```python
import torch

def _softmax(x, axis=-1):
    return torch.softmax(x, dim=axis)
def _gelu(x):
    return torch.nn.functional.gelu(x, approximate="tanh")
def _silu(x):
    return torch.nn.functional.silu(x)
def _sigmoid(x):
    return torch.sigmoid(x)
def _layernorm(x, axis=-1, eps=1e-5):
    m = x.mean(dim=axis, keepdim=True)
    v = x.var(dim=axis, keepdim=True, unbiased=False)
    return (x - m) / torch.sqrt(v + eps)
def _scatter_add(tgt, idx, src, axis=0):
    return tgt.clone().index_add_(axis, idx, src)
def _segment_sum(src, seg, n):
    out = torch.zeros((n,) + src.shape[1:], dtype=src.dtype)
    return out.index_add_(0, seg, src)
def _pad(x, pw):
    flat = tuple(v for pair in reversed(pw) for v in pair)
    return torch.nn.functional.pad(x, flat)

kernel_name = 'gated_mix__compressed_kv_cla__moe_arch_mod__prompt'

def setup_inputs():

    _w = (lambda a: (lambda t: t.to(torch.bfloat16) if t.is_floating_point() else t)(torch.as_tensor(a)))
    def _A_setup():
        B, H, Sq, Sk, D, M = 1, 16, 2048, 2048, 256, 448
        Dc = 4 * D
        return {
            "x": _w((lambda *s: torch.randn(*s, dtype=torch.bfloat16) * 0.05)(B, Sq, M)),
            "c_kv": _w((lambda *s: torch.randn(*s, dtype=torch.bfloat16) * 0.8)(B, Sk, Dc)),
            "w_q": _w((lambda *s: torch.randn(*s, dtype=torch.bfloat16) * 6.4)(M, H, D) * (M ** -0.5)),
            "w_uk": _w((lambda *s: torch.randn(*s, dtype=torch.bfloat16) * 6.4)(Dc, H, D) * (Dc ** -0.5)),
            "w_uv": _w((lambda *s: torch.randn(*s, dtype=torch.bfloat16) * 0.8)(Dc, H, D) * (Dc ** -0.5)),
            "w_o": _w((lambda *s: torch.randn(*s, dtype=torch.bfloat16) * 0.8)(H, D, M) * ((H * D) ** -0.5)),
        }
    _A_in = _A_setup()

    def _B_setup():
        B, S, D, F, C = 1, 2048, 448, 1792, 2
        return {
            "x": _w((lambda *s: torch.randn(*s, dtype=torch.bfloat16) * 0.05)(B, S, D)),
            "w_r": _w((lambda *s: torch.randn(*s, dtype=torch.bfloat16) * 3.2)(D)),
            "w_gate": _w((lambda *s: torch.randn(*s, dtype=torch.bfloat16) * 0.4)(D, F)),
            "w_up": _w((lambda *s: torch.randn(*s, dtype=torch.bfloat16) * 0.4)(D, F)),
            "w_down": _w((lambda *s: torch.randn(*s, dtype=torch.bfloat16) * 0.4)(F, D)),
        }
    _B_in = _B_setup()

    return {
        "A_x": _A_in["x"],
        "A_c_kv": _A_in["c_kv"],
        "A_w_q": _A_in["w_q"],
        "A_w_uk": _A_in["w_uk"],
        "A_w_uv": _A_in["w_uv"],
        "A_w_o": _A_in["w_o"],
        "B_x": _B_in["x"],
        "B_w_r": _B_in["w_r"],
        "B_w_gate": _B_in["w_gate"],
        "B_w_up": _B_in["w_up"],
        "B_w_down": _B_in["w_down"],
        "gate_w": _w((lambda *s: torch.randn(*s, dtype=torch.bfloat16) * 0.05)(448) * 16.0),
    }

def reference(A_x, A_c_kv, A_w_q, A_w_uk, A_w_uv, A_w_o, B_x, B_w_r, B_w_gate, B_w_up, B_w_down, gate_w):
    def _A_ref(x, c_kv, w_q, w_uk, w_uv, w_o):
        B, Sq, M = x.shape[0], x.shape[1], x.shape[2]
        Sk = c_kv.shape[1]
        H, D = w_q.shape[1], w_q.shape[2]
        q = torch.einsum("bqm,mhd->bhqd", x, w_q)
        k = torch.einsum("bkc,chd->bhkd", c_kv, w_uk)
        v = torch.einsum("bkc,chd->bhkd", c_kv, w_uv)
        scores = torch.einsum("bhqd,bhkd->bhqk", q, k) * (D ** -0.5)
        off = Sk - Sq
        qi = torch.arange(Sq)[:, None]
        kj = torch.arange(Sk)[None, :]
        cmask = kj <= (qi + off)
        scores = torch.where(cmask[None, None], scores, -1e9)
        p = _softmax(scores, axis=-1)
        ctx = torch.einsum("bhqk,bhkd->bhqd", p, v)
        return torch.einsum("bhqd,hdm->bqm", ctx, w_o)

    def _B_ref(x, w_r, w_gate, w_up, w_down):
        B, S, D = x.shape
        C = 2
        r = x @ w_r
        idx = torch.argsort(-r, axis=-1)[:, :C]
        idx_e = (lambda x, n, axis: torch.repeat_interleave(x, n, dim=axis))(idx.reshape(B, C, 1), D, axis=2)
        x_sel = (lambda x, i, axis: torch.take_along_dim(x, i, dim=axis))(x, idx_e, axis=1)
        g = _silu(x_sel @ w_gate)
        u = x_sel @ w_up
        y = (g * u) @ w_down
        r_sel = _sigmoid((lambda x, i, axis: torch.take_along_dim(x, i, dim=axis))(r, idx, axis=1))
        y = y * r_sel.reshape(B, C, 1)
        b_off = (torch.arange(B) * S).reshape(B, 1)
        flat_idx = (idx + b_off).reshape(B * C)
        zero = (x * 0.0).reshape(B * S, D)
        upd = _scatter_add(zero, flat_idx, y.reshape(B * C, D), axis=0)
        return x + upd.reshape(B, S, D)

    x = A_x
    g = _sigmoid((x * gate_w).sum(-1, keepdims=True))
    a = _A_ref(x, A_c_kv, A_w_q, A_w_uk, A_w_uv, A_w_o)
    b = _B_ref(x, B_w_r, B_w_gate, B_w_up, B_w_down)
    return g * a + (1 - g) * b
```

```asm
; @launch grid=(256,1,1) block=(256,1,1) lds=163840
.amdgcn_target "amdgcn-amd-amdhsa--gfx950"
.text
.macro M d, a, b, c
v_mfma_f32_16x16x32_bf16 \d, \a, \b, \c
.endm
.globl gated_mix__compressed_kv_cla__moe_arch_mod__prompt_kernel
.p2align 8
.type gated_mix__compressed_kv_cla__moe_arch_mod__prompt_kernel,@function
gated_mix__compressed_kv_cla__moe_arch_mod__prompt_kernel:
 s_cmp_lt_u32 s2, 256
 s_cbranch_scc1 L_go
 s_endpgm
L_go:
 s_load_dwordx8 s[80:87], s[0:1], 0
 s_load_dwordx4 s[88:91], s[0:1], 32
 s_getpc_b64 s[76:77]
L_pc0:
 s_lshr_b32 s42, s2, 3
 s_mov_b32 s79, 0x20000
 s_lshl_b32 s67, s42, 13
 s_mov_b32 s78, L_code_end-L_pc0
 s_and_b32 s77, s77, 0xffff
 v_lshl_add_u32 v31, v0, 5, s67
 buffer_load_dword a240, v31, s[76:79], 0 offen offset:0
 v_lshrrev_b32 v24, 6, v0
 v_and_b32 v0, 63, v0
 s_and_b32 s41, s2, 7
 v_readfirstlane_b32 s20, v24
 s_lshr_b32 s64, s2, 7
 v_and_b32 v24, 15, v0
 v_lshrrev_b32 v25, 4, v0
 s_lshl_b32 s64, s64, 3
 s_add_u32 s41, s41, s64
 s_and_b32 s42, s42, 15
 s_lshr_b32 s45, s42, 3
 v_lshlrev_b32 v28, 1, v25
 v_xor_b32 v28, v28, v24
 v_and_b32 v29, 8, v28
 v_and_b32 v28, 7, v28
 v_lshlrev_b32 v28, 4, v28
 v_lshl_add_u32 v28, v29, 5, v28
 v_lshl_add_u32 v28, v25, 13, v28
 s_lshl_b32 s64, s20, 17
 v_add_u32 v8, s64, v28
 v_xor_b32 v28, 0x100, v8
 v_add_u32 v9, 31744, v8
 v_add_u32 v10, 63488, v28
 v_add_u32 v11, 95232, v28
 s_and_b32 s65, s20, 1
 s_lshr_b32 s66, s20, 1
 v_and_b32 v29, 7, v0
 v_xor_b32 v28, v25, v29
 v_lshlrev_b32 v28, 4, v28
 v_lshrrev_b32 v29, 3, v0
 v_lshl_add_u32 v30, v29, 11, v28
 s_lshl_b32 s64, s66, 19
 s_lshl_b32 s67, s65, 20
 s_add_u32 s64, s64, s67
 v_add_u32 v12, s64, v30
 v_xor_b32 v30, 64, v12
 v_add_u32 v14, 30720, v12
 v_add_u32 v13, 15360, v30
 v_add_u32 v15, 46080, v30
 s_mov_b32 s21, 0
 s_mov_b32 s22, 0
 s_lshl_b32 s23, s20, 12
 s_add_u32 s24, s23, 65536
 s_lshl_b32 s74, s41, 9
 s_sub_u32 s18, 8388608, s74
 s_mov_b32 s19, 0x20000
 s_and_b32 s64, s42, 7
 s_lshl_b32 s64, s64, 16
 s_sub_u32 s50, 4194304, s64
 s_mov_b32 s51, 0x20000
 s_cmp_eq_u32 s45, 0
 s_waitcnt lgkmcnt(0)
 s_cselect_b32 s72, s86, s88
 s_cselect_b32 s73, s87, s89
 s_add_u32 s16, s72, s74
 s_addc_u32 s73, s73, 0
 s_and_b32 s17, s73, 0xffff
 s_add_u32 s48, s82, s64
 s_addc_u32 s73, s83, 0
 s_and_b32 s49, s73, 0xffff
 s_add_u32 m0, s23, 0
 s_nop 0
 buffer_load_dwordx4 v8, s[16:19], s21 offen offset:0  nt lds
 buffer_load_dwordx4 v9, s[16:19], s21 offen offset:1024  nt lds
 buffer_load_dwordx4 v10, s[16:19], s21 offen offset:2048  nt lds
 buffer_load_dwordx4 v11, s[16:19], s21 offen offset:3072  nt lds
 s_add_u32 s21, s21, 128
 s_add_u32 m0, s24, 0
 s_nop 0
 buffer_load_dwordx4 v12, s[48:51], s22 offen offset:0   lds
 buffer_load_dwordx4 v13, s[48:51], s22 offen offset:1024   lds
 buffer_load_dwordx4 v14, s[48:51], s22 offen offset:2048   lds
 buffer_load_dwordx4 v15, s[48:51], s22 offen offset:3072   lds
 s_add_u32 s22, s22, 2097152
 s_add_u32 m0, s23, 16384
 s_nop 0
 buffer_load_dwordx4 v8, s[16:19], s21 offen offset:0  nt lds
 buffer_load_dwordx4 v9, s[16:19], s21 offen offset:1024  nt lds
 buffer_load_dwordx4 v10, s[16:19], s21 offen offset:2048  nt lds
 buffer_load_dwordx4 v11, s[16:19], s21 offen offset:3072  nt lds
 s_add_u32 s21, s21, 524160
 s_load_dwordx2 s[92:93], s[0:1], 56
 s_load_dwordx2 s[94:95], s[0:1], 88
 s_load_dwordx4 s[4:7], s[0:1], 104
 v_lshlrev_b32 v7, 4, v0
 s_mov_b32 s28, 0
 v_lshrrev_b32 v26, 2, v24
 v_and_b32 v28, 1, v25
 v_lshl_or_b32 v28, v28, 2, v26
 v_lshl_add_u32 v29, v25, 3, v26
 v_lshlrev_b32 v29, 8, v29
 v_and_b32 v30, 3, v0
 v_lshl_add_u32 v29, v30, 3, v29
 s_lshl_b32 s64, s65, 2
 s_add_u32 s64, s64, 0
 v_xor_b32 v30, s64, v28
 v_lshl_add_u32 v1, v30, 5, v29
 s_lshl_b32 s64, s65, 2
 s_add_u32 s64, s64, 1
 v_xor_b32 v30, s64, v28
 v_lshl_add_u32 v2, v30, 5, v29
 s_lshl_b32 s64, s65, 2
 s_add_u32 s64, s64, 2
 v_xor_b32 v30, s64, v28
 v_lshl_add_u32 v3, v30, 5, v29
 s_lshl_b32 s64, s65, 2
 s_add_u32 s64, s64, 3
 v_xor_b32 v30, s64, v28
 v_lshl_add_u32 v4, v30, 5, v29
 v_add_u32 v28, 0, v25
 v_lshrrev_b32 v29, 1, v24
 v_xor_b32 v28, v28, v29
 v_lshlrev_b32 v28, 4, v28
 v_lshl_add_u32 v28, v24, 7, v28
 s_lshl_b32 s64, s66, 13
 s_add_u32 s64, s64, 65536
 v_add_u32 v5, s64, v28
 v_add_u32 v28, 4, v25
 v_lshrrev_b32 v29, 1, v24
 v_xor_b32 v28, v28, v29
 v_lshlrev_b32 v28, 4, v28
 v_lshl_add_u32 v28, v24, 7, v28
 s_lshl_b32 s64, s66, 13
 s_add_u32 s64, s64, 65536
 v_add_u32 v6, s64, v28
 s_lshl_b32 s64, s2, 2
 s_add_u32 s64, s64, s20
 s_lshl_b32 s64, s64, 12
 v_lshrrev_b32 v28, 2, v0
 v_and_b32 v29, 3, v0
 v_lshlrev_b32 v29, 7, v29
 v_lshl_add_u32 v28, v28, 11, v29
 v_add_u32 v24, s64, v28
 v_and_b32 v28, 56, v0
 v_lshl_add_u32 v24, v28, 24, v24
 s_mov_b32 s32, s82
 s_and_b32 s33, s83, 0xffff
 s_mov_b32 s34, 4194304
 s_mov_b32 s35, 0x20000
 s_mov_b32 s56, s80
 s_and_b32 s57, s81, 0xffff
 s_mov_b32 s58, 1835008
 s_mov_b32 s59, 0x20000
 s_waitcnt lgkmcnt(0)
 s_mov_b32 s60, s92
 s_and_b32 s61, s93, 0xffff
 s_mov_b32 s62, 896
 s_mov_b32 s63, 0x20000
 s_mov_b32 s68, s94
 s_and_b32 s69, s95, 0xffff
 s_mov_b32 s70, 896
 s_mov_b32 s71, 0x20000
 s_lshl_b32 s95, s20, 11
 s_lshr_b32 s64, s2, 3
 s_lshl_b32 s64, s64, 13
 s_add_u32 s95, s95, s64
 s_mov_b32 s8, s6
 s_and_b32 s9, s7, 0xffff
 s_mov_b32 s10, 268435456
 s_mov_b32 s11, 0x20000
 s_mov_b32 s12, s4
 s_and_b32 s13, s5, 0xffff
 s_mov_b32 s14, 256
 s_mov_b32 s15, 0x20000
 s_add_u32 s72, s84, s74
 s_addc_u32 s73, s85, 0
 s_sub_u32 s75, 3670016, s74
 s_mov_b32 s52, s72
 s_and_b32 s53, s73, 0xffff
 s_mov_b32 s54, s75
 s_mov_b32 s55, 0x20000
 s_mul_i32 s29, s42, 114688
 s_mov_b32 s5, 0x3db8aa3b
 s_mul_i32 s72, s45, 16777216
 s_mul_i32 s73, s41, 1048576
 s_add_u32 s72, s72, s73
 s_bfe_u32 s64, s42, 0x20001
 s_lshl_b32 s64, s64, 15
 s_add_u32 s72, s72, s64
 s_lshl_b32 s64, s66, 17
 s_add_u32 s72, s72, s64
 s_and_b32 s67, s42, 1
 s_cmp_eq_u32 s45, 0
 s_cselect_b32 s64, 12, 14
 s_cselect_b32 s75, 14, 10
 s_lshl_b32 s67, s67, s75
 s_add_u32 s72, s72, s67
 s_lshl_b32 s64, s65, s64
 s_add_u32 s93, s72, s64
 s_load_dwordx4 s[80:83], s[0:1], 64
 s_load_dwordx2 s[84:85], s[0:1], 80
 s_load_dwordx2 s[96:97], s[0:1], 96
 s_cmp_eq_u32 s45, 0
 s_cbranch_scc0 L_kv1
L_kv0:
 s_lshl_b32 s64, s42, 4
 s_add_u32 s64, s64, s41
 s_lshl_b32 s64, s64, 2
 s_add_u32 s64, s64, s20
 s_cmp_lt_u32 s64, 41
 s_cselect_b32 s39, 0, 536870912
 s_min_u32 s64, s64, 41
 s_lshl_b32 s38, s64, 2
 s_max_u32 s67, s64, 8
 s_sub_u32 s67, s67, 8
 s_mul_i32 s67, s67, 3328
 s_lshl_b32 s64, s64, 10
 s_add_u32 s64, s64, s67
 s_add_u32 s73, s64, 104914944
 v_or_b32 v64, s39, v7
 v_mov_b32 v68, 0
 v_mov_b32 v69, 0
 v_mov_b32 v70, 0
 v_mov_b32 v71, 0
 s_lshl_b32 s30, s41, 3
 s_add_u32 s30, s30, s42
 s_lshl_b32 s64, s30, 2
 s_add_u32 s64, s64, s20
 s_mul_i32 s72, s64, 3584
 v_mov_b32 v32, 536870912
 v_cmp_gt_u32 vcc, 56, v0
 s_lshl_b32 s67, s64, 2
 s_nop 0
 v_cndmask_b32 v32, v32, v7, vcc
 buffer_load_dwordx4 v[40:43], v32, s[56:59], s72 offen offset:0
 buffer_load_dwordx4 v[44:47], v32, s[56:59], s72 offen offset:896
 buffer_load_dwordx4 v[48:51], v32, s[56:59], s72 offen offset:1792
 buffer_load_dwordx4 v[52:55], v32, s[56:59], s72 offen offset:2688
 buffer_load_dwordx4 v[56:59], v32, s[60:63], 0 offen
 buffer_load_dwordx4 v[60:63], v32, s[68:71], 0 offen
 buffer_store_dwordx4 v[68:71], v64, s[8:11], s73 offen offset:0 sc1
 buffer_store_dwordx4 v[68:71], v64, s[8:11], s73 offen offset:1024 sc1
 buffer_store_dwordx4 v[68:71], v64, s[8:11], s73 offen offset:2048 sc1
 s_add_u32 m0, s23, 32768
 s_nop 0
 buffer_load_dwordx4 v8, s[16:19], s21 offen offset:0  nt lds
 buffer_load_dwordx4 v9, s[16:19], s21 offen offset:1024  nt lds
 buffer_load_dwordx4 v10, s[16:19], s21 offen offset:2048  nt lds
 buffer_load_dwordx4 v11, s[16:19], s21 offen offset:3072  nt lds
 s_add_u32 s21, s21, 128
 s_add_u32 m0, s24, 16384
 s_nop 0
 buffer_load_dwordx4 v12, s[48:51], s22 offen offset:0   lds
 buffer_load_dwordx4 v13, s[48:51], s22 offen offset:1024   lds
 buffer_load_dwordx4 v14, s[48:51], s22 offen offset:2048   lds
 buffer_load_dwordx4 v15, s[48:51], s22 offen offset:3072   lds
 s_sub_u32 s22, s22, 2097024
 s_waitcnt vmcnt(17) lgkmcnt(0)
 s_barrier
 ds_read_b128 a[160:163], v5 offset:0
 ds_read_b128 a[164:167], v6 offset:0
 ds_read_b64_tr_b16 a[32:33], v1 offset:0
 ds_read_b64_tr_b16 a[34:35], v1 offset:1024
 ds_read_b64_tr_b16 a[36:37], v1 offset:8192
 ds_read_b64_tr_b16 a[38:39], v1 offset:9216
 ds_read_b64_tr_b16 a[40:41], v2 offset:0
 ds_read_b64_tr_b16 a[42:43], v2 offset:1024
 ds_read_b64_tr_b16 a[44:45], v2 offset:8192
 ds_read_b64_tr_b16 a[46:47], v2 offset:9216
 ds_read_b64_tr_b16 a[48:49], v3 offset:0
 ds_read_b64_tr_b16 a[50:51], v3 offset:1024
 ds_read_b64_tr_b16 a[52:53], v3 offset:8192
 ds_read_b64_tr_b16 a[54:55], v3 offset:9216
 ds_read_b64_tr_b16 a[56:57], v4 offset:0
 ds_read_b64_tr_b16 a[58:59], v4 offset:1024
 ds_read_b64_tr_b16 a[60:61], v4 offset:8192
 ds_read_b64_tr_b16 a[62:63], v4 offset:9216
 ds_read_b64_tr_b16 a[64:65], v1 offset:16384
 ds_read_b64_tr_b16 a[66:67], v1 offset:17408
 ds_read_b64_tr_b16 a[68:69], v1 offset:24576
 ds_read_b64_tr_b16 a[70:71], v1 offset:25600
 ds_read_b64_tr_b16 a[72:73], v2 offset:16384
 ds_read_b64_tr_b16 a[74:75], v2 offset:17408
 ds_read_b64_tr_b16 a[76:77], v2 offset:24576
 ds_read_b64_tr_b16 a[78:79], v2 offset:25600
 ds_read_b64_tr_b16 a[80:81], v3 offset:16384
 ds_read_b64_tr_b16 a[82:83], v3 offset:17408
 ds_read_b64_tr_b16 a[84:85], v3 offset:24576
 ds_read_b64_tr_b16 a[86:87], v3 offset:25600
 ds_read_b64_tr_b16 a[88:89], v4 offset:16384
 ds_read_b64_tr_b16 a[90:91], v4 offset:17408
 ds_read_b64_tr_b16 a[92:93], v4 offset:24576
 ds_read_b64_tr_b16 a[94:95], v4 offset:25600
 v_mov_b32 v72, 0
 v_mov_b32 v73, 0
 v_mov_b32 v74, 0
 v_mov_b32 v75, 0
 v_mov_b32 v76, 0
 v_mov_b32 v77, 0
 v_mov_b32 v78, 0
 v_mov_b32 v79, 0
 s_waitcnt vmcnt(12)
 v_dot2c_f32_bf16 v72, v40, v56
 v_dot2c_f32_bf16 v73, v44, v56
 v_dot2c_f32_bf16 v74, v48, v56
 v_dot2c_f32_bf16 v75, v52, v56
 s_waitcnt vmcnt(11)
 v_dot2c_f32_bf16 v76, v40, v60
 v_dot2c_f32_bf16 v77, v44, v60
 v_dot2c_f32_bf16 v78, v48, v60
 v_dot2c_f32_bf16 v79, v52, v60
 v_dot2c_f32_bf16 v72, v41, v57
 v_dot2c_f32_bf16 v73, v45, v57
 v_dot2c_f32_bf16 v74, v49, v57
 v_dot2c_f32_bf16 v75, v53, v57
 v_dot2c_f32_bf16 v76, v41, v61
 v_dot2c_f32_bf16 v77, v45, v61
 v_dot2c_f32_bf16 v78, v49, v61
 v_dot2c_f32_bf16 v79, v53, v61
 v_dot2c_f32_bf16 v72, v42, v58
 v_dot2c_f32_bf16 v73, v46, v58
 v_dot2c_f32_bf16 v74, v50, v58
 v_dot2c_f32_bf16 v75, v54, v58
 v_dot2c_f32_bf16 v76, v42, v62
 v_dot2c_f32_bf16 v77, v46, v62
 v_dot2c_f32_bf16 v78, v50, v62
 v_dot2c_f32_bf16 v79, v54, v62
 v_dot2c_f32_bf16 v72, v43, v59
 v_dot2c_f32_bf16 v73, v47, v59
 v_dot2c_f32_bf16 v74, v51, v59
 v_dot2c_f32_bf16 v75, v55, v59
 v_dot2c_f32_bf16 v76, v43, v63
 v_dot2c_f32_bf16 v77, v47, v63
 v_dot2c_f32_bf16 v78, v51, v63
 v_dot2c_f32_bf16 v79, v55, v63
 v_permlane32_swap_b32 v72, v74
 v_permlane32_swap_b32 v73, v75
 v_permlane32_swap_b32 v76, v78
 v_permlane32_swap_b32 v77, v79
 v_add_f32 v72, v72, v74
 v_add_f32 v73, v73, v75
 v_add_f32 v76, v76, v78
 v_add_f32 v77, v77, v79
 v_lshrrev_b32 v80, 4, v0
 v_permlane16_swap_b32 v72, v73
 v_permlane16_swap_b32 v76, v77
 v_add_f32 v72, v72, v73
 v_add_f32 v76, v76, v77
 v_add_u32 v81, s67, v80
 v_add_f32 v72, v72, v72 row_ror:8 row_mask:0xf bank_mask:0xf
 v_add_f32 v76, v76, v76 row_ror:8 row_mask:0xf bank_mask:0xf
 s_nop 0
 v_add_f32 v72, v72, v72 row_ror:4 row_mask:0xf bank_mask:0xf
 v_add_f32 v76, v76, v76 row_ror:4 row_mask:0xf bank_mask:0xf
 s_nop 0
 v_add_f32 v72, v72, v72 row_ror:2 row_mask:0xf bank_mask:0xf
 v_add_f32 v76, v76, v76 row_ror:2 row_mask:0xf bank_mask:0xf
 s_nop 0
 v_add_f32 v72, v72, v72 row_ror:1 row_mask:0xf bank_mask:0xf
 v_add_f32 v76, v76, v76 row_ror:1 row_mask:0xf bank_mask:0xf
 v_ashrrev_i32 v82, 31, v72
 v_or_b32 v82, 0x80000000, v82
 v_xor_b32 v82, v82, v72
 v_and_b32 v82, 0xfffff800, v82
 v_sub_u32 v81, 2047, v81
 v_or_b32 v82, v82, v81
 v_max_u32 v82, 1, v82
 v_mul_f32 v77, 0xbfb8aa3b, v76
 v_exp_f32 v77, v77
 s_nop 0
 v_add_f32 v77, 1.0, v77
 v_rcp_f32 v76, v77
 s_lshl_b32 s72, s20, 4
 s_add_u32 s72, s72, 163584
 v_lshl_add_u32 v80, v80, 2, s72
 ds_write_b32 v80, v82
 ds_write_b32 v80, v72 offset:64
 ds_write_b32 v80, v76 offset:128
 s_waitcnt lgkmcnt(15)
M a[0:3], a[32:35], a[160:163], 0
 s_add_u32 m0, s23, 49152
 ds_read_b128 a[168:171], v5 offset:2048
 ds_read_b128 a[172:175], v6 offset:2048
M a[0:3], a[36:39], a[164:167], a[0:3]
 buffer_load_dwordx4 v8, s[16:19], s21 offen offset:0  nt lds
M a[4:7], a[44:47], a[164:167], 0
M a[4:7], a[40:43], a[160:163], a[4:7]
M a[8:11], a[48:51], a[160:163], 0
 buffer_load_dwordx4 v9, s[16:19], s21 offen offset:1024  nt lds
M a[8:11], a[52:55], a[164:167], a[8:11]
M a[12:15], a[60:63], a[164:167], 0
M a[12:15], a[56:59], a[160:163], a[12:15]
 buffer_load_dwordx4 v10, s[16:19], s21 offen offset:2048  nt lds
M a[16:19], a[64:67], a[160:163], 0
M a[16:19], a[68:71], a[164:167], a[16:19]
 s_waitcnt lgkmcnt(9)
M a[20:23], a[76:79], a[164:167], 0
 buffer_load_dwordx4 v11, s[16:19], s21 offen offset:3072  nt lds
M a[20:23], a[72:75], a[160:163], a[20:23]
 s_add_u32 s21, s21, 524160
M a[24:27], a[80:83], a[160:163], 0
M a[24:27], a[84:87], a[164:167], a[24:27]
 s_waitcnt lgkmcnt(0)
M a[28:31], a[92:95], a[164:167], 0
 s_waitcnt vmcnt(8)
M a[28:31], a[88:91], a[160:163], a[28:31]
 s_barrier
M v[32:35], a[32:35], a[168:171], 0
 s_add_u32 m0, s24, 32768
 ds_read_b128 a[160:163], v5 offset:4096
 ds_read_b128 a[164:167], v6 offset:4096
M v[32:35], a[36:39], a[172:175], v[32:35]
 ds_read_b64_tr_b16 a[96:97], v1 offset:32768
 ds_read_b64_tr_b16 a[98:99], v1 offset:33792
M v[36:39], a[44:47], a[172:175], 0
 buffer_load_dwordx4 v12, s[48:51], s22 offen offset:0   lds
M v[36:39], a[40:43], a[168:171], v[36:39]
M v[40:43], a[48:51], a[168:171], 0
 ds_read_b64_tr_b16 a[100:101], v1 offset:40960
 ds_read_b64_tr_b16 a[102:103], v1 offset:41984
M v[40:43], a[52:55], a[172:175], v[40:43]
 buffer_load_dwordx4 v13, s[48:51], s22 offen offset:1024   lds
M v[44:47], a[60:63], a[172:175], 0
M v[44:47], a[56:59], a[168:171], v[44:47]
 ds_read_b64_tr_b16 a[104:105], v2 offset:32768
 ds_read_b64_tr_b16 a[106:107], v2 offset:33792
M v[48:51], a[64:67], a[168:171], 0
 buffer_load_dwordx4 v14, s[48:51], s22 offen offset:2048   lds
M v[48:51], a[68:71], a[172:175], v[48:51]
M v[52:55], a[76:79], a[172:175], 0
 ds_read_b64_tr_b16 a[108:109], v2 offset:40960
 ds_read_b64_tr_b16 a[110:111], v2 offset:41984
M v[52:55], a[72:75], a[168:171], v[52:55]
 buffer_load_dwordx4 v15, s[48:51], s22 offen offset:3072   lds
M v[56:59], a[80:83], a[168:171], 0
 s_add_u32 s22, s22, 2097152
M v[56:59], a[84:87], a[172:175], v[56:59]
 s_waitcnt lgkmcnt(8)
 ds_read_b64_tr_b16 a[112:113], v3 offset:32768
 ds_read_b64_tr_b16 a[114:115], v3 offset:33792
M v[60:63], a[92:95], a[172:175], 0
 s_add_u32 m0, s23, 0
M v[60:63], a[88:91], a[168:171], v[60:63]
 buffer_load_dwordx4 v8, s[16:19], s21 offen offset:0  nt lds
M v[64:67], a[32:35], a[160:163], 0
 ds_read_b128 a[168:171], v5 offset:6144
 ds_read_b128 a[172:175], v6 offset:6144
M v[64:67], a[36:39], a[164:167], v[64:67]
 ds_read_b64_tr_b16 a[116:117], v3 offset:40960
 ds_read_b64_tr_b16 a[118:119], v3 offset:41984
M v[68:71], a[44:47], a[164:167], 0
M v[68:71], a[40:43], a[160:163], v[68:71]
 ds_read_b64_tr_b16 a[120:121], v4 offset:32768
 ds_read_b64_tr_b16 a[122:123], v4 offset:33792
M v[72:75], a[48:51], a[160:163], 0
 buffer_load_dwordx4 v9, s[16:19], s21 offen offset:1024  nt lds
M v[72:75], a[52:55], a[164:167], v[72:75]
M v[76:79], a[60:63], a[164:167], 0
 ds_read_b64_tr_b16 a[124:125], v4 offset:40960
 ds_read_b64_tr_b16 a[126:127], v4 offset:41984
M v[76:79], a[56:59], a[160:163], v[76:79]
 buffer_load_dwordx4 v10, s[16:19], s21 offen offset:2048  nt lds
M v[80:83], a[64:67], a[160:163], 0
M v[80:83], a[68:71], a[164:167], v[80:83]
M v[84:87], a[76:79], a[164:167], 0
 buffer_load_dwordx4 v11, s[16:19], s21 offen offset:3072  nt lds
M v[84:87], a[72:75], a[160:163], v[84:87]
 s_add_u32 s21, s21, 128
M v[88:91], a[80:83], a[160:163], 0
M v[88:91], a[84:87], a[164:167], v[88:91]
 s_waitcnt lgkmcnt(6)
M v[92:95], a[92:95], a[164:167], 0
 s_waitcnt vmcnt(8) lgkmcnt(0)
M v[92:95], a[88:91], a[160:163], v[92:95]
 s_barrier
M v[96:99], a[32:35], a[168:171], 0
 s_add_u32 m0, s24, 49152
 ds_read_b128 a[160:163], v5 offset:16384
 ds_read_b128 a[164:167], v6 offset:16384
M v[96:99], a[36:39], a[172:175], v[96:99]
 buffer_load_dwordx4 v12, s[48:51], s22 offen offset:0   lds
M v[100:103], a[44:47], a[172:175], 0
 ds_read_b64_tr_b16 a[128:129], v1 offset:49152
 ds_read_b64_tr_b16 a[130:131], v1 offset:50176
M v[100:103], a[40:43], a[168:171], v[100:103]
M v[104:107], a[48:51], a[168:171], 0
 buffer_load_dwordx4 v13, s[48:51], s22 offen offset:1024   lds
M v[104:107], a[52:55], a[172:175], v[104:107]
M v[108:111], a[60:63], a[172:175], 0
M v[108:111], a[56:59], a[168:171], v[108:111]
M v[112:115], a[64:67], a[168:171], 0
 buffer_load_dwordx4 v14, s[48:51], s22 offen offset:2048   lds
M v[112:115], a[68:71], a[172:175], v[112:115]
 ds_read_b64_tr_b16 a[132:133], v1 offset:57344
 ds_read_b64_tr_b16 a[134:135], v1 offset:58368
M v[116:119], a[76:79], a[172:175], 0
M v[116:119], a[72:75], a[168:171], v[116:119]
M v[120:123], a[80:83], a[168:171], 0
 buffer_load_dwordx4 v15, s[48:51], s22 offen offset:3072   lds
M v[120:123], a[84:87], a[172:175], v[120:123]
 s_waitcnt lgkmcnt(4)
M v[124:127], a[92:95], a[172:175], 0
 s_sub_u32 s22, s22, 2097024
M v[124:127], a[88:91], a[168:171], v[124:127]
 s_add_u32 m0, s23, 16384
M v[128:131], a[32:35], a[160:163], 0
 ds_read_b128 a[168:171], v5 offset:18432
 ds_read_b128 a[172:175], v6 offset:18432
M v[128:131], a[36:39], a[164:167], v[128:131]
 ds_read_b64_tr_b16 a[136:137], v2 offset:49152
 ds_read_b64_tr_b16 a[138:139], v2 offset:50176
M v[132:135], a[44:47], a[164:167], 0
 buffer_load_dwordx4 v8, s[16:19], s21 offen offset:0  nt lds
M v[132:135], a[40:43], a[160:163], v[132:135]
M v[136:139], a[48:51], a[160:163], 0
 buffer_load_dwordx4 v9, s[16:19], s21 offen offset:1024  nt lds
M v[136:139], a[52:55], a[164:167], v[136:139]
M v[140:143], a[60:63], a[164:167], 0
M v[140:143], a[56:59], a[160:163], v[140:143]
 ds_read_b64_tr_b16 a[140:141], v2 offset:57344
 ds_read_b64_tr_b16 a[142:143], v2 offset:58368
M v[144:147], a[64:67], a[160:163], 0
 buffer_load_dwordx4 v10, s[16:19], s21 offen offset:2048  nt lds
M v[144:147], a[68:71], a[164:167], v[144:147]
M v[148:151], a[76:79], a[164:167], 0
M v[148:151], a[72:75], a[160:163], v[148:151]
 buffer_load_dwordx4 v11, s[16:19], s21 offen offset:3072  nt lds
M v[152:155], a[80:83], a[160:163], 0
 s_add_u32 s21, s21, 524160
M v[152:155], a[84:87], a[164:167], v[152:155]
 s_waitcnt lgkmcnt(4)
M v[156:159], a[92:95], a[164:167], 0
 s_add_u32 m0, s24, 0
 ds_read_b64_tr_b16 a[144:145], v3 offset:49152
 ds_read_b64_tr_b16 a[146:147], v3 offset:50176
M v[156:159], a[88:91], a[160:163], v[156:159]
 buffer_load_dwordx4 v12, s[48:51], s22 offen offset:0   lds
M v[160:163], a[32:35], a[168:171], 0
 ds_read_b128 a[160:163], v5 offset:20480
 ds_read_b128 a[164:167], v6 offset:20480
M v[160:163], a[36:39], a[172:175], v[160:163]
M v[164:167], a[44:47], a[172:175], 0
M v[164:167], a[40:43], a[168:171], v[164:167]
 buffer_load_dwordx4 v13, s[48:51], s22 offen offset:1024   lds
M v[168:171], a[48:51], a[168:171], 0
M v[168:171], a[52:55], a[172:175], v[168:171]
 ds_read_b64_tr_b16 a[148:149], v3 offset:57344
 ds_read_b64_tr_b16 a[150:151], v3 offset:58368
M v[172:175], a[60:63], a[172:175], 0
M v[172:175], a[56:59], a[168:171], v[172:175]
 buffer_load_dwordx4 v14, s[48:51], s22 offen offset:2048   lds
M v[176:179], a[64:67], a[168:171], 0
M v[176:179], a[68:71], a[172:175], v[176:179]
M v[180:183], a[76:79], a[172:175], 0
 buffer_load_dwordx4 v15, s[48:51], s22 offen offset:3072   lds
M v[180:183], a[72:75], a[168:171], v[180:183]
 s_add_u32 s22, s22, 2097152
M v[184:187], a[80:83], a[168:171], 0
 ds_read_b64_tr_b16 a[152:153], v4 offset:49152
 ds_read_b64_tr_b16 a[154:155], v4 offset:50176
M v[184:187], a[84:87], a[172:175], v[184:187]
 s_waitcnt lgkmcnt(4)
M v[188:191], a[92:95], a[172:175], 0
 s_add_u32 m0, s23, 32768
M v[188:191], a[88:91], a[168:171], v[188:191]
 buffer_load_dwordx4 v8, s[16:19], s21 offen offset:0  nt lds
M v[192:195], a[32:35], a[160:163], 0
 ds_read_b128 a[168:171], v5 offset:22528
 ds_read_b128 a[172:175], v6 offset:22528
M v[192:195], a[36:39], a[164:167], v[192:195]
M v[196:199], a[44:47], a[164:167], 0
 buffer_load_dwordx4 v9, s[16:19], s21 offen offset:1024  nt lds
M v[196:199], a[40:43], a[160:163], v[196:199]
 ds_read_b64_tr_b16 a[156:157], v4 offset:57344
 ds_read_b64_tr_b16 a[158:159], v4 offset:58368
M v[200:203], a[48:51], a[160:163], 0
M v[200:203], a[52:55], a[164:167], v[200:203]
M v[204:207], a[60:63], a[164:167], 0
 buffer_load_dwordx4 v10, s[16:19], s21 offen offset:2048  nt lds
M v[204:207], a[56:59], a[160:163], v[204:207]
M v[208:211], a[64:67], a[160:163], 0
M v[208:211], a[68:71], a[164:167], v[208:211]
M v[212:215], a[76:79], a[164:167], 0
 buffer_load_dwordx4 v11, s[16:19], s21 offen offset:3072  nt lds
M v[212:215], a[72:75], a[160:163], v[212:215]
 s_add_u32 s21, s21, 128
M v[216:219], a[80:83], a[160:163], 0
M v[216:219], a[84:87], a[164:167], v[216:219]
 s_waitcnt lgkmcnt(2)
M v[220:223], a[92:95], a[164:167], 0
 s_waitcnt vmcnt(16) lgkmcnt(0)
M v[220:223], a[88:91], a[160:163], v[220:223]
 s_barrier
M v[224:227], a[32:35], a[168:171], 0
 ds_read_b128 a[160:163], v5 offset:32768
 ds_read_b128 a[164:167], v6 offset:32768
M v[224:227], a[36:39], a[172:175], v[224:227]
 buffer_load_dword a240, v24, s[32:35], 0 offen offset:512
M v[228:231], a[44:47], a[172:175], 0
M v[228:231], a[40:43], a[168:171], v[228:231]
M v[232:235], a[48:51], a[168:171], 0
M v[232:235], a[52:55], a[172:175], v[232:235]
M v[236:239], a[60:63], a[172:175], 0
M v[236:239], a[56:59], a[168:171], v[236:239]
M v[240:243], a[64:67], a[168:171], 0
M v[240:243], a[68:71], a[172:175], v[240:243]
M v[244:247], a[76:79], a[172:175], 0
M v[244:247], a[72:75], a[168:171], v[244:247]
M v[248:251], a[80:83], a[168:171], 0
M v[248:251], a[84:87], a[172:175], v[248:251]
 s_waitcnt lgkmcnt(0)
M v[252:255], a[92:95], a[172:175], 0
M v[252:255], a[88:91], a[168:171], v[252:255]
M a[0:3], a[96:99], a[160:163], a[0:3]
 ds_read_b128 a[168:171], v5 offset:34816
 ds_read_b128 a[172:175], v6 offset:34816
M a[0:3], a[100:103], a[164:167], a[0:3]
 ds_read_b64_tr_b16 a[32:33], v1 offset:0
 ds_read_b64_tr_b16 a[34:35], v1 offset:1024
M a[4:7], a[108:111], a[164:167], a[4:7]
 s_add_u32 m0, s24, 16384
M a[4:7], a[104:107], a[160:163], a[4:7]
 buffer_load_dwordx4 v12, s[48:51], s22 offen offset:0   lds
M a[8:11], a[112:115], a[160:163], a[8:11]
M a[8:11], a[116:119], a[164:167], a[8:11]
M a[12:15], a[124:127], a[164:167], a[12:15]
 ds_read_b64_tr_b16 a[36:37], v1 offset:8192
 ds_read_b64_tr_b16 a[38:39], v1 offset:9216
M a[12:15], a[120:123], a[160:163], a[12:15]
M a[16:19], a[128:131], a[160:163], a[16:19]
 buffer_load_dwordx4 v13, s[48:51], s22 offen offset:1024   lds
M a[16:19], a[132:135], a[164:167], a[16:19]
M a[20:23], a[140:143], a[164:167], a[20:23]
M a[20:23], a[136:139], a[160:163], a[20:23]
 ds_read_b64_tr_b16 a[40:41], v2 offset:0
 ds_read_b64_tr_b16 a[42:43], v2 offset:1024
M a[24:27], a[144:147], a[160:163], a[24:27]
M a[24:27], a[148:151], a[164:167], a[24:27]
 s_waitcnt lgkmcnt(6)
 buffer_load_dwordx4 v14, s[48:51], s22 offen offset:2048   lds
M a[28:31], a[156:159], a[164:167], a[28:31]
M a[28:31], a[152:155], a[160:163], a[28:31]
M v[32:35], a[96:99], a[168:171], v[32:35]
 ds_read_b128 a[160:163], v5 offset:36864
 ds_read_b128 a[164:167], v6 offset:36864
M v[32:35], a[100:103], a[172:175], v[32:35]
 ds_read_b64_tr_b16 a[44:45], v2 offset:8192
 ds_read_b64_tr_b16 a[46:47], v2 offset:9216
M v[36:39], a[108:111], a[172:175], v[36:39]
 buffer_load_dwordx4 v15, s[48:51], s22 offen offset:3072   lds
M v[36:39], a[104:107], a[168:171], v[36:39]
 s_sub_u32 s22, s22, 2097024
M v[40:43], a[112:115], a[168:171], v[40:43]
M v[40:43], a[116:119], a[172:175], v[40:43]
 ds_read_b64_tr_b16 a[48:49], v3 offset:0
 ds_read_b64_tr_b16 a[50:51], v3 offset:1024
M v[44:47], a[124:127], a[172:175], v[44:47]
 s_add_u32 m0, s23, 49152
M v[44:47], a[120:123], a[168:171], v[44:47]
 buffer_load_dwordx4 v8, s[16:19], s21 offen offset:0  nt lds
M v[48:51], a[128:131], a[168:171], v[48:51]
M v[48:51], a[132:135], a[172:175], v[48:51]
M v[52:55], a[140:143], a[172:175], v[52:55]
 ds_read_b64_tr_b16 a[52:53], v3 offset:8192
 ds_read_b64_tr_b16 a[54:55], v3 offset:9216
M v[52:55], a[136:139], a[168:171], v[52:55]
M v[56:59], a[144:147], a[168:171], v[56:59]
 buffer_load_dwordx4 v9, s[16:19], s21 offen offset:1024  nt lds
M v[56:59], a[148:151], a[172:175], v[56:59]
 s_waitcnt lgkmcnt(6)
M v[60:63], a[156:159], a[172:175], v[60:63]
M v[60:63], a[152:155], a[168:171], v[60:63]
 ds_read_b64_tr_b16 a[56:57], v4 offset:0
 ds_read_b64_tr_b16 a[58:59], v4 offset:1024
M v[64:67], a[96:99], a[160:163], v[64:67]
 ds_read_b128 a[168:171], v5 offset:38912
 ds_read_b128 a[172:175], v6 offset:38912
M v[64:67], a[100:103], a[164:167], v[64:67]
 buffer_load_dwordx4 v10, s[16:19], s21 offen offset:2048  nt lds
M v[68:71], a[108:111], a[164:167], v[68:71]
M v[68:71], a[104:107], a[160:163], v[68:71]
M v[72:75], a[112:115], a[160:163], v[72:75]
 ds_read_b64_tr_b16 a[60:61], v4 offset:8192
 ds_read_b64_tr_b16 a[62:63], v4 offset:9216
M v[72:75], a[116:119], a[164:167], v[72:75]
M v[76:79], a[124:127], a[164:167], v[76:79]
 buffer_load_dwordx4 v11, s[16:19], s21 offen offset:3072  nt lds
M v[76:79], a[120:123], a[160:163], v[76:79]
 s_add_u32 s21, s21, 524160
M v[80:83], a[128:131], a[160:163], v[80:83]
M v[80:83], a[132:135], a[164:167], v[80:83]
M v[84:87], a[140:143], a[164:167], v[84:87]
M v[84:87], a[136:139], a[160:163], v[84:87]
M v[88:91], a[144:147], a[160:163], v[88:91]
M v[88:91], a[148:151], a[164:167], v[88:91]
 s_waitcnt lgkmcnt(2)
M v[92:95], a[156:159], a[164:167], v[92:95]
 s_waitcnt vmcnt(17) lgkmcnt(0)
M v[92:95], a[152:155], a[160:163], v[92:95]
 s_barrier
M v[96:99], a[96:99], a[168:171], v[96:99]
 ds_read_b128 a[160:163], v5 offset:49152
 ds_read_b128 a[164:167], v6 offset:49152
M v[96:99], a[100:103], a[172:175], v[96:99]
M v[100:103], a[108:111], a[172:175], v[100:103]
 s_add_u32 m0, s24, 32768
 ds_read_b64_tr_b16 a[64:65], v1 offset:16384
 ds_read_b64_tr_b16 a[66:67], v1 offset:17408
M v[100:103], a[104:107], a[168:171], v[100:103]
 buffer_load_dwordx4 v12, s[48:51], s22 offen offset:0   lds
M v[104:107], a[112:115], a[168:171], v[104:107]
M v[104:107], a[116:119], a[172:175], v[104:107]
M v[108:111], a[124:127], a[172:175], v[108:111]
M v[108:111], a[120:123], a[168:171], v[108:111]
M v[112:115], a[128:131], a[168:171], v[112:115]
M v[112:115], a[132:135], a[172:175], v[112:115]
 ds_read_b64_tr_b16 a[68:69], v1 offset:24576
 ds_read_b64_tr_b16 a[70:71], v1 offset:25600
M v[116:119], a[140:143], a[172:175], v[116:119]
 buffer_load_dwordx4 v13, s[48:51], s22 offen offset:1024   lds
M v[116:119], a[136:139], a[168:171], v[116:119]
M v[120:123], a[144:147], a[168:171], v[120:123]
M v[120:123], a[148:151], a[172:175], v[120:123]
 s_waitcnt lgkmcnt(4)
M v[124:127], a[156:159], a[172:175], v[124:127]
M v[124:127], a[152:155], a[168:171], v[124:127]
M v[128:131], a[96:99], a[160:163], v[128:131]
 ds_read_b128 a[168:171], v5 offset:51200
 ds_read_b128 a[172:175], v6 offset:51200
M v[128:131], a[100:103], a[164:167], v[128:131]
 ds_read_b64_tr_b16 a[72:73], v2 offset:16384
 ds_read_b64_tr_b16 a[74:75], v2 offset:17408
M v[132:135], a[108:111], a[164:167], v[132:135]
 buffer_load_dwordx4 v14, s[48:51], s22 offen offset:2048   lds
M v[132:135], a[104:107], a[160:163], v[132:135]
M v[136:139], a[112:115], a[160:163], v[136:139]
M v[136:139], a[116:119], a[164:167], v[136:139]
M v[140:143], a[124:127], a[164:167], v[140:143]
M v[140:143], a[120:123], a[160:163], v[140:143]
 ds_read_b64_tr_b16 a[76:77], v2 offset:24576
 ds_read_b64_tr_b16 a[78:79], v2 offset:25600
M v[144:147], a[128:131], a[160:163], v[144:147]
 buffer_load_dwordx4 v15, s[48:51], s22 offen offset:3072   lds
M v[144:147], a[132:135], a[164:167], v[144:147]
 s_add_u32 s22, s22, 2097152
M v[148:151], a[140:143], a[164:167], v[148:151]
M v[148:151], a[136:139], a[160:163], v[148:151]
M v[152:155], a[144:147], a[160:163], v[152:155]
M v[152:155], a[148:151], a[164:167], v[152:155]
 s_waitcnt lgkmcnt(4)
M v[156:159], a[156:159], a[164:167], v[156:159]
 s_add_u32 m0, s23, 0
 ds_read_b64_tr_b16 a[80:81], v3 offset:16384
 ds_read_b64_tr_b16 a[82:83], v3 offset:17408
M v[156:159], a[152:155], a[160:163], v[156:159]
 buffer_load_dwordx4 v8, s[16:19], s21 offen offset:0  nt lds
M v[160:163], a[96:99], a[168:171], v[160:163]
 ds_read_b128 a[160:163], v5 offset:53248
 ds_read_b128 a[164:167], v6 offset:53248
M v[160:163], a[100:103], a[172:175], v[160:163]
M v[164:167], a[108:111], a[172:175], v[164:167]
M v[164:167], a[104:107], a[168:171], v[164:167]
M v[168:171], a[112:115], a[168:171], v[168:171]
M v[168:171], a[116:119], a[172:175], v[168:171]
 ds_read_b64_tr_b16 a[84:85], v3 offset:24576
 ds_read_b64_tr_b16 a[86:87], v3 offset:25600
M v[172:175], a[124:127], a[172:175], v[172:175]
 buffer_load_dwordx4 v9, s[16:19], s21 offen offset:1024  nt lds
M v[172:175], a[120:123], a[168:171], v[172:175]
M v[176:179], a[128:131], a[168:171], v[176:179]
M v[176:179], a[132:135], a[172:175], v[176:179]
M v[180:183], a[140:143], a[172:175], v[180:183]
M v[180:183], a[136:139], a[168:171], v[180:183]
M v[184:187], a[144:147], a[168:171], v[184:187]
 ds_read_b64_tr_b16 a[88:89], v4 offset:16384
 ds_read_b64_tr_b16 a[90:91], v4 offset:17408
M v[184:187], a[148:151], a[172:175], v[184:187]
 s_waitcnt lgkmcnt(4)
 buffer_load_dwordx4 v10, s[16:19], s21 offen offset:2048  nt lds
M v[188:191], a[156:159], a[172:175], v[188:191]
M v[188:191], a[152:155], a[168:171], v[188:191]
M v[192:195], a[96:99], a[160:163], v[192:195]
 ds_read_b128 a[168:171], v5 offset:55296
 ds_read_b128 a[172:175], v6 offset:55296
M v[192:195], a[100:103], a[164:167], v[192:195]
M v[196:199], a[108:111], a[164:167], v[196:199]
M v[196:199], a[104:107], a[160:163], v[196:199]
 ds_read_b64_tr_b16 a[92:93], v4 offset:24576
 ds_read_b64_tr_b16 a[94:95], v4 offset:25600
M v[200:203], a[112:115], a[160:163], v[200:203]
 buffer_load_dwordx4 v11, s[16:19], s21 offen offset:3072  nt lds
M v[200:203], a[116:119], a[164:167], v[200:203]
 s_add_u32 s21, s21, 128
M v[204:207], a[124:127], a[164:167], v[204:207]
M v[204:207], a[120:123], a[160:163], v[204:207]
M v[208:211], a[128:131], a[160:163], v[208:211]
M v[208:211], a[132:135], a[164:167], v[208:211]
M v[212:215], a[140:143], a[164:167], v[212:215]
M v[212:215], a[136:139], a[160:163], v[212:215]
M v[216:219], a[144:147], a[160:163], v[216:219]
M v[216:219], a[148:151], a[164:167], v[216:219]
 s_waitcnt lgkmcnt(2)
M v[220:223], a[156:159], a[164:167], v[220:223]
 s_waitcnt vmcnt(17) lgkmcnt(0)
M v[220:223], a[152:155], a[160:163], v[220:223]
 s_barrier
M v[224:227], a[96:99], a[168:171], v[224:227]
 ds_read_b128 a[160:163], v5 offset:0
 ds_read_b128 a[164:167], v6 offset:0
M v[224:227], a[100:103], a[172:175], v[224:227]
 v_min_u32 v16, 1, v0
 v_lshlrev_b32 v16, 29, v16
M v[228:231], a[108:111], a[172:175], v[228:231]
 v_or_b32 v16, s39, v16
 v_mov_b32 v17, 1
M v[228:231], a[104:107], a[168:171], v[228:231]
 buffer_store_dword v17, v16, s[12:15], s38 offen sc1
M v[232:235], a[112:115], a[168:171], v[232:235]
M v[232:235], a[116:119], a[172:175], v[232:235]
M v[236:239], a[124:127], a[172:175], v[236:239]
M v[236:239], a[120:123], a[168:171], v[236:239]
M v[240:243], a[128:131], a[168:171], v[240:243]
M v[240:243], a[132:135], a[172:175], v[240:243]
M v[244:247], a[140:143], a[172:175], v[244:247]
M v[244:247], a[136:139], a[168:171], v[244:247]
M v[248:251], a[144:147], a[168:171], v[248:251]
M v[248:251], a[148:151], a[172:175], v[248:251]
 s_waitcnt lgkmcnt(0)
M v[252:255], a[156:159], a[172:175], v[252:255]
M v[252:255], a[152:155], a[168:171], v[252:255]
M a[0:3], a[32:35], a[160:163], a[0:3]
 ds_read_b128 a[168:171], v5 offset:2048
 ds_read_b128 a[172:175], v6 offset:2048
M a[0:3], a[36:39], a[164:167], a[0:3]
 ds_read_b64_tr_b16 a[96:97], v1 offset:32768
 ds_read_b64_tr_b16 a[98:99], v1 offset:33792
M a[4:7], a[44:47], a[164:167], a[4:7]
 s_add_u32 m0, s24, 49152
M a[4:7], a[40:43], a[160:163], a[4:7]
 buffer_load_dwordx4 v12, s[48:51], s22 offen offset:0   lds
M a[8:11], a[48:51], a[160:163], a[8:11]
 v_and_b32 v20, 31, v0
M a[8:11], a[52:55], a[164:167], a[8:11]
 v_lshlrev_b32 v20, 2, v20
M a[12:15], a[60:63], a[164:167], a[12:15]
 ds_read_b64_tr_b16 a[100:101], v1 offset:40960
 ds_read_b64_tr_b16 a[102:103], v1 offset:41984
M a[12:15], a[56:59], a[160:163], a[12:15]
 v_add_u32 v21, 163584, v20
M a[16:19], a[64:67], a[160:163], a[16:19]
 buffer_load_dwordx4 v13, s[48:51], s22 offen offset:1024   lds
M a[16:19], a[68:71], a[164:167], a[16:19]
 ds_read_b32 v19, v21
M a[20:23], a[76:79], a[164:167], a[20:23]
 ds_read_b32 v21, v21 offset:64
M a[20:23], a[72:75], a[160:163], a[20:23]
 s_min_u32 s64, s20, 1
 ds_read_b64_tr_b16 a[104:105], v2 offset:32768
 ds_read_b64_tr_b16 a[106:107], v2 offset:33792
M a[24:27], a[80:83], a[160:163], a[24:27]
 s_lshl_b32 s64, s64, 29
 v_and_b32 v22, 32, v0
M a[24:27], a[84:87], a[164:167], a[24:27]
 s_waitcnt lgkmcnt(8)
 buffer_load_dwordx4 v14, s[48:51], s22 offen offset:2048   lds
M a[28:31], a[92:95], a[164:167], a[28:31]
 v_lshl_or_b32 v20, v22, 24, v20
M a[28:31], a[88:91], a[160:163], a[28:31]
 v_or_b32 v20, s64, v20
M v[32:35], a[32:35], a[168:171], v[32:35]
 ds_read_b128 a[160:163], v5 offset:4096
 ds_read_b128 a[164:167], v6 offset:4096
M v[32:35], a[36:39], a[172:175], v[32:35]
 ds_read_b64_tr_b16 a[108:109], v2 offset:40960
 ds_read_b64_tr_b16 a[110:111], v2 offset:41984
M v[36:39], a[44:47], a[172:175], v[36:39]
 buffer_load_dwordx4 v15, s[48:51], s22 offen offset:3072   lds
M v[36:39], a[40:43], a[168:171], v[36:39]
 s_sub_u32 s22, s22, 2097024
 v_and_b32 v22, 16, v0
M v[40:43], a[48:51], a[168:171], v[40:43]
 v_lshl_or_b32 v18, v22, 25, v20
M v[40:43], a[52:55], a[172:175], v[40:43]
 s_lshl_b32 s72, s30, 7
 ds_read_b64_tr_b16 a[112:113], v3 offset:32768
 ds_read_b64_tr_b16 a[114:115], v3 offset:33792
M v[44:47], a[60:63], a[172:175], v[44:47]
 s_add_u32 m0, s23, 16384
 s_add_u32 s72, s72, 104857600
M v[44:47], a[56:59], a[168:171], v[44:47]
 buffer_load_dwordx4 v8, s[16:19], s21 offen offset:0  nt lds
M v[48:51], a[64:67], a[168:171], v[48:51]
M v[48:51], a[68:71], a[172:175], v[48:51]
M v[52:55], a[76:79], a[172:175], v[52:55]
 ds_read_b64_tr_b16 a[116:117], v3 offset:40960
 ds_read_b64_tr_b16 a[118:119], v3 offset:41984
M v[52:55], a[72:75], a[168:171], v[52:55]
M v[56:59], a[80:83], a[168:171], v[56:59]
 buffer_load_dwordx4 v9, s[16:19], s21 offen offset:1024  nt lds
M v[56:59], a[84:87], a[172:175], v[56:59]
 s_waitcnt lgkmcnt(6)
 buffer_store_dword v21, v20, s[8:11], s72 offen sc1
M v[60:63], a[92:95], a[172:175], v[60:63]
M v[60:63], a[88:91], a[168:171], v[60:63]
 ds_read_b64_tr_b16 a[120:121], v4 offset:32768
 ds_read_b64_tr_b16 a[122:123], v4 offset:33792
M v[64:67], a[32:35], a[160:163], v[64:67]
 ds_read_b128 a[168:171], v5 offset:6144
 ds_read_b128 a[172:175], v6 offset:6144
M v[64:67], a[36:39], a[164:167], v[64:67]
 buffer_load_dwordx4 v10, s[16:19], s21 offen offset:2048  nt lds
M v[68:71], a[44:47], a[164:167], v[68:71]
M v[68:71], a[40:43], a[160:163], v[68:71]
M v[72:75], a[48:51], a[160:163], v[72:75]
 ds_read_b64_tr_b16 a[124:125], v4 offset:40960
 ds_read_b64_tr_b16 a[126:127], v4 offset:41984
M v[72:75], a[52:55], a[164:167], v[72:75]
M v[76:79], a[60:63], a[164:167], v[76:79]
 buffer_load_dwordx4 v11, s[16:19], s21 offen offset:3072  nt lds
M v[76:79], a[56:59], a[160:163], v[76:79]
 s_add_u32 s21, s21, 524160
M v[80:83], a[64:67], a[160:163], v[80:83]
M v[80:83], a[68:71], a[164:167], v[80:83]
M v[84:87], a[76:79], a[164:167], v[84:87]
M v[84:87], a[72:75], a[160:163], v[84:87]
 s_and_b32 s86, s41, 7
M v[88:91], a[80:83], a[160:163], v[88:91]
 s_mul_i32 s86, s86, 14
 s_lshr_b32 s64, s41, 3
 s_mul_i32 s64, s64, 7
M v[88:91], a[84:87], a[164:167], v[88:91]
 s_waitcnt lgkmcnt(2)
 s_add_u32 s86, s86, s64
 s_min_u32 s64, s42, 6
M v[92:95], a[92:95], a[164:167], v[92:95]
 s_waitcnt vmcnt(18) lgkmcnt(0)
 s_add_u32 s86, s86, s64
 s_sub_u32 s64, 6, s42
M v[92:95], a[88:91], a[160:163], v[92:95]
 s_barrier
M v[96:99], a[32:35], a[168:171], v[96:99]
 ds_read_b128 a[160:163], v5 offset:16384
 ds_read_b128 a[164:167], v6 offset:16384
M v[96:99], a[36:39], a[172:175], v[96:99]
 s_and_b32 s88, s64, 536870912
 s_mul_i32 s87, s20, 7168
M v[100:103], a[44:47], a[172:175], v[100:103]
 s_add_u32 m0, s24, 0
 ds_read_b64_tr_b16 a[128:129], v1 offset:49152
 ds_read_b64_tr_b16 a[130:131], v1 offset:50176
M v[100:103], a[40:43], a[168:171], v[100:103]
 buffer_load_dwordx4 v12, s[48:51], s22 offen offset:0   lds
M v[104:107], a[48:51], a[168:171], v[104:107]
 s_add_u32 s87, s87, 131072
M v[104:107], a[52:55], a[172:175], v[104:107]
 s_cmp_lt_u32 s20, 2
M v[108:111], a[60:63], a[172:175], v[108:111]
 s_cselect_b64 s[72:73], s[80:81], s[82:83]
M v[108:111], a[56:59], a[168:171], v[108:111]
 s_mov_b32 s60, s72
M v[112:115], a[64:67], a[168:171], v[112:115]
 s_and_b32 s61, s73, 0xffff
M v[112:115], a[68:71], a[172:175], v[112:115]
 s_mov_b32 s62, 1605632
 ds_read_b64_tr_b16 a[132:133], v1 offset:57344
 ds_read_b64_tr_b16 a[134:135], v1 offset:58368
M v[116:119], a[76:79], a[172:175], v[116:119]
 s_mov_b32 s63, 0x20000
 buffer_load_dwordx4 v13, s[48:51], s22 offen offset:1024   lds
M v[116:119], a[72:75], a[168:171], v[116:119]
 s_mov_b32 s68, s84
M v[120:123], a[80:83], a[168:171], v[120:123]
 s_and_b32 s69, s85, 0xffff
 s_mov_b32 s70, 1605632
 s_mov_b32 s71, 0x20000
M v[120:123], a[84:87], a[172:175], v[120:123]
 s_waitcnt lgkmcnt(4)
 s_lshl_b32 s89, s86, 5
M v[124:127], a[92:95], a[172:175], v[124:127]
 s_and_b32 s64, s20, 1
M v[124:127], a[88:91], a[168:171], v[124:127]
 s_mul_i32 s64, s64, 802816
 buffer_load_dwordx4 v14, s[48:51], s22 offen offset:2048   lds
M v[128:131], a[32:35], a[160:163], v[128:131]
 s_add_u32 s89, s89, s64
 ds_read_b128 a[168:171], v5 offset:18432
 ds_read_b128 a[172:175], v6 offset:18432
M v[128:131], a[36:39], a[164:167], v[128:131]
 ds_read_b64_tr_b16 a[136:137], v2 offset:49152
 ds_read_b64_tr_b16 a[138:139], v2 offset:50176
M v[132:135], a[44:47], a[164:167], v[132:135]
 v_lshrrev_b32 v28, 1, v0
 v_mul_u32_u24 v28, 3584, v28
M v[132:135], a[40:43], a[160:163], v[132:135]
 v_and_b32 v29, 1, v0
 v_lshl_add_u32 v25, v29, 4, v28
M v[136:139], a[48:51], a[160:163], v[136:139]
 v_or_b32 v25, s88, v25
M v[136:139], a[52:55], a[164:167], v[136:139]
M v[140:143], a[60:63], a[164:167], v[140:143]
 buffer_load_dwordx4 v15, s[48:51], s22 offen offset:3072   lds
M v[140:143], a[56:59], a[160:163], v[140:143]
 s_add_u32 s22, s22, 2097152
 ds_read_b64_tr_b16 a[140:141], v2 offset:57344
 ds_read_b64_tr_b16 a[142:143], v2 offset:58368
M v[144:147], a[64:67], a[160:163], v[144:147]
M v[144:147], a[68:71], a[164:167], v[144:147]
M v[148:151], a[76:79], a[164:167], v[148:151]
M v[148:151], a[72:75], a[160:163], v[148:151]
 s_add_u32 m0, s23, 32768
M v[152:155], a[80:83], a[160:163], v[152:155]
 buffer_load_dwordx4 v8, s[16:19], s21 offen offset:0  nt lds
M v[152:155], a[84:87], a[164:167], v[152:155]
 s_waitcnt lgkmcnt(4)
M v[156:159], a[92:95], a[164:167], v[156:159]
 ds_read_b64_tr_b16 a[144:145], v3 offset:49152
 ds_read_b64_tr_b16 a[146:147], v3 offset:50176
M v[156:159], a[88:91], a[160:163], v[156:159]
M v[160:163], a[32:35], a[168:171], v[160:163]
 ds_read_b128 a[160:163], v5 offset:20480
 ds_read_b128 a[164:167], v6 offset:20480
M v[160:163], a[36:39], a[172:175], v[160:163]
M v[164:167], a[44:47], a[172:175], v[164:167]
 buffer_load_dwordx4 v9, s[16:19], s21 offen offset:1024  nt lds
M v[164:167], a[40:43], a[168:171], v[164:167]
M v[168:171], a[48:51], a[168:171], v[168:171]
M v[168:171], a[52:55], a[172:175], v[168:171]
 ds_read_b64_tr_b16 a[148:149], v3 offset:57344
 ds_read_b64_tr_b16 a[150:151], v3 offset:58368
M v[172:175], a[60:63], a[172:175], v[172:175]
M v[172:175], a[56:59], a[168:171], v[172:175]
M v[176:179], a[64:67], a[168:171], v[176:179]
M v[176:179], a[68:71], a[172:175], v[176:179]
 buffer_load_dwordx4 v10, s[16:19], s21 offen offset:2048  nt lds
M v[180:183], a[76:79], a[172:175], v[180:183]
M v[180:183], a[72:75], a[168:171], v[180:183]
M v[184:187], a[80:83], a[168:171], v[184:187]
 ds_read_b64_tr_b16 a[152:153], v4 offset:49152
 ds_read_b64_tr_b16 a[154:155], v4 offset:50176
M v[184:187], a[84:87], a[172:175], v[184:187]
 s_waitcnt lgkmcnt(4)
M v[188:191], a[92:95], a[172:175], v[188:191]
M v[188:191], a[88:91], a[168:171], v[188:191]
 buffer_load_dwordx4 v11, s[16:19], s21 offen offset:3072  nt lds
M v[192:195], a[32:35], a[160:163], v[192:195]
 s_add_u32 s21, s21, 128
 ds_read_b128 a[168:171], v5 offset:22528
 ds_read_b128 a[172:175], v6 offset:22528
M v[192:195], a[36:39], a[164:167], v[192:195]
M v[196:199], a[44:47], a[164:167], v[196:199]
M v[196:199], a[40:43], a[160:163], v[196:199]
 ds_read_b64_tr_b16 a[156:157], v4 offset:57344
 ds_read_b64_tr_b16 a[158:159], v4 offset:58368
M v[200:203], a[48:51], a[160:163], v[200:203]
 s_add_u32 m0, s87, 0
M v[200:203], a[52:55], a[164:167], v[200:203]
 buffer_load_dwordx4 v25, s[60:63], s89 offen offset:0 nt lds
M v[204:207], a[60:63], a[164:167], v[204:207]
 s_add_u32 s89, s89, 114688
M v[204:207], a[56:59], a[160:163], v[204:207]
M v[208:211], a[64:67], a[160:163], v[208:211]
M v[208:211], a[68:71], a[164:167], v[208:211]
M v[212:215], a[76:79], a[164:167], v[212:215]
M v[212:215], a[72:75], a[160:163], v[212:215]
M v[216:219], a[80:83], a[160:163], v[216:219]
M v[216:219], a[84:87], a[164:167], v[216:219]
 s_waitcnt lgkmcnt(2)
M v[220:223], a[92:95], a[164:167], v[220:223]
 s_waitcnt vmcnt(19) lgkmcnt(0)
M v[220:223], a[88:91], a[160:163], v[220:223]
 s_barrier
M v[224:227], a[32:35], a[168:171], v[224:227]
 ds_read_b128 a[160:163], v5 offset:32768
 ds_read_b128 a[164:167], v6 offset:32768
M v[224:227], a[36:39], a[172:175], v[224:227]
M v[228:231], a[44:47], a[172:175], v[228:231]
M v[228:231], a[40:43], a[168:171], v[228:231]
M v[232:235], a[48:51], a[168:171], v[232:235]
M v[232:235], a[52:55], a[172:175], v[232:235]
M v[236:239], a[60:63], a[172:175], v[236:239]
M v[236:239], a[56:59], a[168:171], v[236:239]
M v[240:243], a[64:67], a[168:171], v[240:243]
M v[240:243], a[68:71], a[172:175], v[240:243]
M v[244:247], a[76:79], a[172:175], v[244:247]
M v[244:247], a[72:75], a[168:171], v[244:247]
M v[248:251], a[80:83], a[168:171], v[248:251]
M v[248:251], a[84:87], a[172:175], v[248:251]
 s_waitcnt lgkmcnt(0)
M v[252:255], a[92:95], a[172:175], v[252:255]
M v[252:255], a[88:91], a[168:171], v[252:255]
M a[0:3], a[96:99], a[160:163], a[0:3]
 ds_read_b128 a[168:171], v5 offset:34816
 ds_read_b128 a[172:175], v6 offset:34816
M a[0:3], a[100:103], a[164:167], a[0:3]
 ds_read_b64_tr_b16 a[32:33], v1 offset:0
 ds_read_b64_tr_b16 a[34:35], v1 offset:1024
M a[4:7], a[108:111], a[164:167], a[4:7]
 s_add_u32 m0, s24, 16384
M a[4:7], a[104:107], a[160:163], a[4:7]
 buffer_load_dwordx4 v12, s[48:51], s22 offen offset:0   lds
M a[8:11], a[112:115], a[160:163], a[8:11]
M a[8:11], a[116:119], a[164:167], a[8:11]
M a[12:15], a[124:127], a[164:167], a[12:15]
 ds_read_b64_tr_b16 a[36:37], v1 offset:8192
 ds_read_b64_tr_b16 a[38:39], v1 offset:9216
M a[12:15], a[120:123], a[160:163], a[12:15]
M a[16:19], a[128:131], a[160:163], a[16:19]
 buffer_load_dwordx4 v13, s[48:51], s22 offen offset:1024   lds
M a[16:19], a[132:135], a[164:167], a[16:19]
M a[20:23], a[140:143], a[164:167], a[20:23]
M a[20:23], a[136:139], a[160:163], a[20:23]
 ds_read_b64_tr_b16 a[40:41], v2 offset:0
 ds_read_b64_tr_b16 a[42:43], v2 offset:1024
M a[24:27], a[144:147], a[160:163], a[24:27]
M a[24:27], a[148:151], a[164:167], a[24:27]
 s_waitcnt lgkmcnt(6)
 buffer_load_dwordx4 v14, s[48:51], s22 offen offset:2048   lds
M a[28:31], a[156:159], a[164:167], a[28:31]
M a[28:31], a[152:155], a[160:163], a[28:31]
M v[32:35], a[96:99], a[168:171], v[32:35]
 ds_read_b128 a[160:163], v5 offset:36864
 ds_read_b128 a[164:167], v6 offset:36864
M v[32:35], a[100:103], a[172:175], v[32:35]
 ds_read_b64_tr_b16 a[44:45], v2 offset:8192
 ds_read_b64_tr_b16 a[46:47], v2 offset:9216
M v[36:39], a[108:111], a[172:175], v[36:39]
 buffer_load_dwordx4 v15, s[48:51], s22 offen offset:3072   lds
M v[36:39], a[104:107], a[168:171], v[36:39]
 s_sub_u32 s22, s22, 2097024
M v[40:43], a[112:115], a[168:171], v[40:43]
M v[40:43], a[116:119], a[172:175], v[40:43]
 ds_read_b64_tr_b16 a[48:49], v3 offset:0
 ds_read_b64_tr_b16 a[50:51], v3 offset:1024
M v[44:47], a[124:127], a[172:175], v[44:47]
 s_add_u32 m0, s23, 49152
M v[44:47], a[120:123], a[168:171], v[44:47]
 buffer_load_dwordx4 v8, s[16:19], s21 offen offset:0  nt lds
M v[48:51], a[128:131], a[168:171], v[48:51]
M v[48:51], a[132:135], a[172:175], v[48:51]
M v[52:55], a[140:143], a[172:175], v[52:55]
 ds_read_b64_tr_b16 a[52:53], v3 offset:8192
 ds_read_b64_tr_b16 a[54:55], v3 offset:9216
M v[52:55], a[136:139], a[168:171], v[52:55]
M v[56:59], a[144:147], a[168:171], v[56:59]
 buffer_load_dwordx4 v9, s[16:19], s21 offen offset:1024  nt lds
M v[56:59], a[148:151], a[172:175], v[56:59]
 s_waitcnt lgkmcnt(6)
M v[60:63], a[156:159], a[172:175], v[60:63]
M v[60:63], a[152:155], a[168:171], v[60:63]
 ds_read_b64_tr_b16 a[56:57], v4 offset:0
 ds_read_b64_tr_b16 a[58:59], v4 offset:1024
M v[64:67], a[96:99], a[160:163], v[64:67]
 ds_read_b128 a[168:171], v5 offset:38912
 ds_read_b128 a[172:175], v6 offset:38912
M v[64:67], a[100:103], a[164:167], v[64:67]
 buffer_load_dwordx4 v10, s[16:19], s21 offen offset:2048  nt lds
M v[68:71], a[108:111], a[164:167], v[68:71]
M v[68:71], a[104:107], a[160:163], v[68:71]
M v[72:75], a[112:115], a[160:163], v[72:75]
 ds_read_b64_tr_b16 a[60:61], v4 offset:8192
 ds_read_b64_tr_b16 a[62:63], v4 offset:9216
M v[72:75], a[116:119], a[164:167], v[72:75]
M v[76:79], a[124:127], a[164:167], v[76:79]
 buffer_load_dwordx4 v11, s[16:19], s21 offen offset:3072  nt lds
M v[76:79], a[120:123], a[160:163], v[76:79]
 s_add_u32 s21, s21, 524160
M v[80:83], a[128:131], a[160:163], v[80:83]
M v[80:83], a[132:135], a[164:167], v[80:83]
M v[84:87], a[140:143], a[164:167], v[84:87]
M v[84:87], a[136:139], a[160:163], v[84:87]
M v[88:91], a[144:147], a[160:163], v[88:91]
M v[88:91], a[148:151], a[164:167], v[88:91]
 s_waitcnt lgkmcnt(2)
M v[92:95], a[156:159], a[164:167], v[92:95]
 s_waitcnt vmcnt(17) lgkmcnt(0)
M v[92:95], a[152:155], a[160:163], v[92:95]
 s_barrier
M v[96:99], a[96:99], a[168:171], v[96:99]
 ds_read_b128 a[160:163], v5 offset:49152
 ds_read_b128 a[164:167], v6 offset:49152
M v[96:99], a[100:103], a[172:175], v[96:99]
M v[100:103], a[108:111], a[172:175], v[100:103]
 s_add_u32 m0, s24, 32768
 ds_read_b64_tr_b16 a[64:65], v1 offset:16384
 ds_read_b64_tr_b16 a[66:67], v1 offset:17408
M v[100:103], a[104:107], a[168:171], v[100:103]
 buffer_load_dwordx4 v12, s[48:51], s22 offen offset:0   lds
M v[104:107], a[112:115], a[168:171], v[104:107]
 v_min_u32 v16, 40, v0
 v_lshlrev_b32 v16, 2, v16
M v[104:107], a[116:119], a[172:175], v[104:107]
 buffer_load_dword v17, v16, s[12:15], 0 offen sc1
M v[108:111], a[124:127], a[172:175], v[108:111]
M v[108:111], a[120:123], a[168:171], v[108:111]
M v[112:115], a[128:131], a[168:171], v[112:115]
M v[112:115], a[132:135], a[172:175], v[112:115]
 ds_read_b64_tr_b16 a[68:69], v1 offset:24576
 ds_read_b64_tr_b16 a[70:71], v1 offset:25600
M v[116:119], a[140:143], a[172:175], v[116:119]
 buffer_load_dwordx4 v13, s[48:51], s22 offen offset:1024   lds
M v[116:119], a[136:139], a[168:171], v[116:119]
M v[120:123], a[144:147], a[168:171], v[120:123]
M v[120:123], a[148:151], a[172:175], v[120:123]
 s_waitcnt lgkmcnt(4)
M v[124:127], a[156:159], a[172:175], v[124:127]
M v[124:127], a[152:155], a[168:171], v[124:127]
 buffer_load_dwordx4 v14, s[48:51], s22 offen offset:2048   lds
M v[128:131], a[96:99], a[160:163], v[128:131]
 ds_read_b128 a[168:171], v5 offset:51200
 ds_read_b128 a[172:175], v6 offset:51200
M v[128:131], a[100:103], a[164:167], v[128:131]
 ds_read_b64_tr_b16 a[72:73], v2 offset:16384
 ds_read_b64_tr_b16 a[74:75], v2 offset:17408
M v[132:135], a[108:111], a[164:167], v[132:135]
M v[132:135], a[104:107], a[160:163], v[132:135]
M v[136:139], a[112:115], a[160:163], v[136:139]
M v[136:139], a[116:119], a[164:167], v[136:139]
M v[140:143], a[124:127], a[164:167], v[140:143]
 buffer_load_dwordx4 v15, s[48:51], s22 offen offset:3072   lds
M v[140:143], a[120:123], a[160:163], v[140:143]
 s_add_u32 s22, s22, 2097152
 ds_read_b64_tr_b16 a[76:77], v2 offset:24576
 ds_read_b64_tr_b16 a[78:79], v2 offset:25600
M v[144:147], a[128:131], a[160:163], v[144:147]
M v[144:147], a[132:135], a[164:167], v[144:147]
M v[148:151], a[140:143], a[164:167], v[148:151]
M v[148:151], a[136:139], a[160:163], v[148:151]
 s_add_u32 m0, s23, 0
M v[152:155], a[144:147], a[160:163], v[152:155]
 buffer_load_dwordx4 v8, s[16:19], s21 offen offset:0  nt lds
M v[152:155], a[148:151], a[164:167], v[152:155]
 s_waitcnt lgkmcnt(4)
M v[156:159], a[156:159], a[164:167], v[156:159]
 ds_read_b64_tr_b16 a[80:81], v3 offset:16384
 ds_read_b64_tr_b16 a[82:83], v3 offset:17408
M v[156:159], a[152:155], a[160:163], v[156:159]
M v[160:163], a[96:99], a[168:171], v[160:163]
 ds_read_b128 a[160:163], v5 offset:53248
 ds_read_b128 a[164:167], v6 offset:53248
M v[160:163], a[100:103], a[172:175], v[160:163]
M v[164:167], a[108:111], a[172:175], v[164:167]
 buffer_load_dwordx4 v9, s[16:19], s21 offen offset:1024  nt lds
M v[164:167], a[104:107], a[168:171], v[164:167]
M v[168:171], a[112:115], a[168:171], v[168:171]
M v[168:171], a[116:119], a[172:175], v[168:171]
 ds_read_b64_tr_b16 a[84:85], v3 offset:24576
 ds_read_b64_tr_b16 a[86:87], v3 offset:25600
M v[172:175], a[124:127], a[172:175], v[172:175]
M v[172:175], a[120:123], a[168:171], v[172:175]
M v[176:179], a[128:131], a[168:171], v[176:179]
M v[176:179], a[132:135], a[172:175], v[176:179]
 buffer_load_dwordx4 v10, s[16:19], s21 offen offset:2048  nt lds
M v[180:183], a[140:143], a[172:175], v[180:183]
M v[180:183], a[136:139], a[168:171], v[180:183]
M v[184:187], a[144:147], a[168:171], v[184:187]
 ds_read_b64_tr_b16 a[88:89], v4 offset:16384
 ds_read_b64_tr_b16 a[90:91], v4 offset:17408
M v[184:187], a[148:151], a[172:175], v[184:187]
 s_waitcnt lgkmcnt(4)
M v[188:191], a[156:159], a[172:175], v[188:191]
M v[188:191], a[152:155], a[168:171], v[188:191]
 buffer_load_dwordx4 v11, s[16:19], s21 offen offset:3072  nt lds
M v[192:195], a[96:99], a[160:163], v[192:195]
 s_add_u32 s21, s21, 128
 ds_read_b128 a[168:171], v5 offset:55296
 ds_read_b128 a[172:175], v6 offset:55296
M v[192:195], a[100:103], a[164:167], v[192:195]
M v[196:199], a[108:111], a[164:167], v[196:199]
M v[196:199], a[104:107], a[160:163], v[196:199]
 ds_read_b64_tr_b16 a[92:93], v4 offset:24576
 ds_read_b64_tr_b16 a[94:95], v4 offset:25600
M v[200:203], a[112:115], a[160:163], v[200:203]
 s_add_u32 m0, s87, 1024
M v[200:203], a[116:119], a[164:167], v[200:203]
 buffer_load_dwordx4 v25, s[60:63], s89 offen offset:0 nt lds
M v[204:207], a[124:127], a[164:167], v[204:207]
 s_add_u32 s89, s89, 114688
M v[204:207], a[120:123], a[160:163], v[204:207]
M v[208:211], a[128:131], a[160:163], v[208:211]
M v[208:211], a[132:135], a[164:167], v[208:211]
M v[212:215], a[140:143], a[164:167], v[212:215]
M v[212:215], a[136:139], a[160:163], v[212:215]
M v[216:219], a[144:147], a[160:163], v[216:219]
M v[216:219], a[148:151], a[164:167], v[216:219]
 s_waitcnt lgkmcnt(2)
M v[220:223], a[156:159], a[164:167], v[220:223]
 s_waitcnt vmcnt(19) lgkmcnt(0)
M v[220:223], a[152:155], a[160:163], v[220:223]
 s_barrier
M v[224:227], a[96:99], a[168:171], v[224:227]
 ds_read_b128 a[160:163], v5 offset:0
 ds_read_b128 a[164:167], v6 offset:0
M v[224:227], a[100:103], a[172:175], v[224:227]
M v[228:231], a[108:111], a[172:175], v[228:231]
M v[228:231], a[104:107], a[168:171], v[228:231]
M v[232:235], a[112:115], a[168:171], v[232:235]
M v[232:235], a[116:119], a[172:175], v[232:235]
M v[236:239], a[124:127], a[172:175], v[236:239]
M v[236:239], a[120:123], a[168:171], v[236:239]
M v[240:243], a[128:131], a[168:171], v[240:243]
M v[240:243], a[132:135], a[172:175], v[240:243]
M v[244:247], a[140:143], a[172:175], v[244:247]
M v[244:247], a[136:139], a[168:171], v[244:247]
M v[248:251], a[144:147], a[168:171], v[248:251]
M v[248:251], a[148:151], a[172:175], v[248:251]
 s_waitcnt lgkmcnt(0)
M v[252:255], a[156:159], a[172:175], v[252:255]
M v[252:255], a[152:155], a[168:171], v[252:255]
M a[0:3], a[32:35], a[160:163], a[0:3]
 ds_read_b128 a[168:171], v5 offset:2048
 ds_read_b128 a[172:175], v6 offset:2048
M a[0:3], a[36:39], a[164:167], a[0:3]
 ds_read_b64_tr_b16 a[96:97], v1 offset:32768
 ds_read_b64_tr_b16 a[98:99], v1 offset:33792
M a[4:7], a[44:47], a[164:167], a[4:7]
 s_add_u32 m0, s24, 49152
M a[4:7], a[40:43], a[160:163], a[4:7]
 buffer_load_dwordx4 v12, s[48:51], s22 offen offset:0   lds
M a[8:11], a[48:51], a[160:163], a[8:11]
M a[8:11], a[52:55], a[164:167], a[8:11]
M a[12:15], a[60:63], a[164:167], a[12:15]
 ds_read_b64_tr_b16 a[100:101], v1 offset:40960
 ds_read_b64_tr_b16 a[102:103], v1 offset:41984
M a[12:15], a[56:59], a[160:163], a[12:15]
M a[16:19], a[64:67], a[160:163], a[16:19]
 buffer_load_dwordx4 v13, s[48:51], s22 offen offset:1024   lds
M a[16:19], a[68:71], a[164:167], a[16:19]
M a[20:23], a[76:79], a[164:167], a[20:23]
M a[20:23], a[72:75], a[160:163], a[20:23]
 ds_read_b64_tr_b16 a[104:105], v2 offset:32768
 ds_read_b64_tr_b16 a[106:107], v2 offset:33792
M a[24:27], a[80:83], a[160:163], a[24:27]
M a[24:27], a[84:87], a[164:167], a[24:27]
 s_waitcnt lgkmcnt(6)
 buffer_load_dwordx4 v14, s[48:51], s22 offen offset:2048   lds
M a[28:31], a[92:95], a[164:167], a[28:31]
M a[28:31], a[88:91], a[160:163], a[28:31]
M v[32:35], a[32:35], a[168:171], v[32:35]
 ds_read_b128 a[160:163], v5 offset:4096
 ds_read_b128 a[164:167], v6 offset:4096
M v[32:35], a[36:39], a[172:175], v[32:35]
 ds_read_b64_tr_b16 a[108:109], v2 offset:40960
 ds_read_b64_tr_b16 a[110:111], v2 offset:41984
M v[36:39], a[44:47], a[172:175], v[36:39]
 buffer_load_dwordx4 v15, s[48:51], s22 offen offset:3072   lds
M v[36:39], a[40:43], a[168:171], v[36:39]
 s_sub_u32 s22, s22, 2097024
M v[40:43], a[48:51], a[168:171], v[40:43]
M v[40:43], a[52:55], a[172:175], v[40:43]
 ds_read_b64_tr_b16 a[112:113], v3 offset:32768
 ds_read_b64_tr_b16 a[114:115], v3 offset:33792
M v[44:47], a[60:63], a[172:175], v[44:47]
 s_add_u32 m0, s23, 16384
M v[44:47], a[56:59], a[168:171], v[44:47]
 buffer_load_dwordx4 v8, s[16:19], s21 offen offset:0  nt lds
M v[48:51], a[64:67], a[168:171], v[48:51]
M v[48:51], a[68:71], a[172:175], v[48:51]
M v[52:55], a[76:79], a[172:175], v[52:55]
 ds_read_b64_tr_b16 a[116:117], v3 offset:40960
 ds_read_b64_tr_b16 a[118:119], v3 offset:41984
M v[52:55], a[72:75], a[168:171], v[52:55]
M v[56:59], a[80:83], a[168:171], v[56:59]
 buffer_load_dwordx4 v9, s[16:19], s21 offen offset:1024  nt lds
M v[56:59], a[84:87], a[172:175], v[56:59]
 s_waitcnt lgkmcnt(6)
M v[60:63], a[92:95], a[172:175], v[60:63]
M v[60:63], a[88:91], a[168:171], v[60:63]
 ds_read_b64_tr_b16 a[120:121], v4 offset:32768
 ds_read_b64_tr_b16 a[122:123], v4 offset:33792
M v[64:67], a[32:35], a[160:163], v[64:67]
 ds_read_b128 a[168:171], v5 offset:6144
 ds_read_b128 a[172:175], v6 offset:6144
M v[64:67], a[36:39], a[164:167], v[64:67]
 buffer_load_dwordx4 v10, s[16:19], s21 offen offset:2048  nt lds
M v[68:71], a[44:47], a[164:167], v[68:71]
M v[68:71], a[40:43], a[160:163], v[68:71]
M v[72:75], a[48:51], a[160:163], v[72:75]
 ds_read_b64_tr_b16 a[124:125], v4 offset:40960
 ds_read_b64_tr_b16 a[126:127], v4 offset:41984
M v[72:75], a[52:55], a[164:167], v[72:75]
M v[76:79], a[60:63], a[164:167], v[76:79]
 buffer_load_dwordx4 v11, s[16:19], s21 offen offset:3072  nt lds
M v[76:79], a[56:59], a[160:163], v[76:79]
 s_add_u32 s21, s21, 524160
M v[80:83], a[64:67], a[160:163], v[80:83]
M v[80:83], a[68:71], a[164:167], v[80:83]
M v[84:87], a[76:79], a[164:167], v[84:87]
M v[84:87], a[72:75], a[160:163], v[84:87]
M v[88:91], a[80:83], a[160:163], v[88:91]
M v[88:91], a[84:87], a[164:167], v[88:91]
 s_waitcnt lgkmcnt(2)
M v[92:95], a[92:95], a[164:167], v[92:95]
 s_waitcnt vmcnt(18) lgkmcnt(0)
M v[92:95], a[88:91], a[160:163], v[92:95]
 s_barrier
M v[96:99], a[32:35], a[168:171], v[96:99]
 ds_read_b128 a[160:163], v5 offset:16384
 ds_read_b128 a[164:167], v6 offset:16384
M v[96:99], a[36:39], a[172:175], v[96:99]
M v[100:103], a[44:47], a[172:175], v[100:103]
 s_add_u32 m0, s24, 0
 ds_read_b64_tr_b16 a[128:129], v1 offset:49152
 ds_read_b64_tr_b16 a[130:131], v1 offset:50176
M v[100:103], a[40:43], a[168:171], v[100:103]
 buffer_load_dwordx4 v12, s[48:51], s22 offen offset:0   lds
M v[104:107], a[48:51], a[168:171], v[104:107]
M v[104:107], a[52:55], a[172:175], v[104:107]
M v[108:111], a[60:63], a[172:175], v[108:111]
M v[108:111], a[56:59], a[168:171], v[108:111]
M v[112:115], a[64:67], a[168:171], v[112:115]
M v[112:115], a[68:71], a[172:175], v[112:115]
 ds_read_b64_tr_b16 a[132:133], v1 offset:57344
 ds_read_b64_tr_b16 a[134:135], v1 offset:58368
M v[116:119], a[76:79], a[172:175], v[116:119]
 buffer_load_dwordx4 v13, s[48:51], s22 offen offset:1024   lds
M v[116:119], a[72:75], a[168:171], v[116:119]
M v[120:123], a[80:83], a[168:171], v[120:123]
M v[120:123], a[84:87], a[172:175], v[120:123]
 s_waitcnt lgkmcnt(4)
M v[124:127], a[92:95], a[172:175], v[124:127]
M v[124:127], a[88:91], a[168:171], v[124:127]
 buffer_load_dwordx4 v14, s[48:51], s22 offen offset:2048   lds
M v[128:131], a[32:35], a[160:163], v[128:131]
 ds_read_b128 a[168:171], v5 offset:18432
 ds_read_b128 a[172:175], v6 offset:18432
M v[128:131], a[36:39], a[164:167], v[128:131]
 ds_read_b64_tr_b16 a[136:137], v2 offset:49152
 ds_read_b64_tr_b16 a[138:139], v2 offset:50176
M v[132:135], a[44:47], a[164:167], v[132:135]
M v[132:135], a[40:43], a[160:163], v[132:135]
M v[136:139], a[48:51], a[160:163], v[136:139]
M v[136:139], a[52:55], a[164:167], v[136:139]
M v[140:143], a[60:63], a[164:167], v[140:143]
 buffer_load_dwordx4 v15, s[48:51], s22 offen offset:3072   lds
M v[140:143], a[56:59], a[160:163], v[140:143]
 s_add_u32 s22, s22, 2097152
 ds_read_b64_tr_b16 a[140:141], v2 offset:57344
 ds_read_b64_tr_b16 a[142:143], v2 offset:58368
M v[144:147], a[64:67], a[160:163], v[144:147]
M v[144:147], a[68:71], a[164:167], v[144:147]
M v[148:151], a[76:79], a[164:167], v[148:151]
M v[148:151], a[72:75], a[160:163], v[148:151]
 s_add_u32 m0, s23, 32768
M v[152:155], a[80:83], a[160:163], v[152:155]
 buffer_load_dwordx4 v8, s[16:19], s21 offen offset:0  nt lds
M v[152:155], a[84:87], a[164:167], v[152:155]
 s_waitcnt lgkmcnt(4)
M v[156:159], a[92:95], a[164:167], v[156:159]
 ds_read_b64_tr_b16 a[144:145], v3 offset:49152
 ds_read_b64_tr_b16 a[146:147], v3 offset:50176
M v[156:159], a[88:91], a[160:163], v[156:159]
M v[160:163], a[32:35], a[168:171], v[160:163]
 ds_read_b128 a[160:163], v5 offset:20480
 ds_read_b128 a[164:167], v6 offset:20480
M v[160:163], a[36:39], a[172:175], v[160:163]
M v[164:167], a[44:47], a[172:175], v[164:167]
 buffer_load_dwordx4 v9, s[16:19], s21 offen offset:1024  nt lds
M v[164:167], a[40:43], a[168:171], v[164:167]
M v[168:171], a[48:51], a[168:171], v[168:171]
M v[168:171], a[52:55], a[172:175], v[168:171]
 ds_read_b64_tr_b16 a[148:149], v3 offset:57344
 ds_read_b64_tr_b16 a[150:151], v3 offset:58368
M v[172:175], a[60:63], a[172:175], v[172:175]
M v[172:175], a[56:59], a[168:171], v[172:175]
M v[176:179], a[64:67], a[168:171], v[176:179]
M v[176:179], a[68:71], a[172:175], v[176:179]
 buffer_load_dwordx4 v10, s[16:19], s21 offen offset:2048  nt lds
M v[180:183], a[76:79], a[172:175], v[180:183]
M v[180:183], a[72:75], a[168:171], v[180:183]
M v[184:187], a[80:83], a[168:171], v[184:187]
 ds_read_b64_tr_b16 a[152:153], v4 offset:49152
 ds_read_b64_tr_b16 a[154:155], v4 offset:50176
M v[184:187], a[84:87], a[172:175], v[184:187]
 s_waitcnt lgkmcnt(4)
M v[188:191], a[92:95], a[172:175], v[188:191]
M v[188:191], a[88:91], a[168:171], v[188:191]
 buffer_load_dwordx4 v11, s[16:19], s21 offen offset:3072  nt lds
M v[192:195], a[32:35], a[160:163], v[192:195]
 s_add_u32 s21, s21, 128
 ds_read_b128 a[168:171], v5 offset:22528
 ds_read_b128 a[172:175], v6 offset:22528
M v[192:195], a[36:39], a[164:167], v[192:195]
M v[196:199], a[44:47], a[164:167], v[196:199]
M v[196:199], a[40:43], a[160:163], v[196:199]
 ds_read_b64_tr_b16 a[156:157], v4 offset:57344
 ds_read_b64_tr_b16 a[158:159], v4 offset:58368
M v[200:203], a[48:51], a[160:163], v[200:203]
 s_add_u32 m0, s87, 2048
M v[200:203], a[52:55], a[164:167], v[200:203]
 buffer_load_dwordx4 v25, s[60:63], s89 offen offset:0 nt lds
M v[204:207], a[60:63], a[164:167], v[204:207]
 s_add_u32 s89, s89, 114688
M v[204:207], a[56:59], a[160:163], v[204:207]
M v[208:211], a[64:67], a[160:163], v[208:211]
M v[208:211], a[68:71], a[164:167], v[208:211]
M v[212:215], a[76:79], a[164:167], v[212:215]
M v[212:215], a[72:75], a[160:163], v[212:215]
M v[216:219], a[80:83], a[160:163], v[216:219]
M v[216:219], a[84:87], a[164:167], v[216:219]
 s_waitcnt lgkmcnt(2)
M v[220:223], a[92:95], a[164:167], v[220:223]
 s_waitcnt vmcnt(18) lgkmcnt(0)
M v[220:223], a[88:91], a[160:163], v[220:223]
 s_barrier
M v[224:227], a[32:35], a[168:171], v[224:227]
 ds_read_b128 a[160:163], v5 offset:32768
 ds_read_b128 a[164:167], v6 offset:32768
M v[224:227], a[36:39], a[172:175], v[224:227]
 v_cmp_ne_u32 vcc, 1, v17
M v[228:231], a[44:47], a[172:175], v[228:231]
 s_nop 0
 buffer_load_dword a240, v24, s[32:35], 0 offen offset:1024
M v[228:231], a[40:43], a[168:171], v[228:231]
 s_cbranch_vccnz L_zs0
L_zr0:
M v[232:235], a[48:51], a[168:171], v[232:235]
M v[232:235], a[52:55], a[172:175], v[232:235]
 s_lshl_b32 s72, s30, 6
M v[236:239], a[60:63], a[172:175], v[236:239]
 s_add_u32 s72, s72, 104914944
M v[236:239], a[56:59], a[168:171], v[236:239]
 buffer_store_dword v19, v18, s[8:11], s72 offen sc1
M v[240:243], a[64:67], a[168:171], v[240:243]
M v[240:243], a[68:71], a[172:175], v[240:243]
M v[244:247], a[76:79], a[172:175], v[244:247]
M v[244:247], a[72:75], a[168:171], v[244:247]
M v[248:251], a[80:83], a[168:171], v[248:251]
M v[248:251], a[84:87], a[172:175], v[248:251]
 s_waitcnt lgkmcnt(0)
M v[252:255], a[92:95], a[172:175], v[252:255]
M v[252:255], a[88:91], a[168:171], v[252:255]
M a[0:3], a[96:99], a[160:163], a[0:3]
 ds_read_b128 a[168:171], v5 offset:34816
 ds_read_b128 a[172:175], v6 offset:34816
M a[0:3], a[100:103], a[164:167], a[0:3]
 ds_read_b64_tr_b16 a[32:33], v1 offset:0
 ds_read_b64_tr_b16 a[34:35], v1 offset:1024
M a[4:7], a[108:111], a[164:167], a[4:7]
 s_add_u32 m0, s24, 16384
M a[4:7], a[104:107], a[160:163], a[4:7]
 buffer_load_dwordx4 v12, s[48:51], s22 offen offset:0   lds
M a[8:11], a[112:115], a[160:163], a[8:11]
M a[8:11], a[116:119], a[164:167], a[8:11]
M a[12:15], a[124:127], a[164:167], a[12:15]
 ds_read_b64_tr_b16 a[36:37], v1 offset:8192
 ds_read_b64_tr_b16 a[38:39], v1 offset:9216
M a[12:15], a[120:123], a[160:163], a[12:15]
M a[16:19], a[128:131], a[160:163], a[16:19]
 buffer_load_dwordx4 v13, s[48:51], s22 offen offset:1024   lds
M a[16:19], a[132:135], a[164:167], a[16:19]
M a[20:23], a[140:143], a[164:167], a[20:23]
M a[20:23], a[136:139], a[160:163], a[20:23]
 ds_read_b64_tr_b16 a[40:41], v2 offset:0
 ds_read_b64_tr_b16 a[42:43], v2 offset:1024
M a[24:27], a[144:147], a[160:163], a[24:27]
M a[24:27], a[148:151], a[164:167], a[24:27]
 s_waitcnt lgkmcnt(6)
 buffer_load_dwordx4 v14, s[48:51], s22 offen offset:2048   lds
M a[28:31], a[156:159], a[164:167], a[28:31]
M a[28:31], a[152:155], a[160:163], a[28:31]
M v[32:35], a[96:99], a[168:171], v[32:35]
 ds_read_b128 a[160:163], v5 offset:36864
 ds_read_b128 a[164:167], v6 offset:36864
M v[32:35], a[100:103], a[172:175], v[32:35]
 ds_read_b64_tr_b16 a[44:45], v2 offset:8192
 ds_read_b64_tr_b16 a[46:47], v2 offset:9216
M v[36:39], a[108:111], a[172:175], v[36:39]
 buffer_load_dwordx4 v15, s[48:51], s22 offen offset:3072   lds
M v[36:39], a[104:107], a[168:171], v[36:39]
 s_sub_u32 s22, s22, 2097024
M v[40:43], a[112:115], a[168:171], v[40:43]
M v[40:43], a[116:119], a[172:175], v[40:43]
 ds_read_b64_tr_b16 a[48:49], v3 offset:0
 ds_read_b64_tr_b16 a[50:51], v3 offset:1024
M v[44:47], a[124:127], a[172:175], v[44:47]
 s_add_u32 m0, s23, 49152
M v[44:47], a[120:123], a[168:171], v[44:47]
 buffer_load_dwordx4 v8, s[16:19], s21 offen offset:0  nt lds
M v[48:51], a[128:131], a[168:171], v[48:51]
M v[48:51], a[132:135], a[172:175], v[48:51]
M v[52:55], a[140:143], a[172:175], v[52:55]
 ds_read_b64_tr_b16 a[52:53], v3 offset:8192
 ds_read_b64_tr_b16 a[54:55], v3 offset:9216
M v[52:55], a[136:139], a[168:171], v[52:55]
M v[56:59], a[144:147], a[168:171], v[56:59]
 buffer_load_dwordx4 v9, s[16:19], s21 offen offset:1024  nt lds
M v[56:59], a[148:151], a[172:175], v[56:59]
 s_waitcnt lgkmcnt(6)
M v[60:63], a[156:159], a[172:175], v[60:63]
M v[60:63], a[152:155], a[168:171], v[60:63]
 ds_read_b64_tr_b16 a[56:57], v4 offset:0
 ds_read_b64_tr_b16 a[58:59], v4 offset:1024
M v[64:67], a[96:99], a[160:163], v[64:67]
 ds_read_b128 a[168:171], v5 offset:38912
 ds_read_b128 a[172:175], v6 offset:38912
M v[64:67], a[100:103], a[164:167], v[64:67]
 buffer_load_dwordx4 v10, s[16:19], s21 offen offset:2048  nt lds
M v[68:71], a[108:111], a[164:167], v[68:71]
M v[68:71], a[104:107], a[160:163], v[68:71]
M v[72:75], a[112:115], a[160:163], v[72:75]
 ds_read_b64_tr_b16 a[60:61], v4 offset:8192
 ds_read_b64_tr_b16 a[62:63], v4 offset:9216
M v[72:75], a[116:119], a[164:167], v[72:75]
M v[76:79], a[124:127], a[164:167], v[76:79]
 buffer_load_dwordx4 v11, s[16:19], s21 offen offset:3072  nt lds
M v[76:79], a[120:123], a[160:163], v[76:79]
 s_add_u32 s21, s21, 524160
M v[80:83], a[128:131], a[160:163], v[80:83]
M v[80:83], a[132:135], a[164:167], v[80:83]
M v[84:87], a[140:143], a[164:167], v[84:87]
M v[84:87], a[136:139], a[160:163], v[84:87]
M v[88:91], a[144:147], a[160:163], v[88:91]
M v[88:91], a[148:151], a[164:167], v[88:91]
 s_waitcnt lgkmcnt(2)
M v[92:95], a[156:159], a[164:167], v[92:95]
 s_waitcnt vmcnt(19) lgkmcnt(0)
M v[92:95], a[152:155], a[160:163], v[92:95]
 s_barrier
M v[96:99], a[96:99], a[168:171], v[96:99]
 ds_read_b128 a[160:163], v5 offset:49152
 ds_read_b128 a[164:167], v6 offset:49152
M v[96:99], a[100:103], a[172:175], v[96:99]
M v[100:103], a[108:111], a[172:175], v[100:103]
 s_add_u32 m0, s24, 32768
 ds_read_b64_tr_b16 a[64:65], v1 offset:16384
 ds_read_b64_tr_b16 a[66:67], v1 offset:17408
M v[100:103], a[104:107], a[168:171], v[100:103]
 buffer_load_dwordx4 v12, s[48:51], s22 offen offset:0   lds
M v[104:107], a[112:115], a[168:171], v[104:107]
M v[104:107], a[116:119], a[172:175], v[104:107]
M v[108:111], a[124:127], a[172:175], v[108:111]
M v[108:111], a[120:123], a[168:171], v[108:111]
M v[112:115], a[128:131], a[168:171], v[112:115]
M v[112:115], a[132:135], a[172:175], v[112:115]
 ds_read_b64_tr_b16 a[68:69], v1 offset:24576
 ds_read_b64_tr_b16 a[70:71], v1 offset:25600
M v[116:119], a[140:143], a[172:175], v[116:119]
 buffer_load_dwordx4 v13, s[48:51], s22 offen offset:1024   lds
M v[116:119], a[136:139], a[168:171], v[116:119]
M v[120:123], a[144:147], a[168:171], v[120:123]
M v[120:123], a[148:151], a[172:175], v[120:123]
 s_waitcnt lgkmcnt(4)
M v[124:127], a[156:159], a[172:175], v[124:127]
M v[124:127], a[152:155], a[168:171], v[124:127]
 buffer_load_dwordx4 v14, s[48:51], s22 offen offset:2048   lds
M v[128:131], a[96:99], a[160:163], v[128:131]
 ds_read_b128 a[168:171], v5 offset:51200
 ds_read_b128 a[172:175], v6 offset:51200
M v[128:131], a[100:103], a[164:167], v[128:131]
 ds_read_b64_tr_b16 a[72:73], v2 offset:16384
 ds_read_b64_tr_b16 a[74:75], v2 offset:17408
M v[132:135], a[108:111], a[164:167], v[132:135]
M v[132:135], a[104:107], a[160:163], v[132:135]
M v[136:139], a[112:115], a[160:163], v[136:139]
M v[136:139], a[116:119], a[164:167], v[136:139]
M v[140:143], a[124:127], a[164:167], v[140:143]
 buffer_load_dwordx4 v15, s[48:51], s22 offen offset:3072   lds
M v[140:143], a[120:123], a[160:163], v[140:143]
 s_add_u32 s22, s22, 2097152
 ds_read_b64_tr_b16 a[76:77], v2 offset:24576
 ds_read_b64_tr_b16 a[78:79], v2 offset:25600
M v[144:147], a[128:131], a[160:163], v[144:147]
M v[144:147], a[132:135], a[164:167], v[144:147]
M v[148:151], a[140:143], a[164:167], v[148:151]
M v[148:151], a[136:139], a[160:163], v[148:151]
 s_add_u32 m0, s23, 0
M v[152:155], a[144:147], a[160:163], v[152:155]
 buffer_load_dwordx4 v8, s[16:19], s21 offen offset:0  nt lds
M v[152:155], a[148:151], a[164:167], v[152:155]
 s_waitcnt lgkmcnt(4)
M v[156:159], a[156:159], a[164:167], v[156:159]
 ds_read_b64_tr_b16 a[80:81], v3 offset:16384
 ds_read_b64_tr_b16 a[82:83], v3 offset:17408
M v[156:159], a[152:155], a[160:163], v[156:159]
M v[160:163], a[96:99], a[168:171], v[160:163]
 ds_read_b128 a[160:163], v5 offset:53248
 ds_read_b128 a[164:167], v6 offset:53248
M v[160:163], a[100:103], a[172:175], v[160:163]
M v[164:167], a[108:111], a[172:175], v[164:167]
 buffer_load_dwordx4 v9, s[16:19], s21 offen offset:1024  nt lds
M v[164:167], a[104:107], a[168:171], v[164:167]
M v[168:171], a[112:115], a[168:171], v[168:171]
M v[168:171], a[116:119], a[172:175], v[168:171]
 ds_read_b64_tr_b16 a[84:85], v3 offset:24576
 ds_read_b64_tr_b16 a[86:87], v3 offset:25600
M v[172:175], a[124:127], a[172:175], v[172:175]
M v[172:175], a[120:123], a[168:171], v[172:175]
M v[176:179], a[128:131], a[168:171], v[176:179]
M v[176:179], a[132:135], a[172:175], v[176:179]
 buffer_load_dwordx4 v10, s[16:19], s21 offen offset:2048  nt lds
M v[180:183], a[140:143], a[172:175], v[180:183]
M v[180:183], a[136:139], a[168:171], v[180:183]
M v[184:187], a[144:147], a[168:171], v[184:187]
 ds_read_b64_tr_b16 a[88:89], v4 offset:16384
 ds_read_b64_tr_b16 a[90:91], v4 offset:17408
M v[184:187], a[148:151], a[172:175], v[184:187]
 s_waitcnt lgkmcnt(4)
M v[188:191], a[156:159], a[172:175], v[188:191]
M v[188:191], a[152:155], a[168:171], v[188:191]
 buffer_load_dwordx4 v11, s[16:19], s21 offen offset:3072  nt lds
M v[192:195], a[96:99], a[160:163], v[192:195]
 s_add_u32 s21, s21, 128
 ds_read_b128 a[168:171], v5 offset:55296
 ds_read_b128 a[172:175], v6 offset:55296
M v[192:195], a[100:103], a[164:167], v[192:195]
M v[196:199], a[108:111], a[164:167], v[196:199]
M v[196:199], a[104:107], a[160:163], v[196:199]
 ds_read_b64_tr_b16 a[92:93], v4 offset:24576
 ds_read_b64_tr_b16 a[94:95], v4 offset:25600
M v[200:203], a[112:115], a[160:163], v[200:203]
 s_add_u32 m0, s87, 3072
M v[200:203], a[116:119], a[164:167], v[200:203]
 buffer_load_dwordx4 v25, s[60:63], s89 offen offset:0 nt lds
M v[204:207], a[124:127], a[164:167], v[204:207]
 s_add_u32 s89, s89, 114688
M v[204:207], a[120:123], a[160:163], v[204:207]
M v[208:211], a[128:131], a[160:163], v[208:211]
M v[208:211], a[132:135], a[164:167], v[208:211]
M v[212:215], a[140:143], a[164:167], v[212:215]
M v[212:215], a[136:139], a[160:163], v[212:215]
M v[216:219], a[144:147], a[160:163], v[216:219]
M v[216:219], a[148:151], a[164:167], v[216:219]
 s_waitcnt lgkmcnt(2)
M v[220:223], a[156:159], a[164:167], v[220:223]
 s_waitcnt vmcnt(20) lgkmcnt(0)
M v[220:223], a[152:155], a[160:163], v[220:223]
 s_barrier
M v[224:227], a[96:99], a[168:171], v[224:227]
 ds_read_b128 a[160:163], v5 offset:0
 ds_read_b128 a[164:167], v6 offset:0
M v[224:227], a[100:103], a[172:175], v[224:227]
M v[228:231], a[108:111], a[172:175], v[228:231]
M v[228:231], a[104:107], a[168:171], v[228:231]
M v[232:235], a[112:115], a[168:171], v[232:235]
M v[232:235], a[116:119], a[172:175], v[232:235]
M v[236:239], a[124:127], a[172:175], v[236:239]
M v[236:239], a[120:123], a[168:171], v[236:239]
M v[240:243], a[128:131], a[168:171], v[240:243]
M v[240:243], a[132:135], a[172:175], v[240:243]
M v[244:247], a[140:143], a[172:175], v[244:247]
M v[244:247], a[136:139], a[168:171], v[244:247]
M v[248:251], a[144:147], a[168:171], v[248:251]
M v[248:251], a[148:151], a[172:175], v[248:251]
 s_waitcnt lgkmcnt(0)
M v[252:255], a[156:159], a[172:175], v[252:255]
M v[252:255], a[152:155], a[168:171], v[252:255]
M a[0:3], a[32:35], a[160:163], a[0:3]
 ds_read_b128 a[168:171], v5 offset:2048
 ds_read_b128 a[172:175], v6 offset:2048
M a[0:3], a[36:39], a[164:167], a[0:3]
 ds_read_b64_tr_b16 a[96:97], v1 offset:32768
 ds_read_b64_tr_b16 a[98:99], v1 offset:33792
M a[4:7], a[44:47], a[164:167], a[4:7]
 s_add_u32 m0, s24, 49152
M a[4:7], a[40:43], a[160:163], a[4:7]
 buffer_load_dwordx4 v12, s[48:51], s22 offen offset:0   lds
M a[8:11], a[48:51], a[160:163], a[8:11]
M a[8:11], a[52:55], a[164:167], a[8:11]
M a[12:15], a[60:63], a[164:167], a[12:15]
 ds_read_b64_tr_b16 a[100:101], v1 offset:40960
 ds_read_b64_tr_b16 a[102:103], v1 offset:41984
M a[12:15], a[56:59], a[160:163], a[12:15]
M a[16:19], a[64:67], a[160:163], a[16:19]
 buffer_load_dwordx4 v13, s[48:51], s22 offen offset:1024   lds
M a[16:19], a[68:71], a[164:167], a[16:19]
M a[20:23], a[76:79], a[164:167], a[20:23]
M a[20:23], a[72:75], a[160:163], a[20:23]
 ds_read_b64_tr_b16 a[104:105], v2 offset:32768
 ds_read_b64_tr_b16 a[106:107], v2 offset:33792
M a[24:27], a[80:83], a[160:163], a[24:27]
M a[24:27], a[84:87], a[164:167], a[24:27]
 s_waitcnt lgkmcnt(6)
 buffer_load_dwordx4 v14, s[48:51], s22 offen offset:2048   lds
M a[28:31], a[92:95], a[164:167], a[28:31]
M a[28:31], a[88:91], a[160:163], a[28:31]
M v[32:35], a[32:35], a[168:171], v[32:35]
 ds_read_b128 a[160:163], v5 offset:4096
 ds_read_b128 a[164:167], v6 offset:4096
M v[32:35], a[36:39], a[172:175], v[32:35]
 ds_read_b64_tr_b16 a[108:109], v2 offset:40960
 ds_read_b64_tr_b16 a[110:111], v2 offset:41984
M v[36:39], a[44:47], a[172:175], v[36:39]
 buffer_load_dwordx4 v15, s[48:51], s22 offen offset:3072   lds
M v[36:39], a[40:43], a[168:171], v[36:39]
 s_sub_u32 s22, s22, 2097024
M v[40:43], a[48:51], a[168:171], v[40:43]
M v[40:43], a[52:55], a[172:175], v[40:43]
 ds_read_b64_tr_b16 a[112:113], v3 offset:32768
 ds_read_b64_tr_b16 a[114:115], v3 offset:33792
M v[44:47], a[60:63], a[172:175], v[44:47]
 s_add_u32 m0, s23, 16384
M v[44:47], a[56:59], a[168:171], v[44:47]
 buffer_load_dwordx4 v8, s[16:19], s21 offen offset:0  nt lds
M v[48:51], a[64:67], a[168:171], v[48:51]
M v[48:51], a[68:71], a[172:175], v[48:51]
M v[52:55], a[76:79], a[172:175], v[52:55]
 ds_read_b64_tr_b16 a[116:117], v3 offset:40960
 ds_read_b64_tr_b16 a[118:119], v3 offset:41984
M v[52:55], a[72:75], a[168:171], v[52:55]
M v[56:59], a[80:83], a[168:171], v[56:59]
 buffer_load_dwordx4 v9, s[16:19], s21 offen offset:1024  nt lds
M v[56:59], a[84:87], a[172:175], v[56:59]
 s_waitcnt lgkmcnt(6)
M v[60:63], a[92:95], a[172:175], v[60:63]
M v[60:63], a[88:91], a[168:171], v[60:63]
 ds_read_b64_tr_b16 a[120:121], v4 offset:32768
 ds_read_b64_tr_b16 a[122:123], v4 offset:33792
M v[64:67], a[32:35], a[160:163], v[64:67]
 ds_read_b128 a[168:171], v5 offset:6144
 ds_read_b128 a[172:175], v6 offset:6144
M v[64:67], a[36:39], a[164:167], v[64:67]
 buffer_load_dwordx4 v10, s[16:19], s21 offen offset:2048  nt lds
M v[68:71], a[44:47], a[164:167], v[68:71]
M v[68:71], a[40:43], a[160:163], v[68:71]
M v[72:75], a[48:51], a[160:163], v[72:75]
 ds_read_b64_tr_b16 a[124:125], v4 offset:40960
 ds_read_b64_tr_b16 a[126:127], v4 offset:41984
M v[72:75], a[52:55], a[164:167], v[72:75]
M v[76:79], a[60:63], a[164:167], v[76:79]
 buffer_load_dwordx4 v11, s[16:19], s21 offen offset:3072  nt lds
M v[76:79], a[56:59], a[160:163], v[76:79]
 s_add_u32 s21, s21, 524160
M v[80:83], a[64:67], a[160:163], v[80:83]
M v[80:83], a[68:71], a[164:167], v[80:83]
M v[84:87], a[76:79], a[164:167], v[84:87]
M v[84:87], a[72:75], a[160:163], v[84:87]
M v[88:91], a[80:83], a[160:163], v[88:91]
M v[88:91], a[84:87], a[164:167], v[88:91]
 s_waitcnt lgkmcnt(2)
M v[92:95], a[92:95], a[164:167], v[92:95]
 s_waitcnt vmcnt(17) lgkmcnt(0)
M v[92:95], a[88:91], a[160:163], v[92:95]
 s_barrier
M v[96:99], a[32:35], a[168:171], v[96:99]
 ds_read_b128 a[160:163], v5 offset:16384
 ds_read_b128 a[164:167], v6 offset:16384
M v[96:99], a[36:39], a[172:175], v[96:99]
M v[100:103], a[44:47], a[172:175], v[100:103]
 s_add_u32 m0, s24, 0
 ds_read_b64_tr_b16 a[128:129], v1 offset:49152
 ds_read_b64_tr_b16 a[130:131], v1 offset:50176
M v[100:103], a[40:43], a[168:171], v[100:103]
 buffer_load_dwordx4 v12, s[48:51], s22 offen offset:0   lds
M v[104:107], a[48:51], a[168:171], v[104:107]
M v[104:107], a[52:55], a[172:175], v[104:107]
M v[108:111], a[60:63], a[172:175], v[108:111]
M v[108:111], a[56:59], a[168:171], v[108:111]
M v[112:115], a[64:67], a[168:171], v[112:115]
M v[112:115], a[68:71], a[172:175], v[112:115]
 ds_read_b64_tr_b16 a[132:133], v1 offset:57344
 ds_read_b64_tr_b16 a[134:135], v1 offset:58368
M v[116:119], a[76:79], a[172:175], v[116:119]
 buffer_load_dwordx4 v13, s[48:51], s22 offen offset:1024   lds
M v[116:119], a[72:75], a[168:171], v[116:119]
M v[120:123], a[80:83], a[168:171], v[120:123]
M v[120:123], a[84:87], a[172:175], v[120:123]
 s_waitcnt lgkmcnt(4)
M v[124:127], a[92:95], a[172:175], v[124:127]
M v[124:127], a[88:91], a[168:171], v[124:127]
 buffer_load_dwordx4 v14, s[48:51], s22 offen offset:2048   lds
M v[128:131], a[32:35], a[160:163], v[128:131]
 ds_read_b128 a[168:171], v5 offset:18432
 ds_read_b128 a[172:175], v6 offset:18432
M v[128:131], a[36:39], a[164:167], v[128:131]
 ds_read_b64_tr_b16 a[136:137], v2 offset:49152
 ds_read_b64_tr_b16 a[138:139], v2 offset:50176
M v[132:135], a[44:47], a[164:167], v[132:135]
M v[132:135], a[40:43], a[160:163], v[132:135]
M v[136:139], a[48:51], a[160:163], v[136:139]
M v[136:139], a[52:55], a[164:167], v[136:139]
M v[140:143], a[60:63], a[164:167], v[140:143]
 buffer_load_dwordx4 v15, s[48:51], s22 offen offset:3072   lds
M v[140:143], a[56:59], a[160:163], v[140:143]
 s_add_u32 s22, s22, 2097152
 ds_read_b64_tr_b16 a[140:141], v2 offset:57344
 ds_read_b64_tr_b16 a[142:143], v2 offset:58368
M v[144:147], a[64:67], a[160:163], v[144:147]
M v[144:147], a[68:71], a[164:167], v[144:147]
M v[148:151], a[76:79], a[164:167], v[148:151]
M v[148:151], a[72:75], a[160:163], v[148:151]
 s_add_u32 m0, s23, 32768
M v[152:155], a[80:83], a[160:163], v[152:155]
 buffer_load_dwordx4 v8, s[16:19], s21 offen offset:0  nt lds
M v[152:155], a[84:87], a[164:167], v[152:155]
 s_waitcnt lgkmcnt(4)
M v[156:159], a[92:95], a[164:167], v[156:159]
 ds_read_b64_tr_b16 a[144:145], v3 offset:49152
 ds_read_b64_tr_b16 a[146:147], v3 offset:50176
M v[156:159], a[88:91], a[160:163], v[156:159]
M v[160:163], a[32:35], a[168:171], v[160:163]
 ds_read_b128 a[160:163], v5 offset:20480
 ds_read_b128 a[164:167], v6 offset:20480
M v[160:163], a[36:39], a[172:175], v[160:163]
M v[164:167], a[44:47], a[172:175], v[164:167]
 buffer_load_dwordx4 v9, s[16:19], s21 offen offset:1024  nt lds
M v[164:167], a[40:43], a[168:171], v[164:167]
M v[168:171], a[48:51], a[168:171], v[168:171]
M v[168:171], a[52:55], a[172:175], v[168:171]
 ds_read_b64_tr_b16 a[148:149], v3 offset:57344
 ds_read_b64_tr_b16 a[150:151], v3 offset:58368
M v[172:175], a[60:63], a[172:175], v[172:175]
M v[172:175], a[56:59], a[168:171], v[172:175]
M v[176:179], a[64:67], a[168:171], v[176:179]
M v[176:179], a[68:71], a[172:175], v[176:179]
 buffer_load_dwordx4 v10, s[16:19], s21 offen offset:2048  nt lds
M v[180:183], a[76:79], a[172:175], v[180:183]
M v[180:183], a[72:75], a[168:171], v[180:183]
M v[184:187], a[80:83], a[168:171], v[184:187]
 ds_read_b64_tr_b16 a[152:153], v4 offset:49152
 ds_read_b64_tr_b16 a[154:155], v4 offset:50176
M v[184:187], a[84:87], a[172:175], v[184:187]
 s_waitcnt lgkmcnt(4)
M v[188:191], a[92:95], a[172:175], v[188:191]
M v[188:191], a[88:91], a[168:171], v[188:191]
 buffer_load_dwordx4 v11, s[16:19], s21 offen offset:3072  nt lds
M v[192:195], a[32:35], a[160:163], v[192:195]
 s_add_u32 s21, s21, 128
 ds_read_b128 a[168:171], v5 offset:22528
 ds_read_b128 a[172:175], v6 offset:22528
M v[192:195], a[36:39], a[164:167], v[192:195]
M v[196:199], a[44:47], a[164:167], v[196:199]
M v[196:199], a[40:43], a[160:163], v[196:199]
 ds_read_b64_tr_b16 a[156:157], v4 offset:57344
 ds_read_b64_tr_b16 a[158:159], v4 offset:58368
M v[200:203], a[48:51], a[160:163], v[200:203]
 s_add_u32 m0, s87, 4096
M v[200:203], a[52:55], a[164:167], v[200:203]
 buffer_load_dwordx4 v25, s[60:63], s89 offen offset:0 nt lds
M v[204:207], a[60:63], a[164:167], v[204:207]
 s_add_u32 s89, s89, 114688
M v[204:207], a[56:59], a[160:163], v[204:207]
M v[208:211], a[64:67], a[160:163], v[208:211]
M v[208:211], a[68:71], a[164:167], v[208:211]
M v[212:215], a[76:79], a[164:167], v[212:215]
M v[212:215], a[72:75], a[160:163], v[212:215]
M v[216:219], a[80:83], a[160:163], v[216:219]
M v[216:219], a[84:87], a[164:167], v[216:219]
 s_waitcnt lgkmcnt(2)
M v[220:223], a[92:95], a[164:167], v[220:223]
 s_waitcnt vmcnt(18) lgkmcnt(0)
M v[220:223], a[88:91], a[160:163], v[220:223]
 s_barrier
M v[224:227], a[32:35], a[168:171], v[224:227]
 ds_read_b128 a[160:163], v5 offset:32768
 ds_read_b128 a[164:167], v6 offset:32768
M v[224:227], a[36:39], a[172:175], v[224:227]
 v_lshl_add_u32 v27, v0, 7, s95
 v_and_b32 v26, 48, v0
M v[228:231], a[44:47], a[172:175], v[228:231]
 v_lshl_add_u32 v26, v26, 24, v27
M v[228:231], a[40:43], a[168:171], v[228:231]
 buffer_load_dword a240, v26, s[76:79], 0 offen offset:0
M v[232:235], a[48:51], a[168:171], v[232:235]
M v[232:235], a[52:55], a[172:175], v[232:235]
M v[236:239], a[60:63], a[172:175], v[236:239]
M v[236:239], a[56:59], a[168:171], v[236:239]
M v[240:243], a[64:67], a[168:171], v[240:243]
M v[240:243], a[68:71], a[172:175], v[240:243]
M v[244:247], a[76:79], a[172:175], v[244:247]
M v[244:247], a[72:75], a[168:171], v[244:247]
M v[248:251], a[80:83], a[168:171], v[248:251]
M v[248:251], a[84:87], a[172:175], v[248:251]
 s_waitcnt lgkmcnt(0)
M v[252:255], a[92:95], a[172:175], v[252:255]
M v[252:255], a[88:91], a[168:171], v[252:255]
M a[0:3], a[96:99], a[160:163], a[0:3]
 ds_read_b128 a[168:171], v5 offset:34816
 ds_read_b128 a[172:175], v6 offset:34816
M a[0:3], a[100:103], a[164:167], a[0:3]
 ds_read_b64_tr_b16 a[32:33], v1 offset:0
 ds_read_b64_tr_b16 a[34:35], v1 offset:1024
M a[4:7], a[108:111], a[164:167], a[4:7]
 s_add_u32 m0, s24, 16384
M a[4:7], a[104:107], a[160:163], a[4:7]
 buffer_load_dwordx4 v12, s[48:51], s22 offen offset:0   lds
M a[8:11], a[112:115], a[160:163], a[8:11]
M a[8:11], a[116:119], a[164:167], a[8:11]
 s_lshl_b32 s67, s20, 11
M a[12:15], a[124:127], a[164:167], a[12:15]
 s_add_u32 s67, s67, 104914944
 ds_read_b64_tr_b16 a[36:37], v1 offset:8192
 ds_read_b64_tr_b16 a[38:39], v1 offset:9216
M a[12:15], a[120:123], a[160:163], a[12:15]
M a[16:19], a[128:131], a[160:163], a[16:19]
 buffer_load_dwordx4 v13, s[48:51], s22 offen offset:1024   lds
M a[16:19], a[132:135], a[164:167], a[16:19]
M a[20:23], a[140:143], a[164:167], a[20:23]
 buffer_load_dwordx4 v[16:19], v7, s[8:11], s67 offen offset:0 sc1
M a[20:23], a[136:139], a[160:163], a[20:23]
 ds_read_b64_tr_b16 a[40:41], v2 offset:0
 ds_read_b64_tr_b16 a[42:43], v2 offset:1024
M a[24:27], a[144:147], a[160:163], a[24:27]
M a[24:27], a[148:151], a[164:167], a[24:27]
 s_waitcnt lgkmcnt(6)
 buffer_load_dwordx4 v14, s[48:51], s22 offen offset:2048   lds
M a[28:31], a[156:159], a[164:167], a[28:31]
M a[28:31], a[152:155], a[160:163], a[28:31]
 buffer_load_dwordx4 v[20:23], v7, s[8:11], s67 offen offset:1024 sc1
M v[32:35], a[96:99], a[168:171], v[32:35]
 ds_read_b128 a[160:163], v5 offset:36864
 ds_read_b128 a[164:167], v6 offset:36864
M v[32:35], a[100:103], a[172:175], v[32:35]
 ds_read_b64_tr_b16 a[44:45], v2 offset:8192
 ds_read_b64_tr_b16 a[46:47], v2 offset:9216
M v[36:39], a[108:111], a[172:175], v[36:39]
 buffer_load_dwordx4 v15, s[48:51], s22 offen offset:3072   lds
M v[36:39], a[104:107], a[168:171], v[36:39]
 s_sub_u32 s22, s22, 2097024
M v[40:43], a[112:115], a[168:171], v[40:43]
M v[40:43], a[116:119], a[172:175], v[40:43]
 ds_read_b64_tr_b16 a[48:49], v3 offset:0
 ds_read_b64_tr_b16 a[50:51], v3 offset:1024
M v[44:47], a[124:127], a[172:175], v[44:47]
 s_add_u32 m0, s23, 49152
M v[44:47], a[120:123], a[168:171], v[44:47]
 buffer_load_dwordx4 v8, s[16:19], s21 offen offset:0  nt lds
M v[48:51], a[128:131], a[168:171], v[48:51]
M v[48:51], a[132:135], a[172:175], v[48:51]
M v[52:55], a[140:143], a[172:175], v[52:55]
 ds_read_b64_tr_b16 a[52:53], v3 offset:8192
 ds_read_b64_tr_b16 a[54:55], v3 offset:9216
M v[52:55], a[136:139], a[168:171], v[52:55]
M v[56:59], a[144:147], a[168:171], v[56:59]
 buffer_load_dwordx4 v9, s[16:19], s21 offen offset:1024  nt lds
M v[56:59], a[148:151], a[172:175], v[56:59]
 s_waitcnt lgkmcnt(6)
M v[60:63], a[156:159], a[172:175], v[60:63]
M v[60:63], a[152:155], a[168:171], v[60:63]
 ds_read_b64_tr_b16 a[56:57], v4 offset:0
 ds_read_b64_tr_b16 a[58:59], v4 offset:1024
M v[64:67], a[96:99], a[160:163], v[64:67]
 ds_read_b128 a[168:171], v5 offset:38912
 ds_read_b128 a[172:175], v6 offset:38912
M v[64:67], a[100:103], a[164:167], v[64:67]
 buffer_load_dwordx4 v10, s[16:19], s21 offen offset:2048  nt lds
M v[68:71], a[108:111], a[164:167], v[68:71]
M v[68:71], a[104:107], a[160:163], v[68:71]
M v[72:75], a[112:115], a[160:163], v[72:75]
 ds_read_b64_tr_b16 a[60:61], v4 offset:8192
 ds_read_b64_tr_b16 a[62:63], v4 offset:9216
M v[72:75], a[116:119], a[164:167], v[72:75]
M v[76:79], a[124:127], a[164:167], v[76:79]
 buffer_load_dwordx4 v11, s[16:19], s21 offen offset:3072  nt lds
M v[76:79], a[120:123], a[160:163], v[76:79]
 s_add_u32 s21, s21, 524160
M v[80:83], a[128:131], a[160:163], v[80:83]
M v[80:83], a[132:135], a[164:167], v[80:83]
M v[84:87], a[140:143], a[164:167], v[84:87]
M v[84:87], a[136:139], a[160:163], v[84:87]
M v[88:91], a[144:147], a[160:163], v[88:91]
M v[88:91], a[148:151], a[164:167], v[88:91]
 s_waitcnt lgkmcnt(2)
M v[92:95], a[156:159], a[164:167], v[92:95]
 s_waitcnt vmcnt(20) lgkmcnt(0)
M v[92:95], a[152:155], a[160:163], v[92:95]
 s_barrier
M v[96:99], a[96:99], a[168:171], v[96:99]
 ds_read_b128 a[160:163], v5 offset:49152
 ds_read_b128 a[164:167], v6 offset:49152
M v[96:99], a[100:103], a[172:175], v[96:99]
M v[100:103], a[108:111], a[172:175], v[100:103]
 s_add_u32 m0, s24, 32768
 ds_read_b64_tr_b16 a[64:65], v1 offset:16384
 ds_read_b64_tr_b16 a[66:67], v1 offset:17408
M v[100:103], a[104:107], a[168:171], v[100:103]
 buffer_load_dwordx4 v12, s[48:51], s22 offen offset:0   lds
M v[104:107], a[112:115], a[168:171], v[104:107]
M v[104:107], a[116:119], a[172:175], v[104:107]
M v[108:111], a[124:127], a[172:175], v[108:111]
M v[108:111], a[120:123], a[168:171], v[108:111]
M v[112:115], a[128:131], a[168:171], v[112:115]
M v[112:115], a[132:135], a[172:175], v[112:115]
 ds_read_b64_tr_b16 a[68:69], v1 offset:24576
 ds_read_b64_tr_b16 a[70:71], v1 offset:25600
M v[116:119], a[140:143], a[172:175], v[116:119]
 buffer_load_dwordx4 v13, s[48:51], s22 offen offset:1024   lds
M v[116:119], a[136:139], a[168:171], v[116:119]
M v[120:123], a[144:147], a[168:171], v[120:123]
M v[120:123], a[148:151], a[172:175], v[120:123]
 s_waitcnt lgkmcnt(4)
M v[124:127], a[156:159], a[172:175], v[124:127]
M v[124:127], a[152:155], a[168:171], v[124:127]
 buffer_load_dwordx4 v14, s[48:51], s22 offen offset:2048   lds
M v[128:131], a[96:99], a[160:163], v[128:131]
 ds_read_b128 a[168:171], v5 offset:51200
 ds_read_b128 a[172:175], v6 offset:51200
M v[128:131], a[100:103], a[164:167], v[128:131]
 ds_read_b64_tr_b16 a[72:73], v2 offset:16384
 ds_read_b64_tr_b16 a[74:75], v2 offset:17408
M v[132:135], a[108:111], a[164:167], v[132:135]
M v[132:135], a[104:107], a[160:163], v[132:135]
M v[136:139], a[112:115], a[160:163], v[136:139]
M v[136:139], a[116:119], a[164:167], v[136:139]
M v[140:143], a[124:127], a[164:167], v[140:143]
 buffer_load_dwordx4 v15, s[48:51], s22 offen offset:3072   lds
M v[140:143], a[120:123], a[160:163], v[140:143]
 s_add_u32 s22, s22, 2097152
 ds_read_b64_tr_b16 a[76:77], v2 offset:24576
 ds_read_b64_tr_b16 a[78:79], v2 offset:25600
M v[144:147], a[128:131], a[160:163], v[144:147]
M v[144:147], a[132:135], a[164:167], v[144:147]
M v[148:151], a[140:143], a[164:167], v[148:151]
M v[148:151], a[136:139], a[160:163], v[148:151]
 s_add_u32 m0, s23, 0
M v[152:155], a[144:147], a[160:163], v[152:155]
 buffer_load_dwordx4 v8, s[16:19], s21 offen offset:0  nt lds
M v[152:155], a[148:151], a[164:167], v[152:155]
 s_waitcnt lgkmcnt(4)
M v[156:159], a[156:159], a[164:167], v[156:159]
 ds_read_b64_tr_b16 a[80:81], v3 offset:16384
 ds_read_b64_tr_b16 a[82:83], v3 offset:17408
M v[156:159], a[152:155], a[160:163], v[156:159]
M v[160:163], a[96:99], a[168:171], v[160:163]
 ds_read_b128 a[160:163], v5 offset:53248
 ds_read_b128 a[164:167], v6 offset:53248
M v[160:163], a[100:103], a[172:175], v[160:163]
M v[164:167], a[108:111], a[172:175], v[164:167]
 buffer_load_dwordx4 v9, s[16:19], s21 offen offset:1024  nt lds
M v[164:167], a[104:107], a[168:171], v[164:167]
M v[168:171], a[112:115], a[168:171], v[168:171]
M v[168:171], a[116:119], a[172:175], v[168:171]
 ds_read_b64_tr_b16 a[84:85], v3 offset:24576
 ds_read_b64_tr_b16 a[86:87], v3 offset:25600
M v[172:175], a[124:127], a[172:175], v[172:175]
M v[172:175], a[120:123], a[168:171], v[172:175]
M v[176:179], a[128:131], a[168:171], v[176:179]
M v[176:179], a[132:135], a[172:175], v[176:179]
 buffer_load_dwordx4 v10, s[16:19], s21 offen offset:2048  nt lds
M v[180:183], a[140:143], a[172:175], v[180:183]
M v[180:183], a[136:139], a[168:171], v[180:183]
M v[184:187], a[144:147], a[168:171], v[184:187]
 ds_read_b64_tr_b16 a[88:89], v4 offset:16384
 ds_read_b64_tr_b16 a[90:91], v4 offset:17408
M v[184:187], a[148:151], a[172:175], v[184:187]
 s_waitcnt lgkmcnt(4)
M v[188:191], a[156:159], a[172:175], v[188:191]
M v[188:191], a[152:155], a[168:171], v[188:191]
 buffer_load_dwordx4 v11, s[16:19], s21 offen offset:3072  nt lds
M v[192:195], a[96:99], a[160:163], v[192:195]
 s_add_u32 s21, s21, 128
 ds_read_b128 a[168:171], v5 offset:55296
 ds_read_b128 a[172:175], v6 offset:55296
M v[192:195], a[100:103], a[164:167], v[192:195]
M v[196:199], a[108:111], a[164:167], v[196:199]
M v[196:199], a[104:107], a[160:163], v[196:199]
 ds_read_b64_tr_b16 a[92:93], v4 offset:24576
 ds_read_b64_tr_b16 a[94:95], v4 offset:25600
M v[200:203], a[112:115], a[160:163], v[200:203]
 s_add_u32 m0, s87, 5120
M v[200:203], a[116:119], a[164:167], v[200:203]
 buffer_load_dwordx4 v25, s[60:63], s89 offen offset:0 nt lds
M v[204:207], a[124:127], a[164:167], v[204:207]
 s_add_u32 s89, s89, 114688
M v[204:207], a[120:123], a[160:163], v[204:207]
M v[208:211], a[128:131], a[160:163], v[208:211]
M v[208:211], a[132:135], a[164:167], v[208:211]
M v[212:215], a[140:143], a[164:167], v[212:215]
M v[212:215], a[136:139], a[160:163], v[212:215]
M v[216:219], a[144:147], a[160:163], v[216:219]
M v[216:219], a[148:151], a[164:167], v[216:219]
 s_waitcnt lgkmcnt(2)
M v[220:223], a[156:159], a[164:167], v[220:223]
 s_waitcnt vmcnt(21) lgkmcnt(0)
M v[220:223], a[152:155], a[160:163], v[220:223]
 s_barrier
M v[224:227], a[96:99], a[168:171], v[224:227]
 ds_read_b128 a[160:163], v5 offset:0
 ds_read_b128 a[164:167], v6 offset:0
M v[224:227], a[100:103], a[172:175], v[224:227]
M v[228:231], a[108:111], a[172:175], v[228:231]
M v[228:231], a[104:107], a[168:171], v[228:231]
M v[232:235], a[112:115], a[168:171], v[232:235]
M v[232:235], a[116:119], a[172:175], v[232:235]
M v[236:239], a[124:127], a[172:175], v[236:239]
M v[236:239], a[120:123], a[168:171], v[236:239]
M v[240:243], a[128:131], a[168:171], v[240:243]
M v[240:243], a[132:135], a[172:175], v[240:243]
M v[244:247], a[140:143], a[172:175], v[244:247]
M v[244:247], a[136:139], a[168:171], v[244:247]
M v[248:251], a[144:147], a[168:171], v[248:251]
M v[248:251], a[148:151], a[172:175], v[248:251]
 s_waitcnt lgkmcnt(0)
M v[252:255], a[156:159], a[172:175], v[252:255]
M v[252:255], a[152:155], a[168:171], v[252:255]
M a[0:3], a[32:35], a[160:163], a[0:3]
 ds_read_b128 a[168:171], v5 offset:2048
 ds_read_b128 a[172:175], v6 offset:2048
M a[0:3], a[36:39], a[164:167], a[0:3]
 ds_read_b64_tr_b16 a[96:97], v1 offset:32768
 ds_read_b64_tr_b16 a[98:99], v1 offset:33792
M a[4:7], a[44:47], a[164:167], a[4:7]
 s_add_u32 m0, s24, 49152
M a[4:7], a[40:43], a[160:163], a[4:7]
 buffer_load_dwordx4 v12, s[48:51], s22 offen offset:0   lds
M a[8:11], a[48:51], a[160:163], a[8:11]
M a[8:11], a[52:55], a[164:167], a[8:11]
M a[12:15], a[60:63], a[164:167], a[12:15]
 ds_read_b64_tr_b16 a[100:101], v1 offset:40960
 ds_read_b64_tr_b16 a[102:103], v1 offset:41984
M a[12:15], a[56:59], a[160:163], a[12:15]
M a[16:19], a[64:67], a[160:163], a[16:19]
 buffer_load_dwordx4 v13, s[48:51], s22 offen offset:1024   lds
M a[16:19], a[68:71], a[164:167], a[16:19]
M a[20:23], a[76:79], a[164:167], a[20:23]
 s_waitcnt vmcnt(18)
 v_min3_u32 v28, v16, v17, v18
M a[20:23], a[72:75], a[160:163], a[20:23]
 ds_read_b64_tr_b16 a[104:105], v2 offset:32768
 ds_read_b64_tr_b16 a[106:107], v2 offset:33792
M a[24:27], a[80:83], a[160:163], a[24:27]
 s_waitcnt vmcnt(16)
 v_min3_u32 v28, v28, v19, v20
M a[24:27], a[84:87], a[164:167], a[24:27]
 s_waitcnt lgkmcnt(6)
 buffer_load_dwordx4 v14, s[48:51], s22 offen offset:2048   lds
M a[28:31], a[92:95], a[164:167], a[28:31]
 v_min3_u32 v28, v28, v21, v22
M a[28:31], a[88:91], a[160:163], a[28:31]
 v_min_u32 v28, v28, v23
M v[32:35], a[32:35], a[168:171], v[32:35]
 ds_read_b128 a[160:163], v5 offset:4096
 ds_read_b128 a[164:167], v6 offset:4096
M v[32:35], a[36:39], a[172:175], v[32:35]
 ds_read_b64_tr_b16 a[108:109], v2 offset:40960
 ds_read_b64_tr_b16 a[110:111], v2 offset:41984
M v[36:39], a[44:47], a[172:175], v[36:39]
 buffer_load_dwordx4 v15, s[48:51], s22 offen offset:3072   lds
M v[36:39], a[40:43], a[168:171], v[36:39]
 s_sub_u32 s22, s22, 2097024
 v_cmp_eq_u32 vcc, 0, v28
M v[40:43], a[48:51], a[168:171], v[40:43]
 s_nop 0
M v[40:43], a[52:55], a[172:175], v[40:43]
 s_cbranch_vccnz L_hs
L_hr:
 ds_read_b64_tr_b16 a[112:113], v3 offset:32768
 ds_read_b64_tr_b16 a[114:115], v3 offset:33792
M v[44:47], a[60:63], a[172:175], v[44:47]
 s_add_u32 m0, s23, 16384
 v_max_u32 v28, v16, v17
M v[44:47], a[56:59], a[168:171], v[44:47]
 buffer_load_dwordx4 v8, s[16:19], s21 offen offset:0  nt lds
M v[48:51], a[64:67], a[168:171], v[48:51]
 v_min_u32 v29, v16, v17
M v[48:51], a[68:71], a[172:175], v[48:51]
 v_med3_u32 v29, v28, v29, v18
M v[52:55], a[76:79], a[172:175], v[52:55]
 ds_read_b64_tr_b16 a[116:117], v3 offset:40960
 ds_read_b64_tr_b16 a[118:119], v3 offset:41984
M v[52:55], a[72:75], a[168:171], v[52:55]
 v_max_u32 v28, v28, v18
M v[56:59], a[80:83], a[168:171], v[56:59]
 buffer_load_dwordx4 v9, s[16:19], s21 offen offset:1024  nt lds
M v[56:59], a[84:87], a[172:175], v[56:59]
 s_waitcnt lgkmcnt(6)
 v_med3_u32 v29, v28, v29, v19
M v[60:63], a[92:95], a[172:175], v[60:63]
 v_max_u32 v28, v28, v19
M v[60:63], a[88:91], a[168:171], v[60:63]
 ds_read_b64_tr_b16 a[120:121], v4 offset:32768
 ds_read_b64_tr_b16 a[122:123], v4 offset:33792
M v[64:67], a[32:35], a[160:163], v[64:67]
 ds_read_b128 a[168:171], v5 offset:6144
 ds_read_b128 a[172:175], v6 offset:6144
M v[64:67], a[36:39], a[164:167], v[64:67]
 buffer_load_dwordx4 v10, s[16:19], s21 offen offset:2048  nt lds
M v[68:71], a[44:47], a[164:167], v[68:71]
 v_med3_u32 v29, v28, v29, v20
M v[68:71], a[40:43], a[160:163], v[68:71]
 v_max_u32 v28, v28, v20
M v[72:75], a[48:51], a[160:163], v[72:75]
 ds_read_b64_tr_b16 a[124:125], v4 offset:40960
 ds_read_b64_tr_b16 a[126:127], v4 offset:41984
M v[72:75], a[52:55], a[164:167], v[72:75]
 v_med3_u32 v29, v28, v29, v21
M v[76:79], a[60:63], a[164:167], v[76:79]
 buffer_load_dwordx4 v11, s[16:19], s21 offen offset:3072  nt lds
M v[76:79], a[56:59], a[160:163], v[76:79]
 s_add_u32 s21, s21, 524160
 v_max_u32 v28, v28, v21
M v[80:83], a[64:67], a[160:163], v[80:83]
 v_med3_u32 v29, v28, v29, v22
M v[80:83], a[68:71], a[164:167], v[80:83]
 v_max_u32 v28, v28, v22
M v[84:87], a[76:79], a[164:167], v[84:87]
 v_med3_u32 v29, v28, v29, v23
M v[84:87], a[72:75], a[160:163], v[84:87]
 v_max_u32 v28, v28, v23
M v[88:91], a[80:83], a[160:163], v[88:91]
 s_nop 0
 v_mov_b32 v30, v28 row_ror:8 row_mask:0xf bank_mask:0xf
M v[88:91], a[84:87], a[164:167], v[88:91]
 s_waitcnt lgkmcnt(2)
 v_mov_b32 v31, v29 row_ror:8 row_mask:0xf bank_mask:0xf
M v[92:95], a[92:95], a[164:167], v[92:95]
 s_waitcnt vmcnt(17) lgkmcnt(0)
 v_min_u32 v16, v28, v30
M v[92:95], a[88:91], a[160:163], v[92:95]
 s_barrier
M v[96:99], a[32:35], a[168:171], v[96:99]
 ds_read_b128 a[160:163], v5 offset:16384
 ds_read_b128 a[164:167], v6 offset:16384
M v[96:99], a[36:39], a[172:175], v[96:99]
 v_max_u32 v28, v28, v30
M v[100:103], a[44:47], a[172:175], v[100:103]
 s_add_u32 m0, s24, 0
 ds_read_b64_tr_b16 a[128:129], v1 offset:49152
 ds_read_b64_tr_b16 a[130:131], v1 offset:50176
M v[100:103], a[40:43], a[168:171], v[100:103]
 buffer_load_dwordx4 v12, s[48:51], s22 offen offset:0   lds
M v[104:107], a[48:51], a[168:171], v[104:107]
 v_max3_u32 v29, v29, v31, v16
M v[104:107], a[52:55], a[172:175], v[104:107]
 v_mov_b32 v30, v28 row_ror:4 row_mask:0xf bank_mask:0xf
M v[108:111], a[60:63], a[172:175], v[108:111]
 v_mov_b32 v31, v29 row_ror:4 row_mask:0xf bank_mask:0xf
M v[108:111], a[56:59], a[168:171], v[108:111]
 v_min_u32 v16, v28, v30
M v[112:115], a[64:67], a[168:171], v[112:115]
 v_max_u32 v28, v28, v30
M v[112:115], a[68:71], a[172:175], v[112:115]
 ds_read_b64_tr_b16 a[132:133], v1 offset:57344
 ds_read_b64_tr_b16 a[134:135], v1 offset:58368
M v[116:119], a[76:79], a[172:175], v[116:119]
 buffer_load_dwordx4 v13, s[48:51], s22 offen offset:1024   lds
M v[116:119], a[72:75], a[168:171], v[116:119]
 v_max3_u32 v29, v29, v31, v16
M v[120:123], a[80:83], a[168:171], v[120:123]
 v_mov_b32 v30, v28 row_ror:2 row_mask:0xf bank_mask:0xf
M v[120:123], a[84:87], a[172:175], v[120:123]
 s_waitcnt lgkmcnt(4)
 v_mov_b32 v31, v29 row_ror:2 row_mask:0xf bank_mask:0xf
M v[124:127], a[92:95], a[172:175], v[124:127]
 v_min_u32 v16, v28, v30
M v[124:127], a[88:91], a[168:171], v[124:127]
 buffer_load_dwordx4 v14, s[48:51], s22 offen offset:2048   lds
M v[128:131], a[32:35], a[160:163], v[128:131]
 ds_read_b128 a[168:171], v5 offset:18432
 ds_read_b128 a[172:175], v6 offset:18432
M v[128:131], a[36:39], a[164:167], v[128:131]
 ds_read_b64_tr_b16 a[136:137], v2 offset:49152
 ds_read_b64_tr_b16 a[138:139], v2 offset:50176
M v[132:135], a[44:47], a[164:167], v[132:135]
 v_max_u32 v28, v28, v30
M v[132:135], a[40:43], a[160:163], v[132:135]
 v_max3_u32 v29, v29, v31, v16
M v[136:139], a[48:51], a[160:163], v[136:139]
 v_mov_b32 v30, v28 row_ror:1 row_mask:0xf bank_mask:0xf
M v[136:139], a[52:55], a[164:167], v[136:139]
 v_mov_b32 v31, v29 row_ror:1 row_mask:0xf bank_mask:0xf
M v[140:143], a[60:63], a[164:167], v[140:143]
 buffer_load_dwordx4 v15, s[48:51], s22 offen offset:3072   lds
M v[140:143], a[56:59], a[160:163], v[140:143]
 s_add_u32 s22, s22, 2097152
 ds_read_b64_tr_b16 a[140:141], v2 offset:57344
 ds_read_b64_tr_b16 a[142:143], v2 offset:58368
M v[144:147], a[64:67], a[160:163], v[144:147]
 v_min_u32 v16, v28, v30
M v[144:147], a[68:71], a[164:167], v[144:147]
 v_max_u32 v28, v28, v30
M v[148:151], a[76:79], a[164:167], v[148:151]
 v_max3_u32 v29, v29, v31, v16
M v[148:151], a[72:75], a[160:163], v[148:151]
 s_add_u32 m0, s23, 32768
 v_mov_b32 v30, v28
M v[152:155], a[80:83], a[160:163], v[152:155]
 buffer_load_dwordx4 v8, s[16:19], s21 offen offset:0  nt lds
M v[152:155], a[84:87], a[164:167], v[152:155]
 s_waitcnt lgkmcnt(4)
 v_mov_b32 v31, v29
M v[156:159], a[92:95], a[164:167], v[156:159]
 ds_read_b64_tr_b16 a[144:145], v3 offset:49152
 ds_read_b64_tr_b16 a[146:147], v3 offset:50176
M v[156:159], a[88:91], a[160:163], v[156:159]
 v_permlane16_swap_b32 v30, v28
M v[160:163], a[32:35], a[168:171], v[160:163]
 ds_read_b128 a[160:163], v5 offset:20480
 ds_read_b128 a[164:167], v6 offset:20480
M v[160:163], a[36:39], a[172:175], v[160:163]
 v_permlane16_swap_b32 v31, v29
M v[164:167], a[44:47], a[172:175], v[164:167]
 buffer_load_dwordx4 v9, s[16:19], s21 offen offset:1024  nt lds
M v[164:167], a[40:43], a[168:171], v[164:167]
 v_min_u32 v16, v28, v30
M v[168:171], a[48:51], a[168:171], v[168:171]
 v_max_u32 v28, v28, v30
M v[168:171], a[52:55], a[172:175], v[168:171]
 ds_read_b64_tr_b16 a[148:149], v3 offset:57344
 ds_read_b64_tr_b16 a[150:151], v3 offset:58368
M v[172:175], a[60:63], a[172:175], v[172:175]
 v_max3_u32 v29, v29, v31, v16
M v[172:175], a[56:59], a[168:171], v[172:175]
 v_mov_b32 v30, v28
M v[176:179], a[64:67], a[168:171], v[176:179]
 v_mov_b32 v31, v29
M v[176:179], a[68:71], a[172:175], v[176:179]
 buffer_load_dwordx4 v10, s[16:19], s21 offen offset:2048  nt lds
M v[180:183], a[76:79], a[172:175], v[180:183]
 v_permlane32_swap_b32 v30, v28
M v[180:183], a[72:75], a[168:171], v[180:183]
 v_permlane32_swap_b32 v31, v29
M v[184:187], a[80:83], a[168:171], v[184:187]
 ds_read_b64_tr_b16 a[152:153], v4 offset:49152
 ds_read_b64_tr_b16 a[154:155], v4 offset:50176
M v[184:187], a[84:87], a[172:175], v[184:187]
 s_waitcnt lgkmcnt(4)
 v_min_u32 v16, v28, v30
M v[188:191], a[92:95], a[172:175], v[188:191]
 v_max_u32 v28, v28, v30
M v[188:191], a[88:91], a[168:171], v[188:191]
 buffer_load_dwordx4 v11, s[16:19], s21 offen offset:3072  nt lds
M v[192:195], a[32:35], a[160:163], v[192:195]
 s_add_u32 s21, s21, 128
 ds_read_b128 a[168:171], v5 offset:22528
 ds_read_b128 a[172:175], v6 offset:22528
M v[192:195], a[36:39], a[164:167], v[192:195]
 v_max3_u32 v29, v29, v31, v16
M v[196:199], a[44:47], a[164:167], v[196:199]
 s_lshl_b32 s64, s20, 3
M v[196:199], a[40:43], a[160:163], v[196:199]
 s_add_u32 s64, s64, 159744
 ds_read_b64_tr_b16 a[156:157], v4 offset:57344
 ds_read_b64_tr_b16 a[158:159], v4 offset:58368
M v[200:203], a[48:51], a[160:163], v[200:203]
 s_add_u32 m0, s87, 6144
 v_mov_b32 v16, s64
M v[200:203], a[52:55], a[164:167], v[200:203]
 buffer_load_dwordx4 v25, s[60:63], s89 offen offset:0 nt lds
M v[204:207], a[60:63], a[164:167], v[204:207]
 s_add_u32 s89, s89, 114688
 ds_write_b64 v16, v[28:29]
M v[204:207], a[56:59], a[160:163], v[204:207]
M v[208:211], a[64:67], a[160:163], v[208:211]
M v[208:211], a[68:71], a[164:167], v[208:211]
M v[212:215], a[76:79], a[164:167], v[212:215]
M v[212:215], a[72:75], a[160:163], v[212:215]
M v[216:219], a[80:83], a[160:163], v[216:219]
M v[216:219], a[84:87], a[164:167], v[216:219]
 s_waitcnt lgkmcnt(3)
M v[220:223], a[92:95], a[164:167], v[220:223]
 s_waitcnt vmcnt(18) lgkmcnt(0)
M v[220:223], a[88:91], a[160:163], v[220:223]
 s_barrier
M v[224:227], a[32:35], a[168:171], v[224:227]
 ds_read_b128 a[160:163], v5 offset:32768
 ds_read_b128 a[164:167], v6 offset:32768
M v[224:227], a[36:39], a[172:175], v[224:227]
 buffer_load_dword a240, v24, s[32:35], 0 offen offset:1536
M v[228:231], a[44:47], a[172:175], v[228:231]
M v[228:231], a[40:43], a[168:171], v[228:231]
M v[232:235], a[48:51], a[168:171], v[232:235]
M v[232:235], a[52:55], a[172:175], v[232:235]
M v[236:239], a[60:63], a[172:175], v[236:239]
M v[236:239], a[56:59], a[168:171], v[236:239]
M v[240:243], a[64:67], a[168:171], v[240:243]
M v[240:243], a[68:71], a[172:175], v[240:243]
M v[244:247], a[76:79], a[172:175], v[244:247]
M v[244:247], a[72:75], a[168:171], v[244:247]
M v[248:251], a[80:83], a[168:171], v[248:251]
M v[248:251], a[84:87], a[172:175], v[248:251]
 s_waitcnt lgkmcnt(0)
M v[252:255], a[92:95], a[172:175], v[252:255]
M v[252:255], a[88:91], a[168:171], v[252:255]
M a[0:3], a[96:99], a[160:163], a[0:3]
 ds_read_b128 a[168:171], v5 offset:34816
 ds_read_b128 a[172:175], v6 offset:34816
M a[0:3], a[100:103], a[164:167], a[0:3]
 ds_read_b64_tr_b16 a[32:33], v1 offset:0
 ds_read_b64_tr_b16 a[34:35], v1 offset:1024
M a[4:7], a[108:111], a[164:167], a[4:7]
 s_add_u32 m0, s24, 16384
M a[4:7], a[104:107], a[160:163], a[4:7]
 buffer_load_dwordx4 v12, s[48:51], s22 offen offset:0   lds
M a[8:11], a[112:115], a[160:163], a[8:11]
 v_mov_b32 v28, 159744
M a[8:11], a[116:119], a[164:167], a[8:11]
 ds_read_b128 v[16:19], v28
M a[12:15], a[124:127], a[164:167], a[12:15]
 ds_read_b64_tr_b16 a[36:37], v1 offset:8192
 ds_read_b64_tr_b16 a[38:39], v1 offset:9216
M a[12:15], a[120:123], a[160:163], a[12:15]
 ds_read_b128 v[20:23], v28 offset:16
M a[16:19], a[128:131], a[160:163], a[16:19]
 buffer_load_dwordx4 v13, s[48:51], s22 offen offset:1024   lds
M a[16:19], a[132:135], a[164:167], a[16:19]
M a[20:23], a[140:143], a[164:167], a[20:23]
M a[20:23], a[136:139], a[160:163], a[20:23]
 ds_read_b64_tr_b16 a[40:41], v2 offset:0
 ds_read_b64_tr_b16 a[42:43], v2 offset:1024
M a[24:27], a[144:147], a[160:163], a[24:27]
M a[24:27], a[148:151], a[164:167], a[24:27]
 s_waitcnt lgkmcnt(8)
 buffer_load_dwordx4 v14, s[48:51], s22 offen offset:2048   lds
M a[28:31], a[156:159], a[164:167], a[28:31]
M a[28:31], a[152:155], a[160:163], a[28:31]
M v[32:35], a[96:99], a[168:171], v[32:35]
 ds_read_b128 a[160:163], v5 offset:36864
 ds_read_b128 a[164:167], v6 offset:36864
M v[32:35], a[100:103], a[172:175], v[32:35]
 ds_read_b64_tr_b16 a[44:45], v2 offset:8192
 ds_read_b64_tr_b16 a[46:47], v2 offset:9216
M v[36:39], a[108:111], a[172:175], v[36:39]
 buffer_load_dwordx4 v15, s[48:51], s22 offen offset:3072   lds
M v[36:39], a[104:107], a[168:171], v[36:39]
 s_sub_u32 s22, s22, 2097024
 s_waitcnt lgkmcnt(9)
 v_min_u32 v28, v16, v18
M v[40:43], a[112:115], a[168:171], v[40:43]
 v_max_u32 v16, v16, v18
M v[40:43], a[116:119], a[172:175], v[40:43]
 ds_read_b64_tr_b16 a[48:49], v3 offset:0
 ds_read_b64_tr_b16 a[50:51], v3 offset:1024
M v[44:47], a[124:127], a[172:175], v[44:47]
 s_add_u32 m0, s23, 49152
 v_max3_u32 v17, v17, v19, v28
M v[44:47], a[120:123], a[168:171], v[44:47]
 buffer_load_dwordx4 v8, s[16:19], s21 offen offset:0  nt lds
M v[48:51], a[128:131], a[168:171], v[48:51]
 s_waitcnt lgkmcnt(8)
 v_min_u32 v29, v20, v22
M v[48:51], a[132:135], a[172:175], v[48:51]
 v_max_u32 v20, v20, v22
M v[52:55], a[140:143], a[172:175], v[52:55]
 ds_read_b64_tr_b16 a[52:53], v3 offset:8192
 ds_read_b64_tr_b16 a[54:55], v3 offset:9216
M v[52:55], a[136:139], a[168:171], v[52:55]
 v_max3_u32 v21, v21, v23, v29
M v[56:59], a[144:147], a[168:171], v[56:59]
 buffer_load_dwordx4 v9, s[16:19], s21 offen offset:1024  nt lds
M v[56:59], a[148:151], a[172:175], v[56:59]
 s_waitcnt lgkmcnt(6)
 v_min_u32 v28, v16, v20
M v[60:63], a[156:159], a[172:175], v[60:63]
 v_max_u32 v16, v16, v20
M v[60:63], a[152:155], a[168:171], v[60:63]
 ds_read_b64_tr_b16 a[56:57], v4 offset:0
 ds_read_b64_tr_b16 a[58:59], v4 offset:1024
M v[64:67], a[96:99], a[160:163], v[64:67]
 ds_read_b128 a[168:171], v5 offset:38912
 ds_read_b128 a[172:175], v6 offset:38912
M v[64:67], a[100:103], a[164:167], v[64:67]
 buffer_load_dwordx4 v10, s[16:19], s21 offen offset:2048  nt lds
M v[68:71], a[108:111], a[164:167], v[68:71]
 v_max3_u32 v17, v17, v21, v28
M v[68:71], a[104:107], a[160:163], v[68:71]
 v_and_b32 v28, 1, v0
M v[72:75], a[112:115], a[160:163], v[72:75]
 ds_read_b64_tr_b16 a[60:61], v4 offset:8192
 ds_read_b64_tr_b16 a[62:63], v4 offset:9216
M v[72:75], a[116:119], a[164:167], v[72:75]
 v_cmp_eq_u32 vcc, 0, v28
M v[76:79], a[124:127], a[164:167], v[76:79]
 s_and_b32 s64, s20, 1
 buffer_load_dwordx4 v11, s[16:19], s21 offen offset:3072  nt lds
M v[76:79], a[120:123], a[160:163], v[76:79]
 s_add_u32 s21, s21, 524160
 s_mul_i32 s64, s64, 448
 v_cndmask_b32 v24, v17, v16, vcc
M v[80:83], a[128:131], a[160:163], v[80:83]
 v_and_b32 v24, 0x7ff, v24
M v[80:83], a[132:135], a[164:167], v[80:83]
 v_sub_u32 v24, 2047, v24
M v[84:87], a[140:143], a[164:167], v[84:87]
 v_mul_u32_u24 v28, 896, v24
M v[84:87], a[136:139], a[160:163], v[84:87]
 v_lshrrev_b32 v29, 4, v0
M v[88:91], a[144:147], a[160:163], v[88:91]
 v_lshl_add_u32 v28, v29, 4, v28
M v[88:91], a[148:151], a[164:167], v[88:91]
 s_waitcnt lgkmcnt(2)
 v_bfe_u32 v30, v0, 1, 3
M v[92:95], a[156:159], a[164:167], v[92:95]
 s_waitcnt vmcnt(18) lgkmcnt(0)
 v_lshl_or_b32 v28, v30, 26, v28
M v[92:95], a[152:155], a[160:163], v[92:95]
 s_barrier
M v[96:99], a[96:99], a[168:171], v[96:99]
 ds_read_b128 a[160:163], v5 offset:49152
 ds_read_b128 a[164:167], v6 offset:49152
M v[96:99], a[100:103], a[172:175], v[96:99]
 buffer_load_dwordx4 a[208:211], v28, s[56:59], s64 offen offset:0
M v[100:103], a[108:111], a[172:175], v[100:103]
 s_add_u32 m0, s24, 32768
 ds_read_b64_tr_b16 a[64:65], v1 offset:16384
 ds_read_b64_tr_b16 a[66:67], v1 offset:17408
M v[100:103], a[104:107], a[168:171], v[100:103]
 buffer_load_dwordx4 v12, s[48:51], s22 offen offset:0   lds
M v[104:107], a[112:115], a[168:171], v[104:107]
M v[104:107], a[116:119], a[172:175], v[104:107]
M v[108:111], a[124:127], a[172:175], v[108:111]
 buffer_load_dwordx4 a[212:215], v28, s[56:59], s64 offen offset:64
M v[108:111], a[120:123], a[168:171], v[108:111]
M v[112:115], a[128:131], a[168:171], v[112:115]
 buffer_load_dwordx4 a[216:219], v28, s[56:59], s64 offen offset:128
M v[112:115], a[132:135], a[172:175], v[112:115]
 ds_read_b64_tr_b16 a[68:69], v1 offset:24576
 ds_read_b64_tr_b16 a[70:71], v1 offset:25600
M v[116:119], a[140:143], a[172:175], v[116:119]
 buffer_load_dwordx4 v13, s[48:51], s22 offen offset:1024   lds
M v[116:119], a[136:139], a[168:171], v[116:119]
M v[120:123], a[144:147], a[168:171], v[120:123]
M v[120:123], a[148:151], a[172:175], v[120:123]
 s_waitcnt lgkmcnt(4)
M v[124:127], a[156:159], a[172:175], v[124:127]
 buffer_load_dwordx4 a[220:223], v28, s[56:59], s64 offen offset:192
M v[124:127], a[152:155], a[168:171], v[124:127]
M v[128:131], a[96:99], a[160:163], v[128:131]
 ds_read_b128 a[168:171], v5 offset:51200
 ds_read_b128 a[172:175], v6 offset:51200
M v[128:131], a[100:103], a[164:167], v[128:131]
 ds_read_b64_tr_b16 a[72:73], v2 offset:16384
 ds_read_b64_tr_b16 a[74:75], v2 offset:17408
M v[132:135], a[108:111], a[164:167], v[132:135]
 buffer_load_dwordx4 v14, s[48:51], s22 offen offset:2048   lds
M v[132:135], a[104:107], a[160:163], v[132:135]
M v[136:139], a[112:115], a[160:163], v[136:139]
 buffer_load_dwordx4 a[224:227], v28, s[56:59], s64 offen offset:256
M v[136:139], a[116:119], a[164:167], v[136:139]
M v[140:143], a[124:127], a[164:167], v[140:143]
 buffer_load_dwordx4 a[228:231], v28, s[56:59], s64 offen offset:320
M v[140:143], a[120:123], a[160:163], v[140:143]
 ds_read_b64_tr_b16 a[76:77], v2 offset:24576
 ds_read_b64_tr_b16 a[78:79], v2 offset:25600
M v[144:147], a[128:131], a[160:163], v[144:147]
 buffer_load_dwordx4 v15, s[48:51], s22 offen offset:3072   lds
M v[144:147], a[132:135], a[164:167], v[144:147]
 s_add_u32 s22, s22, 2097152
M v[148:151], a[140:143], a[164:167], v[148:151]
M v[148:151], a[136:139], a[160:163], v[148:151]
 buffer_load_dwordx4 a[232:235], v28, s[56:59], s64 offen offset:384
M v[152:155], a[144:147], a[160:163], v[152:155]
 v_lshrrev_b32 v28, 4, v24
M v[152:155], a[148:151], a[164:167], v[152:155]
 s_waitcnt lgkmcnt(4)
 v_lshlrev_b32 v28, 5, v28
M v[156:159], a[156:159], a[164:167], v[156:159]
 s_add_u32 m0, s23, 0
 ds_read_b64_tr_b16 a[80:81], v3 offset:16384
 ds_read_b64_tr_b16 a[82:83], v3 offset:17408
M v[156:159], a[152:155], a[160:163], v[156:159]
 buffer_load_dwordx4 v8, s[16:19], s21 offen offset:0  nt lds
M v[160:163], a[96:99], a[168:171], v[160:163]
 ds_read_b128 a[160:163], v5 offset:53248
 ds_read_b128 a[164:167], v6 offset:53248
M v[160:163], a[100:103], a[172:175], v[160:163]
 v_and_b32 v30, 15, v24
M v[164:167], a[108:111], a[172:175], v[164:167]
 v_add_lshl_u32 v28, v28, v30, 2
M v[164:167], a[104:107], a[168:171], v[164:167]
 v_lshrrev_b32 v30, 1, v0
M v[168:171], a[112:115], a[168:171], v[168:171]
 v_min_u32 v30, 1, v30
M v[168:171], a[116:119], a[172:175], v[168:171]
 ds_read_b64_tr_b16 a[84:85], v3 offset:24576
 ds_read_b64_tr_b16 a[86:87], v3 offset:25600
M v[172:175], a[124:127], a[172:175], v[172:175]
 buffer_load_dwordx4 v9, s[16:19], s21 offen offset:1024  nt lds
M v[172:175], a[120:123], a[168:171], v[172:175]
 v_lshl_or_b32 v28, v30, 29, v28
M v[176:179], a[128:131], a[168:171], v[176:179]
 s_mov_b32 s64, 104857600
 buffer_load_dword v23, v28, s[8:11], s64 offen sc1
M v[176:179], a[132:135], a[172:175], v[176:179]
 v_bfe_u32 v28, v0, 2, 2
M v[180:183], a[140:143], a[172:175], v[180:183]
 v_lshl_add_u32 v28, v29, 3, v28
M v[180:183], a[136:139], a[168:171], v[180:183]
 v_lshlrev_b32 v28, 5, v28
M v[184:187], a[144:147], a[168:171], v[184:187]
 ds_read_b64_tr_b16 a[88:89], v4 offset:16384
 ds_read_b64_tr_b16 a[90:91], v4 offset:17408
M v[184:187], a[148:151], a[172:175], v[184:187]
 s_waitcnt lgkmcnt(4)
 buffer_load_dwordx4 v10, s[16:19], s21 offen offset:2048  nt lds
M v[188:191], a[156:159], a[172:175], v[188:191]
 v_and_b32 v30, 3, v0
M v[188:191], a[152:155], a[168:171], v[188:191]
 v_lshl_add_u32 v28, v30, 3, v28
M v[192:195], a[96:99], a[160:163], v[192:195]
 ds_read_b128 a[168:171], v5 offset:55296
 ds_read_b128 a[172:175], v6 offset:55296
M v[192:195], a[100:103], a[164:167], v[192:195]
 v_add_u32 v22, s87, v28
M v[196:199], a[108:111], a[164:167], v[196:199]
M v[196:199], a[104:107], a[160:163], v[196:199]
 ds_read_b64_tr_b16 a[92:93], v4 offset:24576
 ds_read_b64_tr_b16 a[94:95], v4 offset:25600
M v[200:203], a[112:115], a[160:163], v[200:203]
 buffer_load_dwordx4 v11, s[16:19], s21 offen offset:3072  nt lds
M v[200:203], a[116:119], a[164:167], v[200:203]
 s_add_u32 s21, s21, 128
M v[204:207], a[124:127], a[164:167], v[204:207]
M v[204:207], a[120:123], a[160:163], v[204:207]
M v[208:211], a[128:131], a[160:163], v[208:211]
M v[208:211], a[132:135], a[164:167], v[208:211]
M v[212:215], a[140:143], a[164:167], v[212:215]
M v[212:215], a[136:139], a[160:163], v[212:215]
M v[216:219], a[144:147], a[160:163], v[216:219]
M v[216:219], a[148:151], a[164:167], v[216:219]
 s_waitcnt lgkmcnt(2)
M v[220:223], a[156:159], a[164:167], v[220:223]
 s_waitcnt vmcnt(26) lgkmcnt(0)
M v[220:223], a[152:155], a[160:163], v[220:223]
 s_barrier
M v[224:227], a[96:99], a[168:171], v[224:227]
 ds_read_b128 a[160:163], v5 offset:0
 ds_read_b128 a[164:167], v6 offset:0
M v[224:227], a[100:103], a[172:175], v[224:227]
M v[228:231], a[108:111], a[172:175], v[228:231]
M v[228:231], a[104:107], a[168:171], v[228:231]
M v[232:235], a[112:115], a[168:171], v[232:235]
M v[232:235], a[116:119], a[172:175], v[232:235]
M v[236:239], a[124:127], a[172:175], v[236:239]
M v[236:239], a[120:123], a[168:171], v[236:239]
M v[240:243], a[128:131], a[168:171], v[240:243]
M v[240:243], a[132:135], a[172:175], v[240:243]
M v[244:247], a[140:143], a[172:175], v[244:247]
M v[244:247], a[136:139], a[168:171], v[244:247]
M v[248:251], a[144:147], a[168:171], v[248:251]
M v[248:251], a[148:151], a[172:175], v[248:251]
 s_waitcnt lgkmcnt(0)
M v[252:255], a[156:159], a[172:175], v[252:255]
M v[252:255], a[152:155], a[168:171], v[252:255]
M a[0:3], a[32:35], a[160:163], a[0:3]
 ds_read_b128 a[168:171], v5 offset:2048
 ds_read_b128 a[172:175], v6 offset:2048
M a[0:3], a[36:39], a[164:167], a[0:3]
 ds_read_b64_tr_b16 a[96:97], v1 offset:32768
 ds_read_b64_tr_b16 a[98:99], v1 offset:33792
M a[4:7], a[44:47], a[164:167], a[4:7]
 s_add_u32 m0, s24, 49152
M a[4:7], a[40:43], a[160:163], a[4:7]
 buffer_load_dwordx4 v12, s[48:51], s22 offen offset:0   lds
M a[8:11], a[48:51], a[160:163], a[8:11]
M a[8:11], a[52:55], a[164:167], a[8:11]
M a[12:15], a[60:63], a[164:167], a[12:15]
 ds_read_b64_tr_b16 a[100:101], v1 offset:40960
 ds_read_b64_tr_b16 a[102:103], v1 offset:41984
M a[12:15], a[56:59], a[160:163], a[12:15]
M a[16:19], a[64:67], a[160:163], a[16:19]
 buffer_load_dwordx4 v13, s[48:51], s22 offen offset:1024   lds
M a[16:19], a[68:71], a[164:167], a[16:19]
M a[20:23], a[76:79], a[164:167], a[20:23]
M a[20:23], a[72:75], a[160:163], a[20:23]
 ds_read_b64_tr_b16 a[104:105], v2 offset:32768
 ds_read_b64_tr_b16 a[106:107], v2 offset:33792
M a[24:27], a[80:83], a[160:163], a[24:27]
M a[24:27], a[84:87], a[164:167], a[24:27]
 s_waitcnt lgkmcnt(6)
 buffer_load_dwordx4 v14, s[48:51], s22 offen offset:2048   lds
M a[28:31], a[92:95], a[164:167], a[28:31]
M a[28:31], a[88:91], a[160:163], a[28:31]
M v[32:35], a[32:35], a[168:171], v[32:35]
 ds_read_b128 a[160:163], v5 offset:4096
 ds_read_b128 a[164:167], v6 offset:4096
M v[32:35], a[36:39], a[172:175], v[32:35]
 ds_read_b64_tr_b16 a[108:109], v2 offset:40960
 ds_read_b64_tr_b16 a[110:111], v2 offset:41984
M v[36:39], a[44:47], a[172:175], v[36:39]
 buffer_load_dwordx4 v15, s[48:51], s22 offen offset:3072   lds
M v[36:39], a[40:43], a[168:171], v[36:39]
 s_sub_u32 s22, s22, 2097024
M v[40:43], a[48:51], a[168:171], v[40:43]
M v[40:43], a[52:55], a[172:175], v[40:43]
 ds_read_b64_tr_b16 a[112:113], v3 offset:32768
 ds_read_b64_tr_b16 a[114:115], v3 offset:33792
M v[44:47], a[60:63], a[172:175], v[44:47]
 s_add_u32 m0, s23, 16384
M v[44:47], a[56:59], a[168:171], v[44:47]
 buffer_load_dwordx4 v8, s[16:19], s21 offen offset:0  nt lds
M v[48:51], a[64:67], a[168:171], v[48:51]
M v[48:51], a[68:71], a[172:175], v[48:51]
M v[52:55], a[76:79], a[172:175], v[52:55]
 ds_read_b64_tr_b16 a[116:117], v3 offset:40960
 ds_read_b64_tr_b16 a[118:119], v3 offset:41984
M v[52:55], a[72:75], a[168:171], v[52:55]
M v[56:59], a[80:83], a[168:171], v[56:59]
 buffer_load_dwordx4 v9, s[16:19], s21 offen offset:1024  nt lds
M v[56:59], a[84:87], a[172:175], v[56:59]
 s_waitcnt lgkmcnt(6)
M v[60:63], a[92:95], a[172:175], v[60:63]
M v[60:63], a[88:91], a[168:171], v[60:63]
 ds_read_b64_tr_b16 a[120:121], v4 offset:32768
 ds_read_b64_tr_b16 a[122:123], v4 offset:33792
M v[64:67], a[32:35], a[160:163], v[64:67]
 ds_read_b128 a[168:171], v5 offset:6144
 ds_read_b128 a[172:175], v6 offset:6144
M v[64:67], a[36:39], a[164:167], v[64:67]
 buffer_load_dwordx4 v10, s[16:19], s21 offen offset:2048  nt lds
M v[68:71], a[44:47], a[164:167], v[68:71]
M v[68:71], a[40:43], a[160:163], v[68:71]
M v[72:75], a[48:51], a[160:163], v[72:75]
 ds_read_b64_tr_b16 a[124:125], v4 offset:40960
 ds_read_b64_tr_b16 a[126:127], v4 offset:41984
M v[72:75], a[52:55], a[164:167], v[72:75]
M v[76:79], a[60:63], a[164:167], v[76:79]
 buffer_load_dwordx4 v11, s[16:19], s21 offen offset:3072  nt lds
M v[76:79], a[56:59], a[160:163], v[76:79]
 s_add_u32 s21, s21, 524160
M v[80:83], a[64:67], a[160:163], v[80:83]
M v[80:83], a[68:71], a[164:167], v[80:83]
M v[84:87], a[76:79], a[164:167], v[84:87]
M v[84:87], a[72:75], a[160:163], v[84:87]
M v[88:91], a[80:83], a[160:163], v[88:91]
M v[88:91], a[84:87], a[164:167], v[88:91]
 s_waitcnt lgkmcnt(2)
M v[92:95], a[92:95], a[164:167], v[92:95]
 s_waitcnt vmcnt(24) lgkmcnt(0)
M v[92:95], a[88:91], a[160:163], v[92:95]
 s_barrier
M v[96:99], a[32:35], a[168:171], v[96:99]
 ds_read_b128 a[160:163], v5 offset:16384
 ds_read_b128 a[164:167], v6 offset:16384
M v[96:99], a[36:39], a[172:175], v[96:99]
M v[100:103], a[44:47], a[172:175], v[100:103]
 s_add_u32 m0, s24, 0
 ds_read_b64_tr_b16 a[128:129], v1 offset:49152
 ds_read_b64_tr_b16 a[130:131], v1 offset:50176
M v[100:103], a[40:43], a[168:171], v[100:103]
 buffer_load_dwordx4 v12, s[48:51], s22 offen offset:0   lds
M v[104:107], a[48:51], a[168:171], v[104:107]
 ds_read_b64_tr_b16 a[176:177], v22 offset:0
 ds_read_b64_tr_b16 a[178:179], v22 offset:128
M v[104:107], a[52:55], a[172:175], v[104:107]
 ds_read_b64_tr_b16 a[180:181], v22 offset:1024
 ds_read_b64_tr_b16 a[182:183], v22 offset:1152
M v[108:111], a[60:63], a[172:175], v[108:111]
 ds_read_b64_tr_b16 a[184:185], v22 offset:2048
 ds_read_b64_tr_b16 a[186:187], v22 offset:2176
M v[108:111], a[56:59], a[168:171], v[108:111]
 ds_read_b64_tr_b16 a[188:189], v22 offset:3072
 ds_read_b64_tr_b16 a[190:191], v22 offset:3200
M v[112:115], a[64:67], a[168:171], v[112:115]
M v[112:115], a[68:71], a[172:175], v[112:115]
 ds_read_b64_tr_b16 a[132:133], v1 offset:57344
 ds_read_b64_tr_b16 a[134:135], v1 offset:58368
M v[116:119], a[76:79], a[172:175], v[116:119]
 buffer_load_dwordx4 v13, s[48:51], s22 offen offset:1024   lds
M v[116:119], a[72:75], a[168:171], v[116:119]
M v[120:123], a[80:83], a[168:171], v[120:123]
M v[120:123], a[84:87], a[172:175], v[120:123]
 s_waitcnt lgkmcnt(12)
M v[124:127], a[92:95], a[172:175], v[124:127]
M v[124:127], a[88:91], a[168:171], v[124:127]
M v[128:131], a[32:35], a[160:163], v[128:131]
 ds_read_b128 a[168:171], v5 offset:18432
 ds_read_b128 a[172:175], v6 offset:18432
M v[128:131], a[36:39], a[164:167], v[128:131]
 ds_read_b64_tr_b16 a[136:137], v2 offset:49152
 ds_read_b64_tr_b16 a[138:139], v2 offset:50176
M v[132:135], a[44:47], a[164:167], v[132:135]
 buffer_load_dwordx4 v14, s[48:51], s22 offen offset:2048   lds
M v[132:135], a[40:43], a[160:163], v[132:135]
M v[136:139], a[48:51], a[160:163], v[136:139]
M v[136:139], a[52:55], a[164:167], v[136:139]
M v[140:143], a[60:63], a[164:167], v[140:143]
M v[140:143], a[56:59], a[160:163], v[140:143]
 ds_read_b64_tr_b16 a[140:141], v2 offset:57344
 ds_read_b64_tr_b16 a[142:143], v2 offset:58368
M v[144:147], a[64:67], a[160:163], v[144:147]
 buffer_load_dwordx4 v15, s[48:51], s22 offen offset:3072   lds
M v[144:147], a[68:71], a[164:167], v[144:147]
 s_add_u32 s22, s22, 2097152
M v[148:151], a[76:79], a[164:167], v[148:151]
M v[148:151], a[72:75], a[160:163], v[148:151]
M v[152:155], a[80:83], a[160:163], v[152:155]
M v[152:155], a[84:87], a[164:167], v[152:155]
 s_waitcnt lgkmcnt(4)
M v[156:159], a[92:95], a[164:167], v[156:159]
 s_add_u32 m0, s23, 32768
 ds_read_b64_tr_b16 a[144:145], v3 offset:49152
 ds_read_b64_tr_b16 a[146:147], v3 offset:50176
M v[156:159], a[88:91], a[160:163], v[156:159]
 buffer_load_dwordx4 v8, s[16:19], s21 offen offset:0  nt lds
 s_waitcnt vmcnt(28)
M v[16:19], a[176:179], a[208:211], 0
 s_waitcnt vmcnt(26)
M v[16:19], a[180:183], a[212:215], v[16:19]
 s_waitcnt vmcnt(25)
M v[16:19], a[184:187], a[216:219], v[16:19]
 s_waitcnt vmcnt(23)
M v[16:19], a[188:191], a[220:223], v[16:19]
M v[160:163], a[32:35], a[168:171], v[160:163]
 ds_read_b128 a[160:163], v5 offset:20480
 ds_read_b128 a[164:167], v6 offset:20480
M v[160:163], a[36:39], a[172:175], v[160:163]
 ds_read_b64_tr_b16 a[176:177], v22 offset:4096
 ds_read_b64_tr_b16 a[178:179], v22 offset:4224
M v[164:167], a[44:47], a[172:175], v[164:167]
 ds_read_b64_tr_b16 a[180:181], v22 offset:5120
 ds_read_b64_tr_b16 a[182:183], v22 offset:5248
M v[164:167], a[40:43], a[168:171], v[164:167]
 ds_read_b64_tr_b16 a[184:185], v22 offset:6144
 ds_read_b64_tr_b16 a[186:187], v22 offset:6272
M v[168:171], a[48:51], a[168:171], v[168:171]
M v[168:171], a[52:55], a[172:175], v[168:171]
 ds_read_b64_tr_b16 a[148:149], v3 offset:57344
 ds_read_b64_tr_b16 a[150:151], v3 offset:58368
M v[172:175], a[60:63], a[172:175], v[172:175]
 buffer_load_dwordx4 v9, s[16:19], s21 offen offset:1024  nt lds
M v[172:175], a[56:59], a[168:171], v[172:175]
M v[176:179], a[64:67], a[168:171], v[176:179]
M v[176:179], a[68:71], a[172:175], v[176:179]
M v[180:183], a[76:79], a[172:175], v[180:183]
M v[180:183], a[72:75], a[168:171], v[180:183]
M v[184:187], a[80:83], a[168:171], v[184:187]
 ds_read_b64_tr_b16 a[152:153], v4 offset:49152
 ds_read_b64_tr_b16 a[154:155], v4 offset:50176
M v[184:187], a[84:87], a[172:175], v[184:187]
 s_waitcnt lgkmcnt(10)
 buffer_load_dwordx4 v10, s[16:19], s21 offen offset:2048  nt lds
M v[188:191], a[92:95], a[172:175], v[188:191]
M v[188:191], a[88:91], a[168:171], v[188:191]
M v[192:195], a[32:35], a[160:163], v[192:195]
 ds_read_b128 a[168:171], v5 offset:22528
 ds_read_b128 a[172:175], v6 offset:22528
M v[192:195], a[36:39], a[164:167], v[192:195]
M v[196:199], a[44:47], a[164:167], v[196:199]
M v[196:199], a[40:43], a[160:163], v[196:199]
 ds_read_b64_tr_b16 a[156:157], v4 offset:57344
 ds_read_b64_tr_b16 a[158:159], v4 offset:58368
M v[200:203], a[48:51], a[160:163], v[200:203]
 buffer_load_dwordx4 v11, s[16:19], s21 offen offset:3072  nt lds
M v[200:203], a[52:55], a[164:167], v[200:203]
 s_add_u32 s21, s21, 128
M v[204:207], a[60:63], a[164:167], v[204:207]
M v[204:207], a[56:59], a[160:163], v[204:207]
M v[208:211], a[64:67], a[160:163], v[208:211]
M v[208:211], a[68:71], a[164:167], v[208:211]
M v[212:215], a[76:79], a[164:167], v[212:215]
M v[212:215], a[72:75], a[160:163], v[212:215]
M v[216:219], a[80:83], a[160:163], v[216:219]
M v[216:219], a[84:87], a[164:167], v[216:219]
 s_waitcnt lgkmcnt(2)
M v[220:223], a[92:95], a[164:167], v[220:223]
 s_waitcnt vmcnt(16) lgkmcnt(0)
M v[220:223], a[88:91], a[160:163], v[220:223]
 s_barrier
M v[16:19], a[176:179], a[224:227], v[16:19]
M v[16:19], a[180:183], a[228:231], v[16:19]
M v[16:19], a[184:187], a[232:235], v[16:19]
M v[224:227], a[32:35], a[168:171], v[224:227]
 ds_read_b128 a[160:163], v5 offset:32768
 ds_read_b128 a[164:167], v6 offset:32768
M v[224:227], a[36:39], a[172:175], v[224:227]
M v[228:231], a[44:47], a[172:175], v[228:231]
M v[228:231], a[40:43], a[168:171], v[228:231]
M v[232:235], a[48:51], a[168:171], v[232:235]
M v[232:235], a[52:55], a[172:175], v[232:235]
M v[236:239], a[60:63], a[172:175], v[236:239]
M v[236:239], a[56:59], a[168:171], v[236:239]
M v[240:243], a[64:67], a[168:171], v[240:243]
M v[240:243], a[68:71], a[172:175], v[240:243]
M v[244:247], a[76:79], a[172:175], v[244:247]
M v[244:247], a[72:75], a[168:171], v[244:247]
M v[248:251], a[80:83], a[168:171], v[248:251]
M v[248:251], a[84:87], a[172:175], v[248:251]
 s_waitcnt lgkmcnt(0)
M v[252:255], a[92:95], a[172:175], v[252:255]
M v[252:255], a[88:91], a[168:171], v[252:255]
M a[0:3], a[96:99], a[160:163], a[0:3]
 ds_read_b128 a[168:171], v5 offset:34816
 ds_read_b128 a[172:175], v6 offset:34816
M a[0:3], a[100:103], a[164:167], a[0:3]
 ds_read_b64_tr_b16 a[32:33], v1 offset:0
 ds_read_b64_tr_b16 a[34:35], v1 offset:1024
M a[4:7], a[108:111], a[164:167], a[4:7]
 s_add_u32 m0, s24, 16384
M a[4:7], a[104:107], a[160:163], a[4:7]
 buffer_load_dwordx4 v12, s[48:51], s22 offen offset:0   lds
M a[8:11], a[112:115], a[160:163], a[8:11]
M a[8:11], a[116:119], a[164:167], a[8:11]
 s_lshl_b32 s64, s20, 10
M a[12:15], a[124:127], a[164:167], a[12:15]
 s_add_u32 s64, s64, 159744
 ds_read_b64_tr_b16 a[36:37], v1 offset:8192
 ds_read_b64_tr_b16 a[38:39], v1 offset:9216
M a[12:15], a[120:123], a[160:163], a[12:15]
 v_add_u32 v21, s64, v7
 ds_write_b128 v21, v[16:19]
M a[16:19], a[128:131], a[160:163], a[16:19]
 s_mul_i32 s67, s86, 14336
 buffer_load_dwordx4 v13, s[48:51], s22 offen offset:1024   lds
M a[16:19], a[132:135], a[164:167], a[16:19]
 s_mul_i32 s64, s20, 224
M a[20:23], a[140:143], a[164:167], a[20:23]
 s_add_u32 s67, s67, s64
 v_lshrrev_b32 v28, 4, v0
 v_mul_u32_u24 v28, 896, v28
M a[20:23], a[136:139], a[160:163], a[20:23]
 ds_read_b64_tr_b16 a[40:41], v2 offset:0
 ds_read_b64_tr_b16 a[42:43], v2 offset:1024
M a[24:27], a[144:147], a[160:163], a[24:27]
 v_and_b32 v29, 15, v0
 v_lshl_add_u32 v28, v29, 4, v28
M a[24:27], a[148:151], a[164:167], a[24:27]
 s_waitcnt lgkmcnt(7)
 buffer_load_dwordx4 v14, s[48:51], s22 offen offset:2048   lds
M a[28:31], a[156:159], a[164:167], a[28:31]
 v_mov_b32 v30, 536870912
 v_cmp_gt_u32 vcc, 14, v29
M a[28:31], a[152:155], a[160:163], a[28:31]
 s_nop 0
M v[32:35], a[96:99], a[168:171], v[32:35]
 s_nop 0
 ds_read_b128 a[160:163], v5 offset:36864
 ds_read_b128 a[164:167], v6 offset:36864
M v[32:35], a[100:103], a[172:175], v[32:35]
 ds_read_b64_tr_b16 a[44:45], v2 offset:8192
 ds_read_b64_tr_b16 a[46:47], v2 offset:9216
M v[36:39], a[108:111], a[172:175], v[36:39]
 buffer_load_dwordx4 v15, s[48:51], s22 offen offset:3072   lds
M v[36:39], a[104:107], a[168:171], v[36:39]
 s_sub_u32 s22, s22, 2097024
 v_cndmask_b32 v28, v30, v28, vcc
 v_add_u32 v29, 2560, v28
M v[40:43], a[112:115], a[168:171], v[40:43]
 v_add_u32 v30, 5120, v28
 v_add_u32 v31, 7680, v28
M v[40:43], a[116:119], a[172:175], v[40:43]
 ds_read_b64_tr_b16 a[48:49], v3 offset:0
 ds_read_b64_tr_b16 a[50:51], v3 offset:1024
M v[44:47], a[124:127], a[172:175], v[44:47]
 s_add_u32 m0, s23, 49152
M v[44:47], a[120:123], a[168:171], v[44:47]
 buffer_load_dwordx4 v8, s[16:19], s21 offen offset:0  nt lds
M v[48:51], a[128:131], a[168:171], v[48:51]
M v[48:51], a[132:135], a[172:175], v[48:51]
M v[52:55], a[140:143], a[172:175], v[52:55]
 ds_read_b64_tr_b16 a[52:53], v3 offset:8192
 ds_read_b64_tr_b16 a[54:55], v3 offset:9216
M v[52:55], a[136:139], a[168:171], v[52:55]
M v[56:59], a[144:147], a[168:171], v[56:59]
 buffer_load_dwordx4 v9, s[16:19], s21 offen offset:1024  nt lds
M v[56:59], a[148:151], a[172:175], v[56:59]
 s_waitcnt lgkmcnt(6)
M v[60:63], a[156:159], a[172:175], v[60:63]
M v[60:63], a[152:155], a[168:171], v[60:63]
 ds_read_b64_tr_b16 a[56:57], v4 offset:0
 ds_read_b64_tr_b16 a[58:59], v4 offset:1024
M v[64:67], a[96:99], a[160:163], v[64:67]
 ds_read_b128 a[168:171], v5 offset:38912
 ds_read_b128 a[172:175], v6 offset:38912
M v[64:67], a[100:103], a[164:167], v[64:67]
 buffer_load_dwordx4 v10, s[16:19], s21 offen offset:2048  nt lds
M v[68:71], a[108:111], a[164:167], v[68:71]
M v[68:71], a[104:107], a[160:163], v[68:71]
M v[72:75], a[112:115], a[160:163], v[72:75]
 ds_read_b64_tr_b16 a[60:61], v4 offset:8192
 ds_read_b64_tr_b16 a[62:63], v4 offset:9216
M v[72:75], a[116:119], a[164:167], v[72:75]
M v[76:79], a[124:127], a[164:167], v[76:79]
 buffer_load_dwordx4 v11, s[16:19], s21 offen offset:3072  nt lds
M v[76:79], a[120:123], a[160:163], v[76:79]
 s_add_u32 s21, s21, 524160
M v[80:83], a[128:131], a[160:163], v[80:83]
M v[80:83], a[132:135], a[164:167], v[80:83]
M v[84:87], a[140:143], a[164:167], v[84:87]
M v[84:87], a[136:139], a[160:163], v[84:87]
M v[88:91], a[144:147], a[160:163], v[88:91]
M v[88:91], a[148:151], a[164:167], v[88:91]
 s_waitcnt lgkmcnt(2)
M v[92:95], a[156:159], a[164:167], v[92:95]
 s_waitcnt vmcnt(16) lgkmcnt(0)
M v[92:95], a[152:155], a[160:163], v[92:95]
 s_barrier
M v[96:99], a[96:99], a[168:171], v[96:99]
 ds_read_b128 a[160:163], v5 offset:49152
 ds_read_b128 a[164:167], v6 offset:49152
M v[96:99], a[100:103], a[172:175], v[96:99]
M v[100:103], a[108:111], a[172:175], v[100:103]
 s_add_u32 m0, s24, 32768
 ds_read_b64_tr_b16 a[64:65], v1 offset:16384
 ds_read_b64_tr_b16 a[66:67], v1 offset:17408
M v[100:103], a[104:107], a[168:171], v[100:103]
 buffer_load_dwordx4 v12, s[48:51], s22 offen offset:0   lds
M v[104:107], a[112:115], a[168:171], v[104:107]
M v[104:107], a[116:119], a[172:175], v[104:107]
M v[108:111], a[124:127], a[172:175], v[108:111]
M v[108:111], a[120:123], a[168:171], v[108:111]
 buffer_load_dwordx4 v13, s[48:51], s22 offen offset:1024   lds
M v[112:115], a[128:131], a[168:171], v[112:115]
M v[112:115], a[132:135], a[172:175], v[112:115]
 ds_read_b64_tr_b16 a[68:69], v1 offset:24576
 ds_read_b64_tr_b16 a[70:71], v1 offset:25600
M v[116:119], a[140:143], a[172:175], v[116:119]
M v[116:119], a[136:139], a[168:171], v[116:119]
M v[120:123], a[144:147], a[168:171], v[120:123]
 buffer_load_dwordx4 v14, s[48:51], s22 offen offset:2048   lds
M v[120:123], a[148:151], a[172:175], v[120:123]
 s_waitcnt lgkmcnt(4)
M v[124:127], a[156:159], a[172:175], v[124:127]
M v[124:127], a[152:155], a[168:171], v[124:127]
M v[128:131], a[96:99], a[160:163], v[128:131]
 ds_read_b128 a[168:171], v5 offset:51200
 ds_read_b128 a[172:175], v6 offset:51200
M v[128:131], a[100:103], a[164:167], v[128:131]
 ds_read_b64_tr_b16 a[72:73], v2 offset:16384
 ds_read_b64_tr_b16 a[74:75], v2 offset:17408
M v[132:135], a[108:111], a[164:167], v[132:135]
 buffer_load_dwordx4 v15, s[48:51], s22 offen offset:3072   lds
M v[132:135], a[104:107], a[160:163], v[132:135]
 s_add_u32 s22, s22, 2097152
M v[136:139], a[112:115], a[160:163], v[136:139]
M v[136:139], a[116:119], a[164:167], v[136:139]
 s_add_u32 m0, s23, 0
M v[140:143], a[124:127], a[164:167], v[140:143]
 buffer_load_dwordx4 v8, s[16:19], s21 offen offset:0  nt lds
M v[140:143], a[120:123], a[160:163], v[140:143]
 ds_read_b64_tr_b16 a[76:77], v2 offset:24576
 ds_read_b64_tr_b16 a[78:79], v2 offset:25600
M v[144:147], a[128:131], a[160:163], v[144:147]
M v[144:147], a[132:135], a[164:167], v[144:147]
M v[148:151], a[140:143], a[164:167], v[148:151]
 buffer_load_dwordx4 v9, s[16:19], s21 offen offset:1024  nt lds
M v[148:151], a[136:139], a[160:163], v[148:151]
M v[152:155], a[144:147], a[160:163], v[152:155]
M v[152:155], a[148:151], a[164:167], v[152:155]
 s_waitcnt lgkmcnt(4)
M v[156:159], a[156:159], a[164:167], v[156:159]
 ds_read_b64_tr_b16 a[80:81], v3 offset:16384
 ds_read_b64_tr_b16 a[82:83], v3 offset:17408
M v[156:159], a[152:155], a[160:163], v[156:159]
 buffer_load_dwordx4 v10, s[16:19], s21 offen offset:2048  nt lds
M v[160:163], a[96:99], a[168:171], v[160:163]
 ds_read_b128 a[160:163], v5 offset:53248
 ds_read_b128 a[164:167], v6 offset:53248
M v[160:163], a[100:103], a[172:175], v[160:163]
M v[164:167], a[108:111], a[172:175], v[164:167]
M v[164:167], a[104:107], a[168:171], v[164:167]
M v[168:171], a[112:115], a[168:171], v[168:171]
 buffer_load_dwordx4 v11, s[16:19], s21 offen offset:3072  nt lds
M v[168:171], a[116:119], a[172:175], v[168:171]
 s_add_u32 s21, s21, 128
 ds_read_b64_tr_b16 a[84:85], v3 offset:24576
 ds_read_b64_tr_b16 a[86:87], v3 offset:25600
M v[172:175], a[124:127], a[172:175], v[172:175]
M v[172:175], a[120:123], a[168:171], v[172:175]
M v[176:179], a[128:131], a[168:171], v[176:179]
 s_add_u32 m0, s87, 0
M v[176:179], a[132:135], a[172:175], v[176:179]
 buffer_load_dwordx4 v28, s[68:71], s67 offen offset:0 nt lds
M v[180:183], a[140:143], a[172:175], v[180:183]
M v[180:183], a[136:139], a[168:171], v[180:183]
M v[184:187], a[144:147], a[168:171], v[184:187]
 ds_read_b64_tr_b16 a[88:89], v4 offset:16384
 ds_read_b64_tr_b16 a[90:91], v4 offset:17408
M v[184:187], a[148:151], a[172:175], v[184:187]
 s_waitcnt lgkmcnt(4)
 buffer_load_dwordx4 v29, s[68:71], s67 offen offset:1024 nt lds
M v[188:191], a[156:159], a[172:175], v[188:191]
M v[188:191], a[152:155], a[168:171], v[188:191]
M v[192:195], a[96:99], a[160:163], v[192:195]
 ds_read_b128 a[168:171], v5 offset:55296
 ds_read_b128 a[172:175], v6 offset:55296
M v[192:195], a[100:103], a[164:167], v[192:195]
M v[196:199], a[108:111], a[164:167], v[196:199]
 buffer_load_dwordx4 v30, s[68:71], s67 offen offset:2048 nt lds
M v[196:199], a[104:107], a[160:163], v[196:199]
 ds_read_b64_tr_b16 a[92:93], v4 offset:24576
 ds_read_b64_tr_b16 a[94:95], v4 offset:25600
M v[200:203], a[112:115], a[160:163], v[200:203]
M v[200:203], a[116:119], a[164:167], v[200:203]
M v[204:207], a[124:127], a[164:167], v[204:207]
M v[204:207], a[120:123], a[160:163], v[204:207]
 buffer_load_dwordx4 v31, s[68:71], s67 offen offset:3072 nt lds
M v[208:211], a[128:131], a[160:163], v[208:211]
 s_add_u32 s67, s67, 0
M v[208:211], a[132:135], a[164:167], v[208:211]
M v[212:215], a[140:143], a[164:167], v[212:215]
M v[212:215], a[136:139], a[160:163], v[212:215]
M v[216:219], a[144:147], a[160:163], v[216:219]
M v[216:219], a[148:151], a[164:167], v[216:219]
 s_waitcnt lgkmcnt(2)
M v[220:223], a[156:159], a[164:167], v[220:223]
 s_waitcnt vmcnt(20) lgkmcnt(0)
M v[220:223], a[152:155], a[160:163], v[220:223]
 s_barrier
M v[224:227], a[96:99], a[168:171], v[224:227]
 ds_read_b128 a[160:163], v5 offset:0
 ds_read_b128 a[164:167], v6 offset:0
M v[224:227], a[100:103], a[172:175], v[224:227]
M v[228:231], a[108:111], a[172:175], v[228:231]
M v[228:231], a[104:107], a[168:171], v[228:231]
M v[232:235], a[112:115], a[168:171], v[232:235]
M v[232:235], a[116:119], a[172:175], v[232:235]
M v[236:239], a[124:127], a[172:175], v[236:239]
M v[236:239], a[120:123], a[168:171], v[236:239]
M v[240:243], a[128:131], a[168:171], v[240:243]
M v[240:243], a[132:135], a[172:175], v[240:243]
M v[244:247], a[140:143], a[172:175], v[244:247]
M v[244:247], a[136:139], a[168:171], v[244:247]
M v[248:251], a[144:147], a[168:171], v[248:251]
M v[248:251], a[148:151], a[172:175], v[248:251]
 s_waitcnt lgkmcnt(0)
M v[252:255], a[156:159], a[172:175], v[252:255]
M v[252:255], a[152:155], a[168:171], v[252:255]
M a[0:3], a[32:35], a[160:163], a[0:3]
 ds_read_b128 a[168:171], v5 offset:2048
 ds_read_b128 a[172:175], v6 offset:2048
M a[0:3], a[36:39], a[164:167], a[0:3]
 ds_read_b64_tr_b16 a[96:97], v1 offset:32768
 ds_read_b64_tr_b16 a[98:99], v1 offset:33792
M a[4:7], a[44:47], a[164:167], a[4:7]
 s_add_u32 m0, s24, 49152
 v_cvt_pk_bf16_f32 v23, v23, v23
M a[4:7], a[40:43], a[160:163], a[4:7]
 buffer_load_dwordx4 v12, s[48:51], s22 offen offset:0   lds
M a[8:11], a[48:51], a[160:163], a[8:11]
 v_and_b32 v23, 0xffff0000, v23
M a[8:11], a[52:55], a[164:167], a[8:11]
 v_mul_f32 v22, 0xbfb8aa3b, v23
M a[12:15], a[60:63], a[164:167], a[12:15]
 ds_read_b64_tr_b16 a[100:101], v1 offset:40960
 ds_read_b64_tr_b16 a[102:103], v1 offset:41984
M a[12:15], a[56:59], a[160:163], a[12:15]
 v_exp_f32 v22, v22
M a[16:19], a[64:67], a[160:163], a[16:19]
 buffer_load_dwordx4 v13, s[48:51], s22 offen offset:1024   lds
M a[16:19], a[68:71], a[164:167], a[16:19]
 v_add_f32 v22, 1.0, v22
M a[20:23], a[76:79], a[164:167], a[20:23]
 v_rcp_f32 v23, v22
M a[20:23], a[72:75], a[160:163], a[20:23]
 s_or_b32 s64, s86, s20
 ds_read_b64_tr_b16 a[104:105], v2 offset:32768
 ds_read_b64_tr_b16 a[106:107], v2 offset:33792
M a[24:27], a[80:83], a[160:163], a[24:27]
 s_min_u32 s64, s64, 1
 s_lshl_b32 s64, s64, 29
 v_lshrrev_b32 v22, 1, v0
M a[24:27], a[84:87], a[164:167], a[24:27]
 s_waitcnt lgkmcnt(6)
 buffer_load_dwordx4 v14, s[48:51], s22 offen offset:2048   lds
M a[28:31], a[92:95], a[164:167], a[28:31]
 v_min_u32 v22, 1, v22
M a[28:31], a[88:91], a[160:163], a[28:31]
 v_lshlrev_b32 v22, 29, v22
M v[32:35], a[32:35], a[168:171], v[32:35]
 ds_read_b128 a[160:163], v5 offset:4096
 ds_read_b128 a[164:167], v6 offset:4096
M v[32:35], a[36:39], a[172:175], v[32:35]
 ds_read_b64_tr_b16 a[108:109], v2 offset:40960
 ds_read_b64_tr_b16 a[110:111], v2 offset:41984
M v[36:39], a[44:47], a[172:175], v[36:39]
 buffer_load_dwordx4 v15, s[48:51], s22 offen offset:3072   lds
M v[36:39], a[40:43], a[168:171], v[36:39]
 s_sub_u32 s22, s22, 2097024
 v_lshl_or_b32 v22, v0, 2, v22
M v[40:43], a[48:51], a[168:171], v[40:43]
 v_or_b32 v22, s64, v22
M v[40:43], a[52:55], a[172:175], v[40:43]
 ds_read_b64_tr_b16 a[112:113], v3 offset:32768
 ds_read_b64_tr_b16 a[114:115], v3 offset:33792
M v[44:47], a[60:63], a[172:175], v[44:47]
 s_add_u32 m0, s23, 16384
 v_cvt_pk_bf16_f32 v23, v23, v23
M v[44:47], a[56:59], a[168:171], v[44:47]
 buffer_load_dwordx4 v8, s[16:19], s21 offen offset:0  nt lds
M v[48:51], a[64:67], a[168:171], v[48:51]
 v_and_b32 v23, 0xffff0000, v23
M v[48:51], a[68:71], a[172:175], v[48:51]
 s_mov_b32 s64, 104890368
 buffer_store_dword v24, v22, s[8:11], s64 offen sc1
M v[52:55], a[76:79], a[172:175], v[52:55]
 ds_read_b64_tr_b16 a[116:117], v3 offset:40960
 ds_read_b64_tr_b16 a[118:119], v3 offset:41984
M v[52:55], a[72:75], a[168:171], v[52:55]
 buffer_store_dword v23, v22, s[8:11], s64 offen offset:8 sc1
M v[56:59], a[80:83], a[168:171], v[56:59]
 buffer_load_dwordx4 v9, s[16:19], s21 offen offset:1024  nt lds
M v[56:59], a[84:87], a[172:175], v[56:59]
 s_waitcnt lgkmcnt(6)
 v_add_u32 v25, 159744, v7
M v[60:63], a[92:95], a[172:175], v[60:63]
 ds_read_b128 v[16:19], v25
M v[60:63], a[88:91], a[168:171], v[60:63]
 ds_read_b64_tr_b16 a[120:121], v4 offset:32768
 ds_read_b64_tr_b16 a[122:123], v4 offset:33792
M v[64:67], a[32:35], a[160:163], v[64:67]
 ds_read_b128 a[168:171], v5 offset:6144
 ds_read_b128 a[172:175], v6 offset:6144
M v[64:67], a[36:39], a[164:167], v[64:67]
 buffer_load_dwordx4 v10, s[16:19], s21 offen offset:2048  nt lds
M v[68:71], a[44:47], a[164:167], v[68:71]
 ds_read_b128 v[28:31], v25 offset:1024
M v[68:71], a[40:43], a[160:163], v[68:71]
 ds_read_b128 v[20:23], v25 offset:2048
M v[72:75], a[48:51], a[160:163], v[72:75]
 ds_read_b64_tr_b16 a[124:125], v4 offset:40960
 ds_read_b64_tr_b16 a[126:127], v4 offset:41984
M v[72:75], a[52:55], a[164:167], v[72:75]
M v[76:79], a[60:63], a[164:167], v[76:79]
 buffer_load_dwordx4 v11, s[16:19], s21 offen offset:3072  nt lds
M v[76:79], a[56:59], a[160:163], v[76:79]
 s_add_u32 s21, s21, 524160
M v[80:83], a[64:67], a[160:163], v[80:83]
M v[80:83], a[68:71], a[164:167], v[80:83]
M v[84:87], a[76:79], a[164:167], v[84:87]
M v[84:87], a[72:75], a[160:163], v[84:87]
 s_waitcnt lgkmcnt(3)
 v_add_f32 v16, v28, v16
M v[88:91], a[80:83], a[160:163], v[88:91]
 v_add_f32 v17, v29, v17
M v[88:91], a[84:87], a[164:167], v[88:91]
 v_add_f32 v18, v30, v18
M v[92:95], a[92:95], a[164:167], v[92:95]
 s_waitcnt vmcnt(22) lgkmcnt(0)
 v_add_f32 v19, v31, v19
M v[92:95], a[88:91], a[160:163], v[92:95]
 s_barrier
M v[96:99], a[32:35], a[168:171], v[96:99]
 ds_read_b128 a[160:163], v5 offset:16384
 ds_read_b128 a[164:167], v6 offset:16384
M v[96:99], a[36:39], a[172:175], v[96:99]
 ds_read_b128 v[28:31], v25 offset:3072
M v[100:103], a[44:47], a[172:175], v[100:103]
 s_add_u32 m0, s24, 0
 ds_read_b64_tr_b16 a[128:129], v1 offset:49152
 ds_read_b64_tr_b16 a[130:131], v1 offset:50176
M v[100:103], a[40:43], a[168:171], v[100:103]
 buffer_load_dwordx4 v12, s[48:51], s22 offen offset:0   lds
M v[104:107], a[48:51], a[168:171], v[104:107]
 v_cvt_pk_bf16_f32 v25, v16, v17
M v[104:107], a[52:55], a[172:175], v[104:107]
 v_lshlrev_b32 v16, 16, v25
M v[108:111], a[60:63], a[172:175], v[108:111]
 v_and_b32 v17, 0xffff0000, v25
M v[108:111], a[56:59], a[168:171], v[108:111]
 v_cvt_pk_bf16_f32 v25, v18, v19
M v[112:115], a[64:67], a[168:171], v[112:115]
 v_lshlrev_b32 v18, 16, v25
M v[112:115], a[68:71], a[172:175], v[112:115]
 ds_read_b64_tr_b16 a[132:133], v1 offset:57344
 ds_read_b64_tr_b16 a[134:135], v1 offset:58368
M v[116:119], a[76:79], a[172:175], v[116:119]
 buffer_load_dwordx4 v13, s[48:51], s22 offen offset:1024   lds
M v[116:119], a[72:75], a[168:171], v[116:119]
 v_and_b32 v19, 0xffff0000, v25
M v[120:123], a[80:83], a[168:171], v[120:123]
 s_waitcnt lgkmcnt(4)
 v_add_f32 v20, v28, v20
M v[120:123], a[84:87], a[172:175], v[120:123]
 v_add_f32 v21, v29, v21
M v[124:127], a[92:95], a[172:175], v[124:127]
 v_add_f32 v22, v30, v22
M v[124:127], a[88:91], a[168:171], v[124:127]
 v_add_f32 v23, v31, v23
M v[128:131], a[32:35], a[160:163], v[128:131]
 ds_read_b128 a[168:171], v5 offset:18432
 ds_read_b128 a[172:175], v6 offset:18432
M v[128:131], a[36:39], a[164:167], v[128:131]
 ds_read_b64_tr_b16 a[136:137], v2 offset:49152
 ds_read_b64_tr_b16 a[138:139], v2 offset:50176
M v[132:135], a[44:47], a[164:167], v[132:135]
 buffer_load_dwordx4 v14, s[48:51], s22 offen offset:2048   lds
M v[132:135], a[40:43], a[160:163], v[132:135]
 v_mul_f32 v28, 0xbfb8aa3b, v16
M v[136:139], a[48:51], a[160:163], v[136:139]
 v_mul_f32 v29, 0xbfb8aa3b, v17
M v[136:139], a[52:55], a[164:167], v[136:139]
 v_mul_f32 v30, 0xbfb8aa3b, v18
M v[140:143], a[60:63], a[164:167], v[140:143]
 v_mul_f32 v31, 0xbfb8aa3b, v19
M v[140:143], a[56:59], a[160:163], v[140:143]
 ds_read_b64_tr_b16 a[140:141], v2 offset:57344
 ds_read_b64_tr_b16 a[142:143], v2 offset:58368
M v[144:147], a[64:67], a[160:163], v[144:147]
 buffer_load_dwordx4 v15, s[48:51], s22 offen offset:3072   lds
M v[144:147], a[68:71], a[164:167], v[144:147]
 s_add_u32 s22, s22, 2097152
 v_exp_f32 v28, v28
M v[148:151], a[76:79], a[164:167], v[148:151]
 v_exp_f32 v29, v29
M v[148:151], a[72:75], a[160:163], v[148:151]
 v_exp_f32 v30, v30
M v[152:155], a[80:83], a[160:163], v[152:155]
 v_exp_f32 v31, v31
M v[152:155], a[84:87], a[164:167], v[152:155]
 s_waitcnt lgkmcnt(4)
 v_cvt_pk_bf16_f32 v25, v20, v21
M v[156:159], a[92:95], a[164:167], v[156:159]
 s_add_u32 m0, s23, 32768
 ds_read_b64_tr_b16 a[144:145], v3 offset:49152
 ds_read_b64_tr_b16 a[146:147], v3 offset:50176
M v[156:159], a[88:91], a[160:163], v[156:159]
 buffer_load_dwordx4 v8, s[16:19], s21 offen offset:0  nt lds
M v[160:163], a[32:35], a[168:171], v[160:163]
 ds_read_b128 a[160:163], v5 offset:20480
 ds_read_b128 a[164:167], v6 offset:20480
M v[160:163], a[36:39], a[172:175], v[160:163]
 v_lshlrev_b32 v20, 16, v25
M v[164:167], a[44:47], a[172:175], v[164:167]
 v_and_b32 v21, 0xffff0000, v25
M v[164:167], a[40:43], a[168:171], v[164:167]
 v_cvt_pk_bf16_f32 v25, v22, v23
M v[168:171], a[48:51], a[168:171], v[168:171]
 v_lshlrev_b32 v22, 16, v25
M v[168:171], a[52:55], a[172:175], v[168:171]
 ds_read_b64_tr_b16 a[148:149], v3 offset:57344
 ds_read_b64_tr_b16 a[150:151], v3 offset:58368
M v[172:175], a[60:63], a[172:175], v[172:175]
 buffer_load_dwordx4 v9, s[16:19], s21 offen offset:1024  nt lds
M v[172:175], a[56:59], a[168:171], v[172:175]
 v_and_b32 v23, 0xffff0000, v25
M v[176:179], a[64:67], a[168:171], v[176:179]
 v_add_f32 v28, 1.0, v28
M v[176:179], a[68:71], a[172:175], v[176:179]
 v_add_f32 v29, 1.0, v29
M v[180:183], a[76:79], a[172:175], v[180:183]
 v_add_f32 v30, 1.0, v30
M v[180:183], a[72:75], a[168:171], v[180:183]
 v_add_f32 v31, 1.0, v31
M v[184:187], a[80:83], a[168:171], v[184:187]
 ds_read_b64_tr_b16 a[152:153], v4 offset:49152
 ds_read_b64_tr_b16 a[154:155], v4 offset:50176
M v[184:187], a[84:87], a[172:175], v[184:187]
 s_waitcnt lgkmcnt(4)
 buffer_load_dwordx4 v10, s[16:19], s21 offen offset:2048  nt lds
M v[188:191], a[92:95], a[172:175], v[188:191]
 v_rcp_f32 v28, v28
M v[188:191], a[88:91], a[168:171], v[188:191]
 v_rcp_f32 v29, v29
M v[192:195], a[32:35], a[160:163], v[192:195]
 ds_read_b128 a[168:171], v5 offset:22528
 ds_read_b128 a[172:175], v6 offset:22528
M v[192:195], a[36:39], a[164:167], v[192:195]
 v_rcp_f32 v30, v30
M v[196:199], a[44:47], a[164:167], v[196:199]
 v_rcp_f32 v31, v31
M v[196:199], a[40:43], a[160:163], v[196:199]
 ds_read_b64_tr_b16 a[156:157], v4 offset:57344
 ds_read_b64_tr_b16 a[158:159], v4 offset:58368
M v[200:203], a[48:51], a[160:163], v[200:203]
 buffer_load_dwordx4 v11, s[16:19], s21 offen offset:3072  nt lds
M v[200:203], a[52:55], a[164:167], v[200:203]
 s_add_u32 s21, s21, 128
 v_mul_f32 v16, v28, v16
M v[204:207], a[60:63], a[164:167], v[204:207]
 v_mul_f32 v17, v29, v17
M v[204:207], a[56:59], a[160:163], v[204:207]
 v_mul_f32 v18, v30, v18
M v[208:211], a[64:67], a[160:163], v[208:211]
 v_mul_f32 v19, v31, v19
M v[208:211], a[68:71], a[164:167], v[208:211]
 v_cvt_pk_bf16_f32 v25, v16, v17
M v[212:215], a[76:79], a[164:167], v[212:215]
 v_lshlrev_b32 v16, 16, v25
M v[212:215], a[72:75], a[160:163], v[212:215]
 v_and_b32 v17, 0xffff0000, v25
M v[216:219], a[80:83], a[160:163], v[216:219]
 v_cvt_pk_bf16_f32 v25, v18, v19
M v[216:219], a[84:87], a[164:167], v[216:219]
 s_waitcnt lgkmcnt(2)
 v_lshlrev_b32 v18, 16, v25
M v[220:223], a[92:95], a[164:167], v[220:223]
 s_waitcnt vmcnt(22) lgkmcnt(0)
 v_and_b32 v19, 0xffff0000, v25
M v[220:223], a[88:91], a[160:163], v[220:223]
 s_barrier
M v[224:227], a[32:35], a[168:171], v[224:227]
 ds_read_b128 a[160:163], v5 offset:32768
 ds_read_b128 a[164:167], v6 offset:32768
M v[224:227], a[36:39], a[172:175], v[224:227]
 v_mul_f32 v16, v20, v16
M v[228:231], a[44:47], a[172:175], v[228:231]
 v_mul_f32 v17, v21, v17
M v[228:231], a[40:43], a[168:171], v[228:231]
 v_mul_f32 v18, v22, v18
M v[232:235], a[48:51], a[168:171], v[232:235]
 v_mul_f32 v19, v23, v19
M v[232:235], a[52:55], a[172:175], v[232:235]
 v_cvt_pk_bf16_f32 v16, v16, v17
M v[236:239], a[60:63], a[172:175], v[236:239]
 v_cvt_pk_bf16_f32 v17, v18, v19
M v[236:239], a[56:59], a[168:171], v[236:239]
M v[240:243], a[64:67], a[168:171], v[240:243]
M v[240:243], a[68:71], a[172:175], v[240:243]
M v[244:247], a[76:79], a[172:175], v[244:247]
M v[244:247], a[72:75], a[168:171], v[244:247]
M v[248:251], a[80:83], a[168:171], v[248:251]
M v[248:251], a[84:87], a[172:175], v[248:251]
 s_waitcnt lgkmcnt(0)
M v[252:255], a[92:95], a[172:175], v[252:255]
M v[252:255], a[88:91], a[168:171], v[252:255]
M a[0:3], a[96:99], a[160:163], a[0:3]
 ds_read_b128 a[168:171], v5 offset:34816
 ds_read_b128 a[172:175], v6 offset:34816
M a[0:3], a[100:103], a[164:167], a[0:3]
 ds_read_b64_tr_b16 a[32:33], v1 offset:0
 ds_read_b64_tr_b16 a[34:35], v1 offset:1024
M a[4:7], a[108:111], a[164:167], a[4:7]
 s_add_u32 m0, s24, 16384
 v_lshrrev_b32 v28, 2, v0
 v_lshlrev_b32 v28, 8, v28
M a[4:7], a[104:107], a[160:163], a[4:7]
 buffer_load_dwordx4 v12, s[48:51], s22 offen offset:0   lds
M a[8:11], a[112:115], a[160:163], a[8:11]
 v_and_b32 v29, 3, v0
 v_lshl_add_u32 v28, v29, 3, v28
M a[8:11], a[116:119], a[164:167], a[8:11]
 v_add_u32 v28, s87, v28
M a[12:15], a[124:127], a[164:167], a[12:15]
 s_waitcnt vmcnt(19)
 ds_read_b64_tr_b16 a[36:37], v1 offset:8192
 ds_read_b64_tr_b16 a[38:39], v1 offset:9216
M a[12:15], a[120:123], a[160:163], a[12:15]
 ds_read_b64_tr_b16 a[176:177], v28 offset:0
 ds_read_b64_tr_b16 a[178:179], v28 offset:32
M a[16:19], a[128:131], a[160:163], a[16:19]
 buffer_load_dwordx4 v13, s[48:51], s22 offen offset:1024   lds
M a[16:19], a[132:135], a[164:167], a[16:19]
 ds_read_b64_tr_b16 a[180:181], v28 offset:64
 ds_read_b64_tr_b16 a[182:183], v28 offset:96
M a[20:23], a[140:143], a[164:167], a[20:23]
 ds_read_b64_tr_b16 a[184:185], v28 offset:128
 ds_read_b64_tr_b16 a[186:187], v28 offset:160
M a[20:23], a[136:139], a[160:163], a[20:23]
 ds_read_b64_tr_b16 a[40:41], v2 offset:0
 ds_read_b64_tr_b16 a[42:43], v2 offset:1024
M a[24:27], a[144:147], a[160:163], a[24:27]
 ds_read_b64_tr_b16 a[188:189], v28 offset:192
M a[24:27], a[148:151], a[164:167], a[24:27]
 s_waitcnt lgkmcnt(13)
 buffer_load_dwordx4 v14, s[48:51], s22 offen offset:2048   lds
M a[28:31], a[156:159], a[164:167], a[28:31]
M a[28:31], a[152:155], a[160:163], a[28:31]
M v[32:35], a[96:99], a[168:171], v[32:35]
 ds_read_b128 a[160:163], v5 offset:36864
 ds_read_b128 a[164:167], v6 offset:36864
M v[32:35], a[100:103], a[172:175], v[32:35]
 ds_read_b64_tr_b16 a[44:45], v2 offset:8192
 ds_read_b64_tr_b16 a[46:47], v2 offset:9216
M v[36:39], a[108:111], a[172:175], v[36:39]
 buffer_load_dwordx4 v15, s[48:51], s22 offen offset:3072   lds
M v[36:39], a[104:107], a[168:171], v[36:39]
 s_sub_u32 s22, s22, 2097024
M v[40:43], a[112:115], a[168:171], v[40:43]
M v[40:43], a[116:119], a[172:175], v[40:43]
 ds_read_b64_tr_b16 a[48:49], v3 offset:0
 ds_read_b64_tr_b16 a[50:51], v3 offset:1024
M v[44:47], a[124:127], a[172:175], v[44:47]
 s_add_u32 m0, s23, 49152
M v[44:47], a[120:123], a[168:171], v[44:47]
 buffer_load_dwordx4 v8, s[16:19], s21 offen offset:0  nt lds
M v[48:51], a[128:131], a[168:171], v[48:51]
M v[48:51], a[132:135], a[172:175], v[48:51]
M v[52:55], a[140:143], a[172:175], v[52:55]
 ds_read_b64_tr_b16 a[52:53], v3 offset:8192
 ds_read_b64_tr_b16 a[54:55], v3 offset:9216
M v[52:55], a[136:139], a[168:171], v[52:55]
M v[56:59], a[144:147], a[168:171], v[56:59]
 buffer_load_dwordx4 v9, s[16:19], s21 offen offset:1024  nt lds
M v[56:59], a[148:151], a[172:175], v[56:59]
 s_waitcnt lgkmcnt(6)
M v[60:63], a[156:159], a[172:175], v[60:63]
M v[60:63], a[152:155], a[168:171], v[60:63]
 ds_read_b64_tr_b16 a[56:57], v4 offset:0
 ds_read_b64_tr_b16 a[58:59], v4 offset:1024
M v[64:67], a[96:99], a[160:163], v[64:67]
 ds_read_b128 a[168:171], v5 offset:38912
 ds_read_b128 a[172:175], v6 offset:38912
M v[64:67], a[100:103], a[164:167], v[64:67]
 buffer_load_dwordx4 v10, s[16:19], s21 offen offset:2048  nt lds
M v[68:71], a[108:111], a[164:167], v[68:71]
M v[68:71], a[104:107], a[160:163], v[68:71]
M v[72:75], a[112:115], a[160:163], v[72:75]
 ds_read_b64_tr_b16 a[60:61], v4 offset:8192
 ds_read_b64_tr_b16 a[62:63], v4 offset:9216
M v[72:75], a[116:119], a[164:167], v[72:75]
M v[76:79], a[124:127], a[164:167], v[76:79]
 buffer_load_dwordx4 v11, s[16:19], s21 offen offset:3072  nt lds
M v[76:79], a[120:123], a[160:163], v[76:79]
 s_add_u32 s21, s21, 524160
M v[80:83], a[128:131], a[160:163], v[80:83]
M v[80:83], a[132:135], a[164:167], v[80:83]
M v[84:87], a[140:143], a[164:167], v[84:87]
M v[84:87], a[136:139], a[160:163], v[84:87]
M v[88:91], a[144:147], a[160:163], v[88:91]
M v[88:91], a[148:151], a[164:167], v[88:91]
 s_waitcnt lgkmcnt(2)
M v[92:95], a[156:159], a[164:167], v[92:95]
 s_waitcnt vmcnt(16) lgkmcnt(0)
M v[92:95], a[152:155], a[160:163], v[92:95]
 s_barrier
 v_mfma_f32_16x16x16_bf16 a[208:211], a[176:177], v[16:17], 0
 v_mfma_f32_16x16x16_bf16 a[212:215], a[178:179], v[16:17], 0
 v_mfma_f32_16x16x16_bf16 a[216:219], a[180:181], v[16:17], 0
 v_mfma_f32_16x16x16_bf16 a[220:223], a[182:183], v[16:17], 0
 v_mfma_f32_16x16x16_bf16 a[224:227], a[184:185], v[16:17], 0
 v_mfma_f32_16x16x16_bf16 a[228:231], a[186:187], v[16:17], 0
 v_mfma_f32_16x16x16_bf16 a[232:235], a[188:189], v[16:17], 0
M v[96:99], a[96:99], a[168:171], v[96:99]
 ds_read_b128 a[160:163], v5 offset:49152
 ds_read_b128 a[164:167], v6 offset:49152
M v[96:99], a[100:103], a[172:175], v[96:99]
M v[100:103], a[108:111], a[172:175], v[100:103]
 s_add_u32 m0, s24, 32768
 ds_read_b64_tr_b16 a[64:65], v1 offset:16384
 ds_read_b64_tr_b16 a[66:67], v1 offset:17408
M v[100:103], a[104:107], a[168:171], v[100:103]
 buffer_load_dwordx4 v12, s[48:51], s22 offen offset:0   lds
M v[104:107], a[112:115], a[168:171], v[104:107]
M v[104:107], a[116:119], a[172:175], v[104:107]
M v[108:111], a[124:127], a[172:175], v[108:111]
M v[108:111], a[120:123], a[168:171], v[108:111]
M v[112:115], a[128:131], a[168:171], v[112:115]
M v[112:115], a[132:135], a[172:175], v[112:115]
 ds_read_b64_tr_b16 a[68:69], v1 offset:24576
 ds_read_b64_tr_b16 a[70:71], v1 offset:25600
M v[116:119], a[140:143], a[172:175], v[116:119]
 buffer_load_dwordx4 v13, s[48:51], s22 offen offset:1024   lds
M v[116:119], a[136:139], a[168:171], v[116:119]
M v[120:123], a[144:147], a[168:171], v[120:123]
M v[120:123], a[148:151], a[172:175], v[120:123]
 s_waitcnt lgkmcnt(4)
M v[124:127], a[156:159], a[172:175], v[124:127]
M v[124:127], a[152:155], a[168:171], v[124:127]
M v[128:131], a[96:99], a[160:163], v[128:131]
 ds_read_b128 a[168:171], v5 offset:51200
 ds_read_b128 a[172:175], v6 offset:51200
M v[128:131], a[100:103], a[164:167], v[128:131]
 ds_read_b64_tr_b16 a[72:73], v2 offset:16384
 ds_read_b64_tr_b16 a[74:75], v2 offset:17408
M v[132:135], a[108:111], a[164:167], v[132:135]
 buffer_load_dwordx4 v14, s[48:51], s22 offen offset:2048   lds
M v[132:135], a[104:107], a[160:163], v[132:135]
M v[136:139], a[112:115], a[160:163], v[136:139]
M v[136:139], a[116:119], a[164:167], v[136:139]
M v[140:143], a[124:127], a[164:167], v[140:143]
M v[140:143], a[120:123], a[160:163], v[140:143]
 ds_read_b64_tr_b16 a[76:77], v2 offset:24576
 ds_read_b64_tr_b16 a[78:79], v2 offset:25600
M v[144:147], a[128:131], a[160:163], v[144:147]
 buffer_load_dwordx4 v15, s[48:51], s22 offen offset:3072   lds
M v[144:147], a[132:135], a[164:167], v[144:147]
 s_add_u32 s22, s22, 2097152
M v[148:151], a[140:143], a[164:167], v[148:151]
M v[148:151], a[136:139], a[160:163], v[148:151]
M v[152:155], a[144:147], a[160:163], v[152:155]
M v[152:155], a[148:151], a[164:167], v[152:155]
 s_waitcnt lgkmcnt(4)
M v[156:159], a[156:159], a[164:167], v[156:159]
 s_add_u32 m0, s23, 0
 ds_read_b64_tr_b16 a[80:81], v3 offset:16384
 ds_read_b64_tr_b16 a[82:83], v3 offset:17408
M v[156:159], a[152:155], a[160:163], v[156:159]
 buffer_load_dwordx4 v8, s[52:55], s28 offen offset:0   lds
M v[160:163], a[96:99], a[168:171], v[160:163]
 ds_read_b128 a[160:163], v5 offset:53248
 ds_read_b128 a[164:167], v6 offset:53248
M v[160:163], a[100:103], a[172:175], v[160:163]
M v[164:167], a[108:111], a[172:175], v[164:167]
M v[164:167], a[104:107], a[168:171], v[164:167]
M v[168:171], a[112:115], a[168:171], v[168:171]
M v[168:171], a[116:119], a[172:175], v[168:171]
 ds_read_b64_tr_b16 a[84:85], v3 offset:24576
 ds_read_b64_tr_b16 a[86:87], v3 offset:25600
M v[172:175], a[124:127], a[172:175], v[172:175]
 buffer_load_dwordx4 v9, s[52:55], s28 offen offset:1024   lds
M v[172:175], a[120:123], a[168:171], v[172:175]
M v[176:179], a[128:131], a[168:171], v[176:179]
M v[176:179], a[132:135], a[172:175], v[176:179]
M v[180:183], a[140:143], a[172:175], v[180:183]
M v[180:183], a[136:139], a[168:171], v[180:183]
M v[184:187], a[144:147], a[168:171], v[184:187]
 ds_read_b64_tr_b16 a[88:89], v4 offset:16384
 ds_read_b64_tr_b16 a[90:91], v4 offset:17408
M v[184:187], a[148:151], a[172:175], v[184:187]
 s_waitcnt lgkmcnt(4)
 buffer_load_dwordx4 v10, s[52:55], s28 offen offset:2048   lds
M v[188:191], a[156:159], a[172:175], v[188:191]
M v[188:191], a[152:155], a[168:171], v[188:191]
M v[192:195], a[96:99], a[160:163], v[192:195]
 ds_read_b128 a[168:171], v5 offset:55296
 ds_read_b128 a[172:175], v6 offset:55296
M v[192:195], a[100:103], a[164:167], v[192:195]
M v[196:199], a[108:111], a[164:167], v[196:199]
M v[196:199], a[104:107], a[160:163], v[196:199]
 ds_read_b64_tr_b16 a[92:93], v4 offset:24576
 ds_read_b64_tr_b16 a[94:95], v4 offset:25600
M v[200:203], a[112:115], a[160:163], v[200:203]
 buffer_load_dwordx4 v11, s[52:55], s28 offen offset:3072   lds
M v[200:203], a[116:119], a[164:167], v[200:203]
 s_add_u32 s28, s28, 128
M v[204:207], a[124:127], a[164:167], v[204:207]
M v[204:207], a[120:123], a[160:163], v[204:207]
M v[208:211], a[128:131], a[160:163], v[208:211]
M v[208:211], a[132:135], a[164:167], v[208:211]
M v[212:215], a[140:143], a[164:167], v[212:215]
M v[212:215], a[136:139], a[160:163], v[212:215]
M v[216:219], a[144:147], a[160:163], v[216:219]
M v[216:219], a[148:151], a[164:167], v[216:219]
 s_waitcnt lgkmcnt(2)
M v[220:223], a[156:159], a[164:167], v[220:223]
 s_waitcnt vmcnt(16) lgkmcnt(0)
M v[220:223], a[152:155], a[160:163], v[220:223]
 s_barrier
M v[224:227], a[96:99], a[168:171], v[224:227]
 ds_read_b128 a[160:163], v5 offset:0
 ds_read_b128 a[164:167], v6 offset:0
M v[224:227], a[100:103], a[172:175], v[224:227]
 v_lshl_add_u32 v27, v0, 7, s95
 v_and_b32 v26, 48, v0
M v[228:231], a[108:111], a[172:175], v[228:231]
 v_lshl_add_u32 v26, v26, 24, v27
M v[228:231], a[104:107], a[168:171], v[228:231]
 buffer_load_dword a240, v26, s[76:79], 0 offen offset:0
M v[232:235], a[112:115], a[168:171], v[232:235]
M v[232:235], a[116:119], a[172:175], v[232:235]
M v[236:239], a[124:127], a[172:175], v[236:239]
M v[236:239], a[120:123], a[168:171], v[236:239]
M v[240:243], a[128:131], a[168:171], v[240:243]
M v[240:243], a[132:135], a[172:175], v[240:243]
M v[244:247], a[140:143], a[172:175], v[244:247]
M v[244:247], a[136:139], a[168:171], v[244:247]
M v[248:251], a[144:147], a[168:171], v[248:251]
M v[248:251], a[148:151], a[172:175], v[248:251]
 s_waitcnt lgkmcnt(0)
M v[252:255], a[156:159], a[172:175], v[252:255]
M v[252:255], a[152:155], a[168:171], v[252:255]
M a[0:3], a[32:35], a[160:163], a[0:3]
 ds_read_b128 a[168:171], v5 offset:2048
 ds_read_b128 a[172:175], v6 offset:2048
M a[0:3], a[36:39], a[164:167], a[0:3]
 ds_read_b64_tr_b16 a[96:97], v1 offset:32768
 ds_read_b64_tr_b16 a[98:99], v1 offset:33792
M a[4:7], a[44:47], a[164:167], a[4:7]
 s_add_u32 m0, s24, 49152
 v_lshrrev_b32 v28, 4, v0
 v_add_u32 v28, 0, v28
M a[4:7], a[40:43], a[160:163], a[4:7]
 buffer_load_dwordx4 v12, s[48:51], s22 offen offset:0   lds
M a[8:11], a[48:51], a[160:163], a[8:11]
 v_and_b32 v29, 7, v0
 v_xor_b32 v28, v28, v29
M a[8:11], a[52:55], a[164:167], a[8:11]
 v_lshlrev_b32 v28, 4, v28
 v_lshrrev_b32 v29, 3, v0
M a[12:15], a[60:63], a[164:167], a[12:15]
 ds_read_b64_tr_b16 a[100:101], v1 offset:40960
 ds_read_b64_tr_b16 a[102:103], v1 offset:41984
M a[12:15], a[56:59], a[160:163], a[12:15]
 buffer_load_dwordx4 v13, s[48:51], s22 offen offset:1024   lds
M a[16:19], a[64:67], a[160:163], a[16:19]
 v_mul_u32_u24 v29, 896, v29
M a[16:19], a[68:71], a[164:167], a[16:19]
 s_mul_i32 s64, s20, 28672
 buffer_load_dwordx4 v14, s[48:51], s22 offen offset:2048   lds
M a[20:23], a[76:79], a[164:167], a[20:23]
 s_add_u32 s64, s64, 0
 v_add3_u32 v16, v29, v28, s64
 v_add_u32 v18, 12288, v16
M a[20:23], a[72:75], a[160:163], a[20:23]
 ds_read_b64_tr_b16 a[104:105], v2 offset:32768
 ds_read_b64_tr_b16 a[106:107], v2 offset:33792
M a[24:27], a[80:83], a[160:163], a[24:27]
 v_lshrrev_b32 v28, 4, v0
 v_add_u32 v28, 4, v28
M a[24:27], a[84:87], a[164:167], a[24:27]
 s_waitcnt lgkmcnt(6)
 buffer_load_dwordx4 v15, s[48:51], s22 offen offset:3072   lds
M a[28:31], a[92:95], a[164:167], a[28:31]
 s_sub_u32 s22, s22, 2097024
 v_and_b32 v29, 7, v0
 v_xor_b32 v28, v28, v29
M a[28:31], a[88:91], a[160:163], a[28:31]
 s_add_u32 m0, s23, 16384
 v_lshlrev_b32 v28, 4, v28
 v_lshrrev_b32 v29, 3, v0
M v[32:35], a[32:35], a[168:171], v[32:35]
 ds_read_b128 a[160:163], v5 offset:4096
 ds_read_b128 a[164:167], v6 offset:4096
M v[32:35], a[36:39], a[172:175], v[32:35]
 ds_read_b64_tr_b16 a[108:109], v2 offset:40960
 ds_read_b64_tr_b16 a[110:111], v2 offset:41984
M v[36:39], a[44:47], a[172:175], v[36:39]
 buffer_load_dwordx4 v8, s[52:55], s28 offen offset:0   lds
M v[36:39], a[40:43], a[168:171], v[36:39]
 v_mul_u32_u24 v29, 896, v29
M v[40:43], a[48:51], a[168:171], v[40:43]
 s_mul_i32 s64, s20, 28672
 buffer_load_dwordx4 v9, s[52:55], s28 offen offset:1024   lds
M v[40:43], a[52:55], a[172:175], v[40:43]
 s_add_u32 s64, s64, 6144
 ds_read_b64_tr_b16 a[112:113], v3 offset:32768
 ds_read_b64_tr_b16 a[114:115], v3 offset:33792
M v[44:47], a[60:63], a[172:175], v[44:47]
 v_add3_u32 v17, v29, v28, s64
 v_add_u32 v19, 12288, v17
M v[44:47], a[56:59], a[168:171], v[44:47]
 buffer_load_dwordx4 v10, s[52:55], s28 offen offset:2048   lds
M v[48:51], a[64:67], a[168:171], v[48:51]
 v_add_u32 v20, 0x20000, v1
 v_add_u32 v21, 0x20000, v2
M v[48:51], a[68:71], a[172:175], v[48:51]
 v_add_u32 v22, 0x20000, v3
 v_add_u32 v23, 0x20000, v4
M v[52:55], a[76:79], a[172:175], v[52:55]
 ds_read_b64_tr_b16 a[116:117], v3 offset:40960
 ds_read_b64_tr_b16 a[118:119], v3 offset:41984
M v[52:55], a[72:75], a[168:171], v[52:55]
 buffer_load_dwordx4 v11, s[52:55], s28 offen offset:3072   lds
M v[56:59], a[80:83], a[168:171], v[56:59]
 s_add_u32 s28, s28, 1048448
M v[56:59], a[84:87], a[172:175], v[56:59]
 s_waitcnt lgkmcnt(6)
M v[60:63], a[92:95], a[172:175], v[60:63]
 s_add_u32 m0, s23, 131072
M v[60:63], a[88:91], a[168:171], v[60:63]
 ds_read_b64_tr_b16 a[120:121], v4 offset:32768
 ds_read_b64_tr_b16 a[122:123], v4 offset:33792
M v[64:67], a[32:35], a[160:163], v[64:67]
 ds_read_b128 a[168:171], v5 offset:6144
 ds_read_b128 a[172:175], v6 offset:6144
M v[64:67], a[36:39], a[164:167], v[64:67]
 buffer_load_dwordx4 v8, s[52:55], s28 offen offset:0   lds
M v[68:71], a[44:47], a[164:167], v[68:71]
 buffer_load_dwordx4 v9, s[52:55], s28 offen offset:1024   lds
M v[68:71], a[40:43], a[160:163], v[68:71]
M v[72:75], a[48:51], a[160:163], v[72:75]
 ds_read_b64_tr_b16 a[124:125], v4 offset:40960
 ds_read_b64_tr_b16 a[126:127], v4 offset:41984
M v[72:75], a[52:55], a[164:167], v[72:75]
 buffer_load_dwordx4 v10, s[52:55], s28 offen offset:2048   lds
M v[76:79], a[60:63], a[164:167], v[76:79]
M v[76:79], a[56:59], a[160:163], v[76:79]
M v[80:83], a[64:67], a[160:163], v[80:83]
 buffer_load_dwordx4 v11, s[52:55], s28 offen offset:3072   lds
M v[80:83], a[68:71], a[164:167], v[80:83]
 s_sub_u32 s28, s28, 524288
M v[84:87], a[76:79], a[164:167], v[84:87]
M v[84:87], a[72:75], a[160:163], v[84:87]
M v[88:91], a[80:83], a[160:163], v[88:91]
M v[88:91], a[84:87], a[164:167], v[88:91]
 s_waitcnt lgkmcnt(2)
M v[92:95], a[92:95], a[164:167], v[92:95]
 s_waitcnt vmcnt(21) lgkmcnt(0)
M v[92:95], a[88:91], a[160:163], v[92:95]
 s_barrier
M v[96:99], a[32:35], a[168:171], v[96:99]
 ds_read_b128 a[160:163], v5 offset:16384
 ds_read_b128 a[164:167], v6 offset:16384
M v[96:99], a[36:39], a[172:175], v[96:99]
M v[100:103], a[44:47], a[172:175], v[100:103]
 s_add_u32 m0, s24, 0
 ds_read_b64_tr_b16 a[128:129], v1 offset:49152
 ds_read_b64_tr_b16 a[130:131], v1 offset:50176
M v[100:103], a[40:43], a[168:171], v[100:103]
 buffer_load_dwordx4 v16, s[56:59], s29 offen offset:0   lds
M v[104:107], a[48:51], a[168:171], v[104:107]
M v[104:107], a[52:55], a[172:175], v[104:107]
M v[108:111], a[60:63], a[172:175], v[108:111]
M v[108:111], a[56:59], a[168:171], v[108:111]
 buffer_load_dwordx4 v17, s[56:59], s29 offen offset:1024   lds
M v[112:115], a[64:67], a[168:171], v[112:115]
M v[112:115], a[68:71], a[172:175], v[112:115]
 ds_read_b64_tr_b16 a[132:133], v1 offset:57344
 ds_read_b64_tr_b16 a[134:135], v1 offset:58368
M v[116:119], a[76:79], a[172:175], v[116:119]
M v[116:119], a[72:75], a[168:171], v[116:119]
M v[120:123], a[80:83], a[168:171], v[120:123]
 buffer_load_dwordx4 v18, s[56:59], s29 offen offset:2048   lds
M v[120:123], a[84:87], a[172:175], v[120:123]
 s_waitcnt lgkmcnt(4)
M v[124:127], a[92:95], a[172:175], v[124:127]
M v[124:127], a[88:91], a[168:171], v[124:127]
M v[128:131], a[32:35], a[160:163], v[128:131]
 ds_read_b128 a[168:171], v5 offset:18432
 ds_read_b128 a[172:175], v6 offset:18432
M v[128:131], a[36:39], a[164:167], v[128:131]
 ds_read_b64_tr_b16 a[136:137], v2 offset:49152
 ds_read_b64_tr_b16 a[138:139], v2 offset:50176
M v[132:135], a[44:47], a[164:167], v[132:135]
 buffer_load_dwordx4 v19, s[56:59], s29 offen offset:3072   lds
M v[132:135], a[40:43], a[160:163], v[132:135]
 s_add_u32 s29, s29, 128
M v[136:139], a[48:51], a[160:163], v[136:139]
M v[136:139], a[52:55], a[164:167], v[136:139]
 s_add_u32 m0, s23, 32768
M v[140:143], a[60:63], a[164:167], v[140:143]
 buffer_load_dwordx4 v8, s[52:55], s28 offen offset:0   lds
M v[140:143], a[56:59], a[160:163], v[140:143]
 ds_read_b64_tr_b16 a[140:141], v2 offset:57344
 ds_read_b64_tr_b16 a[142:143], v2 offset:58368
M v[144:147], a[64:67], a[160:163], v[144:147]
M v[144:147], a[68:71], a[164:167], v[144:147]
M v[148:151], a[76:79], a[164:167], v[148:151]
 buffer_load_dwordx4 v9, s[52:55], s28 offen offset:1024   lds
M v[148:151], a[72:75], a[160:163], v[148:151]
M v[152:155], a[80:83], a[160:163], v[152:155]
M v[152:155], a[84:87], a[164:167], v[152:155]
 s_waitcnt lgkmcnt(4)
M v[156:159], a[92:95], a[164:167], v[156:159]
 ds_read_b64_tr_b16 a[144:145], v3 offset:49152
 ds_read_b64_tr_b16 a[146:147], v3 offset:50176
M v[156:159], a[88:91], a[160:163], v[156:159]
 buffer_load_dwordx4 v10, s[52:55], s28 offen offset:2048   lds
M v[160:163], a[32:35], a[168:171], v[160:163]
 ds_read_b128 a[160:163], v5 offset:20480
 ds_read_b128 a[164:167], v6 offset:20480
M v[160:163], a[36:39], a[172:175], v[160:163]
M v[164:167], a[44:47], a[172:175], v[164:167]
M v[164:167], a[40:43], a[168:171], v[164:167]
M v[168:171], a[48:51], a[168:171], v[168:171]
 buffer_load_dwordx4 v11, s[52:55], s28 offen offset:3072   lds
M v[168:171], a[52:55], a[172:175], v[168:171]
 s_add_u32 s28, s28, 524416
 ds_read_b64_tr_b16 a[148:149], v3 offset:57344
 ds_read_b64_tr_b16 a[150:151], v3 offset:58368
M v[172:175], a[60:63], a[172:175], v[172:175]
M v[172:175], a[56:59], a[168:171], v[172:175]
M v[176:179], a[64:67], a[168:171], v[176:179]
 s_add_u32 m0, s23, 147456
M v[176:179], a[68:71], a[172:175], v[176:179]
 buffer_load_dwordx4 v8, s[52:55], s28 offen offset:0   lds
M v[180:183], a[76:79], a[172:175], v[180:183]
M v[180:183], a[72:75], a[168:171], v[180:183]
M v[184:187], a[80:83], a[168:171], v[184:187]
 ds_read_b64_tr_b16 a[152:153], v4 offset:49152
 ds_read_b64_tr_b16 a[154:155], v4 offset:50176
M v[184:187], a[84:87], a[172:175], v[184:187]
 s_waitcnt lgkmcnt(4)
 buffer_load_dwordx4 v9, s[52:55], s28 offen offset:1024   lds
M v[188:191], a[92:95], a[172:175], v[188:191]
M v[188:191], a[88:91], a[168:171], v[188:191]
M v[192:195], a[32:35], a[160:163], v[192:195]
 ds_read_b128 a[168:171], v5 offset:22528
 ds_read_b128 a[172:175], v6 offset:22528
M v[192:195], a[36:39], a[164:167], v[192:195]
M v[196:199], a[44:47], a[164:167], v[196:199]
 buffer_load_dwordx4 v10, s[52:55], s28 offen offset:2048   lds
M v[196:199], a[40:43], a[160:163], v[196:199]
 ds_read_b64_tr_b16 a[156:157], v4 offset:57344
 ds_read_b64_tr_b16 a[158:159], v4 offset:58368
M v[200:203], a[48:51], a[160:163], v[200:203]
M v[200:203], a[52:55], a[164:167], v[200:203]
M v[204:207], a[60:63], a[164:167], v[204:207]
M v[204:207], a[56:59], a[160:163], v[204:207]
 buffer_load_dwordx4 v11, s[52:55], s28 offen offset:3072   lds
M v[208:211], a[64:67], a[160:163], v[208:211]
 s_sub_u32 s28, s28, 524288
M v[208:211], a[68:71], a[164:167], v[208:211]
M v[212:215], a[76:79], a[164:167], v[212:215]
M v[212:215], a[72:75], a[160:163], v[212:215]
M v[216:219], a[80:83], a[160:163], v[216:219]
M v[216:219], a[84:87], a[164:167], v[216:219]
 s_waitcnt lgkmcnt(2)
M v[220:223], a[92:95], a[164:167], v[220:223]
 s_waitcnt vmcnt(25) lgkmcnt(0)
M v[220:223], a[88:91], a[160:163], v[220:223]
 s_barrier
M v[224:227], a[32:35], a[168:171], v[224:227]
 ds_read_b128 a[160:163], v5 offset:32768
 ds_read_b128 a[164:167], v6 offset:32768
M v[224:227], a[36:39], a[172:175], v[224:227]
M v[228:231], a[44:47], a[172:175], v[228:231]
M v[228:231], a[40:43], a[168:171], v[228:231]
M v[232:235], a[48:51], a[168:171], v[232:235]
M v[232:235], a[52:55], a[172:175], v[232:235]
M v[236:239], a[60:63], a[172:175], v[236:239]
M v[236:239], a[56:59], a[168:171], v[236:239]
M v[240:243], a[64:67], a[168:171], v[240:243]
M v[240:243], a[68:71], a[172:175], v[240:243]
M v[244:247], a[76:79], a[172:175], v[244:247]
M v[244:247], a[72:75], a[168:171], v[244:247]
M v[248:251], a[80:83], a[168:171], v[248:251]
M v[248:251], a[84:87], a[172:175], v[248:251]
 s_waitcnt lgkmcnt(0)
M v[252:255], a[92:95], a[172:175], v[252:255]
M v[252:255], a[88:91], a[168:171], v[252:255]
M a[0:3], a[96:99], a[160:163], a[0:3]
 ds_read_b128 a[168:171], v5 offset:34816
 ds_read_b128 a[172:175], v6 offset:34816
M a[0:3], a[100:103], a[164:167], a[0:3]
 ds_read_b64_tr_b16 a[32:33], v1 offset:0
 ds_read_b64_tr_b16 a[34:35], v1 offset:1024
M a[4:7], a[108:111], a[164:167], a[4:7]
 s_add_u32 m0, s24, 16384
M a[4:7], a[104:107], a[160:163], a[4:7]
 buffer_load_dwordx4 v16, s[56:59], s29 offen offset:0   lds
M a[8:11], a[112:115], a[160:163], a[8:11]
M a[8:11], a[116:119], a[164:167], a[8:11]
M a[12:15], a[124:127], a[164:167], a[12:15]
 ds_read_b64_tr_b16 a[36:37], v1 offset:8192
 ds_read_b64_tr_b16 a[38:39], v1 offset:9216
M a[12:15], a[120:123], a[160:163], a[12:15]
M a[16:19], a[128:131], a[160:163], a[16:19]
 buffer_load_dwordx4 v17, s[56:59], s29 offen offset:1024   lds
M a[16:19], a[132:135], a[164:167], a[16:19]
 v_accvgpr_read_b32 v24, a0
 v_accvgpr_read_b32 v25, a1
M a[20:23], a[140:143], a[164:167], a[20:23]
 v_accvgpr_read_b32 v26, a2
 v_accvgpr_read_b32 v27, a3
M a[20:23], a[136:139], a[160:163], a[20:23]
 ds_read_b64_tr_b16 a[40:41], v2 offset:0
 ds_read_b64_tr_b16 a[42:43], v2 offset:1024
M a[24:27], a[144:147], a[160:163], a[24:27]
 v_accvgpr_read_b32 v28, a4
 v_accvgpr_read_b32 v29, a5
M a[24:27], a[148:151], a[164:167], a[24:27]
 s_waitcnt lgkmcnt(6)
 buffer_load_dwordx4 v18, s[56:59], s29 offen offset:2048   lds
M a[28:31], a[156:159], a[164:167], a[28:31]
 v_accvgpr_read_b32 v30, a6
 v_accvgpr_read_b32 v31, a7
M a[28:31], a[152:155], a[160:163], a[28:31]
 v_cvt_pk_bf16_f32 v24, v24, v25
 v_cvt_pk_bf16_f32 v25, v26, v27
M v[32:35], a[96:99], a[168:171], v[32:35]
 ds_read_b128 a[160:163], v5 offset:36864
 ds_read_b128 a[164:167], v6 offset:36864
M v[32:35], a[100:103], a[172:175], v[32:35]
 ds_read_b64_tr_b16 a[44:45], v2 offset:8192
 ds_read_b64_tr_b16 a[46:47], v2 offset:9216
M v[36:39], a[108:111], a[172:175], v[36:39]
 buffer_load_dwordx4 v19, s[56:59], s29 offen offset:3072   lds
M v[36:39], a[104:107], a[168:171], v[36:39]
 s_add_u32 s29, s29, 128
 v_cvt_pk_bf16_f32 v26, v28, v29
 v_cvt_pk_bf16_f32 v27, v30, v31
M v[40:43], a[112:115], a[168:171], v[40:43]
 s_add_u32 s3, s93, 0
 buffer_store_dwordx4 v[24:27], v7, s[8:11], s3 offen offset:0 sc1
M v[40:43], a[116:119], a[172:175], v[40:43]
 ds_read_b64_tr_b16 a[48:49], v3 offset:0
 ds_read_b64_tr_b16 a[50:51], v3 offset:1024
M v[44:47], a[124:127], a[172:175], v[44:47]
 s_add_u32 m0, s23, 49152
 v_accvgpr_read_b32 v24, a8
 v_accvgpr_read_b32 v25, a9
M v[44:47], a[120:123], a[168:171], v[44:47]
 buffer_load_dwordx4 v8, s[52:55], s28 offen offset:0   lds
M v[48:51], a[128:131], a[168:171], v[48:51]
 v_accvgpr_read_b32 v26, a10
 v_accvgpr_read_b32 v27, a11
M v[48:51], a[132:135], a[172:175], v[48:51]
 v_accvgpr_read_b32 v28, a12
 v_accvgpr_read_b32 v29, a13
M v[52:55], a[140:143], a[172:175], v[52:55]
 ds_read_b64_tr_b16 a[52:53], v3 offset:8192
 ds_read_b64_tr_b16 a[54:55], v3 offset:9216
M v[52:55], a[136:139], a[168:171], v[52:55]
 v_accvgpr_read_b32 v30, a14
 v_accvgpr_read_b32 v31, a15
M v[56:59], a[144:147], a[168:171], v[56:59]
 buffer_load_dwordx4 v9, s[52:55], s28 offen offset:1024   lds
M v[56:59], a[148:151], a[172:175], v[56:59]
 s_waitcnt lgkmcnt(6)
 v_cvt_pk_bf16_f32 v24, v24, v25
 v_cvt_pk_bf16_f32 v25, v26, v27
M v[60:63], a[156:159], a[172:175], v[60:63]
 v_cvt_pk_bf16_f32 v26, v28, v29
 v_cvt_pk_bf16_f32 v27, v30, v31
M v[60:63], a[152:155], a[168:171], v[60:63]
 ds_read_b64_tr_b16 a[56:57], v4 offset:0
 ds_read_b64_tr_b16 a[58:59], v4 offset:1024
M v[64:67], a[96:99], a[160:163], v[64:67]
 ds_read_b128 a[168:171], v5 offset:38912
 ds_read_b128 a[172:175], v6 offset:38912
M v[64:67], a[100:103], a[164:167], v[64:67]
 buffer_load_dwordx4 v10, s[52:55], s28 offen offset:2048   lds
M v[68:71], a[108:111], a[164:167], v[68:71]
M v[68:71], a[104:107], a[160:163], v[68:71]
 buffer_store_dwordx4 v[24:27], v7, s[8:11], s3 offen offset:1024 sc1
M v[72:75], a[112:115], a[160:163], v[72:75]
 ds_read_b64_tr_b16 a[60:61], v4 offset:8192
 ds_read_b64_tr_b16 a[62:63], v4 offset:9216
M v[72:75], a[116:119], a[164:167], v[72:75]
 v_accvgpr_read_b32 v24, a16
 v_accvgpr_read_b32 v25, a17
M v[76:79], a[124:127], a[164:167], v[76:79]
 buffer_load_dwordx4 v11, s[52:55], s28 offen offset:3072   lds
M v[76:79], a[120:123], a[160:163], v[76:79]
 s_add_u32 s28, s28, 1048448
 v_accvgpr_read_b32 v26, a18
 v_accvgpr_read_b32 v27, a19
M v[80:83], a[128:131], a[160:163], v[80:83]
 v_accvgpr_read_b32 v28, a20
 v_accvgpr_read_b32 v29, a21
M v[80:83], a[132:135], a[164:167], v[80:83]
 v_accvgpr_read_b32 v30, a22
 v_accvgpr_read_b32 v31, a23
M v[84:87], a[140:143], a[164:167], v[84:87]
 v_cvt_pk_bf16_f32 v24, v24, v25
 v_cvt_pk_bf16_f32 v25, v26, v27
M v[84:87], a[136:139], a[160:163], v[84:87]
 v_cvt_pk_bf16_f32 v26, v28, v29
 v_cvt_pk_bf16_f32 v27, v30, v31
M v[88:91], a[144:147], a[160:163], v[88:91]
 buffer_store_dwordx4 v[24:27], v7, s[8:11], s3 offen offset:2048 sc1
M v[88:91], a[148:151], a[164:167], v[88:91]
 s_waitcnt lgkmcnt(2)
 v_cvt_pk_bf16_f32 v64, v64, v65
 v_cvt_pk_bf16_f32 v65, v66, v67
M v[92:95], a[156:159], a[164:167], v[92:95]
 s_waitcnt vmcnt(27) lgkmcnt(0)
 v_cvt_pk_bf16_f32 v66, v68, v69
 v_cvt_pk_bf16_f32 v67, v70, v71
M v[92:95], a[152:155], a[160:163], v[92:95]
 s_barrier
M v[96:99], a[96:99], a[168:171], v[96:99]
 ds_read_b128 a[160:163], v5 offset:49152
 ds_read_b128 a[164:167], v6 offset:49152
M v[96:99], a[100:103], a[172:175], v[96:99]
 v_accvgpr_read_b32 v24, a24
 v_accvgpr_read_b32 v25, a25
M v[100:103], a[108:111], a[172:175], v[100:103]
 s_add_u32 m0, s24, 32768
 ds_read_b64_tr_b16 a[64:65], v1 offset:16384
 ds_read_b64_tr_b16 a[66:67], v1 offset:17408
M v[100:103], a[104:107], a[168:171], v[100:103]
 buffer_load_dwordx4 v16, s[56:59], s29 offen offset:0   lds
M v[104:107], a[112:115], a[168:171], v[104:107]
 v_accvgpr_read_b32 v26, a26
 v_accvgpr_read_b32 v27, a27
M v[104:107], a[116:119], a[172:175], v[104:107]
 v_accvgpr_read_b32 v28, a28
 v_accvgpr_read_b32 v29, a29
M v[108:111], a[124:127], a[172:175], v[108:111]
 v_accvgpr_read_b32 v30, a30
 v_accvgpr_read_b32 v31, a31
M v[108:111], a[120:123], a[168:171], v[108:111]
 v_cvt_pk_bf16_f32 v24, v24, v25
 v_cvt_pk_bf16_f32 v25, v26, v27
M v[112:115], a[128:131], a[168:171], v[112:115]
 v_cvt_pk_bf16_f32 v26, v28, v29
 v_cvt_pk_bf16_f32 v27, v30, v31
M v[112:115], a[132:135], a[172:175], v[112:115]
 ds_read_b64_tr_b16 a[68:69], v1 offset:24576
 ds_read_b64_tr_b16 a[70:71], v1 offset:25600
M v[116:119], a[140:143], a[172:175], v[116:119]
 buffer_load_dwordx4 v17, s[56:59], s29 offen offset:1024   lds
M v[116:119], a[136:139], a[168:171], v[116:119]
 v_cvt_pk_bf16_f32 v72, v72, v73
 v_cvt_pk_bf16_f32 v73, v74, v75
M v[120:123], a[144:147], a[168:171], v[120:123]
 v_cvt_pk_bf16_f32 v74, v76, v77
 v_cvt_pk_bf16_f32 v75, v78, v79
M v[120:123], a[148:151], a[172:175], v[120:123]
 s_waitcnt lgkmcnt(4)
 buffer_store_dwordx4 v[24:27], v7, s[8:11], s3 offen offset:3072 sc1
M v[124:127], a[156:159], a[172:175], v[124:127]
 v_cvt_pk_bf16_f32 v80, v80, v81
 v_cvt_pk_bf16_f32 v81, v82, v83
M v[124:127], a[152:155], a[168:171], v[124:127]
 v_cvt_pk_bf16_f32 v32, v32, v33
 v_cvt_pk_bf16_f32 v33, v34, v35
M v[128:131], a[96:99], a[160:163], v[128:131]
 ds_read_b128 a[168:171], v5 offset:51200
 ds_read_b128 a[172:175], v6 offset:51200
M v[128:131], a[100:103], a[164:167], v[128:131]
 ds_read_b64_tr_b16 a[72:73], v2 offset:16384
 ds_read_b64_tr_b16 a[74:75], v2 offset:17408
M v[132:135], a[108:111], a[164:167], v[132:135]
 buffer_load_dwordx4 v18, s[56:59], s29 offen offset:2048   lds
M v[132:135], a[104:107], a[160:163], v[132:135]
 v_cvt_pk_bf16_f32 v34, v36, v37
 v_cvt_pk_bf16_f32 v35, v38, v39
M v[136:139], a[112:115], a[160:163], v[136:139]
 s_add_u32 s3, s93, 8192
 v_cvt_pk_bf16_f32 v82, v84, v85
 v_cvt_pk_bf16_f32 v83, v86, v87
M v[136:139], a[116:119], a[164:167], v[136:139]
 buffer_store_dwordx4 v[32:35], v7, s[8:11], s3 offen offset:0 sc1
M v[140:143], a[124:127], a[164:167], v[140:143]
 v_cvt_pk_bf16_f32 v88, v88, v89
 v_cvt_pk_bf16_f32 v89, v90, v91
M v[140:143], a[120:123], a[160:163], v[140:143]
 ds_read_b64_tr_b16 a[76:77], v2 offset:24576
 ds_read_b64_tr_b16 a[78:79], v2 offset:25600
M v[144:147], a[128:131], a[160:163], v[144:147]
 buffer_load_dwordx4 v19, s[56:59], s29 offen offset:3072   lds
M v[144:147], a[132:135], a[164:167], v[144:147]
 s_add_u32 s29, s29, 128
 v_cvt_pk_bf16_f32 v90, v92, v93
 v_cvt_pk_bf16_f32 v91, v94, v95
M v[148:151], a[140:143], a[164:167], v[148:151]
 v_cvt_pk_bf16_f32 v96, v96, v97
 v_cvt_pk_bf16_f32 v97, v98, v99
M v[148:151], a[136:139], a[160:163], v[148:151]
 v_cvt_pk_bf16_f32 v98, v100, v101
 v_cvt_pk_bf16_f32 v99, v102, v103
M v[152:155], a[144:147], a[160:163], v[152:155]
 v_cvt_pk_bf16_f32 v40, v40, v41
 v_cvt_pk_bf16_f32 v41, v42, v43
M v[152:155], a[148:151], a[164:167], v[152:155]
 s_waitcnt lgkmcnt(4)
 v_cvt_pk_bf16_f32 v42, v44, v45
 v_cvt_pk_bf16_f32 v43, v46, v47
M v[156:159], a[156:159], a[164:167], v[156:159]
 s_add_u32 m0, s23, 0
 ds_read_b64_tr_b16 a[80:81], v3 offset:16384
 ds_read_b64_tr_b16 a[82:83], v3 offset:17408
M v[156:159], a[152:155], a[160:163], v[156:159]
 buffer_load_dwordx4 v8, s[52:55], s28 offen offset:0   lds
M v[160:163], a[96:99], a[168:171], v[160:163]
 ds_read_b128 a[160:163], v5 offset:53248
 ds_read_b128 a[164:167], v6 offset:53248
M v[160:163], a[100:103], a[172:175], v[160:163]
 v_cvt_pk_bf16_f32 v104, v104, v105
 v_cvt_pk_bf16_f32 v105, v106, v107
M v[164:167], a[108:111], a[172:175], v[164:167]
 buffer_store_dwordx4 v[40:43], v7, s[8:11], s3 offen offset:1024 sc1
M v[164:167], a[104:107], a[168:171], v[164:167]
 v_cvt_pk_bf16_f32 v106, v108, v109
 v_cvt_pk_bf16_f32 v107, v110, v111
M v[168:171], a[112:115], a[168:171], v[168:171]
 v_cvt_pk_bf16_f32 v112, v112, v113
 v_cvt_pk_bf16_f32 v113, v114, v115
M v[168:171], a[116:119], a[172:175], v[168:171]
 ds_read_b64_tr_b16 a[84:85], v3 offset:24576
 ds_read_b64_tr_b16 a[86:87], v3 offset:25600
M v[172:175], a[124:127], a[172:175], v[172:175]
 buffer_load_dwordx4 v9, s[52:55], s28 offen offset:1024   lds
M v[172:175], a[120:123], a[168:171], v[172:175]
 v_cvt_pk_bf16_f32 v114, v116, v117
 v_cvt_pk_bf16_f32 v115, v118, v119
M v[176:179], a[128:131], a[168:171], v[176:179]
 v_cvt_pk_bf16_f32 v120, v120, v121
 v_cvt_pk_bf16_f32 v121, v122, v123
M v[176:179], a[132:135], a[172:175], v[176:179]
 v_cvt_pk_bf16_f32 v122, v124, v125
 v_cvt_pk_bf16_f32 v123, v126, v127
M v[180:183], a[140:143], a[172:175], v[180:183]
 v_cvt_pk_bf16_f32 v48, v48, v49
 v_cvt_pk_bf16_f32 v49, v50, v51
M v[180:183], a[136:139], a[168:171], v[180:183]
 v_cvt_pk_bf16_f32 v50, v52, v53
 v_cvt_pk_bf16_f32 v51, v54, v55
M v[184:187], a[144:147], a[168:171], v[184:187]
 ds_read_b64_tr_b16 a[88:89], v4 offset:16384
 ds_read_b64_tr_b16 a[90:91], v4 offset:17408
M v[184:187], a[148:151], a[172:175], v[184:187]
 s_waitcnt lgkmcnt(4)
 buffer_load_dwordx4 v10, s[52:55], s28 offen offset:2048   lds
M v[188:191], a[156:159], a[172:175], v[188:191]
 v_cvt_pk_bf16_f32 v128, v128, v129
 v_cvt_pk_bf16_f32 v129, v130, v131
M v[188:191], a[152:155], a[168:171], v[188:191]
 buffer_store_dwordx4 v[48:51], v7, s[8:11], s3 offen offset:2048 sc1
M v[192:195], a[96:99], a[160:163], v[192:195]
 ds_read_b128 a[168:171], v5 offset:55296
 ds_read_b128 a[172:175], v6 offset:55296
M v[192:195], a[100:103], a[164:167], v[192:195]
 v_cvt_pk_bf16_f32 v130, v132, v133
 v_cvt_pk_bf16_f32 v131, v134, v135
M v[196:199], a[108:111], a[164:167], v[196:199]
 v_cvt_pk_bf16_f32 v136, v136, v137
 v_cvt_pk_bf16_f32 v137, v138, v139
M v[196:199], a[104:107], a[160:163], v[196:199]
 ds_read_b64_tr_b16 a[92:93], v4 offset:24576
 ds_read_b64_tr_b16 a[94:95], v4 offset:25600
M v[200:203], a[112:115], a[160:163], v[200:203]
 buffer_load_dwordx4 v11, s[52:55], s28 offen offset:3072   lds
M v[200:203], a[116:119], a[164:167], v[200:203]
 s_add_u32 s28, s28, 128
 v_cvt_pk_bf16_f32 v138, v140, v141
 v_cvt_pk_bf16_f32 v139, v142, v143
M v[204:207], a[124:127], a[164:167], v[204:207]
 v_cvt_pk_bf16_f32 v144, v144, v145
 v_cvt_pk_bf16_f32 v145, v146, v147
M v[204:207], a[120:123], a[160:163], v[204:207]
 v_cvt_pk_bf16_f32 v146, v148, v149
 v_cvt_pk_bf16_f32 v147, v150, v151
M v[208:211], a[128:131], a[160:163], v[208:211]
 v_cvt_pk_bf16_f32 v56, v56, v57
 v_cvt_pk_bf16_f32 v57, v58, v59
M v[208:211], a[132:135], a[164:167], v[208:211]
 v_cvt_pk_bf16_f32 v58, v60, v61
 v_cvt_pk_bf16_f32 v59, v62, v63
M v[212:215], a[140:143], a[164:167], v[212:215]
 buffer_store_dwordx4 v[56:59], v7, s[8:11], s3 offen offset:3072 sc1
M v[212:215], a[136:139], a[160:163], v[212:215]
 v_cvt_pk_bf16_f32 v152, v152, v153
 v_cvt_pk_bf16_f32 v153, v154, v155
M v[216:219], a[144:147], a[160:163], v[216:219]
 v_cvt_pk_bf16_f32 v154, v156, v157
 v_cvt_pk_bf16_f32 v155, v158, v159
M v[216:219], a[148:151], a[164:167], v[216:219]
 s_waitcnt lgkmcnt(2)
 v_cvt_pk_bf16_f32 v160, v160, v161
 v_cvt_pk_bf16_f32 v161, v162, v163
M v[220:223], a[156:159], a[164:167], v[220:223]
 s_waitcnt vmcnt(28) lgkmcnt(0)
 v_cvt_pk_bf16_f32 v162, v164, v165
 v_cvt_pk_bf16_f32 v163, v166, v167
M v[220:223], a[152:155], a[160:163], v[220:223]
 s_barrier
M v[224:227], a[96:99], a[168:171], v[224:227]
 ds_read_b128 a[160:163], v5 offset:0
 ds_read_b128 a[164:167], v6 offset:0
M v[224:227], a[100:103], a[172:175], v[224:227]
 v_cvt_pk_bf16_f32 v168, v168, v169
 v_cvt_pk_bf16_f32 v169, v170, v171
M v[228:231], a[108:111], a[172:175], v[228:231]
 v_cvt_pk_bf16_f32 v170, v172, v173
 v_cvt_pk_bf16_f32 v171, v174, v175
M v[228:231], a[104:107], a[168:171], v[228:231]
 v_cvt_pk_bf16_f32 v176, v176, v177
 v_cvt_pk_bf16_f32 v177, v178, v179
M v[232:235], a[112:115], a[168:171], v[232:235]
 v_cvt_pk_bf16_f32 v178, v180, v181
 v_cvt_pk_bf16_f32 v179, v182, v183
M v[232:235], a[116:119], a[172:175], v[232:235]
 v_cvt_pk_bf16_f32 v184, v184, v185
 v_cvt_pk_bf16_f32 v185, v186, v187
M v[236:239], a[124:127], a[172:175], v[236:239]
 v_cvt_pk_bf16_f32 v186, v188, v189
 v_cvt_pk_bf16_f32 v187, v190, v191
M v[236:239], a[120:123], a[168:171], v[236:239]
 v_cvt_pk_bf16_f32 v192, v192, v193
 v_cvt_pk_bf16_f32 v193, v194, v195
M v[240:243], a[128:131], a[168:171], v[240:243]
 v_cvt_pk_bf16_f32 v194, v196, v197
 v_cvt_pk_bf16_f32 v195, v198, v199
M v[240:243], a[132:135], a[172:175], v[240:243]
 v_cvt_pk_bf16_f32 v200, v200, v201
 v_cvt_pk_bf16_f32 v201, v202, v203
M v[244:247], a[140:143], a[172:175], v[244:247]
 v_cvt_pk_bf16_f32 v202, v204, v205
 v_cvt_pk_bf16_f32 v203, v206, v207
M v[244:247], a[136:139], a[168:171], v[244:247]
 v_cvt_pk_bf16_f32 v208, v208, v209
 v_cvt_pk_bf16_f32 v209, v210, v211
M v[248:251], a[144:147], a[168:171], v[248:251]
 v_cvt_pk_bf16_f32 v210, v212, v213
 v_cvt_pk_bf16_f32 v211, v214, v215
M v[248:251], a[148:151], a[172:175], v[248:251]
 s_waitcnt lgkmcnt(0)
 v_cvt_pk_bf16_f32 v216, v216, v217
 v_cvt_pk_bf16_f32 v217, v218, v219
M v[252:255], a[156:159], a[172:175], v[252:255]
 v_cvt_pk_bf16_f32 v218, v220, v221
 v_cvt_pk_bf16_f32 v219, v222, v223
M v[252:255], a[152:155], a[168:171], v[252:255]
 v_cvt_pk_bf16_f32 v224, v224, v225
 v_cvt_pk_bf16_f32 v225, v226, v227
M v[32:35], a[32:35], a[160:163], 0
 s_add_u32 m0, s23, 16384
 ds_read_b128 a[168:171], v5 offset:2048
 ds_read_b128 a[172:175], v6 offset:2048
M v[32:35], a[36:39], a[164:167], v[32:35]
 ds_read_b64_tr_b16 a[96:97], v1 offset:32768
 ds_read_b64_tr_b16 a[98:99], v1 offset:33792
M v[36:39], a[44:47], a[164:167], 0
 s_mul_i32 s72, s41, 4352
 buffer_load_dwordx4 v8, s[52:55], s28 offen offset:0   lds
M v[36:39], a[40:43], a[160:163], v[36:39]
 s_add_u32 s46, s72, 104923136
 v_cvt_pk_bf16_f32 v226, v228, v229
 v_cvt_pk_bf16_f32 v227, v230, v231
M v[40:43], a[48:51], a[160:163], 0
 s_lshl_b32 s45, s42, 7
 ds_read_b64_tr_b16 a[100:101], v1 offset:40960
 ds_read_b64_tr_b16 a[102:103], v1 offset:41984
M v[40:43], a[52:55], a[164:167], v[40:43]
 s_add_u32 s45, s45, s46
 buffer_load_dwordx4 v9, s[52:55], s28 offen offset:1024   lds
M v[44:47], a[60:63], a[164:167], 0
 v_cvt_pk_bf16_f32 v232, v232, v233
 v_cvt_pk_bf16_f32 v233, v234, v235
M v[44:47], a[56:59], a[160:163], v[44:47]
 ds_read_b64_tr_b16 a[104:105], v2 offset:32768
 ds_read_b64_tr_b16 a[106:107], v2 offset:33792
M v[48:51], a[64:67], a[160:163], 0
 v_cvt_pk_bf16_f32 v234, v236, v237
 v_cvt_pk_bf16_f32 v235, v238, v239
M v[48:51], a[68:71], a[164:167], v[48:51]
 v_cvt_pk_bf16_f32 v240, v240, v241
 v_cvt_pk_bf16_f32 v241, v242, v243
M v[52:55], a[76:79], a[164:167], 0
 ds_read_b64_tr_b16 a[108:109], v2 offset:40960
 ds_read_b64_tr_b16 a[110:111], v2 offset:41984
M v[52:55], a[72:75], a[160:163], v[52:55]
 buffer_load_dwordx4 v10, s[52:55], s28 offen offset:2048   lds
M v[56:59], a[80:83], a[160:163], 0
 v_cvt_pk_bf16_f32 v242, v244, v245
 v_cvt_pk_bf16_f32 v243, v246, v247
M v[56:59], a[84:87], a[164:167], v[56:59]
 s_waitcnt lgkmcnt(8)
 ds_read_b64_tr_b16 a[112:113], v3 offset:32768
 ds_read_b64_tr_b16 a[114:115], v3 offset:33792
M v[60:63], a[92:95], a[164:167], 0
 v_cvt_pk_bf16_f32 v248, v248, v249
 v_cvt_pk_bf16_f32 v249, v250, v251
M v[60:63], a[88:91], a[160:163], v[60:63]
 buffer_load_dwordx4 v11, s[52:55], s28 offen offset:3072   lds
M v[68:71], a[32:35], a[168:171], 0
 s_add_u32 s28, s28, 524160
 ds_read_b128 a[160:163], v5 offset:4096
 ds_read_b128 a[164:167], v6 offset:4096
M v[68:71], a[36:39], a[172:175], v[68:71]
 ds_read_b64_tr_b16 a[116:117], v3 offset:40960
 ds_read_b64_tr_b16 a[118:119], v3 offset:41984
M v[76:79], a[44:47], a[172:175], 0
 v_cvt_pk_bf16_f32 v250, v252, v253
 v_cvt_pk_bf16_f32 v251, v254, v255
M v[76:79], a[40:43], a[168:171], v[76:79]
 s_add_u32 m0, s24, 49152
 ds_read_b64_tr_b16 a[120:121], v4 offset:32768
 ds_read_b64_tr_b16 a[122:123], v4 offset:33792
M v[84:87], a[48:51], a[168:171], 0
 buffer_load_dwordx4 v16, s[56:59], s29 offen offset:0   lds
M v[84:87], a[52:55], a[172:175], v[84:87]
 v_mov_b32 v12, 1
 v_or_b32 v15, s20, v0
M v[92:95], a[60:63], a[172:175], 0
 ds_read_b64_tr_b16 a[124:125], v4 offset:40960
 ds_read_b64_tr_b16 a[126:127], v4 offset:41984
M v[92:95], a[56:59], a[168:171], v[92:95]
 v_min_u32 v15, 1, v15
 v_lshlrev_b32 v15, 29, v15
M v[100:103], a[64:67], a[168:171], 0
 s_add_u32 s3, s93, 262144
M v[100:103], a[68:71], a[172:175], v[100:103]
 buffer_load_dwordx4 v17, s[56:59], s29 offen offset:1024   lds
M v[108:111], a[76:79], a[172:175], 0
M v[108:111], a[72:75], a[168:171], v[108:111]
 buffer_store_dwordx4 v[64:67], v7, s[8:11], s3 offen offset:0 sc1
M v[116:119], a[80:83], a[168:171], 0
M v[116:119], a[84:87], a[172:175], v[116:119]
 s_waitcnt lgkmcnt(6)
M v[124:127], a[92:95], a[172:175], 0
 s_waitcnt vmcnt(21) lgkmcnt(0)
 buffer_load_dwordx4 v18, s[56:59], s29 offen offset:2048   lds
M v[124:127], a[88:91], a[168:171], v[124:127]
 s_barrier
M v[132:135], a[32:35], a[160:163], 0
 ds_read_b128 a[168:171], v5 offset:6144
 ds_read_b128 a[172:175], v6 offset:6144
M v[132:135], a[36:39], a[164:167], v[132:135]
 ds_read_b64_tr_b16 a[128:129], v1 offset:49152
 ds_read_b64_tr_b16 a[130:131], v1 offset:50176
M v[140:143], a[44:47], a[164:167], 0
M v[140:143], a[40:43], a[160:163], v[140:143]
 buffer_load_dwordx4 v19, s[56:59], s29 offen offset:3072   lds
M v[148:151], a[48:51], a[160:163], 0
 s_add_u32 s29, s29, 128
 ds_read_b64_tr_b16 a[132:133], v1 offset:57344
 ds_read_b64_tr_b16 a[134:135], v1 offset:58368
M v[148:151], a[52:55], a[164:167], v[148:151]
 buffer_store_dwordx4 v[72:75], v7, s[8:11], s3 offen offset:1024 sc1
M v[156:159], a[60:63], a[164:167], 0
M v[156:159], a[56:59], a[160:163], v[156:159]
 s_add_u32 m0, s23, 32768
 ds_read_b64_tr_b16 a[136:137], v2 offset:49152
 ds_read_b64_tr_b16 a[138:139], v2 offset:50176
M v[164:167], a[64:67], a[160:163], 0
 buffer_load_dwordx4 v8, s[52:55], s28 offen offset:0   lds
M v[164:167], a[68:71], a[164:167], v[164:167]
M v[172:175], a[76:79], a[164:167], 0
 ds_read_b64_tr_b16 a[140:141], v2 offset:57344
 ds_read_b64_tr_b16 a[142:143], v2 offset:58368
M v[172:175], a[72:75], a[160:163], v[172:175]
M v[180:183], a[80:83], a[160:163], 0
M v[180:183], a[84:87], a[164:167], v[180:183]
 s_waitcnt lgkmcnt(8)
 ds_read_b64_tr_b16 a[144:145], v3 offset:49152
 ds_read_b64_tr_b16 a[146:147], v3 offset:50176
M v[188:191], a[92:95], a[164:167], 0
 buffer_load_dwordx4 v9, s[52:55], s28 offen offset:1024   lds
M v[188:191], a[88:91], a[160:163], v[188:191]
M v[196:199], a[32:35], a[168:171], 0
 ds_read_b128 a[160:163], v5 offset:16384
 ds_read_b128 a[164:167], v6 offset:16384
M v[196:199], a[36:39], a[172:175], v[196:199]
 ds_read_b64_tr_b16 a[148:149], v3 offset:57344
 ds_read_b64_tr_b16 a[150:151], v3 offset:58368
M v[204:207], a[44:47], a[172:175], 0
 buffer_load_dwordx4 v10, s[52:55], s28 offen offset:2048   lds
M v[204:207], a[40:43], a[168:171], v[204:207]
 ds_read_b64_tr_b16 a[152:153], v4 offset:49152
 ds_read_b64_tr_b16 a[154:155], v4 offset:50176
M v[212:215], a[48:51], a[168:171], 0
M v[212:215], a[52:55], a[172:175], v[212:215]
M v[220:223], a[60:63], a[172:175], 0
 ds_read_b64_tr_b16 a[156:157], v4 offset:57344
 ds_read_b64_tr_b16 a[158:159], v4 offset:58368
M v[220:223], a[56:59], a[168:171], v[220:223]
 buffer_load_dwordx4 v11, s[52:55], s28 offen offset:3072   lds
M v[228:231], a[64:67], a[168:171], 0
 s_add_u32 s28, s28, 128
M v[228:231], a[68:71], a[172:175], v[228:231]
M v[236:239], a[76:79], a[172:175], 0
M v[236:239], a[72:75], a[168:171], v[236:239]
M v[244:247], a[80:83], a[168:171], 0
M v[244:247], a[84:87], a[172:175], v[244:247]
 s_waitcnt lgkmcnt(6)
M v[252:255], a[92:95], a[172:175], 0
 s_waitcnt vmcnt(14) lgkmcnt(0)
M v[252:255], a[88:91], a[168:171], v[252:255]
 s_barrier
M v[32:35], a[96:99], a[160:163], v[32:35]
 s_add_u32 m0, s23, 49152
 ds_read_b128 a[168:171], v5 offset:18432
 ds_read_b128 a[172:175], v6 offset:18432
M v[32:35], a[100:103], a[164:167], v[32:35]
 ds_read_b64_tr_b16 a[32:33], v20 offset:0
 ds_read_b64_tr_b16 a[34:35], v20 offset:1024
M v[36:39], a[108:111], a[164:167], v[36:39]
 s_mov_b32 s31, 0x4b800000
 buffer_load_dwordx4 v8, s[52:55], s28 offen offset:0   lds
M v[36:39], a[104:107], a[160:163], v[36:39]
 s_sub_u32 s66, 15, s42
 buffer_store_dword v12, v15, s[8:11], s45 offen sc1
M v[40:43], a[112:115], a[160:163], v[40:43]
 s_min_u32 s66, s66, s42
 ds_read_b64_tr_b16 a[36:37], v20 offset:8192
 ds_read_b64_tr_b16 a[38:39], v20 offset:9216
M v[40:43], a[116:119], a[164:167], v[40:43]
 s_lshl_b32 s47, s66, 7
 buffer_load_dwordx4 v9, s[52:55], s28 offen offset:1024   lds
M v[44:47], a[124:127], a[164:167], v[44:47]
 s_add_u32 s47, s47, s46
M v[44:47], a[120:123], a[160:163], v[44:47]
 s_add_u32 s47, s47, 2048
 ds_read_b64_tr_b16 a[40:41], v21 offset:0
 ds_read_b64_tr_b16 a[42:43], v21 offset:1024
M v[48:51], a[128:131], a[160:163], v[48:51]
 s_lshl_b32 s65, s41, 3
 buffer_store_dwordx4 v[80:83], v7, s[8:11], s3 offen offset:2048 sc1
M v[48:51], a[132:135], a[164:167], v[48:51]
 s_add_u32 s65, s65, s66
M v[52:55], a[140:143], a[164:167], v[52:55]
 s_mul_i32 s34, s65, 73728
 ds_read_b64_tr_b16 a[44:45], v21 offset:8192
 ds_read_b64_tr_b16 a[46:47], v21 offset:9216
M v[52:55], a[136:139], a[160:163], v[52:55]
 s_add_u32 s34, s34, 136314880
 buffer_load_dwordx4 v10, s[52:55], s28 offen offset:2048   lds
M v[56:59], a[144:147], a[160:163], v[56:59]
 s_lshl_b32 s65, s42, 4
 s_add_u32 s65, s65, s41
 s_mul_i32 s33, s65, 114688
M v[56:59], a[148:151], a[164:167], v[56:59]
 s_waitcnt lgkmcnt(8)
 ds_read_b64_tr_b16 a[48:49], v22 offset:0
 ds_read_b64_tr_b16 a[50:51], v22 offset:1024
M v[60:63], a[156:159], a[164:167], v[60:63]
 s_mul_i32 s65, s20, 28672
M v[60:63], a[152:155], a[160:163], v[60:63]
 s_add_u32 s33, s33, s65
 buffer_load_dwordx4 v11, s[52:55], s28 offen offset:3072   lds
M v[68:71], a[96:99], a[168:171], v[68:71]
 s_add_u32 s28, s28, 524160
 ds_read_b128 a[160:163], v5 offset:20480
 ds_read_b128 a[164:167], v6 offset:20480
M v[68:71], a[100:103], a[172:175], v[68:71]
 ds_read_b64_tr_b16 a[52:53], v22 offset:8192
 ds_read_b64_tr_b16 a[54:55], v22 offset:9216
M v[76:79], a[108:111], a[172:175], v[76:79]
 s_add_u32 s33, s33, 67108864
 s_lshl_b32 s25, s41, 18
M v[76:79], a[104:107], a[168:171], v[76:79]
 s_add_u32 m0, s24, 0
 ds_read_b64_tr_b16 a[56:57], v23 offset:0
 ds_read_b64_tr_b16 a[58:59], v23 offset:1024
M v[84:87], a[112:115], a[168:171], v[84:87]
 buffer_load_dwordx4 v16, s[56:59], s29 offen offset:0   lds
M v[84:87], a[116:119], a[172:175], v[84:87]
 s_add_u32 s25, s25, 100663296
M v[92:95], a[124:127], a[172:175], v[92:95]
 s_add_u32 s38, s25, 65536
 ds_read_b64_tr_b16 a[60:61], v23 offset:8192
 ds_read_b64_tr_b16 a[62:63], v23 offset:9216
M v[92:95], a[120:123], a[168:171], v[92:95]
 s_mov_b32 s6, 0
M v[100:103], a[128:131], a[168:171], v[100:103]
 s_mov_b32 s7, 0
M v[100:103], a[132:135], a[172:175], v[100:103]
 s_cmp_eq_u32 s20, 0
 buffer_load_dwordx4 v17, s[56:59], s29 offen offset:1024   lds
M v[108:111], a[140:143], a[172:175], v[108:111]
 s_cselect_b32 s39, 0x12, 0
M v[108:111], a[136:139], a[168:171], v[108:111]
 s_cselect_b32 s92, 0, 0
M v[116:119], a[144:147], a[168:171], v[116:119]
 s_mov_b32 s4, 4
 s_mov_b32 s40, 1
M v[116:119], a[148:151], a[172:175], v[116:119]
 s_waitcnt lgkmcnt(6)
M v[124:127], a[156:159], a[172:175], v[124:127]
 s_waitcnt lgkmcnt(0)
 buffer_load_dwordx4 v18, s[56:59], s29 offen offset:2048   lds
M v[124:127], a[152:155], a[168:171], v[124:127]
 s_barrier
M v[132:135], a[96:99], a[160:163], v[132:135]
 ds_read_b128 a[168:171], v5 offset:22528
 ds_read_b128 a[172:175], v6 offset:22528
M v[132:135], a[100:103], a[164:167], v[132:135]
 ds_read_b64_tr_b16 a[64:65], v20 offset:16384
 ds_read_b64_tr_b16 a[66:67], v20 offset:17408
M v[140:143], a[108:111], a[164:167], v[140:143]
M v[140:143], a[104:107], a[160:163], v[140:143]
 buffer_load_dwordx4 v19, s[56:59], s29 offen offset:3072   lds
M v[148:151], a[112:115], a[160:163], v[148:151]
 s_add_u32 s29, s29, 128
 ds_read_b64_tr_b16 a[68:69], v20 offset:24576
 ds_read_b64_tr_b16 a[70:71], v20 offset:25600
M v[148:151], a[116:119], a[164:167], v[148:151]
 buffer_store_dwordx4 v[88:91], v7, s[8:11], s3 offen offset:3072 sc1
M v[156:159], a[124:127], a[164:167], v[156:159]
M v[156:159], a[120:123], a[160:163], v[156:159]
 s_add_u32 m0, s23, 131072
 ds_read_b64_tr_b16 a[72:73], v21 offset:16384
 ds_read_b64_tr_b16 a[74:75], v21 offset:17408
M v[164:167], a[128:131], a[160:163], v[164:167]
 buffer_load_dwordx4 v8, s[52:55], s28 offen offset:0   lds
M v[164:167], a[132:135], a[164:167], v[164:167]
M v[172:175], a[140:143], a[164:167], v[172:175]
 ds_read_b64_tr_b16 a[76:77], v21 offset:24576
 ds_read_b64_tr_b16 a[78:79], v21 offset:25600
M v[172:175], a[136:139], a[160:163], v[172:175]
M v[180:183], a[144:147], a[160:163], v[180:183]
M v[180:183], a[148:151], a[164:167], v[180:183]
 s_waitcnt lgkmcnt(8)
 ds_read_b64_tr_b16 a[80:81], v22 offset:16384
 ds_read_b64_tr_b16 a[82:83], v22 offset:17408
M v[188:191], a[156:159], a[164:167], v[188:191]
 buffer_load_dwordx4 v9, s[52:55], s28 offen offset:1024   lds
M v[188:191], a[152:155], a[160:163], v[188:191]
M v[196:199], a[96:99], a[168:171], v[196:199]
 ds_read_b128 a[160:163], v5 offset:32768
 ds_read_b128 a[164:167], v6 offset:32768
M v[196:199], a[100:103], a[172:175], v[196:199]
 ds_read_b64_tr_b16 a[84:85], v22 offset:24576
 ds_read_b64_tr_b16 a[86:87], v22 offset:25600
M v[204:207], a[108:111], a[172:175], v[204:207]
 buffer_load_dwordx4 v10, s[52:55], s28 offen offset:2048   lds
M v[204:207], a[104:107], a[168:171], v[204:207]
 ds_read_b64_tr_b16 a[88:89], v23 offset:16384
 ds_read_b64_tr_b16 a[90:91], v23 offset:17408
M v[212:215], a[112:115], a[168:171], v[212:215]
M v[212:215], a[116:119], a[172:175], v[212:215]
M v[220:223], a[124:127], a[172:175], v[220:223]
 ds_read_b64_tr_b16 a[92:93], v23 offset:24576
 ds_read_b64_tr_b16 a[94:95], v23 offset:25600
M v[220:223], a[120:123], a[168:171], v[220:223]
 buffer_load_dwordx4 v11, s[52:55], s28 offen offset:3072   lds
M v[228:231], a[128:131], a[168:171], v[228:231]
 s_add_u32 s28, s28, 128
M v[228:231], a[132:135], a[172:175], v[228:231]
M v[236:239], a[140:143], a[172:175], v[236:239]
M v[236:239], a[136:139], a[168:171], v[236:239]
M v[244:247], a[144:147], a[168:171], v[244:247]
M v[244:247], a[148:151], a[172:175], v[244:247]
 s_waitcnt lgkmcnt(6)
M v[252:255], a[156:159], a[172:175], v[252:255]
 s_waitcnt lgkmcnt(0)
M v[252:255], a[152:155], a[168:171], v[252:255]
 s_barrier
M v[32:35], a[32:35], a[160:163], v[32:35]
 s_add_u32 m0, s23, 147456
 ds_read_b128 a[168:171], v5 offset:34816
 ds_read_b128 a[172:175], v6 offset:34816
M v[32:35], a[36:39], a[164:167], v[32:35]
 ds_read_b64_tr_b16 a[96:97], v1 offset:0
 ds_read_b64_tr_b16 a[98:99], v1 offset:1024
M v[36:39], a[44:47], a[164:167], v[36:39]
 buffer_load_dwordx4 v8, s[52:55], s28 offen offset:0   lds
M v[36:39], a[40:43], a[160:163], v[36:39]
 v_and_b32 v29, 15, v0
 v_mul_u32_u24 v30, 1792, v29
M v[40:43], a[48:51], a[160:163], v[40:43]
 s_add_u32 s3, s93, 270336
 ds_read_b64_tr_b16 a[100:101], v1 offset:8192
 ds_read_b64_tr_b16 a[102:103], v1 offset:9216
M v[40:43], a[52:55], a[164:167], v[40:43]
 buffer_load_dwordx4 v9, s[52:55], s28 offen offset:1024   lds
M v[44:47], a[60:63], a[164:167], v[44:47]
 v_lshrrev_b32 v31, 4, v0
 v_lshl_add_u32 v30, v31, 4, v30
M v[44:47], a[56:59], a[160:163], v[44:47]
 ds_read_b64_tr_b16 a[104:105], v2 offset:0
 ds_read_b64_tr_b16 a[106:107], v2 offset:1024
M v[48:51], a[64:67], a[160:163], v[48:51]
 v_lshrrev_b32 v29, 1, v29
 v_min_u32 v29, 1, v29
M v[48:51], a[68:71], a[164:167], v[48:51]
 v_lshl_or_b32 v30, v29, 29, v30
 v_or_b32 v30, s88, v30
M v[52:55], a[76:79], a[164:167], v[52:55]
 s_mul_i32 s89, s86, 3584
 ds_read_b64_tr_b16 a[108:109], v2 offset:8192
 ds_read_b64_tr_b16 a[110:111], v2 offset:9216
M v[52:55], a[72:75], a[160:163], v[52:55]
 s_mul_i32 s64, s20, 448
 buffer_load_dwordx4 v10, s[52:55], s28 offen offset:2048   lds
M v[56:59], a[80:83], a[160:163], v[56:59]
 s_add_u32 s89, s89, s64
 s_add_u32 s89, s89, 105906176
M v[56:59], a[84:87], a[164:167], v[56:59]
 s_waitcnt lgkmcnt(8)
 ds_read_b64_tr_b16 a[112:113], v3 offset:0
 ds_read_b64_tr_b16 a[114:115], v3 offset:1024
M v[60:63], a[92:95], a[164:167], v[60:63]
 buffer_store_dwordx4 v[96:99], v7, s[8:11], s3 offen offset:0 sc1
M v[60:63], a[88:91], a[160:163], v[60:63]
 buffer_load_dwordx4 v11, s[52:55], s28 offen offset:3072   lds
M v[68:71], a[32:35], a[168:171], v[68:71]
 s_add_u32 s28, s28, 524160
 ds_read_b128 a[160:163], v5 offset:36864
 ds_read_b128 a[164:167], v6 offset:36864
M v[68:71], a[36:39], a[172:175], v[68:71]
 ds_read_b64_tr_b16 a[116:117], v3 offset:8192
 ds_read_b64_tr_b16 a[118:119], v3 offset:9216
M v[76:79], a[44:47], a[172:175], v[76:79]
M v[76:79], a[40:43], a[168:171], v[76:79]
 s_add_u32 m0, s24, 16384
 ds_read_b64_tr_b16 a[120:121], v4 offset:0
 ds_read_b64_tr_b16 a[122:123], v4 offset:1024
M v[84:87], a[48:51], a[168:171], v[84:87]
 buffer_load_dwordx4 v16, s[56:59], s29 offen offset:0   lds
M v[84:87], a[52:55], a[172:175], v[84:87]
M v[92:95], a[60:63], a[172:175], v[92:95]
 ds_read_b64_tr_b16 a[124:125], v4 offset:8192
 ds_read_b64_tr_b16 a[126:127], v4 offset:9216
M v[92:95], a[56:59], a[168:171], v[92:95]
M v[100:103], a[64:67], a[168:171], v[100:103]
M v[100:103], a[68:71], a[172:175], v[100:103]
 buffer_load_dwordx4 v17, s[56:59], s29 offen offset:1024   lds
M v[108:111], a[76:79], a[172:175], v[108:111]
M v[108:111], a[72:75], a[168:171], v[108:111]
M v[116:119], a[80:83], a[168:171], v[116:119]
M v[116:119], a[84:87], a[172:175], v[116:119]
 s_waitcnt lgkmcnt(6)
M v[124:127], a[92:95], a[172:175], v[124:127]
 s_waitcnt vmcnt(27) lgkmcnt(0)
 buffer_load_dwordx4 v18, s[56:59], s29 offen offset:2048   lds
M v[124:127], a[88:91], a[168:171], v[124:127]
 s_barrier
M v[132:135], a[32:35], a[160:163], v[132:135]
 ds_read_b128 a[168:171], v5 offset:38912
 ds_read_b128 a[172:175], v6 offset:38912
M v[132:135], a[36:39], a[164:167], v[132:135]
 ds_read_b64_tr_b16 a[128:129], v1 offset:16384
 ds_read_b64_tr_b16 a[130:131], v1 offset:17408
M v[140:143], a[44:47], a[164:167], v[140:143]
M v[140:143], a[40:43], a[160:163], v[140:143]
 buffer_load_dwordx4 v19, s[56:59], s29 offen offset:3072   lds
M v[148:151], a[48:51], a[160:163], v[148:151]
 s_add_u32 s29, s29, 128
 ds_read_b64_tr_b16 a[132:133], v1 offset:24576
 ds_read_b64_tr_b16 a[134:135], v1 offset:25600
M v[148:151], a[52:55], a[164:167], v[148:151]
 buffer_store_dwordx4 v[104:107], v7, s[8:11], s3 offen offset:1024 sc1
M v[156:159], a[60:63], a[164:167], v[156:159]
M v[156:159], a[56:59], a[160:163], v[156:159]
 s_add_u32 m0, s23, 0
 ds_read_b64_tr_b16 a[136:137], v2 offset:16384
 ds_read_b64_tr_b16 a[138:139], v2 offset:17408
M v[164:167], a[64:67], a[160:163], v[164:167]
 buffer_load_dwordx4 v8, s[52:55], s28 offen offset:0   lds
M v[164:167], a[68:71], a[164:167], v[164:167]
M v[172:175], a[76:79], a[164:167], v[172:175]
 ds_read_b64_tr_b16 a[140:141], v2 offset:24576
 ds_read_b64_tr_b16 a[142:143], v2 offset:25600
M v[172:175], a[72:75], a[160:163], v[172:175]
M v[180:183], a[80:83], a[160:163], v[180:183]
M v[180:183], a[84:87], a[164:167], v[180:183]
 s_waitcnt lgkmcnt(8)
 ds_read_b64_tr_b16 a[144:145], v3 offset:16384
 ds_read_b64_tr_b16 a[146:147], v3 offset:17408
M v[188:191], a[92:95], a[164:167], v[188:191]
 buffer_load_dwordx4 v9, s[52:55], s28 offen offset:1024   lds
M v[188:191], a[88:91], a[160:163], v[188:191]
M v[196:199], a[32:35], a[168:171], v[196:199]
 ds_read_b128 a[160:163], v5 offset:49152
 ds_read_b128 a[164:167], v6 offset:49152
M v[196:199], a[36:39], a[172:175], v[196:199]
 ds_read_b64_tr_b16 a[148:149], v3 offset:24576
 ds_read_b64_tr_b16 a[150:151], v3 offset:25600
M v[204:207], a[44:47], a[172:175], v[204:207]
 buffer_load_dwordx4 v10, s[52:55], s28 offen offset:2048   lds
M v[204:207], a[40:43], a[168:171], v[204:207]
 ds_read_b64_tr_b16 a[152:153], v4 offset:16384
 ds_read_b64_tr_b16 a[154:155], v4 offset:17408
M v[212:215], a[48:51], a[168:171], v[212:215]
M v[212:215], a[52:55], a[172:175], v[212:215]
M v[220:223], a[60:63], a[172:175], v[220:223]
 ds_read_b64_tr_b16 a[156:157], v4 offset:24576
 ds_read_b64_tr_b16 a[158:159], v4 offset:25600
M v[220:223], a[56:59], a[168:171], v[220:223]
 buffer_load_dwordx4 v11, s[52:55], s28 offen offset:3072   lds
M v[228:231], a[64:67], a[168:171], v[228:231]
 s_add_u32 s28, s28, 128
M v[228:231], a[68:71], a[172:175], v[228:231]
M v[236:239], a[76:79], a[172:175], v[236:239]
M v[236:239], a[72:75], a[168:171], v[236:239]
M v[244:247], a[80:83], a[168:171], v[244:247]
M v[244:247], a[84:87], a[172:175], v[244:247]
 s_waitcnt lgkmcnt(6)
M v[252:255], a[92:95], a[172:175], v[252:255]
 s_waitcnt vmcnt(29) lgkmcnt(0)
M v[252:255], a[88:91], a[168:171], v[252:255]
 s_barrier
M v[32:35], a[96:99], a[160:163], v[32:35]
 s_add_u32 m0, s23, 16384
 ds_read_b128 a[168:171], v5 offset:51200
 ds_read_b128 a[172:175], v6 offset:51200
M v[32:35], a[100:103], a[164:167], v[32:35]
 ds_read_b64_tr_b16 a[32:33], v1 offset:32768
 ds_read_b64_tr_b16 a[34:35], v1 offset:33792
M v[36:39], a[108:111], a[164:167], v[36:39]
 buffer_load_dwordx4 v8, s[52:55], s28 offen offset:0   lds
M v[36:39], a[104:107], a[160:163], v[36:39]
 v_min_u32 v25, 15, v0
 v_lshlrev_b32 v25, 7, v25
M v[40:43], a[112:115], a[160:163], v[40:43]
 ds_read_b64_tr_b16 a[36:37], v1 offset:40960
 ds_read_b64_tr_b16 a[38:39], v1 offset:41984
M v[40:43], a[116:119], a[164:167], v[40:43]
 buffer_store_dwordx4 v[112:115], v7, s[8:11], s3 offen offset:2048 sc1
M v[44:47], a[124:127], a[164:167], v[44:47]
M v[44:47], a[120:123], a[160:163], v[44:47]
 ds_read_b64_tr_b16 a[40:41], v2 offset:32768
 ds_read_b64_tr_b16 a[42:43], v2 offset:33792
M v[48:51], a[128:131], a[160:163], v[48:51]
 buffer_load_dwordx4 v9, s[52:55], s28 offen offset:1024   lds
M v[48:51], a[132:135], a[164:167], v[48:51]
M v[52:55], a[140:143], a[164:167], v[52:55]
 ds_read_b64_tr_b16 a[44:45], v2 offset:40960
 ds_read_b64_tr_b16 a[46:47], v2 offset:41984
M v[52:55], a[136:139], a[160:163], v[52:55]
M v[56:59], a[144:147], a[160:163], v[56:59]
M v[56:59], a[148:151], a[164:167], v[56:59]
 s_waitcnt lgkmcnt(8)
 ds_read_b64_tr_b16 a[48:49], v3 offset:32768
 ds_read_b64_tr_b16 a[50:51], v3 offset:33792
M v[60:63], a[156:159], a[164:167], v[60:63]
 buffer_load_dwordx4 v10, s[52:55], s28 offen offset:2048   lds
M v[60:63], a[152:155], a[160:163], v[60:63]
M v[68:71], a[96:99], a[168:171], v[68:71]
 ds_read_b128 a[160:163], v5 offset:53248
 ds_read_b128 a[164:167], v6 offset:53248
M v[68:71], a[100:103], a[172:175], v[68:71]
 ds_read_b64_tr_b16 a[52:53], v3 offset:40960
 ds_read_b64_tr_b16 a[54:55], v3 offset:41984
M v[76:79], a[108:111], a[172:175], v[76:79]
 buffer_store_dwordx4 v[120:123], v7, s[8:11], s3 offen offset:3072 sc1
M v[76:79], a[104:107], a[168:171], v[76:79]
 ds_read_b64_tr_b16 a[56:57], v4 offset:32768
 ds_read_b64_tr_b16 a[58:59], v4 offset:33792
M v[84:87], a[112:115], a[168:171], v[84:87]
M v[84:87], a[116:119], a[172:175], v[84:87]
 buffer_load_dwordx4 v11, s[52:55], s28 offen offset:3072   lds
M v[92:95], a[124:127], a[172:175], v[92:95]
 s_add_u32 s28, s28, 524160
 ds_read_b64_tr_b16 a[60:61], v4 offset:40960
 ds_read_b64_tr_b16 a[62:63], v4 offset:41984
M v[92:95], a[120:123], a[168:171], v[92:95]
M v[100:103], a[128:131], a[168:171], v[100:103]
M v[100:103], a[132:135], a[172:175], v[100:103]
M v[108:111], a[140:143], a[172:175], v[108:111]
M v[108:111], a[136:139], a[168:171], v[108:111]
M v[116:119], a[144:147], a[168:171], v[116:119]
M v[116:119], a[148:151], a[172:175], v[116:119]
 s_waitcnt lgkmcnt(6)
M v[124:127], a[156:159], a[172:175], v[124:127]
 s_waitcnt vmcnt(25) lgkmcnt(0)
M v[124:127], a[152:155], a[168:171], v[124:127]
 s_barrier
M v[132:135], a[96:99], a[160:163], v[132:135]
 ds_read_b128 a[168:171], v5 offset:55296
 ds_read_b128 a[172:175], v6 offset:55296
M v[132:135], a[100:103], a[164:167], v[132:135]
 ds_read_b64_tr_b16 a[64:65], v1 offset:49152
 ds_read_b64_tr_b16 a[66:67], v1 offset:50176
M v[140:143], a[108:111], a[164:167], v[140:143]
 buffer_store_dwordx4 a[208:211], v30, s[8:11], s89 offen offset:0 sc1
M v[140:143], a[104:107], a[160:163], v[140:143]
M v[148:151], a[112:115], a[160:163], v[148:151]
 ds_read_b64_tr_b16 a[68:69], v1 offset:57344
 ds_read_b64_tr_b16 a[70:71], v1 offset:58368
M v[148:151], a[116:119], a[164:167], v[148:151]
M v[156:159], a[124:127], a[164:167], v[156:159]
M v[156:159], a[120:123], a[160:163], v[156:159]
 ds_read_b64_tr_b16 a[72:73], v2 offset:49152
 ds_read_b64_tr_b16 a[74:75], v2 offset:50176
M v[164:167], a[128:131], a[160:163], v[164:167]
M v[164:167], a[132:135], a[164:167], v[164:167]
M v[172:175], a[140:143], a[164:167], v[172:175]
 ds_read_b64_tr_b16 a[76:77], v2 offset:57344
 ds_read_b64_tr_b16 a[78:79], v2 offset:58368
M v[172:175], a[136:139], a[160:163], v[172:175]
M v[180:183], a[144:147], a[160:163], v[180:183]
M v[180:183], a[148:151], a[164:167], v[180:183]
 s_waitcnt lgkmcnt(8)
 ds_read_b64_tr_b16 a[80:81], v3 offset:49152
 ds_read_b64_tr_b16 a[82:83], v3 offset:50176
M v[188:191], a[156:159], a[164:167], v[188:191]
 buffer_store_dwordx4 a[212:215], v30, s[8:11], s89 offen offset:64 sc1
M v[188:191], a[152:155], a[160:163], v[188:191]
M v[196:199], a[96:99], a[168:171], v[196:199]
 ds_read_b128 a[160:163], v5 offset:0
 ds_read_b128 a[164:167], v6 offset:0
M v[196:199], a[100:103], a[172:175], v[196:199]
 ds_read_b64_tr_b16 a[84:85], v3 offset:57344
 ds_read_b64_tr_b16 a[86:87], v3 offset:58368
M v[204:207], a[108:111], a[172:175], v[204:207]
M v[204:207], a[104:107], a[168:171], v[204:207]
 ds_read_b64_tr_b16 a[88:89], v4 offset:49152
 ds_read_b64_tr_b16 a[90:91], v4 offset:50176
M v[212:215], a[112:115], a[168:171], v[212:215]
M v[212:215], a[116:119], a[172:175], v[212:215]
M v[220:223], a[124:127], a[172:175], v[220:223]
 ds_read_b64_tr_b16 a[92:93], v4 offset:57344
 ds_read_b64_tr_b16 a[94:95], v4 offset:58368
M v[220:223], a[120:123], a[168:171], v[220:223]
M v[228:231], a[128:131], a[168:171], v[228:231]
M v[228:231], a[132:135], a[172:175], v[228:231]
M v[236:239], a[140:143], a[172:175], v[236:239]
M v[236:239], a[136:139], a[168:171], v[236:239]
M v[244:247], a[144:147], a[168:171], v[244:247]
M v[244:247], a[148:151], a[172:175], v[244:247]
 s_waitcnt lgkmcnt(6)
M v[252:255], a[156:159], a[172:175], v[252:255]
 s_waitcnt vmcnt(22) lgkmcnt(0)
M v[252:255], a[152:155], a[168:171], v[252:255]
 s_barrier
M v[32:35], a[32:35], a[160:163], v[32:35]
 s_add_u32 m0, s23, 32768
 ds_read_b128 a[168:171], v5 offset:2048
 ds_read_b128 a[172:175], v6 offset:2048
M v[32:35], a[36:39], a[164:167], v[32:35]
 ds_read_b64_tr_b16 a[96:97], v20 offset:0
 ds_read_b64_tr_b16 a[98:99], v20 offset:1024
M v[36:39], a[44:47], a[164:167], v[36:39]
 buffer_load_dwordx4 v16, s[56:59], s29 offen offset:0   lds
M v[36:39], a[40:43], a[160:163], v[36:39]
 buffer_store_dwordx4 a[216:219], v30, s[8:11], s89 offen offset:128 sc1
M v[40:43], a[48:51], a[160:163], v[40:43]
 ds_read_b64_tr_b16 a[100:101], v20 offset:8192
 ds_read_b64_tr_b16 a[102:103], v20 offset:9216
M v[40:43], a[52:55], a[164:167], v[40:43]
 buffer_load_dwordx4 v17, s[56:59], s29 offen offset:1024   lds
M v[44:47], a[60:63], a[164:167], v[44:47]
M v[44:47], a[56:59], a[160:163], v[44:47]
 ds_read_b64_tr_b16 a[104:105], v21 offset:0
 ds_read_b64_tr_b16 a[106:107], v21 offset:1024
M v[48:51], a[64:67], a[160:163], v[48:51]
M v[48:51], a[68:71], a[164:167], v[48:51]
 buffer_load_dwordx4 v18, s[56:59], s29 offen offset:2048   lds
M v[52:55], a[76:79], a[164:167], v[52:55]
 ds_read_b64_tr_b16 a[108:109], v21 offset:8192
 ds_read_b64_tr_b16 a[110:111], v21 offset:9216
M v[52:55], a[72:75], a[160:163], v[52:55]
 buffer_store_dwordx4 a[220:223], v30, s[8:11], s89 offen offset:192 sc1
M v[56:59], a[80:83], a[160:163], v[56:59]
M v[56:59], a[84:87], a[164:167], v[56:59]
 s_waitcnt lgkmcnt(8)
 ds_read_b64_tr_b16 a[112:113], v22 offset:0
 ds_read_b64_tr_b16 a[114:115], v22 offset:1024
M v[60:63], a[92:95], a[164:167], v[60:63]
 buffer_load_dwordx4 v19, s[56:59], s29 offen offset:3072   lds
M v[60:63], a[88:91], a[160:163], v[60:63]
 s_add_u32 s29, s29, 128
M v[68:71], a[32:35], a[168:171], v[68:71]
 ds_read_b128 a[160:163], v5 offset:4096
 ds_read_b128 a[164:167], v6 offset:4096
M v[68:71], a[36:39], a[172:175], v[68:71]
 ds_read_b64_tr_b16 a[116:117], v22 offset:8192
 ds_read_b64_tr_b16 a[118:119], v22 offset:9216
M v[76:79], a[44:47], a[172:175], v[76:79]
 s_lshl_b32 s28, s20, 13
 buffer_store_dwordx4 a[224:227], v30, s[8:11], s89 offen offset:256 sc1
M v[76:79], a[40:43], a[168:171], v[76:79]
 s_mul_i32 s21, s41, 1048576
 ds_read_b64_tr_b16 a[120:121], v23 offset:0
 ds_read_b64_tr_b16 a[122:123], v23 offset:1024
M v[84:87], a[48:51], a[168:171], v[84:87]
 s_lshl_b32 s30, s42, 16
M v[84:87], a[52:55], a[172:175], v[84:87]
 s_add_u32 s23, s21, s30
M v[92:95], a[60:63], a[172:175], v[92:95]
 s_add_u32 s43, s23, 16777216
 ds_read_b64_tr_b16 a[124:125], v23 offset:8192
 ds_read_b64_tr_b16 a[126:127], v23 offset:9216
M v[92:95], a[56:59], a[168:171], v[92:95]
 s_min_u32 s27, s42, 9
 buffer_store_dwordx4 a[228:231], v30, s[8:11], s89 offen offset:320 sc1
M v[100:103], a[64:67], a[168:171], v[100:103]
 s_lshl_b32 s22, s27, 1
M v[100:103], a[68:71], a[172:175], v[100:103]
 s_sub_u32 s30, 15, s66
M v[108:111], a[76:79], a[172:175], v[108:111]
 s_lshl_b32 s30, s30, 16
M v[108:111], a[72:75], a[168:171], v[108:111]
 s_add_u32 s32, s21, s30
 buffer_store_dwordx4 a[232:235], v30, s[8:11], s89 offen offset:384 sc1
M v[116:119], a[80:83], a[168:171], v[116:119]
 s_lshl_b32 s30, s20, 14
 s_add_u32 s32, s32, s30
 s_add_u32 s32, s32, 33554432
M v[116:119], a[84:87], a[172:175], v[116:119]
 s_waitcnt lgkmcnt(6)
 buffer_load_dword v24, v25, s[8:11], s46 offen sc1
M v[124:127], a[92:95], a[172:175], v[124:127]
 s_waitcnt vmcnt(23) lgkmcnt(0)
 s_add_u32 s22, s22, 2
 s_mov_b32 s24, 0x7fff
M v[124:127], a[88:91], a[168:171], v[124:127]
 s_barrier
M v[132:135], a[32:35], a[160:163], v[132:135]
 s_cmp_le_u32 s42, 5
 ds_read_b128 a[168:171], v5 offset:6144
 ds_read_b128 a[172:175], v6 offset:6144
M v[132:135], a[36:39], a[164:167], v[132:135]
 s_cselect_b32 s23, 536870912, s25
 ds_read_b64_tr_b16 a[128:129], v20 offset:16384
 ds_read_b64_tr_b16 a[130:131], v20 offset:17408
M v[140:143], a[44:47], a[164:167], v[140:143]
 s_add_u32 s3, s93, 524288
M v[140:143], a[40:43], a[160:163], v[140:143]
 buffer_store_dwordx4 v[128:131], v7, s[8:11], s3 offen offset:0 sc1
M v[148:151], a[48:51], a[160:163], v[148:151]
 ds_read_b64_tr_b16 a[132:133], v20 offset:24576
 ds_read_b64_tr_b16 a[134:135], v20 offset:25600
M v[148:151], a[52:55], a[164:167], v[148:151]
M v[156:159], a[60:63], a[164:167], v[156:159]
M v[156:159], a[56:59], a[160:163], v[156:159]
 ds_read_b64_tr_b16 a[136:137], v21 offset:16384
 ds_read_b64_tr_b16 a[138:139], v21 offset:17408
M v[164:167], a[64:67], a[160:163], v[164:167]
 buffer_store_dwordx4 v[136:139], v7, s[8:11], s3 offen offset:1024 sc1
M v[164:167], a[68:71], a[164:167], v[164:167]
M v[172:175], a[76:79], a[164:167], v[172:175]
 ds_read_b64_tr_b16 a[140:141], v21 offset:24576
 ds_read_b64_tr_b16 a[142:143], v21 offset:25600
M v[172:175], a[72:75], a[160:163], v[172:175]
M v[180:183], a[80:83], a[160:163], v[180:183]
 buffer_store_dwordx4 v[144:147], v7, s[8:11], s3 offen offset:2048 sc1
M v[180:183], a[84:87], a[164:167], v[180:183]
 s_waitcnt lgkmcnt(8)
 ds_read_b64_tr_b16 a[144:145], v22 offset:16384
 ds_read_b64_tr_b16 a[146:147], v22 offset:17408
M v[188:191], a[92:95], a[164:167], v[188:191]
M v[188:191], a[88:91], a[160:163], v[188:191]
 buffer_store_dwordx4 v[152:155], v7, s[8:11], s3 offen offset:3072 sc1
M v[196:199], a[32:35], a[168:171], v[196:199]
 ds_read_b128 a[160:163], v5 offset:16384
 ds_read_b128 a[164:167], v6 offset:16384
M v[196:199], a[36:39], a[172:175], v[196:199]
 s_add_u32 s3, s93, 532480
 ds_read_b64_tr_b16 a[148:149], v22 offset:24576
 ds_read_b64_tr_b16 a[150:151], v22 offset:25600
M v[204:207], a[44:47], a[172:175], v[204:207]
M v[204:207], a[40:43], a[168:171], v[204:207]
 ds_read_b64_tr_b16 a[152:153], v23 offset:16384
 ds_read_b64_tr_b16 a[154:155], v23 offset:17408
M v[212:215], a[48:51], a[168:171], v[212:215]
 buffer_store_dwordx4 v[160:163], v7, s[8:11], s3 offen offset:0 sc1
M v[212:215], a[52:55], a[172:175], v[212:215]
M v[220:223], a[60:63], a[172:175], v[220:223]
 ds_read_b64_tr_b16 a[156:157], v23 offset:24576
 ds_read_b64_tr_b16 a[158:159], v23 offset:25600
M v[220:223], a[56:59], a[168:171], v[220:223]
M v[228:231], a[64:67], a[168:171], v[228:231]
M v[228:231], a[68:71], a[172:175], v[228:231]
M v[236:239], a[76:79], a[172:175], v[236:239]
M v[236:239], a[72:75], a[168:171], v[236:239]
M v[244:247], a[80:83], a[168:171], v[244:247]
M v[244:247], a[84:87], a[172:175], v[244:247]
 s_waitcnt lgkmcnt(6)
M v[252:255], a[92:95], a[172:175], v[252:255]
 s_waitcnt vmcnt(23) lgkmcnt(0)
M v[252:255], a[88:91], a[168:171], v[252:255]
 s_barrier
M v[32:35], a[96:99], a[160:163], v[32:35]
 ds_read_b128 a[168:171], v5 offset:18432
 ds_read_b128 a[172:175], v6 offset:18432
M v[32:35], a[100:103], a[164:167], v[32:35]
 ds_read_b64_tr_b16 a[32:33], v1 offset:0
 ds_read_b64_tr_b16 a[34:35], v1 offset:1024
M v[36:39], a[108:111], a[164:167], v[36:39]
 v_add_u32 v10, s28, v7
 v_add_u32 v11, 0x1000, v10
M v[36:39], a[104:107], a[160:163], v[36:39]
 s_waitcnt vmcnt(5)
 v_cmp_eq_u32 vcc, 0, v24
M v[40:43], a[112:115], a[160:163], v[40:43]
 s_add_u32 s26, s21, 16777216
 ds_read_b64_tr_b16 a[36:37], v1 offset:8192
 ds_read_b64_tr_b16 a[38:39], v1 offset:9216
M v[40:43], a[116:119], a[164:167], v[40:43]
 s_cbranch_vccnz L_f1s0
L_f1r0:
M v[44:47], a[124:127], a[164:167], v[44:47]
 s_add_u32 m0, s28, 98304
 s_nop 0
 buffer_load_dwordx4 v10, s[8:11], s21 offen offset:0 sc1 lds
M v[44:47], a[120:123], a[160:163], v[44:47]
 ds_read_b64_tr_b16 a[40:41], v2 offset:0
 ds_read_b64_tr_b16 a[42:43], v2 offset:1024
M v[48:51], a[128:131], a[160:163], v[48:51]
 buffer_store_dwordx4 v[168:171], v7, s[8:11], s3 offen offset:1024 sc1
M v[48:51], a[132:135], a[164:167], v[48:51]
M v[52:55], a[140:143], a[164:167], v[52:55]
 ds_read_b64_tr_b16 a[44:45], v2 offset:8192
 ds_read_b64_tr_b16 a[46:47], v2 offset:9216
M v[52:55], a[136:139], a[160:163], v[52:55]
 buffer_load_dwordx4 v10, s[8:11], s21 offen offset:1024 sc1 lds
M v[56:59], a[144:147], a[160:163], v[56:59]
M v[56:59], a[148:151], a[164:167], v[56:59]
 s_waitcnt lgkmcnt(8)
 ds_read_b64_tr_b16 a[48:49], v3 offset:0
 ds_read_b64_tr_b16 a[50:51], v3 offset:1024
M v[60:63], a[156:159], a[164:167], v[60:63]
M v[60:63], a[152:155], a[160:163], v[60:63]
 buffer_load_dwordx4 v10, s[8:11], s21 offen offset:2048 sc1 lds
M v[68:71], a[96:99], a[168:171], v[68:71]
 ds_read_b128 a[160:163], v5 offset:20480
 ds_read_b128 a[164:167], v6 offset:20480
M v[68:71], a[100:103], a[172:175], v[68:71]
 ds_read_b64_tr_b16 a[52:53], v3 offset:8192
 ds_read_b64_tr_b16 a[54:55], v3 offset:9216
M v[76:79], a[108:111], a[172:175], v[76:79]
 buffer_store_dwordx4 v[176:179], v7, s[8:11], s3 offen offset:2048 sc1
M v[76:79], a[104:107], a[168:171], v[76:79]
 ds_read_b64_tr_b16 a[56:57], v4 offset:0
 ds_read_b64_tr_b16 a[58:59], v4 offset:1024
M v[84:87], a[112:115], a[168:171], v[84:87]
 buffer_load_dwordx4 v10, s[8:11], s21 offen offset:3072 sc1 lds
M v[84:87], a[116:119], a[172:175], v[84:87]
 s_add_u32 m0, s28, 102400
M v[92:95], a[124:127], a[172:175], v[92:95]
 ds_read_b64_tr_b16 a[60:61], v4 offset:8192
 ds_read_b64_tr_b16 a[62:63], v4 offset:9216
M v[92:95], a[120:123], a[168:171], v[92:95]
M v[100:103], a[128:131], a[168:171], v[100:103]
 buffer_load_dwordx4 v11, s[8:11], s21 offen offset:0 sc1 lds
M v[100:103], a[132:135], a[172:175], v[100:103]
M v[108:111], a[140:143], a[172:175], v[108:111]
 buffer_store_dwordx4 v[184:187], v7, s[8:11], s3 offen offset:3072 sc1
M v[108:111], a[136:139], a[168:171], v[108:111]
M v[116:119], a[144:147], a[168:171], v[116:119]
 buffer_load_dwordx4 v11, s[8:11], s21 offen offset:1024 sc1 lds
M v[116:119], a[148:151], a[172:175], v[116:119]
 s_waitcnt lgkmcnt(6)
M v[124:127], a[156:159], a[172:175], v[124:127]
 s_waitcnt lgkmcnt(0)
 buffer_load_dwordx4 v11, s[8:11], s21 offen offset:2048 sc1 lds
M v[124:127], a[152:155], a[168:171], v[124:127]
 s_barrier
M v[132:135], a[96:99], a[160:163], v[132:135]
 ds_read_b128 a[168:171], v5 offset:22528
 ds_read_b128 a[172:175], v6 offset:22528
M v[132:135], a[100:103], a[164:167], v[132:135]
 ds_read_b64_tr_b16 a[64:65], v1 offset:16384
 ds_read_b64_tr_b16 a[66:67], v1 offset:17408
M v[140:143], a[108:111], a[164:167], v[140:143]
 buffer_load_dwordx4 v11, s[8:11], s21 offen offset:3072 sc1 lds
M v[140:143], a[104:107], a[160:163], v[140:143]
 s_add_u32 s21, s21, 32768
M v[148:151], a[112:115], a[160:163], v[148:151]
 s_sub_u32 s22, s22, 1
 ds_read_b64_tr_b16 a[68:69], v1 offset:24576
 ds_read_b64_tr_b16 a[70:71], v1 offset:25600
M v[148:151], a[116:119], a[164:167], v[148:151]
 s_cmp_eq_u32 s22, 0
M v[156:159], a[124:127], a[164:167], v[156:159]
 s_cselect_b32 s21, s23, s21
M v[156:159], a[120:123], a[160:163], v[156:159]
 s_cselect_b32 s22, s24, s22
 ds_read_b64_tr_b16 a[72:73], v2 offset:16384
 ds_read_b64_tr_b16 a[74:75], v2 offset:17408
M v[164:167], a[128:131], a[160:163], v[164:167]
 s_cselect_b32 s23, s25, s23
 v_subrev_u32 v5, 0x10000, v5
 v_subrev_u32 v6, 0x10000, v6
M v[164:167], a[132:135], a[164:167], v[164:167]
 s_cselect_b32 s24, 0x7fff, s24
 v_mov_b32 v9, v25
 v_lshrrev_b32 v24, 4, v0
M v[172:175], a[140:143], a[164:167], v[172:175]
 ds_read_b64_tr_b16 a[76:77], v2 offset:24576
 ds_read_b64_tr_b16 a[78:79], v2 offset:25600
M v[172:175], a[136:139], a[160:163], v[172:175]
 v_lshlrev_b32 v24, 2, v24
 v_and_b32 v25, 15, v0
M v[180:183], a[144:147], a[160:163], v[180:183]
 v_sub_u32 v24, v24, v25
 s_lshr_b32 s64, s20, 1
M v[180:183], a[148:151], a[164:167], v[180:183]
 s_waitcnt lgkmcnt(8)
 ds_read_b64_tr_b16 a[80:81], v3 offset:16384
 ds_read_b64_tr_b16 a[82:83], v3 offset:17408
M v[188:191], a[156:159], a[164:167], v[188:191]
 s_add_u32 s64, s64, 0
 s_add_u32 s3, s93, 786432
M v[188:191], a[152:155], a[160:163], v[188:191]
 s_lshl_b32 s64, s64, 17
 buffer_store_dwordx4 v[192:195], v7, s[8:11], s3 offen offset:0 sc1
M v[196:199], a[96:99], a[168:171], v[196:199]
 s_and_b32 s65, s20, 1
 ds_read_b128 a[160:163], v5 offset:32768
 ds_read_b128 a[164:167], v6 offset:32768
M v[196:199], a[100:103], a[172:175], v[196:199]
 s_lshl_b32 s65, s65, 12
 ds_read_b64_tr_b16 a[84:85], v3 offset:24576
 ds_read_b64_tr_b16 a[86:87], v3 offset:25600
M v[204:207], a[108:111], a[172:175], v[204:207]
 s_add_u32 s64, s64, s65
 v_add_u32 v14, s64, v7
M v[204:207], a[104:107], a[168:171], v[204:207]
 s_sub_u32 s64, s42, 10
 ds_read_b64_tr_b16 a[88:89], v4 offset:16384
 ds_read_b64_tr_b16 a[90:91], v4 offset:17408
M v[212:215], a[112:115], a[168:171], v[212:215]
 s_and_b32 s35, s64, 536870912
 v_mov_b32 v8, 0xff800000
 v_cmp_lt_i32 s[16:17], 0, v24
M v[212:215], a[116:119], a[172:175], v[212:215]
 v_cmp_lt_i32 s[18:19], -1, v24
 v_cmp_lt_i32 s[48:49], -2, v24
M v[220:223], a[124:127], a[172:175], v[220:223]
 ds_read_b64_tr_b16 a[92:93], v4 offset:24576
 ds_read_b64_tr_b16 a[94:95], v4 offset:25600
M v[220:223], a[120:123], a[168:171], v[220:223]
 v_cmp_lt_i32 s[50:51], -3, v24
M v[228:231], a[128:131], a[168:171], v[228:231]
 buffer_store_dwordx4 v[200:203], v7, s[8:11], s3 offen offset:1024 sc1
M v[228:231], a[132:135], a[172:175], v[228:231]
M v[236:239], a[140:143], a[172:175], v[236:239]
M v[236:239], a[136:139], a[168:171], v[236:239]
M v[244:247], a[144:147], a[168:171], v[244:247]
M v[244:247], a[148:151], a[172:175], v[244:247]
 s_waitcnt lgkmcnt(6)
M v[252:255], a[156:159], a[172:175], v[252:255]
 s_waitcnt lgkmcnt(0)
M v[252:255], a[152:155], a[168:171], v[252:255]
 s_barrier
M v[32:35], a[32:35], a[160:163], v[32:35]
 ds_read_b128 a[168:171], v5 offset:34816
 ds_read_b128 a[172:175], v6 offset:34816
M v[32:35], a[36:39], a[164:167], v[32:35]
 v_mov_b32 v1, v15
 v_add_u32 v2, 0x10000, v7
M v[36:39], a[44:47], a[164:167], v[36:39]
 v_mov_b32 v3, v10
 v_mov_b32 v4, v11
M v[36:39], a[40:43], a[160:163], v[36:39]
 s_mov_b64 s[60:61], s[76:77]
M v[40:43], a[48:51], a[160:163], v[40:43]
 s_mov_b32 s62, s78
M v[40:43], a[52:55], a[164:167], v[40:43]
 s_mov_b32 s63, 0x20000
 v_lshl_add_u32 v10, v0, 7, s95
 v_and_b32 v0, 48, v0
M v[44:47], a[60:63], a[164:167], v[44:47]
 v_lshl_add_u32 v0, v0, 24, v10
M v[44:47], a[56:59], a[160:163], v[44:47]
 v_mul_f32 v32, s5, v32
 v_mul_f32 v33, s5, v33
M v[48:51], a[64:67], a[160:163], v[48:51]
 v_mul_f32 v34, s5, v34
 v_mul_f32 v35, s5, v35
M v[48:51], a[68:71], a[164:167], v[48:51]
 v_mul_f32 v36, s5, v36
 v_mul_f32 v37, s5, v37
M v[52:55], a[76:79], a[164:167], v[52:55]
 v_mul_f32 v38, s5, v38
 v_mul_f32 v39, s5, v39
M v[52:55], a[72:75], a[160:163], v[52:55]
 v_cvt_pk_bf16_f32 v32, v32, v33
 v_cvt_pk_bf16_f32 v33, v34, v35
M v[56:59], a[80:83], a[160:163], v[56:59]
 v_cvt_pk_bf16_f32 v34, v36, v37
 v_cvt_pk_bf16_f32 v35, v38, v39
M v[56:59], a[84:87], a[164:167], v[56:59]
 s_waitcnt lgkmcnt(0)
 ds_write_b128 v14, v[32:35] offset:0
M v[60:63], a[92:95], a[164:167], v[60:63]
 buffer_store_dwordx4 v[208:211], v7, s[8:11], s3 offen offset:2048 sc1
M v[60:63], a[88:91], a[160:163], v[60:63]
 v_mul_f32 v40, s5, v40
 v_mul_f32 v41, s5, v41
M v[68:71], a[32:35], a[168:171], v[68:71]
 ds_read_b128 a[160:163], v5 offset:36864
 ds_read_b128 a[164:167], v6 offset:36864
M v[68:71], a[36:39], a[172:175], v[68:71]
 v_mul_f32 v42, s5, v42
 v_mul_f32 v43, s5, v43
M v[76:79], a[44:47], a[172:175], v[76:79]
 v_mul_f32 v44, s5, v44
 v_mul_f32 v45, s5, v45
M v[76:79], a[40:43], a[168:171], v[76:79]
 v_mul_f32 v46, s5, v46
 v_mul_f32 v47, s5, v47
M v[84:87], a[48:51], a[168:171], v[84:87]
 v_cvt_pk_bf16_f32 v40, v40, v41
 v_cvt_pk_bf16_f32 v41, v42, v43
M v[84:87], a[52:55], a[172:175], v[84:87]
 v_cvt_pk_bf16_f32 v42, v44, v45
 v_cvt_pk_bf16_f32 v43, v46, v47
M v[92:95], a[60:63], a[172:175], v[92:95]
 ds_write_b128 v14, v[40:43] offset:1024
M v[92:95], a[56:59], a[168:171], v[92:95]
 buffer_store_dwordx4 v[216:219], v7, s[8:11], s3 offen offset:3072 sc1
M v[100:103], a[64:67], a[168:171], v[100:103]
 v_mul_f32 v48, s5, v48
 v_mul_f32 v49, s5, v49
M v[100:103], a[68:71], a[172:175], v[100:103]
 v_mul_f32 v50, s5, v50
 v_mul_f32 v51, s5, v51
M v[108:111], a[76:79], a[172:175], v[108:111]
 v_mul_f32 v52, s5, v52
 v_mul_f32 v53, s5, v53
M v[108:111], a[72:75], a[168:171], v[108:111]
 v_mul_f32 v54, s5, v54
 v_mul_f32 v55, s5, v55
M v[116:119], a[80:83], a[168:171], v[116:119]
 v_cvt_pk_bf16_f32 v48, v48, v49
 v_cvt_pk_bf16_f32 v49, v50, v51
M v[116:119], a[84:87], a[172:175], v[116:119]
 s_waitcnt lgkmcnt(1)
 v_cvt_pk_bf16_f32 v50, v52, v53
 v_cvt_pk_bf16_f32 v51, v54, v55
M v[124:127], a[92:95], a[172:175], v[124:127]
 ds_write_b128 v14, v[48:51] offset:2048
M v[124:127], a[88:91], a[168:171], v[124:127]
 s_add_u32 s3, s93, 794624
 buffer_store_dwordx4 v[224:227], v7, s[8:11], s3 offen offset:0 sc1
M v[132:135], a[32:35], a[160:163], v[132:135]
 ds_read_b128 a[168:171], v5 offset:38912
 ds_read_b128 a[172:175], v6 offset:38912
M v[132:135], a[36:39], a[164:167], v[132:135]
 v_mul_f32 v56, s5, v56
 v_mul_f32 v57, s5, v57
M v[140:143], a[44:47], a[164:167], v[140:143]
 v_mul_f32 v58, s5, v58
 v_mul_f32 v59, s5, v59
M v[140:143], a[40:43], a[160:163], v[140:143]
 v_mul_f32 v60, s5, v60
 v_mul_f32 v61, s5, v61
M v[148:151], a[48:51], a[160:163], v[148:151]
 v_mul_f32 v62, s5, v62
 v_mul_f32 v63, s5, v63
M v[148:151], a[52:55], a[164:167], v[148:151]
 v_cvt_pk_bf16_f32 v56, v56, v57
 v_cvt_pk_bf16_f32 v57, v58, v59
M v[156:159], a[60:63], a[164:167], v[156:159]
 v_cvt_pk_bf16_f32 v58, v60, v61
 v_cvt_pk_bf16_f32 v59, v62, v63
M v[156:159], a[56:59], a[160:163], v[156:159]
 s_waitcnt lgkmcnt(0)
 ds_write_b128 v14, v[56:59] offset:3072
M v[164:167], a[64:67], a[160:163], v[164:167]
 s_barrier
M v[164:167], a[68:71], a[164:167], v[164:167]
M v[172:175], a[76:79], a[164:167], v[172:175]
 s_add_u32 m0, s28, 32768
 s_nop 0
 buffer_load_dwordx4 v3, s[8:11], s21 offen offset:0 sc1 lds
M v[172:175], a[72:75], a[160:163], v[172:175]
M v[180:183], a[80:83], a[160:163], v[180:183]
 buffer_store_dwordx4 v[232:235], v7, s[8:11], s3 offen offset:1024 sc1
M v[180:183], a[84:87], a[164:167], v[180:183]
 v_mul_f32 v68, s5, v68
 v_mul_f32 v69, s5, v69
M v[188:191], a[92:95], a[164:167], v[188:191]
 buffer_load_dwordx4 v3, s[8:11], s21 offen offset:1024 sc1 lds
M v[188:191], a[88:91], a[160:163], v[188:191]
 v_mul_f32 v70, s5, v70
 v_mul_f32 v71, s5, v71
M v[196:199], a[32:35], a[168:171], v[196:199]
 v_mul_f32 v76, s5, v76
 v_mul_f32 v77, s5, v77
M v[196:199], a[36:39], a[172:175], v[196:199]
 v_mul_f32 v78, s5, v78
 v_mul_f32 v79, s5, v79
M v[204:207], a[44:47], a[172:175], v[204:207]
 buffer_load_dwordx4 v3, s[8:11], s21 offen offset:2048 sc1 lds
M v[204:207], a[40:43], a[168:171], v[204:207]
 v_cvt_pk_bf16_f32 v68, v68, v69
 v_cvt_pk_bf16_f32 v69, v70, v71
M v[212:215], a[48:51], a[168:171], v[212:215]
 v_cvt_pk_bf16_f32 v70, v76, v77
 v_cvt_pk_bf16_f32 v71, v78, v79
M v[212:215], a[52:55], a[172:175], v[212:215]
 ds_write_b128 v14, v[68:71] offset:8192
M v[220:223], a[60:63], a[172:175], v[220:223]
 buffer_load_dwordx4 v3, s[8:11], s21 offen offset:3072 sc1 lds
M v[220:223], a[56:59], a[168:171], v[220:223]
 s_add_u32 m0, s28, 36864
M v[228:231], a[64:67], a[168:171], v[228:231]
 buffer_store_dwordx4 v[240:243], v7, s[8:11], s3 offen offset:2048 sc1
M v[228:231], a[68:71], a[172:175], v[228:231]
 v_mul_f32 v84, s5, v84
 v_mul_f32 v85, s5, v85
M v[236:239], a[76:79], a[172:175], v[236:239]
 buffer_load_dwordx4 v4, s[8:11], s21 offen offset:0 sc1 lds
M v[236:239], a[72:75], a[168:171], v[236:239]
 v_mul_f32 v86, s5, v86
 v_mul_f32 v87, s5, v87
M v[244:247], a[80:83], a[168:171], v[244:247]
 v_mul_f32 v92, s5, v92
 v_mul_f32 v93, s5, v93
M v[244:247], a[84:87], a[172:175], v[244:247]
 v_mul_f32 v94, s5, v94
 v_mul_f32 v95, s5, v95
M v[252:255], a[92:95], a[172:175], v[252:255]
 buffer_load_dwordx4 v4, s[8:11], s21 offen offset:1024 sc1 lds
M v[252:255], a[88:91], a[168:171], v[252:255]
 buffer_load_dwordx4 v4, s[8:11], s21 offen offset:2048 sc1 lds
 buffer_load_dwordx4 v4, s[8:11], s21 offen offset:3072 sc1 lds
 s_add_u32 s21, s21, 32768
 s_sub_u32 s22, s22, 1
 s_cmp_eq_u32 s22, 0
 s_cselect_b32 s21, s23, s21
 s_cselect_b32 s22, s24, s22
 s_cselect_b32 s23, s25, s23
 s_cselect_b32 s24, 0x7fff, s24
 v_cvt_pk_bf16_f32 v84, v84, v85
 v_cvt_pk_bf16_f32 v85, v86, v87
 v_cvt_pk_bf16_f32 v86, v92, v93
 v_cvt_pk_bf16_f32 v87, v94, v95
 ds_write_b128 v14, v[84:87] offset:9216
 buffer_store_dwordx4 v[248:251], v7, s[8:11], s3 offen offset:3072 sc1
 v_pk_mul_f32 v[100:101], v[100:101], s[4:5] op_sel:[0,1] op_sel_hi:[1,1]
 v_pk_mul_f32 v[102:103], v[102:103], s[4:5] op_sel:[0,1] op_sel_hi:[1,1]
 v_pk_mul_f32 v[108:109], v[108:109], s[4:5] op_sel:[0,1] op_sel_hi:[1,1]
 v_pk_mul_f32 v[110:111], v[110:111], s[4:5] op_sel:[0,1] op_sel_hi:[1,1]
 v_cvt_pk_bf16_f32 v100, v100, v101
 v_cvt_pk_bf16_f32 v101, v102, v103
 v_cvt_pk_bf16_f32 v102, v108, v109
 v_cvt_pk_bf16_f32 v103, v110, v111
 ds_write_b128 v14, v[100:103] offset:10240
 v_pk_mul_f32 v[116:117], v[116:117], s[4:5] op_sel:[0,1] op_sel_hi:[1,1]
 v_pk_mul_f32 v[118:119], v[118:119], s[4:5] op_sel:[0,1] op_sel_hi:[1,1]
 v_pk_mul_f32 v[124:125], v[124:125], s[4:5] op_sel:[0,1] op_sel_hi:[1,1]
 v_pk_mul_f32 v[126:127], v[126:127], s[4:5] op_sel:[0,1] op_sel_hi:[1,1]
 v_cvt_pk_bf16_f32 v116, v116, v117
 v_cvt_pk_bf16_f32 v117, v118, v119
 v_cvt_pk_bf16_f32 v118, v124, v125
 v_cvt_pk_bf16_f32 v119, v126, v127
 ds_write_b128 v14, v[116:119] offset:11264
 v_pk_mul_f32 v[132:133], v[132:133], s[4:5] op_sel:[0,1] op_sel_hi:[1,1]
 v_pk_mul_f32 v[134:135], v[134:135], s[4:5] op_sel:[0,1] op_sel_hi:[1,1]
 v_pk_mul_f32 v[140:141], v[140:141], s[4:5] op_sel:[0,1] op_sel_hi:[1,1]
 v_pk_mul_f32 v[142:143], v[142:143], s[4:5] op_sel:[0,1] op_sel_hi:[1,1]
 v_cvt_pk_bf16_f32 v132, v132, v133
 v_cvt_pk_bf16_f32 v133, v134, v135
 v_cvt_pk_bf16_f32 v134, v140, v141
 v_cvt_pk_bf16_f32 v135, v142, v143
 ds_write_b128 v14, v[132:135] offset:16384
 v_pk_mul_f32 v[148:149], v[148:149], s[4:5] op_sel:[0,1] op_sel_hi:[1,1]
 v_pk_mul_f32 v[150:151], v[150:151], s[4:5] op_sel:[0,1] op_sel_hi:[1,1]
 v_pk_mul_f32 v[156:157], v[156:157], s[4:5] op_sel:[0,1] op_sel_hi:[1,1]
 v_pk_mul_f32 v[158:159], v[158:159], s[4:5] op_sel:[0,1] op_sel_hi:[1,1]
 v_cvt_pk_bf16_f32 v148, v148, v149
 v_cvt_pk_bf16_f32 v149, v150, v151
 v_cvt_pk_bf16_f32 v150, v156, v157
 v_cvt_pk_bf16_f32 v151, v158, v159
 ds_write_b128 v14, v[148:151] offset:17408
 v_pk_mul_f32 v[164:165], v[164:165], s[4:5] op_sel:[0,1] op_sel_hi:[1,1]
 v_pk_mul_f32 v[166:167], v[166:167], s[4:5] op_sel:[0,1] op_sel_hi:[1,1]
 v_pk_mul_f32 v[172:173], v[172:173], s[4:5] op_sel:[0,1] op_sel_hi:[1,1]
 v_pk_mul_f32 v[174:175], v[174:175], s[4:5] op_sel:[0,1] op_sel_hi:[1,1]
 v_cvt_pk_bf16_f32 v164, v164, v165
 v_cvt_pk_bf16_f32 v165, v166, v167
 v_cvt_pk_bf16_f32 v166, v172, v173
 v_cvt_pk_bf16_f32 v167, v174, v175
 ds_write_b128 v14, v[164:167] offset:18432
 v_pk_mul_f32 v[180:181], v[180:181], s[4:5] op_sel:[0,1] op_sel_hi:[1,1]
 v_pk_mul_f32 v[182:183], v[182:183], s[4:5] op_sel:[0,1] op_sel_hi:[1,1]
 v_pk_mul_f32 v[188:189], v[188:189], s[4:5] op_sel:[0,1] op_sel_hi:[1,1]
 v_pk_mul_f32 v[190:191], v[190:191], s[4:5] op_sel:[0,1] op_sel_hi:[1,1]
 v_cvt_pk_bf16_f32 v180, v180, v181
 v_cvt_pk_bf16_f32 v181, v182, v183
 v_cvt_pk_bf16_f32 v182, v188, v189
 v_cvt_pk_bf16_f32 v183, v190, v191
 ds_write_b128 v14, v[180:183] offset:19456
 v_pk_mul_f32 v[196:197], v[196:197], s[4:5] op_sel:[0,1] op_sel_hi:[1,1]
 v_pk_mul_f32 v[198:199], v[198:199], s[4:5] op_sel:[0,1] op_sel_hi:[1,1]
 v_pk_mul_f32 v[204:205], v[204:205], s[4:5] op_sel:[0,1] op_sel_hi:[1,1]
 v_pk_mul_f32 v[206:207], v[206:207], s[4:5] op_sel:[0,1] op_sel_hi:[1,1]
 v_cvt_pk_bf16_f32 v196, v196, v197
 v_cvt_pk_bf16_f32 v197, v198, v199
 v_cvt_pk_bf16_f32 v198, v204, v205
 v_cvt_pk_bf16_f32 v199, v206, v207
 ds_write_b128 v14, v[196:199] offset:24576
 v_pk_mul_f32 v[212:213], v[212:213], s[4:5] op_sel:[0,1] op_sel_hi:[1,1]
 v_pk_mul_f32 v[214:215], v[214:215], s[4:5] op_sel:[0,1] op_sel_hi:[1,1]
 v_pk_mul_f32 v[220:221], v[220:221], s[4:5] op_sel:[0,1] op_sel_hi:[1,1]
 v_pk_mul_f32 v[222:223], v[222:223], s[4:5] op_sel:[0,1] op_sel_hi:[1,1]
 v_cvt_pk_bf16_f32 v212, v212, v213
 v_cvt_pk_bf16_f32 v213, v214, v215
 v_cvt_pk_bf16_f32 v214, v220, v221
 v_cvt_pk_bf16_f32 v215, v222, v223
 ds_write_b128 v14, v[212:215] offset:25600
 v_pk_mul_f32 v[228:229], v[228:229], s[4:5] op_sel:[0,1] op_sel_hi:[1,1]
 v_pk_mul_f32 v[230:231], v[230:231], s[4:5] op_sel:[0,1] op_sel_hi:[1,1]
 v_pk_mul_f32 v[236:237], v[236:237], s[4:5] op_sel:[0,1] op_sel_hi:[1,1]
 v_pk_mul_f32 v[238:239], v[238:239], s[4:5] op_sel:[0,1] op_sel_hi:[1,1]
 v_cvt_pk_bf16_f32 v228, v228, v229
 v_cvt_pk_bf16_f32 v229, v230, v231
 v_cvt_pk_bf16_f32 v230, v236, v237
 v_cvt_pk_bf16_f32 v231, v238, v239
 ds_write_b128 v14, v[228:231] offset:26624
 v_pk_mul_f32 v[244:245], v[244:245], s[4:5] op_sel:[0,1] op_sel_hi:[1,1]
 v_pk_mul_f32 v[246:247], v[246:247], s[4:5] op_sel:[0,1] op_sel_hi:[1,1]
 v_pk_mul_f32 v[252:253], v[252:253], s[4:5] op_sel:[0,1] op_sel_hi:[1,1]
 v_pk_mul_f32 v[254:255], v[254:255], s[4:5] op_sel:[0,1] op_sel_hi:[1,1]
 v_cvt_pk_bf16_f32 v244, v244, v245
 v_cvt_pk_bf16_f32 v245, v246, v247
 v_cvt_pk_bf16_f32 v246, v252, v253
 v_cvt_pk_bf16_f32 v247, v254, v255
 ds_write_b128 v14, v[244:247] offset:27648
 s_waitcnt vmcnt(16) lgkmcnt(0)
 s_barrier
 ds_read_b128 a[64:67], v2 offset:32768
 ds_read_b128 a[68:71], v2 offset:33792
 ds_read_b128 a[72:75], v2 offset:34816
 ds_read_b128 a[76:79], v2 offset:35840
 ds_read_b128 a[80:83], v2 offset:36864
 ds_read_b128 a[84:87], v2 offset:37888
 ds_read_b128 a[88:91], v2 offset:38912
 ds_read_b128 a[92:95], v2 offset:39936
 s_lshr_b32 s64, s20, 1
 s_add_u32 s64, s64, 0
 s_lshl_b32 s64, s64, 17
 s_and_b32 s65, s20, 1
 s_lshl_b32 s65, s65, 14
 s_add_u32 s64, s64, s65
 v_add_u32 v10, s64, v7
 ds_read_b128 a[0:3], v10 offset:0
 ds_read_b128 a[4:7], v10 offset:1024
 ds_read_b128 a[8:11], v10 offset:2048
 ds_read_b128 a[12:15], v10 offset:3072
 ds_read_b128 a[16:19], v10 offset:4096
 ds_read_b128 a[20:23], v10 offset:5120
 ds_read_b128 a[24:27], v10 offset:6144
 ds_read_b128 a[28:31], v10 offset:7168
 ds_read_b128 a[32:35], v10 offset:8192
 ds_read_b128 a[36:39], v10 offset:9216
 ds_read_b128 a[40:43], v10 offset:10240
 ds_read_b128 a[44:47], v10 offset:11264
 ds_read_b128 a[48:51], v10 offset:12288
 ds_read_b128 a[52:55], v10 offset:13312
 ds_read_b128 a[56:59], v10 offset:14336
 ds_read_b128 a[60:63], v10 offset:15360
 v_mov_b32 v15, 4
 v_or_b32 v6, s35, v7
 v_mov_b32 v56, 0
 v_mov_b32 v57, 0
 v_mov_b32 v58, 0
 v_mov_b32 v59, 0
 s_waitcnt lgkmcnt(0)
M v[64:67], a[64:67], a[0:3], 0
 s_add_u32 m0, s28, 65536
 ds_read_b128 a[96:99], v2 offset:40960
 ds_read_b128 a[100:103], v2 offset:41984
M v[64:67], a[68:71], a[4:7], v[64:67]
 s_cmp_eq_u32 s20, 0
 buffer_load_dwordx4 v3, s[8:11], s26 offen offset:0 sc1 lds
M v[64:67], a[72:75], a[8:11], v[64:67]
 s_cselect_b64 s[64:65], -1, 0
M v[64:67], a[76:79], a[12:15], v[64:67]
 s_cmp_eq_u32 s20, 1
 ds_read_b128 a[104:107], v2 offset:43008
 ds_read_b128 a[108:111], v2 offset:44032
M v[64:67], a[80:83], a[16:19], v[64:67]
 s_cselect_b64 s[84:85], -1, 0
 buffer_load_dwordx4 v3, s[8:11], s26 offen offset:1024 sc1 lds
M v[64:67], a[84:87], a[20:23], v[64:67]
 s_or_b64 s[66:67], s[64:65], s[84:85]
M v[64:67], a[88:91], a[24:27], v[64:67]
 s_and_b64 s[68:69], s[16:17], s[64:65]
 ds_read_b128 a[112:115], v2 offset:45056
 ds_read_b128 a[116:119], v2 offset:46080
M v[64:67], a[92:95], a[28:31], v[64:67]
 s_and_b64 s[76:77], s[16:17], s[84:85]
M v[68:71], a[92:95], a[60:63], 0
 s_or_b64 s[76:77], s[76:77], s[64:65]
 buffer_load_dwordx4 v3, s[8:11], s26 offen offset:2048 sc1 lds
M v[68:71], a[88:91], a[56:59], v[68:71]
 s_and_b64 s[70:71], s[18:19], s[64:65]
 ds_read_b128 a[120:123], v2 offset:47104
 ds_read_b128 a[124:127], v2 offset:48128
M v[68:71], a[84:87], a[52:55], v[68:71]
 s_and_b64 s[78:79], s[18:19], s[84:85]
M v[68:71], a[80:83], a[48:51], v[68:71]
 s_or_b64 s[78:79], s[78:79], s[64:65]
 buffer_load_dwordx4 v3, s[8:11], s26 offen offset:3072 sc1 lds
M v[68:71], a[76:79], a[44:47], v[68:71]
 s_and_b64 s[72:73], s[48:49], s[64:65]
M v[68:71], a[72:75], a[40:43], v[68:71]
 s_and_b64 s[80:81], s[48:49], s[84:85]
 s_or_b64 s[80:81], s[80:81], s[64:65]
 s_and_b64 s[74:75], s[50:51], s[64:65]
M v[68:71], a[68:71], a[36:39], v[68:71]
 s_add_u32 m0, s28, 69632
 s_and_b64 s[82:83], s[50:51], s[84:85]
 s_or_b64 s[82:83], s[82:83], s[64:65]
M v[68:71], a[64:67], a[32:35], v[68:71]
 s_waitcnt lgkmcnt(0)
 buffer_load_dwordx4 v4, s[8:11], s26 offen offset:0 sc1 lds
M v[72:75], a[96:99], a[0:3], 0
 ds_read_b128 a[64:67], v2 offset:49152
 ds_read_b128 a[68:71], v2 offset:50176
M v[72:75], a[100:103], a[4:7], v[72:75]
M v[72:75], a[104:107], a[8:11], v[72:75]
M v[72:75], a[108:111], a[12:15], v[72:75]
 ds_read_b128 a[72:75], v2 offset:51200
 ds_read_b128 a[76:79], v2 offset:52224
M v[72:75], a[112:115], a[16:19], v[72:75]
 buffer_load_dwordx4 v4, s[8:11], s26 offen offset:1024 sc1 lds
M v[72:75], a[116:119], a[20:23], v[72:75]
M v[72:75], a[120:123], a[24:27], v[72:75]
 ds_read_b128 a[80:83], v2 offset:53248
 ds_read_b128 a[84:87], v2 offset:54272
M v[72:75], a[124:127], a[28:31], v[72:75]
 buffer_load_dwordx4 v4, s[8:11], s26 offen offset:2048 sc1 lds
M v[76:79], a[124:127], a[60:63], 0
M v[76:79], a[120:123], a[56:59], v[76:79]
 ds_read_b128 a[88:91], v2 offset:55296
 ds_read_b128 a[92:95], v2 offset:56320
M v[76:79], a[116:119], a[52:55], v[76:79]
 buffer_load_dwordx4 v4, s[8:11], s26 offen offset:3072 sc1 lds
M v[76:79], a[112:115], a[48:51], v[76:79]
 s_add_u32 s26, s26, 32768
M v[76:79], a[108:111], a[44:47], v[76:79]
M v[76:79], a[104:107], a[40:43], v[76:79]
M v[76:79], a[100:103], a[36:39], v[76:79]
M v[76:79], a[96:99], a[32:35], v[76:79]
 s_waitcnt lgkmcnt(0)
M v[80:83], a[64:67], a[0:3], 0
 ds_read_b128 a[96:99], v2 offset:57344
 ds_read_b128 a[100:103], v2 offset:58368
M v[80:83], a[68:71], a[4:7], v[80:83]
M v[80:83], a[72:75], a[8:11], v[80:83]
M v[80:83], a[76:79], a[12:15], v[80:83]
 ds_read_b128 a[104:107], v2 offset:59392
 ds_read_b128 a[108:111], v2 offset:60416
M v[80:83], a[80:83], a[16:19], v[80:83]
M v[80:83], a[84:87], a[20:23], v[80:83]
M v[80:83], a[88:91], a[24:27], v[80:83]
 ds_read_b128 a[112:115], v2 offset:61440
 ds_read_b128 a[116:119], v2 offset:62464
M v[80:83], a[92:95], a[28:31], v[80:83]
M v[84:87], a[92:95], a[60:63], 0
M v[84:87], a[88:91], a[56:59], v[84:87]
 ds_read_b128 a[120:123], v2 offset:63488
 ds_read_b128 a[124:127], v2 offset:64512
M v[84:87], a[84:87], a[52:55], v[84:87]
M v[84:87], a[80:83], a[48:51], v[84:87]
M v[84:87], a[76:79], a[44:47], v[84:87]
M v[84:87], a[72:75], a[40:43], v[84:87]
M v[84:87], a[68:71], a[36:39], v[84:87]
 s_waitcnt vmcnt(8) lgkmcnt(0)
M v[84:87], a[64:67], a[32:35], v[84:87]
 s_barrier
M v[88:91], a[96:99], a[0:3], 0
 ds_read_b128 a[64:67], v7 offset:32768
 ds_read_b128 a[68:71], v7 offset:33792
M v[88:91], a[100:103], a[4:7], v[88:91]
 buffer_store_dword v15, v1, s[8:11], s45 offen sc1
M v[88:91], a[104:107], a[8:11], v[88:91]
M v[88:91], a[108:111], a[12:15], v[88:91]
 ds_read_b128 a[72:75], v7 offset:34816
 ds_read_b128 a[76:79], v7 offset:35840
M v[88:91], a[112:115], a[16:19], v[88:91]
M v[88:91], a[116:119], a[20:23], v[88:91]
M v[88:91], a[120:123], a[24:27], v[88:91]
 ds_read_b128 a[80:83], v7 offset:36864
 ds_read_b128 a[84:87], v7 offset:37888
M v[88:91], a[124:127], a[28:31], v[88:91]
M v[92:95], a[124:127], a[60:63], 0
M v[92:95], a[120:123], a[56:59], v[92:95]
 ds_read_b128 a[88:91], v7 offset:38912
 ds_read_b128 a[92:95], v7 offset:39936
M v[92:95], a[116:119], a[52:55], v[92:95]
M v[92:95], a[112:115], a[48:51], v[92:95]
M v[92:95], a[108:111], a[44:47], v[92:95]
M v[92:95], a[104:107], a[40:43], v[92:95]
M v[92:95], a[100:103], a[36:39], v[92:95]
 s_waitcnt lgkmcnt(0)
M v[92:95], a[96:99], a[32:35], v[92:95]
 s_cmp_lg_u32 s42, 0
 s_cbranch_scc1 L_init
 v_cndmask_b32 v64, v64, v8, s[68:69]
 v_cndmask_b32 v65, v65, v8, s[70:71]
 v_cndmask_b32 v66, v66, v8, s[72:73]
 v_cndmask_b32 v67, v67, v8, s[74:75]
 v_cndmask_b32 v72, v72, v8, s[64:65]
 v_cndmask_b32 v73, v73, v8, s[64:65]
 v_cndmask_b32 v74, v74, v8, s[64:65]
 v_cndmask_b32 v75, v75, v8, s[64:65]
 v_cndmask_b32 v76, v76, v8, s[68:69]
 v_cndmask_b32 v77, v77, v8, s[70:71]
 v_cndmask_b32 v78, v78, v8, s[72:73]
 v_cndmask_b32 v79, v79, v8, s[74:75]
 v_cndmask_b32 v80, v80, v8, s[76:77]
 v_cndmask_b32 v81, v81, v8, s[78:79]
 v_cndmask_b32 v82, v82, v8, s[80:81]
 v_cndmask_b32 v83, v83, v8, s[82:83]
 v_cndmask_b32 v84, v84, v8, s[64:65]
 v_cndmask_b32 v85, v85, v8, s[64:65]
 v_cndmask_b32 v86, v86, v8, s[64:65]
 v_cndmask_b32 v87, v87, v8, s[64:65]
 v_cndmask_b32 v88, v88, v8, s[66:67]
 v_cndmask_b32 v89, v89, v8, s[66:67]
 v_cndmask_b32 v90, v90, v8, s[66:67]
 v_cndmask_b32 v91, v91, v8, s[66:67]
 v_cndmask_b32 v92, v92, v8, s[76:77]
 v_cndmask_b32 v93, v93, v8, s[78:79]
 v_cndmask_b32 v94, v94, v8, s[80:81]
 v_cndmask_b32 v95, v95, v8, s[82:83]
 s_cmp_eq_u32 s20, 2
 s_cselect_b64 s[64:65], -1, 0
 s_cmp_eq_u32 s20, 3
 s_cselect_b64 s[84:85], -1, 0
 s_or_b64 s[66:67], s[64:65], s[84:85]
 s_and_b64 s[68:69], s[16:17], s[64:65]
 s_and_b64 s[76:77], s[16:17], s[84:85]
 s_or_b64 s[76:77], s[76:77], s[64:65]
 s_and_b64 s[70:71], s[18:19], s[64:65]
 s_and_b64 s[78:79], s[18:19], s[84:85]
 s_or_b64 s[78:79], s[78:79], s[64:65]
 s_and_b64 s[72:73], s[48:49], s[64:65]
 s_and_b64 s[80:81], s[48:49], s[84:85]
 s_or_b64 s[80:81], s[80:81], s[64:65]
 s_and_b64 s[74:75], s[50:51], s[64:65]
 s_and_b64 s[82:83], s[50:51], s[84:85]
 s_or_b64 s[82:83], s[82:83], s[64:65]
 s_lshl_b32 s86, s20, 14
 s_add_u32 s86, s86, s34
 s_add_u32 s87, s86, 4096
 s_add_u32 s88, s86, 8192
 s_add_u32 s89, s86, 12288
 s_lshl_b32 s90, s20, 10
 s_add_u32 s90, s90, s34
 s_add_u32 s90, s90, 65536
L_init:
 s_add_u32 m0, s28, 98304
 v_max3_f32 v10, v64, v65, v66
 buffer_load_dwordx4 v3, s[8:11], s21 offen offset:0 sc1 lds
 v_max3_f32 v10, v67, v72, v10
 v_max3_f32 v10, v73, v74, v10
 v_max3_f32 v10, v75, v80, v10
 v_max3_f32 v10, v81, v82, v10
 v_max3_f32 v10, v83, v88, v10
 v_max3_f32 v10, v89, v90, v10
 v_max_f32 v10, v91, v10
 v_max3_f32 v11, v68, v69, v70
 v_max3_f32 v11, v71, v76, v11
 v_max3_f32 v11, v77, v78, v11
 v_max3_f32 v11, v79, v84, v11
 v_mfma_f32_32x32x16_bf16 v[128:143], v[56:59], v[56:59], 0
 v_max3_f32 v11, v85, v86, v11
 buffer_load_dwordx4 v3, s[8:11], s21 offen offset:1024 sc1 lds
 v_max3_f32 v11, v87, v92, v11
 v_max3_f32 v11, v93, v94, v11
 v_max_f32 v11, v95, v11
 v_mov_b32 v12, v10
 v_mov_b32 v13, v11
 s_nop 0
 v_permlane16_swap_b32 v12, v10
 v_permlane16_swap_b32 v13, v11
 v_max_f32 v10, v12, v10
 v_max_f32 v11, v13, v11
 v_mov_b32 v12, v10
 v_mov_b32 v13, v11
 s_nop 0
 v_permlane32_swap_b32 v12, v10
 v_mfma_f32_32x32x16_bf16 v[144:159], v[56:59], v[56:59], 0
 buffer_load_dwordx4 v3, s[8:11], s21 offen offset:2048 sc1 lds
 v_permlane32_swap_b32 v13, v11
 v_max_f32 v10, v12, v10
 v_max_f32 v11, v13, v11
 v_ceil_f32 v10, v10
 v_ceil_f32 v11, v11
 v_sub_f32 v32, 0, v10
 v_sub_f32 v33, 0, v10
 v_sub_f32 v34, 0, v10
 v_sub_f32 v35, 0, v10
 v_sub_f32 v36, 0, v11
 v_sub_f32 v37, 0, v11
 v_sub_f32 v38, 0, v11
 v_sub_f32 v39, 0, v11
 v_mfma_f32_32x32x16_bf16 v[160:175], v[56:59], v[56:59], 0
 buffer_load_dwordx4 v3, s[8:11], s21 offen offset:3072 sc1 lds
 v_sub_f32 v64, v64, v10
 v_sub_f32 v65, v65, v10
 v_sub_f32 v66, v66, v10
 v_sub_f32 v67, v67, v10
 v_sub_f32 v68, v68, v11
 v_sub_f32 v69, v69, v11
 v_sub_f32 v70, v70, v11
 v_sub_f32 v71, v71, v11
 v_sub_f32 v72, v72, v10
 v_sub_f32 v73, v73, v10
 v_sub_f32 v74, v74, v10
 s_add_u32 m0, s28, 102400
 v_sub_f32 v75, v75, v10
 v_mfma_f32_32x32x16_bf16 v[176:191], v[56:59], v[56:59], 0
 buffer_load_dwordx4 v4, s[8:11], s21 offen offset:0 sc1 lds
 v_sub_f32 v76, v76, v11
 v_sub_f32 v77, v77, v11
 v_sub_f32 v78, v78, v11
 v_sub_f32 v79, v79, v11
 v_sub_f32 v80, v80, v10
 v_sub_f32 v81, v81, v10
 v_sub_f32 v82, v82, v10
 v_sub_f32 v83, v83, v10
 v_sub_f32 v84, v84, v11
 v_sub_f32 v85, v85, v11
 v_sub_f32 v86, v86, v11
 v_sub_f32 v87, v87, v11
 buffer_load_dwordx4 v4, s[8:11], s21 offen offset:1024 sc1 lds
 v_mfma_f32_32x32x16_bf16 v[192:207], v[56:59], v[56:59], 0
 v_sub_f32 v88, v88, v10
 v_sub_f32 v89, v89, v10
 v_sub_f32 v90, v90, v10
 v_sub_f32 v91, v91, v10
 v_sub_f32 v92, v92, v11
 v_sub_f32 v93, v93, v11
 v_sub_f32 v94, v94, v11
 v_sub_f32 v95, v95, v11
 v_mov_b32 v30, 0
 v_mov_b32 v31, 0
 v_exp_f32 v18, v64
 v_exp_f32 v19, v65
 v_exp_f32 v20, v66
 buffer_load_dwordx4 v4, s[8:11], s21 offen offset:2048 sc1 lds
 v_mfma_f32_32x32x16_bf16 v[208:223], v[56:59], v[56:59], 0
 v_add_f32 v26, v18, v19
 v_cvt_pk_bf16_f32 v40, v18, v19
 v_exp_f32 v21, v67
 v_exp_f32 v22, v72
 v_add_f32 v26, v20, v26
 v_cvt_pk_bf16_f32 v41, v20, v21
 v_exp_f32 v23, v73
 v_add_f32 v26, v21, v26
 v_exp_f32 v24, v74
 v_add_f32 v26, v22, v26
 v_cvt_pk_bf16_f32 v42, v22, v23
 v_exp_f32 v25, v75
 buffer_load_dwordx4 v4, s[8:11], s21 offen offset:3072 sc1 lds
 s_add_u32 s21, s21, 32768
 v_mfma_f32_32x32x16_bf16 v[224:239], v[56:59], v[56:59], 0
 s_sub_u32 s22, s22, 1
 s_cmp_eq_u32 s22, 0
 s_cselect_b32 s21, s23, s21
 s_cselect_b32 s22, s24, s22
 s_cselect_b32 s23, s25, s23
 s_cselect_b32 s24, 0x7fff, s24
 v_add_f32 v26, v23, v26
 v_exp_f32 v18, v68
 v_add_f32 v26, v24, v26
 v_cvt_pk_bf16_f32 v43, v24, v25
 v_exp_f32 v19, v69
 v_add_f32 v26, v25, v26
 v_exp_f32 v20, v70
 v_add_f32 v27, v18, v19
 v_mfma_f32_32x32x16_bf16 v[240:255], v[56:59], v[56:59], 0
 v_cvt_pk_bf16_f32 v44, v18, v19
 v_exp_f32 v21, v71
 v_exp_f32 v22, v76
 v_add_f32 v27, v20, v27
 v_cvt_pk_bf16_f32 v45, v20, v21
 v_exp_f32 v23, v77
 v_add_f32 v27, v21, v27
 v_exp_f32 v24, v78
 v_add_f32 v27, v22, v27
 v_cvt_pk_bf16_f32 v46, v22, v23
 v_exp_f32 v25, v79
 v_add_f32 v27, v23, v27
 v_add_f32 v27, v24, v27
 v_cvt_pk_bf16_f32 v47, v24, v25
 v_add_f32 v27, v25, v27
 s_cmp_lg_u32 s27, 0
 s_cbranch_scc1 L_loop_mid
 s_branch L_p2
L_kv1:
 s_mov_b32 s60, s90
 s_and_b32 s61, s91, 0xffff
 s_mov_b32 s62, 3670016
 s_mov_b32 s63, 0x20000
 s_and_b32 s64, s42, 7
 s_lshl_b32 s64, s64, 2
 s_add_u32 s64, s64, s20
 s_lshl_b32 s64, s64, 14
 v_lshrrev_b32 v30, 2, v0
 v_and_b32 v29, 3, v0
 v_lshlrev_b32 v29, 7, v29
 v_lshl_add_u32 v30, v30, 13, v29
 v_add_u32 v25, s64, v30
 v_and_b32 v30, 56, v0
 v_lshl_add_u32 v25, v30, 24, v25
 s_add_u32 m0, s23, 32768
 s_nop 0
 buffer_load_dwordx4 v8, s[16:19], s21 offen offset:0  nt lds
 buffer_load_dwordx4 v9, s[16:19], s21 offen offset:1024  nt lds
 buffer_load_dwordx4 v10, s[16:19], s21 offen offset:2048  nt lds
 buffer_load_dwordx4 v11, s[16:19], s21 offen offset:3072  nt lds
 s_add_u32 s21, s21, 128
 s_add_u32 m0, s24, 16384
 s_nop 0
 buffer_load_dwordx4 v12, s[48:51], s22 offen offset:0   lds
 buffer_load_dwordx4 v13, s[48:51], s22 offen offset:1024   lds
 buffer_load_dwordx4 v14, s[48:51], s22 offen offset:2048   lds
 buffer_load_dwordx4 v15, s[48:51], s22 offen offset:3072   lds
 s_sub_u32 s22, s22, 2097024
 s_waitcnt vmcnt(8) lgkmcnt(0)
 s_barrier
 ds_read_b128 a[160:163], v5 offset:0
 ds_read_b128 a[164:167], v6 offset:0
 ds_read_b64_tr_b16 a[32:33], v1 offset:0
 ds_read_b64_tr_b16 a[34:35], v1 offset:1024
 ds_read_b64_tr_b16 a[36:37], v1 offset:8192
 ds_read_b64_tr_b16 a[38:39], v1 offset:9216
 ds_read_b64_tr_b16 a[40:41], v2 offset:0
 ds_read_b64_tr_b16 a[42:43], v2 offset:1024
 ds_read_b64_tr_b16 a[44:45], v2 offset:8192
 ds_read_b64_tr_b16 a[46:47], v2 offset:9216
 ds_read_b64_tr_b16 a[48:49], v3 offset:0
 ds_read_b64_tr_b16 a[50:51], v3 offset:1024
 ds_read_b64_tr_b16 a[52:53], v3 offset:8192
 ds_read_b64_tr_b16 a[54:55], v3 offset:9216
 ds_read_b64_tr_b16 a[56:57], v4 offset:0
 ds_read_b64_tr_b16 a[58:59], v4 offset:1024
 ds_read_b64_tr_b16 a[60:61], v4 offset:8192
 ds_read_b64_tr_b16 a[62:63], v4 offset:9216
 ds_read_b64_tr_b16 a[64:65], v1 offset:16384
 ds_read_b64_tr_b16 a[66:67], v1 offset:17408
 ds_read_b64_tr_b16 a[68:69], v1 offset:24576
 ds_read_b64_tr_b16 a[70:71], v1 offset:25600
 ds_read_b64_tr_b16 a[72:73], v2 offset:16384
 ds_read_b64_tr_b16 a[74:75], v2 offset:17408
 ds_read_b64_tr_b16 a[76:77], v2 offset:24576
 ds_read_b64_tr_b16 a[78:79], v2 offset:25600
 ds_read_b64_tr_b16 a[80:81], v3 offset:16384
 ds_read_b64_tr_b16 a[82:83], v3 offset:17408
 ds_read_b64_tr_b16 a[84:85], v3 offset:24576
 ds_read_b64_tr_b16 a[86:87], v3 offset:25600
 ds_read_b64_tr_b16 a[88:89], v4 offset:16384
 ds_read_b64_tr_b16 a[90:91], v4 offset:17408
 ds_read_b64_tr_b16 a[92:93], v4 offset:24576
 ds_read_b64_tr_b16 a[94:95], v4 offset:25600
 s_waitcnt lgkmcnt(15)
M a[0:3], a[160:163], a[32:35], 0
 s_add_u32 m0, s23, 49152
 ds_read_b128 a[168:171], v5 offset:2048
 ds_read_b128 a[172:175], v6 offset:2048
M a[0:3], a[164:167], a[36:39], a[0:3]
 buffer_load_dwordx4 v8, s[16:19], s21 offen offset:0  nt lds
M a[4:7], a[164:167], a[44:47], 0
M a[4:7], a[160:163], a[40:43], a[4:7]
M a[8:11], a[160:163], a[48:51], 0
 buffer_load_dwordx4 v9, s[16:19], s21 offen offset:1024  nt lds
M a[8:11], a[164:167], a[52:55], a[8:11]
 s_waitcnt lgkmcnt(14)
M a[12:15], a[164:167], a[60:63], 0
M a[12:15], a[160:163], a[56:59], a[12:15]
 buffer_load_dwordx4 v10, s[16:19], s21 offen offset:2048  nt lds
M a[16:19], a[160:163], a[64:67], 0
M a[16:19], a[164:167], a[68:71], a[16:19]
 s_waitcnt lgkmcnt(6)
M a[20:23], a[164:167], a[76:79], 0
 buffer_load_dwordx4 v11, s[16:19], s21 offen offset:3072  nt lds
M a[20:23], a[160:163], a[72:75], a[20:23]
 s_add_u32 s21, s21, 524160
M a[24:27], a[160:163], a[80:83], 0
M a[24:27], a[164:167], a[84:87], a[24:27]
 s_waitcnt lgkmcnt(0)
M a[28:31], a[164:167], a[92:95], 0
 s_waitcnt vmcnt(8)
M a[28:31], a[160:163], a[88:91], a[28:31]
 s_barrier
M v[32:35], a[168:171], a[32:35], 0
 s_add_u32 m0, s24, 32768
 ds_read_b128 a[160:163], v5 offset:4096
 ds_read_b128 a[164:167], v6 offset:4096
M v[32:35], a[172:175], a[36:39], v[32:35]
 ds_read_b64_tr_b16 a[96:97], v1 offset:32768
 ds_read_b64_tr_b16 a[98:99], v1 offset:33792
M v[36:39], a[172:175], a[44:47], 0
 buffer_load_dwordx4 v12, s[48:51], s22 offen offset:0   lds
M v[36:39], a[168:171], a[40:43], v[36:39]
M v[40:43], a[168:171], a[48:51], 0
 ds_read_b64_tr_b16 a[100:101], v1 offset:40960
 ds_read_b64_tr_b16 a[102:103], v1 offset:41984
M v[40:43], a[172:175], a[52:55], v[40:43]
 buffer_load_dwordx4 v13, s[48:51], s22 offen offset:1024   lds
M v[44:47], a[172:175], a[60:63], 0
M v[44:47], a[168:171], a[56:59], v[44:47]
 ds_read_b64_tr_b16 a[104:105], v2 offset:32768
 ds_read_b64_tr_b16 a[106:107], v2 offset:33792
M v[48:51], a[168:171], a[64:67], 0
 buffer_load_dwordx4 v14, s[48:51], s22 offen offset:2048   lds
M v[48:51], a[172:175], a[68:71], v[48:51]
M v[52:55], a[172:175], a[76:79], 0
 ds_read_b64_tr_b16 a[108:109], v2 offset:40960
 ds_read_b64_tr_b16 a[110:111], v2 offset:41984
M v[52:55], a[168:171], a[72:75], v[52:55]
 buffer_load_dwordx4 v15, s[48:51], s22 offen offset:3072   lds
M v[56:59], a[168:171], a[80:83], 0
 s_add_u32 s22, s22, 2097152
M v[56:59], a[172:175], a[84:87], v[56:59]
 s_waitcnt lgkmcnt(8)
 ds_read_b64_tr_b16 a[112:113], v3 offset:32768
 ds_read_b64_tr_b16 a[114:115], v3 offset:33792
M v[60:63], a[172:175], a[92:95], 0
 s_add_u32 m0, s23, 0
M v[60:63], a[168:171], a[88:91], v[60:63]
 buffer_load_dwordx4 v8, s[16:19], s21 offen offset:0  nt lds
M v[64:67], a[160:163], a[32:35], 0
 ds_read_b128 a[168:171], v5 offset:6144
 ds_read_b128 a[172:175], v6 offset:6144
M v[64:67], a[164:167], a[36:39], v[64:67]
 ds_read_b64_tr_b16 a[116:117], v3 offset:40960
 ds_read_b64_tr_b16 a[118:119], v3 offset:41984
M v[68:71], a[164:167], a[44:47], 0
M v[68:71], a[160:163], a[40:43], v[68:71]
 ds_read_b64_tr_b16 a[120:121], v4 offset:32768
 ds_read_b64_tr_b16 a[122:123], v4 offset:33792
M v[72:75], a[160:163], a[48:51], 0
 buffer_load_dwordx4 v9, s[16:19], s21 offen offset:1024  nt lds
M v[72:75], a[164:167], a[52:55], v[72:75]
M v[76:79], a[164:167], a[60:63], 0
 ds_read_b64_tr_b16 a[124:125], v4 offset:40960
 ds_read_b64_tr_b16 a[126:127], v4 offset:41984
M v[76:79], a[160:163], a[56:59], v[76:79]
 buffer_load_dwordx4 v10, s[16:19], s21 offen offset:2048  nt lds
M v[80:83], a[160:163], a[64:67], 0
M v[80:83], a[164:167], a[68:71], v[80:83]
M v[84:87], a[164:167], a[76:79], 0
 buffer_load_dwordx4 v11, s[16:19], s21 offen offset:3072  nt lds
M v[84:87], a[160:163], a[72:75], v[84:87]
 s_add_u32 s21, s21, 128
M v[88:91], a[160:163], a[80:83], 0
M v[88:91], a[164:167], a[84:87], v[88:91]
 s_waitcnt lgkmcnt(6)
M v[92:95], a[164:167], a[92:95], 0
 s_waitcnt vmcnt(8) lgkmcnt(0)
M v[92:95], a[160:163], a[88:91], v[92:95]
 s_barrier
M v[96:99], a[168:171], a[32:35], 0
 s_add_u32 m0, s24, 49152
 ds_read_b128 a[160:163], v5 offset:16384
 ds_read_b128 a[164:167], v6 offset:16384
M v[96:99], a[172:175], a[36:39], v[96:99]
 buffer_load_dwordx4 v12, s[48:51], s22 offen offset:0   lds
M v[100:103], a[172:175], a[44:47], 0
 ds_read_b64_tr_b16 a[128:129], v1 offset:49152
 ds_read_b64_tr_b16 a[130:131], v1 offset:50176
M v[100:103], a[168:171], a[40:43], v[100:103]
M v[104:107], a[168:171], a[48:51], 0
 buffer_load_dwordx4 v13, s[48:51], s22 offen offset:1024   lds
M v[104:107], a[172:175], a[52:55], v[104:107]
M v[108:111], a[172:175], a[60:63], 0
M v[108:111], a[168:171], a[56:59], v[108:111]
M v[112:115], a[168:171], a[64:67], 0
 buffer_load_dwordx4 v14, s[48:51], s22 offen offset:2048   lds
M v[112:115], a[172:175], a[68:71], v[112:115]
 ds_read_b64_tr_b16 a[132:133], v1 offset:57344
 ds_read_b64_tr_b16 a[134:135], v1 offset:58368
M v[116:119], a[172:175], a[76:79], 0
M v[116:119], a[168:171], a[72:75], v[116:119]
M v[120:123], a[168:171], a[80:83], 0
 buffer_load_dwordx4 v15, s[48:51], s22 offen offset:3072   lds
M v[120:123], a[172:175], a[84:87], v[120:123]
 s_waitcnt lgkmcnt(4)
M v[124:127], a[172:175], a[92:95], 0
 s_sub_u32 s22, s22, 2097024
M v[124:127], a[168:171], a[88:91], v[124:127]
 s_add_u32 m0, s23, 16384
M v[128:131], a[160:163], a[32:35], 0
 ds_read_b128 a[168:171], v5 offset:18432
 ds_read_b128 a[172:175], v6 offset:18432
M v[128:131], a[164:167], a[36:39], v[128:131]
 ds_read_b64_tr_b16 a[136:137], v2 offset:49152
 ds_read_b64_tr_b16 a[138:139], v2 offset:50176
M v[132:135], a[164:167], a[44:47], 0
 buffer_load_dwordx4 v8, s[16:19], s21 offen offset:0  nt lds
M v[132:135], a[160:163], a[40:43], v[132:135]
M v[136:139], a[160:163], a[48:51], 0
 buffer_load_dwordx4 v9, s[16:19], s21 offen offset:1024  nt lds
M v[136:139], a[164:167], a[52:55], v[136:139]
M v[140:143], a[164:167], a[60:63], 0
M v[140:143], a[160:163], a[56:59], v[140:143]
 ds_read_b64_tr_b16 a[140:141], v2 offset:57344
 ds_read_b64_tr_b16 a[142:143], v2 offset:58368
M v[144:147], a[160:163], a[64:67], 0
 buffer_load_dwordx4 v10, s[16:19], s21 offen offset:2048  nt lds
M v[144:147], a[164:167], a[68:71], v[144:147]
M v[148:151], a[164:167], a[76:79], 0
M v[148:151], a[160:163], a[72:75], v[148:151]
 buffer_load_dwordx4 v11, s[16:19], s21 offen offset:3072  nt lds
M v[152:155], a[160:163], a[80:83], 0
 s_add_u32 s21, s21, 524160
M v[152:155], a[164:167], a[84:87], v[152:155]
 s_waitcnt lgkmcnt(4)
M v[156:159], a[164:167], a[92:95], 0
 s_add_u32 m0, s24, 0
 ds_read_b64_tr_b16 a[144:145], v3 offset:49152
 ds_read_b64_tr_b16 a[146:147], v3 offset:50176
M v[156:159], a[160:163], a[88:91], v[156:159]
 buffer_load_dwordx4 v12, s[48:51], s22 offen offset:0   lds
M v[160:163], a[168:171], a[32:35], 0
 ds_read_b128 a[160:163], v5 offset:20480
 ds_read_b128 a[164:167], v6 offset:20480
M v[160:163], a[172:175], a[36:39], v[160:163]
M v[164:167], a[172:175], a[44:47], 0
M v[164:167], a[168:171], a[40:43], v[164:167]
 buffer_load_dwordx4 v13, s[48:51], s22 offen offset:1024   lds
M v[168:171], a[168:171], a[48:51], 0
M v[168:171], a[172:175], a[52:55], v[168:171]
 ds_read_b64_tr_b16 a[148:149], v3 offset:57344
 ds_read_b64_tr_b16 a[150:151], v3 offset:58368
M v[172:175], a[172:175], a[60:63], 0
M v[172:175], a[168:171], a[56:59], v[172:175]
 buffer_load_dwordx4 v14, s[48:51], s22 offen offset:2048   lds
M v[176:179], a[168:171], a[64:67], 0
M v[176:179], a[172:175], a[68:71], v[176:179]
M v[180:183], a[172:175], a[76:79], 0
 buffer_load_dwordx4 v15, s[48:51], s22 offen offset:3072   lds
M v[180:183], a[168:171], a[72:75], v[180:183]
 s_add_u32 s22, s22, 2097152
M v[184:187], a[168:171], a[80:83], 0
 ds_read_b64_tr_b16 a[152:153], v4 offset:49152
 ds_read_b64_tr_b16 a[154:155], v4 offset:50176
M v[184:187], a[172:175], a[84:87], v[184:187]
 s_waitcnt lgkmcnt(4)
M v[188:191], a[172:175], a[92:95], 0
 s_add_u32 m0, s23, 32768
M v[188:191], a[168:171], a[88:91], v[188:191]
 buffer_load_dwordx4 v8, s[16:19], s21 offen offset:0  nt lds
M v[192:195], a[160:163], a[32:35], 0
 ds_read_b128 a[168:171], v5 offset:22528
 ds_read_b128 a[172:175], v6 offset:22528
M v[192:195], a[164:167], a[36:39], v[192:195]
M v[196:199], a[164:167], a[44:47], 0
 buffer_load_dwordx4 v9, s[16:19], s21 offen offset:1024  nt lds
M v[196:199], a[160:163], a[40:43], v[196:199]
 ds_read_b64_tr_b16 a[156:157], v4 offset:57344
 ds_read_b64_tr_b16 a[158:159], v4 offset:58368
M v[200:203], a[160:163], a[48:51], 0
M v[200:203], a[164:167], a[52:55], v[200:203]
M v[204:207], a[164:167], a[60:63], 0
 buffer_load_dwordx4 v10, s[16:19], s21 offen offset:2048  nt lds
M v[204:207], a[160:163], a[56:59], v[204:207]
M v[208:211], a[160:163], a[64:67], 0
M v[208:211], a[164:167], a[68:71], v[208:211]
M v[212:215], a[164:167], a[76:79], 0
 buffer_load_dwordx4 v11, s[16:19], s21 offen offset:3072  nt lds
M v[212:215], a[160:163], a[72:75], v[212:215]
 s_add_u32 s21, s21, 128
M v[216:219], a[160:163], a[80:83], 0
M v[216:219], a[164:167], a[84:87], v[216:219]
 s_waitcnt lgkmcnt(2)
M v[220:223], a[164:167], a[92:95], 0
 s_waitcnt vmcnt(16) lgkmcnt(0)
M v[220:223], a[160:163], a[88:91], v[220:223]
 s_barrier
M v[224:227], a[168:171], a[32:35], 0
 ds_read_b128 a[160:163], v5 offset:32768
 ds_read_b128 a[164:167], v6 offset:32768
M v[224:227], a[172:175], a[36:39], v[224:227]
 buffer_load_dword a240, v24, s[32:35], 0 offen offset:512
M v[228:231], a[172:175], a[44:47], 0
M v[228:231], a[168:171], a[40:43], v[228:231]
M v[232:235], a[168:171], a[48:51], 0
M v[232:235], a[172:175], a[52:55], v[232:235]
M v[236:239], a[172:175], a[60:63], 0
M v[236:239], a[168:171], a[56:59], v[236:239]
M v[240:243], a[168:171], a[64:67], 0
M v[240:243], a[172:175], a[68:71], v[240:243]
M v[244:247], a[172:175], a[76:79], 0
M v[244:247], a[168:171], a[72:75], v[244:247]
M v[248:251], a[168:171], a[80:83], 0
M v[248:251], a[172:175], a[84:87], v[248:251]
 s_waitcnt lgkmcnt(0)
M v[252:255], a[172:175], a[92:95], 0
M v[252:255], a[168:171], a[88:91], v[252:255]
M a[0:3], a[160:163], a[96:99], a[0:3]
 ds_read_b128 a[168:171], v5 offset:34816
 ds_read_b128 a[172:175], v6 offset:34816
M a[0:3], a[164:167], a[100:103], a[0:3]
 ds_read_b64_tr_b16 a[32:33], v1 offset:0
 ds_read_b64_tr_b16 a[34:35], v1 offset:1024
M a[4:7], a[164:167], a[108:111], a[4:7]
 s_add_u32 m0, s24, 16384
M a[4:7], a[160:163], a[104:107], a[4:7]
 buffer_load_dwordx4 v12, s[48:51], s22 offen offset:0   lds
M a[8:11], a[160:163], a[112:115], a[8:11]
M a[8:11], a[164:167], a[116:119], a[8:11]
M a[12:15], a[164:167], a[124:127], a[12:15]
 ds_read_b64_tr_b16 a[36:37], v1 offset:8192
 ds_read_b64_tr_b16 a[38:39], v1 offset:9216
M a[12:15], a[160:163], a[120:123], a[12:15]
M a[16:19], a[160:163], a[128:131], a[16:19]
 buffer_load_dwordx4 v13, s[48:51], s22 offen offset:1024   lds
M a[16:19], a[164:167], a[132:135], a[16:19]
M a[20:23], a[164:167], a[140:143], a[20:23]
M a[20:23], a[160:163], a[136:139], a[20:23]
 ds_read_b64_tr_b16 a[40:41], v2 offset:0
 ds_read_b64_tr_b16 a[42:43], v2 offset:1024
M a[24:27], a[160:163], a[144:147], a[24:27]
M a[24:27], a[164:167], a[148:151], a[24:27]
 s_waitcnt lgkmcnt(6)
 buffer_load_dwordx4 v14, s[48:51], s22 offen offset:2048   lds
M a[28:31], a[164:167], a[156:159], a[28:31]
M a[28:31], a[160:163], a[152:155], a[28:31]
M v[32:35], a[168:171], a[96:99], v[32:35]
 ds_read_b128 a[160:163], v5 offset:36864
 ds_read_b128 a[164:167], v6 offset:36864
M v[32:35], a[172:175], a[100:103], v[32:35]
 ds_read_b64_tr_b16 a[44:45], v2 offset:8192
 ds_read_b64_tr_b16 a[46:47], v2 offset:9216
M v[36:39], a[172:175], a[108:111], v[36:39]
 buffer_load_dwordx4 v15, s[48:51], s22 offen offset:3072   lds
M v[36:39], a[168:171], a[104:107], v[36:39]
 s_sub_u32 s22, s22, 2097024
M v[40:43], a[168:171], a[112:115], v[40:43]
M v[40:43], a[172:175], a[116:119], v[40:43]
 ds_read_b64_tr_b16 a[48:49], v3 offset:0
 ds_read_b64_tr_b16 a[50:51], v3 offset:1024
M v[44:47], a[172:175], a[124:127], v[44:47]
 s_add_u32 m0, s23, 49152
M v[44:47], a[168:171], a[120:123], v[44:47]
 buffer_load_dwordx4 v8, s[16:19], s21 offen offset:0  nt lds
M v[48:51], a[168:171], a[128:131], v[48:51]
M v[48:51], a[172:175], a[132:135], v[48:51]
M v[52:55], a[172:175], a[140:143], v[52:55]
 ds_read_b64_tr_b16 a[52:53], v3 offset:8192
 ds_read_b64_tr_b16 a[54:55], v3 offset:9216
M v[52:55], a[168:171], a[136:139], v[52:55]
M v[56:59], a[168:171], a[144:147], v[56:59]
 buffer_load_dwordx4 v9, s[16:19], s21 offen offset:1024  nt lds
M v[56:59], a[172:175], a[148:151], v[56:59]
 s_waitcnt lgkmcnt(6)
M v[60:63], a[172:175], a[156:159], v[60:63]
M v[60:63], a[168:171], a[152:155], v[60:63]
 ds_read_b64_tr_b16 a[56:57], v4 offset:0
 ds_read_b64_tr_b16 a[58:59], v4 offset:1024
M v[64:67], a[160:163], a[96:99], v[64:67]
 ds_read_b128 a[168:171], v5 offset:38912
 ds_read_b128 a[172:175], v6 offset:38912
M v[64:67], a[164:167], a[100:103], v[64:67]
 buffer_load_dwordx4 v10, s[16:19], s21 offen offset:2048  nt lds
M v[68:71], a[164:167], a[108:111], v[68:71]
M v[68:71], a[160:163], a[104:107], v[68:71]
M v[72:75], a[160:163], a[112:115], v[72:75]
 ds_read_b64_tr_b16 a[60:61], v4 offset:8192
 ds_read_b64_tr_b16 a[62:63], v4 offset:9216
M v[72:75], a[164:167], a[116:119], v[72:75]
M v[76:79], a[164:167], a[124:127], v[76:79]
 buffer_load_dwordx4 v11, s[16:19], s21 offen offset:3072  nt lds
M v[76:79], a[160:163], a[120:123], v[76:79]
 s_add_u32 s21, s21, 524160
M v[80:83], a[160:163], a[128:131], v[80:83]
M v[80:83], a[164:167], a[132:135], v[80:83]
M v[84:87], a[164:167], a[140:143], v[84:87]
M v[84:87], a[160:163], a[136:139], v[84:87]
M v[88:91], a[160:163], a[144:147], v[88:91]
M v[88:91], a[164:167], a[148:151], v[88:91]
 s_waitcnt lgkmcnt(2)
M v[92:95], a[164:167], a[156:159], v[92:95]
 s_waitcnt vmcnt(17) lgkmcnt(0)
M v[92:95], a[160:163], a[152:155], v[92:95]
 s_barrier
M v[96:99], a[168:171], a[96:99], v[96:99]
 ds_read_b128 a[160:163], v5 offset:49152
 ds_read_b128 a[164:167], v6 offset:49152
M v[96:99], a[172:175], a[100:103], v[96:99]
M v[100:103], a[172:175], a[108:111], v[100:103]
 s_add_u32 m0, s24, 32768
 ds_read_b64_tr_b16 a[64:65], v1 offset:16384
 ds_read_b64_tr_b16 a[66:67], v1 offset:17408
M v[100:103], a[168:171], a[104:107], v[100:103]
 buffer_load_dwordx4 v12, s[48:51], s22 offen offset:0   lds
M v[104:107], a[168:171], a[112:115], v[104:107]
M v[104:107], a[172:175], a[116:119], v[104:107]
M v[108:111], a[172:175], a[124:127], v[108:111]
M v[108:111], a[168:171], a[120:123], v[108:111]
M v[112:115], a[168:171], a[128:131], v[112:115]
M v[112:115], a[172:175], a[132:135], v[112:115]
 ds_read_b64_tr_b16 a[68:69], v1 offset:24576
 ds_read_b64_tr_b16 a[70:71], v1 offset:25600
M v[116:119], a[172:175], a[140:143], v[116:119]
 buffer_load_dwordx4 v13, s[48:51], s22 offen offset:1024   lds
M v[116:119], a[168:171], a[136:139], v[116:119]
M v[120:123], a[168:171], a[144:147], v[120:123]
M v[120:123], a[172:175], a[148:151], v[120:123]
 s_waitcnt lgkmcnt(4)
M v[124:127], a[172:175], a[156:159], v[124:127]
M v[124:127], a[168:171], a[152:155], v[124:127]
M v[128:131], a[160:163], a[96:99], v[128:131]
 ds_read_b128 a[168:171], v5 offset:51200
 ds_read_b128 a[172:175], v6 offset:51200
M v[128:131], a[164:167], a[100:103], v[128:131]
 ds_read_b64_tr_b16 a[72:73], v2 offset:16384
 ds_read_b64_tr_b16 a[74:75], v2 offset:17408
M v[132:135], a[164:167], a[108:111], v[132:135]
 buffer_load_dwordx4 v14, s[48:51], s22 offen offset:2048   lds
M v[132:135], a[160:163], a[104:107], v[132:135]
M v[136:139], a[160:163], a[112:115], v[136:139]
M v[136:139], a[164:167], a[116:119], v[136:139]
M v[140:143], a[164:167], a[124:127], v[140:143]
M v[140:143], a[160:163], a[120:123], v[140:143]
 ds_read_b64_tr_b16 a[76:77], v2 offset:24576
 ds_read_b64_tr_b16 a[78:79], v2 offset:25600
M v[144:147], a[160:163], a[128:131], v[144:147]
 buffer_load_dwordx4 v15, s[48:51], s22 offen offset:3072   lds
M v[144:147], a[164:167], a[132:135], v[144:147]
 s_add_u32 s22, s22, 2097152
M v[148:151], a[164:167], a[140:143], v[148:151]
M v[148:151], a[160:163], a[136:139], v[148:151]
M v[152:155], a[160:163], a[144:147], v[152:155]
M v[152:155], a[164:167], a[148:151], v[152:155]
 s_waitcnt lgkmcnt(4)
M v[156:159], a[164:167], a[156:159], v[156:159]
 s_add_u32 m0, s23, 0
 ds_read_b64_tr_b16 a[80:81], v3 offset:16384
 ds_read_b64_tr_b16 a[82:83], v3 offset:17408
M v[156:159], a[160:163], a[152:155], v[156:159]
 buffer_load_dwordx4 v8, s[16:19], s21 offen offset:0  nt lds
M v[160:163], a[168:171], a[96:99], v[160:163]
 ds_read_b128 a[160:163], v5 offset:53248
 ds_read_b128 a[164:167], v6 offset:53248
M v[160:163], a[172:175], a[100:103], v[160:163]
M v[164:167], a[172:175], a[108:111], v[164:167]
M v[164:167], a[168:171], a[104:107], v[164:167]
M v[168:171], a[168:171], a[112:115], v[168:171]
M v[168:171], a[172:175], a[116:119], v[168:171]
 ds_read_b64_tr_b16 a[84:85], v3 offset:24576
 ds_read_b64_tr_b16 a[86:87], v3 offset:25600
M v[172:175], a[172:175], a[124:127], v[172:175]
 buffer_load_dwordx4 v9, s[16:19], s21 offen offset:1024  nt lds
M v[172:175], a[168:171], a[120:123], v[172:175]
M v[176:179], a[168:171], a[128:131], v[176:179]
M v[176:179], a[172:175], a[132:135], v[176:179]
M v[180:183], a[172:175], a[140:143], v[180:183]
M v[180:183], a[168:171], a[136:139], v[180:183]
M v[184:187], a[168:171], a[144:147], v[184:187]
 ds_read_b64_tr_b16 a[88:89], v4 offset:16384
 ds_read_b64_tr_b16 a[90:91], v4 offset:17408
M v[184:187], a[172:175], a[148:151], v[184:187]
 s_waitcnt lgkmcnt(4)
 buffer_load_dwordx4 v10, s[16:19], s21 offen offset:2048  nt lds
M v[188:191], a[172:175], a[156:159], v[188:191]
M v[188:191], a[168:171], a[152:155], v[188:191]
M v[192:195], a[160:163], a[96:99], v[192:195]
 ds_read_b128 a[168:171], v5 offset:55296
 ds_read_b128 a[172:175], v6 offset:55296
M v[192:195], a[164:167], a[100:103], v[192:195]
M v[196:199], a[164:167], a[108:111], v[196:199]
M v[196:199], a[160:163], a[104:107], v[196:199]
 ds_read_b64_tr_b16 a[92:93], v4 offset:24576
 ds_read_b64_tr_b16 a[94:95], v4 offset:25600
M v[200:203], a[160:163], a[112:115], v[200:203]
 buffer_load_dwordx4 v11, s[16:19], s21 offen offset:3072  nt lds
M v[200:203], a[164:167], a[116:119], v[200:203]
 s_add_u32 s21, s21, 128
M v[204:207], a[164:167], a[124:127], v[204:207]
M v[204:207], a[160:163], a[120:123], v[204:207]
M v[208:211], a[160:163], a[128:131], v[208:211]
M v[208:211], a[164:167], a[132:135], v[208:211]
M v[212:215], a[164:167], a[140:143], v[212:215]
M v[212:215], a[160:163], a[136:139], v[212:215]
M v[216:219], a[160:163], a[144:147], v[216:219]
M v[216:219], a[164:167], a[148:151], v[216:219]
 s_waitcnt lgkmcnt(2)
M v[220:223], a[164:167], a[156:159], v[220:223]
 s_waitcnt vmcnt(17) lgkmcnt(0)
M v[220:223], a[160:163], a[152:155], v[220:223]
 s_barrier
M v[224:227], a[168:171], a[96:99], v[224:227]
 ds_read_b128 a[160:163], v5 offset:0
 ds_read_b128 a[164:167], v6 offset:0
M v[224:227], a[172:175], a[100:103], v[224:227]
M v[228:231], a[172:175], a[108:111], v[228:231]
M v[228:231], a[168:171], a[104:107], v[228:231]
M v[232:235], a[168:171], a[112:115], v[232:235]
M v[232:235], a[172:175], a[116:119], v[232:235]
M v[236:239], a[172:175], a[124:127], v[236:239]
M v[236:239], a[168:171], a[120:123], v[236:239]
M v[240:243], a[168:171], a[128:131], v[240:243]
M v[240:243], a[172:175], a[132:135], v[240:243]
M v[244:247], a[172:175], a[140:143], v[244:247]
M v[244:247], a[168:171], a[136:139], v[244:247]
M v[248:251], a[168:171], a[144:147], v[248:251]
M v[248:251], a[172:175], a[148:151], v[248:251]
 s_waitcnt lgkmcnt(0)
M v[252:255], a[172:175], a[156:159], v[252:255]
M v[252:255], a[168:171], a[152:155], v[252:255]
M a[0:3], a[160:163], a[32:35], a[0:3]
 ds_read_b128 a[168:171], v5 offset:2048
 ds_read_b128 a[172:175], v6 offset:2048
M a[0:3], a[164:167], a[36:39], a[0:3]
 ds_read_b64_tr_b16 a[96:97], v1 offset:32768
 ds_read_b64_tr_b16 a[98:99], v1 offset:33792
M a[4:7], a[164:167], a[44:47], a[4:7]
 s_add_u32 m0, s24, 49152
M a[4:7], a[160:163], a[40:43], a[4:7]
 buffer_load_dwordx4 v12, s[48:51], s22 offen offset:0   lds
M a[8:11], a[160:163], a[48:51], a[8:11]
M a[8:11], a[164:167], a[52:55], a[8:11]
M a[12:15], a[164:167], a[60:63], a[12:15]
 ds_read_b64_tr_b16 a[100:101], v1 offset:40960
 ds_read_b64_tr_b16 a[102:103], v1 offset:41984
M a[12:15], a[160:163], a[56:59], a[12:15]
M a[16:19], a[160:163], a[64:67], a[16:19]
 buffer_load_dwordx4 v13, s[48:51], s22 offen offset:1024   lds
M a[16:19], a[164:167], a[68:71], a[16:19]
M a[20:23], a[164:167], a[76:79], a[20:23]
M a[20:23], a[160:163], a[72:75], a[20:23]
 ds_read_b64_tr_b16 a[104:105], v2 offset:32768
 ds_read_b64_tr_b16 a[106:107], v2 offset:33792
M a[24:27], a[160:163], a[80:83], a[24:27]
M a[24:27], a[164:167], a[84:87], a[24:27]
 s_waitcnt lgkmcnt(6)
 buffer_load_dwordx4 v14, s[48:51], s22 offen offset:2048   lds
M a[28:31], a[164:167], a[92:95], a[28:31]
M a[28:31], a[160:163], a[88:91], a[28:31]
M v[32:35], a[168:171], a[32:35], v[32:35]
 ds_read_b128 a[160:163], v5 offset:4096
 ds_read_b128 a[164:167], v6 offset:4096
M v[32:35], a[172:175], a[36:39], v[32:35]
 ds_read_b64_tr_b16 a[108:109], v2 offset:40960
 ds_read_b64_tr_b16 a[110:111], v2 offset:41984
M v[36:39], a[172:175], a[44:47], v[36:39]
 buffer_load_dwordx4 v15, s[48:51], s22 offen offset:3072   lds
M v[36:39], a[168:171], a[40:43], v[36:39]
 s_sub_u32 s22, s22, 2097024
M v[40:43], a[168:171], a[48:51], v[40:43]
M v[40:43], a[172:175], a[52:55], v[40:43]
 ds_read_b64_tr_b16 a[112:113], v3 offset:32768
 ds_read_b64_tr_b16 a[114:115], v3 offset:33792
M v[44:47], a[172:175], a[60:63], v[44:47]
 s_add_u32 m0, s23, 16384
M v[44:47], a[168:171], a[56:59], v[44:47]
 buffer_load_dwordx4 v8, s[16:19], s21 offen offset:0  nt lds
M v[48:51], a[168:171], a[64:67], v[48:51]
M v[48:51], a[172:175], a[68:71], v[48:51]
M v[52:55], a[172:175], a[76:79], v[52:55]
 ds_read_b64_tr_b16 a[116:117], v3 offset:40960
 ds_read_b64_tr_b16 a[118:119], v3 offset:41984
M v[52:55], a[168:171], a[72:75], v[52:55]
M v[56:59], a[168:171], a[80:83], v[56:59]
 buffer_load_dwordx4 v9, s[16:19], s21 offen offset:1024  nt lds
M v[56:59], a[172:175], a[84:87], v[56:59]
 s_waitcnt lgkmcnt(6)
M v[60:63], a[172:175], a[92:95], v[60:63]
M v[60:63], a[168:171], a[88:91], v[60:63]
 ds_read_b64_tr_b16 a[120:121], v4 offset:32768
 ds_read_b64_tr_b16 a[122:123], v4 offset:33792
M v[64:67], a[160:163], a[32:35], v[64:67]
 ds_read_b128 a[168:171], v5 offset:6144
 ds_read_b128 a[172:175], v6 offset:6144
M v[64:67], a[164:167], a[36:39], v[64:67]
 buffer_load_dwordx4 v10, s[16:19], s21 offen offset:2048  nt lds
M v[68:71], a[164:167], a[44:47], v[68:71]
M v[68:71], a[160:163], a[40:43], v[68:71]
M v[72:75], a[160:163], a[48:51], v[72:75]
 ds_read_b64_tr_b16 a[124:125], v4 offset:40960
 ds_read_b64_tr_b16 a[126:127], v4 offset:41984
M v[72:75], a[164:167], a[52:55], v[72:75]
M v[76:79], a[164:167], a[60:63], v[76:79]
 buffer_load_dwordx4 v11, s[16:19], s21 offen offset:3072  nt lds
M v[76:79], a[160:163], a[56:59], v[76:79]
 s_add_u32 s21, s21, 524160
M v[80:83], a[160:163], a[64:67], v[80:83]
M v[80:83], a[164:167], a[68:71], v[80:83]
M v[84:87], a[164:167], a[76:79], v[84:87]
M v[84:87], a[160:163], a[72:75], v[84:87]
M v[88:91], a[160:163], a[80:83], v[88:91]
M v[88:91], a[164:167], a[84:87], v[88:91]
 s_waitcnt lgkmcnt(2)
M v[92:95], a[164:167], a[92:95], v[92:95]
 s_waitcnt vmcnt(16) lgkmcnt(0)
M v[92:95], a[160:163], a[88:91], v[92:95]
 s_barrier
M v[96:99], a[168:171], a[32:35], v[96:99]
 ds_read_b128 a[160:163], v5 offset:16384
 ds_read_b128 a[164:167], v6 offset:16384
M v[96:99], a[172:175], a[36:39], v[96:99]
M v[100:103], a[172:175], a[44:47], v[100:103]
 s_add_u32 m0, s24, 0
 ds_read_b64_tr_b16 a[128:129], v1 offset:49152
 ds_read_b64_tr_b16 a[130:131], v1 offset:50176
M v[100:103], a[168:171], a[40:43], v[100:103]
 buffer_load_dwordx4 v12, s[48:51], s22 offen offset:0   lds
M v[104:107], a[168:171], a[48:51], v[104:107]
M v[104:107], a[172:175], a[52:55], v[104:107]
M v[108:111], a[172:175], a[60:63], v[108:111]
M v[108:111], a[168:171], a[56:59], v[108:111]
M v[112:115], a[168:171], a[64:67], v[112:115]
M v[112:115], a[172:175], a[68:71], v[112:115]
 ds_read_b64_tr_b16 a[132:133], v1 offset:57344
 ds_read_b64_tr_b16 a[134:135], v1 offset:58368
M v[116:119], a[172:175], a[76:79], v[116:119]
 buffer_load_dwordx4 v13, s[48:51], s22 offen offset:1024   lds
M v[116:119], a[168:171], a[72:75], v[116:119]
M v[120:123], a[168:171], a[80:83], v[120:123]
M v[120:123], a[172:175], a[84:87], v[120:123]
 s_waitcnt lgkmcnt(4)
M v[124:127], a[172:175], a[92:95], v[124:127]
M v[124:127], a[168:171], a[88:91], v[124:127]
M v[128:131], a[160:163], a[32:35], v[128:131]
 ds_read_b128 a[168:171], v5 offset:18432
 ds_read_b128 a[172:175], v6 offset:18432
M v[128:131], a[164:167], a[36:39], v[128:131]
 ds_read_b64_tr_b16 a[136:137], v2 offset:49152
 ds_read_b64_tr_b16 a[138:139], v2 offset:50176
M v[132:135], a[164:167], a[44:47], v[132:135]
 buffer_load_dwordx4 v14, s[48:51], s22 offen offset:2048   lds
M v[132:135], a[160:163], a[40:43], v[132:135]
M v[136:139], a[160:163], a[48:51], v[136:139]
M v[136:139], a[164:167], a[52:55], v[136:139]
M v[140:143], a[164:167], a[60:63], v[140:143]
M v[140:143], a[160:163], a[56:59], v[140:143]
 ds_read_b64_tr_b16 a[140:141], v2 offset:57344
 ds_read_b64_tr_b16 a[142:143], v2 offset:58368
M v[144:147], a[160:163], a[64:67], v[144:147]
 buffer_load_dwordx4 v15, s[48:51], s22 offen offset:3072   lds
M v[144:147], a[164:167], a[68:71], v[144:147]
 s_add_u32 s22, s22, 2097152
M v[148:151], a[164:167], a[76:79], v[148:151]
M v[148:151], a[160:163], a[72:75], v[148:151]
M v[152:155], a[160:163], a[80:83], v[152:155]
M v[152:155], a[164:167], a[84:87], v[152:155]
 s_waitcnt lgkmcnt(4)
M v[156:159], a[164:167], a[92:95], v[156:159]
 s_add_u32 m0, s23, 32768
 ds_read_b64_tr_b16 a[144:145], v3 offset:49152
 ds_read_b64_tr_b16 a[146:147], v3 offset:50176
M v[156:159], a[160:163], a[88:91], v[156:159]
 buffer_load_dwordx4 v8, s[16:19], s21 offen offset:0  nt lds
M v[160:163], a[168:171], a[32:35], v[160:163]
 ds_read_b128 a[160:163], v5 offset:20480
 ds_read_b128 a[164:167], v6 offset:20480
M v[160:163], a[172:175], a[36:39], v[160:163]
M v[164:167], a[172:175], a[44:47], v[164:167]
M v[164:167], a[168:171], a[40:43], v[164:167]
M v[168:171], a[168:171], a[48:51], v[168:171]
M v[168:171], a[172:175], a[52:55], v[168:171]
 ds_read_b64_tr_b16 a[148:149], v3 offset:57344
 ds_read_b64_tr_b16 a[150:151], v3 offset:58368
M v[172:175], a[172:175], a[60:63], v[172:175]
 buffer_load_dwordx4 v9, s[16:19], s21 offen offset:1024  nt lds
M v[172:175], a[168:171], a[56:59], v[172:175]
M v[176:179], a[168:171], a[64:67], v[176:179]
M v[176:179], a[172:175], a[68:71], v[176:179]
M v[180:183], a[172:175], a[76:79], v[180:183]
M v[180:183], a[168:171], a[72:75], v[180:183]
M v[184:187], a[168:171], a[80:83], v[184:187]
 ds_read_b64_tr_b16 a[152:153], v4 offset:49152
 ds_read_b64_tr_b16 a[154:155], v4 offset:50176
M v[184:187], a[172:175], a[84:87], v[184:187]
 s_waitcnt lgkmcnt(4)
 buffer_load_dwordx4 v10, s[16:19], s21 offen offset:2048  nt lds
M v[188:191], a[172:175], a[92:95], v[188:191]
M v[188:191], a[168:171], a[88:91], v[188:191]
M v[192:195], a[160:163], a[32:35], v[192:195]
 ds_read_b128 a[168:171], v5 offset:22528
 ds_read_b128 a[172:175], v6 offset:22528
M v[192:195], a[164:167], a[36:39], v[192:195]
M v[196:199], a[164:167], a[44:47], v[196:199]
M v[196:199], a[160:163], a[40:43], v[196:199]
 ds_read_b64_tr_b16 a[156:157], v4 offset:57344
 ds_read_b64_tr_b16 a[158:159], v4 offset:58368
M v[200:203], a[160:163], a[48:51], v[200:203]
 buffer_load_dwordx4 v11, s[16:19], s21 offen offset:3072  nt lds
M v[200:203], a[164:167], a[52:55], v[200:203]
 s_add_u32 s21, s21, 128
M v[204:207], a[164:167], a[60:63], v[204:207]
M v[204:207], a[160:163], a[56:59], v[204:207]
M v[208:211], a[160:163], a[64:67], v[208:211]
M v[208:211], a[164:167], a[68:71], v[208:211]
M v[212:215], a[164:167], a[76:79], v[212:215]
M v[212:215], a[160:163], a[72:75], v[212:215]
M v[216:219], a[160:163], a[80:83], v[216:219]
M v[216:219], a[164:167], a[84:87], v[216:219]
 s_waitcnt lgkmcnt(2)
M v[220:223], a[164:167], a[92:95], v[220:223]
 s_waitcnt vmcnt(16) lgkmcnt(0)
M v[220:223], a[160:163], a[88:91], v[220:223]
 s_barrier
M v[224:227], a[168:171], a[32:35], v[224:227]
 ds_read_b128 a[160:163], v5 offset:32768
 ds_read_b128 a[164:167], v6 offset:32768
M v[224:227], a[172:175], a[36:39], v[224:227]
M v[228:231], a[172:175], a[44:47], v[228:231]
M v[228:231], a[168:171], a[40:43], v[228:231]
M v[232:235], a[168:171], a[48:51], v[232:235]
M v[232:235], a[172:175], a[52:55], v[232:235]
M v[236:239], a[172:175], a[60:63], v[236:239]
M v[236:239], a[168:171], a[56:59], v[236:239]
M v[240:243], a[168:171], a[64:67], v[240:243]
M v[240:243], a[172:175], a[68:71], v[240:243]
M v[244:247], a[172:175], a[76:79], v[244:247]
M v[244:247], a[168:171], a[72:75], v[244:247]
M v[248:251], a[168:171], a[80:83], v[248:251]
M v[248:251], a[172:175], a[84:87], v[248:251]
 s_waitcnt lgkmcnt(0)
M v[252:255], a[172:175], a[92:95], v[252:255]
M v[252:255], a[168:171], a[88:91], v[252:255]
M a[0:3], a[160:163], a[96:99], a[0:3]
 ds_read_b128 a[168:171], v5 offset:34816
 ds_read_b128 a[172:175], v6 offset:34816
M a[0:3], a[164:167], a[100:103], a[0:3]
 ds_read_b64_tr_b16 a[32:33], v1 offset:0
 ds_read_b64_tr_b16 a[34:35], v1 offset:1024
M a[4:7], a[164:167], a[108:111], a[4:7]
 s_add_u32 m0, s24, 16384
M a[4:7], a[160:163], a[104:107], a[4:7]
 buffer_load_dwordx4 v12, s[48:51], s22 offen offset:0   lds
M a[8:11], a[160:163], a[112:115], a[8:11]
M a[8:11], a[164:167], a[116:119], a[8:11]
M a[12:15], a[164:167], a[124:127], a[12:15]
 ds_read_b64_tr_b16 a[36:37], v1 offset:8192
 ds_read_b64_tr_b16 a[38:39], v1 offset:9216
M a[12:15], a[160:163], a[120:123], a[12:15]
M a[16:19], a[160:163], a[128:131], a[16:19]
 buffer_load_dwordx4 v13, s[48:51], s22 offen offset:1024   lds
M a[16:19], a[164:167], a[132:135], a[16:19]
M a[20:23], a[164:167], a[140:143], a[20:23]
M a[20:23], a[160:163], a[136:139], a[20:23]
 ds_read_b64_tr_b16 a[40:41], v2 offset:0
 ds_read_b64_tr_b16 a[42:43], v2 offset:1024
M a[24:27], a[160:163], a[144:147], a[24:27]
M a[24:27], a[164:167], a[148:151], a[24:27]
 s_waitcnt lgkmcnt(6)
 buffer_load_dwordx4 v14, s[48:51], s22 offen offset:2048   lds
M a[28:31], a[164:167], a[156:159], a[28:31]
M a[28:31], a[160:163], a[152:155], a[28:31]
M v[32:35], a[168:171], a[96:99], v[32:35]
 ds_read_b128 a[160:163], v5 offset:36864
 ds_read_b128 a[164:167], v6 offset:36864
M v[32:35], a[172:175], a[100:103], v[32:35]
 ds_read_b64_tr_b16 a[44:45], v2 offset:8192
 ds_read_b64_tr_b16 a[46:47], v2 offset:9216
M v[36:39], a[172:175], a[108:111], v[36:39]
 buffer_load_dwordx4 v15, s[48:51], s22 offen offset:3072   lds
M v[36:39], a[168:171], a[104:107], v[36:39]
 s_sub_u32 s22, s22, 2097024
M v[40:43], a[168:171], a[112:115], v[40:43]
M v[40:43], a[172:175], a[116:119], v[40:43]
 ds_read_b64_tr_b16 a[48:49], v3 offset:0
 ds_read_b64_tr_b16 a[50:51], v3 offset:1024
M v[44:47], a[172:175], a[124:127], v[44:47]
 s_add_u32 m0, s23, 49152
M v[44:47], a[168:171], a[120:123], v[44:47]
 buffer_load_dwordx4 v8, s[16:19], s21 offen offset:0  nt lds
M v[48:51], a[168:171], a[128:131], v[48:51]
M v[48:51], a[172:175], a[132:135], v[48:51]
M v[52:55], a[172:175], a[140:143], v[52:55]
 ds_read_b64_tr_b16 a[52:53], v3 offset:8192
 ds_read_b64_tr_b16 a[54:55], v3 offset:9216
M v[52:55], a[168:171], a[136:139], v[52:55]
M v[56:59], a[168:171], a[144:147], v[56:59]
 buffer_load_dwordx4 v9, s[16:19], s21 offen offset:1024  nt lds
M v[56:59], a[172:175], a[148:151], v[56:59]
 s_waitcnt lgkmcnt(6)
M v[60:63], a[172:175], a[156:159], v[60:63]
M v[60:63], a[168:171], a[152:155], v[60:63]
 ds_read_b64_tr_b16 a[56:57], v4 offset:0
 ds_read_b64_tr_b16 a[58:59], v4 offset:1024
M v[64:67], a[160:163], a[96:99], v[64:67]
 ds_read_b128 a[168:171], v5 offset:38912
 ds_read_b128 a[172:175], v6 offset:38912
M v[64:67], a[164:167], a[100:103], v[64:67]
 buffer_load_dwordx4 v10, s[16:19], s21 offen offset:2048  nt lds
M v[68:71], a[164:167], a[108:111], v[68:71]
M v[68:71], a[160:163], a[104:107], v[68:71]
M v[72:75], a[160:163], a[112:115], v[72:75]
 ds_read_b64_tr_b16 a[60:61], v4 offset:8192
 ds_read_b64_tr_b16 a[62:63], v4 offset:9216
M v[72:75], a[164:167], a[116:119], v[72:75]
M v[76:79], a[164:167], a[124:127], v[76:79]
 buffer_load_dwordx4 v11, s[16:19], s21 offen offset:3072  nt lds
M v[76:79], a[160:163], a[120:123], v[76:79]
 s_add_u32 s21, s21, 524160
M v[80:83], a[160:163], a[128:131], v[80:83]
M v[80:83], a[164:167], a[132:135], v[80:83]
M v[84:87], a[164:167], a[140:143], v[84:87]
M v[84:87], a[160:163], a[136:139], v[84:87]
M v[88:91], a[160:163], a[144:147], v[88:91]
M v[88:91], a[164:167], a[148:151], v[88:91]
 s_waitcnt lgkmcnt(2)
M v[92:95], a[164:167], a[156:159], v[92:95]
 s_waitcnt vmcnt(16) lgkmcnt(0)
M v[92:95], a[160:163], a[152:155], v[92:95]
 s_barrier
M v[96:99], a[168:171], a[96:99], v[96:99]
 ds_read_b128 a[160:163], v5 offset:49152
 ds_read_b128 a[164:167], v6 offset:49152
M v[96:99], a[172:175], a[100:103], v[96:99]
M v[100:103], a[172:175], a[108:111], v[100:103]
 s_add_u32 m0, s24, 32768
 ds_read_b64_tr_b16 a[64:65], v1 offset:16384
 ds_read_b64_tr_b16 a[66:67], v1 offset:17408
M v[100:103], a[168:171], a[104:107], v[100:103]
 buffer_load_dwordx4 v12, s[48:51], s22 offen offset:0   lds
M v[104:107], a[168:171], a[112:115], v[104:107]
 v_min_u32 v16, 40, v0
 v_lshlrev_b32 v16, 2, v16
M v[104:107], a[172:175], a[116:119], v[104:107]
 buffer_load_dword v17, v16, s[12:15], 0 offen sc1
M v[108:111], a[172:175], a[124:127], v[108:111]
M v[108:111], a[168:171], a[120:123], v[108:111]
M v[112:115], a[168:171], a[128:131], v[112:115]
M v[112:115], a[172:175], a[132:135], v[112:115]
 ds_read_b64_tr_b16 a[68:69], v1 offset:24576
 ds_read_b64_tr_b16 a[70:71], v1 offset:25600
M v[116:119], a[172:175], a[140:143], v[116:119]
 buffer_load_dwordx4 v13, s[48:51], s22 offen offset:1024   lds
M v[116:119], a[168:171], a[136:139], v[116:119]
M v[120:123], a[168:171], a[144:147], v[120:123]
M v[120:123], a[172:175], a[148:151], v[120:123]
 s_waitcnt lgkmcnt(4)
M v[124:127], a[172:175], a[156:159], v[124:127]
M v[124:127], a[168:171], a[152:155], v[124:127]
M v[128:131], a[160:163], a[96:99], v[128:131]
 ds_read_b128 a[168:171], v5 offset:51200
 ds_read_b128 a[172:175], v6 offset:51200
M v[128:131], a[164:167], a[100:103], v[128:131]
 ds_read_b64_tr_b16 a[72:73], v2 offset:16384
 ds_read_b64_tr_b16 a[74:75], v2 offset:17408
M v[132:135], a[164:167], a[108:111], v[132:135]
 buffer_load_dwordx4 v14, s[48:51], s22 offen offset:2048   lds
M v[132:135], a[160:163], a[104:107], v[132:135]
M v[136:139], a[160:163], a[112:115], v[136:139]
M v[136:139], a[164:167], a[116:119], v[136:139]
M v[140:143], a[164:167], a[124:127], v[140:143]
M v[140:143], a[160:163], a[120:123], v[140:143]
 ds_read_b64_tr_b16 a[76:77], v2 offset:24576
 ds_read_b64_tr_b16 a[78:79], v2 offset:25600
M v[144:147], a[160:163], a[128:131], v[144:147]
 buffer_load_dwordx4 v15, s[48:51], s22 offen offset:3072   lds
M v[144:147], a[164:167], a[132:135], v[144:147]
 s_add_u32 s22, s22, 2097152
M v[148:151], a[164:167], a[140:143], v[148:151]
M v[148:151], a[160:163], a[136:139], v[148:151]
M v[152:155], a[160:163], a[144:147], v[152:155]
M v[152:155], a[164:167], a[148:151], v[152:155]
 s_waitcnt lgkmcnt(4)
M v[156:159], a[164:167], a[156:159], v[156:159]
 s_add_u32 m0, s23, 0
 ds_read_b64_tr_b16 a[80:81], v3 offset:16384
 ds_read_b64_tr_b16 a[82:83], v3 offset:17408
M v[156:159], a[160:163], a[152:155], v[156:159]
 buffer_load_dwordx4 v8, s[16:19], s21 offen offset:0  nt lds
M v[160:163], a[168:171], a[96:99], v[160:163]
 ds_read_b128 a[160:163], v5 offset:53248
 ds_read_b128 a[164:167], v6 offset:53248
M v[160:163], a[172:175], a[100:103], v[160:163]
M v[164:167], a[172:175], a[108:111], v[164:167]
M v[164:167], a[168:171], a[104:107], v[164:167]
M v[168:171], a[168:171], a[112:115], v[168:171]
M v[168:171], a[172:175], a[116:119], v[168:171]
 ds_read_b64_tr_b16 a[84:85], v3 offset:24576
 ds_read_b64_tr_b16 a[86:87], v3 offset:25600
M v[172:175], a[172:175], a[124:127], v[172:175]
 buffer_load_dwordx4 v9, s[16:19], s21 offen offset:1024  nt lds
M v[172:175], a[168:171], a[120:123], v[172:175]
M v[176:179], a[168:171], a[128:131], v[176:179]
M v[176:179], a[172:175], a[132:135], v[176:179]
M v[180:183], a[172:175], a[140:143], v[180:183]
M v[180:183], a[168:171], a[136:139], v[180:183]
M v[184:187], a[168:171], a[144:147], v[184:187]
 ds_read_b64_tr_b16 a[88:89], v4 offset:16384
 ds_read_b64_tr_b16 a[90:91], v4 offset:17408
M v[184:187], a[172:175], a[148:151], v[184:187]
 s_waitcnt lgkmcnt(4)
 buffer_load_dwordx4 v10, s[16:19], s21 offen offset:2048  nt lds
M v[188:191], a[172:175], a[156:159], v[188:191]
M v[188:191], a[168:171], a[152:155], v[188:191]
M v[192:195], a[160:163], a[96:99], v[192:195]
 ds_read_b128 a[168:171], v5 offset:55296
 ds_read_b128 a[172:175], v6 offset:55296
M v[192:195], a[164:167], a[100:103], v[192:195]
M v[196:199], a[164:167], a[108:111], v[196:199]
M v[196:199], a[160:163], a[104:107], v[196:199]
 ds_read_b64_tr_b16 a[92:93], v4 offset:24576
 ds_read_b64_tr_b16 a[94:95], v4 offset:25600
M v[200:203], a[160:163], a[112:115], v[200:203]
 buffer_load_dwordx4 v11, s[16:19], s21 offen offset:3072  nt lds
M v[200:203], a[164:167], a[116:119], v[200:203]
 s_add_u32 s21, s21, 128
M v[204:207], a[164:167], a[124:127], v[204:207]
M v[204:207], a[160:163], a[120:123], v[204:207]
M v[208:211], a[160:163], a[128:131], v[208:211]
M v[208:211], a[164:167], a[132:135], v[208:211]
M v[212:215], a[164:167], a[140:143], v[212:215]
M v[212:215], a[160:163], a[136:139], v[212:215]
M v[216:219], a[160:163], a[144:147], v[216:219]
M v[216:219], a[164:167], a[148:151], v[216:219]
 s_waitcnt lgkmcnt(2)
M v[220:223], a[164:167], a[156:159], v[220:223]
 s_waitcnt vmcnt(17) lgkmcnt(0)
M v[220:223], a[160:163], a[152:155], v[220:223]
 s_barrier
M v[224:227], a[168:171], a[96:99], v[224:227]
 ds_read_b128 a[160:163], v5 offset:0
 ds_read_b128 a[164:167], v6 offset:0
M v[224:227], a[172:175], a[100:103], v[224:227]
M v[228:231], a[172:175], a[108:111], v[228:231]
M v[228:231], a[168:171], a[104:107], v[228:231]
M v[232:235], a[168:171], a[112:115], v[232:235]
M v[232:235], a[172:175], a[116:119], v[232:235]
M v[236:239], a[172:175], a[124:127], v[236:239]
M v[236:239], a[168:171], a[120:123], v[236:239]
M v[240:243], a[168:171], a[128:131], v[240:243]
M v[240:243], a[172:175], a[132:135], v[240:243]
M v[244:247], a[172:175], a[140:143], v[244:247]
M v[244:247], a[168:171], a[136:139], v[244:247]
M v[248:251], a[168:171], a[144:147], v[248:251]
M v[248:251], a[172:175], a[148:151], v[248:251]
 s_waitcnt lgkmcnt(0)
M v[252:255], a[172:175], a[156:159], v[252:255]
M v[252:255], a[168:171], a[152:155], v[252:255]
M a[0:3], a[160:163], a[32:35], a[0:3]
 ds_read_b128 a[168:171], v5 offset:2048
 ds_read_b128 a[172:175], v6 offset:2048
M a[0:3], a[164:167], a[36:39], a[0:3]
 ds_read_b64_tr_b16 a[96:97], v1 offset:32768
 ds_read_b64_tr_b16 a[98:99], v1 offset:33792
M a[4:7], a[164:167], a[44:47], a[4:7]
 s_add_u32 m0, s24, 49152
M a[4:7], a[160:163], a[40:43], a[4:7]
 buffer_load_dwordx4 v12, s[48:51], s22 offen offset:0   lds
M a[8:11], a[160:163], a[48:51], a[8:11]
M a[8:11], a[164:167], a[52:55], a[8:11]
M a[12:15], a[164:167], a[60:63], a[12:15]
 ds_read_b64_tr_b16 a[100:101], v1 offset:40960
 ds_read_b64_tr_b16 a[102:103], v1 offset:41984
M a[12:15], a[160:163], a[56:59], a[12:15]
M a[16:19], a[160:163], a[64:67], a[16:19]
 buffer_load_dwordx4 v13, s[48:51], s22 offen offset:1024   lds
M a[16:19], a[164:167], a[68:71], a[16:19]
M a[20:23], a[164:167], a[76:79], a[20:23]
M a[20:23], a[160:163], a[72:75], a[20:23]
 ds_read_b64_tr_b16 a[104:105], v2 offset:32768
 ds_read_b64_tr_b16 a[106:107], v2 offset:33792
M a[24:27], a[160:163], a[80:83], a[24:27]
M a[24:27], a[164:167], a[84:87], a[24:27]
 s_waitcnt lgkmcnt(6)
 buffer_load_dwordx4 v14, s[48:51], s22 offen offset:2048   lds
M a[28:31], a[164:167], a[92:95], a[28:31]
M a[28:31], a[160:163], a[88:91], a[28:31]
M v[32:35], a[168:171], a[32:35], v[32:35]
 ds_read_b128 a[160:163], v5 offset:4096
 ds_read_b128 a[164:167], v6 offset:4096
M v[32:35], a[172:175], a[36:39], v[32:35]
 ds_read_b64_tr_b16 a[108:109], v2 offset:40960
 ds_read_b64_tr_b16 a[110:111], v2 offset:41984
M v[36:39], a[172:175], a[44:47], v[36:39]
 buffer_load_dwordx4 v15, s[48:51], s22 offen offset:3072   lds
M v[36:39], a[168:171], a[40:43], v[36:39]
 s_sub_u32 s22, s22, 2097024
M v[40:43], a[168:171], a[48:51], v[40:43]
M v[40:43], a[172:175], a[52:55], v[40:43]
 ds_read_b64_tr_b16 a[112:113], v3 offset:32768
 ds_read_b64_tr_b16 a[114:115], v3 offset:33792
M v[44:47], a[172:175], a[60:63], v[44:47]
 s_add_u32 m0, s23, 16384
M v[44:47], a[168:171], a[56:59], v[44:47]
 buffer_load_dwordx4 v8, s[16:19], s21 offen offset:0  nt lds
M v[48:51], a[168:171], a[64:67], v[48:51]
M v[48:51], a[172:175], a[68:71], v[48:51]
M v[52:55], a[172:175], a[76:79], v[52:55]
 ds_read_b64_tr_b16 a[116:117], v3 offset:40960
 ds_read_b64_tr_b16 a[118:119], v3 offset:41984
M v[52:55], a[168:171], a[72:75], v[52:55]
M v[56:59], a[168:171], a[80:83], v[56:59]
 buffer_load_dwordx4 v9, s[16:19], s21 offen offset:1024  nt lds
M v[56:59], a[172:175], a[84:87], v[56:59]
 s_waitcnt lgkmcnt(6)
M v[60:63], a[172:175], a[92:95], v[60:63]
M v[60:63], a[168:171], a[88:91], v[60:63]
 ds_read_b64_tr_b16 a[120:121], v4 offset:32768
 ds_read_b64_tr_b16 a[122:123], v4 offset:33792
M v[64:67], a[160:163], a[32:35], v[64:67]
 ds_read_b128 a[168:171], v5 offset:6144
 ds_read_b128 a[172:175], v6 offset:6144
M v[64:67], a[164:167], a[36:39], v[64:67]
 buffer_load_dwordx4 v10, s[16:19], s21 offen offset:2048  nt lds
M v[68:71], a[164:167], a[44:47], v[68:71]
M v[68:71], a[160:163], a[40:43], v[68:71]
M v[72:75], a[160:163], a[48:51], v[72:75]
 ds_read_b64_tr_b16 a[124:125], v4 offset:40960
 ds_read_b64_tr_b16 a[126:127], v4 offset:41984
M v[72:75], a[164:167], a[52:55], v[72:75]
M v[76:79], a[164:167], a[60:63], v[76:79]
 buffer_load_dwordx4 v11, s[16:19], s21 offen offset:3072  nt lds
M v[76:79], a[160:163], a[56:59], v[76:79]
 s_add_u32 s21, s21, 524160
M v[80:83], a[160:163], a[64:67], v[80:83]
M v[80:83], a[164:167], a[68:71], v[80:83]
M v[84:87], a[164:167], a[76:79], v[84:87]
M v[84:87], a[160:163], a[72:75], v[84:87]
M v[88:91], a[160:163], a[80:83], v[88:91]
M v[88:91], a[164:167], a[84:87], v[88:91]
 s_waitcnt lgkmcnt(2)
M v[92:95], a[164:167], a[92:95], v[92:95]
 s_waitcnt vmcnt(17) lgkmcnt(0)
M v[92:95], a[160:163], a[88:91], v[92:95]
 s_barrier
M v[96:99], a[168:171], a[32:35], v[96:99]
 ds_read_b128 a[160:163], v5 offset:16384
 ds_read_b128 a[164:167], v6 offset:16384
M v[96:99], a[172:175], a[36:39], v[96:99]
M v[100:103], a[172:175], a[44:47], v[100:103]
 s_add_u32 m0, s24, 0
 ds_read_b64_tr_b16 a[128:129], v1 offset:49152
 ds_read_b64_tr_b16 a[130:131], v1 offset:50176
M v[100:103], a[168:171], a[40:43], v[100:103]
 buffer_load_dwordx4 v12, s[48:51], s22 offen offset:0   lds
M v[104:107], a[168:171], a[48:51], v[104:107]
M v[104:107], a[172:175], a[52:55], v[104:107]
M v[108:111], a[172:175], a[60:63], v[108:111]
M v[108:111], a[168:171], a[56:59], v[108:111]
M v[112:115], a[168:171], a[64:67], v[112:115]
M v[112:115], a[172:175], a[68:71], v[112:115]
 ds_read_b64_tr_b16 a[132:133], v1 offset:57344
 ds_read_b64_tr_b16 a[134:135], v1 offset:58368
M v[116:119], a[172:175], a[76:79], v[116:119]
 buffer_load_dwordx4 v13, s[48:51], s22 offen offset:1024   lds
M v[116:119], a[168:171], a[72:75], v[116:119]
M v[120:123], a[168:171], a[80:83], v[120:123]
M v[120:123], a[172:175], a[84:87], v[120:123]
 s_waitcnt lgkmcnt(4)
M v[124:127], a[172:175], a[92:95], v[124:127]
M v[124:127], a[168:171], a[88:91], v[124:127]
M v[128:131], a[160:163], a[32:35], v[128:131]
 ds_read_b128 a[168:171], v5 offset:18432
 ds_read_b128 a[172:175], v6 offset:18432
M v[128:131], a[164:167], a[36:39], v[128:131]
 ds_read_b64_tr_b16 a[136:137], v2 offset:49152
 ds_read_b64_tr_b16 a[138:139], v2 offset:50176
M v[132:135], a[164:167], a[44:47], v[132:135]
 buffer_load_dwordx4 v14, s[48:51], s22 offen offset:2048   lds
M v[132:135], a[160:163], a[40:43], v[132:135]
M v[136:139], a[160:163], a[48:51], v[136:139]
M v[136:139], a[164:167], a[52:55], v[136:139]
M v[140:143], a[164:167], a[60:63], v[140:143]
M v[140:143], a[160:163], a[56:59], v[140:143]
 ds_read_b64_tr_b16 a[140:141], v2 offset:57344
 ds_read_b64_tr_b16 a[142:143], v2 offset:58368
M v[144:147], a[160:163], a[64:67], v[144:147]
 buffer_load_dwordx4 v15, s[48:51], s22 offen offset:3072   lds
M v[144:147], a[164:167], a[68:71], v[144:147]
 s_add_u32 s22, s22, 2097152
M v[148:151], a[164:167], a[76:79], v[148:151]
M v[148:151], a[160:163], a[72:75], v[148:151]
M v[152:155], a[160:163], a[80:83], v[152:155]
M v[152:155], a[164:167], a[84:87], v[152:155]
 s_waitcnt lgkmcnt(4)
M v[156:159], a[164:167], a[92:95], v[156:159]
 s_add_u32 m0, s23, 32768
 ds_read_b64_tr_b16 a[144:145], v3 offset:49152
 ds_read_b64_tr_b16 a[146:147], v3 offset:50176
M v[156:159], a[160:163], a[88:91], v[156:159]
 buffer_load_dwordx4 v8, s[16:19], s21 offen offset:0  nt lds
M v[160:163], a[168:171], a[32:35], v[160:163]
 ds_read_b128 a[160:163], v5 offset:20480
 ds_read_b128 a[164:167], v6 offset:20480
M v[160:163], a[172:175], a[36:39], v[160:163]
M v[164:167], a[172:175], a[44:47], v[164:167]
M v[164:167], a[168:171], a[40:43], v[164:167]
M v[168:171], a[168:171], a[48:51], v[168:171]
M v[168:171], a[172:175], a[52:55], v[168:171]
 ds_read_b64_tr_b16 a[148:149], v3 offset:57344
 ds_read_b64_tr_b16 a[150:151], v3 offset:58368
M v[172:175], a[172:175], a[60:63], v[172:175]
 buffer_load_dwordx4 v9, s[16:19], s21 offen offset:1024  nt lds
M v[172:175], a[168:171], a[56:59], v[172:175]
M v[176:179], a[168:171], a[64:67], v[176:179]
M v[176:179], a[172:175], a[68:71], v[176:179]
M v[180:183], a[172:175], a[76:79], v[180:183]
M v[180:183], a[168:171], a[72:75], v[180:183]
M v[184:187], a[168:171], a[80:83], v[184:187]
 ds_read_b64_tr_b16 a[152:153], v4 offset:49152
 ds_read_b64_tr_b16 a[154:155], v4 offset:50176
M v[184:187], a[172:175], a[84:87], v[184:187]
 s_waitcnt lgkmcnt(4)
 buffer_load_dwordx4 v10, s[16:19], s21 offen offset:2048  nt lds
M v[188:191], a[172:175], a[92:95], v[188:191]
M v[188:191], a[168:171], a[88:91], v[188:191]
M v[192:195], a[160:163], a[32:35], v[192:195]
 ds_read_b128 a[168:171], v5 offset:22528
 ds_read_b128 a[172:175], v6 offset:22528
M v[192:195], a[164:167], a[36:39], v[192:195]
M v[196:199], a[164:167], a[44:47], v[196:199]
M v[196:199], a[160:163], a[40:43], v[196:199]
 ds_read_b64_tr_b16 a[156:157], v4 offset:57344
 ds_read_b64_tr_b16 a[158:159], v4 offset:58368
M v[200:203], a[160:163], a[48:51], v[200:203]
 buffer_load_dwordx4 v11, s[16:19], s21 offen offset:3072  nt lds
M v[200:203], a[164:167], a[52:55], v[200:203]
 s_add_u32 s21, s21, 128
M v[204:207], a[164:167], a[60:63], v[204:207]
M v[204:207], a[160:163], a[56:59], v[204:207]
M v[208:211], a[160:163], a[64:67], v[208:211]
M v[208:211], a[164:167], a[68:71], v[208:211]
M v[212:215], a[164:167], a[76:79], v[212:215]
M v[212:215], a[160:163], a[72:75], v[212:215]
M v[216:219], a[160:163], a[80:83], v[216:219]
M v[216:219], a[164:167], a[84:87], v[216:219]
 s_waitcnt lgkmcnt(2)
M v[220:223], a[164:167], a[92:95], v[220:223]
 s_waitcnt vmcnt(16) lgkmcnt(0)
M v[220:223], a[160:163], a[88:91], v[220:223]
 s_barrier
M v[224:227], a[168:171], a[32:35], v[224:227]
 ds_read_b128 a[160:163], v5 offset:32768
 ds_read_b128 a[164:167], v6 offset:32768
M v[224:227], a[172:175], a[36:39], v[224:227]
 v_cmp_ne_u32 vcc, 1, v17
M v[228:231], a[172:175], a[44:47], v[228:231]
 s_nop 0
 buffer_load_dword a240, v24, s[32:35], 0 offen offset:1024
M v[228:231], a[168:171], a[40:43], v[228:231]
 s_cbranch_vccnz L_zs1
L_zr1:
M v[232:235], a[168:171], a[48:51], v[232:235]
M v[232:235], a[172:175], a[52:55], v[232:235]
M v[236:239], a[172:175], a[60:63], v[236:239]
M v[236:239], a[168:171], a[56:59], v[236:239]
M v[240:243], a[168:171], a[64:67], v[240:243]
M v[240:243], a[172:175], a[68:71], v[240:243]
M v[244:247], a[172:175], a[76:79], v[244:247]
M v[244:247], a[168:171], a[72:75], v[244:247]
M v[248:251], a[168:171], a[80:83], v[248:251]
M v[248:251], a[172:175], a[84:87], v[248:251]
 s_waitcnt lgkmcnt(0)
M v[252:255], a[172:175], a[92:95], v[252:255]
M v[252:255], a[168:171], a[88:91], v[252:255]
M a[0:3], a[160:163], a[96:99], a[0:3]
 ds_read_b128 a[168:171], v5 offset:34816
 ds_read_b128 a[172:175], v6 offset:34816
M a[0:3], a[164:167], a[100:103], a[0:3]
 ds_read_b64_tr_b16 a[32:33], v1 offset:0
 ds_read_b64_tr_b16 a[34:35], v1 offset:1024
M a[4:7], a[164:167], a[108:111], a[4:7]
 s_add_u32 m0, s24, 16384
M a[4:7], a[160:163], a[104:107], a[4:7]
 buffer_load_dwordx4 v12, s[48:51], s22 offen offset:0   lds
M a[8:11], a[160:163], a[112:115], a[8:11]
M a[8:11], a[164:167], a[116:119], a[8:11]
M a[12:15], a[164:167], a[124:127], a[12:15]
 ds_read_b64_tr_b16 a[36:37], v1 offset:8192
 ds_read_b64_tr_b16 a[38:39], v1 offset:9216
M a[12:15], a[160:163], a[120:123], a[12:15]
M a[16:19], a[160:163], a[128:131], a[16:19]
 buffer_load_dwordx4 v13, s[48:51], s22 offen offset:1024   lds
M a[16:19], a[164:167], a[132:135], a[16:19]
M a[20:23], a[164:167], a[140:143], a[20:23]
M a[20:23], a[160:163], a[136:139], a[20:23]
 ds_read_b64_tr_b16 a[40:41], v2 offset:0
 ds_read_b64_tr_b16 a[42:43], v2 offset:1024
M a[24:27], a[160:163], a[144:147], a[24:27]
M a[24:27], a[164:167], a[148:151], a[24:27]
 s_waitcnt lgkmcnt(6)
 buffer_load_dwordx4 v14, s[48:51], s22 offen offset:2048   lds
M a[28:31], a[164:167], a[156:159], a[28:31]
M a[28:31], a[160:163], a[152:155], a[28:31]
M v[32:35], a[168:171], a[96:99], v[32:35]
 ds_read_b128 a[160:163], v5 offset:36864
 ds_read_b128 a[164:167], v6 offset:36864
M v[32:35], a[172:175], a[100:103], v[32:35]
 ds_read_b64_tr_b16 a[44:45], v2 offset:8192
 ds_read_b64_tr_b16 a[46:47], v2 offset:9216
M v[36:39], a[172:175], a[108:111], v[36:39]
 buffer_load_dwordx4 v15, s[48:51], s22 offen offset:3072   lds
M v[36:39], a[168:171], a[104:107], v[36:39]
 s_sub_u32 s22, s22, 2097024
M v[40:43], a[168:171], a[112:115], v[40:43]
M v[40:43], a[172:175], a[116:119], v[40:43]
 ds_read_b64_tr_b16 a[48:49], v3 offset:0
 ds_read_b64_tr_b16 a[50:51], v3 offset:1024
M v[44:47], a[172:175], a[124:127], v[44:47]
 s_add_u32 m0, s23, 49152
M v[44:47], a[168:171], a[120:123], v[44:47]
 buffer_load_dwordx4 v8, s[16:19], s21 offen offset:0  nt lds
M v[48:51], a[168:171], a[128:131], v[48:51]
M v[48:51], a[172:175], a[132:135], v[48:51]
M v[52:55], a[172:175], a[140:143], v[52:55]
 ds_read_b64_tr_b16 a[52:53], v3 offset:8192
 ds_read_b64_tr_b16 a[54:55], v3 offset:9216
M v[52:55], a[168:171], a[136:139], v[52:55]
M v[56:59], a[168:171], a[144:147], v[56:59]
 buffer_load_dwordx4 v9, s[16:19], s21 offen offset:1024  nt lds
M v[56:59], a[172:175], a[148:151], v[56:59]
 s_waitcnt lgkmcnt(6)
M v[60:63], a[172:175], a[156:159], v[60:63]
M v[60:63], a[168:171], a[152:155], v[60:63]
 ds_read_b64_tr_b16 a[56:57], v4 offset:0
 ds_read_b64_tr_b16 a[58:59], v4 offset:1024
M v[64:67], a[160:163], a[96:99], v[64:67]
 ds_read_b128 a[168:171], v5 offset:38912
 ds_read_b128 a[172:175], v6 offset:38912
M v[64:67], a[164:167], a[100:103], v[64:67]
 buffer_load_dwordx4 v10, s[16:19], s21 offen offset:2048  nt lds
M v[68:71], a[164:167], a[108:111], v[68:71]
M v[68:71], a[160:163], a[104:107], v[68:71]
M v[72:75], a[160:163], a[112:115], v[72:75]
 ds_read_b64_tr_b16 a[60:61], v4 offset:8192
 ds_read_b64_tr_b16 a[62:63], v4 offset:9216
M v[72:75], a[164:167], a[116:119], v[72:75]
M v[76:79], a[164:167], a[124:127], v[76:79]
 buffer_load_dwordx4 v11, s[16:19], s21 offen offset:3072  nt lds
M v[76:79], a[160:163], a[120:123], v[76:79]
 s_add_u32 s21, s21, 524160
M v[80:83], a[160:163], a[128:131], v[80:83]
M v[80:83], a[164:167], a[132:135], v[80:83]
M v[84:87], a[164:167], a[140:143], v[84:87]
M v[84:87], a[160:163], a[136:139], v[84:87]
 s_and_b32 s64, s42, 7
M v[88:91], a[160:163], a[144:147], v[88:91]
 s_lshl_b32 s72, s41, 3
 s_add_u32 s64, s64, s72
 s_lshl_b32 s64, s64, 2
M v[88:91], a[164:167], a[148:151], v[88:91]
 s_waitcnt lgkmcnt(2)
 s_add_u32 s64, s64, s20
 s_mul_i32 s67, s64, 7168
M v[92:95], a[164:167], a[156:159], v[92:95]
 s_waitcnt vmcnt(17) lgkmcnt(0)
 s_mul_i32 s86, s20, 7168
 s_add_u32 s86, s86, 131072
M v[92:95], a[160:163], a[152:155], v[92:95]
 s_barrier
M v[96:99], a[168:171], a[96:99], v[96:99]
 ds_read_b128 a[160:163], v5 offset:49152
 ds_read_b128 a[164:167], v6 offset:49152
M v[96:99], a[172:175], a[100:103], v[96:99]
M v[100:103], a[172:175], a[108:111], v[100:103]
 s_add_u32 m0, s24, 32768
 ds_read_b64_tr_b16 a[64:65], v1 offset:16384
 ds_read_b64_tr_b16 a[66:67], v1 offset:17408
M v[100:103], a[168:171], a[104:107], v[100:103]
 buffer_load_dwordx4 v12, s[48:51], s22 offen offset:0   lds
M v[104:107], a[168:171], a[112:115], v[104:107]
M v[104:107], a[172:175], a[116:119], v[104:107]
M v[108:111], a[172:175], a[124:127], v[108:111]
M v[108:111], a[168:171], a[120:123], v[108:111]
 buffer_load_dwordx4 v13, s[48:51], s22 offen offset:1024   lds
M v[112:115], a[168:171], a[128:131], v[112:115]
M v[112:115], a[172:175], a[132:135], v[112:115]
 ds_read_b64_tr_b16 a[68:69], v1 offset:24576
 ds_read_b64_tr_b16 a[70:71], v1 offset:25600
M v[116:119], a[172:175], a[140:143], v[116:119]
M v[116:119], a[168:171], a[136:139], v[116:119]
M v[120:123], a[168:171], a[144:147], v[120:123]
 buffer_load_dwordx4 v14, s[48:51], s22 offen offset:2048   lds
M v[120:123], a[172:175], a[148:151], v[120:123]
 s_waitcnt lgkmcnt(4)
M v[124:127], a[172:175], a[156:159], v[124:127]
M v[124:127], a[168:171], a[152:155], v[124:127]
M v[128:131], a[160:163], a[96:99], v[128:131]
 ds_read_b128 a[168:171], v5 offset:51200
 ds_read_b128 a[172:175], v6 offset:51200
M v[128:131], a[164:167], a[100:103], v[128:131]
 ds_read_b64_tr_b16 a[72:73], v2 offset:16384
 ds_read_b64_tr_b16 a[74:75], v2 offset:17408
M v[132:135], a[164:167], a[108:111], v[132:135]
 buffer_load_dwordx4 v15, s[48:51], s22 offen offset:3072   lds
M v[132:135], a[160:163], a[104:107], v[132:135]
 s_add_u32 s22, s22, 2097152
M v[136:139], a[160:163], a[112:115], v[136:139]
M v[136:139], a[164:167], a[116:119], v[136:139]
 s_add_u32 m0, s23, 0
M v[140:143], a[164:167], a[124:127], v[140:143]
 buffer_load_dwordx4 v8, s[16:19], s21 offen offset:0  nt lds
M v[140:143], a[160:163], a[120:123], v[140:143]
 ds_read_b64_tr_b16 a[76:77], v2 offset:24576
 ds_read_b64_tr_b16 a[78:79], v2 offset:25600
M v[144:147], a[160:163], a[128:131], v[144:147]
M v[144:147], a[164:167], a[132:135], v[144:147]
M v[148:151], a[164:167], a[140:143], v[148:151]
 buffer_load_dwordx4 v9, s[16:19], s21 offen offset:1024  nt lds
M v[148:151], a[160:163], a[136:139], v[148:151]
M v[152:155], a[160:163], a[144:147], v[152:155]
M v[152:155], a[164:167], a[148:151], v[152:155]
 s_waitcnt lgkmcnt(4)
M v[156:159], a[164:167], a[156:159], v[156:159]
 ds_read_b64_tr_b16 a[80:81], v3 offset:16384
 ds_read_b64_tr_b16 a[82:83], v3 offset:17408
M v[156:159], a[160:163], a[152:155], v[156:159]
 buffer_load_dwordx4 v10, s[16:19], s21 offen offset:2048  nt lds
M v[160:163], a[168:171], a[96:99], v[160:163]
 ds_read_b128 a[160:163], v5 offset:53248
 ds_read_b128 a[164:167], v6 offset:53248
M v[160:163], a[172:175], a[100:103], v[160:163]
M v[164:167], a[172:175], a[108:111], v[164:167]
M v[164:167], a[168:171], a[104:107], v[164:167]
M v[168:171], a[168:171], a[112:115], v[168:171]
 buffer_load_dwordx4 v11, s[16:19], s21 offen offset:3072  nt lds
M v[168:171], a[172:175], a[116:119], v[168:171]
 s_add_u32 s21, s21, 128
 ds_read_b64_tr_b16 a[84:85], v3 offset:24576
 ds_read_b64_tr_b16 a[86:87], v3 offset:25600
M v[172:175], a[172:175], a[124:127], v[172:175]
M v[172:175], a[168:171], a[120:123], v[172:175]
M v[176:179], a[168:171], a[128:131], v[176:179]
 s_add_u32 m0, s86, 0
M v[176:179], a[172:175], a[132:135], v[176:179]
 buffer_load_dwordx4 v7, s[60:63], s67 offen offset:0 nt lds
M v[180:183], a[172:175], a[140:143], v[180:183]
M v[180:183], a[168:171], a[136:139], v[180:183]
M v[184:187], a[168:171], a[144:147], v[184:187]
 ds_read_b64_tr_b16 a[88:89], v4 offset:16384
 ds_read_b64_tr_b16 a[90:91], v4 offset:17408
M v[184:187], a[172:175], a[148:151], v[184:187]
 s_waitcnt lgkmcnt(4)
 buffer_load_dwordx4 v7, s[60:63], s67 offen offset:1024 nt lds
M v[188:191], a[172:175], a[156:159], v[188:191]
M v[188:191], a[168:171], a[152:155], v[188:191]
M v[192:195], a[160:163], a[96:99], v[192:195]
 ds_read_b128 a[168:171], v5 offset:55296
 ds_read_b128 a[172:175], v6 offset:55296
M v[192:195], a[164:167], a[100:103], v[192:195]
M v[196:199], a[164:167], a[108:111], v[196:199]
 buffer_load_dwordx4 v7, s[60:63], s67 offen offset:2048 nt lds
M v[196:199], a[160:163], a[104:107], v[196:199]
 ds_read_b64_tr_b16 a[92:93], v4 offset:24576
 ds_read_b64_tr_b16 a[94:95], v4 offset:25600
M v[200:203], a[160:163], a[112:115], v[200:203]
M v[200:203], a[164:167], a[116:119], v[200:203]
M v[204:207], a[164:167], a[124:127], v[204:207]
M v[204:207], a[160:163], a[120:123], v[204:207]
 buffer_load_dwordx4 v7, s[60:63], s67 offen offset:3072 nt lds
M v[208:211], a[160:163], a[128:131], v[208:211]
 s_add_u32 s67, s67, 4096
M v[208:211], a[164:167], a[132:135], v[208:211]
M v[212:215], a[164:167], a[140:143], v[212:215]
M v[212:215], a[160:163], a[136:139], v[212:215]
M v[216:219], a[160:163], a[144:147], v[216:219]
M v[216:219], a[164:167], a[148:151], v[216:219]
 s_waitcnt lgkmcnt(2)
M v[220:223], a[164:167], a[156:159], v[220:223]
 s_waitcnt vmcnt(21) lgkmcnt(0)
M v[220:223], a[160:163], a[152:155], v[220:223]
 s_barrier
M v[224:227], a[168:171], a[96:99], v[224:227]
 ds_read_b128 a[160:163], v5 offset:0
 ds_read_b128 a[164:167], v6 offset:0
M v[224:227], a[172:175], a[100:103], v[224:227]
M v[228:231], a[172:175], a[108:111], v[228:231]
M v[228:231], a[168:171], a[104:107], v[228:231]
M v[232:235], a[168:171], a[112:115], v[232:235]
M v[232:235], a[172:175], a[116:119], v[232:235]
M v[236:239], a[172:175], a[124:127], v[236:239]
M v[236:239], a[168:171], a[120:123], v[236:239]
M v[240:243], a[168:171], a[128:131], v[240:243]
M v[240:243], a[172:175], a[132:135], v[240:243]
M v[244:247], a[172:175], a[140:143], v[244:247]
M v[244:247], a[168:171], a[136:139], v[244:247]
M v[248:251], a[168:171], a[144:147], v[248:251]
M v[248:251], a[172:175], a[148:151], v[248:251]
 s_waitcnt lgkmcnt(0)
M v[252:255], a[172:175], a[156:159], v[252:255]
M v[252:255], a[168:171], a[152:155], v[252:255]
M a[0:3], a[160:163], a[32:35], a[0:3]
 ds_read_b128 a[168:171], v5 offset:2048
 ds_read_b128 a[172:175], v6 offset:2048
M a[0:3], a[164:167], a[36:39], a[0:3]
 ds_read_b64_tr_b16 a[96:97], v1 offset:32768
 ds_read_b64_tr_b16 a[98:99], v1 offset:33792
M a[4:7], a[164:167], a[44:47], a[4:7]
 s_add_u32 m0, s24, 49152
M a[4:7], a[160:163], a[40:43], a[4:7]
 buffer_load_dwordx4 v12, s[48:51], s22 offen offset:0   lds
M a[8:11], a[160:163], a[48:51], a[8:11]
M a[8:11], a[164:167], a[52:55], a[8:11]
M a[12:15], a[164:167], a[60:63], a[12:15]
 ds_read_b64_tr_b16 a[100:101], v1 offset:40960
 ds_read_b64_tr_b16 a[102:103], v1 offset:41984
M a[12:15], a[160:163], a[56:59], a[12:15]
M a[16:19], a[160:163], a[64:67], a[16:19]
 buffer_load_dwordx4 v13, s[48:51], s22 offen offset:1024   lds
M a[16:19], a[164:167], a[68:71], a[16:19]
M a[20:23], a[164:167], a[76:79], a[20:23]
M a[20:23], a[160:163], a[72:75], a[20:23]
 ds_read_b64_tr_b16 a[104:105], v2 offset:32768
 ds_read_b64_tr_b16 a[106:107], v2 offset:33792
M a[24:27], a[160:163], a[80:83], a[24:27]
M a[24:27], a[164:167], a[84:87], a[24:27]
 s_waitcnt lgkmcnt(6)
 buffer_load_dwordx4 v14, s[48:51], s22 offen offset:2048   lds
M a[28:31], a[164:167], a[92:95], a[28:31]
M a[28:31], a[160:163], a[88:91], a[28:31]
M v[32:35], a[168:171], a[32:35], v[32:35]
 ds_read_b128 a[160:163], v5 offset:4096
 ds_read_b128 a[164:167], v6 offset:4096
M v[32:35], a[172:175], a[36:39], v[32:35]
 ds_read_b64_tr_b16 a[108:109], v2 offset:40960
 ds_read_b64_tr_b16 a[110:111], v2 offset:41984
M v[36:39], a[172:175], a[44:47], v[36:39]
 buffer_load_dwordx4 v15, s[48:51], s22 offen offset:3072   lds
M v[36:39], a[168:171], a[40:43], v[36:39]
 s_sub_u32 s22, s22, 2097024
M v[40:43], a[168:171], a[48:51], v[40:43]
M v[40:43], a[172:175], a[52:55], v[40:43]
 ds_read_b64_tr_b16 a[112:113], v3 offset:32768
 ds_read_b64_tr_b16 a[114:115], v3 offset:33792
M v[44:47], a[172:175], a[60:63], v[44:47]
 s_add_u32 m0, s23, 16384
M v[44:47], a[168:171], a[56:59], v[44:47]
 buffer_load_dwordx4 v8, s[16:19], s21 offen offset:0  nt lds
M v[48:51], a[168:171], a[64:67], v[48:51]
M v[48:51], a[172:175], a[68:71], v[48:51]
M v[52:55], a[172:175], a[76:79], v[52:55]
 ds_read_b64_tr_b16 a[116:117], v3 offset:40960
 ds_read_b64_tr_b16 a[118:119], v3 offset:41984
M v[52:55], a[168:171], a[72:75], v[52:55]
M v[56:59], a[168:171], a[80:83], v[56:59]
 buffer_load_dwordx4 v9, s[16:19], s21 offen offset:1024  nt lds
M v[56:59], a[172:175], a[84:87], v[56:59]
 s_waitcnt lgkmcnt(6)
M v[60:63], a[172:175], a[92:95], v[60:63]
M v[60:63], a[168:171], a[88:91], v[60:63]
 ds_read_b64_tr_b16 a[120:121], v4 offset:32768
 ds_read_b64_tr_b16 a[122:123], v4 offset:33792
M v[64:67], a[160:163], a[32:35], v[64:67]
 ds_read_b128 a[168:171], v5 offset:6144
 ds_read_b128 a[172:175], v6 offset:6144
M v[64:67], a[164:167], a[36:39], v[64:67]
 buffer_load_dwordx4 v10, s[16:19], s21 offen offset:2048  nt lds
M v[68:71], a[164:167], a[44:47], v[68:71]
M v[68:71], a[160:163], a[40:43], v[68:71]
M v[72:75], a[160:163], a[48:51], v[72:75]
 ds_read_b64_tr_b16 a[124:125], v4 offset:40960
 ds_read_b64_tr_b16 a[126:127], v4 offset:41984
M v[72:75], a[164:167], a[52:55], v[72:75]
M v[76:79], a[164:167], a[60:63], v[76:79]
 buffer_load_dwordx4 v11, s[16:19], s21 offen offset:3072  nt lds
M v[76:79], a[160:163], a[56:59], v[76:79]
 s_add_u32 s21, s21, 524160
M v[80:83], a[160:163], a[64:67], v[80:83]
M v[80:83], a[164:167], a[68:71], v[80:83]
M v[84:87], a[164:167], a[76:79], v[84:87]
M v[84:87], a[160:163], a[72:75], v[84:87]
M v[88:91], a[160:163], a[80:83], v[88:91]
M v[88:91], a[164:167], a[84:87], v[88:91]
 s_waitcnt lgkmcnt(2)
M v[92:95], a[164:167], a[92:95], v[92:95]
 s_waitcnt vmcnt(20) lgkmcnt(0)
M v[92:95], a[160:163], a[88:91], v[92:95]
 s_barrier
M v[96:99], a[168:171], a[32:35], v[96:99]
 ds_read_b128 a[160:163], v5 offset:16384
 ds_read_b128 a[164:167], v6 offset:16384
M v[96:99], a[172:175], a[36:39], v[96:99]
M v[100:103], a[172:175], a[44:47], v[100:103]
 s_add_u32 m0, s24, 0
 ds_read_b64_tr_b16 a[128:129], v1 offset:49152
 ds_read_b64_tr_b16 a[130:131], v1 offset:50176
M v[100:103], a[168:171], a[40:43], v[100:103]
 buffer_load_dwordx4 v12, s[48:51], s22 offen offset:0   lds
M v[104:107], a[168:171], a[48:51], v[104:107]
M v[104:107], a[172:175], a[52:55], v[104:107]
M v[108:111], a[172:175], a[60:63], v[108:111]
M v[108:111], a[168:171], a[56:59], v[108:111]
M v[112:115], a[168:171], a[64:67], v[112:115]
 buffer_load_dwordx4 v13, s[48:51], s22 offen offset:1024   lds
M v[112:115], a[172:175], a[68:71], v[112:115]
 ds_read_b64_tr_b16 a[132:133], v1 offset:57344
 ds_read_b64_tr_b16 a[134:135], v1 offset:58368
M v[116:119], a[172:175], a[76:79], v[116:119]
M v[116:119], a[168:171], a[72:75], v[116:119]
M v[120:123], a[168:171], a[80:83], v[120:123]
M v[120:123], a[172:175], a[84:87], v[120:123]
 s_waitcnt lgkmcnt(4)
 buffer_load_dwordx4 v14, s[48:51], s22 offen offset:2048   lds
M v[124:127], a[172:175], a[92:95], v[124:127]
M v[124:127], a[168:171], a[88:91], v[124:127]
M v[128:131], a[160:163], a[32:35], v[128:131]
 ds_read_b128 a[168:171], v5 offset:18432
 ds_read_b128 a[172:175], v6 offset:18432
M v[128:131], a[164:167], a[36:39], v[128:131]
 ds_read_b64_tr_b16 a[136:137], v2 offset:49152
 ds_read_b64_tr_b16 a[138:139], v2 offset:50176
M v[132:135], a[164:167], a[44:47], v[132:135]
 buffer_load_dwordx4 v15, s[48:51], s22 offen offset:3072   lds
M v[132:135], a[160:163], a[40:43], v[132:135]
 s_add_u32 s22, s22, 2097152
M v[136:139], a[160:163], a[48:51], v[136:139]
M v[136:139], a[164:167], a[52:55], v[136:139]
M v[140:143], a[164:167], a[60:63], v[140:143]
 s_add_u32 m0, s23, 32768
M v[140:143], a[160:163], a[56:59], v[140:143]
 ds_read_b64_tr_b16 a[140:141], v2 offset:57344
 ds_read_b64_tr_b16 a[142:143], v2 offset:58368
M v[144:147], a[160:163], a[64:67], v[144:147]
 buffer_load_dwordx4 v8, s[16:19], s21 offen offset:0  nt lds
M v[144:147], a[164:167], a[68:71], v[144:147]
M v[148:151], a[164:167], a[76:79], v[148:151]
M v[148:151], a[160:163], a[72:75], v[148:151]
M v[152:155], a[160:163], a[80:83], v[152:155]
 buffer_load_dwordx4 v9, s[16:19], s21 offen offset:1024  nt lds
M v[152:155], a[164:167], a[84:87], v[152:155]
 s_waitcnt lgkmcnt(4)
M v[156:159], a[164:167], a[92:95], v[156:159]
 ds_read_b64_tr_b16 a[144:145], v3 offset:49152
 ds_read_b64_tr_b16 a[146:147], v3 offset:50176
M v[156:159], a[160:163], a[88:91], v[156:159]
M v[160:163], a[168:171], a[32:35], v[160:163]
 ds_read_b128 a[160:163], v5 offset:20480
 ds_read_b128 a[164:167], v6 offset:20480
M v[160:163], a[172:175], a[36:39], v[160:163]
M v[164:167], a[172:175], a[44:47], v[164:167]
 buffer_load_dwordx4 v10, s[16:19], s21 offen offset:2048  nt lds
M v[164:167], a[168:171], a[40:43], v[164:167]
M v[168:171], a[168:171], a[48:51], v[168:171]
M v[168:171], a[172:175], a[52:55], v[168:171]
 ds_read_b64_tr_b16 a[148:149], v3 offset:57344
 ds_read_b64_tr_b16 a[150:151], v3 offset:58368
M v[172:175], a[172:175], a[60:63], v[172:175]
M v[172:175], a[168:171], a[56:59], v[172:175]
 buffer_load_dwordx4 v11, s[16:19], s21 offen offset:3072  nt lds
M v[176:179], a[168:171], a[64:67], v[176:179]
 s_add_u32 s21, s21, 128
M v[176:179], a[172:175], a[68:71], v[176:179]
M v[180:183], a[172:175], a[76:79], v[180:183]
M v[180:183], a[168:171], a[72:75], v[180:183]
 s_add_u32 m0, s86, 4096
M v[184:187], a[168:171], a[80:83], v[184:187]
 ds_read_b64_tr_b16 a[152:153], v4 offset:49152
 ds_read_b64_tr_b16 a[154:155], v4 offset:50176
M v[184:187], a[172:175], a[84:87], v[184:187]
 s_waitcnt lgkmcnt(4)
 buffer_load_dwordx4 v7, s[60:63], s67 offen offset:0 nt lds
M v[188:191], a[172:175], a[92:95], v[188:191]
M v[188:191], a[168:171], a[88:91], v[188:191]
M v[192:195], a[160:163], a[32:35], v[192:195]
 ds_read_b128 a[168:171], v5 offset:22528
 ds_read_b128 a[172:175], v6 offset:22528
M v[192:195], a[164:167], a[36:39], v[192:195]
 buffer_load_dwordx4 v7, s[60:63], s67 offen offset:1024 nt lds
M v[196:199], a[164:167], a[44:47], v[196:199]
M v[196:199], a[160:163], a[40:43], v[196:199]
 ds_read_b64_tr_b16 a[156:157], v4 offset:57344
 ds_read_b64_tr_b16 a[158:159], v4 offset:58368
M v[200:203], a[160:163], a[48:51], v[200:203]
M v[200:203], a[164:167], a[52:55], v[200:203]
M v[204:207], a[164:167], a[60:63], v[204:207]
 buffer_load_dwordx4 v7, s[60:63], s67 offen offset:2048 nt lds
M v[204:207], a[160:163], a[56:59], v[204:207]
 s_add_u32 s67, s67, 4096
M v[208:211], a[160:163], a[64:67], v[208:211]
M v[208:211], a[164:167], a[68:71], v[208:211]
M v[212:215], a[164:167], a[76:79], v[212:215]
M v[212:215], a[160:163], a[72:75], v[212:215]
M v[216:219], a[160:163], a[80:83], v[216:219]
M v[216:219], a[164:167], a[84:87], v[216:219]
 s_waitcnt lgkmcnt(2)
M v[220:223], a[164:167], a[92:95], v[220:223]
 s_waitcnt vmcnt(23) lgkmcnt(0)
M v[220:223], a[160:163], a[88:91], v[220:223]
 s_barrier
M v[224:227], a[168:171], a[32:35], v[224:227]
 ds_read_b128 a[160:163], v5 offset:32768
 ds_read_b128 a[164:167], v6 offset:32768
M v[224:227], a[172:175], a[36:39], v[224:227]
 v_lshl_add_u32 v27, v0, 7, s95
 v_and_b32 v26, 48, v0
M v[228:231], a[172:175], a[44:47], v[228:231]
 v_lshl_add_u32 v26, v26, 24, v27
M v[228:231], a[168:171], a[40:43], v[228:231]
 buffer_load_dword a240, v26, s[76:79], 0 offen offset:0
M v[232:235], a[168:171], a[48:51], v[232:235]
M v[232:235], a[172:175], a[52:55], v[232:235]
M v[236:239], a[172:175], a[60:63], v[236:239]
M v[236:239], a[168:171], a[56:59], v[236:239]
M v[240:243], a[168:171], a[64:67], v[240:243]
M v[240:243], a[172:175], a[68:71], v[240:243]
M v[244:247], a[172:175], a[76:79], v[244:247]
M v[244:247], a[168:171], a[72:75], v[244:247]
M v[248:251], a[168:171], a[80:83], v[248:251]
M v[248:251], a[172:175], a[84:87], v[248:251]
 s_waitcnt lgkmcnt(0)
M v[252:255], a[172:175], a[92:95], v[252:255]
M v[252:255], a[168:171], a[88:91], v[252:255]
M a[0:3], a[160:163], a[96:99], a[0:3]
 ds_read_b128 a[168:171], v5 offset:34816
 ds_read_b128 a[172:175], v6 offset:34816
M a[0:3], a[164:167], a[100:103], a[0:3]
 ds_read_b64_tr_b16 a[32:33], v1 offset:0
 ds_read_b64_tr_b16 a[34:35], v1 offset:1024
M a[4:7], a[164:167], a[108:111], a[4:7]
 s_add_u32 m0, s24, 16384
M a[4:7], a[160:163], a[104:107], a[4:7]
 buffer_load_dwordx4 v12, s[48:51], s22 offen offset:0   lds
M a[8:11], a[160:163], a[112:115], a[8:11]
M a[8:11], a[164:167], a[116:119], a[8:11]
M a[12:15], a[164:167], a[124:127], a[12:15]
 ds_read_b64_tr_b16 a[36:37], v1 offset:8192
 ds_read_b64_tr_b16 a[38:39], v1 offset:9216
M a[12:15], a[160:163], a[120:123], a[12:15]
M a[16:19], a[160:163], a[128:131], a[16:19]
 buffer_load_dwordx4 v13, s[48:51], s22 offen offset:1024   lds
M a[16:19], a[164:167], a[132:135], a[16:19]
M a[20:23], a[164:167], a[140:143], a[20:23]
M a[20:23], a[160:163], a[136:139], a[20:23]
 ds_read_b64_tr_b16 a[40:41], v2 offset:0
 ds_read_b64_tr_b16 a[42:43], v2 offset:1024
M a[24:27], a[160:163], a[144:147], a[24:27]
M a[24:27], a[164:167], a[148:151], a[24:27]
 s_waitcnt lgkmcnt(6)
 buffer_load_dwordx4 v14, s[48:51], s22 offen offset:2048   lds
M a[28:31], a[164:167], a[156:159], a[28:31]
M a[28:31], a[160:163], a[152:155], a[28:31]
M v[32:35], a[168:171], a[96:99], v[32:35]
 ds_read_b128 a[160:163], v5 offset:36864
 ds_read_b128 a[164:167], v6 offset:36864
M v[32:35], a[172:175], a[100:103], v[32:35]
 ds_read_b64_tr_b16 a[44:45], v2 offset:8192
 ds_read_b64_tr_b16 a[46:47], v2 offset:9216
M v[36:39], a[172:175], a[108:111], v[36:39]
 buffer_load_dwordx4 v15, s[48:51], s22 offen offset:3072   lds
M v[36:39], a[168:171], a[104:107], v[36:39]
 s_sub_u32 s22, s22, 2097024
M v[40:43], a[168:171], a[112:115], v[40:43]
M v[40:43], a[172:175], a[116:119], v[40:43]
 ds_read_b64_tr_b16 a[48:49], v3 offset:0
 ds_read_b64_tr_b16 a[50:51], v3 offset:1024
M v[44:47], a[172:175], a[124:127], v[44:47]
 s_add_u32 m0, s23, 49152
M v[44:47], a[168:171], a[120:123], v[44:47]
 buffer_load_dwordx4 v8, s[16:19], s21 offen offset:0  nt lds
M v[48:51], a[168:171], a[128:131], v[48:51]
M v[48:51], a[172:175], a[132:135], v[48:51]
M v[52:55], a[172:175], a[140:143], v[52:55]
 ds_read_b64_tr_b16 a[52:53], v3 offset:8192
 ds_read_b64_tr_b16 a[54:55], v3 offset:9216
M v[52:55], a[168:171], a[136:139], v[52:55]
M v[56:59], a[168:171], a[144:147], v[56:59]
 buffer_load_dwordx4 v9, s[16:19], s21 offen offset:1024  nt lds
M v[56:59], a[172:175], a[148:151], v[56:59]
 s_waitcnt lgkmcnt(6)
M v[60:63], a[172:175], a[156:159], v[60:63]
M v[60:63], a[168:171], a[152:155], v[60:63]
 ds_read_b64_tr_b16 a[56:57], v4 offset:0
 ds_read_b64_tr_b16 a[58:59], v4 offset:1024
M v[64:67], a[160:163], a[96:99], v[64:67]
 ds_read_b128 a[168:171], v5 offset:38912
 ds_read_b128 a[172:175], v6 offset:38912
M v[64:67], a[164:167], a[100:103], v[64:67]
 buffer_load_dwordx4 v10, s[16:19], s21 offen offset:2048  nt lds
M v[68:71], a[164:167], a[108:111], v[68:71]
M v[68:71], a[160:163], a[104:107], v[68:71]
M v[72:75], a[160:163], a[112:115], v[72:75]
 ds_read_b64_tr_b16 a[60:61], v4 offset:8192
 ds_read_b64_tr_b16 a[62:63], v4 offset:9216
M v[72:75], a[164:167], a[116:119], v[72:75]
M v[76:79], a[164:167], a[124:127], v[76:79]
 buffer_load_dwordx4 v11, s[16:19], s21 offen offset:3072  nt lds
M v[76:79], a[160:163], a[120:123], v[76:79]
 s_add_u32 s21, s21, 524160
M v[80:83], a[160:163], a[128:131], v[80:83]
M v[80:83], a[164:167], a[132:135], v[80:83]
M v[84:87], a[164:167], a[140:143], v[84:87]
M v[84:87], a[160:163], a[136:139], v[84:87]
M v[88:91], a[160:163], a[144:147], v[88:91]
M v[88:91], a[164:167], a[148:151], v[88:91]
 s_waitcnt lgkmcnt(2)
M v[92:95], a[164:167], a[156:159], v[92:95]
 s_waitcnt vmcnt(20) lgkmcnt(0)
M v[92:95], a[160:163], a[152:155], v[92:95]
 s_barrier
M v[96:99], a[168:171], a[96:99], v[96:99]
 ds_read_b128 a[160:163], v5 offset:49152
 ds_read_b128 a[164:167], v6 offset:49152
M v[96:99], a[172:175], a[100:103], v[96:99]
M v[100:103], a[172:175], a[108:111], v[100:103]
 s_add_u32 m0, s24, 32768
 ds_read_b64_tr_b16 a[64:65], v1 offset:16384
 ds_read_b64_tr_b16 a[66:67], v1 offset:17408
M v[100:103], a[168:171], a[104:107], v[100:103]
 buffer_load_dwordx4 v12, s[48:51], s22 offen offset:0   lds
M v[104:107], a[168:171], a[112:115], v[104:107]
M v[104:107], a[172:175], a[116:119], v[104:107]
M v[108:111], a[172:175], a[124:127], v[108:111]
M v[108:111], a[168:171], a[120:123], v[108:111]
M v[112:115], a[168:171], a[128:131], v[112:115]
M v[112:115], a[172:175], a[132:135], v[112:115]
 ds_read_b64_tr_b16 a[68:69], v1 offset:24576
 ds_read_b64_tr_b16 a[70:71], v1 offset:25600
M v[116:119], a[172:175], a[140:143], v[116:119]
 buffer_load_dwordx4 v13, s[48:51], s22 offen offset:1024   lds
M v[116:119], a[168:171], a[136:139], v[116:119]
M v[120:123], a[168:171], a[144:147], v[120:123]
M v[120:123], a[172:175], a[148:151], v[120:123]
 s_waitcnt lgkmcnt(4)
M v[124:127], a[172:175], a[156:159], v[124:127]
M v[124:127], a[168:171], a[152:155], v[124:127]
M v[128:131], a[160:163], a[96:99], v[128:131]
 ds_read_b128 a[168:171], v5 offset:51200
 ds_read_b128 a[172:175], v6 offset:51200
M v[128:131], a[164:167], a[100:103], v[128:131]
 ds_read_b64_tr_b16 a[72:73], v2 offset:16384
 ds_read_b64_tr_b16 a[74:75], v2 offset:17408
M v[132:135], a[164:167], a[108:111], v[132:135]
 buffer_load_dwordx4 v14, s[48:51], s22 offen offset:2048   lds
M v[132:135], a[160:163], a[104:107], v[132:135]
M v[136:139], a[160:163], a[112:115], v[136:139]
M v[136:139], a[164:167], a[116:119], v[136:139]
M v[140:143], a[164:167], a[124:127], v[140:143]
M v[140:143], a[160:163], a[120:123], v[140:143]
 ds_read_b64_tr_b16 a[76:77], v2 offset:24576
 ds_read_b64_tr_b16 a[78:79], v2 offset:25600
M v[144:147], a[160:163], a[128:131], v[144:147]
 buffer_load_dwordx4 v15, s[48:51], s22 offen offset:3072   lds
M v[144:147], a[164:167], a[132:135], v[144:147]
 s_add_u32 s22, s22, 2097152
M v[148:151], a[164:167], a[140:143], v[148:151]
M v[148:151], a[160:163], a[136:139], v[148:151]
M v[152:155], a[160:163], a[144:147], v[152:155]
M v[152:155], a[164:167], a[148:151], v[152:155]
 s_waitcnt lgkmcnt(4)
M v[156:159], a[164:167], a[156:159], v[156:159]
 s_add_u32 m0, s23, 0
 ds_read_b64_tr_b16 a[80:81], v3 offset:16384
 ds_read_b64_tr_b16 a[82:83], v3 offset:17408
M v[156:159], a[160:163], a[152:155], v[156:159]
 buffer_load_dwordx4 v8, s[16:19], s21 offen offset:0  nt lds
M v[160:163], a[168:171], a[96:99], v[160:163]
 ds_read_b128 a[160:163], v5 offset:53248
 ds_read_b128 a[164:167], v6 offset:53248
M v[160:163], a[172:175], a[100:103], v[160:163]
M v[164:167], a[172:175], a[108:111], v[164:167]
M v[164:167], a[168:171], a[104:107], v[164:167]
M v[168:171], a[168:171], a[112:115], v[168:171]
M v[168:171], a[172:175], a[116:119], v[168:171]
 ds_read_b64_tr_b16 a[84:85], v3 offset:24576
 ds_read_b64_tr_b16 a[86:87], v3 offset:25600
M v[172:175], a[172:175], a[124:127], v[172:175]
 buffer_load_dwordx4 v9, s[16:19], s21 offen offset:1024  nt lds
M v[172:175], a[168:171], a[120:123], v[172:175]
M v[176:179], a[168:171], a[128:131], v[176:179]
M v[176:179], a[172:175], a[132:135], v[176:179]
M v[180:183], a[172:175], a[140:143], v[180:183]
M v[180:183], a[168:171], a[136:139], v[180:183]
M v[184:187], a[168:171], a[144:147], v[184:187]
 ds_read_b64_tr_b16 a[88:89], v4 offset:16384
 ds_read_b64_tr_b16 a[90:91], v4 offset:17408
M v[184:187], a[172:175], a[148:151], v[184:187]
 s_waitcnt lgkmcnt(4)
 buffer_load_dwordx4 v10, s[16:19], s21 offen offset:2048  nt lds
M v[188:191], a[172:175], a[156:159], v[188:191]
M v[188:191], a[168:171], a[152:155], v[188:191]
M v[192:195], a[160:163], a[96:99], v[192:195]
 ds_read_b128 a[168:171], v5 offset:55296
 ds_read_b128 a[172:175], v6 offset:55296
M v[192:195], a[164:167], a[100:103], v[192:195]
M v[196:199], a[164:167], a[108:111], v[196:199]
M v[196:199], a[160:163], a[104:107], v[196:199]
 ds_read_b64_tr_b16 a[92:93], v4 offset:24576
 ds_read_b64_tr_b16 a[94:95], v4 offset:25600
M v[200:203], a[160:163], a[112:115], v[200:203]
 buffer_load_dwordx4 v11, s[16:19], s21 offen offset:3072  nt lds
M v[200:203], a[164:167], a[116:119], v[200:203]
 s_add_u32 s21, s21, 128
M v[204:207], a[164:167], a[124:127], v[204:207]
M v[204:207], a[160:163], a[120:123], v[204:207]
M v[208:211], a[160:163], a[128:131], v[208:211]
M v[208:211], a[164:167], a[132:135], v[208:211]
M v[212:215], a[164:167], a[140:143], v[212:215]
M v[212:215], a[160:163], a[136:139], v[212:215]
M v[216:219], a[160:163], a[144:147], v[216:219]
M v[216:219], a[164:167], a[148:151], v[216:219]
 s_waitcnt lgkmcnt(2)
M v[220:223], a[164:167], a[156:159], v[220:223]
 s_waitcnt vmcnt(17) lgkmcnt(0)
M v[220:223], a[160:163], a[152:155], v[220:223]
 s_barrier
M v[224:227], a[168:171], a[96:99], v[224:227]
 ds_read_b128 a[160:163], v5 offset:0
 ds_read_b128 a[164:167], v6 offset:0
M v[224:227], a[172:175], a[100:103], v[224:227]
M v[228:231], a[172:175], a[108:111], v[228:231]
M v[228:231], a[168:171], a[104:107], v[228:231]
M v[232:235], a[168:171], a[112:115], v[232:235]
M v[232:235], a[172:175], a[116:119], v[232:235]
M v[236:239], a[172:175], a[124:127], v[236:239]
M v[236:239], a[168:171], a[120:123], v[236:239]
M v[240:243], a[168:171], a[128:131], v[240:243]
M v[240:243], a[172:175], a[132:135], v[240:243]
M v[244:247], a[172:175], a[140:143], v[244:247]
M v[244:247], a[168:171], a[136:139], v[244:247]
M v[248:251], a[168:171], a[144:147], v[248:251]
M v[248:251], a[172:175], a[148:151], v[248:251]
 s_waitcnt lgkmcnt(0)
M v[252:255], a[172:175], a[156:159], v[252:255]
M v[252:255], a[168:171], a[152:155], v[252:255]
M a[0:3], a[160:163], a[32:35], a[0:3]
 ds_read_b128 a[168:171], v5 offset:2048
 ds_read_b128 a[172:175], v6 offset:2048
M a[0:3], a[164:167], a[36:39], a[0:3]
 ds_read_b64_tr_b16 a[96:97], v1 offset:32768
 ds_read_b64_tr_b16 a[98:99], v1 offset:33792
M a[4:7], a[164:167], a[44:47], a[4:7]
 s_add_u32 m0, s24, 49152
 v_lshrrev_b32 v28, 2, v0
M a[4:7], a[160:163], a[40:43], a[4:7]
 buffer_load_dwordx4 v12, s[48:51], s22 offen offset:0   lds
M a[8:11], a[160:163], a[48:51], a[8:11]
 v_mul_u32_u24 v28, 896, v28
M a[8:11], a[164:167], a[52:55], a[8:11]
M a[12:15], a[164:167], a[60:63], a[12:15]
 ds_read_b64_tr_b16 a[100:101], v1 offset:40960
 ds_read_b64_tr_b16 a[102:103], v1 offset:41984
M a[12:15], a[160:163], a[56:59], a[12:15]
 v_and_b32 v29, 3, v0
M a[16:19], a[160:163], a[64:67], a[16:19]
 buffer_load_dwordx4 v13, s[48:51], s22 offen offset:1024   lds
M a[16:19], a[164:167], a[68:71], a[16:19]
 v_lshl_add_u32 v28, v29, 4, v28
M a[20:23], a[164:167], a[76:79], a[20:23]
M a[20:23], a[160:163], a[72:75], a[20:23]
 s_lshr_b32 s64, s20, 1
 ds_read_b64_tr_b16 a[104:105], v2 offset:32768
 ds_read_b64_tr_b16 a[106:107], v2 offset:33792
M a[24:27], a[160:163], a[80:83], a[24:27]
 s_lshl_b32 s64, s64, 6
 s_and_b32 s72, s20, 1
 s_lshl_b32 s72, s72, 3
M a[24:27], a[164:167], a[84:87], a[24:27]
 s_waitcnt lgkmcnt(6)
 buffer_load_dwordx4 v14, s[48:51], s22 offen offset:2048   lds
M a[28:31], a[164:167], a[92:95], a[28:31]
 s_add_u32 s64, s64, s72
M a[28:31], a[160:163], a[88:91], a[28:31]
 s_add_u32 s64, s64, 131072
 v_add_u32 v28, s64, v28
M v[32:35], a[168:171], a[32:35], v[32:35]
 ds_read_b128 a[160:163], v5 offset:4096
 ds_read_b128 a[164:167], v6 offset:4096
M v[32:35], a[172:175], a[36:39], v[32:35]
 s_lshl_b32 s94, s41, 18
 ds_read_b64_tr_b16 a[108:109], v2 offset:40960
 ds_read_b64_tr_b16 a[110:111], v2 offset:41984
M v[36:39], a[172:175], a[44:47], v[36:39]
 s_and_b32 s64, s42, 7
 buffer_load_dwordx4 v15, s[48:51], s22 offen offset:3072   lds
M v[36:39], a[168:171], a[40:43], v[36:39]
 s_sub_u32 s22, s22, 2097024
 s_lshl_b32 s64, s64, 10
M v[40:43], a[168:171], a[48:51], v[40:43]
 s_add_u32 s94, s94, s64
M v[40:43], a[172:175], a[52:55], v[40:43]
 s_lshl_b32 s64, s20, 13
 ds_read_b64_tr_b16 a[112:113], v3 offset:32768
 ds_read_b64_tr_b16 a[114:115], v3 offset:33792
M v[44:47], a[172:175], a[60:63], v[44:47]
 s_add_u32 m0, s23, 16384
 s_add_u32 s94, s94, s64
M v[44:47], a[168:171], a[56:59], v[44:47]
 s_add_u32 s94, s94, 100663296
 buffer_load_dwordx4 v8, s[16:19], s21 offen offset:0  nt lds
M v[48:51], a[168:171], a[64:67], v[48:51]
 ds_read_b64_tr_b16 a[192:193], v28 offset:0
M v[48:51], a[172:175], a[68:71], v[48:51]
M v[52:55], a[172:175], a[76:79], v[52:55]
 ds_read_b64_tr_b16 a[116:117], v3 offset:40960
 ds_read_b64_tr_b16 a[118:119], v3 offset:41984
M v[52:55], a[168:171], a[72:75], v[52:55]
 ds_read_b64_tr_b16 a[194:195], v28 offset:14336
M v[56:59], a[168:171], a[80:83], v[56:59]
 buffer_load_dwordx4 v9, s[16:19], s21 offen offset:1024  nt lds
M v[56:59], a[172:175], a[84:87], v[56:59]
 s_waitcnt lgkmcnt(8)
 ds_read_b64_tr_b16 a[196:197], v28 offset:128
M v[60:63], a[172:175], a[92:95], v[60:63]
M v[60:63], a[168:171], a[88:91], v[60:63]
 ds_read_b64_tr_b16 a[120:121], v4 offset:32768
 ds_read_b64_tr_b16 a[122:123], v4 offset:33792
M v[64:67], a[160:163], a[32:35], v[64:67]
 ds_read_b128 a[168:171], v5 offset:6144
 ds_read_b128 a[172:175], v6 offset:6144
M v[64:67], a[164:167], a[36:39], v[64:67]
 buffer_load_dwordx4 v10, s[16:19], s21 offen offset:2048  nt lds
M v[68:71], a[164:167], a[44:47], v[68:71]
 ds_read_b64_tr_b16 a[198:199], v28 offset:14464
M v[68:71], a[160:163], a[40:43], v[68:71]
M v[72:75], a[160:163], a[48:51], v[72:75]
 ds_read_b64_tr_b16 a[124:125], v4 offset:40960
 ds_read_b64_tr_b16 a[126:127], v4 offset:41984
M v[72:75], a[164:167], a[52:55], v[72:75]
 ds_read_b64_tr_b16 a[200:201], v28 offset:256
M v[76:79], a[164:167], a[60:63], v[76:79]
 buffer_load_dwordx4 v11, s[16:19], s21 offen offset:3072  nt lds
M v[76:79], a[160:163], a[56:59], v[76:79]
 s_add_u32 s21, s21, 524160
 ds_read_b64_tr_b16 a[202:203], v28 offset:14592
M v[80:83], a[160:163], a[64:67], v[80:83]
M v[80:83], a[164:167], a[68:71], v[80:83]
 ds_read_b64_tr_b16 a[204:205], v28 offset:384
M v[84:87], a[164:167], a[76:79], v[84:87]
M v[84:87], a[160:163], a[72:75], v[84:87]
 ds_read_b64_tr_b16 a[206:207], v28 offset:14720
M v[88:91], a[160:163], a[80:83], v[88:91]
M v[88:91], a[164:167], a[84:87], v[88:91]
 s_waitcnt lgkmcnt(7)
 ds_read_b64_tr_b16 a[208:209], v28 offset:512
M v[92:95], a[164:167], a[92:95], v[92:95]
 s_waitcnt vmcnt(16) lgkmcnt(0)
M v[92:95], a[160:163], a[88:91], v[92:95]
 s_barrier
M v[96:99], a[168:171], a[32:35], v[96:99]
 ds_read_b128 a[160:163], v5 offset:16384
 ds_read_b128 a[164:167], v6 offset:16384
M v[96:99], a[172:175], a[36:39], v[96:99]
 ds_read_b64_tr_b16 a[210:211], v28 offset:14848
M v[100:103], a[172:175], a[44:47], v[100:103]
 s_add_u32 m0, s24, 0
 ds_read_b64_tr_b16 a[128:129], v1 offset:49152
 ds_read_b64_tr_b16 a[130:131], v1 offset:50176
M v[100:103], a[168:171], a[40:43], v[100:103]
 buffer_load_dwordx4 v12, s[48:51], s22 offen offset:0   lds
M v[104:107], a[168:171], a[48:51], v[104:107]
 ds_read_b64_tr_b16 a[212:213], v28 offset:640
M v[104:107], a[172:175], a[52:55], v[104:107]
M v[108:111], a[172:175], a[60:63], v[108:111]
 ds_read_b64_tr_b16 a[214:215], v28 offset:14976
M v[108:111], a[168:171], a[56:59], v[108:111]
M v[112:115], a[168:171], a[64:67], v[112:115]
 ds_read_b64_tr_b16 a[216:217], v28 offset:768
M v[112:115], a[172:175], a[68:71], v[112:115]
 ds_read_b64_tr_b16 a[132:133], v1 offset:57344
 ds_read_b64_tr_b16 a[134:135], v1 offset:58368
M v[116:119], a[172:175], a[76:79], v[116:119]
 buffer_load_dwordx4 v13, s[48:51], s22 offen offset:1024   lds
M v[116:119], a[168:171], a[72:75], v[116:119]
 ds_read_b64_tr_b16 a[218:219], v28 offset:15104
M v[120:123], a[168:171], a[80:83], v[120:123]
M v[120:123], a[172:175], a[84:87], v[120:123]
 s_waitcnt lgkmcnt(9)
M v[124:127], a[172:175], a[92:95], v[124:127]
M v[124:127], a[168:171], a[88:91], v[124:127]
M v[128:131], a[160:163], a[32:35], v[128:131]
 ds_read_b128 a[168:171], v5 offset:18432
 ds_read_b128 a[172:175], v6 offset:18432
M v[128:131], a[164:167], a[36:39], v[128:131]
 ds_read_b64_tr_b16 a[136:137], v2 offset:49152
 ds_read_b64_tr_b16 a[138:139], v2 offset:50176
M v[132:135], a[164:167], a[44:47], v[132:135]
 buffer_load_dwordx4 v14, s[48:51], s22 offen offset:2048   lds
M v[132:135], a[160:163], a[40:43], v[132:135]
M v[136:139], a[160:163], a[48:51], v[136:139]
M v[136:139], a[164:167], a[52:55], v[136:139]
M v[140:143], a[164:167], a[60:63], v[140:143]
M v[140:143], a[160:163], a[56:59], v[140:143]
 ds_read_b64_tr_b16 a[140:141], v2 offset:57344
 ds_read_b64_tr_b16 a[142:143], v2 offset:58368
M v[144:147], a[160:163], a[64:67], v[144:147]
 buffer_load_dwordx4 v15, s[48:51], s22 offen offset:3072   lds
M v[144:147], a[164:167], a[68:71], v[144:147]
 s_add_u32 s22, s22, 2097152
M v[148:151], a[164:167], a[76:79], v[148:151]
M v[148:151], a[160:163], a[72:75], v[148:151]
M v[152:155], a[160:163], a[80:83], v[152:155]
M v[152:155], a[164:167], a[84:87], v[152:155]
 s_waitcnt lgkmcnt(4)
M v[156:159], a[164:167], a[92:95], v[156:159]
 s_add_u32 m0, s23, 32768
 ds_read_b64_tr_b16 a[144:145], v3 offset:49152
 ds_read_b64_tr_b16 a[146:147], v3 offset:50176
M v[156:159], a[160:163], a[88:91], v[156:159]
 buffer_load_dwordx4 v8, s[16:19], s21 offen offset:0  nt lds
M v[160:163], a[168:171], a[32:35], v[160:163]
 ds_read_b128 a[160:163], v5 offset:20480
 ds_read_b128 a[164:167], v6 offset:20480
M v[160:163], a[172:175], a[36:39], v[160:163]
M v[164:167], a[172:175], a[44:47], v[164:167]
M v[164:167], a[168:171], a[40:43], v[164:167]
M v[168:171], a[168:171], a[48:51], v[168:171]
M v[168:171], a[172:175], a[52:55], v[168:171]
 ds_read_b64_tr_b16 a[148:149], v3 offset:57344
 ds_read_b64_tr_b16 a[150:151], v3 offset:58368
M v[172:175], a[172:175], a[60:63], v[172:175]
 buffer_load_dwordx4 v9, s[16:19], s21 offen offset:1024  nt lds
M v[172:175], a[168:171], a[56:59], v[172:175]
M v[176:179], a[168:171], a[64:67], v[176:179]
M v[176:179], a[172:175], a[68:71], v[176:179]
M v[180:183], a[172:175], a[76:79], v[180:183]
M v[180:183], a[168:171], a[72:75], v[180:183]
M v[184:187], a[168:171], a[80:83], v[184:187]
 ds_read_b64_tr_b16 a[152:153], v4 offset:49152
 ds_read_b64_tr_b16 a[154:155], v4 offset:50176
M v[184:187], a[172:175], a[84:87], v[184:187]
 s_waitcnt lgkmcnt(4)
 buffer_load_dwordx4 v10, s[16:19], s21 offen offset:2048  nt lds
M v[188:191], a[172:175], a[92:95], v[188:191]
M v[188:191], a[168:171], a[88:91], v[188:191]
M v[192:195], a[160:163], a[32:35], v[192:195]
 ds_read_b128 a[168:171], v5 offset:22528
 ds_read_b128 a[172:175], v6 offset:22528
M v[192:195], a[164:167], a[36:39], v[192:195]
M v[196:199], a[164:167], a[44:47], v[196:199]
M v[196:199], a[160:163], a[40:43], v[196:199]
 ds_read_b64_tr_b16 a[156:157], v4 offset:57344
 ds_read_b64_tr_b16 a[158:159], v4 offset:58368
M v[200:203], a[160:163], a[48:51], v[200:203]
 buffer_load_dwordx4 v11, s[16:19], s21 offen offset:3072  nt lds
M v[200:203], a[164:167], a[52:55], v[200:203]
 s_add_u32 s21, s21, 128
M v[204:207], a[164:167], a[60:63], v[204:207]
M v[204:207], a[160:163], a[56:59], v[204:207]
M v[208:211], a[160:163], a[64:67], v[208:211]
M v[208:211], a[164:167], a[68:71], v[208:211]
M v[212:215], a[164:167], a[76:79], v[212:215]
M v[212:215], a[160:163], a[72:75], v[212:215]
M v[216:219], a[160:163], a[80:83], v[216:219]
M v[216:219], a[164:167], a[84:87], v[216:219]
 s_waitcnt lgkmcnt(2)
M v[220:223], a[164:167], a[92:95], v[220:223]
 s_waitcnt vmcnt(16) lgkmcnt(0)
M v[220:223], a[160:163], a[88:91], v[220:223]
 s_barrier
M v[224:227], a[168:171], a[32:35], v[224:227]
 ds_read_b128 a[160:163], v5 offset:32768
 ds_read_b128 a[164:167], v6 offset:32768
M v[224:227], a[172:175], a[36:39], v[224:227]
 buffer_load_dword a240, v24, s[32:35], 0 offen offset:1536
M v[228:231], a[172:175], a[44:47], v[228:231]
M v[228:231], a[168:171], a[40:43], v[228:231]
M v[232:235], a[168:171], a[48:51], v[232:235]
M v[232:235], a[172:175], a[52:55], v[232:235]
M v[236:239], a[172:175], a[60:63], v[236:239]
M v[236:239], a[168:171], a[56:59], v[236:239]
M v[240:243], a[168:171], a[64:67], v[240:243]
M v[240:243], a[172:175], a[68:71], v[240:243]
M v[244:247], a[172:175], a[76:79], v[244:247]
M v[244:247], a[168:171], a[72:75], v[244:247]
M v[248:251], a[168:171], a[80:83], v[248:251]
M v[248:251], a[172:175], a[84:87], v[248:251]
 s_waitcnt lgkmcnt(0)
M v[252:255], a[172:175], a[92:95], v[252:255]
M v[252:255], a[168:171], a[88:91], v[252:255]
M a[0:3], a[160:163], a[96:99], a[0:3]
 ds_read_b128 a[168:171], v5 offset:34816
 ds_read_b128 a[172:175], v6 offset:34816
M a[0:3], a[164:167], a[100:103], a[0:3]
 ds_read_b64_tr_b16 a[32:33], v1 offset:0
 ds_read_b64_tr_b16 a[34:35], v1 offset:1024
M a[4:7], a[164:167], a[108:111], a[4:7]
 s_add_u32 m0, s24, 16384
M a[4:7], a[160:163], a[104:107], a[4:7]
 buffer_load_dwordx4 v12, s[48:51], s22 offen offset:0   lds
M a[8:11], a[160:163], a[112:115], a[8:11]
M a[8:11], a[164:167], a[116:119], a[8:11]
M a[12:15], a[164:167], a[124:127], a[12:15]
 ds_read_b64_tr_b16 a[36:37], v1 offset:8192
 ds_read_b64_tr_b16 a[38:39], v1 offset:9216
M a[12:15], a[160:163], a[120:123], a[12:15]
M a[16:19], a[160:163], a[128:131], a[16:19]
 buffer_load_dwordx4 v13, s[48:51], s22 offen offset:1024   lds
M a[16:19], a[164:167], a[132:135], a[16:19]
M a[20:23], a[164:167], a[140:143], a[20:23]
M a[20:23], a[160:163], a[136:139], a[20:23]
 ds_read_b64_tr_b16 a[40:41], v2 offset:0
 ds_read_b64_tr_b16 a[42:43], v2 offset:1024
M a[24:27], a[160:163], a[144:147], a[24:27]
M a[24:27], a[164:167], a[148:151], a[24:27]
 s_waitcnt lgkmcnt(6)
 buffer_load_dwordx4 v14, s[48:51], s22 offen offset:2048   lds
M a[28:31], a[164:167], a[156:159], a[28:31]
M a[28:31], a[160:163], a[152:155], a[28:31]
M v[32:35], a[168:171], a[96:99], v[32:35]
 ds_read_b128 a[160:163], v5 offset:36864
 ds_read_b128 a[164:167], v6 offset:36864
M v[32:35], a[172:175], a[100:103], v[32:35]
 ds_read_b64_tr_b16 a[44:45], v2 offset:8192
 ds_read_b64_tr_b16 a[46:47], v2 offset:9216
M v[36:39], a[172:175], a[108:111], v[36:39]
 buffer_load_dwordx4 v15, s[48:51], s22 offen offset:3072   lds
M v[36:39], a[168:171], a[104:107], v[36:39]
 s_sub_u32 s22, s22, 2097024
M v[40:43], a[168:171], a[112:115], v[40:43]
M v[40:43], a[172:175], a[116:119], v[40:43]
 ds_read_b64_tr_b16 a[48:49], v3 offset:0
 ds_read_b64_tr_b16 a[50:51], v3 offset:1024
M v[44:47], a[172:175], a[124:127], v[44:47]
 s_add_u32 m0, s23, 49152
M v[44:47], a[168:171], a[120:123], v[44:47]
 buffer_load_dwordx4 v8, s[16:19], s21 offen offset:0  nt lds
M v[48:51], a[168:171], a[128:131], v[48:51]
M v[48:51], a[172:175], a[132:135], v[48:51]
M v[52:55], a[172:175], a[140:143], v[52:55]
 ds_read_b64_tr_b16 a[52:53], v3 offset:8192
 ds_read_b64_tr_b16 a[54:55], v3 offset:9216
M v[52:55], a[168:171], a[136:139], v[52:55]
M v[56:59], a[168:171], a[144:147], v[56:59]
 buffer_load_dwordx4 v9, s[16:19], s21 offen offset:1024  nt lds
M v[56:59], a[172:175], a[148:151], v[56:59]
 s_waitcnt lgkmcnt(6)
M v[60:63], a[172:175], a[156:159], v[60:63]
M v[60:63], a[168:171], a[152:155], v[60:63]
 ds_read_b64_tr_b16 a[56:57], v4 offset:0
 ds_read_b64_tr_b16 a[58:59], v4 offset:1024
M v[64:67], a[160:163], a[96:99], v[64:67]
 ds_read_b128 a[168:171], v5 offset:38912
 ds_read_b128 a[172:175], v6 offset:38912
M v[64:67], a[164:167], a[100:103], v[64:67]
 buffer_load_dwordx4 v10, s[16:19], s21 offen offset:2048  nt lds
M v[68:71], a[164:167], a[108:111], v[68:71]
M v[68:71], a[160:163], a[104:107], v[68:71]
M v[72:75], a[160:163], a[112:115], v[72:75]
 ds_read_b64_tr_b16 a[60:61], v4 offset:8192
 ds_read_b64_tr_b16 a[62:63], v4 offset:9216
M v[72:75], a[164:167], a[116:119], v[72:75]
M v[76:79], a[164:167], a[124:127], v[76:79]
 buffer_load_dwordx4 v11, s[16:19], s21 offen offset:3072  nt lds
M v[76:79], a[160:163], a[120:123], v[76:79]
 s_add_u32 s21, s21, 524160
M v[80:83], a[160:163], a[128:131], v[80:83]
M v[80:83], a[164:167], a[132:135], v[80:83]
M v[84:87], a[164:167], a[140:143], v[84:87]
M v[84:87], a[160:163], a[136:139], v[84:87]
M v[88:91], a[160:163], a[144:147], v[88:91]
M v[88:91], a[164:167], a[148:151], v[88:91]
 s_waitcnt lgkmcnt(2)
M v[92:95], a[164:167], a[156:159], v[92:95]
 s_waitcnt vmcnt(17) lgkmcnt(0)
M v[92:95], a[160:163], a[152:155], v[92:95]
 s_barrier
M v[96:99], a[168:171], a[96:99], v[96:99]
 ds_read_b128 a[160:163], v5 offset:49152
 ds_read_b128 a[164:167], v6 offset:49152
M v[96:99], a[172:175], a[100:103], v[96:99]
M v[100:103], a[172:175], a[108:111], v[100:103]
 s_add_u32 m0, s24, 32768
 ds_read_b64_tr_b16 a[64:65], v1 offset:16384
 ds_read_b64_tr_b16 a[66:67], v1 offset:17408
M v[100:103], a[168:171], a[104:107], v[100:103]
 buffer_load_dwordx4 v12, s[48:51], s22 offen offset:0   lds
M v[104:107], a[168:171], a[112:115], v[104:107]
M v[104:107], a[172:175], a[116:119], v[104:107]
M v[108:111], a[172:175], a[124:127], v[108:111]
M v[108:111], a[168:171], a[120:123], v[108:111]
M v[112:115], a[168:171], a[128:131], v[112:115]
M v[112:115], a[172:175], a[132:135], v[112:115]
 ds_read_b64_tr_b16 a[68:69], v1 offset:24576
 ds_read_b64_tr_b16 a[70:71], v1 offset:25600
M v[116:119], a[172:175], a[140:143], v[116:119]
 buffer_load_dwordx4 v13, s[48:51], s22 offen offset:1024   lds
M v[116:119], a[168:171], a[136:139], v[116:119]
M v[120:123], a[168:171], a[144:147], v[120:123]
 s_and_b32 s64, s42, 7
 s_lshl_b32 s64, s64, 2
M v[120:123], a[172:175], a[148:151], v[120:123]
 s_waitcnt lgkmcnt(4)
 s_add_u32 s64, s64, s20
M v[124:127], a[172:175], a[156:159], v[124:127]
 s_mul_i32 s64, s64, 114688
 v_bfe_u32 v28, v0, 2, 2
 v_and_b32 v29, 3, v0
M v[124:127], a[168:171], a[152:155], v[124:127]
 v_lshlrev_b32 v29, 7, v29
 v_lshl_add_u32 v28, v28, 13, v29
M v[128:131], a[160:163], a[96:99], v[128:131]
 ds_read_b128 a[168:171], v5 offset:51200
 ds_read_b128 a[172:175], v6 offset:51200
M v[128:131], a[164:167], a[100:103], v[128:131]
 ds_read_b64_tr_b16 a[72:73], v2 offset:16384
 ds_read_b64_tr_b16 a[74:75], v2 offset:17408
M v[132:135], a[164:167], a[108:111], v[132:135]
 buffer_load_dwordx4 v14, s[48:51], s22 offen offset:2048   lds
M v[132:135], a[160:163], a[104:107], v[132:135]
 v_add_u32 v23, s64, v28
 v_and_b32 v28, 48, v0
M v[136:139], a[160:163], a[112:115], v[136:139]
 v_lshl_add_u32 v23, v28, 24, v23
M v[136:139], a[164:167], a[116:119], v[136:139]
M v[140:143], a[164:167], a[124:127], v[140:143]
M v[140:143], a[160:163], a[120:123], v[140:143]
 ds_read_b64_tr_b16 a[76:77], v2 offset:24576
 ds_read_b64_tr_b16 a[78:79], v2 offset:25600
M v[144:147], a[160:163], a[128:131], v[144:147]
 buffer_load_dwordx4 v15, s[48:51], s22 offen offset:3072   lds
M v[144:147], a[164:167], a[132:135], v[144:147]
 s_add_u32 s22, s22, 2097152
M v[148:151], a[164:167], a[140:143], v[148:151]
M v[148:151], a[160:163], a[136:139], v[148:151]
M v[152:155], a[160:163], a[144:147], v[152:155]
M v[152:155], a[164:167], a[148:151], v[152:155]
 s_waitcnt lgkmcnt(4)
M v[156:159], a[164:167], a[156:159], v[156:159]
 s_add_u32 m0, s23, 0
 ds_read_b64_tr_b16 a[80:81], v3 offset:16384
 ds_read_b64_tr_b16 a[82:83], v3 offset:17408
M v[156:159], a[160:163], a[152:155], v[156:159]
 buffer_load_dwordx4 v8, s[16:19], s21 offen offset:0  nt lds
M v[160:163], a[168:171], a[96:99], v[160:163]
 ds_read_b128 a[160:163], v5 offset:53248
 ds_read_b128 a[164:167], v6 offset:53248
M v[160:163], a[172:175], a[100:103], v[160:163]
M v[164:167], a[172:175], a[108:111], v[164:167]
M v[164:167], a[168:171], a[104:107], v[164:167]
M v[168:171], a[168:171], a[112:115], v[168:171]
M v[168:171], a[172:175], a[116:119], v[168:171]
 ds_read_b64_tr_b16 a[84:85], v3 offset:24576
 ds_read_b64_tr_b16 a[86:87], v3 offset:25600
M v[172:175], a[172:175], a[124:127], v[172:175]
 buffer_load_dwordx4 v9, s[16:19], s21 offen offset:1024  nt lds
M v[172:175], a[168:171], a[120:123], v[172:175]
M v[176:179], a[168:171], a[128:131], v[176:179]
M v[176:179], a[172:175], a[132:135], v[176:179]
M v[180:183], a[172:175], a[140:143], v[180:183]
M v[180:183], a[168:171], a[136:139], v[180:183]
M v[184:187], a[168:171], a[144:147], v[184:187]
 ds_read_b64_tr_b16 a[88:89], v4 offset:16384
 ds_read_b64_tr_b16 a[90:91], v4 offset:17408
M v[184:187], a[172:175], a[148:151], v[184:187]
 s_waitcnt lgkmcnt(4)
 buffer_load_dwordx4 v10, s[16:19], s21 offen offset:2048  nt lds
M v[188:191], a[172:175], a[156:159], v[188:191]
M v[188:191], a[168:171], a[152:155], v[188:191]
M v[192:195], a[160:163], a[96:99], v[192:195]
 ds_read_b128 a[168:171], v5 offset:55296
 ds_read_b128 a[172:175], v6 offset:55296
M v[192:195], a[164:167], a[100:103], v[192:195]
M v[196:199], a[164:167], a[108:111], v[196:199]
M v[196:199], a[160:163], a[104:107], v[196:199]
 ds_read_b64_tr_b16 a[92:93], v4 offset:24576
 ds_read_b64_tr_b16 a[94:95], v4 offset:25600
M v[200:203], a[160:163], a[112:115], v[200:203]
 buffer_load_dwordx4 v11, s[16:19], s21 offen offset:3072  nt lds
M v[200:203], a[164:167], a[116:119], v[200:203]
 s_add_u32 s21, s21, 128
M v[204:207], a[164:167], a[124:127], v[204:207]
M v[204:207], a[160:163], a[120:123], v[204:207]
M v[208:211], a[160:163], a[128:131], v[208:211]
M v[208:211], a[164:167], a[132:135], v[208:211]
M v[212:215], a[164:167], a[140:143], v[212:215]
M v[212:215], a[160:163], a[136:139], v[212:215]
M v[216:219], a[160:163], a[144:147], v[216:219]
M v[216:219], a[164:167], a[148:151], v[216:219]
 s_waitcnt lgkmcnt(2)
M v[220:223], a[164:167], a[156:159], v[220:223]
 s_waitcnt vmcnt(17) lgkmcnt(0)
M v[220:223], a[160:163], a[152:155], v[220:223]
 s_barrier
M v[224:227], a[168:171], a[96:99], v[224:227]
 ds_read_b128 a[160:163], v5 offset:0
 ds_read_b128 a[164:167], v6 offset:0
M v[224:227], a[172:175], a[100:103], v[224:227]
 buffer_load_dword a240, v23, s[52:55], 0 offen offset:0
M v[228:231], a[172:175], a[108:111], v[228:231]
 v_add_u32 v23, 32768, v23
M v[228:231], a[168:171], a[104:107], v[228:231]
M v[232:235], a[168:171], a[112:115], v[232:235]
M v[232:235], a[172:175], a[116:119], v[232:235]
M v[236:239], a[172:175], a[124:127], v[236:239]
M v[236:239], a[168:171], a[120:123], v[236:239]
M v[240:243], a[168:171], a[128:131], v[240:243]
M v[240:243], a[172:175], a[132:135], v[240:243]
M v[244:247], a[172:175], a[140:143], v[244:247]
M v[244:247], a[168:171], a[136:139], v[244:247]
M v[248:251], a[168:171], a[144:147], v[248:251]
M v[248:251], a[172:175], a[148:151], v[248:251]
 s_waitcnt lgkmcnt(0)
M v[252:255], a[172:175], a[156:159], v[252:255]
M v[252:255], a[168:171], a[152:155], v[252:255]
M a[0:3], a[160:163], a[32:35], a[0:3]
 ds_read_b128 a[168:171], v5 offset:2048
 ds_read_b128 a[172:175], v6 offset:2048
M a[0:3], a[164:167], a[36:39], a[0:3]
 ds_read_b64_tr_b16 a[96:97], v1 offset:32768
 ds_read_b64_tr_b16 a[98:99], v1 offset:33792
M a[4:7], a[164:167], a[44:47], a[4:7]
 s_add_u32 m0, s24, 49152
M a[4:7], a[160:163], a[40:43], a[4:7]
 buffer_load_dwordx4 v12, s[48:51], s22 offen offset:0   lds
M a[8:11], a[160:163], a[48:51], a[8:11]
M a[8:11], a[164:167], a[52:55], a[8:11]
M a[12:15], a[164:167], a[60:63], a[12:15]
 ds_read_b64_tr_b16 a[100:101], v1 offset:40960
 ds_read_b64_tr_b16 a[102:103], v1 offset:41984
M a[12:15], a[160:163], a[56:59], a[12:15]
M a[16:19], a[160:163], a[64:67], a[16:19]
 buffer_load_dwordx4 v13, s[48:51], s22 offen offset:1024   lds
M a[16:19], a[164:167], a[68:71], a[16:19]
M a[20:23], a[164:167], a[76:79], a[20:23]
M a[20:23], a[160:163], a[72:75], a[20:23]
 ds_read_b64_tr_b16 a[104:105], v2 offset:32768
 ds_read_b64_tr_b16 a[106:107], v2 offset:33792
M a[24:27], a[160:163], a[80:83], a[24:27]
M a[24:27], a[164:167], a[84:87], a[24:27]
 s_waitcnt lgkmcnt(6)
 buffer_load_dwordx4 v14, s[48:51], s22 offen offset:2048   lds
M a[28:31], a[164:167], a[92:95], a[28:31]
M a[28:31], a[160:163], a[88:91], a[28:31]
M v[32:35], a[168:171], a[32:35], v[32:35]
 ds_read_b128 a[160:163], v5 offset:4096
 ds_read_b128 a[164:167], v6 offset:4096
M v[32:35], a[172:175], a[36:39], v[32:35]
 ds_read_b64_tr_b16 a[108:109], v2 offset:40960
 ds_read_b64_tr_b16 a[110:111], v2 offset:41984
M v[36:39], a[172:175], a[44:47], v[36:39]
 buffer_load_dwordx4 v15, s[48:51], s22 offen offset:3072   lds
M v[36:39], a[168:171], a[40:43], v[36:39]
 s_sub_u32 s22, s22, 2097024
M v[40:43], a[168:171], a[48:51], v[40:43]
M v[40:43], a[172:175], a[52:55], v[40:43]
 ds_read_b64_tr_b16 a[112:113], v3 offset:32768
 ds_read_b64_tr_b16 a[114:115], v3 offset:33792
M v[44:47], a[172:175], a[60:63], v[44:47]
 s_add_u32 m0, s23, 16384
M v[44:47], a[168:171], a[56:59], v[44:47]
 buffer_load_dwordx4 v8, s[16:19], s21 offen offset:0  nt lds
M v[48:51], a[168:171], a[64:67], v[48:51]
M v[48:51], a[172:175], a[68:71], v[48:51]
M v[52:55], a[172:175], a[76:79], v[52:55]
 ds_read_b64_tr_b16 a[116:117], v3 offset:40960
 ds_read_b64_tr_b16 a[118:119], v3 offset:41984
M v[52:55], a[168:171], a[72:75], v[52:55]
M v[56:59], a[168:171], a[80:83], v[56:59]
 buffer_load_dwordx4 v9, s[16:19], s21 offen offset:1024  nt lds
M v[56:59], a[172:175], a[84:87], v[56:59]
 s_waitcnt lgkmcnt(6)
M v[60:63], a[172:175], a[92:95], v[60:63]
M v[60:63], a[168:171], a[88:91], v[60:63]
 ds_read_b64_tr_b16 a[120:121], v4 offset:32768
 ds_read_b64_tr_b16 a[122:123], v4 offset:33792
M v[64:67], a[160:163], a[32:35], v[64:67]
 ds_read_b128 a[168:171], v5 offset:6144
 ds_read_b128 a[172:175], v6 offset:6144
M v[64:67], a[164:167], a[36:39], v[64:67]
 buffer_load_dwordx4 v10, s[16:19], s21 offen offset:2048  nt lds
M v[68:71], a[164:167], a[44:47], v[68:71]
M v[68:71], a[160:163], a[40:43], v[68:71]
M v[72:75], a[160:163], a[48:51], v[72:75]
 ds_read_b64_tr_b16 a[124:125], v4 offset:40960
 ds_read_b64_tr_b16 a[126:127], v4 offset:41984
M v[72:75], a[164:167], a[52:55], v[72:75]
M v[76:79], a[164:167], a[60:63], v[76:79]
 buffer_load_dwordx4 v11, s[16:19], s21 offen offset:3072  nt lds
M v[76:79], a[160:163], a[56:59], v[76:79]
 s_add_u32 s21, s21, 524160
M v[80:83], a[160:163], a[64:67], v[80:83]
M v[80:83], a[164:167], a[68:71], v[80:83]
M v[84:87], a[164:167], a[76:79], v[84:87]
M v[84:87], a[160:163], a[72:75], v[84:87]
M v[88:91], a[160:163], a[80:83], v[88:91]
M v[88:91], a[164:167], a[84:87], v[88:91]
 s_waitcnt lgkmcnt(2)
M v[92:95], a[164:167], a[92:95], v[92:95]
 s_waitcnt vmcnt(17) lgkmcnt(0)
M v[92:95], a[160:163], a[88:91], v[92:95]
 s_barrier
M v[96:99], a[168:171], a[32:35], v[96:99]
 ds_read_b128 a[160:163], v5 offset:16384
 ds_read_b128 a[164:167], v6 offset:16384
M v[96:99], a[172:175], a[36:39], v[96:99]
M v[100:103], a[172:175], a[44:47], v[100:103]
 s_add_u32 m0, s24, 0
 ds_read_b64_tr_b16 a[128:129], v1 offset:49152
 ds_read_b64_tr_b16 a[130:131], v1 offset:50176
M v[100:103], a[168:171], a[40:43], v[100:103]
 buffer_load_dwordx4 v12, s[48:51], s22 offen offset:0   lds
M v[104:107], a[168:171], a[48:51], v[104:107]
M v[104:107], a[172:175], a[52:55], v[104:107]
M v[108:111], a[172:175], a[60:63], v[108:111]
M v[108:111], a[168:171], a[56:59], v[108:111]
M v[112:115], a[168:171], a[64:67], v[112:115]
M v[112:115], a[172:175], a[68:71], v[112:115]
 ds_read_b64_tr_b16 a[132:133], v1 offset:57344
 ds_read_b64_tr_b16 a[134:135], v1 offset:58368
M v[116:119], a[172:175], a[76:79], v[116:119]
 buffer_load_dwordx4 v13, s[48:51], s22 offen offset:1024   lds
M v[116:119], a[168:171], a[72:75], v[116:119]
M v[120:123], a[168:171], a[80:83], v[120:123]
M v[120:123], a[172:175], a[84:87], v[120:123]
 s_waitcnt lgkmcnt(4)
M v[124:127], a[172:175], a[92:95], v[124:127]
M v[124:127], a[168:171], a[88:91], v[124:127]
M v[128:131], a[160:163], a[32:35], v[128:131]
 ds_read_b128 a[168:171], v5 offset:18432
 ds_read_b128 a[172:175], v6 offset:18432
M v[128:131], a[164:167], a[36:39], v[128:131]
 ds_read_b64_tr_b16 a[136:137], v2 offset:49152
 ds_read_b64_tr_b16 a[138:139], v2 offset:50176
M v[132:135], a[164:167], a[44:47], v[132:135]
 buffer_load_dwordx4 v14, s[48:51], s22 offen offset:2048   lds
M v[132:135], a[160:163], a[40:43], v[132:135]
M v[136:139], a[160:163], a[48:51], v[136:139]
M v[136:139], a[164:167], a[52:55], v[136:139]
M v[140:143], a[164:167], a[60:63], v[140:143]
M v[140:143], a[160:163], a[56:59], v[140:143]
 ds_read_b64_tr_b16 a[140:141], v2 offset:57344
 ds_read_b64_tr_b16 a[142:143], v2 offset:58368
M v[144:147], a[160:163], a[64:67], v[144:147]
 buffer_load_dwordx4 v15, s[48:51], s22 offen offset:3072   lds
M v[144:147], a[164:167], a[68:71], v[144:147]
 s_add_u32 s22, s22, 2097152
M v[148:151], a[164:167], a[76:79], v[148:151]
M v[148:151], a[160:163], a[72:75], v[148:151]
M v[152:155], a[160:163], a[80:83], v[152:155]
M v[152:155], a[164:167], a[84:87], v[152:155]
 s_waitcnt lgkmcnt(4)
M v[156:159], a[164:167], a[92:95], v[156:159]
 s_add_u32 m0, s23, 32768
 ds_read_b64_tr_b16 a[144:145], v3 offset:49152
 ds_read_b64_tr_b16 a[146:147], v3 offset:50176
M v[156:159], a[160:163], a[88:91], v[156:159]
 buffer_load_dwordx4 v8, s[16:19], s21 offen offset:0  nt lds
M v[160:163], a[168:171], a[32:35], v[160:163]
 ds_read_b128 a[160:163], v5 offset:20480
 ds_read_b128 a[164:167], v6 offset:20480
M v[160:163], a[172:175], a[36:39], v[160:163]
M v[164:167], a[172:175], a[44:47], v[164:167]
M v[164:167], a[168:171], a[40:43], v[164:167]
M v[168:171], a[168:171], a[48:51], v[168:171]
M v[168:171], a[172:175], a[52:55], v[168:171]
 ds_read_b64_tr_b16 a[148:149], v3 offset:57344
 ds_read_b64_tr_b16 a[150:151], v3 offset:58368
M v[172:175], a[172:175], a[60:63], v[172:175]
 buffer_load_dwordx4 v9, s[16:19], s21 offen offset:1024  nt lds
M v[172:175], a[168:171], a[56:59], v[172:175]
M v[176:179], a[168:171], a[64:67], v[176:179]
M v[176:179], a[172:175], a[68:71], v[176:179]
M v[180:183], a[172:175], a[76:79], v[180:183]
M v[180:183], a[168:171], a[72:75], v[180:183]
M v[184:187], a[168:171], a[80:83], v[184:187]
 ds_read_b64_tr_b16 a[152:153], v4 offset:49152
 ds_read_b64_tr_b16 a[154:155], v4 offset:50176
M v[184:187], a[172:175], a[84:87], v[184:187]
 s_waitcnt lgkmcnt(4)
 buffer_load_dwordx4 v10, s[16:19], s21 offen offset:2048  nt lds
M v[188:191], a[172:175], a[92:95], v[188:191]
M v[188:191], a[168:171], a[88:91], v[188:191]
M v[192:195], a[160:163], a[32:35], v[192:195]
 ds_read_b128 a[168:171], v5 offset:22528
 ds_read_b128 a[172:175], v6 offset:22528
M v[192:195], a[164:167], a[36:39], v[192:195]
M v[196:199], a[164:167], a[44:47], v[196:199]
M v[196:199], a[160:163], a[40:43], v[196:199]
 ds_read_b64_tr_b16 a[156:157], v4 offset:57344
 ds_read_b64_tr_b16 a[158:159], v4 offset:58368
M v[200:203], a[160:163], a[48:51], v[200:203]
 buffer_load_dwordx4 v11, s[16:19], s21 offen offset:3072  nt lds
M v[200:203], a[164:167], a[52:55], v[200:203]
 s_add_u32 s21, s21, 128
M v[204:207], a[164:167], a[60:63], v[204:207]
M v[204:207], a[160:163], a[56:59], v[204:207]
M v[208:211], a[160:163], a[64:67], v[208:211]
M v[208:211], a[164:167], a[68:71], v[208:211]
M v[212:215], a[164:167], a[76:79], v[212:215]
M v[212:215], a[160:163], a[72:75], v[212:215]
M v[216:219], a[160:163], a[80:83], v[216:219]
M v[216:219], a[164:167], a[84:87], v[216:219]
 s_waitcnt lgkmcnt(2)
M v[220:223], a[164:167], a[92:95], v[220:223]
 s_waitcnt vmcnt(17) lgkmcnt(0)
M v[220:223], a[160:163], a[88:91], v[220:223]
 s_barrier
M v[224:227], a[168:171], a[32:35], v[224:227]
 ds_read_b128 a[160:163], v5 offset:32768
 ds_read_b128 a[164:167], v6 offset:32768
M v[224:227], a[172:175], a[36:39], v[224:227]
 buffer_load_dword a240, v23, s[52:55], 0 offen offset:0
M v[228:231], a[172:175], a[44:47], v[228:231]
 v_add_u32 v23, 32768, v23
M v[228:231], a[168:171], a[40:43], v[228:231]
M v[232:235], a[168:171], a[48:51], v[232:235]
M v[232:235], a[172:175], a[52:55], v[232:235]
M v[236:239], a[172:175], a[60:63], v[236:239]
M v[236:239], a[168:171], a[56:59], v[236:239]
M v[240:243], a[168:171], a[64:67], v[240:243]
M v[240:243], a[172:175], a[68:71], v[240:243]
M v[244:247], a[172:175], a[76:79], v[244:247]
M v[244:247], a[168:171], a[72:75], v[244:247]
M v[248:251], a[168:171], a[80:83], v[248:251]
M v[248:251], a[172:175], a[84:87], v[248:251]
 s_waitcnt lgkmcnt(0)
M v[252:255], a[172:175], a[92:95], v[252:255]
M v[252:255], a[168:171], a[88:91], v[252:255]
M a[0:3], a[160:163], a[96:99], a[0:3]
 ds_read_b128 a[168:171], v5 offset:34816
 ds_read_b128 a[172:175], v6 offset:34816
M a[0:3], a[164:167], a[100:103], a[0:3]
 ds_read_b64_tr_b16 a[32:33], v1 offset:0
 ds_read_b64_tr_b16 a[34:35], v1 offset:1024
M a[4:7], a[164:167], a[108:111], a[4:7]
 s_add_u32 m0, s24, 16384
M a[4:7], a[160:163], a[104:107], a[4:7]
 buffer_load_dwordx4 v12, s[48:51], s22 offen offset:0   lds
M a[8:11], a[160:163], a[112:115], a[8:11]
M a[8:11], a[164:167], a[116:119], a[8:11]
M a[12:15], a[164:167], a[124:127], a[12:15]
 ds_read_b64_tr_b16 a[36:37], v1 offset:8192
 ds_read_b64_tr_b16 a[38:39], v1 offset:9216
M a[12:15], a[160:163], a[120:123], a[12:15]
M a[16:19], a[160:163], a[128:131], a[16:19]
 buffer_load_dwordx4 v13, s[48:51], s22 offen offset:1024   lds
M a[16:19], a[164:167], a[132:135], a[16:19]
M a[20:23], a[164:167], a[140:143], a[20:23]
M a[20:23], a[160:163], a[136:139], a[20:23]
 ds_read_b64_tr_b16 a[40:41], v2 offset:0
 ds_read_b64_tr_b16 a[42:43], v2 offset:1024
M a[24:27], a[160:163], a[144:147], a[24:27]
M a[24:27], a[164:167], a[148:151], a[24:27]
 s_waitcnt lgkmcnt(6)
 buffer_load_dwordx4 v14, s[48:51], s22 offen offset:2048   lds
M a[28:31], a[164:167], a[156:159], a[28:31]
M a[28:31], a[160:163], a[152:155], a[28:31]
M v[32:35], a[168:171], a[96:99], v[32:35]
 ds_read_b128 a[160:163], v5 offset:36864
 ds_read_b128 a[164:167], v6 offset:36864
M v[32:35], a[172:175], a[100:103], v[32:35]
 ds_read_b64_tr_b16 a[44:45], v2 offset:8192
 ds_read_b64_tr_b16 a[46:47], v2 offset:9216
M v[36:39], a[172:175], a[108:111], v[36:39]
 buffer_load_dwordx4 v15, s[48:51], s22 offen offset:3072   lds
M v[36:39], a[168:171], a[104:107], v[36:39]
 s_sub_u32 s22, s22, 2097024
M v[40:43], a[168:171], a[112:115], v[40:43]
M v[40:43], a[172:175], a[116:119], v[40:43]
 ds_read_b64_tr_b16 a[48:49], v3 offset:0
 ds_read_b64_tr_b16 a[50:51], v3 offset:1024
M v[44:47], a[172:175], a[124:127], v[44:47]
 s_add_u32 m0, s23, 49152
M v[44:47], a[168:171], a[120:123], v[44:47]
 buffer_load_dwordx4 v8, s[16:19], s21 offen offset:0  nt lds
M v[48:51], a[168:171], a[128:131], v[48:51]
M v[48:51], a[172:175], a[132:135], v[48:51]
M v[52:55], a[172:175], a[140:143], v[52:55]
 ds_read_b64_tr_b16 a[52:53], v3 offset:8192
 ds_read_b64_tr_b16 a[54:55], v3 offset:9216
M v[52:55], a[168:171], a[136:139], v[52:55]
M v[56:59], a[168:171], a[144:147], v[56:59]
 buffer_load_dwordx4 v9, s[16:19], s21 offen offset:1024  nt lds
M v[56:59], a[172:175], a[148:151], v[56:59]
 s_waitcnt lgkmcnt(6)
M v[60:63], a[172:175], a[156:159], v[60:63]
M v[60:63], a[168:171], a[152:155], v[60:63]
 ds_read_b64_tr_b16 a[56:57], v4 offset:0
 ds_read_b64_tr_b16 a[58:59], v4 offset:1024
M v[64:67], a[160:163], a[96:99], v[64:67]
 ds_read_b128 a[168:171], v5 offset:38912
 ds_read_b128 a[172:175], v6 offset:38912
M v[64:67], a[164:167], a[100:103], v[64:67]
 buffer_load_dwordx4 v10, s[16:19], s21 offen offset:2048  nt lds
M v[68:71], a[164:167], a[108:111], v[68:71]
M v[68:71], a[160:163], a[104:107], v[68:71]
M v[72:75], a[160:163], a[112:115], v[72:75]
 ds_read_b64_tr_b16 a[60:61], v4 offset:8192
 ds_read_b64_tr_b16 a[62:63], v4 offset:9216
M v[72:75], a[164:167], a[116:119], v[72:75]
M v[76:79], a[164:167], a[124:127], v[76:79]
 buffer_load_dwordx4 v11, s[16:19], s21 offen offset:3072  nt lds
M v[76:79], a[160:163], a[120:123], v[76:79]
 s_add_u32 s21, s21, 524160
M v[80:83], a[160:163], a[128:131], v[80:83]
M v[80:83], a[164:167], a[132:135], v[80:83]
M v[84:87], a[164:167], a[140:143], v[84:87]
M v[84:87], a[160:163], a[136:139], v[84:87]
M v[88:91], a[160:163], a[144:147], v[88:91]
M v[88:91], a[164:167], a[148:151], v[88:91]
 s_waitcnt lgkmcnt(2)
M v[92:95], a[164:167], a[156:159], v[92:95]
 s_waitcnt vmcnt(17) lgkmcnt(0)
M v[92:95], a[160:163], a[152:155], v[92:95]
 s_barrier
M v[96:99], a[168:171], a[96:99], v[96:99]
 ds_read_b128 a[160:163], v5 offset:49152
 ds_read_b128 a[164:167], v6 offset:49152
M v[96:99], a[172:175], a[100:103], v[96:99]
M v[100:103], a[172:175], a[108:111], v[100:103]
 s_add_u32 m0, s24, 32768
 ds_read_b64_tr_b16 a[64:65], v1 offset:16384
 ds_read_b64_tr_b16 a[66:67], v1 offset:17408
M v[100:103], a[168:171], a[104:107], v[100:103]
 buffer_load_dwordx4 v12, s[48:51], s22 offen offset:0   lds
M v[104:107], a[168:171], a[112:115], v[104:107]
M v[104:107], a[172:175], a[116:119], v[104:107]
M v[108:111], a[172:175], a[124:127], v[108:111]
M v[108:111], a[168:171], a[120:123], v[108:111]
M v[112:115], a[168:171], a[128:131], v[112:115]
M v[112:115], a[172:175], a[132:135], v[112:115]
 ds_read_b64_tr_b16 a[68:69], v1 offset:24576
 ds_read_b64_tr_b16 a[70:71], v1 offset:25600
M v[116:119], a[172:175], a[140:143], v[116:119]
 buffer_load_dwordx4 v13, s[48:51], s22 offen offset:1024   lds
M v[116:119], a[168:171], a[136:139], v[116:119]
M v[120:123], a[168:171], a[144:147], v[120:123]
M v[120:123], a[172:175], a[148:151], v[120:123]
 s_waitcnt lgkmcnt(4)
M v[124:127], a[172:175], a[156:159], v[124:127]
M v[124:127], a[168:171], a[152:155], v[124:127]
M v[128:131], a[160:163], a[96:99], v[128:131]
 ds_read_b128 a[168:171], v5 offset:51200
 ds_read_b128 a[172:175], v6 offset:51200
M v[128:131], a[164:167], a[100:103], v[128:131]
 ds_read_b64_tr_b16 a[72:73], v2 offset:16384
 ds_read_b64_tr_b16 a[74:75], v2 offset:17408
M v[132:135], a[164:167], a[108:111], v[132:135]
 buffer_load_dwordx4 v14, s[48:51], s22 offen offset:2048   lds
M v[132:135], a[160:163], a[104:107], v[132:135]
M v[136:139], a[160:163], a[112:115], v[136:139]
M v[136:139], a[164:167], a[116:119], v[136:139]
M v[140:143], a[164:167], a[124:127], v[140:143]
M v[140:143], a[160:163], a[120:123], v[140:143]
 ds_read_b64_tr_b16 a[76:77], v2 offset:24576
 ds_read_b64_tr_b16 a[78:79], v2 offset:25600
M v[144:147], a[160:163], a[128:131], v[144:147]
 buffer_load_dwordx4 v15, s[48:51], s22 offen offset:3072   lds
M v[144:147], a[164:167], a[132:135], v[144:147]
 s_add_u32 s22, s22, 2097152
M v[148:151], a[164:167], a[140:143], v[148:151]
M v[148:151], a[160:163], a[136:139], v[148:151]
M v[152:155], a[160:163], a[144:147], v[152:155]
M v[152:155], a[164:167], a[148:151], v[152:155]
 s_waitcnt lgkmcnt(4)
M v[156:159], a[164:167], a[156:159], v[156:159]
 s_add_u32 m0, s23, 0
 ds_read_b64_tr_b16 a[80:81], v3 offset:16384
 ds_read_b64_tr_b16 a[82:83], v3 offset:17408
M v[156:159], a[160:163], a[152:155], v[156:159]
 buffer_load_dwordx4 v8, s[16:19], s21 offen offset:0  nt lds
M v[160:163], a[168:171], a[96:99], v[160:163]
 ds_read_b128 a[160:163], v5 offset:53248
 ds_read_b128 a[164:167], v6 offset:53248
M v[160:163], a[172:175], a[100:103], v[160:163]
M v[164:167], a[172:175], a[108:111], v[164:167]
M v[164:167], a[168:171], a[104:107], v[164:167]
M v[168:171], a[168:171], a[112:115], v[168:171]
M v[168:171], a[172:175], a[116:119], v[168:171]
 ds_read_b64_tr_b16 a[84:85], v3 offset:24576
 ds_read_b64_tr_b16 a[86:87], v3 offset:25600
M v[172:175], a[172:175], a[124:127], v[172:175]
 buffer_load_dwordx4 v9, s[16:19], s21 offen offset:1024  nt lds
M v[172:175], a[168:171], a[120:123], v[172:175]
M v[176:179], a[168:171], a[128:131], v[176:179]
M v[176:179], a[172:175], a[132:135], v[176:179]
M v[180:183], a[172:175], a[140:143], v[180:183]
M v[180:183], a[168:171], a[136:139], v[180:183]
M v[184:187], a[168:171], a[144:147], v[184:187]
 ds_read_b64_tr_b16 a[88:89], v4 offset:16384
 ds_read_b64_tr_b16 a[90:91], v4 offset:17408
M v[184:187], a[172:175], a[148:151], v[184:187]
 s_waitcnt lgkmcnt(4)
 buffer_load_dwordx4 v10, s[16:19], s21 offen offset:2048  nt lds
M v[188:191], a[172:175], a[156:159], v[188:191]
M v[188:191], a[168:171], a[152:155], v[188:191]
M v[192:195], a[160:163], a[96:99], v[192:195]
 ds_read_b128 a[168:171], v5 offset:55296
 ds_read_b128 a[172:175], v6 offset:55296
M v[192:195], a[164:167], a[100:103], v[192:195]
M v[196:199], a[164:167], a[108:111], v[196:199]
M v[196:199], a[160:163], a[104:107], v[196:199]
 ds_read_b64_tr_b16 a[92:93], v4 offset:24576
 ds_read_b64_tr_b16 a[94:95], v4 offset:25600
M v[200:203], a[160:163], a[112:115], v[200:203]
 buffer_load_dwordx4 v11, s[16:19], s21 offen offset:3072  nt lds
M v[200:203], a[164:167], a[116:119], v[200:203]
 s_add_u32 s21, s21, 128
M v[204:207], a[164:167], a[124:127], v[204:207]
M v[204:207], a[160:163], a[120:123], v[204:207]
M v[208:211], a[160:163], a[128:131], v[208:211]
M v[208:211], a[164:167], a[132:135], v[208:211]
M v[212:215], a[164:167], a[140:143], v[212:215]
M v[212:215], a[160:163], a[136:139], v[212:215]
M v[216:219], a[160:163], a[144:147], v[216:219]
M v[216:219], a[164:167], a[148:151], v[216:219]
 s_waitcnt lgkmcnt(2)
M v[220:223], a[164:167], a[156:159], v[220:223]
 s_waitcnt vmcnt(17) lgkmcnt(0)
M v[220:223], a[160:163], a[152:155], v[220:223]
 s_barrier
M v[224:227], a[168:171], a[96:99], v[224:227]
 ds_read_b128 a[160:163], v5 offset:0
 ds_read_b128 a[164:167], v6 offset:0
M v[224:227], a[172:175], a[100:103], v[224:227]
 buffer_load_dword a240, v23, s[52:55], 0 offen offset:0
M v[228:231], a[172:175], a[108:111], v[228:231]
 v_add_u32 v23, 16384, v23
M v[228:231], a[168:171], a[104:107], v[228:231]
M v[232:235], a[168:171], a[112:115], v[232:235]
M v[232:235], a[172:175], a[116:119], v[232:235]
M v[236:239], a[172:175], a[124:127], v[236:239]
M v[236:239], a[168:171], a[120:123], v[236:239]
M v[240:243], a[168:171], a[128:131], v[240:243]
M v[240:243], a[172:175], a[132:135], v[240:243]
M v[244:247], a[172:175], a[140:143], v[244:247]
M v[244:247], a[168:171], a[136:139], v[244:247]
M v[248:251], a[168:171], a[144:147], v[248:251]
M v[248:251], a[172:175], a[148:151], v[248:251]
 s_waitcnt lgkmcnt(0)
M v[252:255], a[172:175], a[156:159], v[252:255]
M v[252:255], a[168:171], a[152:155], v[252:255]
M a[0:3], a[160:163], a[32:35], a[0:3]
 ds_read_b128 a[168:171], v5 offset:2048
 ds_read_b128 a[172:175], v6 offset:2048
M a[0:3], a[164:167], a[36:39], a[0:3]
 ds_read_b64_tr_b16 a[96:97], v1 offset:32768
 ds_read_b64_tr_b16 a[98:99], v1 offset:33792
M a[4:7], a[164:167], a[44:47], a[4:7]
 s_add_u32 m0, s24, 49152
M a[4:7], a[160:163], a[40:43], a[4:7]
 buffer_load_dwordx4 v12, s[48:51], s22 offen offset:0   lds
M a[8:11], a[160:163], a[48:51], a[8:11]
M a[8:11], a[164:167], a[52:55], a[8:11]
M a[12:15], a[164:167], a[60:63], a[12:15]
 ds_read_b64_tr_b16 a[100:101], v1 offset:40960
 ds_read_b64_tr_b16 a[102:103], v1 offset:41984
M a[12:15], a[160:163], a[56:59], a[12:15]
M a[16:19], a[160:163], a[64:67], a[16:19]
 buffer_load_dwordx4 v13, s[48:51], s22 offen offset:1024   lds
M a[16:19], a[164:167], a[68:71], a[16:19]
M a[20:23], a[164:167], a[76:79], a[20:23]
M a[20:23], a[160:163], a[72:75], a[20:23]
 ds_read_b64_tr_b16 a[104:105], v2 offset:32768
 ds_read_b64_tr_b16 a[106:107], v2 offset:33792
M a[24:27], a[160:163], a[80:83], a[24:27]
M a[24:27], a[164:167], a[84:87], a[24:27]
 s_waitcnt lgkmcnt(6)
 buffer_load_dwordx4 v14, s[48:51], s22 offen offset:2048   lds
M a[28:31], a[164:167], a[92:95], a[28:31]
M a[28:31], a[160:163], a[88:91], a[28:31]
M v[32:35], a[168:171], a[32:35], v[32:35]
 ds_read_b128 a[160:163], v5 offset:4096
 ds_read_b128 a[164:167], v6 offset:4096
M v[32:35], a[172:175], a[36:39], v[32:35]
 ds_read_b64_tr_b16 a[108:109], v2 offset:40960
 ds_read_b64_tr_b16 a[110:111], v2 offset:41984
M v[36:39], a[172:175], a[44:47], v[36:39]
 buffer_load_dwordx4 v15, s[48:51], s22 offen offset:3072   lds
M v[36:39], a[168:171], a[40:43], v[36:39]
 s_sub_u32 s22, s22, 2097024
M v[40:43], a[168:171], a[48:51], v[40:43]
M v[40:43], a[172:175], a[52:55], v[40:43]
 ds_read_b64_tr_b16 a[112:113], v3 offset:32768
 ds_read_b64_tr_b16 a[114:115], v3 offset:33792
M v[44:47], a[172:175], a[60:63], v[44:47]
 s_add_u32 m0, s23, 16384
M v[44:47], a[168:171], a[56:59], v[44:47]
 buffer_load_dwordx4 v8, s[16:19], s21 offen offset:0  nt lds
M v[48:51], a[168:171], a[64:67], v[48:51]
M v[48:51], a[172:175], a[68:71], v[48:51]
M v[52:55], a[172:175], a[76:79], v[52:55]
 ds_read_b64_tr_b16 a[116:117], v3 offset:40960
 ds_read_b64_tr_b16 a[118:119], v3 offset:41984
M v[52:55], a[168:171], a[72:75], v[52:55]
M v[56:59], a[168:171], a[80:83], v[56:59]
 buffer_load_dwordx4 v9, s[16:19], s21 offen offset:1024  nt lds
M v[56:59], a[172:175], a[84:87], v[56:59]
 s_waitcnt lgkmcnt(6)
M v[60:63], a[172:175], a[92:95], v[60:63]
M v[60:63], a[168:171], a[88:91], v[60:63]
 ds_read_b64_tr_b16 a[120:121], v4 offset:32768
 ds_read_b64_tr_b16 a[122:123], v4 offset:33792
M v[64:67], a[160:163], a[32:35], v[64:67]
 ds_read_b128 a[168:171], v5 offset:6144
 ds_read_b128 a[172:175], v6 offset:6144
M v[64:67], a[164:167], a[36:39], v[64:67]
 buffer_load_dwordx4 v10, s[16:19], s21 offen offset:2048  nt lds
M v[68:71], a[164:167], a[44:47], v[68:71]
M v[68:71], a[160:163], a[40:43], v[68:71]
M v[72:75], a[160:163], a[48:51], v[72:75]
 ds_read_b64_tr_b16 a[124:125], v4 offset:40960
 ds_read_b64_tr_b16 a[126:127], v4 offset:41984
M v[72:75], a[164:167], a[52:55], v[72:75]
M v[76:79], a[164:167], a[60:63], v[76:79]
 buffer_load_dwordx4 v11, s[16:19], s21 offen offset:3072  nt lds
M v[76:79], a[160:163], a[56:59], v[76:79]
 s_add_u32 s21, s21, 524160
M v[80:83], a[160:163], a[64:67], v[80:83]
M v[80:83], a[164:167], a[68:71], v[80:83]
M v[84:87], a[164:167], a[76:79], v[84:87]
M v[84:87], a[160:163], a[72:75], v[84:87]
M v[88:91], a[160:163], a[80:83], v[88:91]
M v[88:91], a[164:167], a[84:87], v[88:91]
 s_waitcnt lgkmcnt(2)
M v[92:95], a[164:167], a[92:95], v[92:95]
 s_waitcnt vmcnt(17) lgkmcnt(0)
M v[92:95], a[160:163], a[88:91], v[92:95]
 s_barrier
M v[96:99], a[168:171], a[32:35], v[96:99]
 ds_read_b128 a[160:163], v5 offset:16384
 ds_read_b128 a[164:167], v6 offset:16384
M v[96:99], a[172:175], a[36:39], v[96:99]
M v[100:103], a[172:175], a[44:47], v[100:103]
 s_add_u32 m0, s24, 0
 ds_read_b64_tr_b16 a[128:129], v1 offset:49152
 ds_read_b64_tr_b16 a[130:131], v1 offset:50176
M v[100:103], a[168:171], a[40:43], v[100:103]
 buffer_load_dwordx4 v12, s[48:51], s22 offen offset:0   lds
M v[104:107], a[168:171], a[48:51], v[104:107]
M v[104:107], a[172:175], a[52:55], v[104:107]
M v[108:111], a[172:175], a[60:63], v[108:111]
M v[108:111], a[168:171], a[56:59], v[108:111]
M v[112:115], a[168:171], a[64:67], v[112:115]
M v[112:115], a[172:175], a[68:71], v[112:115]
 ds_read_b64_tr_b16 a[132:133], v1 offset:57344
 ds_read_b64_tr_b16 a[134:135], v1 offset:58368
M v[116:119], a[172:175], a[76:79], v[116:119]
 buffer_load_dwordx4 v13, s[48:51], s22 offen offset:1024   lds
M v[116:119], a[168:171], a[72:75], v[116:119]
M v[120:123], a[168:171], a[80:83], v[120:123]
M v[120:123], a[172:175], a[84:87], v[120:123]
 s_waitcnt lgkmcnt(4)
M v[124:127], a[172:175], a[92:95], v[124:127]
M v[124:127], a[168:171], a[88:91], v[124:127]
M v[128:131], a[160:163], a[32:35], v[128:131]
 ds_read_b128 a[168:171], v5 offset:18432
 ds_read_b128 a[172:175], v6 offset:18432
M v[128:131], a[164:167], a[36:39], v[128:131]
 ds_read_b64_tr_b16 a[136:137], v2 offset:49152
 ds_read_b64_tr_b16 a[138:139], v2 offset:50176
M v[132:135], a[164:167], a[44:47], v[132:135]
 buffer_load_dwordx4 v14, s[48:51], s22 offen offset:2048   lds
M v[132:135], a[160:163], a[40:43], v[132:135]
M v[136:139], a[160:163], a[48:51], v[136:139]
M v[136:139], a[164:167], a[52:55], v[136:139]
M v[140:143], a[164:167], a[60:63], v[140:143]
M v[140:143], a[160:163], a[56:59], v[140:143]
 ds_read_b64_tr_b16 a[140:141], v2 offset:57344
 ds_read_b64_tr_b16 a[142:143], v2 offset:58368
M v[144:147], a[160:163], a[64:67], v[144:147]
 buffer_load_dwordx4 v15, s[48:51], s22 offen offset:3072   lds
M v[144:147], a[164:167], a[68:71], v[144:147]
 s_add_u32 s22, s22, 2097152
M v[148:151], a[164:167], a[76:79], v[148:151]
M v[148:151], a[160:163], a[72:75], v[148:151]
M v[152:155], a[160:163], a[80:83], v[152:155]
M v[152:155], a[164:167], a[84:87], v[152:155]
 s_waitcnt lgkmcnt(4)
M v[156:159], a[164:167], a[92:95], v[156:159]
 s_add_u32 m0, s23, 32768
 ds_read_b64_tr_b16 a[144:145], v3 offset:49152
 ds_read_b64_tr_b16 a[146:147], v3 offset:50176
M v[156:159], a[160:163], a[88:91], v[156:159]
 buffer_load_dwordx4 v8, s[16:19], s21 offen offset:0  nt lds
M v[160:163], a[168:171], a[32:35], v[160:163]
 ds_read_b128 a[160:163], v5 offset:20480
 ds_read_b128 a[164:167], v6 offset:20480
M v[160:163], a[172:175], a[36:39], v[160:163]
M v[164:167], a[172:175], a[44:47], v[164:167]
M v[164:167], a[168:171], a[40:43], v[164:167]
M v[168:171], a[168:171], a[48:51], v[168:171]
M v[168:171], a[172:175], a[52:55], v[168:171]
 ds_read_b64_tr_b16 a[148:149], v3 offset:57344
 ds_read_b64_tr_b16 a[150:151], v3 offset:58368
M v[172:175], a[172:175], a[60:63], v[172:175]
 buffer_load_dwordx4 v9, s[16:19], s21 offen offset:1024  nt lds
M v[172:175], a[168:171], a[56:59], v[172:175]
M v[176:179], a[168:171], a[64:67], v[176:179]
M v[176:179], a[172:175], a[68:71], v[176:179]
M v[180:183], a[172:175], a[76:79], v[180:183]
M v[180:183], a[168:171], a[72:75], v[180:183]
M v[184:187], a[168:171], a[80:83], v[184:187]
 ds_read_b64_tr_b16 a[152:153], v4 offset:49152
 ds_read_b64_tr_b16 a[154:155], v4 offset:50176
M v[184:187], a[172:175], a[84:87], v[184:187]
 s_waitcnt lgkmcnt(4)
 buffer_load_dwordx4 v10, s[16:19], s21 offen offset:2048  nt lds
M v[188:191], a[172:175], a[92:95], v[188:191]
M v[188:191], a[168:171], a[88:91], v[188:191]
M v[192:195], a[160:163], a[32:35], v[192:195]
 ds_read_b128 a[168:171], v5 offset:22528
 ds_read_b128 a[172:175], v6 offset:22528
M v[192:195], a[164:167], a[36:39], v[192:195]
M v[196:199], a[164:167], a[44:47], v[196:199]
M v[196:199], a[160:163], a[40:43], v[196:199]
 ds_read_b64_tr_b16 a[156:157], v4 offset:57344
 ds_read_b64_tr_b16 a[158:159], v4 offset:58368
M v[200:203], a[160:163], a[48:51], v[200:203]
 buffer_load_dwordx4 v11, s[16:19], s21 offen offset:3072  nt lds
M v[200:203], a[164:167], a[52:55], v[200:203]
 s_add_u32 s21, s21, 128
M v[204:207], a[164:167], a[60:63], v[204:207]
M v[204:207], a[160:163], a[56:59], v[204:207]
M v[208:211], a[160:163], a[64:67], v[208:211]
M v[208:211], a[164:167], a[68:71], v[208:211]
M v[212:215], a[164:167], a[76:79], v[212:215]
M v[212:215], a[160:163], a[72:75], v[212:215]
M v[216:219], a[160:163], a[80:83], v[216:219]
M v[216:219], a[164:167], a[84:87], v[216:219]
 s_waitcnt lgkmcnt(2)
M v[220:223], a[164:167], a[92:95], v[220:223]
 s_waitcnt vmcnt(17) lgkmcnt(0)
M v[220:223], a[160:163], a[88:91], v[220:223]
 s_barrier
M v[224:227], a[168:171], a[32:35], v[224:227]
 ds_read_b128 a[160:163], v5 offset:32768
 ds_read_b128 a[164:167], v6 offset:32768
M v[224:227], a[172:175], a[36:39], v[224:227]
 buffer_load_dword a240, v23, s[52:55], 0 offen offset:0
M v[228:231], a[172:175], a[44:47], v[228:231]
 v_add_u32 v23, 16384, v23
M v[228:231], a[168:171], a[40:43], v[228:231]
M v[232:235], a[168:171], a[48:51], v[232:235]
M v[232:235], a[172:175], a[52:55], v[232:235]
M v[236:239], a[172:175], a[60:63], v[236:239]
M v[236:239], a[168:171], a[56:59], v[236:239]
M v[240:243], a[168:171], a[64:67], v[240:243]
M v[240:243], a[172:175], a[68:71], v[240:243]
M v[244:247], a[172:175], a[76:79], v[244:247]
M v[244:247], a[168:171], a[72:75], v[244:247]
M v[248:251], a[168:171], a[80:83], v[248:251]
M v[248:251], a[172:175], a[84:87], v[248:251]
 s_waitcnt lgkmcnt(0)
M v[252:255], a[172:175], a[92:95], v[252:255]
M v[252:255], a[168:171], a[88:91], v[252:255]
M a[0:3], a[160:163], a[96:99], a[0:3]
 ds_read_b128 a[168:171], v5 offset:34816
 ds_read_b128 a[172:175], v6 offset:34816
M a[0:3], a[164:167], a[100:103], a[0:3]
 ds_read_b64_tr_b16 a[32:33], v1 offset:0
 ds_read_b64_tr_b16 a[34:35], v1 offset:1024
M a[4:7], a[164:167], a[108:111], a[4:7]
 s_add_u32 m0, s24, 16384
M a[4:7], a[160:163], a[104:107], a[4:7]
 buffer_load_dwordx4 v12, s[48:51], s22 offen offset:0   lds
M a[8:11], a[160:163], a[112:115], a[8:11]
M a[8:11], a[164:167], a[116:119], a[8:11]
M a[12:15], a[164:167], a[124:127], a[12:15]
 ds_read_b64_tr_b16 a[36:37], v1 offset:8192
 ds_read_b64_tr_b16 a[38:39], v1 offset:9216
M a[12:15], a[160:163], a[120:123], a[12:15]
M a[16:19], a[160:163], a[128:131], a[16:19]
 buffer_load_dwordx4 v13, s[48:51], s22 offen offset:1024   lds
M a[16:19], a[164:167], a[132:135], a[16:19]
M a[20:23], a[164:167], a[140:143], a[20:23]
M a[20:23], a[160:163], a[136:139], a[20:23]
 ds_read_b64_tr_b16 a[40:41], v2 offset:0
 ds_read_b64_tr_b16 a[42:43], v2 offset:1024
M a[24:27], a[160:163], a[144:147], a[24:27]
M a[24:27], a[164:167], a[148:151], a[24:27]
 s_waitcnt lgkmcnt(6)
 buffer_load_dwordx4 v14, s[48:51], s22 offen offset:2048   lds
M a[28:31], a[164:167], a[156:159], a[28:31]
M a[28:31], a[160:163], a[152:155], a[28:31]
M v[32:35], a[168:171], a[96:99], v[32:35]
 ds_read_b128 a[160:163], v5 offset:36864
 ds_read_b128 a[164:167], v6 offset:36864
M v[32:35], a[172:175], a[100:103], v[32:35]
 ds_read_b64_tr_b16 a[44:45], v2 offset:8192
 ds_read_b64_tr_b16 a[46:47], v2 offset:9216
M v[36:39], a[172:175], a[108:111], v[36:39]
 buffer_load_dwordx4 v15, s[48:51], s22 offen offset:3072   lds
M v[36:39], a[168:171], a[104:107], v[36:39]
 s_sub_u32 s22, s22, 2097024
M v[40:43], a[168:171], a[112:115], v[40:43]
M v[40:43], a[172:175], a[116:119], v[40:43]
 ds_read_b64_tr_b16 a[48:49], v3 offset:0
 ds_read_b64_tr_b16 a[50:51], v3 offset:1024
M v[44:47], a[172:175], a[124:127], v[44:47]
 s_add_u32 m0, s23, 49152
M v[44:47], a[168:171], a[120:123], v[44:47]
 buffer_load_dwordx4 v8, s[16:19], s21 offen offset:0  nt lds
M v[48:51], a[168:171], a[128:131], v[48:51]
M v[48:51], a[172:175], a[132:135], v[48:51]
M v[52:55], a[172:175], a[140:143], v[52:55]
 ds_read_b64_tr_b16 a[52:53], v3 offset:8192
 ds_read_b64_tr_b16 a[54:55], v3 offset:9216
M v[52:55], a[168:171], a[136:139], v[52:55]
M v[56:59], a[168:171], a[144:147], v[56:59]
 buffer_load_dwordx4 v9, s[16:19], s21 offen offset:1024  nt lds
M v[56:59], a[172:175], a[148:151], v[56:59]
 s_waitcnt lgkmcnt(6)
M v[60:63], a[172:175], a[156:159], v[60:63]
M v[60:63], a[168:171], a[152:155], v[60:63]
 ds_read_b64_tr_b16 a[56:57], v4 offset:0
 ds_read_b64_tr_b16 a[58:59], v4 offset:1024
M v[64:67], a[160:163], a[96:99], v[64:67]
 ds_read_b128 a[168:171], v5 offset:38912
 ds_read_b128 a[172:175], v6 offset:38912
M v[64:67], a[164:167], a[100:103], v[64:67]
 buffer_load_dwordx4 v10, s[16:19], s21 offen offset:2048  nt lds
M v[68:71], a[164:167], a[108:111], v[68:71]
M v[68:71], a[160:163], a[104:107], v[68:71]
M v[72:75], a[160:163], a[112:115], v[72:75]
 ds_read_b64_tr_b16 a[60:61], v4 offset:8192
 ds_read_b64_tr_b16 a[62:63], v4 offset:9216
M v[72:75], a[164:167], a[116:119], v[72:75]
M v[76:79], a[164:167], a[124:127], v[76:79]
 buffer_load_dwordx4 v11, s[16:19], s21 offen offset:3072  nt lds
M v[76:79], a[160:163], a[120:123], v[76:79]
 s_add_u32 s21, s21, 524160
M v[80:83], a[160:163], a[128:131], v[80:83]
M v[80:83], a[164:167], a[132:135], v[80:83]
M v[84:87], a[164:167], a[140:143], v[84:87]
M v[84:87], a[160:163], a[136:139], v[84:87]
M v[88:91], a[160:163], a[144:147], v[88:91]
M v[88:91], a[164:167], a[148:151], v[88:91]
 s_waitcnt lgkmcnt(2)
M v[92:95], a[164:167], a[156:159], v[92:95]
 s_waitcnt vmcnt(17) lgkmcnt(0)
M v[92:95], a[160:163], a[152:155], v[92:95]
 s_barrier
M v[96:99], a[168:171], a[96:99], v[96:99]
 ds_read_b128 a[160:163], v5 offset:49152
 ds_read_b128 a[164:167], v6 offset:49152
M v[96:99], a[172:175], a[100:103], v[96:99]
M v[100:103], a[172:175], a[108:111], v[100:103]
 s_add_u32 m0, s24, 32768
 ds_read_b64_tr_b16 a[64:65], v1 offset:16384
 ds_read_b64_tr_b16 a[66:67], v1 offset:17408
M v[100:103], a[168:171], a[104:107], v[100:103]
 buffer_load_dwordx4 v12, s[48:51], s22 offen offset:0   lds
M v[104:107], a[168:171], a[112:115], v[104:107]
M v[104:107], a[172:175], a[116:119], v[104:107]
M v[108:111], a[172:175], a[124:127], v[108:111]
M v[108:111], a[168:171], a[120:123], v[108:111]
M v[112:115], a[168:171], a[128:131], v[112:115]
M v[112:115], a[172:175], a[132:135], v[112:115]
 ds_read_b64_tr_b16 a[68:69], v1 offset:24576
 ds_read_b64_tr_b16 a[70:71], v1 offset:25600
M v[116:119], a[172:175], a[140:143], v[116:119]
 buffer_load_dwordx4 v13, s[48:51], s22 offen offset:1024   lds
M v[116:119], a[168:171], a[136:139], v[116:119]
M v[120:123], a[168:171], a[144:147], v[120:123]
M v[120:123], a[172:175], a[148:151], v[120:123]
 s_waitcnt lgkmcnt(4)
M v[124:127], a[172:175], a[156:159], v[124:127]
M v[124:127], a[168:171], a[152:155], v[124:127]
M v[128:131], a[160:163], a[96:99], v[128:131]
 ds_read_b128 a[168:171], v5 offset:51200
 ds_read_b128 a[172:175], v6 offset:51200
M v[128:131], a[164:167], a[100:103], v[128:131]
 ds_read_b64_tr_b16 a[72:73], v2 offset:16384
 ds_read_b64_tr_b16 a[74:75], v2 offset:17408
M v[132:135], a[164:167], a[108:111], v[132:135]
 buffer_load_dwordx4 v14, s[48:51], s22 offen offset:2048   lds
M v[132:135], a[160:163], a[104:107], v[132:135]
M v[136:139], a[160:163], a[112:115], v[136:139]
M v[136:139], a[164:167], a[116:119], v[136:139]
M v[140:143], a[164:167], a[124:127], v[140:143]
M v[140:143], a[160:163], a[120:123], v[140:143]
 ds_read_b64_tr_b16 a[76:77], v2 offset:24576
 ds_read_b64_tr_b16 a[78:79], v2 offset:25600
M v[144:147], a[160:163], a[128:131], v[144:147]
 buffer_load_dwordx4 v15, s[48:51], s22 offen offset:3072   lds
M v[144:147], a[164:167], a[132:135], v[144:147]
 s_add_u32 s22, s22, 2097152
M v[148:151], a[164:167], a[140:143], v[148:151]
M v[148:151], a[160:163], a[136:139], v[148:151]
M v[152:155], a[160:163], a[144:147], v[152:155]
M v[152:155], a[164:167], a[148:151], v[152:155]
 s_waitcnt lgkmcnt(4)
M v[156:159], a[164:167], a[156:159], v[156:159]
 s_add_u32 m0, s23, 0
 ds_read_b64_tr_b16 a[80:81], v3 offset:16384
 ds_read_b64_tr_b16 a[82:83], v3 offset:17408
M v[156:159], a[160:163], a[152:155], v[156:159]
 buffer_load_dwordx4 v8, s[52:55], s28 offen offset:0   lds
M v[160:163], a[168:171], a[96:99], v[160:163]
 ds_read_b128 a[160:163], v5 offset:53248
 ds_read_b128 a[164:167], v6 offset:53248
M v[160:163], a[172:175], a[100:103], v[160:163]
M v[164:167], a[172:175], a[108:111], v[164:167]
M v[164:167], a[168:171], a[104:107], v[164:167]
M v[168:171], a[168:171], a[112:115], v[168:171]
M v[168:171], a[172:175], a[116:119], v[168:171]
 ds_read_b64_tr_b16 a[84:85], v3 offset:24576
 ds_read_b64_tr_b16 a[86:87], v3 offset:25600
M v[172:175], a[172:175], a[124:127], v[172:175]
 buffer_load_dwordx4 v9, s[52:55], s28 offen offset:1024   lds
M v[172:175], a[168:171], a[120:123], v[172:175]
M v[176:179], a[168:171], a[128:131], v[176:179]
M v[176:179], a[172:175], a[132:135], v[176:179]
M v[180:183], a[172:175], a[140:143], v[180:183]
M v[180:183], a[168:171], a[136:139], v[180:183]
M v[184:187], a[168:171], a[144:147], v[184:187]
 ds_read_b64_tr_b16 a[88:89], v4 offset:16384
 ds_read_b64_tr_b16 a[90:91], v4 offset:17408
M v[184:187], a[172:175], a[148:151], v[184:187]
 s_waitcnt lgkmcnt(4)
 buffer_load_dwordx4 v10, s[52:55], s28 offen offset:2048   lds
M v[188:191], a[172:175], a[156:159], v[188:191]
M v[188:191], a[168:171], a[152:155], v[188:191]
M v[192:195], a[160:163], a[96:99], v[192:195]
 ds_read_b128 a[168:171], v5 offset:55296
 ds_read_b128 a[172:175], v6 offset:55296
M v[192:195], a[164:167], a[100:103], v[192:195]
M v[196:199], a[164:167], a[108:111], v[196:199]
M v[196:199], a[160:163], a[104:107], v[196:199]
 ds_read_b64_tr_b16 a[92:93], v4 offset:24576
 ds_read_b64_tr_b16 a[94:95], v4 offset:25600
M v[200:203], a[160:163], a[112:115], v[200:203]
 buffer_load_dwordx4 v11, s[52:55], s28 offen offset:3072   lds
M v[200:203], a[164:167], a[116:119], v[200:203]
 s_add_u32 s28, s28, 128
M v[204:207], a[164:167], a[124:127], v[204:207]
M v[204:207], a[160:163], a[120:123], v[204:207]
M v[208:211], a[160:163], a[128:131], v[208:211]
M v[208:211], a[164:167], a[132:135], v[208:211]
M v[212:215], a[164:167], a[140:143], v[212:215]
M v[212:215], a[160:163], a[136:139], v[212:215]
M v[216:219], a[160:163], a[144:147], v[216:219]
M v[216:219], a[164:167], a[148:151], v[216:219]
 s_waitcnt lgkmcnt(2)
M v[220:223], a[164:167], a[156:159], v[220:223]
 s_waitcnt vmcnt(17) lgkmcnt(0)
M v[220:223], a[160:163], a[152:155], v[220:223]
 s_barrier
M v[224:227], a[168:171], a[96:99], v[224:227]
 ds_read_b128 a[160:163], v5 offset:0
 ds_read_b128 a[164:167], v6 offset:0
M v[224:227], a[172:175], a[100:103], v[224:227]
 v_lshl_add_u32 v27, v0, 7, s95
 v_and_b32 v26, 48, v0
M v[228:231], a[172:175], a[108:111], v[228:231]
 v_lshl_add_u32 v26, v26, 24, v27
M v[228:231], a[168:171], a[104:107], v[228:231]
 buffer_load_dword a240, v26, s[76:79], 0 offen offset:0
M v[232:235], a[168:171], a[112:115], v[232:235]
M v[232:235], a[172:175], a[116:119], v[232:235]
M v[236:239], a[172:175], a[124:127], v[236:239]
M v[236:239], a[168:171], a[120:123], v[236:239]
M v[240:243], a[168:171], a[128:131], v[240:243]
M v[240:243], a[172:175], a[132:135], v[240:243]
M v[244:247], a[172:175], a[140:143], v[244:247]
M v[244:247], a[168:171], a[136:139], v[244:247]
M v[248:251], a[168:171], a[144:147], v[248:251]
M v[248:251], a[172:175], a[148:151], v[248:251]
 s_waitcnt lgkmcnt(0)
M v[252:255], a[172:175], a[156:159], v[252:255]
M v[252:255], a[168:171], a[152:155], v[252:255]
M a[0:3], a[160:163], a[32:35], a[0:3]
 ds_read_b128 a[168:171], v5 offset:2048
 ds_read_b128 a[172:175], v6 offset:2048
M a[0:3], a[164:167], a[36:39], a[0:3]
 ds_read_b64_tr_b16 a[96:97], v1 offset:32768
 ds_read_b64_tr_b16 a[98:99], v1 offset:33792
M a[4:7], a[164:167], a[44:47], a[4:7]
 s_add_u32 m0, s24, 49152
 v_lshrrev_b32 v28, 4, v0
 v_add_u32 v28, 0, v28
M a[4:7], a[160:163], a[40:43], a[4:7]
 buffer_load_dwordx4 v12, s[48:51], s22 offen offset:0   lds
M a[8:11], a[160:163], a[48:51], a[8:11]
 v_and_b32 v29, 7, v0
 v_xor_b32 v28, v28, v29
M a[8:11], a[164:167], a[52:55], a[8:11]
 v_lshlrev_b32 v28, 4, v28
 v_lshrrev_b32 v29, 3, v0
M a[12:15], a[164:167], a[60:63], a[12:15]
 ds_read_b64_tr_b16 a[100:101], v1 offset:40960
 ds_read_b64_tr_b16 a[102:103], v1 offset:41984
M a[12:15], a[160:163], a[56:59], a[12:15]
 buffer_load_dwordx4 v13, s[48:51], s22 offen offset:1024   lds
M a[16:19], a[160:163], a[64:67], a[16:19]
 v_mul_u32_u24 v29, 896, v29
M a[16:19], a[164:167], a[68:71], a[16:19]
 s_mul_i32 s64, s20, 28672
 buffer_load_dwordx4 v14, s[48:51], s22 offen offset:2048   lds
M a[20:23], a[164:167], a[76:79], a[20:23]
 s_add_u32 s64, s64, 0
 v_add3_u32 v16, v29, v28, s64
 v_add_u32 v18, 12288, v16
M a[20:23], a[160:163], a[72:75], a[20:23]
 ds_read_b64_tr_b16 a[104:105], v2 offset:32768
 ds_read_b64_tr_b16 a[106:107], v2 offset:33792
M a[24:27], a[160:163], a[80:83], a[24:27]
 v_lshrrev_b32 v28, 4, v0
 v_add_u32 v28, 4, v28
M a[24:27], a[164:167], a[84:87], a[24:27]
 s_waitcnt lgkmcnt(6)
 buffer_load_dwordx4 v15, s[48:51], s22 offen offset:3072   lds
M a[28:31], a[164:167], a[92:95], a[28:31]
 s_sub_u32 s22, s22, 2097024
 v_and_b32 v29, 7, v0
 v_xor_b32 v28, v28, v29
M a[28:31], a[160:163], a[88:91], a[28:31]
 s_add_u32 m0, s23, 16384
 v_lshlrev_b32 v28, 4, v28
 v_lshrrev_b32 v29, 3, v0
M v[32:35], a[168:171], a[32:35], v[32:35]
 ds_read_b128 a[160:163], v5 offset:4096
 ds_read_b128 a[164:167], v6 offset:4096
M v[32:35], a[172:175], a[36:39], v[32:35]
 ds_read_b64_tr_b16 a[108:109], v2 offset:40960
 ds_read_b64_tr_b16 a[110:111], v2 offset:41984
M v[36:39], a[172:175], a[44:47], v[36:39]
 buffer_load_dwordx4 v8, s[52:55], s28 offen offset:0   lds
M v[36:39], a[168:171], a[40:43], v[36:39]
 v_mul_u32_u24 v29, 896, v29
M v[40:43], a[168:171], a[48:51], v[40:43]
 s_mul_i32 s64, s20, 28672
 buffer_load_dwordx4 v9, s[52:55], s28 offen offset:1024   lds
M v[40:43], a[172:175], a[52:55], v[40:43]
 s_add_u32 s64, s64, 6144
 ds_read_b64_tr_b16 a[112:113], v3 offset:32768
 ds_read_b64_tr_b16 a[114:115], v3 offset:33792
M v[44:47], a[172:175], a[60:63], v[44:47]
 v_add3_u32 v17, v29, v28, s64
 v_add_u32 v19, 12288, v17
M v[44:47], a[168:171], a[56:59], v[44:47]
 buffer_load_dwordx4 v10, s[52:55], s28 offen offset:2048   lds
M v[48:51], a[168:171], a[64:67], v[48:51]
 v_add_u32 v20, 0x20000, v1
 v_add_u32 v21, 0x20000, v2
M v[48:51], a[172:175], a[68:71], v[48:51]
 v_add_u32 v22, 0x20000, v3
 v_add_u32 v23, 0x20000, v4
M v[52:55], a[172:175], a[76:79], v[52:55]
 ds_read_b64_tr_b16 a[116:117], v3 offset:40960
 ds_read_b64_tr_b16 a[118:119], v3 offset:41984
M v[52:55], a[168:171], a[72:75], v[52:55]
 buffer_load_dwordx4 v11, s[52:55], s28 offen offset:3072   lds
M v[56:59], a[168:171], a[80:83], v[56:59]
 s_add_u32 s28, s28, 1048448
M v[56:59], a[172:175], a[84:87], v[56:59]
 s_waitcnt lgkmcnt(6)
M v[60:63], a[172:175], a[92:95], v[60:63]
 s_add_u32 m0, s23, 131072
M v[60:63], a[168:171], a[88:91], v[60:63]
 ds_read_b64_tr_b16 a[120:121], v4 offset:32768
 ds_read_b64_tr_b16 a[122:123], v4 offset:33792
M v[64:67], a[160:163], a[32:35], v[64:67]
 ds_read_b128 a[168:171], v5 offset:6144
 ds_read_b128 a[172:175], v6 offset:6144
M v[64:67], a[164:167], a[36:39], v[64:67]
 buffer_load_dwordx4 v8, s[52:55], s28 offen offset:0   lds
M v[68:71], a[164:167], a[44:47], v[68:71]
 buffer_load_dwordx4 v9, s[52:55], s28 offen offset:1024   lds
M v[68:71], a[160:163], a[40:43], v[68:71]
M v[72:75], a[160:163], a[48:51], v[72:75]
 ds_read_b64_tr_b16 a[124:125], v4 offset:40960
 ds_read_b64_tr_b16 a[126:127], v4 offset:41984
M v[72:75], a[164:167], a[52:55], v[72:75]
 buffer_load_dwordx4 v10, s[52:55], s28 offen offset:2048   lds
M v[76:79], a[164:167], a[60:63], v[76:79]
M v[76:79], a[160:163], a[56:59], v[76:79]
M v[80:83], a[160:163], a[64:67], v[80:83]
 buffer_load_dwordx4 v11, s[52:55], s28 offen offset:3072   lds
M v[80:83], a[164:167], a[68:71], v[80:83]
 s_sub_u32 s28, s28, 524288
M v[84:87], a[164:167], a[76:79], v[84:87]
M v[84:87], a[160:163], a[72:75], v[84:87]
M v[88:91], a[160:163], a[80:83], v[88:91]
M v[88:91], a[164:167], a[84:87], v[88:91]
 s_waitcnt lgkmcnt(2)
M v[92:95], a[164:167], a[92:95], v[92:95]
 s_waitcnt vmcnt(21) lgkmcnt(0)
M v[92:95], a[160:163], a[88:91], v[92:95]
 s_barrier
M v[96:99], a[168:171], a[32:35], v[96:99]
 ds_read_b128 a[160:163], v5 offset:16384
 ds_read_b128 a[164:167], v6 offset:16384
M v[96:99], a[172:175], a[36:39], v[96:99]
M v[100:103], a[172:175], a[44:47], v[100:103]
 s_add_u32 m0, s24, 0
 ds_read_b64_tr_b16 a[128:129], v1 offset:49152
 ds_read_b64_tr_b16 a[130:131], v1 offset:50176
M v[100:103], a[168:171], a[40:43], v[100:103]
 buffer_load_dwordx4 v16, s[56:59], s29 offen offset:0   lds
M v[104:107], a[168:171], a[48:51], v[104:107]
M v[104:107], a[172:175], a[52:55], v[104:107]
M v[108:111], a[172:175], a[60:63], v[108:111]
M v[108:111], a[168:171], a[56:59], v[108:111]
 buffer_load_dwordx4 v17, s[56:59], s29 offen offset:1024   lds
M v[112:115], a[168:171], a[64:67], v[112:115]
M v[112:115], a[172:175], a[68:71], v[112:115]
 ds_read_b64_tr_b16 a[132:133], v1 offset:57344
 ds_read_b64_tr_b16 a[134:135], v1 offset:58368
M v[116:119], a[172:175], a[76:79], v[116:119]
M v[116:119], a[168:171], a[72:75], v[116:119]
M v[120:123], a[168:171], a[80:83], v[120:123]
 buffer_load_dwordx4 v18, s[56:59], s29 offen offset:2048   lds
M v[120:123], a[172:175], a[84:87], v[120:123]
 s_waitcnt lgkmcnt(4)
M v[124:127], a[172:175], a[92:95], v[124:127]
M v[124:127], a[168:171], a[88:91], v[124:127]
M v[128:131], a[160:163], a[32:35], v[128:131]
 ds_read_b128 a[168:171], v5 offset:18432
 ds_read_b128 a[172:175], v6 offset:18432
M v[128:131], a[164:167], a[36:39], v[128:131]
 ds_read_b64_tr_b16 a[136:137], v2 offset:49152
 ds_read_b64_tr_b16 a[138:139], v2 offset:50176
M v[132:135], a[164:167], a[44:47], v[132:135]
 buffer_load_dwordx4 v19, s[56:59], s29 offen offset:3072   lds
M v[132:135], a[160:163], a[40:43], v[132:135]
 s_add_u32 s29, s29, 128
M v[136:139], a[160:163], a[48:51], v[136:139]
M v[136:139], a[164:167], a[52:55], v[136:139]
 s_add_u32 m0, s23, 32768
M v[140:143], a[164:167], a[60:63], v[140:143]
 buffer_load_dwordx4 v8, s[52:55], s28 offen offset:0   lds
M v[140:143], a[160:163], a[56:59], v[140:143]
 ds_read_b64_tr_b16 a[140:141], v2 offset:57344
 ds_read_b64_tr_b16 a[142:143], v2 offset:58368
M v[144:147], a[160:163], a[64:67], v[144:147]
M v[144:147], a[164:167], a[68:71], v[144:147]
M v[148:151], a[164:167], a[76:79], v[148:151]
 buffer_load_dwordx4 v9, s[52:55], s28 offen offset:1024   lds
M v[148:151], a[160:163], a[72:75], v[148:151]
M v[152:155], a[160:163], a[80:83], v[152:155]
M v[152:155], a[164:167], a[84:87], v[152:155]
 s_waitcnt lgkmcnt(4)
M v[156:159], a[164:167], a[92:95], v[156:159]
 ds_read_b64_tr_b16 a[144:145], v3 offset:49152
 ds_read_b64_tr_b16 a[146:147], v3 offset:50176
M v[156:159], a[160:163], a[88:91], v[156:159]
 buffer_load_dwordx4 v10, s[52:55], s28 offen offset:2048   lds
M v[160:163], a[168:171], a[32:35], v[160:163]
 ds_read_b128 a[160:163], v5 offset:20480
 ds_read_b128 a[164:167], v6 offset:20480
M v[160:163], a[172:175], a[36:39], v[160:163]
M v[164:167], a[172:175], a[44:47], v[164:167]
M v[164:167], a[168:171], a[40:43], v[164:167]
M v[168:171], a[168:171], a[48:51], v[168:171]
 buffer_load_dwordx4 v11, s[52:55], s28 offen offset:3072   lds
M v[168:171], a[172:175], a[52:55], v[168:171]
 s_add_u32 s28, s28, 524416
 ds_read_b64_tr_b16 a[148:149], v3 offset:57344
 ds_read_b64_tr_b16 a[150:151], v3 offset:58368
M v[172:175], a[172:175], a[60:63], v[172:175]
M v[172:175], a[168:171], a[56:59], v[172:175]
M v[176:179], a[168:171], a[64:67], v[176:179]
 s_add_u32 m0, s23, 147456
M v[176:179], a[172:175], a[68:71], v[176:179]
 buffer_load_dwordx4 v8, s[52:55], s28 offen offset:0   lds
M v[180:183], a[172:175], a[76:79], v[180:183]
M v[180:183], a[168:171], a[72:75], v[180:183]
M v[184:187], a[168:171], a[80:83], v[184:187]
 ds_read_b64_tr_b16 a[152:153], v4 offset:49152
 ds_read_b64_tr_b16 a[154:155], v4 offset:50176
M v[184:187], a[172:175], a[84:87], v[184:187]
 s_waitcnt lgkmcnt(4)
 buffer_load_dwordx4 v9, s[52:55], s28 offen offset:1024   lds
M v[188:191], a[172:175], a[92:95], v[188:191]
M v[188:191], a[168:171], a[88:91], v[188:191]
M v[192:195], a[160:163], a[32:35], v[192:195]
 ds_read_b128 a[168:171], v5 offset:22528
 ds_read_b128 a[172:175], v6 offset:22528
M v[192:195], a[164:167], a[36:39], v[192:195]
M v[196:199], a[164:167], a[44:47], v[196:199]
 buffer_load_dwordx4 v10, s[52:55], s28 offen offset:2048   lds
M v[196:199], a[160:163], a[40:43], v[196:199]
 ds_read_b64_tr_b16 a[156:157], v4 offset:57344
 ds_read_b64_tr_b16 a[158:159], v4 offset:58368
M v[200:203], a[160:163], a[48:51], v[200:203]
M v[200:203], a[164:167], a[52:55], v[200:203]
M v[204:207], a[164:167], a[60:63], v[204:207]
M v[204:207], a[160:163], a[56:59], v[204:207]
 buffer_load_dwordx4 v11, s[52:55], s28 offen offset:3072   lds
M v[208:211], a[160:163], a[64:67], v[208:211]
 s_sub_u32 s28, s28, 524288
M v[208:211], a[164:167], a[68:71], v[208:211]
M v[212:215], a[164:167], a[76:79], v[212:215]
M v[212:215], a[160:163], a[72:75], v[212:215]
M v[216:219], a[160:163], a[80:83], v[216:219]
M v[216:219], a[164:167], a[84:87], v[216:219]
 s_waitcnt lgkmcnt(2)
M v[220:223], a[164:167], a[92:95], v[220:223]
 s_waitcnt vmcnt(25) lgkmcnt(0)
M v[220:223], a[160:163], a[88:91], v[220:223]
 s_barrier
M v[224:227], a[168:171], a[32:35], v[224:227]
 ds_read_b128 a[160:163], v5 offset:32768
 ds_read_b128 a[164:167], v6 offset:32768
M v[224:227], a[172:175], a[36:39], v[224:227]
M v[228:231], a[172:175], a[44:47], v[228:231]
M v[228:231], a[168:171], a[40:43], v[228:231]
M v[232:235], a[168:171], a[48:51], v[232:235]
M v[232:235], a[172:175], a[52:55], v[232:235]
M v[236:239], a[172:175], a[60:63], v[236:239]
M v[236:239], a[168:171], a[56:59], v[236:239]
M v[240:243], a[168:171], a[64:67], v[240:243]
M v[240:243], a[172:175], a[68:71], v[240:243]
M v[244:247], a[172:175], a[76:79], v[244:247]
M v[244:247], a[168:171], a[72:75], v[244:247]
M v[248:251], a[168:171], a[80:83], v[248:251]
M v[248:251], a[172:175], a[84:87], v[248:251]
 s_waitcnt lgkmcnt(0)
M v[252:255], a[172:175], a[92:95], v[252:255]
M v[252:255], a[168:171], a[88:91], v[252:255]
M a[0:3], a[160:163], a[96:99], a[0:3]
 ds_read_b128 a[168:171], v5 offset:34816
 ds_read_b128 a[172:175], v6 offset:34816
M a[0:3], a[164:167], a[100:103], a[0:3]
 ds_read_b64_tr_b16 a[32:33], v1 offset:0
 ds_read_b64_tr_b16 a[34:35], v1 offset:1024
M a[4:7], a[164:167], a[108:111], a[4:7]
 s_add_u32 m0, s24, 16384
M a[4:7], a[160:163], a[104:107], a[4:7]
 buffer_load_dwordx4 v16, s[56:59], s29 offen offset:0   lds
M a[8:11], a[160:163], a[112:115], a[8:11]
M a[8:11], a[164:167], a[116:119], a[8:11]
M a[12:15], a[164:167], a[124:127], a[12:15]
 ds_read_b64_tr_b16 a[36:37], v1 offset:8192
 ds_read_b64_tr_b16 a[38:39], v1 offset:9216
M a[12:15], a[160:163], a[120:123], a[12:15]
M a[16:19], a[160:163], a[128:131], a[16:19]
 buffer_load_dwordx4 v17, s[56:59], s29 offen offset:1024   lds
M a[16:19], a[164:167], a[132:135], a[16:19]
M a[20:23], a[164:167], a[140:143], a[20:23]
M a[20:23], a[160:163], a[136:139], a[20:23]
 ds_read_b64_tr_b16 a[40:41], v2 offset:0
 ds_read_b64_tr_b16 a[42:43], v2 offset:1024
M a[24:27], a[160:163], a[144:147], a[24:27]
M a[24:27], a[164:167], a[148:151], a[24:27]
 s_waitcnt lgkmcnt(6)
 buffer_load_dwordx4 v18, s[56:59], s29 offen offset:2048   lds
M a[28:31], a[164:167], a[156:159], a[28:31]
M a[28:31], a[160:163], a[152:155], a[28:31]
M v[32:35], a[168:171], a[96:99], v[32:35]
 ds_read_b128 a[160:163], v5 offset:36864
 ds_read_b128 a[164:167], v6 offset:36864
M v[32:35], a[172:175], a[100:103], v[32:35]
 ds_read_b64_tr_b16 a[44:45], v2 offset:8192
 ds_read_b64_tr_b16 a[46:47], v2 offset:9216
M v[36:39], a[172:175], a[108:111], v[36:39]
 buffer_load_dwordx4 v19, s[56:59], s29 offen offset:3072   lds
M v[36:39], a[168:171], a[104:107], v[36:39]
 s_add_u32 s29, s29, 128
M v[40:43], a[168:171], a[112:115], v[40:43]
M v[40:43], a[172:175], a[116:119], v[40:43]
 ds_read_b64_tr_b16 a[48:49], v3 offset:0
 ds_read_b64_tr_b16 a[50:51], v3 offset:1024
M v[44:47], a[172:175], a[124:127], v[44:47]
 s_add_u32 m0, s23, 49152
 v_accvgpr_read_b32 v24, a0
 v_accvgpr_read_b32 v25, a1
M v[44:47], a[168:171], a[120:123], v[44:47]
 buffer_load_dwordx4 v8, s[52:55], s28 offen offset:0   lds
M v[48:51], a[168:171], a[128:131], v[48:51]
 v_accvgpr_read_b32 v26, a2
 v_accvgpr_read_b32 v27, a3
M v[48:51], a[172:175], a[132:135], v[48:51]
 v_cvt_pk_bf16_f32 v24, v24, v25
 v_cvt_pk_bf16_f32 v25, v26, v27
M v[52:55], a[172:175], a[140:143], v[52:55]
 ds_read_b64_tr_b16 a[52:53], v3 offset:8192
 ds_read_b64_tr_b16 a[54:55], v3 offset:9216
M v[52:55], a[168:171], a[136:139], v[52:55]
 v_cvt_pk_bf16_f32 v26, v32, v33
 v_cvt_pk_bf16_f32 v27, v34, v35
M v[56:59], a[168:171], a[144:147], v[56:59]
 s_add_u32 s3, s93, 0
 buffer_load_dwordx4 v9, s[52:55], s28 offen offset:1024   lds
M v[56:59], a[172:175], a[148:151], v[56:59]
 s_waitcnt lgkmcnt(6)
M v[60:63], a[172:175], a[156:159], v[60:63]
 buffer_store_dwordx4 v[24:27], v7, s[8:11], s3 offen offset:0 sc1
M v[60:63], a[168:171], a[152:155], v[60:63]
 ds_read_b64_tr_b16 a[56:57], v4 offset:0
 ds_read_b64_tr_b16 a[58:59], v4 offset:1024
M v[64:67], a[160:163], a[96:99], v[64:67]
 ds_read_b128 a[168:171], v5 offset:38912
 ds_read_b128 a[172:175], v6 offset:38912
M v[64:67], a[164:167], a[100:103], v[64:67]
 buffer_load_dwordx4 v10, s[52:55], s28 offen offset:2048   lds
M v[68:71], a[164:167], a[108:111], v[68:71]
 v_accvgpr_read_b32 v24, a4
 v_accvgpr_read_b32 v25, a5
M v[68:71], a[160:163], a[104:107], v[68:71]
 v_accvgpr_read_b32 v26, a6
 v_accvgpr_read_b32 v27, a7
M v[72:75], a[160:163], a[112:115], v[72:75]
 ds_read_b64_tr_b16 a[60:61], v4 offset:8192
 ds_read_b64_tr_b16 a[62:63], v4 offset:9216
M v[72:75], a[164:167], a[116:119], v[72:75]
 v_cvt_pk_bf16_f32 v24, v24, v25
 v_cvt_pk_bf16_f32 v25, v26, v27
M v[76:79], a[164:167], a[124:127], v[76:79]
 buffer_load_dwordx4 v11, s[52:55], s28 offen offset:3072   lds
M v[76:79], a[160:163], a[120:123], v[76:79]
 s_add_u32 s28, s28, 1048448
 v_cvt_pk_bf16_f32 v26, v36, v37
 v_cvt_pk_bf16_f32 v27, v38, v39
M v[80:83], a[160:163], a[128:131], v[80:83]
M v[80:83], a[164:167], a[132:135], v[80:83]
M v[84:87], a[164:167], a[140:143], v[84:87]
 buffer_store_dwordx4 v[24:27], v7, s[8:11], s3 offen offset:2048 sc1
M v[84:87], a[160:163], a[136:139], v[84:87]
 s_nop 0
 v_accvgpr_read_b32 v24, a8
 v_accvgpr_read_b32 v25, a9
M v[88:91], a[160:163], a[144:147], v[88:91]
 v_accvgpr_read_b32 v26, a10
 v_accvgpr_read_b32 v27, a11
M v[88:91], a[164:167], a[148:151], v[88:91]
 s_waitcnt lgkmcnt(2)
 v_cvt_pk_bf16_f32 v24, v24, v25
 v_cvt_pk_bf16_f32 v25, v26, v27
M v[92:95], a[164:167], a[156:159], v[92:95]
 s_waitcnt vmcnt(26) lgkmcnt(0)
 v_cvt_pk_bf16_f32 v26, v40, v41
 v_cvt_pk_bf16_f32 v27, v42, v43
M v[92:95], a[160:163], a[152:155], v[92:95]
 s_barrier
M v[96:99], a[168:171], a[96:99], v[96:99]
 ds_read_b128 a[160:163], v5 offset:49152
 ds_read_b128 a[164:167], v6 offset:49152
M v[96:99], a[172:175], a[100:103], v[96:99]
 s_add_u32 s3, s93, 4096
M v[100:103], a[172:175], a[108:111], v[100:103]
 s_add_u32 m0, s24, 32768
 ds_read_b64_tr_b16 a[64:65], v1 offset:16384
 ds_read_b64_tr_b16 a[66:67], v1 offset:17408
M v[100:103], a[168:171], a[104:107], v[100:103]
 buffer_load_dwordx4 v16, s[56:59], s29 offen offset:0   lds
M v[104:107], a[168:171], a[112:115], v[104:107]
M v[104:107], a[172:175], a[116:119], v[104:107]
 v_cvt_pk_bf16_f32 v64, v64, v65
 v_cvt_pk_bf16_f32 v65, v66, v67
M v[108:111], a[172:175], a[124:127], v[108:111]
 buffer_store_dwordx4 v[24:27], v7, s[8:11], s3 offen offset:0 sc1
M v[108:111], a[168:171], a[120:123], v[108:111]
 s_nop 0
 v_accvgpr_read_b32 v24, a12
 v_accvgpr_read_b32 v25, a13
M v[112:115], a[168:171], a[128:131], v[112:115]
 v_accvgpr_read_b32 v26, a14
 v_accvgpr_read_b32 v27, a15
M v[112:115], a[172:175], a[132:135], v[112:115]
 ds_read_b64_tr_b16 a[68:69], v1 offset:24576
 ds_read_b64_tr_b16 a[70:71], v1 offset:25600
M v[116:119], a[172:175], a[140:143], v[116:119]
 buffer_load_dwordx4 v17, s[56:59], s29 offen offset:1024   lds
M v[116:119], a[168:171], a[136:139], v[116:119]
 v_cvt_pk_bf16_f32 v24, v24, v25
 v_cvt_pk_bf16_f32 v25, v26, v27
M v[120:123], a[168:171], a[144:147], v[120:123]
 v_cvt_pk_bf16_f32 v26, v44, v45
 v_cvt_pk_bf16_f32 v27, v46, v47
M v[120:123], a[172:175], a[148:151], v[120:123]
 s_waitcnt lgkmcnt(4)
 v_cvt_pk_bf16_f32 v66, v96, v97
 v_cvt_pk_bf16_f32 v67, v98, v99
M v[124:127], a[172:175], a[156:159], v[124:127]
 buffer_store_dwordx4 v[24:27], v7, s[8:11], s3 offen offset:2048 sc1
M v[124:127], a[168:171], a[152:155], v[124:127]
 s_nop 0
 v_accvgpr_read_b32 v24, a16
 v_accvgpr_read_b32 v25, a17
M v[128:131], a[160:163], a[96:99], v[128:131]
 ds_read_b128 a[168:171], v5 offset:51200
 ds_read_b128 a[172:175], v6 offset:51200
M v[128:131], a[164:167], a[100:103], v[128:131]
 ds_read_b64_tr_b16 a[72:73], v2 offset:16384
 ds_read_b64_tr_b16 a[74:75], v2 offset:17408
M v[132:135], a[164:167], a[108:111], v[132:135]
 buffer_load_dwordx4 v18, s[56:59], s29 offen offset:2048   lds
M v[132:135], a[160:163], a[104:107], v[132:135]
 v_accvgpr_read_b32 v26, a18
 v_accvgpr_read_b32 v27, a19
M v[136:139], a[160:163], a[112:115], v[136:139]
 v_cvt_pk_bf16_f32 v24, v24, v25
 v_cvt_pk_bf16_f32 v25, v26, v27
M v[136:139], a[164:167], a[116:119], v[136:139]
 v_cvt_pk_bf16_f32 v26, v48, v49
 v_cvt_pk_bf16_f32 v27, v50, v51
M v[140:143], a[164:167], a[124:127], v[140:143]
 v_accvgpr_write_b32 a16, v24
 v_accvgpr_write_b32 a17, v25
M v[140:143], a[160:163], a[120:123], v[140:143]
 ds_read_b64_tr_b16 a[76:77], v2 offset:24576
 ds_read_b64_tr_b16 a[78:79], v2 offset:25600
M v[144:147], a[160:163], a[128:131], v[144:147]
 buffer_load_dwordx4 v19, s[56:59], s29 offen offset:3072   lds
M v[144:147], a[164:167], a[132:135], v[144:147]
 s_add_u32 s29, s29, 128
 v_accvgpr_write_b32 a18, v26
 v_accvgpr_write_b32 a19, v27
M v[148:151], a[164:167], a[140:143], v[148:151]
 v_accvgpr_read_b32 v24, a20
 v_accvgpr_read_b32 v25, a21
M v[148:151], a[160:163], a[136:139], v[148:151]
 v_accvgpr_read_b32 v26, a22
 v_accvgpr_read_b32 v27, a23
M v[152:155], a[160:163], a[144:147], v[152:155]
 v_cvt_pk_bf16_f32 v24, v24, v25
 v_cvt_pk_bf16_f32 v25, v26, v27
M v[152:155], a[164:167], a[148:151], v[152:155]
 s_waitcnt lgkmcnt(4)
 v_cvt_pk_bf16_f32 v26, v52, v53
 v_cvt_pk_bf16_f32 v27, v54, v55
M v[156:159], a[164:167], a[156:159], v[156:159]
 s_add_u32 m0, s23, 0
 ds_read_b64_tr_b16 a[80:81], v3 offset:16384
 ds_read_b64_tr_b16 a[82:83], v3 offset:17408
M v[156:159], a[160:163], a[152:155], v[156:159]
 buffer_load_dwordx4 v8, s[52:55], s28 offen offset:0   lds
M v[160:163], a[168:171], a[96:99], v[160:163]
 ds_read_b128 a[160:163], v5 offset:53248
 ds_read_b128 a[164:167], v6 offset:53248
M v[160:163], a[172:175], a[100:103], v[160:163]
 v_accvgpr_write_b32 a20, v24
 v_accvgpr_write_b32 a21, v25
M v[164:167], a[172:175], a[108:111], v[164:167]
 v_accvgpr_write_b32 a22, v26
 v_accvgpr_write_b32 a23, v27
M v[164:167], a[168:171], a[104:107], v[164:167]
 v_accvgpr_read_b32 v24, a24
 v_accvgpr_read_b32 v25, a25
M v[168:171], a[168:171], a[112:115], v[168:171]
 v_accvgpr_read_b32 v26, a26
 v_accvgpr_read_b32 v27, a27
M v[168:171], a[172:175], a[116:119], v[168:171]
 ds_read_b64_tr_b16 a[84:85], v3 offset:24576
 ds_read_b64_tr_b16 a[86:87], v3 offset:25600
M v[172:175], a[172:175], a[124:127], v[172:175]
 buffer_load_dwordx4 v9, s[52:55], s28 offen offset:1024   lds
M v[172:175], a[168:171], a[120:123], v[172:175]
 v_cvt_pk_bf16_f32 v24, v24, v25
 v_cvt_pk_bf16_f32 v25, v26, v27
M v[176:179], a[168:171], a[128:131], v[176:179]
 v_cvt_pk_bf16_f32 v26, v56, v57
 v_cvt_pk_bf16_f32 v27, v58, v59
M v[176:179], a[172:175], a[132:135], v[176:179]
 v_accvgpr_write_b32 a24, v24
 v_accvgpr_write_b32 a25, v25
M v[180:183], a[172:175], a[140:143], v[180:183]
 v_accvgpr_write_b32 a26, v26
 v_accvgpr_write_b32 a27, v27
M v[180:183], a[168:171], a[136:139], v[180:183]
 v_accvgpr_read_b32 v24, a28
 v_accvgpr_read_b32 v25, a29
M v[184:187], a[168:171], a[144:147], v[184:187]
 ds_read_b64_tr_b16 a[88:89], v4 offset:16384
 ds_read_b64_tr_b16 a[90:91], v4 offset:17408
M v[184:187], a[172:175], a[148:151], v[184:187]
 s_waitcnt lgkmcnt(4)
 buffer_load_dwordx4 v10, s[52:55], s28 offen offset:2048   lds
M v[188:191], a[172:175], a[156:159], v[188:191]
 v_accvgpr_read_b32 v26, a30
 v_accvgpr_read_b32 v27, a31
M v[188:191], a[168:171], a[152:155], v[188:191]
 v_cvt_pk_bf16_f32 v24, v24, v25
 v_cvt_pk_bf16_f32 v25, v26, v27
M v[192:195], a[160:163], a[96:99], v[192:195]
 ds_read_b128 a[168:171], v5 offset:55296
 ds_read_b128 a[172:175], v6 offset:55296
M v[192:195], a[164:167], a[100:103], v[192:195]
 v_cvt_pk_bf16_f32 v26, v60, v61
 v_cvt_pk_bf16_f32 v27, v62, v63
M v[196:199], a[164:167], a[108:111], v[196:199]
 v_accvgpr_write_b32 a28, v24
 v_accvgpr_write_b32 a29, v25
M v[196:199], a[160:163], a[104:107], v[196:199]
 ds_read_b64_tr_b16 a[92:93], v4 offset:24576
 ds_read_b64_tr_b16 a[94:95], v4 offset:25600
M v[200:203], a[160:163], a[112:115], v[200:203]
 buffer_load_dwordx4 v11, s[52:55], s28 offen offset:3072   lds
M v[200:203], a[164:167], a[116:119], v[200:203]
 s_add_u32 s28, s28, 128
 v_accvgpr_write_b32 a30, v26
 v_accvgpr_write_b32 a31, v27
M v[204:207], a[164:167], a[124:127], v[204:207]
 v_cvt_pk_bf16_f32 v68, v68, v69
 v_cvt_pk_bf16_f32 v69, v70, v71
M v[204:207], a[160:163], a[120:123], v[204:207]
 v_cvt_pk_bf16_f32 v70, v100, v101
 v_cvt_pk_bf16_f32 v71, v102, v103
M v[208:211], a[160:163], a[128:131], v[208:211]
 v_cvt_pk_bf16_f32 v72, v72, v73
 v_cvt_pk_bf16_f32 v73, v74, v75
M v[208:211], a[164:167], a[132:135], v[208:211]
 v_cvt_pk_bf16_f32 v74, v104, v105
 v_cvt_pk_bf16_f32 v75, v106, v107
M v[212:215], a[164:167], a[140:143], v[212:215]
 v_cvt_pk_bf16_f32 v76, v76, v77
 v_cvt_pk_bf16_f32 v77, v78, v79
M v[212:215], a[160:163], a[136:139], v[212:215]
 v_cvt_pk_bf16_f32 v78, v108, v109
 v_cvt_pk_bf16_f32 v79, v110, v111
M v[216:219], a[160:163], a[144:147], v[216:219]
 v_cvt_pk_bf16_f32 v80, v80, v81
 v_cvt_pk_bf16_f32 v81, v82, v83
M v[216:219], a[164:167], a[148:151], v[216:219]
 s_waitcnt lgkmcnt(2)
 v_cvt_pk_bf16_f32 v82, v112, v113
 v_cvt_pk_bf16_f32 v83, v114, v115
M v[220:223], a[164:167], a[156:159], v[220:223]
 s_waitcnt vmcnt(24) lgkmcnt(0)
 v_cvt_pk_bf16_f32 v84, v84, v85
 v_cvt_pk_bf16_f32 v85, v86, v87
M v[220:223], a[160:163], a[152:155], v[220:223]
 s_barrier
M v[224:227], a[168:171], a[96:99], v[224:227]
 ds_read_b128 a[160:163], v5 offset:0
 ds_read_b128 a[164:167], v6 offset:0
M v[224:227], a[172:175], a[100:103], v[224:227]
 v_cvt_pk_bf16_f32 v86, v116, v117
 v_cvt_pk_bf16_f32 v87, v118, v119
M v[228:231], a[172:175], a[108:111], v[228:231]
 v_cvt_pk_bf16_f32 v88, v88, v89
 v_cvt_pk_bf16_f32 v89, v90, v91
M v[228:231], a[168:171], a[104:107], v[228:231]
 v_cvt_pk_bf16_f32 v90, v120, v121
 v_cvt_pk_bf16_f32 v91, v122, v123
M v[232:235], a[168:171], a[112:115], v[232:235]
 v_cvt_pk_bf16_f32 v92, v92, v93
 v_cvt_pk_bf16_f32 v93, v94, v95
M v[232:235], a[172:175], a[116:119], v[232:235]
 v_cvt_pk_bf16_f32 v94, v124, v125
 v_cvt_pk_bf16_f32 v95, v126, v127
M v[236:239], a[172:175], a[124:127], v[236:239]
 v_cvt_pk_bf16_f32 v128, v128, v129
 v_cvt_pk_bf16_f32 v129, v130, v131
M v[236:239], a[168:171], a[120:123], v[236:239]
 v_cvt_pk_bf16_f32 v130, v160, v161
 v_cvt_pk_bf16_f32 v131, v162, v163
M v[240:243], a[168:171], a[128:131], v[240:243]
 v_cvt_pk_bf16_f32 v132, v132, v133
 v_cvt_pk_bf16_f32 v133, v134, v135
M v[240:243], a[172:175], a[132:135], v[240:243]
 v_cvt_pk_bf16_f32 v134, v164, v165
 v_cvt_pk_bf16_f32 v135, v166, v167
M v[244:247], a[172:175], a[140:143], v[244:247]
 v_cvt_pk_bf16_f32 v136, v136, v137
 v_cvt_pk_bf16_f32 v137, v138, v139
M v[244:247], a[168:171], a[136:139], v[244:247]
 v_cvt_pk_bf16_f32 v138, v168, v169
 v_cvt_pk_bf16_f32 v139, v170, v171
M v[248:251], a[168:171], a[144:147], v[248:251]
 v_cvt_pk_bf16_f32 v140, v140, v141
 v_cvt_pk_bf16_f32 v141, v142, v143
M v[248:251], a[172:175], a[148:151], v[248:251]
 s_waitcnt lgkmcnt(0)
 v_cvt_pk_bf16_f32 v142, v172, v173
 v_cvt_pk_bf16_f32 v143, v174, v175
M v[252:255], a[172:175], a[156:159], v[252:255]
 v_cvt_pk_bf16_f32 v144, v144, v145
 v_cvt_pk_bf16_f32 v145, v146, v147
M v[252:255], a[168:171], a[152:155], v[252:255]
 v_cvt_pk_bf16_f32 v146, v176, v177
 v_cvt_pk_bf16_f32 v147, v178, v179
M v[32:35], a[32:35], a[160:163], 0
 s_add_u32 m0, s23, 16384
 ds_read_b128 a[168:171], v5 offset:2048
 ds_read_b128 a[172:175], v6 offset:2048
M v[32:35], a[36:39], a[164:167], v[32:35]
 ds_read_b64_tr_b16 a[96:97], v1 offset:32768
 ds_read_b64_tr_b16 a[98:99], v1 offset:33792
M v[36:39], a[44:47], a[164:167], 0
 s_mul_i32 s72, s41, 4352
 buffer_load_dwordx4 v8, s[52:55], s28 offen offset:0   lds
M v[36:39], a[40:43], a[160:163], v[36:39]
 s_add_u32 s46, s72, 104923136
 v_cvt_pk_bf16_f32 v148, v148, v149
 v_cvt_pk_bf16_f32 v149, v150, v151
M v[40:43], a[48:51], a[160:163], 0
 s_lshl_b32 s45, s42, 7
 ds_read_b64_tr_b16 a[100:101], v1 offset:40960
 ds_read_b64_tr_b16 a[102:103], v1 offset:41984
M v[40:43], a[52:55], a[164:167], v[40:43]
 s_add_u32 s45, s45, s46
 buffer_load_dwordx4 v9, s[52:55], s28 offen offset:1024   lds
M v[44:47], a[60:63], a[164:167], 0
 v_cvt_pk_bf16_f32 v150, v180, v181
 v_cvt_pk_bf16_f32 v151, v182, v183
M v[44:47], a[56:59], a[160:163], v[44:47]
 ds_read_b64_tr_b16 a[104:105], v2 offset:32768
 ds_read_b64_tr_b16 a[106:107], v2 offset:33792
M v[48:51], a[64:67], a[160:163], 0
 v_cvt_pk_bf16_f32 v152, v152, v153
 v_cvt_pk_bf16_f32 v153, v154, v155
M v[48:51], a[68:71], a[164:167], v[48:51]
 v_cvt_pk_bf16_f32 v154, v184, v185
 v_cvt_pk_bf16_f32 v155, v186, v187
M v[52:55], a[76:79], a[164:167], 0
 ds_read_b64_tr_b16 a[108:109], v2 offset:40960
 ds_read_b64_tr_b16 a[110:111], v2 offset:41984
M v[52:55], a[72:75], a[160:163], v[52:55]
 buffer_load_dwordx4 v10, s[52:55], s28 offen offset:2048   lds
M v[56:59], a[80:83], a[160:163], 0
 v_cvt_pk_bf16_f32 v156, v156, v157
 v_cvt_pk_bf16_f32 v157, v158, v159
M v[56:59], a[84:87], a[164:167], v[56:59]
 s_waitcnt lgkmcnt(8)
 ds_read_b64_tr_b16 a[112:113], v3 offset:32768
 ds_read_b64_tr_b16 a[114:115], v3 offset:33792
M v[60:63], a[92:95], a[164:167], 0
 v_cvt_pk_bf16_f32 v158, v188, v189
 v_cvt_pk_bf16_f32 v159, v190, v191
M v[60:63], a[88:91], a[160:163], v[60:63]
 buffer_load_dwordx4 v11, s[52:55], s28 offen offset:3072   lds
M v[96:99], a[32:35], a[168:171], 0
 s_add_u32 s28, s28, 524160
 ds_read_b128 a[160:163], v5 offset:4096
 ds_read_b128 a[164:167], v6 offset:4096
M v[96:99], a[36:39], a[172:175], v[96:99]
 ds_read_b64_tr_b16 a[116:117], v3 offset:40960
 ds_read_b64_tr_b16 a[118:119], v3 offset:41984
M v[100:103], a[44:47], a[172:175], 0
 v_cvt_pk_bf16_f32 v192, v192, v193
 v_cvt_pk_bf16_f32 v193, v194, v195
M v[100:103], a[40:43], a[168:171], v[100:103]
 s_add_u32 m0, s24, 49152
 ds_read_b64_tr_b16 a[120:121], v4 offset:32768
 ds_read_b64_tr_b16 a[122:123], v4 offset:33792
M v[104:107], a[48:51], a[168:171], 0
 buffer_load_dwordx4 v16, s[56:59], s29 offen offset:0   lds
M v[104:107], a[52:55], a[172:175], v[104:107]
 v_cvt_pk_bf16_f32 v194, v224, v225
 v_cvt_pk_bf16_f32 v195, v226, v227
M v[108:111], a[60:63], a[172:175], 0
 ds_read_b64_tr_b16 a[124:125], v4 offset:40960
 ds_read_b64_tr_b16 a[126:127], v4 offset:41984
M v[108:111], a[56:59], a[168:171], v[108:111]
 v_cvt_pk_bf16_f32 v196, v196, v197
 v_cvt_pk_bf16_f32 v197, v198, v199
M v[112:115], a[64:67], a[168:171], 0
 v_cvt_pk_bf16_f32 v198, v228, v229
 v_cvt_pk_bf16_f32 v199, v230, v231
M v[112:115], a[68:71], a[172:175], v[112:115]
 buffer_load_dwordx4 v17, s[56:59], s29 offen offset:1024   lds
M v[116:119], a[76:79], a[172:175], 0
 v_cvt_pk_bf16_f32 v200, v200, v201
 v_cvt_pk_bf16_f32 v201, v202, v203
M v[116:119], a[72:75], a[168:171], v[116:119]
 v_cvt_pk_bf16_f32 v202, v232, v233
 v_cvt_pk_bf16_f32 v203, v234, v235
M v[120:123], a[80:83], a[168:171], 0
 v_cvt_pk_bf16_f32 v204, v204, v205
 v_cvt_pk_bf16_f32 v205, v206, v207
M v[120:123], a[84:87], a[172:175], v[120:123]
 s_waitcnt lgkmcnt(6)
 v_cvt_pk_bf16_f32 v206, v236, v237
 v_cvt_pk_bf16_f32 v207, v238, v239
M v[124:127], a[92:95], a[172:175], 0
 s_waitcnt vmcnt(17) lgkmcnt(0)
 buffer_load_dwordx4 v18, s[56:59], s29 offen offset:2048   lds
M v[124:127], a[88:91], a[168:171], v[124:127]
 s_barrier
M v[160:163], a[32:35], a[160:163], 0
 ds_read_b128 a[168:171], v5 offset:6144
 ds_read_b128 a[172:175], v6 offset:6144
M v[160:163], a[36:39], a[164:167], v[160:163]
 ds_read_b64_tr_b16 a[128:129], v1 offset:49152
 ds_read_b64_tr_b16 a[130:131], v1 offset:50176
M v[164:167], a[44:47], a[164:167], 0
 v_cvt_pk_bf16_f32 v208, v208, v209
 v_cvt_pk_bf16_f32 v209, v210, v211
M v[164:167], a[40:43], a[160:163], v[164:167]
 buffer_load_dwordx4 v19, s[56:59], s29 offen offset:3072   lds
M v[168:171], a[48:51], a[160:163], 0
 s_add_u32 s29, s29, 128
 ds_read_b64_tr_b16 a[132:133], v1 offset:57344
 ds_read_b64_tr_b16 a[134:135], v1 offset:58368
M v[168:171], a[52:55], a[164:167], v[168:171]
 v_cvt_pk_bf16_f32 v210, v240, v241
 v_cvt_pk_bf16_f32 v211, v242, v243
M v[172:175], a[60:63], a[164:167], 0
 v_cvt_pk_bf16_f32 v212, v212, v213
 v_cvt_pk_bf16_f32 v213, v214, v215
M v[172:175], a[56:59], a[160:163], v[172:175]
 s_add_u32 m0, s23, 32768
 ds_read_b64_tr_b16 a[136:137], v2 offset:49152
 ds_read_b64_tr_b16 a[138:139], v2 offset:50176
M v[176:179], a[64:67], a[160:163], 0
 buffer_load_dwordx4 v8, s[52:55], s28 offen offset:0   lds
M v[176:179], a[68:71], a[164:167], v[176:179]
 v_cvt_pk_bf16_f32 v214, v244, v245
 v_cvt_pk_bf16_f32 v215, v246, v247
M v[180:183], a[76:79], a[164:167], 0
 ds_read_b64_tr_b16 a[140:141], v2 offset:57344
 ds_read_b64_tr_b16 a[142:143], v2 offset:58368
M v[180:183], a[72:75], a[160:163], v[180:183]
 v_cvt_pk_bf16_f32 v216, v216, v217
 v_cvt_pk_bf16_f32 v217, v218, v219
M v[184:187], a[80:83], a[160:163], 0
 v_cvt_pk_bf16_f32 v218, v248, v249
 v_cvt_pk_bf16_f32 v219, v250, v251
M v[184:187], a[84:87], a[164:167], v[184:187]
 s_waitcnt lgkmcnt(8)
 ds_read_b64_tr_b16 a[144:145], v3 offset:49152
 ds_read_b64_tr_b16 a[146:147], v3 offset:50176
M v[188:191], a[92:95], a[164:167], 0
 buffer_load_dwordx4 v9, s[52:55], s28 offen offset:1024   lds
M v[188:191], a[88:91], a[160:163], v[188:191]
 v_cvt_pk_bf16_f32 v220, v220, v221
 v_cvt_pk_bf16_f32 v221, v222, v223
M v[224:227], a[32:35], a[168:171], 0
 ds_read_b128 a[160:163], v5 offset:16384
 ds_read_b128 a[164:167], v6 offset:16384
M v[224:227], a[36:39], a[172:175], v[224:227]
 ds_read_b64_tr_b16 a[148:149], v3 offset:57344
 ds_read_b64_tr_b16 a[150:151], v3 offset:58368
M v[228:231], a[44:47], a[172:175], 0
 buffer_load_dwordx4 v10, s[52:55], s28 offen offset:2048   lds
M v[228:231], a[40:43], a[168:171], v[228:231]
 ds_read_b64_tr_b16 a[152:153], v4 offset:49152
 ds_read_b64_tr_b16 a[154:155], v4 offset:50176
M v[232:235], a[48:51], a[168:171], 0
 v_cvt_pk_bf16_f32 v222, v252, v253
 v_cvt_pk_bf16_f32 v223, v254, v255
M v[232:235], a[52:55], a[172:175], v[232:235]
 s_add_u32 s3, s93, 8192
 v_mov_b32 v12, 1
 v_or_b32 v15, s20, v0
M v[236:239], a[60:63], a[172:175], 0
 ds_read_b64_tr_b16 a[156:157], v4 offset:57344
 ds_read_b64_tr_b16 a[158:159], v4 offset:58368
M v[236:239], a[56:59], a[168:171], v[236:239]
 buffer_load_dwordx4 v11, s[52:55], s28 offen offset:3072   lds
M v[240:243], a[64:67], a[168:171], 0
 s_add_u32 s28, s28, 128
 v_min_u32 v15, 1, v15
 v_lshlrev_b32 v15, 29, v15
M v[240:243], a[68:71], a[172:175], v[240:243]
M v[244:247], a[76:79], a[172:175], 0
 buffer_store_dwordx4 a[16:19], v7, s[8:11], s3 offen offset:0 sc1
M v[244:247], a[72:75], a[168:171], v[244:247]
M v[248:251], a[80:83], a[168:171], 0
M v[248:251], a[84:87], a[172:175], v[248:251]
 s_waitcnt lgkmcnt(6)
M v[252:255], a[92:95], a[172:175], 0
 s_waitcnt lgkmcnt(0)
 buffer_store_dwordx4 a[20:23], v7, s[8:11], s3 offen offset:2048 sc1
M v[252:255], a[88:91], a[168:171], v[252:255]
 s_barrier
M v[32:35], a[96:99], a[160:163], v[32:35]
 s_add_u32 m0, s23, 49152
 ds_read_b128 a[168:171], v5 offset:18432
 ds_read_b128 a[172:175], v6 offset:18432
M v[32:35], a[100:103], a[164:167], v[32:35]
 ds_read_b64_tr_b16 a[32:33], v20 offset:0
 ds_read_b64_tr_b16 a[34:35], v20 offset:1024
M v[36:39], a[108:111], a[164:167], v[36:39]
 s_mov_b32 s31, 0x4b800000
 buffer_load_dwordx4 v8, s[52:55], s28 offen offset:0   lds
M v[36:39], a[104:107], a[160:163], v[36:39]
 s_sub_u32 s66, 15, s42
 s_add_u32 s3, s93, 12288
M v[40:43], a[112:115], a[160:163], v[40:43]
 s_min_u32 s66, s66, s42
 ds_read_b64_tr_b16 a[36:37], v20 offset:8192
 ds_read_b64_tr_b16 a[38:39], v20 offset:9216
M v[40:43], a[116:119], a[164:167], v[40:43]
 s_lshl_b32 s47, s66, 7
 buffer_load_dwordx4 v9, s[52:55], s28 offen offset:1024   lds
M v[44:47], a[124:127], a[164:167], v[44:47]
 s_add_u32 s47, s47, s46
M v[44:47], a[120:123], a[160:163], v[44:47]
 s_add_u32 s47, s47, 2048
 ds_read_b64_tr_b16 a[40:41], v21 offset:0
 ds_read_b64_tr_b16 a[42:43], v21 offset:1024
M v[48:51], a[128:131], a[160:163], v[48:51]
 s_lshl_b32 s65, s41, 3
 buffer_store_dwordx4 a[24:27], v7, s[8:11], s3 offen offset:0 sc1
M v[48:51], a[132:135], a[164:167], v[48:51]
 s_add_u32 s65, s65, s66
M v[52:55], a[140:143], a[164:167], v[52:55]
 s_mul_i32 s34, s65, 73728
 ds_read_b64_tr_b16 a[44:45], v21 offset:8192
 ds_read_b64_tr_b16 a[46:47], v21 offset:9216
M v[52:55], a[136:139], a[160:163], v[52:55]
 s_add_u32 s34, s34, 136314880
 buffer_load_dwordx4 v10, s[52:55], s28 offen offset:2048   lds
M v[56:59], a[144:147], a[160:163], v[56:59]
 s_lshl_b32 s65, s42, 4
 s_add_u32 s65, s65, s41
 s_mul_i32 s33, s65, 114688
M v[56:59], a[148:151], a[164:167], v[56:59]
 s_waitcnt lgkmcnt(8)
 ds_read_b64_tr_b16 a[48:49], v22 offset:0
 ds_read_b64_tr_b16 a[50:51], v22 offset:1024
M v[60:63], a[156:159], a[164:167], v[60:63]
 s_mul_i32 s65, s20, 28672
M v[60:63], a[152:155], a[160:163], v[60:63]
 s_add_u32 s33, s33, s65
 buffer_load_dwordx4 v11, s[52:55], s28 offen offset:3072   lds
M v[96:99], a[96:99], a[168:171], v[96:99]
 s_add_u32 s28, s28, 524160
 ds_read_b128 a[160:163], v5 offset:20480
 ds_read_b128 a[164:167], v6 offset:20480
M v[96:99], a[100:103], a[172:175], v[96:99]
 ds_read_b64_tr_b16 a[52:53], v22 offset:8192
 ds_read_b64_tr_b16 a[54:55], v22 offset:9216
M v[100:103], a[108:111], a[172:175], v[100:103]
 s_add_u32 s33, s33, 67108864
 s_lshl_b32 s25, s41, 18
M v[100:103], a[104:107], a[168:171], v[100:103]
 s_add_u32 m0, s24, 0
 ds_read_b64_tr_b16 a[56:57], v23 offset:0
 ds_read_b64_tr_b16 a[58:59], v23 offset:1024
M v[104:107], a[112:115], a[168:171], v[104:107]
 buffer_load_dwordx4 v16, s[56:59], s29 offen offset:0   lds
M v[104:107], a[116:119], a[172:175], v[104:107]
 s_add_u32 s25, s25, 100663296
M v[108:111], a[124:127], a[172:175], v[108:111]
 s_add_u32 s38, s25, 65536
 ds_read_b64_tr_b16 a[60:61], v23 offset:8192
 ds_read_b64_tr_b16 a[62:63], v23 offset:9216
M v[108:111], a[120:123], a[168:171], v[108:111]
 s_mov_b32 s6, 0
M v[112:115], a[128:131], a[168:171], v[112:115]
 s_mov_b32 s7, 1
M v[112:115], a[132:135], a[172:175], v[112:115]
 s_cmp_eq_u32 s20, 0
 buffer_load_dwordx4 v17, s[56:59], s29 offen offset:1024   lds
M v[116:119], a[140:143], a[172:175], v[116:119]
 s_cselect_b32 s39, 0x12, 0
M v[116:119], a[136:139], a[168:171], v[116:119]
 s_cselect_b32 s92, 2, 0
M v[120:123], a[144:147], a[168:171], v[120:123]
 s_mov_b32 s4, 4
 s_mov_b32 s40, 1
M v[120:123], a[148:151], a[172:175], v[120:123]
 s_waitcnt lgkmcnt(6)
M v[124:127], a[156:159], a[172:175], v[124:127]
 s_waitcnt vmcnt(25) lgkmcnt(0)
 buffer_load_dwordx4 v18, s[56:59], s29 offen offset:2048   lds
M v[124:127], a[152:155], a[168:171], v[124:127]
 s_barrier
M v[160:163], a[96:99], a[160:163], v[160:163]
 ds_read_b128 a[168:171], v5 offset:22528
 ds_read_b128 a[172:175], v6 offset:22528
M v[160:163], a[100:103], a[164:167], v[160:163]
 ds_read_b64_tr_b16 a[64:65], v20 offset:16384
 ds_read_b64_tr_b16 a[66:67], v20 offset:17408
M v[164:167], a[108:111], a[164:167], v[164:167]
M v[164:167], a[104:107], a[160:163], v[164:167]
 buffer_load_dwordx4 v19, s[56:59], s29 offen offset:3072   lds
M v[168:171], a[112:115], a[160:163], v[168:171]
 s_add_u32 s29, s29, 128
 ds_read_b64_tr_b16 a[68:69], v20 offset:24576
 ds_read_b64_tr_b16 a[70:71], v20 offset:25600
M v[168:171], a[116:119], a[164:167], v[168:171]
 buffer_store_dwordx4 a[28:31], v7, s[8:11], s3 offen offset:2048 sc1
M v[172:175], a[124:127], a[164:167], v[172:175]
M v[172:175], a[120:123], a[160:163], v[172:175]
 s_add_u32 m0, s23, 131072
 ds_read_b64_tr_b16 a[72:73], v21 offset:16384
 ds_read_b64_tr_b16 a[74:75], v21 offset:17408
M v[176:179], a[128:131], a[160:163], v[176:179]
 buffer_load_dwordx4 v8, s[52:55], s28 offen offset:0   lds
M v[176:179], a[132:135], a[164:167], v[176:179]
M v[180:183], a[140:143], a[164:167], v[180:183]
 ds_read_b64_tr_b16 a[76:77], v21 offset:24576
 ds_read_b64_tr_b16 a[78:79], v21 offset:25600
M v[180:183], a[136:139], a[160:163], v[180:183]
M v[184:187], a[144:147], a[160:163], v[184:187]
M v[184:187], a[148:151], a[164:167], v[184:187]
 s_waitcnt lgkmcnt(8)
 ds_read_b64_tr_b16 a[80:81], v22 offset:16384
 ds_read_b64_tr_b16 a[82:83], v22 offset:17408
M v[188:191], a[156:159], a[164:167], v[188:191]
 buffer_load_dwordx4 v9, s[52:55], s28 offen offset:1024   lds
M v[188:191], a[152:155], a[160:163], v[188:191]
M v[224:227], a[96:99], a[168:171], v[224:227]
 ds_read_b128 a[160:163], v5 offset:32768
 ds_read_b128 a[164:167], v6 offset:32768
M v[224:227], a[100:103], a[172:175], v[224:227]
 ds_read_b64_tr_b16 a[84:85], v22 offset:24576
 ds_read_b64_tr_b16 a[86:87], v22 offset:25600
M v[228:231], a[108:111], a[172:175], v[228:231]
 buffer_load_dwordx4 v10, s[52:55], s28 offen offset:2048   lds
M v[228:231], a[104:107], a[168:171], v[228:231]
 ds_read_b64_tr_b16 a[88:89], v23 offset:16384
 ds_read_b64_tr_b16 a[90:91], v23 offset:17408
M v[232:235], a[112:115], a[168:171], v[232:235]
M v[232:235], a[116:119], a[172:175], v[232:235]
M v[236:239], a[124:127], a[172:175], v[236:239]
 ds_read_b64_tr_b16 a[92:93], v23 offset:24576
 ds_read_b64_tr_b16 a[94:95], v23 offset:25600
M v[236:239], a[120:123], a[168:171], v[236:239]
 buffer_load_dwordx4 v11, s[52:55], s28 offen offset:3072   lds
M v[240:243], a[128:131], a[168:171], v[240:243]
 s_add_u32 s28, s28, 128
M v[240:243], a[132:135], a[172:175], v[240:243]
M v[244:247], a[140:143], a[172:175], v[244:247]
M v[244:247], a[136:139], a[168:171], v[244:247]
M v[248:251], a[144:147], a[168:171], v[248:251]
M v[248:251], a[148:151], a[172:175], v[248:251]
 s_waitcnt lgkmcnt(6)
M v[252:255], a[156:159], a[172:175], v[252:255]
 s_waitcnt vmcnt(28) lgkmcnt(0)
M v[252:255], a[152:155], a[168:171], v[252:255]
 s_barrier
M v[32:35], a[32:35], a[160:163], v[32:35]
 s_add_u32 m0, s23, 147456
 ds_read_b128 a[168:171], v5 offset:34816
 ds_read_b128 a[172:175], v6 offset:34816
M v[32:35], a[36:39], a[164:167], v[32:35]
 ds_read_b64_tr_b16 a[96:97], v1 offset:0
 ds_read_b64_tr_b16 a[98:99], v1 offset:1024
M v[36:39], a[44:47], a[164:167], v[36:39]
 buffer_load_dwordx4 v8, s[52:55], s28 offen offset:0   lds
M v[36:39], a[40:43], a[160:163], v[36:39]
M v[40:43], a[48:51], a[160:163], v[40:43]
 ds_read_b64_tr_b16 a[100:101], v1 offset:8192
 ds_read_b64_tr_b16 a[102:103], v1 offset:9216
M v[40:43], a[52:55], a[164:167], v[40:43]
 buffer_load_dwordx4 v9, s[52:55], s28 offen offset:1024   lds
M v[44:47], a[60:63], a[164:167], v[44:47]
M v[44:47], a[56:59], a[160:163], v[44:47]
 ds_read_b64_tr_b16 a[104:105], v2 offset:0
 ds_read_b64_tr_b16 a[106:107], v2 offset:1024
M v[48:51], a[64:67], a[160:163], v[48:51]
M v[48:51], a[68:71], a[164:167], v[48:51]
M v[52:55], a[76:79], a[164:167], v[52:55]
 ds_read_b64_tr_b16 a[108:109], v2 offset:8192
 ds_read_b64_tr_b16 a[110:111], v2 offset:9216
M v[52:55], a[72:75], a[160:163], v[52:55]
 buffer_load_dwordx4 v10, s[52:55], s28 offen offset:2048   lds
M v[56:59], a[80:83], a[160:163], v[56:59]
M v[56:59], a[84:87], a[164:167], v[56:59]
 s_waitcnt lgkmcnt(8)
 ds_read_b64_tr_b16 a[112:113], v3 offset:0
 ds_read_b64_tr_b16 a[114:115], v3 offset:1024
M v[60:63], a[92:95], a[164:167], v[60:63]
M v[60:63], a[88:91], a[160:163], v[60:63]
 buffer_load_dwordx4 v11, s[52:55], s28 offen offset:3072   lds
M v[96:99], a[32:35], a[168:171], v[96:99]
 s_add_u32 s28, s28, 524160
 ds_read_b128 a[160:163], v5 offset:36864
 ds_read_b128 a[164:167], v6 offset:36864
M v[96:99], a[36:39], a[172:175], v[96:99]
 ds_read_b64_tr_b16 a[116:117], v3 offset:8192
 ds_read_b64_tr_b16 a[118:119], v3 offset:9216
M v[100:103], a[44:47], a[172:175], v[100:103]
M v[100:103], a[40:43], a[168:171], v[100:103]
 s_add_u32 m0, s24, 16384
 ds_read_b64_tr_b16 a[120:121], v4 offset:0
 ds_read_b64_tr_b16 a[122:123], v4 offset:1024
M v[104:107], a[48:51], a[168:171], v[104:107]
 buffer_load_dwordx4 v16, s[56:59], s29 offen offset:0   lds
M v[104:107], a[52:55], a[172:175], v[104:107]
M v[108:111], a[60:63], a[172:175], v[108:111]
 ds_read_b64_tr_b16 a[124:125], v4 offset:8192
 ds_read_b64_tr_b16 a[126:127], v4 offset:9216
M v[108:111], a[56:59], a[168:171], v[108:111]
M v[112:115], a[64:67], a[168:171], v[112:115]
M v[112:115], a[68:71], a[172:175], v[112:115]
 buffer_load_dwordx4 v17, s[56:59], s29 offen offset:1024   lds
M v[116:119], a[76:79], a[172:175], v[116:119]
M v[116:119], a[72:75], a[168:171], v[116:119]
M v[120:123], a[80:83], a[168:171], v[120:123]
M v[120:123], a[84:87], a[172:175], v[120:123]
 s_waitcnt lgkmcnt(6)
M v[124:127], a[92:95], a[172:175], v[124:127]
 s_waitcnt vmcnt(26) lgkmcnt(0)
 buffer_load_dwordx4 v18, s[56:59], s29 offen offset:2048   lds
M v[124:127], a[88:91], a[168:171], v[124:127]
 s_barrier
M v[160:163], a[32:35], a[160:163], v[160:163]
 ds_read_b128 a[168:171], v5 offset:38912
 ds_read_b128 a[172:175], v6 offset:38912
M v[160:163], a[36:39], a[164:167], v[160:163]
 ds_read_b64_tr_b16 a[128:129], v1 offset:16384
 ds_read_b64_tr_b16 a[130:131], v1 offset:17408
M v[164:167], a[44:47], a[164:167], v[164:167]
M v[164:167], a[40:43], a[160:163], v[164:167]
 buffer_load_dwordx4 v19, s[56:59], s29 offen offset:3072   lds
M v[168:171], a[48:51], a[160:163], v[168:171]
 s_add_u32 s29, s29, 128
 ds_read_b64_tr_b16 a[132:133], v1 offset:24576
 ds_read_b64_tr_b16 a[134:135], v1 offset:25600
M v[168:171], a[52:55], a[164:167], v[168:171]
M v[172:175], a[60:63], a[164:167], v[172:175]
M v[172:175], a[56:59], a[160:163], v[172:175]
 s_add_u32 m0, s23, 0
 ds_read_b64_tr_b16 a[136:137], v2 offset:16384
 ds_read_b64_tr_b16 a[138:139], v2 offset:17408
M v[176:179], a[64:67], a[160:163], v[176:179]
 buffer_load_dwordx4 v8, s[52:55], s28 offen offset:0   lds
M v[176:179], a[68:71], a[164:167], v[176:179]
M v[180:183], a[76:79], a[164:167], v[180:183]
 ds_read_b64_tr_b16 a[140:141], v2 offset:24576
 ds_read_b64_tr_b16 a[142:143], v2 offset:25600
M v[180:183], a[72:75], a[160:163], v[180:183]
M v[184:187], a[80:83], a[160:163], v[184:187]
M v[184:187], a[84:87], a[164:167], v[184:187]
 s_waitcnt lgkmcnt(8)
 ds_read_b64_tr_b16 a[144:145], v3 offset:16384
 ds_read_b64_tr_b16 a[146:147], v3 offset:17408
M v[188:191], a[92:95], a[164:167], v[188:191]
 buffer_load_dwordx4 v9, s[52:55], s28 offen offset:1024   lds
M v[188:191], a[88:91], a[160:163], v[188:191]
M v[224:227], a[32:35], a[168:171], v[224:227]
 ds_read_b128 a[160:163], v5 offset:49152
 ds_read_b128 a[164:167], v6 offset:49152
M v[224:227], a[36:39], a[172:175], v[224:227]
 ds_read_b64_tr_b16 a[148:149], v3 offset:24576
 ds_read_b64_tr_b16 a[150:151], v3 offset:25600
M v[228:231], a[44:47], a[172:175], v[228:231]
 buffer_load_dwordx4 v10, s[52:55], s28 offen offset:2048   lds
M v[228:231], a[40:43], a[168:171], v[228:231]
 ds_read_b64_tr_b16 a[152:153], v4 offset:16384
 ds_read_b64_tr_b16 a[154:155], v4 offset:17408
M v[232:235], a[48:51], a[168:171], v[232:235]
M v[232:235], a[52:55], a[172:175], v[232:235]
M v[236:239], a[60:63], a[172:175], v[236:239]
 ds_read_b64_tr_b16 a[156:157], v4 offset:24576
 ds_read_b64_tr_b16 a[158:159], v4 offset:25600
M v[236:239], a[56:59], a[168:171], v[236:239]
 buffer_load_dwordx4 v11, s[52:55], s28 offen offset:3072   lds
M v[240:243], a[64:67], a[168:171], v[240:243]
 s_add_u32 s28, s28, 128
M v[240:243], a[68:71], a[172:175], v[240:243]
M v[244:247], a[76:79], a[172:175], v[244:247]
M v[244:247], a[72:75], a[168:171], v[244:247]
M v[248:251], a[80:83], a[168:171], v[248:251]
M v[248:251], a[84:87], a[172:175], v[248:251]
 s_waitcnt lgkmcnt(6)
M v[252:255], a[92:95], a[172:175], v[252:255]
 s_waitcnt vmcnt(16) lgkmcnt(0)
M v[252:255], a[88:91], a[168:171], v[252:255]
 s_barrier
M v[32:35], a[96:99], a[160:163], v[32:35]
 s_add_u32 m0, s23, 16384
 ds_read_b128 a[168:171], v5 offset:51200
 ds_read_b128 a[172:175], v6 offset:51200
M v[32:35], a[100:103], a[164:167], v[32:35]
 ds_read_b64_tr_b16 a[32:33], v1 offset:32768
 ds_read_b64_tr_b16 a[34:35], v1 offset:33792
M v[36:39], a[108:111], a[164:167], v[36:39]
 buffer_load_dwordx4 v8, s[52:55], s28 offen offset:0   lds
M v[36:39], a[104:107], a[160:163], v[36:39]
 buffer_store_dword v12, v15, s[8:11], s45 offen sc1
M v[40:43], a[112:115], a[160:163], v[40:43]
 s_add_u32 s3, s93, 262144
 ds_read_b64_tr_b16 a[36:37], v1 offset:40960
 ds_read_b64_tr_b16 a[38:39], v1 offset:41984
M v[40:43], a[116:119], a[164:167], v[40:43]
 v_min_u32 v25, 15, v0
 v_lshlrev_b32 v25, 7, v25
M v[44:47], a[124:127], a[164:167], v[44:47]
 buffer_store_dwordx4 v[64:67], v7, s[8:11], s3 offen offset:0 sc1
M v[44:47], a[120:123], a[160:163], v[44:47]
 ds_read_b64_tr_b16 a[40:41], v2 offset:32768
 ds_read_b64_tr_b16 a[42:43], v2 offset:33792
M v[48:51], a[128:131], a[160:163], v[48:51]
 buffer_load_dwordx4 v9, s[52:55], s28 offen offset:1024   lds
M v[48:51], a[132:135], a[164:167], v[48:51]
M v[52:55], a[140:143], a[164:167], v[52:55]
 ds_read_b64_tr_b16 a[44:45], v2 offset:40960
 ds_read_b64_tr_b16 a[46:47], v2 offset:41984
M v[52:55], a[136:139], a[160:163], v[52:55]
M v[56:59], a[144:147], a[160:163], v[56:59]
M v[56:59], a[148:151], a[164:167], v[56:59]
 s_waitcnt lgkmcnt(8)
 ds_read_b64_tr_b16 a[48:49], v3 offset:32768
 ds_read_b64_tr_b16 a[50:51], v3 offset:33792
M v[60:63], a[156:159], a[164:167], v[60:63]
 buffer_load_dwordx4 v10, s[52:55], s28 offen offset:2048   lds
M v[60:63], a[152:155], a[160:163], v[60:63]
M v[96:99], a[96:99], a[168:171], v[96:99]
 ds_read_b128 a[160:163], v5 offset:53248
 ds_read_b128 a[164:167], v6 offset:53248
M v[96:99], a[100:103], a[172:175], v[96:99]
 ds_read_b64_tr_b16 a[52:53], v3 offset:40960
 ds_read_b64_tr_b16 a[54:55], v3 offset:41984
M v[100:103], a[108:111], a[172:175], v[100:103]
 buffer_store_dwordx4 v[68:71], v7, s[8:11], s3 offen offset:2048 sc1
M v[100:103], a[104:107], a[168:171], v[100:103]
 ds_read_b64_tr_b16 a[56:57], v4 offset:32768
 ds_read_b64_tr_b16 a[58:59], v4 offset:33792
M v[104:107], a[112:115], a[168:171], v[104:107]
M v[104:107], a[116:119], a[172:175], v[104:107]
 buffer_load_dwordx4 v11, s[52:55], s28 offen offset:3072   lds
M v[108:111], a[124:127], a[172:175], v[108:111]
 s_add_u32 s28, s28, 524160
 ds_read_b64_tr_b16 a[60:61], v4 offset:40960
 ds_read_b64_tr_b16 a[62:63], v4 offset:41984
M v[108:111], a[120:123], a[168:171], v[108:111]
M v[112:115], a[128:131], a[168:171], v[112:115]
M v[112:115], a[132:135], a[172:175], v[112:115]
M v[116:119], a[140:143], a[172:175], v[116:119]
M v[116:119], a[136:139], a[168:171], v[116:119]
M v[120:123], a[144:147], a[168:171], v[120:123]
M v[120:123], a[148:151], a[172:175], v[120:123]
 s_waitcnt lgkmcnt(6)
M v[124:127], a[156:159], a[172:175], v[124:127]
 s_waitcnt lgkmcnt(0)
M v[124:127], a[152:155], a[168:171], v[124:127]
 s_barrier
M v[160:163], a[96:99], a[160:163], v[160:163]
 s_add_u32 s3, s93, 266240
 ds_read_b128 a[168:171], v5 offset:55296
 ds_read_b128 a[172:175], v6 offset:55296
M v[160:163], a[100:103], a[164:167], v[160:163]
 ds_read_b64_tr_b16 a[64:65], v1 offset:49152
 ds_read_b64_tr_b16 a[66:67], v1 offset:50176
M v[164:167], a[108:111], a[164:167], v[164:167]
 buffer_store_dwordx4 v[72:75], v7, s[8:11], s3 offen offset:0 sc1
M v[164:167], a[104:107], a[160:163], v[164:167]
M v[168:171], a[112:115], a[160:163], v[168:171]
 ds_read_b64_tr_b16 a[68:69], v1 offset:57344
 ds_read_b64_tr_b16 a[70:71], v1 offset:58368
M v[168:171], a[116:119], a[164:167], v[168:171]
M v[172:175], a[124:127], a[164:167], v[172:175]
M v[172:175], a[120:123], a[160:163], v[172:175]
 ds_read_b64_tr_b16 a[72:73], v2 offset:49152
 ds_read_b64_tr_b16 a[74:75], v2 offset:50176
M v[176:179], a[128:131], a[160:163], v[176:179]
M v[176:179], a[132:135], a[164:167], v[176:179]
M v[180:183], a[140:143], a[164:167], v[180:183]
 ds_read_b64_tr_b16 a[76:77], v2 offset:57344
 ds_read_b64_tr_b16 a[78:79], v2 offset:58368
M v[180:183], a[136:139], a[160:163], v[180:183]
M v[184:187], a[144:147], a[160:163], v[184:187]
M v[184:187], a[148:151], a[164:167], v[184:187]
 s_waitcnt lgkmcnt(8)
 ds_read_b64_tr_b16 a[80:81], v3 offset:49152
 ds_read_b64_tr_b16 a[82:83], v3 offset:50176
M v[188:191], a[156:159], a[164:167], v[188:191]
 buffer_store_dwordx4 v[76:79], v7, s[8:11], s3 offen offset:2048 sc1
M v[188:191], a[152:155], a[160:163], v[188:191]
M v[224:227], a[96:99], a[168:171], v[224:227]
 ds_read_b128 a[160:163], v5 offset:0
 ds_read_b128 a[164:167], v6 offset:0
M v[224:227], a[100:103], a[172:175], v[224:227]
 ds_read_b64_tr_b16 a[84:85], v3 offset:57344
 ds_read_b64_tr_b16 a[86:87], v3 offset:58368
M v[228:231], a[108:111], a[172:175], v[228:231]
M v[228:231], a[104:107], a[168:171], v[228:231]
 ds_read_b64_tr_b16 a[88:89], v4 offset:49152
 ds_read_b64_tr_b16 a[90:91], v4 offset:50176
M v[232:235], a[112:115], a[168:171], v[232:235]
M v[232:235], a[116:119], a[172:175], v[232:235]
M v[236:239], a[124:127], a[172:175], v[236:239]
 ds_read_b64_tr_b16 a[92:93], v4 offset:57344
 ds_read_b64_tr_b16 a[94:95], v4 offset:58368
M v[236:239], a[120:123], a[168:171], v[236:239]
M v[240:243], a[128:131], a[168:171], v[240:243]
M v[240:243], a[132:135], a[172:175], v[240:243]
M v[244:247], a[140:143], a[172:175], v[244:247]
M v[244:247], a[136:139], a[168:171], v[244:247]
M v[248:251], a[144:147], a[168:171], v[248:251]
M v[248:251], a[148:151], a[172:175], v[248:251]
 s_waitcnt lgkmcnt(6)
M v[252:255], a[156:159], a[172:175], v[252:255]
 s_waitcnt vmcnt(21) lgkmcnt(0)
M v[252:255], a[152:155], a[168:171], v[252:255]
 s_barrier
M v[32:35], a[32:35], a[160:163], v[32:35]
 s_add_u32 m0, s23, 32768
 ds_read_b128 a[168:171], v5 offset:2048
 ds_read_b128 a[172:175], v6 offset:2048
M v[32:35], a[36:39], a[164:167], v[32:35]
 ds_read_b64_tr_b16 a[96:97], v20 offset:0
 ds_read_b64_tr_b16 a[98:99], v20 offset:1024
M v[36:39], a[44:47], a[164:167], v[36:39]
 buffer_load_dwordx4 v16, s[56:59], s29 offen offset:0   lds
M v[36:39], a[40:43], a[160:163], v[36:39]
M v[40:43], a[48:51], a[160:163], v[40:43]
 s_add_u32 s3, s93, 270336
 ds_read_b64_tr_b16 a[100:101], v20 offset:8192
 ds_read_b64_tr_b16 a[102:103], v20 offset:9216
M v[40:43], a[52:55], a[164:167], v[40:43]
 buffer_load_dwordx4 v17, s[56:59], s29 offen offset:1024   lds
M v[44:47], a[60:63], a[164:167], v[44:47]
 buffer_store_dwordx4 v[80:83], v7, s[8:11], s3 offen offset:0 sc1
M v[44:47], a[56:59], a[160:163], v[44:47]
 ds_read_b64_tr_b16 a[104:105], v21 offset:0
 ds_read_b64_tr_b16 a[106:107], v21 offset:1024
M v[48:51], a[64:67], a[160:163], v[48:51]
M v[48:51], a[68:71], a[164:167], v[48:51]
 buffer_load_dwordx4 v18, s[56:59], s29 offen offset:2048   lds
M v[52:55], a[76:79], a[164:167], v[52:55]
 ds_read_b64_tr_b16 a[108:109], v21 offset:8192
 ds_read_b64_tr_b16 a[110:111], v21 offset:9216
M v[52:55], a[72:75], a[160:163], v[52:55]
M v[56:59], a[80:83], a[160:163], v[56:59]
M v[56:59], a[84:87], a[164:167], v[56:59]
 s_waitcnt lgkmcnt(8)
 ds_read_b64_tr_b16 a[112:113], v22 offset:0
 ds_read_b64_tr_b16 a[114:115], v22 offset:1024
M v[60:63], a[92:95], a[164:167], v[60:63]
 buffer_load_dwordx4 v19, s[56:59], s29 offen offset:3072   lds
M v[60:63], a[88:91], a[160:163], v[60:63]
 s_add_u32 s29, s29, 128
M v[96:99], a[32:35], a[168:171], v[96:99]
 ds_read_b128 a[160:163], v5 offset:4096
 ds_read_b128 a[164:167], v6 offset:4096
M v[96:99], a[36:39], a[172:175], v[96:99]
 ds_read_b64_tr_b16 a[116:117], v22 offset:8192
 ds_read_b64_tr_b16 a[118:119], v22 offset:9216
M v[100:103], a[44:47], a[172:175], v[100:103]
 s_lshl_b32 s28, s20, 13
 buffer_store_dwordx4 v[84:87], v7, s[8:11], s3 offen offset:2048 sc1
M v[100:103], a[40:43], a[168:171], v[100:103]
 s_mul_i32 s21, s41, 1048576
 ds_read_b64_tr_b16 a[120:121], v23 offset:0
 ds_read_b64_tr_b16 a[122:123], v23 offset:1024
M v[104:107], a[48:51], a[168:171], v[104:107]
 s_lshl_b32 s30, s42, 16
M v[104:107], a[52:55], a[172:175], v[104:107]
 s_add_u32 s23, s21, s30
M v[108:111], a[60:63], a[172:175], v[108:111]
 s_add_u32 s43, s23, 16777216
 ds_read_b64_tr_b16 a[124:125], v23 offset:8192
 ds_read_b64_tr_b16 a[126:127], v23 offset:9216
M v[108:111], a[56:59], a[168:171], v[108:111]
 s_min_u32 s27, s42, 9
M v[112:115], a[64:67], a[168:171], v[112:115]
 s_lshl_b32 s22, s27, 1
M v[112:115], a[68:71], a[172:175], v[112:115]
 s_sub_u32 s30, 15, s66
M v[116:119], a[76:79], a[172:175], v[116:119]
 s_lshl_b32 s30, s30, 16
M v[116:119], a[72:75], a[168:171], v[116:119]
 s_add_u32 s32, s21, s30
M v[120:123], a[80:83], a[168:171], v[120:123]
 s_lshl_b32 s30, s20, 14
 s_add_u32 s32, s32, s30
 s_add_u32 s32, s32, 33554432
M v[120:123], a[84:87], a[172:175], v[120:123]
 s_waitcnt lgkmcnt(6)
 buffer_load_dword v24, v25, s[8:11], s46 offen sc1
M v[124:127], a[92:95], a[172:175], v[124:127]
 s_waitcnt vmcnt(20) lgkmcnt(0)
 s_mov_b32 s24, 2
M v[124:127], a[88:91], a[168:171], v[124:127]
 s_barrier
M v[160:163], a[32:35], a[160:163], v[160:163]
 s_add_u32 s3, s93, 274432
 ds_read_b128 a[168:171], v5 offset:6144
 ds_read_b128 a[172:175], v6 offset:6144
M v[160:163], a[36:39], a[164:167], v[160:163]
 ds_read_b64_tr_b16 a[128:129], v20 offset:16384
 ds_read_b64_tr_b16 a[130:131], v20 offset:17408
M v[164:167], a[44:47], a[164:167], v[164:167]
 buffer_store_dwordx4 v[88:91], v7, s[8:11], s3 offen offset:0 sc1
M v[164:167], a[40:43], a[160:163], v[164:167]
M v[168:171], a[48:51], a[160:163], v[168:171]
 ds_read_b64_tr_b16 a[132:133], v20 offset:24576
 ds_read_b64_tr_b16 a[134:135], v20 offset:25600
M v[168:171], a[52:55], a[164:167], v[168:171]
M v[172:175], a[60:63], a[164:167], v[172:175]
M v[172:175], a[56:59], a[160:163], v[172:175]
 ds_read_b64_tr_b16 a[136:137], v21 offset:16384
 ds_read_b64_tr_b16 a[138:139], v21 offset:17408
M v[176:179], a[64:67], a[160:163], v[176:179]
M v[176:179], a[68:71], a[164:167], v[176:179]
M v[180:183], a[76:79], a[164:167], v[180:183]
 ds_read_b64_tr_b16 a[140:141], v21 offset:24576
 ds_read_b64_tr_b16 a[142:143], v21 offset:25600
M v[180:183], a[72:75], a[160:163], v[180:183]
M v[184:187], a[80:83], a[160:163], v[184:187]
M v[184:187], a[84:87], a[164:167], v[184:187]
 s_waitcnt lgkmcnt(8)
 ds_read_b64_tr_b16 a[144:145], v22 offset:16384
 ds_read_b64_tr_b16 a[146:147], v22 offset:17408
M v[188:191], a[92:95], a[164:167], v[188:191]
 buffer_store_dwordx4 v[92:95], v7, s[8:11], s3 offen offset:2048 sc1
M v[188:191], a[88:91], a[160:163], v[188:191]
M v[224:227], a[32:35], a[168:171], v[224:227]
 ds_read_b128 a[160:163], v5 offset:16384
 ds_read_b128 a[164:167], v6 offset:16384
M v[224:227], a[36:39], a[172:175], v[224:227]
 ds_read_b64_tr_b16 a[148:149], v22 offset:24576
 ds_read_b64_tr_b16 a[150:151], v22 offset:25600
M v[228:231], a[44:47], a[172:175], v[228:231]
M v[228:231], a[40:43], a[168:171], v[228:231]
 ds_read_b64_tr_b16 a[152:153], v23 offset:16384
 ds_read_b64_tr_b16 a[154:155], v23 offset:17408
M v[232:235], a[48:51], a[168:171], v[232:235]
M v[232:235], a[52:55], a[172:175], v[232:235]
M v[236:239], a[60:63], a[172:175], v[236:239]
 ds_read_b64_tr_b16 a[156:157], v23 offset:24576
 ds_read_b64_tr_b16 a[158:159], v23 offset:25600
M v[236:239], a[56:59], a[168:171], v[236:239]
M v[240:243], a[64:67], a[168:171], v[240:243]
M v[240:243], a[68:71], a[172:175], v[240:243]
M v[244:247], a[76:79], a[172:175], v[244:247]
M v[244:247], a[72:75], a[168:171], v[244:247]
M v[248:251], a[80:83], a[168:171], v[248:251]
M v[248:251], a[84:87], a[172:175], v[248:251]
 s_waitcnt lgkmcnt(6)
M v[252:255], a[92:95], a[172:175], v[252:255]
 s_waitcnt vmcnt(18) lgkmcnt(0)
M v[252:255], a[88:91], a[168:171], v[252:255]
 s_barrier
M v[32:35], a[96:99], a[160:163], v[32:35]
 ds_read_b128 a[168:171], v5 offset:18432
 ds_read_b128 a[172:175], v6 offset:18432
M v[32:35], a[100:103], a[164:167], v[32:35]
 ds_read_b64_tr_b16 a[32:33], v1 offset:0
 ds_read_b64_tr_b16 a[34:35], v1 offset:1024
M v[36:39], a[108:111], a[164:167], v[36:39]
 v_add_u32 v10, s28, v7
 v_add_u32 v11, 0x1000, v10
M v[36:39], a[104:107], a[160:163], v[36:39]
 s_waitcnt vmcnt(2)
 v_cmp_eq_u32 vcc, 0, v24
 s_add_u32 s3, s93, 524288
M v[40:43], a[112:115], a[160:163], v[40:43]
 s_add_u32 s26, s21, 16777216
 ds_read_b64_tr_b16 a[36:37], v1 offset:8192
 ds_read_b64_tr_b16 a[38:39], v1 offset:9216
M v[40:43], a[116:119], a[164:167], v[40:43]
 s_cbranch_vccnz L_f1s1
L_f1r1:
M v[44:47], a[124:127], a[164:167], v[44:47]
 s_add_u32 m0, s28, 98304
 s_nop 0
 buffer_load_dwordx4 v10, s[8:11], s21 offen offset:0 sc1 lds
M v[44:47], a[120:123], a[160:163], v[44:47]
 ds_read_b64_tr_b16 a[40:41], v2 offset:0
 ds_read_b64_tr_b16 a[42:43], v2 offset:1024
M v[48:51], a[128:131], a[160:163], v[48:51]
 buffer_store_dwordx4 v[128:131], v7, s[8:11], s3 offen offset:0 sc1
M v[48:51], a[132:135], a[164:167], v[48:51]
M v[52:55], a[140:143], a[164:167], v[52:55]
 ds_read_b64_tr_b16 a[44:45], v2 offset:8192
 ds_read_b64_tr_b16 a[46:47], v2 offset:9216
M v[52:55], a[136:139], a[160:163], v[52:55]
 buffer_load_dwordx4 v10, s[8:11], s21 offen offset:1024 sc1 lds
M v[56:59], a[144:147], a[160:163], v[56:59]
M v[56:59], a[148:151], a[164:167], v[56:59]
 s_waitcnt lgkmcnt(8)
 ds_read_b64_tr_b16 a[48:49], v3 offset:0
 ds_read_b64_tr_b16 a[50:51], v3 offset:1024
M v[60:63], a[156:159], a[164:167], v[60:63]
M v[60:63], a[152:155], a[160:163], v[60:63]
 buffer_load_dwordx4 v10, s[8:11], s21 offen offset:2048 sc1 lds
M v[96:99], a[96:99], a[168:171], v[96:99]
 ds_read_b128 a[160:163], v5 offset:20480
 ds_read_b128 a[164:167], v6 offset:20480
M v[96:99], a[100:103], a[172:175], v[96:99]
 ds_read_b64_tr_b16 a[52:53], v3 offset:8192
 ds_read_b64_tr_b16 a[54:55], v3 offset:9216
M v[100:103], a[108:111], a[172:175], v[100:103]
 buffer_store_dwordx4 v[132:135], v7, s[8:11], s3 offen offset:2048 sc1
M v[100:103], a[104:107], a[168:171], v[100:103]
 ds_read_b64_tr_b16 a[56:57], v4 offset:0
 ds_read_b64_tr_b16 a[58:59], v4 offset:1024
M v[104:107], a[112:115], a[168:171], v[104:107]
 buffer_load_dwordx4 v10, s[8:11], s21 offen offset:3072 sc1 lds
M v[104:107], a[116:119], a[172:175], v[104:107]
 s_add_u32 m0, s28, 102400
M v[108:111], a[124:127], a[172:175], v[108:111]
 ds_read_b64_tr_b16 a[60:61], v4 offset:8192
 ds_read_b64_tr_b16 a[62:63], v4 offset:9216
M v[108:111], a[120:123], a[168:171], v[108:111]
M v[112:115], a[128:131], a[168:171], v[112:115]
 buffer_load_dwordx4 v11, s[8:11], s21 offen offset:0 sc1 lds
M v[112:115], a[132:135], a[172:175], v[112:115]
M v[116:119], a[140:143], a[172:175], v[116:119]
M v[116:119], a[136:139], a[168:171], v[116:119]
M v[120:123], a[144:147], a[168:171], v[120:123]
 buffer_load_dwordx4 v11, s[8:11], s21 offen offset:1024 sc1 lds
M v[120:123], a[148:151], a[172:175], v[120:123]
 s_waitcnt lgkmcnt(6)
M v[124:127], a[156:159], a[172:175], v[124:127]
 s_waitcnt lgkmcnt(0)
 buffer_load_dwordx4 v11, s[8:11], s21 offen offset:2048 sc1 lds
M v[124:127], a[152:155], a[168:171], v[124:127]
 s_barrier
M v[160:163], a[96:99], a[160:163], v[160:163]
 s_add_u32 s3, s93, 528384
 ds_read_b128 a[168:171], v5 offset:22528
 ds_read_b128 a[172:175], v6 offset:22528
M v[160:163], a[100:103], a[164:167], v[160:163]
 ds_read_b64_tr_b16 a[64:65], v1 offset:16384
 ds_read_b64_tr_b16 a[66:67], v1 offset:17408
M v[164:167], a[108:111], a[164:167], v[164:167]
 buffer_load_dwordx4 v11, s[8:11], s21 offen offset:3072 sc1 lds
M v[164:167], a[104:107], a[160:163], v[164:167]
 s_add_u32 s21, s21, 32768
M v[168:171], a[112:115], a[160:163], v[168:171]
 s_sub_u32 s22, s22, 1
 ds_read_b64_tr_b16 a[68:69], v1 offset:24576
 ds_read_b64_tr_b16 a[70:71], v1 offset:25600
M v[168:171], a[116:119], a[164:167], v[168:171]
 s_cmp_eq_u32 s22, 0
 buffer_store_dwordx4 v[136:139], v7, s[8:11], s3 offen offset:0 sc1
M v[172:175], a[124:127], a[164:167], v[172:175]
 s_cselect_b32 s21, s23, s21
M v[172:175], a[120:123], a[160:163], v[172:175]
 s_cselect_b32 s22, s24, s22
 ds_read_b64_tr_b16 a[72:73], v2 offset:16384
 ds_read_b64_tr_b16 a[74:75], v2 offset:17408
M v[176:179], a[128:131], a[160:163], v[176:179]
 s_cselect_b32 s23, s25, s23
 v_subrev_u32 v5, 0x10000, v5
 v_subrev_u32 v6, 0x10000, v6
M v[176:179], a[132:135], a[164:167], v[176:179]
 s_cselect_b32 s24, 0x7fff, s24
 v_mov_b32 v9, v25
 v_lshrrev_b32 v24, 4, v0
M v[180:183], a[140:143], a[164:167], v[180:183]
 ds_read_b64_tr_b16 a[76:77], v2 offset:24576
 ds_read_b64_tr_b16 a[78:79], v2 offset:25600
M v[180:183], a[136:139], a[160:163], v[180:183]
 v_lshlrev_b32 v24, 2, v24
 v_and_b32 v25, 15, v0
M v[184:187], a[144:147], a[160:163], v[184:187]
 v_sub_u32 v24, v24, v25
 s_lshr_b32 s64, s20, 1
M v[184:187], a[148:151], a[164:167], v[184:187]
 s_waitcnt lgkmcnt(8)
 ds_read_b64_tr_b16 a[80:81], v3 offset:16384
 ds_read_b64_tr_b16 a[82:83], v3 offset:17408
M v[188:191], a[156:159], a[164:167], v[188:191]
 s_add_u32 s64, s64, 0
M v[188:191], a[152:155], a[160:163], v[188:191]
 s_lshl_b32 s64, s64, 17
 buffer_store_dwordx4 v[140:143], v7, s[8:11], s3 offen offset:2048 sc1
M v[224:227], a[96:99], a[168:171], v[224:227]
 s_and_b32 s65, s20, 1
 ds_read_b128 a[160:163], v5 offset:32768
 ds_read_b128 a[164:167], v6 offset:32768
M v[224:227], a[100:103], a[172:175], v[224:227]
 s_lshl_b32 s65, s65, 12
 ds_read_b64_tr_b16 a[84:85], v3 offset:24576
 ds_read_b64_tr_b16 a[86:87], v3 offset:25600
M v[228:231], a[108:111], a[172:175], v[228:231]
 s_add_u32 s64, s64, s65
 v_add_u32 v14, s64, v7
M v[228:231], a[104:107], a[168:171], v[228:231]
 s_sub_u32 s64, s42, 10
 ds_read_b64_tr_b16 a[88:89], v4 offset:16384
 ds_read_b64_tr_b16 a[90:91], v4 offset:17408
M v[232:235], a[112:115], a[168:171], v[232:235]
 s_and_b32 s35, s64, 536870912
 v_mov_b32 v8, 0xff800000
 v_cmp_lt_i32 s[16:17], 0, v24
M v[232:235], a[116:119], a[172:175], v[232:235]
 v_cmp_lt_i32 s[18:19], -1, v24
 v_cmp_lt_i32 s[48:49], -2, v24
M v[236:239], a[124:127], a[172:175], v[236:239]
 ds_read_b64_tr_b16 a[92:93], v4 offset:24576
 ds_read_b64_tr_b16 a[94:95], v4 offset:25600
M v[236:239], a[120:123], a[168:171], v[236:239]
 v_cmp_lt_i32 s[50:51], -3, v24
M v[240:243], a[128:131], a[168:171], v[240:243]
M v[240:243], a[132:135], a[172:175], v[240:243]
M v[244:247], a[140:143], a[172:175], v[244:247]
M v[244:247], a[136:139], a[168:171], v[244:247]
M v[248:251], a[144:147], a[168:171], v[248:251]
M v[248:251], a[148:151], a[172:175], v[248:251]
 s_waitcnt lgkmcnt(6)
M v[252:255], a[156:159], a[172:175], v[252:255]
 s_waitcnt lgkmcnt(0)
M v[252:255], a[152:155], a[168:171], v[252:255]
 s_barrier
M v[32:35], a[32:35], a[160:163], v[32:35]
 ds_read_b128 a[168:171], v5 offset:34816
 ds_read_b128 a[172:175], v6 offset:34816
M v[32:35], a[36:39], a[164:167], v[32:35]
 v_mov_b32 v1, v15
 v_add_u32 v2, 0x10000, v7
M v[36:39], a[44:47], a[164:167], v[36:39]
 v_mov_b32 v3, v10
 v_mov_b32 v4, v11
M v[36:39], a[40:43], a[160:163], v[36:39]
 s_mov_b64 s[60:61], s[76:77]
M v[40:43], a[48:51], a[160:163], v[40:43]
 s_mov_b32 s62, s78
M v[40:43], a[52:55], a[164:167], v[40:43]
 s_mov_b32 s63, 0x20000
 v_lshl_add_u32 v10, v0, 7, s95
 v_and_b32 v0, 48, v0
M v[44:47], a[60:63], a[164:167], v[44:47]
 v_lshl_add_u32 v0, v0, 24, v10
M v[44:47], a[56:59], a[160:163], v[44:47]
 v_mul_f32 v32, s5, v32
 v_mul_f32 v33, s5, v33
M v[48:51], a[64:67], a[160:163], v[48:51]
 v_mul_f32 v34, s5, v34
 v_mul_f32 v35, s5, v35
M v[48:51], a[68:71], a[164:167], v[48:51]
 v_mul_f32 v36, s5, v36
 v_mul_f32 v37, s5, v37
M v[52:55], a[76:79], a[164:167], v[52:55]
 v_mul_f32 v38, s5, v38
 v_mul_f32 v39, s5, v39
M v[52:55], a[72:75], a[160:163], v[52:55]
 v_cvt_pk_bf16_f32 v32, v32, v33
 v_cvt_pk_bf16_f32 v33, v34, v35
M v[56:59], a[80:83], a[160:163], v[56:59]
 v_cvt_pk_bf16_f32 v34, v36, v37
 v_cvt_pk_bf16_f32 v35, v38, v39
M v[56:59], a[84:87], a[164:167], v[56:59]
 s_waitcnt lgkmcnt(0)
 ds_write_b128 v14, v[32:35] offset:0
M v[60:63], a[92:95], a[164:167], v[60:63]
 s_add_u32 s3, s93, 532480
 buffer_store_dwordx4 v[144:147], v7, s[8:11], s3 offen offset:0 sc1
M v[60:63], a[88:91], a[160:163], v[60:63]
 v_mul_f32 v40, s5, v40
 v_mul_f32 v41, s5, v41
M v[96:99], a[32:35], a[168:171], v[96:99]
 ds_read_b128 a[160:163], v5 offset:36864
 ds_read_b128 a[164:167], v6 offset:36864
M v[96:99], a[36:39], a[172:175], v[96:99]
 v_mul_f32 v42, s5, v42
 v_mul_f32 v43, s5, v43
M v[100:103], a[44:47], a[172:175], v[100:103]
 v_mul_f32 v44, s5, v44
 v_mul_f32 v45, s5, v45
M v[100:103], a[40:43], a[168:171], v[100:103]
 v_mul_f32 v46, s5, v46
 v_mul_f32 v47, s5, v47
M v[104:107], a[48:51], a[168:171], v[104:107]
 v_cvt_pk_bf16_f32 v40, v40, v41
 v_cvt_pk_bf16_f32 v41, v42, v43
M v[104:107], a[52:55], a[172:175], v[104:107]
 v_cvt_pk_bf16_f32 v42, v44, v45
 v_cvt_pk_bf16_f32 v43, v46, v47
M v[108:111], a[60:63], a[172:175], v[108:111]
 ds_write_b128 v14, v[40:43] offset:1024
M v[108:111], a[56:59], a[168:171], v[108:111]
 buffer_store_dwordx4 v[148:151], v7, s[8:11], s3 offen offset:2048 sc1
M v[112:115], a[64:67], a[168:171], v[112:115]
 v_mul_f32 v48, s5, v48
 v_mul_f32 v49, s5, v49
M v[112:115], a[68:71], a[172:175], v[112:115]
 v_mul_f32 v50, s5, v50
 v_mul_f32 v51, s5, v51
M v[116:119], a[76:79], a[172:175], v[116:119]
 v_mul_f32 v52, s5, v52
 v_mul_f32 v53, s5, v53
M v[116:119], a[72:75], a[168:171], v[116:119]
 v_mul_f32 v54, s5, v54
 v_mul_f32 v55, s5, v55
M v[120:123], a[80:83], a[168:171], v[120:123]
 v_cvt_pk_bf16_f32 v48, v48, v49
 v_cvt_pk_bf16_f32 v49, v50, v51
M v[120:123], a[84:87], a[172:175], v[120:123]
 s_waitcnt lgkmcnt(1)
 v_cvt_pk_bf16_f32 v50, v52, v53
 v_cvt_pk_bf16_f32 v51, v54, v55
M v[124:127], a[92:95], a[172:175], v[124:127]
 ds_write_b128 v14, v[48:51] offset:2048
M v[124:127], a[88:91], a[168:171], v[124:127]
 s_add_u32 s3, s93, 536576
 buffer_store_dwordx4 v[152:155], v7, s[8:11], s3 offen offset:0 sc1
M v[160:163], a[32:35], a[160:163], v[160:163]
 ds_read_b128 a[168:171], v5 offset:38912
 ds_read_b128 a[172:175], v6 offset:38912
M v[160:163], a[36:39], a[164:167], v[160:163]
 v_mul_f32 v56, s5, v56
 v_mul_f32 v57, s5, v57
M v[164:167], a[44:47], a[164:167], v[164:167]
 v_mul_f32 v58, s5, v58
 v_mul_f32 v59, s5, v59
M v[164:167], a[40:43], a[160:163], v[164:167]
 v_mul_f32 v60, s5, v60
 v_mul_f32 v61, s5, v61
M v[168:171], a[48:51], a[160:163], v[168:171]
 v_mul_f32 v62, s5, v62
 v_mul_f32 v63, s5, v63
M v[168:171], a[52:55], a[164:167], v[168:171]
 v_cvt_pk_bf16_f32 v56, v56, v57
 v_cvt_pk_bf16_f32 v57, v58, v59
M v[172:175], a[60:63], a[164:167], v[172:175]
 v_cvt_pk_bf16_f32 v58, v60, v61
 v_cvt_pk_bf16_f32 v59, v62, v63
M v[172:175], a[56:59], a[160:163], v[172:175]
 s_waitcnt lgkmcnt(0)
 ds_write_b128 v14, v[56:59] offset:3072
M v[176:179], a[64:67], a[160:163], v[176:179]
 s_barrier
M v[176:179], a[68:71], a[164:167], v[176:179]
M v[180:183], a[76:79], a[164:167], v[180:183]
 s_add_u32 m0, s28, 32768
 s_nop 0
 buffer_load_dwordx4 v3, s[8:11], s21 offen offset:0 sc1 lds
M v[180:183], a[72:75], a[160:163], v[180:183]
M v[184:187], a[80:83], a[160:163], v[184:187]
 buffer_store_dwordx4 v[156:159], v7, s[8:11], s3 offen offset:2048 sc1
M v[184:187], a[84:87], a[164:167], v[184:187]
 v_mul_f32 v96, s5, v96
 v_mul_f32 v97, s5, v97
M v[188:191], a[92:95], a[164:167], v[188:191]
 buffer_load_dwordx4 v3, s[8:11], s21 offen offset:1024 sc1 lds
M v[188:191], a[88:91], a[160:163], v[188:191]
 v_mul_f32 v98, s5, v98
 v_mul_f32 v99, s5, v99
M v[224:227], a[32:35], a[168:171], v[224:227]
 v_mul_f32 v100, s5, v100
 v_mul_f32 v101, s5, v101
M v[224:227], a[36:39], a[172:175], v[224:227]
 v_mul_f32 v102, s5, v102
 v_mul_f32 v103, s5, v103
M v[228:231], a[44:47], a[172:175], v[228:231]
 buffer_load_dwordx4 v3, s[8:11], s21 offen offset:2048 sc1 lds
M v[228:231], a[40:43], a[168:171], v[228:231]
 v_cvt_pk_bf16_f32 v96, v96, v97
 v_cvt_pk_bf16_f32 v97, v98, v99
M v[232:235], a[48:51], a[168:171], v[232:235]
 v_cvt_pk_bf16_f32 v98, v100, v101
 v_cvt_pk_bf16_f32 v99, v102, v103
M v[232:235], a[52:55], a[172:175], v[232:235]
 ds_write_b128 v14, v[96:99] offset:8192
 v_mul_f32 v104, s5, v104
M v[236:239], a[60:63], a[172:175], v[236:239]
 buffer_load_dwordx4 v3, s[8:11], s21 offen offset:3072 sc1 lds
M v[236:239], a[56:59], a[168:171], v[236:239]
 s_add_u32 m0, s28, 36864
 v_mul_f32 v105, s5, v105
 v_mul_f32 v106, s5, v106
M v[240:243], a[64:67], a[168:171], v[240:243]
 v_mul_f32 v107, s5, v107
 v_mul_f32 v108, s5, v108
M v[240:243], a[68:71], a[172:175], v[240:243]
 v_mul_f32 v109, s5, v109
 v_mul_f32 v110, s5, v110
M v[244:247], a[76:79], a[172:175], v[244:247]
 buffer_load_dwordx4 v4, s[8:11], s21 offen offset:0 sc1 lds
M v[244:247], a[72:75], a[168:171], v[244:247]
 v_mul_f32 v111, s5, v111
 v_cvt_pk_bf16_f32 v104, v104, v105
M v[248:251], a[80:83], a[168:171], v[248:251]
 v_cvt_pk_bf16_f32 v105, v106, v107
 v_cvt_pk_bf16_f32 v106, v108, v109
M v[248:251], a[84:87], a[172:175], v[248:251]
 v_cvt_pk_bf16_f32 v107, v110, v111
 ds_write_b128 v14, v[104:107] offset:9216
M v[252:255], a[92:95], a[172:175], v[252:255]
 buffer_load_dwordx4 v4, s[8:11], s21 offen offset:1024 sc1 lds
M v[252:255], a[88:91], a[168:171], v[252:255]
 buffer_load_dwordx4 v4, s[8:11], s21 offen offset:2048 sc1 lds
 buffer_load_dwordx4 v4, s[8:11], s21 offen offset:3072 sc1 lds
 s_add_u32 s21, s21, 32768
 s_sub_u32 s22, s22, 1
 s_cmp_eq_u32 s22, 0
 s_cselect_b32 s21, s23, s21
 s_cselect_b32 s22, s24, s22
 s_cselect_b32 s23, s25, s23
 s_cselect_b32 s24, 0x7fff, s24
 v_mul_f32 v112, s5, v112
 v_mul_f32 v113, s5, v113
 v_mul_f32 v114, s5, v114
 v_mul_f32 v115, s5, v115
 v_mul_f32 v116, s5, v116
 v_mul_f32 v117, s5, v117
 v_mul_f32 v118, s5, v118
 v_mul_f32 v119, s5, v119
 v_cvt_pk_bf16_f32 v112, v112, v113
 v_cvt_pk_bf16_f32 v113, v114, v115
 v_cvt_pk_bf16_f32 v114, v116, v117
 v_cvt_pk_bf16_f32 v115, v118, v119
 ds_write_b128 v14, v[112:115] offset:10240
 v_pk_mul_f32 v[120:121], v[120:121], s[4:5] op_sel:[0,1] op_sel_hi:[1,1]
 v_pk_mul_f32 v[122:123], v[122:123], s[4:5] op_sel:[0,1] op_sel_hi:[1,1]
 v_pk_mul_f32 v[124:125], v[124:125], s[4:5] op_sel:[0,1] op_sel_hi:[1,1]
 v_pk_mul_f32 v[126:127], v[126:127], s[4:5] op_sel:[0,1] op_sel_hi:[1,1]
 v_cvt_pk_bf16_f32 v120, v120, v121
 v_cvt_pk_bf16_f32 v121, v122, v123
 v_cvt_pk_bf16_f32 v122, v124, v125
 v_cvt_pk_bf16_f32 v123, v126, v127
 ds_write_b128 v14, v[120:123] offset:11264
 v_pk_mul_f32 v[160:161], v[160:161], s[4:5] op_sel:[0,1] op_sel_hi:[1,1]
 v_pk_mul_f32 v[162:163], v[162:163], s[4:5] op_sel:[0,1] op_sel_hi:[1,1]
 v_pk_mul_f32 v[164:165], v[164:165], s[4:5] op_sel:[0,1] op_sel_hi:[1,1]
 v_pk_mul_f32 v[166:167], v[166:167], s[4:5] op_sel:[0,1] op_sel_hi:[1,1]
 v_cvt_pk_bf16_f32 v160, v160, v161
 v_cvt_pk_bf16_f32 v161, v162, v163
 v_cvt_pk_bf16_f32 v162, v164, v165
 v_cvt_pk_bf16_f32 v163, v166, v167
 ds_write_b128 v14, v[160:163] offset:16384
 v_pk_mul_f32 v[168:169], v[168:169], s[4:5] op_sel:[0,1] op_sel_hi:[1,1]
 v_pk_mul_f32 v[170:171], v[170:171], s[4:5] op_sel:[0,1] op_sel_hi:[1,1]
 v_pk_mul_f32 v[172:173], v[172:173], s[4:5] op_sel:[0,1] op_sel_hi:[1,1]
 v_pk_mul_f32 v[174:175], v[174:175], s[4:5] op_sel:[0,1] op_sel_hi:[1,1]
 v_cvt_pk_bf16_f32 v168, v168, v169
 v_cvt_pk_bf16_f32 v169, v170, v171
 v_cvt_pk_bf16_f32 v170, v172, v173
 v_cvt_pk_bf16_f32 v171, v174, v175
 ds_write_b128 v14, v[168:171] offset:17408
 v_pk_mul_f32 v[176:177], v[176:177], s[4:5] op_sel:[0,1] op_sel_hi:[1,1]
 v_pk_mul_f32 v[178:179], v[178:179], s[4:5] op_sel:[0,1] op_sel_hi:[1,1]
 v_pk_mul_f32 v[180:181], v[180:181], s[4:5] op_sel:[0,1] op_sel_hi:[1,1]
 v_pk_mul_f32 v[182:183], v[182:183], s[4:5] op_sel:[0,1] op_sel_hi:[1,1]
 v_cvt_pk_bf16_f32 v176, v176, v177
 v_cvt_pk_bf16_f32 v177, v178, v179
 v_cvt_pk_bf16_f32 v178, v180, v181
 v_cvt_pk_bf16_f32 v179, v182, v183
 ds_write_b128 v14, v[176:179] offset:18432
 v_pk_mul_f32 v[184:185], v[184:185], s[4:5] op_sel:[0,1] op_sel_hi:[1,1]
 v_pk_mul_f32 v[186:187], v[186:187], s[4:5] op_sel:[0,1] op_sel_hi:[1,1]
 v_pk_mul_f32 v[188:189], v[188:189], s[4:5] op_sel:[0,1] op_sel_hi:[1,1]
 v_pk_mul_f32 v[190:191], v[190:191], s[4:5] op_sel:[0,1] op_sel_hi:[1,1]
 v_cvt_pk_bf16_f32 v184, v184, v185
 v_cvt_pk_bf16_f32 v185, v186, v187
 v_cvt_pk_bf16_f32 v186, v188, v189
 v_cvt_pk_bf16_f32 v187, v190, v191
 ds_write_b128 v14, v[184:187] offset:19456
 v_pk_mul_f32 v[224:225], v[224:225], s[4:5] op_sel:[0,1] op_sel_hi:[1,1]
 v_pk_mul_f32 v[226:227], v[226:227], s[4:5] op_sel:[0,1] op_sel_hi:[1,1]
 v_pk_mul_f32 v[228:229], v[228:229], s[4:5] op_sel:[0,1] op_sel_hi:[1,1]
 v_pk_mul_f32 v[230:231], v[230:231], s[4:5] op_sel:[0,1] op_sel_hi:[1,1]
 v_cvt_pk_bf16_f32 v224, v224, v225
 v_cvt_pk_bf16_f32 v225, v226, v227
 v_cvt_pk_bf16_f32 v226, v228, v229
 v_cvt_pk_bf16_f32 v227, v230, v231
 ds_write_b128 v14, v[224:227] offset:24576
 v_pk_mul_f32 v[232:233], v[232:233], s[4:5] op_sel:[0,1] op_sel_hi:[1,1]
 v_pk_mul_f32 v[234:235], v[234:235], s[4:5] op_sel:[0,1] op_sel_hi:[1,1]
 v_pk_mul_f32 v[236:237], v[236:237], s[4:5] op_sel:[0,1] op_sel_hi:[1,1]
 v_pk_mul_f32 v[238:239], v[238:239], s[4:5] op_sel:[0,1] op_sel_hi:[1,1]
 v_cvt_pk_bf16_f32 v232, v232, v233
 v_cvt_pk_bf16_f32 v233, v234, v235
 v_cvt_pk_bf16_f32 v234, v236, v237
 v_cvt_pk_bf16_f32 v235, v238, v239
 ds_write_b128 v14, v[232:235] offset:25600
 v_pk_mul_f32 v[240:241], v[240:241], s[4:5] op_sel:[0,1] op_sel_hi:[1,1]
 v_pk_mul_f32 v[242:243], v[242:243], s[4:5] op_sel:[0,1] op_sel_hi:[1,1]
 v_pk_mul_f32 v[244:245], v[244:245], s[4:5] op_sel:[0,1] op_sel_hi:[1,1]
 v_pk_mul_f32 v[246:247], v[246:247], s[4:5] op_sel:[0,1] op_sel_hi:[1,1]
 v_cvt_pk_bf16_f32 v240, v240, v241
 v_cvt_pk_bf16_f32 v241, v242, v243
 v_cvt_pk_bf16_f32 v242, v244, v245
 v_cvt_pk_bf16_f32 v243, v246, v247
 ds_write_b128 v14, v[240:243] offset:26624
 v_pk_mul_f32 v[248:249], v[248:249], s[4:5] op_sel:[0,1] op_sel_hi:[1,1]
 v_pk_mul_f32 v[250:251], v[250:251], s[4:5] op_sel:[0,1] op_sel_hi:[1,1]
 v_pk_mul_f32 v[252:253], v[252:253], s[4:5] op_sel:[0,1] op_sel_hi:[1,1]
 v_pk_mul_f32 v[254:255], v[254:255], s[4:5] op_sel:[0,1] op_sel_hi:[1,1]
 v_cvt_pk_bf16_f32 v248, v248, v249
 v_cvt_pk_bf16_f32 v249, v250, v251
 v_cvt_pk_bf16_f32 v250, v252, v253
 v_cvt_pk_bf16_f32 v251, v254, v255
 ds_write_b128 v14, v[248:251] offset:27648
 s_waitcnt vmcnt(14) lgkmcnt(0)
 s_barrier
 ds_read_b128 a[64:67], v2 offset:32768
 ds_read_b128 a[68:71], v2 offset:33792
 ds_read_b128 a[72:75], v2 offset:34816
 ds_read_b128 a[76:79], v2 offset:35840
 ds_read_b128 a[80:83], v2 offset:36864
 ds_read_b128 a[84:87], v2 offset:37888
 ds_read_b128 a[88:91], v2 offset:38912
 ds_read_b128 a[92:95], v2 offset:39936
 s_lshr_b32 s64, s20, 1
 s_add_u32 s64, s64, 0
 s_lshl_b32 s64, s64, 17
 s_and_b32 s65, s20, 1
 s_lshl_b32 s65, s65, 14
 s_add_u32 s64, s64, s65
 v_add_u32 v10, s64, v7
 ds_read_b128 a[0:3], v10 offset:0
 ds_read_b128 a[4:7], v10 offset:1024
 ds_read_b128 a[8:11], v10 offset:2048
 ds_read_b128 a[12:15], v10 offset:3072
 ds_read_b128 a[16:19], v10 offset:4096
 ds_read_b128 a[20:23], v10 offset:5120
 ds_read_b128 a[24:27], v10 offset:6144
 ds_read_b128 a[28:31], v10 offset:7168
 ds_read_b128 a[32:35], v10 offset:8192
 ds_read_b128 a[36:39], v10 offset:9216
 ds_read_b128 a[40:43], v10 offset:10240
 ds_read_b128 a[44:47], v10 offset:11264
 ds_read_b128 a[48:51], v10 offset:12288
 ds_read_b128 a[52:55], v10 offset:13312
 ds_read_b128 a[56:59], v10 offset:14336
 ds_read_b128 a[60:63], v10 offset:15360
 v_mov_b32 v15, 2
 v_or_b32 v6, s35, v7
 v_mov_b32 v56, 0
 v_mov_b32 v57, 0
 v_mov_b32 v58, 0
 v_mov_b32 v59, 0
 s_waitcnt lgkmcnt(0)
M v[64:67], a[64:67], a[0:3], 0
 s_add_u32 m0, s28, 65536
 ds_read_b128 a[96:99], v2 offset:40960
 ds_read_b128 a[100:103], v2 offset:41984
M v[64:67], a[68:71], a[4:7], v[64:67]
 buffer_load_dwordx4 v3, s[8:11], s26 offen offset:0 sc1 lds
M v[64:67], a[72:75], a[8:11], v[64:67]
 v_accvgpr_write_b32 a128, v192
 v_accvgpr_write_b32 a129, v193
M v[64:67], a[76:79], a[12:15], v[64:67]
 s_cmp_eq_u32 s20, 0
 ds_read_b128 a[104:107], v2 offset:43008
 ds_read_b128 a[108:111], v2 offset:44032
M v[64:67], a[80:83], a[16:19], v[64:67]
 s_cselect_b64 s[64:65], -1, 0
 buffer_load_dwordx4 v3, s[8:11], s26 offen offset:1024 sc1 lds
M v[64:67], a[84:87], a[20:23], v[64:67]
 s_cmp_eq_u32 s20, 1
 v_accvgpr_write_b32 a130, v194
 v_accvgpr_write_b32 a131, v195
M v[64:67], a[88:91], a[24:27], v[64:67]
 s_cselect_b64 s[84:85], -1, 0
 ds_read_b128 a[112:115], v2 offset:45056
 ds_read_b128 a[116:119], v2 offset:46080
M v[64:67], a[92:95], a[28:31], v[64:67]
 s_or_b64 s[66:67], s[64:65], s[84:85]
 v_accvgpr_write_b32 a132, v196
 v_accvgpr_write_b32 a133, v197
M v[68:71], a[92:95], a[60:63], 0
 s_and_b64 s[68:69], s[16:17], s[64:65]
 buffer_load_dwordx4 v3, s[8:11], s26 offen offset:2048 sc1 lds
M v[68:71], a[88:91], a[56:59], v[68:71]
 s_and_b64 s[76:77], s[16:17], s[84:85]
 ds_read_b128 a[120:123], v2 offset:47104
 ds_read_b128 a[124:127], v2 offset:48128
M v[68:71], a[84:87], a[52:55], v[68:71]
 s_or_b64 s[76:77], s[76:77], s[64:65]
 v_accvgpr_write_b32 a134, v198
 v_accvgpr_write_b32 a135, v199
M v[68:71], a[80:83], a[48:51], v[68:71]
 s_and_b64 s[70:71], s[18:19], s[64:65]
 buffer_load_dwordx4 v3, s[8:11], s26 offen offset:3072 sc1 lds
M v[68:71], a[76:79], a[44:47], v[68:71]
 s_and_b64 s[78:79], s[18:19], s[84:85]
 v_accvgpr_write_b32 a136, v200
 v_accvgpr_write_b32 a137, v201
M v[68:71], a[72:75], a[40:43], v[68:71]
 s_or_b64 s[78:79], s[78:79], s[64:65]
 s_and_b64 s[72:73], s[48:49], s[64:65]
 s_and_b64 s[80:81], s[48:49], s[84:85]
M v[68:71], a[68:71], a[36:39], v[68:71]
 s_add_u32 m0, s28, 69632
 s_or_b64 s[80:81], s[80:81], s[64:65]
 s_and_b64 s[74:75], s[50:51], s[64:65]
M v[68:71], a[64:67], a[32:35], v[68:71]
 s_waitcnt lgkmcnt(0)
 buffer_load_dwordx4 v4, s[8:11], s26 offen offset:0 sc1 lds
M v[72:75], a[96:99], a[0:3], 0
 ds_read_b128 a[64:67], v2 offset:49152
 ds_read_b128 a[68:71], v2 offset:50176
M v[72:75], a[100:103], a[4:7], v[72:75]
 s_and_b64 s[82:83], s[50:51], s[84:85]
 v_accvgpr_write_b32 a138, v202
M v[72:75], a[104:107], a[8:11], v[72:75]
 s_or_b64 s[82:83], s[82:83], s[64:65]
 v_accvgpr_write_b32 a139, v203
 v_accvgpr_write_b32 a140, v204
M v[72:75], a[108:111], a[12:15], v[72:75]
 ds_read_b128 a[72:75], v2 offset:51200
 ds_read_b128 a[76:79], v2 offset:52224
M v[72:75], a[112:115], a[16:19], v[72:75]
 buffer_load_dwordx4 v4, s[8:11], s26 offen offset:1024 sc1 lds
M v[72:75], a[116:119], a[20:23], v[72:75]
 v_accvgpr_write_b32 a141, v205
 v_accvgpr_write_b32 a142, v206
M v[72:75], a[120:123], a[24:27], v[72:75]
 ds_read_b128 a[80:83], v2 offset:53248
 ds_read_b128 a[84:87], v2 offset:54272
M v[72:75], a[124:127], a[28:31], v[72:75]
 buffer_load_dwordx4 v4, s[8:11], s26 offen offset:2048 sc1 lds
M v[76:79], a[124:127], a[60:63], 0
 v_accvgpr_write_b32 a143, v207
 v_accvgpr_write_b32 a144, v208
M v[76:79], a[120:123], a[56:59], v[76:79]
 ds_read_b128 a[88:91], v2 offset:55296
 ds_read_b128 a[92:95], v2 offset:56320
M v[76:79], a[116:119], a[52:55], v[76:79]
 buffer_load_dwordx4 v4, s[8:11], s26 offen offset:3072 sc1 lds
M v[76:79], a[112:115], a[48:51], v[76:79]
 s_add_u32 s26, s26, 32768
 v_accvgpr_write_b32 a145, v209
 v_accvgpr_write_b32 a146, v210
M v[76:79], a[108:111], a[44:47], v[76:79]
 v_accvgpr_write_b32 a147, v211
 v_accvgpr_write_b32 a148, v212
M v[76:79], a[104:107], a[40:43], v[76:79]
 v_accvgpr_write_b32 a149, v213
 v_accvgpr_write_b32 a150, v214
M v[76:79], a[100:103], a[36:39], v[76:79]
 v_accvgpr_write_b32 a151, v215
 v_accvgpr_write_b32 a152, v216
M v[76:79], a[96:99], a[32:35], v[76:79]
 s_waitcnt lgkmcnt(0)
 v_accvgpr_write_b32 a153, v217
 v_accvgpr_write_b32 a154, v218
M v[80:83], a[64:67], a[0:3], 0
 s_add_u32 s3, s32, 0
 ds_read_b128 a[96:99], v2 offset:57344
 ds_read_b128 a[100:103], v2 offset:58368
M v[80:83], a[68:71], a[4:7], v[80:83]
 buffer_store_dwordx4 a[0:3], v6, s[8:11], s3 offen offset:0 sc1
M v[80:83], a[72:75], a[8:11], v[80:83]
 s_add_u32 s3, s32, 0
 v_accvgpr_write_b32 a155, v219
 v_accvgpr_write_b32 a156, v220
M v[80:83], a[76:79], a[12:15], v[80:83]
 ds_read_b128 a[104:107], v2 offset:59392
 ds_read_b128 a[108:111], v2 offset:60416
M v[80:83], a[80:83], a[16:19], v[80:83]
 v_accvgpr_write_b32 a157, v221
 v_accvgpr_write_b32 a158, v222
M v[80:83], a[84:87], a[20:23], v[80:83]
 buffer_store_dwordx4 a[4:7], v6, s[8:11], s3 offen offset:1024 sc1
M v[80:83], a[88:91], a[24:27], v[80:83]
 s_add_u32 s3, s32, 0
 ds_read_b128 a[112:115], v2 offset:61440
 ds_read_b128 a[116:119], v2 offset:62464
M v[80:83], a[92:95], a[28:31], v[80:83]
 v_accvgpr_write_b32 a159, v223
 v_mov_b32 v21, 0x3f80
M v[84:87], a[92:95], a[60:63], 0
 v_lshrrev_b32 v22, 8, v7
 v_bfe_u32 v23, v7, 6, 2
M v[84:87], a[88:91], a[56:59], v[84:87]
 ds_read_b128 a[120:123], v2 offset:63488
 ds_read_b128 a[124:127], v2 offset:64512
M v[84:87], a[84:87], a[52:55], v[84:87]
 buffer_store_dwordx4 a[8:11], v6, s[8:11], s3 offen offset:2048 sc1
M v[84:87], a[80:83], a[48:51], v[84:87]
 s_add_u32 s3, s32, 0
 v_and_b32 v24, 16, v7
 v_lshlrev_b32 v24, v24, v21
M v[84:87], a[76:79], a[44:47], v[84:87]
 v_cmp_eq_u32 vcc, v22, v23
 v_and_b32 v25, 32, v7
M v[84:87], a[72:75], a[40:43], v[84:87]
 v_accvgpr_write_b32 a224, 0
 v_accvgpr_write_b32 a232, -1
M v[84:87], a[68:71], a[36:39], v[84:87]
 s_waitcnt vmcnt(11) lgkmcnt(0)
 buffer_store_dwordx4 a[12:15], v6, s[8:11], s3 offen offset:3072 sc1
M v[84:87], a[64:67], a[32:35], v[84:87]
 s_barrier
M v[88:91], a[96:99], a[0:3], 0
 s_add_u32 s3, s32, 4096
 ds_read_b128 a[64:67], v7 offset:32768
 ds_read_b128 a[68:71], v7 offset:33792
M v[88:91], a[100:103], a[4:7], v[88:91]
 buffer_store_dword v15, v1, s[8:11], s45 offen sc1
M v[88:91], a[104:107], a[8:11], v[88:91]
 buffer_store_dwordx4 a[16:19], v6, s[8:11], s3 offen offset:0 sc1
M v[88:91], a[108:111], a[12:15], v[88:91]
 s_add_u32 s3, s32, 4096
 ds_read_b128 a[72:75], v7 offset:34816
 ds_read_b128 a[76:79], v7 offset:35840
M v[88:91], a[112:115], a[16:19], v[88:91]
 v_accvgpr_write_b32 a233, -1
 v_accvgpr_write_b32 a234, -1
M v[88:91], a[116:119], a[20:23], v[88:91]
 v_accvgpr_write_b32 a235, -1
 v_cndmask_b32 v24, 0, v24, vcc
M v[88:91], a[120:123], a[24:27], v[88:91]
 ds_read_b128 a[80:83], v7 offset:36864
 ds_read_b128 a[84:87], v7 offset:37888
M v[88:91], a[124:127], a[28:31], v[88:91]
 buffer_store_dwordx4 a[20:23], v6, s[8:11], s3 offen offset:1024 sc1
M v[92:95], a[124:127], a[60:63], 0
 s_add_u32 s3, s32, 4096
 v_cmp_eq_u32 vcc, 0, v25
 v_accvgpr_write_b32 a225, 0
M v[92:95], a[120:123], a[56:59], v[92:95]
 ds_read_b128 a[88:91], v7 offset:38912
 ds_read_b128 a[92:95], v7 offset:39936
M v[92:95], a[116:119], a[52:55], v[92:95]
 v_accvgpr_write_b32 a228, 0
 v_cndmask_b32 v22, 0, v24, vcc
M v[92:95], a[112:115], a[48:51], v[92:95]
 buffer_store_dwordx4 a[24:27], v6, s[8:11], s3 offen offset:2048 sc1
M v[92:95], a[108:111], a[44:47], v[92:95]
 s_add_u32 s3, s32, 4096
 v_sub_u32 v23, v24, v22
 v_accvgpr_write_b32 a229, 0
M v[92:95], a[104:107], a[40:43], v[92:95]
 v_accvgpr_write_b32 a226, v22
 v_accvgpr_write_b32 a227, v23
M v[92:95], a[100:103], a[36:39], v[92:95]
 s_waitcnt lgkmcnt(0)
M v[92:95], a[96:99], a[32:35], v[92:95]
 buffer_store_dwordx4 a[28:31], v6, s[8:11], s3 offen offset:3072 sc1
 s_add_u32 m0, s28, 98304
 v_max3_f32 v10, v64, v65, v66
 buffer_load_dwordx4 v3, s[8:11], s21 offen offset:0 sc1 lds
 v_max3_f32 v10, v67, v72, v10
 v_max3_f32 v10, v73, v74, v10
 v_max3_f32 v10, v75, v80, v10
 v_max3_f32 v10, v81, v82, v10
 v_max3_f32 v10, v83, v88, v10
 v_max3_f32 v10, v89, v90, v10
 v_max_f32 v10, v91, v10
 v_max3_f32 v11, v68, v69, v70
 v_max3_f32 v11, v71, v76, v11
 v_max3_f32 v11, v77, v78, v11
 v_max3_f32 v11, v79, v84, v11
 v_mfma_f32_32x32x16_bf16 v[128:143], v[56:59], v[56:59], 0
 v_max3_f32 v11, v85, v86, v11
 buffer_load_dwordx4 v3, s[8:11], s21 offen offset:1024 sc1 lds
 v_max3_f32 v11, v87, v92, v11
 v_max3_f32 v11, v93, v94, v11
 v_max_f32 v11, v95, v11
 v_mov_b32 v12, v10
 v_mov_b32 v13, v11
 s_nop 0
 v_permlane16_swap_b32 v12, v10
 v_permlane16_swap_b32 v13, v11
 v_max_f32 v10, v12, v10
 v_max_f32 v11, v13, v11
 v_mov_b32 v12, v10
 v_mov_b32 v13, v11
 s_nop 0
 v_permlane32_swap_b32 v12, v10
 v_mfma_f32_32x32x16_bf16 v[144:159], v[56:59], v[56:59], 0
 buffer_load_dwordx4 v3, s[8:11], s21 offen offset:2048 sc1 lds
 v_permlane32_swap_b32 v13, v11
 v_max_f32 v10, v12, v10
 v_max_f32 v11, v13, v11
 v_ceil_f32 v10, v10
 v_ceil_f32 v11, v11
 v_sub_f32 v32, 0, v10
 v_sub_f32 v33, 0, v10
 v_sub_f32 v34, 0, v10
 v_sub_f32 v35, 0, v10
 v_sub_f32 v36, 0, v11
 v_sub_f32 v37, 0, v11
 v_sub_f32 v38, 0, v11
 v_sub_f32 v39, 0, v11
 v_mfma_f32_32x32x16_bf16 v[160:175], v[56:59], v[56:59], 0
 buffer_load_dwordx4 v3, s[8:11], s21 offen offset:3072 sc1 lds
 v_sub_f32 v64, v64, v10
 v_sub_f32 v65, v65, v10
 v_sub_f32 v66, v66, v10
 v_sub_f32 v67, v67, v10
 v_sub_f32 v68, v68, v11
 v_sub_f32 v69, v69, v11
 v_sub_f32 v70, v70, v11
 v_sub_f32 v71, v71, v11
 v_sub_f32 v72, v72, v10
 v_sub_f32 v73, v73, v10
 v_sub_f32 v74, v74, v10
 s_add_u32 m0, s28, 102400
 v_sub_f32 v75, v75, v10
 v_mfma_f32_32x32x16_bf16 v[176:191], v[56:59], v[56:59], 0
 buffer_load_dwordx4 v4, s[8:11], s21 offen offset:0 sc1 lds
 v_sub_f32 v76, v76, v11
 v_sub_f32 v77, v77, v11
 v_sub_f32 v78, v78, v11
 v_sub_f32 v79, v79, v11
 v_sub_f32 v80, v80, v10
 v_sub_f32 v81, v81, v10
 v_sub_f32 v82, v82, v10
 v_sub_f32 v83, v83, v10
 v_sub_f32 v84, v84, v11
 v_sub_f32 v85, v85, v11
 v_sub_f32 v86, v86, v11
 v_sub_f32 v87, v87, v11
 buffer_load_dwordx4 v4, s[8:11], s21 offen offset:1024 sc1 lds
 v_mfma_f32_32x32x16_bf16 v[192:207], v[56:59], v[56:59], 0
 v_sub_f32 v88, v88, v10
 v_sub_f32 v89, v89, v10
 v_sub_f32 v90, v90, v10
 v_sub_f32 v91, v91, v10
 v_sub_f32 v92, v92, v11
 v_sub_f32 v93, v93, v11
 v_sub_f32 v94, v94, v11
 v_sub_f32 v95, v95, v11
 v_mov_b32 v30, 0
 v_mov_b32 v31, 0
 v_exp_f32 v18, v64
 v_exp_f32 v19, v65
 v_exp_f32 v20, v66
 buffer_load_dwordx4 v4, s[8:11], s21 offen offset:2048 sc1 lds
 v_mfma_f32_32x32x16_bf16 v[208:223], v[56:59], v[56:59], 0
 v_add_f32 v26, v18, v19
 v_cvt_pk_bf16_f32 v40, v18, v19
 v_exp_f32 v21, v67
 v_exp_f32 v22, v72
 v_add_f32 v26, v20, v26
 v_cvt_pk_bf16_f32 v41, v20, v21
 v_exp_f32 v23, v73
 v_add_f32 v26, v21, v26
 v_exp_f32 v24, v74
 v_add_f32 v26, v22, v26
 v_cvt_pk_bf16_f32 v42, v22, v23
 v_exp_f32 v25, v75
 buffer_load_dwordx4 v4, s[8:11], s21 offen offset:3072 sc1 lds
 s_add_u32 s21, s21, 32768
 v_mfma_f32_32x32x16_bf16 v[224:239], v[56:59], v[56:59], 0
 s_sub_u32 s22, s22, 1
 s_cmp_eq_u32 s22, 0
 s_cselect_b32 s21, s23, s21
 s_cselect_b32 s22, s24, s22
 s_cselect_b32 s23, s25, s23
 s_cselect_b32 s24, 0x7fff, s24
 v_add_f32 v26, v23, v26
 v_exp_f32 v18, v68
 v_add_f32 v26, v24, v26
 v_cvt_pk_bf16_f32 v43, v24, v25
 v_exp_f32 v19, v69
 v_add_f32 v26, v25, v26
 v_exp_f32 v20, v70
 v_add_f32 v27, v18, v19
 v_mfma_f32_32x32x16_bf16 v[240:255], v[56:59], v[56:59], 0
 v_cvt_pk_bf16_f32 v44, v18, v19
 v_exp_f32 v21, v71
 v_exp_f32 v22, v76
 v_add_f32 v27, v20, v27
 v_cvt_pk_bf16_f32 v45, v20, v21
 v_exp_f32 v23, v77
 v_add_f32 v27, v21, v27
 v_exp_f32 v24, v78
 v_add_f32 v27, v22, v27
 v_cvt_pk_bf16_f32 v46, v22, v23
 v_exp_f32 v25, v79
 v_add_f32 v27, v23, v27
 v_add_f32 v27, v24, v27
 v_cvt_pk_bf16_f32 v47, v24, v25
 v_add_f32 v27, v25, v27
M v[96:99], a[64:67], a[0:3], v[32:35]
 s_add_u32 m0, s28, 0
 ds_read_b128 a[96:99], v7 offset:40960
 ds_read_b128 a[100:103], v7 offset:41984
M v[96:99], a[68:71], a[4:7], v[96:99]
 buffer_load_dwordx4 v3, s[8:11], s26 offen offset:0 sc1 lds
M v[96:99], a[72:75], a[8:11], v[96:99]
 v_exp_f32 v18, v80
M v[96:99], a[76:79], a[12:15], v[96:99]
 s_lshl_b32 s3, s20, 10
 ds_read_b128 a[104:107], v7 offset:43008
 ds_read_b128 a[108:111], v7 offset:44032
M v[96:99], a[80:83], a[16:19], v[96:99]
 s_add_u32 s3, s3, s34
 v_exp_f32 v19, v81
M v[96:99], a[84:87], a[20:23], v[96:99]
 s_add_u32 s3, s3, 69632
 buffer_store_dwordx4 v[34:37], v6, s[8:11], s3 offen sc1
M v[96:99], a[88:91], a[24:27], v[96:99]
 ds_read_b128 a[112:115], v7 offset:45056
 ds_read_b128 a[116:119], v7 offset:46080
M v[96:99], a[92:95], a[28:31], v[96:99]
 s_add_u32 s3, s32, 8192
 v_exp_f32 v20, v82
M v[100:103], a[92:95], a[60:63], v[36:39]
 buffer_load_dwordx4 v3, s[8:11], s26 offen offset:1024 sc1 lds
M v[100:103], a[88:91], a[56:59], v[100:103]
 ds_read_b128 a[120:123], v7 offset:47104
 ds_read_b128 a[124:127], v7 offset:48128
M v[100:103], a[84:87], a[52:55], v[100:103]
 v_exp_f32 v21, v83
M v[100:103], a[80:83], a[48:51], v[100:103]
 buffer_store_dwordx4 a[32:35], v6, s[8:11], s3 offen offset:0 sc1
M v[100:103], a[76:79], a[44:47], v[100:103]
 s_add_u32 s3, s32, 8192
 v_add_f32 v26, v18, v26
 v_cvt_pk_bf16_f32 v56, v18, v19
M v[100:103], a[72:75], a[40:43], v[100:103]
 v_add_f32 v26, v19, v26
 v_add_f32 v26, v20, v26
M v[100:103], a[68:71], a[36:39], v[100:103]
 buffer_store_dwordx4 a[36:39], v6, s[8:11], s3 offen offset:1024 sc1
M v[100:103], a[64:67], a[32:35], v[100:103]
 s_waitcnt lgkmcnt(0)
 v_exp_f32 v22, v88
M v[104:107], a[96:99], a[0:3], v[32:35]
 s_add_u32 s3, s32, 8192
 ds_read_b128 a[64:67], v7 offset:49152
 ds_read_b128 a[68:71], v7 offset:50176
M v[104:107], a[100:103], a[4:7], v[104:107]
 buffer_load_dwordx4 v3, s[8:11], s26 offen offset:2048 sc1 lds
M v[104:107], a[104:107], a[8:11], v[104:107]
 v_exp_f32 v23, v89
M v[104:107], a[108:111], a[12:15], v[104:107]
 ds_read_b128 a[72:75], v7 offset:51200
 ds_read_b128 a[76:79], v7 offset:52224
M v[104:107], a[112:115], a[16:19], v[104:107]
 buffer_store_dwordx4 a[40:43], v6, s[8:11], s3 offen offset:2048 sc1
M v[104:107], a[116:119], a[20:23], v[104:107]
 s_add_u32 s3, s32, 8192
 buffer_store_dwordx4 a[44:47], v6, s[8:11], s3 offen offset:3072 sc1
M v[104:107], a[120:123], a[24:27], v[104:107]
 ds_read_b128 a[80:83], v7 offset:53248
 ds_read_b128 a[84:87], v7 offset:54272
M v[104:107], a[124:127], a[28:31], v[104:107]
 v_exp_f32 v24, v90
M v[108:111], a[124:127], a[60:63], v[36:39]
 s_add_u32 s3, s32, 12288
 buffer_load_dwordx4 v3, s[8:11], s26 offen offset:3072 sc1 lds
M v[108:111], a[120:123], a[56:59], v[108:111]
 ds_read_b128 a[88:91], v7 offset:55296
 ds_read_b128 a[92:95], v7 offset:56320
M v[108:111], a[116:119], a[52:55], v[108:111]
 v_exp_f32 v25, v91
M v[108:111], a[112:115], a[48:51], v[108:111]
 v_cvt_pk_bf16_f32 v57, v20, v21
 v_add_f32 v26, v21, v26
M v[108:111], a[108:111], a[44:47], v[108:111]
 buffer_store_dwordx4 a[48:51], v6, s[8:11], s3 offen offset:0 sc1
M v[108:111], a[104:107], a[40:43], v[108:111]
 s_add_u32 s3, s32, 12288
 v_exp_f32 v18, v84
M v[108:111], a[100:103], a[36:39], v[108:111]
 buffer_store_dwordx4 a[52:55], v6, s[8:11], s3 offen offset:1024 sc1
M v[108:111], a[96:99], a[32:35], v[108:111]
 s_waitcnt lgkmcnt(0)
 v_exp_f32 v19, v85
M v[112:115], a[64:67], a[0:3], v[32:35]
 s_add_u32 m0, s28, 4096
 ds_read_b128 a[96:99], v7 offset:57344
 ds_read_b128 a[100:103], v7 offset:58368
M v[112:115], a[68:71], a[4:7], v[112:115]
 s_add_u32 s3, s32, 12288
 buffer_load_dwordx4 v4, s[8:11], s26 offen offset:0 sc1 lds
M v[112:115], a[72:75], a[8:11], v[112:115]
 v_add_f32 v26, v22, v26
 v_cvt_pk_bf16_f32 v58, v22, v23
M v[112:115], a[76:79], a[12:15], v[112:115]
 ds_read_b128 a[104:107], v7 offset:59392
 ds_read_b128 a[108:111], v7 offset:60416
M v[112:115], a[80:83], a[16:19], v[112:115]
 buffer_store_dwordx4 a[56:59], v6, s[8:11], s3 offen offset:2048 sc1
M v[112:115], a[84:87], a[20:23], v[112:115]
 s_add_u32 s3, s32, 12288
 buffer_store_dwordx4 a[60:63], v6, s[8:11], s3 offen offset:3072 sc1
M v[112:115], a[88:91], a[24:27], v[112:115]
 ds_read_b128 a[112:115], v7 offset:61440
 ds_read_b128 a[116:119], v7 offset:62464
M v[112:115], a[92:95], a[28:31], v[112:115]
 v_exp_f32 v20, v86
M v[116:119], a[92:95], a[60:63], v[36:39]
 buffer_load_dwordx4 v4, s[8:11], s26 offen offset:1024 sc1 lds
M v[116:119], a[88:91], a[56:59], v[116:119]
 ds_read_b128 a[120:123], v7 offset:63488
 ds_read_b128 a[124:127], v7 offset:64512
M v[116:119], a[84:87], a[52:55], v[116:119]
 v_exp_f32 v21, v87
M v[116:119], a[80:83], a[48:51], v[116:119]
 v_add_f32 v26, v23, v26
 v_add_f32 v26, v24, v26
M v[116:119], a[76:79], a[44:47], v[116:119]
 v_exp_f32 v22, v92
M v[116:119], a[72:75], a[40:43], v[116:119]
 v_exp_f32 v23, v93
M v[116:119], a[68:71], a[36:39], v[116:119]
 s_waitcnt vmcnt(32) lgkmcnt(0)
 v_cvt_pk_bf16_f32 v59, v24, v25
 v_add_f32 v26, v25, v26
M v[116:119], a[64:67], a[32:35], v[116:119]
 s_barrier
M v[120:123], a[96:99], a[0:3], v[32:35]
 ds_read_b128 a[64:67], v2 offset:0
 ds_read_b128 a[68:71], v2 offset:1024
M v[120:123], a[100:103], a[4:7], v[120:123]
 buffer_load_dwordx4 v4, s[8:11], s26 offen offset:2048 sc1 lds
M v[120:123], a[104:107], a[8:11], v[120:123]
 v_exp_f32 v24, v94
M v[120:123], a[108:111], a[12:15], v[120:123]
 ds_read_b128 a[72:75], v2 offset:2048
 ds_read_b128 a[76:79], v2 offset:3072
M v[120:123], a[112:115], a[16:19], v[120:123]
 v_exp_f32 v25, v95
M v[120:123], a[116:119], a[20:23], v[120:123]
 v_add_f32 v27, v18, v27
 v_cvt_pk_bf16_f32 v60, v18, v19
M v[120:123], a[120:123], a[24:27], v[120:123]
 ds_read_b128 a[80:83], v2 offset:4096
 ds_read_b128 a[84:87], v2 offset:5120
M v[120:123], a[124:127], a[28:31], v[120:123]
 v_add_f32 v27, v19, v27
 v_add_f32 v27, v20, v27
M v[124:127], a[124:127], a[60:63], v[36:39]
 buffer_load_dwordx4 v4, s[8:11], s26 offen offset:3072 sc1 lds
M v[124:127], a[120:123], a[56:59], v[124:127]
 s_add_u32 s26, s26, 32768
 ds_read_b128 a[88:91], v2 offset:6144
 ds_read_b128 a[92:95], v2 offset:7168
M v[124:127], a[116:119], a[52:55], v[124:127]
 v_cvt_pk_bf16_f32 v61, v20, v21
 v_add_f32 v27, v21, v27
M v[124:127], a[112:115], a[48:51], v[124:127]
 v_add_f32 v27, v22, v27
 v_cvt_pk_bf16_f32 v62, v22, v23
M v[124:127], a[108:111], a[44:47], v[124:127]
 v_add_f32 v27, v23, v27
 v_add_f32 v27, v24, v27
M v[124:127], a[104:107], a[40:43], v[124:127]
 v_cvt_pk_bf16_f32 v63, v24, v25
 v_add_f32 v27, v25, v27
M v[124:127], a[100:103], a[36:39], v[124:127]
 s_waitcnt lgkmcnt(0)
M v[124:127], a[96:99], a[32:35], v[124:127]
 v_max_f32 v10, v26, v27
 v_cmp_lt_f32 vcc, s31, v10
 s_nop 0
 s_cbranch_vccnz L_st8
L_rt8:
M v[128:131], a[64:67], v[40:43], v[128:131]
 s_add_u32 m0, s28, 32768
 ds_read_b128 a[96:99], v2 offset:8192
 ds_read_b128 a[100:103], v2 offset:9216
M v[128:131], a[68:71], v[56:59], v[128:131]
 buffer_load_dwordx4 v3, s[8:11], s21 offen offset:0 sc1 lds
M v[132:135], a[68:71], v[60:63], v[132:135]
 v_exp_f32 v18, v96
M v[132:135], a[64:67], v[44:47], v[132:135]
 ds_read_b128 a[104:107], v2 offset:10240
 ds_read_b128 a[108:111], v2 offset:11264
M v[136:139], a[72:75], v[40:43], v[136:139]
 v_exp_f32 v19, v97
M v[136:139], a[76:79], v[56:59], v[136:139]
 buffer_load_dwordx4 v3, s[8:11], s21 offen offset:1024 sc1 lds
M v[140:143], a[76:79], v[60:63], v[140:143]
 ds_read_b128 a[112:115], v2 offset:12288
 ds_read_b128 a[116:119], v2 offset:13312
M v[140:143], a[72:75], v[44:47], v[140:143]
 v_exp_f32 v20, v98
M v[144:147], a[80:83], v[40:43], v[144:147]
 v_add_f32 v30, v26, v30
 v_add_f32 v31, v27, v31
M v[144:147], a[84:87], v[56:59], v[144:147]
 ds_read_b128 a[120:123], v2 offset:14336
 ds_read_b128 a[124:127], v2 offset:15360
M v[148:151], a[84:87], v[60:63], v[148:151]
 buffer_load_dwordx4 v3, s[8:11], s21 offen offset:2048 sc1 lds
M v[148:151], a[80:83], v[44:47], v[148:151]
 v_exp_f32 v21, v99
M v[152:155], a[88:91], v[40:43], v[152:155]
 v_add_f32 v28, v18, v19
 v_cvt_pk_bf16_f32 v48, v18, v19
M v[152:155], a[92:95], v[56:59], v[152:155]
 v_add_f32 v28, v20, v28
 v_cvt_pk_bf16_f32 v49, v20, v21
M v[156:159], a[92:95], v[60:63], v[156:159]
 buffer_load_dwordx4 v3, s[8:11], s21 offen offset:3072 sc1 lds
M v[156:159], a[88:91], v[44:47], v[156:159]
 s_waitcnt lgkmcnt(0)
 v_exp_f32 v22, v104
M v[160:163], a[96:99], v[40:43], v[160:163]
 ds_read_b128 a[64:67], v2 offset:16384
 ds_read_b128 a[68:71], v2 offset:17408
M v[160:163], a[100:103], v[56:59], v[160:163]
 v_add_f32 v28, v21, v28
M v[164:167], a[100:103], v[60:63], v[164:167]
 s_add_u32 m0, s28, 36864
 v_exp_f32 v23, v105
M v[164:167], a[96:99], v[44:47], v[164:167]
 ds_read_b128 a[72:75], v2 offset:18432
 ds_read_b128 a[76:79], v2 offset:19456
M v[168:171], a[104:107], v[40:43], v[168:171]
 buffer_load_dwordx4 v4, s[8:11], s21 offen offset:0 sc1 lds
M v[168:171], a[108:111], v[56:59], v[168:171]
 v_add_f32 v28, v22, v28
 v_cvt_pk_bf16_f32 v50, v22, v23
M v[172:175], a[108:111], v[60:63], v[172:175]
 ds_read_b128 a[80:83], v2 offset:20480
 ds_read_b128 a[84:87], v2 offset:21504
M v[172:175], a[104:107], v[44:47], v[172:175]
 v_exp_f32 v24, v106
M v[176:179], a[112:115], v[40:43], v[176:179]
 buffer_load_dwordx4 v4, s[8:11], s21 offen offset:1024 sc1 lds
M v[176:179], a[116:119], v[56:59], v[176:179]
 ds_read_b128 a[88:91], v2 offset:22528
 ds_read_b128 a[92:95], v2 offset:23552
M v[180:183], a[116:119], v[60:63], v[180:183]
 v_exp_f32 v25, v107
M v[180:183], a[112:115], v[44:47], v[180:183]
 v_add_f32 v28, v23, v28
 v_add_f32 v28, v24, v28
M v[184:187], a[120:123], v[40:43], v[184:187]
 buffer_load_dwordx4 v4, s[8:11], s21 offen offset:2048 sc1 lds
M v[184:187], a[124:127], v[56:59], v[184:187]
 v_exp_f32 v18, v100
M v[188:191], a[124:127], v[60:63], v[188:191]
 v_cvt_pk_bf16_f32 v51, v24, v25
 v_add_f32 v28, v25, v28
M v[188:191], a[120:123], v[44:47], v[188:191]
 s_waitcnt lgkmcnt(0)
M v[192:195], a[64:67], v[40:43], v[192:195]
 ds_read_b128 a[96:99], v2 offset:24576
 ds_read_b128 a[100:103], v2 offset:25600
M v[192:195], a[68:71], v[56:59], v[192:195]
 buffer_load_dwordx4 v4, s[8:11], s21 offen offset:3072 sc1 lds
M v[196:199], a[68:71], v[60:63], v[196:199]
 s_add_u32 s21, s21, 32768
 v_exp_f32 v19, v101
M v[196:199], a[64:67], v[44:47], v[196:199]
 s_sub_u32 s22, s22, 1
 ds_read_b128 a[104:107], v2 offset:26624
 ds_read_b128 a[108:111], v2 offset:27648
M v[200:203], a[72:75], v[40:43], v[200:203]
 s_cmp_eq_u32 s22, 0
 v_exp_f32 v20, v102
M v[200:203], a[76:79], v[56:59], v[200:203]
 s_cselect_b32 s21, s23, s21
 v_add_f32 v29, v18, v19
 v_cvt_pk_bf16_f32 v52, v18, v19
M v[204:207], a[76:79], v[60:63], v[204:207]
 s_cselect_b32 s22, s24, s22
 ds_read_b128 a[112:115], v2 offset:28672
 ds_read_b128 a[116:119], v2 offset:29696
M v[204:207], a[72:75], v[44:47], v[204:207]
 s_cselect_b32 s23, s25, s23
M v[208:211], a[80:83], v[40:43], v[208:211]
 s_cselect_b32 s24, 0x7fff, s24
 v_exp_f32 v21, v103
M v[208:211], a[84:87], v[56:59], v[208:211]
 ds_read_b128 a[120:123], v2 offset:30720
 ds_read_b128 a[124:127], v2 offset:31744
M v[212:215], a[84:87], v[60:63], v[212:215]
 v_add_f32 v29, v20, v29
 v_cvt_pk_bf16_f32 v53, v20, v21
M v[212:215], a[80:83], v[44:47], v[212:215]
 v_add_f32 v29, v21, v29
M v[216:219], a[88:91], v[40:43], v[216:219]
 v_exp_f32 v22, v108
M v[216:219], a[92:95], v[56:59], v[216:219]
M v[220:223], a[92:95], v[60:63], v[220:223]
 s_waitcnt vmcnt(11) lgkmcnt(0)
M v[220:223], a[88:91], v[44:47], v[220:223]
 s_barrier
M v[224:227], a[96:99], v[40:43], v[224:227]
 ds_read_b128 a[64:67], v2 offset:32768
 ds_read_b128 a[68:71], v2 offset:33792
M v[224:227], a[100:103], v[56:59], v[224:227]
 v_mov_b32 v17, 3
M v[228:231], a[100:103], v[60:63], v[228:231]
 buffer_store_dword v17, v1, s[8:11], s45 offen sc1
M v[228:231], a[96:99], v[44:47], v[228:231]
 ds_read_b128 a[72:75], v2 offset:34816
 ds_read_b128 a[76:79], v2 offset:35840
M v[232:235], a[104:107], v[40:43], v[232:235]
 v_exp_f32 v23, v109
M v[232:235], a[108:111], v[56:59], v[232:235]
 v_exp_f32 v24, v110
M v[236:239], a[108:111], v[60:63], v[236:239]
 ds_read_b128 a[80:83], v2 offset:36864
 ds_read_b128 a[84:87], v2 offset:37888
M v[236:239], a[104:107], v[44:47], v[236:239]
 v_exp_f32 v25, v111
M v[240:243], a[112:115], v[40:43], v[240:243]
 v_add_f32 v29, v22, v29
 v_cvt_pk_bf16_f32 v54, v22, v23
M v[240:243], a[116:119], v[56:59], v[240:243]
 ds_read_b128 a[88:91], v2 offset:38912
 ds_read_b128 a[92:95], v2 offset:39936
M v[244:247], a[116:119], v[60:63], v[244:247]
 v_add_f32 v29, v23, v29
 v_add_f32 v29, v24, v29
M v[244:247], a[112:115], v[44:47], v[244:247]
 v_cvt_pk_bf16_f32 v55, v24, v25
 v_add_f32 v29, v25, v29
M v[248:251], a[120:123], v[40:43], v[248:251]
M v[248:251], a[124:127], v[56:59], v[248:251]
M v[252:255], a[124:127], v[60:63], v[252:255]
 s_waitcnt lgkmcnt(0)
M v[252:255], a[120:123], v[44:47], v[252:255]
M v[64:67], a[64:67], a[0:3], v[32:35]
 s_add_u32 m0, s28, 65536
 ds_read_b128 a[96:99], v2 offset:40960
 ds_read_b128 a[100:103], v2 offset:41984
M v[64:67], a[68:71], a[4:7], v[64:67]
 buffer_load_dwordx4 v3, s[8:11], s26 offen offset:0 sc1 lds
M v[64:67], a[72:75], a[8:11], v[64:67]
 v_exp_f32 v18, v112
M v[64:67], a[76:79], a[12:15], v[64:67]
 s_add_u32 s3, s93, 786432
 ds_read_b128 a[104:107], v2 offset:43008
 ds_read_b128 a[108:111], v2 offset:44032
M v[64:67], a[80:83], a[16:19], v[64:67]
 buffer_store_dwordx4 a[128:131], v7, s[8:11], s3 offen offset:0 sc1
M v[64:67], a[84:87], a[20:23], v[64:67]
 v_exp_f32 v19, v113
M v[64:67], a[88:91], a[24:27], v[64:67]
 ds_read_b128 a[112:115], v2 offset:45056
 ds_read_b128 a[116:119], v2 offset:46080
M v[64:67], a[92:95], a[28:31], v[64:67]
 v_exp_f32 v20, v114
M v[68:71], a[92:95], a[60:63], v[36:39]
 buffer_load_dwordx4 v3, s[8:11], s26 offen offset:1024 sc1 lds
M v[68:71], a[88:91], a[56:59], v[68:71]
 ds_read_b128 a[120:123], v2 offset:47104
 ds_read_b128 a[124:127], v2 offset:48128
M v[68:71], a[84:87], a[52:55], v[68:71]
 s_add_u32 s3, s93, 786432
 v_exp_f32 v21, v115
M v[68:71], a[80:83], a[48:51], v[68:71]
 v_add_f32 v28, v18, v28
 v_cvt_pk_bf16_f32 v56, v18, v19
M v[68:71], a[76:79], a[44:47], v[68:71]
 buffer_store_dwordx4 a[132:135], v7, s[8:11], s3 offen offset:2048 sc1
M v[68:71], a[72:75], a[40:43], v[68:71]
 v_add_f32 v28, v19, v28
 v_add_f32 v28, v20, v28
M v[68:71], a[68:71], a[36:39], v[68:71]
 v_exp_f32 v22, v120
M v[68:71], a[64:67], a[32:35], v[68:71]
 s_waitcnt lgkmcnt(0)
 v_cvt_pk_bf16_f32 v57, v20, v21
 v_add_f32 v28, v21, v28
M v[72:75], a[96:99], a[0:3], v[32:35]
 ds_read_b128 a[64:67], v2 offset:49152
 ds_read_b128 a[68:71], v2 offset:50176
M v[72:75], a[100:103], a[4:7], v[72:75]
 s_add_u32 s3, s93, 790528
 buffer_load_dwordx4 v3, s[8:11], s26 offen offset:2048 sc1 lds
M v[72:75], a[104:107], a[8:11], v[72:75]
 v_exp_f32 v23, v121
M v[72:75], a[108:111], a[12:15], v[72:75]
 ds_read_b128 a[72:75], v2 offset:51200
 ds_read_b128 a[76:79], v2 offset:52224
M v[72:75], a[112:115], a[16:19], v[72:75]
 buffer_store_dwordx4 a[136:139], v7, s[8:11], s3 offen offset:0 sc1
M v[72:75], a[116:119], a[20:23], v[72:75]
 v_exp_f32 v24, v122
M v[72:75], a[120:123], a[24:27], v[72:75]
 ds_read_b128 a[80:83], v2 offset:53248
 ds_read_b128 a[84:87], v2 offset:54272
M v[72:75], a[124:127], a[28:31], v[72:75]
 v_add_f32 v28, v22, v28
 v_cvt_pk_bf16_f32 v58, v22, v23
M v[76:79], a[124:127], a[60:63], v[36:39]
 s_add_u32 s3, s93, 790528
 buffer_load_dwordx4 v3, s[8:11], s26 offen offset:3072 sc1 lds
M v[76:79], a[120:123], a[56:59], v[76:79]
 ds_read_b128 a[88:91], v2 offset:55296
 ds_read_b128 a[92:95], v2 offset:56320
M v[76:79], a[116:119], a[52:55], v[76:79]
 v_exp_f32 v25, v123
M v[76:79], a[112:115], a[48:51], v[76:79]
 v_add_f32 v28, v23, v28
 v_add_f32 v28, v24, v28
M v[76:79], a[108:111], a[44:47], v[76:79]
 buffer_store_dwordx4 a[140:143], v7, s[8:11], s3 offen offset:2048 sc1
M v[76:79], a[104:107], a[40:43], v[76:79]
 v_exp_f32 v18, v116
M v[76:79], a[100:103], a[36:39], v[76:79]
 v_cvt_pk_bf16_f32 v59, v24, v25
 v_add_f32 v28, v25, v28
M v[76:79], a[96:99], a[32:35], v[76:79]
 s_waitcnt lgkmcnt(0)
 v_exp_f32 v19, v117
M v[80:83], a[64:67], a[0:3], v[32:35]
 s_add_u32 m0, s28, 69632
 ds_read_b128 a[96:99], v2 offset:57344
 ds_read_b128 a[100:103], v2 offset:58368
M v[80:83], a[68:71], a[4:7], v[80:83]
 s_add_u32 s3, s93, 794624
 buffer_load_dwordx4 v4, s[8:11], s26 offen offset:0 sc1 lds
M v[80:83], a[72:75], a[8:11], v[80:83]
 v_add_f32 v29, v18, v29
 v_cvt_pk_bf16_f32 v60, v18, v19
M v[80:83], a[76:79], a[12:15], v[80:83]
 ds_read_b128 a[104:107], v2 offset:59392
 ds_read_b128 a[108:111], v2 offset:60416
M v[80:83], a[80:83], a[16:19], v[80:83]
 buffer_store_dwordx4 a[144:147], v7, s[8:11], s3 offen offset:0 sc1
M v[80:83], a[84:87], a[20:23], v[80:83]
 v_exp_f32 v20, v118
M v[80:83], a[88:91], a[24:27], v[80:83]
 s_add_u32 s3, s93, 794624
 ds_read_b128 a[112:115], v2 offset:61440
 ds_read_b128 a[116:119], v2 offset:62464
M v[80:83], a[92:95], a[28:31], v[80:83]
 v_exp_f32 v21, v119
M v[84:87], a[92:95], a[60:63], v[36:39]
 buffer_load_dwordx4 v4, s[8:11], s26 offen offset:1024 sc1 lds
M v[84:87], a[88:91], a[56:59], v[84:87]
 ds_read_b128 a[120:123], v2 offset:63488
 ds_read_b128 a[124:127], v2 offset:64512
M v[84:87], a[84:87], a[52:55], v[84:87]
 buffer_store_dwordx4 a[148:151], v7, s[8:11], s3 offen offset:2048 sc1
M v[84:87], a[80:83], a[48:51], v[84:87]
 v_exp_f32 v22, v124
M v[84:87], a[76:79], a[44:47], v[84:87]
 v_add_f32 v29, v19, v29
 v_add_f32 v29, v20, v29
M v[84:87], a[72:75], a[40:43], v[84:87]
 s_add_u32 s3, s93, 798720
 buffer_store_dwordx4 a[152:155], v7, s[8:11], s3 offen offset:0 sc1
M v[84:87], a[68:71], a[36:39], v[84:87]
 s_waitcnt vmcnt(22) lgkmcnt(0)
 v_exp_f32 v23, v125
M v[84:87], a[64:67], a[32:35], v[84:87]
 s_barrier
M v[88:91], a[96:99], a[0:3], v[32:35]
 ds_read_b128 a[64:67], v7 offset:0
 ds_read_b128 a[68:71], v7 offset:1024
M v[88:91], a[100:103], a[4:7], v[88:91]
 buffer_load_dwordx4 v4, s[8:11], s26 offen offset:2048 sc1 lds
M v[88:91], a[104:107], a[8:11], v[88:91]
 v_exp_f32 v24, v126
M v[88:91], a[108:111], a[12:15], v[88:91]
 ds_read_b128 a[72:75], v7 offset:2048
 ds_read_b128 a[76:79], v7 offset:3072
M v[88:91], a[112:115], a[16:19], v[88:91]
 s_add_u32 s3, s93, 798720
 buffer_store_dwordx4 a[156:159], v7, s[8:11], s3 offen offset:2048 sc1
M v[88:91], a[116:119], a[20:23], v[88:91]
 v_exp_f32 v25, v127
M v[88:91], a[120:123], a[24:27], v[88:91]
 ds_read_b128 a[80:83], v7 offset:4096
 ds_read_b128 a[84:87], v7 offset:5120
M v[88:91], a[124:127], a[28:31], v[88:91]
 v_cvt_pk_bf16_f32 v61, v20, v21
 v_add_f32 v29, v21, v29
M v[92:95], a[124:127], a[60:63], v[36:39]
 buffer_load_dwordx4 v4, s[8:11], s26 offen offset:3072 sc1 lds
M v[92:95], a[120:123], a[56:59], v[92:95]
 s_add_u32 s26, s26, 32768
 ds_read_b128 a[88:91], v7 offset:6144
 ds_read_b128 a[92:95], v7 offset:7168
M v[92:95], a[116:119], a[52:55], v[92:95]
 v_add_f32 v29, v22, v29
 v_cvt_pk_bf16_f32 v62, v22, v23
M v[92:95], a[112:115], a[48:51], v[92:95]
 v_add_f32 v29, v23, v29
 v_add_f32 v29, v24, v29
M v[92:95], a[108:111], a[44:47], v[92:95]
 v_cvt_pk_bf16_f32 v63, v24, v25
 v_add_f32 v29, v25, v29
M v[92:95], a[104:107], a[40:43], v[92:95]
M v[92:95], a[100:103], a[36:39], v[92:95]
 s_waitcnt lgkmcnt(0)
M v[92:95], a[96:99], a[32:35], v[92:95]
 v_max_f32 v10, v28, v29
 v_cmp_lt_f32 vcc, s31, v10
 s_nop 0
 s_cbranch_vccnz L_st9
L_rt9:
M v[128:131], a[64:67], v[48:51], v[128:131]
 s_add_u32 m0, s28, 98304
 ds_read_b128 a[96:99], v7 offset:8192
 ds_read_b128 a[100:103], v7 offset:9216
M v[128:131], a[68:71], v[56:59], v[128:131]
 buffer_load_dwordx4 v3, s[8:11], s21 offen offset:0 sc1 lds
M v[132:135], a[68:71], v[60:63], v[132:135]
 v_exp_f32 v18, v64
M v[132:135], a[64:67], v[52:55], v[132:135]
 ds_read_b128 a[104:107], v7 offset:10240
 ds_read_b128 a[108:111], v7 offset:11264
M v[136:139], a[72:75], v[48:51], v[136:139]
 v_exp_f32 v19, v65
M v[136:139], a[76:79], v[56:59], v[136:139]
 s_add_u32 s3, s94, 0
 buffer_store_dwordx4 a[192:195], v7, s[8:11], s3 offen sc1
M v[140:143], a[76:79], v[60:63], v[140:143]
 ds_read_b128 a[112:115], v7 offset:12288
 ds_read_b128 a[116:119], v7 offset:13312
M v[140:143], a[72:75], v[52:55], v[140:143]
 v_exp_f32 v20, v66
M v[144:147], a[80:83], v[48:51], v[144:147]
 buffer_load_dwordx4 v3, s[8:11], s21 offen offset:1024 sc1 lds
M v[144:147], a[84:87], v[56:59], v[144:147]
 ds_read_b128 a[120:123], v7 offset:14336
 ds_read_b128 a[124:127], v7 offset:15360
M v[148:151], a[84:87], v[60:63], v[148:151]
 v_add_f32 v30, v28, v30
 v_add_f32 v31, v29, v31
M v[148:151], a[80:83], v[52:55], v[148:151]
 s_add_u32 s3, s94, 32768
 buffer_store_dwordx4 a[196:199], v7, s[8:11], s3 offen sc1
M v[152:155], a[88:91], v[48:51], v[152:155]
 v_exp_f32 v21, v67
M v[152:155], a[92:95], v[56:59], v[152:155]
 v_add_f32 v26, v18, v19
 v_cvt_pk_bf16_f32 v40, v18, v19
M v[156:159], a[92:95], v[60:63], v[156:159]
 v_exp_f32 v22, v72
M v[156:159], a[88:91], v[52:55], v[156:159]
 s_waitcnt lgkmcnt(0)
 buffer_load_dwordx4 v3, s[8:11], s21 offen offset:2048 sc1 lds
M v[160:163], a[96:99], v[48:51], v[160:163]
 ds_read_b128 a[64:67], v7 offset:16384
 ds_read_b128 a[68:71], v7 offset:17408
M v[160:163], a[100:103], v[56:59], v[160:163]
 s_add_u32 s3, s94, 65536
 v_add_f32 v26, v20, v26
 v_cvt_pk_bf16_f32 v41, v20, v21
M v[164:167], a[100:103], v[60:63], v[164:167]
 buffer_store_dwordx4 a[200:203], v7, s[8:11], s3 offen sc1
M v[164:167], a[96:99], v[52:55], v[164:167]
 ds_read_b128 a[72:75], v7 offset:18432
 ds_read_b128 a[76:79], v7 offset:19456
M v[168:171], a[104:107], v[48:51], v[168:171]
 v_exp_f32 v23, v73
M v[168:171], a[108:111], v[56:59], v[168:171]
 v_add_f32 v26, v21, v26
 v_add_f32 v26, v22, v26
M v[172:175], a[108:111], v[60:63], v[172:175]
 ds_read_b128 a[80:83], v7 offset:20480
 ds_read_b128 a[84:87], v7 offset:21504
M v[172:175], a[104:107], v[52:55], v[172:175]
 s_add_u32 s3, s94, 98304
 buffer_load_dwordx4 v3, s[8:11], s21 offen offset:3072 sc1 lds
M v[176:179], a[112:115], v[48:51], v[176:179]
 v_exp_f32 v24, v74
M v[176:179], a[116:119], v[56:59], v[176:179]
 ds_read_b128 a[88:91], v7 offset:22528
 ds_read_b128 a[92:95], v7 offset:23552
M v[180:183], a[116:119], v[60:63], v[180:183]
 buffer_store_dwordx4 a[204:207], v7, s[8:11], s3 offen sc1
M v[180:183], a[112:115], v[52:55], v[180:183]
 v_exp_f32 v25, v75
M v[184:187], a[120:123], v[48:51], v[184:187]
 s_add_u32 m0, s28, 102400
 v_cvt_pk_bf16_f32 v42, v22, v23
 v_add_f32 v26, v23, v26
M v[184:187], a[124:127], v[56:59], v[184:187]
 buffer_load_dwordx4 v4, s[8:11], s21 offen offset:0 sc1 lds
M v[188:191], a[124:127], v[60:63], v[188:191]
 s_add_u32 s3, s94, 131072
 v_exp_f32 v18, v68
M v[188:191], a[120:123], v[52:55], v[188:191]
 s_waitcnt lgkmcnt(0)
 v_add_f32 v26, v24, v26
 v_cvt_pk_bf16_f32 v43, v24, v25
M v[192:195], a[64:67], v[48:51], v[192:195]
 ds_read_b128 a[96:99], v7 offset:24576
 ds_read_b128 a[100:103], v7 offset:25600
M v[192:195], a[68:71], v[56:59], v[192:195]
 buffer_store_dwordx4 a[208:211], v7, s[8:11], s3 offen sc1
M v[196:199], a[68:71], v[60:63], v[196:199]
 v_exp_f32 v19, v69
M v[196:199], a[64:67], v[52:55], v[196:199]
 ds_read_b128 a[104:107], v7 offset:26624
 ds_read_b128 a[108:111], v7 offset:27648
M v[200:203], a[72:75], v[48:51], v[200:203]
 s_add_u32 s3, s94, 163840
 buffer_load_dwordx4 v4, s[8:11], s21 offen offset:1024 sc1 lds
M v[200:203], a[76:79], v[56:59], v[200:203]
 v_exp_f32 v20, v70
M v[204:207], a[76:79], v[60:63], v[204:207]
 ds_read_b128 a[112:115], v7 offset:28672
 ds_read_b128 a[116:119], v7 offset:29696
M v[204:207], a[72:75], v[52:55], v[204:207]
 buffer_store_dwordx4 a[212:215], v7, s[8:11], s3 offen sc1
M v[208:211], a[80:83], v[48:51], v[208:211]
 v_exp_f32 v21, v71
M v[208:211], a[84:87], v[56:59], v[208:211]
 ds_read_b128 a[120:123], v7 offset:30720
 ds_read_b128 a[124:127], v7 offset:31744
M v[212:215], a[84:87], v[60:63], v[212:215]
 s_add_u32 s3, s94, 196608
 v_add_f32 v26, v25, v26
 v_add_f32 v27, v18, v19
M v[212:215], a[80:83], v[52:55], v[212:215]
 buffer_load_dwordx4 v4, s[8:11], s21 offen offset:2048 sc1 lds
M v[216:219], a[88:91], v[48:51], v[216:219]
 v_exp_f32 v22, v76
M v[216:219], a[92:95], v[56:59], v[216:219]
 v_cvt_pk_bf16_f32 v44, v18, v19
 v_add_f32 v27, v20, v27
M v[220:223], a[92:95], v[60:63], v[220:223]
 s_waitcnt vmcnt(30) lgkmcnt(0)
 buffer_store_dwordx4 a[216:219], v7, s[8:11], s3 offen sc1
M v[220:223], a[88:91], v[52:55], v[220:223]
 s_barrier
M v[224:227], a[96:99], v[48:51], v[224:227]
 ds_read_b128 a[64:67], v7 offset:32768
 ds_read_b128 a[68:71], v7 offset:33792
M v[224:227], a[100:103], v[56:59], v[224:227]
 v_exp_f32 v23, v77
M v[228:231], a[100:103], v[60:63], v[228:231]
 buffer_load_dwordx4 v4, s[8:11], s21 offen offset:3072 sc1 lds
M v[228:231], a[96:99], v[52:55], v[228:231]
 s_add_u32 s21, s21, 32768
 ds_read_b128 a[72:75], v7 offset:34816
 ds_read_b128 a[76:79], v7 offset:35840
M v[232:235], a[104:107], v[48:51], v[232:235]
 s_sub_u32 s22, s22, 1
 v_exp_f32 v24, v78
M v[232:235], a[108:111], v[56:59], v[232:235]
 s_cmp_eq_u32 s22, 0
 v_cvt_pk_bf16_f32 v45, v20, v21
 v_add_f32 v27, v21, v27
M v[236:239], a[108:111], v[60:63], v[236:239]
 s_cselect_b32 s21, s23, s21
 ds_read_b128 a[80:83], v7 offset:36864
 ds_read_b128 a[84:87], v7 offset:37888
M v[236:239], a[104:107], v[52:55], v[236:239]
 s_cselect_b32 s22, s24, s22
 v_exp_f32 v25, v79
M v[240:243], a[112:115], v[48:51], v[240:243]
 s_cselect_b32 s23, s25, s23
 v_add_f32 v27, v22, v27
 v_cvt_pk_bf16_f32 v46, v22, v23
M v[240:243], a[116:119], v[56:59], v[240:243]
 s_cselect_b32 s24, 0x7fff, s24
 ds_read_b128 a[88:91], v7 offset:38912
 ds_read_b128 a[92:95], v7 offset:39936
M v[244:247], a[116:119], v[60:63], v[244:247]
 v_add_f32 v27, v23, v27
 v_add_f32 v27, v24, v27
M v[244:247], a[112:115], v[52:55], v[244:247]
 v_cvt_pk_bf16_f32 v47, v24, v25
 v_add_f32 v27, v25, v27
M v[248:251], a[120:123], v[48:51], v[248:251]
M v[248:251], a[124:127], v[56:59], v[248:251]
 s_sub_u32 s27, s27, 1
M v[252:255], a[124:127], v[60:63], v[252:255]
 s_waitcnt lgkmcnt(0)
M v[252:255], a[120:123], v[52:55], v[252:255]
 s_branch L_loop_mid
L_null:
 v_mov_b32 v48, 0
 v_mov_b32 v49, 0
 v_mov_b32 v50, 0
 v_mov_b32 v51, 0
 v_mov_b32 v52, 0
 v_mov_b32 v53, 0
 v_mov_b32 v54, 0
 v_mov_b32 v55, 0
 v_mov_b32 v28, 0
 v_mov_b32 v29, 0
 v_mov_b32 v112, v8
 v_mov_b32 v113, v8
 v_mov_b32 v114, v8
 v_mov_b32 v115, v8
 v_mov_b32 v116, v8
 v_mov_b32 v117, v8
 v_mov_b32 v118, v8
 v_mov_b32 v119, v8
 v_mov_b32 v120, v8
 v_mov_b32 v121, v8
 v_mov_b32 v122, v8
 v_mov_b32 v123, v8
 v_mov_b32 v124, v8
 v_mov_b32 v125, v8
 v_mov_b32 v126, v8
 v_mov_b32 v127, v8
 s_sub_u32 s26, s26, 32768
 s_branch L_null
L_zs0:
 s_mov_b32 s64, 65536
L_zs0_l:
 s_sleep 2
 buffer_load_dword v17, v16, s[12:15], 0 offen sc1
 s_sub_u32 s64, s64, 1
 s_cbranch_scc1 L_zs0_x
 s_waitcnt vmcnt(0)
 v_cmp_ne_u32 vcc, 1, v17
 s_nop 0
 s_cbranch_vccnz L_zs0_l
L_zs0_x:
 s_waitcnt vmcnt(0)
 s_branch L_zr0
L_zs1:
 s_mov_b32 s64, 65536
L_zs1_l:
 s_sleep 2
 buffer_load_dword v17, v16, s[12:15], 0 offen sc1
 s_sub_u32 s64, s64, 1
 s_cbranch_scc1 L_zs1_x
 s_waitcnt vmcnt(0)
 v_cmp_ne_u32 vcc, 1, v17
 s_nop 0
 s_cbranch_vccnz L_zs1_l
L_zs1_x:
 s_waitcnt vmcnt(0)
 s_branch L_zr1
L_hs:
 s_mov_b32 s91, 65536
L_hs_l:
 buffer_load_dwordx4 v[16:19], v7, s[8:11], s67 offen offset:0 sc1
 buffer_load_dwordx4 v[20:23], v7, s[8:11], s67 offen offset:1024 sc1
 s_waitcnt vmcnt(0)
 s_sub_u32 s91, s91, 1
 s_cbranch_scc1 L_hr
 v_min3_u32 v28, v16, v17, v18
 v_min3_u32 v28, v28, v19, v20
 v_min3_u32 v28, v28, v21, v22
 v_min_u32 v28, v28, v23
 v_cmp_eq_u32 vcc, 0, v28
 s_nop 0
 s_cbranch_vccnz L_hs_l
 s_branch L_hr
L_f1s0:
 s_mov_b32 s91, 65536
L_f1s0_l:
 s_sleep 2
 buffer_load_dword v24, v25, s[8:11], s46 offen sc1
 s_sub_u32 s91, s91, 1
 s_cbranch_scc1 L_f1s0_x
 s_waitcnt vmcnt(0)
 v_cmp_eq_u32 vcc, 0, v24
 s_nop 0
 s_cbranch_vccnz L_f1s0_l
L_f1s0_x:
 s_waitcnt vmcnt(0)
 s_branch L_f1r0
L_f1s1:
 s_mov_b32 s91, 65536
L_f1s1_l:
 s_sleep 2
 buffer_load_dword v24, v25, s[8:11], s46 offen sc1
 s_sub_u32 s91, s91, 1
 s_cbranch_scc1 L_f1s1_x
 s_waitcnt vmcnt(0)
 v_cmp_eq_u32 vcc, 0, v24
 s_nop 0
 s_cbranch_vccnz L_f1s1_l
L_f1s1_x:
 s_waitcnt vmcnt(0)
 s_branch L_f1r1
.p2align 6
L_loop_top:
M v[64:67], a[64:67], a[0:3], v[32:35]
 s_add_u32 m0, s28, 65536
 ds_read_b128 a[96:99], v2 offset:40960
M v[64:67], a[68:71], a[4:7], v[64:67]
 ds_read_b128 a[100:103], v2 offset:41984
M v[64:67], a[72:75], a[8:11], v[64:67]
 buffer_load_dword a240, v0, s[60:63], 0 offen offset:0
M v[64:67], a[76:79], a[12:15], v[64:67]
 ds_read_b128 a[104:107], v2 offset:43008
M v[64:67], a[80:83], a[16:19], v[64:67]
 ds_read_b128 a[108:111], v2 offset:44032
M v[64:67], a[84:87], a[20:23], v[64:67]
 buffer_load_dwordx4 v3, s[8:11], s26 offen offset:0 sc1 lds
M v[64:67], a[88:91], a[24:27], v[64:67]
 ds_read_b128 a[112:115], v2 offset:45056
M v[64:67], a[92:95], a[28:31], v[64:67]
 ds_read_b128 a[116:119], v2 offset:46080
M v[68:71], a[92:95], a[60:63], v[36:39]
 buffer_load_dwordx4 v3, s[8:11], s26 offen offset:1024 sc1 lds
M v[68:71], a[88:91], a[56:59], v[68:71]
 ds_read_b128 a[120:123], v2 offset:47104
M v[68:71], a[84:87], a[52:55], v[68:71]
 ds_read_b128 a[124:127], v2 offset:48128
M v[68:71], a[80:83], a[48:51], v[68:71]
 v_exp_f32 v18, v112
M v[68:71], a[76:79], a[44:47], v[68:71]
 buffer_load_dwordx4 v3, s[8:11], s26 offen offset:2048 sc1 lds
M v[68:71], a[72:75], a[40:43], v[68:71]
 v_exp_f32 v19, v113
M v[68:71], a[68:71], a[36:39], v[68:71]
 v_exp_f32 v20, v114
M v[68:71], a[64:67], a[32:35], v[68:71]
 s_waitcnt lgkmcnt(0)
 v_exp_f32 v21, v115
M v[72:75], a[96:99], a[0:3], v[32:35]
 ds_read_b128 a[64:67], v2 offset:49152
 v_add_f32 v28, v18, v28
M v[72:75], a[100:103], a[4:7], v[72:75]
 ds_read_b128 a[68:71], v2 offset:50176
 v_cvt_pk_bf16_f32 v56, v18, v19
M v[72:75], a[104:107], a[8:11], v[72:75]
 buffer_load_dwordx4 v3, s[8:11], s26 offen offset:3072 sc1 lds
M v[72:75], a[108:111], a[12:15], v[72:75]
 ds_read_b128 a[72:75], v2 offset:51200
 v_add_f32 v28, v19, v28
M v[72:75], a[112:115], a[16:19], v[72:75]
 ds_read_b128 a[76:79], v2 offset:52224
 v_add_f32 v28, v20, v28
M v[72:75], a[116:119], a[20:23], v[72:75]
 v_exp_f32 v22, v120
M v[72:75], a[120:123], a[24:27], v[72:75]
 s_add_u32 m0, s28, 69632
 ds_read_b128 a[80:83], v2 offset:53248
 v_cvt_pk_bf16_f32 v57, v20, v21
M v[72:75], a[124:127], a[28:31], v[72:75]
 ds_read_b128 a[84:87], v2 offset:54272
 v_add_f32 v28, v21, v28
M v[76:79], a[124:127], a[60:63], v[36:39]
 buffer_load_dwordx4 v4, s[8:11], s26 offen offset:0 sc1 lds
M v[76:79], a[120:123], a[56:59], v[76:79]
 ds_read_b128 a[88:91], v2 offset:55296
M v[76:79], a[116:119], a[52:55], v[76:79]
 ds_read_b128 a[92:95], v2 offset:56320
M v[76:79], a[112:115], a[48:51], v[76:79]
 v_exp_f32 v23, v121
M v[76:79], a[108:111], a[44:47], v[76:79]
 buffer_load_dwordx4 v4, s[8:11], s26 offen offset:1024 sc1 lds
M v[76:79], a[104:107], a[40:43], v[76:79]
 v_exp_f32 v24, v122
M v[76:79], a[100:103], a[36:39], v[76:79]
 v_exp_f32 v25, v123
M v[76:79], a[96:99], a[32:35], v[76:79]
 s_waitcnt lgkmcnt(0)
 v_exp_f32 v18, v116
M v[80:83], a[64:67], a[0:3], v[32:35]
 ds_read_b128 a[96:99], v2 offset:57344
 v_add_f32 v28, v22, v28
M v[80:83], a[68:71], a[4:7], v[80:83]
 ds_read_b128 a[100:103], v2 offset:58368
 v_cvt_pk_bf16_f32 v58, v22, v23
M v[80:83], a[72:75], a[8:11], v[80:83]
 buffer_load_dwordx4 v4, s[8:11], s26 offen offset:2048 sc1 lds
M v[80:83], a[76:79], a[12:15], v[80:83]
 ds_read_b128 a[104:107], v2 offset:59392
 v_add_f32 v28, v23, v28
M v[80:83], a[80:83], a[16:19], v[80:83]
 ds_read_b128 a[108:111], v2 offset:60416
 v_add_f32 v28, v24, v28
M v[80:83], a[84:87], a[20:23], v[80:83]
 v_exp_f32 v19, v117
M v[80:83], a[88:91], a[24:27], v[80:83]
 ds_read_b128 a[112:115], v2 offset:61440
 v_cvt_pk_bf16_f32 v59, v24, v25
M v[80:83], a[92:95], a[28:31], v[80:83]
 ds_read_b128 a[116:119], v2 offset:62464
 v_add_f32 v28, v25, v28
M v[84:87], a[92:95], a[60:63], v[36:39]
 buffer_load_dwordx4 v4, s[8:11], s26 offen offset:3072 sc1 lds
M v[84:87], a[88:91], a[56:59], v[84:87]
 s_add_u32 s26, s26, 32768
 ds_read_b128 a[120:123], v2 offset:63488
 v_add_f32 v29, v18, v29
M v[84:87], a[84:87], a[52:55], v[84:87]
 ds_read_b128 a[124:127], v2 offset:64512
 v_cvt_pk_bf16_f32 v60, v18, v19
M v[84:87], a[80:83], a[48:51], v[84:87]
 v_exp_f32 v20, v118
M v[84:87], a[76:79], a[44:47], v[84:87]
 v_exp_f32 v21, v119
M v[84:87], a[72:75], a[40:43], v[84:87]
 v_exp_f32 v22, v124
M v[84:87], a[68:71], a[36:39], v[84:87]
 s_waitcnt vmcnt(17) lgkmcnt(0)
 v_exp_f32 v23, v125
M v[84:87], a[64:67], a[32:35], v[84:87]
 s_barrier
M v[88:91], a[96:99], a[0:3], v[32:35]
 ds_read_b128 a[64:67], v7 offset:0
 v_add_f32 v29, v19, v29
M v[88:91], a[100:103], a[4:7], v[88:91]
 ds_read_b128 a[68:71], v7 offset:1024
 v_add_f32 v29, v20, v29
M v[88:91], a[104:107], a[8:11], v[88:91]
 v_exp_f32 v24, v126
M v[88:91], a[108:111], a[12:15], v[88:91]
 ds_read_b128 a[72:75], v7 offset:2048
 v_cvt_pk_bf16_f32 v61, v20, v21
M v[88:91], a[112:115], a[16:19], v[88:91]
 ds_read_b128 a[76:79], v7 offset:3072
 v_add_f32 v29, v21, v29
M v[88:91], a[116:119], a[20:23], v[88:91]
 v_exp_f32 v25, v127
M v[88:91], a[120:123], a[24:27], v[88:91]
 ds_read_b128 a[80:83], v7 offset:4096
 v_add_f32 v29, v22, v29
M v[88:91], a[124:127], a[28:31], v[88:91]
 ds_read_b128 a[84:87], v7 offset:5120
 v_cvt_pk_bf16_f32 v62, v22, v23
M v[92:95], a[124:127], a[60:63], v[36:39]
 v_add_f32 v29, v23, v29
 v_add_f32 v29, v24, v29
M v[92:95], a[120:123], a[56:59], v[92:95]
 ds_read_b128 a[88:91], v7 offset:6144
 v_cvt_pk_bf16_f32 v63, v24, v25
M v[92:95], a[116:119], a[52:55], v[92:95]
 ds_read_b128 a[92:95], v7 offset:7168
 v_add_f32 v29, v25, v29
M v[92:95], a[112:115], a[48:51], v[92:95]
 v_max_f32 v10, v28, v29
M v[92:95], a[108:111], a[44:47], v[92:95]
 v_cmp_lt_f32 vcc, s31, v10
M v[92:95], a[104:107], a[40:43], v[92:95]
M v[92:95], a[100:103], a[36:39], v[92:95]
 s_waitcnt lgkmcnt(0)
M v[92:95], a[96:99], a[32:35], v[92:95]
 s_cbranch_vccnz L_st1
L_rt1:
M v[128:131], a[64:67], v[48:51], v[128:131]
 s_add_u32 m0, s28, 98304
 ds_read_b128 a[96:99], v7 offset:8192
 v_add_f32 v30, v28, v30
M v[128:131], a[68:71], v[56:59], v[128:131]
 ds_read_b128 a[100:103], v7 offset:9216
 v_add_f32 v31, v29, v31
M v[132:135], a[68:71], v[60:63], v[132:135]
 buffer_load_dwordx4 v3, s[8:11], s21 offen offset:0 sc1 lds
M v[132:135], a[64:67], v[52:55], v[132:135]
 ds_read_b128 a[104:107], v7 offset:10240
M v[136:139], a[72:75], v[48:51], v[136:139]
 ds_read_b128 a[108:111], v7 offset:11264
M v[136:139], a[76:79], v[56:59], v[136:139]
 buffer_load_dwordx4 v3, s[8:11], s21 offen offset:1024 sc1 lds
M v[140:143], a[76:79], v[60:63], v[140:143]
 ds_read_b128 a[112:115], v7 offset:12288
M v[140:143], a[72:75], v[52:55], v[140:143]
 ds_read_b128 a[116:119], v7 offset:13312
M v[144:147], a[80:83], v[48:51], v[144:147]
 v_exp_f32 v18, v64
M v[144:147], a[84:87], v[56:59], v[144:147]
 ds_read_b128 a[120:123], v7 offset:14336
M v[148:151], a[84:87], v[60:63], v[148:151]
 ds_read_b128 a[124:127], v7 offset:15360
M v[148:151], a[80:83], v[52:55], v[148:151]
 buffer_load_dwordx4 v3, s[8:11], s21 offen offset:2048 sc1 lds
M v[152:155], a[88:91], v[48:51], v[152:155]
 v_exp_f32 v19, v65
M v[152:155], a[92:95], v[56:59], v[152:155]
 v_exp_f32 v20, v66
M v[156:159], a[92:95], v[60:63], v[156:159]
 buffer_load_dwordx4 v3, s[8:11], s21 offen offset:3072 sc1 lds
M v[156:159], a[88:91], v[52:55], v[156:159]
 s_waitcnt lgkmcnt(0)
 v_exp_f32 v21, v67
M v[160:163], a[96:99], v[48:51], v[160:163]
 ds_read_b128 a[64:67], v7 offset:16384
 v_add_f32 v26, v18, v19
M v[160:163], a[100:103], v[56:59], v[160:163]
 ds_read_b128 a[68:71], v7 offset:17408
 v_cvt_pk_bf16_f32 v40, v18, v19
M v[164:167], a[100:103], v[60:63], v[164:167]
 s_add_u32 m0, s28, 102400
 v_exp_f32 v22, v72
M v[164:167], a[96:99], v[52:55], v[164:167]
 ds_read_b128 a[72:75], v7 offset:18432
 v_add_f32 v26, v20, v26
M v[168:171], a[104:107], v[48:51], v[168:171]
 ds_read_b128 a[76:79], v7 offset:19456
 v_cvt_pk_bf16_f32 v41, v20, v21
M v[168:171], a[108:111], v[56:59], v[168:171]
 buffer_load_dwordx4 v4, s[8:11], s21 offen offset:0 sc1 lds
M v[172:175], a[108:111], v[60:63], v[172:175]
 ds_read_b128 a[80:83], v7 offset:20480
 v_add_f32 v26, v21, v26
M v[172:175], a[104:107], v[52:55], v[172:175]
 ds_read_b128 a[84:87], v7 offset:21504
M v[176:179], a[112:115], v[48:51], v[176:179]
 buffer_load_dwordx4 v4, s[8:11], s21 offen offset:1024 sc1 lds
M v[176:179], a[116:119], v[56:59], v[176:179]
 ds_read_b128 a[88:91], v7 offset:22528
M v[180:183], a[116:119], v[60:63], v[180:183]
 ds_read_b128 a[92:95], v7 offset:23552
M v[180:183], a[112:115], v[52:55], v[180:183]
 v_exp_f32 v23, v73
M v[184:187], a[120:123], v[48:51], v[184:187]
 buffer_load_dwordx4 v4, s[8:11], s21 offen offset:2048 sc1 lds
M v[184:187], a[124:127], v[56:59], v[184:187]
 v_exp_f32 v24, v74
M v[188:191], a[124:127], v[60:63], v[188:191]
 v_exp_f32 v25, v75
M v[188:191], a[120:123], v[52:55], v[188:191]
 s_waitcnt lgkmcnt(0)
 v_exp_f32 v18, v68
M v[192:195], a[64:67], v[48:51], v[192:195]
 ds_read_b128 a[96:99], v7 offset:24576
 v_add_f32 v26, v22, v26
M v[192:195], a[68:71], v[56:59], v[192:195]
 ds_read_b128 a[100:103], v7 offset:25600
 v_cvt_pk_bf16_f32 v42, v22, v23
M v[196:199], a[68:71], v[60:63], v[196:199]
 buffer_load_dwordx4 v4, s[8:11], s21 offen offset:3072 sc1 lds
M v[196:199], a[64:67], v[52:55], v[196:199]
 s_add_u32 s21, s21, 32768
 ds_read_b128 a[104:107], v7 offset:26624
 v_add_f32 v26, v23, v26
M v[200:203], a[72:75], v[48:51], v[200:203]
 s_sub_u32 s22, s22, 1
 ds_read_b128 a[108:111], v7 offset:27648
 v_add_f32 v26, v24, v26
M v[200:203], a[76:79], v[56:59], v[200:203]
 s_cmp_eq_u32 s22, 0
 v_exp_f32 v19, v69
M v[204:207], a[76:79], v[60:63], v[204:207]
 s_cselect_b32 s21, s23, s21
 ds_read_b128 a[112:115], v7 offset:28672
 v_cvt_pk_bf16_f32 v43, v24, v25
M v[204:207], a[72:75], v[52:55], v[204:207]
 s_cselect_b32 s22, s24, s22
 ds_read_b128 a[116:119], v7 offset:29696
 v_add_f32 v26, v25, v26
M v[208:211], a[80:83], v[48:51], v[208:211]
 s_cselect_b32 s23, s25, s23
 v_exp_f32 v20, v70
M v[208:211], a[84:87], v[56:59], v[208:211]
 s_cselect_b32 s24, 0x7fff, s24
 ds_read_b128 a[120:123], v7 offset:30720
 v_add_f32 v27, v18, v19
M v[212:215], a[84:87], v[60:63], v[212:215]
 ds_read_b128 a[124:127], v7 offset:31744
 v_cvt_pk_bf16_f32 v44, v18, v19
M v[212:215], a[80:83], v[52:55], v[212:215]
 v_exp_f32 v21, v71
M v[216:219], a[88:91], v[48:51], v[216:219]
 v_exp_f32 v22, v76
M v[216:219], a[92:95], v[56:59], v[216:219]
 v_add_f32 v27, v20, v27
 v_cvt_pk_bf16_f32 v45, v20, v21
M v[220:223], a[92:95], v[60:63], v[220:223]
 s_waitcnt vmcnt(17) lgkmcnt(0)
 v_add_f32 v27, v21, v27
M v[220:223], a[88:91], v[52:55], v[220:223]
 s_barrier
M v[224:227], a[96:99], v[48:51], v[224:227]
 ds_read_b128 a[64:67], v7 offset:32768
M v[224:227], a[100:103], v[56:59], v[224:227]
 ds_read_b128 a[68:71], v7 offset:33792
M v[228:231], a[100:103], v[60:63], v[228:231]
 v_exp_f32 v23, v77
M v[228:231], a[96:99], v[52:55], v[228:231]
 ds_read_b128 a[72:75], v7 offset:34816
 v_add_f32 v27, v22, v27
M v[232:235], a[104:107], v[48:51], v[232:235]
 ds_read_b128 a[76:79], v7 offset:35840
 v_cvt_pk_bf16_f32 v46, v22, v23
M v[232:235], a[108:111], v[56:59], v[232:235]
 v_exp_f32 v24, v78
M v[236:239], a[108:111], v[60:63], v[236:239]
 ds_read_b128 a[80:83], v7 offset:36864
 v_add_f32 v27, v23, v27
M v[236:239], a[104:107], v[52:55], v[236:239]
 ds_read_b128 a[84:87], v7 offset:37888
M v[240:243], a[112:115], v[48:51], v[240:243]
 v_exp_f32 v25, v79
M v[240:243], a[116:119], v[56:59], v[240:243]
 ds_read_b128 a[88:91], v7 offset:38912
 v_add_f32 v27, v24, v27
M v[244:247], a[116:119], v[60:63], v[244:247]
 ds_read_b128 a[92:95], v7 offset:39936
 v_cvt_pk_bf16_f32 v47, v24, v25
M v[244:247], a[112:115], v[52:55], v[244:247]
 v_add_f32 v27, v25, v27
M v[248:251], a[120:123], v[48:51], v[248:251]
M v[248:251], a[124:127], v[56:59], v[248:251]
M v[252:255], a[124:127], v[60:63], v[252:255]
 s_waitcnt lgkmcnt(0)
M v[252:255], a[120:123], v[52:55], v[252:255]
L_loop_mid:
M v[96:99], a[64:67], a[0:3], v[32:35]
 s_bitcmp1_b32 s39, s7
 ds_read_b128 a[96:99], v7 offset:40960
M v[96:99], a[68:71], a[4:7], v[96:99]
 s_cbranch_scc1 L_fll
L_fllr:
 ds_read_b128 a[100:103], v7 offset:41984
M v[96:99], a[72:75], a[8:11], v[96:99]
 s_add_u32 m0, s28, 0
 v_exp_f32 v18, v80
M v[96:99], a[76:79], a[12:15], v[96:99]
 ds_read_b128 a[104:107], v7 offset:43008
M v[96:99], a[80:83], a[16:19], v[96:99]
 ds_read_b128 a[108:111], v7 offset:44032
M v[96:99], a[84:87], a[20:23], v[96:99]
 buffer_load_dwordx4 v3, s[8:11], s26 offen offset:0 sc1 lds
M v[96:99], a[88:91], a[24:27], v[96:99]
 ds_read_b128 a[112:115], v7 offset:45056
M v[96:99], a[92:95], a[28:31], v[96:99]
 ds_read_b128 a[116:119], v7 offset:46080
M v[100:103], a[92:95], a[60:63], v[36:39]
 buffer_load_dwordx4 v3, s[8:11], s26 offen offset:1024 sc1 lds
M v[100:103], a[88:91], a[56:59], v[100:103]
 ds_read_b128 a[120:123], v7 offset:47104
M v[100:103], a[84:87], a[52:55], v[100:103]
 ds_read_b128 a[124:127], v7 offset:48128
M v[100:103], a[80:83], a[48:51], v[100:103]
 v_exp_f32 v19, v81
M v[100:103], a[76:79], a[44:47], v[100:103]
 v_exp_f32 v20, v82
M v[100:103], a[72:75], a[40:43], v[100:103]
 buffer_load_dwordx4 v3, s[8:11], s26 offen offset:2048 sc1 lds
M v[100:103], a[68:71], a[36:39], v[100:103]
 v_exp_f32 v21, v83
M v[100:103], a[64:67], a[32:35], v[100:103]
 s_waitcnt lgkmcnt(0)
 v_exp_f32 v22, v88
M v[104:107], a[96:99], a[0:3], v[32:35]
 ds_read_b128 a[64:67], v7 offset:49152
 v_add_f32 v26, v18, v26
M v[104:107], a[100:103], a[4:7], v[104:107]
 ds_read_b128 a[68:71], v7 offset:50176
 v_cvt_pk_bf16_f32 v56, v18, v19
M v[104:107], a[104:107], a[8:11], v[104:107]
 buffer_load_dwordx4 v3, s[8:11], s26 offen offset:3072 sc1 lds
M v[104:107], a[108:111], a[12:15], v[104:107]
 ds_read_b128 a[72:75], v7 offset:51200
 v_add_f32 v26, v19, v26
M v[104:107], a[112:115], a[16:19], v[104:107]
 ds_read_b128 a[76:79], v7 offset:52224
 v_add_f32 v26, v20, v26
M v[104:107], a[116:119], a[20:23], v[104:107]
 v_exp_f32 v23, v89
M v[104:107], a[120:123], a[24:27], v[104:107]
 ds_read_b128 a[80:83], v7 offset:53248
 v_cvt_pk_bf16_f32 v57, v20, v21
M v[104:107], a[124:127], a[28:31], v[104:107]
 s_add_u32 m0, s28, 4096
 ds_read_b128 a[84:87], v7 offset:54272
 v_add_f32 v26, v21, v26
M v[108:111], a[124:127], a[60:63], v[36:39]
 buffer_load_dwordx4 v4, s[8:11], s26 offen offset:0 sc1 lds
M v[108:111], a[120:123], a[56:59], v[108:111]
 ds_read_b128 a[88:91], v7 offset:55296
 v_add_f32 v26, v22, v26
M v[108:111], a[116:119], a[52:55], v[108:111]
 ds_read_b128 a[92:95], v7 offset:56320
 v_cvt_pk_bf16_f32 v58, v22, v23
M v[108:111], a[112:115], a[48:51], v[108:111]
 v_exp_f32 v24, v90
M v[108:111], a[108:111], a[44:47], v[108:111]
 v_exp_f32 v25, v91
M v[108:111], a[104:107], a[40:43], v[108:111]
 buffer_load_dwordx4 v4, s[8:11], s26 offen offset:1024 sc1 lds
M v[108:111], a[100:103], a[36:39], v[108:111]
 v_exp_f32 v18, v84
M v[108:111], a[96:99], a[32:35], v[108:111]
 s_waitcnt lgkmcnt(0)
 v_exp_f32 v19, v85
M v[112:115], a[64:67], a[0:3], v[32:35]
 ds_read_b128 a[96:99], v7 offset:57344
 v_add_f32 v26, v23, v26
M v[112:115], a[68:71], a[4:7], v[112:115]
 ds_read_b128 a[100:103], v7 offset:58368
 v_add_f32 v26, v24, v26
M v[112:115], a[72:75], a[8:11], v[112:115]
 buffer_load_dwordx4 v4, s[8:11], s26 offen offset:2048 sc1 lds
M v[112:115], a[76:79], a[12:15], v[112:115]
 ds_read_b128 a[104:107], v7 offset:59392
 v_cvt_pk_bf16_f32 v59, v24, v25
M v[112:115], a[80:83], a[16:19], v[112:115]
 ds_read_b128 a[108:111], v7 offset:60416
 v_add_f32 v26, v25, v26
M v[112:115], a[84:87], a[20:23], v[112:115]
 v_exp_f32 v20, v86
M v[112:115], a[88:91], a[24:27], v[112:115]
 ds_read_b128 a[112:115], v7 offset:61440
 v_add_f32 v27, v18, v27
M v[112:115], a[92:95], a[28:31], v[112:115]
 ds_read_b128 a[116:119], v7 offset:62464
 v_cvt_pk_bf16_f32 v60, v18, v19
M v[116:119], a[92:95], a[60:63], v[36:39]
 buffer_load_dwordx4 v4, s[8:11], s26 offen offset:3072 sc1 lds
M v[116:119], a[88:91], a[56:59], v[116:119]
 s_add_u32 s26, s26, 32768
 ds_read_b128 a[120:123], v7 offset:63488
 v_add_f32 v27, v19, v27
M v[116:119], a[84:87], a[52:55], v[116:119]
 ds_read_b128 a[124:127], v7 offset:64512
M v[116:119], a[80:83], a[48:51], v[116:119]
 v_exp_f32 v21, v87
M v[116:119], a[76:79], a[44:47], v[116:119]
 v_exp_f32 v22, v92
M v[116:119], a[72:75], a[40:43], v[116:119]
 v_exp_f32 v23, v93
M v[116:119], a[68:71], a[36:39], v[116:119]
 s_waitcnt vmcnt(16) lgkmcnt(0)
 v_add_f32 v27, v20, v27
 v_cvt_pk_bf16_f32 v61, v20, v21
M v[116:119], a[64:67], a[32:35], v[116:119]
 s_barrier
M v[120:123], a[96:99], a[0:3], v[32:35]
 ds_read_b128 a[64:67], v2 offset:0
 v_add_f32 v27, v21, v27
M v[120:123], a[100:103], a[4:7], v[120:123]
 ds_read_b128 a[68:71], v2 offset:1024
 v_add_f32 v27, v22, v27
M v[120:123], a[104:107], a[8:11], v[120:123]
 v_exp_f32 v24, v94
M v[120:123], a[108:111], a[12:15], v[120:123]
 ds_read_b128 a[72:75], v2 offset:2048
 v_cvt_pk_bf16_f32 v62, v22, v23
M v[120:123], a[112:115], a[16:19], v[120:123]
 ds_read_b128 a[76:79], v2 offset:3072
 v_add_f32 v27, v23, v27
M v[120:123], a[116:119], a[20:23], v[120:123]
 v_exp_f32 v25, v95
M v[120:123], a[120:123], a[24:27], v[120:123]
 ds_read_b128 a[80:83], v2 offset:4096
 v_add_f32 v27, v24, v27
M v[120:123], a[124:127], a[28:31], v[120:123]
 ds_read_b128 a[84:87], v2 offset:5120
 v_cvt_pk_bf16_f32 v63, v24, v25
M v[124:127], a[124:127], a[60:63], v[36:39]
 v_add_f32 v27, v25, v27
M v[124:127], a[120:123], a[56:59], v[124:127]
 ds_read_b128 a[88:91], v2 offset:6144
M v[124:127], a[116:119], a[52:55], v[124:127]
 ds_read_b128 a[92:95], v2 offset:7168
 v_max_f32 v10, v26, v27
M v[124:127], a[112:115], a[48:51], v[124:127]
 v_cmp_lt_f32 vcc, s31, v10
M v[124:127], a[108:111], a[44:47], v[124:127]
M v[124:127], a[104:107], a[40:43], v[124:127]
M v[124:127], a[100:103], a[36:39], v[124:127]
 s_waitcnt lgkmcnt(0)
M v[124:127], a[96:99], a[32:35], v[124:127]
 s_cbranch_vccnz L_st0
L_rt0:
M v[128:131], a[64:67], v[40:43], v[128:131]
 s_add_u32 m0, s28, 32768
 ds_read_b128 a[96:99], v2 offset:8192
 v_add_f32 v30, v26, v30
M v[128:131], a[68:71], v[56:59], v[128:131]
 ds_read_b128 a[100:103], v2 offset:9216
 v_add_f32 v31, v27, v31
M v[132:135], a[68:71], v[60:63], v[132:135]
 buffer_load_dwordx4 v3, s[8:11], s21 offen offset:0 sc1 lds
M v[132:135], a[64:67], v[44:47], v[132:135]
 ds_read_b128 a[104:107], v2 offset:10240
M v[136:139], a[72:75], v[40:43], v[136:139]
 ds_read_b128 a[108:111], v2 offset:11264
M v[136:139], a[76:79], v[56:59], v[136:139]
 buffer_load_dwordx4 v3, s[8:11], s21 offen offset:1024 sc1 lds
M v[140:143], a[76:79], v[60:63], v[140:143]
 ds_read_b128 a[112:115], v2 offset:12288
M v[140:143], a[72:75], v[44:47], v[140:143]
 ds_read_b128 a[116:119], v2 offset:13312
M v[144:147], a[80:83], v[40:43], v[144:147]
 v_exp_f32 v18, v96
M v[144:147], a[84:87], v[56:59], v[144:147]
 ds_read_b128 a[120:123], v2 offset:14336
M v[148:151], a[84:87], v[60:63], v[148:151]
 ds_read_b128 a[124:127], v2 offset:15360
M v[148:151], a[80:83], v[44:47], v[148:151]
 buffer_load_dwordx4 v3, s[8:11], s21 offen offset:2048 sc1 lds
M v[152:155], a[88:91], v[40:43], v[152:155]
 v_exp_f32 v19, v97
M v[152:155], a[92:95], v[56:59], v[152:155]
 v_exp_f32 v20, v98
M v[156:159], a[92:95], v[60:63], v[156:159]
 buffer_load_dwordx4 v3, s[8:11], s21 offen offset:3072 sc1 lds
M v[156:159], a[88:91], v[44:47], v[156:159]
 s_waitcnt lgkmcnt(0)
 v_exp_f32 v21, v99
M v[160:163], a[96:99], v[40:43], v[160:163]
 ds_read_b128 a[64:67], v2 offset:16384
 v_add_f32 v28, v18, v19
M v[160:163], a[100:103], v[56:59], v[160:163]
 ds_read_b128 a[68:71], v2 offset:17408
 v_cvt_pk_bf16_f32 v48, v18, v19
M v[164:167], a[100:103], v[60:63], v[164:167]
 s_add_u32 m0, s28, 36864
 v_exp_f32 v22, v104
M v[164:167], a[96:99], v[44:47], v[164:167]
 ds_read_b128 a[72:75], v2 offset:18432
 v_add_f32 v28, v20, v28
M v[168:171], a[104:107], v[40:43], v[168:171]
 ds_read_b128 a[76:79], v2 offset:19456
 v_cvt_pk_bf16_f32 v49, v20, v21
M v[168:171], a[108:111], v[56:59], v[168:171]
 buffer_load_dwordx4 v4, s[8:11], s21 offen offset:0 sc1 lds
M v[172:175], a[108:111], v[60:63], v[172:175]
 ds_read_b128 a[80:83], v2 offset:20480
 v_add_f32 v28, v21, v28
M v[172:175], a[104:107], v[44:47], v[172:175]
 ds_read_b128 a[84:87], v2 offset:21504
M v[176:179], a[112:115], v[40:43], v[176:179]
 buffer_load_dwordx4 v4, s[8:11], s21 offen offset:1024 sc1 lds
M v[176:179], a[116:119], v[56:59], v[176:179]
 ds_read_b128 a[88:91], v2 offset:22528
M v[180:183], a[116:119], v[60:63], v[180:183]
 ds_read_b128 a[92:95], v2 offset:23552
M v[180:183], a[112:115], v[44:47], v[180:183]
 v_exp_f32 v23, v105
M v[184:187], a[120:123], v[40:43], v[184:187]
 buffer_load_dwordx4 v4, s[8:11], s21 offen offset:2048 sc1 lds
M v[184:187], a[124:127], v[56:59], v[184:187]
 v_exp_f32 v24, v106
M v[188:191], a[124:127], v[60:63], v[188:191]
 v_exp_f32 v25, v107
M v[188:191], a[120:123], v[44:47], v[188:191]
 s_waitcnt lgkmcnt(0)
 v_exp_f32 v18, v100
M v[192:195], a[64:67], v[40:43], v[192:195]
 ds_read_b128 a[96:99], v2 offset:24576
 v_add_f32 v28, v22, v28
M v[192:195], a[68:71], v[56:59], v[192:195]
 ds_read_b128 a[100:103], v2 offset:25600
 v_cvt_pk_bf16_f32 v50, v22, v23
M v[196:199], a[68:71], v[60:63], v[196:199]
 buffer_load_dwordx4 v4, s[8:11], s21 offen offset:3072 sc1 lds
M v[196:199], a[64:67], v[44:47], v[196:199]
 s_add_u32 s21, s21, 32768
 ds_read_b128 a[104:107], v2 offset:26624
 v_add_f32 v28, v23, v28
M v[200:203], a[72:75], v[40:43], v[200:203]
 s_sub_u32 s22, s22, 1
 ds_read_b128 a[108:111], v2 offset:27648
 v_add_f32 v28, v24, v28
M v[200:203], a[76:79], v[56:59], v[200:203]
 s_cmp_eq_u32 s22, 0
 v_exp_f32 v19, v101
M v[204:207], a[76:79], v[60:63], v[204:207]
 s_cselect_b32 s21, s23, s21
 ds_read_b128 a[112:115], v2 offset:28672
 v_cvt_pk_bf16_f32 v51, v24, v25
M v[204:207], a[72:75], v[44:47], v[204:207]
 s_cselect_b32 s22, s24, s22
 ds_read_b128 a[116:119], v2 offset:29696
 v_add_f32 v28, v25, v28
M v[208:211], a[80:83], v[40:43], v[208:211]
 s_cselect_b32 s23, s25, s23
 v_exp_f32 v20, v102
M v[208:211], a[84:87], v[56:59], v[208:211]
 s_cselect_b32 s24, 0x7fff, s24
 ds_read_b128 a[120:123], v2 offset:30720
 v_add_f32 v29, v18, v19
M v[212:215], a[84:87], v[60:63], v[212:215]
 ds_read_b128 a[124:127], v2 offset:31744
 v_cvt_pk_bf16_f32 v52, v18, v19
M v[212:215], a[80:83], v[44:47], v[212:215]
 v_exp_f32 v21, v103
M v[216:219], a[88:91], v[40:43], v[216:219]
 v_exp_f32 v22, v108
M v[216:219], a[92:95], v[56:59], v[216:219]
 v_add_f32 v29, v20, v29
 v_cvt_pk_bf16_f32 v53, v20, v21
M v[220:223], a[92:95], v[60:63], v[220:223]
 s_waitcnt vmcnt(16) lgkmcnt(0)
 v_exp_f32 v23, v109
M v[220:223], a[88:91], v[44:47], v[220:223]
 s_barrier
M v[224:227], a[96:99], v[40:43], v[224:227]
 ds_read_b128 a[64:67], v2 offset:32768
 v_add_f32 v29, v21, v29
M v[224:227], a[100:103], v[56:59], v[224:227]
 ds_read_b128 a[68:71], v2 offset:33792
 v_add_f32 v29, v22, v29
M v[228:231], a[100:103], v[60:63], v[228:231]
 v_cmp_gt_u32 vcc, s6, v5
 v_cvt_pk_bf16_f32 v54, v22, v23
M v[228:231], a[96:99], v[44:47], v[228:231]
 ds_read_b128 a[72:75], v2 offset:34816
 v_add_f32 v29, v23, v29
M v[232:235], a[104:107], v[40:43], v[232:235]
 ds_read_b128 a[76:79], v2 offset:35840
M v[232:235], a[108:111], v[56:59], v[232:235]
 s_cbranch_vccnz L_fls0
L_flr0:
 v_exp_f32 v24, v110
M v[236:239], a[108:111], v[60:63], v[236:239]
 s_mov_b32 s6, 0
 ds_read_b128 a[80:83], v2 offset:36864
M v[236:239], a[104:107], v[44:47], v[236:239]
 s_bitcmp1_b32 s92, s7
 ds_read_b128 a[84:87], v2 offset:37888
M v[240:243], a[112:115], v[40:43], v[240:243]
 s_cbranch_scc1 L_fl4
L_fl4r:
 v_exp_f32 v25, v111
M v[240:243], a[116:119], v[56:59], v[240:243]
 s_add_u32 s7, s7, 1
 ds_read_b128 a[88:91], v2 offset:38912
 v_add_f32 v29, v24, v29
M v[244:247], a[116:119], v[60:63], v[244:247]
 ds_read_b128 a[92:95], v2 offset:39936
 v_cvt_pk_bf16_f32 v55, v24, v25
M v[244:247], a[112:115], v[44:47], v[244:247]
 v_add_f32 v29, v25, v29
M v[248:251], a[120:123], v[40:43], v[248:251]
 s_sub_u32 s27, s27, 1
M v[248:251], a[124:127], v[56:59], v[248:251]
 s_cmp_lg_u32 s27, 0
M v[252:255], a[124:127], v[60:63], v[252:255]
 s_waitcnt lgkmcnt(0)
M v[252:255], a[120:123], v[44:47], v[252:255]
 s_cbranch_scc1 L_loop_top
L_p1:
 s_cmp_eq_u32 s40, 0
 s_cbranch_scc1 L_final_h
 s_mov_b32 s26, s43
 buffer_load_dword v5, off, s[8:11], s47 sc1
 v_cndmask_b32 v64, v32, v8, s[68:69]
 v_cndmask_b32 v65, v32, v8, s[70:71]
 v_cndmask_b32 v66, v32, v8, s[72:73]
 v_cndmask_b32 v67, v32, v8, s[74:75]
 s_nop 1
M v[64:67], a[64:67], a[0:3], v[64:67]
 s_add_u32 m0, s28, 65536
 ds_read_b128 a[96:99], v2 offset:40960
 ds_read_b128 a[100:103], v2 offset:41984
M v[64:67], a[68:71], a[4:7], v[64:67]
 buffer_load_dwordx4 v3, s[8:11], s26 offen offset:0 sc1 lds
M v[64:67], a[72:75], a[8:11], v[64:67]
 s_lshl_b32 s86, s20, 14
 v_exp_f32 v18, v112
M v[64:67], a[76:79], a[12:15], v[64:67]
 s_add_u32 s86, s86, s34
 ds_read_b128 a[104:107], v2 offset:43008
 ds_read_b128 a[108:111], v2 offset:44032
M v[64:67], a[80:83], a[16:19], v[64:67]
 s_add_u32 s87, s86, 4096
 v_exp_f32 v19, v113
M v[64:67], a[84:87], a[20:23], v[64:67]
 s_add_u32 s88, s86, 8192
 v_add_f32 v28, v18, v28
 v_cvt_pk_bf16_f32 v56, v18, v19
M v[64:67], a[88:91], a[24:27], v[64:67]
 s_add_u32 s89, s86, 12288
 ds_read_b128 a[112:115], v2 offset:45056
 ds_read_b128 a[116:119], v2 offset:46080
M v[64:67], a[92:95], a[28:31], v[64:67]
 s_lshl_b32 s90, s20, 10
 buffer_load_dwordx4 v3, s[8:11], s26 offen offset:1024 sc1 lds
M v[68:71], a[92:95], a[60:63], v[36:39]
 s_add_u32 s90, s90, s34
 v_exp_f32 v20, v114
M v[68:71], a[88:91], a[56:59], v[68:71]
 s_add_u32 s90, s90, 65536
 ds_read_b128 a[120:123], v2 offset:47104
 ds_read_b128 a[124:127], v2 offset:48128
M v[68:71], a[84:87], a[52:55], v[68:71]
 v_exp_f32 v21, v115
M v[68:71], a[80:83], a[48:51], v[68:71]
 v_cndmask_b32 v72, v32, v8, s[64:65]
 v_cndmask_b32 v73, v32, v8, s[64:65]
M v[68:71], a[76:79], a[44:47], v[68:71]
 v_cndmask_b32 v74, v32, v8, s[64:65]
 v_cndmask_b32 v75, v32, v8, s[64:65]
M v[68:71], a[72:75], a[40:43], v[68:71]
 buffer_load_dwordx4 v3, s[8:11], s26 offen offset:2048 sc1 lds
M v[68:71], a[68:71], a[36:39], v[68:71]
 v_exp_f32 v22, v120
M v[68:71], a[64:67], a[32:35], v[68:71]
 s_waitcnt lgkmcnt(0)
 v_add_f32 v28, v19, v28
 v_add_f32 v28, v20, v28
M v[72:75], a[96:99], a[0:3], v[72:75]
 ds_read_b128 a[64:67], v2 offset:49152
 ds_read_b128 a[68:71], v2 offset:50176
M v[72:75], a[100:103], a[4:7], v[72:75]
 buffer_load_dwordx4 v3, s[8:11], s26 offen offset:3072 sc1 lds
M v[72:75], a[104:107], a[8:11], v[72:75]
 v_exp_f32 v23, v121
M v[72:75], a[108:111], a[12:15], v[72:75]
 ds_read_b128 a[72:75], v2 offset:51200
 ds_read_b128 a[76:79], v2 offset:52224
M v[72:75], a[112:115], a[16:19], v[72:75]
 v_cndmask_b32 v76, v36, v8, s[68:69]
 v_cndmask_b32 v77, v36, v8, s[70:71]
M v[72:75], a[116:119], a[20:23], v[72:75]
 v_cndmask_b32 v78, v36, v8, s[72:73]
 v_cndmask_b32 v79, v36, v8, s[74:75]
M v[72:75], a[120:123], a[24:27], v[72:75]
 s_add_u32 m0, s28, 69632
 ds_read_b128 a[80:83], v2 offset:53248
 ds_read_b128 a[84:87], v2 offset:54272
M v[72:75], a[124:127], a[28:31], v[72:75]
 buffer_load_dwordx4 v4, s[8:11], s26 offen offset:0 sc1 lds
M v[76:79], a[124:127], a[60:63], v[76:79]
 v_exp_f32 v24, v122
M v[76:79], a[120:123], a[56:59], v[76:79]
 ds_read_b128 a[88:91], v2 offset:55296
 ds_read_b128 a[92:95], v2 offset:56320
M v[76:79], a[116:119], a[52:55], v[76:79]
 v_exp_f32 v25, v123
M v[76:79], a[112:115], a[48:51], v[76:79]
 v_cndmask_b32 v80, v32, v8, s[76:77]
 v_cndmask_b32 v81, v32, v8, s[78:79]
M v[76:79], a[108:111], a[44:47], v[76:79]
 v_cndmask_b32 v82, v32, v8, s[80:81]
 v_cndmask_b32 v83, v32, v8, s[82:83]
M v[76:79], a[104:107], a[40:43], v[76:79]
 buffer_load_dwordx4 v4, s[8:11], s26 offen offset:1024 sc1 lds
M v[76:79], a[100:103], a[36:39], v[76:79]
 v_exp_f32 v18, v116
M v[76:79], a[96:99], a[32:35], v[76:79]
 s_waitcnt lgkmcnt(0)
 v_exp_f32 v19, v117
M v[80:83], a[64:67], a[0:3], v[80:83]
 ds_read_b128 a[96:99], v2 offset:57344
 ds_read_b128 a[100:103], v2 offset:58368
M v[80:83], a[68:71], a[4:7], v[80:83]
 v_cvt_pk_bf16_f32 v57, v20, v21
 v_add_f32 v28, v21, v28
M v[80:83], a[72:75], a[8:11], v[80:83]
 buffer_load_dwordx4 v4, s[8:11], s26 offen offset:2048 sc1 lds
M v[80:83], a[76:79], a[12:15], v[80:83]
 ds_read_b128 a[104:107], v2 offset:59392
 ds_read_b128 a[108:111], v2 offset:60416
M v[80:83], a[80:83], a[16:19], v[80:83]
 v_cndmask_b32 v84, v36, v8, s[64:65]
 v_cndmask_b32 v85, v36, v8, s[64:65]
M v[80:83], a[84:87], a[20:23], v[80:83]
 v_cndmask_b32 v86, v36, v8, s[64:65]
 v_cndmask_b32 v87, v36, v8, s[64:65]
M v[80:83], a[88:91], a[24:27], v[80:83]
 ds_read_b128 a[112:115], v2 offset:61440
 ds_read_b128 a[116:119], v2 offset:62464
M v[80:83], a[92:95], a[28:31], v[80:83]
 buffer_load_dwordx4 v4, s[8:11], s26 offen offset:3072 sc1 lds
M v[84:87], a[92:95], a[60:63], v[84:87]
 s_add_u32 s26, s26, 32768
 v_exp_f32 v20, v118
M v[84:87], a[88:91], a[56:59], v[84:87]
 ds_read_b128 a[120:123], v2 offset:63488
 ds_read_b128 a[124:127], v2 offset:64512
M v[84:87], a[84:87], a[52:55], v[84:87]
 v_exp_f32 v21, v119
M v[84:87], a[80:83], a[48:51], v[84:87]
 v_cndmask_b32 v88, v32, v8, s[66:67]
 v_cndmask_b32 v89, v32, v8, s[66:67]
M v[84:87], a[76:79], a[44:47], v[84:87]
 v_cndmask_b32 v90, v32, v8, s[66:67]
 v_cndmask_b32 v91, v32, v8, s[66:67]
M v[84:87], a[72:75], a[40:43], v[84:87]
 v_add_f32 v28, v22, v28
 v_cvt_pk_bf16_f32 v58, v22, v23
M v[84:87], a[68:71], a[36:39], v[84:87]
 s_waitcnt vmcnt(17) lgkmcnt(0)
 v_add_f32 v28, v23, v28
 v_add_f32 v28, v24, v28
M v[84:87], a[64:67], a[32:35], v[84:87]
 s_barrier
M v[88:91], a[96:99], a[0:3], v[88:91]
 ds_read_b128 a[64:67], v7 offset:0
 ds_read_b128 a[68:71], v7 offset:1024
M v[88:91], a[100:103], a[4:7], v[88:91]
 v_exp_f32 v22, v124
M v[88:91], a[104:107], a[8:11], v[88:91]
 v_exp_f32 v23, v125
M v[88:91], a[108:111], a[12:15], v[88:91]
 ds_read_b128 a[72:75], v7 offset:2048
 ds_read_b128 a[76:79], v7 offset:3072
M v[88:91], a[112:115], a[16:19], v[88:91]
 v_cndmask_b32 v92, v36, v8, s[76:77]
 v_cndmask_b32 v93, v36, v8, s[78:79]
M v[88:91], a[116:119], a[20:23], v[88:91]
 v_cndmask_b32 v94, v36, v8, s[80:81]
 v_cndmask_b32 v95, v36, v8, s[82:83]
M v[88:91], a[120:123], a[24:27], v[88:91]
 ds_read_b128 a[80:83], v7 offset:4096
 ds_read_b128 a[84:87], v7 offset:5120
M v[88:91], a[124:127], a[28:31], v[88:91]
 v_cvt_pk_bf16_f32 v59, v24, v25
 v_add_f32 v28, v25, v28
M v[92:95], a[124:127], a[60:63], v[92:95]
 v_exp_f32 v24, v126
M v[92:95], a[120:123], a[56:59], v[92:95]
 ds_read_b128 a[88:91], v7 offset:6144
 ds_read_b128 a[92:95], v7 offset:7168
M v[92:95], a[116:119], a[52:55], v[92:95]
 v_exp_f32 v25, v127
M v[92:95], a[112:115], a[48:51], v[92:95]
 v_add_f32 v29, v18, v29
 v_cvt_pk_bf16_f32 v60, v18, v19
M v[92:95], a[108:111], a[44:47], v[92:95]
 v_add_f32 v29, v19, v29
 v_add_f32 v29, v20, v29
M v[92:95], a[104:107], a[40:43], v[92:95]
 v_cvt_pk_bf16_f32 v61, v20, v21
 v_add_f32 v29, v21, v29
M v[92:95], a[100:103], a[36:39], v[92:95]
 s_waitcnt lgkmcnt(0)
 v_add_f32 v29, v22, v29
 v_cvt_pk_bf16_f32 v62, v22, v23
M v[92:95], a[96:99], a[32:35], v[92:95]
 v_add_f32 v29, v23, v29
 v_add_f32 v29, v24, v29
 v_cvt_pk_bf16_f32 v63, v24, v25
 v_add_f32 v29, v25, v29
 v_max_f32 v10, v28, v29
 v_cmp_lt_f32 vcc, s31, v10
 s_nop 0
 s_cbranch_vccnz L_st5
L_rt5:
 s_cmp_ge_u32 s42, 10
 s_cbranch_scc1 L_p1c
M v[128:131], a[64:67], v[48:51], v[128:131]
 s_add_u32 m0, s28, 98304
 ds_read_b128 a[96:99], v7 offset:8192
 ds_read_b128 a[100:103], v7 offset:9216
M v[128:131], a[68:71], v[56:59], v[128:131]
 buffer_load_dwordx4 v3, s[8:11], s21 offen offset:0 sc1 lds
M v[132:135], a[68:71], v[60:63], v[132:135]
 s_cmp_eq_u32 s20, 2
 v_exp_f32 v18, v64
M v[132:135], a[64:67], v[52:55], v[132:135]
 s_cselect_b64 s[64:65], -1, 0
 ds_read_b128 a[104:107], v7 offset:10240
 ds_read_b128 a[108:111], v7 offset:11264
M v[136:139], a[72:75], v[48:51], v[136:139]
 s_cmp_eq_u32 s20, 3
 v_exp_f32 v19, v65
M v[136:139], a[76:79], v[56:59], v[136:139]
 s_cselect_b64 s[84:85], -1, 0
 buffer_load_dwordx4 v3, s[8:11], s21 offen offset:1024 sc1 lds
M v[140:143], a[76:79], v[60:63], v[140:143]
 s_or_b64 s[66:67], s[64:65], s[84:85]
 ds_read_b128 a[112:115], v7 offset:12288
 ds_read_b128 a[116:119], v7 offset:13312
M v[140:143], a[72:75], v[52:55], v[140:143]
 s_and_b64 s[68:69], s[16:17], s[64:65]
 v_exp_f32 v20, v66
M v[144:147], a[80:83], v[48:51], v[144:147]
 s_and_b64 s[76:77], s[16:17], s[84:85]
 v_add_f32 v30, v28, v30
 v_add_f32 v31, v29, v31
M v[144:147], a[84:87], v[56:59], v[144:147]
 s_or_b64 s[76:77], s[76:77], s[64:65]
 ds_read_b128 a[120:123], v7 offset:14336
 ds_read_b128 a[124:127], v7 offset:15360
M v[148:151], a[84:87], v[60:63], v[148:151]
 s_and_b64 s[70:71], s[18:19], s[64:65]
 buffer_load_dwordx4 v3, s[8:11], s21 offen offset:2048 sc1 lds
M v[148:151], a[80:83], v[52:55], v[148:151]
 s_and_b64 s[78:79], s[18:19], s[84:85]
 v_exp_f32 v21, v67
M v[152:155], a[88:91], v[48:51], v[152:155]
 s_or_b64 s[78:79], s[78:79], s[64:65]
 v_add_f32 v26, v18, v19
 v_cvt_pk_bf16_f32 v40, v18, v19
M v[152:155], a[92:95], v[56:59], v[152:155]
 s_and_b64 s[72:73], s[48:49], s[64:65]
 v_add_f32 v26, v20, v26
 v_cvt_pk_bf16_f32 v41, v20, v21
M v[156:159], a[92:95], v[60:63], v[156:159]
 s_and_b64 s[80:81], s[48:49], s[84:85]
 buffer_load_dwordx4 v3, s[8:11], s21 offen offset:3072 sc1 lds
M v[156:159], a[88:91], v[52:55], v[156:159]
 s_waitcnt lgkmcnt(0)
 s_or_b64 s[80:81], s[80:81], s[64:65]
 v_add_f32 v26, v21, v26
M v[160:163], a[96:99], v[48:51], v[160:163]
 s_and_b64 s[74:75], s[50:51], s[64:65]
 ds_read_b128 a[64:67], v7 offset:16384
 ds_read_b128 a[68:71], v7 offset:17408
M v[160:163], a[100:103], v[56:59], v[160:163]
 s_and_b64 s[82:83], s[50:51], s[84:85]
 s_or_b64 s[82:83], s[82:83], s[64:65]
M v[164:167], a[100:103], v[60:63], v[164:167]
 s_add_u32 m0, s28, 102400
 v_exp_f32 v22, v72
M v[164:167], a[96:99], v[52:55], v[164:167]
 ds_read_b128 a[72:75], v7 offset:18432
 ds_read_b128 a[76:79], v7 offset:19456
M v[168:171], a[104:107], v[48:51], v[168:171]
 buffer_load_dwordx4 v4, s[8:11], s21 offen offset:0 sc1 lds
M v[168:171], a[108:111], v[56:59], v[168:171]
 v_exp_f32 v23, v73
M v[172:175], a[108:111], v[60:63], v[172:175]
 ds_read_b128 a[80:83], v7 offset:20480
 ds_read_b128 a[84:87], v7 offset:21504
M v[172:175], a[104:107], v[52:55], v[172:175]
 v_exp_f32 v24, v74
M v[176:179], a[112:115], v[48:51], v[176:179]
 buffer_load_dwordx4 v4, s[8:11], s21 offen offset:1024 sc1 lds
M v[176:179], a[116:119], v[56:59], v[176:179]
 ds_read_b128 a[88:91], v7 offset:22528
 ds_read_b128 a[92:95], v7 offset:23552
M v[180:183], a[116:119], v[60:63], v[180:183]
 v_exp_f32 v25, v75
M v[180:183], a[112:115], v[52:55], v[180:183]
 v_add_f32 v26, v22, v26
 v_cvt_pk_bf16_f32 v42, v22, v23
M v[184:187], a[120:123], v[48:51], v[184:187]
 buffer_load_dwordx4 v4, s[8:11], s21 offen offset:2048 sc1 lds
M v[184:187], a[124:127], v[56:59], v[184:187]
 v_exp_f32 v18, v68
M v[188:191], a[124:127], v[60:63], v[188:191]
 v_add_f32 v26, v23, v26
 v_add_f32 v26, v24, v26
M v[188:191], a[120:123], v[52:55], v[188:191]
 s_waitcnt lgkmcnt(0)
 v_cvt_pk_bf16_f32 v43, v24, v25
 v_add_f32 v26, v25, v26
M v[192:195], a[64:67], v[48:51], v[192:195]
 ds_read_b128 a[96:99], v7 offset:24576
 ds_read_b128 a[100:103], v7 offset:25600
M v[192:195], a[68:71], v[56:59], v[192:195]
 buffer_load_dwordx4 v4, s[8:11], s21 offen offset:3072 sc1 lds
M v[196:199], a[68:71], v[60:63], v[196:199]
 s_add_u32 s21, s21, 32768
 v_exp_f32 v19, v69
M v[196:199], a[64:67], v[52:55], v[196:199]
 s_sub_u32 s22, s22, 1
 ds_read_b128 a[104:107], v7 offset:26624
 ds_read_b128 a[108:111], v7 offset:27648
M v[200:203], a[72:75], v[48:51], v[200:203]
 s_cmp_eq_u32 s22, 0
 v_exp_f32 v20, v70
M v[200:203], a[76:79], v[56:59], v[200:203]
 s_cselect_b32 s21, s23, s21
 v_add_f32 v27, v18, v19
 v_cvt_pk_bf16_f32 v44, v18, v19
M v[204:207], a[76:79], v[60:63], v[204:207]
 s_cselect_b32 s22, s24, s22
 ds_read_b128 a[112:115], v7 offset:28672
 ds_read_b128 a[116:119], v7 offset:29696
M v[204:207], a[72:75], v[52:55], v[204:207]
 s_cselect_b32 s23, s25, s23
M v[208:211], a[80:83], v[48:51], v[208:211]
 s_cselect_b32 s24, 0x7fff, s24
 v_exp_f32 v21, v71
M v[208:211], a[84:87], v[56:59], v[208:211]
 ds_read_b128 a[120:123], v7 offset:30720
 ds_read_b128 a[124:127], v7 offset:31744
M v[212:215], a[84:87], v[60:63], v[212:215]
 v_add_f32 v27, v20, v27
 v_cvt_pk_bf16_f32 v45, v20, v21
M v[212:215], a[80:83], v[52:55], v[212:215]
 v_add_f32 v27, v21, v27
M v[216:219], a[88:91], v[48:51], v[216:219]
 v_exp_f32 v22, v76
M v[216:219], a[92:95], v[56:59], v[216:219]
M v[220:223], a[92:95], v[60:63], v[220:223]
 s_waitcnt vmcnt(17) lgkmcnt(0)
M v[220:223], a[88:91], v[52:55], v[220:223]
 s_barrier
M v[224:227], a[96:99], v[48:51], v[224:227]
 ds_read_b128 a[64:67], v7 offset:32768
 ds_read_b128 a[68:71], v7 offset:33792
M v[224:227], a[100:103], v[56:59], v[224:227]
 v_exp_f32 v23, v77
M v[228:231], a[100:103], v[60:63], v[228:231]
 v_add_f32 v27, v22, v27
 v_cvt_pk_bf16_f32 v46, v22, v23
M v[228:231], a[96:99], v[52:55], v[228:231]
 ds_read_b128 a[72:75], v7 offset:34816
 ds_read_b128 a[76:79], v7 offset:35840
M v[232:235], a[104:107], v[48:51], v[232:235]
 v_exp_f32 v24, v78
M v[232:235], a[108:111], v[56:59], v[232:235]
 v_add_f32 v27, v23, v27
M v[236:239], a[108:111], v[60:63], v[236:239]
 ds_read_b128 a[80:83], v7 offset:36864
 ds_read_b128 a[84:87], v7 offset:37888
M v[236:239], a[104:107], v[52:55], v[236:239]
 v_exp_f32 v25, v79
M v[240:243], a[112:115], v[48:51], v[240:243]
 v_add_f32 v27, v24, v27
 v_cvt_pk_bf16_f32 v47, v24, v25
M v[240:243], a[116:119], v[56:59], v[240:243]
 ds_read_b128 a[88:91], v7 offset:38912
 ds_read_b128 a[92:95], v7 offset:39936
M v[244:247], a[116:119], v[60:63], v[244:247]
 v_add_f32 v27, v25, v27
M v[244:247], a[112:115], v[52:55], v[244:247]
M v[248:251], a[120:123], v[48:51], v[248:251]
M v[248:251], a[124:127], v[56:59], v[248:251]
M v[252:255], a[124:127], v[60:63], v[252:255]
 s_waitcnt lgkmcnt(0)
M v[252:255], a[120:123], v[52:55], v[252:255]
L_p2:
 s_cmp_lt_u32 s20, 2
 s_cbranch_scc1 L_e
 v_cndmask_b32 v96, v32, v8, s[68:69]
 v_cndmask_b32 v97, v32, v8, s[70:71]
 v_cndmask_b32 v98, v32, v8, s[72:73]
 v_cndmask_b32 v99, v32, v8, s[74:75]
 s_nop 1
M v[96:99], a[64:67], a[0:3], v[96:99]
 s_add_u32 m0, s28, 0
 ds_read_b128 a[96:99], v7 offset:40960
 ds_read_b128 a[100:103], v7 offset:41984
M v[96:99], a[68:71], a[4:7], v[96:99]
 buffer_load_dwordx4 v3, s[8:11], s26 offen offset:0 sc1 lds
M v[96:99], a[72:75], a[8:11], v[96:99]
 v_exp_f32 v18, v80
M v[96:99], a[76:79], a[12:15], v[96:99]
 ds_read_b128 a[104:107], v7 offset:43008
 ds_read_b128 a[108:111], v7 offset:44032
M v[96:99], a[80:83], a[16:19], v[96:99]
 v_exp_f32 v19, v81
M v[96:99], a[84:87], a[20:23], v[96:99]
 v_add_f32 v26, v18, v26
 v_cvt_pk_bf16_f32 v56, v18, v19
M v[96:99], a[88:91], a[24:27], v[96:99]
 ds_read_b128 a[112:115], v7 offset:45056
 ds_read_b128 a[116:119], v7 offset:46080
M v[96:99], a[92:95], a[28:31], v[96:99]
 buffer_load_dwordx4 v3, s[8:11], s26 offen offset:1024 sc1 lds
M v[100:103], a[92:95], a[60:63], v[36:39]
 v_exp_f32 v20, v82
M v[100:103], a[88:91], a[56:59], v[100:103]
 ds_read_b128 a[120:123], v7 offset:47104
 ds_read_b128 a[124:127], v7 offset:48128
M v[100:103], a[84:87], a[52:55], v[100:103]
 v_exp_f32 v21, v83
M v[100:103], a[80:83], a[48:51], v[100:103]
 v_cndmask_b32 v104, v32, v8, s[64:65]
 v_cndmask_b32 v105, v32, v8, s[64:65]
M v[100:103], a[76:79], a[44:47], v[100:103]
 v_cndmask_b32 v106, v32, v8, s[64:65]
 v_cndmask_b32 v107, v32, v8, s[64:65]
M v[100:103], a[72:75], a[40:43], v[100:103]
 buffer_load_dwordx4 v3, s[8:11], s26 offen offset:2048 sc1 lds
M v[100:103], a[68:71], a[36:39], v[100:103]
 v_exp_f32 v22, v88
M v[100:103], a[64:67], a[32:35], v[100:103]
 s_waitcnt lgkmcnt(0)
 v_add_f32 v26, v19, v26
 v_add_f32 v26, v20, v26
M v[104:107], a[96:99], a[0:3], v[104:107]
 ds_read_b128 a[64:67], v7 offset:49152
 ds_read_b128 a[68:71], v7 offset:50176
M v[104:107], a[100:103], a[4:7], v[104:107]
 buffer_load_dwordx4 v3, s[8:11], s26 offen offset:3072 sc1 lds
M v[104:107], a[104:107], a[8:11], v[104:107]
 v_exp_f32 v23, v89
M v[104:107], a[108:111], a[12:15], v[104:107]
 ds_read_b128 a[72:75], v7 offset:51200
 ds_read_b128 a[76:79], v7 offset:52224
M v[104:107], a[112:115], a[16:19], v[104:107]
 v_cndmask_b32 v108, v36, v8, s[68:69]
 v_cndmask_b32 v109, v36, v8, s[70:71]
M v[104:107], a[116:119], a[20:23], v[104:107]
 v_cndmask_b32 v110, v36, v8, s[72:73]
 v_cndmask_b32 v111, v36, v8, s[74:75]
M v[104:107], a[120:123], a[24:27], v[104:107]
 s_add_u32 m0, s28, 4096
 ds_read_b128 a[80:83], v7 offset:53248
 ds_read_b128 a[84:87], v7 offset:54272
M v[104:107], a[124:127], a[28:31], v[104:107]
 buffer_load_dwordx4 v4, s[8:11], s26 offen offset:0 sc1 lds
M v[108:111], a[124:127], a[60:63], v[108:111]
 v_exp_f32 v24, v90
M v[108:111], a[120:123], a[56:59], v[108:111]
 ds_read_b128 a[88:91], v7 offset:55296
 ds_read_b128 a[92:95], v7 offset:56320
M v[108:111], a[116:119], a[52:55], v[108:111]
 v_exp_f32 v25, v91
M v[108:111], a[112:115], a[48:51], v[108:111]
 v_cndmask_b32 v112, v32, v8, s[76:77]
 v_cndmask_b32 v113, v32, v8, s[78:79]
M v[108:111], a[108:111], a[44:47], v[108:111]
 v_cndmask_b32 v114, v32, v8, s[80:81]
 v_cndmask_b32 v115, v32, v8, s[82:83]
M v[108:111], a[104:107], a[40:43], v[108:111]
 buffer_load_dwordx4 v4, s[8:11], s26 offen offset:1024 sc1 lds
M v[108:111], a[100:103], a[36:39], v[108:111]
 v_exp_f32 v18, v84
M v[108:111], a[96:99], a[32:35], v[108:111]
 s_waitcnt lgkmcnt(0)
 v_exp_f32 v19, v85
M v[112:115], a[64:67], a[0:3], v[112:115]
 ds_read_b128 a[96:99], v7 offset:57344
 ds_read_b128 a[100:103], v7 offset:58368
M v[112:115], a[68:71], a[4:7], v[112:115]
 v_cvt_pk_bf16_f32 v57, v20, v21
 v_add_f32 v26, v21, v26
M v[112:115], a[72:75], a[8:11], v[112:115]
 buffer_load_dwordx4 v4, s[8:11], s26 offen offset:2048 sc1 lds
M v[112:115], a[76:79], a[12:15], v[112:115]
 ds_read_b128 a[104:107], v7 offset:59392
 ds_read_b128 a[108:111], v7 offset:60416
M v[112:115], a[80:83], a[16:19], v[112:115]
 v_cndmask_b32 v116, v36, v8, s[64:65]
 v_cndmask_b32 v117, v36, v8, s[64:65]
M v[112:115], a[84:87], a[20:23], v[112:115]
 v_cndmask_b32 v118, v36, v8, s[64:65]
 v_cndmask_b32 v119, v36, v8, s[64:65]
M v[112:115], a[88:91], a[24:27], v[112:115]
 ds_read_b128 a[112:115], v7 offset:61440
 ds_read_b128 a[116:119], v7 offset:62464
M v[112:115], a[92:95], a[28:31], v[112:115]
 buffer_load_dwordx4 v4, s[8:11], s26 offen offset:3072 sc1 lds
M v[116:119], a[92:95], a[60:63], v[116:119]
 s_add_u32 s26, s26, 32768
 v_exp_f32 v20, v86
M v[116:119], a[88:91], a[56:59], v[116:119]
 ds_read_b128 a[120:123], v7 offset:63488
 ds_read_b128 a[124:127], v7 offset:64512
M v[116:119], a[84:87], a[52:55], v[116:119]
 v_exp_f32 v21, v87
M v[116:119], a[80:83], a[48:51], v[116:119]
 v_cndmask_b32 v120, v32, v8, s[66:67]
 v_cndmask_b32 v121, v32, v8, s[66:67]
M v[116:119], a[76:79], a[44:47], v[116:119]
 v_cndmask_b32 v122, v32, v8, s[66:67]
 v_cndmask_b32 v123, v32, v8, s[66:67]
M v[116:119], a[72:75], a[40:43], v[116:119]
 v_add_f32 v26, v22, v26
 v_cvt_pk_bf16_f32 v58, v22, v23
M v[116:119], a[68:71], a[36:39], v[116:119]
 s_waitcnt vmcnt(16) lgkmcnt(0)
 v_add_f32 v26, v23, v26
 v_add_f32 v26, v24, v26
M v[116:119], a[64:67], a[32:35], v[116:119]
 s_barrier
M v[120:123], a[96:99], a[0:3], v[120:123]
 ds_read_b128 a[64:67], v2 offset:0
 ds_read_b128 a[68:71], v2 offset:1024
M v[120:123], a[100:103], a[4:7], v[120:123]
 v_exp_f32 v22, v92
M v[120:123], a[104:107], a[8:11], v[120:123]
 v_exp_f32 v23, v93
M v[120:123], a[108:111], a[12:15], v[120:123]
 ds_read_b128 a[72:75], v2 offset:2048
 ds_read_b128 a[76:79], v2 offset:3072
M v[120:123], a[112:115], a[16:19], v[120:123]
 v_cndmask_b32 v124, v36, v8, s[76:77]
 v_cndmask_b32 v125, v36, v8, s[78:79]
M v[120:123], a[116:119], a[20:23], v[120:123]
 v_cndmask_b32 v126, v36, v8, s[80:81]
 v_cndmask_b32 v127, v36, v8, s[82:83]
M v[120:123], a[120:123], a[24:27], v[120:123]
 ds_read_b128 a[80:83], v2 offset:4096
 ds_read_b128 a[84:87], v2 offset:5120
M v[120:123], a[124:127], a[28:31], v[120:123]
 v_cvt_pk_bf16_f32 v59, v24, v25
 v_add_f32 v26, v25, v26
M v[124:127], a[124:127], a[60:63], v[124:127]
 v_exp_f32 v24, v94
M v[124:127], a[120:123], a[56:59], v[124:127]
 ds_read_b128 a[88:91], v2 offset:6144
 ds_read_b128 a[92:95], v2 offset:7168
M v[124:127], a[116:119], a[52:55], v[124:127]
 v_exp_f32 v25, v95
M v[124:127], a[112:115], a[48:51], v[124:127]
 v_add_f32 v27, v18, v27
 v_cvt_pk_bf16_f32 v60, v18, v19
M v[124:127], a[108:111], a[44:47], v[124:127]
 v_add_f32 v27, v19, v27
 v_add_f32 v27, v20, v27
M v[124:127], a[104:107], a[40:43], v[124:127]
 v_cvt_pk_bf16_f32 v61, v20, v21
 v_add_f32 v27, v21, v27
M v[124:127], a[100:103], a[36:39], v[124:127]
 s_waitcnt lgkmcnt(0)
 v_add_f32 v27, v22, v27
 v_cvt_pk_bf16_f32 v62, v22, v23
M v[124:127], a[96:99], a[32:35], v[124:127]
 v_add_f32 v27, v23, v27
 v_add_f32 v27, v24, v27
 v_cvt_pk_bf16_f32 v63, v24, v25
 v_add_f32 v27, v25, v27
 v_max_f32 v10, v26, v27
 v_cmp_lt_f32 vcc, s31, v10
 s_nop 0
 s_cbranch_vccnz L_st6
L_rt6:
 s_cmp_ge_u32 s42, 10
 s_cbranch_scc1 L_p2c
M v[128:131], a[64:67], v[40:43], v[128:131]
 s_add_u32 m0, s28, 32768
 ds_read_b128 a[96:99], v2 offset:8192
 ds_read_b128 a[100:103], v2 offset:9216
M v[128:131], a[68:71], v[56:59], v[128:131]
 buffer_load_dwordx4 v3, s[8:11], s21 offen offset:0 sc1 lds
M v[132:135], a[68:71], v[60:63], v[132:135]
 v_exp_f32 v18, v96
M v[132:135], a[64:67], v[44:47], v[132:135]
 ds_read_b128 a[104:107], v2 offset:10240
 ds_read_b128 a[108:111], v2 offset:11264
M v[136:139], a[72:75], v[40:43], v[136:139]
 v_exp_f32 v19, v97
M v[136:139], a[76:79], v[56:59], v[136:139]
 buffer_load_dwordx4 v3, s[8:11], s21 offen offset:1024 sc1 lds
M v[140:143], a[76:79], v[60:63], v[140:143]
 ds_read_b128 a[112:115], v2 offset:12288
 ds_read_b128 a[116:119], v2 offset:13312
M v[140:143], a[72:75], v[44:47], v[140:143]
 v_exp_f32 v20, v98
M v[144:147], a[80:83], v[40:43], v[144:147]
 v_add_f32 v30, v26, v30
 v_add_f32 v31, v27, v31
M v[144:147], a[84:87], v[56:59], v[144:147]
 ds_read_b128 a[120:123], v2 offset:14336
 ds_read_b128 a[124:127], v2 offset:15360
M v[148:151], a[84:87], v[60:63], v[148:151]
 buffer_load_dwordx4 v3, s[8:11], s21 offen offset:2048 sc1 lds
M v[148:151], a[80:83], v[44:47], v[148:151]
 v_exp_f32 v21, v99
M v[152:155], a[88:91], v[40:43], v[152:155]
 v_add_f32 v28, v18, v19
 v_cvt_pk_bf16_f32 v48, v18, v19
M v[152:155], a[92:95], v[56:59], v[152:155]
 v_add_f32 v28, v20, v28
 v_cvt_pk_bf16_f32 v49, v20, v21
M v[156:159], a[92:95], v[60:63], v[156:159]
 buffer_load_dwordx4 v3, s[8:11], s21 offen offset:3072 sc1 lds
M v[156:159], a[88:91], v[44:47], v[156:159]
 s_waitcnt lgkmcnt(0)
 v_exp_f32 v22, v104
M v[160:163], a[96:99], v[40:43], v[160:163]
 ds_read_b128 a[64:67], v2 offset:16384
 ds_read_b128 a[68:71], v2 offset:17408
M v[160:163], a[100:103], v[56:59], v[160:163]
 v_add_f32 v28, v21, v28
M v[164:167], a[100:103], v[60:63], v[164:167]
 s_add_u32 m0, s28, 36864
 v_exp_f32 v23, v105
M v[164:167], a[96:99], v[44:47], v[164:167]
 ds_read_b128 a[72:75], v2 offset:18432
 ds_read_b128 a[76:79], v2 offset:19456
M v[168:171], a[104:107], v[40:43], v[168:171]
 buffer_load_dwordx4 v4, s[8:11], s21 offen offset:0 sc1 lds
M v[168:171], a[108:111], v[56:59], v[168:171]
 v_add_f32 v28, v22, v28
 v_cvt_pk_bf16_f32 v50, v22, v23
M v[172:175], a[108:111], v[60:63], v[172:175]
 ds_read_b128 a[80:83], v2 offset:20480
 ds_read_b128 a[84:87], v2 offset:21504
M v[172:175], a[104:107], v[44:47], v[172:175]
 v_exp_f32 v24, v106
M v[176:179], a[112:115], v[40:43], v[176:179]
 buffer_load_dwordx4 v4, s[8:11], s21 offen offset:1024 sc1 lds
M v[176:179], a[116:119], v[56:59], v[176:179]
 ds_read_b128 a[88:91], v2 offset:22528
 ds_read_b128 a[92:95], v2 offset:23552
M v[180:183], a[116:119], v[60:63], v[180:183]
 buffer_load_dword v6, v9, s[8:11], s46 offen sc1
M v[180:183], a[112:115], v[44:47], v[180:183]
 v_exp_f32 v25, v107
M v[184:187], a[120:123], v[40:43], v[184:187]
 buffer_load_dwordx4 v4, s[8:11], s21 offen offset:2048 sc1 lds
M v[184:187], a[124:127], v[56:59], v[184:187]
 v_exp_f32 v18, v100
M v[188:191], a[124:127], v[60:63], v[188:191]
 v_add_f32 v28, v23, v28
 v_add_f32 v28, v24, v28
M v[188:191], a[120:123], v[44:47], v[188:191]
 s_waitcnt lgkmcnt(0)
 v_cvt_pk_bf16_f32 v51, v24, v25
 v_add_f32 v28, v25, v28
M v[192:195], a[64:67], v[40:43], v[192:195]
 ds_read_b128 a[96:99], v2 offset:24576
 ds_read_b128 a[100:103], v2 offset:25600
M v[192:195], a[68:71], v[56:59], v[192:195]
 buffer_load_dwordx4 v4, s[8:11], s21 offen offset:3072 sc1 lds
M v[196:199], a[68:71], v[60:63], v[196:199]
 s_add_u32 s21, s21, 32768
 v_exp_f32 v19, v101
M v[196:199], a[64:67], v[44:47], v[196:199]
 s_sub_u32 s22, s22, 1
 ds_read_b128 a[104:107], v2 offset:26624
 ds_read_b128 a[108:111], v2 offset:27648
M v[200:203], a[72:75], v[40:43], v[200:203]
 s_cmp_eq_u32 s22, 0
 v_exp_f32 v20, v102
M v[200:203], a[76:79], v[56:59], v[200:203]
 s_cselect_b32 s21, s23, s21
 v_add_f32 v29, v18, v19
 v_cvt_pk_bf16_f32 v52, v18, v19
M v[204:207], a[76:79], v[60:63], v[204:207]
 s_cselect_b32 s22, s24, s22
 ds_read_b128 a[112:115], v2 offset:28672
 ds_read_b128 a[116:119], v2 offset:29696
M v[204:207], a[72:75], v[44:47], v[204:207]
 s_cselect_b32 s23, s25, s23
M v[208:211], a[80:83], v[40:43], v[208:211]
 s_cselect_b32 s24, 0x7fff, s24
 v_exp_f32 v21, v103
M v[208:211], a[84:87], v[56:59], v[208:211]
 ds_read_b128 a[120:123], v2 offset:30720
 ds_read_b128 a[124:127], v2 offset:31744
M v[212:215], a[84:87], v[60:63], v[212:215]
 v_add_f32 v29, v20, v29
 v_cvt_pk_bf16_f32 v53, v20, v21
M v[212:215], a[80:83], v[44:47], v[212:215]
 v_add_f32 v29, v21, v29
M v[216:219], a[88:91], v[40:43], v[216:219]
 v_exp_f32 v22, v108
M v[216:219], a[92:95], v[56:59], v[216:219]
M v[220:223], a[92:95], v[60:63], v[220:223]
 s_waitcnt vmcnt(17) lgkmcnt(0)
M v[220:223], a[88:91], v[44:47], v[220:223]
 s_barrier
M v[224:227], a[96:99], v[40:43], v[224:227]
 ds_read_b128 a[64:67], v2 offset:32768
 ds_read_b128 a[68:71], v2 offset:33792
M v[224:227], a[100:103], v[56:59], v[224:227]
 v_exp_f32 v23, v109
M v[228:231], a[100:103], v[60:63], v[228:231]
 v_add_f32 v29, v22, v29
 v_cvt_pk_bf16_f32 v54, v22, v23
M v[228:231], a[96:99], v[44:47], v[228:231]
 ds_read_b128 a[72:75], v2 offset:34816
 ds_read_b128 a[76:79], v2 offset:35840
M v[232:235], a[104:107], v[40:43], v[232:235]
 v_exp_f32 v24, v110
M v[232:235], a[108:111], v[56:59], v[232:235]
 v_add_f32 v29, v23, v29
M v[236:239], a[108:111], v[60:63], v[236:239]
 ds_read_b128 a[80:83], v2 offset:36864
 ds_read_b128 a[84:87], v2 offset:37888
M v[236:239], a[104:107], v[44:47], v[236:239]
 v_exp_f32 v25, v111
M v[240:243], a[112:115], v[40:43], v[240:243]
 v_add_f32 v29, v24, v29
 v_cvt_pk_bf16_f32 v55, v24, v25
M v[240:243], a[116:119], v[56:59], v[240:243]
 ds_read_b128 a[88:91], v2 offset:38912
 ds_read_b128 a[92:95], v2 offset:39936
M v[244:247], a[116:119], v[60:63], v[244:247]
 v_add_f32 v29, v25, v29
M v[244:247], a[112:115], v[44:47], v[244:247]
M v[248:251], a[120:123], v[40:43], v[248:251]
M v[248:251], a[124:127], v[56:59], v[248:251]
M v[252:255], a[124:127], v[60:63], v[252:255]
 s_waitcnt lgkmcnt(0)
M v[252:255], a[120:123], v[44:47], v[252:255]
 s_waitcnt vmcnt(9)
 s_barrier
 ds_read_b128 a[64:67], v7 offset:0
 ds_read_b128 a[68:71], v7 offset:1024
 ds_read_b128 a[72:75], v7 offset:2048
 ds_read_b128 a[76:79], v7 offset:3072
 ds_read_b128 a[80:83], v7 offset:4096
 ds_read_b128 a[84:87], v7 offset:5120
 ds_read_b128 a[88:91], v7 offset:6144
 ds_read_b128 a[92:95], v7 offset:7168
 s_cmp_le_u32 s42, 5
 s_cbranch_scc1 L_final_k
 v_exp_f32 v18, v112
 v_exp_f32 v19, v113
 v_exp_f32 v20, v114
 v_add_f32 v28, v18, v28
 v_cvt_pk_bf16_f32 v56, v18, v19
 v_exp_f32 v21, v115
 v_add_f32 v28, v19, v28
 v_exp_f32 v22, v120
 v_add_f32 v28, v20, v28
 v_cvt_pk_bf16_f32 v57, v20, v21
 v_exp_f32 v23, v121
 v_add_f32 v28, v21, v28
 v_exp_f32 v24, v122
 v_add_f32 v28, v22, v28
 v_cvt_pk_bf16_f32 v58, v22, v23
 v_exp_f32 v25, v123
 v_add_f32 v28, v23, v28
 v_exp_f32 v18, v116
 v_add_f32 v28, v24, v28
 v_cvt_pk_bf16_f32 v59, v24, v25
 v_exp_f32 v19, v117
 v_add_f32 v28, v25, v28
 v_exp_f32 v20, v118
 v_add_f32 v29, v18, v29
 v_cvt_pk_bf16_f32 v60, v18, v19
 v_exp_f32 v21, v119
 v_add_f32 v29, v19, v29
 v_exp_f32 v22, v124
 v_add_f32 v29, v20, v29
 v_cvt_pk_bf16_f32 v61, v20, v21
 v_exp_f32 v23, v125
 v_add_f32 v29, v21, v29
 v_exp_f32 v24, v126
 v_add_f32 v29, v22, v29
 v_cvt_pk_bf16_f32 v62, v22, v23
 v_exp_f32 v25, v127
 v_add_f32 v29, v23, v29
 v_add_f32 v29, v24, v29
 v_cvt_pk_bf16_f32 v63, v24, v25
 v_add_f32 v29, v25, v29
L_final_o2:
 v_max_f32 v10, v28, v29
 v_cmp_lt_f32 vcc, s31, v10
 s_nop 0
 s_cbranch_vccnz L_st2
L_rt2:
 s_waitcnt vmcnt(2) lgkmcnt(0)
M v[128:131], a[64:67], v[48:51], v[128:131]
 s_add_u32 m0, s28, 65536
 ds_read_b128 a[96:99], v7 offset:8192
 ds_read_b128 a[100:103], v7 offset:9216
M v[128:131], a[68:71], v[56:59], v[128:131]
 buffer_load_dwordx4 v3, s[8:11], s38 offen offset:0 sc1 lds
M v[132:135], a[68:71], v[60:63], v[132:135]
 v_add_f32 v30, v28, v30
M v[132:135], a[64:67], v[52:55], v[132:135]
 ds_read_b128 a[104:107], v7 offset:10240
 ds_read_b128 a[108:111], v7 offset:11264
M v[136:139], a[72:75], v[48:51], v[136:139]
 v_add_f32 v31, v29, v31
M v[136:139], a[76:79], v[56:59], v[136:139]
 v_mov_b32 v10, v30
M v[140:143], a[76:79], v[60:63], v[140:143]
 ds_read_b128 a[112:115], v7 offset:12288
 ds_read_b128 a[116:119], v7 offset:13312
M v[140:143], a[72:75], v[52:55], v[140:143]
 buffer_load_dwordx4 v3, s[8:11], s38 offen offset:1024 sc1 lds
M v[144:147], a[80:83], v[48:51], v[144:147]
 v_permlane16_swap_b32 v10, v30
M v[144:147], a[84:87], v[56:59], v[144:147]
 ds_read_b128 a[120:123], v7 offset:14336
 ds_read_b128 a[124:127], v7 offset:15360
M v[148:151], a[84:87], v[60:63], v[148:151]
 v_add_f32 v30, v10, v30
M v[148:151], a[80:83], v[52:55], v[148:151]
 v_mov_b32 v10, v30
M v[152:155], a[88:91], v[48:51], v[152:155]
 buffer_load_dwordx4 v3, s[8:11], s38 offen offset:2048 sc1 lds
M v[152:155], a[92:95], v[56:59], v[152:155]
 v_permlane32_swap_b32 v10, v30
M v[156:159], a[92:95], v[60:63], v[156:159]
 v_add_f32 v30, v10, v30
M v[156:159], a[88:91], v[52:55], v[156:159]
 s_waitcnt lgkmcnt(0)
 v_mov_b32 v11, v31
M v[160:163], a[96:99], v[48:51], v[160:163]
 ds_read_b128 a[64:67], v7 offset:16384
 ds_read_b128 a[68:71], v7 offset:17408
M v[160:163], a[100:103], v[56:59], v[160:163]
 buffer_load_dwordx4 v3, s[8:11], s38 offen offset:3072 sc1 lds
M v[164:167], a[100:103], v[60:63], v[164:167]
 v_permlane16_swap_b32 v11, v31
M v[164:167], a[96:99], v[52:55], v[164:167]
 ds_read_b128 a[72:75], v7 offset:18432
 ds_read_b128 a[76:79], v7 offset:19456
M v[168:171], a[104:107], v[48:51], v[168:171]
 v_add_f32 v31, v11, v31
M v[168:171], a[108:111], v[56:59], v[168:171]
 v_mov_b32 v11, v31
M v[172:175], a[108:111], v[60:63], v[172:175]
 s_add_u32 m0, s28, 69632
 ds_read_b128 a[80:83], v7 offset:20480
 ds_read_b128 a[84:87], v7 offset:21504
M v[172:175], a[104:107], v[52:55], v[172:175]
 buffer_load_dwordx4 v4, s[8:11], s38 offen offset:0 sc1 lds
M v[176:179], a[112:115], v[48:51], v[176:179]
 v_permlane32_swap_b32 v11, v31
M v[176:179], a[116:119], v[56:59], v[176:179]
 ds_read_b128 a[88:91], v7 offset:22528
 ds_read_b128 a[92:95], v7 offset:23552
M v[180:183], a[116:119], v[60:63], v[180:183]
 v_add_f32 v31, v11, v31
M v[180:183], a[112:115], v[52:55], v[180:183]
 v_rcp_f32 v5, v30
M v[184:187], a[120:123], v[48:51], v[184:187]
 buffer_load_dwordx4 v4, s[8:11], s38 offen offset:1024 sc1 lds
M v[184:187], a[124:127], v[56:59], v[184:187]
 v_rcp_f32 v6, v31
M v[188:191], a[124:127], v[60:63], v[188:191]
 v_cvt_pk_bf16_f32 v128, v128, v129
 v_cvt_pk_bf16_f32 v129, v130, v131
M v[188:191], a[120:123], v[52:55], v[188:191]
 s_waitcnt lgkmcnt(0)
 v_cvt_pk_bf16_f32 v130, v136, v137
 v_cvt_pk_bf16_f32 v131, v138, v139
M v[192:195], a[64:67], v[48:51], v[192:195]
 ds_read_b128 a[96:99], v7 offset:24576
 ds_read_b128 a[100:103], v7 offset:25600
M v[192:195], a[68:71], v[56:59], v[192:195]
 v_cvt_pk_bf16_f32 v132, v132, v133
 v_cvt_pk_bf16_f32 v133, v134, v135
M v[196:199], a[68:71], v[60:63], v[196:199]
 buffer_load_dwordx4 v4, s[8:11], s38 offen offset:2048 sc1 lds
M v[196:199], a[64:67], v[52:55], v[196:199]
 ds_read_b128 a[104:107], v7 offset:26624
 ds_read_b128 a[108:111], v7 offset:27648
M v[200:203], a[72:75], v[48:51], v[200:203]
 v_cvt_pk_bf16_f32 v134, v140, v141
 v_cvt_pk_bf16_f32 v135, v142, v143
M v[200:203], a[76:79], v[56:59], v[200:203]
 v_cvt_pk_bf16_f32 v144, v144, v145
 v_cvt_pk_bf16_f32 v145, v146, v147
M v[204:207], a[76:79], v[60:63], v[204:207]
 ds_read_b128 a[112:115], v7 offset:28672
 ds_read_b128 a[116:119], v7 offset:29696
M v[204:207], a[72:75], v[52:55], v[204:207]
 buffer_load_dwordx4 v4, s[8:11], s38 offen offset:3072 sc1 lds
M v[208:211], a[80:83], v[48:51], v[208:211]
 s_add_u32 s38, s38, 32768
 v_cvt_pk_bf16_f32 v146, v152, v153
 v_cvt_pk_bf16_f32 v147, v154, v155
M v[208:211], a[84:87], v[56:59], v[208:211]
 ds_read_b128 a[120:123], v7 offset:30720
 ds_read_b128 a[124:127], v7 offset:31744
M v[212:215], a[84:87], v[60:63], v[212:215]
 v_cvt_pk_bf16_f32 v148, v148, v149
 v_cvt_pk_bf16_f32 v149, v150, v151
M v[212:215], a[80:83], v[52:55], v[212:215]
 v_cvt_pk_bf16_f32 v150, v156, v157
 v_cvt_pk_bf16_f32 v151, v158, v159
M v[216:219], a[88:91], v[48:51], v[216:219]
 v_cvt_pk_bf16_f32 v160, v160, v161
 v_cvt_pk_bf16_f32 v161, v162, v163
M v[216:219], a[92:95], v[56:59], v[216:219]
 v_cvt_pk_bf16_f32 v162, v168, v169
 v_cvt_pk_bf16_f32 v163, v170, v171
M v[220:223], a[92:95], v[60:63], v[220:223]
 s_waitcnt lgkmcnt(0)
 v_cvt_pk_bf16_f32 v164, v164, v165
 v_cvt_pk_bf16_f32 v165, v166, v167
M v[220:223], a[88:91], v[52:55], v[220:223]
 s_barrier
M v[224:227], a[96:99], v[48:51], v[224:227]
 ds_read_b128 a[64:67], v2 offset:32768
 ds_read_b128 a[68:71], v2 offset:33792
M v[224:227], a[100:103], v[56:59], v[224:227]
 v_cvt_pk_bf16_f32 v166, v172, v173
 v_cvt_pk_bf16_f32 v167, v174, v175
M v[228:231], a[100:103], v[60:63], v[228:231]
 v_cvt_pk_bf16_f32 v176, v176, v177
 v_cvt_pk_bf16_f32 v177, v178, v179
M v[228:231], a[96:99], v[52:55], v[228:231]
 ds_read_b128 a[72:75], v2 offset:34816
 ds_read_b128 a[76:79], v2 offset:35840
M v[232:235], a[104:107], v[48:51], v[232:235]
 v_cvt_pk_bf16_f32 v178, v184, v185
 v_cvt_pk_bf16_f32 v179, v186, v187
M v[232:235], a[108:111], v[56:59], v[232:235]
 v_cvt_pk_bf16_f32 v180, v180, v181
 v_cvt_pk_bf16_f32 v181, v182, v183
M v[236:239], a[108:111], v[60:63], v[236:239]
 ds_read_b128 a[80:83], v2 offset:36864
 ds_read_b128 a[84:87], v2 offset:37888
M v[236:239], a[104:107], v[52:55], v[236:239]
 v_cvt_pk_bf16_f32 v182, v188, v189
 v_cvt_pk_bf16_f32 v183, v190, v191
M v[240:243], a[112:115], v[48:51], v[240:243]
 v_cvt_pk_bf16_f32 v192, v192, v193
 v_cvt_pk_bf16_f32 v193, v194, v195
M v[240:243], a[116:119], v[56:59], v[240:243]
 ds_read_b128 a[88:91], v2 offset:38912
 ds_read_b128 a[92:95], v2 offset:39936
M v[244:247], a[116:119], v[60:63], v[244:247]
 v_cvt_pk_bf16_f32 v194, v200, v201
 v_cvt_pk_bf16_f32 v195, v202, v203
M v[244:247], a[112:115], v[52:55], v[244:247]
 v_cvt_pk_bf16_f32 v196, v196, v197
 v_cvt_pk_bf16_f32 v197, v198, v199
M v[248:251], a[120:123], v[48:51], v[248:251]
 v_cvt_pk_bf16_f32 v198, v204, v205
 v_cvt_pk_bf16_f32 v199, v206, v207
M v[248:251], a[124:127], v[56:59], v[248:251]
 v_cvt_pk_bf16_f32 v208, v208, v209
 v_cvt_pk_bf16_f32 v209, v210, v211
M v[252:255], a[124:127], v[60:63], v[252:255]
 s_waitcnt lgkmcnt(0)
 v_cvt_pk_bf16_f32 v210, v216, v217
 v_cvt_pk_bf16_f32 v211, v218, v219
M v[252:255], a[120:123], v[52:55], v[252:255]
 v_cvt_pk_bf16_f32 v212, v212, v213
 v_cvt_pk_bf16_f32 v213, v214, v215
 v_cvt_pk_bf16_f32 v214, v220, v221
 v_cvt_pk_bf16_f32 v215, v222, v223
 v_cvt_pk_bf16_f32 v224, v224, v225
 v_cvt_pk_bf16_f32 v225, v226, v227
 v_cvt_pk_bf16_f32 v226, v232, v233
 v_cvt_pk_bf16_f32 v227, v234, v235
 v_cvt_pk_bf16_f32 v228, v228, v229
 v_cvt_pk_bf16_f32 v229, v230, v231
 v_cvt_pk_bf16_f32 v230, v236, v237
 v_cvt_pk_bf16_f32 v231, v238, v239
 v_cvt_pk_bf16_f32 v240, v240, v241
 v_cvt_pk_bf16_f32 v241, v242, v243
 v_cvt_pk_bf16_f32 v242, v248, v249
 v_cvt_pk_bf16_f32 v243, v250, v251
 v_cvt_pk_bf16_f32 v244, v244, v245
 v_cvt_pk_bf16_f32 v245, v246, v247
 v_cvt_pk_bf16_f32 v246, v252, v253
 v_cvt_pk_bf16_f32 v247, v254, v255
 s_branch L_op1
L_p1c:
 s_waitcnt vmcnt(8)
 v_cmp_ne_u32 vcc, 1, v5
 s_nop 0
 s_cbranch_vccnz L_fps0
L_fpr0:
M v[128:131], a[64:67], v[48:51], v[128:131]
 s_add_u32 m0, s28, 98304
 ds_read_b128 a[96:99], v7 offset:8192
 ds_read_b128 a[100:103], v7 offset:9216
M v[128:131], a[68:71], v[56:59], v[128:131]
 buffer_load_dwordx4 v3, s[8:11], s21 offen offset:0 sc1 lds
M v[132:135], a[68:71], v[60:63], v[132:135]
 s_cmp_eq_u32 s20, 2
 v_exp_f32 v18, v64
M v[132:135], a[64:67], v[52:55], v[132:135]
 s_cselect_b64 s[64:65], -1, 0
 ds_read_b128 a[104:107], v7 offset:10240
 ds_read_b128 a[108:111], v7 offset:11264
M v[136:139], a[72:75], v[48:51], v[136:139]
 s_cmp_eq_u32 s20, 3
 buffer_load_dwordx4 a[128:131], v7, s[8:11], s86 offen offset:0 sc1
M v[136:139], a[76:79], v[56:59], v[136:139]
 s_cselect_b64 s[84:85], -1, 0
 v_exp_f32 v19, v65
M v[140:143], a[76:79], v[60:63], v[140:143]
 s_or_b64 s[66:67], s[64:65], s[84:85]
 ds_read_b128 a[112:115], v7 offset:12288
 ds_read_b128 a[116:119], v7 offset:13312
M v[140:143], a[72:75], v[52:55], v[140:143]
 s_and_b64 s[68:69], s[16:17], s[64:65]
 v_exp_f32 v20, v66
M v[144:147], a[80:83], v[48:51], v[144:147]
 s_and_b64 s[76:77], s[16:17], s[84:85]
 buffer_load_dwordx4 v3, s[8:11], s21 offen offset:1024 sc1 lds
M v[144:147], a[84:87], v[56:59], v[144:147]
 s_or_b64 s[76:77], s[76:77], s[64:65]
 ds_read_b128 a[120:123], v7 offset:14336
 ds_read_b128 a[124:127], v7 offset:15360
M v[148:151], a[84:87], v[60:63], v[148:151]
 s_and_b64 s[70:71], s[18:19], s[64:65]
 v_add_f32 v30, v28, v30
 v_add_f32 v31, v29, v31
M v[148:151], a[80:83], v[52:55], v[148:151]
 s_and_b64 s[78:79], s[18:19], s[84:85]
 buffer_load_dwordx4 a[132:135], v7, s[8:11], s86 offen offset:1024 sc1
M v[152:155], a[88:91], v[48:51], v[152:155]
 s_or_b64 s[78:79], s[78:79], s[64:65]
 v_exp_f32 v21, v67
M v[152:155], a[92:95], v[56:59], v[152:155]
 s_and_b64 s[72:73], s[48:49], s[64:65]
 v_add_f32 v26, v18, v19
 v_cvt_pk_bf16_f32 v40, v18, v19
M v[156:159], a[92:95], v[60:63], v[156:159]
 s_and_b64 s[80:81], s[48:49], s[84:85]
 s_or_b64 s[80:81], s[80:81], s[64:65]
 s_and_b64 s[74:75], s[50:51], s[64:65]
M v[156:159], a[88:91], v[52:55], v[156:159]
 s_waitcnt lgkmcnt(0)
 buffer_load_dwordx4 v3, s[8:11], s21 offen offset:2048 sc1 lds
M v[160:163], a[96:99], v[48:51], v[160:163]
 ds_read_b128 a[64:67], v7 offset:16384
 ds_read_b128 a[68:71], v7 offset:17408
M v[160:163], a[100:103], v[56:59], v[160:163]
 s_and_b64 s[82:83], s[50:51], s[84:85]
 v_add_f32 v26, v20, v26
M v[164:167], a[100:103], v[60:63], v[164:167]
 s_or_b64 s[82:83], s[82:83], s[64:65]
 buffer_load_dwordx4 a[136:139], v7, s[8:11], s86 offen offset:2048 sc1
M v[164:167], a[96:99], v[52:55], v[164:167]
 ds_read_b128 a[72:75], v7 offset:18432
 ds_read_b128 a[76:79], v7 offset:19456
M v[168:171], a[104:107], v[48:51], v[168:171]
 v_exp_f32 v22, v72
M v[168:171], a[108:111], v[56:59], v[168:171]
 v_exp_f32 v23, v73
M v[172:175], a[108:111], v[60:63], v[172:175]
 ds_read_b128 a[80:83], v7 offset:20480
 ds_read_b128 a[84:87], v7 offset:21504
M v[172:175], a[104:107], v[52:55], v[172:175]
 buffer_load_dwordx4 v3, s[8:11], s21 offen offset:3072 sc1 lds
M v[176:179], a[112:115], v[48:51], v[176:179]
 v_exp_f32 v24, v74
M v[176:179], a[116:119], v[56:59], v[176:179]
 ds_read_b128 a[88:91], v7 offset:22528
 ds_read_b128 a[92:95], v7 offset:23552
M v[180:183], a[116:119], v[60:63], v[180:183]
 buffer_load_dwordx4 a[140:143], v7, s[8:11], s86 offen offset:3072 sc1
M v[180:183], a[112:115], v[52:55], v[180:183]
 v_exp_f32 v25, v75
M v[184:187], a[120:123], v[48:51], v[184:187]
 s_add_u32 m0, s28, 102400
 v_cvt_pk_bf16_f32 v41, v20, v21
 v_add_f32 v26, v21, v26
M v[184:187], a[124:127], v[56:59], v[184:187]
 buffer_load_dwordx4 v4, s[8:11], s21 offen offset:0 sc1 lds
M v[188:191], a[124:127], v[60:63], v[188:191]
 v_exp_f32 v18, v68
M v[188:191], a[120:123], v[52:55], v[188:191]
 s_waitcnt lgkmcnt(0)
 v_add_f32 v26, v22, v26
 v_cvt_pk_bf16_f32 v42, v22, v23
M v[192:195], a[64:67], v[48:51], v[192:195]
 ds_read_b128 a[96:99], v7 offset:24576
 ds_read_b128 a[100:103], v7 offset:25600
M v[192:195], a[68:71], v[56:59], v[192:195]
 buffer_load_dwordx4 a[144:147], v7, s[8:11], s87 offen offset:0 sc1
M v[196:199], a[68:71], v[60:63], v[196:199]
 v_exp_f32 v19, v69
M v[196:199], a[64:67], v[52:55], v[196:199]
 ds_read_b128 a[104:107], v7 offset:26624
 ds_read_b128 a[108:111], v7 offset:27648
M v[200:203], a[72:75], v[48:51], v[200:203]
 buffer_load_dwordx4 v4, s[8:11], s21 offen offset:1024 sc1 lds
M v[200:203], a[76:79], v[56:59], v[200:203]
 v_exp_f32 v20, v70
M v[204:207], a[76:79], v[60:63], v[204:207]
 ds_read_b128 a[112:115], v7 offset:28672
 ds_read_b128 a[116:119], v7 offset:29696
M v[204:207], a[72:75], v[52:55], v[204:207]
 buffer_load_dwordx4 a[148:151], v7, s[8:11], s87 offen offset:1024 sc1
M v[208:211], a[80:83], v[48:51], v[208:211]
 v_exp_f32 v21, v71
M v[208:211], a[84:87], v[56:59], v[208:211]
 ds_read_b128 a[120:123], v7 offset:30720
 ds_read_b128 a[124:127], v7 offset:31744
M v[212:215], a[84:87], v[60:63], v[212:215]
 v_add_f32 v26, v23, v26
 v_add_f32 v26, v24, v26
M v[212:215], a[80:83], v[52:55], v[212:215]
 buffer_load_dwordx4 v4, s[8:11], s21 offen offset:2048 sc1 lds
M v[216:219], a[88:91], v[48:51], v[216:219]
 v_exp_f32 v22, v76
M v[216:219], a[92:95], v[56:59], v[216:219]
 v_cvt_pk_bf16_f32 v43, v24, v25
 v_add_f32 v26, v25, v26
M v[220:223], a[92:95], v[60:63], v[220:223]
 s_waitcnt lgkmcnt(0)
 buffer_load_dwordx4 a[152:155], v7, s[8:11], s87 offen offset:2048 sc1
M v[220:223], a[88:91], v[52:55], v[220:223]
 s_barrier
M v[224:227], a[96:99], v[48:51], v[224:227]
 ds_read_b128 a[64:67], v7 offset:32768
 ds_read_b128 a[68:71], v7 offset:33792
M v[224:227], a[100:103], v[56:59], v[224:227]
 v_exp_f32 v23, v77
M v[228:231], a[100:103], v[60:63], v[228:231]
 buffer_load_dwordx4 v4, s[8:11], s21 offen offset:3072 sc1 lds
M v[228:231], a[96:99], v[52:55], v[228:231]
 s_add_u32 s21, s21, 32768
 ds_read_b128 a[72:75], v7 offset:34816
 ds_read_b128 a[76:79], v7 offset:35840
M v[232:235], a[104:107], v[48:51], v[232:235]
 s_sub_u32 s22, s22, 1
 v_exp_f32 v24, v78
M v[232:235], a[108:111], v[56:59], v[232:235]
 s_cmp_eq_u32 s22, 0
 v_add_f32 v27, v18, v19
 v_cvt_pk_bf16_f32 v44, v18, v19
M v[236:239], a[108:111], v[60:63], v[236:239]
 s_cselect_b32 s21, s23, s21
 ds_read_b128 a[80:83], v7 offset:36864
 ds_read_b128 a[84:87], v7 offset:37888
M v[236:239], a[104:107], v[52:55], v[236:239]
 s_cselect_b32 s22, s24, s22
 buffer_load_dwordx4 a[156:159], v7, s[8:11], s87 offen offset:3072 sc1
M v[240:243], a[112:115], v[48:51], v[240:243]
 s_cselect_b32 s23, s25, s23
 v_exp_f32 v25, v79
M v[240:243], a[116:119], v[56:59], v[240:243]
 s_cselect_b32 s24, 0x7fff, s24
 ds_read_b128 a[88:91], v7 offset:38912
 ds_read_b128 a[92:95], v7 offset:39936
M v[244:247], a[116:119], v[60:63], v[244:247]
 v_add_f32 v27, v20, v27
 v_cvt_pk_bf16_f32 v45, v20, v21
M v[244:247], a[112:115], v[52:55], v[244:247]
 v_add_f32 v27, v21, v27
 v_add_f32 v27, v22, v27
M v[248:251], a[120:123], v[48:51], v[248:251]
 v_cvt_pk_bf16_f32 v46, v22, v23
 v_add_f32 v27, v23, v27
M v[248:251], a[124:127], v[56:59], v[248:251]
 v_add_f32 v27, v24, v27
 v_cvt_pk_bf16_f32 v47, v24, v25
M v[252:255], a[124:127], v[60:63], v[252:255]
 s_waitcnt lgkmcnt(0)
 v_add_f32 v27, v25, v27
M v[252:255], a[120:123], v[52:55], v[252:255]
 s_branch L_p2
L_p2c:
M v[128:131], a[64:67], v[40:43], v[128:131]
 s_add_u32 m0, s28, 32768
 ds_read_b128 a[96:99], v2 offset:8192
 ds_read_b128 a[100:103], v2 offset:9216
M v[128:131], a[68:71], v[56:59], v[128:131]
 buffer_load_dwordx4 v3, s[8:11], s21 offen offset:0 sc1 lds
M v[132:135], a[68:71], v[60:63], v[132:135]
 v_exp_f32 v18, v96
M v[132:135], a[64:67], v[44:47], v[132:135]
 ds_read_b128 a[104:107], v2 offset:10240
 ds_read_b128 a[108:111], v2 offset:11264
M v[136:139], a[72:75], v[40:43], v[136:139]
 buffer_load_dwordx4 a[160:163], v7, s[8:11], s88 offen offset:0 sc1
M v[136:139], a[76:79], v[56:59], v[136:139]
 v_exp_f32 v19, v97
M v[140:143], a[76:79], v[60:63], v[140:143]
 ds_read_b128 a[112:115], v2 offset:12288
 ds_read_b128 a[116:119], v2 offset:13312
M v[140:143], a[72:75], v[44:47], v[140:143]
 v_exp_f32 v20, v98
M v[144:147], a[80:83], v[40:43], v[144:147]
 buffer_load_dwordx4 v3, s[8:11], s21 offen offset:1024 sc1 lds
M v[144:147], a[84:87], v[56:59], v[144:147]
 ds_read_b128 a[120:123], v2 offset:14336
 ds_read_b128 a[124:127], v2 offset:15360
M v[148:151], a[84:87], v[60:63], v[148:151]
 buffer_load_dwordx4 a[164:167], v7, s[8:11], s88 offen offset:1024 sc1
M v[148:151], a[80:83], v[44:47], v[148:151]
 v_exp_f32 v21, v99
M v[152:155], a[88:91], v[40:43], v[152:155]
 buffer_load_dwordx4 a[168:171], v7, s[8:11], s88 offen offset:2048 sc1
M v[152:155], a[92:95], v[56:59], v[152:155]
 buffer_load_dwordx4 a[172:175], v7, s[8:11], s88 offen offset:3072 sc1
M v[156:159], a[92:95], v[60:63], v[156:159]
 v_exp_f32 v22, v104
M v[156:159], a[88:91], v[44:47], v[156:159]
 s_waitcnt lgkmcnt(0)
 buffer_load_dwordx4 v3, s[8:11], s21 offen offset:2048 sc1 lds
M v[160:163], a[96:99], v[40:43], v[160:163]
 ds_read_b128 a[64:67], v2 offset:16384
 ds_read_b128 a[68:71], v2 offset:17408
M v[160:163], a[100:103], v[56:59], v[160:163]
 v_add_f32 v30, v26, v30
 v_add_f32 v31, v27, v31
M v[164:167], a[100:103], v[60:63], v[164:167]
 buffer_load_dwordx4 a[176:179], v7, s[8:11], s89 offen offset:0 sc1
M v[164:167], a[96:99], v[44:47], v[164:167]
 ds_read_b128 a[72:75], v2 offset:18432
 ds_read_b128 a[76:79], v2 offset:19456
M v[168:171], a[104:107], v[40:43], v[168:171]
 buffer_load_dwordx4 a[180:183], v7, s[8:11], s89 offen offset:1024 sc1
M v[168:171], a[108:111], v[56:59], v[168:171]
 buffer_load_dwordx4 a[184:187], v7, s[8:11], s89 offen offset:2048 sc1
M v[172:175], a[108:111], v[60:63], v[172:175]
 ds_read_b128 a[80:83], v2 offset:20480
 ds_read_b128 a[84:87], v2 offset:21504
M v[172:175], a[104:107], v[44:47], v[172:175]
 buffer_load_dwordx4 v3, s[8:11], s21 offen offset:3072 sc1 lds
M v[176:179], a[112:115], v[40:43], v[176:179]
 v_exp_f32 v23, v105
M v[176:179], a[116:119], v[56:59], v[176:179]
 ds_read_b128 a[88:91], v2 offset:22528
 ds_read_b128 a[92:95], v2 offset:23552
M v[180:183], a[116:119], v[60:63], v[180:183]
 buffer_load_dwordx4 a[188:191], v7, s[8:11], s89 offen offset:3072 sc1
M v[180:183], a[112:115], v[44:47], v[180:183]
 v_exp_f32 v24, v106
M v[184:187], a[120:123], v[40:43], v[184:187]
 s_add_u32 m0, s28, 36864
 v_exp_f32 v25, v107
M v[184:187], a[124:127], v[56:59], v[184:187]
 buffer_load_dwordx4 v4, s[8:11], s21 offen offset:0 sc1 lds
M v[188:191], a[124:127], v[60:63], v[188:191]
 v_add_f32 v28, v18, v19
 v_cvt_pk_bf16_f32 v48, v18, v19
M v[188:191], a[120:123], v[44:47], v[188:191]
 s_waitcnt lgkmcnt(0)
 buffer_load_dwordx4 v[14:17], v7, s[8:11], s90 offen sc1
M v[192:195], a[64:67], v[40:43], v[192:195]
 ds_read_b128 a[96:99], v2 offset:24576
 ds_read_b128 a[100:103], v2 offset:25600
M v[192:195], a[68:71], v[56:59], v[192:195]
 v_exp_f32 v18, v100
M v[196:199], a[68:71], v[60:63], v[196:199]
 v_exp_f32 v19, v101
M v[196:199], a[64:67], v[44:47], v[196:199]
 ds_read_b128 a[104:107], v2 offset:26624
 ds_read_b128 a[108:111], v2 offset:27648
M v[200:203], a[72:75], v[40:43], v[200:203]
 buffer_load_dwordx4 v4, s[8:11], s21 offen offset:1024 sc1 lds
M v[200:203], a[76:79], v[56:59], v[200:203]
 v_add_f32 v28, v20, v28
 v_cvt_pk_bf16_f32 v49, v20, v21
M v[204:207], a[76:79], v[60:63], v[204:207]
 ds_read_b128 a[112:115], v2 offset:28672
 ds_read_b128 a[116:119], v2 offset:29696
M v[204:207], a[72:75], v[44:47], v[204:207]
 v_add_f32 v28, v21, v28
 v_add_f32 v28, v22, v28
M v[208:211], a[80:83], v[40:43], v[208:211]
 v_exp_f32 v20, v102
M v[208:211], a[84:87], v[56:59], v[208:211]
 ds_read_b128 a[120:123], v2 offset:30720
 ds_read_b128 a[124:127], v2 offset:31744
M v[212:215], a[84:87], v[60:63], v[212:215]
 v_exp_f32 v21, v103
M v[212:215], a[80:83], v[44:47], v[212:215]
 buffer_load_dwordx4 v4, s[8:11], s21 offen offset:2048 sc1 lds
M v[216:219], a[88:91], v[40:43], v[216:219]
 v_cvt_pk_bf16_f32 v50, v22, v23
 v_add_f32 v28, v23, v28
M v[216:219], a[92:95], v[56:59], v[216:219]
 v_exp_f32 v22, v108
M v[220:223], a[92:95], v[60:63], v[220:223]
 s_waitcnt vmcnt(25) lgkmcnt(0)
 v_add_f32 v28, v24, v28
 v_cvt_pk_bf16_f32 v51, v24, v25
M v[220:223], a[88:91], v[44:47], v[220:223]
 s_barrier
M v[224:227], a[96:99], v[40:43], v[224:227]
 ds_read_b128 a[64:67], v2 offset:32768
 ds_read_b128 a[68:71], v2 offset:33792
M v[224:227], a[100:103], v[56:59], v[224:227]
 v_exp_f32 v23, v109
M v[228:231], a[100:103], v[60:63], v[228:231]
 buffer_load_dwordx4 v4, s[8:11], s21 offen offset:3072 sc1 lds
M v[228:231], a[96:99], v[44:47], v[228:231]
 s_add_u32 s21, s21, 32768
 ds_read_b128 a[72:75], v2 offset:34816
 ds_read_b128 a[76:79], v2 offset:35840
M v[232:235], a[104:107], v[40:43], v[232:235]
 s_sub_u32 s22, s22, 1
 v_add_f32 v28, v25, v28
 v_add_f32 v29, v18, v19
M v[232:235], a[108:111], v[56:59], v[232:235]
 s_cmp_eq_u32 s22, 0
 v_exp_f32 v24, v110
M v[236:239], a[108:111], v[60:63], v[236:239]
 s_cselect_b32 s21, s23, s21
 ds_read_b128 a[80:83], v2 offset:36864
 ds_read_b128 a[84:87], v2 offset:37888
M v[236:239], a[104:107], v[44:47], v[236:239]
 s_cselect_b32 s22, s24, s22
 v_exp_f32 v25, v111
M v[240:243], a[112:115], v[40:43], v[240:243]
 s_cselect_b32 s23, s25, s23
 v_cvt_pk_bf16_f32 v52, v18, v19
 v_add_f32 v29, v20, v29
M v[240:243], a[116:119], v[56:59], v[240:243]
 s_cselect_b32 s24, 0x7fff, s24
 ds_read_b128 a[88:91], v2 offset:38912
 ds_read_b128 a[92:95], v2 offset:39936
M v[244:247], a[116:119], v[60:63], v[244:247]
 v_cvt_pk_bf16_f32 v53, v20, v21
 v_add_f32 v29, v21, v29
M v[244:247], a[112:115], v[44:47], v[244:247]
 v_add_f32 v29, v22, v29
 v_cvt_pk_bf16_f32 v54, v22, v23
M v[248:251], a[120:123], v[40:43], v[248:251]
 v_add_f32 v29, v23, v29
 v_add_f32 v29, v24, v29
M v[248:251], a[124:127], v[56:59], v[248:251]
 v_cvt_pk_bf16_f32 v55, v24, v25
 v_add_f32 v29, v25, v29
M v[252:255], a[124:127], v[60:63], v[252:255]
 s_waitcnt lgkmcnt(0)
M v[252:255], a[120:123], v[44:47], v[252:255]
 s_waitcnt vmcnt(17)
 s_barrier
 ds_read_b128 a[64:67], v7 offset:0
 ds_read_b128 a[68:71], v7 offset:1024
 ds_read_b128 a[72:75], v7 offset:2048
 ds_read_b128 a[76:79], v7 offset:3072
 ds_read_b128 a[80:83], v7 offset:4096
 ds_read_b128 a[84:87], v7 offset:5120
 ds_read_b128 a[88:91], v7 offset:6144
 ds_read_b128 a[92:95], v7 offset:7168
 s_waitcnt vmcnt(3)
 v_cmp_neq_f32 vcc, v32, v14
 v_cmp_neq_f32 s[64:65], v36, v15
 s_nop 0
 s_or_b64 vcc, vcc, s[64:65]
 s_cbranch_vccnz L_cg0
 v_add_f32 v30, v16, v30
 v_add_f32 v31, v17, v31
M v[128:131], a[226:229], a[128:131], v[128:131]
 v_exp_f32 v18, v112
M v[136:139], a[224:227], a[128:131], v[136:139]
 v_exp_f32 v19, v113
M v[144:147], a[226:229], a[132:135], v[144:147]
 v_exp_f32 v20, v114
M v[152:155], a[224:227], a[132:135], v[152:155]
 v_add_f32 v28, v18, v28
 v_cvt_pk_bf16_f32 v56, v18, v19
M v[160:163], a[226:229], a[136:139], v[160:163]
 v_exp_f32 v21, v115
M v[168:171], a[224:227], a[136:139], v[168:171]
 v_add_f32 v28, v19, v28
M v[176:179], a[226:229], a[140:143], v[176:179]
 v_exp_f32 v22, v120
M v[184:187], a[224:227], a[140:143], v[184:187]
 v_add_f32 v28, v20, v28
 v_cvt_pk_bf16_f32 v57, v20, v21
M v[192:195], a[226:229], a[144:147], v[192:195]
 v_exp_f32 v23, v121
M v[200:203], a[224:227], a[144:147], v[200:203]
 v_add_f32 v28, v21, v28
M v[208:211], a[226:229], a[148:151], v[208:211]
 v_exp_f32 v24, v122
M v[216:219], a[224:227], a[148:151], v[216:219]
 v_add_f32 v28, v22, v28
 v_cvt_pk_bf16_f32 v58, v22, v23
M v[224:227], a[226:229], a[152:155], v[224:227]
 v_exp_f32 v25, v123
M v[232:235], a[224:227], a[152:155], v[232:235]
 v_add_f32 v28, v23, v28
M v[240:243], a[226:229], a[156:159], v[240:243]
 v_exp_f32 v18, v116
M v[248:251], a[224:227], a[156:159], v[248:251]
 v_add_f32 v28, v24, v28
 v_cvt_pk_bf16_f32 v59, v24, v25
M v[132:135], a[226:229], a[160:163], v[132:135]
 v_exp_f32 v19, v117
M v[140:143], a[224:227], a[160:163], v[140:143]
 v_add_f32 v28, v25, v28
M v[148:151], a[226:229], a[164:167], v[148:151]
 v_exp_f32 v20, v118
M v[156:159], a[224:227], a[164:167], v[156:159]
 v_add_f32 v29, v18, v29
 v_cvt_pk_bf16_f32 v60, v18, v19
M v[164:167], a[226:229], a[168:171], v[164:167]
 v_exp_f32 v21, v119
M v[172:175], a[224:227], a[168:171], v[172:175]
 v_add_f32 v29, v19, v29
M v[180:183], a[226:229], a[172:175], v[180:183]
 v_exp_f32 v22, v124
M v[188:191], a[224:227], a[172:175], v[188:191]
 v_add_f32 v29, v20, v29
 v_cvt_pk_bf16_f32 v61, v20, v21
M v[196:199], a[226:229], a[176:179], v[196:199]
 v_exp_f32 v23, v125
M v[204:207], a[224:227], a[176:179], v[204:207]
 v_add_f32 v29, v21, v29
M v[212:215], a[226:229], a[180:183], v[212:215]
 v_exp_f32 v24, v126
M v[220:223], a[224:227], a[180:183], v[220:223]
 v_add_f32 v29, v22, v29
 v_cvt_pk_bf16_f32 v62, v22, v23
M v[228:231], a[226:229], a[184:187], v[228:231]
 v_exp_f32 v25, v127
M v[236:239], a[224:227], a[184:187], v[236:239]
 v_add_f32 v29, v23, v29
 v_add_f32 v29, v24, v29
M v[244:247], a[226:229], a[188:191], v[244:247]
 v_cvt_pk_bf16_f32 v63, v24, v25
 v_add_f32 v29, v25, v29
M v[252:255], a[224:227], a[188:191], v[252:255]
 s_branch L_final_o2
L_op1:
M v[64:67], a[64:67], v[128:131], 0
 s_add_u32 m0, s28, 0
 ds_read_b128 a[96:99], v2 offset:40960
 ds_read_b128 a[100:103], v2 offset:41984
M v[64:67], a[68:71], v[144:147], v[64:67]
 buffer_load_dwordx4 v3, s[8:11], s38 offen offset:0 sc1 lds
M v[64:67], a[72:75], v[160:163], v[64:67]
M v[64:67], a[76:79], v[176:179], v[64:67]
 s_sub_u32 s64, 15, s42
 ds_read_b128 a[104:107], v2 offset:43008
 ds_read_b128 a[108:111], v2 offset:44032
M v[64:67], a[80:83], v[192:195], v[64:67]
 s_min_u32 s64, s64, s42
M v[64:67], a[84:87], v[208:211], v[64:67]
 s_mul_i32 s45, s64, 8704
M v[64:67], a[88:91], v[224:227], v[64:67]
 s_and_b32 s64, s42, 8
 ds_read_b128 a[112:115], v2 offset:45056
 ds_read_b128 a[116:119], v2 offset:46080
M v[64:67], a[92:95], v[240:243], v[64:67]
 s_lshl_b32 s64, s64, 1
 buffer_load_dwordx4 v3, s[8:11], s38 offen offset:1024 sc1 lds
M v[68:71], a[92:95], v[244:247], 0
 s_add_u32 s64, s64, s41
M v[68:71], a[88:91], v[228:231], v[68:71]
 s_lshl_b32 s64, s64, 2
 ds_read_b128 a[120:123], v2 offset:47104
 ds_read_b128 a[124:127], v2 offset:48128
M v[68:71], a[84:87], v[212:215], v[68:71]
 s_add_u32 s45, s45, s64
M v[68:71], a[80:83], v[196:199], v[68:71]
 s_add_u32 s45, s45, 104992768
M v[68:71], a[76:79], v[180:183], v[68:71]
 s_lshl_b32 s64, s20, 8
 buffer_load_dwordx4 v3, s[8:11], s38 offen offset:2048 sc1 lds
M v[68:71], a[72:75], v[164:167], v[68:71]
 s_add_u32 s45, s45, s64
M v[68:71], a[68:71], v[148:151], v[68:71]
 s_add_u32 s3, s45, 4352
 v_lshrrev_b32 v17, 5, v7
 v_min_u32 v17, 1, v17
M v[68:71], a[64:67], v[132:135], v[68:71]
 s_waitcnt lgkmcnt(0)
 v_lshlrev_b32 v16, 3, v7
 v_lshl_or_b32 v16, v17, 29, v16
M v[72:75], a[96:99], v[128:131], 0
 ds_read_b128 a[64:67], v2 offset:49152
 ds_read_b128 a[68:71], v2 offset:50176
M v[72:75], a[100:103], v[144:147], v[72:75]
 buffer_load_dwordx4 v3, s[8:11], s38 offen offset:3072 sc1 lds
M v[72:75], a[104:107], v[160:163], v[72:75]
 v_mov_b32 v15, 1
M v[72:75], a[108:111], v[176:179], v[72:75]
 s_mov_b32 s79, 104923136
 ds_read_b128 a[72:75], v2 offset:51200
 ds_read_b128 a[76:79], v2 offset:52224
M v[72:75], a[112:115], v[192:195], v[72:75]
 buffer_load_dword v24, off, s[8:11], s79 sc1
M v[72:75], a[116:119], v[208:211], v[72:75]
 v_lshrrev_b32 v0, 4, v7
 v_and_b32 v14, 15, v0
M v[72:75], a[120:123], v[224:227], v[72:75]
 s_add_u32 m0, s28, 4096
 ds_read_b128 a[80:83], v2 offset:53248
 ds_read_b128 a[84:87], v2 offset:54272
M v[72:75], a[124:127], v[240:243], v[72:75]
 buffer_load_dwordx4 v4, s[8:11], s38 offen offset:0 sc1 lds
M v[76:79], a[124:127], v[244:247], 0
 v_lshlrev_b32 v14, 2, v14
 v_lshrrev_b32 v11, 4, v0
M v[76:79], a[120:123], v[228:231], v[76:79]
 s_mov_b32 s52, s96
 ds_read_b128 a[88:91], v2 offset:55296
 ds_read_b128 a[92:95], v2 offset:56320
M v[76:79], a[116:119], v[212:215], v[76:79]
 s_and_b32 s53, s97, 0xffff
M v[76:79], a[112:115], v[196:199], v[76:79]
 s_mov_b32 s54, 1835008
M v[76:79], a[108:111], v[180:183], v[76:79]
 s_mov_b32 s55, 0x20000
 buffer_load_dwordx4 v4, s[8:11], s38 offen offset:1024 sc1 lds
M v[76:79], a[104:107], v[164:167], v[76:79]
 s_lshr_b32 s74, s41, 3
M v[76:79], a[100:103], v[148:151], v[76:79]
 s_xor_b32 s74, s74, 0
 s_mul_i32 s67, s74, -2
 s_mul_i32 s74, s74, 8
M v[76:79], a[96:99], v[132:135], v[76:79]
 s_waitcnt lgkmcnt(0)
 s_add_u32 s74, s74, s20
M v[80:83], a[64:67], v[128:131], 0
 s_lshl_b32 s75, s74, 6
 ds_read_b128 a[96:99], v2 offset:57344
 ds_read_b128 a[100:103], v2 offset:58368
M v[80:83], a[68:71], v[144:147], v[80:83]
 s_add_u32 s76, s75, 256
M v[80:83], a[72:75], v[160:163], v[80:83]
 s_add_u32 s67, s67, 3
 buffer_load_dwordx4 v4, s[8:11], s38 offen offset:2048 sc1 lds
M v[80:83], a[76:79], v[176:179], v[80:83]
 s_sub_u32 s67, s67, s20
 ds_read_b128 a[104:107], v2 offset:59392
 ds_read_b128 a[108:111], v2 offset:60416
M v[80:83], a[80:83], v[192:195], v[80:83]
 s_and_b32 s67, s67, 536870912
M v[80:83], a[84:87], v[208:211], v[80:83]
 s_or_b32 s76, s76, s67
 v_or_b32 v27, s67, v7
 v_add_u32 v27, 4096, v27
M v[80:83], a[88:91], v[224:227], v[80:83]
 ds_read_b128 a[112:115], v2 offset:61440
 ds_read_b128 a[116:119], v2 offset:62464
M v[80:83], a[92:95], v[240:243], v[80:83]
 buffer_load_dwordx4 v4, s[8:11], s38 offen offset:3072 sc1 lds
M v[84:87], a[92:95], v[244:247], 0
 s_add_u32 s38, s38, 32768
M v[84:87], a[88:91], v[228:231], v[84:87]
 ds_read_b128 a[120:123], v2 offset:63488
 ds_read_b128 a[124:127], v2 offset:64512
M v[84:87], a[84:87], v[212:215], v[84:87]
M v[84:87], a[80:83], v[196:199], v[84:87]
M v[84:87], a[76:79], v[180:183], v[84:87]
M v[84:87], a[72:75], v[164:167], v[84:87]
M v[84:87], a[68:71], v[148:151], v[84:87]
 s_waitcnt vmcnt(17) lgkmcnt(0)
M v[84:87], a[64:67], v[132:135], v[84:87]
 s_barrier
M v[88:91], a[96:99], v[128:131], 0
 ds_read_b128 a[64:67], v7 offset:32768
 ds_read_b128 a[68:71], v7 offset:33792
M v[88:91], a[100:103], v[144:147], v[88:91]
M v[88:91], a[104:107], v[160:163], v[88:91]
M v[88:91], a[108:111], v[176:179], v[88:91]
 ds_read_b128 a[72:75], v7 offset:34816
 ds_read_b128 a[76:79], v7 offset:35840
M v[88:91], a[112:115], v[192:195], v[88:91]
M v[88:91], a[116:119], v[208:211], v[88:91]
M v[88:91], a[120:123], v[224:227], v[88:91]
 ds_read_b128 a[80:83], v7 offset:36864
 ds_read_b128 a[84:87], v7 offset:37888
M v[88:91], a[124:127], v[240:243], v[88:91]
M v[92:95], a[124:127], v[244:247], 0
M v[92:95], a[120:123], v[228:231], v[92:95]
 ds_read_b128 a[88:91], v7 offset:38912
 ds_read_b128 a[92:95], v7 offset:39936
M v[92:95], a[116:119], v[212:215], v[92:95]
M v[92:95], a[112:115], v[196:199], v[92:95]
M v[92:95], a[108:111], v[180:183], v[92:95]
M v[92:95], a[104:107], v[164:167], v[92:95]
M v[92:95], a[100:103], v[148:151], v[92:95]
 s_waitcnt lgkmcnt(0)
M v[92:95], a[96:99], v[132:135], v[92:95]
M v[96:99], a[64:67], v[128:131], 0
 s_add_u32 m0, s28, 98304
 ds_read_b128 a[96:99], v7 offset:40960
 ds_read_b128 a[100:103], v7 offset:41984
M v[96:99], a[68:71], v[144:147], v[96:99]
 buffer_load_dwordx4 v3, s[8:11], s38 offen offset:0 sc1 lds
M v[96:99], a[72:75], v[160:163], v[96:99]
M v[96:99], a[76:79], v[176:179], v[96:99]
 ds_read_b128 a[104:107], v7 offset:43008
 ds_read_b128 a[108:111], v7 offset:44032
M v[96:99], a[80:83], v[192:195], v[96:99]
 s_add_u32 s29, s33, 0
 s_add_u32 s30, s33, 14336
M v[96:99], a[84:87], v[208:211], v[96:99]
 v_mul_f32 v64, v5, v64
 v_mul_f32 v65, v5, v65
M v[96:99], a[88:91], v[224:227], v[96:99]
 ds_read_b128 a[112:115], v7 offset:45056
 ds_read_b128 a[116:119], v7 offset:46080
M v[96:99], a[92:95], v[240:243], v[96:99]
 buffer_load_dwordx4 v3, s[8:11], s38 offen offset:1024 sc1 lds
M v[100:103], a[92:95], v[244:247], 0
 v_mul_f32 v66, v5, v66
 v_mul_f32 v67, v5, v67
M v[100:103], a[88:91], v[228:231], v[100:103]
 ds_read_b128 a[120:123], v7 offset:47104
 ds_read_b128 a[124:127], v7 offset:48128
M v[100:103], a[84:87], v[212:215], v[100:103]
 v_mul_f32 v72, v5, v72
 v_mul_f32 v73, v5, v73
M v[100:103], a[80:83], v[196:199], v[100:103]
 v_mul_f32 v74, v5, v74
 v_mul_f32 v75, v5, v75
M v[100:103], a[76:79], v[180:183], v[100:103]
 buffer_load_dwordx4 v3, s[8:11], s38 offen offset:2048 sc1 lds
M v[100:103], a[72:75], v[164:167], v[100:103]
 v_cvt_pk_bf16_f32 v64, v64, v65
 v_cvt_pk_bf16_f32 v65, v66, v67
M v[100:103], a[68:71], v[148:151], v[100:103]
 v_cvt_pk_bf16_f32 v66, v72, v73
M v[100:103], a[64:67], v[132:135], v[100:103]
 s_waitcnt lgkmcnt(0)
 v_cvt_pk_bf16_f32 v67, v74, v75
M v[104:107], a[96:99], v[128:131], 0
 ds_read_b128 a[64:67], v7 offset:49152
 ds_read_b128 a[68:71], v7 offset:50176
M v[104:107], a[100:103], v[144:147], v[104:107]
 buffer_load_dwordx4 v3, s[8:11], s38 offen offset:3072 sc1 lds
M v[104:107], a[104:107], v[160:163], v[104:107]
 buffer_store_dwordx4 v[64:67], v7, s[8:11], s29 offen offset:0 sc1
M v[104:107], a[108:111], v[176:179], v[104:107]
 ds_read_b128 a[72:75], v7 offset:51200
 ds_read_b128 a[76:79], v7 offset:52224
M v[104:107], a[112:115], v[192:195], v[104:107]
 v_mul_f32 v68, v6, v68
 v_mul_f32 v69, v6, v69
M v[104:107], a[116:119], v[208:211], v[104:107]
 v_mul_f32 v70, v6, v70
 v_mul_f32 v71, v6, v71
M v[104:107], a[120:123], v[224:227], v[104:107]
 s_add_u32 m0, s28, 102400
 ds_read_b128 a[80:83], v7 offset:53248
 ds_read_b128 a[84:87], v7 offset:54272
M v[104:107], a[124:127], v[240:243], v[104:107]
 buffer_load_dwordx4 v4, s[8:11], s38 offen offset:0 sc1 lds
M v[108:111], a[124:127], v[244:247], 0
 v_mul_f32 v76, v6, v76
 v_mul_f32 v77, v6, v77
M v[108:111], a[120:123], v[228:231], v[108:111]
 ds_read_b128 a[88:91], v7 offset:55296
 ds_read_b128 a[92:95], v7 offset:56320
M v[108:111], a[116:119], v[212:215], v[108:111]
 v_mul_f32 v78, v6, v78
 v_mul_f32 v79, v6, v79
M v[108:111], a[112:115], v[196:199], v[108:111]
 v_cvt_pk_bf16_f32 v68, v68, v69
 v_cvt_pk_bf16_f32 v69, v70, v71
M v[108:111], a[108:111], v[180:183], v[108:111]
 buffer_load_dwordx4 v4, s[8:11], s38 offen offset:1024 sc1 lds
M v[108:111], a[104:107], v[164:167], v[108:111]
 v_cvt_pk_bf16_f32 v70, v76, v77
 v_cvt_pk_bf16_f32 v71, v78, v79
M v[108:111], a[100:103], v[148:151], v[108:111]
M v[108:111], a[96:99], v[132:135], v[108:111]
 s_waitcnt lgkmcnt(0)
 buffer_store_dwordx4 v[68:71], v7, s[8:11], s30 offen offset:0 sc1
M v[112:115], a[64:67], v[128:131], 0
 ds_read_b128 a[96:99], v7 offset:57344
 ds_read_b128 a[100:103], v7 offset:58368
M v[112:115], a[68:71], v[144:147], v[112:115]
 v_mul_f32 v80, v5, v80
 v_mul_f32 v81, v5, v81
M v[112:115], a[72:75], v[160:163], v[112:115]
 buffer_load_dwordx4 v4, s[8:11], s38 offen offset:2048 sc1 lds
M v[112:115], a[76:79], v[176:179], v[112:115]
 ds_read_b128 a[104:107], v7 offset:59392
 ds_read_b128 a[108:111], v7 offset:60416
M v[112:115], a[80:83], v[192:195], v[112:115]
 v_mul_f32 v82, v5, v82
 v_mul_f32 v83, v5, v83
M v[112:115], a[84:87], v[208:211], v[112:115]
 v_mul_f32 v88, v5, v88
 v_mul_f32 v89, v5, v89
M v[112:115], a[88:91], v[224:227], v[112:115]
 ds_read_b128 a[112:115], v7 offset:61440
 ds_read_b128 a[116:119], v7 offset:62464
M v[112:115], a[92:95], v[240:243], v[112:115]
 buffer_load_dwordx4 v4, s[8:11], s38 offen offset:3072 sc1 lds
M v[116:119], a[92:95], v[244:247], 0
 s_add_u32 s38, s38, 32768
 v_mul_f32 v90, v5, v90
 v_mul_f32 v91, v5, v91
M v[116:119], a[88:91], v[228:231], v[116:119]
 ds_read_b128 a[120:123], v7 offset:63488
 ds_read_b128 a[124:127], v7 offset:64512
M v[116:119], a[84:87], v[212:215], v[116:119]
 v_cvt_pk_bf16_f32 v80, v80, v81
 v_cvt_pk_bf16_f32 v81, v82, v83
M v[116:119], a[80:83], v[196:199], v[116:119]
 v_cvt_pk_bf16_f32 v82, v88, v89
 v_cvt_pk_bf16_f32 v83, v90, v91
M v[116:119], a[76:79], v[180:183], v[116:119]
 buffer_store_dwordx4 v[80:83], v7, s[8:11], s29 offen offset:1024 sc1
M v[116:119], a[72:75], v[164:167], v[116:119]
 v_mul_f32 v84, v6, v84
 v_mul_f32 v85, v6, v85
M v[116:119], a[68:71], v[148:151], v[116:119]
 s_waitcnt vmcnt(20) lgkmcnt(0)
 v_mul_f32 v86, v6, v86
M v[116:119], a[64:67], v[132:135], v[116:119]
 s_barrier
M v[120:123], a[96:99], v[128:131], 0
 ds_read_b128 a[64:67], v2 offset:0
 ds_read_b128 a[68:71], v2 offset:1024
M v[120:123], a[100:103], v[144:147], v[120:123]
 v_mul_f32 v87, v6, v87
 v_mul_f32 v92, v6, v92
M v[120:123], a[104:107], v[160:163], v[120:123]
 v_mul_f32 v93, v6, v93
 v_mul_f32 v94, v6, v94
M v[120:123], a[108:111], v[176:179], v[120:123]
 ds_read_b128 a[72:75], v2 offset:2048
 ds_read_b128 a[76:79], v2 offset:3072
M v[120:123], a[112:115], v[192:195], v[120:123]
 v_mul_f32 v95, v6, v95
 v_cvt_pk_bf16_f32 v84, v84, v85
M v[120:123], a[116:119], v[208:211], v[120:123]
 v_cvt_pk_bf16_f32 v85, v86, v87
M v[120:123], a[120:123], v[224:227], v[120:123]
 ds_read_b128 a[80:83], v2 offset:4096
 ds_read_b128 a[84:87], v2 offset:5120
M v[120:123], a[124:127], v[240:243], v[120:123]
 v_cvt_pk_bf16_f32 v86, v92, v93
 v_cvt_pk_bf16_f32 v87, v94, v95
M v[124:127], a[124:127], v[244:247], 0
 buffer_store_dwordx4 v[84:87], v7, s[8:11], s30 offen offset:1024 sc1
M v[124:127], a[120:123], v[228:231], v[124:127]
 ds_read_b128 a[88:91], v2 offset:6144
 ds_read_b128 a[92:95], v2 offset:7168
M v[124:127], a[116:119], v[212:215], v[124:127]
M v[124:127], a[112:115], v[196:199], v[124:127]
M v[124:127], a[108:111], v[180:183], v[124:127]
M v[124:127], a[104:107], v[164:167], v[124:127]
M v[124:127], a[100:103], v[148:151], v[124:127]
 s_waitcnt lgkmcnt(0)
M v[124:127], a[96:99], v[132:135], v[124:127]
M v[64:67], a[64:67], v[128:131], 0
 s_add_u32 m0, s28, 32768
 ds_read_b128 a[96:99], v2 offset:8192
 ds_read_b128 a[100:103], v2 offset:9216
M v[64:67], a[68:71], v[144:147], v[64:67]
 buffer_load_dwordx4 v3, s[8:11], s38 offen offset:0 sc1 lds
M v[64:67], a[72:75], v[160:163], v[64:67]
M v[64:67], a[76:79], v[176:179], v[64:67]
 ds_read_b128 a[104:107], v2 offset:10240
 ds_read_b128 a[108:111], v2 offset:11264
M v[64:67], a[80:83], v[192:195], v[64:67]
 s_add_u32 s29, s33, 2048
 s_add_u32 s30, s33, 16384
M v[64:67], a[84:87], v[208:211], v[64:67]
 v_mul_f32 v96, v5, v96
 v_mul_f32 v97, v5, v97
M v[64:67], a[88:91], v[224:227], v[64:67]
 ds_read_b128 a[112:115], v2 offset:12288
 ds_read_b128 a[116:119], v2 offset:13312
M v[64:67], a[92:95], v[240:243], v[64:67]
 buffer_load_dwordx4 v3, s[8:11], s38 offen offset:1024 sc1 lds
M v[68:71], a[92:95], v[244:247], 0
 v_mul_f32 v98, v5, v98
 v_mul_f32 v99, v5, v99
M v[68:71], a[88:91], v[228:231], v[68:71]
 ds_read_b128 a[120:123], v2 offset:14336
 ds_read_b128 a[124:127], v2 offset:15360
M v[68:71], a[84:87], v[212:215], v[68:71]
 v_mul_f32 v104, v5, v104
 v_mul_f32 v105, v5, v105
M v[68:71], a[80:83], v[196:199], v[68:71]
 v_mul_f32 v106, v5, v106
 v_mul_f32 v107, v5, v107
M v[68:71], a[76:79], v[180:183], v[68:71]
 buffer_load_dwordx4 v3, s[8:11], s38 offen offset:2048 sc1 lds
M v[68:71], a[72:75], v[164:167], v[68:71]
 v_cvt_pk_bf16_f32 v96, v96, v97
 v_cvt_pk_bf16_f32 v97, v98, v99
M v[68:71], a[68:71], v[148:151], v[68:71]
 v_cvt_pk_bf16_f32 v98, v104, v105
M v[68:71], a[64:67], v[132:135], v[68:71]
 s_waitcnt lgkmcnt(0)
 v_cvt_pk_bf16_f32 v99, v106, v107
M v[72:75], a[96:99], v[128:131], 0
 ds_read_b128 a[64:67], v2 offset:16384
 ds_read_b128 a[68:71], v2 offset:17408
M v[72:75], a[100:103], v[144:147], v[72:75]
 buffer_load_dwordx4 v3, s[8:11], s38 offen offset:3072 sc1 lds
M v[72:75], a[104:107], v[160:163], v[72:75]
 buffer_store_dwordx4 v[96:99], v7, s[8:11], s29 offen offset:0 sc1
M v[72:75], a[108:111], v[176:179], v[72:75]
 ds_read_b128 a[72:75], v2 offset:18432
 ds_read_b128 a[76:79], v2 offset:19456
M v[72:75], a[112:115], v[192:195], v[72:75]
 v_mul_f32 v100, v6, v100
 v_mul_f32 v101, v6, v101
M v[72:75], a[116:119], v[208:211], v[72:75]
 v_mul_f32 v102, v6, v102
 v_mul_f32 v103, v6, v103
M v[72:75], a[120:123], v[224:227], v[72:75]
 s_add_u32 m0, s28, 36864
 ds_read_b128 a[80:83], v2 offset:20480
 ds_read_b128 a[84:87], v2 offset:21504
M v[72:75], a[124:127], v[240:243], v[72:75]
 buffer_load_dwordx4 v4, s[8:11], s38 offen offset:0 sc1 lds
M v[76:79], a[124:127], v[244:247], 0
 v_mul_f32 v108, v6, v108
 v_mul_f32 v109, v6, v109
M v[76:79], a[120:123], v[228:231], v[76:79]
 ds_read_b128 a[88:91], v2 offset:22528
 ds_read_b128 a[92:95], v2 offset:23552
M v[76:79], a[116:119], v[212:215], v[76:79]
 v_mul_f32 v110, v6, v110
 v_mul_f32 v111, v6, v111
M v[76:79], a[112:115], v[196:199], v[76:79]
 v_cvt_pk_bf16_f32 v100, v100, v101
 v_cvt_pk_bf16_f32 v101, v102, v103
M v[76:79], a[108:111], v[180:183], v[76:79]
 buffer_load_dwordx4 v4, s[8:11], s38 offen offset:1024 sc1 lds
M v[76:79], a[104:107], v[164:167], v[76:79]
 v_cvt_pk_bf16_f32 v102, v108, v109
 v_cvt_pk_bf16_f32 v103, v110, v111
M v[76:79], a[100:103], v[148:151], v[76:79]
M v[76:79], a[96:99], v[132:135], v[76:79]
 s_waitcnt lgkmcnt(0)
 buffer_store_dwordx4 v[100:103], v7, s[8:11], s30 offen offset:0 sc1
M v[80:83], a[64:67], v[128:131], 0
 ds_read_b128 a[96:99], v2 offset:24576
 ds_read_b128 a[100:103], v2 offset:25600
M v[80:83], a[68:71], v[144:147], v[80:83]
 v_mul_f32 v112, v5, v112
 v_mul_f32 v113, v5, v113
M v[80:83], a[72:75], v[160:163], v[80:83]
 buffer_load_dwordx4 v4, s[8:11], s38 offen offset:2048 sc1 lds
M v[80:83], a[76:79], v[176:179], v[80:83]
 ds_read_b128 a[104:107], v2 offset:26624
 ds_read_b128 a[108:111], v2 offset:27648
M v[80:83], a[80:83], v[192:195], v[80:83]
 v_mul_f32 v114, v5, v114
 v_mul_f32 v115, v5, v115
M v[80:83], a[84:87], v[208:211], v[80:83]
 v_mul_f32 v120, v5, v120
 v_mul_f32 v121, v5, v121
M v[80:83], a[88:91], v[224:227], v[80:83]
 ds_read_b128 a[112:115], v2 offset:28672
 ds_read_b128 a[116:119], v2 offset:29696
M v[80:83], a[92:95], v[240:243], v[80:83]
 buffer_load_dwordx4 v4, s[8:11], s38 offen offset:3072 sc1 lds
M v[84:87], a[92:95], v[244:247], 0
 s_add_u32 s38, s38, 32768
 v_mul_f32 v122, v5, v122
 v_mul_f32 v123, v5, v123
M v[84:87], a[88:91], v[228:231], v[84:87]
 ds_read_b128 a[120:123], v2 offset:30720
 ds_read_b128 a[124:127], v2 offset:31744
M v[84:87], a[84:87], v[212:215], v[84:87]
 v_cvt_pk_bf16_f32 v112, v112, v113
 v_cvt_pk_bf16_f32 v113, v114, v115
M v[84:87], a[80:83], v[196:199], v[84:87]
 v_cvt_pk_bf16_f32 v114, v120, v121
 v_cvt_pk_bf16_f32 v115, v122, v123
M v[84:87], a[76:79], v[180:183], v[84:87]
 buffer_store_dwordx4 v[112:115], v7, s[8:11], s29 offen offset:1024 sc1
M v[84:87], a[72:75], v[164:167], v[84:87]
 v_mul_f32 v116, v6, v116
 v_mul_f32 v117, v6, v117
M v[84:87], a[68:71], v[148:151], v[84:87]
 s_waitcnt vmcnt(23) lgkmcnt(0)
 v_mul_f32 v118, v6, v118
M v[84:87], a[64:67], v[132:135], v[84:87]
 s_barrier
M v[88:91], a[96:99], v[128:131], 0
 ds_read_b128 a[64:67], v7 offset:0
 ds_read_b128 a[68:71], v7 offset:1024
M v[88:91], a[100:103], v[144:147], v[88:91]
 v_mul_f32 v119, v6, v119
 v_mul_f32 v124, v6, v124
M v[88:91], a[104:107], v[160:163], v[88:91]
 v_mul_f32 v125, v6, v125
 v_mul_f32 v126, v6, v126
M v[88:91], a[108:111], v[176:179], v[88:91]
 ds_read_b128 a[72:75], v7 offset:2048
 ds_read_b128 a[76:79], v7 offset:3072
M v[88:91], a[112:115], v[192:195], v[88:91]
 v_mul_f32 v127, v6, v127
 v_cvt_pk_bf16_f32 v116, v116, v117
M v[88:91], a[116:119], v[208:211], v[88:91]
 v_cvt_pk_bf16_f32 v117, v118, v119
M v[88:91], a[120:123], v[224:227], v[88:91]
 ds_read_b128 a[80:83], v7 offset:4096
 ds_read_b128 a[84:87], v7 offset:5120
M v[88:91], a[124:127], v[240:243], v[88:91]
 v_cvt_pk_bf16_f32 v118, v124, v125
 v_cvt_pk_bf16_f32 v119, v126, v127
M v[92:95], a[124:127], v[244:247], 0
 buffer_store_dwordx4 v[116:119], v7, s[8:11], s30 offen offset:1024 sc1
M v[92:95], a[120:123], v[228:231], v[92:95]
 ds_read_b128 a[88:91], v7 offset:6144
 ds_read_b128 a[92:95], v7 offset:7168
M v[92:95], a[116:119], v[212:215], v[92:95]
M v[92:95], a[112:115], v[196:199], v[92:95]
M v[92:95], a[108:111], v[180:183], v[92:95]
M v[92:95], a[104:107], v[164:167], v[92:95]
M v[92:95], a[100:103], v[148:151], v[92:95]
 s_waitcnt lgkmcnt(0)
M v[92:95], a[96:99], v[132:135], v[92:95]
M v[96:99], a[64:67], v[128:131], 0
 s_add_u32 m0, s28, 65536
 ds_read_b128 a[96:99], v7 offset:8192
 ds_read_b128 a[100:103], v7 offset:9216
M v[96:99], a[68:71], v[144:147], v[96:99]
 buffer_load_dwordx4 v3, s[8:11], s38 offen offset:0 sc1 lds
M v[96:99], a[72:75], v[160:163], v[96:99]
M v[96:99], a[76:79], v[176:179], v[96:99]
 ds_read_b128 a[104:107], v7 offset:10240
 ds_read_b128 a[108:111], v7 offset:11264
M v[96:99], a[80:83], v[192:195], v[96:99]
 s_add_u32 s29, s33, 4096
 s_add_u32 s30, s33, 18432
M v[96:99], a[84:87], v[208:211], v[96:99]
 v_mul_f32 v64, v5, v64
 v_mul_f32 v65, v5, v65
M v[96:99], a[88:91], v[224:227], v[96:99]
 ds_read_b128 a[112:115], v7 offset:12288
 ds_read_b128 a[116:119], v7 offset:13312
M v[96:99], a[92:95], v[240:243], v[96:99]
 buffer_load_dwordx4 v3, s[8:11], s38 offen offset:1024 sc1 lds
M v[100:103], a[92:95], v[244:247], 0
 v_mul_f32 v66, v5, v66
 v_mul_f32 v67, v5, v67
M v[100:103], a[88:91], v[228:231], v[100:103]
 ds_read_b128 a[120:123], v7 offset:14336
 ds_read_b128 a[124:127], v7 offset:15360
M v[100:103], a[84:87], v[212:215], v[100:103]
 v_mul_f32 v72, v5, v72
 v_mul_f32 v73, v5, v73
M v[100:103], a[80:83], v[196:199], v[100:103]
 v_mul_f32 v74, v5, v74
 v_mul_f32 v75, v5, v75
M v[100:103], a[76:79], v[180:183], v[100:103]
 buffer_load_dwordx4 v3, s[8:11], s38 offen offset:2048 sc1 lds
M v[100:103], a[72:75], v[164:167], v[100:103]
 v_cvt_pk_bf16_f32 v64, v64, v65
 v_cvt_pk_bf16_f32 v65, v66, v67
M v[100:103], a[68:71], v[148:151], v[100:103]
 v_cvt_pk_bf16_f32 v66, v72, v73
M v[100:103], a[64:67], v[132:135], v[100:103]
 s_waitcnt lgkmcnt(0)
 v_cvt_pk_bf16_f32 v67, v74, v75
M v[104:107], a[96:99], v[128:131], 0
 ds_read_b128 a[64:67], v7 offset:16384
 ds_read_b128 a[68:71], v7 offset:17408
M v[104:107], a[100:103], v[144:147], v[104:107]
 buffer_load_dwordx4 v3, s[8:11], s38 offen offset:3072 sc1 lds
M v[104:107], a[104:107], v[160:163], v[104:107]
 buffer_store_dwordx4 v[64:67], v7, s[8:11], s29 offen offset:0 sc1
M v[104:107], a[108:111], v[176:179], v[104:107]
 ds_read_b128 a[72:75], v7 offset:18432
 ds_read_b128 a[76:79], v7 offset:19456
M v[104:107], a[112:115], v[192:195], v[104:107]
 v_mul_f32 v68, v6, v68
 v_mul_f32 v69, v6, v69
M v[104:107], a[116:119], v[208:211], v[104:107]
 v_mul_f32 v70, v6, v70
 v_mul_f32 v71, v6, v71
M v[104:107], a[120:123], v[224:227], v[104:107]
 s_add_u32 m0, s28, 69632
 ds_read_b128 a[80:83], v7 offset:20480
 ds_read_b128 a[84:87], v7 offset:21504
M v[104:107], a[124:127], v[240:243], v[104:107]
 buffer_load_dwordx4 v4, s[8:11], s38 offen offset:0 sc1 lds
M v[108:111], a[124:127], v[244:247], 0
 v_mul_f32 v76, v6, v76
 v_mul_f32 v77, v6, v77
M v[108:111], a[120:123], v[228:231], v[108:111]
 ds_read_b128 a[88:91], v7 offset:22528
 ds_read_b128 a[92:95], v7 offset:23552
M v[108:111], a[116:119], v[212:215], v[108:111]
 v_mul_f32 v78, v6, v78
 v_mul_f32 v79, v6, v79
M v[108:111], a[112:115], v[196:199], v[108:111]
 v_cvt_pk_bf16_f32 v68, v68, v69
 v_cvt_pk_bf16_f32 v69, v70, v71
M v[108:111], a[108:111], v[180:183], v[108:111]
 buffer_load_dwordx4 v4, s[8:11], s38 offen offset:1024 sc1 lds
M v[108:111], a[104:107], v[164:167], v[108:111]
 v_cvt_pk_bf16_f32 v70, v76, v77
 v_cvt_pk_bf16_f32 v71, v78, v79
M v[108:111], a[100:103], v[148:151], v[108:111]
M v[108:111], a[96:99], v[132:135], v[108:111]
 s_waitcnt lgkmcnt(0)
 buffer_store_dwordx4 v[68:71], v7, s[8:11], s30 offen offset:0 sc1
M v[112:115], a[64:67], v[128:131], 0
 ds_read_b128 a[96:99], v7 offset:24576
 ds_read_b128 a[100:103], v7 offset:25600
M v[112:115], a[68:71], v[144:147], v[112:115]
 v_mul_f32 v80, v5, v80
 v_mul_f32 v81, v5, v81
M v[112:115], a[72:75], v[160:163], v[112:115]
 buffer_load_dwordx4 v4, s[8:11], s38 offen offset:2048 sc1 lds
M v[112:115], a[76:79], v[176:179], v[112:115]
 ds_read_b128 a[104:107], v7 offset:26624
 ds_read_b128 a[108:111], v7 offset:27648
M v[112:115], a[80:83], v[192:195], v[112:115]
 v_mul_f32 v82, v5, v82
 v_mul_f32 v83, v5, v83
M v[112:115], a[84:87], v[208:211], v[112:115]
 v_mul_f32 v88, v5, v88
 v_mul_f32 v89, v5, v89
M v[112:115], a[88:91], v[224:227], v[112:115]
 ds_read_b128 a[112:115], v7 offset:28672
 ds_read_b128 a[116:119], v7 offset:29696
M v[112:115], a[92:95], v[240:243], v[112:115]
 buffer_load_dwordx4 v4, s[8:11], s38 offen offset:3072 sc1 lds
M v[116:119], a[92:95], v[244:247], 0
 s_add_u32 s38, s38, 32768
 v_mul_f32 v90, v5, v90
 v_mul_f32 v91, v5, v91
M v[116:119], a[88:91], v[228:231], v[116:119]
 ds_read_b128 a[120:123], v7 offset:30720
 ds_read_b128 a[124:127], v7 offset:31744
M v[116:119], a[84:87], v[212:215], v[116:119]
 v_cvt_pk_bf16_f32 v80, v80, v81
 v_cvt_pk_bf16_f32 v81, v82, v83
M v[116:119], a[80:83], v[196:199], v[116:119]
 v_cvt_pk_bf16_f32 v82, v88, v89
 v_cvt_pk_bf16_f32 v83, v90, v91
M v[116:119], a[76:79], v[180:183], v[116:119]
 buffer_store_dwordx4 v[80:83], v7, s[8:11], s29 offen offset:1024 sc1
M v[116:119], a[72:75], v[164:167], v[116:119]
 v_mul_f32 v84, v6, v84
 v_mul_f32 v85, v6, v85
M v[116:119], a[68:71], v[148:151], v[116:119]
 s_waitcnt vmcnt(25) lgkmcnt(0)
 v_mul_f32 v86, v6, v86
M v[116:119], a[64:67], v[132:135], v[116:119]
 s_barrier
M v[120:123], a[96:99], v[128:131], 0
 ds_read_b128 a[64:67], v2 offset:32768
 ds_read_b128 a[68:71], v2 offset:33792
M v[120:123], a[100:103], v[144:147], v[120:123]
 v_mul_f32 v87, v6, v87
 v_mul_f32 v92, v6, v92
M v[120:123], a[104:107], v[160:163], v[120:123]
 v_mul_f32 v93, v6, v93
 v_mul_f32 v94, v6, v94
M v[120:123], a[108:111], v[176:179], v[120:123]
 ds_read_b128 a[72:75], v2 offset:34816
 ds_read_b128 a[76:79], v2 offset:35840
M v[120:123], a[112:115], v[192:195], v[120:123]
 v_mul_f32 v95, v6, v95
 v_cvt_pk_bf16_f32 v84, v84, v85
M v[120:123], a[116:119], v[208:211], v[120:123]
 v_cvt_pk_bf16_f32 v85, v86, v87
M v[120:123], a[120:123], v[224:227], v[120:123]
 ds_read_b128 a[80:83], v2 offset:36864
 ds_read_b128 a[84:87], v2 offset:37888
M v[120:123], a[124:127], v[240:243], v[120:123]
 v_cvt_pk_bf16_f32 v86, v92, v93
 v_cvt_pk_bf16_f32 v87, v94, v95
M v[124:127], a[124:127], v[244:247], 0
 buffer_store_dwordx4 v[84:87], v7, s[8:11], s30 offen offset:1024 sc1
M v[124:127], a[120:123], v[228:231], v[124:127]
 ds_read_b128 a[88:91], v2 offset:38912
 ds_read_b128 a[92:95], v2 offset:39936
M v[124:127], a[116:119], v[212:215], v[124:127]
M v[124:127], a[112:115], v[196:199], v[124:127]
M v[124:127], a[108:111], v[180:183], v[124:127]
M v[124:127], a[104:107], v[164:167], v[124:127]
M v[124:127], a[100:103], v[148:151], v[124:127]
 s_waitcnt lgkmcnt(0)
M v[124:127], a[96:99], v[132:135], v[124:127]
M v[64:67], a[64:67], v[128:131], 0
 ds_read_b128 a[96:99], v2 offset:40960
 ds_read_b128 a[100:103], v2 offset:41984
M v[64:67], a[68:71], v[144:147], v[64:67]
M v[64:67], a[72:75], v[160:163], v[64:67]
 v_cmp_gt_u32 vcc, 4, v24
M v[64:67], a[76:79], v[176:179], v[64:67]
 s_mov_b32 s65, 104890368
 ds_read_b128 a[104:107], v2 offset:43008
 ds_read_b128 a[108:111], v2 offset:44032
M v[64:67], a[80:83], v[192:195], v[64:67]
 s_cbranch_vccnz L_fhs1
L_fhr1:
 buffer_load_dword v25, v14, s[8:11], s65 offen sc1
M v[64:67], a[84:87], v[208:211], v[64:67]
 s_add_u32 s29, s33, 6144
 s_add_u32 s30, s33, 20480
M v[64:67], a[88:91], v[224:227], v[64:67]
 ds_read_b128 a[112:115], v2 offset:45056
 ds_read_b128 a[116:119], v2 offset:46080
M v[64:67], a[92:95], v[240:243], v[64:67]
 v_mul_f32 v96, v5, v96
 v_mul_f32 v97, v5, v97
M v[68:71], a[92:95], v[244:247], 0
 v_mul_f32 v98, v5, v98
 v_mul_f32 v99, v5, v99
M v[68:71], a[88:91], v[228:231], v[68:71]
 ds_read_b128 a[120:123], v2 offset:47104
 ds_read_b128 a[124:127], v2 offset:48128
M v[68:71], a[84:87], v[212:215], v[68:71]
 v_mul_f32 v104, v5, v104
 v_mul_f32 v105, v5, v105
M v[68:71], a[80:83], v[196:199], v[68:71]
 v_mul_f32 v106, v5, v106
 v_mul_f32 v107, v5, v107
M v[68:71], a[76:79], v[180:183], v[68:71]
 v_cvt_pk_bf16_f32 v96, v96, v97
M v[68:71], a[72:75], v[164:167], v[68:71]
 v_cvt_pk_bf16_f32 v97, v98, v99
M v[68:71], a[68:71], v[148:151], v[68:71]
 v_cvt_pk_bf16_f32 v98, v104, v105
M v[68:71], a[64:67], v[132:135], v[68:71]
 s_waitcnt lgkmcnt(0)
 v_cvt_pk_bf16_f32 v99, v106, v107
M v[72:75], a[96:99], v[128:131], 0
 ds_read_b128 a[64:67], v2 offset:49152
 ds_read_b128 a[68:71], v2 offset:50176
M v[72:75], a[100:103], v[144:147], v[72:75]
 buffer_store_dwordx4 v[96:99], v7, s[8:11], s29 offen offset:0 sc1
M v[72:75], a[104:107], v[160:163], v[72:75]
 v_mul_f32 v100, v6, v100
M v[72:75], a[108:111], v[176:179], v[72:75]
 ds_read_b128 a[72:75], v2 offset:51200
 ds_read_b128 a[76:79], v2 offset:52224
M v[72:75], a[112:115], v[192:195], v[72:75]
 v_mul_f32 v101, v6, v101
 v_mul_f32 v102, v6, v102
M v[72:75], a[116:119], v[208:211], v[72:75]
 v_mul_f32 v103, v6, v103
 v_mul_f32 v108, v6, v108
M v[72:75], a[120:123], v[224:227], v[72:75]
 ds_read_b128 a[80:83], v2 offset:53248
 ds_read_b128 a[84:87], v2 offset:54272
M v[72:75], a[124:127], v[240:243], v[72:75]
 v_mul_f32 v109, v6, v109
 v_mul_f32 v110, v6, v110
M v[76:79], a[124:127], v[244:247], 0
 v_mul_f32 v111, v6, v111
M v[76:79], a[120:123], v[228:231], v[76:79]
 ds_read_b128 a[88:91], v2 offset:55296
 ds_read_b128 a[92:95], v2 offset:56320
M v[76:79], a[116:119], v[212:215], v[76:79]
 v_cvt_pk_bf16_f32 v100, v100, v101
 v_cvt_pk_bf16_f32 v101, v102, v103
M v[76:79], a[112:115], v[196:199], v[76:79]
 v_cvt_pk_bf16_f32 v102, v108, v109
M v[76:79], a[108:111], v[180:183], v[76:79]
 v_cvt_pk_bf16_f32 v103, v110, v111
M v[76:79], a[104:107], v[164:167], v[76:79]
 buffer_store_dwordx4 v[100:103], v7, s[8:11], s30 offen offset:0 sc1
M v[76:79], a[100:103], v[148:151], v[76:79]
M v[76:79], a[96:99], v[132:135], v[76:79]
 s_waitcnt lgkmcnt(0)
 v_mul_f32 v112, v5, v112
M v[80:83], a[64:67], v[128:131], 0
 ds_read_b128 a[96:99], v2 offset:57344
 ds_read_b128 a[100:103], v2 offset:58368
M v[80:83], a[68:71], v[144:147], v[80:83]
 v_mul_f32 v113, v5, v113
 v_mul_f32 v114, v5, v114
M v[80:83], a[72:75], v[160:163], v[80:83]
 v_mul_f32 v115, v5, v115
M v[80:83], a[76:79], v[176:179], v[80:83]
 ds_read_b128 a[104:107], v2 offset:59392
 ds_read_b128 a[108:111], v2 offset:60416
M v[80:83], a[80:83], v[192:195], v[80:83]
 v_mul_f32 v120, v5, v120
 v_mul_f32 v121, v5, v121
M v[80:83], a[84:87], v[208:211], v[80:83]
 v_mul_f32 v122, v5, v122
M v[80:83], a[88:91], v[224:227], v[80:83]
 ds_read_b128 a[112:115], v2 offset:61440
 ds_read_b128 a[116:119], v2 offset:62464
M v[80:83], a[92:95], v[240:243], v[80:83]
 v_mul_f32 v123, v5, v123
 v_cvt_pk_bf16_f32 v112, v112, v113
M v[84:87], a[92:95], v[244:247], 0
 v_cvt_pk_bf16_f32 v113, v114, v115
 v_cvt_pk_bf16_f32 v114, v120, v121
M v[84:87], a[88:91], v[228:231], v[84:87]
 ds_read_b128 a[120:123], v2 offset:63488
 ds_read_b128 a[124:127], v2 offset:64512
M v[84:87], a[84:87], v[212:215], v[84:87]
 v_cvt_pk_bf16_f32 v115, v122, v123
M v[84:87], a[80:83], v[196:199], v[84:87]
 buffer_store_dwordx4 v[112:115], v7, s[8:11], s29 offen offset:1024 sc1
M v[84:87], a[76:79], v[180:183], v[84:87]
 v_mul_f32 v116, v6, v116
M v[84:87], a[72:75], v[164:167], v[84:87]
 v_mul_f32 v117, v6, v117
M v[84:87], a[68:71], v[148:151], v[84:87]
 s_waitcnt vmcnt(18) lgkmcnt(0)
 v_mul_f32 v118, v6, v118
M v[84:87], a[64:67], v[132:135], v[84:87]
 s_barrier
M v[88:91], a[96:99], v[128:131], 0
 ds_read_b128 a[64:67], v7 offset:32768
 ds_read_b128 a[68:71], v7 offset:33792
M v[88:91], a[100:103], v[144:147], v[88:91]
 v_mul_f32 v119, v6, v119
 v_mul_f32 v124, v6, v124
M v[88:91], a[104:107], v[160:163], v[88:91]
 v_mul_f32 v125, v6, v125
 v_mul_f32 v126, v6, v126
M v[88:91], a[108:111], v[176:179], v[88:91]
 ds_read_b128 a[72:75], v7 offset:34816
 ds_read_b128 a[76:79], v7 offset:35840
M v[88:91], a[112:115], v[192:195], v[88:91]
 v_mul_f32 v127, v6, v127
 v_cvt_pk_bf16_f32 v116, v116, v117
M v[88:91], a[116:119], v[208:211], v[88:91]
 v_cvt_pk_bf16_f32 v117, v118, v119
M v[88:91], a[120:123], v[224:227], v[88:91]
 ds_read_b128 a[80:83], v7 offset:36864
 ds_read_b128 a[84:87], v7 offset:37888
M v[88:91], a[124:127], v[240:243], v[88:91]
 v_cvt_pk_bf16_f32 v118, v124, v125
 v_cvt_pk_bf16_f32 v119, v126, v127
M v[92:95], a[124:127], v[244:247], 0
 buffer_store_dwordx4 v[116:119], v7, s[8:11], s30 offen offset:1024 sc1
M v[92:95], a[120:123], v[228:231], v[92:95]
 ds_read_b128 a[88:91], v7 offset:38912
 ds_read_b128 a[92:95], v7 offset:39936
M v[92:95], a[116:119], v[212:215], v[92:95]
M v[92:95], a[112:115], v[196:199], v[92:95]
M v[92:95], a[108:111], v[180:183], v[92:95]
M v[92:95], a[104:107], v[164:167], v[92:95]
M v[92:95], a[100:103], v[148:151], v[92:95]
 s_waitcnt lgkmcnt(0)
M v[92:95], a[96:99], v[132:135], v[92:95]
M v[96:99], a[64:67], v[128:131], 0
 ds_read_b128 a[96:99], v7 offset:40960
 ds_read_b128 a[100:103], v7 offset:41984
M v[96:99], a[68:71], v[144:147], v[96:99]
M v[96:99], a[72:75], v[160:163], v[96:99]
M v[96:99], a[76:79], v[176:179], v[96:99]
 ds_read_b128 a[104:107], v7 offset:43008
 ds_read_b128 a[108:111], v7 offset:44032
M v[96:99], a[80:83], v[192:195], v[96:99]
 s_add_u32 s29, s33, 8192
 s_add_u32 s30, s33, 22528
M v[96:99], a[84:87], v[208:211], v[96:99]
 v_mul_f32 v64, v5, v64
 v_mul_f32 v65, v5, v65
M v[96:99], a[88:91], v[224:227], v[96:99]
 ds_read_b128 a[112:115], v7 offset:45056
 ds_read_b128 a[116:119], v7 offset:46080
M v[96:99], a[92:95], v[240:243], v[96:99]
 v_mul_f32 v66, v5, v66
 v_mul_f32 v67, v5, v67
M v[100:103], a[92:95], v[244:247], 0
 v_mul_f32 v72, v5, v72
M v[100:103], a[88:91], v[228:231], v[100:103]
 ds_read_b128 a[120:123], v7 offset:47104
 ds_read_b128 a[124:127], v7 offset:48128
M v[100:103], a[84:87], v[212:215], v[100:103]
 v_mul_f32 v73, v5, v73
 v_mul_f32 v74, v5, v74
M v[100:103], a[80:83], v[196:199], v[100:103]
 v_mul_f32 v75, v5, v75
M v[100:103], a[76:79], v[180:183], v[100:103]
 v_cvt_pk_bf16_f32 v64, v64, v65
M v[100:103], a[72:75], v[164:167], v[100:103]
 v_cvt_pk_bf16_f32 v65, v66, v67
M v[100:103], a[68:71], v[148:151], v[100:103]
 v_cvt_pk_bf16_f32 v66, v72, v73
M v[100:103], a[64:67], v[132:135], v[100:103]
 s_waitcnt lgkmcnt(0)
 v_cvt_pk_bf16_f32 v67, v74, v75
M v[104:107], a[96:99], v[128:131], 0
 ds_read_b128 a[64:67], v7 offset:49152
 ds_read_b128 a[68:71], v7 offset:50176
M v[104:107], a[100:103], v[144:147], v[104:107]
 buffer_store_dwordx4 v[64:67], v7, s[8:11], s29 offen offset:0 sc1
M v[104:107], a[104:107], v[160:163], v[104:107]
 v_mul_f32 v68, v6, v68
M v[104:107], a[108:111], v[176:179], v[104:107]
 ds_read_b128 a[72:75], v7 offset:51200
 ds_read_b128 a[76:79], v7 offset:52224
M v[104:107], a[112:115], v[192:195], v[104:107]
 v_mul_f32 v69, v6, v69
 v_mul_f32 v70, v6, v70
M v[104:107], a[116:119], v[208:211], v[104:107]
 v_mul_f32 v71, v6, v71
 v_mul_f32 v76, v6, v76
M v[104:107], a[120:123], v[224:227], v[104:107]
 ds_read_b128 a[80:83], v7 offset:53248
 ds_read_b128 a[84:87], v7 offset:54272
M v[104:107], a[124:127], v[240:243], v[104:107]
 v_mul_f32 v77, v6, v77
 v_mul_f32 v78, v6, v78
M v[108:111], a[124:127], v[244:247], 0
 v_mul_f32 v79, v6, v79
M v[108:111], a[120:123], v[228:231], v[108:111]
 ds_read_b128 a[88:91], v7 offset:55296
 ds_read_b128 a[92:95], v7 offset:56320
M v[108:111], a[116:119], v[212:215], v[108:111]
 v_cvt_pk_bf16_f32 v68, v68, v69
 v_cvt_pk_bf16_f32 v69, v70, v71
M v[108:111], a[112:115], v[196:199], v[108:111]
 v_cvt_pk_bf16_f32 v70, v76, v77
M v[108:111], a[108:111], v[180:183], v[108:111]
 v_cvt_pk_bf16_f32 v71, v78, v79
M v[108:111], a[104:107], v[164:167], v[108:111]
 buffer_store_dwordx4 v[68:71], v7, s[8:11], s30 offen offset:0 sc1
M v[108:111], a[100:103], v[148:151], v[108:111]
M v[108:111], a[96:99], v[132:135], v[108:111]
 s_waitcnt lgkmcnt(0)
 v_mul_f32 v80, v5, v80
M v[112:115], a[64:67], v[128:131], 0
 ds_read_b128 a[96:99], v7 offset:57344
 ds_read_b128 a[100:103], v7 offset:58368
M v[112:115], a[68:71], v[144:147], v[112:115]
 v_mul_f32 v81, v5, v81
 v_mul_f32 v82, v5, v82
M v[112:115], a[72:75], v[160:163], v[112:115]
 v_mul_f32 v83, v5, v83
M v[112:115], a[76:79], v[176:179], v[112:115]
 ds_read_b128 a[104:107], v7 offset:59392
 ds_read_b128 a[108:111], v7 offset:60416
M v[112:115], a[80:83], v[192:195], v[112:115]
 v_mul_f32 v88, v5, v88
 v_mul_f32 v89, v5, v89
M v[112:115], a[84:87], v[208:211], v[112:115]
 v_mul_f32 v90, v5, v90
M v[112:115], a[88:91], v[224:227], v[112:115]
 ds_read_b128 a[112:115], v7 offset:61440
 ds_read_b128 a[116:119], v7 offset:62464
M v[112:115], a[92:95], v[240:243], v[112:115]
 v_mul_f32 v91, v5, v91
 v_cvt_pk_bf16_f32 v80, v80, v81
M v[116:119], a[92:95], v[244:247], 0
 s_waitcnt vmcnt(6)
 v_readlane_b32 s84, v25, 0
 v_readlane_b32 s85, v25, 1
M v[116:119], a[88:91], v[228:231], v[116:119]
 ds_read_b128 a[120:123], v7 offset:63488
 ds_read_b128 a[124:127], v7 offset:64512
M v[116:119], a[84:87], v[212:215], v[116:119]
 v_mov_b32 v24, 0x3f80
 v_mov_b32 v25, 0x3f800000
M v[116:119], a[80:83], v[196:199], v[116:119]
 v_cvt_pk_bf16_f32 v81, v82, v83
 v_cvt_pk_bf16_f32 v82, v88, v89
M v[116:119], a[76:79], v[180:183], v[116:119]
 v_cvt_pk_bf16_f32 v83, v90, v91
M v[116:119], a[72:75], v[164:167], v[116:119]
 buffer_store_dwordx4 v[80:83], v7, s[8:11], s29 offen offset:1024 sc1
M v[116:119], a[68:71], v[148:151], v[116:119]
 s_waitcnt lgkmcnt(0)
 v_mul_f32 v84, v6, v84
 v_mul_f32 v85, v6, v85
M v[116:119], a[64:67], v[132:135], v[116:119]
 s_barrier
M v[120:123], a[96:99], v[128:131], 0
 ds_read_b128 a[64:67], v2 offset:0
 ds_read_b128 a[68:71], v2 offset:1024
M v[120:123], a[100:103], v[144:147], v[120:123]
 v_mul_f32 v86, v6, v86
 v_mul_f32 v87, v6, v87
M v[120:123], a[104:107], v[160:163], v[120:123]
 v_mul_f32 v92, v6, v92
 v_mul_f32 v93, v6, v93
M v[120:123], a[108:111], v[176:179], v[120:123]
 ds_read_b128 a[72:75], v2 offset:2048
 ds_read_b128 a[76:79], v2 offset:3072
M v[120:123], a[112:115], v[192:195], v[120:123]
 v_mul_f32 v94, v6, v94
 v_mul_f32 v95, v6, v95
M v[120:123], a[116:119], v[208:211], v[120:123]
 s_waitcnt vmcnt(3)
 buffer_store_dword v15, v16, s[8:11], s45 offen sc1
M v[120:123], a[120:123], v[224:227], v[120:123]
 ds_read_b128 a[80:83], v2 offset:4096
 ds_read_b128 a[84:87], v2 offset:5120
M v[120:123], a[124:127], v[240:243], v[120:123]
 v_cvt_pk_bf16_f32 v84, v84, v85
 v_cvt_pk_bf16_f32 v85, v86, v87
M v[124:127], a[124:127], v[244:247], 0
 v_cvt_pk_bf16_f32 v86, v92, v93
 v_cvt_pk_bf16_f32 v87, v94, v95
M v[124:127], a[120:123], v[228:231], v[124:127]
 ds_read_b128 a[88:91], v2 offset:6144
 ds_read_b128 a[92:95], v2 offset:7168
M v[124:127], a[116:119], v[212:215], v[124:127]
 buffer_store_dwordx4 v[84:87], v7, s[8:11], s30 offen offset:1024 sc1
M v[124:127], a[112:115], v[196:199], v[124:127]
M v[124:127], a[108:111], v[180:183], v[124:127]
M v[124:127], a[104:107], v[164:167], v[124:127]
M v[124:127], a[100:103], v[148:151], v[124:127]
 s_waitcnt lgkmcnt(0)
M v[124:127], a[96:99], v[132:135], v[124:127]
M v[64:67], a[64:67], v[128:131], 0
 ds_read_b128 a[96:99], v2 offset:8192
M v[64:67], a[68:71], v[144:147], v[64:67]
 ds_read_b128 a[100:103], v2 offset:9216
M v[64:67], a[72:75], v[160:163], v[64:67]
M v[64:67], a[76:79], v[176:179], v[64:67]
 ds_read_b128 a[104:107], v2 offset:10240
 s_add_u32 s29, s33, 10240
M v[64:67], a[80:83], v[192:195], v[64:67]
 ds_read_b128 a[108:111], v2 offset:11264
 s_add_u32 s30, s33, 24576
M v[64:67], a[84:87], v[208:211], v[64:67]
 v_mul_f32 v96, v5, v96
 v_mul_f32 v97, v5, v97
M v[64:67], a[88:91], v[224:227], v[64:67]
 ds_read_b128 a[112:115], v2 offset:12288
 v_mul_f32 v98, v5, v98
M v[64:67], a[92:95], v[240:243], v[64:67]
 ds_read_b128 a[116:119], v2 offset:13312
 v_mul_f32 v99, v5, v99
M v[68:71], a[92:95], v[244:247], 0
 v_mul_f32 v104, v5, v104
 v_mul_f32 v105, v5, v105
M v[68:71], a[88:91], v[228:231], v[68:71]
 ds_read_b128 a[120:123], v2 offset:14336
 v_mul_f32 v106, v5, v106
M v[68:71], a[84:87], v[212:215], v[68:71]
 ds_read_b128 a[124:127], v2 offset:15360
 v_mul_f32 v107, v5, v107
M v[68:71], a[80:83], v[196:199], v[68:71]
 v_cvt_pk_bf16_f32 v96, v96, v97
 v_cvt_pk_bf16_f32 v97, v98, v99
M v[68:71], a[76:79], v[180:183], v[68:71]
 v_cvt_pk_bf16_f32 v98, v104, v105
 v_cvt_pk_bf16_f32 v99, v106, v107
M v[68:71], a[72:75], v[164:167], v[68:71]
 buffer_store_dwordx4 v[96:99], v7, s[8:11], s29 offen offset:0 sc1
M v[68:71], a[68:71], v[148:151], v[68:71]
 v_mul_f32 v100, v6, v100
 v_mul_f32 v101, v6, v101
M v[68:71], a[64:67], v[132:135], v[68:71]
 s_waitcnt lgkmcnt(0)
 v_mul_f32 v102, v6, v102
 v_mul_f32 v103, v6, v103
M v[72:75], a[96:99], v[128:131], 0
 ds_read_b128 a[64:67], v2 offset:16384
 v_mul_f32 v108, v6, v108
M v[72:75], a[100:103], v[144:147], v[72:75]
 ds_read_b128 a[68:71], v2 offset:17408
 v_mul_f32 v109, v6, v109
M v[72:75], a[104:107], v[160:163], v[72:75]
 v_mul_f32 v110, v6, v110
 v_mul_f32 v111, v6, v111
M v[72:75], a[108:111], v[176:179], v[72:75]
 ds_read_b128 a[72:75], v2 offset:18432
 v_cvt_pk_bf16_f32 v100, v100, v101
M v[72:75], a[112:115], v[192:195], v[72:75]
 ds_read_b128 a[76:79], v2 offset:19456
 v_cvt_pk_bf16_f32 v101, v102, v103
M v[72:75], a[116:119], v[208:211], v[72:75]
 v_cvt_pk_bf16_f32 v102, v108, v109
 v_cvt_pk_bf16_f32 v103, v110, v111
M v[72:75], a[120:123], v[224:227], v[72:75]
 ds_read_b128 a[80:83], v2 offset:20480
M v[72:75], a[124:127], v[240:243], v[72:75]
 ds_read_b128 a[84:87], v2 offset:21504
M v[76:79], a[124:127], v[244:247], 0
 buffer_store_dwordx4 v[100:103], v7, s[8:11], s30 offen offset:0 sc1
M v[76:79], a[120:123], v[228:231], v[76:79]
 ds_read_b128 a[88:91], v2 offset:22528
 v_mul_f32 v112, v5, v112
M v[76:79], a[116:119], v[212:215], v[76:79]
 ds_read_b128 a[92:95], v2 offset:23552
 v_mul_f32 v113, v5, v113
M v[76:79], a[112:115], v[196:199], v[76:79]
 v_mul_f32 v114, v5, v114
 v_mul_f32 v115, v5, v115
M v[76:79], a[108:111], v[180:183], v[76:79]
 v_mul_f32 v120, v5, v120
 v_mul_f32 v121, v5, v121
M v[76:79], a[104:107], v[164:167], v[76:79]
 v_mul_f32 v122, v5, v122
 v_mul_f32 v123, v5, v123
M v[76:79], a[100:103], v[148:151], v[76:79]
 v_cvt_pk_bf16_f32 v112, v112, v113
 v_cvt_pk_bf16_f32 v113, v114, v115
M v[76:79], a[96:99], v[132:135], v[76:79]
 s_waitcnt lgkmcnt(0)
 v_cvt_pk_bf16_f32 v114, v120, v121
 v_cvt_pk_bf16_f32 v115, v122, v123
M v[80:83], a[64:67], v[128:131], 0
 ds_read_b128 a[96:99], v2 offset:24576
M v[80:83], a[68:71], v[144:147], v[80:83]
 ds_read_b128 a[100:103], v2 offset:25600
M v[80:83], a[72:75], v[160:163], v[80:83]
 buffer_store_dwordx4 v[112:115], v7, s[8:11], s29 offen offset:1024 sc1
M v[80:83], a[76:79], v[176:179], v[80:83]
 ds_read_b128 a[104:107], v2 offset:26624
 v_mul_f32 v116, v6, v116
M v[80:83], a[80:83], v[192:195], v[80:83]
 ds_read_b128 a[108:111], v2 offset:27648
 v_mul_f32 v117, v6, v117
M v[80:83], a[84:87], v[208:211], v[80:83]
 v_mul_f32 v118, v6, v118
 v_mul_f32 v119, v6, v119
M v[80:83], a[88:91], v[224:227], v[80:83]
 ds_read_b128 a[112:115], v2 offset:28672
 v_mul_f32 v124, v6, v124
M v[80:83], a[92:95], v[240:243], v[80:83]
 ds_read_b128 a[116:119], v2 offset:29696
 v_mul_f32 v125, v6, v125
M v[84:87], a[92:95], v[244:247], 0
 v_mul_f32 v126, v6, v126
 v_mul_f32 v127, v6, v127
M v[84:87], a[88:91], v[228:231], v[84:87]
 ds_read_b128 a[120:123], v2 offset:30720
 v_cvt_pk_bf16_f32 v116, v116, v117
M v[84:87], a[84:87], v[212:215], v[84:87]
 ds_read_b128 a[124:127], v2 offset:31744
 v_cvt_pk_bf16_f32 v117, v118, v119
M v[84:87], a[80:83], v[196:199], v[84:87]
 v_cvt_pk_bf16_f32 v118, v124, v125
 v_cvt_pk_bf16_f32 v119, v126, v127
M v[84:87], a[76:79], v[180:183], v[84:87]
 buffer_store_dwordx4 v[116:119], v7, s[8:11], s30 offen offset:1024 sc1
M v[84:87], a[72:75], v[164:167], v[84:87]
 s_add_u32 s29, s33, 12288
M v[84:87], a[68:71], v[148:151], v[84:87]
 s_add_u32 s30, s33, 26624
 v_mul_f32 v64, v5, v64
 v_mul_f32 v65, v5, v65
M v[84:87], a[64:67], v[132:135], v[84:87]
 s_waitcnt lgkmcnt(0)
 v_mul_f32 v66, v5, v66
 v_mul_f32 v67, v5, v67
M v[88:91], a[96:99], v[128:131], 0
 v_mul_f32 v72, v5, v72
 v_mul_f32 v73, v5, v73
M v[88:91], a[100:103], v[144:147], v[88:91]
 v_mul_f32 v74, v5, v74
 v_mul_f32 v75, v5, v75
M v[88:91], a[104:107], v[160:163], v[88:91]
 v_cvt_pk_bf16_f32 v64, v64, v65
 v_cvt_pk_bf16_f32 v65, v66, v67
M v[88:91], a[108:111], v[176:179], v[88:91]
 v_cvt_pk_bf16_f32 v66, v72, v73
 v_cvt_pk_bf16_f32 v67, v74, v75
M v[88:91], a[112:115], v[192:195], v[88:91]
 buffer_store_dwordx4 v[64:67], v7, s[8:11], s29 offen offset:0 sc1
M v[88:91], a[116:119], v[208:211], v[88:91]
 v_mul_f32 v68, v6, v68
 v_mul_f32 v69, v6, v69
M v[88:91], a[120:123], v[224:227], v[88:91]
 v_mul_f32 v70, v6, v70
 v_mul_f32 v71, v6, v71
M v[88:91], a[124:127], v[240:243], v[88:91]
 v_mul_f32 v76, v6, v76
 v_mul_f32 v77, v6, v77
M v[92:95], a[124:127], v[244:247], 0
 v_mul_f32 v78, v6, v78
 v_mul_f32 v79, v6, v79
M v[92:95], a[120:123], v[228:231], v[92:95]
 v_cvt_pk_bf16_f32 v68, v68, v69
 v_cvt_pk_bf16_f32 v69, v70, v71
M v[92:95], a[116:119], v[212:215], v[92:95]
 v_cvt_pk_bf16_f32 v70, v76, v77
 v_cvt_pk_bf16_f32 v71, v78, v79
M v[92:95], a[112:115], v[196:199], v[92:95]
 buffer_store_dwordx4 v[68:71], v7, s[8:11], s30 offen offset:0 sc1
M v[92:95], a[108:111], v[180:183], v[92:95]
M v[92:95], a[104:107], v[164:167], v[92:95]
M v[92:95], a[100:103], v[148:151], v[92:95]
M v[92:95], a[96:99], v[132:135], v[92:95]
 v_mul_f32 v80, v5, v80
 v_mul_f32 v81, v5, v81
 v_mul_f32 v82, v5, v82
 v_mul_f32 v83, v5, v83
 v_mul_f32 v88, v5, v88
 v_mul_f32 v89, v5, v89
 v_mul_f32 v90, v5, v90
 v_mul_f32 v91, v5, v91
 v_cvt_pk_bf16_f32 v80, v80, v81
 v_cvt_pk_bf16_f32 v81, v82, v83
 v_cvt_pk_bf16_f32 v82, v88, v89
 v_cvt_pk_bf16_f32 v83, v90, v91
 buffer_store_dwordx4 v[80:83], v7, s[8:11], s29 offen offset:1024 sc1
 v_mul_f32 v84, v6, v84
 v_mul_f32 v85, v6, v85
 v_mul_f32 v86, v6, v86
 v_mul_f32 v87, v6, v87
 v_mul_f32 v92, v6, v92
 v_mul_f32 v93, v6, v93
 v_mul_f32 v94, v6, v94
 v_mul_f32 v95, v6, v95
 v_cvt_pk_bf16_f32 v84, v84, v85
 v_cvt_pk_bf16_f32 v85, v86, v87
 v_cvt_pk_bf16_f32 v86, v92, v93
 v_cvt_pk_bf16_f32 v87, v94, v95
 buffer_store_dwordx4 v[84:87], v7, s[8:11], s30 offen offset:1024 sc1
 s_waitcnt vmcnt(0)
 buffer_store_dword v15, v16, s[8:11], s3 offen sc1
 s_cmp_lt_u32 s42, 8
 s_cbranch_scc1 L_red
 s_endpgm
L_final_k:
 s_waitcnt vmcnt(2)
 v_cmp_gt_u32 vcc, 3, v6
 s_sub_u32 s27, 6, s42
 s_cbranch_vccnz L_f3s0
L_f3r0:
 s_mul_i32 s21, s41, 1048576
 s_add_u32 s21, s21, 589824
 s_add_u32 s26, s21, 16777216
 s_lshl_b32 s22, s27, 1
 s_add_u32 s22, s22, 0
 s_mov_b32 s23, s25
 s_mov_b32 s40, 0
 s_max_u32 s7, s7, 3
 s_mov_b32 s72, s32
 s_add_u32 s73, s72, 4096
 s_add_u32 s74, s72, 8192
 s_add_u32 s75, s72, 12288
 s_add_u32 m0, s28, 98304
 s_nop 0
 buffer_load_dwordx4 v3, s[8:11], s21 offen offset:0 sc1 lds
 v_exp_f32 v18, v112
 v_exp_f32 v19, v113
 v_exp_f32 v20, v114
 buffer_load_dwordx4 v3, s[8:11], s21 offen offset:1024 sc1 lds
 v_add_f32 v28, v18, v28
 v_cvt_pk_bf16_f32 v56, v18, v19
 v_exp_f32 v21, v115
 buffer_load_dwordx4 v3, s[8:11], s21 offen offset:2048 sc1 lds
 v_add_f32 v28, v19, v28
 v_exp_f32 v22, v120
 v_add_f32 v28, v20, v28
 buffer_load_dwordx4 v3, s[8:11], s21 offen offset:3072 sc1 lds
 v_cvt_pk_bf16_f32 v57, v20, v21
 v_exp_f32 v23, v121
 s_add_u32 m0, s28, 102400
 v_add_f32 v28, v21, v28
 buffer_load_dwordx4 v4, s[8:11], s21 offen offset:0 sc1 lds
 v_exp_f32 v24, v122
 v_add_f32 v28, v22, v28
 v_cvt_pk_bf16_f32 v58, v22, v23
 buffer_load_dwordx4 v4, s[8:11], s21 offen offset:1024 sc1 lds
 v_exp_f32 v25, v123
 v_add_f32 v28, v23, v28
 v_exp_f32 v18, v116
 buffer_load_dwordx4 v4, s[8:11], s21 offen offset:2048 sc1 lds
 v_add_f32 v28, v24, v28
 v_cvt_pk_bf16_f32 v59, v24, v25
 v_exp_f32 v19, v117
 buffer_load_dwordx4 v4, s[8:11], s21 offen offset:3072 sc1 lds
 v_add_f32 v28, v25, v28
 v_exp_f32 v20, v118
 s_add_u32 s21, s21, 32768
 s_sub_u32 s22, s22, 1
 s_cmp_eq_u32 s22, 0
 s_cselect_b32 s21, s23, s21
 s_cselect_b32 s22, s24, s22
 s_cselect_b32 s23, s25, s23
 s_cselect_b32 s24, 0x7fff, s24
 s_add_u32 s76, s90, 4096
 v_add_f32 v29, v18, v29
 buffer_load_dwordx4 v[14:17], v7, s[8:11], s76 offen sc1
 v_cvt_pk_bf16_f32 v60, v18, v19
 v_exp_f32 v21, v119
 v_add_f32 v29, v19, v29
 buffer_load_dwordx4 a[0:3], v7, s[8:11], s72 offen offset:0 sc1
 v_exp_f32 v22, v124
 v_add_f32 v29, v20, v29
 v_cvt_pk_bf16_f32 v61, v20, v21
 buffer_load_dwordx4 a[4:7], v7, s[8:11], s72 offen offset:1024 sc1
 v_exp_f32 v23, v125
 v_add_f32 v29, v21, v29
 v_exp_f32 v24, v126
 buffer_load_dwordx4 a[8:11], v7, s[8:11], s72 offen offset:2048 sc1
 v_add_f32 v29, v22, v29
 v_cvt_pk_bf16_f32 v62, v22, v23
 v_exp_f32 v25, v127
 buffer_load_dwordx4 a[12:15], v7, s[8:11], s72 offen offset:3072 sc1
 v_add_f32 v29, v23, v29
 v_add_f32 v29, v24, v29
 v_cvt_pk_bf16_f32 v63, v24, v25
 v_add_f32 v29, v25, v29
 v_max_f32 v10, v28, v29
 v_cmp_lt_f32 vcc, s31, v10
 s_nop 0
 s_cbranch_vccnz L_st11
L_rt11:
 s_waitcnt lgkmcnt(0)
M v[128:131], a[64:67], v[48:51], v[128:131]
 ds_read_b128 a[96:99], v7 offset:8192
 ds_read_b128 a[100:103], v7 offset:9216
M v[128:131], a[68:71], v[56:59], v[128:131]
 buffer_load_dwordx4 a[16:19], v7, s[8:11], s73 offen offset:0 sc1
M v[132:135], a[68:71], v[60:63], v[132:135]
 v_add_f32 v30, v28, v30
M v[132:135], a[64:67], v[52:55], v[132:135]
 ds_read_b128 a[104:107], v7 offset:10240
 ds_read_b128 a[108:111], v7 offset:11264
M v[136:139], a[72:75], v[48:51], v[136:139]
 v_add_f32 v31, v29, v31
M v[136:139], a[76:79], v[56:59], v[136:139]
 buffer_load_dwordx4 a[20:23], v7, s[8:11], s73 offen offset:1024 sc1
M v[140:143], a[76:79], v[60:63], v[140:143]
 ds_read_b128 a[112:115], v7 offset:12288
 ds_read_b128 a[116:119], v7 offset:13312
M v[140:143], a[72:75], v[52:55], v[140:143]
 v_mov_b32 v10, v30
M v[144:147], a[80:83], v[48:51], v[144:147]
 s_nop 0
 v_permlane16_swap_b32 v10, v30
M v[144:147], a[84:87], v[56:59], v[144:147]
 ds_read_b128 a[120:123], v7 offset:14336
 ds_read_b128 a[124:127], v7 offset:15360
M v[148:151], a[84:87], v[60:63], v[148:151]
 buffer_load_dwordx4 a[24:27], v7, s[8:11], s73 offen offset:2048 sc1
M v[148:151], a[80:83], v[52:55], v[148:151]
 v_add_f32 v30, v10, v30
M v[152:155], a[88:91], v[48:51], v[152:155]
 v_mov_b32 v10, v30
M v[152:155], a[92:95], v[56:59], v[152:155]
 s_nop 0
 v_permlane32_swap_b32 v10, v30
M v[156:159], a[92:95], v[60:63], v[156:159]
 buffer_load_dwordx4 a[28:31], v7, s[8:11], s73 offen offset:3072 sc1
M v[156:159], a[88:91], v[52:55], v[156:159]
 s_waitcnt lgkmcnt(0)
 v_add_f32 v30, v10, v30
M v[160:163], a[96:99], v[48:51], v[160:163]
 ds_read_b128 a[64:67], v7 offset:16384
 ds_read_b128 a[68:71], v7 offset:17408
M v[160:163], a[100:103], v[56:59], v[160:163]
 v_mov_b32 v11, v31
M v[164:167], a[100:103], v[60:63], v[164:167]
 buffer_load_dwordx4 a[32:35], v7, s[8:11], s74 offen offset:0 sc1
M v[164:167], a[96:99], v[52:55], v[164:167]
 ds_read_b128 a[72:75], v7 offset:18432
 ds_read_b128 a[76:79], v7 offset:19456
M v[168:171], a[104:107], v[48:51], v[168:171]
 v_permlane16_swap_b32 v11, v31
M v[168:171], a[108:111], v[56:59], v[168:171]
 buffer_load_dwordx4 a[36:39], v7, s[8:11], s74 offen offset:1024 sc1
M v[172:175], a[108:111], v[60:63], v[172:175]
 ds_read_b128 a[80:83], v7 offset:20480
 ds_read_b128 a[84:87], v7 offset:21504
M v[172:175], a[104:107], v[52:55], v[172:175]
 v_add_f32 v31, v11, v31
M v[176:179], a[112:115], v[48:51], v[176:179]
 buffer_load_dwordx4 a[40:43], v7, s[8:11], s74 offen offset:2048 sc1
M v[176:179], a[116:119], v[56:59], v[176:179]
 ds_read_b128 a[88:91], v7 offset:22528
 ds_read_b128 a[92:95], v7 offset:23552
M v[180:183], a[116:119], v[60:63], v[180:183]
 v_mov_b32 v11, v31
M v[180:183], a[112:115], v[52:55], v[180:183]
 s_nop 0
 v_permlane32_swap_b32 v11, v31
M v[184:187], a[120:123], v[48:51], v[184:187]
 buffer_load_dwordx4 a[44:47], v7, s[8:11], s74 offen offset:3072 sc1
M v[184:187], a[124:127], v[56:59], v[184:187]
 v_add_f32 v31, v11, v31
M v[188:191], a[124:127], v[60:63], v[188:191]
 v_rcp_f32 v5, v30
M v[188:191], a[120:123], v[52:55], v[188:191]
 s_waitcnt lgkmcnt(0)
 buffer_load_dwordx4 a[48:51], v7, s[8:11], s75 offen offset:0 sc1
M v[192:195], a[64:67], v[48:51], v[192:195]
 ds_read_b128 a[96:99], v7 offset:24576
 ds_read_b128 a[100:103], v7 offset:25600
M v[192:195], a[68:71], v[56:59], v[192:195]
 v_rcp_f32 v6, v31
M v[196:199], a[68:71], v[60:63], v[196:199]
 buffer_load_dwordx4 a[52:55], v7, s[8:11], s75 offen offset:1024 sc1
M v[196:199], a[64:67], v[52:55], v[196:199]
 ds_read_b128 a[104:107], v7 offset:26624
 ds_read_b128 a[108:111], v7 offset:27648
M v[200:203], a[72:75], v[48:51], v[200:203]
 v_cvt_pk_bf16_f32 v128, v128, v129
 v_cvt_pk_bf16_f32 v129, v130, v131
M v[200:203], a[76:79], v[56:59], v[200:203]
 buffer_load_dwordx4 a[56:59], v7, s[8:11], s75 offen offset:2048 sc1
M v[204:207], a[76:79], v[60:63], v[204:207]
 ds_read_b128 a[112:115], v7 offset:28672
 ds_read_b128 a[116:119], v7 offset:29696
M v[204:207], a[72:75], v[52:55], v[204:207]
 v_cvt_pk_bf16_f32 v130, v136, v137
 v_cvt_pk_bf16_f32 v131, v138, v139
M v[208:211], a[80:83], v[48:51], v[208:211]
 buffer_load_dwordx4 a[60:63], v7, s[8:11], s75 offen offset:3072 sc1
M v[208:211], a[84:87], v[56:59], v[208:211]
 ds_read_b128 a[120:123], v7 offset:30720
 ds_read_b128 a[124:127], v7 offset:31744
M v[212:215], a[84:87], v[60:63], v[212:215]
 v_cvt_pk_bf16_f32 v132, v132, v133
 v_cvt_pk_bf16_f32 v133, v134, v135
M v[212:215], a[80:83], v[52:55], v[212:215]
 v_cvt_pk_bf16_f32 v134, v140, v141
 v_cvt_pk_bf16_f32 v135, v142, v143
M v[216:219], a[88:91], v[48:51], v[216:219]
 v_cvt_pk_bf16_f32 v144, v144, v145
 v_cvt_pk_bf16_f32 v145, v146, v147
M v[216:219], a[92:95], v[56:59], v[216:219]
 v_cvt_pk_bf16_f32 v146, v152, v153
 v_cvt_pk_bf16_f32 v147, v154, v155
M v[220:223], a[92:95], v[60:63], v[220:223]
 s_waitcnt vmcnt(17) lgkmcnt(0)
 v_cvt_pk_bf16_f32 v148, v148, v149
 v_cvt_pk_bf16_f32 v149, v150, v151
M v[220:223], a[88:91], v[52:55], v[220:223]
 s_barrier
M v[224:227], a[96:99], v[48:51], v[224:227]
 ds_read_b128 a[64:67], v2 offset:32768
 ds_read_b128 a[68:71], v2 offset:33792
M v[224:227], a[100:103], v[56:59], v[224:227]
 v_cvt_pk_bf16_f32 v150, v156, v157
 v_cvt_pk_bf16_f32 v151, v158, v159
M v[228:231], a[100:103], v[60:63], v[228:231]
 v_cvt_pk_bf16_f32 v160, v160, v161
 v_cvt_pk_bf16_f32 v161, v162, v163
M v[228:231], a[96:99], v[52:55], v[228:231]
 ds_read_b128 a[72:75], v2 offset:34816
 ds_read_b128 a[76:79], v2 offset:35840
M v[232:235], a[104:107], v[48:51], v[232:235]
 v_cvt_pk_bf16_f32 v162, v168, v169
 v_cvt_pk_bf16_f32 v163, v170, v171
M v[232:235], a[108:111], v[56:59], v[232:235]
 v_cvt_pk_bf16_f32 v164, v164, v165
 v_cvt_pk_bf16_f32 v165, v166, v167
M v[236:239], a[108:111], v[60:63], v[236:239]
 ds_read_b128 a[80:83], v2 offset:36864
 ds_read_b128 a[84:87], v2 offset:37888
M v[236:239], a[104:107], v[52:55], v[236:239]
 v_cvt_pk_bf16_f32 v166, v172, v173
 v_cvt_pk_bf16_f32 v167, v174, v175
M v[240:243], a[112:115], v[48:51], v[240:243]
 v_cvt_pk_bf16_f32 v176, v176, v177
 v_cvt_pk_bf16_f32 v177, v178, v179
M v[240:243], a[116:119], v[56:59], v[240:243]
 ds_read_b128 a[88:91], v2 offset:38912
 ds_read_b128 a[92:95], v2 offset:39936
M v[244:247], a[116:119], v[60:63], v[244:247]
 v_cvt_pk_bf16_f32 v178, v184, v185
 v_cvt_pk_bf16_f32 v179, v186, v187
M v[244:247], a[112:115], v[52:55], v[244:247]
 v_cvt_pk_bf16_f32 v180, v180, v181
 v_cvt_pk_bf16_f32 v181, v182, v183
M v[248:251], a[120:123], v[48:51], v[248:251]
 v_cvt_pk_bf16_f32 v182, v188, v189
 v_cvt_pk_bf16_f32 v183, v190, v191
M v[248:251], a[124:127], v[56:59], v[248:251]
 v_cvt_pk_bf16_f32 v192, v192, v193
 v_cvt_pk_bf16_f32 v193, v194, v195
M v[252:255], a[124:127], v[60:63], v[252:255]
 s_waitcnt lgkmcnt(0)
 v_cvt_pk_bf16_f32 v194, v200, v201
 v_cvt_pk_bf16_f32 v195, v202, v203
M v[252:255], a[120:123], v[52:55], v[252:255]
 v_cvt_pk_bf16_f32 v196, v196, v197
 v_cvt_pk_bf16_f32 v197, v198, v199
 s_add_u32 m0, s28, 32768
 v_cvt_pk_bf16_f32 v198, v204, v205
 buffer_load_dwordx4 v3, s[8:11], s21 offen offset:0 sc1 lds
 v_cvt_pk_bf16_f32 v199, v206, v207
 v_cvt_pk_bf16_f32 v208, v208, v209
 v_cvt_pk_bf16_f32 v209, v210, v211
 buffer_load_dwordx4 v3, s[8:11], s21 offen offset:1024 sc1 lds
 v_cvt_pk_bf16_f32 v210, v216, v217
 v_cvt_pk_bf16_f32 v211, v218, v219
 v_cvt_pk_bf16_f32 v212, v212, v213
 buffer_load_dwordx4 v3, s[8:11], s21 offen offset:2048 sc1 lds
 v_cvt_pk_bf16_f32 v213, v214, v215
 v_cvt_pk_bf16_f32 v214, v220, v221
 v_cvt_pk_bf16_f32 v215, v222, v223
 buffer_load_dwordx4 v3, s[8:11], s21 offen offset:3072 sc1 lds
 v_cvt_pk_bf16_f32 v224, v224, v225
 v_cvt_pk_bf16_f32 v225, v226, v227
 s_add_u32 m0, s28, 36864
 v_cvt_pk_bf16_f32 v226, v232, v233
 buffer_load_dwordx4 v4, s[8:11], s21 offen offset:0 sc1 lds
 v_cvt_pk_bf16_f32 v227, v234, v235
 v_cvt_pk_bf16_f32 v228, v228, v229
 v_cvt_pk_bf16_f32 v229, v230, v231
 buffer_load_dwordx4 v4, s[8:11], s21 offen offset:1024 sc1 lds
 v_cvt_pk_bf16_f32 v230, v236, v237
 v_cvt_pk_bf16_f32 v231, v238, v239
 v_cvt_pk_bf16_f32 v240, v240, v241
 buffer_load_dwordx4 v4, s[8:11], s21 offen offset:2048 sc1 lds
 v_cvt_pk_bf16_f32 v241, v242, v243
 v_cvt_pk_bf16_f32 v242, v248, v249
 v_cvt_pk_bf16_f32 v243, v250, v251
 buffer_load_dwordx4 v4, s[8:11], s21 offen offset:3072 sc1 lds
 s_add_u32 s21, s21, 32768
 s_sub_u32 s22, s22, 1
 s_cmp_eq_u32 s22, 0
 s_cselect_b32 s21, s23, s21
 s_cselect_b32 s22, s24, s22
 s_cselect_b32 s23, s25, s23
 s_cselect_b32 s24, 0x7fff, s24
 v_cvt_pk_bf16_f32 v244, v244, v245
 v_cvt_pk_bf16_f32 v245, v246, v247
 v_cvt_pk_bf16_f32 v246, v252, v253
 v_cvt_pk_bf16_f32 v247, v254, v255
L_w0h:
 s_waitcnt vmcnt(24)
 v_mov_b32 v32, v14
 v_mov_b32 v33, v14
 v_mov_b32 v34, v14
 v_mov_b32 v35, v14
 v_mov_b32 v36, v16
 v_mov_b32 v37, v16
 v_mov_b32 v38, v16
 v_mov_b32 v39, v16
 s_waitcnt vmcnt(8)
M v[64:67], a[64:67], a[0:3], v[32:35]
 s_add_u32 m0, s28, 65536
 ds_read_b128 a[96:99], v2 offset:40960
 ds_read_b128 a[100:103], v2 offset:41984
M v[64:67], a[68:71], a[4:7], v[64:67]
 buffer_load_dwordx4 v3, s[8:11], s26 offen offset:0 sc1 lds
M v[64:67], a[72:75], a[8:11], v[64:67]
 v_accvgpr_write_b32 a128, v128
 v_accvgpr_write_b32 a129, v129
M v[64:67], a[76:79], a[12:15], v[64:67]
 ds_read_b128 a[104:107], v2 offset:43008
 ds_read_b128 a[108:111], v2 offset:44032
M v[64:67], a[80:83], a[16:19], v[64:67]
 v_accvgpr_write_b32 a130, v130
 v_accvgpr_write_b32 a131, v131
M v[64:67], a[84:87], a[20:23], v[64:67]
 v_accvgpr_write_b32 a132, v144
 v_accvgpr_write_b32 a133, v145
M v[64:67], a[88:91], a[24:27], v[64:67]
 ds_read_b128 a[112:115], v2 offset:45056
 ds_read_b128 a[116:119], v2 offset:46080
M v[64:67], a[92:95], a[28:31], v[64:67]
 buffer_load_dwordx4 v3, s[8:11], s26 offen offset:1024 sc1 lds
M v[68:71], a[92:95], a[60:63], v[36:39]
 v_accvgpr_write_b32 a134, v146
 v_accvgpr_write_b32 a135, v147
M v[68:71], a[88:91], a[56:59], v[68:71]
 ds_read_b128 a[120:123], v2 offset:47104
 ds_read_b128 a[124:127], v2 offset:48128
M v[68:71], a[84:87], a[52:55], v[68:71]
 v_accvgpr_write_b32 a136, v160
 v_accvgpr_write_b32 a137, v161
M v[68:71], a[80:83], a[48:51], v[68:71]
 v_accvgpr_write_b32 a138, v162
 v_accvgpr_write_b32 a139, v163
M v[68:71], a[76:79], a[44:47], v[68:71]
 buffer_load_dwordx4 v3, s[8:11], s26 offen offset:2048 sc1 lds
M v[68:71], a[72:75], a[40:43], v[68:71]
 v_accvgpr_write_b32 a140, v176
 v_accvgpr_write_b32 a141, v177
M v[68:71], a[68:71], a[36:39], v[68:71]
 v_accvgpr_write_b32 a142, v178
 v_accvgpr_write_b32 a143, v179
M v[68:71], a[64:67], a[32:35], v[68:71]
 s_waitcnt lgkmcnt(0)
 v_accvgpr_write_b32 a144, v192
 v_accvgpr_write_b32 a145, v193
M v[72:75], a[96:99], a[0:3], v[32:35]
 ds_read_b128 a[64:67], v2 offset:49152
 ds_read_b128 a[68:71], v2 offset:50176
M v[72:75], a[100:103], a[4:7], v[72:75]
 buffer_load_dwordx4 v3, s[8:11], s26 offen offset:3072 sc1 lds
M v[72:75], a[104:107], a[8:11], v[72:75]
 v_accvgpr_write_b32 a146, v194
 v_accvgpr_write_b32 a147, v195
M v[72:75], a[108:111], a[12:15], v[72:75]
 ds_read_b128 a[72:75], v2 offset:51200
 ds_read_b128 a[76:79], v2 offset:52224
M v[72:75], a[112:115], a[16:19], v[72:75]
 v_accvgpr_write_b32 a148, v208
 v_accvgpr_write_b32 a149, v209
M v[72:75], a[116:119], a[20:23], v[72:75]
 v_accvgpr_write_b32 a150, v210
 v_accvgpr_write_b32 a151, v211
M v[72:75], a[120:123], a[24:27], v[72:75]
 s_add_u32 m0, s28, 69632
 ds_read_b128 a[80:83], v2 offset:53248
 ds_read_b128 a[84:87], v2 offset:54272
M v[72:75], a[124:127], a[28:31], v[72:75]
 buffer_load_dwordx4 v4, s[8:11], s26 offen offset:0 sc1 lds
M v[76:79], a[124:127], a[60:63], v[36:39]
 v_accvgpr_write_b32 a152, v224
 v_accvgpr_write_b32 a153, v225
M v[76:79], a[120:123], a[56:59], v[76:79]
 ds_read_b128 a[88:91], v2 offset:55296
 ds_read_b128 a[92:95], v2 offset:56320
M v[76:79], a[116:119], a[52:55], v[76:79]
 v_accvgpr_write_b32 a154, v226
 v_accvgpr_write_b32 a155, v227
M v[76:79], a[112:115], a[48:51], v[76:79]
 v_accvgpr_write_b32 a156, v240
 v_accvgpr_write_b32 a157, v241
M v[76:79], a[108:111], a[44:47], v[76:79]
 buffer_load_dwordx4 v4, s[8:11], s26 offen offset:1024 sc1 lds
M v[76:79], a[104:107], a[40:43], v[76:79]
 v_accvgpr_write_b32 a158, v242
 v_accvgpr_write_b32 a159, v243
M v[76:79], a[100:103], a[36:39], v[76:79]
 v_accvgpr_write_b32 a160, v132
 v_accvgpr_write_b32 a161, v133
M v[76:79], a[96:99], a[32:35], v[76:79]
 s_waitcnt lgkmcnt(0)
 v_accvgpr_write_b32 a162, v134
 v_accvgpr_write_b32 a163, v135
M v[80:83], a[64:67], a[0:3], v[32:35]
 ds_read_b128 a[96:99], v2 offset:57344
 ds_read_b128 a[100:103], v2 offset:58368
M v[80:83], a[68:71], a[4:7], v[80:83]
 v_accvgpr_write_b32 a164, v148
 v_accvgpr_write_b32 a165, v149
M v[80:83], a[72:75], a[8:11], v[80:83]
 buffer_load_dwordx4 v4, s[8:11], s26 offen offset:2048 sc1 lds
M v[80:83], a[76:79], a[12:15], v[80:83]
 ds_read_b128 a[104:107], v2 offset:59392
 ds_read_b128 a[108:111], v2 offset:60416
M v[80:83], a[80:83], a[16:19], v[80:83]
 v_accvgpr_write_b32 a166, v150
 v_accvgpr_write_b32 a167, v151
M v[80:83], a[84:87], a[20:23], v[80:83]
 v_accvgpr_write_b32 a168, v164
 v_accvgpr_write_b32 a169, v165
M v[80:83], a[88:91], a[24:27], v[80:83]
 ds_read_b128 a[112:115], v2 offset:61440
 ds_read_b128 a[116:119], v2 offset:62464
M v[80:83], a[92:95], a[28:31], v[80:83]
 buffer_load_dwordx4 v4, s[8:11], s26 offen offset:3072 sc1 lds
M v[84:87], a[92:95], a[60:63], v[36:39]
 s_add_u32 s26, s26, 32768
 v_accvgpr_write_b32 a170, v166
 v_accvgpr_write_b32 a171, v167
M v[84:87], a[88:91], a[56:59], v[84:87]
 ds_read_b128 a[120:123], v2 offset:63488
 ds_read_b128 a[124:127], v2 offset:64512
M v[84:87], a[84:87], a[52:55], v[84:87]
 v_accvgpr_write_b32 a172, v180
 v_accvgpr_write_b32 a173, v181
M v[84:87], a[80:83], a[48:51], v[84:87]
 v_accvgpr_write_b32 a174, v182
 v_accvgpr_write_b32 a175, v183
M v[84:87], a[76:79], a[44:47], v[84:87]
 v_accvgpr_write_b32 a176, v196
 v_accvgpr_write_b32 a177, v197
M v[84:87], a[72:75], a[40:43], v[84:87]
 v_accvgpr_write_b32 a178, v198
 v_accvgpr_write_b32 a179, v199
M v[84:87], a[68:71], a[36:39], v[84:87]
 s_waitcnt vmcnt(8) lgkmcnt(0)
 v_accvgpr_write_b32 a180, v212
 v_accvgpr_write_b32 a181, v213
M v[84:87], a[64:67], a[32:35], v[84:87]
 s_barrier
M v[88:91], a[96:99], a[0:3], v[32:35]
 ds_read_b128 a[64:67], v7 offset:32768
 ds_read_b128 a[68:71], v7 offset:33792
M v[88:91], a[100:103], a[4:7], v[88:91]
 v_accvgpr_write_b32 a182, v214
 v_accvgpr_write_b32 a183, v215
M v[88:91], a[104:107], a[8:11], v[88:91]
 v_accvgpr_write_b32 a184, v228
 v_accvgpr_write_b32 a185, v229
M v[88:91], a[108:111], a[12:15], v[88:91]
 ds_read_b128 a[72:75], v7 offset:34816
 ds_read_b128 a[76:79], v7 offset:35840
M v[88:91], a[112:115], a[16:19], v[88:91]
 v_accvgpr_write_b32 a186, v230
 v_accvgpr_write_b32 a187, v231
M v[88:91], a[116:119], a[20:23], v[88:91]
 v_accvgpr_write_b32 a188, v244
M v[88:91], a[120:123], a[24:27], v[88:91]
 ds_read_b128 a[80:83], v7 offset:36864
 ds_read_b128 a[84:87], v7 offset:37888
M v[88:91], a[124:127], a[28:31], v[88:91]
 v_accvgpr_write_b32 a189, v245
 v_accvgpr_write_b32 a190, v246
M v[92:95], a[124:127], a[60:63], v[36:39]
 v_accvgpr_write_b32 a191, v247
 v_accvgpr_write_b32 a192, v5
M v[92:95], a[120:123], a[56:59], v[92:95]
 ds_read_b128 a[88:91], v7 offset:38912
 ds_read_b128 a[92:95], v7 offset:39936
M v[92:95], a[116:119], a[52:55], v[92:95]
 v_accvgpr_write_b32 a193, v6
 v_mov_b32 v56, 0
M v[92:95], a[112:115], a[48:51], v[92:95]
 v_mov_b32 v57, 0
M v[92:95], a[108:111], a[44:47], v[92:95]
 v_mov_b32 v58, 0
M v[92:95], a[104:107], a[40:43], v[92:95]
 v_mov_b32 v59, 0
M v[92:95], a[100:103], a[36:39], v[92:95]
 s_waitcnt lgkmcnt(0)
M v[92:95], a[96:99], a[32:35], v[92:95]
 s_add_u32 m0, s28, 98304
 v_mov_b32 v30, 0
 buffer_load_dwordx4 v3, s[8:11], s21 offen offset:0 sc1 lds
 v_mov_b32 v31, 0
 v_exp_f32 v18, v64
 v_exp_f32 v19, v65
 v_mfma_f32_32x32x16_bf16 v[128:143], v[56:59], v[56:59], 0
 v_exp_f32 v20, v66
 buffer_load_dwordx4 v3, s[8:11], s21 offen offset:1024 sc1 lds
 v_add_f32 v26, v18, v19
 v_cvt_pk_bf16_f32 v40, v18, v19
 v_exp_f32 v21, v67
 v_exp_f32 v22, v72
 v_mfma_f32_32x32x16_bf16 v[144:159], v[56:59], v[56:59], 0
 v_add_f32 v26, v20, v26
 buffer_load_dwordx4 v3, s[8:11], s21 offen offset:2048 sc1 lds
 v_cvt_pk_bf16_f32 v41, v20, v21
 v_exp_f32 v23, v73
 v_add_f32 v26, v21, v26
 v_exp_f32 v24, v74
 v_mfma_f32_32x32x16_bf16 v[160:175], v[56:59], v[56:59], 0
 v_add_f32 v26, v22, v26
 buffer_load_dwordx4 v3, s[8:11], s21 offen offset:3072 sc1 lds
 v_cvt_pk_bf16_f32 v42, v22, v23
 v_exp_f32 v25, v75
 v_add_f32 v26, v23, v26
 v_exp_f32 v18, v68
 v_mfma_f32_32x32x16_bf16 v[176:191], v[56:59], v[56:59], 0
 s_add_u32 m0, s28, 102400
 v_add_f32 v26, v24, v26
 buffer_load_dwordx4 v4, s[8:11], s21 offen offset:0 sc1 lds
 v_cvt_pk_bf16_f32 v43, v24, v25
 v_exp_f32 v19, v69
 v_add_f32 v26, v25, v26
 v_mfma_f32_32x32x16_bf16 v[192:207], v[56:59], v[56:59], 0
 v_exp_f32 v20, v70
 v_add_f32 v27, v18, v19
 buffer_load_dwordx4 v4, s[8:11], s21 offen offset:1024 sc1 lds
 v_cvt_pk_bf16_f32 v44, v18, v19
 v_exp_f32 v21, v71
 v_exp_f32 v22, v76
 v_mfma_f32_32x32x16_bf16 v[208:223], v[56:59], v[56:59], 0
 v_add_f32 v27, v20, v27
 v_cvt_pk_bf16_f32 v45, v20, v21
 buffer_load_dwordx4 v4, s[8:11], s21 offen offset:2048 sc1 lds
 v_exp_f32 v23, v77
 v_add_f32 v27, v21, v27
 v_exp_f32 v24, v78
 v_mfma_f32_32x32x16_bf16 v[224:239], v[56:59], v[56:59], 0
 v_add_f32 v27, v22, v27
 v_cvt_pk_bf16_f32 v46, v22, v23
 buffer_load_dwordx4 v4, s[8:11], s21 offen offset:3072 sc1 lds
 s_add_u32 s21, s21, 32768
 s_sub_u32 s22, s22, 1
 s_cmp_eq_u32 s22, 0
 v_mfma_f32_32x32x16_bf16 v[240:255], v[56:59], v[56:59], 0
 s_cselect_b32 s21, s23, s21
 s_cselect_b32 s22, s24, s22
 s_cselect_b32 s23, s25, s23
 s_cselect_b32 s24, 0x7fff, s24
 v_exp_f32 v25, v79
 v_add_f32 v27, v23, v27
 v_add_f32 v27, v24, v27
 v_cvt_pk_bf16_f32 v47, v24, v25
 v_add_f32 v27, v25, v27
 s_branch L_loop_mid
L_final_h:
 s_waitcnt vmcnt(8)
 s_barrier
 ds_read_b128 a[64:67], v7 offset:0
 ds_read_b128 a[68:71], v7 offset:1024
 ds_read_b128 a[72:75], v7 offset:2048
 ds_read_b128 a[76:79], v7 offset:3072
 ds_read_b128 a[80:83], v7 offset:4096
 ds_read_b128 a[84:87], v7 offset:5120
 ds_read_b128 a[88:91], v7 offset:6144
 ds_read_b128 a[92:95], v7 offset:7168
 s_add_u32 m0, s28, 65536
 v_exp_f32 v18, v112
 buffer_load_dwordx4 v3, s[8:11], s38 offen offset:0 sc1 lds
 v_exp_f32 v19, v113
 v_exp_f32 v20, v114
 v_add_f32 v28, v18, v28
 v_cvt_pk_bf16_f32 v56, v18, v19
 buffer_load_dwordx4 v3, s[8:11], s38 offen offset:1024 sc1 lds
 v_exp_f32 v21, v115
 v_add_f32 v28, v19, v28
 v_exp_f32 v22, v120
 v_add_f32 v28, v20, v28
 v_cvt_pk_bf16_f32 v57, v20, v21
 buffer_load_dwordx4 v3, s[8:11], s38 offen offset:2048 sc1 lds
 v_exp_f32 v23, v121
 v_add_f32 v28, v21, v28
 v_exp_f32 v24, v122
 v_add_f32 v28, v22, v28
 v_cvt_pk_bf16_f32 v58, v22, v23
 buffer_load_dwordx4 v3, s[8:11], s38 offen offset:3072 sc1 lds
 v_exp_f32 v25, v123
 v_add_f32 v28, v23, v28
 v_exp_f32 v18, v116
 v_add_f32 v28, v24, v28
 s_add_u32 m0, s28, 69632
 v_cvt_pk_bf16_f32 v59, v24, v25
 buffer_load_dwordx4 v4, s[8:11], s38 offen offset:0 sc1 lds
 v_exp_f32 v19, v117
 v_add_f32 v28, v25, v28
 v_exp_f32 v20, v118
 v_add_f32 v29, v18, v29
 v_cvt_pk_bf16_f32 v60, v18, v19
 buffer_load_dwordx4 v4, s[8:11], s38 offen offset:1024 sc1 lds
 v_exp_f32 v21, v119
 v_add_f32 v29, v19, v29
 v_exp_f32 v22, v124
 v_add_f32 v29, v20, v29
 v_cvt_pk_bf16_f32 v61, v20, v21
 buffer_load_dwordx4 v4, s[8:11], s38 offen offset:2048 sc1 lds
 v_exp_f32 v23, v125
 v_add_f32 v29, v21, v29
 v_exp_f32 v24, v126
 v_add_f32 v29, v22, v29
 v_cvt_pk_bf16_f32 v62, v22, v23
 buffer_load_dwordx4 v4, s[8:11], s38 offen offset:3072 sc1 lds
 s_add_u32 s38, s38, 32768
 v_exp_f32 v25, v127
 v_add_f32 v29, v23, v29
 v_add_f32 v29, v24, v29
 v_cvt_pk_bf16_f32 v63, v24, v25
 v_add_f32 v29, v25, v29
 v_max_f32 v10, v28, v29
 v_cmp_lt_f32 vcc, s31, v10
 s_nop 0
 s_cbranch_vccnz L_st4
L_rt4:
 v_add_f32 v30, v28, v30
 v_add_f32 v31, v29, v31
 v_mov_b32 v12, v32
 v_mov_b32 v13, v36
 v_mov_b32 v14, v30
 v_mov_b32 v15, v31
 buffer_store_dwordx4 v[12:15], v7, s[8:11], s90 offen sc1
 s_waitcnt lgkmcnt(0)
M v[128:131], a[64:67], v[48:51], v[128:131]
 ds_read_b128 a[96:99], v7 offset:8192
 ds_read_b128 a[100:103], v7 offset:9216
M v[128:131], a[68:71], v[56:59], v[128:131]
M v[132:135], a[68:71], v[60:63], v[132:135]
M v[132:135], a[64:67], v[52:55], v[132:135]
 ds_read_b128 a[104:107], v7 offset:10240
 ds_read_b128 a[108:111], v7 offset:11264
M v[136:139], a[72:75], v[48:51], v[136:139]
M v[136:139], a[76:79], v[56:59], v[136:139]
M v[140:143], a[76:79], v[60:63], v[140:143]
 ds_read_b128 a[112:115], v7 offset:12288
 ds_read_b128 a[116:119], v7 offset:13312
M v[140:143], a[72:75], v[52:55], v[140:143]
M v[144:147], a[80:83], v[48:51], v[144:147]
M v[144:147], a[84:87], v[56:59], v[144:147]
 ds_read_b128 a[120:123], v7 offset:14336
 ds_read_b128 a[124:127], v7 offset:15360
M v[148:151], a[84:87], v[60:63], v[148:151]
 v_cvt_pk_bf16_f32 v128, v128, v129
 v_cvt_pk_bf16_f32 v129, v130, v131
M v[148:151], a[80:83], v[52:55], v[148:151]
 v_cvt_pk_bf16_f32 v130, v136, v137
 v_cvt_pk_bf16_f32 v131, v138, v139
M v[152:155], a[88:91], v[48:51], v[152:155]
 buffer_store_dwordx4 v[128:131], v7, s[8:11], s86 offen offset:0 sc1
M v[152:155], a[92:95], v[56:59], v[152:155]
 v_cvt_pk_bf16_f32 v132, v132, v133
 v_cvt_pk_bf16_f32 v133, v134, v135
M v[156:159], a[92:95], v[60:63], v[156:159]
 v_cvt_pk_bf16_f32 v134, v140, v141
 v_cvt_pk_bf16_f32 v135, v142, v143
M v[156:159], a[88:91], v[52:55], v[156:159]
 s_waitcnt lgkmcnt(0)
M v[160:163], a[96:99], v[48:51], v[160:163]
 ds_read_b128 a[64:67], v7 offset:16384
 ds_read_b128 a[68:71], v7 offset:17408
M v[160:163], a[100:103], v[56:59], v[160:163]
 buffer_store_dwordx4 v[132:135], v7, s[8:11], s88 offen offset:0 sc1
M v[164:167], a[100:103], v[60:63], v[164:167]
 v_cvt_pk_bf16_f32 v144, v144, v145
 v_cvt_pk_bf16_f32 v145, v146, v147
M v[164:167], a[96:99], v[52:55], v[164:167]
 ds_read_b128 a[72:75], v7 offset:18432
 ds_read_b128 a[76:79], v7 offset:19456
M v[168:171], a[104:107], v[48:51], v[168:171]
 v_cvt_pk_bf16_f32 v146, v152, v153
 v_cvt_pk_bf16_f32 v147, v154, v155
M v[168:171], a[108:111], v[56:59], v[168:171]
 buffer_store_dwordx4 v[144:147], v7, s[8:11], s86 offen offset:1024 sc1
M v[172:175], a[108:111], v[60:63], v[172:175]
 ds_read_b128 a[80:83], v7 offset:20480
 ds_read_b128 a[84:87], v7 offset:21504
M v[172:175], a[104:107], v[52:55], v[172:175]
 v_cvt_pk_bf16_f32 v148, v148, v149
 v_cvt_pk_bf16_f32 v149, v150, v151
M v[176:179], a[112:115], v[48:51], v[176:179]
 v_cvt_pk_bf16_f32 v150, v156, v157
 v_cvt_pk_bf16_f32 v151, v158, v159
M v[176:179], a[116:119], v[56:59], v[176:179]
 ds_read_b128 a[88:91], v7 offset:22528
 ds_read_b128 a[92:95], v7 offset:23552
M v[180:183], a[116:119], v[60:63], v[180:183]
 buffer_store_dwordx4 v[148:151], v7, s[8:11], s88 offen offset:1024 sc1
M v[180:183], a[112:115], v[52:55], v[180:183]
 v_cvt_pk_bf16_f32 v160, v160, v161
 v_cvt_pk_bf16_f32 v161, v162, v163
M v[184:187], a[120:123], v[48:51], v[184:187]
 v_cvt_pk_bf16_f32 v162, v168, v169
 v_cvt_pk_bf16_f32 v163, v170, v171
M v[184:187], a[124:127], v[56:59], v[184:187]
M v[188:191], a[124:127], v[60:63], v[188:191]
 buffer_store_dwordx4 v[160:163], v7, s[8:11], s86 offen offset:2048 sc1
M v[188:191], a[120:123], v[52:55], v[188:191]
 s_waitcnt lgkmcnt(0)
 v_cvt_pk_bf16_f32 v164, v164, v165
 v_cvt_pk_bf16_f32 v165, v166, v167
M v[192:195], a[64:67], v[48:51], v[192:195]
 ds_read_b128 a[96:99], v7 offset:24576
 ds_read_b128 a[100:103], v7 offset:25600
M v[192:195], a[68:71], v[56:59], v[192:195]
 v_cvt_pk_bf16_f32 v166, v172, v173
 v_cvt_pk_bf16_f32 v167, v174, v175
M v[196:199], a[68:71], v[60:63], v[196:199]
 buffer_store_dwordx4 v[164:167], v7, s[8:11], s88 offen offset:2048 sc1
M v[196:199], a[64:67], v[52:55], v[196:199]
 ds_read_b128 a[104:107], v7 offset:26624
 ds_read_b128 a[108:111], v7 offset:27648
M v[200:203], a[72:75], v[48:51], v[200:203]
 v_cvt_pk_bf16_f32 v176, v176, v177
 v_cvt_pk_bf16_f32 v177, v178, v179
M v[200:203], a[76:79], v[56:59], v[200:203]
 v_cvt_pk_bf16_f32 v178, v184, v185
 v_cvt_pk_bf16_f32 v179, v186, v187
M v[204:207], a[76:79], v[60:63], v[204:207]
 ds_read_b128 a[112:115], v7 offset:28672
 ds_read_b128 a[116:119], v7 offset:29696
M v[204:207], a[72:75], v[52:55], v[204:207]
 buffer_store_dwordx4 v[176:179], v7, s[8:11], s86 offen offset:3072 sc1
M v[208:211], a[80:83], v[48:51], v[208:211]
 v_cvt_pk_bf16_f32 v180, v180, v181
 v_cvt_pk_bf16_f32 v181, v182, v183
M v[208:211], a[84:87], v[56:59], v[208:211]
 ds_read_b128 a[120:123], v7 offset:30720
 ds_read_b128 a[124:127], v7 offset:31744
M v[212:215], a[84:87], v[60:63], v[212:215]
 v_cvt_pk_bf16_f32 v182, v188, v189
 v_cvt_pk_bf16_f32 v183, v190, v191
M v[212:215], a[80:83], v[52:55], v[212:215]
 buffer_store_dwordx4 v[180:183], v7, s[8:11], s88 offen offset:3072 sc1
M v[216:219], a[88:91], v[48:51], v[216:219]
 v_cvt_pk_bf16_f32 v192, v192, v193
 v_cvt_pk_bf16_f32 v193, v194, v195
M v[216:219], a[92:95], v[56:59], v[216:219]
 v_cvt_pk_bf16_f32 v194, v200, v201
 v_cvt_pk_bf16_f32 v195, v202, v203
M v[220:223], a[92:95], v[60:63], v[220:223]
 s_waitcnt lgkmcnt(0)
M v[220:223], a[88:91], v[52:55], v[220:223]
 s_barrier
M v[224:227], a[96:99], v[48:51], v[224:227]
 ds_read_b128 a[64:67], v2 offset:32768
 ds_read_b128 a[68:71], v2 offset:33792
M v[224:227], a[100:103], v[56:59], v[224:227]
 buffer_store_dwordx4 v[192:195], v7, s[8:11], s87 offen offset:0 sc1
M v[228:231], a[100:103], v[60:63], v[228:231]
 v_cvt_pk_bf16_f32 v196, v196, v197
 v_cvt_pk_bf16_f32 v197, v198, v199
M v[228:231], a[96:99], v[52:55], v[228:231]
 ds_read_b128 a[72:75], v2 offset:34816
 ds_read_b128 a[76:79], v2 offset:35840
M v[232:235], a[104:107], v[48:51], v[232:235]
 v_cvt_pk_bf16_f32 v198, v204, v205
 v_cvt_pk_bf16_f32 v199, v206, v207
M v[232:235], a[108:111], v[56:59], v[232:235]
 buffer_store_dwordx4 v[196:199], v7, s[8:11], s89 offen offset:0 sc1
M v[236:239], a[108:111], v[60:63], v[236:239]
 ds_read_b128 a[80:83], v2 offset:36864
 ds_read_b128 a[84:87], v2 offset:37888
M v[236:239], a[104:107], v[52:55], v[236:239]
 v_cvt_pk_bf16_f32 v208, v208, v209
 v_cvt_pk_bf16_f32 v209, v210, v211
M v[240:243], a[112:115], v[48:51], v[240:243]
 v_cvt_pk_bf16_f32 v210, v216, v217
 v_cvt_pk_bf16_f32 v211, v218, v219
M v[240:243], a[116:119], v[56:59], v[240:243]
 ds_read_b128 a[88:91], v2 offset:38912
 ds_read_b128 a[92:95], v2 offset:39936
M v[244:247], a[116:119], v[60:63], v[244:247]
 buffer_store_dwordx4 v[208:211], v7, s[8:11], s87 offen offset:1024 sc1
M v[244:247], a[112:115], v[52:55], v[244:247]
 v_cvt_pk_bf16_f32 v212, v212, v213
 v_cvt_pk_bf16_f32 v213, v214, v215
M v[248:251], a[120:123], v[48:51], v[248:251]
 v_cvt_pk_bf16_f32 v214, v220, v221
 v_cvt_pk_bf16_f32 v215, v222, v223
M v[248:251], a[124:127], v[56:59], v[248:251]
M v[252:255], a[124:127], v[60:63], v[252:255]
 s_waitcnt lgkmcnt(0)
 buffer_store_dwordx4 v[212:215], v7, s[8:11], s89 offen offset:1024 sc1
M v[252:255], a[120:123], v[52:55], v[252:255]
 v_cvt_pk_bf16_f32 v224, v224, v225
 v_cvt_pk_bf16_f32 v225, v226, v227
 v_cvt_pk_bf16_f32 v226, v232, v233
 v_cvt_pk_bf16_f32 v227, v234, v235
 buffer_store_dwordx4 v[224:227], v7, s[8:11], s87 offen offset:2048 sc1
 v_cvt_pk_bf16_f32 v228, v228, v229
 v_cvt_pk_bf16_f32 v229, v230, v231
 v_cvt_pk_bf16_f32 v230, v236, v237
 v_cvt_pk_bf16_f32 v231, v238, v239
 buffer_store_dwordx4 v[228:231], v7, s[8:11], s89 offen offset:2048 sc1
 v_cvt_pk_bf16_f32 v240, v240, v241
 v_cvt_pk_bf16_f32 v241, v242, v243
 v_cvt_pk_bf16_f32 v242, v248, v249
 v_cvt_pk_bf16_f32 v243, v250, v251
 buffer_store_dwordx4 v[240:243], v7, s[8:11], s87 offen offset:3072 sc1
 v_cvt_pk_bf16_f32 v244, v244, v245
 v_cvt_pk_bf16_f32 v245, v246, v247
 v_cvt_pk_bf16_f32 v246, v252, v253
 v_cvt_pk_bf16_f32 v247, v254, v255
 buffer_store_dwordx4 v[244:247], v7, s[8:11], s89 offen offset:3072 sc1
M v[64:67], a[64:67], a[128:131], 0
 s_add_u32 m0, s28, 0
 ds_read_b128 a[96:99], v2 offset:40960
 ds_read_b128 a[100:103], v2 offset:41984
M v[64:67], a[68:71], a[132:135], v[64:67]
 buffer_load_dwordx4 v3, s[8:11], s38 offen offset:0 sc1 lds
M v[64:67], a[72:75], a[136:139], v[64:67]
M v[64:67], a[76:79], a[140:143], v[64:67]
 s_sub_u32 s64, 15, s42
 ds_read_b128 a[104:107], v2 offset:43008
 ds_read_b128 a[108:111], v2 offset:44032
M v[64:67], a[80:83], a[144:147], v[64:67]
 s_min_u32 s64, s64, s42
M v[64:67], a[84:87], a[148:151], v[64:67]
 s_mul_i32 s45, s64, 8704
M v[64:67], a[88:91], a[152:155], v[64:67]
 s_and_b32 s64, s42, 8
 ds_read_b128 a[112:115], v2 offset:45056
 ds_read_b128 a[116:119], v2 offset:46080
M v[64:67], a[92:95], a[156:159], v[64:67]
 s_lshl_b32 s64, s64, 1
 buffer_load_dwordx4 v3, s[8:11], s38 offen offset:1024 sc1 lds
M v[68:71], a[92:95], a[188:191], 0
 s_add_u32 s64, s64, s41
M v[68:71], a[88:91], a[184:187], v[68:71]
 s_lshl_b32 s64, s64, 2
 ds_read_b128 a[120:123], v2 offset:47104
 ds_read_b128 a[124:127], v2 offset:48128
M v[68:71], a[84:87], a[180:183], v[68:71]
 s_add_u32 s45, s45, s64
M v[68:71], a[80:83], a[176:179], v[68:71]
 s_add_u32 s45, s45, 104992768
M v[68:71], a[76:79], a[172:175], v[68:71]
 s_lshl_b32 s64, s20, 8
 buffer_load_dwordx4 v3, s[8:11], s38 offen offset:2048 sc1 lds
M v[68:71], a[72:75], a[168:171], v[68:71]
 s_add_u32 s45, s45, s64
M v[68:71], a[68:71], a[164:167], v[68:71]
 s_add_u32 s3, s45, 4352
 v_lshrrev_b32 v17, 5, v7
 v_min_u32 v17, 1, v17
M v[68:71], a[64:67], a[160:163], v[68:71]
 s_waitcnt lgkmcnt(0)
 v_lshlrev_b32 v16, 3, v7
 v_lshl_or_b32 v16, v17, 29, v16
M v[72:75], a[96:99], a[128:131], 0
 ds_read_b128 a[64:67], v2 offset:49152
 ds_read_b128 a[68:71], v2 offset:50176
M v[72:75], a[100:103], a[132:135], v[72:75]
 buffer_load_dwordx4 v3, s[8:11], s38 offen offset:3072 sc1 lds
M v[72:75], a[104:107], a[136:139], v[72:75]
 v_mov_b32 v15, 1
 v_accvgpr_read_b32 v5, a192
M v[72:75], a[108:111], a[140:143], v[72:75]
 ds_read_b128 a[72:75], v2 offset:51200
 ds_read_b128 a[76:79], v2 offset:52224
M v[72:75], a[112:115], a[144:147], v[72:75]
 v_accvgpr_read_b32 v6, a193
M v[72:75], a[116:119], a[148:151], v[72:75]
 s_mov_b32 s79, 104923136
 buffer_load_dword v24, off, s[8:11], s79 sc1
M v[72:75], a[120:123], a[152:155], v[72:75]
 s_add_u32 m0, s28, 4096
 ds_read_b128 a[80:83], v2 offset:53248
 ds_read_b128 a[84:87], v2 offset:54272
M v[72:75], a[124:127], a[156:159], v[72:75]
 buffer_load_dwordx4 v4, s[8:11], s38 offen offset:0 sc1 lds
M v[76:79], a[124:127], a[188:191], 0
 v_lshrrev_b32 v0, 4, v7
 v_and_b32 v14, 15, v0
M v[76:79], a[120:123], a[184:187], v[76:79]
 ds_read_b128 a[88:91], v2 offset:55296
 ds_read_b128 a[92:95], v2 offset:56320
M v[76:79], a[116:119], a[180:183], v[76:79]
 v_lshlrev_b32 v14, 2, v14
 v_lshrrev_b32 v11, 4, v0
M v[76:79], a[112:115], a[176:179], v[76:79]
 s_mov_b32 s52, s96
M v[76:79], a[108:111], a[172:175], v[76:79]
 s_and_b32 s53, s97, 0xffff
 buffer_load_dwordx4 v4, s[8:11], s38 offen offset:1024 sc1 lds
M v[76:79], a[104:107], a[168:171], v[76:79]
 s_mov_b32 s54, 1835008
M v[76:79], a[100:103], a[164:167], v[76:79]
 s_mov_b32 s55, 0x20000
 s_lshr_b32 s74, s41, 3
 s_xor_b32 s74, s74, 0
M v[76:79], a[96:99], a[160:163], v[76:79]
 s_waitcnt lgkmcnt(0)
 s_mul_i32 s67, s74, -2
M v[80:83], a[64:67], a[128:131], 0
 s_mul_i32 s74, s74, 8
 ds_read_b128 a[96:99], v2 offset:57344
 ds_read_b128 a[100:103], v2 offset:58368
M v[80:83], a[68:71], a[132:135], v[80:83]
 s_add_u32 s74, s74, s20
M v[80:83], a[72:75], a[136:139], v[80:83]
 s_lshl_b32 s75, s74, 6
 buffer_load_dwordx4 v4, s[8:11], s38 offen offset:2048 sc1 lds
M v[80:83], a[76:79], a[140:143], v[80:83]
 s_add_u32 s76, s75, 256
 ds_read_b128 a[104:107], v2 offset:59392
 ds_read_b128 a[108:111], v2 offset:60416
M v[80:83], a[80:83], a[144:147], v[80:83]
 s_add_u32 s67, s67, 3
M v[80:83], a[84:87], a[148:151], v[80:83]
 s_sub_u32 s67, s67, s20
M v[80:83], a[88:91], a[152:155], v[80:83]
 s_and_b32 s67, s67, 536870912
 ds_read_b128 a[112:115], v2 offset:61440
 ds_read_b128 a[116:119], v2 offset:62464
M v[80:83], a[92:95], a[156:159], v[80:83]
 s_or_b32 s76, s76, s67
 buffer_load_dwordx4 v4, s[8:11], s38 offen offset:3072 sc1 lds
M v[84:87], a[92:95], a[188:191], 0
 s_add_u32 s38, s38, 32768
 v_or_b32 v27, s67, v7
 v_add_u32 v27, 4096, v27
M v[84:87], a[88:91], a[184:187], v[84:87]
 ds_read_b128 a[120:123], v2 offset:63488
 ds_read_b128 a[124:127], v2 offset:64512
M v[84:87], a[84:87], a[180:183], v[84:87]
M v[84:87], a[80:83], a[176:179], v[84:87]
M v[84:87], a[76:79], a[172:175], v[84:87]
M v[84:87], a[72:75], a[168:171], v[84:87]
M v[84:87], a[68:71], a[164:167], v[84:87]
 s_waitcnt vmcnt(9) lgkmcnt(0)
M v[84:87], a[64:67], a[160:163], v[84:87]
 s_barrier
M v[88:91], a[96:99], a[128:131], 0
 ds_read_b128 a[64:67], v7 offset:32768
 ds_read_b128 a[68:71], v7 offset:33792
M v[88:91], a[100:103], a[132:135], v[88:91]
 buffer_store_dword v15, v1, s[8:11], s47 offen sc1
M v[88:91], a[104:107], a[136:139], v[88:91]
M v[88:91], a[108:111], a[140:143], v[88:91]
 ds_read_b128 a[72:75], v7 offset:34816
 ds_read_b128 a[76:79], v7 offset:35840
M v[88:91], a[112:115], a[144:147], v[88:91]
M v[88:91], a[116:119], a[148:151], v[88:91]
M v[88:91], a[120:123], a[152:155], v[88:91]
 ds_read_b128 a[80:83], v7 offset:36864
 ds_read_b128 a[84:87], v7 offset:37888
M v[88:91], a[124:127], a[156:159], v[88:91]
M v[92:95], a[124:127], a[188:191], 0
M v[92:95], a[120:123], a[184:187], v[92:95]
 ds_read_b128 a[88:91], v7 offset:38912
 ds_read_b128 a[92:95], v7 offset:39936
M v[92:95], a[116:119], a[180:183], v[92:95]
M v[92:95], a[112:115], a[176:179], v[92:95]
M v[92:95], a[108:111], a[172:175], v[92:95]
M v[92:95], a[104:107], a[168:171], v[92:95]
M v[92:95], a[100:103], a[164:167], v[92:95]
 s_waitcnt lgkmcnt(0)
M v[92:95], a[96:99], a[160:163], v[92:95]
M v[96:99], a[64:67], a[128:131], 0
 s_add_u32 m0, s28, 98304
 ds_read_b128 a[96:99], v7 offset:40960
 ds_read_b128 a[100:103], v7 offset:41984
M v[96:99], a[68:71], a[132:135], v[96:99]
 buffer_load_dwordx4 v3, s[8:11], s38 offen offset:0 sc1 lds
M v[96:99], a[72:75], a[136:139], v[96:99]
M v[96:99], a[76:79], a[140:143], v[96:99]
 ds_read_b128 a[104:107], v7 offset:43008
 ds_read_b128 a[108:111], v7 offset:44032
M v[96:99], a[80:83], a[144:147], v[96:99]
 s_add_u32 s29, s33, 0
 s_add_u32 s30, s33, 14336
M v[96:99], a[84:87], a[148:151], v[96:99]
 v_mul_f32 v64, v5, v64
 v_mul_f32 v65, v5, v65
M v[96:99], a[88:91], a[152:155], v[96:99]
 ds_read_b128 a[112:115], v7 offset:45056
 ds_read_b128 a[116:119], v7 offset:46080
M v[96:99], a[92:95], a[156:159], v[96:99]
 buffer_load_dwordx4 v3, s[8:11], s38 offen offset:1024 sc1 lds
M v[100:103], a[92:95], a[188:191], 0
 v_mul_f32 v66, v5, v66
 v_mul_f32 v67, v5, v67
M v[100:103], a[88:91], a[184:187], v[100:103]
 ds_read_b128 a[120:123], v7 offset:47104
 ds_read_b128 a[124:127], v7 offset:48128
M v[100:103], a[84:87], a[180:183], v[100:103]
 v_mul_f32 v72, v5, v72
 v_mul_f32 v73, v5, v73
M v[100:103], a[80:83], a[176:179], v[100:103]
 v_mul_f32 v74, v5, v74
 v_mul_f32 v75, v5, v75
M v[100:103], a[76:79], a[172:175], v[100:103]
 buffer_load_dwordx4 v3, s[8:11], s38 offen offset:2048 sc1 lds
M v[100:103], a[72:75], a[168:171], v[100:103]
 v_cvt_pk_bf16_f32 v64, v64, v65
 v_cvt_pk_bf16_f32 v65, v66, v67
M v[100:103], a[68:71], a[164:167], v[100:103]
 v_cvt_pk_bf16_f32 v66, v72, v73
M v[100:103], a[64:67], a[160:163], v[100:103]
 s_waitcnt lgkmcnt(0)
 v_cvt_pk_bf16_f32 v67, v74, v75
M v[104:107], a[96:99], a[128:131], 0
 ds_read_b128 a[64:67], v7 offset:49152
 ds_read_b128 a[68:71], v7 offset:50176
M v[104:107], a[100:103], a[132:135], v[104:107]
 buffer_load_dwordx4 v3, s[8:11], s38 offen offset:3072 sc1 lds
M v[104:107], a[104:107], a[136:139], v[104:107]
 buffer_store_dwordx4 v[64:67], v7, s[8:11], s29 offen offset:0 sc1
M v[104:107], a[108:111], a[140:143], v[104:107]
 ds_read_b128 a[72:75], v7 offset:51200
 ds_read_b128 a[76:79], v7 offset:52224
M v[104:107], a[112:115], a[144:147], v[104:107]
 v_mul_f32 v68, v6, v68
 v_mul_f32 v69, v6, v69
M v[104:107], a[116:119], a[148:151], v[104:107]
 v_mul_f32 v70, v6, v70
 v_mul_f32 v71, v6, v71
M v[104:107], a[120:123], a[152:155], v[104:107]
 s_add_u32 m0, s28, 102400
 ds_read_b128 a[80:83], v7 offset:53248
 ds_read_b128 a[84:87], v7 offset:54272
M v[104:107], a[124:127], a[156:159], v[104:107]
 buffer_load_dwordx4 v4, s[8:11], s38 offen offset:0 sc1 lds
M v[108:111], a[124:127], a[188:191], 0
 v_mul_f32 v76, v6, v76
 v_mul_f32 v77, v6, v77
M v[108:111], a[120:123], a[184:187], v[108:111]
 ds_read_b128 a[88:91], v7 offset:55296
 ds_read_b128 a[92:95], v7 offset:56320
M v[108:111], a[116:119], a[180:183], v[108:111]
 v_mul_f32 v78, v6, v78
 v_mul_f32 v79, v6, v79
M v[108:111], a[112:115], a[176:179], v[108:111]
 v_cvt_pk_bf16_f32 v68, v68, v69
 v_cvt_pk_bf16_f32 v69, v70, v71
M v[108:111], a[108:111], a[172:175], v[108:111]
 buffer_load_dwordx4 v4, s[8:11], s38 offen offset:1024 sc1 lds
M v[108:111], a[104:107], a[168:171], v[108:111]
 v_cvt_pk_bf16_f32 v70, v76, v77
 v_cvt_pk_bf16_f32 v71, v78, v79
M v[108:111], a[100:103], a[164:167], v[108:111]
M v[108:111], a[96:99], a[160:163], v[108:111]
 s_waitcnt lgkmcnt(0)
 buffer_store_dwordx4 v[68:71], v7, s[8:11], s30 offen offset:0 sc1
M v[112:115], a[64:67], a[128:131], 0
 ds_read_b128 a[96:99], v7 offset:57344
 ds_read_b128 a[100:103], v7 offset:58368
M v[112:115], a[68:71], a[132:135], v[112:115]
 v_mul_f32 v80, v5, v80
 v_mul_f32 v81, v5, v81
M v[112:115], a[72:75], a[136:139], v[112:115]
 buffer_load_dwordx4 v4, s[8:11], s38 offen offset:2048 sc1 lds
M v[112:115], a[76:79], a[140:143], v[112:115]
 ds_read_b128 a[104:107], v7 offset:59392
 ds_read_b128 a[108:111], v7 offset:60416
M v[112:115], a[80:83], a[144:147], v[112:115]
 v_mul_f32 v82, v5, v82
 v_mul_f32 v83, v5, v83
M v[112:115], a[84:87], a[148:151], v[112:115]
 v_mul_f32 v88, v5, v88
 v_mul_f32 v89, v5, v89
M v[112:115], a[88:91], a[152:155], v[112:115]
 ds_read_b128 a[112:115], v7 offset:61440
 ds_read_b128 a[116:119], v7 offset:62464
M v[112:115], a[92:95], a[156:159], v[112:115]
 buffer_load_dwordx4 v4, s[8:11], s38 offen offset:3072 sc1 lds
M v[116:119], a[92:95], a[188:191], 0
 s_add_u32 s38, s38, 32768
 v_mul_f32 v90, v5, v90
 v_mul_f32 v91, v5, v91
M v[116:119], a[88:91], a[184:187], v[116:119]
 ds_read_b128 a[120:123], v7 offset:63488
 ds_read_b128 a[124:127], v7 offset:64512
M v[116:119], a[84:87], a[180:183], v[116:119]
 v_cvt_pk_bf16_f32 v80, v80, v81
 v_cvt_pk_bf16_f32 v81, v82, v83
M v[116:119], a[80:83], a[176:179], v[116:119]
 v_cvt_pk_bf16_f32 v82, v88, v89
 v_cvt_pk_bf16_f32 v83, v90, v91
M v[116:119], a[76:79], a[172:175], v[116:119]
 buffer_store_dwordx4 v[80:83], v7, s[8:11], s29 offen offset:1024 sc1
M v[116:119], a[72:75], a[168:171], v[116:119]
 v_mul_f32 v84, v6, v84
 v_mul_f32 v85, v6, v85
M v[116:119], a[68:71], a[164:167], v[116:119]
 s_waitcnt lgkmcnt(0)
 v_mul_f32 v86, v6, v86
M v[116:119], a[64:67], a[160:163], v[116:119]
 s_barrier
M v[120:123], a[96:99], a[128:131], 0
 ds_read_b128 a[64:67], v2 offset:0
 ds_read_b128 a[68:71], v2 offset:1024
M v[120:123], a[100:103], a[132:135], v[120:123]
 v_mul_f32 v87, v6, v87
 v_mul_f32 v92, v6, v92
M v[120:123], a[104:107], a[136:139], v[120:123]
 v_mul_f32 v93, v6, v93
 v_mul_f32 v94, v6, v94
M v[120:123], a[108:111], a[140:143], v[120:123]
 ds_read_b128 a[72:75], v2 offset:2048
 ds_read_b128 a[76:79], v2 offset:3072
M v[120:123], a[112:115], a[144:147], v[120:123]
 v_mul_f32 v95, v6, v95
 v_cvt_pk_bf16_f32 v84, v84, v85
M v[120:123], a[116:119], a[148:151], v[120:123]
 v_cvt_pk_bf16_f32 v85, v86, v87
M v[120:123], a[120:123], a[152:155], v[120:123]
 ds_read_b128 a[80:83], v2 offset:4096
 ds_read_b128 a[84:87], v2 offset:5120
M v[120:123], a[124:127], a[156:159], v[120:123]
 v_cvt_pk_bf16_f32 v86, v92, v93
 v_cvt_pk_bf16_f32 v87, v94, v95
M v[124:127], a[124:127], a[188:191], 0
 buffer_store_dwordx4 v[84:87], v7, s[8:11], s30 offen offset:1024 sc1
M v[124:127], a[120:123], a[184:187], v[124:127]
 ds_read_b128 a[88:91], v2 offset:6144
 ds_read_b128 a[92:95], v2 offset:7168
M v[124:127], a[116:119], a[180:183], v[124:127]
M v[124:127], a[112:115], a[176:179], v[124:127]
M v[124:127], a[108:111], a[172:175], v[124:127]
M v[124:127], a[104:107], a[168:171], v[124:127]
M v[124:127], a[100:103], a[164:167], v[124:127]
 s_waitcnt lgkmcnt(0)
M v[124:127], a[96:99], a[160:163], v[124:127]
M v[64:67], a[64:67], a[128:131], 0
 s_add_u32 m0, s28, 32768
 ds_read_b128 a[96:99], v2 offset:8192
 ds_read_b128 a[100:103], v2 offset:9216
M v[64:67], a[68:71], a[132:135], v[64:67]
 buffer_load_dwordx4 v3, s[8:11], s38 offen offset:0 sc1 lds
M v[64:67], a[72:75], a[136:139], v[64:67]
M v[64:67], a[76:79], a[140:143], v[64:67]
 ds_read_b128 a[104:107], v2 offset:10240
 ds_read_b128 a[108:111], v2 offset:11264
M v[64:67], a[80:83], a[144:147], v[64:67]
 s_add_u32 s29, s33, 2048
 s_add_u32 s30, s33, 16384
M v[64:67], a[84:87], a[148:151], v[64:67]
 v_mul_f32 v96, v5, v96
 v_mul_f32 v97, v5, v97
M v[64:67], a[88:91], a[152:155], v[64:67]
 ds_read_b128 a[112:115], v2 offset:12288
 ds_read_b128 a[116:119], v2 offset:13312
M v[64:67], a[92:95], a[156:159], v[64:67]
 buffer_load_dwordx4 v3, s[8:11], s38 offen offset:1024 sc1 lds
M v[68:71], a[92:95], a[188:191], 0
 v_mul_f32 v98, v5, v98
 v_mul_f32 v99, v5, v99
M v[68:71], a[88:91], a[184:187], v[68:71]
 ds_read_b128 a[120:123], v2 offset:14336
 ds_read_b128 a[124:127], v2 offset:15360
M v[68:71], a[84:87], a[180:183], v[68:71]
 v_mul_f32 v104, v5, v104
 v_mul_f32 v105, v5, v105
M v[68:71], a[80:83], a[176:179], v[68:71]
 v_mul_f32 v106, v5, v106
 v_mul_f32 v107, v5, v107
M v[68:71], a[76:79], a[172:175], v[68:71]
 buffer_load_dwordx4 v3, s[8:11], s38 offen offset:2048 sc1 lds
M v[68:71], a[72:75], a[168:171], v[68:71]
 v_cvt_pk_bf16_f32 v96, v96, v97
 v_cvt_pk_bf16_f32 v97, v98, v99
M v[68:71], a[68:71], a[164:167], v[68:71]
 v_cvt_pk_bf16_f32 v98, v104, v105
M v[68:71], a[64:67], a[160:163], v[68:71]
 s_waitcnt lgkmcnt(0)
 v_cvt_pk_bf16_f32 v99, v106, v107
M v[72:75], a[96:99], a[128:131], 0
 ds_read_b128 a[64:67], v2 offset:16384
 ds_read_b128 a[68:71], v2 offset:17408
M v[72:75], a[100:103], a[132:135], v[72:75]
 buffer_load_dwordx4 v3, s[8:11], s38 offen offset:3072 sc1 lds
M v[72:75], a[104:107], a[136:139], v[72:75]
 buffer_store_dwordx4 v[96:99], v7, s[8:11], s29 offen offset:0 sc1
M v[72:75], a[108:111], a[140:143], v[72:75]
 ds_read_b128 a[72:75], v2 offset:18432
 ds_read_b128 a[76:79], v2 offset:19456
M v[72:75], a[112:115], a[144:147], v[72:75]
 v_mul_f32 v100, v6, v100
 v_mul_f32 v101, v6, v101
M v[72:75], a[116:119], a[148:151], v[72:75]
 v_mul_f32 v102, v6, v102
 v_mul_f32 v103, v6, v103
M v[72:75], a[120:123], a[152:155], v[72:75]
 s_add_u32 m0, s28, 36864
 ds_read_b128 a[80:83], v2 offset:20480
 ds_read_b128 a[84:87], v2 offset:21504
M v[72:75], a[124:127], a[156:159], v[72:75]
 buffer_load_dwordx4 v4, s[8:11], s38 offen offset:0 sc1 lds
M v[76:79], a[124:127], a[188:191], 0
 v_mul_f32 v108, v6, v108
 v_mul_f32 v109, v6, v109
M v[76:79], a[120:123], a[184:187], v[76:79]
 ds_read_b128 a[88:91], v2 offset:22528
 ds_read_b128 a[92:95], v2 offset:23552
M v[76:79], a[116:119], a[180:183], v[76:79]
 v_mul_f32 v110, v6, v110
 v_mul_f32 v111, v6, v111
M v[76:79], a[112:115], a[176:179], v[76:79]
 v_cvt_pk_bf16_f32 v100, v100, v101
 v_cvt_pk_bf16_f32 v101, v102, v103
M v[76:79], a[108:111], a[172:175], v[76:79]
 buffer_load_dwordx4 v4, s[8:11], s38 offen offset:1024 sc1 lds
M v[76:79], a[104:107], a[168:171], v[76:79]
 v_cvt_pk_bf16_f32 v102, v108, v109
 v_cvt_pk_bf16_f32 v103, v110, v111
M v[76:79], a[100:103], a[164:167], v[76:79]
M v[76:79], a[96:99], a[160:163], v[76:79]
 s_waitcnt lgkmcnt(0)
 buffer_store_dwordx4 v[100:103], v7, s[8:11], s30 offen offset:0 sc1
M v[80:83], a[64:67], a[128:131], 0
 ds_read_b128 a[96:99], v2 offset:24576
 ds_read_b128 a[100:103], v2 offset:25600
M v[80:83], a[68:71], a[132:135], v[80:83]
 v_mul_f32 v112, v5, v112
 v_mul_f32 v113, v5, v113
M v[80:83], a[72:75], a[136:139], v[80:83]
 buffer_load_dwordx4 v4, s[8:11], s38 offen offset:2048 sc1 lds
M v[80:83], a[76:79], a[140:143], v[80:83]
 ds_read_b128 a[104:107], v2 offset:26624
 ds_read_b128 a[108:111], v2 offset:27648
M v[80:83], a[80:83], a[144:147], v[80:83]
 v_mul_f32 v114, v5, v114
 v_mul_f32 v115, v5, v115
M v[80:83], a[84:87], a[148:151], v[80:83]
 v_mul_f32 v120, v5, v120
 v_mul_f32 v121, v5, v121
M v[80:83], a[88:91], a[152:155], v[80:83]
 ds_read_b128 a[112:115], v2 offset:28672
 ds_read_b128 a[116:119], v2 offset:29696
M v[80:83], a[92:95], a[156:159], v[80:83]
 buffer_load_dwordx4 v4, s[8:11], s38 offen offset:3072 sc1 lds
M v[84:87], a[92:95], a[188:191], 0
 s_add_u32 s38, s38, 32768
 v_mul_f32 v122, v5, v122
 v_mul_f32 v123, v5, v123
M v[84:87], a[88:91], a[184:187], v[84:87]
 ds_read_b128 a[120:123], v2 offset:30720
 ds_read_b128 a[124:127], v2 offset:31744
M v[84:87], a[84:87], a[180:183], v[84:87]
 v_cvt_pk_bf16_f32 v112, v112, v113
 v_cvt_pk_bf16_f32 v113, v114, v115
M v[84:87], a[80:83], a[176:179], v[84:87]
 v_cvt_pk_bf16_f32 v114, v120, v121
 v_cvt_pk_bf16_f32 v115, v122, v123
M v[84:87], a[76:79], a[172:175], v[84:87]
 buffer_store_dwordx4 v[112:115], v7, s[8:11], s29 offen offset:1024 sc1
M v[84:87], a[72:75], a[168:171], v[84:87]
 v_mul_f32 v116, v6, v116
 v_mul_f32 v117, v6, v117
M v[84:87], a[68:71], a[164:167], v[84:87]
 s_waitcnt vmcnt(24) lgkmcnt(0)
 v_mul_f32 v118, v6, v118
M v[84:87], a[64:67], a[160:163], v[84:87]
 s_barrier
M v[88:91], a[96:99], a[128:131], 0
 ds_read_b128 a[64:67], v7 offset:0
 ds_read_b128 a[68:71], v7 offset:1024
M v[88:91], a[100:103], a[132:135], v[88:91]
 v_mul_f32 v119, v6, v119
 v_mul_f32 v124, v6, v124
M v[88:91], a[104:107], a[136:139], v[88:91]
 v_mul_f32 v125, v6, v125
 v_mul_f32 v126, v6, v126
M v[88:91], a[108:111], a[140:143], v[88:91]
 ds_read_b128 a[72:75], v7 offset:2048
 ds_read_b128 a[76:79], v7 offset:3072
M v[88:91], a[112:115], a[144:147], v[88:91]
 v_mul_f32 v127, v6, v127
 v_cvt_pk_bf16_f32 v116, v116, v117
M v[88:91], a[116:119], a[148:151], v[88:91]
 v_cvt_pk_bf16_f32 v117, v118, v119
M v[88:91], a[120:123], a[152:155], v[88:91]
 ds_read_b128 a[80:83], v7 offset:4096
 ds_read_b128 a[84:87], v7 offset:5120
M v[88:91], a[124:127], a[156:159], v[88:91]
 v_cvt_pk_bf16_f32 v118, v124, v125
 v_cvt_pk_bf16_f32 v119, v126, v127
M v[92:95], a[124:127], a[188:191], 0
 buffer_store_dwordx4 v[116:119], v7, s[8:11], s30 offen offset:1024 sc1
M v[92:95], a[120:123], a[184:187], v[92:95]
 ds_read_b128 a[88:91], v7 offset:6144
 ds_read_b128 a[92:95], v7 offset:7168
M v[92:95], a[116:119], a[180:183], v[92:95]
M v[92:95], a[112:115], a[176:179], v[92:95]
M v[92:95], a[108:111], a[172:175], v[92:95]
M v[92:95], a[104:107], a[168:171], v[92:95]
M v[92:95], a[100:103], a[164:167], v[92:95]
 s_waitcnt lgkmcnt(0)
M v[92:95], a[96:99], a[160:163], v[92:95]
M v[96:99], a[64:67], a[128:131], 0
 s_add_u32 m0, s28, 65536
 ds_read_b128 a[96:99], v7 offset:8192
 ds_read_b128 a[100:103], v7 offset:9216
M v[96:99], a[68:71], a[132:135], v[96:99]
 buffer_load_dwordx4 v3, s[8:11], s38 offen offset:0 sc1 lds
M v[96:99], a[72:75], a[136:139], v[96:99]
M v[96:99], a[76:79], a[140:143], v[96:99]
 ds_read_b128 a[104:107], v7 offset:10240
 ds_read_b128 a[108:111], v7 offset:11264
M v[96:99], a[80:83], a[144:147], v[96:99]
 s_add_u32 s29, s33, 4096
 s_add_u32 s30, s33, 18432
M v[96:99], a[84:87], a[148:151], v[96:99]
 v_mul_f32 v64, v5, v64
 v_mul_f32 v65, v5, v65
M v[96:99], a[88:91], a[152:155], v[96:99]
 ds_read_b128 a[112:115], v7 offset:12288
 ds_read_b128 a[116:119], v7 offset:13312
M v[96:99], a[92:95], a[156:159], v[96:99]
 buffer_load_dwordx4 v3, s[8:11], s38 offen offset:1024 sc1 lds
M v[100:103], a[92:95], a[188:191], 0
 v_mul_f32 v66, v5, v66
 v_mul_f32 v67, v5, v67
M v[100:103], a[88:91], a[184:187], v[100:103]
 ds_read_b128 a[120:123], v7 offset:14336
 ds_read_b128 a[124:127], v7 offset:15360
M v[100:103], a[84:87], a[180:183], v[100:103]
 v_mul_f32 v72, v5, v72
 v_mul_f32 v73, v5, v73
M v[100:103], a[80:83], a[176:179], v[100:103]
 v_mul_f32 v74, v5, v74
 v_mul_f32 v75, v5, v75
M v[100:103], a[76:79], a[172:175], v[100:103]
 buffer_load_dwordx4 v3, s[8:11], s38 offen offset:2048 sc1 lds
M v[100:103], a[72:75], a[168:171], v[100:103]
 v_cvt_pk_bf16_f32 v64, v64, v65
 v_cvt_pk_bf16_f32 v65, v66, v67
M v[100:103], a[68:71], a[164:167], v[100:103]
 v_cvt_pk_bf16_f32 v66, v72, v73
M v[100:103], a[64:67], a[160:163], v[100:103]
 s_waitcnt lgkmcnt(0)
 v_cvt_pk_bf16_f32 v67, v74, v75
M v[104:107], a[96:99], a[128:131], 0
 ds_read_b128 a[64:67], v7 offset:16384
 ds_read_b128 a[68:71], v7 offset:17408
M v[104:107], a[100:103], a[132:135], v[104:107]
 buffer_load_dwordx4 v3, s[8:11], s38 offen offset:3072 sc1 lds
M v[104:107], a[104:107], a[136:139], v[104:107]
 buffer_store_dwordx4 v[64:67], v7, s[8:11], s29 offen offset:0 sc1
M v[104:107], a[108:111], a[140:143], v[104:107]
 ds_read_b128 a[72:75], v7 offset:18432
 ds_read_b128 a[76:79], v7 offset:19456
M v[104:107], a[112:115], a[144:147], v[104:107]
 v_mul_f32 v68, v6, v68
 v_mul_f32 v69, v6, v69
M v[104:107], a[116:119], a[148:151], v[104:107]
 v_mul_f32 v70, v6, v70
 v_mul_f32 v71, v6, v71
M v[104:107], a[120:123], a[152:155], v[104:107]
 s_add_u32 m0, s28, 69632
 ds_read_b128 a[80:83], v7 offset:20480
 ds_read_b128 a[84:87], v7 offset:21504
M v[104:107], a[124:127], a[156:159], v[104:107]
 buffer_load_dwordx4 v4, s[8:11], s38 offen offset:0 sc1 lds
M v[108:111], a[124:127], a[188:191], 0
 v_mul_f32 v76, v6, v76
 v_mul_f32 v77, v6, v77
M v[108:111], a[120:123], a[184:187], v[108:111]
 ds_read_b128 a[88:91], v7 offset:22528
 ds_read_b128 a[92:95], v7 offset:23552
M v[108:111], a[116:119], a[180:183], v[108:111]
 v_mul_f32 v78, v6, v78
 v_mul_f32 v79, v6, v79
M v[108:111], a[112:115], a[176:179], v[108:111]
 v_cvt_pk_bf16_f32 v68, v68, v69
 v_cvt_pk_bf16_f32 v69, v70, v71
M v[108:111], a[108:111], a[172:175], v[108:111]
 buffer_load_dwordx4 v4, s[8:11], s38 offen offset:1024 sc1 lds
M v[108:111], a[104:107], a[168:171], v[108:111]
 v_cvt_pk_bf16_f32 v70, v76, v77
 v_cvt_pk_bf16_f32 v71, v78, v79
M v[108:111], a[100:103], a[164:167], v[108:111]
M v[108:111], a[96:99], a[160:163], v[108:111]
 s_waitcnt lgkmcnt(0)
 buffer_store_dwordx4 v[68:71], v7, s[8:11], s30 offen offset:0 sc1
M v[112:115], a[64:67], a[128:131], 0
 ds_read_b128 a[96:99], v7 offset:24576
 ds_read_b128 a[100:103], v7 offset:25600
M v[112:115], a[68:71], a[132:135], v[112:115]
 v_mul_f32 v80, v5, v80
 v_mul_f32 v81, v5, v81
M v[112:115], a[72:75], a[136:139], v[112:115]
 buffer_load_dwordx4 v4, s[8:11], s38 offen offset:2048 sc1 lds
M v[112:115], a[76:79], a[140:143], v[112:115]
 ds_read_b128 a[104:107], v7 offset:26624
 ds_read_b128 a[108:111], v7 offset:27648
M v[112:115], a[80:83], a[144:147], v[112:115]
 v_mul_f32 v82, v5, v82
 v_mul_f32 v83, v5, v83
M v[112:115], a[84:87], a[148:151], v[112:115]
 v_mul_f32 v88, v5, v88
 v_mul_f32 v89, v5, v89
M v[112:115], a[88:91], a[152:155], v[112:115]
 ds_read_b128 a[112:115], v7 offset:28672
 ds_read_b128 a[116:119], v7 offset:29696
M v[112:115], a[92:95], a[156:159], v[112:115]
 buffer_load_dwordx4 v4, s[8:11], s38 offen offset:3072 sc1 lds
M v[116:119], a[92:95], a[188:191], 0
 s_add_u32 s38, s38, 32768
 v_mul_f32 v90, v5, v90
 v_mul_f32 v91, v5, v91
M v[116:119], a[88:91], a[184:187], v[116:119]
 ds_read_b128 a[120:123], v7 offset:30720
 ds_read_b128 a[124:127], v7 offset:31744
M v[116:119], a[84:87], a[180:183], v[116:119]
 v_cvt_pk_bf16_f32 v80, v80, v81
 v_cvt_pk_bf16_f32 v81, v82, v83
M v[116:119], a[80:83], a[176:179], v[116:119]
 v_cvt_pk_bf16_f32 v82, v88, v89
 v_cvt_pk_bf16_f32 v83, v90, v91
M v[116:119], a[76:79], a[172:175], v[116:119]
 buffer_store_dwordx4 v[80:83], v7, s[8:11], s29 offen offset:1024 sc1
M v[116:119], a[72:75], a[168:171], v[116:119]
 v_mul_f32 v84, v6, v84
 v_mul_f32 v85, v6, v85
M v[116:119], a[68:71], a[164:167], v[116:119]
 s_waitcnt vmcnt(25) lgkmcnt(0)
 v_mul_f32 v86, v6, v86
M v[116:119], a[64:67], a[160:163], v[116:119]
 s_barrier
M v[120:123], a[96:99], a[128:131], 0
 ds_read_b128 a[64:67], v2 offset:32768
 ds_read_b128 a[68:71], v2 offset:33792
M v[120:123], a[100:103], a[132:135], v[120:123]
 v_mul_f32 v87, v6, v87
 v_mul_f32 v92, v6, v92
M v[120:123], a[104:107], a[136:139], v[120:123]
 v_mul_f32 v93, v6, v93
 v_mul_f32 v94, v6, v94
M v[120:123], a[108:111], a[140:143], v[120:123]
 ds_read_b128 a[72:75], v2 offset:34816
 ds_read_b128 a[76:79], v2 offset:35840
M v[120:123], a[112:115], a[144:147], v[120:123]
 v_mul_f32 v95, v6, v95
 v_cvt_pk_bf16_f32 v84, v84, v85
M v[120:123], a[116:119], a[148:151], v[120:123]
 v_cvt_pk_bf16_f32 v85, v86, v87
M v[120:123], a[120:123], a[152:155], v[120:123]
 ds_read_b128 a[80:83], v2 offset:36864
 ds_read_b128 a[84:87], v2 offset:37888
M v[120:123], a[124:127], a[156:159], v[120:123]
 v_cvt_pk_bf16_f32 v86, v92, v93
 v_cvt_pk_bf16_f32 v87, v94, v95
M v[124:127], a[124:127], a[188:191], 0
 buffer_store_dwordx4 v[84:87], v7, s[8:11], s30 offen offset:1024 sc1
M v[124:127], a[120:123], a[184:187], v[124:127]
 ds_read_b128 a[88:91], v2 offset:38912
 ds_read_b128 a[92:95], v2 offset:39936
M v[124:127], a[116:119], a[180:183], v[124:127]
M v[124:127], a[112:115], a[176:179], v[124:127]
M v[124:127], a[108:111], a[172:175], v[124:127]
M v[124:127], a[104:107], a[168:171], v[124:127]
M v[124:127], a[100:103], a[164:167], v[124:127]
 s_waitcnt lgkmcnt(0)
M v[124:127], a[96:99], a[160:163], v[124:127]
M v[64:67], a[64:67], a[128:131], 0
 ds_read_b128 a[96:99], v2 offset:40960
 ds_read_b128 a[100:103], v2 offset:41984
M v[64:67], a[68:71], a[132:135], v[64:67]
M v[64:67], a[72:75], a[136:139], v[64:67]
 v_cmp_gt_u32 vcc, 4, v24
M v[64:67], a[76:79], a[140:143], v[64:67]
 s_mov_b32 s65, 104890368
 ds_read_b128 a[104:107], v2 offset:43008
 ds_read_b128 a[108:111], v2 offset:44032
M v[64:67], a[80:83], a[144:147], v[64:67]
 s_cbranch_vccnz L_fhs0
L_fhr0:
 buffer_load_dword v25, v14, s[8:11], s65 offen sc1
M v[64:67], a[84:87], a[148:151], v[64:67]
 s_add_u32 s29, s33, 6144
 s_add_u32 s30, s33, 20480
M v[64:67], a[88:91], a[152:155], v[64:67]
 ds_read_b128 a[112:115], v2 offset:45056
 ds_read_b128 a[116:119], v2 offset:46080
M v[64:67], a[92:95], a[156:159], v[64:67]
 v_mul_f32 v96, v5, v96
 v_mul_f32 v97, v5, v97
M v[68:71], a[92:95], a[188:191], 0
 v_mul_f32 v98, v5, v98
 v_mul_f32 v99, v5, v99
M v[68:71], a[88:91], a[184:187], v[68:71]
 ds_read_b128 a[120:123], v2 offset:47104
 ds_read_b128 a[124:127], v2 offset:48128
M v[68:71], a[84:87], a[180:183], v[68:71]
 v_mul_f32 v104, v5, v104
 v_mul_f32 v105, v5, v105
M v[68:71], a[80:83], a[176:179], v[68:71]
 v_mul_f32 v106, v5, v106
 v_mul_f32 v107, v5, v107
M v[68:71], a[76:79], a[172:175], v[68:71]
 v_cvt_pk_bf16_f32 v96, v96, v97
M v[68:71], a[72:75], a[168:171], v[68:71]
 v_cvt_pk_bf16_f32 v97, v98, v99
M v[68:71], a[68:71], a[164:167], v[68:71]
 v_cvt_pk_bf16_f32 v98, v104, v105
M v[68:71], a[64:67], a[160:163], v[68:71]
 s_waitcnt lgkmcnt(0)
 v_cvt_pk_bf16_f32 v99, v106, v107
M v[72:75], a[96:99], a[128:131], 0
 ds_read_b128 a[64:67], v2 offset:49152
 ds_read_b128 a[68:71], v2 offset:50176
M v[72:75], a[100:103], a[132:135], v[72:75]
 buffer_store_dwordx4 v[96:99], v7, s[8:11], s29 offen offset:0 sc1
M v[72:75], a[104:107], a[136:139], v[72:75]
 v_mul_f32 v100, v6, v100
M v[72:75], a[108:111], a[140:143], v[72:75]
 ds_read_b128 a[72:75], v2 offset:51200
 ds_read_b128 a[76:79], v2 offset:52224
M v[72:75], a[112:115], a[144:147], v[72:75]
 v_mul_f32 v101, v6, v101
 v_mul_f32 v102, v6, v102
M v[72:75], a[116:119], a[148:151], v[72:75]
 v_mul_f32 v103, v6, v103
 v_mul_f32 v108, v6, v108
M v[72:75], a[120:123], a[152:155], v[72:75]
 ds_read_b128 a[80:83], v2 offset:53248
 ds_read_b128 a[84:87], v2 offset:54272
M v[72:75], a[124:127], a[156:159], v[72:75]
 v_mul_f32 v109, v6, v109
 v_mul_f32 v110, v6, v110
M v[76:79], a[124:127], a[188:191], 0
 v_mul_f32 v111, v6, v111
M v[76:79], a[120:123], a[184:187], v[76:79]
 ds_read_b128 a[88:91], v2 offset:55296
 ds_read_b128 a[92:95], v2 offset:56320
M v[76:79], a[116:119], a[180:183], v[76:79]
 v_cvt_pk_bf16_f32 v100, v100, v101
 v_cvt_pk_bf16_f32 v101, v102, v103
M v[76:79], a[112:115], a[176:179], v[76:79]
 v_cvt_pk_bf16_f32 v102, v108, v109
M v[76:79], a[108:111], a[172:175], v[76:79]
 v_cvt_pk_bf16_f32 v103, v110, v111
M v[76:79], a[104:107], a[168:171], v[76:79]
 buffer_store_dwordx4 v[100:103], v7, s[8:11], s30 offen offset:0 sc1
M v[76:79], a[100:103], a[164:167], v[76:79]
M v[76:79], a[96:99], a[160:163], v[76:79]
 s_waitcnt lgkmcnt(0)
 v_mul_f32 v112, v5, v112
M v[80:83], a[64:67], a[128:131], 0
 ds_read_b128 a[96:99], v2 offset:57344
 ds_read_b128 a[100:103], v2 offset:58368
M v[80:83], a[68:71], a[132:135], v[80:83]
 v_mul_f32 v113, v5, v113
 v_mul_f32 v114, v5, v114
M v[80:83], a[72:75], a[136:139], v[80:83]
 v_mul_f32 v115, v5, v115
M v[80:83], a[76:79], a[140:143], v[80:83]
 ds_read_b128 a[104:107], v2 offset:59392
 ds_read_b128 a[108:111], v2 offset:60416
M v[80:83], a[80:83], a[144:147], v[80:83]
 v_mul_f32 v120, v5, v120
 v_mul_f32 v121, v5, v121
M v[80:83], a[84:87], a[148:151], v[80:83]
 v_mul_f32 v122, v5, v122
M v[80:83], a[88:91], a[152:155], v[80:83]
 ds_read_b128 a[112:115], v2 offset:61440
 ds_read_b128 a[116:119], v2 offset:62464
M v[80:83], a[92:95], a[156:159], v[80:83]
 v_mul_f32 v123, v5, v123
 v_cvt_pk_bf16_f32 v112, v112, v113
M v[84:87], a[92:95], a[188:191], 0
 v_cvt_pk_bf16_f32 v113, v114, v115
 v_cvt_pk_bf16_f32 v114, v120, v121
M v[84:87], a[88:91], a[184:187], v[84:87]
 ds_read_b128 a[120:123], v2 offset:63488
 ds_read_b128 a[124:127], v2 offset:64512
M v[84:87], a[84:87], a[180:183], v[84:87]
 v_cvt_pk_bf16_f32 v115, v122, v123
M v[84:87], a[80:83], a[176:179], v[84:87]
 buffer_store_dwordx4 v[112:115], v7, s[8:11], s29 offen offset:1024 sc1
M v[84:87], a[76:79], a[172:175], v[84:87]
 v_mul_f32 v116, v6, v116
M v[84:87], a[72:75], a[168:171], v[84:87]
 v_mul_f32 v117, v6, v117
M v[84:87], a[68:71], a[164:167], v[84:87]
 s_waitcnt vmcnt(18) lgkmcnt(0)
 v_mul_f32 v118, v6, v118
M v[84:87], a[64:67], a[160:163], v[84:87]
 s_barrier
M v[88:91], a[96:99], a[128:131], 0
 ds_read_b128 a[64:67], v7 offset:32768
 ds_read_b128 a[68:71], v7 offset:33792
M v[88:91], a[100:103], a[132:135], v[88:91]
 v_mul_f32 v119, v6, v119
 v_mul_f32 v124, v6, v124
M v[88:91], a[104:107], a[136:139], v[88:91]
 v_mul_f32 v125, v6, v125
 v_mul_f32 v126, v6, v126
M v[88:91], a[108:111], a[140:143], v[88:91]
 ds_read_b128 a[72:75], v7 offset:34816
 ds_read_b128 a[76:79], v7 offset:35840
M v[88:91], a[112:115], a[144:147], v[88:91]
 v_mul_f32 v127, v6, v127
 v_cvt_pk_bf16_f32 v116, v116, v117
M v[88:91], a[116:119], a[148:151], v[88:91]
 v_cvt_pk_bf16_f32 v117, v118, v119
M v[88:91], a[120:123], a[152:155], v[88:91]
 ds_read_b128 a[80:83], v7 offset:36864
 ds_read_b128 a[84:87], v7 offset:37888
M v[88:91], a[124:127], a[156:159], v[88:91]
 v_cvt_pk_bf16_f32 v118, v124, v125
 v_cvt_pk_bf16_f32 v119, v126, v127
M v[92:95], a[124:127], a[188:191], 0
 buffer_store_dwordx4 v[116:119], v7, s[8:11], s30 offen offset:1024 sc1
M v[92:95], a[120:123], a[184:187], v[92:95]
 ds_read_b128 a[88:91], v7 offset:38912
 ds_read_b128 a[92:95], v7 offset:39936
M v[92:95], a[116:119], a[180:183], v[92:95]
M v[92:95], a[112:115], a[176:179], v[92:95]
M v[92:95], a[108:111], a[172:175], v[92:95]
M v[92:95], a[104:107], a[168:171], v[92:95]
M v[92:95], a[100:103], a[164:167], v[92:95]
 s_waitcnt lgkmcnt(0)
M v[92:95], a[96:99], a[160:163], v[92:95]
M v[96:99], a[64:67], a[128:131], 0
 ds_read_b128 a[96:99], v7 offset:40960
 ds_read_b128 a[100:103], v7 offset:41984
M v[96:99], a[68:71], a[132:135], v[96:99]
M v[96:99], a[72:75], a[136:139], v[96:99]
M v[96:99], a[76:79], a[140:143], v[96:99]
 ds_read_b128 a[104:107], v7 offset:43008
 ds_read_b128 a[108:111], v7 offset:44032
M v[96:99], a[80:83], a[144:147], v[96:99]
 s_add_u32 s29, s33, 8192
 s_add_u32 s30, s33, 22528
M v[96:99], a[84:87], a[148:151], v[96:99]
 v_mul_f32 v64, v5, v64
 v_mul_f32 v65, v5, v65
M v[96:99], a[88:91], a[152:155], v[96:99]
 ds_read_b128 a[112:115], v7 offset:45056
 ds_read_b128 a[116:119], v7 offset:46080
M v[96:99], a[92:95], a[156:159], v[96:99]
 v_mul_f32 v66, v5, v66
 v_mul_f32 v67, v5, v67
M v[100:103], a[92:95], a[188:191], 0
 v_mul_f32 v72, v5, v72
M v[100:103], a[88:91], a[184:187], v[100:103]
 ds_read_b128 a[120:123], v7 offset:47104
 ds_read_b128 a[124:127], v7 offset:48128
M v[100:103], a[84:87], a[180:183], v[100:103]
 v_mul_f32 v73, v5, v73
 v_mul_f32 v74, v5, v74
M v[100:103], a[80:83], a[176:179], v[100:103]
 v_mul_f32 v75, v5, v75
M v[100:103], a[76:79], a[172:175], v[100:103]
 v_cvt_pk_bf16_f32 v64, v64, v65
M v[100:103], a[72:75], a[168:171], v[100:103]
 v_cvt_pk_bf16_f32 v65, v66, v67
M v[100:103], a[68:71], a[164:167], v[100:103]
 v_cvt_pk_bf16_f32 v66, v72, v73
M v[100:103], a[64:67], a[160:163], v[100:103]
 s_waitcnt lgkmcnt(0)
 v_cvt_pk_bf16_f32 v67, v74, v75
M v[104:107], a[96:99], a[128:131], 0
 ds_read_b128 a[64:67], v7 offset:49152
 ds_read_b128 a[68:71], v7 offset:50176
M v[104:107], a[100:103], a[132:135], v[104:107]
 buffer_store_dwordx4 v[64:67], v7, s[8:11], s29 offen offset:0 sc1
M v[104:107], a[104:107], a[136:139], v[104:107]
 v_mul_f32 v68, v6, v68
M v[104:107], a[108:111], a[140:143], v[104:107]
 ds_read_b128 a[72:75], v7 offset:51200
 ds_read_b128 a[76:79], v7 offset:52224
M v[104:107], a[112:115], a[144:147], v[104:107]
 v_mul_f32 v69, v6, v69
 v_mul_f32 v70, v6, v70
M v[104:107], a[116:119], a[148:151], v[104:107]
 v_mul_f32 v71, v6, v71
 v_mul_f32 v76, v6, v76
M v[104:107], a[120:123], a[152:155], v[104:107]
 ds_read_b128 a[80:83], v7 offset:53248
 ds_read_b128 a[84:87], v7 offset:54272
M v[104:107], a[124:127], a[156:159], v[104:107]
 v_mul_f32 v77, v6, v77
 v_mul_f32 v78, v6, v78
M v[108:111], a[124:127], a[188:191], 0
 v_mul_f32 v79, v6, v79
M v[108:111], a[120:123], a[184:187], v[108:111]
 ds_read_b128 a[88:91], v7 offset:55296
 ds_read_b128 a[92:95], v7 offset:56320
M v[108:111], a[116:119], a[180:183], v[108:111]
 v_cvt_pk_bf16_f32 v68, v68, v69
 v_cvt_pk_bf16_f32 v69, v70, v71
M v[108:111], a[112:115], a[176:179], v[108:111]
 v_cvt_pk_bf16_f32 v70, v76, v77
M v[108:111], a[108:111], a[172:175], v[108:111]
 v_cvt_pk_bf16_f32 v71, v78, v79
M v[108:111], a[104:107], a[168:171], v[108:111]
 buffer_store_dwordx4 v[68:71], v7, s[8:11], s30 offen offset:0 sc1
M v[108:111], a[100:103], a[164:167], v[108:111]
M v[108:111], a[96:99], a[160:163], v[108:111]
 s_waitcnt lgkmcnt(0)
 v_mul_f32 v80, v5, v80
M v[112:115], a[64:67], a[128:131], 0
 ds_read_b128 a[96:99], v7 offset:57344
 ds_read_b128 a[100:103], v7 offset:58368
M v[112:115], a[68:71], a[132:135], v[112:115]
 v_mul_f32 v81, v5, v81
 v_mul_f32 v82, v5, v82
M v[112:115], a[72:75], a[136:139], v[112:115]
 v_mul_f32 v83, v5, v83
M v[112:115], a[76:79], a[140:143], v[112:115]
 ds_read_b128 a[104:107], v7 offset:59392
 ds_read_b128 a[108:111], v7 offset:60416
M v[112:115], a[80:83], a[144:147], v[112:115]
 v_mul_f32 v88, v5, v88
 v_mul_f32 v89, v5, v89
M v[112:115], a[84:87], a[148:151], v[112:115]
 v_mul_f32 v90, v5, v90
M v[112:115], a[88:91], a[152:155], v[112:115]
 ds_read_b128 a[112:115], v7 offset:61440
 ds_read_b128 a[116:119], v7 offset:62464
M v[112:115], a[92:95], a[156:159], v[112:115]
 v_mul_f32 v91, v5, v91
 v_cvt_pk_bf16_f32 v80, v80, v81
M v[116:119], a[92:95], a[188:191], 0
 s_waitcnt vmcnt(6)
 v_readlane_b32 s84, v25, 0
 v_readlane_b32 s85, v25, 1
M v[116:119], a[88:91], a[184:187], v[116:119]
 ds_read_b128 a[120:123], v7 offset:63488
 ds_read_b128 a[124:127], v7 offset:64512
M v[116:119], a[84:87], a[180:183], v[116:119]
 v_mov_b32 v24, 0x3f80
 v_mov_b32 v25, 0x3f800000
M v[116:119], a[80:83], a[176:179], v[116:119]
 v_cvt_pk_bf16_f32 v81, v82, v83
 v_cvt_pk_bf16_f32 v82, v88, v89
M v[116:119], a[76:79], a[172:175], v[116:119]
 v_cvt_pk_bf16_f32 v83, v90, v91
M v[116:119], a[72:75], a[168:171], v[116:119]
 buffer_store_dwordx4 v[80:83], v7, s[8:11], s29 offen offset:1024 sc1
M v[116:119], a[68:71], a[164:167], v[116:119]
 s_waitcnt lgkmcnt(0)
 v_mul_f32 v84, v6, v84
 v_mul_f32 v85, v6, v85
M v[116:119], a[64:67], a[160:163], v[116:119]
 s_barrier
M v[120:123], a[96:99], a[128:131], 0
 ds_read_b128 a[64:67], v2 offset:0
 ds_read_b128 a[68:71], v2 offset:1024
M v[120:123], a[100:103], a[132:135], v[120:123]
 v_mul_f32 v86, v6, v86
 v_mul_f32 v87, v6, v87
M v[120:123], a[104:107], a[136:139], v[120:123]
 v_mul_f32 v92, v6, v92
 v_mul_f32 v93, v6, v93
M v[120:123], a[108:111], a[140:143], v[120:123]
 ds_read_b128 a[72:75], v2 offset:2048
 ds_read_b128 a[76:79], v2 offset:3072
M v[120:123], a[112:115], a[144:147], v[120:123]
 v_mul_f32 v94, v6, v94
 v_mul_f32 v95, v6, v95
M v[120:123], a[116:119], a[148:151], v[120:123]
 s_waitcnt vmcnt(3)
 buffer_store_dword v15, v16, s[8:11], s45 offen sc1
M v[120:123], a[120:123], a[152:155], v[120:123]
 ds_read_b128 a[80:83], v2 offset:4096
 ds_read_b128 a[84:87], v2 offset:5120
M v[120:123], a[124:127], a[156:159], v[120:123]
 v_cvt_pk_bf16_f32 v84, v84, v85
 v_cvt_pk_bf16_f32 v85, v86, v87
M v[124:127], a[124:127], a[188:191], 0
 v_cvt_pk_bf16_f32 v86, v92, v93
 v_cvt_pk_bf16_f32 v87, v94, v95
M v[124:127], a[120:123], a[184:187], v[124:127]
 ds_read_b128 a[88:91], v2 offset:6144
 ds_read_b128 a[92:95], v2 offset:7168
M v[124:127], a[116:119], a[180:183], v[124:127]
 buffer_store_dwordx4 v[84:87], v7, s[8:11], s30 offen offset:1024 sc1
M v[124:127], a[112:115], a[176:179], v[124:127]
M v[124:127], a[108:111], a[172:175], v[124:127]
M v[124:127], a[104:107], a[168:171], v[124:127]
M v[124:127], a[100:103], a[164:167], v[124:127]
 s_waitcnt lgkmcnt(0)
M v[124:127], a[96:99], a[160:163], v[124:127]
M v[64:67], a[64:67], a[128:131], 0
 ds_read_b128 a[96:99], v2 offset:8192
M v[64:67], a[68:71], a[132:135], v[64:67]
 ds_read_b128 a[100:103], v2 offset:9216
M v[64:67], a[72:75], a[136:139], v[64:67]
M v[64:67], a[76:79], a[140:143], v[64:67]
 ds_read_b128 a[104:107], v2 offset:10240
 s_add_u32 s29, s33, 10240
M v[64:67], a[80:83], a[144:147], v[64:67]
 ds_read_b128 a[108:111], v2 offset:11264
 s_add_u32 s30, s33, 24576
M v[64:67], a[84:87], a[148:151], v[64:67]
 v_mul_f32 v96, v5, v96
 v_mul_f32 v97, v5, v97
M v[64:67], a[88:91], a[152:155], v[64:67]
 ds_read_b128 a[112:115], v2 offset:12288
 v_mul_f32 v98, v5, v98
M v[64:67], a[92:95], a[156:159], v[64:67]
 ds_read_b128 a[116:119], v2 offset:13312
 v_mul_f32 v99, v5, v99
M v[68:71], a[92:95], a[188:191], 0
 v_mul_f32 v104, v5, v104
 v_mul_f32 v105, v5, v105
M v[68:71], a[88:91], a[184:187], v[68:71]
 ds_read_b128 a[120:123], v2 offset:14336
 v_mul_f32 v106, v5, v106
M v[68:71], a[84:87], a[180:183], v[68:71]
 ds_read_b128 a[124:127], v2 offset:15360
 v_mul_f32 v107, v5, v107
M v[68:71], a[80:83], a[176:179], v[68:71]
 v_cvt_pk_bf16_f32 v96, v96, v97
 v_cvt_pk_bf16_f32 v97, v98, v99
M v[68:71], a[76:79], a[172:175], v[68:71]
 v_cvt_pk_bf16_f32 v98, v104, v105
 v_cvt_pk_bf16_f32 v99, v106, v107
M v[68:71], a[72:75], a[168:171], v[68:71]
 buffer_store_dwordx4 v[96:99], v7, s[8:11], s29 offen offset:0 sc1
M v[68:71], a[68:71], a[164:167], v[68:71]
 v_mul_f32 v100, v6, v100
 v_mul_f32 v101, v6, v101
M v[68:71], a[64:67], a[160:163], v[68:71]
 s_waitcnt lgkmcnt(0)
 v_mul_f32 v102, v6, v102
 v_mul_f32 v103, v6, v103
M v[72:75], a[96:99], a[128:131], 0
 ds_read_b128 a[64:67], v2 offset:16384
 v_mul_f32 v108, v6, v108
M v[72:75], a[100:103], a[132:135], v[72:75]
 ds_read_b128 a[68:71], v2 offset:17408
 v_mul_f32 v109, v6, v109
M v[72:75], a[104:107], a[136:139], v[72:75]
 v_mul_f32 v110, v6, v110
 v_mul_f32 v111, v6, v111
M v[72:75], a[108:111], a[140:143], v[72:75]
 ds_read_b128 a[72:75], v2 offset:18432
 v_cvt_pk_bf16_f32 v100, v100, v101
M v[72:75], a[112:115], a[144:147], v[72:75]
 ds_read_b128 a[76:79], v2 offset:19456
 v_cvt_pk_bf16_f32 v101, v102, v103
M v[72:75], a[116:119], a[148:151], v[72:75]
 v_cvt_pk_bf16_f32 v102, v108, v109
 v_cvt_pk_bf16_f32 v103, v110, v111
M v[72:75], a[120:123], a[152:155], v[72:75]
 ds_read_b128 a[80:83], v2 offset:20480
M v[72:75], a[124:127], a[156:159], v[72:75]
 ds_read_b128 a[84:87], v2 offset:21504
M v[76:79], a[124:127], a[188:191], 0
 buffer_store_dwordx4 v[100:103], v7, s[8:11], s30 offen offset:0 sc1
M v[76:79], a[120:123], a[184:187], v[76:79]
 ds_read_b128 a[88:91], v2 offset:22528
 v_mul_f32 v112, v5, v112
M v[76:79], a[116:119], a[180:183], v[76:79]
 ds_read_b128 a[92:95], v2 offset:23552
 v_mul_f32 v113, v5, v113
M v[76:79], a[112:115], a[176:179], v[76:79]
 v_mul_f32 v114, v5, v114
 v_mul_f32 v115, v5, v115
M v[76:79], a[108:111], a[172:175], v[76:79]
 v_mul_f32 v120, v5, v120
 v_mul_f32 v121, v5, v121
M v[76:79], a[104:107], a[168:171], v[76:79]
 v_mul_f32 v122, v5, v122
 v_mul_f32 v123, v5, v123
M v[76:79], a[100:103], a[164:167], v[76:79]
 v_cvt_pk_bf16_f32 v112, v112, v113
 v_cvt_pk_bf16_f32 v113, v114, v115
M v[76:79], a[96:99], a[160:163], v[76:79]
 s_waitcnt lgkmcnt(0)
 v_cvt_pk_bf16_f32 v114, v120, v121
 v_cvt_pk_bf16_f32 v115, v122, v123
M v[80:83], a[64:67], a[128:131], 0
 ds_read_b128 a[96:99], v2 offset:24576
M v[80:83], a[68:71], a[132:135], v[80:83]
 ds_read_b128 a[100:103], v2 offset:25600
M v[80:83], a[72:75], a[136:139], v[80:83]
 buffer_store_dwordx4 v[112:115], v7, s[8:11], s29 offen offset:1024 sc1
M v[80:83], a[76:79], a[140:143], v[80:83]
 ds_read_b128 a[104:107], v2 offset:26624
 v_mul_f32 v116, v6, v116
M v[80:83], a[80:83], a[144:147], v[80:83]
 ds_read_b128 a[108:111], v2 offset:27648
 v_mul_f32 v117, v6, v117
M v[80:83], a[84:87], a[148:151], v[80:83]
 v_mul_f32 v118, v6, v118
 v_mul_f32 v119, v6, v119
M v[80:83], a[88:91], a[152:155], v[80:83]
 ds_read_b128 a[112:115], v2 offset:28672
 v_mul_f32 v124, v6, v124
M v[80:83], a[92:95], a[156:159], v[80:83]
 ds_read_b128 a[116:119], v2 offset:29696
 v_mul_f32 v125, v6, v125
M v[84:87], a[92:95], a[188:191], 0
 v_mul_f32 v126, v6, v126
 v_mul_f32 v127, v6, v127
M v[84:87], a[88:91], a[184:187], v[84:87]
 ds_read_b128 a[120:123], v2 offset:30720
 v_cvt_pk_bf16_f32 v116, v116, v117
M v[84:87], a[84:87], a[180:183], v[84:87]
 ds_read_b128 a[124:127], v2 offset:31744
 v_cvt_pk_bf16_f32 v117, v118, v119
M v[84:87], a[80:83], a[176:179], v[84:87]
 v_cvt_pk_bf16_f32 v118, v124, v125
 v_cvt_pk_bf16_f32 v119, v126, v127
M v[84:87], a[76:79], a[172:175], v[84:87]
 buffer_store_dwordx4 v[116:119], v7, s[8:11], s30 offen offset:1024 sc1
M v[84:87], a[72:75], a[168:171], v[84:87]
 s_add_u32 s29, s33, 12288
M v[84:87], a[68:71], a[164:167], v[84:87]
 s_add_u32 s30, s33, 26624
 v_mul_f32 v64, v5, v64
 v_mul_f32 v65, v5, v65
M v[84:87], a[64:67], a[160:163], v[84:87]
 s_waitcnt lgkmcnt(0)
 v_mul_f32 v66, v5, v66
 v_mul_f32 v67, v5, v67
M v[88:91], a[96:99], a[128:131], 0
 v_mul_f32 v72, v5, v72
 v_mul_f32 v73, v5, v73
M v[88:91], a[100:103], a[132:135], v[88:91]
 v_mul_f32 v74, v5, v74
 v_mul_f32 v75, v5, v75
M v[88:91], a[104:107], a[136:139], v[88:91]
 v_cvt_pk_bf16_f32 v64, v64, v65
 v_cvt_pk_bf16_f32 v65, v66, v67
M v[88:91], a[108:111], a[140:143], v[88:91]
 v_cvt_pk_bf16_f32 v66, v72, v73
 v_cvt_pk_bf16_f32 v67, v74, v75
M v[88:91], a[112:115], a[144:147], v[88:91]
 buffer_store_dwordx4 v[64:67], v7, s[8:11], s29 offen offset:0 sc1
M v[88:91], a[116:119], a[148:151], v[88:91]
 v_mul_f32 v68, v6, v68
 v_mul_f32 v69, v6, v69
M v[88:91], a[120:123], a[152:155], v[88:91]
 v_mul_f32 v70, v6, v70
 v_mul_f32 v71, v6, v71
M v[88:91], a[124:127], a[156:159], v[88:91]
 v_mul_f32 v76, v6, v76
 v_mul_f32 v77, v6, v77
M v[92:95], a[124:127], a[188:191], 0
 v_mul_f32 v78, v6, v78
 v_mul_f32 v79, v6, v79
M v[92:95], a[120:123], a[184:187], v[92:95]
 v_cvt_pk_bf16_f32 v68, v68, v69
 v_cvt_pk_bf16_f32 v69, v70, v71
M v[92:95], a[116:119], a[180:183], v[92:95]
 v_cvt_pk_bf16_f32 v70, v76, v77
 v_cvt_pk_bf16_f32 v71, v78, v79
M v[92:95], a[112:115], a[176:179], v[92:95]
 buffer_store_dwordx4 v[68:71], v7, s[8:11], s30 offen offset:0 sc1
M v[92:95], a[108:111], a[172:175], v[92:95]
M v[92:95], a[104:107], a[168:171], v[92:95]
M v[92:95], a[100:103], a[164:167], v[92:95]
M v[92:95], a[96:99], a[160:163], v[92:95]
 v_mul_f32 v80, v5, v80
 v_mul_f32 v81, v5, v81
 v_mul_f32 v82, v5, v82
 v_mul_f32 v83, v5, v83
 v_mul_f32 v88, v5, v88
 v_mul_f32 v89, v5, v89
 v_mul_f32 v90, v5, v90
 v_mul_f32 v91, v5, v91
 v_cvt_pk_bf16_f32 v80, v80, v81
 v_cvt_pk_bf16_f32 v81, v82, v83
 v_cvt_pk_bf16_f32 v82, v88, v89
 v_cvt_pk_bf16_f32 v83, v90, v91
 buffer_store_dwordx4 v[80:83], v7, s[8:11], s29 offen offset:1024 sc1
 v_mul_f32 v84, v6, v84
 v_mul_f32 v85, v6, v85
 v_mul_f32 v86, v6, v86
 v_mul_f32 v87, v6, v87
 v_mul_f32 v92, v6, v92
 v_mul_f32 v93, v6, v93
 v_mul_f32 v94, v6, v94
 v_mul_f32 v95, v6, v95
 v_cvt_pk_bf16_f32 v84, v84, v85
 v_cvt_pk_bf16_f32 v85, v86, v87
 v_cvt_pk_bf16_f32 v86, v92, v93
 v_cvt_pk_bf16_f32 v87, v94, v95
 buffer_store_dwordx4 v[84:87], v7, s[8:11], s30 offen offset:1024 sc1
 s_waitcnt vmcnt(0)
 buffer_store_dword v15, v16, s[8:11], s3 offen sc1
L_red:
 s_lshl_b32 s64, s42, 1
 s_lshr_b32 s65, s41, 3
 s_add_u32 s46, s64, s65
 s_mul_i32 s46, s46, 4352
 s_and_b32 s65, s41, 7
 s_lshl_b32 s65, s65, 7
 s_add_u32 s46, s46, s65
 s_add_u32 s46, s46, 104992768
 v_and_b32 v14, 31, v0
 v_lshlrev_b32 v14, 2, v14
 buffer_load_dword v9, v14, s[8:11], s46 offen sc1
 s_sub_u32 s64, 15, s64
 s_and_b32 s72, s41, 7
 s_mul_i32 s77, s42, 1835008
 s_mul_i32 s78, s72, 14336
 s_add_u32 s77, s77, s78
 s_lshl_b32 s78, s74, 10
 s_add_u32 s77, s77, s78
 s_add_u32 s77, s77, 67108864
 s_sub_u32 s78, s64, 1
 s_mul_i32 s78, s78, 1835008
 s_add_u32 s78, s78, s77
 s_lshl_b32 s73, s72, 4
 s_lshl_b32 s65, s42, 7
 s_add_u32 s73, s73, s65
 s_lshl_b32 s64, s64, 7
 v_and_b32 v10, 15, v0
 v_add_u32 v10, s73, v10
 v_add_u32 v29, s64, v10
 s_mov_b32 s64, 104857664
 v_mul_u32_u24 v12, 896, v10
 v_lshl_add_u32 v12, v11, 4, v12
 v_lshrrev_b32 v13, 4, v10
 v_lshlrev_b32 v13, 5, v13
 v_and_b32 v104, 15, v10
 v_add_lshl_u32 v13, v13, v104, 2
 buffer_load_dword v15, v13, s[8:11], s64 offen sc1
 buffer_load_dwordx4 v[16:19], v12, s[56:59], s75 offen
 buffer_load_dwordx4 v[20:23], v12, s[56:59], s76 offen
 v_mul_u32_u24 v28, 896, v29
 v_lshl_add_u32 v28, v11, 4, v28
 v_lshrrev_b32 v13, 4, v29
 v_lshlrev_b32 v13, 5, v13
 v_and_b32 v104, 15, v29
 v_add_lshl_u32 v13, v13, v104, 2
 buffer_load_dword v26, v13, s[8:11], s64 offen sc1
 buffer_load_dwordx4 v[96:99], v28, s[56:59], s75 offen
 buffer_load_dwordx4 v[100:103], v28, s[56:59], s76 offen
 v_mov_b32 v48, 0
 v_mov_b32 v49, 0
 v_mov_b32 v50, 0
 v_mov_b32 v51, 0
 v_mov_b32 v52, 0
 v_mov_b32 v53, 0
 v_mov_b32 v54, 0
 v_mov_b32 v55, 0
 v_mov_b32 v56, 0
 v_mov_b32 v57, 0
 v_mov_b32 v58, 0
 v_mov_b32 v59, 0
 v_mov_b32 v60, 0
 v_mov_b32 v61, 0
 v_mov_b32 v62, 0
 v_mov_b32 v63, 0
 v_mov_b32 v64, 0
 v_mov_b32 v65, 0
 v_mov_b32 v66, 0
 v_mov_b32 v67, 0
 v_mov_b32 v68, 0
 v_mov_b32 v69, 0
 v_mov_b32 v70, 0
 v_mov_b32 v71, 0
 v_mov_b32 v72, 0
 v_mov_b32 v73, 0
 v_mov_b32 v74, 0
 v_mov_b32 v75, 0
 v_mov_b32 v76, 0
 v_mov_b32 v77, 0
 v_mov_b32 v78, 0
 v_mov_b32 v79, 0
 s_waitcnt vmcnt(6)
 v_cmp_eq_u32 vcc, 1, v9
 s_mov_b32 s91, 65536
 s_mov_b32 s69, 0
 s_mov_b32 s70, vcc_lo
 s_mov_b32 s68, vcc_lo
 s_cmp_lg_u32 s70, 0
 s_cbranch_scc1 L_rk0
 s_call_b64 s[36:37], L_rpoll
L_rk0:
 s_ff1_i32_b32 s71, s70
 s_bitset0_b32 s70, s71
 s_cmp_ge_u32 s71, 16
 s_cselect_b32 s72, s78, s77
 s_cselect_b32 s73, 0x1, 0
 s_mul_i32 s71, s71, 114688
 s_add_u32 s16, s71, s72
 buffer_load_dwordx4 v[128:131], v7, s[8:11], s16 offen sc1
 s_or_b32 s69, s69, s73
 buffer_load_dwordx4 v[132:135], v27, s[8:11], s16 offen sc1
 s_cmp_lg_u32 s70, 0
 s_cbranch_scc1 L_rk1
 s_call_b64 s[36:37], L_rpoll
L_rk1:
 s_ff1_i32_b32 s71, s70
 s_bitset0_b32 s70, s71
 s_cmp_ge_u32 s71, 16
 s_cselect_b32 s72, s78, s77
 s_cselect_b32 s73, 0x2, 0
 s_mul_i32 s71, s71, 114688
 s_add_u32 s17, s71, s72
 buffer_load_dwordx4 v[136:139], v7, s[8:11], s17 offen sc1
 s_or_b32 s69, s69, s73
 buffer_load_dwordx4 v[140:143], v27, s[8:11], s17 offen sc1
 s_waitcnt vmcnt(8)
 v_lshlrev_b32 v32, 16, v16
 v_and_b32 v33, 0xffff0000, v16
 v_lshlrev_b32 v34, 16, v17
 v_and_b32 v35, 0xffff0000, v17
 v_lshlrev_b32 v36, 16, v18
 v_and_b32 v37, 0xffff0000, v18
 v_lshlrev_b32 v38, 16, v19
 v_and_b32 v39, 0xffff0000, v19
 s_waitcnt vmcnt(7)
 v_lshlrev_b32 v40, 16, v20
 v_and_b32 v41, 0xffff0000, v20
 v_lshlrev_b32 v42, 16, v21
 v_and_b32 v43, 0xffff0000, v21
 v_lshlrev_b32 v44, 16, v22
 v_and_b32 v45, 0xffff0000, v22
 v_lshlrev_b32 v46, 16, v23
 v_and_b32 v47, 0xffff0000, v23
 v_sub_f32 v13, 1.0, v15
 v_cmp_eq_u32 s[80:81], s84, v10
 v_cmp_eq_u32 s[82:83], s85, v10
 s_nop 0
 s_or_b64 vcc, s[80:81], s[82:83]
 s_cbranch_vccnz L_moe0
L_moe_ret0:
 v_mul_f32 v32, v13, v32
 v_mul_f32 v33, v13, v33
 v_mul_f32 v34, v13, v34
 v_mul_f32 v35, v13, v35
 v_mul_f32 v36, v13, v36
 v_mul_f32 v37, v13, v37
 v_mul_f32 v38, v13, v38
 v_mul_f32 v39, v13, v39
 v_mul_f32 v40, v13, v40
 v_mul_f32 v41, v13, v41
 v_mul_f32 v42, v13, v42
 v_mul_f32 v43, v13, v43
 v_mul_f32 v44, v13, v44
 v_mul_f32 v45, v13, v45
 v_mul_f32 v46, v13, v46
 v_mul_f32 v47, v13, v47
 s_cmp_lg_u32 s70, 0
 s_cbranch_scc1 L_rk2
 s_call_b64 s[36:37], L_rpoll
L_rk2:
 s_ff1_i32_b32 s71, s70
 s_bitset0_b32 s70, s71
 s_cmp_ge_u32 s71, 16
 s_cselect_b32 s72, s78, s77
 s_cselect_b32 s73, 0x4, 0
 s_mul_i32 s71, s71, 114688
 s_add_u32 s18, s71, s72
 buffer_load_dwordx4 v[144:147], v7, s[8:11], s18 offen sc1
 s_or_b32 s69, s69, s73
 buffer_load_dwordx4 v[148:151], v27, s[8:11], s18 offen sc1
 s_waitcnt vmcnt(7)
 v_lshlrev_b32 v80, 16, v96
 v_and_b32 v81, 0xffff0000, v96
 v_lshlrev_b32 v82, 16, v97
 v_and_b32 v83, 0xffff0000, v97
 v_lshlrev_b32 v84, 16, v98
 v_and_b32 v85, 0xffff0000, v98
 v_lshlrev_b32 v86, 16, v99
 v_and_b32 v87, 0xffff0000, v99
 s_waitcnt vmcnt(6)
 v_lshlrev_b32 v88, 16, v100
 v_and_b32 v89, 0xffff0000, v100
 v_lshlrev_b32 v90, 16, v101
 v_and_b32 v91, 0xffff0000, v101
 v_lshlrev_b32 v92, 16, v102
 v_and_b32 v93, 0xffff0000, v102
 v_lshlrev_b32 v94, 16, v103
 v_and_b32 v95, 0xffff0000, v103
 v_sub_f32 v13, 1.0, v26
 v_cmp_eq_u32 s[80:81], s84, v29
 v_cmp_eq_u32 s[82:83], s85, v29
 s_nop 0
 s_or_b64 vcc, s[80:81], s[82:83]
 s_cbranch_vccnz L_moe1
L_moe_ret1:
 v_mul_f32 v80, v13, v80
 v_mul_f32 v81, v13, v81
 v_mul_f32 v82, v13, v82
 v_mul_f32 v83, v13, v83
 v_mul_f32 v84, v13, v84
 v_mul_f32 v85, v13, v85
 v_mul_f32 v86, v13, v86
 v_mul_f32 v87, v13, v87
 v_mul_f32 v88, v13, v88
 v_mul_f32 v89, v13, v89
 v_mul_f32 v90, v13, v90
 v_mul_f32 v91, v13, v91
 v_mul_f32 v92, v13, v92
 v_mul_f32 v93, v13, v93
 v_mul_f32 v94, v13, v94
 v_mul_f32 v95, v13, v95
 s_cmp_lg_u32 s70, 0
 s_cbranch_scc1 L_rk3
 s_call_b64 s[36:37], L_rpoll
L_rk3:
 s_ff1_i32_b32 s71, s70
 s_bitset0_b32 s70, s71
 s_cmp_ge_u32 s71, 16
 s_cselect_b32 s72, s78, s77
 s_cselect_b32 s73, 0x8, 0
 s_mul_i32 s71, s71, 114688
 s_add_u32 s19, s71, s72
 buffer_load_dwordx4 v[152:155], v7, s[8:11], s19 offen sc1
 s_or_b32 s69, s69, s73
 buffer_load_dwordx4 v[156:159], v27, s[8:11], s19 offen sc1
 s_cmp_lg_u32 s70, 0
 s_cbranch_scc1 L_rk4
 s_call_b64 s[36:37], L_rpoll
L_rk4:
 s_ff1_i32_b32 s71, s70
 s_bitset0_b32 s70, s71
 s_cmp_ge_u32 s71, 16
 s_cselect_b32 s72, s78, s77
 s_cselect_b32 s73, 0x10, 0
 s_mul_i32 s71, s71, 114688
 s_add_u32 s48, s71, s72
 buffer_load_dwordx4 v[160:163], v7, s[8:11], s48 offen sc1
 s_or_b32 s69, s69, s73
 buffer_load_dwordx4 v[164:167], v27, s[8:11], s48 offen sc1
 s_cmp_lg_u32 s70, 0
 s_cbranch_scc1 L_rk5
 s_call_b64 s[36:37], L_rpoll
L_rk5:
 s_ff1_i32_b32 s71, s70
 s_bitset0_b32 s70, s71
 s_cmp_ge_u32 s71, 16
 s_cselect_b32 s72, s78, s77
 s_cselect_b32 s73, 0x20, 0
 s_mul_i32 s71, s71, 114688
 s_add_u32 s49, s71, s72
 buffer_load_dwordx4 v[168:171], v7, s[8:11], s49 offen sc1
 s_or_b32 s69, s69, s73
 buffer_load_dwordx4 v[172:175], v27, s[8:11], s49 offen sc1
 s_cmp_lg_u32 s70, 0
 s_cbranch_scc1 L_rk6
 s_call_b64 s[36:37], L_rpoll
L_rk6:
 s_ff1_i32_b32 s71, s70
 s_bitset0_b32 s70, s71
 s_cmp_ge_u32 s71, 16
 s_cselect_b32 s72, s78, s77
 s_cselect_b32 s73, 0x40, 0
 s_mul_i32 s71, s71, 114688
 s_add_u32 s50, s71, s72
 buffer_load_dwordx4 v[176:179], v7, s[8:11], s50 offen sc1
 s_or_b32 s69, s69, s73
 buffer_load_dwordx4 v[180:183], v27, s[8:11], s50 offen sc1
 s_waitcnt vmcnt(12)
 s_bitcmp1_b32 s69, 0
 s_cbranch_scc1 L_rx0
 v_dot2c_f32_bf16 v48, v128, v24
 v_dot2c_f32_bf16 v49, v128, v25
 v_dot2c_f32_bf16 v50, v129, v24
 v_dot2c_f32_bf16 v51, v129, v25
 v_dot2c_f32_bf16 v52, v130, v24
 v_dot2c_f32_bf16 v53, v130, v25
 v_dot2c_f32_bf16 v54, v131, v24
 v_dot2c_f32_bf16 v55, v131, v25
 v_dot2c_f32_bf16 v56, v132, v24
 v_dot2c_f32_bf16 v57, v132, v25
 v_dot2c_f32_bf16 v58, v133, v24
 v_dot2c_f32_bf16 v59, v133, v25
 v_dot2c_f32_bf16 v60, v134, v24
 v_dot2c_f32_bf16 v61, v134, v25
 v_dot2c_f32_bf16 v62, v135, v24
 v_dot2c_f32_bf16 v63, v135, v25
L_ry0:
 s_cmp_lg_u32 s70, 0
 s_cbranch_scc1 L_rk7
 s_call_b64 s[36:37], L_rpoll
L_rk7:
 s_ff1_i32_b32 s71, s70
 s_bitset0_b32 s70, s71
 s_cmp_ge_u32 s71, 16
 s_cselect_b32 s72, s78, s77
 s_cselect_b32 s73, 0x80, 0
 s_mul_i32 s71, s71, 114688
 s_add_u32 s51, s71, s72
 buffer_load_dwordx4 v[184:187], v7, s[8:11], s51 offen sc1
 s_or_b32 s69, s69, s73
 buffer_load_dwordx4 v[188:191], v27, s[8:11], s51 offen sc1
 s_waitcnt vmcnt(12)
 s_bitcmp1_b32 s69, 1
 s_cbranch_scc1 L_rx1
 v_dot2c_f32_bf16 v48, v136, v24
 v_dot2c_f32_bf16 v49, v136, v25
 v_dot2c_f32_bf16 v50, v137, v24
 v_dot2c_f32_bf16 v51, v137, v25
 v_dot2c_f32_bf16 v52, v138, v24
 v_dot2c_f32_bf16 v53, v138, v25
 v_dot2c_f32_bf16 v54, v139, v24
 v_dot2c_f32_bf16 v55, v139, v25
 v_dot2c_f32_bf16 v56, v140, v24
 v_dot2c_f32_bf16 v57, v140, v25
 v_dot2c_f32_bf16 v58, v141, v24
 v_dot2c_f32_bf16 v59, v141, v25
 v_dot2c_f32_bf16 v60, v142, v24
 v_dot2c_f32_bf16 v61, v142, v25
 v_dot2c_f32_bf16 v62, v143, v24
 v_dot2c_f32_bf16 v63, v143, v25
L_ry1:
 s_cmp_lg_u32 s70, 0
 s_cbranch_scc1 L_rk8
 s_call_b64 s[36:37], L_rpoll
L_rk8:
 s_ff1_i32_b32 s71, s70
 s_bitset0_b32 s70, s71
 s_cmp_ge_u32 s71, 16
 s_cselect_b32 s72, s78, s77
 s_cselect_b32 s73, 0x100, 0
 s_mul_i32 s71, s71, 114688
 s_add_u32 s16, s71, s72
 buffer_load_dwordx4 v[192:195], v7, s[8:11], s16 offen sc1
 s_or_b32 s69, s69, s73
 buffer_load_dwordx4 v[196:199], v27, s[8:11], s16 offen sc1
 s_waitcnt vmcnt(12)
 s_bitcmp1_b32 s69, 2
 s_cbranch_scc1 L_rx2
 v_dot2c_f32_bf16 v48, v144, v24
 v_dot2c_f32_bf16 v49, v144, v25
 v_dot2c_f32_bf16 v50, v145, v24
 v_dot2c_f32_bf16 v51, v145, v25
 v_dot2c_f32_bf16 v52, v146, v24
 v_dot2c_f32_bf16 v53, v146, v25
 v_dot2c_f32_bf16 v54, v147, v24
 v_dot2c_f32_bf16 v55, v147, v25
 v_dot2c_f32_bf16 v56, v148, v24
 v_dot2c_f32_bf16 v57, v148, v25
 v_dot2c_f32_bf16 v58, v149, v24
 v_dot2c_f32_bf16 v59, v149, v25
 v_dot2c_f32_bf16 v60, v150, v24
 v_dot2c_f32_bf16 v61, v150, v25
 v_dot2c_f32_bf16 v62, v151, v24
 v_dot2c_f32_bf16 v63, v151, v25
L_ry2:
 s_cmp_lg_u32 s70, 0
 s_cbranch_scc1 L_rk9
 s_call_b64 s[36:37], L_rpoll
L_rk9:
 s_ff1_i32_b32 s71, s70
 s_bitset0_b32 s70, s71
 s_cmp_ge_u32 s71, 16
 s_cselect_b32 s72, s78, s77
 s_cselect_b32 s73, 0x200, 0
 s_mul_i32 s71, s71, 114688
 s_add_u32 s17, s71, s72
 buffer_load_dwordx4 v[200:203], v7, s[8:11], s17 offen sc1
 s_or_b32 s69, s69, s73
 buffer_load_dwordx4 v[204:207], v27, s[8:11], s17 offen sc1
 s_waitcnt vmcnt(12)
 s_bitcmp1_b32 s69, 3
 s_cbranch_scc1 L_rx3
 v_dot2c_f32_bf16 v48, v152, v24
 v_dot2c_f32_bf16 v49, v152, v25
 v_dot2c_f32_bf16 v50, v153, v24
 v_dot2c_f32_bf16 v51, v153, v25
 v_dot2c_f32_bf16 v52, v154, v24
 v_dot2c_f32_bf16 v53, v154, v25
 v_dot2c_f32_bf16 v54, v155, v24
 v_dot2c_f32_bf16 v55, v155, v25
 v_dot2c_f32_bf16 v56, v156, v24
 v_dot2c_f32_bf16 v57, v156, v25
 v_dot2c_f32_bf16 v58, v157, v24
 v_dot2c_f32_bf16 v59, v157, v25
 v_dot2c_f32_bf16 v60, v158, v24
 v_dot2c_f32_bf16 v61, v158, v25
 v_dot2c_f32_bf16 v62, v159, v24
 v_dot2c_f32_bf16 v63, v159, v25
L_ry3:
 s_cmp_lg_u32 s70, 0
 s_cbranch_scc1 L_rk10
 s_call_b64 s[36:37], L_rpoll
L_rk10:
 s_ff1_i32_b32 s71, s70
 s_bitset0_b32 s70, s71
 s_cmp_ge_u32 s71, 16
 s_cselect_b32 s72, s78, s77
 s_cselect_b32 s73, 0x400, 0
 s_mul_i32 s71, s71, 114688
 s_add_u32 s18, s71, s72
 buffer_load_dwordx4 v[208:211], v7, s[8:11], s18 offen sc1
 s_or_b32 s69, s69, s73
 buffer_load_dwordx4 v[212:215], v27, s[8:11], s18 offen sc1
 s_waitcnt vmcnt(12)
 s_bitcmp1_b32 s69, 4
 s_cbranch_scc1 L_rx4
 v_dot2c_f32_bf16 v48, v160, v24
 v_dot2c_f32_bf16 v49, v160, v25
 v_dot2c_f32_bf16 v50, v161, v24
 v_dot2c_f32_bf16 v51, v161, v25
 v_dot2c_f32_bf16 v52, v162, v24
 v_dot2c_f32_bf16 v53, v162, v25
 v_dot2c_f32_bf16 v54, v163, v24
 v_dot2c_f32_bf16 v55, v163, v25
 v_dot2c_f32_bf16 v56, v164, v24
 v_dot2c_f32_bf16 v57, v164, v25
 v_dot2c_f32_bf16 v58, v165, v24
 v_dot2c_f32_bf16 v59, v165, v25
 v_dot2c_f32_bf16 v60, v166, v24
 v_dot2c_f32_bf16 v61, v166, v25
 v_dot2c_f32_bf16 v62, v167, v24
 v_dot2c_f32_bf16 v63, v167, v25
L_ry4:
 s_cmp_lg_u32 s70, 0
 s_cbranch_scc1 L_rk11
 s_call_b64 s[36:37], L_rpoll
L_rk11:
 s_ff1_i32_b32 s71, s70
 s_bitset0_b32 s70, s71
 s_cmp_ge_u32 s71, 16
 s_cselect_b32 s72, s78, s77
 s_cselect_b32 s73, 0x800, 0
 s_mul_i32 s71, s71, 114688
 s_add_u32 s19, s71, s72
 buffer_load_dwordx4 v[216:219], v7, s[8:11], s19 offen sc1
 s_or_b32 s69, s69, s73
 buffer_load_dwordx4 v[220:223], v27, s[8:11], s19 offen sc1
 s_waitcnt vmcnt(12)
 s_bitcmp1_b32 s69, 5
 s_cbranch_scc1 L_rx5
 v_dot2c_f32_bf16 v48, v168, v24
 v_dot2c_f32_bf16 v49, v168, v25
 v_dot2c_f32_bf16 v50, v169, v24
 v_dot2c_f32_bf16 v51, v169, v25
 v_dot2c_f32_bf16 v52, v170, v24
 v_dot2c_f32_bf16 v53, v170, v25
 v_dot2c_f32_bf16 v54, v171, v24
 v_dot2c_f32_bf16 v55, v171, v25
 v_dot2c_f32_bf16 v56, v172, v24
 v_dot2c_f32_bf16 v57, v172, v25
 v_dot2c_f32_bf16 v58, v173, v24
 v_dot2c_f32_bf16 v59, v173, v25
 v_dot2c_f32_bf16 v60, v174, v24
 v_dot2c_f32_bf16 v61, v174, v25
 v_dot2c_f32_bf16 v62, v175, v24
 v_dot2c_f32_bf16 v63, v175, v25
L_ry5:
 s_cmp_lg_u32 s70, 0
 s_cbranch_scc1 L_rk12
 s_call_b64 s[36:37], L_rpoll
L_rk12:
 s_ff1_i32_b32 s71, s70
 s_bitset0_b32 s70, s71
 s_cmp_ge_u32 s71, 16
 s_cselect_b32 s72, s78, s77
 s_cselect_b32 s73, 0x1000, 0
 s_mul_i32 s71, s71, 114688
 s_add_u32 s48, s71, s72
 buffer_load_dwordx4 v[224:227], v7, s[8:11], s48 offen sc1
 s_or_b32 s69, s69, s73
 buffer_load_dwordx4 v[228:231], v27, s[8:11], s48 offen sc1
 s_waitcnt vmcnt(12)
 s_bitcmp1_b32 s69, 6
 s_cbranch_scc1 L_rx6
 v_dot2c_f32_bf16 v48, v176, v24
 v_dot2c_f32_bf16 v49, v176, v25
 v_dot2c_f32_bf16 v50, v177, v24
 v_dot2c_f32_bf16 v51, v177, v25
 v_dot2c_f32_bf16 v52, v178, v24
 v_dot2c_f32_bf16 v53, v178, v25
 v_dot2c_f32_bf16 v54, v179, v24
 v_dot2c_f32_bf16 v55, v179, v25
 v_dot2c_f32_bf16 v56, v180, v24
 v_dot2c_f32_bf16 v57, v180, v25
 v_dot2c_f32_bf16 v58, v181, v24
 v_dot2c_f32_bf16 v59, v181, v25
 v_dot2c_f32_bf16 v60, v182, v24
 v_dot2c_f32_bf16 v61, v182, v25
 v_dot2c_f32_bf16 v62, v183, v24
 v_dot2c_f32_bf16 v63, v183, v25
L_ry6:
 s_cmp_lg_u32 s70, 0
 s_cbranch_scc1 L_rk13
 s_call_b64 s[36:37], L_rpoll
L_rk13:
 s_ff1_i32_b32 s71, s70
 s_bitset0_b32 s70, s71
 s_cmp_ge_u32 s71, 16
 s_cselect_b32 s72, s78, s77
 s_cselect_b32 s73, 0x2000, 0
 s_mul_i32 s71, s71, 114688
 s_add_u32 s49, s71, s72
 buffer_load_dwordx4 v[232:235], v7, s[8:11], s49 offen sc1
 s_or_b32 s69, s69, s73
 buffer_load_dwordx4 v[236:239], v27, s[8:11], s49 offen sc1
 s_waitcnt vmcnt(12)
 s_bitcmp1_b32 s69, 7
 s_cbranch_scc1 L_rx7
 v_dot2c_f32_bf16 v48, v184, v24
 v_dot2c_f32_bf16 v49, v184, v25
 v_dot2c_f32_bf16 v50, v185, v24
 v_dot2c_f32_bf16 v51, v185, v25
 v_dot2c_f32_bf16 v52, v186, v24
 v_dot2c_f32_bf16 v53, v186, v25
 v_dot2c_f32_bf16 v54, v187, v24
 v_dot2c_f32_bf16 v55, v187, v25
 v_dot2c_f32_bf16 v56, v188, v24
 v_dot2c_f32_bf16 v57, v188, v25
 v_dot2c_f32_bf16 v58, v189, v24
 v_dot2c_f32_bf16 v59, v189, v25
 v_dot2c_f32_bf16 v60, v190, v24
 v_dot2c_f32_bf16 v61, v190, v25
 v_dot2c_f32_bf16 v62, v191, v24
 v_dot2c_f32_bf16 v63, v191, v25
L_ry7:
 s_cmp_lg_u32 s70, 0
 s_cbranch_scc1 L_rk14
 s_call_b64 s[36:37], L_rpoll
L_rk14:
 s_ff1_i32_b32 s71, s70
 s_bitset0_b32 s70, s71
 s_cmp_ge_u32 s71, 16
 s_cselect_b32 s72, s78, s77
 s_cselect_b32 s73, 0x4000, 0
 s_mul_i32 s71, s71, 114688
 s_add_u32 s50, s71, s72
 buffer_load_dwordx4 v[240:243], v7, s[8:11], s50 offen sc1
 s_or_b32 s69, s69, s73
 buffer_load_dwordx4 v[244:247], v27, s[8:11], s50 offen sc1
 s_waitcnt vmcnt(12)
 s_bitcmp1_b32 s69, 8
 s_cbranch_scc1 L_rx8
 v_dot2c_f32_bf16 v48, v192, v24
 v_dot2c_f32_bf16 v49, v192, v25
 v_dot2c_f32_bf16 v50, v193, v24
 v_dot2c_f32_bf16 v51, v193, v25
 v_dot2c_f32_bf16 v52, v194, v24
 v_dot2c_f32_bf16 v53, v194, v25
 v_dot2c_f32_bf16 v54, v195, v24
 v_dot2c_f32_bf16 v55, v195, v25
 v_dot2c_f32_bf16 v56, v196, v24
 v_dot2c_f32_bf16 v57, v196, v25
 v_dot2c_f32_bf16 v58, v197, v24
 v_dot2c_f32_bf16 v59, v197, v25
 v_dot2c_f32_bf16 v60, v198, v24
 v_dot2c_f32_bf16 v61, v198, v25
 v_dot2c_f32_bf16 v62, v199, v24
 v_dot2c_f32_bf16 v63, v199, v25
L_ry8:
 s_cmp_lg_u32 s70, 0
 s_cbranch_scc1 L_rk15
 s_call_b64 s[36:37], L_rpoll
L_rk15:
 s_ff1_i32_b32 s71, s70
 s_bitset0_b32 s70, s71
 s_cmp_ge_u32 s71, 16
 s_cselect_b32 s72, s78, s77
 s_cselect_b32 s73, 0x8000, 0
 s_mul_i32 s71, s71, 114688
 s_add_u32 s51, s71, s72
 buffer_load_dwordx4 v[248:251], v7, s[8:11], s51 offen sc1
 s_or_b32 s69, s69, s73
 buffer_load_dwordx4 v[252:255], v27, s[8:11], s51 offen sc1
 s_waitcnt vmcnt(12)
 s_bitcmp1_b32 s69, 9
 s_cbranch_scc1 L_rx9
 v_dot2c_f32_bf16 v48, v200, v24
 v_dot2c_f32_bf16 v49, v200, v25
 v_dot2c_f32_bf16 v50, v201, v24
 v_dot2c_f32_bf16 v51, v201, v25
 v_dot2c_f32_bf16 v52, v202, v24
 v_dot2c_f32_bf16 v53, v202, v25
 v_dot2c_f32_bf16 v54, v203, v24
 v_dot2c_f32_bf16 v55, v203, v25
 v_dot2c_f32_bf16 v56, v204, v24
 v_dot2c_f32_bf16 v57, v204, v25
 v_dot2c_f32_bf16 v58, v205, v24
 v_dot2c_f32_bf16 v59, v205, v25
 v_dot2c_f32_bf16 v60, v206, v24
 v_dot2c_f32_bf16 v61, v206, v25
 v_dot2c_f32_bf16 v62, v207, v24
 v_dot2c_f32_bf16 v63, v207, v25
L_ry9:
 s_cmp_lg_u32 s70, 0
 s_cbranch_scc1 L_rk16
 s_call_b64 s[36:37], L_rpoll
L_rk16:
 s_ff1_i32_b32 s71, s70
 s_bitset0_b32 s70, s71
 s_cmp_ge_u32 s71, 16
 s_cselect_b32 s72, s78, s77
 s_cselect_b32 s73, 0x10000, 0
 s_mul_i32 s71, s71, 114688
 s_add_u32 s16, s71, s72
 buffer_load_dwordx4 v[128:131], v7, s[8:11], s16 offen sc1
 s_or_b32 s69, s69, s73
 buffer_load_dwordx4 v[132:135], v27, s[8:11], s16 offen sc1
 s_waitcnt vmcnt(12)
 s_bitcmp1_b32 s69, 10
 s_cbranch_scc1 L_rx10
 v_dot2c_f32_bf16 v48, v208, v24
 v_dot2c_f32_bf16 v49, v208, v25
 v_dot2c_f32_bf16 v50, v209, v24
 v_dot2c_f32_bf16 v51, v209, v25
 v_dot2c_f32_bf16 v52, v210, v24
 v_dot2c_f32_bf16 v53, v210, v25
 v_dot2c_f32_bf16 v54, v211, v24
 v_dot2c_f32_bf16 v55, v211, v25
 v_dot2c_f32_bf16 v56, v212, v24
 v_dot2c_f32_bf16 v57, v212, v25
 v_dot2c_f32_bf16 v58, v213, v24
 v_dot2c_f32_bf16 v59, v213, v25
 v_dot2c_f32_bf16 v60, v214, v24
 v_dot2c_f32_bf16 v61, v214, v25
 v_dot2c_f32_bf16 v62, v215, v24
 v_dot2c_f32_bf16 v63, v215, v25
L_ry10:
 s_cmp_lg_u32 s70, 0
 s_cbranch_scc1 L_rk17
 s_call_b64 s[36:37], L_rpoll
L_rk17:
 s_ff1_i32_b32 s71, s70
 s_bitset0_b32 s70, s71
 s_cmp_ge_u32 s71, 16
 s_cselect_b32 s72, s78, s77
 s_cselect_b32 s73, 0x20000, 0
 s_mul_i32 s71, s71, 114688
 s_add_u32 s17, s71, s72
 buffer_load_dwordx4 v[136:139], v7, s[8:11], s17 offen sc1
 s_or_b32 s69, s69, s73
 buffer_load_dwordx4 v[140:143], v27, s[8:11], s17 offen sc1
 s_waitcnt vmcnt(12)
 s_bitcmp1_b32 s69, 11
 s_cbranch_scc1 L_rx11
 v_dot2c_f32_bf16 v48, v216, v24
 v_dot2c_f32_bf16 v49, v216, v25
 v_dot2c_f32_bf16 v50, v217, v24
 v_dot2c_f32_bf16 v51, v217, v25
 v_dot2c_f32_bf16 v52, v218, v24
 v_dot2c_f32_bf16 v53, v218, v25
 v_dot2c_f32_bf16 v54, v219, v24
 v_dot2c_f32_bf16 v55, v219, v25
 v_dot2c_f32_bf16 v56, v220, v24
 v_dot2c_f32_bf16 v57, v220, v25
 v_dot2c_f32_bf16 v58, v221, v24
 v_dot2c_f32_bf16 v59, v221, v25
 v_dot2c_f32_bf16 v60, v222, v24
 v_dot2c_f32_bf16 v61, v222, v25
 v_dot2c_f32_bf16 v62, v223, v24
 v_dot2c_f32_bf16 v63, v223, v25
L_ry11:
 s_cmp_lg_u32 s70, 0
 s_cbranch_scc1 L_rk18
 s_call_b64 s[36:37], L_rpoll
L_rk18:
 s_ff1_i32_b32 s71, s70
 s_bitset0_b32 s70, s71
 s_cmp_ge_u32 s71, 16
 s_cselect_b32 s72, s78, s77
 s_cselect_b32 s73, 0x40000, 0
 s_mul_i32 s71, s71, 114688
 s_add_u32 s18, s71, s72
 buffer_load_dwordx4 v[144:147], v7, s[8:11], s18 offen sc1
 s_or_b32 s69, s69, s73
 buffer_load_dwordx4 v[148:151], v27, s[8:11], s18 offen sc1
 s_waitcnt vmcnt(12)
 s_bitcmp1_b32 s69, 12
 s_cbranch_scc1 L_rx12
 v_dot2c_f32_bf16 v48, v224, v24
 v_dot2c_f32_bf16 v49, v224, v25
 v_dot2c_f32_bf16 v50, v225, v24
 v_dot2c_f32_bf16 v51, v225, v25
 v_dot2c_f32_bf16 v52, v226, v24
 v_dot2c_f32_bf16 v53, v226, v25
 v_dot2c_f32_bf16 v54, v227, v24
 v_dot2c_f32_bf16 v55, v227, v25
 v_dot2c_f32_bf16 v56, v228, v24
 v_dot2c_f32_bf16 v57, v228, v25
 v_dot2c_f32_bf16 v58, v229, v24
 v_dot2c_f32_bf16 v59, v229, v25
 v_dot2c_f32_bf16 v60, v230, v24
 v_dot2c_f32_bf16 v61, v230, v25
 v_dot2c_f32_bf16 v62, v231, v24
 v_dot2c_f32_bf16 v63, v231, v25
L_ry12:
 s_cmp_lg_u32 s70, 0
 s_cbranch_scc1 L_rk19
 s_call_b64 s[36:37], L_rpoll
L_rk19:
 s_ff1_i32_b32 s71, s70
 s_bitset0_b32 s70, s71
 s_cmp_ge_u32 s71, 16
 s_cselect_b32 s72, s78, s77
 s_cselect_b32 s73, 0x80000, 0
 s_mul_i32 s71, s71, 114688
 s_add_u32 s19, s71, s72
 buffer_load_dwordx4 v[152:155], v7, s[8:11], s19 offen sc1
 s_or_b32 s69, s69, s73
 buffer_load_dwordx4 v[156:159], v27, s[8:11], s19 offen sc1
 s_waitcnt vmcnt(12)
 s_bitcmp1_b32 s69, 13
 s_cbranch_scc1 L_rx13
 v_dot2c_f32_bf16 v48, v232, v24
 v_dot2c_f32_bf16 v49, v232, v25
 v_dot2c_f32_bf16 v50, v233, v24
 v_dot2c_f32_bf16 v51, v233, v25
 v_dot2c_f32_bf16 v52, v234, v24
 v_dot2c_f32_bf16 v53, v234, v25
 v_dot2c_f32_bf16 v54, v235, v24
 v_dot2c_f32_bf16 v55, v235, v25
 v_dot2c_f32_bf16 v56, v236, v24
 v_dot2c_f32_bf16 v57, v236, v25
 v_dot2c_f32_bf16 v58, v237, v24
 v_dot2c_f32_bf16 v59, v237, v25
 v_dot2c_f32_bf16 v60, v238, v24
 v_dot2c_f32_bf16 v61, v238, v25
 v_dot2c_f32_bf16 v62, v239, v24
 v_dot2c_f32_bf16 v63, v239, v25
L_ry13:
 s_cmp_lg_u32 s70, 0
 s_cbranch_scc1 L_rk20
 s_call_b64 s[36:37], L_rpoll
L_rk20:
 s_ff1_i32_b32 s71, s70
 s_bitset0_b32 s70, s71
 s_cmp_ge_u32 s71, 16
 s_cselect_b32 s72, s78, s77
 s_cselect_b32 s73, 0x100000, 0
 s_mul_i32 s71, s71, 114688
 s_add_u32 s48, s71, s72
 buffer_load_dwordx4 v[160:163], v7, s[8:11], s48 offen sc1
 s_or_b32 s69, s69, s73
 buffer_load_dwordx4 v[164:167], v27, s[8:11], s48 offen sc1
 s_waitcnt vmcnt(12)
 s_bitcmp1_b32 s69, 14
 s_cbranch_scc1 L_rx14
 v_dot2c_f32_bf16 v48, v240, v24
 v_dot2c_f32_bf16 v49, v240, v25
 v_dot2c_f32_bf16 v50, v241, v24
 v_dot2c_f32_bf16 v51, v241, v25
 v_dot2c_f32_bf16 v52, v242, v24
 v_dot2c_f32_bf16 v53, v242, v25
 v_dot2c_f32_bf16 v54, v243, v24
 v_dot2c_f32_bf16 v55, v243, v25
 v_dot2c_f32_bf16 v56, v244, v24
 v_dot2c_f32_bf16 v57, v244, v25
 v_dot2c_f32_bf16 v58, v245, v24
 v_dot2c_f32_bf16 v59, v245, v25
 v_dot2c_f32_bf16 v60, v246, v24
 v_dot2c_f32_bf16 v61, v246, v25
 v_dot2c_f32_bf16 v62, v247, v24
 v_dot2c_f32_bf16 v63, v247, v25
L_ry14:
 s_cmp_lg_u32 s70, 0
 s_cbranch_scc1 L_rk21
 s_call_b64 s[36:37], L_rpoll
L_rk21:
 s_ff1_i32_b32 s71, s70
 s_bitset0_b32 s70, s71
 s_cmp_ge_u32 s71, 16
 s_cselect_b32 s72, s78, s77
 s_cselect_b32 s73, 0x200000, 0
 s_mul_i32 s71, s71, 114688
 s_add_u32 s49, s71, s72
 buffer_load_dwordx4 v[168:171], v7, s[8:11], s49 offen sc1
 s_or_b32 s69, s69, s73
 buffer_load_dwordx4 v[172:175], v27, s[8:11], s49 offen sc1
 s_waitcnt vmcnt(12)
 s_bitcmp1_b32 s69, 15
 s_cbranch_scc1 L_rx15
 v_dot2c_f32_bf16 v48, v248, v24
 v_dot2c_f32_bf16 v49, v248, v25
 v_dot2c_f32_bf16 v50, v249, v24
 v_dot2c_f32_bf16 v51, v249, v25
 v_dot2c_f32_bf16 v52, v250, v24
 v_dot2c_f32_bf16 v53, v250, v25
 v_dot2c_f32_bf16 v54, v251, v24
 v_dot2c_f32_bf16 v55, v251, v25
 v_dot2c_f32_bf16 v56, v252, v24
 v_dot2c_f32_bf16 v57, v252, v25
 v_dot2c_f32_bf16 v58, v253, v24
 v_dot2c_f32_bf16 v59, v253, v25
 v_dot2c_f32_bf16 v60, v254, v24
 v_dot2c_f32_bf16 v61, v254, v25
 v_dot2c_f32_bf16 v62, v255, v24
 v_dot2c_f32_bf16 v63, v255, v25
L_ry15:
 s_cmp_lg_u32 s70, 0
 s_cbranch_scc1 L_rk22
 s_call_b64 s[36:37], L_rpoll
L_rk22:
 s_ff1_i32_b32 s71, s70
 s_bitset0_b32 s70, s71
 s_cmp_ge_u32 s71, 16
 s_cselect_b32 s72, s78, s77
 s_cselect_b32 s73, 0x400000, 0
 s_mul_i32 s71, s71, 114688
 s_add_u32 s50, s71, s72
 buffer_load_dwordx4 v[176:179], v7, s[8:11], s50 offen sc1
 s_or_b32 s69, s69, s73
 buffer_load_dwordx4 v[180:183], v27, s[8:11], s50 offen sc1
 s_waitcnt vmcnt(12)
 s_bitcmp0_b32 s69, 16
 s_cbranch_scc1 L_rx16
 v_dot2c_f32_bf16 v64, v128, v24
 v_dot2c_f32_bf16 v65, v128, v25
 v_dot2c_f32_bf16 v66, v129, v24
 v_dot2c_f32_bf16 v67, v129, v25
 v_dot2c_f32_bf16 v68, v130, v24
 v_dot2c_f32_bf16 v69, v130, v25
 v_dot2c_f32_bf16 v70, v131, v24
 v_dot2c_f32_bf16 v71, v131, v25
 v_dot2c_f32_bf16 v72, v132, v24
 v_dot2c_f32_bf16 v73, v132, v25
 v_dot2c_f32_bf16 v74, v133, v24
 v_dot2c_f32_bf16 v75, v133, v25
 v_dot2c_f32_bf16 v76, v134, v24
 v_dot2c_f32_bf16 v77, v134, v25
 v_dot2c_f32_bf16 v78, v135, v24
 v_dot2c_f32_bf16 v79, v135, v25
L_ry16:
 s_cmp_lg_u32 s70, 0
 s_cbranch_scc1 L_rk23
 s_call_b64 s[36:37], L_rpoll
L_rk23:
 s_ff1_i32_b32 s71, s70
 s_bitset0_b32 s70, s71
 s_cmp_ge_u32 s71, 16
 s_cselect_b32 s72, s78, s77
 s_cselect_b32 s73, 0x800000, 0
 s_mul_i32 s71, s71, 114688
 s_add_u32 s51, s71, s72
 buffer_load_dwordx4 v[184:187], v7, s[8:11], s51 offen sc1
 s_or_b32 s69, s69, s73
 buffer_load_dwordx4 v[188:191], v27, s[8:11], s51 offen sc1
 s_waitcnt vmcnt(12)
 s_bitcmp0_b32 s69, 17
 s_cbranch_scc1 L_rx17
 v_dot2c_f32_bf16 v64, v136, v24
 v_dot2c_f32_bf16 v65, v136, v25
 v_dot2c_f32_bf16 v66, v137, v24
 v_dot2c_f32_bf16 v67, v137, v25
 v_dot2c_f32_bf16 v68, v138, v24
 v_dot2c_f32_bf16 v69, v138, v25
 v_dot2c_f32_bf16 v70, v139, v24
 v_dot2c_f32_bf16 v71, v139, v25
 v_dot2c_f32_bf16 v72, v140, v24
 v_dot2c_f32_bf16 v73, v140, v25
 v_dot2c_f32_bf16 v74, v141, v24
 v_dot2c_f32_bf16 v75, v141, v25
 v_dot2c_f32_bf16 v76, v142, v24
 v_dot2c_f32_bf16 v77, v142, v25
 v_dot2c_f32_bf16 v78, v143, v24
 v_dot2c_f32_bf16 v79, v143, v25
L_ry17:
 s_cmp_lg_u32 s70, 0
 s_cbranch_scc1 L_rk24
 s_call_b64 s[36:37], L_rpoll
L_rk24:
 s_ff1_i32_b32 s71, s70
 s_bitset0_b32 s70, s71
 s_cmp_ge_u32 s71, 16
 s_cselect_b32 s72, s78, s77
 s_cselect_b32 s73, 0x1000000, 0
 s_mul_i32 s71, s71, 114688
 s_add_u32 s16, s71, s72
 buffer_load_dwordx4 v[192:195], v7, s[8:11], s16 offen sc1
 s_or_b32 s69, s69, s73
 buffer_load_dwordx4 v[196:199], v27, s[8:11], s16 offen sc1
 s_waitcnt vmcnt(12)
 s_bitcmp0_b32 s69, 18
 s_cbranch_scc1 L_rx18
 v_dot2c_f32_bf16 v64, v144, v24
 v_dot2c_f32_bf16 v65, v144, v25
 v_dot2c_f32_bf16 v66, v145, v24
 v_dot2c_f32_bf16 v67, v145, v25
 v_dot2c_f32_bf16 v68, v146, v24
 v_dot2c_f32_bf16 v69, v146, v25
 v_dot2c_f32_bf16 v70, v147, v24
 v_dot2c_f32_bf16 v71, v147, v25
 v_dot2c_f32_bf16 v72, v148, v24
 v_dot2c_f32_bf16 v73, v148, v25
 v_dot2c_f32_bf16 v74, v149, v24
 v_dot2c_f32_bf16 v75, v149, v25
 v_dot2c_f32_bf16 v76, v150, v24
 v_dot2c_f32_bf16 v77, v150, v25
 v_dot2c_f32_bf16 v78, v151, v24
 v_dot2c_f32_bf16 v79, v151, v25
L_ry18:
 s_cmp_lg_u32 s70, 0
 s_cbranch_scc1 L_rk25
 s_call_b64 s[36:37], L_rpoll
L_rk25:
 s_ff1_i32_b32 s71, s70
 s_bitset0_b32 s70, s71
 s_cmp_ge_u32 s71, 16
 s_cselect_b32 s72, s78, s77
 s_cselect_b32 s73, 0x2000000, 0
 s_mul_i32 s71, s71, 114688
 s_add_u32 s17, s71, s72
 buffer_load_dwordx4 v[200:203], v7, s[8:11], s17 offen sc1
 s_or_b32 s69, s69, s73
 buffer_load_dwordx4 v[204:207], v27, s[8:11], s17 offen sc1
 s_waitcnt vmcnt(12)
 s_bitcmp0_b32 s69, 19
 s_cbranch_scc1 L_rx19
 v_dot2c_f32_bf16 v64, v152, v24
 v_dot2c_f32_bf16 v65, v152, v25
 v_dot2c_f32_bf16 v66, v153, v24
 v_dot2c_f32_bf16 v67, v153, v25
 v_dot2c_f32_bf16 v68, v154, v24
 v_dot2c_f32_bf16 v69, v154, v25
 v_dot2c_f32_bf16 v70, v155, v24
 v_dot2c_f32_bf16 v71, v155, v25
 v_dot2c_f32_bf16 v72, v156, v24
 v_dot2c_f32_bf16 v73, v156, v25
 v_dot2c_f32_bf16 v74, v157, v24
 v_dot2c_f32_bf16 v75, v157, v25
 v_dot2c_f32_bf16 v76, v158, v24
 v_dot2c_f32_bf16 v77, v158, v25
 v_dot2c_f32_bf16 v78, v159, v24
 v_dot2c_f32_bf16 v79, v159, v25
L_ry19:
 s_cmp_lg_u32 s70, 0
 s_cbranch_scc1 L_rk26
 s_call_b64 s[36:37], L_rpoll
L_rk26:
 s_ff1_i32_b32 s71, s70
 s_bitset0_b32 s70, s71
 s_cmp_ge_u32 s71, 16
 s_cselect_b32 s72, s78, s77
 s_cselect_b32 s73, 0x4000000, 0
 s_mul_i32 s71, s71, 114688
 s_add_u32 s18, s71, s72
 buffer_load_dwordx4 v[208:211], v7, s[8:11], s18 offen sc1
 s_or_b32 s69, s69, s73
 buffer_load_dwordx4 v[212:215], v27, s[8:11], s18 offen sc1
 s_waitcnt vmcnt(12)
 s_bitcmp0_b32 s69, 20
 s_cbranch_scc1 L_rx20
 v_dot2c_f32_bf16 v64, v160, v24
 v_dot2c_f32_bf16 v65, v160, v25
 v_dot2c_f32_bf16 v66, v161, v24
 v_dot2c_f32_bf16 v67, v161, v25
 v_dot2c_f32_bf16 v68, v162, v24
 v_dot2c_f32_bf16 v69, v162, v25
 v_dot2c_f32_bf16 v70, v163, v24
 v_dot2c_f32_bf16 v71, v163, v25
 v_dot2c_f32_bf16 v72, v164, v24
 v_dot2c_f32_bf16 v73, v164, v25
 v_dot2c_f32_bf16 v74, v165, v24
 v_dot2c_f32_bf16 v75, v165, v25
 v_dot2c_f32_bf16 v76, v166, v24
 v_dot2c_f32_bf16 v77, v166, v25
 v_dot2c_f32_bf16 v78, v167, v24
 v_dot2c_f32_bf16 v79, v167, v25
L_ry20:
 s_cmp_lg_u32 s70, 0
 s_cbranch_scc1 L_rk27
 s_call_b64 s[36:37], L_rpoll
L_rk27:
 s_ff1_i32_b32 s71, s70
 s_bitset0_b32 s70, s71
 s_cmp_ge_u32 s71, 16
 s_cselect_b32 s72, s78, s77
 s_cselect_b32 s73, 0x8000000, 0
 s_mul_i32 s71, s71, 114688
 s_add_u32 s19, s71, s72
 buffer_load_dwordx4 v[216:219], v7, s[8:11], s19 offen sc1
 s_or_b32 s69, s69, s73
 buffer_load_dwordx4 v[220:223], v27, s[8:11], s19 offen sc1
 s_waitcnt vmcnt(12)
 s_bitcmp0_b32 s69, 21
 s_cbranch_scc1 L_rx21
 v_dot2c_f32_bf16 v64, v168, v24
 v_dot2c_f32_bf16 v65, v168, v25
 v_dot2c_f32_bf16 v66, v169, v24
 v_dot2c_f32_bf16 v67, v169, v25
 v_dot2c_f32_bf16 v68, v170, v24
 v_dot2c_f32_bf16 v69, v170, v25
 v_dot2c_f32_bf16 v70, v171, v24
 v_dot2c_f32_bf16 v71, v171, v25
 v_dot2c_f32_bf16 v72, v172, v24
 v_dot2c_f32_bf16 v73, v172, v25
 v_dot2c_f32_bf16 v74, v173, v24
 v_dot2c_f32_bf16 v75, v173, v25
 v_dot2c_f32_bf16 v76, v174, v24
 v_dot2c_f32_bf16 v77, v174, v25
 v_dot2c_f32_bf16 v78, v175, v24
 v_dot2c_f32_bf16 v79, v175, v25
L_ry21:
 s_and_b32 s71, s69, 0x3fffff
 s_bcnt1_i32_b32 s71, s71
 s_cmp_eq_u32 s71, 6
 s_cselect_b32 s66, 1, 0
 s_cbranch_scc0 L_rne
 v_fmac_f32 v32, v15, v48
 v_fmac_f32 v33, v15, v49
 v_fmac_f32 v34, v15, v50
 v_fmac_f32 v35, v15, v51
 v_fmac_f32 v36, v15, v52
 v_fmac_f32 v37, v15, v53
 v_fmac_f32 v38, v15, v54
 v_fmac_f32 v39, v15, v55
 v_cvt_pk_bf16_f32 v16, v32, v33
 v_cvt_pk_bf16_f32 v17, v34, v35
 v_cvt_pk_bf16_f32 v18, v36, v37
 v_cvt_pk_bf16_f32 v19, v38, v39
 buffer_store_dwordx4 v[16:19], v12, s[52:55], s75 offen sc1
 v_fmac_f32 v40, v15, v56
 v_fmac_f32 v41, v15, v57
 v_fmac_f32 v42, v15, v58
 v_fmac_f32 v43, v15, v59
 v_fmac_f32 v44, v15, v60
 v_fmac_f32 v45, v15, v61
 v_fmac_f32 v46, v15, v62
 v_fmac_f32 v47, v15, v63
 v_cvt_pk_bf16_f32 v20, v40, v41
 v_cvt_pk_bf16_f32 v21, v42, v43
 v_cvt_pk_bf16_f32 v22, v44, v45
 v_cvt_pk_bf16_f32 v23, v46, v47
 buffer_store_dwordx4 v[20:23], v12, s[52:55], s76 offen sc1
L_rne:
 s_cmp_lg_u32 s70, 0
 s_cbranch_scc1 L_rk28
 s_call_b64 s[36:37], L_rpoll
L_rk28:
 s_ff1_i32_b32 s71, s70
 s_bitset0_b32 s70, s71
 s_cmp_ge_u32 s71, 16
 s_cselect_b32 s72, s78, s77
 s_cselect_b32 s73, 0x10000000, 0
 s_mul_i32 s71, s71, 114688
 s_add_u32 s48, s71, s72
 buffer_load_dwordx4 v[224:227], v7, s[8:11], s48 offen sc1
 s_or_b32 s69, s69, s73
 buffer_load_dwordx4 v[228:231], v27, s[8:11], s48 offen sc1
 s_waitcnt vmcnt(12)
 s_bitcmp0_b32 s69, 22
 s_cbranch_scc1 L_rx22
 v_dot2c_f32_bf16 v64, v176, v24
 v_dot2c_f32_bf16 v65, v176, v25
 v_dot2c_f32_bf16 v66, v177, v24
 v_dot2c_f32_bf16 v67, v177, v25
 v_dot2c_f32_bf16 v68, v178, v24
 v_dot2c_f32_bf16 v69, v178, v25
 v_dot2c_f32_bf16 v70, v179, v24
 v_dot2c_f32_bf16 v71, v179, v25
 v_dot2c_f32_bf16 v72, v180, v24
 v_dot2c_f32_bf16 v73, v180, v25
 v_dot2c_f32_bf16 v74, v181, v24
 v_dot2c_f32_bf16 v75, v181, v25
 v_dot2c_f32_bf16 v76, v182, v24
 v_dot2c_f32_bf16 v77, v182, v25
 v_dot2c_f32_bf16 v78, v183, v24
 v_dot2c_f32_bf16 v79, v183, v25
L_ry22:
 s_cmp_lg_u32 s70, 0
 s_cbranch_scc1 L_rk29
 s_call_b64 s[36:37], L_rpoll
L_rk29:
 s_ff1_i32_b32 s71, s70
 s_bitset0_b32 s70, s71
 s_cmp_ge_u32 s71, 16
 s_cselect_b32 s72, s78, s77
 s_cselect_b32 s73, 0x20000000, 0
 s_mul_i32 s71, s71, 114688
 s_add_u32 s49, s71, s72
 buffer_load_dwordx4 v[232:235], v7, s[8:11], s49 offen sc1
 s_or_b32 s69, s69, s73
 buffer_load_dwordx4 v[236:239], v27, s[8:11], s49 offen sc1
 s_waitcnt vmcnt(12)
 s_bitcmp0_b32 s69, 23
 s_cbranch_scc1 L_rx23
 v_dot2c_f32_bf16 v64, v184, v24
 v_dot2c_f32_bf16 v65, v184, v25
 v_dot2c_f32_bf16 v66, v185, v24
 v_dot2c_f32_bf16 v67, v185, v25
 v_dot2c_f32_bf16 v68, v186, v24
 v_dot2c_f32_bf16 v69, v186, v25
 v_dot2c_f32_bf16 v70, v187, v24
 v_dot2c_f32_bf16 v71, v187, v25
 v_dot2c_f32_bf16 v72, v188, v24
 v_dot2c_f32_bf16 v73, v188, v25
 v_dot2c_f32_bf16 v74, v189, v24
 v_dot2c_f32_bf16 v75, v189, v25
 v_dot2c_f32_bf16 v76, v190, v24
 v_dot2c_f32_bf16 v77, v190, v25
 v_dot2c_f32_bf16 v78, v191, v24
 v_dot2c_f32_bf16 v79, v191, v25
L_ry23:
 s_cmp_lg_u32 s70, 0
 s_cbranch_scc1 L_rk30
 s_call_b64 s[36:37], L_rpoll
L_rk30:
 s_ff1_i32_b32 s71, s70
 s_bitset0_b32 s70, s71
 s_cmp_ge_u32 s71, 16
 s_cselect_b32 s72, s78, s77
 s_cselect_b32 s73, 0x40000000, 0
 s_mul_i32 s71, s71, 114688
 s_add_u32 s50, s71, s72
 buffer_load_dwordx4 v[240:243], v7, s[8:11], s50 offen sc1
 s_or_b32 s69, s69, s73
 buffer_load_dwordx4 v[244:247], v27, s[8:11], s50 offen sc1
 s_waitcnt vmcnt(12)
 s_bitcmp0_b32 s69, 24
 s_cbranch_scc1 L_rx24
 v_dot2c_f32_bf16 v64, v192, v24
 v_dot2c_f32_bf16 v65, v192, v25
 v_dot2c_f32_bf16 v66, v193, v24
 v_dot2c_f32_bf16 v67, v193, v25
 v_dot2c_f32_bf16 v68, v194, v24
 v_dot2c_f32_bf16 v69, v194, v25
 v_dot2c_f32_bf16 v70, v195, v24
 v_dot2c_f32_bf16 v71, v195, v25
 v_dot2c_f32_bf16 v72, v196, v24
 v_dot2c_f32_bf16 v73, v196, v25
 v_dot2c_f32_bf16 v74, v197, v24
 v_dot2c_f32_bf16 v75, v197, v25
 v_dot2c_f32_bf16 v76, v198, v24
 v_dot2c_f32_bf16 v77, v198, v25
 v_dot2c_f32_bf16 v78, v199, v24
 v_dot2c_f32_bf16 v79, v199, v25
L_ry24:
 s_cmp_lg_u32 s70, 0
 s_cbranch_scc1 L_rk31
 s_call_b64 s[36:37], L_rpoll
L_rk31:
 s_ff1_i32_b32 s71, s70
 s_bitset0_b32 s70, s71
 s_cmp_ge_u32 s71, 16
 s_cselect_b32 s72, s78, s77
 s_cselect_b32 s73, 0x80000000, 0
 s_mul_i32 s71, s71, 114688
 s_add_u32 s51, s71, s72
 buffer_load_dwordx4 v[248:251], v7, s[8:11], s51 offen sc1
 s_or_b32 s69, s69, s73
 buffer_load_dwordx4 v[252:255], v27, s[8:11], s51 offen sc1
 s_waitcnt vmcnt(12)
 s_bitcmp0_b32 s69, 25
 s_cbranch_scc1 L_rx25
 v_dot2c_f32_bf16 v64, v200, v24
 v_dot2c_f32_bf16 v65, v200, v25
 v_dot2c_f32_bf16 v66, v201, v24
 v_dot2c_f32_bf16 v67, v201, v25
 v_dot2c_f32_bf16 v68, v202, v24
 v_dot2c_f32_bf16 v69, v202, v25
 v_dot2c_f32_bf16 v70, v203, v24
 v_dot2c_f32_bf16 v71, v203, v25
 v_dot2c_f32_bf16 v72, v204, v24
 v_dot2c_f32_bf16 v73, v204, v25
 v_dot2c_f32_bf16 v74, v205, v24
 v_dot2c_f32_bf16 v75, v205, v25
 v_dot2c_f32_bf16 v76, v206, v24
 v_dot2c_f32_bf16 v77, v206, v25
 v_dot2c_f32_bf16 v78, v207, v24
 v_dot2c_f32_bf16 v79, v207, v25
L_ry25:
 s_waitcnt vmcnt(10)
 s_bitcmp0_b32 s69, 26
 s_cbranch_scc1 L_rx26
 v_dot2c_f32_bf16 v64, v208, v24
 v_dot2c_f32_bf16 v65, v208, v25
 v_dot2c_f32_bf16 v66, v209, v24
 v_dot2c_f32_bf16 v67, v209, v25
 v_dot2c_f32_bf16 v68, v210, v24
 v_dot2c_f32_bf16 v69, v210, v25
 v_dot2c_f32_bf16 v70, v211, v24
 v_dot2c_f32_bf16 v71, v211, v25
 v_dot2c_f32_bf16 v72, v212, v24
 v_dot2c_f32_bf16 v73, v212, v25
 v_dot2c_f32_bf16 v74, v213, v24
 v_dot2c_f32_bf16 v75, v213, v25
 v_dot2c_f32_bf16 v76, v214, v24
 v_dot2c_f32_bf16 v77, v214, v25
 v_dot2c_f32_bf16 v78, v215, v24
 v_dot2c_f32_bf16 v79, v215, v25
L_ry26:
 s_waitcnt vmcnt(8)
 s_bitcmp0_b32 s69, 27
 s_cbranch_scc1 L_rx27
 v_dot2c_f32_bf16 v64, v216, v24
 v_dot2c_f32_bf16 v65, v216, v25
 v_dot2c_f32_bf16 v66, v217, v24
 v_dot2c_f32_bf16 v67, v217, v25
 v_dot2c_f32_bf16 v68, v218, v24
 v_dot2c_f32_bf16 v69, v218, v25
 v_dot2c_f32_bf16 v70, v219, v24
 v_dot2c_f32_bf16 v71, v219, v25
 v_dot2c_f32_bf16 v72, v220, v24
 v_dot2c_f32_bf16 v73, v220, v25
 v_dot2c_f32_bf16 v74, v221, v24
 v_dot2c_f32_bf16 v75, v221, v25
 v_dot2c_f32_bf16 v76, v222, v24
 v_dot2c_f32_bf16 v77, v222, v25
 v_dot2c_f32_bf16 v78, v223, v24
 v_dot2c_f32_bf16 v79, v223, v25
L_ry27:
 s_waitcnt vmcnt(6)
 s_bitcmp0_b32 s69, 28
 s_cbranch_scc1 L_rx28
 v_dot2c_f32_bf16 v64, v224, v24
 v_dot2c_f32_bf16 v65, v224, v25
 v_dot2c_f32_bf16 v66, v225, v24
 v_dot2c_f32_bf16 v67, v225, v25
 v_dot2c_f32_bf16 v68, v226, v24
 v_dot2c_f32_bf16 v69, v226, v25
 v_dot2c_f32_bf16 v70, v227, v24
 v_dot2c_f32_bf16 v71, v227, v25
 v_dot2c_f32_bf16 v72, v228, v24
 v_dot2c_f32_bf16 v73, v228, v25
 v_dot2c_f32_bf16 v74, v229, v24
 v_dot2c_f32_bf16 v75, v229, v25
 v_dot2c_f32_bf16 v76, v230, v24
 v_dot2c_f32_bf16 v77, v230, v25
 v_dot2c_f32_bf16 v78, v231, v24
 v_dot2c_f32_bf16 v79, v231, v25
L_ry28:
 s_waitcnt vmcnt(4)
 s_bitcmp0_b32 s69, 29
 s_cbranch_scc1 L_rx29
 v_dot2c_f32_bf16 v64, v232, v24
 v_dot2c_f32_bf16 v65, v232, v25
 v_dot2c_f32_bf16 v66, v233, v24
 v_dot2c_f32_bf16 v67, v233, v25
 v_dot2c_f32_bf16 v68, v234, v24
 v_dot2c_f32_bf16 v69, v234, v25
 v_dot2c_f32_bf16 v70, v235, v24
 v_dot2c_f32_bf16 v71, v235, v25
 v_dot2c_f32_bf16 v72, v236, v24
 v_dot2c_f32_bf16 v73, v236, v25
 v_dot2c_f32_bf16 v74, v237, v24
 v_dot2c_f32_bf16 v75, v237, v25
 v_dot2c_f32_bf16 v76, v238, v24
 v_dot2c_f32_bf16 v77, v238, v25
 v_dot2c_f32_bf16 v78, v239, v24
 v_dot2c_f32_bf16 v79, v239, v25
L_ry29:
 s_waitcnt vmcnt(2)
 s_bitcmp0_b32 s69, 30
 s_cbranch_scc1 L_rx30
 v_dot2c_f32_bf16 v64, v240, v24
 v_dot2c_f32_bf16 v65, v240, v25
 v_dot2c_f32_bf16 v66, v241, v24
 v_dot2c_f32_bf16 v67, v241, v25
 v_dot2c_f32_bf16 v68, v242, v24
 v_dot2c_f32_bf16 v69, v242, v25
 v_dot2c_f32_bf16 v70, v243, v24
 v_dot2c_f32_bf16 v71, v243, v25
 v_dot2c_f32_bf16 v72, v244, v24
 v_dot2c_f32_bf16 v73, v244, v25
 v_dot2c_f32_bf16 v74, v245, v24
 v_dot2c_f32_bf16 v75, v245, v25
 v_dot2c_f32_bf16 v76, v246, v24
 v_dot2c_f32_bf16 v77, v246, v25
 v_dot2c_f32_bf16 v78, v247, v24
 v_dot2c_f32_bf16 v79, v247, v25
L_ry30:
 s_waitcnt vmcnt(0)
 s_bitcmp0_b32 s69, 31
 s_cbranch_scc1 L_rx31
 v_dot2c_f32_bf16 v64, v248, v24
 v_dot2c_f32_bf16 v65, v248, v25
 v_dot2c_f32_bf16 v66, v249, v24
 v_dot2c_f32_bf16 v67, v249, v25
 v_dot2c_f32_bf16 v68, v250, v24
 v_dot2c_f32_bf16 v69, v250, v25
 v_dot2c_f32_bf16 v70, v251, v24
 v_dot2c_f32_bf16 v71, v251, v25
 v_dot2c_f32_bf16 v72, v252, v24
 v_dot2c_f32_bf16 v73, v252, v25
 v_dot2c_f32_bf16 v74, v253, v24
 v_dot2c_f32_bf16 v75, v253, v25
 v_dot2c_f32_bf16 v76, v254, v24
 v_dot2c_f32_bf16 v77, v254, v25
 v_dot2c_f32_bf16 v78, v255, v24
 v_dot2c_f32_bf16 v79, v255, v25
L_ry31:
 s_nop 1
 v_fmac_f32 v80, v26, v64
 v_fmac_f32 v81, v26, v65
 v_fmac_f32 v82, v26, v66
 v_fmac_f32 v83, v26, v67
 v_fmac_f32 v84, v26, v68
 v_fmac_f32 v85, v26, v69
 v_fmac_f32 v86, v26, v70
 v_fmac_f32 v87, v26, v71
 v_cvt_pk_bf16_f32 v96, v80, v81
 v_cvt_pk_bf16_f32 v97, v82, v83
 v_cvt_pk_bf16_f32 v98, v84, v85
 v_cvt_pk_bf16_f32 v99, v86, v87
 buffer_store_dwordx4 v[96:99], v28, s[52:55], s75 offen sc1
 v_fmac_f32 v88, v26, v72
 v_fmac_f32 v89, v26, v73
 v_fmac_f32 v90, v26, v74
 v_fmac_f32 v91, v26, v75
 v_fmac_f32 v92, v26, v76
 v_fmac_f32 v93, v26, v77
 v_fmac_f32 v94, v26, v78
 v_fmac_f32 v95, v26, v79
 v_cvt_pk_bf16_f32 v100, v88, v89
 v_cvt_pk_bf16_f32 v101, v90, v91
 v_cvt_pk_bf16_f32 v102, v92, v93
 v_cvt_pk_bf16_f32 v103, v94, v95
 buffer_store_dwordx4 v[100:103], v28, s[52:55], s76 offen sc1
 s_cmp_eq_u32 s66, 1
 s_cbranch_scc1 L_rdone
 v_fmac_f32 v32, v15, v48
 v_fmac_f32 v33, v15, v49
 v_fmac_f32 v34, v15, v50
 v_fmac_f32 v35, v15, v51
 v_fmac_f32 v36, v15, v52
 v_fmac_f32 v37, v15, v53
 v_fmac_f32 v38, v15, v54
 v_fmac_f32 v39, v15, v55
 v_cvt_pk_bf16_f32 v16, v32, v33
 v_cvt_pk_bf16_f32 v17, v34, v35
 v_cvt_pk_bf16_f32 v18, v36, v37
 v_cvt_pk_bf16_f32 v19, v38, v39
 buffer_store_dwordx4 v[16:19], v12, s[52:55], s75 offen sc1
 v_fmac_f32 v40, v15, v56
 v_fmac_f32 v41, v15, v57
 v_fmac_f32 v42, v15, v58
 v_fmac_f32 v43, v15, v59
 v_fmac_f32 v44, v15, v60
 v_fmac_f32 v45, v15, v61
 v_fmac_f32 v46, v15, v62
 v_fmac_f32 v47, v15, v63
 v_cvt_pk_bf16_f32 v20, v40, v41
 v_cvt_pk_bf16_f32 v21, v42, v43
 v_cvt_pk_bf16_f32 v22, v44, v45
 v_cvt_pk_bf16_f32 v23, v46, v47
 buffer_store_dwordx4 v[20:23], v12, s[52:55], s76 offen sc1
L_rdone:
 s_endpgm
L_rx0:
 v_dot2c_f32_bf16 v64, v128, v24
 v_dot2c_f32_bf16 v65, v128, v25
 v_dot2c_f32_bf16 v66, v129, v24
 v_dot2c_f32_bf16 v67, v129, v25
 v_dot2c_f32_bf16 v68, v130, v24
 v_dot2c_f32_bf16 v69, v130, v25
 v_dot2c_f32_bf16 v70, v131, v24
 v_dot2c_f32_bf16 v71, v131, v25
 v_dot2c_f32_bf16 v72, v132, v24
 v_dot2c_f32_bf16 v73, v132, v25
 v_dot2c_f32_bf16 v74, v133, v24
 v_dot2c_f32_bf16 v75, v133, v25
 v_dot2c_f32_bf16 v76, v134, v24
 v_dot2c_f32_bf16 v77, v134, v25
 v_dot2c_f32_bf16 v78, v135, v24
 v_dot2c_f32_bf16 v79, v135, v25
 s_branch L_ry0
L_rx1:
 v_dot2c_f32_bf16 v64, v136, v24
 v_dot2c_f32_bf16 v65, v136, v25
 v_dot2c_f32_bf16 v66, v137, v24
 v_dot2c_f32_bf16 v67, v137, v25
 v_dot2c_f32_bf16 v68, v138, v24
 v_dot2c_f32_bf16 v69, v138, v25
 v_dot2c_f32_bf16 v70, v139, v24
 v_dot2c_f32_bf16 v71, v139, v25
 v_dot2c_f32_bf16 v72, v140, v24
 v_dot2c_f32_bf16 v73, v140, v25
 v_dot2c_f32_bf16 v74, v141, v24
 v_dot2c_f32_bf16 v75, v141, v25
 v_dot2c_f32_bf16 v76, v142, v24
 v_dot2c_f32_bf16 v77, v142, v25
 v_dot2c_f32_bf16 v78, v143, v24
 v_dot2c_f32_bf16 v79, v143, v25
 s_branch L_ry1
L_rx2:
 v_dot2c_f32_bf16 v64, v144, v24
 v_dot2c_f32_bf16 v65, v144, v25
 v_dot2c_f32_bf16 v66, v145, v24
 v_dot2c_f32_bf16 v67, v145, v25
 v_dot2c_f32_bf16 v68, v146, v24
 v_dot2c_f32_bf16 v69, v146, v25
 v_dot2c_f32_bf16 v70, v147, v24
 v_dot2c_f32_bf16 v71, v147, v25
 v_dot2c_f32_bf16 v72, v148, v24
 v_dot2c_f32_bf16 v73, v148, v25
 v_dot2c_f32_bf16 v74, v149, v24
 v_dot2c_f32_bf16 v75, v149, v25
 v_dot2c_f32_bf16 v76, v150, v24
 v_dot2c_f32_bf16 v77, v150, v25
 v_dot2c_f32_bf16 v78, v151, v24
 v_dot2c_f32_bf16 v79, v151, v25
 s_branch L_ry2
L_rx3:
 v_dot2c_f32_bf16 v64, v152, v24
 v_dot2c_f32_bf16 v65, v152, v25
 v_dot2c_f32_bf16 v66, v153, v24
 v_dot2c_f32_bf16 v67, v153, v25
 v_dot2c_f32_bf16 v68, v154, v24
 v_dot2c_f32_bf16 v69, v154, v25
 v_dot2c_f32_bf16 v70, v155, v24
 v_dot2c_f32_bf16 v71, v155, v25
 v_dot2c_f32_bf16 v72, v156, v24
 v_dot2c_f32_bf16 v73, v156, v25
 v_dot2c_f32_bf16 v74, v157, v24
 v_dot2c_f32_bf16 v75, v157, v25
 v_dot2c_f32_bf16 v76, v158, v24
 v_dot2c_f32_bf16 v77, v158, v25
 v_dot2c_f32_bf16 v78, v159, v24
 v_dot2c_f32_bf16 v79, v159, v25
 s_branch L_ry3
L_rx4:
 v_dot2c_f32_bf16 v64, v160, v24
 v_dot2c_f32_bf16 v65, v160, v25
 v_dot2c_f32_bf16 v66, v161, v24
 v_dot2c_f32_bf16 v67, v161, v25
 v_dot2c_f32_bf16 v68, v162, v24
 v_dot2c_f32_bf16 v69, v162, v25
 v_dot2c_f32_bf16 v70, v163, v24
 v_dot2c_f32_bf16 v71, v163, v25
 v_dot2c_f32_bf16 v72, v164, v24
 v_dot2c_f32_bf16 v73, v164, v25
 v_dot2c_f32_bf16 v74, v165, v24
 v_dot2c_f32_bf16 v75, v165, v25
 v_dot2c_f32_bf16 v76, v166, v24
 v_dot2c_f32_bf16 v77, v166, v25
 v_dot2c_f32_bf16 v78, v167, v24
 v_dot2c_f32_bf16 v79, v167, v25
 s_branch L_ry4
L_rx5:
 v_dot2c_f32_bf16 v64, v168, v24
 v_dot2c_f32_bf16 v65, v168, v25
 v_dot2c_f32_bf16 v66, v169, v24
 v_dot2c_f32_bf16 v67, v169, v25
 v_dot2c_f32_bf16 v68, v170, v24
 v_dot2c_f32_bf16 v69, v170, v25
 v_dot2c_f32_bf16 v70, v171, v24
 v_dot2c_f32_bf16 v71, v171, v25
 v_dot2c_f32_bf16 v72, v172, v24
 v_dot2c_f32_bf16 v73, v172, v25
 v_dot2c_f32_bf16 v74, v173, v24
 v_dot2c_f32_bf16 v75, v173, v25
 v_dot2c_f32_bf16 v76, v174, v24
 v_dot2c_f32_bf16 v77, v174, v25
 v_dot2c_f32_bf16 v78, v175, v24
 v_dot2c_f32_bf16 v79, v175, v25
 s_branch L_ry5
L_rx6:
 v_dot2c_f32_bf16 v64, v176, v24
 v_dot2c_f32_bf16 v65, v176, v25
 v_dot2c_f32_bf16 v66, v177, v24
 v_dot2c_f32_bf16 v67, v177, v25
 v_dot2c_f32_bf16 v68, v178, v24
 v_dot2c_f32_bf16 v69, v178, v25
 v_dot2c_f32_bf16 v70, v179, v24
 v_dot2c_f32_bf16 v71, v179, v25
 v_dot2c_f32_bf16 v72, v180, v24
 v_dot2c_f32_bf16 v73, v180, v25
 v_dot2c_f32_bf16 v74, v181, v24
 v_dot2c_f32_bf16 v75, v181, v25
 v_dot2c_f32_bf16 v76, v182, v24
 v_dot2c_f32_bf16 v77, v182, v25
 v_dot2c_f32_bf16 v78, v183, v24
 v_dot2c_f32_bf16 v79, v183, v25
 s_branch L_ry6
L_rx7:
 v_dot2c_f32_bf16 v64, v184, v24
 v_dot2c_f32_bf16 v65, v184, v25
 v_dot2c_f32_bf16 v66, v185, v24
 v_dot2c_f32_bf16 v67, v185, v25
 v_dot2c_f32_bf16 v68, v186, v24
 v_dot2c_f32_bf16 v69, v186, v25
 v_dot2c_f32_bf16 v70, v187, v24
 v_dot2c_f32_bf16 v71, v187, v25
 v_dot2c_f32_bf16 v72, v188, v24
 v_dot2c_f32_bf16 v73, v188, v25
 v_dot2c_f32_bf16 v74, v189, v24
 v_dot2c_f32_bf16 v75, v189, v25
 v_dot2c_f32_bf16 v76, v190, v24
 v_dot2c_f32_bf16 v77, v190, v25
 v_dot2c_f32_bf16 v78, v191, v24
 v_dot2c_f32_bf16 v79, v191, v25
 s_branch L_ry7
L_rx8:
 v_dot2c_f32_bf16 v64, v192, v24
 v_dot2c_f32_bf16 v65, v192, v25
 v_dot2c_f32_bf16 v66, v193, v24
 v_dot2c_f32_bf16 v67, v193, v25
 v_dot2c_f32_bf16 v68, v194, v24
 v_dot2c_f32_bf16 v69, v194, v25
 v_dot2c_f32_bf16 v70, v195, v24
 v_dot2c_f32_bf16 v71, v195, v25
 v_dot2c_f32_bf16 v72, v196, v24
 v_dot2c_f32_bf16 v73, v196, v25
 v_dot2c_f32_bf16 v74, v197, v24
 v_dot2c_f32_bf16 v75, v197, v25
 v_dot2c_f32_bf16 v76, v198, v24
 v_dot2c_f32_bf16 v77, v198, v25
 v_dot2c_f32_bf16 v78, v199, v24
 v_dot2c_f32_bf16 v79, v199, v25
 s_branch L_ry8
L_rx9:
 v_dot2c_f32_bf16 v64, v200, v24
 v_dot2c_f32_bf16 v65, v200, v25
 v_dot2c_f32_bf16 v66, v201, v24
 v_dot2c_f32_bf16 v67, v201, v25
 v_dot2c_f32_bf16 v68, v202, v24
 v_dot2c_f32_bf16 v69, v202, v25
 v_dot2c_f32_bf16 v70, v203, v24
 v_dot2c_f32_bf16 v71, v203, v25
 v_dot2c_f32_bf16 v72, v204, v24
 v_dot2c_f32_bf16 v73, v204, v25
 v_dot2c_f32_bf16 v74, v205, v24
 v_dot2c_f32_bf16 v75, v205, v25
 v_dot2c_f32_bf16 v76, v206, v24
 v_dot2c_f32_bf16 v77, v206, v25
 v_dot2c_f32_bf16 v78, v207, v24
 v_dot2c_f32_bf16 v79, v207, v25
 s_branch L_ry9
L_rx10:
 v_dot2c_f32_bf16 v64, v208, v24
 v_dot2c_f32_bf16 v65, v208, v25
 v_dot2c_f32_bf16 v66, v209, v24
 v_dot2c_f32_bf16 v67, v209, v25
 v_dot2c_f32_bf16 v68, v210, v24
 v_dot2c_f32_bf16 v69, v210, v25
 v_dot2c_f32_bf16 v70, v211, v24
 v_dot2c_f32_bf16 v71, v211, v25
 v_dot2c_f32_bf16 v72, v212, v24
 v_dot2c_f32_bf16 v73, v212, v25
 v_dot2c_f32_bf16 v74, v213, v24
 v_dot2c_f32_bf16 v75, v213, v25
 v_dot2c_f32_bf16 v76, v214, v24
 v_dot2c_f32_bf16 v77, v214, v25
 v_dot2c_f32_bf16 v78, v215, v24
 v_dot2c_f32_bf16 v79, v215, v25
 s_branch L_ry10
L_rx11:
 v_dot2c_f32_bf16 v64, v216, v24
 v_dot2c_f32_bf16 v65, v216, v25
 v_dot2c_f32_bf16 v66, v217, v24
 v_dot2c_f32_bf16 v67, v217, v25
 v_dot2c_f32_bf16 v68, v218, v24
 v_dot2c_f32_bf16 v69, v218, v25
 v_dot2c_f32_bf16 v70, v219, v24
 v_dot2c_f32_bf16 v71, v219, v25
 v_dot2c_f32_bf16 v72, v220, v24
 v_dot2c_f32_bf16 v73, v220, v25
 v_dot2c_f32_bf16 v74, v221, v24
 v_dot2c_f32_bf16 v75, v221, v25
 v_dot2c_f32_bf16 v76, v222, v24
 v_dot2c_f32_bf16 v77, v222, v25
 v_dot2c_f32_bf16 v78, v223, v24
 v_dot2c_f32_bf16 v79, v223, v25
 s_branch L_ry11
L_rx12:
 v_dot2c_f32_bf16 v64, v224, v24
 v_dot2c_f32_bf16 v65, v224, v25
 v_dot2c_f32_bf16 v66, v225, v24
 v_dot2c_f32_bf16 v67, v225, v25
 v_dot2c_f32_bf16 v68, v226, v24
 v_dot2c_f32_bf16 v69, v226, v25
 v_dot2c_f32_bf16 v70, v227, v24
 v_dot2c_f32_bf16 v71, v227, v25
 v_dot2c_f32_bf16 v72, v228, v24
 v_dot2c_f32_bf16 v73, v228, v25
 v_dot2c_f32_bf16 v74, v229, v24
 v_dot2c_f32_bf16 v75, v229, v25
 v_dot2c_f32_bf16 v76, v230, v24
 v_dot2c_f32_bf16 v77, v230, v25
 v_dot2c_f32_bf16 v78, v231, v24
 v_dot2c_f32_bf16 v79, v231, v25
 s_branch L_ry12
L_rx13:
 v_dot2c_f32_bf16 v64, v232, v24
 v_dot2c_f32_bf16 v65, v232, v25
 v_dot2c_f32_bf16 v66, v233, v24
 v_dot2c_f32_bf16 v67, v233, v25
 v_dot2c_f32_bf16 v68, v234, v24
 v_dot2c_f32_bf16 v69, v234, v25
 v_dot2c_f32_bf16 v70, v235, v24
 v_dot2c_f32_bf16 v71, v235, v25
 v_dot2c_f32_bf16 v72, v236, v24
 v_dot2c_f32_bf16 v73, v236, v25
 v_dot2c_f32_bf16 v74, v237, v24
 v_dot2c_f32_bf16 v75, v237, v25
 v_dot2c_f32_bf16 v76, v238, v24
 v_dot2c_f32_bf16 v77, v238, v25
 v_dot2c_f32_bf16 v78, v239, v24
 v_dot2c_f32_bf16 v79, v239, v25
 s_branch L_ry13
L_rx14:
 v_dot2c_f32_bf16 v64, v240, v24
 v_dot2c_f32_bf16 v65, v240, v25
 v_dot2c_f32_bf16 v66, v241, v24
 v_dot2c_f32_bf16 v67, v241, v25
 v_dot2c_f32_bf16 v68, v242, v24
 v_dot2c_f32_bf16 v69, v242, v25
 v_dot2c_f32_bf16 v70, v243, v24
 v_dot2c_f32_bf16 v71, v243, v25
 v_dot2c_f32_bf16 v72, v244, v24
 v_dot2c_f32_bf16 v73, v244, v25
 v_dot2c_f32_bf16 v74, v245, v24
 v_dot2c_f32_bf16 v75, v245, v25
 v_dot2c_f32_bf16 v76, v246, v24
 v_dot2c_f32_bf16 v77, v246, v25
 v_dot2c_f32_bf16 v78, v247, v24
 v_dot2c_f32_bf16 v79, v247, v25
 s_branch L_ry14
L_rx15:
 v_dot2c_f32_bf16 v64, v248, v24
 v_dot2c_f32_bf16 v65, v248, v25
 v_dot2c_f32_bf16 v66, v249, v24
 v_dot2c_f32_bf16 v67, v249, v25
 v_dot2c_f32_bf16 v68, v250, v24
 v_dot2c_f32_bf16 v69, v250, v25
 v_dot2c_f32_bf16 v70, v251, v24
 v_dot2c_f32_bf16 v71, v251, v25
 v_dot2c_f32_bf16 v72, v252, v24
 v_dot2c_f32_bf16 v73, v252, v25
 v_dot2c_f32_bf16 v74, v253, v24
 v_dot2c_f32_bf16 v75, v253, v25
 v_dot2c_f32_bf16 v76, v254, v24
 v_dot2c_f32_bf16 v77, v254, v25
 v_dot2c_f32_bf16 v78, v255, v24
 v_dot2c_f32_bf16 v79, v255, v25
 s_branch L_ry15
L_rx16:
 v_dot2c_f32_bf16 v48, v128, v24
 v_dot2c_f32_bf16 v49, v128, v25
 v_dot2c_f32_bf16 v50, v129, v24
 v_dot2c_f32_bf16 v51, v129, v25
 v_dot2c_f32_bf16 v52, v130, v24
 v_dot2c_f32_bf16 v53, v130, v25
 v_dot2c_f32_bf16 v54, v131, v24
 v_dot2c_f32_bf16 v55, v131, v25
 v_dot2c_f32_bf16 v56, v132, v24
 v_dot2c_f32_bf16 v57, v132, v25
 v_dot2c_f32_bf16 v58, v133, v24
 v_dot2c_f32_bf16 v59, v133, v25
 v_dot2c_f32_bf16 v60, v134, v24
 v_dot2c_f32_bf16 v61, v134, v25
 v_dot2c_f32_bf16 v62, v135, v24
 v_dot2c_f32_bf16 v63, v135, v25
 s_branch L_ry16
L_rx17:
 v_dot2c_f32_bf16 v48, v136, v24
 v_dot2c_f32_bf16 v49, v136, v25
 v_dot2c_f32_bf16 v50, v137, v24
 v_dot2c_f32_bf16 v51, v137, v25
 v_dot2c_f32_bf16 v52, v138, v24
 v_dot2c_f32_bf16 v53, v138, v25
 v_dot2c_f32_bf16 v54, v139, v24
 v_dot2c_f32_bf16 v55, v139, v25
 v_dot2c_f32_bf16 v56, v140, v24
 v_dot2c_f32_bf16 v57, v140, v25
 v_dot2c_f32_bf16 v58, v141, v24
 v_dot2c_f32_bf16 v59, v141, v25
 v_dot2c_f32_bf16 v60, v142, v24
 v_dot2c_f32_bf16 v61, v142, v25
 v_dot2c_f32_bf16 v62, v143, v24
 v_dot2c_f32_bf16 v63, v143, v25
 s_branch L_ry17
L_rx18:
 v_dot2c_f32_bf16 v48, v144, v24
 v_dot2c_f32_bf16 v49, v144, v25
 v_dot2c_f32_bf16 v50, v145, v24
 v_dot2c_f32_bf16 v51, v145, v25
 v_dot2c_f32_bf16 v52, v146, v24
 v_dot2c_f32_bf16 v53, v146, v25
 v_dot2c_f32_bf16 v54, v147, v24
 v_dot2c_f32_bf16 v55, v147, v25
 v_dot2c_f32_bf16 v56, v148, v24
 v_dot2c_f32_bf16 v57, v148, v25
 v_dot2c_f32_bf16 v58, v149, v24
 v_dot2c_f32_bf16 v59, v149, v25
 v_dot2c_f32_bf16 v60, v150, v24
 v_dot2c_f32_bf16 v61, v150, v25
 v_dot2c_f32_bf16 v62, v151, v24
 v_dot2c_f32_bf16 v63, v151, v25
 s_branch L_ry18
L_rx19:
 v_dot2c_f32_bf16 v48, v152, v24
 v_dot2c_f32_bf16 v49, v152, v25
 v_dot2c_f32_bf16 v50, v153, v24
 v_dot2c_f32_bf16 v51, v153, v25
 v_dot2c_f32_bf16 v52, v154, v24
 v_dot2c_f32_bf16 v53, v154, v25
 v_dot2c_f32_bf16 v54, v155, v24
 v_dot2c_f32_bf16 v55, v155, v25
 v_dot2c_f32_bf16 v56, v156, v24
 v_dot2c_f32_bf16 v57, v156, v25
 v_dot2c_f32_bf16 v58, v157, v24
 v_dot2c_f32_bf16 v59, v157, v25
 v_dot2c_f32_bf16 v60, v158, v24
 v_dot2c_f32_bf16 v61, v158, v25
 v_dot2c_f32_bf16 v62, v159, v24
 v_dot2c_f32_bf16 v63, v159, v25
 s_branch L_ry19
L_rx20:
 v_dot2c_f32_bf16 v48, v160, v24
 v_dot2c_f32_bf16 v49, v160, v25
 v_dot2c_f32_bf16 v50, v161, v24
 v_dot2c_f32_bf16 v51, v161, v25
 v_dot2c_f32_bf16 v52, v162, v24
 v_dot2c_f32_bf16 v53, v162, v25
 v_dot2c_f32_bf16 v54, v163, v24
 v_dot2c_f32_bf16 v55, v163, v25
 v_dot2c_f32_bf16 v56, v164, v24
 v_dot2c_f32_bf16 v57, v164, v25
 v_dot2c_f32_bf16 v58, v165, v24
 v_dot2c_f32_bf16 v59, v165, v25
 v_dot2c_f32_bf16 v60, v166, v24
 v_dot2c_f32_bf16 v61, v166, v25
 v_dot2c_f32_bf16 v62, v167, v24
 v_dot2c_f32_bf16 v63, v167, v25
 s_branch L_ry20
L_rx21:
 v_dot2c_f32_bf16 v48, v168, v24
 v_dot2c_f32_bf16 v49, v168, v25
 v_dot2c_f32_bf16 v50, v169, v24
 v_dot2c_f32_bf16 v51, v169, v25
 v_dot2c_f32_bf16 v52, v170, v24
 v_dot2c_f32_bf16 v53, v170, v25
 v_dot2c_f32_bf16 v54, v171, v24
 v_dot2c_f32_bf16 v55, v171, v25
 v_dot2c_f32_bf16 v56, v172, v24
 v_dot2c_f32_bf16 v57, v172, v25
 v_dot2c_f32_bf16 v58, v173, v24
 v_dot2c_f32_bf16 v59, v173, v25
 v_dot2c_f32_bf16 v60, v174, v24
 v_dot2c_f32_bf16 v61, v174, v25
 v_dot2c_f32_bf16 v62, v175, v24
 v_dot2c_f32_bf16 v63, v175, v25
 s_branch L_ry21
L_rx22:
 v_dot2c_f32_bf16 v48, v176, v24
 v_dot2c_f32_bf16 v49, v176, v25
 v_dot2c_f32_bf16 v50, v177, v24
 v_dot2c_f32_bf16 v51, v177, v25
 v_dot2c_f32_bf16 v52, v178, v24
 v_dot2c_f32_bf16 v53, v178, v25
 v_dot2c_f32_bf16 v54, v179, v24
 v_dot2c_f32_bf16 v55, v179, v25
 v_dot2c_f32_bf16 v56, v180, v24
 v_dot2c_f32_bf16 v57, v180, v25
 v_dot2c_f32_bf16 v58, v181, v24
 v_dot2c_f32_bf16 v59, v181, v25
 v_dot2c_f32_bf16 v60, v182, v24
 v_dot2c_f32_bf16 v61, v182, v25
 v_dot2c_f32_bf16 v62, v183, v24
 v_dot2c_f32_bf16 v63, v183, v25
 s_branch L_ry22
L_rx23:
 v_dot2c_f32_bf16 v48, v184, v24
 v_dot2c_f32_bf16 v49, v184, v25
 v_dot2c_f32_bf16 v50, v185, v24
 v_dot2c_f32_bf16 v51, v185, v25
 v_dot2c_f32_bf16 v52, v186, v24
 v_dot2c_f32_bf16 v53, v186, v25
 v_dot2c_f32_bf16 v54, v187, v24
 v_dot2c_f32_bf16 v55, v187, v25
 v_dot2c_f32_bf16 v56, v188, v24
 v_dot2c_f32_bf16 v57, v188, v25
 v_dot2c_f32_bf16 v58, v189, v24
 v_dot2c_f32_bf16 v59, v189, v25
 v_dot2c_f32_bf16 v60, v190, v24
 v_dot2c_f32_bf16 v61, v190, v25
 v_dot2c_f32_bf16 v62, v191, v24
 v_dot2c_f32_bf16 v63, v191, v25
 s_branch L_ry23
L_rx24:
 v_dot2c_f32_bf16 v48, v192, v24
 v_dot2c_f32_bf16 v49, v192, v25
 v_dot2c_f32_bf16 v50, v193, v24
 v_dot2c_f32_bf16 v51, v193, v25
 v_dot2c_f32_bf16 v52, v194, v24
 v_dot2c_f32_bf16 v53, v194, v25
 v_dot2c_f32_bf16 v54, v195, v24
 v_dot2c_f32_bf16 v55, v195, v25
 v_dot2c_f32_bf16 v56, v196, v24
 v_dot2c_f32_bf16 v57, v196, v25
 v_dot2c_f32_bf16 v58, v197, v24
 v_dot2c_f32_bf16 v59, v197, v25
 v_dot2c_f32_bf16 v60, v198, v24
 v_dot2c_f32_bf16 v61, v198, v25
 v_dot2c_f32_bf16 v62, v199, v24
 v_dot2c_f32_bf16 v63, v199, v25
 s_branch L_ry24
L_rx25:
 v_dot2c_f32_bf16 v48, v200, v24
 v_dot2c_f32_bf16 v49, v200, v25
 v_dot2c_f32_bf16 v50, v201, v24
 v_dot2c_f32_bf16 v51, v201, v25
 v_dot2c_f32_bf16 v52, v202, v24
 v_dot2c_f32_bf16 v53, v202, v25
 v_dot2c_f32_bf16 v54, v203, v24
 v_dot2c_f32_bf16 v55, v203, v25
 v_dot2c_f32_bf16 v56, v204, v24
 v_dot2c_f32_bf16 v57, v204, v25
 v_dot2c_f32_bf16 v58, v205, v24
 v_dot2c_f32_bf16 v59, v205, v25
 v_dot2c_f32_bf16 v60, v206, v24
 v_dot2c_f32_bf16 v61, v206, v25
 v_dot2c_f32_bf16 v62, v207, v24
 v_dot2c_f32_bf16 v63, v207, v25
 s_branch L_ry25
L_rx26:
 v_dot2c_f32_bf16 v48, v208, v24
 v_dot2c_f32_bf16 v49, v208, v25
 v_dot2c_f32_bf16 v50, v209, v24
 v_dot2c_f32_bf16 v51, v209, v25
 v_dot2c_f32_bf16 v52, v210, v24
 v_dot2c_f32_bf16 v53, v210, v25
 v_dot2c_f32_bf16 v54, v211, v24
 v_dot2c_f32_bf16 v55, v211, v25
 v_dot2c_f32_bf16 v56, v212, v24
 v_dot2c_f32_bf16 v57, v212, v25
 v_dot2c_f32_bf16 v58, v213, v24
 v_dot2c_f32_bf16 v59, v213, v25
 v_dot2c_f32_bf16 v60, v214, v24
 v_dot2c_f32_bf16 v61, v214, v25
 v_dot2c_f32_bf16 v62, v215, v24
 v_dot2c_f32_bf16 v63, v215, v25
 s_branch L_ry26
L_rx27:
 v_dot2c_f32_bf16 v48, v216, v24
 v_dot2c_f32_bf16 v49, v216, v25
 v_dot2c_f32_bf16 v50, v217, v24
 v_dot2c_f32_bf16 v51, v217, v25
 v_dot2c_f32_bf16 v52, v218, v24
 v_dot2c_f32_bf16 v53, v218, v25
 v_dot2c_f32_bf16 v54, v219, v24
 v_dot2c_f32_bf16 v55, v219, v25
 v_dot2c_f32_bf16 v56, v220, v24
 v_dot2c_f32_bf16 v57, v220, v25
 v_dot2c_f32_bf16 v58, v221, v24
 v_dot2c_f32_bf16 v59, v221, v25
 v_dot2c_f32_bf16 v60, v222, v24
 v_dot2c_f32_bf16 v61, v222, v25
 v_dot2c_f32_bf16 v62, v223, v24
 v_dot2c_f32_bf16 v63, v223, v25
 s_branch L_ry27
L_rx28:
 v_dot2c_f32_bf16 v48, v224, v24
 v_dot2c_f32_bf16 v49, v224, v25
 v_dot2c_f32_bf16 v50, v225, v24
 v_dot2c_f32_bf16 v51, v225, v25
 v_dot2c_f32_bf16 v52, v226, v24
 v_dot2c_f32_bf16 v53, v226, v25
 v_dot2c_f32_bf16 v54, v227, v24
 v_dot2c_f32_bf16 v55, v227, v25
 v_dot2c_f32_bf16 v56, v228, v24
 v_dot2c_f32_bf16 v57, v228, v25
 v_dot2c_f32_bf16 v58, v229, v24
 v_dot2c_f32_bf16 v59, v229, v25
 v_dot2c_f32_bf16 v60, v230, v24
 v_dot2c_f32_bf16 v61, v230, v25
 v_dot2c_f32_bf16 v62, v231, v24
 v_dot2c_f32_bf16 v63, v231, v25
 s_branch L_ry28
L_rx29:
 v_dot2c_f32_bf16 v48, v232, v24
 v_dot2c_f32_bf16 v49, v232, v25
 v_dot2c_f32_bf16 v50, v233, v24
 v_dot2c_f32_bf16 v51, v233, v25
 v_dot2c_f32_bf16 v52, v234, v24
 v_dot2c_f32_bf16 v53, v234, v25
 v_dot2c_f32_bf16 v54, v235, v24
 v_dot2c_f32_bf16 v55, v235, v25
 v_dot2c_f32_bf16 v56, v236, v24
 v_dot2c_f32_bf16 v57, v236, v25
 v_dot2c_f32_bf16 v58, v237, v24
 v_dot2c_f32_bf16 v59, v237, v25
 v_dot2c_f32_bf16 v60, v238, v24
 v_dot2c_f32_bf16 v61, v238, v25
 v_dot2c_f32_bf16 v62, v239, v24
 v_dot2c_f32_bf16 v63, v239, v25
 s_branch L_ry29
L_rx30:
 v_dot2c_f32_bf16 v48, v240, v24
 v_dot2c_f32_bf16 v49, v240, v25
 v_dot2c_f32_bf16 v50, v241, v24
 v_dot2c_f32_bf16 v51, v241, v25
 v_dot2c_f32_bf16 v52, v242, v24
 v_dot2c_f32_bf16 v53, v242, v25
 v_dot2c_f32_bf16 v54, v243, v24
 v_dot2c_f32_bf16 v55, v243, v25
 v_dot2c_f32_bf16 v56, v244, v24
 v_dot2c_f32_bf16 v57, v244, v25
 v_dot2c_f32_bf16 v58, v245, v24
 v_dot2c_f32_bf16 v59, v245, v25
 v_dot2c_f32_bf16 v60, v246, v24
 v_dot2c_f32_bf16 v61, v246, v25
 v_dot2c_f32_bf16 v62, v247, v24
 v_dot2c_f32_bf16 v63, v247, v25
 s_branch L_ry30
L_rx31:
 v_dot2c_f32_bf16 v48, v248, v24
 v_dot2c_f32_bf16 v49, v248, v25
 v_dot2c_f32_bf16 v50, v249, v24
 v_dot2c_f32_bf16 v51, v249, v25
 v_dot2c_f32_bf16 v52, v250, v24
 v_dot2c_f32_bf16 v53, v250, v25
 v_dot2c_f32_bf16 v54, v251, v24
 v_dot2c_f32_bf16 v55, v251, v25
 v_dot2c_f32_bf16 v56, v252, v24
 v_dot2c_f32_bf16 v57, v252, v25
 v_dot2c_f32_bf16 v58, v253, v24
 v_dot2c_f32_bf16 v59, v253, v25
 v_dot2c_f32_bf16 v60, v254, v24
 v_dot2c_f32_bf16 v61, v254, v25
 v_dot2c_f32_bf16 v62, v255, v24
 v_dot2c_f32_bf16 v63, v255, v25
 s_branch L_ry31
L_rpoll0:
 s_sleep 1
L_rpoll:
 buffer_load_dword v9, v14, s[8:11], s46 offen sc1
 s_waitcnt vmcnt(0)
 v_cmp_eq_u32 vcc, 1, v9
 s_sub_u32 s91, s91, 1
 s_cselect_b32 s70, -1, 0
 s_or_b32 s70, s70, vcc_lo
 s_andn2_b32 s70, s70, s68
 s_cbranch_scc0 L_rpoll0
 s_or_b32 s68, s68, s70
 s_setpc_b64 s[36:37]
L_e:
 s_add_u32 m0, s28, 0
 v_exp_f32 v18, v80
 buffer_load_dwordx4 v3, s[8:11], s26 offen offset:0 sc1 lds
 v_exp_f32 v19, v81
 v_exp_f32 v20, v82
 v_add_f32 v26, v18, v26
 v_cvt_pk_bf16_f32 v56, v18, v19
 buffer_load_dwordx4 v3, s[8:11], s26 offen offset:1024 sc1 lds
 v_exp_f32 v21, v83
 v_add_f32 v26, v19, v26
 v_exp_f32 v22, v88
 v_add_f32 v26, v20, v26
 v_cvt_pk_bf16_f32 v57, v20, v21
 buffer_load_dwordx4 v3, s[8:11], s26 offen offset:2048 sc1 lds
 v_exp_f32 v23, v89
 v_add_f32 v26, v21, v26
 v_exp_f32 v24, v90
 v_add_f32 v26, v22, v26
 v_cvt_pk_bf16_f32 v58, v22, v23
 buffer_load_dwordx4 v3, s[8:11], s26 offen offset:3072 sc1 lds
 v_exp_f32 v25, v91
 v_add_f32 v26, v23, v26
 v_exp_f32 v18, v84
 v_add_f32 v26, v24, v26
 s_add_u32 m0, s28, 4096
 v_cvt_pk_bf16_f32 v59, v24, v25
 buffer_load_dwordx4 v4, s[8:11], s26 offen offset:0 sc1 lds
 v_exp_f32 v19, v85
 v_add_f32 v26, v25, v26
 v_exp_f32 v20, v86
 v_add_f32 v27, v18, v27
 v_cvt_pk_bf16_f32 v60, v18, v19
 buffer_load_dwordx4 v4, s[8:11], s26 offen offset:1024 sc1 lds
 v_exp_f32 v21, v87
 v_add_f32 v27, v19, v27
 v_exp_f32 v22, v92
 v_add_f32 v27, v20, v27
 v_cvt_pk_bf16_f32 v61, v20, v21
 buffer_load_dwordx4 v4, s[8:11], s26 offen offset:2048 sc1 lds
 v_exp_f32 v23, v93
 v_add_f32 v27, v21, v27
 v_exp_f32 v24, v94
 v_add_f32 v27, v22, v27
 v_cvt_pk_bf16_f32 v62, v22, v23
 buffer_load_dwordx4 v4, s[8:11], s26 offen offset:3072 sc1 lds
 v_exp_f32 v25, v95
 v_add_f32 v27, v23, v27
 v_add_f32 v27, v24, v27
 v_cvt_pk_bf16_f32 v63, v24, v25
 v_add_f32 v27, v25, v27
 v_max_f32 v10, v26, v27
 v_cmp_lt_f32 vcc, s31, v10
 s_nop 0
 s_cbranch_vccnz L_st7
L_rt7:
 v_add_f32 v30, v26, v30
 v_add_f32 v31, v27, v31
 s_cmp_eq_u32 s42, 6
 s_cbranch_scc1 L_yred
L_yred_ret:
 s_cmp_lt_u32 s42, 10
 s_cbranch_scc1 L_e2
 buffer_load_dwordx4 a[160:163], v7, s[8:11], s88 offen offset:0 sc1
 buffer_load_dwordx4 a[164:167], v7, s[8:11], s88 offen offset:1024 sc1
 buffer_load_dwordx4 a[168:171], v7, s[8:11], s88 offen offset:2048 sc1
 buffer_load_dwordx4 a[172:175], v7, s[8:11], s88 offen offset:3072 sc1
 buffer_load_dwordx4 a[176:179], v7, s[8:11], s89 offen offset:0 sc1
 buffer_load_dwordx4 a[180:183], v7, s[8:11], s89 offen offset:1024 sc1
 buffer_load_dwordx4 a[184:187], v7, s[8:11], s89 offen offset:2048 sc1
 buffer_load_dwordx4 a[188:191], v7, s[8:11], s89 offen offset:3072 sc1
 buffer_load_dwordx4 v[14:17], v7, s[8:11], s90 offen sc1
L_e2:
 s_waitcnt vmcnt(16)
 s_barrier
 ds_read_b128 a[64:67], v2 offset:0
 ds_read_b128 a[68:71], v2 offset:1024
 ds_read_b128 a[72:75], v2 offset:2048
 ds_read_b128 a[76:79], v2 offset:3072
 ds_read_b128 a[80:83], v2 offset:4096
 ds_read_b128 a[84:87], v2 offset:5120
 ds_read_b128 a[88:91], v2 offset:6144
 ds_read_b128 a[92:95], v2 offset:7168
 s_waitcnt lgkmcnt(0)
M v[128:131], a[64:67], v[40:43], v[128:131]
 s_add_u32 m0, s28, 32768
 ds_read_b128 a[96:99], v2 offset:8192
 ds_read_b128 a[100:103], v2 offset:9216
M v[128:131], a[68:71], v[56:59], v[128:131]
 buffer_load_dwordx4 v3, s[8:11], s21 offen offset:0 sc1 lds
M v[132:135], a[68:71], v[60:63], v[132:135]
M v[132:135], a[64:67], v[44:47], v[132:135]
 ds_read_b128 a[104:107], v2 offset:10240
 ds_read_b128 a[108:111], v2 offset:11264
M v[136:139], a[72:75], v[40:43], v[136:139]
M v[136:139], a[76:79], v[56:59], v[136:139]
 buffer_load_dwordx4 v3, s[8:11], s21 offen offset:1024 sc1 lds
M v[140:143], a[76:79], v[60:63], v[140:143]
 ds_read_b128 a[112:115], v2 offset:12288
 ds_read_b128 a[116:119], v2 offset:13312
M v[140:143], a[72:75], v[44:47], v[140:143]
M v[144:147], a[80:83], v[40:43], v[144:147]
M v[144:147], a[84:87], v[56:59], v[144:147]
 ds_read_b128 a[120:123], v2 offset:14336
 ds_read_b128 a[124:127], v2 offset:15360
M v[148:151], a[84:87], v[60:63], v[148:151]
 buffer_load_dwordx4 v3, s[8:11], s21 offen offset:2048 sc1 lds
M v[148:151], a[80:83], v[44:47], v[148:151]
M v[152:155], a[88:91], v[40:43], v[152:155]
M v[152:155], a[92:95], v[56:59], v[152:155]
M v[156:159], a[92:95], v[60:63], v[156:159]
 buffer_load_dwordx4 v3, s[8:11], s21 offen offset:3072 sc1 lds
M v[156:159], a[88:91], v[44:47], v[156:159]
 s_waitcnt lgkmcnt(0)
M v[160:163], a[96:99], v[40:43], v[160:163]
 ds_read_b128 a[64:67], v2 offset:16384
 ds_read_b128 a[68:71], v2 offset:17408
M v[160:163], a[100:103], v[56:59], v[160:163]
M v[164:167], a[100:103], v[60:63], v[164:167]
 s_add_u32 m0, s28, 36864
M v[164:167], a[96:99], v[44:47], v[164:167]
 ds_read_b128 a[72:75], v2 offset:18432
 ds_read_b128 a[76:79], v2 offset:19456
M v[168:171], a[104:107], v[40:43], v[168:171]
 buffer_load_dwordx4 v4, s[8:11], s21 offen offset:0 sc1 lds
M v[168:171], a[108:111], v[56:59], v[168:171]
M v[172:175], a[108:111], v[60:63], v[172:175]
 ds_read_b128 a[80:83], v2 offset:20480
 ds_read_b128 a[84:87], v2 offset:21504
M v[172:175], a[104:107], v[44:47], v[172:175]
M v[176:179], a[112:115], v[40:43], v[176:179]
 buffer_load_dwordx4 v4, s[8:11], s21 offen offset:1024 sc1 lds
M v[176:179], a[116:119], v[56:59], v[176:179]
 ds_read_b128 a[88:91], v2 offset:22528
 ds_read_b128 a[92:95], v2 offset:23552
M v[180:183], a[116:119], v[60:63], v[180:183]
 buffer_load_dword v6, v9, s[8:11], s46 offen sc1
M v[180:183], a[112:115], v[44:47], v[180:183]
M v[184:187], a[120:123], v[40:43], v[184:187]
 buffer_load_dwordx4 v4, s[8:11], s21 offen offset:2048 sc1 lds
M v[184:187], a[124:127], v[56:59], v[184:187]
M v[188:191], a[124:127], v[60:63], v[188:191]
M v[188:191], a[120:123], v[44:47], v[188:191]
 s_waitcnt lgkmcnt(0)
M v[192:195], a[64:67], v[40:43], v[192:195]
 ds_read_b128 a[96:99], v2 offset:24576
 ds_read_b128 a[100:103], v2 offset:25600
M v[192:195], a[68:71], v[56:59], v[192:195]
 buffer_load_dwordx4 v4, s[8:11], s21 offen offset:3072 sc1 lds
M v[196:199], a[68:71], v[60:63], v[196:199]
 s_add_u32 s21, s21, 32768
M v[196:199], a[64:67], v[44:47], v[196:199]
 s_sub_u32 s22, s22, 1
 ds_read_b128 a[104:107], v2 offset:26624
 ds_read_b128 a[108:111], v2 offset:27648
M v[200:203], a[72:75], v[40:43], v[200:203]
 s_cmp_eq_u32 s22, 0
M v[200:203], a[76:79], v[56:59], v[200:203]
 s_cselect_b32 s21, s23, s21
M v[204:207], a[76:79], v[60:63], v[204:207]
 s_cselect_b32 s22, s24, s22
 ds_read_b128 a[112:115], v2 offset:28672
 ds_read_b128 a[116:119], v2 offset:29696
M v[204:207], a[72:75], v[44:47], v[204:207]
 s_cselect_b32 s23, s25, s23
M v[208:211], a[80:83], v[40:43], v[208:211]
 s_cselect_b32 s24, 0x7fff, s24
M v[208:211], a[84:87], v[56:59], v[208:211]
 ds_read_b128 a[120:123], v2 offset:30720
 ds_read_b128 a[124:127], v2 offset:31744
M v[212:215], a[84:87], v[60:63], v[212:215]
M v[212:215], a[80:83], v[44:47], v[212:215]
M v[216:219], a[88:91], v[40:43], v[216:219]
M v[216:219], a[92:95], v[56:59], v[216:219]
M v[220:223], a[92:95], v[60:63], v[220:223]
 s_waitcnt vmcnt(17) lgkmcnt(0)
M v[220:223], a[88:91], v[44:47], v[220:223]
 s_barrier
M v[224:227], a[96:99], v[40:43], v[224:227]
M v[224:227], a[100:103], v[56:59], v[224:227]
M v[228:231], a[100:103], v[60:63], v[228:231]
M v[228:231], a[96:99], v[44:47], v[228:231]
M v[232:235], a[104:107], v[40:43], v[232:235]
M v[232:235], a[108:111], v[56:59], v[232:235]
M v[236:239], a[108:111], v[60:63], v[236:239]
M v[236:239], a[104:107], v[44:47], v[236:239]
M v[240:243], a[112:115], v[40:43], v[240:243]
M v[240:243], a[116:119], v[56:59], v[240:243]
M v[244:247], a[116:119], v[60:63], v[244:247]
M v[244:247], a[112:115], v[44:47], v[244:247]
M v[248:251], a[120:123], v[40:43], v[248:251]
M v[248:251], a[124:127], v[56:59], v[248:251]
M v[252:255], a[124:127], v[60:63], v[252:255]
M v[252:255], a[120:123], v[44:47], v[252:255]
 s_waitcnt vmcnt(9)
 s_barrier
 s_cmp_le_u32 s42, 5
 s_cbranch_scc1 L_e_k
 s_cmp_lt_u32 s42, 10
 s_cbranch_scc1 L_e_o
 s_waitcnt vmcnt(9)
 v_cmp_neq_f32 vcc, v32, v14
 v_cmp_neq_f32 s[64:65], v36, v15
 s_nop 0
 s_or_b64 vcc, vcc, s[64:65]
 s_cbranch_vccnz L_cg1
 v_add_f32 v30, v16, v30
 v_add_f32 v31, v17, v31
M v[128:131], a[226:229], a[128:131], v[128:131]
M v[136:139], a[224:227], a[128:131], v[136:139]
M v[144:147], a[226:229], a[132:135], v[144:147]
M v[152:155], a[224:227], a[132:135], v[152:155]
M v[160:163], a[226:229], a[136:139], v[160:163]
M v[168:171], a[224:227], a[136:139], v[168:171]
M v[176:179], a[226:229], a[140:143], v[176:179]
M v[184:187], a[224:227], a[140:143], v[184:187]
M v[192:195], a[226:229], a[144:147], v[192:195]
M v[200:203], a[224:227], a[144:147], v[200:203]
M v[208:211], a[226:229], a[148:151], v[208:211]
M v[216:219], a[224:227], a[148:151], v[216:219]
M v[224:227], a[226:229], a[152:155], v[224:227]
M v[232:235], a[224:227], a[152:155], v[232:235]
M v[240:243], a[226:229], a[156:159], v[240:243]
M v[248:251], a[224:227], a[156:159], v[248:251]
M v[132:135], a[226:229], a[160:163], v[132:135]
M v[140:143], a[224:227], a[160:163], v[140:143]
M v[148:151], a[226:229], a[164:167], v[148:151]
M v[156:159], a[224:227], a[164:167], v[156:159]
M v[164:167], a[226:229], a[168:171], v[164:167]
M v[172:175], a[224:227], a[168:171], v[172:175]
M v[180:183], a[226:229], a[172:175], v[180:183]
M v[188:191], a[224:227], a[172:175], v[188:191]
M v[196:199], a[226:229], a[176:179], v[196:199]
M v[204:207], a[224:227], a[176:179], v[204:207]
M v[212:215], a[226:229], a[180:183], v[212:215]
M v[220:223], a[224:227], a[180:183], v[220:223]
M v[228:231], a[226:229], a[184:187], v[228:231]
M v[236:239], a[224:227], a[184:187], v[236:239]
M v[244:247], a[226:229], a[188:191], v[244:247]
M v[252:255], a[224:227], a[188:191], v[252:255]
L_e_o:
 s_cmp_eq_u32 s42, 6
 s_cbranch_scc1 L_yred2
L_yred2_ret:
 s_add_u32 m0, s28, 65536
 v_cvt_pk_bf16_f32 v128, v128, v129
 buffer_load_dwordx4 v3, s[8:11], s38 offen offset:0 sc1 lds
 v_cvt_pk_bf16_f32 v129, v130, v131
 v_cvt_pk_bf16_f32 v130, v136, v137
 v_cvt_pk_bf16_f32 v131, v138, v139
 v_cvt_pk_bf16_f32 v144, v144, v145
 v_cvt_pk_bf16_f32 v145, v146, v147
 v_cvt_pk_bf16_f32 v146, v152, v153
 v_cvt_pk_bf16_f32 v147, v154, v155
 buffer_load_dwordx4 v3, s[8:11], s38 offen offset:1024 sc1 lds
 v_cvt_pk_bf16_f32 v160, v160, v161
 v_cvt_pk_bf16_f32 v161, v162, v163
 v_cvt_pk_bf16_f32 v162, v168, v169
 v_cvt_pk_bf16_f32 v163, v170, v171
 v_cvt_pk_bf16_f32 v176, v176, v177
 v_cvt_pk_bf16_f32 v177, v178, v179
 v_cvt_pk_bf16_f32 v178, v184, v185
 v_cvt_pk_bf16_f32 v179, v186, v187
 buffer_load_dwordx4 v3, s[8:11], s38 offen offset:2048 sc1 lds
 v_cvt_pk_bf16_f32 v192, v192, v193
 v_cvt_pk_bf16_f32 v193, v194, v195
 v_cvt_pk_bf16_f32 v194, v200, v201
 v_cvt_pk_bf16_f32 v195, v202, v203
 v_cvt_pk_bf16_f32 v208, v208, v209
 v_cvt_pk_bf16_f32 v209, v210, v211
 v_cvt_pk_bf16_f32 v210, v216, v217
 v_cvt_pk_bf16_f32 v211, v218, v219
 buffer_load_dwordx4 v3, s[8:11], s38 offen offset:3072 sc1 lds
 v_cvt_pk_bf16_f32 v224, v224, v225
 v_cvt_pk_bf16_f32 v225, v226, v227
 v_cvt_pk_bf16_f32 v226, v232, v233
 v_cvt_pk_bf16_f32 v227, v234, v235
 v_cvt_pk_bf16_f32 v240, v240, v241
 v_cvt_pk_bf16_f32 v241, v242, v243
 v_cvt_pk_bf16_f32 v242, v248, v249
 s_add_u32 m0, s28, 69632
 v_cvt_pk_bf16_f32 v243, v250, v251
 buffer_load_dwordx4 v4, s[8:11], s38 offen offset:0 sc1 lds
 v_cvt_pk_bf16_f32 v132, v132, v133
 v_cvt_pk_bf16_f32 v133, v134, v135
 v_cvt_pk_bf16_f32 v134, v140, v141
 v_cvt_pk_bf16_f32 v135, v142, v143
 v_cvt_pk_bf16_f32 v148, v148, v149
 v_cvt_pk_bf16_f32 v149, v150, v151
 v_cvt_pk_bf16_f32 v150, v156, v157
 v_cvt_pk_bf16_f32 v151, v158, v159
 buffer_load_dwordx4 v4, s[8:11], s38 offen offset:1024 sc1 lds
 v_cvt_pk_bf16_f32 v164, v164, v165
 v_cvt_pk_bf16_f32 v165, v166, v167
 v_cvt_pk_bf16_f32 v166, v172, v173
 v_cvt_pk_bf16_f32 v167, v174, v175
 v_cvt_pk_bf16_f32 v180, v180, v181
 v_cvt_pk_bf16_f32 v181, v182, v183
 v_cvt_pk_bf16_f32 v182, v188, v189
 v_cvt_pk_bf16_f32 v183, v190, v191
 buffer_load_dwordx4 v4, s[8:11], s38 offen offset:2048 sc1 lds
 v_cvt_pk_bf16_f32 v196, v196, v197
 v_cvt_pk_bf16_f32 v197, v198, v199
 v_cvt_pk_bf16_f32 v198, v204, v205
 v_cvt_pk_bf16_f32 v199, v206, v207
 v_cvt_pk_bf16_f32 v212, v212, v213
 v_cvt_pk_bf16_f32 v213, v214, v215
 v_cvt_pk_bf16_f32 v214, v220, v221
 v_cvt_pk_bf16_f32 v215, v222, v223
 buffer_load_dwordx4 v4, s[8:11], s38 offen offset:3072 sc1 lds
 s_add_u32 s38, s38, 32768
 v_cvt_pk_bf16_f32 v228, v228, v229
 v_cvt_pk_bf16_f32 v229, v230, v231
 v_cvt_pk_bf16_f32 v230, v236, v237
 v_cvt_pk_bf16_f32 v231, v238, v239
 v_cvt_pk_bf16_f32 v244, v244, v245
 v_cvt_pk_bf16_f32 v245, v246, v247
 v_cvt_pk_bf16_f32 v246, v252, v253
 v_cvt_pk_bf16_f32 v247, v254, v255
 v_mov_b32 v10, v30
 s_nop 1
 v_permlane16_swap_b32 v10, v30
 v_add_f32 v30, v10, v30
 v_mov_b32 v10, v30
 s_nop 1
 v_permlane32_swap_b32 v10, v30
 v_add_f32 v30, v10, v30
 v_mov_b32 v11, v31
 s_nop 1
 v_permlane16_swap_b32 v11, v31
 v_add_f32 v31, v11, v31
 v_mov_b32 v11, v31
 s_nop 1
 v_permlane32_swap_b32 v11, v31
 v_add_f32 v31, v11, v31
 v_rcp_f32 v5, v30
 s_waitcnt vmcnt(10)
 v_rcp_f32 v6, v31
 s_barrier
 ds_read_b128 a[64:67], v2 offset:32768
 ds_read_b128 a[68:71], v2 offset:33792
 ds_read_b128 a[72:75], v2 offset:34816
 ds_read_b128 a[76:79], v2 offset:35840
 ds_read_b128 a[80:83], v2 offset:36864
 ds_read_b128 a[84:87], v2 offset:37888
 ds_read_b128 a[88:91], v2 offset:38912
 ds_read_b128 a[92:95], v2 offset:39936
 s_waitcnt lgkmcnt(0)
 s_branch L_op1
L_e_k:
 s_waitcnt vmcnt(2)
 v_cmp_gt_u32 vcc, 3, v6
 s_sub_u32 s27, 6, s42
 s_cbranch_vccnz L_f3s1
L_f3r1:
 s_mul_i32 s21, s41, 1048576
 s_add_u32 s21, s21, 589824
 s_add_u32 s26, s21, 16777216
 s_lshl_b32 s22, s27, 1
 s_add_u32 s22, s22, 0
 s_mov_b32 s23, s25
 s_mov_b32 s40, 0
 s_max_u32 s7, s7, 3
 s_mov_b32 s72, s32
 s_add_u32 s73, s72, 4096
 s_add_u32 s74, s72, 8192
 s_add_u32 s75, s72, 12288
 s_add_u32 m0, s28, 98304
 v_cvt_pk_bf16_f32 v128, v128, v129
 buffer_load_dwordx4 v3, s[8:11], s21 offen offset:0 sc1 lds
 v_cvt_pk_bf16_f32 v129, v130, v131
 buffer_load_dwordx4 v3, s[8:11], s21 offen offset:1024 sc1 lds
 v_cvt_pk_bf16_f32 v130, v136, v137
 v_cvt_pk_bf16_f32 v131, v138, v139
 buffer_load_dwordx4 v3, s[8:11], s21 offen offset:2048 sc1 lds
 v_cvt_pk_bf16_f32 v144, v144, v145
 v_cvt_pk_bf16_f32 v145, v146, v147
 buffer_load_dwordx4 v3, s[8:11], s21 offen offset:3072 sc1 lds
 v_cvt_pk_bf16_f32 v146, v152, v153
 s_add_u32 m0, s28, 102400
 v_cvt_pk_bf16_f32 v147, v154, v155
 buffer_load_dwordx4 v4, s[8:11], s21 offen offset:0 sc1 lds
 v_cvt_pk_bf16_f32 v160, v160, v161
 v_cvt_pk_bf16_f32 v161, v162, v163
 buffer_load_dwordx4 v4, s[8:11], s21 offen offset:1024 sc1 lds
 v_cvt_pk_bf16_f32 v162, v168, v169
 v_cvt_pk_bf16_f32 v163, v170, v171
 buffer_load_dwordx4 v4, s[8:11], s21 offen offset:2048 sc1 lds
 v_cvt_pk_bf16_f32 v176, v176, v177
 v_cvt_pk_bf16_f32 v177, v178, v179
 buffer_load_dwordx4 v4, s[8:11], s21 offen offset:3072 sc1 lds
 v_cvt_pk_bf16_f32 v178, v184, v185
 s_add_u32 s21, s21, 32768
 s_sub_u32 s22, s22, 1
 s_cmp_eq_u32 s22, 0
 s_cselect_b32 s21, s23, s21
 s_cselect_b32 s22, s24, s22
 s_cselect_b32 s23, s25, s23
 s_cselect_b32 s24, 0x7fff, s24
 s_add_u32 s76, s90, 4096
 v_cvt_pk_bf16_f32 v179, v186, v187
 buffer_load_dwordx4 v[14:17], v7, s[8:11], s76 offen sc1
 v_cvt_pk_bf16_f32 v192, v192, v193
 v_cvt_pk_bf16_f32 v193, v194, v195
 buffer_load_dwordx4 a[0:3], v7, s[8:11], s72 offen offset:0 sc1
 v_cvt_pk_bf16_f32 v194, v200, v201
 v_cvt_pk_bf16_f32 v195, v202, v203
 buffer_load_dwordx4 a[4:7], v7, s[8:11], s72 offen offset:1024 sc1
 v_cvt_pk_bf16_f32 v208, v208, v209
 v_cvt_pk_bf16_f32 v209, v210, v211
 buffer_load_dwordx4 a[8:11], v7, s[8:11], s72 offen offset:2048 sc1
 v_cvt_pk_bf16_f32 v210, v216, v217
 buffer_load_dwordx4 a[12:15], v7, s[8:11], s72 offen offset:3072 sc1
 v_cvt_pk_bf16_f32 v211, v218, v219
 v_cvt_pk_bf16_f32 v224, v224, v225
 buffer_load_dwordx4 a[16:19], v7, s[8:11], s73 offen offset:0 sc1
 v_cvt_pk_bf16_f32 v225, v226, v227
 v_cvt_pk_bf16_f32 v226, v232, v233
 buffer_load_dwordx4 a[20:23], v7, s[8:11], s73 offen offset:1024 sc1
 v_cvt_pk_bf16_f32 v227, v234, v235
 v_cvt_pk_bf16_f32 v240, v240, v241
 buffer_load_dwordx4 a[24:27], v7, s[8:11], s73 offen offset:2048 sc1
 v_cvt_pk_bf16_f32 v241, v242, v243
 v_cvt_pk_bf16_f32 v242, v248, v249
 buffer_load_dwordx4 a[28:31], v7, s[8:11], s73 offen offset:3072 sc1
 v_cvt_pk_bf16_f32 v243, v250, v251
 v_cvt_pk_bf16_f32 v132, v132, v133
 buffer_load_dwordx4 a[32:35], v7, s[8:11], s74 offen offset:0 sc1
 v_cvt_pk_bf16_f32 v133, v134, v135
 v_cvt_pk_bf16_f32 v134, v140, v141
 buffer_load_dwordx4 a[36:39], v7, s[8:11], s74 offen offset:1024 sc1
 v_cvt_pk_bf16_f32 v135, v142, v143
 v_cvt_pk_bf16_f32 v148, v148, v149
 buffer_load_dwordx4 a[40:43], v7, s[8:11], s74 offen offset:2048 sc1
 v_cvt_pk_bf16_f32 v149, v150, v151
 v_cvt_pk_bf16_f32 v150, v156, v157
 buffer_load_dwordx4 a[44:47], v7, s[8:11], s74 offen offset:3072 sc1
 v_cvt_pk_bf16_f32 v151, v158, v159
 v_cvt_pk_bf16_f32 v164, v164, v165
 buffer_load_dwordx4 a[48:51], v7, s[8:11], s75 offen offset:0 sc1
 v_cvt_pk_bf16_f32 v165, v166, v167
 v_cvt_pk_bf16_f32 v166, v172, v173
 buffer_load_dwordx4 a[52:55], v7, s[8:11], s75 offen offset:1024 sc1
 v_cvt_pk_bf16_f32 v167, v174, v175
 buffer_load_dwordx4 a[56:59], v7, s[8:11], s75 offen offset:2048 sc1
 v_cvt_pk_bf16_f32 v180, v180, v181
 v_cvt_pk_bf16_f32 v181, v182, v183
 buffer_load_dwordx4 a[60:63], v7, s[8:11], s75 offen offset:3072 sc1
 v_cvt_pk_bf16_f32 v182, v188, v189
 s_add_u32 m0, s28, 32768
 v_cvt_pk_bf16_f32 v183, v190, v191
 buffer_load_dwordx4 v3, s[8:11], s21 offen offset:0 sc1 lds
 v_cvt_pk_bf16_f32 v196, v196, v197
 v_cvt_pk_bf16_f32 v197, v198, v199
 buffer_load_dwordx4 v3, s[8:11], s21 offen offset:1024 sc1 lds
 v_cvt_pk_bf16_f32 v198, v204, v205
 v_cvt_pk_bf16_f32 v199, v206, v207
 buffer_load_dwordx4 v3, s[8:11], s21 offen offset:2048 sc1 lds
 v_cvt_pk_bf16_f32 v212, v212, v213
 v_cvt_pk_bf16_f32 v213, v214, v215
 buffer_load_dwordx4 v3, s[8:11], s21 offen offset:3072 sc1 lds
 v_cvt_pk_bf16_f32 v214, v220, v221
 s_add_u32 m0, s28, 36864
 v_cvt_pk_bf16_f32 v215, v222, v223
 buffer_load_dwordx4 v4, s[8:11], s21 offen offset:0 sc1 lds
 v_cvt_pk_bf16_f32 v228, v228, v229
 v_cvt_pk_bf16_f32 v229, v230, v231
 buffer_load_dwordx4 v4, s[8:11], s21 offen offset:1024 sc1 lds
 v_cvt_pk_bf16_f32 v230, v236, v237
 v_cvt_pk_bf16_f32 v231, v238, v239
 buffer_load_dwordx4 v4, s[8:11], s21 offen offset:2048 sc1 lds
 v_cvt_pk_bf16_f32 v244, v244, v245
 v_cvt_pk_bf16_f32 v245, v246, v247
 buffer_load_dwordx4 v4, s[8:11], s21 offen offset:3072 sc1 lds
 s_add_u32 s21, s21, 32768
 s_sub_u32 s22, s22, 1
 s_cmp_eq_u32 s22, 0
 s_cselect_b32 s21, s23, s21
 s_cselect_b32 s22, s24, s22
 s_cselect_b32 s23, s25, s23
 s_cselect_b32 s24, 0x7fff, s24
 v_cvt_pk_bf16_f32 v246, v252, v253
 v_cvt_pk_bf16_f32 v247, v254, v255
 v_mov_b32 v10, v30
 s_nop 1
 v_permlane16_swap_b32 v10, v30
 v_add_f32 v30, v10, v30
 v_mov_b32 v10, v30
 s_nop 1
 v_permlane32_swap_b32 v10, v30
 v_add_f32 v30, v10, v30
 v_mov_b32 v11, v31
 s_nop 1
 v_permlane16_swap_b32 v11, v31
 v_add_f32 v31, v11, v31
 v_mov_b32 v11, v31
 s_nop 1
 v_permlane32_swap_b32 v11, v31
 v_add_f32 v31, v11, v31
 v_rcp_f32 v5, v30
 v_rcp_f32 v6, v31
 s_waitcnt vmcnt(25)
 s_barrier
 ds_read_b128 a[64:67], v2 offset:32768
 ds_read_b128 a[68:71], v2 offset:33792
 ds_read_b128 a[72:75], v2 offset:34816
 ds_read_b128 a[76:79], v2 offset:35840
 ds_read_b128 a[80:83], v2 offset:36864
 ds_read_b128 a[84:87], v2 offset:37888
 ds_read_b128 a[88:91], v2 offset:38912
 ds_read_b128 a[92:95], v2 offset:39936
 s_waitcnt lgkmcnt(0)
 s_branch L_w0h
L_comb:
 v_sub_f32 v10, v32, v14
 v_sub_f32 v11, v36, v15
 v_max_f32 v10, 0, v10
 v_max_f32 v11, 0, v11
 v_sub_f32 v96, v96, v10
 v_sub_f32 v97, v97, v10
 v_sub_f32 v98, v98, v10
 v_sub_f32 v99, v99, v10
 v_sub_f32 v100, v100, v11
 v_sub_f32 v101, v101, v11
 v_sub_f32 v102, v102, v11
 v_sub_f32 v103, v103, v11
 v_sub_f32 v104, v104, v10
 v_sub_f32 v105, v105, v10
 v_sub_f32 v106, v106, v10
 v_sub_f32 v107, v107, v10
 v_sub_f32 v108, v108, v11
 v_sub_f32 v109, v109, v11
 v_sub_f32 v110, v110, v11
 v_sub_f32 v111, v111, v11
 v_sub_f32 v112, v112, v10
 v_sub_f32 v113, v113, v10
 v_sub_f32 v114, v114, v10
 v_sub_f32 v115, v115, v10
 v_sub_f32 v116, v116, v11
 v_sub_f32 v117, v117, v11
 v_sub_f32 v118, v118, v11
 v_sub_f32 v119, v119, v11
 v_sub_f32 v120, v120, v10
 v_sub_f32 v121, v121, v10
 v_sub_f32 v122, v122, v10
 v_sub_f32 v123, v123, v10
 v_sub_f32 v124, v124, v11
 v_sub_f32 v125, v125, v11
 v_sub_f32 v126, v126, v11
 v_sub_f32 v127, v127, v11
 v_sub_f32 v32, v32, v10
 v_sub_f32 v33, v33, v10
 v_sub_f32 v34, v34, v10
 v_sub_f32 v35, v35, v10
 v_sub_f32 v36, v36, v11
 v_sub_f32 v37, v37, v11
 v_sub_f32 v38, v38, v11
 v_sub_f32 v39, v39, v11
 v_exp_f32 v12, -v10
 v_exp_f32 v13, -v11
 v_mul_f32 v30, v12, v30
 v_mul_f32 v31, v13, v31
 v_mul_f32 v128, v12, v128
 v_mul_f32 v129, v12, v129
 v_mul_f32 v130, v12, v130
 v_mul_f32 v131, v12, v131
 v_mul_f32 v132, v13, v132
 v_mul_f32 v133, v13, v133
 v_mul_f32 v134, v13, v134
 v_mul_f32 v135, v13, v135
 v_mul_f32 v136, v12, v136
 v_mul_f32 v137, v12, v137
 v_mul_f32 v138, v12, v138
 v_mul_f32 v139, v12, v139
 v_mul_f32 v140, v13, v140
 v_mul_f32 v141, v13, v141
 v_mul_f32 v142, v13, v142
 v_mul_f32 v143, v13, v143
 v_mul_f32 v144, v12, v144
 v_mul_f32 v145, v12, v145
 v_mul_f32 v146, v12, v146
 v_mul_f32 v147, v12, v147
 v_mul_f32 v148, v13, v148
 v_mul_f32 v149, v13, v149
 v_mul_f32 v150, v13, v150
 v_mul_f32 v151, v13, v151
 v_mul_f32 v152, v12, v152
 v_mul_f32 v153, v12, v153
 v_mul_f32 v154, v12, v154
 v_mul_f32 v155, v12, v155
 v_mul_f32 v156, v13, v156
 v_mul_f32 v157, v13, v157
 v_mul_f32 v158, v13, v158
 v_mul_f32 v159, v13, v159
 v_mul_f32 v160, v12, v160
 v_mul_f32 v161, v12, v161
 v_mul_f32 v162, v12, v162
 v_mul_f32 v163, v12, v163
 v_mul_f32 v164, v13, v164
 v_mul_f32 v165, v13, v165
 v_mul_f32 v166, v13, v166
 v_mul_f32 v167, v13, v167
 v_mul_f32 v168, v12, v168
 v_mul_f32 v169, v12, v169
 v_mul_f32 v170, v12, v170
 v_mul_f32 v171, v12, v171
 v_mul_f32 v172, v13, v172
 v_mul_f32 v173, v13, v173
 v_mul_f32 v174, v13, v174
 v_mul_f32 v175, v13, v175
 v_mul_f32 v176, v12, v176
 v_mul_f32 v177, v12, v177
 v_mul_f32 v178, v12, v178
 v_mul_f32 v179, v12, v179
 v_mul_f32 v180, v13, v180
 v_mul_f32 v181, v13, v181
 v_mul_f32 v182, v13, v182
 v_mul_f32 v183, v13, v183
 v_mul_f32 v184, v12, v184
 v_mul_f32 v185, v12, v185
 v_mul_f32 v186, v12, v186
 v_mul_f32 v187, v12, v187
 v_mul_f32 v188, v13, v188
 v_mul_f32 v189, v13, v189
 v_mul_f32 v190, v13, v190
 v_mul_f32 v191, v13, v191
 v_mul_f32 v192, v12, v192
 v_mul_f32 v193, v12, v193
 v_mul_f32 v194, v12, v194
 v_mul_f32 v195, v12, v195
 v_mul_f32 v196, v13, v196
 v_mul_f32 v197, v13, v197
 v_mul_f32 v198, v13, v198
 v_mul_f32 v199, v13, v199
 v_mul_f32 v200, v12, v200
 v_mul_f32 v201, v12, v201
 v_mul_f32 v202, v12, v202
 v_mul_f32 v203, v12, v203
 v_mul_f32 v204, v13, v204
 v_mul_f32 v205, v13, v205
 v_mul_f32 v206, v13, v206
 v_mul_f32 v207, v13, v207
 v_mul_f32 v208, v12, v208
 v_mul_f32 v209, v12, v209
 v_mul_f32 v210, v12, v210
 v_mul_f32 v211, v12, v211
 v_mul_f32 v212, v13, v212
 v_mul_f32 v213, v13, v213
 v_mul_f32 v214, v13, v214
 v_mul_f32 v215, v13, v215
 v_mul_f32 v216, v12, v216
 v_mul_f32 v217, v12, v217
 v_mul_f32 v218, v12, v218
 v_mul_f32 v219, v12, v219
 v_mul_f32 v220, v13, v220
 v_mul_f32 v221, v13, v221
 v_mul_f32 v222, v13, v222
 v_mul_f32 v223, v13, v223
 v_mul_f32 v224, v12, v224
 v_mul_f32 v225, v12, v225
 v_mul_f32 v226, v12, v226
 v_mul_f32 v227, v12, v227
 v_mul_f32 v228, v13, v228
 v_mul_f32 v229, v13, v229
 v_mul_f32 v230, v13, v230
 v_mul_f32 v231, v13, v231
 v_mul_f32 v232, v12, v232
 v_mul_f32 v233, v12, v233
 v_mul_f32 v234, v12, v234
 v_mul_f32 v235, v12, v235
 v_mul_f32 v236, v13, v236
 v_mul_f32 v237, v13, v237
 v_mul_f32 v238, v13, v238
 v_mul_f32 v239, v13, v239
 v_mul_f32 v240, v12, v240
 v_mul_f32 v241, v12, v241
 v_mul_f32 v242, v12, v242
 v_mul_f32 v243, v12, v243
 v_mul_f32 v244, v13, v244
 v_mul_f32 v245, v13, v245
 v_mul_f32 v246, v13, v246
 v_mul_f32 v247, v13, v247
 v_mul_f32 v248, v12, v248
 v_mul_f32 v249, v12, v249
 v_mul_f32 v250, v12, v250
 v_mul_f32 v251, v12, v251
 v_mul_f32 v252, v13, v252
 v_mul_f32 v253, v13, v253
 v_mul_f32 v254, v13, v254
 v_mul_f32 v255, v13, v255
 v_exp_f32 v18, v96
 v_exp_f32 v19, v97
 v_exp_f32 v20, v98
 v_add_f32 v28, v18, v19
 v_cvt_pk_bf16_f32 v48, v18, v19
 v_exp_f32 v21, v99
 v_exp_f32 v22, v104
 v_add_f32 v28, v20, v28
 v_cvt_pk_bf16_f32 v49, v20, v21
 v_exp_f32 v23, v105
 v_add_f32 v28, v21, v28
 v_exp_f32 v24, v106
 v_add_f32 v28, v22, v28
 v_cvt_pk_bf16_f32 v50, v22, v23
 v_exp_f32 v25, v107
 v_add_f32 v28, v23, v28
 v_exp_f32 v18, v100
 v_add_f32 v28, v24, v28
 v_cvt_pk_bf16_f32 v51, v24, v25
 v_exp_f32 v19, v101
 v_add_f32 v28, v25, v28
 v_exp_f32 v20, v102
 v_add_f32 v29, v18, v19
 v_cvt_pk_bf16_f32 v52, v18, v19
 v_exp_f32 v21, v103
 v_exp_f32 v22, v108
 v_add_f32 v29, v20, v29
 v_cvt_pk_bf16_f32 v53, v20, v21
 v_exp_f32 v23, v109
 v_add_f32 v29, v21, v29
 v_exp_f32 v24, v110
 v_add_f32 v29, v22, v29
 v_cvt_pk_bf16_f32 v54, v22, v23
 v_exp_f32 v25, v111
 v_add_f32 v29, v23, v29
 v_add_f32 v29, v24, v29
 v_cvt_pk_bf16_f32 v55, v24, v25
 v_add_f32 v29, v25, v29
 v_exp_f32 v18, v112
 v_exp_f32 v19, v113
 v_exp_f32 v20, v114
 v_add_f32 v28, v18, v28
 v_cvt_pk_bf16_f32 v56, v18, v19
 v_exp_f32 v21, v115
 v_add_f32 v28, v19, v28
 v_exp_f32 v22, v120
 v_add_f32 v28, v20, v28
 v_cvt_pk_bf16_f32 v57, v20, v21
 v_exp_f32 v23, v121
 v_add_f32 v28, v21, v28
 v_exp_f32 v24, v122
 v_add_f32 v28, v22, v28
 v_cvt_pk_bf16_f32 v58, v22, v23
 v_exp_f32 v25, v123
 v_add_f32 v28, v23, v28
 v_exp_f32 v18, v116
 v_add_f32 v28, v24, v28
 v_cvt_pk_bf16_f32 v59, v24, v25
 v_exp_f32 v19, v117
 v_add_f32 v28, v25, v28
 v_exp_f32 v20, v118
 v_add_f32 v29, v18, v29
 v_cvt_pk_bf16_f32 v60, v18, v19
 v_exp_f32 v21, v119
 v_add_f32 v29, v19, v29
 v_exp_f32 v22, v124
 v_add_f32 v29, v20, v29
 v_cvt_pk_bf16_f32 v61, v20, v21
 v_exp_f32 v23, v125
 v_add_f32 v29, v21, v29
 v_exp_f32 v24, v126
 v_add_f32 v29, v22, v29
 v_cvt_pk_bf16_f32 v62, v22, v23
 v_exp_f32 v25, v127
 v_add_f32 v29, v23, v29
 v_add_f32 v29, v24, v29
 v_cvt_pk_bf16_f32 v63, v24, v25
 v_add_f32 v29, v25, v29
 v_sub_f32 v10, v32, v14
 v_sub_f32 v11, v36, v15
 v_cvt_i32_f32 v10, v10
 v_cvt_i32_f32 v11, v11
 v_ldexp_f32 v10, 1.0, v10
 v_ldexp_f32 v11, 1.0, v11
 v_and_b32 v10, 0xffff0000, v10
 v_and_b32 v11, 0xffff0000, v11
 v_fmac_f32 v30, v10, v16
 v_fmac_f32 v31, v11, v17
 v_lshrrev_b32 v12, 16, v10
 v_lshrrev_b32 v13, 16, v11
 v_accvgpr_read_b32 v18, a128
 v_dot2c_f32_bf16 v128, v18, v12
 v_dot2c_f32_bf16 v129, v18, v10
 v_accvgpr_read_b32 v19, a129
 v_dot2c_f32_bf16 v130, v19, v12
 v_dot2c_f32_bf16 v131, v19, v10
 v_accvgpr_read_b32 v20, a130
 v_dot2c_f32_bf16 v136, v20, v12
 v_dot2c_f32_bf16 v137, v20, v10
 v_accvgpr_read_b32 v21, a131
 v_dot2c_f32_bf16 v138, v21, v12
 v_dot2c_f32_bf16 v139, v21, v10
 v_accvgpr_read_b32 v22, a132
 v_dot2c_f32_bf16 v144, v22, v12
 v_dot2c_f32_bf16 v145, v22, v10
 v_accvgpr_read_b32 v23, a133
 v_dot2c_f32_bf16 v146, v23, v12
 v_dot2c_f32_bf16 v147, v23, v10
 v_accvgpr_read_b32 v24, a134
 v_dot2c_f32_bf16 v152, v24, v12
 v_dot2c_f32_bf16 v153, v24, v10
 v_accvgpr_read_b32 v25, a135
 v_dot2c_f32_bf16 v154, v25, v12
 v_dot2c_f32_bf16 v155, v25, v10
 v_accvgpr_read_b32 v18, a136
 v_dot2c_f32_bf16 v160, v18, v12
 v_dot2c_f32_bf16 v161, v18, v10
 v_accvgpr_read_b32 v19, a137
 v_dot2c_f32_bf16 v162, v19, v12
 v_dot2c_f32_bf16 v163, v19, v10
 v_accvgpr_read_b32 v20, a138
 v_dot2c_f32_bf16 v168, v20, v12
 v_dot2c_f32_bf16 v169, v20, v10
 v_accvgpr_read_b32 v21, a139
 v_dot2c_f32_bf16 v170, v21, v12
 v_dot2c_f32_bf16 v171, v21, v10
 v_accvgpr_read_b32 v22, a140
 v_dot2c_f32_bf16 v176, v22, v12
 v_dot2c_f32_bf16 v177, v22, v10
 v_accvgpr_read_b32 v23, a141
 v_dot2c_f32_bf16 v178, v23, v12
 v_dot2c_f32_bf16 v179, v23, v10
 v_accvgpr_read_b32 v24, a142
 v_dot2c_f32_bf16 v184, v24, v12
 v_dot2c_f32_bf16 v185, v24, v10
 v_accvgpr_read_b32 v25, a143
 v_dot2c_f32_bf16 v186, v25, v12
 v_dot2c_f32_bf16 v187, v25, v10
 v_accvgpr_read_b32 v18, a144
 v_dot2c_f32_bf16 v192, v18, v12
 v_dot2c_f32_bf16 v193, v18, v10
 v_accvgpr_read_b32 v19, a145
 v_dot2c_f32_bf16 v194, v19, v12
 v_dot2c_f32_bf16 v195, v19, v10
 v_accvgpr_read_b32 v20, a146
 v_dot2c_f32_bf16 v200, v20, v12
 v_dot2c_f32_bf16 v201, v20, v10
 v_accvgpr_read_b32 v21, a147
 v_dot2c_f32_bf16 v202, v21, v12
 v_dot2c_f32_bf16 v203, v21, v10
 v_accvgpr_read_b32 v22, a148
 v_dot2c_f32_bf16 v208, v22, v12
 v_dot2c_f32_bf16 v209, v22, v10
 v_accvgpr_read_b32 v23, a149
 v_dot2c_f32_bf16 v210, v23, v12
 v_dot2c_f32_bf16 v211, v23, v10
 v_accvgpr_read_b32 v24, a150
 v_dot2c_f32_bf16 v216, v24, v12
 v_dot2c_f32_bf16 v217, v24, v10
 v_accvgpr_read_b32 v25, a151
 v_dot2c_f32_bf16 v218, v25, v12
 v_dot2c_f32_bf16 v219, v25, v10
 v_accvgpr_read_b32 v18, a152
 v_dot2c_f32_bf16 v224, v18, v12
 v_dot2c_f32_bf16 v225, v18, v10
 v_accvgpr_read_b32 v19, a153
 v_dot2c_f32_bf16 v226, v19, v12
 v_dot2c_f32_bf16 v227, v19, v10
 v_accvgpr_read_b32 v20, a154
 v_dot2c_f32_bf16 v232, v20, v12
 v_dot2c_f32_bf16 v233, v20, v10
 v_accvgpr_read_b32 v21, a155
 v_dot2c_f32_bf16 v234, v21, v12
 v_dot2c_f32_bf16 v235, v21, v10
 v_accvgpr_read_b32 v22, a156
 v_dot2c_f32_bf16 v240, v22, v12
 v_dot2c_f32_bf16 v241, v22, v10
 v_accvgpr_read_b32 v23, a157
 v_dot2c_f32_bf16 v242, v23, v12
 v_dot2c_f32_bf16 v243, v23, v10
 v_accvgpr_read_b32 v24, a158
 v_dot2c_f32_bf16 v248, v24, v12
 v_dot2c_f32_bf16 v249, v24, v10
 v_accvgpr_read_b32 v25, a159
 v_dot2c_f32_bf16 v250, v25, v12
 v_dot2c_f32_bf16 v251, v25, v10
 v_accvgpr_read_b32 v18, a160
 v_dot2c_f32_bf16 v132, v18, v13
 v_dot2c_f32_bf16 v133, v18, v11
 v_accvgpr_read_b32 v19, a161
 v_dot2c_f32_bf16 v134, v19, v13
 v_dot2c_f32_bf16 v135, v19, v11
 v_accvgpr_read_b32 v20, a162
 v_dot2c_f32_bf16 v140, v20, v13
 v_dot2c_f32_bf16 v141, v20, v11
 v_accvgpr_read_b32 v21, a163
 v_dot2c_f32_bf16 v142, v21, v13
 v_dot2c_f32_bf16 v143, v21, v11
 v_accvgpr_read_b32 v22, a164
 v_dot2c_f32_bf16 v148, v22, v13
 v_dot2c_f32_bf16 v149, v22, v11
 v_accvgpr_read_b32 v23, a165
 v_dot2c_f32_bf16 v150, v23, v13
 v_dot2c_f32_bf16 v151, v23, v11
 v_accvgpr_read_b32 v24, a166
 v_dot2c_f32_bf16 v156, v24, v13
 v_dot2c_f32_bf16 v157, v24, v11
 v_accvgpr_read_b32 v25, a167
 v_dot2c_f32_bf16 v158, v25, v13
 v_dot2c_f32_bf16 v159, v25, v11
 v_accvgpr_read_b32 v18, a168
 v_dot2c_f32_bf16 v164, v18, v13
 v_dot2c_f32_bf16 v165, v18, v11
 v_accvgpr_read_b32 v19, a169
 v_dot2c_f32_bf16 v166, v19, v13
 v_dot2c_f32_bf16 v167, v19, v11
 v_accvgpr_read_b32 v20, a170
 v_dot2c_f32_bf16 v172, v20, v13
 v_dot2c_f32_bf16 v173, v20, v11
 v_accvgpr_read_b32 v21, a171
 v_dot2c_f32_bf16 v174, v21, v13
 v_dot2c_f32_bf16 v175, v21, v11
 v_accvgpr_read_b32 v22, a172
 v_dot2c_f32_bf16 v180, v22, v13
 v_dot2c_f32_bf16 v181, v22, v11
 v_accvgpr_read_b32 v23, a173
 v_dot2c_f32_bf16 v182, v23, v13
 v_dot2c_f32_bf16 v183, v23, v11
 v_accvgpr_read_b32 v24, a174
 v_dot2c_f32_bf16 v188, v24, v13
 v_dot2c_f32_bf16 v189, v24, v11
 v_accvgpr_read_b32 v25, a175
 v_dot2c_f32_bf16 v190, v25, v13
 v_dot2c_f32_bf16 v191, v25, v11
 v_accvgpr_read_b32 v18, a176
 v_dot2c_f32_bf16 v196, v18, v13
 v_dot2c_f32_bf16 v197, v18, v11
 v_accvgpr_read_b32 v19, a177
 v_dot2c_f32_bf16 v198, v19, v13
 v_dot2c_f32_bf16 v199, v19, v11
 v_accvgpr_read_b32 v20, a178
 v_dot2c_f32_bf16 v204, v20, v13
 v_dot2c_f32_bf16 v205, v20, v11
 v_accvgpr_read_b32 v21, a179
 v_dot2c_f32_bf16 v206, v21, v13
 v_dot2c_f32_bf16 v207, v21, v11
 v_accvgpr_read_b32 v22, a180
 v_dot2c_f32_bf16 v212, v22, v13
 v_dot2c_f32_bf16 v213, v22, v11
 v_accvgpr_read_b32 v23, a181
 v_dot2c_f32_bf16 v214, v23, v13
 v_dot2c_f32_bf16 v215, v23, v11
 v_accvgpr_read_b32 v24, a182
 v_dot2c_f32_bf16 v220, v24, v13
 v_dot2c_f32_bf16 v221, v24, v11
 v_accvgpr_read_b32 v25, a183
 v_dot2c_f32_bf16 v222, v25, v13
 v_dot2c_f32_bf16 v223, v25, v11
 v_accvgpr_read_b32 v18, a184
 v_dot2c_f32_bf16 v228, v18, v13
 v_dot2c_f32_bf16 v229, v18, v11
 v_accvgpr_read_b32 v19, a185
 v_dot2c_f32_bf16 v230, v19, v13
 v_dot2c_f32_bf16 v231, v19, v11
 v_accvgpr_read_b32 v20, a186
 v_dot2c_f32_bf16 v236, v20, v13
 v_dot2c_f32_bf16 v237, v20, v11
 v_accvgpr_read_b32 v21, a187
 v_dot2c_f32_bf16 v238, v21, v13
 v_dot2c_f32_bf16 v239, v21, v11
 v_accvgpr_read_b32 v22, a188
 v_dot2c_f32_bf16 v244, v22, v13
 v_dot2c_f32_bf16 v245, v22, v11
 v_accvgpr_read_b32 v23, a189
 v_dot2c_f32_bf16 v246, v23, v13
 v_dot2c_f32_bf16 v247, v23, v11
 v_accvgpr_read_b32 v24, a190
 v_dot2c_f32_bf16 v252, v24, v13
 v_dot2c_f32_bf16 v253, v24, v11
 v_accvgpr_read_b32 v25, a191
 v_dot2c_f32_bf16 v254, v25, v13
 v_dot2c_f32_bf16 v255, v25, v11
 s_nop 2
 s_setpc_b64 s[36:37]
L_cg0:
 s_call_b64 s[36:37], L_comb
 s_branch L_final_o2
L_cg1:
 s_call_b64 s[36:37], L_comb
 s_branch L_e_o
L_st0:
 s_call_b64 s[36:37], L_slow0
 s_branch L_rt0
L_st1:
 s_call_b64 s[36:37], L_slow1
 s_branch L_rt1
L_st2:
 s_call_b64 s[36:37], L_slow1n
 s_branch L_rt2
L_st4:
 s_call_b64 s[36:37], L_slow1n
 s_branch L_rt4
L_st5:
 s_call_b64 s[36:37], L_slow1
 s_branch L_rt5
L_st6:
 s_call_b64 s[36:37], L_slow0
 s_branch L_rt6
L_st7:
 s_call_b64 s[36:37], L_slow0
 s_branch L_rt7
L_st8:
 s_call_b64 s[36:37], L_slow0
 s_branch L_rt8
L_st9:
 s_call_b64 s[36:37], L_slow1
 s_branch L_rt9
L_st11:
 s_call_b64 s[36:37], L_slow1n
 s_branch L_rt11
L_slow0:
 s_nop 7
 s_nop 3
 v_max3_f32 v10, v64, v65, v66
 v_max3_f32 v10, v67, v72, v10
 v_max3_f32 v10, v73, v74, v10
 v_max3_f32 v10, v75, v80, v10
 v_max3_f32 v10, v81, v82, v10
 v_max3_f32 v10, v83, v88, v10
 v_max3_f32 v10, v89, v90, v10
 v_max_f32 v10, v91, v10
 v_max3_f32 v11, v68, v69, v70
 v_max3_f32 v11, v71, v76, v11
 v_max3_f32 v11, v77, v78, v11
 v_max3_f32 v11, v79, v84, v11
 v_max3_f32 v11, v85, v86, v11
 v_max3_f32 v11, v87, v92, v11
 v_max3_f32 v11, v93, v94, v11
 v_max_f32 v11, v95, v11
 v_mov_b32 v12, v10
 v_mov_b32 v13, v11
 s_nop 0
 v_permlane16_swap_b32 v12, v10
 v_permlane16_swap_b32 v13, v11
 v_max_f32 v10, v12, v10
 v_max_f32 v11, v13, v11
 v_mov_b32 v12, v10
 v_mov_b32 v13, v11
 s_nop 0
 v_permlane32_swap_b32 v12, v10
 v_permlane32_swap_b32 v13, v11
 v_max_f32 v10, v12, v10
 v_max_f32 v11, v13, v11
 v_ceil_f32 v10, v10
 v_ceil_f32 v11, v11
 v_max_f32 v10, 0, v10
 v_max_f32 v11, 0, v11
 v_sub_f32 v64, v64, v10
 v_sub_f32 v65, v65, v10
 v_sub_f32 v66, v66, v10
 v_sub_f32 v67, v67, v10
 v_sub_f32 v68, v68, v11
 v_sub_f32 v69, v69, v11
 v_sub_f32 v70, v70, v11
 v_sub_f32 v71, v71, v11
 v_sub_f32 v72, v72, v10
 v_sub_f32 v73, v73, v10
 v_sub_f32 v74, v74, v10
 v_sub_f32 v75, v75, v10
 v_sub_f32 v76, v76, v11
 v_sub_f32 v77, v77, v11
 v_sub_f32 v78, v78, v11
 v_sub_f32 v79, v79, v11
 v_sub_f32 v80, v80, v10
 v_sub_f32 v81, v81, v10
 v_sub_f32 v82, v82, v10
 v_sub_f32 v83, v83, v10
 v_sub_f32 v84, v84, v11
 v_sub_f32 v85, v85, v11
 v_sub_f32 v86, v86, v11
 v_sub_f32 v87, v87, v11
 v_sub_f32 v88, v88, v10
 v_sub_f32 v89, v89, v10
 v_sub_f32 v90, v90, v10
 v_sub_f32 v91, v91, v10
 v_sub_f32 v92, v92, v11
 v_sub_f32 v93, v93, v11
 v_sub_f32 v94, v94, v11
 v_sub_f32 v95, v95, v11
 v_sub_f32 v96, v96, v10
 v_sub_f32 v97, v97, v10
 v_sub_f32 v98, v98, v10
 v_sub_f32 v99, v99, v10
 v_sub_f32 v100, v100, v11
 v_sub_f32 v101, v101, v11
 v_sub_f32 v102, v102, v11
 v_sub_f32 v103, v103, v11
 v_sub_f32 v104, v104, v10
 v_sub_f32 v105, v105, v10
 v_sub_f32 v106, v106, v10
 v_sub_f32 v107, v107, v10
 v_sub_f32 v108, v108, v11
 v_sub_f32 v109, v109, v11
 v_sub_f32 v110, v110, v11
 v_sub_f32 v111, v111, v11
 v_sub_f32 v112, v112, v10
 v_sub_f32 v113, v113, v10
 v_sub_f32 v114, v114, v10
 v_sub_f32 v115, v115, v10
 v_sub_f32 v116, v116, v11
 v_sub_f32 v117, v117, v11
 v_sub_f32 v118, v118, v11
 v_sub_f32 v119, v119, v11
 v_sub_f32 v120, v120, v10
 v_sub_f32 v121, v121, v10
 v_sub_f32 v122, v122, v10
 v_sub_f32 v123, v123, v10
 v_sub_f32 v124, v124, v11
 v_sub_f32 v125, v125, v11
 v_sub_f32 v126, v126, v11
 v_sub_f32 v127, v127, v11
 v_sub_f32 v32, v32, v10
 v_sub_f32 v33, v33, v10
 v_sub_f32 v34, v34, v10
 v_sub_f32 v35, v35, v10
 v_sub_f32 v36, v36, v11
 v_sub_f32 v37, v37, v11
 v_sub_f32 v38, v38, v11
 v_sub_f32 v39, v39, v11
 v_exp_f32 v12, -v10
 v_exp_f32 v13, -v11
 v_mul_f32 v30, v12, v30
 v_mul_f32 v31, v13, v31
 v_mul_f32 v128, v12, v128
 v_mul_f32 v129, v12, v129
 v_mul_f32 v130, v12, v130
 v_mul_f32 v131, v12, v131
 v_mul_f32 v132, v13, v132
 v_mul_f32 v133, v13, v133
 v_mul_f32 v134, v13, v134
 v_mul_f32 v135, v13, v135
 v_mul_f32 v136, v12, v136
 v_mul_f32 v137, v12, v137
 v_mul_f32 v138, v12, v138
 v_mul_f32 v139, v12, v139
 v_mul_f32 v140, v13, v140
 v_mul_f32 v141, v13, v141
 v_mul_f32 v142, v13, v142
 v_mul_f32 v143, v13, v143
 v_mul_f32 v144, v12, v144
 v_mul_f32 v145, v12, v145
 v_mul_f32 v146, v12, v146
 v_mul_f32 v147, v12, v147
 v_mul_f32 v148, v13, v148
 v_mul_f32 v149, v13, v149
 v_mul_f32 v150, v13, v150
 v_mul_f32 v151, v13, v151
 v_mul_f32 v152, v12, v152
 v_mul_f32 v153, v12, v153
 v_mul_f32 v154, v12, v154
 v_mul_f32 v155, v12, v155
 v_mul_f32 v156, v13, v156
 v_mul_f32 v157, v13, v157
 v_mul_f32 v158, v13, v158
 v_mul_f32 v159, v13, v159
 v_mul_f32 v160, v12, v160
 v_mul_f32 v161, v12, v161
 v_mul_f32 v162, v12, v162
 v_mul_f32 v163, v12, v163
 v_mul_f32 v164, v13, v164
 v_mul_f32 v165, v13, v165
 v_mul_f32 v166, v13, v166
 v_mul_f32 v167, v13, v167
 v_mul_f32 v168, v12, v168
 v_mul_f32 v169, v12, v169
 v_mul_f32 v170, v12, v170
 v_mul_f32 v171, v12, v171
 v_mul_f32 v172, v13, v172
 v_mul_f32 v173, v13, v173
 v_mul_f32 v174, v13, v174
 v_mul_f32 v175, v13, v175
 v_mul_f32 v176, v12, v176
 v_mul_f32 v177, v12, v177
 v_mul_f32 v178, v12, v178
 v_mul_f32 v179, v12, v179
 v_mul_f32 v180, v13, v180
 v_mul_f32 v181, v13, v181
 v_mul_f32 v182, v13, v182
 v_mul_f32 v183, v13, v183
 v_mul_f32 v184, v12, v184
 v_mul_f32 v185, v12, v185
 v_mul_f32 v186, v12, v186
 v_mul_f32 v187, v12, v187
 v_mul_f32 v188, v13, v188
 v_mul_f32 v189, v13, v189
 v_mul_f32 v190, v13, v190
 v_mul_f32 v191, v13, v191
 v_mul_f32 v192, v12, v192
 v_mul_f32 v193, v12, v193
 v_mul_f32 v194, v12, v194
 v_mul_f32 v195, v12, v195
 v_mul_f32 v196, v13, v196
 v_mul_f32 v197, v13, v197
 v_mul_f32 v198, v13, v198
 v_mul_f32 v199, v13, v199
 v_mul_f32 v200, v12, v200
 v_mul_f32 v201, v12, v201
 v_mul_f32 v202, v12, v202
 v_mul_f32 v203, v12, v203
 v_mul_f32 v204, v13, v204
 v_mul_f32 v205, v13, v205
 v_mul_f32 v206, v13, v206
 v_mul_f32 v207, v13, v207
 v_mul_f32 v208, v12, v208
 v_mul_f32 v209, v12, v209
 v_mul_f32 v210, v12, v210
 v_mul_f32 v211, v12, v211
 v_mul_f32 v212, v13, v212
 v_mul_f32 v213, v13, v213
 v_mul_f32 v214, v13, v214
 v_mul_f32 v215, v13, v215
 v_mul_f32 v216, v12, v216
 v_mul_f32 v217, v12, v217
 v_mul_f32 v218, v12, v218
 v_mul_f32 v219, v12, v219
 v_mul_f32 v220, v13, v220
 v_mul_f32 v221, v13, v221
 v_mul_f32 v222, v13, v222
 v_mul_f32 v223, v13, v223
 v_mul_f32 v224, v12, v224
 v_mul_f32 v225, v12, v225
 v_mul_f32 v226, v12, v226
 v_mul_f32 v227, v12, v227
 v_mul_f32 v228, v13, v228
 v_mul_f32 v229, v13, v229
 v_mul_f32 v230, v13, v230
 v_mul_f32 v231, v13, v231
 v_mul_f32 v232, v12, v232
 v_mul_f32 v233, v12, v233
 v_mul_f32 v234, v12, v234
 v_mul_f32 v235, v12, v235
 v_mul_f32 v236, v13, v236
 v_mul_f32 v237, v13, v237
 v_mul_f32 v238, v13, v238
 v_mul_f32 v239, v13, v239
 v_mul_f32 v240, v12, v240
 v_mul_f32 v241, v12, v241
 v_mul_f32 v242, v12, v242
 v_mul_f32 v243, v12, v243
 v_mul_f32 v244, v13, v244
 v_mul_f32 v245, v13, v245
 v_mul_f32 v246, v13, v246
 v_mul_f32 v247, v13, v247
 v_mul_f32 v248, v12, v248
 v_mul_f32 v249, v12, v249
 v_mul_f32 v250, v12, v250
 v_mul_f32 v251, v12, v251
 v_mul_f32 v252, v13, v252
 v_mul_f32 v253, v13, v253
 v_mul_f32 v254, v13, v254
 v_mul_f32 v255, v13, v255
 v_exp_f32 v18, v64
 v_exp_f32 v19, v65
 v_exp_f32 v20, v66
 v_add_f32 v26, v18, v19
 v_cvt_pk_bf16_f32 v40, v18, v19
 v_exp_f32 v21, v67
 v_exp_f32 v22, v72
 v_add_f32 v26, v20, v26
 v_cvt_pk_bf16_f32 v41, v20, v21
 v_exp_f32 v23, v73
 v_add_f32 v26, v21, v26
 v_exp_f32 v24, v74
 v_add_f32 v26, v22, v26
 v_cvt_pk_bf16_f32 v42, v22, v23
 v_exp_f32 v25, v75
 v_add_f32 v26, v23, v26
 v_exp_f32 v18, v68
 v_add_f32 v26, v24, v26
 v_cvt_pk_bf16_f32 v43, v24, v25
 v_exp_f32 v19, v69
 v_add_f32 v26, v25, v26
 v_exp_f32 v20, v70
 v_add_f32 v27, v18, v19
 v_cvt_pk_bf16_f32 v44, v18, v19
 v_exp_f32 v21, v71
 v_exp_f32 v22, v76
 v_add_f32 v27, v20, v27
 v_cvt_pk_bf16_f32 v45, v20, v21
 v_exp_f32 v23, v77
 v_add_f32 v27, v21, v27
 v_exp_f32 v24, v78
 v_add_f32 v27, v22, v27
 v_cvt_pk_bf16_f32 v46, v22, v23
 v_exp_f32 v25, v79
 v_add_f32 v27, v23, v27
 v_add_f32 v27, v24, v27
 v_cvt_pk_bf16_f32 v47, v24, v25
 v_add_f32 v27, v25, v27
 v_exp_f32 v18, v80
 v_exp_f32 v19, v81
 v_exp_f32 v20, v82
 v_add_f32 v26, v18, v26
 v_cvt_pk_bf16_f32 v56, v18, v19
 v_exp_f32 v21, v83
 v_add_f32 v26, v19, v26
 v_exp_f32 v22, v88
 v_add_f32 v26, v20, v26
 v_cvt_pk_bf16_f32 v57, v20, v21
 v_exp_f32 v23, v89
 v_add_f32 v26, v21, v26
 v_exp_f32 v24, v90
 v_add_f32 v26, v22, v26
 v_cvt_pk_bf16_f32 v58, v22, v23
 v_exp_f32 v25, v91
 v_add_f32 v26, v23, v26
 v_exp_f32 v18, v84
 v_add_f32 v26, v24, v26
 v_cvt_pk_bf16_f32 v59, v24, v25
 v_exp_f32 v19, v85
 v_add_f32 v26, v25, v26
 v_exp_f32 v20, v86
 v_add_f32 v27, v18, v27
 v_cvt_pk_bf16_f32 v60, v18, v19
 v_exp_f32 v21, v87
 v_add_f32 v27, v19, v27
 v_exp_f32 v22, v92
 v_add_f32 v27, v20, v27
 v_cvt_pk_bf16_f32 v61, v20, v21
 v_exp_f32 v23, v93
 v_add_f32 v27, v21, v27
 v_exp_f32 v24, v94
 v_add_f32 v27, v22, v27
 v_cvt_pk_bf16_f32 v62, v22, v23
 v_exp_f32 v25, v95
 v_add_f32 v27, v23, v27
 v_add_f32 v27, v24, v27
 v_cvt_pk_bf16_f32 v63, v24, v25
 v_add_f32 v27, v25, v27
 s_nop 3
 s_setpc_b64 s[36:37]
L_slow1:
 s_nop 7
 s_nop 3
 v_max3_f32 v10, v96, v97, v98
 v_max3_f32 v10, v99, v104, v10
 v_max3_f32 v10, v105, v106, v10
 v_max3_f32 v10, v107, v112, v10
 v_max3_f32 v10, v113, v114, v10
 v_max3_f32 v10, v115, v120, v10
 v_max3_f32 v10, v121, v122, v10
 v_max_f32 v10, v123, v10
 v_max3_f32 v11, v100, v101, v102
 v_max3_f32 v11, v103, v108, v11
 v_max3_f32 v11, v109, v110, v11
 v_max3_f32 v11, v111, v116, v11
 v_max3_f32 v11, v117, v118, v11
 v_max3_f32 v11, v119, v124, v11
 v_max3_f32 v11, v125, v126, v11
 v_max_f32 v11, v127, v11
 v_mov_b32 v12, v10
 v_mov_b32 v13, v11
 s_nop 0
 v_permlane16_swap_b32 v12, v10
 v_permlane16_swap_b32 v13, v11
 v_max_f32 v10, v12, v10
 v_max_f32 v11, v13, v11
 v_mov_b32 v12, v10
 v_mov_b32 v13, v11
 s_nop 0
 v_permlane32_swap_b32 v12, v10
 v_permlane32_swap_b32 v13, v11
 v_max_f32 v10, v12, v10
 v_max_f32 v11, v13, v11
 v_ceil_f32 v10, v10
 v_ceil_f32 v11, v11
 v_max_f32 v10, 0, v10
 v_max_f32 v11, 0, v11
 v_sub_f32 v96, v96, v10
 v_sub_f32 v97, v97, v10
 v_sub_f32 v98, v98, v10
 v_sub_f32 v99, v99, v10
 v_sub_f32 v100, v100, v11
 v_sub_f32 v101, v101, v11
 v_sub_f32 v102, v102, v11
 v_sub_f32 v103, v103, v11
 v_sub_f32 v104, v104, v10
 v_sub_f32 v105, v105, v10
 v_sub_f32 v106, v106, v10
 v_sub_f32 v107, v107, v10
 v_sub_f32 v108, v108, v11
 v_sub_f32 v109, v109, v11
 v_sub_f32 v110, v110, v11
 v_sub_f32 v111, v111, v11
 v_sub_f32 v112, v112, v10
 v_sub_f32 v113, v113, v10
 v_sub_f32 v114, v114, v10
 v_sub_f32 v115, v115, v10
 v_sub_f32 v116, v116, v11
 v_sub_f32 v117, v117, v11
 v_sub_f32 v118, v118, v11
 v_sub_f32 v119, v119, v11
 v_sub_f32 v120, v120, v10
 v_sub_f32 v121, v121, v10
 v_sub_f32 v122, v122, v10
 v_sub_f32 v123, v123, v10
 v_sub_f32 v124, v124, v11
 v_sub_f32 v125, v125, v11
 v_sub_f32 v126, v126, v11
 v_sub_f32 v127, v127, v11
 v_sub_f32 v64, v64, v10
 v_sub_f32 v65, v65, v10
 v_sub_f32 v66, v66, v10
 v_sub_f32 v67, v67, v10
 v_sub_f32 v68, v68, v11
 v_sub_f32 v69, v69, v11
 v_sub_f32 v70, v70, v11
 v_sub_f32 v71, v71, v11
 v_sub_f32 v72, v72, v10
 v_sub_f32 v73, v73, v10
 v_sub_f32 v74, v74, v10
 v_sub_f32 v75, v75, v10
 v_sub_f32 v76, v76, v11
 v_sub_f32 v77, v77, v11
 v_sub_f32 v78, v78, v11
 v_sub_f32 v79, v79, v11
 v_sub_f32 v80, v80, v10
 v_sub_f32 v81, v81, v10
 v_sub_f32 v82, v82, v10
 v_sub_f32 v83, v83, v10
 v_sub_f32 v84, v84, v11
 v_sub_f32 v85, v85, v11
 v_sub_f32 v86, v86, v11
 v_sub_f32 v87, v87, v11
 v_sub_f32 v88, v88, v10
 v_sub_f32 v89, v89, v10
 v_sub_f32 v90, v90, v10
 v_sub_f32 v91, v91, v10
 v_sub_f32 v92, v92, v11
 v_sub_f32 v93, v93, v11
 v_sub_f32 v94, v94, v11
 v_sub_f32 v95, v95, v11
 v_sub_f32 v32, v32, v10
 v_sub_f32 v33, v33, v10
 v_sub_f32 v34, v34, v10
 v_sub_f32 v35, v35, v10
 v_sub_f32 v36, v36, v11
 v_sub_f32 v37, v37, v11
 v_sub_f32 v38, v38, v11
 v_sub_f32 v39, v39, v11
 v_exp_f32 v12, -v10
 v_exp_f32 v13, -v11
 v_mul_f32 v30, v12, v30
 v_mul_f32 v31, v13, v31
 v_mul_f32 v128, v12, v128
 v_mul_f32 v129, v12, v129
 v_mul_f32 v130, v12, v130
 v_mul_f32 v131, v12, v131
 v_mul_f32 v132, v13, v132
 v_mul_f32 v133, v13, v133
 v_mul_f32 v134, v13, v134
 v_mul_f32 v135, v13, v135
 v_mul_f32 v136, v12, v136
 v_mul_f32 v137, v12, v137
 v_mul_f32 v138, v12, v138
 v_mul_f32 v139, v12, v139
 v_mul_f32 v140, v13, v140
 v_mul_f32 v141, v13, v141
 v_mul_f32 v142, v13, v142
 v_mul_f32 v143, v13, v143
 v_mul_f32 v144, v12, v144
 v_mul_f32 v145, v12, v145
 v_mul_f32 v146, v12, v146
 v_mul_f32 v147, v12, v147
 v_mul_f32 v148, v13, v148
 v_mul_f32 v149, v13, v149
 v_mul_f32 v150, v13, v150
 v_mul_f32 v151, v13, v151
 v_mul_f32 v152, v12, v152
 v_mul_f32 v153, v12, v153
 v_mul_f32 v154, v12, v154
 v_mul_f32 v155, v12, v155
 v_mul_f32 v156, v13, v156
 v_mul_f32 v157, v13, v157
 v_mul_f32 v158, v13, v158
 v_mul_f32 v159, v13, v159
 v_mul_f32 v160, v12, v160
 v_mul_f32 v161, v12, v161
 v_mul_f32 v162, v12, v162
 v_mul_f32 v163, v12, v163
 v_mul_f32 v164, v13, v164
 v_mul_f32 v165, v13, v165
 v_mul_f32 v166, v13, v166
 v_mul_f32 v167, v13, v167
 v_mul_f32 v168, v12, v168
 v_mul_f32 v169, v12, v169
 v_mul_f32 v170, v12, v170
 v_mul_f32 v171, v12, v171
 v_mul_f32 v172, v13, v172
 v_mul_f32 v173, v13, v173
 v_mul_f32 v174, v13, v174
 v_mul_f32 v175, v13, v175
 v_mul_f32 v176, v12, v176
 v_mul_f32 v177, v12, v177
 v_mul_f32 v178, v12, v178
 v_mul_f32 v179, v12, v179
 v_mul_f32 v180, v13, v180
 v_mul_f32 v181, v13, v181
 v_mul_f32 v182, v13, v182
 v_mul_f32 v183, v13, v183
 v_mul_f32 v184, v12, v184
 v_mul_f32 v185, v12, v185
 v_mul_f32 v186, v12, v186
 v_mul_f32 v187, v12, v187
 v_mul_f32 v188, v13, v188
 v_mul_f32 v189, v13, v189
 v_mul_f32 v190, v13, v190
 v_mul_f32 v191, v13, v191
 v_mul_f32 v192, v12, v192
 v_mul_f32 v193, v12, v193
 v_mul_f32 v194, v12, v194
 v_mul_f32 v195, v12, v195
 v_mul_f32 v196, v13, v196
 v_mul_f32 v197, v13, v197
 v_mul_f32 v198, v13, v198
 v_mul_f32 v199, v13, v199
 v_mul_f32 v200, v12, v200
 v_mul_f32 v201, v12, v201
 v_mul_f32 v202, v12, v202
 v_mul_f32 v203, v12, v203
 v_mul_f32 v204, v13, v204
 v_mul_f32 v205, v13, v205
 v_mul_f32 v206, v13, v206
 v_mul_f32 v207, v13, v207
 v_mul_f32 v208, v12, v208
 v_mul_f32 v209, v12, v209
 v_mul_f32 v210, v12, v210
 v_mul_f32 v211, v12, v211
 v_mul_f32 v212, v13, v212
 v_mul_f32 v213, v13, v213
 v_mul_f32 v214, v13, v214
 v_mul_f32 v215, v13, v215
 v_mul_f32 v216, v12, v216
 v_mul_f32 v217, v12, v217
 v_mul_f32 v218, v12, v218
 v_mul_f32 v219, v12, v219
 v_mul_f32 v220, v13, v220
 v_mul_f32 v221, v13, v221
 v_mul_f32 v222, v13, v222
 v_mul_f32 v223, v13, v223
 v_mul_f32 v224, v12, v224
 v_mul_f32 v225, v12, v225
 v_mul_f32 v226, v12, v226
 v_mul_f32 v227, v12, v227
 v_mul_f32 v228, v13, v228
 v_mul_f32 v229, v13, v229
 v_mul_f32 v230, v13, v230
 v_mul_f32 v231, v13, v231
 v_mul_f32 v232, v12, v232
 v_mul_f32 v233, v12, v233
 v_mul_f32 v234, v12, v234
 v_mul_f32 v235, v12, v235
 v_mul_f32 v236, v13, v236
 v_mul_f32 v237, v13, v237
 v_mul_f32 v238, v13, v238
 v_mul_f32 v239, v13, v239
 v_mul_f32 v240, v12, v240
 v_mul_f32 v241, v12, v241
 v_mul_f32 v242, v12, v242
 v_mul_f32 v243, v12, v243
 v_mul_f32 v244, v13, v244
 v_mul_f32 v245, v13, v245
 v_mul_f32 v246, v13, v246
 v_mul_f32 v247, v13, v247
 v_mul_f32 v248, v12, v248
 v_mul_f32 v249, v12, v249
 v_mul_f32 v250, v12, v250
 v_mul_f32 v251, v12, v251
 v_mul_f32 v252, v13, v252
 v_mul_f32 v253, v13, v253
 v_mul_f32 v254, v13, v254
 v_mul_f32 v255, v13, v255
 v_exp_f32 v18, v96
 v_exp_f32 v19, v97
 v_exp_f32 v20, v98
 v_add_f32 v28, v18, v19
 v_cvt_pk_bf16_f32 v48, v18, v19
 v_exp_f32 v21, v99
 v_exp_f32 v22, v104
 v_add_f32 v28, v20, v28
 v_cvt_pk_bf16_f32 v49, v20, v21
 v_exp_f32 v23, v105
 v_add_f32 v28, v21, v28
 v_exp_f32 v24, v106
 v_add_f32 v28, v22, v28
 v_cvt_pk_bf16_f32 v50, v22, v23
 v_exp_f32 v25, v107
 v_add_f32 v28, v23, v28
 v_exp_f32 v18, v100
 v_add_f32 v28, v24, v28
 v_cvt_pk_bf16_f32 v51, v24, v25
 v_exp_f32 v19, v101
 v_add_f32 v28, v25, v28
 v_exp_f32 v20, v102
 v_add_f32 v29, v18, v19
 v_cvt_pk_bf16_f32 v52, v18, v19
 v_exp_f32 v21, v103
 v_exp_f32 v22, v108
 v_add_f32 v29, v20, v29
 v_cvt_pk_bf16_f32 v53, v20, v21
 v_exp_f32 v23, v109
 v_add_f32 v29, v21, v29
 v_exp_f32 v24, v110
 v_add_f32 v29, v22, v29
 v_cvt_pk_bf16_f32 v54, v22, v23
 v_exp_f32 v25, v111
 v_add_f32 v29, v23, v29
 v_add_f32 v29, v24, v29
 v_cvt_pk_bf16_f32 v55, v24, v25
 v_add_f32 v29, v25, v29
 v_exp_f32 v18, v112
 v_exp_f32 v19, v113
 v_exp_f32 v20, v114
 v_add_f32 v28, v18, v28
 v_cvt_pk_bf16_f32 v56, v18, v19
 v_exp_f32 v21, v115
 v_add_f32 v28, v19, v28
 v_exp_f32 v22, v120
 v_add_f32 v28, v20, v28
 v_cvt_pk_bf16_f32 v57, v20, v21
 v_exp_f32 v23, v121
 v_add_f32 v28, v21, v28
 v_exp_f32 v24, v122
 v_add_f32 v28, v22, v28
 v_cvt_pk_bf16_f32 v58, v22, v23
 v_exp_f32 v25, v123
 v_add_f32 v28, v23, v28
 v_exp_f32 v18, v116
 v_add_f32 v28, v24, v28
 v_cvt_pk_bf16_f32 v59, v24, v25
 v_exp_f32 v19, v117
 v_add_f32 v28, v25, v28
 v_exp_f32 v20, v118
 v_add_f32 v29, v18, v29
 v_cvt_pk_bf16_f32 v60, v18, v19
 v_exp_f32 v21, v119
 v_add_f32 v29, v19, v29
 v_exp_f32 v22, v124
 v_add_f32 v29, v20, v29
 v_cvt_pk_bf16_f32 v61, v20, v21
 v_exp_f32 v23, v125
 v_add_f32 v29, v21, v29
 v_exp_f32 v24, v126
 v_add_f32 v29, v22, v29
 v_cvt_pk_bf16_f32 v62, v22, v23
 v_exp_f32 v25, v127
 v_add_f32 v29, v23, v29
 v_add_f32 v29, v24, v29
 v_cvt_pk_bf16_f32 v63, v24, v25
 v_add_f32 v29, v25, v29
 s_nop 3
 s_setpc_b64 s[36:37]
L_slow1n:
 s_nop 7
 s_nop 3
 v_max3_f32 v10, v96, v97, v98
 v_max3_f32 v10, v99, v104, v10
 v_max3_f32 v10, v105, v106, v10
 v_max3_f32 v10, v107, v112, v10
 v_max3_f32 v10, v113, v114, v10
 v_max3_f32 v10, v115, v120, v10
 v_max3_f32 v10, v121, v122, v10
 v_max_f32 v10, v123, v10
 v_max3_f32 v11, v100, v101, v102
 v_max3_f32 v11, v103, v108, v11
 v_max3_f32 v11, v109, v110, v11
 v_max3_f32 v11, v111, v116, v11
 v_max3_f32 v11, v117, v118, v11
 v_max3_f32 v11, v119, v124, v11
 v_max3_f32 v11, v125, v126, v11
 v_max_f32 v11, v127, v11
 v_mov_b32 v12, v10
 v_mov_b32 v13, v11
 s_nop 0
 v_permlane16_swap_b32 v12, v10
 v_permlane16_swap_b32 v13, v11
 v_max_f32 v10, v12, v10
 v_max_f32 v11, v13, v11
 v_mov_b32 v12, v10
 v_mov_b32 v13, v11
 s_nop 0
 v_permlane32_swap_b32 v12, v10
 v_permlane32_swap_b32 v13, v11
 v_max_f32 v10, v12, v10
 v_max_f32 v11, v13, v11
 v_ceil_f32 v10, v10
 v_ceil_f32 v11, v11
 v_max_f32 v10, 0, v10
 v_max_f32 v11, 0, v11
 v_sub_f32 v96, v96, v10
 v_sub_f32 v97, v97, v10
 v_sub_f32 v98, v98, v10
 v_sub_f32 v99, v99, v10
 v_sub_f32 v100, v100, v11
 v_sub_f32 v101, v101, v11
 v_sub_f32 v102, v102, v11
 v_sub_f32 v103, v103, v11
 v_sub_f32 v104, v104, v10
 v_sub_f32 v105, v105, v10
 v_sub_f32 v106, v106, v10
 v_sub_f32 v107, v107, v10
 v_sub_f32 v108, v108, v11
 v_sub_f32 v109, v109, v11
 v_sub_f32 v110, v110, v11
 v_sub_f32 v111, v111, v11
 v_sub_f32 v112, v112, v10
 v_sub_f32 v113, v113, v10
 v_sub_f32 v114, v114, v10
 v_sub_f32 v115, v115, v10
 v_sub_f32 v116, v116, v11
 v_sub_f32 v117, v117, v11
 v_sub_f32 v118, v118, v11
 v_sub_f32 v119, v119, v11
 v_sub_f32 v120, v120, v10
 v_sub_f32 v121, v121, v10
 v_sub_f32 v122, v122, v10
 v_sub_f32 v123, v123, v10
 v_sub_f32 v124, v124, v11
 v_sub_f32 v125, v125, v11
 v_sub_f32 v126, v126, v11
 v_sub_f32 v127, v127, v11
 v_sub_f32 v32, v32, v10
 v_sub_f32 v33, v33, v10
 v_sub_f32 v34, v34, v10
 v_sub_f32 v35, v35, v10
 v_sub_f32 v36, v36, v11
 v_sub_f32 v37, v37, v11
 v_sub_f32 v38, v38, v11
 v_sub_f32 v39, v39, v11
 v_exp_f32 v12, -v10
 v_exp_f32 v13, -v11
 v_mul_f32 v30, v12, v30
 v_mul_f32 v31, v13, v31
 v_mul_f32 v128, v12, v128
 v_mul_f32 v129, v12, v129
 v_mul_f32 v130, v12, v130
 v_mul_f32 v131, v12, v131
 v_mul_f32 v132, v13, v132
 v_mul_f32 v133, v13, v133
 v_mul_f32 v134, v13, v134
 v_mul_f32 v135, v13, v135
 v_mul_f32 v136, v12, v136
 v_mul_f32 v137, v12, v137
 v_mul_f32 v138, v12, v138
 v_mul_f32 v139, v12, v139
 v_mul_f32 v140, v13, v140
 v_mul_f32 v141, v13, v141
 v_mul_f32 v142, v13, v142
 v_mul_f32 v143, v13, v143
 v_mul_f32 v144, v12, v144
 v_mul_f32 v145, v12, v145
 v_mul_f32 v146, v12, v146
 v_mul_f32 v147, v12, v147
 v_mul_f32 v148, v13, v148
 v_mul_f32 v149, v13, v149
 v_mul_f32 v150, v13, v150
 v_mul_f32 v151, v13, v151
 v_mul_f32 v152, v12, v152
 v_mul_f32 v153, v12, v153
 v_mul_f32 v154, v12, v154
 v_mul_f32 v155, v12, v155
 v_mul_f32 v156, v13, v156
 v_mul_f32 v157, v13, v157
 v_mul_f32 v158, v13, v158
 v_mul_f32 v159, v13, v159
 v_mul_f32 v160, v12, v160
 v_mul_f32 v161, v12, v161
 v_mul_f32 v162, v12, v162
 v_mul_f32 v163, v12, v163
 v_mul_f32 v164, v13, v164
 v_mul_f32 v165, v13, v165
 v_mul_f32 v166, v13, v166
 v_mul_f32 v167, v13, v167
 v_mul_f32 v168, v12, v168
 v_mul_f32 v169, v12, v169
 v_mul_f32 v170, v12, v170
 v_mul_f32 v171, v12, v171
 v_mul_f32 v172, v13, v172
 v_mul_f32 v173, v13, v173
 v_mul_f32 v174, v13, v174
 v_mul_f32 v175, v13, v175
 v_mul_f32 v176, v12, v176
 v_mul_f32 v177, v12, v177
 v_mul_f32 v178, v12, v178
 v_mul_f32 v179, v12, v179
 v_mul_f32 v180, v13, v180
 v_mul_f32 v181, v13, v181
 v_mul_f32 v182, v13, v182
 v_mul_f32 v183, v13, v183
 v_mul_f32 v184, v12, v184
 v_mul_f32 v185, v12, v185
 v_mul_f32 v186, v12, v186
 v_mul_f32 v187, v12, v187
 v_mul_f32 v188, v13, v188
 v_mul_f32 v189, v13, v189
 v_mul_f32 v190, v13, v190
 v_mul_f32 v191, v13, v191
 v_mul_f32 v192, v12, v192
 v_mul_f32 v193, v12, v193
 v_mul_f32 v194, v12, v194
 v_mul_f32 v195, v12, v195
 v_mul_f32 v196, v13, v196
 v_mul_f32 v197, v13, v197
 v_mul_f32 v198, v13, v198
 v_mul_f32 v199, v13, v199
 v_mul_f32 v200, v12, v200
 v_mul_f32 v201, v12, v201
 v_mul_f32 v202, v12, v202
 v_mul_f32 v203, v12, v203
 v_mul_f32 v204, v13, v204
 v_mul_f32 v205, v13, v205
 v_mul_f32 v206, v13, v206
 v_mul_f32 v207, v13, v207
 v_mul_f32 v208, v12, v208
 v_mul_f32 v209, v12, v209
 v_mul_f32 v210, v12, v210
 v_mul_f32 v211, v12, v211
 v_mul_f32 v212, v13, v212
 v_mul_f32 v213, v13, v213
 v_mul_f32 v214, v13, v214
 v_mul_f32 v215, v13, v215
 v_mul_f32 v216, v12, v216
 v_mul_f32 v217, v12, v217
 v_mul_f32 v218, v12, v218
 v_mul_f32 v219, v12, v219
 v_mul_f32 v220, v13, v220
 v_mul_f32 v221, v13, v221
 v_mul_f32 v222, v13, v222
 v_mul_f32 v223, v13, v223
 v_mul_f32 v224, v12, v224
 v_mul_f32 v225, v12, v225
 v_mul_f32 v226, v12, v226
 v_mul_f32 v227, v12, v227
 v_mul_f32 v228, v13, v228
 v_mul_f32 v229, v13, v229
 v_mul_f32 v230, v13, v230
 v_mul_f32 v231, v13, v231
 v_mul_f32 v232, v12, v232
 v_mul_f32 v233, v12, v233
 v_mul_f32 v234, v12, v234
 v_mul_f32 v235, v12, v235
 v_mul_f32 v236, v13, v236
 v_mul_f32 v237, v13, v237
 v_mul_f32 v238, v13, v238
 v_mul_f32 v239, v13, v239
 v_mul_f32 v240, v12, v240
 v_mul_f32 v241, v12, v241
 v_mul_f32 v242, v12, v242
 v_mul_f32 v243, v12, v243
 v_mul_f32 v244, v13, v244
 v_mul_f32 v245, v13, v245
 v_mul_f32 v246, v13, v246
 v_mul_f32 v247, v13, v247
 v_mul_f32 v248, v12, v248
 v_mul_f32 v249, v12, v249
 v_mul_f32 v250, v12, v250
 v_mul_f32 v251, v12, v251
 v_mul_f32 v252, v13, v252
 v_mul_f32 v253, v13, v253
 v_mul_f32 v254, v13, v254
 v_mul_f32 v255, v13, v255
 v_exp_f32 v18, v96
 v_exp_f32 v19, v97
 v_exp_f32 v20, v98
 v_add_f32 v28, v18, v19
 v_cvt_pk_bf16_f32 v48, v18, v19
 v_exp_f32 v21, v99
 v_exp_f32 v22, v104
 v_add_f32 v28, v20, v28
 v_cvt_pk_bf16_f32 v49, v20, v21
 v_exp_f32 v23, v105
 v_add_f32 v28, v21, v28
 v_exp_f32 v24, v106
 v_add_f32 v28, v22, v28
 v_cvt_pk_bf16_f32 v50, v22, v23
 v_exp_f32 v25, v107
 v_add_f32 v28, v23, v28
 v_exp_f32 v18, v100
 v_add_f32 v28, v24, v28
 v_cvt_pk_bf16_f32 v51, v24, v25
 v_exp_f32 v19, v101
 v_add_f32 v28, v25, v28
 v_exp_f32 v20, v102
 v_add_f32 v29, v18, v19
 v_cvt_pk_bf16_f32 v52, v18, v19
 v_exp_f32 v21, v103
 v_exp_f32 v22, v108
 v_add_f32 v29, v20, v29
 v_cvt_pk_bf16_f32 v53, v20, v21
 v_exp_f32 v23, v109
 v_add_f32 v29, v21, v29
 v_exp_f32 v24, v110
 v_add_f32 v29, v22, v29
 v_cvt_pk_bf16_f32 v54, v22, v23
 v_exp_f32 v25, v111
 v_add_f32 v29, v23, v29
 v_add_f32 v29, v24, v29
 v_cvt_pk_bf16_f32 v55, v24, v25
 v_add_f32 v29, v25, v29
 v_exp_f32 v18, v112
 v_exp_f32 v19, v113
 v_exp_f32 v20, v114
 v_add_f32 v28, v18, v28
 v_cvt_pk_bf16_f32 v56, v18, v19
 v_exp_f32 v21, v115
 v_add_f32 v28, v19, v28
 v_exp_f32 v22, v120
 v_add_f32 v28, v20, v28
 v_cvt_pk_bf16_f32 v57, v20, v21
 v_exp_f32 v23, v121
 v_add_f32 v28, v21, v28
 v_exp_f32 v24, v122
 v_add_f32 v28, v22, v28
 v_cvt_pk_bf16_f32 v58, v22, v23
 v_exp_f32 v25, v123
 v_add_f32 v28, v23, v28
 v_exp_f32 v18, v116
 v_add_f32 v28, v24, v28
 v_cvt_pk_bf16_f32 v59, v24, v25
 v_exp_f32 v19, v117
 v_add_f32 v28, v25, v28
 v_exp_f32 v20, v118
 v_add_f32 v29, v18, v29
 v_cvt_pk_bf16_f32 v60, v18, v19
 v_exp_f32 v21, v119
 v_add_f32 v29, v19, v29
 v_exp_f32 v22, v124
 v_add_f32 v29, v20, v29
 v_cvt_pk_bf16_f32 v61, v20, v21
 v_exp_f32 v23, v125
 v_add_f32 v29, v21, v29
 v_exp_f32 v24, v126
 v_add_f32 v29, v22, v29
 v_cvt_pk_bf16_f32 v62, v22, v23
 v_exp_f32 v25, v127
 v_add_f32 v29, v23, v29
 v_add_f32 v29, v24, v29
 v_cvt_pk_bf16_f32 v63, v24, v25
 v_add_f32 v29, v25, v29
 s_nop 3
 s_setpc_b64 s[36:37]
L_moe0:
 s_call_b64 s[36:37], L_moe
 v_add_f32 v32, v108, v32
 v_add_f32 v33, v109, v33
 v_add_f32 v34, v110, v34
 v_add_f32 v35, v111, v35
 v_add_f32 v36, v112, v36
 v_add_f32 v37, v113, v37
 v_add_f32 v38, v114, v38
 v_add_f32 v39, v115, v39
 v_add_f32 v40, v116, v40
 v_add_f32 v41, v117, v41
 v_add_f32 v42, v118, v42
 v_add_f32 v43, v119, v43
 v_add_f32 v44, v120, v44
 v_add_f32 v45, v121, v45
 v_add_f32 v46, v122, v46
 v_add_f32 v47, v123, v47
 s_mov_b64 exec, -1
 s_branch L_moe_ret0
L_moe1:
 s_call_b64 s[36:37], L_moe
 v_add_f32 v80, v108, v80
 v_add_f32 v81, v109, v81
 v_add_f32 v82, v110, v82
 v_add_f32 v83, v111, v83
 v_add_f32 v84, v112, v84
 v_add_f32 v85, v113, v85
 v_add_f32 v86, v114, v86
 v_add_f32 v87, v115, v87
 v_add_f32 v88, v116, v88
 v_add_f32 v89, v117, v89
 v_add_f32 v90, v118, v90
 v_add_f32 v91, v119, v91
 v_add_f32 v92, v120, v92
 v_add_f32 v93, v121, v93
 v_add_f32 v94, v122, v94
 v_add_f32 v95, v123, v95
 s_mov_b64 exec, -1
 s_branch L_moe_ret1
L_moe:
 v_min_u32 v104, 27, v0
 v_lshlrev_b32 v104, 2, v104
 s_mov_b32 s64, 105062912
 s_mov_b32 s65, 65536
 s_mov_b32 exec_lo, 0xffffffff
 s_mov_b32 exec_hi, 0xffffffff
L_pfy:
 buffer_load_dword v105, v104, s[8:11], s64 offen sc1
 s_sub_u32 s65, s65, 1
 s_cbranch_scc1 L_pfy_x
 s_waitcnt vmcnt(0)
 v_cmp_ne_u32 vcc, 1, v105
 s_nop 0
 s_cbranch_vccz L_pfy_x
 s_sleep 2
 s_branch L_pfy
L_pfy_x:
 s_waitcnt vmcnt(0)
 s_mov_b64 exec, -1
 s_or_b64 exec, s[80:81], s[82:83]
 v_mov_b32 v104, 1792
 v_cndmask_b32 v104, v104, 0, s[80:81]
 v_lshl_add_u32 v104, v11, 5, v104
 s_lshl_b32 s88, s75, 1
 s_add_u32 s88, s88, 104898560
 buffer_load_dwordx4 v[108:111], v104, s[8:11], s88 offen sc1
 buffer_load_dwordx4 v[112:115], v104, s[8:11], s88 offen offset:16 sc1
 buffer_load_dwordx4 v[116:119], v104, s[8:11], s88 offen offset:512 sc1
 buffer_load_dwordx4 v[120:123], v104, s[8:11], s88 offen offset:528 sc1
 s_waitcnt vmcnt(0)
 s_setpc_b64 s[36:37]
L_yred:
 s_lshl_b32 s89, s41, 1
 s_add_u32 s89, s89, s20
 s_cmp_ge_u32 s89, 28
 s_cbranch_scc1 L_yred_ret
 v_lshrrev_b32 v20, 4, v7
 v_lshrrev_b32 v21, 3, v20
 v_mul_u32_u24 v21, 4352, v21
 v_and_b32 v22, 7, v20
 v_lshl_add_u32 v21, v22, 7, v21
 s_mov_b32 s64, 104923136
 s_mov_b32 s88, 104957952
 s_mov_b32 s91, 65536
L_yp:
 buffer_load_dword v22, v21, s[8:11], s64 offen sc1
 buffer_load_dword v23, v21, s[8:11], s88 offen sc1
 s_waitcnt vmcnt(0)
 v_min_u32 v22, v22, v23
 v_cmp_gt_u32 vcc, 4, v22
 s_sub_u32 s91, s91, 1
 s_cbranch_scc1 L_ypx
 s_cbranch_vccnz L_yp
L_ypx:
 s_cmp_lt_u32 s89, 14
 s_cselect_b32 s64, 8, 12
 s_add_u32 s64, s64, 104890368
 buffer_load_dword v23, off, s[8:11], s64 sc1
 v_lshrrev_b32 v21, 3, v20
 v_mul_u32_u24 v21, 3584, v21
 v_and_b32 v22, 7, v20
 v_lshl_add_u32 v21, v22, 4, v21
 s_lshl_b32 s88, s89, 7
 s_add_u32 s90, s88, 104898560
 s_add_u32 s88, s88, 105906176
 buffer_load_dwordx4 v[64:67], v21, s[8:11], s88 offen sc1
 s_add_u32 s88, s88, 28672
 buffer_load_dwordx4 v[68:71], v21, s[8:11], s88 offen sc1
 s_add_u32 s88, s88, 28672
 buffer_load_dwordx4 v[72:75], v21, s[8:11], s88 offen sc1
 s_add_u32 s88, s88, 28672
 buffer_load_dwordx4 v[76:79], v21, s[8:11], s88 offen sc1
 s_add_u32 s88, s88, 28672
 buffer_load_dwordx4 v[80:83], v21, s[8:11], s88 offen sc1
 s_add_u32 s88, s88, 28672
 buffer_load_dwordx4 v[84:87], v21, s[8:11], s88 offen sc1
 s_add_u32 s88, s88, 28672
 buffer_load_dwordx4 v[88:91], v21, s[8:11], s88 offen sc1
 s_add_u32 s88, s88, 28672
 buffer_load_dwordx4 v[92:95], v21, s[8:11], s88 offen sc1
 s_add_u32 s88, s88, 28672
 buffer_load_dwordx4 v[96:99], v21, s[8:11], s88 offen sc1
 s_add_u32 s88, s88, 28672
 buffer_load_dwordx4 v[100:103], v21, s[8:11], s88 offen sc1
 s_add_u32 s88, s88, 28672
 buffer_load_dwordx4 v[104:107], v21, s[8:11], s88 offen sc1
 s_add_u32 s88, s88, 28672
 buffer_load_dwordx4 v[108:111], v21, s[8:11], s88 offen sc1
 s_add_u32 s88, s88, 28672
 buffer_load_dwordx4 v[112:115], v21, s[8:11], s88 offen sc1
 s_add_u32 s88, s88, 28672
 buffer_load_dwordx4 v[116:119], v21, s[8:11], s88 offen sc1
 s_add_u32 s88, s88, 28672
 s_branch L_yred_ret
L_yred2:
 s_cmp_ge_u32 s89, 28
 s_cbranch_scc1 L_yred2_ret
 v_mov_b32 v22, 1
 s_waitcnt vmcnt(0)
 v_add_f32 v64, v68, v64
 v_add_f32 v65, v69, v65
 v_add_f32 v66, v70, v66
 v_add_f32 v67, v71, v67
 v_add_f32 v64, v72, v64
 v_add_f32 v65, v73, v65
 v_add_f32 v66, v74, v66
 v_add_f32 v67, v75, v67
 v_add_f32 v64, v76, v64
 v_add_f32 v65, v77, v65
 v_add_f32 v66, v78, v66
 v_add_f32 v67, v79, v67
 v_add_f32 v64, v80, v64
 v_add_f32 v65, v81, v65
 v_add_f32 v66, v82, v66
 v_add_f32 v67, v83, v67
 v_add_f32 v64, v84, v64
 v_add_f32 v65, v85, v65
 v_add_f32 v66, v86, v66
 v_add_f32 v67, v87, v67
 v_add_f32 v64, v88, v64
 v_add_f32 v65, v89, v65
 v_add_f32 v66, v90, v66
 v_add_f32 v67, v91, v67
 v_add_f32 v64, v92, v64
 v_add_f32 v65, v93, v65
 v_add_f32 v66, v94, v66
 v_add_f32 v67, v95, v67
 v_add_f32 v64, v96, v64
 v_add_f32 v65, v97, v65
 v_add_f32 v66, v98, v66
 v_add_f32 v67, v99, v67
 v_add_f32 v64, v100, v64
 v_add_f32 v65, v101, v65
 v_add_f32 v66, v102, v66
 v_add_f32 v67, v103, v67
 v_add_f32 v64, v104, v64
 v_add_f32 v65, v105, v65
 v_add_f32 v66, v106, v66
 v_add_f32 v67, v107, v67
 v_add_f32 v64, v108, v64
 v_add_f32 v65, v109, v65
 v_add_f32 v66, v110, v66
 v_add_f32 v67, v111, v67
 v_add_f32 v64, v112, v64
 v_add_f32 v65, v113, v65
 v_add_f32 v66, v114, v66
 v_add_f32 v67, v115, v67
 v_add_f32 v64, v116, v64
 v_add_f32 v65, v117, v65
 v_add_f32 v66, v118, v66
 v_add_f32 v67, v119, v67
 v_add_f32 v64, v64, v64 row_ror:8 row_mask:0xf bank_mask:0xf
 v_add_f32 v65, v65, v65 row_ror:8 row_mask:0xf bank_mask:0xf
 v_add_f32 v66, v66, v66 row_ror:8 row_mask:0xf bank_mask:0xf
 v_add_f32 v67, v67, v67 row_ror:8 row_mask:0xf bank_mask:0xf
 v_mov_b32 v68, v64
 v_mov_b32 v69, v65
 v_mov_b32 v70, v66
 v_mov_b32 v71, v67
 v_permlane16_swap_b32 v68, v64
 v_permlane16_swap_b32 v69, v65
 v_permlane16_swap_b32 v70, v66
 v_permlane16_swap_b32 v71, v67
 v_add_f32 v64, v68, v64
 v_add_f32 v65, v69, v65
 v_add_f32 v66, v70, v66
 v_add_f32 v67, v71, v67
 v_mov_b32 v68, v64
 v_mov_b32 v69, v65
 v_mov_b32 v70, v66
 v_mov_b32 v71, v67
 v_permlane32_swap_b32 v68, v64
 v_permlane32_swap_b32 v69, v65
 v_permlane32_swap_b32 v70, v66
 v_permlane32_swap_b32 v71, v67
 v_add_f32 v64, v68, v64
 v_add_f32 v65, v69, v65
 v_add_f32 v66, v70, v66
 v_add_f32 v67, v71, v67
 v_cvt_pk_bf16_f32 v21, v64, v65
 v_lshlrev_b32 v64, 16, v21
 v_and_b32 v65, 0xffff0000, v21
 v_cvt_pk_bf16_f32 v21, v66, v67
 v_lshlrev_b32 v66, 16, v21
 v_and_b32 v67, 0xffff0000, v21
 v_mul_f32 v64, v23, v64
 v_mul_f32 v65, v23, v65
 v_mul_f32 v66, v23, v66
 v_mul_f32 v67, v23, v67
 v_cvt_pk_bf16_f32 v21, v64, v65
 v_lshlrev_b32 v64, 16, v21
 v_and_b32 v65, 0xffff0000, v21
 v_cvt_pk_bf16_f32 v21, v66, v67
 v_lshlrev_b32 v66, 16, v21
 v_and_b32 v67, 0xffff0000, v21
 s_mov_b64 exec, 0xff
 buffer_store_dwordx4 v[64:67], v7, s[8:11], s90 offen sc1
 s_lshl_b32 s89, s89, 2
 s_add_u32 s89, s89, 105062912
 s_mov_b64 exec, 1
 s_waitcnt vmcnt(0)
 buffer_store_dword v22, off, s[8:11], s89 sc1
 s_mov_b64 exec, -1
 s_branch L_yred2_ret
L_fll:
 buffer_load_dword v5, v9, s[8:11], s46 offen sc1
 s_cmp_eq_u32 s7, 1
 s_cselect_b32 s6, 2, 4
 s_branch L_fllr
L_fl4:
 v_mov_b32 v17, s4
 buffer_store_dword v17, v1, s[8:11], s45 offen sc1
 s_branch L_fl4r
 s_waitcnt vmcnt(0)
L_fhs0:
 s_mov_b32 s91, 65536
L_fhs0_l:
 s_sleep 2
 buffer_load_dword v24, off, s[8:11], s79 sc1
 s_sub_u32 s91, s91, 1
 s_cbranch_scc1 L_fhs0_x
 s_waitcnt vmcnt(0)
 v_cmp_gt_u32 vcc, 4, v24
 s_nop 0
 s_cbranch_vccnz L_fhs0_l
L_fhs0_x:
 s_waitcnt vmcnt(0)
 s_branch L_fhr0
L_fhs1:
 s_mov_b32 s91, 65536
L_fhs1_l:
 s_sleep 2
 buffer_load_dword v24, off, s[8:11], s79 sc1
 s_sub_u32 s91, s91, 1
 s_cbranch_scc1 L_fhs1_x
 s_waitcnt vmcnt(0)
 v_cmp_gt_u32 vcc, 4, v24
 s_nop 0
 s_cbranch_vccnz L_fhs1_l
L_fhs1_x:
 s_waitcnt vmcnt(0)
 s_branch L_fhr1
L_fps0:
 s_mov_b32 s91, 65536
L_fps0_l:
 s_sleep 2
 buffer_load_dword v5, off, s[8:11], s47 sc1
 s_sub_u32 s91, s91, 1
 s_cbranch_scc1 L_fps0_x
 s_waitcnt vmcnt(0)
 v_cmp_ne_u32 vcc, 1, v5
 s_nop 0
 s_cbranch_vccnz L_fps0_l
L_fps0_x:
 s_waitcnt vmcnt(0)
 s_branch L_fpr0
L_f3s0:
 s_mov_b32 s91, 65536
L_f3s0_l:
 s_sleep 2
 buffer_load_dword v6, v9, s[8:11], s46 offen sc1
 s_sub_u32 s91, s91, 1
 s_cbranch_scc1 L_f3s0_x
 s_waitcnt vmcnt(0)
 v_cmp_gt_u32 vcc, 3, v6
 s_nop 0
 s_cbranch_vccnz L_f3s0_l
L_f3s0_x:
 s_waitcnt vmcnt(0)
 s_branch L_f3r0
L_f3s1:
 s_mov_b32 s91, 65536
L_f3s1_l:
 s_sleep 2
 buffer_load_dword v6, v9, s[8:11], s46 offen sc1
 s_sub_u32 s91, s91, 1
 s_cbranch_scc1 L_f3s1_x
 s_waitcnt vmcnt(0)
 v_cmp_gt_u32 vcc, 3, v6
 s_nop 0
 s_cbranch_vccnz L_f3s1_l
L_f3s1_x:
 s_waitcnt vmcnt(0)
 s_branch L_f3r1
L_fls0:
 s_mov_b32 s91, 65536
L_fls0_l:
 s_sleep 2
 buffer_load_dword v5, v9, s[8:11], s46 offen sc1
 s_sub_u32 s91, s91, 1
 s_cbranch_scc1 L_fls0_x
 s_waitcnt vmcnt(0)
 v_cmp_gt_u32 vcc, s6, v5
 s_nop 0
 s_cbranch_vccnz L_fls0_l
L_fls0_x:
 s_waitcnt vmcnt(0)
 s_branch L_flr0
L_code_end:
.section .rodata,"a"
.p2align 6
.amdhsa_kernel gated_mix__compressed_kv_cla__moe_arch_mod__prompt_kernel
  .amdhsa_next_free_vgpr 512
  .amdhsa_next_free_sgpr 102
  .amdhsa_accum_offset 256
  .amdhsa_group_segment_fixed_size 0
  .amdhsa_kernarg_size 120
  .amdhsa_user_sgpr_count 2
  .amdhsa_user_sgpr_kernarg_segment_ptr 1
  .amdhsa_system_sgpr_workgroup_id_x 1
  .amdhsa_float_denorm_mode_32 3
.end_amdhsa_kernel
```

```asm
; @launch grid=(256,1,1) block=(256,1,1) lds=163840
.amdgcn_target "amdgcn-amd-amdhsa--gfx950"
.text
.macro M a, b, c, d
v_mfma_f32_16x16x32_bf16 \a, \b, \c, \d
.endm
.macro R a, b, c
ds_read_b128 \a, \b offset:\c
.endm
.macro T a, b, c
ds_read_b64_tr_b16 \a, \b offset:\c
.endm
.macro C a, b, c
v_cvt_pk_bf16_f32 \a, \b, \c
.endm
.macro E a, b
v_exp_f32 \a, \b
.endm
.macro W a, b
v_accvgpr_write_b32 \a, \b
.endm
.macro G a, b
v_accvgpr_read_b32 \a, \b
.endm
.macro AF a, b, c
v_add_f32 \a, \b, \c
.endm
.macro MF a, b, c
v_mul_f32 \a, \b, \c
.endm
.macro SA a, b, c
s_add_u32 \a, \b, \c
.endm
.globl gated_mix__compressed_kv_cla__moe_arch_mod__prompt_kernel
.p2align 8
.type gated_mix__compressed_kv_cla__moe_arch_mod__prompt_kernel,@function
gated_mix__compressed_kv_cla__moe_arch_mod__prompt_kernel:
s_cmp_lt_u32 s2, 256
s_cbranch_scc1 L_go
s_endpgm
L_go:
s_load_dwordx8 s[80:87], s[0:1], 0
s_load_dwordx4 s[88:91], s[0:1], 32
s_getpc_b64 s[76:77]
L_pc0:
s_lshr_b32 s42, s2, 3
s_mov_b32 s79, 0x20000
s_lshl_b32 s67, s42, 13
s_mov_b32 s78, L_code_end-L_pc0
s_and_b32 s77, s77, 0xffff
v_lshl_add_u32 v31, v0, 5, s67
buffer_load_dword a240, v31, s[76:79], 0 offen offset:0
v_lshrrev_b32 v24, 6, v0
v_and_b32 v0, 63, v0
s_and_b32 s41, s2, 7
v_readfirstlane_b32 s20, v24
s_lshr_b32 s64, s2, 7
v_and_b32 v24, 15, v0
v_lshrrev_b32 v25, 4, v0
s_lshl_b32 s64, s64, 3
SA s41,s41,s64
s_and_b32 s42, s42, 15
s_lshr_b32 s45, s42, 3
v_lshlrev_b32 v28, 1, v25
v_xor_b32 v28, v28, v24
v_and_b32 v29, 8, v28
v_and_b32 v28, 7, v28
v_lshlrev_b32 v28, 4, v28
v_lshl_add_u32 v28, v29, 5, v28
v_lshl_add_u32 v28, v25, 13, v28
s_lshl_b32 s64, s20, 17
v_add_u32 v8, s64, v28
v_xor_b32 v28, 0x100, v8
v_add_u32 v9, 31744, v8
v_add_u32 v10, 63488, v28
v_add_u32 v11, 95232, v28
s_and_b32 s65, s20, 1
s_lshr_b32 s66, s20, 1
v_and_b32 v29, 7, v0
v_xor_b32 v28, v25, v29
v_lshlrev_b32 v28, 4, v28
v_lshrrev_b32 v29, 3, v0
v_lshl_add_u32 v30, v29, 11, v28
s_lshl_b32 s64, s66, 19
s_lshl_b32 s67, s65, 21
SA s64,s64,s67
v_add_u32 v12, s64, v30
v_xor_b32 v30, 64, v12
v_add_u32 v14, 30720, v12
v_add_u32 v13, 15360, v30
v_add_u32 v15, 46080, v30
s_mov_b32 s21, 0
s_mov_b32 s22, 0
s_lshl_b32 s23, s20, 12
SA s24,s23,65536
s_lshl_b32 s74, s41, 9
s_sub_u32 s18, 8388608, s74
s_mov_b32 s19, 0x20000
s_and_b32 s64, s42, 7
s_lshl_b32 s64, s64, 16
s_sub_u32 s50, 4194304, s64
s_mov_b32 s51, 0x20000
s_cmp_eq_u32 s45, 0
s_waitcnt lgkmcnt(0)
s_cselect_b32 s72, s86, s88
s_cselect_b32 s73, s87, s89
SA s16,s72,s74
s_addc_u32 s73, s73, 0
s_and_b32 s17, s73, 0xffff
SA s48,s82,s64
s_addc_u32 s73, s83, 0
s_and_b32 s49, s73, 0xffff
SA m0,s23,0
s_nop 0
buffer_load_dwordx4 v8, s[16:19], s21 offen offset:0  nt lds
buffer_load_dwordx4 v9, s[16:19], s21 offen offset:1024  nt lds
buffer_load_dwordx4 v10, s[16:19], s21 offen offset:2048  nt lds
buffer_load_dwordx4 v11, s[16:19], s21 offen offset:3072  nt lds
SA s21,s21,128
SA m0,s24,0
s_nop 0
buffer_load_dwordx4 v12, s[48:51], s22 offen offset:0   lds
buffer_load_dwordx4 v13, s[48:51], s22 offen offset:1024   lds
buffer_load_dwordx4 v14, s[48:51], s22 offen offset:2048   lds
buffer_load_dwordx4 v15, s[48:51], s22 offen offset:3072   lds
SA s22,s22,1048576
SA m0,s23,16384
s_nop 0
buffer_load_dwordx4 v8, s[16:19], s21 offen offset:0  nt lds
buffer_load_dwordx4 v9, s[16:19], s21 offen offset:1024  nt lds
buffer_load_dwordx4 v10, s[16:19], s21 offen offset:2048  nt lds
buffer_load_dwordx4 v11, s[16:19], s21 offen offset:3072  nt lds
SA s21,s21,524160
s_load_dwordx2 s[92:93], s[0:1], 56
s_load_dwordx2 s[94:95], s[0:1], 88
s_load_dwordx4 s[4:7], s[0:1], 104
v_lshlrev_b32 v7, 4, v0
v_lshrrev_b32 v26, 2, v24
v_and_b32 v28, 1, v25
v_lshl_or_b32 v28, v28, 2, v26
v_lshl_add_u32 v29, v25, 3, v26
v_lshlrev_b32 v29, 8, v29
v_and_b32 v30, 3, v0
v_lshl_add_u32 v29, v30, 3, v29
s_lshl_b32 s64, s65, 2
SA s64,s64,0
v_xor_b32 v30, s64, v28
v_lshl_add_u32 v1, v30, 5, v29
s_lshl_b32 s64, s65, 2
SA s64,s64,1
v_xor_b32 v30, s64, v28
v_lshl_add_u32 v2, v30, 5, v29
s_lshl_b32 s64, s65, 2
SA s64,s64,2
v_xor_b32 v30, s64, v28
v_lshl_add_u32 v3, v30, 5, v29
s_lshl_b32 s64, s65, 2
SA s64,s64,3
v_xor_b32 v30, s64, v28
v_lshl_add_u32 v4, v30, 5, v29
v_add_u32 v28, 0, v25
v_lshrrev_b32 v29, 1, v24
v_xor_b32 v28, v28, v29
v_lshlrev_b32 v28, 4, v28
v_lshl_add_u32 v28, v24, 7, v28
s_lshl_b32 s64, s66, 13
SA s64,s64,65536
v_add_u32 v5, s64, v28
v_add_u32 v28, 4, v25
v_lshrrev_b32 v29, 1, v24
v_xor_b32 v28, v28, v29
v_lshlrev_b32 v28, 4, v28
v_lshl_add_u32 v28, v24, 7, v28
s_lshl_b32 s64, s66, 13
SA s64,s64,65536
v_add_u32 v6, s64, v28
s_mov_b32 s56, s80
s_and_b32 s57, s81, 0xffff
s_mov_b32 s58, 1835008
s_mov_b32 s59, 0x20000
s_waitcnt lgkmcnt(0)
s_mov_b32 s60, s92
s_and_b32 s61, s93, 0xffff
s_mov_b32 s62, 896
s_mov_b32 s63, 0x20000
s_mov_b32 s68, s94
s_and_b32 s69, s95, 0xffff
s_mov_b32 s70, 896
s_mov_b32 s71, 0x20000
s_lshl_b32 s95, s20, 11
s_lshr_b32 s64, s2, 3
s_lshl_b32 s64, s64, 13
SA s95,s95,s64
s_mov_b32 s8, s6
s_and_b32 s9, s7, 0xffff
s_mov_b32 s10, 268435456
s_mov_b32 s11, 0x20000
s_mov_b32 s12, s4
s_and_b32 s13, s5, 0xffff
s_mov_b32 s14, 256
s_mov_b32 s15, 0x20000
SA s72,s84,s74
s_addc_u32 s73, s85, 0
s_sub_u32 s75, 3670016, s74
s_mov_b32 s52, s72
s_and_b32 s53, s73, 0xffff
s_mov_b32 s54, s75
s_mov_b32 s55, 0x20000
s_mul_i32 s29, s42, 114688
s_mov_b32 s5, 0x3db8aa3b
s_mul_i32 s72, s45, 16777216
s_mul_i32 s73, s41, 1048576
SA s72,s72,s73
s_bfe_u32 s64, s42, 0x20001
s_lshl_b32 s64, s64, 15
SA s72,s72,s64
s_lshl_b32 s64, s66, 17
SA s72,s72,s64
s_and_b32 s67, s42, 1
s_cmp_eq_u32 s45, 0
s_cselect_b32 s64, 12, 14
s_cselect_b32 s75, 14, 10
s_lshl_b32 s67, s67, s75
SA s72,s72,s67
s_lshl_b32 s64, s65, s64
SA s93,s72,s64
s_load_dwordx4 s[80:83], s[0:1], 64
s_load_dwordx2 s[84:85], s[0:1], 80
s_load_dwordx2 s[96:97], s[0:1], 96
s_cmp_eq_u32 s45, 0
s_cbranch_scc0 L_kv1
s_branch L_kv0
.p2align 12
L_kv0:
s_and_b32 s31, s42, 7
s_lshl_b32 s64, s42, 4
SA s64,s64,s41
s_lshl_b32 s64, s64, 2
SA s64,s64,s20
s_cmp_lt_u32 s64, 41
s_cselect_b32 s39, 0, 536870912
s_min_u32 s64, s64, 41
s_lshl_b32 s38, s64, 2
s_max_u32 s67, s64, 8
s_sub_u32 s67, s67, 8
s_mul_i32 s67, s67, 3328
s_lshl_b32 s64, s64, 10
SA s64,s64,s67
SA s73,s64,104914944
v_or_b32 v64, s39, v7
v_mov_b32 v68, 0
v_mov_b32 v69, 0
v_mov_b32 v70, 0
v_mov_b32 v71, 0
buffer_store_dwordx4 v[68:71], v64, s[8:11], s73 offen offset:0 sc1
buffer_store_dwordx4 v[68:71], v64, s[8:11], s73 offen offset:1024 sc1
buffer_store_dwordx4 v[68:71], v64, s[8:11], s73 offen offset:2048 sc1
SA m0,s23,32768
s_nop 0
buffer_load_dwordx4 v8, s[16:19], s21 offen offset:0  nt lds
buffer_load_dwordx4 v9, s[16:19], s21 offen offset:1024  nt lds
buffer_load_dwordx4 v10, s[16:19], s21 offen offset:2048  nt lds
buffer_load_dwordx4 v11, s[16:19], s21 offen offset:3072  nt lds
SA s21,s21,128
SA m0,s24,16384
s_nop 0
buffer_load_dwordx4 v12, s[48:51], s22 offen offset:0   lds
buffer_load_dwordx4 v13, s[48:51], s22 offen offset:1024   lds
buffer_load_dwordx4 v14, s[48:51], s22 offen offset:2048   lds
buffer_load_dwordx4 v15, s[48:51], s22 offen offset:3072   lds
s_sub_u32 s22, s22, 1048448
s_mov_b64 exec, 0
s_cmp_eq_u32 s20, 0
s_cbranch_scc1 L_w_kv01
s_cmp_eq_u32 s20, 1
s_cbranch_scc1 L_w_kv02
s_cmp_eq_u32 s20, 2
s_cbranch_scc1 L_w_kv03
s_branch L_w_kv04
L_wd1:
s_mov_b64 exec, -1
s_waitcnt vmcnt(11) lgkmcnt(0)
s_barrier
R a[160:163],v5,0
R a[164:167],v6,0
T a[96:97],v1,0
T a[98:99],v1,1024
T a[100:101],v1,8192
T a[102:103],v1,9216
T a[104:105],v2,0
T a[106:107],v2,1024
T a[108:109],v2,8192
T a[110:111],v2,9216
T a[112:113],v3,0
T a[114:115],v3,1024
T a[116:117],v3,8192
T a[118:119],v3,9216
T a[120:121],v4,0
T a[122:123],v4,1024
T a[124:125],v4,8192
T a[126:127],v4,9216
T a[128:129],v1,16384
T a[130:131],v1,17408
T a[132:133],v1,24576
T a[134:135],v1,25600
T a[136:137],v2,16384
T a[138:139],v2,17408
T a[140:141],v2,24576
T a[142:143],v2,25600
T a[144:145],v3,16384
T a[146:147],v3,17408
T a[148:149],v3,24576
T a[150:151],v3,25600
T a[152:153],v4,16384
T a[154:155],v4,17408
T a[156:157],v4,24576
T a[158:159],v4,25600
s_waitcnt lgkmcnt(15)
M a[0:3],a[96:99],a[160:163],0
SA m0,s23,49152
R a[168:171],v5,2048
R a[172:175],v6,2048
M a[0:3],a[100:103],a[164:167],a[0:3]
buffer_load_dwordx4 v8, s[16:19], s21 offen offset:0  nt lds
M a[4:7],a[108:111],a[164:167],0
M a[4:7],a[104:107],a[160:163],a[4:7]
M a[8:11],a[112:115],a[160:163],0
buffer_load_dwordx4 v9, s[16:19], s21 offen offset:1024  nt lds
M a[8:11],a[116:119],a[164:167],a[8:11]
s_waitcnt lgkmcnt(14)
M a[12:15],a[124:127],a[164:167],0
M a[12:15],a[120:123],a[160:163],a[12:15]
buffer_load_dwordx4 v10, s[16:19], s21 offen offset:2048  nt lds
M a[16:19],a[128:131],a[160:163],0
M a[16:19],a[132:135],a[164:167],a[16:19]
s_waitcnt lgkmcnt(6)
M a[20:23],a[140:143],a[164:167],0
buffer_load_dwordx4 v11, s[16:19], s21 offen offset:3072  nt lds
M a[20:23],a[136:139],a[160:163],a[20:23]
SA s21,s21,524160
M a[24:27],a[144:147],a[160:163],0
M a[24:27],a[148:151],a[164:167],a[24:27]
s_waitcnt lgkmcnt(0)
M a[28:31],a[156:159],a[164:167],0
s_waitcnt vmcnt(8)
M a[28:31],a[152:155],a[160:163],a[28:31]
s_barrier
M v[32:35],a[96:99],a[168:171],0
SA m0,s24,32768
R a[160:163],v5,4096
R a[164:167],v6,4096
M v[32:35],a[100:103],a[172:175],v[32:35]
T a[32:33],v1,32768
T a[34:35],v1,33792
M v[36:39],a[108:111],a[172:175],0
buffer_load_dwordx4 v12, s[48:51], s22 offen offset:0   lds
M v[36:39],a[104:107],a[168:171],v[36:39]
M v[40:43],a[112:115],a[168:171],0
s_nop 0
T a[36:37],v1,40960
T a[38:39],v1,41984
M v[40:43],a[116:119],a[172:175],v[40:43]
buffer_load_dwordx4 v13, s[48:51], s22 offen offset:1024   lds
M v[44:47],a[124:127],a[172:175],0
M v[44:47],a[120:123],a[168:171],v[44:47]
s_nop 0
T a[40:41],v2,32768
T a[42:43],v2,33792
M v[48:51],a[128:131],a[168:171],0
buffer_load_dwordx4 v14, s[48:51], s22 offen offset:2048   lds
M v[48:51],a[132:135],a[172:175],v[48:51]
M v[52:55],a[140:143],a[172:175],0
s_nop 0
T a[44:45],v2,40960
T a[46:47],v2,41984
M v[52:55],a[136:139],a[168:171],v[52:55]
buffer_load_dwordx4 v15, s[48:51], s22 offen offset:3072   lds
M v[56:59],a[144:147],a[168:171],0
SA s22,s22,1048576
M v[56:59],a[148:151],a[172:175],v[56:59]
s_waitcnt lgkmcnt(8)
s_nop 0
T a[48:49],v3,32768
T a[50:51],v3,33792
M v[60:63],a[156:159],a[172:175],0
SA m0,s23,0
M v[60:63],a[152:155],a[168:171],v[60:63]
buffer_load_dwordx4 v8, s[16:19], s21 offen offset:0  nt lds
M v[64:67],a[96:99],a[160:163],0
R a[168:171],v5,6144
R a[172:175],v6,6144
M v[64:67],a[100:103],a[164:167],v[64:67]
T a[52:53],v3,40960
T a[54:55],v3,41984
M v[68:71],a[108:111],a[164:167],0
M v[68:71],a[104:107],a[160:163],v[68:71]
s_nop 0
T a[56:57],v4,32768
T a[58:59],v4,33792
M v[72:75],a[112:115],a[160:163],0
buffer_load_dwordx4 v9, s[16:19], s21 offen offset:1024  nt lds
M v[72:75],a[116:119],a[164:167],v[72:75]
M v[76:79],a[124:127],a[164:167],0
s_nop 0
T a[60:61],v4,40960
T a[62:63],v4,41984
M v[76:79],a[120:123],a[160:163],v[76:79]
buffer_load_dwordx4 v10, s[16:19], s21 offen offset:2048  nt lds
M v[80:83],a[128:131],a[160:163],0
M v[80:83],a[132:135],a[164:167],v[80:83]
M v[84:87],a[140:143],a[164:167],0
buffer_load_dwordx4 v11, s[16:19], s21 offen offset:3072  nt lds
M v[84:87],a[136:139],a[160:163],v[84:87]
SA s21,s21,128
M v[88:91],a[144:147],a[160:163],0
M v[88:91],a[148:151],a[164:167],v[88:91]
s_waitcnt lgkmcnt(6)
M v[92:95],a[156:159],a[164:167],0
s_waitcnt vmcnt(8) lgkmcnt(0)
M v[92:95],a[152:155],a[160:163],v[92:95]
s_barrier
M v[96:99],a[96:99],a[168:171],0
SA m0,s24,49152
R a[160:163],v5,16384
R a[164:167],v6,16384
M v[96:99],a[100:103],a[172:175],v[96:99]
buffer_load_dwordx4 v12, s[48:51], s22 offen offset:0   lds
M v[100:103],a[108:111],a[172:175],0
s_nop 0
T a[64:65],v1,49152
T a[66:67],v1,50176
M v[100:103],a[104:107],a[168:171],v[100:103]
v_lshlrev_b32 v26, 7, v0
v_and_b32 v27, 48, v0
M v[104:107],a[112:115],a[168:171],0
buffer_load_dwordx4 v13, s[48:51], s22 offen offset:1024   lds
M v[104:107],a[116:119],a[172:175],v[104:107]
v_lshl_add_u32 v26, v27, 24, v26
M v[108:111],a[124:127],a[172:175],0
M v[108:111],a[120:123],a[168:171],v[108:111]
M v[112:115],a[128:131],a[168:171],0
buffer_load_dwordx4 v14, s[48:51], s22 offen offset:2048   lds
M v[112:115],a[132:135],a[172:175],v[112:115]
s_nop 0
T a[68:69],v1,57344
T a[70:71],v1,58368
M v[116:119],a[140:143],a[172:175],0
M v[116:119],a[136:139],a[168:171],v[116:119]
M v[120:123],a[144:147],a[168:171],0
buffer_load_dwordx4 v15, s[48:51], s22 offen offset:3072   lds
M v[120:123],a[148:151],a[172:175],v[120:123]
s_waitcnt lgkmcnt(4)
M v[124:127],a[156:159],a[172:175],0
s_sub_u32 s22, s22, 1048448
M v[124:127],a[152:155],a[168:171],v[124:127]
SA m0,s23,16384
M v[128:131],a[96:99],a[160:163],0
R a[168:171],v5,18432
R a[172:175],v6,18432
M v[128:131],a[100:103],a[164:167],v[128:131]
T a[72:73],v2,49152
T a[74:75],v2,50176
M v[132:135],a[108:111],a[164:167],0
buffer_load_dwordx4 v8, s[16:19], s21 offen offset:0  nt lds
M v[132:135],a[104:107],a[160:163],v[132:135]
M v[136:139],a[112:115],a[160:163],0
buffer_load_dwordx4 v9, s[16:19], s21 offen offset:1024  nt lds
M v[136:139],a[116:119],a[164:167],v[136:139]
M v[140:143],a[124:127],a[164:167],0
M v[140:143],a[120:123],a[160:163],v[140:143]
s_nop 0
T a[76:77],v2,57344
T a[78:79],v2,58368
M v[144:147],a[128:131],a[160:163],0
buffer_load_dwordx4 v10, s[16:19], s21 offen offset:2048  nt lds
M v[144:147],a[132:135],a[164:167],v[144:147]
M v[148:151],a[140:143],a[164:167],0
M v[148:151],a[136:139],a[160:163],v[148:151]
buffer_load_dwordx4 v11, s[16:19], s21 offen offset:3072  nt lds
M v[152:155],a[144:147],a[160:163],0
SA s21,s21,524160
M v[152:155],a[148:151],a[164:167],v[152:155]
s_waitcnt lgkmcnt(4)
M v[156:159],a[156:159],a[164:167],0
SA m0,s24,0
T a[80:81],v3,49152
T a[82:83],v3,50176
M v[156:159],a[152:155],a[160:163],v[156:159]
buffer_load_dwordx4 v12, s[48:51], s22 offen offset:0   lds
M v[160:163],a[96:99],a[168:171],0
R a[160:163],v5,20480
R a[164:167],v6,20480
M v[160:163],a[100:103],a[172:175],v[160:163]
M v[164:167],a[108:111],a[172:175],0
M v[164:167],a[104:107],a[168:171],v[164:167]
buffer_load_dwordx4 v13, s[48:51], s22 offen offset:1024   lds
M v[168:171],a[112:115],a[168:171],0
M v[168:171],a[116:119],a[172:175],v[168:171]
s_nop 0
T a[84:85],v3,57344
T a[86:87],v3,58368
M v[172:175],a[124:127],a[172:175],0
M v[172:175],a[120:123],a[168:171],v[172:175]
buffer_load_dwordx4 v14, s[48:51], s22 offen offset:2048   lds
M v[176:179],a[128:131],a[168:171],0
M v[176:179],a[132:135],a[172:175],v[176:179]
M v[180:183],a[140:143],a[172:175],0
buffer_load_dwordx4 v15, s[48:51], s22 offen offset:3072   lds
M v[180:183],a[136:139],a[168:171],v[180:183]
SA s22,s22,1048576
M v[184:187],a[144:147],a[168:171],0
s_nop 0
T a[88:89],v4,49152
T a[90:91],v4,50176
M v[184:187],a[148:151],a[172:175],v[184:187]
s_waitcnt lgkmcnt(4)
M v[188:191],a[156:159],a[172:175],0
SA m0,s23,32768
M v[188:191],a[152:155],a[168:171],v[188:191]
buffer_load_dwordx4 v8, s[16:19], s21 offen offset:0  nt lds
M v[192:195],a[96:99],a[160:163],0
R a[168:171],v5,22528
R a[172:175],v6,22528
M v[192:195],a[100:103],a[164:167],v[192:195]
M v[196:199],a[108:111],a[164:167],0
buffer_load_dwordx4 v9, s[16:19], s21 offen offset:1024  nt lds
M v[196:199],a[104:107],a[160:163],v[196:199]
s_nop 0
T a[92:93],v4,57344
T a[94:95],v4,58368
M v[200:203],a[112:115],a[160:163],0
M v[200:203],a[116:119],a[164:167],v[200:203]
M v[204:207],a[124:127],a[164:167],0
buffer_load_dwordx4 v10, s[16:19], s21 offen offset:2048  nt lds
M v[204:207],a[120:123],a[160:163],v[204:207]
M v[208:211],a[128:131],a[160:163],0
M v[208:211],a[132:135],a[164:167],v[208:211]
M v[212:215],a[140:143],a[164:167],0
buffer_load_dwordx4 v11, s[16:19], s21 offen offset:3072  nt lds
M v[212:215],a[136:139],a[160:163],v[212:215]
SA s21,s21,128
M v[216:219],a[144:147],a[160:163],0
M v[216:219],a[148:151],a[164:167],v[216:219]
s_waitcnt lgkmcnt(2)
M v[220:223],a[156:159],a[164:167],0
s_waitcnt vmcnt(16) lgkmcnt(0)
M v[220:223],a[152:155],a[160:163],v[220:223]
s_barrier
M v[224:227],a[96:99],a[168:171],0
R a[160:163],v5,32768
R a[164:167],v6,32768
M v[224:227],a[100:103],a[172:175],v[224:227]
M v[228:231],a[108:111],a[172:175],0
M v[228:231],a[104:107],a[168:171],v[228:231]
M v[232:235],a[112:115],a[168:171],0
M v[232:235],a[116:119],a[172:175],v[232:235]
M v[236:239],a[124:127],a[172:175],0
M v[236:239],a[120:123],a[168:171],v[236:239]
M v[240:243],a[128:131],a[168:171],0
M v[240:243],a[132:135],a[172:175],v[240:243]
M v[244:247],a[140:143],a[172:175],0
M v[244:247],a[136:139],a[168:171],v[244:247]
M v[248:251],a[144:147],a[168:171],0
M v[248:251],a[148:151],a[172:175],v[248:251]
s_waitcnt lgkmcnt(0)
M v[252:255],a[156:159],a[172:175],0
M v[252:255],a[152:155],a[168:171],v[252:255]
M a[0:3],a[32:35],a[160:163],a[0:3]
R a[168:171],v5,34816
R a[172:175],v6,34816
M a[0:3],a[36:39],a[164:167],a[0:3]
T a[96:97],v1,0
T a[98:99],v1,1024
M a[4:7],a[44:47],a[164:167],a[4:7]
SA m0,s24,16384
M a[4:7],a[40:43],a[160:163],a[4:7]
buffer_load_dwordx4 v12, s[48:51], s22 offen offset:0   lds
M a[8:11],a[48:51],a[160:163],a[8:11]
M a[8:11],a[52:55],a[164:167],a[8:11]
M a[12:15],a[60:63],a[164:167],a[12:15]
s_nop 0
T a[100:101],v1,8192
T a[102:103],v1,9216
M a[12:15],a[56:59],a[160:163],a[12:15]
M a[16:19],a[64:67],a[160:163],a[16:19]
buffer_load_dwordx4 v13, s[48:51], s22 offen offset:1024   lds
M a[16:19],a[68:71],a[164:167],a[16:19]
M a[20:23],a[76:79],a[164:167],a[20:23]
M a[20:23],a[72:75],a[160:163],a[20:23]
s_nop 0
T a[104:105],v2,0
T a[106:107],v2,1024
M a[24:27],a[80:83],a[160:163],a[24:27]
M a[24:27],a[84:87],a[164:167],a[24:27]
s_waitcnt lgkmcnt(6)
buffer_load_dwordx4 v14, s[48:51], s22 offen offset:2048   lds
M a[28:31],a[92:95],a[164:167],a[28:31]
M a[28:31],a[88:91],a[160:163],a[28:31]
M v[32:35],a[32:35],a[168:171],v[32:35]
R a[160:163],v5,36864
R a[164:167],v6,36864
M v[32:35],a[36:39],a[172:175],v[32:35]
T a[108:109],v2,8192
T a[110:111],v2,9216
M v[36:39],a[44:47],a[172:175],v[36:39]
buffer_load_dwordx4 v15, s[48:51], s22 offen offset:3072   lds
M v[36:39],a[40:43],a[168:171],v[36:39]
s_sub_u32 s22, s22, 1048448
M v[40:43],a[48:51],a[168:171],v[40:43]
M v[40:43],a[52:55],a[172:175],v[40:43]
s_nop 0
T a[112:113],v3,0
T a[114:115],v3,1024
M v[44:47],a[60:63],a[172:175],v[44:47]
SA m0,s23,49152
M v[44:47],a[56:59],a[168:171],v[44:47]
buffer_load_dwordx4 v8, s[16:19], s21 offen offset:0  nt lds
M v[48:51],a[64:67],a[168:171],v[48:51]
M v[48:51],a[68:71],a[172:175],v[48:51]
M v[52:55],a[76:79],a[172:175],v[52:55]
s_nop 0
T a[116:117],v3,8192
T a[118:119],v3,9216
M v[52:55],a[72:75],a[168:171],v[52:55]
M v[56:59],a[80:83],a[168:171],v[56:59]
buffer_load_dwordx4 v9, s[16:19], s21 offen offset:1024  nt lds
M v[56:59],a[84:87],a[172:175],v[56:59]
s_waitcnt lgkmcnt(6)
M v[60:63],a[92:95],a[172:175],v[60:63]
M v[60:63],a[88:91],a[168:171],v[60:63]
s_nop 0
T a[120:121],v4,0
T a[122:123],v4,1024
M v[64:67],a[32:35],a[160:163],v[64:67]
R a[168:171],v5,38912
R a[172:175],v6,38912
M v[64:67],a[36:39],a[164:167],v[64:67]
buffer_load_dwordx4 v10, s[16:19], s21 offen offset:2048  nt lds
M v[68:71],a[44:47],a[164:167],v[68:71]
M v[68:71],a[40:43],a[160:163],v[68:71]
M v[72:75],a[48:51],a[160:163],v[72:75]
s_nop 0
T a[124:125],v4,8192
T a[126:127],v4,9216
M v[72:75],a[52:55],a[164:167],v[72:75]
M v[76:79],a[60:63],a[164:167],v[76:79]
buffer_load_dwordx4 v11, s[16:19], s21 offen offset:3072  nt lds
M v[76:79],a[56:59],a[160:163],v[76:79]
SA s21,s21,524160
M v[80:83],a[64:67],a[160:163],v[80:83]
M v[80:83],a[68:71],a[164:167],v[80:83]
M v[84:87],a[76:79],a[164:167],v[84:87]
M v[84:87],a[72:75],a[160:163],v[84:87]
M v[88:91],a[80:83],a[160:163],v[88:91]
M v[88:91],a[84:87],a[164:167],v[88:91]
s_waitcnt lgkmcnt(2)
M v[92:95],a[92:95],a[164:167],v[92:95]
s_waitcnt vmcnt(16) lgkmcnt(0)
M v[92:95],a[88:91],a[160:163],v[92:95]
s_barrier
M v[96:99],a[32:35],a[168:171],v[96:99]
R a[160:163],v5,49152
R a[164:167],v6,49152
M v[96:99],a[36:39],a[172:175],v[96:99]
M v[100:103],a[44:47],a[172:175],v[100:103]
SA m0,s24,32768
T a[128:129],v1,16384
T a[130:131],v1,17408
M v[100:103],a[40:43],a[168:171],v[100:103]
buffer_load_dwordx4 v12, s[48:51], s22 offen offset:0   lds
M v[104:107],a[48:51],a[168:171],v[104:107]
M v[104:107],a[52:55],a[172:175],v[104:107]
M v[108:111],a[60:63],a[172:175],v[108:111]
M v[108:111],a[56:59],a[168:171],v[108:111]
M v[112:115],a[64:67],a[168:171],v[112:115]
M v[112:115],a[68:71],a[172:175],v[112:115]
s_nop 0
T a[132:133],v1,24576
T a[134:135],v1,25600
M v[116:119],a[76:79],a[172:175],v[116:119]
buffer_load_dwordx4 v13, s[48:51], s22 offen offset:1024   lds
M v[116:119],a[72:75],a[168:171],v[116:119]
M v[120:123],a[80:83],a[168:171],v[120:123]
M v[120:123],a[84:87],a[172:175],v[120:123]
s_waitcnt lgkmcnt(4)
M v[124:127],a[92:95],a[172:175],v[124:127]
M v[124:127],a[88:91],a[168:171],v[124:127]
M v[128:131],a[32:35],a[160:163],v[128:131]
R a[168:171],v5,51200
R a[172:175],v6,51200
M v[128:131],a[36:39],a[164:167],v[128:131]
T a[136:137],v2,16384
T a[138:139],v2,17408
M v[132:135],a[44:47],a[164:167],v[132:135]
buffer_load_dwordx4 v14, s[48:51], s22 offen offset:2048   lds
M v[132:135],a[40:43],a[160:163],v[132:135]
M v[136:139],a[48:51],a[160:163],v[136:139]
M v[136:139],a[52:55],a[164:167],v[136:139]
M v[140:143],a[60:63],a[164:167],v[140:143]
M v[140:143],a[56:59],a[160:163],v[140:143]
s_nop 0
T a[140:141],v2,24576
T a[142:143],v2,25600
M v[144:147],a[64:67],a[160:163],v[144:147]
buffer_load_dwordx4 v15, s[48:51], s22 offen offset:3072   lds
M v[144:147],a[68:71],a[164:167],v[144:147]
SA s22,s22,1048576
M v[148:151],a[76:79],a[164:167],v[148:151]
M v[148:151],a[72:75],a[160:163],v[148:151]
M v[152:155],a[80:83],a[160:163],v[152:155]
M v[152:155],a[84:87],a[164:167],v[152:155]
s_waitcnt lgkmcnt(4)
M v[156:159],a[92:95],a[164:167],v[156:159]
SA m0,s23,0
T a[144:145],v3,16384
T a[146:147],v3,17408
M v[156:159],a[88:91],a[160:163],v[156:159]
buffer_load_dwordx4 v8, s[16:19], s21 offen offset:0  nt lds
M v[160:163],a[32:35],a[168:171],v[160:163]
R a[160:163],v5,53248
R a[164:167],v6,53248
M v[160:163],a[36:39],a[172:175],v[160:163]
M v[164:167],a[44:47],a[172:175],v[164:167]
M v[164:167],a[40:43],a[168:171],v[164:167]
M v[168:171],a[48:51],a[168:171],v[168:171]
M v[168:171],a[52:55],a[172:175],v[168:171]
s_nop 0
T a[148:149],v3,24576
T a[150:151],v3,25600
M v[172:175],a[60:63],a[172:175],v[172:175]
buffer_load_dwordx4 v9, s[16:19], s21 offen offset:1024  nt lds
M v[172:175],a[56:59],a[168:171],v[172:175]
M v[176:179],a[64:67],a[168:171],v[176:179]
M v[176:179],a[68:71],a[172:175],v[176:179]
M v[180:183],a[76:79],a[172:175],v[180:183]
M v[180:183],a[72:75],a[168:171],v[180:183]
M v[184:187],a[80:83],a[168:171],v[184:187]
s_nop 0
T a[152:153],v4,16384
T a[154:155],v4,17408
M v[184:187],a[84:87],a[172:175],v[184:187]
s_waitcnt lgkmcnt(4)
buffer_load_dwordx4 v10, s[16:19], s21 offen offset:2048  nt lds
M v[188:191],a[92:95],a[172:175],v[188:191]
M v[188:191],a[88:91],a[168:171],v[188:191]
M v[192:195],a[32:35],a[160:163],v[192:195]
R a[168:171],v5,55296
R a[172:175],v6,55296
M v[192:195],a[36:39],a[164:167],v[192:195]
M v[196:199],a[44:47],a[164:167],v[196:199]
M v[196:199],a[40:43],a[160:163],v[196:199]
s_nop 0
T a[156:157],v4,24576
T a[158:159],v4,25600
M v[200:203],a[48:51],a[160:163],v[200:203]
buffer_load_dwordx4 v11, s[16:19], s21 offen offset:3072  nt lds
M v[200:203],a[52:55],a[164:167],v[200:203]
SA s21,s21,128
M v[204:207],a[60:63],a[164:167],v[204:207]
M v[204:207],a[56:59],a[160:163],v[204:207]
M v[208:211],a[64:67],a[160:163],v[208:211]
M v[208:211],a[68:71],a[164:167],v[208:211]
M v[212:215],a[76:79],a[164:167],v[212:215]
M v[212:215],a[72:75],a[160:163],v[212:215]
M v[216:219],a[80:83],a[160:163],v[216:219]
M v[216:219],a[84:87],a[164:167],v[216:219]
s_waitcnt lgkmcnt(2)
M v[220:223],a[92:95],a[164:167],v[220:223]
s_waitcnt vmcnt(16) lgkmcnt(0)
M v[220:223],a[88:91],a[160:163],v[220:223]
s_barrier
M v[224:227],a[32:35],a[168:171],v[224:227]
R a[160:163],v5,0
R a[164:167],v6,0
M v[224:227],a[36:39],a[172:175],v[224:227]
v_min_u32 v16, 1, v0
v_lshlrev_b32 v16, 29, v16
M v[228:231],a[44:47],a[172:175],v[228:231]
v_or_b32 v16, s39, v16
v_mov_b32 v17, 1
M v[228:231],a[40:43],a[168:171],v[228:231]
buffer_store_dword v17, v16, s[12:15], s38 offen sc1
M v[232:235],a[48:51],a[168:171],v[232:235]
M v[232:235],a[52:55],a[172:175],v[232:235]
M v[236:239],a[60:63],a[172:175],v[236:239]
M v[236:239],a[56:59],a[168:171],v[236:239]
M v[240:243],a[64:67],a[168:171],v[240:243]
M v[240:243],a[68:71],a[172:175],v[240:243]
M v[244:247],a[76:79],a[172:175],v[244:247]
M v[244:247],a[72:75],a[168:171],v[244:247]
M v[248:251],a[80:83],a[168:171],v[248:251]
M v[248:251],a[84:87],a[172:175],v[248:251]
L_w_kv01:
s_cbranch_execz L_w_kv05
s_waitcnt lgkmcnt(0)
M v[252:255],a[92:95],a[172:175],v[252:255]
M v[252:255],a[88:91],a[168:171],v[252:255]
M a[0:3],a[96:99],a[160:163],a[0:3]
R a[168:171],v5,2048
R a[172:175],v6,2048
M a[0:3],a[100:103],a[164:167],a[0:3]
T a[32:33],v1,32768
T a[34:35],v1,33792
M a[4:7],a[108:111],a[164:167],a[4:7]
SA m0,s24,49152
M a[4:7],a[104:107],a[160:163],a[4:7]
buffer_load_dwordx4 v12, s[48:51], s22 offen offset:0   lds
M a[8:11],a[112:115],a[160:163],a[8:11]
M a[8:11],a[116:119],a[164:167],a[8:11]
M a[12:15],a[124:127],a[164:167],a[12:15]
s_nop 0
T a[36:37],v1,40960
T a[38:39],v1,41984
M a[12:15],a[120:123],a[160:163],a[12:15]
M a[16:19],a[128:131],a[160:163],a[16:19]
buffer_load_dwordx4 v13, s[48:51], s22 offen offset:1024   lds
M a[16:19],a[132:135],a[164:167],a[16:19]
M a[20:23],a[140:143],a[164:167],a[20:23]
M a[20:23],a[136:139],a[160:163],a[20:23]
s_nop 0
T a[40:41],v2,32768
T a[42:43],v2,33792
M a[24:27],a[144:147],a[160:163],a[24:27]
M a[24:27],a[148:151],a[164:167],a[24:27]
s_waitcnt lgkmcnt(6)
buffer_load_dwordx4 v14, s[48:51], s22 offen offset:2048   lds
M a[28:31],a[156:159],a[164:167],a[28:31]
M a[28:31],a[152:155],a[160:163],a[28:31]
M v[32:35],a[96:99],a[168:171],v[32:35]
R a[160:163],v5,4096
R a[164:167],v6,4096
M v[32:35],a[100:103],a[172:175],v[32:35]
T a[44:45],v2,40960
T a[46:47],v2,41984
M v[36:39],a[108:111],a[172:175],v[36:39]
buffer_load_dwordx4 v15, s[48:51], s22 offen offset:3072   lds
M v[36:39],a[104:107],a[168:171],v[36:39]
s_sub_u32 s22, s22, 1048448
M v[40:43],a[112:115],a[168:171],v[40:43]
M v[40:43],a[116:119],a[172:175],v[40:43]
s_nop 0
T a[48:49],v3,32768
T a[50:51],v3,33792
M v[44:47],a[124:127],a[172:175],v[44:47]
SA m0,s23,16384
M v[44:47],a[120:123],a[168:171],v[44:47]
buffer_load_dwordx4 v8, s[16:19], s21 offen offset:0  nt lds
M v[48:51],a[128:131],a[168:171],v[48:51]
M v[48:51],a[132:135],a[172:175],v[48:51]
M v[52:55],a[140:143],a[172:175],v[52:55]
s_nop 0
T a[52:53],v3,40960
T a[54:55],v3,41984
M v[52:55],a[136:139],a[168:171],v[52:55]
M v[56:59],a[144:147],a[168:171],v[56:59]
buffer_load_dwordx4 v9, s[16:19], s21 offen offset:1024  nt lds
M v[56:59],a[148:151],a[172:175],v[56:59]
s_waitcnt lgkmcnt(6)
M v[60:63],a[156:159],a[172:175],v[60:63]
M v[60:63],a[152:155],a[168:171],v[60:63]
s_nop 0
T a[56:57],v4,32768
T a[58:59],v4,33792
M v[64:67],a[96:99],a[160:163],v[64:67]
R a[168:171],v5,6144
R a[172:175],v6,6144
M v[64:67],a[100:103],a[164:167],v[64:67]
buffer_load_dwordx4 v10, s[16:19], s21 offen offset:2048  nt lds
M v[68:71],a[108:111],a[164:167],v[68:71]
M v[68:71],a[104:107],a[160:163],v[68:71]
M v[72:75],a[112:115],a[160:163],v[72:75]
s_nop 0
T a[60:61],v4,40960
T a[62:63],v4,41984
M v[72:75],a[116:119],a[164:167],v[72:75]
M v[76:79],a[124:127],a[164:167],v[76:79]
buffer_load_dwordx4 v11, s[16:19], s21 offen offset:3072  nt lds
M v[76:79],a[120:123],a[160:163],v[76:79]
SA s21,s21,524160
M v[80:83],a[128:131],a[160:163],v[80:83]
M v[80:83],a[132:135],a[164:167],v[80:83]
M v[84:87],a[140:143],a[164:167],v[84:87]
M v[84:87],a[136:139],a[160:163],v[84:87]
s_and_b32 s86, s41, 7
M v[88:91],a[144:147],a[160:163],v[88:91]
s_mul_i32 s86, s86, 14
s_lshr_b32 s64, s41, 3
s_mul_i32 s64, s64, 7
M v[88:91],a[148:151],a[164:167],v[88:91]
s_waitcnt lgkmcnt(2)
SA s86,s86,s64
s_min_u32 s64, s31, 6
M v[92:95],a[156:159],a[164:167],v[92:95]
s_waitcnt vmcnt(17) lgkmcnt(0)
SA s86,s86,s64
s_sub_u32 s64, 6, s31
M v[92:95],a[152:155],a[160:163],v[92:95]
s_barrier
M v[96:99],a[96:99],a[168:171],v[96:99]
R a[160:163],v5,16384
R a[164:167],v6,16384
M v[96:99],a[100:103],a[172:175],v[96:99]
s_and_b32 s88, s64, 536870912
s_mul_i32 s87, s20, 7168
M v[100:103],a[108:111],a[172:175],v[100:103]
SA m0,s24,0
T a[64:65],v1,49152
T a[66:67],v1,50176
M v[100:103],a[104:107],a[168:171],v[100:103]
buffer_load_dwordx4 v12, s[48:51], s22 offen offset:0   lds
M v[104:107],a[112:115],a[168:171],v[104:107]
SA s87,s87,131072
M v[104:107],a[116:119],a[172:175],v[104:107]
s_cmp_lt_u32 s20, 2
M v[108:111],a[124:127],a[172:175],v[108:111]
s_cselect_b64 s[72:73], s[80:81], s[82:83]
M v[108:111],a[120:123],a[168:171],v[108:111]
s_mov_b32 s60, s72
M v[112:115],a[128:131],a[168:171],v[112:115]
s_and_b32 s61, s73, 0xffff
M v[112:115],a[132:135],a[172:175],v[112:115]
s_mov_b32 s62, 1605632
T a[68:69],v1,57344
T a[70:71],v1,58368
M v[116:119],a[140:143],a[172:175],v[116:119]
s_mov_b32 s63, 0x20000
buffer_load_dwordx4 v13, s[48:51], s22 offen offset:1024   lds
M v[116:119],a[136:139],a[168:171],v[116:119]
s_mov_b32 s68, s84
M v[120:123],a[144:147],a[168:171],v[120:123]
s_and_b32 s69, s85, 0xffff
s_mov_b32 s70, 1605632
s_mov_b32 s71, 0x20000
M v[120:123],a[148:151],a[172:175],v[120:123]
s_waitcnt lgkmcnt(4)
s_lshl_b32 s89, s86, 5
M v[124:127],a[156:159],a[172:175],v[124:127]
s_and_b32 s64, s20, 1
M v[124:127],a[152:155],a[168:171],v[124:127]
s_mul_i32 s64, s64, 802816
M v[128:131],a[96:99],a[160:163],v[128:131]
SA s89,s89,s64
R a[168:171],v5,18432
R a[172:175],v6,18432
M v[128:131],a[100:103],a[164:167],v[128:131]
T a[72:73],v2,49152
T a[74:75],v2,50176
M v[132:135],a[108:111],a[164:167],v[132:135]
buffer_load_dwordx4 v14, s[48:51], s22 offen offset:2048   lds
M v[132:135],a[104:107],a[160:163],v[132:135]
v_lshrrev_b32 v28, 1, v0
v_mul_u32_u24 v28, 3584, v28
M v[136:139],a[112:115],a[160:163],v[136:139]
v_and_b32 v29, 1, v0
v_lshl_add_u32 v25, v29, 4, v28
M v[136:139],a[116:119],a[164:167],v[136:139]
v_or_b32 v25, s88, v25
M v[140:143],a[124:127],a[164:167],v[140:143]
M v[140:143],a[120:123],a[160:163],v[140:143]
s_nop 0
T a[76:77],v2,57344
T a[78:79],v2,58368
M v[144:147],a[128:131],a[160:163],v[144:147]
buffer_load_dwordx4 v15, s[48:51], s22 offen offset:3072   lds
M v[144:147],a[132:135],a[164:167],v[144:147]
SA s22,s22,1048576
M v[148:151],a[140:143],a[164:167],v[148:151]
M v[148:151],a[136:139],a[160:163],v[148:151]
M v[152:155],a[144:147],a[160:163],v[152:155]
M v[152:155],a[148:151],a[164:167],v[152:155]
s_waitcnt lgkmcnt(4)
M v[156:159],a[156:159],a[164:167],v[156:159]
SA m0,s23,32768
T a[80:81],v3,49152
T a[82:83],v3,50176
M v[156:159],a[152:155],a[160:163],v[156:159]
buffer_load_dwordx4 v8, s[16:19], s21 offen offset:0  nt lds
M v[160:163],a[96:99],a[168:171],v[160:163]
R a[160:163],v5,20480
R a[164:167],v6,20480
M v[160:163],a[100:103],a[172:175],v[160:163]
M v[164:167],a[108:111],a[172:175],v[164:167]
M v[164:167],a[104:107],a[168:171],v[164:167]
M v[168:171],a[112:115],a[168:171],v[168:171]
M v[168:171],a[116:119],a[172:175],v[168:171]
s_nop 0
T a[84:85],v3,57344
T a[86:87],v3,58368
M v[172:175],a[124:127],a[172:175],v[172:175]
buffer_load_dwordx4 v9, s[16:19], s21 offen offset:1024  nt lds
M v[172:175],a[120:123],a[168:171],v[172:175]
M v[176:179],a[128:131],a[168:171],v[176:179]
M v[176:179],a[132:135],a[172:175],v[176:179]
M v[180:183],a[140:143],a[172:175],v[180:183]
M v[180:183],a[136:139],a[168:171],v[180:183]
M v[184:187],a[144:147],a[168:171],v[184:187]
s_nop 0
T a[88:89],v4,49152
T a[90:91],v4,50176
M v[184:187],a[148:151],a[172:175],v[184:187]
s_waitcnt lgkmcnt(4)
buffer_load_dwordx4 v10, s[16:19], s21 offen offset:2048  nt lds
M v[188:191],a[156:159],a[172:175],v[188:191]
M v[188:191],a[152:155],a[168:171],v[188:191]
M v[192:195],a[96:99],a[160:163],v[192:195]
R a[168:171],v5,22528
R a[172:175],v6,22528
M v[192:195],a[100:103],a[164:167],v[192:195]
M v[196:199],a[108:111],a[164:167],v[196:199]
M v[196:199],a[104:107],a[160:163],v[196:199]
s_nop 0
T a[92:93],v4,57344
T a[94:95],v4,58368
M v[200:203],a[112:115],a[160:163],v[200:203]
buffer_load_dwordx4 v11, s[16:19], s21 offen offset:3072  nt lds
M v[200:203],a[116:119],a[164:167],v[200:203]
SA s21,s21,128
M v[204:207],a[124:127],a[164:167],v[204:207]
M v[204:207],a[120:123],a[160:163],v[204:207]
M v[208:211],a[128:131],a[160:163],v[208:211]
M v[208:211],a[132:135],a[164:167],v[208:211]
M v[212:215],a[140:143],a[164:167],v[212:215]
M v[212:215],a[136:139],a[160:163],v[212:215]
M v[216:219],a[144:147],a[160:163],v[216:219]
M v[216:219],a[148:151],a[164:167],v[216:219]
s_waitcnt lgkmcnt(2)
M v[220:223],a[156:159],a[164:167],v[220:223]
s_waitcnt vmcnt(17) lgkmcnt(0)
M v[220:223],a[152:155],a[160:163],v[220:223]
s_barrier
M v[224:227],a[96:99],a[168:171],v[224:227]
R a[160:163],v5,32768
R a[164:167],v6,32768
M v[224:227],a[100:103],a[172:175],v[224:227]
M v[228:231],a[108:111],a[172:175],v[228:231]
M v[228:231],a[104:107],a[168:171],v[228:231]
M v[232:235],a[112:115],a[168:171],v[232:235]
M v[232:235],a[116:119],a[172:175],v[232:235]
M v[236:239],a[124:127],a[172:175],v[236:239]
M v[236:239],a[120:123],a[168:171],v[236:239]
M v[240:243],a[128:131],a[168:171],v[240:243]
M v[240:243],a[132:135],a[172:175],v[240:243]
M v[244:247],a[140:143],a[172:175],v[244:247]
M v[244:247],a[136:139],a[168:171],v[244:247]
M v[248:251],a[144:147],a[168:171],v[248:251]
M v[248:251],a[148:151],a[172:175],v[248:251]
s_waitcnt lgkmcnt(0)
M v[252:255],a[156:159],a[172:175],v[252:255]
M v[252:255],a[152:155],a[168:171],v[252:255]
M a[0:3],a[32:35],a[160:163],a[0:3]
R a[168:171],v5,34816
R a[172:175],v6,34816
M a[0:3],a[36:39],a[164:167],a[0:3]
T a[96:97],v1,0
T a[98:99],v1,1024
M a[4:7],a[44:47],a[164:167],a[4:7]
SA m0,s24,16384
M a[4:7],a[40:43],a[160:163],a[4:7]
buffer_load_dwordx4 v12, s[48:51], s22 offen offset:0   lds
M a[8:11],a[48:51],a[160:163],a[8:11]
M a[8:11],a[52:55],a[164:167],a[8:11]
M a[12:15],a[60:63],a[164:167],a[12:15]
s_nop 0
T a[100:101],v1,8192
T a[102:103],v1,9216
M a[12:15],a[56:59],a[160:163],a[12:15]
M a[16:19],a[64:67],a[160:163],a[16:19]
buffer_load_dwordx4 v13, s[48:51], s22 offen offset:1024   lds
M a[16:19],a[68:71],a[164:167],a[16:19]
M a[20:23],a[76:79],a[164:167],a[20:23]
M a[20:23],a[72:75],a[160:163],a[20:23]
s_nop 0
T a[104:105],v2,0
T a[106:107],v2,1024
M a[24:27],a[80:83],a[160:163],a[24:27]
M a[24:27],a[84:87],a[164:167],a[24:27]
s_waitcnt lgkmcnt(6)
buffer_load_dwordx4 v14, s[48:51], s22 offen offset:2048   lds
M a[28:31],a[92:95],a[164:167],a[28:31]
M a[28:31],a[88:91],a[160:163],a[28:31]
M v[32:35],a[32:35],a[168:171],v[32:35]
R a[160:163],v5,36864
R a[164:167],v6,36864
M v[32:35],a[36:39],a[172:175],v[32:35]
T a[108:109],v2,8192
T a[110:111],v2,9216
M v[36:39],a[44:47],a[172:175],v[36:39]
buffer_load_dwordx4 v15, s[48:51], s22 offen offset:3072   lds
M v[36:39],a[40:43],a[168:171],v[36:39]
s_sub_u32 s22, s22, 1048448
M v[40:43],a[48:51],a[168:171],v[40:43]
M v[40:43],a[52:55],a[172:175],v[40:43]
s_nop 0
T a[112:113],v3,0
T a[114:115],v3,1024
M v[44:47],a[60:63],a[172:175],v[44:47]
SA m0,s23,49152
M v[44:47],a[56:59],a[168:171],v[44:47]
buffer_load_dwordx4 v8, s[16:19], s21 offen offset:0  nt lds
M v[48:51],a[64:67],a[168:171],v[48:51]
M v[48:51],a[68:71],a[172:175],v[48:51]
M v[52:55],a[76:79],a[172:175],v[52:55]
s_nop 0
T a[116:117],v3,8192
T a[118:119],v3,9216
M v[52:55],a[72:75],a[168:171],v[52:55]
M v[56:59],a[80:83],a[168:171],v[56:59]
buffer_load_dwordx4 v9, s[16:19], s21 offen offset:1024  nt lds
M v[56:59],a[84:87],a[172:175],v[56:59]
s_waitcnt lgkmcnt(6)
M v[60:63],a[92:95],a[172:175],v[60:63]
M v[60:63],a[88:91],a[168:171],v[60:63]
s_nop 0
T a[120:121],v4,0
T a[122:123],v4,1024
M v[64:67],a[32:35],a[160:163],v[64:67]
R a[168:171],v5,38912
R a[172:175],v6,38912
M v[64:67],a[36:39],a[164:167],v[64:67]
buffer_load_dwordx4 v10, s[16:19], s21 offen offset:2048  nt lds
M v[68:71],a[44:47],a[164:167],v[68:71]
M v[68:71],a[40:43],a[160:163],v[68:71]
M v[72:75],a[48:51],a[160:163],v[72:75]
s_nop 0
T a[124:125],v4,8192
T a[126:127],v4,9216
M v[72:75],a[52:55],a[164:167],v[72:75]
M v[76:79],a[60:63],a[164:167],v[76:79]
buffer_load_dwordx4 v11, s[16:19], s21 offen offset:3072  nt lds
M v[76:79],a[56:59],a[160:163],v[76:79]
SA s21,s21,524160
M v[80:83],a[64:67],a[160:163],v[80:83]
M v[80:83],a[68:71],a[164:167],v[80:83]
M v[84:87],a[76:79],a[164:167],v[84:87]
M v[84:87],a[72:75],a[160:163],v[84:87]
M v[88:91],a[80:83],a[160:163],v[88:91]
M v[88:91],a[84:87],a[164:167],v[88:91]
s_waitcnt lgkmcnt(2)
M v[92:95],a[92:95],a[164:167],v[92:95]
s_waitcnt vmcnt(16) lgkmcnt(0)
M v[92:95],a[88:91],a[160:163],v[92:95]
s_barrier
M v[96:99],a[32:35],a[168:171],v[96:99]
R a[160:163],v5,49152
R a[164:167],v6,49152
M v[96:99],a[36:39],a[172:175],v[96:99]
M v[100:103],a[44:47],a[172:175],v[100:103]
SA m0,s24,32768
T a[128:129],v1,16384
T a[130:131],v1,17408
M v[100:103],a[40:43],a[168:171],v[100:103]
buffer_load_dwordx4 v12, s[48:51], s22 offen offset:0   lds
M v[104:107],a[48:51],a[168:171],v[104:107]
v_min_u32 v16, 40, v0
v_lshlrev_b32 v16, 2, v16
M v[104:107],a[52:55],a[172:175],v[104:107]
buffer_load_dword v17, v16, s[12:15], 0 offen sc1
M v[108:111],a[60:63],a[172:175],v[108:111]
M v[108:111],a[56:59],a[168:171],v[108:111]
M v[112:115],a[64:67],a[168:171],v[112:115]
buffer_load_dwordx4 v13, s[48:51], s22 offen offset:1024   lds
M v[112:115],a[68:71],a[172:175],v[112:115]
s_nop 0
T a[132:133],v1,24576
T a[134:135],v1,25600
M v[116:119],a[76:79],a[172:175],v[116:119]
M v[116:119],a[72:75],a[168:171],v[116:119]
M v[120:123],a[80:83],a[168:171],v[120:123]
M v[120:123],a[84:87],a[172:175],v[120:123]
s_waitcnt lgkmcnt(4)
M v[124:127],a[92:95],a[172:175],v[124:127]
buffer_load_dwordx4 v14, s[48:51], s22 offen offset:2048   lds
M v[124:127],a[88:91],a[168:171],v[124:127]
M v[128:131],a[32:35],a[160:163],v[128:131]
R a[168:171],v5,51200
R a[172:175],v6,51200
M v[128:131],a[36:39],a[164:167],v[128:131]
T a[136:137],v2,16384
T a[138:139],v2,17408
M v[132:135],a[44:47],a[164:167],v[132:135]
M v[132:135],a[40:43],a[160:163],v[132:135]
M v[136:139],a[48:51],a[160:163],v[136:139]
buffer_load_dwordx4 v15, s[48:51], s22 offen offset:3072   lds
M v[136:139],a[52:55],a[164:167],v[136:139]
SA s22,s22,1048576
M v[140:143],a[60:63],a[164:167],v[140:143]
M v[140:143],a[56:59],a[160:163],v[140:143]
s_nop 0
T a[140:141],v2,24576
T a[142:143],v2,25600
M v[144:147],a[64:67],a[160:163],v[144:147]
SA m0,s23,0
M v[144:147],a[68:71],a[164:167],v[144:147]
buffer_load_dwordx4 v8, s[16:19], s21 offen offset:0  nt lds
M v[148:151],a[76:79],a[164:167],v[148:151]
M v[148:151],a[72:75],a[160:163],v[148:151]
M v[152:155],a[80:83],a[160:163],v[152:155]
M v[152:155],a[84:87],a[164:167],v[152:155]
s_waitcnt lgkmcnt(4)
M v[156:159],a[92:95],a[164:167],v[156:159]
s_nop 0
T a[144:145],v3,16384
T a[146:147],v3,17408
M v[156:159],a[88:91],a[160:163],v[156:159]
buffer_load_dwordx4 v9, s[16:19], s21 offen offset:1024  nt lds
M v[160:163],a[32:35],a[168:171],v[160:163]
R a[160:163],v5,53248
R a[164:167],v6,53248
M v[160:163],a[36:39],a[172:175],v[160:163]
M v[164:167],a[44:47],a[172:175],v[164:167]
M v[164:167],a[40:43],a[168:171],v[164:167]
M v[168:171],a[48:51],a[168:171],v[168:171]
M v[168:171],a[52:55],a[172:175],v[168:171]
s_nop 0
T a[148:149],v3,24576
T a[150:151],v3,25600
M v[172:175],a[60:63],a[172:175],v[172:175]
buffer_load_dwordx4 v10, s[16:19], s21 offen offset:2048  nt lds
M v[172:175],a[56:59],a[168:171],v[172:175]
M v[176:179],a[64:67],a[168:171],v[176:179]
M v[176:179],a[68:71],a[172:175],v[176:179]
M v[180:183],a[76:79],a[172:175],v[180:183]
buffer_load_dwordx4 v11, s[16:19], s21 offen offset:3072  nt lds
M v[180:183],a[72:75],a[168:171],v[180:183]
SA s21,s21,128
M v[184:187],a[80:83],a[168:171],v[184:187]
s_nop 0
T a[152:153],v4,16384
T a[154:155],v4,17408
M v[184:187],a[84:87],a[172:175],v[184:187]
s_waitcnt lgkmcnt(4)
M v[188:191],a[92:95],a[172:175],v[188:191]
M v[188:191],a[88:91],a[168:171],v[188:191]
SA m0,s87,0
M v[192:195],a[32:35],a[160:163],v[192:195]
R a[168:171],v5,55296
R a[172:175],v6,55296
M v[192:195],a[36:39],a[164:167],v[192:195]
buffer_load_dwordx4 v25, s[60:63], s89 offen offset:0 nt lds
M v[196:199],a[44:47],a[164:167],v[196:199]
SA s89,s89,114688
M v[196:199],a[40:43],a[160:163],v[196:199]
s_nop 0
T a[156:157],v4,24576
T a[158:159],v4,25600
M v[200:203],a[48:51],a[160:163],v[200:203]
M v[200:203],a[52:55],a[164:167],v[200:203]
SA m0,s87,1024
M v[204:207],a[60:63],a[164:167],v[204:207]
buffer_load_dwordx4 v25, s[60:63], s89 offen offset:0 nt lds
M v[204:207],a[56:59],a[160:163],v[204:207]
SA s89,s89,114688
M v[208:211],a[64:67],a[160:163],v[208:211]
M v[208:211],a[68:71],a[164:167],v[208:211]
M v[212:215],a[76:79],a[164:167],v[212:215]
M v[212:215],a[72:75],a[160:163],v[212:215]
M v[216:219],a[80:83],a[160:163],v[216:219]
M v[216:219],a[84:87],a[164:167],v[216:219]
s_waitcnt lgkmcnt(2)
M v[220:223],a[92:95],a[164:167],v[220:223]
s_waitcnt vmcnt(19) lgkmcnt(0)
M v[220:223],a[88:91],a[160:163],v[220:223]
s_barrier
M v[224:227],a[32:35],a[168:171],v[224:227]
R a[160:163],v5,0
R a[164:167],v6,0
M v[224:227],a[36:39],a[172:175],v[224:227]
M v[228:231],a[44:47],a[172:175],v[228:231]
M v[228:231],a[40:43],a[168:171],v[228:231]
M v[232:235],a[48:51],a[168:171],v[232:235]
M v[232:235],a[52:55],a[172:175],v[232:235]
M v[236:239],a[60:63],a[172:175],v[236:239]
M v[236:239],a[56:59],a[168:171],v[236:239]
M v[240:243],a[64:67],a[168:171],v[240:243]
M v[240:243],a[68:71],a[172:175],v[240:243]
M v[244:247],a[76:79],a[172:175],v[244:247]
M v[244:247],a[72:75],a[168:171],v[244:247]
M v[248:251],a[80:83],a[168:171],v[248:251]
M v[248:251],a[84:87],a[172:175],v[248:251]
s_waitcnt lgkmcnt(0)
M v[252:255],a[92:95],a[172:175],v[252:255]
M v[252:255],a[88:91],a[168:171],v[252:255]
M a[0:3],a[96:99],a[160:163],a[0:3]
R a[168:171],v5,2048
R a[172:175],v6,2048
M a[0:3],a[100:103],a[164:167],a[0:3]
T a[32:33],v1,32768
T a[34:35],v1,33792
M a[4:7],a[108:111],a[164:167],a[4:7]
SA m0,s24,49152
M a[4:7],a[104:107],a[160:163],a[4:7]
buffer_load_dwordx4 v12, s[48:51], s22 offen offset:0   lds
M a[8:11],a[112:115],a[160:163],a[8:11]
M a[8:11],a[116:119],a[164:167],a[8:11]
M a[12:15],a[124:127],a[164:167],a[12:15]
s_nop 0
T a[36:37],v1,40960
T a[38:39],v1,41984
M a[12:15],a[120:123],a[160:163],a[12:15]
M a[16:19],a[128:131],a[160:163],a[16:19]
buffer_load_dwordx4 v13, s[48:51], s22 offen offset:1024   lds
M a[16:19],a[132:135],a[164:167],a[16:19]
M a[20:23],a[140:143],a[164:167],a[20:23]
M a[20:23],a[136:139],a[160:163],a[20:23]
s_nop 0
T a[40:41],v2,32768
T a[42:43],v2,33792
M a[24:27],a[144:147],a[160:163],a[24:27]
M a[24:27],a[148:151],a[164:167],a[24:27]
s_waitcnt lgkmcnt(6)
buffer_load_dwordx4 v14, s[48:51], s22 offen offset:2048   lds
M a[28:31],a[156:159],a[164:167],a[28:31]
M a[28:31],a[152:155],a[160:163],a[28:31]
M v[32:35],a[96:99],a[168:171],v[32:35]
R a[160:163],v5,4096
R a[164:167],v6,4096
M v[32:35],a[100:103],a[172:175],v[32:35]
T a[44:45],v2,40960
T a[46:47],v2,41984
M v[36:39],a[108:111],a[172:175],v[36:39]
buffer_load_dwordx4 v15, s[48:51], s22 offen offset:3072   lds
M v[36:39],a[104:107],a[168:171],v[36:39]
s_sub_u32 s22, s22, 1048448
M v[40:43],a[112:115],a[168:171],v[40:43]
M v[40:43],a[116:119],a[172:175],v[40:43]
s_nop 0
T a[48:49],v3,32768
T a[50:51],v3,33792
M v[44:47],a[124:127],a[172:175],v[44:47]
SA m0,s23,16384
M v[44:47],a[120:123],a[168:171],v[44:47]
buffer_load_dwordx4 v8, s[16:19], s21 offen offset:0  nt lds
M v[48:51],a[128:131],a[168:171],v[48:51]
M v[48:51],a[132:135],a[172:175],v[48:51]
M v[52:55],a[140:143],a[172:175],v[52:55]
s_nop 0
T a[52:53],v3,40960
T a[54:55],v3,41984
M v[52:55],a[136:139],a[168:171],v[52:55]
M v[56:59],a[144:147],a[168:171],v[56:59]
buffer_load_dwordx4 v9, s[16:19], s21 offen offset:1024  nt lds
M v[56:59],a[148:151],a[172:175],v[56:59]
s_waitcnt lgkmcnt(6)
M v[60:63],a[156:159],a[172:175],v[60:63]
L_w_kv02:
s_cbranch_execz L_w_kv06
M v[60:63],a[152:155],a[168:171],v[60:63]
s_nop 0
T a[56:57],v4,32768
T a[58:59],v4,33792
M v[64:67],a[96:99],a[160:163],v[64:67]
R a[168:171],v5,6144
R a[172:175],v6,6144
M v[64:67],a[100:103],a[164:167],v[64:67]
buffer_load_dwordx4 v10, s[16:19], s21 offen offset:2048  nt lds
M v[68:71],a[108:111],a[164:167],v[68:71]
M v[68:71],a[104:107],a[160:163],v[68:71]
M v[72:75],a[112:115],a[160:163],v[72:75]
s_nop 0
T a[60:61],v4,40960
T a[62:63],v4,41984
M v[72:75],a[116:119],a[164:167],v[72:75]
M v[76:79],a[124:127],a[164:167],v[76:79]
buffer_load_dwordx4 v11, s[16:19], s21 offen offset:3072  nt lds
M v[76:79],a[120:123],a[160:163],v[76:79]
SA s21,s21,524160
M v[80:83],a[128:131],a[160:163],v[80:83]
M v[80:83],a[132:135],a[164:167],v[80:83]
M v[84:87],a[140:143],a[164:167],v[84:87]
M v[84:87],a[136:139],a[160:163],v[84:87]
M v[88:91],a[144:147],a[160:163],v[88:91]
M v[88:91],a[148:151],a[164:167],v[88:91]
s_waitcnt lgkmcnt(2)
M v[92:95],a[156:159],a[164:167],v[92:95]
s_waitcnt vmcnt(19) lgkmcnt(0)
M v[92:95],a[152:155],a[160:163],v[92:95]
s_barrier
M v[96:99],a[96:99],a[168:171],v[96:99]
R a[160:163],v5,16384
R a[164:167],v6,16384
M v[96:99],a[100:103],a[172:175],v[96:99]
M v[100:103],a[108:111],a[172:175],v[100:103]
SA m0,s24,0
T a[64:65],v1,49152
T a[66:67],v1,50176
M v[100:103],a[104:107],a[168:171],v[100:103]
buffer_load_dwordx4 v12, s[48:51], s22 offen offset:0   lds
M v[104:107],a[112:115],a[168:171],v[104:107]
M v[104:107],a[116:119],a[172:175],v[104:107]
M v[108:111],a[124:127],a[172:175],v[108:111]
M v[108:111],a[120:123],a[168:171],v[108:111]
M v[112:115],a[128:131],a[168:171],v[112:115]
buffer_load_dwordx4 v13, s[48:51], s22 offen offset:1024   lds
M v[112:115],a[132:135],a[172:175],v[112:115]
s_nop 0
T a[68:69],v1,57344
T a[70:71],v1,58368
M v[116:119],a[140:143],a[172:175],v[116:119]
M v[116:119],a[136:139],a[168:171],v[116:119]
M v[120:123],a[144:147],a[168:171],v[120:123]
M v[120:123],a[148:151],a[172:175],v[120:123]
s_waitcnt lgkmcnt(4)
M v[124:127],a[156:159],a[172:175],v[124:127]
buffer_load_dwordx4 v14, s[48:51], s22 offen offset:2048   lds
M v[124:127],a[152:155],a[168:171],v[124:127]
M v[128:131],a[96:99],a[160:163],v[128:131]
R a[168:171],v5,18432
R a[172:175],v6,18432
M v[128:131],a[100:103],a[164:167],v[128:131]
T a[72:73],v2,49152
T a[74:75],v2,50176
M v[132:135],a[108:111],a[164:167],v[132:135]
M v[132:135],a[104:107],a[160:163],v[132:135]
M v[136:139],a[112:115],a[160:163],v[136:139]
buffer_load_dwordx4 v15, s[48:51], s22 offen offset:3072   lds
M v[136:139],a[116:119],a[164:167],v[136:139]
SA s22,s22,1048576
M v[140:143],a[124:127],a[164:167],v[140:143]
M v[140:143],a[120:123],a[160:163],v[140:143]
s_nop 0
T a[76:77],v2,57344
T a[78:79],v2,58368
M v[144:147],a[128:131],a[160:163],v[144:147]
SA m0,s23,32768
M v[144:147],a[132:135],a[164:167],v[144:147]
buffer_load_dwordx4 v8, s[16:19], s21 offen offset:0  nt lds
M v[148:151],a[140:143],a[164:167],v[148:151]
M v[148:151],a[136:139],a[160:163],v[148:151]
M v[152:155],a[144:147],a[160:163],v[152:155]
M v[152:155],a[148:151],a[164:167],v[152:155]
s_waitcnt lgkmcnt(4)
M v[156:159],a[156:159],a[164:167],v[156:159]
s_nop 0
T a[80:81],v3,49152
T a[82:83],v3,50176
M v[156:159],a[152:155],a[160:163],v[156:159]
buffer_load_dwordx4 v9, s[16:19], s21 offen offset:1024  nt lds
M v[160:163],a[96:99],a[168:171],v[160:163]
R a[160:163],v5,20480
R a[164:167],v6,20480
M v[160:163],a[100:103],a[172:175],v[160:163]
M v[164:167],a[108:111],a[172:175],v[164:167]
M v[164:167],a[104:107],a[168:171],v[164:167]
M v[168:171],a[112:115],a[168:171],v[168:171]
M v[168:171],a[116:119],a[172:175],v[168:171]
s_nop 0
T a[84:85],v3,57344
T a[86:87],v3,58368
M v[172:175],a[124:127],a[172:175],v[172:175]
buffer_load_dwordx4 v10, s[16:19], s21 offen offset:2048  nt lds
M v[172:175],a[120:123],a[168:171],v[172:175]
M v[176:179],a[128:131],a[168:171],v[176:179]
M v[176:179],a[132:135],a[172:175],v[176:179]
M v[180:183],a[140:143],a[172:175],v[180:183]
buffer_load_dwordx4 v11, s[16:19], s21 offen offset:3072  nt lds
M v[180:183],a[136:139],a[168:171],v[180:183]
SA s21,s21,128
M v[184:187],a[144:147],a[168:171],v[184:187]
s_nop 0
T a[88:89],v4,49152
T a[90:91],v4,50176
M v[184:187],a[148:151],a[172:175],v[184:187]
s_waitcnt lgkmcnt(4)
M v[188:191],a[156:159],a[172:175],v[188:191]
M v[188:191],a[152:155],a[168:171],v[188:191]
SA m0,s87,2048
M v[192:195],a[96:99],a[160:163],v[192:195]
R a[168:171],v5,22528
R a[172:175],v6,22528
M v[192:195],a[100:103],a[164:167],v[192:195]
buffer_load_dwordx4 v25, s[60:63], s89 offen offset:0 nt lds
M v[196:199],a[108:111],a[164:167],v[196:199]
SA s89,s89,114688
M v[196:199],a[104:107],a[160:163],v[196:199]
s_nop 0
T a[92:93],v4,57344
T a[94:95],v4,58368
M v[200:203],a[112:115],a[160:163],v[200:203]
M v[200:203],a[116:119],a[164:167],v[200:203]
SA m0,s87,3072
M v[204:207],a[124:127],a[164:167],v[204:207]
buffer_load_dwordx4 v25, s[60:63], s89 offen offset:0 nt lds
M v[204:207],a[120:123],a[160:163],v[204:207]
SA s89,s89,114688
M v[208:211],a[128:131],a[160:163],v[208:211]
M v[208:211],a[132:135],a[164:167],v[208:211]
M v[212:215],a[140:143],a[164:167],v[212:215]
M v[212:215],a[136:139],a[160:163],v[212:215]
M v[216:219],a[144:147],a[160:163],v[216:219]
M v[216:219],a[148:151],a[164:167],v[216:219]
s_waitcnt lgkmcnt(2)
M v[220:223],a[156:159],a[164:167],v[220:223]
s_waitcnt vmcnt(20) lgkmcnt(0)
M v[220:223],a[152:155],a[160:163],v[220:223]
s_barrier
M v[224:227],a[96:99],a[168:171],v[224:227]
R a[160:163],v5,32768
R a[164:167],v6,32768
M v[224:227],a[100:103],a[172:175],v[224:227]
v_cmp_ne_u32 vcc, 1, v17
M v[228:231],a[108:111],a[172:175],v[228:231]
s_nop 0
M v[228:231],a[104:107],a[168:171],v[228:231]
s_cbranch_vccnz L_zs0
L_zr0:
M v[232:235],a[112:115],a[168:171],v[232:235]
M v[232:235],a[116:119],a[172:175],v[232:235]
M v[236:239],a[124:127],a[172:175],v[236:239]
M v[236:239],a[120:123],a[168:171],v[236:239]
M v[240:243],a[128:131],a[168:171],v[240:243]
M v[240:243],a[132:135],a[172:175],v[240:243]
M v[244:247],a[140:143],a[172:175],v[244:247]
M v[244:247],a[136:139],a[168:171],v[244:247]
M v[248:251],a[144:147],a[168:171],v[248:251]
M v[248:251],a[148:151],a[172:175],v[248:251]
s_waitcnt lgkmcnt(0)
M v[252:255],a[156:159],a[172:175],v[252:255]
M v[252:255],a[152:155],a[168:171],v[252:255]
M a[0:3],a[32:35],a[160:163],a[0:3]
R a[168:171],v5,34816
R a[172:175],v6,34816
M a[0:3],a[36:39],a[164:167],a[0:3]
T a[96:97],v1,0
T a[98:99],v1,1024
M a[4:7],a[44:47],a[164:167],a[4:7]
SA m0,s24,16384
M a[4:7],a[40:43],a[160:163],a[4:7]
buffer_load_dwordx4 v12, s[48:51], s22 offen offset:0   lds
M a[8:11],a[48:51],a[160:163],a[8:11]
M a[8:11],a[52:55],a[164:167],a[8:11]
s_mul_i32 s64, s41, 229376
M a[12:15],a[60:63],a[164:167],a[12:15]
SA s72,s90,s64
T a[100:101],v1,8192
T a[102:103],v1,9216
M a[12:15],a[56:59],a[160:163],a[12:15]
s_addc_u32 s73, s91, 0
M a[16:19],a[64:67],a[160:163],a[16:19]
s_sub_u32 s75, 3670016, s64
buffer_load_dwordx4 v13, s[48:51], s22 offen offset:1024   lds
M a[16:19],a[68:71],a[164:167],a[16:19]
s_mov_b32 s12, s72
M a[20:23],a[76:79],a[164:167],a[20:23]
s_and_b32 s13, s73, 0xffff
M a[20:23],a[72:75],a[160:163],a[20:23]
s_mov_b32 s14, s75
T a[104:105],v2,0
T a[106:107],v2,1024
M a[24:27],a[80:83],a[160:163],a[24:27]
s_mov_b32 s15, 0x20000
M a[24:27],a[84:87],a[164:167],a[24:27]
s_waitcnt lgkmcnt(6)
buffer_load_dwordx4 v14, s[48:51], s22 offen offset:2048   lds
M a[28:31],a[92:95],a[164:167],a[28:31]
M a[28:31],a[88:91],a[160:163],a[28:31]
M v[32:35],a[32:35],a[168:171],v[32:35]
R a[160:163],v5,36864
R a[164:167],v6,36864
M v[32:35],a[36:39],a[172:175],v[32:35]
T a[108:109],v2,8192
T a[110:111],v2,9216
M v[36:39],a[44:47],a[172:175],v[36:39]
buffer_load_dwordx4 v15, s[48:51], s22 offen offset:3072   lds
M v[36:39],a[40:43],a[168:171],v[36:39]
s_sub_u32 s22, s22, 1048448
M v[40:43],a[48:51],a[168:171],v[40:43]
M v[40:43],a[52:55],a[172:175],v[40:43]
s_nop 0
T a[112:113],v3,0
T a[114:115],v3,1024
M v[44:47],a[60:63],a[172:175],v[44:47]
SA m0,s23,49152
M v[44:47],a[56:59],a[168:171],v[44:47]
buffer_load_dwordx4 v8, s[16:19], s21 offen offset:0  nt lds
M v[48:51],a[64:67],a[168:171],v[48:51]
M v[48:51],a[68:71],a[172:175],v[48:51]
M v[52:55],a[76:79],a[172:175],v[52:55]
s_nop 0
T a[116:117],v3,8192
T a[118:119],v3,9216
M v[52:55],a[72:75],a[168:171],v[52:55]
M v[56:59],a[80:83],a[168:171],v[56:59]
buffer_load_dwordx4 v9, s[16:19], s21 offen offset:1024  nt lds
M v[56:59],a[84:87],a[172:175],v[56:59]
s_waitcnt lgkmcnt(6)
M v[60:63],a[92:95],a[172:175],v[60:63]
M v[60:63],a[88:91],a[168:171],v[60:63]
s_nop 0
T a[120:121],v4,0
T a[122:123],v4,1024
M v[64:67],a[32:35],a[160:163],v[64:67]
R a[168:171],v5,38912
R a[172:175],v6,38912
M v[64:67],a[36:39],a[164:167],v[64:67]
buffer_load_dwordx4 v10, s[16:19], s21 offen offset:2048  nt lds
M v[68:71],a[44:47],a[164:167],v[68:71]
M v[68:71],a[40:43],a[160:163],v[68:71]
M v[72:75],a[48:51],a[160:163],v[72:75]
s_nop 0
T a[124:125],v4,8192
T a[126:127],v4,9216
M v[72:75],a[52:55],a[164:167],v[72:75]
M v[76:79],a[60:63],a[164:167],v[76:79]
buffer_load_dwordx4 v11, s[16:19], s21 offen offset:3072  nt lds
M v[76:79],a[56:59],a[160:163],v[76:79]
SA s21,s21,524160
M v[80:83],a[64:67],a[160:163],v[80:83]
M v[80:83],a[68:71],a[164:167],v[80:83]
M v[84:87],a[76:79],a[164:167],v[84:87]
M v[84:87],a[72:75],a[160:163],v[84:87]
M v[88:91],a[80:83],a[160:163],v[88:91]
M v[88:91],a[84:87],a[164:167],v[88:91]
s_waitcnt lgkmcnt(2)
M v[92:95],a[92:95],a[164:167],v[92:95]
s_waitcnt vmcnt(18) lgkmcnt(0)
M v[92:95],a[88:91],a[160:163],v[92:95]
s_barrier
M v[96:99],a[32:35],a[168:171],v[96:99]
R a[160:163],v5,49152
R a[164:167],v6,49152
M v[96:99],a[36:39],a[172:175],v[96:99]
M v[100:103],a[44:47],a[172:175],v[100:103]
SA m0,s24,32768
T a[128:129],v1,16384
T a[130:131],v1,17408
M v[100:103],a[40:43],a[168:171],v[100:103]
buffer_load_dwordx4 v12, s[48:51], s22 offen offset:0   lds
M v[104:107],a[48:51],a[168:171],v[104:107]
M v[104:107],a[52:55],a[172:175],v[104:107]
M v[108:111],a[60:63],a[172:175],v[108:111]
M v[108:111],a[56:59],a[168:171],v[108:111]
M v[112:115],a[64:67],a[168:171],v[112:115]
buffer_load_dwordx4 v13, s[48:51], s22 offen offset:1024   lds
M v[112:115],a[68:71],a[172:175],v[112:115]
s_nop 0
T a[132:133],v1,24576
T a[134:135],v1,25600
M v[116:119],a[76:79],a[172:175],v[116:119]
M v[116:119],a[72:75],a[168:171],v[116:119]
M v[120:123],a[80:83],a[168:171],v[120:123]
M v[120:123],a[84:87],a[172:175],v[120:123]
s_waitcnt lgkmcnt(4)
M v[124:127],a[92:95],a[172:175],v[124:127]
buffer_load_dwordx4 v14, s[48:51], s22 offen offset:2048   lds
M v[124:127],a[88:91],a[168:171],v[124:127]
M v[128:131],a[32:35],a[160:163],v[128:131]
R a[168:171],v5,51200
R a[172:175],v6,51200
M v[128:131],a[36:39],a[164:167],v[128:131]
T a[136:137],v2,16384
T a[138:139],v2,17408
M v[132:135],a[44:47],a[164:167],v[132:135]
M v[132:135],a[40:43],a[160:163],v[132:135]
M v[136:139],a[48:51],a[160:163],v[136:139]
buffer_load_dwordx4 v15, s[48:51], s22 offen offset:3072   lds
M v[136:139],a[52:55],a[164:167],v[136:139]
SA s22,s22,1048576
M v[140:143],a[60:63],a[164:167],v[140:143]
M v[140:143],a[56:59],a[160:163],v[140:143]
s_nop 0
T a[140:141],v2,24576
T a[142:143],v2,25600
M v[144:147],a[64:67],a[160:163],v[144:147]
SA m0,s23,0
M v[144:147],a[68:71],a[164:167],v[144:147]
buffer_load_dwordx4 v8, s[16:19], s21 offen offset:0  nt lds
M v[148:151],a[76:79],a[164:167],v[148:151]
M v[148:151],a[72:75],a[160:163],v[148:151]
M v[152:155],a[80:83],a[160:163],v[152:155]
M v[152:155],a[84:87],a[164:167],v[152:155]
s_waitcnt lgkmcnt(4)
M v[156:159],a[92:95],a[164:167],v[156:159]
s_nop 0
T a[144:145],v3,16384
T a[146:147],v3,17408
M v[156:159],a[88:91],a[160:163],v[156:159]
buffer_load_dwordx4 v9, s[16:19], s21 offen offset:1024  nt lds
M v[160:163],a[32:35],a[168:171],v[160:163]
R a[160:163],v5,53248
R a[164:167],v6,53248
M v[160:163],a[36:39],a[172:175],v[160:163]
M v[164:167],a[44:47],a[172:175],v[164:167]
M v[164:167],a[40:43],a[168:171],v[164:167]
M v[168:171],a[48:51],a[168:171],v[168:171]
M v[168:171],a[52:55],a[172:175],v[168:171]
s_nop 0
T a[148:149],v3,24576
T a[150:151],v3,25600
M v[172:175],a[60:63],a[172:175],v[172:175]
buffer_load_dwordx4 v10, s[16:19], s21 offen offset:2048  nt lds
M v[172:175],a[56:59],a[168:171],v[172:175]
M v[176:179],a[64:67],a[168:171],v[176:179]
M v[176:179],a[68:71],a[172:175],v[176:179]
M v[180:183],a[76:79],a[172:175],v[180:183]
buffer_load_dwordx4 v11, s[16:19], s21 offen offset:3072  nt lds
M v[180:183],a[72:75],a[168:171],v[180:183]
SA s21,s21,128
M v[184:187],a[80:83],a[168:171],v[184:187]
s_nop 0
T a[152:153],v4,16384
T a[154:155],v4,17408
M v[184:187],a[84:87],a[172:175],v[184:187]
s_waitcnt lgkmcnt(4)
M v[188:191],a[92:95],a[172:175],v[188:191]
M v[188:191],a[88:91],a[168:171],v[188:191]
SA m0,s87,4096
M v[192:195],a[32:35],a[160:163],v[192:195]
R a[168:171],v5,55296
R a[172:175],v6,55296
M v[192:195],a[36:39],a[164:167],v[192:195]
buffer_load_dwordx4 v25, s[60:63], s89 offen offset:0 nt lds
M v[196:199],a[44:47],a[164:167],v[196:199]
SA s89,s89,114688
M v[196:199],a[40:43],a[160:163],v[196:199]
s_nop 0
T a[156:157],v4,24576
T a[158:159],v4,25600
M v[200:203],a[48:51],a[160:163],v[200:203]
M v[200:203],a[52:55],a[164:167],v[200:203]
SA m0,s87,5120
M v[204:207],a[60:63],a[164:167],v[204:207]
buffer_load_dwordx4 v25, s[60:63], s89 offen offset:0 nt lds
M v[204:207],a[56:59],a[160:163],v[204:207]
SA s89,s89,114688
M v[208:211],a[64:67],a[160:163],v[208:211]
M v[208:211],a[68:71],a[164:167],v[208:211]
M v[212:215],a[76:79],a[164:167],v[212:215]
M v[212:215],a[72:75],a[160:163],v[212:215]
M v[216:219],a[80:83],a[160:163],v[216:219]
M v[216:219],a[84:87],a[164:167],v[216:219]
s_waitcnt lgkmcnt(2)
M v[220:223],a[92:95],a[164:167],v[220:223]
s_waitcnt vmcnt(20) lgkmcnt(0)
M v[220:223],a[88:91],a[160:163],v[220:223]
s_barrier
M v[224:227],a[32:35],a[168:171],v[224:227]
R a[160:163],v5,0
R a[164:167],v6,0
M v[224:227],a[36:39],a[172:175],v[224:227]
M v[228:231],a[44:47],a[172:175],v[228:231]
M v[228:231],a[40:43],a[168:171],v[228:231]
M v[232:235],a[48:51],a[168:171],v[232:235]
M v[232:235],a[52:55],a[172:175],v[232:235]
M v[236:239],a[60:63],a[172:175],v[236:239]
M v[236:239],a[56:59],a[168:171],v[236:239]
M v[240:243],a[64:67],a[168:171],v[240:243]
M v[240:243],a[68:71],a[172:175],v[240:243]
M v[244:247],a[76:79],a[172:175],v[244:247]
M v[244:247],a[72:75],a[168:171],v[244:247]
M v[248:251],a[80:83],a[168:171],v[248:251]
M v[248:251],a[84:87],a[172:175],v[248:251]
s_waitcnt lgkmcnt(0)
M v[252:255],a[92:95],a[172:175],v[252:255]
M v[252:255],a[88:91],a[168:171],v[252:255]
M a[0:3],a[96:99],a[160:163],a[0:3]
R a[168:171],v5,2048
R a[172:175],v6,2048
M a[0:3],a[100:103],a[164:167],a[0:3]
T a[32:33],v1,32768
T a[34:35],v1,33792
M a[4:7],a[108:111],a[164:167],a[4:7]
SA m0,s24,49152
M a[4:7],a[104:107],a[160:163],a[4:7]
buffer_load_dwordx4 v12, s[48:51], s22 offen offset:0   lds
M a[8:11],a[112:115],a[160:163],a[8:11]
M a[8:11],a[116:119],a[164:167],a[8:11]
M a[12:15],a[124:127],a[164:167],a[12:15]
s_nop 0
T a[36:37],v1,40960
T a[38:39],v1,41984
M a[12:15],a[120:123],a[160:163],a[12:15]
M a[16:19],a[128:131],a[160:163],a[16:19]
buffer_load_dwordx4 v13, s[48:51], s22 offen offset:1024   lds
M a[16:19],a[132:135],a[164:167],a[16:19]
M a[20:23],a[140:143],a[164:167],a[20:23]
M a[20:23],a[136:139],a[160:163],a[20:23]
s_nop 0
T a[40:41],v2,32768
T a[42:43],v2,33792
M a[24:27],a[144:147],a[160:163],a[24:27]
M a[24:27],a[148:151],a[164:167],a[24:27]
s_waitcnt lgkmcnt(6)
buffer_load_dwordx4 v14, s[48:51], s22 offen offset:2048   lds
M a[28:31],a[156:159],a[164:167],a[28:31]
M a[28:31],a[152:155],a[160:163],a[28:31]
M v[32:35],a[96:99],a[168:171],v[32:35]
R a[160:163],v5,4096
R a[164:167],v6,4096
M v[32:35],a[100:103],a[172:175],v[32:35]
T a[44:45],v2,40960
T a[46:47],v2,41984
M v[36:39],a[108:111],a[172:175],v[36:39]
buffer_load_dwordx4 v15, s[48:51], s22 offen offset:3072   lds
M v[36:39],a[104:107],a[168:171],v[36:39]
s_sub_u32 s22, s22, 1048448
M v[40:43],a[112:115],a[168:171],v[40:43]
M v[40:43],a[116:119],a[172:175],v[40:43]
s_nop 0
T a[48:49],v3,32768
T a[50:51],v3,33792
M v[44:47],a[124:127],a[172:175],v[44:47]
SA m0,s23,16384
M v[44:47],a[120:123],a[168:171],v[44:47]
buffer_load_dwordx4 v8, s[16:19], s21 offen offset:0  nt lds
M v[48:51],a[128:131],a[168:171],v[48:51]
M v[48:51],a[132:135],a[172:175],v[48:51]
M v[52:55],a[140:143],a[172:175],v[52:55]
s_nop 0
T a[52:53],v3,40960
T a[54:55],v3,41984
M v[52:55],a[136:139],a[168:171],v[52:55]
M v[56:59],a[144:147],a[168:171],v[56:59]
buffer_load_dwordx4 v9, s[16:19], s21 offen offset:1024  nt lds
M v[56:59],a[148:151],a[172:175],v[56:59]
s_waitcnt lgkmcnt(6)
M v[60:63],a[156:159],a[172:175],v[60:63]
M v[60:63],a[152:155],a[168:171],v[60:63]
s_nop 0
T a[56:57],v4,32768
T a[58:59],v4,33792
M v[64:67],a[96:99],a[160:163],v[64:67]
R a[168:171],v5,6144
R a[172:175],v6,6144
M v[64:67],a[100:103],a[164:167],v[64:67]
buffer_load_dwordx4 v10, s[16:19], s21 offen offset:2048  nt lds
M v[68:71],a[108:111],a[164:167],v[68:71]
M v[68:71],a[104:107],a[160:163],v[68:71]
M v[72:75],a[112:115],a[160:163],v[72:75]
s_nop 0
T a[60:61],v4,40960
T a[62:63],v4,41984
M v[72:75],a[116:119],a[164:167],v[72:75]
M v[76:79],a[124:127],a[164:167],v[76:79]
buffer_load_dwordx4 v11, s[16:19], s21 offen offset:3072  nt lds
M v[76:79],a[120:123],a[160:163],v[76:79]
SA s21,s21,524160
M v[80:83],a[128:131],a[160:163],v[80:83]
M v[80:83],a[132:135],a[164:167],v[80:83]
M v[84:87],a[140:143],a[164:167],v[84:87]
M v[84:87],a[136:139],a[160:163],v[84:87]
M v[88:91],a[144:147],a[160:163],v[88:91]
M v[88:91],a[148:151],a[164:167],v[88:91]
s_waitcnt lgkmcnt(2)
M v[92:95],a[156:159],a[164:167],v[92:95]
s_waitcnt vmcnt(18) lgkmcnt(0)
M v[92:95],a[152:155],a[160:163],v[92:95]
s_barrier
M v[96:99],a[96:99],a[168:171],v[96:99]
R a[160:163],v5,16384
R a[164:167],v6,16384
M v[96:99],a[100:103],a[172:175],v[96:99]
M v[100:103],a[108:111],a[172:175],v[100:103]
SA m0,s24,0
T a[64:65],v1,49152
T a[66:67],v1,50176
M v[100:103],a[104:107],a[168:171],v[100:103]
buffer_load_dwordx4 v12, s[48:51], s22 offen offset:0   lds
M v[104:107],a[112:115],a[168:171],v[104:107]
M v[104:107],a[116:119],a[172:175],v[104:107]
M v[108:111],a[124:127],a[172:175],v[108:111]
M v[108:111],a[120:123],a[168:171],v[108:111]
M v[112:115],a[128:131],a[168:171],v[112:115]
M v[112:115],a[132:135],a[172:175],v[112:115]
s_nop 0
T a[68:69],v1,57344
T a[70:71],v1,58368
M v[116:119],a[140:143],a[172:175],v[116:119]
buffer_load_dwordx4 v13, s[48:51], s22 offen offset:1024   lds
M v[116:119],a[136:139],a[168:171],v[116:119]
M v[120:123],a[144:147],a[168:171],v[120:123]
M v[120:123],a[148:151],a[172:175],v[120:123]
s_waitcnt lgkmcnt(4)
M v[124:127],a[156:159],a[172:175],v[124:127]
M v[124:127],a[152:155],a[168:171],v[124:127]
buffer_load_dwordx4 v14, s[48:51], s22 offen offset:2048   lds
M v[128:131],a[96:99],a[160:163],v[128:131]
R a[168:171],v5,18432
R a[172:175],v6,18432
M v[128:131],a[100:103],a[164:167],v[128:131]
s_lshl_b32 s67, s20, 11
T a[72:73],v2,49152
T a[74:75],v2,50176
M v[132:135],a[108:111],a[164:167],v[132:135]
SA s67,s67,104914944
buffer_load_dwordx4 v[16:19], v7, s[8:11], s67 offen offset:0 sc1
M v[132:135],a[104:107],a[160:163],v[132:135]
M v[136:139],a[112:115],a[160:163],v[136:139]
buffer_load_dwordx4 v[20:23], v7, s[8:11], s67 offen offset:1024 sc1
M v[136:139],a[116:119],a[164:167],v[136:139]
M v[140:143],a[124:127],a[164:167],v[140:143]
L_w_kv03:
s_cbranch_execz L_w_kv07
buffer_load_dwordx4 v15, s[48:51], s22 offen offset:3072   lds
M v[140:143],a[120:123],a[160:163],v[140:143]
SA s22,s22,1048576
T a[76:77],v2,57344
T a[78:79],v2,58368
M v[144:147],a[128:131],a[160:163],v[144:147]
M v[144:147],a[132:135],a[164:167],v[144:147]
M v[148:151],a[140:143],a[164:167],v[148:151]
M v[148:151],a[136:139],a[160:163],v[148:151]
SA m0,s23,32768
M v[152:155],a[144:147],a[160:163],v[152:155]
buffer_load_dwordx4 v8, s[16:19], s21 offen offset:0  nt lds
M v[152:155],a[148:151],a[164:167],v[152:155]
s_waitcnt lgkmcnt(4)
M v[156:159],a[156:159],a[164:167],v[156:159]
s_nop 0
T a[80:81],v3,49152
T a[82:83],v3,50176
M v[156:159],a[152:155],a[160:163],v[156:159]
M v[160:163],a[96:99],a[168:171],v[160:163]
R a[160:163],v5,20480
R a[164:167],v6,20480
M v[160:163],a[100:103],a[172:175],v[160:163]
M v[164:167],a[108:111],a[172:175],v[164:167]
buffer_load_dwordx4 v9, s[16:19], s21 offen offset:1024  nt lds
M v[164:167],a[104:107],a[168:171],v[164:167]
M v[168:171],a[112:115],a[168:171],v[168:171]
M v[168:171],a[116:119],a[172:175],v[168:171]
s_nop 0
T a[84:85],v3,57344
T a[86:87],v3,58368
M v[172:175],a[124:127],a[172:175],v[172:175]
M v[172:175],a[120:123],a[168:171],v[172:175]
M v[176:179],a[128:131],a[168:171],v[176:179]
M v[176:179],a[132:135],a[172:175],v[176:179]
buffer_load_dwordx4 v10, s[16:19], s21 offen offset:2048  nt lds
M v[180:183],a[140:143],a[172:175],v[180:183]
M v[180:183],a[136:139],a[168:171],v[180:183]
M v[184:187],a[144:147],a[168:171],v[184:187]
s_nop 0
T a[88:89],v4,49152
T a[90:91],v4,50176
M v[184:187],a[148:151],a[172:175],v[184:187]
s_waitcnt lgkmcnt(4)
M v[188:191],a[156:159],a[172:175],v[188:191]
M v[188:191],a[152:155],a[168:171],v[188:191]
buffer_load_dwordx4 v11, s[16:19], s21 offen offset:3072  nt lds
M v[192:195],a[96:99],a[160:163],v[192:195]
SA s21,s21,128
R a[168:171],v5,22528
R a[172:175],v6,22528
M v[192:195],a[100:103],a[164:167],v[192:195]
M v[196:199],a[108:111],a[164:167],v[196:199]
M v[196:199],a[104:107],a[160:163],v[196:199]
s_nop 0
T a[92:93],v4,57344
T a[94:95],v4,58368
M v[200:203],a[112:115],a[160:163],v[200:203]
SA m0,s87,6144
M v[200:203],a[116:119],a[164:167],v[200:203]
buffer_load_dwordx4 v25, s[60:63], s89 offen offset:0 nt lds
M v[204:207],a[124:127],a[164:167],v[204:207]
SA s89,s89,114688
M v[204:207],a[120:123],a[160:163],v[204:207]
M v[208:211],a[128:131],a[160:163],v[208:211]
M v[208:211],a[132:135],a[164:167],v[208:211]
M v[212:215],a[140:143],a[164:167],v[212:215]
M v[212:215],a[136:139],a[160:163],v[212:215]
M v[216:219],a[144:147],a[160:163],v[216:219]
M v[216:219],a[148:151],a[164:167],v[216:219]
s_waitcnt lgkmcnt(2)
M v[220:223],a[156:159],a[164:167],v[220:223]
s_waitcnt vmcnt(21) lgkmcnt(0)
M v[220:223],a[152:155],a[160:163],v[220:223]
s_barrier
M v[224:227],a[96:99],a[168:171],v[224:227]
R a[160:163],v5,32768
R a[164:167],v6,32768
M v[224:227],a[100:103],a[172:175],v[224:227]
M v[228:231],a[108:111],a[172:175],v[228:231]
M v[228:231],a[104:107],a[168:171],v[228:231]
M v[232:235],a[112:115],a[168:171],v[232:235]
M v[232:235],a[116:119],a[172:175],v[232:235]
M v[236:239],a[124:127],a[172:175],v[236:239]
M v[236:239],a[120:123],a[168:171],v[236:239]
M v[240:243],a[128:131],a[168:171],v[240:243]
M v[240:243],a[132:135],a[172:175],v[240:243]
M v[244:247],a[140:143],a[172:175],v[244:247]
M v[244:247],a[136:139],a[168:171],v[244:247]
M v[248:251],a[144:147],a[168:171],v[248:251]
M v[248:251],a[148:151],a[172:175],v[248:251]
s_waitcnt lgkmcnt(0)
M v[252:255],a[156:159],a[172:175],v[252:255]
M v[252:255],a[152:155],a[168:171],v[252:255]
M a[0:3],a[32:35],a[160:163],a[0:3]
R a[168:171],v5,34816
R a[172:175],v6,34816
M a[0:3],a[36:39],a[164:167],a[0:3]
T a[96:97],v1,0
T a[98:99],v1,1024
M a[4:7],a[44:47],a[164:167],a[4:7]
SA m0,s24,16384
M a[4:7],a[40:43],a[160:163],a[4:7]
buffer_load_dwordx4 v12, s[48:51], s22 offen offset:0   lds
M a[8:11],a[48:51],a[160:163],a[8:11]
M a[8:11],a[52:55],a[164:167],a[8:11]
M a[12:15],a[60:63],a[164:167],a[12:15]
s_nop 0
T a[100:101],v1,8192
T a[102:103],v1,9216
M a[12:15],a[56:59],a[160:163],a[12:15]
M a[16:19],a[64:67],a[160:163],a[16:19]
buffer_load_dwordx4 v13, s[48:51], s22 offen offset:1024   lds
M a[16:19],a[68:71],a[164:167],a[16:19]
M a[20:23],a[76:79],a[164:167],a[20:23]
s_waitcnt vmcnt(9)
v_min3_u32 v28, v16, v17, v18
M a[20:23],a[72:75],a[160:163],a[20:23]
s_nop 0
T a[104:105],v2,0
T a[106:107],v2,1024
M a[24:27],a[80:83],a[160:163],a[24:27]
s_waitcnt vmcnt(8)
v_min3_u32 v28, v28, v19, v20
M a[24:27],a[84:87],a[164:167],a[24:27]
s_waitcnt lgkmcnt(6)
buffer_load_dwordx4 v14, s[48:51], s22 offen offset:2048   lds
M a[28:31],a[92:95],a[164:167],a[28:31]
v_min3_u32 v28, v28, v21, v22
M a[28:31],a[88:91],a[160:163],a[28:31]
v_min_u32 v28, v28, v23
M v[32:35],a[32:35],a[168:171],v[32:35]
R a[160:163],v5,36864
R a[164:167],v6,36864
M v[32:35],a[36:39],a[172:175],v[32:35]
T a[108:109],v2,8192
T a[110:111],v2,9216
M v[36:39],a[44:47],a[172:175],v[36:39]
buffer_load_dwordx4 v15, s[48:51], s22 offen offset:3072   lds
M v[36:39],a[40:43],a[168:171],v[36:39]
s_sub_u32 s22, s22, 1048448
v_cmp_eq_u32 vcc, 0, v28
M v[40:43],a[48:51],a[168:171],v[40:43]
s_nop 0
M v[40:43],a[52:55],a[172:175],v[40:43]
s_cbranch_vccnz L_hs
L_hr:
T a[112:113],v3,0
T a[114:115],v3,1024
M v[44:47],a[60:63],a[172:175],v[44:47]
SA m0,s23,49152
v_max_u32 v28, v16, v17
M v[44:47],a[56:59],a[168:171],v[44:47]
buffer_load_dwordx4 v8, s[16:19], s21 offen offset:0  nt lds
M v[48:51],a[64:67],a[168:171],v[48:51]
v_min_u32 v29, v16, v17
M v[48:51],a[68:71],a[172:175],v[48:51]
v_med3_u32 v29, v28, v29, v18
M v[52:55],a[76:79],a[172:175],v[52:55]
s_nop 0
T a[116:117],v3,8192
T a[118:119],v3,9216
M v[52:55],a[72:75],a[168:171],v[52:55]
v_max_u32 v28, v28, v18
M v[56:59],a[80:83],a[168:171],v[56:59]
buffer_load_dwordx4 v9, s[16:19], s21 offen offset:1024  nt lds
M v[56:59],a[84:87],a[172:175],v[56:59]
s_waitcnt lgkmcnt(6)
v_med3_u32 v29, v28, v29, v19
M v[60:63],a[92:95],a[172:175],v[60:63]
v_max_u32 v28, v28, v19
M v[60:63],a[88:91],a[168:171],v[60:63]
s_nop 0
T a[120:121],v4,0
T a[122:123],v4,1024
M v[64:67],a[32:35],a[160:163],v[64:67]
R a[168:171],v5,38912
R a[172:175],v6,38912
M v[64:67],a[36:39],a[164:167],v[64:67]
buffer_load_dwordx4 v10, s[16:19], s21 offen offset:2048  nt lds
M v[68:71],a[44:47],a[164:167],v[68:71]
v_med3_u32 v29, v28, v29, v20
M v[68:71],a[40:43],a[160:163],v[68:71]
v_max_u32 v28, v28, v20
M v[72:75],a[48:51],a[160:163],v[72:75]
s_nop 0
T a[124:125],v4,8192
T a[126:127],v4,9216
M v[72:75],a[52:55],a[164:167],v[72:75]
v_med3_u32 v29, v28, v29, v21
M v[76:79],a[60:63],a[164:167],v[76:79]
buffer_load_dwordx4 v11, s[16:19], s21 offen offset:3072  nt lds
M v[76:79],a[56:59],a[160:163],v[76:79]
SA s21,s21,524160
v_max_u32 v28, v28, v21
M v[80:83],a[64:67],a[160:163],v[80:83]
v_med3_u32 v29, v28, v29, v22
M v[80:83],a[68:71],a[164:167],v[80:83]
v_max_u32 v28, v28, v22
M v[84:87],a[76:79],a[164:167],v[84:87]
v_med3_u32 v29, v28, v29, v23
M v[84:87],a[72:75],a[160:163],v[84:87]
v_max_u32 v28, v28, v23
M v[88:91],a[80:83],a[160:163],v[88:91]
s_nop 0
v_mov_b32 v30, v28 row_ror:8 row_mask:0xf bank_mask:0xf
M v[88:91],a[84:87],a[164:167],v[88:91]
s_waitcnt lgkmcnt(2)
v_mov_b32 v31, v29 row_ror:8 row_mask:0xf bank_mask:0xf
M v[92:95],a[92:95],a[164:167],v[92:95]
s_waitcnt lgkmcnt(0)
v_min_u32 v16, v28, v30
M v[92:95],a[88:91],a[160:163],v[92:95]
s_barrier
M v[96:99],a[32:35],a[168:171],v[96:99]
R a[160:163],v5,49152
R a[164:167],v6,49152
M v[96:99],a[36:39],a[172:175],v[96:99]
v_max_u32 v28, v28, v30
M v[100:103],a[44:47],a[172:175],v[100:103]
SA m0,s24,32768
T a[128:129],v1,16384
T a[130:131],v1,17408
M v[100:103],a[40:43],a[168:171],v[100:103]
buffer_load_dwordx4 v12, s[48:51], s22 offen offset:0   lds
M v[104:107],a[48:51],a[168:171],v[104:107]
v_max3_u32 v29, v29, v31, v16
M v[104:107],a[52:55],a[172:175],v[104:107]
v_mov_b32 v30, v28 row_ror:4 row_mask:0xf bank_mask:0xf
M v[108:111],a[60:63],a[172:175],v[108:111]
v_mov_b32 v31, v29 row_ror:4 row_mask:0xf bank_mask:0xf
M v[108:111],a[56:59],a[168:171],v[108:111]
v_min_u32 v16, v28, v30
M v[112:115],a[64:67],a[168:171],v[112:115]
v_max_u32 v28, v28, v30
M v[112:115],a[68:71],a[172:175],v[112:115]
s_nop 0
T a[132:133],v1,24576
T a[134:135],v1,25600
M v[116:119],a[76:79],a[172:175],v[116:119]
buffer_load_dwordx4 v13, s[48:51], s22 offen offset:1024   lds
M v[116:119],a[72:75],a[168:171],v[116:119]
v_max3_u32 v29, v29, v31, v16
M v[120:123],a[80:83],a[168:171],v[120:123]
v_mov_b32 v30, v28 row_ror:2 row_mask:0xf bank_mask:0xf
M v[120:123],a[84:87],a[172:175],v[120:123]
s_waitcnt lgkmcnt(4)
v_mov_b32 v31, v29 row_ror:2 row_mask:0xf bank_mask:0xf
M v[124:127],a[92:95],a[172:175],v[124:127]
v_min_u32 v16, v28, v30
M v[124:127],a[88:91],a[168:171],v[124:127]
v_max_u32 v28, v28, v30
M v[128:131],a[32:35],a[160:163],v[128:131]
R a[168:171],v5,51200
R a[172:175],v6,51200
M v[128:131],a[36:39],a[164:167],v[128:131]
T a[136:137],v2,16384
T a[138:139],v2,17408
M v[132:135],a[44:47],a[164:167],v[132:135]
buffer_load_dwordx4 v14, s[48:51], s22 offen offset:2048   lds
M v[132:135],a[40:43],a[160:163],v[132:135]
v_max3_u32 v29, v29, v31, v16
M v[136:139],a[48:51],a[160:163],v[136:139]
v_mov_b32 v30, v28 row_ror:1 row_mask:0xf bank_mask:0xf
M v[136:139],a[52:55],a[164:167],v[136:139]
v_mov_b32 v31, v29 row_ror:1 row_mask:0xf bank_mask:0xf
M v[140:143],a[60:63],a[164:167],v[140:143]
v_min_u32 v16, v28, v30
M v[140:143],a[56:59],a[160:163],v[140:143]
s_nop 0
T a[140:141],v2,24576
T a[142:143],v2,25600
M v[144:147],a[64:67],a[160:163],v[144:147]
buffer_load_dwordx4 v15, s[48:51], s22 offen offset:3072   lds
M v[144:147],a[68:71],a[164:167],v[144:147]
SA s22,s22,1048576
v_max_u32 v28, v28, v30
M v[148:151],a[76:79],a[164:167],v[148:151]
v_max3_u32 v29, v29, v31, v16
M v[148:151],a[72:75],a[160:163],v[148:151]
v_mov_b32 v30, v28
M v[152:155],a[80:83],a[160:163],v[152:155]
v_mov_b32 v31, v29
M v[152:155],a[84:87],a[164:167],v[152:155]
s_waitcnt lgkmcnt(4)
v_permlane16_swap_b32 v30, v28
M v[156:159],a[92:95],a[164:167],v[156:159]
SA m0,s23,0
T a[144:145],v3,16384
T a[146:147],v3,17408
M v[156:159],a[88:91],a[160:163],v[156:159]
buffer_load_dwordx4 v8, s[16:19], s21 offen offset:0  nt lds
M v[160:163],a[32:35],a[168:171],v[160:163]
R a[160:163],v5,53248
R a[164:167],v6,53248
M v[160:163],a[36:39],a[172:175],v[160:163]
v_permlane16_swap_b32 v31, v29
M v[164:167],a[44:47],a[172:175],v[164:167]
v_min_u32 v16, v28, v30
M v[164:167],a[40:43],a[168:171],v[164:167]
v_max_u32 v28, v28, v30
M v[168:171],a[48:51],a[168:171],v[168:171]
v_max3_u32 v29, v29, v31, v16
M v[168:171],a[52:55],a[172:175],v[168:171]
s_nop 0
T a[148:149],v3,24576
T a[150:151],v3,25600
M v[172:175],a[60:63],a[172:175],v[172:175]
buffer_load_dwordx4 v9, s[16:19], s21 offen offset:1024  nt lds
M v[172:175],a[56:59],a[168:171],v[172:175]
v_mov_b32 v30, v28
M v[176:179],a[64:67],a[168:171],v[176:179]
v_mov_b32 v31, v29
M v[176:179],a[68:71],a[172:175],v[176:179]
v_permlane32_swap_b32 v30, v28
M v[180:183],a[76:79],a[172:175],v[180:183]
v_permlane32_swap_b32 v31, v29
M v[180:183],a[72:75],a[168:171],v[180:183]
v_min_u32 v16, v28, v30
M v[184:187],a[80:83],a[168:171],v[184:187]
s_nop 0
T a[152:153],v4,16384
T a[154:155],v4,17408
M v[184:187],a[84:87],a[172:175],v[184:187]
s_waitcnt lgkmcnt(4)
buffer_load_dwordx4 v10, s[16:19], s21 offen offset:2048  nt lds
M v[188:191],a[92:95],a[172:175],v[188:191]
v_max_u32 v28, v28, v30
M v[188:191],a[88:91],a[168:171],v[188:191]
v_max3_u32 v29, v29, v31, v16
M v[192:195],a[32:35],a[160:163],v[192:195]
s_lshl_b32 s64, s20, 3
R a[168:171],v5,55296
R a[172:175],v6,55296
M v[192:195],a[36:39],a[164:167],v[192:195]
SA s64,s64,159744
v_mov_b32 v16, s64
M v[196:199],a[44:47],a[164:167],v[196:199]
ds_write_b64 v16, v[28:29]
M v[196:199],a[40:43],a[160:163],v[196:199]
s_nop 0
T a[156:157],v4,24576
T a[158:159],v4,25600
M v[200:203],a[48:51],a[160:163],v[200:203]
buffer_load_dwordx4 v11, s[16:19], s21 offen offset:3072  nt lds
M v[200:203],a[52:55],a[164:167],v[200:203]
SA s21,s21,128
M v[204:207],a[60:63],a[164:167],v[204:207]
M v[204:207],a[56:59],a[160:163],v[204:207]
M v[208:211],a[64:67],a[160:163],v[208:211]
M v[208:211],a[68:71],a[164:167],v[208:211]
M v[212:215],a[76:79],a[164:167],v[212:215]
M v[212:215],a[72:75],a[160:163],v[212:215]
M v[216:219],a[80:83],a[160:163],v[216:219]
M v[216:219],a[84:87],a[164:167],v[216:219]
s_waitcnt lgkmcnt(3)
M v[220:223],a[92:95],a[164:167],v[220:223]
s_waitcnt vmcnt(17) lgkmcnt(0)
M v[220:223],a[88:91],a[160:163],v[220:223]
s_barrier
M v[224:227],a[32:35],a[168:171],v[224:227]
R a[160:163],v5,0
R a[164:167],v6,0
M v[224:227],a[36:39],a[172:175],v[224:227]
M v[228:231],a[44:47],a[172:175],v[228:231]
M v[228:231],a[40:43],a[168:171],v[228:231]
M v[232:235],a[48:51],a[168:171],v[232:235]
M v[232:235],a[52:55],a[172:175],v[232:235]
M v[236:239],a[60:63],a[172:175],v[236:239]
M v[236:239],a[56:59],a[168:171],v[236:239]
M v[240:243],a[64:67],a[168:171],v[240:243]
M v[240:243],a[68:71],a[172:175],v[240:243]
M v[244:247],a[76:79],a[172:175],v[244:247]
M v[244:247],a[72:75],a[168:171],v[244:247]
M v[248:251],a[80:83],a[168:171],v[248:251]
M v[248:251],a[84:87],a[172:175],v[248:251]
s_waitcnt lgkmcnt(0)
M v[252:255],a[92:95],a[172:175],v[252:255]
M v[252:255],a[88:91],a[168:171],v[252:255]
M a[0:3],a[96:99],a[160:163],a[0:3]
R a[168:171],v5,2048
R a[172:175],v6,2048
M a[0:3],a[100:103],a[164:167],a[0:3]
T a[32:33],v1,32768
T a[34:35],v1,33792
M a[4:7],a[108:111],a[164:167],a[4:7]
SA m0,s24,49152
M a[4:7],a[104:107],a[160:163],a[4:7]
buffer_load_dwordx4 v12, s[48:51], s22 offen offset:0   lds
M a[8:11],a[112:115],a[160:163],a[8:11]
v_mov_b32 v28, 159744
M a[8:11],a[116:119],a[164:167],a[8:11]
ds_read_b128 v[16:19], v28
M a[12:15],a[124:127],a[164:167],a[12:15]
s_nop 0
T a[36:37],v1,40960
T a[38:39],v1,41984
M a[12:15],a[120:123],a[160:163],a[12:15]
R v[20:23],v28,16
M a[16:19],a[128:131],a[160:163],a[16:19]
buffer_load_dwordx4 v13, s[48:51], s22 offen offset:1024   lds
M a[16:19],a[132:135],a[164:167],a[16:19]
M a[20:23],a[140:143],a[164:167],a[20:23]
M a[20:23],a[136:139],a[160:163],a[20:23]
s_nop 0
T a[40:41],v2,32768
T a[42:43],v2,33792
M a[24:27],a[144:147],a[160:163],a[24:27]
M a[24:27],a[148:151],a[164:167],a[24:27]
s_waitcnt lgkmcnt(8)
buffer_load_dwordx4 v14, s[48:51], s22 offen offset:2048   lds
M a[28:31],a[156:159],a[164:167],a[28:31]
M a[28:31],a[152:155],a[160:163],a[28:31]
M v[32:35],a[96:99],a[168:171],v[32:35]
R a[160:163],v5,4096
R a[164:167],v6,4096
M v[32:35],a[100:103],a[172:175],v[32:35]
T a[44:45],v2,40960
T a[46:47],v2,41984
M v[36:39],a[108:111],a[172:175],v[36:39]
buffer_load_dwordx4 v15, s[48:51], s22 offen offset:3072   lds
M v[36:39],a[104:107],a[168:171],v[36:39]
s_sub_u32 s22, s22, 1048448
s_waitcnt lgkmcnt(9)
v_min_u32 v28, v16, v18
M v[40:43],a[112:115],a[168:171],v[40:43]
v_max_u32 v16, v16, v18
M v[40:43],a[116:119],a[172:175],v[40:43]
s_nop 0
T a[48:49],v3,32768
T a[50:51],v3,33792
M v[44:47],a[124:127],a[172:175],v[44:47]
SA m0,s23,16384
v_max3_u32 v17, v17, v19, v28
M v[44:47],a[120:123],a[168:171],v[44:47]
buffer_load_dwordx4 v8, s[16:19], s21 offen offset:0  nt lds
M v[48:51],a[128:131],a[168:171],v[48:51]
s_waitcnt lgkmcnt(8)
v_min_u32 v29, v20, v22
M v[48:51],a[132:135],a[172:175],v[48:51]
v_max_u32 v20, v20, v22
M v[52:55],a[140:143],a[172:175],v[52:55]
s_nop 0
T a[52:53],v3,40960
T a[54:55],v3,41984
M v[52:55],a[136:139],a[168:171],v[52:55]
v_max3_u32 v21, v21, v23, v29
M v[56:59],a[144:147],a[168:171],v[56:59]
buffer_load_dwordx4 v9, s[16:19], s21 offen offset:1024  nt lds
M v[56:59],a[148:151],a[172:175],v[56:59]
s_waitcnt lgkmcnt(6)
v_min_u32 v28, v16, v20
M v[60:63],a[156:159],a[172:175],v[60:63]
v_max_u32 v16, v16, v20
M v[60:63],a[152:155],a[168:171],v[60:63]
s_nop 0
T a[56:57],v4,32768
T a[58:59],v4,33792
M v[64:67],a[96:99],a[160:163],v[64:67]
R a[168:171],v5,6144
R a[172:175],v6,6144
M v[64:67],a[100:103],a[164:167],v[64:67]
buffer_load_dwordx4 v10, s[16:19], s21 offen offset:2048  nt lds
M v[68:71],a[108:111],a[164:167],v[68:71]
v_max3_u32 v17, v17, v21, v28
M v[68:71],a[104:107],a[160:163],v[68:71]
v_and_b32 v28, 1, v0
M v[72:75],a[112:115],a[160:163],v[72:75]
s_nop 0
T a[60:61],v4,40960
T a[62:63],v4,41984
M v[72:75],a[116:119],a[164:167],v[72:75]
v_cmp_eq_u32 vcc, 0, v28
M v[76:79],a[124:127],a[164:167],v[76:79]
s_and_b32 s64, s20, 1
buffer_load_dwordx4 v11, s[16:19], s21 offen offset:3072  nt lds
M v[76:79],a[120:123],a[160:163],v[76:79]
SA s21,s21,524160
s_mul_i32 s64, s64, 448
v_cndmask_b32 v24, v17, v16, vcc
M v[80:83],a[128:131],a[160:163],v[80:83]
v_and_b32 v24, 0x7ff, v24
M v[80:83],a[132:135],a[164:167],v[80:83]
v_sub_u32 v24, 2047, v24
M v[84:87],a[140:143],a[164:167],v[84:87]
v_mul_u32_u24 v28, 896, v24
M v[84:87],a[136:139],a[160:163],v[84:87]
v_lshrrev_b32 v29, 4, v0
M v[88:91],a[144:147],a[160:163],v[88:91]
v_lshl_add_u32 v28, v29, 4, v28
M v[88:91],a[148:151],a[164:167],v[88:91]
s_waitcnt lgkmcnt(2)
v_bfe_u32 v30, v0, 1, 3
M v[92:95],a[156:159],a[164:167],v[92:95]
s_waitcnt vmcnt(16) lgkmcnt(0)
v_lshl_or_b32 v28, v30, 26, v28
M v[92:95],a[152:155],a[160:163],v[92:95]
s_barrier
M v[96:99],a[96:99],a[168:171],v[96:99]
R a[160:163],v5,16384
R a[164:167],v6,16384
M v[96:99],a[100:103],a[172:175],v[96:99]
buffer_load_dwordx4 a[208:211], v28, s[56:59], s64 offen offset:0
M v[100:103],a[108:111],a[172:175],v[100:103]
SA m0,s24,0
T a[64:65],v1,49152
T a[66:67],v1,50176
M v[100:103],a[104:107],a[168:171],v[100:103]
buffer_load_dwordx4 v12, s[48:51], s22 offen offset:0   lds
M v[104:107],a[112:115],a[168:171],v[104:107]
M v[104:107],a[116:119],a[172:175],v[104:107]
M v[108:111],a[124:127],a[172:175],v[108:111]
buffer_load_dwordx4 a[212:215], v28, s[56:59], s64 offen offset:64
M v[108:111],a[120:123],a[168:171],v[108:111]
M v[112:115],a[128:131],a[168:171],v[112:115]
buffer_load_dwordx4 a[216:219], v28, s[56:59], s64 offen offset:128
M v[112:115],a[132:135],a[172:175],v[112:115]
s_nop 0
T a[68:69],v1,57344
T a[70:71],v1,58368
M v[116:119],a[140:143],a[172:175],v[116:119]
buffer_load_dwordx4 v13, s[48:51], s22 offen offset:1024   lds
M v[116:119],a[136:139],a[168:171],v[116:119]
M v[120:123],a[144:147],a[168:171],v[120:123]
M v[120:123],a[148:151],a[172:175],v[120:123]
s_waitcnt lgkmcnt(4)
M v[124:127],a[156:159],a[172:175],v[124:127]
buffer_load_dwordx4 a[220:223], v28, s[56:59], s64 offen offset:192
M v[124:127],a[152:155],a[168:171],v[124:127]
M v[128:131],a[96:99],a[160:163],v[128:131]
R a[168:171],v5,18432
R a[172:175],v6,18432
M v[128:131],a[100:103],a[164:167],v[128:131]
T a[72:73],v2,49152
T a[74:75],v2,50176
M v[132:135],a[108:111],a[164:167],v[132:135]
buffer_load_dwordx4 v14, s[48:51], s22 offen offset:2048   lds
M v[132:135],a[104:107],a[160:163],v[132:135]
M v[136:139],a[112:115],a[160:163],v[136:139]
buffer_load_dwordx4 a[224:227], v28, s[56:59], s64 offen offset:256
M v[136:139],a[116:119],a[164:167],v[136:139]
M v[140:143],a[124:127],a[164:167],v[140:143]
buffer_load_dwordx4 a[228:231], v28, s[56:59], s64 offen offset:320
M v[140:143],a[120:123],a[160:163],v[140:143]
s_nop 0
T a[76:77],v2,57344
T a[78:79],v2,58368
M v[144:147],a[128:131],a[160:163],v[144:147]
buffer_load_dwordx4 v15, s[48:51], s22 offen offset:3072   lds
M v[144:147],a[132:135],a[164:167],v[144:147]
SA s22,s22,1048576
M v[148:151],a[140:143],a[164:167],v[148:151]
M v[148:151],a[136:139],a[160:163],v[148:151]
buffer_load_dwordx4 a[232:235], v28, s[56:59], s64 offen offset:384
M v[152:155],a[144:147],a[160:163],v[152:155]
v_lshrrev_b32 v28, 4, v24
M v[152:155],a[148:151],a[164:167],v[152:155]
s_waitcnt lgkmcnt(4)
v_lshlrev_b32 v28, 5, v28
M v[156:159],a[156:159],a[164:167],v[156:159]
SA m0,s23,32768
T a[80:81],v3,49152
T a[82:83],v3,50176
L_w_kv04:
s_cbranch_execz L_w_kv08
M v[156:159],a[152:155],a[160:163],v[156:159]
buffer_load_dwordx4 v8, s[16:19], s21 offen offset:0  nt lds
M v[160:163],a[96:99],a[168:171],v[160:163]
R a[160:163],v5,20480
R a[164:167],v6,20480
M v[160:163],a[100:103],a[172:175],v[160:163]
v_and_b32 v30, 15, v24
M v[164:167],a[108:111],a[172:175],v[164:167]
v_add_lshl_u32 v28, v28, v30, 2
M v[164:167],a[104:107],a[168:171],v[164:167]
v_lshrrev_b32 v30, 1, v0
M v[168:171],a[112:115],a[168:171],v[168:171]
v_min_u32 v30, 1, v30
M v[168:171],a[116:119],a[172:175],v[168:171]
s_nop 0
T a[84:85],v3,57344
T a[86:87],v3,58368
M v[172:175],a[124:127],a[172:175],v[172:175]
buffer_load_dwordx4 v9, s[16:19], s21 offen offset:1024  nt lds
M v[172:175],a[120:123],a[168:171],v[172:175]
v_lshl_or_b32 v28, v30, 29, v28
M v[176:179],a[128:131],a[168:171],v[176:179]
s_mov_b32 s64, 104857600
buffer_load_dword v23, v28, s[8:11], s64 offen sc1
M v[176:179],a[132:135],a[172:175],v[176:179]
v_bfe_u32 v28, v0, 2, 2
M v[180:183],a[140:143],a[172:175],v[180:183]
v_lshl_add_u32 v28, v29, 3, v28
M v[180:183],a[136:139],a[168:171],v[180:183]
v_lshlrev_b32 v28, 5, v28
M v[184:187],a[144:147],a[168:171],v[184:187]
s_nop 0
T a[88:89],v4,49152
T a[90:91],v4,50176
M v[184:187],a[148:151],a[172:175],v[184:187]
s_waitcnt lgkmcnt(4)
buffer_load_dwordx4 v10, s[16:19], s21 offen offset:2048  nt lds
M v[188:191],a[156:159],a[172:175],v[188:191]
v_and_b32 v30, 3, v0
M v[188:191],a[152:155],a[168:171],v[188:191]
v_lshl_add_u32 v28, v30, 3, v28
M v[192:195],a[96:99],a[160:163],v[192:195]
R a[168:171],v5,22528
R a[172:175],v6,22528
M v[192:195],a[100:103],a[164:167],v[192:195]
v_add_u32 v22, s87, v28
M v[196:199],a[108:111],a[164:167],v[196:199]
M v[196:199],a[104:107],a[160:163],v[196:199]
s_nop 0
T a[92:93],v4,57344
T a[94:95],v4,58368
M v[200:203],a[112:115],a[160:163],v[200:203]
buffer_load_dwordx4 v11, s[16:19], s21 offen offset:3072  nt lds
M v[200:203],a[116:119],a[164:167],v[200:203]
SA s21,s21,128
M v[204:207],a[124:127],a[164:167],v[204:207]
M v[204:207],a[120:123],a[160:163],v[204:207]
M v[208:211],a[128:131],a[160:163],v[208:211]
M v[208:211],a[132:135],a[164:167],v[208:211]
M v[212:215],a[140:143],a[164:167],v[212:215]
M v[212:215],a[136:139],a[160:163],v[212:215]
M v[216:219],a[144:147],a[160:163],v[216:219]
M v[216:219],a[148:151],a[164:167],v[216:219]
s_waitcnt lgkmcnt(2)
M v[220:223],a[156:159],a[164:167],v[220:223]
s_waitcnt vmcnt(24) lgkmcnt(0)
M v[220:223],a[152:155],a[160:163],v[220:223]
s_barrier
M v[224:227],a[96:99],a[168:171],v[224:227]
R a[160:163],v5,32768
R a[164:167],v6,32768
M v[224:227],a[100:103],a[172:175],v[224:227]
M v[228:231],a[108:111],a[172:175],v[228:231]
M v[228:231],a[104:107],a[168:171],v[228:231]
M v[232:235],a[112:115],a[168:171],v[232:235]
M v[232:235],a[116:119],a[172:175],v[232:235]
M v[236:239],a[124:127],a[172:175],v[236:239]
M v[236:239],a[120:123],a[168:171],v[236:239]
M v[240:243],a[128:131],a[168:171],v[240:243]
M v[240:243],a[132:135],a[172:175],v[240:243]
M v[244:247],a[140:143],a[172:175],v[244:247]
M v[244:247],a[136:139],a[168:171],v[244:247]
M v[248:251],a[144:147],a[168:171],v[248:251]
M v[248:251],a[148:151],a[172:175],v[248:251]
s_waitcnt lgkmcnt(0)
M v[252:255],a[156:159],a[172:175],v[252:255]
M v[252:255],a[152:155],a[168:171],v[252:255]
M a[0:3],a[32:35],a[160:163],a[0:3]
R a[168:171],v5,34816
R a[172:175],v6,34816
M a[0:3],a[36:39],a[164:167],a[0:3]
T a[96:97],v1,0
T a[98:99],v1,1024
M a[4:7],a[44:47],a[164:167],a[4:7]
SA m0,s24,16384
M a[4:7],a[40:43],a[160:163],a[4:7]
buffer_load_dwordx4 v12, s[48:51], s22 offen offset:0   lds
M a[8:11],a[48:51],a[160:163],a[8:11]
M a[8:11],a[52:55],a[164:167],a[8:11]
M a[12:15],a[60:63],a[164:167],a[12:15]
s_nop 0
T a[100:101],v1,8192
T a[102:103],v1,9216
M a[12:15],a[56:59],a[160:163],a[12:15]
M a[16:19],a[64:67],a[160:163],a[16:19]
buffer_load_dwordx4 v13, s[48:51], s22 offen offset:1024   lds
M a[16:19],a[68:71],a[164:167],a[16:19]
M a[20:23],a[76:79],a[164:167],a[20:23]
M a[20:23],a[72:75],a[160:163],a[20:23]
s_nop 0
T a[104:105],v2,0
T a[106:107],v2,1024
M a[24:27],a[80:83],a[160:163],a[24:27]
M a[24:27],a[84:87],a[164:167],a[24:27]
s_waitcnt lgkmcnt(6)
buffer_load_dwordx4 v14, s[48:51], s22 offen offset:2048   lds
M a[28:31],a[92:95],a[164:167],a[28:31]
M a[28:31],a[88:91],a[160:163],a[28:31]
M v[32:35],a[32:35],a[168:171],v[32:35]
R a[160:163],v5,36864
R a[164:167],v6,36864
M v[32:35],a[36:39],a[172:175],v[32:35]
T a[108:109],v2,8192
T a[110:111],v2,9216
M v[36:39],a[44:47],a[172:175],v[36:39]
buffer_load_dwordx4 v15, s[48:51], s22 offen offset:3072   lds
M v[36:39],a[40:43],a[168:171],v[36:39]
s_sub_u32 s22, s22, 1048448
M v[40:43],a[48:51],a[168:171],v[40:43]
M v[40:43],a[52:55],a[172:175],v[40:43]
s_nop 0
T a[112:113],v3,0
T a[114:115],v3,1024
M v[44:47],a[60:63],a[172:175],v[44:47]
SA m0,s23,49152
M v[44:47],a[56:59],a[168:171],v[44:47]
buffer_load_dwordx4 v8, s[16:19], s21 offen offset:0  nt lds
M v[48:51],a[64:67],a[168:171],v[48:51]
M v[48:51],a[68:71],a[172:175],v[48:51]
M v[52:55],a[76:79],a[172:175],v[52:55]
s_nop 0
T a[116:117],v3,8192
T a[118:119],v3,9216
M v[52:55],a[72:75],a[168:171],v[52:55]
M v[56:59],a[80:83],a[168:171],v[56:59]
buffer_load_dwordx4 v9, s[16:19], s21 offen offset:1024  nt lds
M v[56:59],a[84:87],a[172:175],v[56:59]
s_waitcnt lgkmcnt(6)
M v[60:63],a[92:95],a[172:175],v[60:63]
M v[60:63],a[88:91],a[168:171],v[60:63]
s_nop 0
T a[120:121],v4,0
T a[122:123],v4,1024
M v[64:67],a[32:35],a[160:163],v[64:67]
R a[168:171],v5,38912
R a[172:175],v6,38912
M v[64:67],a[36:39],a[164:167],v[64:67]
buffer_load_dwordx4 v10, s[16:19], s21 offen offset:2048  nt lds
M v[68:71],a[44:47],a[164:167],v[68:71]
M v[68:71],a[40:43],a[160:163],v[68:71]
M v[72:75],a[48:51],a[160:163],v[72:75]
s_nop 0
T a[124:125],v4,8192
T a[126:127],v4,9216
M v[72:75],a[52:55],a[164:167],v[72:75]
M v[76:79],a[60:63],a[164:167],v[76:79]
buffer_load_dwordx4 v11, s[16:19], s21 offen offset:3072  nt lds
M v[76:79],a[56:59],a[160:163],v[76:79]
SA s21,s21,524160
M v[80:83],a[64:67],a[160:163],v[80:83]
M v[80:83],a[68:71],a[164:167],v[80:83]
M v[84:87],a[76:79],a[164:167],v[84:87]
M v[84:87],a[72:75],a[160:163],v[84:87]
M v[88:91],a[80:83],a[160:163],v[88:91]
M v[88:91],a[84:87],a[164:167],v[88:91]
s_waitcnt lgkmcnt(2)
M v[92:95],a[92:95],a[164:167],v[92:95]
s_waitcnt vmcnt(24) lgkmcnt(0)
M v[92:95],a[88:91],a[160:163],v[92:95]
s_barrier
M v[96:99],a[32:35],a[168:171],v[96:99]
R a[160:163],v5,49152
R a[164:167],v6,49152
M v[96:99],a[36:39],a[172:175],v[96:99]
M v[100:103],a[44:47],a[172:175],v[100:103]
SA m0,s24,32768
T a[128:129],v1,16384
T a[130:131],v1,17408
M v[100:103],a[40:43],a[168:171],v[100:103]
buffer_load_dwordx4 v12, s[48:51], s22 offen offset:0   lds
M v[104:107],a[48:51],a[168:171],v[104:107]
s_nop 0
T a[176:177],v22,0
T a[178:179],v22,128
M v[104:107],a[52:55],a[172:175],v[104:107]
T a[180:181],v22,1024
T a[182:183],v22,1152
M v[108:111],a[60:63],a[172:175],v[108:111]
T a[184:185],v22,2048
T a[186:187],v22,2176
M v[108:111],a[56:59],a[168:171],v[108:111]
T a[188:189],v22,3072
T a[190:191],v22,3200
M v[112:115],a[64:67],a[168:171],v[112:115]
M v[112:115],a[68:71],a[172:175],v[112:115]
s_nop 0
T a[132:133],v1,24576
T a[134:135],v1,25600
M v[116:119],a[76:79],a[172:175],v[116:119]
buffer_load_dwordx4 v13, s[48:51], s22 offen offset:1024   lds
M v[116:119],a[72:75],a[168:171],v[116:119]
M v[120:123],a[80:83],a[168:171],v[120:123]
M v[120:123],a[84:87],a[172:175],v[120:123]
s_waitcnt lgkmcnt(12)
M v[124:127],a[92:95],a[172:175],v[124:127]
M v[124:127],a[88:91],a[168:171],v[124:127]
M v[128:131],a[32:35],a[160:163],v[128:131]
R a[168:171],v5,51200
R a[172:175],v6,51200
M v[128:131],a[36:39],a[164:167],v[128:131]
T a[136:137],v2,16384
T a[138:139],v2,17408
M v[132:135],a[44:47],a[164:167],v[132:135]
buffer_load_dwordx4 v14, s[48:51], s22 offen offset:2048   lds
M v[132:135],a[40:43],a[160:163],v[132:135]
M v[136:139],a[48:51],a[160:163],v[136:139]
M v[136:139],a[52:55],a[164:167],v[136:139]
M v[140:143],a[60:63],a[164:167],v[140:143]
M v[140:143],a[56:59],a[160:163],v[140:143]
s_nop 0
T a[140:141],v2,24576
T a[142:143],v2,25600
M v[144:147],a[64:67],a[160:163],v[144:147]
buffer_load_dwordx4 v15, s[48:51], s22 offen offset:3072   lds
M v[144:147],a[68:71],a[164:167],v[144:147]
SA s22,s22,1048576
M v[148:151],a[76:79],a[164:167],v[148:151]
M v[148:151],a[72:75],a[160:163],v[148:151]
M v[152:155],a[80:83],a[160:163],v[152:155]
M v[152:155],a[84:87],a[164:167],v[152:155]
s_waitcnt lgkmcnt(4)
M v[156:159],a[92:95],a[164:167],v[156:159]
SA m0,s23,0
T a[144:145],v3,16384
T a[146:147],v3,17408
M v[156:159],a[88:91],a[160:163],v[156:159]
buffer_load_dwordx4 v8, s[16:19], s21 offen offset:0  nt lds
s_waitcnt vmcnt(28)
M v[16:19],a[176:179],a[208:211],0
s_waitcnt vmcnt(26)
M v[16:19],a[180:183],a[212:215],v[16:19]
s_waitcnt vmcnt(25)
M v[16:19],a[184:187],a[216:219],v[16:19]
s_waitcnt vmcnt(23)
M v[16:19],a[188:191],a[220:223],v[16:19]
M v[160:163],a[32:35],a[168:171],v[160:163]
R a[160:163],v5,53248
R a[164:167],v6,53248
M v[160:163],a[36:39],a[172:175],v[160:163]
T a[176:177],v22,4096
T a[178:179],v22,4224
M v[164:167],a[44:47],a[172:175],v[164:167]
T a[180:181],v22,5120
T a[182:183],v22,5248
M v[164:167],a[40:43],a[168:171],v[164:167]
T a[184:185],v22,6144
T a[186:187],v22,6272
M v[168:171],a[48:51],a[168:171],v[168:171]
M v[168:171],a[52:55],a[172:175],v[168:171]
s_nop 0
T a[148:149],v3,24576
T a[150:151],v3,25600
M v[172:175],a[60:63],a[172:175],v[172:175]
buffer_load_dwordx4 v9, s[16:19], s21 offen offset:1024  nt lds
M v[172:175],a[56:59],a[168:171],v[172:175]
M v[176:179],a[64:67],a[168:171],v[176:179]
M v[176:179],a[68:71],a[172:175],v[176:179]
M v[180:183],a[76:79],a[172:175],v[180:183]
M v[180:183],a[72:75],a[168:171],v[180:183]
M v[184:187],a[80:83],a[168:171],v[184:187]
s_nop 0
T a[152:153],v4,16384
T a[154:155],v4,17408
M v[184:187],a[84:87],a[172:175],v[184:187]
s_waitcnt lgkmcnt(10)
buffer_load_dwordx4 v10, s[16:19], s21 offen offset:2048  nt lds
M v[188:191],a[92:95],a[172:175],v[188:191]
M v[188:191],a[88:91],a[168:171],v[188:191]
M v[192:195],a[32:35],a[160:163],v[192:195]
R a[168:171],v5,55296
R a[172:175],v6,55296
M v[192:195],a[36:39],a[164:167],v[192:195]
M v[196:199],a[44:47],a[164:167],v[196:199]
M v[196:199],a[40:43],a[160:163],v[196:199]
s_nop 0
T a[156:157],v4,24576
T a[158:159],v4,25600
M v[200:203],a[48:51],a[160:163],v[200:203]
buffer_load_dwordx4 v11, s[16:19], s21 offen offset:3072  nt lds
M v[200:203],a[52:55],a[164:167],v[200:203]
SA s21,s21,128
M v[204:207],a[60:63],a[164:167],v[204:207]
M v[204:207],a[56:59],a[160:163],v[204:207]
M v[208:211],a[64:67],a[160:163],v[208:211]
M v[208:211],a[68:71],a[164:167],v[208:211]
M v[212:215],a[76:79],a[164:167],v[212:215]
M v[212:215],a[72:75],a[160:163],v[212:215]
M v[216:219],a[80:83],a[160:163],v[216:219]
M v[216:219],a[84:87],a[164:167],v[216:219]
s_waitcnt lgkmcnt(2)
M v[220:223],a[92:95],a[164:167],v[220:223]
s_waitcnt vmcnt(16) lgkmcnt(0)
M v[220:223],a[88:91],a[160:163],v[220:223]
s_barrier
M v[16:19],a[176:179],a[224:227],v[16:19]
M v[16:19],a[180:183],a[228:231],v[16:19]
M v[16:19],a[184:187],a[232:235],v[16:19]
M v[224:227],a[32:35],a[168:171],v[224:227]
R a[160:163],v5,0
R a[164:167],v6,0
M v[224:227],a[36:39],a[172:175],v[224:227]
M v[228:231],a[44:47],a[172:175],v[228:231]
M v[228:231],a[40:43],a[168:171],v[228:231]
M v[232:235],a[48:51],a[168:171],v[232:235]
M v[232:235],a[52:55],a[172:175],v[232:235]
M v[236:239],a[60:63],a[172:175],v[236:239]
M v[236:239],a[56:59],a[168:171],v[236:239]
M v[240:243],a[64:67],a[168:171],v[240:243]
M v[240:243],a[68:71],a[172:175],v[240:243]
M v[244:247],a[76:79],a[172:175],v[244:247]
M v[244:247],a[72:75],a[168:171],v[244:247]
M v[248:251],a[80:83],a[168:171],v[248:251]
M v[248:251],a[84:87],a[172:175],v[248:251]
s_waitcnt lgkmcnt(0)
M v[252:255],a[92:95],a[172:175],v[252:255]
M v[252:255],a[88:91],a[168:171],v[252:255]
M a[0:3],a[96:99],a[160:163],a[0:3]
R a[168:171],v5,2048
R a[172:175],v6,2048
M a[0:3],a[100:103],a[164:167],a[0:3]
T a[32:33],v1,32768
T a[34:35],v1,33792
M a[4:7],a[108:111],a[164:167],a[4:7]
SA m0,s24,49152
M a[4:7],a[104:107],a[160:163],a[4:7]
buffer_load_dwordx4 v12, s[48:51], s22 offen offset:0   lds
M a[8:11],a[112:115],a[160:163],a[8:11]
M a[8:11],a[116:119],a[164:167],a[8:11]
s_lshl_b32 s64, s20, 10
M a[12:15],a[124:127],a[164:167],a[12:15]
SA s64,s64,159744
T a[36:37],v1,40960
T a[38:39],v1,41984
M a[12:15],a[120:123],a[160:163],a[12:15]
v_add_u32 v21, s64, v7
ds_write_b128 v21, v[16:19]
M a[16:19],a[128:131],a[160:163],a[16:19]
s_mul_i32 s67, s86, 14336
buffer_load_dwordx4 v13, s[48:51], s22 offen offset:1024   lds
M a[16:19],a[132:135],a[164:167],a[16:19]
s_mul_i32 s64, s20, 224
M a[20:23],a[140:143],a[164:167],a[20:23]
SA s67,s67,s64
v_lshrrev_b32 v28, 4, v0
v_mul_u32_u24 v28, 896, v28
M a[20:23],a[136:139],a[160:163],a[20:23]
T a[40:41],v2,32768
T a[42:43],v2,33792
M a[24:27],a[144:147],a[160:163],a[24:27]
v_and_b32 v29, 15, v0
v_lshl_add_u32 v28, v29, 4, v28
M a[24:27],a[148:151],a[164:167],a[24:27]
s_waitcnt lgkmcnt(7)
buffer_load_dwordx4 v14, s[48:51], s22 offen offset:2048   lds
M a[28:31],a[156:159],a[164:167],a[28:31]
v_mov_b32 v30, 536870912
v_cmp_gt_u32 vcc, 14, v29
M a[28:31],a[152:155],a[160:163],a[28:31]
s_nop 0
M v[32:35],a[96:99],a[168:171],v[32:35]
s_nop 0
R a[160:163],v5,4096
R a[164:167],v6,4096
M v[32:35],a[100:103],a[172:175],v[32:35]
T a[44:45],v2,40960
T a[46:47],v2,41984
M v[36:39],a[108:111],a[172:175],v[36:39]
buffer_load_dwordx4 v15, s[48:51], s22 offen offset:3072   lds
M v[36:39],a[104:107],a[168:171],v[36:39]
s_sub_u32 s22, s22, 1048448
v_cndmask_b32 v28, v30, v28, vcc
v_add_u32 v29, 2560, v28
M v[40:43],a[112:115],a[168:171],v[40:43]
v_add_u32 v30, 5120, v28
v_add_u32 v31, 7680, v28
M v[40:43],a[116:119],a[172:175],v[40:43]
T a[48:49],v3,32768
T a[50:51],v3,33792
M v[44:47],a[124:127],a[172:175],v[44:47]
SA m0,s23,16384
M v[44:47],a[120:123],a[168:171],v[44:47]
buffer_load_dwordx4 v8, s[16:19], s21 offen offset:0  nt lds
M v[48:51],a[128:131],a[168:171],v[48:51]
M v[48:51],a[132:135],a[172:175],v[48:51]
M v[52:55],a[140:143],a[172:175],v[52:55]
s_nop 0
T a[52:53],v3,40960
T a[54:55],v3,41984
M v[52:55],a[136:139],a[168:171],v[52:55]
M v[56:59],a[144:147],a[168:171],v[56:59]
buffer_load_dwordx4 v9, s[16:19], s21 offen offset:1024  nt lds
M v[56:59],a[148:151],a[172:175],v[56:59]
s_waitcnt lgkmcnt(6)
M v[60:63],a[156:159],a[172:175],v[60:63]
M v[60:63],a[152:155],a[168:171],v[60:63]
s_nop 0
T a[56:57],v4,32768
T a[58:59],v4,33792
M v[64:67],a[96:99],a[160:163],v[64:67]
R a[168:171],v5,6144
R a[172:175],v6,6144
M v[64:67],a[100:103],a[164:167],v[64:67]
buffer_load_dwordx4 v10, s[16:19], s21 offen offset:2048  nt lds
M v[68:71],a[108:111],a[164:167],v[68:71]
M v[68:71],a[104:107],a[160:163],v[68:71]
M v[72:75],a[112:115],a[160:163],v[72:75]
s_nop 0
T a[60:61],v4,40960
T a[62:63],v4,41984
M v[72:75],a[116:119],a[164:167],v[72:75]
M v[76:79],a[124:127],a[164:167],v[76:79]
buffer_load_dwordx4 v11, s[16:19], s21 offen offset:3072  nt lds
M v[76:79],a[120:123],a[160:163],v[76:79]
SA s21,s21,524160
M v[80:83],a[128:131],a[160:163],v[80:83]
M v[80:83],a[132:135],a[164:167],v[80:83]
M v[84:87],a[140:143],a[164:167],v[84:87]
M v[84:87],a[136:139],a[160:163],v[84:87]
M v[88:91],a[144:147],a[160:163],v[88:91]
M v[88:91],a[148:151],a[164:167],v[88:91]
s_waitcnt lgkmcnt(2)
M v[92:95],a[156:159],a[164:167],v[92:95]
s_waitcnt vmcnt(16) lgkmcnt(0)
M v[92:95],a[152:155],a[160:163],v[92:95]
s_barrier
M v[96:99],a[96:99],a[168:171],v[96:99]
R a[160:163],v5,16384
R a[164:167],v6,16384
M v[96:99],a[100:103],a[172:175],v[96:99]
M v[100:103],a[108:111],a[172:175],v[100:103]
SA m0,s24,0
T a[64:65],v1,49152
T a[66:67],v1,50176
M v[100:103],a[104:107],a[168:171],v[100:103]
buffer_load_dwordx4 v12, s[48:51], s22 offen offset:0   lds
M v[104:107],a[112:115],a[168:171],v[104:107]
M v[104:107],a[116:119],a[172:175],v[104:107]
M v[108:111],a[124:127],a[172:175],v[108:111]
M v[108:111],a[120:123],a[168:171],v[108:111]
buffer_load_dwordx4 v13, s[48:51], s22 offen offset:1024   lds
M v[112:115],a[128:131],a[168:171],v[112:115]
M v[112:115],a[132:135],a[172:175],v[112:115]
s_nop 0
T a[68:69],v1,57344
T a[70:71],v1,58368
M v[116:119],a[140:143],a[172:175],v[116:119]
M v[116:119],a[136:139],a[168:171],v[116:119]
M v[120:123],a[144:147],a[168:171],v[120:123]
buffer_load_dwordx4 v14, s[48:51], s22 offen offset:2048   lds
M v[120:123],a[148:151],a[172:175],v[120:123]
s_waitcnt lgkmcnt(4)
M v[124:127],a[156:159],a[172:175],v[124:127]
M v[124:127],a[152:155],a[168:171],v[124:127]
M v[128:131],a[96:99],a[160:163],v[128:131]
R a[168:171],v5,18432
R a[172:175],v6,18432
M v[128:131],a[100:103],a[164:167],v[128:131]
T a[72:73],v2,49152
T a[74:75],v2,50176
M v[132:135],a[108:111],a[164:167],v[132:135]
buffer_load_dwordx4 v15, s[48:51], s22 offen offset:3072   lds
M v[132:135],a[104:107],a[160:163],v[132:135]
SA s22,s22,1048576
M v[136:139],a[112:115],a[160:163],v[136:139]
M v[136:139],a[116:119],a[164:167],v[136:139]
SA m0,s23,32768
M v[140:143],a[124:127],a[164:167],v[140:143]
buffer_load_dwordx4 v8, s[16:19], s21 offen offset:0  nt lds
M v[140:143],a[120:123],a[160:163],v[140:143]
s_nop 0
T a[76:77],v2,57344
T a[78:79],v2,58368
M v[144:147],a[128:131],a[160:163],v[144:147]
M v[144:147],a[132:135],a[164:167],v[144:147]
M v[148:151],a[140:143],a[164:167],v[148:151]
buffer_load_dwordx4 v9, s[16:19], s21 offen offset:1024  nt lds
M v[148:151],a[136:139],a[160:163],v[148:151]
M v[152:155],a[144:147],a[160:163],v[152:155]
M v[152:155],a[148:151],a[164:167],v[152:155]
s_waitcnt lgkmcnt(4)
M v[156:159],a[156:159],a[164:167],v[156:159]
s_nop 0
T a[80:81],v3,49152
T a[82:83],v3,50176
M v[156:159],a[152:155],a[160:163],v[156:159]
buffer_load_dwordx4 v10, s[16:19], s21 offen offset:2048  nt lds
M v[160:163],a[96:99],a[168:171],v[160:163]
R a[160:163],v5,20480
R a[164:167],v6,20480
M v[160:163],a[100:103],a[172:175],v[160:163]
M v[164:167],a[108:111],a[172:175],v[164:167]
M v[164:167],a[104:107],a[168:171],v[164:167]
M v[168:171],a[112:115],a[168:171],v[168:171]
buffer_load_dwordx4 v11, s[16:19], s21 offen offset:3072  nt lds
M v[168:171],a[116:119],a[172:175],v[168:171]
SA s21,s21,128
T a[84:85],v3,57344
T a[86:87],v3,58368
M v[172:175],a[124:127],a[172:175],v[172:175]
M v[172:175],a[120:123],a[168:171],v[172:175]
M v[176:179],a[128:131],a[168:171],v[176:179]
SA m0,s87,0
M v[176:179],a[132:135],a[172:175],v[176:179]
buffer_load_dwordx4 v28, s[68:71], s67 offen offset:0 nt lds
M v[180:183],a[140:143],a[172:175],v[180:183]
M v[180:183],a[136:139],a[168:171],v[180:183]
M v[184:187],a[144:147],a[168:171],v[184:187]
s_nop 0
T a[88:89],v4,49152
T a[90:91],v4,50176
M v[184:187],a[148:151],a[172:175],v[184:187]
s_waitcnt lgkmcnt(4)
buffer_load_dwordx4 v29, s[68:71], s67 offen offset:1024 nt lds
M v[188:191],a[156:159],a[172:175],v[188:191]
M v[188:191],a[152:155],a[168:171],v[188:191]
M v[192:195],a[96:99],a[160:163],v[192:195]
R a[168:171],v5,22528
R a[172:175],v6,22528
M v[192:195],a[100:103],a[164:167],v[192:195]
M v[196:199],a[108:111],a[164:167],v[196:199]
buffer_load_dwordx4 v30, s[68:71], s67 offen offset:2048 nt lds
M v[196:199],a[104:107],a[160:163],v[196:199]
s_nop 0
T a[92:93],v4,57344
T a[94:95],v4,58368
M v[200:203],a[112:115],a[160:163],v[200:203]
M v[200:203],a[116:119],a[164:167],v[200:203]
L_w_kv05:
s_cbranch_execz L_wd1
M v[204:207],a[124:127],a[164:167],v[204:207]
M v[204:207],a[120:123],a[160:163],v[204:207]
buffer_load_dwordx4 v31, s[68:71], s67 offen offset:3072 nt lds
M v[208:211],a[128:131],a[160:163],v[208:211]
SA s67,s67,0
M v[208:211],a[132:135],a[164:167],v[208:211]
M v[212:215],a[140:143],a[164:167],v[212:215]
M v[212:215],a[136:139],a[160:163],v[212:215]
M v[216:219],a[144:147],a[160:163],v[216:219]
M v[216:219],a[148:151],a[164:167],v[216:219]
s_waitcnt lgkmcnt(2)
M v[220:223],a[156:159],a[164:167],v[220:223]
s_waitcnt vmcnt(20) lgkmcnt(0)
M v[220:223],a[152:155],a[160:163],v[220:223]
s_barrier
M v[224:227],a[96:99],a[168:171],v[224:227]
R a[160:163],v5,32768
R a[164:167],v6,32768
M v[224:227],a[100:103],a[172:175],v[224:227]
M v[228:231],a[108:111],a[172:175],v[228:231]
M v[228:231],a[104:107],a[168:171],v[228:231]
M v[232:235],a[112:115],a[168:171],v[232:235]
M v[232:235],a[116:119],a[172:175],v[232:235]
M v[236:239],a[124:127],a[172:175],v[236:239]
M v[236:239],a[120:123],a[168:171],v[236:239]
M v[240:243],a[128:131],a[168:171],v[240:243]
M v[240:243],a[132:135],a[172:175],v[240:243]
M v[244:247],a[140:143],a[172:175],v[244:247]
M v[244:247],a[136:139],a[168:171],v[244:247]
M v[248:251],a[144:147],a[168:171],v[248:251]
M v[248:251],a[148:151],a[172:175],v[248:251]
s_waitcnt lgkmcnt(0)
M v[252:255],a[156:159],a[172:175],v[252:255]
M v[252:255],a[152:155],a[168:171],v[252:255]
M a[0:3],a[32:35],a[160:163],a[0:3]
R a[168:171],v5,34816
R a[172:175],v6,34816
M a[0:3],a[36:39],a[164:167],a[0:3]
T a[96:97],v1,0
T a[98:99],v1,1024
M a[4:7],a[44:47],a[164:167],a[4:7]
SA m0,s24,16384
C v23,v23,v23
M a[4:7],a[40:43],a[160:163],a[4:7]
buffer_load_dwordx4 v12, s[48:51], s22 offen offset:0   lds
M a[8:11],a[48:51],a[160:163],a[8:11]
v_and_b32 v23, 0xffff0000, v23
M a[8:11],a[52:55],a[164:167],a[8:11]
MF v22,0xbfb8aa3b,v23
M a[12:15],a[60:63],a[164:167],a[12:15]
s_nop 0
T a[100:101],v1,8192
T a[102:103],v1,9216
M a[12:15],a[56:59],a[160:163],a[12:15]
E v22,v22
M a[16:19],a[64:67],a[160:163],a[16:19]
buffer_load_dwordx4 v13, s[48:51], s22 offen offset:1024   lds
M a[16:19],a[68:71],a[164:167],a[16:19]
AF v22,1.0,v22
M a[20:23],a[76:79],a[164:167],a[20:23]
v_rcp_f32 v23, v22
M a[20:23],a[72:75],a[160:163],a[20:23]
s_or_b32 s64, s31, s20
T a[104:105],v2,0
T a[106:107],v2,1024
M a[24:27],a[80:83],a[160:163],a[24:27]
s_min_u32 s64, s64, 1
s_lshl_b32 s64, s64, 29
v_lshrrev_b32 v22, 1, v0
M a[24:27],a[84:87],a[164:167],a[24:27]
s_waitcnt lgkmcnt(6)
buffer_load_dwordx4 v14, s[48:51], s22 offen offset:2048   lds
M a[28:31],a[92:95],a[164:167],a[28:31]
v_min_u32 v22, 1, v22
M a[28:31],a[88:91],a[160:163],a[28:31]
v_lshlrev_b32 v22, 29, v22
M v[32:35],a[32:35],a[168:171],v[32:35]
R a[160:163],v5,36864
R a[164:167],v6,36864
M v[32:35],a[36:39],a[172:175],v[32:35]
T a[108:109],v2,8192
T a[110:111],v2,9216
M v[36:39],a[44:47],a[172:175],v[36:39]
buffer_load_dwordx4 v15, s[48:51], s22 offen offset:3072   lds
M v[36:39],a[40:43],a[168:171],v[36:39]
s_sub_u32 s22, s22, 1048448
v_lshl_or_b32 v22, v0, 2, v22
M v[40:43],a[48:51],a[168:171],v[40:43]
v_or_b32 v22, s64, v22
M v[40:43],a[52:55],a[172:175],v[40:43]
s_nop 0
T a[112:113],v3,0
T a[114:115],v3,1024
M v[44:47],a[60:63],a[172:175],v[44:47]
SA m0,s23,49152
C v23,v23,v23
M v[44:47],a[56:59],a[168:171],v[44:47]
buffer_load_dwordx4 v8, s[16:19], s21 offen offset:0  nt lds
M v[48:51],a[64:67],a[168:171],v[48:51]
v_and_b32 v23, 0xffff0000, v23
M v[48:51],a[68:71],a[172:175],v[48:51]
s_lshl_b32 s64, s41, 7
M v[52:55],a[76:79],a[172:175],v[52:55]
SA s64,s64,104890368
T a[116:117],v3,8192
T a[118:119],v3,9216
M v[52:55],a[72:75],a[168:171],v[52:55]
buffer_store_dword v24, v22, s[8:11], s64 offen sc1
M v[56:59],a[80:83],a[168:171],v[56:59]
buffer_load_dwordx4 v9, s[16:19], s21 offen offset:1024  nt lds
M v[56:59],a[84:87],a[172:175],v[56:59]
s_waitcnt lgkmcnt(6)
buffer_store_dword v23, v22, s[8:11], s64 offen offset:8 sc1
M v[60:63],a[92:95],a[172:175],v[60:63]
v_add_u32 v25, 159744, v7
M v[60:63],a[88:91],a[168:171],v[60:63]
s_nop 0
T a[120:121],v4,0
T a[122:123],v4,1024
M v[64:67],a[32:35],a[160:163],v[64:67]
R a[168:171],v5,38912
R a[172:175],v6,38912
M v[64:67],a[36:39],a[164:167],v[64:67]
buffer_load_dwordx4 v10, s[16:19], s21 offen offset:2048  nt lds
M v[68:71],a[44:47],a[164:167],v[68:71]
ds_read_b128 v[16:19], v25
M v[68:71],a[40:43],a[160:163],v[68:71]
R v[28:31],v25,1024
M v[72:75],a[48:51],a[160:163],v[72:75]
s_nop 0
T a[124:125],v4,8192
T a[126:127],v4,9216
M v[72:75],a[52:55],a[164:167],v[72:75]
R v[20:23],v25,2048
M v[76:79],a[60:63],a[164:167],v[76:79]
buffer_load_dwordx4 v11, s[16:19], s21 offen offset:3072  nt lds
M v[76:79],a[56:59],a[160:163],v[76:79]
SA s21,s21,524160
M v[80:83],a[64:67],a[160:163],v[80:83]
M v[80:83],a[68:71],a[164:167],v[80:83]
M v[84:87],a[76:79],a[164:167],v[84:87]
M v[84:87],a[72:75],a[160:163],v[84:87]
M v[88:91],a[80:83],a[160:163],v[88:91]
M v[88:91],a[84:87],a[164:167],v[88:91]
s_waitcnt lgkmcnt(5)
s_waitcnt lgkmcnt(3)
AF v16,v28,v16
M v[92:95],a[92:95],a[164:167],v[92:95]
s_waitcnt vmcnt(22) lgkmcnt(0)
AF v17,v29,v17
M v[92:95],a[88:91],a[160:163],v[92:95]
s_barrier
M v[96:99],a[32:35],a[168:171],v[96:99]
R a[160:163],v5,49152
R a[164:167],v6,49152
M v[96:99],a[36:39],a[172:175],v[96:99]
AF v18,v30,v18
M v[100:103],a[44:47],a[172:175],v[100:103]
SA m0,s24,32768
T a[128:129],v1,16384
T a[130:131],v1,17408
M v[100:103],a[40:43],a[168:171],v[100:103]
buffer_load_dwordx4 v12, s[48:51], s22 offen offset:0   lds
M v[104:107],a[48:51],a[168:171],v[104:107]
AF v19,v31,v19
M v[104:107],a[52:55],a[172:175],v[104:107]
R v[28:31],v25,3072
M v[108:111],a[60:63],a[172:175],v[108:111]
C v25,v16,v17
M v[108:111],a[56:59],a[168:171],v[108:111]
v_lshlrev_b32 v16, 16, v25
M v[112:115],a[64:67],a[168:171],v[112:115]
v_and_b32 v17, 0xffff0000, v25
M v[112:115],a[68:71],a[172:175],v[112:115]
s_nop 0
T a[132:133],v1,24576
T a[134:135],v1,25600
M v[116:119],a[76:79],a[172:175],v[116:119]
buffer_load_dwordx4 v13, s[48:51], s22 offen offset:1024   lds
M v[116:119],a[72:75],a[168:171],v[116:119]
C v25,v18,v19
M v[120:123],a[80:83],a[168:171],v[120:123]
v_lshlrev_b32 v18, 16, v25
M v[120:123],a[84:87],a[172:175],v[120:123]
s_waitcnt lgkmcnt(5)
v_and_b32 v19, 0xffff0000, v25
M v[124:127],a[92:95],a[172:175],v[124:127]
s_waitcnt lgkmcnt(2)
AF v20,v28,v20
M v[124:127],a[88:91],a[168:171],v[124:127]
AF v21,v29,v21
M v[128:131],a[32:35],a[160:163],v[128:131]
R a[168:171],v5,51200
R a[172:175],v6,51200
M v[128:131],a[36:39],a[164:167],v[128:131]
T a[136:137],v2,16384
T a[138:139],v2,17408
M v[132:135],a[44:47],a[164:167],v[132:135]
buffer_load_dwordx4 v14, s[48:51], s22 offen offset:2048   lds
M v[132:135],a[40:43],a[160:163],v[132:135]
AF v22,v30,v22
M v[136:139],a[48:51],a[160:163],v[136:139]
AF v23,v31,v23
M v[136:139],a[52:55],a[164:167],v[136:139]
MF v28,0xbfb8aa3b,v16
M v[140:143],a[60:63],a[164:167],v[140:143]
MF v29,0xbfb8aa3b,v17
M v[140:143],a[56:59],a[160:163],v[140:143]
s_nop 0
T a[140:141],v2,24576
T a[142:143],v2,25600
M v[144:147],a[64:67],a[160:163],v[144:147]
buffer_load_dwordx4 v15, s[48:51], s22 offen offset:3072   lds
M v[144:147],a[68:71],a[164:167],v[144:147]
SA s22,s22,1048576
MF v30,0xbfb8aa3b,v18
M v[148:151],a[76:79],a[164:167],v[148:151]
MF v31,0xbfb8aa3b,v19
M v[148:151],a[72:75],a[160:163],v[148:151]
E v28,v28
M v[152:155],a[80:83],a[160:163],v[152:155]
E v29,v29
M v[152:155],a[84:87],a[164:167],v[152:155]
s_waitcnt lgkmcnt(4)
E v30,v30
M v[156:159],a[92:95],a[164:167],v[156:159]
SA m0,s23,0
T a[144:145],v3,16384
T a[146:147],v3,17408
M v[156:159],a[88:91],a[160:163],v[156:159]
buffer_load_dwordx4 v8, s[16:19], s21 offen offset:0  nt lds
M v[160:163],a[32:35],a[168:171],v[160:163]
R a[160:163],v5,53248
R a[164:167],v6,53248
M v[160:163],a[36:39],a[172:175],v[160:163]
E v31,v31
M v[164:167],a[44:47],a[172:175],v[164:167]
C v25,v20,v21
M v[164:167],a[40:43],a[168:171],v[164:167]
v_lshlrev_b32 v20, 16, v25
M v[168:171],a[48:51],a[168:171],v[168:171]
v_and_b32 v21, 0xffff0000, v25
M v[168:171],a[52:55],a[172:175],v[168:171]
s_nop 0
T a[148:149],v3,24576
T a[150:151],v3,25600
M v[172:175],a[60:63],a[172:175],v[172:175]
buffer_load_dwordx4 v9, s[16:19], s21 offen offset:1024  nt lds
M v[172:175],a[56:59],a[168:171],v[172:175]
C v25,v22,v23
M v[176:179],a[64:67],a[168:171],v[176:179]
v_lshlrev_b32 v22, 16, v25
M v[176:179],a[68:71],a[172:175],v[176:179]
v_and_b32 v23, 0xffff0000, v25
M v[180:183],a[76:79],a[172:175],v[180:183]
AF v28,1.0,v28
M v[180:183],a[72:75],a[168:171],v[180:183]
AF v29,1.0,v29
M v[184:187],a[80:83],a[168:171],v[184:187]
s_nop 0
T a[152:153],v4,16384
T a[154:155],v4,17408
M v[184:187],a[84:87],a[172:175],v[184:187]
s_waitcnt lgkmcnt(4)
buffer_load_dwordx4 v10, s[16:19], s21 offen offset:2048  nt lds
M v[188:191],a[92:95],a[172:175],v[188:191]
AF v30,1.0,v30
M v[188:191],a[88:91],a[168:171],v[188:191]
AF v31,1.0,v31
M v[192:195],a[32:35],a[160:163],v[192:195]
R a[168:171],v5,55296
R a[172:175],v6,55296
M v[192:195],a[36:39],a[164:167],v[192:195]
v_rcp_f32 v28, v28
M v[196:199],a[44:47],a[164:167],v[196:199]
v_rcp_f32 v29, v29
M v[196:199],a[40:43],a[160:163],v[196:199]
T a[156:157],v4,24576
T a[158:159],v4,25600
M v[200:203],a[48:51],a[160:163],v[200:203]
buffer_load_dwordx4 v11, s[16:19], s21 offen offset:3072  nt lds
M v[200:203],a[52:55],a[164:167],v[200:203]
SA s21,s21,128
v_rcp_f32 v30, v30
M v[204:207],a[60:63],a[164:167],v[204:207]
v_rcp_f32 v31, v31
M v[204:207],a[56:59],a[160:163],v[204:207]
MF v16,v28,v16
M v[208:211],a[64:67],a[160:163],v[208:211]
MF v17,v29,v17
M v[208:211],a[68:71],a[164:167],v[208:211]
MF v18,v30,v18
M v[212:215],a[76:79],a[164:167],v[212:215]
MF v19,v31,v19
M v[212:215],a[72:75],a[160:163],v[212:215]
C v25,v16,v17
M v[216:219],a[80:83],a[160:163],v[216:219]
v_lshlrev_b32 v16, 16, v25
M v[216:219],a[84:87],a[164:167],v[216:219]
s_waitcnt lgkmcnt(2)
v_and_b32 v17, 0xffff0000, v25
M v[220:223],a[92:95],a[164:167],v[220:223]
s_waitcnt vmcnt(22) lgkmcnt(0)
C v25,v18,v19
M v[220:223],a[88:91],a[160:163],v[220:223]
s_barrier
M v[224:227],a[32:35],a[168:171],v[224:227]
R a[160:163],v5,0
R a[164:167],v6,0
M v[224:227],a[36:39],a[172:175],v[224:227]
v_lshlrev_b32 v18, 16, v25
M v[228:231],a[44:47],a[172:175],v[228:231]
v_and_b32 v19, 0xffff0000, v25
M v[228:231],a[40:43],a[168:171],v[228:231]
MF v16,v20,v16
M v[232:235],a[48:51],a[168:171],v[232:235]
MF v17,v21,v17
M v[232:235],a[52:55],a[172:175],v[232:235]
MF v18,v22,v18
M v[236:239],a[60:63],a[172:175],v[236:239]
MF v19,v23,v19
M v[236:239],a[56:59],a[168:171],v[236:239]
C v16,v16,v17
M v[240:243],a[64:67],a[168:171],v[240:243]
C v17,v18,v19
M v[240:243],a[68:71],a[172:175],v[240:243]
M v[244:247],a[76:79],a[172:175],v[244:247]
M v[244:247],a[72:75],a[168:171],v[244:247]
M v[248:251],a[80:83],a[168:171],v[248:251]
M v[248:251],a[84:87],a[172:175],v[248:251]
s_waitcnt lgkmcnt(0)
M v[252:255],a[92:95],a[172:175],v[252:255]
M v[252:255],a[88:91],a[168:171],v[252:255]
M a[0:3],a[96:99],a[160:163],a[0:3]
R a[168:171],v5,2048
R a[172:175],v6,2048
M a[0:3],a[100:103],a[164:167],a[0:3]
T a[32:33],v1,32768
T a[34:35],v1,33792
M a[4:7],a[108:111],a[164:167],a[4:7]
SA m0,s24,49152
v_lshrrev_b32 v28, 4, v0
v_and_b32 v29, 7, v0
M a[4:7],a[104:107],a[160:163],a[4:7]
buffer_load_dwordx4 v12, s[48:51], s22 offen offset:0   lds
M a[8:11],a[112:115],a[160:163],a[8:11]
v_xor_b32 v28, v28, v29
v_lshlrev_b32 v28, 4, v28
M a[8:11],a[116:119],a[164:167],a[8:11]
v_lshrrev_b32 v29, 3, v0
v_mul_u32_u24 v29, 896, v29
M a[12:15],a[124:127],a[164:167],a[12:15]
T a[36:37],v1,40960
T a[38:39],v1,41984
M a[12:15],a[120:123],a[160:163],a[12:15]
v_add_u32 v22, v28, v29
v_xor_b32 v28, 64, v28
M a[16:19],a[128:131],a[160:163],a[16:19]
s_mul_i32 s64, s20, 14336
buffer_load_dwordx4 v13, s[48:51], s22 offen offset:1024   lds
M a[16:19],a[132:135],a[164:167],a[16:19]
s_sub_u32 s65, 98304, s64
M a[20:23],a[140:143],a[164:167],a[20:23]
SA s30,s29,s65
M a[20:23],a[136:139],a[160:163],a[20:23]
SA s29,s29,s64
T a[40:41],v2,32768
T a[42:43],v2,33792
M a[24:27],a[144:147],a[160:163],a[24:27]
v_add_u32 v29, 6144, v29
v_add_u32 v23, v28, v29
M a[24:27],a[148:151],a[164:167],a[24:27]
s_waitcnt lgkmcnt(6)
buffer_load_dwordx4 v14, s[48:51], s22 offen offset:2048   lds
M a[28:31],a[156:159],a[164:167],a[28:31]
s_and_b32 s64, s20, 1
M a[28:31],a[152:155],a[160:163],a[28:31]
s_lshl_b32 s64, s64, 12
M v[32:35],a[96:99],a[168:171],v[32:35]
SA s64,s64,65536
R a[160:163],v5,4096
R a[164:167],v6,4096
M v[32:35],a[100:103],a[172:175],v[32:35]
T a[44:45],v2,40960
T a[46:47],v2,41984
M v[36:39],a[108:111],a[172:175],v[36:39]
buffer_load_dwordx4 v15, s[48:51], s22 offen offset:3072   lds
M v[36:39],a[104:107],a[168:171],v[36:39]
s_sub_u32 s22, s22, 1048448
v_add_u32 v20, s64, v5
v_add_u32 v21, s64, v6
M v[40:43],a[112:115],a[168:171],v[40:43]
v_lshrrev_b32 v28, 2, v0
v_lshlrev_b32 v28, 8, v28
M v[40:43],a[116:119],a[172:175],v[40:43]
T a[48:49],v3,32768
T a[50:51],v3,33792
M v[44:47],a[124:127],a[172:175],v[44:47]
SA m0,s23,16384
v_and_b32 v29, 3, v0
v_lshl_add_u32 v28, v29, 3, v28
M v[44:47],a[120:123],a[168:171],v[44:47]
buffer_load_dwordx4 v8, s[16:19], s21 offen offset:0  nt lds
M v[48:51],a[128:131],a[168:171],v[48:51]
v_add_u32 v28, s87, v28
M v[48:51],a[132:135],a[172:175],v[48:51]
s_waitcnt vmcnt(23)
s_nop 0
T a[176:177],v28,0
T a[178:179],v28,32
M v[52:55],a[140:143],a[172:175],v[52:55]
T a[52:53],v3,40960
T a[54:55],v3,41984
M v[52:55],a[136:139],a[168:171],v[52:55]
T a[180:181],v28,64
T a[182:183],v28,96
M v[56:59],a[144:147],a[168:171],v[56:59]
buffer_load_dwordx4 v9, s[16:19], s21 offen offset:1024  nt lds
M v[56:59],a[148:151],a[172:175],v[56:59]
s_waitcnt lgkmcnt(10)
s_nop 0
T a[184:185],v28,128
T a[186:187],v28,160
M v[60:63],a[156:159],a[172:175],v[60:63]
T a[188:189],v28,192
M v[60:63],a[152:155],a[168:171],v[60:63]
s_nop 0
T a[56:57],v4,32768
T a[58:59],v4,33792
M v[64:67],a[96:99],a[160:163],v[64:67]
R a[168:171],v5,6144
R a[172:175],v6,6144
M v[64:67],a[100:103],a[164:167],v[64:67]
buffer_load_dwordx4 v10, s[16:19], s21 offen offset:2048  nt lds
s_waitcnt lgkmcnt(12)
v_mfma_f32_16x16x16_bf16 a[192:195], a[176:177], v[16:17], 0
M v[68:71],a[108:111],a[164:167],v[68:71]
v_mov_b32 v18, v16 row_shr:2 row_mask:0xf bank_mask:0xf bound_ctrl:0
v_mov_b32 v19, v17 row_shr:2 row_mask:0xf bank_mask:0xf bound_ctrl:0
M v[68:71],a[104:107],a[160:163],v[68:71]
M v[72:75],a[112:115],a[160:163],v[72:75]
s_nop 0
T a[60:61],v4,40960
T a[62:63],v4,41984
M v[72:75],a[116:119],a[164:167],v[72:75]
s_waitcnt lgkmcnt(13)
v_mfma_f32_16x16x16_bf16 a[192:195], a[178:179], v[18:19], a[192:195]
M v[76:79],a[124:127],a[164:167],v[76:79]
buffer_load_dwordx4 v11, s[16:19], s21 offen offset:3072  nt lds
M v[76:79],a[120:123],a[160:163],v[76:79]
SA s21,s21,524160
v_mov_b32 v16, v18 row_shr:2 row_mask:0xf bank_mask:0xf bound_ctrl:0
v_mov_b32 v17, v19 row_shr:2 row_mask:0xf bank_mask:0xf bound_ctrl:0
M v[80:83],a[128:131],a[160:163],v[80:83]
M v[80:83],a[132:135],a[164:167],v[80:83]
s_waitcnt lgkmcnt(10)
v_mfma_f32_16x16x16_bf16 a[192:195], a[180:181], v[16:17], a[192:195]
M v[84:87],a[140:143],a[164:167],v[84:87]
v_mov_b32 v18, v16 row_shr:2 row_mask:0xf bank_mask:0xf bound_ctrl:0
v_mov_b32 v19, v17 row_shr:2 row_mask:0xf bank_mask:0xf bound_ctrl:0
M v[84:87],a[136:139],a[160:163],v[84:87]
M v[88:91],a[144:147],a[160:163],v[88:91]
M v[88:91],a[148:151],a[164:167],v[88:91]
s_waitcnt lgkmcnt(2)
v_mfma_f32_16x16x16_bf16 a[192:195], a[182:183], v[18:19], a[192:195]
M v[92:95],a[156:159],a[164:167],v[92:95]
s_waitcnt vmcnt(16) lgkmcnt(0)
v_mov_b32 v16, v18 row_shr:2 row_mask:0xf bank_mask:0xf bound_ctrl:0
v_mov_b32 v17, v19 row_shr:2 row_mask:0xf bank_mask:0xf bound_ctrl:0
M v[92:95],a[152:155],a[160:163],v[92:95]
s_barrier
M v[96:99],a[96:99],a[168:171],v[96:99]
R a[160:163],v5,16384
R a[164:167],v6,16384
M v[96:99],a[100:103],a[172:175],v[96:99]
SA m0,s23,131072
v_mfma_f32_16x16x16_bf16 a[192:195], a[184:185], v[16:17], a[192:195]
M v[100:103],a[108:111],a[172:175],v[100:103]
s_nop 0
T a[64:65],v1,49152
T a[66:67],v1,50176
M v[100:103],a[104:107],a[168:171],v[100:103]
v_mov_b32 v18, v16 row_shr:2 row_mask:0xf bank_mask:0xf bound_ctrl:0
v_mov_b32 v19, v17 row_shr:2 row_mask:0xf bank_mask:0xf bound_ctrl:0
M v[104:107],a[112:115],a[168:171],v[104:107]
buffer_load_dwordx4 v22, s[56:59], s29 offen offset:0 lds
M v[104:107],a[116:119],a[172:175],v[104:107]
v_mfma_f32_16x16x16_bf16 a[192:195], a[186:187], v[18:19], a[192:195]
M v[108:111],a[124:127],a[172:175],v[108:111]
v_mov_b32 v16, v18 row_shr:2 row_mask:0xf bank_mask:0xf bound_ctrl:0
v_mov_b32 v17, v19 row_shr:2 row_mask:0xf bank_mask:0xf bound_ctrl:0
M v[108:111],a[120:123],a[168:171],v[108:111]
buffer_load_dwordx4 v23, s[56:59], s29 offen offset:1024 lds
M v[112:115],a[128:131],a[168:171],v[112:115]
M v[112:115],a[132:135],a[172:175],v[112:115]
s_nop 0
T a[68:69],v1,57344
T a[70:71],v1,58368
v_mfma_f32_16x16x16_bf16 a[192:195], a[188:189], v[16:17], a[192:195]
M v[116:119],a[140:143],a[172:175],v[116:119]
buffer_load_dwordx4 v22, s[56:59], s30 offen offset:2048 lds
M v[116:119],a[136:139],a[168:171],v[116:119]
v_and_b32 v29, 1, v0
v_mul_u32_u24 v30, 1792, v29
M v[120:123],a[144:147],a[168:171],v[120:123]
v_lshrrev_b32 v31, 4, v0
v_lshl_add_u32 v30, v31, 4, v30
M v[120:123],a[148:151],a[172:175],v[120:123]
s_waitcnt lgkmcnt(4)
v_bfe_u32 v29, v0, 1, 3
v_lshl_add_u32 v30, v29, 6, v30
M v[124:127],a[156:159],a[172:175],v[124:127]
v_add_u32 v29, 1, v29
v_lshrrev_b32 v29, 3, v29
M v[124:127],a[152:155],a[168:171],v[124:127]
v_lshl_or_b32 v30, v29, 29, v30
v_or_b32 v30, s88, v30
M v[128:131],a[96:99],a[160:163],v[128:131]
s_mul_i32 s89, s86, 3584
R a[168:171],v5,18432
R a[172:175],v6,18432
M v[128:131],a[100:103],a[164:167],v[128:131]
s_mul_i32 s64, s20, 448
T a[72:73],v2,49152
T a[74:75],v2,50176
M v[132:135],a[108:111],a[164:167],v[132:135]
SA s89,s89,s64
M v[132:135],a[104:107],a[160:163],v[132:135]
SA s89,s89,105906176
buffer_store_dwordx4 a[192:195], v30, s[8:11], s89 offen sc1
M v[136:139],a[112:115],a[160:163],v[136:139]
M v[136:139],a[116:119],a[164:167],v[136:139]
M v[140:143],a[124:127],a[164:167],v[140:143]
buffer_load_dwordx4 v23, s[56:59], s30 offen offset:3072 lds
M v[140:143],a[120:123],a[160:163],v[140:143]
SA s29,s29,128
T a[76:77],v2,57344
T a[78:79],v2,58368
M v[144:147],a[128:131],a[160:163],v[144:147]
SA s30,s30,128
M v[144:147],a[132:135],a[164:167],v[144:147]
SA m0,s24,0
M v[148:151],a[140:143],a[164:167],v[148:151]
buffer_load_dwordx4 v12, s[48:51], s22 offen offset:0   lds
M v[148:151],a[136:139],a[160:163],v[148:151]
M v[152:155],a[144:147],a[160:163],v[152:155]
M v[152:155],a[148:151],a[164:167],v[152:155]
s_waitcnt lgkmcnt(4)
buffer_load_dwordx4 v13, s[48:51], s22 offen offset:1024   lds
M v[156:159],a[156:159],a[164:167],v[156:159]
s_nop 0
T a[80:81],v3,49152
T a[82:83],v3,50176
M v[156:159],a[152:155],a[160:163],v[156:159]
M v[160:163],a[96:99],a[168:171],v[160:163]
R a[160:163],v5,20480
R a[164:167],v6,20480
M v[160:163],a[100:103],a[172:175],v[160:163]
buffer_load_dwordx4 v14, s[48:51], s22 offen offset:2048   lds
M v[164:167],a[108:111],a[172:175],v[164:167]
M v[164:167],a[104:107],a[168:171],v[164:167]
M v[168:171],a[112:115],a[168:171],v[168:171]
buffer_load_dwordx4 v15, s[48:51], s22 offen offset:3072   lds
M v[168:171],a[116:119],a[172:175],v[168:171]
SA s22,s22,1048576
T a[84:85],v3,57344
T a[86:87],v3,58368
M v[172:175],a[124:127],a[172:175],v[172:175]
SA m0,s23,32768
L_w_kv06:
s_cbranch_execz L_wd1
M v[172:175],a[120:123],a[168:171],v[172:175]
buffer_load_dwordx4 v8, s[16:19], s21 offen offset:0  nt lds
M v[176:179],a[128:131],a[168:171],v[176:179]
M v[176:179],a[132:135],a[172:175],v[176:179]
M v[180:183],a[140:143],a[172:175],v[180:183]
M v[180:183],a[136:139],a[168:171],v[180:183]
buffer_load_dwordx4 v9, s[16:19], s21 offen offset:1024  nt lds
M v[184:187],a[144:147],a[168:171],v[184:187]
s_nop 0
T a[88:89],v4,49152
T a[90:91],v4,50176
M v[184:187],a[148:151],a[172:175],v[184:187]
s_waitcnt lgkmcnt(4)
M v[188:191],a[156:159],a[172:175],v[188:191]
M v[188:191],a[152:155],a[168:171],v[188:191]
M v[192:195],a[96:99],a[160:163],v[192:195]
R a[168:171],v5,22528
R a[172:175],v6,22528
M v[192:195],a[100:103],a[164:167],v[192:195]
buffer_load_dwordx4 v10, s[16:19], s21 offen offset:2048  nt lds
M v[196:199],a[108:111],a[164:167],v[196:199]
M v[196:199],a[104:107],a[160:163],v[196:199]
s_nop 0
T a[92:93],v4,57344
T a[94:95],v4,58368
M v[200:203],a[112:115],a[160:163],v[200:203]
M v[200:203],a[116:119],a[164:167],v[200:203]
buffer_load_dwordx4 v11, s[16:19], s21 offen offset:3072  nt lds
M v[204:207],a[124:127],a[164:167],v[204:207]
M v[204:207],a[120:123],a[160:163],v[204:207]
M v[208:211],a[128:131],a[160:163],v[208:211]
M v[208:211],a[132:135],a[164:167],v[208:211]
M v[212:215],a[140:143],a[164:167],v[212:215]
SA s21,s21,128
M v[212:215],a[136:139],a[160:163],v[212:215]
M v[216:219],a[144:147],a[160:163],v[216:219]
M v[216:219],a[148:151],a[164:167],v[216:219]
s_waitcnt lgkmcnt(2)
M v[220:223],a[156:159],a[164:167],v[220:223]
s_waitcnt vmcnt(21) lgkmcnt(0)
M v[220:223],a[152:155],a[160:163],v[220:223]
s_barrier
M v[224:227],a[96:99],a[168:171],v[224:227]
R a[160:163],v5,32768
R a[164:167],v6,32768
M v[224:227],a[100:103],a[172:175],v[224:227]
M v[228:231],a[108:111],a[172:175],v[228:231]
M v[228:231],a[104:107],a[168:171],v[228:231]
M v[232:235],a[112:115],a[168:171],v[232:235]
M v[232:235],a[116:119],a[172:175],v[232:235]
M v[236:239],a[124:127],a[172:175],v[236:239]
M v[236:239],a[120:123],a[168:171],v[236:239]
M v[240:243],a[128:131],a[168:171],v[240:243]
M v[240:243],a[132:135],a[172:175],v[240:243]
M v[244:247],a[140:143],a[172:175],v[244:247]
M v[244:247],a[136:139],a[168:171],v[244:247]
M v[248:251],a[144:147],a[168:171],v[248:251]
M v[248:251],a[148:151],a[172:175],v[248:251]
s_waitcnt lgkmcnt(0)
M v[252:255],a[156:159],a[172:175],v[252:255]
M v[252:255],a[152:155],a[168:171],v[252:255]
M a[0:3],a[32:35],a[160:163],a[0:3]
R a[168:171],v5,34816
R a[172:175],v6,34816
M a[0:3],a[36:39],a[164:167],a[0:3]
SA m0,s23,147456
T a[96:97],v1,0
T a[98:99],v1,1024
M a[4:7],a[44:47],a[164:167],a[4:7]
buffer_load_dwordx4 v22, s[56:59], s29 offen offset:0 lds
M a[4:7],a[40:43],a[160:163],a[4:7]
M a[8:11],a[48:51],a[160:163],a[8:11]
M a[8:11],a[52:55],a[164:167],a[8:11]
buffer_load_dwordx4 v23, s[56:59], s29 offen offset:1024 lds
M a[12:15],a[60:63],a[164:167],a[12:15]
s_nop 0
T a[100:101],v1,8192
T a[102:103],v1,9216
M a[12:15],a[56:59],a[160:163],a[12:15]
M a[16:19],a[64:67],a[160:163],a[16:19]
buffer_load_dwordx4 v22, s[56:59], s30 offen offset:2048 lds
M a[16:19],a[68:71],a[164:167],a[16:19]
M a[20:23],a[76:79],a[164:167],a[20:23]
M a[20:23],a[72:75],a[160:163],a[20:23]
s_nop 0
T a[104:105],v2,0
T a[106:107],v2,1024
M a[24:27],a[80:83],a[160:163],a[24:27]
buffer_load_dwordx4 v23, s[56:59], s30 offen offset:3072 lds
M a[24:27],a[84:87],a[164:167],a[24:27]
s_waitcnt lgkmcnt(6)
M a[28:31],a[92:95],a[164:167],a[28:31]
SA s29,s29,128
M a[28:31],a[88:91],a[160:163],a[28:31]
SA s30,s30,128
M v[32:35],a[32:35],a[168:171],v[32:35]
SA m0,s24,16384
R a[160:163],v5,36864
R a[164:167],v6,36864
M v[32:35],a[36:39],a[172:175],v[32:35]
T a[108:109],v2,8192
T a[110:111],v2,9216
M v[36:39],a[44:47],a[172:175],v[36:39]
buffer_load_dwordx4 v12, s[48:51], s22 offen offset:0   lds
M v[36:39],a[40:43],a[168:171],v[36:39]
M v[40:43],a[48:51],a[168:171],v[40:43]
M v[40:43],a[52:55],a[172:175],v[40:43]
s_nop 0
T a[112:113],v3,0
T a[114:115],v3,1024
M v[44:47],a[60:63],a[172:175],v[44:47]
buffer_load_dwordx4 v13, s[48:51], s22 offen offset:1024   lds
M v[44:47],a[56:59],a[168:171],v[44:47]
M v[48:51],a[64:67],a[168:171],v[48:51]
M v[48:51],a[68:71],a[172:175],v[48:51]
buffer_load_dwordx4 v14, s[48:51], s22 offen offset:2048   lds
M v[52:55],a[76:79],a[172:175],v[52:55]
s_nop 0
T a[116:117],v3,8192
T a[118:119],v3,9216
M v[52:55],a[72:75],a[168:171],v[52:55]
M v[56:59],a[80:83],a[168:171],v[56:59]
buffer_load_dwordx4 v15, s[48:51], s22 offen offset:3072   lds
M v[56:59],a[84:87],a[172:175],v[56:59]
s_waitcnt lgkmcnt(6)
M v[60:63],a[92:95],a[172:175],v[60:63]
s_sub_u32 s22, s22, 1048448
M v[60:63],a[88:91],a[168:171],v[60:63]
SA m0,s23,49152
T a[120:121],v4,0
T a[122:123],v4,1024
M v[64:67],a[32:35],a[160:163],v[64:67]
R a[168:171],v5,38912
R a[172:175],v6,38912
M v[64:67],a[36:39],a[164:167],v[64:67]
buffer_load_dwordx4 v8, s[16:19], s21 offen offset:0  nt lds
M v[68:71],a[44:47],a[164:167],v[68:71]
M v[68:71],a[40:43],a[160:163],v[68:71]
M v[72:75],a[48:51],a[160:163],v[72:75]
s_waitcnt vmcnt(17)
s_nop 0
T a[124:125],v4,8192
T a[126:127],v4,9216
M v[72:75],a[52:55],a[164:167],v[72:75]
buffer_load_dwordx4 v9, s[16:19], s21 offen offset:1024  nt lds
M v[76:79],a[60:63],a[164:167],v[76:79]
R a[176:179],v20,0
R a[180:183],v20,2048
M v[76:79],a[56:59],a[160:163],v[76:79]
R a[184:187],v21,0
R a[188:191],v21,2048
M v[80:83],a[64:67],a[160:163],v[80:83]
buffer_load_dwordx4 v10, s[16:19], s21 offen offset:2048  nt lds
M v[80:83],a[68:71],a[164:167],v[80:83]
M v[84:87],a[76:79],a[164:167],v[84:87]
M v[84:87],a[72:75],a[160:163],v[84:87]
buffer_load_dwordx4 v11, s[16:19], s21 offen offset:3072  nt lds
M v[88:91],a[80:83],a[160:163],v[88:91]
SA s21,s21,524160
M v[88:91],a[84:87],a[164:167],v[88:91]
s_waitcnt lgkmcnt(6)
M v[92:95],a[92:95],a[164:167],v[92:95]
s_waitcnt lgkmcnt(0)
M v[92:95],a[88:91],a[160:163],v[92:95]
s_barrier
M v[96:99],a[32:35],a[168:171],v[96:99]
s_lshl_b32 s4, s20, 10
R a[160:163],v5,49152
R a[164:167],v6,49152
M v[96:99],a[36:39],a[172:175],v[96:99]
SA m0,s23,131072
v_bfe_u32 v28, v0, 3, 2
M v[100:103],a[44:47],a[172:175],v[100:103]
s_nop 0
T a[128:129],v1,16384
T a[130:131],v1,17408
M v[100:103],a[40:43],a[168:171],v[100:103]
buffer_load_dwordx4 v22, s[56:59], s29 offen offset:0 lds
M v[104:107],a[48:51],a[168:171],v[104:107]
v_lshrrev_b32 v29, 5, v0
v_lshl_add_u32 v28, v29, 3, v28
M v[104:107],a[52:55],a[172:175],v[104:107]
M v[108:111],a[60:63],a[172:175],v[108:111]
buffer_load_dwordx4 v23, s[56:59], s29 offen offset:1024 lds
M v[108:111],a[56:59],a[168:171],v[108:111]
v_lshlrev_b32 v28, 13, v28
M v[112:115],a[64:67],a[168:171],v[112:115]
v_lshrrev_b32 v29, 4, v0
M v[112:115],a[68:71],a[172:175],v[112:115]
s_nop 0
T a[132:133],v1,24576
T a[134:135],v1,25600
M v[116:119],a[76:79],a[172:175],v[116:119]
buffer_load_dwordx4 v22, s[56:59], s30 offen offset:2048 lds
M v[116:119],a[72:75],a[168:171],v[116:119]
v_lshlrev_b32 v29, 1, v29
M v[120:123],a[80:83],a[168:171],v[120:123]
v_and_b32 v30, 7, v0
M v[120:123],a[84:87],a[172:175],v[120:123]
s_waitcnt lgkmcnt(4)
M v[124:127],a[92:95],a[172:175],v[124:127]
v_xor_b32 v29, v29, v30
M v[124:127],a[88:91],a[168:171],v[124:127]
buffer_load_dwordx4 v23, s[56:59], s30 offen offset:3072 lds
M v[128:131],a[32:35],a[160:163],v[128:131]
R a[168:171],v5,51200
R a[172:175],v6,51200
M v[128:131],a[36:39],a[164:167],v[128:131]
SA s29,s29,128
T a[136:137],v2,16384
T a[138:139],v2,17408
M v[132:135],a[44:47],a[164:167],v[132:135]
SA s30,s30,128
v_lshl_add_u32 v28, v29, 4, v28
M v[132:135],a[40:43],a[160:163],v[132:135]
s_and_b32 s64, s20, 1
M v[136:139],a[48:51],a[160:163],v[136:139]
s_lshl_b32 s64, s64, 17
M v[136:139],a[52:55],a[164:167],v[136:139]
s_lshr_b32 s65, s20, 1
M v[140:143],a[60:63],a[164:167],v[140:143]
s_lshl_b32 s65, s65, 15
SA s64,s64,s65
v_add_u32 v8, s64, v28
M v[140:143],a[56:59],a[160:163],v[140:143]
SA m0,s24,32768
T a[140:141],v2,24576
T a[142:143],v2,25600
M v[144:147],a[64:67],a[160:163],v[144:147]
buffer_load_dwordx4 v12, s[48:51], s22 offen offset:0   lds
M v[144:147],a[68:71],a[164:167],v[144:147]
M v[148:151],a[76:79],a[164:167],v[148:151]
M v[148:151],a[72:75],a[160:163],v[148:151]
buffer_load_dwordx4 v13, s[48:51], s22 offen offset:1024   lds
M v[152:155],a[80:83],a[160:163],v[152:155]
M v[152:155],a[84:87],a[164:167],v[152:155]
s_waitcnt lgkmcnt(4)
M v[156:159],a[92:95],a[164:167],v[156:159]
s_nop 0
T a[144:145],v3,16384
T a[146:147],v3,17408
M v[156:159],a[88:91],a[160:163],v[156:159]
buffer_load_dwordx4 v14, s[48:51], s22 offen offset:2048   lds
M v[160:163],a[32:35],a[168:171],v[160:163]
R a[160:163],v5,53248
R a[164:167],v6,53248
M v[160:163],a[36:39],a[172:175],v[160:163]
M v[164:167],a[44:47],a[172:175],v[164:167]
buffer_load_dwordx4 v15, s[48:51], s22 offen offset:3072   lds
M v[164:167],a[40:43],a[168:171],v[164:167]
M v[168:171],a[48:51],a[168:171],v[168:171]
SA s22,s22,1048576
M v[168:171],a[52:55],a[172:175],v[168:171]
s_mov_b32 s25, 0
T a[148:149],v3,24576
T a[150:151],v3,25600
M v[172:175],a[60:63],a[172:175],v[172:175]
SA m0,s4,0
M v[172:175],a[56:59],a[168:171],v[172:175]
buffer_load_dwordx4 v8, s[52:55], s25 offen lds
M v[176:179],a[64:67],a[168:171],v[176:179]
M v[176:179],a[68:71],a[172:175],v[176:179]
s_mov_b32 s25, 262144
M v[180:183],a[76:79],a[172:175],v[180:183]
SA m0,s4,4096
M v[180:183],a[72:75],a[168:171],v[180:183]
buffer_load_dwordx4 v8, s[52:55], s25 offen lds
M v[184:187],a[80:83],a[168:171],v[184:187]
s_nop 0
T a[152:153],v4,16384
T a[154:155],v4,17408
M v[184:187],a[84:87],a[172:175],v[184:187]
s_waitcnt lgkmcnt(4)
M v[188:191],a[92:95],a[172:175],v[188:191]
s_mov_b32 s25, 524288
M v[188:191],a[88:91],a[168:171],v[188:191]
SA m0,s4,8192
M v[192:195],a[32:35],a[160:163],v[192:195]
R a[168:171],v5,55296
R a[172:175],v6,55296
M v[192:195],a[36:39],a[164:167],v[192:195]
buffer_load_dwordx4 v8, s[52:55], s25 offen lds
M v[196:199],a[44:47],a[164:167],v[196:199]
M v[196:199],a[40:43],a[160:163],v[196:199]
s_mov_b32 s25, 786432
T a[156:157],v4,24576
T a[158:159],v4,25600
M v[200:203],a[48:51],a[160:163],v[200:203]
SA m0,s4,12288
M v[200:203],a[52:55],a[164:167],v[200:203]
s_waitcnt vmcnt(19)
buffer_load_dwordx4 v8, s[52:55], s25 offen lds
M v[204:207],a[60:63],a[164:167],v[204:207]
R a[192:195],v20,16384
R a[196:199],v20,18432
M v[204:207],a[56:59],a[160:163],v[204:207]
R a[200:203],v21,16384
R a[204:207],v21,18432
M v[208:211],a[64:67],a[160:163],v[208:211]
M v[208:211],a[68:71],a[164:167],v[208:211]
M v[212:215],a[76:79],a[164:167],v[212:215]
M v[212:215],a[72:75],a[160:163],v[212:215]
M v[216:219],a[80:83],a[160:163],v[216:219]
M v[216:219],a[84:87],a[164:167],v[216:219]
s_waitcnt lgkmcnt(6)
M v[220:223],a[92:95],a[164:167],v[220:223]
s_waitcnt lgkmcnt(0)
M v[220:223],a[88:91],a[160:163],v[220:223]
s_barrier
M v[224:227],a[32:35],a[168:171],v[224:227]
R a[160:163],v5,0
R a[164:167],v6,0
M v[224:227],a[36:39],a[172:175],v[224:227]
M v[228:231],a[44:47],a[172:175],v[228:231]
M v[228:231],a[40:43],a[168:171],v[228:231]
M v[232:235],a[48:51],a[168:171],v[232:235]
M v[232:235],a[52:55],a[172:175],v[232:235]
M v[236:239],a[60:63],a[172:175],v[236:239]
M v[236:239],a[56:59],a[168:171],v[236:239]
M v[240:243],a[64:67],a[168:171],v[240:243]
M v[240:243],a[68:71],a[172:175],v[240:243]
M v[244:247],a[76:79],a[172:175],v[244:247]
M v[244:247],a[72:75],a[168:171],v[244:247]
M v[248:251],a[80:83],a[168:171],v[248:251]
M v[248:251],a[84:87],a[172:175],v[248:251]
s_waitcnt lgkmcnt(0)
M v[252:255],a[92:95],a[172:175],v[252:255]
M v[252:255],a[88:91],a[168:171],v[252:255]
M a[0:3],a[96:99],a[160:163],a[0:3]
R a[168:171],v5,2048
R a[172:175],v6,2048
M a[0:3],a[100:103],a[164:167],a[0:3]
SA m0,s23,147456
T a[32:33],v1,32768
T a[34:35],v1,33792
M a[4:7],a[108:111],a[164:167],a[4:7]
buffer_load_dwordx4 v22, s[56:59], s29 offen offset:0 lds
M a[4:7],a[104:107],a[160:163],a[4:7]
M a[8:11],a[112:115],a[160:163],a[8:11]
M a[8:11],a[116:119],a[164:167],a[8:11]
buffer_load_dwordx4 v23, s[56:59], s29 offen offset:1024 lds
M a[12:15],a[124:127],a[164:167],a[12:15]
s_nop 0
T a[36:37],v1,40960
T a[38:39],v1,41984
M a[12:15],a[120:123],a[160:163],a[12:15]
M a[16:19],a[128:131],a[160:163],a[16:19]
buffer_load_dwordx4 v22, s[56:59], s30 offen offset:2048 lds
M a[16:19],a[132:135],a[164:167],a[16:19]
M a[20:23],a[140:143],a[164:167],a[20:23]
M a[20:23],a[136:139],a[160:163],a[20:23]
s_nop 0
T a[40:41],v2,32768
T a[42:43],v2,33792
M a[24:27],a[144:147],a[160:163],a[24:27]
buffer_load_dwordx4 v23, s[56:59], s30 offen offset:3072 lds
M a[24:27],a[148:151],a[164:167],a[24:27]
s_waitcnt lgkmcnt(6)
M a[28:31],a[156:159],a[164:167],a[28:31]
SA s29,s29,128
M a[28:31],a[152:155],a[160:163],a[28:31]
SA s30,s30,128
M v[32:35],a[96:99],a[168:171],v[32:35]
SA m0,s24,49152
R a[160:163],v5,4096
R a[164:167],v6,4096
M v[32:35],a[100:103],a[172:175],v[32:35]
T a[44:45],v2,40960
T a[46:47],v2,41984
M v[36:39],a[108:111],a[172:175],v[36:39]
buffer_load_dwordx4 v12, s[48:51], s22 offen offset:0   lds
M v[36:39],a[104:107],a[168:171],v[36:39]
M v[40:43],a[112:115],a[168:171],v[40:43]
M v[40:43],a[116:119],a[172:175],v[40:43]
s_nop 0
T a[48:49],v3,32768
T a[50:51],v3,33792
M v[44:47],a[124:127],a[172:175],v[44:47]
buffer_load_dwordx4 v13, s[48:51], s22 offen offset:1024   lds
M v[44:47],a[120:123],a[168:171],v[44:47]
M v[48:51],a[128:131],a[168:171],v[48:51]
M v[48:51],a[132:135],a[172:175],v[48:51]
buffer_load_dwordx4 v14, s[48:51], s22 offen offset:2048   lds
M v[52:55],a[140:143],a[172:175],v[52:55]
s_nop 0
T a[52:53],v3,40960
T a[54:55],v3,41984
M v[52:55],a[136:139],a[168:171],v[52:55]
M v[56:59],a[144:147],a[168:171],v[56:59]
buffer_load_dwordx4 v15, s[48:51], s22 offen offset:3072   lds
M v[56:59],a[148:151],a[172:175],v[56:59]
s_waitcnt lgkmcnt(6)
M v[60:63],a[156:159],a[172:175],v[60:63]
s_sub_u32 s22, s22, 1048448
M v[60:63],a[152:155],a[168:171],v[60:63]
s_mov_b32 s25, 1048576
T a[56:57],v4,32768
T a[58:59],v4,33792
M v[64:67],a[96:99],a[160:163],v[64:67]
SA m0,s4,16384
R a[168:171],v5,6144
R a[172:175],v6,6144
M v[64:67],a[100:103],a[164:167],v[64:67]
buffer_load_dwordx4 v8, s[52:55], s25 offen lds
M v[68:71],a[108:111],a[164:167],v[68:71]
s_mov_b32 s25, 1310720
M v[68:71],a[104:107],a[160:163],v[68:71]
SA m0,s4,20480
M v[72:75],a[112:115],a[160:163],v[72:75]
s_waitcnt vmcnt(17)
s_nop 0
T a[60:61],v4,40960
T a[62:63],v4,41984
M v[72:75],a[116:119],a[164:167],v[72:75]
buffer_load_dwordx4 v8, s[52:55], s25 offen lds
M v[76:79],a[124:127],a[164:167],v[76:79]
s_mov_b32 s25, 1572864
R a[208:211],v20,0
R a[212:215],v20,2048
M v[76:79],a[120:123],a[160:163],v[76:79]
SA m0,s4,24576
R a[216:219],v21,0
R a[220:223],v21,2048
M v[80:83],a[128:131],a[160:163],v[80:83]
buffer_load_dwordx4 v8, s[52:55], s25 offen lds
M v[80:83],a[132:135],a[164:167],v[80:83]
s_mov_b32 s25, 1835008
M v[84:87],a[140:143],a[164:167],v[84:87]
SA m0,s4,28672
M v[84:87],a[136:139],a[160:163],v[84:87]
buffer_load_dwordx4 v8, s[52:55], s25 offen lds
M v[88:91],a[144:147],a[160:163],v[88:91]
M v[88:91],a[148:151],a[164:167],v[88:91]
s_waitcnt lgkmcnt(6)
M v[92:95],a[156:159],a[164:167],v[92:95]
s_waitcnt lgkmcnt(0)
M v[92:95],a[152:155],a[160:163],v[92:95]
s_barrier
M v[96:99],a[96:99],a[168:171],v[96:99]
R a[160:163],v5,16384
R a[164:167],v6,16384
M v[96:99],a[100:103],a[172:175],v[96:99]
SA m0,s23,32768
M v[100:103],a[108:111],a[172:175],v[100:103]
s_nop 0
T a[64:65],v1,49152
T a[66:67],v1,50176
M v[100:103],a[104:107],a[168:171],v[100:103]
buffer_load_dwordx4 v22, s[56:59], s29 offen offset:0 lds
M v[104:107],a[112:115],a[168:171],v[104:107]
v_lshrrev_b32 v28, 2, v0
v_lshlrev_b32 v28, 7, v28
M v[104:107],a[116:119],a[172:175],v[104:107]
M v[108:111],a[124:127],a[172:175],v[108:111]
buffer_load_dwordx4 v23, s[56:59], s29 offen offset:1024 lds
M v[108:111],a[120:123],a[168:171],v[108:111]
v_and_b32 v29, 3, v0
M v[112:115],a[128:131],a[168:171],v[112:115]
v_lshl_add_u32 v28, v29, 3, v28
M v[112:115],a[132:135],a[172:175],v[112:115]
s_nop 0
T a[68:69],v1,57344
T a[70:71],v1,58368
M v[116:119],a[140:143],a[172:175],v[116:119]
buffer_load_dwordx4 v22, s[56:59], s30 offen offset:2048 lds
M v[116:119],a[136:139],a[168:171],v[116:119]
v_bfe_u32 v29, v0, 3, 2
M v[120:123],a[144:147],a[168:171],v[120:123]
M v[120:123],a[148:151],a[172:175],v[120:123]
s_waitcnt lgkmcnt(4)
v_lshl_add_u32 v16, v29, 5, v28
M v[124:127],a[156:159],a[172:175],v[124:127]
M v[124:127],a[152:155],a[168:171],v[124:127]
buffer_load_dwordx4 v23, s[56:59], s30 offen offset:3072 lds
M v[128:131],a[96:99],a[160:163],v[128:131]
R a[168:171],v5,18432
R a[172:175],v6,18432
M v[128:131],a[100:103],a[164:167],v[128:131]
SA s29,s29,128
T a[72:73],v2,49152
T a[74:75],v2,50176
M v[132:135],a[108:111],a[164:167],v[132:135]
SA s30,s30,128
v_xor_b32 v17, 32, v16
v_xor_b32 v18, 64, v16
M v[132:135],a[104:107],a[160:163],v[132:135]
SA m0,s23,65536
M v[136:139],a[112:115],a[160:163],v[136:139]
buffer_load_dwordx4 v22, s[56:59], s29 offen offset:0 lds
M v[136:139],a[116:119],a[164:167],v[136:139]
v_xor_b32 v19, 0x60, v16
M v[140:143],a[124:127],a[164:167],v[140:143]
v_add_u32 v12, 0x20000, v16
M v[140:143],a[120:123],a[160:163],v[140:143]
s_nop 0
T a[76:77],v2,57344
T a[78:79],v2,58368
M v[144:147],a[128:131],a[160:163],v[144:147]
buffer_load_dwordx4 v23, s[56:59], s29 offen offset:1024 lds
M v[144:147],a[132:135],a[164:167],v[144:147]
v_add_u32 v13, 0x20000, v17
M v[148:151],a[140:143],a[164:167],v[148:151]
M v[148:151],a[136:139],a[160:163],v[148:151]
v_add_u32 v14, 0x20000, v18
M v[152:155],a[144:147],a[160:163],v[152:155]
M v[152:155],a[148:151],a[164:167],v[152:155]
s_waitcnt lgkmcnt(4)
buffer_load_dwordx4 v22, s[56:59], s30 offen offset:2048 lds
M v[156:159],a[156:159],a[164:167],v[156:159]
s_nop 0
T a[80:81],v3,49152
T a[82:83],v3,50176
M v[156:159],a[152:155],a[160:163],v[156:159]
v_add_u32 v15, 0x20000, v19
M v[160:163],a[96:99],a[168:171],v[160:163]
R a[160:163],v5,20480
R a[164:167],v6,20480
M v[160:163],a[100:103],a[172:175],v[160:163]
M v[164:167],a[108:111],a[172:175],v[164:167]
buffer_load_dwordx4 v23, s[56:59], s30 offen offset:3072 lds
M v[164:167],a[104:107],a[168:171],v[164:167]
SA s29,s29,128
M v[168:171],a[112:115],a[168:171],v[168:171]
SA s30,s30,128
M v[168:171],a[116:119],a[172:175],v[168:171]
s_mov_b32 s25, 2097152
T a[84:85],v3,57344
T a[86:87],v3,58368
M v[172:175],a[124:127],a[172:175],v[172:175]
SA m0,s4,131072
M v[172:175],a[120:123],a[168:171],v[172:175]
buffer_load_dwordx4 v8, s[52:55], s25 offen lds
M v[176:179],a[128:131],a[168:171],v[176:179]
M v[176:179],a[132:135],a[172:175],v[176:179]
s_mov_b32 s25, 2359296
M v[180:183],a[140:143],a[172:175],v[180:183]
SA m0,s4,135168
M v[180:183],a[136:139],a[168:171],v[180:183]
buffer_load_dwordx4 v8, s[52:55], s25 offen lds
M v[184:187],a[144:147],a[168:171],v[184:187]
s_nop 0
T a[88:89],v4,49152
T a[90:91],v4,50176
M v[184:187],a[148:151],a[172:175],v[184:187]
s_waitcnt lgkmcnt(4)
M v[188:191],a[156:159],a[172:175],v[188:191]
L_w_kv07:
s_cbranch_execz L_wd1
s_mov_b32 s25, 2621440
M v[188:191],a[152:155],a[168:171],v[188:191]
SA m0,s4,139264
M v[192:195],a[96:99],a[160:163],v[192:195]
R a[168:171],v5,22528
R a[172:175],v6,22528
M v[192:195],a[100:103],a[164:167],v[192:195]
buffer_load_dwordx4 v8, s[52:55], s25 offen lds
M v[196:199],a[108:111],a[164:167],v[196:199]
M v[196:199],a[104:107],a[160:163],v[196:199]
s_mov_b32 s25, 2883584
T a[92:93],v4,57344
T a[94:95],v4,58368
M v[200:203],a[112:115],a[160:163],v[200:203]
SA m0,s4,143360
M v[200:203],a[116:119],a[164:167],v[200:203]
s_waitcnt vmcnt(19)
buffer_load_dwordx4 v8, s[52:55], s25 offen lds
M v[204:207],a[124:127],a[164:167],v[204:207]
R a[224:227],v20,16384
R a[228:231],v20,18432
M v[204:207],a[120:123],a[160:163],v[204:207]
R a[232:235],v21,16384
R a[236:239],v21,18432
M v[208:211],a[128:131],a[160:163],v[208:211]
v_subrev_u32 v20, 98304, v20
v_subrev_u32 v21, 98304, v21
M v[208:211],a[132:135],a[164:167],v[208:211]
M v[212:215],a[140:143],a[164:167],v[212:215]
M v[212:215],a[136:139],a[160:163],v[212:215]
M v[216:219],a[144:147],a[160:163],v[216:219]
M v[216:219],a[148:151],a[164:167],v[216:219]
s_waitcnt lgkmcnt(6)
M v[220:223],a[156:159],a[164:167],v[220:223]
s_waitcnt lgkmcnt(0)
M v[220:223],a[152:155],a[160:163],v[220:223]
s_barrier
M v[224:227],a[96:99],a[168:171],v[224:227]
R a[160:163],v5,32768
R a[164:167],v6,32768
M v[224:227],a[100:103],a[172:175],v[224:227]
M v[228:231],a[108:111],a[172:175],v[228:231]
M v[228:231],a[104:107],a[168:171],v[228:231]
M v[232:235],a[112:115],a[168:171],v[232:235]
M v[232:235],a[116:119],a[172:175],v[232:235]
M v[236:239],a[124:127],a[172:175],v[236:239]
M v[236:239],a[120:123],a[168:171],v[236:239]
M v[240:243],a[128:131],a[168:171],v[240:243]
M v[240:243],a[132:135],a[172:175],v[240:243]
M v[244:247],a[140:143],a[172:175],v[244:247]
M v[244:247],a[136:139],a[168:171],v[244:247]
M v[248:251],a[144:147],a[168:171],v[248:251]
M v[248:251],a[148:151],a[172:175],v[248:251]
s_waitcnt lgkmcnt(0)
M v[252:255],a[156:159],a[172:175],v[252:255]
M v[252:255],a[152:155],a[168:171],v[252:255]
M a[0:3],a[32:35],a[160:163],a[0:3]
R a[168:171],v5,34816
R a[172:175],v6,34816
M a[0:3],a[36:39],a[164:167],a[0:3]
SA m0,s23,81920
M a[4:7],a[44:47],a[164:167],a[4:7]
buffer_load_dwordx4 v22, s[56:59], s29 offen offset:0 lds
M a[4:7],a[40:43],a[160:163],a[4:7]
M a[8:11],a[48:51],a[160:163],a[8:11]
M a[8:11],a[52:55],a[164:167],a[8:11]
buffer_load_dwordx4 v23, s[56:59], s29 offen offset:1024 lds
M a[12:15],a[60:63],a[164:167],a[12:15]
M a[12:15],a[56:59],a[160:163],a[12:15]
G v24,a0
G v25,a1
M a[16:19],a[64:67],a[160:163],a[16:19]
G v26,a2
G v27,a3
M a[16:19],a[68:71],a[164:167],a[16:19]
buffer_load_dwordx4 v22, s[56:59], s30 offen offset:2048 lds
M a[20:23],a[76:79],a[164:167],a[20:23]
G v28,a4
G v29,a5
M a[20:23],a[72:75],a[160:163],a[20:23]
G v30,a6
G v31,a7
M a[24:27],a[80:83],a[160:163],a[24:27]
C v24,v24,v25
C v25,v26,v27
M a[24:27],a[84:87],a[164:167],a[24:27]
s_waitcnt lgkmcnt(0)
buffer_load_dwordx4 v23, s[56:59], s30 offen offset:3072 lds
M a[28:31],a[92:95],a[164:167],a[28:31]
SA s29,s29,128
C v26,v28,v29
C v27,v30,v31
M a[28:31],a[88:91],a[160:163],a[28:31]
SA s3,s93,0
buffer_store_dwordx4 v[24:27], v7, s[8:11], s3 offen offset:0 sc1
M v[32:35],a[32:35],a[168:171],v[32:35]
SA s30,s30,128
R a[160:163],v5,36864
R a[164:167],v6,36864
M v[32:35],a[36:39],a[172:175],v[32:35]
s_mov_b32 s25, 3145728
G v24,a8
G v25,a9
M v[36:39],a[44:47],a[172:175],v[36:39]
SA m0,s4,147456
G v26,a10
G v27,a11
M v[36:39],a[40:43],a[168:171],v[36:39]
buffer_load_dwordx4 v8, s[52:55], s25 offen lds
M v[40:43],a[48:51],a[168:171],v[40:43]
s_mov_b32 s25, 3407872
G v28,a12
G v29,a13
M v[40:43],a[52:55],a[172:175],v[40:43]
SA m0,s4,151552
G v30,a14
G v31,a15
M v[44:47],a[60:63],a[172:175],v[44:47]
buffer_load_dwordx4 v8, s[52:55], s25 offen lds
M v[44:47],a[56:59],a[168:171],v[44:47]
s_mov_b32 s25, 128
C v24,v24,v25
C v25,v26,v27
M v[48:51],a[64:67],a[168:171],v[48:51]
SA m0,s4,49152
C v26,v28,v29
C v27,v30,v31
M v[48:51],a[68:71],a[172:175],v[48:51]
buffer_store_dwordx4 v[24:27], v7, s[8:11], s3 offen offset:1024 sc1
M v[52:55],a[76:79],a[172:175],v[52:55]
s_nop 0
G v24,a16
G v25,a17
M v[52:55],a[72:75],a[168:171],v[52:55]
G v26,a18
G v27,a19
M v[56:59],a[80:83],a[168:171],v[56:59]
buffer_load_dwordx4 v8, s[52:55], s25 offen lds
M v[56:59],a[84:87],a[172:175],v[56:59]
s_waitcnt lgkmcnt(0)
G v28,a20
G v29,a21
M v[60:63],a[92:95],a[172:175],v[60:63]
s_mov_b32 s25, 262272
G v30,a22
G v31,a23
M v[60:63],a[88:91],a[168:171],v[60:63]
SA m0,s4,53248
C v24,v24,v25
C v25,v26,v27
M v[64:67],a[32:35],a[160:163],v[64:67]
s_waitcnt vmcnt(17)
R a[168:171],v5,38912
R a[172:175],v6,38912
M v[64:67],a[36:39],a[164:167],v[64:67]
buffer_load_dwordx4 v8, s[52:55], s25 offen lds
M v[68:71],a[44:47],a[164:167],v[68:71]
s_mov_b32 s25, 524416
C v26,v28,v29
C v27,v30,v31
M v[68:71],a[40:43],a[160:163],v[68:71]
SA m0,s4,57344
buffer_store_dwordx4 v[24:27], v7, s[8:11], s3 offen offset:2048 sc1
M v[72:75],a[48:51],a[160:163],v[72:75]
R a[96:99],v20,0
R a[100:103],v20,2048
M v[72:75],a[52:55],a[164:167],v[72:75]
R a[104:107],v21,0
R a[108:111],v21,2048
M v[76:79],a[60:63],a[164:167],v[76:79]
buffer_load_dwordx4 v8, s[52:55], s25 offen lds
M v[76:79],a[56:59],a[160:163],v[76:79]
s_mov_b32 s25, 786560
G v24,a24
G v25,a25
M v[80:83],a[64:67],a[160:163],v[80:83]
SA m0,s4,61440
G v26,a26
G v27,a27
M v[80:83],a[68:71],a[164:167],v[80:83]
buffer_load_dwordx4 v8, s[52:55], s25 offen lds
M v[84:87],a[76:79],a[164:167],v[84:87]
G v28,a28
G v29,a29
M v[84:87],a[72:75],a[160:163],v[84:87]
G v30,a30
G v31,a31
M v[88:91],a[80:83],a[160:163],v[88:91]
C v24,v24,v25
C v25,v26,v27
M v[88:91],a[84:87],a[164:167],v[88:91]
s_waitcnt lgkmcnt(4)
C v26,v28,v29
C v27,v30,v31
M v[92:95],a[92:95],a[164:167],v[92:95]
s_waitcnt lgkmcnt(0)
buffer_store_dwordx4 v[24:27], v7, s[8:11], s3 offen offset:3072 sc1
M v[92:95],a[88:91],a[160:163],v[92:95]
s_barrier
M v[96:99],a[32:35],a[168:171],v[96:99]
R a[160:163],v5,49152
R a[164:167],v6,49152
M v[96:99],a[36:39],a[172:175],v[96:99]
s_mov_b32 s25, 1048704
C v64,v64,v65
C v65,v66,v67
M v[100:103],a[44:47],a[172:175],v[100:103]
SA m0,s4,98304
C v66,v68,v69
C v67,v70,v71
M v[100:103],a[40:43],a[168:171],v[100:103]
s_waitcnt vmcnt(18)
buffer_load_dwordx4 v8, s[52:55], s25 offen lds
M v[104:107],a[48:51],a[168:171],v[104:107]
C v72,v72,v73
C v73,v74,v75
M v[104:107],a[52:55],a[172:175],v[104:107]
C v74,v76,v77
C v75,v78,v79
M v[108:111],a[60:63],a[172:175],v[108:111]
C v32,v32,v33
C v33,v34,v35
M v[108:111],a[56:59],a[168:171],v[108:111]
C v34,v36,v37
C v35,v38,v39
M v[112:115],a[64:67],a[168:171],v[112:115]
SA s3,s93,8192
buffer_store_dwordx4 v[32:35], v7, s[8:11], s3 offen offset:0 sc1
M v[112:115],a[68:71],a[172:175],v[112:115]
s_mov_b32 s25, 1310848
C v80,v80,v81
C v81,v82,v83
M v[116:119],a[76:79],a[172:175],v[116:119]
SA m0,s4,102400
C v82,v84,v85
C v83,v86,v87
M v[116:119],a[72:75],a[168:171],v[116:119]
R a[112:115],v20,32768
R a[116:119],v20,34816
M v[120:123],a[80:83],a[168:171],v[120:123]
buffer_load_dwordx4 v8, s[52:55], s25 offen lds
M v[120:123],a[84:87],a[172:175],v[120:123]
s_waitcnt lgkmcnt(2)
R a[120:123],v21,32768
R a[124:127],v21,34816
M v[124:127],a[92:95],a[172:175],v[124:127]
C v88,v88,v89
C v89,v90,v91
M v[124:127],a[88:91],a[168:171],v[124:127]
C v90,v92,v93
C v91,v94,v95
M v[128:131],a[32:35],a[160:163],v[128:131]
R a[168:171],v5,51200
R a[172:175],v6,51200
M v[128:131],a[36:39],a[164:167],v[128:131]
C v40,v40,v41
C v41,v42,v43
M v[132:135],a[44:47],a[164:167],v[132:135]
C v42,v44,v45
C v43,v46,v47
M v[132:135],a[40:43],a[160:163],v[132:135]
s_mov_b32 s25, 1572992
buffer_store_dwordx4 v[40:43], v7, s[8:11], s3 offen offset:1024 sc1
M v[136:139],a[48:51],a[160:163],v[136:139]
SA m0,s4,106496
C v96,v96,v97
C v97,v98,v99
M v[136:139],a[52:55],a[164:167],v[136:139]
C v98,v100,v101
C v99,v102,v103
M v[140:143],a[60:63],a[164:167],v[140:143]
C v104,v104,v105
C v105,v106,v107
M v[140:143],a[56:59],a[160:163],v[140:143]
buffer_load_dwordx4 v8, s[52:55], s25 offen lds
M v[144:147],a[64:67],a[160:163],v[144:147]
C v106,v108,v109
C v107,v110,v111
M v[144:147],a[68:71],a[164:167],v[144:147]
C v112,v112,v113
C v113,v114,v115
M v[148:151],a[76:79],a[164:167],v[148:151]
C v114,v116,v117
C v115,v118,v119
M v[148:151],a[72:75],a[160:163],v[148:151]
C v48,v48,v49
C v49,v50,v51
M v[152:155],a[80:83],a[160:163],v[152:155]
C v50,v52,v53
C v51,v54,v55
M v[152:155],a[84:87],a[164:167],v[152:155]
s_waitcnt lgkmcnt(0)
buffer_store_dwordx4 v[48:51], v7, s[8:11], s3 offen offset:2048 sc1
M v[156:159],a[92:95],a[164:167],v[156:159]
s_mov_b32 s25, 1835136
C v120,v120,v121
C v121,v122,v123
M v[156:159],a[88:91],a[160:163],v[156:159]
SA m0,s4,110592
C v122,v124,v125
C v123,v126,v127
M v[160:163],a[32:35],a[168:171],v[160:163]
R a[160:163],v5,53248
R a[164:167],v6,53248
M v[160:163],a[36:39],a[172:175],v[160:163]
buffer_load_dwordx4 v8, s[52:55], s25 offen lds
M v[164:167],a[44:47],a[172:175],v[164:167]
C v128,v128,v129
C v129,v130,v131
M v[164:167],a[40:43],a[168:171],v[164:167]
C v130,v132,v133
C v131,v134,v135
M v[168:171],a[48:51],a[168:171],v[168:171]
C v56,v56,v57
C v57,v58,v59
M v[168:171],a[52:55],a[172:175],v[168:171]
C v58,v60,v61
C v59,v62,v63
M v[172:175],a[60:63],a[172:175],v[172:175]
buffer_store_dwordx4 v[56:59], v7, s[8:11], s3 offen offset:3072 sc1
M v[172:175],a[56:59],a[168:171],v[172:175]
C v136,v136,v137
C v137,v138,v139
M v[176:179],a[64:67],a[168:171],v[176:179]
C v138,v140,v141
C v139,v142,v143
M v[176:179],a[68:71],a[172:175],v[176:179]
C v144,v144,v145
C v145,v146,v147
M v[180:183],a[76:79],a[172:175],v[180:183]
C v146,v148,v149
C v147,v150,v151
M v[180:183],a[72:75],a[168:171],v[180:183]
C v152,v152,v153
C v153,v154,v155
M v[184:187],a[80:83],a[168:171],v[184:187]
C v154,v156,v157
C v155,v158,v159
M v[184:187],a[84:87],a[172:175],v[184:187]
s_waitcnt lgkmcnt(0)
C v160,v160,v161
C v161,v162,v163
M v[188:191],a[92:95],a[172:175],v[188:191]
C v162,v164,v165
C v163,v166,v167
M v[188:191],a[88:91],a[168:171],v[188:191]
C v168,v168,v169
C v169,v170,v171
M v[192:195],a[32:35],a[160:163],v[192:195]
s_waitcnt vmcnt(18)
R a[168:171],v5,55296
R a[172:175],v6,55296
M v[192:195],a[36:39],a[164:167],v[192:195]
C v170,v172,v173
C v171,v174,v175
M v[196:199],a[44:47],a[164:167],v[196:199]
C v176,v176,v177
C v177,v178,v179
M v[196:199],a[40:43],a[160:163],v[196:199]
C v178,v180,v181
C v179,v182,v183
M v[200:203],a[48:51],a[160:163],v[200:203]
R a[128:131],v20,49152
R a[132:135],v20,51200
M v[200:203],a[52:55],a[164:167],v[200:203]
R a[136:139],v21,49152
R a[140:143],v21,51200
M v[204:207],a[60:63],a[164:167],v[204:207]
C v184,v184,v185
C v185,v186,v187
M v[204:207],a[56:59],a[160:163],v[204:207]
C v186,v188,v189
C v187,v190,v191
M v[208:211],a[64:67],a[160:163],v[208:211]
C v192,v192,v193
C v193,v194,v195
M v[208:211],a[68:71],a[164:167],v[208:211]
C v194,v196,v197
C v195,v198,v199
M v[212:215],a[76:79],a[164:167],v[212:215]
M v[212:215],a[72:75],a[160:163],v[212:215]
C v200,v200,v201
C v201,v202,v203
M v[216:219],a[80:83],a[160:163],v[216:219]
C v202,v204,v205
C v203,v206,v207
M v[216:219],a[84:87],a[164:167],v[216:219]
s_waitcnt lgkmcnt(4)
M v[220:223],a[92:95],a[164:167],v[220:223]
s_waitcnt vmcnt(15) lgkmcnt(0)
M v[220:223],a[88:91],a[160:163],v[220:223]
s_barrier
M v[224:227],a[32:35],a[168:171],v[224:227]
s_nop 0
T v[32:33],v16,0
T v[34:35],v16,2048
M v[224:227],a[36:39],a[172:175],v[224:227]
C v208,v208,v209
C v209,v210,v211
M v[228:231],a[44:47],a[172:175],v[228:231]
T v[36:37],v16,4096
T v[38:39],v16,6144
M v[228:231],a[40:43],a[168:171],v[228:231]
T v[40:41],v16,8192
T v[42:43],v16,10240
M v[232:235],a[48:51],a[168:171],v[232:235]
C v210,v212,v213
C v211,v214,v215
M v[232:235],a[52:55],a[172:175],v[232:235]
T v[44:45],v16,12288
T v[46:47],v16,14336
M v[236:239],a[60:63],a[172:175],v[236:239]
T v[48:49],v16,16384
T v[50:51],v16,18432
M v[236:239],a[56:59],a[168:171],v[236:239]
C v216,v216,v217
C v217,v218,v219
M v[240:243],a[64:67],a[168:171],v[240:243]
T v[52:53],v16,20480
T v[54:55],v16,22528
M v[240:243],a[68:71],a[172:175],v[240:243]
T v[56:57],v16,24576
T v[58:59],v16,26624
M v[244:247],a[76:79],a[172:175],v[244:247]
C v218,v220,v221
C v219,v222,v223
M v[244:247],a[72:75],a[168:171],v[244:247]
C v224,v224,v225
C v225,v226,v227
M v[248:251],a[80:83],a[168:171],v[248:251]
C v226,v228,v229
C v227,v230,v231
M v[248:251],a[84:87],a[172:175],v[248:251]
C v232,v232,v233
C v233,v234,v235
M v[252:255],a[92:95],a[172:175],v[252:255]
C v234,v236,v237
C v235,v238,v239
M v[252:255],a[88:91],a[168:171],v[252:255]
s_waitcnt lgkmcnt(6)
C v240,v240,v241
C v241,v242,v243
M v[68:71],v[32:35],a[176:179],0
s_mul_i32 s72, s41, 4352
T a[144:145],v17,0
T a[146:147],v17,2048
M v[68:71],v[36:39],a[184:187],v[68:71]
SA s46,s72,104923136
C v242,v244,v245
C v243,v246,v247
M v[68:71],v[40:43],a[192:195],v[68:71]
s_waitcnt lgkmcnt(2)
T a[148:149],v17,4096
T a[150:151],v17,6144
M v[68:71],v[44:47],a[200:203],v[68:71]
s_mov_b32 s25, 2097280
T a[152:153],v17,8192
T a[154:155],v17,10240
M v[68:71],v[48:51],a[208:211],v[68:71]
SA m0,s4,114688
C v248,v248,v249
C v249,v250,v251
M v[68:71],v[52:55],a[216:219],v[68:71]
s_lshl_b32 s45, s42, 7
T a[156:157],v17,12288
T a[158:159],v17,14336
M v[68:71],v[56:59],a[224:227],v[68:71]
SA s45,s45,s46
T a[160:161],v17,16384
T a[162:163],v17,18432
M v[76:79],v[56:59],a[228:231],0
s_lshl_b32 s72, s20, 2
buffer_load_dwordx4 v8, s[52:55], s25 offen lds
M v[76:79],v[52:55],a[220:223],v[76:79]
SA s72,s72,s45
T a[164:165],v17,20480
T a[166:167],v17,22528
M v[76:79],v[48:51],a[212:215],v[76:79]
T a[168:169],v17,24576
T a[170:171],v17,26624
M v[76:79],v[44:47],a[204:207],v[76:79]
s_mov_b32 s25, 2359424
C v250,v252,v253
C v251,v254,v255
M v[76:79],v[40:43],a[196:199],v[76:79]
SA m0,s4,118784
v_min_u32 v29, 1, v0
v_lshlrev_b32 v29, 29, v29
M v[76:79],v[36:39],a[188:191],v[76:79]
buffer_load_dwordx4 v8, s[52:55], s25 offen lds
M v[76:79],v[32:35],a[180:183],v[76:79]
s_waitcnt lgkmcnt(6)
v_mov_b32 v30, 1
M v[84:87],a[144:147],a[176:179],0
s_nop 0
T v[32:33],v18,0
T v[34:35],v18,2048
M v[84:87],a[148:151],a[184:187],v[84:87]
s_mov_b32 s25, 2621568
M v[84:87],a[152:155],a[192:195],v[84:87]
s_waitcnt lgkmcnt(2)
s_nop 0
T v[36:37],v18,4096
T v[38:39],v18,6144
M v[84:87],a[156:159],a[200:203],v[84:87]
SA m0,s4,122880
T v[40:41],v18,8192
T v[42:43],v18,10240
M v[84:87],a[160:163],a[208:211],v[84:87]
buffer_load_dwordx4 v8, s[52:55], s25 offen lds
M v[84:87],a[164:167],a[216:219],v[84:87]
s_nop 0
T v[44:45],v18,12288
T v[46:47],v18,14336
M v[84:87],a[168:171],a[224:227],v[84:87]
s_waitcnt vmcnt(3)
T v[48:49],v18,16384
T v[50:51],v18,18432
M v[92:95],a[168:171],a[228:231],0
s_mov_b32 s25, 2883712
buffer_store_dword v30, v29, s[8:11], s72 offen offset:4 sc1
M v[92:95],a[164:167],a[220:223],v[92:95]
SA m0,s4,126976
T v[52:53],v18,20480
T v[54:55],v18,22528
M v[92:95],a[160:163],a[212:215],v[92:95]
T v[56:57],v18,24576
T v[58:59],v18,26624
M v[92:95],a[156:159],a[204:207],v[92:95]
buffer_load_dwordx4 v8, s[52:55], s25 offen lds
L_w_kv08:
s_cbranch_execz L_wd1
M v[92:95],a[152:155],a[196:199],v[92:95]
v_add_u32 v20, 0x10000, v16
v_add_u32 v21, 0x10000, v17
M v[92:95],a[148:151],a[188:191],v[92:95]
M v[92:95],a[144:147],a[180:183],v[92:95]
s_waitcnt lgkmcnt(6)
v_add_u32 v22, 0x10000, v18
M v[100:103],v[32:35],a[176:179],0
s_mov_b32 s25, 3145856
T a[144:145],v19,0
T a[146:147],v19,2048
M v[100:103],v[36:39],a[184:187],v[100:103]
SA m0,s4,32768
M v[100:103],v[40:43],a[192:195],v[100:103]
s_waitcnt lgkmcnt(2)
s_nop 0
T a[148:149],v19,4096
T a[150:151],v19,6144
M v[100:103],v[44:47],a[200:203],v[100:103]
T a[152:153],v19,8192
T a[154:155],v19,10240
M v[100:103],v[48:51],a[208:211],v[100:103]
buffer_load_dwordx4 v8, s[52:55], s25 offen lds
M v[100:103],v[52:55],a[216:219],v[100:103]
s_nop 0
T a[156:157],v19,12288
T a[158:159],v19,14336
M v[100:103],v[56:59],a[224:227],v[100:103]
T a[160:161],v19,16384
T a[162:163],v19,18432
M v[108:111],v[56:59],a[228:231],0
s_mov_b32 s25, 3408000
v_add_u32 v23, 0x10000, v19
v_or_b32 v1, s20, v0
M v[108:111],v[52:55],a[220:223],v[108:111]
SA m0,s4,36864
T a[164:165],v19,20480
T a[166:167],v19,22528
M v[108:111],v[48:51],a[212:215],v[108:111]
SA s3,s93,524288
T a[168:169],v19,24576
T a[170:171],v19,26624
M v[108:111],v[44:47],a[204:207],v[108:111]
buffer_load_dwordx4 v8, s[52:55], s25 offen lds
M v[108:111],v[40:43],a[196:199],v[108:111]
v_min_u32 v1, 1, v1
M v[108:111],v[36:39],a[188:191],v[108:111]
M v[108:111],v[32:35],a[180:183],v[108:111]
s_waitcnt lgkmcnt(6)
buffer_store_dwordx4 v[64:67], v7, s[8:11], s3 offen offset:0 sc1
M v[116:119],a[144:147],a[176:179],0
s_mov_b32 s25, 256
T v[32:33],v16,28672
T v[34:35],v16,30720
M v[116:119],a[148:151],a[184:187],v[116:119]
SA m0,s4,65536
v_lshlrev_b32 v1, 29, v1
M v[116:119],a[152:155],a[192:195],v[116:119]
s_waitcnt lgkmcnt(2)
s_nop 0
T v[36:37],v12,0
T v[38:39],v12,2048
M v[116:119],a[156:159],a[200:203],v[116:119]
T v[40:41],v12,4096
T v[42:43],v12,6144
M v[116:119],a[160:163],a[208:211],v[116:119]
buffer_load_dwordx4 v8, s[52:55], s25 offen lds
M v[116:119],a[164:167],a[216:219],v[116:119]
s_nop 0
T v[44:45],v12,8192
T v[46:47],v12,10240
M v[116:119],a[168:171],a[224:227],v[116:119]
T v[48:49],v12,12288
T v[50:51],v12,14336
M v[124:127],a[168:171],a[228:231],0
s_mov_b32 s25, 262400
buffer_store_dwordx4 v[72:75], v7, s[8:11], s3 offen offset:1024 sc1
M v[124:127],a[164:167],a[220:223],v[124:127]
SA m0,s4,69632
T v[52:53],v12,16384
T v[54:55],v12,18432
M v[124:127],a[160:163],a[212:215],v[124:127]
T v[56:57],v12,20480
T v[58:59],v12,22528
M v[124:127],a[156:159],a[204:207],v[124:127]
buffer_load_dwordx4 v8, s[52:55], s25 offen lds
M v[124:127],a[152:155],a[196:199],v[124:127]
v_min_u32 v9, 15, v0
v_lshlrev_b32 v9, 7, v9
M v[124:127],a[148:151],a[188:191],v[124:127]
s_sub_u32 s66, 15, s42
buffer_store_dwordx4 v[80:83], v7, s[8:11], s3 offen offset:2048 sc1
M v[124:127],a[144:147],a[180:183],v[124:127]
s_waitcnt lgkmcnt(6)
M v[68:71],v[32:35],a[232:235],v[68:71]
s_mov_b32 s25, 524544
T a[144:145],v17,28672
T a[146:147],v17,30720
M v[68:71],v[36:39],a[96:99],v[68:71]
SA m0,s4,73728
buffer_store_dwordx4 v[88:91], v7, s[8:11], s3 offen offset:3072 sc1
M v[68:71],v[40:43],a[104:107],v[68:71]
s_waitcnt lgkmcnt(2)
s_nop 0
T a[148:149],v13,0
T a[150:151],v13,2048
M v[68:71],v[44:47],a[112:115],v[68:71]
s_max_u32 s67, s66, s42
T a[152:153],v13,4096
T a[154:155],v13,6144
M v[68:71],v[48:51],a[120:123],v[68:71]
s_min_u32 s66, s66, s42
buffer_load_dwordx4 v8, s[52:55], s25 offen lds
M v[68:71],v[52:55],a[128:131],v[68:71]
s_mul_i32 s21, s41, 1048576
T a[156:157],v13,8192
T a[158:159],v13,10240
M v[68:71],v[56:59],a[136:139],v[68:71]
s_lshl_b32 s64, s67, 16
T a[160:161],v13,12288
T a[162:163],v13,14336
M v[76:79],v[56:59],a[140:143],v[76:79]
s_mov_b32 s25, 786688
M v[76:79],v[52:55],a[132:135],v[76:79]
SA m0,s4,77824
T a[164:165],v13,16384
T a[166:167],v13,18432
M v[76:79],v[48:51],a[124:127],v[76:79]
SA s32,s21,s64
T a[168:169],v13,20480
T a[170:171],v13,22528
M v[76:79],v[44:47],a[116:119],v[76:79]
s_lshl_b32 s64, s20, 14
buffer_load_dwordx4 v8, s[52:55], s25 offen lds
M v[76:79],v[40:43],a[108:111],v[76:79]
SA s32,s32,s64
M v[76:79],v[36:39],a[100:103],v[76:79]
SA s32,s32,33554432
M v[76:79],v[32:35],a[236:239],v[76:79]
s_waitcnt lgkmcnt(6)
M v[84:87],a[144:147],a[232:235],v[84:87]
s_mov_b32 s25, 1048832
T v[32:33],v18,28672
T v[34:35],v18,30720
M v[84:87],a[148:151],a[96:99],v[84:87]
SA m0,s4,81920
M v[84:87],a[152:155],a[104:107],v[84:87]
s_waitcnt lgkmcnt(2)
s_nop 0
T v[36:37],v14,0
T v[38:39],v14,2048
M v[84:87],a[156:159],a[112:115],v[84:87]
s_sub_u32 s64, s42, 10
T v[40:41],v14,4096
T v[42:43],v14,6144
M v[84:87],a[160:163],a[120:123],v[84:87]
s_and_b32 s35, s64, 536870912
buffer_load_dwordx4 v8, s[52:55], s25 offen lds
M v[84:87],a[164:167],a[128:131],v[84:87]
s_nop 0
T v[44:45],v14,8192
T v[46:47],v14,10240
M v[84:87],a[168:171],a[136:139],v[84:87]
T v[48:49],v14,12288
T v[50:51],v14,14336
M v[92:95],a[168:171],a[140:143],v[92:95]
s_mov_b32 s25, 1310976
v_or_b32 v6, s35, v7
M v[92:95],a[164:167],a[132:135],v[92:95]
SA m0,s4,86016
T v[52:53],v14,16384
T v[54:55],v14,18432
M v[92:95],a[160:163],a[124:127],v[92:95]
s_lshl_b32 s28, s20, 13
T v[56:57],v14,20480
T v[58:59],v14,22528
M v[92:95],a[156:159],a[116:119],v[92:95]
buffer_load_dwordx4 v8, s[52:55], s25 offen lds
M v[92:95],a[152:155],a[108:111],v[92:95]
v_add_u32 v2, 0x10000, v7
v_add_u32 v3, s28, v7
M v[92:95],a[148:151],a[100:103],v[92:95]
v_add_u32 v4, 0x1000, v3
MF v68,s5,v68
M v[92:95],a[144:147],a[236:239],v[92:95]
s_waitcnt lgkmcnt(6)
MF v69,s5,v69
MF v70,s5,v70
M v[100:103],v[32:35],a[232:235],v[100:103]
s_mov_b32 s25, 1573120
T a[144:145],v19,28672
T a[146:147],v19,30720
M v[100:103],v[36:39],a[96:99],v[100:103]
SA m0,s4,90112
MF v71,s5,v71
MF v84,s5,v84
M v[100:103],v[40:43],a[104:107],v[100:103]
s_waitcnt lgkmcnt(2)
T a[148:149],v15,0
T a[150:151],v15,2048
M v[100:103],v[44:47],a[112:115],v[100:103]
s_lshl_b32 s64, s42, 16
T a[152:153],v15,4096
T a[154:155],v15,6144
M v[100:103],v[48:51],a[120:123],v[100:103]
SA s23,s21,s64
buffer_load_dwordx4 v8, s[52:55], s25 offen lds
M v[100:103],v[52:55],a[128:131],v[100:103]
SA s43,s23,16777216
T a[156:157],v15,8192
T a[158:159],v15,10240
M v[100:103],v[56:59],a[136:139],v[100:103]
SA s26,s21,16777216
T a[160:161],v15,12288
T a[162:163],v15,14336
M v[108:111],v[56:59],a[140:143],v[108:111]
s_mov_b32 s25, 1835264
MF v85,s5,v85
MF v86,s5,v86
M v[108:111],v[52:55],a[132:135],v[108:111]
SA m0,s4,94208
T a[164:165],v15,16384
T a[166:167],v15,18432
M v[108:111],v[48:51],a[124:127],v[108:111]
s_mov_b32 s22, 0x7fff
T a[168:169],v15,20480
T a[170:171],v15,22528
M v[108:111],v[44:47],a[116:119],v[108:111]
s_sub_u32 s27, s42, 1
buffer_load_dwordx4 v8, s[52:55], s25 offen lds
M v[108:111],v[40:43],a[108:111],v[108:111]
s_cmp_eq_u32 s42, 0
MF v87,s5,v87
C v68,v68,v69
M v[108:111],v[36:39],a[100:103],v[108:111]
s_waitcnt vmcnt(12) lgkmcnt(0)
C v69,v70,v71
C v70,v84,v85
M v[108:111],v[32:35],a[236:239],v[108:111]
s_barrier
M v[116:119],a[144:147],a[232:235],v[116:119]
s_mov_b32 s25, 2097408
T v[32:33],v16,49152
T v[34:35],v16,51200
M v[116:119],a[148:151],a[96:99],v[116:119]
s_cselect_b32 s64, 32768, 0
C v71,v86,v87
W a0,v68
M v[116:119],a[152:155],a[104:107],v[116:119]
SA m0,s4,155648
T v[36:37],v16,53248
T v[38:39],v16,55296
M v[116:119],a[156:159],a[112:115],v[116:119]
SA s26,s26,s64
T v[40:41],v16,57344
T v[42:43],v16,59392
M v[116:119],a[160:163],a[120:123],v[116:119]
s_mov_b32 s31, 0x4b800000
buffer_load_dwordx4 v8, s[52:55], s25 offen lds
M v[116:119],a[164:167],a[128:131],v[116:119]
s_mov_b32 s24, 0x33800000
T v[44:45],v16,61440
T v[46:47],v16,63488
M v[116:119],a[168:171],a[136:139],v[116:119]
s_lshl_b32 s47, s66, 7
T v[48:49],v20,32768
T v[50:51],v20,34816
M v[124:127],a[168:171],a[140:143],v[124:127]
s_mov_b32 s25, 2359552
W a1,v69
W a2,v70
M v[124:127],a[164:167],a[132:135],v[124:127]
SA m0,s4,159744
T v[52:53],v20,36864
T v[54:55],v20,38912
M v[124:127],a[160:163],a[124:127],v[124:127]
SA s47,s47,s46
T v[56:57],v20,40960
T v[58:59],v20,43008
M v[124:127],a[156:159],a[116:119],v[124:127]
s_lshl_b32 s64, s20, 5
buffer_load_dwordx4 v8, s[52:55], s25 offen lds
M v[124:127],a[152:155],a[108:111],v[124:127]
SA s47,s47,s64
W a3,v71
MF v76,s5,v76
M v[124:127],a[148:151],a[100:103],v[124:127]
SA s47,s47,2048
MF v77,s5,v77
MF v78,s5,v78
M v[124:127],a[144:147],a[236:239],v[124:127]
s_waitcnt lgkmcnt(6)
MF v79,s5,v79
MF v92,s5,v92
M v[132:135],v[32:35],a[176:179],0
s_lshl_b32 s65, s41, 3
T a[144:145],v17,49152
T a[146:147],v17,51200
M v[132:135],v[36:39],a[184:187],v[132:135]
SA s65,s65,s66
MF v93,s5,v93
MF v94,s5,v94
M v[132:135],v[40:43],a[192:195],v[132:135]
s_waitcnt lgkmcnt(2)
T a[148:149],v17,53248
T a[150:151],v17,55296
M v[132:135],v[44:47],a[200:203],v[132:135]
s_mul_i32 s34, s65, 73728
T a[152:153],v17,57344
T a[154:155],v17,59392
M v[132:135],v[48:51],a[208:211],v[132:135]
SA s34,s34,136314880
MF v95,s5,v95
C v76,v76,v77
M v[132:135],v[52:55],a[216:219],v[132:135]
s_lshl_b32 s65, s42, 4
T a[156:157],v17,61440
T a[158:159],v17,63488
M v[132:135],v[56:59],a[224:227],v[132:135]
SA s65,s65,s41
T a[160:161],v21,32768
T a[162:163],v21,34816
M v[140:143],v[56:59],a[228:231],0
s_mul_i32 s33, s65, 114688
C v77,v78,v79
C v78,v92,v93
M v[140:143],v[52:55],a[220:223],v[140:143]
s_mul_i32 s65, s20, 28672
T a[164:165],v21,36864
T a[166:167],v21,38912
M v[140:143],v[48:51],a[212:215],v[140:143]
SA s33,s33,s65
T a[168:169],v21,40960
T a[170:171],v21,43008
M v[140:143],v[44:47],a[204:207],v[140:143]
SA s33,s33,67108864
C v79,v94,v95
W a32,v76
M v[140:143],v[40:43],a[196:199],v[140:143]
s_mov_b32 s6, 0
W a33,v77
W a34,v78
M v[140:143],v[36:39],a[188:191],v[140:143]
s_mov_b32 s7, 0
W a35,v79
MF v100,s5,v100
M v[140:143],v[32:35],a[180:183],v[140:143]
s_waitcnt lgkmcnt(6)
MF v101,s5,v101
MF v102,s5,v102
M v[148:151],a[144:147],a[176:179],0
s_mov_b32 s40, 1
T v[32:33],v18,49152
T v[34:35],v18,51200
M v[148:151],a[148:151],a[184:187],v[148:151]
s_cmp_eq_u32 s20, 0
MF v103,s5,v103
MF v116,s5,v116
M v[148:151],a[152:155],a[192:195],v[148:151]
s_waitcnt lgkmcnt(2)
T v[36:37],v18,53248
T v[38:39],v18,55296
M v[148:151],a[156:159],a[200:203],v[148:151]
s_cselect_b32 s39, 7, 0
T v[40:41],v18,57344
T v[42:43],v18,59392
M v[148:151],a[160:163],a[208:211],v[148:151]
s_lshl_b32 s64, s41, 1
MF v117,s5,v117
MF v118,s5,v118
M v[148:151],a[164:167],a[216:219],v[148:151]
SA s64,s64,s20
T v[44:45],v18,61440
T v[46:47],v18,63488
M v[148:151],a[168:171],a[224:227],v[148:151]
s_cmp_lt_u32 s64, 30
T v[48:49],v22,32768
T v[50:51],v22,34816
M v[156:159],a[168:171],a[228:231],0
s_cselect_b32 s64, 30, 0
MF v119,s5,v119
C v100,v100,v101
M v[156:159],a[164:167],a[220:223],v[156:159]
s_cmp_ge_u32 s20, 2
T v[52:53],v22,36864
T v[54:55],v22,38912
M v[156:159],a[160:163],a[212:215],v[156:159]
s_cselect_b32 s64, s64, 0
T v[56:57],v22,40960
T v[58:59],v22,43008
M v[156:159],a[156:159],a[204:207],v[156:159]
s_cmp_eq_u32 s42, 6
C v101,v102,v103
C v102,v116,v117
M v[156:159],a[152:155],a[196:199],v[156:159]
s_cselect_b32 s64, s64, 0
C v103,v118,v119
W a4,v100
M v[156:159],a[148:151],a[188:191],v[156:159]
s_or_b32 s39, s39, s64
W a5,v101
W a6,v102
M v[156:159],a[144:147],a[180:183],v[156:159]
s_waitcnt lgkmcnt(6)
W a7,v103
MF v108,s5,v108
M v[164:167],v[32:35],a[176:179],0
s_mov_b64 s[60:61], s[76:77]
T a[144:145],v19,49152
T a[146:147],v19,51200
M v[164:167],v[36:39],a[184:187],v[164:167]
s_mov_b32 s62, s78
MF v109,s5,v109
MF v110,s5,v110
M v[164:167],v[40:43],a[192:195],v[164:167]
s_waitcnt lgkmcnt(2)
T a[148:149],v19,53248
T a[150:151],v19,55296
M v[164:167],v[44:47],a[200:203],v[164:167]
s_mov_b32 s63, 0x20000
T a[152:153],v19,57344
T a[154:155],v19,59392
M v[164:167],v[48:51],a[208:211],v[164:167]
s_mov_b32 s25, 2621696
v_lshrrev_b32 v24, 4, v0
v_lshlrev_b32 v24, 2, v24
M v[164:167],v[52:55],a[216:219],v[164:167]
SA m0,s4,131072
T a[156:157],v19,61440
T a[158:159],v19,63488
M v[164:167],v[56:59],a[224:227],v[164:167]
SA s3,s93,532480
T a[160:161],v23,32768
T a[162:163],v23,34816
M v[172:175],v[56:59],a[228:231],0
buffer_load_dwordx4 v8, s[52:55], s25 offen lds
M v[172:175],v[52:55],a[220:223],v[172:175]
s_nop 0
T a[164:165],v23,36864
T a[166:167],v23,38912
M v[172:175],v[48:51],a[212:215],v[172:175]
T a[168:169],v23,40960
T a[170:171],v23,43008
M v[172:175],v[44:47],a[204:207],v[172:175]
s_mov_b32 s25, 2883840
buffer_store_dwordx4 v[96:99], v7, s[8:11], s3 offen offset:0 sc1
M v[172:175],v[40:43],a[196:199],v[172:175]
SA m0,s4,135168
v_and_b32 v25, 15, v0
v_sub_u32 v24, v24, v25
M v[172:175],v[36:39],a[188:191],v[172:175]
buffer_load_dwordx4 v8, s[52:55], s25 offen lds
M v[172:175],v[32:35],a[180:183],v[172:175]
s_waitcnt lgkmcnt(6)
v_cmp_lt_i32 s[16:17], 0, v24
v_cmp_lt_i32 s[18:19], -1, v24
M v[180:183],a[144:147],a[176:179],0
T v[32:33],v20,45056
T v[34:35],v20,47104
M v[180:183],a[148:151],a[184:187],v[180:183]
s_mov_b32 s25, 3145984
buffer_store_dwordx4 v[104:107], v7, s[8:11], s3 offen offset:1024 sc1
M v[180:183],a[152:155],a[192:195],v[180:183]
s_waitcnt lgkmcnt(2)
s_nop 0
T v[36:37],v20,49152
T v[38:39],v20,51200
M v[180:183],a[156:159],a[200:203],v[180:183]
SA m0,s4,139264
T v[40:41],v20,53248
T v[42:43],v20,55296
M v[180:183],a[160:163],a[208:211],v[180:183]
buffer_load_dwordx4 v8, s[52:55], s25 offen lds
M v[180:183],a[164:167],a[216:219],v[180:183]
s_nop 0
T v[44:45],v20,57344
T v[46:47],v20,59392
M v[180:183],a[168:171],a[224:227],v[180:183]
T v[48:49],v20,61440
T v[50:51],v20,63488
M v[188:191],a[168:171],a[228:231],0
s_mov_b32 s25, 3408128
buffer_store_dwordx4 v[112:115], v7, s[8:11], s3 offen offset:2048 sc1
M v[188:191],a[164:167],a[220:223],v[188:191]
SA m0,s4,143360
T v[52:53],v16,32768
T v[54:55],v16,34816
M v[188:191],a[160:163],a[212:215],v[188:191]
T v[56:57],v16,36864
T v[58:59],v16,38912
M v[188:191],a[156:159],a[204:207],v[188:191]
buffer_load_dwordx4 v8, s[52:55], s25 offen lds
M v[188:191],a[152:155],a[196:199],v[188:191]
v_cmp_lt_i32 s[48:49], -2, v24
v_cmp_lt_i32 s[50:51], -3, v24
M v[188:191],a[148:151],a[188:191],v[188:191]
buffer_store_dwordx4 v[120:123], v7, s[8:11], s3 offen offset:3072 sc1
M v[188:191],a[144:147],a[180:183],v[188:191]
s_waitcnt lgkmcnt(6)
v_lshl_add_u32 v25, v0, 7, s95
v_and_b32 v0, 48, v0
M v[132:135],v[32:35],a[232:235],v[132:135]
s_mov_b32 s25, 384
T a[144:145],v21,45056
T a[146:147],v21,47104
M v[132:135],v[36:39],a[96:99],v[132:135]
SA m0,s4,0
v_lshl_add_u32 v0, v0, 24, v25
v_mov_b32 v24, 0x3f80
M v[132:135],v[40:43],a[104:107],v[132:135]
s_waitcnt lgkmcnt(2)
T a[148:149],v21,49152
T a[150:151],v21,51200
M v[132:135],v[44:47],a[112:115],v[132:135]
T a[152:153],v21,53248
T a[154:155],v21,55296
M v[132:135],v[48:51],a[120:123],v[132:135]
buffer_load_dwordx4 v8, s[52:55], s25 offen lds
M v[132:135],v[52:55],a[128:131],v[132:135]
s_nop 0
T a[156:157],v21,57344
T a[158:159],v21,59392
M v[132:135],v[56:59],a[136:139],v[132:135]
T a[160:161],v21,61440
T a[162:163],v21,63488
M v[140:143],v[56:59],a[140:143],v[140:143]
s_mov_b32 s25, 262528
MF v111,s5,v111
MF v124,s5,v124
M v[140:143],v[52:55],a[132:135],v[140:143]
SA m0,s4,4096
T a[164:165],v17,32768
T a[166:167],v17,34816
M v[140:143],v[48:51],a[124:127],v[140:143]
T a[168:169],v17,36864
T a[170:171],v17,38912
M v[140:143],v[44:47],a[116:119],v[140:143]
buffer_load_dwordx4 v8, s[52:55], s25 offen lds
M v[140:143],v[40:43],a[108:111],v[140:143]
MF v125,s5,v125
MF v126,s5,v126
M v[140:143],v[36:39],a[100:103],v[140:143]
MF v127,s5,v127
C v108,v108,v109
M v[140:143],v[32:35],a[236:239],v[140:143]
s_waitcnt lgkmcnt(6)
C v109,v110,v111
C v110,v124,v125
M v[148:151],a[144:147],a[232:235],v[148:151]
s_mov_b32 s25, 524672
T v[32:33],v22,45056
T v[34:35],v22,47104
M v[148:151],a[148:151],a[96:99],v[148:151]
SA m0,s4,8192
C v111,v126,v127
W a36,v108
M v[148:151],a[152:155],a[104:107],v[148:151]
s_waitcnt lgkmcnt(2)
T v[36:37],v22,49152
T v[38:39],v22,51200
M v[148:151],a[156:159],a[112:115],v[148:151]
T v[40:41],v22,53248
T v[42:43],v22,55296
M v[148:151],a[160:163],a[120:123],v[148:151]
buffer_load_dwordx4 v8, s[52:55], s25 offen lds
M v[148:151],a[164:167],a[128:131],v[148:151]
s_nop 0
T v[44:45],v22,57344
T v[46:47],v22,59392
M v[148:151],a[168:171],a[136:139],v[148:151]
T v[48:49],v22,61440
T v[50:51],v22,63488
M v[156:159],a[168:171],a[140:143],v[156:159]
s_mov_b32 s25, 786816
W a37,v109
W a38,v110
M v[156:159],a[164:167],a[132:135],v[156:159]
SA m0,s4,12288
T v[52:53],v18,32768
T v[54:55],v18,34816
M v[156:159],a[160:163],a[124:127],v[156:159]
T v[56:57],v18,36864
T v[58:59],v18,38912
M v[156:159],a[156:159],a[116:119],v[156:159]
buffer_load_dwordx4 v8, s[52:55], s25 offen lds
M v[156:159],a[152:155],a[108:111],v[156:159]
W a39,v111
v_lshrrev_b32 v25, 8, v7
M v[156:159],a[148:151],a[100:103],v[156:159]
v_bfe_u32 v26, v7, 6, 2
v_and_b32 v27, 16, v7
v_lshlrev_b32 v27, v27, v24
v_cmp_eq_u32 vcc, v25, v26
v_and_b32 v28, 32, v7
W a244,0
v_cndmask_b32 v27, 0, v27, vcc
v_cmp_eq_u32 vcc, 0, v28
W a245,0
W a248,0
v_cndmask_b32 v25, 0, v27, vcc
v_sub_u32 v26, v27, v25
W a249,0
W a246,v25
W a247,v26
M v[156:159],a[144:147],a[236:239],v[156:159]
s_waitcnt lgkmcnt(6)
MF v132,s5,v132
MF v133,s5,v133
M v[164:167],v[32:35],a[232:235],v[164:167]
s_mov_b32 s25, 1048960
T a[144:145],v23,45056
T a[146:147],v23,47104
M v[164:167],v[36:39],a[96:99],v[164:167]
SA m0,s4,16384
MF v134,s5,v134
MF v135,s5,v135
M v[164:167],v[40:43],a[104:107],v[164:167]
s_waitcnt lgkmcnt(2)
T a[148:149],v23,49152
T a[150:151],v23,51200
M v[164:167],v[44:47],a[112:115],v[164:167]
T a[152:153],v23,53248
T a[154:155],v23,55296
M v[164:167],v[48:51],a[120:123],v[164:167]
buffer_load_dwordx4 v8, s[52:55], s25 offen lds
M v[164:167],v[52:55],a[128:131],v[164:167]
s_nop 0
T a[156:157],v23,57344
T a[158:159],v23,59392
M v[164:167],v[56:59],a[136:139],v[164:167]
T a[160:161],v23,61440
T a[162:163],v23,63488
M v[172:175],v[56:59],a[140:143],v[172:175]
s_mov_b32 s25, 1311104
MF v148,s5,v148
MF v149,s5,v149
M v[172:175],v[52:55],a[132:135],v[172:175]
SA m0,s4,20480
T a[164:165],v19,32768
T a[166:167],v19,34816
M v[172:175],v[48:51],a[124:127],v[172:175]
T a[168:169],v19,36864
T a[170:171],v19,38912
M v[172:175],v[44:47],a[116:119],v[172:175]
buffer_load_dwordx4 v8, s[52:55], s25 offen lds
M v[172:175],v[40:43],a[108:111],v[172:175]
MF v150,s5,v150
MF v151,s5,v151
M v[172:175],v[36:39],a[100:103],v[172:175]
s_waitcnt vmcnt(7) lgkmcnt(0)
C v132,v132,v133
C v133,v134,v135
M v[172:175],v[32:35],a[236:239],v[172:175]
s_barrier
M v[180:183],a[144:147],a[232:235],v[180:183]
s_mov_b32 s25, 1573248
T v[32:33],v20,0
T v[34:35],v20,2048
M v[180:183],a[148:151],a[96:99],v[180:183]
SA m0,s4,24576
C v134,v148,v149
C v135,v150,v151
M v[180:183],a[152:155],a[104:107],v[180:183]
T v[36:37],v20,4096
T v[38:39],v20,6144
M v[180:183],a[156:159],a[112:115],v[180:183]
T v[40:41],v20,8192
T v[42:43],v20,10240
M v[180:183],a[160:163],a[120:123],v[180:183]
buffer_load_dwordx4 v8, s[52:55], s25 offen lds
M v[180:183],a[164:167],a[128:131],v[180:183]
s_nop 0
T v[44:45],v20,12288
T v[46:47],v20,14336
M v[180:183],a[168:171],a[136:139],v[180:183]
T v[48:49],v20,16384
T v[50:51],v20,18432
M v[188:191],a[168:171],a[140:143],v[188:191]
s_mov_b32 s25, 1835392
W a8,v132
W a9,v133
M v[188:191],a[164:167],a[132:135],v[188:191]
SA m0,s4,28672
T v[52:53],v20,20480
T v[54:55],v20,22528
M v[188:191],a[160:163],a[124:127],v[188:191]
T v[56:57],v20,24576
T v[58:59],v20,26624
M v[188:191],a[156:159],a[116:119],v[188:191]
buffer_load_dwordx4 v8, s[52:55], s25 offen lds
M v[188:191],a[152:155],a[108:111],v[188:191]
W a10,v134
W a11,v135
M v[188:191],a[148:151],a[100:103],v[188:191]
v_lshrrev_b32 v31, 6, v7
v_bfe_u32 v28, v7, 4, 2
M v[188:191],a[144:147],a[236:239],v[188:191]
s_waitcnt lgkmcnt(6)
v_lshlrev_b32 v31, 5, v31
v_add_lshl_u32 v31, v31, v28, 2
M v[68:71],v[32:35],a[176:179],0
s_mov_b32 s25, 2097536
T a[144:145],v21,0
T a[146:147],v21,2048
M v[68:71],v[36:39],a[184:187],v[68:71]
SA m0,s4,40960
buffer_load_dword v5, v31, s[8:11], s46 offen offset:4 sc1
M v[68:71],v[40:43],a[192:195],v[68:71]
s_waitcnt lgkmcnt(2)
s_nop 0
T a[148:149],v21,4096
T a[150:151],v21,6144
M v[68:71],v[44:47],a[200:203],v[68:71]
T a[152:153],v21,8192
T a[154:155],v21,10240
M v[68:71],v[48:51],a[208:211],v[68:71]
buffer_load_dwordx4 v8, s[52:55], s25 offen lds
M v[68:71],v[52:55],a[216:219],v[68:71]
s_nop 0
T a[156:157],v21,12288
T a[158:159],v21,14336
M v[68:71],v[56:59],a[224:227],v[68:71]
T a[160:161],v21,16384
T a[162:163],v21,18432
M v[76:79],v[56:59],a[228:231],0
s_mov_b32 s25, 2359680
MF v140,s5,v140
MF v141,s5,v141
M v[76:79],v[52:55],a[220:223],v[76:79]
SA m0,s4,45056
T a[164:165],v21,20480
T a[166:167],v21,22528
M v[76:79],v[48:51],a[212:215],v[76:79]
T a[168:169],v21,24576
T a[170:171],v21,26624
M v[76:79],v[44:47],a[204:207],v[76:79]
buffer_load_dwordx4 v8, s[52:55], s25 offen lds
M v[76:79],v[40:43],a[196:199],v[76:79]
MF v142,s5,v142
MF v143,s5,v143
M v[76:79],v[36:39],a[188:191],v[76:79]
MF v156,s5,v156
MF v157,s5,v157
M v[76:79],v[32:35],a[180:183],v[76:79]
s_waitcnt lgkmcnt(6)
MF v158,s5,v158
MF v159,s5,v159
M v[84:87],a[144:147],a[176:179],0
s_mov_b32 s25, 2621824
T v[32:33],v22,0
T v[34:35],v22,2048
M v[84:87],a[148:151],a[184:187],v[84:87]
SA m0,s4,49152
C v140,v140,v141
C v141,v142,v143
M v[84:87],a[152:155],a[192:195],v[84:87]
s_waitcnt lgkmcnt(2)
T v[36:37],v22,4096
T v[38:39],v22,6144
M v[84:87],a[156:159],a[200:203],v[84:87]
SA s3,s93,262144
T v[40:41],v22,8192
T v[42:43],v22,10240
M v[84:87],a[160:163],a[208:211],v[84:87]
buffer_load_dwordx4 v8, s[52:55], s25 offen lds
M v[84:87],a[164:167],a[216:219],v[84:87]
s_nop 0
T v[44:45],v22,12288
T v[46:47],v22,14336
M v[84:87],a[168:171],a[224:227],v[84:87]
T v[48:49],v22,16384
T v[50:51],v22,18432
M v[92:95],a[168:171],a[228:231],0
s_mov_b32 s25, 2883968
buffer_store_dwordx4 v[128:131], v7, s[8:11], s3 offen offset:0 sc1
M v[92:95],a[164:167],a[220:223],v[92:95]
SA m0,s4,53248
T v[52:53],v22,20480
T v[54:55],v22,22528
M v[92:95],a[160:163],a[212:215],v[92:95]
T v[56:57],v22,24576
T v[58:59],v22,26624
M v[92:95],a[156:159],a[204:207],v[92:95]
buffer_load_dwordx4 v8, s[52:55], s25 offen lds
M v[92:95],a[152:155],a[196:199],v[92:95]
C v142,v156,v157
C v143,v158,v159
M v[92:95],a[148:151],a[188:191],v[92:95]
buffer_store_dwordx4 v[136:139], v7, s[8:11], s3 offen offset:1024 sc1
M v[92:95],a[144:147],a[180:183],v[92:95]
s_waitcnt lgkmcnt(6)
W a40,v140
W a41,v141
M v[100:103],v[32:35],a[176:179],0
s_mov_b32 s25, 3146112
T a[144:145],v23,0
T a[146:147],v23,2048
M v[100:103],v[36:39],a[184:187],v[100:103]
SA m0,s4,57344
buffer_store_dwordx4 v[144:147], v7, s[8:11], s3 offen offset:2048 sc1
M v[100:103],v[40:43],a[192:195],v[100:103]
s_waitcnt lgkmcnt(2)
s_nop 0
T a[148:149],v23,4096
T a[150:151],v23,6144
M v[100:103],v[44:47],a[200:203],v[100:103]
T a[152:153],v23,8192
T a[154:155],v23,10240
M v[100:103],v[48:51],a[208:211],v[100:103]
buffer_load_dwordx4 v8, s[52:55], s25 offen lds
M v[100:103],v[52:55],a[216:219],v[100:103]
s_nop 0
T a[156:157],v23,12288
T a[158:159],v23,14336
M v[100:103],v[56:59],a[224:227],v[100:103]
T a[160:161],v23,16384
T a[162:163],v23,18432
M v[108:111],v[56:59],a[228:231],0
s_mov_b32 s25, 3408256
buffer_store_dwordx4 v[152:155], v7, s[8:11], s3 offen offset:3072 sc1
M v[108:111],v[52:55],a[220:223],v[108:111]
SA m0,s4,61440
T a[164:165],v23,20480
T a[166:167],v23,22528
M v[108:111],v[48:51],a[212:215],v[108:111]
T a[168:169],v23,24576
T a[170:171],v23,26624
M v[108:111],v[44:47],a[204:207],v[108:111]
buffer_load_dwordx4 v8, s[52:55], s25 offen lds
M v[108:111],v[40:43],a[196:199],v[108:111]
W a42,v142
W a43,v143
M v[108:111],v[36:39],a[188:191],v[108:111]
v_mov_b32 v8, 0xff800000
MF v164,s5,v164
M v[108:111],v[32:35],a[180:183],v[108:111]
s_waitcnt lgkmcnt(6)
MF v165,s5,v165
MF v166,s5,v166
M v[116:119],a[144:147],a[176:179],0
T v[32:33],v20,28672
T v[34:35],v20,30720
M v[116:119],a[148:151],a[184:187],v[116:119]
MF v167,s5,v167
MF v180,s5,v180
M v[116:119],a[152:155],a[192:195],v[116:119]
s_waitcnt lgkmcnt(2)
T v[36:37],v12,24576
T v[38:39],v12,26624
M v[116:119],a[156:159],a[200:203],v[116:119]
T v[40:41],v12,28672
T v[42:43],v12,30720
M v[116:119],a[160:163],a[208:211],v[116:119]
MF v181,s5,v181
MF v182,s5,v182
M v[116:119],a[164:167],a[216:219],v[116:119]
T v[44:45],v12,0
T v[46:47],v12,2048
M v[116:119],a[168:171],a[224:227],v[116:119]
T v[48:49],v12,4096
T v[50:51],v12,6144
M v[124:127],a[168:171],a[228:231],0
MF v183,s5,v183
C v164,v164,v165
M v[124:127],a[164:167],a[220:223],v[124:127]
T v[52:53],v12,8192
T v[54:55],v12,10240
M v[124:127],a[160:163],a[212:215],v[124:127]
T v[56:57],v12,12288
T v[58:59],v12,14336
M v[124:127],a[156:159],a[204:207],v[124:127]
C v165,v166,v167
C v166,v180,v181
M v[124:127],a[152:155],a[196:199],v[124:127]
C v167,v182,v183
W a12,v164
M v[124:127],a[148:151],a[188:191],v[124:127]
W a13,v165
W a14,v166
M v[124:127],a[144:147],a[180:183],v[124:127]
s_waitcnt lgkmcnt(6)
W a15,v167
MF v172,s5,v172
M v[68:71],v[32:35],a[232:235],v[68:71]
T a[144:145],v21,28672
T a[146:147],v21,30720
M v[68:71],v[36:39],a[96:99],v[68:71]
MF v173,s5,v173
MF v174,s5,v174
M v[68:71],v[40:43],a[104:107],v[68:71]
s_waitcnt lgkmcnt(2)
T a[148:149],v13,24576
T a[150:151],v13,26624
M v[68:71],v[44:47],a[112:115],v[68:71]
T a[152:153],v13,28672
T a[154:155],v13,30720
M v[68:71],v[48:51],a[120:123],v[68:71]
MF v175,s5,v175
MF v188,s5,v188
M v[68:71],v[52:55],a[128:131],v[68:71]
T a[156:157],v13,0
T a[158:159],v13,2048
M v[68:71],v[56:59],a[136:139],v[68:71]
T a[160:161],v13,4096
T a[162:163],v13,6144
M v[76:79],v[56:59],a[140:143],v[76:79]
MF v189,s5,v189
MF v190,s5,v190
M v[76:79],v[52:55],a[132:135],v[76:79]
T a[164:165],v13,8192
T a[166:167],v13,10240
M v[76:79],v[48:51],a[124:127],v[76:79]
T a[168:169],v13,12288
T a[170:171],v13,14336
M v[76:79],v[44:47],a[116:119],v[76:79]
MF v191,s5,v191
C v172,v172,v173
M v[76:79],v[40:43],a[108:111],v[76:79]
C v173,v174,v175
C v174,v188,v189
M v[76:79],v[36:39],a[100:103],v[76:79]
C v175,v190,v191
W a44,v172
M v[76:79],v[32:35],a[236:239],v[76:79]
s_waitcnt lgkmcnt(6)
W a45,v173
W a46,v174
M v[84:87],a[144:147],a[232:235],v[84:87]
T v[32:33],v22,28672
T v[34:35],v22,30720
M v[84:87],a[148:151],a[96:99],v[84:87]
W a47,v175
s_waitcnt vmcnt(10)
v_cmp_ne_u32 vcc, 1, v5
M v[84:87],a[152:155],a[104:107],v[84:87]
s_waitcnt lgkmcnt(2)
T v[36:37],v14,24576
T v[38:39],v14,26624
M v[84:87],a[156:159],a[112:115],v[84:87]
s_nop 0
T v[40:41],v14,28672
T v[42:43],v14,30720
M v[84:87],a[160:163],a[120:123],v[84:87]
s_cmp_lg_u32 vcc_lo, 0
M v[84:87],a[164:167],a[128:131],v[84:87]
s_cbranch_scc1 L_wsq0
L_wrq0:
T v[44:45],v14,0
T v[46:47],v14,2048
M v[84:87],a[168:171],a[136:139],v[84:87]
SA m0,s28,98304
T v[48:49],v14,4096
T v[50:51],v14,6144
M v[92:95],a[168:171],a[140:143],v[92:95]
buffer_load_dwordx4 v3, s[8:11], s21 offen offset:0 sc1 lds
M v[92:95],a[164:167],a[132:135],v[92:95]
s_nop 0
T v[52:53],v14,8192
T v[54:55],v14,10240
M v[92:95],a[160:163],a[124:127],v[92:95]
T v[56:57],v14,12288
T v[58:59],v14,14336
M v[92:95],a[156:159],a[116:119],v[92:95]
buffer_load_dwordx4 v3, s[8:11], s21 offen offset:1024 sc1 lds
M v[92:95],a[152:155],a[108:111],v[92:95]
MF v68,s5,v68
MF v69,s5,v69
M v[92:95],a[148:151],a[100:103],v[92:95]
buffer_load_dwordx4 v3, s[8:11], s21 offen offset:2048 sc1 lds
M v[92:95],a[144:147],a[236:239],v[92:95]
s_waitcnt lgkmcnt(6)
MF v70,s5,v70
MF v71,s5,v71
M v[100:103],v[32:35],a[232:235],v[100:103]
T a[144:145],v23,28672
T a[146:147],v23,30720
M v[100:103],v[36:39],a[96:99],v[100:103]
buffer_load_dwordx4 v3, s[8:11], s21 offen offset:3072 sc1 lds
M v[100:103],v[40:43],a[104:107],v[100:103]
s_waitcnt lgkmcnt(2)
s_nop 0
T a[148:149],v15,24576
T a[150:151],v15,26624
M v[100:103],v[44:47],a[112:115],v[100:103]
SA m0,s28,102400
T a[152:153],v15,28672
T a[154:155],v15,30720
M v[100:103],v[48:51],a[120:123],v[100:103]
buffer_load_dwordx4 v4, s[8:11], s21 offen offset:0 sc1 lds
M v[100:103],v[52:55],a[128:131],v[100:103]
s_nop 0
T a[156:157],v15,0
T a[158:159],v15,2048
M v[100:103],v[56:59],a[136:139],v[100:103]
T a[160:161],v15,4096
T a[162:163],v15,6144
M v[108:111],v[56:59],a[140:143],v[108:111]
buffer_load_dwordx4 v4, s[8:11], s21 offen offset:1024 sc1 lds
M v[108:111],v[52:55],a[132:135],v[108:111]
s_nop 0
T a[164:165],v15,8192
T a[166:167],v15,10240
M v[108:111],v[48:51],a[124:127],v[108:111]
T a[168:169],v15,12288
T a[170:171],v15,14336
M v[108:111],v[44:47],a[116:119],v[108:111]
buffer_load_dwordx4 v4, s[8:11], s21 offen offset:2048 sc1 lds
M v[108:111],v[40:43],a[108:111],v[108:111]
MF v84,s5,v84
MF v85,s5,v85
M v[108:111],v[36:39],a[100:103],v[108:111]
s_waitcnt vmcnt(7) lgkmcnt(0)
buffer_load_dwordx4 v4, s[8:11], s21 offen offset:3072 sc1 lds
M v[108:111],v[32:35],a[236:239],v[108:111]
s_barrier
M v[116:119],a[144:147],a[232:235],v[116:119]
SA s21,s21,32768
T v[32:33],v16,0
T v[34:35],v16,2048
M v[116:119],a[148:151],a[96:99],v[116:119]
s_sub_u32 s22, s22, 1
MF v86,s5,v86
MF v87,s5,v87
M v[116:119],a[152:155],a[104:107],v[116:119]
s_cselect_b32 s21, s23, s21
T v[36:37],v16,4096
T v[38:39],v16,6144
M v[116:119],a[156:159],a[112:115],v[116:119]
SA m0,s28,65536
T v[40:41],v16,8192
T v[42:43],v16,10240
M v[116:119],a[160:163],a[120:123],v[116:119]
buffer_load_dwordx4 v3, s[8:11], s21 offen offset:0 sc1 lds
M v[116:119],a[164:167],a[128:131],v[116:119]
s_nop 0
T v[44:45],v16,12288
T v[46:47],v16,14336
M v[116:119],a[168:171],a[136:139],v[116:119]
T v[48:49],v16,16384
T v[50:51],v16,18432
M v[124:127],a[168:171],a[140:143],v[124:127]
buffer_load_dwordx4 v3, s[8:11], s21 offen offset:1024 sc1 lds
M v[124:127],a[164:167],a[132:135],v[124:127]
s_nop 0
T v[52:53],v16,20480
T v[54:55],v16,22528
M v[124:127],a[160:163],a[124:127],v[124:127]
T v[56:57],v16,24576
T v[58:59],v16,26624
M v[124:127],a[156:159],a[116:119],v[124:127]
buffer_load_dword v5, v31, s[8:11], s46 offen offset:4 sc1
M v[124:127],a[152:155],a[108:111],v[124:127]
buffer_load_dwordx4 v3, s[8:11], s21 offen offset:2048 sc1 lds
M v[124:127],a[148:151],a[100:103],v[124:127]
C v68,v68,v69
C v69,v70,v71
M v[124:127],a[144:147],a[236:239],v[124:127]
s_waitcnt lgkmcnt(6)
buffer_load_dwordx4 v3, s[8:11], s21 offen offset:3072 sc1 lds
M v[132:135],v[32:35],a[176:179],0
SA m0,s28,69632
T a[144:145],v17,0
T a[146:147],v17,2048
M v[132:135],v[36:39],a[184:187],v[132:135]
buffer_load_dwordx4 v4, s[8:11], s21 offen offset:0 sc1 lds
M v[132:135],v[40:43],a[192:195],v[132:135]
s_waitcnt lgkmcnt(2)
s_nop 0
T a[148:149],v17,4096
T a[150:151],v17,6144
M v[132:135],v[44:47],a[200:203],v[132:135]
T a[152:153],v17,8192
T a[154:155],v17,10240
M v[132:135],v[48:51],a[208:211],v[132:135]
buffer_load_dwordx4 v4, s[8:11], s21 offen offset:1024 sc1 lds
M v[132:135],v[52:55],a[216:219],v[132:135]
s_nop 0
T a[156:157],v17,12288
T a[158:159],v17,14336
M v[132:135],v[56:59],a[224:227],v[132:135]
T a[160:161],v17,16384
T a[162:163],v17,18432
M v[140:143],v[56:59],a[228:231],0
buffer_load_dwordx4 v4, s[8:11], s21 offen offset:2048 sc1 lds
M v[140:143],v[52:55],a[220:223],v[140:143]
s_nop 0
T a[164:165],v17,20480
T a[166:167],v17,22528
M v[140:143],v[48:51],a[212:215],v[140:143]
T a[168:169],v17,24576
T a[170:171],v17,26624
M v[140:143],v[44:47],a[204:207],v[140:143]
buffer_load_dwordx4 v4, s[8:11], s21 offen offset:3072 sc1 lds
M v[140:143],v[40:43],a[196:199],v[140:143]
SA s21,s21,32768
C v70,v84,v85
C v71,v86,v87
M v[140:143],v[36:39],a[188:191],v[140:143]
s_sub_u32 s22, s22, 1
W a16,v68
W a17,v69
M v[140:143],v[32:35],a[180:183],v[140:143]
s_waitcnt lgkmcnt(6)
W a18,v70
W a19,v71
M v[148:151],a[144:147],a[176:179],0
s_cselect_b32 s21, s23, s21
T v[32:33],v18,0
T v[34:35],v18,2048
M v[148:151],a[148:151],a[184:187],v[148:151]
MF v76,s5,v76
MF v77,s5,v77
M v[148:151],a[152:155],a[192:195],v[148:151]
s_waitcnt lgkmcnt(2)
T v[36:37],v18,4096
T v[38:39],v18,6144
M v[148:151],a[156:159],a[200:203],v[148:151]
T v[40:41],v18,8192
T v[42:43],v18,10240
M v[148:151],a[160:163],a[208:211],v[148:151]
MF v78,s5,v78
MF v79,s5,v79
M v[148:151],a[164:167],a[216:219],v[148:151]
T v[44:45],v18,12288
T v[46:47],v18,14336
M v[148:151],a[168:171],a[224:227],v[148:151]
T v[48:49],v18,16384
T v[50:51],v18,18432
M v[156:159],a[168:171],a[228:231],0
MF v92,s5,v92
MF v93,s5,v93
M v[156:159],a[164:167],a[220:223],v[156:159]
T v[52:53],v18,20480
T v[54:55],v18,22528
M v[156:159],a[160:163],a[212:215],v[156:159]
T v[56:57],v18,24576
T v[58:59],v18,26624
M v[156:159],a[156:159],a[204:207],v[156:159]
MF v94,s5,v94
MF v95,s5,v95
M v[156:159],a[152:155],a[196:199],v[156:159]
C v76,v76,v77
C v77,v78,v79
M v[156:159],a[148:151],a[188:191],v[156:159]
C v78,v92,v93
C v79,v94,v95
M v[156:159],a[144:147],a[180:183],v[156:159]
s_waitcnt lgkmcnt(6)
W a48,v76
W a49,v77
M v[164:167],v[32:35],a[176:179],0
T a[144:145],v19,0
T a[146:147],v19,2048
M v[164:167],v[36:39],a[184:187],v[164:167]
W a50,v78
W a51,v79
M v[164:167],v[40:43],a[192:195],v[164:167]
s_waitcnt lgkmcnt(2)
T a[148:149],v19,4096
T a[150:151],v19,6144
M v[164:167],v[44:47],a[200:203],v[164:167]
T a[152:153],v19,8192
T a[154:155],v19,10240
M v[164:167],v[48:51],a[208:211],v[164:167]
v_mov_b32 v30, 2
MF v100,s5,v100
M v[164:167],v[52:55],a[216:219],v[164:167]
T a[156:157],v19,12288
T a[158:159],v19,14336
M v[164:167],v[56:59],a[224:227],v[164:167]
T a[160:161],v19,16384
T a[162:163],v19,18432
M v[172:175],v[56:59],a[228:231],0
buffer_store_dword v30, v1, s[8:11], s45 offen sc1
M v[172:175],v[52:55],a[220:223],v[172:175]
s_nop 0
T a[164:165],v19,20480
T a[166:167],v19,22528
M v[172:175],v[48:51],a[212:215],v[172:175]
T a[168:169],v19,24576
T a[170:171],v19,26624
M v[172:175],v[44:47],a[204:207],v[172:175]
MF v101,s5,v101
MF v102,s5,v102
M v[172:175],v[40:43],a[196:199],v[172:175]
MF v103,s5,v103
MF v116,s5,v116
M v[172:175],v[36:39],a[188:191],v[172:175]
MF v117,s5,v117
MF v118,s5,v118
M v[172:175],v[32:35],a[180:183],v[172:175]
s_waitcnt lgkmcnt(6)
MF v119,s5,v119
C v100,v100,v101
M v[180:183],a[144:147],a[176:179],0
T v[32:33],v16,28672
T v[34:35],v16,30720
M v[180:183],a[148:151],a[184:187],v[180:183]
C v101,v102,v103
C v102,v116,v117
M v[180:183],a[152:155],a[192:195],v[180:183]
s_waitcnt lgkmcnt(2)
T v[36:37],v16,40960
T v[38:39],v16,43008
M v[180:183],a[156:159],a[200:203],v[180:183]
SA s3,s93,270336
T v[40:41],v16,45056
T v[42:43],v16,47104
M v[180:183],a[160:163],a[208:211],v[180:183]
buffer_store_dwordx4 v[160:163], v7, s[8:11], s3 offen offset:0 sc1
M v[180:183],a[164:167],a[216:219],v[180:183]
s_nop 0
T v[44:45],v16,49152
T v[46:47],v16,51200
M v[180:183],a[168:171],a[224:227],v[180:183]
T v[48:49],v16,53248
T v[50:51],v16,55296
M v[188:191],a[168:171],a[228:231],0
buffer_store_dwordx4 v[168:171], v7, s[8:11], s3 offen offset:1024 sc1
M v[188:191],a[164:167],a[220:223],v[188:191]
s_nop 0
T v[52:53],v16,57344
T v[54:55],v16,59392
M v[188:191],a[160:163],a[212:215],v[188:191]
T v[56:57],v16,61440
T v[58:59],v16,63488
M v[188:191],a[156:159],a[204:207],v[188:191]
buffer_store_dwordx4 v[176:179], v7, s[8:11], s3 offen offset:2048 sc1
M v[188:191],a[152:155],a[196:199],v[188:191]
C v103,v118,v119
W a20,v100
M v[188:191],a[148:151],a[188:191],v[188:191]
buffer_store_dwordx4 v[184:187], v7, s[8:11], s3 offen offset:3072 sc1
M v[188:191],a[144:147],a[180:183],v[188:191]
s_waitcnt lgkmcnt(6)
W a21,v101
W a22,v102
M v[132:135],v[32:35],a[232:235],v[132:135]
T a[144:145],v17,28672
T a[146:147],v17,30720
M v[132:135],v[36:39],a[96:99],v[132:135]
W a23,v103
MF v108,s5,v108
M v[132:135],v[40:43],a[104:107],v[132:135]
s_waitcnt lgkmcnt(2)
T a[148:149],v17,40960
T a[150:151],v17,43008
M v[132:135],v[44:47],a[112:115],v[132:135]
T a[152:153],v17,45056
T a[154:155],v17,47104
M v[132:135],v[48:51],a[120:123],v[132:135]
MF v109,s5,v109
MF v110,s5,v110
M v[132:135],v[52:55],a[128:131],v[132:135]
T a[156:157],v17,49152
T a[158:159],v17,51200
M v[132:135],v[56:59],a[136:139],v[132:135]
T a[160:161],v17,53248
T a[162:163],v17,55296
M v[140:143],v[56:59],a[140:143],v[140:143]
MF v111,s5,v111
MF v124,s5,v124
M v[140:143],v[52:55],a[132:135],v[140:143]
T a[164:165],v17,57344
T a[166:167],v17,59392
M v[140:143],v[48:51],a[124:127],v[140:143]
T a[168:169],v17,61440
T a[170:171],v17,63488
M v[140:143],v[44:47],a[116:119],v[140:143]
MF v125,s5,v125
MF v126,s5,v126
M v[140:143],v[40:43],a[108:111],v[140:143]
MF v127,s5,v127
C v108,v108,v109
M v[140:143],v[36:39],a[100:103],v[140:143]
C v109,v110,v111
C v110,v124,v125
M v[140:143],v[32:35],a[236:239],v[140:143]
s_waitcnt lgkmcnt(6)
C v111,v126,v127
W a52,v108
M v[148:151],a[144:147],a[232:235],v[148:151]
T v[32:33],v18,28672
T v[34:35],v18,30720
M v[148:151],a[148:151],a[96:99],v[148:151]
W a53,v109
W a54,v110
M v[148:151],a[152:155],a[104:107],v[148:151]
s_waitcnt lgkmcnt(2)
T v[36:37],v18,40960
T v[38:39],v18,43008
M v[148:151],a[156:159],a[112:115],v[148:151]
T v[40:41],v18,45056
T v[42:43],v18,47104
M v[148:151],a[160:163],a[120:123],v[148:151]
W a55,v111
s_waitcnt vmcnt(11)
v_cmp_ne_u32 vcc, 1, v5
M v[148:151],a[164:167],a[128:131],v[148:151]
s_nop 0
T v[44:45],v18,49152
T v[46:47],v18,51200
M v[148:151],a[168:171],a[136:139],v[148:151]
s_cmp_lg_u32 vcc_hi, 0
T v[48:49],v18,53248
T v[50:51],v18,55296
M v[156:159],a[168:171],a[140:143],v[156:159]
s_cbranch_scc1 L_wsr0
L_wrr0:
M v[156:159],a[164:167],a[132:135],v[156:159]
SA m0,s28,131072
T v[52:53],v18,57344
T v[54:55],v18,59392
M v[156:159],a[160:163],a[124:127],v[156:159]
T v[56:57],v18,61440
T v[58:59],v18,63488
M v[156:159],a[156:159],a[116:119],v[156:159]
buffer_load_dwordx4 v3, s[8:11], s26 offen offset:0 sc1 lds
M v[156:159],a[152:155],a[108:111],v[156:159]
MF v132,s5,v132
MF v133,s5,v133
M v[156:159],a[148:151],a[100:103],v[156:159]
buffer_load_dwordx4 v3, s[8:11], s26 offen offset:1024 sc1 lds
M v[156:159],a[144:147],a[236:239],v[156:159]
s_waitcnt lgkmcnt(6)
MF v134,s5,v134
MF v135,s5,v135
M v[164:167],v[32:35],a[232:235],v[164:167]
T a[144:145],v19,28672
T a[146:147],v19,30720
M v[164:167],v[36:39],a[96:99],v[164:167]
buffer_load_dwordx4 v3, s[8:11], s26 offen offset:2048 sc1 lds
M v[164:167],v[40:43],a[104:107],v[164:167]
s_waitcnt lgkmcnt(2)
s_nop 0
T a[148:149],v19,40960
T a[150:151],v19,43008
M v[164:167],v[44:47],a[112:115],v[164:167]
T a[152:153],v19,45056
T a[154:155],v19,47104
M v[164:167],v[48:51],a[120:123],v[164:167]
buffer_load_dwordx4 v3, s[8:11], s26 offen offset:3072 sc1 lds
M v[164:167],v[52:55],a[128:131],v[164:167]
SA m0,s28,135168
T a[156:157],v19,49152
T a[158:159],v19,51200
M v[164:167],v[56:59],a[136:139],v[164:167]
T a[160:161],v19,53248
T a[162:163],v19,55296
M v[172:175],v[56:59],a[140:143],v[172:175]
buffer_load_dwordx4 v4, s[8:11], s26 offen offset:0 sc1 lds
M v[172:175],v[52:55],a[132:135],v[172:175]
s_nop 0
T a[164:165],v19,57344
T a[166:167],v19,59392
M v[172:175],v[48:51],a[124:127],v[172:175]
T a[168:169],v19,61440
T a[170:171],v19,63488
M v[172:175],v[44:47],a[116:119],v[172:175]
buffer_load_dwordx4 v4, s[8:11], s26 offen offset:1024 sc1 lds
M v[172:175],v[40:43],a[108:111],v[172:175]
MF v148,s5,v148
MF v149,s5,v149
M v[172:175],v[36:39],a[100:103],v[172:175]
s_waitcnt lgkmcnt(0)
buffer_load_dwordx4 v4, s[8:11], s26 offen offset:2048 sc1 lds
M v[172:175],v[32:35],a[236:239],v[172:175]
s_barrier
M v[180:183],a[144:147],a[232:235],v[180:183]
R a[64:67],v2,32768
R a[68:71],v2,33792
M v[180:183],a[148:151],a[96:99],v[180:183]
buffer_load_dwordx4 v4, s[8:11], s26 offen offset:3072 sc1 lds
M v[180:183],a[152:155],a[104:107],v[180:183]
SA s26,s26,32768
MF v150,s5,v150
MF v151,s5,v151
M v[180:183],a[156:159],a[112:115],v[180:183]
R a[72:75],v2,34816
R a[76:79],v2,35840
M v[180:183],a[160:163],a[120:123],v[180:183]
C v132,v132,v133
C v133,v134,v135
M v[180:183],a[164:167],a[128:131],v[180:183]
C v134,v148,v149
C v135,v150,v151
M v[180:183],a[168:171],a[136:139],v[180:183]
R a[80:83],v2,36864
R a[84:87],v2,37888
M v[188:191],a[168:171],a[140:143],v[188:191]
W a24,v132
W a25,v133
M v[188:191],a[164:167],a[132:135],v[188:191]
W a26,v134
W a27,v135
M v[188:191],a[160:163],a[124:127],v[188:191]
R a[88:91],v2,38912
R a[92:95],v2,39936
M v[188:191],a[156:159],a[116:119],v[188:191]
MF v140,s5,v140
MF v141,s5,v141
M v[188:191],a[152:155],a[108:111],v[188:191]
MF v142,s5,v142
MF v143,s5,v143
M v[188:191],a[148:151],a[100:103],v[188:191]
MF v156,s5,v156
MF v157,s5,v157
M v[188:191],a[144:147],a[236:239],v[188:191]
s_waitcnt lgkmcnt(0)
MF v158,s5,v158
MF v159,s5,v159
C v140,v140,v141
C v141,v142,v143
C v142,v156,v157
C v143,v158,v159
W a56,v140
W a57,v141
W a58,v142
W a59,v143
s_cmp_eq_u32 s42, 0
s_cbranch_scc1 L_j0
M v[64:67],a[64:67],a[0:3],0
R a[96:99],v2,40960
R a[100:103],v2,41984
M v[64:67],a[68:71],a[4:7],v[64:67]
MF v164,s5,v164
MF v165,s5,v165
M v[64:67],a[72:75],a[8:11],v[64:67]
MF v166,s5,v166
MF v167,s5,v167
M v[64:67],a[76:79],a[12:15],v[64:67]
R a[104:107],v2,43008
R a[108:111],v2,44032
M v[64:67],a[80:83],a[16:19],v[64:67]
MF v180,s5,v180
MF v181,s5,v181
MF v182,s5,v182
MF v183,s5,v183
C v164,v164,v165
C v165,v166,v167
C v166,v180,v181
C v167,v182,v183
W a28,v164
W a29,v165
W a30,v166
W a31,v167
M v[64:67],a[84:87],a[20:23],v[64:67]
MF v172,s5,v172
MF v173,s5,v173
M v[64:67],a[88:91],a[24:27],v[64:67]
R a[112:115],v2,45056
R a[116:119],v2,46080
M v[64:67],a[92:95],a[28:31],v[64:67]
MF v174,s5,v174
MF v175,s5,v175
M v[68:71],a[64:67],a[32:35],0
MF v188,s5,v188
MF v189,s5,v189
M v[68:71],a[68:71],a[36:39],v[68:71]
R a[120:123],v2,47104
R a[124:127],v2,48128
M v[68:71],a[72:75],a[40:43],v[68:71]
SA m0,s28,32768
MF v190,s5,v190
MF v191,s5,v191
M v[68:71],a[76:79],a[44:47],v[68:71]
buffer_load_dwordx4 v3, s[8:11], s26 offen offset:0 sc1 lds
M v[68:71],a[80:83],a[48:51],v[68:71]
C v172,v172,v173
C v173,v174,v175
C v174,v188,v189
C v175,v190,v191
W a60,v172
W a61,v173
W a62,v174
W a63,v175
M v[68:71],a[84:87],a[52:55],v[68:71]
E v18,v64
M v[68:71],a[88:91],a[56:59],v[68:71]
M v[68:71],a[92:95],a[60:63],v[68:71]
s_waitcnt lgkmcnt(0)
buffer_load_dwordx4 v3, s[8:11], s26 offen offset:1024 sc1 lds
M v[72:75],a[96:99],a[0:3],0
R a[64:67],v2,49152
R a[68:71],v2,50176
M v[72:75],a[100:103],a[4:7],v[72:75]
E v19,v65
M v[72:75],a[104:107],a[8:11],v[72:75]
E v20,v66
M v[72:75],a[108:111],a[12:15],v[72:75]
R a[72:75],v2,51200
R a[76:79],v2,52224
M v[72:75],a[112:115],a[16:19],v[72:75]
buffer_load_dwordx4 v3, s[8:11], s26 offen offset:2048 sc1 lds
M v[72:75],a[116:119],a[20:23],v[72:75]
E v21,v67
M v[72:75],a[120:123],a[24:27],v[72:75]
R a[80:83],v2,53248
R a[84:87],v2,54272
M v[72:75],a[124:127],a[28:31],v[72:75]
buffer_load_dwordx4 v3, s[8:11], s26 offen offset:3072 sc1 lds
M v[76:79],a[124:127],a[60:63],0
SA m0,s28,36864
E v22,v68
M v[76:79],a[120:123],a[56:59],v[76:79]
R a[88:91],v2,55296
R a[92:95],v2,56320
M v[76:79],a[116:119],a[52:55],v[76:79]
buffer_load_dwordx4 v4, s[8:11], s26 offen offset:0 sc1 lds
M v[76:79],a[112:115],a[48:51],v[76:79]
E v23,v69
M v[76:79],a[108:111],a[44:47],v[76:79]
AF v26,v18,v19
C v40,v18,v19
M v[76:79],a[104:107],a[40:43],v[76:79]
buffer_load_dwordx4 v4, s[8:11], s26 offen offset:1024 sc1 lds
M v[76:79],a[100:103],a[36:39],v[76:79]
v_add_u32 v16, 0x20000, v7
AF v26,v20,v26
M v[76:79],a[96:99],a[32:35],v[76:79]
s_waitcnt lgkmcnt(0)
E v24,v70
M v[80:83],a[64:67],a[0:3],0
R a[96:99],v2,57344
R a[100:103],v2,58368
M v[80:83],a[68:71],a[4:7],v[80:83]
buffer_load_dwordx4 v4, s[8:11], s26 offen offset:2048 sc1 lds
M v[80:83],a[72:75],a[8:11],v[80:83]
SA s3,s93,786432
E v25,v71
M v[80:83],a[76:79],a[12:15],v[80:83]
R a[104:107],v2,59392
R a[108:111],v2,60416
M v[80:83],a[80:83],a[16:19],v[80:83]
buffer_load_dwordx4 v4, s[8:11], s26 offen offset:3072 sc1 lds
M v[80:83],a[84:87],a[20:23],v[80:83]
SA s26,s26,32768
E v18,v72
M v[80:83],a[88:91],a[24:27],v[80:83]
R a[112:115],v2,61440
R a[116:119],v2,62464
M v[80:83],a[92:95],a[28:31],v[80:83]
buffer_store_dwordx4 v[192:195], v7, s[8:11], s3 offen offset:0 sc1
M v[84:87],a[92:95],a[60:63],0
E v19,v73
M v[84:87],a[88:91],a[56:59],v[84:87]
R a[120:123],v2,63488
R a[124:127],v2,64512
M v[84:87],a[84:87],a[52:55],v[84:87]
C v41,v20,v21
AF v26,v21,v26
M v[84:87],a[80:83],a[48:51],v[84:87]
buffer_store_dwordx4 v[200:203], v7, s[8:11], s3 offen offset:1024 sc1
M v[84:87],a[76:79],a[44:47],v[84:87]
E v20,v74
M v[84:87],a[72:75],a[40:43],v[84:87]
AF v27,v22,v23
C v44,v22,v23
M v[84:87],a[68:71],a[36:39],v[84:87]
s_waitcnt vmcnt(23) lgkmcnt(0)
E v21,v75
M v[84:87],a[64:67],a[32:35],v[84:87]
s_barrier
M v[88:91],a[96:99],a[0:3],0
R a[64:67],v2,0
R a[68:71],v2,1024
M v[88:91],a[100:103],a[4:7],v[88:91]
E v22,v76
M v[88:91],a[104:107],a[8:11],v[88:91]
AF v27,v24,v27
C v45,v24,v25
M v[88:91],a[108:111],a[12:15],v[88:91]
R a[72:75],v2,2048
R a[76:79],v2,3072
M v[88:91],a[112:115],a[16:19],v[88:91]
buffer_store_dwordx4 v[208:211], v7, s[8:11], s3 offen offset:2048 sc1
M v[88:91],a[116:119],a[20:23],v[88:91]
E v23,v77
M v[88:91],a[120:123],a[24:27],v[88:91]
R a[80:83],v2,4096
R a[84:87],v2,5120
M v[88:91],a[124:127],a[28:31],v[88:91]
AF v27,v25,v27
AF v26,v18,v26
M v[92:95],a[124:127],a[60:63],0
E v24,v78
M v[92:95],a[120:123],a[56:59],v[92:95]
R a[88:91],v2,6144
R a[92:95],v2,7168
M v[92:95],a[116:119],a[52:55],v[92:95]
E v25,v79
M v[92:95],a[112:115],a[48:51],v[92:95]
C v42,v18,v19
AF v26,v19,v26
M v[92:95],a[108:111],a[44:47],v[92:95]
AF v26,v20,v26
C v43,v20,v21
M v[92:95],a[104:107],a[40:43],v[92:95]
AF v26,v21,v26
AF v27,v22,v27
M v[92:95],a[100:103],a[36:39],v[92:95]
s_waitcnt lgkmcnt(0)
C v46,v22,v23
AF v27,v23,v27
M v[92:95],a[96:99],a[32:35],v[92:95]
AF v27,v24,v27
C v47,v24,v25
AF v27,v25,v27
M v[96:99],a[64:67],a[0:3],0
R a[96:99],v2,8192
R a[100:103],v2,9216
M v[96:99],a[68:71],a[4:7],v[96:99]
SA m0,s28,98304
E v18,v80
M v[96:99],a[72:75],a[8:11],v[96:99]
buffer_load_dwordx4 v3, s[8:11], s21 offen offset:0 sc1 lds
M v[96:99],a[76:79],a[12:15],v[96:99]
R a[104:107],v2,10240
R a[108:111],v2,11264
M v[96:99],a[80:83],a[16:19],v[96:99]
v_mov_b32 v30, 0
M v[96:99],a[84:87],a[20:23],v[96:99]
E v19,v81
M v[96:99],a[88:91],a[24:27],v[96:99]
R a[112:115],v2,12288
R a[116:119],v2,13312
M v[96:99],a[92:95],a[28:31],v[96:99]
buffer_load_dwordx4 v3, s[8:11], s21 offen offset:1024 sc1 lds
M v[100:103],a[92:95],a[60:63],0
v_mov_b32 v31, 0
AF v26,v18,v26
M v[100:103],a[88:91],a[56:59],v[100:103]
R a[120:123],v2,14336
R a[124:127],v2,15360
M v[100:103],a[84:87],a[52:55],v[100:103]
E v20,v82
M v[100:103],a[80:83],a[48:51],v[100:103]
buffer_load_dwordx4 v3, s[8:11], s21 offen offset:2048 sc1 lds
M v[100:103],a[76:79],a[44:47],v[100:103]
E v21,v83
M v[100:103],a[72:75],a[40:43],v[100:103]
v_mov_b32 v32, 0
C v56,v18,v19
M v[100:103],a[68:71],a[36:39],v[100:103]
E v22,v88
M v[100:103],a[64:67],a[32:35],v[100:103]
s_waitcnt lgkmcnt(0)
buffer_load_dwordx4 v3, s[8:11], s21 offen offset:3072 sc1 lds
M v[104:107],a[96:99],a[0:3],0
SA m0,s28,102400
R a[64:67],v2,16384
R a[68:71],v2,17408
M v[104:107],a[100:103],a[4:7],v[104:107]
v_mov_b32 v33, 0
AF v26,v19,v26
M v[104:107],a[104:107],a[8:11],v[104:107]
E v23,v89
M v[104:107],a[108:111],a[12:15],v[104:107]
R a[72:75],v2,18432
R a[76:79],v2,19456
M v[104:107],a[112:115],a[16:19],v[104:107]
buffer_load_dwordx4 v4, s[8:11], s21 offen offset:0 sc1 lds
M v[104:107],a[116:119],a[20:23],v[104:107]
E v24,v90
M v[104:107],a[120:123],a[24:27],v[104:107]
R a[80:83],v2,20480
R a[84:87],v2,21504
M v[104:107],a[124:127],a[28:31],v[104:107]
buffer_load_dwordx4 v4, s[8:11], s21 offen offset:1024 sc1 lds
M v[108:111],a[124:127],a[60:63],0
v_mov_b32 v34, 0
AF v26,v20,v26
M v[108:111],a[120:123],a[56:59],v[108:111]
R a[88:91],v2,22528
R a[92:95],v2,23552
M v[108:111],a[116:119],a[52:55],v[108:111]
buffer_load_dwordx4 v4, s[8:11], s21 offen offset:2048 sc1 lds
M v[108:111],a[112:115],a[48:51],v[108:111]
v_mov_b32 v35, 0
C v57,v20,v21
M v[108:111],a[108:111],a[44:47],v[108:111]
E v25,v91
M v[108:111],a[104:107],a[40:43],v[108:111]
E v18,v84
M v[108:111],a[100:103],a[36:39],v[108:111]
buffer_load_dwordx4 v4, s[8:11], s21 offen offset:3072 sc1 lds
M v[108:111],a[96:99],a[32:35],v[108:111]
s_waitcnt lgkmcnt(0)
v_mov_b32 v36, 0
AF v26,v21,v26
M v[112:115],a[64:67],a[0:3],0
SA s21,s21,32768
R a[96:99],v2,24576
R a[100:103],v2,25600
M v[112:115],a[68:71],a[4:7],v[112:115]
s_sub_u32 s22, s22, 1
E v19,v85
M v[112:115],a[72:75],a[8:11],v[112:115]
s_cselect_b32 s21, s23, s21
E v20,v86
M v[112:115],a[76:79],a[12:15],v[112:115]
SA s3,s93,786432
R a[104:107],v2,26624
R a[108:111],v2,27648
M v[112:115],a[80:83],a[16:19],v[112:115]
buffer_store_dwordx4 v[216:219], v7, s[8:11], s3 offen offset:3072 sc1
M v[112:115],a[84:87],a[20:23],v[112:115]
v_mov_b32 v37, 0
AF v26,v22,v26
M v[112:115],a[88:91],a[24:27],v[112:115]
R a[112:115],v2,28672
R a[116:119],v2,29696
M v[112:115],a[92:95],a[28:31],v[112:115]
E v21,v87
M v[116:119],a[92:95],a[60:63],0
v_mov_b32 v38, 0
C v58,v22,v23
M v[116:119],a[88:91],a[56:59],v[116:119]
SA s3,s93,794624
R a[120:123],v2,30720
R a[124:127],v2,31744
M v[116:119],a[84:87],a[52:55],v[116:119]
buffer_store_dwordx4 v[224:227], v7, s[8:11], s3 offen offset:0 sc1
M v[116:119],a[80:83],a[48:51],v[116:119]
AF v26,v23,v26
AF v26,v24,v26
M v[116:119],a[76:79],a[44:47],v[116:119]
E v22,v92
M v[116:119],a[72:75],a[40:43],v[116:119]
v_mov_b32 v39, 0
C v59,v24,v25
M v[116:119],a[68:71],a[36:39],v[116:119]
s_waitcnt vmcnt(21) lgkmcnt(0)
E v23,v93
M v[116:119],a[64:67],a[32:35],v[116:119]
s_barrier
M v[120:123],a[96:99],a[0:3],0
R a[64:67],v16,0
R a[68:71],v16,1024
M v[120:123],a[100:103],a[4:7],v[120:123]
AF v26,v25,v26
AF v27,v18,v27
M v[120:123],a[104:107],a[8:11],v[120:123]
E v24,v94
M v[120:123],a[108:111],a[12:15],v[120:123]
R a[72:75],v16,2048
R a[76:79],v16,3072
M v[120:123],a[112:115],a[16:19],v[120:123]
buffer_store_dwordx4 v[232:235], v7, s[8:11], s3 offen offset:1024 sc1
M v[120:123],a[116:119],a[20:23],v[120:123]
E v25,v95
M v[120:123],a[120:123],a[24:27],v[120:123]
R a[80:83],v16,4096
R a[84:87],v16,5120
M v[120:123],a[124:127],a[28:31],v[120:123]
C v60,v18,v19
AF v27,v19,v27
M v[124:127],a[124:127],a[60:63],0
AF v27,v20,v27
C v61,v20,v21
M v[124:127],a[120:123],a[56:59],v[124:127]
R a[88:91],v16,6144
R a[92:95],v16,7168
M v[124:127],a[116:119],a[52:55],v[124:127]
AF v27,v21,v27
AF v27,v22,v27
M v[124:127],a[112:115],a[48:51],v[124:127]
C v62,v22,v23
AF v27,v23,v27
M v[124:127],a[108:111],a[44:47],v[124:127]
AF v27,v24,v27
C v63,v24,v25
M v[124:127],a[104:107],a[40:43],v[124:127]
AF v27,v25,v27
M v[124:127],a[100:103],a[36:39],v[124:127]
s_waitcnt lgkmcnt(0)
M v[124:127],a[96:99],a[32:35],v[124:127]
v_max_f32 v10, v26, v27
v_min_f32 v11, v26, v27
v_cmp_lt_f32 vcc, s31, v10
v_cmp_gt_f32 s[64:65], s24, v11
s_nop 0
s_or_b64 vcc, vcc, s[64:65]
s_cbranch_vccnz L_stk1
L_rtk1:
M v[128:131],a[64:67],v[40:43],0
R a[96:99],v16,8192
R a[100:103],v16,9216
M v[128:131],a[68:71],v[56:59],v[128:131]
SA m0,s28,65536
E v18,v96
M v[132:135],a[68:71],v[60:63],0
buffer_load_dwordx4 v3, s[8:11], s21 offen offset:0 sc1 lds
M v[132:135],a[64:67],v[44:47],v[132:135]
R a[104:107],v16,10240
R a[108:111],v16,11264
M v[136:139],a[72:75],v[40:43],0
SA s3,s93,794624
E v19,v97
M v[136:139],a[76:79],v[56:59],v[136:139]
AF v30,v26,v30
AF v31,v27,v31
M v[140:143],a[76:79],v[60:63],0
R a[112:115],v16,12288
R a[116:119],v16,13312
M v[140:143],a[72:75],v[44:47],v[140:143]
buffer_load_dwordx4 v3, s[8:11], s21 offen offset:1024 sc1 lds
M v[144:147],a[80:83],v[40:43],0
E v20,v98
M v[144:147],a[84:87],v[56:59],v[144:147]
R a[120:123],v16,14336
R a[124:127],v16,15360
M v[148:151],a[84:87],v[60:63],0
buffer_store_dwordx4 v[240:243], v7, s[8:11], s3 offen offset:2048 sc1
M v[148:151],a[80:83],v[44:47],v[148:151]
E v21,v99
M v[152:155],a[88:91],v[40:43],0
AF v28,v18,v19
C v48,v18,v19
M v[152:155],a[92:95],v[56:59],v[152:155]
buffer_load_dwordx4 v3, s[8:11], s21 offen offset:2048 sc1 lds
M v[156:159],a[92:95],v[60:63],0
AF v28,v20,v28
C v49,v20,v21
M v[156:159],a[88:91],v[44:47],v[156:159]
s_waitcnt lgkmcnt(0)
E v22,v104
M v[160:163],a[96:99],v[40:43],0
R a[64:67],v16,16384
R a[68:71],v16,17408
M v[160:163],a[100:103],v[56:59],v[160:163]
buffer_load_dwordx4 v3, s[8:11], s21 offen offset:3072 sc1 lds
M v[164:167],a[100:103],v[60:63],0
SA m0,s28,69632
E v23,v105
M v[164:167],a[96:99],v[44:47],v[164:167]
R a[72:75],v16,18432
R a[76:79],v16,19456
M v[168:171],a[104:107],v[40:43],0
buffer_load_dwordx4 v4, s[8:11], s21 offen offset:0 sc1 lds
M v[168:171],a[108:111],v[56:59],v[168:171]
AF v28,v21,v28
AF v28,v22,v28
M v[172:175],a[108:111],v[60:63],0
R a[80:83],v16,20480
R a[84:87],v16,21504
M v[172:175],a[104:107],v[44:47],v[172:175]
buffer_store_dwordx4 v[248:251], v7, s[8:11], s3 offen offset:3072 sc1
M v[176:179],a[112:115],v[40:43],0
E v24,v106
M v[176:179],a[116:119],v[56:59],v[176:179]
R a[88:91],v16,22528
R a[92:95],v16,23552
M v[180:183],a[116:119],v[60:63],0
buffer_load_dwordx4 v4, s[8:11], s21 offen offset:1024 sc1 lds
M v[180:183],a[112:115],v[44:47],v[180:183]
E v25,v107
M v[184:187],a[120:123],v[40:43],0
C v50,v22,v23
AF v28,v23,v28
M v[184:187],a[124:127],v[56:59],v[184:187]
buffer_load_dwordx4 v4, s[8:11], s21 offen offset:2048 sc1 lds
M v[188:191],a[124:127],v[60:63],0
E v18,v100
M v[188:191],a[120:123],v[44:47],v[188:191]
s_waitcnt lgkmcnt(0)
AF v28,v24,v28
C v51,v24,v25
M v[192:195],a[64:67],v[40:43],0
R a[96:99],v16,24576
R a[100:103],v16,25600
M v[192:195],a[68:71],v[56:59],v[192:195]
buffer_load_dwordx4 v4, s[8:11], s21 offen offset:3072 sc1 lds
M v[196:199],a[68:71],v[60:63],0
SA s21,s21,32768
E v19,v101
M v[196:199],a[64:67],v[44:47],v[196:199]
s_sub_u32 s22, s22, 1
R a[104:107],v16,26624
R a[108:111],v16,27648
M v[200:203],a[72:75],v[40:43],0
s_cselect_b32 s21, s23, s21
AF v28,v25,v28
AF v29,v18,v19
M v[200:203],a[76:79],v[56:59],v[200:203]
E v20,v102
M v[204:207],a[76:79],v[60:63],0
R a[112:115],v16,28672
R a[116:119],v16,29696
M v[204:207],a[72:75],v[44:47],v[204:207]
C v52,v18,v19
M v[208:211],a[80:83],v[40:43],0
M v[208:211],a[84:87],v[56:59],v[208:211]
R a[120:123],v16,30720
R a[124:127],v16,31744
M v[212:215],a[84:87],v[60:63],0
E v21,v103
M v[212:215],a[80:83],v[44:47],v[212:215]
AF v29,v20,v29
C v53,v20,v21
M v[216:219],a[88:91],v[40:43],0
AF v29,v21,v29
M v[216:219],a[92:95],v[56:59],v[216:219]
E v22,v108
M v[220:223],a[92:95],v[60:63],0
s_waitcnt vmcnt(13) lgkmcnt(0)
M v[220:223],a[88:91],v[44:47],v[220:223]
s_barrier
M v[224:227],a[96:99],v[40:43],0
R a[64:67],v2,32768
R a[68:71],v2,33792
M v[224:227],a[100:103],v[56:59],v[224:227]
E v23,v109
M v[228:231],a[100:103],v[60:63],0
AF v29,v22,v29
C v54,v22,v23
M v[228:231],a[96:99],v[44:47],v[228:231]
R a[72:75],v2,34816
R a[76:79],v2,35840
M v[232:235],a[104:107],v[40:43],0
E v24,v110
M v[232:235],a[108:111],v[56:59],v[232:235]
AF v29,v23,v29
M v[236:239],a[108:111],v[60:63],0
R a[80:83],v2,36864
R a[84:87],v2,37888
M v[236:239],a[104:107],v[44:47],v[236:239]
M v[240:243],a[112:115],v[40:43],0
E v25,v111
M v[240:243],a[116:119],v[56:59],v[240:243]
R a[88:91],v2,38912
R a[92:95],v2,39936
M v[244:247],a[116:119],v[60:63],0
AF v29,v24,v29
C v55,v24,v25
M v[244:247],a[112:115],v[44:47],v[244:247]
AF v29,v25,v29
M v[248:251],a[120:123],v[40:43],0
M v[248:251],a[124:127],v[56:59],v[248:251]
M v[252:255],a[124:127],v[60:63],0
s_waitcnt lgkmcnt(0)
M v[252:255],a[120:123],v[44:47],v[252:255]
s_cmp_lg_u32 s27, 0
s_cbranch_scc1 L_loop_top
s_branch L_d1s
L_j0:
M v[68:71],a[64:67],a[32:35],0
s_cmp_lt_u32 s20, 0
R a[96:99],v2,40960
R a[100:103],v2,41984
M v[68:71],a[68:71],a[36:39],v[68:71]
s_cselect_b64 s[82:83], -1, 0
v_mov_b32 v30, 0
MF v172,s5,v172
M v[68:71],a[72:75],a[40:43],v[68:71]
s_cmp_eq_u32 s20, 0
MF v173,s5,v173
MF v174,s5,v174
M v[68:71],a[76:79],a[44:47],v[68:71]
s_cselect_b64 s[66:67], s[16:17], s[82:83]
R a[104:107],v2,43008
R a[108:111],v2,44032
M v[68:71],a[80:83],a[48:51],v[68:71]
s_cselect_b64 s[68:69], s[18:19], s[82:83]
MF v175,s5,v175
MF v188,s5,v188
M v[68:71],a[84:87],a[52:55],v[68:71]
s_cselect_b64 s[70:71], s[48:49], s[82:83]
MF v189,s5,v189
MF v190,s5,v190
MF v191,s5,v191
C v172,v172,v173
C v173,v174,v175
C v174,v188,v189
C v175,v190,v191
W a60,v172
W a61,v173
W a62,v174
W a63,v175
M v[68:71],a[88:91],a[56:59],v[68:71]
s_cselect_b64 s[72:73], s[50:51], s[82:83]
R a[112:115],v2,45056
R a[116:119],v2,46080
v_cndmask_b32 v64, 0, v8, s[66:67]
v_cndmask_b32 v65, 0, v8, s[68:69]
v_cndmask_b32 v66, 0, v8, s[70:71]
v_cndmask_b32 v67, 0, v8, s[72:73]
M v[68:71],a[92:95],a[60:63],v[68:71]
s_cmp_lt_u32 s20, 1
MF v164,s5,v164
MF v165,s5,v165
M v[64:67],a[64:67],a[0:3],v[64:67]
s_cselect_b64 s[82:83], -1, 0
MF v166,s5,v166
MF v167,s5,v167
M v[64:67],a[68:71],a[4:7],v[64:67]
s_cmp_eq_u32 s20, 1
R a[120:123],v2,47104
R a[124:127],v2,48128
M v[64:67],a[72:75],a[8:11],v[64:67]
s_cselect_b64 s[74:75], s[16:17], s[82:83]
MF v180,s5,v180
MF v181,s5,v181
M v[64:67],a[76:79],a[12:15],v[64:67]
s_cselect_b64 s[76:77], s[18:19], s[82:83]
MF v182,s5,v182
MF v183,s5,v183
M v[64:67],a[80:83],a[16:19],v[64:67]
s_cselect_b64 s[78:79], s[48:49], s[82:83]
C v164,v164,v165
C v165,v166,v167
C v166,v180,v181
C v167,v182,v183
W a28,v164
W a29,v165
W a30,v166
W a31,v167
M v[64:67],a[84:87],a[20:23],v[64:67]
s_cselect_b64 s[80:81], s[50:51], s[82:83]
v_mov_b32 v31, 0
v_cndmask_b32 v72, 0, v8, s[74:75]
M v[64:67],a[88:91],a[24:27],v[64:67]
s_mov_b32 s26, s43
v_mov_b32 v32, 0
M v[64:67],a[92:95],a[28:31],v[64:67]
s_waitcnt lgkmcnt(0)
v_cndmask_b32 v73, 0, v8, s[76:77]
M v[76:79],a[96:99],a[32:35],0
SA m0,s28,0
R a[64:67],v2,49152
R a[68:71],v2,50176
M v[76:79],a[100:103],a[36:39],v[76:79]
SA s3,s93,786432
buffer_load_dwordx4 v3, s[8:11], s26 offen offset:0 sc1 lds
M v[76:79],a[104:107],a[40:43],v[76:79]
v_cndmask_b32 v74, 0, v8, s[78:79]
v_mov_b32 v33, 0
M v[76:79],a[108:111],a[44:47],v[76:79]
R a[72:75],v2,51200
R a[76:79],v2,52224
M v[76:79],a[112:115],a[48:51],v[76:79]
buffer_store_dwordx4 v[192:195], v7, s[8:11], s3 offen offset:0 sc1
M v[76:79],a[116:119],a[52:55],v[76:79]
v_cndmask_b32 v75, 0, v8, s[80:81]
M v[76:79],a[120:123],a[56:59],v[76:79]
s_cmp_lt_u32 s20, 2
R a[80:83],v2,53248
R a[84:87],v2,54272
M v[76:79],a[124:127],a[60:63],v[76:79]
s_cselect_b64 s[82:83], -1, 0
buffer_load_dwordx4 v3, s[8:11], s26 offen offset:1024 sc1 lds
M v[72:75],a[124:127],a[28:31],v[72:75]
s_cmp_eq_u32 s20, 2
E v18,v68
M v[72:75],a[120:123],a[24:27],v[72:75]
s_cselect_b64 s[66:67], s[16:17], s[82:83]
R a[88:91],v2,55296
R a[92:95],v2,56320
M v[72:75],a[116:119],a[20:23],v[72:75]
s_cselect_b64 s[68:69], s[18:19], s[82:83]
buffer_load_dwordx4 v3, s[8:11], s26 offen offset:2048 sc1 lds
M v[72:75],a[112:115],a[16:19],v[72:75]
s_cselect_b64 s[70:71], s[48:49], s[82:83]
v_mov_b32 v34, 0
M v[72:75],a[108:111],a[12:15],v[72:75]
s_cselect_b64 s[72:73], s[50:51], s[82:83]
v_cndmask_b32 v80, 0, v8, s[66:67]
v_cndmask_b32 v81, 0, v8, s[68:69]
M v[72:75],a[104:107],a[8:11],v[72:75]
buffer_store_dwordx4 v[200:203], v7, s[8:11], s3 offen offset:1024 sc1
M v[72:75],a[100:103],a[4:7],v[72:75]
E v19,v69
M v[72:75],a[96:99],a[0:3],v[72:75]
s_waitcnt lgkmcnt(0)
buffer_load_dwordx4 v3, s[8:11], s26 offen offset:3072 sc1 lds
M v[84:87],a[64:67],a[32:35],0
SA m0,s28,4096
R a[96:99],v2,57344
R a[100:103],v2,58368
M v[84:87],a[68:71],a[36:39],v[84:87]
v_cndmask_b32 v82, 0, v8, s[70:71]
v_mov_b32 v35, 0
M v[84:87],a[72:75],a[40:43],v[84:87]
buffer_load_dwordx4 v4, s[8:11], s26 offen offset:0 sc1 lds
M v[84:87],a[76:79],a[44:47],v[84:87]
R a[104:107],v2,59392
R a[108:111],v2,60416
M v[84:87],a[80:83],a[48:51],v[84:87]
buffer_store_dwordx4 v[208:211], v7, s[8:11], s3 offen offset:2048 sc1
M v[84:87],a[84:87],a[52:55],v[84:87]
v_cndmask_b32 v83, 0, v8, s[72:73]
v_mov_b32 v36, 0
M v[84:87],a[88:91],a[56:59],v[84:87]
s_cmp_lt_u32 s20, 3
R a[112:115],v2,61440
R a[116:119],v2,62464
M v[84:87],a[92:95],a[60:63],v[84:87]
s_cselect_b64 s[82:83], -1, 0
buffer_load_dwordx4 v4, s[8:11], s26 offen offset:1024 sc1 lds
M v[80:83],a[92:95],a[28:31],v[80:83]
s_cmp_eq_u32 s20, 3
E v20,v70
M v[80:83],a[88:91],a[24:27],v[80:83]
s_cselect_b64 s[74:75], s[16:17], s[82:83]
R a[120:123],v2,63488
R a[124:127],v2,64512
M v[80:83],a[84:87],a[20:23],v[80:83]
s_cselect_b64 s[76:77], s[18:19], s[82:83]
buffer_load_dwordx4 v4, s[8:11], s26 offen offset:2048 sc1 lds
M v[80:83],a[80:83],a[16:19],v[80:83]
s_cselect_b64 s[78:79], s[48:49], s[82:83]
E v21,v71
M v[80:83],a[76:79],a[12:15],v[80:83]
s_cselect_b64 s[80:81], s[50:51], s[82:83]
buffer_store_dwordx4 v[216:219], v7, s[8:11], s3 offen offset:3072 sc1
M v[80:83],a[72:75],a[8:11],v[80:83]
SA s3,s93,794624
v_cndmask_b32 v88, 0, v8, s[74:75]
v_cndmask_b32 v89, 0, v8, s[76:77]
M v[80:83],a[68:71],a[4:7],v[80:83]
s_waitcnt vmcnt(24) lgkmcnt(0)
buffer_load_dwordx4 v4, s[8:11], s26 offen offset:3072 sc1 lds
M v[80:83],a[64:67],a[0:3],v[80:83]
s_barrier
M v[92:95],a[96:99],a[32:35],0
R a[64:67],v2,0
R a[68:71],v2,1024
M v[92:95],a[100:103],a[36:39],v[92:95]
buffer_store_dwordx4 v[224:227], v7, s[8:11], s3 offen offset:0 sc1
M v[92:95],a[104:107],a[40:43],v[92:95]
v_min_u32 v17, 896, v9
v_cndmask_b32 v90, 0, v8, s[78:79]
M v[92:95],a[108:111],a[44:47],v[92:95]
R a[72:75],v2,2048
R a[76:79],v2,3072
M v[92:95],a[112:115],a[48:51],v[92:95]
buffer_load_dword v5, v17, s[8:11], s46 offen sc1
M v[92:95],a[116:119],a[52:55],v[92:95]
buffer_store_dwordx4 v[232:235], v7, s[8:11], s3 offen offset:1024 sc1
M v[92:95],a[120:123],a[56:59],v[92:95]
R a[80:83],v2,4096
R a[84:87],v2,5120
v_cndmask_b32 v91, 0, v8, s[80:81]
M v[92:95],a[124:127],a[60:63],v[92:95]
v_mov_b32 v37, 0
v_mov_b32 v38, 0
M v[88:91],a[124:127],a[28:31],v[88:91]
buffer_store_dwordx4 v[240:243], v7, s[8:11], s3 offen offset:2048 sc1
M v[88:91],a[120:123],a[24:27],v[88:91]
R a[88:91],v2,6144
R a[92:95],v2,7168
M v[88:91],a[116:119],a[20:23],v[88:91]
v_mov_b32 v39, 0
AF v27,v18,v19
M v[88:91],a[112:115],a[16:19],v[88:91]
buffer_store_dwordx4 v[248:251], v7, s[8:11], s3 offen offset:3072 sc1
M v[88:91],a[108:111],a[12:15],v[88:91]
E v22,v64
M v[88:91],a[104:107],a[8:11],v[88:91]
E v23,v65
M v[88:91],a[100:103],a[4:7],v[88:91]
s_waitcnt lgkmcnt(0)
E v24,v66
M v[88:91],a[96:99],a[0:3],v[88:91]
E v25,v67
C v44,v18,v19
AF v27,v20,v27
C v45,v20,v21
AF v27,v21,v27
AF v26,v22,v23
C v40,v22,v23
E v18,v76
E v19,v77
AF v26,v24,v26
C v41,v24,v25
AF v26,v25,v26
E v20,v78
E v21,v79
AF v27,v18,v27
C v46,v18,v19
AF v27,v19,v27
E v22,v72
E v23,v73
AF v27,v20,v27
C v47,v20,v21
AF v27,v21,v27
E v24,v74
E v25,v75
AF v26,v22,v26
C v42,v22,v23
AF v26,v23,v26
AF v26,v24,v26
C v43,v24,v25
AF v26,v25,v26
v_mov_b32 v56, 0
v_mov_b32 v57, 0
v_mov_b32 v58, 0
v_mov_b32 v59, 0
s_mul_i32 s21, s41, 1048576
SA s21,s21,589824
s_lshl_b32 s84, s42, 1
s_sub_u32 s22, 11, s84
s_mov_b32 s23, 536870912
s_lshl_b32 s86, s20, 14
SA s86,s86,s34
SA s87,s86,4096
SA s88,s86,8192
SA s89,s86,12288
s_lshl_b32 s90, s20, 10
SA s90,s90,s34
SA s90,s90,65536
s_waitcnt vmcnt(3)
v_cmp_gt_u32 vcc, 2, v5
s_nop 0
s_cbranch_vccnz L_lsj0
L_lrj0:
SA m0,s28,98304
v_mov_b32 v10, v26
buffer_load_dwordx4 v3, s[8:11], s21 offen offset:0 sc1 lds
v_mov_b32 v11, v27
buffer_load_dwordx4 v3, s[8:11], s21 offen offset:1024 sc1 lds
v_mov_b32 v12, v10
v_mov_b32 v13, v11
buffer_load_dwordx4 v3, s[8:11], s21 offen offset:2048 sc1 lds
v_permlane16_swap_b32 v12, v10
v_permlane16_swap_b32 v13, v11
buffer_load_dwordx4 v3, s[8:11], s21 offen offset:3072 sc1 lds
v_max_f32 v10, v12, v10
SA m0,s28,102400
v_max_f32 v11, v13, v11
buffer_load_dwordx4 v4, s[8:11], s21 offen offset:0 sc1 lds
v_mov_b32 v12, v10
v_mov_b32 v13, v11
buffer_load_dwordx4 v4, s[8:11], s21 offen offset:1024 sc1 lds
v_permlane32_swap_b32 v12, v10
v_permlane32_swap_b32 v13, v11
buffer_load_dwordx4 v4, s[8:11], s21 offen offset:2048 sc1 lds
v_max_f32 v10, v12, v10
v_max_f32 v11, v13, v11
buffer_load_dwordx4 v4, s[8:11], s21 offen offset:3072 sc1 lds
SA s21,s21,32768
s_sub_u32 s22, s22, 1
s_cselect_b32 s21, s23, s21
v_min_f32 v10, v10, v11
v_cmp_gt_f32 vcc, s24, v10
s_nop 0
s_cbranch_vccnz L_stj0
L_rtj0:
s_cmp_gt_u32 s20, 3
s_cselect_b64 s[82:83], -1, 0
s_cmp_eq_u32 s20, 3
s_cselect_b64 s[66:67], s[16:17], s[82:83]
v_mfma_f32_32x32x16_bf16 v[128:143], v[56:59], v[56:59], 0
s_cselect_b64 s[68:69], s[18:19], s[82:83]
s_cselect_b64 s[70:71], s[48:49], s[82:83]
s_cselect_b64 s[72:73], s[50:51], s[82:83]
v_cndmask_b32 v100, v36, v8, s[66:67]
v_mfma_f32_32x32x16_bf16 v[144:159], v[56:59], v[56:59], 0
v_cndmask_b32 v101, v36, v8, s[68:69]
v_cndmask_b32 v102, v36, v8, s[70:71]
v_cndmask_b32 v103, v36, v8, s[72:73]
s_cmp_gt_u32 s20, 2
v_mfma_f32_32x32x16_bf16 v[160:175], v[56:59], v[56:59], 0
s_cselect_b64 s[82:83], -1, 0
s_cmp_eq_u32 s20, 2
s_cselect_b64 s[74:75], s[16:17], s[82:83]
s_cselect_b64 s[76:77], s[18:19], s[82:83]
v_mfma_f32_32x32x16_bf16 v[176:191], v[56:59], v[56:59], 0
s_cselect_b64 s[78:79], s[48:49], s[82:83]
s_cselect_b64 s[80:81], s[50:51], s[82:83]
v_cndmask_b32 v108, v36, v8, s[74:75]
v_cndmask_b32 v109, v36, v8, s[76:77]
v_mfma_f32_32x32x16_bf16 v[192:207], v[56:59], v[56:59], 0
v_cndmask_b32 v110, v36, v8, s[78:79]
v_cndmask_b32 v111, v36, v8, s[80:81]
s_cmp_gt_u32 s20, 1
s_cselect_b64 s[82:83], -1, 0
v_mfma_f32_32x32x16_bf16 v[208:223], v[56:59], v[56:59], 0
s_cmp_eq_u32 s20, 1
s_cselect_b64 s[66:67], s[16:17], s[82:83]
s_cselect_b64 s[68:69], s[18:19], s[82:83]
s_cselect_b64 s[70:71], s[48:49], s[82:83]
v_mfma_f32_32x32x16_bf16 v[224:239], v[56:59], v[56:59], 0
s_cselect_b64 s[72:73], s[50:51], s[82:83]
v_cndmask_b32 v116, v36, v8, s[66:67]
v_cndmask_b32 v117, v36, v8, s[68:69]
v_cndmask_b32 v118, v36, v8, s[70:71]
v_mfma_f32_32x32x16_bf16 v[240:255], v[56:59], v[56:59], 0
v_cndmask_b32 v119, v36, v8, s[72:73]
s_cmp_gt_u32 s20, 0
s_cselect_b64 s[82:83], -1, 0
s_cmp_eq_u32 s20, 0
s_cselect_b64 s[74:75], s[16:17], s[82:83]
s_cselect_b64 s[76:77], s[18:19], s[82:83]
s_cselect_b64 s[78:79], s[48:49], s[82:83]
s_cselect_b64 s[80:81], s[50:51], s[82:83]
v_cndmask_b32 v124, v36, v8, s[74:75]
v_cndmask_b32 v125, v36, v8, s[76:77]
v_cndmask_b32 v126, v36, v8, s[78:79]
v_cndmask_b32 v127, v36, v8, s[80:81]
s_branch L_d3h
.p2align 12
L_kv1:
s_and_b32 s31, s42, 7
s_lshl_b32 s30, s41, 3
SA s30,s30,s31
s_lshl_b32 s64, s30, 2
SA s64,s64,s20
s_mul_i32 s72, s64, 3584
v_mov_b32 v32, 536870912
v_cmp_gt_u32 vcc, 56, v0
s_lshl_b32 s67, s64, 2
s_nop 0
v_cndmask_b32 v32, v32, v7, vcc
buffer_load_dwordx4 v[40:43], v32, s[56:59], s72 offen offset:0
buffer_load_dwordx4 v[44:47], v32, s[56:59], s72 offen offset:896
buffer_load_dwordx4 v[48:51], v32, s[56:59], s72 offen offset:1792
buffer_load_dwordx4 v[52:55], v32, s[56:59], s72 offen offset:2688
buffer_load_dwordx4 v[56:59], v32, s[60:63], 0 offen
buffer_load_dwordx4 v[60:63], v32, s[68:71], 0 offen
SA m0,s23,32768
s_nop 0
buffer_load_dwordx4 v8, s[16:19], s21 offen offset:0  nt lds
buffer_load_dwordx4 v9, s[16:19], s21 offen offset:1024  nt lds
buffer_load_dwordx4 v10, s[16:19], s21 offen offset:2048  nt lds
buffer_load_dwordx4 v11, s[16:19], s21 offen offset:3072  nt lds
SA s21,s21,128
SA m0,s24,16384
s_nop 0
buffer_load_dwordx4 v12, s[48:51], s22 offen offset:0   lds
buffer_load_dwordx4 v13, s[48:51], s22 offen offset:1024   lds
buffer_load_dwordx4 v14, s[48:51], s22 offen offset:2048   lds
buffer_load_dwordx4 v15, s[48:51], s22 offen offset:3072   lds
s_sub_u32 s22, s22, 1048448
s_mov_b64 exec, 0
s_cmp_eq_u32 s20, 0
s_cbranch_scc1 L_w_kv11
s_cmp_eq_u32 s20, 1
s_cbranch_scc1 L_w_kv12
s_cmp_eq_u32 s20, 2
s_cbranch_scc1 L_w_kv13
s_branch L_w_kv14
L_wd2:
s_mov_b64 exec, -1
s_waitcnt vmcnt(14) lgkmcnt(0)
s_barrier
R a[160:163],v5,0
R a[164:167],v6,0
T a[96:97],v1,0
T a[98:99],v1,1024
T a[100:101],v1,8192
T a[102:103],v1,9216
T a[104:105],v2,0
T a[106:107],v2,1024
T a[108:109],v2,8192
T a[110:111],v2,9216
T a[112:113],v3,0
T a[114:115],v3,1024
T a[116:117],v3,8192
T a[118:119],v3,9216
T a[120:121],v4,0
T a[122:123],v4,1024
T a[124:125],v4,8192
T a[126:127],v4,9216
T a[128:129],v1,16384
T a[130:131],v1,17408
T a[132:133],v1,24576
T a[134:135],v1,25600
T a[136:137],v2,16384
T a[138:139],v2,17408
T a[140:141],v2,24576
T a[142:143],v2,25600
T a[144:145],v3,16384
T a[146:147],v3,17408
T a[148:149],v3,24576
T a[150:151],v3,25600
T a[152:153],v4,16384
T a[154:155],v4,17408
T a[156:157],v4,24576
T a[158:159],v4,25600
v_mov_b32 v72, 0
v_mov_b32 v73, 0
v_mov_b32 v74, 0
v_mov_b32 v75, 0
v_mov_b32 v76, 0
v_mov_b32 v77, 0
v_mov_b32 v78, 0
v_mov_b32 v79, 0
s_waitcnt vmcnt(9)
v_dot2c_f32_bf16 v72, v40, v56
v_dot2c_f32_bf16 v73, v44, v56
v_dot2c_f32_bf16 v74, v48, v56
v_dot2c_f32_bf16 v75, v52, v56
s_waitcnt vmcnt(8)
v_dot2c_f32_bf16 v76, v40, v60
v_dot2c_f32_bf16 v77, v44, v60
v_dot2c_f32_bf16 v78, v48, v60
v_dot2c_f32_bf16 v79, v52, v60
v_dot2c_f32_bf16 v72, v41, v57
v_dot2c_f32_bf16 v73, v45, v57
v_dot2c_f32_bf16 v74, v49, v57
v_dot2c_f32_bf16 v75, v53, v57
v_dot2c_f32_bf16 v76, v41, v61
v_dot2c_f32_bf16 v77, v45, v61
v_dot2c_f32_bf16 v78, v49, v61
v_dot2c_f32_bf16 v79, v53, v61
v_dot2c_f32_bf16 v72, v42, v58
v_dot2c_f32_bf16 v73, v46, v58
v_dot2c_f32_bf16 v74, v50, v58
v_dot2c_f32_bf16 v75, v54, v58
v_dot2c_f32_bf16 v76, v42, v62
v_dot2c_f32_bf16 v77, v46, v62
v_dot2c_f32_bf16 v78, v50, v62
v_dot2c_f32_bf16 v79, v54, v62
v_dot2c_f32_bf16 v72, v43, v59
v_dot2c_f32_bf16 v73, v47, v59
v_dot2c_f32_bf16 v74, v51, v59
v_dot2c_f32_bf16 v75, v55, v59
v_dot2c_f32_bf16 v76, v43, v63
v_dot2c_f32_bf16 v77, v47, v63
v_dot2c_f32_bf16 v78, v51, v63
v_dot2c_f32_bf16 v79, v55, v63
v_permlane32_swap_b32 v72, v74
v_permlane32_swap_b32 v73, v75
v_permlane32_swap_b32 v76, v78
v_permlane32_swap_b32 v77, v79
AF v72,v72,v74
AF v73,v73,v75
AF v76,v76,v78
AF v77,v77,v79
v_lshrrev_b32 v80, 4, v0
v_permlane16_swap_b32 v72, v73
v_permlane16_swap_b32 v76, v77
AF v72,v72,v73
AF v76,v76,v77
v_add_u32 v81, s67, v80
v_add_f32 v72, v72, v72 row_ror:8 row_mask:0xf bank_mask:0xf
v_add_f32 v76, v76, v76 row_ror:8 row_mask:0xf bank_mask:0xf
s_nop 0
v_add_f32 v72, v72, v72 row_ror:4 row_mask:0xf bank_mask:0xf
v_add_f32 v76, v76, v76 row_ror:4 row_mask:0xf bank_mask:0xf
s_nop 0
v_add_f32 v72, v72, v72 row_ror:2 row_mask:0xf bank_mask:0xf
v_add_f32 v76, v76, v76 row_ror:2 row_mask:0xf bank_mask:0xf
s_nop 0
v_add_f32 v72, v72, v72 row_ror:1 row_mask:0xf bank_mask:0xf
v_add_f32 v76, v76, v76 row_ror:1 row_mask:0xf bank_mask:0xf
v_ashrrev_i32 v82, 31, v72
v_or_b32 v82, 0x80000000, v82
v_xor_b32 v82, v82, v72
v_and_b32 v82, 0xfffff800, v82
v_sub_u32 v81, 2047, v81
v_or_b32 v82, v82, v81
v_max_u32 v82, 1, v82
MF v77,0xbfb8aa3b,v76
E v77,v77
s_nop 0
AF v77,1.0,v77
v_rcp_f32 v76, v77
s_lshl_b32 s72, s20, 4
SA s72,s72,163584
v_lshl_add_u32 v80, v80, 2, s72
ds_write_b32 v80, v82
ds_write_b32 v80, v72 offset:64
ds_write_b32 v80, v76 offset:128
s_waitcnt lgkmcnt(15)
M a[0:3],a[160:163],a[96:99],0
SA m0,s23,49152
R a[168:171],v5,2048
R a[172:175],v6,2048
M a[0:3],a[164:167],a[100:103],a[0:3]
buffer_load_dwordx4 v8, s[16:19], s21 offen offset:0  nt lds
M a[4:7],a[164:167],a[108:111],0
M a[4:7],a[160:163],a[104:107],a[4:7]
M a[8:11],a[160:163],a[112:115],0
buffer_load_dwordx4 v9, s[16:19], s21 offen offset:1024  nt lds
M a[8:11],a[164:167],a[116:119],a[8:11]
M a[12:15],a[164:167],a[124:127],0
M a[12:15],a[160:163],a[120:123],a[12:15]
buffer_load_dwordx4 v10, s[16:19], s21 offen offset:2048  nt lds
M a[16:19],a[160:163],a[128:131],0
M a[16:19],a[164:167],a[132:135],a[16:19]
s_waitcnt lgkmcnt(9)
M a[20:23],a[164:167],a[140:143],0
buffer_load_dwordx4 v11, s[16:19], s21 offen offset:3072  nt lds
M a[20:23],a[160:163],a[136:139],a[20:23]
SA s21,s21,524160
M a[24:27],a[160:163],a[144:147],0
M a[24:27],a[164:167],a[148:151],a[24:27]
s_waitcnt lgkmcnt(0)
M a[28:31],a[164:167],a[156:159],0
s_waitcnt vmcnt(8)
M a[28:31],a[160:163],a[152:155],a[28:31]
s_barrier
M v[32:35],a[168:171],a[96:99],0
SA m0,s24,32768
R a[160:163],v5,4096
R a[164:167],v6,4096
M v[32:35],a[172:175],a[100:103],v[32:35]
T a[32:33],v1,32768
T a[34:35],v1,33792
M v[36:39],a[172:175],a[108:111],0
buffer_load_dwordx4 v12, s[48:51], s22 offen offset:0   lds
M v[36:39],a[168:171],a[104:107],v[36:39]
M v[40:43],a[168:171],a[112:115],0
s_nop 0
T a[36:37],v1,40960
T a[38:39],v1,41984
M v[40:43],a[172:175],a[116:119],v[40:43]
buffer_load_dwordx4 v13, s[48:51], s22 offen offset:1024   lds
M v[44:47],a[172:175],a[124:127],0
M v[44:47],a[168:171],a[120:123],v[44:47]
s_nop 0
T a[40:41],v2,32768
T a[42:43],v2,33792
M v[48:51],a[168:171],a[128:131],0
buffer_load_dwordx4 v14, s[48:51], s22 offen offset:2048   lds
M v[48:51],a[172:175],a[132:135],v[48:51]
M v[52:55],a[172:175],a[140:143],0
s_nop 0
T a[44:45],v2,40960
T a[46:47],v2,41984
M v[52:55],a[168:171],a[136:139],v[52:55]
buffer_load_dwordx4 v15, s[48:51], s22 offen offset:3072   lds
M v[56:59],a[168:171],a[144:147],0
SA s22,s22,1048576
M v[56:59],a[172:175],a[148:151],v[56:59]
s_waitcnt lgkmcnt(8)
s_nop 0
T a[48:49],v3,32768
T a[50:51],v3,33792
M v[60:63],a[172:175],a[156:159],0
SA m0,s23,0
M v[60:63],a[168:171],a[152:155],v[60:63]
buffer_load_dwordx4 v8, s[16:19], s21 offen offset:0  nt lds
M v[64:67],a[160:163],a[96:99],0
R a[168:171],v5,6144
R a[172:175],v6,6144
M v[64:67],a[164:167],a[100:103],v[64:67]
T a[52:53],v3,40960
T a[54:55],v3,41984
M v[68:71],a[164:167],a[108:111],0
M v[68:71],a[160:163],a[104:107],v[68:71]
s_nop 0
T a[56:57],v4,32768
T a[58:59],v4,33792
M v[72:75],a[160:163],a[112:115],0
buffer_load_dwordx4 v9, s[16:19], s21 offen offset:1024  nt lds
M v[72:75],a[164:167],a[116:119],v[72:75]
M v[76:79],a[164:167],a[124:127],0
s_nop 0
T a[60:61],v4,40960
T a[62:63],v4,41984
M v[76:79],a[160:163],a[120:123],v[76:79]
buffer_load_dwordx4 v10, s[16:19], s21 offen offset:2048  nt lds
M v[80:83],a[160:163],a[128:131],0
M v[80:83],a[164:167],a[132:135],v[80:83]
M v[84:87],a[164:167],a[140:143],0
buffer_load_dwordx4 v11, s[16:19], s21 offen offset:3072  nt lds
M v[84:87],a[160:163],a[136:139],v[84:87]
SA s21,s21,128
M v[88:91],a[160:163],a[144:147],0
M v[88:91],a[164:167],a[148:151],v[88:91]
s_waitcnt lgkmcnt(6)
M v[92:95],a[164:167],a[156:159],0
s_waitcnt vmcnt(8) lgkmcnt(0)
M v[92:95],a[160:163],a[152:155],v[92:95]
s_barrier
M v[96:99],a[168:171],a[96:99],0
SA m0,s24,49152
R a[160:163],v5,16384
R a[164:167],v6,16384
M v[96:99],a[172:175],a[100:103],v[96:99]
buffer_load_dwordx4 v12, s[48:51], s22 offen offset:0   lds
M v[100:103],a[172:175],a[108:111],0
s_nop 0
T a[64:65],v1,49152
T a[66:67],v1,50176
M v[100:103],a[168:171],a[104:107],v[100:103]
v_lshlrev_b32 v26, 7, v0
v_and_b32 v27, 48, v0
M v[104:107],a[168:171],a[112:115],0
buffer_load_dwordx4 v13, s[48:51], s22 offen offset:1024   lds
M v[104:107],a[172:175],a[116:119],v[104:107]
v_lshl_add_u32 v26, v27, 24, v26
M v[108:111],a[172:175],a[124:127],0
M v[108:111],a[168:171],a[120:123],v[108:111]
M v[112:115],a[168:171],a[128:131],0
buffer_load_dwordx4 v14, s[48:51], s22 offen offset:2048   lds
M v[112:115],a[172:175],a[132:135],v[112:115]
s_nop 0
T a[68:69],v1,57344
T a[70:71],v1,58368
M v[116:119],a[172:175],a[140:143],0
M v[116:119],a[168:171],a[136:139],v[116:119]
M v[120:123],a[168:171],a[144:147],0
buffer_load_dwordx4 v15, s[48:51], s22 offen offset:3072   lds
M v[120:123],a[172:175],a[148:151],v[120:123]
s_waitcnt lgkmcnt(4)
M v[124:127],a[172:175],a[156:159],0
s_sub_u32 s22, s22, 1048448
M v[124:127],a[168:171],a[152:155],v[124:127]
SA m0,s23,16384
M v[128:131],a[160:163],a[96:99],0
R a[168:171],v5,18432
R a[172:175],v6,18432
M v[128:131],a[164:167],a[100:103],v[128:131]
T a[72:73],v2,49152
T a[74:75],v2,50176
M v[132:135],a[164:167],a[108:111],0
buffer_load_dwordx4 v8, s[16:19], s21 offen offset:0  nt lds
M v[132:135],a[160:163],a[104:107],v[132:135]
M v[136:139],a[160:163],a[112:115],0
buffer_load_dwordx4 v9, s[16:19], s21 offen offset:1024  nt lds
M v[136:139],a[164:167],a[116:119],v[136:139]
M v[140:143],a[164:167],a[124:127],0
M v[140:143],a[160:163],a[120:123],v[140:143]
s_nop 0
T a[76:77],v2,57344
T a[78:79],v2,58368
M v[144:147],a[160:163],a[128:131],0
buffer_load_dwordx4 v10, s[16:19], s21 offen offset:2048  nt lds
M v[144:147],a[164:167],a[132:135],v[144:147]
M v[148:151],a[164:167],a[140:143],0
M v[148:151],a[160:163],a[136:139],v[148:151]
buffer_load_dwordx4 v11, s[16:19], s21 offen offset:3072  nt lds
M v[152:155],a[160:163],a[144:147],0
SA s21,s21,524160
M v[152:155],a[164:167],a[148:151],v[152:155]
s_waitcnt lgkmcnt(4)
M v[156:159],a[164:167],a[156:159],0
SA m0,s24,0
T a[80:81],v3,49152
T a[82:83],v3,50176
M v[156:159],a[160:163],a[152:155],v[156:159]
buffer_load_dwordx4 v12, s[48:51], s22 offen offset:0   lds
M v[160:163],a[168:171],a[96:99],0
R a[160:163],v5,20480
R a[164:167],v6,20480
M v[160:163],a[172:175],a[100:103],v[160:163]
M v[164:167],a[172:175],a[108:111],0
M v[164:167],a[168:171],a[104:107],v[164:167]
buffer_load_dwordx4 v13, s[48:51], s22 offen offset:1024   lds
M v[168:171],a[168:171],a[112:115],0
M v[168:171],a[172:175],a[116:119],v[168:171]
s_nop 0
T a[84:85],v3,57344
T a[86:87],v3,58368
M v[172:175],a[172:175],a[124:127],0
M v[172:175],a[168:171],a[120:123],v[172:175]
buffer_load_dwordx4 v14, s[48:51], s22 offen offset:2048   lds
M v[176:179],a[168:171],a[128:131],0
M v[176:179],a[172:175],a[132:135],v[176:179]
M v[180:183],a[172:175],a[140:143],0
buffer_load_dwordx4 v15, s[48:51], s22 offen offset:3072   lds
M v[180:183],a[168:171],a[136:139],v[180:183]
SA s22,s22,1048576
M v[184:187],a[168:171],a[144:147],0
s_nop 0
T a[88:89],v4,49152
T a[90:91],v4,50176
M v[184:187],a[172:175],a[148:151],v[184:187]
s_waitcnt lgkmcnt(4)
M v[188:191],a[172:175],a[156:159],0
SA m0,s23,32768
M v[188:191],a[168:171],a[152:155],v[188:191]
buffer_load_dwordx4 v8, s[16:19], s21 offen offset:0  nt lds
M v[192:195],a[160:163],a[96:99],0
R a[168:171],v5,22528
R a[172:175],v6,22528
M v[192:195],a[164:167],a[100:103],v[192:195]
M v[196:199],a[164:167],a[108:111],0
buffer_load_dwordx4 v9, s[16:19], s21 offen offset:1024  nt lds
M v[196:199],a[160:163],a[104:107],v[196:199]
s_nop 0
T a[92:93],v4,57344
T a[94:95],v4,58368
M v[200:203],a[160:163],a[112:115],0
M v[200:203],a[164:167],a[116:119],v[200:203]
M v[204:207],a[164:167],a[124:127],0
buffer_load_dwordx4 v10, s[16:19], s21 offen offset:2048  nt lds
M v[204:207],a[160:163],a[120:123],v[204:207]
M v[208:211],a[160:163],a[128:131],0
M v[208:211],a[164:167],a[132:135],v[208:211]
M v[212:215],a[164:167],a[140:143],0
buffer_load_dwordx4 v11, s[16:19], s21 offen offset:3072  nt lds
M v[212:215],a[160:163],a[136:139],v[212:215]
SA s21,s21,128
M v[216:219],a[160:163],a[144:147],0
M v[216:219],a[164:167],a[148:151],v[216:219]
s_waitcnt lgkmcnt(2)
M v[220:223],a[164:167],a[156:159],0
s_waitcnt vmcnt(16) lgkmcnt(0)
M v[220:223],a[160:163],a[152:155],v[220:223]
s_barrier
M v[224:227],a[168:171],a[96:99],0
R a[160:163],v5,32768
R a[164:167],v6,32768
M v[224:227],a[172:175],a[100:103],v[224:227]
M v[228:231],a[172:175],a[108:111],0
M v[228:231],a[168:171],a[104:107],v[228:231]
M v[232:235],a[168:171],a[112:115],0
M v[232:235],a[172:175],a[116:119],v[232:235]
M v[236:239],a[172:175],a[124:127],0
M v[236:239],a[168:171],a[120:123],v[236:239]
M v[240:243],a[168:171],a[128:131],0
M v[240:243],a[172:175],a[132:135],v[240:243]
M v[244:247],a[172:175],a[140:143],0
M v[244:247],a[168:171],a[136:139],v[244:247]
M v[248:251],a[168:171],a[144:147],0
M v[248:251],a[172:175],a[148:151],v[248:251]
s_waitcnt lgkmcnt(0)
M v[252:255],a[172:175],a[156:159],0
M v[252:255],a[168:171],a[152:155],v[252:255]
M a[0:3],a[160:163],a[32:35],a[0:3]
R a[168:171],v5,34816
R a[172:175],v6,34816
M a[0:3],a[164:167],a[36:39],a[0:3]
T a[96:97],v1,0
T a[98:99],v1,1024
M a[4:7],a[164:167],a[44:47],a[4:7]
SA m0,s24,16384
M a[4:7],a[160:163],a[40:43],a[4:7]
buffer_load_dwordx4 v12, s[48:51], s22 offen offset:0   lds
M a[8:11],a[160:163],a[48:51],a[8:11]
M a[8:11],a[164:167],a[52:55],a[8:11]
M a[12:15],a[164:167],a[60:63],a[12:15]
s_nop 0
T a[100:101],v1,8192
T a[102:103],v1,9216
M a[12:15],a[160:163],a[56:59],a[12:15]
M a[16:19],a[160:163],a[64:67],a[16:19]
buffer_load_dwordx4 v13, s[48:51], s22 offen offset:1024   lds
M a[16:19],a[164:167],a[68:71],a[16:19]
M a[20:23],a[164:167],a[76:79],a[20:23]
M a[20:23],a[160:163],a[72:75],a[20:23]
s_nop 0
T a[104:105],v2,0
T a[106:107],v2,1024
M a[24:27],a[160:163],a[80:83],a[24:27]
M a[24:27],a[164:167],a[84:87],a[24:27]
s_waitcnt lgkmcnt(6)
buffer_load_dwordx4 v14, s[48:51], s22 offen offset:2048   lds
M a[28:31],a[164:167],a[92:95],a[28:31]
M a[28:31],a[160:163],a[88:91],a[28:31]
M v[32:35],a[168:171],a[32:35],v[32:35]
R a[160:163],v5,36864
R a[164:167],v6,36864
M v[32:35],a[172:175],a[36:39],v[32:35]
T a[108:109],v2,8192
T a[110:111],v2,9216
M v[36:39],a[172:175],a[44:47],v[36:39]
buffer_load_dwordx4 v15, s[48:51], s22 offen offset:3072   lds
M v[36:39],a[168:171],a[40:43],v[36:39]
s_sub_u32 s22, s22, 1048448
M v[40:43],a[168:171],a[48:51],v[40:43]
M v[40:43],a[172:175],a[52:55],v[40:43]
s_and_b32 s27, s42, 7
T a[112:113],v3,0
T a[114:115],v3,1024
M v[44:47],a[172:175],a[60:63],v[44:47]
SA m0,s23,49152
s_lshl_b32 s64, s41, 3
M v[44:47],a[168:171],a[56:59],v[44:47]
SA s27,s27,s64
buffer_load_dwordx4 v8, s[16:19], s21 offen offset:0  nt lds
M v[48:51],a[168:171],a[64:67],v[48:51]
s_lshl_b32 s27, s27, 2
M v[48:51],a[172:175],a[68:71],v[48:51]
SA s27,s27,s20
M v[52:55],a[172:175],a[76:79],v[52:55]
s_mul_i32 s27, s27, 7168
T a[116:117],v3,8192
T a[118:119],v3,9216
M v[52:55],a[168:171],a[72:75],v[52:55]
s_mov_b32 s60, s90
M v[56:59],a[168:171],a[80:83],v[56:59]
s_and_b32 s61, s91, 0xffff
buffer_load_dwordx4 v9, s[16:19], s21 offen offset:1024  nt lds
M v[56:59],a[172:175],a[84:87],v[56:59]
s_waitcnt lgkmcnt(6)
s_mov_b32 s62, 3670016
M v[60:63],a[172:175],a[92:95],v[60:63]
s_mov_b32 s63, 0x20000
M v[60:63],a[168:171],a[88:91],v[60:63]
s_nop 0
T a[120:121],v4,0
T a[122:123],v4,1024
M v[64:67],a[160:163],a[32:35],v[64:67]
R a[168:171],v5,38912
R a[172:175],v6,38912
M v[64:67],a[164:167],a[36:39],v[64:67]
buffer_load_dwordx4 v10, s[16:19], s21 offen offset:2048  nt lds
M v[68:71],a[164:167],a[44:47],v[68:71]
M v[68:71],a[160:163],a[40:43],v[68:71]
M v[72:75],a[160:163],a[48:51],v[72:75]
s_nop 0
T a[124:125],v4,8192
T a[126:127],v4,9216
M v[72:75],a[164:167],a[52:55],v[72:75]
M v[76:79],a[164:167],a[60:63],v[76:79]
buffer_load_dwordx4 v11, s[16:19], s21 offen offset:3072  nt lds
M v[76:79],a[160:163],a[56:59],v[76:79]
SA s21,s21,524160
M v[80:83],a[160:163],a[64:67],v[80:83]
M v[80:83],a[164:167],a[68:71],v[80:83]
M v[84:87],a[164:167],a[76:79],v[84:87]
M v[84:87],a[160:163],a[72:75],v[84:87]
M v[88:91],a[160:163],a[80:83],v[88:91]
M v[88:91],a[164:167],a[84:87],v[88:91]
s_waitcnt lgkmcnt(2)
M v[92:95],a[164:167],a[92:95],v[92:95]
s_waitcnt vmcnt(16) lgkmcnt(0)
M v[92:95],a[160:163],a[88:91],v[92:95]
s_barrier
M v[96:99],a[168:171],a[32:35],v[96:99]
R a[160:163],v5,49152
R a[164:167],v6,49152
M v[96:99],a[172:175],a[36:39],v[96:99]
M v[100:103],a[172:175],a[44:47],v[100:103]
SA m0,s24,32768
T a[128:129],v1,16384
T a[130:131],v1,17408
M v[100:103],a[168:171],a[40:43],v[100:103]
buffer_load_dwordx4 v12, s[48:51], s22 offen offset:0   lds
M v[104:107],a[168:171],a[48:51],v[104:107]
M v[104:107],a[172:175],a[52:55],v[104:107]
M v[108:111],a[172:175],a[60:63],v[108:111]
M v[108:111],a[168:171],a[56:59],v[108:111]
M v[112:115],a[168:171],a[64:67],v[112:115]
M v[112:115],a[172:175],a[68:71],v[112:115]
s_nop 0
T a[132:133],v1,24576
T a[134:135],v1,25600
M v[116:119],a[172:175],a[76:79],v[116:119]
buffer_load_dwordx4 v13, s[48:51], s22 offen offset:1024   lds
M v[116:119],a[168:171],a[72:75],v[116:119]
M v[120:123],a[168:171],a[80:83],v[120:123]
M v[120:123],a[172:175],a[84:87],v[120:123]
s_waitcnt lgkmcnt(4)
M v[124:127],a[172:175],a[92:95],v[124:127]
M v[124:127],a[168:171],a[88:91],v[124:127]
M v[128:131],a[160:163],a[32:35],v[128:131]
R a[168:171],v5,51200
R a[172:175],v6,51200
M v[128:131],a[164:167],a[36:39],v[128:131]
T a[136:137],v2,16384
T a[138:139],v2,17408
M v[132:135],a[164:167],a[44:47],v[132:135]
buffer_load_dwordx4 v14, s[48:51], s22 offen offset:2048   lds
M v[132:135],a[160:163],a[40:43],v[132:135]
M v[136:139],a[160:163],a[48:51],v[136:139]
M v[136:139],a[164:167],a[52:55],v[136:139]
M v[140:143],a[164:167],a[60:63],v[140:143]
M v[140:143],a[160:163],a[56:59],v[140:143]
s_nop 0
T a[140:141],v2,24576
T a[142:143],v2,25600
M v[144:147],a[160:163],a[64:67],v[144:147]
buffer_load_dwordx4 v15, s[48:51], s22 offen offset:3072   lds
M v[144:147],a[164:167],a[68:71],v[144:147]
SA s22,s22,1048576
M v[148:151],a[164:167],a[76:79],v[148:151]
M v[148:151],a[160:163],a[72:75],v[148:151]
M v[152:155],a[160:163],a[80:83],v[152:155]
M v[152:155],a[164:167],a[84:87],v[152:155]
s_waitcnt lgkmcnt(4)
M v[156:159],a[164:167],a[92:95],v[156:159]
SA m0,s23,0
T a[144:145],v3,16384
T a[146:147],v3,17408
M v[156:159],a[160:163],a[88:91],v[156:159]
buffer_load_dwordx4 v8, s[16:19], s21 offen offset:0  nt lds
M v[160:163],a[168:171],a[32:35],v[160:163]
R a[160:163],v5,53248
R a[164:167],v6,53248
M v[160:163],a[172:175],a[36:39],v[160:163]
buffer_load_dword a240, v26, s[60:63], s27 offen offset:0
M v[164:167],a[172:175],a[44:47],v[164:167]
SA s27,s27,2048
M v[164:167],a[168:171],a[40:43],v[164:167]
M v[168:171],a[168:171],a[48:51],v[168:171]
M v[168:171],a[172:175],a[52:55],v[168:171]
s_nop 0
T a[148:149],v3,24576
T a[150:151],v3,25600
M v[172:175],a[172:175],a[60:63],v[172:175]
buffer_load_dwordx4 v9, s[16:19], s21 offen offset:1024  nt lds
L_w_kv11:
s_cbranch_execz L_w_kv15
M v[172:175],a[168:171],a[56:59],v[172:175]
M v[176:179],a[168:171],a[64:67],v[176:179]
M v[176:179],a[172:175],a[68:71],v[176:179]
M v[180:183],a[172:175],a[76:79],v[180:183]
M v[180:183],a[168:171],a[72:75],v[180:183]
M v[184:187],a[168:171],a[80:83],v[184:187]
s_nop 0
T a[152:153],v4,16384
T a[154:155],v4,17408
M v[184:187],a[172:175],a[84:87],v[184:187]
s_waitcnt lgkmcnt(4)
buffer_load_dwordx4 v10, s[16:19], s21 offen offset:2048  nt lds
M v[188:191],a[172:175],a[92:95],v[188:191]
M v[188:191],a[168:171],a[88:91],v[188:191]
M v[192:195],a[160:163],a[32:35],v[192:195]
R a[168:171],v5,55296
R a[172:175],v6,55296
M v[192:195],a[164:167],a[36:39],v[192:195]
M v[196:199],a[164:167],a[44:47],v[196:199]
M v[196:199],a[160:163],a[40:43],v[196:199]
s_nop 0
T a[156:157],v4,24576
T a[158:159],v4,25600
M v[200:203],a[160:163],a[48:51],v[200:203]
buffer_load_dwordx4 v11, s[16:19], s21 offen offset:3072  nt lds
M v[200:203],a[164:167],a[52:55],v[200:203]
SA s21,s21,128
M v[204:207],a[164:167],a[60:63],v[204:207]
M v[204:207],a[160:163],a[56:59],v[204:207]
M v[208:211],a[160:163],a[64:67],v[208:211]
M v[208:211],a[164:167],a[68:71],v[208:211]
M v[212:215],a[164:167],a[76:79],v[212:215]
M v[212:215],a[160:163],a[72:75],v[212:215]
M v[216:219],a[160:163],a[80:83],v[216:219]
M v[216:219],a[164:167],a[84:87],v[216:219]
s_waitcnt lgkmcnt(2)
M v[220:223],a[164:167],a[92:95],v[220:223]
s_waitcnt vmcnt(17) lgkmcnt(0)
M v[220:223],a[160:163],a[88:91],v[220:223]
s_barrier
M v[224:227],a[168:171],a[32:35],v[224:227]
R a[160:163],v5,0
R a[164:167],v6,0
M v[224:227],a[172:175],a[36:39],v[224:227]
M v[228:231],a[172:175],a[44:47],v[228:231]
M v[228:231],a[168:171],a[40:43],v[228:231]
M v[232:235],a[168:171],a[48:51],v[232:235]
M v[232:235],a[172:175],a[52:55],v[232:235]
M v[236:239],a[172:175],a[60:63],v[236:239]
M v[236:239],a[168:171],a[56:59],v[236:239]
M v[240:243],a[168:171],a[64:67],v[240:243]
M v[240:243],a[172:175],a[68:71],v[240:243]
M v[244:247],a[172:175],a[76:79],v[244:247]
M v[244:247],a[168:171],a[72:75],v[244:247]
M v[248:251],a[168:171],a[80:83],v[248:251]
M v[248:251],a[172:175],a[84:87],v[248:251]
s_waitcnt lgkmcnt(0)
M v[252:255],a[172:175],a[92:95],v[252:255]
M v[252:255],a[168:171],a[88:91],v[252:255]
M a[0:3],a[160:163],a[96:99],a[0:3]
R a[168:171],v5,2048
R a[172:175],v6,2048
M a[0:3],a[164:167],a[100:103],a[0:3]
T a[32:33],v1,32768
T a[34:35],v1,33792
M a[4:7],a[164:167],a[108:111],a[4:7]
SA m0,s24,49152
M a[4:7],a[160:163],a[104:107],a[4:7]
buffer_load_dwordx4 v12, s[48:51], s22 offen offset:0   lds
M a[8:11],a[160:163],a[112:115],a[8:11]
v_and_b32 v20, 31, v0
M a[8:11],a[164:167],a[116:119],a[8:11]
v_lshlrev_b32 v20, 2, v20
M a[12:15],a[164:167],a[124:127],a[12:15]
s_nop 0
T a[36:37],v1,40960
T a[38:39],v1,41984
M a[12:15],a[160:163],a[120:123],a[12:15]
v_add_u32 v21, 163584, v20
M a[16:19],a[160:163],a[128:131],a[16:19]
buffer_load_dwordx4 v13, s[48:51], s22 offen offset:1024   lds
M a[16:19],a[164:167],a[132:135],a[16:19]
ds_read_b32 v19, v21
M a[20:23],a[164:167],a[140:143],a[20:23]
ds_read_b32 v21, v21 offset:64
M a[20:23],a[160:163],a[136:139],a[20:23]
s_min_u32 s64, s20, 1
T a[40:41],v2,32768
T a[42:43],v2,33792
M a[24:27],a[160:163],a[144:147],a[24:27]
s_lshl_b32 s64, s64, 29
v_and_b32 v22, 32, v0
M a[24:27],a[164:167],a[148:151],a[24:27]
s_waitcnt lgkmcnt(8)
buffer_load_dwordx4 v14, s[48:51], s22 offen offset:2048   lds
M a[28:31],a[164:167],a[156:159],a[28:31]
v_lshl_or_b32 v20, v22, 24, v20
M a[28:31],a[160:163],a[152:155],a[28:31]
v_or_b32 v20, s64, v20
M v[32:35],a[168:171],a[96:99],v[32:35]
R a[160:163],v5,4096
R a[164:167],v6,4096
M v[32:35],a[172:175],a[100:103],v[32:35]
T a[44:45],v2,40960
T a[46:47],v2,41984
M v[36:39],a[172:175],a[108:111],v[36:39]
buffer_load_dwordx4 v15, s[48:51], s22 offen offset:3072   lds
M v[36:39],a[168:171],a[104:107],v[36:39]
s_sub_u32 s22, s22, 1048448
v_and_b32 v22, 16, v0
M v[40:43],a[168:171],a[112:115],v[40:43]
v_lshl_or_b32 v18, v22, 25, v20
M v[40:43],a[172:175],a[116:119],v[40:43]
s_lshl_b32 s72, s30, 7
T a[48:49],v3,32768
T a[50:51],v3,33792
M v[44:47],a[172:175],a[124:127],v[44:47]
SA m0,s23,16384
SA s72,s72,104857600
M v[44:47],a[168:171],a[120:123],v[44:47]
buffer_load_dwordx4 v8, s[16:19], s21 offen offset:0  nt lds
M v[48:51],a[168:171],a[128:131],v[48:51]
M v[48:51],a[172:175],a[132:135],v[48:51]
M v[52:55],a[172:175],a[140:143],v[52:55]
s_nop 0
T a[52:53],v3,40960
T a[54:55],v3,41984
M v[52:55],a[168:171],a[136:139],v[52:55]
M v[56:59],a[168:171],a[144:147],v[56:59]
buffer_load_dwordx4 v9, s[16:19], s21 offen offset:1024  nt lds
M v[56:59],a[172:175],a[148:151],v[56:59]
s_waitcnt lgkmcnt(6)
buffer_store_dword v21, v20, s[8:11], s72 offen sc1
M v[60:63],a[172:175],a[156:159],v[60:63]
M v[60:63],a[168:171],a[152:155],v[60:63]
s_nop 0
T a[56:57],v4,32768
T a[58:59],v4,33792
M v[64:67],a[160:163],a[96:99],v[64:67]
R a[168:171],v5,6144
R a[172:175],v6,6144
M v[64:67],a[164:167],a[100:103],v[64:67]
buffer_load_dwordx4 v10, s[16:19], s21 offen offset:2048  nt lds
M v[68:71],a[164:167],a[108:111],v[68:71]
M v[68:71],a[160:163],a[104:107],v[68:71]
M v[72:75],a[160:163],a[112:115],v[72:75]
s_nop 0
T a[60:61],v4,40960
T a[62:63],v4,41984
M v[72:75],a[164:167],a[116:119],v[72:75]
M v[76:79],a[164:167],a[124:127],v[76:79]
buffer_load_dwordx4 v11, s[16:19], s21 offen offset:3072  nt lds
M v[76:79],a[160:163],a[120:123],v[76:79]
SA s21,s21,524160
M v[80:83],a[160:163],a[128:131],v[80:83]
M v[80:83],a[164:167],a[132:135],v[80:83]
M v[84:87],a[164:167],a[140:143],v[84:87]
M v[84:87],a[160:163],a[136:139],v[84:87]
M v[88:91],a[160:163],a[144:147],v[88:91]
M v[88:91],a[164:167],a[148:151],v[88:91]
s_waitcnt lgkmcnt(2)
M v[92:95],a[164:167],a[156:159],v[92:95]
s_waitcnt vmcnt(18) lgkmcnt(0)
M v[92:95],a[160:163],a[152:155],v[92:95]
s_barrier
M v[96:99],a[168:171],a[96:99],v[96:99]
R a[160:163],v5,16384
R a[164:167],v6,16384
M v[96:99],a[172:175],a[100:103],v[96:99]
M v[100:103],a[172:175],a[108:111],v[100:103]
SA m0,s24,0
T a[64:65],v1,49152
T a[66:67],v1,50176
M v[100:103],a[168:171],a[104:107],v[100:103]
buffer_load_dwordx4 v12, s[48:51], s22 offen offset:0   lds
M v[104:107],a[168:171],a[112:115],v[104:107]
M v[104:107],a[172:175],a[116:119],v[104:107]
M v[108:111],a[172:175],a[124:127],v[108:111]
M v[108:111],a[168:171],a[120:123],v[108:111]
M v[112:115],a[168:171],a[128:131],v[112:115]
M v[112:115],a[172:175],a[132:135],v[112:115]
s_nop 0
T a[68:69],v1,57344
T a[70:71],v1,58368
M v[116:119],a[172:175],a[140:143],v[116:119]
buffer_load_dwordx4 v13, s[48:51], s22 offen offset:1024   lds
M v[116:119],a[168:171],a[136:139],v[116:119]
M v[120:123],a[168:171],a[144:147],v[120:123]
M v[120:123],a[172:175],a[148:151],v[120:123]
s_waitcnt lgkmcnt(4)
M v[124:127],a[172:175],a[156:159],v[124:127]
M v[124:127],a[168:171],a[152:155],v[124:127]
M v[128:131],a[160:163],a[96:99],v[128:131]
R a[168:171],v5,18432
R a[172:175],v6,18432
M v[128:131],a[164:167],a[100:103],v[128:131]
T a[72:73],v2,49152
T a[74:75],v2,50176
M v[132:135],a[164:167],a[108:111],v[132:135]
buffer_load_dwordx4 v14, s[48:51], s22 offen offset:2048   lds
M v[132:135],a[160:163],a[104:107],v[132:135]
M v[136:139],a[160:163],a[112:115],v[136:139]
M v[136:139],a[164:167],a[116:119],v[136:139]
M v[140:143],a[164:167],a[124:127],v[140:143]
M v[140:143],a[160:163],a[120:123],v[140:143]
s_nop 0
T a[76:77],v2,57344
T a[78:79],v2,58368
M v[144:147],a[160:163],a[128:131],v[144:147]
buffer_load_dwordx4 v15, s[48:51], s22 offen offset:3072   lds
M v[144:147],a[164:167],a[132:135],v[144:147]
SA s22,s22,1048576
M v[148:151],a[164:167],a[140:143],v[148:151]
M v[148:151],a[160:163],a[136:139],v[148:151]
M v[152:155],a[160:163],a[144:147],v[152:155]
M v[152:155],a[164:167],a[148:151],v[152:155]
s_waitcnt lgkmcnt(4)
M v[156:159],a[164:167],a[156:159],v[156:159]
SA m0,s23,32768
T a[80:81],v3,49152
T a[82:83],v3,50176
M v[156:159],a[160:163],a[152:155],v[156:159]
buffer_load_dwordx4 v8, s[16:19], s21 offen offset:0  nt lds
M v[160:163],a[168:171],a[96:99],v[160:163]
R a[160:163],v5,20480
R a[164:167],v6,20480
M v[160:163],a[172:175],a[100:103],v[160:163]
buffer_load_dword a240, v26, s[60:63], s27 offen offset:0
M v[164:167],a[172:175],a[108:111],v[164:167]
SA s27,s27,2048
M v[164:167],a[168:171],a[104:107],v[164:167]
M v[168:171],a[168:171],a[112:115],v[168:171]
M v[168:171],a[172:175],a[116:119],v[168:171]
s_nop 0
T a[84:85],v3,57344
T a[86:87],v3,58368
M v[172:175],a[172:175],a[124:127],v[172:175]
buffer_load_dwordx4 v9, s[16:19], s21 offen offset:1024  nt lds
M v[172:175],a[168:171],a[120:123],v[172:175]
M v[176:179],a[168:171],a[128:131],v[176:179]
M v[176:179],a[172:175],a[132:135],v[176:179]
M v[180:183],a[172:175],a[140:143],v[180:183]
M v[180:183],a[168:171],a[136:139],v[180:183]
M v[184:187],a[168:171],a[144:147],v[184:187]
s_nop 0
T a[88:89],v4,49152
T a[90:91],v4,50176
M v[184:187],a[172:175],a[148:151],v[184:187]
s_waitcnt lgkmcnt(4)
buffer_load_dwordx4 v10, s[16:19], s21 offen offset:2048  nt lds
M v[188:191],a[172:175],a[156:159],v[188:191]
M v[188:191],a[168:171],a[152:155],v[188:191]
M v[192:195],a[160:163],a[96:99],v[192:195]
R a[168:171],v5,22528
R a[172:175],v6,22528
M v[192:195],a[164:167],a[100:103],v[192:195]
M v[196:199],a[164:167],a[108:111],v[196:199]
M v[196:199],a[160:163],a[104:107],v[196:199]
s_nop 0
T a[92:93],v4,57344
T a[94:95],v4,58368
M v[200:203],a[160:163],a[112:115],v[200:203]
buffer_load_dwordx4 v11, s[16:19], s21 offen offset:3072  nt lds
M v[200:203],a[164:167],a[116:119],v[200:203]
SA s21,s21,128
M v[204:207],a[164:167],a[124:127],v[204:207]
M v[204:207],a[160:163],a[120:123],v[204:207]
M v[208:211],a[160:163],a[128:131],v[208:211]
M v[208:211],a[164:167],a[132:135],v[208:211]
M v[212:215],a[164:167],a[140:143],v[212:215]
M v[212:215],a[160:163],a[136:139],v[212:215]
M v[216:219],a[160:163],a[144:147],v[216:219]
M v[216:219],a[164:167],a[148:151],v[216:219]
s_waitcnt lgkmcnt(2)
M v[220:223],a[164:167],a[156:159],v[220:223]
s_waitcnt vmcnt(18) lgkmcnt(0)
M v[220:223],a[160:163],a[152:155],v[220:223]
s_barrier
M v[224:227],a[168:171],a[96:99],v[224:227]
R a[160:163],v5,32768
R a[164:167],v6,32768
M v[224:227],a[172:175],a[100:103],v[224:227]
M v[228:231],a[172:175],a[108:111],v[228:231]
M v[228:231],a[168:171],a[104:107],v[228:231]
M v[232:235],a[168:171],a[112:115],v[232:235]
M v[232:235],a[172:175],a[116:119],v[232:235]
M v[236:239],a[172:175],a[124:127],v[236:239]
M v[236:239],a[168:171],a[120:123],v[236:239]
M v[240:243],a[168:171],a[128:131],v[240:243]
M v[240:243],a[172:175],a[132:135],v[240:243]
M v[244:247],a[172:175],a[140:143],v[244:247]
M v[244:247],a[168:171],a[136:139],v[244:247]
M v[248:251],a[168:171],a[144:147],v[248:251]
M v[248:251],a[172:175],a[148:151],v[248:251]
s_waitcnt lgkmcnt(0)
M v[252:255],a[172:175],a[156:159],v[252:255]
M v[252:255],a[168:171],a[152:155],v[252:255]
M a[0:3],a[160:163],a[32:35],a[0:3]
R a[168:171],v5,34816
R a[172:175],v6,34816
M a[0:3],a[164:167],a[36:39],a[0:3]
T a[96:97],v1,0
T a[98:99],v1,1024
M a[4:7],a[164:167],a[44:47],a[4:7]
SA m0,s24,16384
M a[4:7],a[160:163],a[40:43],a[4:7]
buffer_load_dwordx4 v12, s[48:51], s22 offen offset:0   lds
M a[8:11],a[160:163],a[48:51],a[8:11]
M a[8:11],a[164:167],a[52:55],a[8:11]
M a[12:15],a[164:167],a[60:63],a[12:15]
s_nop 0
T a[100:101],v1,8192
T a[102:103],v1,9216
M a[12:15],a[160:163],a[56:59],a[12:15]
M a[16:19],a[160:163],a[64:67],a[16:19]
buffer_load_dwordx4 v13, s[48:51], s22 offen offset:1024   lds
M a[16:19],a[164:167],a[68:71],a[16:19]
M a[20:23],a[164:167],a[76:79],a[20:23]
M a[20:23],a[160:163],a[72:75],a[20:23]
s_nop 0
T a[104:105],v2,0
T a[106:107],v2,1024
M a[24:27],a[160:163],a[80:83],a[24:27]
M a[24:27],a[164:167],a[84:87],a[24:27]
s_waitcnt lgkmcnt(6)
buffer_load_dwordx4 v14, s[48:51], s22 offen offset:2048   lds
M a[28:31],a[164:167],a[92:95],a[28:31]
M a[28:31],a[160:163],a[88:91],a[28:31]
M v[32:35],a[168:171],a[32:35],v[32:35]
R a[160:163],v5,36864
R a[164:167],v6,36864
M v[32:35],a[172:175],a[36:39],v[32:35]
T a[108:109],v2,8192
T a[110:111],v2,9216
M v[36:39],a[172:175],a[44:47],v[36:39]
buffer_load_dwordx4 v15, s[48:51], s22 offen offset:3072   lds
M v[36:39],a[168:171],a[40:43],v[36:39]
s_sub_u32 s22, s22, 1048448
M v[40:43],a[168:171],a[48:51],v[40:43]
M v[40:43],a[172:175],a[52:55],v[40:43]
s_nop 0
T a[112:113],v3,0
T a[114:115],v3,1024
M v[44:47],a[172:175],a[60:63],v[44:47]
SA m0,s23,49152
M v[44:47],a[168:171],a[56:59],v[44:47]
buffer_load_dwordx4 v8, s[16:19], s21 offen offset:0  nt lds
M v[48:51],a[168:171],a[64:67],v[48:51]
M v[48:51],a[172:175],a[68:71],v[48:51]
M v[52:55],a[172:175],a[76:79],v[52:55]
s_nop 0
T a[116:117],v3,8192
T a[118:119],v3,9216
M v[52:55],a[168:171],a[72:75],v[52:55]
M v[56:59],a[168:171],a[80:83],v[56:59]
buffer_load_dwordx4 v9, s[16:19], s21 offen offset:1024  nt lds
M v[56:59],a[172:175],a[84:87],v[56:59]
s_waitcnt lgkmcnt(6)
M v[60:63],a[172:175],a[92:95],v[60:63]
M v[60:63],a[168:171],a[88:91],v[60:63]
s_nop 0
T a[120:121],v4,0
T a[122:123],v4,1024
M v[64:67],a[160:163],a[32:35],v[64:67]
R a[168:171],v5,38912
R a[172:175],v6,38912
M v[64:67],a[164:167],a[36:39],v[64:67]
buffer_load_dwordx4 v10, s[16:19], s21 offen offset:2048  nt lds
M v[68:71],a[164:167],a[44:47],v[68:71]
M v[68:71],a[160:163],a[40:43],v[68:71]
M v[72:75],a[160:163],a[48:51],v[72:75]
s_nop 0
T a[124:125],v4,8192
T a[126:127],v4,9216
M v[72:75],a[164:167],a[52:55],v[72:75]
M v[76:79],a[164:167],a[60:63],v[76:79]
buffer_load_dwordx4 v11, s[16:19], s21 offen offset:3072  nt lds
M v[76:79],a[160:163],a[56:59],v[76:79]
SA s21,s21,524160
M v[80:83],a[160:163],a[64:67],v[80:83]
M v[80:83],a[164:167],a[68:71],v[80:83]
M v[84:87],a[164:167],a[76:79],v[84:87]
M v[84:87],a[160:163],a[72:75],v[84:87]
M v[88:91],a[160:163],a[80:83],v[88:91]
M v[88:91],a[164:167],a[84:87],v[88:91]
s_waitcnt lgkmcnt(2)
M v[92:95],a[164:167],a[92:95],v[92:95]
s_waitcnt vmcnt(17) lgkmcnt(0)
M v[92:95],a[160:163],a[88:91],v[92:95]
s_barrier
M v[96:99],a[168:171],a[32:35],v[96:99]
R a[160:163],v5,49152
R a[164:167],v6,49152
M v[96:99],a[172:175],a[36:39],v[96:99]
M v[100:103],a[172:175],a[44:47],v[100:103]
SA m0,s24,32768
T a[128:129],v1,16384
T a[130:131],v1,17408
M v[100:103],a[168:171],a[40:43],v[100:103]
buffer_load_dwordx4 v12, s[48:51], s22 offen offset:0   lds
M v[104:107],a[168:171],a[48:51],v[104:107]
v_min_u32 v16, 40, v0
v_lshlrev_b32 v16, 2, v16
M v[104:107],a[172:175],a[52:55],v[104:107]
buffer_load_dword v17, v16, s[12:15], 0 offen sc1
M v[108:111],a[172:175],a[60:63],v[108:111]
M v[108:111],a[168:171],a[56:59],v[108:111]
M v[112:115],a[168:171],a[64:67],v[112:115]
M v[112:115],a[172:175],a[68:71],v[112:115]
s_nop 0
T a[132:133],v1,24576
T a[134:135],v1,25600
M v[116:119],a[172:175],a[76:79],v[116:119]
buffer_load_dwordx4 v13, s[48:51], s22 offen offset:1024   lds
M v[116:119],a[168:171],a[72:75],v[116:119]
M v[120:123],a[168:171],a[80:83],v[120:123]
M v[120:123],a[172:175],a[84:87],v[120:123]
s_waitcnt lgkmcnt(4)
M v[124:127],a[172:175],a[92:95],v[124:127]
M v[124:127],a[168:171],a[88:91],v[124:127]
M v[128:131],a[160:163],a[32:35],v[128:131]
R a[168:171],v5,51200
R a[172:175],v6,51200
M v[128:131],a[164:167],a[36:39],v[128:131]
T a[136:137],v2,16384
T a[138:139],v2,17408
M v[132:135],a[164:167],a[44:47],v[132:135]
buffer_load_dwordx4 v14, s[48:51], s22 offen offset:2048   lds
M v[132:135],a[160:163],a[40:43],v[132:135]
M v[136:139],a[160:163],a[48:51],v[136:139]
M v[136:139],a[164:167],a[52:55],v[136:139]
M v[140:143],a[164:167],a[60:63],v[140:143]
M v[140:143],a[160:163],a[56:59],v[140:143]
s_nop 0
T a[140:141],v2,24576
T a[142:143],v2,25600
M v[144:147],a[160:163],a[64:67],v[144:147]
buffer_load_dwordx4 v15, s[48:51], s22 offen offset:3072   lds
M v[144:147],a[164:167],a[68:71],v[144:147]
SA s22,s22,1048576
M v[148:151],a[164:167],a[76:79],v[148:151]
M v[148:151],a[160:163],a[72:75],v[148:151]
M v[152:155],a[160:163],a[80:83],v[152:155]
M v[152:155],a[164:167],a[84:87],v[152:155]
s_waitcnt lgkmcnt(4)
M v[156:159],a[164:167],a[92:95],v[156:159]
SA m0,s23,0
T a[144:145],v3,16384
T a[146:147],v3,17408
M v[156:159],a[160:163],a[88:91],v[156:159]
buffer_load_dwordx4 v8, s[16:19], s21 offen offset:0  nt lds
M v[160:163],a[168:171],a[32:35],v[160:163]
R a[160:163],v5,53248
R a[164:167],v6,53248
M v[160:163],a[172:175],a[36:39],v[160:163]
buffer_load_dword a240, v26, s[60:63], s27 offen offset:0
M v[164:167],a[172:175],a[44:47],v[164:167]
SA s27,s27,2048
M v[164:167],a[168:171],a[40:43],v[164:167]
M v[168:171],a[168:171],a[48:51],v[168:171]
M v[168:171],a[172:175],a[52:55],v[168:171]
s_nop 0
T a[148:149],v3,24576
T a[150:151],v3,25600
M v[172:175],a[172:175],a[60:63],v[172:175]
buffer_load_dwordx4 v9, s[16:19], s21 offen offset:1024  nt lds
M v[172:175],a[168:171],a[56:59],v[172:175]
M v[176:179],a[168:171],a[64:67],v[176:179]
M v[176:179],a[172:175],a[68:71],v[176:179]
M v[180:183],a[172:175],a[76:79],v[180:183]
M v[180:183],a[168:171],a[72:75],v[180:183]
M v[184:187],a[168:171],a[80:83],v[184:187]
s_nop 0
T a[152:153],v4,16384
T a[154:155],v4,17408
M v[184:187],a[172:175],a[84:87],v[184:187]
s_waitcnt lgkmcnt(4)
buffer_load_dwordx4 v10, s[16:19], s21 offen offset:2048  nt lds
M v[188:191],a[172:175],a[92:95],v[188:191]
M v[188:191],a[168:171],a[88:91],v[188:191]
M v[192:195],a[160:163],a[32:35],v[192:195]
R a[168:171],v5,55296
R a[172:175],v6,55296
M v[192:195],a[164:167],a[36:39],v[192:195]
M v[196:199],a[164:167],a[44:47],v[196:199]
M v[196:199],a[160:163],a[40:43],v[196:199]
s_nop 0
T a[156:157],v4,24576
T a[158:159],v4,25600
M v[200:203],a[160:163],a[48:51],v[200:203]
buffer_load_dwordx4 v11, s[16:19], s21 offen offset:3072  nt lds
M v[200:203],a[164:167],a[52:55],v[200:203]
SA s21,s21,128
M v[204:207],a[164:167],a[60:63],v[204:207]
M v[204:207],a[160:163],a[56:59],v[204:207]
M v[208:211],a[160:163],a[64:67],v[208:211]
M v[208:211],a[164:167],a[68:71],v[208:211]
M v[212:215],a[164:167],a[76:79],v[212:215]
M v[212:215],a[160:163],a[72:75],v[212:215]
M v[216:219],a[160:163],a[80:83],v[216:219]
M v[216:219],a[164:167],a[84:87],v[216:219]
s_waitcnt lgkmcnt(2)
M v[220:223],a[164:167],a[92:95],v[220:223]
s_waitcnt vmcnt(18) lgkmcnt(0)
M v[220:223],a[160:163],a[88:91],v[220:223]
s_barrier
M v[224:227],a[168:171],a[32:35],v[224:227]
R a[160:163],v5,0
R a[164:167],v6,0
M v[224:227],a[172:175],a[36:39],v[224:227]
M v[228:231],a[172:175],a[44:47],v[228:231]
M v[228:231],a[168:171],a[40:43],v[228:231]
M v[232:235],a[168:171],a[48:51],v[232:235]
M v[232:235],a[172:175],a[52:55],v[232:235]
M v[236:239],a[172:175],a[60:63],v[236:239]
M v[236:239],a[168:171],a[56:59],v[236:239]
M v[240:243],a[168:171],a[64:67],v[240:243]
M v[240:243],a[172:175],a[68:71],v[240:243]
M v[244:247],a[172:175],a[76:79],v[244:247]
M v[244:247],a[168:171],a[72:75],v[244:247]
M v[248:251],a[168:171],a[80:83],v[248:251]
M v[248:251],a[172:175],a[84:87],v[248:251]
s_waitcnt lgkmcnt(0)
M v[252:255],a[172:175],a[92:95],v[252:255]
M v[252:255],a[168:171],a[88:91],v[252:255]
M a[0:3],a[160:163],a[96:99],a[0:3]
R a[168:171],v5,2048
R a[172:175],v6,2048
M a[0:3],a[164:167],a[100:103],a[0:3]
T a[32:33],v1,32768
T a[34:35],v1,33792
M a[4:7],a[164:167],a[108:111],a[4:7]
SA m0,s24,49152
M a[4:7],a[160:163],a[104:107],a[4:7]
buffer_load_dwordx4 v12, s[48:51], s22 offen offset:0   lds
M a[8:11],a[160:163],a[112:115],a[8:11]
M a[8:11],a[164:167],a[116:119],a[8:11]
M a[12:15],a[164:167],a[124:127],a[12:15]
s_nop 0
T a[36:37],v1,40960
T a[38:39],v1,41984
M a[12:15],a[160:163],a[120:123],a[12:15]
M a[16:19],a[160:163],a[128:131],a[16:19]
L_w_kv12:
s_cbranch_execz L_w_kv16
buffer_load_dwordx4 v13, s[48:51], s22 offen offset:1024   lds
M a[16:19],a[164:167],a[132:135],a[16:19]
M a[20:23],a[164:167],a[140:143],a[20:23]
M a[20:23],a[160:163],a[136:139],a[20:23]
s_nop 0
T a[40:41],v2,32768
T a[42:43],v2,33792
M a[24:27],a[160:163],a[144:147],a[24:27]
M a[24:27],a[164:167],a[148:151],a[24:27]
s_waitcnt lgkmcnt(6)
buffer_load_dwordx4 v14, s[48:51], s22 offen offset:2048   lds
M a[28:31],a[164:167],a[156:159],a[28:31]
M a[28:31],a[160:163],a[152:155],a[28:31]
M v[32:35],a[168:171],a[96:99],v[32:35]
R a[160:163],v5,4096
R a[164:167],v6,4096
M v[32:35],a[172:175],a[100:103],v[32:35]
T a[44:45],v2,40960
T a[46:47],v2,41984
M v[36:39],a[172:175],a[108:111],v[36:39]
buffer_load_dwordx4 v15, s[48:51], s22 offen offset:3072   lds
M v[36:39],a[168:171],a[104:107],v[36:39]
s_sub_u32 s22, s22, 1048448
M v[40:43],a[168:171],a[112:115],v[40:43]
M v[40:43],a[172:175],a[116:119],v[40:43]
s_nop 0
T a[48:49],v3,32768
T a[50:51],v3,33792
M v[44:47],a[172:175],a[124:127],v[44:47]
SA m0,s23,16384
M v[44:47],a[168:171],a[120:123],v[44:47]
buffer_load_dwordx4 v8, s[16:19], s21 offen offset:0  nt lds
M v[48:51],a[168:171],a[128:131],v[48:51]
M v[48:51],a[172:175],a[132:135],v[48:51]
M v[52:55],a[172:175],a[140:143],v[52:55]
s_nop 0
T a[52:53],v3,40960
T a[54:55],v3,41984
M v[52:55],a[168:171],a[136:139],v[52:55]
M v[56:59],a[168:171],a[144:147],v[56:59]
buffer_load_dwordx4 v9, s[16:19], s21 offen offset:1024  nt lds
M v[56:59],a[172:175],a[148:151],v[56:59]
s_waitcnt lgkmcnt(6)
M v[60:63],a[172:175],a[156:159],v[60:63]
M v[60:63],a[168:171],a[152:155],v[60:63]
s_nop 0
T a[56:57],v4,32768
T a[58:59],v4,33792
M v[64:67],a[160:163],a[96:99],v[64:67]
R a[168:171],v5,6144
R a[172:175],v6,6144
M v[64:67],a[164:167],a[100:103],v[64:67]
buffer_load_dwordx4 v10, s[16:19], s21 offen offset:2048  nt lds
M v[68:71],a[164:167],a[108:111],v[68:71]
M v[68:71],a[160:163],a[104:107],v[68:71]
M v[72:75],a[160:163],a[112:115],v[72:75]
s_nop 0
T a[60:61],v4,40960
T a[62:63],v4,41984
M v[72:75],a[164:167],a[116:119],v[72:75]
M v[76:79],a[164:167],a[124:127],v[76:79]
buffer_load_dwordx4 v11, s[16:19], s21 offen offset:3072  nt lds
M v[76:79],a[160:163],a[120:123],v[76:79]
SA s21,s21,524160
M v[80:83],a[160:163],a[128:131],v[80:83]
M v[80:83],a[164:167],a[132:135],v[80:83]
M v[84:87],a[164:167],a[140:143],v[84:87]
M v[84:87],a[160:163],a[136:139],v[84:87]
M v[88:91],a[160:163],a[144:147],v[88:91]
M v[88:91],a[164:167],a[148:151],v[88:91]
s_waitcnt lgkmcnt(2)
M v[92:95],a[164:167],a[156:159],v[92:95]
s_waitcnt vmcnt(18) lgkmcnt(0)
M v[92:95],a[160:163],a[152:155],v[92:95]
s_barrier
M v[96:99],a[168:171],a[96:99],v[96:99]
R a[160:163],v5,16384
R a[164:167],v6,16384
M v[96:99],a[172:175],a[100:103],v[96:99]
M v[100:103],a[172:175],a[108:111],v[100:103]
SA m0,s24,0
T a[64:65],v1,49152
T a[66:67],v1,50176
M v[100:103],a[168:171],a[104:107],v[100:103]
buffer_load_dwordx4 v12, s[48:51], s22 offen offset:0   lds
M v[104:107],a[168:171],a[112:115],v[104:107]
M v[104:107],a[172:175],a[116:119],v[104:107]
M v[108:111],a[172:175],a[124:127],v[108:111]
M v[108:111],a[168:171],a[120:123],v[108:111]
M v[112:115],a[168:171],a[128:131],v[112:115]
M v[112:115],a[172:175],a[132:135],v[112:115]
s_nop 0
T a[68:69],v1,57344
T a[70:71],v1,58368
M v[116:119],a[172:175],a[140:143],v[116:119]
buffer_load_dwordx4 v13, s[48:51], s22 offen offset:1024   lds
M v[116:119],a[168:171],a[136:139],v[116:119]
M v[120:123],a[168:171],a[144:147],v[120:123]
M v[120:123],a[172:175],a[148:151],v[120:123]
s_waitcnt lgkmcnt(4)
M v[124:127],a[172:175],a[156:159],v[124:127]
M v[124:127],a[168:171],a[152:155],v[124:127]
M v[128:131],a[160:163],a[96:99],v[128:131]
R a[168:171],v5,18432
R a[172:175],v6,18432
M v[128:131],a[164:167],a[100:103],v[128:131]
T a[72:73],v2,49152
T a[74:75],v2,50176
M v[132:135],a[164:167],a[108:111],v[132:135]
buffer_load_dwordx4 v14, s[48:51], s22 offen offset:2048   lds
M v[132:135],a[160:163],a[104:107],v[132:135]
M v[136:139],a[160:163],a[112:115],v[136:139]
M v[136:139],a[164:167],a[116:119],v[136:139]
M v[140:143],a[164:167],a[124:127],v[140:143]
M v[140:143],a[160:163],a[120:123],v[140:143]
s_nop 0
T a[76:77],v2,57344
T a[78:79],v2,58368
M v[144:147],a[160:163],a[128:131],v[144:147]
buffer_load_dwordx4 v15, s[48:51], s22 offen offset:3072   lds
M v[144:147],a[164:167],a[132:135],v[144:147]
SA s22,s22,1048576
M v[148:151],a[164:167],a[140:143],v[148:151]
M v[148:151],a[160:163],a[136:139],v[148:151]
M v[152:155],a[160:163],a[144:147],v[152:155]
M v[152:155],a[164:167],a[148:151],v[152:155]
s_waitcnt lgkmcnt(4)
M v[156:159],a[164:167],a[156:159],v[156:159]
SA m0,s23,32768
T a[80:81],v3,49152
T a[82:83],v3,50176
M v[156:159],a[160:163],a[152:155],v[156:159]
buffer_load_dwordx4 v8, s[16:19], s21 offen offset:0  nt lds
M v[160:163],a[168:171],a[96:99],v[160:163]
R a[160:163],v5,20480
R a[164:167],v6,20480
M v[160:163],a[172:175],a[100:103],v[160:163]
buffer_load_dword a240, v26, s[60:63], s27 offen offset:0
M v[164:167],a[172:175],a[108:111],v[164:167]
SA s27,s27,2048
M v[164:167],a[168:171],a[104:107],v[164:167]
M v[168:171],a[168:171],a[112:115],v[168:171]
M v[168:171],a[172:175],a[116:119],v[168:171]
s_nop 0
T a[84:85],v3,57344
T a[86:87],v3,58368
M v[172:175],a[172:175],a[124:127],v[172:175]
buffer_load_dwordx4 v9, s[16:19], s21 offen offset:1024  nt lds
M v[172:175],a[168:171],a[120:123],v[172:175]
M v[176:179],a[168:171],a[128:131],v[176:179]
M v[176:179],a[172:175],a[132:135],v[176:179]
M v[180:183],a[172:175],a[140:143],v[180:183]
M v[180:183],a[168:171],a[136:139],v[180:183]
M v[184:187],a[168:171],a[144:147],v[184:187]
s_nop 0
T a[88:89],v4,49152
T a[90:91],v4,50176
M v[184:187],a[172:175],a[148:151],v[184:187]
s_waitcnt lgkmcnt(4)
buffer_load_dwordx4 v10, s[16:19], s21 offen offset:2048  nt lds
M v[188:191],a[172:175],a[156:159],v[188:191]
M v[188:191],a[168:171],a[152:155],v[188:191]
M v[192:195],a[160:163],a[96:99],v[192:195]
R a[168:171],v5,22528
R a[172:175],v6,22528
M v[192:195],a[164:167],a[100:103],v[192:195]
M v[196:199],a[164:167],a[108:111],v[196:199]
M v[196:199],a[160:163],a[104:107],v[196:199]
s_nop 0
T a[92:93],v4,57344
T a[94:95],v4,58368
M v[200:203],a[160:163],a[112:115],v[200:203]
buffer_load_dwordx4 v11, s[16:19], s21 offen offset:3072  nt lds
M v[200:203],a[164:167],a[116:119],v[200:203]
SA s21,s21,128
M v[204:207],a[164:167],a[124:127],v[204:207]
M v[204:207],a[160:163],a[120:123],v[204:207]
M v[208:211],a[160:163],a[128:131],v[208:211]
M v[208:211],a[164:167],a[132:135],v[208:211]
M v[212:215],a[164:167],a[140:143],v[212:215]
M v[212:215],a[160:163],a[136:139],v[212:215]
M v[216:219],a[160:163],a[144:147],v[216:219]
M v[216:219],a[164:167],a[148:151],v[216:219]
s_waitcnt lgkmcnt(2)
M v[220:223],a[164:167],a[156:159],v[220:223]
s_waitcnt vmcnt(17) lgkmcnt(0)
M v[220:223],a[160:163],a[152:155],v[220:223]
s_barrier
M v[224:227],a[168:171],a[96:99],v[224:227]
R a[160:163],v5,32768
R a[164:167],v6,32768
M v[224:227],a[172:175],a[100:103],v[224:227]
v_cmp_ne_u32 vcc, 1, v17
M v[228:231],a[172:175],a[108:111],v[228:231]
s_nop 0
M v[228:231],a[168:171],a[104:107],v[228:231]
s_cbranch_vccnz L_zs1
L_zr1:
M v[232:235],a[168:171],a[112:115],v[232:235]
M v[232:235],a[172:175],a[116:119],v[232:235]
s_lshl_b32 s72, s30, 6
M v[236:239],a[172:175],a[124:127],v[236:239]
SA s72,s72,104914944
M v[236:239],a[168:171],a[120:123],v[236:239]
buffer_store_dword v19, v18, s[8:11], s72 offen sc1
M v[240:243],a[168:171],a[128:131],v[240:243]
M v[240:243],a[172:175],a[132:135],v[240:243]
M v[244:247],a[172:175],a[140:143],v[244:247]
M v[244:247],a[168:171],a[136:139],v[244:247]
M v[248:251],a[168:171],a[144:147],v[248:251]
M v[248:251],a[172:175],a[148:151],v[248:251]
s_waitcnt lgkmcnt(0)
M v[252:255],a[172:175],a[156:159],v[252:255]
M v[252:255],a[168:171],a[152:155],v[252:255]
M a[0:3],a[160:163],a[32:35],a[0:3]
R a[168:171],v5,34816
R a[172:175],v6,34816
M a[0:3],a[164:167],a[36:39],a[0:3]
T a[96:97],v1,0
T a[98:99],v1,1024
M a[4:7],a[164:167],a[44:47],a[4:7]
SA m0,s24,16384
M a[4:7],a[160:163],a[40:43],a[4:7]
buffer_load_dwordx4 v12, s[48:51], s22 offen offset:0   lds
M a[8:11],a[160:163],a[48:51],a[8:11]
M a[8:11],a[164:167],a[52:55],a[8:11]
s_mul_i32 s64, s41, 229376
M a[12:15],a[164:167],a[60:63],a[12:15]
SA s72,s90,s64
T a[100:101],v1,8192
T a[102:103],v1,9216
M a[12:15],a[160:163],a[56:59],a[12:15]
s_addc_u32 s73, s91, 0
M a[16:19],a[160:163],a[64:67],a[16:19]
s_sub_u32 s75, 3670016, s64
buffer_load_dwordx4 v13, s[48:51], s22 offen offset:1024   lds
M a[16:19],a[164:167],a[68:71],a[16:19]
s_mov_b32 s12, s72
M a[20:23],a[164:167],a[76:79],a[20:23]
s_and_b32 s13, s73, 0xffff
M a[20:23],a[160:163],a[72:75],a[20:23]
s_mov_b32 s14, s75
T a[104:105],v2,0
T a[106:107],v2,1024
M a[24:27],a[160:163],a[80:83],a[24:27]
s_mov_b32 s15, 0x20000
M a[24:27],a[164:167],a[84:87],a[24:27]
s_waitcnt lgkmcnt(6)
buffer_load_dwordx4 v14, s[48:51], s22 offen offset:2048   lds
M a[28:31],a[164:167],a[92:95],a[28:31]
M a[28:31],a[160:163],a[88:91],a[28:31]
M v[32:35],a[168:171],a[32:35],v[32:35]
R a[160:163],v5,36864
R a[164:167],v6,36864
M v[32:35],a[172:175],a[36:39],v[32:35]
T a[108:109],v2,8192
T a[110:111],v2,9216
M v[36:39],a[172:175],a[44:47],v[36:39]
buffer_load_dwordx4 v15, s[48:51], s22 offen offset:3072   lds
M v[36:39],a[168:171],a[40:43],v[36:39]
s_sub_u32 s22, s22, 1048448
M v[40:43],a[168:171],a[48:51],v[40:43]
M v[40:43],a[172:175],a[52:55],v[40:43]
s_nop 0
T a[112:113],v3,0
T a[114:115],v3,1024
M v[44:47],a[172:175],a[60:63],v[44:47]
SA m0,s23,49152
M v[44:47],a[168:171],a[56:59],v[44:47]
buffer_load_dwordx4 v8, s[16:19], s21 offen offset:0  nt lds
M v[48:51],a[168:171],a[64:67],v[48:51]
M v[48:51],a[172:175],a[68:71],v[48:51]
M v[52:55],a[172:175],a[76:79],v[52:55]
s_nop 0
T a[116:117],v3,8192
T a[118:119],v3,9216
M v[52:55],a[168:171],a[72:75],v[52:55]
M v[56:59],a[168:171],a[80:83],v[56:59]
buffer_load_dwordx4 v9, s[16:19], s21 offen offset:1024  nt lds
M v[56:59],a[172:175],a[84:87],v[56:59]
s_waitcnt lgkmcnt(6)
M v[60:63],a[172:175],a[92:95],v[60:63]
M v[60:63],a[168:171],a[88:91],v[60:63]
s_nop 0
T a[120:121],v4,0
T a[122:123],v4,1024
M v[64:67],a[160:163],a[32:35],v[64:67]
R a[168:171],v5,38912
R a[172:175],v6,38912
M v[64:67],a[164:167],a[36:39],v[64:67]
buffer_load_dwordx4 v10, s[16:19], s21 offen offset:2048  nt lds
M v[68:71],a[164:167],a[44:47],v[68:71]
M v[68:71],a[160:163],a[40:43],v[68:71]
M v[72:75],a[160:163],a[48:51],v[72:75]
s_nop 0
T a[124:125],v4,8192
T a[126:127],v4,9216
M v[72:75],a[164:167],a[52:55],v[72:75]
M v[76:79],a[164:167],a[60:63],v[76:79]
buffer_load_dwordx4 v11, s[16:19], s21 offen offset:3072  nt lds
M v[76:79],a[160:163],a[56:59],v[76:79]
SA s21,s21,524160
M v[80:83],a[160:163],a[64:67],v[80:83]
M v[80:83],a[164:167],a[68:71],v[80:83]
M v[84:87],a[164:167],a[76:79],v[84:87]
M v[84:87],a[160:163],a[72:75],v[84:87]
M v[88:91],a[160:163],a[80:83],v[88:91]
M v[88:91],a[164:167],a[84:87],v[88:91]
s_waitcnt lgkmcnt(2)
M v[92:95],a[164:167],a[92:95],v[92:95]
s_waitcnt vmcnt(18) lgkmcnt(0)
M v[92:95],a[160:163],a[88:91],v[92:95]
s_barrier
M v[96:99],a[168:171],a[32:35],v[96:99]
R a[160:163],v5,49152
R a[164:167],v6,49152
M v[96:99],a[172:175],a[36:39],v[96:99]
M v[100:103],a[172:175],a[44:47],v[100:103]
SA m0,s24,32768
T a[128:129],v1,16384
T a[130:131],v1,17408
M v[100:103],a[168:171],a[40:43],v[100:103]
buffer_load_dwordx4 v12, s[48:51], s22 offen offset:0   lds
M v[104:107],a[168:171],a[48:51],v[104:107]
M v[104:107],a[172:175],a[52:55],v[104:107]
M v[108:111],a[172:175],a[60:63],v[108:111]
M v[108:111],a[168:171],a[56:59],v[108:111]
M v[112:115],a[168:171],a[64:67],v[112:115]
M v[112:115],a[172:175],a[68:71],v[112:115]
s_nop 0
T a[132:133],v1,24576
T a[134:135],v1,25600
M v[116:119],a[172:175],a[76:79],v[116:119]
buffer_load_dwordx4 v13, s[48:51], s22 offen offset:1024   lds
M v[116:119],a[168:171],a[72:75],v[116:119]
M v[120:123],a[168:171],a[80:83],v[120:123]
M v[120:123],a[172:175],a[84:87],v[120:123]
s_waitcnt lgkmcnt(4)
M v[124:127],a[172:175],a[92:95],v[124:127]
M v[124:127],a[168:171],a[88:91],v[124:127]
M v[128:131],a[160:163],a[32:35],v[128:131]
R a[168:171],v5,51200
R a[172:175],v6,51200
M v[128:131],a[164:167],a[36:39],v[128:131]
T a[136:137],v2,16384
T a[138:139],v2,17408
M v[132:135],a[164:167],a[44:47],v[132:135]
buffer_load_dwordx4 v14, s[48:51], s22 offen offset:2048   lds
M v[132:135],a[160:163],a[40:43],v[132:135]
M v[136:139],a[160:163],a[48:51],v[136:139]
M v[136:139],a[164:167],a[52:55],v[136:139]
M v[140:143],a[164:167],a[60:63],v[140:143]
M v[140:143],a[160:163],a[56:59],v[140:143]
s_nop 0
T a[140:141],v2,24576
T a[142:143],v2,25600
M v[144:147],a[160:163],a[64:67],v[144:147]
buffer_load_dwordx4 v15, s[48:51], s22 offen offset:3072   lds
M v[144:147],a[164:167],a[68:71],v[144:147]
SA s22,s22,1048576
M v[148:151],a[164:167],a[76:79],v[148:151]
M v[148:151],a[160:163],a[72:75],v[148:151]
M v[152:155],a[160:163],a[80:83],v[152:155]
M v[152:155],a[164:167],a[84:87],v[152:155]
s_waitcnt lgkmcnt(4)
M v[156:159],a[164:167],a[92:95],v[156:159]
SA m0,s23,0
T a[144:145],v3,16384
T a[146:147],v3,17408
M v[156:159],a[160:163],a[88:91],v[156:159]
buffer_load_dwordx4 v8, s[16:19], s21 offen offset:0  nt lds
M v[160:163],a[168:171],a[32:35],v[160:163]
R a[160:163],v5,53248
R a[164:167],v6,53248
M v[160:163],a[172:175],a[36:39],v[160:163]
M v[164:167],a[172:175],a[44:47],v[164:167]
M v[164:167],a[168:171],a[40:43],v[164:167]
M v[168:171],a[168:171],a[48:51],v[168:171]
M v[168:171],a[172:175],a[52:55],v[168:171]
s_nop 0
T a[148:149],v3,24576
T a[150:151],v3,25600
M v[172:175],a[172:175],a[60:63],v[172:175]
buffer_load_dwordx4 v9, s[16:19], s21 offen offset:1024  nt lds
M v[172:175],a[168:171],a[56:59],v[172:175]
M v[176:179],a[168:171],a[64:67],v[176:179]
M v[176:179],a[172:175],a[68:71],v[176:179]
M v[180:183],a[172:175],a[76:79],v[180:183]
M v[180:183],a[168:171],a[72:75],v[180:183]
M v[184:187],a[168:171],a[80:83],v[184:187]
s_nop 0
T a[152:153],v4,16384
T a[154:155],v4,17408
M v[184:187],a[172:175],a[84:87],v[184:187]
s_waitcnt lgkmcnt(4)
buffer_load_dwordx4 v10, s[16:19], s21 offen offset:2048  nt lds
M v[188:191],a[172:175],a[92:95],v[188:191]
M v[188:191],a[168:171],a[88:91],v[188:191]
M v[192:195],a[160:163],a[32:35],v[192:195]
R a[168:171],v5,55296
R a[172:175],v6,55296
M v[192:195],a[164:167],a[36:39],v[192:195]
M v[196:199],a[164:167],a[44:47],v[196:199]
M v[196:199],a[160:163],a[40:43],v[196:199]
s_nop 0
T a[156:157],v4,24576
T a[158:159],v4,25600
M v[200:203],a[160:163],a[48:51],v[200:203]
buffer_load_dwordx4 v11, s[16:19], s21 offen offset:3072  nt lds
M v[200:203],a[164:167],a[52:55],v[200:203]
SA s21,s21,128
M v[204:207],a[164:167],a[60:63],v[204:207]
M v[204:207],a[160:163],a[56:59],v[204:207]
M v[208:211],a[160:163],a[64:67],v[208:211]
M v[208:211],a[164:167],a[68:71],v[208:211]
M v[212:215],a[164:167],a[76:79],v[212:215]
M v[212:215],a[160:163],a[72:75],v[212:215]
M v[216:219],a[160:163],a[80:83],v[216:219]
M v[216:219],a[164:167],a[84:87],v[216:219]
s_waitcnt lgkmcnt(2)
M v[220:223],a[164:167],a[92:95],v[220:223]
s_waitcnt vmcnt(17) lgkmcnt(0)
M v[220:223],a[160:163],a[88:91],v[220:223]
s_barrier
M v[224:227],a[168:171],a[32:35],v[224:227]
R a[160:163],v5,0
R a[164:167],v6,0
M v[224:227],a[172:175],a[36:39],v[224:227]
M v[228:231],a[172:175],a[44:47],v[228:231]
M v[228:231],a[168:171],a[40:43],v[228:231]
M v[232:235],a[168:171],a[48:51],v[232:235]
M v[232:235],a[172:175],a[52:55],v[232:235]
M v[236:239],a[172:175],a[60:63],v[236:239]
M v[236:239],a[168:171],a[56:59],v[236:239]
M v[240:243],a[168:171],a[64:67],v[240:243]
M v[240:243],a[172:175],a[68:71],v[240:243]
M v[244:247],a[172:175],a[76:79],v[244:247]
M v[244:247],a[168:171],a[72:75],v[244:247]
M v[248:251],a[168:171],a[80:83],v[248:251]
M v[248:251],a[172:175],a[84:87],v[248:251]
s_waitcnt lgkmcnt(0)
M v[252:255],a[172:175],a[92:95],v[252:255]
M v[252:255],a[168:171],a[88:91],v[252:255]
M a[0:3],a[160:163],a[96:99],a[0:3]
R a[168:171],v5,2048
R a[172:175],v6,2048
M a[0:3],a[164:167],a[100:103],a[0:3]
T a[32:33],v1,32768
T a[34:35],v1,33792
M a[4:7],a[164:167],a[108:111],a[4:7]
SA m0,s24,49152
M a[4:7],a[160:163],a[104:107],a[4:7]
buffer_load_dwordx4 v12, s[48:51], s22 offen offset:0   lds
M a[8:11],a[160:163],a[112:115],a[8:11]
M a[8:11],a[164:167],a[116:119],a[8:11]
M a[12:15],a[164:167],a[124:127],a[12:15]
s_nop 0
T a[36:37],v1,40960
T a[38:39],v1,41984
M a[12:15],a[160:163],a[120:123],a[12:15]
M a[16:19],a[160:163],a[128:131],a[16:19]
buffer_load_dwordx4 v13, s[48:51], s22 offen offset:1024   lds
M a[16:19],a[164:167],a[132:135],a[16:19]
M a[20:23],a[164:167],a[140:143],a[20:23]
M a[20:23],a[160:163],a[136:139],a[20:23]
s_nop 0
T a[40:41],v2,32768
T a[42:43],v2,33792
M a[24:27],a[160:163],a[144:147],a[24:27]
M a[24:27],a[164:167],a[148:151],a[24:27]
s_waitcnt lgkmcnt(6)
buffer_load_dwordx4 v14, s[48:51], s22 offen offset:2048   lds
M a[28:31],a[164:167],a[156:159],a[28:31]
M a[28:31],a[160:163],a[152:155],a[28:31]
M v[32:35],a[168:171],a[96:99],v[32:35]
R a[160:163],v5,4096
R a[164:167],v6,4096
M v[32:35],a[172:175],a[100:103],v[32:35]
T a[44:45],v2,40960
T a[46:47],v2,41984
M v[36:39],a[172:175],a[108:111],v[36:39]
buffer_load_dwordx4 v15, s[48:51], s22 offen offset:3072   lds
M v[36:39],a[168:171],a[104:107],v[36:39]
s_sub_u32 s22, s22, 1048448
M v[40:43],a[168:171],a[112:115],v[40:43]
M v[40:43],a[172:175],a[116:119],v[40:43]
s_nop 0
T a[48:49],v3,32768
T a[50:51],v3,33792
M v[44:47],a[172:175],a[124:127],v[44:47]
SA m0,s23,16384
M v[44:47],a[168:171],a[120:123],v[44:47]
buffer_load_dwordx4 v8, s[16:19], s21 offen offset:0  nt lds
M v[48:51],a[168:171],a[128:131],v[48:51]
M v[48:51],a[172:175],a[132:135],v[48:51]
M v[52:55],a[172:175],a[140:143],v[52:55]
s_nop 0
T a[52:53],v3,40960
T a[54:55],v3,41984
M v[52:55],a[168:171],a[136:139],v[52:55]
M v[56:59],a[168:171],a[144:147],v[56:59]
buffer_load_dwordx4 v9, s[16:19], s21 offen offset:1024  nt lds
M v[56:59],a[172:175],a[148:151],v[56:59]
s_waitcnt lgkmcnt(6)
M v[60:63],a[172:175],a[156:159],v[60:63]
M v[60:63],a[168:171],a[152:155],v[60:63]
s_nop 0
T a[56:57],v4,32768
T a[58:59],v4,33792
M v[64:67],a[160:163],a[96:99],v[64:67]
R a[168:171],v5,6144
R a[172:175],v6,6144
M v[64:67],a[164:167],a[100:103],v[64:67]
buffer_load_dwordx4 v10, s[16:19], s21 offen offset:2048  nt lds
M v[68:71],a[164:167],a[108:111],v[68:71]
M v[68:71],a[160:163],a[104:107],v[68:71]
M v[72:75],a[160:163],a[112:115],v[72:75]
s_nop 0
T a[60:61],v4,40960
T a[62:63],v4,41984
M v[72:75],a[164:167],a[116:119],v[72:75]
M v[76:79],a[164:167],a[124:127],v[76:79]
buffer_load_dwordx4 v11, s[16:19], s21 offen offset:3072  nt lds
M v[76:79],a[160:163],a[120:123],v[76:79]
SA s21,s21,524160
M v[80:83],a[160:163],a[128:131],v[80:83]
M v[80:83],a[164:167],a[132:135],v[80:83]
M v[84:87],a[164:167],a[140:143],v[84:87]
M v[84:87],a[160:163],a[136:139],v[84:87]
M v[88:91],a[160:163],a[144:147],v[88:91]
M v[88:91],a[164:167],a[148:151],v[88:91]
s_waitcnt lgkmcnt(2)
M v[92:95],a[164:167],a[156:159],v[92:95]
s_waitcnt vmcnt(16) lgkmcnt(0)
M v[92:95],a[160:163],a[152:155],v[92:95]
s_barrier
M v[96:99],a[168:171],a[96:99],v[96:99]
R a[160:163],v5,16384
R a[164:167],v6,16384
M v[96:99],a[172:175],a[100:103],v[96:99]
M v[100:103],a[172:175],a[108:111],v[100:103]
SA m0,s24,0
T a[64:65],v1,49152
T a[66:67],v1,50176
M v[100:103],a[168:171],a[104:107],v[100:103]
L_w_kv13:
s_cbranch_execz L_w_kv17
buffer_load_dwordx4 v12, s[48:51], s22 offen offset:0   lds
M v[104:107],a[168:171],a[112:115],v[104:107]
M v[104:107],a[172:175],a[116:119],v[104:107]
M v[108:111],a[172:175],a[124:127],v[108:111]
M v[108:111],a[168:171],a[120:123],v[108:111]
M v[112:115],a[168:171],a[128:131],v[112:115]
M v[112:115],a[172:175],a[132:135],v[112:115]
s_nop 0
T a[68:69],v1,57344
T a[70:71],v1,58368
M v[116:119],a[172:175],a[140:143],v[116:119]
buffer_load_dwordx4 v13, s[48:51], s22 offen offset:1024   lds
M v[116:119],a[168:171],a[136:139],v[116:119]
M v[120:123],a[168:171],a[144:147],v[120:123]
s_and_b32 s64, s42, 7
s_lshl_b32 s64, s64, 2
M v[120:123],a[172:175],a[148:151],v[120:123]
s_waitcnt lgkmcnt(4)
SA s64,s64,s20
M v[124:127],a[172:175],a[156:159],v[124:127]
s_mul_i32 s64, s64, 114688
v_bfe_u32 v28, v0, 2, 2
v_and_b32 v29, 3, v0
M v[124:127],a[168:171],a[152:155],v[124:127]
v_lshlrev_b32 v29, 7, v29
v_lshl_add_u32 v28, v28, 13, v29
M v[128:131],a[160:163],a[96:99],v[128:131]
R a[168:171],v5,18432
R a[172:175],v6,18432
M v[128:131],a[164:167],a[100:103],v[128:131]
T a[72:73],v2,49152
T a[74:75],v2,50176
M v[132:135],a[164:167],a[108:111],v[132:135]
buffer_load_dwordx4 v14, s[48:51], s22 offen offset:2048   lds
M v[132:135],a[160:163],a[104:107],v[132:135]
v_add_u32 v23, s64, v28
v_and_b32 v28, 48, v0
M v[136:139],a[160:163],a[112:115],v[136:139]
v_lshl_add_u32 v23, v28, 24, v23
M v[136:139],a[164:167],a[116:119],v[136:139]
M v[140:143],a[164:167],a[124:127],v[140:143]
M v[140:143],a[160:163],a[120:123],v[140:143]
s_nop 0
T a[76:77],v2,57344
T a[78:79],v2,58368
M v[144:147],a[160:163],a[128:131],v[144:147]
buffer_load_dwordx4 v15, s[48:51], s22 offen offset:3072   lds
M v[144:147],a[164:167],a[132:135],v[144:147]
SA s22,s22,1048576
M v[148:151],a[164:167],a[140:143],v[148:151]
M v[148:151],a[160:163],a[136:139],v[148:151]
M v[152:155],a[160:163],a[144:147],v[152:155]
M v[152:155],a[164:167],a[148:151],v[152:155]
s_waitcnt lgkmcnt(4)
M v[156:159],a[164:167],a[156:159],v[156:159]
SA m0,s23,32768
T a[80:81],v3,49152
T a[82:83],v3,50176
M v[156:159],a[160:163],a[152:155],v[156:159]
buffer_load_dwordx4 v8, s[16:19], s21 offen offset:0  nt lds
M v[160:163],a[168:171],a[96:99],v[160:163]
R a[160:163],v5,20480
R a[164:167],v6,20480
M v[160:163],a[172:175],a[100:103],v[160:163]
M v[164:167],a[172:175],a[108:111],v[164:167]
M v[164:167],a[168:171],a[104:107],v[164:167]
M v[168:171],a[168:171],a[112:115],v[168:171]
M v[168:171],a[172:175],a[116:119],v[168:171]
s_nop 0
T a[84:85],v3,57344
T a[86:87],v3,58368
M v[172:175],a[172:175],a[124:127],v[172:175]
buffer_load_dwordx4 v9, s[16:19], s21 offen offset:1024  nt lds
M v[172:175],a[168:171],a[120:123],v[172:175]
M v[176:179],a[168:171],a[128:131],v[176:179]
M v[176:179],a[172:175],a[132:135],v[176:179]
M v[180:183],a[172:175],a[140:143],v[180:183]
M v[180:183],a[168:171],a[136:139],v[180:183]
M v[184:187],a[168:171],a[144:147],v[184:187]
s_nop 0
T a[88:89],v4,49152
T a[90:91],v4,50176
M v[184:187],a[172:175],a[148:151],v[184:187]
s_waitcnt lgkmcnt(4)
buffer_load_dwordx4 v10, s[16:19], s21 offen offset:2048  nt lds
M v[188:191],a[172:175],a[156:159],v[188:191]
M v[188:191],a[168:171],a[152:155],v[188:191]
M v[192:195],a[160:163],a[96:99],v[192:195]
R a[168:171],v5,22528
R a[172:175],v6,22528
M v[192:195],a[164:167],a[100:103],v[192:195]
M v[196:199],a[164:167],a[108:111],v[196:199]
M v[196:199],a[160:163],a[104:107],v[196:199]
s_nop 0
T a[92:93],v4,57344
T a[94:95],v4,58368
M v[200:203],a[160:163],a[112:115],v[200:203]
buffer_load_dwordx4 v11, s[16:19], s21 offen offset:3072  nt lds
M v[200:203],a[164:167],a[116:119],v[200:203]
SA s21,s21,128
M v[204:207],a[164:167],a[124:127],v[204:207]
M v[204:207],a[160:163],a[120:123],v[204:207]
M v[208:211],a[160:163],a[128:131],v[208:211]
M v[208:211],a[164:167],a[132:135],v[208:211]
M v[212:215],a[164:167],a[140:143],v[212:215]
M v[212:215],a[160:163],a[136:139],v[212:215]
M v[216:219],a[160:163],a[144:147],v[216:219]
M v[216:219],a[164:167],a[148:151],v[216:219]
s_waitcnt lgkmcnt(2)
M v[220:223],a[164:167],a[156:159],v[220:223]
s_waitcnt vmcnt(16) lgkmcnt(0)
M v[220:223],a[160:163],a[152:155],v[220:223]
s_barrier
M v[224:227],a[168:171],a[96:99],v[224:227]
R a[160:163],v5,32768
R a[164:167],v6,32768
M v[224:227],a[172:175],a[100:103],v[224:227]
buffer_load_dword a240, v23, s[52:55], 0 offen offset:0
M v[228:231],a[172:175],a[108:111],v[228:231]
v_add_u32 v23, 32768, v23
M v[228:231],a[168:171],a[104:107],v[228:231]
M v[232:235],a[168:171],a[112:115],v[232:235]
M v[232:235],a[172:175],a[116:119],v[232:235]
M v[236:239],a[172:175],a[124:127],v[236:239]
M v[236:239],a[168:171],a[120:123],v[236:239]
M v[240:243],a[168:171],a[128:131],v[240:243]
M v[240:243],a[172:175],a[132:135],v[240:243]
M v[244:247],a[172:175],a[140:143],v[244:247]
M v[244:247],a[168:171],a[136:139],v[244:247]
M v[248:251],a[168:171],a[144:147],v[248:251]
M v[248:251],a[172:175],a[148:151],v[248:251]
s_waitcnt lgkmcnt(0)
M v[252:255],a[172:175],a[156:159],v[252:255]
M v[252:255],a[168:171],a[152:155],v[252:255]
M a[0:3],a[160:163],a[32:35],a[0:3]
R a[168:171],v5,34816
R a[172:175],v6,34816
M a[0:3],a[164:167],a[36:39],a[0:3]
T a[96:97],v1,0
T a[98:99],v1,1024
M a[4:7],a[164:167],a[44:47],a[4:7]
SA m0,s24,16384
M a[4:7],a[160:163],a[40:43],a[4:7]
buffer_load_dwordx4 v12, s[48:51], s22 offen offset:0   lds
M a[8:11],a[160:163],a[48:51],a[8:11]
M a[8:11],a[164:167],a[52:55],a[8:11]
M a[12:15],a[164:167],a[60:63],a[12:15]
s_nop 0
T a[100:101],v1,8192
T a[102:103],v1,9216
M a[12:15],a[160:163],a[56:59],a[12:15]
M a[16:19],a[160:163],a[64:67],a[16:19]
buffer_load_dwordx4 v13, s[48:51], s22 offen offset:1024   lds
M a[16:19],a[164:167],a[68:71],a[16:19]
M a[20:23],a[164:167],a[76:79],a[20:23]
M a[20:23],a[160:163],a[72:75],a[20:23]
s_nop 0
T a[104:105],v2,0
T a[106:107],v2,1024
M a[24:27],a[160:163],a[80:83],a[24:27]
M a[24:27],a[164:167],a[84:87],a[24:27]
s_waitcnt lgkmcnt(6)
buffer_load_dwordx4 v14, s[48:51], s22 offen offset:2048   lds
M a[28:31],a[164:167],a[92:95],a[28:31]
M a[28:31],a[160:163],a[88:91],a[28:31]
M v[32:35],a[168:171],a[32:35],v[32:35]
R a[160:163],v5,36864
R a[164:167],v6,36864
M v[32:35],a[172:175],a[36:39],v[32:35]
T a[108:109],v2,8192
T a[110:111],v2,9216
M v[36:39],a[172:175],a[44:47],v[36:39]
buffer_load_dwordx4 v15, s[48:51], s22 offen offset:3072   lds
M v[36:39],a[168:171],a[40:43],v[36:39]
s_sub_u32 s22, s22, 1048448
M v[40:43],a[168:171],a[48:51],v[40:43]
M v[40:43],a[172:175],a[52:55],v[40:43]
s_nop 0
T a[112:113],v3,0
T a[114:115],v3,1024
M v[44:47],a[172:175],a[60:63],v[44:47]
SA m0,s23,49152
M v[44:47],a[168:171],a[56:59],v[44:47]
buffer_load_dwordx4 v8, s[16:19], s21 offen offset:0  nt lds
M v[48:51],a[168:171],a[64:67],v[48:51]
M v[48:51],a[172:175],a[68:71],v[48:51]
M v[52:55],a[172:175],a[76:79],v[52:55]
s_nop 0
T a[116:117],v3,8192
T a[118:119],v3,9216
M v[52:55],a[168:171],a[72:75],v[52:55]
M v[56:59],a[168:171],a[80:83],v[56:59]
buffer_load_dwordx4 v9, s[16:19], s21 offen offset:1024  nt lds
M v[56:59],a[172:175],a[84:87],v[56:59]
s_waitcnt lgkmcnt(6)
M v[60:63],a[172:175],a[92:95],v[60:63]
M v[60:63],a[168:171],a[88:91],v[60:63]
s_nop 0
T a[120:121],v4,0
T a[122:123],v4,1024
M v[64:67],a[160:163],a[32:35],v[64:67]
R a[168:171],v5,38912
R a[172:175],v6,38912
M v[64:67],a[164:167],a[36:39],v[64:67]
buffer_load_dwordx4 v10, s[16:19], s21 offen offset:2048  nt lds
M v[68:71],a[164:167],a[44:47],v[68:71]
M v[68:71],a[160:163],a[40:43],v[68:71]
M v[72:75],a[160:163],a[48:51],v[72:75]
s_nop 0
T a[124:125],v4,8192
T a[126:127],v4,9216
M v[72:75],a[164:167],a[52:55],v[72:75]
M v[76:79],a[164:167],a[60:63],v[76:79]
buffer_load_dwordx4 v11, s[16:19], s21 offen offset:3072  nt lds
M v[76:79],a[160:163],a[56:59],v[76:79]
SA s21,s21,524160
M v[80:83],a[160:163],a[64:67],v[80:83]
M v[80:83],a[164:167],a[68:71],v[80:83]
M v[84:87],a[164:167],a[76:79],v[84:87]
M v[84:87],a[160:163],a[72:75],v[84:87]
M v[88:91],a[160:163],a[80:83],v[88:91]
M v[88:91],a[164:167],a[84:87],v[88:91]
s_waitcnt lgkmcnt(2)
M v[92:95],a[164:167],a[92:95],v[92:95]
s_waitcnt vmcnt(17) lgkmcnt(0)
M v[92:95],a[160:163],a[88:91],v[92:95]
s_barrier
M v[96:99],a[168:171],a[32:35],v[96:99]
R a[160:163],v5,49152
R a[164:167],v6,49152
M v[96:99],a[172:175],a[36:39],v[96:99]
M v[100:103],a[172:175],a[44:47],v[100:103]
SA m0,s24,32768
T a[128:129],v1,16384
T a[130:131],v1,17408
M v[100:103],a[168:171],a[40:43],v[100:103]
buffer_load_dwordx4 v12, s[48:51], s22 offen offset:0   lds
M v[104:107],a[168:171],a[48:51],v[104:107]
M v[104:107],a[172:175],a[52:55],v[104:107]
M v[108:111],a[172:175],a[60:63],v[108:111]
M v[108:111],a[168:171],a[56:59],v[108:111]
M v[112:115],a[168:171],a[64:67],v[112:115]
M v[112:115],a[172:175],a[68:71],v[112:115]
s_nop 0
T a[132:133],v1,24576
T a[134:135],v1,25600
M v[116:119],a[172:175],a[76:79],v[116:119]
buffer_load_dwordx4 v13, s[48:51], s22 offen offset:1024   lds
M v[116:119],a[168:171],a[72:75],v[116:119]
M v[120:123],a[168:171],a[80:83],v[120:123]
M v[120:123],a[172:175],a[84:87],v[120:123]
s_waitcnt lgkmcnt(4)
M v[124:127],a[172:175],a[92:95],v[124:127]
M v[124:127],a[168:171],a[88:91],v[124:127]
M v[128:131],a[160:163],a[32:35],v[128:131]
R a[168:171],v5,51200
R a[172:175],v6,51200
M v[128:131],a[164:167],a[36:39],v[128:131]
T a[136:137],v2,16384
T a[138:139],v2,17408
M v[132:135],a[164:167],a[44:47],v[132:135]
buffer_load_dwordx4 v14, s[48:51], s22 offen offset:2048   lds
M v[132:135],a[160:163],a[40:43],v[132:135]
M v[136:139],a[160:163],a[48:51],v[136:139]
M v[136:139],a[164:167],a[52:55],v[136:139]
M v[140:143],a[164:167],a[60:63],v[140:143]
M v[140:143],a[160:163],a[56:59],v[140:143]
s_nop 0
T a[140:141],v2,24576
T a[142:143],v2,25600
M v[144:147],a[160:163],a[64:67],v[144:147]
buffer_load_dwordx4 v15, s[48:51], s22 offen offset:3072   lds
M v[144:147],a[164:167],a[68:71],v[144:147]
SA s22,s22,1048576
M v[148:151],a[164:167],a[76:79],v[148:151]
M v[148:151],a[160:163],a[72:75],v[148:151]
M v[152:155],a[160:163],a[80:83],v[152:155]
M v[152:155],a[164:167],a[84:87],v[152:155]
s_waitcnt lgkmcnt(4)
M v[156:159],a[164:167],a[92:95],v[156:159]
SA m0,s23,0
T a[144:145],v3,16384
T a[146:147],v3,17408
M v[156:159],a[160:163],a[88:91],v[156:159]
buffer_load_dwordx4 v8, s[16:19], s21 offen offset:0  nt lds
M v[160:163],a[168:171],a[32:35],v[160:163]
R a[160:163],v5,53248
R a[164:167],v6,53248
M v[160:163],a[172:175],a[36:39],v[160:163]
M v[164:167],a[172:175],a[44:47],v[164:167]
M v[164:167],a[168:171],a[40:43],v[164:167]
M v[168:171],a[168:171],a[48:51],v[168:171]
M v[168:171],a[172:175],a[52:55],v[168:171]
s_nop 0
T a[148:149],v3,24576
T a[150:151],v3,25600
M v[172:175],a[172:175],a[60:63],v[172:175]
buffer_load_dwordx4 v9, s[16:19], s21 offen offset:1024  nt lds
M v[172:175],a[168:171],a[56:59],v[172:175]
M v[176:179],a[168:171],a[64:67],v[176:179]
M v[176:179],a[172:175],a[68:71],v[176:179]
M v[180:183],a[172:175],a[76:79],v[180:183]
M v[180:183],a[168:171],a[72:75],v[180:183]
M v[184:187],a[168:171],a[80:83],v[184:187]
s_nop 0
T a[152:153],v4,16384
T a[154:155],v4,17408
M v[184:187],a[172:175],a[84:87],v[184:187]
s_waitcnt lgkmcnt(4)
buffer_load_dwordx4 v10, s[16:19], s21 offen offset:2048  nt lds
M v[188:191],a[172:175],a[92:95],v[188:191]
M v[188:191],a[168:171],a[88:91],v[188:191]
M v[192:195],a[160:163],a[32:35],v[192:195]
R a[168:171],v5,55296
R a[172:175],v6,55296
M v[192:195],a[164:167],a[36:39],v[192:195]
M v[196:199],a[164:167],a[44:47],v[196:199]
M v[196:199],a[160:163],a[40:43],v[196:199]
s_nop 0
T a[156:157],v4,24576
T a[158:159],v4,25600
M v[200:203],a[160:163],a[48:51],v[200:203]
buffer_load_dwordx4 v11, s[16:19], s21 offen offset:3072  nt lds
M v[200:203],a[164:167],a[52:55],v[200:203]
SA s21,s21,128
M v[204:207],a[164:167],a[60:63],v[204:207]
M v[204:207],a[160:163],a[56:59],v[204:207]
M v[208:211],a[160:163],a[64:67],v[208:211]
M v[208:211],a[164:167],a[68:71],v[208:211]
M v[212:215],a[164:167],a[76:79],v[212:215]
M v[212:215],a[160:163],a[72:75],v[212:215]
M v[216:219],a[160:163],a[80:83],v[216:219]
M v[216:219],a[164:167],a[84:87],v[216:219]
s_waitcnt lgkmcnt(2)
M v[220:223],a[164:167],a[92:95],v[220:223]
s_waitcnt vmcnt(17) lgkmcnt(0)
M v[220:223],a[160:163],a[88:91],v[220:223]
s_barrier
M v[224:227],a[168:171],a[32:35],v[224:227]
R a[160:163],v5,0
R a[164:167],v6,0
M v[224:227],a[172:175],a[36:39],v[224:227]
buffer_load_dword a240, v23, s[52:55], 0 offen offset:0
M v[228:231],a[172:175],a[44:47],v[228:231]
v_add_u32 v23, 32768, v23
M v[228:231],a[168:171],a[40:43],v[228:231]
M v[232:235],a[168:171],a[48:51],v[232:235]
M v[232:235],a[172:175],a[52:55],v[232:235]
M v[236:239],a[172:175],a[60:63],v[236:239]
M v[236:239],a[168:171],a[56:59],v[236:239]
M v[240:243],a[168:171],a[64:67],v[240:243]
M v[240:243],a[172:175],a[68:71],v[240:243]
M v[244:247],a[172:175],a[76:79],v[244:247]
M v[244:247],a[168:171],a[72:75],v[244:247]
M v[248:251],a[168:171],a[80:83],v[248:251]
M v[248:251],a[172:175],a[84:87],v[248:251]
s_waitcnt lgkmcnt(0)
M v[252:255],a[172:175],a[92:95],v[252:255]
M v[252:255],a[168:171],a[88:91],v[252:255]
M a[0:3],a[160:163],a[96:99],a[0:3]
R a[168:171],v5,2048
R a[172:175],v6,2048
M a[0:3],a[164:167],a[100:103],a[0:3]
T a[32:33],v1,32768
T a[34:35],v1,33792
M a[4:7],a[164:167],a[108:111],a[4:7]
SA m0,s24,49152
M a[4:7],a[160:163],a[104:107],a[4:7]
buffer_load_dwordx4 v12, s[48:51], s22 offen offset:0   lds
M a[8:11],a[160:163],a[112:115],a[8:11]
M a[8:11],a[164:167],a[116:119],a[8:11]
M a[12:15],a[164:167],a[124:127],a[12:15]
s_nop 0
T a[36:37],v1,40960
T a[38:39],v1,41984
M a[12:15],a[160:163],a[120:123],a[12:15]
M a[16:19],a[160:163],a[128:131],a[16:19]
buffer_load_dwordx4 v13, s[48:51], s22 offen offset:1024   lds
M a[16:19],a[164:167],a[132:135],a[16:19]
M a[20:23],a[164:167],a[140:143],a[20:23]
M a[20:23],a[160:163],a[136:139],a[20:23]
s_nop 0
T a[40:41],v2,32768
T a[42:43],v2,33792
M a[24:27],a[160:163],a[144:147],a[24:27]
M a[24:27],a[164:167],a[148:151],a[24:27]
s_waitcnt lgkmcnt(6)
buffer_load_dwordx4 v14, s[48:51], s22 offen offset:2048   lds
M a[28:31],a[164:167],a[156:159],a[28:31]
M a[28:31],a[160:163],a[152:155],a[28:31]
M v[32:35],a[168:171],a[96:99],v[32:35]
R a[160:163],v5,4096
R a[164:167],v6,4096
M v[32:35],a[172:175],a[100:103],v[32:35]
T a[44:45],v2,40960
T a[46:47],v2,41984
M v[36:39],a[172:175],a[108:111],v[36:39]
buffer_load_dwordx4 v15, s[48:51], s22 offen offset:3072   lds
M v[36:39],a[168:171],a[104:107],v[36:39]
s_sub_u32 s22, s22, 1048448
M v[40:43],a[168:171],a[112:115],v[40:43]
M v[40:43],a[172:175],a[116:119],v[40:43]
s_nop 0
T a[48:49],v3,32768
T a[50:51],v3,33792
M v[44:47],a[172:175],a[124:127],v[44:47]
SA m0,s23,16384
M v[44:47],a[168:171],a[120:123],v[44:47]
buffer_load_dwordx4 v8, s[16:19], s21 offen offset:0  nt lds
M v[48:51],a[168:171],a[128:131],v[48:51]
M v[48:51],a[172:175],a[132:135],v[48:51]
M v[52:55],a[172:175],a[140:143],v[52:55]
s_nop 0
T a[52:53],v3,40960
T a[54:55],v3,41984
M v[52:55],a[168:171],a[136:139],v[52:55]
M v[56:59],a[168:171],a[144:147],v[56:59]
buffer_load_dwordx4 v9, s[16:19], s21 offen offset:1024  nt lds
M v[56:59],a[172:175],a[148:151],v[56:59]
s_waitcnt lgkmcnt(6)
M v[60:63],a[172:175],a[156:159],v[60:63]
M v[60:63],a[168:171],a[152:155],v[60:63]
s_nop 0
T a[56:57],v4,32768
T a[58:59],v4,33792
M v[64:67],a[160:163],a[96:99],v[64:67]
R a[168:171],v5,6144
R a[172:175],v6,6144
M v[64:67],a[164:167],a[100:103],v[64:67]
buffer_load_dwordx4 v10, s[16:19], s21 offen offset:2048  nt lds
M v[68:71],a[164:167],a[108:111],v[68:71]
M v[68:71],a[160:163],a[104:107],v[68:71]
M v[72:75],a[160:163],a[112:115],v[72:75]
s_nop 0
T a[60:61],v4,40960
T a[62:63],v4,41984
M v[72:75],a[164:167],a[116:119],v[72:75]
M v[76:79],a[164:167],a[124:127],v[76:79]
buffer_load_dwordx4 v11, s[16:19], s21 offen offset:3072  nt lds
M v[76:79],a[160:163],a[120:123],v[76:79]
SA s21,s21,524160
M v[80:83],a[160:163],a[128:131],v[80:83]
M v[80:83],a[164:167],a[132:135],v[80:83]
M v[84:87],a[164:167],a[140:143],v[84:87]
M v[84:87],a[160:163],a[136:139],v[84:87]
M v[88:91],a[160:163],a[144:147],v[88:91]
M v[88:91],a[164:167],a[148:151],v[88:91]
s_waitcnt lgkmcnt(2)
M v[92:95],a[164:167],a[156:159],v[92:95]
s_waitcnt vmcnt(17) lgkmcnt(0)
M v[92:95],a[160:163],a[152:155],v[92:95]
s_barrier
M v[96:99],a[168:171],a[96:99],v[96:99]
R a[160:163],v5,16384
R a[164:167],v6,16384
M v[96:99],a[172:175],a[100:103],v[96:99]
M v[100:103],a[172:175],a[108:111],v[100:103]
SA m0,s24,0
T a[64:65],v1,49152
T a[66:67],v1,50176
M v[100:103],a[168:171],a[104:107],v[100:103]
buffer_load_dwordx4 v12, s[48:51], s22 offen offset:0   lds
M v[104:107],a[168:171],a[112:115],v[104:107]
M v[104:107],a[172:175],a[116:119],v[104:107]
M v[108:111],a[172:175],a[124:127],v[108:111]
M v[108:111],a[168:171],a[120:123],v[108:111]
M v[112:115],a[168:171],a[128:131],v[112:115]
M v[112:115],a[172:175],a[132:135],v[112:115]
s_nop 0
T a[68:69],v1,57344
T a[70:71],v1,58368
M v[116:119],a[172:175],a[140:143],v[116:119]
buffer_load_dwordx4 v13, s[48:51], s22 offen offset:1024   lds
M v[116:119],a[168:171],a[136:139],v[116:119]
M v[120:123],a[168:171],a[144:147],v[120:123]
M v[120:123],a[172:175],a[148:151],v[120:123]
s_waitcnt lgkmcnt(4)
M v[124:127],a[172:175],a[156:159],v[124:127]
M v[124:127],a[168:171],a[152:155],v[124:127]
M v[128:131],a[160:163],a[96:99],v[128:131]
R a[168:171],v5,18432
R a[172:175],v6,18432
M v[128:131],a[164:167],a[100:103],v[128:131]
T a[72:73],v2,49152
T a[74:75],v2,50176
M v[132:135],a[164:167],a[108:111],v[132:135]
buffer_load_dwordx4 v14, s[48:51], s22 offen offset:2048   lds
M v[132:135],a[160:163],a[104:107],v[132:135]
M v[136:139],a[160:163],a[112:115],v[136:139]
M v[136:139],a[164:167],a[116:119],v[136:139]
M v[140:143],a[164:167],a[124:127],v[140:143]
M v[140:143],a[160:163],a[120:123],v[140:143]
s_nop 0
T a[76:77],v2,57344
T a[78:79],v2,58368
M v[144:147],a[160:163],a[128:131],v[144:147]
buffer_load_dwordx4 v15, s[48:51], s22 offen offset:3072   lds
M v[144:147],a[164:167],a[132:135],v[144:147]
SA s22,s22,1048576
M v[148:151],a[164:167],a[140:143],v[148:151]
M v[148:151],a[160:163],a[136:139],v[148:151]
M v[152:155],a[160:163],a[144:147],v[152:155]
M v[152:155],a[164:167],a[148:151],v[152:155]
s_waitcnt lgkmcnt(4)
M v[156:159],a[164:167],a[156:159],v[156:159]
SA m0,s23,32768
T a[80:81],v3,49152
T a[82:83],v3,50176
M v[156:159],a[160:163],a[152:155],v[156:159]
buffer_load_dwordx4 v8, s[16:19], s21 offen offset:0  nt lds
M v[160:163],a[168:171],a[96:99],v[160:163]
R a[160:163],v5,20480
R a[164:167],v6,20480
M v[160:163],a[172:175],a[100:103],v[160:163]
M v[164:167],a[172:175],a[108:111],v[164:167]
M v[164:167],a[168:171],a[104:107],v[164:167]
M v[168:171],a[168:171],a[112:115],v[168:171]
M v[168:171],a[172:175],a[116:119],v[168:171]
s_nop 0
T a[84:85],v3,57344
T a[86:87],v3,58368
M v[172:175],a[172:175],a[124:127],v[172:175]
buffer_load_dwordx4 v9, s[16:19], s21 offen offset:1024  nt lds
M v[172:175],a[168:171],a[120:123],v[172:175]
M v[176:179],a[168:171],a[128:131],v[176:179]
M v[176:179],a[172:175],a[132:135],v[176:179]
M v[180:183],a[172:175],a[140:143],v[180:183]
M v[180:183],a[168:171],a[136:139],v[180:183]
M v[184:187],a[168:171],a[144:147],v[184:187]
s_nop 0
T a[88:89],v4,49152
T a[90:91],v4,50176
M v[184:187],a[172:175],a[148:151],v[184:187]
s_waitcnt lgkmcnt(4)
buffer_load_dwordx4 v10, s[16:19], s21 offen offset:2048  nt lds
M v[188:191],a[172:175],a[156:159],v[188:191]
M v[188:191],a[168:171],a[152:155],v[188:191]
M v[192:195],a[160:163],a[96:99],v[192:195]
R a[168:171],v5,22528
R a[172:175],v6,22528
M v[192:195],a[164:167],a[100:103],v[192:195]
M v[196:199],a[164:167],a[108:111],v[196:199]
M v[196:199],a[160:163],a[104:107],v[196:199]
L_w_kv14:
s_cbranch_execz L_w_kv18
s_nop 0
T a[92:93],v4,57344
T a[94:95],v4,58368
M v[200:203],a[160:163],a[112:115],v[200:203]
buffer_load_dwordx4 v11, s[16:19], s21 offen offset:3072  nt lds
M v[200:203],a[164:167],a[116:119],v[200:203]
SA s21,s21,128
M v[204:207],a[164:167],a[124:127],v[204:207]
M v[204:207],a[160:163],a[120:123],v[204:207]
M v[208:211],a[160:163],a[128:131],v[208:211]
M v[208:211],a[164:167],a[132:135],v[208:211]
M v[212:215],a[164:167],a[140:143],v[212:215]
M v[212:215],a[160:163],a[136:139],v[212:215]
M v[216:219],a[160:163],a[144:147],v[216:219]
M v[216:219],a[164:167],a[148:151],v[216:219]
s_waitcnt lgkmcnt(2)
M v[220:223],a[164:167],a[156:159],v[220:223]
s_waitcnt vmcnt(17) lgkmcnt(0)
M v[220:223],a[160:163],a[152:155],v[220:223]
s_barrier
M v[224:227],a[168:171],a[96:99],v[224:227]
R a[160:163],v5,32768
R a[164:167],v6,32768
M v[224:227],a[172:175],a[100:103],v[224:227]
buffer_load_dword a240, v23, s[52:55], 0 offen offset:0
M v[228:231],a[172:175],a[108:111],v[228:231]
v_add_u32 v23, 16384, v23
M v[228:231],a[168:171],a[104:107],v[228:231]
M v[232:235],a[168:171],a[112:115],v[232:235]
M v[232:235],a[172:175],a[116:119],v[232:235]
M v[236:239],a[172:175],a[124:127],v[236:239]
M v[236:239],a[168:171],a[120:123],v[236:239]
M v[240:243],a[168:171],a[128:131],v[240:243]
M v[240:243],a[172:175],a[132:135],v[240:243]
M v[244:247],a[172:175],a[140:143],v[244:247]
M v[244:247],a[168:171],a[136:139],v[244:247]
M v[248:251],a[168:171],a[144:147],v[248:251]
M v[248:251],a[172:175],a[148:151],v[248:251]
s_waitcnt lgkmcnt(0)
M v[252:255],a[172:175],a[156:159],v[252:255]
M v[252:255],a[168:171],a[152:155],v[252:255]
M a[0:3],a[160:163],a[32:35],a[0:3]
R a[168:171],v5,34816
R a[172:175],v6,34816
M a[0:3],a[164:167],a[36:39],a[0:3]
T a[96:97],v1,0
T a[98:99],v1,1024
M a[4:7],a[164:167],a[44:47],a[4:7]
SA m0,s24,16384
M a[4:7],a[160:163],a[40:43],a[4:7]
buffer_load_dwordx4 v12, s[48:51], s22 offen offset:0   lds
M a[8:11],a[160:163],a[48:51],a[8:11]
M a[8:11],a[164:167],a[52:55],a[8:11]
M a[12:15],a[164:167],a[60:63],a[12:15]
s_nop 0
T a[100:101],v1,8192
T a[102:103],v1,9216
M a[12:15],a[160:163],a[56:59],a[12:15]
M a[16:19],a[160:163],a[64:67],a[16:19]
buffer_load_dwordx4 v13, s[48:51], s22 offen offset:1024   lds
M a[16:19],a[164:167],a[68:71],a[16:19]
M a[20:23],a[164:167],a[76:79],a[20:23]
M a[20:23],a[160:163],a[72:75],a[20:23]
s_nop 0
T a[104:105],v2,0
T a[106:107],v2,1024
M a[24:27],a[160:163],a[80:83],a[24:27]
M a[24:27],a[164:167],a[84:87],a[24:27]
s_waitcnt lgkmcnt(6)
buffer_load_dwordx4 v14, s[48:51], s22 offen offset:2048   lds
M a[28:31],a[164:167],a[92:95],a[28:31]
M a[28:31],a[160:163],a[88:91],a[28:31]
M v[32:35],a[168:171],a[32:35],v[32:35]
R a[160:163],v5,36864
R a[164:167],v6,36864
M v[32:35],a[172:175],a[36:39],v[32:35]
T a[108:109],v2,8192
T a[110:111],v2,9216
M v[36:39],a[172:175],a[44:47],v[36:39]
buffer_load_dwordx4 v15, s[48:51], s22 offen offset:3072   lds
M v[36:39],a[168:171],a[40:43],v[36:39]
s_sub_u32 s22, s22, 1048448
M v[40:43],a[168:171],a[48:51],v[40:43]
M v[40:43],a[172:175],a[52:55],v[40:43]
s_nop 0
T a[112:113],v3,0
T a[114:115],v3,1024
M v[44:47],a[172:175],a[60:63],v[44:47]
SA m0,s23,49152
M v[44:47],a[168:171],a[56:59],v[44:47]
buffer_load_dwordx4 v8, s[16:19], s21 offen offset:0  nt lds
M v[48:51],a[168:171],a[64:67],v[48:51]
M v[48:51],a[172:175],a[68:71],v[48:51]
M v[52:55],a[172:175],a[76:79],v[52:55]
s_nop 0
T a[116:117],v3,8192
T a[118:119],v3,9216
M v[52:55],a[168:171],a[72:75],v[52:55]
M v[56:59],a[168:171],a[80:83],v[56:59]
buffer_load_dwordx4 v9, s[16:19], s21 offen offset:1024  nt lds
M v[56:59],a[172:175],a[84:87],v[56:59]
s_waitcnt lgkmcnt(6)
M v[60:63],a[172:175],a[92:95],v[60:63]
M v[60:63],a[168:171],a[88:91],v[60:63]
s_nop 0
T a[120:121],v4,0
T a[122:123],v4,1024
M v[64:67],a[160:163],a[32:35],v[64:67]
R a[168:171],v5,38912
R a[172:175],v6,38912
M v[64:67],a[164:167],a[36:39],v[64:67]
buffer_load_dwordx4 v10, s[16:19], s21 offen offset:2048  nt lds
M v[68:71],a[164:167],a[44:47],v[68:71]
M v[68:71],a[160:163],a[40:43],v[68:71]
M v[72:75],a[160:163],a[48:51],v[72:75]
s_nop 0
T a[124:125],v4,8192
T a[126:127],v4,9216
M v[72:75],a[164:167],a[52:55],v[72:75]
M v[76:79],a[164:167],a[60:63],v[76:79]
buffer_load_dwordx4 v11, s[16:19], s21 offen offset:3072  nt lds
M v[76:79],a[160:163],a[56:59],v[76:79]
SA s21,s21,524160
M v[80:83],a[160:163],a[64:67],v[80:83]
M v[80:83],a[164:167],a[68:71],v[80:83]
M v[84:87],a[164:167],a[76:79],v[84:87]
M v[84:87],a[160:163],a[72:75],v[84:87]
M v[88:91],a[160:163],a[80:83],v[88:91]
M v[88:91],a[164:167],a[84:87],v[88:91]
s_waitcnt lgkmcnt(2)
M v[92:95],a[164:167],a[92:95],v[92:95]
s_waitcnt vmcnt(17) lgkmcnt(0)
M v[92:95],a[160:163],a[88:91],v[92:95]
s_barrier
M v[96:99],a[168:171],a[32:35],v[96:99]
R a[160:163],v5,49152
R a[164:167],v6,49152
M v[96:99],a[172:175],a[36:39],v[96:99]
M v[100:103],a[172:175],a[44:47],v[100:103]
SA m0,s24,32768
T a[128:129],v1,16384
T a[130:131],v1,17408
M v[100:103],a[168:171],a[40:43],v[100:103]
buffer_load_dwordx4 v12, s[48:51], s22 offen offset:0   lds
M v[104:107],a[168:171],a[48:51],v[104:107]
M v[104:107],a[172:175],a[52:55],v[104:107]
M v[108:111],a[172:175],a[60:63],v[108:111]
M v[108:111],a[168:171],a[56:59],v[108:111]
M v[112:115],a[168:171],a[64:67],v[112:115]
M v[112:115],a[172:175],a[68:71],v[112:115]
s_nop 0
T a[132:133],v1,24576
T a[134:135],v1,25600
M v[116:119],a[172:175],a[76:79],v[116:119]
buffer_load_dwordx4 v13, s[48:51], s22 offen offset:1024   lds
M v[116:119],a[168:171],a[72:75],v[116:119]
M v[120:123],a[168:171],a[80:83],v[120:123]
M v[120:123],a[172:175],a[84:87],v[120:123]
s_waitcnt lgkmcnt(4)
M v[124:127],a[172:175],a[92:95],v[124:127]
M v[124:127],a[168:171],a[88:91],v[124:127]
M v[128:131],a[160:163],a[32:35],v[128:131]
R a[168:171],v5,51200
R a[172:175],v6,51200
M v[128:131],a[164:167],a[36:39],v[128:131]
T a[136:137],v2,16384
T a[138:139],v2,17408
M v[132:135],a[164:167],a[44:47],v[132:135]
buffer_load_dwordx4 v14, s[48:51], s22 offen offset:2048   lds
M v[132:135],a[160:163],a[40:43],v[132:135]
M v[136:139],a[160:163],a[48:51],v[136:139]
M v[136:139],a[164:167],a[52:55],v[136:139]
M v[140:143],a[164:167],a[60:63],v[140:143]
M v[140:143],a[160:163],a[56:59],v[140:143]
s_nop 0
T a[140:141],v2,24576
T a[142:143],v2,25600
M v[144:147],a[160:163],a[64:67],v[144:147]
buffer_load_dwordx4 v15, s[48:51], s22 offen offset:3072   lds
M v[144:147],a[164:167],a[68:71],v[144:147]
SA s22,s22,1048576
M v[148:151],a[164:167],a[76:79],v[148:151]
M v[148:151],a[160:163],a[72:75],v[148:151]
M v[152:155],a[160:163],a[80:83],v[152:155]
M v[152:155],a[164:167],a[84:87],v[152:155]
s_waitcnt lgkmcnt(4)
M v[156:159],a[164:167],a[92:95],v[156:159]
SA m0,s23,0
T a[144:145],v3,16384
T a[146:147],v3,17408
M v[156:159],a[160:163],a[88:91],v[156:159]
buffer_load_dwordx4 v8, s[16:19], s21 offen offset:0  nt lds
M v[160:163],a[168:171],a[32:35],v[160:163]
R a[160:163],v5,53248
R a[164:167],v6,53248
M v[160:163],a[172:175],a[36:39],v[160:163]
M v[164:167],a[172:175],a[44:47],v[164:167]
M v[164:167],a[168:171],a[40:43],v[164:167]
M v[168:171],a[168:171],a[48:51],v[168:171]
M v[168:171],a[172:175],a[52:55],v[168:171]
s_nop 0
T a[148:149],v3,24576
T a[150:151],v3,25600
M v[172:175],a[172:175],a[60:63],v[172:175]
buffer_load_dwordx4 v9, s[16:19], s21 offen offset:1024  nt lds
M v[172:175],a[168:171],a[56:59],v[172:175]
M v[176:179],a[168:171],a[64:67],v[176:179]
M v[176:179],a[172:175],a[68:71],v[176:179]
M v[180:183],a[172:175],a[76:79],v[180:183]
M v[180:183],a[168:171],a[72:75],v[180:183]
M v[184:187],a[168:171],a[80:83],v[184:187]
s_nop 0
T a[152:153],v4,16384
T a[154:155],v4,17408
M v[184:187],a[172:175],a[84:87],v[184:187]
s_waitcnt lgkmcnt(4)
buffer_load_dwordx4 v10, s[16:19], s21 offen offset:2048  nt lds
M v[188:191],a[172:175],a[92:95],v[188:191]
M v[188:191],a[168:171],a[88:91],v[188:191]
M v[192:195],a[160:163],a[32:35],v[192:195]
R a[168:171],v5,55296
R a[172:175],v6,55296
M v[192:195],a[164:167],a[36:39],v[192:195]
M v[196:199],a[164:167],a[44:47],v[196:199]
M v[196:199],a[160:163],a[40:43],v[196:199]
s_nop 0
T a[156:157],v4,24576
T a[158:159],v4,25600
M v[200:203],a[160:163],a[48:51],v[200:203]
buffer_load_dwordx4 v11, s[16:19], s21 offen offset:3072  nt lds
M v[200:203],a[164:167],a[52:55],v[200:203]
SA s21,s21,128
M v[204:207],a[164:167],a[60:63],v[204:207]
M v[204:207],a[160:163],a[56:59],v[204:207]
M v[208:211],a[160:163],a[64:67],v[208:211]
M v[208:211],a[164:167],a[68:71],v[208:211]
M v[212:215],a[164:167],a[76:79],v[212:215]
M v[212:215],a[160:163],a[72:75],v[212:215]
M v[216:219],a[160:163],a[80:83],v[216:219]
M v[216:219],a[164:167],a[84:87],v[216:219]
s_waitcnt lgkmcnt(2)
M v[220:223],a[164:167],a[92:95],v[220:223]
s_waitcnt vmcnt(17) lgkmcnt(0)
M v[220:223],a[160:163],a[88:91],v[220:223]
s_barrier
M v[224:227],a[168:171],a[32:35],v[224:227]
R a[160:163],v5,0
R a[164:167],v6,0
M v[224:227],a[172:175],a[36:39],v[224:227]
buffer_load_dword a240, v23, s[52:55], 0 offen offset:0
M v[228:231],a[172:175],a[44:47],v[228:231]
v_add_u32 v23, 16384, v23
M v[228:231],a[168:171],a[40:43],v[228:231]
M v[232:235],a[168:171],a[48:51],v[232:235]
M v[232:235],a[172:175],a[52:55],v[232:235]
M v[236:239],a[172:175],a[60:63],v[236:239]
M v[236:239],a[168:171],a[56:59],v[236:239]
M v[240:243],a[168:171],a[64:67],v[240:243]
M v[240:243],a[172:175],a[68:71],v[240:243]
M v[244:247],a[172:175],a[76:79],v[244:247]
M v[244:247],a[168:171],a[72:75],v[244:247]
M v[248:251],a[168:171],a[80:83],v[248:251]
M v[248:251],a[172:175],a[84:87],v[248:251]
s_waitcnt lgkmcnt(0)
M v[252:255],a[172:175],a[92:95],v[252:255]
M v[252:255],a[168:171],a[88:91],v[252:255]
M a[0:3],a[160:163],a[96:99],a[0:3]
R a[168:171],v5,2048
R a[172:175],v6,2048
M a[0:3],a[164:167],a[100:103],a[0:3]
T a[32:33],v1,32768
T a[34:35],v1,33792
M a[4:7],a[164:167],a[108:111],a[4:7]
SA m0,s24,49152
M a[4:7],a[160:163],a[104:107],a[4:7]
buffer_load_dwordx4 v12, s[48:51], s22 offen offset:0   lds
M a[8:11],a[160:163],a[112:115],a[8:11]
M a[8:11],a[164:167],a[116:119],a[8:11]
M a[12:15],a[164:167],a[124:127],a[12:15]
s_nop 0
T a[36:37],v1,40960
T a[38:39],v1,41984
M a[12:15],a[160:163],a[120:123],a[12:15]
M a[16:19],a[160:163],a[128:131],a[16:19]
buffer_load_dwordx4 v13, s[48:51], s22 offen offset:1024   lds
M a[16:19],a[164:167],a[132:135],a[16:19]
M a[20:23],a[164:167],a[140:143],a[20:23]
M a[20:23],a[160:163],a[136:139],a[20:23]
s_nop 0
T a[40:41],v2,32768
T a[42:43],v2,33792
M a[24:27],a[160:163],a[144:147],a[24:27]
M a[24:27],a[164:167],a[148:151],a[24:27]
s_waitcnt lgkmcnt(6)
buffer_load_dwordx4 v14, s[48:51], s22 offen offset:2048   lds
M a[28:31],a[164:167],a[156:159],a[28:31]
M a[28:31],a[160:163],a[152:155],a[28:31]
M v[32:35],a[168:171],a[96:99],v[32:35]
R a[160:163],v5,4096
R a[164:167],v6,4096
M v[32:35],a[172:175],a[100:103],v[32:35]
T a[44:45],v2,40960
T a[46:47],v2,41984
M v[36:39],a[172:175],a[108:111],v[36:39]
buffer_load_dwordx4 v15, s[48:51], s22 offen offset:3072   lds
M v[36:39],a[168:171],a[104:107],v[36:39]
s_sub_u32 s22, s22, 1048448
M v[40:43],a[168:171],a[112:115],v[40:43]
M v[40:43],a[172:175],a[116:119],v[40:43]
s_nop 0
T a[48:49],v3,32768
T a[50:51],v3,33792
M v[44:47],a[172:175],a[124:127],v[44:47]
SA m0,s23,16384
M v[44:47],a[168:171],a[120:123],v[44:47]
buffer_load_dwordx4 v8, s[16:19], s21 offen offset:0  nt lds
M v[48:51],a[168:171],a[128:131],v[48:51]
M v[48:51],a[172:175],a[132:135],v[48:51]
M v[52:55],a[172:175],a[140:143],v[52:55]
s_nop 0
T a[52:53],v3,40960
T a[54:55],v3,41984
M v[52:55],a[168:171],a[136:139],v[52:55]
M v[56:59],a[168:171],a[144:147],v[56:59]
buffer_load_dwordx4 v9, s[16:19], s21 offen offset:1024  nt lds
M v[56:59],a[172:175],a[148:151],v[56:59]
s_waitcnt lgkmcnt(6)
M v[60:63],a[172:175],a[156:159],v[60:63]
M v[60:63],a[168:171],a[152:155],v[60:63]
s_nop 0
T a[56:57],v4,32768
T a[58:59],v4,33792
M v[64:67],a[160:163],a[96:99],v[64:67]
R a[168:171],v5,6144
R a[172:175],v6,6144
M v[64:67],a[164:167],a[100:103],v[64:67]
buffer_load_dwordx4 v10, s[16:19], s21 offen offset:2048  nt lds
M v[68:71],a[164:167],a[108:111],v[68:71]
M v[68:71],a[160:163],a[104:107],v[68:71]
M v[72:75],a[160:163],a[112:115],v[72:75]
s_nop 0
T a[60:61],v4,40960
T a[62:63],v4,41984
M v[72:75],a[164:167],a[116:119],v[72:75]
M v[76:79],a[164:167],a[124:127],v[76:79]
buffer_load_dwordx4 v11, s[16:19], s21 offen offset:3072  nt lds
M v[76:79],a[160:163],a[120:123],v[76:79]
SA s21,s21,524160
M v[80:83],a[160:163],a[128:131],v[80:83]
M v[80:83],a[164:167],a[132:135],v[80:83]
M v[84:87],a[164:167],a[140:143],v[84:87]
M v[84:87],a[160:163],a[136:139],v[84:87]
M v[88:91],a[160:163],a[144:147],v[88:91]
M v[88:91],a[164:167],a[148:151],v[88:91]
s_waitcnt lgkmcnt(2)
M v[92:95],a[164:167],a[156:159],v[92:95]
s_waitcnt vmcnt(17) lgkmcnt(0)
M v[92:95],a[160:163],a[152:155],v[92:95]
s_barrier
M v[96:99],a[168:171],a[96:99],v[96:99]
R a[160:163],v5,16384
R a[164:167],v6,16384
M v[96:99],a[172:175],a[100:103],v[96:99]
M v[100:103],a[172:175],a[108:111],v[100:103]
SA m0,s24,0
T a[64:65],v1,49152
T a[66:67],v1,50176
M v[100:103],a[168:171],a[104:107],v[100:103]
buffer_load_dwordx4 v12, s[48:51], s22 offen offset:0   lds
M v[104:107],a[168:171],a[112:115],v[104:107]
M v[104:107],a[172:175],a[116:119],v[104:107]
M v[108:111],a[172:175],a[124:127],v[108:111]
M v[108:111],a[168:171],a[120:123],v[108:111]
M v[112:115],a[168:171],a[128:131],v[112:115]
M v[112:115],a[172:175],a[132:135],v[112:115]
s_nop 0
T a[68:69],v1,57344
T a[70:71],v1,58368
M v[116:119],a[172:175],a[140:143],v[116:119]
buffer_load_dwordx4 v13, s[48:51], s22 offen offset:1024   lds
M v[116:119],a[168:171],a[136:139],v[116:119]
M v[120:123],a[168:171],a[144:147],v[120:123]
M v[120:123],a[172:175],a[148:151],v[120:123]
s_waitcnt lgkmcnt(4)
M v[124:127],a[172:175],a[156:159],v[124:127]
M v[124:127],a[168:171],a[152:155],v[124:127]
M v[128:131],a[160:163],a[96:99],v[128:131]
R a[168:171],v5,18432
R a[172:175],v6,18432
M v[128:131],a[164:167],a[100:103],v[128:131]
T a[72:73],v2,49152
T a[74:75],v2,50176
M v[132:135],a[164:167],a[108:111],v[132:135]
buffer_load_dwordx4 v14, s[48:51], s22 offen offset:2048   lds
M v[132:135],a[160:163],a[104:107],v[132:135]
M v[136:139],a[160:163],a[112:115],v[136:139]
M v[136:139],a[164:167],a[116:119],v[136:139]
M v[140:143],a[164:167],a[124:127],v[140:143]
M v[140:143],a[160:163],a[120:123],v[140:143]
s_nop 0
T a[76:77],v2,57344
T a[78:79],v2,58368
M v[144:147],a[160:163],a[128:131],v[144:147]
buffer_load_dwordx4 v15, s[48:51], s22 offen offset:3072   lds
M v[144:147],a[164:167],a[132:135],v[144:147]
SA s22,s22,1048576
M v[148:151],a[164:167],a[140:143],v[148:151]
M v[148:151],a[160:163],a[136:139],v[148:151]
M v[152:155],a[160:163],a[144:147],v[152:155]
M v[152:155],a[164:167],a[148:151],v[152:155]
s_waitcnt lgkmcnt(4)
M v[156:159],a[164:167],a[156:159],v[156:159]
SA m0,s23,32768
T a[80:81],v3,49152
T a[82:83],v3,50176
M v[156:159],a[160:163],a[152:155],v[156:159]
buffer_load_dwordx4 v8, s[16:19], s21 offen offset:0  nt lds
M v[160:163],a[168:171],a[96:99],v[160:163]
R a[160:163],v5,20480
R a[164:167],v6,20480
M v[160:163],a[172:175],a[100:103],v[160:163]
M v[164:167],a[172:175],a[108:111],v[164:167]
M v[164:167],a[168:171],a[104:107],v[164:167]
M v[168:171],a[168:171],a[112:115],v[168:171]
M v[168:171],a[172:175],a[116:119],v[168:171]
s_nop 0
T a[84:85],v3,57344
T a[86:87],v3,58368
M v[172:175],a[172:175],a[124:127],v[172:175]
buffer_load_dwordx4 v9, s[16:19], s21 offen offset:1024  nt lds
M v[172:175],a[168:171],a[120:123],v[172:175]
M v[176:179],a[168:171],a[128:131],v[176:179]
M v[176:179],a[172:175],a[132:135],v[176:179]
M v[180:183],a[172:175],a[140:143],v[180:183]
M v[180:183],a[168:171],a[136:139],v[180:183]
M v[184:187],a[168:171],a[144:147],v[184:187]
s_nop 0
T a[88:89],v4,49152
T a[90:91],v4,50176
M v[184:187],a[172:175],a[148:151],v[184:187]
s_waitcnt lgkmcnt(4)
buffer_load_dwordx4 v10, s[16:19], s21 offen offset:2048  nt lds
M v[188:191],a[172:175],a[156:159],v[188:191]
M v[188:191],a[168:171],a[152:155],v[188:191]
M v[192:195],a[160:163],a[96:99],v[192:195]
R a[168:171],v5,22528
R a[172:175],v6,22528
M v[192:195],a[164:167],a[100:103],v[192:195]
M v[196:199],a[164:167],a[108:111],v[196:199]
M v[196:199],a[160:163],a[104:107],v[196:199]
s_nop 0
T a[92:93],v4,57344
T a[94:95],v4,58368
M v[200:203],a[160:163],a[112:115],v[200:203]
buffer_load_dwordx4 v11, s[16:19], s21 offen offset:3072  nt lds
M v[200:203],a[164:167],a[116:119],v[200:203]
SA s21,s21,128
M v[204:207],a[164:167],a[124:127],v[204:207]
M v[204:207],a[160:163],a[120:123],v[204:207]
M v[208:211],a[160:163],a[128:131],v[208:211]
M v[208:211],a[164:167],a[132:135],v[208:211]
M v[212:215],a[164:167],a[140:143],v[212:215]
M v[212:215],a[160:163],a[136:139],v[212:215]
M v[216:219],a[160:163],a[144:147],v[216:219]
M v[216:219],a[164:167],a[148:151],v[216:219]
s_waitcnt lgkmcnt(2)
M v[220:223],a[164:167],a[156:159],v[220:223]
s_waitcnt vmcnt(17) lgkmcnt(0)
M v[220:223],a[160:163],a[152:155],v[220:223]
s_barrier
M v[224:227],a[168:171],a[96:99],v[224:227]
R a[160:163],v5,32768
R a[164:167],v6,32768
M v[224:227],a[172:175],a[100:103],v[224:227]
M v[228:231],a[172:175],a[108:111],v[228:231]
M v[228:231],a[168:171],a[104:107],v[228:231]
M v[232:235],a[168:171],a[112:115],v[232:235]
M v[232:235],a[172:175],a[116:119],v[232:235]
M v[236:239],a[172:175],a[124:127],v[236:239]
M v[236:239],a[168:171],a[120:123],v[236:239]
M v[240:243],a[168:171],a[128:131],v[240:243]
M v[240:243],a[172:175],a[132:135],v[240:243]
M v[244:247],a[172:175],a[140:143],v[244:247]
M v[244:247],a[168:171],a[136:139],v[244:247]
M v[248:251],a[168:171],a[144:147],v[248:251]
M v[248:251],a[172:175],a[148:151],v[248:251]
s_waitcnt lgkmcnt(0)
M v[252:255],a[172:175],a[156:159],v[252:255]
M v[252:255],a[168:171],a[152:155],v[252:255]
M a[0:3],a[160:163],a[32:35],a[0:3]
R a[168:171],v5,34816
R a[172:175],v6,34816
M a[0:3],a[164:167],a[36:39],a[0:3]
T a[96:97],v1,0
T a[98:99],v1,1024
M a[4:7],a[164:167],a[44:47],a[4:7]
SA m0,s24,16384
M a[4:7],a[160:163],a[40:43],a[4:7]
buffer_load_dwordx4 v12, s[48:51], s22 offen offset:0   lds
M a[8:11],a[160:163],a[48:51],a[8:11]
M a[8:11],a[164:167],a[52:55],a[8:11]
M a[12:15],a[164:167],a[60:63],a[12:15]
s_nop 0
T a[100:101],v1,8192
T a[102:103],v1,9216
M a[12:15],a[160:163],a[56:59],a[12:15]
M a[16:19],a[160:163],a[64:67],a[16:19]
buffer_load_dwordx4 v13, s[48:51], s22 offen offset:1024   lds
M a[16:19],a[164:167],a[68:71],a[16:19]
M a[20:23],a[164:167],a[76:79],a[20:23]
M a[20:23],a[160:163],a[72:75],a[20:23]
s_nop 0
T a[104:105],v2,0
T a[106:107],v2,1024
M a[24:27],a[160:163],a[80:83],a[24:27]
M a[24:27],a[164:167],a[84:87],a[24:27]
s_waitcnt lgkmcnt(6)
buffer_load_dwordx4 v14, s[48:51], s22 offen offset:2048   lds
M a[28:31],a[164:167],a[92:95],a[28:31]
M a[28:31],a[160:163],a[88:91],a[28:31]
M v[32:35],a[168:171],a[32:35],v[32:35]
R a[160:163],v5,36864
R a[164:167],v6,36864
M v[32:35],a[172:175],a[36:39],v[32:35]
T a[108:109],v2,8192
T a[110:111],v2,9216
M v[36:39],a[172:175],a[44:47],v[36:39]
buffer_load_dwordx4 v15, s[48:51], s22 offen offset:3072   lds
M v[36:39],a[168:171],a[40:43],v[36:39]
s_sub_u32 s22, s22, 1048448
M v[40:43],a[168:171],a[48:51],v[40:43]
M v[40:43],a[172:175],a[52:55],v[40:43]
s_nop 0
T a[112:113],v3,0
T a[114:115],v3,1024
M v[44:47],a[172:175],a[60:63],v[44:47]
SA m0,s23,49152
M v[44:47],a[168:171],a[56:59],v[44:47]
buffer_load_dwordx4 v8, s[16:19], s21 offen offset:0  nt lds
M v[48:51],a[168:171],a[64:67],v[48:51]
L_w_kv15:
s_cbranch_execz L_wd2
M v[48:51],a[172:175],a[68:71],v[48:51]
M v[52:55],a[172:175],a[76:79],v[52:55]
s_nop 0
T a[116:117],v3,8192
T a[118:119],v3,9216
M v[52:55],a[168:171],a[72:75],v[52:55]
M v[56:59],a[168:171],a[80:83],v[56:59]
buffer_load_dwordx4 v9, s[16:19], s21 offen offset:1024  nt lds
M v[56:59],a[172:175],a[84:87],v[56:59]
s_waitcnt lgkmcnt(6)
M v[60:63],a[172:175],a[92:95],v[60:63]
M v[60:63],a[168:171],a[88:91],v[60:63]
s_nop 0
T a[120:121],v4,0
T a[122:123],v4,1024
M v[64:67],a[160:163],a[32:35],v[64:67]
R a[168:171],v5,38912
R a[172:175],v6,38912
M v[64:67],a[164:167],a[36:39],v[64:67]
buffer_load_dwordx4 v10, s[16:19], s21 offen offset:2048  nt lds
M v[68:71],a[164:167],a[44:47],v[68:71]
M v[68:71],a[160:163],a[40:43],v[68:71]
M v[72:75],a[160:163],a[48:51],v[72:75]
s_nop 0
T a[124:125],v4,8192
T a[126:127],v4,9216
M v[72:75],a[164:167],a[52:55],v[72:75]
M v[76:79],a[164:167],a[60:63],v[76:79]
buffer_load_dwordx4 v11, s[16:19], s21 offen offset:3072  nt lds
M v[76:79],a[160:163],a[56:59],v[76:79]
SA s21,s21,524160
M v[80:83],a[160:163],a[64:67],v[80:83]
M v[80:83],a[164:167],a[68:71],v[80:83]
M v[84:87],a[164:167],a[76:79],v[84:87]
M v[84:87],a[160:163],a[72:75],v[84:87]
M v[88:91],a[160:163],a[80:83],v[88:91]
M v[88:91],a[164:167],a[84:87],v[88:91]
s_waitcnt lgkmcnt(2)
M v[92:95],a[164:167],a[92:95],v[92:95]
s_waitcnt vmcnt(16) lgkmcnt(0)
M v[92:95],a[160:163],a[88:91],v[92:95]
s_barrier
M v[96:99],a[168:171],a[32:35],v[96:99]
R a[160:163],v5,49152
R a[164:167],v6,49152
M v[96:99],a[172:175],a[36:39],v[96:99]
M v[100:103],a[172:175],a[44:47],v[100:103]
SA m0,s24,32768
T a[128:129],v1,16384
T a[130:131],v1,17408
M v[100:103],a[168:171],a[40:43],v[100:103]
buffer_load_dwordx4 v12, s[48:51], s22 offen offset:0   lds
M v[104:107],a[168:171],a[48:51],v[104:107]
M v[104:107],a[172:175],a[52:55],v[104:107]
M v[108:111],a[172:175],a[60:63],v[108:111]
M v[108:111],a[168:171],a[56:59],v[108:111]
M v[112:115],a[168:171],a[64:67],v[112:115]
M v[112:115],a[172:175],a[68:71],v[112:115]
s_nop 0
T a[132:133],v1,24576
T a[134:135],v1,25600
M v[116:119],a[172:175],a[76:79],v[116:119]
buffer_load_dwordx4 v13, s[48:51], s22 offen offset:1024   lds
M v[116:119],a[168:171],a[72:75],v[116:119]
M v[120:123],a[168:171],a[80:83],v[120:123]
M v[120:123],a[172:175],a[84:87],v[120:123]
s_waitcnt lgkmcnt(4)
M v[124:127],a[172:175],a[92:95],v[124:127]
M v[124:127],a[168:171],a[88:91],v[124:127]
M v[128:131],a[160:163],a[32:35],v[128:131]
R a[168:171],v5,51200
R a[172:175],v6,51200
M v[128:131],a[164:167],a[36:39],v[128:131]
T a[136:137],v2,16384
T a[138:139],v2,17408
M v[132:135],a[164:167],a[44:47],v[132:135]
buffer_load_dwordx4 v14, s[48:51], s22 offen offset:2048   lds
M v[132:135],a[160:163],a[40:43],v[132:135]
M v[136:139],a[160:163],a[48:51],v[136:139]
M v[136:139],a[164:167],a[52:55],v[136:139]
M v[140:143],a[164:167],a[60:63],v[140:143]
M v[140:143],a[160:163],a[56:59],v[140:143]
s_nop 0
T a[140:141],v2,24576
T a[142:143],v2,25600
M v[144:147],a[160:163],a[64:67],v[144:147]
buffer_load_dwordx4 v15, s[48:51], s22 offen offset:3072   lds
M v[144:147],a[164:167],a[68:71],v[144:147]
SA s22,s22,1048576
M v[148:151],a[164:167],a[76:79],v[148:151]
M v[148:151],a[160:163],a[72:75],v[148:151]
M v[152:155],a[160:163],a[80:83],v[152:155]
M v[152:155],a[164:167],a[84:87],v[152:155]
s_waitcnt lgkmcnt(4)
M v[156:159],a[164:167],a[92:95],v[156:159]
SA m0,s23,0
T a[144:145],v3,16384
T a[146:147],v3,17408
M v[156:159],a[160:163],a[88:91],v[156:159]
buffer_load_dwordx4 v8, s[16:19], s21 offen offset:0  nt lds
M v[160:163],a[168:171],a[32:35],v[160:163]
R a[160:163],v5,53248
R a[164:167],v6,53248
M v[160:163],a[172:175],a[36:39],v[160:163]
M v[164:167],a[172:175],a[44:47],v[164:167]
M v[164:167],a[168:171],a[40:43],v[164:167]
M v[168:171],a[168:171],a[48:51],v[168:171]
M v[168:171],a[172:175],a[52:55],v[168:171]
s_nop 0
T a[148:149],v3,24576
T a[150:151],v3,25600
M v[172:175],a[172:175],a[60:63],v[172:175]
buffer_load_dwordx4 v9, s[16:19], s21 offen offset:1024  nt lds
M v[172:175],a[168:171],a[56:59],v[172:175]
M v[176:179],a[168:171],a[64:67],v[176:179]
M v[176:179],a[172:175],a[68:71],v[176:179]
M v[180:183],a[172:175],a[76:79],v[180:183]
M v[180:183],a[168:171],a[72:75],v[180:183]
M v[184:187],a[168:171],a[80:83],v[184:187]
s_nop 0
T a[152:153],v4,16384
T a[154:155],v4,17408
M v[184:187],a[172:175],a[84:87],v[184:187]
s_waitcnt lgkmcnt(4)
buffer_load_dwordx4 v10, s[16:19], s21 offen offset:2048  nt lds
M v[188:191],a[172:175],a[92:95],v[188:191]
M v[188:191],a[168:171],a[88:91],v[188:191]
M v[192:195],a[160:163],a[32:35],v[192:195]
R a[168:171],v5,55296
R a[172:175],v6,55296
M v[192:195],a[164:167],a[36:39],v[192:195]
M v[196:199],a[164:167],a[44:47],v[196:199]
M v[196:199],a[160:163],a[40:43],v[196:199]
s_nop 0
T a[156:157],v4,24576
T a[158:159],v4,25600
M v[200:203],a[160:163],a[48:51],v[200:203]
buffer_load_dwordx4 v11, s[16:19], s21 offen offset:3072  nt lds
M v[200:203],a[164:167],a[52:55],v[200:203]
SA s21,s21,128
M v[204:207],a[164:167],a[60:63],v[204:207]
M v[204:207],a[160:163],a[56:59],v[204:207]
M v[208:211],a[160:163],a[64:67],v[208:211]
M v[208:211],a[164:167],a[68:71],v[208:211]
M v[212:215],a[164:167],a[76:79],v[212:215]
M v[212:215],a[160:163],a[72:75],v[212:215]
M v[216:219],a[160:163],a[80:83],v[216:219]
M v[216:219],a[164:167],a[84:87],v[216:219]
s_waitcnt lgkmcnt(2)
M v[220:223],a[164:167],a[92:95],v[220:223]
s_waitcnt vmcnt(16) lgkmcnt(0)
M v[220:223],a[160:163],a[88:91],v[220:223]
s_barrier
M v[224:227],a[168:171],a[32:35],v[224:227]
R a[160:163],v5,0
R a[164:167],v6,0
M v[224:227],a[172:175],a[36:39],v[224:227]
M v[228:231],a[172:175],a[44:47],v[228:231]
M v[228:231],a[168:171],a[40:43],v[228:231]
M v[232:235],a[168:171],a[48:51],v[232:235]
M v[232:235],a[172:175],a[52:55],v[232:235]
M v[236:239],a[172:175],a[60:63],v[236:239]
M v[236:239],a[168:171],a[56:59],v[236:239]
M v[240:243],a[168:171],a[64:67],v[240:243]
M v[240:243],a[172:175],a[68:71],v[240:243]
M v[244:247],a[172:175],a[76:79],v[244:247]
M v[244:247],a[168:171],a[72:75],v[244:247]
M v[248:251],a[168:171],a[80:83],v[248:251]
M v[248:251],a[172:175],a[84:87],v[248:251]
s_waitcnt lgkmcnt(0)
M v[252:255],a[172:175],a[92:95],v[252:255]
M v[252:255],a[168:171],a[88:91],v[252:255]
M a[0:3],a[160:163],a[96:99],a[0:3]
R a[168:171],v5,2048
R a[172:175],v6,2048
M a[0:3],a[164:167],a[100:103],a[0:3]
T a[32:33],v1,32768
T a[34:35],v1,33792
M a[4:7],a[164:167],a[108:111],a[4:7]
SA m0,s24,49152
v_lshrrev_b32 v28, 4, v0
v_and_b32 v29, 7, v0
M a[4:7],a[160:163],a[104:107],a[4:7]
buffer_load_dwordx4 v12, s[48:51], s22 offen offset:0   lds
M a[8:11],a[160:163],a[112:115],a[8:11]
v_xor_b32 v28, v28, v29
v_lshlrev_b32 v28, 4, v28
M a[8:11],a[164:167],a[116:119],a[8:11]
v_lshrrev_b32 v29, 3, v0
v_mul_u32_u24 v29, 896, v29
M a[12:15],a[164:167],a[124:127],a[12:15]
T a[36:37],v1,40960
T a[38:39],v1,41984
M a[12:15],a[160:163],a[120:123],a[12:15]
v_add_u32 v22, v28, v29
v_xor_b32 v28, 64, v28
M a[16:19],a[160:163],a[128:131],a[16:19]
s_mul_i32 s64, s20, 14336
buffer_load_dwordx4 v13, s[48:51], s22 offen offset:1024   lds
M a[16:19],a[164:167],a[132:135],a[16:19]
s_sub_u32 s65, 98304, s64
M a[20:23],a[164:167],a[140:143],a[20:23]
SA s30,s29,s65
M a[20:23],a[160:163],a[136:139],a[20:23]
SA s29,s29,s64
T a[40:41],v2,32768
T a[42:43],v2,33792
M a[24:27],a[160:163],a[144:147],a[24:27]
v_add_u32 v29, 6144, v29
v_add_u32 v23, v28, v29
M a[24:27],a[164:167],a[148:151],a[24:27]
s_waitcnt lgkmcnt(6)
buffer_load_dwordx4 v14, s[48:51], s22 offen offset:2048   lds
M a[28:31],a[164:167],a[156:159],a[28:31]
s_and_b32 s64, s20, 1
M a[28:31],a[160:163],a[152:155],a[28:31]
s_lshl_b32 s64, s64, 12
M v[32:35],a[168:171],a[96:99],v[32:35]
SA s64,s64,65536
R a[160:163],v5,4096
R a[164:167],v6,4096
M v[32:35],a[172:175],a[100:103],v[32:35]
T a[44:45],v2,40960
T a[46:47],v2,41984
M v[36:39],a[172:175],a[108:111],v[36:39]
buffer_load_dwordx4 v15, s[48:51], s22 offen offset:3072   lds
M v[36:39],a[168:171],a[104:107],v[36:39]
s_sub_u32 s22, s22, 1048448
v_add_u32 v20, s64, v5
v_add_u32 v21, s64, v6
M v[40:43],a[168:171],a[112:115],v[40:43]
M v[40:43],a[172:175],a[116:119],v[40:43]
s_nop 0
T a[48:49],v3,32768
T a[50:51],v3,33792
M v[44:47],a[172:175],a[124:127],v[44:47]
SA m0,s23,16384
M v[44:47],a[168:171],a[120:123],v[44:47]
buffer_load_dwordx4 v8, s[16:19], s21 offen offset:0  nt lds
M v[48:51],a[168:171],a[128:131],v[48:51]
M v[48:51],a[172:175],a[132:135],v[48:51]
M v[52:55],a[172:175],a[140:143],v[52:55]
s_nop 0
T a[52:53],v3,40960
T a[54:55],v3,41984
M v[52:55],a[168:171],a[136:139],v[52:55]
M v[56:59],a[168:171],a[144:147],v[56:59]
buffer_load_dwordx4 v9, s[16:19], s21 offen offset:1024  nt lds
M v[56:59],a[172:175],a[148:151],v[56:59]
s_waitcnt lgkmcnt(6)
M v[60:63],a[172:175],a[156:159],v[60:63]
M v[60:63],a[168:171],a[152:155],v[60:63]
s_nop 0
T a[56:57],v4,32768
T a[58:59],v4,33792
M v[64:67],a[160:163],a[96:99],v[64:67]
R a[168:171],v5,6144
R a[172:175],v6,6144
M v[64:67],a[164:167],a[100:103],v[64:67]
buffer_load_dwordx4 v10, s[16:19], s21 offen offset:2048  nt lds
M v[68:71],a[164:167],a[108:111],v[68:71]
M v[68:71],a[160:163],a[104:107],v[68:71]
M v[72:75],a[160:163],a[112:115],v[72:75]
s_nop 0
T a[60:61],v4,40960
T a[62:63],v4,41984
M v[72:75],a[164:167],a[116:119],v[72:75]
M v[76:79],a[164:167],a[124:127],v[76:79]
buffer_load_dwordx4 v11, s[16:19], s21 offen offset:3072  nt lds
M v[76:79],a[160:163],a[120:123],v[76:79]
SA s21,s21,524160
M v[80:83],a[160:163],a[128:131],v[80:83]
M v[80:83],a[164:167],a[132:135],v[80:83]
M v[84:87],a[164:167],a[140:143],v[84:87]
M v[84:87],a[160:163],a[136:139],v[84:87]
M v[88:91],a[160:163],a[144:147],v[88:91]
M v[88:91],a[164:167],a[148:151],v[88:91]
s_waitcnt lgkmcnt(2)
M v[92:95],a[164:167],a[156:159],v[92:95]
s_waitcnt vmcnt(16) lgkmcnt(0)
M v[92:95],a[160:163],a[152:155],v[92:95]
s_barrier
M v[96:99],a[168:171],a[96:99],v[96:99]
R a[160:163],v5,16384
R a[164:167],v6,16384
M v[96:99],a[172:175],a[100:103],v[96:99]
SA m0,s23,131072
M v[100:103],a[172:175],a[108:111],v[100:103]
s_nop 0
T a[64:65],v1,49152
T a[66:67],v1,50176
M v[100:103],a[168:171],a[104:107],v[100:103]
buffer_load_dwordx4 v22, s[56:59], s29 offen offset:0 lds
M v[104:107],a[168:171],a[112:115],v[104:107]
M v[104:107],a[172:175],a[116:119],v[104:107]
M v[108:111],a[172:175],a[124:127],v[108:111]
buffer_load_dwordx4 v23, s[56:59], s29 offen offset:1024 lds
M v[108:111],a[168:171],a[120:123],v[108:111]
M v[112:115],a[168:171],a[128:131],v[112:115]
M v[112:115],a[172:175],a[132:135],v[112:115]
s_nop 0
T a[68:69],v1,57344
T a[70:71],v1,58368
M v[116:119],a[172:175],a[140:143],v[116:119]
buffer_load_dwordx4 v22, s[56:59], s30 offen offset:2048 lds
M v[116:119],a[168:171],a[136:139],v[116:119]
M v[120:123],a[168:171],a[144:147],v[120:123]
M v[120:123],a[172:175],a[148:151],v[120:123]
s_waitcnt lgkmcnt(4)
M v[124:127],a[172:175],a[156:159],v[124:127]
M v[124:127],a[168:171],a[152:155],v[124:127]
buffer_load_dwordx4 v23, s[56:59], s30 offen offset:3072 lds
M v[128:131],a[160:163],a[96:99],v[128:131]
R a[168:171],v5,18432
R a[172:175],v6,18432
M v[128:131],a[164:167],a[100:103],v[128:131]
SA s29,s29,128
T a[72:73],v2,49152
T a[74:75],v2,50176
M v[132:135],a[164:167],a[108:111],v[132:135]
SA s30,s30,128
M v[132:135],a[160:163],a[104:107],v[132:135]
SA m0,s24,0
M v[136:139],a[160:163],a[112:115],v[136:139]
buffer_load_dwordx4 v12, s[48:51], s22 offen offset:0   lds
M v[136:139],a[164:167],a[116:119],v[136:139]
M v[140:143],a[164:167],a[124:127],v[140:143]
M v[140:143],a[160:163],a[120:123],v[140:143]
s_nop 0
T a[76:77],v2,57344
T a[78:79],v2,58368
M v[144:147],a[160:163],a[128:131],v[144:147]
buffer_load_dwordx4 v13, s[48:51], s22 offen offset:1024   lds
M v[144:147],a[164:167],a[132:135],v[144:147]
M v[148:151],a[164:167],a[140:143],v[148:151]
M v[148:151],a[160:163],a[136:139],v[148:151]
M v[152:155],a[160:163],a[144:147],v[152:155]
M v[152:155],a[164:167],a[148:151],v[152:155]
s_waitcnt lgkmcnt(4)
buffer_load_dwordx4 v14, s[48:51], s22 offen offset:2048   lds
M v[156:159],a[164:167],a[156:159],v[156:159]
s_nop 0
T a[80:81],v3,49152
T a[82:83],v3,50176
M v[156:159],a[160:163],a[152:155],v[156:159]
M v[160:163],a[168:171],a[96:99],v[160:163]
R a[160:163],v5,20480
R a[164:167],v6,20480
M v[160:163],a[172:175],a[100:103],v[160:163]
M v[164:167],a[172:175],a[108:111],v[164:167]
buffer_load_dwordx4 v15, s[48:51], s22 offen offset:3072   lds
M v[164:167],a[168:171],a[104:107],v[164:167]
M v[168:171],a[168:171],a[112:115],v[168:171]
M v[168:171],a[172:175],a[116:119],v[168:171]
SA s22,s22,1048576
T a[84:85],v3,57344
T a[86:87],v3,58368
M v[172:175],a[172:175],a[124:127],v[172:175]
SA m0,s23,32768
M v[172:175],a[168:171],a[120:123],v[172:175]
buffer_load_dwordx4 v8, s[16:19], s21 offen offset:0  nt lds
M v[176:179],a[168:171],a[128:131],v[176:179]
M v[176:179],a[172:175],a[132:135],v[176:179]
M v[180:183],a[172:175],a[140:143],v[180:183]
M v[180:183],a[168:171],a[136:139],v[180:183]
buffer_load_dwordx4 v9, s[16:19], s21 offen offset:1024  nt lds
M v[184:187],a[168:171],a[144:147],v[184:187]
s_nop 0
T a[88:89],v4,49152
T a[90:91],v4,50176
M v[184:187],a[172:175],a[148:151],v[184:187]
s_waitcnt lgkmcnt(4)
M v[188:191],a[172:175],a[156:159],v[188:191]
M v[188:191],a[168:171],a[152:155],v[188:191]
M v[192:195],a[160:163],a[96:99],v[192:195]
R a[168:171],v5,22528
R a[172:175],v6,22528
M v[192:195],a[164:167],a[100:103],v[192:195]
buffer_load_dwordx4 v10, s[16:19], s21 offen offset:2048  nt lds
M v[196:199],a[164:167],a[108:111],v[196:199]
M v[196:199],a[160:163],a[104:107],v[196:199]
s_nop 0
T a[92:93],v4,57344
T a[94:95],v4,58368
M v[200:203],a[160:163],a[112:115],v[200:203]
M v[200:203],a[164:167],a[116:119],v[200:203]
buffer_load_dwordx4 v11, s[16:19], s21 offen offset:3072  nt lds
M v[204:207],a[164:167],a[124:127],v[204:207]
M v[204:207],a[160:163],a[120:123],v[204:207]
M v[208:211],a[160:163],a[128:131],v[208:211]
M v[208:211],a[164:167],a[132:135],v[208:211]
M v[212:215],a[164:167],a[140:143],v[212:215]
SA s21,s21,128
M v[212:215],a[160:163],a[136:139],v[212:215]
M v[216:219],a[160:163],a[144:147],v[216:219]
M v[216:219],a[164:167],a[148:151],v[216:219]
s_waitcnt lgkmcnt(2)
M v[220:223],a[164:167],a[156:159],v[220:223]
s_waitcnt vmcnt(20) lgkmcnt(0)
M v[220:223],a[160:163],a[152:155],v[220:223]
s_barrier
M v[224:227],a[168:171],a[96:99],v[224:227]
R a[160:163],v5,32768
R a[164:167],v6,32768
M v[224:227],a[172:175],a[100:103],v[224:227]
M v[228:231],a[172:175],a[108:111],v[228:231]
M v[228:231],a[168:171],a[104:107],v[228:231]
M v[232:235],a[168:171],a[112:115],v[232:235]
M v[232:235],a[172:175],a[116:119],v[232:235]
M v[236:239],a[172:175],a[124:127],v[236:239]
M v[236:239],a[168:171],a[120:123],v[236:239]
M v[240:243],a[168:171],a[128:131],v[240:243]
M v[240:243],a[172:175],a[132:135],v[240:243]
M v[244:247],a[172:175],a[140:143],v[244:247]
M v[244:247],a[168:171],a[136:139],v[244:247]
M v[248:251],a[168:171],a[144:147],v[248:251]
M v[248:251],a[172:175],a[148:151],v[248:251]
s_waitcnt lgkmcnt(0)
M v[252:255],a[172:175],a[156:159],v[252:255]
M v[252:255],a[168:171],a[152:155],v[252:255]
M a[0:3],a[160:163],a[32:35],a[0:3]
R a[168:171],v5,34816
R a[172:175],v6,34816
M a[0:3],a[164:167],a[36:39],a[0:3]
SA m0,s23,147456
T a[96:97],v1,0
T a[98:99],v1,1024
M a[4:7],a[164:167],a[44:47],a[4:7]
buffer_load_dwordx4 v22, s[56:59], s29 offen offset:0 lds
M a[4:7],a[160:163],a[40:43],a[4:7]
M a[8:11],a[160:163],a[48:51],a[8:11]
M a[8:11],a[164:167],a[52:55],a[8:11]
buffer_load_dwordx4 v23, s[56:59], s29 offen offset:1024 lds
M a[12:15],a[164:167],a[60:63],a[12:15]
s_nop 0
T a[100:101],v1,8192
T a[102:103],v1,9216
M a[12:15],a[160:163],a[56:59],a[12:15]
M a[16:19],a[160:163],a[64:67],a[16:19]
buffer_load_dwordx4 v22, s[56:59], s30 offen offset:2048 lds
M a[16:19],a[164:167],a[68:71],a[16:19]
M a[20:23],a[164:167],a[76:79],a[20:23]
M a[20:23],a[160:163],a[72:75],a[20:23]
s_nop 0
T a[104:105],v2,0
T a[106:107],v2,1024
M a[24:27],a[160:163],a[80:83],a[24:27]
buffer_load_dwordx4 v23, s[56:59], s30 offen offset:3072 lds
M a[24:27],a[164:167],a[84:87],a[24:27]
s_waitcnt lgkmcnt(6)
M a[28:31],a[164:167],a[92:95],a[28:31]
SA s29,s29,128
M a[28:31],a[160:163],a[88:91],a[28:31]
SA s30,s30,128
M v[32:35],a[168:171],a[32:35],v[32:35]
SA m0,s24,16384
R a[160:163],v5,36864
R a[164:167],v6,36864
M v[32:35],a[172:175],a[36:39],v[32:35]
T a[108:109],v2,8192
T a[110:111],v2,9216
M v[36:39],a[172:175],a[44:47],v[36:39]
buffer_load_dwordx4 v12, s[48:51], s22 offen offset:0   lds
M v[36:39],a[168:171],a[40:43],v[36:39]
M v[40:43],a[168:171],a[48:51],v[40:43]
M v[40:43],a[172:175],a[52:55],v[40:43]
s_nop 0
T a[112:113],v3,0
T a[114:115],v3,1024
M v[44:47],a[172:175],a[60:63],v[44:47]
buffer_load_dwordx4 v13, s[48:51], s22 offen offset:1024   lds
M v[44:47],a[168:171],a[56:59],v[44:47]
M v[48:51],a[168:171],a[64:67],v[48:51]
M v[48:51],a[172:175],a[68:71],v[48:51]
buffer_load_dwordx4 v14, s[48:51], s22 offen offset:2048   lds
M v[52:55],a[172:175],a[76:79],v[52:55]
s_nop 0
T a[116:117],v3,8192
T a[118:119],v3,9216
M v[52:55],a[168:171],a[72:75],v[52:55]
M v[56:59],a[168:171],a[80:83],v[56:59]
buffer_load_dwordx4 v15, s[48:51], s22 offen offset:3072   lds
M v[56:59],a[172:175],a[84:87],v[56:59]
s_waitcnt lgkmcnt(6)
M v[60:63],a[172:175],a[92:95],v[60:63]
s_sub_u32 s22, s22, 1048448
M v[60:63],a[168:171],a[88:91],v[60:63]
SA m0,s23,49152
T a[120:121],v4,0
T a[122:123],v4,1024
M v[64:67],a[160:163],a[32:35],v[64:67]
R a[168:171],v5,38912
R a[172:175],v6,38912
M v[64:67],a[164:167],a[36:39],v[64:67]
buffer_load_dwordx4 v8, s[16:19], s21 offen offset:0  nt lds
M v[68:71],a[164:167],a[44:47],v[68:71]
M v[68:71],a[160:163],a[40:43],v[68:71]
M v[72:75],a[160:163],a[48:51],v[72:75]
s_waitcnt vmcnt(17)
s_nop 0
T a[124:125],v4,8192
T a[126:127],v4,9216
M v[72:75],a[164:167],a[52:55],v[72:75]
buffer_load_dwordx4 v9, s[16:19], s21 offen offset:1024  nt lds
M v[76:79],a[164:167],a[60:63],v[76:79]
R a[176:179],v20,0
R a[180:183],v20,2048
M v[76:79],a[160:163],a[56:59],v[76:79]
R a[184:187],v21,0
R a[188:191],v21,2048
M v[80:83],a[160:163],a[64:67],v[80:83]
buffer_load_dwordx4 v10, s[16:19], s21 offen offset:2048  nt lds
M v[80:83],a[164:167],a[68:71],v[80:83]
M v[84:87],a[164:167],a[76:79],v[84:87]
M v[84:87],a[160:163],a[72:75],v[84:87]
buffer_load_dwordx4 v11, s[16:19], s21 offen offset:3072  nt lds
M v[88:91],a[160:163],a[80:83],v[88:91]
SA s21,s21,524160
M v[88:91],a[164:167],a[84:87],v[88:91]
s_waitcnt lgkmcnt(6)
M v[92:95],a[164:167],a[92:95],v[92:95]
s_waitcnt lgkmcnt(0)
M v[92:95],a[160:163],a[88:91],v[92:95]
s_barrier
M v[96:99],a[168:171],a[32:35],v[96:99]
s_lshl_b32 s4, s20, 10
R a[160:163],v5,49152
R a[164:167],v6,49152
M v[96:99],a[172:175],a[36:39],v[96:99]
SA m0,s23,131072
v_bfe_u32 v28, v0, 3, 2
M v[100:103],a[172:175],a[44:47],v[100:103]
s_nop 0
T a[128:129],v1,16384
T a[130:131],v1,17408
M v[100:103],a[168:171],a[40:43],v[100:103]
buffer_load_dwordx4 v22, s[56:59], s29 offen offset:0 lds
M v[104:107],a[168:171],a[48:51],v[104:107]
v_lshrrev_b32 v29, 5, v0
v_lshl_add_u32 v28, v29, 3, v28
M v[104:107],a[172:175],a[52:55],v[104:107]
M v[108:111],a[172:175],a[60:63],v[108:111]
buffer_load_dwordx4 v23, s[56:59], s29 offen offset:1024 lds
M v[108:111],a[168:171],a[56:59],v[108:111]
v_lshlrev_b32 v28, 13, v28
M v[112:115],a[168:171],a[64:67],v[112:115]
v_lshrrev_b32 v29, 4, v0
M v[112:115],a[172:175],a[68:71],v[112:115]
L_w_kv16:
s_cbranch_execz L_wd2
s_nop 0
T a[132:133],v1,24576
T a[134:135],v1,25600
M v[116:119],a[172:175],a[76:79],v[116:119]
buffer_load_dwordx4 v22, s[56:59], s30 offen offset:2048 lds
M v[116:119],a[168:171],a[72:75],v[116:119]
v_lshlrev_b32 v29, 1, v29
M v[120:123],a[168:171],a[80:83],v[120:123]
v_and_b32 v30, 7, v0
M v[120:123],a[172:175],a[84:87],v[120:123]
s_waitcnt lgkmcnt(4)
M v[124:127],a[172:175],a[92:95],v[124:127]
v_xor_b32 v29, v29, v30
M v[124:127],a[168:171],a[88:91],v[124:127]
buffer_load_dwordx4 v23, s[56:59], s30 offen offset:3072 lds
M v[128:131],a[160:163],a[32:35],v[128:131]
R a[168:171],v5,51200
R a[172:175],v6,51200
M v[128:131],a[164:167],a[36:39],v[128:131]
SA s29,s29,128
T a[136:137],v2,16384
T a[138:139],v2,17408
M v[132:135],a[164:167],a[44:47],v[132:135]
SA s30,s30,128
v_lshl_add_u32 v28, v29, 4, v28
M v[132:135],a[160:163],a[40:43],v[132:135]
s_and_b32 s64, s20, 1
M v[136:139],a[160:163],a[48:51],v[136:139]
s_lshl_b32 s64, s64, 17
M v[136:139],a[164:167],a[52:55],v[136:139]
s_lshr_b32 s65, s20, 1
M v[140:143],a[164:167],a[60:63],v[140:143]
s_lshl_b32 s65, s65, 15
SA s64,s64,s65
v_add_u32 v8, s64, v28
M v[140:143],a[160:163],a[56:59],v[140:143]
SA m0,s24,32768
T a[140:141],v2,24576
T a[142:143],v2,25600
M v[144:147],a[160:163],a[64:67],v[144:147]
buffer_load_dwordx4 v12, s[48:51], s22 offen offset:0   lds
M v[144:147],a[164:167],a[68:71],v[144:147]
M v[148:151],a[164:167],a[76:79],v[148:151]
M v[148:151],a[160:163],a[72:75],v[148:151]
buffer_load_dwordx4 v13, s[48:51], s22 offen offset:1024   lds
M v[152:155],a[160:163],a[80:83],v[152:155]
M v[152:155],a[164:167],a[84:87],v[152:155]
s_waitcnt lgkmcnt(4)
M v[156:159],a[164:167],a[92:95],v[156:159]
s_nop 0
T a[144:145],v3,16384
T a[146:147],v3,17408
M v[156:159],a[160:163],a[88:91],v[156:159]
buffer_load_dwordx4 v14, s[48:51], s22 offen offset:2048   lds
M v[160:163],a[168:171],a[32:35],v[160:163]
R a[160:163],v5,53248
R a[164:167],v6,53248
M v[160:163],a[172:175],a[36:39],v[160:163]
M v[164:167],a[172:175],a[44:47],v[164:167]
buffer_load_dwordx4 v15, s[48:51], s22 offen offset:3072   lds
M v[164:167],a[168:171],a[40:43],v[164:167]
M v[168:171],a[168:171],a[48:51],v[168:171]
SA s22,s22,1048576
M v[168:171],a[172:175],a[52:55],v[168:171]
s_mov_b32 s25, 0
T a[148:149],v3,24576
T a[150:151],v3,25600
M v[172:175],a[172:175],a[60:63],v[172:175]
SA m0,s4,0
M v[172:175],a[168:171],a[56:59],v[172:175]
buffer_load_dwordx4 v8, s[52:55], s25 offen lds
M v[176:179],a[168:171],a[64:67],v[176:179]
M v[176:179],a[172:175],a[68:71],v[176:179]
s_mov_b32 s25, 262144
M v[180:183],a[172:175],a[76:79],v[180:183]
SA m0,s4,4096
M v[180:183],a[168:171],a[72:75],v[180:183]
buffer_load_dwordx4 v8, s[52:55], s25 offen lds
M v[184:187],a[168:171],a[80:83],v[184:187]
s_nop 0
T a[152:153],v4,16384
T a[154:155],v4,17408
M v[184:187],a[172:175],a[84:87],v[184:187]
s_waitcnt lgkmcnt(4)
M v[188:191],a[172:175],a[92:95],v[188:191]
s_mov_b32 s25, 524288
M v[188:191],a[168:171],a[88:91],v[188:191]
SA m0,s4,8192
M v[192:195],a[160:163],a[32:35],v[192:195]
R a[168:171],v5,55296
R a[172:175],v6,55296
M v[192:195],a[164:167],a[36:39],v[192:195]
buffer_load_dwordx4 v8, s[52:55], s25 offen lds
M v[196:199],a[164:167],a[44:47],v[196:199]
M v[196:199],a[160:163],a[40:43],v[196:199]
s_mov_b32 s25, 786432
T a[156:157],v4,24576
T a[158:159],v4,25600
M v[200:203],a[160:163],a[48:51],v[200:203]
SA m0,s4,12288
M v[200:203],a[164:167],a[52:55],v[200:203]
s_waitcnt vmcnt(19)
buffer_load_dwordx4 v8, s[52:55], s25 offen lds
M v[204:207],a[164:167],a[60:63],v[204:207]
R a[192:195],v20,16384
R a[196:199],v20,18432
M v[204:207],a[160:163],a[56:59],v[204:207]
R a[200:203],v21,16384
R a[204:207],v21,18432
M v[208:211],a[160:163],a[64:67],v[208:211]
M v[208:211],a[164:167],a[68:71],v[208:211]
M v[212:215],a[164:167],a[76:79],v[212:215]
M v[212:215],a[160:163],a[72:75],v[212:215]
M v[216:219],a[160:163],a[80:83],v[216:219]
M v[216:219],a[164:167],a[84:87],v[216:219]
s_waitcnt lgkmcnt(6)
M v[220:223],a[164:167],a[92:95],v[220:223]
s_waitcnt lgkmcnt(0)
M v[220:223],a[160:163],a[88:91],v[220:223]
s_barrier
M v[224:227],a[168:171],a[32:35],v[224:227]
R a[160:163],v5,0
R a[164:167],v6,0
M v[224:227],a[172:175],a[36:39],v[224:227]
M v[228:231],a[172:175],a[44:47],v[228:231]
M v[228:231],a[168:171],a[40:43],v[228:231]
M v[232:235],a[168:171],a[48:51],v[232:235]
M v[232:235],a[172:175],a[52:55],v[232:235]
M v[236:239],a[172:175],a[60:63],v[236:239]
M v[236:239],a[168:171],a[56:59],v[236:239]
M v[240:243],a[168:171],a[64:67],v[240:243]
M v[240:243],a[172:175],a[68:71],v[240:243]
M v[244:247],a[172:175],a[76:79],v[244:247]
M v[244:247],a[168:171],a[72:75],v[244:247]
M v[248:251],a[168:171],a[80:83],v[248:251]
M v[248:251],a[172:175],a[84:87],v[248:251]
s_waitcnt lgkmcnt(0)
M v[252:255],a[172:175],a[92:95],v[252:255]
M v[252:255],a[168:171],a[88:91],v[252:255]
M a[0:3],a[160:163],a[96:99],a[0:3]
R a[168:171],v5,2048
R a[172:175],v6,2048
M a[0:3],a[164:167],a[100:103],a[0:3]
SA m0,s23,147456
T a[32:33],v1,32768
T a[34:35],v1,33792
M a[4:7],a[164:167],a[108:111],a[4:7]
buffer_load_dwordx4 v22, s[56:59], s29 offen offset:0 lds
M a[4:7],a[160:163],a[104:107],a[4:7]
M a[8:11],a[160:163],a[112:115],a[8:11]
M a[8:11],a[164:167],a[116:119],a[8:11]
buffer_load_dwordx4 v23, s[56:59], s29 offen offset:1024 lds
M a[12:15],a[164:167],a[124:127],a[12:15]
s_nop 0
T a[36:37],v1,40960
T a[38:39],v1,41984
M a[12:15],a[160:163],a[120:123],a[12:15]
M a[16:19],a[160:163],a[128:131],a[16:19]
buffer_load_dwordx4 v22, s[56:59], s30 offen offset:2048 lds
M a[16:19],a[164:167],a[132:135],a[16:19]
M a[20:23],a[164:167],a[140:143],a[20:23]
M a[20:23],a[160:163],a[136:139],a[20:23]
s_nop 0
T a[40:41],v2,32768
T a[42:43],v2,33792
M a[24:27],a[160:163],a[144:147],a[24:27]
buffer_load_dwordx4 v23, s[56:59], s30 offen offset:3072 lds
M a[24:27],a[164:167],a[148:151],a[24:27]
s_waitcnt lgkmcnt(6)
M a[28:31],a[164:167],a[156:159],a[28:31]
SA s29,s29,128
M a[28:31],a[160:163],a[152:155],a[28:31]
SA s30,s30,128
M v[32:35],a[168:171],a[96:99],v[32:35]
SA m0,s24,49152
R a[160:163],v5,4096
R a[164:167],v6,4096
M v[32:35],a[172:175],a[100:103],v[32:35]
T a[44:45],v2,40960
T a[46:47],v2,41984
M v[36:39],a[172:175],a[108:111],v[36:39]
buffer_load_dwordx4 v12, s[48:51], s22 offen offset:0   lds
M v[36:39],a[168:171],a[104:107],v[36:39]
M v[40:43],a[168:171],a[112:115],v[40:43]
M v[40:43],a[172:175],a[116:119],v[40:43]
s_nop 0
T a[48:49],v3,32768
T a[50:51],v3,33792
M v[44:47],a[172:175],a[124:127],v[44:47]
buffer_load_dwordx4 v13, s[48:51], s22 offen offset:1024   lds
M v[44:47],a[168:171],a[120:123],v[44:47]
M v[48:51],a[168:171],a[128:131],v[48:51]
M v[48:51],a[172:175],a[132:135],v[48:51]
buffer_load_dwordx4 v14, s[48:51], s22 offen offset:2048   lds
M v[52:55],a[172:175],a[140:143],v[52:55]
s_nop 0
T a[52:53],v3,40960
T a[54:55],v3,41984
M v[52:55],a[168:171],a[136:139],v[52:55]
M v[56:59],a[168:171],a[144:147],v[56:59]
buffer_load_dwordx4 v15, s[48:51], s22 offen offset:3072   lds
M v[56:59],a[172:175],a[148:151],v[56:59]
s_waitcnt lgkmcnt(6)
M v[60:63],a[172:175],a[156:159],v[60:63]
s_sub_u32 s22, s22, 1048448
M v[60:63],a[168:171],a[152:155],v[60:63]
s_mov_b32 s25, 1048576
T a[56:57],v4,32768
T a[58:59],v4,33792
M v[64:67],a[160:163],a[96:99],v[64:67]
SA m0,s4,16384
R a[168:171],v5,6144
R a[172:175],v6,6144
M v[64:67],a[164:167],a[100:103],v[64:67]
buffer_load_dwordx4 v8, s[52:55], s25 offen lds
M v[68:71],a[164:167],a[108:111],v[68:71]
s_mov_b32 s25, 1310720
M v[68:71],a[160:163],a[104:107],v[68:71]
SA m0,s4,20480
M v[72:75],a[160:163],a[112:115],v[72:75]
s_waitcnt vmcnt(17)
s_nop 0
T a[60:61],v4,40960
T a[62:63],v4,41984
M v[72:75],a[164:167],a[116:119],v[72:75]
buffer_load_dwordx4 v8, s[52:55], s25 offen lds
M v[76:79],a[164:167],a[124:127],v[76:79]
s_mov_b32 s25, 1572864
R a[208:211],v20,0
R a[212:215],v20,2048
M v[76:79],a[160:163],a[120:123],v[76:79]
SA m0,s4,24576
R a[216:219],v21,0
R a[220:223],v21,2048
M v[80:83],a[160:163],a[128:131],v[80:83]
buffer_load_dwordx4 v8, s[52:55], s25 offen lds
M v[80:83],a[164:167],a[132:135],v[80:83]
s_mov_b32 s25, 1835008
M v[84:87],a[164:167],a[140:143],v[84:87]
SA m0,s4,28672
M v[84:87],a[160:163],a[136:139],v[84:87]
buffer_load_dwordx4 v8, s[52:55], s25 offen lds
M v[88:91],a[160:163],a[144:147],v[88:91]
M v[88:91],a[164:167],a[148:151],v[88:91]
s_waitcnt lgkmcnt(6)
M v[92:95],a[164:167],a[156:159],v[92:95]
s_waitcnt lgkmcnt(0)
M v[92:95],a[160:163],a[152:155],v[92:95]
s_barrier
M v[96:99],a[168:171],a[96:99],v[96:99]
R a[160:163],v5,16384
R a[164:167],v6,16384
M v[96:99],a[172:175],a[100:103],v[96:99]
SA m0,s23,32768
M v[100:103],a[172:175],a[108:111],v[100:103]
s_nop 0
T a[64:65],v1,49152
T a[66:67],v1,50176
M v[100:103],a[168:171],a[104:107],v[100:103]
buffer_load_dwordx4 v22, s[56:59], s29 offen offset:0 lds
M v[104:107],a[168:171],a[112:115],v[104:107]
v_lshrrev_b32 v28, 2, v0
v_lshlrev_b32 v28, 7, v28
M v[104:107],a[172:175],a[116:119],v[104:107]
M v[108:111],a[172:175],a[124:127],v[108:111]
buffer_load_dwordx4 v23, s[56:59], s29 offen offset:1024 lds
M v[108:111],a[168:171],a[120:123],v[108:111]
v_and_b32 v29, 3, v0
M v[112:115],a[168:171],a[128:131],v[112:115]
v_lshl_add_u32 v28, v29, 3, v28
M v[112:115],a[172:175],a[132:135],v[112:115]
s_nop 0
T a[68:69],v1,57344
T a[70:71],v1,58368
M v[116:119],a[172:175],a[140:143],v[116:119]
buffer_load_dwordx4 v22, s[56:59], s30 offen offset:2048 lds
M v[116:119],a[168:171],a[136:139],v[116:119]
v_bfe_u32 v29, v0, 3, 2
M v[120:123],a[168:171],a[144:147],v[120:123]
M v[120:123],a[172:175],a[148:151],v[120:123]
s_waitcnt lgkmcnt(4)
v_lshl_add_u32 v16, v29, 5, v28
M v[124:127],a[172:175],a[156:159],v[124:127]
M v[124:127],a[168:171],a[152:155],v[124:127]
buffer_load_dwordx4 v23, s[56:59], s30 offen offset:3072 lds
M v[128:131],a[160:163],a[96:99],v[128:131]
R a[168:171],v5,18432
R a[172:175],v6,18432
M v[128:131],a[164:167],a[100:103],v[128:131]
SA s29,s29,128
T a[72:73],v2,49152
T a[74:75],v2,50176
M v[132:135],a[164:167],a[108:111],v[132:135]
SA s30,s30,128
v_xor_b32 v17, 32, v16
v_xor_b32 v18, 64, v16
M v[132:135],a[160:163],a[104:107],v[132:135]
SA m0,s23,65536
M v[136:139],a[160:163],a[112:115],v[136:139]
buffer_load_dwordx4 v22, s[56:59], s29 offen offset:0 lds
M v[136:139],a[164:167],a[116:119],v[136:139]
v_xor_b32 v19, 0x60, v16
M v[140:143],a[164:167],a[124:127],v[140:143]
v_add_u32 v12, 0x20000, v16
M v[140:143],a[160:163],a[120:123],v[140:143]
s_nop 0
T a[76:77],v2,57344
T a[78:79],v2,58368
M v[144:147],a[160:163],a[128:131],v[144:147]
buffer_load_dwordx4 v23, s[56:59], s29 offen offset:1024 lds
M v[144:147],a[164:167],a[132:135],v[144:147]
v_add_u32 v13, 0x20000, v17
M v[148:151],a[164:167],a[140:143],v[148:151]
M v[148:151],a[160:163],a[136:139],v[148:151]
v_add_u32 v14, 0x20000, v18
M v[152:155],a[160:163],a[144:147],v[152:155]
M v[152:155],a[164:167],a[148:151],v[152:155]
s_waitcnt lgkmcnt(4)
buffer_load_dwordx4 v22, s[56:59], s30 offen offset:2048 lds
M v[156:159],a[164:167],a[156:159],v[156:159]
s_nop 0
T a[80:81],v3,49152
T a[82:83],v3,50176
M v[156:159],a[160:163],a[152:155],v[156:159]
v_add_u32 v15, 0x20000, v19
M v[160:163],a[168:171],a[96:99],v[160:163]
R a[160:163],v5,20480
R a[164:167],v6,20480
M v[160:163],a[172:175],a[100:103],v[160:163]
M v[164:167],a[172:175],a[108:111],v[164:167]
buffer_load_dwordx4 v23, s[56:59], s30 offen offset:3072 lds
M v[164:167],a[168:171],a[104:107],v[164:167]
SA s29,s29,128
M v[168:171],a[168:171],a[112:115],v[168:171]
SA s30,s30,128
M v[168:171],a[172:175],a[116:119],v[168:171]
s_mov_b32 s25, 2097152
T a[84:85],v3,57344
T a[86:87],v3,58368
M v[172:175],a[172:175],a[124:127],v[172:175]
SA m0,s4,131072
M v[172:175],a[168:171],a[120:123],v[172:175]
buffer_load_dwordx4 v8, s[52:55], s25 offen lds
M v[176:179],a[168:171],a[128:131],v[176:179]
M v[176:179],a[172:175],a[132:135],v[176:179]
s_mov_b32 s25, 2359296
M v[180:183],a[172:175],a[140:143],v[180:183]
SA m0,s4,135168
M v[180:183],a[168:171],a[136:139],v[180:183]
buffer_load_dwordx4 v8, s[52:55], s25 offen lds
M v[184:187],a[168:171],a[144:147],v[184:187]
s_nop 0
T a[88:89],v4,49152
T a[90:91],v4,50176
M v[184:187],a[172:175],a[148:151],v[184:187]
s_waitcnt lgkmcnt(4)
M v[188:191],a[172:175],a[156:159],v[188:191]
s_mov_b32 s25, 2621440
M v[188:191],a[168:171],a[152:155],v[188:191]
SA m0,s4,139264
M v[192:195],a[160:163],a[96:99],v[192:195]
R a[168:171],v5,22528
R a[172:175],v6,22528
M v[192:195],a[164:167],a[100:103],v[192:195]
buffer_load_dwordx4 v8, s[52:55], s25 offen lds
M v[196:199],a[164:167],a[108:111],v[196:199]
M v[196:199],a[160:163],a[104:107],v[196:199]
s_mov_b32 s25, 2883584
T a[92:93],v4,57344
T a[94:95],v4,58368
M v[200:203],a[160:163],a[112:115],v[200:203]
SA m0,s4,143360
M v[200:203],a[164:167],a[116:119],v[200:203]
s_waitcnt vmcnt(19)
buffer_load_dwordx4 v8, s[52:55], s25 offen lds
M v[204:207],a[164:167],a[124:127],v[204:207]
R a[224:227],v20,16384
R a[228:231],v20,18432
M v[204:207],a[160:163],a[120:123],v[204:207]
R a[232:235],v21,16384
R a[236:239],v21,18432
M v[208:211],a[160:163],a[128:131],v[208:211]
v_subrev_u32 v20, 98304, v20
v_subrev_u32 v21, 98304, v21
M v[208:211],a[164:167],a[132:135],v[208:211]
M v[212:215],a[164:167],a[140:143],v[212:215]
M v[212:215],a[160:163],a[136:139],v[212:215]
M v[216:219],a[160:163],a[144:147],v[216:219]
M v[216:219],a[164:167],a[148:151],v[216:219]
s_waitcnt lgkmcnt(6)
M v[220:223],a[164:167],a[156:159],v[220:223]
s_waitcnt lgkmcnt(0)
M v[220:223],a[160:163],a[152:155],v[220:223]
s_barrier
M v[224:227],a[168:171],a[96:99],v[224:227]
R a[160:163],v5,32768
R a[164:167],v6,32768
M v[224:227],a[172:175],a[100:103],v[224:227]
M v[228:231],a[172:175],a[108:111],v[228:231]
M v[228:231],a[168:171],a[104:107],v[228:231]
M v[232:235],a[168:171],a[112:115],v[232:235]
M v[232:235],a[172:175],a[116:119],v[232:235]
M v[236:239],a[172:175],a[124:127],v[236:239]
M v[236:239],a[168:171],a[120:123],v[236:239]
M v[240:243],a[168:171],a[128:131],v[240:243]
M v[240:243],a[172:175],a[132:135],v[240:243]
M v[244:247],a[172:175],a[140:143],v[244:247]
M v[244:247],a[168:171],a[136:139],v[244:247]
M v[248:251],a[168:171],a[144:147],v[248:251]
M v[248:251],a[172:175],a[148:151],v[248:251]
s_waitcnt lgkmcnt(0)
M v[252:255],a[172:175],a[156:159],v[252:255]
M v[252:255],a[168:171],a[152:155],v[252:255]
M a[0:3],a[160:163],a[32:35],a[0:3]
R a[168:171],v5,34816
R a[172:175],v6,34816
M a[0:3],a[164:167],a[36:39],a[0:3]
SA m0,s23,81920
M a[4:7],a[164:167],a[44:47],a[4:7]
buffer_load_dwordx4 v22, s[56:59], s29 offen offset:0 lds
M a[4:7],a[160:163],a[40:43],a[4:7]
M a[8:11],a[160:163],a[48:51],a[8:11]
M a[8:11],a[164:167],a[52:55],a[8:11]
buffer_load_dwordx4 v23, s[56:59], s29 offen offset:1024 lds
M a[12:15],a[164:167],a[60:63],a[12:15]
M a[12:15],a[160:163],a[56:59],a[12:15]
M a[16:19],a[160:163],a[64:67],a[16:19]
M a[16:19],a[164:167],a[68:71],a[16:19]
buffer_load_dwordx4 v22, s[56:59], s30 offen offset:2048 lds
M a[20:23],a[164:167],a[76:79],a[20:23]
M a[20:23],a[160:163],a[72:75],a[20:23]
M a[24:27],a[160:163],a[80:83],a[24:27]
M a[24:27],a[164:167],a[84:87],a[24:27]
s_waitcnt lgkmcnt(0)
buffer_load_dwordx4 v23, s[56:59], s30 offen offset:3072 lds
M a[28:31],a[164:167],a[92:95],a[28:31]
SA s29,s29,128
M a[28:31],a[160:163],a[88:91],a[28:31]
SA s30,s30,128
M v[32:35],a[168:171],a[32:35],v[32:35]
s_mov_b32 s25, 3145728
R a[160:163],v5,36864
R a[164:167],v6,36864
M v[32:35],a[172:175],a[36:39],v[32:35]
SA m0,s4,147456
M v[36:39],a[172:175],a[44:47],v[36:39]
buffer_load_dwordx4 v8, s[52:55], s25 offen lds
M v[36:39],a[168:171],a[40:43],v[36:39]
s_mov_b32 s25, 3407872
M v[40:43],a[168:171],a[48:51],v[40:43]
SA m0,s4,151552
M v[40:43],a[172:175],a[52:55],v[40:43]
buffer_load_dwordx4 v8, s[52:55], s25 offen lds
M v[44:47],a[172:175],a[60:63],v[44:47]
G v24,a0
G v25,a1
M v[44:47],a[168:171],a[56:59],v[44:47]
s_mov_b32 s25, 128
G v26,a2
G v27,a3
M v[48:51],a[168:171],a[64:67],v[48:51]
SA m0,s4,49152
C v24,v24,v25
C v25,v26,v27
M v[48:51],a[172:175],a[68:71],v[48:51]
buffer_load_dwordx4 v8, s[52:55], s25 offen lds
M v[52:55],a[172:175],a[76:79],v[52:55]
C v26,v32,v33
C v27,v34,v35
M v[52:55],a[168:171],a[72:75],v[52:55]
SA s3,s93,0
M v[56:59],a[168:171],a[80:83],v[56:59]
s_mov_b32 s25, 262272
buffer_store_dwordx4 v[24:27], v7, s[8:11], s3 offen offset:0 sc1
M v[56:59],a[172:175],a[84:87],v[56:59]
s_waitcnt lgkmcnt(0)
G v28,a4
G v29,a5
M v[60:63],a[172:175],a[92:95],v[60:63]
SA m0,s4,53248
G v30,a6
G v31,a7
M v[60:63],a[168:171],a[88:91],v[60:63]
s_waitcnt vmcnt(16)
buffer_load_dwordx4 v8, s[52:55], s25 offen lds
M v[64:67],a[160:163],a[32:35],v[64:67]
s_mov_b32 s25, 524416
R a[168:171],v5,38912
R a[172:175],v6,38912
M v[64:67],a[164:167],a[36:39],v[64:67]
SA m0,s4,57344
C v28,v28,v29
C v29,v30,v31
M v[68:71],a[164:167],a[44:47],v[68:71]
buffer_load_dwordx4 v8, s[52:55], s25 offen lds
M v[68:71],a[160:163],a[40:43],v[68:71]
s_mov_b32 s25, 786560
C v30,v36,v37
C v31,v38,v39
M v[72:75],a[160:163],a[48:51],v[72:75]
SA m0,s4,61440
buffer_store_dwordx4 v[28:31], v7, s[8:11], s3 offen offset:2048 sc1
M v[72:75],a[164:167],a[52:55],v[72:75]
G v24,a8
G v25,a9
M v[76:79],a[164:167],a[60:63],v[76:79]
G v26,a10
G v27,a11
M v[76:79],a[160:163],a[56:59],v[76:79]
buffer_load_dwordx4 v8, s[52:55], s25 offen lds
M v[80:83],a[160:163],a[64:67],v[80:83]
C v24,v24,v25
C v25,v26,v27
M v[80:83],a[164:167],a[68:71],v[80:83]
C v26,v40,v41
C v27,v42,v43
M v[84:87],a[164:167],a[76:79],v[84:87]
SA s3,s93,4096
buffer_store_dwordx4 v[24:27], v7, s[8:11], s3 offen offset:0 sc1
M v[84:87],a[160:163],a[72:75],v[84:87]
R a[96:99],v20,0
R a[100:103],v20,2048
M v[88:91],a[160:163],a[80:83],v[88:91]
R a[104:107],v21,0
R a[108:111],v21,2048
M v[88:91],a[164:167],a[84:87],v[88:91]
s_waitcnt lgkmcnt(4)
G v28,a12
G v29,a13
M v[92:95],a[164:167],a[92:95],v[92:95]
s_waitcnt lgkmcnt(0)
G v30,a14
G v31,a15
M v[92:95],a[160:163],a[88:91],v[92:95]
s_barrier
M v[96:99],a[168:171],a[32:35],v[96:99]
R a[160:163],v5,49152
R a[164:167],v6,49152
M v[96:99],a[172:175],a[36:39],v[96:99]
s_mov_b32 s25, 1048704
L_w_kv17:
s_cbranch_execz L_wd2
C v28,v28,v29
C v29,v30,v31
M v[100:103],a[172:175],a[44:47],v[100:103]
SA m0,s4,98304
C v30,v44,v45
C v31,v46,v47
M v[100:103],a[168:171],a[40:43],v[100:103]
s_waitcnt vmcnt(17)
buffer_store_dwordx4 v[28:31], v7, s[8:11], s3 offen offset:2048 sc1
M v[104:107],a[168:171],a[48:51],v[104:107]
G v24,a16
G v25,a17
M v[104:107],a[172:175],a[52:55],v[104:107]
G v26,a18
G v27,a19
M v[108:111],a[172:175],a[60:63],v[108:111]
buffer_load_dwordx4 v8, s[52:55], s25 offen lds
M v[108:111],a[168:171],a[56:59],v[108:111]
C v24,v24,v25
C v25,v26,v27
M v[112:115],a[168:171],a[64:67],v[112:115]
C v26,v48,v49
C v27,v50,v51
M v[112:115],a[172:175],a[68:71],v[112:115]
SA s3,s93,8192
buffer_store_dwordx4 v[24:27], v7, s[8:11], s3 offen offset:0 sc1
M v[116:119],a[172:175],a[76:79],v[116:119]
s_mov_b32 s25, 1310848
R a[112:115],v20,32768
R a[116:119],v20,34816
M v[116:119],a[168:171],a[72:75],v[116:119]
SA m0,s4,102400
R a[120:123],v21,32768
R a[124:127],v21,34816
M v[120:123],a[168:171],a[80:83],v[120:123]
C v64,v64,v65
C v65,v66,v67
M v[120:123],a[172:175],a[84:87],v[120:123]
s_waitcnt lgkmcnt(4)
buffer_load_dwordx4 v8, s[52:55], s25 offen lds
M v[124:127],a[172:175],a[92:95],v[124:127]
C v66,v96,v97
C v67,v98,v99
M v[124:127],a[168:171],a[88:91],v[124:127]
G v28,a20
G v29,a21
M v[128:131],a[160:163],a[32:35],v[128:131]
R a[168:171],v5,51200
R a[172:175],v6,51200
M v[128:131],a[164:167],a[36:39],v[128:131]
G v30,a22
G v31,a23
M v[132:135],a[164:167],a[44:47],v[132:135]
C v28,v28,v29
C v29,v30,v31
M v[132:135],a[160:163],a[40:43],v[132:135]
s_mov_b32 s25, 1572992
C v30,v52,v53
C v31,v54,v55
M v[136:139],a[160:163],a[48:51],v[136:139]
SA m0,s4,106496
buffer_store_dwordx4 v[28:31], v7, s[8:11], s3 offen offset:2048 sc1
M v[136:139],a[164:167],a[52:55],v[136:139]
C v68,v68,v69
C v69,v70,v71
M v[140:143],a[164:167],a[60:63],v[140:143]
C v70,v100,v101
C v71,v102,v103
M v[140:143],a[160:163],a[56:59],v[140:143]
C v72,v72,v73
C v73,v74,v75
M v[144:147],a[160:163],a[64:67],v[144:147]
buffer_load_dwordx4 v8, s[52:55], s25 offen lds
M v[144:147],a[164:167],a[68:71],v[144:147]
C v74,v104,v105
C v75,v106,v107
M v[148:151],a[164:167],a[76:79],v[148:151]
C v76,v76,v77
C v77,v78,v79
M v[148:151],a[160:163],a[72:75],v[148:151]
C v78,v108,v109
C v79,v110,v111
M v[152:155],a[160:163],a[80:83],v[152:155]
C v80,v80,v81
C v81,v82,v83
M v[152:155],a[164:167],a[84:87],v[152:155]
s_waitcnt lgkmcnt(0)
C v82,v112,v113
C v83,v114,v115
M v[156:159],a[164:167],a[92:95],v[156:159]
s_mov_b32 s25, 1835136
C v84,v84,v85
C v85,v86,v87
M v[156:159],a[160:163],a[88:91],v[156:159]
SA m0,s4,110592
C v86,v116,v117
C v87,v118,v119
M v[160:163],a[168:171],a[32:35],v[160:163]
R a[160:163],v5,53248
R a[164:167],v6,53248
M v[160:163],a[172:175],a[36:39],v[160:163]
buffer_load_dwordx4 v8, s[52:55], s25 offen lds
M v[164:167],a[172:175],a[44:47],v[164:167]
G v24,a24
G v25,a25
M v[164:167],a[168:171],a[40:43],v[164:167]
G v26,a26
G v27,a27
M v[168:171],a[168:171],a[48:51],v[168:171]
C v24,v24,v25
C v25,v26,v27
M v[168:171],a[172:175],a[52:55],v[168:171]
C v26,v56,v57
C v27,v58,v59
M v[172:175],a[172:175],a[60:63],v[172:175]
SA s3,s93,12288
buffer_store_dwordx4 v[24:27], v7, s[8:11], s3 offen offset:0 sc1
M v[172:175],a[168:171],a[56:59],v[172:175]
C v88,v88,v89
C v89,v90,v91
M v[176:179],a[168:171],a[64:67],v[176:179]
C v90,v120,v121
C v91,v122,v123
M v[176:179],a[172:175],a[68:71],v[176:179]
C v92,v92,v93
C v93,v94,v95
M v[180:183],a[172:175],a[76:79],v[180:183]
C v94,v124,v125
C v95,v126,v127
M v[180:183],a[168:171],a[72:75],v[180:183]
G v28,a28
G v29,a29
M v[184:187],a[168:171],a[80:83],v[184:187]
G v30,a30
G v31,a31
M v[184:187],a[172:175],a[84:87],v[184:187]
s_waitcnt lgkmcnt(0)
C v28,v28,v29
C v29,v30,v31
M v[188:191],a[172:175],a[92:95],v[188:191]
C v30,v60,v61
C v31,v62,v63
M v[188:191],a[168:171],a[88:91],v[188:191]
buffer_store_dwordx4 v[28:31], v7, s[8:11], s3 offen offset:2048 sc1
M v[192:195],a[160:163],a[32:35],v[192:195]
s_waitcnt vmcnt(18)
R a[168:171],v5,55296
R a[172:175],v6,55296
M v[192:195],a[164:167],a[36:39],v[192:195]
C v128,v128,v129
C v129,v130,v131
M v[196:199],a[164:167],a[44:47],v[196:199]
C v130,v160,v161
C v131,v162,v163
M v[196:199],a[160:163],a[40:43],v[196:199]
C v132,v132,v133
C v133,v134,v135
M v[200:203],a[160:163],a[48:51],v[200:203]
C v134,v164,v165
C v135,v166,v167
M v[200:203],a[164:167],a[52:55],v[200:203]
C v136,v136,v137
C v137,v138,v139
M v[204:207],a[164:167],a[60:63],v[204:207]
C v138,v168,v169
C v139,v170,v171
M v[204:207],a[160:163],a[56:59],v[204:207]
C v140,v140,v141
C v141,v142,v143
M v[208:211],a[160:163],a[64:67],v[208:211]
C v142,v172,v173
C v143,v174,v175
M v[208:211],a[164:167],a[68:71],v[208:211]
C v144,v144,v145
C v145,v146,v147
M v[212:215],a[164:167],a[76:79],v[212:215]
R a[128:131],v20,49152
R a[132:135],v20,51200
R a[136:139],v21,49152
R a[140:143],v21,51200
M v[212:215],a[160:163],a[72:75],v[212:215]
C v146,v176,v177
C v147,v178,v179
M v[216:219],a[160:163],a[80:83],v[216:219]
C v148,v148,v149
C v149,v150,v151
M v[216:219],a[164:167],a[84:87],v[216:219]
s_waitcnt lgkmcnt(4)
C v150,v180,v181
C v151,v182,v183
M v[220:223],a[164:167],a[92:95],v[220:223]
s_waitcnt vmcnt(16) lgkmcnt(0)
C v152,v152,v153
C v153,v154,v155
M v[220:223],a[160:163],a[88:91],v[220:223]
s_barrier
M v[224:227],a[168:171],a[32:35],v[224:227]
s_nop 0
T v[32:33],v16,0
T v[34:35],v16,2048
M v[224:227],a[172:175],a[36:39],v[224:227]
C v154,v184,v185
C v155,v186,v187
M v[228:231],a[172:175],a[44:47],v[228:231]
T v[36:37],v16,4096
T v[38:39],v16,6144
M v[228:231],a[168:171],a[40:43],v[228:231]
T v[40:41],v16,8192
T v[42:43],v16,10240
M v[232:235],a[168:171],a[48:51],v[232:235]
C v156,v156,v157
C v157,v158,v159
M v[232:235],a[172:175],a[52:55],v[232:235]
T v[44:45],v16,12288
T v[46:47],v16,14336
M v[236:239],a[172:175],a[60:63],v[236:239]
T v[48:49],v16,16384
T v[50:51],v16,18432
M v[236:239],a[168:171],a[56:59],v[236:239]
C v158,v188,v189
C v159,v190,v191
M v[240:243],a[168:171],a[64:67],v[240:243]
T v[52:53],v16,20480
T v[54:55],v16,22528
M v[240:243],a[172:175],a[68:71],v[240:243]
T v[56:57],v16,24576
T v[58:59],v16,26624
M v[244:247],a[172:175],a[76:79],v[244:247]
C v192,v192,v193
C v193,v194,v195
M v[244:247],a[168:171],a[72:75],v[244:247]
C v194,v224,v225
C v195,v226,v227
M v[248:251],a[168:171],a[80:83],v[248:251]
C v196,v196,v197
C v197,v198,v199
M v[248:251],a[172:175],a[84:87],v[248:251]
C v198,v228,v229
C v199,v230,v231
M v[252:255],a[172:175],a[92:95],v[252:255]
C v200,v200,v201
C v201,v202,v203
M v[252:255],a[168:171],a[88:91],v[252:255]
s_waitcnt lgkmcnt(6)
C v202,v232,v233
C v203,v234,v235
M v[96:99],v[32:35],a[176:179],0
s_mul_i32 s72, s41, 4352
T a[144:145],v17,0
T a[146:147],v17,2048
M v[96:99],v[36:39],a[184:187],v[96:99]
SA s46,s72,104923136
C v204,v204,v205
C v205,v206,v207
M v[96:99],v[40:43],a[192:195],v[96:99]
s_waitcnt lgkmcnt(2)
T a[148:149],v17,4096
T a[150:151],v17,6144
M v[96:99],v[44:47],a[200:203],v[96:99]
s_mov_b32 s25, 2097280
T a[152:153],v17,8192
T a[154:155],v17,10240
M v[96:99],v[48:51],a[208:211],v[96:99]
SA m0,s4,114688
C v206,v236,v237
C v207,v238,v239
M v[96:99],v[52:55],a[216:219],v[96:99]
s_lshl_b32 s45, s42, 7
T a[156:157],v17,12288
T a[158:159],v17,14336
M v[96:99],v[56:59],a[224:227],v[96:99]
SA s45,s45,s46
T a[160:161],v17,16384
T a[162:163],v17,18432
M v[100:103],v[56:59],a[228:231],0
s_lshl_b32 s72, s20, 2
buffer_load_dwordx4 v8, s[52:55], s25 offen lds
M v[100:103],v[52:55],a[220:223],v[100:103]
SA s72,s72,s45
T a[164:165],v17,20480
T a[166:167],v17,22528
M v[100:103],v[48:51],a[212:215],v[100:103]
T a[168:169],v17,24576
T a[170:171],v17,26624
M v[100:103],v[44:47],a[204:207],v[100:103]
s_mov_b32 s25, 2359424
C v208,v208,v209
C v209,v210,v211
M v[100:103],v[40:43],a[196:199],v[100:103]
SA m0,s4,118784
C v210,v240,v241
C v211,v242,v243
M v[100:103],v[36:39],a[188:191],v[100:103]
buffer_load_dwordx4 v8, s[52:55], s25 offen lds
M v[100:103],v[32:35],a[180:183],v[100:103]
s_waitcnt lgkmcnt(6)
C v212,v212,v213
C v213,v214,v215
M v[104:107],a[144:147],a[176:179],0
T v[32:33],v18,0
T v[34:35],v18,2048
M v[104:107],a[148:151],a[184:187],v[104:107]
s_mov_b32 s25, 2621568
C v214,v244,v245
C v215,v246,v247
M v[104:107],a[152:155],a[192:195],v[104:107]
s_waitcnt lgkmcnt(2)
T v[36:37],v18,4096
T v[38:39],v18,6144
M v[104:107],a[156:159],a[200:203],v[104:107]
SA m0,s4,122880
T v[40:41],v18,8192
T v[42:43],v18,10240
M v[104:107],a[160:163],a[208:211],v[104:107]
buffer_load_dwordx4 v8, s[52:55], s25 offen lds
M v[104:107],a[164:167],a[216:219],v[104:107]
s_nop 0
T v[44:45],v18,12288
T v[46:47],v18,14336
M v[104:107],a[168:171],a[224:227],v[104:107]
T v[48:49],v18,16384
T v[50:51],v18,18432
M v[108:111],a[168:171],a[228:231],0
s_mov_b32 s25, 2883712
C v216,v216,v217
C v217,v218,v219
M v[108:111],a[164:167],a[220:223],v[108:111]
SA m0,s4,126976
T v[52:53],v18,20480
T v[54:55],v18,22528
M v[108:111],a[160:163],a[212:215],v[108:111]
T v[56:57],v18,24576
T v[58:59],v18,26624
M v[108:111],a[156:159],a[204:207],v[108:111]
buffer_load_dwordx4 v8, s[52:55], s25 offen lds
M v[108:111],a[152:155],a[196:199],v[108:111]
C v218,v248,v249
C v219,v250,v251
M v[108:111],a[148:151],a[188:191],v[108:111]
C v220,v220,v221
C v221,v222,v223
M v[108:111],a[144:147],a[180:183],v[108:111]
s_waitcnt lgkmcnt(6)
C v222,v252,v253
C v223,v254,v255
M v[112:115],v[32:35],a[176:179],0
s_mov_b32 s25, 3145856
T a[144:145],v19,0
T a[146:147],v19,2048
M v[112:115],v[36:39],a[184:187],v[112:115]
SA m0,s4,32768
v_min_u32 v29, 1, v0
v_lshlrev_b32 v29, 29, v29
M v[112:115],v[40:43],a[192:195],v[112:115]
s_waitcnt lgkmcnt(2)
T a[148:149],v19,4096
T a[150:151],v19,6144
M v[112:115],v[44:47],a[200:203],v[112:115]
T a[152:153],v19,8192
T a[154:155],v19,10240
M v[112:115],v[48:51],a[208:211],v[112:115]
buffer_load_dwordx4 v8, s[52:55], s25 offen lds
M v[112:115],v[52:55],a[216:219],v[112:115]
s_nop 0
T a[156:157],v19,12288
T a[158:159],v19,14336
M v[112:115],v[56:59],a[224:227],v[112:115]
T a[160:161],v19,16384
T a[162:163],v19,18432
M v[116:119],v[56:59],a[228:231],0
s_mov_b32 s25, 3408000
v_mov_b32 v30, 1
v_add_u32 v20, 0x10000, v16
M v[116:119],v[52:55],a[220:223],v[116:119]
SA m0,s4,36864
T a[164:165],v19,20480
T a[166:167],v19,22528
M v[116:119],v[48:51],a[212:215],v[116:119]
s_waitcnt vmcnt(5)
T a[168:169],v19,24576
T a[170:171],v19,26624
M v[116:119],v[44:47],a[204:207],v[116:119]
SA s3,s93,524288
buffer_load_dwordx4 v8, s[52:55], s25 offen lds
M v[116:119],v[40:43],a[196:199],v[116:119]
buffer_store_dword v30, v29, s[8:11], s72 offen offset:4 sc1
M v[116:119],v[36:39],a[188:191],v[116:119]
v_add_u32 v21, 0x10000, v17
v_add_u32 v22, 0x10000, v18
M v[116:119],v[32:35],a[180:183],v[116:119]
s_waitcnt lgkmcnt(6)
buffer_store_dwordx4 v[64:67], v7, s[8:11], s3 offen offset:0 sc1
M v[120:123],a[144:147],a[176:179],0
s_mov_b32 s25, 256
T v[32:33],v16,28672
T v[34:35],v16,30720
M v[120:123],a[148:151],a[184:187],v[120:123]
SA m0,s4,65536
v_add_u32 v23, 0x10000, v19
v_or_b32 v1, s20, v0
M v[120:123],a[152:155],a[192:195],v[120:123]
s_waitcnt lgkmcnt(2)
T v[36:37],v12,0
T v[38:39],v12,2048
M v[120:123],a[156:159],a[200:203],v[120:123]
T v[40:41],v12,4096
T v[42:43],v12,6144
M v[120:123],a[160:163],a[208:211],v[120:123]
buffer_load_dwordx4 v8, s[52:55], s25 offen lds
M v[120:123],a[164:167],a[216:219],v[120:123]
s_nop 0
T v[44:45],v12,8192
T v[46:47],v12,10240
M v[120:123],a[168:171],a[224:227],v[120:123]
T v[48:49],v12,12288
T v[50:51],v12,14336
M v[124:127],a[168:171],a[228:231],0
s_mov_b32 s25, 262400
buffer_store_dwordx4 v[68:71], v7, s[8:11], s3 offen offset:2048 sc1
M v[124:127],a[164:167],a[220:223],v[124:127]
SA m0,s4,69632
T v[52:53],v12,16384
T v[54:55],v12,18432
M v[124:127],a[160:163],a[212:215],v[124:127]
T v[56:57],v12,20480
T v[58:59],v12,22528
M v[124:127],a[156:159],a[204:207],v[124:127]
buffer_load_dwordx4 v8, s[52:55], s25 offen lds
M v[124:127],a[152:155],a[196:199],v[124:127]
v_min_u32 v1, 1, v1
v_lshlrev_b32 v1, 29, v1
M v[124:127],a[148:151],a[188:191],v[124:127]
v_min_u32 v9, 15, v0
v_lshlrev_b32 v9, 7, v9
M v[124:127],a[144:147],a[180:183],v[124:127]
s_waitcnt lgkmcnt(6)
M v[96:99],v[32:35],a[232:235],v[96:99]
s_mov_b32 s25, 524544
T a[144:145],v17,28672
T a[146:147],v17,30720
M v[96:99],v[36:39],a[96:99],v[96:99]
SA m0,s4,73728
M v[96:99],v[40:43],a[104:107],v[96:99]
s_waitcnt lgkmcnt(2)
s_nop 0
T a[148:149],v13,0
T a[150:151],v13,2048
M v[96:99],v[44:47],a[112:115],v[96:99]
SA s3,s93,528384
T a[152:153],v13,4096
T a[154:155],v13,6144
M v[96:99],v[48:51],a[120:123],v[96:99]
s_sub_u32 s66, 15, s42
buffer_load_dwordx4 v8, s[52:55], s25 offen lds
M v[96:99],v[52:55],a[128:131],v[96:99]
s_max_u32 s67, s66, s42
T a[156:157],v13,8192
T a[158:159],v13,10240
M v[96:99],v[56:59],a[136:139],v[96:99]
s_min_u32 s66, s66, s42
T a[160:161],v13,12288
T a[162:163],v13,14336
M v[100:103],v[56:59],a[140:143],v[100:103]
s_mov_b32 s25, 786688
buffer_store_dwordx4 v[72:75], v7, s[8:11], s3 offen offset:0 sc1
M v[100:103],v[52:55],a[132:135],v[100:103]
SA m0,s4,77824
T a[164:165],v13,16384
T a[166:167],v13,18432
M v[100:103],v[48:51],a[124:127],v[100:103]
s_mul_i32 s21, s41, 1048576
T a[168:169],v13,20480
T a[170:171],v13,22528
M v[100:103],v[44:47],a[116:119],v[100:103]
s_lshl_b32 s64, s67, 16
buffer_load_dwordx4 v8, s[52:55], s25 offen lds
M v[100:103],v[40:43],a[108:111],v[100:103]
SA s32,s21,s64
M v[100:103],v[36:39],a[100:103],v[100:103]
s_lshl_b32 s64, s20, 14
buffer_store_dwordx4 v[76:79], v7, s[8:11], s3 offen offset:2048 sc1
M v[100:103],v[32:35],a[236:239],v[100:103]
s_waitcnt lgkmcnt(6)
M v[104:107],a[144:147],a[232:235],v[104:107]
s_mov_b32 s25, 1048832
T v[32:33],v18,28672
T v[34:35],v18,30720
M v[104:107],a[148:151],a[96:99],v[104:107]
SA m0,s4,81920
M v[104:107],a[152:155],a[104:107],v[104:107]
s_waitcnt lgkmcnt(2)
s_nop 0
T v[36:37],v14,0
T v[38:39],v14,2048
M v[104:107],a[156:159],a[112:115],v[104:107]
SA s32,s32,s64
T v[40:41],v14,4096
T v[42:43],v14,6144
M v[104:107],a[160:163],a[120:123],v[104:107]
SA s32,s32,33554432
buffer_load_dwordx4 v8, s[52:55], s25 offen lds
M v[104:107],a[164:167],a[128:131],v[104:107]
s_sub_u32 s64, s42, 10
T v[44:45],v14,8192
T v[46:47],v14,10240
M v[104:107],a[168:171],a[136:139],v[104:107]
s_and_b32 s35, s64, 536870912
T v[48:49],v14,12288
T v[50:51],v14,14336
M v[108:111],a[168:171],a[140:143],v[108:111]
s_mov_b32 s25, 1310976
v_or_b32 v6, s35, v7
M v[108:111],a[164:167],a[132:135],v[108:111]
SA m0,s4,86016
T v[52:53],v14,16384
T v[54:55],v14,18432
M v[108:111],a[160:163],a[124:127],v[108:111]
s_lshl_b32 s28, s20, 13
T v[56:57],v14,20480
T v[58:59],v14,22528
M v[108:111],a[156:159],a[116:119],v[108:111]
buffer_load_dwordx4 v8, s[52:55], s25 offen lds
M v[108:111],a[152:155],a[108:111],v[108:111]
v_add_u32 v2, 0x10000, v7
v_add_u32 v3, s28, v7
M v[108:111],a[148:151],a[100:103],v[108:111]
v_add_u32 v4, 0x1000, v3
MF v96,s5,v96
M v[108:111],a[144:147],a[236:239],v[108:111]
s_waitcnt lgkmcnt(6)
MF v97,s5,v97
MF v98,s5,v98
M v[112:115],v[32:35],a[232:235],v[112:115]
s_mov_b32 s25, 1573120
T a[144:145],v19,28672
T a[146:147],v19,30720
M v[112:115],v[36:39],a[96:99],v[112:115]
SA m0,s4,90112
MF v99,s5,v99
L_w_kv18:
s_cbranch_execz L_wd2
MF v104,s5,v104
M v[112:115],v[40:43],a[104:107],v[112:115]
s_waitcnt lgkmcnt(2)
T a[148:149],v15,0
T a[150:151],v15,2048
M v[112:115],v[44:47],a[112:115],v[112:115]
s_lshl_b32 s64, s42, 16
T a[152:153],v15,4096
T a[154:155],v15,6144
M v[112:115],v[48:51],a[120:123],v[112:115]
SA s23,s21,s64
buffer_load_dwordx4 v8, s[52:55], s25 offen lds
M v[112:115],v[52:55],a[128:131],v[112:115]
SA s43,s23,16777216
T a[156:157],v15,8192
T a[158:159],v15,10240
M v[112:115],v[56:59],a[136:139],v[112:115]
SA s26,s21,16777216
T a[160:161],v15,12288
T a[162:163],v15,14336
M v[116:119],v[56:59],a[140:143],v[116:119]
s_mov_b32 s25, 1835264
MF v105,s5,v105
MF v106,s5,v106
M v[116:119],v[52:55],a[132:135],v[116:119]
SA m0,s4,94208
T a[164:165],v15,16384
T a[166:167],v15,18432
M v[116:119],v[48:51],a[124:127],v[116:119]
s_min_u32 s27, s42, 9
T a[168:169],v15,20480
T a[170:171],v15,22528
M v[116:119],v[44:47],a[116:119],v[116:119]
s_lshl_b32 s22, s27, 1
buffer_load_dwordx4 v8, s[52:55], s25 offen lds
M v[116:119],v[40:43],a[108:111],v[116:119]
s_sub_u32 s22, s22, 1
MF v107,s5,v107
C v96,v96,v97
M v[116:119],v[36:39],a[100:103],v[116:119]
s_waitcnt vmcnt(13) lgkmcnt(0)
C v97,v98,v99
C v98,v104,v105
M v[116:119],v[32:35],a[236:239],v[116:119]
s_barrier
M v[120:123],a[144:147],a[232:235],v[120:123]
s_mov_b32 s25, 2097408
T v[32:33],v16,49152
T v[34:35],v16,51200
M v[120:123],a[148:151],a[96:99],v[120:123]
SA m0,s4,155648
C v99,v106,v107
W a0,v96
M v[120:123],a[152:155],a[104:107],v[120:123]
s_sub_u32 s27, s27, 2
T v[36:37],v16,53248
T v[38:39],v16,55296
M v[120:123],a[156:159],a[112:115],v[120:123]
s_mov_b32 s31, 0x4b800000
T v[40:41],v16,57344
T v[42:43],v16,59392
M v[120:123],a[160:163],a[120:123],v[120:123]
s_mov_b32 s24, 0x33800000
buffer_load_dwordx4 v8, s[52:55], s25 offen lds
M v[120:123],a[164:167],a[128:131],v[120:123]
s_lshl_b32 s47, s66, 7
T v[44:45],v16,61440
T v[46:47],v16,63488
M v[120:123],a[168:171],a[136:139],v[120:123]
SA s47,s47,s46
T v[48:49],v20,32768
T v[50:51],v20,34816
M v[124:127],a[168:171],a[140:143],v[124:127]
s_mov_b32 s25, 2359552
W a1,v97
W a2,v98
M v[124:127],a[164:167],a[132:135],v[124:127]
SA m0,s4,159744
T v[52:53],v20,36864
T v[54:55],v20,38912
M v[124:127],a[160:163],a[124:127],v[124:127]
s_lshl_b32 s64, s20, 5
T v[56:57],v20,40960
T v[58:59],v20,43008
M v[124:127],a[156:159],a[116:119],v[124:127]
SA s47,s47,s64
buffer_load_dwordx4 v8, s[52:55], s25 offen lds
M v[124:127],a[152:155],a[108:111],v[124:127]
SA s47,s47,2048
W a3,v99
MF v100,s5,v100
M v[124:127],a[148:151],a[100:103],v[124:127]
SA s30,s32,0
buffer_store_dwordx4 a[0:3], v6, s[8:11], s30 offen offset:0 sc1
M v[124:127],a[144:147],a[236:239],v[124:127]
s_waitcnt lgkmcnt(6)
MF v101,s5,v101
MF v102,s5,v102
M v[160:163],v[32:35],a[176:179],0
s_lshl_b32 s65, s41, 3
T a[144:145],v17,49152
T a[146:147],v17,51200
M v[160:163],v[36:39],a[184:187],v[160:163]
SA s65,s65,s66
MF v103,s5,v103
MF v108,s5,v108
M v[160:163],v[40:43],a[192:195],v[160:163]
s_waitcnt lgkmcnt(2)
T a[148:149],v17,53248
T a[150:151],v17,55296
M v[160:163],v[44:47],a[200:203],v[160:163]
s_mul_i32 s34, s65, 73728
T a[152:153],v17,57344
T a[154:155],v17,59392
M v[160:163],v[48:51],a[208:211],v[160:163]
SA s34,s34,136314880
MF v109,s5,v109
MF v110,s5,v110
M v[160:163],v[52:55],a[216:219],v[160:163]
s_lshl_b32 s65, s42, 4
T a[156:157],v17,61440
T a[158:159],v17,63488
M v[160:163],v[56:59],a[224:227],v[160:163]
SA s65,s65,s41
T a[160:161],v21,32768
T a[162:163],v21,34816
M v[164:167],v[56:59],a[228:231],0
s_mul_i32 s33, s65, 114688
MF v111,s5,v111
C v100,v100,v101
M v[164:167],v[52:55],a[220:223],v[164:167]
s_mul_i32 s65, s20, 28672
T a[164:165],v21,36864
T a[166:167],v21,38912
M v[164:167],v[48:51],a[212:215],v[164:167]
SA s33,s33,s65
T a[168:169],v21,40960
T a[170:171],v21,43008
M v[164:167],v[44:47],a[204:207],v[164:167]
SA s33,s33,67108864
C v101,v102,v103
C v102,v108,v109
M v[164:167],v[40:43],a[196:199],v[164:167]
s_mov_b32 s6, 0
C v103,v110,v111
W a32,v100
M v[164:167],v[36:39],a[188:191],v[164:167]
s_mov_b32 s7, 1
W a33,v101
W a34,v102
M v[164:167],v[32:35],a[180:183],v[164:167]
s_waitcnt lgkmcnt(6)
W a35,v103
MF v112,s5,v112
M v[168:171],a[144:147],a[176:179],0
SA s30,s32,8192
T v[32:33],v18,49152
T v[34:35],v18,51200
M v[168:171],a[148:151],a[184:187],v[168:171]
s_mov_b32 s40, 1
buffer_store_dwordx4 a[32:35], v6, s[8:11], s30 offen offset:0 sc1
M v[168:171],a[152:155],a[192:195],v[168:171]
s_waitcnt lgkmcnt(2)
s_nop 0
T v[36:37],v18,53248
T v[38:39],v18,55296
M v[168:171],a[156:159],a[200:203],v[168:171]
s_cmp_eq_u32 s20, 0
T v[40:41],v18,57344
T v[42:43],v18,59392
M v[168:171],a[160:163],a[208:211],v[168:171]
s_cselect_b32 s39, 6, 0
MF v113,s5,v113
MF v114,s5,v114
M v[168:171],a[164:167],a[216:219],v[168:171]
s_cmp_eq_u32 s42, 8
T v[44:45],v18,61440
T v[46:47],v18,63488
M v[168:171],a[168:171],a[224:227],v[168:171]
s_cselect_b32 s64, 0, 0
T v[48:49],v22,32768
T v[50:51],v22,34816
M v[172:175],a[168:171],a[228:231],0
s_or_b32 s39, s39, s64
MF v115,s5,v115
MF v120,s5,v120
M v[172:175],a[164:167],a[220:223],v[172:175]
s_mov_b64 s[60:61], s[76:77]
T v[52:53],v22,36864
T v[54:55],v22,38912
M v[172:175],a[160:163],a[212:215],v[172:175]
s_mov_b32 s62, s78
T v[56:57],v22,40960
T v[58:59],v22,43008
M v[172:175],a[156:159],a[204:207],v[172:175]
s_mov_b32 s63, 0x20000
v_lshrrev_b32 v24, 4, v0
v_lshlrev_b32 v24, 2, v24
M v[172:175],a[152:155],a[196:199],v[172:175]
s_mov_b32 s25, 2621696
v_and_b32 v25, 15, v0
v_sub_u32 v24, v24, v25
M v[172:175],a[148:151],a[188:191],v[172:175]
SA m0,s4,131072
v_cmp_lt_i32 s[16:17], 0, v24
v_cmp_lt_i32 s[18:19], -1, v24
M v[172:175],a[144:147],a[180:183],v[172:175]
s_waitcnt lgkmcnt(6)
buffer_load_dwordx4 v8, s[52:55], s25 offen lds
M v[176:179],v[32:35],a[176:179],0
SA s3,s93,532480
T a[144:145],v19,49152
T a[146:147],v19,51200
M v[176:179],v[36:39],a[184:187],v[176:179]
v_cmp_lt_i32 s[48:49], -2, v24
v_cmp_lt_i32 s[50:51], -3, v24
M v[176:179],v[40:43],a[192:195],v[176:179]
s_waitcnt lgkmcnt(2)
T a[148:149],v19,53248
T a[150:151],v19,55296
M v[176:179],v[44:47],a[200:203],v[176:179]
s_mov_b32 s25, 2883840
T a[152:153],v19,57344
T a[154:155],v19,59392
M v[176:179],v[48:51],a[208:211],v[176:179]
SA m0,s4,135168
buffer_store_dwordx4 v[80:83], v7, s[8:11], s3 offen offset:0 sc1
M v[176:179],v[52:55],a[216:219],v[176:179]
s_nop 0
T a[156:157],v19,61440
T a[158:159],v19,63488
M v[176:179],v[56:59],a[224:227],v[176:179]
T a[160:161],v23,32768
T a[162:163],v23,34816
M v[180:183],v[56:59],a[228:231],0
buffer_load_dwordx4 v8, s[52:55], s25 offen lds
M v[180:183],v[52:55],a[220:223],v[180:183]
s_nop 0
T a[164:165],v23,36864
T a[166:167],v23,38912
M v[180:183],v[48:51],a[212:215],v[180:183]
T a[168:169],v23,40960
T a[170:171],v23,43008
M v[180:183],v[44:47],a[204:207],v[180:183]
s_mov_b32 s25, 3145984
buffer_store_dwordx4 v[84:87], v7, s[8:11], s3 offen offset:2048 sc1
M v[180:183],v[40:43],a[196:199],v[180:183]
SA m0,s4,139264
v_lshl_add_u32 v25, v0, 7, s95
v_and_b32 v0, 48, v0
M v[180:183],v[36:39],a[188:191],v[180:183]
buffer_load_dwordx4 v8, s[52:55], s25 offen lds
M v[180:183],v[32:35],a[180:183],v[180:183]
s_waitcnt lgkmcnt(6)
MF v121,s5,v121
MF v122,s5,v122
M v[184:187],a[144:147],a[176:179],0
T v[32:33],v20,45056
T v[34:35],v20,47104
M v[184:187],a[148:151],a[184:187],v[184:187]
s_mov_b32 s25, 3408128
MF v123,s5,v123
C v112,v112,v113
M v[184:187],a[152:155],a[192:195],v[184:187]
s_waitcnt lgkmcnt(2)
T v[36:37],v20,49152
T v[38:39],v20,51200
M v[184:187],a[156:159],a[200:203],v[184:187]
SA m0,s4,143360
T v[40:41],v20,53248
T v[42:43],v20,55296
M v[184:187],a[160:163],a[208:211],v[184:187]
SA s3,s93,536576
buffer_load_dwordx4 v8, s[52:55], s25 offen lds
M v[184:187],a[164:167],a[216:219],v[184:187]
s_nop 0
T v[44:45],v20,57344
T v[46:47],v20,59392
M v[184:187],a[168:171],a[224:227],v[184:187]
T v[48:49],v20,61440
T v[50:51],v20,63488
M v[188:191],a[168:171],a[228:231],0
s_mov_b32 s25, 384
buffer_store_dwordx4 v[88:91], v7, s[8:11], s3 offen offset:0 sc1
M v[188:191],a[164:167],a[220:223],v[188:191]
SA m0,s4,0
T v[52:53],v16,32768
T v[54:55],v16,34816
M v[188:191],a[160:163],a[212:215],v[188:191]
T v[56:57],v16,36864
T v[58:59],v16,38912
M v[188:191],a[156:159],a[204:207],v[188:191]
buffer_load_dwordx4 v8, s[52:55], s25 offen lds
M v[188:191],a[152:155],a[196:199],v[188:191]
C v113,v114,v115
C v114,v120,v121
M v[188:191],a[148:151],a[188:191],v[188:191]
buffer_store_dwordx4 v[92:95], v7, s[8:11], s3 offen offset:2048 sc1
M v[188:191],a[144:147],a[180:183],v[188:191]
s_waitcnt lgkmcnt(6)
C v115,v122,v123
W a4,v112
M v[160:163],v[32:35],a[232:235],v[160:163]
s_mov_b32 s25, 262528
T a[144:145],v21,45056
T a[146:147],v21,47104
M v[160:163],v[36:39],a[96:99],v[160:163]
SA m0,s4,4096
W a5,v113
W a6,v114
M v[160:163],v[40:43],a[104:107],v[160:163]
s_waitcnt lgkmcnt(2)
T a[148:149],v21,49152
T a[150:151],v21,51200
M v[160:163],v[44:47],a[112:115],v[160:163]
T a[152:153],v21,53248
T a[154:155],v21,55296
M v[160:163],v[48:51],a[120:123],v[160:163]
buffer_load_dwordx4 v8, s[52:55], s25 offen lds
M v[160:163],v[52:55],a[128:131],v[160:163]
s_nop 0
T a[156:157],v21,57344
T a[158:159],v21,59392
M v[160:163],v[56:59],a[136:139],v[160:163]
T a[160:161],v21,61440
T a[162:163],v21,63488
M v[164:167],v[56:59],a[140:143],v[164:167]
s_mov_b32 s25, 524672
W a7,v115
v_lshl_add_u32 v0, v0, 24, v25
M v[164:167],v[52:55],a[132:135],v[164:167]
SA s30,s32,0
T a[164:165],v17,32768
T a[166:167],v17,34816
M v[164:167],v[48:51],a[124:127],v[164:167]
SA m0,s4,8192
T a[168:169],v17,36864
T a[170:171],v17,38912
M v[164:167],v[44:47],a[116:119],v[164:167]
buffer_store_dwordx4 a[4:7], v6, s[8:11], s30 offen offset:1024 sc1
M v[164:167],v[40:43],a[108:111],v[164:167]
v_mov_b32 v24, 0x3f80
MF v116,s5,v116
M v[164:167],v[36:39],a[100:103],v[164:167]
buffer_load_dwordx4 v8, s[52:55], s25 offen lds
M v[164:167],v[32:35],a[236:239],v[164:167]
s_waitcnt lgkmcnt(6)
MF v117,s5,v117
MF v118,s5,v118
M v[168:171],a[144:147],a[232:235],v[168:171]
T v[32:33],v22,45056
T v[34:35],v22,47104
M v[168:171],a[148:151],a[96:99],v[168:171]
s_mov_b32 s25, 786816
MF v119,s5,v119
MF v124,s5,v124
M v[168:171],a[152:155],a[104:107],v[168:171]
s_waitcnt lgkmcnt(2)
T v[36:37],v22,49152
T v[38:39],v22,51200
M v[168:171],a[156:159],a[112:115],v[168:171]
SA m0,s4,12288
T v[40:41],v22,53248
T v[42:43],v22,55296
M v[168:171],a[160:163],a[120:123],v[168:171]
buffer_load_dwordx4 v8, s[52:55], s25 offen lds
M v[168:171],a[164:167],a[128:131],v[168:171]
s_nop 0
T v[44:45],v22,57344
T v[46:47],v22,59392
M v[168:171],a[168:171],a[136:139],v[168:171]
T v[48:49],v22,61440
T v[50:51],v22,63488
M v[172:175],a[168:171],a[140:143],v[172:175]
s_mov_b32 s25, 1048960
MF v125,s5,v125
MF v126,s5,v126
M v[172:175],a[164:167],a[132:135],v[172:175]
SA m0,s4,16384
T v[52:53],v18,32768
T v[54:55],v18,34816
M v[172:175],a[160:163],a[124:127],v[172:175]
T v[56:57],v18,36864
T v[58:59],v18,38912
M v[172:175],a[156:159],a[116:119],v[172:175]
buffer_load_dwordx4 v8, s[52:55], s25 offen lds
M v[172:175],a[152:155],a[108:111],v[172:175]
MF v127,s5,v127
C v116,v116,v117
M v[172:175],a[148:151],a[100:103],v[172:175]
v_lshrrev_b32 v25, 8, v7
v_bfe_u32 v26, v7, 6, 2
v_and_b32 v27, 16, v7
v_lshlrev_b32 v27, v27, v24
v_cmp_eq_u32 vcc, v25, v26
v_and_b32 v28, 32, v7
W a244,0
v_cndmask_b32 v27, 0, v27, vcc
v_cmp_eq_u32 vcc, 0, v28
W a245,0
W a248,0
v_cndmask_b32 v25, 0, v27, vcc
v_sub_u32 v26, v27, v25
W a249,0
W a246,v25
W a247,v26
M v[172:175],a[144:147],a[236:239],v[172:175]
s_waitcnt lgkmcnt(6)
C v117,v118,v119
C v118,v124,v125
M v[176:179],v[32:35],a[232:235],v[176:179]
s_mov_b32 s25, 1311104
T a[144:145],v23,45056
T a[146:147],v23,47104
M v[176:179],v[36:39],a[96:99],v[176:179]
SA m0,s4,20480
C v119,v126,v127
W a36,v116
M v[176:179],v[40:43],a[104:107],v[176:179]
s_waitcnt lgkmcnt(2)
T a[148:149],v23,49152
T a[150:151],v23,51200
M v[176:179],v[44:47],a[112:115],v[176:179]
T a[152:153],v23,53248
T a[154:155],v23,55296
M v[176:179],v[48:51],a[120:123],v[176:179]
buffer_load_dwordx4 v8, s[52:55], s25 offen lds
M v[176:179],v[52:55],a[128:131],v[176:179]
s_nop 0
T a[156:157],v23,57344
T a[158:159],v23,59392
M v[176:179],v[56:59],a[136:139],v[176:179]
T a[160:161],v23,61440
T a[162:163],v23,63488
M v[180:183],v[56:59],a[140:143],v[180:183]
s_mov_b32 s25, 1573248
W a37,v117
W a38,v118
M v[180:183],v[52:55],a[132:135],v[180:183]
SA m0,s4,24576
T a[164:165],v19,32768
T a[166:167],v19,34816
M v[180:183],v[48:51],a[124:127],v[180:183]
T a[168:169],v19,36864
T a[170:171],v19,38912
M v[180:183],v[44:47],a[116:119],v[180:183]
buffer_load_dwordx4 v8, s[52:55], s25 offen lds
M v[180:183],v[40:43],a[108:111],v[180:183]
W a39,v119
MF v160,s5,v160
M v[180:183],v[36:39],a[100:103],v[180:183]
s_waitcnt vmcnt(10) lgkmcnt(0)
MF v161,s5,v161
MF v162,s5,v162
M v[180:183],v[32:35],a[236:239],v[180:183]
s_barrier
M v[184:187],a[144:147],a[232:235],v[184:187]
SA s30,s32,8192
T v[32:33],v20,0
T v[34:35],v20,2048
M v[184:187],a[148:151],a[96:99],v[184:187]
s_mov_b32 s25, 1835392
buffer_store_dwordx4 a[36:39], v6, s[8:11], s30 offen offset:1024 sc1
M v[184:187],a[152:155],a[104:107],v[184:187]
SA m0,s4,28672
T v[36:37],v20,4096
T v[38:39],v20,6144
M v[184:187],a[156:159],a[112:115],v[184:187]
T v[40:41],v20,8192
T v[42:43],v20,10240
M v[184:187],a[160:163],a[120:123],v[184:187]
buffer_load_dwordx4 v8, s[52:55], s25 offen lds
M v[184:187],a[164:167],a[128:131],v[184:187]
s_nop 0
T v[44:45],v20,12288
T v[46:47],v20,14336
M v[184:187],a[168:171],a[136:139],v[184:187]
T v[48:49],v20,16384
T v[50:51],v20,18432
M v[188:191],a[168:171],a[140:143],v[188:191]
s_mov_b32 s25, 2097536
MF v163,s5,v163
MF v168,s5,v168
M v[188:191],a[164:167],a[132:135],v[188:191]
SA m0,s4,40960
T v[52:53],v20,20480
T v[54:55],v20,22528
M v[188:191],a[160:163],a[124:127],v[188:191]
T v[56:57],v20,24576
T v[58:59],v20,26624
M v[188:191],a[156:159],a[116:119],v[188:191]
buffer_load_dwordx4 v8, s[52:55], s25 offen lds
M v[188:191],a[152:155],a[108:111],v[188:191]
MF v169,s5,v169
MF v170,s5,v170
M v[188:191],a[148:151],a[100:103],v[188:191]
MF v171,s5,v171
C v160,v160,v161
M v[188:191],a[144:147],a[236:239],v[188:191]
s_waitcnt lgkmcnt(6)
C v161,v162,v163
C v162,v168,v169
M v[96:99],v[32:35],a[176:179],0
s_mov_b32 s25, 2359680
T a[144:145],v21,0
T a[146:147],v21,2048
M v[96:99],v[36:39],a[184:187],v[96:99]
SA m0,s4,45056
C v163,v170,v171
W a8,v160
M v[96:99],v[40:43],a[192:195],v[96:99]
s_waitcnt lgkmcnt(2)
T a[148:149],v21,4096
T a[150:151],v21,6144
M v[96:99],v[44:47],a[200:203],v[96:99]
T a[152:153],v21,8192
T a[154:155],v21,10240
M v[96:99],v[48:51],a[208:211],v[96:99]
buffer_load_dwordx4 v8, s[52:55], s25 offen lds
M v[96:99],v[52:55],a[216:219],v[96:99]
s_nop 0
T a[156:157],v21,12288
T a[158:159],v21,14336
M v[96:99],v[56:59],a[224:227],v[96:99]
T a[160:161],v21,16384
T a[162:163],v21,18432
M v[100:103],v[56:59],a[228:231],0
s_mov_b32 s25, 2621824
W a9,v161
W a10,v162
M v[100:103],v[52:55],a[220:223],v[100:103]
SA m0,s4,49152
T a[164:165],v21,20480
T a[166:167],v21,22528
M v[100:103],v[48:51],a[212:215],v[100:103]
T a[168:169],v21,24576
T a[170:171],v21,26624
M v[100:103],v[44:47],a[204:207],v[100:103]
buffer_load_dwordx4 v8, s[52:55], s25 offen lds
M v[100:103],v[40:43],a[196:199],v[100:103]
W a11,v163
v_lshrrev_b32 v31, 6, v7
M v[100:103],v[36:39],a[188:191],v[100:103]
SA s30,s32,0
buffer_store_dwordx4 a[8:11], v6, s[8:11], s30 offen offset:2048 sc1
M v[100:103],v[32:35],a[180:183],v[100:103]
s_waitcnt lgkmcnt(6)
v_bfe_u32 v28, v7, 4, 2
v_lshlrev_b32 v31, 5, v31
M v[104:107],a[144:147],a[176:179],0
s_mov_b32 s25, 2883968
T v[32:33],v22,0
T v[34:35],v22,2048
M v[104:107],a[148:151],a[184:187],v[104:107]
SA m0,s4,53248
v_add_lshl_u32 v31, v31, v28, 2
MF v164,s5,v164
M v[104:107],a[152:155],a[192:195],v[104:107]
s_waitcnt lgkmcnt(2)
T v[36:37],v22,4096
T v[38:39],v22,6144
M v[104:107],a[156:159],a[200:203],v[104:107]
T v[40:41],v22,8192
T v[42:43],v22,10240
M v[104:107],a[160:163],a[208:211],v[104:107]
buffer_load_dword v5, v31, s[8:11], s46 offen offset:4 sc1
M v[104:107],a[164:167],a[216:219],v[104:107]
s_nop 0
T v[44:45],v22,12288
T v[46:47],v22,14336
M v[104:107],a[168:171],a[224:227],v[104:107]
T v[48:49],v22,16384
T v[50:51],v22,18432
M v[108:111],a[168:171],a[228:231],0
buffer_load_dwordx4 v8, s[52:55], s25 offen lds
M v[108:111],a[164:167],a[220:223],v[108:111]
s_nop 0
T v[52:53],v22,20480
T v[54:55],v22,22528
M v[108:111],a[160:163],a[212:215],v[108:111]
T v[56:57],v22,24576
T v[58:59],v22,26624
M v[108:111],a[156:159],a[204:207],v[108:111]
s_mov_b32 s25, 3146112
MF v165,s5,v165
MF v166,s5,v166
M v[108:111],a[152:155],a[196:199],v[108:111]
SA m0,s4,57344
MF v167,s5,v167
MF v172,s5,v172
M v[108:111],a[148:151],a[188:191],v[108:111]
buffer_load_dwordx4 v8, s[52:55], s25 offen lds
M v[108:111],a[144:147],a[180:183],v[108:111]
s_waitcnt lgkmcnt(6)
MF v173,s5,v173
MF v174,s5,v174
M v[112:115],v[32:35],a[176:179],0
T a[144:145],v23,0
T a[146:147],v23,2048
M v[112:115],v[36:39],a[184:187],v[112:115]
s_mov_b32 s25, 3408256
MF v175,s5,v175
C v164,v164,v165
M v[112:115],v[40:43],a[192:195],v[112:115]
s_waitcnt lgkmcnt(2)
T a[148:149],v23,4096
T a[150:151],v23,6144
M v[112:115],v[44:47],a[200:203],v[112:115]
SA m0,s4,61440
T a[152:153],v23,8192
T a[154:155],v23,10240
M v[112:115],v[48:51],a[208:211],v[112:115]
buffer_load_dwordx4 v8, s[52:55], s25 offen lds
M v[112:115],v[52:55],a[216:219],v[112:115]
s_nop 0
T a[156:157],v23,12288
T a[158:159],v23,14336
M v[112:115],v[56:59],a[224:227],v[112:115]
T a[160:161],v23,16384
T a[162:163],v23,18432
M v[116:119],v[56:59],a[228:231],0
C v165,v166,v167
C v166,v172,v173
M v[116:119],v[52:55],a[220:223],v[116:119]
T a[164:165],v23,20480
T a[166:167],v23,22528
M v[116:119],v[48:51],a[212:215],v[116:119]
T a[168:169],v23,24576
T a[170:171],v23,26624
M v[116:119],v[44:47],a[204:207],v[116:119]
C v167,v174,v175
W a40,v164
M v[116:119],v[40:43],a[196:199],v[116:119]
W a41,v165
W a42,v166
M v[116:119],v[36:39],a[188:191],v[116:119]
W a43,v167
v_mov_b32 v8, 0xff800000
M v[116:119],v[32:35],a[180:183],v[116:119]
s_waitcnt lgkmcnt(6)
MF v176,s5,v176
MF v177,s5,v177
M v[120:123],a[144:147],a[176:179],0
SA s30,s32,8192
T v[32:33],v20,28672
T v[34:35],v20,30720
M v[120:123],a[148:151],a[184:187],v[120:123]
buffer_store_dwordx4 a[40:43], v6, s[8:11], s30 offen offset:2048 sc1
M v[120:123],a[152:155],a[192:195],v[120:123]
s_waitcnt lgkmcnt(2)
s_nop 0
T v[36:37],v12,24576
T v[38:39],v12,26624
M v[120:123],a[156:159],a[200:203],v[120:123]
T v[40:41],v12,28672
T v[42:43],v12,30720
M v[120:123],a[160:163],a[208:211],v[120:123]
MF v178,s5,v178
MF v179,s5,v179
M v[120:123],a[164:167],a[216:219],v[120:123]
T v[44:45],v12,0
T v[46:47],v12,2048
M v[120:123],a[168:171],a[224:227],v[120:123]
T v[48:49],v12,4096
T v[50:51],v12,6144
M v[124:127],a[168:171],a[228:231],0
MF v184,s5,v184
MF v185,s5,v185
M v[124:127],a[164:167],a[220:223],v[124:127]
T v[52:53],v12,8192
T v[54:55],v12,10240
M v[124:127],a[160:163],a[212:215],v[124:127]
T v[56:57],v12,12288
T v[58:59],v12,14336
M v[124:127],a[156:159],a[204:207],v[124:127]
MF v186,s5,v186
MF v187,s5,v187
M v[124:127],a[152:155],a[196:199],v[124:127]
C v176,v176,v177
C v177,v178,v179
M v[124:127],a[148:151],a[188:191],v[124:127]
C v178,v184,v185
C v179,v186,v187
M v[124:127],a[144:147],a[180:183],v[124:127]
s_waitcnt lgkmcnt(6)
W a12,v176
W a13,v177
M v[96:99],v[32:35],a[232:235],v[96:99]
T a[144:145],v21,28672
T a[146:147],v21,30720
M v[96:99],v[36:39],a[96:99],v[96:99]
W a14,v178
W a15,v179
M v[96:99],v[40:43],a[104:107],v[96:99]
s_waitcnt lgkmcnt(2)
T a[148:149],v13,24576
T a[150:151],v13,26624
M v[96:99],v[44:47],a[112:115],v[96:99]
SA s30,s32,0
T a[152:153],v13,28672
T a[154:155],v13,30720
M v[96:99],v[48:51],a[120:123],v[96:99]
buffer_store_dwordx4 a[12:15], v6, s[8:11], s30 offen offset:3072 sc1
M v[96:99],v[52:55],a[128:131],v[96:99]
s_nop 0
T a[156:157],v13,0
T a[158:159],v13,2048
M v[96:99],v[56:59],a[136:139],v[96:99]
T a[160:161],v13,4096
T a[162:163],v13,6144
M v[100:103],v[56:59],a[140:143],v[100:103]
MF v180,s5,v180
MF v181,s5,v181
M v[100:103],v[52:55],a[132:135],v[100:103]
T a[164:165],v13,8192
T a[166:167],v13,10240
M v[100:103],v[48:51],a[124:127],v[100:103]
T a[168:169],v13,12288
T a[170:171],v13,14336
M v[100:103],v[44:47],a[116:119],v[100:103]
MF v182,s5,v182
MF v183,s5,v183
M v[100:103],v[40:43],a[108:111],v[100:103]
MF v188,s5,v188
MF v189,s5,v189
M v[100:103],v[36:39],a[100:103],v[100:103]
MF v190,s5,v190
MF v191,s5,v191
M v[100:103],v[32:35],a[236:239],v[100:103]
s_waitcnt lgkmcnt(6)
C v180,v180,v181
C v181,v182,v183
M v[104:107],a[144:147],a[232:235],v[104:107]
T v[32:33],v22,28672
T v[34:35],v22,30720
M v[104:107],a[148:151],a[96:99],v[104:107]
C v182,v188,v189
C v183,v190,v191
M v[104:107],a[152:155],a[104:107],v[104:107]
s_waitcnt lgkmcnt(2)
T v[36:37],v14,24576
T v[38:39],v14,26624
M v[104:107],a[156:159],a[112:115],v[104:107]
T v[40:41],v14,28672
T v[42:43],v14,30720
M v[104:107],a[160:163],a[120:123],v[104:107]
W a44,v180
W a45,v181
M v[104:107],a[164:167],a[128:131],v[104:107]
T v[44:45],v14,0
T v[46:47],v14,2048
M v[104:107],a[168:171],a[136:139],v[104:107]
T v[48:49],v14,4096
T v[50:51],v14,6144
M v[108:111],a[168:171],a[140:143],v[108:111]
W a46,v182
W a47,v183
M v[108:111],a[164:167],a[132:135],v[108:111]
SA s30,s32,8192
T v[52:53],v14,8192
T v[54:55],v14,10240
M v[108:111],a[160:163],a[124:127],v[108:111]
T v[56:57],v14,12288
T v[58:59],v14,14336
M v[108:111],a[156:159],a[116:119],v[108:111]
buffer_store_dwordx4 a[44:47], v6, s[8:11], s30 offen offset:3072 sc1
M v[108:111],a[152:155],a[108:111],v[108:111]
s_waitcnt vmcnt(6)
v_cmp_ne_u32 vcc, 1, v5
MF v96,s5,v96
M v[108:111],a[148:151],a[100:103],v[108:111]
s_nop 0
MF v97,s5,v97
MF v98,s5,v98
M v[108:111],a[144:147],a[236:239],v[108:111]
s_waitcnt lgkmcnt(6)
MF v99,s5,v99
MF v104,s5,v104
M v[112:115],v[32:35],a[232:235],v[112:115]
s_cmp_lg_u32 vcc_lo, 0
T a[144:145],v23,28672
T a[146:147],v23,30720
M v[112:115],v[36:39],a[96:99],v[112:115]
s_cbranch_scc1 L_wsq1
L_wrq1:
MF v105,s5,v105
MF v106,s5,v106
M v[112:115],v[40:43],a[104:107],v[112:115]
s_waitcnt lgkmcnt(2)
T a[148:149],v15,24576
T a[150:151],v15,26624
M v[112:115],v[44:47],a[112:115],v[112:115]
SA m0,s28,98304
T a[152:153],v15,28672
T a[154:155],v15,30720
M v[112:115],v[48:51],a[120:123],v[112:115]
buffer_load_dwordx4 v3, s[8:11], s21 offen offset:0 sc1 lds
M v[112:115],v[52:55],a[128:131],v[112:115]
s_nop 0
T a[156:157],v15,0
T a[158:159],v15,2048
M v[112:115],v[56:59],a[136:139],v[112:115]
T a[160:161],v15,4096
T a[162:163],v15,6144
M v[116:119],v[56:59],a[140:143],v[116:119]
buffer_load_dwordx4 v3, s[8:11], s21 offen offset:1024 sc1 lds
M v[116:119],v[52:55],a[132:135],v[116:119]
s_nop 0
T a[164:165],v15,8192
T a[166:167],v15,10240
M v[116:119],v[48:51],a[124:127],v[116:119]
T a[168:169],v15,12288
T a[170:171],v15,14336
M v[116:119],v[44:47],a[116:119],v[116:119]
buffer_load_dwordx4 v3, s[8:11], s21 offen offset:2048 sc1 lds
M v[116:119],v[40:43],a[108:111],v[116:119]
MF v107,s5,v107
C v96,v96,v97
M v[116:119],v[36:39],a[100:103],v[116:119]
s_waitcnt vmcnt(6) lgkmcnt(0)
buffer_load_dwordx4 v3, s[8:11], s21 offen offset:3072 sc1 lds
M v[116:119],v[32:35],a[236:239],v[116:119]
s_barrier
M v[120:123],a[144:147],a[232:235],v[120:123]
SA m0,s28,102400
T v[32:33],v16,0
T v[34:35],v16,2048
M v[120:123],a[148:151],a[96:99],v[120:123]
buffer_load_dwordx4 v4, s[8:11], s21 offen offset:0 sc1 lds
M v[120:123],a[152:155],a[104:107],v[120:123]
s_nop 0
T v[36:37],v16,4096
T v[38:39],v16,6144
M v[120:123],a[156:159],a[112:115],v[120:123]
T v[40:41],v16,8192
T v[42:43],v16,10240
M v[120:123],a[160:163],a[120:123],v[120:123]
buffer_load_dwordx4 v4, s[8:11], s21 offen offset:1024 sc1 lds
M v[120:123],a[164:167],a[128:131],v[120:123]
s_nop 0
T v[44:45],v16,12288
T v[46:47],v16,14336
M v[120:123],a[168:171],a[136:139],v[120:123]
T v[48:49],v16,16384
T v[50:51],v16,18432
M v[124:127],a[168:171],a[140:143],v[124:127]
buffer_load_dwordx4 v4, s[8:11], s21 offen offset:2048 sc1 lds
M v[124:127],a[164:167],a[132:135],v[124:127]
s_nop 0
T v[52:53],v16,20480
T v[54:55],v16,22528
M v[124:127],a[160:163],a[124:127],v[124:127]
T v[56:57],v16,24576
T v[58:59],v16,26624
M v[124:127],a[156:159],a[116:119],v[124:127]
buffer_load_dwordx4 v4, s[8:11], s21 offen offset:3072 sc1 lds
M v[124:127],a[152:155],a[108:111],v[124:127]
SA s21,s21,32768
C v97,v98,v99
C v98,v104,v105
M v[124:127],a[148:151],a[100:103],v[124:127]
s_sub_u32 s22, s22, 1
C v99,v106,v107
W a16,v96
M v[124:127],a[144:147],a[236:239],v[124:127]
s_waitcnt lgkmcnt(6)
W a17,v97
W a18,v98
M v[160:163],v[32:35],a[176:179],0
s_cselect_b32 s21, s23, s21
T a[144:145],v17,0
T a[146:147],v17,2048
M v[160:163],v[36:39],a[184:187],v[160:163]
SA m0,s28,65536
W a19,v99
MF v100,s5,v100
M v[160:163],v[40:43],a[192:195],v[160:163]
s_waitcnt lgkmcnt(2)
T a[148:149],v17,4096
T a[150:151],v17,6144
M v[160:163],v[44:47],a[200:203],v[160:163]
SA s30,s32,4096
T a[152:153],v17,8192
T a[154:155],v17,10240
M v[160:163],v[48:51],a[208:211],v[160:163]
buffer_store_dwordx4 a[16:19], v6, s[8:11], s30 offen offset:0 sc1
M v[160:163],v[52:55],a[216:219],v[160:163]
s_nop 0
T a[156:157],v17,12288
T a[158:159],v17,14336
M v[160:163],v[56:59],a[224:227],v[160:163]
T a[160:161],v17,16384
T a[162:163],v17,18432
M v[164:167],v[56:59],a[228:231],0
buffer_load_dwordx4 v3, s[8:11], s21 offen offset:0 sc1 lds
M v[164:167],v[52:55],a[220:223],v[164:167]
s_nop 0
T a[164:165],v17,20480
T a[166:167],v17,22528
M v[164:167],v[48:51],a[212:215],v[164:167]
T a[168:169],v17,24576
T a[170:171],v17,26624
M v[164:167],v[44:47],a[204:207],v[164:167]
buffer_load_dwordx4 v3, s[8:11], s21 offen offset:1024 sc1 lds
M v[164:167],v[40:43],a[196:199],v[164:167]
buffer_load_dword v5, v31, s[8:11], s46 offen offset:4 sc1
M v[164:167],v[36:39],a[188:191],v[164:167]
buffer_load_dwordx4 v3, s[8:11], s21 offen offset:2048 sc1 lds
M v[164:167],v[32:35],a[180:183],v[164:167]
s_waitcnt lgkmcnt(6)
MF v101,s5,v101
MF v102,s5,v102
M v[168:171],a[144:147],a[176:179],0
T v[32:33],v18,0
T v[34:35],v18,2048
M v[168:171],a[148:151],a[184:187],v[168:171]
buffer_load_dwordx4 v3, s[8:11], s21 offen offset:3072 sc1 lds
M v[168:171],a[152:155],a[192:195],v[168:171]
s_waitcnt lgkmcnt(2)
s_nop 0
T v[36:37],v18,4096
T v[38:39],v18,6144
M v[168:171],a[156:159],a[200:203],v[168:171]
SA m0,s28,69632
T v[40:41],v18,8192
T v[42:43],v18,10240
M v[168:171],a[160:163],a[208:211],v[168:171]
buffer_load_dwordx4 v4, s[8:11], s21 offen offset:0 sc1 lds
M v[168:171],a[164:167],a[216:219],v[168:171]
s_nop 0
T v[44:45],v18,12288
T v[46:47],v18,14336
M v[168:171],a[168:171],a[224:227],v[168:171]
T v[48:49],v18,16384
T v[50:51],v18,18432
M v[172:175],a[168:171],a[228:231],0
buffer_load_dwordx4 v4, s[8:11], s21 offen offset:1024 sc1 lds
M v[172:175],a[164:167],a[220:223],v[172:175]
s_nop 0
T v[52:53],v18,20480
T v[54:55],v18,22528
M v[172:175],a[160:163],a[212:215],v[172:175]
T v[56:57],v18,24576
T v[58:59],v18,26624
M v[172:175],a[156:159],a[204:207],v[172:175]
buffer_load_dwordx4 v4, s[8:11], s21 offen offset:2048 sc1 lds
M v[172:175],a[152:155],a[196:199],v[172:175]
MF v103,s5,v103
MF v108,s5,v108
M v[172:175],a[148:151],a[188:191],v[172:175]
buffer_load_dwordx4 v4, s[8:11], s21 offen offset:3072 sc1 lds
M v[172:175],a[144:147],a[180:183],v[172:175]
s_waitcnt lgkmcnt(6)
MF v109,s5,v109
MF v110,s5,v110
M v[176:179],v[32:35],a[176:179],0
SA s21,s21,32768
T a[144:145],v19,0
T a[146:147],v19,2048
M v[176:179],v[36:39],a[184:187],v[176:179]
s_sub_u32 s22, s22, 1
MF v111,s5,v111
C v100,v100,v101
M v[176:179],v[40:43],a[192:195],v[176:179]
s_waitcnt lgkmcnt(2)
T a[148:149],v19,4096
T a[150:151],v19,6144
M v[176:179],v[44:47],a[200:203],v[176:179]
s_cselect_b32 s21, s23, s21
T a[152:153],v19,8192
T a[154:155],v19,10240
M v[176:179],v[48:51],a[208:211],v[176:179]
C v101,v102,v103
C v102,v108,v109
M v[176:179],v[52:55],a[216:219],v[176:179]
T a[156:157],v19,12288
T a[158:159],v19,14336
M v[176:179],v[56:59],a[224:227],v[176:179]
T a[160:161],v19,16384
T a[162:163],v19,18432
M v[180:183],v[56:59],a[228:231],0
C v103,v110,v111
W a48,v100
M v[180:183],v[52:55],a[220:223],v[180:183]
T a[164:165],v19,20480
T a[166:167],v19,22528
M v[180:183],v[48:51],a[212:215],v[180:183]
T a[168:169],v19,24576
T a[170:171],v19,26624
M v[180:183],v[44:47],a[204:207],v[180:183]
W a49,v101
W a50,v102
M v[180:183],v[40:43],a[196:199],v[180:183]
W a51,v103
MF v112,s5,v112
M v[180:183],v[36:39],a[188:191],v[180:183]
SA s30,s32,12288
buffer_store_dwordx4 a[48:51], v6, s[8:11], s30 offen offset:0 sc1
M v[180:183],v[32:35],a[180:183],v[180:183]
s_waitcnt lgkmcnt(6)
MF v113,s5,v113
MF v114,s5,v114
M v[184:187],a[144:147],a[176:179],0
T v[32:33],v16,28672
T v[34:35],v16,30720
M v[184:187],a[148:151],a[184:187],v[184:187]
MF v115,s5,v115
MF v120,s5,v120
M v[184:187],a[152:155],a[192:195],v[184:187]
s_waitcnt lgkmcnt(2)
T v[36:37],v16,40960
T v[38:39],v16,43008
M v[184:187],a[156:159],a[200:203],v[184:187]
T v[40:41],v16,45056
T v[42:43],v16,47104
M v[184:187],a[160:163],a[208:211],v[184:187]
MF v121,s5,v121
MF v122,s5,v122
M v[184:187],a[164:167],a[216:219],v[184:187]
T v[44:45],v16,49152
T v[46:47],v16,51200
M v[184:187],a[168:171],a[224:227],v[184:187]
T v[48:49],v16,53248
T v[50:51],v16,55296
M v[188:191],a[168:171],a[228:231],0
MF v123,s5,v123
C v112,v112,v113
M v[188:191],a[164:167],a[220:223],v[188:191]
T v[52:53],v16,57344
T v[54:55],v16,59392
M v[188:191],a[160:163],a[212:215],v[188:191]
T v[56:57],v16,61440
T v[58:59],v16,63488
M v[188:191],a[156:159],a[204:207],v[188:191]
C v113,v114,v115
C v114,v120,v121
M v[188:191],a[152:155],a[196:199],v[188:191]
C v115,v122,v123
W a20,v112
M v[188:191],a[148:151],a[188:191],v[188:191]
W a21,v113
W a22,v114
M v[188:191],a[144:147],a[180:183],v[188:191]
s_waitcnt lgkmcnt(6)
W a23,v115
MF v116,s5,v116
M v[160:163],v[32:35],a[232:235],v[160:163]
SA s30,s32,4096
T a[144:145],v17,28672
T a[146:147],v17,30720
M v[160:163],v[36:39],a[96:99],v[160:163]
buffer_store_dwordx4 a[20:23], v6, s[8:11], s30 offen offset:1024 sc1
M v[160:163],v[40:43],a[104:107],v[160:163]
s_waitcnt lgkmcnt(2)
s_nop 0
T a[148:149],v17,40960
T a[150:151],v17,43008
M v[160:163],v[44:47],a[112:115],v[160:163]
T a[152:153],v17,45056
T a[154:155],v17,47104
M v[160:163],v[48:51],a[120:123],v[160:163]
MF v117,s5,v117
MF v118,s5,v118
M v[160:163],v[52:55],a[128:131],v[160:163]
T a[156:157],v17,49152
T a[158:159],v17,51200
M v[160:163],v[56:59],a[136:139],v[160:163]
T a[160:161],v17,53248
T a[162:163],v17,55296
M v[164:167],v[56:59],a[140:143],v[164:167]
MF v119,s5,v119
MF v124,s5,v124
M v[164:167],v[52:55],a[132:135],v[164:167]
T a[164:165],v17,57344
T a[166:167],v17,59392
M v[164:167],v[48:51],a[124:127],v[164:167]
T a[168:169],v17,61440
T a[170:171],v17,63488
M v[164:167],v[44:47],a[116:119],v[164:167]
MF v125,s5,v125
MF v126,s5,v126
M v[164:167],v[40:43],a[108:111],v[164:167]
MF v127,s5,v127
C v116,v116,v117
M v[164:167],v[36:39],a[100:103],v[164:167]
C v117,v118,v119
C v118,v124,v125
M v[164:167],v[32:35],a[236:239],v[164:167]
s_waitcnt lgkmcnt(6)
C v119,v126,v127
W a52,v116
M v[168:171],a[144:147],a[232:235],v[168:171]
T v[32:33],v18,28672
T v[34:35],v18,30720
M v[168:171],a[148:151],a[96:99],v[168:171]
W a53,v117
W a54,v118
M v[168:171],a[152:155],a[104:107],v[168:171]
s_waitcnt lgkmcnt(2)
T v[36:37],v18,40960
T v[38:39],v18,43008
M v[168:171],a[156:159],a[112:115],v[168:171]
T v[40:41],v18,45056
T v[42:43],v18,47104
M v[168:171],a[160:163],a[120:123],v[168:171]
W a55,v119
s_waitcnt vmcnt(8)
v_cmp_ne_u32 vcc, 1, v5
M v[168:171],a[164:167],a[128:131],v[168:171]
SA s30,s32,12288
T v[44:45],v18,49152
T v[46:47],v18,51200
M v[168:171],a[168:171],a[136:139],v[168:171]
s_nop 0
T v[48:49],v18,53248
T v[50:51],v18,55296
M v[172:175],a[168:171],a[140:143],v[172:175]
s_cmp_lg_u32 vcc_hi, 0
buffer_store_dwordx4 a[52:55], v6, s[8:11], s30 offen offset:1024 sc1
M v[172:175],a[164:167],a[132:135],v[172:175]
s_cbranch_scc1 L_wsr1
L_wrr1:
T v[52:53],v18,57344
T v[54:55],v18,59392
M v[172:175],a[160:163],a[124:127],v[172:175]
SA m0,s28,131072
T v[56:57],v18,61440
T v[58:59],v18,63488
M v[172:175],a[156:159],a[116:119],v[172:175]
buffer_load_dwordx4 v3, s[8:11], s26 offen offset:0 sc1 lds
M v[172:175],a[152:155],a[108:111],v[172:175]
MF v160,s5,v160
MF v161,s5,v161
M v[172:175],a[148:151],a[100:103],v[172:175]
buffer_load_dwordx4 v3, s[8:11], s26 offen offset:1024 sc1 lds
M v[172:175],a[144:147],a[236:239],v[172:175]
s_waitcnt lgkmcnt(6)
MF v162,s5,v162
MF v163,s5,v163
M v[176:179],v[32:35],a[232:235],v[176:179]
T a[144:145],v19,28672
T a[146:147],v19,30720
M v[176:179],v[36:39],a[96:99],v[176:179]
buffer_load_dwordx4 v3, s[8:11], s26 offen offset:2048 sc1 lds
M v[176:179],v[40:43],a[104:107],v[176:179]
s_waitcnt lgkmcnt(2)
s_nop 0
T a[148:149],v19,40960
T a[150:151],v19,43008
M v[176:179],v[44:47],a[112:115],v[176:179]
T a[152:153],v19,45056
T a[154:155],v19,47104
M v[176:179],v[48:51],a[120:123],v[176:179]
buffer_load_dwordx4 v3, s[8:11], s26 offen offset:3072 sc1 lds
M v[176:179],v[52:55],a[128:131],v[176:179]
SA m0,s28,135168
T a[156:157],v19,49152
T a[158:159],v19,51200
M v[176:179],v[56:59],a[136:139],v[176:179]
T a[160:161],v19,53248
T a[162:163],v19,55296
M v[180:183],v[56:59],a[140:143],v[180:183]
buffer_load_dwordx4 v4, s[8:11], s26 offen offset:0 sc1 lds
M v[180:183],v[52:55],a[132:135],v[180:183]
s_nop 0
T a[164:165],v19,57344
T a[166:167],v19,59392
M v[180:183],v[48:51],a[124:127],v[180:183]
T a[168:169],v19,61440
T a[170:171],v19,63488
M v[180:183],v[44:47],a[116:119],v[180:183]
buffer_load_dwordx4 v4, s[8:11], s26 offen offset:1024 sc1 lds
M v[180:183],v[40:43],a[108:111],v[180:183]
MF v168,s5,v168
MF v169,s5,v169
M v[180:183],v[36:39],a[100:103],v[180:183]
s_waitcnt lgkmcnt(0)
buffer_load_dwordx4 v4, s[8:11], s26 offen offset:2048 sc1 lds
M v[180:183],v[32:35],a[236:239],v[180:183]
s_barrier
M v[184:187],a[144:147],a[232:235],v[184:187]
R a[64:67],v2,32768
R a[68:71],v2,33792
M v[184:187],a[148:151],a[96:99],v[184:187]
buffer_load_dwordx4 v4, s[8:11], s26 offen offset:3072 sc1 lds
M v[184:187],a[152:155],a[104:107],v[184:187]
SA s26,s26,32768
MF v170,s5,v170
MF v171,s5,v171
M v[184:187],a[156:159],a[112:115],v[184:187]
R a[72:75],v2,34816
R a[76:79],v2,35840
M v[184:187],a[160:163],a[120:123],v[184:187]
C v160,v160,v161
C v161,v162,v163
M v[184:187],a[164:167],a[128:131],v[184:187]
C v162,v168,v169
C v163,v170,v171
M v[184:187],a[168:171],a[136:139],v[184:187]
R a[80:83],v2,36864
R a[84:87],v2,37888
M v[188:191],a[168:171],a[140:143],v[188:191]
W a24,v160
W a25,v161
M v[188:191],a[164:167],a[132:135],v[188:191]
W a26,v162
W a27,v163
M v[188:191],a[160:163],a[124:127],v[188:191]
SA s30,s32,4096
R a[88:91],v2,38912
R a[92:95],v2,39936
M v[188:191],a[156:159],a[116:119],v[188:191]
buffer_store_dwordx4 a[24:27], v6, s[8:11], s30 offen offset:2048 sc1
M v[188:191],a[152:155],a[108:111],v[188:191]
MF v164,s5,v164
MF v165,s5,v165
M v[188:191],a[148:151],a[100:103],v[188:191]
MF v166,s5,v166
MF v167,s5,v167
M v[188:191],a[144:147],a[236:239],v[188:191]
s_waitcnt lgkmcnt(0)
MF v172,s5,v172
MF v173,s5,v173
MF v174,s5,v174
MF v175,s5,v175
C v164,v164,v165
C v165,v166,v167
C v166,v172,v173
C v167,v174,v175
W a56,v164
W a57,v165
W a58,v166
W a59,v167
SA s30,s32,12288
buffer_store_dwordx4 a[56:59], v6, s[8:11], s30 offen offset:2048 sc1
v_mov_b32 v30, 2
buffer_store_dword v30, v1, s[8:11], s45 offen sc1
M v[64:67],a[64:67],a[0:3],0
R a[96:99],v2,40960
R a[100:103],v2,41984
M v[64:67],a[68:71],a[4:7],v[64:67]
MF v176,s5,v176
MF v177,s5,v177
M v[64:67],a[72:75],a[8:11],v[64:67]
MF v178,s5,v178
MF v179,s5,v179
M v[64:67],a[76:79],a[12:15],v[64:67]
R a[104:107],v2,43008
R a[108:111],v2,44032
M v[64:67],a[80:83],a[16:19],v[64:67]
MF v184,s5,v184
MF v185,s5,v185
MF v186,s5,v186
MF v187,s5,v187
C v176,v176,v177
C v177,v178,v179
C v178,v184,v185
C v179,v186,v187
W a28,v176
W a29,v177
W a30,v178
W a31,v179
M v[64:67],a[84:87],a[20:23],v[64:67]
MF v180,s5,v180
MF v181,s5,v181
M v[64:67],a[88:91],a[24:27],v[64:67]
R a[112:115],v2,45056
R a[116:119],v2,46080
M v[64:67],a[92:95],a[28:31],v[64:67]
MF v182,s5,v182
MF v183,s5,v183
M v[68:71],a[64:67],a[32:35],0
MF v188,s5,v188
MF v189,s5,v189
M v[68:71],a[68:71],a[36:39],v[68:71]
R a[120:123],v2,47104
R a[124:127],v2,48128
M v[68:71],a[72:75],a[40:43],v[68:71]
SA m0,s28,32768
MF v190,s5,v190
MF v191,s5,v191
M v[68:71],a[76:79],a[44:47],v[68:71]
buffer_load_dwordx4 v3, s[8:11], s26 offen offset:0 sc1 lds
M v[68:71],a[80:83],a[48:51],v[68:71]
C v180,v180,v181
C v181,v182,v183
C v182,v188,v189
C v183,v190,v191
W a60,v180
W a61,v181
W a62,v182
W a63,v183
M v[68:71],a[84:87],a[52:55],v[68:71]
SA s30,s32,4096
buffer_store_dwordx4 a[28:31], v6, s[8:11], s30 offen offset:3072 sc1
M v[68:71],a[88:91],a[56:59],v[68:71]
SA s30,s32,12288
E v18,v64
M v[68:71],a[92:95],a[60:63],v[68:71]
s_waitcnt lgkmcnt(0)
buffer_store_dwordx4 a[60:63], v6, s[8:11], s30 offen offset:3072 sc1
M v[72:75],a[96:99],a[0:3],0
R a[64:67],v2,49152
R a[68:71],v2,50176
M v[72:75],a[100:103],a[4:7],v[72:75]
E v19,v65
M v[72:75],a[104:107],a[8:11],v[72:75]
buffer_load_dwordx4 v3, s[8:11], s26 offen offset:1024 sc1 lds
M v[72:75],a[108:111],a[12:15],v[72:75]
R a[72:75],v2,51200
R a[76:79],v2,52224
M v[72:75],a[112:115],a[16:19],v[72:75]
E v20,v66
M v[72:75],a[116:119],a[20:23],v[72:75]
buffer_load_dwordx4 v3, s[8:11], s26 offen offset:2048 sc1 lds
M v[72:75],a[120:123],a[24:27],v[72:75]
R a[80:83],v2,53248
R a[84:87],v2,54272
M v[72:75],a[124:127],a[28:31],v[72:75]
E v21,v67
M v[76:79],a[124:127],a[60:63],0
buffer_load_dwordx4 v3, s[8:11], s26 offen offset:3072 sc1 lds
M v[76:79],a[120:123],a[56:59],v[76:79]
SA m0,s28,36864
R a[88:91],v2,55296
R a[92:95],v2,56320
M v[76:79],a[116:119],a[52:55],v[76:79]
E v22,v68
M v[76:79],a[112:115],a[48:51],v[76:79]
buffer_load_dwordx4 v4, s[8:11], s26 offen offset:0 sc1 lds
M v[76:79],a[108:111],a[44:47],v[76:79]
E v23,v69
M v[76:79],a[104:107],a[40:43],v[76:79]
AF v26,v18,v19
C v40,v18,v19
M v[76:79],a[100:103],a[36:39],v[76:79]
buffer_load_dwordx4 v4, s[8:11], s26 offen offset:1024 sc1 lds
M v[76:79],a[96:99],a[32:35],v[76:79]
s_waitcnt lgkmcnt(0)
v_add_u32 v16, 0x20000, v7
AF v26,v20,v26
M v[80:83],a[64:67],a[0:3],0
R a[96:99],v2,57344
R a[100:103],v2,58368
M v[80:83],a[68:71],a[4:7],v[80:83]
buffer_load_dwordx4 v4, s[8:11], s26 offen offset:2048 sc1 lds
M v[80:83],a[72:75],a[8:11],v[80:83]
E v24,v70
M v[80:83],a[76:79],a[12:15],v[80:83]
R a[104:107],v2,59392
R a[108:111],v2,60416
M v[80:83],a[80:83],a[16:19],v[80:83]
buffer_load_dwordx4 v4, s[8:11], s26 offen offset:3072 sc1 lds
M v[80:83],a[84:87],a[20:23],v[80:83]
SA s26,s26,32768
E v25,v71
M v[80:83],a[88:91],a[24:27],v[80:83]
R a[112:115],v2,61440
R a[116:119],v2,62464
M v[80:83],a[92:95],a[28:31],v[80:83]
E v18,v72
M v[84:87],a[92:95],a[60:63],0
E v19,v73
M v[84:87],a[88:91],a[56:59],v[84:87]
R a[120:123],v2,63488
R a[124:127],v2,64512
M v[84:87],a[84:87],a[52:55],v[84:87]
C v41,v20,v21
AF v26,v21,v26
M v[84:87],a[80:83],a[48:51],v[84:87]
E v20,v74
M v[84:87],a[76:79],a[44:47],v[84:87]
AF v27,v22,v23
C v44,v22,v23
M v[84:87],a[72:75],a[40:43],v[84:87]
AF v27,v24,v27
C v45,v24,v25
M v[84:87],a[68:71],a[36:39],v[84:87]
s_waitcnt vmcnt(24) lgkmcnt(0)
E v21,v75
M v[84:87],a[64:67],a[32:35],v[84:87]
s_barrier
M v[88:91],a[96:99],a[0:3],0
R a[64:67],v2,0
R a[68:71],v2,1024
M v[88:91],a[100:103],a[4:7],v[88:91]
E v22,v76
M v[88:91],a[104:107],a[8:11],v[88:91]
AF v27,v25,v27
AF v26,v18,v26
M v[88:91],a[108:111],a[12:15],v[88:91]
R a[72:75],v2,2048
R a[76:79],v2,3072
M v[88:91],a[112:115],a[16:19],v[88:91]
E v23,v77
M v[88:91],a[116:119],a[20:23],v[88:91]
C v42,v18,v19
AF v26,v19,v26
M v[88:91],a[120:123],a[24:27],v[88:91]
R a[80:83],v2,4096
R a[84:87],v2,5120
M v[88:91],a[124:127],a[28:31],v[88:91]
E v24,v78
M v[92:95],a[124:127],a[60:63],0
AF v26,v20,v26
C v43,v20,v21
M v[92:95],a[120:123],a[56:59],v[92:95]
R a[88:91],v2,6144
R a[92:95],v2,7168
M v[92:95],a[116:119],a[52:55],v[92:95]
E v25,v79
M v[92:95],a[112:115],a[48:51],v[92:95]
AF v26,v21,v26
AF v27,v22,v27
M v[92:95],a[108:111],a[44:47],v[92:95]
C v46,v22,v23
AF v27,v23,v27
M v[92:95],a[104:107],a[40:43],v[92:95]
AF v27,v24,v27
C v47,v24,v25
M v[92:95],a[100:103],a[36:39],v[92:95]
s_waitcnt lgkmcnt(0)
AF v27,v25,v27
M v[92:95],a[96:99],a[32:35],v[92:95]
M v[96:99],a[64:67],a[0:3],0
R a[96:99],v2,8192
R a[100:103],v2,9216
M v[96:99],a[68:71],a[4:7],v[96:99]
SA m0,s28,98304
W a128,v128
W a129,v129
M v[96:99],a[72:75],a[8:11],v[96:99]
buffer_load_dwordx4 v3, s[8:11], s21 offen offset:0 sc1 lds
M v[96:99],a[76:79],a[12:15],v[96:99]
R a[104:107],v2,10240
R a[108:111],v2,11264
M v[96:99],a[80:83],a[16:19],v[96:99]
W a130,v130
v_mov_b32 v30, 0
M v[96:99],a[84:87],a[20:23],v[96:99]
W a131,v131
M v[96:99],a[88:91],a[24:27],v[96:99]
R a[112:115],v2,12288
R a[116:119],v2,13312
M v[96:99],a[92:95],a[28:31],v[96:99]
buffer_load_dwordx4 v3, s[8:11], s21 offen offset:1024 sc1 lds
M v[100:103],a[92:95],a[60:63],0
W a132,v132
v_mov_b32 v31, 0
M v[100:103],a[88:91],a[56:59],v[100:103]
R a[120:123],v2,14336
R a[124:127],v2,15360
M v[100:103],a[84:87],a[52:55],v[100:103]
W a133,v133
W a134,v134
M v[100:103],a[80:83],a[48:51],v[100:103]
buffer_load_dwordx4 v3, s[8:11], s21 offen offset:2048 sc1 lds
M v[100:103],a[76:79],a[44:47],v[100:103]
W a135,v135
M v[100:103],a[72:75],a[40:43],v[100:103]
v_mov_b32 v32, 0
M v[100:103],a[68:71],a[36:39],v[100:103]
W a136,v136
M v[100:103],a[64:67],a[32:35],v[100:103]
s_waitcnt lgkmcnt(0)
buffer_load_dwordx4 v3, s[8:11], s21 offen offset:3072 sc1 lds
M v[104:107],a[96:99],a[0:3],0
SA m0,s28,102400
R a[64:67],v2,16384
R a[68:71],v2,17408
M v[104:107],a[100:103],a[4:7],v[104:107]
W a137,v137
v_mov_b32 v33, 0
M v[104:107],a[104:107],a[8:11],v[104:107]
W a138,v138
M v[104:107],a[108:111],a[12:15],v[104:107]
R a[72:75],v2,18432
R a[76:79],v2,19456
M v[104:107],a[112:115],a[16:19],v[104:107]
buffer_load_dwordx4 v4, s[8:11], s21 offen offset:0 sc1 lds
M v[104:107],a[116:119],a[20:23],v[104:107]
W a139,v139
W a140,v140
M v[104:107],a[120:123],a[24:27],v[104:107]
R a[80:83],v2,20480
R a[84:87],v2,21504
M v[104:107],a[124:127],a[28:31],v[104:107]
buffer_load_dwordx4 v4, s[8:11], s21 offen offset:1024 sc1 lds
M v[108:111],a[124:127],a[60:63],0
v_mov_b32 v34, 0
W a141,v141
M v[108:111],a[120:123],a[56:59],v[108:111]
R a[88:91],v2,22528
R a[92:95],v2,23552
M v[108:111],a[116:119],a[52:55],v[108:111]
buffer_load_dwordx4 v4, s[8:11], s21 offen offset:2048 sc1 lds
M v[108:111],a[112:115],a[48:51],v[108:111]
W a142,v142
W a143,v143
M v[108:111],a[108:111],a[44:47],v[108:111]
v_mov_b32 v35, 0
W a144,v144
M v[108:111],a[104:107],a[40:43],v[108:111]
W a145,v145
M v[108:111],a[100:103],a[36:39],v[108:111]
buffer_load_dwordx4 v4, s[8:11], s21 offen offset:3072 sc1 lds
M v[108:111],a[96:99],a[32:35],v[108:111]
s_waitcnt lgkmcnt(0)
v_mov_b32 v36, 0
W a146,v146
M v[112:115],a[64:67],a[0:3],0
SA s21,s21,32768
R a[96:99],v2,24576
R a[100:103],v2,25600
M v[112:115],a[68:71],a[4:7],v[112:115]
s_sub_u32 s22, s22, 1
W a147,v147
M v[112:115],a[72:75],a[8:11],v[112:115]
s_cselect_b32 s21, s23, s21
E v18,v80
M v[112:115],a[76:79],a[12:15],v[112:115]
R a[104:107],v2,26624
R a[108:111],v2,27648
M v[112:115],a[80:83],a[16:19],v[112:115]
W a148,v148
v_mov_b32 v37, 0
M v[112:115],a[84:87],a[20:23],v[112:115]
W a149,v149
M v[112:115],a[88:91],a[24:27],v[112:115]
R a[112:115],v2,28672
R a[116:119],v2,29696
M v[112:115],a[92:95],a[28:31],v[112:115]
W a150,v150
M v[116:119],a[92:95],a[60:63],0
v_mov_b32 v38, 0
W a151,v151
M v[116:119],a[88:91],a[56:59],v[116:119]
R a[120:123],v2,30720
R a[124:127],v2,31744
M v[116:119],a[84:87],a[52:55],v[116:119]
W a152,v152
M v[116:119],a[80:83],a[48:51],v[116:119]
W a153,v153
M v[116:119],a[76:79],a[44:47],v[116:119]
E v19,v81
M v[116:119],a[72:75],a[40:43],v[116:119]
v_mov_b32 v39, 0
W a154,v154
M v[116:119],a[68:71],a[36:39],v[116:119]
s_waitcnt vmcnt(21) lgkmcnt(0)
E v20,v82
M v[116:119],a[64:67],a[32:35],v[116:119]
s_barrier
M v[120:123],a[96:99],a[0:3],0
R a[64:67],v16,0
R a[68:71],v16,1024
M v[120:123],a[100:103],a[4:7],v[120:123]
W a155,v155
W a156,v156
M v[120:123],a[104:107],a[8:11],v[120:123]
W a157,v157
AF v26,v18,v26
M v[120:123],a[108:111],a[12:15],v[120:123]
R a[72:75],v16,2048
R a[76:79],v16,3072
M v[120:123],a[112:115],a[16:19],v[120:123]
W a158,v158
C v56,v18,v19
M v[120:123],a[116:119],a[20:23],v[120:123]
E v21,v83
M v[120:123],a[120:123],a[24:27],v[120:123]
R a[80:83],v16,4096
R a[84:87],v16,5120
M v[120:123],a[124:127],a[28:31],v[120:123]
W a159,v159
AF v26,v19,v26
M v[124:127],a[124:127],a[60:63],0
E v22,v88
M v[124:127],a[120:123],a[56:59],v[124:127]
R a[88:91],v16,6144
R a[92:95],v16,7168
M v[124:127],a[116:119],a[52:55],v[124:127]
E v23,v89
M v[124:127],a[112:115],a[48:51],v[124:127]
E v24,v90
M v[124:127],a[108:111],a[44:47],v[124:127]
E v25,v91
M v[124:127],a[104:107],a[40:43],v[124:127]
E v18,v84
M v[124:127],a[100:103],a[36:39],v[124:127]
s_waitcnt lgkmcnt(0)
E v19,v85
M v[124:127],a[96:99],a[32:35],v[124:127]
AF v26,v20,v26
C v57,v20,v21
AF v26,v21,v26
AF v26,v22,v26
C v58,v22,v23
AF v26,v23,v26
AF v26,v24,v26
C v59,v24,v25
AF v26,v25,v26
E v20,v86
E v21,v87
AF v27,v18,v27
C v60,v18,v19
AF v27,v19,v27
E v22,v92
E v23,v93
AF v27,v20,v27
C v61,v20,v21
AF v27,v21,v27
E v24,v94
E v25,v95
AF v27,v22,v27
C v62,v22,v23
AF v27,v23,v27
AF v27,v24,v27
C v63,v24,v25
AF v27,v25,v27
v_max_f32 v10, v26, v27
v_min_f32 v11, v26, v27
v_cmp_lt_f32 vcc, s31, v10
v_cmp_gt_f32 s[64:65], s24, v11
s_nop 0
s_or_b64 vcc, vcc, s[64:65]
s_cbranch_vccnz L_stv1
L_rtv1:
M v[128:131],a[64:67],v[40:43],0
R a[96:99],v16,8192
R a[100:103],v16,9216
M v[128:131],a[68:71],v[56:59],v[128:131]
SA m0,s28,65536
W a160,v192
W a161,v193
M v[132:135],a[68:71],v[60:63],0
buffer_load_dwordx4 v3, s[8:11], s21 offen offset:0 sc1 lds
M v[132:135],a[64:67],v[44:47],v[132:135]
R a[104:107],v16,10240
R a[108:111],v16,11264
M v[136:139],a[72:75],v[40:43],0
W a162,v194
W a163,v195
M v[136:139],a[76:79],v[56:59],v[136:139]
W a164,v196
W a165,v197
M v[140:143],a[76:79],v[60:63],0
R a[112:115],v16,12288
R a[116:119],v16,13312
M v[140:143],a[72:75],v[44:47],v[140:143]
buffer_load_dwordx4 v3, s[8:11], s21 offen offset:1024 sc1 lds
M v[144:147],a[80:83],v[40:43],0
W a166,v198
W a167,v199
M v[144:147],a[84:87],v[56:59],v[144:147]
R a[120:123],v16,14336
R a[124:127],v16,15360
M v[148:151],a[84:87],v[60:63],0
W a168,v200
W a169,v201
M v[148:151],a[80:83],v[44:47],v[148:151]
buffer_load_dwordx4 v3, s[8:11], s21 offen offset:2048 sc1 lds
M v[152:155],a[88:91],v[40:43],0
W a170,v202
W a171,v203
M v[152:155],a[92:95],v[56:59],v[152:155]
W a172,v204
W a173,v205
M v[156:159],a[92:95],v[60:63],0
W a174,v206
W a175,v207
M v[156:159],a[88:91],v[44:47],v[156:159]
s_waitcnt lgkmcnt(0)
buffer_load_dwordx4 v3, s[8:11], s21 offen offset:3072 sc1 lds
M v[160:163],a[96:99],v[40:43],0
SA m0,s28,69632
R a[64:67],v16,16384
R a[68:71],v16,17408
M v[160:163],a[100:103],v[56:59],v[160:163]
W a176,v208
W a177,v209
M v[164:167],a[100:103],v[60:63],0
W a178,v210
W a179,v211
M v[164:167],a[96:99],v[44:47],v[164:167]
R a[72:75],v16,18432
R a[76:79],v16,19456
M v[168:171],a[104:107],v[40:43],0
buffer_load_dwordx4 v4, s[8:11], s21 offen offset:0 sc1 lds
M v[168:171],a[108:111],v[56:59],v[168:171]
W a180,v212
W a181,v213
M v[172:175],a[108:111],v[60:63],0
R a[80:83],v16,20480
R a[84:87],v16,21504
M v[172:175],a[104:107],v[44:47],v[172:175]
buffer_load_dwordx4 v4, s[8:11], s21 offen offset:1024 sc1 lds
M v[176:179],a[112:115],v[40:43],0
W a182,v214
W a183,v215
M v[176:179],a[116:119],v[56:59],v[176:179]
R a[88:91],v16,22528
R a[92:95],v16,23552
M v[180:183],a[116:119],v[60:63],0
buffer_load_dwordx4 v4, s[8:11], s21 offen offset:2048 sc1 lds
M v[180:183],a[112:115],v[44:47],v[180:183]
W a184,v216
W a185,v217
M v[184:187],a[120:123],v[40:43],0
W a186,v218
W a187,v219
W a188,v220
W a189,v221
W a190,v222
W a191,v223
M v[184:187],a[124:127],v[56:59],v[184:187]
E v18,v96
M v[188:191],a[124:127],v[60:63],0
buffer_load_dwordx4 v4, s[8:11], s21 offen offset:3072 sc1 lds
M v[188:191],a[120:123],v[44:47],v[188:191]
s_waitcnt lgkmcnt(0)
v_min_u32 v17, 1, v7
v_lshlrev_b32 v17, 29, v17
M v[192:195],a[64:67],v[40:43],0
SA s21,s21,32768
R a[96:99],v16,24576
R a[100:103],v16,25600
M v[192:195],a[68:71],v[56:59],v[192:195]
s_sub_u32 s22, s22, 1
v_mov_b32 v15, 1
AF v30,v26,v30
M v[196:199],a[68:71],v[60:63],0
s_cselect_b32 s21, s23, s21
E v19,v97
M v[196:199],a[64:67],v[44:47],v[196:199]
SA s84,s47,16
R a[104:107],v16,26624
R a[108:111],v16,27648
M v[200:203],a[72:75],v[40:43],0
SA s3,s93,262144
buffer_store_dwordx4 a[128:131], v7, s[8:11], s3 offen offset:0 sc1
M v[200:203],a[76:79],v[56:59],v[200:203]
E v20,v98
M v[204:207],a[76:79],v[60:63],0
R a[112:115],v16,28672
R a[116:119],v16,29696
M v[204:207],a[72:75],v[44:47],v[204:207]
E v21,v99
M v[208:211],a[80:83],v[40:43],0
E v22,v104
M v[208:211],a[84:87],v[56:59],v[208:211]
R a[120:123],v16,30720
R a[124:127],v16,31744
M v[212:215],a[84:87],v[60:63],0
buffer_store_dwordx4 a[132:135], v7, s[8:11], s3 offen offset:2048 sc1
M v[212:215],a[80:83],v[44:47],v[212:215]
E v23,v105
M v[216:219],a[88:91],v[40:43],0
AF v31,v27,v31
AF v28,v18,v19
M v[216:219],a[92:95],v[56:59],v[216:219]
E v24,v106
M v[220:223],a[92:95],v[60:63],0
s_waitcnt vmcnt(10) lgkmcnt(0)
E v25,v107
M v[220:223],a[88:91],v[44:47],v[220:223]
s_barrier
M v[224:227],a[96:99],v[40:43],0
R a[64:67],v2,32768
R a[68:71],v2,33792
M v[224:227],a[100:103],v[56:59],v[224:227]
buffer_store_dword v15, v17, s[8:11], s84 offen sc1
M v[228:231],a[100:103],v[60:63],0
SA s3,s93,266240
C v48,v18,v19
AF v28,v20,v28
M v[228:231],a[96:99],v[44:47],v[228:231]
R a[72:75],v2,34816
R a[76:79],v2,35840
M v[232:235],a[104:107],v[40:43],0
buffer_store_dwordx4 a[136:139], v7, s[8:11], s3 offen offset:0 sc1
M v[232:235],a[108:111],v[56:59],v[232:235]
E v18,v100
M v[236:239],a[108:111],v[60:63],0
R a[80:83],v2,36864
R a[84:87],v2,37888
M v[236:239],a[104:107],v[44:47],v[236:239]
E v19,v101
M v[240:243],a[112:115],v[40:43],0
C v49,v20,v21
AF v28,v21,v28
M v[240:243],a[116:119],v[56:59],v[240:243]
R a[88:91],v2,38912
R a[92:95],v2,39936
M v[244:247],a[116:119],v[60:63],0
E v20,v102
M v[244:247],a[112:115],v[44:47],v[244:247]
E v21,v103
M v[248:251],a[120:123],v[40:43],0
AF v28,v22,v28
C v50,v22,v23
M v[248:251],a[124:127],v[56:59],v[248:251]
AF v28,v23,v28
AF v28,v24,v28
M v[252:255],a[124:127],v[60:63],0
s_waitcnt lgkmcnt(0)
E v22,v108
M v[252:255],a[120:123],v[44:47],v[252:255]
E v23,v109
C v51,v24,v25
AF v28,v25,v28
AF v29,v18,v19
C v52,v18,v19
AF v29,v20,v29
C v53,v20,v21
AF v29,v21,v29
E v24,v110
E v25,v111
AF v29,v22,v29
C v54,v22,v23
AF v29,v23,v29
AF v29,v24,v29
C v55,v24,v25
AF v29,v25,v29
M v[64:67],a[64:67],a[0:3],v[32:35]
R a[96:99],v2,40960
R a[100:103],v2,41984
M v[64:67],a[68:71],a[4:7],v[64:67]
SA m0,s28,0
E v18,v112
M v[64:67],a[72:75],a[8:11],v[64:67]
buffer_load_dwordx4 v3, s[8:11], s26 offen offset:0 sc1 lds
M v[64:67],a[76:79],a[12:15],v[64:67]
R a[104:107],v2,43008
R a[108:111],v2,44032
M v[64:67],a[80:83],a[16:19],v[64:67]
E v19,v113
M v[64:67],a[84:87],a[20:23],v[64:67]
AF v28,v18,v28
C v56,v18,v19
M v[64:67],a[88:91],a[24:27],v[64:67]
R a[112:115],v2,45056
R a[116:119],v2,46080
M v[64:67],a[92:95],a[28:31],v[64:67]
buffer_load_dwordx4 v3, s[8:11], s26 offen offset:1024 sc1 lds
M v[68:71],a[92:95],a[60:63],v[36:39]
E v20,v114
M v[68:71],a[88:91],a[56:59],v[68:71]
R a[120:123],v2,47104
R a[124:127],v2,48128
M v[68:71],a[84:87],a[52:55],v[68:71]
E v21,v115
M v[68:71],a[80:83],a[48:51],v[68:71]
buffer_load_dwordx4 v3, s[8:11], s26 offen offset:2048 sc1 lds
M v[68:71],a[76:79],a[44:47],v[68:71]
AF v28,v19,v28
AF v28,v20,v28
M v[68:71],a[72:75],a[40:43],v[68:71]
C v57,v20,v21
AF v28,v21,v28
M v[68:71],a[68:71],a[36:39],v[68:71]
E v22,v120
M v[68:71],a[64:67],a[32:35],v[68:71]
s_waitcnt lgkmcnt(0)
buffer_load_dwordx4 v3, s[8:11], s26 offen offset:3072 sc1 lds
M v[72:75],a[96:99],a[0:3],v[32:35]
SA m0,s28,4096
R a[64:67],v2,49152
R a[68:71],v2,50176
M v[72:75],a[100:103],a[4:7],v[72:75]
E v23,v121
M v[72:75],a[104:107],a[8:11],v[72:75]
AF v28,v22,v28
C v58,v22,v23
M v[72:75],a[108:111],a[12:15],v[72:75]
R a[72:75],v2,51200
R a[76:79],v2,52224
M v[72:75],a[112:115],a[16:19],v[72:75]
buffer_load_dwordx4 v4, s[8:11], s26 offen offset:0 sc1 lds
M v[72:75],a[116:119],a[20:23],v[72:75]
E v24,v122
M v[72:75],a[120:123],a[24:27],v[72:75]
R a[80:83],v2,53248
R a[84:87],v2,54272
M v[72:75],a[124:127],a[28:31],v[72:75]
buffer_load_dwordx4 v4, s[8:11], s26 offen offset:1024 sc1 lds
M v[76:79],a[124:127],a[60:63],v[36:39]
E v25,v123
M v[76:79],a[120:123],a[56:59],v[76:79]
R a[88:91],v2,55296
R a[92:95],v2,56320
M v[76:79],a[116:119],a[52:55],v[76:79]
buffer_load_dwordx4 v4, s[8:11], s26 offen offset:2048 sc1 lds
M v[76:79],a[112:115],a[48:51],v[76:79]
AF v28,v23,v28
AF v28,v24,v28
M v[76:79],a[108:111],a[44:47],v[76:79]
E v18,v116
M v[76:79],a[104:107],a[40:43],v[76:79]
C v59,v24,v25
AF v28,v25,v28
M v[76:79],a[100:103],a[36:39],v[76:79]
buffer_load_dwordx4 v4, s[8:11], s26 offen offset:3072 sc1 lds
M v[76:79],a[96:99],a[32:35],v[76:79]
s_waitcnt lgkmcnt(0)
E v19,v117
M v[80:83],a[64:67],a[0:3],v[32:35]
SA s26,s26,32768
R a[96:99],v2,57344
R a[100:103],v2,58368
M v[80:83],a[68:71],a[4:7],v[80:83]
AF v29,v18,v29
C v60,v18,v19
M v[80:83],a[72:75],a[8:11],v[80:83]
SA s3,s93,266240
buffer_store_dwordx4 a[140:143], v7, s[8:11], s3 offen offset:2048 sc1
M v[80:83],a[76:79],a[12:15],v[80:83]
R a[104:107],v2,59392
R a[108:111],v2,60416
M v[80:83],a[80:83],a[16:19],v[80:83]
E v20,v118
M v[80:83],a[84:87],a[20:23],v[80:83]
AF v29,v19,v29
M v[80:83],a[88:91],a[24:27],v[80:83]
R a[112:115],v2,61440
R a[116:119],v2,62464
M v[80:83],a[92:95],a[28:31],v[80:83]
E v21,v119
M v[84:87],a[92:95],a[60:63],v[36:39]
AF v29,v20,v29
C v61,v20,v21
M v[84:87],a[88:91],a[56:59],v[84:87]
SA s3,s93,270336
R a[120:123],v2,63488
R a[124:127],v2,64512
M v[84:87],a[84:87],a[52:55],v[84:87]
buffer_store_dwordx4 a[144:147], v7, s[8:11], s3 offen offset:0 sc1
M v[84:87],a[80:83],a[48:51],v[84:87]
E v22,v124
M v[84:87],a[76:79],a[44:47],v[84:87]
AF v29,v21,v29
M v[84:87],a[72:75],a[40:43],v[84:87]
E v23,v125
M v[84:87],a[68:71],a[36:39],v[84:87]
s_waitcnt lgkmcnt(0)
AF v29,v22,v29
C v62,v22,v23
M v[84:87],a[64:67],a[32:35],v[84:87]
s_barrier
M v[88:91],a[96:99],a[0:3],v[32:35]
R a[64:67],v7,32768
R a[68:71],v7,33792
M v[88:91],a[100:103],a[4:7],v[88:91]
E v24,v126
M v[88:91],a[104:107],a[8:11],v[88:91]
AF v29,v23,v29
M v[88:91],a[108:111],a[12:15],v[88:91]
R a[72:75],v7,34816
R a[76:79],v7,35840
M v[88:91],a[112:115],a[16:19],v[88:91]
buffer_store_dwordx4 a[148:151], v7, s[8:11], s3 offen offset:2048 sc1
M v[88:91],a[116:119],a[20:23],v[88:91]
E v25,v127
M v[88:91],a[120:123],a[24:27],v[88:91]
R a[80:83],v7,36864
R a[84:87],v7,37888
M v[88:91],a[124:127],a[28:31],v[88:91]
AF v29,v24,v29
C v63,v24,v25
M v[92:95],a[124:127],a[60:63],v[36:39]
AF v29,v25,v29
M v[92:95],a[120:123],a[56:59],v[92:95]
R a[88:91],v7,38912
R a[92:95],v7,39936
M v[92:95],a[116:119],a[52:55],v[92:95]
v_max_f32 v10, v28, v29
M v[92:95],a[112:115],a[48:51],v[92:95]
v_cmp_lt_f32 vcc, s31, v10
M v[92:95],a[108:111],a[44:47],v[92:95]
M v[92:95],a[104:107],a[40:43],v[92:95]
M v[92:95],a[100:103],a[36:39],v[92:95]
s_waitcnt lgkmcnt(0)
M v[92:95],a[96:99],a[32:35],v[92:95]
s_cbranch_vccnz L_stv2
L_rtv2:
M v[128:131],a[64:67],v[48:51],v[128:131]
R a[96:99],v7,40960
R a[100:103],v7,41984
M v[128:131],a[68:71],v[56:59],v[128:131]
SA m0,s28,98304
E v18,v64
M v[132:135],a[68:71],v[60:63],v[132:135]
buffer_load_dwordx4 v3, s[8:11], s21 offen offset:0 sc1 lds
M v[132:135],a[64:67],v[52:55],v[132:135]
R a[104:107],v7,43008
R a[108:111],v7,44032
M v[136:139],a[72:75],v[48:51],v[136:139]
E v19,v65
M v[136:139],a[76:79],v[56:59],v[136:139]
AF v30,v28,v30
AF v31,v29,v31
M v[140:143],a[76:79],v[60:63],v[140:143]
R a[112:115],v7,45056
R a[116:119],v7,46080
M v[140:143],a[72:75],v[52:55],v[140:143]
buffer_load_dwordx4 v3, s[8:11], s21 offen offset:1024 sc1 lds
M v[144:147],a[80:83],v[48:51],v[144:147]
E v20,v66
M v[144:147],a[84:87],v[56:59],v[144:147]
R a[120:123],v7,47104
R a[124:127],v7,48128
M v[148:151],a[84:87],v[60:63],v[148:151]
AF v26,v18,v19
C v40,v18,v19
M v[148:151],a[80:83],v[52:55],v[148:151]
buffer_load_dwordx4 v3, s[8:11], s21 offen offset:2048 sc1 lds
M v[152:155],a[88:91],v[48:51],v[152:155]
E v21,v67
M v[152:155],a[92:95],v[56:59],v[152:155]
AF v26,v20,v26
C v41,v20,v21
M v[156:159],a[92:95],v[60:63],v[156:159]
AF v26,v21,v26
M v[156:159],a[88:91],v[52:55],v[156:159]
s_waitcnt lgkmcnt(0)
buffer_load_dwordx4 v3, s[8:11], s21 offen offset:3072 sc1 lds
M v[160:163],a[96:99],v[48:51],v[160:163]
SA m0,s28,102400
R a[64:67],v7,49152
R a[68:71],v7,50176
M v[160:163],a[100:103],v[56:59],v[160:163]
E v22,v72
M v[164:167],a[100:103],v[60:63],v[164:167]
E v23,v73
M v[164:167],a[96:99],v[52:55],v[164:167]
R a[72:75],v7,51200
R a[76:79],v7,52224
M v[168:171],a[104:107],v[48:51],v[168:171]
buffer_load_dwordx4 v4, s[8:11], s21 offen offset:0 sc1 lds
M v[168:171],a[108:111],v[56:59],v[168:171]
AF v26,v22,v26
C v42,v22,v23
M v[172:175],a[108:111],v[60:63],v[172:175]
R a[80:83],v7,53248
R a[84:87],v7,54272
M v[172:175],a[104:107],v[52:55],v[172:175]
buffer_load_dwordx4 v4, s[8:11], s21 offen offset:1024 sc1 lds
M v[176:179],a[112:115],v[48:51],v[176:179]
E v24,v74
M v[176:179],a[116:119],v[56:59],v[176:179]
R a[88:91],v7,55296
R a[92:95],v7,56320
M v[180:183],a[116:119],v[60:63],v[180:183]
buffer_load_dwordx4 v4, s[8:11], s21 offen offset:2048 sc1 lds
M v[180:183],a[112:115],v[52:55],v[180:183]
E v25,v75
M v[184:187],a[120:123],v[48:51],v[184:187]
AF v26,v23,v26
AF v26,v24,v26
M v[184:187],a[124:127],v[56:59],v[184:187]
C v43,v24,v25
AF v26,v25,v26
M v[188:191],a[124:127],v[60:63],v[188:191]
buffer_load_dwordx4 v4, s[8:11], s21 offen offset:3072 sc1 lds
M v[188:191],a[120:123],v[52:55],v[188:191]
s_waitcnt lgkmcnt(0)
E v18,v68
M v[192:195],a[64:67],v[48:51],v[192:195]
SA s21,s21,32768
R a[96:99],v7,57344
R a[100:103],v7,58368
M v[192:195],a[68:71],v[56:59],v[192:195]
s_sub_u32 s22, s22, 1
E v19,v69
M v[196:199],a[68:71],v[60:63],v[196:199]
s_cselect_b32 s21, s23, s21
AF v27,v18,v19
C v44,v18,v19
M v[196:199],a[64:67],v[52:55],v[196:199]
SA s3,s93,274432
R a[104:107],v7,59392
R a[108:111],v7,60416
M v[200:203],a[72:75],v[48:51],v[200:203]
buffer_store_dwordx4 a[152:155], v7, s[8:11], s3 offen offset:0 sc1
M v[200:203],a[76:79],v[56:59],v[200:203]
E v20,v70
M v[204:207],a[76:79],v[60:63],v[204:207]
R a[112:115],v7,61440
R a[116:119],v7,62464
M v[204:207],a[72:75],v[52:55],v[204:207]
M v[208:211],a[80:83],v[48:51],v[208:211]
M v[208:211],a[84:87],v[56:59],v[208:211]
R a[120:123],v7,63488
R a[124:127],v7,64512
M v[212:215],a[84:87],v[60:63],v[212:215]
buffer_store_dwordx4 a[156:159], v7, s[8:11], s3 offen offset:2048 sc1
M v[212:215],a[80:83],v[52:55],v[212:215]
E v21,v71
M v[216:219],a[88:91],v[48:51],v[216:219]
AF v27,v20,v27
C v45,v20,v21
M v[216:219],a[92:95],v[56:59],v[216:219]
E v22,v76
M v[220:223],a[92:95],v[60:63],v[220:223]
s_waitcnt vmcnt(25) lgkmcnt(0)
AF v27,v21,v27
M v[220:223],a[88:91],v[52:55],v[220:223]
s_barrier
M v[224:227],a[96:99],v[48:51],v[224:227]
R a[64:67],v2,0
R a[68:71],v2,1024
M v[224:227],a[100:103],v[56:59],v[224:227]
E v23,v77
M v[228:231],a[100:103],v[60:63],v[228:231]
SA s3,s93,786432
AF v27,v22,v27
C v46,v22,v23
M v[228:231],a[96:99],v[52:55],v[228:231]
R a[72:75],v2,2048
R a[76:79],v2,3072
M v[232:235],a[104:107],v[48:51],v[232:235]
buffer_store_dwordx4 a[160:163], v7, s[8:11], s3 offen offset:0 sc1
M v[232:235],a[108:111],v[56:59],v[232:235]
E v24,v78
M v[236:239],a[108:111],v[60:63],v[236:239]
R a[80:83],v2,4096
R a[84:87],v2,5120
M v[236:239],a[104:107],v[52:55],v[236:239]
AF v27,v23,v27
M v[240:243],a[112:115],v[48:51],v[240:243]
E v25,v79
M v[240:243],a[116:119],v[56:59],v[240:243]
R a[88:91],v2,6144
R a[92:95],v2,7168
M v[244:247],a[116:119],v[60:63],v[244:247]
AF v27,v24,v27
C v47,v24,v25
M v[244:247],a[112:115],v[52:55],v[244:247]
AF v27,v25,v27
M v[248:251],a[120:123],v[48:51],v[248:251]
M v[248:251],a[124:127],v[56:59],v[248:251]
M v[252:255],a[124:127],v[60:63],v[252:255]
s_waitcnt lgkmcnt(0)
M v[252:255],a[120:123],v[52:55],v[252:255]
M v[96:99],a[64:67],a[0:3],v[32:35]
R a[96:99],v2,8192
R a[100:103],v2,9216
M v[96:99],a[68:71],a[4:7],v[96:99]
SA m0,s28,32768
E v18,v80
M v[96:99],a[72:75],a[8:11],v[96:99]
buffer_load_dwordx4 v3, s[8:11], s26 offen offset:0 sc1 lds
M v[96:99],a[76:79],a[12:15],v[96:99]
R a[104:107],v2,10240
R a[108:111],v2,11264
M v[96:99],a[80:83],a[16:19],v[96:99]
E v19,v81
M v[96:99],a[84:87],a[20:23],v[96:99]
AF v26,v18,v26
C v56,v18,v19
M v[96:99],a[88:91],a[24:27],v[96:99]
R a[112:115],v2,12288
R a[116:119],v2,13312
M v[96:99],a[92:95],a[28:31],v[96:99]
buffer_load_dwordx4 v3, s[8:11], s26 offen offset:1024 sc1 lds
M v[100:103],a[92:95],a[60:63],v[36:39]
E v20,v82
M v[100:103],a[88:91],a[56:59],v[100:103]
R a[120:123],v2,14336
R a[124:127],v2,15360
M v[100:103],a[84:87],a[52:55],v[100:103]
E v21,v83
M v[100:103],a[80:83],a[48:51],v[100:103]
buffer_load_dwordx4 v3, s[8:11], s26 offen offset:2048 sc1 lds
M v[100:103],a[76:79],a[44:47],v[100:103]
AF v26,v19,v26
AF v26,v20,v26
M v[100:103],a[72:75],a[40:43],v[100:103]
C v57,v20,v21
AF v26,v21,v26
M v[100:103],a[68:71],a[36:39],v[100:103]
E v22,v88
M v[100:103],a[64:67],a[32:35],v[100:103]
s_waitcnt lgkmcnt(0)
buffer_load_dwordx4 v3, s[8:11], s26 offen offset:3072 sc1 lds
M v[104:107],a[96:99],a[0:3],v[32:35]
SA m0,s28,36864
R a[64:67],v2,16384
R a[68:71],v2,17408
M v[104:107],a[100:103],a[4:7],v[104:107]
E v23,v89
M v[104:107],a[104:107],a[8:11],v[104:107]
AF v26,v22,v26
C v58,v22,v23
M v[104:107],a[108:111],a[12:15],v[104:107]
R a[72:75],v2,18432
R a[76:79],v2,19456
M v[104:107],a[112:115],a[16:19],v[104:107]
buffer_load_dwordx4 v4, s[8:11], s26 offen offset:0 sc1 lds
M v[104:107],a[116:119],a[20:23],v[104:107]
E v24,v90
M v[104:107],a[120:123],a[24:27],v[104:107]
R a[80:83],v2,20480
R a[84:87],v2,21504
M v[104:107],a[124:127],a[28:31],v[104:107]
buffer_load_dwordx4 v4, s[8:11], s26 offen offset:1024 sc1 lds
M v[108:111],a[124:127],a[60:63],v[36:39]
E v25,v91
M v[108:111],a[120:123],a[56:59],v[108:111]
R a[88:91],v2,22528
R a[92:95],v2,23552
M v[108:111],a[116:119],a[52:55],v[108:111]
buffer_load_dwordx4 v4, s[8:11], s26 offen offset:2048 sc1 lds
M v[108:111],a[112:115],a[48:51],v[108:111]
AF v26,v23,v26
AF v26,v24,v26
M v[108:111],a[108:111],a[44:47],v[108:111]
E v18,v84
M v[108:111],a[104:107],a[40:43],v[108:111]
C v59,v24,v25
AF v26,v25,v26
M v[108:111],a[100:103],a[36:39],v[108:111]
buffer_load_dwordx4 v4, s[8:11], s26 offen offset:3072 sc1 lds
M v[108:111],a[96:99],a[32:35],v[108:111]
s_waitcnt lgkmcnt(0)
E v19,v85
M v[112:115],a[64:67],a[0:3],v[32:35]
SA s26,s26,32768
R a[96:99],v2,24576
R a[100:103],v2,25600
M v[112:115],a[68:71],a[4:7],v[112:115]
AF v27,v18,v27
C v60,v18,v19
M v[112:115],a[72:75],a[8:11],v[112:115]
SA s3,s93,786432
buffer_store_dwordx4 a[164:167], v7, s[8:11], s3 offen offset:2048 sc1
M v[112:115],a[76:79],a[12:15],v[112:115]
R a[104:107],v2,26624
R a[108:111],v2,27648
M v[112:115],a[80:83],a[16:19],v[112:115]
E v20,v86
M v[112:115],a[84:87],a[20:23],v[112:115]
AF v27,v19,v27
M v[112:115],a[88:91],a[24:27],v[112:115]
R a[112:115],v2,28672
R a[116:119],v2,29696
M v[112:115],a[92:95],a[28:31],v[112:115]
SA s3,s93,790528
E v21,v87
M v[116:119],a[92:95],a[60:63],v[36:39]
buffer_store_dwordx4 a[168:171], v7, s[8:11], s3 offen offset:0 sc1
M v[116:119],a[88:91],a[56:59],v[116:119]
R a[120:123],v2,30720
R a[124:127],v2,31744
M v[116:119],a[84:87],a[52:55],v[116:119]
E v22,v92
M v[116:119],a[80:83],a[48:51],v[116:119]
AF v27,v20,v27
C v61,v20,v21
M v[116:119],a[76:79],a[44:47],v[116:119]
AF v27,v21,v27
M v[116:119],a[72:75],a[40:43],v[116:119]
E v23,v93
M v[116:119],a[68:71],a[36:39],v[116:119]
s_waitcnt vmcnt(24) lgkmcnt(0)
AF v27,v22,v27
C v62,v22,v23
M v[116:119],a[64:67],a[32:35],v[116:119]
s_barrier
M v[120:123],a[96:99],a[0:3],v[32:35]
R a[64:67],v7,0
R a[68:71],v7,1024
M v[120:123],a[100:103],a[4:7],v[120:123]
buffer_store_dwordx4 a[172:175], v7, s[8:11], s3 offen offset:2048 sc1
M v[120:123],a[104:107],a[8:11],v[120:123]
E v24,v94
M v[120:123],a[108:111],a[12:15],v[120:123]
R a[72:75],v7,2048
R a[76:79],v7,3072
M v[120:123],a[112:115],a[16:19],v[120:123]
SA s3,s93,794624
E v25,v95
M v[120:123],a[116:119],a[20:23],v[120:123]
buffer_store_dwordx4 a[176:179], v7, s[8:11], s3 offen offset:0 sc1
M v[120:123],a[120:123],a[24:27],v[120:123]
R a[80:83],v7,4096
R a[84:87],v7,5120
M v[120:123],a[124:127],a[28:31],v[120:123]
AF v27,v23,v27
AF v27,v24,v27
M v[124:127],a[124:127],a[60:63],v[36:39]
C v63,v24,v25
AF v27,v25,v27
M v[124:127],a[120:123],a[56:59],v[124:127]
R a[88:91],v7,6144
R a[92:95],v7,7168
M v[124:127],a[116:119],a[52:55],v[124:127]
v_max_f32 v10, v26, v27
M v[124:127],a[112:115],a[48:51],v[124:127]
v_cmp_lt_f32 vcc, s31, v10
M v[124:127],a[108:111],a[44:47],v[124:127]
M v[124:127],a[104:107],a[40:43],v[124:127]
M v[124:127],a[100:103],a[36:39],v[124:127]
s_waitcnt lgkmcnt(0)
M v[124:127],a[96:99],a[32:35],v[124:127]
s_cbranch_vccnz L_stv3
L_rtv3:
M v[128:131],a[64:67],v[40:43],v[128:131]
R a[96:99],v7,8192
R a[100:103],v7,9216
M v[128:131],a[68:71],v[56:59],v[128:131]
SA m0,s28,65536
E v18,v96
M v[132:135],a[68:71],v[60:63],v[132:135]
buffer_load_dwordx4 v3, s[8:11], s21 offen offset:0 sc1 lds
M v[132:135],a[64:67],v[44:47],v[132:135]
R a[104:107],v7,10240
R a[108:111],v7,11264
M v[136:139],a[72:75],v[40:43],v[136:139]
E v19,v97
M v[136:139],a[76:79],v[56:59],v[136:139]
AF v30,v26,v30
AF v31,v27,v31
M v[140:143],a[76:79],v[60:63],v[140:143]
R a[112:115],v7,12288
R a[116:119],v7,13312
M v[140:143],a[72:75],v[44:47],v[140:143]
buffer_load_dwordx4 v3, s[8:11], s21 offen offset:1024 sc1 lds
M v[144:147],a[80:83],v[40:43],v[144:147]
E v20,v98
M v[144:147],a[84:87],v[56:59],v[144:147]
R a[120:123],v7,14336
R a[124:127],v7,15360
M v[148:151],a[84:87],v[60:63],v[148:151]
AF v28,v18,v19
C v48,v18,v19
M v[148:151],a[80:83],v[44:47],v[148:151]
buffer_load_dwordx4 v3, s[8:11], s21 offen offset:2048 sc1 lds
M v[152:155],a[88:91],v[40:43],v[152:155]
E v21,v99
M v[152:155],a[92:95],v[56:59],v[152:155]
AF v28,v20,v28
C v49,v20,v21
M v[156:159],a[92:95],v[60:63],v[156:159]
AF v28,v21,v28
M v[156:159],a[88:91],v[44:47],v[156:159]
s_waitcnt lgkmcnt(0)
buffer_load_dwordx4 v3, s[8:11], s21 offen offset:3072 sc1 lds
M v[160:163],a[96:99],v[40:43],v[160:163]
SA m0,s28,69632
R a[64:67],v7,16384
R a[68:71],v7,17408
M v[160:163],a[100:103],v[56:59],v[160:163]
E v22,v104
M v[164:167],a[100:103],v[60:63],v[164:167]
E v23,v105
M v[164:167],a[96:99],v[44:47],v[164:167]
R a[72:75],v7,18432
R a[76:79],v7,19456
M v[168:171],a[104:107],v[40:43],v[168:171]
buffer_load_dwordx4 v4, s[8:11], s21 offen offset:0 sc1 lds
M v[168:171],a[108:111],v[56:59],v[168:171]
AF v28,v22,v28
C v50,v22,v23
M v[172:175],a[108:111],v[60:63],v[172:175]
R a[80:83],v7,20480
R a[84:87],v7,21504
M v[172:175],a[104:107],v[44:47],v[172:175]
buffer_load_dwordx4 v4, s[8:11], s21 offen offset:1024 sc1 lds
M v[176:179],a[112:115],v[40:43],v[176:179]
E v24,v106
M v[176:179],a[116:119],v[56:59],v[176:179]
R a[88:91],v7,22528
R a[92:95],v7,23552
M v[180:183],a[116:119],v[60:63],v[180:183]
buffer_load_dwordx4 v4, s[8:11], s21 offen offset:2048 sc1 lds
M v[180:183],a[112:115],v[44:47],v[180:183]
E v25,v107
M v[184:187],a[120:123],v[40:43],v[184:187]
AF v28,v23,v28
AF v28,v24,v28
M v[184:187],a[124:127],v[56:59],v[184:187]
C v51,v24,v25
AF v28,v25,v28
M v[188:191],a[124:127],v[60:63],v[188:191]
buffer_load_dwordx4 v4, s[8:11], s21 offen offset:3072 sc1 lds
M v[188:191],a[120:123],v[44:47],v[188:191]
s_waitcnt lgkmcnt(0)
E v18,v100
M v[192:195],a[64:67],v[40:43],v[192:195]
SA s21,s21,32768
R a[96:99],v7,24576
R a[100:103],v7,25600
M v[192:195],a[68:71],v[56:59],v[192:195]
s_sub_u32 s22, s22, 1
E v19,v101
M v[196:199],a[68:71],v[60:63],v[196:199]
s_cselect_b32 s21, s23, s21
AF v29,v18,v19
C v52,v18,v19
M v[196:199],a[64:67],v[44:47],v[196:199]
SA s3,s93,794624
R a[104:107],v7,26624
R a[108:111],v7,27648
M v[200:203],a[72:75],v[40:43],v[200:203]
buffer_store_dwordx4 a[180:183], v7, s[8:11], s3 offen offset:2048 sc1
M v[200:203],a[76:79],v[56:59],v[200:203]
E v20,v102
M v[204:207],a[76:79],v[60:63],v[204:207]
R a[112:115],v7,28672
R a[116:119],v7,29696
M v[204:207],a[72:75],v[44:47],v[204:207]
M v[208:211],a[80:83],v[40:43],v[208:211]
M v[208:211],a[84:87],v[56:59],v[208:211]
SA s3,s93,798720
R a[120:123],v7,30720
R a[124:127],v7,31744
M v[212:215],a[84:87],v[60:63],v[212:215]
buffer_store_dwordx4 a[184:187], v7, s[8:11], s3 offen offset:0 sc1
M v[212:215],a[80:83],v[44:47],v[212:215]
E v21,v103
M v[216:219],a[88:91],v[40:43],v[216:219]
AF v29,v20,v29
C v53,v20,v21
M v[216:219],a[92:95],v[56:59],v[216:219]
E v22,v108
M v[220:223],a[92:95],v[60:63],v[220:223]
s_waitcnt vmcnt(25) lgkmcnt(0)
AF v29,v21,v29
M v[220:223],a[88:91],v[44:47],v[220:223]
s_barrier
M v[224:227],a[96:99],v[40:43],v[224:227]
R a[64:67],v2,32768
R a[68:71],v2,33792
M v[224:227],a[100:103],v[56:59],v[224:227]
E v23,v109
M v[228:231],a[100:103],v[60:63],v[228:231]
AF v29,v22,v29
C v54,v22,v23
M v[228:231],a[96:99],v[44:47],v[228:231]
R a[72:75],v2,34816
R a[76:79],v2,35840
M v[232:235],a[104:107],v[40:43],v[232:235]
buffer_store_dwordx4 a[188:191], v7, s[8:11], s3 offen offset:2048 sc1
M v[232:235],a[108:111],v[56:59],v[232:235]
E v24,v110
M v[236:239],a[108:111],v[60:63],v[236:239]
R a[80:83],v2,36864
R a[84:87],v2,37888
M v[236:239],a[104:107],v[44:47],v[236:239]
AF v29,v23,v29
M v[240:243],a[112:115],v[40:43],v[240:243]
E v25,v111
M v[240:243],a[116:119],v[56:59],v[240:243]
R a[88:91],v2,38912
R a[92:95],v2,39936
M v[244:247],a[116:119],v[60:63],v[244:247]
AF v29,v24,v29
C v55,v24,v25
M v[244:247],a[112:115],v[44:47],v[244:247]
AF v29,v25,v29
M v[248:251],a[120:123],v[40:43],v[248:251]
M v[248:251],a[124:127],v[56:59],v[248:251]
M v[252:255],a[124:127],v[60:63],v[252:255]
s_waitcnt lgkmcnt(0)
M v[252:255],a[120:123],v[44:47],v[252:255]
s_branch L_loop_top
L_st0:
s_call_b64 s[36:37], L_slow0
s_branch L_rt0
L_st1:
s_call_b64 s[36:37], L_slow1
s_branch L_rt1
L_stv1:
s_call_b64 s[36:37], L_slowf
s_branch L_rtv1
L_stk1:
s_call_b64 s[36:37], L_slowf
s_branch L_rtk1
L_sth1:
s_call_b64 s[36:37], L_slowf
s_branch L_rth1
L_stj0:
s_call_b64 s[36:37], L_slowj
s_branch L_rtj0
L_stv2:
s_call_b64 s[36:37], L_slow1
s_branch L_rtv2
L_stv3:
s_call_b64 s[36:37], L_slow0
s_branch L_rtv3
L_std1:
s_call_b64 s[36:37], L_slow1
s_branch L_rtd1
L_std3n:
s_call_b64 s[36:37], L_slow0
s_branch L_rtd3n
L_std3h:
s_call_b64 s[36:37], L_slow0
s_branch L_rtd3h
L_std4n:
s_call_b64 s[36:37], L_slowb
s_branch L_rtd4n
L_std4h:
s_call_b64 s[36:37], L_slowb
s_branch L_rtd4h
L_stfh:
s_call_b64 s[36:37], L_slow1n
s_branch L_rtfh
L_stc:
s_call_b64 s[36:37], L_comb
s_branch L_rtc
L_slow0:
s_nop 7
s_nop 3
v_max3_f32 v10, v64, v65, v66
v_max3_f32 v10, v67, v72, v10
v_max3_f32 v10, v73, v74, v10
v_max3_f32 v10, v75, v80, v10
v_max3_f32 v10, v81, v82, v10
v_max3_f32 v10, v83, v88, v10
v_max3_f32 v10, v89, v90, v10
v_max_f32 v10, v91, v10
v_max3_f32 v11, v68, v69, v70
v_max3_f32 v11, v71, v76, v11
v_max3_f32 v11, v77, v78, v11
v_max3_f32 v11, v79, v84, v11
v_max3_f32 v11, v85, v86, v11
v_max3_f32 v11, v87, v92, v11
v_max3_f32 v11, v93, v94, v11
v_max_f32 v11, v95, v11
v_mov_b32 v12, v10
v_mov_b32 v13, v11
s_nop 0
v_permlane16_swap_b32 v12, v10
v_permlane16_swap_b32 v13, v11
v_max_f32 v10, v12, v10
v_max_f32 v11, v13, v11
v_mov_b32 v12, v10
v_mov_b32 v13, v11
s_nop 0
v_permlane32_swap_b32 v12, v10
v_permlane32_swap_b32 v13, v11
v_max_f32 v10, v12, v10
v_max_f32 v11, v13, v11
v_ceil_f32 v10, v10
v_ceil_f32 v11, v11
v_max_f32 v10, 0, v10
v_max_f32 v11, 0, v11
v_sub_f32 v64, v64, v10
v_sub_f32 v65, v65, v10
v_sub_f32 v66, v66, v10
v_sub_f32 v67, v67, v10
v_sub_f32 v68, v68, v11
v_sub_f32 v69, v69, v11
v_sub_f32 v70, v70, v11
v_sub_f32 v71, v71, v11
v_sub_f32 v72, v72, v10
v_sub_f32 v73, v73, v10
v_sub_f32 v74, v74, v10
v_sub_f32 v75, v75, v10
v_sub_f32 v76, v76, v11
v_sub_f32 v77, v77, v11
v_sub_f32 v78, v78, v11
v_sub_f32 v79, v79, v11
v_sub_f32 v80, v80, v10
v_sub_f32 v81, v81, v10
v_sub_f32 v82, v82, v10
v_sub_f32 v83, v83, v10
v_sub_f32 v84, v84, v11
v_sub_f32 v85, v85, v11
v_sub_f32 v86, v86, v11
v_sub_f32 v87, v87, v11
v_sub_f32 v88, v88, v10
v_sub_f32 v89, v89, v10
v_sub_f32 v90, v90, v10
v_sub_f32 v91, v91, v10
v_sub_f32 v92, v92, v11
v_sub_f32 v93, v93, v11
v_sub_f32 v94, v94, v11
v_sub_f32 v95, v95, v11
v_sub_f32 v96, v96, v10
v_sub_f32 v97, v97, v10
v_sub_f32 v98, v98, v10
v_sub_f32 v99, v99, v10
v_sub_f32 v100, v100, v11
v_sub_f32 v101, v101, v11
v_sub_f32 v102, v102, v11
v_sub_f32 v103, v103, v11
v_sub_f32 v104, v104, v10
v_sub_f32 v105, v105, v10
v_sub_f32 v106, v106, v10
v_sub_f32 v107, v107, v10
v_sub_f32 v108, v108, v11
v_sub_f32 v109, v109, v11
v_sub_f32 v110, v110, v11
v_sub_f32 v111, v111, v11
v_sub_f32 v112, v112, v10
v_sub_f32 v113, v113, v10
v_sub_f32 v114, v114, v10
v_sub_f32 v115, v115, v10
v_sub_f32 v116, v116, v11
v_sub_f32 v117, v117, v11
v_sub_f32 v118, v118, v11
v_sub_f32 v119, v119, v11
v_sub_f32 v120, v120, v10
v_sub_f32 v121, v121, v10
v_sub_f32 v122, v122, v10
v_sub_f32 v123, v123, v10
v_sub_f32 v124, v124, v11
v_sub_f32 v125, v125, v11
v_sub_f32 v126, v126, v11
v_sub_f32 v127, v127, v11
v_sub_f32 v32, v32, v10
v_sub_f32 v33, v33, v10
v_sub_f32 v34, v34, v10
v_sub_f32 v35, v35, v10
v_sub_f32 v36, v36, v11
v_sub_f32 v37, v37, v11
v_sub_f32 v38, v38, v11
v_sub_f32 v39, v39, v11
E v12,-v10
E v13,-v11
MF v30,v12,v30
MF v31,v13,v31
MF v128,v12,v128
MF v129,v12,v129
MF v130,v12,v130
MF v131,v12,v131
MF v132,v13,v132
MF v133,v13,v133
MF v134,v13,v134
MF v135,v13,v135
MF v136,v12,v136
MF v137,v12,v137
MF v138,v12,v138
MF v139,v12,v139
MF v140,v13,v140
MF v141,v13,v141
MF v142,v13,v142
MF v143,v13,v143
MF v144,v12,v144
MF v145,v12,v145
MF v146,v12,v146
MF v147,v12,v147
MF v148,v13,v148
MF v149,v13,v149
MF v150,v13,v150
MF v151,v13,v151
MF v152,v12,v152
MF v153,v12,v153
MF v154,v12,v154
MF v155,v12,v155
MF v156,v13,v156
MF v157,v13,v157
MF v158,v13,v158
MF v159,v13,v159
MF v160,v12,v160
MF v161,v12,v161
MF v162,v12,v162
MF v163,v12,v163
MF v164,v13,v164
MF v165,v13,v165
MF v166,v13,v166
MF v167,v13,v167
MF v168,v12,v168
MF v169,v12,v169
MF v170,v12,v170
MF v171,v12,v171
MF v172,v13,v172
MF v173,v13,v173
MF v174,v13,v174
MF v175,v13,v175
MF v176,v12,v176
MF v177,v12,v177
MF v178,v12,v178
MF v179,v12,v179
MF v180,v13,v180
MF v181,v13,v181
MF v182,v13,v182
MF v183,v13,v183
MF v184,v12,v184
MF v185,v12,v185
MF v186,v12,v186
MF v187,v12,v187
MF v188,v13,v188
MF v189,v13,v189
MF v190,v13,v190
MF v191,v13,v191
MF v192,v12,v192
MF v193,v12,v193
MF v194,v12,v194
MF v195,v12,v195
MF v196,v13,v196
MF v197,v13,v197
MF v198,v13,v198
MF v199,v13,v199
MF v200,v12,v200
MF v201,v12,v201
MF v202,v12,v202
MF v203,v12,v203
MF v204,v13,v204
MF v205,v13,v205
MF v206,v13,v206
MF v207,v13,v207
MF v208,v12,v208
MF v209,v12,v209
MF v210,v12,v210
MF v211,v12,v211
MF v212,v13,v212
MF v213,v13,v213
MF v214,v13,v214
MF v215,v13,v215
MF v216,v12,v216
MF v217,v12,v217
MF v218,v12,v218
MF v219,v12,v219
MF v220,v13,v220
MF v221,v13,v221
MF v222,v13,v222
MF v223,v13,v223
MF v224,v12,v224
MF v225,v12,v225
MF v226,v12,v226
MF v227,v12,v227
MF v228,v13,v228
MF v229,v13,v229
MF v230,v13,v230
MF v231,v13,v231
MF v232,v12,v232
MF v233,v12,v233
MF v234,v12,v234
MF v235,v12,v235
MF v236,v13,v236
MF v237,v13,v237
MF v238,v13,v238
MF v239,v13,v239
MF v240,v12,v240
MF v241,v12,v241
MF v242,v12,v242
MF v243,v12,v243
MF v244,v13,v244
MF v245,v13,v245
MF v246,v13,v246
MF v247,v13,v247
MF v248,v12,v248
MF v249,v12,v249
MF v250,v12,v250
MF v251,v12,v251
MF v252,v13,v252
MF v253,v13,v253
MF v254,v13,v254
MF v255,v13,v255
E v18,v64
E v19,v65
E v20,v66
AF v26,v18,v19
C v40,v18,v19
E v21,v67
E v22,v72
AF v26,v20,v26
C v41,v20,v21
E v23,v73
AF v26,v21,v26
E v24,v74
AF v26,v22,v26
C v42,v22,v23
E v25,v75
AF v26,v23,v26
E v18,v68
AF v26,v24,v26
C v43,v24,v25
E v19,v69
AF v26,v25,v26
E v20,v70
AF v27,v18,v19
C v44,v18,v19
E v21,v71
E v22,v76
AF v27,v20,v27
C v45,v20,v21
E v23,v77
AF v27,v21,v27
E v24,v78
AF v27,v22,v27
C v46,v22,v23
E v25,v79
AF v27,v23,v27
AF v27,v24,v27
C v47,v24,v25
AF v27,v25,v27
E v18,v80
E v19,v81
E v20,v82
AF v26,v18,v26
C v56,v18,v19
E v21,v83
AF v26,v19,v26
E v22,v88
AF v26,v20,v26
C v57,v20,v21
E v23,v89
AF v26,v21,v26
E v24,v90
AF v26,v22,v26
C v58,v22,v23
E v25,v91
AF v26,v23,v26
E v18,v84
AF v26,v24,v26
C v59,v24,v25
E v19,v85
AF v26,v25,v26
E v20,v86
AF v27,v18,v27
C v60,v18,v19
E v21,v87
AF v27,v19,v27
E v22,v92
AF v27,v20,v27
C v61,v20,v21
E v23,v93
AF v27,v21,v27
E v24,v94
AF v27,v22,v27
C v62,v22,v23
E v25,v95
AF v27,v23,v27
AF v27,v24,v27
C v63,v24,v25
AF v27,v25,v27
s_nop 3
s_setpc_b64 s[36:37]
L_slow1:
s_nop 7
s_nop 3
v_max3_f32 v10, v96, v97, v98
v_max3_f32 v10, v99, v104, v10
v_max3_f32 v10, v105, v106, v10
v_max3_f32 v10, v107, v112, v10
v_max3_f32 v10, v113, v114, v10
v_max3_f32 v10, v115, v120, v10
v_max3_f32 v10, v121, v122, v10
v_max_f32 v10, v123, v10
v_max3_f32 v11, v100, v101, v102
v_max3_f32 v11, v103, v108, v11
v_max3_f32 v11, v109, v110, v11
v_max3_f32 v11, v111, v116, v11
v_max3_f32 v11, v117, v118, v11
v_max3_f32 v11, v119, v124, v11
v_max3_f32 v11, v125, v126, v11
v_max_f32 v11, v127, v11
v_mov_b32 v12, v10
v_mov_b32 v13, v11
s_nop 0
v_permlane16_swap_b32 v12, v10
v_permlane16_swap_b32 v13, v11
v_max_f32 v10, v12, v10
v_max_f32 v11, v13, v11
v_mov_b32 v12, v10
v_mov_b32 v13, v11
s_nop 0
v_permlane32_swap_b32 v12, v10
v_permlane32_swap_b32 v13, v11
v_max_f32 v10, v12, v10
v_max_f32 v11, v13, v11
v_ceil_f32 v10, v10
v_ceil_f32 v11, v11
v_max_f32 v10, 0, v10
v_max_f32 v11, 0, v11
v_sub_f32 v96, v96, v10
v_sub_f32 v97, v97, v10
v_sub_f32 v98, v98, v10
v_sub_f32 v99, v99, v10
v_sub_f32 v100, v100, v11
v_sub_f32 v101, v101, v11
v_sub_f32 v102, v102, v11
v_sub_f32 v103, v103, v11
v_sub_f32 v104, v104, v10
v_sub_f32 v105, v105, v10
v_sub_f32 v106, v106, v10
v_sub_f32 v107, v107, v10
v_sub_f32 v108, v108, v11
v_sub_f32 v109, v109, v11
v_sub_f32 v110, v110, v11
v_sub_f32 v111, v111, v11
v_sub_f32 v112, v112, v10
v_sub_f32 v113, v113, v10
v_sub_f32 v114, v114, v10
v_sub_f32 v115, v115, v10
v_sub_f32 v116, v116, v11
v_sub_f32 v117, v117, v11
v_sub_f32 v118, v118, v11
v_sub_f32 v119, v119, v11
v_sub_f32 v120, v120, v10
v_sub_f32 v121, v121, v10
v_sub_f32 v122, v122, v10
v_sub_f32 v123, v123, v10
v_sub_f32 v124, v124, v11
v_sub_f32 v125, v125, v11
v_sub_f32 v126, v126, v11
v_sub_f32 v127, v127, v11
v_sub_f32 v64, v64, v10
v_sub_f32 v65, v65, v10
v_sub_f32 v66, v66, v10
v_sub_f32 v67, v67, v10
v_sub_f32 v68, v68, v11
v_sub_f32 v69, v69, v11
v_sub_f32 v70, v70, v11
v_sub_f32 v71, v71, v11
v_sub_f32 v72, v72, v10
v_sub_f32 v73, v73, v10
v_sub_f32 v74, v74, v10
v_sub_f32 v75, v75, v10
v_sub_f32 v76, v76, v11
v_sub_f32 v77, v77, v11
v_sub_f32 v78, v78, v11
v_sub_f32 v79, v79, v11
v_sub_f32 v80, v80, v10
v_sub_f32 v81, v81, v10
v_sub_f32 v82, v82, v10
v_sub_f32 v83, v83, v10
v_sub_f32 v84, v84, v11
v_sub_f32 v85, v85, v11
v_sub_f32 v86, v86, v11
v_sub_f32 v87, v87, v11
v_sub_f32 v88, v88, v10
v_sub_f32 v89, v89, v10
v_sub_f32 v90, v90, v10
v_sub_f32 v91, v91, v10
v_sub_f32 v92, v92, v11
v_sub_f32 v93, v93, v11
v_sub_f32 v94, v94, v11
v_sub_f32 v95, v95, v11
v_sub_f32 v32, v32, v10
v_sub_f32 v33, v33, v10
v_sub_f32 v34, v34, v10
v_sub_f32 v35, v35, v10
v_sub_f32 v36, v36, v11
v_sub_f32 v37, v37, v11
v_sub_f32 v38, v38, v11
v_sub_f32 v39, v39, v11
E v12,-v10
E v13,-v11
MF v30,v12,v30
MF v31,v13,v31
MF v128,v12,v128
MF v129,v12,v129
MF v130,v12,v130
MF v131,v12,v131
MF v132,v13,v132
MF v133,v13,v133
MF v134,v13,v134
MF v135,v13,v135
MF v136,v12,v136
MF v137,v12,v137
MF v138,v12,v138
MF v139,v12,v139
MF v140,v13,v140
MF v141,v13,v141
MF v142,v13,v142
MF v143,v13,v143
MF v144,v12,v144
MF v145,v12,v145
MF v146,v12,v146
MF v147,v12,v147
MF v148,v13,v148
MF v149,v13,v149
MF v150,v13,v150
MF v151,v13,v151
MF v152,v12,v152
MF v153,v12,v153
MF v154,v12,v154
MF v155,v12,v155
MF v156,v13,v156
MF v157,v13,v157
MF v158,v13,v158
MF v159,v13,v159
MF v160,v12,v160
MF v161,v12,v161
MF v162,v12,v162
MF v163,v12,v163
MF v164,v13,v164
MF v165,v13,v165
MF v166,v13,v166
MF v167,v13,v167
MF v168,v12,v168
MF v169,v12,v169
MF v170,v12,v170
MF v171,v12,v171
MF v172,v13,v172
MF v173,v13,v173
MF v174,v13,v174
MF v175,v13,v175
MF v176,v12,v176
MF v177,v12,v177
MF v178,v12,v178
MF v179,v12,v179
MF v180,v13,v180
MF v181,v13,v181
MF v182,v13,v182
MF v183,v13,v183
MF v184,v12,v184
MF v185,v12,v185
MF v186,v12,v186
MF v187,v12,v187
MF v188,v13,v188
MF v189,v13,v189
MF v190,v13,v190
MF v191,v13,v191
MF v192,v12,v192
MF v193,v12,v193
MF v194,v12,v194
MF v195,v12,v195
MF v196,v13,v196
MF v197,v13,v197
MF v198,v13,v198
MF v199,v13,v199
MF v200,v12,v200
MF v201,v12,v201
MF v202,v12,v202
MF v203,v12,v203
MF v204,v13,v204
MF v205,v13,v205
MF v206,v13,v206
MF v207,v13,v207
MF v208,v12,v208
MF v209,v12,v209
MF v210,v12,v210
MF v211,v12,v211
MF v212,v13,v212
MF v213,v13,v213
MF v214,v13,v214
MF v215,v13,v215
MF v216,v12,v216
MF v217,v12,v217
MF v218,v12,v218
MF v219,v12,v219
MF v220,v13,v220
MF v221,v13,v221
MF v222,v13,v222
MF v223,v13,v223
MF v224,v12,v224
MF v225,v12,v225
MF v226,v12,v226
MF v227,v12,v227
MF v228,v13,v228
MF v229,v13,v229
MF v230,v13,v230
MF v231,v13,v231
MF v232,v12,v232
MF v233,v12,v233
MF v234,v12,v234
MF v235,v12,v235
MF v236,v13,v236
MF v237,v13,v237
MF v238,v13,v238
MF v239,v13,v239
MF v240,v12,v240
MF v241,v12,v241
MF v242,v12,v242
MF v243,v12,v243
MF v244,v13,v244
MF v245,v13,v245
MF v246,v13,v246
MF v247,v13,v247
MF v248,v12,v248
MF v249,v12,v249
MF v250,v12,v250
MF v251,v12,v251
MF v252,v13,v252
MF v253,v13,v253
MF v254,v13,v254
MF v255,v13,v255
E v18,v96
E v19,v97
E v20,v98
AF v28,v18,v19
C v48,v18,v19
E v21,v99
E v22,v104
AF v28,v20,v28
C v49,v20,v21
E v23,v105
AF v28,v21,v28
E v24,v106
AF v28,v22,v28
C v50,v22,v23
E v25,v107
AF v28,v23,v28
E v18,v100
AF v28,v24,v28
C v51,v24,v25
E v19,v101
AF v28,v25,v28
E v20,v102
AF v29,v18,v19
C v52,v18,v19
E v21,v103
E v22,v108
AF v29,v20,v29
C v53,v20,v21
E v23,v109
AF v29,v21,v29
E v24,v110
AF v29,v22,v29
C v54,v22,v23
E v25,v111
AF v29,v23,v29
AF v29,v24,v29
C v55,v24,v25
AF v29,v25,v29
E v18,v112
E v19,v113
E v20,v114
AF v28,v18,v28
C v56,v18,v19
E v21,v115
AF v28,v19,v28
E v22,v120
AF v28,v20,v28
C v57,v20,v21
E v23,v121
AF v28,v21,v28
E v24,v122
AF v28,v22,v28
C v58,v22,v23
E v25,v123
AF v28,v23,v28
E v18,v116
AF v28,v24,v28
C v59,v24,v25
E v19,v117
AF v28,v25,v28
E v20,v118
AF v29,v18,v29
C v60,v18,v19
E v21,v119
AF v29,v19,v29
E v22,v124
AF v29,v20,v29
C v61,v20,v21
E v23,v125
AF v29,v21,v29
E v24,v126
AF v29,v22,v29
C v62,v22,v23
E v25,v127
AF v29,v23,v29
AF v29,v24,v29
C v63,v24,v25
AF v29,v25,v29
s_nop 3
s_setpc_b64 s[36:37]
L_slow1n:
s_nop 7
s_nop 3
v_max3_f32 v10, v96, v97, v98
v_max3_f32 v10, v99, v104, v10
v_max3_f32 v10, v105, v106, v10
v_max3_f32 v10, v107, v112, v10
v_max3_f32 v10, v113, v114, v10
v_max3_f32 v10, v115, v120, v10
v_max3_f32 v10, v121, v122, v10
v_max_f32 v10, v123, v10
v_max3_f32 v11, v100, v101, v102
v_max3_f32 v11, v103, v108, v11
v_max3_f32 v11, v109, v110, v11
v_max3_f32 v11, v111, v116, v11
v_max3_f32 v11, v117, v118, v11
v_max3_f32 v11, v119, v124, v11
v_max3_f32 v11, v125, v126, v11
v_max_f32 v11, v127, v11
v_mov_b32 v12, v10
v_mov_b32 v13, v11
s_nop 0
v_permlane16_swap_b32 v12, v10
v_permlane16_swap_b32 v13, v11
v_max_f32 v10, v12, v10
v_max_f32 v11, v13, v11
v_mov_b32 v12, v10
v_mov_b32 v13, v11
s_nop 0
v_permlane32_swap_b32 v12, v10
v_permlane32_swap_b32 v13, v11
v_max_f32 v10, v12, v10
v_max_f32 v11, v13, v11
v_ceil_f32 v10, v10
v_ceil_f32 v11, v11
v_max_f32 v10, 0, v10
v_max_f32 v11, 0, v11
v_sub_f32 v96, v96, v10
v_sub_f32 v97, v97, v10
v_sub_f32 v98, v98, v10
v_sub_f32 v99, v99, v10
v_sub_f32 v100, v100, v11
v_sub_f32 v101, v101, v11
v_sub_f32 v102, v102, v11
v_sub_f32 v103, v103, v11
v_sub_f32 v104, v104, v10
v_sub_f32 v105, v105, v10
v_sub_f32 v106, v106, v10
v_sub_f32 v107, v107, v10
v_sub_f32 v108, v108, v11
v_sub_f32 v109, v109, v11
v_sub_f32 v110, v110, v11
v_sub_f32 v111, v111, v11
v_sub_f32 v112, v112, v10
v_sub_f32 v113, v113, v10
v_sub_f32 v114, v114, v10
v_sub_f32 v115, v115, v10
v_sub_f32 v116, v116, v11
v_sub_f32 v117, v117, v11
v_sub_f32 v118, v118, v11
v_sub_f32 v119, v119, v11
v_sub_f32 v120, v120, v10
v_sub_f32 v121, v121, v10
v_sub_f32 v122, v122, v10
v_sub_f32 v123, v123, v10
v_sub_f32 v124, v124, v11
v_sub_f32 v125, v125, v11
v_sub_f32 v126, v126, v11
v_sub_f32 v127, v127, v11
v_sub_f32 v32, v32, v10
v_sub_f32 v33, v33, v10
v_sub_f32 v34, v34, v10
v_sub_f32 v35, v35, v10
v_sub_f32 v36, v36, v11
v_sub_f32 v37, v37, v11
v_sub_f32 v38, v38, v11
v_sub_f32 v39, v39, v11
E v12,-v10
E v13,-v11
MF v30,v12,v30
MF v31,v13,v31
MF v128,v12,v128
MF v129,v12,v129
MF v130,v12,v130
MF v131,v12,v131
MF v132,v13,v132
MF v133,v13,v133
MF v134,v13,v134
MF v135,v13,v135
MF v136,v12,v136
MF v137,v12,v137
MF v138,v12,v138
MF v139,v12,v139
MF v140,v13,v140
MF v141,v13,v141
MF v142,v13,v142
MF v143,v13,v143
MF v144,v12,v144
MF v145,v12,v145
MF v146,v12,v146
MF v147,v12,v147
MF v148,v13,v148
MF v149,v13,v149
MF v150,v13,v150
MF v151,v13,v151
MF v152,v12,v152
MF v153,v12,v153
MF v154,v12,v154
MF v155,v12,v155
MF v156,v13,v156
MF v157,v13,v157
MF v158,v13,v158
MF v159,v13,v159
MF v160,v12,v160
MF v161,v12,v161
MF v162,v12,v162
MF v163,v12,v163
MF v164,v13,v164
MF v165,v13,v165
MF v166,v13,v166
MF v167,v13,v167
MF v168,v12,v168
MF v169,v12,v169
MF v170,v12,v170
MF v171,v12,v171
MF v172,v13,v172
MF v173,v13,v173
MF v174,v13,v174
MF v175,v13,v175
MF v176,v12,v176
MF v177,v12,v177
MF v178,v12,v178
MF v179,v12,v179
MF v180,v13,v180
MF v181,v13,v181
MF v182,v13,v182
MF v183,v13,v183
MF v184,v12,v184
MF v185,v12,v185
MF v186,v12,v186
MF v187,v12,v187
MF v188,v13,v188
MF v189,v13,v189
MF v190,v13,v190
MF v191,v13,v191
MF v192,v12,v192
MF v193,v12,v193
MF v194,v12,v194
MF v195,v12,v195
MF v196,v13,v196
MF v197,v13,v197
MF v198,v13,v198
MF v199,v13,v199
MF v200,v12,v200
MF v201,v12,v201
MF v202,v12,v202
MF v203,v12,v203
MF v204,v13,v204
MF v205,v13,v205
MF v206,v13,v206
MF v207,v13,v207
MF v208,v12,v208
MF v209,v12,v209
MF v210,v12,v210
MF v211,v12,v211
MF v212,v13,v212
MF v213,v13,v213
MF v214,v13,v214
MF v215,v13,v215
MF v216,v12,v216
MF v217,v12,v217
MF v218,v12,v218
MF v219,v12,v219
MF v220,v13,v220
MF v221,v13,v221
MF v222,v13,v222
MF v223,v13,v223
MF v224,v12,v224
MF v225,v12,v225
MF v226,v12,v226
MF v227,v12,v227
MF v228,v13,v228
MF v229,v13,v229
MF v230,v13,v230
MF v231,v13,v231
MF v232,v12,v232
MF v233,v12,v233
MF v234,v12,v234
MF v235,v12,v235
MF v236,v13,v236
MF v237,v13,v237
MF v238,v13,v238
MF v239,v13,v239
MF v240,v12,v240
MF v241,v12,v241
MF v242,v12,v242
MF v243,v12,v243
MF v244,v13,v244
MF v245,v13,v245
MF v246,v13,v246
MF v247,v13,v247
MF v248,v12,v248
MF v249,v12,v249
MF v250,v12,v250
MF v251,v12,v251
MF v252,v13,v252
MF v253,v13,v253
MF v254,v13,v254
MF v255,v13,v255
E v18,v96
E v19,v97
E v20,v98
AF v28,v18,v19
C v48,v18,v19
E v21,v99
E v22,v104
AF v28,v20,v28
C v49,v20,v21
E v23,v105
AF v28,v21,v28
E v24,v106
AF v28,v22,v28
C v50,v22,v23
E v25,v107
AF v28,v23,v28
E v18,v100
AF v28,v24,v28
C v51,v24,v25
E v19,v101
AF v28,v25,v28
E v20,v102
AF v29,v18,v19
C v52,v18,v19
E v21,v103
E v22,v108
AF v29,v20,v29
C v53,v20,v21
E v23,v109
AF v29,v21,v29
E v24,v110
AF v29,v22,v29
C v54,v22,v23
E v25,v111
AF v29,v23,v29
AF v29,v24,v29
C v55,v24,v25
AF v29,v25,v29
E v18,v112
E v19,v113
E v20,v114
AF v28,v18,v28
C v56,v18,v19
E v21,v115
AF v28,v19,v28
E v22,v120
AF v28,v20,v28
C v57,v20,v21
E v23,v121
AF v28,v21,v28
E v24,v122
AF v28,v22,v28
C v58,v22,v23
E v25,v123
AF v28,v23,v28
E v18,v116
AF v28,v24,v28
C v59,v24,v25
E v19,v117
AF v28,v25,v28
E v20,v118
AF v29,v18,v29
C v60,v18,v19
E v21,v119
AF v29,v19,v29
E v22,v124
AF v29,v20,v29
C v61,v20,v21
E v23,v125
AF v29,v21,v29
E v24,v126
AF v29,v22,v29
C v62,v22,v23
E v25,v127
AF v29,v23,v29
AF v29,v24,v29
C v63,v24,v25
AF v29,v25,v29
s_nop 3
s_setpc_b64 s[36:37]
L_slowf:
s_nop 7
s_nop 3
v_max3_f32 v10, v64, v65, v66
v_max3_f32 v10, v67, v72, v10
v_max3_f32 v10, v73, v74, v10
v_max3_f32 v10, v75, v80, v10
v_max3_f32 v10, v81, v82, v10
v_max3_f32 v10, v83, v88, v10
v_max3_f32 v10, v89, v90, v10
v_max_f32 v10, v91, v10
v_max3_f32 v11, v68, v69, v70
v_max3_f32 v11, v71, v76, v11
v_max3_f32 v11, v77, v78, v11
v_max3_f32 v11, v79, v84, v11
v_max3_f32 v11, v85, v86, v11
v_max3_f32 v11, v87, v92, v11
v_max3_f32 v11, v93, v94, v11
v_max_f32 v11, v95, v11
v_mov_b32 v12, v10
v_mov_b32 v13, v11
s_nop 0
v_permlane16_swap_b32 v12, v10
v_permlane16_swap_b32 v13, v11
v_max_f32 v10, v12, v10
v_max_f32 v11, v13, v11
v_mov_b32 v12, v10
v_mov_b32 v13, v11
s_nop 0
v_permlane32_swap_b32 v12, v10
v_permlane32_swap_b32 v13, v11
v_max_f32 v10, v12, v10
v_max_f32 v11, v13, v11
v_ceil_f32 v10, v10
v_ceil_f32 v11, v11
v_sub_f32 v64, v64, v10
v_sub_f32 v65, v65, v10
v_sub_f32 v66, v66, v10
v_sub_f32 v67, v67, v10
v_sub_f32 v68, v68, v11
v_sub_f32 v69, v69, v11
v_sub_f32 v70, v70, v11
v_sub_f32 v71, v71, v11
v_sub_f32 v72, v72, v10
v_sub_f32 v73, v73, v10
v_sub_f32 v74, v74, v10
v_sub_f32 v75, v75, v10
v_sub_f32 v76, v76, v11
v_sub_f32 v77, v77, v11
v_sub_f32 v78, v78, v11
v_sub_f32 v79, v79, v11
v_sub_f32 v80, v80, v10
v_sub_f32 v81, v81, v10
v_sub_f32 v82, v82, v10
v_sub_f32 v83, v83, v10
v_sub_f32 v84, v84, v11
v_sub_f32 v85, v85, v11
v_sub_f32 v86, v86, v11
v_sub_f32 v87, v87, v11
v_sub_f32 v88, v88, v10
v_sub_f32 v89, v89, v10
v_sub_f32 v90, v90, v10
v_sub_f32 v91, v91, v10
v_sub_f32 v92, v92, v11
v_sub_f32 v93, v93, v11
v_sub_f32 v94, v94, v11
v_sub_f32 v95, v95, v11
v_sub_f32 v96, v96, v10
v_sub_f32 v97, v97, v10
v_sub_f32 v98, v98, v10
v_sub_f32 v99, v99, v10
v_sub_f32 v100, v100, v11
v_sub_f32 v101, v101, v11
v_sub_f32 v102, v102, v11
v_sub_f32 v103, v103, v11
v_sub_f32 v104, v104, v10
v_sub_f32 v105, v105, v10
v_sub_f32 v106, v106, v10
v_sub_f32 v107, v107, v10
v_sub_f32 v108, v108, v11
v_sub_f32 v109, v109, v11
v_sub_f32 v110, v110, v11
v_sub_f32 v111, v111, v11
v_sub_f32 v112, v112, v10
v_sub_f32 v113, v113, v10
v_sub_f32 v114, v114, v10
v_sub_f32 v115, v115, v10
v_sub_f32 v116, v116, v11
v_sub_f32 v117, v117, v11
v_sub_f32 v118, v118, v11
v_sub_f32 v119, v119, v11
v_sub_f32 v120, v120, v10
v_sub_f32 v121, v121, v10
v_sub_f32 v122, v122, v10
v_sub_f32 v123, v123, v10
v_sub_f32 v124, v124, v11
v_sub_f32 v125, v125, v11
v_sub_f32 v126, v126, v11
v_sub_f32 v127, v127, v11
v_sub_f32 v32, v32, v10
v_sub_f32 v33, v33, v10
v_sub_f32 v34, v34, v10
v_sub_f32 v35, v35, v10
v_sub_f32 v36, v36, v11
v_sub_f32 v37, v37, v11
v_sub_f32 v38, v38, v11
v_sub_f32 v39, v39, v11
E v18,v64
E v19,v65
E v20,v66
AF v26,v18,v19
C v40,v18,v19
E v21,v67
E v22,v72
AF v26,v20,v26
C v41,v20,v21
E v23,v73
AF v26,v21,v26
E v24,v74
AF v26,v22,v26
C v42,v22,v23
E v25,v75
AF v26,v23,v26
E v18,v68
AF v26,v24,v26
C v43,v24,v25
E v19,v69
AF v26,v25,v26
E v20,v70
AF v27,v18,v19
C v44,v18,v19
E v21,v71
E v22,v76
AF v27,v20,v27
C v45,v20,v21
E v23,v77
AF v27,v21,v27
E v24,v78
AF v27,v22,v27
C v46,v22,v23
E v25,v79
AF v27,v23,v27
AF v27,v24,v27
C v47,v24,v25
AF v27,v25,v27
E v18,v80
E v19,v81
E v20,v82
AF v26,v18,v26
C v56,v18,v19
E v21,v83
AF v26,v19,v26
E v22,v88
AF v26,v20,v26
C v57,v20,v21
E v23,v89
AF v26,v21,v26
E v24,v90
AF v26,v22,v26
C v58,v22,v23
E v25,v91
AF v26,v23,v26
E v18,v84
AF v26,v24,v26
C v59,v24,v25
E v19,v85
AF v26,v25,v26
E v20,v86
AF v27,v18,v27
C v60,v18,v19
E v21,v87
AF v27,v19,v27
E v22,v92
AF v27,v20,v27
C v61,v20,v21
E v23,v93
AF v27,v21,v27
E v24,v94
AF v27,v22,v27
C v62,v22,v23
E v25,v95
AF v27,v23,v27
AF v27,v24,v27
C v63,v24,v25
AF v27,v25,v27
s_nop 3
s_setpc_b64 s[36:37]
L_slowj:
s_nop 7
s_nop 3
v_max3_f32 v10, v64, v65, v66
v_max3_f32 v10, v67, v72, v10
v_max3_f32 v10, v73, v74, v10
v_max3_f32 v10, v75, v80, v10
v_max3_f32 v10, v81, v82, v10
v_max3_f32 v10, v83, v88, v10
v_max3_f32 v10, v89, v90, v10
v_max_f32 v10, v91, v10
v_max3_f32 v11, v68, v69, v70
v_max3_f32 v11, v71, v76, v11
v_max3_f32 v11, v77, v78, v11
v_max3_f32 v11, v79, v84, v11
v_max3_f32 v11, v85, v86, v11
v_max3_f32 v11, v87, v92, v11
v_max3_f32 v11, v93, v94, v11
v_max_f32 v11, v95, v11
v_mov_b32 v12, v10
v_mov_b32 v13, v11
s_nop 0
v_permlane16_swap_b32 v12, v10
v_permlane16_swap_b32 v13, v11
v_max_f32 v10, v12, v10
v_max_f32 v11, v13, v11
v_mov_b32 v12, v10
v_mov_b32 v13, v11
s_nop 0
v_permlane32_swap_b32 v12, v10
v_permlane32_swap_b32 v13, v11
v_max_f32 v10, v12, v10
v_max_f32 v11, v13, v11
v_ceil_f32 v10, v10
v_ceil_f32 v11, v11
v_sub_f32 v64, v64, v10
v_sub_f32 v65, v65, v10
v_sub_f32 v66, v66, v10
v_sub_f32 v67, v67, v10
v_sub_f32 v68, v68, v11
v_sub_f32 v69, v69, v11
v_sub_f32 v70, v70, v11
v_sub_f32 v71, v71, v11
v_sub_f32 v72, v72, v10
v_sub_f32 v73, v73, v10
v_sub_f32 v74, v74, v10
v_sub_f32 v75, v75, v10
v_sub_f32 v76, v76, v11
v_sub_f32 v77, v77, v11
v_sub_f32 v78, v78, v11
v_sub_f32 v79, v79, v11
v_sub_f32 v80, v80, v10
v_sub_f32 v81, v81, v10
v_sub_f32 v82, v82, v10
v_sub_f32 v83, v83, v10
v_sub_f32 v84, v84, v11
v_sub_f32 v85, v85, v11
v_sub_f32 v86, v86, v11
v_sub_f32 v87, v87, v11
v_sub_f32 v88, v88, v10
v_sub_f32 v89, v89, v10
v_sub_f32 v90, v90, v10
v_sub_f32 v91, v91, v10
v_sub_f32 v92, v92, v11
v_sub_f32 v93, v93, v11
v_sub_f32 v94, v94, v11
v_sub_f32 v95, v95, v11
v_sub_f32 v32, v32, v10
v_sub_f32 v33, v33, v10
v_sub_f32 v34, v34, v10
v_sub_f32 v35, v35, v10
v_sub_f32 v36, v36, v11
v_sub_f32 v37, v37, v11
v_sub_f32 v38, v38, v11
v_sub_f32 v39, v39, v11
E v18,v64
E v19,v65
E v20,v66
AF v26,v18,v19
C v40,v18,v19
E v21,v67
E v22,v72
AF v26,v20,v26
C v41,v20,v21
E v23,v73
AF v26,v21,v26
E v24,v74
AF v26,v22,v26
C v42,v22,v23
E v25,v75
AF v26,v23,v26
E v18,v68
AF v26,v24,v26
C v43,v24,v25
E v19,v69
AF v26,v25,v26
E v20,v70
AF v27,v18,v19
C v44,v18,v19
E v21,v71
E v22,v76
AF v27,v20,v27
C v45,v20,v21
E v23,v77
AF v27,v21,v27
E v24,v78
AF v27,v22,v27
C v46,v22,v23
E v25,v79
AF v27,v23,v27
AF v27,v24,v27
C v47,v24,v25
AF v27,v25,v27
s_nop 3
s_setpc_b64 s[36:37]
L_slowb:
s_nop 7
s_nop 3
v_max3_f32 v11, v100, v101, v102
v_max3_f32 v11, v103, v108, v11
v_max3_f32 v11, v109, v110, v11
v_max3_f32 v11, v111, v116, v11
v_max3_f32 v11, v117, v118, v11
v_max3_f32 v11, v119, v124, v11
v_max3_f32 v11, v125, v126, v11
v_max_f32 v11, v127, v11
v_mov_b32 v13, v11
s_nop 1
v_permlane16_swap_b32 v13, v11
v_max_f32 v11, v13, v11
v_mov_b32 v13, v11
s_nop 1
v_permlane32_swap_b32 v13, v11
v_max_f32 v11, v13, v11
v_ceil_f32 v11, v11
v_max_f32 v11, 0, v11
v_mov_b32 v10, 0
v_sub_f32 v100, v100, v11
v_sub_f32 v101, v101, v11
v_sub_f32 v102, v102, v11
v_sub_f32 v103, v103, v11
v_sub_f32 v108, v108, v11
v_sub_f32 v109, v109, v11
v_sub_f32 v110, v110, v11
v_sub_f32 v111, v111, v11
v_sub_f32 v116, v116, v11
v_sub_f32 v117, v117, v11
v_sub_f32 v118, v118, v11
v_sub_f32 v119, v119, v11
v_sub_f32 v124, v124, v11
v_sub_f32 v125, v125, v11
v_sub_f32 v126, v126, v11
v_sub_f32 v127, v127, v11
v_sub_f32 v32, v32, v10
v_sub_f32 v33, v33, v10
v_sub_f32 v34, v34, v10
v_sub_f32 v35, v35, v10
v_sub_f32 v36, v36, v11
v_sub_f32 v37, v37, v11
v_sub_f32 v38, v38, v11
v_sub_f32 v39, v39, v11
E v12,-v10
E v13,-v11
MF v30,v12,v30
MF v31,v13,v31
MF v128,v12,v128
MF v129,v12,v129
MF v130,v12,v130
MF v131,v12,v131
MF v132,v13,v132
MF v133,v13,v133
MF v134,v13,v134
MF v135,v13,v135
MF v136,v12,v136
MF v137,v12,v137
MF v138,v12,v138
MF v139,v12,v139
MF v140,v13,v140
MF v141,v13,v141
MF v142,v13,v142
MF v143,v13,v143
MF v144,v12,v144
MF v145,v12,v145
MF v146,v12,v146
MF v147,v12,v147
MF v148,v13,v148
MF v149,v13,v149
MF v150,v13,v150
MF v151,v13,v151
MF v152,v12,v152
MF v153,v12,v153
MF v154,v12,v154
MF v155,v12,v155
MF v156,v13,v156
MF v157,v13,v157
MF v158,v13,v158
MF v159,v13,v159
MF v160,v12,v160
MF v161,v12,v161
MF v162,v12,v162
MF v163,v12,v163
MF v164,v13,v164
MF v165,v13,v165
MF v166,v13,v166
MF v167,v13,v167
MF v168,v12,v168
MF v169,v12,v169
MF v170,v12,v170
MF v171,v12,v171
MF v172,v13,v172
MF v173,v13,v173
MF v174,v13,v174
MF v175,v13,v175
MF v176,v12,v176
MF v177,v12,v177
MF v178,v12,v178
MF v179,v12,v179
MF v180,v13,v180
MF v181,v13,v181
MF v182,v13,v182
MF v183,v13,v183
MF v184,v12,v184
MF v185,v12,v185
MF v186,v12,v186
MF v187,v12,v187
MF v188,v13,v188
MF v189,v13,v189
MF v190,v13,v190
MF v191,v13,v191
MF v192,v12,v192
MF v193,v12,v193
MF v194,v12,v194
MF v195,v12,v195
MF v196,v13,v196
MF v197,v13,v197
MF v198,v13,v198
MF v199,v13,v199
MF v200,v12,v200
MF v201,v12,v201
MF v202,v12,v202
MF v203,v12,v203
MF v204,v13,v204
MF v205,v13,v205
MF v206,v13,v206
MF v207,v13,v207
MF v208,v12,v208
MF v209,v12,v209
MF v210,v12,v210
MF v211,v12,v211
MF v212,v13,v212
MF v213,v13,v213
MF v214,v13,v214
MF v215,v13,v215
MF v216,v12,v216
MF v217,v12,v217
MF v218,v12,v218
MF v219,v12,v219
MF v220,v13,v220
MF v221,v13,v221
MF v222,v13,v222
MF v223,v13,v223
MF v224,v12,v224
MF v225,v12,v225
MF v226,v12,v226
MF v227,v12,v227
MF v228,v13,v228
MF v229,v13,v229
MF v230,v13,v230
MF v231,v13,v231
MF v232,v12,v232
MF v233,v12,v233
MF v234,v12,v234
MF v235,v12,v235
MF v236,v13,v236
MF v237,v13,v237
MF v238,v13,v238
MF v239,v13,v239
MF v240,v12,v240
MF v241,v12,v241
MF v242,v12,v242
MF v243,v12,v243
MF v244,v13,v244
MF v245,v13,v245
MF v246,v13,v246
MF v247,v13,v247
MF v248,v12,v248
MF v249,v12,v249
MF v250,v12,v250
MF v251,v12,v251
MF v252,v13,v252
MF v253,v13,v253
MF v254,v13,v254
MF v255,v13,v255
E v18,v100
E v19,v101
E v20,v102
AF v29,v18,v19
C v52,v18,v19
E v21,v103
E v22,v108
AF v29,v20,v29
C v53,v20,v21
E v23,v109
AF v29,v21,v29
E v24,v110
AF v29,v22,v29
C v54,v22,v23
E v25,v111
AF v29,v23,v29
E v18,v116
AF v29,v24,v29
C v55,v24,v25
E v19,v117
AF v29,v25,v29
E v20,v118
AF v29,v18,v29
C v48,v18,v19
E v21,v119
AF v29,v19,v29
E v22,v124
AF v29,v20,v29
C v49,v20,v21
E v23,v125
AF v29,v21,v29
E v24,v126
AF v29,v22,v29
C v50,v22,v23
E v25,v127
AF v29,v23,v29
AF v29,v24,v29
C v51,v24,v25
AF v29,v25,v29
s_nop 3
s_setpc_b64 s[36:37]
L_comb:
s_waitcnt vmcnt(0)
s_nop 7
v_sub_f32 v10, v32, v14
v_sub_f32 v11, v36, v15
v_max_f32 v10, 0, v10
v_max_f32 v11, 0, v11
v_sub_f32 v100, v100, v11
v_sub_f32 v101, v101, v11
v_sub_f32 v102, v102, v11
v_sub_f32 v103, v103, v11
v_sub_f32 v108, v108, v11
v_sub_f32 v109, v109, v11
v_sub_f32 v110, v110, v11
v_sub_f32 v111, v111, v11
v_sub_f32 v116, v116, v11
v_sub_f32 v117, v117, v11
v_sub_f32 v118, v118, v11
v_sub_f32 v119, v119, v11
v_sub_f32 v124, v124, v11
v_sub_f32 v125, v125, v11
v_sub_f32 v126, v126, v11
v_sub_f32 v127, v127, v11
v_sub_f32 v32, v32, v10
v_sub_f32 v33, v33, v10
v_sub_f32 v34, v34, v10
v_sub_f32 v35, v35, v10
v_sub_f32 v36, v36, v11
v_sub_f32 v37, v37, v11
v_sub_f32 v38, v38, v11
v_sub_f32 v39, v39, v11
E v12,-v10
E v13,-v11
MF v30,v12,v30
MF v31,v13,v31
MF v128,v12,v128
MF v129,v12,v129
MF v130,v12,v130
MF v131,v12,v131
MF v132,v13,v132
MF v133,v13,v133
MF v134,v13,v134
MF v135,v13,v135
MF v136,v12,v136
MF v137,v12,v137
MF v138,v12,v138
MF v139,v12,v139
MF v140,v13,v140
MF v141,v13,v141
MF v142,v13,v142
MF v143,v13,v143
MF v144,v12,v144
MF v145,v12,v145
MF v146,v12,v146
MF v147,v12,v147
MF v148,v13,v148
MF v149,v13,v149
MF v150,v13,v150
MF v151,v13,v151
MF v152,v12,v152
MF v153,v12,v153
MF v154,v12,v154
MF v155,v12,v155
MF v156,v13,v156
MF v157,v13,v157
MF v158,v13,v158
MF v159,v13,v159
MF v160,v12,v160
MF v161,v12,v161
MF v162,v12,v162
MF v163,v12,v163
MF v164,v13,v164
MF v165,v13,v165
MF v166,v13,v166
MF v167,v13,v167
MF v168,v12,v168
MF v169,v12,v169
MF v170,v12,v170
MF v171,v12,v171
MF v172,v13,v172
MF v173,v13,v173
MF v174,v13,v174
MF v175,v13,v175
MF v176,v12,v176
MF v177,v12,v177
MF v178,v12,v178
MF v179,v12,v179
MF v180,v13,v180
MF v181,v13,v181
MF v182,v13,v182
MF v183,v13,v183
MF v184,v12,v184
MF v185,v12,v185
MF v186,v12,v186
MF v187,v12,v187
MF v188,v13,v188
MF v189,v13,v189
MF v190,v13,v190
MF v191,v13,v191
MF v192,v12,v192
MF v193,v12,v193
MF v194,v12,v194
MF v195,v12,v195
MF v196,v13,v196
MF v197,v13,v197
MF v198,v13,v198
MF v199,v13,v199
MF v200,v12,v200
MF v201,v12,v201
MF v202,v12,v202
MF v203,v12,v203
MF v204,v13,v204
MF v205,v13,v205
MF v206,v13,v206
MF v207,v13,v207
MF v208,v12,v208
MF v209,v12,v209
MF v210,v12,v210
MF v211,v12,v211
MF v212,v13,v212
MF v213,v13,v213
MF v214,v13,v214
MF v215,v13,v215
MF v216,v12,v216
MF v217,v12,v217
MF v218,v12,v218
MF v219,v12,v219
MF v220,v13,v220
MF v221,v13,v221
MF v222,v13,v222
MF v223,v13,v223
MF v224,v12,v224
MF v225,v12,v225
MF v226,v12,v226
MF v227,v12,v227
MF v228,v13,v228
MF v229,v13,v229
MF v230,v13,v230
MF v231,v13,v231
MF v232,v12,v232
MF v233,v12,v233
MF v234,v12,v234
MF v235,v12,v235
MF v236,v13,v236
MF v237,v13,v237
MF v238,v13,v238
MF v239,v13,v239
MF v240,v12,v240
MF v241,v12,v241
MF v242,v12,v242
MF v243,v12,v243
MF v244,v13,v244
MF v245,v13,v245
MF v246,v13,v246
MF v247,v13,v247
MF v248,v12,v248
MF v249,v12,v249
MF v250,v12,v250
MF v251,v12,v251
MF v252,v13,v252
MF v253,v13,v253
MF v254,v13,v254
MF v255,v13,v255
E v18,v100
E v19,v101
E v20,v102
AF v29,v18,v19
C v52,v18,v19
E v21,v103
E v22,v108
AF v29,v20,v29
C v53,v20,v21
E v23,v109
AF v29,v21,v29
E v24,v110
AF v29,v22,v29
C v54,v22,v23
E v25,v111
AF v29,v23,v29
E v18,v116
AF v29,v24,v29
C v55,v24,v25
E v19,v117
AF v29,v25,v29
E v20,v118
AF v29,v18,v29
C v48,v18,v19
E v21,v119
AF v29,v19,v29
E v22,v124
AF v29,v20,v29
C v49,v20,v21
E v23,v125
AF v29,v21,v29
E v24,v126
AF v29,v22,v29
C v50,v22,v23
E v25,v127
AF v29,v23,v29
AF v29,v24,v29
C v51,v24,v25
AF v29,v25,v29
v_sub_f32 v10, v32, v14
v_sub_f32 v11, v36, v15
E v10,v10
E v11,v11
s_nop 0
MF v16,v10,v16
MF v17,v11,v17
G v64,a128
v_and_b32 v65, 0xffff0000, v64
v_lshlrev_b32 v64, 16, v64
MF v64,v10,v64
MF v65,v10,v65
C v64,v64,v65
W a128,v64
G v66,a129
v_and_b32 v67, 0xffff0000, v66
v_lshlrev_b32 v66, 16, v66
MF v66,v10,v66
MF v67,v10,v67
C v66,v66,v67
W a129,v66
G v68,a130
v_and_b32 v69, 0xffff0000, v68
v_lshlrev_b32 v68, 16, v68
MF v68,v10,v68
MF v69,v10,v69
C v68,v68,v69
W a130,v68
G v70,a131
v_and_b32 v71, 0xffff0000, v70
v_lshlrev_b32 v70, 16, v70
MF v70,v10,v70
MF v71,v10,v71
C v70,v70,v71
W a131,v70
G v72,a132
v_and_b32 v73, 0xffff0000, v72
v_lshlrev_b32 v72, 16, v72
MF v72,v10,v72
MF v73,v10,v73
C v72,v72,v73
W a132,v72
G v74,a133
v_and_b32 v75, 0xffff0000, v74
v_lshlrev_b32 v74, 16, v74
MF v74,v10,v74
MF v75,v10,v75
C v74,v74,v75
W a133,v74
G v76,a134
v_and_b32 v77, 0xffff0000, v76
v_lshlrev_b32 v76, 16, v76
MF v76,v10,v76
MF v77,v10,v77
C v76,v76,v77
W a134,v76
G v78,a135
v_and_b32 v79, 0xffff0000, v78
v_lshlrev_b32 v78, 16, v78
MF v78,v10,v78
MF v79,v10,v79
C v78,v78,v79
W a135,v78
G v64,a136
v_and_b32 v65, 0xffff0000, v64
v_lshlrev_b32 v64, 16, v64
MF v64,v10,v64
MF v65,v10,v65
C v64,v64,v65
W a136,v64
G v66,a137
v_and_b32 v67, 0xffff0000, v66
v_lshlrev_b32 v66, 16, v66
MF v66,v10,v66
MF v67,v10,v67
C v66,v66,v67
W a137,v66
G v68,a138
v_and_b32 v69, 0xffff0000, v68
v_lshlrev_b32 v68, 16, v68
MF v68,v10,v68
MF v69,v10,v69
C v68,v68,v69
W a138,v68
G v70,a139
v_and_b32 v71, 0xffff0000, v70
v_lshlrev_b32 v70, 16, v70
MF v70,v10,v70
MF v71,v10,v71
C v70,v70,v71
W a139,v70
G v72,a140
v_and_b32 v73, 0xffff0000, v72
v_lshlrev_b32 v72, 16, v72
MF v72,v10,v72
MF v73,v10,v73
C v72,v72,v73
W a140,v72
G v74,a141
v_and_b32 v75, 0xffff0000, v74
v_lshlrev_b32 v74, 16, v74
MF v74,v10,v74
MF v75,v10,v75
C v74,v74,v75
W a141,v74
G v76,a142
v_and_b32 v77, 0xffff0000, v76
v_lshlrev_b32 v76, 16, v76
MF v76,v10,v76
MF v77,v10,v77
C v76,v76,v77
W a142,v76
G v78,a143
v_and_b32 v79, 0xffff0000, v78
v_lshlrev_b32 v78, 16, v78
MF v78,v10,v78
MF v79,v10,v79
C v78,v78,v79
W a143,v78
G v64,a144
v_and_b32 v65, 0xffff0000, v64
v_lshlrev_b32 v64, 16, v64
MF v64,v10,v64
MF v65,v10,v65
C v64,v64,v65
W a144,v64
G v66,a145
v_and_b32 v67, 0xffff0000, v66
v_lshlrev_b32 v66, 16, v66
MF v66,v10,v66
MF v67,v10,v67
C v66,v66,v67
W a145,v66
G v68,a146
v_and_b32 v69, 0xffff0000, v68
v_lshlrev_b32 v68, 16, v68
MF v68,v10,v68
MF v69,v10,v69
C v68,v68,v69
W a146,v68
G v70,a147
v_and_b32 v71, 0xffff0000, v70
v_lshlrev_b32 v70, 16, v70
MF v70,v10,v70
MF v71,v10,v71
C v70,v70,v71
W a147,v70
G v72,a148
v_and_b32 v73, 0xffff0000, v72
v_lshlrev_b32 v72, 16, v72
MF v72,v10,v72
MF v73,v10,v73
C v72,v72,v73
W a148,v72
G v74,a149
v_and_b32 v75, 0xffff0000, v74
v_lshlrev_b32 v74, 16, v74
MF v74,v10,v74
MF v75,v10,v75
C v74,v74,v75
W a149,v74
G v76,a150
v_and_b32 v77, 0xffff0000, v76
v_lshlrev_b32 v76, 16, v76
MF v76,v10,v76
MF v77,v10,v77
C v76,v76,v77
W a150,v76
G v78,a151
v_and_b32 v79, 0xffff0000, v78
v_lshlrev_b32 v78, 16, v78
MF v78,v10,v78
MF v79,v10,v79
C v78,v78,v79
W a151,v78
G v64,a152
v_and_b32 v65, 0xffff0000, v64
v_lshlrev_b32 v64, 16, v64
MF v64,v10,v64
MF v65,v10,v65
C v64,v64,v65
W a152,v64
G v66,a153
v_and_b32 v67, 0xffff0000, v66
v_lshlrev_b32 v66, 16, v66
MF v66,v10,v66
MF v67,v10,v67
C v66,v66,v67
W a153,v66
G v68,a154
v_and_b32 v69, 0xffff0000, v68
v_lshlrev_b32 v68, 16, v68
MF v68,v10,v68
MF v69,v10,v69
C v68,v68,v69
W a154,v68
G v70,a155
v_and_b32 v71, 0xffff0000, v70
v_lshlrev_b32 v70, 16, v70
MF v70,v10,v70
MF v71,v10,v71
C v70,v70,v71
W a155,v70
G v72,a156
v_and_b32 v73, 0xffff0000, v72
v_lshlrev_b32 v72, 16, v72
MF v72,v10,v72
MF v73,v10,v73
C v72,v72,v73
W a156,v72
G v74,a157
v_and_b32 v75, 0xffff0000, v74
v_lshlrev_b32 v74, 16, v74
MF v74,v10,v74
MF v75,v10,v75
C v74,v74,v75
W a157,v74
G v76,a158
v_and_b32 v77, 0xffff0000, v76
v_lshlrev_b32 v76, 16, v76
MF v76,v10,v76
MF v77,v10,v77
C v76,v76,v77
W a158,v76
G v78,a159
v_and_b32 v79, 0xffff0000, v78
v_lshlrev_b32 v78, 16, v78
MF v78,v10,v78
MF v79,v10,v79
C v78,v78,v79
W a159,v78
G v64,a160
v_and_b32 v65, 0xffff0000, v64
v_lshlrev_b32 v64, 16, v64
MF v64,v11,v64
MF v65,v11,v65
C v64,v64,v65
W a160,v64
G v66,a161
v_and_b32 v67, 0xffff0000, v66
v_lshlrev_b32 v66, 16, v66
MF v66,v11,v66
MF v67,v11,v67
C v66,v66,v67
W a161,v66
G v68,a162
v_and_b32 v69, 0xffff0000, v68
v_lshlrev_b32 v68, 16, v68
MF v68,v11,v68
MF v69,v11,v69
C v68,v68,v69
W a162,v68
G v70,a163
v_and_b32 v71, 0xffff0000, v70
v_lshlrev_b32 v70, 16, v70
MF v70,v11,v70
MF v71,v11,v71
C v70,v70,v71
W a163,v70
G v72,a164
v_and_b32 v73, 0xffff0000, v72
v_lshlrev_b32 v72, 16, v72
MF v72,v11,v72
MF v73,v11,v73
C v72,v72,v73
W a164,v72
G v74,a165
v_and_b32 v75, 0xffff0000, v74
v_lshlrev_b32 v74, 16, v74
MF v74,v11,v74
MF v75,v11,v75
C v74,v74,v75
W a165,v74
G v76,a166
v_and_b32 v77, 0xffff0000, v76
v_lshlrev_b32 v76, 16, v76
MF v76,v11,v76
MF v77,v11,v77
C v76,v76,v77
W a166,v76
G v78,a167
v_and_b32 v79, 0xffff0000, v78
v_lshlrev_b32 v78, 16, v78
MF v78,v11,v78
MF v79,v11,v79
C v78,v78,v79
W a167,v78
G v64,a168
v_and_b32 v65, 0xffff0000, v64
v_lshlrev_b32 v64, 16, v64
MF v64,v11,v64
MF v65,v11,v65
C v64,v64,v65
W a168,v64
G v66,a169
v_and_b32 v67, 0xffff0000, v66
v_lshlrev_b32 v66, 16, v66
MF v66,v11,v66
MF v67,v11,v67
C v66,v66,v67
W a169,v66
G v68,a170
v_and_b32 v69, 0xffff0000, v68
v_lshlrev_b32 v68, 16, v68
MF v68,v11,v68
MF v69,v11,v69
C v68,v68,v69
W a170,v68
G v70,a171
v_and_b32 v71, 0xffff0000, v70
v_lshlrev_b32 v70, 16, v70
MF v70,v11,v70
MF v71,v11,v71
C v70,v70,v71
W a171,v70
G v72,a172
v_and_b32 v73, 0xffff0000, v72
v_lshlrev_b32 v72, 16, v72
MF v72,v11,v72
MF v73,v11,v73
C v72,v72,v73
W a172,v72
G v74,a173
v_and_b32 v75, 0xffff0000, v74
v_lshlrev_b32 v74, 16, v74
MF v74,v11,v74
MF v75,v11,v75
C v74,v74,v75
W a173,v74
G v76,a174
v_and_b32 v77, 0xffff0000, v76
v_lshlrev_b32 v76, 16, v76
MF v76,v11,v76
MF v77,v11,v77
C v76,v76,v77
W a174,v76
G v78,a175
v_and_b32 v79, 0xffff0000, v78
v_lshlrev_b32 v78, 16, v78
MF v78,v11,v78
MF v79,v11,v79
C v78,v78,v79
W a175,v78
G v64,a176
v_and_b32 v65, 0xffff0000, v64
v_lshlrev_b32 v64, 16, v64
MF v64,v11,v64
MF v65,v11,v65
C v64,v64,v65
W a176,v64
G v66,a177
v_and_b32 v67, 0xffff0000, v66
v_lshlrev_b32 v66, 16, v66
MF v66,v11,v66
MF v67,v11,v67
C v66,v66,v67
W a177,v66
G v68,a178
v_and_b32 v69, 0xffff0000, v68
v_lshlrev_b32 v68, 16, v68
MF v68,v11,v68
MF v69,v11,v69
C v68,v68,v69
W a178,v68
G v70,a179
v_and_b32 v71, 0xffff0000, v70
v_lshlrev_b32 v70, 16, v70
MF v70,v11,v70
MF v71,v11,v71
C v70,v70,v71
W a179,v70
G v72,a180
v_and_b32 v73, 0xffff0000, v72
v_lshlrev_b32 v72, 16, v72
MF v72,v11,v72
MF v73,v11,v73
C v72,v72,v73
W a180,v72
G v74,a181
v_and_b32 v75, 0xffff0000, v74
v_lshlrev_b32 v74, 16, v74
MF v74,v11,v74
MF v75,v11,v75
C v74,v74,v75
W a181,v74
G v76,a182
v_and_b32 v77, 0xffff0000, v76
v_lshlrev_b32 v76, 16, v76
MF v76,v11,v76
MF v77,v11,v77
C v76,v76,v77
W a182,v76
G v78,a183
v_and_b32 v79, 0xffff0000, v78
v_lshlrev_b32 v78, 16, v78
MF v78,v11,v78
MF v79,v11,v79
C v78,v78,v79
W a183,v78
G v64,a184
v_and_b32 v65, 0xffff0000, v64
v_lshlrev_b32 v64, 16, v64
MF v64,v11,v64
MF v65,v11,v65
C v64,v64,v65
W a184,v64
G v66,a185
v_and_b32 v67, 0xffff0000, v66
v_lshlrev_b32 v66, 16, v66
MF v66,v11,v66
MF v67,v11,v67
C v66,v66,v67
W a185,v66
G v68,a186
v_and_b32 v69, 0xffff0000, v68
v_lshlrev_b32 v68, 16, v68
MF v68,v11,v68
MF v69,v11,v69
C v68,v68,v69
W a186,v68
G v70,a187
v_and_b32 v71, 0xffff0000, v70
v_lshlrev_b32 v70, 16, v70
MF v70,v11,v70
MF v71,v11,v71
C v70,v70,v71
W a187,v70
G v72,a188
v_and_b32 v73, 0xffff0000, v72
v_lshlrev_b32 v72, 16, v72
MF v72,v11,v72
MF v73,v11,v73
C v72,v72,v73
W a188,v72
G v74,a189
v_and_b32 v75, 0xffff0000, v74
v_lshlrev_b32 v74, 16, v74
MF v74,v11,v74
MF v75,v11,v75
C v74,v74,v75
W a189,v74
G v76,a190
v_and_b32 v77, 0xffff0000, v76
v_lshlrev_b32 v76, 16, v76
MF v76,v11,v76
MF v77,v11,v77
C v76,v76,v77
W a190,v76
G v78,a191
v_and_b32 v79, 0xffff0000, v78
v_lshlrev_b32 v78, 16, v78
MF v78,v11,v78
MF v79,v11,v79
C v78,v78,v79
W a191,v78
s_nop 3
s_setpc_b64 s[36:37]
L_zs0:
s_mov_b32 s64, 65536
L_zs0_l:
s_sleep 2
buffer_load_dword v17, v16, s[12:15], 0 offen sc1
s_sub_u32 s64, s64, 1
s_cbranch_scc1 L_zs0_x
s_waitcnt vmcnt(0)
v_cmp_ne_u32 vcc, 1, v17
s_nop 0
s_cbranch_vccnz L_zs0_l
L_zs0_x:
s_waitcnt vmcnt(0)
s_branch L_zr0
L_zs1:
s_mov_b32 s64, 65536
L_zs1_l:
s_sleep 2
buffer_load_dword v17, v16, s[12:15], 0 offen sc1
s_sub_u32 s64, s64, 1
s_cbranch_scc1 L_zs1_x
s_waitcnt vmcnt(0)
v_cmp_ne_u32 vcc, 1, v17
s_nop 0
s_cbranch_vccnz L_zs1_l
L_zs1_x:
s_waitcnt vmcnt(0)
s_branch L_zr1
L_hs:
s_mov_b32 s91, 65536
L_hs_l:
buffer_load_dwordx4 v[16:19], v7, s[8:11], s67 offen offset:0 sc1
buffer_load_dwordx4 v[20:23], v7, s[8:11], s67 offen offset:1024 sc1
s_waitcnt vmcnt(0)
s_sub_u32 s91, s91, 1
s_cbranch_scc1 L_hr
v_min3_u32 v28, v16, v17, v18
v_min3_u32 v28, v28, v19, v20
v_min3_u32 v28, v28, v21, v22
v_min_u32 v28, v28, v23
v_cmp_eq_u32 vcc, 0, v28
s_nop 0
s_cbranch_vccnz L_hs_l
s_branch L_hr
L_lsj0:
s_mov_b32 s91, 65536
L_lsj0_l:
s_sleep 2
buffer_load_dword v5, v17, s[8:11], s46 offen sc1
s_sub_u32 s91, s91, 1
s_cbranch_scc1 L_lsj0_x
s_waitcnt vmcnt(0)
v_cmp_gt_u32 vcc, 2, v5
s_nop 0
s_cbranch_vccnz L_lsj0_l
L_lsj0_x:
s_waitcnt vmcnt(0)
s_branch L_lrj0
L_lsh2:
s_mov_b32 s91, 65536
L_lsh2_l:
s_sleep 2
buffer_load_dword v5, v17, s[8:11], s46 offen sc1
s_sub_u32 s91, s91, 1
s_cbranch_scc1 L_lsh2_x
s_waitcnt vmcnt(0)
v_cmp_gt_u32 vcc, 2, v5
s_nop 0
s_cbranch_vccnz L_lsh2_l
L_lsh2_x:
s_waitcnt vmcnt(0)
s_branch L_lrh2
L_lsh4:
s_mov_b32 s91, 65536
L_lsh4_l:
s_sleep 2
buffer_load_dword v5, v9, s[8:11], s46 offen sc1
s_sub_u32 s91, s91, 1
s_cbranch_scc1 L_lsh4_x
s_waitcnt vmcnt(0)
v_cmp_gt_u32 vcc, 2, v5
s_nop 0
s_cbranch_vccnz L_lsh4_l
L_lsh4_x:
s_waitcnt vmcnt(0)
s_branch L_lrh4
L_wsq0:
s_mov_b32 s91, 65536
L_wsq0_l:
s_sleep 2
buffer_load_dword v5, v31, s[8:11], s46 offen offset:4 sc1
s_sub_u32 s91, s91, 1
s_cbranch_scc1 L_wsq0_x
s_waitcnt vmcnt(0)
v_cmp_ne_u32 vcc, 1, v5
s_nop 0
s_mov_b32 vcc_hi, 0
s_cbranch_vccnz L_wsq0_l
L_wsq0_x:
s_waitcnt vmcnt(0)
s_branch L_wrq0
L_wsr0:
s_mov_b32 s91, 65536
L_wsr0_l:
s_sleep 2
buffer_load_dword v5, v31, s[8:11], s46 offen offset:4 sc1
s_sub_u32 s91, s91, 1
s_cbranch_scc1 L_wsr0_x
s_waitcnt vmcnt(0)
v_cmp_ne_u32 vcc, 1, v5
s_nop 0
s_mov_b32 vcc_lo, 0
s_cbranch_vccnz L_wsr0_l
L_wsr0_x:
s_waitcnt vmcnt(0)
s_branch L_wrr0
L_wsq1:
s_mov_b32 s91, 65536
L_wsq1_l:
s_sleep 2
buffer_load_dword v5, v31, s[8:11], s46 offen offset:4 sc1
s_sub_u32 s91, s91, 1
s_cbranch_scc1 L_wsq1_x
s_waitcnt vmcnt(0)
v_cmp_ne_u32 vcc, 1, v5
s_nop 0
s_mov_b32 vcc_hi, 0
s_cbranch_vccnz L_wsq1_l
L_wsq1_x:
s_waitcnt vmcnt(0)
s_branch L_wrq1
L_wsr1:
s_mov_b32 s91, 65536
L_wsr1_l:
s_sleep 2
buffer_load_dword v5, v31, s[8:11], s46 offen offset:4 sc1
s_sub_u32 s91, s91, 1
s_cbranch_scc1 L_wsr1_x
s_waitcnt vmcnt(0)
v_cmp_ne_u32 vcc, 1, v5
s_nop 0
s_mov_b32 vcc_lo, 0
s_cbranch_vccnz L_wsr1_l
L_wsr1_x:
s_waitcnt vmcnt(0)
s_branch L_wrr1
L_fll:
s_cmp_eq_u32 s42, 8
s_cbranch_scc1 L_fl8
L_fl0:
s_cmp_lg_u32 s20, 0
s_cbranch_scc1 L_fl3
s_lshr_b32 s64, s42, 3
s_cmp_eq_u32 s7, s64
s_cbranch_scc0 L_fl1
v_mov_b32 v15, 4
buffer_store_dword v15, v1, s[8:11], s45 offen sc1
L_fl1:
s_cmp_lt_u32 s7, s40
s_cbranch_scc1 L_fllr
s_cmp_eq_u32 s7, s40
s_cselect_b32 s64, 0x380, -1
v_min_u32 v17, s64, v9
s_mov_b32 s6, 4
buffer_load_dword v5, v17, s[8:11], s46 offen sc1
s_branch L_fllr
L_fl8:
s_mul_i32 s64, s20, 57344
s_sub_u32 s65, s7, 1
s_lshl_b32 s65, s65, 14
SA s64,s64,s65
SA s65,s64,8192
v_lshlrev_b32 v11, 3, v7
s_bitcmp1_b32 0, s7
s_cbranch_scc0 L_fl0
buffer_load_dword a240, v11, s[12:15], s64 offen offset:0
s_waitcnt vmcnt(0)
buffer_load_dword a240, v11, s[12:15], s65 offen offset:0
s_cmp_gt_u32 s7, 2
s_cbranch_scc1 L_fllr
s_cmp_lg_u32 s20, 0
s_cbranch_scc1 L_fllr
s_branch L_fl0
L_fl3:
s_cmp_eq_u32 s7, 1
s_cbranch_scc1 L_y2
s_cmp_eq_u32 s7, 2
s_cbranch_scc1 L_y3
s_cmp_eq_u32 s7, 3
s_cbranch_scc1 L_y4
s_branch L_y5
s_waitcnt vmcnt(0)
L_fps:
s_cmp_lg_u32 s35, 0
s_cbranch_scc1 L_fpr
L_fps2:
s_mov_b32 s91, 65536
L_fps2_l:
s_sleep 2
buffer_load_dword v6, off, s[8:11], s47 sc1
s_sub_u32 s91, s91, 1
s_cbranch_scc1 L_fps2_x
s_waitcnt vmcnt(0)
v_cmp_ne_u32 vcc, 1, v6
s_nop 0
s_cbranch_vccnz L_fps2_l
L_fps2_x:
s_waitcnt vmcnt(0)
s_branch L_fpr
L_fqs:
s_mov_b32 s91, 65536
L_fqs_l:
s_sleep 2
buffer_load_dword v6, off, s[8:11], s47 offset:16 sc1
s_sub_u32 s91, s91, 1
s_cbranch_scc1 L_fqs_x
s_waitcnt vmcnt(0)
v_cmp_ne_u32 vcc, 1, v6
s_nop 0
s_cbranch_vccnz L_fqs_l
L_fqs_x:
s_waitcnt vmcnt(0)
s_branch L_fqr
L_fls0:
s_mov_b32 s91, 65536
L_fls0_l:
s_sleep 2
buffer_load_dword v5, v17, s[8:11], s46 offen sc1
s_sub_u32 s91, s91, 1
s_cbranch_scc1 L_fls0_x
s_waitcnt vmcnt(0)
v_cmp_gt_u32 vcc, s6, v5
s_nop 0
s_cbranch_vccnz L_fls0_l
L_fls0_x:
s_waitcnt vmcnt(0)
s_branch L_flr0
L_y2:
v_lshrrev_b32 v11, 7, v7
v_mul_u32_u24 v11, 4352, v11
v_and_b32 v12, 0x70, v7
v_lshl_add_u32 v11, v12, 3, v11
s_mov_b32 s64, 104923136
s_mov_b32 s65, 104957952
buffer_load_dword a128, v11, s[8:11], s64 offen sc1
buffer_load_dword a129, v11, s[8:11], s65 offen sc1
s_branch L_fllr
s_waitcnt vmcnt(0)
L_y3:
s_mov_b32 s91, 65536
L_y3c:
G v12,a128
G v13,a129
v_min_u32 v12, v12, v13
v_cmp_gt_u32 vcc, 2, v12
s_sub_u32 s91, s91, 1
s_cbranch_scc1 L_y3x
s_cbranch_vccz L_y3x
v_lshrrev_b32 v11, 7, v7
v_mul_u32_u24 v11, 4352, v11
v_and_b32 v12, 0x70, v7
v_lshl_add_u32 v11, v12, 3, v11
s_mov_b32 s64, 104923136
s_mov_b32 s65, 104957952
buffer_load_dword a128, v11, s[8:11], s64 offen sc1
buffer_load_dword a129, v11, s[8:11], s65 offen sc1
s_waitcnt vmcnt(0)
s_branch L_y3c
L_y3x:
s_lshl_b32 s66, s41, 1
SA s66,s66,s20
s_sub_u32 s66, s66, 2
s_cmp_lt_u32 s66, 14
s_cselect_b32 s64, 8, 12
SA s64,s64,104890368
buffer_load_dword a130, off, s[8:11], s64 sc1
v_lshrrev_b32 v11, 7, v7
v_mul_u32_u24 v11, 3584, v11
v_and_b32 v12, 0x70, v7
v_add_u32 v11, v12, v11
s_lshl_b32 s65, s66, 7
SA s65,s65,105906176
buffer_load_dwordx4 a[132:135], v11, s[8:11], s65 offen sc1
SA s65,s65,28672
buffer_load_dwordx4 a[136:139], v11, s[8:11], s65 offen sc1
SA s65,s65,28672
buffer_load_dwordx4 a[140:143], v11, s[8:11], s65 offen sc1
SA s65,s65,28672
buffer_load_dwordx4 a[144:147], v11, s[8:11], s65 offen sc1
SA s65,s65,28672
buffer_load_dwordx4 a[148:151], v11, s[8:11], s65 offen sc1
SA s65,s65,28672
buffer_load_dwordx4 a[152:155], v11, s[8:11], s65 offen sc1
SA s65,s65,28672
buffer_load_dwordx4 a[156:159], v11, s[8:11], s65 offen sc1
SA s65,s65,28672
buffer_load_dwordx4 a[160:163], v11, s[8:11], s65 offen sc1
SA s65,s65,28672
buffer_load_dwordx4 a[164:167], v11, s[8:11], s65 offen sc1
SA s65,s65,28672
buffer_load_dwordx4 a[168:171], v11, s[8:11], s65 offen sc1
SA s65,s65,28672
buffer_load_dwordx4 a[172:175], v11, s[8:11], s65 offen sc1
SA s65,s65,28672
buffer_load_dwordx4 a[176:179], v11, s[8:11], s65 offen sc1
SA s65,s65,28672
buffer_load_dwordx4 a[180:183], v11, s[8:11], s65 offen sc1
SA s65,s65,28672
buffer_load_dwordx4 a[184:187], v11, s[8:11], s65 offen sc1
SA s65,s65,28672
s_branch L_fllr
s_waitcnt vmcnt(0)
L_y4:
G v12,a132
G v13,a133
G v14,a134
G v15,a135
G v16,a136
G v17,a137
AF v12,v16,v12
AF v13,v17,v13
G v16,a138
G v17,a139
AF v14,v16,v14
AF v15,v17,v15
G v16,a140
G v17,a141
AF v12,v16,v12
AF v13,v17,v13
G v16,a142
G v17,a143
AF v14,v16,v14
AF v15,v17,v15
G v16,a144
G v17,a145
AF v12,v16,v12
AF v13,v17,v13
G v16,a146
G v17,a147
AF v14,v16,v14
AF v15,v17,v15
G v16,a148
G v17,a149
AF v12,v16,v12
AF v13,v17,v13
G v16,a150
G v17,a151
AF v14,v16,v14
AF v15,v17,v15
G v16,a152
G v17,a153
AF v12,v16,v12
AF v13,v17,v13
G v16,a154
G v17,a155
AF v14,v16,v14
AF v15,v17,v15
G v16,a156
G v17,a157
AF v12,v16,v12
AF v13,v17,v13
G v16,a158
G v17,a159
AF v14,v16,v14
AF v15,v17,v15
G v16,a160
G v17,a161
AF v12,v16,v12
AF v13,v17,v13
G v16,a162
G v17,a163
AF v14,v16,v14
AF v15,v17,v15
G v16,a164
G v17,a165
AF v12,v16,v12
AF v13,v17,v13
G v16,a166
G v17,a167
AF v14,v16,v14
AF v15,v17,v15
G v16,a168
G v17,a169
AF v12,v16,v12
AF v13,v17,v13
G v16,a170
G v17,a171
AF v14,v16,v14
AF v15,v17,v15
G v16,a172
G v17,a173
AF v12,v16,v12
AF v13,v17,v13
G v16,a174
G v17,a175
AF v14,v16,v14
AF v15,v17,v15
G v16,a176
G v17,a177
AF v12,v16,v12
AF v13,v17,v13
G v16,a178
G v17,a179
AF v14,v16,v14
AF v15,v17,v15
G v16,a180
G v17,a181
AF v12,v16,v12
AF v13,v17,v13
G v16,a182
G v17,a183
AF v14,v16,v14
AF v15,v17,v15
G v16,a184
G v17,a185
AF v12,v16,v12
AF v13,v17,v13
G v16,a186
G v17,a187
AF v14,v16,v14
AF v15,v17,v15
v_add_f32 v12, v12, v12 row_ror:8 row_mask:0xf bank_mask:0xf
v_add_f32 v13, v13, v13 row_ror:8 row_mask:0xf bank_mask:0xf
v_add_f32 v14, v14, v14 row_ror:8 row_mask:0xf bank_mask:0xf
v_add_f32 v15, v15, v15 row_ror:8 row_mask:0xf bank_mask:0xf
v_mov_b32 v11, v12
s_nop 1
v_permlane16_swap_b32 v11, v12
AF v12,v11,v12
v_mov_b32 v11, v13
s_nop 1
v_permlane16_swap_b32 v11, v13
AF v13,v11,v13
v_mov_b32 v11, v14
s_nop 1
v_permlane16_swap_b32 v11, v14
AF v14,v11,v14
v_mov_b32 v11, v15
s_nop 1
v_permlane16_swap_b32 v11, v15
AF v15,v11,v15
v_mov_b32 v11, v12
s_nop 1
v_permlane32_swap_b32 v11, v12
AF v12,v11,v12
v_mov_b32 v11, v13
s_nop 1
v_permlane32_swap_b32 v11, v13
AF v13,v11,v13
v_mov_b32 v11, v14
s_nop 1
v_permlane32_swap_b32 v11, v14
AF v14,v11,v14
v_mov_b32 v11, v15
s_nop 1
v_permlane32_swap_b32 v11, v15
AF v15,v11,v15
G v16,a130
C v11,v12,v13
v_lshlrev_b32 v12, 16, v11
v_and_b32 v13, 0xffff0000, v11
C v11,v14,v15
v_lshlrev_b32 v14, 16, v11
v_and_b32 v15, 0xffff0000, v11
MF v12,v16,v12
MF v13,v16,v13
MF v14,v16,v14
MF v15,v16,v15
C v11,v12,v13
v_lshlrev_b32 v12, 16, v11
v_and_b32 v13, 0xffff0000, v11
C v11,v14,v15
v_lshlrev_b32 v14, 16, v11
v_and_b32 v15, 0xffff0000, v11
s_lshl_b32 s66, s41, 1
SA s66,s66,s20
s_sub_u32 s66, s66, 2
s_lshl_b32 s65, s66, 7
SA s65,s65,104898560
s_mov_b64 exec, 0xff
buffer_store_dwordx4 v[12:15], v7, s[8:11], s65 offen sc1
s_mov_b64 exec, -1
s_nop 1
s_branch L_fllr
L_y5:
s_lshl_b32 s66, s41, 1
SA s66,s66,s20
s_sub_u32 s66, s66, 2
s_lshl_b32 s66, s66, 2
SA s66,s66,105062912
v_mov_b32 v11, 1
s_mov_b64 exec, 1
buffer_store_dword v11, off, s[8:11], s66 sc1
s_mov_b64 exec, -1
s_branch L_fllr
.p2align 12
L_loop_top:
M v[64:67],a[64:67],a[0:3],v[32:35]
SA m0,s28,0
R a[96:99],v2,40960
M v[64:67],a[68:71],a[4:7],v[64:67]
buffer_load_dword a240, v0, s[60:63], 0 offen offset:0
M v[64:67],a[72:75],a[8:11],v[64:67]
R a[100:103],v2,41984
M v[64:67],a[76:79],a[12:15],v[64:67]
s_waitcnt lgkmcnt(2)
buffer_load_dwordx4 v3, s[8:11], s26 offen offset:0 sc1 lds
M v[64:67],a[80:83],a[16:19],v[64:67]
R a[104:107],v2,43008
M v[64:67],a[84:87],a[20:23],v[64:67]
E v18,v112
M v[64:67],a[88:91],a[24:27],v[64:67]
R a[108:111],v2,44032
M v[64:67],a[92:95],a[28:31],v[64:67]
buffer_load_dwordx4 v3, s[8:11], s26 offen offset:1024 sc1 lds
M v[68:71],a[92:95],a[60:63],v[36:39]
R a[112:115],v2,45056
M v[68:71],a[88:91],a[56:59],v[68:71]
E v19,v113
M v[68:71],a[84:87],a[52:55],v[68:71]
R a[116:119],v2,46080
AF v28,v18,v28
M v[68:71],a[80:83],a[48:51],v[68:71]
E v20,v114
M v[68:71],a[76:79],a[44:47],v[68:71]
R a[120:123],v2,47104
C v56,v18,v19
M v[68:71],a[72:75],a[40:43],v[68:71]
buffer_load_dwordx4 v3, s[8:11], s26 offen offset:2048 sc1 lds
M v[68:71],a[68:71],a[36:39],v[68:71]
R a[124:127],v2,48128
AF v28,v19,v28
M v[68:71],a[64:67],a[32:35],v[68:71]
s_waitcnt lgkmcnt(4)
E v21,v115
M v[72:75],a[96:99],a[0:3],v[32:35]
R a[64:67],v2,49152
AF v28,v20,v28
M v[72:75],a[100:103],a[4:7],v[72:75]
buffer_load_dwordx4 v3, s[8:11], s26 offen offset:3072 sc1 lds
M v[72:75],a[104:107],a[8:11],v[72:75]
R a[68:71],v2,50176
C v57,v20,v21
M v[72:75],a[108:111],a[12:15],v[72:75]
s_waitcnt lgkmcnt(2)
E v22,v120
M v[72:75],a[112:115],a[16:19],v[72:75]
R a[72:75],v2,51200
AF v28,v21,v28
M v[72:75],a[116:119],a[20:23],v[72:75]
E v23,v121
M v[72:75],a[120:123],a[24:27],v[72:75]
SA m0,s28,4096
R a[76:79],v2,52224
AF v28,v22,v28
M v[72:75],a[124:127],a[28:31],v[72:75]
buffer_load_dwordx4 v4, s[8:11], s26 offen offset:0 sc1 lds
M v[76:79],a[124:127],a[60:63],v[36:39]
R a[80:83],v2,53248
C v58,v22,v23
M v[76:79],a[120:123],a[56:59],v[76:79]
E v24,v122
M v[76:79],a[116:119],a[52:55],v[76:79]
R a[84:87],v2,54272
AF v28,v23,v28
M v[76:79],a[112:115],a[48:51],v[76:79]
E v25,v123
M v[76:79],a[108:111],a[44:47],v[76:79]
R a[88:91],v2,55296
AF v28,v24,v28
M v[76:79],a[104:107],a[40:43],v[76:79]
buffer_load_dwordx4 v4, s[8:11], s26 offen offset:1024 sc1 lds
M v[76:79],a[100:103],a[36:39],v[76:79]
R a[92:95],v2,56320
C v59,v24,v25
M v[76:79],a[96:99],a[32:35],v[76:79]
s_waitcnt lgkmcnt(4)
E v18,v116
M v[80:83],a[64:67],a[0:3],v[32:35]
R a[96:99],v2,57344
AF v28,v25,v28
M v[80:83],a[68:71],a[4:7],v[80:83]
R a[100:103],v2,58368
M v[80:83],a[72:75],a[8:11],v[80:83]
buffer_load_dwordx4 v4, s[8:11], s26 offen offset:2048 sc1 lds
M v[80:83],a[76:79],a[12:15],v[80:83]
s_waitcnt lgkmcnt(2)
R a[104:107],v2,59392
M v[80:83],a[80:83],a[16:19],v[80:83]
R a[108:111],v2,60416
M v[80:83],a[84:87],a[20:23],v[80:83]
E v19,v117
M v[80:83],a[88:91],a[24:27],v[80:83]
R a[112:115],v2,61440
AF v29,v18,v29
M v[80:83],a[92:95],a[28:31],v[80:83]
R a[116:119],v2,62464
C v60,v18,v19
M v[84:87],a[92:95],a[60:63],v[36:39]
buffer_load_dwordx4 v4, s[8:11], s26 offen offset:3072 sc1 lds
M v[84:87],a[88:91],a[56:59],v[84:87]
SA s26,s26,32768
R a[120:123],v2,63488
AF v29,v19,v29
M v[84:87],a[84:87],a[52:55],v[84:87]
R a[124:127],v2,64512
M v[84:87],a[80:83],a[48:51],v[84:87]
E v20,v118
M v[84:87],a[76:79],a[44:47],v[84:87]
E v21,v119
M v[84:87],a[72:75],a[40:43],v[84:87]
E v22,v124
M v[84:87],a[68:71],a[36:39],v[84:87]
s_waitcnt vmcnt(17) lgkmcnt(0)
E v23,v125
M v[84:87],a[64:67],a[32:35],v[84:87]
s_barrier
M v[88:91],a[96:99],a[0:3],v[32:35]
R a[64:67],v7,32768
AF v29,v20,v29
M v[88:91],a[100:103],a[4:7],v[88:91]
E v24,v126
M v[88:91],a[104:107],a[8:11],v[88:91]
R a[68:71],v7,33792
C v61,v20,v21
M v[88:91],a[108:111],a[12:15],v[88:91]
AF v29,v21,v29
AF v29,v22,v29
M v[88:91],a[112:115],a[16:19],v[88:91]
R a[72:75],v7,34816
C v62,v22,v23
M v[88:91],a[116:119],a[20:23],v[88:91]
E v25,v127
M v[88:91],a[120:123],a[24:27],v[88:91]
R a[76:79],v7,35840
AF v29,v23,v29
M v[88:91],a[124:127],a[28:31],v[88:91]
AF v29,v24,v29
C v63,v24,v25
M v[92:95],a[124:127],a[60:63],v[36:39]
R a[80:83],v7,36864
AF v29,v25,v29
M v[92:95],a[120:123],a[56:59],v[92:95]
M v[92:95],a[116:119],a[52:55],v[92:95]
R a[84:87],v7,37888
v_max_f32 v10, v28, v29
M v[92:95],a[112:115],a[48:51],v[92:95]
v_cmp_lt_f32 vcc, s31, v10
M v[92:95],a[108:111],a[44:47],v[92:95]
R a[88:91],v7,38912
M v[92:95],a[104:107],a[40:43],v[92:95]
M v[92:95],a[100:103],a[36:39],v[92:95]
s_waitcnt lgkmcnt(3)
R a[92:95],v7,39936
M v[92:95],a[96:99],a[32:35],v[92:95]
s_cbranch_vccnz L_st1
L_rt1:
M v[128:131],a[64:67],v[48:51],v[128:131]
SA m0,s28,98304
R a[96:99],v7,40960
AF v30,v28,v30
M v[128:131],a[68:71],v[56:59],v[128:131]
buffer_load_dwordx4 v3, s[8:11], s21 offen offset:0 sc1 lds
M v[132:135],a[68:71],v[60:63],v[132:135]
R a[100:103],v7,41984
AF v31,v29,v31
M v[132:135],a[64:67],v[52:55],v[132:135]
s_waitcnt lgkmcnt(2)
E v18,v64
M v[136:139],a[72:75],v[48:51],v[136:139]
R a[104:107],v7,43008
M v[136:139],a[76:79],v[56:59],v[136:139]
buffer_load_dwordx4 v3, s[8:11], s21 offen offset:1024 sc1 lds
M v[140:143],a[76:79],v[60:63],v[140:143]
R a[108:111],v7,44032
M v[140:143],a[72:75],v[52:55],v[140:143]
E v19,v65
M v[144:147],a[80:83],v[48:51],v[144:147]
R a[112:115],v7,45056
AF v26,v18,v19
M v[144:147],a[84:87],v[56:59],v[144:147]
E v20,v66
M v[148:151],a[84:87],v[60:63],v[148:151]
R a[116:119],v7,46080
C v40,v18,v19
M v[148:151],a[80:83],v[52:55],v[148:151]
buffer_load_dwordx4 v3, s[8:11], s21 offen offset:2048 sc1 lds
M v[152:155],a[88:91],v[48:51],v[152:155]
R a[120:123],v7,47104
M v[152:155],a[92:95],v[56:59],v[152:155]
E v21,v67
M v[156:159],a[92:95],v[60:63],v[156:159]
R a[124:127],v7,48128
AF v26,v20,v26
M v[156:159],a[88:91],v[52:55],v[156:159]
s_waitcnt lgkmcnt(4)
buffer_load_dwordx4 v3, s[8:11], s21 offen offset:3072 sc1 lds
M v[160:163],a[96:99],v[48:51],v[160:163]
R a[64:67],v7,49152
C v41,v20,v21
M v[160:163],a[100:103],v[56:59],v[160:163]
E v22,v72
M v[164:167],a[100:103],v[60:63],v[164:167]
SA m0,s28,102400
R a[68:71],v7,50176
AF v26,v21,v26
M v[164:167],a[96:99],v[52:55],v[164:167]
s_waitcnt lgkmcnt(2)
buffer_load_dwordx4 v4, s[8:11], s21 offen offset:0 sc1 lds
M v[168:171],a[104:107],v[48:51],v[168:171]
R a[72:75],v7,51200
M v[168:171],a[108:111],v[56:59],v[168:171]
E v23,v73
M v[172:175],a[108:111],v[60:63],v[172:175]
R a[76:79],v7,52224
AF v26,v22,v26
M v[172:175],a[104:107],v[52:55],v[172:175]
E v24,v74
M v[176:179],a[112:115],v[48:51],v[176:179]
R a[80:83],v7,53248
C v42,v22,v23
M v[176:179],a[116:119],v[56:59],v[176:179]
buffer_load_dwordx4 v4, s[8:11], s21 offen offset:1024 sc1 lds
M v[180:183],a[116:119],v[60:63],v[180:183]
R a[84:87],v7,54272
AF v26,v23,v26
M v[180:183],a[112:115],v[52:55],v[180:183]
E v25,v75
M v[184:187],a[120:123],v[48:51],v[184:187]
R a[88:91],v7,55296
AF v26,v24,v26
M v[184:187],a[124:127],v[56:59],v[184:187]
buffer_load_dwordx4 v4, s[8:11], s21 offen offset:2048 sc1 lds
M v[188:191],a[124:127],v[60:63],v[188:191]
R a[92:95],v7,56320
C v43,v24,v25
M v[188:191],a[120:123],v[52:55],v[188:191]
s_waitcnt lgkmcnt(4)
E v18,v68
M v[192:195],a[64:67],v[48:51],v[192:195]
R a[96:99],v7,57344
AF v26,v25,v26
M v[192:195],a[68:71],v[56:59],v[192:195]
R a[100:103],v7,58368
M v[196:199],a[68:71],v[60:63],v[196:199]
buffer_load_dwordx4 v4, s[8:11], s21 offen offset:3072 sc1 lds
M v[196:199],a[64:67],v[52:55],v[196:199]
s_waitcnt lgkmcnt(2)
R a[104:107],v7,59392
M v[200:203],a[72:75],v[48:51],v[200:203]
SA s21,s21,32768
R a[108:111],v7,60416
M v[200:203],a[76:79],v[56:59],v[200:203]
s_sub_u32 s22, s22, 1
E v19,v69
M v[204:207],a[76:79],v[60:63],v[204:207]
s_cselect_b32 s21, s23, s21
R a[112:115],v7,61440
AF v27,v18,v19
M v[204:207],a[72:75],v[52:55],v[204:207]
R a[116:119],v7,62464
C v44,v18,v19
M v[208:211],a[80:83],v[48:51],v[208:211]
E v20,v70
M v[208:211],a[84:87],v[56:59],v[208:211]
R a[120:123],v7,63488
M v[212:215],a[84:87],v[60:63],v[212:215]
R a[124:127],v7,64512
M v[212:215],a[80:83],v[52:55],v[212:215]
E v21,v71
M v[216:219],a[88:91],v[48:51],v[216:219]
E v22,v76
M v[216:219],a[92:95],v[56:59],v[216:219]
AF v27,v20,v27
C v45,v20,v21
M v[220:223],a[92:95],v[60:63],v[220:223]
s_waitcnt vmcnt(17) lgkmcnt(0)
AF v27,v21,v27
M v[220:223],a[88:91],v[52:55],v[220:223]
s_barrier
M v[224:227],a[96:99],v[48:51],v[224:227]
R a[64:67],v2,0
M v[224:227],a[100:103],v[56:59],v[224:227]
E v23,v77
M v[228:231],a[100:103],v[60:63],v[228:231]
R a[68:71],v2,1024
AF v27,v22,v27
M v[228:231],a[96:99],v[52:55],v[228:231]
E v24,v78
M v[232:235],a[104:107],v[48:51],v[232:235]
R a[72:75],v2,2048
C v46,v22,v23
M v[232:235],a[108:111],v[56:59],v[232:235]
AF v27,v23,v27
M v[236:239],a[108:111],v[60:63],v[236:239]
R a[76:79],v2,3072
M v[236:239],a[104:107],v[52:55],v[236:239]
E v25,v79
M v[240:243],a[112:115],v[48:51],v[240:243]
R a[80:83],v2,4096
AF v27,v24,v27
M v[240:243],a[116:119],v[56:59],v[240:243]
C v47,v24,v25
AF v27,v25,v27
M v[244:247],a[116:119],v[60:63],v[244:247]
R a[84:87],v2,5120
M v[244:247],a[112:115],v[52:55],v[244:247]
M v[248:251],a[120:123],v[48:51],v[248:251]
R a[88:91],v2,6144
M v[248:251],a[124:127],v[56:59],v[248:251]
M v[252:255],a[124:127],v[60:63],v[252:255]
s_waitcnt lgkmcnt(3)
R a[92:95],v2,7168
M v[252:255],a[120:123],v[52:55],v[252:255]
M v[96:99],a[64:67],a[0:3],v[32:35]
s_bitcmp1_b32 s39, s7
R a[96:99],v2,8192
M v[96:99],a[68:71],a[4:7],v[96:99]
s_cbranch_scc1 L_fll
L_fllr:
E v18,v80
M v[96:99],a[72:75],a[8:11],v[96:99]
SA m0,s28,32768
R a[100:103],v2,9216
M v[96:99],a[76:79],a[12:15],v[96:99]
s_waitcnt lgkmcnt(2)
buffer_load_dwordx4 v3, s[8:11], s26 offen offset:0 sc1 lds
M v[96:99],a[80:83],a[16:19],v[96:99]
R a[104:107],v2,10240
M v[96:99],a[84:87],a[20:23],v[96:99]
E v19,v81
M v[96:99],a[88:91],a[24:27],v[96:99]
R a[108:111],v2,11264
AF v26,v18,v26
M v[96:99],a[92:95],a[28:31],v[96:99]
E v20,v82
M v[100:103],a[92:95],a[60:63],v[36:39]
R a[112:115],v2,12288
C v56,v18,v19
M v[100:103],a[88:91],a[56:59],v[100:103]
buffer_load_dwordx4 v3, s[8:11], s26 offen offset:1024 sc1 lds
M v[100:103],a[84:87],a[52:55],v[100:103]
R a[116:119],v2,13312
AF v26,v19,v26
M v[100:103],a[80:83],a[48:51],v[100:103]
E v21,v83
M v[100:103],a[76:79],a[44:47],v[100:103]
R a[120:123],v2,14336
AF v26,v20,v26
M v[100:103],a[72:75],a[40:43],v[100:103]
buffer_load_dwordx4 v3, s[8:11], s26 offen offset:2048 sc1 lds
M v[100:103],a[68:71],a[36:39],v[100:103]
R a[124:127],v2,15360
C v57,v20,v21
M v[100:103],a[64:67],a[32:35],v[100:103]
s_waitcnt lgkmcnt(4)
E v22,v88
M v[104:107],a[96:99],a[0:3],v[32:35]
R a[64:67],v2,16384
AF v26,v21,v26
M v[104:107],a[100:103],a[4:7],v[104:107]
E v23,v89
M v[104:107],a[104:107],a[8:11],v[104:107]
R a[68:71],v2,17408
AF v26,v22,v26
M v[104:107],a[108:111],a[12:15],v[104:107]
s_waitcnt lgkmcnt(2)
buffer_load_dwordx4 v3, s[8:11], s26 offen offset:3072 sc1 lds
M v[104:107],a[112:115],a[16:19],v[104:107]
R a[72:75],v2,18432
C v58,v22,v23
M v[104:107],a[116:119],a[20:23],v[104:107]
E v24,v90
M v[104:107],a[120:123],a[24:27],v[104:107]
R a[76:79],v2,19456
AF v26,v23,v26
M v[104:107],a[124:127],a[28:31],v[104:107]
SA m0,s28,36864
M v[108:111],a[124:127],a[60:63],v[36:39]
R a[80:83],v2,20480
M v[108:111],a[120:123],a[56:59],v[108:111]
buffer_load_dwordx4 v4, s[8:11], s26 offen offset:0 sc1 lds
M v[108:111],a[116:119],a[52:55],v[108:111]
R a[84:87],v2,21504
M v[108:111],a[112:115],a[48:51],v[108:111]
E v25,v91
M v[108:111],a[108:111],a[44:47],v[108:111]
R a[88:91],v2,22528
AF v26,v24,v26
M v[108:111],a[104:107],a[40:43],v[108:111]
buffer_load_dwordx4 v4, s[8:11], s26 offen offset:1024 sc1 lds
M v[108:111],a[100:103],a[36:39],v[108:111]
R a[92:95],v2,23552
C v59,v24,v25
M v[108:111],a[96:99],a[32:35],v[108:111]
s_waitcnt lgkmcnt(4)
E v18,v84
M v[112:115],a[64:67],a[0:3],v[32:35]
R a[96:99],v2,24576
AF v26,v25,v26
M v[112:115],a[68:71],a[4:7],v[112:115]
R a[100:103],v2,25600
M v[112:115],a[72:75],a[8:11],v[112:115]
buffer_load_dwordx4 v4, s[8:11], s26 offen offset:2048 sc1 lds
M v[112:115],a[76:79],a[12:15],v[112:115]
s_waitcnt lgkmcnt(2)
R a[104:107],v2,26624
M v[112:115],a[80:83],a[16:19],v[112:115]
R a[108:111],v2,27648
M v[112:115],a[84:87],a[20:23],v[112:115]
E v19,v85
M v[112:115],a[88:91],a[24:27],v[112:115]
R a[112:115],v2,28672
AF v27,v18,v27
M v[112:115],a[92:95],a[28:31],v[112:115]
R a[116:119],v2,29696
C v60,v18,v19
M v[116:119],a[92:95],a[60:63],v[36:39]
buffer_load_dwordx4 v4, s[8:11], s26 offen offset:3072 sc1 lds
M v[116:119],a[88:91],a[56:59],v[116:119]
SA s26,s26,32768
R a[120:123],v2,30720
AF v27,v19,v27
M v[116:119],a[84:87],a[52:55],v[116:119]
R a[124:127],v2,31744
M v[116:119],a[80:83],a[48:51],v[116:119]
E v20,v86
M v[116:119],a[76:79],a[44:47],v[116:119]
E v21,v87
M v[116:119],a[72:75],a[40:43],v[116:119]
E v22,v92
M v[116:119],a[68:71],a[36:39],v[116:119]
s_waitcnt vmcnt(16) lgkmcnt(0)
E v23,v93
M v[116:119],a[64:67],a[32:35],v[116:119]
s_barrier
M v[120:123],a[96:99],a[0:3],v[32:35]
R a[64:67],v7,0
AF v27,v20,v27
M v[120:123],a[100:103],a[4:7],v[120:123]
E v24,v94
M v[120:123],a[104:107],a[8:11],v[120:123]
R a[68:71],v7,1024
C v61,v20,v21
M v[120:123],a[108:111],a[12:15],v[120:123]
AF v27,v21,v27
AF v27,v22,v27
M v[120:123],a[112:115],a[16:19],v[120:123]
R a[72:75],v7,2048
C v62,v22,v23
M v[120:123],a[116:119],a[20:23],v[120:123]
E v25,v95
M v[120:123],a[120:123],a[24:27],v[120:123]
R a[76:79],v7,3072
AF v27,v23,v27
M v[120:123],a[124:127],a[28:31],v[120:123]
AF v27,v24,v27
C v63,v24,v25
M v[124:127],a[124:127],a[60:63],v[36:39]
R a[80:83],v7,4096
AF v27,v25,v27
M v[124:127],a[120:123],a[56:59],v[124:127]
M v[124:127],a[116:119],a[52:55],v[124:127]
R a[84:87],v7,5120
v_max_f32 v10, v26, v27
M v[124:127],a[112:115],a[48:51],v[124:127]
v_cmp_lt_f32 vcc, s31, v10
M v[124:127],a[108:111],a[44:47],v[124:127]
R a[88:91],v7,6144
M v[124:127],a[104:107],a[40:43],v[124:127]
M v[124:127],a[100:103],a[36:39],v[124:127]
s_waitcnt lgkmcnt(3)
R a[92:95],v7,7168
M v[124:127],a[96:99],a[32:35],v[124:127]
s_cbranch_vccnz L_st0
L_rt0:
M v[128:131],a[64:67],v[40:43],v[128:131]
SA m0,s28,65536
R a[96:99],v7,8192
AF v30,v26,v30
M v[128:131],a[68:71],v[56:59],v[128:131]
buffer_load_dwordx4 v3, s[8:11], s21 offen offset:0 sc1 lds
M v[132:135],a[68:71],v[60:63],v[132:135]
R a[100:103],v7,9216
AF v31,v27,v31
M v[132:135],a[64:67],v[44:47],v[132:135]
s_waitcnt lgkmcnt(2)
E v18,v96
M v[136:139],a[72:75],v[40:43],v[136:139]
R a[104:107],v7,10240
M v[136:139],a[76:79],v[56:59],v[136:139]
buffer_load_dwordx4 v3, s[8:11], s21 offen offset:1024 sc1 lds
M v[140:143],a[76:79],v[60:63],v[140:143]
R a[108:111],v7,11264
M v[140:143],a[72:75],v[44:47],v[140:143]
E v19,v97
M v[144:147],a[80:83],v[40:43],v[144:147]
R a[112:115],v7,12288
AF v28,v18,v19
M v[144:147],a[84:87],v[56:59],v[144:147]
E v20,v98
M v[148:151],a[84:87],v[60:63],v[148:151]
R a[116:119],v7,13312
C v48,v18,v19
M v[148:151],a[80:83],v[44:47],v[148:151]
buffer_load_dwordx4 v3, s[8:11], s21 offen offset:2048 sc1 lds
M v[152:155],a[88:91],v[40:43],v[152:155]
R a[120:123],v7,14336
M v[152:155],a[92:95],v[56:59],v[152:155]
E v21,v99
M v[156:159],a[92:95],v[60:63],v[156:159]
R a[124:127],v7,15360
AF v28,v20,v28
M v[156:159],a[88:91],v[44:47],v[156:159]
s_waitcnt lgkmcnt(4)
buffer_load_dwordx4 v3, s[8:11], s21 offen offset:3072 sc1 lds
M v[160:163],a[96:99],v[40:43],v[160:163]
R a[64:67],v7,16384
C v49,v20,v21
M v[160:163],a[100:103],v[56:59],v[160:163]
E v22,v104
M v[164:167],a[100:103],v[60:63],v[164:167]
SA m0,s28,69632
R a[68:71],v7,17408
AF v28,v21,v28
M v[164:167],a[96:99],v[44:47],v[164:167]
s_waitcnt lgkmcnt(2)
buffer_load_dwordx4 v4, s[8:11], s21 offen offset:0 sc1 lds
M v[168:171],a[104:107],v[40:43],v[168:171]
R a[72:75],v7,18432
M v[168:171],a[108:111],v[56:59],v[168:171]
E v23,v105
M v[172:175],a[108:111],v[60:63],v[172:175]
R a[76:79],v7,19456
AF v28,v22,v28
M v[172:175],a[104:107],v[44:47],v[172:175]
E v24,v106
M v[176:179],a[112:115],v[40:43],v[176:179]
R a[80:83],v7,20480
C v50,v22,v23
M v[176:179],a[116:119],v[56:59],v[176:179]
buffer_load_dwordx4 v4, s[8:11], s21 offen offset:1024 sc1 lds
M v[180:183],a[116:119],v[60:63],v[180:183]
R a[84:87],v7,21504
AF v28,v23,v28
M v[180:183],a[112:115],v[44:47],v[180:183]
E v25,v107
M v[184:187],a[120:123],v[40:43],v[184:187]
R a[88:91],v7,22528
AF v28,v24,v28
M v[184:187],a[124:127],v[56:59],v[184:187]
buffer_load_dwordx4 v4, s[8:11], s21 offen offset:2048 sc1 lds
M v[188:191],a[124:127],v[60:63],v[188:191]
R a[92:95],v7,23552
C v51,v24,v25
M v[188:191],a[120:123],v[44:47],v[188:191]
s_waitcnt lgkmcnt(4)
E v18,v100
M v[192:195],a[64:67],v[40:43],v[192:195]
R a[96:99],v7,24576
AF v28,v25,v28
M v[192:195],a[68:71],v[56:59],v[192:195]
R a[100:103],v7,25600
M v[196:199],a[68:71],v[60:63],v[196:199]
buffer_load_dwordx4 v4, s[8:11], s21 offen offset:3072 sc1 lds
M v[196:199],a[64:67],v[44:47],v[196:199]
s_waitcnt lgkmcnt(2)
R a[104:107],v7,26624
M v[200:203],a[72:75],v[40:43],v[200:203]
SA s21,s21,32768
R a[108:111],v7,27648
M v[200:203],a[76:79],v[56:59],v[200:203]
s_sub_u32 s22, s22, 1
E v19,v101
M v[204:207],a[76:79],v[60:63],v[204:207]
s_cselect_b32 s21, s23, s21
R a[112:115],v7,28672
AF v29,v18,v19
M v[204:207],a[72:75],v[44:47],v[204:207]
R a[116:119],v7,29696
C v52,v18,v19
M v[208:211],a[80:83],v[40:43],v[208:211]
E v20,v102
M v[208:211],a[84:87],v[56:59],v[208:211]
R a[120:123],v7,30720
M v[212:215],a[84:87],v[60:63],v[212:215]
R a[124:127],v7,31744
M v[212:215],a[80:83],v[44:47],v[212:215]
E v21,v103
M v[216:219],a[88:91],v[40:43],v[216:219]
E v22,v108
M v[216:219],a[92:95],v[56:59],v[216:219]
AF v29,v20,v29
C v53,v20,v21
M v[220:223],a[92:95],v[60:63],v[220:223]
s_waitcnt vmcnt(16) lgkmcnt(0)
AF v29,v21,v29
M v[220:223],a[88:91],v[44:47],v[220:223]
s_barrier
M v[224:227],a[96:99],v[40:43],v[224:227]
R a[64:67],v2,32768
M v[224:227],a[100:103],v[56:59],v[224:227]
E v23,v109
M v[228:231],a[100:103],v[60:63],v[228:231]
R a[68:71],v2,33792
v_cmp_gt_u32 vcc, s6, v5
M v[228:231],a[96:99],v[44:47],v[228:231]
E v24,v110
M v[232:235],a[104:107],v[40:43],v[232:235]
R a[72:75],v2,34816
AF v29,v22,v29
M v[232:235],a[108:111],v[56:59],v[232:235]
s_cbranch_vccnz L_fls0
L_flr0:
C v54,v22,v23
AF v29,v23,v29
M v[236:239],a[108:111],v[60:63],v[236:239]
s_mov_b32 s6, 0
R a[76:79],v2,35840
M v[236:239],a[104:107],v[44:47],v[236:239]
SA s7,s7,1
E v25,v111
M v[240:243],a[112:115],v[40:43],v[240:243]
R a[80:83],v2,36864
AF v29,v24,v29
M v[240:243],a[116:119],v[56:59],v[240:243]
C v55,v24,v25
AF v29,v25,v29
M v[244:247],a[116:119],v[60:63],v[244:247]
R a[84:87],v2,37888
M v[244:247],a[112:115],v[44:47],v[244:247]
M v[248:251],a[120:123],v[40:43],v[248:251]
s_sub_u32 s27, s27, 1
R a[88:91],v2,38912
M v[248:251],a[124:127],v[56:59],v[248:251]
s_cmp_lg_u32 s27, 0
M v[252:255],a[124:127],v[60:63],v[252:255]
s_waitcnt lgkmcnt(3)
R a[92:95],v2,39936
M v[252:255],a[120:123],v[44:47],v[252:255]
s_cbranch_scc1 L_loop_top
s_cmp_eq_u32 s40, 0
s_cbranch_scc1 L_final_h
L_d1s:
M v[68:71],a[64:67],a[32:35],v[36:39]
s_cmp_lt_u32 s20, 0
R a[96:99],v2,40960
R a[100:103],v2,41984
M v[68:71],a[68:71],a[36:39],v[68:71]
s_cselect_b64 s[82:83], -1, 0
E v18,v112
M v[68:71],a[72:75],a[40:43],v[68:71]
s_cmp_eq_u32 s20, 0
M v[68:71],a[76:79],a[44:47],v[68:71]
s_cselect_b64 s[66:67], s[16:17], s[82:83]
R a[104:107],v2,43008
R a[108:111],v2,44032
s_waitcnt lgkmcnt(7)
M v[68:71],a[80:83],a[48:51],v[68:71]
s_cselect_b64 s[68:69], s[18:19], s[82:83]
E v19,v113
s_waitcnt lgkmcnt(6)
M v[68:71],a[84:87],a[52:55],v[68:71]
s_cselect_b64 s[70:71], s[48:49], s[82:83]
AF v28,v18,v28
C v56,v18,v19
s_waitcnt lgkmcnt(5)
M v[68:71],a[88:91],a[56:59],v[68:71]
s_cselect_b64 s[72:73], s[50:51], s[82:83]
R a[112:115],v2,45056
R a[116:119],v2,46080
v_cndmask_b32 v64, v32, v8, s[66:67]
v_cndmask_b32 v65, v32, v8, s[68:69]
v_cndmask_b32 v66, v32, v8, s[70:71]
v_cndmask_b32 v67, v32, v8, s[72:73]
s_waitcnt lgkmcnt(6)
M v[68:71],a[92:95],a[60:63],v[68:71]
s_mov_b32 s26, s43
v_min_u32 v17, 896, v9
AF v28,v19,v28
M v[64:67],a[92:95],a[28:31],v[64:67]
s_cmp_lt_u32 s20, 1
buffer_load_dword v5, v17, s[8:11], s46 offen sc1
M v[64:67],a[88:91],a[24:27],v[64:67]
s_cselect_b64 s[82:83], -1, 0
R a[120:123],v2,47104
R a[124:127],v2,48128
M v[64:67],a[84:87],a[20:23],v[64:67]
SA m0,s28,0
E v20,v114
M v[64:67],a[80:83],a[16:19],v[64:67]
s_cmp_eq_u32 s20, 1
buffer_load_dwordx4 v3, s[8:11], s26 offen offset:0 sc1 lds
M v[64:67],a[76:79],a[12:15],v[64:67]
s_cselect_b64 s[74:75], s[16:17], s[82:83]
E v21,v115
M v[64:67],a[72:75],a[8:11],v[64:67]
s_cselect_b64 s[76:77], s[18:19], s[82:83]
AF v28,v20,v28
C v57,v20,v21
M v[64:67],a[68:71],a[4:7],v[64:67]
s_cselect_b64 s[78:79], s[48:49], s[82:83]
E v22,v120
M v[64:67],a[64:67],a[0:3],v[64:67]
s_waitcnt lgkmcnt(0)
buffer_load_dwordx4 v3, s[8:11], s26 offen offset:1024 sc1 lds
M v[76:79],a[96:99],a[32:35],v[36:39]
s_cselect_b64 s[80:81], s[50:51], s[82:83]
R a[64:67],v2,49152
R a[68:71],v2,50176
M v[76:79],a[100:103],a[36:39],v[76:79]
v_cndmask_b32 v72, v32, v8, s[74:75]
v_cndmask_b32 v73, v32, v8, s[76:77]
M v[76:79],a[104:107],a[40:43],v[76:79]
v_cndmask_b32 v74, v32, v8, s[78:79]
AF v28,v21,v28
M v[76:79],a[108:111],a[44:47],v[76:79]
R a[72:75],v2,51200
R a[76:79],v2,52224
M v[76:79],a[112:115],a[48:51],v[76:79]
buffer_load_dwordx4 v3, s[8:11], s26 offen offset:2048 sc1 lds
M v[76:79],a[116:119],a[52:55],v[76:79]
v_cndmask_b32 v75, v32, v8, s[80:81]
M v[76:79],a[120:123],a[56:59],v[76:79]
s_cmp_lt_u32 s20, 2
R a[80:83],v2,53248
R a[84:87],v2,54272
M v[76:79],a[124:127],a[60:63],v[76:79]
s_cselect_b64 s[82:83], -1, 0
E v23,v121
M v[72:75],a[124:127],a[28:31],v[72:75]
s_cmp_eq_u32 s20, 2
buffer_load_dwordx4 v3, s[8:11], s26 offen offset:3072 sc1 lds
M v[72:75],a[120:123],a[24:27],v[72:75]
s_cselect_b64 s[66:67], s[16:17], s[82:83]
R a[88:91],v2,55296
R a[92:95],v2,56320
M v[72:75],a[116:119],a[20:23],v[72:75]
s_cselect_b64 s[68:69], s[18:19], s[82:83]
E v24,v122
M v[72:75],a[112:115],a[16:19],v[72:75]
s_cselect_b64 s[70:71], s[48:49], s[82:83]
E v25,v123
M v[72:75],a[108:111],a[12:15],v[72:75]
s_cselect_b64 s[72:73], s[50:51], s[82:83]
v_cndmask_b32 v80, v32, v8, s[66:67]
v_cndmask_b32 v81, v32, v8, s[68:69]
M v[72:75],a[104:107],a[8:11],v[72:75]
SA m0,s28,4096
E v18,v116
M v[72:75],a[100:103],a[4:7],v[72:75]
s_lshl_b32 s86, s20, 14
buffer_load_dwordx4 v4, s[8:11], s26 offen offset:0 sc1 lds
M v[72:75],a[96:99],a[0:3],v[72:75]
s_waitcnt lgkmcnt(0)
v_cndmask_b32 v82, v32, v8, s[70:71]
AF v28,v22,v28
M v[84:87],a[64:67],a[32:35],v[36:39]
SA s86,s86,s34
R a[96:99],v2,57344
R a[100:103],v2,58368
M v[84:87],a[68:71],a[36:39],v[84:87]
SA s87,s86,4096
buffer_load_dwordx4 v4, s[8:11], s26 offen offset:1024 sc1 lds
M v[84:87],a[72:75],a[40:43],v[84:87]
SA s88,s86,8192
v_cndmask_b32 v83, v32, v8, s[72:73]
C v58,v22,v23
M v[84:87],a[76:79],a[44:47],v[84:87]
s_cmp_lt_u32 s20, 3
R a[104:107],v2,59392
R a[108:111],v2,60416
M v[84:87],a[80:83],a[48:51],v[84:87]
s_cselect_b64 s[82:83], -1, 0
E v19,v117
M v[84:87],a[84:87],a[52:55],v[84:87]
SA s89,s86,12288
buffer_load_dwordx4 v4, s[8:11], s26 offen offset:2048 sc1 lds
M v[84:87],a[88:91],a[56:59],v[84:87]
s_lshl_b32 s90, s20, 10
R a[112:115],v2,61440
R a[116:119],v2,62464
M v[84:87],a[92:95],a[60:63],v[84:87]
SA s90,s90,s34
E v20,v118
M v[80:83],a[92:95],a[28:31],v[80:83]
SA s90,s90,65536
E v21,v119
M v[80:83],a[88:91],a[24:27],v[80:83]
s_cmp_eq_u32 s20, 3
R a[120:123],v2,63488
R a[124:127],v2,64512
M v[80:83],a[84:87],a[20:23],v[80:83]
s_cselect_b64 s[74:75], s[16:17], s[82:83]
buffer_load_dwordx4 v4, s[8:11], s26 offen offset:3072 sc1 lds
M v[80:83],a[80:83],a[16:19],v[80:83]
s_cselect_b64 s[76:77], s[18:19], s[82:83]
AF v28,v23,v28
AF v28,v24,v28
M v[80:83],a[76:79],a[12:15],v[80:83]
s_cselect_b64 s[78:79], s[48:49], s[82:83]
E v22,v124
M v[80:83],a[72:75],a[8:11],v[80:83]
s_cselect_b64 s[80:81], s[50:51], s[82:83]
v_cndmask_b32 v88, v32, v8, s[74:75]
v_cndmask_b32 v89, v32, v8, s[76:77]
M v[80:83],a[68:71],a[4:7],v[80:83]
s_waitcnt vmcnt(17) lgkmcnt(0)
v_cndmask_b32 v90, v32, v8, s[78:79]
v_cndmask_b32 v91, v32, v8, s[80:81]
M v[80:83],a[64:67],a[0:3],v[80:83]
s_barrier
M v[92:95],a[96:99],a[32:35],v[36:39]
SA s26,s26,32768
R a[64:67],v7,32768
R a[68:71],v7,33792
M v[92:95],a[100:103],a[36:39],v[92:95]
SA m0,s28,131072
E v23,v125
M v[92:95],a[104:107],a[40:43],v[92:95]
buffer_load_dwordx4 v3, s[8:11], s26 offen offset:0 sc1 lds
M v[92:95],a[108:111],a[44:47],v[92:95]
R a[72:75],v7,34816
R a[76:79],v7,35840
M v[92:95],a[112:115],a[48:51],v[92:95]
C v59,v24,v25
AF v28,v25,v28
M v[92:95],a[116:119],a[52:55],v[92:95]
buffer_load_dwordx4 v3, s[8:11], s26 offen offset:1024 sc1 lds
M v[92:95],a[120:123],a[56:59],v[92:95]
R a[80:83],v7,36864
R a[84:87],v7,37888
M v[92:95],a[124:127],a[60:63],v[92:95]
E v24,v126
M v[88:91],a[124:127],a[28:31],v[88:91]
buffer_load_dwordx4 v3, s[8:11], s26 offen offset:2048 sc1 lds
M v[88:91],a[120:123],a[24:27],v[88:91]
R a[88:91],v7,38912
R a[92:95],v7,39936
M v[88:91],a[116:119],a[20:23],v[88:91]
E v25,v127
M v[88:91],a[112:115],a[16:19],v[88:91]
buffer_load_dwordx4 v3, s[8:11], s26 offen offset:3072 sc1 lds
M v[88:91],a[108:111],a[12:15],v[88:91]
AF v29,v18,v29
C v60,v18,v19
M v[88:91],a[104:107],a[8:11],v[88:91]
AF v29,v19,v29
AF v29,v20,v29
M v[88:91],a[100:103],a[4:7],v[88:91]
s_waitcnt lgkmcnt(0)
C v61,v20,v21
AF v29,v21,v29
M v[88:91],a[96:99],a[0:3],v[88:91]
AF v29,v22,v29
C v62,v22,v23
AF v29,v23,v29
AF v29,v24,v29
C v63,v24,v25
AF v29,v25,v29
v_max_f32 v10, v28, v29
v_cmp_lt_f32 vcc, s31, v10
s_nop 0
s_cbranch_vccnz L_std1
L_rtd1:
s_cmp_lt_u32 s42, 6
s_cbranch_scc1 L_d2h
M v[128:131],a[64:67],v[48:51],v[128:131]
R a[96:99],v7,40960
R a[100:103],v7,41984
M v[128:131],a[68:71],v[56:59],v[128:131]
SA m0,s28,135168
E v18,v64
M v[132:135],a[68:71],v[60:63],v[132:135]
buffer_load_dwordx4 v4, s[8:11], s26 offen offset:0 sc1 lds
M v[132:135],a[64:67],v[52:55],v[132:135]
R a[104:107],v7,43008
R a[108:111],v7,44032
M v[136:139],a[72:75],v[48:51],v[136:139]
s_cmp_gt_u32 s20, 3
E v19,v65
M v[136:139],a[76:79],v[56:59],v[136:139]
s_cselect_b64 s[82:83], -1, 0
AF v30,v28,v30
AF v31,v29,v31
M v[140:143],a[76:79],v[60:63],v[140:143]
s_cmp_eq_u32 s20, 3
R a[112:115],v7,45056
R a[116:119],v7,46080
M v[140:143],a[72:75],v[52:55],v[140:143]
s_cselect_b64 s[66:67], s[16:17], s[82:83]
buffer_load_dwordx4 v4, s[8:11], s26 offen offset:1024 sc1 lds
M v[144:147],a[80:83],v[48:51],v[144:147]
s_cselect_b64 s[68:69], s[18:19], s[82:83]
E v20,v66
M v[144:147],a[84:87],v[56:59],v[144:147]
s_cselect_b64 s[70:71], s[48:49], s[82:83]
R a[120:123],v7,47104
R a[124:127],v7,48128
M v[148:151],a[84:87],v[60:63],v[148:151]
s_cselect_b64 s[72:73], s[50:51], s[82:83]
v_cndmask_b32 v100, v36, v8, s[66:67]
v_cndmask_b32 v101, v36, v8, s[68:69]
M v[148:151],a[80:83],v[52:55],v[148:151]
buffer_load_dwordx4 v4, s[8:11], s26 offen offset:2048 sc1 lds
M v[152:155],a[88:91],v[48:51],v[152:155]
v_cndmask_b32 v102, v36, v8, s[70:71]
AF v26,v18,v19
M v[152:155],a[92:95],v[56:59],v[152:155]
E v21,v67
M v[156:159],a[92:95],v[60:63],v[156:159]
v_cndmask_b32 v103, v36, v8, s[72:73]
C v40,v18,v19
M v[156:159],a[88:91],v[52:55],v[156:159]
s_waitcnt lgkmcnt(0)
buffer_load_dwordx4 v4, s[8:11], s26 offen offset:3072 sc1 lds
M v[160:163],a[96:99],v[48:51],v[160:163]
s_cmp_gt_u32 s20, 2
R a[64:67],v7,49152
R a[68:71],v7,50176
M v[160:163],a[100:103],v[56:59],v[160:163]
s_cselect_b64 s[82:83], -1, 0
v_lshrrev_b32 v14, 7, v7
AF v26,v20,v26
M v[164:167],a[100:103],v[60:63],v[164:167]
s_cmp_eq_u32 s20, 2
v_mul_u32_u24 v14, 896, v14
C v41,v20,v21
M v[164:167],a[96:99],v[52:55],v[164:167]
s_cselect_b64 s[74:75], s[16:17], s[82:83]
R a[72:75],v7,51200
R a[76:79],v7,52224
M v[168:171],a[104:107],v[48:51],v[168:171]
s_cselect_b64 s[76:77], s[18:19], s[82:83]
v_lshrrev_b32 v15, 8, v7
AF v26,v21,v26
M v[168:171],a[108:111],v[56:59],v[168:171]
s_cselect_b64 s[78:79], s[48:49], s[82:83]
v_lshlrev_b32 v15, 5, v15
M v[172:175],a[108:111],v[60:63],v[172:175]
s_cselect_b64 s[80:81], s[50:51], s[82:83]
R a[80:83],v7,53248
R a[84:87],v7,54272
M v[172:175],a[104:107],v[52:55],v[172:175]
v_cndmask_b32 v108, v36, v8, s[74:75]
v_cndmask_b32 v109, v36, v8, s[76:77]
M v[176:179],a[112:115],v[48:51],v[176:179]
v_xor_b32 v15, v15, v7
M v[176:179],a[116:119],v[56:59],v[176:179]
R a[88:91],v7,55296
R a[92:95],v7,56320
M v[180:183],a[116:119],v[60:63],v[180:183]
v_and_b32 v15, 0x70, v15
v_cndmask_b32 v110, v36, v8, s[78:79]
M v[180:183],a[112:115],v[52:55],v[180:183]
v_add_u32 v0, v14, v15
M v[184:187],a[120:123],v[48:51],v[184:187]
s_mul_i32 s38, s20, 57344
v_cndmask_b32 v111, v36, v8, s[80:81]
M v[184:187],a[124:127],v[56:59],v[184:187]
s_cmp_gt_u32 s20, 1
E v22,v72
M v[188:191],a[124:127],v[60:63],v[188:191]
s_cselect_b64 s[82:83], -1, 0
E v23,v73
M v[188:191],a[120:123],v[52:55],v[188:191]
s_waitcnt lgkmcnt(0)
E v24,v74
M v[192:195],a[64:67],v[48:51],v[192:195]
SA m0,s28,98304
R a[96:99],v7,57344
R a[100:103],v7,58368
M v[192:195],a[68:71],v[56:59],v[192:195]
s_cmp_eq_u32 s20, 1
E v25,v75
M v[196:199],a[68:71],v[60:63],v[196:199]
s_cselect_b64 s[66:67], s[16:17], s[82:83]
E v18,v68
M v[196:199],a[64:67],v[52:55],v[196:199]
s_cselect_b64 s[68:69], s[18:19], s[82:83]
R a[104:107],v7,59392
R a[108:111],v7,60416
M v[200:203],a[72:75],v[48:51],v[200:203]
s_cselect_b64 s[70:71], s[48:49], s[82:83]
E v19,v69
M v[200:203],a[76:79],v[56:59],v[200:203]
s_cselect_b64 s[72:73], s[50:51], s[82:83]
v_cndmask_b32 v116, v36, v8, s[66:67]
v_cndmask_b32 v117, v36, v8, s[68:69]
M v[204:207],a[76:79],v[60:63],v[204:207]
SA s85,s38,0
R a[112:115],v7,61440
R a[116:119],v7,62464
M v[204:207],a[72:75],v[52:55],v[204:207]
buffer_load_dwordx4 v0, s[12:15], s85 offen offset:0 lds
M v[208:211],a[80:83],v[48:51],v[208:211]
SA s85,s38,6144
v_cndmask_b32 v118, v36, v8, s[70:71]
AF v26,v22,v26
M v[208:211],a[84:87],v[56:59],v[208:211]
R a[120:123],v7,63488
R a[124:127],v7,64512
M v[212:215],a[84:87],v[60:63],v[212:215]
buffer_load_dwordx4 v0, s[12:15], s85 offen offset:1024 lds
M v[212:215],a[80:83],v[52:55],v[212:215]
SA s85,s38,12288
v_cndmask_b32 v119, v36, v8, s[72:73]
C v42,v22,v23
M v[216:219],a[88:91],v[48:51],v[216:219]
s_cmp_gt_u32 s20, 0
E v20,v70
M v[216:219],a[92:95],v[56:59],v[216:219]
s_cselect_b64 s[82:83], -1, 0
buffer_load_dwordx4 v0, s[12:15], s85 offen offset:2048 lds
M v[220:223],a[92:95],v[60:63],v[220:223]
s_waitcnt vmcnt(20) lgkmcnt(0)
E v21,v71
M v[220:223],a[88:91],v[52:55],v[220:223]
s_barrier
M v[224:227],a[96:99],v[48:51],v[224:227]
SA s85,s38,18432
R a[64:67],v2,0
R a[68:71],v2,1024
M v[224:227],a[100:103],v[56:59],v[224:227]
s_cmp_eq_u32 s20, 0
buffer_load_dwordx4 v0, s[12:15], s85 offen offset:3072 lds
M v[228:231],a[100:103],v[60:63],v[228:231]
s_cselect_b64 s[74:75], s[16:17], s[82:83]
AF v26,v23,v26
AF v26,v24,v26
M v[228:231],a[96:99],v[52:55],v[228:231]
s_cselect_b64 s[76:77], s[18:19], s[82:83]
R a[72:75],v2,2048
R a[76:79],v2,3072
M v[232:235],a[104:107],v[48:51],v[232:235]
s_cselect_b64 s[78:79], s[48:49], s[82:83]
E v22,v76
M v[232:235],a[108:111],v[56:59],v[232:235]
s_cselect_b64 s[80:81], s[50:51], s[82:83]
v_cndmask_b32 v124, v36, v8, s[74:75]
v_cndmask_b32 v125, v36, v8, s[76:77]
M v[236:239],a[108:111],v[60:63],v[236:239]
SA m0,s28,102400
R a[80:83],v2,4096
R a[84:87],v2,5120
M v[236:239],a[104:107],v[52:55],v[236:239]
SA s85,s38,28672
buffer_load_dwordx4 v0, s[12:15], s85 offen offset:0 lds
M v[240:243],a[112:115],v[48:51],v[240:243]
SA s85,s38,34816
v_cndmask_b32 v126, v36, v8, s[78:79]
v_cndmask_b32 v127, v36, v8, s[80:81]
M v[240:243],a[116:119],v[56:59],v[240:243]
R a[88:91],v2,6144
R a[92:95],v2,7168
M v[244:247],a[116:119],v[60:63],v[244:247]
buffer_load_dwordx4 v0, s[12:15], s85 offen offset:1024 lds
M v[244:247],a[112:115],v[52:55],v[244:247]
SA s85,s38,40960
E v23,v77
M v[248:251],a[120:123],v[48:51],v[248:251]
buffer_load_dwordx4 v0, s[12:15], s85 offen offset:2048 lds
M v[248:251],a[124:127],v[56:59],v[248:251]
SA s85,s38,47104
C v43,v24,v25
AF v26,v25,v26
M v[252:255],a[124:127],v[60:63],v[252:255]
s_waitcnt lgkmcnt(0)
E v24,v78
M v[252:255],a[120:123],v[52:55],v[252:255]
buffer_load_dwordx4 v0, s[12:15], s85 offen offset:3072 lds
SA s38,s38,128
AF v27,v18,v19
C v44,v18,v19
AF v27,v20,v27
C v45,v20,v21
AF v27,v21,v27
E v25,v79
AF v27,v22,v27
C v46,v22,v23
AF v27,v23,v27
AF v27,v24,v27
C v47,v24,v25
AF v27,v25,v27
M v[100:103],a[64:67],a[32:35],v[100:103]
R a[96:99],v2,8192
R a[100:103],v2,9216
M v[100:103],a[68:71],a[36:39],v[100:103]
R a[104:107],v2,10240
R a[108:111],v2,11264
M v[100:103],a[72:75],a[40:43],v[100:103]
R a[112:115],v2,12288
R a[116:119],v2,13312
M v[100:103],a[76:79],a[44:47],v[100:103]
R a[120:123],v2,14336
R a[124:127],v2,15360
M v[100:103],a[80:83],a[48:51],v[100:103]
v_add_u32 v8, 0x20000, v7
M v[100:103],a[84:87],a[52:55],v[100:103]
SA m0,s28,32768
E v18,v80
M v[100:103],a[88:91],a[56:59],v[100:103]
SA s85,s38,0
buffer_load_dwordx4 v0, s[12:15], s85 offen offset:0 lds
M v[100:103],a[92:95],a[60:63],v[100:103]
s_waitcnt lgkmcnt(0)
E v19,v81
M v[108:111],a[96:99],a[32:35],v[108:111]
SA s85,s38,6144
R a[64:67],v2,16384
R a[68:71],v2,17408
M v[108:111],a[100:103],a[36:39],v[108:111]
R a[72:75],v2,18432
R a[76:79],v2,19456
M v[108:111],a[104:107],a[40:43],v[108:111]
R a[80:83],v2,20480
R a[84:87],v2,21504
M v[108:111],a[108:111],a[44:47],v[108:111]
R a[88:91],v2,22528
R a[92:95],v2,23552
M v[108:111],a[112:115],a[48:51],v[108:111]
buffer_load_dwordx4 v0, s[12:15], s85 offen offset:1024 lds
M v[108:111],a[116:119],a[52:55],v[108:111]
SA s85,s38,12288
E v20,v82
M v[108:111],a[120:123],a[56:59],v[108:111]
buffer_load_dwordx4 v0, s[12:15], s85 offen offset:2048 lds
M v[108:111],a[124:127],a[60:63],v[108:111]
s_waitcnt lgkmcnt(0)
E v21,v83
M v[116:119],a[64:67],a[32:35],v[116:119]
SA s85,s38,18432
R a[96:99],v2,24576
R a[100:103],v2,25600
M v[116:119],a[68:71],a[36:39],v[116:119]
R a[104:107],v2,26624
R a[108:111],v2,27648
M v[116:119],a[72:75],a[40:43],v[116:119]
R a[112:115],v2,28672
R a[116:119],v2,29696
M v[116:119],a[76:79],a[44:47],v[116:119]
R a[120:123],v2,30720
R a[124:127],v2,31744
M v[116:119],a[80:83],a[48:51],v[116:119]
buffer_load_dwordx4 v0, s[12:15], s85 offen offset:3072 lds
M v[116:119],a[84:87],a[52:55],v[116:119]
buffer_load_dword v6, off, s[8:11], s47 sc1
M v[116:119],a[88:91],a[56:59],v[116:119]
s_waitcnt vmcnt(21) lgkmcnt(0)
E v22,v88
M v[116:119],a[92:95],a[60:63],v[116:119]
s_barrier
M v[124:127],a[96:99],a[32:35],v[124:127]
R a[64:67],v7,0
R a[68:71],v7,1024
M v[124:127],a[100:103],a[36:39],v[124:127]
R a[72:75],v7,2048
R a[76:79],v7,3072
M v[124:127],a[104:107],a[40:43],v[124:127]
R a[80:83],v7,4096
R a[84:87],v7,5120
M v[124:127],a[108:111],a[44:47],v[124:127]
R a[88:91],v7,6144
R a[92:95],v7,7168
M v[124:127],a[112:115],a[48:51],v[124:127]
E v23,v89
M v[124:127],a[116:119],a[52:55],v[124:127]
E v24,v90
M v[124:127],a[120:123],a[56:59],v[124:127]
s_waitcnt lgkmcnt(0)
E v25,v91
M v[124:127],a[124:127],a[60:63],v[124:127]
AF v26,v18,v26
C v56,v18,v19
AF v26,v19,v26
AF v26,v20,v26
C v57,v20,v21
AF v26,v21,v26
AF v26,v22,v26
C v58,v22,v23
AF v26,v23,v26
E v18,v84
E v19,v85
AF v26,v24,v26
C v59,v24,v25
AF v26,v25,v26
E v20,v86
E v21,v87
AF v27,v18,v27
C v60,v18,v19
AF v27,v19,v27
E v22,v92
E v23,v93
AF v27,v20,v27
C v61,v20,v21
AF v27,v21,v27
E v24,v94
E v25,v95
AF v27,v22,v27
C v62,v22,v23
AF v27,v23,v27
AF v27,v24,v27
C v63,v24,v25
AF v27,v25,v27
v_max_f32 v10, v26, v27
v_cmp_lt_f32 vcc, s31, v10
s_nop 0
s_cbranch_vccnz L_std3n
L_rtd3n:
M v[128:131],a[64:67],v[40:43],v[128:131]
R a[96:99],v7,8192
R a[100:103],v7,9216
M v[128:131],a[68:71],v[56:59],v[128:131]
v_or_b32 v9, s35, v7
s_waitcnt vmcnt(0)
v_cmp_ne_u32 vcc, 1, v6
M v[132:135],a[68:71],v[60:63],v[132:135]
s_cbranch_vccnz L_fps
L_fpr:
E v18,v100
M v[132:135],a[64:67],v[44:47],v[132:135]
R a[104:107],v7,10240
R a[108:111],v7,11264
M v[136:139],a[72:75],v[40:43],v[136:139]
buffer_load_dwordx4 v[14:17], v9, s[8:11], s90 offen sc1
M v[136:139],a[76:79],v[56:59],v[136:139]
E v19,v101
M v[140:143],a[76:79],v[60:63],v[140:143]
R a[112:115],v7,12288
R a[116:119],v7,13312
M v[140:143],a[72:75],v[44:47],v[140:143]
buffer_load_dwordx4 a[160:163], v9, s[8:11], s88 offen offset:0 sc1
M v[144:147],a[80:83],v[40:43],v[144:147]
E v20,v102
M v[144:147],a[84:87],v[56:59],v[144:147]
R a[120:123],v7,14336
R a[124:127],v7,15360
M v[148:151],a[84:87],v[60:63],v[148:151]
buffer_load_dwordx4 a[128:131], v9, s[8:11], s86 offen offset:0 sc1
M v[148:151],a[80:83],v[44:47],v[148:151]
E v21,v103
M v[152:155],a[88:91],v[40:43],v[152:155]
AF v30,v26,v30
AF v31,v27,v31
M v[152:155],a[92:95],v[56:59],v[152:155]
buffer_load_dwordx4 a[164:167], v9, s[8:11], s88 offen offset:1024 sc1
M v[156:159],a[92:95],v[60:63],v[156:159]
AF v29,v18,v19
C v52,v18,v19
M v[156:159],a[88:91],v[44:47],v[156:159]
s_waitcnt lgkmcnt(0)
E v22,v108
M v[160:163],a[96:99],v[40:43],v[160:163]
R a[64:67],v7,16384
R a[68:71],v7,17408
M v[160:163],a[100:103],v[56:59],v[160:163]
buffer_load_dwordx4 a[132:135], v9, s[8:11], s86 offen offset:1024 sc1
M v[164:167],a[100:103],v[60:63],v[164:167]
E v23,v109
M v[164:167],a[96:99],v[44:47],v[164:167]
R a[72:75],v7,18432
R a[76:79],v7,19456
M v[168:171],a[104:107],v[40:43],v[168:171]
buffer_load_dwordx4 a[168:171], v9, s[8:11], s88 offen offset:2048 sc1
M v[168:171],a[108:111],v[56:59],v[168:171]
AF v29,v20,v29
C v53,v20,v21
M v[172:175],a[108:111],v[60:63],v[172:175]
R a[80:83],v7,20480
R a[84:87],v7,21504
M v[172:175],a[104:107],v[44:47],v[172:175]
buffer_load_dwordx4 a[136:139], v9, s[8:11], s86 offen offset:2048 sc1
M v[176:179],a[112:115],v[40:43],v[176:179]
E v24,v110
M v[176:179],a[116:119],v[56:59],v[176:179]
R a[88:91],v7,22528
R a[92:95],v7,23552
M v[180:183],a[116:119],v[60:63],v[180:183]
buffer_load_dwordx4 a[172:175], v9, s[8:11], s88 offen offset:3072 sc1
M v[180:183],a[112:115],v[44:47],v[180:183]
E v25,v111
M v[184:187],a[120:123],v[40:43],v[184:187]
AF v29,v21,v29
AF v29,v22,v29
M v[184:187],a[124:127],v[56:59],v[184:187]
buffer_load_dwordx4 a[140:143], v9, s[8:11], s86 offen offset:3072 sc1
M v[188:191],a[124:127],v[60:63],v[188:191]
E v18,v116
M v[188:191],a[120:123],v[44:47],v[188:191]
s_waitcnt lgkmcnt(0)
C v54,v22,v23
AF v29,v23,v29
M v[192:195],a[64:67],v[40:43],v[192:195]
R a[96:99],v7,24576
R a[100:103],v7,25600
M v[192:195],a[68:71],v[56:59],v[192:195]
buffer_load_dwordx4 a[176:179], v9, s[8:11], s89 offen offset:0 sc1
M v[196:199],a[68:71],v[60:63],v[196:199]
E v19,v117
M v[196:199],a[64:67],v[44:47],v[196:199]
R a[104:107],v7,26624
R a[108:111],v7,27648
M v[200:203],a[72:75],v[40:43],v[200:203]
buffer_load_dwordx4 a[144:147], v9, s[8:11], s87 offen offset:0 sc1
M v[200:203],a[76:79],v[56:59],v[200:203]
E v20,v118
M v[204:207],a[76:79],v[60:63],v[204:207]
R a[112:115],v7,28672
R a[116:119],v7,29696
M v[204:207],a[72:75],v[44:47],v[204:207]
buffer_load_dwordx4 a[180:183], v9, s[8:11], s89 offen offset:1024 sc1
M v[208:211],a[80:83],v[40:43],v[208:211]
AF v29,v24,v29
C v55,v24,v25
M v[208:211],a[84:87],v[56:59],v[208:211]
R a[120:123],v7,30720
R a[124:127],v7,31744
M v[212:215],a[84:87],v[60:63],v[212:215]
buffer_load_dwordx4 a[148:151], v9, s[8:11], s87 offen offset:1024 sc1
M v[212:215],a[80:83],v[44:47],v[212:215]
E v21,v119
M v[216:219],a[88:91],v[40:43],v[216:219]
AF v29,v25,v29
AF v29,v18,v29
M v[216:219],a[92:95],v[56:59],v[216:219]
buffer_load_dwordx4 a[184:187], v9, s[8:11], s89 offen offset:2048 sc1
M v[220:223],a[92:95],v[60:63],v[220:223]
s_waitcnt lgkmcnt(0)
E v22,v124
M v[220:223],a[88:91],v[44:47],v[220:223]
s_barrier
M v[224:227],a[96:99],v[40:43],v[224:227]
R a[64:67],v8,0
R a[68:71],v8,1024
M v[224:227],a[100:103],v[56:59],v[224:227]
buffer_load_dwordx4 a[152:155], v9, s[8:11], s87 offen offset:2048 sc1
M v[228:231],a[100:103],v[60:63],v[228:231]
E v23,v125
M v[228:231],a[96:99],v[44:47],v[228:231]
R a[72:75],v8,2048
R a[76:79],v8,3072
M v[232:235],a[104:107],v[40:43],v[232:235]
buffer_load_dwordx4 a[188:191], v9, s[8:11], s89 offen offset:3072 sc1
M v[232:235],a[108:111],v[56:59],v[232:235]
E v24,v126
M v[236:239],a[108:111],v[60:63],v[236:239]
R a[80:83],v8,4096
R a[84:87],v8,5120
M v[236:239],a[104:107],v[44:47],v[236:239]
buffer_load_dwordx4 a[156:159], v9, s[8:11], s87 offen offset:3072 sc1
M v[240:243],a[112:115],v[40:43],v[240:243]
E v25,v127
M v[240:243],a[116:119],v[56:59],v[240:243]
R a[88:91],v8,6144
R a[92:95],v8,7168
M v[244:247],a[116:119],v[60:63],v[244:247]
C v48,v18,v19
AF v29,v19,v29
M v[244:247],a[112:115],v[44:47],v[244:247]
AF v29,v20,v29
C v49,v20,v21
M v[248:251],a[120:123],v[40:43],v[248:251]
AF v29,v21,v29
AF v29,v22,v29
M v[248:251],a[124:127],v[56:59],v[248:251]
C v50,v22,v23
AF v29,v23,v29
M v[252:255],a[124:127],v[60:63],v[252:255]
s_waitcnt lgkmcnt(0)
AF v29,v24,v29
C v51,v24,v25
M v[252:255],a[120:123],v[44:47],v[252:255]
AF v29,v25,v29
v_cmp_lt_f32 vcc, s31, v29
s_nop 0
s_cbranch_vccnz L_std4n
L_rtd4n:
s_waitcnt vmcnt(16)
v_cmp_neq_f32 vcc, v32, v14
v_cmp_neq_f32 s[64:65], v36, v15
s_cmp_eq_u32 s35, 0
s_cselect_b64 s[66:67], -1, 0
s_or_b64 vcc, vcc, s[64:65]
s_and_b64 vcc, vcc, s[66:67]
s_cbranch_vccnz L_stc
L_rtc:
M v[132:135],a[64:67],v[52:55],v[132:135]
R a[96:99],v8,8192
R a[100:103],v8,9216
M v[132:135],a[68:71],v[48:51],v[132:135]
s_waitcnt vmcnt(12)
AF v30,v16,v30
AF v31,v17,v31
M v[132:135],a[246:249],a[160:163],v[132:135]
SA m0,s28,36864
AF v31,v29,v31
v_mov_b32 v10, v30
M v[128:131],a[246:249],a[128:131],v[128:131]
SA s85,s38,28672
R a[104:107],v8,10240
R a[108:111],v8,11264
M v[140:143],a[72:75],v[52:55],v[140:143]
buffer_load_dwordx4 v0, s[12:15], s85 offen offset:0 lds
M v[140:143],a[76:79],v[48:51],v[140:143]
SA s85,s38,34816
v_mov_b32 v11, v31
v_permlane16_swap_b32 v10, v30
M v[140:143],a[244:247],a[160:163],v[140:143]
R a[112:115],v8,12288
R a[116:119],v8,13312
M v[136:139],a[244:247],a[128:131],v[136:139]
v_permlane16_swap_b32 v11, v31
AF v30,v10,v30
M v[148:151],a[80:83],v[52:55],v[148:151]
buffer_load_dwordx4 v0, s[12:15], s85 offen offset:1024 lds
M v[148:151],a[84:87],v[48:51],v[148:151]
SA s85,s38,40960
R a[120:123],v8,14336
R a[124:127],v8,15360
M v[148:151],a[246:249],a[164:167],v[148:151]
AF v31,v11,v31
v_mov_b32 v10, v30
M v[144:147],a[246:249],a[132:135],v[144:147]
v_mov_b32 v11, v31
v_permlane32_swap_b32 v10, v30
M v[156:159],a[88:91],v[52:55],v[156:159]
buffer_load_dwordx4 v0, s[12:15], s85 offen offset:2048 lds
M v[156:159],a[92:95],v[48:51],v[156:159]
SA s85,s38,47104
C v132,v132,v133
C v133,v134,v135
M v[156:159],a[244:247],a[164:167],v[156:159]
s_waitcnt vmcnt(11)
C v134,v140,v141
C v135,v142,v143
M v[152:155],a[244:247],a[132:135],v[152:155]
s_waitcnt lgkmcnt(0)
buffer_load_dwordx4 v0, s[12:15], s85 offen offset:3072 lds
M v[164:167],a[96:99],v[52:55],v[164:167]
SA s38,s38,128
R a[64:67],v8,16384
R a[68:71],v8,17408
M v[164:167],a[100:103],v[48:51],v[164:167]
SA m0,s28,65536
v_permlane32_swap_b32 v11, v31
C v128,v128,v129
M v[164:167],a[246:249],a[168:171],v[164:167]
SA s85,s38,0
buffer_load_dwordx4 v0, s[12:15], s85 offen offset:0 lds
M v[160:163],a[246:249],a[136:139],v[160:163]
SA s85,s38,6144
R a[72:75],v8,18432
R a[76:79],v8,19456
AF v30,v10,v30
AF v31,v11,v31
v_rcp_f32 v5, v30
v_rcp_f32 v6, v31
M v[172:175],a[104:107],v[52:55],v[172:175]
C v129,v130,v131
C v130,v136,v137
M v[172:175],a[108:111],v[48:51],v[172:175]
buffer_load_dwordx4 v0, s[12:15], s85 offen offset:1024 lds
M v[172:175],a[244:247],a[168:171],v[172:175]
SA s85,s38,12288
R a[80:83],v8,20480
R a[84:87],v8,21504
M v[168:171],a[244:247],a[136:139],v[168:171]
C v131,v138,v139
C v148,v148,v149
M v[180:183],a[112:115],v[52:55],v[180:183]
C v149,v150,v151
C v150,v156,v157
M v[180:183],a[116:119],v[48:51],v[180:183]
R a[88:91],v8,22528
R a[92:95],v8,23552
M v[180:183],a[246:249],a[172:175],v[180:183]
buffer_load_dwordx4 v0, s[12:15], s85 offen offset:2048 lds
M v[176:179],a[246:249],a[140:143],v[176:179]
SA s85,s38,18432
C v151,v158,v159
C v144,v144,v145
M v[188:191],a[120:123],v[52:55],v[188:191]
C v145,v146,v147
C v146,v152,v153
M v[188:191],a[124:127],v[48:51],v[188:191]
buffer_load_dwordx4 v0, s[12:15], s85 offen offset:3072 lds
M v[188:191],a[244:247],a[172:175],v[188:191]
s_waitcnt vmcnt(12)
C v147,v154,v155
v_lshrrev_b32 v16, 4, v7
M v[184:187],a[244:247],a[140:143],v[184:187]
s_waitcnt lgkmcnt(0)
v_lshrrev_b32 v14, 2, v16
v_lshlrev_b32 v14, 7, v14
M v[196:199],a[64:67],v[52:55],v[196:199]
SA m0,s28,69632
R a[96:99],v8,24576
R a[100:103],v8,25600
M v[196:199],a[68:71],v[48:51],v[196:199]
SA s85,s38,28672
buffer_load_dwordx4 v0, s[12:15], s85 offen offset:0 lds
M v[196:199],a[246:249],a[176:179],v[196:199]
SA s85,s38,34816
v_and_b32 v15, 3, v16
v_lshl_add_u32 v14, v15, 3, v14
M v[192:195],a[246:249],a[144:147],v[192:195]
R a[104:107],v8,26624
R a[108:111],v8,27648
M v[204:207],a[72:75],v[52:55],v[204:207]
buffer_load_dwordx4 v0, s[12:15], s85 offen offset:1024 lds
M v[204:207],a[76:79],v[48:51],v[204:207]
SA s85,s38,40960
C v164,v164,v165
C v165,v166,v167
M v[204:207],a[244:247],a[176:179],v[204:207]
R a[112:115],v8,28672
R a[116:119],v8,29696
M v[200:203],a[244:247],a[144:147],v[200:203]
buffer_load_dwordx4 v0, s[12:15], s85 offen offset:2048 lds
M v[212:215],a[80:83],v[52:55],v[212:215]
SA s85,s38,47104
C v166,v172,v173
C v167,v174,v175
M v[212:215],a[84:87],v[48:51],v[212:215]
R a[120:123],v8,30720
R a[124:127],v8,31744
M v[212:215],a[246:249],a[180:183],v[212:215]
buffer_load_dwordx4 v0, s[12:15], s85 offen offset:3072 lds
M v[208:211],a[246:249],a[148:151],v[208:211]
SA s38,s38,128
C v160,v160,v161
C v161,v162,v163
M v[220:223],a[88:91],v[52:55],v[220:223]
C v162,v168,v169
C v163,v170,v171
M v[220:223],a[92:95],v[48:51],v[220:223]
s_waitcnt vmcnt(12)
v_bfe_u32 v15, v16, 3, 2
v_lshl_add_u32 v18, v15, 5, v14
M v[220:223],a[244:247],a[180:183],v[220:223]
s_waitcnt lgkmcnt(0)
v_xor_b32 v19, 32, v18
v_xor_b32 v20, 64, v18
v_xor_b32 v21, 0x60, v18
v_add_u32 v22, 0x10000, v18
v_add_u32 v23, 0x10000, v19
v_add_u32 v24, 0x10000, v20
v_add_u32 v25, 0x10000, v21
M v[216:219],a[244:247],a[148:151],v[216:219]
s_barrier
M v[228:231],a[96:99],v[52:55],v[228:231]
s_nop 0
T a[64:65],v22,32768
T a[66:67],v22,34816
M v[228:231],a[100:103],v[48:51],v[228:231]
T a[68:69],v22,36864
T a[70:71],v22,38912
M v[228:231],a[246:249],a[184:187],v[228:231]
C v180,v180,v181
C v181,v182,v183
M v[224:227],a[246:249],a[152:155],v[224:227]
T a[72:73],v22,40960
T a[74:75],v22,43008
M v[236:239],a[104:107],v[52:55],v[236:239]
T a[76:77],v22,45056
T a[78:79],v22,47104
M v[236:239],a[108:111],v[48:51],v[236:239]
C v182,v188,v189
C v183,v190,v191
M v[236:239],a[244:247],a[184:187],v[236:239]
T a[80:81],v22,49152
T a[82:83],v22,51200
M v[232:235],a[244:247],a[152:155],v[232:235]
T a[84:85],v22,53248
T a[86:87],v22,55296
M v[244:247],a[112:115],v[52:55],v[244:247]
C v176,v176,v177
C v177,v178,v179
M v[244:247],a[116:119],v[48:51],v[244:247]
T a[88:89],v22,57344
T a[90:91],v22,59392
M v[244:247],a[246:249],a[188:191],v[244:247]
T a[92:93],v22,61440
T a[94:95],v22,63488
M v[240:243],a[246:249],a[156:159],v[240:243]
C v178,v184,v185
C v179,v186,v187
M v[252:255],a[120:123],v[52:55],v[252:255]
C v196,v196,v197
C v197,v198,v199
M v[252:255],a[124:127],v[48:51],v[252:255]
C v198,v204,v205
C v199,v206,v207
M v[252:255],a[244:247],a[188:191],v[252:255]
s_waitcnt lgkmcnt(0)
C v192,v192,v193
C v193,v194,v195
M v[248:251],a[244:247],a[156:159],v[248:251]
C v194,v200,v201
C v195,v202,v203
C v212,v212,v213
C v213,v214,v215
C v214,v220,v221
C v215,v222,v223
C v208,v208,v209
C v209,v210,v211
C v210,v216,v217
C v211,v218,v219
C v228,v228,v229
C v229,v230,v231
C v230,v236,v237
C v231,v238,v239
C v224,v224,v225
C v225,v226,v227
C v226,v232,v233
C v227,v234,v235
C v244,v244,v245
C v245,v246,v247
C v246,v252,v253
C v247,v254,v255
C v240,v240,v241
C v241,v242,v243
C v242,v248,v249
C v243,v250,v251
M v[64:67],a[64:67],v[128:131],0
s_sub_u32 s64, 15, s42
T a[96:97],v23,32768
T a[98:99],v23,34816
M v[64:67],a[68:71],v[144:147],v[64:67]
s_min_u32 s64, s64, s42
T a[100:101],v23,36864
T a[102:103],v23,38912
M v[64:67],a[72:75],v[160:163],v[64:67]
s_mul_i32 s45, s64, 8704
M v[64:67],a[76:79],v[176:179],v[64:67]
s_lshl_b32 s64, s41, 2
T a[104:105],v23,40960
T a[106:107],v23,43008
M v[64:67],a[80:83],v[192:195],v[64:67]
SA s45,s45,s64
T a[108:109],v23,45056
T a[110:111],v23,47104
M v[64:67],a[84:87],v[208:211],v[64:67]
s_lshl_b32 s64, s20, 8
M v[64:67],a[88:91],v[224:227],v[64:67]
SA s45,s45,s64
T a[112:113],v23,49152
T a[114:115],v23,51200
M v[64:67],a[92:95],v[240:243],v[64:67]
SA s45,s45,104992768
T a[116:117],v23,53248
T a[118:119],v23,55296
M v[68:71],a[92:95],v[244:247],0
s_mov_b32 s64, 1024
M v[68:71],a[88:91],v[228:231],v[68:71]
s_mov_b32 s66, 4096
T a[120:121],v23,57344
T a[122:123],v23,59392
M v[68:71],a[84:87],v[212:215],v[68:71]
s_cmp_lt_u32 s42, 8
T a[124:125],v23,61440
T a[126:127],v23,63488
M v[68:71],a[80:83],v[196:199],v[68:71]
s_cselect_b32 s64, 4352, s64
M v[68:71],a[76:79],v[180:183],v[68:71]
s_cselect_b32 s65, 0, 64
M v[68:71],a[72:75],v[164:167],v[68:71]
s_cselect_b32 s66, 536870912, s66
M v[68:71],a[68:71],v[148:151],v[68:71]
SA s3,s45,s64
M v[68:71],a[64:67],v[132:135],v[68:71]
s_waitcnt lgkmcnt(0)
M v[72:75],a[96:99],v[128:131],0
SA s45,s45,s65
T a[64:65],v24,32768
T a[66:67],v24,34816
M v[72:75],a[100:103],v[144:147],v[72:75]
SA m0,s28,0
T a[68:69],v24,36864
T a[70:71],v24,38912
M v[72:75],a[104:107],v[160:163],v[72:75]
SA s85,s38,0
buffer_load_dwordx4 v0, s[12:15], s85 offen offset:0 lds
M v[72:75],a[108:111],v[176:179],v[72:75]
SA s85,s38,6144
T a[72:73],v24,40960
T a[74:75],v24,43008
M v[72:75],a[112:115],v[192:195],v[72:75]
SA s29,s33,0
T a[76:77],v24,45056
T a[78:79],v24,47104
M v[72:75],a[116:119],v[208:211],v[72:75]
SA s30,s33,14336
buffer_load_dwordx4 v0, s[12:15], s85 offen offset:1024 lds
M v[72:75],a[120:123],v[224:227],v[72:75]
SA s85,s38,12288
T a[80:81],v24,49152
T a[82:83],v24,51200
M v[72:75],a[124:127],v[240:243],v[72:75]
T a[84:85],v24,53248
T a[86:87],v24,55296
M v[76:79],a[124:127],v[244:247],0
buffer_load_dwordx4 v0, s[12:15], s85 offen offset:2048 lds
M v[76:79],a[120:123],v[228:231],v[76:79]
SA s85,s38,18432
T a[88:89],v24,57344
T a[90:91],v24,59392
M v[76:79],a[116:119],v[212:215],v[76:79]
T a[92:93],v24,61440
T a[94:95],v24,63488
M v[76:79],a[112:115],v[196:199],v[76:79]
buffer_load_dwordx4 v0, s[12:15], s85 offen offset:3072 lds
M v[76:79],a[108:111],v[180:183],v[76:79]
SA m0,s28,4096
v_lshrrev_b32 v17, 5, v7
v_min_u32 v15, 1, v17
M v[76:79],a[104:107],v[164:167],v[76:79]
SA s85,s38,28672
buffer_load_dwordx4 v0, s[12:15], s85 offen offset:0 lds
M v[76:79],a[100:103],v[148:151],v[76:79]
SA s85,s38,34816
v_lshlrev_b32 v14, 3, v7
v_lshl_or_b32 v16, v15, 29, v14
M v[76:79],a[96:99],v[132:135],v[76:79]
s_waitcnt lgkmcnt(0)
buffer_load_dwordx4 v0, s[12:15], s85 offen offset:1024 lds
M v[80:83],a[64:67],v[128:131],0
SA s85,s38,40960
T a[96:97],v25,32768
T a[98:99],v25,34816
M v[80:83],a[68:71],v[144:147],v[80:83]
T a[100:101],v25,36864
T a[102:103],v25,38912
M v[80:83],a[72:75],v[160:163],v[80:83]
buffer_load_dwordx4 v0, s[12:15], s85 offen offset:2048 lds
M v[80:83],a[76:79],v[176:179],v[80:83]
SA s85,s38,47104
T a[104:105],v25,40960
T a[106:107],v25,43008
M v[80:83],a[80:83],v[192:195],v[80:83]
T a[108:109],v25,45056
T a[110:111],v25,47104
M v[80:83],a[84:87],v[208:211],v[80:83]
buffer_load_dwordx4 v0, s[12:15], s85 offen offset:3072 lds
M v[80:83],a[88:91],v[224:227],v[80:83]
SA s38,s38,128
T a[112:113],v25,49152
T a[114:115],v25,51200
M v[80:83],a[92:95],v[240:243],v[80:83]
SA m0,s28,131072
T a[116:117],v25,53248
T a[118:119],v25,55296
M v[84:87],a[92:95],v[244:247],0
SA s85,s38,0
buffer_load_dwordx4 v0, s[12:15], s85 offen offset:0 lds
M v[84:87],a[88:91],v[228:231],v[84:87]
SA s85,s38,6144
T a[120:121],v25,57344
T a[122:123],v25,59392
M v[84:87],a[84:87],v[212:215],v[84:87]
T a[124:125],v25,61440
T a[126:127],v25,63488
M v[84:87],a[80:83],v[196:199],v[84:87]
buffer_load_dwordx4 v0, s[12:15], s85 offen offset:1024 lds
M v[84:87],a[76:79],v[180:183],v[84:87]
SA s85,s38,12288
v_cmp_eq_u32 vcc, 1, v17
v_add_u32 v14, s66, v14
M v[84:87],a[72:75],v[164:167],v[84:87]
buffer_load_dwordx4 v0, s[12:15], s85 offen offset:2048 lds
M v[84:87],a[68:71],v[148:151],v[84:87]
s_waitcnt vmcnt(19) lgkmcnt(0)
v_mov_b32 v15, 1
v_cndmask_b32 v17, v16, v14, vcc
M v[84:87],a[64:67],v[132:135],v[84:87]
s_barrier
M v[88:91],a[96:99],v[128:131],0
SA s85,s38,18432
T a[64:65],v18,32768
T a[66:67],v18,34816
M v[88:91],a[100:103],v[144:147],v[88:91]
T a[68:69],v18,36864
T a[70:71],v18,38912
M v[88:91],a[104:107],v[160:163],v[88:91]
buffer_load_dwordx4 v0, s[12:15], s85 offen offset:3072 lds
M v[88:91],a[108:111],v[176:179],v[88:91]
SA m0,s28,135168
T a[72:73],v18,40960
T a[74:75],v18,43008
M v[88:91],a[112:115],v[192:195],v[88:91]
SA s85,s38,28672
T a[76:77],v18,45056
T a[78:79],v18,47104
M v[88:91],a[116:119],v[208:211],v[88:91]
buffer_load_dwordx4 v0, s[12:15], s85 offen offset:0 lds
M v[88:91],a[120:123],v[224:227],v[88:91]
SA s85,s38,34816
T a[80:81],v18,49152
T a[82:83],v18,51200
M v[88:91],a[124:127],v[240:243],v[88:91]
T a[84:85],v18,53248
T a[86:87],v18,55296
M v[92:95],a[124:127],v[244:247],0
buffer_load_dwordx4 v0, s[12:15], s85 offen offset:1024 lds
M v[92:95],a[120:123],v[228:231],v[92:95]
SA s85,s38,40960
T a[88:89],v18,57344
T a[90:91],v18,59392
M v[92:95],a[116:119],v[212:215],v[92:95]
T a[92:93],v18,61440
T a[94:95],v18,63488
M v[92:95],a[112:115],v[196:199],v[92:95]
buffer_load_dwordx4 v0, s[12:15], s85 offen offset:2048 lds
M v[92:95],a[108:111],v[180:183],v[92:95]
SA s85,s38,47104
v_add_u32 v40, 0x20000, v18
v_add_u32 v41, 0x20000, v19
M v[92:95],a[104:107],v[164:167],v[92:95]
buffer_load_dwordx4 v0, s[12:15], s85 offen offset:3072 lds
M v[92:95],a[100:103],v[148:151],v[92:95]
s_waitcnt lgkmcnt(0)
v_add_u32 v42, 0x20000, v20
v_add_u32 v43, 0x20000, v21
M v[92:95],a[96:99],v[132:135],v[92:95]
SA s38,s38,128
MF v64,v5,v64
MF v65,v5,v65
MF v66,v5,v66
MF v67,v5,v67
MF v72,v5,v72
MF v73,v5,v73
MF v74,v5,v74
MF v75,v5,v75
C v64,v64,v65
C v65,v66,v67
C v66,v72,v73
C v67,v74,v75
buffer_store_dwordx4 v[64:67], v7, s[8:11], s29 offen offset:0 sc1
MF v68,v6,v68
MF v69,v6,v69
MF v70,v6,v70
MF v71,v6,v71
MF v76,v6,v76
MF v77,v6,v77
MF v78,v6,v78
MF v79,v6,v79
C v68,v68,v69
C v69,v70,v71
C v70,v76,v77
C v71,v78,v79
buffer_store_dwordx4 v[68:71], v7, s[8:11], s30 offen offset:0 sc1
M v[96:99],a[64:67],v[128:131],0
s_nop 0
T a[96:97],v19,32768
T a[98:99],v19,34816
M v[96:99],a[68:71],v[144:147],v[96:99]
SA m0,s28,98304
T a[100:101],v19,36864
T a[102:103],v19,38912
M v[96:99],a[72:75],v[160:163],v[96:99]
SA s85,s38,0
buffer_load_dwordx4 v0, s[12:15], s85 offen offset:0 lds
M v[96:99],a[76:79],v[176:179],v[96:99]
s_nop 0
T a[104:105],v19,40960
T a[106:107],v19,43008
M v[96:99],a[80:83],v[192:195],v[96:99]
T a[108:109],v19,45056
T a[110:111],v19,47104
M v[96:99],a[84:87],v[208:211],v[96:99]
SA s85,s38,6144
MF v80,v5,v80
MF v81,v5,v81
M v[96:99],a[88:91],v[224:227],v[96:99]
T a[112:113],v19,49152
T a[114:115],v19,51200
M v[96:99],a[92:95],v[240:243],v[96:99]
T a[116:117],v19,53248
T a[118:119],v19,55296
M v[100:103],a[92:95],v[244:247],0
buffer_load_dwordx4 v0, s[12:15], s85 offen offset:1024 lds
M v[100:103],a[88:91],v[228:231],v[100:103]
s_nop 0
T a[120:121],v19,57344
T a[122:123],v19,59392
M v[100:103],a[84:87],v[212:215],v[100:103]
T a[124:125],v19,61440
T a[126:127],v19,63488
M v[100:103],a[80:83],v[196:199],v[100:103]
SA s85,s38,12288
MF v82,v5,v82
MF v83,v5,v83
M v[100:103],a[76:79],v[180:183],v[100:103]
buffer_load_dwordx4 v0, s[12:15], s85 offen offset:2048 lds
M v[100:103],a[72:75],v[164:167],v[100:103]
MF v88,v5,v88
MF v89,v5,v89
M v[100:103],a[68:71],v[148:151],v[100:103]
MF v90,v5,v90
MF v91,v5,v91
M v[100:103],a[64:67],v[132:135],v[100:103]
s_waitcnt lgkmcnt(0)
C v80,v80,v81
C v81,v82,v83
M v[104:107],a[96:99],v[128:131],0
SA s85,s38,18432
T a[64:65],v20,32768
T a[66:67],v20,34816
M v[104:107],a[100:103],v[144:147],v[104:107]
T a[68:69],v20,36864
T a[70:71],v20,38912
M v[104:107],a[104:107],v[160:163],v[104:107]
buffer_load_dwordx4 v0, s[12:15], s85 offen offset:3072 lds
M v[104:107],a[108:111],v[176:179],v[104:107]
s_nop 0
T a[72:73],v20,40960
T a[74:75],v20,43008
M v[104:107],a[112:115],v[192:195],v[104:107]
T a[76:77],v20,45056
T a[78:79],v20,47104
M v[104:107],a[116:119],v[208:211],v[104:107]
SA m0,s28,102400
C v82,v88,v89
C v83,v90,v91
M v[104:107],a[120:123],v[224:227],v[104:107]
SA s85,s38,28672
T a[80:81],v20,49152
T a[82:83],v20,51200
M v[104:107],a[124:127],v[240:243],v[104:107]
T a[84:85],v20,53248
T a[86:87],v20,55296
M v[108:111],a[124:127],v[244:247],0
buffer_store_dwordx4 v[80:83], v7, s[8:11], s29 offen offset:1024 sc1
M v[108:111],a[120:123],v[228:231],v[108:111]
s_nop 0
T a[88:89],v20,57344
T a[90:91],v20,59392
M v[108:111],a[116:119],v[212:215],v[108:111]
T a[92:93],v20,61440
T a[94:95],v20,63488
M v[108:111],a[112:115],v[196:199],v[108:111]
buffer_load_dwordx4 v0, s[12:15], s85 offen offset:0 lds
M v[108:111],a[108:111],v[180:183],v[108:111]
SA s85,s38,34816
MF v84,v6,v84
MF v85,v6,v85
M v[108:111],a[104:107],v[164:167],v[108:111]
MF v86,v6,v86
MF v87,v6,v87
M v[108:111],a[100:103],v[148:151],v[108:111]
buffer_load_dwordx4 v0, s[12:15], s85 offen offset:1024 lds
M v[108:111],a[96:99],v[132:135],v[108:111]
s_waitcnt lgkmcnt(0)
MF v92,v6,v92
MF v93,v6,v93
M v[112:115],a[64:67],v[128:131],0
T a[96:97],v21,32768
T a[98:99],v21,34816
M v[112:115],a[68:71],v[144:147],v[112:115]
SA s85,s38,40960
T a[100:101],v21,36864
T a[102:103],v21,38912
M v[112:115],a[72:75],v[160:163],v[112:115]
buffer_load_dwordx4 v0, s[12:15], s85 offen offset:2048 lds
M v[112:115],a[76:79],v[176:179],v[112:115]
s_nop 0
T a[104:105],v21,40960
T a[106:107],v21,43008
M v[112:115],a[80:83],v[192:195],v[112:115]
T a[108:109],v21,45056
T a[110:111],v21,47104
M v[112:115],a[84:87],v[208:211],v[112:115]
MF v94,v6,v94
MF v95,v6,v95
M v[112:115],a[88:91],v[224:227],v[112:115]
SA s85,s38,47104
T a[112:113],v21,49152
T a[114:115],v21,51200
M v[112:115],a[92:95],v[240:243],v[112:115]
T a[116:117],v21,53248
T a[118:119],v21,55296
M v[116:119],a[92:95],v[244:247],0
buffer_load_dwordx4 v0, s[12:15], s85 offen offset:3072 lds
M v[116:119],a[88:91],v[228:231],v[116:119]
s_nop 0
T a[120:121],v21,57344
T a[122:123],v21,59392
M v[116:119],a[84:87],v[212:215],v[116:119]
T a[124:125],v21,61440
T a[126:127],v21,63488
M v[116:119],a[80:83],v[196:199],v[116:119]
C v84,v84,v85
C v85,v86,v87
M v[116:119],a[76:79],v[180:183],v[116:119]
C v86,v92,v93
C v87,v94,v95
M v[116:119],a[72:75],v[164:167],v[116:119]
SA s38,s38,128
buffer_store_dwordx4 v[84:87], v7, s[8:11], s30 offen offset:1024 sc1
M v[116:119],a[68:71],v[148:151],v[116:119]
s_waitcnt vmcnt(28) lgkmcnt(0)
M v[116:119],a[64:67],v[132:135],v[116:119]
s_barrier
M v[120:123],a[96:99],v[128:131],0
SA s29,s33,2048
T a[64:65],v22,0
T a[66:67],v22,2048
M v[120:123],a[100:103],v[144:147],v[120:123]
SA s30,s33,16384
T a[68:69],v22,4096
T a[70:71],v22,6144
M v[120:123],a[104:107],v[160:163],v[120:123]
MF v96,v5,v96
MF v97,v5,v97
M v[120:123],a[108:111],v[176:179],v[120:123]
T a[72:73],v22,8192
T a[74:75],v22,10240
M v[120:123],a[112:115],v[192:195],v[120:123]
T a[76:77],v22,12288
T a[78:79],v22,14336
M v[120:123],a[116:119],v[208:211],v[120:123]
MF v98,v5,v98
MF v99,v5,v99
M v[120:123],a[120:123],v[224:227],v[120:123]
T a[80:81],v22,16384
T a[82:83],v22,18432
M v[120:123],a[124:127],v[240:243],v[120:123]
T a[84:85],v22,20480
T a[86:87],v22,22528
M v[124:127],a[124:127],v[244:247],0
MF v104,v5,v104
MF v105,v5,v105
M v[124:127],a[120:123],v[228:231],v[124:127]
T a[88:89],v22,24576
T a[90:91],v22,26624
M v[124:127],a[116:119],v[212:215],v[124:127]
T a[92:93],v22,28672
T a[94:95],v22,30720
M v[124:127],a[112:115],v[196:199],v[124:127]
MF v106,v5,v106
MF v107,v5,v107
M v[124:127],a[108:111],v[180:183],v[124:127]
C v96,v96,v97
C v97,v98,v99
M v[124:127],a[104:107],v[164:167],v[124:127]
C v98,v104,v105
C v99,v106,v107
M v[124:127],a[100:103],v[148:151],v[124:127]
s_waitcnt lgkmcnt(0)
buffer_store_dwordx4 v[96:99], v7, s[8:11], s29 offen offset:0 sc1
M v[124:127],a[96:99],v[132:135],v[124:127]
MF v100,v6,v100
MF v101,v6,v101
MF v102,v6,v102
MF v103,v6,v103
MF v108,v6,v108
MF v109,v6,v109
MF v110,v6,v110
MF v111,v6,v111
C v100,v100,v101
C v101,v102,v103
C v102,v108,v109
C v103,v110,v111
buffer_store_dwordx4 v[100:103], v7, s[8:11], s30 offen offset:0 sc1
M v[64:67],a[64:67],v[128:131],0
s_nop 0
T a[96:97],v23,0
T a[98:99],v23,2048
M v[64:67],a[68:71],v[144:147],v[64:67]
SA m0,s28,32768
T a[100:101],v23,4096
T a[102:103],v23,6144
M v[64:67],a[72:75],v[160:163],v[64:67]
SA s85,s38,0
buffer_load_dwordx4 v0, s[12:15], s85 offen offset:0 lds
M v[64:67],a[76:79],v[176:179],v[64:67]
s_nop 0
T a[104:105],v23,8192
T a[106:107],v23,10240
M v[64:67],a[80:83],v[192:195],v[64:67]
T a[108:109],v23,12288
T a[110:111],v23,14336
M v[64:67],a[84:87],v[208:211],v[64:67]
SA s85,s38,6144
MF v112,v5,v112
MF v113,v5,v113
M v[64:67],a[88:91],v[224:227],v[64:67]
T a[112:113],v23,16384
T a[114:115],v23,18432
M v[64:67],a[92:95],v[240:243],v[64:67]
T a[116:117],v23,20480
T a[118:119],v23,22528
M v[68:71],a[92:95],v[244:247],0
buffer_load_dwordx4 v0, s[12:15], s85 offen offset:1024 lds
M v[68:71],a[88:91],v[228:231],v[68:71]
s_nop 0
T a[120:121],v23,24576
T a[122:123],v23,26624
M v[68:71],a[84:87],v[212:215],v[68:71]
T a[124:125],v23,28672
T a[126:127],v23,30720
M v[68:71],a[80:83],v[196:199],v[68:71]
SA s85,s38,12288
MF v114,v5,v114
MF v115,v5,v115
M v[68:71],a[76:79],v[180:183],v[68:71]
buffer_load_dwordx4 v0, s[12:15], s85 offen offset:2048 lds
M v[68:71],a[72:75],v[164:167],v[68:71]
MF v120,v5,v120
MF v121,v5,v121
M v[68:71],a[68:71],v[148:151],v[68:71]
MF v122,v5,v122
MF v123,v5,v123
M v[68:71],a[64:67],v[132:135],v[68:71]
s_waitcnt lgkmcnt(0)
C v112,v112,v113
C v113,v114,v115
M v[72:75],a[96:99],v[128:131],0
SA s85,s38,18432
T a[64:65],v24,0
T a[66:67],v24,2048
M v[72:75],a[100:103],v[144:147],v[72:75]
T a[68:69],v24,4096
T a[70:71],v24,6144
M v[72:75],a[104:107],v[160:163],v[72:75]
buffer_load_dwordx4 v0, s[12:15], s85 offen offset:3072 lds
M v[72:75],a[108:111],v[176:179],v[72:75]
s_nop 0
T a[72:73],v24,8192
T a[74:75],v24,10240
M v[72:75],a[112:115],v[192:195],v[72:75]
T a[76:77],v24,12288
T a[78:79],v24,14336
M v[72:75],a[116:119],v[208:211],v[72:75]
SA m0,s28,36864
C v114,v120,v121
C v115,v122,v123
M v[72:75],a[120:123],v[224:227],v[72:75]
SA s85,s38,28672
T a[80:81],v24,16384
T a[82:83],v24,18432
M v[72:75],a[124:127],v[240:243],v[72:75]
T a[84:85],v24,20480
T a[86:87],v24,22528
M v[76:79],a[124:127],v[244:247],0
buffer_store_dwordx4 v[112:115], v7, s[8:11], s29 offen offset:1024 sc1
M v[76:79],a[120:123],v[228:231],v[76:79]
s_nop 0
T a[88:89],v24,24576
T a[90:91],v24,26624
M v[76:79],a[116:119],v[212:215],v[76:79]
T a[92:93],v24,28672
T a[94:95],v24,30720
M v[76:79],a[112:115],v[196:199],v[76:79]
buffer_load_dwordx4 v0, s[12:15], s85 offen offset:0 lds
M v[76:79],a[108:111],v[180:183],v[76:79]
SA s85,s38,34816
MF v116,v6,v116
MF v117,v6,v117
M v[76:79],a[104:107],v[164:167],v[76:79]
MF v118,v6,v118
MF v119,v6,v119
M v[76:79],a[100:103],v[148:151],v[76:79]
buffer_load_dwordx4 v0, s[12:15], s85 offen offset:1024 lds
M v[76:79],a[96:99],v[132:135],v[76:79]
s_waitcnt lgkmcnt(0)
MF v124,v6,v124
MF v125,v6,v125
M v[80:83],a[64:67],v[128:131],0
T a[96:97],v25,0
T a[98:99],v25,2048
M v[80:83],a[68:71],v[144:147],v[80:83]
SA s85,s38,40960
T a[100:101],v25,4096
T a[102:103],v25,6144
M v[80:83],a[72:75],v[160:163],v[80:83]
buffer_load_dwordx4 v0, s[12:15], s85 offen offset:2048 lds
M v[80:83],a[76:79],v[176:179],v[80:83]
s_nop 0
T a[104:105],v25,8192
T a[106:107],v25,10240
M v[80:83],a[80:83],v[192:195],v[80:83]
T a[108:109],v25,12288
T a[110:111],v25,14336
M v[80:83],a[84:87],v[208:211],v[80:83]
MF v126,v6,v126
MF v127,v6,v127
M v[80:83],a[88:91],v[224:227],v[80:83]
SA s85,s38,47104
T a[112:113],v25,16384
T a[114:115],v25,18432
M v[80:83],a[92:95],v[240:243],v[80:83]
T a[116:117],v25,20480
T a[118:119],v25,22528
M v[84:87],a[92:95],v[244:247],0
buffer_load_dwordx4 v0, s[12:15], s85 offen offset:3072 lds
M v[84:87],a[88:91],v[228:231],v[84:87]
s_nop 0
T a[120:121],v25,24576
T a[122:123],v25,26624
M v[84:87],a[84:87],v[212:215],v[84:87]
T a[124:125],v25,28672
T a[126:127],v25,30720
M v[84:87],a[80:83],v[196:199],v[84:87]
C v116,v116,v117
C v117,v118,v119
M v[84:87],a[76:79],v[180:183],v[84:87]
C v118,v124,v125
C v119,v126,v127
M v[84:87],a[72:75],v[164:167],v[84:87]
SA s38,s38,128
buffer_store_dwordx4 v[116:119], v7, s[8:11], s30 offen offset:1024 sc1
M v[84:87],a[68:71],v[148:151],v[84:87]
s_waitcnt vmcnt(32) lgkmcnt(0)
M v[84:87],a[64:67],v[132:135],v[84:87]
s_barrier
M v[88:91],a[96:99],v[128:131],0
SA s29,s33,4096
T a[64:65],v18,0
T a[66:67],v18,2048
M v[88:91],a[100:103],v[144:147],v[88:91]
SA s30,s33,18432
T a[68:69],v18,4096
T a[70:71],v18,6144
M v[88:91],a[104:107],v[160:163],v[88:91]
MF v64,v5,v64
MF v65,v5,v65
M v[88:91],a[108:111],v[176:179],v[88:91]
T a[72:73],v18,8192
T a[74:75],v18,10240
M v[88:91],a[112:115],v[192:195],v[88:91]
T a[76:77],v18,12288
T a[78:79],v18,14336
M v[88:91],a[116:119],v[208:211],v[88:91]
MF v66,v5,v66
MF v67,v5,v67
M v[88:91],a[120:123],v[224:227],v[88:91]
T a[80:81],v18,16384
T a[82:83],v18,18432
M v[88:91],a[124:127],v[240:243],v[88:91]
T a[84:85],v18,20480
T a[86:87],v18,22528
M v[92:95],a[124:127],v[244:247],0
MF v72,v5,v72
MF v73,v5,v73
M v[92:95],a[120:123],v[228:231],v[92:95]
T a[88:89],v18,24576
T a[90:91],v18,26624
M v[92:95],a[116:119],v[212:215],v[92:95]
T a[92:93],v18,28672
T a[94:95],v18,30720
M v[92:95],a[112:115],v[196:199],v[92:95]
MF v74,v5,v74
MF v75,v5,v75
M v[92:95],a[108:111],v[180:183],v[92:95]
C v64,v64,v65
C v65,v66,v67
M v[92:95],a[104:107],v[164:167],v[92:95]
C v66,v72,v73
C v67,v74,v75
M v[92:95],a[100:103],v[148:151],v[92:95]
s_waitcnt lgkmcnt(0)
buffer_store_dwordx4 v[64:67], v7, s[8:11], s29 offen offset:0 sc1
M v[92:95],a[96:99],v[132:135],v[92:95]
MF v68,v6,v68
MF v69,v6,v69
MF v70,v6,v70
MF v71,v6,v71
MF v76,v6,v76
MF v77,v6,v77
MF v78,v6,v78
MF v79,v6,v79
C v68,v68,v69
C v69,v70,v71
C v70,v76,v77
C v71,v78,v79
buffer_store_dwordx4 v[68:71], v7, s[8:11], s30 offen offset:0 sc1
M v[96:99],a[64:67],v[128:131],0
s_nop 0
T a[96:97],v19,0
T a[98:99],v19,2048
M v[96:99],a[68:71],v[144:147],v[96:99]
T a[100:101],v19,4096
T a[102:103],v19,6144
M v[96:99],a[72:75],v[160:163],v[96:99]
MF v80,v5,v80
MF v81,v5,v81
M v[96:99],a[76:79],v[176:179],v[96:99]
T a[104:105],v19,8192
T a[106:107],v19,10240
M v[96:99],a[80:83],v[192:195],v[96:99]
T a[108:109],v19,12288
T a[110:111],v19,14336
M v[96:99],a[84:87],v[208:211],v[96:99]
MF v82,v5,v82
MF v83,v5,v83
M v[96:99],a[88:91],v[224:227],v[96:99]
T a[112:113],v19,16384
T a[114:115],v19,18432
M v[96:99],a[92:95],v[240:243],v[96:99]
T a[116:117],v19,20480
T a[118:119],v19,22528
M v[100:103],a[92:95],v[244:247],0
MF v88,v5,v88
MF v89,v5,v89
M v[100:103],a[88:91],v[228:231],v[100:103]
T a[120:121],v19,24576
T a[122:123],v19,26624
M v[100:103],a[84:87],v[212:215],v[100:103]
T a[124:125],v19,28672
T a[126:127],v19,30720
M v[100:103],a[80:83],v[196:199],v[100:103]
MF v90,v5,v90
MF v91,v5,v91
M v[100:103],a[76:79],v[180:183],v[100:103]
C v80,v80,v81
C v81,v82,v83
M v[100:103],a[72:75],v[164:167],v[100:103]
C v82,v88,v89
C v83,v90,v91
M v[100:103],a[68:71],v[148:151],v[100:103]
buffer_store_dwordx4 v[80:83], v7, s[8:11], s29 offen offset:1024 sc1
M v[100:103],a[64:67],v[132:135],v[100:103]
s_waitcnt lgkmcnt(0)
MF v84,v6,v84
MF v85,v6,v85
M v[104:107],a[96:99],v[128:131],0
T a[64:65],v20,0
T a[66:67],v20,2048
M v[104:107],a[100:103],v[144:147],v[104:107]
T a[68:69],v20,4096
T a[70:71],v20,6144
M v[104:107],a[104:107],v[160:163],v[104:107]
MF v86,v6,v86
MF v87,v6,v87
M v[104:107],a[108:111],v[176:179],v[104:107]
T a[72:73],v20,8192
T a[74:75],v20,10240
M v[104:107],a[112:115],v[192:195],v[104:107]
T a[76:77],v20,12288
T a[78:79],v20,14336
M v[104:107],a[116:119],v[208:211],v[104:107]
MF v92,v6,v92
MF v93,v6,v93
M v[104:107],a[120:123],v[224:227],v[104:107]
T a[80:81],v20,16384
T a[82:83],v20,18432
M v[104:107],a[124:127],v[240:243],v[104:107]
T a[84:85],v20,20480
T a[86:87],v20,22528
M v[108:111],a[124:127],v[244:247],0
MF v94,v6,v94
MF v95,v6,v95
M v[108:111],a[120:123],v[228:231],v[108:111]
T a[88:89],v20,24576
T a[90:91],v20,26624
M v[108:111],a[116:119],v[212:215],v[108:111]
T a[92:93],v20,28672
T a[94:95],v20,30720
M v[108:111],a[112:115],v[196:199],v[108:111]
C v84,v84,v85
C v85,v86,v87
M v[108:111],a[108:111],v[180:183],v[108:111]
C v86,v92,v93
C v87,v94,v95
M v[108:111],a[104:107],v[164:167],v[108:111]
buffer_store_dwordx4 v[84:87], v7, s[8:11], s30 offen offset:1024 sc1
M v[108:111],a[100:103],v[148:151],v[108:111]
SA s29,s33,6144
M v[108:111],a[96:99],v[132:135],v[108:111]
s_waitcnt lgkmcnt(0)
M v[112:115],a[64:67],v[128:131],0
SA s30,s33,20480
T a[96:97],v21,0
T a[98:99],v21,2048
M v[112:115],a[68:71],v[144:147],v[112:115]
T a[100:101],v21,4096
T a[102:103],v21,6144
M v[112:115],a[72:75],v[160:163],v[112:115]
MF v96,v5,v96
MF v97,v5,v97
M v[112:115],a[76:79],v[176:179],v[112:115]
T a[104:105],v21,8192
T a[106:107],v21,10240
M v[112:115],a[80:83],v[192:195],v[112:115]
T a[108:109],v21,12288
T a[110:111],v21,14336
M v[112:115],a[84:87],v[208:211],v[112:115]
MF v98,v5,v98
MF v99,v5,v99
M v[112:115],a[88:91],v[224:227],v[112:115]
T a[112:113],v21,16384
T a[114:115],v21,18432
M v[112:115],a[92:95],v[240:243],v[112:115]
T a[116:117],v21,20480
T a[118:119],v21,22528
M v[116:119],a[92:95],v[244:247],0
MF v104,v5,v104
MF v105,v5,v105
M v[116:119],a[88:91],v[228:231],v[116:119]
T a[120:121],v21,24576
T a[122:123],v21,26624
M v[116:119],a[84:87],v[212:215],v[116:119]
T a[124:125],v21,28672
T a[126:127],v21,30720
M v[116:119],a[80:83],v[196:199],v[116:119]
MF v106,v5,v106
MF v107,v5,v107
M v[116:119],a[76:79],v[180:183],v[116:119]
C v96,v96,v97
C v97,v98,v99
M v[116:119],a[72:75],v[164:167],v[116:119]
C v98,v104,v105
C v99,v106,v107
M v[116:119],a[68:71],v[148:151],v[116:119]
s_waitcnt vmcnt(28) lgkmcnt(0)
buffer_store_dwordx4 v[96:99], v7, s[8:11], s29 offen offset:0 sc1
M v[116:119],a[64:67],v[132:135],v[116:119]
s_barrier
M v[120:123],a[96:99],v[128:131],0
s_nop 0
T a[64:65],v40,0
T a[66:67],v40,2048
M v[120:123],a[100:103],v[144:147],v[120:123]
T a[68:69],v40,4096
T a[70:71],v40,6144
M v[120:123],a[104:107],v[160:163],v[120:123]
MF v100,v6,v100
MF v101,v6,v101
M v[120:123],a[108:111],v[176:179],v[120:123]
T a[72:73],v40,8192
T a[74:75],v40,10240
M v[120:123],a[112:115],v[192:195],v[120:123]
T a[76:77],v40,12288
T a[78:79],v40,14336
M v[120:123],a[116:119],v[208:211],v[120:123]
MF v102,v6,v102
MF v103,v6,v103
M v[120:123],a[120:123],v[224:227],v[120:123]
T a[80:81],v40,16384
T a[82:83],v40,18432
M v[120:123],a[124:127],v[240:243],v[120:123]
T a[84:85],v40,20480
T a[86:87],v40,22528
M v[124:127],a[124:127],v[244:247],0
MF v108,v6,v108
MF v109,v6,v109
M v[124:127],a[120:123],v[228:231],v[124:127]
T a[88:89],v40,24576
T a[90:91],v40,26624
M v[124:127],a[116:119],v[212:215],v[124:127]
T a[92:93],v40,28672
T a[94:95],v40,30720
M v[124:127],a[112:115],v[196:199],v[124:127]
MF v110,v6,v110
MF v111,v6,v111
M v[124:127],a[108:111],v[180:183],v[124:127]
C v100,v100,v101
C v101,v102,v103
M v[124:127],a[104:107],v[164:167],v[124:127]
C v102,v108,v109
C v103,v110,v111
M v[124:127],a[100:103],v[148:151],v[124:127]
s_waitcnt lgkmcnt(0)
buffer_store_dwordx4 v[100:103], v7, s[8:11], s30 offen offset:0 sc1
M v[124:127],a[96:99],v[132:135],v[124:127]
M v[64:67],a[64:67],v[128:131],0
s_nop 0
T a[96:97],v41,0
T a[98:99],v41,2048
M v[64:67],a[68:71],v[144:147],v[64:67]
T a[100:101],v41,4096
T a[102:103],v41,6144
M v[64:67],a[72:75],v[160:163],v[64:67]
v_lshrrev_b32 v32, 4, v7
MF v112,v5,v112
M v[64:67],a[76:79],v[176:179],v[64:67]
s_lshr_b32 s74, s41, 3
T a[104:105],v41,8192
T a[106:107],v41,10240
M v[64:67],a[80:83],v[192:195],v[64:67]
s_sub_u32 s64, 15, s42
T a[108:109],v41,12288
T a[110:111],v41,14336
M v[64:67],a[84:87],v[208:211],v[64:67]
s_mul_i32 s46, s64, 8704
MF v113,v5,v113
MF v114,v5,v114
M v[64:67],a[88:91],v[224:227],v[64:67]
s_and_b32 s72, s41, 7
T a[112:113],v41,16384
T a[114:115],v41,18432
M v[64:67],a[92:95],v[240:243],v[64:67]
s_lshl_b32 s65, s72, 7
T a[116:117],v41,20480
T a[118:119],v41,22528
M v[68:71],a[92:95],v[244:247],0
SA s46,s46,s65
MF v115,v5,v115
MF v120,v5,v120
M v[68:71],a[88:91],v[228:231],v[68:71]
SA s46,s46,104993792
T a[120:121],v41,24576
T a[122:123],v41,26624
M v[68:71],a[84:87],v[212:215],v[68:71]
T a[124:125],v41,28672
T a[126:127],v41,30720
M v[68:71],a[80:83],v[196:199],v[68:71]
v_and_b32 v33, 31, v32
MF v121,v5,v121
M v[68:71],a[76:79],v[180:183],v[68:71]
MF v122,v5,v122
MF v123,v5,v123
M v[68:71],a[72:75],v[164:167],v[68:71]
C v112,v112,v113
C v113,v114,v115
M v[68:71],a[68:71],v[148:151],v[68:71]
C v114,v120,v121
C v115,v122,v123
M v[68:71],a[64:67],v[132:135],v[68:71]
s_waitcnt lgkmcnt(0)
buffer_store_dwordx4 v[112:115], v7, s[8:11], s29 offen offset:1024 sc1
M v[72:75],a[96:99],v[128:131],0
s_nop 0
T a[64:65],v42,0
T a[66:67],v42,2048
M v[72:75],a[100:103],v[144:147],v[72:75]
T a[68:69],v42,4096
T a[70:71],v42,6144
M v[72:75],a[104:107],v[160:163],v[72:75]
MF v116,v6,v116
MF v117,v6,v117
M v[72:75],a[108:111],v[176:179],v[72:75]
T a[72:73],v42,8192
T a[74:75],v42,10240
M v[72:75],a[112:115],v[192:195],v[72:75]
T a[76:77],v42,12288
T a[78:79],v42,14336
M v[72:75],a[116:119],v[208:211],v[72:75]
MF v118,v6,v118
MF v119,v6,v119
M v[72:75],a[120:123],v[224:227],v[72:75]
T a[80:81],v42,16384
T a[82:83],v42,18432
M v[72:75],a[124:127],v[240:243],v[72:75]
T a[84:85],v42,20480
T a[86:87],v42,22528
M v[76:79],a[124:127],v[244:247],0
MF v124,v6,v124
MF v125,v6,v125
M v[76:79],a[120:123],v[228:231],v[76:79]
T a[88:89],v42,24576
T a[90:91],v42,26624
M v[76:79],a[116:119],v[212:215],v[76:79]
T a[92:93],v42,28672
T a[94:95],v42,30720
M v[76:79],a[112:115],v[196:199],v[76:79]
MF v126,v6,v126
MF v127,v6,v127
M v[76:79],a[108:111],v[180:183],v[76:79]
C v116,v116,v117
C v117,v118,v119
M v[76:79],a[104:107],v[164:167],v[76:79]
C v118,v124,v125
C v119,v126,v127
M v[76:79],a[100:103],v[148:151],v[76:79]
buffer_store_dwordx4 v[116:119], v7, s[8:11], s30 offen offset:1024 sc1
M v[76:79],a[96:99],v[132:135],v[76:79]
s_waitcnt lgkmcnt(0)
v_lshlrev_b32 v33, 2, v33
M v[80:83],a[64:67],v[128:131],0
SA s29,s33,8192
T a[96:97],v43,0
T a[98:99],v43,2048
M v[80:83],a[68:71],v[144:147],v[80:83]
SA s30,s33,22528
T a[100:101],v43,4096
T a[102:103],v43,6144
M v[80:83],a[72:75],v[160:163],v[80:83]
s_lshl_b32 s65, s41, 7
MF v64,v5,v64
MF v65,v5,v65
M v[80:83],a[76:79],v[176:179],v[80:83]
SA s65,s65,104890368
T a[104:105],v43,8192
T a[106:107],v43,10240
M v[80:83],a[80:83],v[192:195],v[80:83]
T a[108:109],v43,12288
T a[110:111],v43,14336
M v[80:83],a[84:87],v[208:211],v[80:83]
buffer_load_dword v31, v33, s[8:11], s65 offen sc1
M v[80:83],a[88:91],v[224:227],v[80:83]
s_nop 0
T a[112:113],v43,16384
T a[114:115],v43,18432
M v[80:83],a[92:95],v[240:243],v[80:83]
T a[116:117],v43,20480
T a[118:119],v43,22528
M v[84:87],a[92:95],v[244:247],0
s_cmp_ge_u32 s42, 8
v_bfe_u32 v34, v32, 4, 1
v_lshlrev_b32 v34, 1, v34
M v[84:87],a[88:91],v[228:231],v[84:87]
s_cselect_b32 s84, s45, 536870912
T a[120:121],v43,24576
T a[122:123],v43,26624
M v[84:87],a[84:87],v[212:215],v[84:87]
T a[124:125],v43,28672
T a[126:127],v43,30720
M v[84:87],a[80:83],v[196:199],v[84:87]
v_lshrrev_b32 v35, 5, v32
v_add_u32 v34, v34, v35
M v[84:87],a[76:79],v[180:183],v[84:87]
s_mov_b32 s52, s96
MF v66,v5,v66
MF v67,v5,v67
M v[84:87],a[72:75],v[164:167],v[84:87]
s_and_b32 s53, s97, 0xffff
MF v72,v5,v72
MF v73,v5,v73
M v[84:87],a[68:71],v[148:151],v[84:87]
s_waitcnt vmcnt(22) lgkmcnt(0)
MF v74,v5,v74
MF v75,v5,v75
M v[84:87],a[64:67],v[132:135],v[84:87]
s_barrier
M v[88:91],a[96:99],v[128:131],0
s_mov_b32 s54, 1835008
T a[64:65],v22,32768
T a[66:67],v22,34816
M v[88:91],a[100:103],v[144:147],v[88:91]
s_mov_b32 s55, 0x20000
T a[68:69],v22,36864
T a[70:71],v22,38912
M v[88:91],a[104:107],v[160:163],v[88:91]
s_mul_i32 s77, s42, 1835008
C v64,v64,v65
C v65,v66,v67
M v[88:91],a[108:111],v[176:179],v[88:91]
s_mul_i32 s78, s72, 14336
T a[72:73],v22,40960
T a[74:75],v22,43008
M v[88:91],a[112:115],v[192:195],v[88:91]
SA s77,s77,s78
T a[76:77],v22,45056
T a[78:79],v22,47104
M v[88:91],a[116:119],v[208:211],v[88:91]
SA s77,s77,67108864
C v66,v72,v73
C v67,v74,v75
M v[88:91],a[120:123],v[224:227],v[88:91]
s_lshl_b32 s79, s74, 2
T a[80:81],v22,49152
T a[82:83],v22,51200
M v[88:91],a[124:127],v[240:243],v[88:91]
SA s79,s79,s20
T a[84:85],v22,53248
T a[86:87],v22,55296
M v[92:95],a[124:127],v[244:247],0
SA s79,s79,6
buffer_store_dwordx4 v[64:67], v7, s[8:11], s29 offen offset:0 sc1
M v[92:95],a[120:123],v[228:231],v[92:95]
s_sub_u32 s67, 13, s79
T a[88:89],v22,57344
T a[90:91],v22,59392
M v[92:95],a[116:119],v[212:215],v[92:95]
s_and_b32 s67, s67, 536870912
T a[92:93],v22,61440
T a[94:95],v22,63488
M v[92:95],a[112:115],v[196:199],v[92:95]
s_lshl_b32 s78, s79, 10
MF v68,v6,v68
MF v69,v6,v69
M v[92:95],a[108:111],v[180:183],v[92:95]
SA s78,s78,s77
MF v70,v6,v70
MF v71,v6,v71
M v[92:95],a[104:107],v[164:167],v[92:95]
s_lshl_b32 s79, s79, 6
MF v76,v6,v76
MF v77,v6,v77
M v[92:95],a[100:103],v[148:151],v[92:95]
s_waitcnt lgkmcnt(0)
MF v78,v6,v78
MF v79,v6,v79
M v[92:95],a[96:99],v[132:135],v[92:95]
s_or_b32 s79, s79, s67
v_or_b32 v27, s67, v7
s_lshr_b32 s73, s72, 1
s_sub_u32 s65, 7, s73
s_bitcmp1_b32 s72, 0
s_cselect_b32 s73, s65, s73
s_lshl_b32 s73, s73, 4
s_lshl_b32 s65, s42, 7
SA s73,s73,s65
v_and_b32 v29, 15, v32
v_add_u32 v29, s73, v29
s_mov_b32 s64, 104857664
v_mul_u32_u24 v28, 896, v29
v_lshl_add_u32 v28, v34, 4, v28
C v68,v68,v69
C v69,v70,v71
C v70,v76,v77
C v71,v78,v79
buffer_store_dwordx4 v[68:71], v7, s[8:11], s30 offen offset:0 sc1
v_lshrrev_b32 v35, 4, v29
v_lshlrev_b32 v35, 5, v35
v_and_b32 v36, 15, v29
v_add_lshl_u32 v35, v35, v36, 2
buffer_load_dword v26, v35, s[8:11], s64 offen sc1
s_waitcnt vmcnt(8)
buffer_store_dword v15, v17, s[8:11], s84 offen sc1
buffer_load_dwordx4 v[44:47], v28, s[56:59], s79 offen
M v[96:99],a[64:67],v[128:131],0
s_nop 0
T a[96:97],v23,32768
T a[98:99],v23,34816
M v[96:99],a[68:71],v[144:147],v[96:99]
T a[100:101],v23,36864
T a[102:103],v23,38912
M v[96:99],a[72:75],v[160:163],v[96:99]
MF v80,v5,v80
MF v81,v5,v81
M v[96:99],a[76:79],v[176:179],v[96:99]
T a[104:105],v23,40960
T a[106:107],v23,43008
M v[96:99],a[80:83],v[192:195],v[96:99]
T a[108:109],v23,45056
T a[110:111],v23,47104
M v[96:99],a[84:87],v[208:211],v[96:99]
MF v82,v5,v82
MF v83,v5,v83
M v[96:99],a[88:91],v[224:227],v[96:99]
T a[112:113],v23,49152
T a[114:115],v23,51200
M v[96:99],a[92:95],v[240:243],v[96:99]
T a[116:117],v23,53248
T a[118:119],v23,55296
M v[100:103],a[92:95],v[244:247],0
MF v88,v5,v88
MF v89,v5,v89
M v[100:103],a[88:91],v[228:231],v[100:103]
T a[120:121],v23,57344
T a[122:123],v23,59392
M v[100:103],a[84:87],v[212:215],v[100:103]
T a[124:125],v23,61440
T a[126:127],v23,63488
M v[100:103],a[80:83],v[196:199],v[100:103]
MF v90,v5,v90
MF v91,v5,v91
M v[100:103],a[76:79],v[180:183],v[100:103]
C v80,v80,v81
C v81,v82,v83
M v[100:103],a[72:75],v[164:167],v[100:103]
C v82,v88,v89
C v83,v90,v91
M v[100:103],a[68:71],v[148:151],v[100:103]
buffer_store_dwordx4 v[80:83], v7, s[8:11], s29 offen offset:1024 sc1
M v[100:103],a[64:67],v[132:135],v[100:103]
s_waitcnt lgkmcnt(0)
MF v84,v6,v84
MF v85,v6,v85
M v[104:107],a[96:99],v[128:131],0
T a[64:65],v24,32768
T a[66:67],v24,34816
M v[104:107],a[100:103],v[144:147],v[104:107]
T a[68:69],v24,36864
T a[70:71],v24,38912
M v[104:107],a[104:107],v[160:163],v[104:107]
MF v86,v6,v86
MF v87,v6,v87
M v[104:107],a[108:111],v[176:179],v[104:107]
T a[72:73],v24,40960
T a[74:75],v24,43008
M v[104:107],a[112:115],v[192:195],v[104:107]
T a[76:77],v24,45056
T a[78:79],v24,47104
M v[104:107],a[116:119],v[208:211],v[104:107]
MF v92,v6,v92
MF v93,v6,v93
M v[104:107],a[120:123],v[224:227],v[104:107]
T a[80:81],v24,49152
T a[82:83],v24,51200
M v[104:107],a[124:127],v[240:243],v[104:107]
T a[84:85],v24,53248
T a[86:87],v24,55296
M v[108:111],a[124:127],v[244:247],0
MF v94,v6,v94
MF v95,v6,v95
M v[108:111],a[120:123],v[228:231],v[108:111]
T a[88:89],v24,57344
T a[90:91],v24,59392
M v[108:111],a[116:119],v[212:215],v[108:111]
T a[92:93],v24,61440
T a[94:95],v24,63488
M v[108:111],a[112:115],v[196:199],v[108:111]
C v84,v84,v85
C v85,v86,v87
M v[108:111],a[108:111],v[180:183],v[108:111]
C v86,v92,v93
C v87,v94,v95
M v[108:111],a[104:107],v[164:167],v[108:111]
buffer_store_dwordx4 v[84:87], v7, s[8:11], s30 offen offset:1024 sc1
M v[108:111],a[100:103],v[148:151],v[108:111]
SA s29,s33,10240
M v[108:111],a[96:99],v[132:135],v[108:111]
s_waitcnt lgkmcnt(0)
M v[112:115],a[64:67],v[128:131],0
SA s30,s33,24576
T a[96:97],v25,32768
T a[98:99],v25,34816
M v[112:115],a[68:71],v[144:147],v[112:115]
T a[100:101],v25,36864
T a[102:103],v25,38912
M v[112:115],a[72:75],v[160:163],v[112:115]
MF v96,v5,v96
MF v97,v5,v97
M v[112:115],a[76:79],v[176:179],v[112:115]
T a[104:105],v25,40960
T a[106:107],v25,43008
M v[112:115],a[80:83],v[192:195],v[112:115]
T a[108:109],v25,45056
T a[110:111],v25,47104
M v[112:115],a[84:87],v[208:211],v[112:115]
MF v98,v5,v98
MF v99,v5,v99
M v[112:115],a[88:91],v[224:227],v[112:115]
T a[112:113],v25,49152
T a[114:115],v25,51200
M v[112:115],a[92:95],v[240:243],v[112:115]
T a[116:117],v25,53248
T a[118:119],v25,55296
M v[116:119],a[92:95],v[244:247],0
s_cmp_lt_u32 s42, 8
MF v104,v5,v104
MF v105,v5,v105
M v[116:119],a[88:91],v[228:231],v[116:119]
s_cselect_b32 s84, s45, 536870912
T a[120:121],v25,57344
T a[122:123],v25,59392
M v[116:119],a[84:87],v[212:215],v[116:119]
T a[124:125],v25,61440
T a[126:127],v25,63488
M v[116:119],a[80:83],v[196:199],v[116:119]
MF v106,v5,v106
MF v107,v5,v107
M v[116:119],a[76:79],v[180:183],v[116:119]
C v96,v96,v97
C v97,v98,v99
M v[116:119],a[72:75],v[164:167],v[116:119]
C v98,v104,v105
C v99,v106,v107
M v[116:119],a[68:71],v[148:151],v[116:119]
s_waitcnt lgkmcnt(0)
buffer_store_dwordx4 v[96:99], v7, s[8:11], s29 offen offset:0 sc1
M v[116:119],a[64:67],v[132:135],v[116:119]
s_barrier
M v[120:123],a[96:99],v[128:131],0
s_nop 0
T a[64:65],v18,32768
T a[66:67],v18,34816
M v[120:123],a[100:103],v[144:147],v[120:123]
T a[68:69],v18,36864
T a[70:71],v18,38912
M v[120:123],a[104:107],v[160:163],v[120:123]
MF v100,v6,v100
MF v101,v6,v101
M v[120:123],a[108:111],v[176:179],v[120:123]
T a[72:73],v18,40960
T a[74:75],v18,43008
M v[120:123],a[112:115],v[192:195],v[120:123]
s_waitcnt vmcnt(9)
T a[76:77],v18,45056
T a[78:79],v18,47104
M v[120:123],a[116:119],v[208:211],v[120:123]
buffer_store_dword v15, v17, s[8:11], s84 offen sc1
M v[120:123],a[120:123],v[224:227],v[120:123]
s_nop 0
T a[80:81],v18,49152
T a[82:83],v18,51200
M v[120:123],a[124:127],v[240:243],v[120:123]
T a[84:85],v18,53248
T a[86:87],v18,55296
M v[124:127],a[124:127],v[244:247],0
MF v102,v6,v102
MF v103,v6,v103
M v[124:127],a[120:123],v[228:231],v[124:127]
T a[88:89],v18,57344
T a[90:91],v18,59392
M v[124:127],a[116:119],v[212:215],v[124:127]
T a[92:93],v18,61440
T a[94:95],v18,63488
M v[124:127],a[112:115],v[196:199],v[124:127]
MF v108,v6,v108
MF v109,v6,v109
M v[124:127],a[108:111],v[180:183],v[124:127]
MF v110,v6,v110
MF v111,v6,v111
M v[124:127],a[104:107],v[164:167],v[124:127]
C v100,v100,v101
C v101,v102,v103
M v[124:127],a[100:103],v[148:151],v[124:127]
s_waitcnt lgkmcnt(0)
C v102,v108,v109
C v103,v110,v111
M v[124:127],a[96:99],v[132:135],v[124:127]
buffer_store_dwordx4 v[100:103], v7, s[8:11], s30 offen offset:0 sc1
M v[64:67],a[64:67],v[128:131],0
s_nop 0
T a[96:97],v19,32768
T a[98:99],v19,34816
M v[64:67],a[68:71],v[144:147],v[64:67]
T a[100:101],v19,36864
T a[102:103],v19,38912
M v[64:67],a[72:75],v[160:163],v[64:67]
MF v112,v5,v112
MF v113,v5,v113
M v[64:67],a[76:79],v[176:179],v[64:67]
T a[104:105],v19,40960
T a[106:107],v19,43008
M v[64:67],a[80:83],v[192:195],v[64:67]
T a[108:109],v19,45056
T a[110:111],v19,47104
M v[64:67],a[84:87],v[208:211],v[64:67]
MF v114,v5,v114
MF v115,v5,v115
M v[64:67],a[88:91],v[224:227],v[64:67]
T a[112:113],v19,49152
T a[114:115],v19,51200
M v[64:67],a[92:95],v[240:243],v[64:67]
T a[116:117],v19,53248
T a[118:119],v19,55296
M v[68:71],a[92:95],v[244:247],0
MF v120,v5,v120
MF v121,v5,v121
M v[68:71],a[88:91],v[228:231],v[68:71]
T a[120:121],v19,57344
T a[122:123],v19,59392
M v[68:71],a[84:87],v[212:215],v[68:71]
T a[124:125],v19,61440
T a[126:127],v19,63488
M v[68:71],a[80:83],v[196:199],v[68:71]
MF v122,v5,v122
MF v123,v5,v123
M v[68:71],a[76:79],v[180:183],v[68:71]
C v112,v112,v113
C v113,v114,v115
M v[68:71],a[72:75],v[164:167],v[68:71]
C v114,v120,v121
C v115,v122,v123
M v[68:71],a[68:71],v[148:151],v[68:71]
buffer_store_dwordx4 v[112:115], v7, s[8:11], s29 offen offset:1024 sc1
M v[68:71],a[64:67],v[132:135],v[68:71]
s_waitcnt lgkmcnt(0)
MF v116,v6,v116
MF v117,v6,v117
M v[72:75],a[96:99],v[128:131],0
T a[64:65],v20,32768
T a[66:67],v20,34816
M v[72:75],a[100:103],v[144:147],v[72:75]
T a[68:69],v20,36864
T a[70:71],v20,38912
M v[72:75],a[104:107],v[160:163],v[72:75]
MF v118,v6,v118
MF v119,v6,v119
M v[72:75],a[108:111],v[176:179],v[72:75]
T a[72:73],v20,40960
T a[74:75],v20,43008
M v[72:75],a[112:115],v[192:195],v[72:75]
T a[76:77],v20,45056
T a[78:79],v20,47104
M v[72:75],a[116:119],v[208:211],v[72:75]
MF v124,v6,v124
MF v125,v6,v125
M v[72:75],a[120:123],v[224:227],v[72:75]
T a[80:81],v20,49152
T a[82:83],v20,51200
M v[72:75],a[124:127],v[240:243],v[72:75]
T a[84:85],v20,53248
T a[86:87],v20,55296
M v[76:79],a[124:127],v[244:247],0
MF v126,v6,v126
MF v127,v6,v127
M v[76:79],a[120:123],v[228:231],v[76:79]
T a[88:89],v20,57344
T a[90:91],v20,59392
M v[76:79],a[116:119],v[212:215],v[76:79]
T a[92:93],v20,61440
T a[94:95],v20,63488
M v[76:79],a[112:115],v[196:199],v[76:79]
C v116,v116,v117
C v117,v118,v119
M v[76:79],a[108:111],v[180:183],v[76:79]
C v118,v124,v125
C v119,v126,v127
M v[76:79],a[104:107],v[164:167],v[76:79]
buffer_store_dwordx4 v[116:119], v7, s[8:11], s30 offen offset:1024 sc1
M v[76:79],a[100:103],v[148:151],v[76:79]
SA s29,s33,12288
s_waitcnt vmcnt(12)
v_readlane_b32 s92, v31, 0
v_readlane_b32 s94, v31, 1
M v[76:79],a[96:99],v[132:135],v[76:79]
s_waitcnt lgkmcnt(0)
s_waitcnt vmcnt(9)
v_sub_f32 v30, 1.0, v26
s_waitcnt vmcnt(7)
v_lshlrev_b32 v48, 16, v44
M v[80:83],a[64:67],v[128:131],0
SA s30,s33,26624
T a[96:97],v21,32768
T a[98:99],v21,34816
M v[80:83],a[68:71],v[144:147],v[80:83]
T a[100:101],v21,36864
T a[102:103],v21,38912
M v[80:83],a[72:75],v[160:163],v[80:83]
v_and_b32 v49, 0xffff0000, v44
v_lshlrev_b32 v50, 16, v45
M v[80:83],a[76:79],v[176:179],v[80:83]
T a[104:105],v21,40960
T a[106:107],v21,43008
M v[80:83],a[80:83],v[192:195],v[80:83]
T a[108:109],v21,45056
T a[110:111],v21,47104
M v[80:83],a[84:87],v[208:211],v[80:83]
MF v64,v5,v64
MF v65,v5,v65
M v[80:83],a[88:91],v[224:227],v[80:83]
T a[112:113],v21,49152
T a[114:115],v21,51200
M v[80:83],a[92:95],v[240:243],v[80:83]
T a[116:117],v21,53248
T a[118:119],v21,55296
M v[84:87],a[92:95],v[244:247],0
MF v66,v5,v66
MF v67,v5,v67
M v[84:87],a[88:91],v[228:231],v[84:87]
T a[120:121],v21,57344
T a[122:123],v21,59392
M v[84:87],a[84:87],v[212:215],v[84:87]
T a[124:125],v21,61440
T a[126:127],v21,63488
M v[84:87],a[80:83],v[196:199],v[84:87]
MF v72,v5,v72
MF v73,v5,v73
M v[84:87],a[76:79],v[180:183],v[84:87]
MF v74,v5,v74
MF v75,v5,v75
M v[84:87],a[72:75],v[164:167],v[84:87]
C v64,v64,v65
C v65,v66,v67
M v[84:87],a[68:71],v[148:151],v[84:87]
C v66,v72,v73
C v67,v74,v75
M v[84:87],a[64:67],v[132:135],v[84:87]
s_waitcnt lgkmcnt(0)
buffer_store_dwordx4 v[64:67], v7, s[8:11], s29 offen offset:0 sc1
M v[88:91],a[96:99],v[128:131],0
v_and_b32 v51, 0xffff0000, v45
v_lshlrev_b32 v52, 16, v46
M v[88:91],a[100:103],v[144:147],v[88:91]
MF v68,v6,v68
MF v69,v6,v69
M v[88:91],a[104:107],v[160:163],v[88:91]
MF v70,v6,v70
MF v71,v6,v71
M v[88:91],a[108:111],v[176:179],v[88:91]
MF v76,v6,v76
MF v77,v6,v77
M v[88:91],a[112:115],v[192:195],v[88:91]
MF v78,v6,v78
MF v79,v6,v79
M v[88:91],a[116:119],v[208:211],v[88:91]
C v68,v68,v69
C v69,v70,v71
M v[88:91],a[120:123],v[224:227],v[88:91]
C v70,v76,v77
C v71,v78,v79
M v[88:91],a[124:127],v[240:243],v[88:91]
buffer_store_dwordx4 v[68:71], v7, s[8:11], s30 offen offset:0 sc1
M v[92:95],a[124:127],v[244:247],0
v_and_b32 v53, 0xffff0000, v46
v_lshlrev_b32 v54, 16, v47
M v[92:95],a[120:123],v[228:231],v[92:95]
v_and_b32 v55, 0xffff0000, v47
v_cmp_eq_u32 s[80:81], s92, v29
M v[92:95],a[116:119],v[212:215],v[92:95]
v_cmp_eq_u32 s[82:83], s94, v29
M v[92:95],a[112:115],v[196:199],v[92:95]
MF v80,v5,v80
MF v81,v5,v81
M v[92:95],a[108:111],v[180:183],v[92:95]
MF v82,v5,v82
MF v83,v5,v83
M v[92:95],a[104:107],v[164:167],v[92:95]
MF v88,v5,v88
MF v89,v5,v89
M v[92:95],a[100:103],v[148:151],v[92:95]
MF v90,v5,v90
MF v91,v5,v91
M v[92:95],a[96:99],v[132:135],v[92:95]
C v80,v80,v81
C v81,v82,v83
C v82,v88,v89
C v83,v90,v91
buffer_store_dwordx4 v[80:83], v7, s[8:11], s29 offen offset:1024 sc1
MF v84,v6,v84
MF v85,v6,v85
MF v86,v6,v86
MF v87,v6,v87
MF v92,v6,v92
MF v93,v6,v93
MF v94,v6,v94
MF v95,v6,v95
C v84,v84,v85
C v85,v86,v87
C v86,v92,v93
C v87,v94,v95
buffer_store_dwordx4 v[84:87], v7, s[8:11], s30 offen offset:1024 sc1
buffer_load_dword v9, v33, s[8:11], s46 offen sc1
s_waitcnt vmcnt(1)
buffer_store_dword v15, v16, s[8:11], s3 offen sc1
s_cmp_lt_u32 s42, 8
s_cbranch_scc1 L_red
s_waitcnt vmcnt(1)
v_cmp_eq_u32 vcc, 1, v9
s_mov_b32 s91, 65536
s_lshl_b32 s70, 1, s41
s_mov_b32 s69, 0xffff
s_or_b32 s70, s70, vcc_lo
s_mov_b32 s68, s70
s_barrier
s_cmp_lg_u32 s70, 0
s_cbranch_scc1 L_vk0
s_call_b64 s[36:37], L_rpoll
L_vk0:
s_ff1_i32_b32 s71, s70
s_bitset0_b32 s70, s71
s_mul_i32 s71, s71, 114688
SA s16,s71,s78
buffer_load_dwordx4 v[128:131], v27, s[8:11], s16 offen sc1
s_cmp_lg_u32 s70, 0
s_cbranch_scc1 L_vk1
s_call_b64 s[36:37], L_rpoll
L_vk1:
s_ff1_i32_b32 s71, s70
s_bitset0_b32 s70, s71
s_mul_i32 s71, s71, 114688
SA s17,s71,s78
buffer_load_dwordx4 v[132:135], v27, s[8:11], s17 offen sc1
s_cmp_lg_u32 s70, 0
s_cbranch_scc1 L_vk2
s_call_b64 s[36:37], L_rpoll
L_vk2:
s_ff1_i32_b32 s71, s70
s_bitset0_b32 s70, s71
s_mul_i32 s71, s71, 114688
SA s18,s71,s78
buffer_load_dwordx4 v[136:139], v27, s[8:11], s18 offen sc1
s_cmp_lg_u32 s70, 0
s_cbranch_scc1 L_vk3
s_call_b64 s[36:37], L_rpoll
L_vk3:
s_ff1_i32_b32 s71, s70
s_bitset0_b32 s70, s71
s_mul_i32 s71, s71, 114688
SA s19,s71,s78
buffer_load_dwordx4 v[140:143], v27, s[8:11], s19 offen sc1
s_cmp_lg_u32 s70, 0
s_cbranch_scc1 L_vk4
s_call_b64 s[36:37], L_rpoll
L_vk4:
s_ff1_i32_b32 s71, s70
s_bitset0_b32 s70, s71
s_mul_i32 s71, s71, 114688
SA s48,s71,s78
buffer_load_dwordx4 v[144:147], v27, s[8:11], s48 offen sc1
s_cmp_lg_u32 s70, 0
s_cbranch_scc1 L_vk5
s_call_b64 s[36:37], L_rpoll
L_vk5:
s_ff1_i32_b32 s71, s70
s_bitset0_b32 s70, s71
s_mul_i32 s71, s71, 114688
SA s49,s71,s78
buffer_load_dwordx4 v[148:151], v27, s[8:11], s49 offen sc1
s_cmp_lg_u32 s70, 0
s_cbranch_scc1 L_vk6
s_call_b64 s[36:37], L_rpoll
L_vk6:
s_ff1_i32_b32 s71, s70
s_bitset0_b32 s70, s71
s_mul_i32 s71, s71, 114688
SA s50,s71,s78
buffer_load_dwordx4 v[152:155], v27, s[8:11], s50 offen sc1
s_cmp_lg_u32 s70, 0
s_cbranch_scc1 L_vk7
s_call_b64 s[36:37], L_rpoll
L_vk7:
s_ff1_i32_b32 s71, s70
s_bitset0_b32 s70, s71
s_mul_i32 s71, s71, 114688
SA s51,s71,s78
buffer_load_dwordx4 v[156:159], v27, s[8:11], s51 offen sc1
s_or_b64 vcc, s[80:81], s[82:83]
s_cbranch_vccnz L_moe2
L_moe_ret2:
MF v48,v30,v48
MF v49,v30,v49
MF v50,v30,v50
MF v51,v30,v51
MF v52,v30,v52
MF v53,v30,v53
MF v54,v30,v54
MF v55,v30,v55
s_cmp_lg_u32 s70, 0
s_cbranch_scc1 L_vk8
s_call_b64 s[36:37], L_rpoll
L_vk8:
s_ff1_i32_b32 s71, s70
s_bitset0_b32 s70, s71
s_mul_i32 s71, s71, 114688
SA s21,s71,s78
buffer_load_dwordx4 v[160:163], v27, s[8:11], s21 offen sc1
s_waitcnt vmcnt(8)
M v[56:59],a[246:249],v[128:131],0
M v[60:63],a[244:247],v[128:131],0
s_cmp_lg_u32 s70, 0
s_cbranch_scc1 L_vk9
s_call_b64 s[36:37], L_rpoll
L_vk9:
s_ff1_i32_b32 s71, s70
s_bitset0_b32 s70, s71
s_mul_i32 s71, s71, 114688
SA s22,s71,s78
buffer_load_dwordx4 v[164:167], v27, s[8:11], s22 offen sc1
s_waitcnt vmcnt(8)
M v[56:59],a[246:249],v[132:135],v[56:59]
M v[60:63],a[244:247],v[132:135],v[60:63]
s_cmp_lg_u32 s70, 0
s_cbranch_scc1 L_vk10
s_call_b64 s[36:37], L_rpoll
L_vk10:
s_ff1_i32_b32 s71, s70
s_bitset0_b32 s70, s71
s_mul_i32 s71, s71, 114688
SA s23,s71,s78
buffer_load_dwordx4 v[168:171], v27, s[8:11], s23 offen sc1
s_waitcnt vmcnt(8)
M v[56:59],a[246:249],v[136:139],v[56:59]
M v[60:63],a[244:247],v[136:139],v[60:63]
s_cmp_lg_u32 s70, 0
s_cbranch_scc1 L_vk11
s_call_b64 s[36:37], L_rpoll
L_vk11:
s_ff1_i32_b32 s71, s70
s_bitset0_b32 s70, s71
s_mul_i32 s71, s71, 114688
SA s24,s71,s78
buffer_load_dwordx4 v[172:175], v27, s[8:11], s24 offen sc1
s_waitcnt vmcnt(8)
M v[56:59],a[246:249],v[140:143],v[56:59]
M v[60:63],a[244:247],v[140:143],v[60:63]
s_cmp_lg_u32 s70, 0
s_cbranch_scc1 L_vk12
s_call_b64 s[36:37], L_rpoll
L_vk12:
s_ff1_i32_b32 s71, s70
s_bitset0_b32 s70, s71
s_mul_i32 s71, s71, 114688
SA s25,s71,s78
buffer_load_dwordx4 v[176:179], v27, s[8:11], s25 offen sc1
s_waitcnt vmcnt(8)
M v[56:59],a[246:249],v[144:147],v[56:59]
M v[60:63],a[244:247],v[144:147],v[60:63]
s_cmp_lg_u32 s70, 0
s_cbranch_scc1 L_vk13
s_call_b64 s[36:37], L_rpoll
L_vk13:
s_ff1_i32_b32 s71, s70
s_bitset0_b32 s70, s71
s_mul_i32 s71, s71, 114688
SA s26,s71,s78
buffer_load_dwordx4 v[180:183], v27, s[8:11], s26 offen sc1
s_waitcnt vmcnt(8)
M v[56:59],a[246:249],v[148:151],v[56:59]
M v[60:63],a[244:247],v[148:151],v[60:63]
s_cmp_lg_u32 s70, 0
s_cbranch_scc1 L_vk14
s_call_b64 s[36:37], L_rpoll
L_vk14:
s_ff1_i32_b32 s71, s70
s_bitset0_b32 s70, s71
s_mul_i32 s71, s71, 114688
SA s27,s71,s78
buffer_load_dwordx4 v[184:187], v27, s[8:11], s27 offen sc1
s_waitcnt vmcnt(8)
M v[56:59],a[246:249],v[152:155],v[56:59]
M v[60:63],a[244:247],v[152:155],v[60:63]
s_cmp_lg_u32 s70, 0
s_cbranch_scc1 L_vk15
s_call_b64 s[36:37], L_rpoll
L_vk15:
s_ff1_i32_b32 s71, s70
s_bitset0_b32 s70, s71
s_mul_i32 s71, s71, 114688
SA s28,s71,s78
buffer_load_dwordx4 v[188:191], v27, s[8:11], s28 offen sc1
s_waitcnt vmcnt(8)
M v[56:59],a[246:249],v[156:159],v[56:59]
M v[60:63],a[244:247],v[156:159],v[60:63]
s_waitcnt vmcnt(7)
M v[56:59],a[246:249],v[160:163],v[56:59]
M v[60:63],a[244:247],v[160:163],v[60:63]
s_waitcnt vmcnt(6)
M v[56:59],a[246:249],v[164:167],v[56:59]
M v[60:63],a[244:247],v[164:167],v[60:63]
s_waitcnt vmcnt(5)
M v[56:59],a[246:249],v[168:171],v[56:59]
M v[60:63],a[244:247],v[168:171],v[60:63]
s_waitcnt vmcnt(4)
M v[56:59],a[246:249],v[172:175],v[56:59]
M v[60:63],a[244:247],v[172:175],v[60:63]
s_waitcnt vmcnt(3)
M v[56:59],a[246:249],v[176:179],v[56:59]
M v[60:63],a[244:247],v[176:179],v[60:63]
s_waitcnt vmcnt(2)
M v[56:59],a[246:249],v[180:183],v[56:59]
M v[60:63],a[244:247],v[180:183],v[60:63]
s_waitcnt vmcnt(1)
M v[56:59],a[246:249],v[184:187],v[56:59]
M v[60:63],a[244:247],v[184:187],v[60:63]
s_waitcnt vmcnt(0)
M v[56:59],a[246:249],v[188:191],v[56:59]
M v[60:63],a[244:247],v[188:191],v[60:63]
s_nop 7
v_permlane16_swap_b32 v56, v60
v_permlane16_swap_b32 v57, v61
v_permlane16_swap_b32 v58, v62
v_permlane16_swap_b32 v59, v63
v_fmac_f32 v48, v26, v56
v_fmac_f32 v49, v26, v57
v_fmac_f32 v50, v26, v58
v_fmac_f32 v51, v26, v59
v_fmac_f32 v52, v26, v60
v_fmac_f32 v53, v26, v61
v_fmac_f32 v54, v26, v62
v_fmac_f32 v55, v26, v63
C v44,v48,v49
C v45,v50,v51
C v46,v52,v53
C v47,v54,v55
buffer_store_dwordx4 v[44:47], v28, s[52:55], s79 offen sc1
s_endpgm
L_d2h:
M v[128:131],a[64:67],v[48:51],v[128:131]
R a[96:99],v7,40960
R a[100:103],v7,41984
M v[128:131],a[68:71],v[56:59],v[128:131]
SA m0,s28,135168
E v18,v64
M v[132:135],a[68:71],v[60:63],v[132:135]
buffer_load_dwordx4 v4, s[8:11], s26 offen offset:0 sc1 lds
M v[132:135],a[64:67],v[52:55],v[132:135]
R a[104:107],v7,43008
R a[108:111],v7,44032
M v[136:139],a[72:75],v[48:51],v[136:139]
s_cmp_gt_u32 s20, 3
E v19,v65
M v[136:139],a[76:79],v[56:59],v[136:139]
s_cselect_b64 s[82:83], -1, 0
AF v30,v28,v30
AF v31,v29,v31
M v[140:143],a[76:79],v[60:63],v[140:143]
s_cmp_eq_u32 s20, 3
R a[112:115],v7,45056
R a[116:119],v7,46080
M v[140:143],a[72:75],v[52:55],v[140:143]
s_cselect_b64 s[66:67], s[16:17], s[82:83]
buffer_load_dwordx4 v4, s[8:11], s26 offen offset:1024 sc1 lds
M v[144:147],a[80:83],v[48:51],v[144:147]
s_cselect_b64 s[68:69], s[18:19], s[82:83]
E v20,v66
M v[144:147],a[84:87],v[56:59],v[144:147]
s_cselect_b64 s[70:71], s[48:49], s[82:83]
R a[120:123],v7,47104
R a[124:127],v7,48128
M v[148:151],a[84:87],v[60:63],v[148:151]
s_cselect_b64 s[72:73], s[50:51], s[82:83]
v_cndmask_b32 v100, v36, v8, s[66:67]
v_cndmask_b32 v101, v36, v8, s[68:69]
M v[148:151],a[80:83],v[52:55],v[148:151]
buffer_load_dwordx4 v4, s[8:11], s26 offen offset:2048 sc1 lds
M v[152:155],a[88:91],v[48:51],v[152:155]
v_cndmask_b32 v102, v36, v8, s[70:71]
AF v26,v18,v19
M v[152:155],a[92:95],v[56:59],v[152:155]
E v21,v67
M v[156:159],a[92:95],v[60:63],v[156:159]
v_cndmask_b32 v103, v36, v8, s[72:73]
C v40,v18,v19
M v[156:159],a[88:91],v[52:55],v[156:159]
s_waitcnt lgkmcnt(0)
buffer_load_dwordx4 v4, s[8:11], s26 offen offset:3072 sc1 lds
M v[160:163],a[96:99],v[48:51],v[160:163]
s_cmp_gt_u32 s20, 2
R a[64:67],v7,49152
R a[68:71],v7,50176
M v[160:163],a[100:103],v[56:59],v[160:163]
s_cselect_b64 s[82:83], -1, 0
E v22,v72
M v[164:167],a[100:103],v[60:63],v[164:167]
s_cmp_eq_u32 s20, 2
AF v26,v20,v26
C v41,v20,v21
M v[164:167],a[96:99],v[52:55],v[164:167]
s_mul_i32 s21, s41, 1048576
R a[72:75],v7,51200
R a[76:79],v7,52224
M v[168:171],a[104:107],v[48:51],v[168:171]
s_cselect_b64 s[74:75], s[16:17], s[82:83]
E v23,v73
M v[168:171],a[108:111],v[56:59],v[168:171]
s_cselect_b64 s[76:77], s[18:19], s[82:83]
AF v26,v21,v26
AF v26,v22,v26
M v[172:175],a[108:111],v[60:63],v[172:175]
s_cselect_b64 s[78:79], s[48:49], s[82:83]
R a[80:83],v7,53248
R a[84:87],v7,54272
M v[172:175],a[104:107],v[52:55],v[172:175]
s_cselect_b64 s[80:81], s[50:51], s[82:83]
v_cndmask_b32 v108, v36, v8, s[74:75]
v_cndmask_b32 v109, v36, v8, s[76:77]
M v[176:179],a[112:115],v[48:51],v[176:179]
SA s21,s21,589824
E v24,v74
M v[176:179],a[116:119],v[56:59],v[176:179]
s_lshl_b32 s84, s42, 1
R a[88:91],v7,55296
R a[92:95],v7,56320
M v[180:183],a[116:119],v[60:63],v[180:183]
s_sub_u32 s22, 11, s84
v_cndmask_b32 v110, v36, v8, s[78:79]
C v42,v22,v23
M v[180:183],a[112:115],v[52:55],v[180:183]
s_mov_b32 s23, 536870912
s_waitcnt vmcnt(16)
v_cmp_gt_u32 vcc, 2, v5
AF v26,v23,v26
M v[184:187],a[120:123],v[48:51],v[184:187]
s_cbranch_vccnz L_lsh2
L_lrh2:
v_cndmask_b32 v111, v36, v8, s[80:81]
M v[184:187],a[124:127],v[56:59],v[184:187]
SA m0,s28,98304
E v25,v75
M v[188:191],a[124:127],v[60:63],v[188:191]
s_cmp_gt_u32 s20, 1
buffer_load_dwordx4 v3, s[8:11], s21 offen offset:0 sc1 lds
M v[188:191],a[120:123],v[52:55],v[188:191]
s_waitcnt lgkmcnt(0)
E v18,v68
M v[192:195],a[64:67],v[48:51],v[192:195]
s_cselect_b64 s[82:83], -1, 0
R a[96:99],v7,57344
R a[100:103],v7,58368
M v[192:195],a[68:71],v[56:59],v[192:195]
s_cmp_eq_u32 s20, 1
buffer_load_dwordx4 v3, s[8:11], s21 offen offset:1024 sc1 lds
M v[196:199],a[68:71],v[60:63],v[196:199]
s_cselect_b64 s[66:67], s[16:17], s[82:83]
E v19,v69
M v[196:199],a[64:67],v[52:55],v[196:199]
s_cselect_b64 s[68:69], s[18:19], s[82:83]
R a[104:107],v7,59392
R a[108:111],v7,60416
M v[200:203],a[72:75],v[48:51],v[200:203]
s_cselect_b64 s[70:71], s[48:49], s[82:83]
buffer_load_dwordx4 v3, s[8:11], s21 offen offset:2048 sc1 lds
M v[200:203],a[76:79],v[56:59],v[200:203]
s_cselect_b64 s[72:73], s[50:51], s[82:83]
v_cndmask_b32 v116, v36, v8, s[66:67]
v_cndmask_b32 v117, v36, v8, s[68:69]
M v[204:207],a[76:79],v[60:63],v[204:207]
R a[112:115],v7,61440
R a[116:119],v7,62464
M v[204:207],a[72:75],v[52:55],v[204:207]
v_cndmask_b32 v118, v36, v8, s[70:71]
AF v26,v24,v26
M v[208:211],a[80:83],v[48:51],v[208:211]
buffer_load_dwordx4 v3, s[8:11], s21 offen offset:3072 sc1 lds
M v[208:211],a[84:87],v[56:59],v[208:211]
SA m0,s28,102400
R a[120:123],v7,63488
R a[124:127],v7,64512
M v[212:215],a[84:87],v[60:63],v[212:215]
v_cndmask_b32 v119, v36, v8, s[72:73]
C v43,v24,v25
M v[212:215],a[80:83],v[52:55],v[212:215]
s_cmp_gt_u32 s20, 0
E v20,v70
M v[216:219],a[88:91],v[48:51],v[216:219]
s_cselect_b64 s[82:83], -1, 0
buffer_load_dwordx4 v4, s[8:11], s21 offen offset:0 sc1 lds
M v[216:219],a[92:95],v[56:59],v[216:219]
s_cmp_eq_u32 s20, 0
E v21,v71
M v[220:223],a[92:95],v[60:63],v[220:223]
s_waitcnt lgkmcnt(0)
E v22,v76
M v[220:223],a[88:91],v[52:55],v[220:223]
s_barrier
M v[224:227],a[96:99],v[48:51],v[224:227]
s_cselect_b64 s[74:75], s[16:17], s[82:83]
R a[64:67],v2,0
R a[68:71],v2,1024
M v[224:227],a[100:103],v[56:59],v[224:227]
s_cselect_b64 s[76:77], s[18:19], s[82:83]
buffer_load_dwordx4 v4, s[8:11], s21 offen offset:1024 sc1 lds
M v[228:231],a[100:103],v[60:63],v[228:231]
s_cselect_b64 s[78:79], s[48:49], s[82:83]
E v23,v77
M v[228:231],a[96:99],v[52:55],v[228:231]
s_cselect_b64 s[80:81], s[50:51], s[82:83]
R a[72:75],v2,2048
R a[76:79],v2,3072
M v[232:235],a[104:107],v[48:51],v[232:235]
v_cndmask_b32 v124, v36, v8, s[74:75]
v_cndmask_b32 v125, v36, v8, s[76:77]
M v[232:235],a[108:111],v[56:59],v[232:235]
buffer_load_dwordx4 v4, s[8:11], s21 offen offset:2048 sc1 lds
M v[236:239],a[108:111],v[60:63],v[236:239]
R a[80:83],v2,4096
R a[84:87],v2,5120
M v[236:239],a[104:107],v[52:55],v[236:239]
v_cndmask_b32 v126, v36, v8, s[78:79]
AF v26,v25,v26
M v[240:243],a[112:115],v[48:51],v[240:243]
v_cndmask_b32 v127, v36, v8, s[80:81]
AF v27,v18,v19
M v[240:243],a[116:119],v[56:59],v[240:243]
R a[88:91],v2,6144
R a[92:95],v2,7168
M v[244:247],a[116:119],v[60:63],v[244:247]
buffer_load_dwordx4 v4, s[8:11], s21 offen offset:3072 sc1 lds
M v[244:247],a[112:115],v[52:55],v[244:247]
SA s21,s21,32768
E v24,v78
M v[248:251],a[120:123],v[48:51],v[248:251]
s_sub_u32 s22, s22, 1
E v25,v79
M v[248:251],a[124:127],v[56:59],v[248:251]
s_cselect_b32 s21, s23, s21
C v44,v18,v19
AF v27,v20,v27
M v[252:255],a[124:127],v[60:63],v[252:255]
s_waitcnt lgkmcnt(0)
C v45,v20,v21
AF v27,v21,v27
M v[252:255],a[120:123],v[52:55],v[252:255]
AF v27,v22,v27
C v46,v22,v23
AF v27,v23,v27
AF v27,v24,v27
C v47,v24,v25
AF v27,v25,v27
L_d3h:
M v[100:103],a[64:67],a[32:35],v[100:103]
R a[96:99],v2,8192
R a[100:103],v2,9216
M v[100:103],a[68:71],a[36:39],v[100:103]
R a[104:107],v2,10240
R a[108:111],v2,11264
M v[100:103],a[72:75],a[40:43],v[100:103]
R a[112:115],v2,12288
R a[116:119],v2,13312
M v[100:103],a[76:79],a[44:47],v[100:103]
R a[120:123],v2,14336
R a[124:127],v2,15360
M v[100:103],a[80:83],a[48:51],v[100:103]
v_add_u32 v8, 0x20000, v7
M v[100:103],a[84:87],a[52:55],v[100:103]
buffer_load_dword v5, v9, s[8:11], s46 offen sc1
M v[100:103],a[88:91],a[56:59],v[100:103]
buffer_load_dword v6, off, s[8:11], s47 offset:16 sc1
M v[100:103],a[92:95],a[60:63],v[100:103]
s_waitcnt lgkmcnt(0)
E v18,v80
M v[108:111],a[96:99],a[32:35],v[108:111]
R a[64:67],v2,16384
R a[68:71],v2,17408
M v[108:111],a[100:103],a[36:39],v[108:111]
R a[72:75],v2,18432
R a[76:79],v2,19456
M v[108:111],a[104:107],a[40:43],v[108:111]
R a[80:83],v2,20480
R a[84:87],v2,21504
M v[108:111],a[108:111],a[44:47],v[108:111]
R a[88:91],v2,22528
R a[92:95],v2,23552
M v[108:111],a[112:115],a[48:51],v[108:111]
E v19,v81
M v[108:111],a[116:119],a[52:55],v[108:111]
E v20,v82
M v[108:111],a[120:123],a[56:59],v[108:111]
E v21,v83
M v[108:111],a[124:127],a[60:63],v[108:111]
s_waitcnt lgkmcnt(0)
E v22,v88
M v[116:119],a[64:67],a[32:35],v[116:119]
R a[96:99],v2,24576
R a[100:103],v2,25600
M v[116:119],a[68:71],a[36:39],v[116:119]
R a[104:107],v2,26624
R a[108:111],v2,27648
M v[116:119],a[72:75],a[40:43],v[116:119]
R a[112:115],v2,28672
R a[116:119],v2,29696
M v[116:119],a[76:79],a[44:47],v[116:119]
R a[120:123],v2,30720
R a[124:127],v2,31744
M v[116:119],a[80:83],a[48:51],v[116:119]
E v23,v89
M v[116:119],a[84:87],a[52:55],v[116:119]
E v24,v90
M v[116:119],a[88:91],a[56:59],v[116:119]
s_waitcnt vmcnt(18) lgkmcnt(0)
E v25,v91
M v[116:119],a[92:95],a[60:63],v[116:119]
s_barrier
M v[124:127],a[96:99],a[32:35],v[124:127]
R a[64:67],v7,0
R a[68:71],v7,1024
M v[124:127],a[100:103],a[36:39],v[124:127]
R a[72:75],v7,2048
R a[76:79],v7,3072
M v[124:127],a[104:107],a[40:43],v[124:127]
R a[80:83],v7,4096
R a[84:87],v7,5120
M v[124:127],a[108:111],a[44:47],v[124:127]
R a[88:91],v7,6144
R a[92:95],v7,7168
M v[124:127],a[112:115],a[48:51],v[124:127]
AF v26,v18,v26
C v56,v18,v19
M v[124:127],a[116:119],a[52:55],v[124:127]
AF v26,v19,v26
AF v26,v20,v26
M v[124:127],a[120:123],a[56:59],v[124:127]
s_waitcnt lgkmcnt(0)
E v18,v84
M v[124:127],a[124:127],a[60:63],v[124:127]
E v19,v85
C v57,v20,v21
AF v26,v21,v26
AF v26,v22,v26
C v58,v22,v23
AF v26,v23,v26
AF v26,v24,v26
C v59,v24,v25
AF v26,v25,v26
E v20,v86
E v21,v87
AF v27,v18,v27
C v60,v18,v19
AF v27,v19,v27
E v22,v92
E v23,v93
AF v27,v20,v27
C v61,v20,v21
AF v27,v21,v27
E v24,v94
E v25,v95
AF v27,v22,v27
C v62,v22,v23
AF v27,v23,v27
AF v27,v24,v27
C v63,v24,v25
AF v27,v25,v27
v_max_f32 v10, v26, v27
v_cmp_lt_f32 vcc, s31, v10
s_nop 0
s_cbranch_vccnz L_std3h
L_rtd3h:
M v[128:131],a[64:67],v[40:43],v[128:131]
R a[96:99],v7,8192
R a[100:103],v7,9216
M v[128:131],a[68:71],v[56:59],v[128:131]
s_waitcnt vmcnt(0)
v_cmp_ne_u32 vcc, 1, v6
AF v30,v26,v30
M v[132:135],a[68:71],v[60:63],v[132:135]
s_cbranch_vccnz L_fqs
L_fqr:
E v18,v100
M v[132:135],a[64:67],v[44:47],v[132:135]
SA s73,s32,4096
R a[104:107],v7,10240
R a[108:111],v7,11264
M v[136:139],a[72:75],v[40:43],v[136:139]
SA s74,s32,8192
E v19,v101
M v[136:139],a[76:79],v[56:59],v[136:139]
SA s75,s32,12288
buffer_load_dwordx4 a[0:3], v7, s[8:11], s32 offen offset:0 sc1
M v[140:143],a[76:79],v[60:63],v[140:143]
R a[112:115],v7,12288
R a[116:119],v7,13312
M v[140:143],a[72:75],v[44:47],v[140:143]
E v20,v102
M v[144:147],a[80:83],v[40:43],v[144:147]
buffer_load_dwordx4 a[4:7], v7, s[8:11], s32 offen offset:1024 sc1
M v[144:147],a[84:87],v[56:59],v[144:147]
R a[120:123],v7,14336
R a[124:127],v7,15360
M v[148:151],a[84:87],v[60:63],v[148:151]
AF v31,v27,v31
AF v29,v18,v19
M v[148:151],a[80:83],v[44:47],v[148:151]
buffer_load_dwordx4 a[8:11], v7, s[8:11], s32 offen offset:2048 sc1
M v[152:155],a[88:91],v[40:43],v[152:155]
E v21,v103
M v[152:155],a[92:95],v[56:59],v[152:155]
C v52,v18,v19
AF v29,v20,v29
M v[156:159],a[92:95],v[60:63],v[156:159]
buffer_load_dwordx4 a[12:15], v7, s[8:11], s32 offen offset:3072 sc1
M v[156:159],a[88:91],v[44:47],v[156:159]
s_waitcnt lgkmcnt(0)
E v22,v108
M v[160:163],a[96:99],v[40:43],v[160:163]
R a[64:67],v7,16384
R a[68:71],v7,17408
M v[160:163],a[100:103],v[56:59],v[160:163]
buffer_load_dwordx4 a[16:19], v7, s[8:11], s73 offen offset:0 sc1
M v[164:167],a[100:103],v[60:63],v[164:167]
E v23,v109
M v[164:167],a[96:99],v[44:47],v[164:167]
R a[72:75],v7,18432
R a[76:79],v7,19456
M v[168:171],a[104:107],v[40:43],v[168:171]
buffer_load_dwordx4 a[20:23], v7, s[8:11], s73 offen offset:1024 sc1
M v[168:171],a[108:111],v[56:59],v[168:171]
C v53,v20,v21
AF v29,v21,v29
M v[172:175],a[108:111],v[60:63],v[172:175]
R a[80:83],v7,20480
R a[84:87],v7,21504
M v[172:175],a[104:107],v[44:47],v[172:175]
buffer_load_dwordx4 a[24:27], v7, s[8:11], s73 offen offset:2048 sc1
M v[176:179],a[112:115],v[40:43],v[176:179]
E v24,v110
M v[176:179],a[116:119],v[56:59],v[176:179]
R a[88:91],v7,22528
R a[92:95],v7,23552
M v[180:183],a[116:119],v[60:63],v[180:183]
buffer_load_dwordx4 a[28:31], v7, s[8:11], s73 offen offset:3072 sc1
M v[180:183],a[112:115],v[44:47],v[180:183]
E v25,v111
M v[184:187],a[120:123],v[40:43],v[184:187]
AF v29,v22,v29
C v54,v22,v23
M v[184:187],a[124:127],v[56:59],v[184:187]
buffer_load_dwordx4 a[32:35], v7, s[8:11], s74 offen offset:0 sc1
M v[188:191],a[124:127],v[60:63],v[188:191]
E v18,v116
M v[188:191],a[120:123],v[44:47],v[188:191]
s_waitcnt lgkmcnt(0)
AF v29,v23,v29
AF v29,v24,v29
M v[192:195],a[64:67],v[40:43],v[192:195]
R a[96:99],v7,24576
R a[100:103],v7,25600
M v[192:195],a[68:71],v[56:59],v[192:195]
buffer_load_dwordx4 a[36:39], v7, s[8:11], s74 offen offset:1024 sc1
M v[196:199],a[68:71],v[60:63],v[196:199]
E v19,v117
M v[196:199],a[64:67],v[44:47],v[196:199]
R a[104:107],v7,26624
R a[108:111],v7,27648
M v[200:203],a[72:75],v[40:43],v[200:203]
buffer_load_dwordx4 a[40:43], v7, s[8:11], s74 offen offset:2048 sc1
M v[200:203],a[76:79],v[56:59],v[200:203]
E v20,v118
M v[204:207],a[76:79],v[60:63],v[204:207]
R a[112:115],v7,28672
R a[116:119],v7,29696
M v[204:207],a[72:75],v[44:47],v[204:207]
buffer_load_dwordx4 a[44:47], v7, s[8:11], s74 offen offset:3072 sc1
M v[208:211],a[80:83],v[40:43],v[208:211]
C v55,v24,v25
AF v29,v25,v29
M v[208:211],a[84:87],v[56:59],v[208:211]
R a[120:123],v7,30720
R a[124:127],v7,31744
M v[212:215],a[84:87],v[60:63],v[212:215]
buffer_load_dwordx4 a[48:51], v7, s[8:11], s75 offen offset:0 sc1
M v[212:215],a[80:83],v[44:47],v[212:215]
E v21,v119
M v[216:219],a[88:91],v[40:43],v[216:219]
AF v29,v18,v29
C v48,v18,v19
M v[216:219],a[92:95],v[56:59],v[216:219]
buffer_load_dwordx4 a[52:55], v7, s[8:11], s75 offen offset:1024 sc1
M v[220:223],a[92:95],v[60:63],v[220:223]
s_waitcnt lgkmcnt(0)
E v22,v124
M v[220:223],a[88:91],v[44:47],v[220:223]
s_barrier
M v[224:227],a[96:99],v[40:43],v[224:227]
R a[64:67],v8,0
R a[68:71],v8,1024
M v[224:227],a[100:103],v[56:59],v[224:227]
buffer_load_dwordx4 a[56:59], v7, s[8:11], s75 offen offset:2048 sc1
M v[228:231],a[100:103],v[60:63],v[228:231]
v_mov_b32 v15, 4
AF v29,v19,v29
M v[228:231],a[96:99],v[44:47],v[228:231]
R a[72:75],v8,2048
R a[76:79],v8,3072
M v[232:235],a[104:107],v[40:43],v[232:235]
buffer_store_dword v15, v1, s[8:11], s45 offen sc1
M v[232:235],a[108:111],v[56:59],v[232:235]
buffer_load_dwordx4 a[60:63], v7, s[8:11], s75 offen offset:3072 sc1
M v[236:239],a[108:111],v[60:63],v[236:239]
R a[80:83],v8,4096
R a[84:87],v8,5120
M v[236:239],a[104:107],v[44:47],v[236:239]
v_cmp_gt_u32 vcc, 2, v5
AF v29,v20,v29
M v[240:243],a[112:115],v[40:43],v[240:243]
s_cbranch_vccnz L_lsh4
L_lrh4:
E v23,v125
M v[240:243],a[116:119],v[56:59],v[240:243]
R a[88:91],v8,6144
R a[92:95],v8,7168
M v[244:247],a[116:119],v[60:63],v[244:247]
E v24,v126
M v[244:247],a[112:115],v[44:47],v[244:247]
E v25,v127
M v[248:251],a[120:123],v[40:43],v[248:251]
C v49,v20,v21
AF v29,v21,v29
M v[248:251],a[124:127],v[56:59],v[248:251]
AF v29,v22,v29
C v50,v22,v23
M v[252:255],a[124:127],v[60:63],v[252:255]
s_waitcnt lgkmcnt(0)
AF v29,v23,v29
AF v29,v24,v29
M v[252:255],a[120:123],v[44:47],v[252:255]
C v51,v24,v25
AF v29,v25,v29
v_cmp_lt_f32 vcc, s31, v29
s_nop 0
s_cbranch_vccnz L_std4h
L_rtd4h:
M v[132:135],a[64:67],v[52:55],v[132:135]
R a[96:99],v8,8192
R a[100:103],v8,9216
M v[132:135],a[68:71],v[48:51],v[132:135]
R a[104:107],v8,10240
R a[108:111],v8,11264
M v[140:143],a[72:75],v[52:55],v[140:143]
SA m0,s28,65536
R a[112:115],v8,12288
R a[116:119],v8,13312
M v[140:143],a[76:79],v[48:51],v[140:143]
R a[120:123],v8,14336
R a[124:127],v8,15360
M v[148:151],a[80:83],v[52:55],v[148:151]
buffer_load_dwordx4 v3, s[8:11], s21 offen offset:0 sc1 lds
M v[148:151],a[84:87],v[48:51],v[148:151]
AF v31,v29,v31
v_mov_b32 v10, v30
M v[156:159],a[88:91],v[52:55],v[156:159]
v_mov_b32 v11, v31
v_permlane16_swap_b32 v10, v30
M v[156:159],a[92:95],v[48:51],v[156:159]
s_waitcnt lgkmcnt(0)
v_permlane16_swap_b32 v11, v31
AF v30,v10,v30
M v[164:167],a[96:99],v[52:55],v[164:167]
R a[64:67],v8,16384
R a[68:71],v8,17408
M v[164:167],a[100:103],v[48:51],v[164:167]
R a[72:75],v8,18432
R a[76:79],v8,19456
M v[172:175],a[104:107],v[52:55],v[172:175]
R a[80:83],v8,20480
R a[84:87],v8,21504
M v[172:175],a[108:111],v[48:51],v[172:175]
R a[88:91],v8,22528
R a[92:95],v8,23552
M v[180:183],a[112:115],v[52:55],v[180:183]
buffer_load_dwordx4 v3, s[8:11], s21 offen offset:1024 sc1 lds
M v[180:183],a[116:119],v[48:51],v[180:183]
AF v31,v11,v31
v_mov_b32 v10, v30
M v[188:191],a[120:123],v[52:55],v[188:191]
v_mov_b32 v11, v31
v_permlane32_swap_b32 v10, v30
M v[188:191],a[124:127],v[48:51],v[188:191]
s_waitcnt lgkmcnt(0)
buffer_load_dwordx4 v3, s[8:11], s21 offen offset:2048 sc1 lds
M v[196:199],a[64:67],v[52:55],v[196:199]
R a[96:99],v8,24576
R a[100:103],v8,25600
M v[196:199],a[68:71],v[48:51],v[196:199]
R a[104:107],v8,26624
R a[108:111],v8,27648
M v[204:207],a[72:75],v[52:55],v[204:207]
R a[112:115],v8,28672
R a[116:119],v8,29696
M v[204:207],a[76:79],v[48:51],v[204:207]
R a[120:123],v8,30720
R a[124:127],v8,31744
M v[212:215],a[80:83],v[52:55],v[212:215]
buffer_load_dwordx4 v3, s[8:11], s21 offen offset:3072 sc1 lds
M v[212:215],a[84:87],v[48:51],v[212:215]
SA m0,s28,69632
v_permlane32_swap_b32 v11, v31
AF v30,v10,v30
M v[220:223],a[88:91],v[52:55],v[220:223]
s_waitcnt lgkmcnt(0)
AF v31,v11,v31
C v128,v128,v129
M v[220:223],a[92:95],v[48:51],v[220:223]
s_barrier
M v[228:231],a[96:99],v[52:55],v[228:231]
R a[64:67],v2,32768
R a[68:71],v2,33792
M v[228:231],a[100:103],v[48:51],v[228:231]
R a[72:75],v2,34816
R a[76:79],v2,35840
M v[236:239],a[104:107],v[52:55],v[236:239]
R a[80:83],v2,36864
R a[84:87],v2,37888
M v[236:239],a[108:111],v[48:51],v[236:239]
R a[88:91],v2,38912
R a[92:95],v2,39936
M v[244:247],a[112:115],v[52:55],v[244:247]
v_rcp_f32 v5, v30
M v[244:247],a[116:119],v[48:51],v[244:247]
s_waitcnt vmcnt(4)
buffer_load_dwordx4 v4, s[8:11], s21 offen offset:0 sc1 lds
M v[252:255],a[120:123],v[52:55],v[252:255]
s_waitcnt lgkmcnt(0)
v_rcp_f32 v6, v31
M v[252:255],a[124:127],v[48:51],v[252:255]
W a192,v5
W a193,v6
M v[64:67],a[64:67],a[0:3],0
R a[96:99],v2,40960
R a[100:103],v2,41984
M v[64:67],a[68:71],a[4:7],v[64:67]
buffer_load_dwordx4 v4, s[8:11], s21 offen offset:1024 sc1 lds
M v[64:67],a[72:75],a[8:11],v[64:67]
v_mov_b32 v30, 0
v_mov_b32 v31, 0
M v[64:67],a[76:79],a[12:15],v[64:67]
R a[104:107],v2,43008
R a[108:111],v2,44032
M v[64:67],a[80:83],a[16:19],v[64:67]
buffer_load_dwordx4 v4, s[8:11], s21 offen offset:2048 sc1 lds
M v[64:67],a[84:87],a[20:23],v[64:67]
v_mov_b32 v32, 0
v_mov_b32 v33, 0
M v[64:67],a[88:91],a[24:27],v[64:67]
R a[112:115],v2,45056
R a[116:119],v2,46080
M v[64:67],a[92:95],a[28:31],v[64:67]
buffer_load_dwordx4 v4, s[8:11], s21 offen offset:3072 sc1 lds
M v[68:71],a[92:95],a[60:63],0
SA s21,s21,32768
v_mov_b32 v34, 0
v_mov_b32 v35, 0
M v[68:71],a[88:91],a[56:59],v[68:71]
s_sub_u32 s22, s22, 1
R a[120:123],v2,47104
R a[124:127],v2,48128
M v[68:71],a[84:87],a[52:55],v[68:71]
s_cselect_b32 s21, s23, s21
v_mov_b32 v36, 0
v_mov_b32 v37, 0
M v[68:71],a[80:83],a[48:51],v[68:71]
s_mul_i32 s26, s41, 1048576
v_mov_b32 v38, 0
v_mov_b32 v39, 0
M v[68:71],a[76:79],a[44:47],v[68:71]
SA s26,s26,17367040
E v18,v64
M v[68:71],a[72:75],a[40:43],v[68:71]
SA m0,s28,0
C v129,v130,v131
C v130,v136,v137
M v[68:71],a[68:71],a[36:39],v[68:71]
buffer_load_dwordx4 v3, s[8:11], s26 offen offset:0 sc1 lds
M v[68:71],a[64:67],a[32:35],v[68:71]
s_waitcnt lgkmcnt(0)
E v19,v65
M v[72:75],a[96:99],a[0:3],0
R a[64:67],v2,49152
R a[68:71],v2,50176
M v[72:75],a[100:103],a[4:7],v[72:75]
buffer_load_dwordx4 v3, s[8:11], s26 offen offset:1024 sc1 lds
M v[72:75],a[104:107],a[8:11],v[72:75]
E v20,v66
M v[72:75],a[108:111],a[12:15],v[72:75]
R a[72:75],v2,51200
R a[76:79],v2,52224
M v[72:75],a[112:115],a[16:19],v[72:75]
buffer_load_dwordx4 v3, s[8:11], s26 offen offset:2048 sc1 lds
M v[72:75],a[116:119],a[20:23],v[72:75]
E v21,v67
M v[72:75],a[120:123],a[24:27],v[72:75]
R a[80:83],v2,53248
R a[84:87],v2,54272
M v[72:75],a[124:127],a[28:31],v[72:75]
buffer_load_dwordx4 v3, s[8:11], s26 offen offset:3072 sc1 lds
M v[76:79],a[124:127],a[60:63],0
SA m0,s28,4096
E v22,v68
M v[76:79],a[120:123],a[56:59],v[76:79]
R a[88:91],v2,55296
R a[92:95],v2,56320
M v[76:79],a[116:119],a[52:55],v[76:79]
AF v26,v18,v19
C v40,v18,v19
M v[76:79],a[112:115],a[48:51],v[76:79]
buffer_load_dwordx4 v4, s[8:11], s26 offen offset:0 sc1 lds
M v[76:79],a[108:111],a[44:47],v[76:79]
E v23,v69
M v[76:79],a[104:107],a[40:43],v[76:79]
AF v26,v20,v26
C v41,v20,v21
M v[76:79],a[100:103],a[36:39],v[76:79]
E v24,v70
M v[76:79],a[96:99],a[32:35],v[76:79]
s_waitcnt lgkmcnt(0)
buffer_load_dwordx4 v4, s[8:11], s26 offen offset:1024 sc1 lds
M v[80:83],a[64:67],a[0:3],0
R a[96:99],v2,57344
R a[100:103],v2,58368
M v[80:83],a[68:71],a[4:7],v[80:83]
E v25,v71
M v[80:83],a[72:75],a[8:11],v[80:83]
AF v26,v21,v26
AF v27,v22,v23
M v[80:83],a[76:79],a[12:15],v[80:83]
R a[104:107],v2,59392
R a[108:111],v2,60416
M v[80:83],a[80:83],a[16:19],v[80:83]
buffer_load_dwordx4 v4, s[8:11], s26 offen offset:2048 sc1 lds
M v[80:83],a[84:87],a[20:23],v[80:83]
E v18,v72
M v[80:83],a[88:91],a[24:27],v[80:83]
R a[112:115],v2,61440
R a[116:119],v2,62464
M v[80:83],a[92:95],a[28:31],v[80:83]
C v44,v22,v23
AF v27,v24,v27
M v[84:87],a[92:95],a[60:63],0
buffer_load_dwordx4 v4, s[8:11], s26 offen offset:3072 sc1 lds
M v[84:87],a[88:91],a[56:59],v[84:87]
SA s26,s26,32768
R a[120:123],v2,63488
R a[124:127],v2,64512
M v[84:87],a[84:87],a[52:55],v[84:87]
SA m0,s28,32768
E v19,v73
M v[84:87],a[80:83],a[48:51],v[84:87]
E v20,v74
M v[84:87],a[76:79],a[44:47],v[84:87]
buffer_load_dwordx4 v3, s[8:11], s26 offen offset:0 sc1 lds
M v[84:87],a[72:75],a[40:43],v[84:87]
C v45,v24,v25
AF v27,v25,v27
M v[84:87],a[68:71],a[36:39],v[84:87]
s_waitcnt vmcnt(9) lgkmcnt(0)
E v21,v75
M v[84:87],a[64:67],a[32:35],v[84:87]
s_barrier
M v[88:91],a[96:99],a[0:3],0
R a[64:67],v2,0
R a[68:71],v2,1024
M v[88:91],a[100:103],a[4:7],v[88:91]
buffer_load_dwordx4 v3, s[8:11], s26 offen offset:1024 sc1 lds
M v[88:91],a[104:107],a[8:11],v[88:91]
E v22,v76
M v[88:91],a[108:111],a[12:15],v[88:91]
R a[72:75],v2,2048
R a[76:79],v2,3072
M v[88:91],a[112:115],a[16:19],v[88:91]
E v23,v77
M v[88:91],a[116:119],a[20:23],v[88:91]
buffer_load_dwordx4 v3, s[8:11], s26 offen offset:2048 sc1 lds
M v[88:91],a[120:123],a[24:27],v[88:91]
R a[80:83],v2,4096
R a[84:87],v2,5120
M v[88:91],a[124:127],a[28:31],v[88:91]
E v24,v78
M v[92:95],a[124:127],a[60:63],0
AF v26,v18,v26
C v42,v18,v19
M v[92:95],a[120:123],a[56:59],v[92:95]
R a[88:91],v2,6144
R a[92:95],v2,7168
M v[92:95],a[116:119],a[52:55],v[92:95]
buffer_load_dwordx4 v3, s[8:11], s26 offen offset:3072 sc1 lds
M v[92:95],a[112:115],a[48:51],v[92:95]
E v25,v79
M v[92:95],a[108:111],a[44:47],v[92:95]
AF v26,v19,v26
AF v26,v20,v26
M v[92:95],a[104:107],a[40:43],v[92:95]
C v43,v20,v21
AF v26,v21,v26
M v[92:95],a[100:103],a[36:39],v[92:95]
s_waitcnt lgkmcnt(0)
AF v27,v22,v27
C v46,v22,v23
M v[92:95],a[96:99],a[32:35],v[92:95]
AF v27,v23,v27
AF v27,v24,v27
C v47,v24,v25
AF v27,v25,v27
M v[96:99],a[64:67],a[0:3],0
R a[96:99],v2,8192
R a[100:103],v2,9216
M v[96:99],a[68:71],a[4:7],v[96:99]
SA m0,s28,98304
E v18,v80
M v[96:99],a[72:75],a[8:11],v[96:99]
buffer_load_dwordx4 v3, s[8:11], s21 offen offset:0 sc1 lds
M v[96:99],a[76:79],a[12:15],v[96:99]
R a[104:107],v2,10240
R a[108:111],v2,11264
M v[96:99],a[80:83],a[16:19],v[96:99]
E v19,v81
M v[96:99],a[84:87],a[20:23],v[96:99]
AF v26,v18,v26
C v56,v18,v19
M v[96:99],a[88:91],a[24:27],v[96:99]
R a[112:115],v2,12288
R a[116:119],v2,13312
M v[96:99],a[92:95],a[28:31],v[96:99]
buffer_load_dwordx4 v3, s[8:11], s21 offen offset:1024 sc1 lds
M v[100:103],a[92:95],a[60:63],0
E v20,v82
M v[100:103],a[88:91],a[56:59],v[100:103]
R a[120:123],v2,14336
R a[124:127],v2,15360
M v[100:103],a[84:87],a[52:55],v[100:103]
E v21,v83
M v[100:103],a[80:83],a[48:51],v[100:103]
buffer_load_dwordx4 v3, s[8:11], s21 offen offset:2048 sc1 lds
M v[100:103],a[76:79],a[44:47],v[100:103]
AF v26,v19,v26
AF v26,v20,v26
M v[100:103],a[72:75],a[40:43],v[100:103]
E v22,v88
M v[100:103],a[68:71],a[36:39],v[100:103]
C v57,v20,v21
AF v26,v21,v26
M v[100:103],a[64:67],a[32:35],v[100:103]
s_waitcnt lgkmcnt(0)
buffer_load_dwordx4 v3, s[8:11], s21 offen offset:3072 sc1 lds
M v[104:107],a[96:99],a[0:3],0
R a[64:67],v2,16384
R a[68:71],v2,17408
M v[104:107],a[100:103],a[4:7],v[104:107]
E v23,v89
M v[104:107],a[104:107],a[8:11],v[104:107]
SA m0,s28,102400
AF v26,v22,v26
C v58,v22,v23
M v[104:107],a[108:111],a[12:15],v[104:107]
R a[72:75],v2,18432
R a[76:79],v2,19456
M v[104:107],a[112:115],a[16:19],v[104:107]
buffer_load_dwordx4 v4, s[8:11], s21 offen offset:0 sc1 lds
M v[104:107],a[116:119],a[20:23],v[104:107]
E v24,v90
M v[104:107],a[120:123],a[24:27],v[104:107]
R a[80:83],v2,20480
R a[84:87],v2,21504
M v[104:107],a[124:127],a[28:31],v[104:107]
E v25,v91
M v[108:111],a[124:127],a[60:63],0
buffer_load_dwordx4 v4, s[8:11], s21 offen offset:1024 sc1 lds
M v[108:111],a[120:123],a[56:59],v[108:111]
R a[88:91],v2,22528
R a[92:95],v2,23552
M v[108:111],a[116:119],a[52:55],v[108:111]
AF v26,v23,v26
AF v26,v24,v26
M v[108:111],a[112:115],a[48:51],v[108:111]
E v18,v84
M v[108:111],a[108:111],a[44:47],v[108:111]
buffer_load_dwordx4 v4, s[8:11], s21 offen offset:2048 sc1 lds
M v[108:111],a[104:107],a[40:43],v[108:111]
C v59,v24,v25
AF v26,v25,v26
M v[108:111],a[100:103],a[36:39],v[108:111]
E v19,v85
M v[108:111],a[96:99],a[32:35],v[108:111]
s_waitcnt lgkmcnt(0)
AF v27,v18,v27
C v60,v18,v19
M v[112:115],a[64:67],a[0:3],0
R a[96:99],v2,24576
R a[100:103],v2,25600
M v[112:115],a[68:71],a[4:7],v[112:115]
buffer_load_dwordx4 v4, s[8:11], s21 offen offset:3072 sc1 lds
M v[112:115],a[72:75],a[8:11],v[112:115]
SA s21,s21,32768
E v20,v86
M v[112:115],a[76:79],a[12:15],v[112:115]
s_sub_u32 s22, s22, 1
R a[104:107],v2,26624
R a[108:111],v2,27648
M v[112:115],a[80:83],a[16:19],v[112:115]
s_cselect_b32 s21, s23, s21
AF v27,v19,v27
C v131,v138,v139
M v[112:115],a[84:87],a[20:23],v[112:115]
SA m0,s28,36864
E v21,v87
M v[112:115],a[88:91],a[24:27],v[112:115]
R a[112:115],v2,28672
R a[116:119],v2,29696
M v[112:115],a[92:95],a[28:31],v[112:115]
buffer_load_dwordx4 v4, s[8:11], s26 offen offset:0 sc1 lds
M v[116:119],a[92:95],a[60:63],0
E v22,v92
M v[116:119],a[88:91],a[56:59],v[116:119]
R a[120:123],v2,30720
R a[124:127],v2,31744
M v[116:119],a[84:87],a[52:55],v[116:119]
AF v27,v20,v27
C v61,v20,v21
M v[116:119],a[80:83],a[48:51],v[116:119]
buffer_load_dwordx4 v4, s[8:11], s26 offen offset:1024 sc1 lds
M v[116:119],a[76:79],a[44:47],v[116:119]
E v23,v93
M v[116:119],a[72:75],a[40:43],v[116:119]
AF v27,v21,v27
AF v27,v22,v27
M v[116:119],a[68:71],a[36:39],v[116:119]
s_waitcnt vmcnt(14) lgkmcnt(0)
C v62,v22,v23
AF v27,v23,v27
M v[116:119],a[64:67],a[32:35],v[116:119]
s_barrier
M v[120:123],a[96:99],a[0:3],0
R a[64:67],v7,0
R a[68:71],v7,1024
M v[120:123],a[100:103],a[4:7],v[120:123]
buffer_load_dwordx4 v4, s[8:11], s26 offen offset:2048 sc1 lds
M v[120:123],a[104:107],a[8:11],v[120:123]
E v24,v94
M v[120:123],a[108:111],a[12:15],v[120:123]
R a[72:75],v7,2048
R a[76:79],v7,3072
M v[120:123],a[112:115],a[16:19],v[120:123]
E v25,v95
M v[120:123],a[116:119],a[20:23],v[120:123]
buffer_load_dwordx4 v4, s[8:11], s26 offen offset:3072 sc1 lds
M v[120:123],a[120:123],a[24:27],v[120:123]
R a[80:83],v7,4096
R a[84:87],v7,5120
M v[120:123],a[124:127],a[28:31],v[120:123]
AF v27,v24,v27
C v63,v24,v25
M v[124:127],a[124:127],a[60:63],0
SA s26,s26,32768
AF v27,v25,v27
W a128,v128
M v[124:127],a[120:123],a[56:59],v[124:127]
R a[88:91],v7,6144
R a[92:95],v7,7168
W a129,v129
W a130,v130
W a131,v131
C v144,v144,v145
C v145,v146,v147
C v146,v152,v153
C v147,v154,v155
W a132,v144
W a133,v145
W a134,v146
W a135,v147
C v132,v132,v133
C v133,v134,v135
C v134,v140,v141
C v135,v142,v143
W a160,v132
W a161,v133
W a162,v134
W a163,v135
C v160,v160,v161
C v161,v162,v163
C v162,v168,v169
C v163,v170,v171
W a136,v160
W a137,v161
W a138,v162
W a139,v163
C v148,v148,v149
C v149,v150,v151
C v150,v156,v157
C v151,v158,v159
W a164,v148
W a165,v149
W a166,v150
W a167,v151
C v176,v176,v177
C v177,v178,v179
C v178,v184,v185
C v179,v186,v187
W a140,v176
W a141,v177
W a142,v178
W a143,v179
C v164,v164,v165
C v165,v166,v167
C v166,v172,v173
C v167,v174,v175
W a168,v164
W a169,v165
W a170,v166
W a171,v167
C v192,v192,v193
C v193,v194,v195
C v194,v200,v201
C v195,v202,v203
W a144,v192
W a145,v193
W a146,v194
W a147,v195
C v180,v180,v181
C v181,v182,v183
C v182,v188,v189
C v183,v190,v191
W a172,v180
W a173,v181
W a174,v182
W a175,v183
C v208,v208,v209
C v209,v210,v211
C v210,v216,v217
C v211,v218,v219
W a148,v208
W a149,v209
W a150,v210
W a151,v211
C v196,v196,v197
C v197,v198,v199
C v198,v204,v205
C v199,v206,v207
W a176,v196
W a177,v197
W a178,v198
W a179,v199
C v224,v224,v225
C v225,v226,v227
C v226,v232,v233
C v227,v234,v235
W a152,v224
W a153,v225
W a154,v226
W a155,v227
C v212,v212,v213
C v213,v214,v215
C v214,v220,v221
C v215,v222,v223
W a180,v212
W a181,v213
W a182,v214
W a183,v215
C v240,v240,v241
C v241,v242,v243
C v242,v248,v249
C v243,v250,v251
W a156,v240
W a157,v241
W a158,v242
W a159,v243
C v228,v228,v229
C v229,v230,v231
C v230,v236,v237
C v231,v238,v239
W a184,v228
W a185,v229
W a186,v230
W a187,v231
C v244,v244,v245
C v245,v246,v247
C v246,v252,v253
C v247,v254,v255
W a188,v244
W a189,v245
W a190,v246
W a191,v247
M v[124:127],a[116:119],a[52:55],v[124:127]
M v[124:127],a[112:115],a[48:51],v[124:127]
M v[124:127],a[108:111],a[44:47],v[124:127]
M v[124:127],a[104:107],a[40:43],v[124:127]
M v[124:127],a[100:103],a[36:39],v[124:127]
s_waitcnt lgkmcnt(0)
M v[124:127],a[96:99],a[32:35],v[124:127]
v_max_f32 v10, v26, v27
v_min_f32 v11, v26, v27
v_cmp_lt_f32 vcc, s31, v10
v_cmp_gt_f32 s[64:65], s24, v11
s_nop 0
s_or_b64 vcc, vcc, s[64:65]
s_cbranch_vccnz L_sth1
L_rth1:
M v[128:131],a[64:67],v[40:43],0
R a[96:99],v7,8192
R a[100:103],v7,9216
M v[128:131],a[68:71],v[56:59],v[128:131]
SA m0,s28,65536
E v18,v96
M v[132:135],a[68:71],v[60:63],0
buffer_load_dwordx4 v3, s[8:11], s21 offen offset:0 sc1 lds
M v[132:135],a[64:67],v[44:47],v[132:135]
R a[104:107],v7,10240
R a[108:111],v7,11264
M v[136:139],a[72:75],v[40:43],0
E v19,v97
M v[136:139],a[76:79],v[56:59],v[136:139]
AF v30,v26,v30
AF v31,v27,v31
M v[140:143],a[76:79],v[60:63],0
R a[112:115],v7,12288
R a[116:119],v7,13312
M v[140:143],a[72:75],v[44:47],v[140:143]
buffer_load_dwordx4 v3, s[8:11], s21 offen offset:1024 sc1 lds
M v[144:147],a[80:83],v[40:43],0
E v20,v98
M v[144:147],a[84:87],v[56:59],v[144:147]
R a[120:123],v7,14336
R a[124:127],v7,15360
M v[148:151],a[84:87],v[60:63],0
s_mov_b32 s40, 0
AF v28,v18,v19
C v48,v18,v19
M v[148:151],a[80:83],v[44:47],v[148:151]
s_mov_b32 s7, 0
buffer_load_dwordx4 v3, s[8:11], s21 offen offset:2048 sc1 lds
M v[152:155],a[88:91],v[40:43],0
s_and_b32 s39, s39, 3
E v21,v99
M v[152:155],a[92:95],v[56:59],v[152:155]
s_sub_u32 s27, 5, s42
AF v28,v20,v28
C v49,v20,v21
M v[156:159],a[92:95],v[60:63],0
AF v28,v21,v28
M v[156:159],a[88:91],v[44:47],v[156:159]
s_waitcnt lgkmcnt(0)
buffer_load_dwordx4 v3, s[8:11], s21 offen offset:3072 sc1 lds
M v[160:163],a[96:99],v[40:43],0
SA m0,s28,69632
R a[64:67],v7,16384
R a[68:71],v7,17408
M v[160:163],a[100:103],v[56:59],v[160:163]
E v22,v104
M v[164:167],a[100:103],v[60:63],0
E v23,v105
M v[164:167],a[96:99],v[44:47],v[164:167]
R a[72:75],v7,18432
R a[76:79],v7,19456
M v[168:171],a[104:107],v[40:43],0
buffer_load_dwordx4 v4, s[8:11], s21 offen offset:0 sc1 lds
M v[168:171],a[108:111],v[56:59],v[168:171]
AF v28,v22,v28
C v50,v22,v23
M v[172:175],a[108:111],v[60:63],0
R a[80:83],v7,20480
R a[84:87],v7,21504
M v[172:175],a[104:107],v[44:47],v[172:175]
buffer_load_dwordx4 v4, s[8:11], s21 offen offset:1024 sc1 lds
M v[176:179],a[112:115],v[40:43],0
E v24,v106
M v[176:179],a[116:119],v[56:59],v[176:179]
R a[88:91],v7,22528
R a[92:95],v7,23552
M v[180:183],a[116:119],v[60:63],0
buffer_load_dwordx4 v4, s[8:11], s21 offen offset:2048 sc1 lds
M v[180:183],a[112:115],v[44:47],v[180:183]
E v25,v107
M v[184:187],a[120:123],v[40:43],0
AF v28,v23,v28
AF v28,v24,v28
M v[184:187],a[124:127],v[56:59],v[184:187]
C v51,v24,v25
AF v28,v25,v28
M v[188:191],a[124:127],v[60:63],0
buffer_load_dwordx4 v4, s[8:11], s21 offen offset:3072 sc1 lds
M v[188:191],a[120:123],v[44:47],v[188:191]
s_waitcnt lgkmcnt(0)
E v18,v100
M v[192:195],a[64:67],v[40:43],0
SA s21,s21,32768
R a[96:99],v7,24576
R a[100:103],v7,25600
M v[192:195],a[68:71],v[56:59],v[192:195]
s_sub_u32 s22, s22, 1
E v19,v101
M v[196:199],a[68:71],v[60:63],0
s_cselect_b32 s21, s23, s21
AF v29,v18,v19
C v52,v18,v19
M v[196:199],a[64:67],v[44:47],v[196:199]
R a[104:107],v7,26624
R a[108:111],v7,27648
M v[200:203],a[72:75],v[40:43],0
M v[200:203],a[76:79],v[56:59],v[200:203]
E v20,v102
M v[204:207],a[76:79],v[60:63],0
R a[112:115],v7,28672
R a[116:119],v7,29696
M v[204:207],a[72:75],v[44:47],v[204:207]
M v[208:211],a[80:83],v[40:43],0
M v[208:211],a[84:87],v[56:59],v[208:211]
R a[120:123],v7,30720
R a[124:127],v7,31744
M v[212:215],a[84:87],v[60:63],0
E v21,v103
M v[212:215],a[80:83],v[44:47],v[212:215]
AF v29,v20,v29
C v53,v20,v21
M v[216:219],a[88:91],v[40:43],0
AF v29,v21,v29
M v[216:219],a[92:95],v[56:59],v[216:219]
E v22,v108
M v[220:223],a[92:95],v[60:63],0
s_waitcnt vmcnt(12) lgkmcnt(0)
M v[220:223],a[88:91],v[44:47],v[220:223]
s_barrier
M v[224:227],a[96:99],v[40:43],0
R a[64:67],v2,32768
R a[68:71],v2,33792
M v[224:227],a[100:103],v[56:59],v[224:227]
E v23,v109
M v[228:231],a[100:103],v[60:63],0
AF v29,v22,v29
C v54,v22,v23
M v[228:231],a[96:99],v[44:47],v[228:231]
R a[72:75],v2,34816
R a[76:79],v2,35840
M v[232:235],a[104:107],v[40:43],0
E v24,v110
M v[232:235],a[108:111],v[56:59],v[232:235]
AF v29,v23,v29
M v[236:239],a[108:111],v[60:63],0
R a[80:83],v2,36864
R a[84:87],v2,37888
M v[236:239],a[104:107],v[44:47],v[236:239]
M v[240:243],a[112:115],v[40:43],0
E v25,v111
M v[240:243],a[116:119],v[56:59],v[240:243]
R a[88:91],v2,38912
R a[92:95],v2,39936
M v[244:247],a[116:119],v[60:63],0
AF v29,v24,v29
C v55,v24,v25
M v[244:247],a[112:115],v[44:47],v[244:247]
AF v29,v25,v29
M v[248:251],a[120:123],v[40:43],0
M v[248:251],a[124:127],v[56:59],v[248:251]
M v[252:255],a[124:127],v[60:63],0
s_waitcnt lgkmcnt(0)
M v[252:255],a[120:123],v[44:47],v[252:255]
s_cmp_lg_u32 s27, 0
s_cbranch_scc1 L_loop_top
L_final_h:
s_waitcnt vmcnt(8) lgkmcnt(0)
s_barrier
R a[64:67],v7,32768
R a[68:71],v7,33792
R a[72:75],v7,34816
R a[76:79],v7,35840
R a[80:83],v7,36864
R a[84:87],v7,37888
R a[88:91],v7,38912
R a[92:95],v7,39936
v_lshrrev_b32 v14, 7, v7
v_mul_u32_u24 v14, 896, v14
v_lshrrev_b32 v15, 8, v7
v_lshlrev_b32 v15, 5, v15
v_xor_b32 v15, v15, v7
v_and_b32 v15, 0x70, v15
v_add_u32 v0, v14, v15
s_mul_i32 s38, s20, 57344
SA m0,s28,98304
SA s85,s38,0
E v18,v112
buffer_load_dwordx4 v0, s[12:15], s85 offen offset:0 lds
E v19,v113
E v20,v114
AF v28,v18,v28
SA s85,s38,6144
C v56,v18,v19
buffer_load_dwordx4 v0, s[12:15], s85 offen offset:1024 lds
E v21,v115
AF v28,v19,v28
E v22,v120
AF v28,v20,v28
SA s85,s38,12288
C v57,v20,v21
buffer_load_dwordx4 v0, s[12:15], s85 offen offset:2048 lds
E v23,v121
AF v28,v21,v28
E v24,v122
AF v28,v22,v28
SA s85,s38,18432
C v58,v22,v23
buffer_load_dwordx4 v0, s[12:15], s85 offen offset:3072 lds
E v25,v123
AF v28,v23,v28
E v18,v116
AF v28,v24,v28
SA m0,s28,102400
SA s85,s38,28672
C v59,v24,v25
buffer_load_dwordx4 v0, s[12:15], s85 offen offset:0 lds
E v19,v117
AF v28,v25,v28
E v20,v118
AF v29,v18,v29
SA s85,s38,34816
C v60,v18,v19
buffer_load_dwordx4 v0, s[12:15], s85 offen offset:1024 lds
E v21,v119
AF v29,v19,v29
E v22,v124
AF v29,v20,v29
SA s85,s38,40960
C v61,v20,v21
buffer_load_dwordx4 v0, s[12:15], s85 offen offset:2048 lds
E v23,v125
AF v29,v21,v29
E v24,v126
AF v29,v22,v29
SA s85,s38,47104
C v62,v22,v23
buffer_load_dwordx4 v0, s[12:15], s85 offen offset:3072 lds
SA s38,s38,128
E v25,v127
AF v29,v23,v29
AF v29,v24,v29
C v63,v24,v25
AF v29,v25,v29
v_max_f32 v10, v28, v29
v_cmp_lt_f32 vcc, s31, v10
s_nop 0
s_cbranch_vccnz L_stfh
L_rtfh:
AF v30,v28,v30
AF v31,v29,v31
v_mov_b32 v10, v32
v_mov_b32 v11, v36
v_mov_b32 v12, v30
v_mov_b32 v13, v31
buffer_store_dwordx4 v[10:13], v7, s[8:11], s90 offen sc1
s_waitcnt lgkmcnt(0)
M v[128:131],a[64:67],v[48:51],v[128:131]
SA m0,s28,65536
R a[96:99],v7,40960
R a[100:103],v7,41984
M v[128:131],a[68:71],v[56:59],v[128:131]
SA s85,s38,0
buffer_load_dwordx4 v0, s[12:15], s85 offen offset:0 lds
M v[132:135],a[68:71],v[60:63],v[132:135]
SA s85,s38,6144
v_lshrrev_b32 v16, 4, v7
v_lshrrev_b32 v14, 2, v16
M v[132:135],a[64:67],v[52:55],v[132:135]
R a[104:107],v7,43008
R a[108:111],v7,44032
M v[136:139],a[72:75],v[48:51],v[136:139]
buffer_load_dwordx4 v0, s[12:15], s85 offen offset:1024 lds
M v[136:139],a[76:79],v[56:59],v[136:139]
SA s85,s38,12288
v_lshlrev_b32 v14, 7, v14
v_and_b32 v15, 3, v16
M v[140:143],a[76:79],v[60:63],v[140:143]
R a[112:115],v7,45056
R a[116:119],v7,46080
M v[140:143],a[72:75],v[52:55],v[140:143]
buffer_load_dwordx4 v0, s[12:15], s85 offen offset:2048 lds
M v[144:147],a[80:83],v[48:51],v[144:147]
SA s85,s38,18432
v_lshl_add_u32 v14, v15, 3, v14
v_bfe_u32 v15, v16, 3, 2
M v[144:147],a[84:87],v[56:59],v[144:147]
R a[120:123],v7,47104
R a[124:127],v7,48128
M v[148:151],a[84:87],v[60:63],v[148:151]
buffer_load_dwordx4 v0, s[12:15], s85 offen offset:3072 lds
M v[148:151],a[80:83],v[52:55],v[148:151]
v_lshl_add_u32 v18, v15, 5, v14
v_xor_b32 v19, 32, v18
M v[152:155],a[88:91],v[48:51],v[152:155]
v_xor_b32 v20, 64, v18
v_xor_b32 v21, 0x60, v18
M v[152:155],a[92:95],v[56:59],v[152:155]
v_add_u32 v22, 0x10000, v18
v_add_u32 v23, 0x10000, v19
M v[156:159],a[92:95],v[60:63],v[156:159]
v_add_u32 v24, 0x10000, v20
v_add_u32 v25, 0x10000, v21
M v[156:159],a[88:91],v[52:55],v[156:159]
s_waitcnt lgkmcnt(0)
C v128,v128,v129
C v129,v130,v131
M v[160:163],a[96:99],v[48:51],v[160:163]
R a[64:67],v7,49152
R a[68:71],v7,50176
M v[160:163],a[100:103],v[56:59],v[160:163]
C v130,v136,v137
C v131,v138,v139
M v[164:167],a[100:103],v[60:63],v[164:167]
buffer_store_dwordx4 v[128:131], v7, s[8:11], s86 offen offset:0 sc1
M v[164:167],a[96:99],v[52:55],v[164:167]
R a[72:75],v7,51200
R a[76:79],v7,52224
M v[168:171],a[104:107],v[48:51],v[168:171]
C v132,v132,v133
C v133,v134,v135
M v[168:171],a[108:111],v[56:59],v[168:171]
C v134,v140,v141
C v135,v142,v143
M v[172:175],a[108:111],v[60:63],v[172:175]
R a[80:83],v7,53248
R a[84:87],v7,54272
M v[172:175],a[104:107],v[52:55],v[172:175]
buffer_store_dwordx4 v[132:135], v7, s[8:11], s88 offen offset:0 sc1
M v[176:179],a[112:115],v[48:51],v[176:179]
C v144,v144,v145
C v145,v146,v147
M v[176:179],a[116:119],v[56:59],v[176:179]
R a[88:91],v7,55296
R a[92:95],v7,56320
M v[180:183],a[116:119],v[60:63],v[180:183]
C v146,v152,v153
C v147,v154,v155
M v[180:183],a[112:115],v[52:55],v[180:183]
buffer_store_dwordx4 v[144:147], v7, s[8:11], s86 offen offset:1024 sc1
M v[184:187],a[120:123],v[48:51],v[184:187]
C v148,v148,v149
C v149,v150,v151
M v[184:187],a[124:127],v[56:59],v[184:187]
C v150,v156,v157
C v151,v158,v159
M v[188:191],a[124:127],v[60:63],v[188:191]
buffer_store_dwordx4 v[148:151], v7, s[8:11], s88 offen offset:1024 sc1
M v[188:191],a[120:123],v[52:55],v[188:191]
s_waitcnt lgkmcnt(0)
C v160,v160,v161
C v161,v162,v163
M v[192:195],a[64:67],v[48:51],v[192:195]
R a[96:99],v7,57344
R a[100:103],v7,58368
M v[192:195],a[68:71],v[56:59],v[192:195]
C v162,v168,v169
C v163,v170,v171
M v[196:199],a[68:71],v[60:63],v[196:199]
buffer_store_dwordx4 v[160:163], v7, s[8:11], s86 offen offset:2048 sc1
M v[196:199],a[64:67],v[52:55],v[196:199]
R a[104:107],v7,59392
R a[108:111],v7,60416
M v[200:203],a[72:75],v[48:51],v[200:203]
C v164,v164,v165
C v165,v166,v167
M v[200:203],a[76:79],v[56:59],v[200:203]
C v166,v172,v173
C v167,v174,v175
M v[204:207],a[76:79],v[60:63],v[204:207]
R a[112:115],v7,61440
R a[116:119],v7,62464
M v[204:207],a[72:75],v[52:55],v[204:207]
buffer_store_dwordx4 v[164:167], v7, s[8:11], s88 offen offset:2048 sc1
M v[208:211],a[80:83],v[48:51],v[208:211]
C v176,v176,v177
C v177,v178,v179
M v[208:211],a[84:87],v[56:59],v[208:211]
R a[120:123],v7,63488
R a[124:127],v7,64512
M v[212:215],a[84:87],v[60:63],v[212:215]
C v178,v184,v185
C v179,v186,v187
M v[212:215],a[80:83],v[52:55],v[212:215]
buffer_store_dwordx4 v[176:179], v7, s[8:11], s86 offen offset:3072 sc1
M v[216:219],a[88:91],v[48:51],v[216:219]
C v180,v180,v181
C v181,v182,v183
M v[216:219],a[92:95],v[56:59],v[216:219]
C v182,v188,v189
C v183,v190,v191
M v[220:223],a[92:95],v[60:63],v[220:223]
s_waitcnt vmcnt(12) lgkmcnt(0)
buffer_store_dwordx4 v[180:183], v7, s[8:11], s88 offen offset:3072 sc1
M v[220:223],a[88:91],v[52:55],v[220:223]
s_barrier
M v[224:227],a[96:99],v[48:51],v[224:227]
s_nop 0
T a[64:65],v22,32768
T a[66:67],v22,34816
M v[224:227],a[100:103],v[56:59],v[224:227]
T a[68:69],v22,36864
T a[70:71],v22,38912
M v[228:231],a[100:103],v[60:63],v[228:231]
C v192,v192,v193
C v193,v194,v195
M v[228:231],a[96:99],v[52:55],v[228:231]
T a[72:73],v22,40960
T a[74:75],v22,43008
M v[232:235],a[104:107],v[48:51],v[232:235]
T a[76:77],v22,45056
T a[78:79],v22,47104
M v[232:235],a[108:111],v[56:59],v[232:235]
C v194,v200,v201
C v195,v202,v203
M v[236:239],a[108:111],v[60:63],v[236:239]
T a[80:81],v22,49152
T a[82:83],v22,51200
M v[236:239],a[104:107],v[52:55],v[236:239]
T a[84:85],v22,53248
T a[86:87],v22,55296
M v[240:243],a[112:115],v[48:51],v[240:243]
buffer_store_dwordx4 v[192:195], v7, s[8:11], s87 offen offset:0 sc1
M v[240:243],a[116:119],v[56:59],v[240:243]
s_nop 0
T a[88:89],v22,57344
T a[90:91],v22,59392
M v[244:247],a[116:119],v[60:63],v[244:247]
T a[92:93],v22,61440
T a[94:95],v22,63488
M v[244:247],a[112:115],v[52:55],v[244:247]
C v196,v196,v197
C v197,v198,v199
M v[248:251],a[120:123],v[48:51],v[248:251]
C v198,v204,v205
C v199,v206,v207
M v[248:251],a[124:127],v[56:59],v[248:251]
buffer_store_dwordx4 v[196:199], v7, s[8:11], s89 offen offset:0 sc1
M v[252:255],a[124:127],v[60:63],v[252:255]
s_waitcnt lgkmcnt(0)
C v208,v208,v209
C v209,v210,v211
M v[252:255],a[120:123],v[52:55],v[252:255]
C v210,v216,v217
C v211,v218,v219
buffer_store_dwordx4 v[208:211], v7, s[8:11], s87 offen offset:1024 sc1
C v212,v212,v213
C v213,v214,v215
C v214,v220,v221
C v215,v222,v223
buffer_store_dwordx4 v[212:215], v7, s[8:11], s89 offen offset:1024 sc1
C v224,v224,v225
C v225,v226,v227
C v226,v232,v233
C v227,v234,v235
buffer_store_dwordx4 v[224:227], v7, s[8:11], s87 offen offset:2048 sc1
C v228,v228,v229
C v229,v230,v231
C v230,v236,v237
C v231,v238,v239
buffer_store_dwordx4 v[228:231], v7, s[8:11], s89 offen offset:2048 sc1
C v240,v240,v241
C v241,v242,v243
C v242,v248,v249
C v243,v250,v251
buffer_store_dwordx4 v[240:243], v7, s[8:11], s87 offen offset:3072 sc1
C v244,v244,v245
C v245,v246,v247
C v246,v252,v253
C v247,v254,v255
buffer_store_dwordx4 v[244:247], v7, s[8:11], s89 offen offset:3072 sc1
M v[64:67],a[64:67],a[128:131],0
s_nop 0
T a[96:97],v23,32768
T a[98:99],v23,34816
M v[64:67],a[68:71],a[132:135],v[64:67]
SA m0,s28,69632
T a[100:101],v23,36864
T a[102:103],v23,38912
M v[64:67],a[72:75],a[136:139],v[64:67]
SA s85,s38,28672
buffer_load_dwordx4 v0, s[12:15], s85 offen offset:0 lds
M v[64:67],a[76:79],a[140:143],v[64:67]
SA s85,s38,34816
T a[104:105],v23,40960
T a[106:107],v23,43008
M v[64:67],a[80:83],a[144:147],v[64:67]
SA s29,s33,0
T a[108:109],v23,45056
T a[110:111],v23,47104
M v[64:67],a[84:87],a[148:151],v[64:67]
SA s30,s33,14336
buffer_load_dwordx4 v0, s[12:15], s85 offen offset:1024 lds
M v[64:67],a[88:91],a[152:155],v[64:67]
SA s85,s38,40960
T a[112:113],v23,49152
T a[114:115],v23,51200
M v[64:67],a[92:95],a[156:159],v[64:67]
T a[116:117],v23,53248
T a[118:119],v23,55296
M v[68:71],a[92:95],a[188:191],0
buffer_load_dwordx4 v0, s[12:15], s85 offen offset:2048 lds
M v[68:71],a[88:91],a[184:187],v[68:71]
SA s85,s38,47104
T a[120:121],v23,57344
T a[122:123],v23,59392
M v[68:71],a[84:87],a[180:183],v[68:71]
T a[124:125],v23,61440
T a[126:127],v23,63488
M v[68:71],a[80:83],a[176:179],v[68:71]
buffer_load_dwordx4 v0, s[12:15], s85 offen offset:3072 lds
M v[68:71],a[76:79],a[172:175],v[68:71]
SA s38,s38,128
G v5,a192
G v6,a193
M v[68:71],a[72:75],a[168:171],v[68:71]
s_sub_u32 s64, 15, s42
M v[68:71],a[68:71],a[164:167],v[68:71]
s_min_u32 s64, s64, s42
M v[68:71],a[64:67],a[160:163],v[68:71]
s_waitcnt lgkmcnt(0)
M v[72:75],a[96:99],a[128:131],0
s_mul_i32 s45, s64, 8704
T a[64:65],v24,32768
T a[66:67],v24,34816
M v[72:75],a[100:103],a[132:135],v[72:75]
s_lshl_b32 s64, s41, 2
T a[68:69],v24,36864
T a[70:71],v24,38912
M v[72:75],a[104:107],a[136:139],v[72:75]
SA s45,s45,s64
M v[72:75],a[108:111],a[140:143],v[72:75]
s_lshl_b32 s64, s20, 8
T a[72:73],v24,40960
T a[74:75],v24,43008
M v[72:75],a[112:115],a[144:147],v[72:75]
SA s45,s45,s64
T a[76:77],v24,45056
T a[78:79],v24,47104
M v[72:75],a[116:119],a[148:151],v[72:75]
SA s45,s45,104992768
M v[72:75],a[120:123],a[152:155],v[72:75]
s_mov_b32 s64, 1024
T a[80:81],v24,49152
T a[82:83],v24,51200
M v[72:75],a[124:127],a[156:159],v[72:75]
s_mov_b32 s66, 4096
T a[84:85],v24,53248
T a[86:87],v24,55296
M v[76:79],a[124:127],a[188:191],0
s_cmp_lt_u32 s42, 8
M v[76:79],a[120:123],a[184:187],v[76:79]
s_cselect_b32 s64, 4352, s64
T a[88:89],v24,57344
T a[90:91],v24,59392
M v[76:79],a[116:119],a[180:183],v[76:79]
s_cselect_b32 s65, 0, 64
T a[92:93],v24,61440
T a[94:95],v24,63488
M v[76:79],a[112:115],a[176:179],v[76:79]
s_cselect_b32 s66, 536870912, s66
MF v64,v5,v64
MF v65,v5,v65
M v[76:79],a[108:111],a[172:175],v[76:79]
SA s3,s45,s64
MF v66,v5,v66
MF v67,v5,v67
M v[76:79],a[104:107],a[168:171],v[76:79]
SA s45,s45,s65
v_lshrrev_b32 v17, 5, v7
v_min_u32 v15, 1, v17
M v[76:79],a[100:103],a[164:167],v[76:79]
SA m0,s28,0
v_lshlrev_b32 v14, 3, v7
v_lshl_or_b32 v16, v15, 29, v14
M v[76:79],a[96:99],a[160:163],v[76:79]
s_waitcnt lgkmcnt(0)
v_cmp_eq_u32 vcc, 1, v17
v_add_u32 v14, s66, v14
M v[80:83],a[64:67],a[128:131],0
SA s85,s38,0
T a[96:97],v25,32768
T a[98:99],v25,34816
M v[80:83],a[68:71],a[132:135],v[80:83]
T a[100:101],v25,36864
T a[102:103],v25,38912
M v[80:83],a[72:75],a[136:139],v[80:83]
buffer_load_dwordx4 v0, s[12:15], s85 offen offset:0 lds
M v[80:83],a[76:79],a[140:143],v[80:83]
SA s85,s38,6144
T a[104:105],v25,40960
T a[106:107],v25,43008
M v[80:83],a[80:83],a[144:147],v[80:83]
T a[108:109],v25,45056
T a[110:111],v25,47104
M v[80:83],a[84:87],a[148:151],v[80:83]
buffer_load_dwordx4 v0, s[12:15], s85 offen offset:1024 lds
M v[80:83],a[88:91],a[152:155],v[80:83]
SA s85,s38,12288
T a[112:113],v25,49152
T a[114:115],v25,51200
M v[80:83],a[92:95],a[156:159],v[80:83]
T a[116:117],v25,53248
T a[118:119],v25,55296
M v[84:87],a[92:95],a[188:191],0
buffer_load_dwordx4 v0, s[12:15], s85 offen offset:2048 lds
M v[84:87],a[88:91],a[184:187],v[84:87]
SA s85,s38,18432
T a[120:121],v25,57344
T a[122:123],v25,59392
M v[84:87],a[84:87],a[180:183],v[84:87]
T a[124:125],v25,61440
T a[126:127],v25,63488
M v[84:87],a[80:83],a[176:179],v[84:87]
buffer_load_dwordx4 v0, s[12:15], s85 offen offset:3072 lds
M v[84:87],a[76:79],a[172:175],v[84:87]
SA m0,s28,4096
v_mov_b32 v15, 1
v_cndmask_b32 v17, v16, v14, vcc
M v[84:87],a[72:75],a[168:171],v[84:87]
SA s85,s38,28672
buffer_load_dwordx4 v0, s[12:15], s85 offen offset:0 lds
M v[84:87],a[68:71],a[164:167],v[84:87]
s_waitcnt vmcnt(5) lgkmcnt(0)
v_min_u32 v10, 1, v7
v_lshlrev_b32 v10, 29, v10
M v[84:87],a[64:67],a[160:163],v[84:87]
s_barrier
M v[88:91],a[96:99],a[128:131],0
SA s85,s38,34816
T a[64:65],v22,0
T a[66:67],v22,2048
M v[88:91],a[100:103],a[132:135],v[88:91]
T a[68:69],v22,4096
T a[70:71],v22,6144
M v[88:91],a[104:107],a[136:139],v[88:91]
buffer_load_dwordx4 v0, s[12:15], s85 offen offset:1024 lds
M v[88:91],a[108:111],a[140:143],v[88:91]
SA s85,s38,40960
T a[72:73],v22,8192
T a[74:75],v22,10240
M v[88:91],a[112:115],a[144:147],v[88:91]
T a[76:77],v22,12288
T a[78:79],v22,14336
M v[88:91],a[116:119],a[148:151],v[88:91]
buffer_load_dwordx4 v0, s[12:15], s85 offen offset:2048 lds
M v[88:91],a[120:123],a[152:155],v[88:91]
SA s85,s38,47104
T a[80:81],v22,16384
T a[82:83],v22,18432
M v[88:91],a[124:127],a[156:159],v[88:91]
T a[84:85],v22,20480
T a[86:87],v22,22528
M v[92:95],a[124:127],a[188:191],0
buffer_store_dword v15, v10, s[8:11], s47 offen sc1
M v[92:95],a[120:123],a[184:187],v[92:95]
s_nop 0
T a[88:89],v22,24576
T a[90:91],v22,26624
M v[92:95],a[116:119],a[180:183],v[92:95]
T a[92:93],v22,28672
T a[94:95],v22,30720
M v[92:95],a[112:115],a[176:179],v[92:95]
buffer_load_dwordx4 v0, s[12:15], s85 offen offset:3072 lds
M v[92:95],a[108:111],a[172:175],v[92:95]
SA s38,s38,128
MF v72,v5,v72
MF v73,v5,v73
M v[92:95],a[104:107],a[168:171],v[92:95]
SA m0,s28,131072
MF v74,v5,v74
MF v75,v5,v75
M v[92:95],a[100:103],a[164:167],v[92:95]
s_waitcnt lgkmcnt(0)
C v64,v64,v65
C v65,v66,v67
M v[92:95],a[96:99],a[160:163],v[92:95]
SA s85,s38,0
C v66,v72,v73
C v67,v74,v75
buffer_store_dwordx4 v[64:67], v7, s[8:11], s29 offen offset:0 sc1
buffer_load_dwordx4 v0, s[12:15], s85 offen offset:0 lds
v_add_u32 v40, 0x20000, v18
v_add_u32 v41, 0x20000, v19
v_add_u32 v42, 0x20000, v20
v_add_u32 v43, 0x20000, v21
SA s85,s38,6144
MF v68,v6,v68
MF v69,v6,v69
MF v70,v6,v70
MF v71,v6,v71
MF v76,v6,v76
MF v77,v6,v77
MF v78,v6,v78
MF v79,v6,v79
C v68,v68,v69
C v69,v70,v71
C v70,v76,v77
C v71,v78,v79
buffer_store_dwordx4 v[68:71], v7, s[8:11], s30 offen offset:0 sc1
buffer_load_dwordx4 v0, s[12:15], s85 offen offset:1024 lds
SA s85,s38,12288
buffer_load_dwordx4 v0, s[12:15], s85 offen offset:2048 lds
SA s85,s38,18432
buffer_load_dwordx4 v0, s[12:15], s85 offen offset:3072 lds
M v[96:99],a[64:67],a[128:131],0
s_nop 0
T a[96:97],v23,0
T a[98:99],v23,2048
M v[96:99],a[68:71],a[132:135],v[96:99]
SA m0,s28,135168
T a[100:101],v23,4096
T a[102:103],v23,6144
M v[96:99],a[72:75],a[136:139],v[96:99]
SA s85,s38,28672
buffer_load_dwordx4 v0, s[12:15], s85 offen offset:0 lds
M v[96:99],a[76:79],a[140:143],v[96:99]
SA s85,s38,34816
T a[104:105],v23,8192
T a[106:107],v23,10240
M v[96:99],a[80:83],a[144:147],v[96:99]
T a[108:109],v23,12288
T a[110:111],v23,14336
M v[96:99],a[84:87],a[148:151],v[96:99]
buffer_load_dwordx4 v0, s[12:15], s85 offen offset:1024 lds
M v[96:99],a[88:91],a[152:155],v[96:99]
SA s85,s38,40960
T a[112:113],v23,16384
T a[114:115],v23,18432
M v[96:99],a[92:95],a[156:159],v[96:99]
T a[116:117],v23,20480
T a[118:119],v23,22528
M v[100:103],a[92:95],a[188:191],0
buffer_load_dwordx4 v0, s[12:15], s85 offen offset:2048 lds
M v[100:103],a[88:91],a[184:187],v[100:103]
SA s85,s38,47104
T a[120:121],v23,24576
T a[122:123],v23,26624
M v[100:103],a[84:87],a[180:183],v[100:103]
T a[124:125],v23,28672
T a[126:127],v23,30720
M v[100:103],a[80:83],a[176:179],v[100:103]
buffer_load_dwordx4 v0, s[12:15], s85 offen offset:3072 lds
M v[100:103],a[76:79],a[172:175],v[100:103]
SA s38,s38,128
MF v80,v5,v80
MF v81,v5,v81
M v[100:103],a[72:75],a[168:171],v[100:103]
SA m0,s28,32768
MF v82,v5,v82
MF v83,v5,v83
M v[100:103],a[68:71],a[164:167],v[100:103]
SA s85,s38,0
buffer_load_dwordx4 v0, s[12:15], s85 offen offset:0 lds
M v[100:103],a[64:67],a[160:163],v[100:103]
s_waitcnt lgkmcnt(0)
MF v88,v5,v88
MF v89,v5,v89
M v[104:107],a[96:99],a[128:131],0
SA s85,s38,6144
T a[64:65],v24,0
T a[66:67],v24,2048
M v[104:107],a[100:103],a[132:135],v[104:107]
T a[68:69],v24,4096
T a[70:71],v24,6144
M v[104:107],a[104:107],a[136:139],v[104:107]
buffer_load_dwordx4 v0, s[12:15], s85 offen offset:1024 lds
M v[104:107],a[108:111],a[140:143],v[104:107]
SA s85,s38,12288
T a[72:73],v24,8192
T a[74:75],v24,10240
M v[104:107],a[112:115],a[144:147],v[104:107]
T a[76:77],v24,12288
T a[78:79],v24,14336
M v[104:107],a[116:119],a[148:151],v[104:107]
buffer_load_dwordx4 v0, s[12:15], s85 offen offset:2048 lds
M v[104:107],a[120:123],a[152:155],v[104:107]
SA s85,s38,18432
T a[80:81],v24,16384
T a[82:83],v24,18432
M v[104:107],a[124:127],a[156:159],v[104:107]
T a[84:85],v24,20480
T a[86:87],v24,22528
M v[108:111],a[124:127],a[188:191],0
buffer_load_dwordx4 v0, s[12:15], s85 offen offset:3072 lds
M v[108:111],a[120:123],a[184:187],v[108:111]
SA m0,s28,36864
T a[88:89],v24,24576
T a[90:91],v24,26624
M v[108:111],a[116:119],a[180:183],v[108:111]
SA s85,s38,28672
T a[92:93],v24,28672
T a[94:95],v24,30720
M v[108:111],a[112:115],a[176:179],v[108:111]
buffer_load_dwordx4 v0, s[12:15], s85 offen offset:0 lds
M v[108:111],a[108:111],a[172:175],v[108:111]
SA s85,s38,34816
MF v90,v5,v90
MF v91,v5,v91
M v[108:111],a[104:107],a[168:171],v[108:111]
C v80,v80,v81
C v81,v82,v83
M v[108:111],a[100:103],a[164:167],v[108:111]
buffer_load_dwordx4 v0, s[12:15], s85 offen offset:1024 lds
M v[108:111],a[96:99],a[160:163],v[108:111]
s_waitcnt lgkmcnt(0)
C v82,v88,v89
C v83,v90,v91
M v[112:115],a[64:67],a[128:131],0
SA s85,s38,40960
T a[96:97],v25,0
T a[98:99],v25,2048
M v[112:115],a[68:71],a[132:135],v[112:115]
T a[100:101],v25,4096
T a[102:103],v25,6144
M v[112:115],a[72:75],a[136:139],v[112:115]
buffer_store_dwordx4 v[80:83], v7, s[8:11], s29 offen offset:1024 sc1
M v[112:115],a[76:79],a[140:143],v[112:115]
s_nop 0
T a[104:105],v25,8192
T a[106:107],v25,10240
M v[112:115],a[80:83],a[144:147],v[112:115]
T a[108:109],v25,12288
T a[110:111],v25,14336
M v[112:115],a[84:87],a[148:151],v[112:115]
buffer_load_dwordx4 v0, s[12:15], s85 offen offset:2048 lds
M v[112:115],a[88:91],a[152:155],v[112:115]
SA s85,s38,47104
T a[112:113],v25,16384
T a[114:115],v25,18432
M v[112:115],a[92:95],a[156:159],v[112:115]
T a[116:117],v25,20480
T a[118:119],v25,22528
M v[116:119],a[92:95],a[188:191],0
buffer_load_dwordx4 v0, s[12:15], s85 offen offset:3072 lds
M v[116:119],a[88:91],a[184:187],v[116:119]
SA s38,s38,128
T a[120:121],v25,24576
T a[122:123],v25,26624
M v[116:119],a[84:87],a[180:183],v[116:119]
SA m0,s28,98304
T a[124:125],v25,28672
T a[126:127],v25,30720
M v[116:119],a[80:83],a[176:179],v[116:119]
SA s85,s38,0
buffer_load_dwordx4 v0, s[12:15], s85 offen offset:0 lds
M v[116:119],a[76:79],a[172:175],v[116:119]
SA s85,s38,6144
MF v84,v6,v84
MF v85,v6,v85
M v[116:119],a[72:75],a[168:171],v[116:119]
buffer_load_dwordx4 v0, s[12:15], s85 offen offset:1024 lds
M v[116:119],a[68:71],a[164:167],v[116:119]
s_waitcnt vmcnt(21) lgkmcnt(0)
MF v86,v6,v86
MF v87,v6,v87
M v[116:119],a[64:67],a[160:163],v[116:119]
s_barrier
M v[120:123],a[96:99],a[128:131],0
SA s85,s38,12288
T a[64:65],v18,0
T a[66:67],v18,2048
M v[120:123],a[100:103],a[132:135],v[120:123]
T a[68:69],v18,4096
T a[70:71],v18,6144
M v[120:123],a[104:107],a[136:139],v[120:123]
buffer_load_dwordx4 v0, s[12:15], s85 offen offset:2048 lds
M v[120:123],a[108:111],a[140:143],v[120:123]
SA s85,s38,18432
T a[72:73],v18,8192
T a[74:75],v18,10240
M v[120:123],a[112:115],a[144:147],v[120:123]
T a[76:77],v18,12288
T a[78:79],v18,14336
M v[120:123],a[116:119],a[148:151],v[120:123]
buffer_load_dwordx4 v0, s[12:15], s85 offen offset:3072 lds
M v[120:123],a[120:123],a[152:155],v[120:123]
s_nop 0
T a[80:81],v18,16384
T a[82:83],v18,18432
M v[120:123],a[124:127],a[156:159],v[120:123]
T a[84:85],v18,20480
T a[86:87],v18,22528
M v[124:127],a[124:127],a[188:191],0
MF v92,v6,v92
MF v93,v6,v93
M v[124:127],a[120:123],a[184:187],v[124:127]
T a[88:89],v18,24576
T a[90:91],v18,26624
M v[124:127],a[116:119],a[180:183],v[124:127]
T a[92:93],v18,28672
T a[94:95],v18,30720
M v[124:127],a[112:115],a[176:179],v[124:127]
MF v94,v6,v94
MF v95,v6,v95
M v[124:127],a[108:111],a[172:175],v[124:127]
C v84,v84,v85
C v85,v86,v87
M v[124:127],a[104:107],a[168:171],v[124:127]
C v86,v92,v93
C v87,v94,v95
M v[124:127],a[100:103],a[164:167],v[124:127]
s_waitcnt lgkmcnt(0)
buffer_store_dwordx4 v[84:87], v7, s[8:11], s30 offen offset:1024 sc1
M v[124:127],a[96:99],a[160:163],v[124:127]
SA s29,s33,2048
SA s30,s33,16384
MF v96,v5,v96
MF v97,v5,v97
MF v98,v5,v98
MF v99,v5,v99
MF v104,v5,v104
MF v105,v5,v105
MF v106,v5,v106
MF v107,v5,v107
C v96,v96,v97
C v97,v98,v99
C v98,v104,v105
C v99,v106,v107
buffer_store_dwordx4 v[96:99], v7, s[8:11], s29 offen offset:0 sc1
MF v100,v6,v100
MF v101,v6,v101
MF v102,v6,v102
MF v103,v6,v103
MF v108,v6,v108
MF v109,v6,v109
MF v110,v6,v110
MF v111,v6,v111
C v100,v100,v101
C v101,v102,v103
C v102,v108,v109
C v103,v110,v111
buffer_store_dwordx4 v[100:103], v7, s[8:11], s30 offen offset:0 sc1
M v[64:67],a[64:67],a[128:131],0
s_nop 0
T a[96:97],v19,0
T a[98:99],v19,2048
M v[64:67],a[68:71],a[132:135],v[64:67]
SA m0,s28,102400
T a[100:101],v19,4096
T a[102:103],v19,6144
M v[64:67],a[72:75],a[136:139],v[64:67]
SA s85,s38,28672
buffer_load_dwordx4 v0, s[12:15], s85 offen offset:0 lds
M v[64:67],a[76:79],a[140:143],v[64:67]
SA s85,s38,34816
T a[104:105],v19,8192
T a[106:107],v19,10240
M v[64:67],a[80:83],a[144:147],v[64:67]
T a[108:109],v19,12288
T a[110:111],v19,14336
M v[64:67],a[84:87],a[148:151],v[64:67]
buffer_load_dwordx4 v0, s[12:15], s85 offen offset:1024 lds
M v[64:67],a[88:91],a[152:155],v[64:67]
s_nop 0
T a[112:113],v19,16384
T a[114:115],v19,18432
M v[64:67],a[92:95],a[156:159],v[64:67]
SA s85,s38,40960
T a[116:117],v19,20480
T a[118:119],v19,22528
M v[68:71],a[92:95],a[188:191],0
buffer_load_dwordx4 v0, s[12:15], s85 offen offset:2048 lds
M v[68:71],a[88:91],a[184:187],v[68:71]
s_nop 0
T a[120:121],v19,24576
T a[122:123],v19,26624
M v[68:71],a[84:87],a[180:183],v[68:71]
T a[124:125],v19,28672
T a[126:127],v19,30720
M v[68:71],a[80:83],a[176:179],v[68:71]
SA s85,s38,47104
MF v112,v5,v112
MF v113,v5,v113
M v[68:71],a[76:79],a[172:175],v[68:71]
buffer_load_dwordx4 v0, s[12:15], s85 offen offset:3072 lds
M v[68:71],a[72:75],a[168:171],v[68:71]
SA s38,s38,128
MF v114,v5,v114
MF v115,v5,v115
M v[68:71],a[68:71],a[164:167],v[68:71]
SA m0,s28,65536
MF v120,v5,v120
MF v121,v5,v121
M v[68:71],a[64:67],a[160:163],v[68:71]
s_waitcnt lgkmcnt(0)
MF v122,v5,v122
MF v123,v5,v123
M v[72:75],a[96:99],a[128:131],0
SA s85,s38,0
T a[64:65],v20,0
T a[66:67],v20,2048
M v[72:75],a[100:103],a[132:135],v[72:75]
T a[68:69],v20,4096
T a[70:71],v20,6144
M v[72:75],a[104:107],a[136:139],v[72:75]
buffer_load_dwordx4 v0, s[12:15], s85 offen offset:0 lds
M v[72:75],a[108:111],a[140:143],v[72:75]
SA s85,s38,6144
T a[72:73],v20,8192
T a[74:75],v20,10240
M v[72:75],a[112:115],a[144:147],v[72:75]
T a[76:77],v20,12288
T a[78:79],v20,14336
M v[72:75],a[116:119],a[148:151],v[72:75]
buffer_load_dwordx4 v0, s[12:15], s85 offen offset:1024 lds
M v[72:75],a[120:123],a[152:155],v[72:75]
SA s85,s38,12288
T a[80:81],v20,16384
T a[82:83],v20,18432
M v[72:75],a[124:127],a[156:159],v[72:75]
T a[84:85],v20,20480
T a[86:87],v20,22528
M v[76:79],a[124:127],a[188:191],0
buffer_load_dwordx4 v0, s[12:15], s85 offen offset:2048 lds
M v[76:79],a[120:123],a[184:187],v[76:79]
SA s85,s38,18432
T a[88:89],v20,24576
T a[90:91],v20,26624
M v[76:79],a[116:119],a[180:183],v[76:79]
T a[92:93],v20,28672
T a[94:95],v20,30720
M v[76:79],a[112:115],a[176:179],v[76:79]
buffer_load_dwordx4 v0, s[12:15], s85 offen offset:3072 lds
M v[76:79],a[108:111],a[172:175],v[76:79]
SA m0,s28,69632
C v112,v112,v113
C v113,v114,v115
M v[76:79],a[104:107],a[168:171],v[76:79]
SA s85,s38,28672
C v114,v120,v121
C v115,v122,v123
M v[76:79],a[100:103],a[164:167],v[76:79]
buffer_store_dwordx4 v[112:115], v7, s[8:11], s29 offen offset:1024 sc1
M v[76:79],a[96:99],a[160:163],v[76:79]
s_waitcnt lgkmcnt(0)
MF v116,v6,v116
MF v117,v6,v117
M v[80:83],a[64:67],a[128:131],0
T a[96:97],v21,0
T a[98:99],v21,2048
M v[80:83],a[68:71],a[132:135],v[80:83]
T a[100:101],v21,4096
T a[102:103],v21,6144
M v[80:83],a[72:75],a[136:139],v[80:83]
buffer_load_dwordx4 v0, s[12:15], s85 offen offset:0 lds
M v[80:83],a[76:79],a[140:143],v[80:83]
SA s85,s38,34816
T a[104:105],v21,8192
T a[106:107],v21,10240
M v[80:83],a[80:83],a[144:147],v[80:83]
T a[108:109],v21,12288
T a[110:111],v21,14336
M v[80:83],a[84:87],a[148:151],v[80:83]
buffer_load_dwordx4 v0, s[12:15], s85 offen offset:1024 lds
M v[80:83],a[88:91],a[152:155],v[80:83]
SA s85,s38,40960
T a[112:113],v21,16384
T a[114:115],v21,18432
M v[80:83],a[92:95],a[156:159],v[80:83]
T a[116:117],v21,20480
T a[118:119],v21,22528
M v[84:87],a[92:95],a[188:191],0
buffer_load_dwordx4 v0, s[12:15], s85 offen offset:2048 lds
M v[84:87],a[88:91],a[184:187],v[84:87]
SA s85,s38,47104
T a[120:121],v21,24576
T a[122:123],v21,26624
M v[84:87],a[84:87],a[180:183],v[84:87]
T a[124:125],v21,28672
T a[126:127],v21,30720
M v[84:87],a[80:83],a[176:179],v[84:87]
buffer_load_dwordx4 v0, s[12:15], s85 offen offset:3072 lds
M v[84:87],a[76:79],a[172:175],v[84:87]
MF v118,v6,v118
MF v119,v6,v119
M v[84:87],a[72:75],a[168:171],v[84:87]
SA s38,s38,128
MF v124,v6,v124
MF v125,v6,v125
M v[84:87],a[68:71],a[164:167],v[84:87]
s_waitcnt vmcnt(29) lgkmcnt(0)
MF v126,v6,v126
MF v127,v6,v127
M v[84:87],a[64:67],a[160:163],v[84:87]
s_barrier
M v[88:91],a[96:99],a[128:131],0
s_nop 0
T a[64:65],v40,0
T a[66:67],v40,2048
M v[88:91],a[100:103],a[132:135],v[88:91]
T a[68:69],v40,4096
T a[70:71],v40,6144
M v[88:91],a[104:107],a[136:139],v[88:91]
C v116,v116,v117
C v117,v118,v119
M v[88:91],a[108:111],a[140:143],v[88:91]
T a[72:73],v40,8192
T a[74:75],v40,10240
M v[88:91],a[112:115],a[144:147],v[88:91]
T a[76:77],v40,12288
T a[78:79],v40,14336
M v[88:91],a[116:119],a[148:151],v[88:91]
C v118,v124,v125
C v119,v126,v127
M v[88:91],a[120:123],a[152:155],v[88:91]
T a[80:81],v40,16384
T a[82:83],v40,18432
M v[88:91],a[124:127],a[156:159],v[88:91]
T a[84:85],v40,20480
T a[86:87],v40,22528
M v[92:95],a[124:127],a[188:191],0
buffer_store_dwordx4 v[116:119], v7, s[8:11], s30 offen offset:1024 sc1
M v[92:95],a[120:123],a[184:187],v[92:95]
SA s29,s33,4096
T a[88:89],v40,24576
T a[90:91],v40,26624
M v[92:95],a[116:119],a[180:183],v[92:95]
SA s30,s33,18432
T a[92:93],v40,28672
T a[94:95],v40,30720
M v[92:95],a[112:115],a[176:179],v[92:95]
MF v64,v5,v64
MF v65,v5,v65
M v[92:95],a[108:111],a[172:175],v[92:95]
MF v66,v5,v66
MF v67,v5,v67
M v[92:95],a[104:107],a[168:171],v[92:95]
MF v72,v5,v72
MF v73,v5,v73
M v[92:95],a[100:103],a[164:167],v[92:95]
s_waitcnt lgkmcnt(0)
MF v74,v5,v74
MF v75,v5,v75
M v[92:95],a[96:99],a[160:163],v[92:95]
C v64,v64,v65
C v65,v66,v67
C v66,v72,v73
C v67,v74,v75
buffer_store_dwordx4 v[64:67], v7, s[8:11], s29 offen offset:0 sc1
MF v68,v6,v68
MF v69,v6,v69
MF v70,v6,v70
MF v71,v6,v71
MF v76,v6,v76
MF v77,v6,v77
MF v78,v6,v78
MF v79,v6,v79
C v68,v68,v69
C v69,v70,v71
C v70,v76,v77
C v71,v78,v79
buffer_store_dwordx4 v[68:71], v7, s[8:11], s30 offen offset:0 sc1
M v[96:99],a[64:67],a[128:131],0
s_nop 0
T a[96:97],v41,0
T a[98:99],v41,2048
M v[96:99],a[68:71],a[132:135],v[96:99]
T a[100:101],v41,4096
T a[102:103],v41,6144
M v[96:99],a[72:75],a[136:139],v[96:99]
MF v80,v5,v80
MF v81,v5,v81
M v[96:99],a[76:79],a[140:143],v[96:99]
T a[104:105],v41,8192
T a[106:107],v41,10240
M v[96:99],a[80:83],a[144:147],v[96:99]
T a[108:109],v41,12288
T a[110:111],v41,14336
M v[96:99],a[84:87],a[148:151],v[96:99]
MF v82,v5,v82
MF v83,v5,v83
M v[96:99],a[88:91],a[152:155],v[96:99]
T a[112:113],v41,16384
T a[114:115],v41,18432
M v[96:99],a[92:95],a[156:159],v[96:99]
T a[116:117],v41,20480
T a[118:119],v41,22528
M v[100:103],a[92:95],a[188:191],0
MF v88,v5,v88
MF v89,v5,v89
M v[100:103],a[88:91],a[184:187],v[100:103]
T a[120:121],v41,24576
T a[122:123],v41,26624
M v[100:103],a[84:87],a[180:183],v[100:103]
T a[124:125],v41,28672
T a[126:127],v41,30720
M v[100:103],a[80:83],a[176:179],v[100:103]
MF v90,v5,v90
MF v91,v5,v91
M v[100:103],a[76:79],a[172:175],v[100:103]
C v80,v80,v81
C v81,v82,v83
M v[100:103],a[72:75],a[168:171],v[100:103]
C v82,v88,v89
C v83,v90,v91
M v[100:103],a[68:71],a[164:167],v[100:103]
buffer_store_dwordx4 v[80:83], v7, s[8:11], s29 offen offset:1024 sc1
M v[100:103],a[64:67],a[160:163],v[100:103]
s_waitcnt lgkmcnt(0)
MF v84,v6,v84
MF v85,v6,v85
M v[104:107],a[96:99],a[128:131],0
T a[64:65],v42,0
T a[66:67],v42,2048
M v[104:107],a[100:103],a[132:135],v[104:107]
T a[68:69],v42,4096
T a[70:71],v42,6144
M v[104:107],a[104:107],a[136:139],v[104:107]
MF v86,v6,v86
MF v87,v6,v87
M v[104:107],a[108:111],a[140:143],v[104:107]
T a[72:73],v42,8192
T a[74:75],v42,10240
M v[104:107],a[112:115],a[144:147],v[104:107]
T a[76:77],v42,12288
T a[78:79],v42,14336
M v[104:107],a[116:119],a[148:151],v[104:107]
MF v92,v6,v92
MF v93,v6,v93
M v[104:107],a[120:123],a[152:155],v[104:107]
T a[80:81],v42,16384
T a[82:83],v42,18432
M v[104:107],a[124:127],a[156:159],v[104:107]
T a[84:85],v42,20480
T a[86:87],v42,22528
M v[108:111],a[124:127],a[188:191],0
MF v94,v6,v94
MF v95,v6,v95
M v[108:111],a[120:123],a[184:187],v[108:111]
T a[88:89],v42,24576
T a[90:91],v42,26624
M v[108:111],a[116:119],a[180:183],v[108:111]
T a[92:93],v42,28672
T a[94:95],v42,30720
M v[108:111],a[112:115],a[176:179],v[108:111]
C v84,v84,v85
C v85,v86,v87
M v[108:111],a[108:111],a[172:175],v[108:111]
C v86,v92,v93
C v87,v94,v95
M v[108:111],a[104:107],a[168:171],v[108:111]
buffer_store_dwordx4 v[84:87], v7, s[8:11], s30 offen offset:1024 sc1
M v[108:111],a[100:103],a[164:167],v[108:111]
SA s29,s33,6144
M v[108:111],a[96:99],a[160:163],v[108:111]
s_waitcnt lgkmcnt(0)
M v[112:115],a[64:67],a[128:131],0
SA s30,s33,20480
T a[96:97],v43,0
T a[98:99],v43,2048
M v[112:115],a[68:71],a[132:135],v[112:115]
T a[100:101],v43,4096
T a[102:103],v43,6144
M v[112:115],a[72:75],a[136:139],v[112:115]
MF v96,v5,v96
MF v97,v5,v97
M v[112:115],a[76:79],a[140:143],v[112:115]
T a[104:105],v43,8192
T a[106:107],v43,10240
M v[112:115],a[80:83],a[144:147],v[112:115]
T a[108:109],v43,12288
T a[110:111],v43,14336
M v[112:115],a[84:87],a[148:151],v[112:115]
MF v98,v5,v98
MF v99,v5,v99
M v[112:115],a[88:91],a[152:155],v[112:115]
T a[112:113],v43,16384
T a[114:115],v43,18432
M v[112:115],a[92:95],a[156:159],v[112:115]
T a[116:117],v43,20480
T a[118:119],v43,22528
M v[116:119],a[92:95],a[188:191],0
MF v104,v5,v104
MF v105,v5,v105
M v[116:119],a[88:91],a[184:187],v[116:119]
T a[120:121],v43,24576
T a[122:123],v43,26624
M v[116:119],a[84:87],a[180:183],v[116:119]
T a[124:125],v43,28672
T a[126:127],v43,30720
M v[116:119],a[80:83],a[176:179],v[116:119]
MF v106,v5,v106
MF v107,v5,v107
M v[116:119],a[76:79],a[172:175],v[116:119]
C v96,v96,v97
C v97,v98,v99
M v[116:119],a[72:75],a[168:171],v[116:119]
C v98,v104,v105
C v99,v106,v107
M v[116:119],a[68:71],a[164:167],v[116:119]
s_waitcnt vmcnt(25) lgkmcnt(0)
buffer_store_dwordx4 v[96:99], v7, s[8:11], s29 offen offset:0 sc1
M v[116:119],a[64:67],a[160:163],v[116:119]
s_barrier
M v[120:123],a[96:99],a[128:131],0
s_nop 0
T a[64:65],v18,32768
T a[66:67],v18,34816
M v[120:123],a[100:103],a[132:135],v[120:123]
T a[68:69],v18,36864
T a[70:71],v18,38912
M v[120:123],a[104:107],a[136:139],v[120:123]
MF v100,v6,v100
MF v101,v6,v101
M v[120:123],a[108:111],a[140:143],v[120:123]
T a[72:73],v18,40960
T a[74:75],v18,43008
M v[120:123],a[112:115],a[144:147],v[120:123]
T a[76:77],v18,45056
T a[78:79],v18,47104
M v[120:123],a[116:119],a[148:151],v[120:123]
MF v102,v6,v102
MF v103,v6,v103
M v[120:123],a[120:123],a[152:155],v[120:123]
T a[80:81],v18,49152
T a[82:83],v18,51200
M v[120:123],a[124:127],a[156:159],v[120:123]
T a[84:85],v18,53248
T a[86:87],v18,55296
M v[124:127],a[124:127],a[188:191],0
MF v108,v6,v108
MF v109,v6,v109
M v[124:127],a[120:123],a[184:187],v[124:127]
T a[88:89],v18,57344
T a[90:91],v18,59392
M v[124:127],a[116:119],a[180:183],v[124:127]
T a[92:93],v18,61440
T a[94:95],v18,63488
M v[124:127],a[112:115],a[176:179],v[124:127]
MF v110,v6,v110
MF v111,v6,v111
M v[124:127],a[108:111],a[172:175],v[124:127]
C v100,v100,v101
C v101,v102,v103
M v[124:127],a[104:107],a[168:171],v[124:127]
C v102,v108,v109
C v103,v110,v111
M v[124:127],a[100:103],a[164:167],v[124:127]
s_waitcnt lgkmcnt(0)
buffer_store_dwordx4 v[100:103], v7, s[8:11], s30 offen offset:0 sc1
M v[124:127],a[96:99],a[160:163],v[124:127]
M v[64:67],a[64:67],a[128:131],0
s_nop 0
T a[96:97],v19,32768
T a[98:99],v19,34816
M v[64:67],a[68:71],a[132:135],v[64:67]
T a[100:101],v19,36864
T a[102:103],v19,38912
M v[64:67],a[72:75],a[136:139],v[64:67]
v_lshrrev_b32 v32, 4, v7
MF v112,v5,v112
M v[64:67],a[76:79],a[140:143],v[64:67]
s_lshr_b32 s74, s41, 3
T a[104:105],v19,40960
T a[106:107],v19,43008
M v[64:67],a[80:83],a[144:147],v[64:67]
s_lshl_b32 s64, s42, 1
T a[108:109],v19,45056
T a[110:111],v19,47104
M v[64:67],a[84:87],a[148:151],v[64:67]
SA s46,s64,s74
MF v113,v5,v113
MF v114,v5,v114
M v[64:67],a[88:91],a[152:155],v[64:67]
s_mul_i32 s46, s46, 4352
T a[112:113],v19,49152
T a[114:115],v19,51200
M v[64:67],a[92:95],a[156:159],v[64:67]
s_and_b32 s72, s41, 7
T a[116:117],v19,53248
T a[118:119],v19,55296
M v[68:71],a[92:95],a[188:191],0
s_lshl_b32 s65, s72, 7
MF v115,v5,v115
MF v120,v5,v120
M v[68:71],a[88:91],a[184:187],v[68:71]
SA s46,s46,s65
T a[120:121],v19,57344
T a[122:123],v19,59392
M v[68:71],a[84:87],a[180:183],v[68:71]
SA s46,s46,104992768
T a[124:125],v19,61440
T a[126:127],v19,63488
M v[68:71],a[80:83],a[176:179],v[68:71]
v_and_b32 v33, 31, v32
MF v121,v5,v121
M v[68:71],a[76:79],a[172:175],v[68:71]
MF v122,v5,v122
MF v123,v5,v123
M v[68:71],a[72:75],a[168:171],v[68:71]
C v112,v112,v113
C v113,v114,v115
M v[68:71],a[68:71],a[164:167],v[68:71]
C v114,v120,v121
C v115,v122,v123
M v[68:71],a[64:67],a[160:163],v[68:71]
s_waitcnt lgkmcnt(0)
buffer_store_dwordx4 v[112:115], v7, s[8:11], s29 offen offset:1024 sc1
M v[72:75],a[96:99],a[128:131],0
s_nop 0
T a[64:65],v20,32768
T a[66:67],v20,34816
M v[72:75],a[100:103],a[132:135],v[72:75]
T a[68:69],v20,36864
T a[70:71],v20,38912
M v[72:75],a[104:107],a[136:139],v[72:75]
MF v116,v6,v116
MF v117,v6,v117
M v[72:75],a[108:111],a[140:143],v[72:75]
T a[72:73],v20,40960
T a[74:75],v20,43008
M v[72:75],a[112:115],a[144:147],v[72:75]
T a[76:77],v20,45056
T a[78:79],v20,47104
M v[72:75],a[116:119],a[148:151],v[72:75]
MF v118,v6,v118
MF v119,v6,v119
M v[72:75],a[120:123],a[152:155],v[72:75]
T a[80:81],v20,49152
T a[82:83],v20,51200
M v[72:75],a[124:127],a[156:159],v[72:75]
T a[84:85],v20,53248
T a[86:87],v20,55296
M v[76:79],a[124:127],a[188:191],0
MF v124,v6,v124
MF v125,v6,v125
M v[76:79],a[120:123],a[184:187],v[76:79]
T a[88:89],v20,57344
T a[90:91],v20,59392
M v[76:79],a[116:119],a[180:183],v[76:79]
T a[92:93],v20,61440
T a[94:95],v20,63488
M v[76:79],a[112:115],a[176:179],v[76:79]
MF v126,v6,v126
MF v127,v6,v127
M v[76:79],a[108:111],a[172:175],v[76:79]
C v116,v116,v117
C v117,v118,v119
M v[76:79],a[104:107],a[168:171],v[76:79]
C v118,v124,v125
C v119,v126,v127
M v[76:79],a[100:103],a[164:167],v[76:79]
buffer_store_dwordx4 v[116:119], v7, s[8:11], s30 offen offset:1024 sc1
M v[76:79],a[96:99],a[160:163],v[76:79]
s_waitcnt lgkmcnt(0)
v_lshlrev_b32 v33, 2, v33
M v[80:83],a[64:67],a[128:131],0
SA s29,s33,8192
T a[96:97],v21,32768
T a[98:99],v21,34816
M v[80:83],a[68:71],a[132:135],v[80:83]
SA s30,s33,22528
T a[100:101],v21,36864
T a[102:103],v21,38912
M v[80:83],a[72:75],a[136:139],v[80:83]
s_lshl_b32 s65, s41, 7
MF v64,v5,v64
MF v65,v5,v65
M v[80:83],a[76:79],a[140:143],v[80:83]
SA s65,s65,104890368
T a[104:105],v21,40960
T a[106:107],v21,43008
M v[80:83],a[80:83],a[144:147],v[80:83]
T a[108:109],v21,45056
T a[110:111],v21,47104
M v[80:83],a[84:87],a[148:151],v[80:83]
buffer_load_dword v31, v33, s[8:11], s65 offen sc1
M v[80:83],a[88:91],a[152:155],v[80:83]
s_nop 0
T a[112:113],v21,49152
T a[114:115],v21,51200
M v[80:83],a[92:95],a[156:159],v[80:83]
T a[116:117],v21,53248
T a[118:119],v21,55296
M v[84:87],a[92:95],a[188:191],0
v_bfe_u32 v34, v32, 4, 1
v_lshlrev_b32 v34, 1, v34
M v[84:87],a[88:91],a[184:187],v[84:87]
T a[120:121],v21,57344
T a[122:123],v21,59392
M v[84:87],a[84:87],a[180:183],v[84:87]
T a[124:125],v21,61440
T a[126:127],v21,63488
M v[84:87],a[80:83],a[176:179],v[84:87]
v_lshrrev_b32 v35, 5, v32
v_add_u32 v34, v34, v35
M v[84:87],a[76:79],a[172:175],v[84:87]
s_mov_b32 s52, s96
MF v66,v5,v66
MF v67,v5,v67
M v[84:87],a[72:75],a[168:171],v[84:87]
s_and_b32 s53, s97, 0xffff
MF v72,v5,v72
MF v73,v5,v73
M v[84:87],a[68:71],a[164:167],v[84:87]
s_waitcnt vmcnt(19) lgkmcnt(0)
MF v74,v5,v74
MF v75,v5,v75
M v[84:87],a[64:67],a[160:163],v[84:87]
s_barrier
M v[88:91],a[96:99],a[128:131],0
s_mov_b32 s54, 1835008
T a[64:65],v22,32768
T a[66:67],v22,34816
M v[88:91],a[100:103],a[132:135],v[88:91]
s_mov_b32 s55, 0x20000
T a[68:69],v22,36864
T a[70:71],v22,38912
M v[88:91],a[104:107],a[136:139],v[88:91]
s_mul_i32 s77, s42, 1835008
C v64,v64,v65
C v65,v66,v67
M v[88:91],a[108:111],a[140:143],v[88:91]
s_mul_i32 s78, s72, 14336
T a[72:73],v22,40960
T a[74:75],v22,43008
M v[88:91],a[112:115],a[144:147],v[88:91]
SA s77,s77,s78
T a[76:77],v22,45056
T a[78:79],v22,47104
M v[88:91],a[116:119],a[148:151],v[88:91]
SA s77,s77,67108864
C v66,v72,v73
C v67,v74,v75
M v[88:91],a[120:123],a[152:155],v[88:91]
s_lshl_b32 s79, s74, 1
T a[80:81],v22,49152
T a[82:83],v22,51200
M v[88:91],a[124:127],a[156:159],v[88:91]
SA s79,s79,s20
T a[84:85],v22,53248
T a[86:87],v22,55296
M v[92:95],a[124:127],a[188:191],0
s_lshl_b32 s71, s74, 1
buffer_store_dwordx4 v[64:67], v7, s[8:11], s29 offen offset:0 sc1
M v[92:95],a[120:123],a[184:187],v[92:95]
SA s71,s71,1
T a[88:89],v22,57344
T a[90:91],v22,59392
M v[92:95],a[116:119],a[180:183],v[92:95]
s_sub_u32 s71, s71, s20
T a[92:93],v22,61440
T a[94:95],v22,63488
M v[92:95],a[112:115],a[176:179],v[92:95]
s_and_b32 s71, s71, 536870912
MF v68,v6,v68
MF v69,v6,v69
M v[92:95],a[108:111],a[172:175],v[92:95]
s_sub_u32 s64, 15, s64
MF v70,v6,v70
MF v71,v6,v71
M v[92:95],a[104:107],a[168:171],v[92:95]
s_sub_u32 s78, s64, 1
MF v76,v6,v76
MF v77,v6,v77
M v[92:95],a[100:103],a[164:167],v[92:95]
s_waitcnt lgkmcnt(0)
MF v78,v6,v78
MF v79,v6,v79
M v[92:95],a[96:99],a[160:163],v[92:95]
s_mul_i32 s78, s78, 1835008
SA s78,s78,s77
s_lshl_b32 s65, s79, 10
SA s78,s78,s65
SA s78,s78,s71
s_lshl_b32 s79, s79, 6
s_or_b32 s79, s79, s71
s_mul_i32 s67, s74, -2
s_lshl_b32 s74, s74, 3
SA s74,s74,s20
s_lshl_b32 s75, s74, 6
SA s76,s75,256
SA s67,s67,3
s_sub_u32 s67, s67, s20
s_and_b32 s67, s67, 536870912
s_or_b32 s76, s76, s67
v_or_b32 v27, s67, v7
v_add_u32 v27, 4096, v27
s_lshl_b32 s65, s74, 10
SA s77,s77,s65
s_lshl_b32 s64, s64, 7
s_lshr_b32 s73, s72, 1
s_sub_u32 s65, 7, s73
s_bitcmp1_b32 s72, 0
s_cselect_b32 s73, s65, s73
s_lshl_b32 s73, s73, 4
s_lshl_b32 s65, s42, 7
SA s73,s73,s65
v_and_b32 v37, 15, v32
v_add_u32 v37, s73, v37
v_add_u32 v29, s64, v37
s_mov_b32 s64, 104857664
v_mul_u32_u24 v38, 896, v37
v_lshl_add_u32 v38, v34, 4, v38
v_lshrrev_b32 v35, 4, v37
v_lshlrev_b32 v35, 5, v35
v_and_b32 v36, 15, v37
v_add_lshl_u32 v35, v35, v36, 2
buffer_load_dword v39, v35, s[8:11], s64 offen sc1
C v68,v68,v69
C v69,v70,v71
C v70,v76,v77
C v71,v78,v79
buffer_store_dwordx4 v[68:71], v7, s[8:11], s30 offen offset:0 sc1
buffer_load_dwordx4 v[48:51], v38, s[56:59], s75 offen
buffer_load_dwordx4 v[52:55], v38, s[56:59], s76 offen
v_mul_u32_u24 v28, 896, v29
v_lshl_add_u32 v28, v34, 4, v28
v_lshrrev_b32 v35, 4, v29
v_lshlrev_b32 v35, 5, v35
v_and_b32 v36, 15, v29
v_add_lshl_u32 v35, v35, v36, 2
buffer_load_dword v26, v35, s[8:11], s64 offen sc1
buffer_load_dwordx4 v[44:47], v28, s[56:59], s79 offen
M v[96:99],a[64:67],a[128:131],0
s_nop 0
T a[96:97],v23,32768
T a[98:99],v23,34816
M v[96:99],a[68:71],a[132:135],v[96:99]
T a[100:101],v23,36864
T a[102:103],v23,38912
M v[96:99],a[72:75],a[136:139],v[96:99]
MF v80,v5,v80
MF v81,v5,v81
M v[96:99],a[76:79],a[140:143],v[96:99]
T a[104:105],v23,40960
T a[106:107],v23,43008
M v[96:99],a[80:83],a[144:147],v[96:99]
T a[108:109],v23,45056
T a[110:111],v23,47104
M v[96:99],a[84:87],a[148:151],v[96:99]
MF v82,v5,v82
MF v83,v5,v83
M v[96:99],a[88:91],a[152:155],v[96:99]
T a[112:113],v23,49152
T a[114:115],v23,51200
M v[96:99],a[92:95],a[156:159],v[96:99]
T a[116:117],v23,53248
T a[118:119],v23,55296
M v[100:103],a[92:95],a[188:191],0
MF v88,v5,v88
MF v89,v5,v89
M v[100:103],a[88:91],a[184:187],v[100:103]
T a[120:121],v23,57344
T a[122:123],v23,59392
M v[100:103],a[84:87],a[180:183],v[100:103]
T a[124:125],v23,61440
T a[126:127],v23,63488
M v[100:103],a[80:83],a[176:179],v[100:103]
MF v90,v5,v90
MF v91,v5,v91
M v[100:103],a[76:79],a[172:175],v[100:103]
C v80,v80,v81
C v81,v82,v83
M v[100:103],a[72:75],a[168:171],v[100:103]
C v82,v88,v89
C v83,v90,v91
M v[100:103],a[68:71],a[164:167],v[100:103]
buffer_store_dwordx4 v[80:83], v7, s[8:11], s29 offen offset:1024 sc1
M v[100:103],a[64:67],a[160:163],v[100:103]
s_waitcnt lgkmcnt(0)
MF v84,v6,v84
MF v85,v6,v85
M v[104:107],a[96:99],a[128:131],0
T a[64:65],v24,32768
T a[66:67],v24,34816
M v[104:107],a[100:103],a[132:135],v[104:107]
T a[68:69],v24,36864
T a[70:71],v24,38912
M v[104:107],a[104:107],a[136:139],v[104:107]
MF v86,v6,v86
MF v87,v6,v87
M v[104:107],a[108:111],a[140:143],v[104:107]
T a[72:73],v24,40960
T a[74:75],v24,43008
M v[104:107],a[112:115],a[144:147],v[104:107]
T a[76:77],v24,45056
T a[78:79],v24,47104
M v[104:107],a[116:119],a[148:151],v[104:107]
MF v92,v6,v92
MF v93,v6,v93
M v[104:107],a[120:123],a[152:155],v[104:107]
T a[80:81],v24,49152
T a[82:83],v24,51200
M v[104:107],a[124:127],a[156:159],v[104:107]
T a[84:85],v24,53248
T a[86:87],v24,55296
M v[108:111],a[124:127],a[188:191],0
MF v94,v6,v94
MF v95,v6,v95
M v[108:111],a[120:123],a[184:187],v[108:111]
T a[88:89],v24,57344
T a[90:91],v24,59392
M v[108:111],a[116:119],a[180:183],v[108:111]
T a[92:93],v24,61440
T a[94:95],v24,63488
M v[108:111],a[112:115],a[176:179],v[108:111]
C v84,v84,v85
C v85,v86,v87
M v[108:111],a[108:111],a[172:175],v[108:111]
C v86,v92,v93
C v87,v94,v95
M v[108:111],a[104:107],a[168:171],v[108:111]
buffer_store_dwordx4 v[84:87], v7, s[8:11], s30 offen offset:1024 sc1
M v[108:111],a[100:103],a[164:167],v[108:111]
SA s29,s33,10240
M v[108:111],a[96:99],a[160:163],v[108:111]
s_waitcnt lgkmcnt(0)
M v[112:115],a[64:67],a[128:131],0
SA s30,s33,24576
T a[96:97],v25,32768
T a[98:99],v25,34816
M v[112:115],a[68:71],a[132:135],v[112:115]
T a[100:101],v25,36864
T a[102:103],v25,38912
M v[112:115],a[72:75],a[136:139],v[112:115]
MF v96,v5,v96
MF v97,v5,v97
M v[112:115],a[76:79],a[140:143],v[112:115]
T a[104:105],v25,40960
T a[106:107],v25,43008
M v[112:115],a[80:83],a[144:147],v[112:115]
T a[108:109],v25,45056
T a[110:111],v25,47104
M v[112:115],a[84:87],a[148:151],v[112:115]
MF v98,v5,v98
MF v99,v5,v99
M v[112:115],a[88:91],a[152:155],v[112:115]
T a[112:113],v25,49152
T a[114:115],v25,51200
M v[112:115],a[92:95],a[156:159],v[112:115]
T a[116:117],v25,53248
T a[118:119],v25,55296
M v[116:119],a[92:95],a[188:191],0
s_mov_b32 s84, s45
MF v104,v5,v104
MF v105,v5,v105
M v[116:119],a[88:91],a[184:187],v[116:119]
T a[120:121],v25,57344
T a[122:123],v25,59392
M v[116:119],a[84:87],a[180:183],v[116:119]
T a[124:125],v25,61440
T a[126:127],v25,63488
M v[116:119],a[80:83],a[176:179],v[116:119]
MF v106,v5,v106
MF v107,v5,v107
M v[116:119],a[76:79],a[172:175],v[116:119]
C v96,v96,v97
C v97,v98,v99
M v[116:119],a[72:75],a[168:171],v[116:119]
C v98,v104,v105
C v99,v106,v107
M v[116:119],a[68:71],a[164:167],v[116:119]
s_waitcnt vmcnt(19) lgkmcnt(0)
buffer_store_dwordx4 v[96:99], v7, s[8:11], s29 offen offset:0 sc1
M v[116:119],a[64:67],a[160:163],v[116:119]
s_barrier
M v[120:123],a[96:99],a[128:131],0
s_nop 0
T a[64:65],v22,0
T a[66:67],v22,2048
M v[120:123],a[100:103],a[132:135],v[120:123]
T a[68:69],v22,4096
T a[70:71],v22,6144
M v[120:123],a[104:107],a[136:139],v[120:123]
MF v100,v6,v100
MF v101,v6,v101
M v[120:123],a[108:111],a[140:143],v[120:123]
T a[72:73],v22,8192
T a[74:75],v22,10240
M v[120:123],a[112:115],a[144:147],v[120:123]
s_waitcnt vmcnt(11)
T a[76:77],v22,12288
T a[78:79],v22,14336
M v[120:123],a[116:119],a[148:151],v[120:123]
buffer_store_dword v15, v17, s[8:11], s84 offen sc1
M v[120:123],a[120:123],a[152:155],v[120:123]
s_nop 0
T a[80:81],v22,16384
T a[82:83],v22,18432
M v[120:123],a[124:127],a[156:159],v[120:123]
T a[84:85],v22,20480
T a[86:87],v22,22528
M v[124:127],a[124:127],a[188:191],0
MF v102,v6,v102
MF v103,v6,v103
M v[124:127],a[120:123],a[184:187],v[124:127]
T a[88:89],v22,24576
T a[90:91],v22,26624
M v[124:127],a[116:119],a[180:183],v[124:127]
T a[92:93],v22,28672
T a[94:95],v22,30720
M v[124:127],a[112:115],a[176:179],v[124:127]
MF v108,v6,v108
MF v109,v6,v109
M v[124:127],a[108:111],a[172:175],v[124:127]
MF v110,v6,v110
MF v111,v6,v111
M v[124:127],a[104:107],a[168:171],v[124:127]
C v100,v100,v101
C v101,v102,v103
M v[124:127],a[100:103],a[164:167],v[124:127]
s_waitcnt lgkmcnt(0)
C v102,v108,v109
C v103,v110,v111
M v[124:127],a[96:99],a[160:163],v[124:127]
buffer_store_dwordx4 v[100:103], v7, s[8:11], s30 offen offset:0 sc1
M v[64:67],a[64:67],a[128:131],0
s_nop 0
T a[96:97],v23,0
T a[98:99],v23,2048
M v[64:67],a[68:71],a[132:135],v[64:67]
T a[100:101],v23,4096
T a[102:103],v23,6144
M v[64:67],a[72:75],a[136:139],v[64:67]
MF v112,v5,v112
MF v113,v5,v113
M v[64:67],a[76:79],a[140:143],v[64:67]
T a[104:105],v23,8192
T a[106:107],v23,10240
M v[64:67],a[80:83],a[144:147],v[64:67]
T a[108:109],v23,12288
T a[110:111],v23,14336
M v[64:67],a[84:87],a[148:151],v[64:67]
MF v114,v5,v114
MF v115,v5,v115
M v[64:67],a[88:91],a[152:155],v[64:67]
T a[112:113],v23,16384
T a[114:115],v23,18432
M v[64:67],a[92:95],a[156:159],v[64:67]
T a[116:117],v23,20480
T a[118:119],v23,22528
M v[68:71],a[92:95],a[188:191],0
MF v120,v5,v120
MF v121,v5,v121
M v[68:71],a[88:91],a[184:187],v[68:71]
T a[120:121],v23,24576
T a[122:123],v23,26624
M v[68:71],a[84:87],a[180:183],v[68:71]
T a[124:125],v23,28672
T a[126:127],v23,30720
M v[68:71],a[80:83],a[176:179],v[68:71]
MF v122,v5,v122
MF v123,v5,v123
M v[68:71],a[76:79],a[172:175],v[68:71]
C v112,v112,v113
C v113,v114,v115
M v[68:71],a[72:75],a[168:171],v[68:71]
C v114,v120,v121
C v115,v122,v123
M v[68:71],a[68:71],a[164:167],v[68:71]
buffer_store_dwordx4 v[112:115], v7, s[8:11], s29 offen offset:1024 sc1
M v[68:71],a[64:67],a[160:163],v[68:71]
s_waitcnt lgkmcnt(0)
MF v116,v6,v116
MF v117,v6,v117
M v[72:75],a[96:99],a[128:131],0
T a[64:65],v24,0
T a[66:67],v24,2048
M v[72:75],a[100:103],a[132:135],v[72:75]
T a[68:69],v24,4096
T a[70:71],v24,6144
M v[72:75],a[104:107],a[136:139],v[72:75]
MF v118,v6,v118
MF v119,v6,v119
M v[72:75],a[108:111],a[140:143],v[72:75]
T a[72:73],v24,8192
T a[74:75],v24,10240
M v[72:75],a[112:115],a[144:147],v[72:75]
T a[76:77],v24,12288
T a[78:79],v24,14336
M v[72:75],a[116:119],a[148:151],v[72:75]
MF v124,v6,v124
MF v125,v6,v125
M v[72:75],a[120:123],a[152:155],v[72:75]
T a[80:81],v24,16384
T a[82:83],v24,18432
M v[72:75],a[124:127],a[156:159],v[72:75]
T a[84:85],v24,20480
T a[86:87],v24,22528
M v[76:79],a[124:127],a[188:191],0
MF v126,v6,v126
MF v127,v6,v127
M v[76:79],a[120:123],a[184:187],v[76:79]
T a[88:89],v24,24576
T a[90:91],v24,26624
M v[76:79],a[116:119],a[180:183],v[76:79]
T a[92:93],v24,28672
T a[94:95],v24,30720
M v[76:79],a[112:115],a[176:179],v[76:79]
C v116,v116,v117
C v117,v118,v119
M v[76:79],a[108:111],a[172:175],v[76:79]
C v118,v124,v125
C v119,v126,v127
M v[76:79],a[104:107],a[168:171],v[76:79]
buffer_store_dwordx4 v[116:119], v7, s[8:11], s30 offen offset:1024 sc1
M v[76:79],a[100:103],a[164:167],v[76:79]
SA s29,s33,12288
M v[76:79],a[96:99],a[160:163],v[76:79]
s_waitcnt lgkmcnt(0)
M v[80:83],a[64:67],a[128:131],0
SA s30,s33,26624
T a[96:97],v25,0
T a[98:99],v25,2048
M v[80:83],a[68:71],a[132:135],v[80:83]
T a[100:101],v25,4096
T a[102:103],v25,6144
M v[80:83],a[72:75],a[136:139],v[80:83]
MF v64,v5,v64
MF v65,v5,v65
M v[80:83],a[76:79],a[140:143],v[80:83]
T a[104:105],v25,8192
T a[106:107],v25,10240
M v[80:83],a[80:83],a[144:147],v[80:83]
T a[108:109],v25,12288
T a[110:111],v25,14336
M v[80:83],a[84:87],a[148:151],v[80:83]
MF v66,v5,v66
MF v67,v5,v67
M v[80:83],a[88:91],a[152:155],v[80:83]
T a[112:113],v25,16384
T a[114:115],v25,18432
M v[80:83],a[92:95],a[156:159],v[80:83]
T a[116:117],v25,20480
T a[118:119],v25,22528
M v[84:87],a[92:95],a[188:191],0
MF v72,v5,v72
MF v73,v5,v73
M v[84:87],a[88:91],a[184:187],v[84:87]
T a[120:121],v25,24576
T a[122:123],v25,26624
M v[84:87],a[84:87],a[180:183],v[84:87]
T a[124:125],v25,28672
T a[126:127],v25,30720
M v[84:87],a[80:83],a[176:179],v[84:87]
MF v74,v5,v74
MF v75,v5,v75
M v[84:87],a[76:79],a[172:175],v[84:87]
C v64,v64,v65
C v65,v66,v67
M v[84:87],a[72:75],a[168:171],v[84:87]
C v66,v72,v73
C v67,v74,v75
M v[84:87],a[68:71],a[164:167],v[84:87]
buffer_store_dwordx4 v[64:67], v7, s[8:11], s29 offen offset:0 sc1
M v[84:87],a[64:67],a[160:163],v[84:87]
s_waitcnt lgkmcnt(0)
MF v68,v6,v68
MF v69,v6,v69
M v[88:91],a[96:99],a[128:131],0
MF v70,v6,v70
MF v71,v6,v71
M v[88:91],a[100:103],a[132:135],v[88:91]
MF v76,v6,v76
MF v77,v6,v77
M v[88:91],a[104:107],a[136:139],v[88:91]
MF v78,v6,v78
MF v79,v6,v79
M v[88:91],a[108:111],a[140:143],v[88:91]
C v68,v68,v69
C v69,v70,v71
M v[88:91],a[112:115],a[144:147],v[88:91]
C v70,v76,v77
C v71,v78,v79
M v[88:91],a[116:119],a[148:151],v[88:91]
buffer_store_dwordx4 v[68:71], v7, s[8:11], s30 offen offset:0 sc1
M v[88:91],a[120:123],a[152:155],v[88:91]
M v[88:91],a[124:127],a[156:159],v[88:91]
M v[92:95],a[124:127],a[188:191],0
M v[92:95],a[120:123],a[184:187],v[92:95]
M v[92:95],a[116:119],a[180:183],v[92:95]
M v[92:95],a[112:115],a[176:179],v[92:95]
MF v80,v5,v80
MF v81,v5,v81
M v[92:95],a[108:111],a[172:175],v[92:95]
MF v82,v5,v82
MF v83,v5,v83
M v[92:95],a[104:107],a[168:171],v[92:95]
MF v88,v5,v88
MF v89,v5,v89
M v[92:95],a[100:103],a[164:167],v[92:95]
MF v90,v5,v90
MF v91,v5,v91
M v[92:95],a[96:99],a[160:163],v[92:95]
C v80,v80,v81
C v81,v82,v83
C v82,v88,v89
C v83,v90,v91
buffer_store_dwordx4 v[80:83], v7, s[8:11], s29 offen offset:1024 sc1
MF v84,v6,v84
MF v85,v6,v85
MF v86,v6,v86
MF v87,v6,v87
MF v92,v6,v92
MF v93,v6,v93
MF v94,v6,v94
MF v95,v6,v95
C v84,v84,v85
C v85,v86,v87
C v86,v92,v93
C v87,v94,v95
buffer_store_dwordx4 v[84:87], v7, s[8:11], s30 offen offset:1024 sc1
buffer_load_dword v9, v33, s[8:11], s46 offen sc1
s_waitcnt vmcnt(1)
buffer_store_dword v15, v16, s[8:11], s3 offen sc1
L_red1:
s_waitcnt vmcnt(0)
v_cmp_eq_u32 vcc, 1, v9
s_mov_b32 s91, 65536
s_mov_b32 s69, 0xffff
s_and_b32 s70, vcc_lo, s69
s_mov_b32 s68, s70
s_cmp_lg_u32 s70, 0
s_cbranch_scc1 L_rk0
s_call_b64 s[36:37], L_rpoll
L_rk0:
s_ff1_i32_b32 s71, s70
s_bitset0_b32 s70, s71
s_mul_i32 s71, s71, 114688
SA s72,s71,s77
buffer_load_dwordx4 v[128:131], v7, s[8:11], s72 offen sc1
buffer_load_dwordx4 v[132:135], v27, s[8:11], s72 offen sc1
s_cmp_lg_u32 s70, 0
s_cbranch_scc1 L_rk1
s_call_b64 s[36:37], L_rpoll
L_rk1:
s_ff1_i32_b32 s71, s70
s_bitset0_b32 s70, s71
s_mul_i32 s71, s71, 114688
SA s72,s71,s77
buffer_load_dwordx4 v[136:139], v7, s[8:11], s72 offen sc1
buffer_load_dwordx4 v[140:143], v27, s[8:11], s72 offen sc1
v_readlane_b32 s92, v31, 0
v_readlane_b32 s94, v31, 1
v_lshlrev_b32 v64, 16, v48
v_and_b32 v65, 0xffff0000, v48
v_lshlrev_b32 v66, 16, v49
v_and_b32 v67, 0xffff0000, v49
v_lshlrev_b32 v68, 16, v50
v_and_b32 v69, 0xffff0000, v50
v_lshlrev_b32 v70, 16, v51
v_and_b32 v71, 0xffff0000, v51
v_lshlrev_b32 v72, 16, v52
v_and_b32 v73, 0xffff0000, v52
v_lshlrev_b32 v74, 16, v53
v_and_b32 v75, 0xffff0000, v53
v_lshlrev_b32 v76, 16, v54
v_and_b32 v77, 0xffff0000, v54
v_lshlrev_b32 v78, 16, v55
v_and_b32 v79, 0xffff0000, v55
v_sub_f32 v30, 1.0, v39
v_cmp_eq_u32 s[80:81], s92, v37
v_cmp_eq_u32 s[82:83], s94, v37
s_nop 0
s_or_b64 vcc, s[80:81], s[82:83]
s_cbranch_vccnz L_moe0
L_moe_ret0:
MF v64,v30,v64
MF v65,v30,v65
MF v66,v30,v66
MF v67,v30,v67
MF v68,v30,v68
MF v69,v30,v69
MF v70,v30,v70
MF v71,v30,v71
MF v72,v30,v72
MF v73,v30,v73
MF v74,v30,v74
MF v75,v30,v75
MF v76,v30,v76
MF v77,v30,v77
MF v78,v30,v78
MF v79,v30,v79
s_cmp_lg_u32 s70, 0
s_cbranch_scc1 L_rk2
s_call_b64 s[36:37], L_rpoll
L_rk2:
s_ff1_i32_b32 s71, s70
s_bitset0_b32 s70, s71
s_mul_i32 s71, s71, 114688
SA s72,s71,s77
buffer_load_dwordx4 v[144:147], v7, s[8:11], s72 offen sc1
buffer_load_dwordx4 v[148:151], v27, s[8:11], s72 offen sc1
v_lshlrev_b32 v80, 16, v44
v_and_b32 v81, 0xffff0000, v44
v_lshlrev_b32 v82, 16, v45
v_and_b32 v83, 0xffff0000, v45
v_lshlrev_b32 v84, 16, v46
v_and_b32 v85, 0xffff0000, v46
v_lshlrev_b32 v86, 16, v47
v_and_b32 v87, 0xffff0000, v47
v_sub_f32 v30, 1.0, v26
v_cmp_eq_u32 s[80:81], s92, v29
v_cmp_eq_u32 s[82:83], s94, v29
s_nop 0
s_or_b64 vcc, s[80:81], s[82:83]
s_cbranch_vccnz L_moe1
L_moe_ret1:
MF v80,v30,v80
MF v81,v30,v81
MF v82,v30,v82
MF v83,v30,v83
MF v84,v30,v84
MF v85,v30,v85
MF v86,v30,v86
MF v87,v30,v87
s_waitcnt vmcnt(5)
M v[96:99],a[246:249],v[128:131],0
M v[100:103],a[244:247],v[128:131],0
s_waitcnt vmcnt(4)
M v[104:107],a[246:249],v[132:135],0
M v[108:111],a[244:247],v[132:135],0
s_cmp_lg_u32 s70, 0
s_cbranch_scc1 L_rk3
s_call_b64 s[36:37], L_rpoll
L_rk3:
s_ff1_i32_b32 s71, s70
s_bitset0_b32 s70, s71
s_mul_i32 s71, s71, 114688
SA s72,s71,s77
buffer_load_dwordx4 v[152:155], v7, s[8:11], s72 offen sc1
buffer_load_dwordx4 v[156:159], v27, s[8:11], s72 offen sc1
s_waitcnt vmcnt(5)
M v[96:99],a[246:249],v[136:139],v[96:99]
M v[100:103],a[244:247],v[136:139],v[100:103]
s_waitcnt vmcnt(4)
M v[104:107],a[246:249],v[140:143],v[104:107]
M v[108:111],a[244:247],v[140:143],v[108:111]
s_cmp_lg_u32 s70, 0
s_cbranch_scc1 L_rk4
s_call_b64 s[36:37], L_rpoll
L_rk4:
s_ff1_i32_b32 s71, s70
s_bitset0_b32 s70, s71
s_mul_i32 s71, s71, 114688
SA s72,s71,s77
buffer_load_dwordx4 v[160:163], v7, s[8:11], s72 offen sc1
buffer_load_dwordx4 v[164:167], v27, s[8:11], s72 offen sc1
s_waitcnt vmcnt(5)
M v[96:99],a[246:249],v[144:147],v[96:99]
M v[100:103],a[244:247],v[144:147],v[100:103]
s_waitcnt vmcnt(4)
M v[104:107],a[246:249],v[148:151],v[104:107]
M v[108:111],a[244:247],v[148:151],v[108:111]
s_cmp_lg_u32 s70, 0
s_cbranch_scc1 L_rk5
s_call_b64 s[36:37], L_rpoll
L_rk5:
s_ff1_i32_b32 s71, s70
s_bitset0_b32 s70, s71
s_mul_i32 s71, s71, 114688
SA s72,s71,s77
buffer_load_dwordx4 v[168:171], v7, s[8:11], s72 offen sc1
buffer_load_dwordx4 v[172:175], v27, s[8:11], s72 offen sc1
s_waitcnt vmcnt(5)
M v[96:99],a[246:249],v[152:155],v[96:99]
M v[100:103],a[244:247],v[152:155],v[100:103]
s_waitcnt vmcnt(4)
M v[104:107],a[246:249],v[156:159],v[104:107]
M v[108:111],a[244:247],v[156:159],v[108:111]
s_cmp_lg_u32 s70, 0
s_cbranch_scc1 L_rk6
s_call_b64 s[36:37], L_rpoll
L_rk6:
s_ff1_i32_b32 s71, s70
s_bitset0_b32 s70, s71
s_mul_i32 s71, s71, 114688
SA s72,s71,s77
buffer_load_dwordx4 v[176:179], v7, s[8:11], s72 offen sc1
buffer_load_dwordx4 v[180:183], v27, s[8:11], s72 offen sc1
s_waitcnt vmcnt(5)
M v[96:99],a[246:249],v[160:163],v[96:99]
M v[100:103],a[244:247],v[160:163],v[100:103]
s_waitcnt vmcnt(4)
M v[104:107],a[246:249],v[164:167],v[104:107]
M v[108:111],a[244:247],v[164:167],v[108:111]
s_cmp_lg_u32 s70, 0
s_cbranch_scc1 L_rk7
s_call_b64 s[36:37], L_rpoll
L_rk7:
s_ff1_i32_b32 s71, s70
s_bitset0_b32 s70, s71
s_mul_i32 s71, s71, 114688
SA s72,s71,s77
buffer_load_dwordx4 v[184:187], v7, s[8:11], s72 offen sc1
buffer_load_dwordx4 v[188:191], v27, s[8:11], s72 offen sc1
s_waitcnt vmcnt(5)
M v[96:99],a[246:249],v[168:171],v[96:99]
M v[100:103],a[244:247],v[168:171],v[100:103]
s_waitcnt vmcnt(4)
M v[104:107],a[246:249],v[172:175],v[104:107]
M v[108:111],a[244:247],v[172:175],v[108:111]
s_cmp_lg_u32 s70, 0
s_cbranch_scc1 L_rk8
s_call_b64 s[36:37], L_rpoll
L_rk8:
s_ff1_i32_b32 s71, s70
s_bitset0_b32 s70, s71
s_mul_i32 s71, s71, 114688
SA s72,s71,s77
buffer_load_dwordx4 v[128:131], v7, s[8:11], s72 offen sc1
buffer_load_dwordx4 v[132:135], v27, s[8:11], s72 offen sc1
s_waitcnt vmcnt(5)
M v[96:99],a[246:249],v[176:179],v[96:99]
M v[100:103],a[244:247],v[176:179],v[100:103]
s_waitcnt vmcnt(4)
M v[104:107],a[246:249],v[180:183],v[104:107]
M v[108:111],a[244:247],v[180:183],v[108:111]
s_cmp_lg_u32 s70, 0
s_cbranch_scc1 L_rk9
s_call_b64 s[36:37], L_rpoll
L_rk9:
s_ff1_i32_b32 s71, s70
s_bitset0_b32 s70, s71
s_mul_i32 s71, s71, 114688
SA s72,s71,s77
buffer_load_dwordx4 v[136:139], v7, s[8:11], s72 offen sc1
buffer_load_dwordx4 v[140:143], v27, s[8:11], s72 offen sc1
s_waitcnt vmcnt(5)
M v[96:99],a[246:249],v[184:187],v[96:99]
M v[100:103],a[244:247],v[184:187],v[100:103]
s_waitcnt vmcnt(4)
M v[104:107],a[246:249],v[188:191],v[104:107]
M v[108:111],a[244:247],v[188:191],v[108:111]
s_cmp_lg_u32 s70, 0
s_cbranch_scc1 L_rk10
s_call_b64 s[36:37], L_rpoll
L_rk10:
s_ff1_i32_b32 s71, s70
s_bitset0_b32 s70, s71
s_mul_i32 s71, s71, 114688
SA s72,s71,s77
buffer_load_dwordx4 v[144:147], v7, s[8:11], s72 offen sc1
buffer_load_dwordx4 v[148:151], v27, s[8:11], s72 offen sc1
s_waitcnt vmcnt(5)
M v[96:99],a[246:249],v[128:131],v[96:99]
M v[100:103],a[244:247],v[128:131],v[100:103]
s_waitcnt vmcnt(4)
M v[104:107],a[246:249],v[132:135],v[104:107]
M v[108:111],a[244:247],v[132:135],v[108:111]
s_cmp_lg_u32 s70, 0
s_cbranch_scc1 L_rk11
s_call_b64 s[36:37], L_rpoll
L_rk11:
s_ff1_i32_b32 s71, s70
s_bitset0_b32 s70, s71
s_mul_i32 s71, s71, 114688
SA s72,s71,s77
buffer_load_dwordx4 v[152:155], v7, s[8:11], s72 offen sc1
buffer_load_dwordx4 v[156:159], v27, s[8:11], s72 offen sc1
s_waitcnt vmcnt(5)
M v[96:99],a[246:249],v[136:139],v[96:99]
M v[100:103],a[244:247],v[136:139],v[100:103]
s_waitcnt vmcnt(4)
M v[104:107],a[246:249],v[140:143],v[104:107]
M v[108:111],a[244:247],v[140:143],v[108:111]
s_cmp_lg_u32 s70, 0
s_cbranch_scc1 L_rk12
s_call_b64 s[36:37], L_rpoll
L_rk12:
s_ff1_i32_b32 s71, s70
s_bitset0_b32 s70, s71
s_mul_i32 s71, s71, 114688
SA s72,s71,s77
buffer_load_dwordx4 v[160:163], v7, s[8:11], s72 offen sc1
buffer_load_dwordx4 v[164:167], v27, s[8:11], s72 offen sc1
buffer_load_dword v8, v33, s[8:11], s46 offen sc1
s_waitcnt vmcnt(6)
M v[96:99],a[246:249],v[144:147],v[96:99]
M v[100:103],a[244:247],v[144:147],v[100:103]
s_waitcnt vmcnt(5)
M v[104:107],a[246:249],v[148:151],v[104:107]
M v[108:111],a[244:247],v[148:151],v[108:111]
s_cmp_lg_u32 s70, 0
s_cbranch_scc1 L_rk13
s_call_b64 s[36:37], L_rpoll
L_rk13:
s_ff1_i32_b32 s71, s70
s_bitset0_b32 s70, s71
s_mul_i32 s71, s71, 114688
SA s72,s71,s77
buffer_load_dwordx4 v[168:171], v7, s[8:11], s72 offen sc1
buffer_load_dwordx4 v[172:175], v27, s[8:11], s72 offen sc1
s_waitcnt vmcnt(6)
M v[96:99],a[246:249],v[152:155],v[96:99]
M v[100:103],a[244:247],v[152:155],v[100:103]
s_waitcnt vmcnt(5)
M v[104:107],a[246:249],v[156:159],v[104:107]
M v[108:111],a[244:247],v[156:159],v[108:111]
s_cmp_lg_u32 s70, 0
s_cbranch_scc1 L_rk14
s_call_b64 s[36:37], L_rpoll
L_rk14:
s_ff1_i32_b32 s71, s70
s_bitset0_b32 s70, s71
s_mul_i32 s71, s71, 114688
SA s72,s71,s77
buffer_load_dwordx4 v[176:179], v7, s[8:11], s72 offen sc1
buffer_load_dwordx4 v[180:183], v27, s[8:11], s72 offen sc1
s_waitcnt vmcnt(6)
M v[96:99],a[246:249],v[160:163],v[96:99]
M v[100:103],a[244:247],v[160:163],v[100:103]
s_waitcnt vmcnt(5)
M v[104:107],a[246:249],v[164:167],v[104:107]
M v[108:111],a[244:247],v[164:167],v[108:111]
s_cmp_lg_u32 s70, 0
s_cbranch_scc1 L_rk15
s_call_b64 s[36:37], L_rpoll
L_rk15:
s_ff1_i32_b32 s71, s70
s_bitset0_b32 s70, s71
s_mul_i32 s71, s71, 114688
SA s72,s71,s77
buffer_load_dwordx4 v[184:187], v7, s[8:11], s72 offen sc1
buffer_load_dwordx4 v[188:191], v27, s[8:11], s72 offen sc1
s_waitcnt vmcnt(5)
M v[96:99],a[246:249],v[168:171],v[96:99]
M v[100:103],a[244:247],v[168:171],v[100:103]
s_waitcnt vmcnt(4)
M v[104:107],a[246:249],v[172:175],v[104:107]
M v[108:111],a[244:247],v[172:175],v[108:111]
v_cmp_eq_u32 vcc, 1, v8
s_mov_b32 s69, 0xffff0000
s_and_b32 s70, vcc_lo, s69
s_mov_b32 s68, s70
s_cmp_lg_u32 s70, 0
s_cbranch_scc1 L_rk16
s_call_b64 s[36:37], L_rpoll
L_rk16:
s_ff1_i32_b32 s71, s70
s_bitset0_b32 s70, s71
s_mul_i32 s71, s71, 114688
SA s72,s71,s78
buffer_load_dwordx4 v[192:195], v7, s[8:11], s72 offen sc1
s_waitcnt vmcnt(4)
M v[96:99],a[246:249],v[176:179],v[96:99]
M v[100:103],a[244:247],v[176:179],v[100:103]
s_waitcnt vmcnt(3)
M v[104:107],a[246:249],v[180:183],v[104:107]
M v[108:111],a[244:247],v[180:183],v[108:111]
s_cmp_lg_u32 s70, 0
s_cbranch_scc1 L_rk17
s_call_b64 s[36:37], L_rpoll
L_rk17:
s_ff1_i32_b32 s71, s70
s_bitset0_b32 s70, s71
s_mul_i32 s71, s71, 114688
SA s72,s71,s78
buffer_load_dwordx4 v[196:199], v7, s[8:11], s72 offen sc1
s_waitcnt vmcnt(3)
M v[96:99],a[246:249],v[184:187],v[96:99]
M v[100:103],a[244:247],v[184:187],v[100:103]
s_waitcnt vmcnt(2)
M v[104:107],a[246:249],v[188:191],v[104:107]
M v[108:111],a[244:247],v[188:191],v[108:111]
s_nop 4
v_permlane16_swap_b32 v96, v100
v_permlane16_swap_b32 v97, v101
v_permlane16_swap_b32 v98, v102
v_permlane16_swap_b32 v99, v103
v_permlane16_swap_b32 v104, v108
v_permlane16_swap_b32 v105, v109
v_permlane16_swap_b32 v106, v110
v_permlane16_swap_b32 v107, v111
v_fmac_f32 v64, v39, v96
v_fmac_f32 v65, v39, v97
v_fmac_f32 v66, v39, v98
v_fmac_f32 v67, v39, v99
v_fmac_f32 v68, v39, v100
v_fmac_f32 v69, v39, v101
v_fmac_f32 v70, v39, v102
v_fmac_f32 v71, v39, v103
C v48,v64,v65
C v49,v66,v67
C v50,v68,v69
C v51,v70,v71
buffer_store_dwordx4 v[48:51], v38, s[52:55], s75 offen sc1
v_fmac_f32 v72, v39, v104
v_fmac_f32 v73, v39, v105
v_fmac_f32 v74, v39, v106
v_fmac_f32 v75, v39, v107
v_fmac_f32 v76, v39, v108
v_fmac_f32 v77, v39, v109
v_fmac_f32 v78, v39, v110
v_fmac_f32 v79, v39, v111
C v52,v72,v73
C v53,v74,v75
C v54,v76,v77
C v55,v78,v79
buffer_store_dwordx4 v[52:55], v38, s[52:55], s76 offen sc1
s_cmp_lg_u32 s70, 0
s_cbranch_scc1 L_rk18
s_call_b64 s[36:37], L_rpoll
L_rk18:
s_ff1_i32_b32 s71, s70
s_bitset0_b32 s70, s71
s_mul_i32 s71, s71, 114688
SA s72,s71,s78
buffer_load_dwordx4 v[200:203], v7, s[8:11], s72 offen sc1
s_cmp_lg_u32 s70, 0
s_cbranch_scc1 L_rk19
s_call_b64 s[36:37], L_rpoll
L_rk19:
s_ff1_i32_b32 s71, s70
s_bitset0_b32 s70, s71
s_mul_i32 s71, s71, 114688
SA s72,s71,s78
buffer_load_dwordx4 v[204:207], v7, s[8:11], s72 offen sc1
s_cmp_lg_u32 s70, 0
s_cbranch_scc1 L_rk20
s_call_b64 s[36:37], L_rpoll
L_rk20:
s_ff1_i32_b32 s71, s70
s_bitset0_b32 s70, s71
s_mul_i32 s71, s71, 114688
SA s72,s71,s78
buffer_load_dwordx4 v[208:211], v7, s[8:11], s72 offen sc1
s_cmp_lg_u32 s70, 0
s_cbranch_scc1 L_rk21
s_call_b64 s[36:37], L_rpoll
L_rk21:
s_ff1_i32_b32 s71, s70
s_bitset0_b32 s70, s71
s_mul_i32 s71, s71, 114688
SA s72,s71,s78
buffer_load_dwordx4 v[212:215], v7, s[8:11], s72 offen sc1
s_cmp_lg_u32 s70, 0
s_cbranch_scc1 L_rk22
s_call_b64 s[36:37], L_rpoll
L_rk22:
s_ff1_i32_b32 s71, s70
s_bitset0_b32 s70, s71
s_mul_i32 s71, s71, 114688
SA s72,s71,s78
buffer_load_dwordx4 v[216:219], v7, s[8:11], s72 offen sc1
s_cmp_lg_u32 s70, 0
s_cbranch_scc1 L_rk23
s_call_b64 s[36:37], L_rpoll
L_rk23:
s_ff1_i32_b32 s71, s70
s_bitset0_b32 s70, s71
s_mul_i32 s71, s71, 114688
SA s72,s71,s78
buffer_load_dwordx4 v[220:223], v7, s[8:11], s72 offen sc1
s_cmp_lg_u32 s70, 0
s_cbranch_scc1 L_rk24
s_call_b64 s[36:37], L_rpoll
L_rk24:
s_ff1_i32_b32 s71, s70
s_bitset0_b32 s70, s71
s_mul_i32 s71, s71, 114688
SA s72,s71,s78
buffer_load_dwordx4 v[224:227], v7, s[8:11], s72 offen sc1
s_cmp_lg_u32 s70, 0
s_cbranch_scc1 L_rk25
s_call_b64 s[36:37], L_rpoll
L_rk25:
s_ff1_i32_b32 s71, s70
s_bitset0_b32 s70, s71
s_mul_i32 s71, s71, 114688
SA s72,s71,s78
buffer_load_dwordx4 v[228:231], v7, s[8:11], s72 offen sc1
s_cmp_lg_u32 s70, 0
s_cbranch_scc1 L_rk26
s_call_b64 s[36:37], L_rpoll
L_rk26:
s_ff1_i32_b32 s71, s70
s_bitset0_b32 s70, s71
s_mul_i32 s71, s71, 114688
SA s72,s71,s78
buffer_load_dwordx4 v[232:235], v7, s[8:11], s72 offen sc1
s_cmp_lg_u32 s70, 0
s_cbranch_scc1 L_rk27
s_call_b64 s[36:37], L_rpoll
L_rk27:
s_ff1_i32_b32 s71, s70
s_bitset0_b32 s70, s71
s_mul_i32 s71, s71, 114688
SA s72,s71,s78
buffer_load_dwordx4 v[236:239], v7, s[8:11], s72 offen sc1
s_waitcnt vmcnt(13)
M v[112:115],a[246:249],v[192:195],0
M v[116:119],a[244:247],v[192:195],0
s_cmp_lg_u32 s70, 0
s_cbranch_scc1 L_rk28
s_call_b64 s[36:37], L_rpoll
L_rk28:
s_ff1_i32_b32 s71, s70
s_bitset0_b32 s70, s71
s_mul_i32 s71, s71, 114688
SA s72,s71,s78
buffer_load_dwordx4 v[240:243], v7, s[8:11], s72 offen sc1
s_waitcnt vmcnt(13)
M v[112:115],a[246:249],v[196:199],v[112:115]
M v[116:119],a[244:247],v[196:199],v[116:119]
s_cmp_lg_u32 s70, 0
s_cbranch_scc1 L_rk29
s_call_b64 s[36:37], L_rpoll
L_rk29:
s_ff1_i32_b32 s71, s70
s_bitset0_b32 s70, s71
s_mul_i32 s71, s71, 114688
SA s72,s71,s78
buffer_load_dwordx4 v[244:247], v7, s[8:11], s72 offen sc1
s_waitcnt vmcnt(11)
M v[112:115],a[246:249],v[200:203],v[112:115]
M v[116:119],a[244:247],v[200:203],v[116:119]
s_cmp_lg_u32 s70, 0
s_cbranch_scc1 L_rk30
s_call_b64 s[36:37], L_rpoll
L_rk30:
s_ff1_i32_b32 s71, s70
s_bitset0_b32 s70, s71
s_mul_i32 s71, s71, 114688
SA s72,s71,s78
buffer_load_dwordx4 v[248:251], v7, s[8:11], s72 offen sc1
s_waitcnt vmcnt(11)
M v[112:115],a[246:249],v[204:207],v[112:115]
M v[116:119],a[244:247],v[204:207],v[116:119]
s_cmp_lg_u32 s70, 0
s_cbranch_scc1 L_rk31
s_call_b64 s[36:37], L_rpoll
L_rk31:
s_ff1_i32_b32 s71, s70
s_bitset0_b32 s70, s71
s_mul_i32 s71, s71, 114688
SA s72,s71,s78
buffer_load_dwordx4 v[252:255], v7, s[8:11], s72 offen sc1
s_waitcnt vmcnt(11)
M v[112:115],a[246:249],v[208:211],v[112:115]
M v[116:119],a[244:247],v[208:211],v[116:119]
s_waitcnt vmcnt(10)
M v[112:115],a[246:249],v[212:215],v[112:115]
M v[116:119],a[244:247],v[212:215],v[116:119]
s_waitcnt vmcnt(9)
M v[112:115],a[246:249],v[216:219],v[112:115]
M v[116:119],a[244:247],v[216:219],v[116:119]
s_waitcnt vmcnt(8)
M v[112:115],a[246:249],v[220:223],v[112:115]
M v[116:119],a[244:247],v[220:223],v[116:119]
s_waitcnt vmcnt(7)
M v[112:115],a[246:249],v[224:227],v[112:115]
M v[116:119],a[244:247],v[224:227],v[116:119]
s_waitcnt vmcnt(6)
M v[112:115],a[246:249],v[228:231],v[112:115]
M v[116:119],a[244:247],v[228:231],v[116:119]
s_waitcnt vmcnt(5)
M v[112:115],a[246:249],v[232:235],v[112:115]
M v[116:119],a[244:247],v[232:235],v[116:119]
s_waitcnt vmcnt(4)
M v[112:115],a[246:249],v[236:239],v[112:115]
M v[116:119],a[244:247],v[236:239],v[116:119]
s_waitcnt vmcnt(3)
M v[112:115],a[246:249],v[240:243],v[112:115]
M v[116:119],a[244:247],v[240:243],v[116:119]
s_waitcnt vmcnt(2)
M v[112:115],a[246:249],v[244:247],v[112:115]
M v[116:119],a[244:247],v[244:247],v[116:119]
s_waitcnt vmcnt(1)
M v[112:115],a[246:249],v[248:251],v[112:115]
M v[116:119],a[244:247],v[248:251],v[116:119]
s_waitcnt vmcnt(0)
M v[112:115],a[246:249],v[252:255],v[112:115]
M v[116:119],a[244:247],v[252:255],v[116:119]
s_nop 7
v_permlane16_swap_b32 v112, v116
v_permlane16_swap_b32 v113, v117
v_permlane16_swap_b32 v114, v118
v_permlane16_swap_b32 v115, v119
v_fmac_f32 v80, v26, v112
v_fmac_f32 v81, v26, v113
v_fmac_f32 v82, v26, v114
v_fmac_f32 v83, v26, v115
v_fmac_f32 v84, v26, v116
v_fmac_f32 v85, v26, v117
v_fmac_f32 v86, v26, v118
v_fmac_f32 v87, v26, v119
C v44,v80,v81
C v45,v82,v83
C v46,v84,v85
C v47,v86,v87
buffer_store_dwordx4 v[44:47], v28, s[52:55], s79 offen sc1
s_endpgm
L_rpoll0:
s_sleep 1
L_rpoll:
buffer_load_dword v9, v33, s[8:11], s46 offen sc1
s_waitcnt vmcnt(0)
v_cmp_eq_u32 vcc, 1, v9
s_sub_u32 s91, s91, 1
s_cselect_b32 s70, -1, 0
s_or_b32 s70, s70, vcc_lo
s_and_b32 s70, s70, s69
s_andn2_b32 s70, s70, s68
s_cbranch_scc0 L_rpoll0
s_or_b32 s68, s68, s70
s_setpc_b64 s[36:37]
L_moe0:
s_lshl_b32 s88, s75, 1
s_call_b64 s[36:37], L_moe
AF v64,v2,v64
AF v65,v3,v65
AF v66,v4,v66
AF v67,v5,v67
AF v68,v10,v68
AF v69,v11,v69
AF v70,v12,v70
AF v71,v13,v71
AF v72,v14,v72
AF v73,v15,v73
AF v74,v16,v74
AF v75,v17,v75
AF v76,v18,v76
AF v77,v19,v77
AF v78,v20,v78
AF v79,v21,v79
s_mov_b64 exec, -1
s_branch L_moe_ret0
L_moe1:
s_lshl_b32 s88, s79, 1
s_call_b64 s[36:37], L_moe
AF v80,v2,v80
AF v81,v3,v81
AF v82,v4,v82
AF v83,v5,v83
AF v84,v10,v84
AF v85,v11,v85
AF v86,v12,v86
AF v87,v13,v87
s_mov_b64 exec, -1
s_branch L_moe_ret1
L_moe2:
s_lshl_b32 s88, s79, 1
s_call_b64 s[36:37], L_moe
AF v48,v2,v48
AF v49,v3,v49
AF v50,v4,v50
AF v51,v5,v51
AF v52,v10,v52
AF v53,v11,v53
AF v54,v12,v54
AF v55,v13,v55
s_mov_b64 exec, -1
s_branch L_moe_ret2
L_moe:
v_min_u32 v0, 27, v32
v_lshlrev_b32 v0, 2, v0
s_mov_b32 s64, 105062912
s_mov_b32 s65, 65536
s_mov_b32 exec_lo, 0xffffffff
s_mov_b32 exec_hi, 0xffffffff
L_pfy:
buffer_load_dword v1, v0, s[8:11], s64 offen sc1
s_sub_u32 s65, s65, 1
s_cbranch_scc1 L_pfy_x
s_waitcnt vmcnt(0)
v_cmp_ne_u32 vcc, 1, v1
s_nop 0
s_cbranch_vccz L_pfy_x
s_sleep 2
s_branch L_pfy
L_pfy_x:
s_waitcnt vmcnt(0)
s_mov_b64 exec, -1
s_or_b64 exec, s[80:81], s[82:83]
v_mov_b32 v0, 1792
v_cndmask_b32 v0, v0, 0, s[80:81]
v_lshl_add_u32 v0, v34, 5, v0
SA s88,s88,104898560
buffer_load_dwordx4 v[2:5], v0, s[8:11], s88 offen sc1
buffer_load_dwordx4 v[10:13], v0, s[8:11], s88 offen offset:16 sc1
buffer_load_dwordx4 v[14:17], v0, s[8:11], s88 offen offset:512 sc1
buffer_load_dwordx4 v[18:21], v0, s[8:11], s88 offen offset:528 sc1
s_waitcnt vmcnt(0)
s_setpc_b64 s[36:37]
L_red:
v_lshrrev_b32 v32, 4, v7
s_lshr_b32 s74, s41, 3
s_lshl_b32 s64, s42, 1
SA s46,s64,s74
s_mul_i32 s46, s46, 4352
s_and_b32 s72, s41, 7
s_lshl_b32 s65, s72, 7
SA s46,s46,s65
SA s46,s46,104992768
v_and_b32 v33, 31, v32
v_lshlrev_b32 v33, 2, v33
s_lshl_b32 s65, s41, 7
SA s65,s65,104890368
buffer_load_dword v31, v33, s[8:11], s65 offen sc1
v_bfe_u32 v34, v32, 4, 1
v_lshlrev_b32 v34, 1, v34
v_lshrrev_b32 v35, 5, v32
v_add_u32 v34, v34, v35
s_mov_b32 s52, s96
s_and_b32 s53, s97, 0xffff
s_mov_b32 s54, 1835008
s_mov_b32 s55, 0x20000
s_mul_i32 s77, s42, 1835008
s_mul_i32 s78, s72, 14336
SA s77,s77,s78
SA s77,s77,67108864
s_lshl_b32 s79, s74, 1
SA s79,s79,s20
s_lshl_b32 s71, s74, 1
SA s71,s71,1
s_sub_u32 s71, s71, s20
s_and_b32 s71, s71, 536870912
s_sub_u32 s64, 15, s64
s_sub_u32 s78, s64, 1
s_mul_i32 s78, s78, 1835008
SA s78,s78,s77
s_lshl_b32 s65, s79, 10
SA s78,s78,s65
SA s78,s78,s71
s_lshl_b32 s79, s79, 6
s_or_b32 s79, s79, s71
s_mul_i32 s67, s74, -2
s_lshl_b32 s74, s74, 3
SA s74,s74,s20
s_lshl_b32 s75, s74, 6
SA s76,s75,256
SA s67,s67,3
s_sub_u32 s67, s67, s20
s_and_b32 s67, s67, 536870912
s_or_b32 s76, s76, s67
v_or_b32 v27, s67, v7
v_add_u32 v27, 4096, v27
s_lshl_b32 s65, s74, 10
SA s77,s77,s65
s_lshl_b32 s64, s64, 7
s_lshr_b32 s73, s72, 1
s_sub_u32 s65, 7, s73
s_bitcmp1_b32 s72, 0
s_cselect_b32 s73, s65, s73
s_lshl_b32 s73, s73, 4
s_lshl_b32 s65, s42, 7
SA s73,s73,s65
v_and_b32 v37, 15, v32
v_add_u32 v37, s73, v37
v_add_u32 v29, s64, v37
s_mov_b32 s64, 104857664
v_mul_u32_u24 v38, 896, v37
v_lshl_add_u32 v38, v34, 4, v38
v_lshrrev_b32 v35, 4, v37
v_lshlrev_b32 v35, 5, v35
v_and_b32 v36, 15, v37
v_add_lshl_u32 v35, v35, v36, 2
buffer_load_dword v39, v35, s[8:11], s64 offen sc1
buffer_load_dwordx4 v[48:51], v38, s[56:59], s75 offen
buffer_load_dwordx4 v[52:55], v38, s[56:59], s76 offen
v_mul_u32_u24 v28, 896, v29
v_lshl_add_u32 v28, v34, 4, v28
v_lshrrev_b32 v35, 4, v29
v_lshlrev_b32 v35, 5, v35
v_and_b32 v36, 15, v29
v_add_lshl_u32 v35, v35, v36, 2
buffer_load_dword v26, v35, s[8:11], s64 offen sc1
buffer_load_dwordx4 v[44:47], v28, s[56:59], s79 offen
s_waitcnt vmcnt(7)
buffer_load_dword v9, v33, s[8:11], s46 offen sc1
s_branch L_red1
L_code_end:
.section .rodata,"a"
.p2align 6
.amdhsa_kernel gated_mix__compressed_kv_cla__moe_arch_mod__prompt_kernel
  .amdhsa_next_free_vgpr 512
  .amdhsa_next_free_sgpr 102
  .amdhsa_accum_offset 256
  .amdhsa_group_segment_fixed_size 0
  .amdhsa_kernarg_size 120
  .amdhsa_user_sgpr_count 2
  .amdhsa_user_sgpr_kernarg_segment_ptr 1
  .amdhsa_system_sgpr_workgroup_id_x 1
  .amdhsa_float_denorm_mode_32 3
.end_amdhsa_kernel
```

```asm
; @launch grid=(256,1,1) block=(256,1,1) lds=163840
.amdgcn_target "amdgcn-amd-amdhsa--gfx950"
.text
.macro M a, b, c, d
v_mfma_f32_16x16x32_bf16 \a, \b, \c, \d
.endm
.macro R a, b, c
ds_read_b128 \a, \b offset:\c
.endm
.macro T a, b, c
ds_read_b64_tr_b16 \a, \b offset:\c
.endm
.macro C a, b, c
v_cvt_pk_bf16_f32 \a, \b, \c
.endm
.macro E a, b
v_exp_f32 \a, \b
.endm
.macro W a, b
v_accvgpr_write_b32 \a, \b
.endm
.macro G a, b
v_accvgpr_read_b32 \a, \b
.endm
.macro AF a, b, c
v_add_f32 \a, \b, \c
.endm
.macro MF a, b, c
v_mul_f32 \a, \b, \c
.endm
.macro SA a, b, c
s_add_u32 \a, \b, \c
.endm
.globl gated_mix__compressed_kv_cla__moe_arch_mod__prompt_kernel
.p2align 8
.type gated_mix__compressed_kv_cla__moe_arch_mod__prompt_kernel,@function
gated_mix__compressed_kv_cla__moe_arch_mod__prompt_kernel:
s_cmp_lt_u32 s2, 256
s_cbranch_scc1 L_go
s_endpgm
L_go:
s_load_dwordx8 s[80:87], s[0:1], 0
s_load_dwordx4 s[88:91], s[0:1], 32
s_getpc_b64 s[76:77]
L_pc0:
s_lshr_b32 s42, s2, 3
s_mov_b32 s79, 0x20000
s_lshl_b32 s67, s42, 13
s_mov_b32 s78, L_code_end-L_pc0
s_and_b32 s77, s77, 0xffff
v_lshl_add_u32 v31, v0, 5, s67
buffer_load_dword a240, v31, s[76:79], 0 offen offset:0
v_lshrrev_b32 v24, 6, v0
v_and_b32 v0, 63, v0
s_and_b32 s41, s2, 7
v_readfirstlane_b32 s20, v24
s_lshr_b32 s64, s2, 7
v_and_b32 v24, 15, v0
v_lshrrev_b32 v25, 4, v0
s_lshl_b32 s64, s64, 3
SA s41,s41,s64
s_and_b32 s42, s42, 15
s_lshr_b32 s45, s42, 3
v_lshlrev_b32 v28, 1, v25
v_xor_b32 v28, v28, v24
v_and_b32 v29, 8, v28
v_and_b32 v28, 7, v28
v_lshlrev_b32 v28, 4, v28
v_lshl_add_u32 v28, v29, 5, v28
v_lshl_add_u32 v28, v25, 13, v28
s_lshl_b32 s64, s20, 17
v_add_u32 v8, s64, v28
v_xor_b32 v28, 0x100, v8
v_add_u32 v9, 31744, v8
v_add_u32 v10, 63488, v28
v_add_u32 v11, 95232, v28
s_and_b32 s65, s20, 1
s_lshr_b32 s66, s20, 1
v_and_b32 v29, 7, v0
v_xor_b32 v28, v25, v29
v_lshlrev_b32 v28, 4, v28
v_lshrrev_b32 v29, 3, v0
v_lshl_add_u32 v30, v29, 11, v28
s_lshl_b32 s64, s66, 19
s_lshl_b32 s67, s65, 21
SA s64,s64,s67
v_add_u32 v12, s64, v30
v_xor_b32 v30, 64, v12
v_add_u32 v14, 30720, v12
v_add_u32 v13, 15360, v30
v_add_u32 v15, 46080, v30
s_mov_b32 s21, 0
s_mov_b32 s22, 0
s_lshl_b32 s23, s20, 12
SA s24,s23,65536
s_lshl_b32 s74, s41, 9
s_sub_u32 s18, 8388608, s74
s_mov_b32 s19, 0x20000
s_and_b32 s64, s42, 7
s_lshl_b32 s64, s64, 16
s_sub_u32 s50, 4194304, s64
s_mov_b32 s51, 0x20000
s_cmp_eq_u32 s45, 0
s_waitcnt lgkmcnt(0)
s_cselect_b32 s72, s86, s88
s_cselect_b32 s73, s87, s89
SA s16,s72,s74
s_addc_u32 s73, s73, 0
s_and_b32 s17, s73, 0xffff
SA s48,s82,s64
s_addc_u32 s73, s83, 0
s_and_b32 s49, s73, 0xffff
SA m0,s23,0
s_nop 0
buffer_load_dwordx4 v8, s[16:19], s21 offen offset:0  nt lds
buffer_load_dwordx4 v9, s[16:19], s21 offen offset:1024  nt lds
buffer_load_dwordx4 v10, s[16:19], s21 offen offset:2048  nt lds
buffer_load_dwordx4 v11, s[16:19], s21 offen offset:3072  nt lds
SA s21,s21,128
SA m0,s24,0
s_nop 0
buffer_load_dwordx4 v12, s[48:51], s22 offen offset:0   lds
buffer_load_dwordx4 v13, s[48:51], s22 offen offset:1024   lds
buffer_load_dwordx4 v14, s[48:51], s22 offen offset:2048   lds
buffer_load_dwordx4 v15, s[48:51], s22 offen offset:3072   lds
SA s22,s22,1048576
SA m0,s23,16384
s_nop 0
buffer_load_dwordx4 v8, s[16:19], s21 offen offset:0  nt lds
buffer_load_dwordx4 v9, s[16:19], s21 offen offset:1024  nt lds
buffer_load_dwordx4 v10, s[16:19], s21 offen offset:2048  nt lds
buffer_load_dwordx4 v11, s[16:19], s21 offen offset:3072  nt lds
SA s21,s21,524160
s_load_dwordx2 s[92:93], s[0:1], 56
s_load_dwordx2 s[94:95], s[0:1], 88
s_load_dwordx4 s[4:7], s[0:1], 104
v_lshlrev_b32 v7, 4, v0
v_lshrrev_b32 v26, 2, v24
v_and_b32 v28, 1, v25
v_lshl_or_b32 v28, v28, 2, v26
v_lshl_add_u32 v29, v25, 3, v26
v_lshlrev_b32 v29, 8, v29
v_and_b32 v30, 3, v0
v_lshl_add_u32 v29, v30, 3, v29
s_lshl_b32 s64, s65, 2
SA s64,s64,0
v_xor_b32 v30, s64, v28
v_lshl_add_u32 v1, v30, 5, v29
s_lshl_b32 s64, s65, 2
SA s64,s64,1
v_xor_b32 v30, s64, v28
v_lshl_add_u32 v2, v30, 5, v29
s_lshl_b32 s64, s65, 2
SA s64,s64,2
v_xor_b32 v30, s64, v28
v_lshl_add_u32 v3, v30, 5, v29
s_lshl_b32 s64, s65, 2
SA s64,s64,3
v_xor_b32 v30, s64, v28
v_lshl_add_u32 v4, v30, 5, v29
v_add_u32 v28, 0, v25
v_lshrrev_b32 v29, 1, v24
v_xor_b32 v28, v28, v29
v_lshlrev_b32 v28, 4, v28
v_lshl_add_u32 v28, v24, 7, v28
s_lshl_b32 s64, s66, 13
SA s64,s64,65536
v_add_u32 v5, s64, v28
v_add_u32 v28, 4, v25
v_lshrrev_b32 v29, 1, v24
v_xor_b32 v28, v28, v29
v_lshlrev_b32 v28, 4, v28
v_lshl_add_u32 v28, v24, 7, v28
s_lshl_b32 s64, s66, 13
SA s64,s64,65536
v_add_u32 v6, s64, v28
s_mov_b32 s56, s80
s_and_b32 s57, s81, 0xffff
s_mov_b32 s58, 1835008
s_mov_b32 s59, 0x20000
s_waitcnt lgkmcnt(0)
s_mov_b32 s60, s92
s_and_b32 s61, s93, 0xffff
s_mov_b32 s62, 896
s_mov_b32 s63, 0x20000
s_mov_b32 s68, s94
s_and_b32 s69, s95, 0xffff
s_mov_b32 s70, 896
s_mov_b32 s71, 0x20000
s_lshl_b32 s95, s20, 11
s_lshr_b32 s64, s2, 3
s_lshl_b32 s64, s64, 13
SA s95,s95,s64
s_mov_b32 s8, s6
s_and_b32 s9, s7, 0xffff
s_mov_b32 s10, 268435456
s_mov_b32 s11, 0x20000
s_mov_b32 s12, s4
s_and_b32 s13, s5, 0xffff
s_mov_b32 s14, 256
s_mov_b32 s15, 0x20000
SA s72,s84,s74
s_addc_u32 s73, s85, 0
s_sub_u32 s75, 3670016, s74
s_mov_b32 s52, s72
s_and_b32 s53, s73, 0xffff
s_mov_b32 s54, s75
s_mov_b32 s55, 0x20000
s_mul_i32 s29, s42, 114688
s_mov_b32 s5, 0x3db8aa3b
s_mul_i32 s72, s45, 16777216
s_mul_i32 s73, s41, 1048576
SA s72,s72,s73
s_bfe_u32 s64, s42, 0x20001
s_lshl_b32 s64, s64, 15
SA s72,s72,s64
s_lshl_b32 s64, s66, 17
SA s72,s72,s64
s_and_b32 s67, s42, 1
s_cmp_eq_u32 s45, 0
s_cselect_b32 s64, 12, 14
s_cselect_b32 s75, 14, 10
s_lshl_b32 s67, s67, s75
SA s72,s72,s67
s_lshl_b32 s64, s65, s64
SA s93,s72,s64
s_load_dwordx4 s[80:83], s[0:1], 64
s_load_dwordx2 s[84:85], s[0:1], 80
s_load_dwordx2 s[96:97], s[0:1], 96
s_cmp_eq_u32 s45, 0
s_cbranch_scc0 L_kv1
s_branch L_kv0
.p2align 12
L_kv0:
s_and_b32 s31, s42, 7
s_lshl_b32 s64, s42, 4
SA s64,s64,s41
s_lshl_b32 s64, s64, 2
SA s64,s64,s20
s_cmp_lt_u32 s64, 41
s_cselect_b32 s39, 0, 536870912
s_min_u32 s64, s64, 41
s_lshl_b32 s38, s64, 2
s_max_u32 s67, s64, 8
s_sub_u32 s67, s67, 8
s_mul_i32 s67, s67, 3328
s_lshl_b32 s64, s64, 10
SA s64,s64,s67
SA s73,s64,104914944
v_or_b32 v64, s39, v7
v_mov_b32 v68, 0
v_mov_b32 v69, 0
v_mov_b32 v70, 0
v_mov_b32 v71, 0
buffer_store_dwordx4 v[68:71], v64, s[8:11], s73 offen offset:0 sc1
buffer_store_dwordx4 v[68:71], v64, s[8:11], s73 offen offset:1024 sc1
buffer_store_dwordx4 v[68:71], v64, s[8:11], s73 offen offset:2048 sc1
SA m0,s24,16384
s_nop 0
buffer_load_dwordx4 v12, s[48:51], s22 offen offset:0   lds
buffer_load_dwordx4 v13, s[48:51], s22 offen offset:1024   lds
buffer_load_dwordx4 v14, s[48:51], s22 offen offset:2048   lds
buffer_load_dwordx4 v15, s[48:51], s22 offen offset:3072   lds
s_sub_u32 s22, s22, 1048448
SA m0,s23,32768
s_nop 0
buffer_load_dwordx4 v8, s[16:19], s21 offen offset:0  nt lds
buffer_load_dwordx4 v9, s[16:19], s21 offen offset:1024  nt lds
buffer_load_dwordx4 v10, s[16:19], s21 offen offset:2048  nt lds
buffer_load_dwordx4 v11, s[16:19], s21 offen offset:3072  nt lds
SA s21,s21,128
s_mov_b64 exec, 0
s_cmp_eq_u32 s20, 0
s_cbranch_scc1 L_w_kv01
s_cmp_eq_u32 s20, 1
s_cbranch_scc1 L_w_kv02
s_cmp_eq_u32 s20, 2
s_cbranch_scc1 L_w_kv03
s_branch L_w_kv04
L_wd1:
s_mov_b64 exec, -1
s_waitcnt vmcnt(11) lgkmcnt(0)
s_barrier
R a[160:163],v5,0
R a[164:167],v6,0
T a[96:97],v1,0
T a[98:99],v1,1024
T a[100:101],v1,8192
T a[102:103],v1,9216
T a[104:105],v2,0
T a[106:107],v2,1024
T a[108:109],v2,8192
T a[110:111],v2,9216
T a[112:113],v3,0
T a[114:115],v3,1024
T a[116:117],v3,8192
T a[118:119],v3,9216
T a[120:121],v4,0
T a[122:123],v4,1024
T a[124:125],v4,8192
T a[126:127],v4,9216
T a[128:129],v1,16384
T a[130:131],v1,17408
T a[132:133],v1,24576
T a[134:135],v1,25600
T a[136:137],v2,16384
T a[138:139],v2,17408
T a[140:141],v2,24576
T a[142:143],v2,25600
T a[144:145],v3,16384
T a[146:147],v3,17408
T a[148:149],v3,24576
T a[150:151],v3,25600
T a[152:153],v4,16384
T a[154:155],v4,17408
T a[156:157],v4,24576
T a[158:159],v4,25600
s_waitcnt lgkmcnt(15)
M a[0:3],a[96:99],a[160:163],0
SA m0,s23,49152
R a[168:171],v5,2048
R a[172:175],v6,2048
M a[0:3],a[100:103],a[164:167],a[0:3]
buffer_load_dwordx4 v8, s[16:19], s21 offen offset:0  nt lds
M a[4:7],a[108:111],a[164:167],0
M a[4:7],a[104:107],a[160:163],a[4:7]
M a[8:11],a[112:115],a[160:163],0
buffer_load_dwordx4 v9, s[16:19], s21 offen offset:1024  nt lds
M a[8:11],a[116:119],a[164:167],a[8:11]
s_waitcnt lgkmcnt(14)
M a[12:15],a[124:127],a[164:167],0
M a[12:15],a[120:123],a[160:163],a[12:15]
M a[16:19],a[128:131],a[160:163],0
buffer_load_dwordx4 v10, s[16:19], s21 offen offset:2048  nt lds
M a[16:19],a[132:135],a[164:167],a[16:19]
s_waitcnt lgkmcnt(6)
M a[20:23],a[140:143],a[164:167],0
M a[20:23],a[136:139],a[160:163],a[20:23]
buffer_load_dwordx4 v11, s[16:19], s21 offen offset:3072  nt lds
M a[24:27],a[144:147],a[160:163],0
SA s21,s21,524160
M a[24:27],a[148:151],a[164:167],a[24:27]
s_waitcnt lgkmcnt(0)
M a[28:31],a[156:159],a[164:167],0
SA m0,s24,32768
M a[28:31],a[152:155],a[160:163],a[28:31]
buffer_load_dwordx4 v12, s[48:51], s22 offen offset:0   lds
M v[32:35],a[96:99],a[168:171],0
R a[160:163],v5,4096
R a[164:167],v6,4096
M v[32:35],a[100:103],a[172:175],v[32:35]
M v[36:39],a[108:111],a[172:175],0
M v[36:39],a[104:107],a[168:171],v[36:39]
buffer_load_dwordx4 v13, s[48:51], s22 offen offset:1024   lds
M v[40:43],a[112:115],a[168:171],0
M v[40:43],a[116:119],a[172:175],v[40:43]
M v[44:47],a[124:127],a[172:175],0
buffer_load_dwordx4 v14, s[48:51], s22 offen offset:2048   lds
M v[44:47],a[120:123],a[168:171],v[44:47]
M v[48:51],a[128:131],a[168:171],0
M v[48:51],a[132:135],a[172:175],v[48:51]
M v[52:55],a[140:143],a[172:175],0
buffer_load_dwordx4 v15, s[48:51], s22 offen offset:3072   lds
M v[52:55],a[136:139],a[168:171],v[52:55]
SA s22,s22,1048576
M v[56:59],a[144:147],a[168:171],0
M v[56:59],a[148:151],a[172:175],v[56:59]
s_waitcnt lgkmcnt(0)
M v[60:63],a[156:159],a[172:175],0
M v[60:63],a[152:155],a[168:171],v[60:63]
M v[64:67],a[96:99],a[160:163],0
R a[168:171],v5,6144
R a[172:175],v6,6144
M v[64:67],a[100:103],a[164:167],v[64:67]
M v[68:71],a[108:111],a[164:167],0
M v[68:71],a[104:107],a[160:163],v[68:71]
M v[72:75],a[112:115],a[160:163],0
M v[72:75],a[116:119],a[164:167],v[72:75]
M v[76:79],a[124:127],a[164:167],0
M v[76:79],a[120:123],a[160:163],v[76:79]
M v[80:83],a[128:131],a[160:163],0
M v[80:83],a[132:135],a[164:167],v[80:83]
M v[84:87],a[140:143],a[164:167],0
M v[84:87],a[136:139],a[160:163],v[84:87]
M v[88:91],a[144:147],a[160:163],0
M v[88:91],a[148:151],a[164:167],v[88:91]
s_waitcnt lgkmcnt(0)
M v[92:95],a[156:159],a[164:167],0
s_waitcnt vmcnt(12)
M v[92:95],a[152:155],a[160:163],v[92:95]
s_barrier
M v[96:99],a[96:99],a[168:171],0
SA m0,s23,0
R a[160:163],v5,16384
R a[164:167],v6,16384
M v[96:99],a[100:103],a[172:175],v[96:99]
buffer_load_dwordx4 v8, s[16:19], s21 offen offset:0  nt lds
M v[100:103],a[108:111],a[172:175],0
v_lshlrev_b32 v26, 7, v0
v_and_b32 v27, 48, v0
M v[100:103],a[104:107],a[168:171],v[100:103]
v_lshl_add_u32 v26, v27, 24, v26
M v[104:107],a[112:115],a[168:171],0
buffer_load_dwordx4 v9, s[16:19], s21 offen offset:1024  nt lds
M v[104:107],a[116:119],a[172:175],v[104:107]
M v[108:111],a[124:127],a[172:175],0
M v[108:111],a[120:123],a[168:171],v[108:111]
buffer_load_dwordx4 v10, s[16:19], s21 offen offset:2048  nt lds
M v[112:115],a[128:131],a[168:171],0
M v[112:115],a[132:135],a[172:175],v[112:115]
M v[116:119],a[140:143],a[172:175],0
M v[116:119],a[136:139],a[168:171],v[116:119]
buffer_load_dwordx4 v11, s[16:19], s21 offen offset:3072  nt lds
M v[120:123],a[144:147],a[168:171],0
SA s21,s21,128
M v[120:123],a[148:151],a[172:175],v[120:123]
s_waitcnt lgkmcnt(0)
M v[124:127],a[156:159],a[172:175],0
SA m0,s24,49152
M v[124:127],a[152:155],a[168:171],v[124:127]
buffer_load_dwordx4 v12, s[48:51], s22 offen offset:0   lds
M v[128:131],a[96:99],a[160:163],0
R a[168:171],v5,18432
R a[172:175],v6,18432
M v[128:131],a[100:103],a[164:167],v[128:131]
buffer_load_dwordx4 v13, s[48:51], s22 offen offset:1024   lds
M v[132:135],a[108:111],a[164:167],0
M v[132:135],a[104:107],a[160:163],v[132:135]
M v[136:139],a[112:115],a[160:163],0
M v[136:139],a[116:119],a[164:167],v[136:139]
buffer_load_dwordx4 v14, s[48:51], s22 offen offset:2048   lds
M v[140:143],a[124:127],a[164:167],0
M v[140:143],a[120:123],a[160:163],v[140:143]
M v[144:147],a[128:131],a[160:163],0
buffer_load_dwordx4 v15, s[48:51], s22 offen offset:3072   lds
M v[144:147],a[132:135],a[164:167],v[144:147]
s_sub_u32 s22, s22, 1048448
M v[148:151],a[140:143],a[164:167],0
M v[148:151],a[136:139],a[160:163],v[148:151]
M v[152:155],a[144:147],a[160:163],0
M v[152:155],a[148:151],a[164:167],v[152:155]
s_waitcnt lgkmcnt(0)
M v[156:159],a[156:159],a[164:167],0
s_waitcnt vmcnt(12)
M v[156:159],a[152:155],a[160:163],v[156:159]
s_barrier
M v[160:163],a[96:99],a[168:171],0
SA m0,s23,16384
R a[160:163],v5,20480
R a[164:167],v6,20480
M v[160:163],a[100:103],a[172:175],v[160:163]
T a[32:33],v1,32768
T a[34:35],v1,33792
M v[164:167],a[108:111],a[172:175],0
T a[36:37],v1,40960
T a[38:39],v1,41984
M v[164:167],a[104:107],a[168:171],v[164:167]
T a[40:41],v2,32768
T a[42:43],v2,33792
M v[168:171],a[112:115],a[168:171],0
T a[44:45],v2,40960
T a[46:47],v2,41984
M v[168:171],a[116:119],a[172:175],v[168:171]
buffer_load_dwordx4 v8, s[16:19], s21 offen offset:0  nt lds
M v[172:175],a[124:127],a[172:175],0
s_nop 0
T a[48:49],v3,32768
T a[50:51],v3,33792
M v[172:175],a[120:123],a[168:171],v[172:175]
buffer_load_dwordx4 v9, s[16:19], s21 offen offset:1024  nt lds
M v[176:179],a[128:131],a[168:171],0
s_nop 0
T a[52:53],v3,40960
T a[54:55],v3,41984
M v[176:179],a[132:135],a[172:175],v[176:179]
T a[56:57],v4,32768
T a[58:59],v4,33792
M v[180:183],a[140:143],a[172:175],0
buffer_load_dwordx4 v10, s[16:19], s21 offen offset:2048  nt lds
M v[180:183],a[136:139],a[168:171],v[180:183]
s_nop 0
T a[60:61],v4,40960
T a[62:63],v4,41984
M v[184:187],a[144:147],a[168:171],0
buffer_load_dwordx4 v11, s[16:19], s21 offen offset:3072  nt lds
M v[184:187],a[148:151],a[172:175],v[184:187]
s_waitcnt lgkmcnt(15)
s_nop 0
T a[64:65],v1,49152
T a[66:67],v1,50176
M v[188:191],a[156:159],a[172:175],0
SA s21,s21,524160
T a[68:69],v1,57344
T a[70:71],v1,58368
M v[188:191],a[152:155],a[168:171],v[188:191]
SA m0,s24,0
M v[192:195],a[96:99],a[160:163],0
R a[168:171],v5,22528
R a[172:175],v6,22528
M v[192:195],a[100:103],a[164:167],v[192:195]
T a[72:73],v2,49152
T a[74:75],v2,50176
M v[196:199],a[108:111],a[164:167],0
T a[76:77],v2,57344
T a[78:79],v2,58368
M v[196:199],a[104:107],a[160:163],v[196:199]
T a[80:81],v3,49152
T a[82:83],v3,50176
M v[200:203],a[112:115],a[160:163],0
buffer_load_dwordx4 v12, s[48:51], s22 offen offset:0   lds
M v[200:203],a[116:119],a[164:167],v[200:203]
s_nop 0
T a[84:85],v3,57344
T a[86:87],v3,58368
M v[204:207],a[124:127],a[164:167],0
T a[88:89],v4,49152
T a[90:91],v4,50176
M v[204:207],a[120:123],a[160:163],v[204:207]
buffer_load_dwordx4 v13, s[48:51], s22 offen offset:1024   lds
M v[208:211],a[128:131],a[160:163],0
s_nop 0
T a[92:93],v4,57344
T a[94:95],v4,58368
M v[208:211],a[132:135],a[164:167],v[208:211]
buffer_load_dwordx4 v14, s[48:51], s22 offen offset:2048   lds
M v[212:215],a[140:143],a[164:167],0
buffer_load_dwordx4 v15, s[48:51], s22 offen offset:3072   lds
M v[212:215],a[136:139],a[160:163],v[212:215]
SA s22,s22,1048576
M v[216:219],a[144:147],a[160:163],0
M v[216:219],a[148:151],a[164:167],v[216:219]
s_waitcnt lgkmcnt(12)
M v[220:223],a[156:159],a[164:167],0
s_waitcnt vmcnt(12) lgkmcnt(0)
M v[220:223],a[152:155],a[160:163],v[220:223]
s_barrier
M v[224:227],a[96:99],a[168:171],0
SA m0,s23,32768
R a[160:163],v5,32768
R a[164:167],v6,32768
M v[224:227],a[100:103],a[172:175],v[224:227]
buffer_load_dwordx4 v8, s[16:19], s21 offen offset:0  nt lds
M v[228:231],a[108:111],a[172:175],0
M v[228:231],a[104:107],a[168:171],v[228:231]
M v[232:235],a[112:115],a[168:171],0
buffer_load_dwordx4 v9, s[16:19], s21 offen offset:1024  nt lds
M v[232:235],a[116:119],a[172:175],v[232:235]
M v[236:239],a[124:127],a[172:175],0
M v[236:239],a[120:123],a[168:171],v[236:239]
buffer_load_dwordx4 v10, s[16:19], s21 offen offset:2048  nt lds
M v[240:243],a[128:131],a[168:171],0
M v[240:243],a[132:135],a[172:175],v[240:243]
M v[244:247],a[140:143],a[172:175],0
buffer_load_dwordx4 v11, s[16:19], s21 offen offset:3072  nt lds
M v[244:247],a[136:139],a[168:171],v[244:247]
SA s21,s21,128
M v[248:251],a[144:147],a[168:171],0
M v[248:251],a[148:151],a[172:175],v[248:251]
s_waitcnt lgkmcnt(0)
M v[252:255],a[156:159],a[172:175],0
M v[252:255],a[152:155],a[168:171],v[252:255]
M a[0:3],a[32:35],a[160:163],a[0:3]
R a[168:171],v5,34816
R a[172:175],v6,34816
M a[0:3],a[36:39],a[164:167],a[0:3]
T a[96:97],v1,0
T a[98:99],v1,1024
M a[4:7],a[44:47],a[164:167],a[4:7]
SA m0,s24,16384
M a[4:7],a[40:43],a[160:163],a[4:7]
buffer_load_dwordx4 v12, s[48:51], s22 offen offset:0   lds
M a[8:11],a[48:51],a[160:163],a[8:11]
M a[8:11],a[52:55],a[164:167],a[8:11]
M a[12:15],a[60:63],a[164:167],a[12:15]
s_nop 0
T a[100:101],v1,8192
T a[102:103],v1,9216
M a[12:15],a[56:59],a[160:163],a[12:15]
M a[16:19],a[64:67],a[160:163],a[16:19]
buffer_load_dwordx4 v13, s[48:51], s22 offen offset:1024   lds
M a[16:19],a[68:71],a[164:167],a[16:19]
M a[20:23],a[76:79],a[164:167],a[20:23]
M a[20:23],a[72:75],a[160:163],a[20:23]
s_nop 0
T a[104:105],v2,0
T a[106:107],v2,1024
M a[24:27],a[80:83],a[160:163],a[24:27]
M a[24:27],a[84:87],a[164:167],a[24:27]
s_waitcnt lgkmcnt(6)
buffer_load_dwordx4 v14, s[48:51], s22 offen offset:2048   lds
M a[28:31],a[92:95],a[164:167],a[28:31]
M a[28:31],a[88:91],a[160:163],a[28:31]
M v[32:35],a[32:35],a[168:171],v[32:35]
R a[160:163],v5,36864
R a[164:167],v6,36864
M v[32:35],a[36:39],a[172:175],v[32:35]
T a[108:109],v2,8192
T a[110:111],v2,9216
M v[36:39],a[44:47],a[172:175],v[36:39]
buffer_load_dwordx4 v15, s[48:51], s22 offen offset:3072   lds
M v[36:39],a[40:43],a[168:171],v[36:39]
s_sub_u32 s22, s22, 1048448
M v[40:43],a[48:51],a[168:171],v[40:43]
M v[40:43],a[52:55],a[172:175],v[40:43]
s_nop 0
T a[112:113],v3,0
T a[114:115],v3,1024
M v[44:47],a[60:63],a[172:175],v[44:47]
SA m0,s23,49152
M v[44:47],a[56:59],a[168:171],v[44:47]
buffer_load_dwordx4 v8, s[16:19], s21 offen offset:0  nt lds
M v[48:51],a[64:67],a[168:171],v[48:51]
M v[48:51],a[68:71],a[172:175],v[48:51]
M v[52:55],a[76:79],a[172:175],v[52:55]
s_nop 0
T a[116:117],v3,8192
T a[118:119],v3,9216
M v[52:55],a[72:75],a[168:171],v[52:55]
M v[56:59],a[80:83],a[168:171],v[56:59]
buffer_load_dwordx4 v9, s[16:19], s21 offen offset:1024  nt lds
M v[56:59],a[84:87],a[172:175],v[56:59]
s_waitcnt lgkmcnt(6)
M v[60:63],a[92:95],a[172:175],v[60:63]
M v[60:63],a[88:91],a[168:171],v[60:63]
s_nop 0
T a[120:121],v4,0
T a[122:123],v4,1024
M v[64:67],a[32:35],a[160:163],v[64:67]
R a[168:171],v5,38912
R a[172:175],v6,38912
M v[64:67],a[36:39],a[164:167],v[64:67]
buffer_load_dwordx4 v10, s[16:19], s21 offen offset:2048  nt lds
M v[68:71],a[44:47],a[164:167],v[68:71]
M v[68:71],a[40:43],a[160:163],v[68:71]
M v[72:75],a[48:51],a[160:163],v[72:75]
s_nop 0
T a[124:125],v4,8192
T a[126:127],v4,9216
M v[72:75],a[52:55],a[164:167],v[72:75]
M v[76:79],a[60:63],a[164:167],v[76:79]
buffer_load_dwordx4 v11, s[16:19], s21 offen offset:3072  nt lds
M v[76:79],a[56:59],a[160:163],v[76:79]
SA s21,s21,524160
M v[80:83],a[64:67],a[160:163],v[80:83]
M v[80:83],a[68:71],a[164:167],v[80:83]
M v[84:87],a[76:79],a[164:167],v[84:87]
M v[84:87],a[72:75],a[160:163],v[84:87]
M v[88:91],a[80:83],a[160:163],v[88:91]
M v[88:91],a[84:87],a[164:167],v[88:91]
s_waitcnt lgkmcnt(2)
M v[92:95],a[92:95],a[164:167],v[92:95]
s_waitcnt vmcnt(16) lgkmcnt(0)
M v[92:95],a[88:91],a[160:163],v[92:95]
s_barrier
M v[96:99],a[32:35],a[168:171],v[96:99]
R a[160:163],v5,49152
R a[164:167],v6,49152
M v[96:99],a[36:39],a[172:175],v[96:99]
M v[100:103],a[44:47],a[172:175],v[100:103]
SA m0,s24,32768
T a[128:129],v1,16384
T a[130:131],v1,17408
M v[100:103],a[40:43],a[168:171],v[100:103]
buffer_load_dwordx4 v12, s[48:51], s22 offen offset:0   lds
M v[104:107],a[48:51],a[168:171],v[104:107]
M v[104:107],a[52:55],a[172:175],v[104:107]
M v[108:111],a[60:63],a[172:175],v[108:111]
M v[108:111],a[56:59],a[168:171],v[108:111]
M v[112:115],a[64:67],a[168:171],v[112:115]
M v[112:115],a[68:71],a[172:175],v[112:115]
s_nop 0
T a[132:133],v1,24576
T a[134:135],v1,25600
M v[116:119],a[76:79],a[172:175],v[116:119]
buffer_load_dwordx4 v13, s[48:51], s22 offen offset:1024   lds
M v[116:119],a[72:75],a[168:171],v[116:119]
M v[120:123],a[80:83],a[168:171],v[120:123]
M v[120:123],a[84:87],a[172:175],v[120:123]
s_waitcnt lgkmcnt(4)
M v[124:127],a[92:95],a[172:175],v[124:127]
M v[124:127],a[88:91],a[168:171],v[124:127]
M v[128:131],a[32:35],a[160:163],v[128:131]
R a[168:171],v5,51200
R a[172:175],v6,51200
M v[128:131],a[36:39],a[164:167],v[128:131]
T a[136:137],v2,16384
T a[138:139],v2,17408
M v[132:135],a[44:47],a[164:167],v[132:135]
buffer_load_dwordx4 v14, s[48:51], s22 offen offset:2048   lds
M v[132:135],a[40:43],a[160:163],v[132:135]
M v[136:139],a[48:51],a[160:163],v[136:139]
M v[136:139],a[52:55],a[164:167],v[136:139]
M v[140:143],a[60:63],a[164:167],v[140:143]
M v[140:143],a[56:59],a[160:163],v[140:143]
s_nop 0
T a[140:141],v2,24576
T a[142:143],v2,25600
M v[144:147],a[64:67],a[160:163],v[144:147]
buffer_load_dwordx4 v15, s[48:51], s22 offen offset:3072   lds
M v[144:147],a[68:71],a[164:167],v[144:147]
SA s22,s22,1048576
M v[148:151],a[76:79],a[164:167],v[148:151]
M v[148:151],a[72:75],a[160:163],v[148:151]
M v[152:155],a[80:83],a[160:163],v[152:155]
M v[152:155],a[84:87],a[164:167],v[152:155]
s_waitcnt lgkmcnt(4)
M v[156:159],a[92:95],a[164:167],v[156:159]
SA m0,s23,0
T a[144:145],v3,16384
T a[146:147],v3,17408
M v[156:159],a[88:91],a[160:163],v[156:159]
buffer_load_dwordx4 v8, s[16:19], s21 offen offset:0  nt lds
M v[160:163],a[32:35],a[168:171],v[160:163]
R a[160:163],v5,53248
R a[164:167],v6,53248
M v[160:163],a[36:39],a[172:175],v[160:163]
M v[164:167],a[44:47],a[172:175],v[164:167]
M v[164:167],a[40:43],a[168:171],v[164:167]
M v[168:171],a[48:51],a[168:171],v[168:171]
M v[168:171],a[52:55],a[172:175],v[168:171]
s_nop 0
T a[148:149],v3,24576
T a[150:151],v3,25600
M v[172:175],a[60:63],a[172:175],v[172:175]
buffer_load_dwordx4 v9, s[16:19], s21 offen offset:1024  nt lds
M v[172:175],a[56:59],a[168:171],v[172:175]
M v[176:179],a[64:67],a[168:171],v[176:179]
M v[176:179],a[68:71],a[172:175],v[176:179]
M v[180:183],a[76:79],a[172:175],v[180:183]
M v[180:183],a[72:75],a[168:171],v[180:183]
M v[184:187],a[80:83],a[168:171],v[184:187]
s_nop 0
T a[152:153],v4,16384
T a[154:155],v4,17408
M v[184:187],a[84:87],a[172:175],v[184:187]
s_waitcnt lgkmcnt(4)
buffer_load_dwordx4 v10, s[16:19], s21 offen offset:2048  nt lds
M v[188:191],a[92:95],a[172:175],v[188:191]
M v[188:191],a[88:91],a[168:171],v[188:191]
M v[192:195],a[32:35],a[160:163],v[192:195]
R a[168:171],v5,55296
R a[172:175],v6,55296
M v[192:195],a[36:39],a[164:167],v[192:195]
M v[196:199],a[44:47],a[164:167],v[196:199]
M v[196:199],a[40:43],a[160:163],v[196:199]
s_nop 0
T a[156:157],v4,24576
T a[158:159],v4,25600
M v[200:203],a[48:51],a[160:163],v[200:203]
buffer_load_dwordx4 v11, s[16:19], s21 offen offset:3072  nt lds
M v[200:203],a[52:55],a[164:167],v[200:203]
SA s21,s21,128
M v[204:207],a[60:63],a[164:167],v[204:207]
M v[204:207],a[56:59],a[160:163],v[204:207]
M v[208:211],a[64:67],a[160:163],v[208:211]
M v[208:211],a[68:71],a[164:167],v[208:211]
M v[212:215],a[76:79],a[164:167],v[212:215]
M v[212:215],a[72:75],a[160:163],v[212:215]
M v[216:219],a[80:83],a[160:163],v[216:219]
M v[216:219],a[84:87],a[164:167],v[216:219]
s_waitcnt lgkmcnt(2)
M v[220:223],a[92:95],a[164:167],v[220:223]
s_waitcnt vmcnt(16) lgkmcnt(0)
M v[220:223],a[88:91],a[160:163],v[220:223]
s_barrier
M v[224:227],a[32:35],a[168:171],v[224:227]
R a[160:163],v5,0
R a[164:167],v6,0
M v[224:227],a[36:39],a[172:175],v[224:227]
v_min_u32 v16, 1, v0
v_lshlrev_b32 v16, 29, v16
M v[228:231],a[44:47],a[172:175],v[228:231]
v_or_b32 v16, s39, v16
v_mov_b32 v17, 1
M v[228:231],a[40:43],a[168:171],v[228:231]
buffer_store_dword v17, v16, s[12:15], s38 offen sc1
M v[232:235],a[48:51],a[168:171],v[232:235]
M v[232:235],a[52:55],a[172:175],v[232:235]
M v[236:239],a[60:63],a[172:175],v[236:239]
M v[236:239],a[56:59],a[168:171],v[236:239]
M v[240:243],a[64:67],a[168:171],v[240:243]
M v[240:243],a[68:71],a[172:175],v[240:243]
M v[244:247],a[76:79],a[172:175],v[244:247]
M v[244:247],a[72:75],a[168:171],v[244:247]
M v[248:251],a[80:83],a[168:171],v[248:251]
M v[248:251],a[84:87],a[172:175],v[248:251]
s_waitcnt lgkmcnt(0)
M v[252:255],a[92:95],a[172:175],v[252:255]
M v[252:255],a[88:91],a[168:171],v[252:255]
M a[0:3],a[96:99],a[160:163],a[0:3]
L_w_kv01:
s_cbranch_execz L_w_kv05
R a[168:171],v5,2048
R a[172:175],v6,2048
M a[0:3],a[100:103],a[164:167],a[0:3]
T a[32:33],v1,32768
T a[34:35],v1,33792
M a[4:7],a[108:111],a[164:167],a[4:7]
SA m0,s24,49152
M a[4:7],a[104:107],a[160:163],a[4:7]
buffer_load_dwordx4 v12, s[48:51], s22 offen offset:0   lds
M a[8:11],a[112:115],a[160:163],a[8:11]
M a[8:11],a[116:119],a[164:167],a[8:11]
M a[12:15],a[124:127],a[164:167],a[12:15]
s_nop 0
T a[36:37],v1,40960
T a[38:39],v1,41984
M a[12:15],a[120:123],a[160:163],a[12:15]
M a[16:19],a[128:131],a[160:163],a[16:19]
buffer_load_dwordx4 v13, s[48:51], s22 offen offset:1024   lds
M a[16:19],a[132:135],a[164:167],a[16:19]
M a[20:23],a[140:143],a[164:167],a[20:23]
M a[20:23],a[136:139],a[160:163],a[20:23]
s_nop 0
T a[40:41],v2,32768
T a[42:43],v2,33792
M a[24:27],a[144:147],a[160:163],a[24:27]
M a[24:27],a[148:151],a[164:167],a[24:27]
s_waitcnt lgkmcnt(6)
buffer_load_dwordx4 v14, s[48:51], s22 offen offset:2048   lds
M a[28:31],a[156:159],a[164:167],a[28:31]
M a[28:31],a[152:155],a[160:163],a[28:31]
M v[32:35],a[96:99],a[168:171],v[32:35]
R a[160:163],v5,4096
R a[164:167],v6,4096
M v[32:35],a[100:103],a[172:175],v[32:35]
T a[44:45],v2,40960
T a[46:47],v2,41984
M v[36:39],a[108:111],a[172:175],v[36:39]
buffer_load_dwordx4 v15, s[48:51], s22 offen offset:3072   lds
M v[36:39],a[104:107],a[168:171],v[36:39]
s_sub_u32 s22, s22, 1048448
M v[40:43],a[112:115],a[168:171],v[40:43]
M v[40:43],a[116:119],a[172:175],v[40:43]
s_nop 0
T a[48:49],v3,32768
T a[50:51],v3,33792
M v[44:47],a[124:127],a[172:175],v[44:47]
SA m0,s23,16384
M v[44:47],a[120:123],a[168:171],v[44:47]
buffer_load_dwordx4 v8, s[16:19], s21 offen offset:0  nt lds
M v[48:51],a[128:131],a[168:171],v[48:51]
M v[48:51],a[132:135],a[172:175],v[48:51]
M v[52:55],a[140:143],a[172:175],v[52:55]
s_nop 0
T a[52:53],v3,40960
T a[54:55],v3,41984
M v[52:55],a[136:139],a[168:171],v[52:55]
M v[56:59],a[144:147],a[168:171],v[56:59]
buffer_load_dwordx4 v9, s[16:19], s21 offen offset:1024  nt lds
M v[56:59],a[148:151],a[172:175],v[56:59]
s_waitcnt lgkmcnt(6)
M v[60:63],a[156:159],a[172:175],v[60:63]
M v[60:63],a[152:155],a[168:171],v[60:63]
s_nop 0
T a[56:57],v4,32768
T a[58:59],v4,33792
M v[64:67],a[96:99],a[160:163],v[64:67]
R a[168:171],v5,6144
R a[172:175],v6,6144
M v[64:67],a[100:103],a[164:167],v[64:67]
buffer_load_dwordx4 v10, s[16:19], s21 offen offset:2048  nt lds
M v[68:71],a[108:111],a[164:167],v[68:71]
M v[68:71],a[104:107],a[160:163],v[68:71]
M v[72:75],a[112:115],a[160:163],v[72:75]
s_nop 0
T a[60:61],v4,40960
T a[62:63],v4,41984
M v[72:75],a[116:119],a[164:167],v[72:75]
M v[76:79],a[124:127],a[164:167],v[76:79]
buffer_load_dwordx4 v11, s[16:19], s21 offen offset:3072  nt lds
M v[76:79],a[120:123],a[160:163],v[76:79]
SA s21,s21,524160
M v[80:83],a[128:131],a[160:163],v[80:83]
M v[80:83],a[132:135],a[164:167],v[80:83]
M v[84:87],a[140:143],a[164:167],v[84:87]
M v[84:87],a[136:139],a[160:163],v[84:87]
s_and_b32 s86, s41, 7
M v[88:91],a[144:147],a[160:163],v[88:91]
s_mul_i32 s86, s86, 14
s_lshr_b32 s64, s41, 3
s_mul_i32 s64, s64, 7
M v[88:91],a[148:151],a[164:167],v[88:91]
s_waitcnt lgkmcnt(2)
SA s86,s86,s64
s_min_u32 s64, s31, 6
M v[92:95],a[156:159],a[164:167],v[92:95]
s_waitcnt vmcnt(17) lgkmcnt(0)
SA s86,s86,s64
s_sub_u32 s64, 6, s31
M v[92:95],a[152:155],a[160:163],v[92:95]
s_barrier
M v[96:99],a[96:99],a[168:171],v[96:99]
R a[160:163],v5,16384
R a[164:167],v6,16384
M v[96:99],a[100:103],a[172:175],v[96:99]
s_and_b32 s88, s64, 536870912
s_mul_i32 s87, s20, 7168
M v[100:103],a[108:111],a[172:175],v[100:103]
SA m0,s24,0
T a[64:65],v1,49152
T a[66:67],v1,50176
M v[100:103],a[104:107],a[168:171],v[100:103]
buffer_load_dwordx4 v12, s[48:51], s22 offen offset:0   lds
M v[104:107],a[112:115],a[168:171],v[104:107]
SA s87,s87,131072
M v[104:107],a[116:119],a[172:175],v[104:107]
s_cmp_lt_u32 s20, 2
M v[108:111],a[124:127],a[172:175],v[108:111]
s_cselect_b64 s[72:73], s[80:81], s[82:83]
M v[108:111],a[120:123],a[168:171],v[108:111]
s_mov_b32 s60, s72
M v[112:115],a[128:131],a[168:171],v[112:115]
s_and_b32 s61, s73, 0xffff
M v[112:115],a[132:135],a[172:175],v[112:115]
s_mov_b32 s62, 1605632
T a[68:69],v1,57344
T a[70:71],v1,58368
M v[116:119],a[140:143],a[172:175],v[116:119]
s_mov_b32 s63, 0x20000
buffer_load_dwordx4 v13, s[48:51], s22 offen offset:1024   lds
M v[116:119],a[136:139],a[168:171],v[116:119]
s_mov_b32 s68, s84
M v[120:123],a[144:147],a[168:171],v[120:123]
s_and_b32 s69, s85, 0xffff
s_mov_b32 s70, 1605632
s_mov_b32 s71, 0x20000
M v[120:123],a[148:151],a[172:175],v[120:123]
s_waitcnt lgkmcnt(4)
s_lshl_b32 s89, s86, 5
M v[124:127],a[156:159],a[172:175],v[124:127]
s_and_b32 s64, s20, 1
M v[124:127],a[152:155],a[168:171],v[124:127]
s_mul_i32 s64, s64, 802816
M v[128:131],a[96:99],a[160:163],v[128:131]
SA s89,s89,s64
R a[168:171],v5,18432
R a[172:175],v6,18432
M v[128:131],a[100:103],a[164:167],v[128:131]
T a[72:73],v2,49152
T a[74:75],v2,50176
M v[132:135],a[108:111],a[164:167],v[132:135]
buffer_load_dwordx4 v14, s[48:51], s22 offen offset:2048   lds
M v[132:135],a[104:107],a[160:163],v[132:135]
v_lshrrev_b32 v28, 1, v0
v_mul_u32_u24 v28, 3584, v28
M v[136:139],a[112:115],a[160:163],v[136:139]
v_and_b32 v29, 1, v0
v_lshl_add_u32 v25, v29, 4, v28
M v[136:139],a[116:119],a[164:167],v[136:139]
v_or_b32 v25, s88, v25
M v[140:143],a[124:127],a[164:167],v[140:143]
M v[140:143],a[120:123],a[160:163],v[140:143]
s_nop 0
T a[76:77],v2,57344
T a[78:79],v2,58368
M v[144:147],a[128:131],a[160:163],v[144:147]
buffer_load_dwordx4 v15, s[48:51], s22 offen offset:3072   lds
M v[144:147],a[132:135],a[164:167],v[144:147]
SA s22,s22,1048576
M v[148:151],a[140:143],a[164:167],v[148:151]
M v[148:151],a[136:139],a[160:163],v[148:151]
M v[152:155],a[144:147],a[160:163],v[152:155]
M v[152:155],a[148:151],a[164:167],v[152:155]
s_waitcnt lgkmcnt(4)
M v[156:159],a[156:159],a[164:167],v[156:159]
SA m0,s23,32768
T a[80:81],v3,49152
T a[82:83],v3,50176
M v[156:159],a[152:155],a[160:163],v[156:159]
buffer_load_dwordx4 v8, s[16:19], s21 offen offset:0  nt lds
M v[160:163],a[96:99],a[168:171],v[160:163]
R a[160:163],v5,20480
R a[164:167],v6,20480
M v[160:163],a[100:103],a[172:175],v[160:163]
M v[164:167],a[108:111],a[172:175],v[164:167]
M v[164:167],a[104:107],a[168:171],v[164:167]
M v[168:171],a[112:115],a[168:171],v[168:171]
M v[168:171],a[116:119],a[172:175],v[168:171]
s_nop 0
T a[84:85],v3,57344
T a[86:87],v3,58368
M v[172:175],a[124:127],a[172:175],v[172:175]
buffer_load_dwordx4 v9, s[16:19], s21 offen offset:1024  nt lds
M v[172:175],a[120:123],a[168:171],v[172:175]
M v[176:179],a[128:131],a[168:171],v[176:179]
M v[176:179],a[132:135],a[172:175],v[176:179]
M v[180:183],a[140:143],a[172:175],v[180:183]
M v[180:183],a[136:139],a[168:171],v[180:183]
M v[184:187],a[144:147],a[168:171],v[184:187]
s_nop 0
T a[88:89],v4,49152
T a[90:91],v4,50176
M v[184:187],a[148:151],a[172:175],v[184:187]
s_waitcnt lgkmcnt(4)
buffer_load_dwordx4 v10, s[16:19], s21 offen offset:2048  nt lds
M v[188:191],a[156:159],a[172:175],v[188:191]
M v[188:191],a[152:155],a[168:171],v[188:191]
M v[192:195],a[96:99],a[160:163],v[192:195]
R a[168:171],v5,22528
R a[172:175],v6,22528
M v[192:195],a[100:103],a[164:167],v[192:195]
M v[196:199],a[108:111],a[164:167],v[196:199]
M v[196:199],a[104:107],a[160:163],v[196:199]
s_nop 0
T a[92:93],v4,57344
T a[94:95],v4,58368
M v[200:203],a[112:115],a[160:163],v[200:203]
buffer_load_dwordx4 v11, s[16:19], s21 offen offset:3072  nt lds
M v[200:203],a[116:119],a[164:167],v[200:203]
SA s21,s21,128
M v[204:207],a[124:127],a[164:167],v[204:207]
M v[204:207],a[120:123],a[160:163],v[204:207]
M v[208:211],a[128:131],a[160:163],v[208:211]
M v[208:211],a[132:135],a[164:167],v[208:211]
M v[212:215],a[140:143],a[164:167],v[212:215]
M v[212:215],a[136:139],a[160:163],v[212:215]
M v[216:219],a[144:147],a[160:163],v[216:219]
M v[216:219],a[148:151],a[164:167],v[216:219]
s_waitcnt lgkmcnt(2)
M v[220:223],a[156:159],a[164:167],v[220:223]
s_waitcnt vmcnt(17) lgkmcnt(0)
M v[220:223],a[152:155],a[160:163],v[220:223]
s_barrier
M v[224:227],a[96:99],a[168:171],v[224:227]
R a[160:163],v5,32768
R a[164:167],v6,32768
M v[224:227],a[100:103],a[172:175],v[224:227]
M v[228:231],a[108:111],a[172:175],v[228:231]
M v[228:231],a[104:107],a[168:171],v[228:231]
M v[232:235],a[112:115],a[168:171],v[232:235]
M v[232:235],a[116:119],a[172:175],v[232:235]
M v[236:239],a[124:127],a[172:175],v[236:239]
M v[236:239],a[120:123],a[168:171],v[236:239]
M v[240:243],a[128:131],a[168:171],v[240:243]
M v[240:243],a[132:135],a[172:175],v[240:243]
M v[244:247],a[140:143],a[172:175],v[244:247]
M v[244:247],a[136:139],a[168:171],v[244:247]
M v[248:251],a[144:147],a[168:171],v[248:251]
M v[248:251],a[148:151],a[172:175],v[248:251]
s_waitcnt lgkmcnt(0)
M v[252:255],a[156:159],a[172:175],v[252:255]
M v[252:255],a[152:155],a[168:171],v[252:255]
M a[0:3],a[32:35],a[160:163],a[0:3]
R a[168:171],v5,34816
R a[172:175],v6,34816
M a[0:3],a[36:39],a[164:167],a[0:3]
T a[96:97],v1,0
T a[98:99],v1,1024
M a[4:7],a[44:47],a[164:167],a[4:7]
SA m0,s24,16384
M a[4:7],a[40:43],a[160:163],a[4:7]
buffer_load_dwordx4 v12, s[48:51], s22 offen offset:0   lds
M a[8:11],a[48:51],a[160:163],a[8:11]
M a[8:11],a[52:55],a[164:167],a[8:11]
M a[12:15],a[60:63],a[164:167],a[12:15]
s_nop 0
T a[100:101],v1,8192
T a[102:103],v1,9216
M a[12:15],a[56:59],a[160:163],a[12:15]
M a[16:19],a[64:67],a[160:163],a[16:19]
buffer_load_dwordx4 v13, s[48:51], s22 offen offset:1024   lds
M a[16:19],a[68:71],a[164:167],a[16:19]
M a[20:23],a[76:79],a[164:167],a[20:23]
M a[20:23],a[72:75],a[160:163],a[20:23]
s_nop 0
T a[104:105],v2,0
T a[106:107],v2,1024
M a[24:27],a[80:83],a[160:163],a[24:27]
M a[24:27],a[84:87],a[164:167],a[24:27]
s_waitcnt lgkmcnt(6)
buffer_load_dwordx4 v14, s[48:51], s22 offen offset:2048   lds
M a[28:31],a[92:95],a[164:167],a[28:31]
M a[28:31],a[88:91],a[160:163],a[28:31]
M v[32:35],a[32:35],a[168:171],v[32:35]
R a[160:163],v5,36864
R a[164:167],v6,36864
M v[32:35],a[36:39],a[172:175],v[32:35]
T a[108:109],v2,8192
T a[110:111],v2,9216
M v[36:39],a[44:47],a[172:175],v[36:39]
buffer_load_dwordx4 v15, s[48:51], s22 offen offset:3072   lds
M v[36:39],a[40:43],a[168:171],v[36:39]
s_sub_u32 s22, s22, 1048448
M v[40:43],a[48:51],a[168:171],v[40:43]
M v[40:43],a[52:55],a[172:175],v[40:43]
s_nop 0
T a[112:113],v3,0
T a[114:115],v3,1024
M v[44:47],a[60:63],a[172:175],v[44:47]
SA m0,s23,49152
M v[44:47],a[56:59],a[168:171],v[44:47]
buffer_load_dwordx4 v8, s[16:19], s21 offen offset:0  nt lds
M v[48:51],a[64:67],a[168:171],v[48:51]
M v[48:51],a[68:71],a[172:175],v[48:51]
M v[52:55],a[76:79],a[172:175],v[52:55]
s_nop 0
T a[116:117],v3,8192
T a[118:119],v3,9216
M v[52:55],a[72:75],a[168:171],v[52:55]
M v[56:59],a[80:83],a[168:171],v[56:59]
buffer_load_dwordx4 v9, s[16:19], s21 offen offset:1024  nt lds
M v[56:59],a[84:87],a[172:175],v[56:59]
s_waitcnt lgkmcnt(6)
M v[60:63],a[92:95],a[172:175],v[60:63]
M v[60:63],a[88:91],a[168:171],v[60:63]
s_nop 0
T a[120:121],v4,0
T a[122:123],v4,1024
M v[64:67],a[32:35],a[160:163],v[64:67]
R a[168:171],v5,38912
R a[172:175],v6,38912
M v[64:67],a[36:39],a[164:167],v[64:67]
buffer_load_dwordx4 v10, s[16:19], s21 offen offset:2048  nt lds
M v[68:71],a[44:47],a[164:167],v[68:71]
M v[68:71],a[40:43],a[160:163],v[68:71]
M v[72:75],a[48:51],a[160:163],v[72:75]
s_nop 0
T a[124:125],v4,8192
T a[126:127],v4,9216
M v[72:75],a[52:55],a[164:167],v[72:75]
M v[76:79],a[60:63],a[164:167],v[76:79]
buffer_load_dwordx4 v11, s[16:19], s21 offen offset:3072  nt lds
M v[76:79],a[56:59],a[160:163],v[76:79]
SA s21,s21,524160
M v[80:83],a[64:67],a[160:163],v[80:83]
M v[80:83],a[68:71],a[164:167],v[80:83]
M v[84:87],a[76:79],a[164:167],v[84:87]
M v[84:87],a[72:75],a[160:163],v[84:87]
M v[88:91],a[80:83],a[160:163],v[88:91]
M v[88:91],a[84:87],a[164:167],v[88:91]
s_waitcnt lgkmcnt(2)
M v[92:95],a[92:95],a[164:167],v[92:95]
s_waitcnt vmcnt(16) lgkmcnt(0)
M v[92:95],a[88:91],a[160:163],v[92:95]
s_barrier
M v[96:99],a[32:35],a[168:171],v[96:99]
R a[160:163],v5,49152
R a[164:167],v6,49152
M v[96:99],a[36:39],a[172:175],v[96:99]
M v[100:103],a[44:47],a[172:175],v[100:103]
SA m0,s24,32768
T a[128:129],v1,16384
T a[130:131],v1,17408
M v[100:103],a[40:43],a[168:171],v[100:103]
buffer_load_dwordx4 v12, s[48:51], s22 offen offset:0   lds
M v[104:107],a[48:51],a[168:171],v[104:107]
v_min_u32 v16, 40, v0
v_lshlrev_b32 v16, 2, v16
M v[104:107],a[52:55],a[172:175],v[104:107]
buffer_load_dword v17, v16, s[12:15], 0 offen sc1
M v[108:111],a[60:63],a[172:175],v[108:111]
M v[108:111],a[56:59],a[168:171],v[108:111]
M v[112:115],a[64:67],a[168:171],v[112:115]
buffer_load_dwordx4 v13, s[48:51], s22 offen offset:1024   lds
M v[112:115],a[68:71],a[172:175],v[112:115]
s_nop 0
T a[132:133],v1,24576
T a[134:135],v1,25600
M v[116:119],a[76:79],a[172:175],v[116:119]
M v[116:119],a[72:75],a[168:171],v[116:119]
M v[120:123],a[80:83],a[168:171],v[120:123]
M v[120:123],a[84:87],a[172:175],v[120:123]
s_waitcnt lgkmcnt(4)
M v[124:127],a[92:95],a[172:175],v[124:127]
buffer_load_dwordx4 v14, s[48:51], s22 offen offset:2048   lds
M v[124:127],a[88:91],a[168:171],v[124:127]
M v[128:131],a[32:35],a[160:163],v[128:131]
R a[168:171],v5,51200
R a[172:175],v6,51200
M v[128:131],a[36:39],a[164:167],v[128:131]
T a[136:137],v2,16384
T a[138:139],v2,17408
M v[132:135],a[44:47],a[164:167],v[132:135]
M v[132:135],a[40:43],a[160:163],v[132:135]
M v[136:139],a[48:51],a[160:163],v[136:139]
buffer_load_dwordx4 v15, s[48:51], s22 offen offset:3072   lds
M v[136:139],a[52:55],a[164:167],v[136:139]
SA s22,s22,1048576
M v[140:143],a[60:63],a[164:167],v[140:143]
M v[140:143],a[56:59],a[160:163],v[140:143]
s_nop 0
T a[140:141],v2,24576
T a[142:143],v2,25600
M v[144:147],a[64:67],a[160:163],v[144:147]
SA m0,s23,0
M v[144:147],a[68:71],a[164:167],v[144:147]
buffer_load_dwordx4 v8, s[16:19], s21 offen offset:0  nt lds
M v[148:151],a[76:79],a[164:167],v[148:151]
M v[148:151],a[72:75],a[160:163],v[148:151]
M v[152:155],a[80:83],a[160:163],v[152:155]
M v[152:155],a[84:87],a[164:167],v[152:155]
s_waitcnt lgkmcnt(4)
M v[156:159],a[92:95],a[164:167],v[156:159]
s_nop 0
T a[144:145],v3,16384
T a[146:147],v3,17408
M v[156:159],a[88:91],a[160:163],v[156:159]
buffer_load_dwordx4 v9, s[16:19], s21 offen offset:1024  nt lds
M v[160:163],a[32:35],a[168:171],v[160:163]
R a[160:163],v5,53248
R a[164:167],v6,53248
M v[160:163],a[36:39],a[172:175],v[160:163]
M v[164:167],a[44:47],a[172:175],v[164:167]
M v[164:167],a[40:43],a[168:171],v[164:167]
M v[168:171],a[48:51],a[168:171],v[168:171]
M v[168:171],a[52:55],a[172:175],v[168:171]
s_nop 0
T a[148:149],v3,24576
T a[150:151],v3,25600
M v[172:175],a[60:63],a[172:175],v[172:175]
buffer_load_dwordx4 v10, s[16:19], s21 offen offset:2048  nt lds
M v[172:175],a[56:59],a[168:171],v[172:175]
M v[176:179],a[64:67],a[168:171],v[176:179]
M v[176:179],a[68:71],a[172:175],v[176:179]
M v[180:183],a[76:79],a[172:175],v[180:183]
buffer_load_dwordx4 v11, s[16:19], s21 offen offset:3072  nt lds
M v[180:183],a[72:75],a[168:171],v[180:183]
SA s21,s21,128
M v[184:187],a[80:83],a[168:171],v[184:187]
s_nop 0
T a[152:153],v4,16384
T a[154:155],v4,17408
M v[184:187],a[84:87],a[172:175],v[184:187]
s_waitcnt lgkmcnt(4)
M v[188:191],a[92:95],a[172:175],v[188:191]
M v[188:191],a[88:91],a[168:171],v[188:191]
SA m0,s87,0
M v[192:195],a[32:35],a[160:163],v[192:195]
R a[168:171],v5,55296
R a[172:175],v6,55296
M v[192:195],a[36:39],a[164:167],v[192:195]
buffer_load_dwordx4 v25, s[60:63], s89 offen offset:0 nt lds
M v[196:199],a[44:47],a[164:167],v[196:199]
SA s89,s89,114688
M v[196:199],a[40:43],a[160:163],v[196:199]
s_nop 0
T a[156:157],v4,24576
T a[158:159],v4,25600
M v[200:203],a[48:51],a[160:163],v[200:203]
M v[200:203],a[52:55],a[164:167],v[200:203]
SA m0,s87,1024
M v[204:207],a[60:63],a[164:167],v[204:207]
buffer_load_dwordx4 v25, s[60:63], s89 offen offset:0 nt lds
M v[204:207],a[56:59],a[160:163],v[204:207]
SA s89,s89,114688
M v[208:211],a[64:67],a[160:163],v[208:211]
M v[208:211],a[68:71],a[164:167],v[208:211]
M v[212:215],a[76:79],a[164:167],v[212:215]
M v[212:215],a[72:75],a[160:163],v[212:215]
M v[216:219],a[80:83],a[160:163],v[216:219]
M v[216:219],a[84:87],a[164:167],v[216:219]
s_waitcnt lgkmcnt(2)
M v[220:223],a[92:95],a[164:167],v[220:223]
s_waitcnt vmcnt(19) lgkmcnt(0)
M v[220:223],a[88:91],a[160:163],v[220:223]
s_barrier
M v[224:227],a[32:35],a[168:171],v[224:227]
R a[160:163],v5,0
R a[164:167],v6,0
M v[224:227],a[36:39],a[172:175],v[224:227]
M v[228:231],a[44:47],a[172:175],v[228:231]
M v[228:231],a[40:43],a[168:171],v[228:231]
M v[232:235],a[48:51],a[168:171],v[232:235]
M v[232:235],a[52:55],a[172:175],v[232:235]
M v[236:239],a[60:63],a[172:175],v[236:239]
M v[236:239],a[56:59],a[168:171],v[236:239]
M v[240:243],a[64:67],a[168:171],v[240:243]
M v[240:243],a[68:71],a[172:175],v[240:243]
M v[244:247],a[76:79],a[172:175],v[244:247]
M v[244:247],a[72:75],a[168:171],v[244:247]
M v[248:251],a[80:83],a[168:171],v[248:251]
M v[248:251],a[84:87],a[172:175],v[248:251]
s_waitcnt lgkmcnt(0)
M v[252:255],a[92:95],a[172:175],v[252:255]
M v[252:255],a[88:91],a[168:171],v[252:255]
M a[0:3],a[96:99],a[160:163],a[0:3]
R a[168:171],v5,2048
R a[172:175],v6,2048
M a[0:3],a[100:103],a[164:167],a[0:3]
T a[32:33],v1,32768
T a[34:35],v1,33792
M a[4:7],a[108:111],a[164:167],a[4:7]
SA m0,s24,49152
M a[4:7],a[104:107],a[160:163],a[4:7]
buffer_load_dwordx4 v12, s[48:51], s22 offen offset:0   lds
M a[8:11],a[112:115],a[160:163],a[8:11]
M a[8:11],a[116:119],a[164:167],a[8:11]
M a[12:15],a[124:127],a[164:167],a[12:15]
s_nop 0
T a[36:37],v1,40960
T a[38:39],v1,41984
M a[12:15],a[120:123],a[160:163],a[12:15]
M a[16:19],a[128:131],a[160:163],a[16:19]
buffer_load_dwordx4 v13, s[48:51], s22 offen offset:1024   lds
M a[16:19],a[132:135],a[164:167],a[16:19]
M a[20:23],a[140:143],a[164:167],a[20:23]
M a[20:23],a[136:139],a[160:163],a[20:23]
s_nop 0
T a[40:41],v2,32768
T a[42:43],v2,33792
M a[24:27],a[144:147],a[160:163],a[24:27]
M a[24:27],a[148:151],a[164:167],a[24:27]
s_waitcnt lgkmcnt(6)
buffer_load_dwordx4 v14, s[48:51], s22 offen offset:2048   lds
M a[28:31],a[156:159],a[164:167],a[28:31]
M a[28:31],a[152:155],a[160:163],a[28:31]
M v[32:35],a[96:99],a[168:171],v[32:35]
R a[160:163],v5,4096
R a[164:167],v6,4096
M v[32:35],a[100:103],a[172:175],v[32:35]
T a[44:45],v2,40960
T a[46:47],v2,41984
M v[36:39],a[108:111],a[172:175],v[36:39]
buffer_load_dwordx4 v15, s[48:51], s22 offen offset:3072   lds
M v[36:39],a[104:107],a[168:171],v[36:39]
s_sub_u32 s22, s22, 1048448
M v[40:43],a[112:115],a[168:171],v[40:43]
M v[40:43],a[116:119],a[172:175],v[40:43]
s_nop 0
T a[48:49],v3,32768
T a[50:51],v3,33792
M v[44:47],a[124:127],a[172:175],v[44:47]
SA m0,s23,16384
M v[44:47],a[120:123],a[168:171],v[44:47]
buffer_load_dwordx4 v8, s[16:19], s21 offen offset:0  nt lds
M v[48:51],a[128:131],a[168:171],v[48:51]
M v[48:51],a[132:135],a[172:175],v[48:51]
M v[52:55],a[140:143],a[172:175],v[52:55]
s_nop 0
T a[52:53],v3,40960
T a[54:55],v3,41984
M v[52:55],a[136:139],a[168:171],v[52:55]
M v[56:59],a[144:147],a[168:171],v[56:59]
buffer_load_dwordx4 v9, s[16:19], s21 offen offset:1024  nt lds
M v[56:59],a[148:151],a[172:175],v[56:59]
s_waitcnt lgkmcnt(6)
M v[60:63],a[156:159],a[172:175],v[60:63]
M v[60:63],a[152:155],a[168:171],v[60:63]
s_nop 0
T a[56:57],v4,32768
L_w_kv02:
s_cbranch_execz L_w_kv06
T a[58:59],v4,33792
M v[64:67],a[96:99],a[160:163],v[64:67]
R a[168:171],v5,6144
R a[172:175],v6,6144
M v[64:67],a[100:103],a[164:167],v[64:67]
buffer_load_dwordx4 v10, s[16:19], s21 offen offset:2048  nt lds
M v[68:71],a[108:111],a[164:167],v[68:71]
M v[68:71],a[104:107],a[160:163],v[68:71]
M v[72:75],a[112:115],a[160:163],v[72:75]
s_nop 0
T a[60:61],v4,40960
T a[62:63],v4,41984
M v[72:75],a[116:119],a[164:167],v[72:75]
M v[76:79],a[124:127],a[164:167],v[76:79]
buffer_load_dwordx4 v11, s[16:19], s21 offen offset:3072  nt lds
M v[76:79],a[120:123],a[160:163],v[76:79]
SA s21,s21,524160
M v[80:83],a[128:131],a[160:163],v[80:83]
M v[80:83],a[132:135],a[164:167],v[80:83]
M v[84:87],a[140:143],a[164:167],v[84:87]
M v[84:87],a[136:139],a[160:163],v[84:87]
M v[88:91],a[144:147],a[160:163],v[88:91]
M v[88:91],a[148:151],a[164:167],v[88:91]
s_waitcnt lgkmcnt(2)
M v[92:95],a[156:159],a[164:167],v[92:95]
s_waitcnt vmcnt(19) lgkmcnt(0)
M v[92:95],a[152:155],a[160:163],v[92:95]
s_barrier
M v[96:99],a[96:99],a[168:171],v[96:99]
R a[160:163],v5,16384
R a[164:167],v6,16384
M v[96:99],a[100:103],a[172:175],v[96:99]
M v[100:103],a[108:111],a[172:175],v[100:103]
SA m0,s24,0
T a[64:65],v1,49152
T a[66:67],v1,50176
M v[100:103],a[104:107],a[168:171],v[100:103]
buffer_load_dwordx4 v12, s[48:51], s22 offen offset:0   lds
M v[104:107],a[112:115],a[168:171],v[104:107]
M v[104:107],a[116:119],a[172:175],v[104:107]
M v[108:111],a[124:127],a[172:175],v[108:111]
M v[108:111],a[120:123],a[168:171],v[108:111]
M v[112:115],a[128:131],a[168:171],v[112:115]
buffer_load_dwordx4 v13, s[48:51], s22 offen offset:1024   lds
M v[112:115],a[132:135],a[172:175],v[112:115]
s_nop 0
T a[68:69],v1,57344
T a[70:71],v1,58368
M v[116:119],a[140:143],a[172:175],v[116:119]
M v[116:119],a[136:139],a[168:171],v[116:119]
M v[120:123],a[144:147],a[168:171],v[120:123]
M v[120:123],a[148:151],a[172:175],v[120:123]
s_waitcnt lgkmcnt(4)
M v[124:127],a[156:159],a[172:175],v[124:127]
buffer_load_dwordx4 v14, s[48:51], s22 offen offset:2048   lds
M v[124:127],a[152:155],a[168:171],v[124:127]
M v[128:131],a[96:99],a[160:163],v[128:131]
R a[168:171],v5,18432
R a[172:175],v6,18432
M v[128:131],a[100:103],a[164:167],v[128:131]
T a[72:73],v2,49152
T a[74:75],v2,50176
M v[132:135],a[108:111],a[164:167],v[132:135]
M v[132:135],a[104:107],a[160:163],v[132:135]
M v[136:139],a[112:115],a[160:163],v[136:139]
buffer_load_dwordx4 v15, s[48:51], s22 offen offset:3072   lds
M v[136:139],a[116:119],a[164:167],v[136:139]
SA s22,s22,1048576
M v[140:143],a[124:127],a[164:167],v[140:143]
M v[140:143],a[120:123],a[160:163],v[140:143]
s_nop 0
T a[76:77],v2,57344
T a[78:79],v2,58368
M v[144:147],a[128:131],a[160:163],v[144:147]
SA m0,s23,32768
M v[144:147],a[132:135],a[164:167],v[144:147]
buffer_load_dwordx4 v8, s[16:19], s21 offen offset:0  nt lds
M v[148:151],a[140:143],a[164:167],v[148:151]
M v[148:151],a[136:139],a[160:163],v[148:151]
M v[152:155],a[144:147],a[160:163],v[152:155]
M v[152:155],a[148:151],a[164:167],v[152:155]
s_waitcnt lgkmcnt(4)
M v[156:159],a[156:159],a[164:167],v[156:159]
s_nop 0
T a[80:81],v3,49152
T a[82:83],v3,50176
M v[156:159],a[152:155],a[160:163],v[156:159]
buffer_load_dwordx4 v9, s[16:19], s21 offen offset:1024  nt lds
M v[160:163],a[96:99],a[168:171],v[160:163]
R a[160:163],v5,20480
R a[164:167],v6,20480
M v[160:163],a[100:103],a[172:175],v[160:163]
M v[164:167],a[108:111],a[172:175],v[164:167]
M v[164:167],a[104:107],a[168:171],v[164:167]
M v[168:171],a[112:115],a[168:171],v[168:171]
M v[168:171],a[116:119],a[172:175],v[168:171]
s_nop 0
T a[84:85],v3,57344
T a[86:87],v3,58368
M v[172:175],a[124:127],a[172:175],v[172:175]
buffer_load_dwordx4 v10, s[16:19], s21 offen offset:2048  nt lds
M v[172:175],a[120:123],a[168:171],v[172:175]
M v[176:179],a[128:131],a[168:171],v[176:179]
M v[176:179],a[132:135],a[172:175],v[176:179]
M v[180:183],a[140:143],a[172:175],v[180:183]
buffer_load_dwordx4 v11, s[16:19], s21 offen offset:3072  nt lds
M v[180:183],a[136:139],a[168:171],v[180:183]
SA s21,s21,128
M v[184:187],a[144:147],a[168:171],v[184:187]
s_nop 0
T a[88:89],v4,49152
T a[90:91],v4,50176
M v[184:187],a[148:151],a[172:175],v[184:187]
s_waitcnt lgkmcnt(4)
M v[188:191],a[156:159],a[172:175],v[188:191]
M v[188:191],a[152:155],a[168:171],v[188:191]
SA m0,s87,2048
M v[192:195],a[96:99],a[160:163],v[192:195]
R a[168:171],v5,22528
R a[172:175],v6,22528
M v[192:195],a[100:103],a[164:167],v[192:195]
buffer_load_dwordx4 v25, s[60:63], s89 offen offset:0 nt lds
M v[196:199],a[108:111],a[164:167],v[196:199]
SA s89,s89,114688
M v[196:199],a[104:107],a[160:163],v[196:199]
s_nop 0
T a[92:93],v4,57344
T a[94:95],v4,58368
M v[200:203],a[112:115],a[160:163],v[200:203]
M v[200:203],a[116:119],a[164:167],v[200:203]
SA m0,s87,3072
M v[204:207],a[124:127],a[164:167],v[204:207]
buffer_load_dwordx4 v25, s[60:63], s89 offen offset:0 nt lds
M v[204:207],a[120:123],a[160:163],v[204:207]
SA s89,s89,114688
M v[208:211],a[128:131],a[160:163],v[208:211]
M v[208:211],a[132:135],a[164:167],v[208:211]
M v[212:215],a[140:143],a[164:167],v[212:215]
M v[212:215],a[136:139],a[160:163],v[212:215]
M v[216:219],a[144:147],a[160:163],v[216:219]
M v[216:219],a[148:151],a[164:167],v[216:219]
s_waitcnt lgkmcnt(2)
M v[220:223],a[156:159],a[164:167],v[220:223]
s_waitcnt vmcnt(20) lgkmcnt(0)
M v[220:223],a[152:155],a[160:163],v[220:223]
s_barrier
M v[224:227],a[96:99],a[168:171],v[224:227]
R a[160:163],v5,32768
R a[164:167],v6,32768
M v[224:227],a[100:103],a[172:175],v[224:227]
v_cmp_ne_u32 vcc, 1, v17
M v[228:231],a[108:111],a[172:175],v[228:231]
s_nop 0
M v[228:231],a[104:107],a[168:171],v[228:231]
s_cbranch_vccnz L_zs0
L_zr0:
M v[232:235],a[112:115],a[168:171],v[232:235]
M v[232:235],a[116:119],a[172:175],v[232:235]
M v[236:239],a[124:127],a[172:175],v[236:239]
M v[236:239],a[120:123],a[168:171],v[236:239]
M v[240:243],a[128:131],a[168:171],v[240:243]
M v[240:243],a[132:135],a[172:175],v[240:243]
M v[244:247],a[140:143],a[172:175],v[244:247]
M v[244:247],a[136:139],a[168:171],v[244:247]
M v[248:251],a[144:147],a[168:171],v[248:251]
M v[248:251],a[148:151],a[172:175],v[248:251]
s_waitcnt lgkmcnt(0)
M v[252:255],a[156:159],a[172:175],v[252:255]
M v[252:255],a[152:155],a[168:171],v[252:255]
M a[0:3],a[32:35],a[160:163],a[0:3]
R a[168:171],v5,34816
R a[172:175],v6,34816
M a[0:3],a[36:39],a[164:167],a[0:3]
T a[96:97],v1,0
T a[98:99],v1,1024
M a[4:7],a[44:47],a[164:167],a[4:7]
SA m0,s24,16384
M a[4:7],a[40:43],a[160:163],a[4:7]
buffer_load_dwordx4 v12, s[48:51], s22 offen offset:0   lds
M a[8:11],a[48:51],a[160:163],a[8:11]
M a[8:11],a[52:55],a[164:167],a[8:11]
s_mul_i32 s64, s41, 229376
M a[12:15],a[60:63],a[164:167],a[12:15]
SA s72,s90,s64
T a[100:101],v1,8192
T a[102:103],v1,9216
M a[12:15],a[56:59],a[160:163],a[12:15]
s_addc_u32 s73, s91, 0
M a[16:19],a[64:67],a[160:163],a[16:19]
s_sub_u32 s75, 3670016, s64
buffer_load_dwordx4 v13, s[48:51], s22 offen offset:1024   lds
M a[16:19],a[68:71],a[164:167],a[16:19]
s_mov_b32 s12, s72
M a[20:23],a[76:79],a[164:167],a[20:23]
s_and_b32 s13, s73, 0xffff
M a[20:23],a[72:75],a[160:163],a[20:23]
s_mov_b32 s14, s75
T a[104:105],v2,0
T a[106:107],v2,1024
M a[24:27],a[80:83],a[160:163],a[24:27]
s_mov_b32 s15, 0x20000
M a[24:27],a[84:87],a[164:167],a[24:27]
s_waitcnt lgkmcnt(6)
buffer_load_dwordx4 v14, s[48:51], s22 offen offset:2048   lds
M a[28:31],a[92:95],a[164:167],a[28:31]
M a[28:31],a[88:91],a[160:163],a[28:31]
M v[32:35],a[32:35],a[168:171],v[32:35]
R a[160:163],v5,36864
R a[164:167],v6,36864
M v[32:35],a[36:39],a[172:175],v[32:35]
T a[108:109],v2,8192
T a[110:111],v2,9216
M v[36:39],a[44:47],a[172:175],v[36:39]
buffer_load_dwordx4 v15, s[48:51], s22 offen offset:3072   lds
M v[36:39],a[40:43],a[168:171],v[36:39]
s_sub_u32 s22, s22, 1048448
M v[40:43],a[48:51],a[168:171],v[40:43]
M v[40:43],a[52:55],a[172:175],v[40:43]
s_nop 0
T a[112:113],v3,0
T a[114:115],v3,1024
M v[44:47],a[60:63],a[172:175],v[44:47]
SA m0,s23,49152
M v[44:47],a[56:59],a[168:171],v[44:47]
buffer_load_dwordx4 v8, s[16:19], s21 offen offset:0  nt lds
M v[48:51],a[64:67],a[168:171],v[48:51]
M v[48:51],a[68:71],a[172:175],v[48:51]
M v[52:55],a[76:79],a[172:175],v[52:55]
s_nop 0
T a[116:117],v3,8192
T a[118:119],v3,9216
M v[52:55],a[72:75],a[168:171],v[52:55]
M v[56:59],a[80:83],a[168:171],v[56:59]
buffer_load_dwordx4 v9, s[16:19], s21 offen offset:1024  nt lds
M v[56:59],a[84:87],a[172:175],v[56:59]
s_waitcnt lgkmcnt(6)
M v[60:63],a[92:95],a[172:175],v[60:63]
M v[60:63],a[88:91],a[168:171],v[60:63]
s_nop 0
T a[120:121],v4,0
T a[122:123],v4,1024
M v[64:67],a[32:35],a[160:163],v[64:67]
R a[168:171],v5,38912
R a[172:175],v6,38912
M v[64:67],a[36:39],a[164:167],v[64:67]
buffer_load_dwordx4 v10, s[16:19], s21 offen offset:2048  nt lds
M v[68:71],a[44:47],a[164:167],v[68:71]
M v[68:71],a[40:43],a[160:163],v[68:71]
M v[72:75],a[48:51],a[160:163],v[72:75]
s_nop 0
T a[124:125],v4,8192
T a[126:127],v4,9216
M v[72:75],a[52:55],a[164:167],v[72:75]
M v[76:79],a[60:63],a[164:167],v[76:79]
buffer_load_dwordx4 v11, s[16:19], s21 offen offset:3072  nt lds
M v[76:79],a[56:59],a[160:163],v[76:79]
SA s21,s21,524160
M v[80:83],a[64:67],a[160:163],v[80:83]
M v[80:83],a[68:71],a[164:167],v[80:83]
M v[84:87],a[76:79],a[164:167],v[84:87]
M v[84:87],a[72:75],a[160:163],v[84:87]
M v[88:91],a[80:83],a[160:163],v[88:91]
M v[88:91],a[84:87],a[164:167],v[88:91]
s_waitcnt lgkmcnt(2)
M v[92:95],a[92:95],a[164:167],v[92:95]
s_waitcnt vmcnt(18) lgkmcnt(0)
M v[92:95],a[88:91],a[160:163],v[92:95]
s_barrier
M v[96:99],a[32:35],a[168:171],v[96:99]
R a[160:163],v5,49152
R a[164:167],v6,49152
M v[96:99],a[36:39],a[172:175],v[96:99]
M v[100:103],a[44:47],a[172:175],v[100:103]
SA m0,s24,32768
T a[128:129],v1,16384
T a[130:131],v1,17408
M v[100:103],a[40:43],a[168:171],v[100:103]
buffer_load_dwordx4 v12, s[48:51], s22 offen offset:0   lds
M v[104:107],a[48:51],a[168:171],v[104:107]
M v[104:107],a[52:55],a[172:175],v[104:107]
M v[108:111],a[60:63],a[172:175],v[108:111]
M v[108:111],a[56:59],a[168:171],v[108:111]
M v[112:115],a[64:67],a[168:171],v[112:115]
buffer_load_dwordx4 v13, s[48:51], s22 offen offset:1024   lds
M v[112:115],a[68:71],a[172:175],v[112:115]
s_nop 0
T a[132:133],v1,24576
T a[134:135],v1,25600
M v[116:119],a[76:79],a[172:175],v[116:119]
M v[116:119],a[72:75],a[168:171],v[116:119]
M v[120:123],a[80:83],a[168:171],v[120:123]
M v[120:123],a[84:87],a[172:175],v[120:123]
s_waitcnt lgkmcnt(4)
M v[124:127],a[92:95],a[172:175],v[124:127]
buffer_load_dwordx4 v14, s[48:51], s22 offen offset:2048   lds
M v[124:127],a[88:91],a[168:171],v[124:127]
M v[128:131],a[32:35],a[160:163],v[128:131]
R a[168:171],v5,51200
R a[172:175],v6,51200
M v[128:131],a[36:39],a[164:167],v[128:131]
T a[136:137],v2,16384
T a[138:139],v2,17408
M v[132:135],a[44:47],a[164:167],v[132:135]
M v[132:135],a[40:43],a[160:163],v[132:135]
M v[136:139],a[48:51],a[160:163],v[136:139]
buffer_load_dwordx4 v15, s[48:51], s22 offen offset:3072   lds
M v[136:139],a[52:55],a[164:167],v[136:139]
SA s22,s22,1048576
M v[140:143],a[60:63],a[164:167],v[140:143]
M v[140:143],a[56:59],a[160:163],v[140:143]
s_nop 0
T a[140:141],v2,24576
T a[142:143],v2,25600
M v[144:147],a[64:67],a[160:163],v[144:147]
SA m0,s23,0
M v[144:147],a[68:71],a[164:167],v[144:147]
buffer_load_dwordx4 v8, s[16:19], s21 offen offset:0  nt lds
M v[148:151],a[76:79],a[164:167],v[148:151]
M v[148:151],a[72:75],a[160:163],v[148:151]
M v[152:155],a[80:83],a[160:163],v[152:155]
M v[152:155],a[84:87],a[164:167],v[152:155]
s_waitcnt lgkmcnt(4)
M v[156:159],a[92:95],a[164:167],v[156:159]
s_nop 0
T a[144:145],v3,16384
T a[146:147],v3,17408
M v[156:159],a[88:91],a[160:163],v[156:159]
buffer_load_dwordx4 v9, s[16:19], s21 offen offset:1024  nt lds
M v[160:163],a[32:35],a[168:171],v[160:163]
R a[160:163],v5,53248
R a[164:167],v6,53248
M v[160:163],a[36:39],a[172:175],v[160:163]
M v[164:167],a[44:47],a[172:175],v[164:167]
M v[164:167],a[40:43],a[168:171],v[164:167]
M v[168:171],a[48:51],a[168:171],v[168:171]
M v[168:171],a[52:55],a[172:175],v[168:171]
s_nop 0
T a[148:149],v3,24576
T a[150:151],v3,25600
M v[172:175],a[60:63],a[172:175],v[172:175]
buffer_load_dwordx4 v10, s[16:19], s21 offen offset:2048  nt lds
M v[172:175],a[56:59],a[168:171],v[172:175]
M v[176:179],a[64:67],a[168:171],v[176:179]
M v[176:179],a[68:71],a[172:175],v[176:179]
M v[180:183],a[76:79],a[172:175],v[180:183]
buffer_load_dwordx4 v11, s[16:19], s21 offen offset:3072  nt lds
M v[180:183],a[72:75],a[168:171],v[180:183]
SA s21,s21,128
M v[184:187],a[80:83],a[168:171],v[184:187]
s_nop 0
T a[152:153],v4,16384
T a[154:155],v4,17408
M v[184:187],a[84:87],a[172:175],v[184:187]
s_waitcnt lgkmcnt(4)
M v[188:191],a[92:95],a[172:175],v[188:191]
M v[188:191],a[88:91],a[168:171],v[188:191]
SA m0,s87,4096
M v[192:195],a[32:35],a[160:163],v[192:195]
R a[168:171],v5,55296
R a[172:175],v6,55296
M v[192:195],a[36:39],a[164:167],v[192:195]
buffer_load_dwordx4 v25, s[60:63], s89 offen offset:0 nt lds
M v[196:199],a[44:47],a[164:167],v[196:199]
SA s89,s89,114688
M v[196:199],a[40:43],a[160:163],v[196:199]
s_nop 0
T a[156:157],v4,24576
T a[158:159],v4,25600
M v[200:203],a[48:51],a[160:163],v[200:203]
M v[200:203],a[52:55],a[164:167],v[200:203]
SA m0,s87,5120
M v[204:207],a[60:63],a[164:167],v[204:207]
buffer_load_dwordx4 v25, s[60:63], s89 offen offset:0 nt lds
M v[204:207],a[56:59],a[160:163],v[204:207]
SA s89,s89,114688
M v[208:211],a[64:67],a[160:163],v[208:211]
M v[208:211],a[68:71],a[164:167],v[208:211]
M v[212:215],a[76:79],a[164:167],v[212:215]
M v[212:215],a[72:75],a[160:163],v[212:215]
M v[216:219],a[80:83],a[160:163],v[216:219]
M v[216:219],a[84:87],a[164:167],v[216:219]
s_waitcnt lgkmcnt(2)
M v[220:223],a[92:95],a[164:167],v[220:223]
s_waitcnt vmcnt(20) lgkmcnt(0)
M v[220:223],a[88:91],a[160:163],v[220:223]
s_barrier
M v[224:227],a[32:35],a[168:171],v[224:227]
R a[160:163],v5,0
R a[164:167],v6,0
M v[224:227],a[36:39],a[172:175],v[224:227]
M v[228:231],a[44:47],a[172:175],v[228:231]
M v[228:231],a[40:43],a[168:171],v[228:231]
M v[232:235],a[48:51],a[168:171],v[232:235]
M v[232:235],a[52:55],a[172:175],v[232:235]
M v[236:239],a[60:63],a[172:175],v[236:239]
M v[236:239],a[56:59],a[168:171],v[236:239]
M v[240:243],a[64:67],a[168:171],v[240:243]
M v[240:243],a[68:71],a[172:175],v[240:243]
M v[244:247],a[76:79],a[172:175],v[244:247]
M v[244:247],a[72:75],a[168:171],v[244:247]
M v[248:251],a[80:83],a[168:171],v[248:251]
M v[248:251],a[84:87],a[172:175],v[248:251]
s_waitcnt lgkmcnt(0)
M v[252:255],a[92:95],a[172:175],v[252:255]
M v[252:255],a[88:91],a[168:171],v[252:255]
M a[0:3],a[96:99],a[160:163],a[0:3]
R a[168:171],v5,2048
R a[172:175],v6,2048
M a[0:3],a[100:103],a[164:167],a[0:3]
T a[32:33],v1,32768
T a[34:35],v1,33792
M a[4:7],a[108:111],a[164:167],a[4:7]
SA m0,s24,49152
M a[4:7],a[104:107],a[160:163],a[4:7]
buffer_load_dwordx4 v12, s[48:51], s22 offen offset:0   lds
M a[8:11],a[112:115],a[160:163],a[8:11]
M a[8:11],a[116:119],a[164:167],a[8:11]
M a[12:15],a[124:127],a[164:167],a[12:15]
s_nop 0
T a[36:37],v1,40960
T a[38:39],v1,41984
M a[12:15],a[120:123],a[160:163],a[12:15]
M a[16:19],a[128:131],a[160:163],a[16:19]
buffer_load_dwordx4 v13, s[48:51], s22 offen offset:1024   lds
M a[16:19],a[132:135],a[164:167],a[16:19]
M a[20:23],a[140:143],a[164:167],a[20:23]
M a[20:23],a[136:139],a[160:163],a[20:23]
s_nop 0
T a[40:41],v2,32768
T a[42:43],v2,33792
M a[24:27],a[144:147],a[160:163],a[24:27]
M a[24:27],a[148:151],a[164:167],a[24:27]
s_waitcnt lgkmcnt(6)
buffer_load_dwordx4 v14, s[48:51], s22 offen offset:2048   lds
M a[28:31],a[156:159],a[164:167],a[28:31]
M a[28:31],a[152:155],a[160:163],a[28:31]
M v[32:35],a[96:99],a[168:171],v[32:35]
R a[160:163],v5,4096
R a[164:167],v6,4096
M v[32:35],a[100:103],a[172:175],v[32:35]
T a[44:45],v2,40960
T a[46:47],v2,41984
M v[36:39],a[108:111],a[172:175],v[36:39]
buffer_load_dwordx4 v15, s[48:51], s22 offen offset:3072   lds
M v[36:39],a[104:107],a[168:171],v[36:39]
s_sub_u32 s22, s22, 1048448
M v[40:43],a[112:115],a[168:171],v[40:43]
M v[40:43],a[116:119],a[172:175],v[40:43]
s_nop 0
T a[48:49],v3,32768
T a[50:51],v3,33792
M v[44:47],a[124:127],a[172:175],v[44:47]
SA m0,s23,16384
M v[44:47],a[120:123],a[168:171],v[44:47]
buffer_load_dwordx4 v8, s[16:19], s21 offen offset:0  nt lds
M v[48:51],a[128:131],a[168:171],v[48:51]
M v[48:51],a[132:135],a[172:175],v[48:51]
M v[52:55],a[140:143],a[172:175],v[52:55]
s_nop 0
T a[52:53],v3,40960
T a[54:55],v3,41984
M v[52:55],a[136:139],a[168:171],v[52:55]
M v[56:59],a[144:147],a[168:171],v[56:59]
buffer_load_dwordx4 v9, s[16:19], s21 offen offset:1024  nt lds
M v[56:59],a[148:151],a[172:175],v[56:59]
s_waitcnt lgkmcnt(6)
M v[60:63],a[156:159],a[172:175],v[60:63]
M v[60:63],a[152:155],a[168:171],v[60:63]
s_nop 0
T a[56:57],v4,32768
T a[58:59],v4,33792
M v[64:67],a[96:99],a[160:163],v[64:67]
R a[168:171],v5,6144
R a[172:175],v6,6144
M v[64:67],a[100:103],a[164:167],v[64:67]
buffer_load_dwordx4 v10, s[16:19], s21 offen offset:2048  nt lds
M v[68:71],a[108:111],a[164:167],v[68:71]
M v[68:71],a[104:107],a[160:163],v[68:71]
M v[72:75],a[112:115],a[160:163],v[72:75]
s_nop 0
T a[60:61],v4,40960
T a[62:63],v4,41984
M v[72:75],a[116:119],a[164:167],v[72:75]
M v[76:79],a[124:127],a[164:167],v[76:79]
buffer_load_dwordx4 v11, s[16:19], s21 offen offset:3072  nt lds
M v[76:79],a[120:123],a[160:163],v[76:79]
SA s21,s21,524160
M v[80:83],a[128:131],a[160:163],v[80:83]
M v[80:83],a[132:135],a[164:167],v[80:83]
M v[84:87],a[140:143],a[164:167],v[84:87]
M v[84:87],a[136:139],a[160:163],v[84:87]
M v[88:91],a[144:147],a[160:163],v[88:91]
M v[88:91],a[148:151],a[164:167],v[88:91]
s_waitcnt lgkmcnt(2)
M v[92:95],a[156:159],a[164:167],v[92:95]
s_waitcnt vmcnt(18) lgkmcnt(0)
M v[92:95],a[152:155],a[160:163],v[92:95]
s_barrier
M v[96:99],a[96:99],a[168:171],v[96:99]
R a[160:163],v5,16384
R a[164:167],v6,16384
M v[96:99],a[100:103],a[172:175],v[96:99]
M v[100:103],a[108:111],a[172:175],v[100:103]
SA m0,s24,0
T a[64:65],v1,49152
T a[66:67],v1,50176
M v[100:103],a[104:107],a[168:171],v[100:103]
buffer_load_dwordx4 v12, s[48:51], s22 offen offset:0   lds
M v[104:107],a[112:115],a[168:171],v[104:107]
M v[104:107],a[116:119],a[172:175],v[104:107]
M v[108:111],a[124:127],a[172:175],v[108:111]
M v[108:111],a[120:123],a[168:171],v[108:111]
M v[112:115],a[128:131],a[168:171],v[112:115]
M v[112:115],a[132:135],a[172:175],v[112:115]
s_nop 0
T a[68:69],v1,57344
T a[70:71],v1,58368
M v[116:119],a[140:143],a[172:175],v[116:119]
buffer_load_dwordx4 v13, s[48:51], s22 offen offset:1024   lds
M v[116:119],a[136:139],a[168:171],v[116:119]
M v[120:123],a[144:147],a[168:171],v[120:123]
M v[120:123],a[148:151],a[172:175],v[120:123]
s_waitcnt lgkmcnt(4)
M v[124:127],a[156:159],a[172:175],v[124:127]
M v[124:127],a[152:155],a[168:171],v[124:127]
buffer_load_dwordx4 v14, s[48:51], s22 offen offset:2048   lds
M v[128:131],a[96:99],a[160:163],v[128:131]
R a[168:171],v5,18432
R a[172:175],v6,18432
M v[128:131],a[100:103],a[164:167],v[128:131]
s_lshl_b32 s67, s20, 11
T a[72:73],v2,49152
T a[74:75],v2,50176
M v[132:135],a[108:111],a[164:167],v[132:135]
SA s67,s67,104914944
buffer_load_dwordx4 v[16:19], v7, s[8:11], s67 offen offset:0 sc1
M v[132:135],a[104:107],a[160:163],v[132:135]
M v[136:139],a[112:115],a[160:163],v[136:139]
buffer_load_dwordx4 v[20:23], v7, s[8:11], s67 offen offset:1024 sc1
M v[136:139],a[116:119],a[164:167],v[136:139]
M v[140:143],a[124:127],a[164:167],v[140:143]
buffer_load_dwordx4 v15, s[48:51], s22 offen offset:3072   lds
M v[140:143],a[120:123],a[160:163],v[140:143]
SA s22,s22,1048576
L_w_kv03:
s_cbranch_execz L_w_kv07
T a[76:77],v2,57344
T a[78:79],v2,58368
M v[144:147],a[128:131],a[160:163],v[144:147]
M v[144:147],a[132:135],a[164:167],v[144:147]
M v[148:151],a[140:143],a[164:167],v[148:151]
M v[148:151],a[136:139],a[160:163],v[148:151]
SA m0,s23,32768
M v[152:155],a[144:147],a[160:163],v[152:155]
buffer_load_dwordx4 v8, s[16:19], s21 offen offset:0  nt lds
M v[152:155],a[148:151],a[164:167],v[152:155]
s_waitcnt lgkmcnt(4)
M v[156:159],a[156:159],a[164:167],v[156:159]
s_nop 0
T a[80:81],v3,49152
T a[82:83],v3,50176
M v[156:159],a[152:155],a[160:163],v[156:159]
M v[160:163],a[96:99],a[168:171],v[160:163]
R a[160:163],v5,20480
R a[164:167],v6,20480
M v[160:163],a[100:103],a[172:175],v[160:163]
M v[164:167],a[108:111],a[172:175],v[164:167]
buffer_load_dwordx4 v9, s[16:19], s21 offen offset:1024  nt lds
M v[164:167],a[104:107],a[168:171],v[164:167]
M v[168:171],a[112:115],a[168:171],v[168:171]
M v[168:171],a[116:119],a[172:175],v[168:171]
s_nop 0
T a[84:85],v3,57344
T a[86:87],v3,58368
M v[172:175],a[124:127],a[172:175],v[172:175]
M v[172:175],a[120:123],a[168:171],v[172:175]
M v[176:179],a[128:131],a[168:171],v[176:179]
M v[176:179],a[132:135],a[172:175],v[176:179]
buffer_load_dwordx4 v10, s[16:19], s21 offen offset:2048  nt lds
M v[180:183],a[140:143],a[172:175],v[180:183]
M v[180:183],a[136:139],a[168:171],v[180:183]
M v[184:187],a[144:147],a[168:171],v[184:187]
s_nop 0
T a[88:89],v4,49152
T a[90:91],v4,50176
M v[184:187],a[148:151],a[172:175],v[184:187]
s_waitcnt lgkmcnt(4)
M v[188:191],a[156:159],a[172:175],v[188:191]
M v[188:191],a[152:155],a[168:171],v[188:191]
buffer_load_dwordx4 v11, s[16:19], s21 offen offset:3072  nt lds
M v[192:195],a[96:99],a[160:163],v[192:195]
SA s21,s21,128
R a[168:171],v5,22528
R a[172:175],v6,22528
M v[192:195],a[100:103],a[164:167],v[192:195]
M v[196:199],a[108:111],a[164:167],v[196:199]
M v[196:199],a[104:107],a[160:163],v[196:199]
s_nop 0
T a[92:93],v4,57344
T a[94:95],v4,58368
M v[200:203],a[112:115],a[160:163],v[200:203]
SA m0,s87,6144
M v[200:203],a[116:119],a[164:167],v[200:203]
buffer_load_dwordx4 v25, s[60:63], s89 offen offset:0 nt lds
M v[204:207],a[124:127],a[164:167],v[204:207]
SA s89,s89,114688
M v[204:207],a[120:123],a[160:163],v[204:207]
M v[208:211],a[128:131],a[160:163],v[208:211]
M v[208:211],a[132:135],a[164:167],v[208:211]
M v[212:215],a[140:143],a[164:167],v[212:215]
M v[212:215],a[136:139],a[160:163],v[212:215]
M v[216:219],a[144:147],a[160:163],v[216:219]
M v[216:219],a[148:151],a[164:167],v[216:219]
s_waitcnt lgkmcnt(2)
M v[220:223],a[156:159],a[164:167],v[220:223]
s_waitcnt vmcnt(21) lgkmcnt(0)
M v[220:223],a[152:155],a[160:163],v[220:223]
s_barrier
M v[224:227],a[96:99],a[168:171],v[224:227]
R a[160:163],v5,32768
R a[164:167],v6,32768
M v[224:227],a[100:103],a[172:175],v[224:227]
M v[228:231],a[108:111],a[172:175],v[228:231]
M v[228:231],a[104:107],a[168:171],v[228:231]
M v[232:235],a[112:115],a[168:171],v[232:235]
M v[232:235],a[116:119],a[172:175],v[232:235]
M v[236:239],a[124:127],a[172:175],v[236:239]
M v[236:239],a[120:123],a[168:171],v[236:239]
M v[240:243],a[128:131],a[168:171],v[240:243]
M v[240:243],a[132:135],a[172:175],v[240:243]
M v[244:247],a[140:143],a[172:175],v[244:247]
M v[244:247],a[136:139],a[168:171],v[244:247]
M v[248:251],a[144:147],a[168:171],v[248:251]
M v[248:251],a[148:151],a[172:175],v[248:251]
s_waitcnt lgkmcnt(0)
M v[252:255],a[156:159],a[172:175],v[252:255]
M v[252:255],a[152:155],a[168:171],v[252:255]
M a[0:3],a[32:35],a[160:163],a[0:3]
R a[168:171],v5,34816
R a[172:175],v6,34816
M a[0:3],a[36:39],a[164:167],a[0:3]
T a[96:97],v1,0
T a[98:99],v1,1024
M a[4:7],a[44:47],a[164:167],a[4:7]
SA m0,s24,16384
M a[4:7],a[40:43],a[160:163],a[4:7]
buffer_load_dwordx4 v12, s[48:51], s22 offen offset:0   lds
M a[8:11],a[48:51],a[160:163],a[8:11]
M a[8:11],a[52:55],a[164:167],a[8:11]
M a[12:15],a[60:63],a[164:167],a[12:15]
s_nop 0
T a[100:101],v1,8192
T a[102:103],v1,9216
M a[12:15],a[56:59],a[160:163],a[12:15]
M a[16:19],a[64:67],a[160:163],a[16:19]
buffer_load_dwordx4 v13, s[48:51], s22 offen offset:1024   lds
M a[16:19],a[68:71],a[164:167],a[16:19]
M a[20:23],a[76:79],a[164:167],a[20:23]
s_waitcnt vmcnt(9)
v_min3_u32 v28, v16, v17, v18
M a[20:23],a[72:75],a[160:163],a[20:23]
s_nop 0
T a[104:105],v2,0
T a[106:107],v2,1024
M a[24:27],a[80:83],a[160:163],a[24:27]
s_waitcnt vmcnt(8)
v_min3_u32 v28, v28, v19, v20
M a[24:27],a[84:87],a[164:167],a[24:27]
s_waitcnt lgkmcnt(6)
buffer_load_dwordx4 v14, s[48:51], s22 offen offset:2048   lds
M a[28:31],a[92:95],a[164:167],a[28:31]
v_min3_u32 v28, v28, v21, v22
M a[28:31],a[88:91],a[160:163],a[28:31]
v_min_u32 v28, v28, v23
M v[32:35],a[32:35],a[168:171],v[32:35]
R a[160:163],v5,36864
R a[164:167],v6,36864
M v[32:35],a[36:39],a[172:175],v[32:35]
T a[108:109],v2,8192
T a[110:111],v2,9216
M v[36:39],a[44:47],a[172:175],v[36:39]
buffer_load_dwordx4 v15, s[48:51], s22 offen offset:3072   lds
M v[36:39],a[40:43],a[168:171],v[36:39]
s_sub_u32 s22, s22, 1048448
v_cmp_eq_u32 vcc, 0, v28
M v[40:43],a[48:51],a[168:171],v[40:43]
s_nop 0
M v[40:43],a[52:55],a[172:175],v[40:43]
s_cbranch_vccnz L_hs
L_hr:
T a[112:113],v3,0
T a[114:115],v3,1024
M v[44:47],a[60:63],a[172:175],v[44:47]
SA m0,s23,49152
v_max_u32 v28, v16, v17
M v[44:47],a[56:59],a[168:171],v[44:47]
buffer_load_dwordx4 v8, s[16:19], s21 offen offset:0  nt lds
M v[48:51],a[64:67],a[168:171],v[48:51]
v_min_u32 v29, v16, v17
M v[48:51],a[68:71],a[172:175],v[48:51]
v_med3_u32 v29, v28, v29, v18
M v[52:55],a[76:79],a[172:175],v[52:55]
s_nop 0
T a[116:117],v3,8192
T a[118:119],v3,9216
M v[52:55],a[72:75],a[168:171],v[52:55]
v_max_u32 v28, v28, v18
M v[56:59],a[80:83],a[168:171],v[56:59]
buffer_load_dwordx4 v9, s[16:19], s21 offen offset:1024  nt lds
M v[56:59],a[84:87],a[172:175],v[56:59]
s_waitcnt lgkmcnt(6)
v_med3_u32 v29, v28, v29, v19
M v[60:63],a[92:95],a[172:175],v[60:63]
v_max_u32 v28, v28, v19
M v[60:63],a[88:91],a[168:171],v[60:63]
s_nop 0
T a[120:121],v4,0
T a[122:123],v4,1024
M v[64:67],a[32:35],a[160:163],v[64:67]
R a[168:171],v5,38912
R a[172:175],v6,38912
M v[64:67],a[36:39],a[164:167],v[64:67]
buffer_load_dwordx4 v10, s[16:19], s21 offen offset:2048  nt lds
M v[68:71],a[44:47],a[164:167],v[68:71]
v_med3_u32 v29, v28, v29, v20
M v[68:71],a[40:43],a[160:163],v[68:71]
v_max_u32 v28, v28, v20
M v[72:75],a[48:51],a[160:163],v[72:75]
s_nop 0
T a[124:125],v4,8192
T a[126:127],v4,9216
M v[72:75],a[52:55],a[164:167],v[72:75]
v_med3_u32 v29, v28, v29, v21
M v[76:79],a[60:63],a[164:167],v[76:79]
buffer_load_dwordx4 v11, s[16:19], s21 offen offset:3072  nt lds
M v[76:79],a[56:59],a[160:163],v[76:79]
SA s21,s21,524160
v_max_u32 v28, v28, v21
M v[80:83],a[64:67],a[160:163],v[80:83]
v_med3_u32 v29, v28, v29, v22
M v[80:83],a[68:71],a[164:167],v[80:83]
v_max_u32 v28, v28, v22
M v[84:87],a[76:79],a[164:167],v[84:87]
v_med3_u32 v29, v28, v29, v23
M v[84:87],a[72:75],a[160:163],v[84:87]
v_max_u32 v28, v28, v23
M v[88:91],a[80:83],a[160:163],v[88:91]
s_nop 0
v_mov_b32 v30, v28 row_ror:8 row_mask:0xf bank_mask:0xf
M v[88:91],a[84:87],a[164:167],v[88:91]
s_waitcnt lgkmcnt(2)
v_mov_b32 v31, v29 row_ror:8 row_mask:0xf bank_mask:0xf
M v[92:95],a[92:95],a[164:167],v[92:95]
s_waitcnt lgkmcnt(0)
v_min_u32 v16, v28, v30
M v[92:95],a[88:91],a[160:163],v[92:95]
s_barrier
M v[96:99],a[32:35],a[168:171],v[96:99]
R a[160:163],v5,49152
R a[164:167],v6,49152
M v[96:99],a[36:39],a[172:175],v[96:99]
v_max_u32 v28, v28, v30
M v[100:103],a[44:47],a[172:175],v[100:103]
SA m0,s24,32768
T a[128:129],v1,16384
T a[130:131],v1,17408
M v[100:103],a[40:43],a[168:171],v[100:103]
buffer_load_dwordx4 v12, s[48:51], s22 offen offset:0   lds
M v[104:107],a[48:51],a[168:171],v[104:107]
v_max3_u32 v29, v29, v31, v16
M v[104:107],a[52:55],a[172:175],v[104:107]
v_mov_b32 v30, v28 row_ror:4 row_mask:0xf bank_mask:0xf
M v[108:111],a[60:63],a[172:175],v[108:111]
v_mov_b32 v31, v29 row_ror:4 row_mask:0xf bank_mask:0xf
M v[108:111],a[56:59],a[168:171],v[108:111]
v_min_u32 v16, v28, v30
M v[112:115],a[64:67],a[168:171],v[112:115]
v_max_u32 v28, v28, v30
M v[112:115],a[68:71],a[172:175],v[112:115]
s_nop 0
T a[132:133],v1,24576
T a[134:135],v1,25600
M v[116:119],a[76:79],a[172:175],v[116:119]
buffer_load_dwordx4 v13, s[48:51], s22 offen offset:1024   lds
M v[116:119],a[72:75],a[168:171],v[116:119]
v_max3_u32 v29, v29, v31, v16
M v[120:123],a[80:83],a[168:171],v[120:123]
v_mov_b32 v30, v28 row_ror:2 row_mask:0xf bank_mask:0xf
M v[120:123],a[84:87],a[172:175],v[120:123]
s_waitcnt lgkmcnt(4)
v_mov_b32 v31, v29 row_ror:2 row_mask:0xf bank_mask:0xf
M v[124:127],a[92:95],a[172:175],v[124:127]
v_min_u32 v16, v28, v30
M v[124:127],a[88:91],a[168:171],v[124:127]
v_max_u32 v28, v28, v30
M v[128:131],a[32:35],a[160:163],v[128:131]
R a[168:171],v5,51200
R a[172:175],v6,51200
M v[128:131],a[36:39],a[164:167],v[128:131]
T a[136:137],v2,16384
T a[138:139],v2,17408
M v[132:135],a[44:47],a[164:167],v[132:135]
buffer_load_dwordx4 v14, s[48:51], s22 offen offset:2048   lds
M v[132:135],a[40:43],a[160:163],v[132:135]
v_max3_u32 v29, v29, v31, v16
M v[136:139],a[48:51],a[160:163],v[136:139]
v_mov_b32 v30, v28 row_ror:1 row_mask:0xf bank_mask:0xf
M v[136:139],a[52:55],a[164:167],v[136:139]
v_mov_b32 v31, v29 row_ror:1 row_mask:0xf bank_mask:0xf
M v[140:143],a[60:63],a[164:167],v[140:143]
v_min_u32 v16, v28, v30
M v[140:143],a[56:59],a[160:163],v[140:143]
s_nop 0
T a[140:141],v2,24576
T a[142:143],v2,25600
M v[144:147],a[64:67],a[160:163],v[144:147]
buffer_load_dwordx4 v15, s[48:51], s22 offen offset:3072   lds
M v[144:147],a[68:71],a[164:167],v[144:147]
SA s22,s22,1048576
v_max_u32 v28, v28, v30
M v[148:151],a[76:79],a[164:167],v[148:151]
v_max3_u32 v29, v29, v31, v16
M v[148:151],a[72:75],a[160:163],v[148:151]
v_mov_b32 v30, v28
M v[152:155],a[80:83],a[160:163],v[152:155]
v_mov_b32 v31, v29
M v[152:155],a[84:87],a[164:167],v[152:155]
s_waitcnt lgkmcnt(4)
v_permlane16_swap_b32 v30, v28
M v[156:159],a[92:95],a[164:167],v[156:159]
SA m0,s23,0
T a[144:145],v3,16384
T a[146:147],v3,17408
M v[156:159],a[88:91],a[160:163],v[156:159]
buffer_load_dwordx4 v8, s[16:19], s21 offen offset:0  nt lds
M v[160:163],a[32:35],a[168:171],v[160:163]
R a[160:163],v5,53248
R a[164:167],v6,53248
M v[160:163],a[36:39],a[172:175],v[160:163]
v_permlane16_swap_b32 v31, v29
M v[164:167],a[44:47],a[172:175],v[164:167]
v_min_u32 v16, v28, v30
M v[164:167],a[40:43],a[168:171],v[164:167]
v_max_u32 v28, v28, v30
M v[168:171],a[48:51],a[168:171],v[168:171]
v_max3_u32 v29, v29, v31, v16
M v[168:171],a[52:55],a[172:175],v[168:171]
s_nop 0
T a[148:149],v3,24576
T a[150:151],v3,25600
M v[172:175],a[60:63],a[172:175],v[172:175]
buffer_load_dwordx4 v9, s[16:19], s21 offen offset:1024  nt lds
M v[172:175],a[56:59],a[168:171],v[172:175]
v_mov_b32 v30, v28
M v[176:179],a[64:67],a[168:171],v[176:179]
v_mov_b32 v31, v29
M v[176:179],a[68:71],a[172:175],v[176:179]
v_permlane32_swap_b32 v30, v28
M v[180:183],a[76:79],a[172:175],v[180:183]
v_permlane32_swap_b32 v31, v29
M v[180:183],a[72:75],a[168:171],v[180:183]
v_min_u32 v16, v28, v30
M v[184:187],a[80:83],a[168:171],v[184:187]
s_nop 0
T a[152:153],v4,16384
T a[154:155],v4,17408
M v[184:187],a[84:87],a[172:175],v[184:187]
s_waitcnt lgkmcnt(4)
buffer_load_dwordx4 v10, s[16:19], s21 offen offset:2048  nt lds
M v[188:191],a[92:95],a[172:175],v[188:191]
v_max_u32 v28, v28, v30
M v[188:191],a[88:91],a[168:171],v[188:191]
v_max3_u32 v29, v29, v31, v16
M v[192:195],a[32:35],a[160:163],v[192:195]
s_lshl_b32 s64, s20, 3
R a[168:171],v5,55296
R a[172:175],v6,55296
M v[192:195],a[36:39],a[164:167],v[192:195]
SA s64,s64,159744
v_mov_b32 v16, s64
M v[196:199],a[44:47],a[164:167],v[196:199]
ds_write_b64 v16, v[28:29]
M v[196:199],a[40:43],a[160:163],v[196:199]
s_nop 0
T a[156:157],v4,24576
T a[158:159],v4,25600
M v[200:203],a[48:51],a[160:163],v[200:203]
buffer_load_dwordx4 v11, s[16:19], s21 offen offset:3072  nt lds
M v[200:203],a[52:55],a[164:167],v[200:203]
SA s21,s21,128
M v[204:207],a[60:63],a[164:167],v[204:207]
M v[204:207],a[56:59],a[160:163],v[204:207]
M v[208:211],a[64:67],a[160:163],v[208:211]
M v[208:211],a[68:71],a[164:167],v[208:211]
M v[212:215],a[76:79],a[164:167],v[212:215]
M v[212:215],a[72:75],a[160:163],v[212:215]
M v[216:219],a[80:83],a[160:163],v[216:219]
M v[216:219],a[84:87],a[164:167],v[216:219]
s_waitcnt lgkmcnt(3)
M v[220:223],a[92:95],a[164:167],v[220:223]
s_waitcnt vmcnt(17) lgkmcnt(0)
M v[220:223],a[88:91],a[160:163],v[220:223]
s_barrier
M v[224:227],a[32:35],a[168:171],v[224:227]
R a[160:163],v5,0
R a[164:167],v6,0
M v[224:227],a[36:39],a[172:175],v[224:227]
M v[228:231],a[44:47],a[172:175],v[228:231]
M v[228:231],a[40:43],a[168:171],v[228:231]
M v[232:235],a[48:51],a[168:171],v[232:235]
M v[232:235],a[52:55],a[172:175],v[232:235]
M v[236:239],a[60:63],a[172:175],v[236:239]
M v[236:239],a[56:59],a[168:171],v[236:239]
M v[240:243],a[64:67],a[168:171],v[240:243]
M v[240:243],a[68:71],a[172:175],v[240:243]
M v[244:247],a[76:79],a[172:175],v[244:247]
M v[244:247],a[72:75],a[168:171],v[244:247]
M v[248:251],a[80:83],a[168:171],v[248:251]
M v[248:251],a[84:87],a[172:175],v[248:251]
s_waitcnt lgkmcnt(0)
M v[252:255],a[92:95],a[172:175],v[252:255]
M v[252:255],a[88:91],a[168:171],v[252:255]
M a[0:3],a[96:99],a[160:163],a[0:3]
R a[168:171],v5,2048
R a[172:175],v6,2048
M a[0:3],a[100:103],a[164:167],a[0:3]
T a[32:33],v1,32768
T a[34:35],v1,33792
M a[4:7],a[108:111],a[164:167],a[4:7]
SA m0,s24,49152
M a[4:7],a[104:107],a[160:163],a[4:7]
buffer_load_dwordx4 v12, s[48:51], s22 offen offset:0   lds
M a[8:11],a[112:115],a[160:163],a[8:11]
v_mov_b32 v28, 159744
M a[8:11],a[116:119],a[164:167],a[8:11]
ds_read_b128 v[16:19], v28
M a[12:15],a[124:127],a[164:167],a[12:15]
s_nop 0
T a[36:37],v1,40960
T a[38:39],v1,41984
M a[12:15],a[120:123],a[160:163],a[12:15]
R v[20:23],v28,16
M a[16:19],a[128:131],a[160:163],a[16:19]
buffer_load_dwordx4 v13, s[48:51], s22 offen offset:1024   lds
M a[16:19],a[132:135],a[164:167],a[16:19]
M a[20:23],a[140:143],a[164:167],a[20:23]
M a[20:23],a[136:139],a[160:163],a[20:23]
s_nop 0
T a[40:41],v2,32768
T a[42:43],v2,33792
M a[24:27],a[144:147],a[160:163],a[24:27]
M a[24:27],a[148:151],a[164:167],a[24:27]
s_waitcnt lgkmcnt(8)
buffer_load_dwordx4 v14, s[48:51], s22 offen offset:2048   lds
M a[28:31],a[156:159],a[164:167],a[28:31]
M a[28:31],a[152:155],a[160:163],a[28:31]
M v[32:35],a[96:99],a[168:171],v[32:35]
R a[160:163],v5,4096
R a[164:167],v6,4096
M v[32:35],a[100:103],a[172:175],v[32:35]
T a[44:45],v2,40960
T a[46:47],v2,41984
M v[36:39],a[108:111],a[172:175],v[36:39]
buffer_load_dwordx4 v15, s[48:51], s22 offen offset:3072   lds
M v[36:39],a[104:107],a[168:171],v[36:39]
s_sub_u32 s22, s22, 1048448
s_waitcnt lgkmcnt(9)
v_min_u32 v28, v16, v18
M v[40:43],a[112:115],a[168:171],v[40:43]
v_max_u32 v16, v16, v18
M v[40:43],a[116:119],a[172:175],v[40:43]
s_nop 0
T a[48:49],v3,32768
T a[50:51],v3,33792
M v[44:47],a[124:127],a[172:175],v[44:47]
SA m0,s23,16384
v_max3_u32 v17, v17, v19, v28
M v[44:47],a[120:123],a[168:171],v[44:47]
buffer_load_dwordx4 v8, s[16:19], s21 offen offset:0  nt lds
M v[48:51],a[128:131],a[168:171],v[48:51]
s_waitcnt lgkmcnt(8)
v_min_u32 v29, v20, v22
M v[48:51],a[132:135],a[172:175],v[48:51]
v_max_u32 v20, v20, v22
M v[52:55],a[140:143],a[172:175],v[52:55]
s_nop 0
T a[52:53],v3,40960
T a[54:55],v3,41984
M v[52:55],a[136:139],a[168:171],v[52:55]
v_max3_u32 v21, v21, v23, v29
M v[56:59],a[144:147],a[168:171],v[56:59]
buffer_load_dwordx4 v9, s[16:19], s21 offen offset:1024  nt lds
M v[56:59],a[148:151],a[172:175],v[56:59]
s_waitcnt lgkmcnt(6)
v_min_u32 v28, v16, v20
M v[60:63],a[156:159],a[172:175],v[60:63]
v_max_u32 v16, v16, v20
M v[60:63],a[152:155],a[168:171],v[60:63]
s_nop 0
T a[56:57],v4,32768
T a[58:59],v4,33792
M v[64:67],a[96:99],a[160:163],v[64:67]
R a[168:171],v5,6144
R a[172:175],v6,6144
M v[64:67],a[100:103],a[164:167],v[64:67]
buffer_load_dwordx4 v10, s[16:19], s21 offen offset:2048  nt lds
M v[68:71],a[108:111],a[164:167],v[68:71]
v_max3_u32 v17, v17, v21, v28
M v[68:71],a[104:107],a[160:163],v[68:71]
v_and_b32 v28, 1, v0
M v[72:75],a[112:115],a[160:163],v[72:75]
s_nop 0
T a[60:61],v4,40960
T a[62:63],v4,41984
M v[72:75],a[116:119],a[164:167],v[72:75]
v_cmp_eq_u32 vcc, 0, v28
M v[76:79],a[124:127],a[164:167],v[76:79]
s_and_b32 s64, s20, 1
buffer_load_dwordx4 v11, s[16:19], s21 offen offset:3072  nt lds
M v[76:79],a[120:123],a[160:163],v[76:79]
SA s21,s21,524160
s_mul_i32 s64, s64, 448
v_cndmask_b32 v24, v17, v16, vcc
M v[80:83],a[128:131],a[160:163],v[80:83]
v_and_b32 v24, 0x7ff, v24
M v[80:83],a[132:135],a[164:167],v[80:83]
v_sub_u32 v24, 2047, v24
M v[84:87],a[140:143],a[164:167],v[84:87]
v_mul_u32_u24 v28, 896, v24
M v[84:87],a[136:139],a[160:163],v[84:87]
v_lshrrev_b32 v29, 4, v0
M v[88:91],a[144:147],a[160:163],v[88:91]
v_lshl_add_u32 v28, v29, 4, v28
M v[88:91],a[148:151],a[164:167],v[88:91]
s_waitcnt lgkmcnt(2)
v_bfe_u32 v30, v0, 1, 3
M v[92:95],a[156:159],a[164:167],v[92:95]
s_waitcnt vmcnt(16) lgkmcnt(0)
v_lshl_or_b32 v28, v30, 26, v28
M v[92:95],a[152:155],a[160:163],v[92:95]
s_barrier
M v[96:99],a[96:99],a[168:171],v[96:99]
R a[160:163],v5,16384
R a[164:167],v6,16384
M v[96:99],a[100:103],a[172:175],v[96:99]
buffer_load_dwordx4 a[208:211], v28, s[56:59], s64 offen offset:0
M v[100:103],a[108:111],a[172:175],v[100:103]
SA m0,s24,0
T a[64:65],v1,49152
T a[66:67],v1,50176
M v[100:103],a[104:107],a[168:171],v[100:103]
buffer_load_dwordx4 v12, s[48:51], s22 offen offset:0   lds
M v[104:107],a[112:115],a[168:171],v[104:107]
M v[104:107],a[116:119],a[172:175],v[104:107]
M v[108:111],a[124:127],a[172:175],v[108:111]
buffer_load_dwordx4 a[212:215], v28, s[56:59], s64 offen offset:64
M v[108:111],a[120:123],a[168:171],v[108:111]
M v[112:115],a[128:131],a[168:171],v[112:115]
buffer_load_dwordx4 a[216:219], v28, s[56:59], s64 offen offset:128
M v[112:115],a[132:135],a[172:175],v[112:115]
s_nop 0
T a[68:69],v1,57344
T a[70:71],v1,58368
M v[116:119],a[140:143],a[172:175],v[116:119]
buffer_load_dwordx4 v13, s[48:51], s22 offen offset:1024   lds
M v[116:119],a[136:139],a[168:171],v[116:119]
M v[120:123],a[144:147],a[168:171],v[120:123]
M v[120:123],a[148:151],a[172:175],v[120:123]
s_waitcnt lgkmcnt(4)
M v[124:127],a[156:159],a[172:175],v[124:127]
buffer_load_dwordx4 a[220:223], v28, s[56:59], s64 offen offset:192
M v[124:127],a[152:155],a[168:171],v[124:127]
M v[128:131],a[96:99],a[160:163],v[128:131]
R a[168:171],v5,18432
R a[172:175],v6,18432
M v[128:131],a[100:103],a[164:167],v[128:131]
T a[72:73],v2,49152
T a[74:75],v2,50176
M v[132:135],a[108:111],a[164:167],v[132:135]
buffer_load_dwordx4 v14, s[48:51], s22 offen offset:2048   lds
M v[132:135],a[104:107],a[160:163],v[132:135]
M v[136:139],a[112:115],a[160:163],v[136:139]
buffer_load_dwordx4 a[224:227], v28, s[56:59], s64 offen offset:256
M v[136:139],a[116:119],a[164:167],v[136:139]
M v[140:143],a[124:127],a[164:167],v[140:143]
buffer_load_dwordx4 a[228:231], v28, s[56:59], s64 offen offset:320
M v[140:143],a[120:123],a[160:163],v[140:143]
s_nop 0
T a[76:77],v2,57344
T a[78:79],v2,58368
M v[144:147],a[128:131],a[160:163],v[144:147]
buffer_load_dwordx4 v15, s[48:51], s22 offen offset:3072   lds
M v[144:147],a[132:135],a[164:167],v[144:147]
SA s22,s22,1048576
M v[148:151],a[140:143],a[164:167],v[148:151]
M v[148:151],a[136:139],a[160:163],v[148:151]
buffer_load_dwordx4 a[232:235], v28, s[56:59], s64 offen offset:384
M v[152:155],a[144:147],a[160:163],v[152:155]
v_lshrrev_b32 v28, 4, v24
M v[152:155],a[148:151],a[164:167],v[152:155]
s_waitcnt lgkmcnt(4)
v_lshlrev_b32 v28, 5, v28
M v[156:159],a[156:159],a[164:167],v[156:159]
SA m0,s23,32768
T a[80:81],v3,49152
T a[82:83],v3,50176
M v[156:159],a[152:155],a[160:163],v[156:159]
buffer_load_dwordx4 v8, s[16:19], s21 offen offset:0  nt lds
M v[160:163],a[96:99],a[168:171],v[160:163]
L_w_kv04:
s_cbranch_execz L_w_kv08
R a[160:163],v5,20480
R a[164:167],v6,20480
M v[160:163],a[100:103],a[172:175],v[160:163]
v_and_b32 v30, 15, v24
M v[164:167],a[108:111],a[172:175],v[164:167]
v_add_lshl_u32 v28, v28, v30, 2
M v[164:167],a[104:107],a[168:171],v[164:167]
v_lshrrev_b32 v30, 1, v0
M v[168:171],a[112:115],a[168:171],v[168:171]
v_min_u32 v30, 1, v30
M v[168:171],a[116:119],a[172:175],v[168:171]
s_nop 0
T a[84:85],v3,57344
T a[86:87],v3,58368
M v[172:175],a[124:127],a[172:175],v[172:175]
buffer_load_dwordx4 v9, s[16:19], s21 offen offset:1024  nt lds
M v[172:175],a[120:123],a[168:171],v[172:175]
v_lshl_or_b32 v28, v30, 29, v28
M v[176:179],a[128:131],a[168:171],v[176:179]
s_or_b32 s64, s31, s20
M v[176:179],a[132:135],a[172:175],v[176:179]
s_min_u32 s64, s64, 1
M v[180:183],a[140:143],a[172:175],v[180:183]
s_lshl_b32 s64, s64, 29
M v[180:183],a[136:139],a[168:171],v[180:183]
SA s64,s64,104857600
buffer_load_dword v23, v28, s[8:11], s64 offen sc1
M v[184:187],a[144:147],a[168:171],v[184:187]
s_nop 0
T a[88:89],v4,49152
T a[90:91],v4,50176
M v[184:187],a[148:151],a[172:175],v[184:187]
s_waitcnt lgkmcnt(4)
buffer_load_dwordx4 v10, s[16:19], s21 offen offset:2048  nt lds
M v[188:191],a[156:159],a[172:175],v[188:191]
v_bfe_u32 v28, v0, 2, 2
M v[188:191],a[152:155],a[168:171],v[188:191]
v_lshl_add_u32 v28, v29, 3, v28
M v[192:195],a[96:99],a[160:163],v[192:195]
R a[168:171],v5,22528
R a[172:175],v6,22528
M v[192:195],a[100:103],a[164:167],v[192:195]
v_lshlrev_b32 v28, 5, v28
M v[196:199],a[108:111],a[164:167],v[196:199]
v_and_b32 v30, 3, v0
M v[196:199],a[104:107],a[160:163],v[196:199]
s_nop 0
T a[92:93],v4,57344
T a[94:95],v4,58368
M v[200:203],a[112:115],a[160:163],v[200:203]
buffer_load_dwordx4 v11, s[16:19], s21 offen offset:3072  nt lds
M v[200:203],a[116:119],a[164:167],v[200:203]
SA s21,s21,128
v_lshl_add_u32 v28, v30, 3, v28
M v[204:207],a[124:127],a[164:167],v[204:207]
v_add_u32 v22, s87, v28
M v[204:207],a[120:123],a[160:163],v[204:207]
M v[208:211],a[128:131],a[160:163],v[208:211]
M v[208:211],a[132:135],a[164:167],v[208:211]
M v[212:215],a[140:143],a[164:167],v[212:215]
M v[212:215],a[136:139],a[160:163],v[212:215]
M v[216:219],a[144:147],a[160:163],v[216:219]
M v[216:219],a[148:151],a[164:167],v[216:219]
s_waitcnt lgkmcnt(2)
M v[220:223],a[156:159],a[164:167],v[220:223]
s_waitcnt vmcnt(24) lgkmcnt(0)
M v[220:223],a[152:155],a[160:163],v[220:223]
s_barrier
M v[224:227],a[96:99],a[168:171],v[224:227]
R a[160:163],v5,32768
R a[164:167],v6,32768
M v[224:227],a[100:103],a[172:175],v[224:227]
M v[228:231],a[108:111],a[172:175],v[228:231]
M v[228:231],a[104:107],a[168:171],v[228:231]
M v[232:235],a[112:115],a[168:171],v[232:235]
M v[232:235],a[116:119],a[172:175],v[232:235]
M v[236:239],a[124:127],a[172:175],v[236:239]
M v[236:239],a[120:123],a[168:171],v[236:239]
M v[240:243],a[128:131],a[168:171],v[240:243]
M v[240:243],a[132:135],a[172:175],v[240:243]
M v[244:247],a[140:143],a[172:175],v[244:247]
M v[244:247],a[136:139],a[168:171],v[244:247]
M v[248:251],a[144:147],a[168:171],v[248:251]
M v[248:251],a[148:151],a[172:175],v[248:251]
s_waitcnt lgkmcnt(0)
M v[252:255],a[156:159],a[172:175],v[252:255]
M v[252:255],a[152:155],a[168:171],v[252:255]
M a[0:3],a[32:35],a[160:163],a[0:3]
R a[168:171],v5,34816
R a[172:175],v6,34816
M a[0:3],a[36:39],a[164:167],a[0:3]
T a[96:97],v1,0
T a[98:99],v1,1024
M a[4:7],a[44:47],a[164:167],a[4:7]
SA m0,s24,16384
M a[4:7],a[40:43],a[160:163],a[4:7]
buffer_load_dwordx4 v12, s[48:51], s22 offen offset:0   lds
M a[8:11],a[48:51],a[160:163],a[8:11]
M a[8:11],a[52:55],a[164:167],a[8:11]
M a[12:15],a[60:63],a[164:167],a[12:15]
s_nop 0
T a[100:101],v1,8192
T a[102:103],v1,9216
M a[12:15],a[56:59],a[160:163],a[12:15]
M a[16:19],a[64:67],a[160:163],a[16:19]
buffer_load_dwordx4 v13, s[48:51], s22 offen offset:1024   lds
M a[16:19],a[68:71],a[164:167],a[16:19]
M a[20:23],a[76:79],a[164:167],a[20:23]
M a[20:23],a[72:75],a[160:163],a[20:23]
s_nop 0
T a[104:105],v2,0
T a[106:107],v2,1024
M a[24:27],a[80:83],a[160:163],a[24:27]
M a[24:27],a[84:87],a[164:167],a[24:27]
s_waitcnt lgkmcnt(6)
buffer_load_dwordx4 v14, s[48:51], s22 offen offset:2048   lds
M a[28:31],a[92:95],a[164:167],a[28:31]
M a[28:31],a[88:91],a[160:163],a[28:31]
M v[32:35],a[32:35],a[168:171],v[32:35]
R a[160:163],v5,36864
R a[164:167],v6,36864
M v[32:35],a[36:39],a[172:175],v[32:35]
T a[108:109],v2,8192
T a[110:111],v2,9216
M v[36:39],a[44:47],a[172:175],v[36:39]
buffer_load_dwordx4 v15, s[48:51], s22 offen offset:3072   lds
M v[36:39],a[40:43],a[168:171],v[36:39]
s_sub_u32 s22, s22, 1048448
M v[40:43],a[48:51],a[168:171],v[40:43]
M v[40:43],a[52:55],a[172:175],v[40:43]
s_nop 0
T a[112:113],v3,0
T a[114:115],v3,1024
M v[44:47],a[60:63],a[172:175],v[44:47]
SA m0,s23,49152
M v[44:47],a[56:59],a[168:171],v[44:47]
buffer_load_dwordx4 v8, s[16:19], s21 offen offset:0  nt lds
M v[48:51],a[64:67],a[168:171],v[48:51]
M v[48:51],a[68:71],a[172:175],v[48:51]
M v[52:55],a[76:79],a[172:175],v[52:55]
s_nop 0
T a[116:117],v3,8192
T a[118:119],v3,9216
M v[52:55],a[72:75],a[168:171],v[52:55]
M v[56:59],a[80:83],a[168:171],v[56:59]
buffer_load_dwordx4 v9, s[16:19], s21 offen offset:1024  nt lds
M v[56:59],a[84:87],a[172:175],v[56:59]
s_waitcnt lgkmcnt(6)
M v[60:63],a[92:95],a[172:175],v[60:63]
M v[60:63],a[88:91],a[168:171],v[60:63]
s_nop 0
T a[120:121],v4,0
T a[122:123],v4,1024
M v[64:67],a[32:35],a[160:163],v[64:67]
R a[168:171],v5,38912
R a[172:175],v6,38912
M v[64:67],a[36:39],a[164:167],v[64:67]
buffer_load_dwordx4 v10, s[16:19], s21 offen offset:2048  nt lds
M v[68:71],a[44:47],a[164:167],v[68:71]
M v[68:71],a[40:43],a[160:163],v[68:71]
M v[72:75],a[48:51],a[160:163],v[72:75]
s_nop 0
T a[124:125],v4,8192
T a[126:127],v4,9216
M v[72:75],a[52:55],a[164:167],v[72:75]
M v[76:79],a[60:63],a[164:167],v[76:79]
buffer_load_dwordx4 v11, s[16:19], s21 offen offset:3072  nt lds
M v[76:79],a[56:59],a[160:163],v[76:79]
SA s21,s21,524160
M v[80:83],a[64:67],a[160:163],v[80:83]
M v[80:83],a[68:71],a[164:167],v[80:83]
M v[84:87],a[76:79],a[164:167],v[84:87]
M v[84:87],a[72:75],a[160:163],v[84:87]
M v[88:91],a[80:83],a[160:163],v[88:91]
M v[88:91],a[84:87],a[164:167],v[88:91]
s_waitcnt lgkmcnt(2)
M v[92:95],a[92:95],a[164:167],v[92:95]
s_waitcnt vmcnt(24) lgkmcnt(0)
M v[92:95],a[88:91],a[160:163],v[92:95]
s_barrier
M v[96:99],a[32:35],a[168:171],v[96:99]
R a[160:163],v5,49152
R a[164:167],v6,49152
M v[96:99],a[36:39],a[172:175],v[96:99]
M v[100:103],a[44:47],a[172:175],v[100:103]
SA m0,s24,32768
T a[128:129],v1,16384
T a[130:131],v1,17408
M v[100:103],a[40:43],a[168:171],v[100:103]
buffer_load_dwordx4 v12, s[48:51], s22 offen offset:0   lds
M v[104:107],a[48:51],a[168:171],v[104:107]
s_nop 0
T a[176:177],v22,0
T a[178:179],v22,128
M v[104:107],a[52:55],a[172:175],v[104:107]
T a[180:181],v22,1024
T a[182:183],v22,1152
M v[108:111],a[60:63],a[172:175],v[108:111]
T a[184:185],v22,2048
T a[186:187],v22,2176
M v[108:111],a[56:59],a[168:171],v[108:111]
T a[188:189],v22,3072
T a[190:191],v22,3200
M v[112:115],a[64:67],a[168:171],v[112:115]
M v[112:115],a[68:71],a[172:175],v[112:115]
s_nop 0
T a[132:133],v1,24576
T a[134:135],v1,25600
M v[116:119],a[76:79],a[172:175],v[116:119]
buffer_load_dwordx4 v13, s[48:51], s22 offen offset:1024   lds
M v[116:119],a[72:75],a[168:171],v[116:119]
M v[120:123],a[80:83],a[168:171],v[120:123]
M v[120:123],a[84:87],a[172:175],v[120:123]
s_waitcnt lgkmcnt(12)
M v[124:127],a[92:95],a[172:175],v[124:127]
M v[124:127],a[88:91],a[168:171],v[124:127]
M v[128:131],a[32:35],a[160:163],v[128:131]
R a[168:171],v5,51200
R a[172:175],v6,51200
M v[128:131],a[36:39],a[164:167],v[128:131]
T a[136:137],v2,16384
T a[138:139],v2,17408
M v[132:135],a[44:47],a[164:167],v[132:135]
buffer_load_dwordx4 v14, s[48:51], s22 offen offset:2048   lds
M v[132:135],a[40:43],a[160:163],v[132:135]
M v[136:139],a[48:51],a[160:163],v[136:139]
M v[136:139],a[52:55],a[164:167],v[136:139]
M v[140:143],a[60:63],a[164:167],v[140:143]
M v[140:143],a[56:59],a[160:163],v[140:143]
s_nop 0
T a[140:141],v2,24576
T a[142:143],v2,25600
M v[144:147],a[64:67],a[160:163],v[144:147]
buffer_load_dwordx4 v15, s[48:51], s22 offen offset:3072   lds
M v[144:147],a[68:71],a[164:167],v[144:147]
SA s22,s22,1048576
M v[148:151],a[76:79],a[164:167],v[148:151]
M v[148:151],a[72:75],a[160:163],v[148:151]
M v[152:155],a[80:83],a[160:163],v[152:155]
M v[152:155],a[84:87],a[164:167],v[152:155]
s_waitcnt lgkmcnt(4)
M v[156:159],a[92:95],a[164:167],v[156:159]
SA m0,s23,0
T a[144:145],v3,16384
T a[146:147],v3,17408
M v[156:159],a[88:91],a[160:163],v[156:159]
buffer_load_dwordx4 v8, s[16:19], s21 offen offset:0  nt lds
s_waitcnt vmcnt(28)
M v[16:19],a[176:179],a[208:211],0
s_waitcnt vmcnt(26)
M v[16:19],a[180:183],a[212:215],v[16:19]
s_waitcnt vmcnt(25)
M v[16:19],a[184:187],a[216:219],v[16:19]
s_waitcnt vmcnt(23)
M v[16:19],a[188:191],a[220:223],v[16:19]
M v[160:163],a[32:35],a[168:171],v[160:163]
R a[160:163],v5,53248
R a[164:167],v6,53248
M v[160:163],a[36:39],a[172:175],v[160:163]
T a[176:177],v22,4096
T a[178:179],v22,4224
M v[164:167],a[44:47],a[172:175],v[164:167]
T a[180:181],v22,5120
T a[182:183],v22,5248
M v[164:167],a[40:43],a[168:171],v[164:167]
T a[184:185],v22,6144
T a[186:187],v22,6272
M v[168:171],a[48:51],a[168:171],v[168:171]
M v[168:171],a[52:55],a[172:175],v[168:171]
s_nop 0
T a[148:149],v3,24576
T a[150:151],v3,25600
M v[172:175],a[60:63],a[172:175],v[172:175]
buffer_load_dwordx4 v9, s[16:19], s21 offen offset:1024  nt lds
M v[172:175],a[56:59],a[168:171],v[172:175]
M v[176:179],a[64:67],a[168:171],v[176:179]
M v[176:179],a[68:71],a[172:175],v[176:179]
M v[180:183],a[76:79],a[172:175],v[180:183]
M v[180:183],a[72:75],a[168:171],v[180:183]
M v[184:187],a[80:83],a[168:171],v[184:187]
s_nop 0
T a[152:153],v4,16384
T a[154:155],v4,17408
M v[184:187],a[84:87],a[172:175],v[184:187]
s_waitcnt lgkmcnt(10)
buffer_load_dwordx4 v10, s[16:19], s21 offen offset:2048  nt lds
M v[188:191],a[92:95],a[172:175],v[188:191]
M v[188:191],a[88:91],a[168:171],v[188:191]
M v[192:195],a[32:35],a[160:163],v[192:195]
R a[168:171],v5,55296
R a[172:175],v6,55296
M v[192:195],a[36:39],a[164:167],v[192:195]
M v[196:199],a[44:47],a[164:167],v[196:199]
M v[196:199],a[40:43],a[160:163],v[196:199]
s_nop 0
T a[156:157],v4,24576
T a[158:159],v4,25600
M v[200:203],a[48:51],a[160:163],v[200:203]
buffer_load_dwordx4 v11, s[16:19], s21 offen offset:3072  nt lds
M v[200:203],a[52:55],a[164:167],v[200:203]
SA s21,s21,128
M v[204:207],a[60:63],a[164:167],v[204:207]
M v[204:207],a[56:59],a[160:163],v[204:207]
M v[208:211],a[64:67],a[160:163],v[208:211]
M v[208:211],a[68:71],a[164:167],v[208:211]
M v[212:215],a[76:79],a[164:167],v[212:215]
M v[212:215],a[72:75],a[160:163],v[212:215]
M v[216:219],a[80:83],a[160:163],v[216:219]
M v[216:219],a[84:87],a[164:167],v[216:219]
s_waitcnt lgkmcnt(2)
M v[220:223],a[92:95],a[164:167],v[220:223]
s_waitcnt vmcnt(16) lgkmcnt(0)
M v[220:223],a[88:91],a[160:163],v[220:223]
s_barrier
M v[16:19],a[176:179],a[224:227],v[16:19]
M v[16:19],a[180:183],a[228:231],v[16:19]
M v[16:19],a[184:187],a[232:235],v[16:19]
M v[224:227],a[32:35],a[168:171],v[224:227]
R a[160:163],v5,0
R a[164:167],v6,0
M v[224:227],a[36:39],a[172:175],v[224:227]
M v[228:231],a[44:47],a[172:175],v[228:231]
M v[228:231],a[40:43],a[168:171],v[228:231]
M v[232:235],a[48:51],a[168:171],v[232:235]
M v[232:235],a[52:55],a[172:175],v[232:235]
M v[236:239],a[60:63],a[172:175],v[236:239]
M v[236:239],a[56:59],a[168:171],v[236:239]
M v[240:243],a[64:67],a[168:171],v[240:243]
M v[240:243],a[68:71],a[172:175],v[240:243]
M v[244:247],a[76:79],a[172:175],v[244:247]
M v[244:247],a[72:75],a[168:171],v[244:247]
M v[248:251],a[80:83],a[168:171],v[248:251]
M v[248:251],a[84:87],a[172:175],v[248:251]
s_waitcnt lgkmcnt(0)
M v[252:255],a[92:95],a[172:175],v[252:255]
M v[252:255],a[88:91],a[168:171],v[252:255]
M a[0:3],a[96:99],a[160:163],a[0:3]
R a[168:171],v5,2048
R a[172:175],v6,2048
M a[0:3],a[100:103],a[164:167],a[0:3]
T a[32:33],v1,32768
T a[34:35],v1,33792
M a[4:7],a[108:111],a[164:167],a[4:7]
SA m0,s24,49152
M a[4:7],a[104:107],a[160:163],a[4:7]
buffer_load_dwordx4 v12, s[48:51], s22 offen offset:0   lds
M a[8:11],a[112:115],a[160:163],a[8:11]
M a[8:11],a[116:119],a[164:167],a[8:11]
s_lshl_b32 s64, s20, 10
M a[12:15],a[124:127],a[164:167],a[12:15]
SA s64,s64,159744
T a[36:37],v1,40960
T a[38:39],v1,41984
M a[12:15],a[120:123],a[160:163],a[12:15]
v_add_u32 v21, s64, v7
ds_write_b128 v21, v[16:19]
M a[16:19],a[128:131],a[160:163],a[16:19]
s_mul_i32 s67, s86, 14336
buffer_load_dwordx4 v13, s[48:51], s22 offen offset:1024   lds
M a[16:19],a[132:135],a[164:167],a[16:19]
s_mul_i32 s64, s20, 224
M a[20:23],a[140:143],a[164:167],a[20:23]
SA s67,s67,s64
v_lshrrev_b32 v28, 4, v0
v_mul_u32_u24 v28, 896, v28
M a[20:23],a[136:139],a[160:163],a[20:23]
T a[40:41],v2,32768
T a[42:43],v2,33792
M a[24:27],a[144:147],a[160:163],a[24:27]
v_and_b32 v29, 15, v0
v_lshl_add_u32 v28, v29, 4, v28
M a[24:27],a[148:151],a[164:167],a[24:27]
s_waitcnt lgkmcnt(7)
buffer_load_dwordx4 v14, s[48:51], s22 offen offset:2048   lds
M a[28:31],a[156:159],a[164:167],a[28:31]
v_mov_b32 v30, 536870912
v_cmp_gt_u32 vcc, 14, v29
M a[28:31],a[152:155],a[160:163],a[28:31]
s_nop 0
M v[32:35],a[96:99],a[168:171],v[32:35]
s_nop 0
R a[160:163],v5,4096
R a[164:167],v6,4096
M v[32:35],a[100:103],a[172:175],v[32:35]
T a[44:45],v2,40960
T a[46:47],v2,41984
M v[36:39],a[108:111],a[172:175],v[36:39]
buffer_load_dwordx4 v15, s[48:51], s22 offen offset:3072   lds
M v[36:39],a[104:107],a[168:171],v[36:39]
s_sub_u32 s22, s22, 1048448
v_cndmask_b32 v28, v30, v28, vcc
v_add_u32 v29, 2560, v28
M v[40:43],a[112:115],a[168:171],v[40:43]
v_add_u32 v30, 5120, v28
v_add_u32 v31, 7680, v28
M v[40:43],a[116:119],a[172:175],v[40:43]
T a[48:49],v3,32768
T a[50:51],v3,33792
M v[44:47],a[124:127],a[172:175],v[44:47]
SA m0,s23,16384
M v[44:47],a[120:123],a[168:171],v[44:47]
buffer_load_dwordx4 v8, s[16:19], s21 offen offset:0  nt lds
M v[48:51],a[128:131],a[168:171],v[48:51]
M v[48:51],a[132:135],a[172:175],v[48:51]
M v[52:55],a[140:143],a[172:175],v[52:55]
s_nop 0
T a[52:53],v3,40960
T a[54:55],v3,41984
M v[52:55],a[136:139],a[168:171],v[52:55]
M v[56:59],a[144:147],a[168:171],v[56:59]
buffer_load_dwordx4 v9, s[16:19], s21 offen offset:1024  nt lds
M v[56:59],a[148:151],a[172:175],v[56:59]
s_waitcnt lgkmcnt(6)
M v[60:63],a[156:159],a[172:175],v[60:63]
M v[60:63],a[152:155],a[168:171],v[60:63]
s_nop 0
T a[56:57],v4,32768
T a[58:59],v4,33792
M v[64:67],a[96:99],a[160:163],v[64:67]
R a[168:171],v5,6144
R a[172:175],v6,6144
M v[64:67],a[100:103],a[164:167],v[64:67]
buffer_load_dwordx4 v10, s[16:19], s21 offen offset:2048  nt lds
M v[68:71],a[108:111],a[164:167],v[68:71]
M v[68:71],a[104:107],a[160:163],v[68:71]
M v[72:75],a[112:115],a[160:163],v[72:75]
s_nop 0
T a[60:61],v4,40960
T a[62:63],v4,41984
M v[72:75],a[116:119],a[164:167],v[72:75]
M v[76:79],a[124:127],a[164:167],v[76:79]
buffer_load_dwordx4 v11, s[16:19], s21 offen offset:3072  nt lds
M v[76:79],a[120:123],a[160:163],v[76:79]
SA s21,s21,524160
M v[80:83],a[128:131],a[160:163],v[80:83]
M v[80:83],a[132:135],a[164:167],v[80:83]
M v[84:87],a[140:143],a[164:167],v[84:87]
M v[84:87],a[136:139],a[160:163],v[84:87]
M v[88:91],a[144:147],a[160:163],v[88:91]
M v[88:91],a[148:151],a[164:167],v[88:91]
s_waitcnt lgkmcnt(2)
M v[92:95],a[156:159],a[164:167],v[92:95]
s_waitcnt vmcnt(16) lgkmcnt(0)
M v[92:95],a[152:155],a[160:163],v[92:95]
s_barrier
M v[96:99],a[96:99],a[168:171],v[96:99]
R a[160:163],v5,16384
R a[164:167],v6,16384
M v[96:99],a[100:103],a[172:175],v[96:99]
M v[100:103],a[108:111],a[172:175],v[100:103]
SA m0,s24,0
T a[64:65],v1,49152
T a[66:67],v1,50176
M v[100:103],a[104:107],a[168:171],v[100:103]
buffer_load_dwordx4 v12, s[48:51], s22 offen offset:0   lds
M v[104:107],a[112:115],a[168:171],v[104:107]
M v[104:107],a[116:119],a[172:175],v[104:107]
M v[108:111],a[124:127],a[172:175],v[108:111]
M v[108:111],a[120:123],a[168:171],v[108:111]
buffer_load_dwordx4 v13, s[48:51], s22 offen offset:1024   lds
M v[112:115],a[128:131],a[168:171],v[112:115]
M v[112:115],a[132:135],a[172:175],v[112:115]
s_nop 0
T a[68:69],v1,57344
T a[70:71],v1,58368
M v[116:119],a[140:143],a[172:175],v[116:119]
M v[116:119],a[136:139],a[168:171],v[116:119]
M v[120:123],a[144:147],a[168:171],v[120:123]
buffer_load_dwordx4 v14, s[48:51], s22 offen offset:2048   lds
M v[120:123],a[148:151],a[172:175],v[120:123]
s_waitcnt lgkmcnt(4)
M v[124:127],a[156:159],a[172:175],v[124:127]
M v[124:127],a[152:155],a[168:171],v[124:127]
M v[128:131],a[96:99],a[160:163],v[128:131]
R a[168:171],v5,18432
R a[172:175],v6,18432
M v[128:131],a[100:103],a[164:167],v[128:131]
T a[72:73],v2,49152
T a[74:75],v2,50176
M v[132:135],a[108:111],a[164:167],v[132:135]
buffer_load_dwordx4 v15, s[48:51], s22 offen offset:3072   lds
M v[132:135],a[104:107],a[160:163],v[132:135]
SA s22,s22,1048576
M v[136:139],a[112:115],a[160:163],v[136:139]
M v[136:139],a[116:119],a[164:167],v[136:139]
SA m0,s23,32768
M v[140:143],a[124:127],a[164:167],v[140:143]
buffer_load_dwordx4 v8, s[16:19], s21 offen offset:0  nt lds
M v[140:143],a[120:123],a[160:163],v[140:143]
s_nop 0
T a[76:77],v2,57344
T a[78:79],v2,58368
M v[144:147],a[128:131],a[160:163],v[144:147]
M v[144:147],a[132:135],a[164:167],v[144:147]
M v[148:151],a[140:143],a[164:167],v[148:151]
buffer_load_dwordx4 v9, s[16:19], s21 offen offset:1024  nt lds
M v[148:151],a[136:139],a[160:163],v[148:151]
M v[152:155],a[144:147],a[160:163],v[152:155]
M v[152:155],a[148:151],a[164:167],v[152:155]
s_waitcnt lgkmcnt(4)
M v[156:159],a[156:159],a[164:167],v[156:159]
s_nop 0
T a[80:81],v3,49152
T a[82:83],v3,50176
M v[156:159],a[152:155],a[160:163],v[156:159]
buffer_load_dwordx4 v10, s[16:19], s21 offen offset:2048  nt lds
M v[160:163],a[96:99],a[168:171],v[160:163]
R a[160:163],v5,20480
R a[164:167],v6,20480
M v[160:163],a[100:103],a[172:175],v[160:163]
M v[164:167],a[108:111],a[172:175],v[164:167]
M v[164:167],a[104:107],a[168:171],v[164:167]
M v[168:171],a[112:115],a[168:171],v[168:171]
buffer_load_dwordx4 v11, s[16:19], s21 offen offset:3072  nt lds
M v[168:171],a[116:119],a[172:175],v[168:171]
SA s21,s21,128
T a[84:85],v3,57344
T a[86:87],v3,58368
M v[172:175],a[124:127],a[172:175],v[172:175]
M v[172:175],a[120:123],a[168:171],v[172:175]
M v[176:179],a[128:131],a[168:171],v[176:179]
SA m0,s87,0
M v[176:179],a[132:135],a[172:175],v[176:179]
buffer_load_dwordx4 v28, s[68:71], s67 offen offset:0 nt lds
M v[180:183],a[140:143],a[172:175],v[180:183]
M v[180:183],a[136:139],a[168:171],v[180:183]
M v[184:187],a[144:147],a[168:171],v[184:187]
s_nop 0
T a[88:89],v4,49152
T a[90:91],v4,50176
M v[184:187],a[148:151],a[172:175],v[184:187]
s_waitcnt lgkmcnt(4)
buffer_load_dwordx4 v29, s[68:71], s67 offen offset:1024 nt lds
M v[188:191],a[156:159],a[172:175],v[188:191]
M v[188:191],a[152:155],a[168:171],v[188:191]
M v[192:195],a[96:99],a[160:163],v[192:195]
R a[168:171],v5,22528
R a[172:175],v6,22528
M v[192:195],a[100:103],a[164:167],v[192:195]
M v[196:199],a[108:111],a[164:167],v[196:199]
buffer_load_dwordx4 v30, s[68:71], s67 offen offset:2048 nt lds
M v[196:199],a[104:107],a[160:163],v[196:199]
s_nop 0
T a[92:93],v4,57344
T a[94:95],v4,58368
M v[200:203],a[112:115],a[160:163],v[200:203]
M v[200:203],a[116:119],a[164:167],v[200:203]
M v[204:207],a[124:127],a[164:167],v[204:207]
L_w_kv05:
s_cbranch_execz L_wd1
M v[204:207],a[120:123],a[160:163],v[204:207]
buffer_load_dwordx4 v31, s[68:71], s67 offen offset:3072 nt lds
M v[208:211],a[128:131],a[160:163],v[208:211]
SA s67,s67,0
M v[208:211],a[132:135],a[164:167],v[208:211]
M v[212:215],a[140:143],a[164:167],v[212:215]
M v[212:215],a[136:139],a[160:163],v[212:215]
M v[216:219],a[144:147],a[160:163],v[216:219]
M v[216:219],a[148:151],a[164:167],v[216:219]
s_waitcnt lgkmcnt(2)
M v[220:223],a[156:159],a[164:167],v[220:223]
s_waitcnt vmcnt(20) lgkmcnt(0)
M v[220:223],a[152:155],a[160:163],v[220:223]
s_barrier
M v[224:227],a[96:99],a[168:171],v[224:227]
R a[160:163],v5,32768
R a[164:167],v6,32768
M v[224:227],a[100:103],a[172:175],v[224:227]
M v[228:231],a[108:111],a[172:175],v[228:231]
M v[228:231],a[104:107],a[168:171],v[228:231]
M v[232:235],a[112:115],a[168:171],v[232:235]
M v[232:235],a[116:119],a[172:175],v[232:235]
M v[236:239],a[124:127],a[172:175],v[236:239]
M v[236:239],a[120:123],a[168:171],v[236:239]
M v[240:243],a[128:131],a[168:171],v[240:243]
M v[240:243],a[132:135],a[172:175],v[240:243]
M v[244:247],a[140:143],a[172:175],v[244:247]
M v[244:247],a[136:139],a[168:171],v[244:247]
M v[248:251],a[144:147],a[168:171],v[248:251]
M v[248:251],a[148:151],a[172:175],v[248:251]
s_waitcnt lgkmcnt(0)
M v[252:255],a[156:159],a[172:175],v[252:255]
M v[252:255],a[152:155],a[168:171],v[252:255]
M a[0:3],a[32:35],a[160:163],a[0:3]
R a[168:171],v5,34816
R a[172:175],v6,34816
M a[0:3],a[36:39],a[164:167],a[0:3]
T a[96:97],v1,0
T a[98:99],v1,1024
M a[4:7],a[44:47],a[164:167],a[4:7]
SA m0,s24,16384
C v23,v23,v23
M a[4:7],a[40:43],a[160:163],a[4:7]
buffer_load_dwordx4 v12, s[48:51], s22 offen offset:0   lds
M a[8:11],a[48:51],a[160:163],a[8:11]
v_and_b32 v23, 0xffff0000, v23
M a[8:11],a[52:55],a[164:167],a[8:11]
MF v22,0xbfb8aa3b,v23
M a[12:15],a[60:63],a[164:167],a[12:15]
s_nop 0
T a[100:101],v1,8192
T a[102:103],v1,9216
M a[12:15],a[56:59],a[160:163],a[12:15]
E v22,v22
M a[16:19],a[64:67],a[160:163],a[16:19]
buffer_load_dwordx4 v13, s[48:51], s22 offen offset:1024   lds
M a[16:19],a[68:71],a[164:167],a[16:19]
AF v22,1.0,v22
M a[20:23],a[76:79],a[164:167],a[20:23]
v_rcp_f32 v23, v22
M a[20:23],a[72:75],a[160:163],a[20:23]
s_or_b32 s64, s31, s20
T a[104:105],v2,0
T a[106:107],v2,1024
M a[24:27],a[80:83],a[160:163],a[24:27]
s_min_u32 s64, s64, 1
s_lshl_b32 s64, s64, 29
v_lshrrev_b32 v22, 1, v0
M a[24:27],a[84:87],a[164:167],a[24:27]
s_waitcnt lgkmcnt(6)
buffer_load_dwordx4 v14, s[48:51], s22 offen offset:2048   lds
M a[28:31],a[92:95],a[164:167],a[28:31]
v_min_u32 v22, 1, v22
M a[28:31],a[88:91],a[160:163],a[28:31]
v_lshlrev_b32 v22, 29, v22
M v[32:35],a[32:35],a[168:171],v[32:35]
R a[160:163],v5,36864
R a[164:167],v6,36864
M v[32:35],a[36:39],a[172:175],v[32:35]
T a[108:109],v2,8192
T a[110:111],v2,9216
M v[36:39],a[44:47],a[172:175],v[36:39]
buffer_load_dwordx4 v15, s[48:51], s22 offen offset:3072   lds
M v[36:39],a[40:43],a[168:171],v[36:39]
s_sub_u32 s22, s22, 1048448
v_lshl_or_b32 v22, v0, 2, v22
M v[40:43],a[48:51],a[168:171],v[40:43]
v_or_b32 v22, s64, v22
M v[40:43],a[52:55],a[172:175],v[40:43]
s_nop 0
T a[112:113],v3,0
T a[114:115],v3,1024
M v[44:47],a[60:63],a[172:175],v[44:47]
SA m0,s23,49152
C v23,v23,v23
M v[44:47],a[56:59],a[168:171],v[44:47]
buffer_load_dwordx4 v8, s[16:19], s21 offen offset:0  nt lds
M v[48:51],a[64:67],a[168:171],v[48:51]
v_and_b32 v23, 0xffff0000, v23
M v[48:51],a[68:71],a[172:175],v[48:51]
s_lshl_b32 s64, s41, 7
M v[52:55],a[76:79],a[172:175],v[52:55]
SA s64,s64,104890368
T a[116:117],v3,8192
T a[118:119],v3,9216
M v[52:55],a[72:75],a[168:171],v[52:55]
buffer_store_dword v24, v22, s[8:11], s64 offen sc1
M v[56:59],a[80:83],a[168:171],v[56:59]
buffer_load_dwordx4 v9, s[16:19], s21 offen offset:1024  nt lds
M v[56:59],a[84:87],a[172:175],v[56:59]
s_waitcnt lgkmcnt(6)
buffer_store_dword v23, v22, s[8:11], s64 offen offset:8 sc1
M v[60:63],a[92:95],a[172:175],v[60:63]
v_add_u32 v25, 159744, v7
M v[60:63],a[88:91],a[168:171],v[60:63]
s_nop 0
T a[120:121],v4,0
T a[122:123],v4,1024
M v[64:67],a[32:35],a[160:163],v[64:67]
R a[168:171],v5,38912
R a[172:175],v6,38912
M v[64:67],a[36:39],a[164:167],v[64:67]
buffer_load_dwordx4 v10, s[16:19], s21 offen offset:2048  nt lds
M v[68:71],a[44:47],a[164:167],v[68:71]
ds_read_b128 v[16:19], v25
M v[68:71],a[40:43],a[160:163],v[68:71]
R v[28:31],v25,1024
M v[72:75],a[48:51],a[160:163],v[72:75]
s_nop 0
T a[124:125],v4,8192
T a[126:127],v4,9216
M v[72:75],a[52:55],a[164:167],v[72:75]
R v[20:23],v25,2048
M v[76:79],a[60:63],a[164:167],v[76:79]
buffer_load_dwordx4 v11, s[16:19], s21 offen offset:3072  nt lds
M v[76:79],a[56:59],a[160:163],v[76:79]
SA s21,s21,524160
M v[80:83],a[64:67],a[160:163],v[80:83]
M v[80:83],a[68:71],a[164:167],v[80:83]
M v[84:87],a[76:79],a[164:167],v[84:87]
M v[84:87],a[72:75],a[160:163],v[84:87]
M v[88:91],a[80:83],a[160:163],v[88:91]
M v[88:91],a[84:87],a[164:167],v[88:91]
s_waitcnt lgkmcnt(5)
s_waitcnt lgkmcnt(3)
AF v16,v28,v16
M v[92:95],a[92:95],a[164:167],v[92:95]
s_waitcnt vmcnt(22) lgkmcnt(0)
AF v17,v29,v17
M v[92:95],a[88:91],a[160:163],v[92:95]
s_barrier
M v[96:99],a[32:35],a[168:171],v[96:99]
R a[160:163],v5,49152
R a[164:167],v6,49152
M v[96:99],a[36:39],a[172:175],v[96:99]
AF v18,v30,v18
M v[100:103],a[44:47],a[172:175],v[100:103]
SA m0,s24,32768
T a[128:129],v1,16384
T a[130:131],v1,17408
M v[100:103],a[40:43],a[168:171],v[100:103]
buffer_load_dwordx4 v12, s[48:51], s22 offen offset:0   lds
M v[104:107],a[48:51],a[168:171],v[104:107]
AF v19,v31,v19
M v[104:107],a[52:55],a[172:175],v[104:107]
R v[28:31],v25,3072
M v[108:111],a[60:63],a[172:175],v[108:111]
C v25,v16,v17
M v[108:111],a[56:59],a[168:171],v[108:111]
v_lshlrev_b32 v16, 16, v25
M v[112:115],a[64:67],a[168:171],v[112:115]
v_and_b32 v17, 0xffff0000, v25
M v[112:115],a[68:71],a[172:175],v[112:115]
s_nop 0
T a[132:133],v1,24576
T a[134:135],v1,25600
M v[116:119],a[76:79],a[172:175],v[116:119]
buffer_load_dwordx4 v13, s[48:51], s22 offen offset:1024   lds
M v[116:119],a[72:75],a[168:171],v[116:119]
C v25,v18,v19
M v[120:123],a[80:83],a[168:171],v[120:123]
v_lshlrev_b32 v18, 16, v25
M v[120:123],a[84:87],a[172:175],v[120:123]
s_waitcnt lgkmcnt(5)
v_and_b32 v19, 0xffff0000, v25
M v[124:127],a[92:95],a[172:175],v[124:127]
s_waitcnt lgkmcnt(2)
AF v20,v28,v20
M v[124:127],a[88:91],a[168:171],v[124:127]
AF v21,v29,v21
M v[128:131],a[32:35],a[160:163],v[128:131]
R a[168:171],v5,51200
R a[172:175],v6,51200
M v[128:131],a[36:39],a[164:167],v[128:131]
T a[136:137],v2,16384
T a[138:139],v2,17408
M v[132:135],a[44:47],a[164:167],v[132:135]
buffer_load_dwordx4 v14, s[48:51], s22 offen offset:2048   lds
M v[132:135],a[40:43],a[160:163],v[132:135]
AF v22,v30,v22
M v[136:139],a[48:51],a[160:163],v[136:139]
AF v23,v31,v23
M v[136:139],a[52:55],a[164:167],v[136:139]
MF v28,0xbfb8aa3b,v16
M v[140:143],a[60:63],a[164:167],v[140:143]
MF v29,0xbfb8aa3b,v17
M v[140:143],a[56:59],a[160:163],v[140:143]
s_nop 0
T a[140:141],v2,24576
T a[142:143],v2,25600
M v[144:147],a[64:67],a[160:163],v[144:147]
buffer_load_dwordx4 v15, s[48:51], s22 offen offset:3072   lds
M v[144:147],a[68:71],a[164:167],v[144:147]
SA s22,s22,1048576
MF v30,0xbfb8aa3b,v18
M v[148:151],a[76:79],a[164:167],v[148:151]
MF v31,0xbfb8aa3b,v19
M v[148:151],a[72:75],a[160:163],v[148:151]
E v28,v28
M v[152:155],a[80:83],a[160:163],v[152:155]
E v29,v29
M v[152:155],a[84:87],a[164:167],v[152:155]
s_waitcnt lgkmcnt(4)
E v30,v30
M v[156:159],a[92:95],a[164:167],v[156:159]
SA m0,s23,0
T a[144:145],v3,16384
T a[146:147],v3,17408
M v[156:159],a[88:91],a[160:163],v[156:159]
buffer_load_dwordx4 v8, s[16:19], s21 offen offset:0  nt lds
M v[160:163],a[32:35],a[168:171],v[160:163]
R a[160:163],v5,53248
R a[164:167],v6,53248
M v[160:163],a[36:39],a[172:175],v[160:163]
E v31,v31
M v[164:167],a[44:47],a[172:175],v[164:167]
C v25,v20,v21
M v[164:167],a[40:43],a[168:171],v[164:167]
v_lshlrev_b32 v20, 16, v25
M v[168:171],a[48:51],a[168:171],v[168:171]
v_and_b32 v21, 0xffff0000, v25
M v[168:171],a[52:55],a[172:175],v[168:171]
s_nop 0
T a[148:149],v3,24576
T a[150:151],v3,25600
M v[172:175],a[60:63],a[172:175],v[172:175]
buffer_load_dwordx4 v9, s[16:19], s21 offen offset:1024  nt lds
M v[172:175],a[56:59],a[168:171],v[172:175]
C v25,v22,v23
M v[176:179],a[64:67],a[168:171],v[176:179]
v_lshlrev_b32 v22, 16, v25
M v[176:179],a[68:71],a[172:175],v[176:179]
v_and_b32 v23, 0xffff0000, v25
M v[180:183],a[76:79],a[172:175],v[180:183]
AF v28,1.0,v28
M v[180:183],a[72:75],a[168:171],v[180:183]
AF v29,1.0,v29
M v[184:187],a[80:83],a[168:171],v[184:187]
s_nop 0
T a[152:153],v4,16384
T a[154:155],v4,17408
M v[184:187],a[84:87],a[172:175],v[184:187]
s_waitcnt lgkmcnt(4)
buffer_load_dwordx4 v10, s[16:19], s21 offen offset:2048  nt lds
M v[188:191],a[92:95],a[172:175],v[188:191]
AF v30,1.0,v30
M v[188:191],a[88:91],a[168:171],v[188:191]
AF v31,1.0,v31
M v[192:195],a[32:35],a[160:163],v[192:195]
R a[168:171],v5,55296
R a[172:175],v6,55296
M v[192:195],a[36:39],a[164:167],v[192:195]
v_rcp_f32 v28, v28
M v[196:199],a[44:47],a[164:167],v[196:199]
v_rcp_f32 v29, v29
M v[196:199],a[40:43],a[160:163],v[196:199]
T a[156:157],v4,24576
T a[158:159],v4,25600
M v[200:203],a[48:51],a[160:163],v[200:203]
buffer_load_dwordx4 v11, s[16:19], s21 offen offset:3072  nt lds
M v[200:203],a[52:55],a[164:167],v[200:203]
SA s21,s21,128
v_rcp_f32 v30, v30
M v[204:207],a[60:63],a[164:167],v[204:207]
v_rcp_f32 v31, v31
M v[204:207],a[56:59],a[160:163],v[204:207]
MF v16,v28,v16
M v[208:211],a[64:67],a[160:163],v[208:211]
MF v17,v29,v17
M v[208:211],a[68:71],a[164:167],v[208:211]
MF v18,v30,v18
M v[212:215],a[76:79],a[164:167],v[212:215]
MF v19,v31,v19
M v[212:215],a[72:75],a[160:163],v[212:215]
C v25,v16,v17
M v[216:219],a[80:83],a[160:163],v[216:219]
v_lshlrev_b32 v16, 16, v25
M v[216:219],a[84:87],a[164:167],v[216:219]
s_waitcnt lgkmcnt(2)
v_and_b32 v17, 0xffff0000, v25
M v[220:223],a[92:95],a[164:167],v[220:223]
s_waitcnt vmcnt(22) lgkmcnt(0)
C v25,v18,v19
M v[220:223],a[88:91],a[160:163],v[220:223]
s_barrier
M v[224:227],a[32:35],a[168:171],v[224:227]
R a[160:163],v5,0
R a[164:167],v6,0
M v[224:227],a[36:39],a[172:175],v[224:227]
v_lshlrev_b32 v18, 16, v25
M v[228:231],a[44:47],a[172:175],v[228:231]
v_and_b32 v19, 0xffff0000, v25
M v[228:231],a[40:43],a[168:171],v[228:231]
MF v16,v20,v16
M v[232:235],a[48:51],a[168:171],v[232:235]
MF v17,v21,v17
M v[232:235],a[52:55],a[172:175],v[232:235]
MF v18,v22,v18
M v[236:239],a[60:63],a[172:175],v[236:239]
MF v19,v23,v19
M v[236:239],a[56:59],a[168:171],v[236:239]
C v16,v16,v17
M v[240:243],a[64:67],a[168:171],v[240:243]
C v17,v18,v19
M v[240:243],a[68:71],a[172:175],v[240:243]
M v[244:247],a[76:79],a[172:175],v[244:247]
M v[244:247],a[72:75],a[168:171],v[244:247]
M v[248:251],a[80:83],a[168:171],v[248:251]
M v[248:251],a[84:87],a[172:175],v[248:251]
s_waitcnt lgkmcnt(0)
M v[252:255],a[92:95],a[172:175],v[252:255]
M v[252:255],a[88:91],a[168:171],v[252:255]
M a[0:3],a[96:99],a[160:163],a[0:3]
R a[168:171],v5,2048
R a[172:175],v6,2048
M a[0:3],a[100:103],a[164:167],a[0:3]
T a[32:33],v1,32768
T a[34:35],v1,33792
M a[4:7],a[108:111],a[164:167],a[4:7]
SA m0,s24,49152
v_lshrrev_b32 v28, 4, v0
v_and_b32 v29, 7, v0
M a[4:7],a[104:107],a[160:163],a[4:7]
buffer_load_dwordx4 v12, s[48:51], s22 offen offset:0   lds
M a[8:11],a[112:115],a[160:163],a[8:11]
v_xor_b32 v28, v28, v29
v_lshlrev_b32 v28, 4, v28
M a[8:11],a[116:119],a[164:167],a[8:11]
v_lshrrev_b32 v29, 3, v0
v_mul_u32_u24 v29, 896, v29
M a[12:15],a[124:127],a[164:167],a[12:15]
T a[36:37],v1,40960
T a[38:39],v1,41984
M a[12:15],a[120:123],a[160:163],a[12:15]
v_add_u32 v22, v28, v29
v_xor_b32 v28, 64, v28
M a[16:19],a[128:131],a[160:163],a[16:19]
s_mul_i32 s64, s20, 14336
buffer_load_dwordx4 v13, s[48:51], s22 offen offset:1024   lds
M a[16:19],a[132:135],a[164:167],a[16:19]
s_sub_u32 s65, 98304, s64
M a[20:23],a[140:143],a[164:167],a[20:23]
SA s30,s29,s65
M a[20:23],a[136:139],a[160:163],a[20:23]
SA s29,s29,s64
T a[40:41],v2,32768
T a[42:43],v2,33792
M a[24:27],a[144:147],a[160:163],a[24:27]
v_add_u32 v29, 6144, v29
v_add_u32 v23, v28, v29
M a[24:27],a[148:151],a[164:167],a[24:27]
s_waitcnt lgkmcnt(6)
buffer_load_dwordx4 v14, s[48:51], s22 offen offset:2048   lds
M a[28:31],a[156:159],a[164:167],a[28:31]
s_and_b32 s64, s20, 1
M a[28:31],a[152:155],a[160:163],a[28:31]
s_lshl_b32 s64, s64, 12
M v[32:35],a[96:99],a[168:171],v[32:35]
SA s64,s64,65536
R a[160:163],v5,4096
R a[164:167],v6,4096
M v[32:35],a[100:103],a[172:175],v[32:35]
T a[44:45],v2,40960
T a[46:47],v2,41984
M v[36:39],a[108:111],a[172:175],v[36:39]
buffer_load_dwordx4 v15, s[48:51], s22 offen offset:3072   lds
M v[36:39],a[104:107],a[168:171],v[36:39]
s_sub_u32 s22, s22, 1048448
v_add_u32 v20, s64, v5
v_add_u32 v21, s64, v6
M v[40:43],a[112:115],a[168:171],v[40:43]
v_lshrrev_b32 v28, 2, v0
v_lshlrev_b32 v28, 8, v28
M v[40:43],a[116:119],a[172:175],v[40:43]
T a[48:49],v3,32768
T a[50:51],v3,33792
M v[44:47],a[124:127],a[172:175],v[44:47]
SA m0,s23,16384
v_and_b32 v29, 3, v0
v_lshl_add_u32 v28, v29, 3, v28
M v[44:47],a[120:123],a[168:171],v[44:47]
buffer_load_dwordx4 v8, s[16:19], s21 offen offset:0  nt lds
M v[48:51],a[128:131],a[168:171],v[48:51]
v_add_u32 v28, s87, v28
M v[48:51],a[132:135],a[172:175],v[48:51]
s_waitcnt vmcnt(23)
s_nop 0
T a[176:177],v28,0
T a[178:179],v28,32
M v[52:55],a[140:143],a[172:175],v[52:55]
T a[52:53],v3,40960
T a[54:55],v3,41984
M v[52:55],a[136:139],a[168:171],v[52:55]
T a[180:181],v28,64
T a[182:183],v28,96
M v[56:59],a[144:147],a[168:171],v[56:59]
buffer_load_dwordx4 v9, s[16:19], s21 offen offset:1024  nt lds
M v[56:59],a[148:151],a[172:175],v[56:59]
s_waitcnt lgkmcnt(10)
s_nop 0
T a[184:185],v28,128
T a[186:187],v28,160
M v[60:63],a[156:159],a[172:175],v[60:63]
T a[188:189],v28,192
M v[60:63],a[152:155],a[168:171],v[60:63]
s_nop 0
T a[56:57],v4,32768
T a[58:59],v4,33792
M v[64:67],a[96:99],a[160:163],v[64:67]
R a[168:171],v5,6144
R a[172:175],v6,6144
M v[64:67],a[100:103],a[164:167],v[64:67]
buffer_load_dwordx4 v10, s[16:19], s21 offen offset:2048  nt lds
s_waitcnt lgkmcnt(12)
v_mfma_f32_16x16x16_bf16 a[192:195], a[176:177], v[16:17], 0
M v[68:71],a[108:111],a[164:167],v[68:71]
v_mov_b32 v18, v16 row_shr:2 row_mask:0xf bank_mask:0xf bound_ctrl:0
v_mov_b32 v19, v17 row_shr:2 row_mask:0xf bank_mask:0xf bound_ctrl:0
M v[68:71],a[104:107],a[160:163],v[68:71]
M v[72:75],a[112:115],a[160:163],v[72:75]
s_nop 0
T a[60:61],v4,40960
T a[62:63],v4,41984
M v[72:75],a[116:119],a[164:167],v[72:75]
s_waitcnt lgkmcnt(13)
v_mfma_f32_16x16x16_bf16 a[192:195], a[178:179], v[18:19], a[192:195]
M v[76:79],a[124:127],a[164:167],v[76:79]
buffer_load_dwordx4 v11, s[16:19], s21 offen offset:3072  nt lds
M v[76:79],a[120:123],a[160:163],v[76:79]
SA s21,s21,524160
v_mov_b32 v16, v18 row_shr:2 row_mask:0xf bank_mask:0xf bound_ctrl:0
v_mov_b32 v17, v19 row_shr:2 row_mask:0xf bank_mask:0xf bound_ctrl:0
M v[80:83],a[128:131],a[160:163],v[80:83]
M v[80:83],a[132:135],a[164:167],v[80:83]
s_waitcnt lgkmcnt(10)
v_mfma_f32_16x16x16_bf16 a[192:195], a[180:181], v[16:17], a[192:195]
M v[84:87],a[140:143],a[164:167],v[84:87]
v_mov_b32 v18, v16 row_shr:2 row_mask:0xf bank_mask:0xf bound_ctrl:0
v_mov_b32 v19, v17 row_shr:2 row_mask:0xf bank_mask:0xf bound_ctrl:0
M v[84:87],a[136:139],a[160:163],v[84:87]
M v[88:91],a[144:147],a[160:163],v[88:91]
M v[88:91],a[148:151],a[164:167],v[88:91]
s_waitcnt lgkmcnt(2)
v_mfma_f32_16x16x16_bf16 a[192:195], a[182:183], v[18:19], a[192:195]
M v[92:95],a[156:159],a[164:167],v[92:95]
s_waitcnt vmcnt(16) lgkmcnt(0)
v_mov_b32 v16, v18 row_shr:2 row_mask:0xf bank_mask:0xf bound_ctrl:0
v_mov_b32 v17, v19 row_shr:2 row_mask:0xf bank_mask:0xf bound_ctrl:0
M v[92:95],a[152:155],a[160:163],v[92:95]
s_barrier
M v[96:99],a[96:99],a[168:171],v[96:99]
R a[160:163],v5,16384
R a[164:167],v6,16384
M v[96:99],a[100:103],a[172:175],v[96:99]
SA m0,s23,131072
v_mfma_f32_16x16x16_bf16 a[192:195], a[184:185], v[16:17], a[192:195]
M v[100:103],a[108:111],a[172:175],v[100:103]
s_nop 0
T a[64:65],v1,49152
T a[66:67],v1,50176
M v[100:103],a[104:107],a[168:171],v[100:103]
v_mov_b32 v18, v16 row_shr:2 row_mask:0xf bank_mask:0xf bound_ctrl:0
v_mov_b32 v19, v17 row_shr:2 row_mask:0xf bank_mask:0xf bound_ctrl:0
M v[104:107],a[112:115],a[168:171],v[104:107]
buffer_load_dwordx4 v22, s[56:59], s29 offen offset:0 lds
M v[104:107],a[116:119],a[172:175],v[104:107]
v_mfma_f32_16x16x16_bf16 a[192:195], a[186:187], v[18:19], a[192:195]
M v[108:111],a[124:127],a[172:175],v[108:111]
v_mov_b32 v16, v18 row_shr:2 row_mask:0xf bank_mask:0xf bound_ctrl:0
v_mov_b32 v17, v19 row_shr:2 row_mask:0xf bank_mask:0xf bound_ctrl:0
M v[108:111],a[120:123],a[168:171],v[108:111]
buffer_load_dwordx4 v23, s[56:59], s29 offen offset:1024 lds
M v[112:115],a[128:131],a[168:171],v[112:115]
M v[112:115],a[132:135],a[172:175],v[112:115]
s_nop 0
T a[68:69],v1,57344
T a[70:71],v1,58368
v_mfma_f32_16x16x16_bf16 a[192:195], a[188:189], v[16:17], a[192:195]
M v[116:119],a[140:143],a[172:175],v[116:119]
buffer_load_dwordx4 v22, s[56:59], s30 offen offset:2048 lds
M v[116:119],a[136:139],a[168:171],v[116:119]
v_and_b32 v29, 1, v0
v_mul_u32_u24 v30, 1792, v29
M v[120:123],a[144:147],a[168:171],v[120:123]
v_lshrrev_b32 v31, 4, v0
v_lshl_add_u32 v30, v31, 4, v30
M v[120:123],a[148:151],a[172:175],v[120:123]
s_waitcnt lgkmcnt(4)
v_bfe_u32 v29, v0, 1, 3
v_lshl_add_u32 v30, v29, 6, v30
M v[124:127],a[156:159],a[172:175],v[124:127]
v_add_u32 v29, 1, v29
v_lshrrev_b32 v29, 3, v29
M v[124:127],a[152:155],a[168:171],v[124:127]
v_lshl_or_b32 v30, v29, 29, v30
v_or_b32 v30, s88, v30
M v[128:131],a[96:99],a[160:163],v[128:131]
s_mul_i32 s89, s86, 3584
R a[168:171],v5,18432
R a[172:175],v6,18432
M v[128:131],a[100:103],a[164:167],v[128:131]
s_mul_i32 s64, s20, 448
T a[72:73],v2,49152
T a[74:75],v2,50176
M v[132:135],a[108:111],a[164:167],v[132:135]
SA s89,s89,s64
M v[132:135],a[104:107],a[160:163],v[132:135]
SA s89,s89,105906176
buffer_store_dwordx4 a[192:195], v30, s[8:11], s89 offen sc1
M v[136:139],a[112:115],a[160:163],v[136:139]
M v[136:139],a[116:119],a[164:167],v[136:139]
M v[140:143],a[124:127],a[164:167],v[140:143]
buffer_load_dwordx4 v23, s[56:59], s30 offen offset:3072 lds
M v[140:143],a[120:123],a[160:163],v[140:143]
SA s29,s29,128
T a[76:77],v2,57344
T a[78:79],v2,58368
M v[144:147],a[128:131],a[160:163],v[144:147]
SA s30,s30,128
M v[144:147],a[132:135],a[164:167],v[144:147]
SA m0,s24,0
M v[148:151],a[140:143],a[164:167],v[148:151]
buffer_load_dwordx4 v12, s[48:51], s22 offen offset:0   lds
M v[148:151],a[136:139],a[160:163],v[148:151]
M v[152:155],a[144:147],a[160:163],v[152:155]
M v[152:155],a[148:151],a[164:167],v[152:155]
s_waitcnt lgkmcnt(4)
buffer_load_dwordx4 v13, s[48:51], s22 offen offset:1024   lds
M v[156:159],a[156:159],a[164:167],v[156:159]
s_nop 0
T a[80:81],v3,49152
T a[82:83],v3,50176
M v[156:159],a[152:155],a[160:163],v[156:159]
M v[160:163],a[96:99],a[168:171],v[160:163]
R a[160:163],v5,20480
R a[164:167],v6,20480
M v[160:163],a[100:103],a[172:175],v[160:163]
buffer_load_dwordx4 v14, s[48:51], s22 offen offset:2048   lds
M v[164:167],a[108:111],a[172:175],v[164:167]
M v[164:167],a[104:107],a[168:171],v[164:167]
M v[168:171],a[112:115],a[168:171],v[168:171]
buffer_load_dwordx4 v15, s[48:51], s22 offen offset:3072   lds
M v[168:171],a[116:119],a[172:175],v[168:171]
SA s22,s22,1048576
T a[84:85],v3,57344
T a[86:87],v3,58368
M v[172:175],a[124:127],a[172:175],v[172:175]
SA m0,s23,32768
M v[172:175],a[120:123],a[168:171],v[172:175]
buffer_load_dwordx4 v8, s[16:19], s21 offen offset:0  nt lds
L_w_kv06:
s_cbranch_execz L_wd1
M v[176:179],a[128:131],a[168:171],v[176:179]
M v[176:179],a[132:135],a[172:175],v[176:179]
M v[180:183],a[140:143],a[172:175],v[180:183]
M v[180:183],a[136:139],a[168:171],v[180:183]
buffer_load_dwordx4 v9, s[16:19], s21 offen offset:1024  nt lds
M v[184:187],a[144:147],a[168:171],v[184:187]
s_nop 0
T a[88:89],v4,49152
T a[90:91],v4,50176
M v[184:187],a[148:151],a[172:175],v[184:187]
s_waitcnt lgkmcnt(4)
M v[188:191],a[156:159],a[172:175],v[188:191]
M v[188:191],a[152:155],a[168:171],v[188:191]
M v[192:195],a[96:99],a[160:163],v[192:195]
R a[168:171],v5,22528
R a[172:175],v6,22528
M v[192:195],a[100:103],a[164:167],v[192:195]
buffer_load_dwordx4 v10, s[16:19], s21 offen offset:2048  nt lds
M v[196:199],a[108:111],a[164:167],v[196:199]
M v[196:199],a[104:107],a[160:163],v[196:199]
s_nop 0
T a[92:93],v4,57344
T a[94:95],v4,58368
M v[200:203],a[112:115],a[160:163],v[200:203]
M v[200:203],a[116:119],a[164:167],v[200:203]
buffer_load_dwordx4 v11, s[16:19], s21 offen offset:3072  nt lds
M v[204:207],a[124:127],a[164:167],v[204:207]
M v[204:207],a[120:123],a[160:163],v[204:207]
M v[208:211],a[128:131],a[160:163],v[208:211]
M v[208:211],a[132:135],a[164:167],v[208:211]
M v[212:215],a[140:143],a[164:167],v[212:215]
SA s21,s21,128
M v[212:215],a[136:139],a[160:163],v[212:215]
M v[216:219],a[144:147],a[160:163],v[216:219]
M v[216:219],a[148:151],a[164:167],v[216:219]
s_waitcnt lgkmcnt(2)
M v[220:223],a[156:159],a[164:167],v[220:223]
s_waitcnt vmcnt(21) lgkmcnt(0)
M v[220:223],a[152:155],a[160:163],v[220:223]
s_barrier
M v[224:227],a[96:99],a[168:171],v[224:227]
R a[160:163],v5,32768
R a[164:167],v6,32768
M v[224:227],a[100:103],a[172:175],v[224:227]
M v[228:231],a[108:111],a[172:175],v[228:231]
M v[228:231],a[104:107],a[168:171],v[228:231]
M v[232:235],a[112:115],a[168:171],v[232:235]
M v[232:235],a[116:119],a[172:175],v[232:235]
M v[236:239],a[124:127],a[172:175],v[236:239]
M v[236:239],a[120:123],a[168:171],v[236:239]
M v[240:243],a[128:131],a[168:171],v[240:243]
M v[240:243],a[132:135],a[172:175],v[240:243]
M v[244:247],a[140:143],a[172:175],v[244:247]
M v[244:247],a[136:139],a[168:171],v[244:247]
M v[248:251],a[144:147],a[168:171],v[248:251]
M v[248:251],a[148:151],a[172:175],v[248:251]
s_waitcnt lgkmcnt(0)
M v[252:255],a[156:159],a[172:175],v[252:255]
M v[252:255],a[152:155],a[168:171],v[252:255]
M a[0:3],a[32:35],a[160:163],a[0:3]
R a[168:171],v5,34816
R a[172:175],v6,34816
M a[0:3],a[36:39],a[164:167],a[0:3]
SA m0,s23,147456
T a[96:97],v1,0
T a[98:99],v1,1024
M a[4:7],a[44:47],a[164:167],a[4:7]
buffer_load_dwordx4 v22, s[56:59], s29 offen offset:0 lds
M a[4:7],a[40:43],a[160:163],a[4:7]
M a[8:11],a[48:51],a[160:163],a[8:11]
M a[8:11],a[52:55],a[164:167],a[8:11]
buffer_load_dwordx4 v23, s[56:59], s29 offen offset:1024 lds
M a[12:15],a[60:63],a[164:167],a[12:15]
s_nop 0
T a[100:101],v1,8192
T a[102:103],v1,9216
M a[12:15],a[56:59],a[160:163],a[12:15]
M a[16:19],a[64:67],a[160:163],a[16:19]
buffer_load_dwordx4 v22, s[56:59], s30 offen offset:2048 lds
M a[16:19],a[68:71],a[164:167],a[16:19]
M a[20:23],a[76:79],a[164:167],a[20:23]
M a[20:23],a[72:75],a[160:163],a[20:23]
s_nop 0
T a[104:105],v2,0
T a[106:107],v2,1024
M a[24:27],a[80:83],a[160:163],a[24:27]
buffer_load_dwordx4 v23, s[56:59], s30 offen offset:3072 lds
M a[24:27],a[84:87],a[164:167],a[24:27]
s_waitcnt lgkmcnt(6)
M a[28:31],a[92:95],a[164:167],a[28:31]
SA s29,s29,128
M a[28:31],a[88:91],a[160:163],a[28:31]
SA s30,s30,128
M v[32:35],a[32:35],a[168:171],v[32:35]
SA m0,s24,16384
R a[160:163],v5,36864
R a[164:167],v6,36864
M v[32:35],a[36:39],a[172:175],v[32:35]
T a[108:109],v2,8192
T a[110:111],v2,9216
M v[36:39],a[44:47],a[172:175],v[36:39]
buffer_load_dwordx4 v12, s[48:51], s22 offen offset:0   lds
M v[36:39],a[40:43],a[168:171],v[36:39]
M v[40:43],a[48:51],a[168:171],v[40:43]
M v[40:43],a[52:55],a[172:175],v[40:43]
s_nop 0
T a[112:113],v3,0
T a[114:115],v3,1024
M v[44:47],a[60:63],a[172:175],v[44:47]
buffer_load_dwordx4 v13, s[48:51], s22 offen offset:1024   lds
M v[44:47],a[56:59],a[168:171],v[44:47]
M v[48:51],a[64:67],a[168:171],v[48:51]
M v[48:51],a[68:71],a[172:175],v[48:51]
buffer_load_dwordx4 v14, s[48:51], s22 offen offset:2048   lds
M v[52:55],a[76:79],a[172:175],v[52:55]
s_nop 0
T a[116:117],v3,8192
T a[118:119],v3,9216
M v[52:55],a[72:75],a[168:171],v[52:55]
M v[56:59],a[80:83],a[168:171],v[56:59]
buffer_load_dwordx4 v15, s[48:51], s22 offen offset:3072   lds
M v[56:59],a[84:87],a[172:175],v[56:59]
s_waitcnt lgkmcnt(6)
M v[60:63],a[92:95],a[172:175],v[60:63]
s_sub_u32 s22, s22, 1048448
M v[60:63],a[88:91],a[168:171],v[60:63]
SA m0,s23,49152
T a[120:121],v4,0
T a[122:123],v4,1024
M v[64:67],a[32:35],a[160:163],v[64:67]
R a[168:171],v5,38912
R a[172:175],v6,38912
M v[64:67],a[36:39],a[164:167],v[64:67]
buffer_load_dwordx4 v8, s[16:19], s21 offen offset:0  nt lds
M v[68:71],a[44:47],a[164:167],v[68:71]
M v[68:71],a[40:43],a[160:163],v[68:71]
M v[72:75],a[48:51],a[160:163],v[72:75]
s_waitcnt vmcnt(17)
s_nop 0
T a[124:125],v4,8192
T a[126:127],v4,9216
M v[72:75],a[52:55],a[164:167],v[72:75]
buffer_load_dwordx4 v9, s[16:19], s21 offen offset:1024  nt lds
M v[76:79],a[60:63],a[164:167],v[76:79]
R a[176:179],v20,0
R a[180:183],v20,2048
M v[76:79],a[56:59],a[160:163],v[76:79]
R a[184:187],v21,0
R a[188:191],v21,2048
M v[80:83],a[64:67],a[160:163],v[80:83]
buffer_load_dwordx4 v10, s[16:19], s21 offen offset:2048  nt lds
M v[80:83],a[68:71],a[164:167],v[80:83]
M v[84:87],a[76:79],a[164:167],v[84:87]
M v[84:87],a[72:75],a[160:163],v[84:87]
buffer_load_dwordx4 v11, s[16:19], s21 offen offset:3072  nt lds
M v[88:91],a[80:83],a[160:163],v[88:91]
SA s21,s21,524160
M v[88:91],a[84:87],a[164:167],v[88:91]
s_waitcnt lgkmcnt(6)
M v[92:95],a[92:95],a[164:167],v[92:95]
s_waitcnt lgkmcnt(0)
M v[92:95],a[88:91],a[160:163],v[92:95]
s_barrier
M v[96:99],a[32:35],a[168:171],v[96:99]
s_lshl_b32 s4, s20, 10
R a[160:163],v5,49152
R a[164:167],v6,49152
M v[96:99],a[36:39],a[172:175],v[96:99]
SA m0,s23,131072
v_bfe_u32 v28, v0, 3, 2
M v[100:103],a[44:47],a[172:175],v[100:103]
s_nop 0
T a[128:129],v1,16384
T a[130:131],v1,17408
M v[100:103],a[40:43],a[168:171],v[100:103]
buffer_load_dwordx4 v22, s[56:59], s29 offen offset:0 lds
M v[104:107],a[48:51],a[168:171],v[104:107]
v_lshrrev_b32 v29, 5, v0
v_lshl_add_u32 v28, v29, 3, v28
M v[104:107],a[52:55],a[172:175],v[104:107]
M v[108:111],a[60:63],a[172:175],v[108:111]
buffer_load_dwordx4 v23, s[56:59], s29 offen offset:1024 lds
M v[108:111],a[56:59],a[168:171],v[108:111]
v_lshlrev_b32 v28, 13, v28
M v[112:115],a[64:67],a[168:171],v[112:115]
v_lshrrev_b32 v29, 4, v0
M v[112:115],a[68:71],a[172:175],v[112:115]
s_nop 0
T a[132:133],v1,24576
T a[134:135],v1,25600
M v[116:119],a[76:79],a[172:175],v[116:119]
buffer_load_dwordx4 v22, s[56:59], s30 offen offset:2048 lds
M v[116:119],a[72:75],a[168:171],v[116:119]
v_lshlrev_b32 v29, 1, v29
M v[120:123],a[80:83],a[168:171],v[120:123]
v_and_b32 v30, 7, v0
M v[120:123],a[84:87],a[172:175],v[120:123]
s_waitcnt lgkmcnt(4)
M v[124:127],a[92:95],a[172:175],v[124:127]
v_xor_b32 v29, v29, v30
M v[124:127],a[88:91],a[168:171],v[124:127]
buffer_load_dwordx4 v23, s[56:59], s30 offen offset:3072 lds
M v[128:131],a[32:35],a[160:163],v[128:131]
R a[168:171],v5,51200
R a[172:175],v6,51200
M v[128:131],a[36:39],a[164:167],v[128:131]
SA s29,s29,128
T a[136:137],v2,16384
T a[138:139],v2,17408
M v[132:135],a[44:47],a[164:167],v[132:135]
SA s30,s30,128
v_lshl_add_u32 v28, v29, 4, v28
M v[132:135],a[40:43],a[160:163],v[132:135]
s_and_b32 s64, s20, 1
M v[136:139],a[48:51],a[160:163],v[136:139]
s_lshl_b32 s64, s64, 17
M v[136:139],a[52:55],a[164:167],v[136:139]
s_lshr_b32 s65, s20, 1
M v[140:143],a[60:63],a[164:167],v[140:143]
s_lshl_b32 s65, s65, 15
SA s64,s64,s65
v_add_u32 v8, s64, v28
M v[140:143],a[56:59],a[160:163],v[140:143]
SA m0,s24,32768
T a[140:141],v2,24576
T a[142:143],v2,25600
M v[144:147],a[64:67],a[160:163],v[144:147]
buffer_load_dwordx4 v12, s[48:51], s22 offen offset:0   lds
M v[144:147],a[68:71],a[164:167],v[144:147]
M v[148:151],a[76:79],a[164:167],v[148:151]
M v[148:151],a[72:75],a[160:163],v[148:151]
buffer_load_dwordx4 v13, s[48:51], s22 offen offset:1024   lds
M v[152:155],a[80:83],a[160:163],v[152:155]
M v[152:155],a[84:87],a[164:167],v[152:155]
s_waitcnt lgkmcnt(4)
M v[156:159],a[92:95],a[164:167],v[156:159]
s_nop 0
T a[144:145],v3,16384
T a[146:147],v3,17408
M v[156:159],a[88:91],a[160:163],v[156:159]
buffer_load_dwordx4 v14, s[48:51], s22 offen offset:2048   lds
M v[160:163],a[32:35],a[168:171],v[160:163]
R a[160:163],v5,53248
R a[164:167],v6,53248
M v[160:163],a[36:39],a[172:175],v[160:163]
M v[164:167],a[44:47],a[172:175],v[164:167]
buffer_load_dwordx4 v15, s[48:51], s22 offen offset:3072   lds
M v[164:167],a[40:43],a[168:171],v[164:167]
M v[168:171],a[48:51],a[168:171],v[168:171]
SA s22,s22,1048576
M v[168:171],a[52:55],a[172:175],v[168:171]
s_mov_b32 s25, 0
T a[148:149],v3,24576
T a[150:151],v3,25600
M v[172:175],a[60:63],a[172:175],v[172:175]
SA m0,s4,0
M v[172:175],a[56:59],a[168:171],v[172:175]
buffer_load_dwordx4 v8, s[52:55], s25 offen lds
M v[176:179],a[64:67],a[168:171],v[176:179]
M v[176:179],a[68:71],a[172:175],v[176:179]
s_mov_b32 s25, 262144
M v[180:183],a[76:79],a[172:175],v[180:183]
SA m0,s4,4096
M v[180:183],a[72:75],a[168:171],v[180:183]
buffer_load_dwordx4 v8, s[52:55], s25 offen lds
M v[184:187],a[80:83],a[168:171],v[184:187]
s_nop 0
T a[152:153],v4,16384
T a[154:155],v4,17408
M v[184:187],a[84:87],a[172:175],v[184:187]
s_waitcnt lgkmcnt(4)
M v[188:191],a[92:95],a[172:175],v[188:191]
s_mov_b32 s25, 524288
M v[188:191],a[88:91],a[168:171],v[188:191]
SA m0,s4,8192
M v[192:195],a[32:35],a[160:163],v[192:195]
R a[168:171],v5,55296
R a[172:175],v6,55296
M v[192:195],a[36:39],a[164:167],v[192:195]
buffer_load_dwordx4 v8, s[52:55], s25 offen lds
M v[196:199],a[44:47],a[164:167],v[196:199]
M v[196:199],a[40:43],a[160:163],v[196:199]
s_mov_b32 s25, 786432
T a[156:157],v4,24576
T a[158:159],v4,25600
M v[200:203],a[48:51],a[160:163],v[200:203]
SA m0,s4,12288
M v[200:203],a[52:55],a[164:167],v[200:203]
s_waitcnt vmcnt(19)
buffer_load_dwordx4 v8, s[52:55], s25 offen lds
M v[204:207],a[60:63],a[164:167],v[204:207]
R a[192:195],v20,16384
R a[196:199],v20,18432
M v[204:207],a[56:59],a[160:163],v[204:207]
R a[200:203],v21,16384
R a[204:207],v21,18432
M v[208:211],a[64:67],a[160:163],v[208:211]
M v[208:211],a[68:71],a[164:167],v[208:211]
M v[212:215],a[76:79],a[164:167],v[212:215]
M v[212:215],a[72:75],a[160:163],v[212:215]
M v[216:219],a[80:83],a[160:163],v[216:219]
M v[216:219],a[84:87],a[164:167],v[216:219]
s_waitcnt lgkmcnt(6)
M v[220:223],a[92:95],a[164:167],v[220:223]
s_waitcnt lgkmcnt(0)
M v[220:223],a[88:91],a[160:163],v[220:223]
s_barrier
M v[224:227],a[32:35],a[168:171],v[224:227]
R a[160:163],v5,0
R a[164:167],v6,0
M v[224:227],a[36:39],a[172:175],v[224:227]
M v[228:231],a[44:47],a[172:175],v[228:231]
M v[228:231],a[40:43],a[168:171],v[228:231]
M v[232:235],a[48:51],a[168:171],v[232:235]
M v[232:235],a[52:55],a[172:175],v[232:235]
M v[236:239],a[60:63],a[172:175],v[236:239]
M v[236:239],a[56:59],a[168:171],v[236:239]
M v[240:243],a[64:67],a[168:171],v[240:243]
M v[240:243],a[68:71],a[172:175],v[240:243]
M v[244:247],a[76:79],a[172:175],v[244:247]
M v[244:247],a[72:75],a[168:171],v[244:247]
M v[248:251],a[80:83],a[168:171],v[248:251]
M v[248:251],a[84:87],a[172:175],v[248:251]
s_waitcnt lgkmcnt(0)
M v[252:255],a[92:95],a[172:175],v[252:255]
M v[252:255],a[88:91],a[168:171],v[252:255]
M a[0:3],a[96:99],a[160:163],a[0:3]
R a[168:171],v5,2048
R a[172:175],v6,2048
M a[0:3],a[100:103],a[164:167],a[0:3]
SA m0,s23,147456
T a[32:33],v1,32768
T a[34:35],v1,33792
M a[4:7],a[108:111],a[164:167],a[4:7]
buffer_load_dwordx4 v22, s[56:59], s29 offen offset:0 lds
M a[4:7],a[104:107],a[160:163],a[4:7]
M a[8:11],a[112:115],a[160:163],a[8:11]
M a[8:11],a[116:119],a[164:167],a[8:11]
buffer_load_dwordx4 v23, s[56:59], s29 offen offset:1024 lds
M a[12:15],a[124:127],a[164:167],a[12:15]
s_nop 0
T a[36:37],v1,40960
T a[38:39],v1,41984
M a[12:15],a[120:123],a[160:163],a[12:15]
M a[16:19],a[128:131],a[160:163],a[16:19]
buffer_load_dwordx4 v22, s[56:59], s30 offen offset:2048 lds
M a[16:19],a[132:135],a[164:167],a[16:19]
M a[20:23],a[140:143],a[164:167],a[20:23]
M a[20:23],a[136:139],a[160:163],a[20:23]
s_nop 0
T a[40:41],v2,32768
T a[42:43],v2,33792
M a[24:27],a[144:147],a[160:163],a[24:27]
buffer_load_dwordx4 v23, s[56:59], s30 offen offset:3072 lds
M a[24:27],a[148:151],a[164:167],a[24:27]
s_waitcnt lgkmcnt(6)
M a[28:31],a[156:159],a[164:167],a[28:31]
SA s29,s29,128
M a[28:31],a[152:155],a[160:163],a[28:31]
SA s30,s30,128
M v[32:35],a[96:99],a[168:171],v[32:35]
SA m0,s24,49152
R a[160:163],v5,4096
R a[164:167],v6,4096
M v[32:35],a[100:103],a[172:175],v[32:35]
T a[44:45],v2,40960
T a[46:47],v2,41984
M v[36:39],a[108:111],a[172:175],v[36:39]
buffer_load_dwordx4 v12, s[48:51], s22 offen offset:0   lds
M v[36:39],a[104:107],a[168:171],v[36:39]
M v[40:43],a[112:115],a[168:171],v[40:43]
M v[40:43],a[116:119],a[172:175],v[40:43]
s_nop 0
T a[48:49],v3,32768
T a[50:51],v3,33792
M v[44:47],a[124:127],a[172:175],v[44:47]
buffer_load_dwordx4 v13, s[48:51], s22 offen offset:1024   lds
M v[44:47],a[120:123],a[168:171],v[44:47]
M v[48:51],a[128:131],a[168:171],v[48:51]
M v[48:51],a[132:135],a[172:175],v[48:51]
buffer_load_dwordx4 v14, s[48:51], s22 offen offset:2048   lds
M v[52:55],a[140:143],a[172:175],v[52:55]
s_nop 0
T a[52:53],v3,40960
T a[54:55],v3,41984
M v[52:55],a[136:139],a[168:171],v[52:55]
M v[56:59],a[144:147],a[168:171],v[56:59]
buffer_load_dwordx4 v15, s[48:51], s22 offen offset:3072   lds
M v[56:59],a[148:151],a[172:175],v[56:59]
s_waitcnt lgkmcnt(6)
M v[60:63],a[156:159],a[172:175],v[60:63]
s_sub_u32 s22, s22, 1048448
M v[60:63],a[152:155],a[168:171],v[60:63]
s_mov_b32 s25, 1048576
T a[56:57],v4,32768
T a[58:59],v4,33792
M v[64:67],a[96:99],a[160:163],v[64:67]
SA m0,s4,16384
R a[168:171],v5,6144
R a[172:175],v6,6144
M v[64:67],a[100:103],a[164:167],v[64:67]
buffer_load_dwordx4 v8, s[52:55], s25 offen lds
M v[68:71],a[108:111],a[164:167],v[68:71]
s_mov_b32 s25, 1310720
M v[68:71],a[104:107],a[160:163],v[68:71]
SA m0,s4,20480
M v[72:75],a[112:115],a[160:163],v[72:75]
s_waitcnt vmcnt(17)
s_nop 0
T a[60:61],v4,40960
T a[62:63],v4,41984
M v[72:75],a[116:119],a[164:167],v[72:75]
buffer_load_dwordx4 v8, s[52:55], s25 offen lds
M v[76:79],a[124:127],a[164:167],v[76:79]
s_mov_b32 s25, 1572864
R a[208:211],v20,0
R a[212:215],v20,2048
M v[76:79],a[120:123],a[160:163],v[76:79]
SA m0,s4,24576
R a[216:219],v21,0
R a[220:223],v21,2048
M v[80:83],a[128:131],a[160:163],v[80:83]
buffer_load_dwordx4 v8, s[52:55], s25 offen lds
M v[80:83],a[132:135],a[164:167],v[80:83]
s_mov_b32 s25, 1835008
M v[84:87],a[140:143],a[164:167],v[84:87]
SA m0,s4,28672
M v[84:87],a[136:139],a[160:163],v[84:87]
buffer_load_dwordx4 v8, s[52:55], s25 offen lds
M v[88:91],a[144:147],a[160:163],v[88:91]
M v[88:91],a[148:151],a[164:167],v[88:91]
s_waitcnt lgkmcnt(6)
M v[92:95],a[156:159],a[164:167],v[92:95]
s_waitcnt lgkmcnt(0)
M v[92:95],a[152:155],a[160:163],v[92:95]
s_barrier
M v[96:99],a[96:99],a[168:171],v[96:99]
R a[160:163],v5,16384
R a[164:167],v6,16384
M v[96:99],a[100:103],a[172:175],v[96:99]
SA m0,s23,32768
M v[100:103],a[108:111],a[172:175],v[100:103]
s_nop 0
T a[64:65],v1,49152
T a[66:67],v1,50176
M v[100:103],a[104:107],a[168:171],v[100:103]
buffer_load_dwordx4 v22, s[56:59], s29 offen offset:0 lds
M v[104:107],a[112:115],a[168:171],v[104:107]
v_lshrrev_b32 v28, 2, v0
v_lshlrev_b32 v28, 7, v28
M v[104:107],a[116:119],a[172:175],v[104:107]
M v[108:111],a[124:127],a[172:175],v[108:111]
buffer_load_dwordx4 v23, s[56:59], s29 offen offset:1024 lds
M v[108:111],a[120:123],a[168:171],v[108:111]
v_and_b32 v29, 3, v0
M v[112:115],a[128:131],a[168:171],v[112:115]
v_lshl_add_u32 v28, v29, 3, v28
M v[112:115],a[132:135],a[172:175],v[112:115]
s_nop 0
T a[68:69],v1,57344
T a[70:71],v1,58368
M v[116:119],a[140:143],a[172:175],v[116:119]
buffer_load_dwordx4 v22, s[56:59], s30 offen offset:2048 lds
M v[116:119],a[136:139],a[168:171],v[116:119]
v_bfe_u32 v29, v0, 3, 2
M v[120:123],a[144:147],a[168:171],v[120:123]
M v[120:123],a[148:151],a[172:175],v[120:123]
s_waitcnt lgkmcnt(4)
v_lshl_add_u32 v16, v29, 5, v28
M v[124:127],a[156:159],a[172:175],v[124:127]
M v[124:127],a[152:155],a[168:171],v[124:127]
buffer_load_dwordx4 v23, s[56:59], s30 offen offset:3072 lds
M v[128:131],a[96:99],a[160:163],v[128:131]
R a[168:171],v5,18432
R a[172:175],v6,18432
M v[128:131],a[100:103],a[164:167],v[128:131]
SA s29,s29,128
T a[72:73],v2,49152
T a[74:75],v2,50176
M v[132:135],a[108:111],a[164:167],v[132:135]
SA s30,s30,128
v_xor_b32 v17, 32, v16
v_xor_b32 v18, 64, v16
M v[132:135],a[104:107],a[160:163],v[132:135]
SA m0,s23,65536
M v[136:139],a[112:115],a[160:163],v[136:139]
buffer_load_dwordx4 v22, s[56:59], s29 offen offset:0 lds
M v[136:139],a[116:119],a[164:167],v[136:139]
v_xor_b32 v19, 0x60, v16
M v[140:143],a[124:127],a[164:167],v[140:143]
v_add_u32 v12, 0x20000, v16
M v[140:143],a[120:123],a[160:163],v[140:143]
s_nop 0
T a[76:77],v2,57344
T a[78:79],v2,58368
M v[144:147],a[128:131],a[160:163],v[144:147]
buffer_load_dwordx4 v23, s[56:59], s29 offen offset:1024 lds
M v[144:147],a[132:135],a[164:167],v[144:147]
v_add_u32 v13, 0x20000, v17
M v[148:151],a[140:143],a[164:167],v[148:151]
M v[148:151],a[136:139],a[160:163],v[148:151]
v_add_u32 v14, 0x20000, v18
M v[152:155],a[144:147],a[160:163],v[152:155]
M v[152:155],a[148:151],a[164:167],v[152:155]
s_waitcnt lgkmcnt(4)
buffer_load_dwordx4 v22, s[56:59], s30 offen offset:2048 lds
M v[156:159],a[156:159],a[164:167],v[156:159]
s_nop 0
T a[80:81],v3,49152
T a[82:83],v3,50176
M v[156:159],a[152:155],a[160:163],v[156:159]
v_add_u32 v15, 0x20000, v19
M v[160:163],a[96:99],a[168:171],v[160:163]
R a[160:163],v5,20480
R a[164:167],v6,20480
M v[160:163],a[100:103],a[172:175],v[160:163]
M v[164:167],a[108:111],a[172:175],v[164:167]
buffer_load_dwordx4 v23, s[56:59], s30 offen offset:3072 lds
M v[164:167],a[104:107],a[168:171],v[164:167]
SA s29,s29,128
M v[168:171],a[112:115],a[168:171],v[168:171]
SA s30,s30,128
M v[168:171],a[116:119],a[172:175],v[168:171]
s_mov_b32 s25, 2097152
T a[84:85],v3,57344
T a[86:87],v3,58368
M v[172:175],a[124:127],a[172:175],v[172:175]
SA m0,s4,131072
M v[172:175],a[120:123],a[168:171],v[172:175]
buffer_load_dwordx4 v8, s[52:55], s25 offen lds
M v[176:179],a[128:131],a[168:171],v[176:179]
M v[176:179],a[132:135],a[172:175],v[176:179]
s_mov_b32 s25, 2359296
M v[180:183],a[140:143],a[172:175],v[180:183]
SA m0,s4,135168
M v[180:183],a[136:139],a[168:171],v[180:183]
buffer_load_dwordx4 v8, s[52:55], s25 offen lds
M v[184:187],a[144:147],a[168:171],v[184:187]
s_nop 0
T a[88:89],v4,49152
T a[90:91],v4,50176
M v[184:187],a[148:151],a[172:175],v[184:187]
s_waitcnt lgkmcnt(4)
M v[188:191],a[156:159],a[172:175],v[188:191]
s_mov_b32 s25, 2621440
M v[188:191],a[152:155],a[168:171],v[188:191]
L_w_kv07:
s_cbranch_execz L_wd1
SA m0,s4,139264
M v[192:195],a[96:99],a[160:163],v[192:195]
R a[168:171],v5,22528
R a[172:175],v6,22528
M v[192:195],a[100:103],a[164:167],v[192:195]
buffer_load_dwordx4 v8, s[52:55], s25 offen lds
M v[196:199],a[108:111],a[164:167],v[196:199]
M v[196:199],a[104:107],a[160:163],v[196:199]
s_mov_b32 s25, 2883584
T a[92:93],v4,57344
T a[94:95],v4,58368
M v[200:203],a[112:115],a[160:163],v[200:203]
SA m0,s4,143360
M v[200:203],a[116:119],a[164:167],v[200:203]
s_waitcnt vmcnt(19)
buffer_load_dwordx4 v8, s[52:55], s25 offen lds
M v[204:207],a[124:127],a[164:167],v[204:207]
R a[224:227],v20,16384
R a[228:231],v20,18432
M v[204:207],a[120:123],a[160:163],v[204:207]
R a[232:235],v21,16384
R a[236:239],v21,18432
M v[208:211],a[128:131],a[160:163],v[208:211]
v_subrev_u32 v20, 98304, v20
v_subrev_u32 v21, 98304, v21
M v[208:211],a[132:135],a[164:167],v[208:211]
M v[212:215],a[140:143],a[164:167],v[212:215]
M v[212:215],a[136:139],a[160:163],v[212:215]
M v[216:219],a[144:147],a[160:163],v[216:219]
M v[216:219],a[148:151],a[164:167],v[216:219]
s_waitcnt lgkmcnt(6)
M v[220:223],a[156:159],a[164:167],v[220:223]
s_waitcnt lgkmcnt(0)
M v[220:223],a[152:155],a[160:163],v[220:223]
s_barrier
M v[224:227],a[96:99],a[168:171],v[224:227]
R a[160:163],v5,32768
R a[164:167],v6,32768
M v[224:227],a[100:103],a[172:175],v[224:227]
M v[228:231],a[108:111],a[172:175],v[228:231]
M v[228:231],a[104:107],a[168:171],v[228:231]
M v[232:235],a[112:115],a[168:171],v[232:235]
M v[232:235],a[116:119],a[172:175],v[232:235]
M v[236:239],a[124:127],a[172:175],v[236:239]
M v[236:239],a[120:123],a[168:171],v[236:239]
M v[240:243],a[128:131],a[168:171],v[240:243]
M v[240:243],a[132:135],a[172:175],v[240:243]
M v[244:247],a[140:143],a[172:175],v[244:247]
M v[244:247],a[136:139],a[168:171],v[244:247]
M v[248:251],a[144:147],a[168:171],v[248:251]
M v[248:251],a[148:151],a[172:175],v[248:251]
s_waitcnt lgkmcnt(0)
M v[252:255],a[156:159],a[172:175],v[252:255]
M v[252:255],a[152:155],a[168:171],v[252:255]
M a[0:3],a[32:35],a[160:163],a[0:3]
R a[168:171],v5,34816
R a[172:175],v6,34816
M a[0:3],a[36:39],a[164:167],a[0:3]
SA m0,s23,81920
M a[4:7],a[44:47],a[164:167],a[4:7]
buffer_load_dwordx4 v22, s[56:59], s29 offen offset:0 lds
M a[4:7],a[40:43],a[160:163],a[4:7]
M a[8:11],a[48:51],a[160:163],a[8:11]
M a[8:11],a[52:55],a[164:167],a[8:11]
buffer_load_dwordx4 v23, s[56:59], s29 offen offset:1024 lds
M a[12:15],a[60:63],a[164:167],a[12:15]
M a[12:15],a[56:59],a[160:163],a[12:15]
G v24,a0
G v25,a1
M a[16:19],a[64:67],a[160:163],a[16:19]
G v26,a2
G v27,a3
M a[16:19],a[68:71],a[164:167],a[16:19]
buffer_load_dwordx4 v22, s[56:59], s30 offen offset:2048 lds
M a[20:23],a[76:79],a[164:167],a[20:23]
G v28,a4
G v29,a5
M a[20:23],a[72:75],a[160:163],a[20:23]
G v30,a6
G v31,a7
M a[24:27],a[80:83],a[160:163],a[24:27]
C v24,v24,v25
C v25,v26,v27
M a[24:27],a[84:87],a[164:167],a[24:27]
s_waitcnt lgkmcnt(0)
buffer_load_dwordx4 v23, s[56:59], s30 offen offset:3072 lds
M a[28:31],a[92:95],a[164:167],a[28:31]
SA s29,s29,128
C v26,v28,v29
C v27,v30,v31
M a[28:31],a[88:91],a[160:163],a[28:31]
SA s3,s93,0
buffer_store_dwordx4 v[24:27], v7, s[8:11], s3 offen offset:0 sc1
M v[32:35],a[32:35],a[168:171],v[32:35]
SA s30,s30,128
R a[160:163],v5,36864
R a[164:167],v6,36864
M v[32:35],a[36:39],a[172:175],v[32:35]
s_mov_b32 s25, 3145728
G v24,a8
G v25,a9
M v[36:39],a[44:47],a[172:175],v[36:39]
SA m0,s4,147456
G v26,a10
G v27,a11
M v[36:39],a[40:43],a[168:171],v[36:39]
buffer_load_dwordx4 v8, s[52:55], s25 offen lds
M v[40:43],a[48:51],a[168:171],v[40:43]
s_mov_b32 s25, 3407872
G v28,a12
G v29,a13
M v[40:43],a[52:55],a[172:175],v[40:43]
SA m0,s4,151552
G v30,a14
G v31,a15
M v[44:47],a[60:63],a[172:175],v[44:47]
buffer_load_dwordx4 v8, s[52:55], s25 offen lds
M v[44:47],a[56:59],a[168:171],v[44:47]
s_mov_b32 s25, 128
C v24,v24,v25
C v25,v26,v27
M v[48:51],a[64:67],a[168:171],v[48:51]
SA m0,s4,49152
C v26,v28,v29
C v27,v30,v31
M v[48:51],a[68:71],a[172:175],v[48:51]
buffer_store_dwordx4 v[24:27], v7, s[8:11], s3 offen offset:1024 sc1
M v[52:55],a[76:79],a[172:175],v[52:55]
s_nop 0
G v24,a16
G v25,a17
M v[52:55],a[72:75],a[168:171],v[52:55]
G v26,a18
G v27,a19
M v[56:59],a[80:83],a[168:171],v[56:59]
buffer_load_dwordx4 v8, s[52:55], s25 offen lds
M v[56:59],a[84:87],a[172:175],v[56:59]
s_waitcnt lgkmcnt(0)
G v28,a20
G v29,a21
M v[60:63],a[92:95],a[172:175],v[60:63]
s_mov_b32 s25, 262272
G v30,a22
G v31,a23
M v[60:63],a[88:91],a[168:171],v[60:63]
SA m0,s4,53248
C v24,v24,v25
C v25,v26,v27
M v[64:67],a[32:35],a[160:163],v[64:67]
s_waitcnt vmcnt(17)
R a[168:171],v5,38912
R a[172:175],v6,38912
M v[64:67],a[36:39],a[164:167],v[64:67]
buffer_load_dwordx4 v8, s[52:55], s25 offen lds
M v[68:71],a[44:47],a[164:167],v[68:71]
s_mov_b32 s25, 524416
C v26,v28,v29
C v27,v30,v31
M v[68:71],a[40:43],a[160:163],v[68:71]
SA m0,s4,57344
buffer_store_dwordx4 v[24:27], v7, s[8:11], s3 offen offset:2048 sc1
M v[72:75],a[48:51],a[160:163],v[72:75]
R a[96:99],v20,0
R a[100:103],v20,2048
M v[72:75],a[52:55],a[164:167],v[72:75]
R a[104:107],v21,0
R a[108:111],v21,2048
M v[76:79],a[60:63],a[164:167],v[76:79]
buffer_load_dwordx4 v8, s[52:55], s25 offen lds
M v[76:79],a[56:59],a[160:163],v[76:79]
s_mov_b32 s25, 786560
G v24,a24
G v25,a25
M v[80:83],a[64:67],a[160:163],v[80:83]
SA m0,s4,61440
G v26,a26
G v27,a27
M v[80:83],a[68:71],a[164:167],v[80:83]
buffer_load_dwordx4 v8, s[52:55], s25 offen lds
M v[84:87],a[76:79],a[164:167],v[84:87]
G v28,a28
G v29,a29
M v[84:87],a[72:75],a[160:163],v[84:87]
G v30,a30
G v31,a31
M v[88:91],a[80:83],a[160:163],v[88:91]
C v24,v24,v25
C v25,v26,v27
M v[88:91],a[84:87],a[164:167],v[88:91]
s_waitcnt lgkmcnt(4)
C v26,v28,v29
C v27,v30,v31
M v[92:95],a[92:95],a[164:167],v[92:95]
s_waitcnt lgkmcnt(0)
buffer_store_dwordx4 v[24:27], v7, s[8:11], s3 offen offset:3072 sc1
M v[92:95],a[88:91],a[160:163],v[92:95]
s_barrier
M v[96:99],a[32:35],a[168:171],v[96:99]
R a[160:163],v5,49152
R a[164:167],v6,49152
M v[96:99],a[36:39],a[172:175],v[96:99]
s_mov_b32 s25, 1048704
C v64,v64,v65
C v65,v66,v67
M v[100:103],a[44:47],a[172:175],v[100:103]
SA m0,s4,98304
C v66,v68,v69
C v67,v70,v71
M v[100:103],a[40:43],a[168:171],v[100:103]
s_waitcnt vmcnt(18)
buffer_load_dwordx4 v8, s[52:55], s25 offen lds
M v[104:107],a[48:51],a[168:171],v[104:107]
C v72,v72,v73
C v73,v74,v75
M v[104:107],a[52:55],a[172:175],v[104:107]
C v74,v76,v77
C v75,v78,v79
M v[108:111],a[60:63],a[172:175],v[108:111]
C v32,v32,v33
C v33,v34,v35
M v[108:111],a[56:59],a[168:171],v[108:111]
C v34,v36,v37
C v35,v38,v39
M v[112:115],a[64:67],a[168:171],v[112:115]
SA s3,s93,8192
buffer_store_dwordx4 v[32:35], v7, s[8:11], s3 offen offset:0 sc1
M v[112:115],a[68:71],a[172:175],v[112:115]
s_mov_b32 s25, 1310848
C v80,v80,v81
C v81,v82,v83
M v[116:119],a[76:79],a[172:175],v[116:119]
SA m0,s4,102400
C v82,v84,v85
C v83,v86,v87
M v[116:119],a[72:75],a[168:171],v[116:119]
R a[112:115],v20,32768
R a[116:119],v20,34816
M v[120:123],a[80:83],a[168:171],v[120:123]
buffer_load_dwordx4 v8, s[52:55], s25 offen lds
M v[120:123],a[84:87],a[172:175],v[120:123]
s_waitcnt lgkmcnt(2)
R a[120:123],v21,32768
R a[124:127],v21,34816
M v[124:127],a[92:95],a[172:175],v[124:127]
C v88,v88,v89
C v89,v90,v91
M v[124:127],a[88:91],a[168:171],v[124:127]
C v90,v92,v93
C v91,v94,v95
M v[128:131],a[32:35],a[160:163],v[128:131]
R a[168:171],v5,51200
R a[172:175],v6,51200
M v[128:131],a[36:39],a[164:167],v[128:131]
C v40,v40,v41
C v41,v42,v43
M v[132:135],a[44:47],a[164:167],v[132:135]
C v42,v44,v45
C v43,v46,v47
M v[132:135],a[40:43],a[160:163],v[132:135]
s_mov_b32 s25, 1572992
buffer_store_dwordx4 v[40:43], v7, s[8:11], s3 offen offset:1024 sc1
M v[136:139],a[48:51],a[160:163],v[136:139]
SA m0,s4,106496
C v96,v96,v97
C v97,v98,v99
M v[136:139],a[52:55],a[164:167],v[136:139]
C v98,v100,v101
C v99,v102,v103
M v[140:143],a[60:63],a[164:167],v[140:143]
C v104,v104,v105
C v105,v106,v107
M v[140:143],a[56:59],a[160:163],v[140:143]
buffer_load_dwordx4 v8, s[52:55], s25 offen lds
M v[144:147],a[64:67],a[160:163],v[144:147]
C v106,v108,v109
C v107,v110,v111
M v[144:147],a[68:71],a[164:167],v[144:147]
C v112,v112,v113
C v113,v114,v115
M v[148:151],a[76:79],a[164:167],v[148:151]
C v114,v116,v117
C v115,v118,v119
M v[148:151],a[72:75],a[160:163],v[148:151]
C v48,v48,v49
C v49,v50,v51
M v[152:155],a[80:83],a[160:163],v[152:155]
C v50,v52,v53
C v51,v54,v55
M v[152:155],a[84:87],a[164:167],v[152:155]
s_waitcnt lgkmcnt(0)
buffer_store_dwordx4 v[48:51], v7, s[8:11], s3 offen offset:2048 sc1
M v[156:159],a[92:95],a[164:167],v[156:159]
s_mov_b32 s25, 1835136
C v120,v120,v121
C v121,v122,v123
M v[156:159],a[88:91],a[160:163],v[156:159]
SA m0,s4,110592
C v122,v124,v125
C v123,v126,v127
M v[160:163],a[32:35],a[168:171],v[160:163]
R a[160:163],v5,53248
R a[164:167],v6,53248
M v[160:163],a[36:39],a[172:175],v[160:163]
buffer_load_dwordx4 v8, s[52:55], s25 offen lds
M v[164:167],a[44:47],a[172:175],v[164:167]
C v128,v128,v129
C v129,v130,v131
M v[164:167],a[40:43],a[168:171],v[164:167]
C v130,v132,v133
C v131,v134,v135
M v[168:171],a[48:51],a[168:171],v[168:171]
C v56,v56,v57
C v57,v58,v59
M v[168:171],a[52:55],a[172:175],v[168:171]
C v58,v60,v61
C v59,v62,v63
M v[172:175],a[60:63],a[172:175],v[172:175]
buffer_store_dwordx4 v[56:59], v7, s[8:11], s3 offen offset:3072 sc1
M v[172:175],a[56:59],a[168:171],v[172:175]
C v136,v136,v137
C v137,v138,v139
M v[176:179],a[64:67],a[168:171],v[176:179]
C v138,v140,v141
C v139,v142,v143
M v[176:179],a[68:71],a[172:175],v[176:179]
C v144,v144,v145
C v145,v146,v147
M v[180:183],a[76:79],a[172:175],v[180:183]
C v146,v148,v149
C v147,v150,v151
M v[180:183],a[72:75],a[168:171],v[180:183]
C v152,v152,v153
C v153,v154,v155
M v[184:187],a[80:83],a[168:171],v[184:187]
C v154,v156,v157
C v155,v158,v159
M v[184:187],a[84:87],a[172:175],v[184:187]
s_waitcnt lgkmcnt(0)
C v160,v160,v161
C v161,v162,v163
M v[188:191],a[92:95],a[172:175],v[188:191]
C v162,v164,v165
C v163,v166,v167
M v[188:191],a[88:91],a[168:171],v[188:191]
C v168,v168,v169
C v169,v170,v171
M v[192:195],a[32:35],a[160:163],v[192:195]
s_waitcnt vmcnt(18)
R a[168:171],v5,55296
R a[172:175],v6,55296
M v[192:195],a[36:39],a[164:167],v[192:195]
C v170,v172,v173
C v171,v174,v175
M v[196:199],a[44:47],a[164:167],v[196:199]
C v176,v176,v177
C v177,v178,v179
M v[196:199],a[40:43],a[160:163],v[196:199]
C v178,v180,v181
C v179,v182,v183
M v[200:203],a[48:51],a[160:163],v[200:203]
R a[128:131],v20,49152
R a[132:135],v20,51200
M v[200:203],a[52:55],a[164:167],v[200:203]
R a[136:139],v21,49152
R a[140:143],v21,51200
M v[204:207],a[60:63],a[164:167],v[204:207]
C v184,v184,v185
C v185,v186,v187
M v[204:207],a[56:59],a[160:163],v[204:207]
C v186,v188,v189
C v187,v190,v191
M v[208:211],a[64:67],a[160:163],v[208:211]
C v192,v192,v193
C v193,v194,v195
M v[208:211],a[68:71],a[164:167],v[208:211]
C v194,v196,v197
C v195,v198,v199
M v[212:215],a[76:79],a[164:167],v[212:215]
M v[212:215],a[72:75],a[160:163],v[212:215]
C v200,v200,v201
C v201,v202,v203
M v[216:219],a[80:83],a[160:163],v[216:219]
C v202,v204,v205
C v203,v206,v207
M v[216:219],a[84:87],a[164:167],v[216:219]
s_waitcnt lgkmcnt(4)
M v[220:223],a[92:95],a[164:167],v[220:223]
s_waitcnt vmcnt(15) lgkmcnt(0)
M v[220:223],a[88:91],a[160:163],v[220:223]
s_barrier
M v[224:227],a[32:35],a[168:171],v[224:227]
s_nop 0
T v[32:33],v16,0
T v[34:35],v16,2048
M v[224:227],a[36:39],a[172:175],v[224:227]
C v208,v208,v209
C v209,v210,v211
M v[228:231],a[44:47],a[172:175],v[228:231]
T v[36:37],v16,4096
T v[38:39],v16,6144
M v[228:231],a[40:43],a[168:171],v[228:231]
T v[40:41],v16,8192
T v[42:43],v16,10240
M v[232:235],a[48:51],a[168:171],v[232:235]
C v210,v212,v213
C v211,v214,v215
M v[232:235],a[52:55],a[172:175],v[232:235]
T v[44:45],v16,12288
T v[46:47],v16,14336
M v[236:239],a[60:63],a[172:175],v[236:239]
T v[48:49],v16,16384
T v[50:51],v16,18432
M v[236:239],a[56:59],a[168:171],v[236:239]
C v216,v216,v217
C v217,v218,v219
M v[240:243],a[64:67],a[168:171],v[240:243]
T v[52:53],v16,20480
T v[54:55],v16,22528
M v[240:243],a[68:71],a[172:175],v[240:243]
T v[56:57],v16,24576
T v[58:59],v16,26624
M v[244:247],a[76:79],a[172:175],v[244:247]
C v218,v220,v221
C v219,v222,v223
M v[244:247],a[72:75],a[168:171],v[244:247]
C v224,v224,v225
C v225,v226,v227
M v[248:251],a[80:83],a[168:171],v[248:251]
C v226,v228,v229
C v227,v230,v231
M v[248:251],a[84:87],a[172:175],v[248:251]
C v232,v232,v233
C v233,v234,v235
M v[252:255],a[92:95],a[172:175],v[252:255]
C v234,v236,v237
C v235,v238,v239
M v[252:255],a[88:91],a[168:171],v[252:255]
s_waitcnt lgkmcnt(6)
C v240,v240,v241
C v241,v242,v243
M v[68:71],v[32:35],a[176:179],0
s_mul_i32 s72, s41, 4352
T a[144:145],v17,0
T a[146:147],v17,2048
M v[68:71],v[36:39],a[184:187],v[68:71]
SA s46,s72,104923136
C v242,v244,v245
C v243,v246,v247
M v[68:71],v[40:43],a[192:195],v[68:71]
s_waitcnt lgkmcnt(2)
T a[148:149],v17,4096
T a[150:151],v17,6144
M v[68:71],v[44:47],a[200:203],v[68:71]
s_mov_b32 s25, 2097280
T a[152:153],v17,8192
T a[154:155],v17,10240
M v[68:71],v[48:51],a[208:211],v[68:71]
SA m0,s4,114688
C v248,v248,v249
C v249,v250,v251
M v[68:71],v[52:55],a[216:219],v[68:71]
s_lshl_b32 s45, s42, 7
T a[156:157],v17,12288
T a[158:159],v17,14336
M v[68:71],v[56:59],a[224:227],v[68:71]
SA s45,s45,s46
T a[160:161],v17,16384
T a[162:163],v17,18432
M v[76:79],v[56:59],a[228:231],0
s_lshl_b32 s72, s20, 2
buffer_load_dwordx4 v8, s[52:55], s25 offen lds
M v[76:79],v[52:55],a[220:223],v[76:79]
SA s72,s72,s45
T a[164:165],v17,20480
T a[166:167],v17,22528
M v[76:79],v[48:51],a[212:215],v[76:79]
T a[168:169],v17,24576
T a[170:171],v17,26624
M v[76:79],v[44:47],a[204:207],v[76:79]
s_mov_b32 s25, 2359424
C v250,v252,v253
C v251,v254,v255
M v[76:79],v[40:43],a[196:199],v[76:79]
SA m0,s4,118784
v_min_u32 v29, 1, v0
v_lshlrev_b32 v29, 29, v29
M v[76:79],v[36:39],a[188:191],v[76:79]
buffer_load_dwordx4 v8, s[52:55], s25 offen lds
M v[76:79],v[32:35],a[180:183],v[76:79]
s_waitcnt lgkmcnt(6)
v_mov_b32 v30, 1
M v[84:87],a[144:147],a[176:179],0
s_nop 0
T v[32:33],v18,0
T v[34:35],v18,2048
M v[84:87],a[148:151],a[184:187],v[84:87]
s_mov_b32 s25, 2621568
M v[84:87],a[152:155],a[192:195],v[84:87]
s_waitcnt lgkmcnt(2)
s_nop 0
T v[36:37],v18,4096
T v[38:39],v18,6144
M v[84:87],a[156:159],a[200:203],v[84:87]
SA m0,s4,122880
T v[40:41],v18,8192
T v[42:43],v18,10240
M v[84:87],a[160:163],a[208:211],v[84:87]
buffer_load_dwordx4 v8, s[52:55], s25 offen lds
M v[84:87],a[164:167],a[216:219],v[84:87]
s_nop 0
T v[44:45],v18,12288
T v[46:47],v18,14336
M v[84:87],a[168:171],a[224:227],v[84:87]
s_waitcnt vmcnt(3)
T v[48:49],v18,16384
T v[50:51],v18,18432
M v[92:95],a[168:171],a[228:231],0
s_mov_b32 s25, 2883712
buffer_store_dword v30, v29, s[8:11], s72 offen offset:4 sc1
M v[92:95],a[164:167],a[220:223],v[92:95]
SA m0,s4,126976
T v[52:53],v18,20480
T v[54:55],v18,22528
M v[92:95],a[160:163],a[212:215],v[92:95]
T v[56:57],v18,24576
T v[58:59],v18,26624
M v[92:95],a[156:159],a[204:207],v[92:95]
buffer_load_dwordx4 v8, s[52:55], s25 offen lds
M v[92:95],a[152:155],a[196:199],v[92:95]
v_add_u32 v20, 0x10000, v16
L_w_kv08:
s_cbranch_execz L_wd1
v_add_u32 v21, 0x10000, v17
M v[92:95],a[148:151],a[188:191],v[92:95]
M v[92:95],a[144:147],a[180:183],v[92:95]
s_waitcnt lgkmcnt(6)
v_add_u32 v22, 0x10000, v18
M v[100:103],v[32:35],a[176:179],0
s_mov_b32 s25, 3145856
T a[144:145],v19,0
T a[146:147],v19,2048
M v[100:103],v[36:39],a[184:187],v[100:103]
SA m0,s4,32768
M v[100:103],v[40:43],a[192:195],v[100:103]
s_waitcnt lgkmcnt(2)
s_nop 0
T a[148:149],v19,4096
T a[150:151],v19,6144
M v[100:103],v[44:47],a[200:203],v[100:103]
T a[152:153],v19,8192
T a[154:155],v19,10240
M v[100:103],v[48:51],a[208:211],v[100:103]
buffer_load_dwordx4 v8, s[52:55], s25 offen lds
M v[100:103],v[52:55],a[216:219],v[100:103]
s_nop 0
T a[156:157],v19,12288
T a[158:159],v19,14336
M v[100:103],v[56:59],a[224:227],v[100:103]
T a[160:161],v19,16384
T a[162:163],v19,18432
M v[108:111],v[56:59],a[228:231],0
s_mov_b32 s25, 3408000
v_add_u32 v23, 0x10000, v19
v_or_b32 v1, s20, v0
M v[108:111],v[52:55],a[220:223],v[108:111]
SA m0,s4,36864
T a[164:165],v19,20480
T a[166:167],v19,22528
M v[108:111],v[48:51],a[212:215],v[108:111]
SA s3,s93,524288
T a[168:169],v19,24576
T a[170:171],v19,26624
M v[108:111],v[44:47],a[204:207],v[108:111]
buffer_load_dwordx4 v8, s[52:55], s25 offen lds
M v[108:111],v[40:43],a[196:199],v[108:111]
v_min_u32 v1, 1, v1
M v[108:111],v[36:39],a[188:191],v[108:111]
M v[108:111],v[32:35],a[180:183],v[108:111]
s_waitcnt lgkmcnt(6)
buffer_store_dwordx4 v[64:67], v7, s[8:11], s3 offen offset:0 sc1
M v[116:119],a[144:147],a[176:179],0
s_mov_b32 s25, 256
T v[32:33],v16,28672
T v[34:35],v16,30720
M v[116:119],a[148:151],a[184:187],v[116:119]
SA m0,s4,65536
v_lshlrev_b32 v1, 29, v1
M v[116:119],a[152:155],a[192:195],v[116:119]
s_waitcnt lgkmcnt(2)
s_nop 0
T v[36:37],v12,0
T v[38:39],v12,2048
M v[116:119],a[156:159],a[200:203],v[116:119]
T v[40:41],v12,4096
T v[42:43],v12,6144
M v[116:119],a[160:163],a[208:211],v[116:119]
buffer_load_dwordx4 v8, s[52:55], s25 offen lds
M v[116:119],a[164:167],a[216:219],v[116:119]
s_nop 0
T v[44:45],v12,8192
T v[46:47],v12,10240
M v[116:119],a[168:171],a[224:227],v[116:119]
T v[48:49],v12,12288
T v[50:51],v12,14336
M v[124:127],a[168:171],a[228:231],0
s_mov_b32 s25, 262400
buffer_store_dwordx4 v[72:75], v7, s[8:11], s3 offen offset:1024 sc1
M v[124:127],a[164:167],a[220:223],v[124:127]
SA m0,s4,69632
T v[52:53],v12,16384
T v[54:55],v12,18432
M v[124:127],a[160:163],a[212:215],v[124:127]
T v[56:57],v12,20480
T v[58:59],v12,22528
M v[124:127],a[156:159],a[204:207],v[124:127]
buffer_load_dwordx4 v8, s[52:55], s25 offen lds
M v[124:127],a[152:155],a[196:199],v[124:127]
v_min_u32 v9, 15, v0
v_lshlrev_b32 v9, 7, v9
M v[124:127],a[148:151],a[188:191],v[124:127]
s_sub_u32 s66, 15, s42
buffer_store_dwordx4 v[80:83], v7, s[8:11], s3 offen offset:2048 sc1
M v[124:127],a[144:147],a[180:183],v[124:127]
s_waitcnt lgkmcnt(6)
M v[68:71],v[32:35],a[232:235],v[68:71]
s_mov_b32 s25, 524544
T a[144:145],v17,28672
T a[146:147],v17,30720
M v[68:71],v[36:39],a[96:99],v[68:71]
SA m0,s4,73728
buffer_store_dwordx4 v[88:91], v7, s[8:11], s3 offen offset:3072 sc1
M v[68:71],v[40:43],a[104:107],v[68:71]
s_waitcnt lgkmcnt(2)
s_nop 0
T a[148:149],v13,0
T a[150:151],v13,2048
M v[68:71],v[44:47],a[112:115],v[68:71]
s_max_u32 s67, s66, s42
T a[152:153],v13,4096
T a[154:155],v13,6144
M v[68:71],v[48:51],a[120:123],v[68:71]
s_min_u32 s66, s66, s42
buffer_load_dwordx4 v8, s[52:55], s25 offen lds
M v[68:71],v[52:55],a[128:131],v[68:71]
s_mul_i32 s21, s41, 1048576
T a[156:157],v13,8192
T a[158:159],v13,10240
M v[68:71],v[56:59],a[136:139],v[68:71]
s_lshl_b32 s64, s67, 16
T a[160:161],v13,12288
T a[162:163],v13,14336
M v[76:79],v[56:59],a[140:143],v[76:79]
s_mov_b32 s25, 786688
M v[76:79],v[52:55],a[132:135],v[76:79]
SA m0,s4,77824
T a[164:165],v13,16384
T a[166:167],v13,18432
M v[76:79],v[48:51],a[124:127],v[76:79]
SA s32,s21,s64
T a[168:169],v13,20480
T a[170:171],v13,22528
M v[76:79],v[44:47],a[116:119],v[76:79]
s_lshl_b32 s64, s20, 14
buffer_load_dwordx4 v8, s[52:55], s25 offen lds
M v[76:79],v[40:43],a[108:111],v[76:79]
SA s32,s32,s64
M v[76:79],v[36:39],a[100:103],v[76:79]
SA s32,s32,33554432
M v[76:79],v[32:35],a[236:239],v[76:79]
s_waitcnt lgkmcnt(6)
M v[84:87],a[144:147],a[232:235],v[84:87]
s_mov_b32 s25, 1048832
T v[32:33],v18,28672
T v[34:35],v18,30720
M v[84:87],a[148:151],a[96:99],v[84:87]
SA m0,s4,81920
M v[84:87],a[152:155],a[104:107],v[84:87]
s_waitcnt lgkmcnt(2)
s_nop 0
T v[36:37],v14,0
T v[38:39],v14,2048
M v[84:87],a[156:159],a[112:115],v[84:87]
s_sub_u32 s64, s42, 10
T v[40:41],v14,4096
T v[42:43],v14,6144
M v[84:87],a[160:163],a[120:123],v[84:87]
s_and_b32 s35, s64, 536870912
buffer_load_dwordx4 v8, s[52:55], s25 offen lds
M v[84:87],a[164:167],a[128:131],v[84:87]
s_nop 0
T v[44:45],v14,8192
T v[46:47],v14,10240
M v[84:87],a[168:171],a[136:139],v[84:87]
T v[48:49],v14,12288
T v[50:51],v14,14336
M v[92:95],a[168:171],a[140:143],v[92:95]
s_mov_b32 s25, 1310976
v_or_b32 v6, s35, v7
M v[92:95],a[164:167],a[132:135],v[92:95]
SA m0,s4,86016
T v[52:53],v14,16384
T v[54:55],v14,18432
M v[92:95],a[160:163],a[124:127],v[92:95]
s_lshl_b32 s28, s20, 13
T v[56:57],v14,20480
T v[58:59],v14,22528
M v[92:95],a[156:159],a[116:119],v[92:95]
buffer_load_dwordx4 v8, s[52:55], s25 offen lds
M v[92:95],a[152:155],a[108:111],v[92:95]
v_add_u32 v2, 0x10000, v7
v_add_u32 v3, s28, v7
M v[92:95],a[148:151],a[100:103],v[92:95]
v_add_u32 v4, 0x1000, v3
MF v68,s5,v68
M v[92:95],a[144:147],a[236:239],v[92:95]
s_waitcnt lgkmcnt(6)
MF v69,s5,v69
MF v70,s5,v70
M v[100:103],v[32:35],a[232:235],v[100:103]
s_mov_b32 s25, 1573120
T a[144:145],v19,28672
T a[146:147],v19,30720
M v[100:103],v[36:39],a[96:99],v[100:103]
SA m0,s4,90112
MF v71,s5,v71
MF v84,s5,v84
M v[100:103],v[40:43],a[104:107],v[100:103]
s_waitcnt lgkmcnt(2)
T a[148:149],v15,0
T a[150:151],v15,2048
M v[100:103],v[44:47],a[112:115],v[100:103]
s_lshl_b32 s64, s42, 16
T a[152:153],v15,4096
T a[154:155],v15,6144
M v[100:103],v[48:51],a[120:123],v[100:103]
SA s23,s21,s64
buffer_load_dwordx4 v8, s[52:55], s25 offen lds
M v[100:103],v[52:55],a[128:131],v[100:103]
SA s43,s23,16777216
T a[156:157],v15,8192
T a[158:159],v15,10240
M v[100:103],v[56:59],a[136:139],v[100:103]
SA s26,s21,16777216
T a[160:161],v15,12288
T a[162:163],v15,14336
M v[108:111],v[56:59],a[140:143],v[108:111]
s_mov_b32 s25, 1835264
MF v85,s5,v85
MF v86,s5,v86
M v[108:111],v[52:55],a[132:135],v[108:111]
SA m0,s4,94208
T a[164:165],v15,16384
T a[166:167],v15,18432
M v[108:111],v[48:51],a[124:127],v[108:111]
s_mov_b32 s22, 0x7fff
T a[168:169],v15,20480
T a[170:171],v15,22528
M v[108:111],v[44:47],a[116:119],v[108:111]
s_sub_u32 s27, s42, 1
buffer_load_dwordx4 v8, s[52:55], s25 offen lds
M v[108:111],v[40:43],a[108:111],v[108:111]
s_cmp_eq_u32 s42, 0
MF v87,s5,v87
C v68,v68,v69
M v[108:111],v[36:39],a[100:103],v[108:111]
s_waitcnt vmcnt(12) lgkmcnt(0)
C v69,v70,v71
C v70,v84,v85
M v[108:111],v[32:35],a[236:239],v[108:111]
s_barrier
M v[116:119],a[144:147],a[232:235],v[116:119]
s_mov_b32 s25, 2097408
T v[32:33],v16,49152
T v[34:35],v16,51200
M v[116:119],a[148:151],a[96:99],v[116:119]
s_cselect_b32 s64, 32768, 0
C v71,v86,v87
W a0,v68
M v[116:119],a[152:155],a[104:107],v[116:119]
SA m0,s4,155648
T v[36:37],v16,53248
T v[38:39],v16,55296
M v[116:119],a[156:159],a[112:115],v[116:119]
SA s26,s26,s64
T v[40:41],v16,57344
T v[42:43],v16,59392
M v[116:119],a[160:163],a[120:123],v[116:119]
s_mov_b32 s31, 0x4b800000
buffer_load_dwordx4 v8, s[52:55], s25 offen lds
M v[116:119],a[164:167],a[128:131],v[116:119]
s_mov_b32 s24, 0x33800000
T v[44:45],v16,61440
T v[46:47],v16,63488
M v[116:119],a[168:171],a[136:139],v[116:119]
s_lshl_b32 s47, s66, 7
T v[48:49],v20,32768
T v[50:51],v20,34816
M v[124:127],a[168:171],a[140:143],v[124:127]
s_mov_b32 s25, 2359552
W a1,v69
W a2,v70
M v[124:127],a[164:167],a[132:135],v[124:127]
SA m0,s4,159744
T v[52:53],v20,36864
T v[54:55],v20,38912
M v[124:127],a[160:163],a[124:127],v[124:127]
SA s47,s47,s46
T v[56:57],v20,40960
T v[58:59],v20,43008
M v[124:127],a[156:159],a[116:119],v[124:127]
s_lshl_b32 s64, s20, 5
buffer_load_dwordx4 v8, s[52:55], s25 offen lds
M v[124:127],a[152:155],a[108:111],v[124:127]
SA s47,s47,s64
W a3,v71
MF v76,s5,v76
M v[124:127],a[148:151],a[100:103],v[124:127]
SA s47,s47,2048
MF v77,s5,v77
MF v78,s5,v78
M v[124:127],a[144:147],a[236:239],v[124:127]
s_waitcnt lgkmcnt(6)
MF v79,s5,v79
MF v92,s5,v92
M v[132:135],v[32:35],a[176:179],0
s_lshl_b32 s65, s41, 3
T a[144:145],v17,49152
T a[146:147],v17,51200
M v[132:135],v[36:39],a[184:187],v[132:135]
SA s65,s65,s66
MF v93,s5,v93
MF v94,s5,v94
M v[132:135],v[40:43],a[192:195],v[132:135]
s_waitcnt lgkmcnt(2)
T a[148:149],v17,53248
T a[150:151],v17,55296
M v[132:135],v[44:47],a[200:203],v[132:135]
s_mul_i32 s34, s65, 73728
T a[152:153],v17,57344
T a[154:155],v17,59392
M v[132:135],v[48:51],a[208:211],v[132:135]
SA s34,s34,136314880
MF v95,s5,v95
C v76,v76,v77
M v[132:135],v[52:55],a[216:219],v[132:135]
s_lshl_b32 s65, s42, 4
T a[156:157],v17,61440
T a[158:159],v17,63488
M v[132:135],v[56:59],a[224:227],v[132:135]
SA s65,s65,s41
T a[160:161],v21,32768
T a[162:163],v21,34816
M v[140:143],v[56:59],a[228:231],0
s_mul_i32 s33, s65, 114688
C v77,v78,v79
C v78,v92,v93
M v[140:143],v[52:55],a[220:223],v[140:143]
s_mul_i32 s65, s20, 28672
T a[164:165],v21,36864
T a[166:167],v21,38912
M v[140:143],v[48:51],a[212:215],v[140:143]
SA s33,s33,s65
T a[168:169],v21,40960
T a[170:171],v21,43008
M v[140:143],v[44:47],a[204:207],v[140:143]
SA s33,s33,67108864
C v79,v94,v95
W a32,v76
M v[140:143],v[40:43],a[196:199],v[140:143]
s_mov_b32 s6, 0
W a33,v77
W a34,v78
M v[140:143],v[36:39],a[188:191],v[140:143]
s_mov_b32 s7, 0
W a35,v79
MF v100,s5,v100
M v[140:143],v[32:35],a[180:183],v[140:143]
s_waitcnt lgkmcnt(6)
MF v101,s5,v101
MF v102,s5,v102
M v[148:151],a[144:147],a[176:179],0
s_mov_b32 s40, 1
T v[32:33],v18,49152
T v[34:35],v18,51200
M v[148:151],a[148:151],a[184:187],v[148:151]
s_cmp_eq_u32 s20, 0
MF v103,s5,v103
MF v116,s5,v116
M v[148:151],a[152:155],a[192:195],v[148:151]
s_waitcnt lgkmcnt(2)
T v[36:37],v18,53248
T v[38:39],v18,55296
M v[148:151],a[156:159],a[200:203],v[148:151]
s_cselect_b32 s39, 7, 0
T v[40:41],v18,57344
T v[42:43],v18,59392
M v[148:151],a[160:163],a[208:211],v[148:151]
s_lshl_b32 s64, s41, 1
MF v117,s5,v117
MF v118,s5,v118
M v[148:151],a[164:167],a[216:219],v[148:151]
SA s64,s64,s20
T v[44:45],v18,61440
T v[46:47],v18,63488
M v[148:151],a[168:171],a[224:227],v[148:151]
s_cmp_lt_u32 s64, 30
T v[48:49],v22,32768
T v[50:51],v22,34816
M v[156:159],a[168:171],a[228:231],0
s_cselect_b32 s64, 30, 0
MF v119,s5,v119
C v100,v100,v101
M v[156:159],a[164:167],a[220:223],v[156:159]
s_cmp_ge_u32 s20, 2
T v[52:53],v22,36864
T v[54:55],v22,38912
M v[156:159],a[160:163],a[212:215],v[156:159]
s_cselect_b32 s64, s64, 0
T v[56:57],v22,40960
T v[58:59],v22,43008
M v[156:159],a[156:159],a[204:207],v[156:159]
s_cmp_eq_u32 s42, 6
C v101,v102,v103
C v102,v116,v117
M v[156:159],a[152:155],a[196:199],v[156:159]
s_cselect_b32 s64, s64, 0
C v103,v118,v119
W a4,v100
M v[156:159],a[148:151],a[188:191],v[156:159]
s_or_b32 s39, s39, s64
W a5,v101
W a6,v102
M v[156:159],a[144:147],a[180:183],v[156:159]
s_waitcnt lgkmcnt(6)
W a7,v103
MF v108,s5,v108
M v[164:167],v[32:35],a[176:179],0
s_mov_b64 s[60:61], s[76:77]
T a[144:145],v19,49152
T a[146:147],v19,51200
M v[164:167],v[36:39],a[184:187],v[164:167]
s_mov_b32 s62, s78
MF v109,s5,v109
MF v110,s5,v110
M v[164:167],v[40:43],a[192:195],v[164:167]
s_waitcnt lgkmcnt(2)
T a[148:149],v19,53248
T a[150:151],v19,55296
M v[164:167],v[44:47],a[200:203],v[164:167]
s_mov_b32 s63, 0x20000
T a[152:153],v19,57344
T a[154:155],v19,59392
M v[164:167],v[48:51],a[208:211],v[164:167]
s_mov_b32 s25, 2621696
v_lshrrev_b32 v24, 4, v0
v_lshlrev_b32 v24, 2, v24
M v[164:167],v[52:55],a[216:219],v[164:167]
SA m0,s4,131072
T a[156:157],v19,61440
T a[158:159],v19,63488
M v[164:167],v[56:59],a[224:227],v[164:167]
SA s3,s93,532480
T a[160:161],v23,32768
T a[162:163],v23,34816
M v[172:175],v[56:59],a[228:231],0
buffer_load_dwordx4 v8, s[52:55], s25 offen lds
M v[172:175],v[52:55],a[220:223],v[172:175]
s_nop 0
T a[164:165],v23,36864
T a[166:167],v23,38912
M v[172:175],v[48:51],a[212:215],v[172:175]
T a[168:169],v23,40960
T a[170:171],v23,43008
M v[172:175],v[44:47],a[204:207],v[172:175]
s_mov_b32 s25, 2883840
buffer_store_dwordx4 v[96:99], v7, s[8:11], s3 offen offset:0 sc1
M v[172:175],v[40:43],a[196:199],v[172:175]
SA m0,s4,135168
v_and_b32 v25, 15, v0
v_sub_u32 v24, v24, v25
M v[172:175],v[36:39],a[188:191],v[172:175]
buffer_load_dwordx4 v8, s[52:55], s25 offen lds
M v[172:175],v[32:35],a[180:183],v[172:175]
s_waitcnt lgkmcnt(6)
v_cmp_lt_i32 s[16:17], 0, v24
v_cmp_lt_i32 s[18:19], -1, v24
M v[180:183],a[144:147],a[176:179],0
T v[32:33],v20,45056
T v[34:35],v20,47104
M v[180:183],a[148:151],a[184:187],v[180:183]
s_mov_b32 s25, 3145984
buffer_store_dwordx4 v[104:107], v7, s[8:11], s3 offen offset:1024 sc1
M v[180:183],a[152:155],a[192:195],v[180:183]
s_waitcnt lgkmcnt(2)
s_nop 0
T v[36:37],v20,49152
T v[38:39],v20,51200
M v[180:183],a[156:159],a[200:203],v[180:183]
SA m0,s4,139264
T v[40:41],v20,53248
T v[42:43],v20,55296
M v[180:183],a[160:163],a[208:211],v[180:183]
buffer_load_dwordx4 v8, s[52:55], s25 offen lds
M v[180:183],a[164:167],a[216:219],v[180:183]
s_nop 0
T v[44:45],v20,57344
T v[46:47],v20,59392
M v[180:183],a[168:171],a[224:227],v[180:183]
T v[48:49],v20,61440
T v[50:51],v20,63488
M v[188:191],a[168:171],a[228:231],0
s_mov_b32 s25, 3408128
buffer_store_dwordx4 v[112:115], v7, s[8:11], s3 offen offset:2048 sc1
M v[188:191],a[164:167],a[220:223],v[188:191]
SA m0,s4,143360
T v[52:53],v16,32768
T v[54:55],v16,34816
M v[188:191],a[160:163],a[212:215],v[188:191]
T v[56:57],v16,36864
T v[58:59],v16,38912
M v[188:191],a[156:159],a[204:207],v[188:191]
buffer_load_dwordx4 v8, s[52:55], s25 offen lds
M v[188:191],a[152:155],a[196:199],v[188:191]
v_cmp_lt_i32 s[48:49], -2, v24
v_cmp_lt_i32 s[50:51], -3, v24
M v[188:191],a[148:151],a[188:191],v[188:191]
buffer_store_dwordx4 v[120:123], v7, s[8:11], s3 offen offset:3072 sc1
M v[188:191],a[144:147],a[180:183],v[188:191]
s_waitcnt lgkmcnt(6)
v_lshl_add_u32 v25, v0, 7, s95
v_and_b32 v0, 48, v0
M v[132:135],v[32:35],a[232:235],v[132:135]
s_mov_b32 s25, 384
T a[144:145],v21,45056
T a[146:147],v21,47104
M v[132:135],v[36:39],a[96:99],v[132:135]
SA m0,s4,0
v_lshl_add_u32 v0, v0, 24, v25
v_mov_b32 v24, 0x3f80
M v[132:135],v[40:43],a[104:107],v[132:135]
s_waitcnt lgkmcnt(2)
T a[148:149],v21,49152
T a[150:151],v21,51200
M v[132:135],v[44:47],a[112:115],v[132:135]
T a[152:153],v21,53248
T a[154:155],v21,55296
M v[132:135],v[48:51],a[120:123],v[132:135]
buffer_load_dwordx4 v8, s[52:55], s25 offen lds
M v[132:135],v[52:55],a[128:131],v[132:135]
s_nop 0
T a[156:157],v21,57344
T a[158:159],v21,59392
M v[132:135],v[56:59],a[136:139],v[132:135]
T a[160:161],v21,61440
T a[162:163],v21,63488
M v[140:143],v[56:59],a[140:143],v[140:143]
s_mov_b32 s25, 262528
MF v111,s5,v111
MF v124,s5,v124
M v[140:143],v[52:55],a[132:135],v[140:143]
SA m0,s4,4096
T a[164:165],v17,32768
T a[166:167],v17,34816
M v[140:143],v[48:51],a[124:127],v[140:143]
T a[168:169],v17,36864
T a[170:171],v17,38912
M v[140:143],v[44:47],a[116:119],v[140:143]
buffer_load_dwordx4 v8, s[52:55], s25 offen lds
M v[140:143],v[40:43],a[108:111],v[140:143]
MF v125,s5,v125
MF v126,s5,v126
M v[140:143],v[36:39],a[100:103],v[140:143]
MF v127,s5,v127
C v108,v108,v109
M v[140:143],v[32:35],a[236:239],v[140:143]
s_waitcnt lgkmcnt(6)
C v109,v110,v111
C v110,v124,v125
M v[148:151],a[144:147],a[232:235],v[148:151]
s_mov_b32 s25, 524672
T v[32:33],v22,45056
T v[34:35],v22,47104
M v[148:151],a[148:151],a[96:99],v[148:151]
SA m0,s4,8192
C v111,v126,v127
W a36,v108
M v[148:151],a[152:155],a[104:107],v[148:151]
s_waitcnt lgkmcnt(2)
T v[36:37],v22,49152
T v[38:39],v22,51200
M v[148:151],a[156:159],a[112:115],v[148:151]
T v[40:41],v22,53248
T v[42:43],v22,55296
M v[148:151],a[160:163],a[120:123],v[148:151]
buffer_load_dwordx4 v8, s[52:55], s25 offen lds
M v[148:151],a[164:167],a[128:131],v[148:151]
s_nop 0
T v[44:45],v22,57344
T v[46:47],v22,59392
M v[148:151],a[168:171],a[136:139],v[148:151]
T v[48:49],v22,61440
T v[50:51],v22,63488
M v[156:159],a[168:171],a[140:143],v[156:159]
s_mov_b32 s25, 786816
W a37,v109
W a38,v110
M v[156:159],a[164:167],a[132:135],v[156:159]
SA m0,s4,12288
T v[52:53],v18,32768
T v[54:55],v18,34816
M v[156:159],a[160:163],a[124:127],v[156:159]
T v[56:57],v18,36864
T v[58:59],v18,38912
M v[156:159],a[156:159],a[116:119],v[156:159]
buffer_load_dwordx4 v8, s[52:55], s25 offen lds
M v[156:159],a[152:155],a[108:111],v[156:159]
W a39,v111
v_lshrrev_b32 v25, 8, v7
M v[156:159],a[148:151],a[100:103],v[156:159]
v_bfe_u32 v26, v7, 6, 2
v_and_b32 v27, 16, v7
v_lshlrev_b32 v27, v27, v24
v_cmp_eq_u32 vcc, v25, v26
v_and_b32 v28, 32, v7
W a244,0
v_cndmask_b32 v27, 0, v27, vcc
v_cmp_eq_u32 vcc, 0, v28
W a245,0
W a248,0
v_cndmask_b32 v25, 0, v27, vcc
v_sub_u32 v26, v27, v25
W a249,0
W a246,v25
W a247,v26
M v[156:159],a[144:147],a[236:239],v[156:159]
s_waitcnt lgkmcnt(6)
MF v132,s5,v132
MF v133,s5,v133
M v[164:167],v[32:35],a[232:235],v[164:167]
s_mov_b32 s25, 1048960
T a[144:145],v23,45056
T a[146:147],v23,47104
M v[164:167],v[36:39],a[96:99],v[164:167]
SA m0,s4,16384
MF v134,s5,v134
MF v135,s5,v135
M v[164:167],v[40:43],a[104:107],v[164:167]
s_waitcnt lgkmcnt(2)
T a[148:149],v23,49152
T a[150:151],v23,51200
M v[164:167],v[44:47],a[112:115],v[164:167]
T a[152:153],v23,53248
T a[154:155],v23,55296
M v[164:167],v[48:51],a[120:123],v[164:167]
buffer_load_dwordx4 v8, s[52:55], s25 offen lds
M v[164:167],v[52:55],a[128:131],v[164:167]
s_nop 0
T a[156:157],v23,57344
T a[158:159],v23,59392
M v[164:167],v[56:59],a[136:139],v[164:167]
T a[160:161],v23,61440
T a[162:163],v23,63488
M v[172:175],v[56:59],a[140:143],v[172:175]
s_mov_b32 s25, 1311104
MF v148,s5,v148
MF v149,s5,v149
M v[172:175],v[52:55],a[132:135],v[172:175]
SA m0,s4,20480
T a[164:165],v19,32768
T a[166:167],v19,34816
M v[172:175],v[48:51],a[124:127],v[172:175]
T a[168:169],v19,36864
T a[170:171],v19,38912
M v[172:175],v[44:47],a[116:119],v[172:175]
buffer_load_dwordx4 v8, s[52:55], s25 offen lds
M v[172:175],v[40:43],a[108:111],v[172:175]
MF v150,s5,v150
MF v151,s5,v151
M v[172:175],v[36:39],a[100:103],v[172:175]
s_waitcnt vmcnt(7) lgkmcnt(0)
C v132,v132,v133
C v133,v134,v135
M v[172:175],v[32:35],a[236:239],v[172:175]
s_barrier
M v[180:183],a[144:147],a[232:235],v[180:183]
s_mov_b32 s25, 1573248
T v[32:33],v20,0
T v[34:35],v20,2048
M v[180:183],a[148:151],a[96:99],v[180:183]
SA m0,s4,24576
C v134,v148,v149
C v135,v150,v151
M v[180:183],a[152:155],a[104:107],v[180:183]
T v[36:37],v20,4096
T v[38:39],v20,6144
M v[180:183],a[156:159],a[112:115],v[180:183]
T v[40:41],v20,8192
T v[42:43],v20,10240
M v[180:183],a[160:163],a[120:123],v[180:183]
buffer_load_dwordx4 v8, s[52:55], s25 offen lds
M v[180:183],a[164:167],a[128:131],v[180:183]
s_nop 0
T v[44:45],v20,12288
T v[46:47],v20,14336
M v[180:183],a[168:171],a[136:139],v[180:183]
T v[48:49],v20,16384
T v[50:51],v20,18432
M v[188:191],a[168:171],a[140:143],v[188:191]
s_mov_b32 s25, 1835392
W a8,v132
W a9,v133
M v[188:191],a[164:167],a[132:135],v[188:191]
SA m0,s4,28672
T v[52:53],v20,20480
T v[54:55],v20,22528
M v[188:191],a[160:163],a[124:127],v[188:191]
T v[56:57],v20,24576
T v[58:59],v20,26624
M v[188:191],a[156:159],a[116:119],v[188:191]
buffer_load_dwordx4 v8, s[52:55], s25 offen lds
M v[188:191],a[152:155],a[108:111],v[188:191]
W a10,v134
W a11,v135
M v[188:191],a[148:151],a[100:103],v[188:191]
v_lshrrev_b32 v31, 6, v7
v_bfe_u32 v28, v7, 4, 2
M v[188:191],a[144:147],a[236:239],v[188:191]
s_waitcnt lgkmcnt(6)
v_lshlrev_b32 v31, 5, v31
v_add_lshl_u32 v31, v31, v28, 2
M v[68:71],v[32:35],a[176:179],0
s_mov_b32 s25, 2097536
T a[144:145],v21,0
T a[146:147],v21,2048
M v[68:71],v[36:39],a[184:187],v[68:71]
SA m0,s4,40960
buffer_load_dword v5, v31, s[8:11], s46 offen offset:4 sc1
M v[68:71],v[40:43],a[192:195],v[68:71]
s_waitcnt lgkmcnt(2)
s_nop 0
T a[148:149],v21,4096
T a[150:151],v21,6144
M v[68:71],v[44:47],a[200:203],v[68:71]
T a[152:153],v21,8192
T a[154:155],v21,10240
M v[68:71],v[48:51],a[208:211],v[68:71]
buffer_load_dwordx4 v8, s[52:55], s25 offen lds
M v[68:71],v[52:55],a[216:219],v[68:71]
s_nop 0
T a[156:157],v21,12288
T a[158:159],v21,14336
M v[68:71],v[56:59],a[224:227],v[68:71]
T a[160:161],v21,16384
T a[162:163],v21,18432
M v[76:79],v[56:59],a[228:231],0
s_mov_b32 s25, 2359680
MF v140,s5,v140
MF v141,s5,v141
M v[76:79],v[52:55],a[220:223],v[76:79]
SA m0,s4,45056
T a[164:165],v21,20480
T a[166:167],v21,22528
M v[76:79],v[48:51],a[212:215],v[76:79]
T a[168:169],v21,24576
T a[170:171],v21,26624
M v[76:79],v[44:47],a[204:207],v[76:79]
buffer_load_dwordx4 v8, s[52:55], s25 offen lds
M v[76:79],v[40:43],a[196:199],v[76:79]
MF v142,s5,v142
MF v143,s5,v143
M v[76:79],v[36:39],a[188:191],v[76:79]
MF v156,s5,v156
MF v157,s5,v157
M v[76:79],v[32:35],a[180:183],v[76:79]
s_waitcnt lgkmcnt(6)
MF v158,s5,v158
MF v159,s5,v159
M v[84:87],a[144:147],a[176:179],0
s_mov_b32 s25, 2621824
T v[32:33],v22,0
T v[34:35],v22,2048
M v[84:87],a[148:151],a[184:187],v[84:87]
SA m0,s4,49152
C v140,v140,v141
C v141,v142,v143
M v[84:87],a[152:155],a[192:195],v[84:87]
s_waitcnt lgkmcnt(2)
T v[36:37],v22,4096
T v[38:39],v22,6144
M v[84:87],a[156:159],a[200:203],v[84:87]
SA s3,s93,262144
T v[40:41],v22,8192
T v[42:43],v22,10240
M v[84:87],a[160:163],a[208:211],v[84:87]
buffer_load_dwordx4 v8, s[52:55], s25 offen lds
M v[84:87],a[164:167],a[216:219],v[84:87]
s_nop 0
T v[44:45],v22,12288
T v[46:47],v22,14336
M v[84:87],a[168:171],a[224:227],v[84:87]
T v[48:49],v22,16384
T v[50:51],v22,18432
M v[92:95],a[168:171],a[228:231],0
s_mov_b32 s25, 2883968
buffer_store_dwordx4 v[128:131], v7, s[8:11], s3 offen offset:0 sc1
M v[92:95],a[164:167],a[220:223],v[92:95]
SA m0,s4,53248
T v[52:53],v22,20480
T v[54:55],v22,22528
M v[92:95],a[160:163],a[212:215],v[92:95]
T v[56:57],v22,24576
T v[58:59],v22,26624
M v[92:95],a[156:159],a[204:207],v[92:95]
buffer_load_dwordx4 v8, s[52:55], s25 offen lds
M v[92:95],a[152:155],a[196:199],v[92:95]
C v142,v156,v157
C v143,v158,v159
M v[92:95],a[148:151],a[188:191],v[92:95]
buffer_store_dwordx4 v[136:139], v7, s[8:11], s3 offen offset:1024 sc1
M v[92:95],a[144:147],a[180:183],v[92:95]
s_waitcnt lgkmcnt(6)
W a40,v140
W a41,v141
M v[100:103],v[32:35],a[176:179],0
s_mov_b32 s25, 3146112
T a[144:145],v23,0
T a[146:147],v23,2048
M v[100:103],v[36:39],a[184:187],v[100:103]
SA m0,s4,57344
buffer_store_dwordx4 v[144:147], v7, s[8:11], s3 offen offset:2048 sc1
M v[100:103],v[40:43],a[192:195],v[100:103]
s_waitcnt lgkmcnt(2)
s_nop 0
T a[148:149],v23,4096
T a[150:151],v23,6144
M v[100:103],v[44:47],a[200:203],v[100:103]
T a[152:153],v23,8192
T a[154:155],v23,10240
M v[100:103],v[48:51],a[208:211],v[100:103]
buffer_load_dwordx4 v8, s[52:55], s25 offen lds
M v[100:103],v[52:55],a[216:219],v[100:103]
s_nop 0
T a[156:157],v23,12288
T a[158:159],v23,14336
M v[100:103],v[56:59],a[224:227],v[100:103]
T a[160:161],v23,16384
T a[162:163],v23,18432
M v[108:111],v[56:59],a[228:231],0
s_mov_b32 s25, 3408256
buffer_store_dwordx4 v[152:155], v7, s[8:11], s3 offen offset:3072 sc1
M v[108:111],v[52:55],a[220:223],v[108:111]
SA m0,s4,61440
T a[164:165],v23,20480
T a[166:167],v23,22528
M v[108:111],v[48:51],a[212:215],v[108:111]
T a[168:169],v23,24576
T a[170:171],v23,26624
M v[108:111],v[44:47],a[204:207],v[108:111]
buffer_load_dwordx4 v8, s[52:55], s25 offen lds
M v[108:111],v[40:43],a[196:199],v[108:111]
W a42,v142
W a43,v143
M v[108:111],v[36:39],a[188:191],v[108:111]
v_mov_b32 v8, 0xff800000
MF v164,s5,v164
M v[108:111],v[32:35],a[180:183],v[108:111]
s_waitcnt lgkmcnt(6)
MF v165,s5,v165
MF v166,s5,v166
M v[116:119],a[144:147],a[176:179],0
T v[32:33],v20,28672
T v[34:35],v20,30720
M v[116:119],a[148:151],a[184:187],v[116:119]
MF v167,s5,v167
MF v180,s5,v180
M v[116:119],a[152:155],a[192:195],v[116:119]
s_waitcnt lgkmcnt(2)
T v[36:37],v12,24576
T v[38:39],v12,26624
M v[116:119],a[156:159],a[200:203],v[116:119]
T v[40:41],v12,28672
T v[42:43],v12,30720
M v[116:119],a[160:163],a[208:211],v[116:119]
MF v181,s5,v181
MF v182,s5,v182
M v[116:119],a[164:167],a[216:219],v[116:119]
T v[44:45],v12,0
T v[46:47],v12,2048
M v[116:119],a[168:171],a[224:227],v[116:119]
T v[48:49],v12,4096
T v[50:51],v12,6144
M v[124:127],a[168:171],a[228:231],0
MF v183,s5,v183
C v164,v164,v165
M v[124:127],a[164:167],a[220:223],v[124:127]
T v[52:53],v12,8192
T v[54:55],v12,10240
M v[124:127],a[160:163],a[212:215],v[124:127]
T v[56:57],v12,12288
T v[58:59],v12,14336
M v[124:127],a[156:159],a[204:207],v[124:127]
C v165,v166,v167
C v166,v180,v181
M v[124:127],a[152:155],a[196:199],v[124:127]
C v167,v182,v183
W a12,v164
M v[124:127],a[148:151],a[188:191],v[124:127]
W a13,v165
W a14,v166
M v[124:127],a[144:147],a[180:183],v[124:127]
s_waitcnt lgkmcnt(6)
W a15,v167
MF v172,s5,v172
M v[68:71],v[32:35],a[232:235],v[68:71]
T a[144:145],v21,28672
T a[146:147],v21,30720
M v[68:71],v[36:39],a[96:99],v[68:71]
MF v173,s5,v173
MF v174,s5,v174
M v[68:71],v[40:43],a[104:107],v[68:71]
s_waitcnt lgkmcnt(2)
T a[148:149],v13,24576
T a[150:151],v13,26624
M v[68:71],v[44:47],a[112:115],v[68:71]
T a[152:153],v13,28672
T a[154:155],v13,30720
M v[68:71],v[48:51],a[120:123],v[68:71]
MF v175,s5,v175
MF v188,s5,v188
M v[68:71],v[52:55],a[128:131],v[68:71]
T a[156:157],v13,0
T a[158:159],v13,2048
M v[68:71],v[56:59],a[136:139],v[68:71]
T a[160:161],v13,4096
T a[162:163],v13,6144
M v[76:79],v[56:59],a[140:143],v[76:79]
MF v189,s5,v189
MF v190,s5,v190
M v[76:79],v[52:55],a[132:135],v[76:79]
T a[164:165],v13,8192
T a[166:167],v13,10240
M v[76:79],v[48:51],a[124:127],v[76:79]
T a[168:169],v13,12288
T a[170:171],v13,14336
M v[76:79],v[44:47],a[116:119],v[76:79]
MF v191,s5,v191
C v172,v172,v173
M v[76:79],v[40:43],a[108:111],v[76:79]
C v173,v174,v175
C v174,v188,v189
M v[76:79],v[36:39],a[100:103],v[76:79]
C v175,v190,v191
W a44,v172
M v[76:79],v[32:35],a[236:239],v[76:79]
s_waitcnt lgkmcnt(6)
W a45,v173
W a46,v174
M v[84:87],a[144:147],a[232:235],v[84:87]
T v[32:33],v22,28672
T v[34:35],v22,30720
M v[84:87],a[148:151],a[96:99],v[84:87]
W a47,v175
s_waitcnt vmcnt(10)
v_cmp_ne_u32 vcc, 1, v5
M v[84:87],a[152:155],a[104:107],v[84:87]
s_waitcnt lgkmcnt(2)
T v[36:37],v14,24576
T v[38:39],v14,26624
M v[84:87],a[156:159],a[112:115],v[84:87]
s_nop 0
T v[40:41],v14,28672
T v[42:43],v14,30720
M v[84:87],a[160:163],a[120:123],v[84:87]
s_cmp_lg_u32 vcc_lo, 0
M v[84:87],a[164:167],a[128:131],v[84:87]
s_cbranch_scc1 L_wsq0
L_wrq0:
T v[44:45],v14,0
T v[46:47],v14,2048
M v[84:87],a[168:171],a[136:139],v[84:87]
SA m0,s28,98304
T v[48:49],v14,4096
T v[50:51],v14,6144
M v[92:95],a[168:171],a[140:143],v[92:95]
buffer_load_dwordx4 v3, s[8:11], s21 offen offset:0 sc1 lds
M v[92:95],a[164:167],a[132:135],v[92:95]
s_nop 0
T v[52:53],v14,8192
T v[54:55],v14,10240
M v[92:95],a[160:163],a[124:127],v[92:95]
T v[56:57],v14,12288
T v[58:59],v14,14336
M v[92:95],a[156:159],a[116:119],v[92:95]
buffer_load_dwordx4 v3, s[8:11], s21 offen offset:1024 sc1 lds
M v[92:95],a[152:155],a[108:111],v[92:95]
MF v68,s5,v68
MF v69,s5,v69
M v[92:95],a[148:151],a[100:103],v[92:95]
buffer_load_dwordx4 v3, s[8:11], s21 offen offset:2048 sc1 lds
M v[92:95],a[144:147],a[236:239],v[92:95]
s_waitcnt lgkmcnt(6)
MF v70,s5,v70
MF v71,s5,v71
M v[100:103],v[32:35],a[232:235],v[100:103]
T a[144:145],v23,28672
T a[146:147],v23,30720
M v[100:103],v[36:39],a[96:99],v[100:103]
buffer_load_dwordx4 v3, s[8:11], s21 offen offset:3072 sc1 lds
M v[100:103],v[40:43],a[104:107],v[100:103]
s_waitcnt lgkmcnt(2)
s_nop 0
T a[148:149],v15,24576
T a[150:151],v15,26624
M v[100:103],v[44:47],a[112:115],v[100:103]
SA m0,s28,102400
T a[152:153],v15,28672
T a[154:155],v15,30720
M v[100:103],v[48:51],a[120:123],v[100:103]
buffer_load_dwordx4 v4, s[8:11], s21 offen offset:0 sc1 lds
M v[100:103],v[52:55],a[128:131],v[100:103]
s_nop 0
T a[156:157],v15,0
T a[158:159],v15,2048
M v[100:103],v[56:59],a[136:139],v[100:103]
T a[160:161],v15,4096
T a[162:163],v15,6144
M v[108:111],v[56:59],a[140:143],v[108:111]
buffer_load_dwordx4 v4, s[8:11], s21 offen offset:1024 sc1 lds
M v[108:111],v[52:55],a[132:135],v[108:111]
s_nop 0
T a[164:165],v15,8192
T a[166:167],v15,10240
M v[108:111],v[48:51],a[124:127],v[108:111]
T a[168:169],v15,12288
T a[170:171],v15,14336
M v[108:111],v[44:47],a[116:119],v[108:111]
buffer_load_dwordx4 v4, s[8:11], s21 offen offset:2048 sc1 lds
M v[108:111],v[40:43],a[108:111],v[108:111]
MF v84,s5,v84
MF v85,s5,v85
M v[108:111],v[36:39],a[100:103],v[108:111]
s_waitcnt vmcnt(7) lgkmcnt(0)
buffer_load_dwordx4 v4, s[8:11], s21 offen offset:3072 sc1 lds
M v[108:111],v[32:35],a[236:239],v[108:111]
s_barrier
M v[116:119],a[144:147],a[232:235],v[116:119]
SA s21,s21,32768
T v[32:33],v16,0
T v[34:35],v16,2048
M v[116:119],a[148:151],a[96:99],v[116:119]
s_sub_u32 s22, s22, 1
MF v86,s5,v86
MF v87,s5,v87
M v[116:119],a[152:155],a[104:107],v[116:119]
s_cselect_b32 s21, s23, s21
T v[36:37],v16,4096
T v[38:39],v16,6144
M v[116:119],a[156:159],a[112:115],v[116:119]
SA m0,s28,65536
T v[40:41],v16,8192
T v[42:43],v16,10240
M v[116:119],a[160:163],a[120:123],v[116:119]
buffer_load_dwordx4 v3, s[8:11], s21 offen offset:0 sc1 lds
M v[116:119],a[164:167],a[128:131],v[116:119]
s_nop 0
T v[44:45],v16,12288
T v[46:47],v16,14336
M v[116:119],a[168:171],a[136:139],v[116:119]
T v[48:49],v16,16384
T v[50:51],v16,18432
M v[124:127],a[168:171],a[140:143],v[124:127]
buffer_load_dwordx4 v3, s[8:11], s21 offen offset:1024 sc1 lds
M v[124:127],a[164:167],a[132:135],v[124:127]
s_nop 0
T v[52:53],v16,20480
T v[54:55],v16,22528
M v[124:127],a[160:163],a[124:127],v[124:127]
T v[56:57],v16,24576
T v[58:59],v16,26624
M v[124:127],a[156:159],a[116:119],v[124:127]
buffer_load_dword v5, v31, s[8:11], s46 offen offset:4 sc1
M v[124:127],a[152:155],a[108:111],v[124:127]
buffer_load_dwordx4 v3, s[8:11], s21 offen offset:2048 sc1 lds
M v[124:127],a[148:151],a[100:103],v[124:127]
C v68,v68,v69
C v69,v70,v71
M v[124:127],a[144:147],a[236:239],v[124:127]
s_waitcnt lgkmcnt(6)
buffer_load_dwordx4 v3, s[8:11], s21 offen offset:3072 sc1 lds
M v[132:135],v[32:35],a[176:179],0
SA m0,s28,69632
T a[144:145],v17,0
T a[146:147],v17,2048
M v[132:135],v[36:39],a[184:187],v[132:135]
buffer_load_dwordx4 v4, s[8:11], s21 offen offset:0 sc1 lds
M v[132:135],v[40:43],a[192:195],v[132:135]
s_waitcnt lgkmcnt(2)
s_nop 0
T a[148:149],v17,4096
T a[150:151],v17,6144
M v[132:135],v[44:47],a[200:203],v[132:135]
T a[152:153],v17,8192
T a[154:155],v17,10240
M v[132:135],v[48:51],a[208:211],v[132:135]
buffer_load_dwordx4 v4, s[8:11], s21 offen offset:1024 sc1 lds
M v[132:135],v[52:55],a[216:219],v[132:135]
s_nop 0
T a[156:157],v17,12288
T a[158:159],v17,14336
M v[132:135],v[56:59],a[224:227],v[132:135]
T a[160:161],v17,16384
T a[162:163],v17,18432
M v[140:143],v[56:59],a[228:231],0
buffer_load_dwordx4 v4, s[8:11], s21 offen offset:2048 sc1 lds
M v[140:143],v[52:55],a[220:223],v[140:143]
s_nop 0
T a[164:165],v17,20480
T a[166:167],v17,22528
M v[140:143],v[48:51],a[212:215],v[140:143]
T a[168:169],v17,24576
T a[170:171],v17,26624
M v[140:143],v[44:47],a[204:207],v[140:143]
buffer_load_dwordx4 v4, s[8:11], s21 offen offset:3072 sc1 lds
M v[140:143],v[40:43],a[196:199],v[140:143]
SA s21,s21,32768
C v70,v84,v85
C v71,v86,v87
M v[140:143],v[36:39],a[188:191],v[140:143]
s_sub_u32 s22, s22, 1
W a16,v68
W a17,v69
M v[140:143],v[32:35],a[180:183],v[140:143]
s_waitcnt lgkmcnt(6)
W a18,v70
W a19,v71
M v[148:151],a[144:147],a[176:179],0
s_cselect_b32 s21, s23, s21
T v[32:33],v18,0
T v[34:35],v18,2048
M v[148:151],a[148:151],a[184:187],v[148:151]
MF v76,s5,v76
MF v77,s5,v77
M v[148:151],a[152:155],a[192:195],v[148:151]
s_waitcnt lgkmcnt(2)
T v[36:37],v18,4096
T v[38:39],v18,6144
M v[148:151],a[156:159],a[200:203],v[148:151]
T v[40:41],v18,8192
T v[42:43],v18,10240
M v[148:151],a[160:163],a[208:211],v[148:151]
MF v78,s5,v78
MF v79,s5,v79
M v[148:151],a[164:167],a[216:219],v[148:151]
T v[44:45],v18,12288
T v[46:47],v18,14336
M v[148:151],a[168:171],a[224:227],v[148:151]
T v[48:49],v18,16384
T v[50:51],v18,18432
M v[156:159],a[168:171],a[228:231],0
MF v92,s5,v92
MF v93,s5,v93
M v[156:159],a[164:167],a[220:223],v[156:159]
T v[52:53],v18,20480
T v[54:55],v18,22528
M v[156:159],a[160:163],a[212:215],v[156:159]
T v[56:57],v18,24576
T v[58:59],v18,26624
M v[156:159],a[156:159],a[204:207],v[156:159]
MF v94,s5,v94
MF v95,s5,v95
M v[156:159],a[152:155],a[196:199],v[156:159]
C v76,v76,v77
C v77,v78,v79
M v[156:159],a[148:151],a[188:191],v[156:159]
C v78,v92,v93
C v79,v94,v95
M v[156:159],a[144:147],a[180:183],v[156:159]
s_waitcnt lgkmcnt(6)
W a48,v76
W a49,v77
M v[164:167],v[32:35],a[176:179],0
T a[144:145],v19,0
T a[146:147],v19,2048
M v[164:167],v[36:39],a[184:187],v[164:167]
W a50,v78
W a51,v79
M v[164:167],v[40:43],a[192:195],v[164:167]
s_waitcnt lgkmcnt(2)
T a[148:149],v19,4096
T a[150:151],v19,6144
M v[164:167],v[44:47],a[200:203],v[164:167]
T a[152:153],v19,8192
T a[154:155],v19,10240
M v[164:167],v[48:51],a[208:211],v[164:167]
v_mov_b32 v30, 2
MF v100,s5,v100
M v[164:167],v[52:55],a[216:219],v[164:167]
T a[156:157],v19,12288
T a[158:159],v19,14336
M v[164:167],v[56:59],a[224:227],v[164:167]
T a[160:161],v19,16384
T a[162:163],v19,18432
M v[172:175],v[56:59],a[228:231],0
buffer_store_dword v30, v1, s[8:11], s45 offen sc1
M v[172:175],v[52:55],a[220:223],v[172:175]
s_nop 0
T a[164:165],v19,20480
T a[166:167],v19,22528
M v[172:175],v[48:51],a[212:215],v[172:175]
T a[168:169],v19,24576
T a[170:171],v19,26624
M v[172:175],v[44:47],a[204:207],v[172:175]
MF v101,s5,v101
MF v102,s5,v102
M v[172:175],v[40:43],a[196:199],v[172:175]
MF v103,s5,v103
MF v116,s5,v116
M v[172:175],v[36:39],a[188:191],v[172:175]
MF v117,s5,v117
MF v118,s5,v118
M v[172:175],v[32:35],a[180:183],v[172:175]
s_waitcnt lgkmcnt(6)
MF v119,s5,v119
C v100,v100,v101
M v[180:183],a[144:147],a[176:179],0
T v[32:33],v16,28672
T v[34:35],v16,30720
M v[180:183],a[148:151],a[184:187],v[180:183]
C v101,v102,v103
C v102,v116,v117
M v[180:183],a[152:155],a[192:195],v[180:183]
s_waitcnt lgkmcnt(2)
T v[36:37],v16,40960
T v[38:39],v16,43008
M v[180:183],a[156:159],a[200:203],v[180:183]
SA s3,s93,270336
T v[40:41],v16,45056
T v[42:43],v16,47104
M v[180:183],a[160:163],a[208:211],v[180:183]
buffer_store_dwordx4 v[160:163], v7, s[8:11], s3 offen offset:0 sc1
M v[180:183],a[164:167],a[216:219],v[180:183]
s_nop 0
T v[44:45],v16,49152
T v[46:47],v16,51200
M v[180:183],a[168:171],a[224:227],v[180:183]
T v[48:49],v16,53248
T v[50:51],v16,55296
M v[188:191],a[168:171],a[228:231],0
buffer_store_dwordx4 v[168:171], v7, s[8:11], s3 offen offset:1024 sc1
M v[188:191],a[164:167],a[220:223],v[188:191]
s_nop 0
T v[52:53],v16,57344
T v[54:55],v16,59392
M v[188:191],a[160:163],a[212:215],v[188:191]
T v[56:57],v16,61440
T v[58:59],v16,63488
M v[188:191],a[156:159],a[204:207],v[188:191]
buffer_store_dwordx4 v[176:179], v7, s[8:11], s3 offen offset:2048 sc1
M v[188:191],a[152:155],a[196:199],v[188:191]
C v103,v118,v119
W a20,v100
M v[188:191],a[148:151],a[188:191],v[188:191]
buffer_store_dwordx4 v[184:187], v7, s[8:11], s3 offen offset:3072 sc1
M v[188:191],a[144:147],a[180:183],v[188:191]
s_waitcnt lgkmcnt(6)
W a21,v101
W a22,v102
M v[132:135],v[32:35],a[232:235],v[132:135]
T a[144:145],v17,28672
T a[146:147],v17,30720
M v[132:135],v[36:39],a[96:99],v[132:135]
W a23,v103
MF v108,s5,v108
M v[132:135],v[40:43],a[104:107],v[132:135]
s_waitcnt lgkmcnt(2)
T a[148:149],v17,40960
T a[150:151],v17,43008
M v[132:135],v[44:47],a[112:115],v[132:135]
T a[152:153],v17,45056
T a[154:155],v17,47104
M v[132:135],v[48:51],a[120:123],v[132:135]
MF v109,s5,v109
MF v110,s5,v110
M v[132:135],v[52:55],a[128:131],v[132:135]
T a[156:157],v17,49152
T a[158:159],v17,51200
M v[132:135],v[56:59],a[136:139],v[132:135]
T a[160:161],v17,53248
T a[162:163],v17,55296
M v[140:143],v[56:59],a[140:143],v[140:143]
MF v111,s5,v111
MF v124,s5,v124
M v[140:143],v[52:55],a[132:135],v[140:143]
T a[164:165],v17,57344
T a[166:167],v17,59392
M v[140:143],v[48:51],a[124:127],v[140:143]
T a[168:169],v17,61440
T a[170:171],v17,63488
M v[140:143],v[44:47],a[116:119],v[140:143]
MF v125,s5,v125
MF v126,s5,v126
M v[140:143],v[40:43],a[108:111],v[140:143]
MF v127,s5,v127
C v108,v108,v109
M v[140:143],v[36:39],a[100:103],v[140:143]
C v109,v110,v111
C v110,v124,v125
M v[140:143],v[32:35],a[236:239],v[140:143]
s_waitcnt lgkmcnt(6)
C v111,v126,v127
W a52,v108
M v[148:151],a[144:147],a[232:235],v[148:151]
T v[32:33],v18,28672
T v[34:35],v18,30720
M v[148:151],a[148:151],a[96:99],v[148:151]
W a53,v109
W a54,v110
M v[148:151],a[152:155],a[104:107],v[148:151]
s_waitcnt lgkmcnt(2)
T v[36:37],v18,40960
T v[38:39],v18,43008
M v[148:151],a[156:159],a[112:115],v[148:151]
T v[40:41],v18,45056
T v[42:43],v18,47104
M v[148:151],a[160:163],a[120:123],v[148:151]
W a55,v111
s_waitcnt vmcnt(11)
v_cmp_ne_u32 vcc, 1, v5
M v[148:151],a[164:167],a[128:131],v[148:151]
s_nop 0
T v[44:45],v18,49152
T v[46:47],v18,51200
M v[148:151],a[168:171],a[136:139],v[148:151]
s_cmp_lg_u32 vcc_hi, 0
T v[48:49],v18,53248
T v[50:51],v18,55296
M v[156:159],a[168:171],a[140:143],v[156:159]
s_cbranch_scc1 L_wsr0
L_wrr0:
M v[156:159],a[164:167],a[132:135],v[156:159]
SA m0,s28,131072
T v[52:53],v18,57344
T v[54:55],v18,59392
M v[156:159],a[160:163],a[124:127],v[156:159]
T v[56:57],v18,61440
T v[58:59],v18,63488
M v[156:159],a[156:159],a[116:119],v[156:159]
buffer_load_dwordx4 v3, s[8:11], s26 offen offset:0 sc1 lds
M v[156:159],a[152:155],a[108:111],v[156:159]
MF v132,s5,v132
MF v133,s5,v133
M v[156:159],a[148:151],a[100:103],v[156:159]
buffer_load_dwordx4 v3, s[8:11], s26 offen offset:1024 sc1 lds
M v[156:159],a[144:147],a[236:239],v[156:159]
s_waitcnt lgkmcnt(6)
MF v134,s5,v134
MF v135,s5,v135
M v[164:167],v[32:35],a[232:235],v[164:167]
T a[144:145],v19,28672
T a[146:147],v19,30720
M v[164:167],v[36:39],a[96:99],v[164:167]
buffer_load_dwordx4 v3, s[8:11], s26 offen offset:2048 sc1 lds
M v[164:167],v[40:43],a[104:107],v[164:167]
s_waitcnt lgkmcnt(2)
s_nop 0
T a[148:149],v19,40960
T a[150:151],v19,43008
M v[164:167],v[44:47],a[112:115],v[164:167]
T a[152:153],v19,45056
T a[154:155],v19,47104
M v[164:167],v[48:51],a[120:123],v[164:167]
buffer_load_dwordx4 v3, s[8:11], s26 offen offset:3072 sc1 lds
M v[164:167],v[52:55],a[128:131],v[164:167]
SA m0,s28,135168
T a[156:157],v19,49152
T a[158:159],v19,51200
M v[164:167],v[56:59],a[136:139],v[164:167]
T a[160:161],v19,53248
T a[162:163],v19,55296
M v[172:175],v[56:59],a[140:143],v[172:175]
buffer_load_dwordx4 v4, s[8:11], s26 offen offset:0 sc1 lds
M v[172:175],v[52:55],a[132:135],v[172:175]
s_nop 0
T a[164:165],v19,57344
T a[166:167],v19,59392
M v[172:175],v[48:51],a[124:127],v[172:175]
T a[168:169],v19,61440
T a[170:171],v19,63488
M v[172:175],v[44:47],a[116:119],v[172:175]
buffer_load_dwordx4 v4, s[8:11], s26 offen offset:1024 sc1 lds
M v[172:175],v[40:43],a[108:111],v[172:175]
MF v148,s5,v148
MF v149,s5,v149
M v[172:175],v[36:39],a[100:103],v[172:175]
s_waitcnt lgkmcnt(0)
buffer_load_dwordx4 v4, s[8:11], s26 offen offset:2048 sc1 lds
M v[172:175],v[32:35],a[236:239],v[172:175]
s_barrier
M v[180:183],a[144:147],a[232:235],v[180:183]
R a[64:67],v2,32768
R a[68:71],v2,33792
M v[180:183],a[148:151],a[96:99],v[180:183]
buffer_load_dwordx4 v4, s[8:11], s26 offen offset:3072 sc1 lds
M v[180:183],a[152:155],a[104:107],v[180:183]
SA s26,s26,32768
MF v150,s5,v150
MF v151,s5,v151
M v[180:183],a[156:159],a[112:115],v[180:183]
R a[72:75],v2,34816
R a[76:79],v2,35840
M v[180:183],a[160:163],a[120:123],v[180:183]
C v132,v132,v133
C v133,v134,v135
M v[180:183],a[164:167],a[128:131],v[180:183]
C v134,v148,v149
C v135,v150,v151
M v[180:183],a[168:171],a[136:139],v[180:183]
R a[80:83],v2,36864
R a[84:87],v2,37888
M v[188:191],a[168:171],a[140:143],v[188:191]
W a24,v132
W a25,v133
M v[188:191],a[164:167],a[132:135],v[188:191]
W a26,v134
W a27,v135
M v[188:191],a[160:163],a[124:127],v[188:191]
R a[88:91],v2,38912
R a[92:95],v2,39936
M v[188:191],a[156:159],a[116:119],v[188:191]
MF v140,s5,v140
MF v141,s5,v141
M v[188:191],a[152:155],a[108:111],v[188:191]
MF v142,s5,v142
MF v143,s5,v143
M v[188:191],a[148:151],a[100:103],v[188:191]
MF v156,s5,v156
MF v157,s5,v157
M v[188:191],a[144:147],a[236:239],v[188:191]
s_waitcnt lgkmcnt(0)
MF v158,s5,v158
MF v159,s5,v159
C v140,v140,v141
C v141,v142,v143
C v142,v156,v157
C v143,v158,v159
W a56,v140
W a57,v141
W a58,v142
W a59,v143
s_cmp_eq_u32 s42, 0
s_cbranch_scc1 L_j0
M v[64:67],a[64:67],a[0:3],0
R a[96:99],v2,40960
R a[100:103],v2,41984
M v[64:67],a[68:71],a[4:7],v[64:67]
MF v164,s5,v164
MF v165,s5,v165
M v[64:67],a[72:75],a[8:11],v[64:67]
MF v166,s5,v166
MF v167,s5,v167
M v[64:67],a[76:79],a[12:15],v[64:67]
R a[104:107],v2,43008
R a[108:111],v2,44032
M v[64:67],a[80:83],a[16:19],v[64:67]
MF v180,s5,v180
MF v181,s5,v181
MF v182,s5,v182
MF v183,s5,v183
C v164,v164,v165
C v165,v166,v167
C v166,v180,v181
C v167,v182,v183
W a28,v164
W a29,v165
W a30,v166
W a31,v167
M v[64:67],a[84:87],a[20:23],v[64:67]
MF v172,s5,v172
MF v173,s5,v173
M v[64:67],a[88:91],a[24:27],v[64:67]
R a[112:115],v2,45056
R a[116:119],v2,46080
M v[64:67],a[92:95],a[28:31],v[64:67]
MF v174,s5,v174
MF v175,s5,v175
M v[68:71],a[64:67],a[32:35],0
MF v188,s5,v188
MF v189,s5,v189
M v[68:71],a[68:71],a[36:39],v[68:71]
R a[120:123],v2,47104
R a[124:127],v2,48128
M v[68:71],a[72:75],a[40:43],v[68:71]
SA m0,s28,32768
MF v190,s5,v190
MF v191,s5,v191
M v[68:71],a[76:79],a[44:47],v[68:71]
buffer_load_dwordx4 v3, s[8:11], s26 offen offset:0 sc1 lds
M v[68:71],a[80:83],a[48:51],v[68:71]
C v172,v172,v173
C v173,v174,v175
C v174,v188,v189
C v175,v190,v191
W a60,v172
W a61,v173
W a62,v174
W a63,v175
M v[68:71],a[84:87],a[52:55],v[68:71]
E v18,v64
M v[68:71],a[88:91],a[56:59],v[68:71]
M v[68:71],a[92:95],a[60:63],v[68:71]
s_waitcnt lgkmcnt(0)
buffer_load_dwordx4 v3, s[8:11], s26 offen offset:1024 sc1 lds
M v[72:75],a[96:99],a[0:3],0
R a[64:67],v2,49152
R a[68:71],v2,50176
M v[72:75],a[100:103],a[4:7],v[72:75]
E v19,v65
M v[72:75],a[104:107],a[8:11],v[72:75]
E v20,v66
M v[72:75],a[108:111],a[12:15],v[72:75]
R a[72:75],v2,51200
R a[76:79],v2,52224
M v[72:75],a[112:115],a[16:19],v[72:75]
buffer_load_dwordx4 v3, s[8:11], s26 offen offset:2048 sc1 lds
M v[72:75],a[116:119],a[20:23],v[72:75]
E v21,v67
M v[72:75],a[120:123],a[24:27],v[72:75]
R a[80:83],v2,53248
R a[84:87],v2,54272
M v[72:75],a[124:127],a[28:31],v[72:75]
buffer_load_dwordx4 v3, s[8:11], s26 offen offset:3072 sc1 lds
M v[76:79],a[124:127],a[60:63],0
SA m0,s28,36864
E v22,v68
M v[76:79],a[120:123],a[56:59],v[76:79]
R a[88:91],v2,55296
R a[92:95],v2,56320
M v[76:79],a[116:119],a[52:55],v[76:79]
buffer_load_dwordx4 v4, s[8:11], s26 offen offset:0 sc1 lds
M v[76:79],a[112:115],a[48:51],v[76:79]
E v23,v69
M v[76:79],a[108:111],a[44:47],v[76:79]
AF v26,v18,v19
C v40,v18,v19
M v[76:79],a[104:107],a[40:43],v[76:79]
buffer_load_dwordx4 v4, s[8:11], s26 offen offset:1024 sc1 lds
M v[76:79],a[100:103],a[36:39],v[76:79]
v_add_u32 v16, 0x20000, v7
AF v26,v20,v26
M v[76:79],a[96:99],a[32:35],v[76:79]
s_waitcnt lgkmcnt(0)
E v24,v70
M v[80:83],a[64:67],a[0:3],0
R a[96:99],v2,57344
R a[100:103],v2,58368
M v[80:83],a[68:71],a[4:7],v[80:83]
buffer_load_dwordx4 v4, s[8:11], s26 offen offset:2048 sc1 lds
M v[80:83],a[72:75],a[8:11],v[80:83]
SA s3,s93,786432
E v25,v71
M v[80:83],a[76:79],a[12:15],v[80:83]
R a[104:107],v2,59392
R a[108:111],v2,60416
M v[80:83],a[80:83],a[16:19],v[80:83]
buffer_load_dwordx4 v4, s[8:11], s26 offen offset:3072 sc1 lds
M v[80:83],a[84:87],a[20:23],v[80:83]
SA s26,s26,32768
E v18,v72
M v[80:83],a[88:91],a[24:27],v[80:83]
R a[112:115],v2,61440
R a[116:119],v2,62464
M v[80:83],a[92:95],a[28:31],v[80:83]
buffer_store_dwordx4 v[192:195], v7, s[8:11], s3 offen offset:0 sc1
M v[84:87],a[92:95],a[60:63],0
E v19,v73
M v[84:87],a[88:91],a[56:59],v[84:87]
R a[120:123],v2,63488
R a[124:127],v2,64512
M v[84:87],a[84:87],a[52:55],v[84:87]
C v41,v20,v21
AF v26,v21,v26
M v[84:87],a[80:83],a[48:51],v[84:87]
buffer_store_dwordx4 v[200:203], v7, s[8:11], s3 offen offset:1024 sc1
M v[84:87],a[76:79],a[44:47],v[84:87]
E v20,v74
M v[84:87],a[72:75],a[40:43],v[84:87]
AF v27,v22,v23
C v44,v22,v23
M v[84:87],a[68:71],a[36:39],v[84:87]
s_waitcnt vmcnt(23) lgkmcnt(0)
E v21,v75
M v[84:87],a[64:67],a[32:35],v[84:87]
s_barrier
M v[88:91],a[96:99],a[0:3],0
R a[64:67],v2,0
R a[68:71],v2,1024
M v[88:91],a[100:103],a[4:7],v[88:91]
E v22,v76
M v[88:91],a[104:107],a[8:11],v[88:91]
AF v27,v24,v27
C v45,v24,v25
M v[88:91],a[108:111],a[12:15],v[88:91]
R a[72:75],v2,2048
R a[76:79],v2,3072
M v[88:91],a[112:115],a[16:19],v[88:91]
buffer_store_dwordx4 v[208:211], v7, s[8:11], s3 offen offset:2048 sc1
M v[88:91],a[116:119],a[20:23],v[88:91]
E v23,v77
M v[88:91],a[120:123],a[24:27],v[88:91]
R a[80:83],v2,4096
R a[84:87],v2,5120
M v[88:91],a[124:127],a[28:31],v[88:91]
AF v27,v25,v27
AF v26,v18,v26
M v[92:95],a[124:127],a[60:63],0
E v24,v78
M v[92:95],a[120:123],a[56:59],v[92:95]
R a[88:91],v2,6144
R a[92:95],v2,7168
M v[92:95],a[116:119],a[52:55],v[92:95]
E v25,v79
M v[92:95],a[112:115],a[48:51],v[92:95]
C v42,v18,v19
AF v26,v19,v26
M v[92:95],a[108:111],a[44:47],v[92:95]
AF v26,v20,v26
C v43,v20,v21
M v[92:95],a[104:107],a[40:43],v[92:95]
AF v26,v21,v26
AF v27,v22,v27
M v[92:95],a[100:103],a[36:39],v[92:95]
s_waitcnt lgkmcnt(0)
C v46,v22,v23
AF v27,v23,v27
M v[92:95],a[96:99],a[32:35],v[92:95]
AF v27,v24,v27
C v47,v24,v25
AF v27,v25,v27
M v[96:99],a[64:67],a[0:3],0
R a[96:99],v2,8192
R a[100:103],v2,9216
M v[96:99],a[68:71],a[4:7],v[96:99]
SA m0,s28,98304
E v18,v80
M v[96:99],a[72:75],a[8:11],v[96:99]
buffer_load_dwordx4 v3, s[8:11], s21 offen offset:0 sc1 lds
M v[96:99],a[76:79],a[12:15],v[96:99]
R a[104:107],v2,10240
R a[108:111],v2,11264
M v[96:99],a[80:83],a[16:19],v[96:99]
v_mov_b32 v30, 0
M v[96:99],a[84:87],a[20:23],v[96:99]
E v19,v81
M v[96:99],a[88:91],a[24:27],v[96:99]
R a[112:115],v2,12288
R a[116:119],v2,13312
M v[96:99],a[92:95],a[28:31],v[96:99]
buffer_load_dwordx4 v3, s[8:11], s21 offen offset:1024 sc1 lds
M v[100:103],a[92:95],a[60:63],0
v_mov_b32 v31, 0
AF v26,v18,v26
M v[100:103],a[88:91],a[56:59],v[100:103]
R a[120:123],v2,14336
R a[124:127],v2,15360
M v[100:103],a[84:87],a[52:55],v[100:103]
E v20,v82
M v[100:103],a[80:83],a[48:51],v[100:103]
buffer_load_dwordx4 v3, s[8:11], s21 offen offset:2048 sc1 lds
M v[100:103],a[76:79],a[44:47],v[100:103]
E v21,v83
M v[100:103],a[72:75],a[40:43],v[100:103]
v_mov_b32 v32, 0
C v56,v18,v19
M v[100:103],a[68:71],a[36:39],v[100:103]
E v22,v88
M v[100:103],a[64:67],a[32:35],v[100:103]
s_waitcnt lgkmcnt(0)
buffer_load_dwordx4 v3, s[8:11], s21 offen offset:3072 sc1 lds
M v[104:107],a[96:99],a[0:3],0
SA m0,s28,102400
R a[64:67],v2,16384
R a[68:71],v2,17408
M v[104:107],a[100:103],a[4:7],v[104:107]
v_mov_b32 v33, 0
AF v26,v19,v26
M v[104:107],a[104:107],a[8:11],v[104:107]
E v23,v89
M v[104:107],a[108:111],a[12:15],v[104:107]
R a[72:75],v2,18432
R a[76:79],v2,19456
M v[104:107],a[112:115],a[16:19],v[104:107]
buffer_load_dwordx4 v4, s[8:11], s21 offen offset:0 sc1 lds
M v[104:107],a[116:119],a[20:23],v[104:107]
E v24,v90
M v[104:107],a[120:123],a[24:27],v[104:107]
R a[80:83],v2,20480
R a[84:87],v2,21504
M v[104:107],a[124:127],a[28:31],v[104:107]
buffer_load_dwordx4 v4, s[8:11], s21 offen offset:1024 sc1 lds
M v[108:111],a[124:127],a[60:63],0
v_mov_b32 v34, 0
AF v26,v20,v26
M v[108:111],a[120:123],a[56:59],v[108:111]
R a[88:91],v2,22528
R a[92:95],v2,23552
M v[108:111],a[116:119],a[52:55],v[108:111]
buffer_load_dwordx4 v4, s[8:11], s21 offen offset:2048 sc1 lds
M v[108:111],a[112:115],a[48:51],v[108:111]
v_mov_b32 v35, 0
C v57,v20,v21
M v[108:111],a[108:111],a[44:47],v[108:111]
E v25,v91
M v[108:111],a[104:107],a[40:43],v[108:111]
E v18,v84
M v[108:111],a[100:103],a[36:39],v[108:111]
buffer_load_dwordx4 v4, s[8:11], s21 offen offset:3072 sc1 lds
M v[108:111],a[96:99],a[32:35],v[108:111]
s_waitcnt lgkmcnt(0)
v_mov_b32 v36, 0
AF v26,v21,v26
M v[112:115],a[64:67],a[0:3],0
SA s21,s21,32768
R a[96:99],v2,24576
R a[100:103],v2,25600
M v[112:115],a[68:71],a[4:7],v[112:115]
s_sub_u32 s22, s22, 1
E v19,v85
M v[112:115],a[72:75],a[8:11],v[112:115]
s_cselect_b32 s21, s23, s21
E v20,v86
M v[112:115],a[76:79],a[12:15],v[112:115]
SA s3,s93,786432
R a[104:107],v2,26624
R a[108:111],v2,27648
M v[112:115],a[80:83],a[16:19],v[112:115]
buffer_store_dwordx4 v[216:219], v7, s[8:11], s3 offen offset:3072 sc1
M v[112:115],a[84:87],a[20:23],v[112:115]
v_mov_b32 v37, 0
AF v26,v22,v26
M v[112:115],a[88:91],a[24:27],v[112:115]
R a[112:115],v2,28672
R a[116:119],v2,29696
M v[112:115],a[92:95],a[28:31],v[112:115]
E v21,v87
M v[116:119],a[92:95],a[60:63],0
v_mov_b32 v38, 0
C v58,v22,v23
M v[116:119],a[88:91],a[56:59],v[116:119]
SA s3,s93,794624
R a[120:123],v2,30720
R a[124:127],v2,31744
M v[116:119],a[84:87],a[52:55],v[116:119]
buffer_store_dwordx4 v[224:227], v7, s[8:11], s3 offen offset:0 sc1
M v[116:119],a[80:83],a[48:51],v[116:119]
AF v26,v23,v26
AF v26,v24,v26
M v[116:119],a[76:79],a[44:47],v[116:119]
E v22,v92
M v[116:119],a[72:75],a[40:43],v[116:119]
v_mov_b32 v39, 0
C v59,v24,v25
M v[116:119],a[68:71],a[36:39],v[116:119]
s_waitcnt vmcnt(21) lgkmcnt(0)
E v23,v93
M v[116:119],a[64:67],a[32:35],v[116:119]
s_barrier
M v[120:123],a[96:99],a[0:3],0
R a[64:67],v16,0
R a[68:71],v16,1024
M v[120:123],a[100:103],a[4:7],v[120:123]
AF v26,v25,v26
AF v27,v18,v27
M v[120:123],a[104:107],a[8:11],v[120:123]
E v24,v94
M v[120:123],a[108:111],a[12:15],v[120:123]
R a[72:75],v16,2048
R a[76:79],v16,3072
M v[120:123],a[112:115],a[16:19],v[120:123]
buffer_store_dwordx4 v[232:235], v7, s[8:11], s3 offen offset:1024 sc1
M v[120:123],a[116:119],a[20:23],v[120:123]
E v25,v95
M v[120:123],a[120:123],a[24:27],v[120:123]
R a[80:83],v16,4096
R a[84:87],v16,5120
M v[120:123],a[124:127],a[28:31],v[120:123]
C v60,v18,v19
AF v27,v19,v27
M v[124:127],a[124:127],a[60:63],0
AF v27,v20,v27
C v61,v20,v21
M v[124:127],a[120:123],a[56:59],v[124:127]
R a[88:91],v16,6144
R a[92:95],v16,7168
M v[124:127],a[116:119],a[52:55],v[124:127]
AF v27,v21,v27
AF v27,v22,v27
M v[124:127],a[112:115],a[48:51],v[124:127]
C v62,v22,v23
AF v27,v23,v27
M v[124:127],a[108:111],a[44:47],v[124:127]
AF v27,v24,v27
C v63,v24,v25
M v[124:127],a[104:107],a[40:43],v[124:127]
AF v27,v25,v27
M v[124:127],a[100:103],a[36:39],v[124:127]
s_waitcnt lgkmcnt(0)
M v[124:127],a[96:99],a[32:35],v[124:127]
v_max_f32 v10, v26, v27
v_min_f32 v11, v26, v27
v_cmp_lt_f32 vcc, s31, v10
v_cmp_gt_f32 s[64:65], s24, v11
s_nop 0
s_or_b64 vcc, vcc, s[64:65]
s_cbranch_vccnz L_stk1
L_rtk1:
M v[128:131],a[64:67],v[40:43],0
R a[96:99],v16,8192
R a[100:103],v16,9216
M v[128:131],a[68:71],v[56:59],v[128:131]
SA m0,s28,65536
E v18,v96
M v[132:135],a[68:71],v[60:63],0
buffer_load_dwordx4 v3, s[8:11], s21 offen offset:0 sc1 lds
M v[132:135],a[64:67],v[44:47],v[132:135]
R a[104:107],v16,10240
R a[108:111],v16,11264
M v[136:139],a[72:75],v[40:43],0
SA s3,s93,794624
E v19,v97
M v[136:139],a[76:79],v[56:59],v[136:139]
AF v30,v26,v30
AF v31,v27,v31
M v[140:143],a[76:79],v[60:63],0
R a[112:115],v16,12288
R a[116:119],v16,13312
M v[140:143],a[72:75],v[44:47],v[140:143]
buffer_load_dwordx4 v3, s[8:11], s21 offen offset:1024 sc1 lds
M v[144:147],a[80:83],v[40:43],0
E v20,v98
M v[144:147],a[84:87],v[56:59],v[144:147]
R a[120:123],v16,14336
R a[124:127],v16,15360
M v[148:151],a[84:87],v[60:63],0
buffer_store_dwordx4 v[240:243], v7, s[8:11], s3 offen offset:2048 sc1
M v[148:151],a[80:83],v[44:47],v[148:151]
E v21,v99
M v[152:155],a[88:91],v[40:43],0
AF v28,v18,v19
C v48,v18,v19
M v[152:155],a[92:95],v[56:59],v[152:155]
buffer_load_dwordx4 v3, s[8:11], s21 offen offset:2048 sc1 lds
M v[156:159],a[92:95],v[60:63],0
AF v28,v20,v28
C v49,v20,v21
M v[156:159],a[88:91],v[44:47],v[156:159]
s_waitcnt lgkmcnt(0)
E v22,v104
M v[160:163],a[96:99],v[40:43],0
R a[64:67],v16,16384
R a[68:71],v16,17408
M v[160:163],a[100:103],v[56:59],v[160:163]
buffer_load_dwordx4 v3, s[8:11], s21 offen offset:3072 sc1 lds
M v[164:167],a[100:103],v[60:63],0
SA m0,s28,69632
E v23,v105
M v[164:167],a[96:99],v[44:47],v[164:167]
R a[72:75],v16,18432
R a[76:79],v16,19456
M v[168:171],a[104:107],v[40:43],0
buffer_load_dwordx4 v4, s[8:11], s21 offen offset:0 sc1 lds
M v[168:171],a[108:111],v[56:59],v[168:171]
AF v28,v21,v28
AF v28,v22,v28
M v[172:175],a[108:111],v[60:63],0
R a[80:83],v16,20480
R a[84:87],v16,21504
M v[172:175],a[104:107],v[44:47],v[172:175]
buffer_store_dwordx4 v[248:251], v7, s[8:11], s3 offen offset:3072 sc1
M v[176:179],a[112:115],v[40:43],0
E v24,v106
M v[176:179],a[116:119],v[56:59],v[176:179]
R a[88:91],v16,22528
R a[92:95],v16,23552
M v[180:183],a[116:119],v[60:63],0
buffer_load_dwordx4 v4, s[8:11], s21 offen offset:1024 sc1 lds
M v[180:183],a[112:115],v[44:47],v[180:183]
E v25,v107
M v[184:187],a[120:123],v[40:43],0
C v50,v22,v23
AF v28,v23,v28
M v[184:187],a[124:127],v[56:59],v[184:187]
buffer_load_dwordx4 v4, s[8:11], s21 offen offset:2048 sc1 lds
M v[188:191],a[124:127],v[60:63],0
E v18,v100
M v[188:191],a[120:123],v[44:47],v[188:191]
s_waitcnt lgkmcnt(0)
AF v28,v24,v28
C v51,v24,v25
M v[192:195],a[64:67],v[40:43],0
R a[96:99],v16,24576
R a[100:103],v16,25600
M v[192:195],a[68:71],v[56:59],v[192:195]
buffer_load_dwordx4 v4, s[8:11], s21 offen offset:3072 sc1 lds
M v[196:199],a[68:71],v[60:63],0
SA s21,s21,32768
E v19,v101
M v[196:199],a[64:67],v[44:47],v[196:199]
s_sub_u32 s22, s22, 1
R a[104:107],v16,26624
R a[108:111],v16,27648
M v[200:203],a[72:75],v[40:43],0
s_cselect_b32 s21, s23, s21
AF v28,v25,v28
AF v29,v18,v19
M v[200:203],a[76:79],v[56:59],v[200:203]
E v20,v102
M v[204:207],a[76:79],v[60:63],0
R a[112:115],v16,28672
R a[116:119],v16,29696
M v[204:207],a[72:75],v[44:47],v[204:207]
C v52,v18,v19
M v[208:211],a[80:83],v[40:43],0
M v[208:211],a[84:87],v[56:59],v[208:211]
R a[120:123],v16,30720
R a[124:127],v16,31744
M v[212:215],a[84:87],v[60:63],0
E v21,v103
M v[212:215],a[80:83],v[44:47],v[212:215]
AF v29,v20,v29
C v53,v20,v21
M v[216:219],a[88:91],v[40:43],0
AF v29,v21,v29
M v[216:219],a[92:95],v[56:59],v[216:219]
E v22,v108
M v[220:223],a[92:95],v[60:63],0
s_waitcnt vmcnt(13) lgkmcnt(0)
M v[220:223],a[88:91],v[44:47],v[220:223]
s_barrier
M v[224:227],a[96:99],v[40:43],0
R a[64:67],v2,32768
R a[68:71],v2,33792
M v[224:227],a[100:103],v[56:59],v[224:227]
E v23,v109
M v[228:231],a[100:103],v[60:63],0
AF v29,v22,v29
C v54,v22,v23
M v[228:231],a[96:99],v[44:47],v[228:231]
R a[72:75],v2,34816
R a[76:79],v2,35840
M v[232:235],a[104:107],v[40:43],0
E v24,v110
M v[232:235],a[108:111],v[56:59],v[232:235]
AF v29,v23,v29
M v[236:239],a[108:111],v[60:63],0
R a[80:83],v2,36864
R a[84:87],v2,37888
M v[236:239],a[104:107],v[44:47],v[236:239]
M v[240:243],a[112:115],v[40:43],0
E v25,v111
M v[240:243],a[116:119],v[56:59],v[240:243]
R a[88:91],v2,38912
R a[92:95],v2,39936
M v[244:247],a[116:119],v[60:63],0
AF v29,v24,v29
C v55,v24,v25
M v[244:247],a[112:115],v[44:47],v[244:247]
AF v29,v25,v29
M v[248:251],a[120:123],v[40:43],0
M v[248:251],a[124:127],v[56:59],v[248:251]
M v[252:255],a[124:127],v[60:63],0
s_waitcnt lgkmcnt(0)
M v[252:255],a[120:123],v[44:47],v[252:255]
s_cmp_lg_u32 s27, 0
s_cbranch_scc1 L_loop_top
s_branch L_d1s
L_j0:
M v[68:71],a[64:67],a[32:35],0
s_cmp_lt_u32 s20, 0
R a[96:99],v2,40960
R a[100:103],v2,41984
M v[68:71],a[68:71],a[36:39],v[68:71]
s_cselect_b64 s[82:83], -1, 0
v_mov_b32 v30, 0
MF v172,s5,v172
M v[68:71],a[72:75],a[40:43],v[68:71]
s_cmp_eq_u32 s20, 0
MF v173,s5,v173
MF v174,s5,v174
M v[68:71],a[76:79],a[44:47],v[68:71]
s_cselect_b64 s[66:67], s[16:17], s[82:83]
R a[104:107],v2,43008
R a[108:111],v2,44032
M v[68:71],a[80:83],a[48:51],v[68:71]
s_cselect_b64 s[68:69], s[18:19], s[82:83]
MF v175,s5,v175
MF v188,s5,v188
M v[68:71],a[84:87],a[52:55],v[68:71]
s_cselect_b64 s[70:71], s[48:49], s[82:83]
MF v189,s5,v189
MF v190,s5,v190
MF v191,s5,v191
C v172,v172,v173
C v173,v174,v175
C v174,v188,v189
C v175,v190,v191
W a60,v172
W a61,v173
W a62,v174
W a63,v175
M v[68:71],a[88:91],a[56:59],v[68:71]
s_cselect_b64 s[72:73], s[50:51], s[82:83]
R a[112:115],v2,45056
R a[116:119],v2,46080
v_cndmask_b32 v64, 0, v8, s[66:67]
v_cndmask_b32 v65, 0, v8, s[68:69]
v_cndmask_b32 v66, 0, v8, s[70:71]
v_cndmask_b32 v67, 0, v8, s[72:73]
M v[68:71],a[92:95],a[60:63],v[68:71]
s_cmp_lt_u32 s20, 1
MF v164,s5,v164
MF v165,s5,v165
M v[64:67],a[64:67],a[0:3],v[64:67]
s_cselect_b64 s[82:83], -1, 0
MF v166,s5,v166
MF v167,s5,v167
M v[64:67],a[68:71],a[4:7],v[64:67]
s_cmp_eq_u32 s20, 1
R a[120:123],v2,47104
R a[124:127],v2,48128
M v[64:67],a[72:75],a[8:11],v[64:67]
s_cselect_b64 s[74:75], s[16:17], s[82:83]
MF v180,s5,v180
MF v181,s5,v181
M v[64:67],a[76:79],a[12:15],v[64:67]
s_cselect_b64 s[76:77], s[18:19], s[82:83]
MF v182,s5,v182
MF v183,s5,v183
M v[64:67],a[80:83],a[16:19],v[64:67]
s_cselect_b64 s[78:79], s[48:49], s[82:83]
C v164,v164,v165
C v165,v166,v167
C v166,v180,v181
C v167,v182,v183
W a28,v164
W a29,v165
W a30,v166
W a31,v167
M v[64:67],a[84:87],a[20:23],v[64:67]
s_cselect_b64 s[80:81], s[50:51], s[82:83]
v_mov_b32 v31, 0
v_cndmask_b32 v72, 0, v8, s[74:75]
M v[64:67],a[88:91],a[24:27],v[64:67]
s_mov_b32 s26, s43
v_mov_b32 v32, 0
M v[64:67],a[92:95],a[28:31],v[64:67]
s_waitcnt lgkmcnt(0)
v_cndmask_b32 v73, 0, v8, s[76:77]
M v[76:79],a[96:99],a[32:35],0
SA m0,s28,0
R a[64:67],v2,49152
R a[68:71],v2,50176
M v[76:79],a[100:103],a[36:39],v[76:79]
SA s3,s93,786432
buffer_load_dwordx4 v3, s[8:11], s26 offen offset:0 sc1 lds
M v[76:79],a[104:107],a[40:43],v[76:79]
v_cndmask_b32 v74, 0, v8, s[78:79]
v_mov_b32 v33, 0
M v[76:79],a[108:111],a[44:47],v[76:79]
R a[72:75],v2,51200
R a[76:79],v2,52224
M v[76:79],a[112:115],a[48:51],v[76:79]
buffer_store_dwordx4 v[192:195], v7, s[8:11], s3 offen offset:0 sc1
M v[76:79],a[116:119],a[52:55],v[76:79]
v_cndmask_b32 v75, 0, v8, s[80:81]
M v[76:79],a[120:123],a[56:59],v[76:79]
s_cmp_lt_u32 s20, 2
R a[80:83],v2,53248
R a[84:87],v2,54272
M v[76:79],a[124:127],a[60:63],v[76:79]
s_cselect_b64 s[82:83], -1, 0
buffer_load_dwordx4 v3, s[8:11], s26 offen offset:1024 sc1 lds
M v[72:75],a[124:127],a[28:31],v[72:75]
s_cmp_eq_u32 s20, 2
E v18,v68
M v[72:75],a[120:123],a[24:27],v[72:75]
s_cselect_b64 s[66:67], s[16:17], s[82:83]
R a[88:91],v2,55296
R a[92:95],v2,56320
M v[72:75],a[116:119],a[20:23],v[72:75]
s_cselect_b64 s[68:69], s[18:19], s[82:83]
buffer_load_dwordx4 v3, s[8:11], s26 offen offset:2048 sc1 lds
M v[72:75],a[112:115],a[16:19],v[72:75]
s_cselect_b64 s[70:71], s[48:49], s[82:83]
v_mov_b32 v34, 0
M v[72:75],a[108:111],a[12:15],v[72:75]
s_cselect_b64 s[72:73], s[50:51], s[82:83]
v_cndmask_b32 v80, 0, v8, s[66:67]
v_cndmask_b32 v81, 0, v8, s[68:69]
M v[72:75],a[104:107],a[8:11],v[72:75]
buffer_store_dwordx4 v[200:203], v7, s[8:11], s3 offen offset:1024 sc1
M v[72:75],a[100:103],a[4:7],v[72:75]
E v19,v69
M v[72:75],a[96:99],a[0:3],v[72:75]
s_waitcnt lgkmcnt(0)
buffer_load_dwordx4 v3, s[8:11], s26 offen offset:3072 sc1 lds
M v[84:87],a[64:67],a[32:35],0
SA m0,s28,4096
R a[96:99],v2,57344
R a[100:103],v2,58368
M v[84:87],a[68:71],a[36:39],v[84:87]
v_cndmask_b32 v82, 0, v8, s[70:71]
v_mov_b32 v35, 0
M v[84:87],a[72:75],a[40:43],v[84:87]
buffer_load_dwordx4 v4, s[8:11], s26 offen offset:0 sc1 lds
M v[84:87],a[76:79],a[44:47],v[84:87]
R a[104:107],v2,59392
R a[108:111],v2,60416
M v[84:87],a[80:83],a[48:51],v[84:87]
buffer_store_dwordx4 v[208:211], v7, s[8:11], s3 offen offset:2048 sc1
M v[84:87],a[84:87],a[52:55],v[84:87]
v_cndmask_b32 v83, 0, v8, s[72:73]
v_mov_b32 v36, 0
M v[84:87],a[88:91],a[56:59],v[84:87]
s_cmp_lt_u32 s20, 3
R a[112:115],v2,61440
R a[116:119],v2,62464
M v[84:87],a[92:95],a[60:63],v[84:87]
s_cselect_b64 s[82:83], -1, 0
buffer_load_dwordx4 v4, s[8:11], s26 offen offset:1024 sc1 lds
M v[80:83],a[92:95],a[28:31],v[80:83]
s_cmp_eq_u32 s20, 3
E v20,v70
M v[80:83],a[88:91],a[24:27],v[80:83]
s_cselect_b64 s[74:75], s[16:17], s[82:83]
R a[120:123],v2,63488
R a[124:127],v2,64512
M v[80:83],a[84:87],a[20:23],v[80:83]
s_cselect_b64 s[76:77], s[18:19], s[82:83]
buffer_load_dwordx4 v4, s[8:11], s26 offen offset:2048 sc1 lds
M v[80:83],a[80:83],a[16:19],v[80:83]
s_cselect_b64 s[78:79], s[48:49], s[82:83]
E v21,v71
M v[80:83],a[76:79],a[12:15],v[80:83]
s_cselect_b64 s[80:81], s[50:51], s[82:83]
buffer_store_dwordx4 v[216:219], v7, s[8:11], s3 offen offset:3072 sc1
M v[80:83],a[72:75],a[8:11],v[80:83]
SA s3,s93,794624
v_cndmask_b32 v88, 0, v8, s[74:75]
v_cndmask_b32 v89, 0, v8, s[76:77]
M v[80:83],a[68:71],a[4:7],v[80:83]
s_waitcnt vmcnt(24) lgkmcnt(0)
buffer_load_dwordx4 v4, s[8:11], s26 offen offset:3072 sc1 lds
M v[80:83],a[64:67],a[0:3],v[80:83]
s_barrier
M v[92:95],a[96:99],a[32:35],0
R a[64:67],v2,0
R a[68:71],v2,1024
M v[92:95],a[100:103],a[36:39],v[92:95]
buffer_store_dwordx4 v[224:227], v7, s[8:11], s3 offen offset:0 sc1
M v[92:95],a[104:107],a[40:43],v[92:95]
v_min_u32 v17, 896, v9
v_cndmask_b32 v90, 0, v8, s[78:79]
M v[92:95],a[108:111],a[44:47],v[92:95]
R a[72:75],v2,2048
R a[76:79],v2,3072
M v[92:95],a[112:115],a[48:51],v[92:95]
buffer_load_dword v5, v17, s[8:11], s46 offen sc1
M v[92:95],a[116:119],a[52:55],v[92:95]
buffer_store_dwordx4 v[232:235], v7, s[8:11], s3 offen offset:1024 sc1
M v[92:95],a[120:123],a[56:59],v[92:95]
R a[80:83],v2,4096
R a[84:87],v2,5120
v_cndmask_b32 v91, 0, v8, s[80:81]
M v[92:95],a[124:127],a[60:63],v[92:95]
v_mov_b32 v37, 0
v_mov_b32 v38, 0
M v[88:91],a[124:127],a[28:31],v[88:91]
buffer_store_dwordx4 v[240:243], v7, s[8:11], s3 offen offset:2048 sc1
M v[88:91],a[120:123],a[24:27],v[88:91]
R a[88:91],v2,6144
R a[92:95],v2,7168
M v[88:91],a[116:119],a[20:23],v[88:91]
v_mov_b32 v39, 0
AF v27,v18,v19
M v[88:91],a[112:115],a[16:19],v[88:91]
buffer_store_dwordx4 v[248:251], v7, s[8:11], s3 offen offset:3072 sc1
M v[88:91],a[108:111],a[12:15],v[88:91]
E v22,v64
M v[88:91],a[104:107],a[8:11],v[88:91]
E v23,v65
M v[88:91],a[100:103],a[4:7],v[88:91]
s_waitcnt lgkmcnt(0)
E v24,v66
M v[88:91],a[96:99],a[0:3],v[88:91]
E v25,v67
C v44,v18,v19
AF v27,v20,v27
C v45,v20,v21
AF v27,v21,v27
AF v26,v22,v23
C v40,v22,v23
E v18,v76
E v19,v77
AF v26,v24,v26
C v41,v24,v25
AF v26,v25,v26
E v20,v78
E v21,v79
AF v27,v18,v27
C v46,v18,v19
AF v27,v19,v27
E v22,v72
E v23,v73
AF v27,v20,v27
C v47,v20,v21
AF v27,v21,v27
E v24,v74
E v25,v75
AF v26,v22,v26
C v42,v22,v23
AF v26,v23,v26
AF v26,v24,v26
C v43,v24,v25
AF v26,v25,v26
v_mov_b32 v56, 0
v_mov_b32 v57, 0
v_mov_b32 v58, 0
v_mov_b32 v59, 0
s_mul_i32 s21, s41, 1048576
SA s21,s21,589824
s_lshl_b32 s84, s42, 1
s_sub_u32 s22, 11, s84
s_mov_b32 s23, 536870912
s_lshl_b32 s86, s20, 14
SA s86,s86,s34
SA s87,s86,4096
SA s88,s86,8192
SA s89,s86,12288
s_lshl_b32 s90, s20, 10
SA s90,s90,s34
SA s90,s90,65536
s_waitcnt vmcnt(3)
v_cmp_gt_u32 vcc, 2, v5
s_nop 0
s_cbranch_vccnz L_lsj0
L_lrj0:
SA m0,s28,98304
v_mov_b32 v10, v26
buffer_load_dwordx4 v3, s[8:11], s21 offen offset:0 sc1 lds
v_mov_b32 v11, v27
buffer_load_dwordx4 v3, s[8:11], s21 offen offset:1024 sc1 lds
v_mov_b32 v12, v10
v_mov_b32 v13, v11
buffer_load_dwordx4 v3, s[8:11], s21 offen offset:2048 sc1 lds
v_permlane16_swap_b32 v12, v10
v_permlane16_swap_b32 v13, v11
buffer_load_dwordx4 v3, s[8:11], s21 offen offset:3072 sc1 lds
v_max_f32 v10, v12, v10
SA m0,s28,102400
v_max_f32 v11, v13, v11
buffer_load_dwordx4 v4, s[8:11], s21 offen offset:0 sc1 lds
v_mov_b32 v12, v10
v_mov_b32 v13, v11
buffer_load_dwordx4 v4, s[8:11], s21 offen offset:1024 sc1 lds
v_permlane32_swap_b32 v12, v10
v_permlane32_swap_b32 v13, v11
buffer_load_dwordx4 v4, s[8:11], s21 offen offset:2048 sc1 lds
v_max_f32 v10, v12, v10
v_max_f32 v11, v13, v11
buffer_load_dwordx4 v4, s[8:11], s21 offen offset:3072 sc1 lds
SA s21,s21,32768
s_sub_u32 s22, s22, 1
s_cselect_b32 s21, s23, s21
v_min_f32 v10, v10, v11
v_cmp_gt_f32 vcc, s24, v10
s_nop 0
s_cbranch_vccnz L_stj0
L_rtj0:
s_cmp_gt_u32 s20, 3
s_cselect_b64 s[82:83], -1, 0
s_cmp_eq_u32 s20, 3
s_cselect_b64 s[66:67], s[16:17], s[82:83]
v_mfma_f32_32x32x16_bf16 v[128:143], v[56:59], v[56:59], 0
s_cselect_b64 s[68:69], s[18:19], s[82:83]
s_cselect_b64 s[70:71], s[48:49], s[82:83]
s_cselect_b64 s[72:73], s[50:51], s[82:83]
v_cndmask_b32 v100, v36, v8, s[66:67]
v_mfma_f32_32x32x16_bf16 v[144:159], v[56:59], v[56:59], 0
v_cndmask_b32 v101, v36, v8, s[68:69]
v_cndmask_b32 v102, v36, v8, s[70:71]
v_cndmask_b32 v103, v36, v8, s[72:73]
s_cmp_gt_u32 s20, 2
v_mfma_f32_32x32x16_bf16 v[160:175], v[56:59], v[56:59], 0
s_cselect_b64 s[82:83], -1, 0
s_cmp_eq_u32 s20, 2
s_cselect_b64 s[74:75], s[16:17], s[82:83]
s_cselect_b64 s[76:77], s[18:19], s[82:83]
v_mfma_f32_32x32x16_bf16 v[176:191], v[56:59], v[56:59], 0
s_cselect_b64 s[78:79], s[48:49], s[82:83]
s_cselect_b64 s[80:81], s[50:51], s[82:83]
v_cndmask_b32 v108, v36, v8, s[74:75]
v_cndmask_b32 v109, v36, v8, s[76:77]
v_mfma_f32_32x32x16_bf16 v[192:207], v[56:59], v[56:59], 0
v_cndmask_b32 v110, v36, v8, s[78:79]
v_cndmask_b32 v111, v36, v8, s[80:81]
s_cmp_gt_u32 s20, 1
s_cselect_b64 s[82:83], -1, 0
v_mfma_f32_32x32x16_bf16 v[208:223], v[56:59], v[56:59], 0
s_cmp_eq_u32 s20, 1
s_cselect_b64 s[66:67], s[16:17], s[82:83]
s_cselect_b64 s[68:69], s[18:19], s[82:83]
s_cselect_b64 s[70:71], s[48:49], s[82:83]
v_mfma_f32_32x32x16_bf16 v[224:239], v[56:59], v[56:59], 0
s_cselect_b64 s[72:73], s[50:51], s[82:83]
v_cndmask_b32 v116, v36, v8, s[66:67]
v_cndmask_b32 v117, v36, v8, s[68:69]
v_cndmask_b32 v118, v36, v8, s[70:71]
v_mfma_f32_32x32x16_bf16 v[240:255], v[56:59], v[56:59], 0
v_cndmask_b32 v119, v36, v8, s[72:73]
s_cmp_gt_u32 s20, 0
s_cselect_b64 s[82:83], -1, 0
s_cmp_eq_u32 s20, 0
s_cselect_b64 s[74:75], s[16:17], s[82:83]
s_cselect_b64 s[76:77], s[18:19], s[82:83]
s_cselect_b64 s[78:79], s[48:49], s[82:83]
s_cselect_b64 s[80:81], s[50:51], s[82:83]
v_cndmask_b32 v124, v36, v8, s[74:75]
v_cndmask_b32 v125, v36, v8, s[76:77]
v_cndmask_b32 v126, v36, v8, s[78:79]
v_cndmask_b32 v127, v36, v8, s[80:81]
s_branch L_d3h
.p2align 12
L_kv1:
s_and_b32 s31, s42, 7
s_lshl_b32 s30, s41, 3
SA s30,s30,s31
s_lshl_b32 s64, s30, 2
SA s64,s64,s20
s_mul_i32 s72, s64, 3584
v_mov_b32 v32, 536870912
v_cmp_gt_u32 vcc, 56, v0
s_lshl_b32 s67, s64, 2
s_nop 0
v_cndmask_b32 v32, v32, v7, vcc
buffer_load_dwordx4 a[176:179], v32, s[56:59], s72 offen offset:0
buffer_load_dwordx4 a[180:183], v32, s[56:59], s72 offen offset:896
buffer_load_dwordx4 a[184:187], v32, s[56:59], s72 offen offset:1792
buffer_load_dwordx4 a[188:191], v32, s[56:59], s72 offen offset:2688
buffer_load_dwordx4 a[192:195], v32, s[60:63], 0 offen
buffer_load_dwordx4 a[196:199], v32, s[68:71], 0 offen
SA m0,s24,16384
s_nop 0
buffer_load_dwordx4 v12, s[48:51], s22 offen offset:0   lds
buffer_load_dwordx4 v13, s[48:51], s22 offen offset:1024   lds
buffer_load_dwordx4 v14, s[48:51], s22 offen offset:2048   lds
buffer_load_dwordx4 v15, s[48:51], s22 offen offset:3072   lds
s_sub_u32 s22, s22, 1048448
SA m0,s23,32768
s_nop 0
buffer_load_dwordx4 v8, s[16:19], s21 offen offset:0  nt lds
buffer_load_dwordx4 v9, s[16:19], s21 offen offset:1024  nt lds
buffer_load_dwordx4 v10, s[16:19], s21 offen offset:2048  nt lds
buffer_load_dwordx4 v11, s[16:19], s21 offen offset:3072  nt lds
SA s21,s21,128
s_mov_b64 exec, 0
s_cmp_eq_u32 s20, 0
s_cbranch_scc1 L_w_kv11
s_cmp_eq_u32 s20, 1
s_cbranch_scc1 L_w_kv12
s_cmp_eq_u32 s20, 2
s_cbranch_scc1 L_w_kv13
s_branch L_w_kv14
L_wd2:
s_mov_b64 exec, -1
s_waitcnt vmcnt(14) lgkmcnt(0)
s_barrier
R a[160:163],v5,0
R a[164:167],v6,0
T a[96:97],v1,0
T a[98:99],v1,1024
T a[100:101],v1,8192
T a[102:103],v1,9216
T a[104:105],v2,0
T a[106:107],v2,1024
T a[108:109],v2,8192
T a[110:111],v2,9216
T a[112:113],v3,0
T a[114:115],v3,1024
T a[116:117],v3,8192
T a[118:119],v3,9216
T a[120:121],v4,0
T a[122:123],v4,1024
T a[124:125],v4,8192
T a[126:127],v4,9216
T a[128:129],v1,16384
T a[130:131],v1,17408
T a[132:133],v1,24576
T a[134:135],v1,25600
T a[136:137],v2,16384
T a[138:139],v2,17408
T a[140:141],v2,24576
T a[142:143],v2,25600
T a[144:145],v3,16384
T a[146:147],v3,17408
T a[148:149],v3,24576
T a[150:151],v3,25600
T a[152:153],v4,16384
T a[154:155],v4,17408
T a[156:157],v4,24576
T a[158:159],v4,25600
s_waitcnt lgkmcnt(15)
M a[0:3],a[160:163],a[96:99],0
SA m0,s23,49152
R a[168:171],v5,2048
R a[172:175],v6,2048
M a[0:3],a[164:167],a[100:103],a[0:3]
buffer_load_dwordx4 v8, s[16:19], s21 offen offset:0  nt lds
M a[4:7],a[164:167],a[108:111],0
M a[4:7],a[160:163],a[104:107],a[4:7]
M a[8:11],a[160:163],a[112:115],0
buffer_load_dwordx4 v9, s[16:19], s21 offen offset:1024  nt lds
M a[8:11],a[164:167],a[116:119],a[8:11]
s_waitcnt lgkmcnt(14)
M a[12:15],a[164:167],a[124:127],0
M a[12:15],a[160:163],a[120:123],a[12:15]
M a[16:19],a[160:163],a[128:131],0
buffer_load_dwordx4 v10, s[16:19], s21 offen offset:2048  nt lds
M a[16:19],a[164:167],a[132:135],a[16:19]
s_waitcnt lgkmcnt(6)
M a[20:23],a[164:167],a[140:143],0
M a[20:23],a[160:163],a[136:139],a[20:23]
buffer_load_dwordx4 v11, s[16:19], s21 offen offset:3072  nt lds
M a[24:27],a[160:163],a[144:147],0
SA s21,s21,524160
M a[24:27],a[164:167],a[148:151],a[24:27]
s_waitcnt lgkmcnt(0)
M a[28:31],a[164:167],a[156:159],0
SA m0,s24,32768
M a[28:31],a[160:163],a[152:155],a[28:31]
buffer_load_dwordx4 v12, s[48:51], s22 offen offset:0   lds
M v[32:35],a[168:171],a[96:99],0
R a[160:163],v5,4096
R a[164:167],v6,4096
M v[32:35],a[172:175],a[100:103],v[32:35]
M v[36:39],a[172:175],a[108:111],0
M v[36:39],a[168:171],a[104:107],v[36:39]
buffer_load_dwordx4 v13, s[48:51], s22 offen offset:1024   lds
M v[40:43],a[168:171],a[112:115],0
M v[40:43],a[172:175],a[116:119],v[40:43]
M v[44:47],a[172:175],a[124:127],0
buffer_load_dwordx4 v14, s[48:51], s22 offen offset:2048   lds
M v[44:47],a[168:171],a[120:123],v[44:47]
M v[48:51],a[168:171],a[128:131],0
M v[48:51],a[172:175],a[132:135],v[48:51]
M v[52:55],a[172:175],a[140:143],0
buffer_load_dwordx4 v15, s[48:51], s22 offen offset:3072   lds
M v[52:55],a[168:171],a[136:139],v[52:55]
SA s22,s22,1048576
M v[56:59],a[168:171],a[144:147],0
M v[56:59],a[172:175],a[148:151],v[56:59]
s_waitcnt lgkmcnt(0)
M v[60:63],a[172:175],a[156:159],0
M v[60:63],a[168:171],a[152:155],v[60:63]
M v[64:67],a[160:163],a[96:99],0
R a[168:171],v5,6144
R a[172:175],v6,6144
M v[64:67],a[164:167],a[100:103],v[64:67]
M v[68:71],a[164:167],a[108:111],0
M v[68:71],a[160:163],a[104:107],v[68:71]
M v[72:75],a[160:163],a[112:115],0
M v[72:75],a[164:167],a[116:119],v[72:75]
M v[76:79],a[164:167],a[124:127],0
M v[76:79],a[160:163],a[120:123],v[76:79]
M v[80:83],a[160:163],a[128:131],0
M v[80:83],a[164:167],a[132:135],v[80:83]
M v[84:87],a[164:167],a[140:143],0
M v[84:87],a[160:163],a[136:139],v[84:87]
M v[88:91],a[160:163],a[144:147],0
M v[88:91],a[164:167],a[148:151],v[88:91]
s_waitcnt lgkmcnt(0)
M v[92:95],a[164:167],a[156:159],0
s_waitcnt vmcnt(12)
M v[92:95],a[160:163],a[152:155],v[92:95]
s_barrier
M v[96:99],a[168:171],a[96:99],0
SA m0,s23,0
R a[160:163],v5,16384
R a[164:167],v6,16384
M v[96:99],a[172:175],a[100:103],v[96:99]
buffer_load_dwordx4 v8, s[16:19], s21 offen offset:0  nt lds
M v[100:103],a[172:175],a[108:111],0
v_lshlrev_b32 v26, 7, v0
v_and_b32 v27, 48, v0
M v[100:103],a[168:171],a[104:107],v[100:103]
v_lshl_add_u32 v26, v27, 24, v26
M v[104:107],a[168:171],a[112:115],0
buffer_load_dwordx4 v9, s[16:19], s21 offen offset:1024  nt lds
M v[104:107],a[172:175],a[116:119],v[104:107]
M v[108:111],a[172:175],a[124:127],0
M v[108:111],a[168:171],a[120:123],v[108:111]
buffer_load_dwordx4 v10, s[16:19], s21 offen offset:2048  nt lds
M v[112:115],a[168:171],a[128:131],0
M v[112:115],a[172:175],a[132:135],v[112:115]
M v[116:119],a[172:175],a[140:143],0
M v[116:119],a[168:171],a[136:139],v[116:119]
buffer_load_dwordx4 v11, s[16:19], s21 offen offset:3072  nt lds
M v[120:123],a[168:171],a[144:147],0
SA s21,s21,128
M v[120:123],a[172:175],a[148:151],v[120:123]
s_waitcnt lgkmcnt(0)
M v[124:127],a[172:175],a[156:159],0
SA m0,s24,49152
M v[124:127],a[168:171],a[152:155],v[124:127]
buffer_load_dwordx4 v12, s[48:51], s22 offen offset:0   lds
M v[128:131],a[160:163],a[96:99],0
R a[168:171],v5,18432
R a[172:175],v6,18432
M v[128:131],a[164:167],a[100:103],v[128:131]
buffer_load_dwordx4 v13, s[48:51], s22 offen offset:1024   lds
M v[132:135],a[164:167],a[108:111],0
M v[132:135],a[160:163],a[104:107],v[132:135]
M v[136:139],a[160:163],a[112:115],0
M v[136:139],a[164:167],a[116:119],v[136:139]
buffer_load_dwordx4 v14, s[48:51], s22 offen offset:2048   lds
M v[140:143],a[164:167],a[124:127],0
M v[140:143],a[160:163],a[120:123],v[140:143]
M v[144:147],a[160:163],a[128:131],0
buffer_load_dwordx4 v15, s[48:51], s22 offen offset:3072   lds
M v[144:147],a[164:167],a[132:135],v[144:147]
s_sub_u32 s22, s22, 1048448
M v[148:151],a[164:167],a[140:143],0
M v[148:151],a[160:163],a[136:139],v[148:151]
M v[152:155],a[160:163],a[144:147],0
M v[152:155],a[164:167],a[148:151],v[152:155]
s_waitcnt lgkmcnt(0)
M v[156:159],a[164:167],a[156:159],0
s_waitcnt vmcnt(12)
M v[156:159],a[160:163],a[152:155],v[156:159]
s_barrier
M v[160:163],a[168:171],a[96:99],0
SA m0,s23,16384
R a[160:163],v5,20480
R a[164:167],v6,20480
M v[160:163],a[172:175],a[100:103],v[160:163]
T a[32:33],v1,32768
T a[34:35],v1,33792
M v[164:167],a[172:175],a[108:111],0
T a[36:37],v1,40960
T a[38:39],v1,41984
M v[164:167],a[168:171],a[104:107],v[164:167]
T a[40:41],v2,32768
T a[42:43],v2,33792
M v[168:171],a[168:171],a[112:115],0
T a[44:45],v2,40960
T a[46:47],v2,41984
M v[168:171],a[172:175],a[116:119],v[168:171]
buffer_load_dwordx4 v8, s[16:19], s21 offen offset:0  nt lds
M v[172:175],a[172:175],a[124:127],0
s_nop 0
T a[48:49],v3,32768
T a[50:51],v3,33792
M v[172:175],a[168:171],a[120:123],v[172:175]
buffer_load_dwordx4 v9, s[16:19], s21 offen offset:1024  nt lds
M v[176:179],a[168:171],a[128:131],0
s_nop 0
T a[52:53],v3,40960
T a[54:55],v3,41984
M v[176:179],a[172:175],a[132:135],v[176:179]
T a[56:57],v4,32768
T a[58:59],v4,33792
M v[180:183],a[172:175],a[140:143],0
buffer_load_dwordx4 v10, s[16:19], s21 offen offset:2048  nt lds
M v[180:183],a[168:171],a[136:139],v[180:183]
s_nop 0
T a[60:61],v4,40960
T a[62:63],v4,41984
M v[184:187],a[168:171],a[144:147],0
buffer_load_dwordx4 v11, s[16:19], s21 offen offset:3072  nt lds
M v[184:187],a[172:175],a[148:151],v[184:187]
s_waitcnt lgkmcnt(15)
s_nop 0
T a[64:65],v1,49152
T a[66:67],v1,50176
M v[188:191],a[172:175],a[156:159],0
SA s21,s21,524160
T a[68:69],v1,57344
T a[70:71],v1,58368
M v[188:191],a[168:171],a[152:155],v[188:191]
SA m0,s24,0
M v[192:195],a[160:163],a[96:99],0
R a[168:171],v5,22528
R a[172:175],v6,22528
M v[192:195],a[164:167],a[100:103],v[192:195]
T a[72:73],v2,49152
T a[74:75],v2,50176
M v[196:199],a[164:167],a[108:111],0
T a[76:77],v2,57344
T a[78:79],v2,58368
M v[196:199],a[160:163],a[104:107],v[196:199]
T a[80:81],v3,49152
T a[82:83],v3,50176
M v[200:203],a[160:163],a[112:115],0
buffer_load_dwordx4 v12, s[48:51], s22 offen offset:0   lds
M v[200:203],a[164:167],a[116:119],v[200:203]
s_nop 0
T a[84:85],v3,57344
T a[86:87],v3,58368
M v[204:207],a[164:167],a[124:127],0
T a[88:89],v4,49152
T a[90:91],v4,50176
M v[204:207],a[160:163],a[120:123],v[204:207]
buffer_load_dwordx4 v13, s[48:51], s22 offen offset:1024   lds
M v[208:211],a[160:163],a[128:131],0
s_nop 0
T a[92:93],v4,57344
T a[94:95],v4,58368
M v[208:211],a[164:167],a[132:135],v[208:211]
buffer_load_dwordx4 v14, s[48:51], s22 offen offset:2048   lds
M v[212:215],a[164:167],a[140:143],0
buffer_load_dwordx4 v15, s[48:51], s22 offen offset:3072   lds
M v[212:215],a[160:163],a[136:139],v[212:215]
SA s22,s22,1048576
M v[216:219],a[160:163],a[144:147],0
M v[216:219],a[164:167],a[148:151],v[216:219]
s_waitcnt lgkmcnt(12)
M v[220:223],a[164:167],a[156:159],0
s_waitcnt vmcnt(12) lgkmcnt(0)
M v[220:223],a[160:163],a[152:155],v[220:223]
s_barrier
M v[224:227],a[168:171],a[96:99],0
SA m0,s23,32768
R a[160:163],v5,32768
R a[164:167],v6,32768
M v[224:227],a[172:175],a[100:103],v[224:227]
buffer_load_dwordx4 v8, s[16:19], s21 offen offset:0  nt lds
M v[228:231],a[172:175],a[108:111],0
M v[228:231],a[168:171],a[104:107],v[228:231]
M v[232:235],a[168:171],a[112:115],0
buffer_load_dwordx4 v9, s[16:19], s21 offen offset:1024  nt lds
M v[232:235],a[172:175],a[116:119],v[232:235]
M v[236:239],a[172:175],a[124:127],0
M v[236:239],a[168:171],a[120:123],v[236:239]
buffer_load_dwordx4 v10, s[16:19], s21 offen offset:2048  nt lds
M v[240:243],a[168:171],a[128:131],0
M v[240:243],a[172:175],a[132:135],v[240:243]
M v[244:247],a[172:175],a[140:143],0
buffer_load_dwordx4 v11, s[16:19], s21 offen offset:3072  nt lds
M v[244:247],a[168:171],a[136:139],v[244:247]
SA s21,s21,128
M v[248:251],a[168:171],a[144:147],0
M v[248:251],a[172:175],a[148:151],v[248:251]
s_waitcnt lgkmcnt(0)
M v[252:255],a[172:175],a[156:159],0
M v[252:255],a[168:171],a[152:155],v[252:255]
M a[0:3],a[160:163],a[32:35],a[0:3]
R a[168:171],v5,34816
R a[172:175],v6,34816
M a[0:3],a[164:167],a[36:39],a[0:3]
T a[96:97],v1,0
T a[98:99],v1,1024
M a[4:7],a[164:167],a[44:47],a[4:7]
SA m0,s24,16384
v_mov_b32 v16, 0
v_mov_b32 v17, 0
M a[4:7],a[160:163],a[40:43],a[4:7]
buffer_load_dwordx4 v12, s[48:51], s22 offen offset:0   lds
M a[8:11],a[160:163],a[48:51],a[8:11]
v_mov_b32 v18, 0
v_mov_b32 v19, 0
M a[8:11],a[164:167],a[52:55],a[8:11]
v_mov_b32 v20, 0
v_mov_b32 v21, 0
M a[12:15],a[164:167],a[60:63],a[12:15]
T a[100:101],v1,8192
T a[102:103],v1,9216
M a[12:15],a[160:163],a[56:59],a[12:15]
v_mov_b32 v22, 0
v_mov_b32 v23, 0
M a[16:19],a[160:163],a[64:67],a[16:19]
buffer_load_dwordx4 v13, s[48:51], s22 offen offset:1024   lds
M a[16:19],a[164:167],a[68:71],a[16:19]
G v28,a192
G v29,a196
M a[20:23],a[164:167],a[76:79],a[20:23]
v_lshlrev_b32 v24, 16, v28
v_lshlrev_b32 v25, 16, v29
M a[20:23],a[160:163],a[72:75],a[20:23]
T a[104:105],v2,0
T a[106:107],v2,1024
M a[24:27],a[160:163],a[80:83],a[24:27]
v_and_b32 v28, 0xffff0000, v28
v_and_b32 v29, 0xffff0000, v29
M a[24:27],a[164:167],a[84:87],a[24:27]
s_waitcnt lgkmcnt(6)
buffer_load_dwordx4 v14, s[48:51], s22 offen offset:2048   lds
M a[28:31],a[164:167],a[92:95],a[28:31]
G v30,a176
v_lshlrev_b32 v31, 16, v30
M a[28:31],a[160:163],a[88:91],a[28:31]
v_and_b32 v30, 0xffff0000, v30
v_fmac_f32 v16, v31, v24
M v[32:35],a[168:171],a[32:35],v[32:35]
R a[160:163],v5,36864
R a[164:167],v6,36864
M v[32:35],a[172:175],a[36:39],v[32:35]
T a[108:109],v2,8192
T a[110:111],v2,9216
M v[36:39],a[172:175],a[44:47],v[36:39]
buffer_load_dwordx4 v15, s[48:51], s22 offen offset:3072   lds
M v[36:39],a[168:171],a[40:43],v[36:39]
s_sub_u32 s22, s22, 1048448
v_fmac_f32 v20, v31, v25
v_fmac_f32 v16, v30, v28
M v[40:43],a[168:171],a[48:51],v[40:43]
v_fmac_f32 v20, v30, v29
G v30,a180
M v[40:43],a[172:175],a[52:55],v[40:43]
T a[112:113],v3,0
T a[114:115],v3,1024
M v[44:47],a[172:175],a[60:63],v[44:47]
SA m0,s23,49152
v_lshlrev_b32 v31, 16, v30
v_and_b32 v30, 0xffff0000, v30
M v[44:47],a[168:171],a[56:59],v[44:47]
buffer_load_dwordx4 v8, s[16:19], s21 offen offset:0  nt lds
M v[48:51],a[168:171],a[64:67],v[48:51]
v_fmac_f32 v17, v31, v24
v_fmac_f32 v21, v31, v25
M v[48:51],a[172:175],a[68:71],v[48:51]
v_fmac_f32 v17, v30, v28
v_fmac_f32 v21, v30, v29
M v[52:55],a[172:175],a[76:79],v[52:55]
T a[116:117],v3,8192
T a[118:119],v3,9216
M v[52:55],a[168:171],a[72:75],v[52:55]
G v30,a184
v_lshlrev_b32 v31, 16, v30
M v[56:59],a[168:171],a[80:83],v[56:59]
buffer_load_dwordx4 v9, s[16:19], s21 offen offset:1024  nt lds
M v[56:59],a[172:175],a[84:87],v[56:59]
s_waitcnt lgkmcnt(6)
v_and_b32 v30, 0xffff0000, v30
v_fmac_f32 v18, v31, v24
M v[60:63],a[172:175],a[92:95],v[60:63]
v_fmac_f32 v22, v31, v25
v_fmac_f32 v18, v30, v28
M v[60:63],a[168:171],a[88:91],v[60:63]
T a[120:121],v4,0
T a[122:123],v4,1024
M v[64:67],a[160:163],a[32:35],v[64:67]
R a[168:171],v5,38912
R a[172:175],v6,38912
M v[64:67],a[164:167],a[36:39],v[64:67]
buffer_load_dwordx4 v10, s[16:19], s21 offen offset:2048  nt lds
M v[68:71],a[164:167],a[44:47],v[68:71]
v_fmac_f32 v22, v30, v29
G v30,a188
M v[68:71],a[160:163],a[40:43],v[68:71]
v_lshlrev_b32 v31, 16, v30
v_and_b32 v30, 0xffff0000, v30
M v[72:75],a[160:163],a[48:51],v[72:75]
T a[124:125],v4,8192
T a[126:127],v4,9216
M v[72:75],a[164:167],a[52:55],v[72:75]
v_fmac_f32 v19, v31, v24
v_fmac_f32 v23, v31, v25
M v[76:79],a[164:167],a[60:63],v[76:79]
buffer_load_dwordx4 v11, s[16:19], s21 offen offset:3072  nt lds
M v[76:79],a[160:163],a[56:59],v[76:79]
SA s21,s21,524160
v_fmac_f32 v19, v30, v28
v_fmac_f32 v23, v30, v29
M v[80:83],a[160:163],a[64:67],v[80:83]
G v28,a193
G v29,a197
M v[80:83],a[164:167],a[68:71],v[80:83]
v_lshlrev_b32 v24, 16, v28
v_lshlrev_b32 v25, 16, v29
M v[84:87],a[164:167],a[76:79],v[84:87]
v_and_b32 v28, 0xffff0000, v28
v_and_b32 v29, 0xffff0000, v29
M v[84:87],a[160:163],a[72:75],v[84:87]
G v30,a177
v_lshlrev_b32 v31, 16, v30
M v[88:91],a[160:163],a[80:83],v[88:91]
v_and_b32 v30, 0xffff0000, v30
v_fmac_f32 v16, v31, v24
M v[88:91],a[164:167],a[84:87],v[88:91]
s_waitcnt lgkmcnt(2)
v_fmac_f32 v20, v31, v25
v_fmac_f32 v16, v30, v28
M v[92:95],a[164:167],a[92:95],v[92:95]
s_waitcnt vmcnt(16) lgkmcnt(0)
v_fmac_f32 v20, v30, v29
G v30,a181
M v[92:95],a[160:163],a[88:91],v[92:95]
s_barrier
M v[96:99],a[168:171],a[32:35],v[96:99]
R a[160:163],v5,49152
R a[164:167],v6,49152
M v[96:99],a[172:175],a[36:39],v[96:99]
v_lshlrev_b32 v31, 16, v30
v_and_b32 v30, 0xffff0000, v30
M v[100:103],a[172:175],a[44:47],v[100:103]
SA m0,s24,32768
T a[128:129],v1,16384
T a[130:131],v1,17408
M v[100:103],a[168:171],a[40:43],v[100:103]
buffer_load_dwordx4 v12, s[48:51], s22 offen offset:0   lds
M v[104:107],a[168:171],a[48:51],v[104:107]
v_fmac_f32 v17, v31, v24
v_fmac_f32 v21, v31, v25
M v[104:107],a[172:175],a[52:55],v[104:107]
v_fmac_f32 v17, v30, v28
v_fmac_f32 v21, v30, v29
M v[108:111],a[172:175],a[60:63],v[108:111]
G v30,a185
v_lshlrev_b32 v31, 16, v30
M v[108:111],a[168:171],a[56:59],v[108:111]
v_and_b32 v30, 0xffff0000, v30
v_fmac_f32 v18, v31, v24
M v[112:115],a[168:171],a[64:67],v[112:115]
v_fmac_f32 v22, v31, v25
v_fmac_f32 v18, v30, v28
M v[112:115],a[172:175],a[68:71],v[112:115]
T a[132:133],v1,24576
T a[134:135],v1,25600
M v[116:119],a[172:175],a[76:79],v[116:119]
buffer_load_dwordx4 v13, s[48:51], s22 offen offset:1024   lds
M v[116:119],a[168:171],a[72:75],v[116:119]
v_fmac_f32 v22, v30, v29
G v30,a189
M v[120:123],a[168:171],a[80:83],v[120:123]
v_lshlrev_b32 v31, 16, v30
v_and_b32 v30, 0xffff0000, v30
M v[120:123],a[172:175],a[84:87],v[120:123]
s_waitcnt lgkmcnt(4)
v_fmac_f32 v19, v31, v24
v_fmac_f32 v23, v31, v25
M v[124:127],a[172:175],a[92:95],v[124:127]
v_fmac_f32 v19, v30, v28
v_fmac_f32 v23, v30, v29
M v[124:127],a[168:171],a[88:91],v[124:127]
G v28,a194
G v29,a198
M v[128:131],a[160:163],a[32:35],v[128:131]
R a[168:171],v5,51200
R a[172:175],v6,51200
M v[128:131],a[164:167],a[36:39],v[128:131]
T a[136:137],v2,16384
T a[138:139],v2,17408
M v[132:135],a[164:167],a[44:47],v[132:135]
buffer_load_dwordx4 v14, s[48:51], s22 offen offset:2048   lds
M v[132:135],a[160:163],a[40:43],v[132:135]
v_lshlrev_b32 v24, 16, v28
v_lshlrev_b32 v25, 16, v29
M v[136:139],a[160:163],a[48:51],v[136:139]
v_and_b32 v28, 0xffff0000, v28
v_and_b32 v29, 0xffff0000, v29
M v[136:139],a[164:167],a[52:55],v[136:139]
G v30,a178
v_lshlrev_b32 v31, 16, v30
M v[140:143],a[164:167],a[60:63],v[140:143]
v_and_b32 v30, 0xffff0000, v30
v_fmac_f32 v16, v31, v24
M v[140:143],a[160:163],a[56:59],v[140:143]
T a[140:141],v2,24576
T a[142:143],v2,25600
M v[144:147],a[160:163],a[64:67],v[144:147]
buffer_load_dwordx4 v15, s[48:51], s22 offen offset:3072   lds
M v[144:147],a[164:167],a[68:71],v[144:147]
SA s22,s22,1048576
v_fmac_f32 v20, v31, v25
v_fmac_f32 v16, v30, v28
M v[148:151],a[164:167],a[76:79],v[148:151]
v_fmac_f32 v20, v30, v29
G v30,a182
M v[148:151],a[160:163],a[72:75],v[148:151]
v_lshlrev_b32 v31, 16, v30
v_and_b32 v30, 0xffff0000, v30
M v[152:155],a[160:163],a[80:83],v[152:155]
v_fmac_f32 v17, v31, v24
v_fmac_f32 v21, v31, v25
M v[152:155],a[164:167],a[84:87],v[152:155]
s_waitcnt lgkmcnt(4)
v_fmac_f32 v17, v30, v28
v_fmac_f32 v21, v30, v29
M v[156:159],a[164:167],a[92:95],v[156:159]
SA m0,s23,0
T a[144:145],v3,16384
T a[146:147],v3,17408
M v[156:159],a[160:163],a[88:91],v[156:159]
buffer_load_dwordx4 v8, s[16:19], s21 offen offset:0  nt lds
M v[160:163],a[168:171],a[32:35],v[160:163]
R a[160:163],v5,53248
R a[164:167],v6,53248
M v[160:163],a[172:175],a[36:39],v[160:163]
G v30,a186
v_lshlrev_b32 v31, 16, v30
M v[164:167],a[172:175],a[44:47],v[164:167]
v_and_b32 v30, 0xffff0000, v30
v_fmac_f32 v18, v31, v24
M v[164:167],a[168:171],a[40:43],v[164:167]
v_fmac_f32 v22, v31, v25
v_fmac_f32 v18, v30, v28
M v[168:171],a[168:171],a[48:51],v[168:171]
v_fmac_f32 v22, v30, v29
G v30,a190
M v[168:171],a[172:175],a[52:55],v[168:171]
L_w_kv11:
s_cbranch_execz L_w_kv15
T a[148:149],v3,24576
T a[150:151],v3,25600
M v[172:175],a[172:175],a[60:63],v[172:175]
buffer_load_dwordx4 v9, s[16:19], s21 offen offset:1024  nt lds
M v[172:175],a[168:171],a[56:59],v[172:175]
v_lshlrev_b32 v31, 16, v30
v_and_b32 v30, 0xffff0000, v30
M v[176:179],a[168:171],a[64:67],v[176:179]
v_fmac_f32 v19, v31, v24
v_fmac_f32 v23, v31, v25
M v[176:179],a[172:175],a[68:71],v[176:179]
v_fmac_f32 v19, v30, v28
v_fmac_f32 v23, v30, v29
M v[180:183],a[172:175],a[76:79],v[180:183]
M v[180:183],a[168:171],a[72:75],v[180:183]
M v[184:187],a[168:171],a[80:83],v[184:187]
s_nop 0
T a[152:153],v4,16384
T a[154:155],v4,17408
M v[184:187],a[172:175],a[84:87],v[184:187]
s_waitcnt lgkmcnt(4)
buffer_load_dwordx4 v10, s[16:19], s21 offen offset:2048  nt lds
M v[188:191],a[172:175],a[92:95],v[188:191]
M v[188:191],a[168:171],a[88:91],v[188:191]
M v[192:195],a[160:163],a[32:35],v[192:195]
R a[168:171],v5,55296
R a[172:175],v6,55296
M v[192:195],a[164:167],a[36:39],v[192:195]
M v[196:199],a[164:167],a[44:47],v[196:199]
M v[196:199],a[160:163],a[40:43],v[196:199]
s_nop 0
T a[156:157],v4,24576
T a[158:159],v4,25600
M v[200:203],a[160:163],a[48:51],v[200:203]
buffer_load_dwordx4 v11, s[16:19], s21 offen offset:3072  nt lds
M v[200:203],a[164:167],a[52:55],v[200:203]
SA s21,s21,128
M v[204:207],a[164:167],a[60:63],v[204:207]
M v[204:207],a[160:163],a[56:59],v[204:207]
M v[208:211],a[160:163],a[64:67],v[208:211]
M v[208:211],a[164:167],a[68:71],v[208:211]
M v[212:215],a[164:167],a[76:79],v[212:215]
M v[212:215],a[160:163],a[72:75],v[212:215]
M v[216:219],a[160:163],a[80:83],v[216:219]
M v[216:219],a[164:167],a[84:87],v[216:219]
s_waitcnt lgkmcnt(2)
M v[220:223],a[164:167],a[92:95],v[220:223]
s_waitcnt vmcnt(16) lgkmcnt(0)
M v[220:223],a[160:163],a[88:91],v[220:223]
s_barrier
M v[224:227],a[168:171],a[32:35],v[224:227]
R a[160:163],v5,0
R a[164:167],v6,0
M v[224:227],a[172:175],a[36:39],v[224:227]
M v[228:231],a[172:175],a[44:47],v[228:231]
M v[228:231],a[168:171],a[40:43],v[228:231]
M v[232:235],a[168:171],a[48:51],v[232:235]
M v[232:235],a[172:175],a[52:55],v[232:235]
M v[236:239],a[172:175],a[60:63],v[236:239]
M v[236:239],a[168:171],a[56:59],v[236:239]
M v[240:243],a[168:171],a[64:67],v[240:243]
M v[240:243],a[172:175],a[68:71],v[240:243]
M v[244:247],a[172:175],a[76:79],v[244:247]
M v[244:247],a[168:171],a[72:75],v[244:247]
M v[248:251],a[168:171],a[80:83],v[248:251]
M v[248:251],a[172:175],a[84:87],v[248:251]
s_waitcnt lgkmcnt(0)
M v[252:255],a[172:175],a[92:95],v[252:255]
M v[252:255],a[168:171],a[88:91],v[252:255]
M a[0:3],a[160:163],a[96:99],a[0:3]
R a[168:171],v5,2048
R a[172:175],v6,2048
M a[0:3],a[164:167],a[100:103],a[0:3]
T a[32:33],v1,32768
T a[34:35],v1,33792
M a[4:7],a[164:167],a[108:111],a[4:7]
SA m0,s24,49152
G v28,a195
G v29,a199
M a[4:7],a[160:163],a[104:107],a[4:7]
buffer_load_dwordx4 v12, s[48:51], s22 offen offset:0   lds
M a[8:11],a[160:163],a[112:115],a[8:11]
v_lshlrev_b32 v24, 16, v28
v_lshlrev_b32 v25, 16, v29
M a[8:11],a[164:167],a[116:119],a[8:11]
v_and_b32 v28, 0xffff0000, v28
v_and_b32 v29, 0xffff0000, v29
M a[12:15],a[164:167],a[124:127],a[12:15]
T a[36:37],v1,40960
T a[38:39],v1,41984
M a[12:15],a[160:163],a[120:123],a[12:15]
G v30,a179
v_lshlrev_b32 v31, 16, v30
M a[16:19],a[160:163],a[128:131],a[16:19]
buffer_load_dwordx4 v13, s[48:51], s22 offen offset:1024   lds
M a[16:19],a[164:167],a[132:135],a[16:19]
v_and_b32 v30, 0xffff0000, v30
v_fmac_f32 v16, v31, v24
M a[20:23],a[164:167],a[140:143],a[20:23]
v_fmac_f32 v20, v31, v25
v_fmac_f32 v16, v30, v28
M a[20:23],a[160:163],a[136:139],a[20:23]
T a[40:41],v2,32768
T a[42:43],v2,33792
M a[24:27],a[160:163],a[144:147],a[24:27]
v_fmac_f32 v20, v30, v29
G v30,a183
M a[24:27],a[164:167],a[148:151],a[24:27]
s_waitcnt lgkmcnt(6)
buffer_load_dwordx4 v14, s[48:51], s22 offen offset:2048   lds
M a[28:31],a[164:167],a[156:159],a[28:31]
v_lshlrev_b32 v31, 16, v30
v_and_b32 v30, 0xffff0000, v30
M a[28:31],a[160:163],a[152:155],a[28:31]
v_fmac_f32 v17, v31, v24
v_fmac_f32 v21, v31, v25
M v[32:35],a[168:171],a[96:99],v[32:35]
R a[160:163],v5,4096
R a[164:167],v6,4096
M v[32:35],a[172:175],a[100:103],v[32:35]
T a[44:45],v2,40960
T a[46:47],v2,41984
M v[36:39],a[172:175],a[108:111],v[36:39]
buffer_load_dwordx4 v15, s[48:51], s22 offen offset:3072   lds
M v[36:39],a[168:171],a[104:107],v[36:39]
s_sub_u32 s22, s22, 1048448
v_fmac_f32 v17, v30, v28
v_fmac_f32 v21, v30, v29
M v[40:43],a[168:171],a[112:115],v[40:43]
G v30,a187
v_lshlrev_b32 v31, 16, v30
M v[40:43],a[172:175],a[116:119],v[40:43]
T a[48:49],v3,32768
T a[50:51],v3,33792
M v[44:47],a[172:175],a[124:127],v[44:47]
SA m0,s23,16384
v_and_b32 v30, 0xffff0000, v30
v_fmac_f32 v18, v31, v24
M v[44:47],a[168:171],a[120:123],v[44:47]
buffer_load_dwordx4 v8, s[16:19], s21 offen offset:0  nt lds
M v[48:51],a[168:171],a[128:131],v[48:51]
v_fmac_f32 v22, v31, v25
v_fmac_f32 v18, v30, v28
M v[48:51],a[172:175],a[132:135],v[48:51]
v_fmac_f32 v22, v30, v29
G v30,a191
M v[52:55],a[172:175],a[140:143],v[52:55]
T a[52:53],v3,40960
T a[54:55],v3,41984
M v[52:55],a[168:171],a[136:139],v[52:55]
v_lshlrev_b32 v31, 16, v30
v_and_b32 v30, 0xffff0000, v30
M v[56:59],a[168:171],a[144:147],v[56:59]
buffer_load_dwordx4 v9, s[16:19], s21 offen offset:1024  nt lds
M v[56:59],a[172:175],a[148:151],v[56:59]
s_waitcnt lgkmcnt(6)
v_fmac_f32 v19, v31, v24
v_fmac_f32 v23, v31, v25
M v[60:63],a[172:175],a[156:159],v[60:63]
v_fmac_f32 v19, v30, v28
v_fmac_f32 v23, v30, v29
M v[60:63],a[168:171],a[152:155],v[60:63]
T a[56:57],v4,32768
T a[58:59],v4,33792
M v[64:67],a[160:163],a[96:99],v[64:67]
R a[168:171],v5,6144
R a[172:175],v6,6144
M v[64:67],a[164:167],a[100:103],v[64:67]
buffer_load_dwordx4 v10, s[16:19], s21 offen offset:2048  nt lds
M v[68:71],a[164:167],a[108:111],v[68:71]
v_permlane32_swap_b32 v16, v18
M v[68:71],a[160:163],a[104:107],v[68:71]
v_permlane32_swap_b32 v17, v19
M v[72:75],a[160:163],a[112:115],v[72:75]
s_nop 0
T a[60:61],v4,40960
T a[62:63],v4,41984
M v[72:75],a[164:167],a[116:119],v[72:75]
v_permlane32_swap_b32 v20, v22
M v[76:79],a[164:167],a[124:127],v[76:79]
buffer_load_dwordx4 v11, s[16:19], s21 offen offset:3072  nt lds
M v[76:79],a[160:163],a[120:123],v[76:79]
SA s21,s21,524160
v_permlane32_swap_b32 v21, v23
M v[80:83],a[160:163],a[128:131],v[80:83]
AF v16,v16,v18
AF v17,v17,v19
M v[80:83],a[164:167],a[132:135],v[80:83]
AF v20,v20,v22
AF v21,v21,v23
M v[84:87],a[164:167],a[140:143],v[84:87]
v_lshrrev_b32 v28, 4, v0
M v[84:87],a[160:163],a[136:139],v[84:87]
v_permlane16_swap_b32 v16, v17
M v[88:91],a[160:163],a[144:147],v[88:91]
v_permlane16_swap_b32 v20, v21
M v[88:91],a[164:167],a[148:151],v[88:91]
s_waitcnt lgkmcnt(2)
AF v16,v16,v17
AF v20,v20,v21
M v[92:95],a[164:167],a[156:159],v[92:95]
s_waitcnt vmcnt(16) lgkmcnt(0)
v_add_u32 v29, s67, v28
v_add_f32 v16, v16, v16 row_ror:8 row_mask:0xf bank_mask:0xf
M v[92:95],a[160:163],a[152:155],v[92:95]
s_barrier
M v[96:99],a[168:171],a[96:99],v[96:99]
R a[160:163],v5,16384
R a[164:167],v6,16384
M v[96:99],a[172:175],a[100:103],v[96:99]
v_add_f32 v20, v20, v20 row_ror:8 row_mask:0xf bank_mask:0xf
v_add_f32 v16, v16, v16 row_ror:4 row_mask:0xf bank_mask:0xf
M v[100:103],a[172:175],a[108:111],v[100:103]
SA m0,s24,0
T a[64:65],v1,49152
T a[66:67],v1,50176
M v[100:103],a[168:171],a[104:107],v[100:103]
buffer_load_dwordx4 v12, s[48:51], s22 offen offset:0   lds
M v[104:107],a[168:171],a[112:115],v[104:107]
v_add_f32 v20, v20, v20 row_ror:4 row_mask:0xf bank_mask:0xf
v_add_f32 v16, v16, v16 row_ror:2 row_mask:0xf bank_mask:0xf
M v[104:107],a[172:175],a[116:119],v[104:107]
v_add_f32 v20, v20, v20 row_ror:2 row_mask:0xf bank_mask:0xf
v_add_f32 v16, v16, v16 row_ror:1 row_mask:0xf bank_mask:0xf
M v[108:111],a[172:175],a[124:127],v[108:111]
v_add_f32 v20, v20, v20 row_ror:1 row_mask:0xf bank_mask:0xf
v_ashrrev_i32 v30, 31, v16
M v[108:111],a[168:171],a[120:123],v[108:111]
v_or_b32 v30, 0x80000000, v30
v_xor_b32 v30, v30, v16
M v[112:115],a[168:171],a[128:131],v[112:115]
v_and_b32 v30, 0xfffff800, v30
v_sub_u32 v29, 2047, v29
M v[112:115],a[172:175],a[132:135],v[112:115]
T a[68:69],v1,57344
T a[70:71],v1,58368
M v[116:119],a[172:175],a[140:143],v[116:119]
buffer_load_dwordx4 v13, s[48:51], s22 offen offset:1024   lds
M v[116:119],a[168:171],a[136:139],v[116:119]
v_or_b32 v30, v30, v29
v_max_u32 v30, 1, v30
M v[120:123],a[168:171],a[144:147],v[120:123]
MF v21,0xbfb8aa3b,v20
M v[120:123],a[172:175],a[148:151],v[120:123]
s_waitcnt lgkmcnt(4)
E v21,v21
M v[124:127],a[172:175],a[156:159],v[124:127]
AF v21,1.0,v21
M v[124:127],a[168:171],a[152:155],v[124:127]
v_rcp_f32 v20, v21
M v[128:131],a[160:163],a[96:99],v[128:131]
s_lshl_b32 s72, s20, 4
R a[168:171],v5,18432
R a[172:175],v6,18432
M v[128:131],a[164:167],a[100:103],v[128:131]
SA s72,s72,163584
T a[72:73],v2,49152
T a[74:75],v2,50176
M v[132:135],a[164:167],a[108:111],v[132:135]
buffer_load_dwordx4 v14, s[48:51], s22 offen offset:2048   lds
M v[132:135],a[160:163],a[104:107],v[132:135]
v_lshl_add_u32 v28, v28, 2, s72
ds_write_b32 v28, v30
M v[136:139],a[160:163],a[112:115],v[136:139]
ds_write_b32 v28, v16 offset:64
ds_write_b32 v28, v20 offset:128
M v[136:139],a[164:167],a[116:119],v[136:139]
M v[140:143],a[164:167],a[124:127],v[140:143]
M v[140:143],a[160:163],a[120:123],v[140:143]
s_nop 0
T a[76:77],v2,57344
T a[78:79],v2,58368
M v[144:147],a[160:163],a[128:131],v[144:147]
buffer_load_dwordx4 v15, s[48:51], s22 offen offset:3072   lds
M v[144:147],a[164:167],a[132:135],v[144:147]
SA s22,s22,1048576
M v[148:151],a[164:167],a[140:143],v[148:151]
M v[148:151],a[160:163],a[136:139],v[148:151]
M v[152:155],a[160:163],a[144:147],v[152:155]
M v[152:155],a[164:167],a[148:151],v[152:155]
s_waitcnt lgkmcnt(7)
M v[156:159],a[164:167],a[156:159],v[156:159]
SA m0,s23,32768
T a[80:81],v3,49152
T a[82:83],v3,50176
M v[156:159],a[160:163],a[152:155],v[156:159]
buffer_load_dwordx4 v8, s[16:19], s21 offen offset:0  nt lds
M v[160:163],a[168:171],a[96:99],v[160:163]
R a[160:163],v5,20480
R a[164:167],v6,20480
M v[160:163],a[172:175],a[100:103],v[160:163]
M v[164:167],a[172:175],a[108:111],v[164:167]
M v[164:167],a[168:171],a[104:107],v[164:167]
M v[168:171],a[168:171],a[112:115],v[168:171]
M v[168:171],a[172:175],a[116:119],v[168:171]
s_nop 0
T a[84:85],v3,57344
T a[86:87],v3,58368
M v[172:175],a[172:175],a[124:127],v[172:175]
buffer_load_dwordx4 v9, s[16:19], s21 offen offset:1024  nt lds
M v[172:175],a[168:171],a[120:123],v[172:175]
M v[176:179],a[168:171],a[128:131],v[176:179]
M v[176:179],a[172:175],a[132:135],v[176:179]
M v[180:183],a[172:175],a[140:143],v[180:183]
M v[180:183],a[168:171],a[136:139],v[180:183]
M v[184:187],a[168:171],a[144:147],v[184:187]
s_nop 0
T a[88:89],v4,49152
T a[90:91],v4,50176
M v[184:187],a[172:175],a[148:151],v[184:187]
s_waitcnt lgkmcnt(4)
buffer_load_dwordx4 v10, s[16:19], s21 offen offset:2048  nt lds
M v[188:191],a[172:175],a[156:159],v[188:191]
M v[188:191],a[168:171],a[152:155],v[188:191]
M v[192:195],a[160:163],a[96:99],v[192:195]
R a[168:171],v5,22528
R a[172:175],v6,22528
M v[192:195],a[164:167],a[100:103],v[192:195]
M v[196:199],a[164:167],a[108:111],v[196:199]
M v[196:199],a[160:163],a[104:107],v[196:199]
s_nop 0
T a[92:93],v4,57344
T a[94:95],v4,58368
M v[200:203],a[160:163],a[112:115],v[200:203]
buffer_load_dwordx4 v11, s[16:19], s21 offen offset:3072  nt lds
M v[200:203],a[164:167],a[116:119],v[200:203]
SA s21,s21,128
M v[204:207],a[164:167],a[124:127],v[204:207]
M v[204:207],a[160:163],a[120:123],v[204:207]
M v[208:211],a[160:163],a[128:131],v[208:211]
M v[208:211],a[164:167],a[132:135],v[208:211]
M v[212:215],a[164:167],a[140:143],v[212:215]
M v[212:215],a[160:163],a[136:139],v[212:215]
M v[216:219],a[160:163],a[144:147],v[216:219]
M v[216:219],a[164:167],a[148:151],v[216:219]
s_waitcnt lgkmcnt(2)
M v[220:223],a[164:167],a[156:159],v[220:223]
s_waitcnt vmcnt(16) lgkmcnt(0)
M v[220:223],a[160:163],a[152:155],v[220:223]
s_barrier
M v[224:227],a[168:171],a[96:99],v[224:227]
R a[160:163],v5,32768
R a[164:167],v6,32768
M v[224:227],a[172:175],a[100:103],v[224:227]
M v[228:231],a[172:175],a[108:111],v[228:231]
M v[228:231],a[168:171],a[104:107],v[228:231]
M v[232:235],a[168:171],a[112:115],v[232:235]
M v[232:235],a[172:175],a[116:119],v[232:235]
M v[236:239],a[172:175],a[124:127],v[236:239]
M v[236:239],a[168:171],a[120:123],v[236:239]
M v[240:243],a[168:171],a[128:131],v[240:243]
M v[240:243],a[172:175],a[132:135],v[240:243]
M v[244:247],a[172:175],a[140:143],v[244:247]
M v[244:247],a[168:171],a[136:139],v[244:247]
M v[248:251],a[168:171],a[144:147],v[248:251]
M v[248:251],a[172:175],a[148:151],v[248:251]
s_waitcnt lgkmcnt(0)
M v[252:255],a[172:175],a[156:159],v[252:255]
M v[252:255],a[168:171],a[152:155],v[252:255]
M a[0:3],a[160:163],a[32:35],a[0:3]
R a[168:171],v5,34816
R a[172:175],v6,34816
M a[0:3],a[164:167],a[36:39],a[0:3]
T a[96:97],v1,0
T a[98:99],v1,1024
M a[4:7],a[164:167],a[44:47],a[4:7]
SA m0,s24,16384
M a[4:7],a[160:163],a[40:43],a[4:7]
buffer_load_dwordx4 v12, s[48:51], s22 offen offset:0   lds
M a[8:11],a[160:163],a[48:51],a[8:11]
v_and_b32 v20, 31, v0
M a[8:11],a[164:167],a[52:55],a[8:11]
v_lshlrev_b32 v20, 2, v20
M a[12:15],a[164:167],a[60:63],a[12:15]
s_nop 0
T a[100:101],v1,8192
T a[102:103],v1,9216
M a[12:15],a[160:163],a[56:59],a[12:15]
v_add_u32 v21, 163584, v20
M a[16:19],a[160:163],a[64:67],a[16:19]
buffer_load_dwordx4 v13, s[48:51], s22 offen offset:1024   lds
M a[16:19],a[164:167],a[68:71],a[16:19]
ds_read_b32 v19, v21
M a[20:23],a[164:167],a[76:79],a[20:23]
ds_read_b32 v21, v21 offset:64
M a[20:23],a[160:163],a[72:75],a[20:23]
s_min_u32 s64, s20, 1
T a[104:105],v2,0
T a[106:107],v2,1024
M a[24:27],a[160:163],a[80:83],a[24:27]
s_lshl_b32 s64, s64, 29
v_and_b32 v22, 32, v0
M a[24:27],a[164:167],a[84:87],a[24:27]
s_waitcnt lgkmcnt(8)
buffer_load_dwordx4 v14, s[48:51], s22 offen offset:2048   lds
M a[28:31],a[164:167],a[92:95],a[28:31]
v_lshl_or_b32 v20, v22, 24, v20
M a[28:31],a[160:163],a[88:91],a[28:31]
v_or_b32 v20, s64, v20
M v[32:35],a[168:171],a[32:35],v[32:35]
R a[160:163],v5,36864
R a[164:167],v6,36864
M v[32:35],a[172:175],a[36:39],v[32:35]
T a[108:109],v2,8192
T a[110:111],v2,9216
M v[36:39],a[172:175],a[44:47],v[36:39]
buffer_load_dwordx4 v15, s[48:51], s22 offen offset:3072   lds
M v[36:39],a[168:171],a[40:43],v[36:39]
s_sub_u32 s22, s22, 1048448
v_and_b32 v22, 16, v0
M v[40:43],a[168:171],a[48:51],v[40:43]
v_lshl_or_b32 v18, v22, 25, v20
s_and_b32 s27, s42, 7
M v[40:43],a[172:175],a[52:55],v[40:43]
s_lshl_b32 s72, s30, 7
T a[112:113],v3,0
T a[114:115],v3,1024
M v[44:47],a[172:175],a[60:63],v[44:47]
SA m0,s23,49152
SA s72,s72,104857600
s_lshl_b32 s64, s41, 3
M v[44:47],a[168:171],a[56:59],v[44:47]
SA s27,s27,s64
buffer_load_dwordx4 v8, s[16:19], s21 offen offset:0  nt lds
M v[48:51],a[168:171],a[64:67],v[48:51]
s_lshl_b32 s27, s27, 2
M v[48:51],a[172:175],a[68:71],v[48:51]
SA s27,s27,s20
M v[52:55],a[172:175],a[76:79],v[52:55]
s_mul_i32 s27, s27, 7168
T a[116:117],v3,8192
T a[118:119],v3,9216
M v[52:55],a[168:171],a[72:75],v[52:55]
s_mov_b32 s60, s90
M v[56:59],a[168:171],a[80:83],v[56:59]
s_and_b32 s61, s91, 0xffff
buffer_load_dwordx4 v9, s[16:19], s21 offen offset:1024  nt lds
M v[56:59],a[172:175],a[84:87],v[56:59]
s_waitcnt lgkmcnt(6)
buffer_store_dword v21, v20, s[8:11], s72 offen sc1
M v[60:63],a[172:175],a[92:95],v[60:63]
s_mov_b32 s62, 3670016
M v[60:63],a[168:171],a[88:91],v[60:63]
s_mov_b32 s63, 0x20000
T a[120:121],v4,0
T a[122:123],v4,1024
M v[64:67],a[160:163],a[32:35],v[64:67]
R a[168:171],v5,38912
R a[172:175],v6,38912
M v[64:67],a[164:167],a[36:39],v[64:67]
buffer_load_dwordx4 v10, s[16:19], s21 offen offset:2048  nt lds
M v[68:71],a[164:167],a[44:47],v[68:71]
M v[68:71],a[160:163],a[40:43],v[68:71]
M v[72:75],a[160:163],a[48:51],v[72:75]
s_nop 0
T a[124:125],v4,8192
T a[126:127],v4,9216
M v[72:75],a[164:167],a[52:55],v[72:75]
M v[76:79],a[164:167],a[60:63],v[76:79]
buffer_load_dwordx4 v11, s[16:19], s21 offen offset:3072  nt lds
M v[76:79],a[160:163],a[56:59],v[76:79]
SA s21,s21,524160
M v[80:83],a[160:163],a[64:67],v[80:83]
M v[80:83],a[164:167],a[68:71],v[80:83]
M v[84:87],a[164:167],a[76:79],v[84:87]
M v[84:87],a[160:163],a[72:75],v[84:87]
M v[88:91],a[160:163],a[80:83],v[88:91]
M v[88:91],a[164:167],a[84:87],v[88:91]
s_waitcnt lgkmcnt(2)
M v[92:95],a[164:167],a[92:95],v[92:95]
s_waitcnt vmcnt(17) lgkmcnt(0)
M v[92:95],a[160:163],a[88:91],v[92:95]
s_barrier
M v[96:99],a[168:171],a[32:35],v[96:99]
R a[160:163],v5,49152
R a[164:167],v6,49152
M v[96:99],a[172:175],a[36:39],v[96:99]
M v[100:103],a[172:175],a[44:47],v[100:103]
SA m0,s24,32768
T a[128:129],v1,16384
T a[130:131],v1,17408
M v[100:103],a[168:171],a[40:43],v[100:103]
buffer_load_dwordx4 v12, s[48:51], s22 offen offset:0   lds
M v[104:107],a[168:171],a[48:51],v[104:107]
v_min_u32 v16, 40, v0
v_lshlrev_b32 v16, 2, v16
M v[104:107],a[172:175],a[52:55],v[104:107]
buffer_load_dword v17, v16, s[12:15], 0 offen sc1
M v[108:111],a[172:175],a[60:63],v[108:111]
M v[108:111],a[168:171],a[56:59],v[108:111]
M v[112:115],a[168:171],a[64:67],v[112:115]
M v[112:115],a[172:175],a[68:71],v[112:115]
s_nop 0
T a[132:133],v1,24576
T a[134:135],v1,25600
M v[116:119],a[172:175],a[76:79],v[116:119]
buffer_load_dwordx4 v13, s[48:51], s22 offen offset:1024   lds
M v[116:119],a[168:171],a[72:75],v[116:119]
M v[120:123],a[168:171],a[80:83],v[120:123]
M v[120:123],a[172:175],a[84:87],v[120:123]
s_waitcnt lgkmcnt(4)
M v[124:127],a[172:175],a[92:95],v[124:127]
M v[124:127],a[168:171],a[88:91],v[124:127]
M v[128:131],a[160:163],a[32:35],v[128:131]
R a[168:171],v5,51200
R a[172:175],v6,51200
M v[128:131],a[164:167],a[36:39],v[128:131]
T a[136:137],v2,16384
T a[138:139],v2,17408
M v[132:135],a[164:167],a[44:47],v[132:135]
buffer_load_dwordx4 v14, s[48:51], s22 offen offset:2048   lds
M v[132:135],a[160:163],a[40:43],v[132:135]
M v[136:139],a[160:163],a[48:51],v[136:139]
M v[136:139],a[164:167],a[52:55],v[136:139]
M v[140:143],a[164:167],a[60:63],v[140:143]
M v[140:143],a[160:163],a[56:59],v[140:143]
s_nop 0
T a[140:141],v2,24576
T a[142:143],v2,25600
M v[144:147],a[160:163],a[64:67],v[144:147]
buffer_load_dwordx4 v15, s[48:51], s22 offen offset:3072   lds
M v[144:147],a[164:167],a[68:71],v[144:147]
SA s22,s22,1048576
M v[148:151],a[164:167],a[76:79],v[148:151]
M v[148:151],a[160:163],a[72:75],v[148:151]
M v[152:155],a[160:163],a[80:83],v[152:155]
M v[152:155],a[164:167],a[84:87],v[152:155]
s_waitcnt lgkmcnt(4)
M v[156:159],a[164:167],a[92:95],v[156:159]
SA m0,s23,0
T a[144:145],v3,16384
T a[146:147],v3,17408
M v[156:159],a[160:163],a[88:91],v[156:159]
buffer_load_dwordx4 v8, s[16:19], s21 offen offset:0  nt lds
M v[160:163],a[168:171],a[32:35],v[160:163]
R a[160:163],v5,53248
R a[164:167],v6,53248
M v[160:163],a[172:175],a[36:39],v[160:163]
buffer_load_dword a240, v26, s[60:63], s27 offen offset:0
M v[164:167],a[172:175],a[44:47],v[164:167]
SA s27,s27,2048
M v[164:167],a[168:171],a[40:43],v[164:167]
M v[168:171],a[168:171],a[48:51],v[168:171]
M v[168:171],a[172:175],a[52:55],v[168:171]
s_nop 0
T a[148:149],v3,24576
T a[150:151],v3,25600
M v[172:175],a[172:175],a[60:63],v[172:175]
buffer_load_dwordx4 v9, s[16:19], s21 offen offset:1024  nt lds
M v[172:175],a[168:171],a[56:59],v[172:175]
M v[176:179],a[168:171],a[64:67],v[176:179]
M v[176:179],a[172:175],a[68:71],v[176:179]
M v[180:183],a[172:175],a[76:79],v[180:183]
M v[180:183],a[168:171],a[72:75],v[180:183]
M v[184:187],a[168:171],a[80:83],v[184:187]
s_nop 0
T a[152:153],v4,16384
T a[154:155],v4,17408
M v[184:187],a[172:175],a[84:87],v[184:187]
s_waitcnt lgkmcnt(4)
buffer_load_dwordx4 v10, s[16:19], s21 offen offset:2048  nt lds
M v[188:191],a[172:175],a[92:95],v[188:191]
M v[188:191],a[168:171],a[88:91],v[188:191]
M v[192:195],a[160:163],a[32:35],v[192:195]
L_w_kv12:
s_cbranch_execz L_w_kv16
R a[168:171],v5,55296
R a[172:175],v6,55296
M v[192:195],a[164:167],a[36:39],v[192:195]
M v[196:199],a[164:167],a[44:47],v[196:199]
M v[196:199],a[160:163],a[40:43],v[196:199]
s_nop 0
T a[156:157],v4,24576
T a[158:159],v4,25600
M v[200:203],a[160:163],a[48:51],v[200:203]
buffer_load_dwordx4 v11, s[16:19], s21 offen offset:3072  nt lds
M v[200:203],a[164:167],a[52:55],v[200:203]
SA s21,s21,128
M v[204:207],a[164:167],a[60:63],v[204:207]
M v[204:207],a[160:163],a[56:59],v[204:207]
M v[208:211],a[160:163],a[64:67],v[208:211]
M v[208:211],a[164:167],a[68:71],v[208:211]
M v[212:215],a[164:167],a[76:79],v[212:215]
M v[212:215],a[160:163],a[72:75],v[212:215]
M v[216:219],a[160:163],a[80:83],v[216:219]
M v[216:219],a[164:167],a[84:87],v[216:219]
s_waitcnt lgkmcnt(2)
M v[220:223],a[164:167],a[92:95],v[220:223]
s_waitcnt vmcnt(19) lgkmcnt(0)
M v[220:223],a[160:163],a[88:91],v[220:223]
s_barrier
M v[224:227],a[168:171],a[32:35],v[224:227]
R a[160:163],v5,0
R a[164:167],v6,0
M v[224:227],a[172:175],a[36:39],v[224:227]
M v[228:231],a[172:175],a[44:47],v[228:231]
M v[228:231],a[168:171],a[40:43],v[228:231]
M v[232:235],a[168:171],a[48:51],v[232:235]
M v[232:235],a[172:175],a[52:55],v[232:235]
M v[236:239],a[172:175],a[60:63],v[236:239]
M v[236:239],a[168:171],a[56:59],v[236:239]
M v[240:243],a[168:171],a[64:67],v[240:243]
M v[240:243],a[172:175],a[68:71],v[240:243]
M v[244:247],a[172:175],a[76:79],v[244:247]
M v[244:247],a[168:171],a[72:75],v[244:247]
M v[248:251],a[168:171],a[80:83],v[248:251]
M v[248:251],a[172:175],a[84:87],v[248:251]
s_waitcnt lgkmcnt(0)
M v[252:255],a[172:175],a[92:95],v[252:255]
M v[252:255],a[168:171],a[88:91],v[252:255]
M a[0:3],a[160:163],a[96:99],a[0:3]
R a[168:171],v5,2048
R a[172:175],v6,2048
M a[0:3],a[164:167],a[100:103],a[0:3]
T a[32:33],v1,32768
T a[34:35],v1,33792
M a[4:7],a[164:167],a[108:111],a[4:7]
SA m0,s24,49152
M a[4:7],a[160:163],a[104:107],a[4:7]
buffer_load_dwordx4 v12, s[48:51], s22 offen offset:0   lds
M a[8:11],a[160:163],a[112:115],a[8:11]
M a[8:11],a[164:167],a[116:119],a[8:11]
M a[12:15],a[164:167],a[124:127],a[12:15]
s_nop 0
T a[36:37],v1,40960
T a[38:39],v1,41984
M a[12:15],a[160:163],a[120:123],a[12:15]
M a[16:19],a[160:163],a[128:131],a[16:19]
buffer_load_dwordx4 v13, s[48:51], s22 offen offset:1024   lds
M a[16:19],a[164:167],a[132:135],a[16:19]
M a[20:23],a[164:167],a[140:143],a[20:23]
M a[20:23],a[160:163],a[136:139],a[20:23]
s_nop 0
T a[40:41],v2,32768
T a[42:43],v2,33792
M a[24:27],a[160:163],a[144:147],a[24:27]
M a[24:27],a[164:167],a[148:151],a[24:27]
s_waitcnt lgkmcnt(6)
buffer_load_dwordx4 v14, s[48:51], s22 offen offset:2048   lds
M a[28:31],a[164:167],a[156:159],a[28:31]
M a[28:31],a[160:163],a[152:155],a[28:31]
M v[32:35],a[168:171],a[96:99],v[32:35]
R a[160:163],v5,4096
R a[164:167],v6,4096
M v[32:35],a[172:175],a[100:103],v[32:35]
T a[44:45],v2,40960
T a[46:47],v2,41984
M v[36:39],a[172:175],a[108:111],v[36:39]
buffer_load_dwordx4 v15, s[48:51], s22 offen offset:3072   lds
M v[36:39],a[168:171],a[104:107],v[36:39]
s_sub_u32 s22, s22, 1048448
M v[40:43],a[168:171],a[112:115],v[40:43]
M v[40:43],a[172:175],a[116:119],v[40:43]
s_nop 0
T a[48:49],v3,32768
T a[50:51],v3,33792
M v[44:47],a[172:175],a[124:127],v[44:47]
SA m0,s23,16384
M v[44:47],a[168:171],a[120:123],v[44:47]
buffer_load_dwordx4 v8, s[16:19], s21 offen offset:0  nt lds
M v[48:51],a[168:171],a[128:131],v[48:51]
M v[48:51],a[172:175],a[132:135],v[48:51]
M v[52:55],a[172:175],a[140:143],v[52:55]
s_nop 0
T a[52:53],v3,40960
T a[54:55],v3,41984
M v[52:55],a[168:171],a[136:139],v[52:55]
M v[56:59],a[168:171],a[144:147],v[56:59]
buffer_load_dwordx4 v9, s[16:19], s21 offen offset:1024  nt lds
M v[56:59],a[172:175],a[148:151],v[56:59]
s_waitcnt lgkmcnt(6)
M v[60:63],a[172:175],a[156:159],v[60:63]
M v[60:63],a[168:171],a[152:155],v[60:63]
s_nop 0
T a[56:57],v4,32768
T a[58:59],v4,33792
M v[64:67],a[160:163],a[96:99],v[64:67]
R a[168:171],v5,6144
R a[172:175],v6,6144
M v[64:67],a[164:167],a[100:103],v[64:67]
buffer_load_dwordx4 v10, s[16:19], s21 offen offset:2048  nt lds
M v[68:71],a[164:167],a[108:111],v[68:71]
M v[68:71],a[160:163],a[104:107],v[68:71]
M v[72:75],a[160:163],a[112:115],v[72:75]
s_nop 0
T a[60:61],v4,40960
T a[62:63],v4,41984
M v[72:75],a[164:167],a[116:119],v[72:75]
M v[76:79],a[164:167],a[124:127],v[76:79]
buffer_load_dwordx4 v11, s[16:19], s21 offen offset:3072  nt lds
M v[76:79],a[160:163],a[120:123],v[76:79]
SA s21,s21,524160
M v[80:83],a[160:163],a[128:131],v[80:83]
M v[80:83],a[164:167],a[132:135],v[80:83]
M v[84:87],a[164:167],a[140:143],v[84:87]
M v[84:87],a[160:163],a[136:139],v[84:87]
M v[88:91],a[160:163],a[144:147],v[88:91]
M v[88:91],a[164:167],a[148:151],v[88:91]
s_waitcnt lgkmcnt(2)
M v[92:95],a[164:167],a[156:159],v[92:95]
s_waitcnt vmcnt(18) lgkmcnt(0)
M v[92:95],a[160:163],a[152:155],v[92:95]
s_barrier
M v[96:99],a[168:171],a[96:99],v[96:99]
R a[160:163],v5,16384
R a[164:167],v6,16384
M v[96:99],a[172:175],a[100:103],v[96:99]
M v[100:103],a[172:175],a[108:111],v[100:103]
SA m0,s24,0
T a[64:65],v1,49152
T a[66:67],v1,50176
M v[100:103],a[168:171],a[104:107],v[100:103]
buffer_load_dwordx4 v12, s[48:51], s22 offen offset:0   lds
M v[104:107],a[168:171],a[112:115],v[104:107]
M v[104:107],a[172:175],a[116:119],v[104:107]
M v[108:111],a[172:175],a[124:127],v[108:111]
M v[108:111],a[168:171],a[120:123],v[108:111]
M v[112:115],a[168:171],a[128:131],v[112:115]
M v[112:115],a[172:175],a[132:135],v[112:115]
s_nop 0
T a[68:69],v1,57344
T a[70:71],v1,58368
M v[116:119],a[172:175],a[140:143],v[116:119]
buffer_load_dwordx4 v13, s[48:51], s22 offen offset:1024   lds
M v[116:119],a[168:171],a[136:139],v[116:119]
M v[120:123],a[168:171],a[144:147],v[120:123]
M v[120:123],a[172:175],a[148:151],v[120:123]
s_waitcnt lgkmcnt(4)
M v[124:127],a[172:175],a[156:159],v[124:127]
M v[124:127],a[168:171],a[152:155],v[124:127]
M v[128:131],a[160:163],a[96:99],v[128:131]
R a[168:171],v5,18432
R a[172:175],v6,18432
M v[128:131],a[164:167],a[100:103],v[128:131]
T a[72:73],v2,49152
T a[74:75],v2,50176
M v[132:135],a[164:167],a[108:111],v[132:135]
buffer_load_dwordx4 v14, s[48:51], s22 offen offset:2048   lds
M v[132:135],a[160:163],a[104:107],v[132:135]
M v[136:139],a[160:163],a[112:115],v[136:139]
M v[136:139],a[164:167],a[116:119],v[136:139]
M v[140:143],a[164:167],a[124:127],v[140:143]
M v[140:143],a[160:163],a[120:123],v[140:143]
s_nop 0
T a[76:77],v2,57344
T a[78:79],v2,58368
M v[144:147],a[160:163],a[128:131],v[144:147]
buffer_load_dwordx4 v15, s[48:51], s22 offen offset:3072   lds
M v[144:147],a[164:167],a[132:135],v[144:147]
SA s22,s22,1048576
M v[148:151],a[164:167],a[140:143],v[148:151]
M v[148:151],a[160:163],a[136:139],v[148:151]
M v[152:155],a[160:163],a[144:147],v[152:155]
M v[152:155],a[164:167],a[148:151],v[152:155]
s_waitcnt lgkmcnt(4)
M v[156:159],a[164:167],a[156:159],v[156:159]
SA m0,s23,32768
T a[80:81],v3,49152
T a[82:83],v3,50176
M v[156:159],a[160:163],a[152:155],v[156:159]
buffer_load_dwordx4 v8, s[16:19], s21 offen offset:0  nt lds
M v[160:163],a[168:171],a[96:99],v[160:163]
R a[160:163],v5,20480
R a[164:167],v6,20480
M v[160:163],a[172:175],a[100:103],v[160:163]
buffer_load_dword a240, v26, s[60:63], s27 offen offset:0
M v[164:167],a[172:175],a[108:111],v[164:167]
SA s27,s27,2048
M v[164:167],a[168:171],a[104:107],v[164:167]
M v[168:171],a[168:171],a[112:115],v[168:171]
M v[168:171],a[172:175],a[116:119],v[168:171]
s_nop 0
T a[84:85],v3,57344
T a[86:87],v3,58368
M v[172:175],a[172:175],a[124:127],v[172:175]
buffer_load_dwordx4 v9, s[16:19], s21 offen offset:1024  nt lds
M v[172:175],a[168:171],a[120:123],v[172:175]
M v[176:179],a[168:171],a[128:131],v[176:179]
M v[176:179],a[172:175],a[132:135],v[176:179]
M v[180:183],a[172:175],a[140:143],v[180:183]
M v[180:183],a[168:171],a[136:139],v[180:183]
M v[184:187],a[168:171],a[144:147],v[184:187]
s_nop 0
T a[88:89],v4,49152
T a[90:91],v4,50176
M v[184:187],a[172:175],a[148:151],v[184:187]
s_waitcnt lgkmcnt(4)
buffer_load_dwordx4 v10, s[16:19], s21 offen offset:2048  nt lds
M v[188:191],a[172:175],a[156:159],v[188:191]
M v[188:191],a[168:171],a[152:155],v[188:191]
M v[192:195],a[160:163],a[96:99],v[192:195]
R a[168:171],v5,22528
R a[172:175],v6,22528
M v[192:195],a[164:167],a[100:103],v[192:195]
M v[196:199],a[164:167],a[108:111],v[196:199]
M v[196:199],a[160:163],a[104:107],v[196:199]
s_nop 0
T a[92:93],v4,57344
T a[94:95],v4,58368
M v[200:203],a[160:163],a[112:115],v[200:203]
buffer_load_dwordx4 v11, s[16:19], s21 offen offset:3072  nt lds
M v[200:203],a[164:167],a[116:119],v[200:203]
SA s21,s21,128
M v[204:207],a[164:167],a[124:127],v[204:207]
M v[204:207],a[160:163],a[120:123],v[204:207]
M v[208:211],a[160:163],a[128:131],v[208:211]
M v[208:211],a[164:167],a[132:135],v[208:211]
M v[212:215],a[164:167],a[140:143],v[212:215]
M v[212:215],a[160:163],a[136:139],v[212:215]
M v[216:219],a[160:163],a[144:147],v[216:219]
M v[216:219],a[164:167],a[148:151],v[216:219]
s_waitcnt lgkmcnt(2)
M v[220:223],a[164:167],a[156:159],v[220:223]
s_waitcnt vmcnt(17) lgkmcnt(0)
M v[220:223],a[160:163],a[152:155],v[220:223]
s_barrier
M v[224:227],a[168:171],a[96:99],v[224:227]
R a[160:163],v5,32768
R a[164:167],v6,32768
M v[224:227],a[172:175],a[100:103],v[224:227]
v_cmp_ne_u32 vcc, 1, v17
M v[228:231],a[172:175],a[108:111],v[228:231]
s_nop 0
M v[228:231],a[168:171],a[104:107],v[228:231]
s_cbranch_vccnz L_zs1
L_zr1:
M v[232:235],a[168:171],a[112:115],v[232:235]
M v[232:235],a[172:175],a[116:119],v[232:235]
s_lshl_b32 s72, s30, 6
M v[236:239],a[172:175],a[124:127],v[236:239]
SA s72,s72,104914944
M v[236:239],a[168:171],a[120:123],v[236:239]
buffer_store_dword v19, v18, s[8:11], s72 offen sc1
M v[240:243],a[168:171],a[128:131],v[240:243]
M v[240:243],a[172:175],a[132:135],v[240:243]
M v[244:247],a[172:175],a[140:143],v[244:247]
M v[244:247],a[168:171],a[136:139],v[244:247]
M v[248:251],a[168:171],a[144:147],v[248:251]
M v[248:251],a[172:175],a[148:151],v[248:251]
s_waitcnt lgkmcnt(0)
M v[252:255],a[172:175],a[156:159],v[252:255]
M v[252:255],a[168:171],a[152:155],v[252:255]
M a[0:3],a[160:163],a[32:35],a[0:3]
R a[168:171],v5,34816
R a[172:175],v6,34816
M a[0:3],a[164:167],a[36:39],a[0:3]
T a[96:97],v1,0
T a[98:99],v1,1024
M a[4:7],a[164:167],a[44:47],a[4:7]
SA m0,s24,16384
M a[4:7],a[160:163],a[40:43],a[4:7]
buffer_load_dwordx4 v12, s[48:51], s22 offen offset:0   lds
M a[8:11],a[160:163],a[48:51],a[8:11]
M a[8:11],a[164:167],a[52:55],a[8:11]
s_mul_i32 s64, s41, 229376
M a[12:15],a[164:167],a[60:63],a[12:15]
SA s72,s90,s64
T a[100:101],v1,8192
T a[102:103],v1,9216
M a[12:15],a[160:163],a[56:59],a[12:15]
s_addc_u32 s73, s91, 0
M a[16:19],a[160:163],a[64:67],a[16:19]
s_sub_u32 s75, 3670016, s64
buffer_load_dwordx4 v13, s[48:51], s22 offen offset:1024   lds
M a[16:19],a[164:167],a[68:71],a[16:19]
s_mov_b32 s12, s72
M a[20:23],a[164:167],a[76:79],a[20:23]
s_and_b32 s13, s73, 0xffff
M a[20:23],a[160:163],a[72:75],a[20:23]
s_mov_b32 s14, s75
T a[104:105],v2,0
T a[106:107],v2,1024
M a[24:27],a[160:163],a[80:83],a[24:27]
s_mov_b32 s15, 0x20000
M a[24:27],a[164:167],a[84:87],a[24:27]
s_waitcnt lgkmcnt(6)
buffer_load_dwordx4 v14, s[48:51], s22 offen offset:2048   lds
M a[28:31],a[164:167],a[92:95],a[28:31]
M a[28:31],a[160:163],a[88:91],a[28:31]
M v[32:35],a[168:171],a[32:35],v[32:35]
R a[160:163],v5,36864
R a[164:167],v6,36864
M v[32:35],a[172:175],a[36:39],v[32:35]
T a[108:109],v2,8192
T a[110:111],v2,9216
M v[36:39],a[172:175],a[44:47],v[36:39]
buffer_load_dwordx4 v15, s[48:51], s22 offen offset:3072   lds
M v[36:39],a[168:171],a[40:43],v[36:39]
s_sub_u32 s22, s22, 1048448
M v[40:43],a[168:171],a[48:51],v[40:43]
M v[40:43],a[172:175],a[52:55],v[40:43]
s_nop 0
T a[112:113],v3,0
T a[114:115],v3,1024
M v[44:47],a[172:175],a[60:63],v[44:47]
SA m0,s23,49152
M v[44:47],a[168:171],a[56:59],v[44:47]
buffer_load_dwordx4 v8, s[16:19], s21 offen offset:0  nt lds
M v[48:51],a[168:171],a[64:67],v[48:51]
M v[48:51],a[172:175],a[68:71],v[48:51]
M v[52:55],a[172:175],a[76:79],v[52:55]
s_nop 0
T a[116:117],v3,8192
T a[118:119],v3,9216
M v[52:55],a[168:171],a[72:75],v[52:55]
M v[56:59],a[168:171],a[80:83],v[56:59]
buffer_load_dwordx4 v9, s[16:19], s21 offen offset:1024  nt lds
M v[56:59],a[172:175],a[84:87],v[56:59]
s_waitcnt lgkmcnt(6)
M v[60:63],a[172:175],a[92:95],v[60:63]
M v[60:63],a[168:171],a[88:91],v[60:63]
s_nop 0
T a[120:121],v4,0
T a[122:123],v4,1024
M v[64:67],a[160:163],a[32:35],v[64:67]
R a[168:171],v5,38912
R a[172:175],v6,38912
M v[64:67],a[164:167],a[36:39],v[64:67]
buffer_load_dwordx4 v10, s[16:19], s21 offen offset:2048  nt lds
M v[68:71],a[164:167],a[44:47],v[68:71]
M v[68:71],a[160:163],a[40:43],v[68:71]
M v[72:75],a[160:163],a[48:51],v[72:75]
s_nop 0
T a[124:125],v4,8192
T a[126:127],v4,9216
M v[72:75],a[164:167],a[52:55],v[72:75]
M v[76:79],a[164:167],a[60:63],v[76:79]
buffer_load_dwordx4 v11, s[16:19], s21 offen offset:3072  nt lds
M v[76:79],a[160:163],a[56:59],v[76:79]
SA s21,s21,524160
M v[80:83],a[160:163],a[64:67],v[80:83]
M v[80:83],a[164:167],a[68:71],v[80:83]
M v[84:87],a[164:167],a[76:79],v[84:87]
M v[84:87],a[160:163],a[72:75],v[84:87]
M v[88:91],a[160:163],a[80:83],v[88:91]
M v[88:91],a[164:167],a[84:87],v[88:91]
s_waitcnt lgkmcnt(2)
M v[92:95],a[164:167],a[92:95],v[92:95]
s_waitcnt vmcnt(18) lgkmcnt(0)
M v[92:95],a[160:163],a[88:91],v[92:95]
s_barrier
M v[96:99],a[168:171],a[32:35],v[96:99]
R a[160:163],v5,49152
R a[164:167],v6,49152
M v[96:99],a[172:175],a[36:39],v[96:99]
M v[100:103],a[172:175],a[44:47],v[100:103]
SA m0,s24,32768
T a[128:129],v1,16384
T a[130:131],v1,17408
M v[100:103],a[168:171],a[40:43],v[100:103]
buffer_load_dwordx4 v12, s[48:51], s22 offen offset:0   lds
M v[104:107],a[168:171],a[48:51],v[104:107]
M v[104:107],a[172:175],a[52:55],v[104:107]
M v[108:111],a[172:175],a[60:63],v[108:111]
M v[108:111],a[168:171],a[56:59],v[108:111]
M v[112:115],a[168:171],a[64:67],v[112:115]
M v[112:115],a[172:175],a[68:71],v[112:115]
s_nop 0
T a[132:133],v1,24576
T a[134:135],v1,25600
M v[116:119],a[172:175],a[76:79],v[116:119]
buffer_load_dwordx4 v13, s[48:51], s22 offen offset:1024   lds
M v[116:119],a[168:171],a[72:75],v[116:119]
M v[120:123],a[168:171],a[80:83],v[120:123]
M v[120:123],a[172:175],a[84:87],v[120:123]
s_waitcnt lgkmcnt(4)
M v[124:127],a[172:175],a[92:95],v[124:127]
M v[124:127],a[168:171],a[88:91],v[124:127]
M v[128:131],a[160:163],a[32:35],v[128:131]
R a[168:171],v5,51200
R a[172:175],v6,51200
M v[128:131],a[164:167],a[36:39],v[128:131]
T a[136:137],v2,16384
T a[138:139],v2,17408
M v[132:135],a[164:167],a[44:47],v[132:135]
buffer_load_dwordx4 v14, s[48:51], s22 offen offset:2048   lds
M v[132:135],a[160:163],a[40:43],v[132:135]
M v[136:139],a[160:163],a[48:51],v[136:139]
M v[136:139],a[164:167],a[52:55],v[136:139]
M v[140:143],a[164:167],a[60:63],v[140:143]
M v[140:143],a[160:163],a[56:59],v[140:143]
s_nop 0
T a[140:141],v2,24576
T a[142:143],v2,25600
M v[144:147],a[160:163],a[64:67],v[144:147]
buffer_load_dwordx4 v15, s[48:51], s22 offen offset:3072   lds
M v[144:147],a[164:167],a[68:71],v[144:147]
SA s22,s22,1048576
M v[148:151],a[164:167],a[76:79],v[148:151]
M v[148:151],a[160:163],a[72:75],v[148:151]
M v[152:155],a[160:163],a[80:83],v[152:155]
M v[152:155],a[164:167],a[84:87],v[152:155]
s_waitcnt lgkmcnt(4)
M v[156:159],a[164:167],a[92:95],v[156:159]
SA m0,s23,0
T a[144:145],v3,16384
T a[146:147],v3,17408
M v[156:159],a[160:163],a[88:91],v[156:159]
buffer_load_dwordx4 v8, s[16:19], s21 offen offset:0  nt lds
M v[160:163],a[168:171],a[32:35],v[160:163]
R a[160:163],v5,53248
R a[164:167],v6,53248
M v[160:163],a[172:175],a[36:39],v[160:163]
buffer_load_dword a240, v26, s[60:63], s27 offen offset:0
M v[164:167],a[172:175],a[44:47],v[164:167]
SA s27,s27,2048
M v[164:167],a[168:171],a[40:43],v[164:167]
M v[168:171],a[168:171],a[48:51],v[168:171]
M v[168:171],a[172:175],a[52:55],v[168:171]
s_nop 0
T a[148:149],v3,24576
T a[150:151],v3,25600
M v[172:175],a[172:175],a[60:63],v[172:175]
buffer_load_dwordx4 v9, s[16:19], s21 offen offset:1024  nt lds
M v[172:175],a[168:171],a[56:59],v[172:175]
M v[176:179],a[168:171],a[64:67],v[176:179]
M v[176:179],a[172:175],a[68:71],v[176:179]
M v[180:183],a[172:175],a[76:79],v[180:183]
M v[180:183],a[168:171],a[72:75],v[180:183]
M v[184:187],a[168:171],a[80:83],v[184:187]
s_nop 0
T a[152:153],v4,16384
T a[154:155],v4,17408
M v[184:187],a[172:175],a[84:87],v[184:187]
s_waitcnt lgkmcnt(4)
buffer_load_dwordx4 v10, s[16:19], s21 offen offset:2048  nt lds
M v[188:191],a[172:175],a[92:95],v[188:191]
M v[188:191],a[168:171],a[88:91],v[188:191]
M v[192:195],a[160:163],a[32:35],v[192:195]
R a[168:171],v5,55296
R a[172:175],v6,55296
M v[192:195],a[164:167],a[36:39],v[192:195]
M v[196:199],a[164:167],a[44:47],v[196:199]
M v[196:199],a[160:163],a[40:43],v[196:199]
s_nop 0
T a[156:157],v4,24576
T a[158:159],v4,25600
M v[200:203],a[160:163],a[48:51],v[200:203]
buffer_load_dwordx4 v11, s[16:19], s21 offen offset:3072  nt lds
M v[200:203],a[164:167],a[52:55],v[200:203]
SA s21,s21,128
M v[204:207],a[164:167],a[60:63],v[204:207]
M v[204:207],a[160:163],a[56:59],v[204:207]
M v[208:211],a[160:163],a[64:67],v[208:211]
M v[208:211],a[164:167],a[68:71],v[208:211]
M v[212:215],a[164:167],a[76:79],v[212:215]
M v[212:215],a[160:163],a[72:75],v[212:215]
M v[216:219],a[160:163],a[80:83],v[216:219]
M v[216:219],a[164:167],a[84:87],v[216:219]
s_waitcnt lgkmcnt(2)
M v[220:223],a[164:167],a[92:95],v[220:223]
s_waitcnt vmcnt(18) lgkmcnt(0)
M v[220:223],a[160:163],a[88:91],v[220:223]
s_barrier
M v[224:227],a[168:171],a[32:35],v[224:227]
R a[160:163],v5,0
R a[164:167],v6,0
M v[224:227],a[172:175],a[36:39],v[224:227]
M v[228:231],a[172:175],a[44:47],v[228:231]
M v[228:231],a[168:171],a[40:43],v[228:231]
M v[232:235],a[168:171],a[48:51],v[232:235]
M v[232:235],a[172:175],a[52:55],v[232:235]
M v[236:239],a[172:175],a[60:63],v[236:239]
M v[236:239],a[168:171],a[56:59],v[236:239]
M v[240:243],a[168:171],a[64:67],v[240:243]
M v[240:243],a[172:175],a[68:71],v[240:243]
M v[244:247],a[172:175],a[76:79],v[244:247]
M v[244:247],a[168:171],a[72:75],v[244:247]
M v[248:251],a[168:171],a[80:83],v[248:251]
M v[248:251],a[172:175],a[84:87],v[248:251]
s_waitcnt lgkmcnt(0)
M v[252:255],a[172:175],a[92:95],v[252:255]
M v[252:255],a[168:171],a[88:91],v[252:255]
M a[0:3],a[160:163],a[96:99],a[0:3]
R a[168:171],v5,2048
R a[172:175],v6,2048
M a[0:3],a[164:167],a[100:103],a[0:3]
T a[32:33],v1,32768
T a[34:35],v1,33792
M a[4:7],a[164:167],a[108:111],a[4:7]
SA m0,s24,49152
M a[4:7],a[160:163],a[104:107],a[4:7]
buffer_load_dwordx4 v12, s[48:51], s22 offen offset:0   lds
M a[8:11],a[160:163],a[112:115],a[8:11]
M a[8:11],a[164:167],a[116:119],a[8:11]
M a[12:15],a[164:167],a[124:127],a[12:15]
s_nop 0
T a[36:37],v1,40960
T a[38:39],v1,41984
M a[12:15],a[160:163],a[120:123],a[12:15]
M a[16:19],a[160:163],a[128:131],a[16:19]
buffer_load_dwordx4 v13, s[48:51], s22 offen offset:1024   lds
M a[16:19],a[164:167],a[132:135],a[16:19]
M a[20:23],a[164:167],a[140:143],a[20:23]
M a[20:23],a[160:163],a[136:139],a[20:23]
s_nop 0
T a[40:41],v2,32768
T a[42:43],v2,33792
M a[24:27],a[160:163],a[144:147],a[24:27]
M a[24:27],a[164:167],a[148:151],a[24:27]
s_waitcnt lgkmcnt(6)
buffer_load_dwordx4 v14, s[48:51], s22 offen offset:2048   lds
M a[28:31],a[164:167],a[156:159],a[28:31]
M a[28:31],a[160:163],a[152:155],a[28:31]
M v[32:35],a[168:171],a[96:99],v[32:35]
R a[160:163],v5,4096
R a[164:167],v6,4096
M v[32:35],a[172:175],a[100:103],v[32:35]
T a[44:45],v2,40960
T a[46:47],v2,41984
L_w_kv13:
s_cbranch_execz L_w_kv17
M v[36:39],a[172:175],a[108:111],v[36:39]
buffer_load_dwordx4 v15, s[48:51], s22 offen offset:3072   lds
M v[36:39],a[168:171],a[104:107],v[36:39]
s_sub_u32 s22, s22, 1048448
M v[40:43],a[168:171],a[112:115],v[40:43]
M v[40:43],a[172:175],a[116:119],v[40:43]
s_nop 0
T a[48:49],v3,32768
T a[50:51],v3,33792
M v[44:47],a[172:175],a[124:127],v[44:47]
SA m0,s23,16384
M v[44:47],a[168:171],a[120:123],v[44:47]
buffer_load_dwordx4 v8, s[16:19], s21 offen offset:0  nt lds
M v[48:51],a[168:171],a[128:131],v[48:51]
M v[48:51],a[172:175],a[132:135],v[48:51]
M v[52:55],a[172:175],a[140:143],v[52:55]
s_nop 0
T a[52:53],v3,40960
T a[54:55],v3,41984
M v[52:55],a[168:171],a[136:139],v[52:55]
M v[56:59],a[168:171],a[144:147],v[56:59]
buffer_load_dwordx4 v9, s[16:19], s21 offen offset:1024  nt lds
M v[56:59],a[172:175],a[148:151],v[56:59]
s_waitcnt lgkmcnt(6)
M v[60:63],a[172:175],a[156:159],v[60:63]
M v[60:63],a[168:171],a[152:155],v[60:63]
s_nop 0
T a[56:57],v4,32768
T a[58:59],v4,33792
M v[64:67],a[160:163],a[96:99],v[64:67]
R a[168:171],v5,6144
R a[172:175],v6,6144
M v[64:67],a[164:167],a[100:103],v[64:67]
buffer_load_dwordx4 v10, s[16:19], s21 offen offset:2048  nt lds
M v[68:71],a[164:167],a[108:111],v[68:71]
M v[68:71],a[160:163],a[104:107],v[68:71]
M v[72:75],a[160:163],a[112:115],v[72:75]
s_nop 0
T a[60:61],v4,40960
T a[62:63],v4,41984
M v[72:75],a[164:167],a[116:119],v[72:75]
M v[76:79],a[164:167],a[124:127],v[76:79]
buffer_load_dwordx4 v11, s[16:19], s21 offen offset:3072  nt lds
M v[76:79],a[160:163],a[120:123],v[76:79]
SA s21,s21,524160
M v[80:83],a[160:163],a[128:131],v[80:83]
M v[80:83],a[164:167],a[132:135],v[80:83]
M v[84:87],a[164:167],a[140:143],v[84:87]
M v[84:87],a[160:163],a[136:139],v[84:87]
M v[88:91],a[160:163],a[144:147],v[88:91]
M v[88:91],a[164:167],a[148:151],v[88:91]
s_waitcnt lgkmcnt(2)
M v[92:95],a[164:167],a[156:159],v[92:95]
s_waitcnt vmcnt(17) lgkmcnt(0)
M v[92:95],a[160:163],a[152:155],v[92:95]
s_barrier
M v[96:99],a[168:171],a[96:99],v[96:99]
R a[160:163],v5,16384
R a[164:167],v6,16384
M v[96:99],a[172:175],a[100:103],v[96:99]
M v[100:103],a[172:175],a[108:111],v[100:103]
SA m0,s24,0
T a[64:65],v1,49152
T a[66:67],v1,50176
M v[100:103],a[168:171],a[104:107],v[100:103]
buffer_load_dwordx4 v12, s[48:51], s22 offen offset:0   lds
M v[104:107],a[168:171],a[112:115],v[104:107]
M v[104:107],a[172:175],a[116:119],v[104:107]
M v[108:111],a[172:175],a[124:127],v[108:111]
M v[108:111],a[168:171],a[120:123],v[108:111]
M v[112:115],a[168:171],a[128:131],v[112:115]
M v[112:115],a[172:175],a[132:135],v[112:115]
s_nop 0
T a[68:69],v1,57344
T a[70:71],v1,58368
M v[116:119],a[172:175],a[140:143],v[116:119]
buffer_load_dwordx4 v13, s[48:51], s22 offen offset:1024   lds
M v[116:119],a[168:171],a[136:139],v[116:119]
M v[120:123],a[168:171],a[144:147],v[120:123]
M v[120:123],a[172:175],a[148:151],v[120:123]
s_waitcnt lgkmcnt(4)
M v[124:127],a[172:175],a[156:159],v[124:127]
M v[124:127],a[168:171],a[152:155],v[124:127]
M v[128:131],a[160:163],a[96:99],v[128:131]
R a[168:171],v5,18432
R a[172:175],v6,18432
M v[128:131],a[164:167],a[100:103],v[128:131]
T a[72:73],v2,49152
T a[74:75],v2,50176
M v[132:135],a[164:167],a[108:111],v[132:135]
buffer_load_dwordx4 v14, s[48:51], s22 offen offset:2048   lds
M v[132:135],a[160:163],a[104:107],v[132:135]
M v[136:139],a[160:163],a[112:115],v[136:139]
M v[136:139],a[164:167],a[116:119],v[136:139]
M v[140:143],a[164:167],a[124:127],v[140:143]
M v[140:143],a[160:163],a[120:123],v[140:143]
s_nop 0
T a[76:77],v2,57344
T a[78:79],v2,58368
M v[144:147],a[160:163],a[128:131],v[144:147]
buffer_load_dwordx4 v15, s[48:51], s22 offen offset:3072   lds
M v[144:147],a[164:167],a[132:135],v[144:147]
SA s22,s22,1048576
M v[148:151],a[164:167],a[140:143],v[148:151]
M v[148:151],a[160:163],a[136:139],v[148:151]
M v[152:155],a[160:163],a[144:147],v[152:155]
M v[152:155],a[164:167],a[148:151],v[152:155]
s_waitcnt lgkmcnt(4)
M v[156:159],a[164:167],a[156:159],v[156:159]
SA m0,s23,32768
T a[80:81],v3,49152
T a[82:83],v3,50176
M v[156:159],a[160:163],a[152:155],v[156:159]
buffer_load_dwordx4 v8, s[16:19], s21 offen offset:0  nt lds
M v[160:163],a[168:171],a[96:99],v[160:163]
R a[160:163],v5,20480
R a[164:167],v6,20480
M v[160:163],a[172:175],a[100:103],v[160:163]
buffer_load_dword a240, v26, s[60:63], s27 offen offset:0
M v[164:167],a[172:175],a[108:111],v[164:167]
SA s27,s27,2048
M v[164:167],a[168:171],a[104:107],v[164:167]
M v[168:171],a[168:171],a[112:115],v[168:171]
M v[168:171],a[172:175],a[116:119],v[168:171]
s_nop 0
T a[84:85],v3,57344
T a[86:87],v3,58368
M v[172:175],a[172:175],a[124:127],v[172:175]
buffer_load_dwordx4 v9, s[16:19], s21 offen offset:1024  nt lds
M v[172:175],a[168:171],a[120:123],v[172:175]
M v[176:179],a[168:171],a[128:131],v[176:179]
M v[176:179],a[172:175],a[132:135],v[176:179]
M v[180:183],a[172:175],a[140:143],v[180:183]
M v[180:183],a[168:171],a[136:139],v[180:183]
M v[184:187],a[168:171],a[144:147],v[184:187]
s_nop 0
T a[88:89],v4,49152
T a[90:91],v4,50176
M v[184:187],a[172:175],a[148:151],v[184:187]
s_waitcnt lgkmcnt(4)
buffer_load_dwordx4 v10, s[16:19], s21 offen offset:2048  nt lds
M v[188:191],a[172:175],a[156:159],v[188:191]
M v[188:191],a[168:171],a[152:155],v[188:191]
M v[192:195],a[160:163],a[96:99],v[192:195]
R a[168:171],v5,22528
R a[172:175],v6,22528
M v[192:195],a[164:167],a[100:103],v[192:195]
M v[196:199],a[164:167],a[108:111],v[196:199]
M v[196:199],a[160:163],a[104:107],v[196:199]
s_nop 0
T a[92:93],v4,57344
T a[94:95],v4,58368
M v[200:203],a[160:163],a[112:115],v[200:203]
buffer_load_dwordx4 v11, s[16:19], s21 offen offset:3072  nt lds
M v[200:203],a[164:167],a[116:119],v[200:203]
SA s21,s21,128
M v[204:207],a[164:167],a[124:127],v[204:207]
M v[204:207],a[160:163],a[120:123],v[204:207]
M v[208:211],a[160:163],a[128:131],v[208:211]
M v[208:211],a[164:167],a[132:135],v[208:211]
M v[212:215],a[164:167],a[140:143],v[212:215]
M v[212:215],a[160:163],a[136:139],v[212:215]
M v[216:219],a[160:163],a[144:147],v[216:219]
M v[216:219],a[164:167],a[148:151],v[216:219]
s_waitcnt lgkmcnt(2)
M v[220:223],a[164:167],a[156:159],v[220:223]
s_waitcnt vmcnt(17) lgkmcnt(0)
M v[220:223],a[160:163],a[152:155],v[220:223]
s_barrier
M v[224:227],a[168:171],a[96:99],v[224:227]
R a[160:163],v5,32768
R a[164:167],v6,32768
M v[224:227],a[172:175],a[100:103],v[224:227]
M v[228:231],a[172:175],a[108:111],v[228:231]
M v[228:231],a[168:171],a[104:107],v[228:231]
M v[232:235],a[168:171],a[112:115],v[232:235]
M v[232:235],a[172:175],a[116:119],v[232:235]
M v[236:239],a[172:175],a[124:127],v[236:239]
M v[236:239],a[168:171],a[120:123],v[236:239]
M v[240:243],a[168:171],a[128:131],v[240:243]
M v[240:243],a[172:175],a[132:135],v[240:243]
M v[244:247],a[172:175],a[140:143],v[244:247]
M v[244:247],a[168:171],a[136:139],v[244:247]
M v[248:251],a[168:171],a[144:147],v[248:251]
M v[248:251],a[172:175],a[148:151],v[248:251]
s_waitcnt lgkmcnt(0)
M v[252:255],a[172:175],a[156:159],v[252:255]
M v[252:255],a[168:171],a[152:155],v[252:255]
M a[0:3],a[160:163],a[32:35],a[0:3]
R a[168:171],v5,34816
R a[172:175],v6,34816
M a[0:3],a[164:167],a[36:39],a[0:3]
T a[96:97],v1,0
T a[98:99],v1,1024
M a[4:7],a[164:167],a[44:47],a[4:7]
SA m0,s24,16384
M a[4:7],a[160:163],a[40:43],a[4:7]
buffer_load_dwordx4 v12, s[48:51], s22 offen offset:0   lds
M a[8:11],a[160:163],a[48:51],a[8:11]
M a[8:11],a[164:167],a[52:55],a[8:11]
M a[12:15],a[164:167],a[60:63],a[12:15]
s_nop 0
T a[100:101],v1,8192
T a[102:103],v1,9216
M a[12:15],a[160:163],a[56:59],a[12:15]
M a[16:19],a[160:163],a[64:67],a[16:19]
buffer_load_dwordx4 v13, s[48:51], s22 offen offset:1024   lds
M a[16:19],a[164:167],a[68:71],a[16:19]
M a[20:23],a[164:167],a[76:79],a[20:23]
M a[20:23],a[160:163],a[72:75],a[20:23]
s_nop 0
T a[104:105],v2,0
T a[106:107],v2,1024
M a[24:27],a[160:163],a[80:83],a[24:27]
M a[24:27],a[164:167],a[84:87],a[24:27]
s_waitcnt lgkmcnt(6)
buffer_load_dwordx4 v14, s[48:51], s22 offen offset:2048   lds
M a[28:31],a[164:167],a[92:95],a[28:31]
M a[28:31],a[160:163],a[88:91],a[28:31]
M v[32:35],a[168:171],a[32:35],v[32:35]
R a[160:163],v5,36864
R a[164:167],v6,36864
M v[32:35],a[172:175],a[36:39],v[32:35]
T a[108:109],v2,8192
T a[110:111],v2,9216
M v[36:39],a[172:175],a[44:47],v[36:39]
buffer_load_dwordx4 v15, s[48:51], s22 offen offset:3072   lds
M v[36:39],a[168:171],a[40:43],v[36:39]
s_sub_u32 s22, s22, 1048448
M v[40:43],a[168:171],a[48:51],v[40:43]
M v[40:43],a[172:175],a[52:55],v[40:43]
s_nop 0
T a[112:113],v3,0
T a[114:115],v3,1024
M v[44:47],a[172:175],a[60:63],v[44:47]
SA m0,s23,49152
M v[44:47],a[168:171],a[56:59],v[44:47]
buffer_load_dwordx4 v8, s[16:19], s21 offen offset:0  nt lds
M v[48:51],a[168:171],a[64:67],v[48:51]
M v[48:51],a[172:175],a[68:71],v[48:51]
M v[52:55],a[172:175],a[76:79],v[52:55]
s_nop 0
T a[116:117],v3,8192
T a[118:119],v3,9216
M v[52:55],a[168:171],a[72:75],v[52:55]
M v[56:59],a[168:171],a[80:83],v[56:59]
buffer_load_dwordx4 v9, s[16:19], s21 offen offset:1024  nt lds
M v[56:59],a[172:175],a[84:87],v[56:59]
s_waitcnt lgkmcnt(6)
M v[60:63],a[172:175],a[92:95],v[60:63]
M v[60:63],a[168:171],a[88:91],v[60:63]
s_nop 0
T a[120:121],v4,0
T a[122:123],v4,1024
M v[64:67],a[160:163],a[32:35],v[64:67]
R a[168:171],v5,38912
R a[172:175],v6,38912
M v[64:67],a[164:167],a[36:39],v[64:67]
buffer_load_dwordx4 v10, s[16:19], s21 offen offset:2048  nt lds
M v[68:71],a[164:167],a[44:47],v[68:71]
M v[68:71],a[160:163],a[40:43],v[68:71]
M v[72:75],a[160:163],a[48:51],v[72:75]
s_nop 0
T a[124:125],v4,8192
T a[126:127],v4,9216
M v[72:75],a[164:167],a[52:55],v[72:75]
M v[76:79],a[164:167],a[60:63],v[76:79]
buffer_load_dwordx4 v11, s[16:19], s21 offen offset:3072  nt lds
M v[76:79],a[160:163],a[56:59],v[76:79]
SA s21,s21,524160
M v[80:83],a[160:163],a[64:67],v[80:83]
M v[80:83],a[164:167],a[68:71],v[80:83]
M v[84:87],a[164:167],a[76:79],v[84:87]
M v[84:87],a[160:163],a[72:75],v[84:87]
M v[88:91],a[160:163],a[80:83],v[88:91]
M v[88:91],a[164:167],a[84:87],v[88:91]
s_waitcnt lgkmcnt(2)
M v[92:95],a[164:167],a[92:95],v[92:95]
s_waitcnt vmcnt(17) lgkmcnt(0)
M v[92:95],a[160:163],a[88:91],v[92:95]
s_barrier
M v[96:99],a[168:171],a[32:35],v[96:99]
R a[160:163],v5,49152
R a[164:167],v6,49152
M v[96:99],a[172:175],a[36:39],v[96:99]
M v[100:103],a[172:175],a[44:47],v[100:103]
SA m0,s24,32768
T a[128:129],v1,16384
T a[130:131],v1,17408
M v[100:103],a[168:171],a[40:43],v[100:103]
buffer_load_dwordx4 v12, s[48:51], s22 offen offset:0   lds
M v[104:107],a[168:171],a[48:51],v[104:107]
M v[104:107],a[172:175],a[52:55],v[104:107]
M v[108:111],a[172:175],a[60:63],v[108:111]
M v[108:111],a[168:171],a[56:59],v[108:111]
M v[112:115],a[168:171],a[64:67],v[112:115]
M v[112:115],a[172:175],a[68:71],v[112:115]
s_nop 0
T a[132:133],v1,24576
T a[134:135],v1,25600
M v[116:119],a[172:175],a[76:79],v[116:119]
buffer_load_dwordx4 v13, s[48:51], s22 offen offset:1024   lds
M v[116:119],a[168:171],a[72:75],v[116:119]
M v[120:123],a[168:171],a[80:83],v[120:123]
s_and_b32 s64, s42, 7
s_lshl_b32 s64, s64, 2
M v[120:123],a[172:175],a[84:87],v[120:123]
s_waitcnt lgkmcnt(4)
SA s64,s64,s20
M v[124:127],a[172:175],a[92:95],v[124:127]
s_mul_i32 s64, s64, 114688
v_bfe_u32 v28, v0, 2, 2
v_and_b32 v29, 3, v0
M v[124:127],a[168:171],a[88:91],v[124:127]
v_lshlrev_b32 v29, 7, v29
v_lshl_add_u32 v28, v28, 13, v29
M v[128:131],a[160:163],a[32:35],v[128:131]
R a[168:171],v5,51200
R a[172:175],v6,51200
M v[128:131],a[164:167],a[36:39],v[128:131]
T a[136:137],v2,16384
T a[138:139],v2,17408
M v[132:135],a[164:167],a[44:47],v[132:135]
buffer_load_dwordx4 v14, s[48:51], s22 offen offset:2048   lds
M v[132:135],a[160:163],a[40:43],v[132:135]
v_add_u32 v23, s64, v28
v_and_b32 v28, 48, v0
M v[136:139],a[160:163],a[48:51],v[136:139]
v_lshl_add_u32 v23, v28, 24, v23
M v[136:139],a[164:167],a[52:55],v[136:139]
M v[140:143],a[164:167],a[60:63],v[140:143]
M v[140:143],a[160:163],a[56:59],v[140:143]
s_nop 0
T a[140:141],v2,24576
T a[142:143],v2,25600
M v[144:147],a[160:163],a[64:67],v[144:147]
buffer_load_dwordx4 v15, s[48:51], s22 offen offset:3072   lds
M v[144:147],a[164:167],a[68:71],v[144:147]
SA s22,s22,1048576
M v[148:151],a[164:167],a[76:79],v[148:151]
M v[148:151],a[160:163],a[72:75],v[148:151]
M v[152:155],a[160:163],a[80:83],v[152:155]
M v[152:155],a[164:167],a[84:87],v[152:155]
s_waitcnt lgkmcnt(4)
M v[156:159],a[164:167],a[92:95],v[156:159]
SA m0,s23,0
T a[144:145],v3,16384
T a[146:147],v3,17408
M v[156:159],a[160:163],a[88:91],v[156:159]
buffer_load_dwordx4 v8, s[16:19], s21 offen offset:0  nt lds
M v[160:163],a[168:171],a[32:35],v[160:163]
R a[160:163],v5,53248
R a[164:167],v6,53248
M v[160:163],a[172:175],a[36:39],v[160:163]
M v[164:167],a[172:175],a[44:47],v[164:167]
M v[164:167],a[168:171],a[40:43],v[164:167]
M v[168:171],a[168:171],a[48:51],v[168:171]
M v[168:171],a[172:175],a[52:55],v[168:171]
s_nop 0
T a[148:149],v3,24576
T a[150:151],v3,25600
M v[172:175],a[172:175],a[60:63],v[172:175]
buffer_load_dwordx4 v9, s[16:19], s21 offen offset:1024  nt lds
M v[172:175],a[168:171],a[56:59],v[172:175]
M v[176:179],a[168:171],a[64:67],v[176:179]
M v[176:179],a[172:175],a[68:71],v[176:179]
M v[180:183],a[172:175],a[76:79],v[180:183]
M v[180:183],a[168:171],a[72:75],v[180:183]
M v[184:187],a[168:171],a[80:83],v[184:187]
s_nop 0
T a[152:153],v4,16384
T a[154:155],v4,17408
M v[184:187],a[172:175],a[84:87],v[184:187]
s_waitcnt lgkmcnt(4)
buffer_load_dwordx4 v10, s[16:19], s21 offen offset:2048  nt lds
M v[188:191],a[172:175],a[92:95],v[188:191]
M v[188:191],a[168:171],a[88:91],v[188:191]
M v[192:195],a[160:163],a[32:35],v[192:195]
R a[168:171],v5,55296
R a[172:175],v6,55296
M v[192:195],a[164:167],a[36:39],v[192:195]
M v[196:199],a[164:167],a[44:47],v[196:199]
M v[196:199],a[160:163],a[40:43],v[196:199]
s_nop 0
T a[156:157],v4,24576
T a[158:159],v4,25600
M v[200:203],a[160:163],a[48:51],v[200:203]
buffer_load_dwordx4 v11, s[16:19], s21 offen offset:3072  nt lds
M v[200:203],a[164:167],a[52:55],v[200:203]
SA s21,s21,128
M v[204:207],a[164:167],a[60:63],v[204:207]
M v[204:207],a[160:163],a[56:59],v[204:207]
M v[208:211],a[160:163],a[64:67],v[208:211]
M v[208:211],a[164:167],a[68:71],v[208:211]
M v[212:215],a[164:167],a[76:79],v[212:215]
M v[212:215],a[160:163],a[72:75],v[212:215]
M v[216:219],a[160:163],a[80:83],v[216:219]
M v[216:219],a[164:167],a[84:87],v[216:219]
s_waitcnt lgkmcnt(2)
M v[220:223],a[164:167],a[92:95],v[220:223]
s_waitcnt vmcnt(16) lgkmcnt(0)
M v[220:223],a[160:163],a[88:91],v[220:223]
s_barrier
M v[224:227],a[168:171],a[32:35],v[224:227]
R a[160:163],v5,0
R a[164:167],v6,0
M v[224:227],a[172:175],a[36:39],v[224:227]
buffer_load_dword a240, v23, s[52:55], 0 offen offset:0
M v[228:231],a[172:175],a[44:47],v[228:231]
v_add_u32 v23, 32768, v23
M v[228:231],a[168:171],a[40:43],v[228:231]
M v[232:235],a[168:171],a[48:51],v[232:235]
M v[232:235],a[172:175],a[52:55],v[232:235]
M v[236:239],a[172:175],a[60:63],v[236:239]
M v[236:239],a[168:171],a[56:59],v[236:239]
M v[240:243],a[168:171],a[64:67],v[240:243]
M v[240:243],a[172:175],a[68:71],v[240:243]
M v[244:247],a[172:175],a[76:79],v[244:247]
M v[244:247],a[168:171],a[72:75],v[244:247]
M v[248:251],a[168:171],a[80:83],v[248:251]
M v[248:251],a[172:175],a[84:87],v[248:251]
s_waitcnt lgkmcnt(0)
M v[252:255],a[172:175],a[92:95],v[252:255]
M v[252:255],a[168:171],a[88:91],v[252:255]
M a[0:3],a[160:163],a[96:99],a[0:3]
R a[168:171],v5,2048
R a[172:175],v6,2048
M a[0:3],a[164:167],a[100:103],a[0:3]
T a[32:33],v1,32768
T a[34:35],v1,33792
M a[4:7],a[164:167],a[108:111],a[4:7]
SA m0,s24,49152
M a[4:7],a[160:163],a[104:107],a[4:7]
buffer_load_dwordx4 v12, s[48:51], s22 offen offset:0   lds
M a[8:11],a[160:163],a[112:115],a[8:11]
M a[8:11],a[164:167],a[116:119],a[8:11]
M a[12:15],a[164:167],a[124:127],a[12:15]
s_nop 0
T a[36:37],v1,40960
T a[38:39],v1,41984
M a[12:15],a[160:163],a[120:123],a[12:15]
M a[16:19],a[160:163],a[128:131],a[16:19]
buffer_load_dwordx4 v13, s[48:51], s22 offen offset:1024   lds
M a[16:19],a[164:167],a[132:135],a[16:19]
M a[20:23],a[164:167],a[140:143],a[20:23]
M a[20:23],a[160:163],a[136:139],a[20:23]
s_nop 0
T a[40:41],v2,32768
T a[42:43],v2,33792
M a[24:27],a[160:163],a[144:147],a[24:27]
M a[24:27],a[164:167],a[148:151],a[24:27]
s_waitcnt lgkmcnt(6)
buffer_load_dwordx4 v14, s[48:51], s22 offen offset:2048   lds
M a[28:31],a[164:167],a[156:159],a[28:31]
M a[28:31],a[160:163],a[152:155],a[28:31]
M v[32:35],a[168:171],a[96:99],v[32:35]
R a[160:163],v5,4096
R a[164:167],v6,4096
M v[32:35],a[172:175],a[100:103],v[32:35]
T a[44:45],v2,40960
T a[46:47],v2,41984
M v[36:39],a[172:175],a[108:111],v[36:39]
buffer_load_dwordx4 v15, s[48:51], s22 offen offset:3072   lds
M v[36:39],a[168:171],a[104:107],v[36:39]
s_sub_u32 s22, s22, 1048448
M v[40:43],a[168:171],a[112:115],v[40:43]
M v[40:43],a[172:175],a[116:119],v[40:43]
s_nop 0
T a[48:49],v3,32768
T a[50:51],v3,33792
M v[44:47],a[172:175],a[124:127],v[44:47]
SA m0,s23,16384
M v[44:47],a[168:171],a[120:123],v[44:47]
buffer_load_dwordx4 v8, s[16:19], s21 offen offset:0  nt lds
M v[48:51],a[168:171],a[128:131],v[48:51]
M v[48:51],a[172:175],a[132:135],v[48:51]
M v[52:55],a[172:175],a[140:143],v[52:55]
s_nop 0
T a[52:53],v3,40960
T a[54:55],v3,41984
M v[52:55],a[168:171],a[136:139],v[52:55]
M v[56:59],a[168:171],a[144:147],v[56:59]
buffer_load_dwordx4 v9, s[16:19], s21 offen offset:1024  nt lds
M v[56:59],a[172:175],a[148:151],v[56:59]
s_waitcnt lgkmcnt(6)
M v[60:63],a[172:175],a[156:159],v[60:63]
M v[60:63],a[168:171],a[152:155],v[60:63]
s_nop 0
T a[56:57],v4,32768
T a[58:59],v4,33792
M v[64:67],a[160:163],a[96:99],v[64:67]
R a[168:171],v5,6144
R a[172:175],v6,6144
M v[64:67],a[164:167],a[100:103],v[64:67]
buffer_load_dwordx4 v10, s[16:19], s21 offen offset:2048  nt lds
M v[68:71],a[164:167],a[108:111],v[68:71]
M v[68:71],a[160:163],a[104:107],v[68:71]
M v[72:75],a[160:163],a[112:115],v[72:75]
s_nop 0
T a[60:61],v4,40960
T a[62:63],v4,41984
M v[72:75],a[164:167],a[116:119],v[72:75]
M v[76:79],a[164:167],a[124:127],v[76:79]
buffer_load_dwordx4 v11, s[16:19], s21 offen offset:3072  nt lds
M v[76:79],a[160:163],a[120:123],v[76:79]
SA s21,s21,524160
M v[80:83],a[160:163],a[128:131],v[80:83]
M v[80:83],a[164:167],a[132:135],v[80:83]
M v[84:87],a[164:167],a[140:143],v[84:87]
M v[84:87],a[160:163],a[136:139],v[84:87]
M v[88:91],a[160:163],a[144:147],v[88:91]
M v[88:91],a[164:167],a[148:151],v[88:91]
s_waitcnt lgkmcnt(2)
M v[92:95],a[164:167],a[156:159],v[92:95]
s_waitcnt vmcnt(17) lgkmcnt(0)
M v[92:95],a[160:163],a[152:155],v[92:95]
s_barrier
M v[96:99],a[168:171],a[96:99],v[96:99]
R a[160:163],v5,16384
R a[164:167],v6,16384
M v[96:99],a[172:175],a[100:103],v[96:99]
M v[100:103],a[172:175],a[108:111],v[100:103]
SA m0,s24,0
T a[64:65],v1,49152
T a[66:67],v1,50176
M v[100:103],a[168:171],a[104:107],v[100:103]
buffer_load_dwordx4 v12, s[48:51], s22 offen offset:0   lds
M v[104:107],a[168:171],a[112:115],v[104:107]
M v[104:107],a[172:175],a[116:119],v[104:107]
M v[108:111],a[172:175],a[124:127],v[108:111]
M v[108:111],a[168:171],a[120:123],v[108:111]
M v[112:115],a[168:171],a[128:131],v[112:115]
M v[112:115],a[172:175],a[132:135],v[112:115]
s_nop 0
T a[68:69],v1,57344
T a[70:71],v1,58368
M v[116:119],a[172:175],a[140:143],v[116:119]
buffer_load_dwordx4 v13, s[48:51], s22 offen offset:1024   lds
M v[116:119],a[168:171],a[136:139],v[116:119]
M v[120:123],a[168:171],a[144:147],v[120:123]
M v[120:123],a[172:175],a[148:151],v[120:123]
s_waitcnt lgkmcnt(4)
M v[124:127],a[172:175],a[156:159],v[124:127]
M v[124:127],a[168:171],a[152:155],v[124:127]
L_w_kv14:
s_cbranch_execz L_w_kv18
M v[128:131],a[160:163],a[96:99],v[128:131]
R a[168:171],v5,18432
R a[172:175],v6,18432
M v[128:131],a[164:167],a[100:103],v[128:131]
T a[72:73],v2,49152
T a[74:75],v2,50176
M v[132:135],a[164:167],a[108:111],v[132:135]
buffer_load_dwordx4 v14, s[48:51], s22 offen offset:2048   lds
M v[132:135],a[160:163],a[104:107],v[132:135]
M v[136:139],a[160:163],a[112:115],v[136:139]
M v[136:139],a[164:167],a[116:119],v[136:139]
M v[140:143],a[164:167],a[124:127],v[140:143]
M v[140:143],a[160:163],a[120:123],v[140:143]
s_nop 0
T a[76:77],v2,57344
T a[78:79],v2,58368
M v[144:147],a[160:163],a[128:131],v[144:147]
buffer_load_dwordx4 v15, s[48:51], s22 offen offset:3072   lds
M v[144:147],a[164:167],a[132:135],v[144:147]
SA s22,s22,1048576
M v[148:151],a[164:167],a[140:143],v[148:151]
M v[148:151],a[160:163],a[136:139],v[148:151]
M v[152:155],a[160:163],a[144:147],v[152:155]
M v[152:155],a[164:167],a[148:151],v[152:155]
s_waitcnt lgkmcnt(4)
M v[156:159],a[164:167],a[156:159],v[156:159]
SA m0,s23,32768
T a[80:81],v3,49152
T a[82:83],v3,50176
M v[156:159],a[160:163],a[152:155],v[156:159]
buffer_load_dwordx4 v8, s[16:19], s21 offen offset:0  nt lds
M v[160:163],a[168:171],a[96:99],v[160:163]
R a[160:163],v5,20480
R a[164:167],v6,20480
M v[160:163],a[172:175],a[100:103],v[160:163]
M v[164:167],a[172:175],a[108:111],v[164:167]
M v[164:167],a[168:171],a[104:107],v[164:167]
M v[168:171],a[168:171],a[112:115],v[168:171]
M v[168:171],a[172:175],a[116:119],v[168:171]
s_nop 0
T a[84:85],v3,57344
T a[86:87],v3,58368
M v[172:175],a[172:175],a[124:127],v[172:175]
buffer_load_dwordx4 v9, s[16:19], s21 offen offset:1024  nt lds
M v[172:175],a[168:171],a[120:123],v[172:175]
M v[176:179],a[168:171],a[128:131],v[176:179]
M v[176:179],a[172:175],a[132:135],v[176:179]
M v[180:183],a[172:175],a[140:143],v[180:183]
M v[180:183],a[168:171],a[136:139],v[180:183]
M v[184:187],a[168:171],a[144:147],v[184:187]
s_nop 0
T a[88:89],v4,49152
T a[90:91],v4,50176
M v[184:187],a[172:175],a[148:151],v[184:187]
s_waitcnt lgkmcnt(4)
buffer_load_dwordx4 v10, s[16:19], s21 offen offset:2048  nt lds
M v[188:191],a[172:175],a[156:159],v[188:191]
M v[188:191],a[168:171],a[152:155],v[188:191]
M v[192:195],a[160:163],a[96:99],v[192:195]
R a[168:171],v5,22528
R a[172:175],v6,22528
M v[192:195],a[164:167],a[100:103],v[192:195]
M v[196:199],a[164:167],a[108:111],v[196:199]
M v[196:199],a[160:163],a[104:107],v[196:199]
s_nop 0
T a[92:93],v4,57344
T a[94:95],v4,58368
M v[200:203],a[160:163],a[112:115],v[200:203]
buffer_load_dwordx4 v11, s[16:19], s21 offen offset:3072  nt lds
M v[200:203],a[164:167],a[116:119],v[200:203]
SA s21,s21,128
M v[204:207],a[164:167],a[124:127],v[204:207]
M v[204:207],a[160:163],a[120:123],v[204:207]
M v[208:211],a[160:163],a[128:131],v[208:211]
M v[208:211],a[164:167],a[132:135],v[208:211]
M v[212:215],a[164:167],a[140:143],v[212:215]
M v[212:215],a[160:163],a[136:139],v[212:215]
M v[216:219],a[160:163],a[144:147],v[216:219]
M v[216:219],a[164:167],a[148:151],v[216:219]
s_waitcnt lgkmcnt(2)
M v[220:223],a[164:167],a[156:159],v[220:223]
s_waitcnt vmcnt(17) lgkmcnt(0)
M v[220:223],a[160:163],a[152:155],v[220:223]
s_barrier
M v[224:227],a[168:171],a[96:99],v[224:227]
R a[160:163],v5,32768
R a[164:167],v6,32768
M v[224:227],a[172:175],a[100:103],v[224:227]
buffer_load_dword a240, v23, s[52:55], 0 offen offset:0
M v[228:231],a[172:175],a[108:111],v[228:231]
v_add_u32 v23, 32768, v23
M v[228:231],a[168:171],a[104:107],v[228:231]
M v[232:235],a[168:171],a[112:115],v[232:235]
M v[232:235],a[172:175],a[116:119],v[232:235]
M v[236:239],a[172:175],a[124:127],v[236:239]
M v[236:239],a[168:171],a[120:123],v[236:239]
M v[240:243],a[168:171],a[128:131],v[240:243]
M v[240:243],a[172:175],a[132:135],v[240:243]
M v[244:247],a[172:175],a[140:143],v[244:247]
M v[244:247],a[168:171],a[136:139],v[244:247]
M v[248:251],a[168:171],a[144:147],v[248:251]
M v[248:251],a[172:175],a[148:151],v[248:251]
s_waitcnt lgkmcnt(0)
M v[252:255],a[172:175],a[156:159],v[252:255]
M v[252:255],a[168:171],a[152:155],v[252:255]
M a[0:3],a[160:163],a[32:35],a[0:3]
R a[168:171],v5,34816
R a[172:175],v6,34816
M a[0:3],a[164:167],a[36:39],a[0:3]
T a[96:97],v1,0
T a[98:99],v1,1024
M a[4:7],a[164:167],a[44:47],a[4:7]
SA m0,s24,16384
M a[4:7],a[160:163],a[40:43],a[4:7]
buffer_load_dwordx4 v12, s[48:51], s22 offen offset:0   lds
M a[8:11],a[160:163],a[48:51],a[8:11]
M a[8:11],a[164:167],a[52:55],a[8:11]
M a[12:15],a[164:167],a[60:63],a[12:15]
s_nop 0
T a[100:101],v1,8192
T a[102:103],v1,9216
M a[12:15],a[160:163],a[56:59],a[12:15]
M a[16:19],a[160:163],a[64:67],a[16:19]
buffer_load_dwordx4 v13, s[48:51], s22 offen offset:1024   lds
M a[16:19],a[164:167],a[68:71],a[16:19]
M a[20:23],a[164:167],a[76:79],a[20:23]
M a[20:23],a[160:163],a[72:75],a[20:23]
s_nop 0
T a[104:105],v2,0
T a[106:107],v2,1024
M a[24:27],a[160:163],a[80:83],a[24:27]
M a[24:27],a[164:167],a[84:87],a[24:27]
s_waitcnt lgkmcnt(6)
buffer_load_dwordx4 v14, s[48:51], s22 offen offset:2048   lds
M a[28:31],a[164:167],a[92:95],a[28:31]
M a[28:31],a[160:163],a[88:91],a[28:31]
M v[32:35],a[168:171],a[32:35],v[32:35]
R a[160:163],v5,36864
R a[164:167],v6,36864
M v[32:35],a[172:175],a[36:39],v[32:35]
T a[108:109],v2,8192
T a[110:111],v2,9216
M v[36:39],a[172:175],a[44:47],v[36:39]
buffer_load_dwordx4 v15, s[48:51], s22 offen offset:3072   lds
M v[36:39],a[168:171],a[40:43],v[36:39]
s_sub_u32 s22, s22, 1048448
M v[40:43],a[168:171],a[48:51],v[40:43]
M v[40:43],a[172:175],a[52:55],v[40:43]
s_nop 0
T a[112:113],v3,0
T a[114:115],v3,1024
M v[44:47],a[172:175],a[60:63],v[44:47]
SA m0,s23,49152
M v[44:47],a[168:171],a[56:59],v[44:47]
buffer_load_dwordx4 v8, s[16:19], s21 offen offset:0  nt lds
M v[48:51],a[168:171],a[64:67],v[48:51]
M v[48:51],a[172:175],a[68:71],v[48:51]
M v[52:55],a[172:175],a[76:79],v[52:55]
s_nop 0
T a[116:117],v3,8192
T a[118:119],v3,9216
M v[52:55],a[168:171],a[72:75],v[52:55]
M v[56:59],a[168:171],a[80:83],v[56:59]
buffer_load_dwordx4 v9, s[16:19], s21 offen offset:1024  nt lds
M v[56:59],a[172:175],a[84:87],v[56:59]
s_waitcnt lgkmcnt(6)
M v[60:63],a[172:175],a[92:95],v[60:63]
M v[60:63],a[168:171],a[88:91],v[60:63]
s_nop 0
T a[120:121],v4,0
T a[122:123],v4,1024
M v[64:67],a[160:163],a[32:35],v[64:67]
R a[168:171],v5,38912
R a[172:175],v6,38912
M v[64:67],a[164:167],a[36:39],v[64:67]
buffer_load_dwordx4 v10, s[16:19], s21 offen offset:2048  nt lds
M v[68:71],a[164:167],a[44:47],v[68:71]
M v[68:71],a[160:163],a[40:43],v[68:71]
M v[72:75],a[160:163],a[48:51],v[72:75]
s_nop 0
T a[124:125],v4,8192
T a[126:127],v4,9216
M v[72:75],a[164:167],a[52:55],v[72:75]
M v[76:79],a[164:167],a[60:63],v[76:79]
buffer_load_dwordx4 v11, s[16:19], s21 offen offset:3072  nt lds
M v[76:79],a[160:163],a[56:59],v[76:79]
SA s21,s21,524160
M v[80:83],a[160:163],a[64:67],v[80:83]
M v[80:83],a[164:167],a[68:71],v[80:83]
M v[84:87],a[164:167],a[76:79],v[84:87]
M v[84:87],a[160:163],a[72:75],v[84:87]
M v[88:91],a[160:163],a[80:83],v[88:91]
M v[88:91],a[164:167],a[84:87],v[88:91]
s_waitcnt lgkmcnt(2)
M v[92:95],a[164:167],a[92:95],v[92:95]
s_waitcnt vmcnt(17) lgkmcnt(0)
M v[92:95],a[160:163],a[88:91],v[92:95]
s_barrier
M v[96:99],a[168:171],a[32:35],v[96:99]
R a[160:163],v5,49152
R a[164:167],v6,49152
M v[96:99],a[172:175],a[36:39],v[96:99]
M v[100:103],a[172:175],a[44:47],v[100:103]
SA m0,s24,32768
T a[128:129],v1,16384
T a[130:131],v1,17408
M v[100:103],a[168:171],a[40:43],v[100:103]
buffer_load_dwordx4 v12, s[48:51], s22 offen offset:0   lds
M v[104:107],a[168:171],a[48:51],v[104:107]
M v[104:107],a[172:175],a[52:55],v[104:107]
M v[108:111],a[172:175],a[60:63],v[108:111]
M v[108:111],a[168:171],a[56:59],v[108:111]
M v[112:115],a[168:171],a[64:67],v[112:115]
M v[112:115],a[172:175],a[68:71],v[112:115]
s_nop 0
T a[132:133],v1,24576
T a[134:135],v1,25600
M v[116:119],a[172:175],a[76:79],v[116:119]
buffer_load_dwordx4 v13, s[48:51], s22 offen offset:1024   lds
M v[116:119],a[168:171],a[72:75],v[116:119]
M v[120:123],a[168:171],a[80:83],v[120:123]
M v[120:123],a[172:175],a[84:87],v[120:123]
s_waitcnt lgkmcnt(4)
M v[124:127],a[172:175],a[92:95],v[124:127]
M v[124:127],a[168:171],a[88:91],v[124:127]
M v[128:131],a[160:163],a[32:35],v[128:131]
R a[168:171],v5,51200
R a[172:175],v6,51200
M v[128:131],a[164:167],a[36:39],v[128:131]
T a[136:137],v2,16384
T a[138:139],v2,17408
M v[132:135],a[164:167],a[44:47],v[132:135]
buffer_load_dwordx4 v14, s[48:51], s22 offen offset:2048   lds
M v[132:135],a[160:163],a[40:43],v[132:135]
M v[136:139],a[160:163],a[48:51],v[136:139]
M v[136:139],a[164:167],a[52:55],v[136:139]
M v[140:143],a[164:167],a[60:63],v[140:143]
M v[140:143],a[160:163],a[56:59],v[140:143]
s_nop 0
T a[140:141],v2,24576
T a[142:143],v2,25600
M v[144:147],a[160:163],a[64:67],v[144:147]
buffer_load_dwordx4 v15, s[48:51], s22 offen offset:3072   lds
M v[144:147],a[164:167],a[68:71],v[144:147]
SA s22,s22,1048576
M v[148:151],a[164:167],a[76:79],v[148:151]
M v[148:151],a[160:163],a[72:75],v[148:151]
M v[152:155],a[160:163],a[80:83],v[152:155]
M v[152:155],a[164:167],a[84:87],v[152:155]
s_waitcnt lgkmcnt(4)
M v[156:159],a[164:167],a[92:95],v[156:159]
SA m0,s23,0
T a[144:145],v3,16384
T a[146:147],v3,17408
M v[156:159],a[160:163],a[88:91],v[156:159]
buffer_load_dwordx4 v8, s[16:19], s21 offen offset:0  nt lds
M v[160:163],a[168:171],a[32:35],v[160:163]
R a[160:163],v5,53248
R a[164:167],v6,53248
M v[160:163],a[172:175],a[36:39],v[160:163]
M v[164:167],a[172:175],a[44:47],v[164:167]
M v[164:167],a[168:171],a[40:43],v[164:167]
M v[168:171],a[168:171],a[48:51],v[168:171]
M v[168:171],a[172:175],a[52:55],v[168:171]
s_nop 0
T a[148:149],v3,24576
T a[150:151],v3,25600
M v[172:175],a[172:175],a[60:63],v[172:175]
buffer_load_dwordx4 v9, s[16:19], s21 offen offset:1024  nt lds
M v[172:175],a[168:171],a[56:59],v[172:175]
M v[176:179],a[168:171],a[64:67],v[176:179]
M v[176:179],a[172:175],a[68:71],v[176:179]
M v[180:183],a[172:175],a[76:79],v[180:183]
M v[180:183],a[168:171],a[72:75],v[180:183]
M v[184:187],a[168:171],a[80:83],v[184:187]
s_nop 0
T a[152:153],v4,16384
T a[154:155],v4,17408
M v[184:187],a[172:175],a[84:87],v[184:187]
s_waitcnt lgkmcnt(4)
buffer_load_dwordx4 v10, s[16:19], s21 offen offset:2048  nt lds
M v[188:191],a[172:175],a[92:95],v[188:191]
M v[188:191],a[168:171],a[88:91],v[188:191]
M v[192:195],a[160:163],a[32:35],v[192:195]
R a[168:171],v5,55296
R a[172:175],v6,55296
M v[192:195],a[164:167],a[36:39],v[192:195]
M v[196:199],a[164:167],a[44:47],v[196:199]
M v[196:199],a[160:163],a[40:43],v[196:199]
s_nop 0
T a[156:157],v4,24576
T a[158:159],v4,25600
M v[200:203],a[160:163],a[48:51],v[200:203]
buffer_load_dwordx4 v11, s[16:19], s21 offen offset:3072  nt lds
M v[200:203],a[164:167],a[52:55],v[200:203]
SA s21,s21,128
M v[204:207],a[164:167],a[60:63],v[204:207]
M v[204:207],a[160:163],a[56:59],v[204:207]
M v[208:211],a[160:163],a[64:67],v[208:211]
M v[208:211],a[164:167],a[68:71],v[208:211]
M v[212:215],a[164:167],a[76:79],v[212:215]
M v[212:215],a[160:163],a[72:75],v[212:215]
M v[216:219],a[160:163],a[80:83],v[216:219]
M v[216:219],a[164:167],a[84:87],v[216:219]
s_waitcnt lgkmcnt(2)
M v[220:223],a[164:167],a[92:95],v[220:223]
s_waitcnt vmcnt(17) lgkmcnt(0)
M v[220:223],a[160:163],a[88:91],v[220:223]
s_barrier
M v[224:227],a[168:171],a[32:35],v[224:227]
R a[160:163],v5,0
R a[164:167],v6,0
M v[224:227],a[172:175],a[36:39],v[224:227]
buffer_load_dword a240, v23, s[52:55], 0 offen offset:0
M v[228:231],a[172:175],a[44:47],v[228:231]
v_add_u32 v23, 16384, v23
M v[228:231],a[168:171],a[40:43],v[228:231]
M v[232:235],a[168:171],a[48:51],v[232:235]
M v[232:235],a[172:175],a[52:55],v[232:235]
M v[236:239],a[172:175],a[60:63],v[236:239]
M v[236:239],a[168:171],a[56:59],v[236:239]
M v[240:243],a[168:171],a[64:67],v[240:243]
M v[240:243],a[172:175],a[68:71],v[240:243]
M v[244:247],a[172:175],a[76:79],v[244:247]
M v[244:247],a[168:171],a[72:75],v[244:247]
M v[248:251],a[168:171],a[80:83],v[248:251]
M v[248:251],a[172:175],a[84:87],v[248:251]
s_waitcnt lgkmcnt(0)
M v[252:255],a[172:175],a[92:95],v[252:255]
M v[252:255],a[168:171],a[88:91],v[252:255]
M a[0:3],a[160:163],a[96:99],a[0:3]
R a[168:171],v5,2048
R a[172:175],v6,2048
M a[0:3],a[164:167],a[100:103],a[0:3]
T a[32:33],v1,32768
T a[34:35],v1,33792
M a[4:7],a[164:167],a[108:111],a[4:7]
SA m0,s24,49152
M a[4:7],a[160:163],a[104:107],a[4:7]
buffer_load_dwordx4 v12, s[48:51], s22 offen offset:0   lds
M a[8:11],a[160:163],a[112:115],a[8:11]
M a[8:11],a[164:167],a[116:119],a[8:11]
M a[12:15],a[164:167],a[124:127],a[12:15]
s_nop 0
T a[36:37],v1,40960
T a[38:39],v1,41984
M a[12:15],a[160:163],a[120:123],a[12:15]
M a[16:19],a[160:163],a[128:131],a[16:19]
buffer_load_dwordx4 v13, s[48:51], s22 offen offset:1024   lds
M a[16:19],a[164:167],a[132:135],a[16:19]
M a[20:23],a[164:167],a[140:143],a[20:23]
M a[20:23],a[160:163],a[136:139],a[20:23]
s_nop 0
T a[40:41],v2,32768
T a[42:43],v2,33792
M a[24:27],a[160:163],a[144:147],a[24:27]
M a[24:27],a[164:167],a[148:151],a[24:27]
s_waitcnt lgkmcnt(6)
buffer_load_dwordx4 v14, s[48:51], s22 offen offset:2048   lds
M a[28:31],a[164:167],a[156:159],a[28:31]
M a[28:31],a[160:163],a[152:155],a[28:31]
M v[32:35],a[168:171],a[96:99],v[32:35]
R a[160:163],v5,4096
R a[164:167],v6,4096
M v[32:35],a[172:175],a[100:103],v[32:35]
T a[44:45],v2,40960
T a[46:47],v2,41984
M v[36:39],a[172:175],a[108:111],v[36:39]
buffer_load_dwordx4 v15, s[48:51], s22 offen offset:3072   lds
M v[36:39],a[168:171],a[104:107],v[36:39]
s_sub_u32 s22, s22, 1048448
M v[40:43],a[168:171],a[112:115],v[40:43]
M v[40:43],a[172:175],a[116:119],v[40:43]
s_nop 0
T a[48:49],v3,32768
T a[50:51],v3,33792
M v[44:47],a[172:175],a[124:127],v[44:47]
SA m0,s23,16384
M v[44:47],a[168:171],a[120:123],v[44:47]
buffer_load_dwordx4 v8, s[16:19], s21 offen offset:0  nt lds
M v[48:51],a[168:171],a[128:131],v[48:51]
M v[48:51],a[172:175],a[132:135],v[48:51]
M v[52:55],a[172:175],a[140:143],v[52:55]
s_nop 0
T a[52:53],v3,40960
T a[54:55],v3,41984
M v[52:55],a[168:171],a[136:139],v[52:55]
M v[56:59],a[168:171],a[144:147],v[56:59]
buffer_load_dwordx4 v9, s[16:19], s21 offen offset:1024  nt lds
M v[56:59],a[172:175],a[148:151],v[56:59]
s_waitcnt lgkmcnt(6)
M v[60:63],a[172:175],a[156:159],v[60:63]
M v[60:63],a[168:171],a[152:155],v[60:63]
s_nop 0
T a[56:57],v4,32768
T a[58:59],v4,33792
M v[64:67],a[160:163],a[96:99],v[64:67]
R a[168:171],v5,6144
R a[172:175],v6,6144
M v[64:67],a[164:167],a[100:103],v[64:67]
buffer_load_dwordx4 v10, s[16:19], s21 offen offset:2048  nt lds
M v[68:71],a[164:167],a[108:111],v[68:71]
M v[68:71],a[160:163],a[104:107],v[68:71]
M v[72:75],a[160:163],a[112:115],v[72:75]
s_nop 0
T a[60:61],v4,40960
T a[62:63],v4,41984
M v[72:75],a[164:167],a[116:119],v[72:75]
M v[76:79],a[164:167],a[124:127],v[76:79]
buffer_load_dwordx4 v11, s[16:19], s21 offen offset:3072  nt lds
M v[76:79],a[160:163],a[120:123],v[76:79]
SA s21,s21,524160
M v[80:83],a[160:163],a[128:131],v[80:83]
M v[80:83],a[164:167],a[132:135],v[80:83]
M v[84:87],a[164:167],a[140:143],v[84:87]
M v[84:87],a[160:163],a[136:139],v[84:87]
M v[88:91],a[160:163],a[144:147],v[88:91]
M v[88:91],a[164:167],a[148:151],v[88:91]
s_waitcnt lgkmcnt(2)
M v[92:95],a[164:167],a[156:159],v[92:95]
s_waitcnt vmcnt(17) lgkmcnt(0)
M v[92:95],a[160:163],a[152:155],v[92:95]
s_barrier
M v[96:99],a[168:171],a[96:99],v[96:99]
R a[160:163],v5,16384
R a[164:167],v6,16384
M v[96:99],a[172:175],a[100:103],v[96:99]
M v[100:103],a[172:175],a[108:111],v[100:103]
SA m0,s24,0
T a[64:65],v1,49152
T a[66:67],v1,50176
M v[100:103],a[168:171],a[104:107],v[100:103]
buffer_load_dwordx4 v12, s[48:51], s22 offen offset:0   lds
M v[104:107],a[168:171],a[112:115],v[104:107]
M v[104:107],a[172:175],a[116:119],v[104:107]
M v[108:111],a[172:175],a[124:127],v[108:111]
M v[108:111],a[168:171],a[120:123],v[108:111]
M v[112:115],a[168:171],a[128:131],v[112:115]
M v[112:115],a[172:175],a[132:135],v[112:115]
s_nop 0
T a[68:69],v1,57344
T a[70:71],v1,58368
M v[116:119],a[172:175],a[140:143],v[116:119]
buffer_load_dwordx4 v13, s[48:51], s22 offen offset:1024   lds
M v[116:119],a[168:171],a[136:139],v[116:119]
M v[120:123],a[168:171],a[144:147],v[120:123]
M v[120:123],a[172:175],a[148:151],v[120:123]
s_waitcnt lgkmcnt(4)
M v[124:127],a[172:175],a[156:159],v[124:127]
M v[124:127],a[168:171],a[152:155],v[124:127]
M v[128:131],a[160:163],a[96:99],v[128:131]
R a[168:171],v5,18432
R a[172:175],v6,18432
M v[128:131],a[164:167],a[100:103],v[128:131]
T a[72:73],v2,49152
T a[74:75],v2,50176
M v[132:135],a[164:167],a[108:111],v[132:135]
buffer_load_dwordx4 v14, s[48:51], s22 offen offset:2048   lds
M v[132:135],a[160:163],a[104:107],v[132:135]
M v[136:139],a[160:163],a[112:115],v[136:139]
M v[136:139],a[164:167],a[116:119],v[136:139]
M v[140:143],a[164:167],a[124:127],v[140:143]
M v[140:143],a[160:163],a[120:123],v[140:143]
s_nop 0
T a[76:77],v2,57344
T a[78:79],v2,58368
M v[144:147],a[160:163],a[128:131],v[144:147]
buffer_load_dwordx4 v15, s[48:51], s22 offen offset:3072   lds
M v[144:147],a[164:167],a[132:135],v[144:147]
SA s22,s22,1048576
M v[148:151],a[164:167],a[140:143],v[148:151]
M v[148:151],a[160:163],a[136:139],v[148:151]
M v[152:155],a[160:163],a[144:147],v[152:155]
M v[152:155],a[164:167],a[148:151],v[152:155]
s_waitcnt lgkmcnt(4)
M v[156:159],a[164:167],a[156:159],v[156:159]
SA m0,s23,32768
T a[80:81],v3,49152
T a[82:83],v3,50176
M v[156:159],a[160:163],a[152:155],v[156:159]
buffer_load_dwordx4 v8, s[16:19], s21 offen offset:0  nt lds
M v[160:163],a[168:171],a[96:99],v[160:163]
R a[160:163],v5,20480
R a[164:167],v6,20480
M v[160:163],a[172:175],a[100:103],v[160:163]
M v[164:167],a[172:175],a[108:111],v[164:167]
M v[164:167],a[168:171],a[104:107],v[164:167]
M v[168:171],a[168:171],a[112:115],v[168:171]
M v[168:171],a[172:175],a[116:119],v[168:171]
s_nop 0
T a[84:85],v3,57344
T a[86:87],v3,58368
M v[172:175],a[172:175],a[124:127],v[172:175]
buffer_load_dwordx4 v9, s[16:19], s21 offen offset:1024  nt lds
M v[172:175],a[168:171],a[120:123],v[172:175]
M v[176:179],a[168:171],a[128:131],v[176:179]
M v[176:179],a[172:175],a[132:135],v[176:179]
M v[180:183],a[172:175],a[140:143],v[180:183]
M v[180:183],a[168:171],a[136:139],v[180:183]
M v[184:187],a[168:171],a[144:147],v[184:187]
s_nop 0
T a[88:89],v4,49152
T a[90:91],v4,50176
M v[184:187],a[172:175],a[148:151],v[184:187]
s_waitcnt lgkmcnt(4)
buffer_load_dwordx4 v10, s[16:19], s21 offen offset:2048  nt lds
M v[188:191],a[172:175],a[156:159],v[188:191]
M v[188:191],a[168:171],a[152:155],v[188:191]
M v[192:195],a[160:163],a[96:99],v[192:195]
R a[168:171],v5,22528
R a[172:175],v6,22528
M v[192:195],a[164:167],a[100:103],v[192:195]
M v[196:199],a[164:167],a[108:111],v[196:199]
M v[196:199],a[160:163],a[104:107],v[196:199]
s_nop 0
T a[92:93],v4,57344
T a[94:95],v4,58368
M v[200:203],a[160:163],a[112:115],v[200:203]
buffer_load_dwordx4 v11, s[16:19], s21 offen offset:3072  nt lds
M v[200:203],a[164:167],a[116:119],v[200:203]
SA s21,s21,128
M v[204:207],a[164:167],a[124:127],v[204:207]
M v[204:207],a[160:163],a[120:123],v[204:207]
M v[208:211],a[160:163],a[128:131],v[208:211]
M v[208:211],a[164:167],a[132:135],v[208:211]
M v[212:215],a[164:167],a[140:143],v[212:215]
M v[212:215],a[160:163],a[136:139],v[212:215]
M v[216:219],a[160:163],a[144:147],v[216:219]
M v[216:219],a[164:167],a[148:151],v[216:219]
s_waitcnt lgkmcnt(2)
M v[220:223],a[164:167],a[156:159],v[220:223]
s_waitcnt vmcnt(17) lgkmcnt(0)
M v[220:223],a[160:163],a[152:155],v[220:223]
s_barrier
M v[224:227],a[168:171],a[96:99],v[224:227]
R a[160:163],v5,32768
R a[164:167],v6,32768
M v[224:227],a[172:175],a[100:103],v[224:227]
buffer_load_dword a240, v23, s[52:55], 0 offen offset:0
M v[228:231],a[172:175],a[108:111],v[228:231]
L_w_kv15:
s_cbranch_execz L_wd2
v_add_u32 v23, 16384, v23
M v[228:231],a[168:171],a[104:107],v[228:231]
M v[232:235],a[168:171],a[112:115],v[232:235]
M v[232:235],a[172:175],a[116:119],v[232:235]
M v[236:239],a[172:175],a[124:127],v[236:239]
M v[236:239],a[168:171],a[120:123],v[236:239]
M v[240:243],a[168:171],a[128:131],v[240:243]
M v[240:243],a[172:175],a[132:135],v[240:243]
M v[244:247],a[172:175],a[140:143],v[244:247]
M v[244:247],a[168:171],a[136:139],v[244:247]
M v[248:251],a[168:171],a[144:147],v[248:251]
M v[248:251],a[172:175],a[148:151],v[248:251]
s_waitcnt lgkmcnt(0)
M v[252:255],a[172:175],a[156:159],v[252:255]
M v[252:255],a[168:171],a[152:155],v[252:255]
M a[0:3],a[160:163],a[32:35],a[0:3]
R a[168:171],v5,34816
R a[172:175],v6,34816
M a[0:3],a[164:167],a[36:39],a[0:3]
T a[96:97],v1,0
T a[98:99],v1,1024
M a[4:7],a[164:167],a[44:47],a[4:7]
SA m0,s24,16384
M a[4:7],a[160:163],a[40:43],a[4:7]
buffer_load_dwordx4 v12, s[48:51], s22 offen offset:0   lds
M a[8:11],a[160:163],a[48:51],a[8:11]
M a[8:11],a[164:167],a[52:55],a[8:11]
M a[12:15],a[164:167],a[60:63],a[12:15]
s_nop 0
T a[100:101],v1,8192
T a[102:103],v1,9216
M a[12:15],a[160:163],a[56:59],a[12:15]
M a[16:19],a[160:163],a[64:67],a[16:19]
buffer_load_dwordx4 v13, s[48:51], s22 offen offset:1024   lds
M a[16:19],a[164:167],a[68:71],a[16:19]
M a[20:23],a[164:167],a[76:79],a[20:23]
M a[20:23],a[160:163],a[72:75],a[20:23]
s_nop 0
T a[104:105],v2,0
T a[106:107],v2,1024
M a[24:27],a[160:163],a[80:83],a[24:27]
M a[24:27],a[164:167],a[84:87],a[24:27]
s_waitcnt lgkmcnt(6)
buffer_load_dwordx4 v14, s[48:51], s22 offen offset:2048   lds
M a[28:31],a[164:167],a[92:95],a[28:31]
M a[28:31],a[160:163],a[88:91],a[28:31]
M v[32:35],a[168:171],a[32:35],v[32:35]
R a[160:163],v5,36864
R a[164:167],v6,36864
M v[32:35],a[172:175],a[36:39],v[32:35]
T a[108:109],v2,8192
T a[110:111],v2,9216
M v[36:39],a[172:175],a[44:47],v[36:39]
buffer_load_dwordx4 v15, s[48:51], s22 offen offset:3072   lds
M v[36:39],a[168:171],a[40:43],v[36:39]
s_sub_u32 s22, s22, 1048448
M v[40:43],a[168:171],a[48:51],v[40:43]
M v[40:43],a[172:175],a[52:55],v[40:43]
s_nop 0
T a[112:113],v3,0
T a[114:115],v3,1024
M v[44:47],a[172:175],a[60:63],v[44:47]
SA m0,s23,49152
M v[44:47],a[168:171],a[56:59],v[44:47]
buffer_load_dwordx4 v8, s[16:19], s21 offen offset:0  nt lds
M v[48:51],a[168:171],a[64:67],v[48:51]
M v[48:51],a[172:175],a[68:71],v[48:51]
M v[52:55],a[172:175],a[76:79],v[52:55]
s_nop 0
T a[116:117],v3,8192
T a[118:119],v3,9216
M v[52:55],a[168:171],a[72:75],v[52:55]
M v[56:59],a[168:171],a[80:83],v[56:59]
buffer_load_dwordx4 v9, s[16:19], s21 offen offset:1024  nt lds
M v[56:59],a[172:175],a[84:87],v[56:59]
s_waitcnt lgkmcnt(6)
M v[60:63],a[172:175],a[92:95],v[60:63]
M v[60:63],a[168:171],a[88:91],v[60:63]
s_nop 0
T a[120:121],v4,0
T a[122:123],v4,1024
M v[64:67],a[160:163],a[32:35],v[64:67]
R a[168:171],v5,38912
R a[172:175],v6,38912
M v[64:67],a[164:167],a[36:39],v[64:67]
buffer_load_dwordx4 v10, s[16:19], s21 offen offset:2048  nt lds
M v[68:71],a[164:167],a[44:47],v[68:71]
M v[68:71],a[160:163],a[40:43],v[68:71]
M v[72:75],a[160:163],a[48:51],v[72:75]
s_nop 0
T a[124:125],v4,8192
T a[126:127],v4,9216
M v[72:75],a[164:167],a[52:55],v[72:75]
M v[76:79],a[164:167],a[60:63],v[76:79]
buffer_load_dwordx4 v11, s[16:19], s21 offen offset:3072  nt lds
M v[76:79],a[160:163],a[56:59],v[76:79]
SA s21,s21,524160
M v[80:83],a[160:163],a[64:67],v[80:83]
M v[80:83],a[164:167],a[68:71],v[80:83]
M v[84:87],a[164:167],a[76:79],v[84:87]
M v[84:87],a[160:163],a[72:75],v[84:87]
M v[88:91],a[160:163],a[80:83],v[88:91]
M v[88:91],a[164:167],a[84:87],v[88:91]
s_waitcnt lgkmcnt(2)
M v[92:95],a[164:167],a[92:95],v[92:95]
s_waitcnt vmcnt(17) lgkmcnt(0)
M v[92:95],a[160:163],a[88:91],v[92:95]
s_barrier
M v[96:99],a[168:171],a[32:35],v[96:99]
R a[160:163],v5,49152
R a[164:167],v6,49152
M v[96:99],a[172:175],a[36:39],v[96:99]
M v[100:103],a[172:175],a[44:47],v[100:103]
SA m0,s24,32768
T a[128:129],v1,16384
T a[130:131],v1,17408
M v[100:103],a[168:171],a[40:43],v[100:103]
buffer_load_dwordx4 v12, s[48:51], s22 offen offset:0   lds
M v[104:107],a[168:171],a[48:51],v[104:107]
M v[104:107],a[172:175],a[52:55],v[104:107]
M v[108:111],a[172:175],a[60:63],v[108:111]
M v[108:111],a[168:171],a[56:59],v[108:111]
M v[112:115],a[168:171],a[64:67],v[112:115]
M v[112:115],a[172:175],a[68:71],v[112:115]
s_nop 0
T a[132:133],v1,24576
T a[134:135],v1,25600
M v[116:119],a[172:175],a[76:79],v[116:119]
buffer_load_dwordx4 v13, s[48:51], s22 offen offset:1024   lds
M v[116:119],a[168:171],a[72:75],v[116:119]
M v[120:123],a[168:171],a[80:83],v[120:123]
M v[120:123],a[172:175],a[84:87],v[120:123]
s_waitcnt lgkmcnt(4)
M v[124:127],a[172:175],a[92:95],v[124:127]
M v[124:127],a[168:171],a[88:91],v[124:127]
M v[128:131],a[160:163],a[32:35],v[128:131]
R a[168:171],v5,51200
R a[172:175],v6,51200
M v[128:131],a[164:167],a[36:39],v[128:131]
T a[136:137],v2,16384
T a[138:139],v2,17408
M v[132:135],a[164:167],a[44:47],v[132:135]
buffer_load_dwordx4 v14, s[48:51], s22 offen offset:2048   lds
M v[132:135],a[160:163],a[40:43],v[132:135]
M v[136:139],a[160:163],a[48:51],v[136:139]
M v[136:139],a[164:167],a[52:55],v[136:139]
M v[140:143],a[164:167],a[60:63],v[140:143]
M v[140:143],a[160:163],a[56:59],v[140:143]
s_nop 0
T a[140:141],v2,24576
T a[142:143],v2,25600
M v[144:147],a[160:163],a[64:67],v[144:147]
buffer_load_dwordx4 v15, s[48:51], s22 offen offset:3072   lds
M v[144:147],a[164:167],a[68:71],v[144:147]
SA s22,s22,1048576
M v[148:151],a[164:167],a[76:79],v[148:151]
M v[148:151],a[160:163],a[72:75],v[148:151]
M v[152:155],a[160:163],a[80:83],v[152:155]
M v[152:155],a[164:167],a[84:87],v[152:155]
s_waitcnt lgkmcnt(4)
M v[156:159],a[164:167],a[92:95],v[156:159]
SA m0,s23,0
T a[144:145],v3,16384
T a[146:147],v3,17408
M v[156:159],a[160:163],a[88:91],v[156:159]
buffer_load_dwordx4 v8, s[16:19], s21 offen offset:0  nt lds
M v[160:163],a[168:171],a[32:35],v[160:163]
R a[160:163],v5,53248
R a[164:167],v6,53248
M v[160:163],a[172:175],a[36:39],v[160:163]
M v[164:167],a[172:175],a[44:47],v[164:167]
M v[164:167],a[168:171],a[40:43],v[164:167]
M v[168:171],a[168:171],a[48:51],v[168:171]
M v[168:171],a[172:175],a[52:55],v[168:171]
s_nop 0
T a[148:149],v3,24576
T a[150:151],v3,25600
M v[172:175],a[172:175],a[60:63],v[172:175]
buffer_load_dwordx4 v9, s[16:19], s21 offen offset:1024  nt lds
M v[172:175],a[168:171],a[56:59],v[172:175]
M v[176:179],a[168:171],a[64:67],v[176:179]
M v[176:179],a[172:175],a[68:71],v[176:179]
M v[180:183],a[172:175],a[76:79],v[180:183]
M v[180:183],a[168:171],a[72:75],v[180:183]
M v[184:187],a[168:171],a[80:83],v[184:187]
s_nop 0
T a[152:153],v4,16384
T a[154:155],v4,17408
M v[184:187],a[172:175],a[84:87],v[184:187]
s_waitcnt lgkmcnt(4)
buffer_load_dwordx4 v10, s[16:19], s21 offen offset:2048  nt lds
M v[188:191],a[172:175],a[92:95],v[188:191]
M v[188:191],a[168:171],a[88:91],v[188:191]
M v[192:195],a[160:163],a[32:35],v[192:195]
R a[168:171],v5,55296
R a[172:175],v6,55296
M v[192:195],a[164:167],a[36:39],v[192:195]
M v[196:199],a[164:167],a[44:47],v[196:199]
M v[196:199],a[160:163],a[40:43],v[196:199]
s_nop 0
T a[156:157],v4,24576
T a[158:159],v4,25600
M v[200:203],a[160:163],a[48:51],v[200:203]
buffer_load_dwordx4 v11, s[16:19], s21 offen offset:3072  nt lds
M v[200:203],a[164:167],a[52:55],v[200:203]
SA s21,s21,128
M v[204:207],a[164:167],a[60:63],v[204:207]
M v[204:207],a[160:163],a[56:59],v[204:207]
M v[208:211],a[160:163],a[64:67],v[208:211]
M v[208:211],a[164:167],a[68:71],v[208:211]
M v[212:215],a[164:167],a[76:79],v[212:215]
M v[212:215],a[160:163],a[72:75],v[212:215]
M v[216:219],a[160:163],a[80:83],v[216:219]
M v[216:219],a[164:167],a[84:87],v[216:219]
s_waitcnt lgkmcnt(2)
M v[220:223],a[164:167],a[92:95],v[220:223]
s_waitcnt vmcnt(17) lgkmcnt(0)
M v[220:223],a[160:163],a[88:91],v[220:223]
s_barrier
M v[224:227],a[168:171],a[32:35],v[224:227]
R a[160:163],v5,0
R a[164:167],v6,0
M v[224:227],a[172:175],a[36:39],v[224:227]
M v[228:231],a[172:175],a[44:47],v[228:231]
M v[228:231],a[168:171],a[40:43],v[228:231]
M v[232:235],a[168:171],a[48:51],v[232:235]
M v[232:235],a[172:175],a[52:55],v[232:235]
M v[236:239],a[172:175],a[60:63],v[236:239]
M v[236:239],a[168:171],a[56:59],v[236:239]
M v[240:243],a[168:171],a[64:67],v[240:243]
M v[240:243],a[172:175],a[68:71],v[240:243]
M v[244:247],a[172:175],a[76:79],v[244:247]
M v[244:247],a[168:171],a[72:75],v[244:247]
M v[248:251],a[168:171],a[80:83],v[248:251]
M v[248:251],a[172:175],a[84:87],v[248:251]
s_waitcnt lgkmcnt(0)
M v[252:255],a[172:175],a[92:95],v[252:255]
M v[252:255],a[168:171],a[88:91],v[252:255]
M a[0:3],a[160:163],a[96:99],a[0:3]
R a[168:171],v5,2048
R a[172:175],v6,2048
M a[0:3],a[164:167],a[100:103],a[0:3]
T a[32:33],v1,32768
T a[34:35],v1,33792
M a[4:7],a[164:167],a[108:111],a[4:7]
SA m0,s24,49152
v_lshrrev_b32 v28, 4, v0
v_and_b32 v29, 7, v0
M a[4:7],a[160:163],a[104:107],a[4:7]
buffer_load_dwordx4 v12, s[48:51], s22 offen offset:0   lds
M a[8:11],a[160:163],a[112:115],a[8:11]
v_xor_b32 v28, v28, v29
v_lshlrev_b32 v28, 4, v28
M a[8:11],a[164:167],a[116:119],a[8:11]
v_lshrrev_b32 v29, 3, v0
v_mul_u32_u24 v29, 896, v29
M a[12:15],a[164:167],a[124:127],a[12:15]
T a[36:37],v1,40960
T a[38:39],v1,41984
M a[12:15],a[160:163],a[120:123],a[12:15]
v_add_u32 v22, v28, v29
v_xor_b32 v28, 64, v28
M a[16:19],a[160:163],a[128:131],a[16:19]
s_mul_i32 s64, s20, 14336
buffer_load_dwordx4 v13, s[48:51], s22 offen offset:1024   lds
M a[16:19],a[164:167],a[132:135],a[16:19]
s_sub_u32 s65, 98304, s64
M a[20:23],a[164:167],a[140:143],a[20:23]
SA s30,s29,s65
M a[20:23],a[160:163],a[136:139],a[20:23]
SA s29,s29,s64
T a[40:41],v2,32768
T a[42:43],v2,33792
M a[24:27],a[160:163],a[144:147],a[24:27]
v_add_u32 v29, 6144, v29
v_add_u32 v23, v28, v29
M a[24:27],a[164:167],a[148:151],a[24:27]
s_waitcnt lgkmcnt(6)
buffer_load_dwordx4 v14, s[48:51], s22 offen offset:2048   lds
M a[28:31],a[164:167],a[156:159],a[28:31]
s_and_b32 s64, s20, 1
M a[28:31],a[160:163],a[152:155],a[28:31]
s_lshl_b32 s64, s64, 12
M v[32:35],a[168:171],a[96:99],v[32:35]
SA s64,s64,65536
R a[160:163],v5,4096
R a[164:167],v6,4096
M v[32:35],a[172:175],a[100:103],v[32:35]
T a[44:45],v2,40960
T a[46:47],v2,41984
M v[36:39],a[172:175],a[108:111],v[36:39]
buffer_load_dwordx4 v15, s[48:51], s22 offen offset:3072   lds
M v[36:39],a[168:171],a[104:107],v[36:39]
s_sub_u32 s22, s22, 1048448
v_add_u32 v20, s64, v5
v_add_u32 v21, s64, v6
M v[40:43],a[168:171],a[112:115],v[40:43]
M v[40:43],a[172:175],a[116:119],v[40:43]
s_nop 0
T a[48:49],v3,32768
T a[50:51],v3,33792
M v[44:47],a[172:175],a[124:127],v[44:47]
SA m0,s23,16384
M v[44:47],a[168:171],a[120:123],v[44:47]
buffer_load_dwordx4 v8, s[16:19], s21 offen offset:0  nt lds
M v[48:51],a[168:171],a[128:131],v[48:51]
M v[48:51],a[172:175],a[132:135],v[48:51]
M v[52:55],a[172:175],a[140:143],v[52:55]
s_nop 0
T a[52:53],v3,40960
T a[54:55],v3,41984
M v[52:55],a[168:171],a[136:139],v[52:55]
M v[56:59],a[168:171],a[144:147],v[56:59]
buffer_load_dwordx4 v9, s[16:19], s21 offen offset:1024  nt lds
M v[56:59],a[172:175],a[148:151],v[56:59]
s_waitcnt lgkmcnt(6)
M v[60:63],a[172:175],a[156:159],v[60:63]
M v[60:63],a[168:171],a[152:155],v[60:63]
s_nop 0
T a[56:57],v4,32768
T a[58:59],v4,33792
M v[64:67],a[160:163],a[96:99],v[64:67]
R a[168:171],v5,6144
R a[172:175],v6,6144
M v[64:67],a[164:167],a[100:103],v[64:67]
buffer_load_dwordx4 v10, s[16:19], s21 offen offset:2048  nt lds
M v[68:71],a[164:167],a[108:111],v[68:71]
M v[68:71],a[160:163],a[104:107],v[68:71]
M v[72:75],a[160:163],a[112:115],v[72:75]
s_nop 0
T a[60:61],v4,40960
T a[62:63],v4,41984
M v[72:75],a[164:167],a[116:119],v[72:75]
M v[76:79],a[164:167],a[124:127],v[76:79]
buffer_load_dwordx4 v11, s[16:19], s21 offen offset:3072  nt lds
M v[76:79],a[160:163],a[120:123],v[76:79]
SA s21,s21,524160
M v[80:83],a[160:163],a[128:131],v[80:83]
M v[80:83],a[164:167],a[132:135],v[80:83]
M v[84:87],a[164:167],a[140:143],v[84:87]
M v[84:87],a[160:163],a[136:139],v[84:87]
M v[88:91],a[160:163],a[144:147],v[88:91]
M v[88:91],a[164:167],a[148:151],v[88:91]
s_waitcnt lgkmcnt(2)
M v[92:95],a[164:167],a[156:159],v[92:95]
s_waitcnt vmcnt(16) lgkmcnt(0)
M v[92:95],a[160:163],a[152:155],v[92:95]
s_barrier
M v[96:99],a[168:171],a[96:99],v[96:99]
R a[160:163],v5,16384
R a[164:167],v6,16384
M v[96:99],a[172:175],a[100:103],v[96:99]
SA m0,s23,131072
M v[100:103],a[172:175],a[108:111],v[100:103]
s_nop 0
T a[64:65],v1,49152
T a[66:67],v1,50176
M v[100:103],a[168:171],a[104:107],v[100:103]
buffer_load_dwordx4 v22, s[56:59], s29 offen offset:0 lds
M v[104:107],a[168:171],a[112:115],v[104:107]
M v[104:107],a[172:175],a[116:119],v[104:107]
M v[108:111],a[172:175],a[124:127],v[108:111]
buffer_load_dwordx4 v23, s[56:59], s29 offen offset:1024 lds
M v[108:111],a[168:171],a[120:123],v[108:111]
M v[112:115],a[168:171],a[128:131],v[112:115]
M v[112:115],a[172:175],a[132:135],v[112:115]
s_nop 0
T a[68:69],v1,57344
T a[70:71],v1,58368
M v[116:119],a[172:175],a[140:143],v[116:119]
buffer_load_dwordx4 v22, s[56:59], s30 offen offset:2048 lds
M v[116:119],a[168:171],a[136:139],v[116:119]
M v[120:123],a[168:171],a[144:147],v[120:123]
M v[120:123],a[172:175],a[148:151],v[120:123]
s_waitcnt lgkmcnt(4)
M v[124:127],a[172:175],a[156:159],v[124:127]
M v[124:127],a[168:171],a[152:155],v[124:127]
buffer_load_dwordx4 v23, s[56:59], s30 offen offset:3072 lds
M v[128:131],a[160:163],a[96:99],v[128:131]
R a[168:171],v5,18432
R a[172:175],v6,18432
M v[128:131],a[164:167],a[100:103],v[128:131]
SA s29,s29,128
T a[72:73],v2,49152
T a[74:75],v2,50176
M v[132:135],a[164:167],a[108:111],v[132:135]
SA s30,s30,128
M v[132:135],a[160:163],a[104:107],v[132:135]
SA m0,s24,0
M v[136:139],a[160:163],a[112:115],v[136:139]
buffer_load_dwordx4 v12, s[48:51], s22 offen offset:0   lds
M v[136:139],a[164:167],a[116:119],v[136:139]
M v[140:143],a[164:167],a[124:127],v[140:143]
M v[140:143],a[160:163],a[120:123],v[140:143]
s_nop 0
T a[76:77],v2,57344
T a[78:79],v2,58368
M v[144:147],a[160:163],a[128:131],v[144:147]
buffer_load_dwordx4 v13, s[48:51], s22 offen offset:1024   lds
M v[144:147],a[164:167],a[132:135],v[144:147]
M v[148:151],a[164:167],a[140:143],v[148:151]
M v[148:151],a[160:163],a[136:139],v[148:151]
M v[152:155],a[160:163],a[144:147],v[152:155]
M v[152:155],a[164:167],a[148:151],v[152:155]
s_waitcnt lgkmcnt(4)
buffer_load_dwordx4 v14, s[48:51], s22 offen offset:2048   lds
M v[156:159],a[164:167],a[156:159],v[156:159]
s_nop 0
T a[80:81],v3,49152
T a[82:83],v3,50176
M v[156:159],a[160:163],a[152:155],v[156:159]
M v[160:163],a[168:171],a[96:99],v[160:163]
R a[160:163],v5,20480
R a[164:167],v6,20480
M v[160:163],a[172:175],a[100:103],v[160:163]
M v[164:167],a[172:175],a[108:111],v[164:167]
buffer_load_dwordx4 v15, s[48:51], s22 offen offset:3072   lds
M v[164:167],a[168:171],a[104:107],v[164:167]
M v[168:171],a[168:171],a[112:115],v[168:171]
M v[168:171],a[172:175],a[116:119],v[168:171]
SA s22,s22,1048576
T a[84:85],v3,57344
T a[86:87],v3,58368
M v[172:175],a[172:175],a[124:127],v[172:175]
SA m0,s23,32768
M v[172:175],a[168:171],a[120:123],v[172:175]
buffer_load_dwordx4 v8, s[16:19], s21 offen offset:0  nt lds
M v[176:179],a[168:171],a[128:131],v[176:179]
M v[176:179],a[172:175],a[132:135],v[176:179]
M v[180:183],a[172:175],a[140:143],v[180:183]
M v[180:183],a[168:171],a[136:139],v[180:183]
buffer_load_dwordx4 v9, s[16:19], s21 offen offset:1024  nt lds
M v[184:187],a[168:171],a[144:147],v[184:187]
s_nop 0
T a[88:89],v4,49152
T a[90:91],v4,50176
M v[184:187],a[172:175],a[148:151],v[184:187]
s_waitcnt lgkmcnt(4)
M v[188:191],a[172:175],a[156:159],v[188:191]
M v[188:191],a[168:171],a[152:155],v[188:191]
M v[192:195],a[160:163],a[96:99],v[192:195]
R a[168:171],v5,22528
R a[172:175],v6,22528
M v[192:195],a[164:167],a[100:103],v[192:195]
buffer_load_dwordx4 v10, s[16:19], s21 offen offset:2048  nt lds
M v[196:199],a[164:167],a[108:111],v[196:199]
M v[196:199],a[160:163],a[104:107],v[196:199]
s_nop 0
T a[92:93],v4,57344
T a[94:95],v4,58368
M v[200:203],a[160:163],a[112:115],v[200:203]
M v[200:203],a[164:167],a[116:119],v[200:203]
buffer_load_dwordx4 v11, s[16:19], s21 offen offset:3072  nt lds
M v[204:207],a[164:167],a[124:127],v[204:207]
M v[204:207],a[160:163],a[120:123],v[204:207]
M v[208:211],a[160:163],a[128:131],v[208:211]
M v[208:211],a[164:167],a[132:135],v[208:211]
M v[212:215],a[164:167],a[140:143],v[212:215]
SA s21,s21,128
M v[212:215],a[160:163],a[136:139],v[212:215]
M v[216:219],a[160:163],a[144:147],v[216:219]
M v[216:219],a[164:167],a[148:151],v[216:219]
s_waitcnt lgkmcnt(2)
M v[220:223],a[164:167],a[156:159],v[220:223]
s_waitcnt vmcnt(20) lgkmcnt(0)
M v[220:223],a[160:163],a[152:155],v[220:223]
s_barrier
M v[224:227],a[168:171],a[96:99],v[224:227]
R a[160:163],v5,32768
R a[164:167],v6,32768
M v[224:227],a[172:175],a[100:103],v[224:227]
M v[228:231],a[172:175],a[108:111],v[228:231]
M v[228:231],a[168:171],a[104:107],v[228:231]
M v[232:235],a[168:171],a[112:115],v[232:235]
M v[232:235],a[172:175],a[116:119],v[232:235]
M v[236:239],a[172:175],a[124:127],v[236:239]
M v[236:239],a[168:171],a[120:123],v[236:239]
M v[240:243],a[168:171],a[128:131],v[240:243]
M v[240:243],a[172:175],a[132:135],v[240:243]
M v[244:247],a[172:175],a[140:143],v[244:247]
M v[244:247],a[168:171],a[136:139],v[244:247]
M v[248:251],a[168:171],a[144:147],v[248:251]
M v[248:251],a[172:175],a[148:151],v[248:251]
s_waitcnt lgkmcnt(0)
M v[252:255],a[172:175],a[156:159],v[252:255]
M v[252:255],a[168:171],a[152:155],v[252:255]
M a[0:3],a[160:163],a[32:35],a[0:3]
R a[168:171],v5,34816
R a[172:175],v6,34816
M a[0:3],a[164:167],a[36:39],a[0:3]
SA m0,s23,147456
T a[96:97],v1,0
T a[98:99],v1,1024
M a[4:7],a[164:167],a[44:47],a[4:7]
buffer_load_dwordx4 v22, s[56:59], s29 offen offset:0 lds
M a[4:7],a[160:163],a[40:43],a[4:7]
M a[8:11],a[160:163],a[48:51],a[8:11]
M a[8:11],a[164:167],a[52:55],a[8:11]
buffer_load_dwordx4 v23, s[56:59], s29 offen offset:1024 lds
M a[12:15],a[164:167],a[60:63],a[12:15]
s_nop 0
T a[100:101],v1,8192
T a[102:103],v1,9216
M a[12:15],a[160:163],a[56:59],a[12:15]
M a[16:19],a[160:163],a[64:67],a[16:19]
buffer_load_dwordx4 v22, s[56:59], s30 offen offset:2048 lds
M a[16:19],a[164:167],a[68:71],a[16:19]
M a[20:23],a[164:167],a[76:79],a[20:23]
M a[20:23],a[160:163],a[72:75],a[20:23]
s_nop 0
T a[104:105],v2,0
T a[106:107],v2,1024
M a[24:27],a[160:163],a[80:83],a[24:27]
buffer_load_dwordx4 v23, s[56:59], s30 offen offset:3072 lds
M a[24:27],a[164:167],a[84:87],a[24:27]
s_waitcnt lgkmcnt(6)
M a[28:31],a[164:167],a[92:95],a[28:31]
SA s29,s29,128
M a[28:31],a[160:163],a[88:91],a[28:31]
SA s30,s30,128
M v[32:35],a[168:171],a[32:35],v[32:35]
SA m0,s24,16384
R a[160:163],v5,36864
R a[164:167],v6,36864
M v[32:35],a[172:175],a[36:39],v[32:35]
T a[108:109],v2,8192
T a[110:111],v2,9216
M v[36:39],a[172:175],a[44:47],v[36:39]
buffer_load_dwordx4 v12, s[48:51], s22 offen offset:0   lds
M v[36:39],a[168:171],a[40:43],v[36:39]
M v[40:43],a[168:171],a[48:51],v[40:43]
M v[40:43],a[172:175],a[52:55],v[40:43]
s_nop 0
T a[112:113],v3,0
T a[114:115],v3,1024
M v[44:47],a[172:175],a[60:63],v[44:47]
buffer_load_dwordx4 v13, s[48:51], s22 offen offset:1024   lds
M v[44:47],a[168:171],a[56:59],v[44:47]
M v[48:51],a[168:171],a[64:67],v[48:51]
M v[48:51],a[172:175],a[68:71],v[48:51]
buffer_load_dwordx4 v14, s[48:51], s22 offen offset:2048   lds
M v[52:55],a[172:175],a[76:79],v[52:55]
s_nop 0
T a[116:117],v3,8192
T a[118:119],v3,9216
L_w_kv16:
s_cbranch_execz L_wd2
M v[52:55],a[168:171],a[72:75],v[52:55]
M v[56:59],a[168:171],a[80:83],v[56:59]
buffer_load_dwordx4 v15, s[48:51], s22 offen offset:3072   lds
M v[56:59],a[172:175],a[84:87],v[56:59]
s_waitcnt lgkmcnt(6)
M v[60:63],a[172:175],a[92:95],v[60:63]
s_sub_u32 s22, s22, 1048448
M v[60:63],a[168:171],a[88:91],v[60:63]
SA m0,s23,49152
T a[120:121],v4,0
T a[122:123],v4,1024
M v[64:67],a[160:163],a[32:35],v[64:67]
R a[168:171],v5,38912
R a[172:175],v6,38912
M v[64:67],a[164:167],a[36:39],v[64:67]
buffer_load_dwordx4 v8, s[16:19], s21 offen offset:0  nt lds
M v[68:71],a[164:167],a[44:47],v[68:71]
M v[68:71],a[160:163],a[40:43],v[68:71]
M v[72:75],a[160:163],a[48:51],v[72:75]
s_waitcnt vmcnt(17)
s_nop 0
T a[124:125],v4,8192
T a[126:127],v4,9216
M v[72:75],a[164:167],a[52:55],v[72:75]
buffer_load_dwordx4 v9, s[16:19], s21 offen offset:1024  nt lds
M v[76:79],a[164:167],a[60:63],v[76:79]
R a[176:179],v20,0
R a[180:183],v20,2048
M v[76:79],a[160:163],a[56:59],v[76:79]
R a[184:187],v21,0
R a[188:191],v21,2048
M v[80:83],a[160:163],a[64:67],v[80:83]
buffer_load_dwordx4 v10, s[16:19], s21 offen offset:2048  nt lds
M v[80:83],a[164:167],a[68:71],v[80:83]
M v[84:87],a[164:167],a[76:79],v[84:87]
M v[84:87],a[160:163],a[72:75],v[84:87]
buffer_load_dwordx4 v11, s[16:19], s21 offen offset:3072  nt lds
M v[88:91],a[160:163],a[80:83],v[88:91]
SA s21,s21,524160
M v[88:91],a[164:167],a[84:87],v[88:91]
s_waitcnt lgkmcnt(6)
M v[92:95],a[164:167],a[92:95],v[92:95]
s_waitcnt lgkmcnt(0)
M v[92:95],a[160:163],a[88:91],v[92:95]
s_barrier
M v[96:99],a[168:171],a[32:35],v[96:99]
s_lshl_b32 s4, s20, 10
R a[160:163],v5,49152
R a[164:167],v6,49152
M v[96:99],a[172:175],a[36:39],v[96:99]
SA m0,s23,131072
v_bfe_u32 v28, v0, 3, 2
M v[100:103],a[172:175],a[44:47],v[100:103]
s_nop 0
T a[128:129],v1,16384
T a[130:131],v1,17408
M v[100:103],a[168:171],a[40:43],v[100:103]
buffer_load_dwordx4 v22, s[56:59], s29 offen offset:0 lds
M v[104:107],a[168:171],a[48:51],v[104:107]
v_lshrrev_b32 v29, 5, v0
v_lshl_add_u32 v28, v29, 3, v28
M v[104:107],a[172:175],a[52:55],v[104:107]
M v[108:111],a[172:175],a[60:63],v[108:111]
buffer_load_dwordx4 v23, s[56:59], s29 offen offset:1024 lds
M v[108:111],a[168:171],a[56:59],v[108:111]
v_lshlrev_b32 v28, 13, v28
M v[112:115],a[168:171],a[64:67],v[112:115]
v_lshrrev_b32 v29, 4, v0
M v[112:115],a[172:175],a[68:71],v[112:115]
s_nop 0
T a[132:133],v1,24576
T a[134:135],v1,25600
M v[116:119],a[172:175],a[76:79],v[116:119]
buffer_load_dwordx4 v22, s[56:59], s30 offen offset:2048 lds
M v[116:119],a[168:171],a[72:75],v[116:119]
v_lshlrev_b32 v29, 1, v29
M v[120:123],a[168:171],a[80:83],v[120:123]
v_and_b32 v30, 7, v0
M v[120:123],a[172:175],a[84:87],v[120:123]
s_waitcnt lgkmcnt(4)
M v[124:127],a[172:175],a[92:95],v[124:127]
v_xor_b32 v29, v29, v30
M v[124:127],a[168:171],a[88:91],v[124:127]
buffer_load_dwordx4 v23, s[56:59], s30 offen offset:3072 lds
M v[128:131],a[160:163],a[32:35],v[128:131]
R a[168:171],v5,51200
R a[172:175],v6,51200
M v[128:131],a[164:167],a[36:39],v[128:131]
SA s29,s29,128
T a[136:137],v2,16384
T a[138:139],v2,17408
M v[132:135],a[164:167],a[44:47],v[132:135]
SA s30,s30,128
v_lshl_add_u32 v28, v29, 4, v28
M v[132:135],a[160:163],a[40:43],v[132:135]
s_and_b32 s64, s20, 1
M v[136:139],a[160:163],a[48:51],v[136:139]
s_lshl_b32 s64, s64, 17
M v[136:139],a[164:167],a[52:55],v[136:139]
s_lshr_b32 s65, s20, 1
M v[140:143],a[164:167],a[60:63],v[140:143]
s_lshl_b32 s65, s65, 15
SA s64,s64,s65
v_add_u32 v8, s64, v28
M v[140:143],a[160:163],a[56:59],v[140:143]
SA m0,s24,32768
T a[140:141],v2,24576
T a[142:143],v2,25600
M v[144:147],a[160:163],a[64:67],v[144:147]
buffer_load_dwordx4 v12, s[48:51], s22 offen offset:0   lds
M v[144:147],a[164:167],a[68:71],v[144:147]
M v[148:151],a[164:167],a[76:79],v[148:151]
M v[148:151],a[160:163],a[72:75],v[148:151]
buffer_load_dwordx4 v13, s[48:51], s22 offen offset:1024   lds
M v[152:155],a[160:163],a[80:83],v[152:155]
M v[152:155],a[164:167],a[84:87],v[152:155]
s_waitcnt lgkmcnt(4)
M v[156:159],a[164:167],a[92:95],v[156:159]
s_nop 0
T a[144:145],v3,16384
T a[146:147],v3,17408
M v[156:159],a[160:163],a[88:91],v[156:159]
buffer_load_dwordx4 v14, s[48:51], s22 offen offset:2048   lds
M v[160:163],a[168:171],a[32:35],v[160:163]
R a[160:163],v5,53248
R a[164:167],v6,53248
M v[160:163],a[172:175],a[36:39],v[160:163]
M v[164:167],a[172:175],a[44:47],v[164:167]
buffer_load_dwordx4 v15, s[48:51], s22 offen offset:3072   lds
M v[164:167],a[168:171],a[40:43],v[164:167]
M v[168:171],a[168:171],a[48:51],v[168:171]
SA s22,s22,1048576
M v[168:171],a[172:175],a[52:55],v[168:171]
s_mov_b32 s25, 0
T a[148:149],v3,24576
T a[150:151],v3,25600
M v[172:175],a[172:175],a[60:63],v[172:175]
SA m0,s4,0
M v[172:175],a[168:171],a[56:59],v[172:175]
buffer_load_dwordx4 v8, s[52:55], s25 offen lds
M v[176:179],a[168:171],a[64:67],v[176:179]
M v[176:179],a[172:175],a[68:71],v[176:179]
s_mov_b32 s25, 262144
M v[180:183],a[172:175],a[76:79],v[180:183]
SA m0,s4,4096
M v[180:183],a[168:171],a[72:75],v[180:183]
buffer_load_dwordx4 v8, s[52:55], s25 offen lds
M v[184:187],a[168:171],a[80:83],v[184:187]
s_nop 0
T a[152:153],v4,16384
T a[154:155],v4,17408
M v[184:187],a[172:175],a[84:87],v[184:187]
s_waitcnt lgkmcnt(4)
M v[188:191],a[172:175],a[92:95],v[188:191]
s_mov_b32 s25, 524288
M v[188:191],a[168:171],a[88:91],v[188:191]
SA m0,s4,8192
M v[192:195],a[160:163],a[32:35],v[192:195]
R a[168:171],v5,55296
R a[172:175],v6,55296
M v[192:195],a[164:167],a[36:39],v[192:195]
buffer_load_dwordx4 v8, s[52:55], s25 offen lds
M v[196:199],a[164:167],a[44:47],v[196:199]
M v[196:199],a[160:163],a[40:43],v[196:199]
s_mov_b32 s25, 786432
T a[156:157],v4,24576
T a[158:159],v4,25600
M v[200:203],a[160:163],a[48:51],v[200:203]
SA m0,s4,12288
M v[200:203],a[164:167],a[52:55],v[200:203]
s_waitcnt vmcnt(19)
buffer_load_dwordx4 v8, s[52:55], s25 offen lds
M v[204:207],a[164:167],a[60:63],v[204:207]
R a[192:195],v20,16384
R a[196:199],v20,18432
M v[204:207],a[160:163],a[56:59],v[204:207]
R a[200:203],v21,16384
R a[204:207],v21,18432
M v[208:211],a[160:163],a[64:67],v[208:211]
M v[208:211],a[164:167],a[68:71],v[208:211]
M v[212:215],a[164:167],a[76:79],v[212:215]
M v[212:215],a[160:163],a[72:75],v[212:215]
M v[216:219],a[160:163],a[80:83],v[216:219]
M v[216:219],a[164:167],a[84:87],v[216:219]
s_waitcnt lgkmcnt(6)
M v[220:223],a[164:167],a[92:95],v[220:223]
s_waitcnt lgkmcnt(0)
M v[220:223],a[160:163],a[88:91],v[220:223]
s_barrier
M v[224:227],a[168:171],a[32:35],v[224:227]
R a[160:163],v5,0
R a[164:167],v6,0
M v[224:227],a[172:175],a[36:39],v[224:227]
M v[228:231],a[172:175],a[44:47],v[228:231]
M v[228:231],a[168:171],a[40:43],v[228:231]
M v[232:235],a[168:171],a[48:51],v[232:235]
M v[232:235],a[172:175],a[52:55],v[232:235]
M v[236:239],a[172:175],a[60:63],v[236:239]
M v[236:239],a[168:171],a[56:59],v[236:239]
M v[240:243],a[168:171],a[64:67],v[240:243]
M v[240:243],a[172:175],a[68:71],v[240:243]
M v[244:247],a[172:175],a[76:79],v[244:247]
M v[244:247],a[168:171],a[72:75],v[244:247]
M v[248:251],a[168:171],a[80:83],v[248:251]
M v[248:251],a[172:175],a[84:87],v[248:251]
s_waitcnt lgkmcnt(0)
M v[252:255],a[172:175],a[92:95],v[252:255]
M v[252:255],a[168:171],a[88:91],v[252:255]
M a[0:3],a[160:163],a[96:99],a[0:3]
R a[168:171],v5,2048
R a[172:175],v6,2048
M a[0:3],a[164:167],a[100:103],a[0:3]
SA m0,s23,147456
T a[32:33],v1,32768
T a[34:35],v1,33792
M a[4:7],a[164:167],a[108:111],a[4:7]
buffer_load_dwordx4 v22, s[56:59], s29 offen offset:0 lds
M a[4:7],a[160:163],a[104:107],a[4:7]
M a[8:11],a[160:163],a[112:115],a[8:11]
M a[8:11],a[164:167],a[116:119],a[8:11]
buffer_load_dwordx4 v23, s[56:59], s29 offen offset:1024 lds
M a[12:15],a[164:167],a[124:127],a[12:15]
s_nop 0
T a[36:37],v1,40960
T a[38:39],v1,41984
M a[12:15],a[160:163],a[120:123],a[12:15]
M a[16:19],a[160:163],a[128:131],a[16:19]
buffer_load_dwordx4 v22, s[56:59], s30 offen offset:2048 lds
M a[16:19],a[164:167],a[132:135],a[16:19]
M a[20:23],a[164:167],a[140:143],a[20:23]
M a[20:23],a[160:163],a[136:139],a[20:23]
s_nop 0
T a[40:41],v2,32768
T a[42:43],v2,33792
M a[24:27],a[160:163],a[144:147],a[24:27]
buffer_load_dwordx4 v23, s[56:59], s30 offen offset:3072 lds
M a[24:27],a[164:167],a[148:151],a[24:27]
s_waitcnt lgkmcnt(6)
M a[28:31],a[164:167],a[156:159],a[28:31]
SA s29,s29,128
M a[28:31],a[160:163],a[152:155],a[28:31]
SA s30,s30,128
M v[32:35],a[168:171],a[96:99],v[32:35]
SA m0,s24,49152
R a[160:163],v5,4096
R a[164:167],v6,4096
M v[32:35],a[172:175],a[100:103],v[32:35]
T a[44:45],v2,40960
T a[46:47],v2,41984
M v[36:39],a[172:175],a[108:111],v[36:39]
buffer_load_dwordx4 v12, s[48:51], s22 offen offset:0   lds
M v[36:39],a[168:171],a[104:107],v[36:39]
M v[40:43],a[168:171],a[112:115],v[40:43]
M v[40:43],a[172:175],a[116:119],v[40:43]
s_nop 0
T a[48:49],v3,32768
T a[50:51],v3,33792
M v[44:47],a[172:175],a[124:127],v[44:47]
buffer_load_dwordx4 v13, s[48:51], s22 offen offset:1024   lds
M v[44:47],a[168:171],a[120:123],v[44:47]
M v[48:51],a[168:171],a[128:131],v[48:51]
M v[48:51],a[172:175],a[132:135],v[48:51]
buffer_load_dwordx4 v14, s[48:51], s22 offen offset:2048   lds
M v[52:55],a[172:175],a[140:143],v[52:55]
s_nop 0
T a[52:53],v3,40960
T a[54:55],v3,41984
M v[52:55],a[168:171],a[136:139],v[52:55]
M v[56:59],a[168:171],a[144:147],v[56:59]
buffer_load_dwordx4 v15, s[48:51], s22 offen offset:3072   lds
M v[56:59],a[172:175],a[148:151],v[56:59]
s_waitcnt lgkmcnt(6)
M v[60:63],a[172:175],a[156:159],v[60:63]
s_sub_u32 s22, s22, 1048448
M v[60:63],a[168:171],a[152:155],v[60:63]
s_mov_b32 s25, 1048576
T a[56:57],v4,32768
T a[58:59],v4,33792
M v[64:67],a[160:163],a[96:99],v[64:67]
SA m0,s4,16384
R a[168:171],v5,6144
R a[172:175],v6,6144
M v[64:67],a[164:167],a[100:103],v[64:67]
buffer_load_dwordx4 v8, s[52:55], s25 offen lds
M v[68:71],a[164:167],a[108:111],v[68:71]
s_mov_b32 s25, 1310720
M v[68:71],a[160:163],a[104:107],v[68:71]
SA m0,s4,20480
M v[72:75],a[160:163],a[112:115],v[72:75]
s_waitcnt vmcnt(17)
s_nop 0
T a[60:61],v4,40960
T a[62:63],v4,41984
M v[72:75],a[164:167],a[116:119],v[72:75]
buffer_load_dwordx4 v8, s[52:55], s25 offen lds
M v[76:79],a[164:167],a[124:127],v[76:79]
s_mov_b32 s25, 1572864
R a[208:211],v20,0
R a[212:215],v20,2048
M v[76:79],a[160:163],a[120:123],v[76:79]
SA m0,s4,24576
R a[216:219],v21,0
R a[220:223],v21,2048
M v[80:83],a[160:163],a[128:131],v[80:83]
buffer_load_dwordx4 v8, s[52:55], s25 offen lds
M v[80:83],a[164:167],a[132:135],v[80:83]
s_mov_b32 s25, 1835008
M v[84:87],a[164:167],a[140:143],v[84:87]
SA m0,s4,28672
M v[84:87],a[160:163],a[136:139],v[84:87]
buffer_load_dwordx4 v8, s[52:55], s25 offen lds
M v[88:91],a[160:163],a[144:147],v[88:91]
M v[88:91],a[164:167],a[148:151],v[88:91]
s_waitcnt lgkmcnt(6)
M v[92:95],a[164:167],a[156:159],v[92:95]
s_waitcnt lgkmcnt(0)
M v[92:95],a[160:163],a[152:155],v[92:95]
s_barrier
M v[96:99],a[168:171],a[96:99],v[96:99]
R a[160:163],v5,16384
R a[164:167],v6,16384
M v[96:99],a[172:175],a[100:103],v[96:99]
SA m0,s23,32768
M v[100:103],a[172:175],a[108:111],v[100:103]
s_nop 0
T a[64:65],v1,49152
T a[66:67],v1,50176
M v[100:103],a[168:171],a[104:107],v[100:103]
buffer_load_dwordx4 v22, s[56:59], s29 offen offset:0 lds
M v[104:107],a[168:171],a[112:115],v[104:107]
v_lshrrev_b32 v28, 2, v0
v_lshlrev_b32 v28, 7, v28
M v[104:107],a[172:175],a[116:119],v[104:107]
M v[108:111],a[172:175],a[124:127],v[108:111]
buffer_load_dwordx4 v23, s[56:59], s29 offen offset:1024 lds
M v[108:111],a[168:171],a[120:123],v[108:111]
v_and_b32 v29, 3, v0
M v[112:115],a[168:171],a[128:131],v[112:115]
v_lshl_add_u32 v28, v29, 3, v28
M v[112:115],a[172:175],a[132:135],v[112:115]
s_nop 0
T a[68:69],v1,57344
T a[70:71],v1,58368
M v[116:119],a[172:175],a[140:143],v[116:119]
buffer_load_dwordx4 v22, s[56:59], s30 offen offset:2048 lds
M v[116:119],a[168:171],a[136:139],v[116:119]
v_bfe_u32 v29, v0, 3, 2
M v[120:123],a[168:171],a[144:147],v[120:123]
M v[120:123],a[172:175],a[148:151],v[120:123]
s_waitcnt lgkmcnt(4)
v_lshl_add_u32 v16, v29, 5, v28
M v[124:127],a[172:175],a[156:159],v[124:127]
M v[124:127],a[168:171],a[152:155],v[124:127]
buffer_load_dwordx4 v23, s[56:59], s30 offen offset:3072 lds
M v[128:131],a[160:163],a[96:99],v[128:131]
R a[168:171],v5,18432
R a[172:175],v6,18432
M v[128:131],a[164:167],a[100:103],v[128:131]
SA s29,s29,128
T a[72:73],v2,49152
T a[74:75],v2,50176
M v[132:135],a[164:167],a[108:111],v[132:135]
SA s30,s30,128
v_xor_b32 v17, 32, v16
v_xor_b32 v18, 64, v16
M v[132:135],a[160:163],a[104:107],v[132:135]
SA m0,s23,65536
M v[136:139],a[160:163],a[112:115],v[136:139]
buffer_load_dwordx4 v22, s[56:59], s29 offen offset:0 lds
M v[136:139],a[164:167],a[116:119],v[136:139]
v_xor_b32 v19, 0x60, v16
M v[140:143],a[164:167],a[124:127],v[140:143]
v_add_u32 v12, 0x20000, v16
M v[140:143],a[160:163],a[120:123],v[140:143]
s_nop 0
T a[76:77],v2,57344
T a[78:79],v2,58368
M v[144:147],a[160:163],a[128:131],v[144:147]
buffer_load_dwordx4 v23, s[56:59], s29 offen offset:1024 lds
M v[144:147],a[164:167],a[132:135],v[144:147]
v_add_u32 v13, 0x20000, v17
M v[148:151],a[164:167],a[140:143],v[148:151]
M v[148:151],a[160:163],a[136:139],v[148:151]
v_add_u32 v14, 0x20000, v18
M v[152:155],a[160:163],a[144:147],v[152:155]
M v[152:155],a[164:167],a[148:151],v[152:155]
s_waitcnt lgkmcnt(4)
buffer_load_dwordx4 v22, s[56:59], s30 offen offset:2048 lds
M v[156:159],a[164:167],a[156:159],v[156:159]
s_nop 0
T a[80:81],v3,49152
T a[82:83],v3,50176
M v[156:159],a[160:163],a[152:155],v[156:159]
v_add_u32 v15, 0x20000, v19
M v[160:163],a[168:171],a[96:99],v[160:163]
R a[160:163],v5,20480
R a[164:167],v6,20480
M v[160:163],a[172:175],a[100:103],v[160:163]
M v[164:167],a[172:175],a[108:111],v[164:167]
buffer_load_dwordx4 v23, s[56:59], s30 offen offset:3072 lds
M v[164:167],a[168:171],a[104:107],v[164:167]
SA s29,s29,128
M v[168:171],a[168:171],a[112:115],v[168:171]
SA s30,s30,128
M v[168:171],a[172:175],a[116:119],v[168:171]
s_mov_b32 s25, 2097152
T a[84:85],v3,57344
T a[86:87],v3,58368
M v[172:175],a[172:175],a[124:127],v[172:175]
SA m0,s4,131072
M v[172:175],a[168:171],a[120:123],v[172:175]
buffer_load_dwordx4 v8, s[52:55], s25 offen lds
M v[176:179],a[168:171],a[128:131],v[176:179]
M v[176:179],a[172:175],a[132:135],v[176:179]
s_mov_b32 s25, 2359296
M v[180:183],a[172:175],a[140:143],v[180:183]
SA m0,s4,135168
M v[180:183],a[168:171],a[136:139],v[180:183]
buffer_load_dwordx4 v8, s[52:55], s25 offen lds
M v[184:187],a[168:171],a[144:147],v[184:187]
s_nop 0
T a[88:89],v4,49152
T a[90:91],v4,50176
M v[184:187],a[172:175],a[148:151],v[184:187]
s_waitcnt lgkmcnt(4)
M v[188:191],a[172:175],a[156:159],v[188:191]
s_mov_b32 s25, 2621440
M v[188:191],a[168:171],a[152:155],v[188:191]
SA m0,s4,139264
M v[192:195],a[160:163],a[96:99],v[192:195]
R a[168:171],v5,22528
R a[172:175],v6,22528
M v[192:195],a[164:167],a[100:103],v[192:195]
buffer_load_dwordx4 v8, s[52:55], s25 offen lds
M v[196:199],a[164:167],a[108:111],v[196:199]
M v[196:199],a[160:163],a[104:107],v[196:199]
s_mov_b32 s25, 2883584
T a[92:93],v4,57344
T a[94:95],v4,58368
M v[200:203],a[160:163],a[112:115],v[200:203]
SA m0,s4,143360
M v[200:203],a[164:167],a[116:119],v[200:203]
s_waitcnt vmcnt(19)
buffer_load_dwordx4 v8, s[52:55], s25 offen lds
M v[204:207],a[164:167],a[124:127],v[204:207]
R a[224:227],v20,16384
R a[228:231],v20,18432
M v[204:207],a[160:163],a[120:123],v[204:207]
R a[232:235],v21,16384
R a[236:239],v21,18432
M v[208:211],a[160:163],a[128:131],v[208:211]
v_subrev_u32 v20, 98304, v20
v_subrev_u32 v21, 98304, v21
M v[208:211],a[164:167],a[132:135],v[208:211]
M v[212:215],a[164:167],a[140:143],v[212:215]
M v[212:215],a[160:163],a[136:139],v[212:215]
M v[216:219],a[160:163],a[144:147],v[216:219]
M v[216:219],a[164:167],a[148:151],v[216:219]
s_waitcnt lgkmcnt(6)
M v[220:223],a[164:167],a[156:159],v[220:223]
s_waitcnt lgkmcnt(0)
M v[220:223],a[160:163],a[152:155],v[220:223]
s_barrier
M v[224:227],a[168:171],a[96:99],v[224:227]
R a[160:163],v5,32768
R a[164:167],v6,32768
M v[224:227],a[172:175],a[100:103],v[224:227]
M v[228:231],a[172:175],a[108:111],v[228:231]
M v[228:231],a[168:171],a[104:107],v[228:231]
M v[232:235],a[168:171],a[112:115],v[232:235]
M v[232:235],a[172:175],a[116:119],v[232:235]
M v[236:239],a[172:175],a[124:127],v[236:239]
M v[236:239],a[168:171],a[120:123],v[236:239]
M v[240:243],a[168:171],a[128:131],v[240:243]
M v[240:243],a[172:175],a[132:135],v[240:243]
M v[244:247],a[172:175],a[140:143],v[244:247]
M v[244:247],a[168:171],a[136:139],v[244:247]
M v[248:251],a[168:171],a[144:147],v[248:251]
M v[248:251],a[172:175],a[148:151],v[248:251]
s_waitcnt lgkmcnt(0)
M v[252:255],a[172:175],a[156:159],v[252:255]
M v[252:255],a[168:171],a[152:155],v[252:255]
M a[0:3],a[160:163],a[32:35],a[0:3]
R a[168:171],v5,34816
R a[172:175],v6,34816
M a[0:3],a[164:167],a[36:39],a[0:3]
SA m0,s23,81920
M a[4:7],a[164:167],a[44:47],a[4:7]
buffer_load_dwordx4 v22, s[56:59], s29 offen offset:0 lds
M a[4:7],a[160:163],a[40:43],a[4:7]
M a[8:11],a[160:163],a[48:51],a[8:11]
M a[8:11],a[164:167],a[52:55],a[8:11]
buffer_load_dwordx4 v23, s[56:59], s29 offen offset:1024 lds
M a[12:15],a[164:167],a[60:63],a[12:15]
M a[12:15],a[160:163],a[56:59],a[12:15]
M a[16:19],a[160:163],a[64:67],a[16:19]
M a[16:19],a[164:167],a[68:71],a[16:19]
buffer_load_dwordx4 v22, s[56:59], s30 offen offset:2048 lds
M a[20:23],a[164:167],a[76:79],a[20:23]
M a[20:23],a[160:163],a[72:75],a[20:23]
M a[24:27],a[160:163],a[80:83],a[24:27]
M a[24:27],a[164:167],a[84:87],a[24:27]
s_waitcnt lgkmcnt(0)
buffer_load_dwordx4 v23, s[56:59], s30 offen offset:3072 lds
M a[28:31],a[164:167],a[92:95],a[28:31]
SA s29,s29,128
M a[28:31],a[160:163],a[88:91],a[28:31]
SA s30,s30,128
M v[32:35],a[168:171],a[32:35],v[32:35]
s_mov_b32 s25, 3145728
R a[160:163],v5,36864
R a[164:167],v6,36864
M v[32:35],a[172:175],a[36:39],v[32:35]
SA m0,s4,147456
M v[36:39],a[172:175],a[44:47],v[36:39]
buffer_load_dwordx4 v8, s[52:55], s25 offen lds
M v[36:39],a[168:171],a[40:43],v[36:39]
s_mov_b32 s25, 3407872
M v[40:43],a[168:171],a[48:51],v[40:43]
SA m0,s4,151552
M v[40:43],a[172:175],a[52:55],v[40:43]
buffer_load_dwordx4 v8, s[52:55], s25 offen lds
M v[44:47],a[172:175],a[60:63],v[44:47]
G v24,a0
G v25,a1
M v[44:47],a[168:171],a[56:59],v[44:47]
s_mov_b32 s25, 128
G v26,a2
G v27,a3
M v[48:51],a[168:171],a[64:67],v[48:51]
SA m0,s4,49152
C v24,v24,v25
C v25,v26,v27
M v[48:51],a[172:175],a[68:71],v[48:51]
buffer_load_dwordx4 v8, s[52:55], s25 offen lds
M v[52:55],a[172:175],a[76:79],v[52:55]
C v26,v32,v33
C v27,v34,v35
M v[52:55],a[168:171],a[72:75],v[52:55]
SA s3,s93,0
M v[56:59],a[168:171],a[80:83],v[56:59]
s_mov_b32 s25, 262272
buffer_store_dwordx4 v[24:27], v7, s[8:11], s3 offen offset:0 sc1
M v[56:59],a[172:175],a[84:87],v[56:59]
L_w_kv17:
s_cbranch_execz L_wd2
s_waitcnt lgkmcnt(0)
G v28,a4
G v29,a5
M v[60:63],a[172:175],a[92:95],v[60:63]
SA m0,s4,53248
G v30,a6
G v31,a7
M v[60:63],a[168:171],a[88:91],v[60:63]
s_waitcnt vmcnt(16)
buffer_load_dwordx4 v8, s[52:55], s25 offen lds
M v[64:67],a[160:163],a[32:35],v[64:67]
s_mov_b32 s25, 524416
R a[168:171],v5,38912
R a[172:175],v6,38912
M v[64:67],a[164:167],a[36:39],v[64:67]
SA m0,s4,57344
C v28,v28,v29
C v29,v30,v31
M v[68:71],a[164:167],a[44:47],v[68:71]
buffer_load_dwordx4 v8, s[52:55], s25 offen lds
M v[68:71],a[160:163],a[40:43],v[68:71]
s_mov_b32 s25, 786560
C v30,v36,v37
C v31,v38,v39
M v[72:75],a[160:163],a[48:51],v[72:75]
SA m0,s4,61440
buffer_store_dwordx4 v[28:31], v7, s[8:11], s3 offen offset:2048 sc1
M v[72:75],a[164:167],a[52:55],v[72:75]
G v24,a8
G v25,a9
M v[76:79],a[164:167],a[60:63],v[76:79]
G v26,a10
G v27,a11
M v[76:79],a[160:163],a[56:59],v[76:79]
buffer_load_dwordx4 v8, s[52:55], s25 offen lds
M v[80:83],a[160:163],a[64:67],v[80:83]
C v24,v24,v25
C v25,v26,v27
M v[80:83],a[164:167],a[68:71],v[80:83]
C v26,v40,v41
C v27,v42,v43
M v[84:87],a[164:167],a[76:79],v[84:87]
SA s3,s93,4096
buffer_store_dwordx4 v[24:27], v7, s[8:11], s3 offen offset:0 sc1
M v[84:87],a[160:163],a[72:75],v[84:87]
R a[96:99],v20,0
R a[100:103],v20,2048
M v[88:91],a[160:163],a[80:83],v[88:91]
R a[104:107],v21,0
R a[108:111],v21,2048
M v[88:91],a[164:167],a[84:87],v[88:91]
s_waitcnt lgkmcnt(4)
G v28,a12
G v29,a13
M v[92:95],a[164:167],a[92:95],v[92:95]
s_waitcnt lgkmcnt(0)
G v30,a14
G v31,a15
M v[92:95],a[160:163],a[88:91],v[92:95]
s_barrier
M v[96:99],a[168:171],a[32:35],v[96:99]
R a[160:163],v5,49152
R a[164:167],v6,49152
M v[96:99],a[172:175],a[36:39],v[96:99]
s_mov_b32 s25, 1048704
C v28,v28,v29
C v29,v30,v31
M v[100:103],a[172:175],a[44:47],v[100:103]
SA m0,s4,98304
C v30,v44,v45
C v31,v46,v47
M v[100:103],a[168:171],a[40:43],v[100:103]
s_waitcnt vmcnt(17)
buffer_store_dwordx4 v[28:31], v7, s[8:11], s3 offen offset:2048 sc1
M v[104:107],a[168:171],a[48:51],v[104:107]
G v24,a16
G v25,a17
M v[104:107],a[172:175],a[52:55],v[104:107]
G v26,a18
G v27,a19
M v[108:111],a[172:175],a[60:63],v[108:111]
buffer_load_dwordx4 v8, s[52:55], s25 offen lds
M v[108:111],a[168:171],a[56:59],v[108:111]
C v24,v24,v25
C v25,v26,v27
M v[112:115],a[168:171],a[64:67],v[112:115]
C v26,v48,v49
C v27,v50,v51
M v[112:115],a[172:175],a[68:71],v[112:115]
SA s3,s93,8192
buffer_store_dwordx4 v[24:27], v7, s[8:11], s3 offen offset:0 sc1
M v[116:119],a[172:175],a[76:79],v[116:119]
s_mov_b32 s25, 1310848
R a[112:115],v20,32768
R a[116:119],v20,34816
M v[116:119],a[168:171],a[72:75],v[116:119]
SA m0,s4,102400
R a[120:123],v21,32768
R a[124:127],v21,34816
M v[120:123],a[168:171],a[80:83],v[120:123]
C v64,v64,v65
C v65,v66,v67
M v[120:123],a[172:175],a[84:87],v[120:123]
s_waitcnt lgkmcnt(4)
buffer_load_dwordx4 v8, s[52:55], s25 offen lds
M v[124:127],a[172:175],a[92:95],v[124:127]
C v66,v96,v97
C v67,v98,v99
M v[124:127],a[168:171],a[88:91],v[124:127]
G v28,a20
G v29,a21
M v[128:131],a[160:163],a[32:35],v[128:131]
R a[168:171],v5,51200
R a[172:175],v6,51200
M v[128:131],a[164:167],a[36:39],v[128:131]
G v30,a22
G v31,a23
M v[132:135],a[164:167],a[44:47],v[132:135]
C v28,v28,v29
C v29,v30,v31
M v[132:135],a[160:163],a[40:43],v[132:135]
s_mov_b32 s25, 1572992
C v30,v52,v53
C v31,v54,v55
M v[136:139],a[160:163],a[48:51],v[136:139]
SA m0,s4,106496
buffer_store_dwordx4 v[28:31], v7, s[8:11], s3 offen offset:2048 sc1
M v[136:139],a[164:167],a[52:55],v[136:139]
C v68,v68,v69
C v69,v70,v71
M v[140:143],a[164:167],a[60:63],v[140:143]
C v70,v100,v101
C v71,v102,v103
M v[140:143],a[160:163],a[56:59],v[140:143]
C v72,v72,v73
C v73,v74,v75
M v[144:147],a[160:163],a[64:67],v[144:147]
buffer_load_dwordx4 v8, s[52:55], s25 offen lds
M v[144:147],a[164:167],a[68:71],v[144:147]
C v74,v104,v105
C v75,v106,v107
M v[148:151],a[164:167],a[76:79],v[148:151]
C v76,v76,v77
C v77,v78,v79
M v[148:151],a[160:163],a[72:75],v[148:151]
C v78,v108,v109
C v79,v110,v111
M v[152:155],a[160:163],a[80:83],v[152:155]
C v80,v80,v81
C v81,v82,v83
M v[152:155],a[164:167],a[84:87],v[152:155]
s_waitcnt lgkmcnt(0)
C v82,v112,v113
C v83,v114,v115
M v[156:159],a[164:167],a[92:95],v[156:159]
s_mov_b32 s25, 1835136
C v84,v84,v85
C v85,v86,v87
M v[156:159],a[160:163],a[88:91],v[156:159]
SA m0,s4,110592
C v86,v116,v117
C v87,v118,v119
M v[160:163],a[168:171],a[32:35],v[160:163]
R a[160:163],v5,53248
R a[164:167],v6,53248
M v[160:163],a[172:175],a[36:39],v[160:163]
buffer_load_dwordx4 v8, s[52:55], s25 offen lds
M v[164:167],a[172:175],a[44:47],v[164:167]
G v24,a24
G v25,a25
M v[164:167],a[168:171],a[40:43],v[164:167]
G v26,a26
G v27,a27
M v[168:171],a[168:171],a[48:51],v[168:171]
C v24,v24,v25
C v25,v26,v27
M v[168:171],a[172:175],a[52:55],v[168:171]
C v26,v56,v57
C v27,v58,v59
M v[172:175],a[172:175],a[60:63],v[172:175]
SA s3,s93,12288
buffer_store_dwordx4 v[24:27], v7, s[8:11], s3 offen offset:0 sc1
M v[172:175],a[168:171],a[56:59],v[172:175]
C v88,v88,v89
C v89,v90,v91
M v[176:179],a[168:171],a[64:67],v[176:179]
C v90,v120,v121
C v91,v122,v123
M v[176:179],a[172:175],a[68:71],v[176:179]
C v92,v92,v93
C v93,v94,v95
M v[180:183],a[172:175],a[76:79],v[180:183]
C v94,v124,v125
C v95,v126,v127
M v[180:183],a[168:171],a[72:75],v[180:183]
G v28,a28
G v29,a29
M v[184:187],a[168:171],a[80:83],v[184:187]
G v30,a30
G v31,a31
M v[184:187],a[172:175],a[84:87],v[184:187]
s_waitcnt lgkmcnt(0)
C v28,v28,v29
C v29,v30,v31
M v[188:191],a[172:175],a[92:95],v[188:191]
C v30,v60,v61
C v31,v62,v63
M v[188:191],a[168:171],a[88:91],v[188:191]
buffer_store_dwordx4 v[28:31], v7, s[8:11], s3 offen offset:2048 sc1
M v[192:195],a[160:163],a[32:35],v[192:195]
s_waitcnt vmcnt(18)
R a[168:171],v5,55296
R a[172:175],v6,55296
M v[192:195],a[164:167],a[36:39],v[192:195]
C v128,v128,v129
C v129,v130,v131
M v[196:199],a[164:167],a[44:47],v[196:199]
C v130,v160,v161
C v131,v162,v163
M v[196:199],a[160:163],a[40:43],v[196:199]
C v132,v132,v133
C v133,v134,v135
M v[200:203],a[160:163],a[48:51],v[200:203]
C v134,v164,v165
C v135,v166,v167
M v[200:203],a[164:167],a[52:55],v[200:203]
C v136,v136,v137
C v137,v138,v139
M v[204:207],a[164:167],a[60:63],v[204:207]
C v138,v168,v169
C v139,v170,v171
M v[204:207],a[160:163],a[56:59],v[204:207]
C v140,v140,v141
C v141,v142,v143
M v[208:211],a[160:163],a[64:67],v[208:211]
C v142,v172,v173
C v143,v174,v175
M v[208:211],a[164:167],a[68:71],v[208:211]
C v144,v144,v145
C v145,v146,v147
M v[212:215],a[164:167],a[76:79],v[212:215]
R a[128:131],v20,49152
R a[132:135],v20,51200
R a[136:139],v21,49152
R a[140:143],v21,51200
M v[212:215],a[160:163],a[72:75],v[212:215]
C v146,v176,v177
C v147,v178,v179
M v[216:219],a[160:163],a[80:83],v[216:219]
C v148,v148,v149
C v149,v150,v151
M v[216:219],a[164:167],a[84:87],v[216:219]
s_waitcnt lgkmcnt(4)
C v150,v180,v181
C v151,v182,v183
M v[220:223],a[164:167],a[92:95],v[220:223]
s_waitcnt vmcnt(16) lgkmcnt(0)
C v152,v152,v153
C v153,v154,v155
M v[220:223],a[160:163],a[88:91],v[220:223]
s_barrier
M v[224:227],a[168:171],a[32:35],v[224:227]
s_nop 0
T v[32:33],v16,0
T v[34:35],v16,2048
M v[224:227],a[172:175],a[36:39],v[224:227]
C v154,v184,v185
C v155,v186,v187
M v[228:231],a[172:175],a[44:47],v[228:231]
T v[36:37],v16,4096
T v[38:39],v16,6144
M v[228:231],a[168:171],a[40:43],v[228:231]
T v[40:41],v16,8192
T v[42:43],v16,10240
M v[232:235],a[168:171],a[48:51],v[232:235]
C v156,v156,v157
C v157,v158,v159
M v[232:235],a[172:175],a[52:55],v[232:235]
T v[44:45],v16,12288
T v[46:47],v16,14336
M v[236:239],a[172:175],a[60:63],v[236:239]
T v[48:49],v16,16384
T v[50:51],v16,18432
M v[236:239],a[168:171],a[56:59],v[236:239]
C v158,v188,v189
C v159,v190,v191
M v[240:243],a[168:171],a[64:67],v[240:243]
T v[52:53],v16,20480
T v[54:55],v16,22528
M v[240:243],a[172:175],a[68:71],v[240:243]
T v[56:57],v16,24576
T v[58:59],v16,26624
M v[244:247],a[172:175],a[76:79],v[244:247]
C v192,v192,v193
C v193,v194,v195
M v[244:247],a[168:171],a[72:75],v[244:247]
C v194,v224,v225
C v195,v226,v227
M v[248:251],a[168:171],a[80:83],v[248:251]
C v196,v196,v197
C v197,v198,v199
M v[248:251],a[172:175],a[84:87],v[248:251]
C v198,v228,v229
C v199,v230,v231
M v[252:255],a[172:175],a[92:95],v[252:255]
C v200,v200,v201
C v201,v202,v203
M v[252:255],a[168:171],a[88:91],v[252:255]
s_waitcnt lgkmcnt(6)
C v202,v232,v233
C v203,v234,v235
M v[96:99],v[32:35],a[176:179],0
s_mul_i32 s72, s41, 4352
T a[144:145],v17,0
T a[146:147],v17,2048
M v[96:99],v[36:39],a[184:187],v[96:99]
SA s46,s72,104923136
C v204,v204,v205
C v205,v206,v207
M v[96:99],v[40:43],a[192:195],v[96:99]
s_waitcnt lgkmcnt(2)
T a[148:149],v17,4096
T a[150:151],v17,6144
M v[96:99],v[44:47],a[200:203],v[96:99]
s_mov_b32 s25, 2097280
T a[152:153],v17,8192
T a[154:155],v17,10240
M v[96:99],v[48:51],a[208:211],v[96:99]
SA m0,s4,114688
C v206,v236,v237
C v207,v238,v239
M v[96:99],v[52:55],a[216:219],v[96:99]
s_lshl_b32 s45, s42, 7
T a[156:157],v17,12288
T a[158:159],v17,14336
M v[96:99],v[56:59],a[224:227],v[96:99]
SA s45,s45,s46
T a[160:161],v17,16384
T a[162:163],v17,18432
M v[100:103],v[56:59],a[228:231],0
s_lshl_b32 s72, s20, 2
buffer_load_dwordx4 v8, s[52:55], s25 offen lds
M v[100:103],v[52:55],a[220:223],v[100:103]
SA s72,s72,s45
T a[164:165],v17,20480
T a[166:167],v17,22528
M v[100:103],v[48:51],a[212:215],v[100:103]
T a[168:169],v17,24576
T a[170:171],v17,26624
M v[100:103],v[44:47],a[204:207],v[100:103]
s_mov_b32 s25, 2359424
C v208,v208,v209
C v209,v210,v211
M v[100:103],v[40:43],a[196:199],v[100:103]
SA m0,s4,118784
C v210,v240,v241
C v211,v242,v243
M v[100:103],v[36:39],a[188:191],v[100:103]
buffer_load_dwordx4 v8, s[52:55], s25 offen lds
M v[100:103],v[32:35],a[180:183],v[100:103]
s_waitcnt lgkmcnt(6)
C v212,v212,v213
C v213,v214,v215
M v[104:107],a[144:147],a[176:179],0
T v[32:33],v18,0
T v[34:35],v18,2048
M v[104:107],a[148:151],a[184:187],v[104:107]
s_mov_b32 s25, 2621568
C v214,v244,v245
C v215,v246,v247
M v[104:107],a[152:155],a[192:195],v[104:107]
s_waitcnt lgkmcnt(2)
T v[36:37],v18,4096
T v[38:39],v18,6144
M v[104:107],a[156:159],a[200:203],v[104:107]
SA m0,s4,122880
T v[40:41],v18,8192
T v[42:43],v18,10240
M v[104:107],a[160:163],a[208:211],v[104:107]
buffer_load_dwordx4 v8, s[52:55], s25 offen lds
M v[104:107],a[164:167],a[216:219],v[104:107]
s_nop 0
T v[44:45],v18,12288
T v[46:47],v18,14336
M v[104:107],a[168:171],a[224:227],v[104:107]
T v[48:49],v18,16384
T v[50:51],v18,18432
M v[108:111],a[168:171],a[228:231],0
s_mov_b32 s25, 2883712
C v216,v216,v217
C v217,v218,v219
M v[108:111],a[164:167],a[220:223],v[108:111]
SA m0,s4,126976
T v[52:53],v18,20480
T v[54:55],v18,22528
M v[108:111],a[160:163],a[212:215],v[108:111]
T v[56:57],v18,24576
T v[58:59],v18,26624
M v[108:111],a[156:159],a[204:207],v[108:111]
buffer_load_dwordx4 v8, s[52:55], s25 offen lds
M v[108:111],a[152:155],a[196:199],v[108:111]
C v218,v248,v249
C v219,v250,v251
M v[108:111],a[148:151],a[188:191],v[108:111]
C v220,v220,v221
C v221,v222,v223
M v[108:111],a[144:147],a[180:183],v[108:111]
s_waitcnt lgkmcnt(6)
C v222,v252,v253
C v223,v254,v255
M v[112:115],v[32:35],a[176:179],0
s_mov_b32 s25, 3145856
T a[144:145],v19,0
T a[146:147],v19,2048
M v[112:115],v[36:39],a[184:187],v[112:115]
SA m0,s4,32768
v_min_u32 v29, 1, v0
v_lshlrev_b32 v29, 29, v29
M v[112:115],v[40:43],a[192:195],v[112:115]
s_waitcnt lgkmcnt(2)
T a[148:149],v19,4096
T a[150:151],v19,6144
M v[112:115],v[44:47],a[200:203],v[112:115]
T a[152:153],v19,8192
T a[154:155],v19,10240
M v[112:115],v[48:51],a[208:211],v[112:115]
buffer_load_dwordx4 v8, s[52:55], s25 offen lds
M v[112:115],v[52:55],a[216:219],v[112:115]
s_nop 0
T a[156:157],v19,12288
T a[158:159],v19,14336
M v[112:115],v[56:59],a[224:227],v[112:115]
T a[160:161],v19,16384
T a[162:163],v19,18432
M v[116:119],v[56:59],a[228:231],0
s_mov_b32 s25, 3408000
v_mov_b32 v30, 1
v_add_u32 v20, 0x10000, v16
M v[116:119],v[52:55],a[220:223],v[116:119]
SA m0,s4,36864
T a[164:165],v19,20480
T a[166:167],v19,22528
M v[116:119],v[48:51],a[212:215],v[116:119]
s_waitcnt vmcnt(5)
T a[168:169],v19,24576
T a[170:171],v19,26624
M v[116:119],v[44:47],a[204:207],v[116:119]
SA s3,s93,524288
buffer_load_dwordx4 v8, s[52:55], s25 offen lds
M v[116:119],v[40:43],a[196:199],v[116:119]
buffer_store_dword v30, v29, s[8:11], s72 offen offset:4 sc1
M v[116:119],v[36:39],a[188:191],v[116:119]
v_add_u32 v21, 0x10000, v17
v_add_u32 v22, 0x10000, v18
M v[116:119],v[32:35],a[180:183],v[116:119]
s_waitcnt lgkmcnt(6)
buffer_store_dwordx4 v[64:67], v7, s[8:11], s3 offen offset:0 sc1
M v[120:123],a[144:147],a[176:179],0
s_mov_b32 s25, 256
T v[32:33],v16,28672
T v[34:35],v16,30720
M v[120:123],a[148:151],a[184:187],v[120:123]
SA m0,s4,65536
v_add_u32 v23, 0x10000, v19
v_or_b32 v1, s20, v0
M v[120:123],a[152:155],a[192:195],v[120:123]
s_waitcnt lgkmcnt(2)
T v[36:37],v12,0
T v[38:39],v12,2048
M v[120:123],a[156:159],a[200:203],v[120:123]
T v[40:41],v12,4096
T v[42:43],v12,6144
M v[120:123],a[160:163],a[208:211],v[120:123]
buffer_load_dwordx4 v8, s[52:55], s25 offen lds
M v[120:123],a[164:167],a[216:219],v[120:123]
s_nop 0
T v[44:45],v12,8192
T v[46:47],v12,10240
M v[120:123],a[168:171],a[224:227],v[120:123]
T v[48:49],v12,12288
T v[50:51],v12,14336
M v[124:127],a[168:171],a[228:231],0
s_mov_b32 s25, 262400
buffer_store_dwordx4 v[68:71], v7, s[8:11], s3 offen offset:2048 sc1
M v[124:127],a[164:167],a[220:223],v[124:127]
SA m0,s4,69632
T v[52:53],v12,16384
T v[54:55],v12,18432
M v[124:127],a[160:163],a[212:215],v[124:127]
T v[56:57],v12,20480
T v[58:59],v12,22528
M v[124:127],a[156:159],a[204:207],v[124:127]
buffer_load_dwordx4 v8, s[52:55], s25 offen lds
M v[124:127],a[152:155],a[196:199],v[124:127]
v_min_u32 v1, 1, v1
v_lshlrev_b32 v1, 29, v1
M v[124:127],a[148:151],a[188:191],v[124:127]
v_min_u32 v9, 15, v0
v_lshlrev_b32 v9, 7, v9
M v[124:127],a[144:147],a[180:183],v[124:127]
s_waitcnt lgkmcnt(6)
M v[96:99],v[32:35],a[232:235],v[96:99]
s_mov_b32 s25, 524544
T a[144:145],v17,28672
T a[146:147],v17,30720
M v[96:99],v[36:39],a[96:99],v[96:99]
SA m0,s4,73728
M v[96:99],v[40:43],a[104:107],v[96:99]
s_waitcnt lgkmcnt(2)
s_nop 0
T a[148:149],v13,0
T a[150:151],v13,2048
M v[96:99],v[44:47],a[112:115],v[96:99]
SA s3,s93,528384
T a[152:153],v13,4096
T a[154:155],v13,6144
M v[96:99],v[48:51],a[120:123],v[96:99]
s_sub_u32 s66, 15, s42
buffer_load_dwordx4 v8, s[52:55], s25 offen lds
M v[96:99],v[52:55],a[128:131],v[96:99]
s_max_u32 s67, s66, s42
T a[156:157],v13,8192
T a[158:159],v13,10240
M v[96:99],v[56:59],a[136:139],v[96:99]
s_min_u32 s66, s66, s42
T a[160:161],v13,12288
T a[162:163],v13,14336
M v[100:103],v[56:59],a[140:143],v[100:103]
s_mov_b32 s25, 786688
buffer_store_dwordx4 v[72:75], v7, s[8:11], s3 offen offset:0 sc1
M v[100:103],v[52:55],a[132:135],v[100:103]
SA m0,s4,77824
T a[164:165],v13,16384
L_w_kv18:
s_cbranch_execz L_wd2
T a[166:167],v13,18432
M v[100:103],v[48:51],a[124:127],v[100:103]
s_mul_i32 s21, s41, 1048576
T a[168:169],v13,20480
T a[170:171],v13,22528
M v[100:103],v[44:47],a[116:119],v[100:103]
s_lshl_b32 s64, s67, 16
buffer_load_dwordx4 v8, s[52:55], s25 offen lds
M v[100:103],v[40:43],a[108:111],v[100:103]
SA s32,s21,s64
M v[100:103],v[36:39],a[100:103],v[100:103]
s_lshl_b32 s64, s20, 14
buffer_store_dwordx4 v[76:79], v7, s[8:11], s3 offen offset:2048 sc1
M v[100:103],v[32:35],a[236:239],v[100:103]
s_waitcnt lgkmcnt(6)
M v[104:107],a[144:147],a[232:235],v[104:107]
s_mov_b32 s25, 1048832
T v[32:33],v18,28672
T v[34:35],v18,30720
M v[104:107],a[148:151],a[96:99],v[104:107]
SA m0,s4,81920
M v[104:107],a[152:155],a[104:107],v[104:107]
s_waitcnt lgkmcnt(2)
s_nop 0
T v[36:37],v14,0
T v[38:39],v14,2048
M v[104:107],a[156:159],a[112:115],v[104:107]
SA s32,s32,s64
T v[40:41],v14,4096
T v[42:43],v14,6144
M v[104:107],a[160:163],a[120:123],v[104:107]
SA s32,s32,33554432
buffer_load_dwordx4 v8, s[52:55], s25 offen lds
M v[104:107],a[164:167],a[128:131],v[104:107]
s_sub_u32 s64, s42, 10
T v[44:45],v14,8192
T v[46:47],v14,10240
M v[104:107],a[168:171],a[136:139],v[104:107]
s_and_b32 s35, s64, 536870912
T v[48:49],v14,12288
T v[50:51],v14,14336
M v[108:111],a[168:171],a[140:143],v[108:111]
s_mov_b32 s25, 1310976
v_or_b32 v6, s35, v7
M v[108:111],a[164:167],a[132:135],v[108:111]
SA m0,s4,86016
T v[52:53],v14,16384
T v[54:55],v14,18432
M v[108:111],a[160:163],a[124:127],v[108:111]
s_lshl_b32 s28, s20, 13
T v[56:57],v14,20480
T v[58:59],v14,22528
M v[108:111],a[156:159],a[116:119],v[108:111]
buffer_load_dwordx4 v8, s[52:55], s25 offen lds
M v[108:111],a[152:155],a[108:111],v[108:111]
v_add_u32 v2, 0x10000, v7
v_add_u32 v3, s28, v7
M v[108:111],a[148:151],a[100:103],v[108:111]
v_add_u32 v4, 0x1000, v3
MF v96,s5,v96
M v[108:111],a[144:147],a[236:239],v[108:111]
s_waitcnt lgkmcnt(6)
MF v97,s5,v97
MF v98,s5,v98
M v[112:115],v[32:35],a[232:235],v[112:115]
s_mov_b32 s25, 1573120
T a[144:145],v19,28672
T a[146:147],v19,30720
M v[112:115],v[36:39],a[96:99],v[112:115]
SA m0,s4,90112
MF v99,s5,v99
MF v104,s5,v104
M v[112:115],v[40:43],a[104:107],v[112:115]
s_waitcnt lgkmcnt(2)
T a[148:149],v15,0
T a[150:151],v15,2048
M v[112:115],v[44:47],a[112:115],v[112:115]
s_lshl_b32 s64, s42, 16
T a[152:153],v15,4096
T a[154:155],v15,6144
M v[112:115],v[48:51],a[120:123],v[112:115]
SA s23,s21,s64
buffer_load_dwordx4 v8, s[52:55], s25 offen lds
M v[112:115],v[52:55],a[128:131],v[112:115]
SA s43,s23,16777216
T a[156:157],v15,8192
T a[158:159],v15,10240
M v[112:115],v[56:59],a[136:139],v[112:115]
SA s26,s21,16777216
T a[160:161],v15,12288
T a[162:163],v15,14336
M v[116:119],v[56:59],a[140:143],v[116:119]
s_mov_b32 s25, 1835264
MF v105,s5,v105
MF v106,s5,v106
M v[116:119],v[52:55],a[132:135],v[116:119]
SA m0,s4,94208
T a[164:165],v15,16384
T a[166:167],v15,18432
M v[116:119],v[48:51],a[124:127],v[116:119]
s_min_u32 s27, s42, 9
T a[168:169],v15,20480
T a[170:171],v15,22528
M v[116:119],v[44:47],a[116:119],v[116:119]
s_lshl_b32 s22, s27, 1
buffer_load_dwordx4 v8, s[52:55], s25 offen lds
M v[116:119],v[40:43],a[108:111],v[116:119]
s_sub_u32 s22, s22, 1
MF v107,s5,v107
C v96,v96,v97
M v[116:119],v[36:39],a[100:103],v[116:119]
s_waitcnt vmcnt(13) lgkmcnt(0)
C v97,v98,v99
C v98,v104,v105
M v[116:119],v[32:35],a[236:239],v[116:119]
s_barrier
M v[120:123],a[144:147],a[232:235],v[120:123]
s_mov_b32 s25, 2097408
T v[32:33],v16,49152
T v[34:35],v16,51200
M v[120:123],a[148:151],a[96:99],v[120:123]
SA m0,s4,155648
C v99,v106,v107
W a0,v96
M v[120:123],a[152:155],a[104:107],v[120:123]
s_sub_u32 s27, s27, 2
T v[36:37],v16,53248
T v[38:39],v16,55296
M v[120:123],a[156:159],a[112:115],v[120:123]
s_mov_b32 s31, 0x4b800000
T v[40:41],v16,57344
T v[42:43],v16,59392
M v[120:123],a[160:163],a[120:123],v[120:123]
s_mov_b32 s24, 0x33800000
buffer_load_dwordx4 v8, s[52:55], s25 offen lds
M v[120:123],a[164:167],a[128:131],v[120:123]
s_lshl_b32 s47, s66, 7
T v[44:45],v16,61440
T v[46:47],v16,63488
M v[120:123],a[168:171],a[136:139],v[120:123]
SA s47,s47,s46
T v[48:49],v20,32768
T v[50:51],v20,34816
M v[124:127],a[168:171],a[140:143],v[124:127]
s_mov_b32 s25, 2359552
W a1,v97
W a2,v98
M v[124:127],a[164:167],a[132:135],v[124:127]
SA m0,s4,159744
T v[52:53],v20,36864
T v[54:55],v20,38912
M v[124:127],a[160:163],a[124:127],v[124:127]
s_lshl_b32 s64, s20, 5
T v[56:57],v20,40960
T v[58:59],v20,43008
M v[124:127],a[156:159],a[116:119],v[124:127]
SA s47,s47,s64
buffer_load_dwordx4 v8, s[52:55], s25 offen lds
M v[124:127],a[152:155],a[108:111],v[124:127]
SA s47,s47,2048
W a3,v99
MF v100,s5,v100
M v[124:127],a[148:151],a[100:103],v[124:127]
SA s30,s32,0
buffer_store_dwordx4 a[0:3], v6, s[8:11], s30 offen offset:0 sc1
M v[124:127],a[144:147],a[236:239],v[124:127]
s_waitcnt lgkmcnt(6)
MF v101,s5,v101
MF v102,s5,v102
M v[160:163],v[32:35],a[176:179],0
s_lshl_b32 s65, s41, 3
T a[144:145],v17,49152
T a[146:147],v17,51200
M v[160:163],v[36:39],a[184:187],v[160:163]
SA s65,s65,s66
MF v103,s5,v103
MF v108,s5,v108
M v[160:163],v[40:43],a[192:195],v[160:163]
s_waitcnt lgkmcnt(2)
T a[148:149],v17,53248
T a[150:151],v17,55296
M v[160:163],v[44:47],a[200:203],v[160:163]
s_mul_i32 s34, s65, 73728
T a[152:153],v17,57344
T a[154:155],v17,59392
M v[160:163],v[48:51],a[208:211],v[160:163]
SA s34,s34,136314880
MF v109,s5,v109
MF v110,s5,v110
M v[160:163],v[52:55],a[216:219],v[160:163]
s_lshl_b32 s65, s42, 4
T a[156:157],v17,61440
T a[158:159],v17,63488
M v[160:163],v[56:59],a[224:227],v[160:163]
SA s65,s65,s41
T a[160:161],v21,32768
T a[162:163],v21,34816
M v[164:167],v[56:59],a[228:231],0
s_mul_i32 s33, s65, 114688
MF v111,s5,v111
C v100,v100,v101
M v[164:167],v[52:55],a[220:223],v[164:167]
s_mul_i32 s65, s20, 28672
T a[164:165],v21,36864
T a[166:167],v21,38912
M v[164:167],v[48:51],a[212:215],v[164:167]
SA s33,s33,s65
T a[168:169],v21,40960
T a[170:171],v21,43008
M v[164:167],v[44:47],a[204:207],v[164:167]
SA s33,s33,67108864
C v101,v102,v103
C v102,v108,v109
M v[164:167],v[40:43],a[196:199],v[164:167]
s_mov_b32 s6, 0
C v103,v110,v111
W a32,v100
M v[164:167],v[36:39],a[188:191],v[164:167]
s_mov_b32 s7, 1
W a33,v101
W a34,v102
M v[164:167],v[32:35],a[180:183],v[164:167]
s_waitcnt lgkmcnt(6)
W a35,v103
MF v112,s5,v112
M v[168:171],a[144:147],a[176:179],0
SA s30,s32,8192
T v[32:33],v18,49152
T v[34:35],v18,51200
M v[168:171],a[148:151],a[184:187],v[168:171]
s_mov_b32 s40, 1
buffer_store_dwordx4 a[32:35], v6, s[8:11], s30 offen offset:0 sc1
M v[168:171],a[152:155],a[192:195],v[168:171]
s_waitcnt lgkmcnt(2)
s_nop 0
T v[36:37],v18,53248
T v[38:39],v18,55296
M v[168:171],a[156:159],a[200:203],v[168:171]
s_cmp_eq_u32 s20, 0
T v[40:41],v18,57344
T v[42:43],v18,59392
M v[168:171],a[160:163],a[208:211],v[168:171]
s_cselect_b32 s39, 6, 0
MF v113,s5,v113
MF v114,s5,v114
M v[168:171],a[164:167],a[216:219],v[168:171]
s_cmp_eq_u32 s42, 8
T v[44:45],v18,61440
T v[46:47],v18,63488
M v[168:171],a[168:171],a[224:227],v[168:171]
s_cselect_b32 s64, 0, 0
T v[48:49],v22,32768
T v[50:51],v22,34816
M v[172:175],a[168:171],a[228:231],0
s_or_b32 s39, s39, s64
MF v115,s5,v115
MF v120,s5,v120
M v[172:175],a[164:167],a[220:223],v[172:175]
s_mov_b64 s[60:61], s[76:77]
T v[52:53],v22,36864
T v[54:55],v22,38912
M v[172:175],a[160:163],a[212:215],v[172:175]
s_mov_b32 s62, s78
T v[56:57],v22,40960
T v[58:59],v22,43008
M v[172:175],a[156:159],a[204:207],v[172:175]
s_mov_b32 s63, 0x20000
v_lshrrev_b32 v24, 4, v0
v_lshlrev_b32 v24, 2, v24
M v[172:175],a[152:155],a[196:199],v[172:175]
s_mov_b32 s25, 2621696
v_and_b32 v25, 15, v0
v_sub_u32 v24, v24, v25
M v[172:175],a[148:151],a[188:191],v[172:175]
SA m0,s4,131072
v_cmp_lt_i32 s[16:17], 0, v24
v_cmp_lt_i32 s[18:19], -1, v24
M v[172:175],a[144:147],a[180:183],v[172:175]
s_waitcnt lgkmcnt(6)
buffer_load_dwordx4 v8, s[52:55], s25 offen lds
M v[176:179],v[32:35],a[176:179],0
SA s3,s93,532480
T a[144:145],v19,49152
T a[146:147],v19,51200
M v[176:179],v[36:39],a[184:187],v[176:179]
v_cmp_lt_i32 s[48:49], -2, v24
v_cmp_lt_i32 s[50:51], -3, v24
M v[176:179],v[40:43],a[192:195],v[176:179]
s_waitcnt lgkmcnt(2)
T a[148:149],v19,53248
T a[150:151],v19,55296
M v[176:179],v[44:47],a[200:203],v[176:179]
s_mov_b32 s25, 2883840
T a[152:153],v19,57344
T a[154:155],v19,59392
M v[176:179],v[48:51],a[208:211],v[176:179]
SA m0,s4,135168
buffer_store_dwordx4 v[80:83], v7, s[8:11], s3 offen offset:0 sc1
M v[176:179],v[52:55],a[216:219],v[176:179]
s_nop 0
T a[156:157],v19,61440
T a[158:159],v19,63488
M v[176:179],v[56:59],a[224:227],v[176:179]
T a[160:161],v23,32768
T a[162:163],v23,34816
M v[180:183],v[56:59],a[228:231],0
buffer_load_dwordx4 v8, s[52:55], s25 offen lds
M v[180:183],v[52:55],a[220:223],v[180:183]
s_nop 0
T a[164:165],v23,36864
T a[166:167],v23,38912
M v[180:183],v[48:51],a[212:215],v[180:183]
T a[168:169],v23,40960
T a[170:171],v23,43008
M v[180:183],v[44:47],a[204:207],v[180:183]
s_mov_b32 s25, 3145984
buffer_store_dwordx4 v[84:87], v7, s[8:11], s3 offen offset:2048 sc1
M v[180:183],v[40:43],a[196:199],v[180:183]
SA m0,s4,139264
v_lshl_add_u32 v25, v0, 7, s95
v_and_b32 v0, 48, v0
M v[180:183],v[36:39],a[188:191],v[180:183]
buffer_load_dwordx4 v8, s[52:55], s25 offen lds
M v[180:183],v[32:35],a[180:183],v[180:183]
s_waitcnt lgkmcnt(6)
MF v121,s5,v121
MF v122,s5,v122
M v[184:187],a[144:147],a[176:179],0
T v[32:33],v20,45056
T v[34:35],v20,47104
M v[184:187],a[148:151],a[184:187],v[184:187]
s_mov_b32 s25, 3408128
MF v123,s5,v123
C v112,v112,v113
M v[184:187],a[152:155],a[192:195],v[184:187]
s_waitcnt lgkmcnt(2)
T v[36:37],v20,49152
T v[38:39],v20,51200
M v[184:187],a[156:159],a[200:203],v[184:187]
SA m0,s4,143360
T v[40:41],v20,53248
T v[42:43],v20,55296
M v[184:187],a[160:163],a[208:211],v[184:187]
SA s3,s93,536576
buffer_load_dwordx4 v8, s[52:55], s25 offen lds
M v[184:187],a[164:167],a[216:219],v[184:187]
s_nop 0
T v[44:45],v20,57344
T v[46:47],v20,59392
M v[184:187],a[168:171],a[224:227],v[184:187]
T v[48:49],v20,61440
T v[50:51],v20,63488
M v[188:191],a[168:171],a[228:231],0
s_mov_b32 s25, 384
buffer_store_dwordx4 v[88:91], v7, s[8:11], s3 offen offset:0 sc1
M v[188:191],a[164:167],a[220:223],v[188:191]
SA m0,s4,0
T v[52:53],v16,32768
T v[54:55],v16,34816
M v[188:191],a[160:163],a[212:215],v[188:191]
T v[56:57],v16,36864
T v[58:59],v16,38912
M v[188:191],a[156:159],a[204:207],v[188:191]
buffer_load_dwordx4 v8, s[52:55], s25 offen lds
M v[188:191],a[152:155],a[196:199],v[188:191]
C v113,v114,v115
C v114,v120,v121
M v[188:191],a[148:151],a[188:191],v[188:191]
buffer_store_dwordx4 v[92:95], v7, s[8:11], s3 offen offset:2048 sc1
M v[188:191],a[144:147],a[180:183],v[188:191]
s_waitcnt lgkmcnt(6)
C v115,v122,v123
W a4,v112
M v[160:163],v[32:35],a[232:235],v[160:163]
s_mov_b32 s25, 262528
T a[144:145],v21,45056
T a[146:147],v21,47104
M v[160:163],v[36:39],a[96:99],v[160:163]
SA m0,s4,4096
W a5,v113
W a6,v114
M v[160:163],v[40:43],a[104:107],v[160:163]
s_waitcnt lgkmcnt(2)
T a[148:149],v21,49152
T a[150:151],v21,51200
M v[160:163],v[44:47],a[112:115],v[160:163]
T a[152:153],v21,53248
T a[154:155],v21,55296
M v[160:163],v[48:51],a[120:123],v[160:163]
buffer_load_dwordx4 v8, s[52:55], s25 offen lds
M v[160:163],v[52:55],a[128:131],v[160:163]
s_nop 0
T a[156:157],v21,57344
T a[158:159],v21,59392
M v[160:163],v[56:59],a[136:139],v[160:163]
T a[160:161],v21,61440
T a[162:163],v21,63488
M v[164:167],v[56:59],a[140:143],v[164:167]
s_mov_b32 s25, 524672
W a7,v115
v_lshl_add_u32 v0, v0, 24, v25
M v[164:167],v[52:55],a[132:135],v[164:167]
SA s30,s32,0
T a[164:165],v17,32768
T a[166:167],v17,34816
M v[164:167],v[48:51],a[124:127],v[164:167]
SA m0,s4,8192
T a[168:169],v17,36864
T a[170:171],v17,38912
M v[164:167],v[44:47],a[116:119],v[164:167]
buffer_store_dwordx4 a[4:7], v6, s[8:11], s30 offen offset:1024 sc1
M v[164:167],v[40:43],a[108:111],v[164:167]
v_mov_b32 v24, 0x3f80
MF v116,s5,v116
M v[164:167],v[36:39],a[100:103],v[164:167]
buffer_load_dwordx4 v8, s[52:55], s25 offen lds
M v[164:167],v[32:35],a[236:239],v[164:167]
s_waitcnt lgkmcnt(6)
MF v117,s5,v117
MF v118,s5,v118
M v[168:171],a[144:147],a[232:235],v[168:171]
T v[32:33],v22,45056
T v[34:35],v22,47104
M v[168:171],a[148:151],a[96:99],v[168:171]
s_mov_b32 s25, 786816
MF v119,s5,v119
MF v124,s5,v124
M v[168:171],a[152:155],a[104:107],v[168:171]
s_waitcnt lgkmcnt(2)
T v[36:37],v22,49152
T v[38:39],v22,51200
M v[168:171],a[156:159],a[112:115],v[168:171]
SA m0,s4,12288
T v[40:41],v22,53248
T v[42:43],v22,55296
M v[168:171],a[160:163],a[120:123],v[168:171]
buffer_load_dwordx4 v8, s[52:55], s25 offen lds
M v[168:171],a[164:167],a[128:131],v[168:171]
s_nop 0
T v[44:45],v22,57344
T v[46:47],v22,59392
M v[168:171],a[168:171],a[136:139],v[168:171]
T v[48:49],v22,61440
T v[50:51],v22,63488
M v[172:175],a[168:171],a[140:143],v[172:175]
s_mov_b32 s25, 1048960
MF v125,s5,v125
MF v126,s5,v126
M v[172:175],a[164:167],a[132:135],v[172:175]
SA m0,s4,16384
T v[52:53],v18,32768
T v[54:55],v18,34816
M v[172:175],a[160:163],a[124:127],v[172:175]
T v[56:57],v18,36864
T v[58:59],v18,38912
M v[172:175],a[156:159],a[116:119],v[172:175]
buffer_load_dwordx4 v8, s[52:55], s25 offen lds
M v[172:175],a[152:155],a[108:111],v[172:175]
MF v127,s5,v127
C v116,v116,v117
M v[172:175],a[148:151],a[100:103],v[172:175]
v_lshrrev_b32 v25, 8, v7
v_bfe_u32 v26, v7, 6, 2
v_and_b32 v27, 16, v7
v_lshlrev_b32 v27, v27, v24
v_cmp_eq_u32 vcc, v25, v26
v_and_b32 v28, 32, v7
W a244,0
v_cndmask_b32 v27, 0, v27, vcc
v_cmp_eq_u32 vcc, 0, v28
W a245,0
W a248,0
v_cndmask_b32 v25, 0, v27, vcc
v_sub_u32 v26, v27, v25
W a249,0
W a246,v25
W a247,v26
M v[172:175],a[144:147],a[236:239],v[172:175]
s_waitcnt lgkmcnt(6)
C v117,v118,v119
C v118,v124,v125
M v[176:179],v[32:35],a[232:235],v[176:179]
s_mov_b32 s25, 1311104
T a[144:145],v23,45056
T a[146:147],v23,47104
M v[176:179],v[36:39],a[96:99],v[176:179]
SA m0,s4,20480
C v119,v126,v127
W a36,v116
M v[176:179],v[40:43],a[104:107],v[176:179]
s_waitcnt lgkmcnt(2)
T a[148:149],v23,49152
T a[150:151],v23,51200
M v[176:179],v[44:47],a[112:115],v[176:179]
T a[152:153],v23,53248
T a[154:155],v23,55296
M v[176:179],v[48:51],a[120:123],v[176:179]
buffer_load_dwordx4 v8, s[52:55], s25 offen lds
M v[176:179],v[52:55],a[128:131],v[176:179]
s_nop 0
T a[156:157],v23,57344
T a[158:159],v23,59392
M v[176:179],v[56:59],a[136:139],v[176:179]
T a[160:161],v23,61440
T a[162:163],v23,63488
M v[180:183],v[56:59],a[140:143],v[180:183]
s_mov_b32 s25, 1573248
W a37,v117
W a38,v118
M v[180:183],v[52:55],a[132:135],v[180:183]
SA m0,s4,24576
T a[164:165],v19,32768
T a[166:167],v19,34816
M v[180:183],v[48:51],a[124:127],v[180:183]
T a[168:169],v19,36864
T a[170:171],v19,38912
M v[180:183],v[44:47],a[116:119],v[180:183]
buffer_load_dwordx4 v8, s[52:55], s25 offen lds
M v[180:183],v[40:43],a[108:111],v[180:183]
W a39,v119
MF v160,s5,v160
M v[180:183],v[36:39],a[100:103],v[180:183]
s_waitcnt vmcnt(10) lgkmcnt(0)
MF v161,s5,v161
MF v162,s5,v162
M v[180:183],v[32:35],a[236:239],v[180:183]
s_barrier
M v[184:187],a[144:147],a[232:235],v[184:187]
SA s30,s32,8192
T v[32:33],v20,0
T v[34:35],v20,2048
M v[184:187],a[148:151],a[96:99],v[184:187]
s_mov_b32 s25, 1835392
buffer_store_dwordx4 a[36:39], v6, s[8:11], s30 offen offset:1024 sc1
M v[184:187],a[152:155],a[104:107],v[184:187]
SA m0,s4,28672
T v[36:37],v20,4096
T v[38:39],v20,6144
M v[184:187],a[156:159],a[112:115],v[184:187]
T v[40:41],v20,8192
T v[42:43],v20,10240
M v[184:187],a[160:163],a[120:123],v[184:187]
buffer_load_dwordx4 v8, s[52:55], s25 offen lds
M v[184:187],a[164:167],a[128:131],v[184:187]
s_nop 0
T v[44:45],v20,12288
T v[46:47],v20,14336
M v[184:187],a[168:171],a[136:139],v[184:187]
T v[48:49],v20,16384
T v[50:51],v20,18432
M v[188:191],a[168:171],a[140:143],v[188:191]
s_mov_b32 s25, 2097536
MF v163,s5,v163
MF v168,s5,v168
M v[188:191],a[164:167],a[132:135],v[188:191]
SA m0,s4,40960
T v[52:53],v20,20480
T v[54:55],v20,22528
M v[188:191],a[160:163],a[124:127],v[188:191]
T v[56:57],v20,24576
T v[58:59],v20,26624
M v[188:191],a[156:159],a[116:119],v[188:191]
buffer_load_dwordx4 v8, s[52:55], s25 offen lds
M v[188:191],a[152:155],a[108:111],v[188:191]
MF v169,s5,v169
MF v170,s5,v170
M v[188:191],a[148:151],a[100:103],v[188:191]
MF v171,s5,v171
C v160,v160,v161
M v[188:191],a[144:147],a[236:239],v[188:191]
s_waitcnt lgkmcnt(6)
C v161,v162,v163
C v162,v168,v169
M v[96:99],v[32:35],a[176:179],0
s_mov_b32 s25, 2359680
T a[144:145],v21,0
T a[146:147],v21,2048
M v[96:99],v[36:39],a[184:187],v[96:99]
SA m0,s4,45056
C v163,v170,v171
W a8,v160
M v[96:99],v[40:43],a[192:195],v[96:99]
s_waitcnt lgkmcnt(2)
T a[148:149],v21,4096
T a[150:151],v21,6144
M v[96:99],v[44:47],a[200:203],v[96:99]
T a[152:153],v21,8192
T a[154:155],v21,10240
M v[96:99],v[48:51],a[208:211],v[96:99]
buffer_load_dwordx4 v8, s[52:55], s25 offen lds
M v[96:99],v[52:55],a[216:219],v[96:99]
s_nop 0
T a[156:157],v21,12288
T a[158:159],v21,14336
M v[96:99],v[56:59],a[224:227],v[96:99]
T a[160:161],v21,16384
T a[162:163],v21,18432
M v[100:103],v[56:59],a[228:231],0
s_mov_b32 s25, 2621824
W a9,v161
W a10,v162
M v[100:103],v[52:55],a[220:223],v[100:103]
SA m0,s4,49152
T a[164:165],v21,20480
T a[166:167],v21,22528
M v[100:103],v[48:51],a[212:215],v[100:103]
T a[168:169],v21,24576
T a[170:171],v21,26624
M v[100:103],v[44:47],a[204:207],v[100:103]
buffer_load_dwordx4 v8, s[52:55], s25 offen lds
M v[100:103],v[40:43],a[196:199],v[100:103]
W a11,v163
v_lshrrev_b32 v31, 6, v7
M v[100:103],v[36:39],a[188:191],v[100:103]
SA s30,s32,0
buffer_store_dwordx4 a[8:11], v6, s[8:11], s30 offen offset:2048 sc1
M v[100:103],v[32:35],a[180:183],v[100:103]
s_waitcnt lgkmcnt(6)
v_bfe_u32 v28, v7, 4, 2
v_lshlrev_b32 v31, 5, v31
M v[104:107],a[144:147],a[176:179],0
s_mov_b32 s25, 2883968
T v[32:33],v22,0
T v[34:35],v22,2048
M v[104:107],a[148:151],a[184:187],v[104:107]
SA m0,s4,53248
v_add_lshl_u32 v31, v31, v28, 2
MF v164,s5,v164
M v[104:107],a[152:155],a[192:195],v[104:107]
s_waitcnt lgkmcnt(2)
T v[36:37],v22,4096
T v[38:39],v22,6144
M v[104:107],a[156:159],a[200:203],v[104:107]
T v[40:41],v22,8192
T v[42:43],v22,10240
M v[104:107],a[160:163],a[208:211],v[104:107]
buffer_load_dword v5, v31, s[8:11], s46 offen offset:4 sc1
M v[104:107],a[164:167],a[216:219],v[104:107]
s_nop 0
T v[44:45],v22,12288
T v[46:47],v22,14336
M v[104:107],a[168:171],a[224:227],v[104:107]
T v[48:49],v22,16384
T v[50:51],v22,18432
M v[108:111],a[168:171],a[228:231],0
buffer_load_dwordx4 v8, s[52:55], s25 offen lds
M v[108:111],a[164:167],a[220:223],v[108:111]
s_nop 0
T v[52:53],v22,20480
T v[54:55],v22,22528
M v[108:111],a[160:163],a[212:215],v[108:111]
T v[56:57],v22,24576
T v[58:59],v22,26624
M v[108:111],a[156:159],a[204:207],v[108:111]
s_mov_b32 s25, 3146112
MF v165,s5,v165
MF v166,s5,v166
M v[108:111],a[152:155],a[196:199],v[108:111]
SA m0,s4,57344
MF v167,s5,v167
MF v172,s5,v172
M v[108:111],a[148:151],a[188:191],v[108:111]
buffer_load_dwordx4 v8, s[52:55], s25 offen lds
M v[108:111],a[144:147],a[180:183],v[108:111]
s_waitcnt lgkmcnt(6)
MF v173,s5,v173
MF v174,s5,v174
M v[112:115],v[32:35],a[176:179],0
T a[144:145],v23,0
T a[146:147],v23,2048
M v[112:115],v[36:39],a[184:187],v[112:115]
s_mov_b32 s25, 3408256
MF v175,s5,v175
C v164,v164,v165
M v[112:115],v[40:43],a[192:195],v[112:115]
s_waitcnt lgkmcnt(2)
T a[148:149],v23,4096
T a[150:151],v23,6144
M v[112:115],v[44:47],a[200:203],v[112:115]
SA m0,s4,61440
T a[152:153],v23,8192
T a[154:155],v23,10240
M v[112:115],v[48:51],a[208:211],v[112:115]
buffer_load_dwordx4 v8, s[52:55], s25 offen lds
M v[112:115],v[52:55],a[216:219],v[112:115]
s_nop 0
T a[156:157],v23,12288
T a[158:159],v23,14336
M v[112:115],v[56:59],a[224:227],v[112:115]
T a[160:161],v23,16384
T a[162:163],v23,18432
M v[116:119],v[56:59],a[228:231],0
C v165,v166,v167
C v166,v172,v173
M v[116:119],v[52:55],a[220:223],v[116:119]
T a[164:165],v23,20480
T a[166:167],v23,22528
M v[116:119],v[48:51],a[212:215],v[116:119]
T a[168:169],v23,24576
T a[170:171],v23,26624
M v[116:119],v[44:47],a[204:207],v[116:119]
C v167,v174,v175
W a40,v164
M v[116:119],v[40:43],a[196:199],v[116:119]
W a41,v165
W a42,v166
M v[116:119],v[36:39],a[188:191],v[116:119]
W a43,v167
v_mov_b32 v8, 0xff800000
M v[116:119],v[32:35],a[180:183],v[116:119]
s_waitcnt lgkmcnt(6)
MF v176,s5,v176
MF v177,s5,v177
M v[120:123],a[144:147],a[176:179],0
SA s30,s32,8192
T v[32:33],v20,28672
T v[34:35],v20,30720
M v[120:123],a[148:151],a[184:187],v[120:123]
buffer_store_dwordx4 a[40:43], v6, s[8:11], s30 offen offset:2048 sc1
M v[120:123],a[152:155],a[192:195],v[120:123]
s_waitcnt lgkmcnt(2)
s_nop 0
T v[36:37],v12,24576
T v[38:39],v12,26624
M v[120:123],a[156:159],a[200:203],v[120:123]
T v[40:41],v12,28672
T v[42:43],v12,30720
M v[120:123],a[160:163],a[208:211],v[120:123]
MF v178,s5,v178
MF v179,s5,v179
M v[120:123],a[164:167],a[216:219],v[120:123]
T v[44:45],v12,0
T v[46:47],v12,2048
M v[120:123],a[168:171],a[224:227],v[120:123]
T v[48:49],v12,4096
T v[50:51],v12,6144
M v[124:127],a[168:171],a[228:231],0
MF v184,s5,v184
MF v185,s5,v185
M v[124:127],a[164:167],a[220:223],v[124:127]
T v[52:53],v12,8192
T v[54:55],v12,10240
M v[124:127],a[160:163],a[212:215],v[124:127]
T v[56:57],v12,12288
T v[58:59],v12,14336
M v[124:127],a[156:159],a[204:207],v[124:127]
MF v186,s5,v186
MF v187,s5,v187
M v[124:127],a[152:155],a[196:199],v[124:127]
C v176,v176,v177
C v177,v178,v179
M v[124:127],a[148:151],a[188:191],v[124:127]
C v178,v184,v185
C v179,v186,v187
M v[124:127],a[144:147],a[180:183],v[124:127]
s_waitcnt lgkmcnt(6)
W a12,v176
W a13,v177
M v[96:99],v[32:35],a[232:235],v[96:99]
T a[144:145],v21,28672
T a[146:147],v21,30720
M v[96:99],v[36:39],a[96:99],v[96:99]
W a14,v178
W a15,v179
M v[96:99],v[40:43],a[104:107],v[96:99]
s_waitcnt lgkmcnt(2)
T a[148:149],v13,24576
T a[150:151],v13,26624
M v[96:99],v[44:47],a[112:115],v[96:99]
SA s30,s32,0
T a[152:153],v13,28672
T a[154:155],v13,30720
M v[96:99],v[48:51],a[120:123],v[96:99]
buffer_store_dwordx4 a[12:15], v6, s[8:11], s30 offen offset:3072 sc1
M v[96:99],v[52:55],a[128:131],v[96:99]
s_nop 0
T a[156:157],v13,0
T a[158:159],v13,2048
M v[96:99],v[56:59],a[136:139],v[96:99]
T a[160:161],v13,4096
T a[162:163],v13,6144
M v[100:103],v[56:59],a[140:143],v[100:103]
MF v180,s5,v180
MF v181,s5,v181
M v[100:103],v[52:55],a[132:135],v[100:103]
T a[164:165],v13,8192
T a[166:167],v13,10240
M v[100:103],v[48:51],a[124:127],v[100:103]
T a[168:169],v13,12288
T a[170:171],v13,14336
M v[100:103],v[44:47],a[116:119],v[100:103]
MF v182,s5,v182
MF v183,s5,v183
M v[100:103],v[40:43],a[108:111],v[100:103]
MF v188,s5,v188
MF v189,s5,v189
M v[100:103],v[36:39],a[100:103],v[100:103]
MF v190,s5,v190
MF v191,s5,v191
M v[100:103],v[32:35],a[236:239],v[100:103]
s_waitcnt lgkmcnt(6)
C v180,v180,v181
C v181,v182,v183
M v[104:107],a[144:147],a[232:235],v[104:107]
T v[32:33],v22,28672
T v[34:35],v22,30720
M v[104:107],a[148:151],a[96:99],v[104:107]
C v182,v188,v189
C v183,v190,v191
M v[104:107],a[152:155],a[104:107],v[104:107]
s_waitcnt lgkmcnt(2)
T v[36:37],v14,24576
T v[38:39],v14,26624
M v[104:107],a[156:159],a[112:115],v[104:107]
T v[40:41],v14,28672
T v[42:43],v14,30720
M v[104:107],a[160:163],a[120:123],v[104:107]
W a44,v180
W a45,v181
M v[104:107],a[164:167],a[128:131],v[104:107]
T v[44:45],v14,0
T v[46:47],v14,2048
M v[104:107],a[168:171],a[136:139],v[104:107]
T v[48:49],v14,4096
T v[50:51],v14,6144
M v[108:111],a[168:171],a[140:143],v[108:111]
W a46,v182
W a47,v183
M v[108:111],a[164:167],a[132:135],v[108:111]
SA s30,s32,8192
T v[52:53],v14,8192
T v[54:55],v14,10240
M v[108:111],a[160:163],a[124:127],v[108:111]
T v[56:57],v14,12288
T v[58:59],v14,14336
M v[108:111],a[156:159],a[116:119],v[108:111]
buffer_store_dwordx4 a[44:47], v6, s[8:11], s30 offen offset:3072 sc1
M v[108:111],a[152:155],a[108:111],v[108:111]
s_waitcnt vmcnt(6)
v_cmp_ne_u32 vcc, 1, v5
MF v96,s5,v96
M v[108:111],a[148:151],a[100:103],v[108:111]
s_nop 0
MF v97,s5,v97
MF v98,s5,v98
M v[108:111],a[144:147],a[236:239],v[108:111]
s_waitcnt lgkmcnt(6)
MF v99,s5,v99
MF v104,s5,v104
M v[112:115],v[32:35],a[232:235],v[112:115]
s_cmp_lg_u32 vcc_lo, 0
T a[144:145],v23,28672
T a[146:147],v23,30720
M v[112:115],v[36:39],a[96:99],v[112:115]
s_cbranch_scc1 L_wsq1
L_wrq1:
MF v105,s5,v105
MF v106,s5,v106
M v[112:115],v[40:43],a[104:107],v[112:115]
s_waitcnt lgkmcnt(2)
T a[148:149],v15,24576
T a[150:151],v15,26624
M v[112:115],v[44:47],a[112:115],v[112:115]
SA m0,s28,98304
T a[152:153],v15,28672
T a[154:155],v15,30720
M v[112:115],v[48:51],a[120:123],v[112:115]
buffer_load_dwordx4 v3, s[8:11], s21 offen offset:0 sc1 lds
M v[112:115],v[52:55],a[128:131],v[112:115]
s_nop 0
T a[156:157],v15,0
T a[158:159],v15,2048
M v[112:115],v[56:59],a[136:139],v[112:115]
T a[160:161],v15,4096
T a[162:163],v15,6144
M v[116:119],v[56:59],a[140:143],v[116:119]
buffer_load_dwordx4 v3, s[8:11], s21 offen offset:1024 sc1 lds
M v[116:119],v[52:55],a[132:135],v[116:119]
s_nop 0
T a[164:165],v15,8192
T a[166:167],v15,10240
M v[116:119],v[48:51],a[124:127],v[116:119]
T a[168:169],v15,12288
T a[170:171],v15,14336
M v[116:119],v[44:47],a[116:119],v[116:119]
buffer_load_dwordx4 v3, s[8:11], s21 offen offset:2048 sc1 lds
M v[116:119],v[40:43],a[108:111],v[116:119]
MF v107,s5,v107
C v96,v96,v97
M v[116:119],v[36:39],a[100:103],v[116:119]
s_waitcnt vmcnt(6) lgkmcnt(0)
buffer_load_dwordx4 v3, s[8:11], s21 offen offset:3072 sc1 lds
M v[116:119],v[32:35],a[236:239],v[116:119]
s_barrier
M v[120:123],a[144:147],a[232:235],v[120:123]
SA m0,s28,102400
T v[32:33],v16,0
T v[34:35],v16,2048
M v[120:123],a[148:151],a[96:99],v[120:123]
buffer_load_dwordx4 v4, s[8:11], s21 offen offset:0 sc1 lds
M v[120:123],a[152:155],a[104:107],v[120:123]
s_nop 0
T v[36:37],v16,4096
T v[38:39],v16,6144
M v[120:123],a[156:159],a[112:115],v[120:123]
T v[40:41],v16,8192
T v[42:43],v16,10240
M v[120:123],a[160:163],a[120:123],v[120:123]
buffer_load_dwordx4 v4, s[8:11], s21 offen offset:1024 sc1 lds
M v[120:123],a[164:167],a[128:131],v[120:123]
s_nop 0
T v[44:45],v16,12288
T v[46:47],v16,14336
M v[120:123],a[168:171],a[136:139],v[120:123]
T v[48:49],v16,16384
T v[50:51],v16,18432
M v[124:127],a[168:171],a[140:143],v[124:127]
buffer_load_dwordx4 v4, s[8:11], s21 offen offset:2048 sc1 lds
M v[124:127],a[164:167],a[132:135],v[124:127]
s_nop 0
T v[52:53],v16,20480
T v[54:55],v16,22528
M v[124:127],a[160:163],a[124:127],v[124:127]
T v[56:57],v16,24576
T v[58:59],v16,26624
M v[124:127],a[156:159],a[116:119],v[124:127]
buffer_load_dwordx4 v4, s[8:11], s21 offen offset:3072 sc1 lds
M v[124:127],a[152:155],a[108:111],v[124:127]
SA s21,s21,32768
C v97,v98,v99
C v98,v104,v105
M v[124:127],a[148:151],a[100:103],v[124:127]
s_sub_u32 s22, s22, 1
C v99,v106,v107
W a16,v96
M v[124:127],a[144:147],a[236:239],v[124:127]
s_waitcnt lgkmcnt(6)
W a17,v97
W a18,v98
M v[160:163],v[32:35],a[176:179],0
s_cselect_b32 s21, s23, s21
T a[144:145],v17,0
T a[146:147],v17,2048
M v[160:163],v[36:39],a[184:187],v[160:163]
SA m0,s28,65536
W a19,v99
MF v100,s5,v100
M v[160:163],v[40:43],a[192:195],v[160:163]
s_waitcnt lgkmcnt(2)
T a[148:149],v17,4096
T a[150:151],v17,6144
M v[160:163],v[44:47],a[200:203],v[160:163]
SA s30,s32,4096
T a[152:153],v17,8192
T a[154:155],v17,10240
M v[160:163],v[48:51],a[208:211],v[160:163]
buffer_store_dwordx4 a[16:19], v6, s[8:11], s30 offen offset:0 sc1
M v[160:163],v[52:55],a[216:219],v[160:163]
s_nop 0
T a[156:157],v17,12288
T a[158:159],v17,14336
M v[160:163],v[56:59],a[224:227],v[160:163]
T a[160:161],v17,16384
T a[162:163],v17,18432
M v[164:167],v[56:59],a[228:231],0
buffer_load_dwordx4 v3, s[8:11], s21 offen offset:0 sc1 lds
M v[164:167],v[52:55],a[220:223],v[164:167]
s_nop 0
T a[164:165],v17,20480
T a[166:167],v17,22528
M v[164:167],v[48:51],a[212:215],v[164:167]
T a[168:169],v17,24576
T a[170:171],v17,26624
M v[164:167],v[44:47],a[204:207],v[164:167]
buffer_load_dwordx4 v3, s[8:11], s21 offen offset:1024 sc1 lds
M v[164:167],v[40:43],a[196:199],v[164:167]
buffer_load_dword v5, v31, s[8:11], s46 offen offset:4 sc1
M v[164:167],v[36:39],a[188:191],v[164:167]
buffer_load_dwordx4 v3, s[8:11], s21 offen offset:2048 sc1 lds
M v[164:167],v[32:35],a[180:183],v[164:167]
s_waitcnt lgkmcnt(6)
MF v101,s5,v101
MF v102,s5,v102
M v[168:171],a[144:147],a[176:179],0
T v[32:33],v18,0
T v[34:35],v18,2048
M v[168:171],a[148:151],a[184:187],v[168:171]
buffer_load_dwordx4 v3, s[8:11], s21 offen offset:3072 sc1 lds
M v[168:171],a[152:155],a[192:195],v[168:171]
s_waitcnt lgkmcnt(2)
s_nop 0
T v[36:37],v18,4096
T v[38:39],v18,6144
M v[168:171],a[156:159],a[200:203],v[168:171]
SA m0,s28,69632
T v[40:41],v18,8192
T v[42:43],v18,10240
M v[168:171],a[160:163],a[208:211],v[168:171]
buffer_load_dwordx4 v4, s[8:11], s21 offen offset:0 sc1 lds
M v[168:171],a[164:167],a[216:219],v[168:171]
s_nop 0
T v[44:45],v18,12288
T v[46:47],v18,14336
M v[168:171],a[168:171],a[224:227],v[168:171]
T v[48:49],v18,16384
T v[50:51],v18,18432
M v[172:175],a[168:171],a[228:231],0
buffer_load_dwordx4 v4, s[8:11], s21 offen offset:1024 sc1 lds
M v[172:175],a[164:167],a[220:223],v[172:175]
s_nop 0
T v[52:53],v18,20480
T v[54:55],v18,22528
M v[172:175],a[160:163],a[212:215],v[172:175]
T v[56:57],v18,24576
T v[58:59],v18,26624
M v[172:175],a[156:159],a[204:207],v[172:175]
buffer_load_dwordx4 v4, s[8:11], s21 offen offset:2048 sc1 lds
M v[172:175],a[152:155],a[196:199],v[172:175]
MF v103,s5,v103
MF v108,s5,v108
M v[172:175],a[148:151],a[188:191],v[172:175]
buffer_load_dwordx4 v4, s[8:11], s21 offen offset:3072 sc1 lds
M v[172:175],a[144:147],a[180:183],v[172:175]
s_waitcnt lgkmcnt(6)
MF v109,s5,v109
MF v110,s5,v110
M v[176:179],v[32:35],a[176:179],0
SA s21,s21,32768
T a[144:145],v19,0
T a[146:147],v19,2048
M v[176:179],v[36:39],a[184:187],v[176:179]
s_sub_u32 s22, s22, 1
MF v111,s5,v111
C v100,v100,v101
M v[176:179],v[40:43],a[192:195],v[176:179]
s_waitcnt lgkmcnt(2)
T a[148:149],v19,4096
T a[150:151],v19,6144
M v[176:179],v[44:47],a[200:203],v[176:179]
s_cselect_b32 s21, s23, s21
T a[152:153],v19,8192
T a[154:155],v19,10240
M v[176:179],v[48:51],a[208:211],v[176:179]
C v101,v102,v103
C v102,v108,v109
M v[176:179],v[52:55],a[216:219],v[176:179]
T a[156:157],v19,12288
T a[158:159],v19,14336
M v[176:179],v[56:59],a[224:227],v[176:179]
T a[160:161],v19,16384
T a[162:163],v19,18432
M v[180:183],v[56:59],a[228:231],0
C v103,v110,v111
W a48,v100
M v[180:183],v[52:55],a[220:223],v[180:183]
T a[164:165],v19,20480
T a[166:167],v19,22528
M v[180:183],v[48:51],a[212:215],v[180:183]
T a[168:169],v19,24576
T a[170:171],v19,26624
M v[180:183],v[44:47],a[204:207],v[180:183]
W a49,v101
W a50,v102
M v[180:183],v[40:43],a[196:199],v[180:183]
W a51,v103
MF v112,s5,v112
M v[180:183],v[36:39],a[188:191],v[180:183]
SA s30,s32,12288
buffer_store_dwordx4 a[48:51], v6, s[8:11], s30 offen offset:0 sc1
M v[180:183],v[32:35],a[180:183],v[180:183]
s_waitcnt lgkmcnt(6)
MF v113,s5,v113
MF v114,s5,v114
M v[184:187],a[144:147],a[176:179],0
T v[32:33],v16,28672
T v[34:35],v16,30720
M v[184:187],a[148:151],a[184:187],v[184:187]
MF v115,s5,v115
MF v120,s5,v120
M v[184:187],a[152:155],a[192:195],v[184:187]
s_waitcnt lgkmcnt(2)
T v[36:37],v16,40960
T v[38:39],v16,43008
M v[184:187],a[156:159],a[200:203],v[184:187]
T v[40:41],v16,45056
T v[42:43],v16,47104
M v[184:187],a[160:163],a[208:211],v[184:187]
MF v121,s5,v121
MF v122,s5,v122
M v[184:187],a[164:167],a[216:219],v[184:187]
T v[44:45],v16,49152
T v[46:47],v16,51200
M v[184:187],a[168:171],a[224:227],v[184:187]
T v[48:49],v16,53248
T v[50:51],v16,55296
M v[188:191],a[168:171],a[228:231],0
MF v123,s5,v123
C v112,v112,v113
M v[188:191],a[164:167],a[220:223],v[188:191]
T v[52:53],v16,57344
T v[54:55],v16,59392
M v[188:191],a[160:163],a[212:215],v[188:191]
T v[56:57],v16,61440
T v[58:59],v16,63488
M v[188:191],a[156:159],a[204:207],v[188:191]
C v113,v114,v115
C v114,v120,v121
M v[188:191],a[152:155],a[196:199],v[188:191]
C v115,v122,v123
W a20,v112
M v[188:191],a[148:151],a[188:191],v[188:191]
W a21,v113
W a22,v114
M v[188:191],a[144:147],a[180:183],v[188:191]
s_waitcnt lgkmcnt(6)
W a23,v115
MF v116,s5,v116
M v[160:163],v[32:35],a[232:235],v[160:163]
SA s30,s32,4096
T a[144:145],v17,28672
T a[146:147],v17,30720
M v[160:163],v[36:39],a[96:99],v[160:163]
buffer_store_dwordx4 a[20:23], v6, s[8:11], s30 offen offset:1024 sc1
M v[160:163],v[40:43],a[104:107],v[160:163]
s_waitcnt lgkmcnt(2)
s_nop 0
T a[148:149],v17,40960
T a[150:151],v17,43008
M v[160:163],v[44:47],a[112:115],v[160:163]
T a[152:153],v17,45056
T a[154:155],v17,47104
M v[160:163],v[48:51],a[120:123],v[160:163]
MF v117,s5,v117
MF v118,s5,v118
M v[160:163],v[52:55],a[128:131],v[160:163]
T a[156:157],v17,49152
T a[158:159],v17,51200
M v[160:163],v[56:59],a[136:139],v[160:163]
T a[160:161],v17,53248
T a[162:163],v17,55296
M v[164:167],v[56:59],a[140:143],v[164:167]
MF v119,s5,v119
MF v124,s5,v124
M v[164:167],v[52:55],a[132:135],v[164:167]
T a[164:165],v17,57344
T a[166:167],v17,59392
M v[164:167],v[48:51],a[124:127],v[164:167]
T a[168:169],v17,61440
T a[170:171],v17,63488
M v[164:167],v[44:47],a[116:119],v[164:167]
MF v125,s5,v125
MF v126,s5,v126
M v[164:167],v[40:43],a[108:111],v[164:167]
MF v127,s5,v127
C v116,v116,v117
M v[164:167],v[36:39],a[100:103],v[164:167]
C v117,v118,v119
C v118,v124,v125
M v[164:167],v[32:35],a[236:239],v[164:167]
s_waitcnt lgkmcnt(6)
C v119,v126,v127
W a52,v116
M v[168:171],a[144:147],a[232:235],v[168:171]
T v[32:33],v18,28672
T v[34:35],v18,30720
M v[168:171],a[148:151],a[96:99],v[168:171]
W a53,v117
W a54,v118
M v[168:171],a[152:155],a[104:107],v[168:171]
s_waitcnt lgkmcnt(2)
T v[36:37],v18,40960
T v[38:39],v18,43008
M v[168:171],a[156:159],a[112:115],v[168:171]
T v[40:41],v18,45056
T v[42:43],v18,47104
M v[168:171],a[160:163],a[120:123],v[168:171]
W a55,v119
s_waitcnt vmcnt(8)
v_cmp_ne_u32 vcc, 1, v5
M v[168:171],a[164:167],a[128:131],v[168:171]
SA s30,s32,12288
T v[44:45],v18,49152
T v[46:47],v18,51200
M v[168:171],a[168:171],a[136:139],v[168:171]
s_nop 0
T v[48:49],v18,53248
T v[50:51],v18,55296
M v[172:175],a[168:171],a[140:143],v[172:175]
s_cmp_lg_u32 vcc_hi, 0
buffer_store_dwordx4 a[52:55], v6, s[8:11], s30 offen offset:1024 sc1
M v[172:175],a[164:167],a[132:135],v[172:175]
s_cbranch_scc1 L_wsr1
L_wrr1:
T v[52:53],v18,57344
T v[54:55],v18,59392
M v[172:175],a[160:163],a[124:127],v[172:175]
SA m0,s28,131072
T v[56:57],v18,61440
T v[58:59],v18,63488
M v[172:175],a[156:159],a[116:119],v[172:175]
buffer_load_dwordx4 v3, s[8:11], s26 offen offset:0 sc1 lds
M v[172:175],a[152:155],a[108:111],v[172:175]
MF v160,s5,v160
MF v161,s5,v161
M v[172:175],a[148:151],a[100:103],v[172:175]
buffer_load_dwordx4 v3, s[8:11], s26 offen offset:1024 sc1 lds
M v[172:175],a[144:147],a[236:239],v[172:175]
s_waitcnt lgkmcnt(6)
MF v162,s5,v162
MF v163,s5,v163
M v[176:179],v[32:35],a[232:235],v[176:179]
T a[144:145],v19,28672
T a[146:147],v19,30720
M v[176:179],v[36:39],a[96:99],v[176:179]
buffer_load_dwordx4 v3, s[8:11], s26 offen offset:2048 sc1 lds
M v[176:179],v[40:43],a[104:107],v[176:179]
s_waitcnt lgkmcnt(2)
s_nop 0
T a[148:149],v19,40960
T a[150:151],v19,43008
M v[176:179],v[44:47],a[112:115],v[176:179]
T a[152:153],v19,45056
T a[154:155],v19,47104
M v[176:179],v[48:51],a[120:123],v[176:179]
buffer_load_dwordx4 v3, s[8:11], s26 offen offset:3072 sc1 lds
M v[176:179],v[52:55],a[128:131],v[176:179]
SA m0,s28,135168
T a[156:157],v19,49152
T a[158:159],v19,51200
M v[176:179],v[56:59],a[136:139],v[176:179]
T a[160:161],v19,53248
T a[162:163],v19,55296
M v[180:183],v[56:59],a[140:143],v[180:183]
buffer_load_dwordx4 v4, s[8:11], s26 offen offset:0 sc1 lds
M v[180:183],v[52:55],a[132:135],v[180:183]
s_nop 0
T a[164:165],v19,57344
T a[166:167],v19,59392
M v[180:183],v[48:51],a[124:127],v[180:183]
T a[168:169],v19,61440
T a[170:171],v19,63488
M v[180:183],v[44:47],a[116:119],v[180:183]
buffer_load_dwordx4 v4, s[8:11], s26 offen offset:1024 sc1 lds
M v[180:183],v[40:43],a[108:111],v[180:183]
MF v168,s5,v168
MF v169,s5,v169
M v[180:183],v[36:39],a[100:103],v[180:183]
s_waitcnt lgkmcnt(0)
buffer_load_dwordx4 v4, s[8:11], s26 offen offset:2048 sc1 lds
M v[180:183],v[32:35],a[236:239],v[180:183]
s_barrier
M v[184:187],a[144:147],a[232:235],v[184:187]
R a[64:67],v2,32768
R a[68:71],v2,33792
M v[184:187],a[148:151],a[96:99],v[184:187]
buffer_load_dwordx4 v4, s[8:11], s26 offen offset:3072 sc1 lds
M v[184:187],a[152:155],a[104:107],v[184:187]
SA s26,s26,32768
MF v170,s5,v170
MF v171,s5,v171
M v[184:187],a[156:159],a[112:115],v[184:187]
R a[72:75],v2,34816
R a[76:79],v2,35840
M v[184:187],a[160:163],a[120:123],v[184:187]
C v160,v160,v161
C v161,v162,v163
M v[184:187],a[164:167],a[128:131],v[184:187]
C v162,v168,v169
C v163,v170,v171
M v[184:187],a[168:171],a[136:139],v[184:187]
R a[80:83],v2,36864
R a[84:87],v2,37888
M v[188:191],a[168:171],a[140:143],v[188:191]
W a24,v160
W a25,v161
M v[188:191],a[164:167],a[132:135],v[188:191]
W a26,v162
W a27,v163
M v[188:191],a[160:163],a[124:127],v[188:191]
SA s30,s32,4096
R a[88:91],v2,38912
R a[92:95],v2,39936
M v[188:191],a[156:159],a[116:119],v[188:191]
buffer_store_dwordx4 a[24:27], v6, s[8:11], s30 offen offset:2048 sc1
M v[188:191],a[152:155],a[108:111],v[188:191]
MF v164,s5,v164
MF v165,s5,v165
M v[188:191],a[148:151],a[100:103],v[188:191]
MF v166,s5,v166
MF v167,s5,v167
M v[188:191],a[144:147],a[236:239],v[188:191]
s_waitcnt lgkmcnt(0)
MF v172,s5,v172
MF v173,s5,v173
MF v174,s5,v174
MF v175,s5,v175
C v164,v164,v165
C v165,v166,v167
C v166,v172,v173
C v167,v174,v175
W a56,v164
W a57,v165
W a58,v166
W a59,v167
SA s30,s32,12288
buffer_store_dwordx4 a[56:59], v6, s[8:11], s30 offen offset:2048 sc1
v_mov_b32 v30, 2
buffer_store_dword v30, v1, s[8:11], s45 offen sc1
M v[64:67],a[64:67],a[0:3],0
R a[96:99],v2,40960
R a[100:103],v2,41984
M v[64:67],a[68:71],a[4:7],v[64:67]
MF v176,s5,v176
MF v177,s5,v177
M v[64:67],a[72:75],a[8:11],v[64:67]
MF v178,s5,v178
MF v179,s5,v179
M v[64:67],a[76:79],a[12:15],v[64:67]
R a[104:107],v2,43008
R a[108:111],v2,44032
M v[64:67],a[80:83],a[16:19],v[64:67]
MF v184,s5,v184
MF v185,s5,v185
MF v186,s5,v186
MF v187,s5,v187
C v176,v176,v177
C v177,v178,v179
C v178,v184,v185
C v179,v186,v187
W a28,v176
W a29,v177
W a30,v178
W a31,v179
M v[64:67],a[84:87],a[20:23],v[64:67]
MF v180,s5,v180
MF v181,s5,v181
M v[64:67],a[88:91],a[24:27],v[64:67]
R a[112:115],v2,45056
R a[116:119],v2,46080
M v[64:67],a[92:95],a[28:31],v[64:67]
MF v182,s5,v182
MF v183,s5,v183
M v[68:71],a[64:67],a[32:35],0
MF v188,s5,v188
MF v189,s5,v189
M v[68:71],a[68:71],a[36:39],v[68:71]
R a[120:123],v2,47104
R a[124:127],v2,48128
M v[68:71],a[72:75],a[40:43],v[68:71]
SA m0,s28,32768
MF v190,s5,v190
MF v191,s5,v191
M v[68:71],a[76:79],a[44:47],v[68:71]
buffer_load_dwordx4 v3, s[8:11], s26 offen offset:0 sc1 lds
M v[68:71],a[80:83],a[48:51],v[68:71]
C v180,v180,v181
C v181,v182,v183
C v182,v188,v189
C v183,v190,v191
W a60,v180
W a61,v181
W a62,v182
W a63,v183
M v[68:71],a[84:87],a[52:55],v[68:71]
SA s30,s32,4096
buffer_store_dwordx4 a[28:31], v6, s[8:11], s30 offen offset:3072 sc1
M v[68:71],a[88:91],a[56:59],v[68:71]
SA s30,s32,12288
E v18,v64
M v[68:71],a[92:95],a[60:63],v[68:71]
s_waitcnt lgkmcnt(0)
buffer_store_dwordx4 a[60:63], v6, s[8:11], s30 offen offset:3072 sc1
M v[72:75],a[96:99],a[0:3],0
R a[64:67],v2,49152
R a[68:71],v2,50176
M v[72:75],a[100:103],a[4:7],v[72:75]
E v19,v65
M v[72:75],a[104:107],a[8:11],v[72:75]
buffer_load_dwordx4 v3, s[8:11], s26 offen offset:1024 sc1 lds
M v[72:75],a[108:111],a[12:15],v[72:75]
R a[72:75],v2,51200
R a[76:79],v2,52224
M v[72:75],a[112:115],a[16:19],v[72:75]
E v20,v66
M v[72:75],a[116:119],a[20:23],v[72:75]
buffer_load_dwordx4 v3, s[8:11], s26 offen offset:2048 sc1 lds
M v[72:75],a[120:123],a[24:27],v[72:75]
R a[80:83],v2,53248
R a[84:87],v2,54272
M v[72:75],a[124:127],a[28:31],v[72:75]
E v21,v67
M v[76:79],a[124:127],a[60:63],0
buffer_load_dwordx4 v3, s[8:11], s26 offen offset:3072 sc1 lds
M v[76:79],a[120:123],a[56:59],v[76:79]
SA m0,s28,36864
R a[88:91],v2,55296
R a[92:95],v2,56320
M v[76:79],a[116:119],a[52:55],v[76:79]
E v22,v68
M v[76:79],a[112:115],a[48:51],v[76:79]
buffer_load_dwordx4 v4, s[8:11], s26 offen offset:0 sc1 lds
M v[76:79],a[108:111],a[44:47],v[76:79]
E v23,v69
M v[76:79],a[104:107],a[40:43],v[76:79]
AF v26,v18,v19
C v40,v18,v19
M v[76:79],a[100:103],a[36:39],v[76:79]
buffer_load_dwordx4 v4, s[8:11], s26 offen offset:1024 sc1 lds
M v[76:79],a[96:99],a[32:35],v[76:79]
s_waitcnt lgkmcnt(0)
v_add_u32 v16, 0x20000, v7
AF v26,v20,v26
M v[80:83],a[64:67],a[0:3],0
R a[96:99],v2,57344
R a[100:103],v2,58368
M v[80:83],a[68:71],a[4:7],v[80:83]
buffer_load_dwordx4 v4, s[8:11], s26 offen offset:2048 sc1 lds
M v[80:83],a[72:75],a[8:11],v[80:83]
E v24,v70
M v[80:83],a[76:79],a[12:15],v[80:83]
R a[104:107],v2,59392
R a[108:111],v2,60416
M v[80:83],a[80:83],a[16:19],v[80:83]
buffer_load_dwordx4 v4, s[8:11], s26 offen offset:3072 sc1 lds
M v[80:83],a[84:87],a[20:23],v[80:83]
SA s26,s26,32768
E v25,v71
M v[80:83],a[88:91],a[24:27],v[80:83]
R a[112:115],v2,61440
R a[116:119],v2,62464
M v[80:83],a[92:95],a[28:31],v[80:83]
E v18,v72
M v[84:87],a[92:95],a[60:63],0
E v19,v73
M v[84:87],a[88:91],a[56:59],v[84:87]
R a[120:123],v2,63488
R a[124:127],v2,64512
M v[84:87],a[84:87],a[52:55],v[84:87]
C v41,v20,v21
AF v26,v21,v26
M v[84:87],a[80:83],a[48:51],v[84:87]
E v20,v74
M v[84:87],a[76:79],a[44:47],v[84:87]
AF v27,v22,v23
C v44,v22,v23
M v[84:87],a[72:75],a[40:43],v[84:87]
AF v27,v24,v27
C v45,v24,v25
M v[84:87],a[68:71],a[36:39],v[84:87]
s_waitcnt vmcnt(24) lgkmcnt(0)
E v21,v75
M v[84:87],a[64:67],a[32:35],v[84:87]
s_barrier
M v[88:91],a[96:99],a[0:3],0
R a[64:67],v2,0
R a[68:71],v2,1024
M v[88:91],a[100:103],a[4:7],v[88:91]
E v22,v76
M v[88:91],a[104:107],a[8:11],v[88:91]
AF v27,v25,v27
AF v26,v18,v26
M v[88:91],a[108:111],a[12:15],v[88:91]
R a[72:75],v2,2048
R a[76:79],v2,3072
M v[88:91],a[112:115],a[16:19],v[88:91]
E v23,v77
M v[88:91],a[116:119],a[20:23],v[88:91]
C v42,v18,v19
AF v26,v19,v26
M v[88:91],a[120:123],a[24:27],v[88:91]
R a[80:83],v2,4096
R a[84:87],v2,5120
M v[88:91],a[124:127],a[28:31],v[88:91]
E v24,v78
M v[92:95],a[124:127],a[60:63],0
AF v26,v20,v26
C v43,v20,v21
M v[92:95],a[120:123],a[56:59],v[92:95]
R a[88:91],v2,6144
R a[92:95],v2,7168
M v[92:95],a[116:119],a[52:55],v[92:95]
E v25,v79
M v[92:95],a[112:115],a[48:51],v[92:95]
AF v26,v21,v26
AF v27,v22,v27
M v[92:95],a[108:111],a[44:47],v[92:95]
C v46,v22,v23
AF v27,v23,v27
M v[92:95],a[104:107],a[40:43],v[92:95]
AF v27,v24,v27
C v47,v24,v25
M v[92:95],a[100:103],a[36:39],v[92:95]
s_waitcnt lgkmcnt(0)
AF v27,v25,v27
M v[92:95],a[96:99],a[32:35],v[92:95]
M v[96:99],a[64:67],a[0:3],0
R a[96:99],v2,8192
R a[100:103],v2,9216
M v[96:99],a[68:71],a[4:7],v[96:99]
SA m0,s28,98304
W a128,v128
W a129,v129
M v[96:99],a[72:75],a[8:11],v[96:99]
buffer_load_dwordx4 v3, s[8:11], s21 offen offset:0 sc1 lds
M v[96:99],a[76:79],a[12:15],v[96:99]
R a[104:107],v2,10240
R a[108:111],v2,11264
M v[96:99],a[80:83],a[16:19],v[96:99]
W a130,v130
v_mov_b32 v30, 0
M v[96:99],a[84:87],a[20:23],v[96:99]
W a131,v131
M v[96:99],a[88:91],a[24:27],v[96:99]
R a[112:115],v2,12288
R a[116:119],v2,13312
M v[96:99],a[92:95],a[28:31],v[96:99]
buffer_load_dwordx4 v3, s[8:11], s21 offen offset:1024 sc1 lds
M v[100:103],a[92:95],a[60:63],0
W a132,v132
v_mov_b32 v31, 0
M v[100:103],a[88:91],a[56:59],v[100:103]
R a[120:123],v2,14336
R a[124:127],v2,15360
M v[100:103],a[84:87],a[52:55],v[100:103]
W a133,v133
W a134,v134
M v[100:103],a[80:83],a[48:51],v[100:103]
buffer_load_dwordx4 v3, s[8:11], s21 offen offset:2048 sc1 lds
M v[100:103],a[76:79],a[44:47],v[100:103]
W a135,v135
M v[100:103],a[72:75],a[40:43],v[100:103]
v_mov_b32 v32, 0
M v[100:103],a[68:71],a[36:39],v[100:103]
W a136,v136
M v[100:103],a[64:67],a[32:35],v[100:103]
s_waitcnt lgkmcnt(0)
buffer_load_dwordx4 v3, s[8:11], s21 offen offset:3072 sc1 lds
M v[104:107],a[96:99],a[0:3],0
SA m0,s28,102400
R a[64:67],v2,16384
R a[68:71],v2,17408
M v[104:107],a[100:103],a[4:7],v[104:107]
W a137,v137
v_mov_b32 v33, 0
M v[104:107],a[104:107],a[8:11],v[104:107]
W a138,v138
M v[104:107],a[108:111],a[12:15],v[104:107]
R a[72:75],v2,18432
R a[76:79],v2,19456
M v[104:107],a[112:115],a[16:19],v[104:107]
buffer_load_dwordx4 v4, s[8:11], s21 offen offset:0 sc1 lds
M v[104:107],a[116:119],a[20:23],v[104:107]
W a139,v139
W a140,v140
M v[104:107],a[120:123],a[24:27],v[104:107]
R a[80:83],v2,20480
R a[84:87],v2,21504
M v[104:107],a[124:127],a[28:31],v[104:107]
buffer_load_dwordx4 v4, s[8:11], s21 offen offset:1024 sc1 lds
M v[108:111],a[124:127],a[60:63],0
v_mov_b32 v34, 0
W a141,v141
M v[108:111],a[120:123],a[56:59],v[108:111]
R a[88:91],v2,22528
R a[92:95],v2,23552
M v[108:111],a[116:119],a[52:55],v[108:111]
buffer_load_dwordx4 v4, s[8:11], s21 offen offset:2048 sc1 lds
M v[108:111],a[112:115],a[48:51],v[108:111]
W a142,v142
W a143,v143
M v[108:111],a[108:111],a[44:47],v[108:111]
v_mov_b32 v35, 0
W a144,v144
M v[108:111],a[104:107],a[40:43],v[108:111]
W a145,v145
M v[108:111],a[100:103],a[36:39],v[108:111]
buffer_load_dwordx4 v4, s[8:11], s21 offen offset:3072 sc1 lds
M v[108:111],a[96:99],a[32:35],v[108:111]
s_waitcnt lgkmcnt(0)
v_mov_b32 v36, 0
W a146,v146
M v[112:115],a[64:67],a[0:3],0
SA s21,s21,32768
R a[96:99],v2,24576
R a[100:103],v2,25600
M v[112:115],a[68:71],a[4:7],v[112:115]
s_sub_u32 s22, s22, 1
W a147,v147
M v[112:115],a[72:75],a[8:11],v[112:115]
s_cselect_b32 s21, s23, s21
E v18,v80
M v[112:115],a[76:79],a[12:15],v[112:115]
R a[104:107],v2,26624
R a[108:111],v2,27648
M v[112:115],a[80:83],a[16:19],v[112:115]
W a148,v148
v_mov_b32 v37, 0
M v[112:115],a[84:87],a[20:23],v[112:115]
W a149,v149
M v[112:115],a[88:91],a[24:27],v[112:115]
R a[112:115],v2,28672
R a[116:119],v2,29696
M v[112:115],a[92:95],a[28:31],v[112:115]
W a150,v150
M v[116:119],a[92:95],a[60:63],0
v_mov_b32 v38, 0
W a151,v151
M v[116:119],a[88:91],a[56:59],v[116:119]
R a[120:123],v2,30720
R a[124:127],v2,31744
M v[116:119],a[84:87],a[52:55],v[116:119]
W a152,v152
M v[116:119],a[80:83],a[48:51],v[116:119]
W a153,v153
M v[116:119],a[76:79],a[44:47],v[116:119]
E v19,v81
M v[116:119],a[72:75],a[40:43],v[116:119]
v_mov_b32 v39, 0
W a154,v154
M v[116:119],a[68:71],a[36:39],v[116:119]
s_waitcnt vmcnt(21) lgkmcnt(0)
E v20,v82
M v[116:119],a[64:67],a[32:35],v[116:119]
s_barrier
M v[120:123],a[96:99],a[0:3],0
R a[64:67],v16,0
R a[68:71],v16,1024
M v[120:123],a[100:103],a[4:7],v[120:123]
W a155,v155
W a156,v156
M v[120:123],a[104:107],a[8:11],v[120:123]
W a157,v157
AF v26,v18,v26
M v[120:123],a[108:111],a[12:15],v[120:123]
R a[72:75],v16,2048
R a[76:79],v16,3072
M v[120:123],a[112:115],a[16:19],v[120:123]
W a158,v158
C v56,v18,v19
M v[120:123],a[116:119],a[20:23],v[120:123]
E v21,v83
M v[120:123],a[120:123],a[24:27],v[120:123]
R a[80:83],v16,4096
R a[84:87],v16,5120
M v[120:123],a[124:127],a[28:31],v[120:123]
W a159,v159
AF v26,v19,v26
M v[124:127],a[124:127],a[60:63],0
E v22,v88
M v[124:127],a[120:123],a[56:59],v[124:127]
R a[88:91],v16,6144
R a[92:95],v16,7168
M v[124:127],a[116:119],a[52:55],v[124:127]
E v23,v89
M v[124:127],a[112:115],a[48:51],v[124:127]
E v24,v90
M v[124:127],a[108:111],a[44:47],v[124:127]
E v25,v91
M v[124:127],a[104:107],a[40:43],v[124:127]
E v18,v84
M v[124:127],a[100:103],a[36:39],v[124:127]
s_waitcnt lgkmcnt(0)
E v19,v85
M v[124:127],a[96:99],a[32:35],v[124:127]
AF v26,v20,v26
C v57,v20,v21
AF v26,v21,v26
AF v26,v22,v26
C v58,v22,v23
AF v26,v23,v26
AF v26,v24,v26
C v59,v24,v25
AF v26,v25,v26
E v20,v86
E v21,v87
AF v27,v18,v27
C v60,v18,v19
AF v27,v19,v27
E v22,v92
E v23,v93
AF v27,v20,v27
C v61,v20,v21
AF v27,v21,v27
E v24,v94
E v25,v95
AF v27,v22,v27
C v62,v22,v23
AF v27,v23,v27
AF v27,v24,v27
C v63,v24,v25
AF v27,v25,v27
v_max_f32 v10, v26, v27
v_min_f32 v11, v26, v27
v_cmp_lt_f32 vcc, s31, v10
v_cmp_gt_f32 s[64:65], s24, v11
s_nop 0
s_or_b64 vcc, vcc, s[64:65]
s_cbranch_vccnz L_stv1
L_rtv1:
M v[128:131],a[64:67],v[40:43],0
R a[96:99],v16,8192
R a[100:103],v16,9216
M v[128:131],a[68:71],v[56:59],v[128:131]
SA m0,s28,65536
W a160,v192
W a161,v193
M v[132:135],a[68:71],v[60:63],0
buffer_load_dwordx4 v3, s[8:11], s21 offen offset:0 sc1 lds
M v[132:135],a[64:67],v[44:47],v[132:135]
R a[104:107],v16,10240
R a[108:111],v16,11264
M v[136:139],a[72:75],v[40:43],0
W a162,v194
W a163,v195
M v[136:139],a[76:79],v[56:59],v[136:139]
W a164,v196
W a165,v197
M v[140:143],a[76:79],v[60:63],0
R a[112:115],v16,12288
R a[116:119],v16,13312
M v[140:143],a[72:75],v[44:47],v[140:143]
buffer_load_dwordx4 v3, s[8:11], s21 offen offset:1024 sc1 lds
M v[144:147],a[80:83],v[40:43],0
W a166,v198
W a167,v199
M v[144:147],a[84:87],v[56:59],v[144:147]
R a[120:123],v16,14336
R a[124:127],v16,15360
M v[148:151],a[84:87],v[60:63],0
W a168,v200
W a169,v201
M v[148:151],a[80:83],v[44:47],v[148:151]
buffer_load_dwordx4 v3, s[8:11], s21 offen offset:2048 sc1 lds
M v[152:155],a[88:91],v[40:43],0
W a170,v202
W a171,v203
M v[152:155],a[92:95],v[56:59],v[152:155]
W a172,v204
W a173,v205
M v[156:159],a[92:95],v[60:63],0
W a174,v206
W a175,v207
M v[156:159],a[88:91],v[44:47],v[156:159]
s_waitcnt lgkmcnt(0)
buffer_load_dwordx4 v3, s[8:11], s21 offen offset:3072 sc1 lds
M v[160:163],a[96:99],v[40:43],0
SA m0,s28,69632
R a[64:67],v16,16384
R a[68:71],v16,17408
M v[160:163],a[100:103],v[56:59],v[160:163]
W a176,v208
W a177,v209
M v[164:167],a[100:103],v[60:63],0
W a178,v210
W a179,v211
M v[164:167],a[96:99],v[44:47],v[164:167]
R a[72:75],v16,18432
R a[76:79],v16,19456
M v[168:171],a[104:107],v[40:43],0
buffer_load_dwordx4 v4, s[8:11], s21 offen offset:0 sc1 lds
M v[168:171],a[108:111],v[56:59],v[168:171]
W a180,v212
W a181,v213
M v[172:175],a[108:111],v[60:63],0
R a[80:83],v16,20480
R a[84:87],v16,21504
M v[172:175],a[104:107],v[44:47],v[172:175]
buffer_load_dwordx4 v4, s[8:11], s21 offen offset:1024 sc1 lds
M v[176:179],a[112:115],v[40:43],0
W a182,v214
W a183,v215
M v[176:179],a[116:119],v[56:59],v[176:179]
R a[88:91],v16,22528
R a[92:95],v16,23552
M v[180:183],a[116:119],v[60:63],0
buffer_load_dwordx4 v4, s[8:11], s21 offen offset:2048 sc1 lds
M v[180:183],a[112:115],v[44:47],v[180:183]
W a184,v216
W a185,v217
M v[184:187],a[120:123],v[40:43],0
W a186,v218
W a187,v219
W a188,v220
W a189,v221
W a190,v222
W a191,v223
M v[184:187],a[124:127],v[56:59],v[184:187]
E v18,v96
M v[188:191],a[124:127],v[60:63],0
buffer_load_dwordx4 v4, s[8:11], s21 offen offset:3072 sc1 lds
M v[188:191],a[120:123],v[44:47],v[188:191]
s_waitcnt lgkmcnt(0)
v_min_u32 v17, 1, v7
v_lshlrev_b32 v17, 29, v17
M v[192:195],a[64:67],v[40:43],0
SA s21,s21,32768
R a[96:99],v16,24576
R a[100:103],v16,25600
M v[192:195],a[68:71],v[56:59],v[192:195]
s_sub_u32 s22, s22, 1
v_mov_b32 v15, 1
AF v30,v26,v30
M v[196:199],a[68:71],v[60:63],0
s_cselect_b32 s21, s23, s21
E v19,v97
M v[196:199],a[64:67],v[44:47],v[196:199]
SA s84,s47,16
R a[104:107],v16,26624
R a[108:111],v16,27648
M v[200:203],a[72:75],v[40:43],0
SA s3,s93,262144
buffer_store_dwordx4 a[128:131], v7, s[8:11], s3 offen offset:0 sc1
M v[200:203],a[76:79],v[56:59],v[200:203]
E v20,v98
M v[204:207],a[76:79],v[60:63],0
R a[112:115],v16,28672
R a[116:119],v16,29696
M v[204:207],a[72:75],v[44:47],v[204:207]
E v21,v99
M v[208:211],a[80:83],v[40:43],0
E v22,v104
M v[208:211],a[84:87],v[56:59],v[208:211]
R a[120:123],v16,30720
R a[124:127],v16,31744
M v[212:215],a[84:87],v[60:63],0
buffer_store_dwordx4 a[132:135], v7, s[8:11], s3 offen offset:2048 sc1
M v[212:215],a[80:83],v[44:47],v[212:215]
E v23,v105
M v[216:219],a[88:91],v[40:43],0
AF v31,v27,v31
AF v28,v18,v19
M v[216:219],a[92:95],v[56:59],v[216:219]
E v24,v106
M v[220:223],a[92:95],v[60:63],0
s_waitcnt vmcnt(10) lgkmcnt(0)
E v25,v107
M v[220:223],a[88:91],v[44:47],v[220:223]
s_barrier
M v[224:227],a[96:99],v[40:43],0
R a[64:67],v2,32768
R a[68:71],v2,33792
M v[224:227],a[100:103],v[56:59],v[224:227]
buffer_store_dword v15, v17, s[8:11], s84 offen sc1
M v[228:231],a[100:103],v[60:63],0
SA s3,s93,266240
C v48,v18,v19
AF v28,v20,v28
M v[228:231],a[96:99],v[44:47],v[228:231]
R a[72:75],v2,34816
R a[76:79],v2,35840
M v[232:235],a[104:107],v[40:43],0
buffer_store_dwordx4 a[136:139], v7, s[8:11], s3 offen offset:0 sc1
M v[232:235],a[108:111],v[56:59],v[232:235]
E v18,v100
M v[236:239],a[108:111],v[60:63],0
R a[80:83],v2,36864
R a[84:87],v2,37888
M v[236:239],a[104:107],v[44:47],v[236:239]
E v19,v101
M v[240:243],a[112:115],v[40:43],0
C v49,v20,v21
AF v28,v21,v28
M v[240:243],a[116:119],v[56:59],v[240:243]
R a[88:91],v2,38912
R a[92:95],v2,39936
M v[244:247],a[116:119],v[60:63],0
E v20,v102
M v[244:247],a[112:115],v[44:47],v[244:247]
E v21,v103
M v[248:251],a[120:123],v[40:43],0
AF v28,v22,v28
C v50,v22,v23
M v[248:251],a[124:127],v[56:59],v[248:251]
AF v28,v23,v28
AF v28,v24,v28
M v[252:255],a[124:127],v[60:63],0
s_waitcnt lgkmcnt(0)
E v22,v108
M v[252:255],a[120:123],v[44:47],v[252:255]
E v23,v109
C v51,v24,v25
AF v28,v25,v28
AF v29,v18,v19
C v52,v18,v19
AF v29,v20,v29
C v53,v20,v21
AF v29,v21,v29
E v24,v110
E v25,v111
AF v29,v22,v29
C v54,v22,v23
AF v29,v23,v29
AF v29,v24,v29
C v55,v24,v25
AF v29,v25,v29
M v[64:67],a[64:67],a[0:3],v[32:35]
R a[96:99],v2,40960
R a[100:103],v2,41984
M v[64:67],a[68:71],a[4:7],v[64:67]
SA m0,s28,0
E v18,v112
M v[64:67],a[72:75],a[8:11],v[64:67]
buffer_load_dwordx4 v3, s[8:11], s26 offen offset:0 sc1 lds
M v[64:67],a[76:79],a[12:15],v[64:67]
R a[104:107],v2,43008
R a[108:111],v2,44032
M v[64:67],a[80:83],a[16:19],v[64:67]
E v19,v113
M v[64:67],a[84:87],a[20:23],v[64:67]
AF v28,v18,v28
C v56,v18,v19
M v[64:67],a[88:91],a[24:27],v[64:67]
R a[112:115],v2,45056
R a[116:119],v2,46080
M v[64:67],a[92:95],a[28:31],v[64:67]
buffer_load_dwordx4 v3, s[8:11], s26 offen offset:1024 sc1 lds
M v[68:71],a[92:95],a[60:63],v[36:39]
E v20,v114
M v[68:71],a[88:91],a[56:59],v[68:71]
R a[120:123],v2,47104
R a[124:127],v2,48128
M v[68:71],a[84:87],a[52:55],v[68:71]
E v21,v115
M v[68:71],a[80:83],a[48:51],v[68:71]
buffer_load_dwordx4 v3, s[8:11], s26 offen offset:2048 sc1 lds
M v[68:71],a[76:79],a[44:47],v[68:71]
AF v28,v19,v28
AF v28,v20,v28
M v[68:71],a[72:75],a[40:43],v[68:71]
C v57,v20,v21
AF v28,v21,v28
M v[68:71],a[68:71],a[36:39],v[68:71]
E v22,v120
M v[68:71],a[64:67],a[32:35],v[68:71]
s_waitcnt lgkmcnt(0)
buffer_load_dwordx4 v3, s[8:11], s26 offen offset:3072 sc1 lds
M v[72:75],a[96:99],a[0:3],v[32:35]
SA m0,s28,4096
R a[64:67],v2,49152
R a[68:71],v2,50176
M v[72:75],a[100:103],a[4:7],v[72:75]
E v23,v121
M v[72:75],a[104:107],a[8:11],v[72:75]
AF v28,v22,v28
C v58,v22,v23
M v[72:75],a[108:111],a[12:15],v[72:75]
R a[72:75],v2,51200
R a[76:79],v2,52224
M v[72:75],a[112:115],a[16:19],v[72:75]
buffer_load_dwordx4 v4, s[8:11], s26 offen offset:0 sc1 lds
M v[72:75],a[116:119],a[20:23],v[72:75]
E v24,v122
M v[72:75],a[120:123],a[24:27],v[72:75]
R a[80:83],v2,53248
R a[84:87],v2,54272
M v[72:75],a[124:127],a[28:31],v[72:75]
buffer_load_dwordx4 v4, s[8:11], s26 offen offset:1024 sc1 lds
M v[76:79],a[124:127],a[60:63],v[36:39]
E v25,v123
M v[76:79],a[120:123],a[56:59],v[76:79]
R a[88:91],v2,55296
R a[92:95],v2,56320
M v[76:79],a[116:119],a[52:55],v[76:79]
buffer_load_dwordx4 v4, s[8:11], s26 offen offset:2048 sc1 lds
M v[76:79],a[112:115],a[48:51],v[76:79]
AF v28,v23,v28
AF v28,v24,v28
M v[76:79],a[108:111],a[44:47],v[76:79]
E v18,v116
M v[76:79],a[104:107],a[40:43],v[76:79]
C v59,v24,v25
AF v28,v25,v28
M v[76:79],a[100:103],a[36:39],v[76:79]
buffer_load_dwordx4 v4, s[8:11], s26 offen offset:3072 sc1 lds
M v[76:79],a[96:99],a[32:35],v[76:79]
s_waitcnt lgkmcnt(0)
E v19,v117
M v[80:83],a[64:67],a[0:3],v[32:35]
SA s26,s26,32768
R a[96:99],v2,57344
R a[100:103],v2,58368
M v[80:83],a[68:71],a[4:7],v[80:83]
AF v29,v18,v29
C v60,v18,v19
M v[80:83],a[72:75],a[8:11],v[80:83]
SA s3,s93,266240
buffer_store_dwordx4 a[140:143], v7, s[8:11], s3 offen offset:2048 sc1
M v[80:83],a[76:79],a[12:15],v[80:83]
R a[104:107],v2,59392
R a[108:111],v2,60416
M v[80:83],a[80:83],a[16:19],v[80:83]
E v20,v118
M v[80:83],a[84:87],a[20:23],v[80:83]
AF v29,v19,v29
M v[80:83],a[88:91],a[24:27],v[80:83]
R a[112:115],v2,61440
R a[116:119],v2,62464
M v[80:83],a[92:95],a[28:31],v[80:83]
E v21,v119
M v[84:87],a[92:95],a[60:63],v[36:39]
AF v29,v20,v29
C v61,v20,v21
M v[84:87],a[88:91],a[56:59],v[84:87]
SA s3,s93,270336
R a[120:123],v2,63488
R a[124:127],v2,64512
M v[84:87],a[84:87],a[52:55],v[84:87]
buffer_store_dwordx4 a[144:147], v7, s[8:11], s3 offen offset:0 sc1
M v[84:87],a[80:83],a[48:51],v[84:87]
E v22,v124
M v[84:87],a[76:79],a[44:47],v[84:87]
AF v29,v21,v29
M v[84:87],a[72:75],a[40:43],v[84:87]
E v23,v125
M v[84:87],a[68:71],a[36:39],v[84:87]
s_waitcnt lgkmcnt(0)
AF v29,v22,v29
C v62,v22,v23
M v[84:87],a[64:67],a[32:35],v[84:87]
s_barrier
M v[88:91],a[96:99],a[0:3],v[32:35]
R a[64:67],v7,32768
R a[68:71],v7,33792
M v[88:91],a[100:103],a[4:7],v[88:91]
E v24,v126
M v[88:91],a[104:107],a[8:11],v[88:91]
AF v29,v23,v29
M v[88:91],a[108:111],a[12:15],v[88:91]
R a[72:75],v7,34816
R a[76:79],v7,35840
M v[88:91],a[112:115],a[16:19],v[88:91]
buffer_store_dwordx4 a[148:151], v7, s[8:11], s3 offen offset:2048 sc1
M v[88:91],a[116:119],a[20:23],v[88:91]
E v25,v127
M v[88:91],a[120:123],a[24:27],v[88:91]
R a[80:83],v7,36864
R a[84:87],v7,37888
M v[88:91],a[124:127],a[28:31],v[88:91]
AF v29,v24,v29
C v63,v24,v25
M v[92:95],a[124:127],a[60:63],v[36:39]
AF v29,v25,v29
M v[92:95],a[120:123],a[56:59],v[92:95]
R a[88:91],v7,38912
R a[92:95],v7,39936
M v[92:95],a[116:119],a[52:55],v[92:95]
v_max_f32 v10, v28, v29
M v[92:95],a[112:115],a[48:51],v[92:95]
v_cmp_lt_f32 vcc, s31, v10
M v[92:95],a[108:111],a[44:47],v[92:95]
M v[92:95],a[104:107],a[40:43],v[92:95]
M v[92:95],a[100:103],a[36:39],v[92:95]
s_waitcnt lgkmcnt(0)
M v[92:95],a[96:99],a[32:35],v[92:95]
s_cbranch_vccnz L_stv2
L_rtv2:
M v[128:131],a[64:67],v[48:51],v[128:131]
R a[96:99],v7,40960
R a[100:103],v7,41984
M v[128:131],a[68:71],v[56:59],v[128:131]
SA m0,s28,98304
E v18,v64
M v[132:135],a[68:71],v[60:63],v[132:135]
buffer_load_dwordx4 v3, s[8:11], s21 offen offset:0 sc1 lds
M v[132:135],a[64:67],v[52:55],v[132:135]
R a[104:107],v7,43008
R a[108:111],v7,44032
M v[136:139],a[72:75],v[48:51],v[136:139]
E v19,v65
M v[136:139],a[76:79],v[56:59],v[136:139]
AF v30,v28,v30
AF v31,v29,v31
M v[140:143],a[76:79],v[60:63],v[140:143]
R a[112:115],v7,45056
R a[116:119],v7,46080
M v[140:143],a[72:75],v[52:55],v[140:143]
buffer_load_dwordx4 v3, s[8:11], s21 offen offset:1024 sc1 lds
M v[144:147],a[80:83],v[48:51],v[144:147]
E v20,v66
M v[144:147],a[84:87],v[56:59],v[144:147]
R a[120:123],v7,47104
R a[124:127],v7,48128
M v[148:151],a[84:87],v[60:63],v[148:151]
AF v26,v18,v19
C v40,v18,v19
M v[148:151],a[80:83],v[52:55],v[148:151]
buffer_load_dwordx4 v3, s[8:11], s21 offen offset:2048 sc1 lds
M v[152:155],a[88:91],v[48:51],v[152:155]
E v21,v67
M v[152:155],a[92:95],v[56:59],v[152:155]
AF v26,v20,v26
C v41,v20,v21
M v[156:159],a[92:95],v[60:63],v[156:159]
AF v26,v21,v26
M v[156:159],a[88:91],v[52:55],v[156:159]
s_waitcnt lgkmcnt(0)
buffer_load_dwordx4 v3, s[8:11], s21 offen offset:3072 sc1 lds
M v[160:163],a[96:99],v[48:51],v[160:163]
SA m0,s28,102400
R a[64:67],v7,49152
R a[68:71],v7,50176
M v[160:163],a[100:103],v[56:59],v[160:163]
E v22,v72
M v[164:167],a[100:103],v[60:63],v[164:167]
E v23,v73
M v[164:167],a[96:99],v[52:55],v[164:167]
R a[72:75],v7,51200
R a[76:79],v7,52224
M v[168:171],a[104:107],v[48:51],v[168:171]
buffer_load_dwordx4 v4, s[8:11], s21 offen offset:0 sc1 lds
M v[168:171],a[108:111],v[56:59],v[168:171]
AF v26,v22,v26
C v42,v22,v23
M v[172:175],a[108:111],v[60:63],v[172:175]
R a[80:83],v7,53248
R a[84:87],v7,54272
M v[172:175],a[104:107],v[52:55],v[172:175]
buffer_load_dwordx4 v4, s[8:11], s21 offen offset:1024 sc1 lds
M v[176:179],a[112:115],v[48:51],v[176:179]
E v24,v74
M v[176:179],a[116:119],v[56:59],v[176:179]
R a[88:91],v7,55296
R a[92:95],v7,56320
M v[180:183],a[116:119],v[60:63],v[180:183]
buffer_load_dwordx4 v4, s[8:11], s21 offen offset:2048 sc1 lds
M v[180:183],a[112:115],v[52:55],v[180:183]
E v25,v75
M v[184:187],a[120:123],v[48:51],v[184:187]
AF v26,v23,v26
AF v26,v24,v26
M v[184:187],a[124:127],v[56:59],v[184:187]
C v43,v24,v25
AF v26,v25,v26
M v[188:191],a[124:127],v[60:63],v[188:191]
buffer_load_dwordx4 v4, s[8:11], s21 offen offset:3072 sc1 lds
M v[188:191],a[120:123],v[52:55],v[188:191]
s_waitcnt lgkmcnt(0)
E v18,v68
M v[192:195],a[64:67],v[48:51],v[192:195]
SA s21,s21,32768
R a[96:99],v7,57344
R a[100:103],v7,58368
M v[192:195],a[68:71],v[56:59],v[192:195]
s_sub_u32 s22, s22, 1
E v19,v69
M v[196:199],a[68:71],v[60:63],v[196:199]
s_cselect_b32 s21, s23, s21
AF v27,v18,v19
C v44,v18,v19
M v[196:199],a[64:67],v[52:55],v[196:199]
SA s3,s93,274432
R a[104:107],v7,59392
R a[108:111],v7,60416
M v[200:203],a[72:75],v[48:51],v[200:203]
buffer_store_dwordx4 a[152:155], v7, s[8:11], s3 offen offset:0 sc1
M v[200:203],a[76:79],v[56:59],v[200:203]
E v20,v70
M v[204:207],a[76:79],v[60:63],v[204:207]
R a[112:115],v7,61440
R a[116:119],v7,62464
M v[204:207],a[72:75],v[52:55],v[204:207]
M v[208:211],a[80:83],v[48:51],v[208:211]
M v[208:211],a[84:87],v[56:59],v[208:211]
R a[120:123],v7,63488
R a[124:127],v7,64512
M v[212:215],a[84:87],v[60:63],v[212:215]
buffer_store_dwordx4 a[156:159], v7, s[8:11], s3 offen offset:2048 sc1
M v[212:215],a[80:83],v[52:55],v[212:215]
E v21,v71
M v[216:219],a[88:91],v[48:51],v[216:219]
AF v27,v20,v27
C v45,v20,v21
M v[216:219],a[92:95],v[56:59],v[216:219]
E v22,v76
M v[220:223],a[92:95],v[60:63],v[220:223]
s_waitcnt vmcnt(25) lgkmcnt(0)
AF v27,v21,v27
M v[220:223],a[88:91],v[52:55],v[220:223]
s_barrier
M v[224:227],a[96:99],v[48:51],v[224:227]
R a[64:67],v2,0
R a[68:71],v2,1024
M v[224:227],a[100:103],v[56:59],v[224:227]
E v23,v77
M v[228:231],a[100:103],v[60:63],v[228:231]
SA s3,s93,786432
AF v27,v22,v27
C v46,v22,v23
M v[228:231],a[96:99],v[52:55],v[228:231]
R a[72:75],v2,2048
R a[76:79],v2,3072
M v[232:235],a[104:107],v[48:51],v[232:235]
buffer_store_dwordx4 a[160:163], v7, s[8:11], s3 offen offset:0 sc1
M v[232:235],a[108:111],v[56:59],v[232:235]
E v24,v78
M v[236:239],a[108:111],v[60:63],v[236:239]
R a[80:83],v2,4096
R a[84:87],v2,5120
M v[236:239],a[104:107],v[52:55],v[236:239]
AF v27,v23,v27
M v[240:243],a[112:115],v[48:51],v[240:243]
E v25,v79
M v[240:243],a[116:119],v[56:59],v[240:243]
R a[88:91],v2,6144
R a[92:95],v2,7168
M v[244:247],a[116:119],v[60:63],v[244:247]
AF v27,v24,v27
C v47,v24,v25
M v[244:247],a[112:115],v[52:55],v[244:247]
AF v27,v25,v27
M v[248:251],a[120:123],v[48:51],v[248:251]
M v[248:251],a[124:127],v[56:59],v[248:251]
M v[252:255],a[124:127],v[60:63],v[252:255]
s_waitcnt lgkmcnt(0)
M v[252:255],a[120:123],v[52:55],v[252:255]
M v[96:99],a[64:67],a[0:3],v[32:35]
R a[96:99],v2,8192
R a[100:103],v2,9216
M v[96:99],a[68:71],a[4:7],v[96:99]
SA m0,s28,32768
E v18,v80
M v[96:99],a[72:75],a[8:11],v[96:99]
buffer_load_dwordx4 v3, s[8:11], s26 offen offset:0 sc1 lds
M v[96:99],a[76:79],a[12:15],v[96:99]
R a[104:107],v2,10240
R a[108:111],v2,11264
M v[96:99],a[80:83],a[16:19],v[96:99]
E v19,v81
M v[96:99],a[84:87],a[20:23],v[96:99]
AF v26,v18,v26
C v56,v18,v19
M v[96:99],a[88:91],a[24:27],v[96:99]
R a[112:115],v2,12288
R a[116:119],v2,13312
M v[96:99],a[92:95],a[28:31],v[96:99]
buffer_load_dwordx4 v3, s[8:11], s26 offen offset:1024 sc1 lds
M v[100:103],a[92:95],a[60:63],v[36:39]
E v20,v82
M v[100:103],a[88:91],a[56:59],v[100:103]
R a[120:123],v2,14336
R a[124:127],v2,15360
M v[100:103],a[84:87],a[52:55],v[100:103]
E v21,v83
M v[100:103],a[80:83],a[48:51],v[100:103]
buffer_load_dwordx4 v3, s[8:11], s26 offen offset:2048 sc1 lds
M v[100:103],a[76:79],a[44:47],v[100:103]
AF v26,v19,v26
AF v26,v20,v26
M v[100:103],a[72:75],a[40:43],v[100:103]
C v57,v20,v21
AF v26,v21,v26
M v[100:103],a[68:71],a[36:39],v[100:103]
E v22,v88
M v[100:103],a[64:67],a[32:35],v[100:103]
s_waitcnt lgkmcnt(0)
buffer_load_dwordx4 v3, s[8:11], s26 offen offset:3072 sc1 lds
M v[104:107],a[96:99],a[0:3],v[32:35]
SA m0,s28,36864
R a[64:67],v2,16384
R a[68:71],v2,17408
M v[104:107],a[100:103],a[4:7],v[104:107]
E v23,v89
M v[104:107],a[104:107],a[8:11],v[104:107]
AF v26,v22,v26
C v58,v22,v23
M v[104:107],a[108:111],a[12:15],v[104:107]
R a[72:75],v2,18432
R a[76:79],v2,19456
M v[104:107],a[112:115],a[16:19],v[104:107]
buffer_load_dwordx4 v4, s[8:11], s26 offen offset:0 sc1 lds
M v[104:107],a[116:119],a[20:23],v[104:107]
E v24,v90
M v[104:107],a[120:123],a[24:27],v[104:107]
R a[80:83],v2,20480
R a[84:87],v2,21504
M v[104:107],a[124:127],a[28:31],v[104:107]
buffer_load_dwordx4 v4, s[8:11], s26 offen offset:1024 sc1 lds
M v[108:111],a[124:127],a[60:63],v[36:39]
E v25,v91
M v[108:111],a[120:123],a[56:59],v[108:111]
R a[88:91],v2,22528
R a[92:95],v2,23552
M v[108:111],a[116:119],a[52:55],v[108:111]
buffer_load_dwordx4 v4, s[8:11], s26 offen offset:2048 sc1 lds
M v[108:111],a[112:115],a[48:51],v[108:111]
AF v26,v23,v26
AF v26,v24,v26
M v[108:111],a[108:111],a[44:47],v[108:111]
E v18,v84
M v[108:111],a[104:107],a[40:43],v[108:111]
C v59,v24,v25
AF v26,v25,v26
M v[108:111],a[100:103],a[36:39],v[108:111]
buffer_load_dwordx4 v4, s[8:11], s26 offen offset:3072 sc1 lds
M v[108:111],a[96:99],a[32:35],v[108:111]
s_waitcnt lgkmcnt(0)
E v19,v85
M v[112:115],a[64:67],a[0:3],v[32:35]
SA s26,s26,32768
R a[96:99],v2,24576
R a[100:103],v2,25600
M v[112:115],a[68:71],a[4:7],v[112:115]
AF v27,v18,v27
C v60,v18,v19
M v[112:115],a[72:75],a[8:11],v[112:115]
SA s3,s93,786432
buffer_store_dwordx4 a[164:167], v7, s[8:11], s3 offen offset:2048 sc1
M v[112:115],a[76:79],a[12:15],v[112:115]
R a[104:107],v2,26624
R a[108:111],v2,27648
M v[112:115],a[80:83],a[16:19],v[112:115]
E v20,v86
M v[112:115],a[84:87],a[20:23],v[112:115]
AF v27,v19,v27
M v[112:115],a[88:91],a[24:27],v[112:115]
R a[112:115],v2,28672
R a[116:119],v2,29696
M v[112:115],a[92:95],a[28:31],v[112:115]
SA s3,s93,790528
E v21,v87
M v[116:119],a[92:95],a[60:63],v[36:39]
buffer_store_dwordx4 a[168:171], v7, s[8:11], s3 offen offset:0 sc1
M v[116:119],a[88:91],a[56:59],v[116:119]
R a[120:123],v2,30720
R a[124:127],v2,31744
M v[116:119],a[84:87],a[52:55],v[116:119]
E v22,v92
M v[116:119],a[80:83],a[48:51],v[116:119]
AF v27,v20,v27
C v61,v20,v21
M v[116:119],a[76:79],a[44:47],v[116:119]
AF v27,v21,v27
M v[116:119],a[72:75],a[40:43],v[116:119]
E v23,v93
M v[116:119],a[68:71],a[36:39],v[116:119]
s_waitcnt vmcnt(24) lgkmcnt(0)
AF v27,v22,v27
C v62,v22,v23
M v[116:119],a[64:67],a[32:35],v[116:119]
s_barrier
M v[120:123],a[96:99],a[0:3],v[32:35]
R a[64:67],v7,0
R a[68:71],v7,1024
M v[120:123],a[100:103],a[4:7],v[120:123]
buffer_store_dwordx4 a[172:175], v7, s[8:11], s3 offen offset:2048 sc1
M v[120:123],a[104:107],a[8:11],v[120:123]
E v24,v94
M v[120:123],a[108:111],a[12:15],v[120:123]
R a[72:75],v7,2048
R a[76:79],v7,3072
M v[120:123],a[112:115],a[16:19],v[120:123]
SA s3,s93,794624
E v25,v95
M v[120:123],a[116:119],a[20:23],v[120:123]
buffer_store_dwordx4 a[176:179], v7, s[8:11], s3 offen offset:0 sc1
M v[120:123],a[120:123],a[24:27],v[120:123]
R a[80:83],v7,4096
R a[84:87],v7,5120
M v[120:123],a[124:127],a[28:31],v[120:123]
AF v27,v23,v27
AF v27,v24,v27
M v[124:127],a[124:127],a[60:63],v[36:39]
C v63,v24,v25
AF v27,v25,v27
M v[124:127],a[120:123],a[56:59],v[124:127]
R a[88:91],v7,6144
R a[92:95],v7,7168
M v[124:127],a[116:119],a[52:55],v[124:127]
v_max_f32 v10, v26, v27
M v[124:127],a[112:115],a[48:51],v[124:127]
v_cmp_lt_f32 vcc, s31, v10
M v[124:127],a[108:111],a[44:47],v[124:127]
M v[124:127],a[104:107],a[40:43],v[124:127]
M v[124:127],a[100:103],a[36:39],v[124:127]
s_waitcnt lgkmcnt(0)
M v[124:127],a[96:99],a[32:35],v[124:127]
s_cbranch_vccnz L_stv3
L_rtv3:
M v[128:131],a[64:67],v[40:43],v[128:131]
R a[96:99],v7,8192
R a[100:103],v7,9216
M v[128:131],a[68:71],v[56:59],v[128:131]
SA m0,s28,65536
E v18,v96
M v[132:135],a[68:71],v[60:63],v[132:135]
buffer_load_dwordx4 v3, s[8:11], s21 offen offset:0 sc1 lds
M v[132:135],a[64:67],v[44:47],v[132:135]
R a[104:107],v7,10240
R a[108:111],v7,11264
M v[136:139],a[72:75],v[40:43],v[136:139]
E v19,v97
M v[136:139],a[76:79],v[56:59],v[136:139]
AF v30,v26,v30
AF v31,v27,v31
M v[140:143],a[76:79],v[60:63],v[140:143]
R a[112:115],v7,12288
R a[116:119],v7,13312
M v[140:143],a[72:75],v[44:47],v[140:143]
buffer_load_dwordx4 v3, s[8:11], s21 offen offset:1024 sc1 lds
M v[144:147],a[80:83],v[40:43],v[144:147]
E v20,v98
M v[144:147],a[84:87],v[56:59],v[144:147]
R a[120:123],v7,14336
R a[124:127],v7,15360
M v[148:151],a[84:87],v[60:63],v[148:151]
AF v28,v18,v19
C v48,v18,v19
M v[148:151],a[80:83],v[44:47],v[148:151]
buffer_load_dwordx4 v3, s[8:11], s21 offen offset:2048 sc1 lds
M v[152:155],a[88:91],v[40:43],v[152:155]
E v21,v99
M v[152:155],a[92:95],v[56:59],v[152:155]
AF v28,v20,v28
C v49,v20,v21
M v[156:159],a[92:95],v[60:63],v[156:159]
AF v28,v21,v28
M v[156:159],a[88:91],v[44:47],v[156:159]
s_waitcnt lgkmcnt(0)
buffer_load_dwordx4 v3, s[8:11], s21 offen offset:3072 sc1 lds
M v[160:163],a[96:99],v[40:43],v[160:163]
SA m0,s28,69632
R a[64:67],v7,16384
R a[68:71],v7,17408
M v[160:163],a[100:103],v[56:59],v[160:163]
E v22,v104
M v[164:167],a[100:103],v[60:63],v[164:167]
E v23,v105
M v[164:167],a[96:99],v[44:47],v[164:167]
R a[72:75],v7,18432
R a[76:79],v7,19456
M v[168:171],a[104:107],v[40:43],v[168:171]
buffer_load_dwordx4 v4, s[8:11], s21 offen offset:0 sc1 lds
M v[168:171],a[108:111],v[56:59],v[168:171]
AF v28,v22,v28
C v50,v22,v23
M v[172:175],a[108:111],v[60:63],v[172:175]
R a[80:83],v7,20480
R a[84:87],v7,21504
M v[172:175],a[104:107],v[44:47],v[172:175]
buffer_load_dwordx4 v4, s[8:11], s21 offen offset:1024 sc1 lds
M v[176:179],a[112:115],v[40:43],v[176:179]
E v24,v106
M v[176:179],a[116:119],v[56:59],v[176:179]
R a[88:91],v7,22528
R a[92:95],v7,23552
M v[180:183],a[116:119],v[60:63],v[180:183]
buffer_load_dwordx4 v4, s[8:11], s21 offen offset:2048 sc1 lds
M v[180:183],a[112:115],v[44:47],v[180:183]
E v25,v107
M v[184:187],a[120:123],v[40:43],v[184:187]
AF v28,v23,v28
AF v28,v24,v28
M v[184:187],a[124:127],v[56:59],v[184:187]
C v51,v24,v25
AF v28,v25,v28
M v[188:191],a[124:127],v[60:63],v[188:191]
buffer_load_dwordx4 v4, s[8:11], s21 offen offset:3072 sc1 lds
M v[188:191],a[120:123],v[44:47],v[188:191]
s_waitcnt lgkmcnt(0)
E v18,v100
M v[192:195],a[64:67],v[40:43],v[192:195]
SA s21,s21,32768
R a[96:99],v7,24576
R a[100:103],v7,25600
M v[192:195],a[68:71],v[56:59],v[192:195]
s_sub_u32 s22, s22, 1
E v19,v101
M v[196:199],a[68:71],v[60:63],v[196:199]
s_cselect_b32 s21, s23, s21
AF v29,v18,v19
C v52,v18,v19
M v[196:199],a[64:67],v[44:47],v[196:199]
SA s3,s93,794624
R a[104:107],v7,26624
R a[108:111],v7,27648
M v[200:203],a[72:75],v[40:43],v[200:203]
buffer_store_dwordx4 a[180:183], v7, s[8:11], s3 offen offset:2048 sc1
M v[200:203],a[76:79],v[56:59],v[200:203]
E v20,v102
M v[204:207],a[76:79],v[60:63],v[204:207]
R a[112:115],v7,28672
R a[116:119],v7,29696
M v[204:207],a[72:75],v[44:47],v[204:207]
M v[208:211],a[80:83],v[40:43],v[208:211]
M v[208:211],a[84:87],v[56:59],v[208:211]
SA s3,s93,798720
R a[120:123],v7,30720
R a[124:127],v7,31744
M v[212:215],a[84:87],v[60:63],v[212:215]
buffer_store_dwordx4 a[184:187], v7, s[8:11], s3 offen offset:0 sc1
M v[212:215],a[80:83],v[44:47],v[212:215]
E v21,v103
M v[216:219],a[88:91],v[40:43],v[216:219]
AF v29,v20,v29
C v53,v20,v21
M v[216:219],a[92:95],v[56:59],v[216:219]
E v22,v108
M v[220:223],a[92:95],v[60:63],v[220:223]
s_waitcnt vmcnt(25) lgkmcnt(0)
AF v29,v21,v29
M v[220:223],a[88:91],v[44:47],v[220:223]
s_barrier
M v[224:227],a[96:99],v[40:43],v[224:227]
R a[64:67],v2,32768
R a[68:71],v2,33792
M v[224:227],a[100:103],v[56:59],v[224:227]
E v23,v109
M v[228:231],a[100:103],v[60:63],v[228:231]
AF v29,v22,v29
C v54,v22,v23
M v[228:231],a[96:99],v[44:47],v[228:231]
R a[72:75],v2,34816
R a[76:79],v2,35840
M v[232:235],a[104:107],v[40:43],v[232:235]
buffer_store_dwordx4 a[188:191], v7, s[8:11], s3 offen offset:2048 sc1
M v[232:235],a[108:111],v[56:59],v[232:235]
E v24,v110
M v[236:239],a[108:111],v[60:63],v[236:239]
R a[80:83],v2,36864
R a[84:87],v2,37888
M v[236:239],a[104:107],v[44:47],v[236:239]
AF v29,v23,v29
M v[240:243],a[112:115],v[40:43],v[240:243]
E v25,v111
M v[240:243],a[116:119],v[56:59],v[240:243]
R a[88:91],v2,38912
R a[92:95],v2,39936
M v[244:247],a[116:119],v[60:63],v[244:247]
AF v29,v24,v29
C v55,v24,v25
M v[244:247],a[112:115],v[44:47],v[244:247]
AF v29,v25,v29
M v[248:251],a[120:123],v[40:43],v[248:251]
M v[248:251],a[124:127],v[56:59],v[248:251]
M v[252:255],a[124:127],v[60:63],v[252:255]
s_waitcnt lgkmcnt(0)
M v[252:255],a[120:123],v[44:47],v[252:255]
s_branch L_loop_top
L_st0:
s_call_b64 s[36:37], L_slow0
s_branch L_rt0
L_st1:
s_call_b64 s[36:37], L_slow1
s_branch L_rt1
L_stv1:
s_call_b64 s[36:37], L_slowf
s_branch L_rtv1
L_stk1:
s_call_b64 s[36:37], L_slowf
s_branch L_rtk1
L_sth1:
s_call_b64 s[36:37], L_slowf
s_branch L_rth1
L_stj0:
s_call_b64 s[36:37], L_slowj
s_branch L_rtj0
L_stv2:
s_call_b64 s[36:37], L_slow1
s_branch L_rtv2
L_stv3:
s_call_b64 s[36:37], L_slow0
s_branch L_rtv3
L_std1:
s_call_b64 s[36:37], L_slow1
s_branch L_rtd1
L_std3n:
s_call_b64 s[36:37], L_slow0
s_branch L_rtd3n
L_std3h:
s_call_b64 s[36:37], L_slow0
s_branch L_rtd3h
L_std4n:
s_call_b64 s[36:37], L_slowb
s_branch L_rtd4n
L_std4h:
s_call_b64 s[36:37], L_slowb
s_branch L_rtd4h
L_stfh:
s_call_b64 s[36:37], L_slow1n
s_branch L_rtfh
L_stc:
s_call_b64 s[36:37], L_comb
s_branch L_rtc
L_slow0:
s_nop 7
s_nop 3
v_max3_f32 v10, v64, v65, v66
v_max3_f32 v10, v67, v72, v10
v_max3_f32 v10, v73, v74, v10
v_max3_f32 v10, v75, v80, v10
v_max3_f32 v10, v81, v82, v10
v_max3_f32 v10, v83, v88, v10
v_max3_f32 v10, v89, v90, v10
v_max_f32 v10, v91, v10
v_max3_f32 v11, v68, v69, v70
v_max3_f32 v11, v71, v76, v11
v_max3_f32 v11, v77, v78, v11
v_max3_f32 v11, v79, v84, v11
v_max3_f32 v11, v85, v86, v11
v_max3_f32 v11, v87, v92, v11
v_max3_f32 v11, v93, v94, v11
v_max_f32 v11, v95, v11
v_mov_b32 v12, v10
v_mov_b32 v13, v11
s_nop 0
v_permlane16_swap_b32 v12, v10
v_permlane16_swap_b32 v13, v11
v_max_f32 v10, v12, v10
v_max_f32 v11, v13, v11
v_mov_b32 v12, v10
v_mov_b32 v13, v11
s_nop 0
v_permlane32_swap_b32 v12, v10
v_permlane32_swap_b32 v13, v11
v_max_f32 v10, v12, v10
v_max_f32 v11, v13, v11
v_ceil_f32 v10, v10
v_ceil_f32 v11, v11
v_max_f32 v10, 0, v10
v_max_f32 v11, 0, v11
v_sub_f32 v64, v64, v10
v_sub_f32 v65, v65, v10
v_sub_f32 v66, v66, v10
v_sub_f32 v67, v67, v10
v_sub_f32 v68, v68, v11
v_sub_f32 v69, v69, v11
v_sub_f32 v70, v70, v11
v_sub_f32 v71, v71, v11
v_sub_f32 v72, v72, v10
v_sub_f32 v73, v73, v10
v_sub_f32 v74, v74, v10
v_sub_f32 v75, v75, v10
v_sub_f32 v76, v76, v11
v_sub_f32 v77, v77, v11
v_sub_f32 v78, v78, v11
v_sub_f32 v79, v79, v11
v_sub_f32 v80, v80, v10
v_sub_f32 v81, v81, v10
v_sub_f32 v82, v82, v10
v_sub_f32 v83, v83, v10
v_sub_f32 v84, v84, v11
v_sub_f32 v85, v85, v11
v_sub_f32 v86, v86, v11
v_sub_f32 v87, v87, v11
v_sub_f32 v88, v88, v10
v_sub_f32 v89, v89, v10
v_sub_f32 v90, v90, v10
v_sub_f32 v91, v91, v10
v_sub_f32 v92, v92, v11
v_sub_f32 v93, v93, v11
v_sub_f32 v94, v94, v11
v_sub_f32 v95, v95, v11
v_sub_f32 v96, v96, v10
v_sub_f32 v97, v97, v10
v_sub_f32 v98, v98, v10
v_sub_f32 v99, v99, v10
v_sub_f32 v100, v100, v11
v_sub_f32 v101, v101, v11
v_sub_f32 v102, v102, v11
v_sub_f32 v103, v103, v11
v_sub_f32 v104, v104, v10
v_sub_f32 v105, v105, v10
v_sub_f32 v106, v106, v10
v_sub_f32 v107, v107, v10
v_sub_f32 v108, v108, v11
v_sub_f32 v109, v109, v11
v_sub_f32 v110, v110, v11
v_sub_f32 v111, v111, v11
v_sub_f32 v112, v112, v10
v_sub_f32 v113, v113, v10
v_sub_f32 v114, v114, v10
v_sub_f32 v115, v115, v10
v_sub_f32 v116, v116, v11
v_sub_f32 v117, v117, v11
v_sub_f32 v118, v118, v11
v_sub_f32 v119, v119, v11
v_sub_f32 v120, v120, v10
v_sub_f32 v121, v121, v10
v_sub_f32 v122, v122, v10
v_sub_f32 v123, v123, v10
v_sub_f32 v124, v124, v11
v_sub_f32 v125, v125, v11
v_sub_f32 v126, v126, v11
v_sub_f32 v127, v127, v11
v_sub_f32 v32, v32, v10
v_sub_f32 v33, v33, v10
v_sub_f32 v34, v34, v10
v_sub_f32 v35, v35, v10
v_sub_f32 v36, v36, v11
v_sub_f32 v37, v37, v11
v_sub_f32 v38, v38, v11
v_sub_f32 v39, v39, v11
E v12,-v10
E v13,-v11
MF v30,v12,v30
MF v31,v13,v31
MF v128,v12,v128
MF v129,v12,v129
MF v130,v12,v130
MF v131,v12,v131
MF v132,v13,v132
MF v133,v13,v133
MF v134,v13,v134
MF v135,v13,v135
MF v136,v12,v136
MF v137,v12,v137
MF v138,v12,v138
MF v139,v12,v139
MF v140,v13,v140
MF v141,v13,v141
MF v142,v13,v142
MF v143,v13,v143
MF v144,v12,v144
MF v145,v12,v145
MF v146,v12,v146
MF v147,v12,v147
MF v148,v13,v148
MF v149,v13,v149
MF v150,v13,v150
MF v151,v13,v151
MF v152,v12,v152
MF v153,v12,v153
MF v154,v12,v154
MF v155,v12,v155
MF v156,v13,v156
MF v157,v13,v157
MF v158,v13,v158
MF v159,v13,v159
MF v160,v12,v160
MF v161,v12,v161
MF v162,v12,v162
MF v163,v12,v163
MF v164,v13,v164
MF v165,v13,v165
MF v166,v13,v166
MF v167,v13,v167
MF v168,v12,v168
MF v169,v12,v169
MF v170,v12,v170
MF v171,v12,v171
MF v172,v13,v172
MF v173,v13,v173
MF v174,v13,v174
MF v175,v13,v175
MF v176,v12,v176
MF v177,v12,v177
MF v178,v12,v178
MF v179,v12,v179
MF v180,v13,v180
MF v181,v13,v181
MF v182,v13,v182
MF v183,v13,v183
MF v184,v12,v184
MF v185,v12,v185
MF v186,v12,v186
MF v187,v12,v187
MF v188,v13,v188
MF v189,v13,v189
MF v190,v13,v190
MF v191,v13,v191
MF v192,v12,v192
MF v193,v12,v193
MF v194,v12,v194
MF v195,v12,v195
MF v196,v13,v196
MF v197,v13,v197
MF v198,v13,v198
MF v199,v13,v199
MF v200,v12,v200
MF v201,v12,v201
MF v202,v12,v202
MF v203,v12,v203
MF v204,v13,v204
MF v205,v13,v205
MF v206,v13,v206
MF v207,v13,v207
MF v208,v12,v208
MF v209,v12,v209
MF v210,v12,v210
MF v211,v12,v211
MF v212,v13,v212
MF v213,v13,v213
MF v214,v13,v214
MF v215,v13,v215
MF v216,v12,v216
MF v217,v12,v217
MF v218,v12,v218
MF v219,v12,v219
MF v220,v13,v220
MF v221,v13,v221
MF v222,v13,v222
MF v223,v13,v223
MF v224,v12,v224
MF v225,v12,v225
MF v226,v12,v226
MF v227,v12,v227
MF v228,v13,v228
MF v229,v13,v229
MF v230,v13,v230
MF v231,v13,v231
MF v232,v12,v232
MF v233,v12,v233
MF v234,v12,v234
MF v235,v12,v235
MF v236,v13,v236
MF v237,v13,v237
MF v238,v13,v238
MF v239,v13,v239
MF v240,v12,v240
MF v241,v12,v241
MF v242,v12,v242
MF v243,v12,v243
MF v244,v13,v244
MF v245,v13,v245
MF v246,v13,v246
MF v247,v13,v247
MF v248,v12,v248
MF v249,v12,v249
MF v250,v12,v250
MF v251,v12,v251
MF v252,v13,v252
MF v253,v13,v253
MF v254,v13,v254
MF v255,v13,v255
E v18,v64
E v19,v65
E v20,v66
AF v26,v18,v19
C v40,v18,v19
E v21,v67
E v22,v72
AF v26,v20,v26
C v41,v20,v21
E v23,v73
AF v26,v21,v26
E v24,v74
AF v26,v22,v26
C v42,v22,v23
E v25,v75
AF v26,v23,v26
E v18,v68
AF v26,v24,v26
C v43,v24,v25
E v19,v69
AF v26,v25,v26
E v20,v70
AF v27,v18,v19
C v44,v18,v19
E v21,v71
E v22,v76
AF v27,v20,v27
C v45,v20,v21
E v23,v77
AF v27,v21,v27
E v24,v78
AF v27,v22,v27
C v46,v22,v23
E v25,v79
AF v27,v23,v27
AF v27,v24,v27
C v47,v24,v25
AF v27,v25,v27
E v18,v80
E v19,v81
E v20,v82
AF v26,v18,v26
C v56,v18,v19
E v21,v83
AF v26,v19,v26
E v22,v88
AF v26,v20,v26
C v57,v20,v21
E v23,v89
AF v26,v21,v26
E v24,v90
AF v26,v22,v26
C v58,v22,v23
E v25,v91
AF v26,v23,v26
E v18,v84
AF v26,v24,v26
C v59,v24,v25
E v19,v85
AF v26,v25,v26
E v20,v86
AF v27,v18,v27
C v60,v18,v19
E v21,v87
AF v27,v19,v27
E v22,v92
AF v27,v20,v27
C v61,v20,v21
E v23,v93
AF v27,v21,v27
E v24,v94
AF v27,v22,v27
C v62,v22,v23
E v25,v95
AF v27,v23,v27
AF v27,v24,v27
C v63,v24,v25
AF v27,v25,v27
s_nop 3
s_setpc_b64 s[36:37]
L_slow1:
s_nop 7
s_nop 3
v_max3_f32 v10, v96, v97, v98
v_max3_f32 v10, v99, v104, v10
v_max3_f32 v10, v105, v106, v10
v_max3_f32 v10, v107, v112, v10
v_max3_f32 v10, v113, v114, v10
v_max3_f32 v10, v115, v120, v10
v_max3_f32 v10, v121, v122, v10
v_max_f32 v10, v123, v10
v_max3_f32 v11, v100, v101, v102
v_max3_f32 v11, v103, v108, v11
v_max3_f32 v11, v109, v110, v11
v_max3_f32 v11, v111, v116, v11
v_max3_f32 v11, v117, v118, v11
v_max3_f32 v11, v119, v124, v11
v_max3_f32 v11, v125, v126, v11
v_max_f32 v11, v127, v11
v_mov_b32 v12, v10
v_mov_b32 v13, v11
s_nop 0
v_permlane16_swap_b32 v12, v10
v_permlane16_swap_b32 v13, v11
v_max_f32 v10, v12, v10
v_max_f32 v11, v13, v11
v_mov_b32 v12, v10
v_mov_b32 v13, v11
s_nop 0
v_permlane32_swap_b32 v12, v10
v_permlane32_swap_b32 v13, v11
v_max_f32 v10, v12, v10
v_max_f32 v11, v13, v11
v_ceil_f32 v10, v10
v_ceil_f32 v11, v11
v_max_f32 v10, 0, v10
v_max_f32 v11, 0, v11
v_sub_f32 v96, v96, v10
v_sub_f32 v97, v97, v10
v_sub_f32 v98, v98, v10
v_sub_f32 v99, v99, v10
v_sub_f32 v100, v100, v11
v_sub_f32 v101, v101, v11
v_sub_f32 v102, v102, v11
v_sub_f32 v103, v103, v11
v_sub_f32 v104, v104, v10
v_sub_f32 v105, v105, v10
v_sub_f32 v106, v106, v10
v_sub_f32 v107, v107, v10
v_sub_f32 v108, v108, v11
v_sub_f32 v109, v109, v11
v_sub_f32 v110, v110, v11
v_sub_f32 v111, v111, v11
v_sub_f32 v112, v112, v10
v_sub_f32 v113, v113, v10
v_sub_f32 v114, v114, v10
v_sub_f32 v115, v115, v10
v_sub_f32 v116, v116, v11
v_sub_f32 v117, v117, v11
v_sub_f32 v118, v118, v11
v_sub_f32 v119, v119, v11
v_sub_f32 v120, v120, v10
v_sub_f32 v121, v121, v10
v_sub_f32 v122, v122, v10
v_sub_f32 v123, v123, v10
v_sub_f32 v124, v124, v11
v_sub_f32 v125, v125, v11
v_sub_f32 v126, v126, v11
v_sub_f32 v127, v127, v11
v_sub_f32 v64, v64, v10
v_sub_f32 v65, v65, v10
v_sub_f32 v66, v66, v10
v_sub_f32 v67, v67, v10
v_sub_f32 v68, v68, v11
v_sub_f32 v69, v69, v11
v_sub_f32 v70, v70, v11
v_sub_f32 v71, v71, v11
v_sub_f32 v72, v72, v10
v_sub_f32 v73, v73, v10
v_sub_f32 v74, v74, v10
v_sub_f32 v75, v75, v10
v_sub_f32 v76, v76, v11
v_sub_f32 v77, v77, v11
v_sub_f32 v78, v78, v11
v_sub_f32 v79, v79, v11
v_sub_f32 v80, v80, v10
v_sub_f32 v81, v81, v10
v_sub_f32 v82, v82, v10
v_sub_f32 v83, v83, v10
v_sub_f32 v84, v84, v11
v_sub_f32 v85, v85, v11
v_sub_f32 v86, v86, v11
v_sub_f32 v87, v87, v11
v_sub_f32 v88, v88, v10
v_sub_f32 v89, v89, v10
v_sub_f32 v90, v90, v10
v_sub_f32 v91, v91, v10
v_sub_f32 v92, v92, v11
v_sub_f32 v93, v93, v11
v_sub_f32 v94, v94, v11
v_sub_f32 v95, v95, v11
v_sub_f32 v32, v32, v10
v_sub_f32 v33, v33, v10
v_sub_f32 v34, v34, v10
v_sub_f32 v35, v35, v10
v_sub_f32 v36, v36, v11
v_sub_f32 v37, v37, v11
v_sub_f32 v38, v38, v11
v_sub_f32 v39, v39, v11
E v12,-v10
E v13,-v11
MF v30,v12,v30
MF v31,v13,v31
MF v128,v12,v128
MF v129,v12,v129
MF v130,v12,v130
MF v131,v12,v131
MF v132,v13,v132
MF v133,v13,v133
MF v134,v13,v134
MF v135,v13,v135
MF v136,v12,v136
MF v137,v12,v137
MF v138,v12,v138
MF v139,v12,v139
MF v140,v13,v140
MF v141,v13,v141
MF v142,v13,v142
MF v143,v13,v143
MF v144,v12,v144
MF v145,v12,v145
MF v146,v12,v146
MF v147,v12,v147
MF v148,v13,v148
MF v149,v13,v149
MF v150,v13,v150
MF v151,v13,v151
MF v152,v12,v152
MF v153,v12,v153
MF v154,v12,v154
MF v155,v12,v155
MF v156,v13,v156
MF v157,v13,v157
MF v158,v13,v158
MF v159,v13,v159
MF v160,v12,v160
MF v161,v12,v161
MF v162,v12,v162
MF v163,v12,v163
MF v164,v13,v164
MF v165,v13,v165
MF v166,v13,v166
MF v167,v13,v167
MF v168,v12,v168
MF v169,v12,v169
MF v170,v12,v170
MF v171,v12,v171
MF v172,v13,v172
MF v173,v13,v173
MF v174,v13,v174
MF v175,v13,v175
MF v176,v12,v176
MF v177,v12,v177
MF v178,v12,v178
MF v179,v12,v179
MF v180,v13,v180
MF v181,v13,v181
MF v182,v13,v182
MF v183,v13,v183
MF v184,v12,v184
MF v185,v12,v185
MF v186,v12,v186
MF v187,v12,v187
MF v188,v13,v188
MF v189,v13,v189
MF v190,v13,v190
MF v191,v13,v191
MF v192,v12,v192
MF v193,v12,v193
MF v194,v12,v194
MF v195,v12,v195
MF v196,v13,v196
MF v197,v13,v197
MF v198,v13,v198
MF v199,v13,v199
MF v200,v12,v200
MF v201,v12,v201
MF v202,v12,v202
MF v203,v12,v203
MF v204,v13,v204
MF v205,v13,v205
MF v206,v13,v206
MF v207,v13,v207
MF v208,v12,v208
MF v209,v12,v209
MF v210,v12,v210
MF v211,v12,v211
MF v212,v13,v212
MF v213,v13,v213
MF v214,v13,v214
MF v215,v13,v215
MF v216,v12,v216
MF v217,v12,v217
MF v218,v12,v218
MF v219,v12,v219
MF v220,v13,v220
MF v221,v13,v221
MF v222,v13,v222
MF v223,v13,v223
MF v224,v12,v224
MF v225,v12,v225
MF v226,v12,v226
MF v227,v12,v227
MF v228,v13,v228
MF v229,v13,v229
MF v230,v13,v230
MF v231,v13,v231
MF v232,v12,v232
MF v233,v12,v233
MF v234,v12,v234
MF v235,v12,v235
MF v236,v13,v236
MF v237,v13,v237
MF v238,v13,v238
MF v239,v13,v239
MF v240,v12,v240
MF v241,v12,v241
MF v242,v12,v242
MF v243,v12,v243
MF v244,v13,v244
MF v245,v13,v245
MF v246,v13,v246
MF v247,v13,v247
MF v248,v12,v248
MF v249,v12,v249
MF v250,v12,v250
MF v251,v12,v251
MF v252,v13,v252
MF v253,v13,v253
MF v254,v13,v254
MF v255,v13,v255
E v18,v96
E v19,v97
E v20,v98
AF v28,v18,v19
C v48,v18,v19
E v21,v99
E v22,v104
AF v28,v20,v28
C v49,v20,v21
E v23,v105
AF v28,v21,v28
E v24,v106
AF v28,v22,v28
C v50,v22,v23
E v25,v107
AF v28,v23,v28
E v18,v100
AF v28,v24,v28
C v51,v24,v25
E v19,v101
AF v28,v25,v28
E v20,v102
AF v29,v18,v19
C v52,v18,v19
E v21,v103
E v22,v108
AF v29,v20,v29
C v53,v20,v21
E v23,v109
AF v29,v21,v29
E v24,v110
AF v29,v22,v29
C v54,v22,v23
E v25,v111
AF v29,v23,v29
AF v29,v24,v29
C v55,v24,v25
AF v29,v25,v29
E v18,v112
E v19,v113
E v20,v114
AF v28,v18,v28
C v56,v18,v19
E v21,v115
AF v28,v19,v28
E v22,v120
AF v28,v20,v28
C v57,v20,v21
E v23,v121
AF v28,v21,v28
E v24,v122
AF v28,v22,v28
C v58,v22,v23
E v25,v123
AF v28,v23,v28
E v18,v116
AF v28,v24,v28
C v59,v24,v25
E v19,v117
AF v28,v25,v28
E v20,v118
AF v29,v18,v29
C v60,v18,v19
E v21,v119
AF v29,v19,v29
E v22,v124
AF v29,v20,v29
C v61,v20,v21
E v23,v125
AF v29,v21,v29
E v24,v126
AF v29,v22,v29
C v62,v22,v23
E v25,v127
AF v29,v23,v29
AF v29,v24,v29
C v63,v24,v25
AF v29,v25,v29
s_nop 3
s_setpc_b64 s[36:37]
L_slow1n:
s_nop 7
s_nop 3
v_max3_f32 v10, v96, v97, v98
v_max3_f32 v10, v99, v104, v10
v_max3_f32 v10, v105, v106, v10
v_max3_f32 v10, v107, v112, v10
v_max3_f32 v10, v113, v114, v10
v_max3_f32 v10, v115, v120, v10
v_max3_f32 v10, v121, v122, v10
v_max_f32 v10, v123, v10
v_max3_f32 v11, v100, v101, v102
v_max3_f32 v11, v103, v108, v11
v_max3_f32 v11, v109, v110, v11
v_max3_f32 v11, v111, v116, v11
v_max3_f32 v11, v117, v118, v11
v_max3_f32 v11, v119, v124, v11
v_max3_f32 v11, v125, v126, v11
v_max_f32 v11, v127, v11
v_mov_b32 v12, v10
v_mov_b32 v13, v11
s_nop 0
v_permlane16_swap_b32 v12, v10
v_permlane16_swap_b32 v13, v11
v_max_f32 v10, v12, v10
v_max_f32 v11, v13, v11
v_mov_b32 v12, v10
v_mov_b32 v13, v11
s_nop 0
v_permlane32_swap_b32 v12, v10
v_permlane32_swap_b32 v13, v11
v_max_f32 v10, v12, v10
v_max_f32 v11, v13, v11
v_ceil_f32 v10, v10
v_ceil_f32 v11, v11
v_max_f32 v10, 0, v10
v_max_f32 v11, 0, v11
v_sub_f32 v96, v96, v10
v_sub_f32 v97, v97, v10
v_sub_f32 v98, v98, v10
v_sub_f32 v99, v99, v10
v_sub_f32 v100, v100, v11
v_sub_f32 v101, v101, v11
v_sub_f32 v102, v102, v11
v_sub_f32 v103, v103, v11
v_sub_f32 v104, v104, v10
v_sub_f32 v105, v105, v10
v_sub_f32 v106, v106, v10
v_sub_f32 v107, v107, v10
v_sub_f32 v108, v108, v11
v_sub_f32 v109, v109, v11
v_sub_f32 v110, v110, v11
v_sub_f32 v111, v111, v11
v_sub_f32 v112, v112, v10
v_sub_f32 v113, v113, v10
v_sub_f32 v114, v114, v10
v_sub_f32 v115, v115, v10
v_sub_f32 v116, v116, v11
v_sub_f32 v117, v117, v11
v_sub_f32 v118, v118, v11
v_sub_f32 v119, v119, v11
v_sub_f32 v120, v120, v10
v_sub_f32 v121, v121, v10
v_sub_f32 v122, v122, v10
v_sub_f32 v123, v123, v10
v_sub_f32 v124, v124, v11
v_sub_f32 v125, v125, v11
v_sub_f32 v126, v126, v11
v_sub_f32 v127, v127, v11
v_sub_f32 v32, v32, v10
v_sub_f32 v33, v33, v10
v_sub_f32 v34, v34, v10
v_sub_f32 v35, v35, v10
v_sub_f32 v36, v36, v11
v_sub_f32 v37, v37, v11
v_sub_f32 v38, v38, v11
v_sub_f32 v39, v39, v11
E v12,-v10
E v13,-v11
MF v30,v12,v30
MF v31,v13,v31
MF v128,v12,v128
MF v129,v12,v129
MF v130,v12,v130
MF v131,v12,v131
MF v132,v13,v132
MF v133,v13,v133
MF v134,v13,v134
MF v135,v13,v135
MF v136,v12,v136
MF v137,v12,v137
MF v138,v12,v138
MF v139,v12,v139
MF v140,v13,v140
MF v141,v13,v141
MF v142,v13,v142
MF v143,v13,v143
MF v144,v12,v144
MF v145,v12,v145
MF v146,v12,v146
MF v147,v12,v147
MF v148,v13,v148
MF v149,v13,v149
MF v150,v13,v150
MF v151,v13,v151
MF v152,v12,v152
MF v153,v12,v153
MF v154,v12,v154
MF v155,v12,v155
MF v156,v13,v156
MF v157,v13,v157
MF v158,v13,v158
MF v159,v13,v159
MF v160,v12,v160
MF v161,v12,v161
MF v162,v12,v162
MF v163,v12,v163
MF v164,v13,v164
MF v165,v13,v165
MF v166,v13,v166
MF v167,v13,v167
MF v168,v12,v168
MF v169,v12,v169
MF v170,v12,v170
MF v171,v12,v171
MF v172,v13,v172
MF v173,v13,v173
MF v174,v13,v174
MF v175,v13,v175
MF v176,v12,v176
MF v177,v12,v177
MF v178,v12,v178
MF v179,v12,v179
MF v180,v13,v180
MF v181,v13,v181
MF v182,v13,v182
MF v183,v13,v183
MF v184,v12,v184
MF v185,v12,v185
MF v186,v12,v186
MF v187,v12,v187
MF v188,v13,v188
MF v189,v13,v189
MF v190,v13,v190
MF v191,v13,v191
MF v192,v12,v192
MF v193,v12,v193
MF v194,v12,v194
MF v195,v12,v195
MF v196,v13,v196
MF v197,v13,v197
MF v198,v13,v198
MF v199,v13,v199
MF v200,v12,v200
MF v201,v12,v201
MF v202,v12,v202
MF v203,v12,v203
MF v204,v13,v204
MF v205,v13,v205
MF v206,v13,v206
MF v207,v13,v207
MF v208,v12,v208
MF v209,v12,v209
MF v210,v12,v210
MF v211,v12,v211
MF v212,v13,v212
MF v213,v13,v213
MF v214,v13,v214
MF v215,v13,v215
MF v216,v12,v216
MF v217,v12,v217
MF v218,v12,v218
MF v219,v12,v219
MF v220,v13,v220
MF v221,v13,v221
MF v222,v13,v222
MF v223,v13,v223
MF v224,v12,v224
MF v225,v12,v225
MF v226,v12,v226
MF v227,v12,v227
MF v228,v13,v228
MF v229,v13,v229
MF v230,v13,v230
MF v231,v13,v231
MF v232,v12,v232
MF v233,v12,v233
MF v234,v12,v234
MF v235,v12,v235
MF v236,v13,v236
MF v237,v13,v237
MF v238,v13,v238
MF v239,v13,v239
MF v240,v12,v240
MF v241,v12,v241
MF v242,v12,v242
MF v243,v12,v243
MF v244,v13,v244
MF v245,v13,v245
MF v246,v13,v246
MF v247,v13,v247
MF v248,v12,v248
MF v249,v12,v249
MF v250,v12,v250
MF v251,v12,v251
MF v252,v13,v252
MF v253,v13,v253
MF v254,v13,v254
MF v255,v13,v255
E v18,v96
E v19,v97
E v20,v98
AF v28,v18,v19
C v48,v18,v19
E v21,v99
E v22,v104
AF v28,v20,v28
C v49,v20,v21
E v23,v105
AF v28,v21,v28
E v24,v106
AF v28,v22,v28
C v50,v22,v23
E v25,v107
AF v28,v23,v28
E v18,v100
AF v28,v24,v28
C v51,v24,v25
E v19,v101
AF v28,v25,v28
E v20,v102
AF v29,v18,v19
C v52,v18,v19
E v21,v103
E v22,v108
AF v29,v20,v29
C v53,v20,v21
E v23,v109
AF v29,v21,v29
E v24,v110
AF v29,v22,v29
C v54,v22,v23
E v25,v111
AF v29,v23,v29
AF v29,v24,v29
C v55,v24,v25
AF v29,v25,v29
E v18,v112
E v19,v113
E v20,v114
AF v28,v18,v28
C v56,v18,v19
E v21,v115
AF v28,v19,v28
E v22,v120
AF v28,v20,v28
C v57,v20,v21
E v23,v121
AF v28,v21,v28
E v24,v122
AF v28,v22,v28
C v58,v22,v23
E v25,v123
AF v28,v23,v28
E v18,v116
AF v28,v24,v28
C v59,v24,v25
E v19,v117
AF v28,v25,v28
E v20,v118
AF v29,v18,v29
C v60,v18,v19
E v21,v119
AF v29,v19,v29
E v22,v124
AF v29,v20,v29
C v61,v20,v21
E v23,v125
AF v29,v21,v29
E v24,v126
AF v29,v22,v29
C v62,v22,v23
E v25,v127
AF v29,v23,v29
AF v29,v24,v29
C v63,v24,v25
AF v29,v25,v29
s_nop 3
s_setpc_b64 s[36:37]
L_slowf:
s_nop 7
s_nop 3
v_max3_f32 v10, v64, v65, v66
v_max3_f32 v10, v67, v72, v10
v_max3_f32 v10, v73, v74, v10
v_max3_f32 v10, v75, v80, v10
v_max3_f32 v10, v81, v82, v10
v_max3_f32 v10, v83, v88, v10
v_max3_f32 v10, v89, v90, v10
v_max_f32 v10, v91, v10
v_max3_f32 v11, v68, v69, v70
v_max3_f32 v11, v71, v76, v11
v_max3_f32 v11, v77, v78, v11
v_max3_f32 v11, v79, v84, v11
v_max3_f32 v11, v85, v86, v11
v_max3_f32 v11, v87, v92, v11
v_max3_f32 v11, v93, v94, v11
v_max_f32 v11, v95, v11
v_mov_b32 v12, v10
v_mov_b32 v13, v11
s_nop 0
v_permlane16_swap_b32 v12, v10
v_permlane16_swap_b32 v13, v11
v_max_f32 v10, v12, v10
v_max_f32 v11, v13, v11
v_mov_b32 v12, v10
v_mov_b32 v13, v11
s_nop 0
v_permlane32_swap_b32 v12, v10
v_permlane32_swap_b32 v13, v11
v_max_f32 v10, v12, v10
v_max_f32 v11, v13, v11
v_ceil_f32 v10, v10
v_ceil_f32 v11, v11
v_sub_f32 v64, v64, v10
v_sub_f32 v65, v65, v10
v_sub_f32 v66, v66, v10
v_sub_f32 v67, v67, v10
v_sub_f32 v68, v68, v11
v_sub_f32 v69, v69, v11
v_sub_f32 v70, v70, v11
v_sub_f32 v71, v71, v11
v_sub_f32 v72, v72, v10
v_sub_f32 v73, v73, v10
v_sub_f32 v74, v74, v10
v_sub_f32 v75, v75, v10
v_sub_f32 v76, v76, v11
v_sub_f32 v77, v77, v11
v_sub_f32 v78, v78, v11
v_sub_f32 v79, v79, v11
v_sub_f32 v80, v80, v10
v_sub_f32 v81, v81, v10
v_sub_f32 v82, v82, v10
v_sub_f32 v83, v83, v10
v_sub_f32 v84, v84, v11
v_sub_f32 v85, v85, v11
v_sub_f32 v86, v86, v11
v_sub_f32 v87, v87, v11
v_sub_f32 v88, v88, v10
v_sub_f32 v89, v89, v10
v_sub_f32 v90, v90, v10
v_sub_f32 v91, v91, v10
v_sub_f32 v92, v92, v11
v_sub_f32 v93, v93, v11
v_sub_f32 v94, v94, v11
v_sub_f32 v95, v95, v11
v_sub_f32 v96, v96, v10
v_sub_f32 v97, v97, v10
v_sub_f32 v98, v98, v10
v_sub_f32 v99, v99, v10
v_sub_f32 v100, v100, v11
v_sub_f32 v101, v101, v11
v_sub_f32 v102, v102, v11
v_sub_f32 v103, v103, v11
v_sub_f32 v104, v104, v10
v_sub_f32 v105, v105, v10
v_sub_f32 v106, v106, v10
v_sub_f32 v107, v107, v10
v_sub_f32 v108, v108, v11
v_sub_f32 v109, v109, v11
v_sub_f32 v110, v110, v11
v_sub_f32 v111, v111, v11
v_sub_f32 v112, v112, v10
v_sub_f32 v113, v113, v10
v_sub_f32 v114, v114, v10
v_sub_f32 v115, v115, v10
v_sub_f32 v116, v116, v11
v_sub_f32 v117, v117, v11
v_sub_f32 v118, v118, v11
v_sub_f32 v119, v119, v11
v_sub_f32 v120, v120, v10
v_sub_f32 v121, v121, v10
v_sub_f32 v122, v122, v10
v_sub_f32 v123, v123, v10
v_sub_f32 v124, v124, v11
v_sub_f32 v125, v125, v11
v_sub_f32 v126, v126, v11
v_sub_f32 v127, v127, v11
v_sub_f32 v32, v32, v10
v_sub_f32 v33, v33, v10
v_sub_f32 v34, v34, v10
v_sub_f32 v35, v35, v10
v_sub_f32 v36, v36, v11
v_sub_f32 v37, v37, v11
v_sub_f32 v38, v38, v11
v_sub_f32 v39, v39, v11
E v18,v64
E v19,v65
E v20,v66
AF v26,v18,v19
C v40,v18,v19
E v21,v67
E v22,v72
AF v26,v20,v26
C v41,v20,v21
E v23,v73
AF v26,v21,v26
E v24,v74
AF v26,v22,v26
C v42,v22,v23
E v25,v75
AF v26,v23,v26
E v18,v68
AF v26,v24,v26
C v43,v24,v25
E v19,v69
AF v26,v25,v26
E v20,v70
AF v27,v18,v19
C v44,v18,v19
E v21,v71
E v22,v76
AF v27,v20,v27
C v45,v20,v21
E v23,v77
AF v27,v21,v27
E v24,v78
AF v27,v22,v27
C v46,v22,v23
E v25,v79
AF v27,v23,v27
AF v27,v24,v27
C v47,v24,v25
AF v27,v25,v27
E v18,v80
E v19,v81
E v20,v82
AF v26,v18,v26
C v56,v18,v19
E v21,v83
AF v26,v19,v26
E v22,v88
AF v26,v20,v26
C v57,v20,v21
E v23,v89
AF v26,v21,v26
E v24,v90
AF v26,v22,v26
C v58,v22,v23
E v25,v91
AF v26,v23,v26
E v18,v84
AF v26,v24,v26
C v59,v24,v25
E v19,v85
AF v26,v25,v26
E v20,v86
AF v27,v18,v27
C v60,v18,v19
E v21,v87
AF v27,v19,v27
E v22,v92
AF v27,v20,v27
C v61,v20,v21
E v23,v93
AF v27,v21,v27
E v24,v94
AF v27,v22,v27
C v62,v22,v23
E v25,v95
AF v27,v23,v27
AF v27,v24,v27
C v63,v24,v25
AF v27,v25,v27
s_nop 3
s_setpc_b64 s[36:37]
L_slowj:
s_nop 7
s_nop 3
v_max3_f32 v10, v64, v65, v66
v_max3_f32 v10, v67, v72, v10
v_max3_f32 v10, v73, v74, v10
v_max3_f32 v10, v75, v80, v10
v_max3_f32 v10, v81, v82, v10
v_max3_f32 v10, v83, v88, v10
v_max3_f32 v10, v89, v90, v10
v_max_f32 v10, v91, v10
v_max3_f32 v11, v68, v69, v70
v_max3_f32 v11, v71, v76, v11
v_max3_f32 v11, v77, v78, v11
v_max3_f32 v11, v79, v84, v11
v_max3_f32 v11, v85, v86, v11
v_max3_f32 v11, v87, v92, v11
v_max3_f32 v11, v93, v94, v11
v_max_f32 v11, v95, v11
v_mov_b32 v12, v10
v_mov_b32 v13, v11
s_nop 0
v_permlane16_swap_b32 v12, v10
v_permlane16_swap_b32 v13, v11
v_max_f32 v10, v12, v10
v_max_f32 v11, v13, v11
v_mov_b32 v12, v10
v_mov_b32 v13, v11
s_nop 0
v_permlane32_swap_b32 v12, v10
v_permlane32_swap_b32 v13, v11
v_max_f32 v10, v12, v10
v_max_f32 v11, v13, v11
v_ceil_f32 v10, v10
v_ceil_f32 v11, v11
v_sub_f32 v64, v64, v10
v_sub_f32 v65, v65, v10
v_sub_f32 v66, v66, v10
v_sub_f32 v67, v67, v10
v_sub_f32 v68, v68, v11
v_sub_f32 v69, v69, v11
v_sub_f32 v70, v70, v11
v_sub_f32 v71, v71, v11
v_sub_f32 v72, v72, v10
v_sub_f32 v73, v73, v10
v_sub_f32 v74, v74, v10
v_sub_f32 v75, v75, v10
v_sub_f32 v76, v76, v11
v_sub_f32 v77, v77, v11
v_sub_f32 v78, v78, v11
v_sub_f32 v79, v79, v11
v_sub_f32 v80, v80, v10
v_sub_f32 v81, v81, v10
v_sub_f32 v82, v82, v10
v_sub_f32 v83, v83, v10
v_sub_f32 v84, v84, v11
v_sub_f32 v85, v85, v11
v_sub_f32 v86, v86, v11
v_sub_f32 v87, v87, v11
v_sub_f32 v88, v88, v10
v_sub_f32 v89, v89, v10
v_sub_f32 v90, v90, v10
v_sub_f32 v91, v91, v10
v_sub_f32 v92, v92, v11
v_sub_f32 v93, v93, v11
v_sub_f32 v94, v94, v11
v_sub_f32 v95, v95, v11
v_sub_f32 v32, v32, v10
v_sub_f32 v33, v33, v10
v_sub_f32 v34, v34, v10
v_sub_f32 v35, v35, v10
v_sub_f32 v36, v36, v11
v_sub_f32 v37, v37, v11
v_sub_f32 v38, v38, v11
v_sub_f32 v39, v39, v11
E v18,v64
E v19,v65
E v20,v66
AF v26,v18,v19
C v40,v18,v19
E v21,v67
E v22,v72
AF v26,v20,v26
C v41,v20,v21
E v23,v73
AF v26,v21,v26
E v24,v74
AF v26,v22,v26
C v42,v22,v23
E v25,v75
AF v26,v23,v26
E v18,v68
AF v26,v24,v26
C v43,v24,v25
E v19,v69
AF v26,v25,v26
E v20,v70
AF v27,v18,v19
C v44,v18,v19
E v21,v71
E v22,v76
AF v27,v20,v27
C v45,v20,v21
E v23,v77
AF v27,v21,v27
E v24,v78
AF v27,v22,v27
C v46,v22,v23
E v25,v79
AF v27,v23,v27
AF v27,v24,v27
C v47,v24,v25
AF v27,v25,v27
s_nop 3
s_setpc_b64 s[36:37]
L_slowb:
s_nop 7
s_nop 3
v_max3_f32 v11, v100, v101, v102
v_max3_f32 v11, v103, v108, v11
v_max3_f32 v11, v109, v110, v11
v_max3_f32 v11, v111, v116, v11
v_max3_f32 v11, v117, v118, v11
v_max3_f32 v11, v119, v124, v11
v_max3_f32 v11, v125, v126, v11
v_max_f32 v11, v127, v11
v_mov_b32 v13, v11
s_nop 1
v_permlane16_swap_b32 v13, v11
v_max_f32 v11, v13, v11
v_mov_b32 v13, v11
s_nop 1
v_permlane32_swap_b32 v13, v11
v_max_f32 v11, v13, v11
v_ceil_f32 v11, v11
v_max_f32 v11, 0, v11
v_mov_b32 v10, 0
v_sub_f32 v100, v100, v11
v_sub_f32 v101, v101, v11
v_sub_f32 v102, v102, v11
v_sub_f32 v103, v103, v11
v_sub_f32 v108, v108, v11
v_sub_f32 v109, v109, v11
v_sub_f32 v110, v110, v11
v_sub_f32 v111, v111, v11
v_sub_f32 v116, v116, v11
v_sub_f32 v117, v117, v11
v_sub_f32 v118, v118, v11
v_sub_f32 v119, v119, v11
v_sub_f32 v124, v124, v11
v_sub_f32 v125, v125, v11
v_sub_f32 v126, v126, v11
v_sub_f32 v127, v127, v11
v_sub_f32 v32, v32, v10
v_sub_f32 v33, v33, v10
v_sub_f32 v34, v34, v10
v_sub_f32 v35, v35, v10
v_sub_f32 v36, v36, v11
v_sub_f32 v37, v37, v11
v_sub_f32 v38, v38, v11
v_sub_f32 v39, v39, v11
E v12,-v10
E v13,-v11
MF v30,v12,v30
MF v31,v13,v31
MF v128,v12,v128
MF v129,v12,v129
MF v130,v12,v130
MF v131,v12,v131
MF v132,v13,v132
MF v133,v13,v133
MF v134,v13,v134
MF v135,v13,v135
MF v136,v12,v136
MF v137,v12,v137
MF v138,v12,v138
MF v139,v12,v139
MF v140,v13,v140
MF v141,v13,v141
MF v142,v13,v142
MF v143,v13,v143
MF v144,v12,v144
MF v145,v12,v145
MF v146,v12,v146
MF v147,v12,v147
MF v148,v13,v148
MF v149,v13,v149
MF v150,v13,v150
MF v151,v13,v151
MF v152,v12,v152
MF v153,v12,v153
MF v154,v12,v154
MF v155,v12,v155
MF v156,v13,v156
MF v157,v13,v157
MF v158,v13,v158
MF v159,v13,v159
MF v160,v12,v160
MF v161,v12,v161
MF v162,v12,v162
MF v163,v12,v163
MF v164,v13,v164
MF v165,v13,v165
MF v166,v13,v166
MF v167,v13,v167
MF v168,v12,v168
MF v169,v12,v169
MF v170,v12,v170
MF v171,v12,v171
MF v172,v13,v172
MF v173,v13,v173
MF v174,v13,v174
MF v175,v13,v175
MF v176,v12,v176
MF v177,v12,v177
MF v178,v12,v178
MF v179,v12,v179
MF v180,v13,v180
MF v181,v13,v181
MF v182,v13,v182
MF v183,v13,v183
MF v184,v12,v184
MF v185,v12,v185
MF v186,v12,v186
MF v187,v12,v187
MF v188,v13,v188
MF v189,v13,v189
MF v190,v13,v190
MF v191,v13,v191
MF v192,v12,v192
MF v193,v12,v193
MF v194,v12,v194
MF v195,v12,v195
MF v196,v13,v196
MF v197,v13,v197
MF v198,v13,v198
MF v199,v13,v199
MF v200,v12,v200
MF v201,v12,v201
MF v202,v12,v202
MF v203,v12,v203
MF v204,v13,v204
MF v205,v13,v205
MF v206,v13,v206
MF v207,v13,v207
MF v208,v12,v208
MF v209,v12,v209
MF v210,v12,v210
MF v211,v12,v211
MF v212,v13,v212
MF v213,v13,v213
MF v214,v13,v214
MF v215,v13,v215
MF v216,v12,v216
MF v217,v12,v217
MF v218,v12,v218
MF v219,v12,v219
MF v220,v13,v220
MF v221,v13,v221
MF v222,v13,v222
MF v223,v13,v223
MF v224,v12,v224
MF v225,v12,v225
MF v226,v12,v226
MF v227,v12,v227
MF v228,v13,v228
MF v229,v13,v229
MF v230,v13,v230
MF v231,v13,v231
MF v232,v12,v232
MF v233,v12,v233
MF v234,v12,v234
MF v235,v12,v235
MF v236,v13,v236
MF v237,v13,v237
MF v238,v13,v238
MF v239,v13,v239
MF v240,v12,v240
MF v241,v12,v241
MF v242,v12,v242
MF v243,v12,v243
MF v244,v13,v244
MF v245,v13,v245
MF v246,v13,v246
MF v247,v13,v247
MF v248,v12,v248
MF v249,v12,v249
MF v250,v12,v250
MF v251,v12,v251
MF v252,v13,v252
MF v253,v13,v253
MF v254,v13,v254
MF v255,v13,v255
E v18,v100
E v19,v101
E v20,v102
AF v29,v18,v19
C v52,v18,v19
E v21,v103
E v22,v108
AF v29,v20,v29
C v53,v20,v21
E v23,v109
AF v29,v21,v29
E v24,v110
AF v29,v22,v29
C v54,v22,v23
E v25,v111
AF v29,v23,v29
E v18,v116
AF v29,v24,v29
C v55,v24,v25
E v19,v117
AF v29,v25,v29
E v20,v118
AF v29,v18,v29
C v48,v18,v19
E v21,v119
AF v29,v19,v29
E v22,v124
AF v29,v20,v29
C v49,v20,v21
E v23,v125
AF v29,v21,v29
E v24,v126
AF v29,v22,v29
C v50,v22,v23
E v25,v127
AF v29,v23,v29
AF v29,v24,v29
C v51,v24,v25
AF v29,v25,v29
s_nop 3
s_setpc_b64 s[36:37]
L_comb:
s_waitcnt vmcnt(0)
s_nop 7
v_sub_f32 v10, v32, v14
v_sub_f32 v11, v36, v15
v_max_f32 v10, 0, v10
v_max_f32 v11, 0, v11
v_sub_f32 v100, v100, v11
v_sub_f32 v101, v101, v11
v_sub_f32 v102, v102, v11
v_sub_f32 v103, v103, v11
v_sub_f32 v108, v108, v11
v_sub_f32 v109, v109, v11
v_sub_f32 v110, v110, v11
v_sub_f32 v111, v111, v11
v_sub_f32 v116, v116, v11
v_sub_f32 v117, v117, v11
v_sub_f32 v118, v118, v11
v_sub_f32 v119, v119, v11
v_sub_f32 v124, v124, v11
v_sub_f32 v125, v125, v11
v_sub_f32 v126, v126, v11
v_sub_f32 v127, v127, v11
v_sub_f32 v32, v32, v10
v_sub_f32 v33, v33, v10
v_sub_f32 v34, v34, v10
v_sub_f32 v35, v35, v10
v_sub_f32 v36, v36, v11
v_sub_f32 v37, v37, v11
v_sub_f32 v38, v38, v11
v_sub_f32 v39, v39, v11
E v12,-v10
E v13,-v11
MF v30,v12,v30
MF v31,v13,v31
MF v128,v12,v128
MF v129,v12,v129
MF v130,v12,v130
MF v131,v12,v131
MF v132,v13,v132
MF v133,v13,v133
MF v134,v13,v134
MF v135,v13,v135
MF v136,v12,v136
MF v137,v12,v137
MF v138,v12,v138
MF v139,v12,v139
MF v140,v13,v140
MF v141,v13,v141
MF v142,v13,v142
MF v143,v13,v143
MF v144,v12,v144
MF v145,v12,v145
MF v146,v12,v146
MF v147,v12,v147
MF v148,v13,v148
MF v149,v13,v149
MF v150,v13,v150
MF v151,v13,v151
MF v152,v12,v152
MF v153,v12,v153
MF v154,v12,v154
MF v155,v12,v155
MF v156,v13,v156
MF v157,v13,v157
MF v158,v13,v158
MF v159,v13,v159
MF v160,v12,v160
MF v161,v12,v161
MF v162,v12,v162
MF v163,v12,v163
MF v164,v13,v164
MF v165,v13,v165
MF v166,v13,v166
MF v167,v13,v167
MF v168,v12,v168
MF v169,v12,v169
MF v170,v12,v170
MF v171,v12,v171
MF v172,v13,v172
MF v173,v13,v173
MF v174,v13,v174
MF v175,v13,v175
MF v176,v12,v176
MF v177,v12,v177
MF v178,v12,v178
MF v179,v12,v179
MF v180,v13,v180
MF v181,v13,v181
MF v182,v13,v182
MF v183,v13,v183
MF v184,v12,v184
MF v185,v12,v185
MF v186,v12,v186
MF v187,v12,v187
MF v188,v13,v188
MF v189,v13,v189
MF v190,v13,v190
MF v191,v13,v191
MF v192,v12,v192
MF v193,v12,v193
MF v194,v12,v194
MF v195,v12,v195
MF v196,v13,v196
MF v197,v13,v197
MF v198,v13,v198
MF v199,v13,v199
MF v200,v12,v200
MF v201,v12,v201
MF v202,v12,v202
MF v203,v12,v203
MF v204,v13,v204
MF v205,v13,v205
MF v206,v13,v206
MF v207,v13,v207
MF v208,v12,v208
MF v209,v12,v209
MF v210,v12,v210
MF v211,v12,v211
MF v212,v13,v212
MF v213,v13,v213
MF v214,v13,v214
MF v215,v13,v215
MF v216,v12,v216
MF v217,v12,v217
MF v218,v12,v218
MF v219,v12,v219
MF v220,v13,v220
MF v221,v13,v221
MF v222,v13,v222
MF v223,v13,v223
MF v224,v12,v224
MF v225,v12,v225
MF v226,v12,v226
MF v227,v12,v227
MF v228,v13,v228
MF v229,v13,v229
MF v230,v13,v230
MF v231,v13,v231
MF v232,v12,v232
MF v233,v12,v233
MF v234,v12,v234
MF v235,v12,v235
MF v236,v13,v236
MF v237,v13,v237
MF v238,v13,v238
MF v239,v13,v239
MF v240,v12,v240
MF v241,v12,v241
MF v242,v12,v242
MF v243,v12,v243
MF v244,v13,v244
MF v245,v13,v245
MF v246,v13,v246
MF v247,v13,v247
MF v248,v12,v248
MF v249,v12,v249
MF v250,v12,v250
MF v251,v12,v251
MF v252,v13,v252
MF v253,v13,v253
MF v254,v13,v254
MF v255,v13,v255
E v18,v100
E v19,v101
E v20,v102
AF v29,v18,v19
C v52,v18,v19
E v21,v103
E v22,v108
AF v29,v20,v29
C v53,v20,v21
E v23,v109
AF v29,v21,v29
E v24,v110
AF v29,v22,v29
C v54,v22,v23
E v25,v111
AF v29,v23,v29
E v18,v116
AF v29,v24,v29
C v55,v24,v25
E v19,v117
AF v29,v25,v29
E v20,v118
AF v29,v18,v29
C v48,v18,v19
E v21,v119
AF v29,v19,v29
E v22,v124
AF v29,v20,v29
C v49,v20,v21
E v23,v125
AF v29,v21,v29
E v24,v126
AF v29,v22,v29
C v50,v22,v23
E v25,v127
AF v29,v23,v29
AF v29,v24,v29
C v51,v24,v25
AF v29,v25,v29
v_sub_f32 v10, v32, v14
v_sub_f32 v11, v36, v15
E v10,v10
E v11,v11
s_nop 0
MF v16,v10,v16
MF v17,v11,v17
G v64,a128
v_and_b32 v65, 0xffff0000, v64
v_lshlrev_b32 v64, 16, v64
MF v64,v10,v64
MF v65,v10,v65
C v64,v64,v65
W a128,v64
G v66,a129
v_and_b32 v67, 0xffff0000, v66
v_lshlrev_b32 v66, 16, v66
MF v66,v10,v66
MF v67,v10,v67
C v66,v66,v67
W a129,v66
G v68,a130
v_and_b32 v69, 0xffff0000, v68
v_lshlrev_b32 v68, 16, v68
MF v68,v10,v68
MF v69,v10,v69
C v68,v68,v69
W a130,v68
G v70,a131
v_and_b32 v71, 0xffff0000, v70
v_lshlrev_b32 v70, 16, v70
MF v70,v10,v70
MF v71,v10,v71
C v70,v70,v71
W a131,v70
G v72,a132
v_and_b32 v73, 0xffff0000, v72
v_lshlrev_b32 v72, 16, v72
MF v72,v10,v72
MF v73,v10,v73
C v72,v72,v73
W a132,v72
G v74,a133
v_and_b32 v75, 0xffff0000, v74
v_lshlrev_b32 v74, 16, v74
MF v74,v10,v74
MF v75,v10,v75
C v74,v74,v75
W a133,v74
G v76,a134
v_and_b32 v77, 0xffff0000, v76
v_lshlrev_b32 v76, 16, v76
MF v76,v10,v76
MF v77,v10,v77
C v76,v76,v77
W a134,v76
G v78,a135
v_and_b32 v79, 0xffff0000, v78
v_lshlrev_b32 v78, 16, v78
MF v78,v10,v78
MF v79,v10,v79
C v78,v78,v79
W a135,v78
G v64,a136
v_and_b32 v65, 0xffff0000, v64
v_lshlrev_b32 v64, 16, v64
MF v64,v10,v64
MF v65,v10,v65
C v64,v64,v65
W a136,v64
G v66,a137
v_and_b32 v67, 0xffff0000, v66
v_lshlrev_b32 v66, 16, v66
MF v66,v10,v66
MF v67,v10,v67
C v66,v66,v67
W a137,v66
G v68,a138
v_and_b32 v69, 0xffff0000, v68
v_lshlrev_b32 v68, 16, v68
MF v68,v10,v68
MF v69,v10,v69
C v68,v68,v69
W a138,v68
G v70,a139
v_and_b32 v71, 0xffff0000, v70
v_lshlrev_b32 v70, 16, v70
MF v70,v10,v70
MF v71,v10,v71
C v70,v70,v71
W a139,v70
G v72,a140
v_and_b32 v73, 0xffff0000, v72
v_lshlrev_b32 v72, 16, v72
MF v72,v10,v72
MF v73,v10,v73
C v72,v72,v73
W a140,v72
G v74,a141
v_and_b32 v75, 0xffff0000, v74
v_lshlrev_b32 v74, 16, v74
MF v74,v10,v74
MF v75,v10,v75
C v74,v74,v75
W a141,v74
G v76,a142
v_and_b32 v77, 0xffff0000, v76
v_lshlrev_b32 v76, 16, v76
MF v76,v10,v76
MF v77,v10,v77
C v76,v76,v77
W a142,v76
G v78,a143
v_and_b32 v79, 0xffff0000, v78
v_lshlrev_b32 v78, 16, v78
MF v78,v10,v78
MF v79,v10,v79
C v78,v78,v79
W a143,v78
G v64,a144
v_and_b32 v65, 0xffff0000, v64
v_lshlrev_b32 v64, 16, v64
MF v64,v10,v64
MF v65,v10,v65
C v64,v64,v65
W a144,v64
G v66,a145
v_and_b32 v67, 0xffff0000, v66
v_lshlrev_b32 v66, 16, v66
MF v66,v10,v66
MF v67,v10,v67
C v66,v66,v67
W a145,v66
G v68,a146
v_and_b32 v69, 0xffff0000, v68
v_lshlrev_b32 v68, 16, v68
MF v68,v10,v68
MF v69,v10,v69
C v68,v68,v69
W a146,v68
G v70,a147
v_and_b32 v71, 0xffff0000, v70
v_lshlrev_b32 v70, 16, v70
MF v70,v10,v70
MF v71,v10,v71
C v70,v70,v71
W a147,v70
G v72,a148
v_and_b32 v73, 0xffff0000, v72
v_lshlrev_b32 v72, 16, v72
MF v72,v10,v72
MF v73,v10,v73
C v72,v72,v73
W a148,v72
G v74,a149
v_and_b32 v75, 0xffff0000, v74
v_lshlrev_b32 v74, 16, v74
MF v74,v10,v74
MF v75,v10,v75
C v74,v74,v75
W a149,v74
G v76,a150
v_and_b32 v77, 0xffff0000, v76
v_lshlrev_b32 v76, 16, v76
MF v76,v10,v76
MF v77,v10,v77
C v76,v76,v77
W a150,v76
G v78,a151
v_and_b32 v79, 0xffff0000, v78
v_lshlrev_b32 v78, 16, v78
MF v78,v10,v78
MF v79,v10,v79
C v78,v78,v79
W a151,v78
G v64,a152
v_and_b32 v65, 0xffff0000, v64
v_lshlrev_b32 v64, 16, v64
MF v64,v10,v64
MF v65,v10,v65
C v64,v64,v65
W a152,v64
G v66,a153
v_and_b32 v67, 0xffff0000, v66
v_lshlrev_b32 v66, 16, v66
MF v66,v10,v66
MF v67,v10,v67
C v66,v66,v67
W a153,v66
G v68,a154
v_and_b32 v69, 0xffff0000, v68
v_lshlrev_b32 v68, 16, v68
MF v68,v10,v68
MF v69,v10,v69
C v68,v68,v69
W a154,v68
G v70,a155
v_and_b32 v71, 0xffff0000, v70
v_lshlrev_b32 v70, 16, v70
MF v70,v10,v70
MF v71,v10,v71
C v70,v70,v71
W a155,v70
G v72,a156
v_and_b32 v73, 0xffff0000, v72
v_lshlrev_b32 v72, 16, v72
MF v72,v10,v72
MF v73,v10,v73
C v72,v72,v73
W a156,v72
G v74,a157
v_and_b32 v75, 0xffff0000, v74
v_lshlrev_b32 v74, 16, v74
MF v74,v10,v74
MF v75,v10,v75
C v74,v74,v75
W a157,v74
G v76,a158
v_and_b32 v77, 0xffff0000, v76
v_lshlrev_b32 v76, 16, v76
MF v76,v10,v76
MF v77,v10,v77
C v76,v76,v77
W a158,v76
G v78,a159
v_and_b32 v79, 0xffff0000, v78
v_lshlrev_b32 v78, 16, v78
MF v78,v10,v78
MF v79,v10,v79
C v78,v78,v79
W a159,v78
G v64,a160
v_and_b32 v65, 0xffff0000, v64
v_lshlrev_b32 v64, 16, v64
MF v64,v11,v64
MF v65,v11,v65
C v64,v64,v65
W a160,v64
G v66,a161
v_and_b32 v67, 0xffff0000, v66
v_lshlrev_b32 v66, 16, v66
MF v66,v11,v66
MF v67,v11,v67
C v66,v66,v67
W a161,v66
G v68,a162
v_and_b32 v69, 0xffff0000, v68
v_lshlrev_b32 v68, 16, v68
MF v68,v11,v68
MF v69,v11,v69
C v68,v68,v69
W a162,v68
G v70,a163
v_and_b32 v71, 0xffff0000, v70
v_lshlrev_b32 v70, 16, v70
MF v70,v11,v70
MF v71,v11,v71
C v70,v70,v71
W a163,v70
G v72,a164
v_and_b32 v73, 0xffff0000, v72
v_lshlrev_b32 v72, 16, v72
MF v72,v11,v72
MF v73,v11,v73
C v72,v72,v73
W a164,v72
G v74,a165
v_and_b32 v75, 0xffff0000, v74
v_lshlrev_b32 v74, 16, v74
MF v74,v11,v74
MF v75,v11,v75
C v74,v74,v75
W a165,v74
G v76,a166
v_and_b32 v77, 0xffff0000, v76
v_lshlrev_b32 v76, 16, v76
MF v76,v11,v76
MF v77,v11,v77
C v76,v76,v77
W a166,v76
G v78,a167
v_and_b32 v79, 0xffff0000, v78
v_lshlrev_b32 v78, 16, v78
MF v78,v11,v78
MF v79,v11,v79
C v78,v78,v79
W a167,v78
G v64,a168
v_and_b32 v65, 0xffff0000, v64
v_lshlrev_b32 v64, 16, v64
MF v64,v11,v64
MF v65,v11,v65
C v64,v64,v65
W a168,v64
G v66,a169
v_and_b32 v67, 0xffff0000, v66
v_lshlrev_b32 v66, 16, v66
MF v66,v11,v66
MF v67,v11,v67
C v66,v66,v67
W a169,v66
G v68,a170
v_and_b32 v69, 0xffff0000, v68
v_lshlrev_b32 v68, 16, v68
MF v68,v11,v68
MF v69,v11,v69
C v68,v68,v69
W a170,v68
G v70,a171
v_and_b32 v71, 0xffff0000, v70
v_lshlrev_b32 v70, 16, v70
MF v70,v11,v70
MF v71,v11,v71
C v70,v70,v71
W a171,v70
G v72,a172
v_and_b32 v73, 0xffff0000, v72
v_lshlrev_b32 v72, 16, v72
MF v72,v11,v72
MF v73,v11,v73
C v72,v72,v73
W a172,v72
G v74,a173
v_and_b32 v75, 0xffff0000, v74
v_lshlrev_b32 v74, 16, v74
MF v74,v11,v74
MF v75,v11,v75
C v74,v74,v75
W a173,v74
G v76,a174
v_and_b32 v77, 0xffff0000, v76
v_lshlrev_b32 v76, 16, v76
MF v76,v11,v76
MF v77,v11,v77
C v76,v76,v77
W a174,v76
G v78,a175
v_and_b32 v79, 0xffff0000, v78
v_lshlrev_b32 v78, 16, v78
MF v78,v11,v78
MF v79,v11,v79
C v78,v78,v79
W a175,v78
G v64,a176
v_and_b32 v65, 0xffff0000, v64
v_lshlrev_b32 v64, 16, v64
MF v64,v11,v64
MF v65,v11,v65
C v64,v64,v65
W a176,v64
G v66,a177
v_and_b32 v67, 0xffff0000, v66
v_lshlrev_b32 v66, 16, v66
MF v66,v11,v66
MF v67,v11,v67
C v66,v66,v67
W a177,v66
G v68,a178
v_and_b32 v69, 0xffff0000, v68
v_lshlrev_b32 v68, 16, v68
MF v68,v11,v68
MF v69,v11,v69
C v68,v68,v69
W a178,v68
G v70,a179
v_and_b32 v71, 0xffff0000, v70
v_lshlrev_b32 v70, 16, v70
MF v70,v11,v70
MF v71,v11,v71
C v70,v70,v71
W a179,v70
G v72,a180
v_and_b32 v73, 0xffff0000, v72
v_lshlrev_b32 v72, 16, v72
MF v72,v11,v72
MF v73,v11,v73
C v72,v72,v73
W a180,v72
G v74,a181
v_and_b32 v75, 0xffff0000, v74
v_lshlrev_b32 v74, 16, v74
MF v74,v11,v74
MF v75,v11,v75
C v74,v74,v75
W a181,v74
G v76,a182
v_and_b32 v77, 0xffff0000, v76
v_lshlrev_b32 v76, 16, v76
MF v76,v11,v76
MF v77,v11,v77
C v76,v76,v77
W a182,v76
G v78,a183
v_and_b32 v79, 0xffff0000, v78
v_lshlrev_b32 v78, 16, v78
MF v78,v11,v78
MF v79,v11,v79
C v78,v78,v79
W a183,v78
G v64,a184
v_and_b32 v65, 0xffff0000, v64
v_lshlrev_b32 v64, 16, v64
MF v64,v11,v64
MF v65,v11,v65
C v64,v64,v65
W a184,v64
G v66,a185
v_and_b32 v67, 0xffff0000, v66
v_lshlrev_b32 v66, 16, v66
MF v66,v11,v66
MF v67,v11,v67
C v66,v66,v67
W a185,v66
G v68,a186
v_and_b32 v69, 0xffff0000, v68
v_lshlrev_b32 v68, 16, v68
MF v68,v11,v68
MF v69,v11,v69
C v68,v68,v69
W a186,v68
G v70,a187
v_and_b32 v71, 0xffff0000, v70
v_lshlrev_b32 v70, 16, v70
MF v70,v11,v70
MF v71,v11,v71
C v70,v70,v71
W a187,v70
G v72,a188
v_and_b32 v73, 0xffff0000, v72
v_lshlrev_b32 v72, 16, v72
MF v72,v11,v72
MF v73,v11,v73
C v72,v72,v73
W a188,v72
G v74,a189
v_and_b32 v75, 0xffff0000, v74
v_lshlrev_b32 v74, 16, v74
MF v74,v11,v74
MF v75,v11,v75
C v74,v74,v75
W a189,v74
G v76,a190
v_and_b32 v77, 0xffff0000, v76
v_lshlrev_b32 v76, 16, v76
MF v76,v11,v76
MF v77,v11,v77
C v76,v76,v77
W a190,v76
G v78,a191
v_and_b32 v79, 0xffff0000, v78
v_lshlrev_b32 v78, 16, v78
MF v78,v11,v78
MF v79,v11,v79
C v78,v78,v79
W a191,v78
s_nop 3
s_setpc_b64 s[36:37]
L_zs0:
s_mov_b32 s64, 65536
L_zs0_l:
s_sleep 2
buffer_load_dword v17, v16, s[12:15], 0 offen sc1
s_sub_u32 s64, s64, 1
s_cbranch_scc1 L_zs0_x
s_waitcnt vmcnt(0)
v_cmp_ne_u32 vcc, 1, v17
s_nop 0
s_cbranch_vccnz L_zs0_l
L_zs0_x:
s_waitcnt vmcnt(0)
s_branch L_zr0
L_zs1:
s_mov_b32 s64, 65536
L_zs1_l:
s_sleep 2
buffer_load_dword v17, v16, s[12:15], 0 offen sc1
s_sub_u32 s64, s64, 1
s_cbranch_scc1 L_zs1_x
s_waitcnt vmcnt(0)
v_cmp_ne_u32 vcc, 1, v17
s_nop 0
s_cbranch_vccnz L_zs1_l
L_zs1_x:
s_waitcnt vmcnt(0)
s_branch L_zr1
L_hs:
s_mov_b32 s91, 65536
L_hs_l:
buffer_load_dwordx4 v[16:19], v7, s[8:11], s67 offen offset:0 sc1
buffer_load_dwordx4 v[20:23], v7, s[8:11], s67 offen offset:1024 sc1
s_waitcnt vmcnt(0)
s_sub_u32 s91, s91, 1
s_cbranch_scc1 L_hr
v_min3_u32 v28, v16, v17, v18
v_min3_u32 v28, v28, v19, v20
v_min3_u32 v28, v28, v21, v22
v_min_u32 v28, v28, v23
v_cmp_eq_u32 vcc, 0, v28
s_nop 0
s_cbranch_vccnz L_hs_l
s_branch L_hr
L_lsj0:
s_mov_b32 s91, 65536
L_lsj0_l:
s_sleep 2
buffer_load_dword v5, v17, s[8:11], s46 offen sc1
s_sub_u32 s91, s91, 1
s_cbranch_scc1 L_lsj0_x
s_waitcnt vmcnt(0)
v_cmp_gt_u32 vcc, 2, v5
s_nop 0
s_cbranch_vccnz L_lsj0_l
L_lsj0_x:
s_waitcnt vmcnt(0)
s_branch L_lrj0
L_lsh2:
s_mov_b32 s91, 65536
L_lsh2_l:
s_sleep 2
buffer_load_dword v5, v17, s[8:11], s46 offen sc1
s_sub_u32 s91, s91, 1
s_cbranch_scc1 L_lsh2_x
s_waitcnt vmcnt(0)
v_cmp_gt_u32 vcc, 2, v5
s_nop 0
s_cbranch_vccnz L_lsh2_l
L_lsh2_x:
s_waitcnt vmcnt(0)
s_branch L_lrh2
L_lsh4:
s_mov_b32 s91, 65536
L_lsh4_l:
s_sleep 2
buffer_load_dword v5, v9, s[8:11], s46 offen sc1
s_sub_u32 s91, s91, 1
s_cbranch_scc1 L_lsh4_x
s_waitcnt vmcnt(0)
v_cmp_gt_u32 vcc, s84, v5
s_nop 0
s_cbranch_vccnz L_lsh4_l
L_lsh4_x:
s_waitcnt vmcnt(0)
s_branch L_lrh4
L_wsq0:
s_mov_b32 s91, 65536
L_wsq0_l:
s_sleep 2
buffer_load_dword v5, v31, s[8:11], s46 offen offset:4 sc1
s_sub_u32 s91, s91, 1
s_cbranch_scc1 L_wsq0_x
s_waitcnt vmcnt(0)
v_cmp_ne_u32 vcc, 1, v5
s_nop 0
s_mov_b32 vcc_hi, 0
s_cbranch_vccnz L_wsq0_l
L_wsq0_x:
s_waitcnt vmcnt(0)
s_branch L_wrq0
L_wsr0:
s_mov_b32 s91, 65536
L_wsr0_l:
s_sleep 2
buffer_load_dword v5, v31, s[8:11], s46 offen offset:4 sc1
s_sub_u32 s91, s91, 1
s_cbranch_scc1 L_wsr0_x
s_waitcnt vmcnt(0)
v_cmp_ne_u32 vcc, 1, v5
s_nop 0
s_mov_b32 vcc_lo, 0
s_cbranch_vccnz L_wsr0_l
L_wsr0_x:
s_waitcnt vmcnt(0)
s_branch L_wrr0
L_wsq1:
s_mov_b32 s91, 65536
L_wsq1_l:
s_sleep 2
buffer_load_dword v5, v31, s[8:11], s46 offen offset:4 sc1
s_sub_u32 s91, s91, 1
s_cbranch_scc1 L_wsq1_x
s_waitcnt vmcnt(0)
v_cmp_ne_u32 vcc, 1, v5
s_nop 0
s_mov_b32 vcc_hi, 0
s_cbranch_vccnz L_wsq1_l
L_wsq1_x:
s_waitcnt vmcnt(0)
s_branch L_wrq1
L_wsr1:
s_mov_b32 s91, 65536
L_wsr1_l:
s_sleep 2
buffer_load_dword v5, v31, s[8:11], s46 offen offset:4 sc1
s_sub_u32 s91, s91, 1
s_cbranch_scc1 L_wsr1_x
s_waitcnt vmcnt(0)
v_cmp_ne_u32 vcc, 1, v5
s_nop 0
s_mov_b32 vcc_lo, 0
s_cbranch_vccnz L_wsr1_l
L_wsr1_x:
s_waitcnt vmcnt(0)
s_branch L_wrr1
L_fll:
s_cmp_eq_u32 s42, 8
s_cbranch_scc1 L_fl8
L_fl0:
s_cmp_lg_u32 s20, 0
s_cbranch_scc1 L_fl3
s_lshr_b32 s64, s42, 3
s_cmp_eq_u32 s7, s64
s_cbranch_scc0 L_fl1
v_mov_b32 v15, 4
buffer_store_dword v15, v1, s[8:11], s45 offen sc1
L_fl1:
s_cmp_lt_u32 s7, s40
s_cbranch_scc1 L_fllr
s_cmp_eq_u32 s7, s40
s_cselect_b32 s64, 0x380, -1
v_min_u32 v17, s64, v9
s_mov_b32 s6, 4
buffer_load_dword v5, v17, s[8:11], s46 offen sc1
s_branch L_fllr
L_fl8:
s_mul_i32 s64, s20, 57344
s_sub_u32 s65, s7, 1
s_lshl_b32 s65, s65, 14
SA s64,s64,s65
SA s65,s64,8192
v_lshlrev_b32 v11, 3, v7
s_bitcmp1_b32 0, s7
s_cbranch_scc0 L_fl0
buffer_load_dword a240, v11, s[12:15], s64 offen offset:0
s_waitcnt vmcnt(0)
buffer_load_dword a240, v11, s[12:15], s65 offen offset:0
s_cmp_gt_u32 s7, 2
s_cbranch_scc1 L_fllr
s_cmp_lg_u32 s20, 0
s_cbranch_scc1 L_fllr
s_branch L_fl0
L_fl3:
s_cmp_eq_u32 s7, 1
s_cbranch_scc1 L_y2
s_cmp_eq_u32 s7, 2
s_cbranch_scc1 L_y3
s_cmp_eq_u32 s7, 3
s_cbranch_scc1 L_y4
s_branch L_y5
s_waitcnt vmcnt(0)
L_fps:
s_cmp_lg_u32 s35, 0
s_cbranch_scc1 L_fpr
L_fps2:
s_mov_b32 s91, 65536
L_fps2_l:
s_sleep 2
buffer_load_dword v6, off, s[8:11], s47 sc1
s_sub_u32 s91, s91, 1
s_cbranch_scc1 L_fps2_x
s_waitcnt vmcnt(0)
v_cmp_ne_u32 vcc, 1, v6
s_nop 0
s_cbranch_vccnz L_fps2_l
L_fps2_x:
s_waitcnt vmcnt(0)
s_branch L_fpr
L_fqs:
s_mov_b32 s91, 65536
L_fqs_l:
s_sleep 2
buffer_load_dword v6, off, s[8:11], s47 offset:16 sc1
s_sub_u32 s91, s91, 1
s_cbranch_scc1 L_fqs_x
s_waitcnt vmcnt(0)
v_cmp_ne_u32 vcc, 1, v6
s_nop 0
s_cbranch_vccnz L_fqs_l
L_fqs_x:
s_waitcnt vmcnt(0)
s_branch L_fqr
L_fls0:
s_mov_b32 s91, 65536
L_fls0_l:
s_sleep 2
buffer_load_dword v5, v17, s[8:11], s46 offen sc1
s_sub_u32 s91, s91, 1
s_cbranch_scc1 L_fls0_x
s_waitcnt vmcnt(0)
v_cmp_gt_u32 vcc, s6, v5
s_nop 0
s_cbranch_vccnz L_fls0_l
L_fls0_x:
s_waitcnt vmcnt(0)
s_branch L_flr0
L_y2:
v_lshrrev_b32 v11, 7, v7
v_mul_u32_u24 v11, 4352, v11
v_and_b32 v12, 0x70, v7
v_lshl_add_u32 v11, v12, 3, v11
s_mov_b32 s64, 104923136
s_mov_b32 s65, 104957952
buffer_load_dword a128, v11, s[8:11], s64 offen sc1
buffer_load_dword a129, v11, s[8:11], s65 offen sc1
s_branch L_fllr
s_waitcnt vmcnt(0)
L_y3:
s_mov_b32 s91, 65536
L_y3c:
G v12,a128
G v13,a129
v_min_u32 v12, v12, v13
v_cmp_gt_u32 vcc, 2, v12
s_sub_u32 s91, s91, 1
s_cbranch_scc1 L_y3x
s_cbranch_vccz L_y3x
v_lshrrev_b32 v11, 7, v7
v_mul_u32_u24 v11, 4352, v11
v_and_b32 v12, 0x70, v7
v_lshl_add_u32 v11, v12, 3, v11
s_mov_b32 s64, 104923136
s_mov_b32 s65, 104957952
buffer_load_dword a128, v11, s[8:11], s64 offen sc1
buffer_load_dword a129, v11, s[8:11], s65 offen sc1
s_waitcnt vmcnt(0)
s_branch L_y3c
L_y3x:
s_lshl_b32 s66, s41, 1
SA s66,s66,s20
s_sub_u32 s66, s66, 2
s_cmp_lt_u32 s66, 14
s_cselect_b32 s64, 8, 12
SA s64,s64,104890368
buffer_load_dword a130, off, s[8:11], s64 sc1
v_lshrrev_b32 v11, 7, v7
v_mul_u32_u24 v11, 3584, v11
v_and_b32 v12, 0x70, v7
v_add_u32 v11, v12, v11
s_lshl_b32 s65, s66, 7
SA s65,s65,105906176
buffer_load_dwordx4 a[132:135], v11, s[8:11], s65 offen sc1
SA s65,s65,28672
buffer_load_dwordx4 a[136:139], v11, s[8:11], s65 offen sc1
SA s65,s65,28672
buffer_load_dwordx4 a[140:143], v11, s[8:11], s65 offen sc1
SA s65,s65,28672
buffer_load_dwordx4 a[144:147], v11, s[8:11], s65 offen sc1
SA s65,s65,28672
buffer_load_dwordx4 a[148:151], v11, s[8:11], s65 offen sc1
SA s65,s65,28672
buffer_load_dwordx4 a[152:155], v11, s[8:11], s65 offen sc1
SA s65,s65,28672
buffer_load_dwordx4 a[156:159], v11, s[8:11], s65 offen sc1
SA s65,s65,28672
buffer_load_dwordx4 a[160:163], v11, s[8:11], s65 offen sc1
SA s65,s65,28672
buffer_load_dwordx4 a[164:167], v11, s[8:11], s65 offen sc1
SA s65,s65,28672
buffer_load_dwordx4 a[168:171], v11, s[8:11], s65 offen sc1
SA s65,s65,28672
buffer_load_dwordx4 a[172:175], v11, s[8:11], s65 offen sc1
SA s65,s65,28672
buffer_load_dwordx4 a[176:179], v11, s[8:11], s65 offen sc1
SA s65,s65,28672
buffer_load_dwordx4 a[180:183], v11, s[8:11], s65 offen sc1
SA s65,s65,28672
buffer_load_dwordx4 a[184:187], v11, s[8:11], s65 offen sc1
SA s65,s65,28672
s_branch L_fllr
s_waitcnt vmcnt(0)
L_y4:
G v12,a132
G v13,a133
G v14,a134
G v15,a135
G v16,a136
G v17,a137
AF v12,v16,v12
AF v13,v17,v13
G v16,a138
G v17,a139
AF v14,v16,v14
AF v15,v17,v15
G v16,a140
G v17,a141
AF v12,v16,v12
AF v13,v17,v13
G v16,a142
G v17,a143
AF v14,v16,v14
AF v15,v17,v15
G v16,a144
G v17,a145
AF v12,v16,v12
AF v13,v17,v13
G v16,a146
G v17,a147
AF v14,v16,v14
AF v15,v17,v15
G v16,a148
G v17,a149
AF v12,v16,v12
AF v13,v17,v13
G v16,a150
G v17,a151
AF v14,v16,v14
AF v15,v17,v15
G v16,a152
G v17,a153
AF v12,v16,v12
AF v13,v17,v13
G v16,a154
G v17,a155
AF v14,v16,v14
AF v15,v17,v15
G v16,a156
G v17,a157
AF v12,v16,v12
AF v13,v17,v13
G v16,a158
G v17,a159
AF v14,v16,v14
AF v15,v17,v15
G v16,a160
G v17,a161
AF v12,v16,v12
AF v13,v17,v13
G v16,a162
G v17,a163
AF v14,v16,v14
AF v15,v17,v15
G v16,a164
G v17,a165
AF v12,v16,v12
AF v13,v17,v13
G v16,a166
G v17,a167
AF v14,v16,v14
AF v15,v17,v15
G v16,a168
G v17,a169
AF v12,v16,v12
AF v13,v17,v13
G v16,a170
G v17,a171
AF v14,v16,v14
AF v15,v17,v15
G v16,a172
G v17,a173
AF v12,v16,v12
AF v13,v17,v13
G v16,a174
G v17,a175
AF v14,v16,v14
AF v15,v17,v15
G v16,a176
G v17,a177
AF v12,v16,v12
AF v13,v17,v13
G v16,a178
G v17,a179
AF v14,v16,v14
AF v15,v17,v15
G v16,a180
G v17,a181
AF v12,v16,v12
AF v13,v17,v13
G v16,a182
G v17,a183
AF v14,v16,v14
AF v15,v17,v15
G v16,a184
G v17,a185
AF v12,v16,v12
AF v13,v17,v13
G v16,a186
G v17,a187
AF v14,v16,v14
AF v15,v17,v15
v_add_f32 v12, v12, v12 row_ror:8 row_mask:0xf bank_mask:0xf
v_add_f32 v13, v13, v13 row_ror:8 row_mask:0xf bank_mask:0xf
v_add_f32 v14, v14, v14 row_ror:8 row_mask:0xf bank_mask:0xf
v_add_f32 v15, v15, v15 row_ror:8 row_mask:0xf bank_mask:0xf
v_mov_b32 v11, v12
s_nop 1
v_permlane16_swap_b32 v11, v12
AF v12,v11,v12
v_mov_b32 v11, v13
s_nop 1
v_permlane16_swap_b32 v11, v13
AF v13,v11,v13
v_mov_b32 v11, v14
s_nop 1
v_permlane16_swap_b32 v11, v14
AF v14,v11,v14
v_mov_b32 v11, v15
s_nop 1
v_permlane16_swap_b32 v11, v15
AF v15,v11,v15
v_mov_b32 v11, v12
s_nop 1
v_permlane32_swap_b32 v11, v12
AF v12,v11,v12
v_mov_b32 v11, v13
s_nop 1
v_permlane32_swap_b32 v11, v13
AF v13,v11,v13
v_mov_b32 v11, v14
s_nop 1
v_permlane32_swap_b32 v11, v14
AF v14,v11,v14
v_mov_b32 v11, v15
s_nop 1
v_permlane32_swap_b32 v11, v15
AF v15,v11,v15
G v16,a130
C v11,v12,v13
v_lshlrev_b32 v12, 16, v11
v_and_b32 v13, 0xffff0000, v11
C v11,v14,v15
v_lshlrev_b32 v14, 16, v11
v_and_b32 v15, 0xffff0000, v11
MF v12,v16,v12
MF v13,v16,v13
MF v14,v16,v14
MF v15,v16,v15
C v11,v12,v13
v_lshlrev_b32 v12, 16, v11
v_and_b32 v13, 0xffff0000, v11
C v11,v14,v15
v_lshlrev_b32 v14, 16, v11
v_and_b32 v15, 0xffff0000, v11
s_lshl_b32 s66, s41, 1
SA s66,s66,s20
s_sub_u32 s66, s66, 2
s_lshl_b32 s65, s66, 7
SA s65,s65,104898560
s_mov_b64 exec, 0xff
buffer_store_dwordx4 v[12:15], v7, s[8:11], s65 offen sc1
s_mov_b64 exec, -1
s_nop 1
s_branch L_fllr
L_y5:
s_lshl_b32 s66, s41, 1
SA s66,s66,s20
s_sub_u32 s66, s66, 2
s_lshl_b32 s66, s66, 2
SA s66,s66,105062912
v_mov_b32 v11, 1
s_mov_b64 exec, 1
buffer_store_dword v11, off, s[8:11], s66 sc1
s_mov_b64 exec, -1
s_branch L_fllr
.p2align 12
L_loop_top:
M v[64:67],a[64:67],a[0:3],v[32:35]
SA m0,s28,0
R a[96:99],v2,40960
M v[64:67],a[68:71],a[4:7],v[64:67]
buffer_load_dword a240, v0, s[60:63], 0 offen offset:0
M v[64:67],a[72:75],a[8:11],v[64:67]
R a[100:103],v2,41984
M v[64:67],a[76:79],a[12:15],v[64:67]
s_waitcnt lgkmcnt(2)
buffer_load_dwordx4 v3, s[8:11], s26 offen offset:0 sc1 lds
M v[64:67],a[80:83],a[16:19],v[64:67]
R a[104:107],v2,43008
M v[64:67],a[84:87],a[20:23],v[64:67]
E v18,v112
M v[64:67],a[88:91],a[24:27],v[64:67]
R a[108:111],v2,44032
M v[64:67],a[92:95],a[28:31],v[64:67]
buffer_load_dwordx4 v3, s[8:11], s26 offen offset:1024 sc1 lds
M v[68:71],a[92:95],a[60:63],v[36:39]
R a[112:115],v2,45056
M v[68:71],a[88:91],a[56:59],v[68:71]
E v19,v113
M v[68:71],a[84:87],a[52:55],v[68:71]
R a[116:119],v2,46080
AF v28,v18,v28
M v[68:71],a[80:83],a[48:51],v[68:71]
E v20,v114
M v[68:71],a[76:79],a[44:47],v[68:71]
R a[120:123],v2,47104
C v56,v18,v19
M v[68:71],a[72:75],a[40:43],v[68:71]
buffer_load_dwordx4 v3, s[8:11], s26 offen offset:2048 sc1 lds
M v[68:71],a[68:71],a[36:39],v[68:71]
R a[124:127],v2,48128
AF v28,v19,v28
M v[68:71],a[64:67],a[32:35],v[68:71]
s_waitcnt lgkmcnt(4)
E v21,v115
M v[72:75],a[96:99],a[0:3],v[32:35]
R a[64:67],v2,49152
AF v28,v20,v28
M v[72:75],a[100:103],a[4:7],v[72:75]
buffer_load_dwordx4 v3, s[8:11], s26 offen offset:3072 sc1 lds
M v[72:75],a[104:107],a[8:11],v[72:75]
R a[68:71],v2,50176
C v57,v20,v21
M v[72:75],a[108:111],a[12:15],v[72:75]
s_waitcnt lgkmcnt(2)
E v22,v120
M v[72:75],a[112:115],a[16:19],v[72:75]
R a[72:75],v2,51200
AF v28,v21,v28
M v[72:75],a[116:119],a[20:23],v[72:75]
E v23,v121
M v[72:75],a[120:123],a[24:27],v[72:75]
SA m0,s28,4096
R a[76:79],v2,52224
AF v28,v22,v28
M v[72:75],a[124:127],a[28:31],v[72:75]
buffer_load_dwordx4 v4, s[8:11], s26 offen offset:0 sc1 lds
M v[76:79],a[124:127],a[60:63],v[36:39]
R a[80:83],v2,53248
C v58,v22,v23
M v[76:79],a[120:123],a[56:59],v[76:79]
E v24,v122
M v[76:79],a[116:119],a[52:55],v[76:79]
R a[84:87],v2,54272
AF v28,v23,v28
M v[76:79],a[112:115],a[48:51],v[76:79]
E v25,v123
M v[76:79],a[108:111],a[44:47],v[76:79]
R a[88:91],v2,55296
AF v28,v24,v28
M v[76:79],a[104:107],a[40:43],v[76:79]
buffer_load_dwordx4 v4, s[8:11], s26 offen offset:1024 sc1 lds
M v[76:79],a[100:103],a[36:39],v[76:79]
R a[92:95],v2,56320
C v59,v24,v25
M v[76:79],a[96:99],a[32:35],v[76:79]
s_waitcnt lgkmcnt(4)
E v18,v116
M v[80:83],a[64:67],a[0:3],v[32:35]
R a[96:99],v2,57344
AF v28,v25,v28
M v[80:83],a[68:71],a[4:7],v[80:83]
R a[100:103],v2,58368
M v[80:83],a[72:75],a[8:11],v[80:83]
buffer_load_dwordx4 v4, s[8:11], s26 offen offset:2048 sc1 lds
M v[80:83],a[76:79],a[12:15],v[80:83]
s_waitcnt lgkmcnt(2)
R a[104:107],v2,59392
M v[80:83],a[80:83],a[16:19],v[80:83]
R a[108:111],v2,60416
M v[80:83],a[84:87],a[20:23],v[80:83]
E v19,v117
M v[80:83],a[88:91],a[24:27],v[80:83]
R a[112:115],v2,61440
AF v29,v18,v29
M v[80:83],a[92:95],a[28:31],v[80:83]
R a[116:119],v2,62464
C v60,v18,v19
M v[84:87],a[92:95],a[60:63],v[36:39]
buffer_load_dwordx4 v4, s[8:11], s26 offen offset:3072 sc1 lds
M v[84:87],a[88:91],a[56:59],v[84:87]
SA s26,s26,32768
R a[120:123],v2,63488
AF v29,v19,v29
M v[84:87],a[84:87],a[52:55],v[84:87]
R a[124:127],v2,64512
M v[84:87],a[80:83],a[48:51],v[84:87]
E v20,v118
M v[84:87],a[76:79],a[44:47],v[84:87]
E v21,v119
M v[84:87],a[72:75],a[40:43],v[84:87]
E v22,v124
M v[84:87],a[68:71],a[36:39],v[84:87]
s_waitcnt vmcnt(17) lgkmcnt(0)
E v23,v125
M v[84:87],a[64:67],a[32:35],v[84:87]
s_barrier
M v[88:91],a[96:99],a[0:3],v[32:35]
R a[64:67],v7,32768
AF v29,v20,v29
M v[88:91],a[100:103],a[4:7],v[88:91]
E v24,v126
M v[88:91],a[104:107],a[8:11],v[88:91]
R a[68:71],v7,33792
C v61,v20,v21
M v[88:91],a[108:111],a[12:15],v[88:91]
AF v29,v21,v29
AF v29,v22,v29
M v[88:91],a[112:115],a[16:19],v[88:91]
R a[72:75],v7,34816
C v62,v22,v23
M v[88:91],a[116:119],a[20:23],v[88:91]
E v25,v127
M v[88:91],a[120:123],a[24:27],v[88:91]
R a[76:79],v7,35840
AF v29,v23,v29
M v[88:91],a[124:127],a[28:31],v[88:91]
AF v29,v24,v29
C v63,v24,v25
M v[92:95],a[124:127],a[60:63],v[36:39]
R a[80:83],v7,36864
AF v29,v25,v29
M v[92:95],a[120:123],a[56:59],v[92:95]
M v[92:95],a[116:119],a[52:55],v[92:95]
R a[84:87],v7,37888
v_max_f32 v10, v28, v29
M v[92:95],a[112:115],a[48:51],v[92:95]
v_cmp_lt_f32 vcc, s31, v10
M v[92:95],a[108:111],a[44:47],v[92:95]
R a[88:91],v7,38912
M v[92:95],a[104:107],a[40:43],v[92:95]
M v[92:95],a[100:103],a[36:39],v[92:95]
s_waitcnt lgkmcnt(3)
R a[92:95],v7,39936
M v[92:95],a[96:99],a[32:35],v[92:95]
s_cbranch_vccnz L_st1
L_rt1:
M v[128:131],a[64:67],v[48:51],v[128:131]
SA m0,s28,98304
R a[96:99],v7,40960
AF v30,v28,v30
M v[128:131],a[68:71],v[56:59],v[128:131]
buffer_load_dwordx4 v3, s[8:11], s21 offen offset:0 sc1 lds
M v[132:135],a[68:71],v[60:63],v[132:135]
R a[100:103],v7,41984
AF v31,v29,v31
M v[132:135],a[64:67],v[52:55],v[132:135]
s_waitcnt lgkmcnt(2)
E v18,v64
M v[136:139],a[72:75],v[48:51],v[136:139]
R a[104:107],v7,43008
M v[136:139],a[76:79],v[56:59],v[136:139]
buffer_load_dwordx4 v3, s[8:11], s21 offen offset:1024 sc1 lds
M v[140:143],a[76:79],v[60:63],v[140:143]
R a[108:111],v7,44032
M v[140:143],a[72:75],v[52:55],v[140:143]
E v19,v65
M v[144:147],a[80:83],v[48:51],v[144:147]
R a[112:115],v7,45056
AF v26,v18,v19
M v[144:147],a[84:87],v[56:59],v[144:147]
E v20,v66
M v[148:151],a[84:87],v[60:63],v[148:151]
R a[116:119],v7,46080
C v40,v18,v19
M v[148:151],a[80:83],v[52:55],v[148:151]
buffer_load_dwordx4 v3, s[8:11], s21 offen offset:2048 sc1 lds
M v[152:155],a[88:91],v[48:51],v[152:155]
R a[120:123],v7,47104
M v[152:155],a[92:95],v[56:59],v[152:155]
E v21,v67
M v[156:159],a[92:95],v[60:63],v[156:159]
R a[124:127],v7,48128
AF v26,v20,v26
M v[156:159],a[88:91],v[52:55],v[156:159]
s_waitcnt lgkmcnt(4)
buffer_load_dwordx4 v3, s[8:11], s21 offen offset:3072 sc1 lds
M v[160:163],a[96:99],v[48:51],v[160:163]
R a[64:67],v7,49152
C v41,v20,v21
M v[160:163],a[100:103],v[56:59],v[160:163]
E v22,v72
M v[164:167],a[100:103],v[60:63],v[164:167]
SA m0,s28,102400
R a[68:71],v7,50176
AF v26,v21,v26
M v[164:167],a[96:99],v[52:55],v[164:167]
s_waitcnt lgkmcnt(2)
buffer_load_dwordx4 v4, s[8:11], s21 offen offset:0 sc1 lds
M v[168:171],a[104:107],v[48:51],v[168:171]
R a[72:75],v7,51200
M v[168:171],a[108:111],v[56:59],v[168:171]
E v23,v73
M v[172:175],a[108:111],v[60:63],v[172:175]
R a[76:79],v7,52224
AF v26,v22,v26
M v[172:175],a[104:107],v[52:55],v[172:175]
E v24,v74
M v[176:179],a[112:115],v[48:51],v[176:179]
R a[80:83],v7,53248
C v42,v22,v23
M v[176:179],a[116:119],v[56:59],v[176:179]
buffer_load_dwordx4 v4, s[8:11], s21 offen offset:1024 sc1 lds
M v[180:183],a[116:119],v[60:63],v[180:183]
R a[84:87],v7,54272
AF v26,v23,v26
M v[180:183],a[112:115],v[52:55],v[180:183]
E v25,v75
M v[184:187],a[120:123],v[48:51],v[184:187]
R a[88:91],v7,55296
AF v26,v24,v26
M v[184:187],a[124:127],v[56:59],v[184:187]
buffer_load_dwordx4 v4, s[8:11], s21 offen offset:2048 sc1 lds
M v[188:191],a[124:127],v[60:63],v[188:191]
R a[92:95],v7,56320
C v43,v24,v25
M v[188:191],a[120:123],v[52:55],v[188:191]
s_waitcnt lgkmcnt(4)
E v18,v68
M v[192:195],a[64:67],v[48:51],v[192:195]
R a[96:99],v7,57344
AF v26,v25,v26
M v[192:195],a[68:71],v[56:59],v[192:195]
R a[100:103],v7,58368
M v[196:199],a[68:71],v[60:63],v[196:199]
buffer_load_dwordx4 v4, s[8:11], s21 offen offset:3072 sc1 lds
M v[196:199],a[64:67],v[52:55],v[196:199]
s_waitcnt lgkmcnt(2)
R a[104:107],v7,59392
M v[200:203],a[72:75],v[48:51],v[200:203]
SA s21,s21,32768
R a[108:111],v7,60416
M v[200:203],a[76:79],v[56:59],v[200:203]
s_sub_u32 s22, s22, 1
E v19,v69
M v[204:207],a[76:79],v[60:63],v[204:207]
s_cselect_b32 s21, s23, s21
R a[112:115],v7,61440
AF v27,v18,v19
M v[204:207],a[72:75],v[52:55],v[204:207]
R a[116:119],v7,62464
C v44,v18,v19
M v[208:211],a[80:83],v[48:51],v[208:211]
E v20,v70
M v[208:211],a[84:87],v[56:59],v[208:211]
R a[120:123],v7,63488
M v[212:215],a[84:87],v[60:63],v[212:215]
R a[124:127],v7,64512
M v[212:215],a[80:83],v[52:55],v[212:215]
E v21,v71
M v[216:219],a[88:91],v[48:51],v[216:219]
E v22,v76
M v[216:219],a[92:95],v[56:59],v[216:219]
AF v27,v20,v27
C v45,v20,v21
M v[220:223],a[92:95],v[60:63],v[220:223]
s_waitcnt vmcnt(17) lgkmcnt(0)
AF v27,v21,v27
M v[220:223],a[88:91],v[52:55],v[220:223]
s_barrier
M v[224:227],a[96:99],v[48:51],v[224:227]
R a[64:67],v2,0
M v[224:227],a[100:103],v[56:59],v[224:227]
E v23,v77
M v[228:231],a[100:103],v[60:63],v[228:231]
R a[68:71],v2,1024
AF v27,v22,v27
M v[228:231],a[96:99],v[52:55],v[228:231]
E v24,v78
M v[232:235],a[104:107],v[48:51],v[232:235]
R a[72:75],v2,2048
C v46,v22,v23
M v[232:235],a[108:111],v[56:59],v[232:235]
AF v27,v23,v27
M v[236:239],a[108:111],v[60:63],v[236:239]
R a[76:79],v2,3072
M v[236:239],a[104:107],v[52:55],v[236:239]
E v25,v79
M v[240:243],a[112:115],v[48:51],v[240:243]
R a[80:83],v2,4096
AF v27,v24,v27
M v[240:243],a[116:119],v[56:59],v[240:243]
C v47,v24,v25
AF v27,v25,v27
M v[244:247],a[116:119],v[60:63],v[244:247]
R a[84:87],v2,5120
M v[244:247],a[112:115],v[52:55],v[244:247]
M v[248:251],a[120:123],v[48:51],v[248:251]
R a[88:91],v2,6144
M v[248:251],a[124:127],v[56:59],v[248:251]
M v[252:255],a[124:127],v[60:63],v[252:255]
s_waitcnt lgkmcnt(3)
R a[92:95],v2,7168
M v[252:255],a[120:123],v[52:55],v[252:255]
M v[96:99],a[64:67],a[0:3],v[32:35]
s_bitcmp1_b32 s39, s7
R a[96:99],v2,8192
M v[96:99],a[68:71],a[4:7],v[96:99]
s_cbranch_scc1 L_fll
L_fllr:
E v18,v80
M v[96:99],a[72:75],a[8:11],v[96:99]
SA m0,s28,32768
R a[100:103],v2,9216
M v[96:99],a[76:79],a[12:15],v[96:99]
s_waitcnt lgkmcnt(2)
buffer_load_dwordx4 v3, s[8:11], s26 offen offset:0 sc1 lds
M v[96:99],a[80:83],a[16:19],v[96:99]
R a[104:107],v2,10240
M v[96:99],a[84:87],a[20:23],v[96:99]
E v19,v81
M v[96:99],a[88:91],a[24:27],v[96:99]
R a[108:111],v2,11264
AF v26,v18,v26
M v[96:99],a[92:95],a[28:31],v[96:99]
E v20,v82
M v[100:103],a[92:95],a[60:63],v[36:39]
R a[112:115],v2,12288
C v56,v18,v19
M v[100:103],a[88:91],a[56:59],v[100:103]
buffer_load_dwordx4 v3, s[8:11], s26 offen offset:1024 sc1 lds
M v[100:103],a[84:87],a[52:55],v[100:103]
R a[116:119],v2,13312
AF v26,v19,v26
M v[100:103],a[80:83],a[48:51],v[100:103]
E v21,v83
M v[100:103],a[76:79],a[44:47],v[100:103]
R a[120:123],v2,14336
AF v26,v20,v26
M v[100:103],a[72:75],a[40:43],v[100:103]
buffer_load_dwordx4 v3, s[8:11], s26 offen offset:2048 sc1 lds
M v[100:103],a[68:71],a[36:39],v[100:103]
R a[124:127],v2,15360
C v57,v20,v21
M v[100:103],a[64:67],a[32:35],v[100:103]
s_waitcnt lgkmcnt(4)
E v22,v88
M v[104:107],a[96:99],a[0:3],v[32:35]
R a[64:67],v2,16384
AF v26,v21,v26
M v[104:107],a[100:103],a[4:7],v[104:107]
E v23,v89
M v[104:107],a[104:107],a[8:11],v[104:107]
R a[68:71],v2,17408
AF v26,v22,v26
M v[104:107],a[108:111],a[12:15],v[104:107]
s_waitcnt lgkmcnt(2)
buffer_load_dwordx4 v3, s[8:11], s26 offen offset:3072 sc1 lds
M v[104:107],a[112:115],a[16:19],v[104:107]
R a[72:75],v2,18432
C v58,v22,v23
M v[104:107],a[116:119],a[20:23],v[104:107]
E v24,v90
M v[104:107],a[120:123],a[24:27],v[104:107]
R a[76:79],v2,19456
AF v26,v23,v26
M v[104:107],a[124:127],a[28:31],v[104:107]
SA m0,s28,36864
M v[108:111],a[124:127],a[60:63],v[36:39]
R a[80:83],v2,20480
M v[108:111],a[120:123],a[56:59],v[108:111]
buffer_load_dwordx4 v4, s[8:11], s26 offen offset:0 sc1 lds
M v[108:111],a[116:119],a[52:55],v[108:111]
R a[84:87],v2,21504
M v[108:111],a[112:115],a[48:51],v[108:111]
E v25,v91
M v[108:111],a[108:111],a[44:47],v[108:111]
R a[88:91],v2,22528
AF v26,v24,v26
M v[108:111],a[104:107],a[40:43],v[108:111]
buffer_load_dwordx4 v4, s[8:11], s26 offen offset:1024 sc1 lds
M v[108:111],a[100:103],a[36:39],v[108:111]
R a[92:95],v2,23552
C v59,v24,v25
M v[108:111],a[96:99],a[32:35],v[108:111]
s_waitcnt lgkmcnt(4)
E v18,v84
M v[112:115],a[64:67],a[0:3],v[32:35]
R a[96:99],v2,24576
AF v26,v25,v26
M v[112:115],a[68:71],a[4:7],v[112:115]
R a[100:103],v2,25600
M v[112:115],a[72:75],a[8:11],v[112:115]
buffer_load_dwordx4 v4, s[8:11], s26 offen offset:2048 sc1 lds
M v[112:115],a[76:79],a[12:15],v[112:115]
s_waitcnt lgkmcnt(2)
R a[104:107],v2,26624
M v[112:115],a[80:83],a[16:19],v[112:115]
R a[108:111],v2,27648
M v[112:115],a[84:87],a[20:23],v[112:115]
E v19,v85
M v[112:115],a[88:91],a[24:27],v[112:115]
R a[112:115],v2,28672
AF v27,v18,v27
M v[112:115],a[92:95],a[28:31],v[112:115]
R a[116:119],v2,29696
C v60,v18,v19
M v[116:119],a[92:95],a[60:63],v[36:39]
buffer_load_dwordx4 v4, s[8:11], s26 offen offset:3072 sc1 lds
M v[116:119],a[88:91],a[56:59],v[116:119]
SA s26,s26,32768
R a[120:123],v2,30720
AF v27,v19,v27
M v[116:119],a[84:87],a[52:55],v[116:119]
R a[124:127],v2,31744
M v[116:119],a[80:83],a[48:51],v[116:119]
E v20,v86
M v[116:119],a[76:79],a[44:47],v[116:119]
E v21,v87
M v[116:119],a[72:75],a[40:43],v[116:119]
E v22,v92
M v[116:119],a[68:71],a[36:39],v[116:119]
s_waitcnt vmcnt(16) lgkmcnt(0)
E v23,v93
M v[116:119],a[64:67],a[32:35],v[116:119]
s_barrier
M v[120:123],a[96:99],a[0:3],v[32:35]
R a[64:67],v7,0
AF v27,v20,v27
M v[120:123],a[100:103],a[4:7],v[120:123]
E v24,v94
M v[120:123],a[104:107],a[8:11],v[120:123]
R a[68:71],v7,1024
C v61,v20,v21
M v[120:123],a[108:111],a[12:15],v[120:123]
AF v27,v21,v27
AF v27,v22,v27
M v[120:123],a[112:115],a[16:19],v[120:123]
R a[72:75],v7,2048
C v62,v22,v23
M v[120:123],a[116:119],a[20:23],v[120:123]
E v25,v95
M v[120:123],a[120:123],a[24:27],v[120:123]
R a[76:79],v7,3072
AF v27,v23,v27
M v[120:123],a[124:127],a[28:31],v[120:123]
AF v27,v24,v27
C v63,v24,v25
M v[124:127],a[124:127],a[60:63],v[36:39]
R a[80:83],v7,4096
AF v27,v25,v27
M v[124:127],a[120:123],a[56:59],v[124:127]
M v[124:127],a[116:119],a[52:55],v[124:127]
R a[84:87],v7,5120
v_max_f32 v10, v26, v27
M v[124:127],a[112:115],a[48:51],v[124:127]
v_cmp_lt_f32 vcc, s31, v10
M v[124:127],a[108:111],a[44:47],v[124:127]
R a[88:91],v7,6144
M v[124:127],a[104:107],a[40:43],v[124:127]
M v[124:127],a[100:103],a[36:39],v[124:127]
s_waitcnt lgkmcnt(3)
R a[92:95],v7,7168
M v[124:127],a[96:99],a[32:35],v[124:127]
s_cbranch_vccnz L_st0
L_rt0:
M v[128:131],a[64:67],v[40:43],v[128:131]
SA m0,s28,65536
R a[96:99],v7,8192
AF v30,v26,v30
M v[128:131],a[68:71],v[56:59],v[128:131]
buffer_load_dwordx4 v3, s[8:11], s21 offen offset:0 sc1 lds
M v[132:135],a[68:71],v[60:63],v[132:135]
R a[100:103],v7,9216
AF v31,v27,v31
M v[132:135],a[64:67],v[44:47],v[132:135]
s_waitcnt lgkmcnt(2)
E v18,v96
M v[136:139],a[72:75],v[40:43],v[136:139]
R a[104:107],v7,10240
M v[136:139],a[76:79],v[56:59],v[136:139]
buffer_load_dwordx4 v3, s[8:11], s21 offen offset:1024 sc1 lds
M v[140:143],a[76:79],v[60:63],v[140:143]
R a[108:111],v7,11264
M v[140:143],a[72:75],v[44:47],v[140:143]
E v19,v97
M v[144:147],a[80:83],v[40:43],v[144:147]
R a[112:115],v7,12288
AF v28,v18,v19
M v[144:147],a[84:87],v[56:59],v[144:147]
E v20,v98
M v[148:151],a[84:87],v[60:63],v[148:151]
R a[116:119],v7,13312
C v48,v18,v19
M v[148:151],a[80:83],v[44:47],v[148:151]
buffer_load_dwordx4 v3, s[8:11], s21 offen offset:2048 sc1 lds
M v[152:155],a[88:91],v[40:43],v[152:155]
R a[120:123],v7,14336
M v[152:155],a[92:95],v[56:59],v[152:155]
E v21,v99
M v[156:159],a[92:95],v[60:63],v[156:159]
R a[124:127],v7,15360
AF v28,v20,v28
M v[156:159],a[88:91],v[44:47],v[156:159]
s_waitcnt lgkmcnt(4)
buffer_load_dwordx4 v3, s[8:11], s21 offen offset:3072 sc1 lds
M v[160:163],a[96:99],v[40:43],v[160:163]
R a[64:67],v7,16384
C v49,v20,v21
M v[160:163],a[100:103],v[56:59],v[160:163]
E v22,v104
M v[164:167],a[100:103],v[60:63],v[164:167]
SA m0,s28,69632
R a[68:71],v7,17408
AF v28,v21,v28
M v[164:167],a[96:99],v[44:47],v[164:167]
s_waitcnt lgkmcnt(2)
buffer_load_dwordx4 v4, s[8:11], s21 offen offset:0 sc1 lds
M v[168:171],a[104:107],v[40:43],v[168:171]
R a[72:75],v7,18432
M v[168:171],a[108:111],v[56:59],v[168:171]
E v23,v105
M v[172:175],a[108:111],v[60:63],v[172:175]
R a[76:79],v7,19456
AF v28,v22,v28
M v[172:175],a[104:107],v[44:47],v[172:175]
E v24,v106
M v[176:179],a[112:115],v[40:43],v[176:179]
R a[80:83],v7,20480
C v50,v22,v23
M v[176:179],a[116:119],v[56:59],v[176:179]
buffer_load_dwordx4 v4, s[8:11], s21 offen offset:1024 sc1 lds
M v[180:183],a[116:119],v[60:63],v[180:183]
R a[84:87],v7,21504
AF v28,v23,v28
M v[180:183],a[112:115],v[44:47],v[180:183]
E v25,v107
M v[184:187],a[120:123],v[40:43],v[184:187]
R a[88:91],v7,22528
AF v28,v24,v28
M v[184:187],a[124:127],v[56:59],v[184:187]
buffer_load_dwordx4 v4, s[8:11], s21 offen offset:2048 sc1 lds
M v[188:191],a[124:127],v[60:63],v[188:191]
R a[92:95],v7,23552
C v51,v24,v25
M v[188:191],a[120:123],v[44:47],v[188:191]
s_waitcnt lgkmcnt(4)
E v18,v100
M v[192:195],a[64:67],v[40:43],v[192:195]
R a[96:99],v7,24576
AF v28,v25,v28
M v[192:195],a[68:71],v[56:59],v[192:195]
R a[100:103],v7,25600
M v[196:199],a[68:71],v[60:63],v[196:199]
buffer_load_dwordx4 v4, s[8:11], s21 offen offset:3072 sc1 lds
M v[196:199],a[64:67],v[44:47],v[196:199]
s_waitcnt lgkmcnt(2)
R a[104:107],v7,26624
M v[200:203],a[72:75],v[40:43],v[200:203]
SA s21,s21,32768
R a[108:111],v7,27648
M v[200:203],a[76:79],v[56:59],v[200:203]
s_sub_u32 s22, s22, 1
E v19,v101
M v[204:207],a[76:79],v[60:63],v[204:207]
s_cselect_b32 s21, s23, s21
R a[112:115],v7,28672
AF v29,v18,v19
M v[204:207],a[72:75],v[44:47],v[204:207]
R a[116:119],v7,29696
C v52,v18,v19
M v[208:211],a[80:83],v[40:43],v[208:211]
E v20,v102
M v[208:211],a[84:87],v[56:59],v[208:211]
R a[120:123],v7,30720
M v[212:215],a[84:87],v[60:63],v[212:215]
R a[124:127],v7,31744
M v[212:215],a[80:83],v[44:47],v[212:215]
E v21,v103
M v[216:219],a[88:91],v[40:43],v[216:219]
E v22,v108
M v[216:219],a[92:95],v[56:59],v[216:219]
AF v29,v20,v29
C v53,v20,v21
M v[220:223],a[92:95],v[60:63],v[220:223]
s_waitcnt vmcnt(16) lgkmcnt(0)
AF v29,v21,v29
M v[220:223],a[88:91],v[44:47],v[220:223]
s_barrier
M v[224:227],a[96:99],v[40:43],v[224:227]
R a[64:67],v2,32768
M v[224:227],a[100:103],v[56:59],v[224:227]
E v23,v109
M v[228:231],a[100:103],v[60:63],v[228:231]
R a[68:71],v2,33792
v_cmp_gt_u32 vcc, s6, v5
M v[228:231],a[96:99],v[44:47],v[228:231]
E v24,v110
M v[232:235],a[104:107],v[40:43],v[232:235]
R a[72:75],v2,34816
AF v29,v22,v29
M v[232:235],a[108:111],v[56:59],v[232:235]
s_cbranch_vccnz L_fls0
L_flr0:
C v54,v22,v23
AF v29,v23,v29
M v[236:239],a[108:111],v[60:63],v[236:239]
s_mov_b32 s6, 0
R a[76:79],v2,35840
M v[236:239],a[104:107],v[44:47],v[236:239]
SA s7,s7,1
E v25,v111
M v[240:243],a[112:115],v[40:43],v[240:243]
R a[80:83],v2,36864
AF v29,v24,v29
M v[240:243],a[116:119],v[56:59],v[240:243]
C v55,v24,v25
AF v29,v25,v29
M v[244:247],a[116:119],v[60:63],v[244:247]
R a[84:87],v2,37888
M v[244:247],a[112:115],v[44:47],v[244:247]
M v[248:251],a[120:123],v[40:43],v[248:251]
s_sub_u32 s27, s27, 1
R a[88:91],v2,38912
M v[248:251],a[124:127],v[56:59],v[248:251]
s_cmp_lg_u32 s27, 0
M v[252:255],a[124:127],v[60:63],v[252:255]
s_waitcnt lgkmcnt(3)
R a[92:95],v2,39936
M v[252:255],a[120:123],v[44:47],v[252:255]
s_cbranch_scc1 L_loop_top
s_cmp_eq_u32 s40, 0
s_cbranch_scc1 L_final_h
L_d1s:
M v[68:71],a[64:67],a[32:35],v[36:39]
s_cmp_lt_u32 s20, 0
R a[96:99],v2,40960
R a[100:103],v2,41984
M v[68:71],a[68:71],a[36:39],v[68:71]
s_cselect_b64 s[82:83], -1, 0
E v18,v112
M v[68:71],a[72:75],a[40:43],v[68:71]
s_cmp_eq_u32 s20, 0
M v[68:71],a[76:79],a[44:47],v[68:71]
s_cselect_b64 s[66:67], s[16:17], s[82:83]
R a[104:107],v2,43008
R a[108:111],v2,44032
s_waitcnt lgkmcnt(7)
M v[68:71],a[80:83],a[48:51],v[68:71]
s_cselect_b64 s[68:69], s[18:19], s[82:83]
E v19,v113
s_waitcnt lgkmcnt(6)
M v[68:71],a[84:87],a[52:55],v[68:71]
s_cselect_b64 s[70:71], s[48:49], s[82:83]
AF v28,v18,v28
C v56,v18,v19
s_waitcnt lgkmcnt(5)
M v[68:71],a[88:91],a[56:59],v[68:71]
s_cselect_b64 s[72:73], s[50:51], s[82:83]
R a[112:115],v2,45056
R a[116:119],v2,46080
v_cndmask_b32 v64, v32, v8, s[66:67]
v_cndmask_b32 v65, v32, v8, s[68:69]
v_cndmask_b32 v66, v32, v8, s[70:71]
v_cndmask_b32 v67, v32, v8, s[72:73]
s_waitcnt lgkmcnt(6)
M v[68:71],a[92:95],a[60:63],v[68:71]
s_mov_b32 s26, s43
v_min_u32 v17, 896, v9
AF v28,v19,v28
M v[64:67],a[92:95],a[28:31],v[64:67]
s_cmp_lt_u32 s20, 1
buffer_load_dword v5, v17, s[8:11], s46 offen sc1
M v[64:67],a[88:91],a[24:27],v[64:67]
s_cselect_b64 s[82:83], -1, 0
R a[120:123],v2,47104
R a[124:127],v2,48128
M v[64:67],a[84:87],a[20:23],v[64:67]
SA m0,s28,0
E v20,v114
M v[64:67],a[80:83],a[16:19],v[64:67]
s_cmp_eq_u32 s20, 1
buffer_load_dwordx4 v3, s[8:11], s26 offen offset:0 sc1 lds
M v[64:67],a[76:79],a[12:15],v[64:67]
s_cselect_b64 s[74:75], s[16:17], s[82:83]
E v21,v115
M v[64:67],a[72:75],a[8:11],v[64:67]
s_cselect_b64 s[76:77], s[18:19], s[82:83]
AF v28,v20,v28
C v57,v20,v21
M v[64:67],a[68:71],a[4:7],v[64:67]
s_cselect_b64 s[78:79], s[48:49], s[82:83]
E v22,v120
M v[64:67],a[64:67],a[0:3],v[64:67]
s_waitcnt lgkmcnt(0)
buffer_load_dwordx4 v3, s[8:11], s26 offen offset:1024 sc1 lds
M v[76:79],a[96:99],a[32:35],v[36:39]
s_cselect_b64 s[80:81], s[50:51], s[82:83]
R a[64:67],v2,49152
R a[68:71],v2,50176
M v[76:79],a[100:103],a[36:39],v[76:79]
v_cndmask_b32 v72, v32, v8, s[74:75]
v_cndmask_b32 v73, v32, v8, s[76:77]
M v[76:79],a[104:107],a[40:43],v[76:79]
v_cndmask_b32 v74, v32, v8, s[78:79]
AF v28,v21,v28
M v[76:79],a[108:111],a[44:47],v[76:79]
R a[72:75],v2,51200
R a[76:79],v2,52224
M v[76:79],a[112:115],a[48:51],v[76:79]
buffer_load_dwordx4 v3, s[8:11], s26 offen offset:2048 sc1 lds
M v[76:79],a[116:119],a[52:55],v[76:79]
v_cndmask_b32 v75, v32, v8, s[80:81]
M v[76:79],a[120:123],a[56:59],v[76:79]
s_cmp_lt_u32 s20, 2
R a[80:83],v2,53248
R a[84:87],v2,54272
M v[76:79],a[124:127],a[60:63],v[76:79]
s_cselect_b64 s[82:83], -1, 0
E v23,v121
M v[72:75],a[124:127],a[28:31],v[72:75]
s_cmp_eq_u32 s20, 2
buffer_load_dwordx4 v3, s[8:11], s26 offen offset:3072 sc1 lds
M v[72:75],a[120:123],a[24:27],v[72:75]
s_cselect_b64 s[66:67], s[16:17], s[82:83]
R a[88:91],v2,55296
R a[92:95],v2,56320
M v[72:75],a[116:119],a[20:23],v[72:75]
s_cselect_b64 s[68:69], s[18:19], s[82:83]
E v24,v122
M v[72:75],a[112:115],a[16:19],v[72:75]
s_cselect_b64 s[70:71], s[48:49], s[82:83]
E v25,v123
M v[72:75],a[108:111],a[12:15],v[72:75]
s_cselect_b64 s[72:73], s[50:51], s[82:83]
v_cndmask_b32 v80, v32, v8, s[66:67]
v_cndmask_b32 v81, v32, v8, s[68:69]
M v[72:75],a[104:107],a[8:11],v[72:75]
SA m0,s28,4096
E v18,v116
M v[72:75],a[100:103],a[4:7],v[72:75]
s_lshl_b32 s86, s20, 14
buffer_load_dwordx4 v4, s[8:11], s26 offen offset:0 sc1 lds
M v[72:75],a[96:99],a[0:3],v[72:75]
s_waitcnt lgkmcnt(0)
v_cndmask_b32 v82, v32, v8, s[70:71]
AF v28,v22,v28
M v[84:87],a[64:67],a[32:35],v[36:39]
SA s86,s86,s34
R a[96:99],v2,57344
R a[100:103],v2,58368
M v[84:87],a[68:71],a[36:39],v[84:87]
SA s87,s86,4096
buffer_load_dwordx4 v4, s[8:11], s26 offen offset:1024 sc1 lds
M v[84:87],a[72:75],a[40:43],v[84:87]
SA s88,s86,8192
v_cndmask_b32 v83, v32, v8, s[72:73]
C v58,v22,v23
M v[84:87],a[76:79],a[44:47],v[84:87]
s_cmp_lt_u32 s20, 3
R a[104:107],v2,59392
R a[108:111],v2,60416
M v[84:87],a[80:83],a[48:51],v[84:87]
s_cselect_b64 s[82:83], -1, 0
E v19,v117
M v[84:87],a[84:87],a[52:55],v[84:87]
SA s89,s86,12288
buffer_load_dwordx4 v4, s[8:11], s26 offen offset:2048 sc1 lds
M v[84:87],a[88:91],a[56:59],v[84:87]
s_lshl_b32 s90, s20, 10
R a[112:115],v2,61440
R a[116:119],v2,62464
M v[84:87],a[92:95],a[60:63],v[84:87]
SA s90,s90,s34
E v20,v118
M v[80:83],a[92:95],a[28:31],v[80:83]
SA s90,s90,65536
E v21,v119
M v[80:83],a[88:91],a[24:27],v[80:83]
s_cmp_eq_u32 s20, 3
R a[120:123],v2,63488
R a[124:127],v2,64512
M v[80:83],a[84:87],a[20:23],v[80:83]
s_cselect_b64 s[74:75], s[16:17], s[82:83]
buffer_load_dwordx4 v4, s[8:11], s26 offen offset:3072 sc1 lds
M v[80:83],a[80:83],a[16:19],v[80:83]
s_cselect_b64 s[76:77], s[18:19], s[82:83]
AF v28,v23,v28
AF v28,v24,v28
M v[80:83],a[76:79],a[12:15],v[80:83]
s_cselect_b64 s[78:79], s[48:49], s[82:83]
E v22,v124
M v[80:83],a[72:75],a[8:11],v[80:83]
s_cselect_b64 s[80:81], s[50:51], s[82:83]
v_cndmask_b32 v88, v32, v8, s[74:75]
v_cndmask_b32 v89, v32, v8, s[76:77]
M v[80:83],a[68:71],a[4:7],v[80:83]
s_waitcnt vmcnt(17) lgkmcnt(0)
v_cndmask_b32 v90, v32, v8, s[78:79]
v_cndmask_b32 v91, v32, v8, s[80:81]
M v[80:83],a[64:67],a[0:3],v[80:83]
s_barrier
M v[92:95],a[96:99],a[32:35],v[36:39]
SA s26,s26,32768
R a[64:67],v7,32768
R a[68:71],v7,33792
M v[92:95],a[100:103],a[36:39],v[92:95]
SA m0,s28,131072
E v23,v125
M v[92:95],a[104:107],a[40:43],v[92:95]
buffer_load_dwordx4 v3, s[8:11], s26 offen offset:0 sc1 lds
M v[92:95],a[108:111],a[44:47],v[92:95]
R a[72:75],v7,34816
R a[76:79],v7,35840
M v[92:95],a[112:115],a[48:51],v[92:95]
C v59,v24,v25
AF v28,v25,v28
M v[92:95],a[116:119],a[52:55],v[92:95]
buffer_load_dwordx4 v3, s[8:11], s26 offen offset:1024 sc1 lds
M v[92:95],a[120:123],a[56:59],v[92:95]
R a[80:83],v7,36864
R a[84:87],v7,37888
M v[92:95],a[124:127],a[60:63],v[92:95]
E v24,v126
M v[88:91],a[124:127],a[28:31],v[88:91]
buffer_load_dwordx4 v3, s[8:11], s26 offen offset:2048 sc1 lds
M v[88:91],a[120:123],a[24:27],v[88:91]
R a[88:91],v7,38912
R a[92:95],v7,39936
M v[88:91],a[116:119],a[20:23],v[88:91]
E v25,v127
M v[88:91],a[112:115],a[16:19],v[88:91]
buffer_load_dwordx4 v3, s[8:11], s26 offen offset:3072 sc1 lds
M v[88:91],a[108:111],a[12:15],v[88:91]
AF v29,v18,v29
C v60,v18,v19
M v[88:91],a[104:107],a[8:11],v[88:91]
AF v29,v19,v29
AF v29,v20,v29
M v[88:91],a[100:103],a[4:7],v[88:91]
s_waitcnt lgkmcnt(0)
C v61,v20,v21
AF v29,v21,v29
M v[88:91],a[96:99],a[0:3],v[88:91]
AF v29,v22,v29
C v62,v22,v23
AF v29,v23,v29
AF v29,v24,v29
C v63,v24,v25
AF v29,v25,v29
v_max_f32 v10, v28, v29
v_cmp_lt_f32 vcc, s31, v10
s_nop 0
s_cbranch_vccnz L_std1
L_rtd1:
s_cmp_lt_u32 s42, 6
s_cbranch_scc1 L_d2h
M v[128:131],a[64:67],v[48:51],v[128:131]
R a[96:99],v7,40960
R a[100:103],v7,41984
M v[128:131],a[68:71],v[56:59],v[128:131]
SA m0,s28,135168
E v18,v64
M v[132:135],a[68:71],v[60:63],v[132:135]
buffer_load_dwordx4 v4, s[8:11], s26 offen offset:0 sc1 lds
M v[132:135],a[64:67],v[52:55],v[132:135]
R a[104:107],v7,43008
R a[108:111],v7,44032
M v[136:139],a[72:75],v[48:51],v[136:139]
s_cmp_gt_u32 s20, 3
E v19,v65
M v[136:139],a[76:79],v[56:59],v[136:139]
s_cselect_b64 s[82:83], -1, 0
AF v30,v28,v30
AF v31,v29,v31
M v[140:143],a[76:79],v[60:63],v[140:143]
s_cmp_eq_u32 s20, 3
R a[112:115],v7,45056
R a[116:119],v7,46080
M v[140:143],a[72:75],v[52:55],v[140:143]
s_cselect_b64 s[66:67], s[16:17], s[82:83]
buffer_load_dwordx4 v4, s[8:11], s26 offen offset:1024 sc1 lds
M v[144:147],a[80:83],v[48:51],v[144:147]
s_cselect_b64 s[68:69], s[18:19], s[82:83]
E v20,v66
M v[144:147],a[84:87],v[56:59],v[144:147]
s_cselect_b64 s[70:71], s[48:49], s[82:83]
R a[120:123],v7,47104
R a[124:127],v7,48128
M v[148:151],a[84:87],v[60:63],v[148:151]
s_cselect_b64 s[72:73], s[50:51], s[82:83]
v_cndmask_b32 v100, v36, v8, s[66:67]
v_cndmask_b32 v101, v36, v8, s[68:69]
M v[148:151],a[80:83],v[52:55],v[148:151]
buffer_load_dwordx4 v4, s[8:11], s26 offen offset:2048 sc1 lds
M v[152:155],a[88:91],v[48:51],v[152:155]
v_cndmask_b32 v102, v36, v8, s[70:71]
AF v26,v18,v19
M v[152:155],a[92:95],v[56:59],v[152:155]
E v21,v67
M v[156:159],a[92:95],v[60:63],v[156:159]
v_cndmask_b32 v103, v36, v8, s[72:73]
C v40,v18,v19
M v[156:159],a[88:91],v[52:55],v[156:159]
s_waitcnt lgkmcnt(0)
buffer_load_dwordx4 v4, s[8:11], s26 offen offset:3072 sc1 lds
M v[160:163],a[96:99],v[48:51],v[160:163]
s_cmp_gt_u32 s20, 2
R a[64:67],v7,49152
R a[68:71],v7,50176
M v[160:163],a[100:103],v[56:59],v[160:163]
s_cselect_b64 s[82:83], -1, 0
v_lshrrev_b32 v14, 7, v7
AF v26,v20,v26
M v[164:167],a[100:103],v[60:63],v[164:167]
s_cmp_eq_u32 s20, 2
v_mul_u32_u24 v14, 896, v14
C v41,v20,v21
M v[164:167],a[96:99],v[52:55],v[164:167]
s_cselect_b64 s[74:75], s[16:17], s[82:83]
R a[72:75],v7,51200
R a[76:79],v7,52224
M v[168:171],a[104:107],v[48:51],v[168:171]
s_cselect_b64 s[76:77], s[18:19], s[82:83]
v_lshrrev_b32 v15, 8, v7
AF v26,v21,v26
M v[168:171],a[108:111],v[56:59],v[168:171]
s_cselect_b64 s[78:79], s[48:49], s[82:83]
v_lshlrev_b32 v15, 5, v15
M v[172:175],a[108:111],v[60:63],v[172:175]
s_cselect_b64 s[80:81], s[50:51], s[82:83]
R a[80:83],v7,53248
R a[84:87],v7,54272
M v[172:175],a[104:107],v[52:55],v[172:175]
v_cndmask_b32 v108, v36, v8, s[74:75]
v_cndmask_b32 v109, v36, v8, s[76:77]
M v[176:179],a[112:115],v[48:51],v[176:179]
v_xor_b32 v15, v15, v7
M v[176:179],a[116:119],v[56:59],v[176:179]
R a[88:91],v7,55296
R a[92:95],v7,56320
M v[180:183],a[116:119],v[60:63],v[180:183]
v_and_b32 v15, 0x70, v15
v_cndmask_b32 v110, v36, v8, s[78:79]
M v[180:183],a[112:115],v[52:55],v[180:183]
v_add_u32 v0, v14, v15
M v[184:187],a[120:123],v[48:51],v[184:187]
s_mul_i32 s38, s20, 57344
v_cndmask_b32 v111, v36, v8, s[80:81]
M v[184:187],a[124:127],v[56:59],v[184:187]
s_cmp_gt_u32 s20, 1
E v22,v72
M v[188:191],a[124:127],v[60:63],v[188:191]
s_cselect_b64 s[82:83], -1, 0
E v23,v73
M v[188:191],a[120:123],v[52:55],v[188:191]
s_waitcnt lgkmcnt(0)
E v24,v74
M v[192:195],a[64:67],v[48:51],v[192:195]
SA m0,s28,98304
R a[96:99],v7,57344
R a[100:103],v7,58368
M v[192:195],a[68:71],v[56:59],v[192:195]
s_cmp_eq_u32 s20, 1
E v25,v75
M v[196:199],a[68:71],v[60:63],v[196:199]
s_cselect_b64 s[66:67], s[16:17], s[82:83]
E v18,v68
M v[196:199],a[64:67],v[52:55],v[196:199]
s_cselect_b64 s[68:69], s[18:19], s[82:83]
R a[104:107],v7,59392
R a[108:111],v7,60416
M v[200:203],a[72:75],v[48:51],v[200:203]
s_cselect_b64 s[70:71], s[48:49], s[82:83]
E v19,v69
M v[200:203],a[76:79],v[56:59],v[200:203]
s_cselect_b64 s[72:73], s[50:51], s[82:83]
v_cndmask_b32 v116, v36, v8, s[66:67]
v_cndmask_b32 v117, v36, v8, s[68:69]
M v[204:207],a[76:79],v[60:63],v[204:207]
SA s85,s38,0
R a[112:115],v7,61440
R a[116:119],v7,62464
M v[204:207],a[72:75],v[52:55],v[204:207]
buffer_load_dwordx4 v0, s[12:15], s85 offen offset:0 lds
M v[208:211],a[80:83],v[48:51],v[208:211]
SA s85,s38,6144
v_cndmask_b32 v118, v36, v8, s[70:71]
AF v26,v22,v26
M v[208:211],a[84:87],v[56:59],v[208:211]
R a[120:123],v7,63488
R a[124:127],v7,64512
M v[212:215],a[84:87],v[60:63],v[212:215]
buffer_load_dwordx4 v0, s[12:15], s85 offen offset:1024 lds
M v[212:215],a[80:83],v[52:55],v[212:215]
SA s85,s38,12288
v_cndmask_b32 v119, v36, v8, s[72:73]
C v42,v22,v23
M v[216:219],a[88:91],v[48:51],v[216:219]
s_cmp_gt_u32 s20, 0
E v20,v70
M v[216:219],a[92:95],v[56:59],v[216:219]
s_cselect_b64 s[82:83], -1, 0
buffer_load_dwordx4 v0, s[12:15], s85 offen offset:2048 lds
M v[220:223],a[92:95],v[60:63],v[220:223]
s_waitcnt vmcnt(20) lgkmcnt(0)
E v21,v71
M v[220:223],a[88:91],v[52:55],v[220:223]
s_barrier
M v[224:227],a[96:99],v[48:51],v[224:227]
SA s85,s38,18432
R a[64:67],v2,0
R a[68:71],v2,1024
M v[224:227],a[100:103],v[56:59],v[224:227]
s_cmp_eq_u32 s20, 0
buffer_load_dwordx4 v0, s[12:15], s85 offen offset:3072 lds
M v[228:231],a[100:103],v[60:63],v[228:231]
s_cselect_b64 s[74:75], s[16:17], s[82:83]
AF v26,v23,v26
AF v26,v24,v26
M v[228:231],a[96:99],v[52:55],v[228:231]
s_cselect_b64 s[76:77], s[18:19], s[82:83]
R a[72:75],v2,2048
R a[76:79],v2,3072
M v[232:235],a[104:107],v[48:51],v[232:235]
s_cselect_b64 s[78:79], s[48:49], s[82:83]
E v22,v76
M v[232:235],a[108:111],v[56:59],v[232:235]
s_cselect_b64 s[80:81], s[50:51], s[82:83]
v_cndmask_b32 v124, v36, v8, s[74:75]
v_cndmask_b32 v125, v36, v8, s[76:77]
M v[236:239],a[108:111],v[60:63],v[236:239]
SA m0,s28,102400
R a[80:83],v2,4096
R a[84:87],v2,5120
M v[236:239],a[104:107],v[52:55],v[236:239]
SA s85,s38,28672
buffer_load_dwordx4 v0, s[12:15], s85 offen offset:0 lds
M v[240:243],a[112:115],v[48:51],v[240:243]
SA s85,s38,34816
v_cndmask_b32 v126, v36, v8, s[78:79]
v_cndmask_b32 v127, v36, v8, s[80:81]
M v[240:243],a[116:119],v[56:59],v[240:243]
R a[88:91],v2,6144
R a[92:95],v2,7168
M v[244:247],a[116:119],v[60:63],v[244:247]
buffer_load_dwordx4 v0, s[12:15], s85 offen offset:1024 lds
M v[244:247],a[112:115],v[52:55],v[244:247]
SA s85,s38,40960
E v23,v77
M v[248:251],a[120:123],v[48:51],v[248:251]
buffer_load_dwordx4 v0, s[12:15], s85 offen offset:2048 lds
M v[248:251],a[124:127],v[56:59],v[248:251]
SA s85,s38,47104
C v43,v24,v25
AF v26,v25,v26
M v[252:255],a[124:127],v[60:63],v[252:255]
s_waitcnt lgkmcnt(0)
E v24,v78
M v[252:255],a[120:123],v[52:55],v[252:255]
buffer_load_dwordx4 v0, s[12:15], s85 offen offset:3072 lds
SA s38,s38,128
AF v27,v18,v19
C v44,v18,v19
AF v27,v20,v27
C v45,v20,v21
AF v27,v21,v27
E v25,v79
AF v27,v22,v27
C v46,v22,v23
AF v27,v23,v27
AF v27,v24,v27
C v47,v24,v25
AF v27,v25,v27
M v[100:103],a[64:67],a[32:35],v[100:103]
R a[96:99],v2,8192
R a[100:103],v2,9216
M v[100:103],a[68:71],a[36:39],v[100:103]
R a[104:107],v2,10240
R a[108:111],v2,11264
M v[100:103],a[72:75],a[40:43],v[100:103]
R a[112:115],v2,12288
R a[116:119],v2,13312
M v[100:103],a[76:79],a[44:47],v[100:103]
R a[120:123],v2,14336
R a[124:127],v2,15360
M v[100:103],a[80:83],a[48:51],v[100:103]
v_add_u32 v8, 0x20000, v7
M v[100:103],a[84:87],a[52:55],v[100:103]
SA m0,s28,32768
E v18,v80
M v[100:103],a[88:91],a[56:59],v[100:103]
SA s85,s38,0
buffer_load_dwordx4 v0, s[12:15], s85 offen offset:0 lds
M v[100:103],a[92:95],a[60:63],v[100:103]
s_waitcnt lgkmcnt(0)
E v19,v81
M v[108:111],a[96:99],a[32:35],v[108:111]
SA s85,s38,6144
R a[64:67],v2,16384
R a[68:71],v2,17408
M v[108:111],a[100:103],a[36:39],v[108:111]
R a[72:75],v2,18432
R a[76:79],v2,19456
M v[108:111],a[104:107],a[40:43],v[108:111]
R a[80:83],v2,20480
R a[84:87],v2,21504
M v[108:111],a[108:111],a[44:47],v[108:111]
R a[88:91],v2,22528
R a[92:95],v2,23552
M v[108:111],a[112:115],a[48:51],v[108:111]
buffer_load_dwordx4 v0, s[12:15], s85 offen offset:1024 lds
M v[108:111],a[116:119],a[52:55],v[108:111]
SA s85,s38,12288
E v20,v82
M v[108:111],a[120:123],a[56:59],v[108:111]
buffer_load_dwordx4 v0, s[12:15], s85 offen offset:2048 lds
M v[108:111],a[124:127],a[60:63],v[108:111]
s_waitcnt lgkmcnt(0)
E v21,v83
M v[116:119],a[64:67],a[32:35],v[116:119]
SA s85,s38,18432
R a[96:99],v2,24576
R a[100:103],v2,25600
M v[116:119],a[68:71],a[36:39],v[116:119]
R a[104:107],v2,26624
R a[108:111],v2,27648
M v[116:119],a[72:75],a[40:43],v[116:119]
R a[112:115],v2,28672
R a[116:119],v2,29696
M v[116:119],a[76:79],a[44:47],v[116:119]
R a[120:123],v2,30720
R a[124:127],v2,31744
M v[116:119],a[80:83],a[48:51],v[116:119]
buffer_load_dwordx4 v0, s[12:15], s85 offen offset:3072 lds
M v[116:119],a[84:87],a[52:55],v[116:119]
buffer_load_dword v6, off, s[8:11], s47 sc1
M v[116:119],a[88:91],a[56:59],v[116:119]
s_waitcnt vmcnt(21) lgkmcnt(0)
E v22,v88
M v[116:119],a[92:95],a[60:63],v[116:119]
s_barrier
M v[124:127],a[96:99],a[32:35],v[124:127]
R a[64:67],v7,0
R a[68:71],v7,1024
M v[124:127],a[100:103],a[36:39],v[124:127]
R a[72:75],v7,2048
R a[76:79],v7,3072
M v[124:127],a[104:107],a[40:43],v[124:127]
R a[80:83],v7,4096
R a[84:87],v7,5120
M v[124:127],a[108:111],a[44:47],v[124:127]
R a[88:91],v7,6144
R a[92:95],v7,7168
M v[124:127],a[112:115],a[48:51],v[124:127]
E v23,v89
M v[124:127],a[116:119],a[52:55],v[124:127]
E v24,v90
M v[124:127],a[120:123],a[56:59],v[124:127]
s_waitcnt lgkmcnt(0)
E v25,v91
M v[124:127],a[124:127],a[60:63],v[124:127]
AF v26,v18,v26
C v56,v18,v19
AF v26,v19,v26
AF v26,v20,v26
C v57,v20,v21
AF v26,v21,v26
AF v26,v22,v26
C v58,v22,v23
AF v26,v23,v26
E v18,v84
E v19,v85
AF v26,v24,v26
C v59,v24,v25
AF v26,v25,v26
E v20,v86
E v21,v87
AF v27,v18,v27
C v60,v18,v19
AF v27,v19,v27
E v22,v92
E v23,v93
AF v27,v20,v27
C v61,v20,v21
AF v27,v21,v27
E v24,v94
E v25,v95
AF v27,v22,v27
C v62,v22,v23
AF v27,v23,v27
AF v27,v24,v27
C v63,v24,v25
AF v27,v25,v27
v_max_f32 v10, v26, v27
v_cmp_lt_f32 vcc, s31, v10
s_nop 0
s_cbranch_vccnz L_std3n
L_rtd3n:
M v[128:131],a[64:67],v[40:43],v[128:131]
R a[96:99],v7,8192
R a[100:103],v7,9216
M v[128:131],a[68:71],v[56:59],v[128:131]
v_or_b32 v9, s35, v7
s_waitcnt vmcnt(0)
v_cmp_ne_u32 vcc, 1, v6
M v[132:135],a[68:71],v[60:63],v[132:135]
s_cbranch_vccnz L_fps
L_fpr:
E v18,v100
M v[132:135],a[64:67],v[44:47],v[132:135]
R a[104:107],v7,10240
R a[108:111],v7,11264
M v[136:139],a[72:75],v[40:43],v[136:139]
buffer_load_dwordx4 v[14:17], v9, s[8:11], s90 offen sc1
M v[136:139],a[76:79],v[56:59],v[136:139]
E v19,v101
M v[140:143],a[76:79],v[60:63],v[140:143]
R a[112:115],v7,12288
R a[116:119],v7,13312
M v[140:143],a[72:75],v[44:47],v[140:143]
buffer_load_dwordx4 a[160:163], v9, s[8:11], s88 offen offset:0 sc1
M v[144:147],a[80:83],v[40:43],v[144:147]
E v20,v102
M v[144:147],a[84:87],v[56:59],v[144:147]
R a[120:123],v7,14336
R a[124:127],v7,15360
M v[148:151],a[84:87],v[60:63],v[148:151]
buffer_load_dwordx4 a[128:131], v9, s[8:11], s86 offen offset:0 sc1
M v[148:151],a[80:83],v[44:47],v[148:151]
E v21,v103
M v[152:155],a[88:91],v[40:43],v[152:155]
AF v30,v26,v30
AF v31,v27,v31
M v[152:155],a[92:95],v[56:59],v[152:155]
buffer_load_dwordx4 a[164:167], v9, s[8:11], s88 offen offset:1024 sc1
M v[156:159],a[92:95],v[60:63],v[156:159]
AF v29,v18,v19
C v52,v18,v19
M v[156:159],a[88:91],v[44:47],v[156:159]
s_waitcnt lgkmcnt(0)
E v22,v108
M v[160:163],a[96:99],v[40:43],v[160:163]
R a[64:67],v7,16384
R a[68:71],v7,17408
M v[160:163],a[100:103],v[56:59],v[160:163]
buffer_load_dwordx4 a[132:135], v9, s[8:11], s86 offen offset:1024 sc1
M v[164:167],a[100:103],v[60:63],v[164:167]
E v23,v109
M v[164:167],a[96:99],v[44:47],v[164:167]
R a[72:75],v7,18432
R a[76:79],v7,19456
M v[168:171],a[104:107],v[40:43],v[168:171]
buffer_load_dwordx4 a[168:171], v9, s[8:11], s88 offen offset:2048 sc1
M v[168:171],a[108:111],v[56:59],v[168:171]
AF v29,v20,v29
C v53,v20,v21
M v[172:175],a[108:111],v[60:63],v[172:175]
R a[80:83],v7,20480
R a[84:87],v7,21504
M v[172:175],a[104:107],v[44:47],v[172:175]
buffer_load_dwordx4 a[136:139], v9, s[8:11], s86 offen offset:2048 sc1
M v[176:179],a[112:115],v[40:43],v[176:179]
E v24,v110
M v[176:179],a[116:119],v[56:59],v[176:179]
R a[88:91],v7,22528
R a[92:95],v7,23552
M v[180:183],a[116:119],v[60:63],v[180:183]
buffer_load_dwordx4 a[172:175], v9, s[8:11], s88 offen offset:3072 sc1
M v[180:183],a[112:115],v[44:47],v[180:183]
E v25,v111
M v[184:187],a[120:123],v[40:43],v[184:187]
AF v29,v21,v29
AF v29,v22,v29
M v[184:187],a[124:127],v[56:59],v[184:187]
buffer_load_dwordx4 a[140:143], v9, s[8:11], s86 offen offset:3072 sc1
M v[188:191],a[124:127],v[60:63],v[188:191]
E v18,v116
M v[188:191],a[120:123],v[44:47],v[188:191]
s_waitcnt lgkmcnt(0)
C v54,v22,v23
AF v29,v23,v29
M v[192:195],a[64:67],v[40:43],v[192:195]
R a[96:99],v7,24576
R a[100:103],v7,25600
M v[192:195],a[68:71],v[56:59],v[192:195]
buffer_load_dwordx4 a[176:179], v9, s[8:11], s89 offen offset:0 sc1
M v[196:199],a[68:71],v[60:63],v[196:199]
E v19,v117
M v[196:199],a[64:67],v[44:47],v[196:199]
R a[104:107],v7,26624
R a[108:111],v7,27648
M v[200:203],a[72:75],v[40:43],v[200:203]
buffer_load_dwordx4 a[144:147], v9, s[8:11], s87 offen offset:0 sc1
M v[200:203],a[76:79],v[56:59],v[200:203]
E v20,v118
M v[204:207],a[76:79],v[60:63],v[204:207]
R a[112:115],v7,28672
R a[116:119],v7,29696
M v[204:207],a[72:75],v[44:47],v[204:207]
buffer_load_dwordx4 a[180:183], v9, s[8:11], s89 offen offset:1024 sc1
M v[208:211],a[80:83],v[40:43],v[208:211]
AF v29,v24,v29
C v55,v24,v25
M v[208:211],a[84:87],v[56:59],v[208:211]
R a[120:123],v7,30720
R a[124:127],v7,31744
M v[212:215],a[84:87],v[60:63],v[212:215]
buffer_load_dwordx4 a[148:151], v9, s[8:11], s87 offen offset:1024 sc1
M v[212:215],a[80:83],v[44:47],v[212:215]
E v21,v119
M v[216:219],a[88:91],v[40:43],v[216:219]
AF v29,v25,v29
AF v29,v18,v29
M v[216:219],a[92:95],v[56:59],v[216:219]
buffer_load_dwordx4 a[184:187], v9, s[8:11], s89 offen offset:2048 sc1
M v[220:223],a[92:95],v[60:63],v[220:223]
s_waitcnt lgkmcnt(0)
E v22,v124
M v[220:223],a[88:91],v[44:47],v[220:223]
s_barrier
M v[224:227],a[96:99],v[40:43],v[224:227]
R a[64:67],v8,0
R a[68:71],v8,1024
M v[224:227],a[100:103],v[56:59],v[224:227]
buffer_load_dwordx4 a[152:155], v9, s[8:11], s87 offen offset:2048 sc1
M v[228:231],a[100:103],v[60:63],v[228:231]
E v23,v125
M v[228:231],a[96:99],v[44:47],v[228:231]
R a[72:75],v8,2048
R a[76:79],v8,3072
M v[232:235],a[104:107],v[40:43],v[232:235]
buffer_load_dwordx4 a[188:191], v9, s[8:11], s89 offen offset:3072 sc1
M v[232:235],a[108:111],v[56:59],v[232:235]
E v24,v126
M v[236:239],a[108:111],v[60:63],v[236:239]
R a[80:83],v8,4096
R a[84:87],v8,5120
M v[236:239],a[104:107],v[44:47],v[236:239]
buffer_load_dwordx4 a[156:159], v9, s[8:11], s87 offen offset:3072 sc1
M v[240:243],a[112:115],v[40:43],v[240:243]
E v25,v127
M v[240:243],a[116:119],v[56:59],v[240:243]
R a[88:91],v8,6144
R a[92:95],v8,7168
M v[244:247],a[116:119],v[60:63],v[244:247]
C v48,v18,v19
AF v29,v19,v29
M v[244:247],a[112:115],v[44:47],v[244:247]
AF v29,v20,v29
C v49,v20,v21
M v[248:251],a[120:123],v[40:43],v[248:251]
AF v29,v21,v29
AF v29,v22,v29
M v[248:251],a[124:127],v[56:59],v[248:251]
C v50,v22,v23
AF v29,v23,v29
M v[252:255],a[124:127],v[60:63],v[252:255]
s_waitcnt lgkmcnt(0)
AF v29,v24,v29
C v51,v24,v25
M v[252:255],a[120:123],v[44:47],v[252:255]
AF v29,v25,v29
v_cmp_lt_f32 vcc, s31, v29
s_nop 0
s_cbranch_vccnz L_std4n
L_rtd4n:
s_waitcnt vmcnt(16)
v_cmp_neq_f32 vcc, v32, v14
v_cmp_neq_f32 s[64:65], v36, v15
s_cmp_eq_u32 s35, 0
s_cselect_b64 s[66:67], -1, 0
s_or_b64 vcc, vcc, s[64:65]
s_and_b64 vcc, vcc, s[66:67]
s_cbranch_vccnz L_stc
L_rtc:
M v[132:135],a[64:67],v[52:55],v[132:135]
R a[96:99],v8,8192
R a[100:103],v8,9216
M v[132:135],a[68:71],v[48:51],v[132:135]
s_waitcnt vmcnt(12)
AF v30,v16,v30
AF v31,v17,v31
M v[132:135],a[246:249],a[160:163],v[132:135]
SA m0,s28,36864
AF v31,v29,v31
v_mov_b32 v10, v30
M v[128:131],a[246:249],a[128:131],v[128:131]
SA s85,s38,28672
R a[104:107],v8,10240
R a[108:111],v8,11264
M v[140:143],a[72:75],v[52:55],v[140:143]
buffer_load_dwordx4 v0, s[12:15], s85 offen offset:0 lds
M v[140:143],a[76:79],v[48:51],v[140:143]
SA s85,s38,34816
v_mov_b32 v11, v31
M v[140:143],a[244:247],a[160:163],v[140:143]
R a[112:115],v8,12288
R a[116:119],v8,13312
M v[136:139],a[244:247],a[128:131],v[136:139]
v_permlane16_swap_b32 v10, v30
M v[148:151],a[80:83],v[52:55],v[148:151]
v_permlane16_swap_b32 v11, v31
M v[148:151],a[84:87],v[48:51],v[148:151]
R a[120:123],v8,14336
R a[124:127],v8,15360
M v[148:151],a[246:249],a[164:167],v[148:151]
buffer_load_dwordx4 v0, s[12:15], s85 offen offset:1024 lds
M v[144:147],a[246:249],a[132:135],v[144:147]
SA s85,s38,40960
AF v30,v10,v30
AF v31,v11,v31
M v[156:159],a[88:91],v[52:55],v[156:159]
v_mov_b32 v10, v30
v_mov_b32 v11, v31
M v[156:159],a[92:95],v[48:51],v[156:159]
buffer_load_dwordx4 v0, s[12:15], s85 offen offset:2048 lds
M v[156:159],a[244:247],a[164:167],v[156:159]
s_waitcnt vmcnt(11)
v_permlane32_swap_b32 v10, v30
M v[152:155],a[244:247],a[132:135],v[152:155]
s_waitcnt lgkmcnt(0)
v_permlane32_swap_b32 v11, v31
M v[164:167],a[96:99],v[52:55],v[164:167]
SA s85,s38,47104
R a[64:67],v8,16384
R a[68:71],v8,17408
M v[164:167],a[100:103],v[48:51],v[164:167]
buffer_load_dwordx4 v0, s[12:15], s85 offen offset:3072 lds
M v[164:167],a[246:249],a[168:171],v[164:167]
SA s38,s38,128
C v132,v132,v133
C v133,v134,v135
M v[160:163],a[246:249],a[136:139],v[160:163]
SA m0,s28,65536
R a[72:75],v8,18432
R a[76:79],v8,19456
AF v30,v10,v30
AF v31,v11,v31
v_rcp_f32 v5, v30
v_rcp_f32 v6, v31
M v[172:175],a[104:107],v[52:55],v[172:175]
SA s85,s38,0
buffer_load_dwordx4 v0, s[12:15], s85 offen offset:0 lds
M v[172:175],a[108:111],v[48:51],v[172:175]
SA s85,s38,6144
C v134,v140,v141
C v135,v142,v143
M v[172:175],a[244:247],a[168:171],v[172:175]
R a[80:83],v8,20480
R a[84:87],v8,21504
M v[168:171],a[244:247],a[136:139],v[168:171]
buffer_load_dwordx4 v0, s[12:15], s85 offen offset:1024 lds
M v[180:183],a[112:115],v[52:55],v[180:183]
SA s85,s38,12288
C v128,v128,v129
C v129,v130,v131
M v[180:183],a[116:119],v[48:51],v[180:183]
R a[88:91],v8,22528
R a[92:95],v8,23552
M v[180:183],a[246:249],a[172:175],v[180:183]
buffer_load_dwordx4 v0, s[12:15], s85 offen offset:2048 lds
M v[176:179],a[246:249],a[140:143],v[176:179]
SA s85,s38,18432
C v130,v136,v137
C v131,v138,v139
M v[188:191],a[120:123],v[52:55],v[188:191]
C v148,v148,v149
C v149,v150,v151
M v[188:191],a[124:127],v[48:51],v[188:191]
buffer_load_dwordx4 v0, s[12:15], s85 offen offset:3072 lds
M v[188:191],a[244:247],a[172:175],v[188:191]
s_waitcnt vmcnt(12)
C v150,v156,v157
C v151,v158,v159
M v[184:187],a[244:247],a[140:143],v[184:187]
s_waitcnt lgkmcnt(0)
C v144,v144,v145
C v145,v146,v147
M v[196:199],a[64:67],v[52:55],v[196:199]
SA m0,s28,69632
R a[96:99],v8,24576
R a[100:103],v8,25600
M v[196:199],a[68:71],v[48:51],v[196:199]
SA s85,s38,28672
buffer_load_dwordx4 v0, s[12:15], s85 offen offset:0 lds
M v[196:199],a[246:249],a[176:179],v[196:199]
SA s85,s38,34816
C v146,v152,v153
C v147,v154,v155
M v[192:195],a[246:249],a[144:147],v[192:195]
R a[104:107],v8,26624
R a[108:111],v8,27648
M v[204:207],a[72:75],v[52:55],v[204:207]
buffer_load_dwordx4 v0, s[12:15], s85 offen offset:1024 lds
M v[204:207],a[76:79],v[48:51],v[204:207]
SA s85,s38,40960
v_lshrrev_b32 v16, 4, v7
v_lshrrev_b32 v14, 2, v16
M v[204:207],a[244:247],a[176:179],v[204:207]
R a[112:115],v8,28672
R a[116:119],v8,29696
M v[200:203],a[244:247],a[144:147],v[200:203]
buffer_load_dwordx4 v0, s[12:15], s85 offen offset:2048 lds
M v[212:215],a[80:83],v[52:55],v[212:215]
SA s85,s38,47104
v_lshlrev_b32 v14, 7, v14
v_and_b32 v15, 3, v16
M v[212:215],a[84:87],v[48:51],v[212:215]
R a[120:123],v8,30720
R a[124:127],v8,31744
M v[212:215],a[246:249],a[180:183],v[212:215]
buffer_load_dwordx4 v0, s[12:15], s85 offen offset:3072 lds
M v[208:211],a[246:249],a[148:151],v[208:211]
SA s38,s38,128
v_lshl_add_u32 v14, v15, 3, v14
C v164,v164,v165
M v[220:223],a[88:91],v[52:55],v[220:223]
C v165,v166,v167
C v166,v172,v173
M v[220:223],a[92:95],v[48:51],v[220:223]
s_waitcnt vmcnt(12)
C v167,v174,v175
C v160,v160,v161
M v[220:223],a[244:247],a[180:183],v[220:223]
s_waitcnt lgkmcnt(0)
v_bfe_u32 v15, v16, 3, 2
v_lshl_add_u32 v18, v15, 5, v14
v_xor_b32 v19, 32, v18
v_xor_b32 v20, 64, v18
v_xor_b32 v21, 0x60, v18
v_add_u32 v22, 0x10000, v18
v_add_u32 v23, 0x10000, v19
v_add_u32 v24, 0x10000, v20
v_add_u32 v25, 0x10000, v21
M v[216:219],a[244:247],a[148:151],v[216:219]
s_barrier
M v[228:231],a[96:99],v[52:55],v[228:231]
s_nop 0
T a[64:65],v22,32768
T a[66:67],v22,34816
M v[228:231],a[100:103],v[48:51],v[228:231]
T a[68:69],v22,36864
T a[70:71],v22,38912
M v[228:231],a[246:249],a[184:187],v[228:231]
C v161,v162,v163
C v162,v168,v169
M v[224:227],a[246:249],a[152:155],v[224:227]
T a[72:73],v22,40960
T a[74:75],v22,43008
M v[236:239],a[104:107],v[52:55],v[236:239]
T a[76:77],v22,45056
T a[78:79],v22,47104
M v[236:239],a[108:111],v[48:51],v[236:239]
C v163,v170,v171
C v180,v180,v181
M v[236:239],a[244:247],a[184:187],v[236:239]
T a[80:81],v22,49152
T a[82:83],v22,51200
M v[232:235],a[244:247],a[152:155],v[232:235]
T a[84:85],v22,53248
T a[86:87],v22,55296
M v[244:247],a[112:115],v[52:55],v[244:247]
C v181,v182,v183
C v182,v188,v189
M v[244:247],a[116:119],v[48:51],v[244:247]
T a[88:89],v22,57344
T a[90:91],v22,59392
M v[244:247],a[246:249],a[188:191],v[244:247]
T a[92:93],v22,61440
T a[94:95],v22,63488
M v[240:243],a[246:249],a[156:159],v[240:243]
C v183,v190,v191
C v176,v176,v177
M v[252:255],a[120:123],v[52:55],v[252:255]
C v177,v178,v179
C v178,v184,v185
M v[252:255],a[124:127],v[48:51],v[252:255]
C v179,v186,v187
C v196,v196,v197
M v[252:255],a[244:247],a[188:191],v[252:255]
s_waitcnt lgkmcnt(0)
C v197,v198,v199
C v198,v204,v205
M v[248:251],a[244:247],a[156:159],v[248:251]
C v199,v206,v207
C v192,v192,v193
C v193,v194,v195
C v194,v200,v201
C v195,v202,v203
C v212,v212,v213
C v213,v214,v215
C v214,v220,v221
C v215,v222,v223
C v208,v208,v209
C v209,v210,v211
C v210,v216,v217
C v211,v218,v219
C v228,v228,v229
C v229,v230,v231
C v230,v236,v237
C v231,v238,v239
C v224,v224,v225
C v225,v226,v227
C v226,v232,v233
C v227,v234,v235
C v244,v244,v245
C v245,v246,v247
C v246,v252,v253
C v247,v254,v255
C v240,v240,v241
C v241,v242,v243
C v242,v248,v249
C v243,v250,v251
M v[64:67],a[64:67],v[128:131],0
s_sub_u32 s64, 15, s42
T a[96:97],v23,32768
T a[98:99],v23,34816
M v[64:67],a[68:71],v[144:147],v[64:67]
s_min_u32 s64, s64, s42
T a[100:101],v23,36864
T a[102:103],v23,38912
M v[64:67],a[72:75],v[160:163],v[64:67]
s_mul_i32 s45, s64, 8704
M v[64:67],a[76:79],v[176:179],v[64:67]
s_lshl_b32 s64, s41, 2
T a[104:105],v23,40960
T a[106:107],v23,43008
M v[64:67],a[80:83],v[192:195],v[64:67]
SA s45,s45,s64
T a[108:109],v23,45056
T a[110:111],v23,47104
M v[64:67],a[84:87],v[208:211],v[64:67]
s_lshl_b32 s64, s20, 8
M v[64:67],a[88:91],v[224:227],v[64:67]
SA s45,s45,s64
T a[112:113],v23,49152
T a[114:115],v23,51200
M v[64:67],a[92:95],v[240:243],v[64:67]
SA s45,s45,104992768
T a[116:117],v23,53248
T a[118:119],v23,55296
M v[68:71],a[92:95],v[244:247],0
s_mov_b32 s64, 1024
M v[68:71],a[88:91],v[228:231],v[68:71]
s_mov_b32 s66, 4096
T a[120:121],v23,57344
T a[122:123],v23,59392
M v[68:71],a[84:87],v[212:215],v[68:71]
s_cmp_lt_u32 s42, 8
T a[124:125],v23,61440
T a[126:127],v23,63488
M v[68:71],a[80:83],v[196:199],v[68:71]
s_cselect_b32 s64, 4352, s64
M v[68:71],a[76:79],v[180:183],v[68:71]
s_cselect_b32 s65, 0, 64
M v[68:71],a[72:75],v[164:167],v[68:71]
s_cselect_b32 s66, 536870912, s66
M v[68:71],a[68:71],v[148:151],v[68:71]
SA s3,s45,s64
M v[68:71],a[64:67],v[132:135],v[68:71]
s_waitcnt lgkmcnt(0)
M v[72:75],a[96:99],v[128:131],0
SA s45,s45,s65
T a[64:65],v24,32768
T a[66:67],v24,34816
M v[72:75],a[100:103],v[144:147],v[72:75]
SA m0,s28,0
T a[68:69],v24,36864
T a[70:71],v24,38912
M v[72:75],a[104:107],v[160:163],v[72:75]
SA s85,s38,0
buffer_load_dwordx4 v0, s[12:15], s85 offen offset:0 lds
M v[72:75],a[108:111],v[176:179],v[72:75]
SA s85,s38,6144
T a[72:73],v24,40960
T a[74:75],v24,43008
M v[72:75],a[112:115],v[192:195],v[72:75]
SA s29,s33,0
T a[76:77],v24,45056
T a[78:79],v24,47104
M v[72:75],a[116:119],v[208:211],v[72:75]
SA s30,s33,14336
buffer_load_dwordx4 v0, s[12:15], s85 offen offset:1024 lds
M v[72:75],a[120:123],v[224:227],v[72:75]
SA s85,s38,12288
T a[80:81],v24,49152
T a[82:83],v24,51200
M v[72:75],a[124:127],v[240:243],v[72:75]
T a[84:85],v24,53248
T a[86:87],v24,55296
M v[76:79],a[124:127],v[244:247],0
buffer_load_dwordx4 v0, s[12:15], s85 offen offset:2048 lds
M v[76:79],a[120:123],v[228:231],v[76:79]
SA s85,s38,18432
T a[88:89],v24,57344
T a[90:91],v24,59392
M v[76:79],a[116:119],v[212:215],v[76:79]
T a[92:93],v24,61440
T a[94:95],v24,63488
M v[76:79],a[112:115],v[196:199],v[76:79]
buffer_load_dwordx4 v0, s[12:15], s85 offen offset:3072 lds
M v[76:79],a[108:111],v[180:183],v[76:79]
SA m0,s28,4096
v_lshrrev_b32 v17, 5, v7
v_min_u32 v15, 1, v17
M v[76:79],a[104:107],v[164:167],v[76:79]
SA s85,s38,28672
buffer_load_dwordx4 v0, s[12:15], s85 offen offset:0 lds
M v[76:79],a[100:103],v[148:151],v[76:79]
SA s85,s38,34816
v_lshlrev_b32 v14, 3, v7
v_lshl_or_b32 v16, v15, 29, v14
M v[76:79],a[96:99],v[132:135],v[76:79]
s_waitcnt lgkmcnt(0)
buffer_load_dwordx4 v0, s[12:15], s85 offen offset:1024 lds
M v[80:83],a[64:67],v[128:131],0
SA s85,s38,40960
T a[96:97],v25,32768
T a[98:99],v25,34816
M v[80:83],a[68:71],v[144:147],v[80:83]
T a[100:101],v25,36864
T a[102:103],v25,38912
M v[80:83],a[72:75],v[160:163],v[80:83]
buffer_load_dwordx4 v0, s[12:15], s85 offen offset:2048 lds
M v[80:83],a[76:79],v[176:179],v[80:83]
SA s85,s38,47104
T a[104:105],v25,40960
T a[106:107],v25,43008
M v[80:83],a[80:83],v[192:195],v[80:83]
T a[108:109],v25,45056
T a[110:111],v25,47104
M v[80:83],a[84:87],v[208:211],v[80:83]
buffer_load_dwordx4 v0, s[12:15], s85 offen offset:3072 lds
M v[80:83],a[88:91],v[224:227],v[80:83]
SA s38,s38,128
T a[112:113],v25,49152
T a[114:115],v25,51200
M v[80:83],a[92:95],v[240:243],v[80:83]
SA m0,s28,131072
T a[116:117],v25,53248
T a[118:119],v25,55296
M v[84:87],a[92:95],v[244:247],0
SA s85,s38,0
buffer_load_dwordx4 v0, s[12:15], s85 offen offset:0 lds
M v[84:87],a[88:91],v[228:231],v[84:87]
SA s85,s38,6144
T a[120:121],v25,57344
T a[122:123],v25,59392
M v[84:87],a[84:87],v[212:215],v[84:87]
T a[124:125],v25,61440
T a[126:127],v25,63488
M v[84:87],a[80:83],v[196:199],v[84:87]
buffer_load_dwordx4 v0, s[12:15], s85 offen offset:1024 lds
M v[84:87],a[76:79],v[180:183],v[84:87]
SA s85,s38,12288
v_cmp_eq_u32 vcc, 1, v17
v_add_u32 v14, s66, v14
M v[84:87],a[72:75],v[164:167],v[84:87]
buffer_load_dwordx4 v0, s[12:15], s85 offen offset:2048 lds
M v[84:87],a[68:71],v[148:151],v[84:87]
s_waitcnt vmcnt(19) lgkmcnt(0)
v_mov_b32 v15, 1
v_cndmask_b32 v17, v16, v14, vcc
M v[84:87],a[64:67],v[132:135],v[84:87]
s_barrier
M v[88:91],a[96:99],v[128:131],0
SA s85,s38,18432
T a[64:65],v18,32768
T a[66:67],v18,34816
M v[88:91],a[100:103],v[144:147],v[88:91]
T a[68:69],v18,36864
T a[70:71],v18,38912
M v[88:91],a[104:107],v[160:163],v[88:91]
buffer_load_dwordx4 v0, s[12:15], s85 offen offset:3072 lds
M v[88:91],a[108:111],v[176:179],v[88:91]
SA m0,s28,135168
T a[72:73],v18,40960
T a[74:75],v18,43008
M v[88:91],a[112:115],v[192:195],v[88:91]
SA s85,s38,28672
T a[76:77],v18,45056
T a[78:79],v18,47104
M v[88:91],a[116:119],v[208:211],v[88:91]
buffer_load_dwordx4 v0, s[12:15], s85 offen offset:0 lds
M v[88:91],a[120:123],v[224:227],v[88:91]
SA s85,s38,34816
T a[80:81],v18,49152
T a[82:83],v18,51200
M v[88:91],a[124:127],v[240:243],v[88:91]
T a[84:85],v18,53248
T a[86:87],v18,55296
M v[92:95],a[124:127],v[244:247],0
buffer_load_dwordx4 v0, s[12:15], s85 offen offset:1024 lds
M v[92:95],a[120:123],v[228:231],v[92:95]
SA s85,s38,40960
T a[88:89],v18,57344
T a[90:91],v18,59392
M v[92:95],a[116:119],v[212:215],v[92:95]
T a[92:93],v18,61440
T a[94:95],v18,63488
M v[92:95],a[112:115],v[196:199],v[92:95]
buffer_load_dwordx4 v0, s[12:15], s85 offen offset:2048 lds
M v[92:95],a[108:111],v[180:183],v[92:95]
SA s85,s38,47104
v_add_u32 v40, 0x20000, v18
v_add_u32 v41, 0x20000, v19
M v[92:95],a[104:107],v[164:167],v[92:95]
buffer_load_dwordx4 v0, s[12:15], s85 offen offset:3072 lds
M v[92:95],a[100:103],v[148:151],v[92:95]
s_waitcnt lgkmcnt(0)
v_add_u32 v42, 0x20000, v20
v_add_u32 v43, 0x20000, v21
M v[92:95],a[96:99],v[132:135],v[92:95]
SA s38,s38,128
MF v64,v5,v64
MF v65,v5,v65
MF v66,v5,v66
MF v67,v5,v67
MF v72,v5,v72
MF v73,v5,v73
MF v74,v5,v74
MF v75,v5,v75
C v64,v64,v65
C v65,v66,v67
C v66,v72,v73
C v67,v74,v75
buffer_store_dwordx4 v[64:67], v7, s[8:11], s29 offen offset:0 sc1
MF v68,v6,v68
MF v69,v6,v69
MF v70,v6,v70
MF v71,v6,v71
MF v76,v6,v76
MF v77,v6,v77
MF v78,v6,v78
MF v79,v6,v79
C v68,v68,v69
C v69,v70,v71
C v70,v76,v77
C v71,v78,v79
buffer_store_dwordx4 v[68:71], v7, s[8:11], s30 offen offset:0 sc1
M v[96:99],a[64:67],v[128:131],0
s_nop 0
T a[96:97],v19,32768
T a[98:99],v19,34816
M v[96:99],a[68:71],v[144:147],v[96:99]
SA m0,s28,98304
T a[100:101],v19,36864
T a[102:103],v19,38912
M v[96:99],a[72:75],v[160:163],v[96:99]
SA s85,s38,0
buffer_load_dwordx4 v0, s[12:15], s85 offen offset:0 lds
M v[96:99],a[76:79],v[176:179],v[96:99]
s_nop 0
T a[104:105],v19,40960
T a[106:107],v19,43008
M v[96:99],a[80:83],v[192:195],v[96:99]
T a[108:109],v19,45056
T a[110:111],v19,47104
M v[96:99],a[84:87],v[208:211],v[96:99]
SA s85,s38,6144
MF v80,v5,v80
MF v81,v5,v81
M v[96:99],a[88:91],v[224:227],v[96:99]
T a[112:113],v19,49152
T a[114:115],v19,51200
M v[96:99],a[92:95],v[240:243],v[96:99]
T a[116:117],v19,53248
T a[118:119],v19,55296
M v[100:103],a[92:95],v[244:247],0
buffer_load_dwordx4 v0, s[12:15], s85 offen offset:1024 lds
M v[100:103],a[88:91],v[228:231],v[100:103]
s_nop 0
T a[120:121],v19,57344
T a[122:123],v19,59392
M v[100:103],a[84:87],v[212:215],v[100:103]
T a[124:125],v19,61440
T a[126:127],v19,63488
M v[100:103],a[80:83],v[196:199],v[100:103]
SA s85,s38,12288
MF v82,v5,v82
MF v83,v5,v83
M v[100:103],a[76:79],v[180:183],v[100:103]
buffer_load_dwordx4 v0, s[12:15], s85 offen offset:2048 lds
M v[100:103],a[72:75],v[164:167],v[100:103]
MF v88,v5,v88
MF v89,v5,v89
M v[100:103],a[68:71],v[148:151],v[100:103]
MF v90,v5,v90
MF v91,v5,v91
M v[100:103],a[64:67],v[132:135],v[100:103]
s_waitcnt lgkmcnt(0)
C v80,v80,v81
C v81,v82,v83
M v[104:107],a[96:99],v[128:131],0
SA s85,s38,18432
T a[64:65],v20,32768
T a[66:67],v20,34816
M v[104:107],a[100:103],v[144:147],v[104:107]
T a[68:69],v20,36864
T a[70:71],v20,38912
M v[104:107],a[104:107],v[160:163],v[104:107]
buffer_load_dwordx4 v0, s[12:15], s85 offen offset:3072 lds
M v[104:107],a[108:111],v[176:179],v[104:107]
s_nop 0
T a[72:73],v20,40960
T a[74:75],v20,43008
M v[104:107],a[112:115],v[192:195],v[104:107]
T a[76:77],v20,45056
T a[78:79],v20,47104
M v[104:107],a[116:119],v[208:211],v[104:107]
SA m0,s28,102400
C v82,v88,v89
C v83,v90,v91
M v[104:107],a[120:123],v[224:227],v[104:107]
SA s85,s38,28672
T a[80:81],v20,49152
T a[82:83],v20,51200
M v[104:107],a[124:127],v[240:243],v[104:107]
T a[84:85],v20,53248
T a[86:87],v20,55296
M v[108:111],a[124:127],v[244:247],0
buffer_store_dwordx4 v[80:83], v7, s[8:11], s29 offen offset:1024 sc1
M v[108:111],a[120:123],v[228:231],v[108:111]
s_nop 0
T a[88:89],v20,57344
T a[90:91],v20,59392
M v[108:111],a[116:119],v[212:215],v[108:111]
T a[92:93],v20,61440
T a[94:95],v20,63488
M v[108:111],a[112:115],v[196:199],v[108:111]
buffer_load_dwordx4 v0, s[12:15], s85 offen offset:0 lds
M v[108:111],a[108:111],v[180:183],v[108:111]
SA s85,s38,34816
MF v84,v6,v84
MF v85,v6,v85
M v[108:111],a[104:107],v[164:167],v[108:111]
MF v86,v6,v86
MF v87,v6,v87
M v[108:111],a[100:103],v[148:151],v[108:111]
buffer_load_dwordx4 v0, s[12:15], s85 offen offset:1024 lds
M v[108:111],a[96:99],v[132:135],v[108:111]
s_waitcnt lgkmcnt(0)
MF v92,v6,v92
MF v93,v6,v93
M v[112:115],a[64:67],v[128:131],0
T a[96:97],v21,32768
T a[98:99],v21,34816
M v[112:115],a[68:71],v[144:147],v[112:115]
SA s85,s38,40960
T a[100:101],v21,36864
T a[102:103],v21,38912
M v[112:115],a[72:75],v[160:163],v[112:115]
buffer_load_dwordx4 v0, s[12:15], s85 offen offset:2048 lds
M v[112:115],a[76:79],v[176:179],v[112:115]
s_nop 0
T a[104:105],v21,40960
T a[106:107],v21,43008
M v[112:115],a[80:83],v[192:195],v[112:115]
T a[108:109],v21,45056
T a[110:111],v21,47104
M v[112:115],a[84:87],v[208:211],v[112:115]
MF v94,v6,v94
MF v95,v6,v95
M v[112:115],a[88:91],v[224:227],v[112:115]
SA s85,s38,47104
T a[112:113],v21,49152
T a[114:115],v21,51200
M v[112:115],a[92:95],v[240:243],v[112:115]
T a[116:117],v21,53248
T a[118:119],v21,55296
M v[116:119],a[92:95],v[244:247],0
buffer_load_dwordx4 v0, s[12:15], s85 offen offset:3072 lds
M v[116:119],a[88:91],v[228:231],v[116:119]
s_nop 0
T a[120:121],v21,57344
T a[122:123],v21,59392
M v[116:119],a[84:87],v[212:215],v[116:119]
T a[124:125],v21,61440
T a[126:127],v21,63488
M v[116:119],a[80:83],v[196:199],v[116:119]
C v84,v84,v85
C v85,v86,v87
M v[116:119],a[76:79],v[180:183],v[116:119]
C v86,v92,v93
C v87,v94,v95
M v[116:119],a[72:75],v[164:167],v[116:119]
SA s38,s38,128
buffer_store_dwordx4 v[84:87], v7, s[8:11], s30 offen offset:1024 sc1
M v[116:119],a[68:71],v[148:151],v[116:119]
s_waitcnt vmcnt(28) lgkmcnt(0)
M v[116:119],a[64:67],v[132:135],v[116:119]
s_barrier
M v[120:123],a[96:99],v[128:131],0
SA s29,s33,2048
T a[64:65],v22,0
T a[66:67],v22,2048
M v[120:123],a[100:103],v[144:147],v[120:123]
SA s30,s33,16384
T a[68:69],v22,4096
T a[70:71],v22,6144
M v[120:123],a[104:107],v[160:163],v[120:123]
MF v96,v5,v96
MF v97,v5,v97
M v[120:123],a[108:111],v[176:179],v[120:123]
T a[72:73],v22,8192
T a[74:75],v22,10240
M v[120:123],a[112:115],v[192:195],v[120:123]
T a[76:77],v22,12288
T a[78:79],v22,14336
M v[120:123],a[116:119],v[208:211],v[120:123]
MF v98,v5,v98
MF v99,v5,v99
M v[120:123],a[120:123],v[224:227],v[120:123]
T a[80:81],v22,16384
T a[82:83],v22,18432
M v[120:123],a[124:127],v[240:243],v[120:123]
T a[84:85],v22,20480
T a[86:87],v22,22528
M v[124:127],a[124:127],v[244:247],0
MF v104,v5,v104
MF v105,v5,v105
M v[124:127],a[120:123],v[228:231],v[124:127]
T a[88:89],v22,24576
T a[90:91],v22,26624
M v[124:127],a[116:119],v[212:215],v[124:127]
T a[92:93],v22,28672
T a[94:95],v22,30720
M v[124:127],a[112:115],v[196:199],v[124:127]
MF v106,v5,v106
MF v107,v5,v107
M v[124:127],a[108:111],v[180:183],v[124:127]
C v96,v96,v97
C v97,v98,v99
M v[124:127],a[104:107],v[164:167],v[124:127]
C v98,v104,v105
C v99,v106,v107
M v[124:127],a[100:103],v[148:151],v[124:127]
s_waitcnt lgkmcnt(0)
buffer_store_dwordx4 v[96:99], v7, s[8:11], s29 offen offset:0 sc1
M v[124:127],a[96:99],v[132:135],v[124:127]
MF v100,v6,v100
MF v101,v6,v101
MF v102,v6,v102
MF v103,v6,v103
MF v108,v6,v108
MF v109,v6,v109
MF v110,v6,v110
MF v111,v6,v111
C v100,v100,v101
C v101,v102,v103
C v102,v108,v109
C v103,v110,v111
buffer_store_dwordx4 v[100:103], v7, s[8:11], s30 offen offset:0 sc1
M v[64:67],a[64:67],v[128:131],0
s_nop 0
T a[96:97],v23,0
T a[98:99],v23,2048
M v[64:67],a[68:71],v[144:147],v[64:67]
SA m0,s28,32768
T a[100:101],v23,4096
T a[102:103],v23,6144
M v[64:67],a[72:75],v[160:163],v[64:67]
SA s85,s38,0
buffer_load_dwordx4 v0, s[12:15], s85 offen offset:0 lds
M v[64:67],a[76:79],v[176:179],v[64:67]
s_nop 0
T a[104:105],v23,8192
T a[106:107],v23,10240
M v[64:67],a[80:83],v[192:195],v[64:67]
T a[108:109],v23,12288
T a[110:111],v23,14336
M v[64:67],a[84:87],v[208:211],v[64:67]
SA s85,s38,6144
MF v112,v5,v112
MF v113,v5,v113
M v[64:67],a[88:91],v[224:227],v[64:67]
T a[112:113],v23,16384
T a[114:115],v23,18432
M v[64:67],a[92:95],v[240:243],v[64:67]
T a[116:117],v23,20480
T a[118:119],v23,22528
M v[68:71],a[92:95],v[244:247],0
buffer_load_dwordx4 v0, s[12:15], s85 offen offset:1024 lds
M v[68:71],a[88:91],v[228:231],v[68:71]
s_nop 0
T a[120:121],v23,24576
T a[122:123],v23,26624
M v[68:71],a[84:87],v[212:215],v[68:71]
T a[124:125],v23,28672
T a[126:127],v23,30720
M v[68:71],a[80:83],v[196:199],v[68:71]
SA s85,s38,12288
MF v114,v5,v114
MF v115,v5,v115
M v[68:71],a[76:79],v[180:183],v[68:71]
buffer_load_dwordx4 v0, s[12:15], s85 offen offset:2048 lds
M v[68:71],a[72:75],v[164:167],v[68:71]
MF v120,v5,v120
MF v121,v5,v121
M v[68:71],a[68:71],v[148:151],v[68:71]
MF v122,v5,v122
MF v123,v5,v123
M v[68:71],a[64:67],v[132:135],v[68:71]
s_waitcnt lgkmcnt(0)
C v112,v112,v113
C v113,v114,v115
M v[72:75],a[96:99],v[128:131],0
SA s85,s38,18432
T a[64:65],v24,0
T a[66:67],v24,2048
M v[72:75],a[100:103],v[144:147],v[72:75]
T a[68:69],v24,4096
T a[70:71],v24,6144
M v[72:75],a[104:107],v[160:163],v[72:75]
buffer_load_dwordx4 v0, s[12:15], s85 offen offset:3072 lds
M v[72:75],a[108:111],v[176:179],v[72:75]
s_nop 0
T a[72:73],v24,8192
T a[74:75],v24,10240
M v[72:75],a[112:115],v[192:195],v[72:75]
T a[76:77],v24,12288
T a[78:79],v24,14336
M v[72:75],a[116:119],v[208:211],v[72:75]
SA m0,s28,36864
C v114,v120,v121
C v115,v122,v123
M v[72:75],a[120:123],v[224:227],v[72:75]
SA s85,s38,28672
T a[80:81],v24,16384
T a[82:83],v24,18432
M v[72:75],a[124:127],v[240:243],v[72:75]
T a[84:85],v24,20480
T a[86:87],v24,22528
M v[76:79],a[124:127],v[244:247],0
buffer_store_dwordx4 v[112:115], v7, s[8:11], s29 offen offset:1024 sc1
M v[76:79],a[120:123],v[228:231],v[76:79]
s_nop 0
T a[88:89],v24,24576
T a[90:91],v24,26624
M v[76:79],a[116:119],v[212:215],v[76:79]
T a[92:93],v24,28672
T a[94:95],v24,30720
M v[76:79],a[112:115],v[196:199],v[76:79]
buffer_load_dwordx4 v0, s[12:15], s85 offen offset:0 lds
M v[76:79],a[108:111],v[180:183],v[76:79]
SA s85,s38,34816
MF v116,v6,v116
MF v117,v6,v117
M v[76:79],a[104:107],v[164:167],v[76:79]
MF v118,v6,v118
MF v119,v6,v119
M v[76:79],a[100:103],v[148:151],v[76:79]
buffer_load_dwordx4 v0, s[12:15], s85 offen offset:1024 lds
M v[76:79],a[96:99],v[132:135],v[76:79]
s_waitcnt lgkmcnt(0)
MF v124,v6,v124
MF v125,v6,v125
M v[80:83],a[64:67],v[128:131],0
T a[96:97],v25,0
T a[98:99],v25,2048
M v[80:83],a[68:71],v[144:147],v[80:83]
SA s85,s38,40960
T a[100:101],v25,4096
T a[102:103],v25,6144
M v[80:83],a[72:75],v[160:163],v[80:83]
buffer_load_dwordx4 v0, s[12:15], s85 offen offset:2048 lds
M v[80:83],a[76:79],v[176:179],v[80:83]
s_nop 0
T a[104:105],v25,8192
T a[106:107],v25,10240
M v[80:83],a[80:83],v[192:195],v[80:83]
T a[108:109],v25,12288
T a[110:111],v25,14336
M v[80:83],a[84:87],v[208:211],v[80:83]
MF v126,v6,v126
MF v127,v6,v127
M v[80:83],a[88:91],v[224:227],v[80:83]
SA s85,s38,47104
T a[112:113],v25,16384
T a[114:115],v25,18432
M v[80:83],a[92:95],v[240:243],v[80:83]
T a[116:117],v25,20480
T a[118:119],v25,22528
M v[84:87],a[92:95],v[244:247],0
buffer_load_dwordx4 v0, s[12:15], s85 offen offset:3072 lds
M v[84:87],a[88:91],v[228:231],v[84:87]
s_nop 0
T a[120:121],v25,24576
T a[122:123],v25,26624
M v[84:87],a[84:87],v[212:215],v[84:87]
T a[124:125],v25,28672
T a[126:127],v25,30720
M v[84:87],a[80:83],v[196:199],v[84:87]
C v116,v116,v117
C v117,v118,v119
M v[84:87],a[76:79],v[180:183],v[84:87]
C v118,v124,v125
C v119,v126,v127
M v[84:87],a[72:75],v[164:167],v[84:87]
SA s38,s38,128
buffer_store_dwordx4 v[116:119], v7, s[8:11], s30 offen offset:1024 sc1
M v[84:87],a[68:71],v[148:151],v[84:87]
s_waitcnt vmcnt(32) lgkmcnt(0)
M v[84:87],a[64:67],v[132:135],v[84:87]
s_barrier
M v[88:91],a[96:99],v[128:131],0
SA s29,s33,4096
T a[64:65],v18,0
T a[66:67],v18,2048
M v[88:91],a[100:103],v[144:147],v[88:91]
SA s30,s33,18432
T a[68:69],v18,4096
T a[70:71],v18,6144
M v[88:91],a[104:107],v[160:163],v[88:91]
MF v64,v5,v64
MF v65,v5,v65
M v[88:91],a[108:111],v[176:179],v[88:91]
T a[72:73],v18,8192
T a[74:75],v18,10240
M v[88:91],a[112:115],v[192:195],v[88:91]
T a[76:77],v18,12288
T a[78:79],v18,14336
M v[88:91],a[116:119],v[208:211],v[88:91]
MF v66,v5,v66
MF v67,v5,v67
M v[88:91],a[120:123],v[224:227],v[88:91]
T a[80:81],v18,16384
T a[82:83],v18,18432
M v[88:91],a[124:127],v[240:243],v[88:91]
T a[84:85],v18,20480
T a[86:87],v18,22528
M v[92:95],a[124:127],v[244:247],0
MF v72,v5,v72
MF v73,v5,v73
M v[92:95],a[120:123],v[228:231],v[92:95]
T a[88:89],v18,24576
T a[90:91],v18,26624
M v[92:95],a[116:119],v[212:215],v[92:95]
T a[92:93],v18,28672
T a[94:95],v18,30720
M v[92:95],a[112:115],v[196:199],v[92:95]
MF v74,v5,v74
MF v75,v5,v75
M v[92:95],a[108:111],v[180:183],v[92:95]
C v64,v64,v65
C v65,v66,v67
M v[92:95],a[104:107],v[164:167],v[92:95]
C v66,v72,v73
C v67,v74,v75
M v[92:95],a[100:103],v[148:151],v[92:95]
s_waitcnt lgkmcnt(0)
buffer_store_dwordx4 v[64:67], v7, s[8:11], s29 offen offset:0 sc1
M v[92:95],a[96:99],v[132:135],v[92:95]
MF v68,v6,v68
MF v69,v6,v69
MF v70,v6,v70
MF v71,v6,v71
MF v76,v6,v76
MF v77,v6,v77
MF v78,v6,v78
MF v79,v6,v79
C v68,v68,v69
C v69,v70,v71
C v70,v76,v77
C v71,v78,v79
buffer_store_dwordx4 v[68:71], v7, s[8:11], s30 offen offset:0 sc1
M v[96:99],a[64:67],v[128:131],0
s_nop 0
T a[96:97],v19,0
T a[98:99],v19,2048
M v[96:99],a[68:71],v[144:147],v[96:99]
T a[100:101],v19,4096
T a[102:103],v19,6144
M v[96:99],a[72:75],v[160:163],v[96:99]
MF v80,v5,v80
MF v81,v5,v81
M v[96:99],a[76:79],v[176:179],v[96:99]
T a[104:105],v19,8192
T a[106:107],v19,10240
M v[96:99],a[80:83],v[192:195],v[96:99]
T a[108:109],v19,12288
T a[110:111],v19,14336
M v[96:99],a[84:87],v[208:211],v[96:99]
MF v82,v5,v82
MF v83,v5,v83
M v[96:99],a[88:91],v[224:227],v[96:99]
T a[112:113],v19,16384
T a[114:115],v19,18432
M v[96:99],a[92:95],v[240:243],v[96:99]
T a[116:117],v19,20480
T a[118:119],v19,22528
M v[100:103],a[92:95],v[244:247],0
MF v88,v5,v88
MF v89,v5,v89
M v[100:103],a[88:91],v[228:231],v[100:103]
T a[120:121],v19,24576
T a[122:123],v19,26624
M v[100:103],a[84:87],v[212:215],v[100:103]
T a[124:125],v19,28672
T a[126:127],v19,30720
M v[100:103],a[80:83],v[196:199],v[100:103]
MF v90,v5,v90
MF v91,v5,v91
M v[100:103],a[76:79],v[180:183],v[100:103]
C v80,v80,v81
C v81,v82,v83
M v[100:103],a[72:75],v[164:167],v[100:103]
C v82,v88,v89
C v83,v90,v91
M v[100:103],a[68:71],v[148:151],v[100:103]
buffer_store_dwordx4 v[80:83], v7, s[8:11], s29 offen offset:1024 sc1
M v[100:103],a[64:67],v[132:135],v[100:103]
s_waitcnt lgkmcnt(0)
MF v84,v6,v84
MF v85,v6,v85
M v[104:107],a[96:99],v[128:131],0
T a[64:65],v20,0
T a[66:67],v20,2048
M v[104:107],a[100:103],v[144:147],v[104:107]
T a[68:69],v20,4096
T a[70:71],v20,6144
M v[104:107],a[104:107],v[160:163],v[104:107]
MF v86,v6,v86
MF v87,v6,v87
M v[104:107],a[108:111],v[176:179],v[104:107]
T a[72:73],v20,8192
T a[74:75],v20,10240
M v[104:107],a[112:115],v[192:195],v[104:107]
T a[76:77],v20,12288
T a[78:79],v20,14336
M v[104:107],a[116:119],v[208:211],v[104:107]
MF v92,v6,v92
MF v93,v6,v93
M v[104:107],a[120:123],v[224:227],v[104:107]
T a[80:81],v20,16384
T a[82:83],v20,18432
M v[104:107],a[124:127],v[240:243],v[104:107]
T a[84:85],v20,20480
T a[86:87],v20,22528
M v[108:111],a[124:127],v[244:247],0
MF v94,v6,v94
MF v95,v6,v95
M v[108:111],a[120:123],v[228:231],v[108:111]
T a[88:89],v20,24576
T a[90:91],v20,26624
M v[108:111],a[116:119],v[212:215],v[108:111]
T a[92:93],v20,28672
T a[94:95],v20,30720
M v[108:111],a[112:115],v[196:199],v[108:111]
C v84,v84,v85
C v85,v86,v87
M v[108:111],a[108:111],v[180:183],v[108:111]
C v86,v92,v93
C v87,v94,v95
M v[108:111],a[104:107],v[164:167],v[108:111]
buffer_store_dwordx4 v[84:87], v7, s[8:11], s30 offen offset:1024 sc1
M v[108:111],a[100:103],v[148:151],v[108:111]
SA s29,s33,6144
M v[108:111],a[96:99],v[132:135],v[108:111]
s_waitcnt lgkmcnt(0)
M v[112:115],a[64:67],v[128:131],0
SA s30,s33,20480
T a[96:97],v21,0
T a[98:99],v21,2048
M v[112:115],a[68:71],v[144:147],v[112:115]
T a[100:101],v21,4096
T a[102:103],v21,6144
M v[112:115],a[72:75],v[160:163],v[112:115]
MF v96,v5,v96
MF v97,v5,v97
M v[112:115],a[76:79],v[176:179],v[112:115]
T a[104:105],v21,8192
T a[106:107],v21,10240
M v[112:115],a[80:83],v[192:195],v[112:115]
T a[108:109],v21,12288
T a[110:111],v21,14336
M v[112:115],a[84:87],v[208:211],v[112:115]
MF v98,v5,v98
MF v99,v5,v99
M v[112:115],a[88:91],v[224:227],v[112:115]
T a[112:113],v21,16384
T a[114:115],v21,18432
M v[112:115],a[92:95],v[240:243],v[112:115]
T a[116:117],v21,20480
T a[118:119],v21,22528
M v[116:119],a[92:95],v[244:247],0
MF v104,v5,v104
MF v105,v5,v105
M v[116:119],a[88:91],v[228:231],v[116:119]
T a[120:121],v21,24576
T a[122:123],v21,26624
M v[116:119],a[84:87],v[212:215],v[116:119]
T a[124:125],v21,28672
T a[126:127],v21,30720
M v[116:119],a[80:83],v[196:199],v[116:119]
MF v106,v5,v106
MF v107,v5,v107
M v[116:119],a[76:79],v[180:183],v[116:119]
C v96,v96,v97
C v97,v98,v99
M v[116:119],a[72:75],v[164:167],v[116:119]
C v98,v104,v105
C v99,v106,v107
M v[116:119],a[68:71],v[148:151],v[116:119]
s_waitcnt vmcnt(28) lgkmcnt(0)
buffer_store_dwordx4 v[96:99], v7, s[8:11], s29 offen offset:0 sc1
M v[116:119],a[64:67],v[132:135],v[116:119]
s_barrier
M v[120:123],a[96:99],v[128:131],0
s_nop 0
T a[64:65],v40,0
T a[66:67],v40,2048
M v[120:123],a[100:103],v[144:147],v[120:123]
T a[68:69],v40,4096
T a[70:71],v40,6144
M v[120:123],a[104:107],v[160:163],v[120:123]
MF v100,v6,v100
MF v101,v6,v101
M v[120:123],a[108:111],v[176:179],v[120:123]
T a[72:73],v40,8192
T a[74:75],v40,10240
M v[120:123],a[112:115],v[192:195],v[120:123]
T a[76:77],v40,12288
T a[78:79],v40,14336
M v[120:123],a[116:119],v[208:211],v[120:123]
MF v102,v6,v102
MF v103,v6,v103
M v[120:123],a[120:123],v[224:227],v[120:123]
T a[80:81],v40,16384
T a[82:83],v40,18432
M v[120:123],a[124:127],v[240:243],v[120:123]
T a[84:85],v40,20480
T a[86:87],v40,22528
M v[124:127],a[124:127],v[244:247],0
MF v108,v6,v108
MF v109,v6,v109
M v[124:127],a[120:123],v[228:231],v[124:127]
T a[88:89],v40,24576
T a[90:91],v40,26624
M v[124:127],a[116:119],v[212:215],v[124:127]
T a[92:93],v40,28672
T a[94:95],v40,30720
M v[124:127],a[112:115],v[196:199],v[124:127]
MF v110,v6,v110
MF v111,v6,v111
M v[124:127],a[108:111],v[180:183],v[124:127]
C v100,v100,v101
C v101,v102,v103
M v[124:127],a[104:107],v[164:167],v[124:127]
C v102,v108,v109
C v103,v110,v111
M v[124:127],a[100:103],v[148:151],v[124:127]
s_waitcnt lgkmcnt(0)
buffer_store_dwordx4 v[100:103], v7, s[8:11], s30 offen offset:0 sc1
M v[124:127],a[96:99],v[132:135],v[124:127]
M v[64:67],a[64:67],v[128:131],0
s_nop 0
T a[96:97],v41,0
T a[98:99],v41,2048
M v[64:67],a[68:71],v[144:147],v[64:67]
T a[100:101],v41,4096
T a[102:103],v41,6144
M v[64:67],a[72:75],v[160:163],v[64:67]
v_lshrrev_b32 v32, 4, v7
MF v112,v5,v112
M v[64:67],a[76:79],v[176:179],v[64:67]
s_lshr_b32 s74, s41, 3
T a[104:105],v41,8192
T a[106:107],v41,10240
M v[64:67],a[80:83],v[192:195],v[64:67]
s_sub_u32 s64, 15, s42
T a[108:109],v41,12288
T a[110:111],v41,14336
M v[64:67],a[84:87],v[208:211],v[64:67]
s_mul_i32 s46, s64, 8704
MF v113,v5,v113
MF v114,v5,v114
M v[64:67],a[88:91],v[224:227],v[64:67]
s_and_b32 s72, s41, 7
T a[112:113],v41,16384
T a[114:115],v41,18432
M v[64:67],a[92:95],v[240:243],v[64:67]
s_lshl_b32 s65, s72, 7
T a[116:117],v41,20480
T a[118:119],v41,22528
M v[68:71],a[92:95],v[244:247],0
SA s46,s46,s65
MF v115,v5,v115
MF v120,v5,v120
M v[68:71],a[88:91],v[228:231],v[68:71]
SA s46,s46,104993792
T a[120:121],v41,24576
T a[122:123],v41,26624
M v[68:71],a[84:87],v[212:215],v[68:71]
T a[124:125],v41,28672
T a[126:127],v41,30720
M v[68:71],a[80:83],v[196:199],v[68:71]
v_and_b32 v33, 31, v32
MF v121,v5,v121
M v[68:71],a[76:79],v[180:183],v[68:71]
MF v122,v5,v122
MF v123,v5,v123
M v[68:71],a[72:75],v[164:167],v[68:71]
C v112,v112,v113
C v113,v114,v115
M v[68:71],a[68:71],v[148:151],v[68:71]
C v114,v120,v121
C v115,v122,v123
M v[68:71],a[64:67],v[132:135],v[68:71]
s_waitcnt lgkmcnt(0)
buffer_store_dwordx4 v[112:115], v7, s[8:11], s29 offen offset:1024 sc1
M v[72:75],a[96:99],v[128:131],0
s_nop 0
T a[64:65],v42,0
T a[66:67],v42,2048
M v[72:75],a[100:103],v[144:147],v[72:75]
T a[68:69],v42,4096
T a[70:71],v42,6144
M v[72:75],a[104:107],v[160:163],v[72:75]
MF v116,v6,v116
MF v117,v6,v117
M v[72:75],a[108:111],v[176:179],v[72:75]
T a[72:73],v42,8192
T a[74:75],v42,10240
M v[72:75],a[112:115],v[192:195],v[72:75]
T a[76:77],v42,12288
T a[78:79],v42,14336
M v[72:75],a[116:119],v[208:211],v[72:75]
MF v118,v6,v118
MF v119,v6,v119
M v[72:75],a[120:123],v[224:227],v[72:75]
T a[80:81],v42,16384
T a[82:83],v42,18432
M v[72:75],a[124:127],v[240:243],v[72:75]
T a[84:85],v42,20480
T a[86:87],v42,22528
M v[76:79],a[124:127],v[244:247],0
MF v124,v6,v124
MF v125,v6,v125
M v[76:79],a[120:123],v[228:231],v[76:79]
T a[88:89],v42,24576
T a[90:91],v42,26624
M v[76:79],a[116:119],v[212:215],v[76:79]
T a[92:93],v42,28672
T a[94:95],v42,30720
M v[76:79],a[112:115],v[196:199],v[76:79]
MF v126,v6,v126
MF v127,v6,v127
M v[76:79],a[108:111],v[180:183],v[76:79]
C v116,v116,v117
C v117,v118,v119
M v[76:79],a[104:107],v[164:167],v[76:79]
C v118,v124,v125
C v119,v126,v127
M v[76:79],a[100:103],v[148:151],v[76:79]
buffer_store_dwordx4 v[116:119], v7, s[8:11], s30 offen offset:1024 sc1
M v[76:79],a[96:99],v[132:135],v[76:79]
s_waitcnt lgkmcnt(0)
v_lshlrev_b32 v33, 2, v33
M v[80:83],a[64:67],v[128:131],0
SA s29,s33,8192
T a[96:97],v43,0
T a[98:99],v43,2048
M v[80:83],a[68:71],v[144:147],v[80:83]
SA s30,s33,22528
T a[100:101],v43,4096
T a[102:103],v43,6144
M v[80:83],a[72:75],v[160:163],v[80:83]
s_lshl_b32 s65, s41, 7
MF v64,v5,v64
MF v65,v5,v65
M v[80:83],a[76:79],v[176:179],v[80:83]
SA s65,s65,104890368
T a[104:105],v43,8192
T a[106:107],v43,10240
M v[80:83],a[80:83],v[192:195],v[80:83]
T a[108:109],v43,12288
T a[110:111],v43,14336
M v[80:83],a[84:87],v[208:211],v[80:83]
buffer_load_dword v31, v33, s[8:11], s65 offen sc1
M v[80:83],a[88:91],v[224:227],v[80:83]
s_nop 0
T a[112:113],v43,16384
T a[114:115],v43,18432
M v[80:83],a[92:95],v[240:243],v[80:83]
T a[116:117],v43,20480
T a[118:119],v43,22528
M v[84:87],a[92:95],v[244:247],0
s_cmp_ge_u32 s42, 8
v_bfe_u32 v34, v32, 4, 1
v_lshlrev_b32 v34, 1, v34
M v[84:87],a[88:91],v[228:231],v[84:87]
s_cselect_b32 s84, s45, 536870912
T a[120:121],v43,24576
T a[122:123],v43,26624
M v[84:87],a[84:87],v[212:215],v[84:87]
T a[124:125],v43,28672
T a[126:127],v43,30720
M v[84:87],a[80:83],v[196:199],v[84:87]
v_lshrrev_b32 v35, 5, v32
v_add_u32 v34, v34, v35
M v[84:87],a[76:79],v[180:183],v[84:87]
s_mov_b32 s52, s96
MF v66,v5,v66
MF v67,v5,v67
M v[84:87],a[72:75],v[164:167],v[84:87]
s_and_b32 s53, s97, 0xffff
MF v72,v5,v72
MF v73,v5,v73
M v[84:87],a[68:71],v[148:151],v[84:87]
s_waitcnt vmcnt(22) lgkmcnt(0)
MF v74,v5,v74
MF v75,v5,v75
M v[84:87],a[64:67],v[132:135],v[84:87]
s_barrier
M v[88:91],a[96:99],v[128:131],0
s_mov_b32 s54, 1835008
T a[64:65],v22,32768
T a[66:67],v22,34816
M v[88:91],a[100:103],v[144:147],v[88:91]
s_mov_b32 s55, 0x20000
T a[68:69],v22,36864
T a[70:71],v22,38912
M v[88:91],a[104:107],v[160:163],v[88:91]
s_mul_i32 s77, s42, 1835008
C v64,v64,v65
C v65,v66,v67
M v[88:91],a[108:111],v[176:179],v[88:91]
s_mul_i32 s78, s72, 14336
T a[72:73],v22,40960
T a[74:75],v22,43008
M v[88:91],a[112:115],v[192:195],v[88:91]
SA s77,s77,s78
T a[76:77],v22,45056
T a[78:79],v22,47104
M v[88:91],a[116:119],v[208:211],v[88:91]
SA s77,s77,67108864
C v66,v72,v73
C v67,v74,v75
M v[88:91],a[120:123],v[224:227],v[88:91]
s_lshl_b32 s79, s74, 2
T a[80:81],v22,49152
T a[82:83],v22,51200
M v[88:91],a[124:127],v[240:243],v[88:91]
SA s79,s79,s20
T a[84:85],v22,53248
T a[86:87],v22,55296
M v[92:95],a[124:127],v[244:247],0
SA s79,s79,6
buffer_store_dwordx4 v[64:67], v7, s[8:11], s29 offen offset:0 sc1
M v[92:95],a[120:123],v[228:231],v[92:95]
s_sub_u32 s67, 13, s79
T a[88:89],v22,57344
T a[90:91],v22,59392
M v[92:95],a[116:119],v[212:215],v[92:95]
s_and_b32 s67, s67, 536870912
T a[92:93],v22,61440
T a[94:95],v22,63488
M v[92:95],a[112:115],v[196:199],v[92:95]
s_lshl_b32 s78, s79, 10
MF v68,v6,v68
MF v69,v6,v69
M v[92:95],a[108:111],v[180:183],v[92:95]
SA s78,s78,s77
MF v70,v6,v70
MF v71,v6,v71
M v[92:95],a[104:107],v[164:167],v[92:95]
s_lshl_b32 s79, s79, 6
MF v76,v6,v76
MF v77,v6,v77
M v[92:95],a[100:103],v[148:151],v[92:95]
s_waitcnt lgkmcnt(0)
MF v78,v6,v78
MF v79,v6,v79
M v[92:95],a[96:99],v[132:135],v[92:95]
s_or_b32 s79, s79, s67
v_or_b32 v27, s67, v7
s_lshr_b32 s73, s72, 1
s_sub_u32 s65, 7, s73
s_bitcmp1_b32 s72, 0
s_cselect_b32 s73, s65, s73
s_lshl_b32 s73, s73, 4
s_lshl_b32 s65, s42, 7
SA s73,s73,s65
v_and_b32 v29, 15, v32
v_add_u32 v29, s73, v29
s_mov_b32 s64, 104857664
v_mul_u32_u24 v28, 896, v29
v_lshl_add_u32 v28, v34, 4, v28
C v68,v68,v69
C v69,v70,v71
C v70,v76,v77
C v71,v78,v79
buffer_store_dwordx4 v[68:71], v7, s[8:11], s30 offen offset:0 sc1
v_lshrrev_b32 v35, 4, v29
v_lshlrev_b32 v35, 5, v35
v_and_b32 v36, 15, v29
v_add_lshl_u32 v35, v35, v36, 2
buffer_load_dword v26, v35, s[8:11], s64 offen sc1
s_waitcnt vmcnt(8)
buffer_store_dword v15, v17, s[8:11], s84 offen sc1
buffer_load_dwordx4 v[44:47], v28, s[56:59], s79 offen
M v[96:99],a[64:67],v[128:131],0
s_nop 0
T a[96:97],v23,32768
T a[98:99],v23,34816
M v[96:99],a[68:71],v[144:147],v[96:99]
T a[100:101],v23,36864
T a[102:103],v23,38912
M v[96:99],a[72:75],v[160:163],v[96:99]
MF v80,v5,v80
MF v81,v5,v81
M v[96:99],a[76:79],v[176:179],v[96:99]
T a[104:105],v23,40960
T a[106:107],v23,43008
M v[96:99],a[80:83],v[192:195],v[96:99]
T a[108:109],v23,45056
T a[110:111],v23,47104
M v[96:99],a[84:87],v[208:211],v[96:99]
MF v82,v5,v82
MF v83,v5,v83
M v[96:99],a[88:91],v[224:227],v[96:99]
T a[112:113],v23,49152
T a[114:115],v23,51200
M v[96:99],a[92:95],v[240:243],v[96:99]
T a[116:117],v23,53248
T a[118:119],v23,55296
M v[100:103],a[92:95],v[244:247],0
MF v88,v5,v88
MF v89,v5,v89
M v[100:103],a[88:91],v[228:231],v[100:103]
T a[120:121],v23,57344
T a[122:123],v23,59392
M v[100:103],a[84:87],v[212:215],v[100:103]
T a[124:125],v23,61440
T a[126:127],v23,63488
M v[100:103],a[80:83],v[196:199],v[100:103]
MF v90,v5,v90
MF v91,v5,v91
M v[100:103],a[76:79],v[180:183],v[100:103]
C v80,v80,v81
C v81,v82,v83
M v[100:103],a[72:75],v[164:167],v[100:103]
C v82,v88,v89
C v83,v90,v91
M v[100:103],a[68:71],v[148:151],v[100:103]
buffer_store_dwordx4 v[80:83], v7, s[8:11], s29 offen offset:1024 sc1
M v[100:103],a[64:67],v[132:135],v[100:103]
s_waitcnt lgkmcnt(0)
MF v84,v6,v84
MF v85,v6,v85
M v[104:107],a[96:99],v[128:131],0
T a[64:65],v24,32768
T a[66:67],v24,34816
M v[104:107],a[100:103],v[144:147],v[104:107]
T a[68:69],v24,36864
T a[70:71],v24,38912
M v[104:107],a[104:107],v[160:163],v[104:107]
MF v86,v6,v86
MF v87,v6,v87
M v[104:107],a[108:111],v[176:179],v[104:107]
T a[72:73],v24,40960
T a[74:75],v24,43008
M v[104:107],a[112:115],v[192:195],v[104:107]
T a[76:77],v24,45056
T a[78:79],v24,47104
M v[104:107],a[116:119],v[208:211],v[104:107]
MF v92,v6,v92
MF v93,v6,v93
M v[104:107],a[120:123],v[224:227],v[104:107]
T a[80:81],v24,49152
T a[82:83],v24,51200
M v[104:107],a[124:127],v[240:243],v[104:107]
T a[84:85],v24,53248
T a[86:87],v24,55296
M v[108:111],a[124:127],v[244:247],0
MF v94,v6,v94
MF v95,v6,v95
M v[108:111],a[120:123],v[228:231],v[108:111]
T a[88:89],v24,57344
T a[90:91],v24,59392
M v[108:111],a[116:119],v[212:215],v[108:111]
T a[92:93],v24,61440
T a[94:95],v24,63488
M v[108:111],a[112:115],v[196:199],v[108:111]
C v84,v84,v85
C v85,v86,v87
M v[108:111],a[108:111],v[180:183],v[108:111]
C v86,v92,v93
C v87,v94,v95
M v[108:111],a[104:107],v[164:167],v[108:111]
buffer_store_dwordx4 v[84:87], v7, s[8:11], s30 offen offset:1024 sc1
M v[108:111],a[100:103],v[148:151],v[108:111]
SA s29,s33,10240
M v[108:111],a[96:99],v[132:135],v[108:111]
s_waitcnt lgkmcnt(0)
M v[112:115],a[64:67],v[128:131],0
SA s30,s33,24576
T a[96:97],v25,32768
T a[98:99],v25,34816
M v[112:115],a[68:71],v[144:147],v[112:115]
T a[100:101],v25,36864
T a[102:103],v25,38912
M v[112:115],a[72:75],v[160:163],v[112:115]
MF v96,v5,v96
MF v97,v5,v97
M v[112:115],a[76:79],v[176:179],v[112:115]
T a[104:105],v25,40960
T a[106:107],v25,43008
M v[112:115],a[80:83],v[192:195],v[112:115]
T a[108:109],v25,45056
T a[110:111],v25,47104
M v[112:115],a[84:87],v[208:211],v[112:115]
MF v98,v5,v98
MF v99,v5,v99
M v[112:115],a[88:91],v[224:227],v[112:115]
T a[112:113],v25,49152
T a[114:115],v25,51200
M v[112:115],a[92:95],v[240:243],v[112:115]
T a[116:117],v25,53248
T a[118:119],v25,55296
M v[116:119],a[92:95],v[244:247],0
s_cmp_lt_u32 s42, 8
MF v104,v5,v104
MF v105,v5,v105
M v[116:119],a[88:91],v[228:231],v[116:119]
s_cselect_b32 s84, s45, 536870912
T a[120:121],v25,57344
T a[122:123],v25,59392
M v[116:119],a[84:87],v[212:215],v[116:119]
T a[124:125],v25,61440
T a[126:127],v25,63488
M v[116:119],a[80:83],v[196:199],v[116:119]
MF v106,v5,v106
MF v107,v5,v107
M v[116:119],a[76:79],v[180:183],v[116:119]
C v96,v96,v97
C v97,v98,v99
M v[116:119],a[72:75],v[164:167],v[116:119]
C v98,v104,v105
C v99,v106,v107
M v[116:119],a[68:71],v[148:151],v[116:119]
s_waitcnt lgkmcnt(0)
buffer_store_dwordx4 v[96:99], v7, s[8:11], s29 offen offset:0 sc1
M v[116:119],a[64:67],v[132:135],v[116:119]
s_barrier
M v[120:123],a[96:99],v[128:131],0
s_nop 0
T a[64:65],v18,32768
T a[66:67],v18,34816
M v[120:123],a[100:103],v[144:147],v[120:123]
T a[68:69],v18,36864
T a[70:71],v18,38912
M v[120:123],a[104:107],v[160:163],v[120:123]
MF v100,v6,v100
MF v101,v6,v101
M v[120:123],a[108:111],v[176:179],v[120:123]
T a[72:73],v18,40960
T a[74:75],v18,43008
M v[120:123],a[112:115],v[192:195],v[120:123]
s_waitcnt vmcnt(9)
T a[76:77],v18,45056
T a[78:79],v18,47104
M v[120:123],a[116:119],v[208:211],v[120:123]
buffer_store_dword v15, v17, s[8:11], s84 offen sc1
M v[120:123],a[120:123],v[224:227],v[120:123]
s_nop 0
T a[80:81],v18,49152
T a[82:83],v18,51200
M v[120:123],a[124:127],v[240:243],v[120:123]
T a[84:85],v18,53248
T a[86:87],v18,55296
M v[124:127],a[124:127],v[244:247],0
MF v102,v6,v102
MF v103,v6,v103
M v[124:127],a[120:123],v[228:231],v[124:127]
T a[88:89],v18,57344
T a[90:91],v18,59392
M v[124:127],a[116:119],v[212:215],v[124:127]
T a[92:93],v18,61440
T a[94:95],v18,63488
M v[124:127],a[112:115],v[196:199],v[124:127]
MF v108,v6,v108
MF v109,v6,v109
M v[124:127],a[108:111],v[180:183],v[124:127]
MF v110,v6,v110
MF v111,v6,v111
M v[124:127],a[104:107],v[164:167],v[124:127]
C v100,v100,v101
C v101,v102,v103
M v[124:127],a[100:103],v[148:151],v[124:127]
s_waitcnt lgkmcnt(0)
C v102,v108,v109
C v103,v110,v111
M v[124:127],a[96:99],v[132:135],v[124:127]
buffer_store_dwordx4 v[100:103], v7, s[8:11], s30 offen offset:0 sc1
M v[64:67],a[64:67],v[128:131],0
s_nop 0
T a[96:97],v19,32768
T a[98:99],v19,34816
M v[64:67],a[68:71],v[144:147],v[64:67]
T a[100:101],v19,36864
T a[102:103],v19,38912
M v[64:67],a[72:75],v[160:163],v[64:67]
MF v112,v5,v112
MF v113,v5,v113
M v[64:67],a[76:79],v[176:179],v[64:67]
T a[104:105],v19,40960
T a[106:107],v19,43008
M v[64:67],a[80:83],v[192:195],v[64:67]
T a[108:109],v19,45056
T a[110:111],v19,47104
M v[64:67],a[84:87],v[208:211],v[64:67]
MF v114,v5,v114
MF v115,v5,v115
M v[64:67],a[88:91],v[224:227],v[64:67]
T a[112:113],v19,49152
T a[114:115],v19,51200
M v[64:67],a[92:95],v[240:243],v[64:67]
T a[116:117],v19,53248
T a[118:119],v19,55296
M v[68:71],a[92:95],v[244:247],0
MF v120,v5,v120
MF v121,v5,v121
M v[68:71],a[88:91],v[228:231],v[68:71]
T a[120:121],v19,57344
T a[122:123],v19,59392
M v[68:71],a[84:87],v[212:215],v[68:71]
T a[124:125],v19,61440
T a[126:127],v19,63488
M v[68:71],a[80:83],v[196:199],v[68:71]
MF v122,v5,v122
MF v123,v5,v123
M v[68:71],a[76:79],v[180:183],v[68:71]
C v112,v112,v113
C v113,v114,v115
M v[68:71],a[72:75],v[164:167],v[68:71]
C v114,v120,v121
C v115,v122,v123
M v[68:71],a[68:71],v[148:151],v[68:71]
buffer_store_dwordx4 v[112:115], v7, s[8:11], s29 offen offset:1024 sc1
M v[68:71],a[64:67],v[132:135],v[68:71]
s_waitcnt lgkmcnt(0)
MF v116,v6,v116
MF v117,v6,v117
M v[72:75],a[96:99],v[128:131],0
T a[64:65],v20,32768
T a[66:67],v20,34816
M v[72:75],a[100:103],v[144:147],v[72:75]
T a[68:69],v20,36864
T a[70:71],v20,38912
M v[72:75],a[104:107],v[160:163],v[72:75]
MF v118,v6,v118
MF v119,v6,v119
M v[72:75],a[108:111],v[176:179],v[72:75]
T a[72:73],v20,40960
T a[74:75],v20,43008
M v[72:75],a[112:115],v[192:195],v[72:75]
T a[76:77],v20,45056
T a[78:79],v20,47104
M v[72:75],a[116:119],v[208:211],v[72:75]
MF v124,v6,v124
MF v125,v6,v125
M v[72:75],a[120:123],v[224:227],v[72:75]
T a[80:81],v20,49152
T a[82:83],v20,51200
M v[72:75],a[124:127],v[240:243],v[72:75]
T a[84:85],v20,53248
T a[86:87],v20,55296
M v[76:79],a[124:127],v[244:247],0
MF v126,v6,v126
MF v127,v6,v127
M v[76:79],a[120:123],v[228:231],v[76:79]
T a[88:89],v20,57344
T a[90:91],v20,59392
M v[76:79],a[116:119],v[212:215],v[76:79]
T a[92:93],v20,61440
T a[94:95],v20,63488
M v[76:79],a[112:115],v[196:199],v[76:79]
C v116,v116,v117
C v117,v118,v119
M v[76:79],a[108:111],v[180:183],v[76:79]
C v118,v124,v125
C v119,v126,v127
M v[76:79],a[104:107],v[164:167],v[76:79]
buffer_store_dwordx4 v[116:119], v7, s[8:11], s30 offen offset:1024 sc1
M v[76:79],a[100:103],v[148:151],v[76:79]
SA s29,s33,12288
s_waitcnt vmcnt(12)
v_readlane_b32 s92, v31, 0
v_readlane_b32 s94, v31, 1
M v[76:79],a[96:99],v[132:135],v[76:79]
s_waitcnt lgkmcnt(0)
s_waitcnt vmcnt(9)
v_sub_f32 v30, 1.0, v26
s_waitcnt vmcnt(7)
v_lshlrev_b32 v48, 16, v44
M v[80:83],a[64:67],v[128:131],0
SA s30,s33,26624
T a[96:97],v21,32768
T a[98:99],v21,34816
M v[80:83],a[68:71],v[144:147],v[80:83]
T a[100:101],v21,36864
T a[102:103],v21,38912
M v[80:83],a[72:75],v[160:163],v[80:83]
v_and_b32 v49, 0xffff0000, v44
v_lshlrev_b32 v50, 16, v45
M v[80:83],a[76:79],v[176:179],v[80:83]
T a[104:105],v21,40960
T a[106:107],v21,43008
M v[80:83],a[80:83],v[192:195],v[80:83]
T a[108:109],v21,45056
T a[110:111],v21,47104
M v[80:83],a[84:87],v[208:211],v[80:83]
MF v64,v5,v64
MF v65,v5,v65
M v[80:83],a[88:91],v[224:227],v[80:83]
T a[112:113],v21,49152
T a[114:115],v21,51200
M v[80:83],a[92:95],v[240:243],v[80:83]
T a[116:117],v21,53248
T a[118:119],v21,55296
M v[84:87],a[92:95],v[244:247],0
MF v66,v5,v66
MF v67,v5,v67
M v[84:87],a[88:91],v[228:231],v[84:87]
T a[120:121],v21,57344
T a[122:123],v21,59392
M v[84:87],a[84:87],v[212:215],v[84:87]
T a[124:125],v21,61440
T a[126:127],v21,63488
M v[84:87],a[80:83],v[196:199],v[84:87]
MF v72,v5,v72
MF v73,v5,v73
M v[84:87],a[76:79],v[180:183],v[84:87]
MF v74,v5,v74
MF v75,v5,v75
M v[84:87],a[72:75],v[164:167],v[84:87]
C v64,v64,v65
C v65,v66,v67
M v[84:87],a[68:71],v[148:151],v[84:87]
C v66,v72,v73
C v67,v74,v75
M v[84:87],a[64:67],v[132:135],v[84:87]
s_waitcnt lgkmcnt(0)
buffer_store_dwordx4 v[64:67], v7, s[8:11], s29 offen offset:0 sc1
M v[88:91],a[96:99],v[128:131],0
v_and_b32 v51, 0xffff0000, v45
v_lshlrev_b32 v52, 16, v46
M v[88:91],a[100:103],v[144:147],v[88:91]
MF v68,v6,v68
MF v69,v6,v69
M v[88:91],a[104:107],v[160:163],v[88:91]
MF v70,v6,v70
MF v71,v6,v71
M v[88:91],a[108:111],v[176:179],v[88:91]
MF v76,v6,v76
MF v77,v6,v77
M v[88:91],a[112:115],v[192:195],v[88:91]
MF v78,v6,v78
MF v79,v6,v79
M v[88:91],a[116:119],v[208:211],v[88:91]
C v68,v68,v69
C v69,v70,v71
M v[88:91],a[120:123],v[224:227],v[88:91]
C v70,v76,v77
C v71,v78,v79
M v[88:91],a[124:127],v[240:243],v[88:91]
buffer_store_dwordx4 v[68:71], v7, s[8:11], s30 offen offset:0 sc1
M v[92:95],a[124:127],v[244:247],0
v_and_b32 v53, 0xffff0000, v46
v_lshlrev_b32 v54, 16, v47
M v[92:95],a[120:123],v[228:231],v[92:95]
v_and_b32 v55, 0xffff0000, v47
v_cmp_eq_u32 s[80:81], s92, v29
M v[92:95],a[116:119],v[212:215],v[92:95]
v_cmp_eq_u32 s[82:83], s94, v29
M v[92:95],a[112:115],v[196:199],v[92:95]
MF v80,v5,v80
MF v81,v5,v81
M v[92:95],a[108:111],v[180:183],v[92:95]
MF v82,v5,v82
MF v83,v5,v83
M v[92:95],a[104:107],v[164:167],v[92:95]
MF v88,v5,v88
MF v89,v5,v89
M v[92:95],a[100:103],v[148:151],v[92:95]
MF v90,v5,v90
MF v91,v5,v91
M v[92:95],a[96:99],v[132:135],v[92:95]
C v80,v80,v81
C v81,v82,v83
C v82,v88,v89
C v83,v90,v91
buffer_store_dwordx4 v[80:83], v7, s[8:11], s29 offen offset:1024 sc1
MF v84,v6,v84
MF v85,v6,v85
MF v86,v6,v86
MF v87,v6,v87
MF v92,v6,v92
MF v93,v6,v93
MF v94,v6,v94
MF v95,v6,v95
C v84,v84,v85
C v85,v86,v87
C v86,v92,v93
C v87,v94,v95
buffer_store_dwordx4 v[84:87], v7, s[8:11], s30 offen offset:1024 sc1
buffer_load_dword v9, v33, s[8:11], s46 offen sc1
s_waitcnt vmcnt(1)
buffer_store_dword v15, v16, s[8:11], s3 offen sc1
s_cmp_lt_u32 s42, 8
s_cbranch_scc1 L_red
s_waitcnt vmcnt(1)
v_cmp_eq_u32 vcc, 1, v9
s_mov_b32 s91, 65536
s_lshl_b32 s70, 1, s41
s_mov_b32 s69, 0xffff
s_or_b32 s70, s70, vcc_lo
s_mov_b32 s68, s70
s_barrier
s_cmp_lg_u32 s70, 0
s_cbranch_scc1 L_vk0
s_call_b64 s[36:37], L_rpoll
L_vk0:
s_ff1_i32_b32 s71, s70
s_bitset0_b32 s70, s71
s_mul_i32 s71, s71, 114688
SA s16,s71,s78
buffer_load_dwordx4 v[128:131], v27, s[8:11], s16 offen sc1
s_cmp_lg_u32 s70, 0
s_cbranch_scc1 L_vk1
s_call_b64 s[36:37], L_rpoll
L_vk1:
s_ff1_i32_b32 s71, s70
s_bitset0_b32 s70, s71
s_mul_i32 s71, s71, 114688
SA s17,s71,s78
buffer_load_dwordx4 v[132:135], v27, s[8:11], s17 offen sc1
s_cmp_lg_u32 s70, 0
s_cbranch_scc1 L_vk2
s_call_b64 s[36:37], L_rpoll
L_vk2:
s_ff1_i32_b32 s71, s70
s_bitset0_b32 s70, s71
s_mul_i32 s71, s71, 114688
SA s18,s71,s78
buffer_load_dwordx4 v[136:139], v27, s[8:11], s18 offen sc1
s_cmp_lg_u32 s70, 0
s_cbranch_scc1 L_vk3
s_call_b64 s[36:37], L_rpoll
L_vk3:
s_ff1_i32_b32 s71, s70
s_bitset0_b32 s70, s71
s_mul_i32 s71, s71, 114688
SA s19,s71,s78
buffer_load_dwordx4 v[140:143], v27, s[8:11], s19 offen sc1
s_cmp_lg_u32 s70, 0
s_cbranch_scc1 L_vk4
s_call_b64 s[36:37], L_rpoll
L_vk4:
s_ff1_i32_b32 s71, s70
s_bitset0_b32 s70, s71
s_mul_i32 s71, s71, 114688
SA s48,s71,s78
buffer_load_dwordx4 v[144:147], v27, s[8:11], s48 offen sc1
s_cmp_lg_u32 s70, 0
s_cbranch_scc1 L_vk5
s_call_b64 s[36:37], L_rpoll
L_vk5:
s_ff1_i32_b32 s71, s70
s_bitset0_b32 s70, s71
s_mul_i32 s71, s71, 114688
SA s49,s71,s78
buffer_load_dwordx4 v[148:151], v27, s[8:11], s49 offen sc1
s_cmp_lg_u32 s70, 0
s_cbranch_scc1 L_vk6
s_call_b64 s[36:37], L_rpoll
L_vk6:
s_ff1_i32_b32 s71, s70
s_bitset0_b32 s70, s71
s_mul_i32 s71, s71, 114688
SA s50,s71,s78
buffer_load_dwordx4 v[152:155], v27, s[8:11], s50 offen sc1
s_cmp_lg_u32 s70, 0
s_cbranch_scc1 L_vk7
s_call_b64 s[36:37], L_rpoll
L_vk7:
s_ff1_i32_b32 s71, s70
s_bitset0_b32 s70, s71
s_mul_i32 s71, s71, 114688
SA s51,s71,s78
buffer_load_dwordx4 v[156:159], v27, s[8:11], s51 offen sc1
s_or_b64 vcc, s[80:81], s[82:83]
s_cbranch_vccnz L_moe2
L_moe_ret2:
MF v48,v30,v48
MF v49,v30,v49
MF v50,v30,v50
MF v51,v30,v51
MF v52,v30,v52
MF v53,v30,v53
MF v54,v30,v54
MF v55,v30,v55
s_cmp_lg_u32 s70, 0
s_cbranch_scc1 L_vk8
s_call_b64 s[36:37], L_rpoll
L_vk8:
s_ff1_i32_b32 s71, s70
s_bitset0_b32 s70, s71
s_mul_i32 s71, s71, 114688
SA s21,s71,s78
buffer_load_dwordx4 v[160:163], v27, s[8:11], s21 offen sc1
s_waitcnt vmcnt(8)
M v[56:59],a[246:249],v[128:131],0
M v[60:63],a[244:247],v[128:131],0
s_cmp_lg_u32 s70, 0
s_cbranch_scc1 L_vk9
s_call_b64 s[36:37], L_rpoll
L_vk9:
s_ff1_i32_b32 s71, s70
s_bitset0_b32 s70, s71
s_mul_i32 s71, s71, 114688
SA s22,s71,s78
buffer_load_dwordx4 v[164:167], v27, s[8:11], s22 offen sc1
s_waitcnt vmcnt(8)
M v[56:59],a[246:249],v[132:135],v[56:59]
M v[60:63],a[244:247],v[132:135],v[60:63]
s_cmp_lg_u32 s70, 0
s_cbranch_scc1 L_vk10
s_call_b64 s[36:37], L_rpoll
L_vk10:
s_ff1_i32_b32 s71, s70
s_bitset0_b32 s70, s71
s_mul_i32 s71, s71, 114688
SA s23,s71,s78
buffer_load_dwordx4 v[168:171], v27, s[8:11], s23 offen sc1
s_waitcnt vmcnt(8)
M v[56:59],a[246:249],v[136:139],v[56:59]
M v[60:63],a[244:247],v[136:139],v[60:63]
s_cmp_lg_u32 s70, 0
s_cbranch_scc1 L_vk11
s_call_b64 s[36:37], L_rpoll
L_vk11:
s_ff1_i32_b32 s71, s70
s_bitset0_b32 s70, s71
s_mul_i32 s71, s71, 114688
SA s24,s71,s78
buffer_load_dwordx4 v[172:175], v27, s[8:11], s24 offen sc1
s_waitcnt vmcnt(8)
M v[56:59],a[246:249],v[140:143],v[56:59]
M v[60:63],a[244:247],v[140:143],v[60:63]
s_cmp_lg_u32 s70, 0
s_cbranch_scc1 L_vk12
s_call_b64 s[36:37], L_rpoll
L_vk12:
s_ff1_i32_b32 s71, s70
s_bitset0_b32 s70, s71
s_mul_i32 s71, s71, 114688
SA s25,s71,s78
buffer_load_dwordx4 v[176:179], v27, s[8:11], s25 offen sc1
s_waitcnt vmcnt(8)
M v[56:59],a[246:249],v[144:147],v[56:59]
M v[60:63],a[244:247],v[144:147],v[60:63]
s_cmp_lg_u32 s70, 0
s_cbranch_scc1 L_vk13
s_call_b64 s[36:37], L_rpoll
L_vk13:
s_ff1_i32_b32 s71, s70
s_bitset0_b32 s70, s71
s_mul_i32 s71, s71, 114688
SA s26,s71,s78
buffer_load_dwordx4 v[180:183], v27, s[8:11], s26 offen sc1
s_waitcnt vmcnt(8)
M v[56:59],a[246:249],v[148:151],v[56:59]
M v[60:63],a[244:247],v[148:151],v[60:63]
s_cmp_lg_u32 s70, 0
s_cbranch_scc1 L_vk14
s_call_b64 s[36:37], L_rpoll
L_vk14:
s_ff1_i32_b32 s71, s70
s_bitset0_b32 s70, s71
s_mul_i32 s71, s71, 114688
SA s27,s71,s78
buffer_load_dwordx4 v[184:187], v27, s[8:11], s27 offen sc1
s_waitcnt vmcnt(8)
M v[56:59],a[246:249],v[152:155],v[56:59]
M v[60:63],a[244:247],v[152:155],v[60:63]
s_cmp_lg_u32 s70, 0
s_cbranch_scc1 L_vk15
s_call_b64 s[36:37], L_rpoll
L_vk15:
s_ff1_i32_b32 s71, s70
s_bitset0_b32 s70, s71
s_mul_i32 s71, s71, 114688
SA s28,s71,s78
buffer_load_dwordx4 v[188:191], v27, s[8:11], s28 offen sc1
s_waitcnt vmcnt(8)
M v[56:59],a[246:249],v[156:159],v[56:59]
M v[60:63],a[244:247],v[156:159],v[60:63]
s_waitcnt vmcnt(7)
M v[56:59],a[246:249],v[160:163],v[56:59]
M v[60:63],a[244:247],v[160:163],v[60:63]
s_waitcnt vmcnt(6)
M v[56:59],a[246:249],v[164:167],v[56:59]
M v[60:63],a[244:247],v[164:167],v[60:63]
s_waitcnt vmcnt(5)
M v[56:59],a[246:249],v[168:171],v[56:59]
M v[60:63],a[244:247],v[168:171],v[60:63]
s_waitcnt vmcnt(4)
M v[56:59],a[246:249],v[172:175],v[56:59]
M v[60:63],a[244:247],v[172:175],v[60:63]
s_waitcnt vmcnt(3)
M v[56:59],a[246:249],v[176:179],v[56:59]
M v[60:63],a[244:247],v[176:179],v[60:63]
s_waitcnt vmcnt(2)
M v[56:59],a[246:249],v[180:183],v[56:59]
M v[60:63],a[244:247],v[180:183],v[60:63]
s_waitcnt vmcnt(1)
M v[56:59],a[246:249],v[184:187],v[56:59]
M v[60:63],a[244:247],v[184:187],v[60:63]
s_waitcnt vmcnt(0)
M v[56:59],a[246:249],v[188:191],v[56:59]
M v[60:63],a[244:247],v[188:191],v[60:63]
s_nop 7
v_permlane16_swap_b32 v56, v60
v_permlane16_swap_b32 v57, v61
v_permlane16_swap_b32 v58, v62
v_permlane16_swap_b32 v59, v63
v_fmac_f32 v48, v26, v56
v_fmac_f32 v49, v26, v57
v_fmac_f32 v50, v26, v58
v_fmac_f32 v51, v26, v59
v_fmac_f32 v52, v26, v60
v_fmac_f32 v53, v26, v61
v_fmac_f32 v54, v26, v62
v_fmac_f32 v55, v26, v63
C v44,v48,v49
C v45,v50,v51
C v46,v52,v53
C v47,v54,v55
buffer_store_dwordx4 v[44:47], v28, s[52:55], s79 offen sc1
s_endpgm
L_d2h:
M v[128:131],a[64:67],v[48:51],v[128:131]
R a[96:99],v7,40960
R a[100:103],v7,41984
M v[128:131],a[68:71],v[56:59],v[128:131]
SA m0,s28,135168
E v18,v64
M v[132:135],a[68:71],v[60:63],v[132:135]
buffer_load_dwordx4 v4, s[8:11], s26 offen offset:0 sc1 lds
M v[132:135],a[64:67],v[52:55],v[132:135]
R a[104:107],v7,43008
R a[108:111],v7,44032
M v[136:139],a[72:75],v[48:51],v[136:139]
s_cmp_gt_u32 s20, 3
E v19,v65
M v[136:139],a[76:79],v[56:59],v[136:139]
s_cselect_b64 s[82:83], -1, 0
AF v30,v28,v30
AF v31,v29,v31
M v[140:143],a[76:79],v[60:63],v[140:143]
s_cmp_eq_u32 s20, 3
R a[112:115],v7,45056
R a[116:119],v7,46080
M v[140:143],a[72:75],v[52:55],v[140:143]
s_cselect_b64 s[66:67], s[16:17], s[82:83]
buffer_load_dwordx4 v4, s[8:11], s26 offen offset:1024 sc1 lds
M v[144:147],a[80:83],v[48:51],v[144:147]
s_cselect_b64 s[68:69], s[18:19], s[82:83]
E v20,v66
M v[144:147],a[84:87],v[56:59],v[144:147]
s_cselect_b64 s[70:71], s[48:49], s[82:83]
R a[120:123],v7,47104
R a[124:127],v7,48128
M v[148:151],a[84:87],v[60:63],v[148:151]
s_cselect_b64 s[72:73], s[50:51], s[82:83]
v_cndmask_b32 v100, v36, v8, s[66:67]
v_cndmask_b32 v101, v36, v8, s[68:69]
M v[148:151],a[80:83],v[52:55],v[148:151]
buffer_load_dwordx4 v4, s[8:11], s26 offen offset:2048 sc1 lds
M v[152:155],a[88:91],v[48:51],v[152:155]
v_cndmask_b32 v102, v36, v8, s[70:71]
AF v26,v18,v19
M v[152:155],a[92:95],v[56:59],v[152:155]
E v21,v67
M v[156:159],a[92:95],v[60:63],v[156:159]
v_cndmask_b32 v103, v36, v8, s[72:73]
C v40,v18,v19
M v[156:159],a[88:91],v[52:55],v[156:159]
s_waitcnt lgkmcnt(0)
buffer_load_dwordx4 v4, s[8:11], s26 offen offset:3072 sc1 lds
M v[160:163],a[96:99],v[48:51],v[160:163]
s_cmp_gt_u32 s20, 2
R a[64:67],v7,49152
R a[68:71],v7,50176
M v[160:163],a[100:103],v[56:59],v[160:163]
s_cselect_b64 s[82:83], -1, 0
E v22,v72
M v[164:167],a[100:103],v[60:63],v[164:167]
s_cmp_eq_u32 s20, 2
AF v26,v20,v26
C v41,v20,v21
M v[164:167],a[96:99],v[52:55],v[164:167]
s_mul_i32 s21, s41, 1048576
R a[72:75],v7,51200
R a[76:79],v7,52224
M v[168:171],a[104:107],v[48:51],v[168:171]
s_cselect_b64 s[74:75], s[16:17], s[82:83]
E v23,v73
M v[168:171],a[108:111],v[56:59],v[168:171]
s_cselect_b64 s[76:77], s[18:19], s[82:83]
AF v26,v21,v26
AF v26,v22,v26
M v[172:175],a[108:111],v[60:63],v[172:175]
s_cselect_b64 s[78:79], s[48:49], s[82:83]
R a[80:83],v7,53248
R a[84:87],v7,54272
M v[172:175],a[104:107],v[52:55],v[172:175]
s_cselect_b64 s[80:81], s[50:51], s[82:83]
v_cndmask_b32 v108, v36, v8, s[74:75]
v_cndmask_b32 v109, v36, v8, s[76:77]
M v[176:179],a[112:115],v[48:51],v[176:179]
SA s21,s21,589824
E v24,v74
M v[176:179],a[116:119],v[56:59],v[176:179]
s_lshl_b32 s84, s42, 1
R a[88:91],v7,55296
R a[92:95],v7,56320
M v[180:183],a[116:119],v[60:63],v[180:183]
s_sub_u32 s22, 11, s84
v_cndmask_b32 v110, v36, v8, s[78:79]
C v42,v22,v23
M v[180:183],a[112:115],v[52:55],v[180:183]
s_mov_b32 s23, 536870912
s_waitcnt vmcnt(16)
v_cmp_gt_u32 vcc, 2, v5
AF v26,v23,v26
M v[184:187],a[120:123],v[48:51],v[184:187]
s_cbranch_vccnz L_lsh2
L_lrh2:
v_cndmask_b32 v111, v36, v8, s[80:81]
M v[184:187],a[124:127],v[56:59],v[184:187]
SA m0,s28,98304
E v25,v75
M v[188:191],a[124:127],v[60:63],v[188:191]
s_cmp_gt_u32 s20, 1
buffer_load_dwordx4 v3, s[8:11], s21 offen offset:0 sc1 lds
M v[188:191],a[120:123],v[52:55],v[188:191]
s_waitcnt lgkmcnt(0)
E v18,v68
M v[192:195],a[64:67],v[48:51],v[192:195]
s_cselect_b64 s[82:83], -1, 0
R a[96:99],v7,57344
R a[100:103],v7,58368
M v[192:195],a[68:71],v[56:59],v[192:195]
s_cmp_eq_u32 s20, 1
buffer_load_dwordx4 v3, s[8:11], s21 offen offset:1024 sc1 lds
M v[196:199],a[68:71],v[60:63],v[196:199]
s_cselect_b64 s[66:67], s[16:17], s[82:83]
E v19,v69
M v[196:199],a[64:67],v[52:55],v[196:199]
s_cselect_b64 s[68:69], s[18:19], s[82:83]
R a[104:107],v7,59392
R a[108:111],v7,60416
M v[200:203],a[72:75],v[48:51],v[200:203]
s_cselect_b64 s[70:71], s[48:49], s[82:83]
buffer_load_dwordx4 v3, s[8:11], s21 offen offset:2048 sc1 lds
M v[200:203],a[76:79],v[56:59],v[200:203]
s_cselect_b64 s[72:73], s[50:51], s[82:83]
v_cndmask_b32 v116, v36, v8, s[66:67]
v_cndmask_b32 v117, v36, v8, s[68:69]
M v[204:207],a[76:79],v[60:63],v[204:207]
R a[112:115],v7,61440
R a[116:119],v7,62464
M v[204:207],a[72:75],v[52:55],v[204:207]
v_cndmask_b32 v118, v36, v8, s[70:71]
AF v26,v24,v26
M v[208:211],a[80:83],v[48:51],v[208:211]
buffer_load_dwordx4 v3, s[8:11], s21 offen offset:3072 sc1 lds
M v[208:211],a[84:87],v[56:59],v[208:211]
SA m0,s28,102400
R a[120:123],v7,63488
R a[124:127],v7,64512
M v[212:215],a[84:87],v[60:63],v[212:215]
v_cndmask_b32 v119, v36, v8, s[72:73]
C v43,v24,v25
M v[212:215],a[80:83],v[52:55],v[212:215]
s_cmp_gt_u32 s20, 0
E v20,v70
M v[216:219],a[88:91],v[48:51],v[216:219]
s_cselect_b64 s[82:83], -1, 0
buffer_load_dwordx4 v4, s[8:11], s21 offen offset:0 sc1 lds
M v[216:219],a[92:95],v[56:59],v[216:219]
s_cmp_eq_u32 s20, 0
E v21,v71
M v[220:223],a[92:95],v[60:63],v[220:223]
s_waitcnt lgkmcnt(0)
E v22,v76
M v[220:223],a[88:91],v[52:55],v[220:223]
s_barrier
M v[224:227],a[96:99],v[48:51],v[224:227]
s_cselect_b64 s[74:75], s[16:17], s[82:83]
R a[64:67],v2,0
R a[68:71],v2,1024
M v[224:227],a[100:103],v[56:59],v[224:227]
s_cselect_b64 s[76:77], s[18:19], s[82:83]
buffer_load_dwordx4 v4, s[8:11], s21 offen offset:1024 sc1 lds
M v[228:231],a[100:103],v[60:63],v[228:231]
s_cselect_b64 s[78:79], s[48:49], s[82:83]
E v23,v77
M v[228:231],a[96:99],v[52:55],v[228:231]
s_cselect_b64 s[80:81], s[50:51], s[82:83]
R a[72:75],v2,2048
R a[76:79],v2,3072
M v[232:235],a[104:107],v[48:51],v[232:235]
v_cndmask_b32 v124, v36, v8, s[74:75]
v_cndmask_b32 v125, v36, v8, s[76:77]
M v[232:235],a[108:111],v[56:59],v[232:235]
buffer_load_dwordx4 v4, s[8:11], s21 offen offset:2048 sc1 lds
M v[236:239],a[108:111],v[60:63],v[236:239]
R a[80:83],v2,4096
R a[84:87],v2,5120
M v[236:239],a[104:107],v[52:55],v[236:239]
v_cndmask_b32 v126, v36, v8, s[78:79]
AF v26,v25,v26
M v[240:243],a[112:115],v[48:51],v[240:243]
v_cndmask_b32 v127, v36, v8, s[80:81]
AF v27,v18,v19
M v[240:243],a[116:119],v[56:59],v[240:243]
R a[88:91],v2,6144
R a[92:95],v2,7168
M v[244:247],a[116:119],v[60:63],v[244:247]
buffer_load_dwordx4 v4, s[8:11], s21 offen offset:3072 sc1 lds
M v[244:247],a[112:115],v[52:55],v[244:247]
SA s21,s21,32768
E v24,v78
M v[248:251],a[120:123],v[48:51],v[248:251]
s_sub_u32 s22, s22, 1
E v25,v79
M v[248:251],a[124:127],v[56:59],v[248:251]
s_cselect_b32 s21, s23, s21
C v44,v18,v19
AF v27,v20,v27
M v[252:255],a[124:127],v[60:63],v[252:255]
s_waitcnt lgkmcnt(0)
C v45,v20,v21
AF v27,v21,v27
M v[252:255],a[120:123],v[52:55],v[252:255]
AF v27,v22,v27
C v46,v22,v23
AF v27,v23,v27
AF v27,v24,v27
C v47,v24,v25
AF v27,v25,v27
L_d3h:
M v[100:103],a[64:67],a[32:35],v[100:103]
R a[96:99],v2,8192
R a[100:103],v2,9216
M v[100:103],a[68:71],a[36:39],v[100:103]
R a[104:107],v2,10240
R a[108:111],v2,11264
M v[100:103],a[72:75],a[40:43],v[100:103]
R a[112:115],v2,12288
R a[116:119],v2,13312
M v[100:103],a[76:79],a[44:47],v[100:103]
R a[120:123],v2,14336
R a[124:127],v2,15360
M v[100:103],a[80:83],a[48:51],v[100:103]
v_add_u32 v8, 0x20000, v7
M v[100:103],a[84:87],a[52:55],v[100:103]
buffer_load_dword v5, v9, s[8:11], s46 offen sc1
M v[100:103],a[88:91],a[56:59],v[100:103]
buffer_load_dword v6, off, s[8:11], s47 offset:16 sc1
M v[100:103],a[92:95],a[60:63],v[100:103]
s_waitcnt lgkmcnt(0)
E v18,v80
M v[108:111],a[96:99],a[32:35],v[108:111]
R a[64:67],v2,16384
R a[68:71],v2,17408
M v[108:111],a[100:103],a[36:39],v[108:111]
R a[72:75],v2,18432
R a[76:79],v2,19456
M v[108:111],a[104:107],a[40:43],v[108:111]
R a[80:83],v2,20480
R a[84:87],v2,21504
M v[108:111],a[108:111],a[44:47],v[108:111]
R a[88:91],v2,22528
R a[92:95],v2,23552
M v[108:111],a[112:115],a[48:51],v[108:111]
E v19,v81
M v[108:111],a[116:119],a[52:55],v[108:111]
E v20,v82
M v[108:111],a[120:123],a[56:59],v[108:111]
E v21,v83
M v[108:111],a[124:127],a[60:63],v[108:111]
s_waitcnt lgkmcnt(0)
E v22,v88
M v[116:119],a[64:67],a[32:35],v[116:119]
R a[96:99],v2,24576
R a[100:103],v2,25600
M v[116:119],a[68:71],a[36:39],v[116:119]
R a[104:107],v2,26624
R a[108:111],v2,27648
M v[116:119],a[72:75],a[40:43],v[116:119]
R a[112:115],v2,28672
R a[116:119],v2,29696
M v[116:119],a[76:79],a[44:47],v[116:119]
R a[120:123],v2,30720
R a[124:127],v2,31744
M v[116:119],a[80:83],a[48:51],v[116:119]
E v23,v89
M v[116:119],a[84:87],a[52:55],v[116:119]
E v24,v90
M v[116:119],a[88:91],a[56:59],v[116:119]
s_waitcnt vmcnt(18) lgkmcnt(0)
E v25,v91
M v[116:119],a[92:95],a[60:63],v[116:119]
s_barrier
M v[124:127],a[96:99],a[32:35],v[124:127]
R a[64:67],v7,0
R a[68:71],v7,1024
M v[124:127],a[100:103],a[36:39],v[124:127]
R a[72:75],v7,2048
R a[76:79],v7,3072
M v[124:127],a[104:107],a[40:43],v[124:127]
R a[80:83],v7,4096
R a[84:87],v7,5120
M v[124:127],a[108:111],a[44:47],v[124:127]
R a[88:91],v7,6144
R a[92:95],v7,7168
M v[124:127],a[112:115],a[48:51],v[124:127]
AF v26,v18,v26
C v56,v18,v19
M v[124:127],a[116:119],a[52:55],v[124:127]
AF v26,v19,v26
AF v26,v20,v26
M v[124:127],a[120:123],a[56:59],v[124:127]
s_waitcnt lgkmcnt(0)
E v18,v84
M v[124:127],a[124:127],a[60:63],v[124:127]
E v19,v85
C v57,v20,v21
AF v26,v21,v26
AF v26,v22,v26
C v58,v22,v23
AF v26,v23,v26
AF v26,v24,v26
C v59,v24,v25
AF v26,v25,v26
E v20,v86
E v21,v87
AF v27,v18,v27
C v60,v18,v19
AF v27,v19,v27
E v22,v92
E v23,v93
AF v27,v20,v27
C v61,v20,v21
AF v27,v21,v27
E v24,v94
E v25,v95
AF v27,v22,v27
C v62,v22,v23
AF v27,v23,v27
AF v27,v24,v27
C v63,v24,v25
AF v27,v25,v27
v_max_f32 v10, v26, v27
v_cmp_lt_f32 vcc, s31, v10
s_nop 0
s_cbranch_vccnz L_std3h
L_rtd3h:
M v[128:131],a[64:67],v[40:43],v[128:131]
R a[96:99],v7,8192
R a[100:103],v7,9216
M v[128:131],a[68:71],v[56:59],v[128:131]
s_waitcnt vmcnt(0)
v_cmp_ne_u32 vcc, 1, v6
AF v30,v26,v30
M v[132:135],a[68:71],v[60:63],v[132:135]
s_cbranch_vccnz L_fqs
L_fqr:
E v18,v100
M v[132:135],a[64:67],v[44:47],v[132:135]
SA s73,s32,4096
R a[104:107],v7,10240
R a[108:111],v7,11264
M v[136:139],a[72:75],v[40:43],v[136:139]
SA s74,s32,8192
E v19,v101
M v[136:139],a[76:79],v[56:59],v[136:139]
SA s75,s32,12288
buffer_load_dwordx4 a[0:3], v7, s[8:11], s32 offen offset:0 sc1
M v[140:143],a[76:79],v[60:63],v[140:143]
R a[112:115],v7,12288
R a[116:119],v7,13312
M v[140:143],a[72:75],v[44:47],v[140:143]
E v20,v102
M v[144:147],a[80:83],v[40:43],v[144:147]
buffer_load_dwordx4 a[4:7], v7, s[8:11], s32 offen offset:1024 sc1
M v[144:147],a[84:87],v[56:59],v[144:147]
R a[120:123],v7,14336
R a[124:127],v7,15360
M v[148:151],a[84:87],v[60:63],v[148:151]
AF v31,v27,v31
AF v29,v18,v19
M v[148:151],a[80:83],v[44:47],v[148:151]
buffer_load_dwordx4 a[8:11], v7, s[8:11], s32 offen offset:2048 sc1
M v[152:155],a[88:91],v[40:43],v[152:155]
E v21,v103
M v[152:155],a[92:95],v[56:59],v[152:155]
C v52,v18,v19
AF v29,v20,v29
M v[156:159],a[92:95],v[60:63],v[156:159]
buffer_load_dwordx4 a[12:15], v7, s[8:11], s32 offen offset:3072 sc1
M v[156:159],a[88:91],v[44:47],v[156:159]
s_waitcnt lgkmcnt(0)
E v22,v108
M v[160:163],a[96:99],v[40:43],v[160:163]
R a[64:67],v7,16384
R a[68:71],v7,17408
M v[160:163],a[100:103],v[56:59],v[160:163]
buffer_load_dwordx4 a[16:19], v7, s[8:11], s73 offen offset:0 sc1
M v[164:167],a[100:103],v[60:63],v[164:167]
E v23,v109
M v[164:167],a[96:99],v[44:47],v[164:167]
R a[72:75],v7,18432
R a[76:79],v7,19456
M v[168:171],a[104:107],v[40:43],v[168:171]
buffer_load_dwordx4 a[20:23], v7, s[8:11], s73 offen offset:1024 sc1
M v[168:171],a[108:111],v[56:59],v[168:171]
C v53,v20,v21
AF v29,v21,v29
M v[172:175],a[108:111],v[60:63],v[172:175]
R a[80:83],v7,20480
R a[84:87],v7,21504
M v[172:175],a[104:107],v[44:47],v[172:175]
buffer_load_dwordx4 a[24:27], v7, s[8:11], s73 offen offset:2048 sc1
M v[176:179],a[112:115],v[40:43],v[176:179]
E v24,v110
M v[176:179],a[116:119],v[56:59],v[176:179]
R a[88:91],v7,22528
R a[92:95],v7,23552
M v[180:183],a[116:119],v[60:63],v[180:183]
buffer_load_dwordx4 a[28:31], v7, s[8:11], s73 offen offset:3072 sc1
M v[180:183],a[112:115],v[44:47],v[180:183]
E v25,v111
M v[184:187],a[120:123],v[40:43],v[184:187]
AF v29,v22,v29
C v54,v22,v23
M v[184:187],a[124:127],v[56:59],v[184:187]
buffer_load_dwordx4 a[32:35], v7, s[8:11], s74 offen offset:0 sc1
M v[188:191],a[124:127],v[60:63],v[188:191]
E v18,v116
M v[188:191],a[120:123],v[44:47],v[188:191]
s_waitcnt lgkmcnt(0)
AF v29,v23,v29
AF v29,v24,v29
M v[192:195],a[64:67],v[40:43],v[192:195]
R a[96:99],v7,24576
R a[100:103],v7,25600
M v[192:195],a[68:71],v[56:59],v[192:195]
buffer_load_dwordx4 a[36:39], v7, s[8:11], s74 offen offset:1024 sc1
M v[196:199],a[68:71],v[60:63],v[196:199]
E v19,v117
M v[196:199],a[64:67],v[44:47],v[196:199]
R a[104:107],v7,26624
R a[108:111],v7,27648
M v[200:203],a[72:75],v[40:43],v[200:203]
buffer_load_dwordx4 a[40:43], v7, s[8:11], s74 offen offset:2048 sc1
M v[200:203],a[76:79],v[56:59],v[200:203]
E v20,v118
M v[204:207],a[76:79],v[60:63],v[204:207]
R a[112:115],v7,28672
R a[116:119],v7,29696
M v[204:207],a[72:75],v[44:47],v[204:207]
buffer_load_dwordx4 a[44:47], v7, s[8:11], s74 offen offset:3072 sc1
M v[208:211],a[80:83],v[40:43],v[208:211]
C v55,v24,v25
AF v29,v25,v29
M v[208:211],a[84:87],v[56:59],v[208:211]
R a[120:123],v7,30720
R a[124:127],v7,31744
M v[212:215],a[84:87],v[60:63],v[212:215]
buffer_load_dwordx4 a[48:51], v7, s[8:11], s75 offen offset:0 sc1
M v[212:215],a[80:83],v[44:47],v[212:215]
E v21,v119
M v[216:219],a[88:91],v[40:43],v[216:219]
AF v29,v18,v29
C v48,v18,v19
M v[216:219],a[92:95],v[56:59],v[216:219]
buffer_load_dwordx4 a[52:55], v7, s[8:11], s75 offen offset:1024 sc1
M v[220:223],a[92:95],v[60:63],v[220:223]
s_waitcnt lgkmcnt(0)
E v22,v124
M v[220:223],a[88:91],v[44:47],v[220:223]
s_barrier
M v[224:227],a[96:99],v[40:43],v[224:227]
R a[64:67],v8,0
R a[68:71],v8,1024
M v[224:227],a[100:103],v[56:59],v[224:227]
buffer_load_dwordx4 a[56:59], v7, s[8:11], s75 offen offset:2048 sc1
M v[228:231],a[100:103],v[60:63],v[228:231]
v_mov_b32 v15, 4
AF v29,v19,v29
M v[228:231],a[96:99],v[44:47],v[228:231]
R a[72:75],v8,2048
R a[76:79],v8,3072
M v[232:235],a[104:107],v[40:43],v[232:235]
buffer_store_dword v15, v1, s[8:11], s45 offen sc1
M v[232:235],a[108:111],v[56:59],v[232:235]
buffer_load_dwordx4 a[60:63], v7, s[8:11], s75 offen offset:3072 sc1
M v[236:239],a[108:111],v[60:63],v[236:239]
s_cmp_ge_u32 s42, 2
R a[80:83],v8,4096
R a[84:87],v8,5120
M v[236:239],a[104:107],v[44:47],v[236:239]
s_cselect_b32 s84, 4, 2
v_cmp_gt_u32 vcc, s84, v5
AF v29,v20,v29
M v[240:243],a[112:115],v[40:43],v[240:243]
s_cbranch_vccnz L_lsh4
L_lrh4:
E v23,v125
M v[240:243],a[116:119],v[56:59],v[240:243]
R a[88:91],v8,6144
R a[92:95],v8,7168
M v[244:247],a[116:119],v[60:63],v[244:247]
E v24,v126
M v[244:247],a[112:115],v[44:47],v[244:247]
E v25,v127
M v[248:251],a[120:123],v[40:43],v[248:251]
C v49,v20,v21
AF v29,v21,v29
M v[248:251],a[124:127],v[56:59],v[248:251]
AF v29,v22,v29
C v50,v22,v23
M v[252:255],a[124:127],v[60:63],v[252:255]
s_waitcnt lgkmcnt(0)
AF v29,v23,v29
AF v29,v24,v29
M v[252:255],a[120:123],v[44:47],v[252:255]
C v51,v24,v25
AF v29,v25,v29
v_cmp_lt_f32 vcc, s31, v29
s_nop 0
s_cbranch_vccnz L_std4h
L_rtd4h:
M v[132:135],a[64:67],v[52:55],v[132:135]
R a[96:99],v8,8192
R a[100:103],v8,9216
M v[132:135],a[68:71],v[48:51],v[132:135]
R a[104:107],v8,10240
R a[108:111],v8,11264
M v[140:143],a[72:75],v[52:55],v[140:143]
SA m0,s28,65536
R a[112:115],v8,12288
R a[116:119],v8,13312
M v[140:143],a[76:79],v[48:51],v[140:143]
R a[120:123],v8,14336
R a[124:127],v8,15360
M v[148:151],a[80:83],v[52:55],v[148:151]
buffer_load_dwordx4 v3, s[8:11], s21 offen offset:0 sc1 lds
M v[148:151],a[84:87],v[48:51],v[148:151]
AF v31,v29,v31
v_mov_b32 v10, v30
M v[156:159],a[88:91],v[52:55],v[156:159]
v_mov_b32 v11, v31
C v128,v128,v129
M v[156:159],a[92:95],v[48:51],v[156:159]
s_waitcnt lgkmcnt(0)
v_permlane16_swap_b32 v10, v30
M v[164:167],a[96:99],v[52:55],v[164:167]
R a[64:67],v8,16384
R a[68:71],v8,17408
M v[164:167],a[100:103],v[48:51],v[164:167]
R a[72:75],v8,18432
R a[76:79],v8,19456
M v[172:175],a[104:107],v[52:55],v[172:175]
R a[80:83],v8,20480
R a[84:87],v8,21504
M v[172:175],a[108:111],v[48:51],v[172:175]
R a[88:91],v8,22528
R a[92:95],v8,23552
M v[180:183],a[112:115],v[52:55],v[180:183]
buffer_load_dwordx4 v3, s[8:11], s21 offen offset:1024 sc1 lds
M v[180:183],a[116:119],v[48:51],v[180:183]
v_permlane16_swap_b32 v11, v31
M v[188:191],a[120:123],v[52:55],v[188:191]
AF v30,v10,v30
AF v31,v11,v31
M v[188:191],a[124:127],v[48:51],v[188:191]
s_waitcnt lgkmcnt(0)
buffer_load_dwordx4 v3, s[8:11], s21 offen offset:2048 sc1 lds
M v[196:199],a[64:67],v[52:55],v[196:199]
R a[96:99],v8,24576
R a[100:103],v8,25600
M v[196:199],a[68:71],v[48:51],v[196:199]
R a[104:107],v8,26624
R a[108:111],v8,27648
M v[204:207],a[72:75],v[52:55],v[204:207]
R a[112:115],v8,28672
R a[116:119],v8,29696
M v[204:207],a[76:79],v[48:51],v[204:207]
R a[120:123],v8,30720
R a[124:127],v8,31744
M v[212:215],a[80:83],v[52:55],v[212:215]
buffer_load_dwordx4 v3, s[8:11], s21 offen offset:3072 sc1 lds
M v[212:215],a[84:87],v[48:51],v[212:215]
SA m0,s28,69632
v_mov_b32 v10, v30
v_mov_b32 v11, v31
M v[220:223],a[88:91],v[52:55],v[220:223]
s_waitcnt lgkmcnt(0)
v_permlane32_swap_b32 v10, v30
M v[220:223],a[92:95],v[48:51],v[220:223]
s_barrier
M v[228:231],a[96:99],v[52:55],v[228:231]
R a[64:67],v2,32768
R a[68:71],v2,33792
M v[228:231],a[100:103],v[48:51],v[228:231]
R a[72:75],v2,34816
R a[76:79],v2,35840
M v[236:239],a[104:107],v[52:55],v[236:239]
R a[80:83],v2,36864
R a[84:87],v2,37888
M v[236:239],a[108:111],v[48:51],v[236:239]
R a[88:91],v2,38912
R a[92:95],v2,39936
M v[244:247],a[112:115],v[52:55],v[244:247]
v_permlane32_swap_b32 v11, v31
M v[244:247],a[116:119],v[48:51],v[244:247]
s_waitcnt vmcnt(4)
buffer_load_dwordx4 v4, s[8:11], s21 offen offset:0 sc1 lds
M v[252:255],a[120:123],v[52:55],v[252:255]
s_waitcnt lgkmcnt(0)
AF v30,v10,v30
AF v31,v11,v31
M v[252:255],a[124:127],v[48:51],v[252:255]
v_rcp_f32 v5, v30
M v[64:67],a[64:67],a[0:3],0
R a[96:99],v2,40960
R a[100:103],v2,41984
M v[64:67],a[68:71],a[4:7],v[64:67]
v_rcp_f32 v6, v31
M v[64:67],a[72:75],a[8:11],v[64:67]
buffer_load_dwordx4 v4, s[8:11], s21 offen offset:1024 sc1 lds
M v[64:67],a[76:79],a[12:15],v[64:67]
R a[104:107],v2,43008
R a[108:111],v2,44032
M v[64:67],a[80:83],a[16:19],v[64:67]
W a192,v5
W a193,v6
M v[64:67],a[84:87],a[20:23],v[64:67]
buffer_load_dwordx4 v4, s[8:11], s21 offen offset:2048 sc1 lds
M v[64:67],a[88:91],a[24:27],v[64:67]
R a[112:115],v2,45056
R a[116:119],v2,46080
M v[64:67],a[92:95],a[28:31],v[64:67]
v_mov_b32 v30, 0
v_mov_b32 v31, 0
M v[68:71],a[92:95],a[60:63],0
buffer_load_dwordx4 v4, s[8:11], s21 offen offset:3072 sc1 lds
M v[68:71],a[88:91],a[56:59],v[68:71]
SA s21,s21,32768
R a[120:123],v2,47104
R a[124:127],v2,48128
M v[68:71],a[84:87],a[52:55],v[68:71]
s_sub_u32 s22, s22, 1
v_mov_b32 v32, 0
v_mov_b32 v33, 0
M v[68:71],a[80:83],a[48:51],v[68:71]
s_cselect_b32 s21, s23, s21
v_mov_b32 v34, 0
v_mov_b32 v35, 0
M v[68:71],a[76:79],a[44:47],v[68:71]
s_mul_i32 s26, s41, 1048576
v_mov_b32 v36, 0
v_mov_b32 v37, 0
M v[68:71],a[72:75],a[40:43],v[68:71]
SA s26,s26,17367040
v_mov_b32 v38, 0
v_mov_b32 v39, 0
M v[68:71],a[68:71],a[36:39],v[68:71]
SA m0,s28,0
E v18,v64
M v[68:71],a[64:67],a[32:35],v[68:71]
s_waitcnt lgkmcnt(0)
buffer_load_dwordx4 v3, s[8:11], s26 offen offset:0 sc1 lds
M v[72:75],a[96:99],a[0:3],0
R a[64:67],v2,49152
R a[68:71],v2,50176
M v[72:75],a[100:103],a[4:7],v[72:75]
E v19,v65
M v[72:75],a[104:107],a[8:11],v[72:75]
buffer_load_dwordx4 v3, s[8:11], s26 offen offset:1024 sc1 lds
M v[72:75],a[108:111],a[12:15],v[72:75]
R a[72:75],v2,51200
R a[76:79],v2,52224
M v[72:75],a[112:115],a[16:19],v[72:75]
E v20,v66
M v[72:75],a[116:119],a[20:23],v[72:75]
buffer_load_dwordx4 v3, s[8:11], s26 offen offset:2048 sc1 lds
M v[72:75],a[120:123],a[24:27],v[72:75]
R a[80:83],v2,53248
R a[84:87],v2,54272
M v[72:75],a[124:127],a[28:31],v[72:75]
E v21,v67
M v[76:79],a[124:127],a[60:63],0
buffer_load_dwordx4 v3, s[8:11], s26 offen offset:3072 sc1 lds
M v[76:79],a[120:123],a[56:59],v[76:79]
SA m0,s28,4096
R a[88:91],v2,55296
R a[92:95],v2,56320
M v[76:79],a[116:119],a[52:55],v[76:79]
E v22,v68
M v[76:79],a[112:115],a[48:51],v[76:79]
E v23,v69
M v[76:79],a[108:111],a[44:47],v[76:79]
buffer_load_dwordx4 v4, s[8:11], s26 offen offset:0 sc1 lds
M v[76:79],a[104:107],a[40:43],v[76:79]
AF v26,v18,v19
C v40,v18,v19
M v[76:79],a[100:103],a[36:39],v[76:79]
E v24,v70
M v[76:79],a[96:99],a[32:35],v[76:79]
s_waitcnt lgkmcnt(0)
AF v26,v20,v26
C v41,v20,v21
M v[80:83],a[64:67],a[0:3],0
R a[96:99],v2,57344
R a[100:103],v2,58368
M v[80:83],a[68:71],a[4:7],v[80:83]
buffer_load_dwordx4 v4, s[8:11], s26 offen offset:1024 sc1 lds
M v[80:83],a[72:75],a[8:11],v[80:83]
E v25,v71
M v[80:83],a[76:79],a[12:15],v[80:83]
R a[104:107],v2,59392
R a[108:111],v2,60416
M v[80:83],a[80:83],a[16:19],v[80:83]
AF v26,v21,v26
AF v27,v22,v23
M v[80:83],a[84:87],a[20:23],v[80:83]
buffer_load_dwordx4 v4, s[8:11], s26 offen offset:2048 sc1 lds
M v[80:83],a[88:91],a[24:27],v[80:83]
R a[112:115],v2,61440
R a[116:119],v2,62464
M v[80:83],a[92:95],a[28:31],v[80:83]
E v18,v72
M v[84:87],a[92:95],a[60:63],0
E v19,v73
M v[84:87],a[88:91],a[56:59],v[84:87]
R a[120:123],v2,63488
R a[124:127],v2,64512
M v[84:87],a[84:87],a[52:55],v[84:87]
buffer_load_dwordx4 v4, s[8:11], s26 offen offset:3072 sc1 lds
M v[84:87],a[80:83],a[48:51],v[84:87]
SA s26,s26,32768
E v20,v74
M v[84:87],a[76:79],a[44:47],v[84:87]
SA m0,s28,32768
C v44,v22,v23
AF v27,v24,v27
M v[84:87],a[72:75],a[40:43],v[84:87]
C v45,v24,v25
AF v27,v25,v27
M v[84:87],a[68:71],a[36:39],v[84:87]
s_waitcnt vmcnt(8) lgkmcnt(0)
buffer_load_dwordx4 v3, s[8:11], s26 offen offset:0 sc1 lds
M v[84:87],a[64:67],a[32:35],v[84:87]
s_barrier
M v[88:91],a[96:99],a[0:3],0
R a[64:67],v2,0
R a[68:71],v2,1024
M v[88:91],a[100:103],a[4:7],v[88:91]
E v21,v75
M v[88:91],a[104:107],a[8:11],v[88:91]
buffer_load_dwordx4 v3, s[8:11], s26 offen offset:1024 sc1 lds
M v[88:91],a[108:111],a[12:15],v[88:91]
R a[72:75],v2,2048
R a[76:79],v2,3072
M v[88:91],a[112:115],a[16:19],v[88:91]
E v22,v76
M v[88:91],a[116:119],a[20:23],v[88:91]
E v23,v77
M v[88:91],a[120:123],a[24:27],v[88:91]
R a[80:83],v2,4096
R a[84:87],v2,5120
M v[88:91],a[124:127],a[28:31],v[88:91]
buffer_load_dwordx4 v3, s[8:11], s26 offen offset:2048 sc1 lds
M v[92:95],a[124:127],a[60:63],0
E v24,v78
M v[92:95],a[120:123],a[56:59],v[92:95]
R a[88:91],v2,6144
R a[92:95],v2,7168
M v[92:95],a[116:119],a[52:55],v[92:95]
E v25,v79
M v[92:95],a[112:115],a[48:51],v[92:95]
buffer_load_dwordx4 v3, s[8:11], s26 offen offset:3072 sc1 lds
M v[92:95],a[108:111],a[44:47],v[92:95]
AF v26,v18,v26
C v42,v18,v19
M v[92:95],a[104:107],a[40:43],v[92:95]
AF v26,v19,v26
AF v26,v20,v26
M v[92:95],a[100:103],a[36:39],v[92:95]
s_waitcnt lgkmcnt(0)
C v43,v20,v21
AF v26,v21,v26
M v[92:95],a[96:99],a[32:35],v[92:95]
AF v27,v22,v27
C v46,v22,v23
AF v27,v23,v27
AF v27,v24,v27
C v47,v24,v25
AF v27,v25,v27
M v[96:99],a[64:67],a[0:3],0
R a[96:99],v2,8192
R a[100:103],v2,9216
M v[96:99],a[68:71],a[4:7],v[96:99]
SA m0,s28,98304
E v18,v80
M v[96:99],a[72:75],a[8:11],v[96:99]
buffer_load_dwordx4 v3, s[8:11], s21 offen offset:0 sc1 lds
M v[96:99],a[76:79],a[12:15],v[96:99]
R a[104:107],v2,10240
R a[108:111],v2,11264
M v[96:99],a[80:83],a[16:19],v[96:99]
E v19,v81
M v[96:99],a[84:87],a[20:23],v[96:99]
AF v26,v18,v26
C v56,v18,v19
M v[96:99],a[88:91],a[24:27],v[96:99]
R a[112:115],v2,12288
R a[116:119],v2,13312
M v[96:99],a[92:95],a[28:31],v[96:99]
buffer_load_dwordx4 v3, s[8:11], s21 offen offset:1024 sc1 lds
M v[100:103],a[92:95],a[60:63],0
E v20,v82
M v[100:103],a[88:91],a[56:59],v[100:103]
R a[120:123],v2,14336
R a[124:127],v2,15360
M v[100:103],a[84:87],a[52:55],v[100:103]
E v21,v83
M v[100:103],a[80:83],a[48:51],v[100:103]
buffer_load_dwordx4 v3, s[8:11], s21 offen offset:2048 sc1 lds
M v[100:103],a[76:79],a[44:47],v[100:103]
AF v26,v19,v26
AF v26,v20,v26
M v[100:103],a[72:75],a[40:43],v[100:103]
E v22,v88
M v[100:103],a[68:71],a[36:39],v[100:103]
C v57,v20,v21
AF v26,v21,v26
M v[100:103],a[64:67],a[32:35],v[100:103]
s_waitcnt lgkmcnt(0)
buffer_load_dwordx4 v3, s[8:11], s21 offen offset:3072 sc1 lds
M v[104:107],a[96:99],a[0:3],0
R a[64:67],v2,16384
R a[68:71],v2,17408
M v[104:107],a[100:103],a[4:7],v[104:107]
E v23,v89
M v[104:107],a[104:107],a[8:11],v[104:107]
SA m0,s28,102400
AF v26,v22,v26
C v58,v22,v23
M v[104:107],a[108:111],a[12:15],v[104:107]
R a[72:75],v2,18432
R a[76:79],v2,19456
M v[104:107],a[112:115],a[16:19],v[104:107]
buffer_load_dwordx4 v4, s[8:11], s21 offen offset:0 sc1 lds
M v[104:107],a[116:119],a[20:23],v[104:107]
E v24,v90
M v[104:107],a[120:123],a[24:27],v[104:107]
R a[80:83],v2,20480
R a[84:87],v2,21504
M v[104:107],a[124:127],a[28:31],v[104:107]
E v25,v91
M v[108:111],a[124:127],a[60:63],0
buffer_load_dwordx4 v4, s[8:11], s21 offen offset:1024 sc1 lds
M v[108:111],a[120:123],a[56:59],v[108:111]
R a[88:91],v2,22528
R a[92:95],v2,23552
M v[108:111],a[116:119],a[52:55],v[108:111]
AF v26,v23,v26
AF v26,v24,v26
M v[108:111],a[112:115],a[48:51],v[108:111]
E v18,v84
M v[108:111],a[108:111],a[44:47],v[108:111]
buffer_load_dwordx4 v4, s[8:11], s21 offen offset:2048 sc1 lds
M v[108:111],a[104:107],a[40:43],v[108:111]
C v59,v24,v25
AF v26,v25,v26
M v[108:111],a[100:103],a[36:39],v[108:111]
E v19,v85
M v[108:111],a[96:99],a[32:35],v[108:111]
s_waitcnt lgkmcnt(0)
AF v27,v18,v27
C v60,v18,v19
M v[112:115],a[64:67],a[0:3],0
R a[96:99],v2,24576
R a[100:103],v2,25600
M v[112:115],a[68:71],a[4:7],v[112:115]
buffer_load_dwordx4 v4, s[8:11], s21 offen offset:3072 sc1 lds
M v[112:115],a[72:75],a[8:11],v[112:115]
SA s21,s21,32768
E v20,v86
M v[112:115],a[76:79],a[12:15],v[112:115]
s_sub_u32 s22, s22, 1
R a[104:107],v2,26624
R a[108:111],v2,27648
M v[112:115],a[80:83],a[16:19],v[112:115]
s_cselect_b32 s21, s23, s21
AF v27,v19,v27
C v129,v130,v131
M v[112:115],a[84:87],a[20:23],v[112:115]
SA m0,s28,36864
E v21,v87
M v[112:115],a[88:91],a[24:27],v[112:115]
R a[112:115],v2,28672
R a[116:119],v2,29696
M v[112:115],a[92:95],a[28:31],v[112:115]
buffer_load_dwordx4 v4, s[8:11], s26 offen offset:0 sc1 lds
M v[116:119],a[92:95],a[60:63],0
E v22,v92
M v[116:119],a[88:91],a[56:59],v[116:119]
R a[120:123],v2,30720
R a[124:127],v2,31744
M v[116:119],a[84:87],a[52:55],v[116:119]
AF v27,v20,v27
C v61,v20,v21
M v[116:119],a[80:83],a[48:51],v[116:119]
buffer_load_dwordx4 v4, s[8:11], s26 offen offset:1024 sc1 lds
M v[116:119],a[76:79],a[44:47],v[116:119]
E v23,v93
M v[116:119],a[72:75],a[40:43],v[116:119]
AF v27,v21,v27
AF v27,v22,v27
M v[116:119],a[68:71],a[36:39],v[116:119]
s_waitcnt vmcnt(14) lgkmcnt(0)
C v62,v22,v23
AF v27,v23,v27
M v[116:119],a[64:67],a[32:35],v[116:119]
s_barrier
M v[120:123],a[96:99],a[0:3],0
R a[64:67],v7,0
R a[68:71],v7,1024
M v[120:123],a[100:103],a[4:7],v[120:123]
buffer_load_dwordx4 v4, s[8:11], s26 offen offset:2048 sc1 lds
M v[120:123],a[104:107],a[8:11],v[120:123]
E v24,v94
M v[120:123],a[108:111],a[12:15],v[120:123]
R a[72:75],v7,2048
R a[76:79],v7,3072
M v[120:123],a[112:115],a[16:19],v[120:123]
E v25,v95
M v[120:123],a[116:119],a[20:23],v[120:123]
buffer_load_dwordx4 v4, s[8:11], s26 offen offset:3072 sc1 lds
M v[120:123],a[120:123],a[24:27],v[120:123]
R a[80:83],v7,4096
R a[84:87],v7,5120
M v[120:123],a[124:127],a[28:31],v[120:123]
AF v27,v24,v27
C v63,v24,v25
M v[124:127],a[124:127],a[60:63],0
SA s26,s26,32768
AF v27,v25,v27
C v130,v136,v137
M v[124:127],a[120:123],a[56:59],v[124:127]
R a[88:91],v7,6144
R a[92:95],v7,7168
C v131,v138,v139
W a128,v128
W a129,v129
W a130,v130
W a131,v131
C v144,v144,v145
C v145,v146,v147
C v146,v152,v153
C v147,v154,v155
W a132,v144
W a133,v145
W a134,v146
W a135,v147
C v132,v132,v133
C v133,v134,v135
C v134,v140,v141
C v135,v142,v143
W a160,v132
W a161,v133
W a162,v134
W a163,v135
C v160,v160,v161
C v161,v162,v163
C v162,v168,v169
C v163,v170,v171
W a136,v160
W a137,v161
W a138,v162
W a139,v163
C v148,v148,v149
C v149,v150,v151
C v150,v156,v157
C v151,v158,v159
W a164,v148
W a165,v149
W a166,v150
W a167,v151
C v176,v176,v177
C v177,v178,v179
C v178,v184,v185
C v179,v186,v187
W a140,v176
W a141,v177
W a142,v178
W a143,v179
C v164,v164,v165
C v165,v166,v167
C v166,v172,v173
C v167,v174,v175
W a168,v164
W a169,v165
W a170,v166
W a171,v167
C v192,v192,v193
C v193,v194,v195
C v194,v200,v201
C v195,v202,v203
W a144,v192
W a145,v193
W a146,v194
W a147,v195
C v180,v180,v181
C v181,v182,v183
C v182,v188,v189
C v183,v190,v191
W a172,v180
W a173,v181
W a174,v182
W a175,v183
C v208,v208,v209
C v209,v210,v211
C v210,v216,v217
C v211,v218,v219
W a148,v208
W a149,v209
W a150,v210
W a151,v211
C v196,v196,v197
C v197,v198,v199
C v198,v204,v205
C v199,v206,v207
W a176,v196
W a177,v197
W a178,v198
W a179,v199
C v224,v224,v225
C v225,v226,v227
C v226,v232,v233
C v227,v234,v235
W a152,v224
W a153,v225
W a154,v226
W a155,v227
C v212,v212,v213
C v213,v214,v215
C v214,v220,v221
C v215,v222,v223
W a180,v212
W a181,v213
W a182,v214
W a183,v215
C v240,v240,v241
C v241,v242,v243
C v242,v248,v249
C v243,v250,v251
W a156,v240
W a157,v241
W a158,v242
W a159,v243
C v228,v228,v229
C v229,v230,v231
C v230,v236,v237
C v231,v238,v239
W a184,v228
W a185,v229
W a186,v230
W a187,v231
C v244,v244,v245
C v245,v246,v247
C v246,v252,v253
C v247,v254,v255
W a188,v244
W a189,v245
W a190,v246
W a191,v247
M v[124:127],a[116:119],a[52:55],v[124:127]
M v[124:127],a[112:115],a[48:51],v[124:127]
M v[124:127],a[108:111],a[44:47],v[124:127]
M v[124:127],a[104:107],a[40:43],v[124:127]
M v[124:127],a[100:103],a[36:39],v[124:127]
s_waitcnt lgkmcnt(0)
M v[124:127],a[96:99],a[32:35],v[124:127]
v_max_f32 v10, v26, v27
v_min_f32 v11, v26, v27
v_cmp_lt_f32 vcc, s31, v10
v_cmp_gt_f32 s[64:65], s24, v11
s_nop 0
s_or_b64 vcc, vcc, s[64:65]
s_cbranch_vccnz L_sth1
L_rth1:
M v[128:131],a[64:67],v[40:43],0
R a[96:99],v7,8192
R a[100:103],v7,9216
M v[128:131],a[68:71],v[56:59],v[128:131]
SA m0,s28,65536
E v18,v96
M v[132:135],a[68:71],v[60:63],0
buffer_load_dwordx4 v3, s[8:11], s21 offen offset:0 sc1 lds
M v[132:135],a[64:67],v[44:47],v[132:135]
R a[104:107],v7,10240
R a[108:111],v7,11264
M v[136:139],a[72:75],v[40:43],0
E v19,v97
M v[136:139],a[76:79],v[56:59],v[136:139]
AF v30,v26,v30
AF v31,v27,v31
M v[140:143],a[76:79],v[60:63],0
R a[112:115],v7,12288
R a[116:119],v7,13312
M v[140:143],a[72:75],v[44:47],v[140:143]
buffer_load_dwordx4 v3, s[8:11], s21 offen offset:1024 sc1 lds
M v[144:147],a[80:83],v[40:43],0
E v20,v98
M v[144:147],a[84:87],v[56:59],v[144:147]
R a[120:123],v7,14336
R a[124:127],v7,15360
M v[148:151],a[84:87],v[60:63],0
s_mov_b32 s40, 0
AF v28,v18,v19
C v48,v18,v19
M v[148:151],a[80:83],v[44:47],v[148:151]
s_mov_b32 s7, 0
buffer_load_dwordx4 v3, s[8:11], s21 offen offset:2048 sc1 lds
M v[152:155],a[88:91],v[40:43],0
s_and_b32 s39, s39, 3
E v21,v99
M v[152:155],a[92:95],v[56:59],v[152:155]
s_sub_u32 s27, 5, s42
AF v28,v20,v28
C v49,v20,v21
M v[156:159],a[92:95],v[60:63],0
AF v28,v21,v28
M v[156:159],a[88:91],v[44:47],v[156:159]
s_waitcnt lgkmcnt(0)
buffer_load_dwordx4 v3, s[8:11], s21 offen offset:3072 sc1 lds
M v[160:163],a[96:99],v[40:43],0
SA m0,s28,69632
R a[64:67],v7,16384
R a[68:71],v7,17408
M v[160:163],a[100:103],v[56:59],v[160:163]
E v22,v104
M v[164:167],a[100:103],v[60:63],0
E v23,v105
M v[164:167],a[96:99],v[44:47],v[164:167]
R a[72:75],v7,18432
R a[76:79],v7,19456
M v[168:171],a[104:107],v[40:43],0
buffer_load_dwordx4 v4, s[8:11], s21 offen offset:0 sc1 lds
M v[168:171],a[108:111],v[56:59],v[168:171]
AF v28,v22,v28
C v50,v22,v23
M v[172:175],a[108:111],v[60:63],0
R a[80:83],v7,20480
R a[84:87],v7,21504
M v[172:175],a[104:107],v[44:47],v[172:175]
buffer_load_dwordx4 v4, s[8:11], s21 offen offset:1024 sc1 lds
M v[176:179],a[112:115],v[40:43],0
E v24,v106
M v[176:179],a[116:119],v[56:59],v[176:179]
R a[88:91],v7,22528
R a[92:95],v7,23552
M v[180:183],a[116:119],v[60:63],0
buffer_load_dwordx4 v4, s[8:11], s21 offen offset:2048 sc1 lds
M v[180:183],a[112:115],v[44:47],v[180:183]
E v25,v107
M v[184:187],a[120:123],v[40:43],0
AF v28,v23,v28
AF v28,v24,v28
M v[184:187],a[124:127],v[56:59],v[184:187]
C v51,v24,v25
AF v28,v25,v28
M v[188:191],a[124:127],v[60:63],0
buffer_load_dwordx4 v4, s[8:11], s21 offen offset:3072 sc1 lds
M v[188:191],a[120:123],v[44:47],v[188:191]
s_waitcnt lgkmcnt(0)
E v18,v100
M v[192:195],a[64:67],v[40:43],0
SA s21,s21,32768
R a[96:99],v7,24576
R a[100:103],v7,25600
M v[192:195],a[68:71],v[56:59],v[192:195]
s_sub_u32 s22, s22, 1
E v19,v101
M v[196:199],a[68:71],v[60:63],0
s_cselect_b32 s21, s23, s21
AF v29,v18,v19
C v52,v18,v19
M v[196:199],a[64:67],v[44:47],v[196:199]
R a[104:107],v7,26624
R a[108:111],v7,27648
M v[200:203],a[72:75],v[40:43],0
M v[200:203],a[76:79],v[56:59],v[200:203]
E v20,v102
M v[204:207],a[76:79],v[60:63],0
R a[112:115],v7,28672
R a[116:119],v7,29696
M v[204:207],a[72:75],v[44:47],v[204:207]
M v[208:211],a[80:83],v[40:43],0
M v[208:211],a[84:87],v[56:59],v[208:211]
R a[120:123],v7,30720
R a[124:127],v7,31744
M v[212:215],a[84:87],v[60:63],0
E v21,v103
M v[212:215],a[80:83],v[44:47],v[212:215]
AF v29,v20,v29
C v53,v20,v21
M v[216:219],a[88:91],v[40:43],0
AF v29,v21,v29
M v[216:219],a[92:95],v[56:59],v[216:219]
E v22,v108
M v[220:223],a[92:95],v[60:63],0
s_waitcnt vmcnt(12) lgkmcnt(0)
M v[220:223],a[88:91],v[44:47],v[220:223]
s_barrier
M v[224:227],a[96:99],v[40:43],0
R a[64:67],v2,32768
R a[68:71],v2,33792
M v[224:227],a[100:103],v[56:59],v[224:227]
E v23,v109
M v[228:231],a[100:103],v[60:63],0
AF v29,v22,v29
C v54,v22,v23
M v[228:231],a[96:99],v[44:47],v[228:231]
R a[72:75],v2,34816
R a[76:79],v2,35840
M v[232:235],a[104:107],v[40:43],0
E v24,v110
M v[232:235],a[108:111],v[56:59],v[232:235]
AF v29,v23,v29
M v[236:239],a[108:111],v[60:63],0
R a[80:83],v2,36864
R a[84:87],v2,37888
M v[236:239],a[104:107],v[44:47],v[236:239]
M v[240:243],a[112:115],v[40:43],0
E v25,v111
M v[240:243],a[116:119],v[56:59],v[240:243]
R a[88:91],v2,38912
R a[92:95],v2,39936
M v[244:247],a[116:119],v[60:63],0
AF v29,v24,v29
C v55,v24,v25
M v[244:247],a[112:115],v[44:47],v[244:247]
AF v29,v25,v29
M v[248:251],a[120:123],v[40:43],0
M v[248:251],a[124:127],v[56:59],v[248:251]
M v[252:255],a[124:127],v[60:63],0
s_waitcnt lgkmcnt(0)
M v[252:255],a[120:123],v[44:47],v[252:255]
s_cmp_lg_u32 s27, 0
s_cbranch_scc1 L_loop_top
L_final_h:
s_waitcnt vmcnt(8) lgkmcnt(0)
s_barrier
R a[64:67],v7,32768
R a[68:71],v7,33792
R a[72:75],v7,34816
R a[76:79],v7,35840
R a[80:83],v7,36864
R a[84:87],v7,37888
R a[88:91],v7,38912
R a[92:95],v7,39936
v_lshrrev_b32 v14, 7, v7
v_mul_u32_u24 v14, 896, v14
v_lshrrev_b32 v15, 8, v7
v_lshlrev_b32 v15, 5, v15
v_xor_b32 v15, v15, v7
v_and_b32 v15, 0x70, v15
v_add_u32 v0, v14, v15
s_mul_i32 s38, s20, 57344
SA m0,s28,98304
SA s85,s38,0
E v18,v112
buffer_load_dwordx4 v0, s[12:15], s85 offen offset:0 lds
E v19,v113
E v20,v114
AF v28,v18,v28
SA s85,s38,6144
C v56,v18,v19
buffer_load_dwordx4 v0, s[12:15], s85 offen offset:1024 lds
E v21,v115
AF v28,v19,v28
E v22,v120
AF v28,v20,v28
SA s85,s38,12288
C v57,v20,v21
buffer_load_dwordx4 v0, s[12:15], s85 offen offset:2048 lds
E v23,v121
AF v28,v21,v28
E v24,v122
AF v28,v22,v28
SA s85,s38,18432
C v58,v22,v23
buffer_load_dwordx4 v0, s[12:15], s85 offen offset:3072 lds
E v25,v123
AF v28,v23,v28
E v18,v116
AF v28,v24,v28
SA m0,s28,102400
SA s85,s38,28672
C v59,v24,v25
buffer_load_dwordx4 v0, s[12:15], s85 offen offset:0 lds
E v19,v117
AF v28,v25,v28
E v20,v118
AF v29,v18,v29
SA s85,s38,34816
C v60,v18,v19
buffer_load_dwordx4 v0, s[12:15], s85 offen offset:1024 lds
E v21,v119
AF v29,v19,v29
E v22,v124
AF v29,v20,v29
SA s85,s38,40960
C v61,v20,v21
buffer_load_dwordx4 v0, s[12:15], s85 offen offset:2048 lds
E v23,v125
AF v29,v21,v29
E v24,v126
AF v29,v22,v29
SA s85,s38,47104
C v62,v22,v23
buffer_load_dwordx4 v0, s[12:15], s85 offen offset:3072 lds
SA s38,s38,128
E v25,v127
AF v29,v23,v29
AF v29,v24,v29
C v63,v24,v25
AF v29,v25,v29
v_max_f32 v10, v28, v29
v_cmp_lt_f32 vcc, s31, v10
s_nop 0
s_cbranch_vccnz L_stfh
L_rtfh:
AF v30,v28,v30
AF v31,v29,v31
v_mov_b32 v10, v32
v_mov_b32 v11, v36
v_mov_b32 v12, v30
v_mov_b32 v13, v31
buffer_store_dwordx4 v[10:13], v7, s[8:11], s90 offen sc1
s_waitcnt lgkmcnt(0)
M v[128:131],a[64:67],v[48:51],v[128:131]
SA m0,s28,65536
R a[96:99],v7,40960
R a[100:103],v7,41984
M v[128:131],a[68:71],v[56:59],v[128:131]
SA s85,s38,0
buffer_load_dwordx4 v0, s[12:15], s85 offen offset:0 lds
M v[132:135],a[68:71],v[60:63],v[132:135]
SA s85,s38,6144
v_lshrrev_b32 v16, 4, v7
v_lshrrev_b32 v14, 2, v16
M v[132:135],a[64:67],v[52:55],v[132:135]
R a[104:107],v7,43008
R a[108:111],v7,44032
M v[136:139],a[72:75],v[48:51],v[136:139]
buffer_load_dwordx4 v0, s[12:15], s85 offen offset:1024 lds
M v[136:139],a[76:79],v[56:59],v[136:139]
SA s85,s38,12288
v_lshlrev_b32 v14, 7, v14
v_and_b32 v15, 3, v16
M v[140:143],a[76:79],v[60:63],v[140:143]
R a[112:115],v7,45056
R a[116:119],v7,46080
M v[140:143],a[72:75],v[52:55],v[140:143]
buffer_load_dwordx4 v0, s[12:15], s85 offen offset:2048 lds
M v[144:147],a[80:83],v[48:51],v[144:147]
SA s85,s38,18432
v_lshl_add_u32 v14, v15, 3, v14
v_bfe_u32 v15, v16, 3, 2
M v[144:147],a[84:87],v[56:59],v[144:147]
R a[120:123],v7,47104
R a[124:127],v7,48128
M v[148:151],a[84:87],v[60:63],v[148:151]
buffer_load_dwordx4 v0, s[12:15], s85 offen offset:3072 lds
M v[148:151],a[80:83],v[52:55],v[148:151]
v_lshl_add_u32 v18, v15, 5, v14
v_xor_b32 v19, 32, v18
M v[152:155],a[88:91],v[48:51],v[152:155]
v_xor_b32 v20, 64, v18
v_xor_b32 v21, 0x60, v18
M v[152:155],a[92:95],v[56:59],v[152:155]
v_add_u32 v22, 0x10000, v18
v_add_u32 v23, 0x10000, v19
M v[156:159],a[92:95],v[60:63],v[156:159]
v_add_u32 v24, 0x10000, v20
v_add_u32 v25, 0x10000, v21
M v[156:159],a[88:91],v[52:55],v[156:159]
s_waitcnt lgkmcnt(0)
C v128,v128,v129
C v129,v130,v131
M v[160:163],a[96:99],v[48:51],v[160:163]
R a[64:67],v7,49152
R a[68:71],v7,50176
M v[160:163],a[100:103],v[56:59],v[160:163]
C v130,v136,v137
C v131,v138,v139
M v[164:167],a[100:103],v[60:63],v[164:167]
buffer_store_dwordx4 v[128:131], v7, s[8:11], s86 offen offset:0 sc1
M v[164:167],a[96:99],v[52:55],v[164:167]
R a[72:75],v7,51200
R a[76:79],v7,52224
M v[168:171],a[104:107],v[48:51],v[168:171]
C v132,v132,v133
C v133,v134,v135
M v[168:171],a[108:111],v[56:59],v[168:171]
C v134,v140,v141
C v135,v142,v143
M v[172:175],a[108:111],v[60:63],v[172:175]
R a[80:83],v7,53248
R a[84:87],v7,54272
M v[172:175],a[104:107],v[52:55],v[172:175]
buffer_store_dwordx4 v[132:135], v7, s[8:11], s88 offen offset:0 sc1
M v[176:179],a[112:115],v[48:51],v[176:179]
C v144,v144,v145
C v145,v146,v147
M v[176:179],a[116:119],v[56:59],v[176:179]
R a[88:91],v7,55296
R a[92:95],v7,56320
M v[180:183],a[116:119],v[60:63],v[180:183]
C v146,v152,v153
C v147,v154,v155
M v[180:183],a[112:115],v[52:55],v[180:183]
buffer_store_dwordx4 v[144:147], v7, s[8:11], s86 offen offset:1024 sc1
M v[184:187],a[120:123],v[48:51],v[184:187]
C v148,v148,v149
C v149,v150,v151
M v[184:187],a[124:127],v[56:59],v[184:187]
C v150,v156,v157
C v151,v158,v159
M v[188:191],a[124:127],v[60:63],v[188:191]
buffer_store_dwordx4 v[148:151], v7, s[8:11], s88 offen offset:1024 sc1
M v[188:191],a[120:123],v[52:55],v[188:191]
s_waitcnt lgkmcnt(0)
C v160,v160,v161
C v161,v162,v163
M v[192:195],a[64:67],v[48:51],v[192:195]
R a[96:99],v7,57344
R a[100:103],v7,58368
M v[192:195],a[68:71],v[56:59],v[192:195]
C v162,v168,v169
C v163,v170,v171
M v[196:199],a[68:71],v[60:63],v[196:199]
buffer_store_dwordx4 v[160:163], v7, s[8:11], s86 offen offset:2048 sc1
M v[196:199],a[64:67],v[52:55],v[196:199]
R a[104:107],v7,59392
R a[108:111],v7,60416
M v[200:203],a[72:75],v[48:51],v[200:203]
C v164,v164,v165
C v165,v166,v167
M v[200:203],a[76:79],v[56:59],v[200:203]
C v166,v172,v173
C v167,v174,v175
M v[204:207],a[76:79],v[60:63],v[204:207]
R a[112:115],v7,61440
R a[116:119],v7,62464
M v[204:207],a[72:75],v[52:55],v[204:207]
buffer_store_dwordx4 v[164:167], v7, s[8:11], s88 offen offset:2048 sc1
M v[208:211],a[80:83],v[48:51],v[208:211]
C v176,v176,v177
C v177,v178,v179
M v[208:211],a[84:87],v[56:59],v[208:211]
R a[120:123],v7,63488
R a[124:127],v7,64512
M v[212:215],a[84:87],v[60:63],v[212:215]
C v178,v184,v185
C v179,v186,v187
M v[212:215],a[80:83],v[52:55],v[212:215]
buffer_store_dwordx4 v[176:179], v7, s[8:11], s86 offen offset:3072 sc1
M v[216:219],a[88:91],v[48:51],v[216:219]
C v180,v180,v181
C v181,v182,v183
M v[216:219],a[92:95],v[56:59],v[216:219]
C v182,v188,v189
C v183,v190,v191
M v[220:223],a[92:95],v[60:63],v[220:223]
s_waitcnt vmcnt(12) lgkmcnt(0)
buffer_store_dwordx4 v[180:183], v7, s[8:11], s88 offen offset:3072 sc1
M v[220:223],a[88:91],v[52:55],v[220:223]
s_barrier
M v[224:227],a[96:99],v[48:51],v[224:227]
s_nop 0
T a[64:65],v22,32768
T a[66:67],v22,34816
M v[224:227],a[100:103],v[56:59],v[224:227]
T a[68:69],v22,36864
T a[70:71],v22,38912
M v[228:231],a[100:103],v[60:63],v[228:231]
C v192,v192,v193
C v193,v194,v195
M v[228:231],a[96:99],v[52:55],v[228:231]
T a[72:73],v22,40960
T a[74:75],v22,43008
M v[232:235],a[104:107],v[48:51],v[232:235]
T a[76:77],v22,45056
T a[78:79],v22,47104
M v[232:235],a[108:111],v[56:59],v[232:235]
C v194,v200,v201
C v195,v202,v203
M v[236:239],a[108:111],v[60:63],v[236:239]
T a[80:81],v22,49152
T a[82:83],v22,51200
M v[236:239],a[104:107],v[52:55],v[236:239]
T a[84:85],v22,53248
T a[86:87],v22,55296
M v[240:243],a[112:115],v[48:51],v[240:243]
buffer_store_dwordx4 v[192:195], v7, s[8:11], s87 offen offset:0 sc1
M v[240:243],a[116:119],v[56:59],v[240:243]
s_nop 0
T a[88:89],v22,57344
T a[90:91],v22,59392
M v[244:247],a[116:119],v[60:63],v[244:247]
T a[92:93],v22,61440
T a[94:95],v22,63488
M v[244:247],a[112:115],v[52:55],v[244:247]
C v196,v196,v197
C v197,v198,v199
M v[248:251],a[120:123],v[48:51],v[248:251]
C v198,v204,v205
C v199,v206,v207
M v[248:251],a[124:127],v[56:59],v[248:251]
buffer_store_dwordx4 v[196:199], v7, s[8:11], s89 offen offset:0 sc1
M v[252:255],a[124:127],v[60:63],v[252:255]
s_waitcnt lgkmcnt(0)
C v208,v208,v209
C v209,v210,v211
M v[252:255],a[120:123],v[52:55],v[252:255]
C v210,v216,v217
C v211,v218,v219
buffer_store_dwordx4 v[208:211], v7, s[8:11], s87 offen offset:1024 sc1
C v212,v212,v213
C v213,v214,v215
C v214,v220,v221
C v215,v222,v223
buffer_store_dwordx4 v[212:215], v7, s[8:11], s89 offen offset:1024 sc1
C v224,v224,v225
C v225,v226,v227
C v226,v232,v233
C v227,v234,v235
buffer_store_dwordx4 v[224:227], v7, s[8:11], s87 offen offset:2048 sc1
C v228,v228,v229
C v229,v230,v231
C v230,v236,v237
C v231,v238,v239
buffer_store_dwordx4 v[228:231], v7, s[8:11], s89 offen offset:2048 sc1
C v240,v240,v241
C v241,v242,v243
C v242,v248,v249
C v243,v250,v251
buffer_store_dwordx4 v[240:243], v7, s[8:11], s87 offen offset:3072 sc1
C v244,v244,v245
C v245,v246,v247
C v246,v252,v253
C v247,v254,v255
buffer_store_dwordx4 v[244:247], v7, s[8:11], s89 offen offset:3072 sc1
M v[64:67],a[64:67],a[128:131],0
s_nop 0
T a[96:97],v23,32768
T a[98:99],v23,34816
M v[64:67],a[68:71],a[132:135],v[64:67]
SA m0,s28,69632
T a[100:101],v23,36864
T a[102:103],v23,38912
M v[64:67],a[72:75],a[136:139],v[64:67]
SA s85,s38,28672
buffer_load_dwordx4 v0, s[12:15], s85 offen offset:0 lds
M v[64:67],a[76:79],a[140:143],v[64:67]
SA s85,s38,34816
T a[104:105],v23,40960
T a[106:107],v23,43008
M v[64:67],a[80:83],a[144:147],v[64:67]
SA s29,s33,0
T a[108:109],v23,45056
T a[110:111],v23,47104
M v[64:67],a[84:87],a[148:151],v[64:67]
SA s30,s33,14336
buffer_load_dwordx4 v0, s[12:15], s85 offen offset:1024 lds
M v[64:67],a[88:91],a[152:155],v[64:67]
SA s85,s38,40960
T a[112:113],v23,49152
T a[114:115],v23,51200
M v[64:67],a[92:95],a[156:159],v[64:67]
T a[116:117],v23,53248
T a[118:119],v23,55296
M v[68:71],a[92:95],a[188:191],0
buffer_load_dwordx4 v0, s[12:15], s85 offen offset:2048 lds
M v[68:71],a[88:91],a[184:187],v[68:71]
SA s85,s38,47104
T a[120:121],v23,57344
T a[122:123],v23,59392
M v[68:71],a[84:87],a[180:183],v[68:71]
T a[124:125],v23,61440
T a[126:127],v23,63488
M v[68:71],a[80:83],a[176:179],v[68:71]
buffer_load_dwordx4 v0, s[12:15], s85 offen offset:3072 lds
M v[68:71],a[76:79],a[172:175],v[68:71]
SA s38,s38,128
G v5,a192
G v6,a193
M v[68:71],a[72:75],a[168:171],v[68:71]
s_sub_u32 s64, 15, s42
M v[68:71],a[68:71],a[164:167],v[68:71]
s_min_u32 s64, s64, s42
M v[68:71],a[64:67],a[160:163],v[68:71]
s_waitcnt lgkmcnt(0)
M v[72:75],a[96:99],a[128:131],0
s_mul_i32 s45, s64, 8704
T a[64:65],v24,32768
T a[66:67],v24,34816
M v[72:75],a[100:103],a[132:135],v[72:75]
s_lshl_b32 s64, s41, 2
T a[68:69],v24,36864
T a[70:71],v24,38912
M v[72:75],a[104:107],a[136:139],v[72:75]
SA s45,s45,s64
M v[72:75],a[108:111],a[140:143],v[72:75]
s_lshl_b32 s64, s20, 8
T a[72:73],v24,40960
T a[74:75],v24,43008
M v[72:75],a[112:115],a[144:147],v[72:75]
SA s45,s45,s64
T a[76:77],v24,45056
T a[78:79],v24,47104
M v[72:75],a[116:119],a[148:151],v[72:75]
SA s45,s45,104992768
M v[72:75],a[120:123],a[152:155],v[72:75]
s_mov_b32 s64, 1024
T a[80:81],v24,49152
T a[82:83],v24,51200
M v[72:75],a[124:127],a[156:159],v[72:75]
s_mov_b32 s66, 4096
T a[84:85],v24,53248
T a[86:87],v24,55296
M v[76:79],a[124:127],a[188:191],0
s_cmp_lt_u32 s42, 8
M v[76:79],a[120:123],a[184:187],v[76:79]
s_cselect_b32 s64, 4352, s64
T a[88:89],v24,57344
T a[90:91],v24,59392
M v[76:79],a[116:119],a[180:183],v[76:79]
s_cselect_b32 s65, 0, 64
T a[92:93],v24,61440
T a[94:95],v24,63488
M v[76:79],a[112:115],a[176:179],v[76:79]
s_cselect_b32 s66, 536870912, s66
MF v64,v5,v64
MF v65,v5,v65
M v[76:79],a[108:111],a[172:175],v[76:79]
SA s3,s45,s64
MF v66,v5,v66
MF v67,v5,v67
M v[76:79],a[104:107],a[168:171],v[76:79]
SA s45,s45,s65
v_lshrrev_b32 v17, 5, v7
v_min_u32 v15, 1, v17
M v[76:79],a[100:103],a[164:167],v[76:79]
SA m0,s28,0
v_lshlrev_b32 v14, 3, v7
v_lshl_or_b32 v16, v15, 29, v14
M v[76:79],a[96:99],a[160:163],v[76:79]
s_waitcnt lgkmcnt(0)
v_cmp_eq_u32 vcc, 1, v17
v_add_u32 v14, s66, v14
M v[80:83],a[64:67],a[128:131],0
SA s85,s38,0
T a[96:97],v25,32768
T a[98:99],v25,34816
M v[80:83],a[68:71],a[132:135],v[80:83]
T a[100:101],v25,36864
T a[102:103],v25,38912
M v[80:83],a[72:75],a[136:139],v[80:83]
buffer_load_dwordx4 v0, s[12:15], s85 offen offset:0 lds
M v[80:83],a[76:79],a[140:143],v[80:83]
SA s85,s38,6144
T a[104:105],v25,40960
T a[106:107],v25,43008
M v[80:83],a[80:83],a[144:147],v[80:83]
T a[108:109],v25,45056
T a[110:111],v25,47104
M v[80:83],a[84:87],a[148:151],v[80:83]
buffer_load_dwordx4 v0, s[12:15], s85 offen offset:1024 lds
M v[80:83],a[88:91],a[152:155],v[80:83]
SA s85,s38,12288
T a[112:113],v25,49152
T a[114:115],v25,51200
M v[80:83],a[92:95],a[156:159],v[80:83]
T a[116:117],v25,53248
T a[118:119],v25,55296
M v[84:87],a[92:95],a[188:191],0
buffer_load_dwordx4 v0, s[12:15], s85 offen offset:2048 lds
M v[84:87],a[88:91],a[184:187],v[84:87]
SA s85,s38,18432
T a[120:121],v25,57344
T a[122:123],v25,59392
M v[84:87],a[84:87],a[180:183],v[84:87]
T a[124:125],v25,61440
T a[126:127],v25,63488
M v[84:87],a[80:83],a[176:179],v[84:87]
buffer_load_dwordx4 v0, s[12:15], s85 offen offset:3072 lds
M v[84:87],a[76:79],a[172:175],v[84:87]
SA m0,s28,4096
v_mov_b32 v15, 1
v_cndmask_b32 v17, v16, v14, vcc
M v[84:87],a[72:75],a[168:171],v[84:87]
SA s85,s38,28672
buffer_load_dwordx4 v0, s[12:15], s85 offen offset:0 lds
M v[84:87],a[68:71],a[164:167],v[84:87]
s_waitcnt vmcnt(5) lgkmcnt(0)
v_min_u32 v10, 1, v7
v_lshlrev_b32 v10, 29, v10
M v[84:87],a[64:67],a[160:163],v[84:87]
s_barrier
M v[88:91],a[96:99],a[128:131],0
SA s85,s38,34816
T a[64:65],v22,0
T a[66:67],v22,2048
M v[88:91],a[100:103],a[132:135],v[88:91]
T a[68:69],v22,4096
T a[70:71],v22,6144
M v[88:91],a[104:107],a[136:139],v[88:91]
buffer_load_dwordx4 v0, s[12:15], s85 offen offset:1024 lds
M v[88:91],a[108:111],a[140:143],v[88:91]
SA s85,s38,40960
T a[72:73],v22,8192
T a[74:75],v22,10240
M v[88:91],a[112:115],a[144:147],v[88:91]
T a[76:77],v22,12288
T a[78:79],v22,14336
M v[88:91],a[116:119],a[148:151],v[88:91]
buffer_load_dwordx4 v0, s[12:15], s85 offen offset:2048 lds
M v[88:91],a[120:123],a[152:155],v[88:91]
SA s85,s38,47104
T a[80:81],v22,16384
T a[82:83],v22,18432
M v[88:91],a[124:127],a[156:159],v[88:91]
T a[84:85],v22,20480
T a[86:87],v22,22528
M v[92:95],a[124:127],a[188:191],0
buffer_store_dword v15, v10, s[8:11], s47 offen sc1
M v[92:95],a[120:123],a[184:187],v[92:95]
s_nop 0
T a[88:89],v22,24576
T a[90:91],v22,26624
M v[92:95],a[116:119],a[180:183],v[92:95]
T a[92:93],v22,28672
T a[94:95],v22,30720
M v[92:95],a[112:115],a[176:179],v[92:95]
buffer_load_dwordx4 v0, s[12:15], s85 offen offset:3072 lds
M v[92:95],a[108:111],a[172:175],v[92:95]
SA s38,s38,128
MF v72,v5,v72
MF v73,v5,v73
M v[92:95],a[104:107],a[168:171],v[92:95]
SA m0,s28,131072
MF v74,v5,v74
MF v75,v5,v75
M v[92:95],a[100:103],a[164:167],v[92:95]
s_waitcnt lgkmcnt(0)
C v64,v64,v65
C v65,v66,v67
M v[92:95],a[96:99],a[160:163],v[92:95]
SA s85,s38,0
C v66,v72,v73
C v67,v74,v75
buffer_store_dwordx4 v[64:67], v7, s[8:11], s29 offen offset:0 sc1
buffer_load_dwordx4 v0, s[12:15], s85 offen offset:0 lds
v_add_u32 v40, 0x20000, v18
v_add_u32 v41, 0x20000, v19
v_add_u32 v42, 0x20000, v20
v_add_u32 v43, 0x20000, v21
SA s85,s38,6144
MF v68,v6,v68
MF v69,v6,v69
MF v70,v6,v70
MF v71,v6,v71
MF v76,v6,v76
MF v77,v6,v77
MF v78,v6,v78
MF v79,v6,v79
C v68,v68,v69
C v69,v70,v71
C v70,v76,v77
C v71,v78,v79
buffer_store_dwordx4 v[68:71], v7, s[8:11], s30 offen offset:0 sc1
buffer_load_dwordx4 v0, s[12:15], s85 offen offset:1024 lds
SA s85,s38,12288
buffer_load_dwordx4 v0, s[12:15], s85 offen offset:2048 lds
SA s85,s38,18432
buffer_load_dwordx4 v0, s[12:15], s85 offen offset:3072 lds
M v[96:99],a[64:67],a[128:131],0
s_nop 0
T a[96:97],v23,0
T a[98:99],v23,2048
M v[96:99],a[68:71],a[132:135],v[96:99]
SA m0,s28,135168
T a[100:101],v23,4096
T a[102:103],v23,6144
M v[96:99],a[72:75],a[136:139],v[96:99]
SA s85,s38,28672
buffer_load_dwordx4 v0, s[12:15], s85 offen offset:0 lds
M v[96:99],a[76:79],a[140:143],v[96:99]
SA s85,s38,34816
T a[104:105],v23,8192
T a[106:107],v23,10240
M v[96:99],a[80:83],a[144:147],v[96:99]
T a[108:109],v23,12288
T a[110:111],v23,14336
M v[96:99],a[84:87],a[148:151],v[96:99]
buffer_load_dwordx4 v0, s[12:15], s85 offen offset:1024 lds
M v[96:99],a[88:91],a[152:155],v[96:99]
SA s85,s38,40960
T a[112:113],v23,16384
T a[114:115],v23,18432
M v[96:99],a[92:95],a[156:159],v[96:99]
T a[116:117],v23,20480
T a[118:119],v23,22528
M v[100:103],a[92:95],a[188:191],0
buffer_load_dwordx4 v0, s[12:15], s85 offen offset:2048 lds
M v[100:103],a[88:91],a[184:187],v[100:103]
SA s85,s38,47104
T a[120:121],v23,24576
T a[122:123],v23,26624
M v[100:103],a[84:87],a[180:183],v[100:103]
T a[124:125],v23,28672
T a[126:127],v23,30720
M v[100:103],a[80:83],a[176:179],v[100:103]
buffer_load_dwordx4 v0, s[12:15], s85 offen offset:3072 lds
M v[100:103],a[76:79],a[172:175],v[100:103]
SA s38,s38,128
MF v80,v5,v80
MF v81,v5,v81
M v[100:103],a[72:75],a[168:171],v[100:103]
SA m0,s28,32768
MF v82,v5,v82
MF v83,v5,v83
M v[100:103],a[68:71],a[164:167],v[100:103]
SA s85,s38,0
buffer_load_dwordx4 v0, s[12:15], s85 offen offset:0 lds
M v[100:103],a[64:67],a[160:163],v[100:103]
s_waitcnt lgkmcnt(0)
MF v88,v5,v88
MF v89,v5,v89
M v[104:107],a[96:99],a[128:131],0
SA s85,s38,6144
T a[64:65],v24,0
T a[66:67],v24,2048
M v[104:107],a[100:103],a[132:135],v[104:107]
T a[68:69],v24,4096
T a[70:71],v24,6144
M v[104:107],a[104:107],a[136:139],v[104:107]
buffer_load_dwordx4 v0, s[12:15], s85 offen offset:1024 lds
M v[104:107],a[108:111],a[140:143],v[104:107]
SA s85,s38,12288
T a[72:73],v24,8192
T a[74:75],v24,10240
M v[104:107],a[112:115],a[144:147],v[104:107]
T a[76:77],v24,12288
T a[78:79],v24,14336
M v[104:107],a[116:119],a[148:151],v[104:107]
buffer_load_dwordx4 v0, s[12:15], s85 offen offset:2048 lds
M v[104:107],a[120:123],a[152:155],v[104:107]
SA s85,s38,18432
T a[80:81],v24,16384
T a[82:83],v24,18432
M v[104:107],a[124:127],a[156:159],v[104:107]
T a[84:85],v24,20480
T a[86:87],v24,22528
M v[108:111],a[124:127],a[188:191],0
buffer_load_dwordx4 v0, s[12:15], s85 offen offset:3072 lds
M v[108:111],a[120:123],a[184:187],v[108:111]
SA m0,s28,36864
T a[88:89],v24,24576
T a[90:91],v24,26624
M v[108:111],a[116:119],a[180:183],v[108:111]
SA s85,s38,28672
T a[92:93],v24,28672
T a[94:95],v24,30720
M v[108:111],a[112:115],a[176:179],v[108:111]
buffer_load_dwordx4 v0, s[12:15], s85 offen offset:0 lds
M v[108:111],a[108:111],a[172:175],v[108:111]
SA s85,s38,34816
MF v90,v5,v90
MF v91,v5,v91
M v[108:111],a[104:107],a[168:171],v[108:111]
C v80,v80,v81
C v81,v82,v83
M v[108:111],a[100:103],a[164:167],v[108:111]
buffer_load_dwordx4 v0, s[12:15], s85 offen offset:1024 lds
M v[108:111],a[96:99],a[160:163],v[108:111]
s_waitcnt lgkmcnt(0)
C v82,v88,v89
C v83,v90,v91
M v[112:115],a[64:67],a[128:131],0
SA s85,s38,40960
T a[96:97],v25,0
T a[98:99],v25,2048
M v[112:115],a[68:71],a[132:135],v[112:115]
T a[100:101],v25,4096
T a[102:103],v25,6144
M v[112:115],a[72:75],a[136:139],v[112:115]
buffer_store_dwordx4 v[80:83], v7, s[8:11], s29 offen offset:1024 sc1
M v[112:115],a[76:79],a[140:143],v[112:115]
s_nop 0
T a[104:105],v25,8192
T a[106:107],v25,10240
M v[112:115],a[80:83],a[144:147],v[112:115]
T a[108:109],v25,12288
T a[110:111],v25,14336
M v[112:115],a[84:87],a[148:151],v[112:115]
buffer_load_dwordx4 v0, s[12:15], s85 offen offset:2048 lds
M v[112:115],a[88:91],a[152:155],v[112:115]
SA s85,s38,47104
T a[112:113],v25,16384
T a[114:115],v25,18432
M v[112:115],a[92:95],a[156:159],v[112:115]
T a[116:117],v25,20480
T a[118:119],v25,22528
M v[116:119],a[92:95],a[188:191],0
buffer_load_dwordx4 v0, s[12:15], s85 offen offset:3072 lds
M v[116:119],a[88:91],a[184:187],v[116:119]
SA s38,s38,128
T a[120:121],v25,24576
T a[122:123],v25,26624
M v[116:119],a[84:87],a[180:183],v[116:119]
SA m0,s28,98304
T a[124:125],v25,28672
T a[126:127],v25,30720
M v[116:119],a[80:83],a[176:179],v[116:119]
SA s85,s38,0
buffer_load_dwordx4 v0, s[12:15], s85 offen offset:0 lds
M v[116:119],a[76:79],a[172:175],v[116:119]
SA s85,s38,6144
MF v84,v6,v84
MF v85,v6,v85
M v[116:119],a[72:75],a[168:171],v[116:119]
buffer_load_dwordx4 v0, s[12:15], s85 offen offset:1024 lds
M v[116:119],a[68:71],a[164:167],v[116:119]
s_waitcnt vmcnt(21) lgkmcnt(0)
MF v86,v6,v86
MF v87,v6,v87
M v[116:119],a[64:67],a[160:163],v[116:119]
s_barrier
M v[120:123],a[96:99],a[128:131],0
SA s85,s38,12288
T a[64:65],v18,0
T a[66:67],v18,2048
M v[120:123],a[100:103],a[132:135],v[120:123]
T a[68:69],v18,4096
T a[70:71],v18,6144
M v[120:123],a[104:107],a[136:139],v[120:123]
buffer_load_dwordx4 v0, s[12:15], s85 offen offset:2048 lds
M v[120:123],a[108:111],a[140:143],v[120:123]
SA s85,s38,18432
T a[72:73],v18,8192
T a[74:75],v18,10240
M v[120:123],a[112:115],a[144:147],v[120:123]
T a[76:77],v18,12288
T a[78:79],v18,14336
M v[120:123],a[116:119],a[148:151],v[120:123]
buffer_load_dwordx4 v0, s[12:15], s85 offen offset:3072 lds
M v[120:123],a[120:123],a[152:155],v[120:123]
s_nop 0
T a[80:81],v18,16384
T a[82:83],v18,18432
M v[120:123],a[124:127],a[156:159],v[120:123]
T a[84:85],v18,20480
T a[86:87],v18,22528
M v[124:127],a[124:127],a[188:191],0
MF v92,v6,v92
MF v93,v6,v93
M v[124:127],a[120:123],a[184:187],v[124:127]
T a[88:89],v18,24576
T a[90:91],v18,26624
M v[124:127],a[116:119],a[180:183],v[124:127]
T a[92:93],v18,28672
T a[94:95],v18,30720
M v[124:127],a[112:115],a[176:179],v[124:127]
MF v94,v6,v94
MF v95,v6,v95
M v[124:127],a[108:111],a[172:175],v[124:127]
C v84,v84,v85
C v85,v86,v87
M v[124:127],a[104:107],a[168:171],v[124:127]
C v86,v92,v93
C v87,v94,v95
M v[124:127],a[100:103],a[164:167],v[124:127]
s_waitcnt lgkmcnt(0)
buffer_store_dwordx4 v[84:87], v7, s[8:11], s30 offen offset:1024 sc1
M v[124:127],a[96:99],a[160:163],v[124:127]
SA s29,s33,2048
SA s30,s33,16384
MF v96,v5,v96
MF v97,v5,v97
MF v98,v5,v98
MF v99,v5,v99
MF v104,v5,v104
MF v105,v5,v105
MF v106,v5,v106
MF v107,v5,v107
C v96,v96,v97
C v97,v98,v99
C v98,v104,v105
C v99,v106,v107
buffer_store_dwordx4 v[96:99], v7, s[8:11], s29 offen offset:0 sc1
MF v100,v6,v100
MF v101,v6,v101
MF v102,v6,v102
MF v103,v6,v103
MF v108,v6,v108
MF v109,v6,v109
MF v110,v6,v110
MF v111,v6,v111
C v100,v100,v101
C v101,v102,v103
C v102,v108,v109
C v103,v110,v111
buffer_store_dwordx4 v[100:103], v7, s[8:11], s30 offen offset:0 sc1
M v[64:67],a[64:67],a[128:131],0
s_nop 0
T a[96:97],v19,0
T a[98:99],v19,2048
M v[64:67],a[68:71],a[132:135],v[64:67]
SA m0,s28,102400
T a[100:101],v19,4096
T a[102:103],v19,6144
M v[64:67],a[72:75],a[136:139],v[64:67]
SA s85,s38,28672
buffer_load_dwordx4 v0, s[12:15], s85 offen offset:0 lds
M v[64:67],a[76:79],a[140:143],v[64:67]
SA s85,s38,34816
T a[104:105],v19,8192
T a[106:107],v19,10240
M v[64:67],a[80:83],a[144:147],v[64:67]
T a[108:109],v19,12288
T a[110:111],v19,14336
M v[64:67],a[84:87],a[148:151],v[64:67]
buffer_load_dwordx4 v0, s[12:15], s85 offen offset:1024 lds
M v[64:67],a[88:91],a[152:155],v[64:67]
s_nop 0
T a[112:113],v19,16384
T a[114:115],v19,18432
M v[64:67],a[92:95],a[156:159],v[64:67]
SA s85,s38,40960
T a[116:117],v19,20480
T a[118:119],v19,22528
M v[68:71],a[92:95],a[188:191],0
buffer_load_dwordx4 v0, s[12:15], s85 offen offset:2048 lds
M v[68:71],a[88:91],a[184:187],v[68:71]
s_nop 0
T a[120:121],v19,24576
T a[122:123],v19,26624
M v[68:71],a[84:87],a[180:183],v[68:71]
T a[124:125],v19,28672
T a[126:127],v19,30720
M v[68:71],a[80:83],a[176:179],v[68:71]
SA s85,s38,47104
MF v112,v5,v112
MF v113,v5,v113
M v[68:71],a[76:79],a[172:175],v[68:71]
buffer_load_dwordx4 v0, s[12:15], s85 offen offset:3072 lds
M v[68:71],a[72:75],a[168:171],v[68:71]
SA s38,s38,128
MF v114,v5,v114
MF v115,v5,v115
M v[68:71],a[68:71],a[164:167],v[68:71]
SA m0,s28,65536
MF v120,v5,v120
MF v121,v5,v121
M v[68:71],a[64:67],a[160:163],v[68:71]
s_waitcnt lgkmcnt(0)
MF v122,v5,v122
MF v123,v5,v123
M v[72:75],a[96:99],a[128:131],0
SA s85,s38,0
T a[64:65],v20,0
T a[66:67],v20,2048
M v[72:75],a[100:103],a[132:135],v[72:75]
T a[68:69],v20,4096
T a[70:71],v20,6144
M v[72:75],a[104:107],a[136:139],v[72:75]
buffer_load_dwordx4 v0, s[12:15], s85 offen offset:0 lds
M v[72:75],a[108:111],a[140:143],v[72:75]
SA s85,s38,6144
T a[72:73],v20,8192
T a[74:75],v20,10240
M v[72:75],a[112:115],a[144:147],v[72:75]
T a[76:77],v20,12288
T a[78:79],v20,14336
M v[72:75],a[116:119],a[148:151],v[72:75]
buffer_load_dwordx4 v0, s[12:15], s85 offen offset:1024 lds
M v[72:75],a[120:123],a[152:155],v[72:75]
SA s85,s38,12288
T a[80:81],v20,16384
T a[82:83],v20,18432
M v[72:75],a[124:127],a[156:159],v[72:75]
T a[84:85],v20,20480
T a[86:87],v20,22528
M v[76:79],a[124:127],a[188:191],0
buffer_load_dwordx4 v0, s[12:15], s85 offen offset:2048 lds
M v[76:79],a[120:123],a[184:187],v[76:79]
SA s85,s38,18432
T a[88:89],v20,24576
T a[90:91],v20,26624
M v[76:79],a[116:119],a[180:183],v[76:79]
T a[92:93],v20,28672
T a[94:95],v20,30720
M v[76:79],a[112:115],a[176:179],v[76:79]
buffer_load_dwordx4 v0, s[12:15], s85 offen offset:3072 lds
M v[76:79],a[108:111],a[172:175],v[76:79]
SA m0,s28,69632
C v112,v112,v113
C v113,v114,v115
M v[76:79],a[104:107],a[168:171],v[76:79]
SA s85,s38,28672
C v114,v120,v121
C v115,v122,v123
M v[76:79],a[100:103],a[164:167],v[76:79]
buffer_store_dwordx4 v[112:115], v7, s[8:11], s29 offen offset:1024 sc1
M v[76:79],a[96:99],a[160:163],v[76:79]
s_waitcnt lgkmcnt(0)
MF v116,v6,v116
MF v117,v6,v117
M v[80:83],a[64:67],a[128:131],0
T a[96:97],v21,0
T a[98:99],v21,2048
M v[80:83],a[68:71],a[132:135],v[80:83]
T a[100:101],v21,4096
T a[102:103],v21,6144
M v[80:83],a[72:75],a[136:139],v[80:83]
buffer_load_dwordx4 v0, s[12:15], s85 offen offset:0 lds
M v[80:83],a[76:79],a[140:143],v[80:83]
SA s85,s38,34816
T a[104:105],v21,8192
T a[106:107],v21,10240
M v[80:83],a[80:83],a[144:147],v[80:83]
T a[108:109],v21,12288
T a[110:111],v21,14336
M v[80:83],a[84:87],a[148:151],v[80:83]
buffer_load_dwordx4 v0, s[12:15], s85 offen offset:1024 lds
M v[80:83],a[88:91],a[152:155],v[80:83]
SA s85,s38,40960
T a[112:113],v21,16384
T a[114:115],v21,18432
M v[80:83],a[92:95],a[156:159],v[80:83]
T a[116:117],v21,20480
T a[118:119],v21,22528
M v[84:87],a[92:95],a[188:191],0
buffer_load_dwordx4 v0, s[12:15], s85 offen offset:2048 lds
M v[84:87],a[88:91],a[184:187],v[84:87]
SA s85,s38,47104
T a[120:121],v21,24576
T a[122:123],v21,26624
M v[84:87],a[84:87],a[180:183],v[84:87]
T a[124:125],v21,28672
T a[126:127],v21,30720
M v[84:87],a[80:83],a[176:179],v[84:87]
buffer_load_dwordx4 v0, s[12:15], s85 offen offset:3072 lds
M v[84:87],a[76:79],a[172:175],v[84:87]
MF v118,v6,v118
MF v119,v6,v119
M v[84:87],a[72:75],a[168:171],v[84:87]
SA s38,s38,128
MF v124,v6,v124
MF v125,v6,v125
M v[84:87],a[68:71],a[164:167],v[84:87]
s_waitcnt vmcnt(29) lgkmcnt(0)
MF v126,v6,v126
MF v127,v6,v127
M v[84:87],a[64:67],a[160:163],v[84:87]
s_barrier
M v[88:91],a[96:99],a[128:131],0
s_nop 0
T a[64:65],v40,0
T a[66:67],v40,2048
M v[88:91],a[100:103],a[132:135],v[88:91]
T a[68:69],v40,4096
T a[70:71],v40,6144
M v[88:91],a[104:107],a[136:139],v[88:91]
C v116,v116,v117
C v117,v118,v119
M v[88:91],a[108:111],a[140:143],v[88:91]
T a[72:73],v40,8192
T a[74:75],v40,10240
M v[88:91],a[112:115],a[144:147],v[88:91]
T a[76:77],v40,12288
T a[78:79],v40,14336
M v[88:91],a[116:119],a[148:151],v[88:91]
C v118,v124,v125
C v119,v126,v127
M v[88:91],a[120:123],a[152:155],v[88:91]
T a[80:81],v40,16384
T a[82:83],v40,18432
M v[88:91],a[124:127],a[156:159],v[88:91]
T a[84:85],v40,20480
T a[86:87],v40,22528
M v[92:95],a[124:127],a[188:191],0
buffer_store_dwordx4 v[116:119], v7, s[8:11], s30 offen offset:1024 sc1
M v[92:95],a[120:123],a[184:187],v[92:95]
SA s29,s33,4096
T a[88:89],v40,24576
T a[90:91],v40,26624
M v[92:95],a[116:119],a[180:183],v[92:95]
SA s30,s33,18432
T a[92:93],v40,28672
T a[94:95],v40,30720
M v[92:95],a[112:115],a[176:179],v[92:95]
MF v64,v5,v64
MF v65,v5,v65
M v[92:95],a[108:111],a[172:175],v[92:95]
MF v66,v5,v66
MF v67,v5,v67
M v[92:95],a[104:107],a[168:171],v[92:95]
MF v72,v5,v72
MF v73,v5,v73
M v[92:95],a[100:103],a[164:167],v[92:95]
s_waitcnt lgkmcnt(0)
MF v74,v5,v74
MF v75,v5,v75
M v[92:95],a[96:99],a[160:163],v[92:95]
C v64,v64,v65
C v65,v66,v67
C v66,v72,v73
C v67,v74,v75
buffer_store_dwordx4 v[64:67], v7, s[8:11], s29 offen offset:0 sc1
MF v68,v6,v68
MF v69,v6,v69
MF v70,v6,v70
MF v71,v6,v71
MF v76,v6,v76
MF v77,v6,v77
MF v78,v6,v78
MF v79,v6,v79
C v68,v68,v69
C v69,v70,v71
C v70,v76,v77
C v71,v78,v79
buffer_store_dwordx4 v[68:71], v7, s[8:11], s30 offen offset:0 sc1
M v[96:99],a[64:67],a[128:131],0
s_nop 0
T a[96:97],v41,0
T a[98:99],v41,2048
M v[96:99],a[68:71],a[132:135],v[96:99]
T a[100:101],v41,4096
T a[102:103],v41,6144
M v[96:99],a[72:75],a[136:139],v[96:99]
MF v80,v5,v80
MF v81,v5,v81
M v[96:99],a[76:79],a[140:143],v[96:99]
T a[104:105],v41,8192
T a[106:107],v41,10240
M v[96:99],a[80:83],a[144:147],v[96:99]
T a[108:109],v41,12288
T a[110:111],v41,14336
M v[96:99],a[84:87],a[148:151],v[96:99]
MF v82,v5,v82
MF v83,v5,v83
M v[96:99],a[88:91],a[152:155],v[96:99]
T a[112:113],v41,16384
T a[114:115],v41,18432
M v[96:99],a[92:95],a[156:159],v[96:99]
T a[116:117],v41,20480
T a[118:119],v41,22528
M v[100:103],a[92:95],a[188:191],0
MF v88,v5,v88
MF v89,v5,v89
M v[100:103],a[88:91],a[184:187],v[100:103]
T a[120:121],v41,24576
T a[122:123],v41,26624
M v[100:103],a[84:87],a[180:183],v[100:103]
T a[124:125],v41,28672
T a[126:127],v41,30720
M v[100:103],a[80:83],a[176:179],v[100:103]
MF v90,v5,v90
MF v91,v5,v91
M v[100:103],a[76:79],a[172:175],v[100:103]
C v80,v80,v81
C v81,v82,v83
M v[100:103],a[72:75],a[168:171],v[100:103]
C v82,v88,v89
C v83,v90,v91
M v[100:103],a[68:71],a[164:167],v[100:103]
buffer_store_dwordx4 v[80:83], v7, s[8:11], s29 offen offset:1024 sc1
M v[100:103],a[64:67],a[160:163],v[100:103]
s_waitcnt lgkmcnt(0)
MF v84,v6,v84
MF v85,v6,v85
M v[104:107],a[96:99],a[128:131],0
T a[64:65],v42,0
T a[66:67],v42,2048
M v[104:107],a[100:103],a[132:135],v[104:107]
T a[68:69],v42,4096
T a[70:71],v42,6144
M v[104:107],a[104:107],a[136:139],v[104:107]
MF v86,v6,v86
MF v87,v6,v87
M v[104:107],a[108:111],a[140:143],v[104:107]
T a[72:73],v42,8192
T a[74:75],v42,10240
M v[104:107],a[112:115],a[144:147],v[104:107]
T a[76:77],v42,12288
T a[78:79],v42,14336
M v[104:107],a[116:119],a[148:151],v[104:107]
MF v92,v6,v92
MF v93,v6,v93
M v[104:107],a[120:123],a[152:155],v[104:107]
T a[80:81],v42,16384
T a[82:83],v42,18432
M v[104:107],a[124:127],a[156:159],v[104:107]
T a[84:85],v42,20480
T a[86:87],v42,22528
M v[108:111],a[124:127],a[188:191],0
MF v94,v6,v94
MF v95,v6,v95
M v[108:111],a[120:123],a[184:187],v[108:111]
T a[88:89],v42,24576
T a[90:91],v42,26624
M v[108:111],a[116:119],a[180:183],v[108:111]
T a[92:93],v42,28672
T a[94:95],v42,30720
M v[108:111],a[112:115],a[176:179],v[108:111]
C v84,v84,v85
C v85,v86,v87
M v[108:111],a[108:111],a[172:175],v[108:111]
C v86,v92,v93
C v87,v94,v95
M v[108:111],a[104:107],a[168:171],v[108:111]
buffer_store_dwordx4 v[84:87], v7, s[8:11], s30 offen offset:1024 sc1
M v[108:111],a[100:103],a[164:167],v[108:111]
SA s29,s33,6144
M v[108:111],a[96:99],a[160:163],v[108:111]
s_waitcnt lgkmcnt(0)
M v[112:115],a[64:67],a[128:131],0
SA s30,s33,20480
T a[96:97],v43,0
T a[98:99],v43,2048
M v[112:115],a[68:71],a[132:135],v[112:115]
T a[100:101],v43,4096
T a[102:103],v43,6144
M v[112:115],a[72:75],a[136:139],v[112:115]
MF v96,v5,v96
MF v97,v5,v97
M v[112:115],a[76:79],a[140:143],v[112:115]
T a[104:105],v43,8192
T a[106:107],v43,10240
M v[112:115],a[80:83],a[144:147],v[112:115]
T a[108:109],v43,12288
T a[110:111],v43,14336
M v[112:115],a[84:87],a[148:151],v[112:115]
MF v98,v5,v98
MF v99,v5,v99
M v[112:115],a[88:91],a[152:155],v[112:115]
T a[112:113],v43,16384
T a[114:115],v43,18432
M v[112:115],a[92:95],a[156:159],v[112:115]
T a[116:117],v43,20480
T a[118:119],v43,22528
M v[116:119],a[92:95],a[188:191],0
MF v104,v5,v104
MF v105,v5,v105
M v[116:119],a[88:91],a[184:187],v[116:119]
T a[120:121],v43,24576
T a[122:123],v43,26624
M v[116:119],a[84:87],a[180:183],v[116:119]
T a[124:125],v43,28672
T a[126:127],v43,30720
M v[116:119],a[80:83],a[176:179],v[116:119]
MF v106,v5,v106
MF v107,v5,v107
M v[116:119],a[76:79],a[172:175],v[116:119]
C v96,v96,v97
C v97,v98,v99
M v[116:119],a[72:75],a[168:171],v[116:119]
C v98,v104,v105
C v99,v106,v107
M v[116:119],a[68:71],a[164:167],v[116:119]
s_waitcnt vmcnt(25) lgkmcnt(0)
buffer_store_dwordx4 v[96:99], v7, s[8:11], s29 offen offset:0 sc1
M v[116:119],a[64:67],a[160:163],v[116:119]
s_barrier
M v[120:123],a[96:99],a[128:131],0
s_nop 0
T a[64:65],v18,32768
T a[66:67],v18,34816
M v[120:123],a[100:103],a[132:135],v[120:123]
T a[68:69],v18,36864
T a[70:71],v18,38912
M v[120:123],a[104:107],a[136:139],v[120:123]
MF v100,v6,v100
MF v101,v6,v101
M v[120:123],a[108:111],a[140:143],v[120:123]
T a[72:73],v18,40960
T a[74:75],v18,43008
M v[120:123],a[112:115],a[144:147],v[120:123]
T a[76:77],v18,45056
T a[78:79],v18,47104
M v[120:123],a[116:119],a[148:151],v[120:123]
MF v102,v6,v102
MF v103,v6,v103
M v[120:123],a[120:123],a[152:155],v[120:123]
T a[80:81],v18,49152
T a[82:83],v18,51200
M v[120:123],a[124:127],a[156:159],v[120:123]
T a[84:85],v18,53248
T a[86:87],v18,55296
M v[124:127],a[124:127],a[188:191],0
MF v108,v6,v108
MF v109,v6,v109
M v[124:127],a[120:123],a[184:187],v[124:127]
T a[88:89],v18,57344
T a[90:91],v18,59392
M v[124:127],a[116:119],a[180:183],v[124:127]
T a[92:93],v18,61440
T a[94:95],v18,63488
M v[124:127],a[112:115],a[176:179],v[124:127]
MF v110,v6,v110
MF v111,v6,v111
M v[124:127],a[108:111],a[172:175],v[124:127]
C v100,v100,v101
C v101,v102,v103
M v[124:127],a[104:107],a[168:171],v[124:127]
C v102,v108,v109
C v103,v110,v111
M v[124:127],a[100:103],a[164:167],v[124:127]
s_waitcnt lgkmcnt(0)
buffer_store_dwordx4 v[100:103], v7, s[8:11], s30 offen offset:0 sc1
M v[124:127],a[96:99],a[160:163],v[124:127]
M v[64:67],a[64:67],a[128:131],0
s_nop 0
T a[96:97],v19,32768
T a[98:99],v19,34816
M v[64:67],a[68:71],a[132:135],v[64:67]
T a[100:101],v19,36864
T a[102:103],v19,38912
M v[64:67],a[72:75],a[136:139],v[64:67]
v_lshrrev_b32 v32, 4, v7
MF v112,v5,v112
M v[64:67],a[76:79],a[140:143],v[64:67]
s_lshr_b32 s74, s41, 3
T a[104:105],v19,40960
T a[106:107],v19,43008
M v[64:67],a[80:83],a[144:147],v[64:67]
s_lshl_b32 s64, s42, 1
T a[108:109],v19,45056
T a[110:111],v19,47104
M v[64:67],a[84:87],a[148:151],v[64:67]
SA s46,s64,s74
MF v113,v5,v113
MF v114,v5,v114
M v[64:67],a[88:91],a[152:155],v[64:67]
s_mul_i32 s46, s46, 4352
T a[112:113],v19,49152
T a[114:115],v19,51200
M v[64:67],a[92:95],a[156:159],v[64:67]
s_and_b32 s72, s41, 7
T a[116:117],v19,53248
T a[118:119],v19,55296
M v[68:71],a[92:95],a[188:191],0
s_lshl_b32 s65, s72, 7
MF v115,v5,v115
MF v120,v5,v120
M v[68:71],a[88:91],a[184:187],v[68:71]
SA s46,s46,s65
T a[120:121],v19,57344
T a[122:123],v19,59392
M v[68:71],a[84:87],a[180:183],v[68:71]
SA s46,s46,104992768
T a[124:125],v19,61440
T a[126:127],v19,63488
M v[68:71],a[80:83],a[176:179],v[68:71]
v_and_b32 v33, 31, v32
MF v121,v5,v121
M v[68:71],a[76:79],a[172:175],v[68:71]
MF v122,v5,v122
MF v123,v5,v123
M v[68:71],a[72:75],a[168:171],v[68:71]
C v112,v112,v113
C v113,v114,v115
M v[68:71],a[68:71],a[164:167],v[68:71]
C v114,v120,v121
C v115,v122,v123
M v[68:71],a[64:67],a[160:163],v[68:71]
s_waitcnt lgkmcnt(0)
buffer_store_dwordx4 v[112:115], v7, s[8:11], s29 offen offset:1024 sc1
M v[72:75],a[96:99],a[128:131],0
s_nop 0
T a[64:65],v20,32768
T a[66:67],v20,34816
M v[72:75],a[100:103],a[132:135],v[72:75]
T a[68:69],v20,36864
T a[70:71],v20,38912
M v[72:75],a[104:107],a[136:139],v[72:75]
MF v116,v6,v116
MF v117,v6,v117
M v[72:75],a[108:111],a[140:143],v[72:75]
T a[72:73],v20,40960
T a[74:75],v20,43008
M v[72:75],a[112:115],a[144:147],v[72:75]
T a[76:77],v20,45056
T a[78:79],v20,47104
M v[72:75],a[116:119],a[148:151],v[72:75]
MF v118,v6,v118
MF v119,v6,v119
M v[72:75],a[120:123],a[152:155],v[72:75]
T a[80:81],v20,49152
T a[82:83],v20,51200
M v[72:75],a[124:127],a[156:159],v[72:75]
T a[84:85],v20,53248
T a[86:87],v20,55296
M v[76:79],a[124:127],a[188:191],0
MF v124,v6,v124
MF v125,v6,v125
M v[76:79],a[120:123],a[184:187],v[76:79]
T a[88:89],v20,57344
T a[90:91],v20,59392
M v[76:79],a[116:119],a[180:183],v[76:79]
T a[92:93],v20,61440
T a[94:95],v20,63488
M v[76:79],a[112:115],a[176:179],v[76:79]
MF v126,v6,v126
MF v127,v6,v127
M v[76:79],a[108:111],a[172:175],v[76:79]
C v116,v116,v117
C v117,v118,v119
M v[76:79],a[104:107],a[168:171],v[76:79]
C v118,v124,v125
C v119,v126,v127
M v[76:79],a[100:103],a[164:167],v[76:79]
buffer_store_dwordx4 v[116:119], v7, s[8:11], s30 offen offset:1024 sc1
M v[76:79],a[96:99],a[160:163],v[76:79]
s_waitcnt lgkmcnt(0)
v_lshlrev_b32 v33, 2, v33
M v[80:83],a[64:67],a[128:131],0
SA s29,s33,8192
T a[96:97],v21,32768
T a[98:99],v21,34816
M v[80:83],a[68:71],a[132:135],v[80:83]
SA s30,s33,22528
T a[100:101],v21,36864
T a[102:103],v21,38912
M v[80:83],a[72:75],a[136:139],v[80:83]
s_lshl_b32 s65, s41, 7
MF v64,v5,v64
MF v65,v5,v65
M v[80:83],a[76:79],a[140:143],v[80:83]
SA s65,s65,104890368
T a[104:105],v21,40960
T a[106:107],v21,43008
M v[80:83],a[80:83],a[144:147],v[80:83]
T a[108:109],v21,45056
T a[110:111],v21,47104
M v[80:83],a[84:87],a[148:151],v[80:83]
buffer_load_dword v31, v33, s[8:11], s65 offen sc1
M v[80:83],a[88:91],a[152:155],v[80:83]
s_nop 0
T a[112:113],v21,49152
T a[114:115],v21,51200
M v[80:83],a[92:95],a[156:159],v[80:83]
T a[116:117],v21,53248
T a[118:119],v21,55296
M v[84:87],a[92:95],a[188:191],0
v_bfe_u32 v34, v32, 4, 1
v_lshlrev_b32 v34, 1, v34
M v[84:87],a[88:91],a[184:187],v[84:87]
T a[120:121],v21,57344
T a[122:123],v21,59392
M v[84:87],a[84:87],a[180:183],v[84:87]
T a[124:125],v21,61440
T a[126:127],v21,63488
M v[84:87],a[80:83],a[176:179],v[84:87]
v_lshrrev_b32 v35, 5, v32
v_add_u32 v34, v34, v35
M v[84:87],a[76:79],a[172:175],v[84:87]
s_mov_b32 s52, s96
MF v66,v5,v66
MF v67,v5,v67
M v[84:87],a[72:75],a[168:171],v[84:87]
s_and_b32 s53, s97, 0xffff
MF v72,v5,v72
MF v73,v5,v73
M v[84:87],a[68:71],a[164:167],v[84:87]
s_waitcnt vmcnt(19) lgkmcnt(0)
MF v74,v5,v74
MF v75,v5,v75
M v[84:87],a[64:67],a[160:163],v[84:87]
s_barrier
M v[88:91],a[96:99],a[128:131],0
s_mov_b32 s54, 1835008
T a[64:65],v22,32768
T a[66:67],v22,34816
M v[88:91],a[100:103],a[132:135],v[88:91]
s_mov_b32 s55, 0x20000
T a[68:69],v22,36864
T a[70:71],v22,38912
M v[88:91],a[104:107],a[136:139],v[88:91]
s_mul_i32 s77, s42, 1835008
C v64,v64,v65
C v65,v66,v67
M v[88:91],a[108:111],a[140:143],v[88:91]
s_mul_i32 s78, s72, 14336
T a[72:73],v22,40960
T a[74:75],v22,43008
M v[88:91],a[112:115],a[144:147],v[88:91]
SA s77,s77,s78
T a[76:77],v22,45056
T a[78:79],v22,47104
M v[88:91],a[116:119],a[148:151],v[88:91]
SA s77,s77,67108864
C v66,v72,v73
C v67,v74,v75
M v[88:91],a[120:123],a[152:155],v[88:91]
s_lshl_b32 s79, s74, 1
T a[80:81],v22,49152
T a[82:83],v22,51200
M v[88:91],a[124:127],a[156:159],v[88:91]
SA s79,s79,s20
T a[84:85],v22,53248
T a[86:87],v22,55296
M v[92:95],a[124:127],a[188:191],0
s_lshl_b32 s71, s74, 1
buffer_store_dwordx4 v[64:67], v7, s[8:11], s29 offen offset:0 sc1
M v[92:95],a[120:123],a[184:187],v[92:95]
SA s71,s71,1
T a[88:89],v22,57344
T a[90:91],v22,59392
M v[92:95],a[116:119],a[180:183],v[92:95]
s_sub_u32 s71, s71, s20
T a[92:93],v22,61440
T a[94:95],v22,63488
M v[92:95],a[112:115],a[176:179],v[92:95]
s_and_b32 s71, s71, 536870912
MF v68,v6,v68
MF v69,v6,v69
M v[92:95],a[108:111],a[172:175],v[92:95]
s_sub_u32 s64, 15, s64
MF v70,v6,v70
MF v71,v6,v71
M v[92:95],a[104:107],a[168:171],v[92:95]
s_sub_u32 s78, s64, 1
MF v76,v6,v76
MF v77,v6,v77
M v[92:95],a[100:103],a[164:167],v[92:95]
s_waitcnt lgkmcnt(0)
MF v78,v6,v78
MF v79,v6,v79
M v[92:95],a[96:99],a[160:163],v[92:95]
s_mul_i32 s78, s78, 1835008
SA s78,s78,s77
s_lshl_b32 s65, s79, 10
SA s78,s78,s65
SA s78,s78,s71
s_lshl_b32 s79, s79, 6
s_or_b32 s79, s79, s71
s_mul_i32 s67, s74, -2
s_lshl_b32 s74, s74, 3
SA s74,s74,s20
s_lshl_b32 s75, s74, 6
SA s76,s75,256
SA s67,s67,3
s_sub_u32 s67, s67, s20
s_and_b32 s67, s67, 536870912
s_or_b32 s76, s76, s67
v_or_b32 v27, s67, v7
v_add_u32 v27, 4096, v27
s_lshl_b32 s65, s74, 10
SA s77,s77,s65
s_lshl_b32 s64, s64, 7
s_lshr_b32 s73, s72, 1
s_sub_u32 s65, 7, s73
s_bitcmp1_b32 s72, 0
s_cselect_b32 s73, s65, s73
s_lshl_b32 s73, s73, 4
s_lshl_b32 s65, s42, 7
SA s73,s73,s65
v_and_b32 v37, 15, v32
v_add_u32 v37, s73, v37
v_add_u32 v29, s64, v37
s_mov_b32 s64, 104857664
v_mul_u32_u24 v38, 896, v37
v_lshl_add_u32 v38, v34, 4, v38
v_lshrrev_b32 v35, 4, v37
v_lshlrev_b32 v35, 5, v35
v_and_b32 v36, 15, v37
v_add_lshl_u32 v35, v35, v36, 2
buffer_load_dword v39, v35, s[8:11], s64 offen sc1
C v68,v68,v69
C v69,v70,v71
C v70,v76,v77
C v71,v78,v79
buffer_store_dwordx4 v[68:71], v7, s[8:11], s30 offen offset:0 sc1
buffer_load_dwordx4 v[48:51], v38, s[56:59], s75 offen
buffer_load_dwordx4 v[52:55], v38, s[56:59], s76 offen
v_mul_u32_u24 v28, 896, v29
v_lshl_add_u32 v28, v34, 4, v28
v_lshrrev_b32 v35, 4, v29
v_lshlrev_b32 v35, 5, v35
v_and_b32 v36, 15, v29
v_add_lshl_u32 v35, v35, v36, 2
buffer_load_dword v26, v35, s[8:11], s64 offen sc1
buffer_load_dwordx4 v[44:47], v28, s[56:59], s79 offen
M v[96:99],a[64:67],a[128:131],0
s_nop 0
T a[96:97],v23,32768
T a[98:99],v23,34816
M v[96:99],a[68:71],a[132:135],v[96:99]
T a[100:101],v23,36864
T a[102:103],v23,38912
M v[96:99],a[72:75],a[136:139],v[96:99]
MF v80,v5,v80
MF v81,v5,v81
M v[96:99],a[76:79],a[140:143],v[96:99]
T a[104:105],v23,40960
T a[106:107],v23,43008
M v[96:99],a[80:83],a[144:147],v[96:99]
T a[108:109],v23,45056
T a[110:111],v23,47104
M v[96:99],a[84:87],a[148:151],v[96:99]
MF v82,v5,v82
MF v83,v5,v83
M v[96:99],a[88:91],a[152:155],v[96:99]
T a[112:113],v23,49152
T a[114:115],v23,51200
M v[96:99],a[92:95],a[156:159],v[96:99]
T a[116:117],v23,53248
T a[118:119],v23,55296
M v[100:103],a[92:95],a[188:191],0
MF v88,v5,v88
MF v89,v5,v89
M v[100:103],a[88:91],a[184:187],v[100:103]
T a[120:121],v23,57344
T a[122:123],v23,59392
M v[100:103],a[84:87],a[180:183],v[100:103]
T a[124:125],v23,61440
T a[126:127],v23,63488
M v[100:103],a[80:83],a[176:179],v[100:103]
MF v90,v5,v90
MF v91,v5,v91
M v[100:103],a[76:79],a[172:175],v[100:103]
C v80,v80,v81
C v81,v82,v83
M v[100:103],a[72:75],a[168:171],v[100:103]
C v82,v88,v89
C v83,v90,v91
M v[100:103],a[68:71],a[164:167],v[100:103]
buffer_store_dwordx4 v[80:83], v7, s[8:11], s29 offen offset:1024 sc1
M v[100:103],a[64:67],a[160:163],v[100:103]
s_waitcnt lgkmcnt(0)
MF v84,v6,v84
MF v85,v6,v85
M v[104:107],a[96:99],a[128:131],0
T a[64:65],v24,32768
T a[66:67],v24,34816
M v[104:107],a[100:103],a[132:135],v[104:107]
T a[68:69],v24,36864
T a[70:71],v24,38912
M v[104:107],a[104:107],a[136:139],v[104:107]
MF v86,v6,v86
MF v87,v6,v87
M v[104:107],a[108:111],a[140:143],v[104:107]
T a[72:73],v24,40960
T a[74:75],v24,43008
M v[104:107],a[112:115],a[144:147],v[104:107]
T a[76:77],v24,45056
T a[78:79],v24,47104
M v[104:107],a[116:119],a[148:151],v[104:107]
MF v92,v6,v92
MF v93,v6,v93
M v[104:107],a[120:123],a[152:155],v[104:107]
T a[80:81],v24,49152
T a[82:83],v24,51200
M v[104:107],a[124:127],a[156:159],v[104:107]
T a[84:85],v24,53248
T a[86:87],v24,55296
M v[108:111],a[124:127],a[188:191],0
MF v94,v6,v94
MF v95,v6,v95
M v[108:111],a[120:123],a[184:187],v[108:111]
T a[88:89],v24,57344
T a[90:91],v24,59392
M v[108:111],a[116:119],a[180:183],v[108:111]
T a[92:93],v24,61440
T a[94:95],v24,63488
M v[108:111],a[112:115],a[176:179],v[108:111]
C v84,v84,v85
C v85,v86,v87
M v[108:111],a[108:111],a[172:175],v[108:111]
C v86,v92,v93
C v87,v94,v95
M v[108:111],a[104:107],a[168:171],v[108:111]
buffer_store_dwordx4 v[84:87], v7, s[8:11], s30 offen offset:1024 sc1
M v[108:111],a[100:103],a[164:167],v[108:111]
SA s29,s33,10240
M v[108:111],a[96:99],a[160:163],v[108:111]
s_waitcnt lgkmcnt(0)
M v[112:115],a[64:67],a[128:131],0
SA s30,s33,24576
T a[96:97],v25,32768
T a[98:99],v25,34816
M v[112:115],a[68:71],a[132:135],v[112:115]
T a[100:101],v25,36864
T a[102:103],v25,38912
M v[112:115],a[72:75],a[136:139],v[112:115]
MF v96,v5,v96
MF v97,v5,v97
M v[112:115],a[76:79],a[140:143],v[112:115]
T a[104:105],v25,40960
T a[106:107],v25,43008
M v[112:115],a[80:83],a[144:147],v[112:115]
T a[108:109],v25,45056
T a[110:111],v25,47104
M v[112:115],a[84:87],a[148:151],v[112:115]
MF v98,v5,v98
MF v99,v5,v99
M v[112:115],a[88:91],a[152:155],v[112:115]
T a[112:113],v25,49152
T a[114:115],v25,51200
M v[112:115],a[92:95],a[156:159],v[112:115]
T a[116:117],v25,53248
T a[118:119],v25,55296
M v[116:119],a[92:95],a[188:191],0
s_mov_b32 s84, s45
MF v104,v5,v104
MF v105,v5,v105
M v[116:119],a[88:91],a[184:187],v[116:119]
T a[120:121],v25,57344
T a[122:123],v25,59392
M v[116:119],a[84:87],a[180:183],v[116:119]
T a[124:125],v25,61440
T a[126:127],v25,63488
M v[116:119],a[80:83],a[176:179],v[116:119]
MF v106,v5,v106
MF v107,v5,v107
M v[116:119],a[76:79],a[172:175],v[116:119]
C v96,v96,v97
C v97,v98,v99
M v[116:119],a[72:75],a[168:171],v[116:119]
C v98,v104,v105
C v99,v106,v107
M v[116:119],a[68:71],a[164:167],v[116:119]
s_waitcnt vmcnt(19) lgkmcnt(0)
buffer_store_dwordx4 v[96:99], v7, s[8:11], s29 offen offset:0 sc1
M v[116:119],a[64:67],a[160:163],v[116:119]
s_barrier
M v[120:123],a[96:99],a[128:131],0
s_nop 0
T a[64:65],v22,0
T a[66:67],v22,2048
M v[120:123],a[100:103],a[132:135],v[120:123]
T a[68:69],v22,4096
T a[70:71],v22,6144
M v[120:123],a[104:107],a[136:139],v[120:123]
MF v100,v6,v100
MF v101,v6,v101
M v[120:123],a[108:111],a[140:143],v[120:123]
T a[72:73],v22,8192
T a[74:75],v22,10240
M v[120:123],a[112:115],a[144:147],v[120:123]
s_waitcnt vmcnt(11)
T a[76:77],v22,12288
T a[78:79],v22,14336
M v[120:123],a[116:119],a[148:151],v[120:123]
buffer_store_dword v15, v17, s[8:11], s84 offen sc1
M v[120:123],a[120:123],a[152:155],v[120:123]
s_nop 0
T a[80:81],v22,16384
T a[82:83],v22,18432
M v[120:123],a[124:127],a[156:159],v[120:123]
T a[84:85],v22,20480
T a[86:87],v22,22528
M v[124:127],a[124:127],a[188:191],0
MF v102,v6,v102
MF v103,v6,v103
M v[124:127],a[120:123],a[184:187],v[124:127]
T a[88:89],v22,24576
T a[90:91],v22,26624
M v[124:127],a[116:119],a[180:183],v[124:127]
T a[92:93],v22,28672
T a[94:95],v22,30720
M v[124:127],a[112:115],a[176:179],v[124:127]
MF v108,v6,v108
MF v109,v6,v109
M v[124:127],a[108:111],a[172:175],v[124:127]
MF v110,v6,v110
MF v111,v6,v111
M v[124:127],a[104:107],a[168:171],v[124:127]
C v100,v100,v101
C v101,v102,v103
M v[124:127],a[100:103],a[164:167],v[124:127]
s_waitcnt lgkmcnt(0)
C v102,v108,v109
C v103,v110,v111
M v[124:127],a[96:99],a[160:163],v[124:127]
buffer_store_dwordx4 v[100:103], v7, s[8:11], s30 offen offset:0 sc1
M v[64:67],a[64:67],a[128:131],0
s_nop 0
T a[96:97],v23,0
T a[98:99],v23,2048
M v[64:67],a[68:71],a[132:135],v[64:67]
T a[100:101],v23,4096
T a[102:103],v23,6144
M v[64:67],a[72:75],a[136:139],v[64:67]
MF v112,v5,v112
MF v113,v5,v113
M v[64:67],a[76:79],a[140:143],v[64:67]
T a[104:105],v23,8192
T a[106:107],v23,10240
M v[64:67],a[80:83],a[144:147],v[64:67]
T a[108:109],v23,12288
T a[110:111],v23,14336
M v[64:67],a[84:87],a[148:151],v[64:67]
MF v114,v5,v114
MF v115,v5,v115
M v[64:67],a[88:91],a[152:155],v[64:67]
T a[112:113],v23,16384
T a[114:115],v23,18432
M v[64:67],a[92:95],a[156:159],v[64:67]
T a[116:117],v23,20480
T a[118:119],v23,22528
M v[68:71],a[92:95],a[188:191],0
MF v120,v5,v120
MF v121,v5,v121
M v[68:71],a[88:91],a[184:187],v[68:71]
T a[120:121],v23,24576
T a[122:123],v23,26624
M v[68:71],a[84:87],a[180:183],v[68:71]
T a[124:125],v23,28672
T a[126:127],v23,30720
M v[68:71],a[80:83],a[176:179],v[68:71]
MF v122,v5,v122
MF v123,v5,v123
M v[68:71],a[76:79],a[172:175],v[68:71]
C v112,v112,v113
C v113,v114,v115
M v[68:71],a[72:75],a[168:171],v[68:71]
C v114,v120,v121
C v115,v122,v123
M v[68:71],a[68:71],a[164:167],v[68:71]
buffer_store_dwordx4 v[112:115], v7, s[8:11], s29 offen offset:1024 sc1
M v[68:71],a[64:67],a[160:163],v[68:71]
s_waitcnt lgkmcnt(0)
MF v116,v6,v116
MF v117,v6,v117
M v[72:75],a[96:99],a[128:131],0
T a[64:65],v24,0
T a[66:67],v24,2048
M v[72:75],a[100:103],a[132:135],v[72:75]
T a[68:69],v24,4096
T a[70:71],v24,6144
M v[72:75],a[104:107],a[136:139],v[72:75]
MF v118,v6,v118
MF v119,v6,v119
M v[72:75],a[108:111],a[140:143],v[72:75]
T a[72:73],v24,8192
T a[74:75],v24,10240
M v[72:75],a[112:115],a[144:147],v[72:75]
T a[76:77],v24,12288
T a[78:79],v24,14336
M v[72:75],a[116:119],a[148:151],v[72:75]
MF v124,v6,v124
MF v125,v6,v125
M v[72:75],a[120:123],a[152:155],v[72:75]
T a[80:81],v24,16384
T a[82:83],v24,18432
M v[72:75],a[124:127],a[156:159],v[72:75]
T a[84:85],v24,20480
T a[86:87],v24,22528
M v[76:79],a[124:127],a[188:191],0
MF v126,v6,v126
MF v127,v6,v127
M v[76:79],a[120:123],a[184:187],v[76:79]
T a[88:89],v24,24576
T a[90:91],v24,26624
M v[76:79],a[116:119],a[180:183],v[76:79]
T a[92:93],v24,28672
T a[94:95],v24,30720
M v[76:79],a[112:115],a[176:179],v[76:79]
C v116,v116,v117
C v117,v118,v119
M v[76:79],a[108:111],a[172:175],v[76:79]
C v118,v124,v125
C v119,v126,v127
M v[76:79],a[104:107],a[168:171],v[76:79]
buffer_store_dwordx4 v[116:119], v7, s[8:11], s30 offen offset:1024 sc1
M v[76:79],a[100:103],a[164:167],v[76:79]
SA s29,s33,12288
M v[76:79],a[96:99],a[160:163],v[76:79]
s_waitcnt lgkmcnt(0)
M v[80:83],a[64:67],a[128:131],0
SA s30,s33,26624
T a[96:97],v25,0
T a[98:99],v25,2048
M v[80:83],a[68:71],a[132:135],v[80:83]
T a[100:101],v25,4096
T a[102:103],v25,6144
M v[80:83],a[72:75],a[136:139],v[80:83]
MF v64,v5,v64
MF v65,v5,v65
M v[80:83],a[76:79],a[140:143],v[80:83]
T a[104:105],v25,8192
T a[106:107],v25,10240
M v[80:83],a[80:83],a[144:147],v[80:83]
T a[108:109],v25,12288
T a[110:111],v25,14336
M v[80:83],a[84:87],a[148:151],v[80:83]
MF v66,v5,v66
MF v67,v5,v67
M v[80:83],a[88:91],a[152:155],v[80:83]
T a[112:113],v25,16384
T a[114:115],v25,18432
M v[80:83],a[92:95],a[156:159],v[80:83]
T a[116:117],v25,20480
T a[118:119],v25,22528
M v[84:87],a[92:95],a[188:191],0
MF v72,v5,v72
MF v73,v5,v73
M v[84:87],a[88:91],a[184:187],v[84:87]
T a[120:121],v25,24576
T a[122:123],v25,26624
M v[84:87],a[84:87],a[180:183],v[84:87]
T a[124:125],v25,28672
T a[126:127],v25,30720
M v[84:87],a[80:83],a[176:179],v[84:87]
MF v74,v5,v74
MF v75,v5,v75
M v[84:87],a[76:79],a[172:175],v[84:87]
C v64,v64,v65
C v65,v66,v67
M v[84:87],a[72:75],a[168:171],v[84:87]
C v66,v72,v73
C v67,v74,v75
M v[84:87],a[68:71],a[164:167],v[84:87]
buffer_store_dwordx4 v[64:67], v7, s[8:11], s29 offen offset:0 sc1
M v[84:87],a[64:67],a[160:163],v[84:87]
s_waitcnt lgkmcnt(0)
MF v68,v6,v68
MF v69,v6,v69
M v[88:91],a[96:99],a[128:131],0
MF v70,v6,v70
MF v71,v6,v71
M v[88:91],a[100:103],a[132:135],v[88:91]
MF v76,v6,v76
MF v77,v6,v77
M v[88:91],a[104:107],a[136:139],v[88:91]
MF v78,v6,v78
MF v79,v6,v79
M v[88:91],a[108:111],a[140:143],v[88:91]
C v68,v68,v69
C v69,v70,v71
M v[88:91],a[112:115],a[144:147],v[88:91]
C v70,v76,v77
C v71,v78,v79
M v[88:91],a[116:119],a[148:151],v[88:91]
buffer_store_dwordx4 v[68:71], v7, s[8:11], s30 offen offset:0 sc1
M v[88:91],a[120:123],a[152:155],v[88:91]
M v[88:91],a[124:127],a[156:159],v[88:91]
M v[92:95],a[124:127],a[188:191],0
M v[92:95],a[120:123],a[184:187],v[92:95]
M v[92:95],a[116:119],a[180:183],v[92:95]
M v[92:95],a[112:115],a[176:179],v[92:95]
MF v80,v5,v80
MF v81,v5,v81
M v[92:95],a[108:111],a[172:175],v[92:95]
MF v82,v5,v82
MF v83,v5,v83
M v[92:95],a[104:107],a[168:171],v[92:95]
MF v88,v5,v88
MF v89,v5,v89
M v[92:95],a[100:103],a[164:167],v[92:95]
MF v90,v5,v90
MF v91,v5,v91
M v[92:95],a[96:99],a[160:163],v[92:95]
C v80,v80,v81
C v81,v82,v83
C v82,v88,v89
C v83,v90,v91
buffer_store_dwordx4 v[80:83], v7, s[8:11], s29 offen offset:1024 sc1
MF v84,v6,v84
MF v85,v6,v85
MF v86,v6,v86
MF v87,v6,v87
MF v92,v6,v92
MF v93,v6,v93
MF v94,v6,v94
MF v95,v6,v95
C v84,v84,v85
C v85,v86,v87
C v86,v92,v93
C v87,v94,v95
buffer_store_dwordx4 v[84:87], v7, s[8:11], s30 offen offset:1024 sc1
buffer_load_dword v9, v33, s[8:11], s46 offen sc1
s_waitcnt vmcnt(1)
buffer_store_dword v15, v16, s[8:11], s3 offen sc1
L_red1:
s_waitcnt vmcnt(0)
v_cmp_eq_u32 vcc, 1, v9
s_mov_b32 s91, 65536
s_mov_b32 s69, 0xffff
s_and_b32 s70, vcc_lo, s69
s_mov_b32 s68, s70
s_cmp_lg_u32 s70, 0
s_cbranch_scc1 L_rk0
s_call_b64 s[36:37], L_rpoll
L_rk0:
s_ff1_i32_b32 s71, s70
s_bitset0_b32 s70, s71
s_mul_i32 s71, s71, 114688
SA s72,s71,s77
buffer_load_dwordx4 v[128:131], v7, s[8:11], s72 offen sc1
buffer_load_dwordx4 v[132:135], v27, s[8:11], s72 offen sc1
s_cmp_lg_u32 s70, 0
s_cbranch_scc1 L_rk1
s_call_b64 s[36:37], L_rpoll
L_rk1:
s_ff1_i32_b32 s71, s70
s_bitset0_b32 s70, s71
s_mul_i32 s71, s71, 114688
SA s72,s71,s77
buffer_load_dwordx4 v[136:139], v7, s[8:11], s72 offen sc1
buffer_load_dwordx4 v[140:143], v27, s[8:11], s72 offen sc1
s_cmp_lg_u32 s70, 0
s_cbranch_scc1 L_rk2
s_call_b64 s[36:37], L_rpoll
L_rk2:
s_ff1_i32_b32 s71, s70
s_bitset0_b32 s70, s71
s_mul_i32 s71, s71, 114688
SA s72,s71,s77
buffer_load_dwordx4 v[144:147], v7, s[8:11], s72 offen sc1
buffer_load_dwordx4 v[148:151], v27, s[8:11], s72 offen sc1
v_readlane_b32 s92, v31, 0
v_readlane_b32 s94, v31, 1
v_lshlrev_b32 v64, 16, v48
v_and_b32 v65, 0xffff0000, v48
v_lshlrev_b32 v66, 16, v49
v_and_b32 v67, 0xffff0000, v49
v_lshlrev_b32 v68, 16, v50
v_and_b32 v69, 0xffff0000, v50
v_lshlrev_b32 v70, 16, v51
v_and_b32 v71, 0xffff0000, v51
v_lshlrev_b32 v72, 16, v52
v_and_b32 v73, 0xffff0000, v52
v_lshlrev_b32 v74, 16, v53
v_and_b32 v75, 0xffff0000, v53
v_lshlrev_b32 v76, 16, v54
v_and_b32 v77, 0xffff0000, v54
v_lshlrev_b32 v78, 16, v55
v_and_b32 v79, 0xffff0000, v55
v_sub_f32 v30, 1.0, v39
v_cmp_eq_u32 s[80:81], s92, v37
v_cmp_eq_u32 s[82:83], s94, v37
s_nop 0
s_or_b64 vcc, s[80:81], s[82:83]
s_cbranch_vccnz L_moe0
L_moe_ret0:
MF v64,v30,v64
MF v65,v30,v65
MF v66,v30,v66
MF v67,v30,v67
MF v68,v30,v68
MF v69,v30,v69
MF v70,v30,v70
MF v71,v30,v71
MF v72,v30,v72
MF v73,v30,v73
MF v74,v30,v74
MF v75,v30,v75
MF v76,v30,v76
MF v77,v30,v77
MF v78,v30,v78
MF v79,v30,v79
s_cmp_lg_u32 s70, 0
s_cbranch_scc1 L_rk3
s_call_b64 s[36:37], L_rpoll
L_rk3:
s_ff1_i32_b32 s71, s70
s_bitset0_b32 s70, s71
s_mul_i32 s71, s71, 114688
SA s72,s71,s77
buffer_load_dwordx4 v[152:155], v7, s[8:11], s72 offen sc1
buffer_load_dwordx4 v[156:159], v27, s[8:11], s72 offen sc1
v_lshlrev_b32 v80, 16, v44
v_and_b32 v81, 0xffff0000, v44
v_lshlrev_b32 v82, 16, v45
v_and_b32 v83, 0xffff0000, v45
v_lshlrev_b32 v84, 16, v46
v_and_b32 v85, 0xffff0000, v46
v_lshlrev_b32 v86, 16, v47
v_and_b32 v87, 0xffff0000, v47
v_sub_f32 v30, 1.0, v26
v_cmp_eq_u32 s[80:81], s92, v29
v_cmp_eq_u32 s[82:83], s94, v29
s_nop 0
s_or_b64 vcc, s[80:81], s[82:83]
s_cbranch_vccnz L_moe1
L_moe_ret1:
MF v80,v30,v80
MF v81,v30,v81
MF v82,v30,v82
MF v83,v30,v83
MF v84,v30,v84
MF v85,v30,v85
MF v86,v30,v86
MF v87,v30,v87
s_waitcnt vmcnt(7)
M v[96:99],a[246:249],v[128:131],0
M v[100:103],a[244:247],v[128:131],0
s_waitcnt vmcnt(6)
M v[104:107],a[246:249],v[132:135],0
M v[108:111],a[244:247],v[132:135],0
s_cmp_lg_u32 s70, 0
s_cbranch_scc1 L_rk4
s_call_b64 s[36:37], L_rpoll
L_rk4:
s_ff1_i32_b32 s71, s70
s_bitset0_b32 s70, s71
s_mul_i32 s71, s71, 114688
SA s72,s71,s77
buffer_load_dwordx4 v[160:163], v7, s[8:11], s72 offen sc1
buffer_load_dwordx4 v[164:167], v27, s[8:11], s72 offen sc1
s_waitcnt vmcnt(7)
M v[96:99],a[246:249],v[136:139],v[96:99]
M v[100:103],a[244:247],v[136:139],v[100:103]
s_waitcnt vmcnt(6)
M v[104:107],a[246:249],v[140:143],v[104:107]
M v[108:111],a[244:247],v[140:143],v[108:111]
s_cmp_lg_u32 s70, 0
s_cbranch_scc1 L_rk5
s_call_b64 s[36:37], L_rpoll
L_rk5:
s_ff1_i32_b32 s71, s70
s_bitset0_b32 s70, s71
s_mul_i32 s71, s71, 114688
SA s72,s71,s77
buffer_load_dwordx4 v[168:171], v7, s[8:11], s72 offen sc1
buffer_load_dwordx4 v[172:175], v27, s[8:11], s72 offen sc1
s_waitcnt vmcnt(7)
M v[96:99],a[246:249],v[144:147],v[96:99]
M v[100:103],a[244:247],v[144:147],v[100:103]
s_waitcnt vmcnt(6)
M v[104:107],a[246:249],v[148:151],v[104:107]
M v[108:111],a[244:247],v[148:151],v[108:111]
s_cmp_lg_u32 s70, 0
s_cbranch_scc1 L_rk6
s_call_b64 s[36:37], L_rpoll
L_rk6:
s_ff1_i32_b32 s71, s70
s_bitset0_b32 s70, s71
s_mul_i32 s71, s71, 114688
SA s72,s71,s77
buffer_load_dwordx4 v[176:179], v7, s[8:11], s72 offen sc1
buffer_load_dwordx4 v[180:183], v27, s[8:11], s72 offen sc1
s_waitcnt vmcnt(7)
M v[96:99],a[246:249],v[152:155],v[96:99]
M v[100:103],a[244:247],v[152:155],v[100:103]
s_waitcnt vmcnt(6)
M v[104:107],a[246:249],v[156:159],v[104:107]
M v[108:111],a[244:247],v[156:159],v[108:111]
s_cmp_lg_u32 s70, 0
s_cbranch_scc1 L_rk7
s_call_b64 s[36:37], L_rpoll
L_rk7:
s_ff1_i32_b32 s71, s70
s_bitset0_b32 s70, s71
s_mul_i32 s71, s71, 114688
SA s72,s71,s77
buffer_load_dwordx4 v[184:187], v7, s[8:11], s72 offen sc1
buffer_load_dwordx4 v[188:191], v27, s[8:11], s72 offen sc1
s_waitcnt vmcnt(7)
M v[96:99],a[246:249],v[160:163],v[96:99]
M v[100:103],a[244:247],v[160:163],v[100:103]
s_waitcnt vmcnt(6)
M v[104:107],a[246:249],v[164:167],v[104:107]
M v[108:111],a[244:247],v[164:167],v[108:111]
s_cmp_lg_u32 s70, 0
s_cbranch_scc1 L_rk8
s_call_b64 s[36:37], L_rpoll
L_rk8:
s_ff1_i32_b32 s71, s70
s_bitset0_b32 s70, s71
s_mul_i32 s71, s71, 114688
SA s72,s71,s77
buffer_load_dwordx4 v[128:131], v7, s[8:11], s72 offen sc1
buffer_load_dwordx4 v[132:135], v27, s[8:11], s72 offen sc1
s_waitcnt vmcnt(7)
M v[96:99],a[246:249],v[168:171],v[96:99]
M v[100:103],a[244:247],v[168:171],v[100:103]
s_waitcnt vmcnt(6)
M v[104:107],a[246:249],v[172:175],v[104:107]
M v[108:111],a[244:247],v[172:175],v[108:111]
s_cmp_lg_u32 s70, 0
s_cbranch_scc1 L_rk9
s_call_b64 s[36:37], L_rpoll
L_rk9:
s_ff1_i32_b32 s71, s70
s_bitset0_b32 s70, s71
s_mul_i32 s71, s71, 114688
SA s72,s71,s77
buffer_load_dwordx4 v[136:139], v7, s[8:11], s72 offen sc1
buffer_load_dwordx4 v[140:143], v27, s[8:11], s72 offen sc1
s_waitcnt vmcnt(7)
M v[96:99],a[246:249],v[176:179],v[96:99]
M v[100:103],a[244:247],v[176:179],v[100:103]
s_waitcnt vmcnt(6)
M v[104:107],a[246:249],v[180:183],v[104:107]
M v[108:111],a[244:247],v[180:183],v[108:111]
s_cmp_lg_u32 s70, 0
s_cbranch_scc1 L_rk10
s_call_b64 s[36:37], L_rpoll
L_rk10:
s_ff1_i32_b32 s71, s70
s_bitset0_b32 s70, s71
s_mul_i32 s71, s71, 114688
SA s72,s71,s77
buffer_load_dwordx4 v[144:147], v7, s[8:11], s72 offen sc1
buffer_load_dwordx4 v[148:151], v27, s[8:11], s72 offen sc1
s_waitcnt vmcnt(7)
M v[96:99],a[246:249],v[184:187],v[96:99]
M v[100:103],a[244:247],v[184:187],v[100:103]
s_waitcnt vmcnt(6)
M v[104:107],a[246:249],v[188:191],v[104:107]
M v[108:111],a[244:247],v[188:191],v[108:111]
s_cmp_lg_u32 s70, 0
s_cbranch_scc1 L_rk11
s_call_b64 s[36:37], L_rpoll
L_rk11:
s_ff1_i32_b32 s71, s70
s_bitset0_b32 s70, s71
s_mul_i32 s71, s71, 114688
SA s72,s71,s77
buffer_load_dwordx4 v[152:155], v7, s[8:11], s72 offen sc1
buffer_load_dwordx4 v[156:159], v27, s[8:11], s72 offen sc1
s_waitcnt vmcnt(7)
M v[96:99],a[246:249],v[128:131],v[96:99]
M v[100:103],a[244:247],v[128:131],v[100:103]
s_waitcnt vmcnt(6)
M v[104:107],a[246:249],v[132:135],v[104:107]
M v[108:111],a[244:247],v[132:135],v[108:111]
s_cmp_lg_u32 s70, 0
s_cbranch_scc1 L_rk12
s_call_b64 s[36:37], L_rpoll
L_rk12:
s_ff1_i32_b32 s71, s70
s_bitset0_b32 s70, s71
s_mul_i32 s71, s71, 114688
SA s72,s71,s77
buffer_load_dwordx4 v[160:163], v7, s[8:11], s72 offen sc1
buffer_load_dwordx4 v[164:167], v27, s[8:11], s72 offen sc1
buffer_load_dword v8, v33, s[8:11], s46 offen sc1
s_waitcnt vmcnt(8)
M v[96:99],a[246:249],v[136:139],v[96:99]
M v[100:103],a[244:247],v[136:139],v[100:103]
s_waitcnt vmcnt(7)
M v[104:107],a[246:249],v[140:143],v[104:107]
M v[108:111],a[244:247],v[140:143],v[108:111]
s_cmp_lg_u32 s70, 0
s_cbranch_scc1 L_rk13
s_call_b64 s[36:37], L_rpoll
L_rk13:
s_ff1_i32_b32 s71, s70
s_bitset0_b32 s70, s71
s_mul_i32 s71, s71, 114688
SA s72,s71,s77
buffer_load_dwordx4 v[168:171], v7, s[8:11], s72 offen sc1
buffer_load_dwordx4 v[172:175], v27, s[8:11], s72 offen sc1
s_waitcnt vmcnt(8)
M v[96:99],a[246:249],v[144:147],v[96:99]
M v[100:103],a[244:247],v[144:147],v[100:103]
s_waitcnt vmcnt(7)
M v[104:107],a[246:249],v[148:151],v[104:107]
M v[108:111],a[244:247],v[148:151],v[108:111]
s_cmp_lg_u32 s70, 0
s_cbranch_scc1 L_rk14
s_call_b64 s[36:37], L_rpoll
L_rk14:
s_ff1_i32_b32 s71, s70
s_bitset0_b32 s70, s71
s_mul_i32 s71, s71, 114688
SA s72,s71,s77
buffer_load_dwordx4 v[176:179], v7, s[8:11], s72 offen sc1
buffer_load_dwordx4 v[180:183], v27, s[8:11], s72 offen sc1
s_waitcnt vmcnt(8)
M v[96:99],a[246:249],v[152:155],v[96:99]
M v[100:103],a[244:247],v[152:155],v[100:103]
s_waitcnt vmcnt(7)
M v[104:107],a[246:249],v[156:159],v[104:107]
M v[108:111],a[244:247],v[156:159],v[108:111]
s_cmp_lg_u32 s70, 0
s_cbranch_scc1 L_rk15
s_call_b64 s[36:37], L_rpoll
L_rk15:
s_ff1_i32_b32 s71, s70
s_bitset0_b32 s70, s71
s_mul_i32 s71, s71, 114688
SA s72,s71,s77
buffer_load_dwordx4 v[184:187], v7, s[8:11], s72 offen sc1
buffer_load_dwordx4 v[188:191], v27, s[8:11], s72 offen sc1
s_waitcnt vmcnt(8)
M v[96:99],a[246:249],v[160:163],v[96:99]
M v[100:103],a[244:247],v[160:163],v[100:103]
s_waitcnt vmcnt(7)
M v[104:107],a[246:249],v[164:167],v[104:107]
M v[108:111],a[244:247],v[164:167],v[108:111]
s_waitcnt vmcnt(6)
v_cmp_eq_u32 vcc, 1, v8
s_mov_b32 s69, 0xffff0000
s_and_b32 s70, vcc_lo, s69
s_mov_b32 s68, s70
s_cmp_lg_u32 s70, 0
s_cbranch_scc1 L_rk16
s_call_b64 s[36:37], L_rpoll
L_rk16:
s_ff1_i32_b32 s71, s70
s_bitset0_b32 s70, s71
s_mul_i32 s71, s71, 114688
SA s72,s71,s78
buffer_load_dwordx4 v[192:195], v7, s[8:11], s72 offen sc1
s_waitcnt vmcnt(6)
M v[96:99],a[246:249],v[168:171],v[96:99]
M v[100:103],a[244:247],v[168:171],v[100:103]
s_waitcnt vmcnt(5)
M v[104:107],a[246:249],v[172:175],v[104:107]
M v[108:111],a[244:247],v[172:175],v[108:111]
s_cmp_lg_u32 s70, 0
s_cbranch_scc1 L_rk17
s_call_b64 s[36:37], L_rpoll
L_rk17:
s_ff1_i32_b32 s71, s70
s_bitset0_b32 s70, s71
s_mul_i32 s71, s71, 114688
SA s72,s71,s78
buffer_load_dwordx4 v[196:199], v7, s[8:11], s72 offen sc1
s_waitcnt vmcnt(5)
M v[96:99],a[246:249],v[176:179],v[96:99]
M v[100:103],a[244:247],v[176:179],v[100:103]
s_waitcnt vmcnt(4)
M v[104:107],a[246:249],v[180:183],v[104:107]
M v[108:111],a[244:247],v[180:183],v[108:111]
s_cmp_lg_u32 s70, 0
s_cbranch_scc1 L_rk18
s_call_b64 s[36:37], L_rpoll
L_rk18:
s_ff1_i32_b32 s71, s70
s_bitset0_b32 s70, s71
s_mul_i32 s71, s71, 114688
SA s72,s71,s78
buffer_load_dwordx4 v[200:203], v7, s[8:11], s72 offen sc1
s_waitcnt vmcnt(4)
M v[96:99],a[246:249],v[184:187],v[96:99]
M v[100:103],a[244:247],v[184:187],v[100:103]
s_waitcnt vmcnt(3)
M v[104:107],a[246:249],v[188:191],v[104:107]
M v[108:111],a[244:247],v[188:191],v[108:111]
s_nop 4
v_permlane16_swap_b32 v96, v100
v_permlane16_swap_b32 v97, v101
v_permlane16_swap_b32 v98, v102
v_permlane16_swap_b32 v99, v103
v_permlane16_swap_b32 v104, v108
v_permlane16_swap_b32 v105, v109
v_permlane16_swap_b32 v106, v110
v_permlane16_swap_b32 v107, v111
v_fmac_f32 v64, v39, v96
v_fmac_f32 v65, v39, v97
v_fmac_f32 v66, v39, v98
v_fmac_f32 v67, v39, v99
v_fmac_f32 v68, v39, v100
v_fmac_f32 v69, v39, v101
v_fmac_f32 v70, v39, v102
v_fmac_f32 v71, v39, v103
C v48,v64,v65
C v49,v66,v67
C v50,v68,v69
C v51,v70,v71
buffer_store_dwordx4 v[48:51], v38, s[52:55], s75 offen sc1
v_fmac_f32 v72, v39, v104
v_fmac_f32 v73, v39, v105
v_fmac_f32 v74, v39, v106
v_fmac_f32 v75, v39, v107
v_fmac_f32 v76, v39, v108
v_fmac_f32 v77, v39, v109
v_fmac_f32 v78, v39, v110
v_fmac_f32 v79, v39, v111
C v52,v72,v73
C v53,v74,v75
C v54,v76,v77
C v55,v78,v79
buffer_store_dwordx4 v[52:55], v38, s[52:55], s76 offen sc1
s_cmp_lg_u32 s70, 0
s_cbranch_scc1 L_rk19
s_call_b64 s[36:37], L_rpoll
L_rk19:
s_ff1_i32_b32 s71, s70
s_bitset0_b32 s70, s71
s_mul_i32 s71, s71, 114688
SA s72,s71,s78
buffer_load_dwordx4 v[204:207], v7, s[8:11], s72 offen sc1
s_cmp_lg_u32 s70, 0
s_cbranch_scc1 L_rk20
s_call_b64 s[36:37], L_rpoll
L_rk20:
s_ff1_i32_b32 s71, s70
s_bitset0_b32 s70, s71
s_mul_i32 s71, s71, 114688
SA s72,s71,s78
buffer_load_dwordx4 v[208:211], v7, s[8:11], s72 offen sc1
s_cmp_lg_u32 s70, 0
s_cbranch_scc1 L_rk21
s_call_b64 s[36:37], L_rpoll
L_rk21:
s_ff1_i32_b32 s71, s70
s_bitset0_b32 s70, s71
s_mul_i32 s71, s71, 114688
SA s72,s71,s78
buffer_load_dwordx4 v[212:215], v7, s[8:11], s72 offen sc1
s_cmp_lg_u32 s70, 0
s_cbranch_scc1 L_rk22
s_call_b64 s[36:37], L_rpoll
L_rk22:
s_ff1_i32_b32 s71, s70
s_bitset0_b32 s70, s71
s_mul_i32 s71, s71, 114688
SA s72,s71,s78
buffer_load_dwordx4 v[216:219], v7, s[8:11], s72 offen sc1
s_cmp_lg_u32 s70, 0
s_cbranch_scc1 L_rk23
s_call_b64 s[36:37], L_rpoll
L_rk23:
s_ff1_i32_b32 s71, s70
s_bitset0_b32 s70, s71
s_mul_i32 s71, s71, 114688
SA s72,s71,s78
buffer_load_dwordx4 v[220:223], v7, s[8:11], s72 offen sc1
s_cmp_lg_u32 s70, 0
s_cbranch_scc1 L_rk24
s_call_b64 s[36:37], L_rpoll
L_rk24:
s_ff1_i32_b32 s71, s70
s_bitset0_b32 s70, s71
s_mul_i32 s71, s71, 114688
SA s72,s71,s78
buffer_load_dwordx4 v[224:227], v7, s[8:11], s72 offen sc1
s_cmp_lg_u32 s70, 0
s_cbranch_scc1 L_rk25
s_call_b64 s[36:37], L_rpoll
L_rk25:
s_ff1_i32_b32 s71, s70
s_bitset0_b32 s70, s71
s_mul_i32 s71, s71, 114688
SA s72,s71,s78
buffer_load_dwordx4 v[228:231], v7, s[8:11], s72 offen sc1
s_cmp_lg_u32 s70, 0
s_cbranch_scc1 L_rk26
s_call_b64 s[36:37], L_rpoll
L_rk26:
s_ff1_i32_b32 s71, s70
s_bitset0_b32 s70, s71
s_mul_i32 s71, s71, 114688
SA s72,s71,s78
buffer_load_dwordx4 v[232:235], v7, s[8:11], s72 offen sc1
s_cmp_lg_u32 s70, 0
s_cbranch_scc1 L_rk27
s_call_b64 s[36:37], L_rpoll
L_rk27:
s_ff1_i32_b32 s71, s70
s_bitset0_b32 s70, s71
s_mul_i32 s71, s71, 114688
SA s72,s71,s78
buffer_load_dwordx4 v[236:239], v7, s[8:11], s72 offen sc1
s_waitcnt vmcnt(13)
M v[112:115],a[246:249],v[192:195],0
M v[116:119],a[244:247],v[192:195],0
s_cmp_lg_u32 s70, 0
s_cbranch_scc1 L_rk28
s_call_b64 s[36:37], L_rpoll
L_rk28:
s_ff1_i32_b32 s71, s70
s_bitset0_b32 s70, s71
s_mul_i32 s71, s71, 114688
SA s72,s71,s78
buffer_load_dwordx4 v[240:243], v7, s[8:11], s72 offen sc1
s_waitcnt vmcnt(13)
M v[112:115],a[246:249],v[196:199],v[112:115]
M v[116:119],a[244:247],v[196:199],v[116:119]
s_cmp_lg_u32 s70, 0
s_cbranch_scc1 L_rk29
s_call_b64 s[36:37], L_rpoll
L_rk29:
s_ff1_i32_b32 s71, s70
s_bitset0_b32 s70, s71
s_mul_i32 s71, s71, 114688
SA s72,s71,s78
buffer_load_dwordx4 v[244:247], v7, s[8:11], s72 offen sc1
s_waitcnt vmcnt(13)
M v[112:115],a[246:249],v[200:203],v[112:115]
M v[116:119],a[244:247],v[200:203],v[116:119]
s_cmp_lg_u32 s70, 0
s_cbranch_scc1 L_rk30
s_call_b64 s[36:37], L_rpoll
L_rk30:
s_ff1_i32_b32 s71, s70
s_bitset0_b32 s70, s71
s_mul_i32 s71, s71, 114688
SA s72,s71,s78
buffer_load_dwordx4 v[248:251], v7, s[8:11], s72 offen sc1
s_waitcnt vmcnt(11)
M v[112:115],a[246:249],v[204:207],v[112:115]
M v[116:119],a[244:247],v[204:207],v[116:119]
s_cmp_lg_u32 s70, 0
s_cbranch_scc1 L_rk31
s_call_b64 s[36:37], L_rpoll
L_rk31:
s_ff1_i32_b32 s71, s70
s_bitset0_b32 s70, s71
s_mul_i32 s71, s71, 114688
SA s72,s71,s78
buffer_load_dwordx4 v[252:255], v7, s[8:11], s72 offen sc1
s_waitcnt vmcnt(11)
M v[112:115],a[246:249],v[208:211],v[112:115]
M v[116:119],a[244:247],v[208:211],v[116:119]
s_waitcnt vmcnt(10)
M v[112:115],a[246:249],v[212:215],v[112:115]
M v[116:119],a[244:247],v[212:215],v[116:119]
s_waitcnt vmcnt(9)
M v[112:115],a[246:249],v[216:219],v[112:115]
M v[116:119],a[244:247],v[216:219],v[116:119]
s_waitcnt vmcnt(8)
M v[112:115],a[246:249],v[220:223],v[112:115]
M v[116:119],a[244:247],v[220:223],v[116:119]
s_waitcnt vmcnt(7)
M v[112:115],a[246:249],v[224:227],v[112:115]
M v[116:119],a[244:247],v[224:227],v[116:119]
s_waitcnt vmcnt(6)
M v[112:115],a[246:249],v[228:231],v[112:115]
M v[116:119],a[244:247],v[228:231],v[116:119]
s_waitcnt vmcnt(5)
M v[112:115],a[246:249],v[232:235],v[112:115]
M v[116:119],a[244:247],v[232:235],v[116:119]
s_waitcnt vmcnt(4)
M v[112:115],a[246:249],v[236:239],v[112:115]
M v[116:119],a[244:247],v[236:239],v[116:119]
s_waitcnt vmcnt(3)
M v[112:115],a[246:249],v[240:243],v[112:115]
M v[116:119],a[244:247],v[240:243],v[116:119]
s_waitcnt vmcnt(2)
M v[112:115],a[246:249],v[244:247],v[112:115]
M v[116:119],a[244:247],v[244:247],v[116:119]
s_waitcnt vmcnt(1)
M v[112:115],a[246:249],v[248:251],v[112:115]
M v[116:119],a[244:247],v[248:251],v[116:119]
s_waitcnt vmcnt(0)
M v[112:115],a[246:249],v[252:255],v[112:115]
M v[116:119],a[244:247],v[252:255],v[116:119]
s_nop 7
v_permlane16_swap_b32 v112, v116
v_permlane16_swap_b32 v113, v117
v_permlane16_swap_b32 v114, v118
v_permlane16_swap_b32 v115, v119
v_fmac_f32 v80, v26, v112
v_fmac_f32 v81, v26, v113
v_fmac_f32 v82, v26, v114
v_fmac_f32 v83, v26, v115
v_fmac_f32 v84, v26, v116
v_fmac_f32 v85, v26, v117
v_fmac_f32 v86, v26, v118
v_fmac_f32 v87, v26, v119
C v44,v80,v81
C v45,v82,v83
C v46,v84,v85
C v47,v86,v87
buffer_store_dwordx4 v[44:47], v28, s[52:55], s79 offen sc1
s_endpgm
L_rpoll0:
s_sleep 1
L_rpoll:
buffer_load_dword v9, v33, s[8:11], s46 offen sc1
s_waitcnt vmcnt(0)
v_cmp_eq_u32 vcc, 1, v9
s_sub_u32 s91, s91, 1
s_cselect_b32 s70, -1, 0
s_or_b32 s70, s70, vcc_lo
s_and_b32 s70, s70, s69
s_andn2_b32 s70, s70, s68
s_cbranch_scc0 L_rpoll0
s_or_b32 s68, s68, s70
s_setpc_b64 s[36:37]
L_moe0:
s_lshl_b32 s88, s75, 1
s_call_b64 s[36:37], L_moe
AF v64,v2,v64
AF v65,v3,v65
AF v66,v4,v66
AF v67,v5,v67
AF v68,v10,v68
AF v69,v11,v69
AF v70,v12,v70
AF v71,v13,v71
AF v72,v14,v72
AF v73,v15,v73
AF v74,v16,v74
AF v75,v17,v75
AF v76,v18,v76
AF v77,v19,v77
AF v78,v20,v78
AF v79,v21,v79
s_mov_b64 exec, -1
s_branch L_moe_ret0
L_moe1:
s_lshl_b32 s88, s79, 1
s_call_b64 s[36:37], L_moe
AF v80,v2,v80
AF v81,v3,v81
AF v82,v4,v82
AF v83,v5,v83
AF v84,v10,v84
AF v85,v11,v85
AF v86,v12,v86
AF v87,v13,v87
s_mov_b64 exec, -1
s_branch L_moe_ret1
L_moe2:
s_lshl_b32 s88, s79, 1
s_call_b64 s[36:37], L_moe
AF v48,v2,v48
AF v49,v3,v49
AF v50,v4,v50
AF v51,v5,v51
AF v52,v10,v52
AF v53,v11,v53
AF v54,v12,v54
AF v55,v13,v55
s_mov_b64 exec, -1
s_branch L_moe_ret2
L_moe:
v_min_u32 v0, 27, v32
v_lshlrev_b32 v0, 2, v0
s_mov_b32 s64, 105062912
s_mov_b32 s65, 65536
s_mov_b32 exec_lo, 0xffffffff
s_mov_b32 exec_hi, 0xffffffff
L_pfy:
buffer_load_dword v1, v0, s[8:11], s64 offen sc1
s_sub_u32 s65, s65, 1
s_cbranch_scc1 L_pfy_x
s_waitcnt vmcnt(0)
v_cmp_ne_u32 vcc, 1, v1
s_nop 0
s_cbranch_vccz L_pfy_x
s_sleep 2
s_branch L_pfy
L_pfy_x:
s_waitcnt vmcnt(0)
s_mov_b64 exec, -1
s_or_b64 exec, s[80:81], s[82:83]
v_mov_b32 v0, 1792
v_cndmask_b32 v0, v0, 0, s[80:81]
v_lshl_add_u32 v0, v34, 5, v0
SA s88,s88,104898560
buffer_load_dwordx4 v[2:5], v0, s[8:11], s88 offen sc1
buffer_load_dwordx4 v[10:13], v0, s[8:11], s88 offen offset:16 sc1
buffer_load_dwordx4 v[14:17], v0, s[8:11], s88 offen offset:512 sc1
buffer_load_dwordx4 v[18:21], v0, s[8:11], s88 offen offset:528 sc1
s_waitcnt vmcnt(0)
s_setpc_b64 s[36:37]
L_red:
v_lshrrev_b32 v32, 4, v7
s_lshr_b32 s74, s41, 3
s_lshl_b32 s64, s42, 1
SA s46,s64,s74
s_mul_i32 s46, s46, 4352
s_and_b32 s72, s41, 7
s_lshl_b32 s65, s72, 7
SA s46,s46,s65
SA s46,s46,104992768
v_and_b32 v33, 31, v32
v_lshlrev_b32 v33, 2, v33
s_lshl_b32 s65, s41, 7
SA s65,s65,104890368
buffer_load_dword v31, v33, s[8:11], s65 offen sc1
v_bfe_u32 v34, v32, 4, 1
v_lshlrev_b32 v34, 1, v34
v_lshrrev_b32 v35, 5, v32
v_add_u32 v34, v34, v35
s_mov_b32 s52, s96
s_and_b32 s53, s97, 0xffff
s_mov_b32 s54, 1835008
s_mov_b32 s55, 0x20000
s_mul_i32 s77, s42, 1835008
s_mul_i32 s78, s72, 14336
SA s77,s77,s78
SA s77,s77,67108864
s_lshl_b32 s79, s74, 1
SA s79,s79,s20
s_lshl_b32 s71, s74, 1
SA s71,s71,1
s_sub_u32 s71, s71, s20
s_and_b32 s71, s71, 536870912
s_sub_u32 s64, 15, s64
s_sub_u32 s78, s64, 1
s_mul_i32 s78, s78, 1835008
SA s78,s78,s77
s_lshl_b32 s65, s79, 10
SA s78,s78,s65
SA s78,s78,s71
s_lshl_b32 s79, s79, 6
s_or_b32 s79, s79, s71
s_mul_i32 s67, s74, -2
s_lshl_b32 s74, s74, 3
SA s74,s74,s20
s_lshl_b32 s75, s74, 6
SA s76,s75,256
SA s67,s67,3
s_sub_u32 s67, s67, s20
s_and_b32 s67, s67, 536870912
s_or_b32 s76, s76, s67
v_or_b32 v27, s67, v7
v_add_u32 v27, 4096, v27
s_lshl_b32 s65, s74, 10
SA s77,s77,s65
s_lshl_b32 s64, s64, 7
s_lshr_b32 s73, s72, 1
s_sub_u32 s65, 7, s73
s_bitcmp1_b32 s72, 0
s_cselect_b32 s73, s65, s73
s_lshl_b32 s73, s73, 4
s_lshl_b32 s65, s42, 7
SA s73,s73,s65
v_and_b32 v37, 15, v32
v_add_u32 v37, s73, v37
v_add_u32 v29, s64, v37
s_mov_b32 s64, 104857664
v_mul_u32_u24 v38, 896, v37
v_lshl_add_u32 v38, v34, 4, v38
v_lshrrev_b32 v35, 4, v37
v_lshlrev_b32 v35, 5, v35
v_and_b32 v36, 15, v37
v_add_lshl_u32 v35, v35, v36, 2
buffer_load_dword v39, v35, s[8:11], s64 offen sc1
buffer_load_dwordx4 v[48:51], v38, s[56:59], s75 offen
buffer_load_dwordx4 v[52:55], v38, s[56:59], s76 offen
v_mul_u32_u24 v28, 896, v29
v_lshl_add_u32 v28, v34, 4, v28
v_lshrrev_b32 v35, 4, v29
v_lshlrev_b32 v35, 5, v35
v_and_b32 v36, 15, v29
v_add_lshl_u32 v35, v35, v36, 2
buffer_load_dword v26, v35, s[8:11], s64 offen sc1
buffer_load_dwordx4 v[44:47], v28, s[56:59], s79 offen
s_waitcnt vmcnt(7)
buffer_load_dword v9, v33, s[8:11], s46 offen sc1
s_branch L_red1
L_code_end:
.section .rodata,"a"
.p2align 6
.amdhsa_kernel gated_mix__compressed_kv_cla__moe_arch_mod__prompt_kernel
  .amdhsa_next_free_vgpr 512
  .amdhsa_next_free_sgpr 102
  .amdhsa_accum_offset 256
  .amdhsa_group_segment_fixed_size 0
  .amdhsa_kernarg_size 120
  .amdhsa_user_sgpr_count 2
  .amdhsa_user_sgpr_kernarg_segment_ptr 1
  .amdhsa_system_sgpr_workgroup_id_x 1
  .amdhsa_float_denorm_mode_32 3
.end_amdhsa_kernel
```

```asm
; @launch grid=(256,1,1) block=(256,1,1) lds=163840
.amdgcn_target "amdgcn-amd-amdhsa--gfx950"
.text
.macro M a, b, c, d
v_mfma_f32_16x16x32_bf16 \a, \b, \c, \d
.endm
.macro R a, b, c
ds_read_b128 \a, \b offset:\c
.endm
.macro T a, b, c
ds_read_b64_tr_b16 \a, \b offset:\c
.endm
.macro C a, b, c
v_cvt_pk_bf16_f32 \a, \b, \c
.endm
.macro E a, b
v_exp_f32 \a, \b
.endm
.macro W a, b
v_accvgpr_write_b32 \a, \b
.endm
.macro G a, b
v_accvgpr_read_b32 \a, \b
.endm
.macro AF a, b, c
v_add_f32 \a, \b, \c
.endm
.macro MF a, b, c
v_mul_f32 \a, \b, \c
.endm
.macro SA a, b, c
s_add_u32 \a, \b, \c
.endm
.globl gated_mix__compressed_kv_cla__moe_arch_mod__prompt_kernel
.p2align 8
.type gated_mix__compressed_kv_cla__moe_arch_mod__prompt_kernel,@function
gated_mix__compressed_kv_cla__moe_arch_mod__prompt_kernel:
s_cmp_lt_u32 s2, 256
s_cbranch_scc1 L_go
s_endpgm
L_go:
s_load_dwordx8 s[80:87], s[0:1], 0
s_load_dwordx4 s[88:91], s[0:1], 32
s_getpc_b64 s[76:77]
L_pc0:
s_lshr_b32 s42, s2, 3
s_mov_b32 s79, 0x20000
s_lshl_b32 s67, s42, 13
s_mov_b32 s78, L_code_end-L_pc0
s_and_b32 s77, s77, 0xffff
v_lshl_add_u32 v31, v0, 5, s67
buffer_load_dword a240, v31, s[76:79], 0 offen offset:0
v_lshrrev_b32 v24, 6, v0
v_and_b32 v0, 63, v0
s_and_b32 s41, s2, 7
v_readfirstlane_b32 s20, v24
s_lshr_b32 s64, s2, 4
v_and_b32 v24, 15, v0
v_lshrrev_b32 v25, 4, v0
s_and_b32 s64, s64, 8
s_or_b32 s41, s41, s64
v_lshlrev_b32 v28, 1, v25
v_xor_b32 v28, v28, v24
v_and_b32 v29, 8, v28
v_and_b32 v28, 7, v28
v_lshlrev_b32 v28, 4, v28
v_lshl_add_u32 v28, v29, 5, v28
v_lshl_add_u32 v28, v25, 13, v28
s_lshl_b32 s64, s20, 17
v_add_u32 v8, s64, v28
v_xor_b32 v28, 0x100, v8
v_add_u32 v9, 31744, v8
v_add_u32 v10, 63488, v28
v_add_u32 v11, 95232, v28
s_mov_b32 s21, 0
s_lshl_b32 s23, s20, 12
s_lshl_b32 s74, s41, 9
s_sub_u32 s18, 8388608, s74
s_mov_b32 s19, s79
s_bitcmp0_b32 s2, 6
s_waitcnt lgkmcnt(0)
s_cselect_b64 s[72:73], s[86:87], s[88:89]
SA s16,s72,s74
s_addc_u32 s73, s73, 0
s_and_b32 s17, s73, 0xffff
SA m0,s23,0
s_nop 0
buffer_load_dwordx4 v8, s[16:19], s21 offen offset:0  nt lds
buffer_load_dwordx4 v9, s[16:19], s21 offen offset:1024  nt lds
buffer_load_dwordx4 v10, s[16:19], s21 offen offset:2048  nt lds
buffer_load_dwordx4 v11, s[16:19], s21 offen offset:3072  nt lds
SA s21,s21,128
s_and_b32 s42, s42, 15
s_lshr_b32 s45, s42, 3
s_and_b32 s65, s20, 1
s_lshr_b32 s66, s20, 1
v_and_b32 v29, 7, v0
v_xor_b32 v28, v25, v29
v_lshlrev_b32 v28, 4, v28
v_lshrrev_b32 v29, 3, v0
v_lshl_add_u32 v30, v29, 11, v28
s_lshl_b32 s64, s66, 19
s_lshl_b32 s67, s65, 21
SA s64,s64,s67
v_add_u32 v12, s64, v30
v_xor_b32 v30, 64, v12
v_add_u32 v14, 30720, v12
v_add_u32 v13, 15360, v30
v_add_u32 v15, 46080, v30
s_mov_b32 s22, 0
SA s24,s23,65536
s_and_b32 s64, s42, 7
s_lshl_b32 s64, s64, 16
s_sub_u32 s50, 4194304, s64
s_mov_b32 s51, s79
SA s48,s82,s64
s_addc_u32 s73, s83, 0
s_and_b32 s49, s73, 0xffff
SA m0,s23,16384
s_nop 0
buffer_load_dwordx4 v8, s[16:19], s21 offen offset:0  nt lds
buffer_load_dwordx4 v9, s[16:19], s21 offen offset:1024  nt lds
buffer_load_dwordx4 v10, s[16:19], s21 offen offset:2048  nt lds
buffer_load_dwordx4 v11, s[16:19], s21 offen offset:3072  nt lds
SA s21,s21,524160
SA m0,s24,0
s_nop 0
buffer_load_dwordx4 v12, s[48:51], s22 offen offset:0   lds
buffer_load_dwordx4 v13, s[48:51], s22 offen offset:1024   lds
buffer_load_dwordx4 v14, s[48:51], s22 offen offset:2048   lds
buffer_load_dwordx4 v15, s[48:51], s22 offen offset:3072   lds
SA s22,s22,1048576
s_load_dwordx2 s[92:93], s[0:1], 56
s_load_dwordx2 s[94:95], s[0:1], 88
s_load_dwordx4 s[4:7], s[0:1], 104
v_lshlrev_b32 v7, 4, v0
v_lshrrev_b32 v26, 2, v24
v_and_b32 v28, 1, v25
v_lshl_or_b32 v28, v28, 2, v26
v_lshl_add_u32 v29, v25, 3, v26
v_lshlrev_b32 v29, 8, v29
v_and_b32 v30, 3, v0
v_lshl_add_u32 v29, v30, 3, v29
s_lshl_b32 s64, s65, 2
SA s64,s64,0
v_xor_b32 v30, s64, v28
v_lshl_add_u32 v1, v30, 5, v29
s_lshl_b32 s64, s65, 2
SA s64,s64,1
v_xor_b32 v30, s64, v28
v_lshl_add_u32 v2, v30, 5, v29
s_lshl_b32 s64, s65, 2
SA s64,s64,2
v_xor_b32 v30, s64, v28
v_lshl_add_u32 v3, v30, 5, v29
s_lshl_b32 s64, s65, 2
SA s64,s64,3
v_xor_b32 v30, s64, v28
v_lshl_add_u32 v4, v30, 5, v29
v_add_u32 v28, 0, v25
v_lshrrev_b32 v29, 1, v24
v_xor_b32 v28, v28, v29
v_lshlrev_b32 v28, 4, v28
v_lshl_add_u32 v28, v24, 7, v28
s_lshl_b32 s64, s66, 13
SA s64,s64,65536
v_add_u32 v5, s64, v28
v_add_u32 v28, 4, v25
v_lshrrev_b32 v29, 1, v24
v_xor_b32 v28, v28, v29
v_lshlrev_b32 v28, 4, v28
v_lshl_add_u32 v28, v24, 7, v28
s_lshl_b32 s64, s66, 13
SA s64,s64,65536
v_add_u32 v6, s64, v28
s_mov_b32 s56, s80
s_and_b32 s57, s81, 0xffff
s_mov_b32 s58, 1835008
s_mov_b32 s59, 0x20000
s_waitcnt lgkmcnt(0)
s_mov_b32 s60, s92
s_and_b32 s61, s93, 0xffff
s_mov_b32 s62, 896
s_mov_b32 s63, 0x20000
s_mov_b32 s68, s94
s_and_b32 s69, s95, 0xffff
s_mov_b32 s70, 896
s_mov_b32 s71, 0x20000
s_lshl_b32 s95, s20, 11
s_lshr_b32 s64, s2, 3
s_lshl_b32 s64, s64, 13
SA s95,s95,s64
s_mov_b32 s8, s6
s_and_b32 s9, s7, 0xffff
s_mov_b32 s10, 268435456
s_mov_b32 s11, 0x20000
s_mov_b32 s12, s4
s_and_b32 s13, s5, 0xffff
s_mov_b32 s14, 256
s_mov_b32 s15, 0x20000
SA s72,s84,s74
s_addc_u32 s73, s85, 0
s_sub_u32 s75, 3670016, s74
s_mov_b32 s52, s72
s_and_b32 s53, s73, 0xffff
s_mov_b32 s54, s75
s_mov_b32 s55, 0x20000
s_mul_i32 s29, s42, 114688
s_mov_b32 s5, 0x3db8aa3b
s_mul_i32 s72, s45, 16777216
s_mul_i32 s73, s41, 1048576
SA s72,s72,s73
s_bfe_u32 s64, s42, 0x20001
s_lshl_b32 s64, s64, 15
SA s72,s72,s64
s_lshl_b32 s64, s66, 17
SA s72,s72,s64
s_and_b32 s67, s42, 1
s_cmp_eq_u32 s45, 0
s_cselect_b32 s64, 12, 14
s_cselect_b32 s75, 14, 10
s_lshl_b32 s67, s67, s75
SA s72,s72,s67
s_lshl_b32 s64, s65, s64
SA s93,s72,s64
s_load_dwordx4 s[80:83], s[0:1], 64
s_load_dwordx2 s[84:85], s[0:1], 80
s_load_dwordx2 s[96:97], s[0:1], 96
s_cmp_eq_u32 s45, 0
s_cbranch_scc0 L_kv1
s_branch L_kv0
.p2align 12
L_kv0:
s_and_b32 s31, s42, 7
s_lshl_b32 s64, s42, 4
SA s64,s64,s41
s_lshl_b32 s64, s64, 2
SA s64,s64,s20
s_cmp_lt_u32 s64, 41
s_cselect_b32 s39, 0, 536870912
s_min_u32 s64, s64, 41
s_lshl_b32 s38, s64, 2
s_max_u32 s67, s64, 8
s_sub_u32 s67, s67, 8
s_mul_i32 s67, s67, 3328
s_lshl_b32 s64, s64, 10
SA s64,s64,s67
SA s73,s64,104914944
v_or_b32 v64, s39, v7
v_mov_b32 v68, 0
v_mov_b32 v69, 0
v_mov_b32 v70, 0
v_mov_b32 v71, 0
buffer_store_dwordx4 v[68:71], v64, s[8:11], s73 offen offset:0 sc1
buffer_store_dwordx4 v[68:71], v64, s[8:11], s73 offen offset:1024 sc1
buffer_store_dwordx4 v[68:71], v64, s[8:11], s73 offen offset:2048 sc1
SA m0,s24,16384
s_nop 0
buffer_load_dwordx4 v12, s[48:51], s22 offen offset:0   lds
buffer_load_dwordx4 v13, s[48:51], s22 offen offset:1024   lds
buffer_load_dwordx4 v14, s[48:51], s22 offen offset:2048   lds
buffer_load_dwordx4 v15, s[48:51], s22 offen offset:3072   lds
s_sub_u32 s22, s22, 1048448
SA m0,s23,32768
s_nop 0
buffer_load_dwordx4 v8, s[16:19], s21 offen offset:0  nt lds
buffer_load_dwordx4 v9, s[16:19], s21 offen offset:1024  nt lds
buffer_load_dwordx4 v10, s[16:19], s21 offen offset:2048  nt lds
buffer_load_dwordx4 v11, s[16:19], s21 offen offset:3072  nt lds
SA s21,s21,128
s_mov_b64 exec, 0
s_cmp_eq_u32 s20, 0
s_cbranch_scc1 L_w_kv01
s_cmp_eq_u32 s20, 1
s_cbranch_scc1 L_w_kv02
s_cmp_eq_u32 s20, 2
s_cbranch_scc1 L_w_kv03
s_branch L_w_kv04
L_wd1:
s_mov_b64 exec, -1
s_waitcnt vmcnt(11) lgkmcnt(0)
s_barrier
R a[160:163],v5,0
R a[164:167],v6,0
T a[96:97],v1,0
T a[98:99],v1,1024
T a[100:101],v1,8192
T a[102:103],v1,9216
T a[104:105],v2,0
T a[106:107],v2,1024
T a[108:109],v2,8192
T a[110:111],v2,9216
T a[112:113],v3,0
T a[114:115],v3,1024
T a[116:117],v3,8192
T a[118:119],v3,9216
T a[120:121],v4,0
T a[122:123],v4,1024
T a[124:125],v4,8192
T a[126:127],v4,9216
T a[128:129],v1,16384
T a[130:131],v1,17408
T a[132:133],v1,24576
T a[134:135],v1,25600
T a[136:137],v2,16384
T a[138:139],v2,17408
T a[140:141],v2,24576
T a[142:143],v2,25600
T a[144:145],v3,16384
T a[146:147],v3,17408
T a[148:149],v3,24576
T a[150:151],v3,25600
T a[152:153],v4,16384
T a[154:155],v4,17408
T a[156:157],v4,24576
T a[158:159],v4,25600
s_waitcnt lgkmcnt(15)
M a[0:3],a[96:99],a[160:163],0
SA m0,s23,49152
R a[168:171],v5,2048
R a[172:175],v6,2048
M a[0:3],a[100:103],a[164:167],a[0:3]
buffer_load_dwordx4 v8, s[16:19], s21 offen offset:0  nt lds
M a[4:7],a[108:111],a[164:167],0
M a[4:7],a[104:107],a[160:163],a[4:7]
M a[8:11],a[112:115],a[160:163],0
buffer_load_dwordx4 v9, s[16:19], s21 offen offset:1024  nt lds
M a[8:11],a[116:119],a[164:167],a[8:11]
s_waitcnt lgkmcnt(14)
M a[12:15],a[124:127],a[164:167],0
M a[12:15],a[120:123],a[160:163],a[12:15]
M a[16:19],a[128:131],a[160:163],0
buffer_load_dwordx4 v10, s[16:19], s21 offen offset:2048  nt lds
M a[16:19],a[132:135],a[164:167],a[16:19]
s_waitcnt lgkmcnt(6)
M a[20:23],a[140:143],a[164:167],0
M a[20:23],a[136:139],a[160:163],a[20:23]
buffer_load_dwordx4 v11, s[16:19], s21 offen offset:3072  nt lds
M a[24:27],a[144:147],a[160:163],0
SA s21,s21,524160
M a[24:27],a[148:151],a[164:167],a[24:27]
s_waitcnt lgkmcnt(0)
M a[28:31],a[156:159],a[164:167],0
SA m0,s24,32768
M a[28:31],a[152:155],a[160:163],a[28:31]
buffer_load_dwordx4 v12, s[48:51], s22 offen offset:0   lds
M v[32:35],a[96:99],a[168:171],0
R a[160:163],v5,4096
R a[164:167],v6,4096
M v[32:35],a[100:103],a[172:175],v[32:35]
M v[36:39],a[108:111],a[172:175],0
M v[36:39],a[104:107],a[168:171],v[36:39]
buffer_load_dwordx4 v13, s[48:51], s22 offen offset:1024   lds
M v[40:43],a[112:115],a[168:171],0
M v[40:43],a[116:119],a[172:175],v[40:43]
M v[44:47],a[124:127],a[172:175],0
buffer_load_dwordx4 v14, s[48:51], s22 offen offset:2048   lds
M v[44:47],a[120:123],a[168:171],v[44:47]
M v[48:51],a[128:131],a[168:171],0
M v[48:51],a[132:135],a[172:175],v[48:51]
M v[52:55],a[140:143],a[172:175],0
buffer_load_dwordx4 v15, s[48:51], s22 offen offset:3072   lds
M v[52:55],a[136:139],a[168:171],v[52:55]
SA s22,s22,1048576
M v[56:59],a[144:147],a[168:171],0
M v[56:59],a[148:151],a[172:175],v[56:59]
s_waitcnt lgkmcnt(0)
M v[60:63],a[156:159],a[172:175],0
M v[60:63],a[152:155],a[168:171],v[60:63]
M v[64:67],a[96:99],a[160:163],0
R a[168:171],v5,6144
R a[172:175],v6,6144
M v[64:67],a[100:103],a[164:167],v[64:67]
M v[68:71],a[108:111],a[164:167],0
M v[68:71],a[104:107],a[160:163],v[68:71]
M v[72:75],a[112:115],a[160:163],0
M v[72:75],a[116:119],a[164:167],v[72:75]
M v[76:79],a[124:127],a[164:167],0
M v[76:79],a[120:123],a[160:163],v[76:79]
M v[80:83],a[128:131],a[160:163],0
M v[80:83],a[132:135],a[164:167],v[80:83]
M v[84:87],a[140:143],a[164:167],0
M v[84:87],a[136:139],a[160:163],v[84:87]
M v[88:91],a[144:147],a[160:163],0
M v[88:91],a[148:151],a[164:167],v[88:91]
s_waitcnt lgkmcnt(0)
M v[92:95],a[156:159],a[164:167],0
s_waitcnt vmcnt(12)
M v[92:95],a[152:155],a[160:163],v[92:95]
s_barrier
M v[96:99],a[96:99],a[168:171],0
SA m0,s23,0
R a[160:163],v5,16384
R a[164:167],v6,16384
M v[96:99],a[100:103],a[172:175],v[96:99]
buffer_load_dwordx4 v8, s[16:19], s21 offen offset:0  nt lds
M v[100:103],a[108:111],a[172:175],0
v_lshlrev_b32 v26, 7, v0
v_and_b32 v27, 48, v0
M v[100:103],a[104:107],a[168:171],v[100:103]
v_lshl_add_u32 v26, v27, 24, v26
M v[104:107],a[112:115],a[168:171],0
buffer_load_dwordx4 v9, s[16:19], s21 offen offset:1024  nt lds
M v[104:107],a[116:119],a[172:175],v[104:107]
M v[108:111],a[124:127],a[172:175],0
M v[108:111],a[120:123],a[168:171],v[108:111]
buffer_load_dwordx4 v10, s[16:19], s21 offen offset:2048  nt lds
M v[112:115],a[128:131],a[168:171],0
M v[112:115],a[132:135],a[172:175],v[112:115]
M v[116:119],a[140:143],a[172:175],0
M v[116:119],a[136:139],a[168:171],v[116:119]
buffer_load_dwordx4 v11, s[16:19], s21 offen offset:3072  nt lds
M v[120:123],a[144:147],a[168:171],0
SA s21,s21,128
M v[120:123],a[148:151],a[172:175],v[120:123]
s_waitcnt lgkmcnt(0)
M v[124:127],a[156:159],a[172:175],0
SA m0,s24,49152
M v[124:127],a[152:155],a[168:171],v[124:127]
buffer_load_dwordx4 v12, s[48:51], s22 offen offset:0   lds
M v[128:131],a[96:99],a[160:163],0
R a[168:171],v5,18432
R a[172:175],v6,18432
M v[128:131],a[100:103],a[164:167],v[128:131]
buffer_load_dwordx4 v13, s[48:51], s22 offen offset:1024   lds
M v[132:135],a[108:111],a[164:167],0
M v[132:135],a[104:107],a[160:163],v[132:135]
M v[136:139],a[112:115],a[160:163],0
M v[136:139],a[116:119],a[164:167],v[136:139]
buffer_load_dwordx4 v14, s[48:51], s22 offen offset:2048   lds
M v[140:143],a[124:127],a[164:167],0
M v[140:143],a[120:123],a[160:163],v[140:143]
M v[144:147],a[128:131],a[160:163],0
buffer_load_dwordx4 v15, s[48:51], s22 offen offset:3072   lds
M v[144:147],a[132:135],a[164:167],v[144:147]
s_sub_u32 s22, s22, 1048448
M v[148:151],a[140:143],a[164:167],0
M v[148:151],a[136:139],a[160:163],v[148:151]
M v[152:155],a[144:147],a[160:163],0
M v[152:155],a[148:151],a[164:167],v[152:155]
s_waitcnt lgkmcnt(0)
M v[156:159],a[156:159],a[164:167],0
s_waitcnt vmcnt(12)
M v[156:159],a[152:155],a[160:163],v[156:159]
s_barrier
M v[160:163],a[96:99],a[168:171],0
SA m0,s23,16384
R a[160:163],v5,20480
R a[164:167],v6,20480
M v[160:163],a[100:103],a[172:175],v[160:163]
T a[32:33],v1,32768
T a[34:35],v1,33792
M v[164:167],a[108:111],a[172:175],0
T a[36:37],v1,40960
T a[38:39],v1,41984
M v[164:167],a[104:107],a[168:171],v[164:167]
T a[40:41],v2,32768
T a[42:43],v2,33792
M v[168:171],a[112:115],a[168:171],0
T a[44:45],v2,40960
T a[46:47],v2,41984
M v[168:171],a[116:119],a[172:175],v[168:171]
buffer_load_dwordx4 v8, s[16:19], s21 offen offset:0  nt lds
M v[172:175],a[124:127],a[172:175],0
s_nop 0
T a[48:49],v3,32768
T a[50:51],v3,33792
M v[172:175],a[120:123],a[168:171],v[172:175]
buffer_load_dwordx4 v9, s[16:19], s21 offen offset:1024  nt lds
M v[176:179],a[128:131],a[168:171],0
s_nop 0
T a[52:53],v3,40960
T a[54:55],v3,41984
M v[176:179],a[132:135],a[172:175],v[176:179]
T a[56:57],v4,32768
T a[58:59],v4,33792
M v[180:183],a[140:143],a[172:175],0
buffer_load_dwordx4 v10, s[16:19], s21 offen offset:2048  nt lds
M v[180:183],a[136:139],a[168:171],v[180:183]
s_nop 0
T a[60:61],v4,40960
T a[62:63],v4,41984
M v[184:187],a[144:147],a[168:171],0
buffer_load_dwordx4 v11, s[16:19], s21 offen offset:3072  nt lds
M v[184:187],a[148:151],a[172:175],v[184:187]
s_waitcnt lgkmcnt(15)
s_nop 0
T a[64:65],v1,49152
T a[66:67],v1,50176
M v[188:191],a[156:159],a[172:175],0
SA s21,s21,524160
T a[68:69],v1,57344
T a[70:71],v1,58368
M v[188:191],a[152:155],a[168:171],v[188:191]
SA m0,s24,0
M v[192:195],a[96:99],a[160:163],0
R a[168:171],v5,22528
R a[172:175],v6,22528
M v[192:195],a[100:103],a[164:167],v[192:195]
T a[72:73],v2,49152
T a[74:75],v2,50176
M v[196:199],a[108:111],a[164:167],0
T a[76:77],v2,57344
T a[78:79],v2,58368
M v[196:199],a[104:107],a[160:163],v[196:199]
T a[80:81],v3,49152
T a[82:83],v3,50176
M v[200:203],a[112:115],a[160:163],0
buffer_load_dwordx4 v12, s[48:51], s22 offen offset:0   lds
M v[200:203],a[116:119],a[164:167],v[200:203]
s_nop 0
T a[84:85],v3,57344
T a[86:87],v3,58368
M v[204:207],a[124:127],a[164:167],0
T a[88:89],v4,49152
T a[90:91],v4,50176
M v[204:207],a[120:123],a[160:163],v[204:207]
buffer_load_dwordx4 v13, s[48:51], s22 offen offset:1024   lds
M v[208:211],a[128:131],a[160:163],0
s_nop 0
T a[92:93],v4,57344
T a[94:95],v4,58368
M v[208:211],a[132:135],a[164:167],v[208:211]
buffer_load_dwordx4 v14, s[48:51], s22 offen offset:2048   lds
M v[212:215],a[140:143],a[164:167],0
buffer_load_dwordx4 v15, s[48:51], s22 offen offset:3072   lds
M v[212:215],a[136:139],a[160:163],v[212:215]
SA s22,s22,1048576
M v[216:219],a[144:147],a[160:163],0
M v[216:219],a[148:151],a[164:167],v[216:219]
s_waitcnt lgkmcnt(12)
M v[220:223],a[156:159],a[164:167],0
s_waitcnt vmcnt(12) lgkmcnt(0)
M v[220:223],a[152:155],a[160:163],v[220:223]
s_barrier
M v[224:227],a[96:99],a[168:171],0
SA m0,s23,32768
R a[160:163],v5,32768
R a[164:167],v6,32768
M v[224:227],a[100:103],a[172:175],v[224:227]
buffer_load_dwordx4 v8, s[16:19], s21 offen offset:0  nt lds
M v[228:231],a[108:111],a[172:175],0
M v[228:231],a[104:107],a[168:171],v[228:231]
M v[232:235],a[112:115],a[168:171],0
buffer_load_dwordx4 v9, s[16:19], s21 offen offset:1024  nt lds
M v[232:235],a[116:119],a[172:175],v[232:235]
M v[236:239],a[124:127],a[172:175],0
M v[236:239],a[120:123],a[168:171],v[236:239]
buffer_load_dwordx4 v10, s[16:19], s21 offen offset:2048  nt lds
M v[240:243],a[128:131],a[168:171],0
M v[240:243],a[132:135],a[172:175],v[240:243]
M v[244:247],a[140:143],a[172:175],0
buffer_load_dwordx4 v11, s[16:19], s21 offen offset:3072  nt lds
M v[244:247],a[136:139],a[168:171],v[244:247]
SA s21,s21,128
M v[248:251],a[144:147],a[168:171],0
M v[248:251],a[148:151],a[172:175],v[248:251]
s_waitcnt lgkmcnt(0)
M v[252:255],a[156:159],a[172:175],0
M v[252:255],a[152:155],a[168:171],v[252:255]
M a[0:3],a[32:35],a[160:163],a[0:3]
R a[168:171],v5,34816
R a[172:175],v6,34816
M a[0:3],a[36:39],a[164:167],a[0:3]
T a[96:97],v1,0
T a[98:99],v1,1024
M a[4:7],a[44:47],a[164:167],a[4:7]
SA m0,s24,16384
M a[4:7],a[40:43],a[160:163],a[4:7]
buffer_load_dwordx4 v12, s[48:51], s22 offen offset:0   lds
M a[8:11],a[48:51],a[160:163],a[8:11]
M a[8:11],a[52:55],a[164:167],a[8:11]
M a[12:15],a[60:63],a[164:167],a[12:15]
s_nop 0
T a[100:101],v1,8192
T a[102:103],v1,9216
M a[12:15],a[56:59],a[160:163],a[12:15]
M a[16:19],a[64:67],a[160:163],a[16:19]
buffer_load_dwordx4 v13, s[48:51], s22 offen offset:1024   lds
M a[16:19],a[68:71],a[164:167],a[16:19]
M a[20:23],a[76:79],a[164:167],a[20:23]
M a[20:23],a[72:75],a[160:163],a[20:23]
s_nop 0
T a[104:105],v2,0
T a[106:107],v2,1024
M a[24:27],a[80:83],a[160:163],a[24:27]
M a[24:27],a[84:87],a[164:167],a[24:27]
s_waitcnt lgkmcnt(6)
buffer_load_dwordx4 v14, s[48:51], s22 offen offset:2048   lds
M a[28:31],a[92:95],a[164:167],a[28:31]
M a[28:31],a[88:91],a[160:163],a[28:31]
M v[32:35],a[32:35],a[168:171],v[32:35]
R a[160:163],v5,36864
R a[164:167],v6,36864
M v[32:35],a[36:39],a[172:175],v[32:35]
T a[108:109],v2,8192
T a[110:111],v2,9216
M v[36:39],a[44:47],a[172:175],v[36:39]
buffer_load_dwordx4 v15, s[48:51], s22 offen offset:3072   lds
M v[36:39],a[40:43],a[168:171],v[36:39]
s_sub_u32 s22, s22, 1048448
M v[40:43],a[48:51],a[168:171],v[40:43]
M v[40:43],a[52:55],a[172:175],v[40:43]
s_nop 0
T a[112:113],v3,0
T a[114:115],v3,1024
M v[44:47],a[60:63],a[172:175],v[44:47]
SA m0,s23,49152
M v[44:47],a[56:59],a[168:171],v[44:47]
buffer_load_dwordx4 v8, s[16:19], s21 offen offset:0  nt lds
M v[48:51],a[64:67],a[168:171],v[48:51]
M v[48:51],a[68:71],a[172:175],v[48:51]
M v[52:55],a[76:79],a[172:175],v[52:55]
s_nop 0
T a[116:117],v3,8192
T a[118:119],v3,9216
M v[52:55],a[72:75],a[168:171],v[52:55]
M v[56:59],a[80:83],a[168:171],v[56:59]
buffer_load_dwordx4 v9, s[16:19], s21 offen offset:1024  nt lds
M v[56:59],a[84:87],a[172:175],v[56:59]
s_waitcnt lgkmcnt(6)
M v[60:63],a[92:95],a[172:175],v[60:63]
M v[60:63],a[88:91],a[168:171],v[60:63]
s_nop 0
T a[120:121],v4,0
T a[122:123],v4,1024
M v[64:67],a[32:35],a[160:163],v[64:67]
R a[168:171],v5,38912
R a[172:175],v6,38912
M v[64:67],a[36:39],a[164:167],v[64:67]
buffer_load_dwordx4 v10, s[16:19], s21 offen offset:2048  nt lds
M v[68:71],a[44:47],a[164:167],v[68:71]
M v[68:71],a[40:43],a[160:163],v[68:71]
M v[72:75],a[48:51],a[160:163],v[72:75]
s_nop 0
T a[124:125],v4,8192
T a[126:127],v4,9216
M v[72:75],a[52:55],a[164:167],v[72:75]
M v[76:79],a[60:63],a[164:167],v[76:79]
buffer_load_dwordx4 v11, s[16:19], s21 offen offset:3072  nt lds
M v[76:79],a[56:59],a[160:163],v[76:79]
SA s21,s21,524160
M v[80:83],a[64:67],a[160:163],v[80:83]
M v[80:83],a[68:71],a[164:167],v[80:83]
M v[84:87],a[76:79],a[164:167],v[84:87]
M v[84:87],a[72:75],a[160:163],v[84:87]
M v[88:91],a[80:83],a[160:163],v[88:91]
M v[88:91],a[84:87],a[164:167],v[88:91]
s_waitcnt lgkmcnt(2)
M v[92:95],a[92:95],a[164:167],v[92:95]
s_waitcnt vmcnt(16) lgkmcnt(0)
M v[92:95],a[88:91],a[160:163],v[92:95]
s_barrier
M v[96:99],a[32:35],a[168:171],v[96:99]
R a[160:163],v5,49152
R a[164:167],v6,49152
M v[96:99],a[36:39],a[172:175],v[96:99]
M v[100:103],a[44:47],a[172:175],v[100:103]
SA m0,s24,32768
T a[128:129],v1,16384
T a[130:131],v1,17408
M v[100:103],a[40:43],a[168:171],v[100:103]
buffer_load_dwordx4 v12, s[48:51], s22 offen offset:0   lds
M v[104:107],a[48:51],a[168:171],v[104:107]
M v[104:107],a[52:55],a[172:175],v[104:107]
M v[108:111],a[60:63],a[172:175],v[108:111]
M v[108:111],a[56:59],a[168:171],v[108:111]
M v[112:115],a[64:67],a[168:171],v[112:115]
M v[112:115],a[68:71],a[172:175],v[112:115]
s_nop 0
T a[132:133],v1,24576
T a[134:135],v1,25600
M v[116:119],a[76:79],a[172:175],v[116:119]
buffer_load_dwordx4 v13, s[48:51], s22 offen offset:1024   lds
M v[116:119],a[72:75],a[168:171],v[116:119]
M v[120:123],a[80:83],a[168:171],v[120:123]
M v[120:123],a[84:87],a[172:175],v[120:123]
s_waitcnt lgkmcnt(4)
M v[124:127],a[92:95],a[172:175],v[124:127]
M v[124:127],a[88:91],a[168:171],v[124:127]
M v[128:131],a[32:35],a[160:163],v[128:131]
R a[168:171],v5,51200
R a[172:175],v6,51200
M v[128:131],a[36:39],a[164:167],v[128:131]
T a[136:137],v2,16384
T a[138:139],v2,17408
M v[132:135],a[44:47],a[164:167],v[132:135]
buffer_load_dwordx4 v14, s[48:51], s22 offen offset:2048   lds
M v[132:135],a[40:43],a[160:163],v[132:135]
M v[136:139],a[48:51],a[160:163],v[136:139]
M v[136:139],a[52:55],a[164:167],v[136:139]
M v[140:143],a[60:63],a[164:167],v[140:143]
M v[140:143],a[56:59],a[160:163],v[140:143]
s_nop 0
T a[140:141],v2,24576
T a[142:143],v2,25600
M v[144:147],a[64:67],a[160:163],v[144:147]
buffer_load_dwordx4 v15, s[48:51], s22 offen offset:3072   lds
M v[144:147],a[68:71],a[164:167],v[144:147]
SA s22,s22,1048576
M v[148:151],a[76:79],a[164:167],v[148:151]
M v[148:151],a[72:75],a[160:163],v[148:151]
M v[152:155],a[80:83],a[160:163],v[152:155]
M v[152:155],a[84:87],a[164:167],v[152:155]
s_waitcnt lgkmcnt(4)
M v[156:159],a[92:95],a[164:167],v[156:159]
SA m0,s23,0
T a[144:145],v3,16384
T a[146:147],v3,17408
M v[156:159],a[88:91],a[160:163],v[156:159]
buffer_load_dwordx4 v8, s[16:19], s21 offen offset:0  nt lds
M v[160:163],a[32:35],a[168:171],v[160:163]
R a[160:163],v5,53248
R a[164:167],v6,53248
M v[160:163],a[36:39],a[172:175],v[160:163]
M v[164:167],a[44:47],a[172:175],v[164:167]
M v[164:167],a[40:43],a[168:171],v[164:167]
M v[168:171],a[48:51],a[168:171],v[168:171]
M v[168:171],a[52:55],a[172:175],v[168:171]
s_nop 0
T a[148:149],v3,24576
T a[150:151],v3,25600
M v[172:175],a[60:63],a[172:175],v[172:175]
buffer_load_dwordx4 v9, s[16:19], s21 offen offset:1024  nt lds
M v[172:175],a[56:59],a[168:171],v[172:175]
M v[176:179],a[64:67],a[168:171],v[176:179]
M v[176:179],a[68:71],a[172:175],v[176:179]
M v[180:183],a[76:79],a[172:175],v[180:183]
M v[180:183],a[72:75],a[168:171],v[180:183]
M v[184:187],a[80:83],a[168:171],v[184:187]
s_nop 0
T a[152:153],v4,16384
T a[154:155],v4,17408
M v[184:187],a[84:87],a[172:175],v[184:187]
s_waitcnt lgkmcnt(4)
buffer_load_dwordx4 v10, s[16:19], s21 offen offset:2048  nt lds
M v[188:191],a[92:95],a[172:175],v[188:191]
M v[188:191],a[88:91],a[168:171],v[188:191]
M v[192:195],a[32:35],a[160:163],v[192:195]
R a[168:171],v5,55296
R a[172:175],v6,55296
M v[192:195],a[36:39],a[164:167],v[192:195]
M v[196:199],a[44:47],a[164:167],v[196:199]
M v[196:199],a[40:43],a[160:163],v[196:199]
s_nop 0
T a[156:157],v4,24576
T a[158:159],v4,25600
M v[200:203],a[48:51],a[160:163],v[200:203]
buffer_load_dwordx4 v11, s[16:19], s21 offen offset:3072  nt lds
M v[200:203],a[52:55],a[164:167],v[200:203]
SA s21,s21,128
M v[204:207],a[60:63],a[164:167],v[204:207]
M v[204:207],a[56:59],a[160:163],v[204:207]
M v[208:211],a[64:67],a[160:163],v[208:211]
M v[208:211],a[68:71],a[164:167],v[208:211]
M v[212:215],a[76:79],a[164:167],v[212:215]
M v[212:215],a[72:75],a[160:163],v[212:215]
M v[216:219],a[80:83],a[160:163],v[216:219]
M v[216:219],a[84:87],a[164:167],v[216:219]
s_waitcnt lgkmcnt(2)
M v[220:223],a[92:95],a[164:167],v[220:223]
s_waitcnt vmcnt(16) lgkmcnt(0)
M v[220:223],a[88:91],a[160:163],v[220:223]
s_barrier
M v[224:227],a[32:35],a[168:171],v[224:227]
R a[160:163],v5,0
R a[164:167],v6,0
M v[224:227],a[36:39],a[172:175],v[224:227]
v_min_u32 v16, 1, v0
v_lshlrev_b32 v16, 29, v16
M v[228:231],a[44:47],a[172:175],v[228:231]
v_or_b32 v16, s39, v16
v_mov_b32 v17, 1
M v[228:231],a[40:43],a[168:171],v[228:231]
buffer_store_dword v17, v16, s[12:15], s38 offen sc1
M v[232:235],a[48:51],a[168:171],v[232:235]
M v[232:235],a[52:55],a[172:175],v[232:235]
M v[236:239],a[60:63],a[172:175],v[236:239]
M v[236:239],a[56:59],a[168:171],v[236:239]
M v[240:243],a[64:67],a[168:171],v[240:243]
M v[240:243],a[68:71],a[172:175],v[240:243]
M v[244:247],a[76:79],a[172:175],v[244:247]
M v[244:247],a[72:75],a[168:171],v[244:247]
M v[248:251],a[80:83],a[168:171],v[248:251]
M v[248:251],a[84:87],a[172:175],v[248:251]
s_waitcnt lgkmcnt(0)
M v[252:255],a[92:95],a[172:175],v[252:255]
M v[252:255],a[88:91],a[168:171],v[252:255]
M a[0:3],a[96:99],a[160:163],a[0:3]
L_w_kv01:
s_cbranch_execz L_w_kv05
R a[168:171],v5,2048
R a[172:175],v6,2048
M a[0:3],a[100:103],a[164:167],a[0:3]
T a[32:33],v1,32768
T a[34:35],v1,33792
M a[4:7],a[108:111],a[164:167],a[4:7]
SA m0,s24,49152
M a[4:7],a[104:107],a[160:163],a[4:7]
buffer_load_dwordx4 v12, s[48:51], s22 offen offset:0   lds
M a[8:11],a[112:115],a[160:163],a[8:11]
M a[8:11],a[116:119],a[164:167],a[8:11]
M a[12:15],a[124:127],a[164:167],a[12:15]
s_nop 0
T a[36:37],v1,40960
T a[38:39],v1,41984
M a[12:15],a[120:123],a[160:163],a[12:15]
M a[16:19],a[128:131],a[160:163],a[16:19]
buffer_load_dwordx4 v13, s[48:51], s22 offen offset:1024   lds
M a[16:19],a[132:135],a[164:167],a[16:19]
M a[20:23],a[140:143],a[164:167],a[20:23]
M a[20:23],a[136:139],a[160:163],a[20:23]
s_nop 0
T a[40:41],v2,32768
T a[42:43],v2,33792
M a[24:27],a[144:147],a[160:163],a[24:27]
M a[24:27],a[148:151],a[164:167],a[24:27]
s_waitcnt lgkmcnt(6)
buffer_load_dwordx4 v14, s[48:51], s22 offen offset:2048   lds
M a[28:31],a[156:159],a[164:167],a[28:31]
M a[28:31],a[152:155],a[160:163],a[28:31]
M v[32:35],a[96:99],a[168:171],v[32:35]
R a[160:163],v5,4096
R a[164:167],v6,4096
M v[32:35],a[100:103],a[172:175],v[32:35]
T a[44:45],v2,40960
T a[46:47],v2,41984
M v[36:39],a[108:111],a[172:175],v[36:39]
buffer_load_dwordx4 v15, s[48:51], s22 offen offset:3072   lds
M v[36:39],a[104:107],a[168:171],v[36:39]
s_sub_u32 s22, s22, 1048448
M v[40:43],a[112:115],a[168:171],v[40:43]
M v[40:43],a[116:119],a[172:175],v[40:43]
s_nop 0
T a[48:49],v3,32768
T a[50:51],v3,33792
M v[44:47],a[124:127],a[172:175],v[44:47]
SA m0,s23,16384
M v[44:47],a[120:123],a[168:171],v[44:47]
buffer_load_dwordx4 v8, s[16:19], s21 offen offset:0  nt lds
M v[48:51],a[128:131],a[168:171],v[48:51]
M v[48:51],a[132:135],a[172:175],v[48:51]
M v[52:55],a[140:143],a[172:175],v[52:55]
s_nop 0
T a[52:53],v3,40960
T a[54:55],v3,41984
M v[52:55],a[136:139],a[168:171],v[52:55]
M v[56:59],a[144:147],a[168:171],v[56:59]
buffer_load_dwordx4 v9, s[16:19], s21 offen offset:1024  nt lds
M v[56:59],a[148:151],a[172:175],v[56:59]
s_waitcnt lgkmcnt(6)
M v[60:63],a[156:159],a[172:175],v[60:63]
M v[60:63],a[152:155],a[168:171],v[60:63]
s_nop 0
T a[56:57],v4,32768
T a[58:59],v4,33792
M v[64:67],a[96:99],a[160:163],v[64:67]
R a[168:171],v5,6144
R a[172:175],v6,6144
M v[64:67],a[100:103],a[164:167],v[64:67]
buffer_load_dwordx4 v10, s[16:19], s21 offen offset:2048  nt lds
M v[68:71],a[108:111],a[164:167],v[68:71]
M v[68:71],a[104:107],a[160:163],v[68:71]
M v[72:75],a[112:115],a[160:163],v[72:75]
s_nop 0
T a[60:61],v4,40960
T a[62:63],v4,41984
M v[72:75],a[116:119],a[164:167],v[72:75]
M v[76:79],a[124:127],a[164:167],v[76:79]
buffer_load_dwordx4 v11, s[16:19], s21 offen offset:3072  nt lds
M v[76:79],a[120:123],a[160:163],v[76:79]
SA s21,s21,524160
M v[80:83],a[128:131],a[160:163],v[80:83]
M v[80:83],a[132:135],a[164:167],v[80:83]
M v[84:87],a[140:143],a[164:167],v[84:87]
M v[84:87],a[136:139],a[160:163],v[84:87]
s_and_b32 s86, s41, 7
M v[88:91],a[144:147],a[160:163],v[88:91]
s_mul_i32 s86, s86, 14
s_lshr_b32 s64, s41, 3
s_mul_i32 s64, s64, 7
M v[88:91],a[148:151],a[164:167],v[88:91]
s_waitcnt lgkmcnt(2)
SA s86,s86,s64
s_min_u32 s64, s31, 6
M v[92:95],a[156:159],a[164:167],v[92:95]
s_waitcnt vmcnt(17) lgkmcnt(0)
SA s86,s86,s64
s_sub_u32 s64, 6, s31
M v[92:95],a[152:155],a[160:163],v[92:95]
s_barrier
M v[96:99],a[96:99],a[168:171],v[96:99]
R a[160:163],v5,16384
R a[164:167],v6,16384
M v[96:99],a[100:103],a[172:175],v[96:99]
s_and_b32 s88, s64, 536870912
s_mul_i32 s87, s20, 7168
M v[100:103],a[108:111],a[172:175],v[100:103]
SA m0,s24,0
T a[64:65],v1,49152
T a[66:67],v1,50176
M v[100:103],a[104:107],a[168:171],v[100:103]
buffer_load_dwordx4 v12, s[48:51], s22 offen offset:0   lds
M v[104:107],a[112:115],a[168:171],v[104:107]
SA s87,s87,131072
M v[104:107],a[116:119],a[172:175],v[104:107]
s_cmp_lt_u32 s20, 2
M v[108:111],a[124:127],a[172:175],v[108:111]
s_cselect_b64 s[72:73], s[80:81], s[82:83]
M v[108:111],a[120:123],a[168:171],v[108:111]
s_mov_b32 s60, s72
M v[112:115],a[128:131],a[168:171],v[112:115]
s_and_b32 s61, s73, 0xffff
M v[112:115],a[132:135],a[172:175],v[112:115]
s_mov_b32 s62, 1605632
T a[68:69],v1,57344
T a[70:71],v1,58368
M v[116:119],a[140:143],a[172:175],v[116:119]
s_mov_b32 s63, 0x20000
buffer_load_dwordx4 v13, s[48:51], s22 offen offset:1024   lds
M v[116:119],a[136:139],a[168:171],v[116:119]
s_mov_b32 s68, s84
M v[120:123],a[144:147],a[168:171],v[120:123]
s_and_b32 s69, s85, 0xffff
s_mov_b32 s70, 1605632
s_mov_b32 s71, 0x20000
M v[120:123],a[148:151],a[172:175],v[120:123]
s_waitcnt lgkmcnt(4)
s_lshl_b32 s89, s86, 5
M v[124:127],a[156:159],a[172:175],v[124:127]
s_and_b32 s64, s20, 1
M v[124:127],a[152:155],a[168:171],v[124:127]
s_mul_i32 s64, s64, 802816
M v[128:131],a[96:99],a[160:163],v[128:131]
SA s89,s89,s64
R a[168:171],v5,18432
R a[172:175],v6,18432
M v[128:131],a[100:103],a[164:167],v[128:131]
T a[72:73],v2,49152
T a[74:75],v2,50176
M v[132:135],a[108:111],a[164:167],v[132:135]
buffer_load_dwordx4 v14, s[48:51], s22 offen offset:2048   lds
M v[132:135],a[104:107],a[160:163],v[132:135]
v_lshrrev_b32 v28, 1, v0
v_mul_u32_u24 v28, 3584, v28
M v[136:139],a[112:115],a[160:163],v[136:139]
v_and_b32 v29, 1, v0
v_lshl_add_u32 v25, v29, 4, v28
M v[136:139],a[116:119],a[164:167],v[136:139]
v_or_b32 v25, s88, v25
M v[140:143],a[124:127],a[164:167],v[140:143]
M v[140:143],a[120:123],a[160:163],v[140:143]
s_nop 0
T a[76:77],v2,57344
T a[78:79],v2,58368
M v[144:147],a[128:131],a[160:163],v[144:147]
buffer_load_dwordx4 v15, s[48:51], s22 offen offset:3072   lds
M v[144:147],a[132:135],a[164:167],v[144:147]
SA s22,s22,1048576
M v[148:151],a[140:143],a[164:167],v[148:151]
M v[148:151],a[136:139],a[160:163],v[148:151]
M v[152:155],a[144:147],a[160:163],v[152:155]
M v[152:155],a[148:151],a[164:167],v[152:155]
s_waitcnt lgkmcnt(4)
M v[156:159],a[156:159],a[164:167],v[156:159]
SA m0,s23,32768
T a[80:81],v3,49152
T a[82:83],v3,50176
M v[156:159],a[152:155],a[160:163],v[156:159]
buffer_load_dwordx4 v8, s[16:19], s21 offen offset:0  nt lds
M v[160:163],a[96:99],a[168:171],v[160:163]
R a[160:163],v5,20480
R a[164:167],v6,20480
M v[160:163],a[100:103],a[172:175],v[160:163]
M v[164:167],a[108:111],a[172:175],v[164:167]
M v[164:167],a[104:107],a[168:171],v[164:167]
M v[168:171],a[112:115],a[168:171],v[168:171]
M v[168:171],a[116:119],a[172:175],v[168:171]
s_nop 0
T a[84:85],v3,57344
T a[86:87],v3,58368
M v[172:175],a[124:127],a[172:175],v[172:175]
buffer_load_dwordx4 v9, s[16:19], s21 offen offset:1024  nt lds
M v[172:175],a[120:123],a[168:171],v[172:175]
M v[176:179],a[128:131],a[168:171],v[176:179]
M v[176:179],a[132:135],a[172:175],v[176:179]
M v[180:183],a[140:143],a[172:175],v[180:183]
M v[180:183],a[136:139],a[168:171],v[180:183]
M v[184:187],a[144:147],a[168:171],v[184:187]
s_nop 0
T a[88:89],v4,49152
T a[90:91],v4,50176
M v[184:187],a[148:151],a[172:175],v[184:187]
s_waitcnt lgkmcnt(4)
buffer_load_dwordx4 v10, s[16:19], s21 offen offset:2048  nt lds
M v[188:191],a[156:159],a[172:175],v[188:191]
M v[188:191],a[152:155],a[168:171],v[188:191]
M v[192:195],a[96:99],a[160:163],v[192:195]
R a[168:171],v5,22528
R a[172:175],v6,22528
M v[192:195],a[100:103],a[164:167],v[192:195]
M v[196:199],a[108:111],a[164:167],v[196:199]
M v[196:199],a[104:107],a[160:163],v[196:199]
s_nop 0
T a[92:93],v4,57344
T a[94:95],v4,58368
M v[200:203],a[112:115],a[160:163],v[200:203]
buffer_load_dwordx4 v11, s[16:19], s21 offen offset:3072  nt lds
M v[200:203],a[116:119],a[164:167],v[200:203]
SA s21,s21,128
M v[204:207],a[124:127],a[164:167],v[204:207]
M v[204:207],a[120:123],a[160:163],v[204:207]
M v[208:211],a[128:131],a[160:163],v[208:211]
M v[208:211],a[132:135],a[164:167],v[208:211]
M v[212:215],a[140:143],a[164:167],v[212:215]
M v[212:215],a[136:139],a[160:163],v[212:215]
M v[216:219],a[144:147],a[160:163],v[216:219]
M v[216:219],a[148:151],a[164:167],v[216:219]
s_waitcnt lgkmcnt(2)
M v[220:223],a[156:159],a[164:167],v[220:223]
s_waitcnt vmcnt(17) lgkmcnt(0)
M v[220:223],a[152:155],a[160:163],v[220:223]
s_barrier
M v[224:227],a[96:99],a[168:171],v[224:227]
R a[160:163],v5,32768
R a[164:167],v6,32768
M v[224:227],a[100:103],a[172:175],v[224:227]
M v[228:231],a[108:111],a[172:175],v[228:231]
M v[228:231],a[104:107],a[168:171],v[228:231]
M v[232:235],a[112:115],a[168:171],v[232:235]
M v[232:235],a[116:119],a[172:175],v[232:235]
M v[236:239],a[124:127],a[172:175],v[236:239]
M v[236:239],a[120:123],a[168:171],v[236:239]
M v[240:243],a[128:131],a[168:171],v[240:243]
M v[240:243],a[132:135],a[172:175],v[240:243]
M v[244:247],a[140:143],a[172:175],v[244:247]
M v[244:247],a[136:139],a[168:171],v[244:247]
M v[248:251],a[144:147],a[168:171],v[248:251]
M v[248:251],a[148:151],a[172:175],v[248:251]
s_waitcnt lgkmcnt(0)
M v[252:255],a[156:159],a[172:175],v[252:255]
M v[252:255],a[152:155],a[168:171],v[252:255]
M a[0:3],a[32:35],a[160:163],a[0:3]
R a[168:171],v5,34816
R a[172:175],v6,34816
M a[0:3],a[36:39],a[164:167],a[0:3]
T a[96:97],v1,0
T a[98:99],v1,1024
M a[4:7],a[44:47],a[164:167],a[4:7]
SA m0,s24,16384
M a[4:7],a[40:43],a[160:163],a[4:7]
buffer_load_dwordx4 v12, s[48:51], s22 offen offset:0   lds
M a[8:11],a[48:51],a[160:163],a[8:11]
M a[8:11],a[52:55],a[164:167],a[8:11]
M a[12:15],a[60:63],a[164:167],a[12:15]
s_nop 0
T a[100:101],v1,8192
T a[102:103],v1,9216
M a[12:15],a[56:59],a[160:163],a[12:15]
M a[16:19],a[64:67],a[160:163],a[16:19]
buffer_load_dwordx4 v13, s[48:51], s22 offen offset:1024   lds
M a[16:19],a[68:71],a[164:167],a[16:19]
M a[20:23],a[76:79],a[164:167],a[20:23]
M a[20:23],a[72:75],a[160:163],a[20:23]
s_nop 0
T a[104:105],v2,0
T a[106:107],v2,1024
M a[24:27],a[80:83],a[160:163],a[24:27]
M a[24:27],a[84:87],a[164:167],a[24:27]
s_waitcnt lgkmcnt(6)
buffer_load_dwordx4 v14, s[48:51], s22 offen offset:2048   lds
M a[28:31],a[92:95],a[164:167],a[28:31]
M a[28:31],a[88:91],a[160:163],a[28:31]
M v[32:35],a[32:35],a[168:171],v[32:35]
R a[160:163],v5,36864
R a[164:167],v6,36864
M v[32:35],a[36:39],a[172:175],v[32:35]
T a[108:109],v2,8192
T a[110:111],v2,9216
M v[36:39],a[44:47],a[172:175],v[36:39]
buffer_load_dwordx4 v15, s[48:51], s22 offen offset:3072   lds
M v[36:39],a[40:43],a[168:171],v[36:39]
s_sub_u32 s22, s22, 1048448
M v[40:43],a[48:51],a[168:171],v[40:43]
M v[40:43],a[52:55],a[172:175],v[40:43]
s_nop 0
T a[112:113],v3,0
T a[114:115],v3,1024
M v[44:47],a[60:63],a[172:175],v[44:47]
SA m0,s23,49152
M v[44:47],a[56:59],a[168:171],v[44:47]
buffer_load_dwordx4 v8, s[16:19], s21 offen offset:0  nt lds
M v[48:51],a[64:67],a[168:171],v[48:51]
M v[48:51],a[68:71],a[172:175],v[48:51]
M v[52:55],a[76:79],a[172:175],v[52:55]
s_nop 0
T a[116:117],v3,8192
T a[118:119],v3,9216
M v[52:55],a[72:75],a[168:171],v[52:55]
M v[56:59],a[80:83],a[168:171],v[56:59]
buffer_load_dwordx4 v9, s[16:19], s21 offen offset:1024  nt lds
M v[56:59],a[84:87],a[172:175],v[56:59]
s_waitcnt lgkmcnt(6)
M v[60:63],a[92:95],a[172:175],v[60:63]
M v[60:63],a[88:91],a[168:171],v[60:63]
s_nop 0
T a[120:121],v4,0
T a[122:123],v4,1024
M v[64:67],a[32:35],a[160:163],v[64:67]
R a[168:171],v5,38912
R a[172:175],v6,38912
M v[64:67],a[36:39],a[164:167],v[64:67]
buffer_load_dwordx4 v10, s[16:19], s21 offen offset:2048  nt lds
M v[68:71],a[44:47],a[164:167],v[68:71]
M v[68:71],a[40:43],a[160:163],v[68:71]
M v[72:75],a[48:51],a[160:163],v[72:75]
s_nop 0
T a[124:125],v4,8192
T a[126:127],v4,9216
M v[72:75],a[52:55],a[164:167],v[72:75]
M v[76:79],a[60:63],a[164:167],v[76:79]
buffer_load_dwordx4 v11, s[16:19], s21 offen offset:3072  nt lds
M v[76:79],a[56:59],a[160:163],v[76:79]
SA s21,s21,524160
M v[80:83],a[64:67],a[160:163],v[80:83]
M v[80:83],a[68:71],a[164:167],v[80:83]
M v[84:87],a[76:79],a[164:167],v[84:87]
M v[84:87],a[72:75],a[160:163],v[84:87]
M v[88:91],a[80:83],a[160:163],v[88:91]
M v[88:91],a[84:87],a[164:167],v[88:91]
s_waitcnt lgkmcnt(2)
M v[92:95],a[92:95],a[164:167],v[92:95]
s_waitcnt vmcnt(16) lgkmcnt(0)
M v[92:95],a[88:91],a[160:163],v[92:95]
s_barrier
M v[96:99],a[32:35],a[168:171],v[96:99]
R a[160:163],v5,49152
R a[164:167],v6,49152
M v[96:99],a[36:39],a[172:175],v[96:99]
M v[100:103],a[44:47],a[172:175],v[100:103]
SA m0,s24,32768
T a[128:129],v1,16384
T a[130:131],v1,17408
M v[100:103],a[40:43],a[168:171],v[100:103]
buffer_load_dwordx4 v12, s[48:51], s22 offen offset:0   lds
M v[104:107],a[48:51],a[168:171],v[104:107]
v_min_u32 v16, 40, v0
v_lshlrev_b32 v16, 2, v16
M v[104:107],a[52:55],a[172:175],v[104:107]
buffer_load_dword v17, v16, s[12:15], 0 offen sc1
M v[108:111],a[60:63],a[172:175],v[108:111]
M v[108:111],a[56:59],a[168:171],v[108:111]
M v[112:115],a[64:67],a[168:171],v[112:115]
buffer_load_dwordx4 v13, s[48:51], s22 offen offset:1024   lds
M v[112:115],a[68:71],a[172:175],v[112:115]
s_nop 0
T a[132:133],v1,24576
T a[134:135],v1,25600
M v[116:119],a[76:79],a[172:175],v[116:119]
M v[116:119],a[72:75],a[168:171],v[116:119]
M v[120:123],a[80:83],a[168:171],v[120:123]
M v[120:123],a[84:87],a[172:175],v[120:123]
s_waitcnt lgkmcnt(4)
M v[124:127],a[92:95],a[172:175],v[124:127]
buffer_load_dwordx4 v14, s[48:51], s22 offen offset:2048   lds
M v[124:127],a[88:91],a[168:171],v[124:127]
M v[128:131],a[32:35],a[160:163],v[128:131]
R a[168:171],v5,51200
R a[172:175],v6,51200
M v[128:131],a[36:39],a[164:167],v[128:131]
T a[136:137],v2,16384
T a[138:139],v2,17408
M v[132:135],a[44:47],a[164:167],v[132:135]
M v[132:135],a[40:43],a[160:163],v[132:135]
M v[136:139],a[48:51],a[160:163],v[136:139]
buffer_load_dwordx4 v15, s[48:51], s22 offen offset:3072   lds
M v[136:139],a[52:55],a[164:167],v[136:139]
SA s22,s22,1048576
M v[140:143],a[60:63],a[164:167],v[140:143]
M v[140:143],a[56:59],a[160:163],v[140:143]
s_nop 0
T a[140:141],v2,24576
T a[142:143],v2,25600
M v[144:147],a[64:67],a[160:163],v[144:147]
SA m0,s23,0
M v[144:147],a[68:71],a[164:167],v[144:147]
buffer_load_dwordx4 v8, s[16:19], s21 offen offset:0  nt lds
M v[148:151],a[76:79],a[164:167],v[148:151]
M v[148:151],a[72:75],a[160:163],v[148:151]
M v[152:155],a[80:83],a[160:163],v[152:155]
M v[152:155],a[84:87],a[164:167],v[152:155]
s_waitcnt lgkmcnt(4)
M v[156:159],a[92:95],a[164:167],v[156:159]
s_nop 0
T a[144:145],v3,16384
T a[146:147],v3,17408
M v[156:159],a[88:91],a[160:163],v[156:159]
buffer_load_dwordx4 v9, s[16:19], s21 offen offset:1024  nt lds
M v[160:163],a[32:35],a[168:171],v[160:163]
R a[160:163],v5,53248
R a[164:167],v6,53248
M v[160:163],a[36:39],a[172:175],v[160:163]
M v[164:167],a[44:47],a[172:175],v[164:167]
M v[164:167],a[40:43],a[168:171],v[164:167]
M v[168:171],a[48:51],a[168:171],v[168:171]
M v[168:171],a[52:55],a[172:175],v[168:171]
s_nop 0
T a[148:149],v3,24576
T a[150:151],v3,25600
M v[172:175],a[60:63],a[172:175],v[172:175]
buffer_load_dwordx4 v10, s[16:19], s21 offen offset:2048  nt lds
M v[172:175],a[56:59],a[168:171],v[172:175]
M v[176:179],a[64:67],a[168:171],v[176:179]
M v[176:179],a[68:71],a[172:175],v[176:179]
M v[180:183],a[76:79],a[172:175],v[180:183]
buffer_load_dwordx4 v11, s[16:19], s21 offen offset:3072  nt lds
M v[180:183],a[72:75],a[168:171],v[180:183]
SA s21,s21,128
M v[184:187],a[80:83],a[168:171],v[184:187]
s_nop 0
T a[152:153],v4,16384
T a[154:155],v4,17408
M v[184:187],a[84:87],a[172:175],v[184:187]
s_waitcnt lgkmcnt(4)
M v[188:191],a[92:95],a[172:175],v[188:191]
M v[188:191],a[88:91],a[168:171],v[188:191]
SA m0,s87,0
M v[192:195],a[32:35],a[160:163],v[192:195]
R a[168:171],v5,55296
R a[172:175],v6,55296
M v[192:195],a[36:39],a[164:167],v[192:195]
buffer_load_dwordx4 v25, s[60:63], s89 offen offset:0 nt lds
M v[196:199],a[44:47],a[164:167],v[196:199]
SA s89,s89,114688
M v[196:199],a[40:43],a[160:163],v[196:199]
s_nop 0
T a[156:157],v4,24576
T a[158:159],v4,25600
M v[200:203],a[48:51],a[160:163],v[200:203]
M v[200:203],a[52:55],a[164:167],v[200:203]
SA m0,s87,1024
M v[204:207],a[60:63],a[164:167],v[204:207]
buffer_load_dwordx4 v25, s[60:63], s89 offen offset:0 nt lds
M v[204:207],a[56:59],a[160:163],v[204:207]
SA s89,s89,114688
M v[208:211],a[64:67],a[160:163],v[208:211]
M v[208:211],a[68:71],a[164:167],v[208:211]
M v[212:215],a[76:79],a[164:167],v[212:215]
M v[212:215],a[72:75],a[160:163],v[212:215]
M v[216:219],a[80:83],a[160:163],v[216:219]
M v[216:219],a[84:87],a[164:167],v[216:219]
s_waitcnt lgkmcnt(2)
M v[220:223],a[92:95],a[164:167],v[220:223]
s_waitcnt vmcnt(19) lgkmcnt(0)
M v[220:223],a[88:91],a[160:163],v[220:223]
s_barrier
M v[224:227],a[32:35],a[168:171],v[224:227]
R a[160:163],v5,0
R a[164:167],v6,0
M v[224:227],a[36:39],a[172:175],v[224:227]
M v[228:231],a[44:47],a[172:175],v[228:231]
M v[228:231],a[40:43],a[168:171],v[228:231]
M v[232:235],a[48:51],a[168:171],v[232:235]
M v[232:235],a[52:55],a[172:175],v[232:235]
M v[236:239],a[60:63],a[172:175],v[236:239]
M v[236:239],a[56:59],a[168:171],v[236:239]
M v[240:243],a[64:67],a[168:171],v[240:243]
M v[240:243],a[68:71],a[172:175],v[240:243]
M v[244:247],a[76:79],a[172:175],v[244:247]
M v[244:247],a[72:75],a[168:171],v[244:247]
M v[248:251],a[80:83],a[168:171],v[248:251]
M v[248:251],a[84:87],a[172:175],v[248:251]
s_waitcnt lgkmcnt(0)
M v[252:255],a[92:95],a[172:175],v[252:255]
M v[252:255],a[88:91],a[168:171],v[252:255]
M a[0:3],a[96:99],a[160:163],a[0:3]
R a[168:171],v5,2048
R a[172:175],v6,2048
M a[0:3],a[100:103],a[164:167],a[0:3]
T a[32:33],v1,32768
T a[34:35],v1,33792
M a[4:7],a[108:111],a[164:167],a[4:7]
SA m0,s24,49152
M a[4:7],a[104:107],a[160:163],a[4:7]
buffer_load_dwordx4 v12, s[48:51], s22 offen offset:0   lds
M a[8:11],a[112:115],a[160:163],a[8:11]
M a[8:11],a[116:119],a[164:167],a[8:11]
M a[12:15],a[124:127],a[164:167],a[12:15]
s_nop 0
T a[36:37],v1,40960
T a[38:39],v1,41984
M a[12:15],a[120:123],a[160:163],a[12:15]
M a[16:19],a[128:131],a[160:163],a[16:19]
buffer_load_dwordx4 v13, s[48:51], s22 offen offset:1024   lds
M a[16:19],a[132:135],a[164:167],a[16:19]
M a[20:23],a[140:143],a[164:167],a[20:23]
M a[20:23],a[136:139],a[160:163],a[20:23]
s_nop 0
T a[40:41],v2,32768
T a[42:43],v2,33792
M a[24:27],a[144:147],a[160:163],a[24:27]
M a[24:27],a[148:151],a[164:167],a[24:27]
s_waitcnt lgkmcnt(6)
buffer_load_dwordx4 v14, s[48:51], s22 offen offset:2048   lds
M a[28:31],a[156:159],a[164:167],a[28:31]
M a[28:31],a[152:155],a[160:163],a[28:31]
M v[32:35],a[96:99],a[168:171],v[32:35]
R a[160:163],v5,4096
R a[164:167],v6,4096
M v[32:35],a[100:103],a[172:175],v[32:35]
T a[44:45],v2,40960
T a[46:47],v2,41984
M v[36:39],a[108:111],a[172:175],v[36:39]
buffer_load_dwordx4 v15, s[48:51], s22 offen offset:3072   lds
M v[36:39],a[104:107],a[168:171],v[36:39]
s_sub_u32 s22, s22, 1048448
M v[40:43],a[112:115],a[168:171],v[40:43]
M v[40:43],a[116:119],a[172:175],v[40:43]
s_nop 0
T a[48:49],v3,32768
T a[50:51],v3,33792
M v[44:47],a[124:127],a[172:175],v[44:47]
SA m0,s23,16384
M v[44:47],a[120:123],a[168:171],v[44:47]
buffer_load_dwordx4 v8, s[16:19], s21 offen offset:0  nt lds
M v[48:51],a[128:131],a[168:171],v[48:51]
M v[48:51],a[132:135],a[172:175],v[48:51]
M v[52:55],a[140:143],a[172:175],v[52:55]
s_nop 0
T a[52:53],v3,40960
T a[54:55],v3,41984
M v[52:55],a[136:139],a[168:171],v[52:55]
M v[56:59],a[144:147],a[168:171],v[56:59]
buffer_load_dwordx4 v9, s[16:19], s21 offen offset:1024  nt lds
M v[56:59],a[148:151],a[172:175],v[56:59]
s_waitcnt lgkmcnt(6)
M v[60:63],a[156:159],a[172:175],v[60:63]
M v[60:63],a[152:155],a[168:171],v[60:63]
s_nop 0
T a[56:57],v4,32768
L_w_kv02:
s_cbranch_execz L_w_kv06
T a[58:59],v4,33792
M v[64:67],a[96:99],a[160:163],v[64:67]
R a[168:171],v5,6144
R a[172:175],v6,6144
M v[64:67],a[100:103],a[164:167],v[64:67]
buffer_load_dwordx4 v10, s[16:19], s21 offen offset:2048  nt lds
M v[68:71],a[108:111],a[164:167],v[68:71]
M v[68:71],a[104:107],a[160:163],v[68:71]
M v[72:75],a[112:115],a[160:163],v[72:75]
s_nop 0
T a[60:61],v4,40960
T a[62:63],v4,41984
M v[72:75],a[116:119],a[164:167],v[72:75]
M v[76:79],a[124:127],a[164:167],v[76:79]
buffer_load_dwordx4 v11, s[16:19], s21 offen offset:3072  nt lds
M v[76:79],a[120:123],a[160:163],v[76:79]
SA s21,s21,524160
M v[80:83],a[128:131],a[160:163],v[80:83]
M v[80:83],a[132:135],a[164:167],v[80:83]
M v[84:87],a[140:143],a[164:167],v[84:87]
M v[84:87],a[136:139],a[160:163],v[84:87]
M v[88:91],a[144:147],a[160:163],v[88:91]
M v[88:91],a[148:151],a[164:167],v[88:91]
s_waitcnt lgkmcnt(2)
M v[92:95],a[156:159],a[164:167],v[92:95]
s_waitcnt vmcnt(19) lgkmcnt(0)
M v[92:95],a[152:155],a[160:163],v[92:95]
s_barrier
M v[96:99],a[96:99],a[168:171],v[96:99]
R a[160:163],v5,16384
R a[164:167],v6,16384
M v[96:99],a[100:103],a[172:175],v[96:99]
M v[100:103],a[108:111],a[172:175],v[100:103]
SA m0,s24,0
T a[64:65],v1,49152
T a[66:67],v1,50176
M v[100:103],a[104:107],a[168:171],v[100:103]
buffer_load_dwordx4 v12, s[48:51], s22 offen offset:0   lds
M v[104:107],a[112:115],a[168:171],v[104:107]
M v[104:107],a[116:119],a[172:175],v[104:107]
M v[108:111],a[124:127],a[172:175],v[108:111]
M v[108:111],a[120:123],a[168:171],v[108:111]
M v[112:115],a[128:131],a[168:171],v[112:115]
buffer_load_dwordx4 v13, s[48:51], s22 offen offset:1024   lds
M v[112:115],a[132:135],a[172:175],v[112:115]
s_nop 0
T a[68:69],v1,57344
T a[70:71],v1,58368
M v[116:119],a[140:143],a[172:175],v[116:119]
M v[116:119],a[136:139],a[168:171],v[116:119]
M v[120:123],a[144:147],a[168:171],v[120:123]
M v[120:123],a[148:151],a[172:175],v[120:123]
s_waitcnt lgkmcnt(4)
M v[124:127],a[156:159],a[172:175],v[124:127]
buffer_load_dwordx4 v14, s[48:51], s22 offen offset:2048   lds
M v[124:127],a[152:155],a[168:171],v[124:127]
M v[128:131],a[96:99],a[160:163],v[128:131]
R a[168:171],v5,18432
R a[172:175],v6,18432
M v[128:131],a[100:103],a[164:167],v[128:131]
T a[72:73],v2,49152
T a[74:75],v2,50176
M v[132:135],a[108:111],a[164:167],v[132:135]
M v[132:135],a[104:107],a[160:163],v[132:135]
M v[136:139],a[112:115],a[160:163],v[136:139]
buffer_load_dwordx4 v15, s[48:51], s22 offen offset:3072   lds
M v[136:139],a[116:119],a[164:167],v[136:139]
SA s22,s22,1048576
M v[140:143],a[124:127],a[164:167],v[140:143]
M v[140:143],a[120:123],a[160:163],v[140:143]
s_nop 0
T a[76:77],v2,57344
T a[78:79],v2,58368
M v[144:147],a[128:131],a[160:163],v[144:147]
SA m0,s23,32768
M v[144:147],a[132:135],a[164:167],v[144:147]
buffer_load_dwordx4 v8, s[16:19], s21 offen offset:0  nt lds
M v[148:151],a[140:143],a[164:167],v[148:151]
M v[148:151],a[136:139],a[160:163],v[148:151]
M v[152:155],a[144:147],a[160:163],v[152:155]
M v[152:155],a[148:151],a[164:167],v[152:155]
s_waitcnt lgkmcnt(4)
M v[156:159],a[156:159],a[164:167],v[156:159]
s_nop 0
T a[80:81],v3,49152
T a[82:83],v3,50176
M v[156:159],a[152:155],a[160:163],v[156:159]
buffer_load_dwordx4 v9, s[16:19], s21 offen offset:1024  nt lds
M v[160:163],a[96:99],a[168:171],v[160:163]
R a[160:163],v5,20480
R a[164:167],v6,20480
M v[160:163],a[100:103],a[172:175],v[160:163]
M v[164:167],a[108:111],a[172:175],v[164:167]
M v[164:167],a[104:107],a[168:171],v[164:167]
M v[168:171],a[112:115],a[168:171],v[168:171]
M v[168:171],a[116:119],a[172:175],v[168:171]
s_nop 0
T a[84:85],v3,57344
T a[86:87],v3,58368
M v[172:175],a[124:127],a[172:175],v[172:175]
buffer_load_dwordx4 v10, s[16:19], s21 offen offset:2048  nt lds
M v[172:175],a[120:123],a[168:171],v[172:175]
M v[176:179],a[128:131],a[168:171],v[176:179]
M v[176:179],a[132:135],a[172:175],v[176:179]
M v[180:183],a[140:143],a[172:175],v[180:183]
buffer_load_dwordx4 v11, s[16:19], s21 offen offset:3072  nt lds
M v[180:183],a[136:139],a[168:171],v[180:183]
SA s21,s21,128
M v[184:187],a[144:147],a[168:171],v[184:187]
s_nop 0
T a[88:89],v4,49152
T a[90:91],v4,50176
M v[184:187],a[148:151],a[172:175],v[184:187]
s_waitcnt lgkmcnt(4)
M v[188:191],a[156:159],a[172:175],v[188:191]
M v[188:191],a[152:155],a[168:171],v[188:191]
SA m0,s87,2048
M v[192:195],a[96:99],a[160:163],v[192:195]
R a[168:171],v5,22528
R a[172:175],v6,22528
M v[192:195],a[100:103],a[164:167],v[192:195]
buffer_load_dwordx4 v25, s[60:63], s89 offen offset:0 nt lds
M v[196:199],a[108:111],a[164:167],v[196:199]
SA s89,s89,114688
M v[196:199],a[104:107],a[160:163],v[196:199]
s_nop 0
T a[92:93],v4,57344
T a[94:95],v4,58368
M v[200:203],a[112:115],a[160:163],v[200:203]
M v[200:203],a[116:119],a[164:167],v[200:203]
SA m0,s87,3072
M v[204:207],a[124:127],a[164:167],v[204:207]
buffer_load_dwordx4 v25, s[60:63], s89 offen offset:0 nt lds
M v[204:207],a[120:123],a[160:163],v[204:207]
SA s89,s89,114688
M v[208:211],a[128:131],a[160:163],v[208:211]
M v[208:211],a[132:135],a[164:167],v[208:211]
M v[212:215],a[140:143],a[164:167],v[212:215]
M v[212:215],a[136:139],a[160:163],v[212:215]
M v[216:219],a[144:147],a[160:163],v[216:219]
M v[216:219],a[148:151],a[164:167],v[216:219]
s_waitcnt lgkmcnt(2)
M v[220:223],a[156:159],a[164:167],v[220:223]
s_waitcnt vmcnt(20) lgkmcnt(0)
M v[220:223],a[152:155],a[160:163],v[220:223]
s_barrier
M v[224:227],a[96:99],a[168:171],v[224:227]
R a[160:163],v5,32768
R a[164:167],v6,32768
M v[224:227],a[100:103],a[172:175],v[224:227]
v_cmp_ne_u32 vcc, 1, v17
M v[228:231],a[108:111],a[172:175],v[228:231]
s_nop 0
M v[228:231],a[104:107],a[168:171],v[228:231]
s_cbranch_vccnz L_zs0
L_zr0:
M v[232:235],a[112:115],a[168:171],v[232:235]
M v[232:235],a[116:119],a[172:175],v[232:235]
M v[236:239],a[124:127],a[172:175],v[236:239]
M v[236:239],a[120:123],a[168:171],v[236:239]
M v[240:243],a[128:131],a[168:171],v[240:243]
M v[240:243],a[132:135],a[172:175],v[240:243]
M v[244:247],a[140:143],a[172:175],v[244:247]
M v[244:247],a[136:139],a[168:171],v[244:247]
M v[248:251],a[144:147],a[168:171],v[248:251]
M v[248:251],a[148:151],a[172:175],v[248:251]
s_waitcnt lgkmcnt(0)
M v[252:255],a[156:159],a[172:175],v[252:255]
M v[252:255],a[152:155],a[168:171],v[252:255]
M a[0:3],a[32:35],a[160:163],a[0:3]
R a[168:171],v5,34816
R a[172:175],v6,34816
M a[0:3],a[36:39],a[164:167],a[0:3]
T a[96:97],v1,0
T a[98:99],v1,1024
M a[4:7],a[44:47],a[164:167],a[4:7]
SA m0,s24,16384
M a[4:7],a[40:43],a[160:163],a[4:7]
buffer_load_dwordx4 v12, s[48:51], s22 offen offset:0   lds
M a[8:11],a[48:51],a[160:163],a[8:11]
M a[8:11],a[52:55],a[164:167],a[8:11]
s_mul_i32 s64, s41, 229376
M a[12:15],a[60:63],a[164:167],a[12:15]
SA s72,s90,s64
T a[100:101],v1,8192
T a[102:103],v1,9216
M a[12:15],a[56:59],a[160:163],a[12:15]
s_addc_u32 s73, s91, 0
M a[16:19],a[64:67],a[160:163],a[16:19]
s_sub_u32 s75, 3670016, s64
buffer_load_dwordx4 v13, s[48:51], s22 offen offset:1024   lds
M a[16:19],a[68:71],a[164:167],a[16:19]
s_mov_b32 s12, s72
M a[20:23],a[76:79],a[164:167],a[20:23]
s_and_b32 s13, s73, 0xffff
M a[20:23],a[72:75],a[160:163],a[20:23]
s_mov_b32 s14, s75
T a[104:105],v2,0
T a[106:107],v2,1024
M a[24:27],a[80:83],a[160:163],a[24:27]
s_mov_b32 s15, 0x20000
M a[24:27],a[84:87],a[164:167],a[24:27]
s_waitcnt lgkmcnt(6)
buffer_load_dwordx4 v14, s[48:51], s22 offen offset:2048   lds
M a[28:31],a[92:95],a[164:167],a[28:31]
M a[28:31],a[88:91],a[160:163],a[28:31]
M v[32:35],a[32:35],a[168:171],v[32:35]
R a[160:163],v5,36864
R a[164:167],v6,36864
M v[32:35],a[36:39],a[172:175],v[32:35]
T a[108:109],v2,8192
T a[110:111],v2,9216
M v[36:39],a[44:47],a[172:175],v[36:39]
buffer_load_dwordx4 v15, s[48:51], s22 offen offset:3072   lds
M v[36:39],a[40:43],a[168:171],v[36:39]
s_sub_u32 s22, s22, 1048448
M v[40:43],a[48:51],a[168:171],v[40:43]
M v[40:43],a[52:55],a[172:175],v[40:43]
s_nop 0
T a[112:113],v3,0
T a[114:115],v3,1024
M v[44:47],a[60:63],a[172:175],v[44:47]
SA m0,s23,49152
M v[44:47],a[56:59],a[168:171],v[44:47]
buffer_load_dwordx4 v8, s[16:19], s21 offen offset:0  nt lds
M v[48:51],a[64:67],a[168:171],v[48:51]
M v[48:51],a[68:71],a[172:175],v[48:51]
M v[52:55],a[76:79],a[172:175],v[52:55]
s_nop 0
T a[116:117],v3,8192
T a[118:119],v3,9216
M v[52:55],a[72:75],a[168:171],v[52:55]
M v[56:59],a[80:83],a[168:171],v[56:59]
buffer_load_dwordx4 v9, s[16:19], s21 offen offset:1024  nt lds
M v[56:59],a[84:87],a[172:175],v[56:59]
s_waitcnt lgkmcnt(6)
M v[60:63],a[92:95],a[172:175],v[60:63]
M v[60:63],a[88:91],a[168:171],v[60:63]
s_nop 0
T a[120:121],v4,0
T a[122:123],v4,1024
M v[64:67],a[32:35],a[160:163],v[64:67]
R a[168:171],v5,38912
R a[172:175],v6,38912
M v[64:67],a[36:39],a[164:167],v[64:67]
buffer_load_dwordx4 v10, s[16:19], s21 offen offset:2048  nt lds
M v[68:71],a[44:47],a[164:167],v[68:71]
M v[68:71],a[40:43],a[160:163],v[68:71]
M v[72:75],a[48:51],a[160:163],v[72:75]
s_nop 0
T a[124:125],v4,8192
T a[126:127],v4,9216
M v[72:75],a[52:55],a[164:167],v[72:75]
M v[76:79],a[60:63],a[164:167],v[76:79]
buffer_load_dwordx4 v11, s[16:19], s21 offen offset:3072  nt lds
M v[76:79],a[56:59],a[160:163],v[76:79]
SA s21,s21,524160
M v[80:83],a[64:67],a[160:163],v[80:83]
M v[80:83],a[68:71],a[164:167],v[80:83]
M v[84:87],a[76:79],a[164:167],v[84:87]
M v[84:87],a[72:75],a[160:163],v[84:87]
M v[88:91],a[80:83],a[160:163],v[88:91]
M v[88:91],a[84:87],a[164:167],v[88:91]
s_waitcnt lgkmcnt(2)
M v[92:95],a[92:95],a[164:167],v[92:95]
s_waitcnt vmcnt(18) lgkmcnt(0)
M v[92:95],a[88:91],a[160:163],v[92:95]
s_barrier
M v[96:99],a[32:35],a[168:171],v[96:99]
R a[160:163],v5,49152
R a[164:167],v6,49152
M v[96:99],a[36:39],a[172:175],v[96:99]
M v[100:103],a[44:47],a[172:175],v[100:103]
SA m0,s24,32768
T a[128:129],v1,16384
T a[130:131],v1,17408
M v[100:103],a[40:43],a[168:171],v[100:103]
buffer_load_dwordx4 v12, s[48:51], s22 offen offset:0   lds
M v[104:107],a[48:51],a[168:171],v[104:107]
M v[104:107],a[52:55],a[172:175],v[104:107]
M v[108:111],a[60:63],a[172:175],v[108:111]
M v[108:111],a[56:59],a[168:171],v[108:111]
M v[112:115],a[64:67],a[168:171],v[112:115]
buffer_load_dwordx4 v13, s[48:51], s22 offen offset:1024   lds
M v[112:115],a[68:71],a[172:175],v[112:115]
s_nop 0
T a[132:133],v1,24576
T a[134:135],v1,25600
M v[116:119],a[76:79],a[172:175],v[116:119]
M v[116:119],a[72:75],a[168:171],v[116:119]
M v[120:123],a[80:83],a[168:171],v[120:123]
M v[120:123],a[84:87],a[172:175],v[120:123]
s_waitcnt lgkmcnt(4)
M v[124:127],a[92:95],a[172:175],v[124:127]
buffer_load_dwordx4 v14, s[48:51], s22 offen offset:2048   lds
M v[124:127],a[88:91],a[168:171],v[124:127]
M v[128:131],a[32:35],a[160:163],v[128:131]
R a[168:171],v5,51200
R a[172:175],v6,51200
M v[128:131],a[36:39],a[164:167],v[128:131]
T a[136:137],v2,16384
T a[138:139],v2,17408
M v[132:135],a[44:47],a[164:167],v[132:135]
M v[132:135],a[40:43],a[160:163],v[132:135]
M v[136:139],a[48:51],a[160:163],v[136:139]
buffer_load_dwordx4 v15, s[48:51], s22 offen offset:3072   lds
M v[136:139],a[52:55],a[164:167],v[136:139]
SA s22,s22,1048576
M v[140:143],a[60:63],a[164:167],v[140:143]
M v[140:143],a[56:59],a[160:163],v[140:143]
s_nop 0
T a[140:141],v2,24576
T a[142:143],v2,25600
M v[144:147],a[64:67],a[160:163],v[144:147]
SA m0,s23,0
M v[144:147],a[68:71],a[164:167],v[144:147]
buffer_load_dwordx4 v8, s[16:19], s21 offen offset:0  nt lds
M v[148:151],a[76:79],a[164:167],v[148:151]
M v[148:151],a[72:75],a[160:163],v[148:151]
M v[152:155],a[80:83],a[160:163],v[152:155]
M v[152:155],a[84:87],a[164:167],v[152:155]
s_waitcnt lgkmcnt(4)
M v[156:159],a[92:95],a[164:167],v[156:159]
s_nop 0
T a[144:145],v3,16384
T a[146:147],v3,17408
M v[156:159],a[88:91],a[160:163],v[156:159]
buffer_load_dwordx4 v9, s[16:19], s21 offen offset:1024  nt lds
M v[160:163],a[32:35],a[168:171],v[160:163]
R a[160:163],v5,53248
R a[164:167],v6,53248
M v[160:163],a[36:39],a[172:175],v[160:163]
M v[164:167],a[44:47],a[172:175],v[164:167]
M v[164:167],a[40:43],a[168:171],v[164:167]
M v[168:171],a[48:51],a[168:171],v[168:171]
M v[168:171],a[52:55],a[172:175],v[168:171]
s_nop 0
T a[148:149],v3,24576
T a[150:151],v3,25600
M v[172:175],a[60:63],a[172:175],v[172:175]
buffer_load_dwordx4 v10, s[16:19], s21 offen offset:2048  nt lds
M v[172:175],a[56:59],a[168:171],v[172:175]
M v[176:179],a[64:67],a[168:171],v[176:179]
M v[176:179],a[68:71],a[172:175],v[176:179]
M v[180:183],a[76:79],a[172:175],v[180:183]
buffer_load_dwordx4 v11, s[16:19], s21 offen offset:3072  nt lds
M v[180:183],a[72:75],a[168:171],v[180:183]
SA s21,s21,128
M v[184:187],a[80:83],a[168:171],v[184:187]
s_nop 0
T a[152:153],v4,16384
T a[154:155],v4,17408
M v[184:187],a[84:87],a[172:175],v[184:187]
s_waitcnt lgkmcnt(4)
M v[188:191],a[92:95],a[172:175],v[188:191]
M v[188:191],a[88:91],a[168:171],v[188:191]
SA m0,s87,4096
M v[192:195],a[32:35],a[160:163],v[192:195]
R a[168:171],v5,55296
R a[172:175],v6,55296
M v[192:195],a[36:39],a[164:167],v[192:195]
buffer_load_dwordx4 v25, s[60:63], s89 offen offset:0 nt lds
M v[196:199],a[44:47],a[164:167],v[196:199]
SA s89,s89,114688
M v[196:199],a[40:43],a[160:163],v[196:199]
s_nop 0
T a[156:157],v4,24576
T a[158:159],v4,25600
M v[200:203],a[48:51],a[160:163],v[200:203]
M v[200:203],a[52:55],a[164:167],v[200:203]
SA m0,s87,5120
M v[204:207],a[60:63],a[164:167],v[204:207]
buffer_load_dwordx4 v25, s[60:63], s89 offen offset:0 nt lds
M v[204:207],a[56:59],a[160:163],v[204:207]
SA s89,s89,114688
M v[208:211],a[64:67],a[160:163],v[208:211]
M v[208:211],a[68:71],a[164:167],v[208:211]
M v[212:215],a[76:79],a[164:167],v[212:215]
M v[212:215],a[72:75],a[160:163],v[212:215]
M v[216:219],a[80:83],a[160:163],v[216:219]
M v[216:219],a[84:87],a[164:167],v[216:219]
s_waitcnt lgkmcnt(2)
M v[220:223],a[92:95],a[164:167],v[220:223]
s_waitcnt vmcnt(20) lgkmcnt(0)
M v[220:223],a[88:91],a[160:163],v[220:223]
s_barrier
M v[224:227],a[32:35],a[168:171],v[224:227]
R a[160:163],v5,0
R a[164:167],v6,0
M v[224:227],a[36:39],a[172:175],v[224:227]
M v[228:231],a[44:47],a[172:175],v[228:231]
M v[228:231],a[40:43],a[168:171],v[228:231]
M v[232:235],a[48:51],a[168:171],v[232:235]
M v[232:235],a[52:55],a[172:175],v[232:235]
M v[236:239],a[60:63],a[172:175],v[236:239]
M v[236:239],a[56:59],a[168:171],v[236:239]
M v[240:243],a[64:67],a[168:171],v[240:243]
M v[240:243],a[68:71],a[172:175],v[240:243]
M v[244:247],a[76:79],a[172:175],v[244:247]
M v[244:247],a[72:75],a[168:171],v[244:247]
M v[248:251],a[80:83],a[168:171],v[248:251]
M v[248:251],a[84:87],a[172:175],v[248:251]
s_waitcnt lgkmcnt(0)
M v[252:255],a[92:95],a[172:175],v[252:255]
M v[252:255],a[88:91],a[168:171],v[252:255]
M a[0:3],a[96:99],a[160:163],a[0:3]
R a[168:171],v5,2048
R a[172:175],v6,2048
M a[0:3],a[100:103],a[164:167],a[0:3]
T a[32:33],v1,32768
T a[34:35],v1,33792
M a[4:7],a[108:111],a[164:167],a[4:7]
SA m0,s24,49152
M a[4:7],a[104:107],a[160:163],a[4:7]
buffer_load_dwordx4 v12, s[48:51], s22 offen offset:0   lds
M a[8:11],a[112:115],a[160:163],a[8:11]
M a[8:11],a[116:119],a[164:167],a[8:11]
M a[12:15],a[124:127],a[164:167],a[12:15]
s_nop 0
T a[36:37],v1,40960
T a[38:39],v1,41984
M a[12:15],a[120:123],a[160:163],a[12:15]
M a[16:19],a[128:131],a[160:163],a[16:19]
buffer_load_dwordx4 v13, s[48:51], s22 offen offset:1024   lds
M a[16:19],a[132:135],a[164:167],a[16:19]
M a[20:23],a[140:143],a[164:167],a[20:23]
M a[20:23],a[136:139],a[160:163],a[20:23]
s_nop 0
T a[40:41],v2,32768
T a[42:43],v2,33792
M a[24:27],a[144:147],a[160:163],a[24:27]
M a[24:27],a[148:151],a[164:167],a[24:27]
s_waitcnt lgkmcnt(6)
buffer_load_dwordx4 v14, s[48:51], s22 offen offset:2048   lds
M a[28:31],a[156:159],a[164:167],a[28:31]
M a[28:31],a[152:155],a[160:163],a[28:31]
M v[32:35],a[96:99],a[168:171],v[32:35]
R a[160:163],v5,4096
R a[164:167],v6,4096
M v[32:35],a[100:103],a[172:175],v[32:35]
T a[44:45],v2,40960
T a[46:47],v2,41984
M v[36:39],a[108:111],a[172:175],v[36:39]
buffer_load_dwordx4 v15, s[48:51], s22 offen offset:3072   lds
M v[36:39],a[104:107],a[168:171],v[36:39]
s_sub_u32 s22, s22, 1048448
M v[40:43],a[112:115],a[168:171],v[40:43]
M v[40:43],a[116:119],a[172:175],v[40:43]
s_nop 0
T a[48:49],v3,32768
T a[50:51],v3,33792
M v[44:47],a[124:127],a[172:175],v[44:47]
SA m0,s23,16384
M v[44:47],a[120:123],a[168:171],v[44:47]
buffer_load_dwordx4 v8, s[16:19], s21 offen offset:0  nt lds
M v[48:51],a[128:131],a[168:171],v[48:51]
M v[48:51],a[132:135],a[172:175],v[48:51]
M v[52:55],a[140:143],a[172:175],v[52:55]
s_nop 0
T a[52:53],v3,40960
T a[54:55],v3,41984
M v[52:55],a[136:139],a[168:171],v[52:55]
M v[56:59],a[144:147],a[168:171],v[56:59]
buffer_load_dwordx4 v9, s[16:19], s21 offen offset:1024  nt lds
M v[56:59],a[148:151],a[172:175],v[56:59]
s_waitcnt lgkmcnt(6)
M v[60:63],a[156:159],a[172:175],v[60:63]
M v[60:63],a[152:155],a[168:171],v[60:63]
s_nop 0
T a[56:57],v4,32768
T a[58:59],v4,33792
M v[64:67],a[96:99],a[160:163],v[64:67]
R a[168:171],v5,6144
R a[172:175],v6,6144
M v[64:67],a[100:103],a[164:167],v[64:67]
buffer_load_dwordx4 v10, s[16:19], s21 offen offset:2048  nt lds
M v[68:71],a[108:111],a[164:167],v[68:71]
M v[68:71],a[104:107],a[160:163],v[68:71]
M v[72:75],a[112:115],a[160:163],v[72:75]
s_nop 0
T a[60:61],v4,40960
T a[62:63],v4,41984
M v[72:75],a[116:119],a[164:167],v[72:75]
M v[76:79],a[124:127],a[164:167],v[76:79]
buffer_load_dwordx4 v11, s[16:19], s21 offen offset:3072  nt lds
M v[76:79],a[120:123],a[160:163],v[76:79]
SA s21,s21,524160
M v[80:83],a[128:131],a[160:163],v[80:83]
M v[80:83],a[132:135],a[164:167],v[80:83]
M v[84:87],a[140:143],a[164:167],v[84:87]
M v[84:87],a[136:139],a[160:163],v[84:87]
M v[88:91],a[144:147],a[160:163],v[88:91]
M v[88:91],a[148:151],a[164:167],v[88:91]
s_waitcnt lgkmcnt(2)
M v[92:95],a[156:159],a[164:167],v[92:95]
s_waitcnt vmcnt(18) lgkmcnt(0)
M v[92:95],a[152:155],a[160:163],v[92:95]
s_barrier
M v[96:99],a[96:99],a[168:171],v[96:99]
R a[160:163],v5,16384
R a[164:167],v6,16384
M v[96:99],a[100:103],a[172:175],v[96:99]
M v[100:103],a[108:111],a[172:175],v[100:103]
SA m0,s24,0
T a[64:65],v1,49152
T a[66:67],v1,50176
M v[100:103],a[104:107],a[168:171],v[100:103]
buffer_load_dwordx4 v12, s[48:51], s22 offen offset:0   lds
M v[104:107],a[112:115],a[168:171],v[104:107]
M v[104:107],a[116:119],a[172:175],v[104:107]
M v[108:111],a[124:127],a[172:175],v[108:111]
M v[108:111],a[120:123],a[168:171],v[108:111]
M v[112:115],a[128:131],a[168:171],v[112:115]
M v[112:115],a[132:135],a[172:175],v[112:115]
s_nop 0
T a[68:69],v1,57344
T a[70:71],v1,58368
M v[116:119],a[140:143],a[172:175],v[116:119]
buffer_load_dwordx4 v13, s[48:51], s22 offen offset:1024   lds
M v[116:119],a[136:139],a[168:171],v[116:119]
M v[120:123],a[144:147],a[168:171],v[120:123]
M v[120:123],a[148:151],a[172:175],v[120:123]
s_waitcnt lgkmcnt(4)
M v[124:127],a[156:159],a[172:175],v[124:127]
M v[124:127],a[152:155],a[168:171],v[124:127]
buffer_load_dwordx4 v14, s[48:51], s22 offen offset:2048   lds
M v[128:131],a[96:99],a[160:163],v[128:131]
R a[168:171],v5,18432
R a[172:175],v6,18432
M v[128:131],a[100:103],a[164:167],v[128:131]
s_lshl_b32 s67, s20, 11
T a[72:73],v2,49152
T a[74:75],v2,50176
M v[132:135],a[108:111],a[164:167],v[132:135]
SA s67,s67,104914944
buffer_load_dwordx4 v[16:19], v7, s[8:11], s67 offen offset:0 sc1
M v[132:135],a[104:107],a[160:163],v[132:135]
M v[136:139],a[112:115],a[160:163],v[136:139]
buffer_load_dwordx4 v[20:23], v7, s[8:11], s67 offen offset:1024 sc1
M v[136:139],a[116:119],a[164:167],v[136:139]
M v[140:143],a[124:127],a[164:167],v[140:143]
buffer_load_dwordx4 v15, s[48:51], s22 offen offset:3072   lds
M v[140:143],a[120:123],a[160:163],v[140:143]
SA s22,s22,1048576
L_w_kv03:
s_cbranch_execz L_w_kv07
T a[76:77],v2,57344
T a[78:79],v2,58368
M v[144:147],a[128:131],a[160:163],v[144:147]
M v[144:147],a[132:135],a[164:167],v[144:147]
M v[148:151],a[140:143],a[164:167],v[148:151]
M v[148:151],a[136:139],a[160:163],v[148:151]
SA m0,s23,32768
M v[152:155],a[144:147],a[160:163],v[152:155]
buffer_load_dwordx4 v8, s[16:19], s21 offen offset:0  nt lds
M v[152:155],a[148:151],a[164:167],v[152:155]
s_waitcnt lgkmcnt(4)
M v[156:159],a[156:159],a[164:167],v[156:159]
s_nop 0
T a[80:81],v3,49152
T a[82:83],v3,50176
M v[156:159],a[152:155],a[160:163],v[156:159]
M v[160:163],a[96:99],a[168:171],v[160:163]
R a[160:163],v5,20480
R a[164:167],v6,20480
M v[160:163],a[100:103],a[172:175],v[160:163]
M v[164:167],a[108:111],a[172:175],v[164:167]
buffer_load_dwordx4 v9, s[16:19], s21 offen offset:1024  nt lds
M v[164:167],a[104:107],a[168:171],v[164:167]
M v[168:171],a[112:115],a[168:171],v[168:171]
M v[168:171],a[116:119],a[172:175],v[168:171]
s_nop 0
T a[84:85],v3,57344
T a[86:87],v3,58368
M v[172:175],a[124:127],a[172:175],v[172:175]
M v[172:175],a[120:123],a[168:171],v[172:175]
M v[176:179],a[128:131],a[168:171],v[176:179]
M v[176:179],a[132:135],a[172:175],v[176:179]
buffer_load_dwordx4 v10, s[16:19], s21 offen offset:2048  nt lds
M v[180:183],a[140:143],a[172:175],v[180:183]
M v[180:183],a[136:139],a[168:171],v[180:183]
M v[184:187],a[144:147],a[168:171],v[184:187]
s_nop 0
T a[88:89],v4,49152
T a[90:91],v4,50176
M v[184:187],a[148:151],a[172:175],v[184:187]
s_waitcnt lgkmcnt(4)
M v[188:191],a[156:159],a[172:175],v[188:191]
M v[188:191],a[152:155],a[168:171],v[188:191]
buffer_load_dwordx4 v11, s[16:19], s21 offen offset:3072  nt lds
M v[192:195],a[96:99],a[160:163],v[192:195]
SA s21,s21,128
R a[168:171],v5,22528
R a[172:175],v6,22528
M v[192:195],a[100:103],a[164:167],v[192:195]
M v[196:199],a[108:111],a[164:167],v[196:199]
M v[196:199],a[104:107],a[160:163],v[196:199]
s_nop 0
T a[92:93],v4,57344
T a[94:95],v4,58368
M v[200:203],a[112:115],a[160:163],v[200:203]
SA m0,s87,6144
M v[200:203],a[116:119],a[164:167],v[200:203]
buffer_load_dwordx4 v25, s[60:63], s89 offen offset:0 nt lds
M v[204:207],a[124:127],a[164:167],v[204:207]
SA s89,s89,114688
M v[204:207],a[120:123],a[160:163],v[204:207]
M v[208:211],a[128:131],a[160:163],v[208:211]
M v[208:211],a[132:135],a[164:167],v[208:211]
M v[212:215],a[140:143],a[164:167],v[212:215]
M v[212:215],a[136:139],a[160:163],v[212:215]
M v[216:219],a[144:147],a[160:163],v[216:219]
M v[216:219],a[148:151],a[164:167],v[216:219]
s_waitcnt lgkmcnt(2)
M v[220:223],a[156:159],a[164:167],v[220:223]
s_waitcnt vmcnt(21) lgkmcnt(0)
M v[220:223],a[152:155],a[160:163],v[220:223]
s_barrier
M v[224:227],a[96:99],a[168:171],v[224:227]
R a[160:163],v5,32768
R a[164:167],v6,32768
M v[224:227],a[100:103],a[172:175],v[224:227]
M v[228:231],a[108:111],a[172:175],v[228:231]
M v[228:231],a[104:107],a[168:171],v[228:231]
M v[232:235],a[112:115],a[168:171],v[232:235]
M v[232:235],a[116:119],a[172:175],v[232:235]
M v[236:239],a[124:127],a[172:175],v[236:239]
M v[236:239],a[120:123],a[168:171],v[236:239]
M v[240:243],a[128:131],a[168:171],v[240:243]
M v[240:243],a[132:135],a[172:175],v[240:243]
M v[244:247],a[140:143],a[172:175],v[244:247]
M v[244:247],a[136:139],a[168:171],v[244:247]
M v[248:251],a[144:147],a[168:171],v[248:251]
M v[248:251],a[148:151],a[172:175],v[248:251]
s_waitcnt lgkmcnt(0)
M v[252:255],a[156:159],a[172:175],v[252:255]
M v[252:255],a[152:155],a[168:171],v[252:255]
M a[0:3],a[32:35],a[160:163],a[0:3]
R a[168:171],v5,34816
R a[172:175],v6,34816
M a[0:3],a[36:39],a[164:167],a[0:3]
T a[96:97],v1,0
T a[98:99],v1,1024
M a[4:7],a[44:47],a[164:167],a[4:7]
SA m0,s24,16384
M a[4:7],a[40:43],a[160:163],a[4:7]
buffer_load_dwordx4 v12, s[48:51], s22 offen offset:0   lds
M a[8:11],a[48:51],a[160:163],a[8:11]
M a[8:11],a[52:55],a[164:167],a[8:11]
M a[12:15],a[60:63],a[164:167],a[12:15]
s_nop 0
T a[100:101],v1,8192
T a[102:103],v1,9216
M a[12:15],a[56:59],a[160:163],a[12:15]
M a[16:19],a[64:67],a[160:163],a[16:19]
buffer_load_dwordx4 v13, s[48:51], s22 offen offset:1024   lds
M a[16:19],a[68:71],a[164:167],a[16:19]
M a[20:23],a[76:79],a[164:167],a[20:23]
s_waitcnt vmcnt(9)
v_min3_u32 v28, v16, v17, v18
M a[20:23],a[72:75],a[160:163],a[20:23]
s_nop 0
T a[104:105],v2,0
T a[106:107],v2,1024
M a[24:27],a[80:83],a[160:163],a[24:27]
s_waitcnt vmcnt(8)
v_min3_u32 v28, v28, v19, v20
M a[24:27],a[84:87],a[164:167],a[24:27]
s_waitcnt lgkmcnt(6)
buffer_load_dwordx4 v14, s[48:51], s22 offen offset:2048   lds
M a[28:31],a[92:95],a[164:167],a[28:31]
v_min3_u32 v28, v28, v21, v22
M a[28:31],a[88:91],a[160:163],a[28:31]
v_min_u32 v28, v28, v23
M v[32:35],a[32:35],a[168:171],v[32:35]
R a[160:163],v5,36864
R a[164:167],v6,36864
M v[32:35],a[36:39],a[172:175],v[32:35]
T a[108:109],v2,8192
T a[110:111],v2,9216
M v[36:39],a[44:47],a[172:175],v[36:39]
buffer_load_dwordx4 v15, s[48:51], s22 offen offset:3072   lds
M v[36:39],a[40:43],a[168:171],v[36:39]
s_sub_u32 s22, s22, 1048448
v_cmp_eq_u32 vcc, 0, v28
M v[40:43],a[48:51],a[168:171],v[40:43]
s_nop 0
M v[40:43],a[52:55],a[172:175],v[40:43]
s_cbranch_vccnz L_hs
L_hr:
T a[112:113],v3,0
T a[114:115],v3,1024
M v[44:47],a[60:63],a[172:175],v[44:47]
SA m0,s23,49152
v_max_u32 v28, v16, v17
M v[44:47],a[56:59],a[168:171],v[44:47]
buffer_load_dwordx4 v8, s[16:19], s21 offen offset:0  nt lds
M v[48:51],a[64:67],a[168:171],v[48:51]
v_min_u32 v29, v16, v17
M v[48:51],a[68:71],a[172:175],v[48:51]
v_med3_u32 v29, v28, v29, v18
M v[52:55],a[76:79],a[172:175],v[52:55]
s_nop 0
T a[116:117],v3,8192
T a[118:119],v3,9216
M v[52:55],a[72:75],a[168:171],v[52:55]
v_max_u32 v28, v28, v18
M v[56:59],a[80:83],a[168:171],v[56:59]
buffer_load_dwordx4 v9, s[16:19], s21 offen offset:1024  nt lds
M v[56:59],a[84:87],a[172:175],v[56:59]
s_waitcnt lgkmcnt(6)
v_med3_u32 v29, v28, v29, v19
M v[60:63],a[92:95],a[172:175],v[60:63]
v_max_u32 v28, v28, v19
M v[60:63],a[88:91],a[168:171],v[60:63]
s_nop 0
T a[120:121],v4,0
T a[122:123],v4,1024
M v[64:67],a[32:35],a[160:163],v[64:67]
R a[168:171],v5,38912
R a[172:175],v6,38912
M v[64:67],a[36:39],a[164:167],v[64:67]
buffer_load_dwordx4 v10, s[16:19], s21 offen offset:2048  nt lds
M v[68:71],a[44:47],a[164:167],v[68:71]
v_med3_u32 v29, v28, v29, v20
M v[68:71],a[40:43],a[160:163],v[68:71]
v_max_u32 v28, v28, v20
M v[72:75],a[48:51],a[160:163],v[72:75]
s_nop 0
T a[124:125],v4,8192
T a[126:127],v4,9216
M v[72:75],a[52:55],a[164:167],v[72:75]
v_med3_u32 v29, v28, v29, v21
M v[76:79],a[60:63],a[164:167],v[76:79]
buffer_load_dwordx4 v11, s[16:19], s21 offen offset:3072  nt lds
M v[76:79],a[56:59],a[160:163],v[76:79]
SA s21,s21,524160
v_max_u32 v28, v28, v21
M v[80:83],a[64:67],a[160:163],v[80:83]
v_med3_u32 v29, v28, v29, v22
M v[80:83],a[68:71],a[164:167],v[80:83]
v_max_u32 v28, v28, v22
M v[84:87],a[76:79],a[164:167],v[84:87]
v_med3_u32 v29, v28, v29, v23
M v[84:87],a[72:75],a[160:163],v[84:87]
v_max_u32 v28, v28, v23
M v[88:91],a[80:83],a[160:163],v[88:91]
s_nop 0
v_mov_b32 v30, v28 row_ror:8 row_mask:0xf bank_mask:0xf
M v[88:91],a[84:87],a[164:167],v[88:91]
s_waitcnt lgkmcnt(2)
v_mov_b32 v31, v29 row_ror:8 row_mask:0xf bank_mask:0xf
M v[92:95],a[92:95],a[164:167],v[92:95]
s_waitcnt lgkmcnt(0)
v_min_u32 v16, v28, v30
M v[92:95],a[88:91],a[160:163],v[92:95]
s_barrier
M v[96:99],a[32:35],a[168:171],v[96:99]
R a[160:163],v5,49152
R a[164:167],v6,49152
M v[96:99],a[36:39],a[172:175],v[96:99]
v_max_u32 v28, v28, v30
M v[100:103],a[44:47],a[172:175],v[100:103]
SA m0,s24,32768
T a[128:129],v1,16384
T a[130:131],v1,17408
M v[100:103],a[40:43],a[168:171],v[100:103]
buffer_load_dwordx4 v12, s[48:51], s22 offen offset:0   lds
M v[104:107],a[48:51],a[168:171],v[104:107]
v_max3_u32 v29, v29, v31, v16
M v[104:107],a[52:55],a[172:175],v[104:107]
v_mov_b32 v30, v28 row_ror:4 row_mask:0xf bank_mask:0xf
M v[108:111],a[60:63],a[172:175],v[108:111]
v_mov_b32 v31, v29 row_ror:4 row_mask:0xf bank_mask:0xf
M v[108:111],a[56:59],a[168:171],v[108:111]
v_min_u32 v16, v28, v30
M v[112:115],a[64:67],a[168:171],v[112:115]
v_max_u32 v28, v28, v30
M v[112:115],a[68:71],a[172:175],v[112:115]
s_nop 0
T a[132:133],v1,24576
T a[134:135],v1,25600
M v[116:119],a[76:79],a[172:175],v[116:119]
buffer_load_dwordx4 v13, s[48:51], s22 offen offset:1024   lds
M v[116:119],a[72:75],a[168:171],v[116:119]
v_max3_u32 v29, v29, v31, v16
M v[120:123],a[80:83],a[168:171],v[120:123]
v_mov_b32 v30, v28 row_ror:2 row_mask:0xf bank_mask:0xf
M v[120:123],a[84:87],a[172:175],v[120:123]
s_waitcnt lgkmcnt(4)
v_mov_b32 v31, v29 row_ror:2 row_mask:0xf bank_mask:0xf
M v[124:127],a[92:95],a[172:175],v[124:127]
v_min_u32 v16, v28, v30
M v[124:127],a[88:91],a[168:171],v[124:127]
v_max_u32 v28, v28, v30
M v[128:131],a[32:35],a[160:163],v[128:131]
R a[168:171],v5,51200
R a[172:175],v6,51200
M v[128:131],a[36:39],a[164:167],v[128:131]
T a[136:137],v2,16384
T a[138:139],v2,17408
M v[132:135],a[44:47],a[164:167],v[132:135]
buffer_load_dwordx4 v14, s[48:51], s22 offen offset:2048   lds
M v[132:135],a[40:43],a[160:163],v[132:135]
v_max3_u32 v29, v29, v31, v16
M v[136:139],a[48:51],a[160:163],v[136:139]
v_mov_b32 v30, v28 row_ror:1 row_mask:0xf bank_mask:0xf
M v[136:139],a[52:55],a[164:167],v[136:139]
v_mov_b32 v31, v29 row_ror:1 row_mask:0xf bank_mask:0xf
M v[140:143],a[60:63],a[164:167],v[140:143]
v_min_u32 v16, v28, v30
M v[140:143],a[56:59],a[160:163],v[140:143]
s_nop 0
T a[140:141],v2,24576
T a[142:143],v2,25600
M v[144:147],a[64:67],a[160:163],v[144:147]
buffer_load_dwordx4 v15, s[48:51], s22 offen offset:3072   lds
M v[144:147],a[68:71],a[164:167],v[144:147]
SA s22,s22,1048576
v_max_u32 v28, v28, v30
M v[148:151],a[76:79],a[164:167],v[148:151]
v_max3_u32 v29, v29, v31, v16
M v[148:151],a[72:75],a[160:163],v[148:151]
v_mov_b32 v30, v28
M v[152:155],a[80:83],a[160:163],v[152:155]
v_mov_b32 v31, v29
M v[152:155],a[84:87],a[164:167],v[152:155]
s_waitcnt lgkmcnt(4)
v_permlane16_swap_b32 v30, v28
M v[156:159],a[92:95],a[164:167],v[156:159]
SA m0,s23,0
T a[144:145],v3,16384
T a[146:147],v3,17408
M v[156:159],a[88:91],a[160:163],v[156:159]
buffer_load_dwordx4 v8, s[16:19], s21 offen offset:0  nt lds
M v[160:163],a[32:35],a[168:171],v[160:163]
R a[160:163],v5,53248
R a[164:167],v6,53248
M v[160:163],a[36:39],a[172:175],v[160:163]
v_permlane16_swap_b32 v31, v29
M v[164:167],a[44:47],a[172:175],v[164:167]
v_min_u32 v16, v28, v30
M v[164:167],a[40:43],a[168:171],v[164:167]
v_max_u32 v28, v28, v30
M v[168:171],a[48:51],a[168:171],v[168:171]
v_max3_u32 v29, v29, v31, v16
M v[168:171],a[52:55],a[172:175],v[168:171]
s_nop 0
T a[148:149],v3,24576
T a[150:151],v3,25600
M v[172:175],a[60:63],a[172:175],v[172:175]
buffer_load_dwordx4 v9, s[16:19], s21 offen offset:1024  nt lds
M v[172:175],a[56:59],a[168:171],v[172:175]
v_mov_b32 v30, v28
M v[176:179],a[64:67],a[168:171],v[176:179]
v_mov_b32 v31, v29
M v[176:179],a[68:71],a[172:175],v[176:179]
v_permlane32_swap_b32 v30, v28
M v[180:183],a[76:79],a[172:175],v[180:183]
v_permlane32_swap_b32 v31, v29
M v[180:183],a[72:75],a[168:171],v[180:183]
v_min_u32 v16, v28, v30
M v[184:187],a[80:83],a[168:171],v[184:187]
s_nop 0
T a[152:153],v4,16384
T a[154:155],v4,17408
M v[184:187],a[84:87],a[172:175],v[184:187]
s_waitcnt lgkmcnt(4)
buffer_load_dwordx4 v10, s[16:19], s21 offen offset:2048  nt lds
M v[188:191],a[92:95],a[172:175],v[188:191]
v_max_u32 v28, v28, v30
M v[188:191],a[88:91],a[168:171],v[188:191]
v_max3_u32 v29, v29, v31, v16
M v[192:195],a[32:35],a[160:163],v[192:195]
s_lshl_b32 s64, s20, 3
R a[168:171],v5,55296
R a[172:175],v6,55296
M v[192:195],a[36:39],a[164:167],v[192:195]
SA s64,s64,159744
v_mov_b32 v16, s64
M v[196:199],a[44:47],a[164:167],v[196:199]
ds_write_b64 v16, v[28:29]
M v[196:199],a[40:43],a[160:163],v[196:199]
s_nop 0
T a[156:157],v4,24576
T a[158:159],v4,25600
M v[200:203],a[48:51],a[160:163],v[200:203]
buffer_load_dwordx4 v11, s[16:19], s21 offen offset:3072  nt lds
M v[200:203],a[52:55],a[164:167],v[200:203]
SA s21,s21,128
M v[204:207],a[60:63],a[164:167],v[204:207]
M v[204:207],a[56:59],a[160:163],v[204:207]
M v[208:211],a[64:67],a[160:163],v[208:211]
M v[208:211],a[68:71],a[164:167],v[208:211]
M v[212:215],a[76:79],a[164:167],v[212:215]
M v[212:215],a[72:75],a[160:163],v[212:215]
M v[216:219],a[80:83],a[160:163],v[216:219]
M v[216:219],a[84:87],a[164:167],v[216:219]
s_waitcnt lgkmcnt(3)
M v[220:223],a[92:95],a[164:167],v[220:223]
s_waitcnt vmcnt(17) lgkmcnt(0)
M v[220:223],a[88:91],a[160:163],v[220:223]
s_barrier
M v[224:227],a[32:35],a[168:171],v[224:227]
R a[160:163],v5,0
R a[164:167],v6,0
M v[224:227],a[36:39],a[172:175],v[224:227]
M v[228:231],a[44:47],a[172:175],v[228:231]
M v[228:231],a[40:43],a[168:171],v[228:231]
M v[232:235],a[48:51],a[168:171],v[232:235]
M v[232:235],a[52:55],a[172:175],v[232:235]
M v[236:239],a[60:63],a[172:175],v[236:239]
M v[236:239],a[56:59],a[168:171],v[236:239]
M v[240:243],a[64:67],a[168:171],v[240:243]
M v[240:243],a[68:71],a[172:175],v[240:243]
M v[244:247],a[76:79],a[172:175],v[244:247]
M v[244:247],a[72:75],a[168:171],v[244:247]
M v[248:251],a[80:83],a[168:171],v[248:251]
M v[248:251],a[84:87],a[172:175],v[248:251]
s_waitcnt lgkmcnt(0)
M v[252:255],a[92:95],a[172:175],v[252:255]
M v[252:255],a[88:91],a[168:171],v[252:255]
M a[0:3],a[96:99],a[160:163],a[0:3]
R a[168:171],v5,2048
R a[172:175],v6,2048
M a[0:3],a[100:103],a[164:167],a[0:3]
T a[32:33],v1,32768
T a[34:35],v1,33792
M a[4:7],a[108:111],a[164:167],a[4:7]
SA m0,s24,49152
M a[4:7],a[104:107],a[160:163],a[4:7]
buffer_load_dwordx4 v12, s[48:51], s22 offen offset:0   lds
M a[8:11],a[112:115],a[160:163],a[8:11]
v_mov_b32 v28, 159744
M a[8:11],a[116:119],a[164:167],a[8:11]
ds_read_b128 v[16:19], v28
M a[12:15],a[124:127],a[164:167],a[12:15]
s_nop 0
T a[36:37],v1,40960
T a[38:39],v1,41984
M a[12:15],a[120:123],a[160:163],a[12:15]
R v[20:23],v28,16
M a[16:19],a[128:131],a[160:163],a[16:19]
buffer_load_dwordx4 v13, s[48:51], s22 offen offset:1024   lds
M a[16:19],a[132:135],a[164:167],a[16:19]
M a[20:23],a[140:143],a[164:167],a[20:23]
M a[20:23],a[136:139],a[160:163],a[20:23]
s_nop 0
T a[40:41],v2,32768
T a[42:43],v2,33792
M a[24:27],a[144:147],a[160:163],a[24:27]
M a[24:27],a[148:151],a[164:167],a[24:27]
s_waitcnt lgkmcnt(8)
buffer_load_dwordx4 v14, s[48:51], s22 offen offset:2048   lds
M a[28:31],a[156:159],a[164:167],a[28:31]
M a[28:31],a[152:155],a[160:163],a[28:31]
M v[32:35],a[96:99],a[168:171],v[32:35]
R a[160:163],v5,4096
R a[164:167],v6,4096
M v[32:35],a[100:103],a[172:175],v[32:35]
T a[44:45],v2,40960
T a[46:47],v2,41984
M v[36:39],a[108:111],a[172:175],v[36:39]
buffer_load_dwordx4 v15, s[48:51], s22 offen offset:3072   lds
M v[36:39],a[104:107],a[168:171],v[36:39]
s_sub_u32 s22, s22, 1048448
s_waitcnt lgkmcnt(9)
v_min_u32 v28, v16, v18
M v[40:43],a[112:115],a[168:171],v[40:43]
v_max_u32 v16, v16, v18
M v[40:43],a[116:119],a[172:175],v[40:43]
s_nop 0
T a[48:49],v3,32768
T a[50:51],v3,33792
M v[44:47],a[124:127],a[172:175],v[44:47]
SA m0,s23,16384
v_max3_u32 v17, v17, v19, v28
M v[44:47],a[120:123],a[168:171],v[44:47]
buffer_load_dwordx4 v8, s[16:19], s21 offen offset:0  nt lds
M v[48:51],a[128:131],a[168:171],v[48:51]
s_waitcnt lgkmcnt(8)
v_min_u32 v29, v20, v22
M v[48:51],a[132:135],a[172:175],v[48:51]
v_max_u32 v20, v20, v22
M v[52:55],a[140:143],a[172:175],v[52:55]
s_nop 0
T a[52:53],v3,40960
T a[54:55],v3,41984
M v[52:55],a[136:139],a[168:171],v[52:55]
v_max3_u32 v21, v21, v23, v29
M v[56:59],a[144:147],a[168:171],v[56:59]
buffer_load_dwordx4 v9, s[16:19], s21 offen offset:1024  nt lds
M v[56:59],a[148:151],a[172:175],v[56:59]
s_waitcnt lgkmcnt(6)
v_min_u32 v28, v16, v20
M v[60:63],a[156:159],a[172:175],v[60:63]
v_max_u32 v16, v16, v20
M v[60:63],a[152:155],a[168:171],v[60:63]
s_nop 0
T a[56:57],v4,32768
T a[58:59],v4,33792
M v[64:67],a[96:99],a[160:163],v[64:67]
R a[168:171],v5,6144
R a[172:175],v6,6144
M v[64:67],a[100:103],a[164:167],v[64:67]
buffer_load_dwordx4 v10, s[16:19], s21 offen offset:2048  nt lds
M v[68:71],a[108:111],a[164:167],v[68:71]
v_max3_u32 v17, v17, v21, v28
M v[68:71],a[104:107],a[160:163],v[68:71]
v_and_b32 v28, 1, v0
M v[72:75],a[112:115],a[160:163],v[72:75]
s_nop 0
T a[60:61],v4,40960
T a[62:63],v4,41984
M v[72:75],a[116:119],a[164:167],v[72:75]
v_cmp_eq_u32 vcc, 0, v28
M v[76:79],a[124:127],a[164:167],v[76:79]
s_and_b32 s64, s20, 1
buffer_load_dwordx4 v11, s[16:19], s21 offen offset:3072  nt lds
M v[76:79],a[120:123],a[160:163],v[76:79]
SA s21,s21,524160
s_mul_i32 s64, s64, 448
v_cndmask_b32 v24, v17, v16, vcc
M v[80:83],a[128:131],a[160:163],v[80:83]
v_and_b32 v24, 0x7ff, v24
M v[80:83],a[132:135],a[164:167],v[80:83]
v_sub_u32 v24, 2047, v24
M v[84:87],a[140:143],a[164:167],v[84:87]
v_mul_u32_u24 v28, 896, v24
M v[84:87],a[136:139],a[160:163],v[84:87]
v_lshrrev_b32 v29, 4, v0
M v[88:91],a[144:147],a[160:163],v[88:91]
v_lshl_add_u32 v28, v29, 4, v28
M v[88:91],a[148:151],a[164:167],v[88:91]
s_waitcnt lgkmcnt(2)
v_bfe_u32 v30, v0, 1, 3
M v[92:95],a[156:159],a[164:167],v[92:95]
s_waitcnt vmcnt(16) lgkmcnt(0)
v_lshl_or_b32 v28, v30, 26, v28
M v[92:95],a[152:155],a[160:163],v[92:95]
s_barrier
M v[96:99],a[96:99],a[168:171],v[96:99]
R a[160:163],v5,16384
R a[164:167],v6,16384
M v[96:99],a[100:103],a[172:175],v[96:99]
buffer_load_dwordx4 a[208:211], v28, s[56:59], s64 offen offset:0
M v[100:103],a[108:111],a[172:175],v[100:103]
SA m0,s24,0
T a[64:65],v1,49152
T a[66:67],v1,50176
M v[100:103],a[104:107],a[168:171],v[100:103]
buffer_load_dwordx4 v12, s[48:51], s22 offen offset:0   lds
M v[104:107],a[112:115],a[168:171],v[104:107]
M v[104:107],a[116:119],a[172:175],v[104:107]
M v[108:111],a[124:127],a[172:175],v[108:111]
buffer_load_dwordx4 a[212:215], v28, s[56:59], s64 offen offset:64
M v[108:111],a[120:123],a[168:171],v[108:111]
M v[112:115],a[128:131],a[168:171],v[112:115]
buffer_load_dwordx4 a[216:219], v28, s[56:59], s64 offen offset:128
M v[112:115],a[132:135],a[172:175],v[112:115]
s_nop 0
T a[68:69],v1,57344
T a[70:71],v1,58368
M v[116:119],a[140:143],a[172:175],v[116:119]
buffer_load_dwordx4 v13, s[48:51], s22 offen offset:1024   lds
M v[116:119],a[136:139],a[168:171],v[116:119]
M v[120:123],a[144:147],a[168:171],v[120:123]
M v[120:123],a[148:151],a[172:175],v[120:123]
s_waitcnt lgkmcnt(4)
M v[124:127],a[156:159],a[172:175],v[124:127]
buffer_load_dwordx4 a[220:223], v28, s[56:59], s64 offen offset:192
M v[124:127],a[152:155],a[168:171],v[124:127]
M v[128:131],a[96:99],a[160:163],v[128:131]
R a[168:171],v5,18432
R a[172:175],v6,18432
M v[128:131],a[100:103],a[164:167],v[128:131]
T a[72:73],v2,49152
T a[74:75],v2,50176
M v[132:135],a[108:111],a[164:167],v[132:135]
buffer_load_dwordx4 v14, s[48:51], s22 offen offset:2048   lds
M v[132:135],a[104:107],a[160:163],v[132:135]
M v[136:139],a[112:115],a[160:163],v[136:139]
buffer_load_dwordx4 a[224:227], v28, s[56:59], s64 offen offset:256
M v[136:139],a[116:119],a[164:167],v[136:139]
M v[140:143],a[124:127],a[164:167],v[140:143]
buffer_load_dwordx4 a[228:231], v28, s[56:59], s64 offen offset:320
M v[140:143],a[120:123],a[160:163],v[140:143]
s_nop 0
T a[76:77],v2,57344
T a[78:79],v2,58368
M v[144:147],a[128:131],a[160:163],v[144:147]
buffer_load_dwordx4 v15, s[48:51], s22 offen offset:3072   lds
M v[144:147],a[132:135],a[164:167],v[144:147]
SA s22,s22,1048576
M v[148:151],a[140:143],a[164:167],v[148:151]
M v[148:151],a[136:139],a[160:163],v[148:151]
buffer_load_dwordx4 a[232:235], v28, s[56:59], s64 offen offset:384
M v[152:155],a[144:147],a[160:163],v[152:155]
v_lshrrev_b32 v28, 4, v24
M v[152:155],a[148:151],a[164:167],v[152:155]
s_waitcnt lgkmcnt(4)
v_lshlrev_b32 v28, 5, v28
M v[156:159],a[156:159],a[164:167],v[156:159]
SA m0,s23,32768
T a[80:81],v3,49152
T a[82:83],v3,50176
M v[156:159],a[152:155],a[160:163],v[156:159]
buffer_load_dwordx4 v8, s[16:19], s21 offen offset:0  nt lds
M v[160:163],a[96:99],a[168:171],v[160:163]
L_w_kv04:
s_cbranch_execz L_w_kv08
R a[160:163],v5,20480
R a[164:167],v6,20480
M v[160:163],a[100:103],a[172:175],v[160:163]
v_and_b32 v30, 15, v24
M v[164:167],a[108:111],a[172:175],v[164:167]
v_add_lshl_u32 v28, v28, v30, 2
M v[164:167],a[104:107],a[168:171],v[164:167]
v_lshrrev_b32 v30, 1, v0
M v[168:171],a[112:115],a[168:171],v[168:171]
v_min_u32 v30, 1, v30
M v[168:171],a[116:119],a[172:175],v[168:171]
s_nop 0
T a[84:85],v3,57344
T a[86:87],v3,58368
M v[172:175],a[124:127],a[172:175],v[172:175]
buffer_load_dwordx4 v9, s[16:19], s21 offen offset:1024  nt lds
M v[172:175],a[120:123],a[168:171],v[172:175]
v_lshl_or_b32 v28, v30, 29, v28
M v[176:179],a[128:131],a[168:171],v[176:179]
s_or_b32 s64, s31, s20
M v[176:179],a[132:135],a[172:175],v[176:179]
s_min_u32 s64, s64, 1
M v[180:183],a[140:143],a[172:175],v[180:183]
s_lshl_b32 s64, s64, 29
M v[180:183],a[136:139],a[168:171],v[180:183]
SA s64,s64,104857600
buffer_load_dword v23, v28, s[8:11], s64 offen sc1
M v[184:187],a[144:147],a[168:171],v[184:187]
s_nop 0
T a[88:89],v4,49152
T a[90:91],v4,50176
M v[184:187],a[148:151],a[172:175],v[184:187]
s_waitcnt lgkmcnt(4)
buffer_load_dwordx4 v10, s[16:19], s21 offen offset:2048  nt lds
M v[188:191],a[156:159],a[172:175],v[188:191]
v_bfe_u32 v28, v0, 2, 2
M v[188:191],a[152:155],a[168:171],v[188:191]
v_lshl_add_u32 v28, v29, 3, v28
M v[192:195],a[96:99],a[160:163],v[192:195]
R a[168:171],v5,22528
R a[172:175],v6,22528
M v[192:195],a[100:103],a[164:167],v[192:195]
v_lshlrev_b32 v28, 5, v28
M v[196:199],a[108:111],a[164:167],v[196:199]
v_and_b32 v30, 3, v0
M v[196:199],a[104:107],a[160:163],v[196:199]
s_nop 0
T a[92:93],v4,57344
T a[94:95],v4,58368
M v[200:203],a[112:115],a[160:163],v[200:203]
buffer_load_dwordx4 v11, s[16:19], s21 offen offset:3072  nt lds
M v[200:203],a[116:119],a[164:167],v[200:203]
SA s21,s21,128
v_lshl_add_u32 v28, v30, 3, v28
M v[204:207],a[124:127],a[164:167],v[204:207]
v_add_u32 v22, s87, v28
M v[204:207],a[120:123],a[160:163],v[204:207]
M v[208:211],a[128:131],a[160:163],v[208:211]
M v[208:211],a[132:135],a[164:167],v[208:211]
M v[212:215],a[140:143],a[164:167],v[212:215]
M v[212:215],a[136:139],a[160:163],v[212:215]
M v[216:219],a[144:147],a[160:163],v[216:219]
M v[216:219],a[148:151],a[164:167],v[216:219]
s_waitcnt lgkmcnt(2)
M v[220:223],a[156:159],a[164:167],v[220:223]
s_waitcnt vmcnt(24) lgkmcnt(0)
M v[220:223],a[152:155],a[160:163],v[220:223]
s_barrier
M v[224:227],a[96:99],a[168:171],v[224:227]
R a[160:163],v5,32768
R a[164:167],v6,32768
M v[224:227],a[100:103],a[172:175],v[224:227]
M v[228:231],a[108:111],a[172:175],v[228:231]
M v[228:231],a[104:107],a[168:171],v[228:231]
M v[232:235],a[112:115],a[168:171],v[232:235]
M v[232:235],a[116:119],a[172:175],v[232:235]
M v[236:239],a[124:127],a[172:175],v[236:239]
M v[236:239],a[120:123],a[168:171],v[236:239]
M v[240:243],a[128:131],a[168:171],v[240:243]
M v[240:243],a[132:135],a[172:175],v[240:243]
M v[244:247],a[140:143],a[172:175],v[244:247]
M v[244:247],a[136:139],a[168:171],v[244:247]
M v[248:251],a[144:147],a[168:171],v[248:251]
M v[248:251],a[148:151],a[172:175],v[248:251]
s_waitcnt lgkmcnt(0)
M v[252:255],a[156:159],a[172:175],v[252:255]
M v[252:255],a[152:155],a[168:171],v[252:255]
M a[0:3],a[32:35],a[160:163],a[0:3]
R a[168:171],v5,34816
R a[172:175],v6,34816
M a[0:3],a[36:39],a[164:167],a[0:3]
T a[96:97],v1,0
T a[98:99],v1,1024
M a[4:7],a[44:47],a[164:167],a[4:7]
SA m0,s24,16384
M a[4:7],a[40:43],a[160:163],a[4:7]
buffer_load_dwordx4 v12, s[48:51], s22 offen offset:0   lds
M a[8:11],a[48:51],a[160:163],a[8:11]
M a[8:11],a[52:55],a[164:167],a[8:11]
M a[12:15],a[60:63],a[164:167],a[12:15]
s_nop 0
T a[100:101],v1,8192
T a[102:103],v1,9216
M a[12:15],a[56:59],a[160:163],a[12:15]
M a[16:19],a[64:67],a[160:163],a[16:19]
buffer_load_dwordx4 v13, s[48:51], s22 offen offset:1024   lds
M a[16:19],a[68:71],a[164:167],a[16:19]
M a[20:23],a[76:79],a[164:167],a[20:23]
M a[20:23],a[72:75],a[160:163],a[20:23]
s_nop 0
T a[104:105],v2,0
T a[106:107],v2,1024
M a[24:27],a[80:83],a[160:163],a[24:27]
M a[24:27],a[84:87],a[164:167],a[24:27]
s_waitcnt lgkmcnt(6)
buffer_load_dwordx4 v14, s[48:51], s22 offen offset:2048   lds
M a[28:31],a[92:95],a[164:167],a[28:31]
M a[28:31],a[88:91],a[160:163],a[28:31]
M v[32:35],a[32:35],a[168:171],v[32:35]
R a[160:163],v5,36864
R a[164:167],v6,36864
M v[32:35],a[36:39],a[172:175],v[32:35]
T a[108:109],v2,8192
T a[110:111],v2,9216
M v[36:39],a[44:47],a[172:175],v[36:39]
buffer_load_dwordx4 v15, s[48:51], s22 offen offset:3072   lds
M v[36:39],a[40:43],a[168:171],v[36:39]
s_sub_u32 s22, s22, 1048448
M v[40:43],a[48:51],a[168:171],v[40:43]
M v[40:43],a[52:55],a[172:175],v[40:43]
s_nop 0
T a[112:113],v3,0
T a[114:115],v3,1024
M v[44:47],a[60:63],a[172:175],v[44:47]
SA m0,s23,49152
M v[44:47],a[56:59],a[168:171],v[44:47]
buffer_load_dwordx4 v8, s[16:19], s21 offen offset:0  nt lds
M v[48:51],a[64:67],a[168:171],v[48:51]
M v[48:51],a[68:71],a[172:175],v[48:51]
M v[52:55],a[76:79],a[172:175],v[52:55]
s_nop 0
T a[116:117],v3,8192
T a[118:119],v3,9216
M v[52:55],a[72:75],a[168:171],v[52:55]
M v[56:59],a[80:83],a[168:171],v[56:59]
buffer_load_dwordx4 v9, s[16:19], s21 offen offset:1024  nt lds
M v[56:59],a[84:87],a[172:175],v[56:59]
s_waitcnt lgkmcnt(6)
M v[60:63],a[92:95],a[172:175],v[60:63]
M v[60:63],a[88:91],a[168:171],v[60:63]
s_nop 0
T a[120:121],v4,0
T a[122:123],v4,1024
M v[64:67],a[32:35],a[160:163],v[64:67]
R a[168:171],v5,38912
R a[172:175],v6,38912
M v[64:67],a[36:39],a[164:167],v[64:67]
buffer_load_dwordx4 v10, s[16:19], s21 offen offset:2048  nt lds
M v[68:71],a[44:47],a[164:167],v[68:71]
M v[68:71],a[40:43],a[160:163],v[68:71]
M v[72:75],a[48:51],a[160:163],v[72:75]
s_nop 0
T a[124:125],v4,8192
T a[126:127],v4,9216
M v[72:75],a[52:55],a[164:167],v[72:75]
M v[76:79],a[60:63],a[164:167],v[76:79]
buffer_load_dwordx4 v11, s[16:19], s21 offen offset:3072  nt lds
M v[76:79],a[56:59],a[160:163],v[76:79]
SA s21,s21,524160
M v[80:83],a[64:67],a[160:163],v[80:83]
M v[80:83],a[68:71],a[164:167],v[80:83]
M v[84:87],a[76:79],a[164:167],v[84:87]
M v[84:87],a[72:75],a[160:163],v[84:87]
M v[88:91],a[80:83],a[160:163],v[88:91]
M v[88:91],a[84:87],a[164:167],v[88:91]
s_waitcnt lgkmcnt(2)
M v[92:95],a[92:95],a[164:167],v[92:95]
s_waitcnt vmcnt(24) lgkmcnt(0)
M v[92:95],a[88:91],a[160:163],v[92:95]
s_barrier
M v[96:99],a[32:35],a[168:171],v[96:99]
R a[160:163],v5,49152
R a[164:167],v6,49152
M v[96:99],a[36:39],a[172:175],v[96:99]
M v[100:103],a[44:47],a[172:175],v[100:103]
SA m0,s24,32768
T a[128:129],v1,16384
T a[130:131],v1,17408
M v[100:103],a[40:43],a[168:171],v[100:103]
buffer_load_dwordx4 v12, s[48:51], s22 offen offset:0   lds
M v[104:107],a[48:51],a[168:171],v[104:107]
s_nop 0
T a[176:177],v22,0
T a[178:179],v22,128
M v[104:107],a[52:55],a[172:175],v[104:107]
T a[180:181],v22,1024
T a[182:183],v22,1152
M v[108:111],a[60:63],a[172:175],v[108:111]
T a[184:185],v22,2048
T a[186:187],v22,2176
M v[108:111],a[56:59],a[168:171],v[108:111]
T a[188:189],v22,3072
T a[190:191],v22,3200
M v[112:115],a[64:67],a[168:171],v[112:115]
M v[112:115],a[68:71],a[172:175],v[112:115]
s_nop 0
T a[132:133],v1,24576
T a[134:135],v1,25600
M v[116:119],a[76:79],a[172:175],v[116:119]
buffer_load_dwordx4 v13, s[48:51], s22 offen offset:1024   lds
M v[116:119],a[72:75],a[168:171],v[116:119]
M v[120:123],a[80:83],a[168:171],v[120:123]
M v[120:123],a[84:87],a[172:175],v[120:123]
s_waitcnt lgkmcnt(12)
M v[124:127],a[92:95],a[172:175],v[124:127]
M v[124:127],a[88:91],a[168:171],v[124:127]
M v[128:131],a[32:35],a[160:163],v[128:131]
R a[168:171],v5,51200
R a[172:175],v6,51200
M v[128:131],a[36:39],a[164:167],v[128:131]
T a[136:137],v2,16384
T a[138:139],v2,17408
M v[132:135],a[44:47],a[164:167],v[132:135]
buffer_load_dwordx4 v14, s[48:51], s22 offen offset:2048   lds
M v[132:135],a[40:43],a[160:163],v[132:135]
M v[136:139],a[48:51],a[160:163],v[136:139]
M v[136:139],a[52:55],a[164:167],v[136:139]
M v[140:143],a[60:63],a[164:167],v[140:143]
M v[140:143],a[56:59],a[160:163],v[140:143]
s_nop 0
T a[140:141],v2,24576
T a[142:143],v2,25600
M v[144:147],a[64:67],a[160:163],v[144:147]
buffer_load_dwordx4 v15, s[48:51], s22 offen offset:3072   lds
M v[144:147],a[68:71],a[164:167],v[144:147]
SA s22,s22,1048576
M v[148:151],a[76:79],a[164:167],v[148:151]
M v[148:151],a[72:75],a[160:163],v[148:151]
M v[152:155],a[80:83],a[160:163],v[152:155]
M v[152:155],a[84:87],a[164:167],v[152:155]
s_waitcnt lgkmcnt(4)
M v[156:159],a[92:95],a[164:167],v[156:159]
SA m0,s23,0
T a[144:145],v3,16384
T a[146:147],v3,17408
M v[156:159],a[88:91],a[160:163],v[156:159]
buffer_load_dwordx4 v8, s[16:19], s21 offen offset:0  nt lds
s_waitcnt vmcnt(28)
M v[16:19],a[176:179],a[208:211],0
s_waitcnt vmcnt(26)
M v[16:19],a[180:183],a[212:215],v[16:19]
s_waitcnt vmcnt(25)
M v[16:19],a[184:187],a[216:219],v[16:19]
s_waitcnt vmcnt(23)
M v[16:19],a[188:191],a[220:223],v[16:19]
M v[160:163],a[32:35],a[168:171],v[160:163]
R a[160:163],v5,53248
R a[164:167],v6,53248
M v[160:163],a[36:39],a[172:175],v[160:163]
T a[176:177],v22,4096
T a[178:179],v22,4224
M v[164:167],a[44:47],a[172:175],v[164:167]
T a[180:181],v22,5120
T a[182:183],v22,5248
M v[164:167],a[40:43],a[168:171],v[164:167]
T a[184:185],v22,6144
T a[186:187],v22,6272
M v[168:171],a[48:51],a[168:171],v[168:171]
M v[168:171],a[52:55],a[172:175],v[168:171]
s_nop 0
T a[148:149],v3,24576
T a[150:151],v3,25600
M v[172:175],a[60:63],a[172:175],v[172:175]
buffer_load_dwordx4 v9, s[16:19], s21 offen offset:1024  nt lds
M v[172:175],a[56:59],a[168:171],v[172:175]
M v[176:179],a[64:67],a[168:171],v[176:179]
M v[176:179],a[68:71],a[172:175],v[176:179]
M v[180:183],a[76:79],a[172:175],v[180:183]
M v[180:183],a[72:75],a[168:171],v[180:183]
M v[184:187],a[80:83],a[168:171],v[184:187]
s_nop 0
T a[152:153],v4,16384
T a[154:155],v4,17408
M v[184:187],a[84:87],a[172:175],v[184:187]
s_waitcnt lgkmcnt(10)
buffer_load_dwordx4 v10, s[16:19], s21 offen offset:2048  nt lds
M v[188:191],a[92:95],a[172:175],v[188:191]
M v[188:191],a[88:91],a[168:171],v[188:191]
M v[192:195],a[32:35],a[160:163],v[192:195]
R a[168:171],v5,55296
R a[172:175],v6,55296
M v[192:195],a[36:39],a[164:167],v[192:195]
M v[196:199],a[44:47],a[164:167],v[196:199]
M v[196:199],a[40:43],a[160:163],v[196:199]
s_nop 0
T a[156:157],v4,24576
T a[158:159],v4,25600
M v[200:203],a[48:51],a[160:163],v[200:203]
buffer_load_dwordx4 v11, s[16:19], s21 offen offset:3072  nt lds
M v[200:203],a[52:55],a[164:167],v[200:203]
SA s21,s21,128
M v[204:207],a[60:63],a[164:167],v[204:207]
M v[204:207],a[56:59],a[160:163],v[204:207]
M v[208:211],a[64:67],a[160:163],v[208:211]
M v[208:211],a[68:71],a[164:167],v[208:211]
M v[212:215],a[76:79],a[164:167],v[212:215]
M v[212:215],a[72:75],a[160:163],v[212:215]
M v[216:219],a[80:83],a[160:163],v[216:219]
M v[216:219],a[84:87],a[164:167],v[216:219]
s_waitcnt lgkmcnt(2)
M v[220:223],a[92:95],a[164:167],v[220:223]
s_waitcnt vmcnt(16) lgkmcnt(0)
M v[220:223],a[88:91],a[160:163],v[220:223]
s_barrier
M v[16:19],a[176:179],a[224:227],v[16:19]
M v[16:19],a[180:183],a[228:231],v[16:19]
M v[16:19],a[184:187],a[232:235],v[16:19]
M v[224:227],a[32:35],a[168:171],v[224:227]
R a[160:163],v5,0
R a[164:167],v6,0
M v[224:227],a[36:39],a[172:175],v[224:227]
M v[228:231],a[44:47],a[172:175],v[228:231]
M v[228:231],a[40:43],a[168:171],v[228:231]
M v[232:235],a[48:51],a[168:171],v[232:235]
M v[232:235],a[52:55],a[172:175],v[232:235]
M v[236:239],a[60:63],a[172:175],v[236:239]
M v[236:239],a[56:59],a[168:171],v[236:239]
M v[240:243],a[64:67],a[168:171],v[240:243]
M v[240:243],a[68:71],a[172:175],v[240:243]
M v[244:247],a[76:79],a[172:175],v[244:247]
M v[244:247],a[72:75],a[168:171],v[244:247]
M v[248:251],a[80:83],a[168:171],v[248:251]
M v[248:251],a[84:87],a[172:175],v[248:251]
s_waitcnt lgkmcnt(0)
M v[252:255],a[92:95],a[172:175],v[252:255]
M v[252:255],a[88:91],a[168:171],v[252:255]
M a[0:3],a[96:99],a[160:163],a[0:3]
R a[168:171],v5,2048
R a[172:175],v6,2048
M a[0:3],a[100:103],a[164:167],a[0:3]
T a[32:33],v1,32768
T a[34:35],v1,33792
M a[4:7],a[108:111],a[164:167],a[4:7]
SA m0,s24,49152
M a[4:7],a[104:107],a[160:163],a[4:7]
buffer_load_dwordx4 v12, s[48:51], s22 offen offset:0   lds
M a[8:11],a[112:115],a[160:163],a[8:11]
M a[8:11],a[116:119],a[164:167],a[8:11]
s_lshl_b32 s64, s20, 10
M a[12:15],a[124:127],a[164:167],a[12:15]
SA s64,s64,159744
T a[36:37],v1,40960
T a[38:39],v1,41984
M a[12:15],a[120:123],a[160:163],a[12:15]
v_add_u32 v21, s64, v7
ds_write_b128 v21, v[16:19]
M a[16:19],a[128:131],a[160:163],a[16:19]
s_mul_i32 s67, s86, 14336
buffer_load_dwordx4 v13, s[48:51], s22 offen offset:1024   lds
M a[16:19],a[132:135],a[164:167],a[16:19]
s_mul_i32 s64, s20, 224
M a[20:23],a[140:143],a[164:167],a[20:23]
SA s67,s67,s64
v_lshrrev_b32 v28, 4, v0
v_mul_u32_u24 v28, 896, v28
M a[20:23],a[136:139],a[160:163],a[20:23]
T a[40:41],v2,32768
T a[42:43],v2,33792
M a[24:27],a[144:147],a[160:163],a[24:27]
v_and_b32 v29, 15, v0
v_lshl_add_u32 v28, v29, 4, v28
M a[24:27],a[148:151],a[164:167],a[24:27]
s_waitcnt lgkmcnt(7)
buffer_load_dwordx4 v14, s[48:51], s22 offen offset:2048   lds
M a[28:31],a[156:159],a[164:167],a[28:31]
v_mov_b32 v30, 536870912
v_cmp_gt_u32 vcc, 14, v29
M a[28:31],a[152:155],a[160:163],a[28:31]
s_nop 0
M v[32:35],a[96:99],a[168:171],v[32:35]
s_nop 0
R a[160:163],v5,4096
R a[164:167],v6,4096
M v[32:35],a[100:103],a[172:175],v[32:35]
T a[44:45],v2,40960
T a[46:47],v2,41984
M v[36:39],a[108:111],a[172:175],v[36:39]
buffer_load_dwordx4 v15, s[48:51], s22 offen offset:3072   lds
M v[36:39],a[104:107],a[168:171],v[36:39]
s_sub_u32 s22, s22, 1048448
v_cndmask_b32 v28, v30, v28, vcc
v_add_u32 v29, 2560, v28
M v[40:43],a[112:115],a[168:171],v[40:43]
v_add_u32 v30, 5120, v28
v_add_u32 v31, 7680, v28
M v[40:43],a[116:119],a[172:175],v[40:43]
T a[48:49],v3,32768
T a[50:51],v3,33792
M v[44:47],a[124:127],a[172:175],v[44:47]
SA m0,s23,16384
M v[44:47],a[120:123],a[168:171],v[44:47]
buffer_load_dwordx4 v8, s[16:19], s21 offen offset:0  nt lds
M v[48:51],a[128:131],a[168:171],v[48:51]
M v[48:51],a[132:135],a[172:175],v[48:51]
M v[52:55],a[140:143],a[172:175],v[52:55]
s_nop 0
T a[52:53],v3,40960
T a[54:55],v3,41984
M v[52:55],a[136:139],a[168:171],v[52:55]
M v[56:59],a[144:147],a[168:171],v[56:59]
buffer_load_dwordx4 v9, s[16:19], s21 offen offset:1024  nt lds
M v[56:59],a[148:151],a[172:175],v[56:59]
s_waitcnt lgkmcnt(6)
M v[60:63],a[156:159],a[172:175],v[60:63]
M v[60:63],a[152:155],a[168:171],v[60:63]
s_nop 0
T a[56:57],v4,32768
T a[58:59],v4,33792
M v[64:67],a[96:99],a[160:163],v[64:67]
R a[168:171],v5,6144
R a[172:175],v6,6144
M v[64:67],a[100:103],a[164:167],v[64:67]
buffer_load_dwordx4 v10, s[16:19], s21 offen offset:2048  nt lds
M v[68:71],a[108:111],a[164:167],v[68:71]
M v[68:71],a[104:107],a[160:163],v[68:71]
M v[72:75],a[112:115],a[160:163],v[72:75]
s_nop 0
T a[60:61],v4,40960
T a[62:63],v4,41984
M v[72:75],a[116:119],a[164:167],v[72:75]
M v[76:79],a[124:127],a[164:167],v[76:79]
buffer_load_dwordx4 v11, s[16:19], s21 offen offset:3072  nt lds
M v[76:79],a[120:123],a[160:163],v[76:79]
SA s21,s21,524160
M v[80:83],a[128:131],a[160:163],v[80:83]
M v[80:83],a[132:135],a[164:167],v[80:83]
M v[84:87],a[140:143],a[164:167],v[84:87]
M v[84:87],a[136:139],a[160:163],v[84:87]
M v[88:91],a[144:147],a[160:163],v[88:91]
M v[88:91],a[148:151],a[164:167],v[88:91]
s_waitcnt lgkmcnt(2)
M v[92:95],a[156:159],a[164:167],v[92:95]
s_waitcnt vmcnt(16) lgkmcnt(0)
M v[92:95],a[152:155],a[160:163],v[92:95]
s_barrier
M v[96:99],a[96:99],a[168:171],v[96:99]
R a[160:163],v5,16384
R a[164:167],v6,16384
M v[96:99],a[100:103],a[172:175],v[96:99]
M v[100:103],a[108:111],a[172:175],v[100:103]
SA m0,s24,0
T a[64:65],v1,49152
T a[66:67],v1,50176
M v[100:103],a[104:107],a[168:171],v[100:103]
buffer_load_dwordx4 v12, s[48:51], s22 offen offset:0   lds
M v[104:107],a[112:115],a[168:171],v[104:107]
M v[104:107],a[116:119],a[172:175],v[104:107]
M v[108:111],a[124:127],a[172:175],v[108:111]
M v[108:111],a[120:123],a[168:171],v[108:111]
buffer_load_dwordx4 v13, s[48:51], s22 offen offset:1024   lds
M v[112:115],a[128:131],a[168:171],v[112:115]
M v[112:115],a[132:135],a[172:175],v[112:115]
s_nop 0
T a[68:69],v1,57344
T a[70:71],v1,58368
M v[116:119],a[140:143],a[172:175],v[116:119]
M v[116:119],a[136:139],a[168:171],v[116:119]
M v[120:123],a[144:147],a[168:171],v[120:123]
buffer_load_dwordx4 v14, s[48:51], s22 offen offset:2048   lds
M v[120:123],a[148:151],a[172:175],v[120:123]
s_waitcnt lgkmcnt(4)
M v[124:127],a[156:159],a[172:175],v[124:127]
M v[124:127],a[152:155],a[168:171],v[124:127]
M v[128:131],a[96:99],a[160:163],v[128:131]
R a[168:171],v5,18432
R a[172:175],v6,18432
M v[128:131],a[100:103],a[164:167],v[128:131]
T a[72:73],v2,49152
T a[74:75],v2,50176
M v[132:135],a[108:111],a[164:167],v[132:135]
buffer_load_dwordx4 v15, s[48:51], s22 offen offset:3072   lds
M v[132:135],a[104:107],a[160:163],v[132:135]
SA s22,s22,1048576
M v[136:139],a[112:115],a[160:163],v[136:139]
M v[136:139],a[116:119],a[164:167],v[136:139]
SA m0,s23,32768
M v[140:143],a[124:127],a[164:167],v[140:143]
buffer_load_dwordx4 v8, s[16:19], s21 offen offset:0  nt lds
M v[140:143],a[120:123],a[160:163],v[140:143]
s_nop 0
T a[76:77],v2,57344
T a[78:79],v2,58368
M v[144:147],a[128:131],a[160:163],v[144:147]
M v[144:147],a[132:135],a[164:167],v[144:147]
M v[148:151],a[140:143],a[164:167],v[148:151]
buffer_load_dwordx4 v9, s[16:19], s21 offen offset:1024  nt lds
M v[148:151],a[136:139],a[160:163],v[148:151]
M v[152:155],a[144:147],a[160:163],v[152:155]
M v[152:155],a[148:151],a[164:167],v[152:155]
s_waitcnt lgkmcnt(4)
M v[156:159],a[156:159],a[164:167],v[156:159]
s_nop 0
T a[80:81],v3,49152
T a[82:83],v3,50176
M v[156:159],a[152:155],a[160:163],v[156:159]
buffer_load_dwordx4 v10, s[16:19], s21 offen offset:2048  nt lds
M v[160:163],a[96:99],a[168:171],v[160:163]
R a[160:163],v5,20480
R a[164:167],v6,20480
M v[160:163],a[100:103],a[172:175],v[160:163]
M v[164:167],a[108:111],a[172:175],v[164:167]
M v[164:167],a[104:107],a[168:171],v[164:167]
M v[168:171],a[112:115],a[168:171],v[168:171]
buffer_load_dwordx4 v11, s[16:19], s21 offen offset:3072  nt lds
M v[168:171],a[116:119],a[172:175],v[168:171]
SA s21,s21,128
T a[84:85],v3,57344
T a[86:87],v3,58368
M v[172:175],a[124:127],a[172:175],v[172:175]
M v[172:175],a[120:123],a[168:171],v[172:175]
M v[176:179],a[128:131],a[168:171],v[176:179]
SA m0,s87,0
M v[176:179],a[132:135],a[172:175],v[176:179]
buffer_load_dwordx4 v28, s[68:71], s67 offen offset:0 nt lds
M v[180:183],a[140:143],a[172:175],v[180:183]
M v[180:183],a[136:139],a[168:171],v[180:183]
M v[184:187],a[144:147],a[168:171],v[184:187]
s_nop 0
T a[88:89],v4,49152
T a[90:91],v4,50176
M v[184:187],a[148:151],a[172:175],v[184:187]
s_waitcnt lgkmcnt(4)
buffer_load_dwordx4 v29, s[68:71], s67 offen offset:1024 nt lds
M v[188:191],a[156:159],a[172:175],v[188:191]
M v[188:191],a[152:155],a[168:171],v[188:191]
M v[192:195],a[96:99],a[160:163],v[192:195]
R a[168:171],v5,22528
R a[172:175],v6,22528
M v[192:195],a[100:103],a[164:167],v[192:195]
M v[196:199],a[108:111],a[164:167],v[196:199]
buffer_load_dwordx4 v30, s[68:71], s67 offen offset:2048 nt lds
M v[196:199],a[104:107],a[160:163],v[196:199]
s_nop 0
T a[92:93],v4,57344
T a[94:95],v4,58368
M v[200:203],a[112:115],a[160:163],v[200:203]
M v[200:203],a[116:119],a[164:167],v[200:203]
M v[204:207],a[124:127],a[164:167],v[204:207]
L_w_kv05:
s_cbranch_execz L_wd1
M v[204:207],a[120:123],a[160:163],v[204:207]
buffer_load_dwordx4 v31, s[68:71], s67 offen offset:3072 nt lds
M v[208:211],a[128:131],a[160:163],v[208:211]
SA s67,s67,0
M v[208:211],a[132:135],a[164:167],v[208:211]
M v[212:215],a[140:143],a[164:167],v[212:215]
M v[212:215],a[136:139],a[160:163],v[212:215]
M v[216:219],a[144:147],a[160:163],v[216:219]
M v[216:219],a[148:151],a[164:167],v[216:219]
s_waitcnt lgkmcnt(2)
M v[220:223],a[156:159],a[164:167],v[220:223]
s_waitcnt vmcnt(20) lgkmcnt(0)
M v[220:223],a[152:155],a[160:163],v[220:223]
s_barrier
M v[224:227],a[96:99],a[168:171],v[224:227]
R a[160:163],v5,32768
R a[164:167],v6,32768
M v[224:227],a[100:103],a[172:175],v[224:227]
M v[228:231],a[108:111],a[172:175],v[228:231]
M v[228:231],a[104:107],a[168:171],v[228:231]
M v[232:235],a[112:115],a[168:171],v[232:235]
M v[232:235],a[116:119],a[172:175],v[232:235]
M v[236:239],a[124:127],a[172:175],v[236:239]
M v[236:239],a[120:123],a[168:171],v[236:239]
M v[240:243],a[128:131],a[168:171],v[240:243]
M v[240:243],a[132:135],a[172:175],v[240:243]
M v[244:247],a[140:143],a[172:175],v[244:247]
M v[244:247],a[136:139],a[168:171],v[244:247]
M v[248:251],a[144:147],a[168:171],v[248:251]
M v[248:251],a[148:151],a[172:175],v[248:251]
s_waitcnt lgkmcnt(0)
M v[252:255],a[156:159],a[172:175],v[252:255]
M v[252:255],a[152:155],a[168:171],v[252:255]
M a[0:3],a[32:35],a[160:163],a[0:3]
R a[168:171],v5,34816
R a[172:175],v6,34816
M a[0:3],a[36:39],a[164:167],a[0:3]
T a[96:97],v1,0
T a[98:99],v1,1024
M a[4:7],a[44:47],a[164:167],a[4:7]
SA m0,s24,16384
C v23,v23,v23
M a[4:7],a[40:43],a[160:163],a[4:7]
buffer_load_dwordx4 v12, s[48:51], s22 offen offset:0   lds
M a[8:11],a[48:51],a[160:163],a[8:11]
v_and_b32 v23, 0xffff0000, v23
M a[8:11],a[52:55],a[164:167],a[8:11]
MF v22,0xbfb8aa3b,v23
M a[12:15],a[60:63],a[164:167],a[12:15]
s_nop 0
T a[100:101],v1,8192
T a[102:103],v1,9216
M a[12:15],a[56:59],a[160:163],a[12:15]
E v22,v22
M a[16:19],a[64:67],a[160:163],a[16:19]
buffer_load_dwordx4 v13, s[48:51], s22 offen offset:1024   lds
M a[16:19],a[68:71],a[164:167],a[16:19]
AF v22,1.0,v22
M a[20:23],a[76:79],a[164:167],a[20:23]
v_rcp_f32 v23, v22
M a[20:23],a[72:75],a[160:163],a[20:23]
s_or_b32 s64, s31, s20
T a[104:105],v2,0
T a[106:107],v2,1024
M a[24:27],a[80:83],a[160:163],a[24:27]
s_min_u32 s64, s64, 1
s_lshl_b32 s64, s64, 29
v_lshrrev_b32 v22, 1, v0
M a[24:27],a[84:87],a[164:167],a[24:27]
s_waitcnt lgkmcnt(6)
buffer_load_dwordx4 v14, s[48:51], s22 offen offset:2048   lds
M a[28:31],a[92:95],a[164:167],a[28:31]
v_min_u32 v22, 1, v22
M a[28:31],a[88:91],a[160:163],a[28:31]
v_lshlrev_b32 v22, 29, v22
M v[32:35],a[32:35],a[168:171],v[32:35]
R a[160:163],v5,36864
R a[164:167],v6,36864
M v[32:35],a[36:39],a[172:175],v[32:35]
T a[108:109],v2,8192
T a[110:111],v2,9216
M v[36:39],a[44:47],a[172:175],v[36:39]
buffer_load_dwordx4 v15, s[48:51], s22 offen offset:3072   lds
M v[36:39],a[40:43],a[168:171],v[36:39]
s_sub_u32 s22, s22, 1048448
v_lshl_or_b32 v22, v0, 2, v22
M v[40:43],a[48:51],a[168:171],v[40:43]
v_or_b32 v22, s64, v22
M v[40:43],a[52:55],a[172:175],v[40:43]
s_nop 0
T a[112:113],v3,0
T a[114:115],v3,1024
M v[44:47],a[60:63],a[172:175],v[44:47]
SA m0,s23,49152
C v23,v23,v23
M v[44:47],a[56:59],a[168:171],v[44:47]
buffer_load_dwordx4 v8, s[16:19], s21 offen offset:0  nt lds
M v[48:51],a[64:67],a[168:171],v[48:51]
v_and_b32 v23, 0xffff0000, v23
M v[48:51],a[68:71],a[172:175],v[48:51]
s_lshl_b32 s64, s41, 7
M v[52:55],a[76:79],a[172:175],v[52:55]
SA s64,s64,104890368
T a[116:117],v3,8192
T a[118:119],v3,9216
M v[52:55],a[72:75],a[168:171],v[52:55]
buffer_store_dword v24, v22, s[8:11], s64 offen sc1
M v[56:59],a[80:83],a[168:171],v[56:59]
buffer_load_dwordx4 v9, s[16:19], s21 offen offset:1024  nt lds
M v[56:59],a[84:87],a[172:175],v[56:59]
s_waitcnt lgkmcnt(6)
buffer_store_dword v23, v22, s[8:11], s64 offen offset:8 sc1
M v[60:63],a[92:95],a[172:175],v[60:63]
v_add_u32 v25, 159744, v7
M v[60:63],a[88:91],a[168:171],v[60:63]
s_nop 0
T a[120:121],v4,0
T a[122:123],v4,1024
M v[64:67],a[32:35],a[160:163],v[64:67]
R a[168:171],v5,38912
R a[172:175],v6,38912
M v[64:67],a[36:39],a[164:167],v[64:67]
buffer_load_dwordx4 v10, s[16:19], s21 offen offset:2048  nt lds
M v[68:71],a[44:47],a[164:167],v[68:71]
ds_read_b128 v[16:19], v25
M v[68:71],a[40:43],a[160:163],v[68:71]
R v[28:31],v25,1024
M v[72:75],a[48:51],a[160:163],v[72:75]
s_nop 0
T a[124:125],v4,8192
T a[126:127],v4,9216
M v[72:75],a[52:55],a[164:167],v[72:75]
R v[20:23],v25,2048
M v[76:79],a[60:63],a[164:167],v[76:79]
buffer_load_dwordx4 v11, s[16:19], s21 offen offset:3072  nt lds
M v[76:79],a[56:59],a[160:163],v[76:79]
SA s21,s21,524160
M v[80:83],a[64:67],a[160:163],v[80:83]
M v[80:83],a[68:71],a[164:167],v[80:83]
M v[84:87],a[76:79],a[164:167],v[84:87]
M v[84:87],a[72:75],a[160:163],v[84:87]
M v[88:91],a[80:83],a[160:163],v[88:91]
M v[88:91],a[84:87],a[164:167],v[88:91]
s_waitcnt lgkmcnt(5)
s_waitcnt lgkmcnt(3)
AF v16,v28,v16
M v[92:95],a[92:95],a[164:167],v[92:95]
s_waitcnt vmcnt(22) lgkmcnt(0)
AF v17,v29,v17
M v[92:95],a[88:91],a[160:163],v[92:95]
s_barrier
M v[96:99],a[32:35],a[168:171],v[96:99]
R a[160:163],v5,49152
R a[164:167],v6,49152
M v[96:99],a[36:39],a[172:175],v[96:99]
AF v18,v30,v18
M v[100:103],a[44:47],a[172:175],v[100:103]
SA m0,s24,32768
T a[128:129],v1,16384
T a[130:131],v1,17408
M v[100:103],a[40:43],a[168:171],v[100:103]
buffer_load_dwordx4 v12, s[48:51], s22 offen offset:0   lds
M v[104:107],a[48:51],a[168:171],v[104:107]
AF v19,v31,v19
M v[104:107],a[52:55],a[172:175],v[104:107]
R v[28:31],v25,3072
M v[108:111],a[60:63],a[172:175],v[108:111]
C v25,v16,v17
M v[108:111],a[56:59],a[168:171],v[108:111]
v_lshlrev_b32 v16, 16, v25
M v[112:115],a[64:67],a[168:171],v[112:115]
v_and_b32 v17, 0xffff0000, v25
M v[112:115],a[68:71],a[172:175],v[112:115]
s_nop 0
T a[132:133],v1,24576
T a[134:135],v1,25600
M v[116:119],a[76:79],a[172:175],v[116:119]
buffer_load_dwordx4 v13, s[48:51], s22 offen offset:1024   lds
M v[116:119],a[72:75],a[168:171],v[116:119]
C v25,v18,v19
M v[120:123],a[80:83],a[168:171],v[120:123]
v_lshlrev_b32 v18, 16, v25
M v[120:123],a[84:87],a[172:175],v[120:123]
s_waitcnt lgkmcnt(5)
v_and_b32 v19, 0xffff0000, v25
M v[124:127],a[92:95],a[172:175],v[124:127]
s_waitcnt lgkmcnt(2)
AF v20,v28,v20
M v[124:127],a[88:91],a[168:171],v[124:127]
AF v21,v29,v21
M v[128:131],a[32:35],a[160:163],v[128:131]
R a[168:171],v5,51200
R a[172:175],v6,51200
M v[128:131],a[36:39],a[164:167],v[128:131]
T a[136:137],v2,16384
T a[138:139],v2,17408
M v[132:135],a[44:47],a[164:167],v[132:135]
buffer_load_dwordx4 v14, s[48:51], s22 offen offset:2048   lds
M v[132:135],a[40:43],a[160:163],v[132:135]
AF v22,v30,v22
M v[136:139],a[48:51],a[160:163],v[136:139]
AF v23,v31,v23
M v[136:139],a[52:55],a[164:167],v[136:139]
MF v28,0xbfb8aa3b,v16
M v[140:143],a[60:63],a[164:167],v[140:143]
MF v29,0xbfb8aa3b,v17
M v[140:143],a[56:59],a[160:163],v[140:143]
s_nop 0
T a[140:141],v2,24576
T a[142:143],v2,25600
M v[144:147],a[64:67],a[160:163],v[144:147]
buffer_load_dwordx4 v15, s[48:51], s22 offen offset:3072   lds
M v[144:147],a[68:71],a[164:167],v[144:147]
SA s22,s22,1048576
MF v30,0xbfb8aa3b,v18
M v[148:151],a[76:79],a[164:167],v[148:151]
MF v31,0xbfb8aa3b,v19
M v[148:151],a[72:75],a[160:163],v[148:151]
E v28,v28
M v[152:155],a[80:83],a[160:163],v[152:155]
E v29,v29
M v[152:155],a[84:87],a[164:167],v[152:155]
s_waitcnt lgkmcnt(4)
E v30,v30
M v[156:159],a[92:95],a[164:167],v[156:159]
SA m0,s23,0
T a[144:145],v3,16384
T a[146:147],v3,17408
M v[156:159],a[88:91],a[160:163],v[156:159]
buffer_load_dwordx4 v8, s[16:19], s21 offen offset:0  nt lds
M v[160:163],a[32:35],a[168:171],v[160:163]
R a[160:163],v5,53248
R a[164:167],v6,53248
M v[160:163],a[36:39],a[172:175],v[160:163]
E v31,v31
M v[164:167],a[44:47],a[172:175],v[164:167]
C v25,v20,v21
M v[164:167],a[40:43],a[168:171],v[164:167]
v_lshlrev_b32 v20, 16, v25
M v[168:171],a[48:51],a[168:171],v[168:171]
v_and_b32 v21, 0xffff0000, v25
M v[168:171],a[52:55],a[172:175],v[168:171]
s_nop 0
T a[148:149],v3,24576
T a[150:151],v3,25600
M v[172:175],a[60:63],a[172:175],v[172:175]
buffer_load_dwordx4 v9, s[16:19], s21 offen offset:1024  nt lds
M v[172:175],a[56:59],a[168:171],v[172:175]
C v25,v22,v23
M v[176:179],a[64:67],a[168:171],v[176:179]
v_lshlrev_b32 v22, 16, v25
M v[176:179],a[68:71],a[172:175],v[176:179]
v_and_b32 v23, 0xffff0000, v25
M v[180:183],a[76:79],a[172:175],v[180:183]
AF v28,1.0,v28
M v[180:183],a[72:75],a[168:171],v[180:183]
AF v29,1.0,v29
M v[184:187],a[80:83],a[168:171],v[184:187]
s_nop 0
T a[152:153],v4,16384
T a[154:155],v4,17408
M v[184:187],a[84:87],a[172:175],v[184:187]
s_waitcnt lgkmcnt(4)
buffer_load_dwordx4 v10, s[16:19], s21 offen offset:2048  nt lds
M v[188:191],a[92:95],a[172:175],v[188:191]
AF v30,1.0,v30
M v[188:191],a[88:91],a[168:171],v[188:191]
AF v31,1.0,v31
M v[192:195],a[32:35],a[160:163],v[192:195]
R a[168:171],v5,55296
R a[172:175],v6,55296
M v[192:195],a[36:39],a[164:167],v[192:195]
v_rcp_f32 v28, v28
M v[196:199],a[44:47],a[164:167],v[196:199]
v_rcp_f32 v29, v29
M v[196:199],a[40:43],a[160:163],v[196:199]
T a[156:157],v4,24576
T a[158:159],v4,25600
M v[200:203],a[48:51],a[160:163],v[200:203]
buffer_load_dwordx4 v11, s[16:19], s21 offen offset:3072  nt lds
M v[200:203],a[52:55],a[164:167],v[200:203]
SA s21,s21,128
v_rcp_f32 v30, v30
M v[204:207],a[60:63],a[164:167],v[204:207]
v_rcp_f32 v31, v31
M v[204:207],a[56:59],a[160:163],v[204:207]
MF v16,v28,v16
M v[208:211],a[64:67],a[160:163],v[208:211]
MF v17,v29,v17
M v[208:211],a[68:71],a[164:167],v[208:211]
MF v18,v30,v18
M v[212:215],a[76:79],a[164:167],v[212:215]
MF v19,v31,v19
M v[212:215],a[72:75],a[160:163],v[212:215]
C v25,v16,v17
M v[216:219],a[80:83],a[160:163],v[216:219]
v_lshlrev_b32 v16, 16, v25
M v[216:219],a[84:87],a[164:167],v[216:219]
s_waitcnt lgkmcnt(2)
v_and_b32 v17, 0xffff0000, v25
M v[220:223],a[92:95],a[164:167],v[220:223]
s_waitcnt vmcnt(22) lgkmcnt(0)
C v25,v18,v19
M v[220:223],a[88:91],a[160:163],v[220:223]
s_barrier
M v[224:227],a[32:35],a[168:171],v[224:227]
R a[160:163],v5,0
R a[164:167],v6,0
M v[224:227],a[36:39],a[172:175],v[224:227]
v_lshlrev_b32 v18, 16, v25
M v[228:231],a[44:47],a[172:175],v[228:231]
v_and_b32 v19, 0xffff0000, v25
M v[228:231],a[40:43],a[168:171],v[228:231]
MF v16,v20,v16
M v[232:235],a[48:51],a[168:171],v[232:235]
MF v17,v21,v17
M v[232:235],a[52:55],a[172:175],v[232:235]
MF v18,v22,v18
M v[236:239],a[60:63],a[172:175],v[236:239]
MF v19,v23,v19
M v[236:239],a[56:59],a[168:171],v[236:239]
C v16,v16,v17
M v[240:243],a[64:67],a[168:171],v[240:243]
C v17,v18,v19
M v[240:243],a[68:71],a[172:175],v[240:243]
M v[244:247],a[76:79],a[172:175],v[244:247]
M v[244:247],a[72:75],a[168:171],v[244:247]
M v[248:251],a[80:83],a[168:171],v[248:251]
M v[248:251],a[84:87],a[172:175],v[248:251]
s_waitcnt lgkmcnt(0)
M v[252:255],a[92:95],a[172:175],v[252:255]
M v[252:255],a[88:91],a[168:171],v[252:255]
M a[0:3],a[96:99],a[160:163],a[0:3]
R a[168:171],v5,2048
R a[172:175],v6,2048
M a[0:3],a[100:103],a[164:167],a[0:3]
T a[32:33],v1,32768
T a[34:35],v1,33792
M a[4:7],a[108:111],a[164:167],a[4:7]
SA m0,s24,49152
v_lshrrev_b32 v28, 4, v0
v_and_b32 v29, 7, v0
M a[4:7],a[104:107],a[160:163],a[4:7]
buffer_load_dwordx4 v12, s[48:51], s22 offen offset:0   lds
M a[8:11],a[112:115],a[160:163],a[8:11]
v_xor_b32 v28, v28, v29
v_lshlrev_b32 v28, 4, v28
M a[8:11],a[116:119],a[164:167],a[8:11]
v_lshrrev_b32 v29, 3, v0
v_mul_u32_u24 v29, 896, v29
M a[12:15],a[124:127],a[164:167],a[12:15]
T a[36:37],v1,40960
T a[38:39],v1,41984
M a[12:15],a[120:123],a[160:163],a[12:15]
v_add_u32 v22, v28, v29
v_xor_b32 v28, 64, v28
M a[16:19],a[128:131],a[160:163],a[16:19]
s_mul_i32 s64, s20, 14336
buffer_load_dwordx4 v13, s[48:51], s22 offen offset:1024   lds
M a[16:19],a[132:135],a[164:167],a[16:19]
s_sub_u32 s65, 98304, s64
M a[20:23],a[140:143],a[164:167],a[20:23]
SA s30,s29,s65
M a[20:23],a[136:139],a[160:163],a[20:23]
SA s29,s29,s64
T a[40:41],v2,32768
T a[42:43],v2,33792
M a[24:27],a[144:147],a[160:163],a[24:27]
v_add_u32 v29, 6144, v29
v_add_u32 v23, v28, v29
M a[24:27],a[148:151],a[164:167],a[24:27]
s_waitcnt lgkmcnt(6)
buffer_load_dwordx4 v14, s[48:51], s22 offen offset:2048   lds
M a[28:31],a[156:159],a[164:167],a[28:31]
s_and_b32 s64, s20, 1
M a[28:31],a[152:155],a[160:163],a[28:31]
s_lshl_b32 s64, s64, 12
M v[32:35],a[96:99],a[168:171],v[32:35]
SA s64,s64,65536
R a[160:163],v5,4096
R a[164:167],v6,4096
M v[32:35],a[100:103],a[172:175],v[32:35]
T a[44:45],v2,40960
T a[46:47],v2,41984
M v[36:39],a[108:111],a[172:175],v[36:39]
buffer_load_dwordx4 v15, s[48:51], s22 offen offset:3072   lds
M v[36:39],a[104:107],a[168:171],v[36:39]
s_sub_u32 s22, s22, 1048448
v_add_u32 v20, s64, v5
v_add_u32 v21, s64, v6
M v[40:43],a[112:115],a[168:171],v[40:43]
v_lshrrev_b32 v28, 2, v0
v_lshlrev_b32 v28, 8, v28
M v[40:43],a[116:119],a[172:175],v[40:43]
T a[48:49],v3,32768
T a[50:51],v3,33792
M v[44:47],a[124:127],a[172:175],v[44:47]
SA m0,s23,16384
v_and_b32 v29, 3, v0
v_lshl_add_u32 v28, v29, 3, v28
M v[44:47],a[120:123],a[168:171],v[44:47]
buffer_load_dwordx4 v8, s[16:19], s21 offen offset:0  nt lds
M v[48:51],a[128:131],a[168:171],v[48:51]
v_add_u32 v28, s87, v28
M v[48:51],a[132:135],a[172:175],v[48:51]
s_waitcnt vmcnt(23)
s_nop 0
T a[176:177],v28,0
T a[178:179],v28,32
M v[52:55],a[140:143],a[172:175],v[52:55]
T a[52:53],v3,40960
T a[54:55],v3,41984
M v[52:55],a[136:139],a[168:171],v[52:55]
T a[180:181],v28,64
T a[182:183],v28,96
M v[56:59],a[144:147],a[168:171],v[56:59]
buffer_load_dwordx4 v9, s[16:19], s21 offen offset:1024  nt lds
M v[56:59],a[148:151],a[172:175],v[56:59]
s_waitcnt lgkmcnt(10)
s_nop 0
T a[184:185],v28,128
T a[186:187],v28,160
M v[60:63],a[156:159],a[172:175],v[60:63]
T a[188:189],v28,192
M v[60:63],a[152:155],a[168:171],v[60:63]
s_nop 0
T a[56:57],v4,32768
T a[58:59],v4,33792
M v[64:67],a[96:99],a[160:163],v[64:67]
R a[168:171],v5,6144
R a[172:175],v6,6144
M v[64:67],a[100:103],a[164:167],v[64:67]
buffer_load_dwordx4 v10, s[16:19], s21 offen offset:2048  nt lds
s_waitcnt lgkmcnt(12)
v_mfma_f32_16x16x16_bf16 a[192:195], a[176:177], v[16:17], 0
M v[68:71],a[108:111],a[164:167],v[68:71]
v_mov_b32 v18, v16 row_shr:2 row_mask:0xf bank_mask:0xf bound_ctrl:0
v_mov_b32 v19, v17 row_shr:2 row_mask:0xf bank_mask:0xf bound_ctrl:0
M v[68:71],a[104:107],a[160:163],v[68:71]
M v[72:75],a[112:115],a[160:163],v[72:75]
s_nop 0
T a[60:61],v4,40960
T a[62:63],v4,41984
M v[72:75],a[116:119],a[164:167],v[72:75]
s_waitcnt lgkmcnt(13)
v_mfma_f32_16x16x16_bf16 a[192:195], a[178:179], v[18:19], a[192:195]
M v[76:79],a[124:127],a[164:167],v[76:79]
buffer_load_dwordx4 v11, s[16:19], s21 offen offset:3072  nt lds
M v[76:79],a[120:123],a[160:163],v[76:79]
SA s21,s21,524160
v_mov_b32 v16, v18 row_shr:2 row_mask:0xf bank_mask:0xf bound_ctrl:0
v_mov_b32 v17, v19 row_shr:2 row_mask:0xf bank_mask:0xf bound_ctrl:0
M v[80:83],a[128:131],a[160:163],v[80:83]
M v[80:83],a[132:135],a[164:167],v[80:83]
s_waitcnt lgkmcnt(10)
v_mfma_f32_16x16x16_bf16 a[192:195], a[180:181], v[16:17], a[192:195]
M v[84:87],a[140:143],a[164:167],v[84:87]
v_mov_b32 v18, v16 row_shr:2 row_mask:0xf bank_mask:0xf bound_ctrl:0
v_mov_b32 v19, v17 row_shr:2 row_mask:0xf bank_mask:0xf bound_ctrl:0
M v[84:87],a[136:139],a[160:163],v[84:87]
M v[88:91],a[144:147],a[160:163],v[88:91]
M v[88:91],a[148:151],a[164:167],v[88:91]
s_waitcnt lgkmcnt(2)
v_mfma_f32_16x16x16_bf16 a[192:195], a[182:183], v[18:19], a[192:195]
M v[92:95],a[156:159],a[164:167],v[92:95]
s_waitcnt vmcnt(16) lgkmcnt(0)
v_mov_b32 v16, v18 row_shr:2 row_mask:0xf bank_mask:0xf bound_ctrl:0
v_mov_b32 v17, v19 row_shr:2 row_mask:0xf bank_mask:0xf bound_ctrl:0
M v[92:95],a[152:155],a[160:163],v[92:95]
s_barrier
M v[96:99],a[96:99],a[168:171],v[96:99]
R a[160:163],v5,16384
R a[164:167],v6,16384
M v[96:99],a[100:103],a[172:175],v[96:99]
SA m0,s23,131072
v_mfma_f32_16x16x16_bf16 a[192:195], a[184:185], v[16:17], a[192:195]
M v[100:103],a[108:111],a[172:175],v[100:103]
s_nop 0
T a[64:65],v1,49152
T a[66:67],v1,50176
M v[100:103],a[104:107],a[168:171],v[100:103]
v_mov_b32 v18, v16 row_shr:2 row_mask:0xf bank_mask:0xf bound_ctrl:0
v_mov_b32 v19, v17 row_shr:2 row_mask:0xf bank_mask:0xf bound_ctrl:0
M v[104:107],a[112:115],a[168:171],v[104:107]
buffer_load_dwordx4 v22, s[56:59], s29 offen offset:0 lds
M v[104:107],a[116:119],a[172:175],v[104:107]
v_mfma_f32_16x16x16_bf16 a[192:195], a[186:187], v[18:19], a[192:195]
M v[108:111],a[124:127],a[172:175],v[108:111]
v_mov_b32 v16, v18 row_shr:2 row_mask:0xf bank_mask:0xf bound_ctrl:0
v_mov_b32 v17, v19 row_shr:2 row_mask:0xf bank_mask:0xf bound_ctrl:0
M v[108:111],a[120:123],a[168:171],v[108:111]
buffer_load_dwordx4 v23, s[56:59], s29 offen offset:1024 lds
M v[112:115],a[128:131],a[168:171],v[112:115]
M v[112:115],a[132:135],a[172:175],v[112:115]
s_nop 0
T a[68:69],v1,57344
T a[70:71],v1,58368
v_mfma_f32_16x16x16_bf16 a[192:195], a[188:189], v[16:17], a[192:195]
M v[116:119],a[140:143],a[172:175],v[116:119]
buffer_load_dwordx4 v22, s[56:59], s30 offen offset:2048 lds
M v[116:119],a[136:139],a[168:171],v[116:119]
v_and_b32 v29, 1, v0
v_mul_u32_u24 v30, 1792, v29
M v[120:123],a[144:147],a[168:171],v[120:123]
v_lshrrev_b32 v31, 4, v0
v_lshl_add_u32 v30, v31, 4, v30
M v[120:123],a[148:151],a[172:175],v[120:123]
s_waitcnt lgkmcnt(4)
v_bfe_u32 v29, v0, 1, 3
v_lshl_add_u32 v30, v29, 6, v30
M v[124:127],a[156:159],a[172:175],v[124:127]
v_add_u32 v29, 1, v29
v_lshrrev_b32 v29, 3, v29
M v[124:127],a[152:155],a[168:171],v[124:127]
v_lshl_or_b32 v30, v29, 29, v30
v_or_b32 v30, s88, v30
M v[128:131],a[96:99],a[160:163],v[128:131]
s_mul_i32 s89, s86, 3584
R a[168:171],v5,18432
R a[172:175],v6,18432
M v[128:131],a[100:103],a[164:167],v[128:131]
s_mul_i32 s64, s20, 448
T a[72:73],v2,49152
T a[74:75],v2,50176
M v[132:135],a[108:111],a[164:167],v[132:135]
SA s89,s89,s64
M v[132:135],a[104:107],a[160:163],v[132:135]
SA s89,s89,105906176
buffer_store_dwordx4 a[192:195], v30, s[8:11], s89 offen sc1
M v[136:139],a[112:115],a[160:163],v[136:139]
M v[136:139],a[116:119],a[164:167],v[136:139]
M v[140:143],a[124:127],a[164:167],v[140:143]
buffer_load_dwordx4 v23, s[56:59], s30 offen offset:3072 lds
M v[140:143],a[120:123],a[160:163],v[140:143]
SA s29,s29,128
T a[76:77],v2,57344
T a[78:79],v2,58368
M v[144:147],a[128:131],a[160:163],v[144:147]
SA s30,s30,128
M v[144:147],a[132:135],a[164:167],v[144:147]
SA m0,s24,0
M v[148:151],a[140:143],a[164:167],v[148:151]
buffer_load_dwordx4 v12, s[48:51], s22 offen offset:0   lds
M v[148:151],a[136:139],a[160:163],v[148:151]
M v[152:155],a[144:147],a[160:163],v[152:155]
M v[152:155],a[148:151],a[164:167],v[152:155]
s_waitcnt lgkmcnt(4)
buffer_load_dwordx4 v13, s[48:51], s22 offen offset:1024   lds
M v[156:159],a[156:159],a[164:167],v[156:159]
s_nop 0
T a[80:81],v3,49152
T a[82:83],v3,50176
M v[156:159],a[152:155],a[160:163],v[156:159]
M v[160:163],a[96:99],a[168:171],v[160:163]
R a[160:163],v5,20480
R a[164:167],v6,20480
M v[160:163],a[100:103],a[172:175],v[160:163]
buffer_load_dwordx4 v14, s[48:51], s22 offen offset:2048   lds
M v[164:167],a[108:111],a[172:175],v[164:167]
M v[164:167],a[104:107],a[168:171],v[164:167]
M v[168:171],a[112:115],a[168:171],v[168:171]
buffer_load_dwordx4 v15, s[48:51], s22 offen offset:3072   lds
M v[168:171],a[116:119],a[172:175],v[168:171]
SA s22,s22,1048576
T a[84:85],v3,57344
T a[86:87],v3,58368
M v[172:175],a[124:127],a[172:175],v[172:175]
SA m0,s23,32768
M v[172:175],a[120:123],a[168:171],v[172:175]
buffer_load_dwordx4 v8, s[16:19], s21 offen offset:0  nt lds
L_w_kv06:
s_cbranch_execz L_wd1
M v[176:179],a[128:131],a[168:171],v[176:179]
M v[176:179],a[132:135],a[172:175],v[176:179]
M v[180:183],a[140:143],a[172:175],v[180:183]
M v[180:183],a[136:139],a[168:171],v[180:183]
buffer_load_dwordx4 v9, s[16:19], s21 offen offset:1024  nt lds
M v[184:187],a[144:147],a[168:171],v[184:187]
s_nop 0
T a[88:89],v4,49152
T a[90:91],v4,50176
M v[184:187],a[148:151],a[172:175],v[184:187]
s_waitcnt lgkmcnt(4)
M v[188:191],a[156:159],a[172:175],v[188:191]
M v[188:191],a[152:155],a[168:171],v[188:191]
M v[192:195],a[96:99],a[160:163],v[192:195]
R a[168:171],v5,22528
R a[172:175],v6,22528
M v[192:195],a[100:103],a[164:167],v[192:195]
buffer_load_dwordx4 v10, s[16:19], s21 offen offset:2048  nt lds
M v[196:199],a[108:111],a[164:167],v[196:199]
M v[196:199],a[104:107],a[160:163],v[196:199]
s_nop 0
T a[92:93],v4,57344
T a[94:95],v4,58368
M v[200:203],a[112:115],a[160:163],v[200:203]
M v[200:203],a[116:119],a[164:167],v[200:203]
buffer_load_dwordx4 v11, s[16:19], s21 offen offset:3072  nt lds
M v[204:207],a[124:127],a[164:167],v[204:207]
M v[204:207],a[120:123],a[160:163],v[204:207]
M v[208:211],a[128:131],a[160:163],v[208:211]
M v[208:211],a[132:135],a[164:167],v[208:211]
M v[212:215],a[140:143],a[164:167],v[212:215]
SA s21,s21,128
M v[212:215],a[136:139],a[160:163],v[212:215]
M v[216:219],a[144:147],a[160:163],v[216:219]
M v[216:219],a[148:151],a[164:167],v[216:219]
s_waitcnt lgkmcnt(2)
M v[220:223],a[156:159],a[164:167],v[220:223]
s_waitcnt vmcnt(21) lgkmcnt(0)
M v[220:223],a[152:155],a[160:163],v[220:223]
s_barrier
M v[224:227],a[96:99],a[168:171],v[224:227]
R a[160:163],v5,32768
R a[164:167],v6,32768
M v[224:227],a[100:103],a[172:175],v[224:227]
M v[228:231],a[108:111],a[172:175],v[228:231]
M v[228:231],a[104:107],a[168:171],v[228:231]
M v[232:235],a[112:115],a[168:171],v[232:235]
M v[232:235],a[116:119],a[172:175],v[232:235]
M v[236:239],a[124:127],a[172:175],v[236:239]
M v[236:239],a[120:123],a[168:171],v[236:239]
M v[240:243],a[128:131],a[168:171],v[240:243]
M v[240:243],a[132:135],a[172:175],v[240:243]
M v[244:247],a[140:143],a[172:175],v[244:247]
M v[244:247],a[136:139],a[168:171],v[244:247]
M v[248:251],a[144:147],a[168:171],v[248:251]
M v[248:251],a[148:151],a[172:175],v[248:251]
s_waitcnt lgkmcnt(0)
M v[252:255],a[156:159],a[172:175],v[252:255]
M v[252:255],a[152:155],a[168:171],v[252:255]
M a[0:3],a[32:35],a[160:163],a[0:3]
R a[168:171],v5,34816
R a[172:175],v6,34816
M a[0:3],a[36:39],a[164:167],a[0:3]
SA m0,s23,147456
T a[96:97],v1,0
T a[98:99],v1,1024
M a[4:7],a[44:47],a[164:167],a[4:7]
buffer_load_dwordx4 v22, s[56:59], s29 offen offset:0 lds
M a[4:7],a[40:43],a[160:163],a[4:7]
M a[8:11],a[48:51],a[160:163],a[8:11]
M a[8:11],a[52:55],a[164:167],a[8:11]
buffer_load_dwordx4 v23, s[56:59], s29 offen offset:1024 lds
M a[12:15],a[60:63],a[164:167],a[12:15]
s_nop 0
T a[100:101],v1,8192
T a[102:103],v1,9216
M a[12:15],a[56:59],a[160:163],a[12:15]
M a[16:19],a[64:67],a[160:163],a[16:19]
buffer_load_dwordx4 v22, s[56:59], s30 offen offset:2048 lds
M a[16:19],a[68:71],a[164:167],a[16:19]
M a[20:23],a[76:79],a[164:167],a[20:23]
M a[20:23],a[72:75],a[160:163],a[20:23]
s_nop 0
T a[104:105],v2,0
T a[106:107],v2,1024
M a[24:27],a[80:83],a[160:163],a[24:27]
buffer_load_dwordx4 v23, s[56:59], s30 offen offset:3072 lds
M a[24:27],a[84:87],a[164:167],a[24:27]
s_waitcnt lgkmcnt(6)
M a[28:31],a[92:95],a[164:167],a[28:31]
SA s29,s29,128
M a[28:31],a[88:91],a[160:163],a[28:31]
SA s30,s30,128
M v[32:35],a[32:35],a[168:171],v[32:35]
SA m0,s24,16384
R a[160:163],v5,36864
R a[164:167],v6,36864
M v[32:35],a[36:39],a[172:175],v[32:35]
T a[108:109],v2,8192
T a[110:111],v2,9216
M v[36:39],a[44:47],a[172:175],v[36:39]
buffer_load_dwordx4 v12, s[48:51], s22 offen offset:0   lds
M v[36:39],a[40:43],a[168:171],v[36:39]
M v[40:43],a[48:51],a[168:171],v[40:43]
M v[40:43],a[52:55],a[172:175],v[40:43]
s_nop 0
T a[112:113],v3,0
T a[114:115],v3,1024
M v[44:47],a[60:63],a[172:175],v[44:47]
buffer_load_dwordx4 v13, s[48:51], s22 offen offset:1024   lds
M v[44:47],a[56:59],a[168:171],v[44:47]
M v[48:51],a[64:67],a[168:171],v[48:51]
M v[48:51],a[68:71],a[172:175],v[48:51]
buffer_load_dwordx4 v14, s[48:51], s22 offen offset:2048   lds
M v[52:55],a[76:79],a[172:175],v[52:55]
s_nop 0
T a[116:117],v3,8192
T a[118:119],v3,9216
M v[52:55],a[72:75],a[168:171],v[52:55]
M v[56:59],a[80:83],a[168:171],v[56:59]
buffer_load_dwordx4 v15, s[48:51], s22 offen offset:3072   lds
M v[56:59],a[84:87],a[172:175],v[56:59]
s_waitcnt lgkmcnt(6)
M v[60:63],a[92:95],a[172:175],v[60:63]
s_sub_u32 s22, s22, 1048448
M v[60:63],a[88:91],a[168:171],v[60:63]
SA m0,s23,49152
T a[120:121],v4,0
T a[122:123],v4,1024
M v[64:67],a[32:35],a[160:163],v[64:67]
R a[168:171],v5,38912
R a[172:175],v6,38912
M v[64:67],a[36:39],a[164:167],v[64:67]
buffer_load_dwordx4 v8, s[16:19], s21 offen offset:0  nt lds
M v[68:71],a[44:47],a[164:167],v[68:71]
M v[68:71],a[40:43],a[160:163],v[68:71]
M v[72:75],a[48:51],a[160:163],v[72:75]
s_waitcnt vmcnt(17)
s_nop 0
T a[124:125],v4,8192
T a[126:127],v4,9216
M v[72:75],a[52:55],a[164:167],v[72:75]
buffer_load_dwordx4 v9, s[16:19], s21 offen offset:1024  nt lds
M v[76:79],a[60:63],a[164:167],v[76:79]
R a[176:179],v20,0
R a[180:183],v20,2048
M v[76:79],a[56:59],a[160:163],v[76:79]
R a[184:187],v21,0
R a[188:191],v21,2048
M v[80:83],a[64:67],a[160:163],v[80:83]
buffer_load_dwordx4 v10, s[16:19], s21 offen offset:2048  nt lds
M v[80:83],a[68:71],a[164:167],v[80:83]
M v[84:87],a[76:79],a[164:167],v[84:87]
M v[84:87],a[72:75],a[160:163],v[84:87]
buffer_load_dwordx4 v11, s[16:19], s21 offen offset:3072  nt lds
M v[88:91],a[80:83],a[160:163],v[88:91]
SA s21,s21,524160
M v[88:91],a[84:87],a[164:167],v[88:91]
s_waitcnt lgkmcnt(6)
M v[92:95],a[92:95],a[164:167],v[92:95]
s_waitcnt lgkmcnt(0)
M v[92:95],a[88:91],a[160:163],v[92:95]
s_barrier
M v[96:99],a[32:35],a[168:171],v[96:99]
s_lshl_b32 s4, s20, 10
R a[160:163],v5,49152
R a[164:167],v6,49152
M v[96:99],a[36:39],a[172:175],v[96:99]
SA m0,s23,131072
v_bfe_u32 v28, v0, 3, 2
M v[100:103],a[44:47],a[172:175],v[100:103]
s_nop 0
T a[128:129],v1,16384
T a[130:131],v1,17408
M v[100:103],a[40:43],a[168:171],v[100:103]
buffer_load_dwordx4 v22, s[56:59], s29 offen offset:0 lds
M v[104:107],a[48:51],a[168:171],v[104:107]
v_lshrrev_b32 v29, 5, v0
v_lshl_add_u32 v28, v29, 3, v28
M v[104:107],a[52:55],a[172:175],v[104:107]
M v[108:111],a[60:63],a[172:175],v[108:111]
buffer_load_dwordx4 v23, s[56:59], s29 offen offset:1024 lds
M v[108:111],a[56:59],a[168:171],v[108:111]
v_lshlrev_b32 v28, 13, v28
M v[112:115],a[64:67],a[168:171],v[112:115]
v_lshrrev_b32 v29, 4, v0
M v[112:115],a[68:71],a[172:175],v[112:115]
s_nop 0
T a[132:133],v1,24576
T a[134:135],v1,25600
M v[116:119],a[76:79],a[172:175],v[116:119]
buffer_load_dwordx4 v22, s[56:59], s30 offen offset:2048 lds
M v[116:119],a[72:75],a[168:171],v[116:119]
v_lshlrev_b32 v29, 1, v29
M v[120:123],a[80:83],a[168:171],v[120:123]
v_and_b32 v30, 7, v0
M v[120:123],a[84:87],a[172:175],v[120:123]
s_waitcnt lgkmcnt(4)
M v[124:127],a[92:95],a[172:175],v[124:127]
v_xor_b32 v29, v29, v30
M v[124:127],a[88:91],a[168:171],v[124:127]
buffer_load_dwordx4 v23, s[56:59], s30 offen offset:3072 lds
M v[128:131],a[32:35],a[160:163],v[128:131]
R a[168:171],v5,51200
R a[172:175],v6,51200
M v[128:131],a[36:39],a[164:167],v[128:131]
SA s29,s29,128
T a[136:137],v2,16384
T a[138:139],v2,17408
M v[132:135],a[44:47],a[164:167],v[132:135]
SA s30,s30,128
v_lshl_add_u32 v28, v29, 4, v28
M v[132:135],a[40:43],a[160:163],v[132:135]
s_and_b32 s64, s20, 1
M v[136:139],a[48:51],a[160:163],v[136:139]
s_lshl_b32 s64, s64, 17
M v[136:139],a[52:55],a[164:167],v[136:139]
s_lshr_b32 s65, s20, 1
M v[140:143],a[60:63],a[164:167],v[140:143]
s_lshl_b32 s65, s65, 15
SA s64,s64,s65
v_add_u32 v8, s64, v28
M v[140:143],a[56:59],a[160:163],v[140:143]
SA m0,s24,32768
T a[140:141],v2,24576
T a[142:143],v2,25600
M v[144:147],a[64:67],a[160:163],v[144:147]
buffer_load_dwordx4 v12, s[48:51], s22 offen offset:0   lds
M v[144:147],a[68:71],a[164:167],v[144:147]
M v[148:151],a[76:79],a[164:167],v[148:151]
M v[148:151],a[72:75],a[160:163],v[148:151]
buffer_load_dwordx4 v13, s[48:51], s22 offen offset:1024   lds
M v[152:155],a[80:83],a[160:163],v[152:155]
M v[152:155],a[84:87],a[164:167],v[152:155]
s_waitcnt lgkmcnt(4)
M v[156:159],a[92:95],a[164:167],v[156:159]
s_nop 0
T a[144:145],v3,16384
T a[146:147],v3,17408
M v[156:159],a[88:91],a[160:163],v[156:159]
buffer_load_dwordx4 v14, s[48:51], s22 offen offset:2048   lds
M v[160:163],a[32:35],a[168:171],v[160:163]
R a[160:163],v5,53248
R a[164:167],v6,53248
M v[160:163],a[36:39],a[172:175],v[160:163]
M v[164:167],a[44:47],a[172:175],v[164:167]
buffer_load_dwordx4 v15, s[48:51], s22 offen offset:3072   lds
M v[164:167],a[40:43],a[168:171],v[164:167]
M v[168:171],a[48:51],a[168:171],v[168:171]
SA s22,s22,1048576
M v[168:171],a[52:55],a[172:175],v[168:171]
s_mov_b32 s25, 0
T a[148:149],v3,24576
T a[150:151],v3,25600
M v[172:175],a[60:63],a[172:175],v[172:175]
SA m0,s4,0
M v[172:175],a[56:59],a[168:171],v[172:175]
buffer_load_dwordx4 v8, s[52:55], s25 offen lds
M v[176:179],a[64:67],a[168:171],v[176:179]
M v[176:179],a[68:71],a[172:175],v[176:179]
s_mov_b32 s25, 262144
M v[180:183],a[76:79],a[172:175],v[180:183]
SA m0,s4,4096
M v[180:183],a[72:75],a[168:171],v[180:183]
buffer_load_dwordx4 v8, s[52:55], s25 offen lds
M v[184:187],a[80:83],a[168:171],v[184:187]
s_nop 0
T a[152:153],v4,16384
T a[154:155],v4,17408
M v[184:187],a[84:87],a[172:175],v[184:187]
s_waitcnt lgkmcnt(4)
M v[188:191],a[92:95],a[172:175],v[188:191]
s_mov_b32 s25, 524288
M v[188:191],a[88:91],a[168:171],v[188:191]
SA m0,s4,8192
M v[192:195],a[32:35],a[160:163],v[192:195]
R a[168:171],v5,55296
R a[172:175],v6,55296
M v[192:195],a[36:39],a[164:167],v[192:195]
buffer_load_dwordx4 v8, s[52:55], s25 offen lds
M v[196:199],a[44:47],a[164:167],v[196:199]
M v[196:199],a[40:43],a[160:163],v[196:199]
s_mov_b32 s25, 786432
T a[156:157],v4,24576
T a[158:159],v4,25600
M v[200:203],a[48:51],a[160:163],v[200:203]
SA m0,s4,12288
M v[200:203],a[52:55],a[164:167],v[200:203]
s_waitcnt vmcnt(19)
buffer_load_dwordx4 v8, s[52:55], s25 offen lds
M v[204:207],a[60:63],a[164:167],v[204:207]
R a[192:195],v20,16384
R a[196:199],v20,18432
M v[204:207],a[56:59],a[160:163],v[204:207]
R a[200:203],v21,16384
R a[204:207],v21,18432
M v[208:211],a[64:67],a[160:163],v[208:211]
M v[208:211],a[68:71],a[164:167],v[208:211]
M v[212:215],a[76:79],a[164:167],v[212:215]
M v[212:215],a[72:75],a[160:163],v[212:215]
M v[216:219],a[80:83],a[160:163],v[216:219]
M v[216:219],a[84:87],a[164:167],v[216:219]
s_waitcnt lgkmcnt(6)
M v[220:223],a[92:95],a[164:167],v[220:223]
s_waitcnt lgkmcnt(0)
M v[220:223],a[88:91],a[160:163],v[220:223]
s_barrier
M v[224:227],a[32:35],a[168:171],v[224:227]
R a[160:163],v5,0
R a[164:167],v6,0
M v[224:227],a[36:39],a[172:175],v[224:227]
M v[228:231],a[44:47],a[172:175],v[228:231]
M v[228:231],a[40:43],a[168:171],v[228:231]
M v[232:235],a[48:51],a[168:171],v[232:235]
M v[232:235],a[52:55],a[172:175],v[232:235]
M v[236:239],a[60:63],a[172:175],v[236:239]
M v[236:239],a[56:59],a[168:171],v[236:239]
M v[240:243],a[64:67],a[168:171],v[240:243]
M v[240:243],a[68:71],a[172:175],v[240:243]
M v[244:247],a[76:79],a[172:175],v[244:247]
M v[244:247],a[72:75],a[168:171],v[244:247]
M v[248:251],a[80:83],a[168:171],v[248:251]
M v[248:251],a[84:87],a[172:175],v[248:251]
s_waitcnt lgkmcnt(0)
M v[252:255],a[92:95],a[172:175],v[252:255]
M v[252:255],a[88:91],a[168:171],v[252:255]
M a[0:3],a[96:99],a[160:163],a[0:3]
R a[168:171],v5,2048
R a[172:175],v6,2048
M a[0:3],a[100:103],a[164:167],a[0:3]
SA m0,s23,147456
T a[32:33],v1,32768
T a[34:35],v1,33792
M a[4:7],a[108:111],a[164:167],a[4:7]
buffer_load_dwordx4 v22, s[56:59], s29 offen offset:0 lds
M a[4:7],a[104:107],a[160:163],a[4:7]
M a[8:11],a[112:115],a[160:163],a[8:11]
M a[8:11],a[116:119],a[164:167],a[8:11]
buffer_load_dwordx4 v23, s[56:59], s29 offen offset:1024 lds
M a[12:15],a[124:127],a[164:167],a[12:15]
s_nop 0
T a[36:37],v1,40960
T a[38:39],v1,41984
M a[12:15],a[120:123],a[160:163],a[12:15]
M a[16:19],a[128:131],a[160:163],a[16:19]
buffer_load_dwordx4 v22, s[56:59], s30 offen offset:2048 lds
M a[16:19],a[132:135],a[164:167],a[16:19]
M a[20:23],a[140:143],a[164:167],a[20:23]
M a[20:23],a[136:139],a[160:163],a[20:23]
s_nop 0
T a[40:41],v2,32768
T a[42:43],v2,33792
M a[24:27],a[144:147],a[160:163],a[24:27]
buffer_load_dwordx4 v23, s[56:59], s30 offen offset:3072 lds
M a[24:27],a[148:151],a[164:167],a[24:27]
s_waitcnt lgkmcnt(6)
M a[28:31],a[156:159],a[164:167],a[28:31]
SA s29,s29,128
M a[28:31],a[152:155],a[160:163],a[28:31]
SA s30,s30,128
M v[32:35],a[96:99],a[168:171],v[32:35]
SA m0,s24,49152
R a[160:163],v5,4096
R a[164:167],v6,4096
M v[32:35],a[100:103],a[172:175],v[32:35]
T a[44:45],v2,40960
T a[46:47],v2,41984
M v[36:39],a[108:111],a[172:175],v[36:39]
buffer_load_dwordx4 v12, s[48:51], s22 offen offset:0   lds
M v[36:39],a[104:107],a[168:171],v[36:39]
M v[40:43],a[112:115],a[168:171],v[40:43]
M v[40:43],a[116:119],a[172:175],v[40:43]
s_nop 0
T a[48:49],v3,32768
T a[50:51],v3,33792
M v[44:47],a[124:127],a[172:175],v[44:47]
buffer_load_dwordx4 v13, s[48:51], s22 offen offset:1024   lds
M v[44:47],a[120:123],a[168:171],v[44:47]
M v[48:51],a[128:131],a[168:171],v[48:51]
M v[48:51],a[132:135],a[172:175],v[48:51]
buffer_load_dwordx4 v14, s[48:51], s22 offen offset:2048   lds
M v[52:55],a[140:143],a[172:175],v[52:55]
s_nop 0
T a[52:53],v3,40960
T a[54:55],v3,41984
M v[52:55],a[136:139],a[168:171],v[52:55]
M v[56:59],a[144:147],a[168:171],v[56:59]
buffer_load_dwordx4 v15, s[48:51], s22 offen offset:3072   lds
M v[56:59],a[148:151],a[172:175],v[56:59]
s_waitcnt lgkmcnt(6)
M v[60:63],a[156:159],a[172:175],v[60:63]
s_sub_u32 s22, s22, 1048448
M v[60:63],a[152:155],a[168:171],v[60:63]
s_mov_b32 s25, 1048576
T a[56:57],v4,32768
T a[58:59],v4,33792
M v[64:67],a[96:99],a[160:163],v[64:67]
SA m0,s4,16384
R a[168:171],v5,6144
R a[172:175],v6,6144
M v[64:67],a[100:103],a[164:167],v[64:67]
buffer_load_dwordx4 v8, s[52:55], s25 offen lds
M v[68:71],a[108:111],a[164:167],v[68:71]
s_mov_b32 s25, 1310720
M v[68:71],a[104:107],a[160:163],v[68:71]
SA m0,s4,20480
M v[72:75],a[112:115],a[160:163],v[72:75]
s_waitcnt vmcnt(17)
s_nop 0
T a[60:61],v4,40960
T a[62:63],v4,41984
M v[72:75],a[116:119],a[164:167],v[72:75]
buffer_load_dwordx4 v8, s[52:55], s25 offen lds
M v[76:79],a[124:127],a[164:167],v[76:79]
s_mov_b32 s25, 1572864
R a[208:211],v20,0
R a[212:215],v20,2048
M v[76:79],a[120:123],a[160:163],v[76:79]
SA m0,s4,24576
R a[216:219],v21,0
R a[220:223],v21,2048
M v[80:83],a[128:131],a[160:163],v[80:83]
buffer_load_dwordx4 v8, s[52:55], s25 offen lds
M v[80:83],a[132:135],a[164:167],v[80:83]
s_mov_b32 s25, 1835008
M v[84:87],a[140:143],a[164:167],v[84:87]
SA m0,s4,28672
M v[84:87],a[136:139],a[160:163],v[84:87]
buffer_load_dwordx4 v8, s[52:55], s25 offen lds
M v[88:91],a[144:147],a[160:163],v[88:91]
M v[88:91],a[148:151],a[164:167],v[88:91]
s_waitcnt lgkmcnt(6)
M v[92:95],a[156:159],a[164:167],v[92:95]
s_waitcnt lgkmcnt(0)
M v[92:95],a[152:155],a[160:163],v[92:95]
s_barrier
M v[96:99],a[96:99],a[168:171],v[96:99]
R a[160:163],v5,16384
R a[164:167],v6,16384
M v[96:99],a[100:103],a[172:175],v[96:99]
SA m0,s23,32768
M v[100:103],a[108:111],a[172:175],v[100:103]
s_nop 0
T a[64:65],v1,49152
T a[66:67],v1,50176
M v[100:103],a[104:107],a[168:171],v[100:103]
buffer_load_dwordx4 v22, s[56:59], s29 offen offset:0 lds
M v[104:107],a[112:115],a[168:171],v[104:107]
v_lshrrev_b32 v28, 2, v0
v_lshlrev_b32 v28, 7, v28
M v[104:107],a[116:119],a[172:175],v[104:107]
M v[108:111],a[124:127],a[172:175],v[108:111]
buffer_load_dwordx4 v23, s[56:59], s29 offen offset:1024 lds
M v[108:111],a[120:123],a[168:171],v[108:111]
v_and_b32 v29, 3, v0
M v[112:115],a[128:131],a[168:171],v[112:115]
v_lshl_add_u32 v28, v29, 3, v28
M v[112:115],a[132:135],a[172:175],v[112:115]
s_nop 0
T a[68:69],v1,57344
T a[70:71],v1,58368
M v[116:119],a[140:143],a[172:175],v[116:119]
buffer_load_dwordx4 v22, s[56:59], s30 offen offset:2048 lds
M v[116:119],a[136:139],a[168:171],v[116:119]
v_bfe_u32 v29, v0, 3, 2
M v[120:123],a[144:147],a[168:171],v[120:123]
M v[120:123],a[148:151],a[172:175],v[120:123]
s_waitcnt lgkmcnt(4)
v_lshl_add_u32 v16, v29, 5, v28
M v[124:127],a[156:159],a[172:175],v[124:127]
M v[124:127],a[152:155],a[168:171],v[124:127]
buffer_load_dwordx4 v23, s[56:59], s30 offen offset:3072 lds
M v[128:131],a[96:99],a[160:163],v[128:131]
R a[168:171],v5,18432
R a[172:175],v6,18432
M v[128:131],a[100:103],a[164:167],v[128:131]
SA s29,s29,128
T a[72:73],v2,49152
T a[74:75],v2,50176
M v[132:135],a[108:111],a[164:167],v[132:135]
SA s30,s30,128
v_xor_b32 v17, 32, v16
v_xor_b32 v18, 64, v16
M v[132:135],a[104:107],a[160:163],v[132:135]
SA m0,s23,65536
M v[136:139],a[112:115],a[160:163],v[136:139]
buffer_load_dwordx4 v22, s[56:59], s29 offen offset:0 lds
M v[136:139],a[116:119],a[164:167],v[136:139]
v_xor_b32 v19, 0x60, v16
M v[140:143],a[124:127],a[164:167],v[140:143]
v_add_u32 v12, 0x20000, v16
M v[140:143],a[120:123],a[160:163],v[140:143]
s_nop 0
T a[76:77],v2,57344
T a[78:79],v2,58368
M v[144:147],a[128:131],a[160:163],v[144:147]
buffer_load_dwordx4 v23, s[56:59], s29 offen offset:1024 lds
M v[144:147],a[132:135],a[164:167],v[144:147]
v_add_u32 v13, 0x20000, v17
M v[148:151],a[140:143],a[164:167],v[148:151]
M v[148:151],a[136:139],a[160:163],v[148:151]
v_add_u32 v14, 0x20000, v18
M v[152:155],a[144:147],a[160:163],v[152:155]
M v[152:155],a[148:151],a[164:167],v[152:155]
s_waitcnt lgkmcnt(4)
buffer_load_dwordx4 v22, s[56:59], s30 offen offset:2048 lds
M v[156:159],a[156:159],a[164:167],v[156:159]
s_nop 0
T a[80:81],v3,49152
T a[82:83],v3,50176
M v[156:159],a[152:155],a[160:163],v[156:159]
v_add_u32 v15, 0x20000, v19
M v[160:163],a[96:99],a[168:171],v[160:163]
R a[160:163],v5,20480
R a[164:167],v6,20480
M v[160:163],a[100:103],a[172:175],v[160:163]
M v[164:167],a[108:111],a[172:175],v[164:167]
buffer_load_dwordx4 v23, s[56:59], s30 offen offset:3072 lds
M v[164:167],a[104:107],a[168:171],v[164:167]
SA s29,s29,128
M v[168:171],a[112:115],a[168:171],v[168:171]
SA s30,s30,128
M v[168:171],a[116:119],a[172:175],v[168:171]
s_mov_b32 s25, 2097152
T a[84:85],v3,57344
T a[86:87],v3,58368
M v[172:175],a[124:127],a[172:175],v[172:175]
SA m0,s4,131072
M v[172:175],a[120:123],a[168:171],v[172:175]
buffer_load_dwordx4 v8, s[52:55], s25 offen lds
M v[176:179],a[128:131],a[168:171],v[176:179]
M v[176:179],a[132:135],a[172:175],v[176:179]
s_mov_b32 s25, 2359296
M v[180:183],a[140:143],a[172:175],v[180:183]
SA m0,s4,135168
M v[180:183],a[136:139],a[168:171],v[180:183]
buffer_load_dwordx4 v8, s[52:55], s25 offen lds
M v[184:187],a[144:147],a[168:171],v[184:187]
s_nop 0
T a[88:89],v4,49152
T a[90:91],v4,50176
M v[184:187],a[148:151],a[172:175],v[184:187]
s_waitcnt lgkmcnt(4)
M v[188:191],a[156:159],a[172:175],v[188:191]
s_mov_b32 s25, 2621440
M v[188:191],a[152:155],a[168:171],v[188:191]
L_w_kv07:
s_cbranch_execz L_wd1
SA m0,s4,139264
M v[192:195],a[96:99],a[160:163],v[192:195]
R a[168:171],v5,22528
R a[172:175],v6,22528
M v[192:195],a[100:103],a[164:167],v[192:195]
buffer_load_dwordx4 v8, s[52:55], s25 offen lds
M v[196:199],a[108:111],a[164:167],v[196:199]
M v[196:199],a[104:107],a[160:163],v[196:199]
s_mov_b32 s25, 2883584
T a[92:93],v4,57344
T a[94:95],v4,58368
M v[200:203],a[112:115],a[160:163],v[200:203]
SA m0,s4,143360
M v[200:203],a[116:119],a[164:167],v[200:203]
s_waitcnt vmcnt(19)
buffer_load_dwordx4 v8, s[52:55], s25 offen lds
M v[204:207],a[124:127],a[164:167],v[204:207]
R a[224:227],v20,16384
R a[228:231],v20,18432
M v[204:207],a[120:123],a[160:163],v[204:207]
R a[232:235],v21,16384
R a[236:239],v21,18432
M v[208:211],a[128:131],a[160:163],v[208:211]
v_subrev_u32 v20, 98304, v20
v_subrev_u32 v21, 98304, v21
M v[208:211],a[132:135],a[164:167],v[208:211]
M v[212:215],a[140:143],a[164:167],v[212:215]
M v[212:215],a[136:139],a[160:163],v[212:215]
M v[216:219],a[144:147],a[160:163],v[216:219]
M v[216:219],a[148:151],a[164:167],v[216:219]
s_waitcnt lgkmcnt(6)
M v[220:223],a[156:159],a[164:167],v[220:223]
s_waitcnt lgkmcnt(0)
M v[220:223],a[152:155],a[160:163],v[220:223]
s_barrier
M v[224:227],a[96:99],a[168:171],v[224:227]
R a[160:163],v5,32768
R a[164:167],v6,32768
M v[224:227],a[100:103],a[172:175],v[224:227]
M v[228:231],a[108:111],a[172:175],v[228:231]
M v[228:231],a[104:107],a[168:171],v[228:231]
M v[232:235],a[112:115],a[168:171],v[232:235]
M v[232:235],a[116:119],a[172:175],v[232:235]
M v[236:239],a[124:127],a[172:175],v[236:239]
M v[236:239],a[120:123],a[168:171],v[236:239]
M v[240:243],a[128:131],a[168:171],v[240:243]
M v[240:243],a[132:135],a[172:175],v[240:243]
M v[244:247],a[140:143],a[172:175],v[244:247]
M v[244:247],a[136:139],a[168:171],v[244:247]
M v[248:251],a[144:147],a[168:171],v[248:251]
M v[248:251],a[148:151],a[172:175],v[248:251]
s_waitcnt lgkmcnt(0)
M v[252:255],a[156:159],a[172:175],v[252:255]
M v[252:255],a[152:155],a[168:171],v[252:255]
M a[0:3],a[32:35],a[160:163],a[0:3]
R a[168:171],v5,34816
R a[172:175],v6,34816
M a[0:3],a[36:39],a[164:167],a[0:3]
SA m0,s23,81920
M a[4:7],a[44:47],a[164:167],a[4:7]
buffer_load_dwordx4 v22, s[56:59], s29 offen offset:0 lds
M a[4:7],a[40:43],a[160:163],a[4:7]
M a[8:11],a[48:51],a[160:163],a[8:11]
M a[8:11],a[52:55],a[164:167],a[8:11]
buffer_load_dwordx4 v23, s[56:59], s29 offen offset:1024 lds
M a[12:15],a[60:63],a[164:167],a[12:15]
M a[12:15],a[56:59],a[160:163],a[12:15]
G v24,a0
G v25,a1
M a[16:19],a[64:67],a[160:163],a[16:19]
G v26,a2
G v27,a3
M a[16:19],a[68:71],a[164:167],a[16:19]
buffer_load_dwordx4 v22, s[56:59], s30 offen offset:2048 lds
M a[20:23],a[76:79],a[164:167],a[20:23]
G v28,a4
G v29,a5
M a[20:23],a[72:75],a[160:163],a[20:23]
G v30,a6
G v31,a7
M a[24:27],a[80:83],a[160:163],a[24:27]
C v24,v24,v25
C v25,v26,v27
M a[24:27],a[84:87],a[164:167],a[24:27]
s_waitcnt lgkmcnt(0)
buffer_load_dwordx4 v23, s[56:59], s30 offen offset:3072 lds
M a[28:31],a[92:95],a[164:167],a[28:31]
SA s29,s29,128
C v26,v28,v29
C v27,v30,v31
M a[28:31],a[88:91],a[160:163],a[28:31]
SA s3,s93,0
buffer_store_dwordx4 v[24:27], v7, s[8:11], s3 offen offset:0 sc1
M v[32:35],a[32:35],a[168:171],v[32:35]
SA s30,s30,128
R a[160:163],v5,36864
R a[164:167],v6,36864
M v[32:35],a[36:39],a[172:175],v[32:35]
s_mov_b32 s25, 3145728
G v24,a8
G v25,a9
M v[36:39],a[44:47],a[172:175],v[36:39]
SA m0,s4,147456
G v26,a10
G v27,a11
M v[36:39],a[40:43],a[168:171],v[36:39]
buffer_load_dwordx4 v8, s[52:55], s25 offen lds
M v[40:43],a[48:51],a[168:171],v[40:43]
s_mov_b32 s25, 3407872
G v28,a12
G v29,a13
M v[40:43],a[52:55],a[172:175],v[40:43]
SA m0,s4,151552
G v30,a14
G v31,a15
M v[44:47],a[60:63],a[172:175],v[44:47]
buffer_load_dwordx4 v8, s[52:55], s25 offen lds
M v[44:47],a[56:59],a[168:171],v[44:47]
s_mov_b32 s25, 128
C v24,v24,v25
C v25,v26,v27
M v[48:51],a[64:67],a[168:171],v[48:51]
SA m0,s4,49152
C v26,v28,v29
C v27,v30,v31
M v[48:51],a[68:71],a[172:175],v[48:51]
buffer_store_dwordx4 v[24:27], v7, s[8:11], s3 offen offset:1024 sc1
M v[52:55],a[76:79],a[172:175],v[52:55]
s_nop 0
G v24,a16
G v25,a17
M v[52:55],a[72:75],a[168:171],v[52:55]
G v26,a18
G v27,a19
M v[56:59],a[80:83],a[168:171],v[56:59]
buffer_load_dwordx4 v8, s[52:55], s25 offen lds
M v[56:59],a[84:87],a[172:175],v[56:59]
s_waitcnt lgkmcnt(0)
G v28,a20
G v29,a21
M v[60:63],a[92:95],a[172:175],v[60:63]
s_mov_b32 s25, 262272
G v30,a22
G v31,a23
M v[60:63],a[88:91],a[168:171],v[60:63]
SA m0,s4,53248
C v24,v24,v25
C v25,v26,v27
M v[64:67],a[32:35],a[160:163],v[64:67]
s_waitcnt vmcnt(17)
R a[168:171],v5,38912
R a[172:175],v6,38912
M v[64:67],a[36:39],a[164:167],v[64:67]
buffer_load_dwordx4 v8, s[52:55], s25 offen lds
M v[68:71],a[44:47],a[164:167],v[68:71]
s_mov_b32 s25, 524416
C v26,v28,v29
C v27,v30,v31
M v[68:71],a[40:43],a[160:163],v[68:71]
SA m0,s4,57344
buffer_store_dwordx4 v[24:27], v7, s[8:11], s3 offen offset:2048 sc1
M v[72:75],a[48:51],a[160:163],v[72:75]
R a[96:99],v20,0
R a[100:103],v20,2048
M v[72:75],a[52:55],a[164:167],v[72:75]
R a[104:107],v21,0
R a[108:111],v21,2048
M v[76:79],a[60:63],a[164:167],v[76:79]
buffer_load_dwordx4 v8, s[52:55], s25 offen lds
M v[76:79],a[56:59],a[160:163],v[76:79]
s_mov_b32 s25, 786560
G v24,a24
G v25,a25
M v[80:83],a[64:67],a[160:163],v[80:83]
SA m0,s4,61440
G v26,a26
G v27,a27
M v[80:83],a[68:71],a[164:167],v[80:83]
buffer_load_dwordx4 v8, s[52:55], s25 offen lds
M v[84:87],a[76:79],a[164:167],v[84:87]
G v28,a28
G v29,a29
M v[84:87],a[72:75],a[160:163],v[84:87]
G v30,a30
G v31,a31
M v[88:91],a[80:83],a[160:163],v[88:91]
C v24,v24,v25
C v25,v26,v27
M v[88:91],a[84:87],a[164:167],v[88:91]
s_waitcnt lgkmcnt(4)
C v26,v28,v29
C v27,v30,v31
M v[92:95],a[92:95],a[164:167],v[92:95]
s_waitcnt lgkmcnt(0)
buffer_store_dwordx4 v[24:27], v7, s[8:11], s3 offen offset:3072 sc1
M v[92:95],a[88:91],a[160:163],v[92:95]
s_barrier
M v[96:99],a[32:35],a[168:171],v[96:99]
R a[160:163],v5,49152
R a[164:167],v6,49152
M v[96:99],a[36:39],a[172:175],v[96:99]
s_mov_b32 s25, 1048704
C v64,v64,v65
C v65,v66,v67
M v[100:103],a[44:47],a[172:175],v[100:103]
SA m0,s4,98304
C v66,v68,v69
C v67,v70,v71
M v[100:103],a[40:43],a[168:171],v[100:103]
s_waitcnt vmcnt(18)
buffer_load_dwordx4 v8, s[52:55], s25 offen lds
M v[104:107],a[48:51],a[168:171],v[104:107]
C v72,v72,v73
C v73,v74,v75
M v[104:107],a[52:55],a[172:175],v[104:107]
C v74,v76,v77
C v75,v78,v79
M v[108:111],a[60:63],a[172:175],v[108:111]
C v32,v32,v33
C v33,v34,v35
M v[108:111],a[56:59],a[168:171],v[108:111]
C v34,v36,v37
C v35,v38,v39
M v[112:115],a[64:67],a[168:171],v[112:115]
SA s3,s93,8192
buffer_store_dwordx4 v[32:35], v7, s[8:11], s3 offen offset:0 sc1
M v[112:115],a[68:71],a[172:175],v[112:115]
s_mov_b32 s25, 1310848
C v80,v80,v81
C v81,v82,v83
M v[116:119],a[76:79],a[172:175],v[116:119]
SA m0,s4,102400
C v82,v84,v85
C v83,v86,v87
M v[116:119],a[72:75],a[168:171],v[116:119]
R a[112:115],v20,32768
R a[116:119],v20,34816
M v[120:123],a[80:83],a[168:171],v[120:123]
buffer_load_dwordx4 v8, s[52:55], s25 offen lds
M v[120:123],a[84:87],a[172:175],v[120:123]
s_waitcnt lgkmcnt(2)
R a[120:123],v21,32768
R a[124:127],v21,34816
M v[124:127],a[92:95],a[172:175],v[124:127]
C v88,v88,v89
C v89,v90,v91
M v[124:127],a[88:91],a[168:171],v[124:127]
C v90,v92,v93
C v91,v94,v95
M v[128:131],a[32:35],a[160:163],v[128:131]
R a[168:171],v5,51200
R a[172:175],v6,51200
M v[128:131],a[36:39],a[164:167],v[128:131]
C v40,v40,v41
C v41,v42,v43
M v[132:135],a[44:47],a[164:167],v[132:135]
C v42,v44,v45
C v43,v46,v47
M v[132:135],a[40:43],a[160:163],v[132:135]
s_mov_b32 s25, 1572992
buffer_store_dwordx4 v[40:43], v7, s[8:11], s3 offen offset:1024 sc1
M v[136:139],a[48:51],a[160:163],v[136:139]
SA m0,s4,106496
C v96,v96,v97
C v97,v98,v99
M v[136:139],a[52:55],a[164:167],v[136:139]
C v98,v100,v101
C v99,v102,v103
M v[140:143],a[60:63],a[164:167],v[140:143]
C v104,v104,v105
C v105,v106,v107
M v[140:143],a[56:59],a[160:163],v[140:143]
buffer_load_dwordx4 v8, s[52:55], s25 offen lds
M v[144:147],a[64:67],a[160:163],v[144:147]
C v106,v108,v109
C v107,v110,v111
M v[144:147],a[68:71],a[164:167],v[144:147]
C v112,v112,v113
C v113,v114,v115
M v[148:151],a[76:79],a[164:167],v[148:151]
C v114,v116,v117
C v115,v118,v119
M v[148:151],a[72:75],a[160:163],v[148:151]
C v48,v48,v49
C v49,v50,v51
M v[152:155],a[80:83],a[160:163],v[152:155]
C v50,v52,v53
C v51,v54,v55
M v[152:155],a[84:87],a[164:167],v[152:155]
s_waitcnt lgkmcnt(0)
buffer_store_dwordx4 v[48:51], v7, s[8:11], s3 offen offset:2048 sc1
M v[156:159],a[92:95],a[164:167],v[156:159]
s_mov_b32 s25, 1835136
C v120,v120,v121
C v121,v122,v123
M v[156:159],a[88:91],a[160:163],v[156:159]
SA m0,s4,110592
C v122,v124,v125
C v123,v126,v127
M v[160:163],a[32:35],a[168:171],v[160:163]
R a[160:163],v5,53248
R a[164:167],v6,53248
M v[160:163],a[36:39],a[172:175],v[160:163]
buffer_load_dwordx4 v8, s[52:55], s25 offen lds
M v[164:167],a[44:47],a[172:175],v[164:167]
C v128,v128,v129
C v129,v130,v131
M v[164:167],a[40:43],a[168:171],v[164:167]
C v130,v132,v133
C v131,v134,v135
M v[168:171],a[48:51],a[168:171],v[168:171]
C v56,v56,v57
C v57,v58,v59
M v[168:171],a[52:55],a[172:175],v[168:171]
C v58,v60,v61
C v59,v62,v63
M v[172:175],a[60:63],a[172:175],v[172:175]
buffer_store_dwordx4 v[56:59], v7, s[8:11], s3 offen offset:3072 sc1
M v[172:175],a[56:59],a[168:171],v[172:175]
C v136,v136,v137
C v137,v138,v139
M v[176:179],a[64:67],a[168:171],v[176:179]
C v138,v140,v141
C v139,v142,v143
M v[176:179],a[68:71],a[172:175],v[176:179]
C v144,v144,v145
C v145,v146,v147
M v[180:183],a[76:79],a[172:175],v[180:183]
C v146,v148,v149
C v147,v150,v151
M v[180:183],a[72:75],a[168:171],v[180:183]
C v152,v152,v153
C v153,v154,v155
M v[184:187],a[80:83],a[168:171],v[184:187]
C v154,v156,v157
C v155,v158,v159
M v[184:187],a[84:87],a[172:175],v[184:187]
s_waitcnt lgkmcnt(0)
C v160,v160,v161
C v161,v162,v163
M v[188:191],a[92:95],a[172:175],v[188:191]
C v162,v164,v165
C v163,v166,v167
M v[188:191],a[88:91],a[168:171],v[188:191]
C v168,v168,v169
C v169,v170,v171
M v[192:195],a[32:35],a[160:163],v[192:195]
s_waitcnt vmcnt(18)
R a[168:171],v5,55296
R a[172:175],v6,55296
M v[192:195],a[36:39],a[164:167],v[192:195]
C v170,v172,v173
C v171,v174,v175
M v[196:199],a[44:47],a[164:167],v[196:199]
C v176,v176,v177
C v177,v178,v179
M v[196:199],a[40:43],a[160:163],v[196:199]
C v178,v180,v181
C v179,v182,v183
M v[200:203],a[48:51],a[160:163],v[200:203]
R a[128:131],v20,49152
R a[132:135],v20,51200
M v[200:203],a[52:55],a[164:167],v[200:203]
R a[136:139],v21,49152
R a[140:143],v21,51200
M v[204:207],a[60:63],a[164:167],v[204:207]
C v184,v184,v185
C v185,v186,v187
M v[204:207],a[56:59],a[160:163],v[204:207]
C v186,v188,v189
C v187,v190,v191
M v[208:211],a[64:67],a[160:163],v[208:211]
C v192,v192,v193
C v193,v194,v195
M v[208:211],a[68:71],a[164:167],v[208:211]
C v194,v196,v197
C v195,v198,v199
M v[212:215],a[76:79],a[164:167],v[212:215]
M v[212:215],a[72:75],a[160:163],v[212:215]
C v200,v200,v201
C v201,v202,v203
M v[216:219],a[80:83],a[160:163],v[216:219]
C v202,v204,v205
C v203,v206,v207
M v[216:219],a[84:87],a[164:167],v[216:219]
s_waitcnt lgkmcnt(4)
M v[220:223],a[92:95],a[164:167],v[220:223]
s_waitcnt vmcnt(15) lgkmcnt(0)
M v[220:223],a[88:91],a[160:163],v[220:223]
s_barrier
M v[224:227],a[32:35],a[168:171],v[224:227]
s_nop 0
T v[32:33],v16,0
T v[34:35],v16,2048
M v[224:227],a[36:39],a[172:175],v[224:227]
C v208,v208,v209
C v209,v210,v211
M v[228:231],a[44:47],a[172:175],v[228:231]
T v[36:37],v16,4096
T v[38:39],v16,6144
M v[228:231],a[40:43],a[168:171],v[228:231]
T v[40:41],v16,8192
T v[42:43],v16,10240
M v[232:235],a[48:51],a[168:171],v[232:235]
C v210,v212,v213
C v211,v214,v215
M v[232:235],a[52:55],a[172:175],v[232:235]
T v[44:45],v16,12288
T v[46:47],v16,14336
M v[236:239],a[60:63],a[172:175],v[236:239]
T v[48:49],v16,16384
T v[50:51],v16,18432
M v[236:239],a[56:59],a[168:171],v[236:239]
C v216,v216,v217
C v217,v218,v219
M v[240:243],a[64:67],a[168:171],v[240:243]
T v[52:53],v16,20480
T v[54:55],v16,22528
M v[240:243],a[68:71],a[172:175],v[240:243]
T v[56:57],v16,24576
T v[58:59],v16,26624
M v[244:247],a[76:79],a[172:175],v[244:247]
C v218,v220,v221
C v219,v222,v223
M v[244:247],a[72:75],a[168:171],v[244:247]
C v224,v224,v225
C v225,v226,v227
M v[248:251],a[80:83],a[168:171],v[248:251]
C v226,v228,v229
C v227,v230,v231
M v[248:251],a[84:87],a[172:175],v[248:251]
C v232,v232,v233
C v233,v234,v235
M v[252:255],a[92:95],a[172:175],v[252:255]
C v234,v236,v237
C v235,v238,v239
M v[252:255],a[88:91],a[168:171],v[252:255]
s_waitcnt lgkmcnt(6)
C v240,v240,v241
C v241,v242,v243
M v[68:71],v[32:35],a[176:179],0
s_mul_i32 s72, s41, 4352
T a[144:145],v17,0
T a[146:147],v17,2048
M v[68:71],v[36:39],a[184:187],v[68:71]
SA s46,s72,104923136
C v242,v244,v245
C v243,v246,v247
M v[68:71],v[40:43],a[192:195],v[68:71]
s_waitcnt lgkmcnt(2)
T a[148:149],v17,4096
T a[150:151],v17,6144
M v[68:71],v[44:47],a[200:203],v[68:71]
s_mov_b32 s25, 2097280
T a[152:153],v17,8192
T a[154:155],v17,10240
M v[68:71],v[48:51],a[208:211],v[68:71]
SA m0,s4,114688
C v248,v248,v249
C v249,v250,v251
M v[68:71],v[52:55],a[216:219],v[68:71]
s_lshl_b32 s45, s42, 7
T a[156:157],v17,12288
T a[158:159],v17,14336
M v[68:71],v[56:59],a[224:227],v[68:71]
SA s45,s45,s46
T a[160:161],v17,16384
T a[162:163],v17,18432
M v[76:79],v[56:59],a[228:231],0
s_lshl_b32 s72, s20, 2
buffer_load_dwordx4 v8, s[52:55], s25 offen lds
M v[76:79],v[52:55],a[220:223],v[76:79]
SA s72,s72,s45
T a[164:165],v17,20480
T a[166:167],v17,22528
M v[76:79],v[48:51],a[212:215],v[76:79]
T a[168:169],v17,24576
T a[170:171],v17,26624
M v[76:79],v[44:47],a[204:207],v[76:79]
s_mov_b32 s25, 2359424
C v250,v252,v253
C v251,v254,v255
M v[76:79],v[40:43],a[196:199],v[76:79]
SA m0,s4,118784
v_min_u32 v29, 1, v0
v_lshlrev_b32 v29, 29, v29
M v[76:79],v[36:39],a[188:191],v[76:79]
buffer_load_dwordx4 v8, s[52:55], s25 offen lds
M v[76:79],v[32:35],a[180:183],v[76:79]
s_waitcnt lgkmcnt(6)
v_mov_b32 v30, 1
M v[84:87],a[144:147],a[176:179],0
s_nop 0
T v[32:33],v18,0
T v[34:35],v18,2048
M v[84:87],a[148:151],a[184:187],v[84:87]
s_mov_b32 s25, 2621568
M v[84:87],a[152:155],a[192:195],v[84:87]
s_waitcnt lgkmcnt(2)
s_nop 0
T v[36:37],v18,4096
T v[38:39],v18,6144
M v[84:87],a[156:159],a[200:203],v[84:87]
SA m0,s4,122880
T v[40:41],v18,8192
T v[42:43],v18,10240
M v[84:87],a[160:163],a[208:211],v[84:87]
buffer_load_dwordx4 v8, s[52:55], s25 offen lds
M v[84:87],a[164:167],a[216:219],v[84:87]
s_nop 0
T v[44:45],v18,12288
T v[46:47],v18,14336
M v[84:87],a[168:171],a[224:227],v[84:87]
s_waitcnt vmcnt(3)
T v[48:49],v18,16384
T v[50:51],v18,18432
M v[92:95],a[168:171],a[228:231],0
s_mov_b32 s25, 2883712
buffer_store_dword v30, v29, s[8:11], s72 offen offset:4 sc1
M v[92:95],a[164:167],a[220:223],v[92:95]
SA m0,s4,126976
T v[52:53],v18,20480
T v[54:55],v18,22528
M v[92:95],a[160:163],a[212:215],v[92:95]
T v[56:57],v18,24576
T v[58:59],v18,26624
M v[92:95],a[156:159],a[204:207],v[92:95]
buffer_load_dwordx4 v8, s[52:55], s25 offen lds
M v[92:95],a[152:155],a[196:199],v[92:95]
v_add_u32 v20, 0x10000, v16
L_w_kv08:
s_cbranch_execz L_wd1
v_add_u32 v21, 0x10000, v17
M v[92:95],a[148:151],a[188:191],v[92:95]
M v[92:95],a[144:147],a[180:183],v[92:95]
s_waitcnt lgkmcnt(6)
v_add_u32 v22, 0x10000, v18
M v[100:103],v[32:35],a[176:179],0
s_mov_b32 s25, 3145856
T a[144:145],v19,0
T a[146:147],v19,2048
M v[100:103],v[36:39],a[184:187],v[100:103]
SA m0,s4,32768
M v[100:103],v[40:43],a[192:195],v[100:103]
s_waitcnt lgkmcnt(2)
s_nop 0
T a[148:149],v19,4096
T a[150:151],v19,6144
M v[100:103],v[44:47],a[200:203],v[100:103]
T a[152:153],v19,8192
T a[154:155],v19,10240
M v[100:103],v[48:51],a[208:211],v[100:103]
buffer_load_dwordx4 v8, s[52:55], s25 offen lds
M v[100:103],v[52:55],a[216:219],v[100:103]
s_nop 0
T a[156:157],v19,12288
T a[158:159],v19,14336
M v[100:103],v[56:59],a[224:227],v[100:103]
T a[160:161],v19,16384
T a[162:163],v19,18432
M v[108:111],v[56:59],a[228:231],0
s_mov_b32 s25, 3408000
v_add_u32 v23, 0x10000, v19
v_or_b32 v1, s20, v0
M v[108:111],v[52:55],a[220:223],v[108:111]
SA m0,s4,36864
T a[164:165],v19,20480
T a[166:167],v19,22528
M v[108:111],v[48:51],a[212:215],v[108:111]
SA s3,s93,524288
T a[168:169],v19,24576
T a[170:171],v19,26624
M v[108:111],v[44:47],a[204:207],v[108:111]
buffer_load_dwordx4 v8, s[52:55], s25 offen lds
M v[108:111],v[40:43],a[196:199],v[108:111]
v_min_u32 v1, 1, v1
M v[108:111],v[36:39],a[188:191],v[108:111]
M v[108:111],v[32:35],a[180:183],v[108:111]
s_waitcnt lgkmcnt(6)
buffer_store_dwordx4 v[64:67], v7, s[8:11], s3 offen offset:0 sc1
M v[116:119],a[144:147],a[176:179],0
s_mov_b32 s25, 256
T v[32:33],v16,28672
T v[34:35],v16,30720
M v[116:119],a[148:151],a[184:187],v[116:119]
SA m0,s4,65536
v_lshlrev_b32 v1, 29, v1
M v[116:119],a[152:155],a[192:195],v[116:119]
s_waitcnt lgkmcnt(2)
s_nop 0
T v[36:37],v12,0
T v[38:39],v12,2048
M v[116:119],a[156:159],a[200:203],v[116:119]
T v[40:41],v12,4096
T v[42:43],v12,6144
M v[116:119],a[160:163],a[208:211],v[116:119]
buffer_load_dwordx4 v8, s[52:55], s25 offen lds
M v[116:119],a[164:167],a[216:219],v[116:119]
s_nop 0
T v[44:45],v12,8192
T v[46:47],v12,10240
M v[116:119],a[168:171],a[224:227],v[116:119]
T v[48:49],v12,12288
T v[50:51],v12,14336
M v[124:127],a[168:171],a[228:231],0
s_mov_b32 s25, 262400
buffer_store_dwordx4 v[72:75], v7, s[8:11], s3 offen offset:1024 sc1
M v[124:127],a[164:167],a[220:223],v[124:127]
SA m0,s4,69632
T v[52:53],v12,16384
T v[54:55],v12,18432
M v[124:127],a[160:163],a[212:215],v[124:127]
T v[56:57],v12,20480
T v[58:59],v12,22528
M v[124:127],a[156:159],a[204:207],v[124:127]
buffer_load_dwordx4 v8, s[52:55], s25 offen lds
M v[124:127],a[152:155],a[196:199],v[124:127]
v_min_u32 v9, 15, v0
v_lshlrev_b32 v9, 7, v9
M v[124:127],a[148:151],a[188:191],v[124:127]
s_sub_u32 s66, 15, s42
buffer_store_dwordx4 v[80:83], v7, s[8:11], s3 offen offset:2048 sc1
M v[124:127],a[144:147],a[180:183],v[124:127]
s_waitcnt lgkmcnt(6)
M v[68:71],v[32:35],a[232:235],v[68:71]
s_mov_b32 s25, 524544
T a[144:145],v17,28672
T a[146:147],v17,30720
M v[68:71],v[36:39],a[96:99],v[68:71]
SA m0,s4,73728
buffer_store_dwordx4 v[88:91], v7, s[8:11], s3 offen offset:3072 sc1
M v[68:71],v[40:43],a[104:107],v[68:71]
s_waitcnt lgkmcnt(2)
s_nop 0
T a[148:149],v13,0
T a[150:151],v13,2048
M v[68:71],v[44:47],a[112:115],v[68:71]
s_max_u32 s67, s66, s42
T a[152:153],v13,4096
T a[154:155],v13,6144
M v[68:71],v[48:51],a[120:123],v[68:71]
s_min_u32 s66, s66, s42
buffer_load_dwordx4 v8, s[52:55], s25 offen lds
M v[68:71],v[52:55],a[128:131],v[68:71]
s_mul_i32 s21, s41, 1048576
T a[156:157],v13,8192
T a[158:159],v13,10240
M v[68:71],v[56:59],a[136:139],v[68:71]
s_lshl_b32 s64, s67, 16
T a[160:161],v13,12288
T a[162:163],v13,14336
M v[76:79],v[56:59],a[140:143],v[76:79]
s_mov_b32 s25, 786688
M v[76:79],v[52:55],a[132:135],v[76:79]
SA m0,s4,77824
T a[164:165],v13,16384
T a[166:167],v13,18432
M v[76:79],v[48:51],a[124:127],v[76:79]
SA s32,s21,s64
T a[168:169],v13,20480
T a[170:171],v13,22528
M v[76:79],v[44:47],a[116:119],v[76:79]
s_lshl_b32 s64, s20, 14
buffer_load_dwordx4 v8, s[52:55], s25 offen lds
M v[76:79],v[40:43],a[108:111],v[76:79]
SA s32,s32,s64
M v[76:79],v[36:39],a[100:103],v[76:79]
SA s32,s32,33554432
M v[76:79],v[32:35],a[236:239],v[76:79]
s_waitcnt lgkmcnt(6)
M v[84:87],a[144:147],a[232:235],v[84:87]
s_mov_b32 s25, 1048832
T v[32:33],v18,28672
T v[34:35],v18,30720
M v[84:87],a[148:151],a[96:99],v[84:87]
SA m0,s4,81920
M v[84:87],a[152:155],a[104:107],v[84:87]
s_waitcnt lgkmcnt(2)
s_nop 0
T v[36:37],v14,0
T v[38:39],v14,2048
M v[84:87],a[156:159],a[112:115],v[84:87]
s_sub_u32 s64, s42, 10
T v[40:41],v14,4096
T v[42:43],v14,6144
M v[84:87],a[160:163],a[120:123],v[84:87]
s_and_b32 s35, s64, 536870912
buffer_load_dwordx4 v8, s[52:55], s25 offen lds
M v[84:87],a[164:167],a[128:131],v[84:87]
s_nop 0
T v[44:45],v14,8192
T v[46:47],v14,10240
M v[84:87],a[168:171],a[136:139],v[84:87]
T v[48:49],v14,12288
T v[50:51],v14,14336
M v[92:95],a[168:171],a[140:143],v[92:95]
s_mov_b32 s25, 1310976
v_or_b32 v6, s35, v7
M v[92:95],a[164:167],a[132:135],v[92:95]
SA m0,s4,86016
T v[52:53],v14,16384
T v[54:55],v14,18432
M v[92:95],a[160:163],a[124:127],v[92:95]
s_lshl_b32 s28, s20, 13
T v[56:57],v14,20480
T v[58:59],v14,22528
M v[92:95],a[156:159],a[116:119],v[92:95]
buffer_load_dwordx4 v8, s[52:55], s25 offen lds
M v[92:95],a[152:155],a[108:111],v[92:95]
v_add_u32 v2, 0x10000, v7
v_add_u32 v3, s28, v7
M v[92:95],a[148:151],a[100:103],v[92:95]
v_add_u32 v4, 0x1000, v3
MF v68,s5,v68
M v[92:95],a[144:147],a[236:239],v[92:95]
s_waitcnt lgkmcnt(6)
MF v69,s5,v69
MF v70,s5,v70
M v[100:103],v[32:35],a[232:235],v[100:103]
s_mov_b32 s25, 1573120
T a[144:145],v19,28672
T a[146:147],v19,30720
M v[100:103],v[36:39],a[96:99],v[100:103]
SA m0,s4,90112
MF v71,s5,v71
MF v84,s5,v84
M v[100:103],v[40:43],a[104:107],v[100:103]
s_waitcnt lgkmcnt(2)
T a[148:149],v15,0
T a[150:151],v15,2048
M v[100:103],v[44:47],a[112:115],v[100:103]
s_lshl_b32 s64, s42, 16
T a[152:153],v15,4096
T a[154:155],v15,6144
M v[100:103],v[48:51],a[120:123],v[100:103]
SA s23,s21,s64
buffer_load_dwordx4 v8, s[52:55], s25 offen lds
M v[100:103],v[52:55],a[128:131],v[100:103]
SA s43,s23,16777216
T a[156:157],v15,8192
T a[158:159],v15,10240
M v[100:103],v[56:59],a[136:139],v[100:103]
SA s26,s21,16777216
T a[160:161],v15,12288
T a[162:163],v15,14336
M v[108:111],v[56:59],a[140:143],v[108:111]
s_mov_b32 s25, 1835264
MF v85,s5,v85
MF v86,s5,v86
M v[108:111],v[52:55],a[132:135],v[108:111]
SA m0,s4,94208
T a[164:165],v15,16384
T a[166:167],v15,18432
M v[108:111],v[48:51],a[124:127],v[108:111]
s_mov_b32 s22, 0x7fff
T a[168:169],v15,20480
T a[170:171],v15,22528
M v[108:111],v[44:47],a[116:119],v[108:111]
s_sub_u32 s27, s42, 1
buffer_load_dwordx4 v8, s[52:55], s25 offen lds
M v[108:111],v[40:43],a[108:111],v[108:111]
s_cmp_eq_u32 s42, 0
MF v87,s5,v87
C v68,v68,v69
M v[108:111],v[36:39],a[100:103],v[108:111]
s_waitcnt vmcnt(12) lgkmcnt(0)
C v69,v70,v71
C v70,v84,v85
M v[108:111],v[32:35],a[236:239],v[108:111]
s_barrier
M v[116:119],a[144:147],a[232:235],v[116:119]
s_mov_b32 s25, 2097408
T v[32:33],v16,49152
T v[34:35],v16,51200
M v[116:119],a[148:151],a[96:99],v[116:119]
s_cselect_b32 s64, 32768, 0
C v71,v86,v87
W a0,v68
M v[116:119],a[152:155],a[104:107],v[116:119]
SA m0,s4,155648
T v[36:37],v16,53248
T v[38:39],v16,55296
M v[116:119],a[156:159],a[112:115],v[116:119]
SA s26,s26,s64
T v[40:41],v16,57344
T v[42:43],v16,59392
M v[116:119],a[160:163],a[120:123],v[116:119]
s_mov_b32 s31, 0x4b800000
buffer_load_dwordx4 v8, s[52:55], s25 offen lds
M v[116:119],a[164:167],a[128:131],v[116:119]
s_mov_b32 s24, 0x33800000
T v[44:45],v16,61440
T v[46:47],v16,63488
M v[116:119],a[168:171],a[136:139],v[116:119]
s_lshl_b32 s47, s66, 7
T v[48:49],v20,32768
T v[50:51],v20,34816
M v[124:127],a[168:171],a[140:143],v[124:127]
s_mov_b32 s25, 2359552
W a1,v69
W a2,v70
M v[124:127],a[164:167],a[132:135],v[124:127]
SA m0,s4,159744
T v[52:53],v20,36864
T v[54:55],v20,38912
M v[124:127],a[160:163],a[124:127],v[124:127]
SA s47,s47,s46
T v[56:57],v20,40960
T v[58:59],v20,43008
M v[124:127],a[156:159],a[116:119],v[124:127]
s_lshl_b32 s64, s20, 5
buffer_load_dwordx4 v8, s[52:55], s25 offen lds
M v[124:127],a[152:155],a[108:111],v[124:127]
SA s47,s47,s64
W a3,v71
MF v76,s5,v76
M v[124:127],a[148:151],a[100:103],v[124:127]
SA s47,s47,2048
MF v77,s5,v77
MF v78,s5,v78
M v[124:127],a[144:147],a[236:239],v[124:127]
s_waitcnt lgkmcnt(6)
MF v79,s5,v79
MF v92,s5,v92
M v[132:135],v[32:35],a[176:179],0
s_lshl_b32 s65, s41, 3
T a[144:145],v17,49152
T a[146:147],v17,51200
M v[132:135],v[36:39],a[184:187],v[132:135]
SA s65,s65,s66
MF v93,s5,v93
MF v94,s5,v94
M v[132:135],v[40:43],a[192:195],v[132:135]
s_waitcnt lgkmcnt(2)
T a[148:149],v17,53248
T a[150:151],v17,55296
M v[132:135],v[44:47],a[200:203],v[132:135]
s_mul_i32 s34, s65, 73728
T a[152:153],v17,57344
T a[154:155],v17,59392
M v[132:135],v[48:51],a[208:211],v[132:135]
SA s34,s34,136314880
MF v95,s5,v95
C v76,v76,v77
M v[132:135],v[52:55],a[216:219],v[132:135]
s_lshl_b32 s65, s42, 4
T a[156:157],v17,61440
T a[158:159],v17,63488
M v[132:135],v[56:59],a[224:227],v[132:135]
SA s65,s65,s41
T a[160:161],v21,32768
T a[162:163],v21,34816
M v[140:143],v[56:59],a[228:231],0
s_mul_i32 s33, s65, 114688
C v77,v78,v79
C v78,v92,v93
M v[140:143],v[52:55],a[220:223],v[140:143]
s_mul_i32 s65, s20, 28672
T a[164:165],v21,36864
T a[166:167],v21,38912
M v[140:143],v[48:51],a[212:215],v[140:143]
SA s33,s33,s65
T a[168:169],v21,40960
T a[170:171],v21,43008
M v[140:143],v[44:47],a[204:207],v[140:143]
SA s33,s33,67108864
C v79,v94,v95
W a32,v76
M v[140:143],v[40:43],a[196:199],v[140:143]
s_mov_b32 s6, 0
W a33,v77
W a34,v78
M v[140:143],v[36:39],a[188:191],v[140:143]
s_mov_b32 s7, 0
W a35,v79
MF v100,s5,v100
M v[140:143],v[32:35],a[180:183],v[140:143]
s_waitcnt lgkmcnt(6)
MF v101,s5,v101
MF v102,s5,v102
M v[148:151],a[144:147],a[176:179],0
s_mov_b32 s40, 1
T v[32:33],v18,49152
T v[34:35],v18,51200
M v[148:151],a[148:151],a[184:187],v[148:151]
s_cmp_eq_u32 s20, 0
MF v103,s5,v103
MF v116,s5,v116
M v[148:151],a[152:155],a[192:195],v[148:151]
s_waitcnt lgkmcnt(2)
T v[36:37],v18,53248
T v[38:39],v18,55296
M v[148:151],a[156:159],a[200:203],v[148:151]
s_cselect_b32 s39, 7, 0
T v[40:41],v18,57344
T v[42:43],v18,59392
M v[148:151],a[160:163],a[208:211],v[148:151]
s_lshl_b32 s64, s41, 1
MF v117,s5,v117
MF v118,s5,v118
M v[148:151],a[164:167],a[216:219],v[148:151]
SA s64,s64,s20
T v[44:45],v18,61440
T v[46:47],v18,63488
M v[148:151],a[168:171],a[224:227],v[148:151]
s_cmp_lt_u32 s64, 30
T v[48:49],v22,32768
T v[50:51],v22,34816
M v[156:159],a[168:171],a[228:231],0
s_cselect_b32 s64, 30, 0
MF v119,s5,v119
C v100,v100,v101
M v[156:159],a[164:167],a[220:223],v[156:159]
s_cmp_ge_u32 s20, 2
T v[52:53],v22,36864
T v[54:55],v22,38912
M v[156:159],a[160:163],a[212:215],v[156:159]
s_cselect_b32 s64, s64, 0
T v[56:57],v22,40960
T v[58:59],v22,43008
M v[156:159],a[156:159],a[204:207],v[156:159]
s_cmp_eq_u32 s42, 6
C v101,v102,v103
C v102,v116,v117
M v[156:159],a[152:155],a[196:199],v[156:159]
s_cselect_b32 s64, s64, 0
C v103,v118,v119
W a4,v100
M v[156:159],a[148:151],a[188:191],v[156:159]
s_or_b32 s39, s39, s64
W a5,v101
W a6,v102
M v[156:159],a[144:147],a[180:183],v[156:159]
s_waitcnt lgkmcnt(6)
W a7,v103
MF v108,s5,v108
M v[164:167],v[32:35],a[176:179],0
s_mov_b64 s[60:61], s[76:77]
T a[144:145],v19,49152
T a[146:147],v19,51200
M v[164:167],v[36:39],a[184:187],v[164:167]
s_mov_b32 s62, s78
MF v109,s5,v109
MF v110,s5,v110
M v[164:167],v[40:43],a[192:195],v[164:167]
s_waitcnt lgkmcnt(2)
T a[148:149],v19,53248
T a[150:151],v19,55296
M v[164:167],v[44:47],a[200:203],v[164:167]
s_mov_b32 s63, 0x20000
T a[152:153],v19,57344
T a[154:155],v19,59392
M v[164:167],v[48:51],a[208:211],v[164:167]
s_mov_b32 s25, 2621696
v_lshrrev_b32 v24, 4, v0
v_lshlrev_b32 v24, 2, v24
M v[164:167],v[52:55],a[216:219],v[164:167]
SA m0,s4,131072
T a[156:157],v19,61440
T a[158:159],v19,63488
M v[164:167],v[56:59],a[224:227],v[164:167]
SA s3,s93,532480
T a[160:161],v23,32768
T a[162:163],v23,34816
M v[172:175],v[56:59],a[228:231],0
buffer_load_dwordx4 v8, s[52:55], s25 offen lds
M v[172:175],v[52:55],a[220:223],v[172:175]
s_nop 0
T a[164:165],v23,36864
T a[166:167],v23,38912
M v[172:175],v[48:51],a[212:215],v[172:175]
T a[168:169],v23,40960
T a[170:171],v23,43008
M v[172:175],v[44:47],a[204:207],v[172:175]
s_mov_b32 s25, 2883840
buffer_store_dwordx4 v[96:99], v7, s[8:11], s3 offen offset:0 sc1
M v[172:175],v[40:43],a[196:199],v[172:175]
SA m0,s4,135168
v_and_b32 v25, 15, v0
v_sub_u32 v24, v24, v25
M v[172:175],v[36:39],a[188:191],v[172:175]
buffer_load_dwordx4 v8, s[52:55], s25 offen lds
M v[172:175],v[32:35],a[180:183],v[172:175]
s_waitcnt lgkmcnt(6)
v_cmp_lt_i32 s[16:17], 0, v24
v_cmp_lt_i32 s[18:19], -1, v24
M v[180:183],a[144:147],a[176:179],0
T v[32:33],v20,45056
T v[34:35],v20,47104
M v[180:183],a[148:151],a[184:187],v[180:183]
s_mov_b32 s25, 3145984
buffer_store_dwordx4 v[104:107], v7, s[8:11], s3 offen offset:1024 sc1
M v[180:183],a[152:155],a[192:195],v[180:183]
s_waitcnt lgkmcnt(2)
s_nop 0
T v[36:37],v20,49152
T v[38:39],v20,51200
M v[180:183],a[156:159],a[200:203],v[180:183]
SA m0,s4,139264
T v[40:41],v20,53248
T v[42:43],v20,55296
M v[180:183],a[160:163],a[208:211],v[180:183]
buffer_load_dwordx4 v8, s[52:55], s25 offen lds
M v[180:183],a[164:167],a[216:219],v[180:183]
s_nop 0
T v[44:45],v20,57344
T v[46:47],v20,59392
M v[180:183],a[168:171],a[224:227],v[180:183]
T v[48:49],v20,61440
T v[50:51],v20,63488
M v[188:191],a[168:171],a[228:231],0
s_mov_b32 s25, 3408128
buffer_store_dwordx4 v[112:115], v7, s[8:11], s3 offen offset:2048 sc1
M v[188:191],a[164:167],a[220:223],v[188:191]
SA m0,s4,143360
T v[52:53],v16,32768
T v[54:55],v16,34816
M v[188:191],a[160:163],a[212:215],v[188:191]
T v[56:57],v16,36864
T v[58:59],v16,38912
M v[188:191],a[156:159],a[204:207],v[188:191]
buffer_load_dwordx4 v8, s[52:55], s25 offen lds
M v[188:191],a[152:155],a[196:199],v[188:191]
v_cmp_lt_i32 s[48:49], -2, v24
v_cmp_lt_i32 s[50:51], -3, v24
M v[188:191],a[148:151],a[188:191],v[188:191]
buffer_store_dwordx4 v[120:123], v7, s[8:11], s3 offen offset:3072 sc1
M v[188:191],a[144:147],a[180:183],v[188:191]
s_waitcnt lgkmcnt(6)
v_lshl_add_u32 v25, v0, 7, s95
v_and_b32 v0, 48, v0
M v[132:135],v[32:35],a[232:235],v[132:135]
s_mov_b32 s25, 384
T a[144:145],v21,45056
T a[146:147],v21,47104
M v[132:135],v[36:39],a[96:99],v[132:135]
SA m0,s4,0
v_lshl_add_u32 v0, v0, 24, v25
v_mov_b32 v24, 0x3f80
M v[132:135],v[40:43],a[104:107],v[132:135]
s_waitcnt lgkmcnt(2)
T a[148:149],v21,49152
T a[150:151],v21,51200
M v[132:135],v[44:47],a[112:115],v[132:135]
T a[152:153],v21,53248
T a[154:155],v21,55296
M v[132:135],v[48:51],a[120:123],v[132:135]
buffer_load_dwordx4 v8, s[52:55], s25 offen lds
M v[132:135],v[52:55],a[128:131],v[132:135]
s_nop 0
T a[156:157],v21,57344
T a[158:159],v21,59392
M v[132:135],v[56:59],a[136:139],v[132:135]
T a[160:161],v21,61440
T a[162:163],v21,63488
M v[140:143],v[56:59],a[140:143],v[140:143]
s_mov_b32 s25, 262528
MF v111,s5,v111
MF v124,s5,v124
M v[140:143],v[52:55],a[132:135],v[140:143]
SA m0,s4,4096
T a[164:165],v17,32768
T a[166:167],v17,34816
M v[140:143],v[48:51],a[124:127],v[140:143]
T a[168:169],v17,36864
T a[170:171],v17,38912
M v[140:143],v[44:47],a[116:119],v[140:143]
buffer_load_dwordx4 v8, s[52:55], s25 offen lds
M v[140:143],v[40:43],a[108:111],v[140:143]
MF v125,s5,v125
MF v126,s5,v126
M v[140:143],v[36:39],a[100:103],v[140:143]
MF v127,s5,v127
C v108,v108,v109
M v[140:143],v[32:35],a[236:239],v[140:143]
s_waitcnt lgkmcnt(6)
C v109,v110,v111
C v110,v124,v125
M v[148:151],a[144:147],a[232:235],v[148:151]
s_mov_b32 s25, 524672
T v[32:33],v22,45056
T v[34:35],v22,47104
M v[148:151],a[148:151],a[96:99],v[148:151]
SA m0,s4,8192
C v111,v126,v127
W a36,v108
M v[148:151],a[152:155],a[104:107],v[148:151]
s_waitcnt lgkmcnt(2)
T v[36:37],v22,49152
T v[38:39],v22,51200
M v[148:151],a[156:159],a[112:115],v[148:151]
T v[40:41],v22,53248
T v[42:43],v22,55296
M v[148:151],a[160:163],a[120:123],v[148:151]
buffer_load_dwordx4 v8, s[52:55], s25 offen lds
M v[148:151],a[164:167],a[128:131],v[148:151]
s_nop 0
T v[44:45],v22,57344
T v[46:47],v22,59392
M v[148:151],a[168:171],a[136:139],v[148:151]
T v[48:49],v22,61440
T v[50:51],v22,63488
M v[156:159],a[168:171],a[140:143],v[156:159]
s_mov_b32 s25, 786816
W a37,v109
W a38,v110
M v[156:159],a[164:167],a[132:135],v[156:159]
SA m0,s4,12288
T v[52:53],v18,32768
T v[54:55],v18,34816
M v[156:159],a[160:163],a[124:127],v[156:159]
T v[56:57],v18,36864
T v[58:59],v18,38912
M v[156:159],a[156:159],a[116:119],v[156:159]
buffer_load_dwordx4 v8, s[52:55], s25 offen lds
M v[156:159],a[152:155],a[108:111],v[156:159]
W a39,v111
v_lshrrev_b32 v25, 8, v7
M v[156:159],a[148:151],a[100:103],v[156:159]
v_bfe_u32 v26, v7, 6, 2
v_and_b32 v27, 16, v7
v_lshlrev_b32 v27, v27, v24
v_cmp_eq_u32 vcc, v25, v26
v_and_b32 v28, 32, v7
W a244,0
v_cndmask_b32 v27, 0, v27, vcc
v_cmp_eq_u32 vcc, 0, v28
W a245,0
W a248,0
v_cndmask_b32 v25, 0, v27, vcc
v_sub_u32 v26, v27, v25
W a249,0
W a246,v25
W a247,v26
M v[156:159],a[144:147],a[236:239],v[156:159]
s_waitcnt lgkmcnt(6)
MF v132,s5,v132
MF v133,s5,v133
M v[164:167],v[32:35],a[232:235],v[164:167]
s_mov_b32 s25, 1048960
T a[144:145],v23,45056
T a[146:147],v23,47104
M v[164:167],v[36:39],a[96:99],v[164:167]
SA m0,s4,16384
MF v134,s5,v134
MF v135,s5,v135
M v[164:167],v[40:43],a[104:107],v[164:167]
s_waitcnt lgkmcnt(2)
T a[148:149],v23,49152
T a[150:151],v23,51200
M v[164:167],v[44:47],a[112:115],v[164:167]
T a[152:153],v23,53248
T a[154:155],v23,55296
M v[164:167],v[48:51],a[120:123],v[164:167]
buffer_load_dwordx4 v8, s[52:55], s25 offen lds
M v[164:167],v[52:55],a[128:131],v[164:167]
s_nop 0
T a[156:157],v23,57344
T a[158:159],v23,59392
M v[164:167],v[56:59],a[136:139],v[164:167]
T a[160:161],v23,61440
T a[162:163],v23,63488
M v[172:175],v[56:59],a[140:143],v[172:175]
s_mov_b32 s25, 1311104
MF v148,s5,v148
MF v149,s5,v149
M v[172:175],v[52:55],a[132:135],v[172:175]
SA m0,s4,20480
T a[164:165],v19,32768
T a[166:167],v19,34816
M v[172:175],v[48:51],a[124:127],v[172:175]
T a[168:169],v19,36864
T a[170:171],v19,38912
M v[172:175],v[44:47],a[116:119],v[172:175]
buffer_load_dwordx4 v8, s[52:55], s25 offen lds
M v[172:175],v[40:43],a[108:111],v[172:175]
MF v150,s5,v150
MF v151,s5,v151
M v[172:175],v[36:39],a[100:103],v[172:175]
s_waitcnt vmcnt(7) lgkmcnt(0)
C v132,v132,v133
C v133,v134,v135
M v[172:175],v[32:35],a[236:239],v[172:175]
s_barrier
M v[180:183],a[144:147],a[232:235],v[180:183]
s_mov_b32 s25, 1573248
T v[32:33],v20,0
T v[34:35],v20,2048
M v[180:183],a[148:151],a[96:99],v[180:183]
SA m0,s4,24576
C v134,v148,v149
C v135,v150,v151
M v[180:183],a[152:155],a[104:107],v[180:183]
T v[36:37],v20,4096
T v[38:39],v20,6144
M v[180:183],a[156:159],a[112:115],v[180:183]
T v[40:41],v20,8192
T v[42:43],v20,10240
M v[180:183],a[160:163],a[120:123],v[180:183]
buffer_load_dwordx4 v8, s[52:55], s25 offen lds
M v[180:183],a[164:167],a[128:131],v[180:183]
s_nop 0
T v[44:45],v20,12288
T v[46:47],v20,14336
M v[180:183],a[168:171],a[136:139],v[180:183]
T v[48:49],v20,16384
T v[50:51],v20,18432
M v[188:191],a[168:171],a[140:143],v[188:191]
s_mov_b32 s25, 1835392
W a8,v132
W a9,v133
M v[188:191],a[164:167],a[132:135],v[188:191]
SA m0,s4,28672
T v[52:53],v20,20480
T v[54:55],v20,22528
M v[188:191],a[160:163],a[124:127],v[188:191]
T v[56:57],v20,24576
T v[58:59],v20,26624
M v[188:191],a[156:159],a[116:119],v[188:191]
buffer_load_dwordx4 v8, s[52:55], s25 offen lds
M v[188:191],a[152:155],a[108:111],v[188:191]
W a10,v134
W a11,v135
M v[188:191],a[148:151],a[100:103],v[188:191]
v_lshrrev_b32 v31, 6, v7
v_bfe_u32 v28, v7, 4, 2
M v[188:191],a[144:147],a[236:239],v[188:191]
s_waitcnt lgkmcnt(6)
v_lshlrev_b32 v31, 5, v31
v_add_lshl_u32 v31, v31, v28, 2
M v[68:71],v[32:35],a[176:179],0
s_mov_b32 s25, 2097536
T a[144:145],v21,0
T a[146:147],v21,2048
M v[68:71],v[36:39],a[184:187],v[68:71]
SA m0,s4,40960
buffer_load_dword v5, v31, s[8:11], s46 offen offset:4 sc1
M v[68:71],v[40:43],a[192:195],v[68:71]
s_waitcnt lgkmcnt(2)
s_nop 0
T a[148:149],v21,4096
T a[150:151],v21,6144
M v[68:71],v[44:47],a[200:203],v[68:71]
T a[152:153],v21,8192
T a[154:155],v21,10240
M v[68:71],v[48:51],a[208:211],v[68:71]
buffer_load_dwordx4 v8, s[52:55], s25 offen lds
M v[68:71],v[52:55],a[216:219],v[68:71]
s_nop 0
T a[156:157],v21,12288
T a[158:159],v21,14336
M v[68:71],v[56:59],a[224:227],v[68:71]
T a[160:161],v21,16384
T a[162:163],v21,18432
M v[76:79],v[56:59],a[228:231],0
s_mov_b32 s25, 2359680
MF v140,s5,v140
MF v141,s5,v141
M v[76:79],v[52:55],a[220:223],v[76:79]
SA m0,s4,45056
T a[164:165],v21,20480
T a[166:167],v21,22528
M v[76:79],v[48:51],a[212:215],v[76:79]
T a[168:169],v21,24576
T a[170:171],v21,26624
M v[76:79],v[44:47],a[204:207],v[76:79]
buffer_load_dwordx4 v8, s[52:55], s25 offen lds
M v[76:79],v[40:43],a[196:199],v[76:79]
MF v142,s5,v142
MF v143,s5,v143
M v[76:79],v[36:39],a[188:191],v[76:79]
MF v156,s5,v156
MF v157,s5,v157
M v[76:79],v[32:35],a[180:183],v[76:79]
s_waitcnt lgkmcnt(6)
MF v158,s5,v158
MF v159,s5,v159
M v[84:87],a[144:147],a[176:179],0
s_mov_b32 s25, 2621824
T v[32:33],v22,0
T v[34:35],v22,2048
M v[84:87],a[148:151],a[184:187],v[84:87]
SA m0,s4,49152
C v140,v140,v141
C v141,v142,v143
M v[84:87],a[152:155],a[192:195],v[84:87]
s_waitcnt lgkmcnt(2)
T v[36:37],v22,4096
T v[38:39],v22,6144
M v[84:87],a[156:159],a[200:203],v[84:87]
SA s3,s93,262144
T v[40:41],v22,8192
T v[42:43],v22,10240
M v[84:87],a[160:163],a[208:211],v[84:87]
buffer_load_dwordx4 v8, s[52:55], s25 offen lds
M v[84:87],a[164:167],a[216:219],v[84:87]
s_nop 0
T v[44:45],v22,12288
T v[46:47],v22,14336
M v[84:87],a[168:171],a[224:227],v[84:87]
T v[48:49],v22,16384
T v[50:51],v22,18432
M v[92:95],a[168:171],a[228:231],0
s_mov_b32 s25, 2883968
buffer_store_dwordx4 v[128:131], v7, s[8:11], s3 offen offset:0 sc1
M v[92:95],a[164:167],a[220:223],v[92:95]
SA m0,s4,53248
T v[52:53],v22,20480
T v[54:55],v22,22528
M v[92:95],a[160:163],a[212:215],v[92:95]
T v[56:57],v22,24576
T v[58:59],v22,26624
M v[92:95],a[156:159],a[204:207],v[92:95]
buffer_load_dwordx4 v8, s[52:55], s25 offen lds
M v[92:95],a[152:155],a[196:199],v[92:95]
C v142,v156,v157
C v143,v158,v159
M v[92:95],a[148:151],a[188:191],v[92:95]
buffer_store_dwordx4 v[136:139], v7, s[8:11], s3 offen offset:1024 sc1
M v[92:95],a[144:147],a[180:183],v[92:95]
s_waitcnt lgkmcnt(6)
W a40,v140
W a41,v141
M v[100:103],v[32:35],a[176:179],0
s_mov_b32 s25, 3146112
T a[144:145],v23,0
T a[146:147],v23,2048
M v[100:103],v[36:39],a[184:187],v[100:103]
SA m0,s4,57344
buffer_store_dwordx4 v[144:147], v7, s[8:11], s3 offen offset:2048 sc1
M v[100:103],v[40:43],a[192:195],v[100:103]
s_waitcnt lgkmcnt(2)
s_nop 0
T a[148:149],v23,4096
T a[150:151],v23,6144
M v[100:103],v[44:47],a[200:203],v[100:103]
T a[152:153],v23,8192
T a[154:155],v23,10240
M v[100:103],v[48:51],a[208:211],v[100:103]
buffer_load_dwordx4 v8, s[52:55], s25 offen lds
M v[100:103],v[52:55],a[216:219],v[100:103]
s_nop 0
T a[156:157],v23,12288
T a[158:159],v23,14336
M v[100:103],v[56:59],a[224:227],v[100:103]
T a[160:161],v23,16384
T a[162:163],v23,18432
M v[108:111],v[56:59],a[228:231],0
s_mov_b32 s25, 3408256
buffer_store_dwordx4 v[152:155], v7, s[8:11], s3 offen offset:3072 sc1
M v[108:111],v[52:55],a[220:223],v[108:111]
SA m0,s4,61440
T a[164:165],v23,20480
T a[166:167],v23,22528
M v[108:111],v[48:51],a[212:215],v[108:111]
T a[168:169],v23,24576
T a[170:171],v23,26624
M v[108:111],v[44:47],a[204:207],v[108:111]
buffer_load_dwordx4 v8, s[52:55], s25 offen lds
M v[108:111],v[40:43],a[196:199],v[108:111]
W a42,v142
W a43,v143
M v[108:111],v[36:39],a[188:191],v[108:111]
v_mov_b32 v8, 0xff800000
MF v164,s5,v164
M v[108:111],v[32:35],a[180:183],v[108:111]
s_waitcnt lgkmcnt(6)
MF v165,s5,v165
MF v166,s5,v166
M v[116:119],a[144:147],a[176:179],0
T v[32:33],v20,28672
T v[34:35],v20,30720
M v[116:119],a[148:151],a[184:187],v[116:119]
MF v167,s5,v167
MF v180,s5,v180
M v[116:119],a[152:155],a[192:195],v[116:119]
s_waitcnt lgkmcnt(2)
T v[36:37],v12,24576
T v[38:39],v12,26624
M v[116:119],a[156:159],a[200:203],v[116:119]
T v[40:41],v12,28672
T v[42:43],v12,30720
M v[116:119],a[160:163],a[208:211],v[116:119]
MF v181,s5,v181
MF v182,s5,v182
M v[116:119],a[164:167],a[216:219],v[116:119]
T v[44:45],v12,0
T v[46:47],v12,2048
M v[116:119],a[168:171],a[224:227],v[116:119]
T v[48:49],v12,4096
T v[50:51],v12,6144
M v[124:127],a[168:171],a[228:231],0
MF v183,s5,v183
C v164,v164,v165
M v[124:127],a[164:167],a[220:223],v[124:127]
T v[52:53],v12,8192
T v[54:55],v12,10240
M v[124:127],a[160:163],a[212:215],v[124:127]
T v[56:57],v12,12288
T v[58:59],v12,14336
M v[124:127],a[156:159],a[204:207],v[124:127]
C v165,v166,v167
C v166,v180,v181
M v[124:127],a[152:155],a[196:199],v[124:127]
C v167,v182,v183
W a12,v164
M v[124:127],a[148:151],a[188:191],v[124:127]
W a13,v165
W a14,v166
M v[124:127],a[144:147],a[180:183],v[124:127]
s_waitcnt lgkmcnt(6)
W a15,v167
MF v172,s5,v172
M v[68:71],v[32:35],a[232:235],v[68:71]
T a[144:145],v21,28672
T a[146:147],v21,30720
M v[68:71],v[36:39],a[96:99],v[68:71]
MF v173,s5,v173
MF v174,s5,v174
M v[68:71],v[40:43],a[104:107],v[68:71]
s_waitcnt lgkmcnt(2)
T a[148:149],v13,24576
T a[150:151],v13,26624
M v[68:71],v[44:47],a[112:115],v[68:71]
T a[152:153],v13,28672
T a[154:155],v13,30720
M v[68:71],v[48:51],a[120:123],v[68:71]
MF v175,s5,v175
MF v188,s5,v188
M v[68:71],v[52:55],a[128:131],v[68:71]
T a[156:157],v13,0
T a[158:159],v13,2048
M v[68:71],v[56:59],a[136:139],v[68:71]
T a[160:161],v13,4096
T a[162:163],v13,6144
M v[76:79],v[56:59],a[140:143],v[76:79]
MF v189,s5,v189
MF v190,s5,v190
M v[76:79],v[52:55],a[132:135],v[76:79]
T a[164:165],v13,8192
T a[166:167],v13,10240
M v[76:79],v[48:51],a[124:127],v[76:79]
T a[168:169],v13,12288
T a[170:171],v13,14336
M v[76:79],v[44:47],a[116:119],v[76:79]
MF v191,s5,v191
C v172,v172,v173
M v[76:79],v[40:43],a[108:111],v[76:79]
C v173,v174,v175
C v174,v188,v189
M v[76:79],v[36:39],a[100:103],v[76:79]
C v175,v190,v191
W a44,v172
M v[76:79],v[32:35],a[236:239],v[76:79]
s_waitcnt lgkmcnt(6)
W a45,v173
W a46,v174
M v[84:87],a[144:147],a[232:235],v[84:87]
T v[32:33],v22,28672
T v[34:35],v22,30720
M v[84:87],a[148:151],a[96:99],v[84:87]
W a47,v175
s_waitcnt vmcnt(10)
v_cmp_ne_u32 vcc, 1, v5
M v[84:87],a[152:155],a[104:107],v[84:87]
s_waitcnt lgkmcnt(2)
T v[36:37],v14,24576
T v[38:39],v14,26624
M v[84:87],a[156:159],a[112:115],v[84:87]
s_nop 0
T v[40:41],v14,28672
T v[42:43],v14,30720
M v[84:87],a[160:163],a[120:123],v[84:87]
s_cmp_lg_u32 vcc_lo, 0
M v[84:87],a[164:167],a[128:131],v[84:87]
s_cbranch_scc1 L_wsq0
L_wrq0:
T v[44:45],v14,0
T v[46:47],v14,2048
M v[84:87],a[168:171],a[136:139],v[84:87]
SA m0,s28,98304
T v[48:49],v14,4096
T v[50:51],v14,6144
M v[92:95],a[168:171],a[140:143],v[92:95]
buffer_load_dwordx4 v3, s[8:11], s21 offen offset:0 sc1 lds
M v[92:95],a[164:167],a[132:135],v[92:95]
s_nop 0
T v[52:53],v14,8192
T v[54:55],v14,10240
M v[92:95],a[160:163],a[124:127],v[92:95]
T v[56:57],v14,12288
T v[58:59],v14,14336
M v[92:95],a[156:159],a[116:119],v[92:95]
buffer_load_dwordx4 v3, s[8:11], s21 offen offset:1024 sc1 lds
M v[92:95],a[152:155],a[108:111],v[92:95]
MF v68,s5,v68
MF v69,s5,v69
M v[92:95],a[148:151],a[100:103],v[92:95]
buffer_load_dwordx4 v3, s[8:11], s21 offen offset:2048 sc1 lds
M v[92:95],a[144:147],a[236:239],v[92:95]
s_waitcnt lgkmcnt(6)
MF v70,s5,v70
MF v71,s5,v71
M v[100:103],v[32:35],a[232:235],v[100:103]
T a[144:145],v23,28672
T a[146:147],v23,30720
M v[100:103],v[36:39],a[96:99],v[100:103]
buffer_load_dwordx4 v3, s[8:11], s21 offen offset:3072 sc1 lds
M v[100:103],v[40:43],a[104:107],v[100:103]
s_waitcnt lgkmcnt(2)
s_nop 0
T a[148:149],v15,24576
T a[150:151],v15,26624
M v[100:103],v[44:47],a[112:115],v[100:103]
SA m0,s28,102400
T a[152:153],v15,28672
T a[154:155],v15,30720
M v[100:103],v[48:51],a[120:123],v[100:103]
buffer_load_dwordx4 v4, s[8:11], s21 offen offset:0 sc1 lds
M v[100:103],v[52:55],a[128:131],v[100:103]
s_nop 0
T a[156:157],v15,0
T a[158:159],v15,2048
M v[100:103],v[56:59],a[136:139],v[100:103]
T a[160:161],v15,4096
T a[162:163],v15,6144
M v[108:111],v[56:59],a[140:143],v[108:111]
buffer_load_dwordx4 v4, s[8:11], s21 offen offset:1024 sc1 lds
M v[108:111],v[52:55],a[132:135],v[108:111]
s_nop 0
T a[164:165],v15,8192
T a[166:167],v15,10240
M v[108:111],v[48:51],a[124:127],v[108:111]
T a[168:169],v15,12288
T a[170:171],v15,14336
M v[108:111],v[44:47],a[116:119],v[108:111]
buffer_load_dwordx4 v4, s[8:11], s21 offen offset:2048 sc1 lds
M v[108:111],v[40:43],a[108:111],v[108:111]
MF v84,s5,v84
MF v85,s5,v85
M v[108:111],v[36:39],a[100:103],v[108:111]
s_waitcnt vmcnt(7) lgkmcnt(0)
buffer_load_dwordx4 v4, s[8:11], s21 offen offset:3072 sc1 lds
M v[108:111],v[32:35],a[236:239],v[108:111]
s_barrier
M v[116:119],a[144:147],a[232:235],v[116:119]
SA s21,s21,32768
T v[32:33],v16,0
T v[34:35],v16,2048
M v[116:119],a[148:151],a[96:99],v[116:119]
s_sub_u32 s22, s22, 1
MF v86,s5,v86
MF v87,s5,v87
M v[116:119],a[152:155],a[104:107],v[116:119]
s_cselect_b32 s21, s23, s21
T v[36:37],v16,4096
T v[38:39],v16,6144
M v[116:119],a[156:159],a[112:115],v[116:119]
SA m0,s28,65536
T v[40:41],v16,8192
T v[42:43],v16,10240
M v[116:119],a[160:163],a[120:123],v[116:119]
buffer_load_dwordx4 v3, s[8:11], s21 offen offset:0 sc1 lds
M v[116:119],a[164:167],a[128:131],v[116:119]
s_nop 0
T v[44:45],v16,12288
T v[46:47],v16,14336
M v[116:119],a[168:171],a[136:139],v[116:119]
T v[48:49],v16,16384
T v[50:51],v16,18432
M v[124:127],a[168:171],a[140:143],v[124:127]
buffer_load_dwordx4 v3, s[8:11], s21 offen offset:1024 sc1 lds
M v[124:127],a[164:167],a[132:135],v[124:127]
s_nop 0
T v[52:53],v16,20480
T v[54:55],v16,22528
M v[124:127],a[160:163],a[124:127],v[124:127]
T v[56:57],v16,24576
T v[58:59],v16,26624
M v[124:127],a[156:159],a[116:119],v[124:127]
buffer_load_dword v5, v31, s[8:11], s46 offen offset:4 sc1
M v[124:127],a[152:155],a[108:111],v[124:127]
buffer_load_dwordx4 v3, s[8:11], s21 offen offset:2048 sc1 lds
M v[124:127],a[148:151],a[100:103],v[124:127]
C v68,v68,v69
C v69,v70,v71
M v[124:127],a[144:147],a[236:239],v[124:127]
s_waitcnt lgkmcnt(6)
buffer_load_dwordx4 v3, s[8:11], s21 offen offset:3072 sc1 lds
M v[132:135],v[32:35],a[176:179],0
SA m0,s28,69632
T a[144:145],v17,0
T a[146:147],v17,2048
M v[132:135],v[36:39],a[184:187],v[132:135]
buffer_load_dwordx4 v4, s[8:11], s21 offen offset:0 sc1 lds
M v[132:135],v[40:43],a[192:195],v[132:135]
s_waitcnt lgkmcnt(2)
s_nop 0
T a[148:149],v17,4096
T a[150:151],v17,6144
M v[132:135],v[44:47],a[200:203],v[132:135]
T a[152:153],v17,8192
T a[154:155],v17,10240
M v[132:135],v[48:51],a[208:211],v[132:135]
buffer_load_dwordx4 v4, s[8:11], s21 offen offset:1024 sc1 lds
M v[132:135],v[52:55],a[216:219],v[132:135]
s_nop 0
T a[156:157],v17,12288
T a[158:159],v17,14336
M v[132:135],v[56:59],a[224:227],v[132:135]
T a[160:161],v17,16384
T a[162:163],v17,18432
M v[140:143],v[56:59],a[228:231],0
buffer_load_dwordx4 v4, s[8:11], s21 offen offset:2048 sc1 lds
M v[140:143],v[52:55],a[220:223],v[140:143]
s_nop 0
T a[164:165],v17,20480
T a[166:167],v17,22528
M v[140:143],v[48:51],a[212:215],v[140:143]
T a[168:169],v17,24576
T a[170:171],v17,26624
M v[140:143],v[44:47],a[204:207],v[140:143]
buffer_load_dwordx4 v4, s[8:11], s21 offen offset:3072 sc1 lds
M v[140:143],v[40:43],a[196:199],v[140:143]
SA s21,s21,32768
C v70,v84,v85
C v71,v86,v87
M v[140:143],v[36:39],a[188:191],v[140:143]
s_sub_u32 s22, s22, 1
W a16,v68
W a17,v69
M v[140:143],v[32:35],a[180:183],v[140:143]
s_waitcnt lgkmcnt(6)
W a18,v70
W a19,v71
M v[148:151],a[144:147],a[176:179],0
s_cselect_b32 s21, s23, s21
T v[32:33],v18,0
T v[34:35],v18,2048
M v[148:151],a[148:151],a[184:187],v[148:151]
MF v76,s5,v76
MF v77,s5,v77
M v[148:151],a[152:155],a[192:195],v[148:151]
s_waitcnt lgkmcnt(2)
T v[36:37],v18,4096
T v[38:39],v18,6144
M v[148:151],a[156:159],a[200:203],v[148:151]
T v[40:41],v18,8192
T v[42:43],v18,10240
M v[148:151],a[160:163],a[208:211],v[148:151]
MF v78,s5,v78
MF v79,s5,v79
M v[148:151],a[164:167],a[216:219],v[148:151]
T v[44:45],v18,12288
T v[46:47],v18,14336
M v[148:151],a[168:171],a[224:227],v[148:151]
T v[48:49],v18,16384
T v[50:51],v18,18432
M v[156:159],a[168:171],a[228:231],0
MF v92,s5,v92
MF v93,s5,v93
M v[156:159],a[164:167],a[220:223],v[156:159]
T v[52:53],v18,20480
T v[54:55],v18,22528
M v[156:159],a[160:163],a[212:215],v[156:159]
T v[56:57],v18,24576
T v[58:59],v18,26624
M v[156:159],a[156:159],a[204:207],v[156:159]
MF v94,s5,v94
MF v95,s5,v95
M v[156:159],a[152:155],a[196:199],v[156:159]
C v76,v76,v77
C v77,v78,v79
M v[156:159],a[148:151],a[188:191],v[156:159]
C v78,v92,v93
C v79,v94,v95
M v[156:159],a[144:147],a[180:183],v[156:159]
s_waitcnt lgkmcnt(6)
W a48,v76
W a49,v77
M v[164:167],v[32:35],a[176:179],0
T a[144:145],v19,0
T a[146:147],v19,2048
M v[164:167],v[36:39],a[184:187],v[164:167]
W a50,v78
W a51,v79
M v[164:167],v[40:43],a[192:195],v[164:167]
s_waitcnt lgkmcnt(2)
T a[148:149],v19,4096
T a[150:151],v19,6144
M v[164:167],v[44:47],a[200:203],v[164:167]
T a[152:153],v19,8192
T a[154:155],v19,10240
M v[164:167],v[48:51],a[208:211],v[164:167]
v_mov_b32 v30, 2
MF v100,s5,v100
M v[164:167],v[52:55],a[216:219],v[164:167]
T a[156:157],v19,12288
T a[158:159],v19,14336
M v[164:167],v[56:59],a[224:227],v[164:167]
T a[160:161],v19,16384
T a[162:163],v19,18432
M v[172:175],v[56:59],a[228:231],0
buffer_store_dword v30, v1, s[8:11], s45 offen sc1
M v[172:175],v[52:55],a[220:223],v[172:175]
s_nop 0
T a[164:165],v19,20480
T a[166:167],v19,22528
M v[172:175],v[48:51],a[212:215],v[172:175]
T a[168:169],v19,24576
T a[170:171],v19,26624
M v[172:175],v[44:47],a[204:207],v[172:175]
MF v101,s5,v101
MF v102,s5,v102
M v[172:175],v[40:43],a[196:199],v[172:175]
MF v103,s5,v103
MF v116,s5,v116
M v[172:175],v[36:39],a[188:191],v[172:175]
MF v117,s5,v117
MF v118,s5,v118
M v[172:175],v[32:35],a[180:183],v[172:175]
s_waitcnt lgkmcnt(6)
MF v119,s5,v119
C v100,v100,v101
M v[180:183],a[144:147],a[176:179],0
T v[32:33],v16,28672
T v[34:35],v16,30720
M v[180:183],a[148:151],a[184:187],v[180:183]
C v101,v102,v103
C v102,v116,v117
M v[180:183],a[152:155],a[192:195],v[180:183]
s_waitcnt lgkmcnt(2)
T v[36:37],v16,40960
T v[38:39],v16,43008
M v[180:183],a[156:159],a[200:203],v[180:183]
SA s3,s93,270336
T v[40:41],v16,45056
T v[42:43],v16,47104
M v[180:183],a[160:163],a[208:211],v[180:183]
buffer_store_dwordx4 v[160:163], v7, s[8:11], s3 offen offset:0 sc1
M v[180:183],a[164:167],a[216:219],v[180:183]
s_nop 0
T v[44:45],v16,49152
T v[46:47],v16,51200
M v[180:183],a[168:171],a[224:227],v[180:183]
T v[48:49],v16,53248
T v[50:51],v16,55296
M v[188:191],a[168:171],a[228:231],0
buffer_store_dwordx4 v[168:171], v7, s[8:11], s3 offen offset:1024 sc1
M v[188:191],a[164:167],a[220:223],v[188:191]
s_nop 0
T v[52:53],v16,57344
T v[54:55],v16,59392
M v[188:191],a[160:163],a[212:215],v[188:191]
T v[56:57],v16,61440
T v[58:59],v16,63488
M v[188:191],a[156:159],a[204:207],v[188:191]
buffer_store_dwordx4 v[176:179], v7, s[8:11], s3 offen offset:2048 sc1
M v[188:191],a[152:155],a[196:199],v[188:191]
C v103,v118,v119
W a20,v100
M v[188:191],a[148:151],a[188:191],v[188:191]
buffer_store_dwordx4 v[184:187], v7, s[8:11], s3 offen offset:3072 sc1
M v[188:191],a[144:147],a[180:183],v[188:191]
s_waitcnt lgkmcnt(6)
W a21,v101
W a22,v102
M v[132:135],v[32:35],a[232:235],v[132:135]
T a[144:145],v17,28672
T a[146:147],v17,30720
M v[132:135],v[36:39],a[96:99],v[132:135]
W a23,v103
MF v108,s5,v108
M v[132:135],v[40:43],a[104:107],v[132:135]
s_waitcnt lgkmcnt(2)
T a[148:149],v17,40960
T a[150:151],v17,43008
M v[132:135],v[44:47],a[112:115],v[132:135]
T a[152:153],v17,45056
T a[154:155],v17,47104
M v[132:135],v[48:51],a[120:123],v[132:135]
MF v109,s5,v109
MF v110,s5,v110
M v[132:135],v[52:55],a[128:131],v[132:135]
T a[156:157],v17,49152
T a[158:159],v17,51200
M v[132:135],v[56:59],a[136:139],v[132:135]
T a[160:161],v17,53248
T a[162:163],v17,55296
M v[140:143],v[56:59],a[140:143],v[140:143]
MF v111,s5,v111
MF v124,s5,v124
M v[140:143],v[52:55],a[132:135],v[140:143]
T a[164:165],v17,57344
T a[166:167],v17,59392
M v[140:143],v[48:51],a[124:127],v[140:143]
T a[168:169],v17,61440
T a[170:171],v17,63488
M v[140:143],v[44:47],a[116:119],v[140:143]
MF v125,s5,v125
MF v126,s5,v126
M v[140:143],v[40:43],a[108:111],v[140:143]
MF v127,s5,v127
C v108,v108,v109
M v[140:143],v[36:39],a[100:103],v[140:143]
C v109,v110,v111
C v110,v124,v125
M v[140:143],v[32:35],a[236:239],v[140:143]
s_waitcnt lgkmcnt(6)
C v111,v126,v127
W a52,v108
M v[148:151],a[144:147],a[232:235],v[148:151]
T v[32:33],v18,28672
T v[34:35],v18,30720
M v[148:151],a[148:151],a[96:99],v[148:151]
W a53,v109
W a54,v110
M v[148:151],a[152:155],a[104:107],v[148:151]
s_waitcnt lgkmcnt(2)
T v[36:37],v18,40960
T v[38:39],v18,43008
M v[148:151],a[156:159],a[112:115],v[148:151]
T v[40:41],v18,45056
T v[42:43],v18,47104
M v[148:151],a[160:163],a[120:123],v[148:151]
W a55,v111
s_waitcnt vmcnt(11)
v_cmp_ne_u32 vcc, 1, v5
M v[148:151],a[164:167],a[128:131],v[148:151]
s_nop 0
T v[44:45],v18,49152
T v[46:47],v18,51200
M v[148:151],a[168:171],a[136:139],v[148:151]
s_cmp_lg_u32 vcc_hi, 0
T v[48:49],v18,53248
T v[50:51],v18,55296
M v[156:159],a[168:171],a[140:143],v[156:159]
s_cbranch_scc1 L_wsr0
L_wrr0:
M v[156:159],a[164:167],a[132:135],v[156:159]
SA m0,s28,131072
T v[52:53],v18,57344
T v[54:55],v18,59392
M v[156:159],a[160:163],a[124:127],v[156:159]
T v[56:57],v18,61440
T v[58:59],v18,63488
M v[156:159],a[156:159],a[116:119],v[156:159]
buffer_load_dwordx4 v3, s[8:11], s26 offen offset:0 sc1 lds
M v[156:159],a[152:155],a[108:111],v[156:159]
MF v132,s5,v132
MF v133,s5,v133
M v[156:159],a[148:151],a[100:103],v[156:159]
buffer_load_dwordx4 v3, s[8:11], s26 offen offset:1024 sc1 lds
M v[156:159],a[144:147],a[236:239],v[156:159]
s_waitcnt lgkmcnt(6)
MF v134,s5,v134
MF v135,s5,v135
M v[164:167],v[32:35],a[232:235],v[164:167]
T a[144:145],v19,28672
T a[146:147],v19,30720
M v[164:167],v[36:39],a[96:99],v[164:167]
buffer_load_dwordx4 v3, s[8:11], s26 offen offset:2048 sc1 lds
M v[164:167],v[40:43],a[104:107],v[164:167]
s_waitcnt lgkmcnt(2)
s_nop 0
T a[148:149],v19,40960
T a[150:151],v19,43008
M v[164:167],v[44:47],a[112:115],v[164:167]
T a[152:153],v19,45056
T a[154:155],v19,47104
M v[164:167],v[48:51],a[120:123],v[164:167]
buffer_load_dwordx4 v3, s[8:11], s26 offen offset:3072 sc1 lds
M v[164:167],v[52:55],a[128:131],v[164:167]
SA m0,s28,135168
T a[156:157],v19,49152
T a[158:159],v19,51200
M v[164:167],v[56:59],a[136:139],v[164:167]
T a[160:161],v19,53248
T a[162:163],v19,55296
M v[172:175],v[56:59],a[140:143],v[172:175]
buffer_load_dwordx4 v4, s[8:11], s26 offen offset:0 sc1 lds
M v[172:175],v[52:55],a[132:135],v[172:175]
s_nop 0
T a[164:165],v19,57344
T a[166:167],v19,59392
M v[172:175],v[48:51],a[124:127],v[172:175]
T a[168:169],v19,61440
T a[170:171],v19,63488
M v[172:175],v[44:47],a[116:119],v[172:175]
buffer_load_dwordx4 v4, s[8:11], s26 offen offset:1024 sc1 lds
M v[172:175],v[40:43],a[108:111],v[172:175]
MF v148,s5,v148
MF v149,s5,v149
M v[172:175],v[36:39],a[100:103],v[172:175]
s_waitcnt lgkmcnt(0)
buffer_load_dwordx4 v4, s[8:11], s26 offen offset:2048 sc1 lds
M v[172:175],v[32:35],a[236:239],v[172:175]
s_barrier
M v[180:183],a[144:147],a[232:235],v[180:183]
R a[64:67],v2,32768
R a[68:71],v2,33792
M v[180:183],a[148:151],a[96:99],v[180:183]
buffer_load_dwordx4 v4, s[8:11], s26 offen offset:3072 sc1 lds
M v[180:183],a[152:155],a[104:107],v[180:183]
SA s26,s26,32768
MF v150,s5,v150
MF v151,s5,v151
M v[180:183],a[156:159],a[112:115],v[180:183]
R a[72:75],v2,34816
R a[76:79],v2,35840
M v[180:183],a[160:163],a[120:123],v[180:183]
C v132,v132,v133
C v133,v134,v135
M v[180:183],a[164:167],a[128:131],v[180:183]
C v134,v148,v149
C v135,v150,v151
M v[180:183],a[168:171],a[136:139],v[180:183]
R a[80:83],v2,36864
R a[84:87],v2,37888
M v[188:191],a[168:171],a[140:143],v[188:191]
W a24,v132
W a25,v133
M v[188:191],a[164:167],a[132:135],v[188:191]
W a26,v134
W a27,v135
M v[188:191],a[160:163],a[124:127],v[188:191]
R a[88:91],v2,38912
R a[92:95],v2,39936
M v[188:191],a[156:159],a[116:119],v[188:191]
MF v140,s5,v140
MF v141,s5,v141
M v[188:191],a[152:155],a[108:111],v[188:191]
MF v142,s5,v142
MF v143,s5,v143
M v[188:191],a[148:151],a[100:103],v[188:191]
MF v156,s5,v156
MF v157,s5,v157
M v[188:191],a[144:147],a[236:239],v[188:191]
s_waitcnt lgkmcnt(0)
MF v158,s5,v158
MF v159,s5,v159
C v140,v140,v141
C v141,v142,v143
C v142,v156,v157
C v143,v158,v159
W a56,v140
W a57,v141
W a58,v142
W a59,v143
s_cmp_eq_u32 s42, 0
s_cbranch_scc1 L_j0
M v[64:67],a[64:67],a[0:3],0
R a[96:99],v2,40960
R a[100:103],v2,41984
M v[64:67],a[68:71],a[4:7],v[64:67]
MF v164,s5,v164
MF v165,s5,v165
M v[64:67],a[72:75],a[8:11],v[64:67]
MF v166,s5,v166
MF v167,s5,v167
M v[64:67],a[76:79],a[12:15],v[64:67]
R a[104:107],v2,43008
R a[108:111],v2,44032
M v[64:67],a[80:83],a[16:19],v[64:67]
MF v180,s5,v180
MF v181,s5,v181
MF v182,s5,v182
MF v183,s5,v183
C v164,v164,v165
C v165,v166,v167
C v166,v180,v181
C v167,v182,v183
W a28,v164
W a29,v165
W a30,v166
W a31,v167
M v[64:67],a[84:87],a[20:23],v[64:67]
MF v172,s5,v172
MF v173,s5,v173
M v[64:67],a[88:91],a[24:27],v[64:67]
R a[112:115],v2,45056
R a[116:119],v2,46080
M v[64:67],a[92:95],a[28:31],v[64:67]
MF v174,s5,v174
MF v175,s5,v175
M v[68:71],a[64:67],a[32:35],0
MF v188,s5,v188
MF v189,s5,v189
M v[68:71],a[68:71],a[36:39],v[68:71]
R a[120:123],v2,47104
R a[124:127],v2,48128
M v[68:71],a[72:75],a[40:43],v[68:71]
SA m0,s28,32768
MF v190,s5,v190
MF v191,s5,v191
M v[68:71],a[76:79],a[44:47],v[68:71]
buffer_load_dwordx4 v3, s[8:11], s26 offen offset:0 sc1 lds
M v[68:71],a[80:83],a[48:51],v[68:71]
C v172,v172,v173
C v173,v174,v175
C v174,v188,v189
C v175,v190,v191
W a60,v172
W a61,v173
W a62,v174
W a63,v175
M v[68:71],a[84:87],a[52:55],v[68:71]
E v18,v64
M v[68:71],a[88:91],a[56:59],v[68:71]
M v[68:71],a[92:95],a[60:63],v[68:71]
s_waitcnt lgkmcnt(0)
buffer_load_dwordx4 v3, s[8:11], s26 offen offset:1024 sc1 lds
M v[72:75],a[96:99],a[0:3],0
R a[64:67],v2,49152
R a[68:71],v2,50176
M v[72:75],a[100:103],a[4:7],v[72:75]
E v19,v65
M v[72:75],a[104:107],a[8:11],v[72:75]
E v20,v66
M v[72:75],a[108:111],a[12:15],v[72:75]
R a[72:75],v2,51200
R a[76:79],v2,52224
M v[72:75],a[112:115],a[16:19],v[72:75]
buffer_load_dwordx4 v3, s[8:11], s26 offen offset:2048 sc1 lds
M v[72:75],a[116:119],a[20:23],v[72:75]
E v21,v67
M v[72:75],a[120:123],a[24:27],v[72:75]
R a[80:83],v2,53248
R a[84:87],v2,54272
M v[72:75],a[124:127],a[28:31],v[72:75]
buffer_load_dwordx4 v3, s[8:11], s26 offen offset:3072 sc1 lds
M v[76:79],a[124:127],a[60:63],0
SA m0,s28,36864
E v22,v68
M v[76:79],a[120:123],a[56:59],v[76:79]
R a[88:91],v2,55296
R a[92:95],v2,56320
M v[76:79],a[116:119],a[52:55],v[76:79]
buffer_load_dwordx4 v4, s[8:11], s26 offen offset:0 sc1 lds
M v[76:79],a[112:115],a[48:51],v[76:79]
E v23,v69
M v[76:79],a[108:111],a[44:47],v[76:79]
AF v26,v18,v19
C v40,v18,v19
M v[76:79],a[104:107],a[40:43],v[76:79]
buffer_load_dwordx4 v4, s[8:11], s26 offen offset:1024 sc1 lds
M v[76:79],a[100:103],a[36:39],v[76:79]
v_add_u32 v16, 0x20000, v7
AF v26,v20,v26
M v[76:79],a[96:99],a[32:35],v[76:79]
s_waitcnt lgkmcnt(0)
E v24,v70
M v[80:83],a[64:67],a[0:3],0
R a[96:99],v2,57344
R a[100:103],v2,58368
M v[80:83],a[68:71],a[4:7],v[80:83]
buffer_load_dwordx4 v4, s[8:11], s26 offen offset:2048 sc1 lds
M v[80:83],a[72:75],a[8:11],v[80:83]
SA s3,s93,786432
E v25,v71
M v[80:83],a[76:79],a[12:15],v[80:83]
R a[104:107],v2,59392
R a[108:111],v2,60416
M v[80:83],a[80:83],a[16:19],v[80:83]
buffer_load_dwordx4 v4, s[8:11], s26 offen offset:3072 sc1 lds
M v[80:83],a[84:87],a[20:23],v[80:83]
SA s26,s26,32768
E v18,v72
M v[80:83],a[88:91],a[24:27],v[80:83]
R a[112:115],v2,61440
R a[116:119],v2,62464
M v[80:83],a[92:95],a[28:31],v[80:83]
buffer_store_dwordx4 v[192:195], v7, s[8:11], s3 offen offset:0 sc1
M v[84:87],a[92:95],a[60:63],0
E v19,v73
M v[84:87],a[88:91],a[56:59],v[84:87]
R a[120:123],v2,63488
R a[124:127],v2,64512
M v[84:87],a[84:87],a[52:55],v[84:87]
C v41,v20,v21
AF v26,v21,v26
M v[84:87],a[80:83],a[48:51],v[84:87]
buffer_store_dwordx4 v[200:203], v7, s[8:11], s3 offen offset:1024 sc1
M v[84:87],a[76:79],a[44:47],v[84:87]
E v20,v74
M v[84:87],a[72:75],a[40:43],v[84:87]
AF v27,v22,v23
C v44,v22,v23
M v[84:87],a[68:71],a[36:39],v[84:87]
s_waitcnt vmcnt(23) lgkmcnt(0)
E v21,v75
M v[84:87],a[64:67],a[32:35],v[84:87]
s_barrier
M v[88:91],a[96:99],a[0:3],0
R a[64:67],v2,0
R a[68:71],v2,1024
M v[88:91],a[100:103],a[4:7],v[88:91]
E v22,v76
M v[88:91],a[104:107],a[8:11],v[88:91]
AF v27,v24,v27
C v45,v24,v25
M v[88:91],a[108:111],a[12:15],v[88:91]
R a[72:75],v2,2048
R a[76:79],v2,3072
M v[88:91],a[112:115],a[16:19],v[88:91]
buffer_store_dwordx4 v[208:211], v7, s[8:11], s3 offen offset:2048 sc1
M v[88:91],a[116:119],a[20:23],v[88:91]
E v23,v77
M v[88:91],a[120:123],a[24:27],v[88:91]
R a[80:83],v2,4096
R a[84:87],v2,5120
M v[88:91],a[124:127],a[28:31],v[88:91]
AF v27,v25,v27
AF v26,v18,v26
M v[92:95],a[124:127],a[60:63],0
E v24,v78
M v[92:95],a[120:123],a[56:59],v[92:95]
R a[88:91],v2,6144
R a[92:95],v2,7168
M v[92:95],a[116:119],a[52:55],v[92:95]
E v25,v79
M v[92:95],a[112:115],a[48:51],v[92:95]
C v42,v18,v19
AF v26,v19,v26
M v[92:95],a[108:111],a[44:47],v[92:95]
AF v26,v20,v26
C v43,v20,v21
M v[92:95],a[104:107],a[40:43],v[92:95]
AF v26,v21,v26
AF v27,v22,v27
M v[92:95],a[100:103],a[36:39],v[92:95]
s_waitcnt lgkmcnt(0)
C v46,v22,v23
AF v27,v23,v27
M v[92:95],a[96:99],a[32:35],v[92:95]
AF v27,v24,v27
C v47,v24,v25
AF v27,v25,v27
M v[96:99],a[64:67],a[0:3],0
R a[96:99],v2,8192
R a[100:103],v2,9216
M v[96:99],a[68:71],a[4:7],v[96:99]
SA m0,s28,98304
E v18,v80
M v[96:99],a[72:75],a[8:11],v[96:99]
buffer_load_dwordx4 v3, s[8:11], s21 offen offset:0 sc1 lds
M v[96:99],a[76:79],a[12:15],v[96:99]
R a[104:107],v2,10240
R a[108:111],v2,11264
M v[96:99],a[80:83],a[16:19],v[96:99]
v_mov_b32 v30, 0
M v[96:99],a[84:87],a[20:23],v[96:99]
E v19,v81
M v[96:99],a[88:91],a[24:27],v[96:99]
R a[112:115],v2,12288
R a[116:119],v2,13312
M v[96:99],a[92:95],a[28:31],v[96:99]
buffer_load_dwordx4 v3, s[8:11], s21 offen offset:1024 sc1 lds
M v[100:103],a[92:95],a[60:63],0
v_mov_b32 v31, 0
AF v26,v18,v26
M v[100:103],a[88:91],a[56:59],v[100:103]
R a[120:123],v2,14336
R a[124:127],v2,15360
M v[100:103],a[84:87],a[52:55],v[100:103]
E v20,v82
M v[100:103],a[80:83],a[48:51],v[100:103]
buffer_load_dwordx4 v3, s[8:11], s21 offen offset:2048 sc1 lds
M v[100:103],a[76:79],a[44:47],v[100:103]
E v21,v83
M v[100:103],a[72:75],a[40:43],v[100:103]
v_mov_b32 v32, 0
C v56,v18,v19
M v[100:103],a[68:71],a[36:39],v[100:103]
E v22,v88
M v[100:103],a[64:67],a[32:35],v[100:103]
s_waitcnt lgkmcnt(0)
buffer_load_dwordx4 v3, s[8:11], s21 offen offset:3072 sc1 lds
M v[104:107],a[96:99],a[0:3],0
SA m0,s28,102400
R a[64:67],v2,16384
R a[68:71],v2,17408
M v[104:107],a[100:103],a[4:7],v[104:107]
v_mov_b32 v33, 0
AF v26,v19,v26
M v[104:107],a[104:107],a[8:11],v[104:107]
E v23,v89
M v[104:107],a[108:111],a[12:15],v[104:107]
R a[72:75],v2,18432
R a[76:79],v2,19456
M v[104:107],a[112:115],a[16:19],v[104:107]
buffer_load_dwordx4 v4, s[8:11], s21 offen offset:0 sc1 lds
M v[104:107],a[116:119],a[20:23],v[104:107]
E v24,v90
M v[104:107],a[120:123],a[24:27],v[104:107]
R a[80:83],v2,20480
R a[84:87],v2,21504
M v[104:107],a[124:127],a[28:31],v[104:107]
buffer_load_dwordx4 v4, s[8:11], s21 offen offset:1024 sc1 lds
M v[108:111],a[124:127],a[60:63],0
v_mov_b32 v34, 0
AF v26,v20,v26
M v[108:111],a[120:123],a[56:59],v[108:111]
R a[88:91],v2,22528
R a[92:95],v2,23552
M v[108:111],a[116:119],a[52:55],v[108:111]
buffer_load_dwordx4 v4, s[8:11], s21 offen offset:2048 sc1 lds
M v[108:111],a[112:115],a[48:51],v[108:111]
v_mov_b32 v35, 0
C v57,v20,v21
M v[108:111],a[108:111],a[44:47],v[108:111]
E v25,v91
M v[108:111],a[104:107],a[40:43],v[108:111]
E v18,v84
M v[108:111],a[100:103],a[36:39],v[108:111]
buffer_load_dwordx4 v4, s[8:11], s21 offen offset:3072 sc1 lds
M v[108:111],a[96:99],a[32:35],v[108:111]
s_waitcnt lgkmcnt(0)
v_mov_b32 v36, 0
AF v26,v21,v26
M v[112:115],a[64:67],a[0:3],0
SA s21,s21,32768
R a[96:99],v2,24576
R a[100:103],v2,25600
M v[112:115],a[68:71],a[4:7],v[112:115]
s_sub_u32 s22, s22, 1
E v19,v85
M v[112:115],a[72:75],a[8:11],v[112:115]
s_cselect_b32 s21, s23, s21
E v20,v86
M v[112:115],a[76:79],a[12:15],v[112:115]
SA s3,s93,786432
R a[104:107],v2,26624
R a[108:111],v2,27648
M v[112:115],a[80:83],a[16:19],v[112:115]
buffer_store_dwordx4 v[216:219], v7, s[8:11], s3 offen offset:3072 sc1
M v[112:115],a[84:87],a[20:23],v[112:115]
v_mov_b32 v37, 0
AF v26,v22,v26
M v[112:115],a[88:91],a[24:27],v[112:115]
R a[112:115],v2,28672
R a[116:119],v2,29696
M v[112:115],a[92:95],a[28:31],v[112:115]
E v21,v87
M v[116:119],a[92:95],a[60:63],0
v_mov_b32 v38, 0
C v58,v22,v23
M v[116:119],a[88:91],a[56:59],v[116:119]
SA s3,s93,794624
R a[120:123],v2,30720
R a[124:127],v2,31744
M v[116:119],a[84:87],a[52:55],v[116:119]
buffer_store_dwordx4 v[224:227], v7, s[8:11], s3 offen offset:0 sc1
M v[116:119],a[80:83],a[48:51],v[116:119]
AF v26,v23,v26
AF v26,v24,v26
M v[116:119],a[76:79],a[44:47],v[116:119]
E v22,v92
M v[116:119],a[72:75],a[40:43],v[116:119]
v_mov_b32 v39, 0
C v59,v24,v25
M v[116:119],a[68:71],a[36:39],v[116:119]
s_waitcnt vmcnt(21) lgkmcnt(0)
E v23,v93
M v[116:119],a[64:67],a[32:35],v[116:119]
s_barrier
M v[120:123],a[96:99],a[0:3],0
R a[64:67],v16,0
R a[68:71],v16,1024
M v[120:123],a[100:103],a[4:7],v[120:123]
AF v26,v25,v26
AF v27,v18,v27
M v[120:123],a[104:107],a[8:11],v[120:123]
E v24,v94
M v[120:123],a[108:111],a[12:15],v[120:123]
R a[72:75],v16,2048
R a[76:79],v16,3072
M v[120:123],a[112:115],a[16:19],v[120:123]
buffer_store_dwordx4 v[232:235], v7, s[8:11], s3 offen offset:1024 sc1
M v[120:123],a[116:119],a[20:23],v[120:123]
E v25,v95
M v[120:123],a[120:123],a[24:27],v[120:123]
R a[80:83],v16,4096
R a[84:87],v16,5120
M v[120:123],a[124:127],a[28:31],v[120:123]
C v60,v18,v19
AF v27,v19,v27
M v[124:127],a[124:127],a[60:63],0
AF v27,v20,v27
C v61,v20,v21
M v[124:127],a[120:123],a[56:59],v[124:127]
R a[88:91],v16,6144
R a[92:95],v16,7168
M v[124:127],a[116:119],a[52:55],v[124:127]
AF v27,v21,v27
AF v27,v22,v27
M v[124:127],a[112:115],a[48:51],v[124:127]
C v62,v22,v23
AF v27,v23,v27
M v[124:127],a[108:111],a[44:47],v[124:127]
AF v27,v24,v27
C v63,v24,v25
M v[124:127],a[104:107],a[40:43],v[124:127]
AF v27,v25,v27
M v[124:127],a[100:103],a[36:39],v[124:127]
s_waitcnt lgkmcnt(0)
M v[124:127],a[96:99],a[32:35],v[124:127]
v_max_f32 v10, v26, v27
v_min_f32 v11, v26, v27
v_cmp_lt_f32 vcc, s31, v10
v_cmp_gt_f32 s[64:65], s24, v11
s_nop 0
s_or_b64 vcc, vcc, s[64:65]
s_cbranch_vccnz L_stk1
L_rtk1:
M v[128:131],a[64:67],v[40:43],0
R a[96:99],v16,8192
R a[100:103],v16,9216
M v[128:131],a[68:71],v[56:59],v[128:131]
SA m0,s28,65536
E v18,v96
M v[132:135],a[68:71],v[60:63],0
buffer_load_dwordx4 v3, s[8:11], s21 offen offset:0 sc1 lds
M v[132:135],a[64:67],v[44:47],v[132:135]
R a[104:107],v16,10240
R a[108:111],v16,11264
M v[136:139],a[72:75],v[40:43],0
SA s3,s93,794624
E v19,v97
M v[136:139],a[76:79],v[56:59],v[136:139]
AF v30,v26,v30
AF v31,v27,v31
M v[140:143],a[76:79],v[60:63],0
R a[112:115],v16,12288
R a[116:119],v16,13312
M v[140:143],a[72:75],v[44:47],v[140:143]
buffer_load_dwordx4 v3, s[8:11], s21 offen offset:1024 sc1 lds
M v[144:147],a[80:83],v[40:43],0
E v20,v98
M v[144:147],a[84:87],v[56:59],v[144:147]
R a[120:123],v16,14336
R a[124:127],v16,15360
M v[148:151],a[84:87],v[60:63],0
buffer_store_dwordx4 v[240:243], v7, s[8:11], s3 offen offset:2048 sc1
M v[148:151],a[80:83],v[44:47],v[148:151]
E v21,v99
M v[152:155],a[88:91],v[40:43],0
AF v28,v18,v19
C v48,v18,v19
M v[152:155],a[92:95],v[56:59],v[152:155]
buffer_load_dwordx4 v3, s[8:11], s21 offen offset:2048 sc1 lds
M v[156:159],a[92:95],v[60:63],0
AF v28,v20,v28
C v49,v20,v21
M v[156:159],a[88:91],v[44:47],v[156:159]
s_waitcnt lgkmcnt(0)
E v22,v104
M v[160:163],a[96:99],v[40:43],0
R a[64:67],v16,16384
R a[68:71],v16,17408
M v[160:163],a[100:103],v[56:59],v[160:163]
buffer_load_dwordx4 v3, s[8:11], s21 offen offset:3072 sc1 lds
M v[164:167],a[100:103],v[60:63],0
SA m0,s28,69632
E v23,v105
M v[164:167],a[96:99],v[44:47],v[164:167]
R a[72:75],v16,18432
R a[76:79],v16,19456
M v[168:171],a[104:107],v[40:43],0
buffer_load_dwordx4 v4, s[8:11], s21 offen offset:0 sc1 lds
M v[168:171],a[108:111],v[56:59],v[168:171]
AF v28,v21,v28
AF v28,v22,v28
M v[172:175],a[108:111],v[60:63],0
R a[80:83],v16,20480
R a[84:87],v16,21504
M v[172:175],a[104:107],v[44:47],v[172:175]
buffer_store_dwordx4 v[248:251], v7, s[8:11], s3 offen offset:3072 sc1
M v[176:179],a[112:115],v[40:43],0
E v24,v106
M v[176:179],a[116:119],v[56:59],v[176:179]
R a[88:91],v16,22528
R a[92:95],v16,23552
M v[180:183],a[116:119],v[60:63],0
buffer_load_dwordx4 v4, s[8:11], s21 offen offset:1024 sc1 lds
M v[180:183],a[112:115],v[44:47],v[180:183]
E v25,v107
M v[184:187],a[120:123],v[40:43],0
C v50,v22,v23
AF v28,v23,v28
M v[184:187],a[124:127],v[56:59],v[184:187]
buffer_load_dwordx4 v4, s[8:11], s21 offen offset:2048 sc1 lds
M v[188:191],a[124:127],v[60:63],0
E v18,v100
M v[188:191],a[120:123],v[44:47],v[188:191]
s_waitcnt lgkmcnt(0)
AF v28,v24,v28
C v51,v24,v25
M v[192:195],a[64:67],v[40:43],0
R a[96:99],v16,24576
R a[100:103],v16,25600
M v[192:195],a[68:71],v[56:59],v[192:195]
buffer_load_dwordx4 v4, s[8:11], s21 offen offset:3072 sc1 lds
M v[196:199],a[68:71],v[60:63],0
SA s21,s21,32768
E v19,v101
M v[196:199],a[64:67],v[44:47],v[196:199]
s_sub_u32 s22, s22, 1
R a[104:107],v16,26624
R a[108:111],v16,27648
M v[200:203],a[72:75],v[40:43],0
s_cselect_b32 s21, s23, s21
AF v28,v25,v28
AF v29,v18,v19
M v[200:203],a[76:79],v[56:59],v[200:203]
E v20,v102
M v[204:207],a[76:79],v[60:63],0
R a[112:115],v16,28672
R a[116:119],v16,29696
M v[204:207],a[72:75],v[44:47],v[204:207]
C v52,v18,v19
M v[208:211],a[80:83],v[40:43],0
M v[208:211],a[84:87],v[56:59],v[208:211]
R a[120:123],v16,30720
R a[124:127],v16,31744
M v[212:215],a[84:87],v[60:63],0
E v21,v103
M v[212:215],a[80:83],v[44:47],v[212:215]
AF v29,v20,v29
C v53,v20,v21
M v[216:219],a[88:91],v[40:43],0
AF v29,v21,v29
M v[216:219],a[92:95],v[56:59],v[216:219]
E v22,v108
M v[220:223],a[92:95],v[60:63],0
s_waitcnt vmcnt(13) lgkmcnt(0)
M v[220:223],a[88:91],v[44:47],v[220:223]
s_barrier
M v[224:227],a[96:99],v[40:43],0
R a[64:67],v2,32768
R a[68:71],v2,33792
M v[224:227],a[100:103],v[56:59],v[224:227]
E v23,v109
M v[228:231],a[100:103],v[60:63],0
AF v29,v22,v29
C v54,v22,v23
M v[228:231],a[96:99],v[44:47],v[228:231]
R a[72:75],v2,34816
R a[76:79],v2,35840
M v[232:235],a[104:107],v[40:43],0
E v24,v110
M v[232:235],a[108:111],v[56:59],v[232:235]
AF v29,v23,v29
M v[236:239],a[108:111],v[60:63],0
R a[80:83],v2,36864
R a[84:87],v2,37888
M v[236:239],a[104:107],v[44:47],v[236:239]
M v[240:243],a[112:115],v[40:43],0
E v25,v111
M v[240:243],a[116:119],v[56:59],v[240:243]
R a[88:91],v2,38912
R a[92:95],v2,39936
M v[244:247],a[116:119],v[60:63],0
AF v29,v24,v29
C v55,v24,v25
M v[244:247],a[112:115],v[44:47],v[244:247]
AF v29,v25,v29
M v[248:251],a[120:123],v[40:43],0
M v[248:251],a[124:127],v[56:59],v[248:251]
M v[252:255],a[124:127],v[60:63],0
s_waitcnt lgkmcnt(0)
M v[252:255],a[120:123],v[44:47],v[252:255]
s_cmp_lg_u32 s27, 0
s_cbranch_scc1 L_loop_top
s_branch L_d1s
L_j0:
M v[68:71],a[64:67],a[32:35],0
s_cmp_lt_u32 s20, 0
R a[96:99],v2,40960
R a[100:103],v2,41984
M v[68:71],a[68:71],a[36:39],v[68:71]
s_cselect_b64 s[82:83], -1, 0
v_mov_b32 v30, 0
MF v172,s5,v172
M v[68:71],a[72:75],a[40:43],v[68:71]
s_cmp_eq_u32 s20, 0
MF v173,s5,v173
MF v174,s5,v174
M v[68:71],a[76:79],a[44:47],v[68:71]
s_cselect_b64 s[66:67], s[16:17], s[82:83]
R a[104:107],v2,43008
R a[108:111],v2,44032
M v[68:71],a[80:83],a[48:51],v[68:71]
s_cselect_b64 s[68:69], s[18:19], s[82:83]
MF v175,s5,v175
MF v188,s5,v188
M v[68:71],a[84:87],a[52:55],v[68:71]
s_cselect_b64 s[70:71], s[48:49], s[82:83]
MF v189,s5,v189
MF v190,s5,v190
MF v191,s5,v191
C v172,v172,v173
C v173,v174,v175
C v174,v188,v189
C v175,v190,v191
W a60,v172
W a61,v173
W a62,v174
W a63,v175
M v[68:71],a[88:91],a[56:59],v[68:71]
s_cselect_b64 s[72:73], s[50:51], s[82:83]
R a[112:115],v2,45056
R a[116:119],v2,46080
v_cndmask_b32 v64, 0, v8, s[66:67]
v_cndmask_b32 v65, 0, v8, s[68:69]
v_cndmask_b32 v66, 0, v8, s[70:71]
v_cndmask_b32 v67, 0, v8, s[72:73]
M v[68:71],a[92:95],a[60:63],v[68:71]
s_cmp_lt_u32 s20, 1
MF v164,s5,v164
MF v165,s5,v165
M v[64:67],a[64:67],a[0:3],v[64:67]
s_cselect_b64 s[82:83], -1, 0
MF v166,s5,v166
MF v167,s5,v167
M v[64:67],a[68:71],a[4:7],v[64:67]
s_cmp_eq_u32 s20, 1
R a[120:123],v2,47104
R a[124:127],v2,48128
M v[64:67],a[72:75],a[8:11],v[64:67]
s_cselect_b64 s[74:75], s[16:17], s[82:83]
MF v180,s5,v180
MF v181,s5,v181
M v[64:67],a[76:79],a[12:15],v[64:67]
s_cselect_b64 s[76:77], s[18:19], s[82:83]
MF v182,s5,v182
MF v183,s5,v183
M v[64:67],a[80:83],a[16:19],v[64:67]
s_cselect_b64 s[78:79], s[48:49], s[82:83]
C v164,v164,v165
C v165,v166,v167
C v166,v180,v181
C v167,v182,v183
W a28,v164
W a29,v165
W a30,v166
W a31,v167
M v[64:67],a[84:87],a[20:23],v[64:67]
s_cselect_b64 s[80:81], s[50:51], s[82:83]
v_mov_b32 v31, 0
v_cndmask_b32 v72, 0, v8, s[74:75]
M v[64:67],a[88:91],a[24:27],v[64:67]
s_mov_b32 s26, s43
v_mov_b32 v32, 0
M v[64:67],a[92:95],a[28:31],v[64:67]
s_waitcnt lgkmcnt(0)
v_cndmask_b32 v73, 0, v8, s[76:77]
M v[76:79],a[96:99],a[32:35],0
SA m0,s28,0
R a[64:67],v2,49152
R a[68:71],v2,50176
M v[76:79],a[100:103],a[36:39],v[76:79]
SA s3,s93,786432
buffer_load_dwordx4 v3, s[8:11], s26 offen offset:0 sc1 lds
M v[76:79],a[104:107],a[40:43],v[76:79]
v_cndmask_b32 v74, 0, v8, s[78:79]
v_mov_b32 v33, 0
M v[76:79],a[108:111],a[44:47],v[76:79]
R a[72:75],v2,51200
R a[76:79],v2,52224
M v[76:79],a[112:115],a[48:51],v[76:79]
buffer_store_dwordx4 v[192:195], v7, s[8:11], s3 offen offset:0 sc1
M v[76:79],a[116:119],a[52:55],v[76:79]
v_cndmask_b32 v75, 0, v8, s[80:81]
M v[76:79],a[120:123],a[56:59],v[76:79]
s_cmp_lt_u32 s20, 2
R a[80:83],v2,53248
R a[84:87],v2,54272
M v[76:79],a[124:127],a[60:63],v[76:79]
s_cselect_b64 s[82:83], -1, 0
buffer_load_dwordx4 v3, s[8:11], s26 offen offset:1024 sc1 lds
M v[72:75],a[124:127],a[28:31],v[72:75]
s_cmp_eq_u32 s20, 2
E v18,v68
M v[72:75],a[120:123],a[24:27],v[72:75]
s_cselect_b64 s[66:67], s[16:17], s[82:83]
R a[88:91],v2,55296
R a[92:95],v2,56320
M v[72:75],a[116:119],a[20:23],v[72:75]
s_cselect_b64 s[68:69], s[18:19], s[82:83]
buffer_load_dwordx4 v3, s[8:11], s26 offen offset:2048 sc1 lds
M v[72:75],a[112:115],a[16:19],v[72:75]
s_cselect_b64 s[70:71], s[48:49], s[82:83]
v_mov_b32 v34, 0
M v[72:75],a[108:111],a[12:15],v[72:75]
s_cselect_b64 s[72:73], s[50:51], s[82:83]
v_cndmask_b32 v80, 0, v8, s[66:67]
v_cndmask_b32 v81, 0, v8, s[68:69]
M v[72:75],a[104:107],a[8:11],v[72:75]
buffer_store_dwordx4 v[200:203], v7, s[8:11], s3 offen offset:1024 sc1
M v[72:75],a[100:103],a[4:7],v[72:75]
E v19,v69
M v[72:75],a[96:99],a[0:3],v[72:75]
s_waitcnt lgkmcnt(0)
buffer_load_dwordx4 v3, s[8:11], s26 offen offset:3072 sc1 lds
M v[84:87],a[64:67],a[32:35],0
SA m0,s28,4096
R a[96:99],v2,57344
R a[100:103],v2,58368
M v[84:87],a[68:71],a[36:39],v[84:87]
v_cndmask_b32 v82, 0, v8, s[70:71]
v_mov_b32 v35, 0
M v[84:87],a[72:75],a[40:43],v[84:87]
buffer_load_dwordx4 v4, s[8:11], s26 offen offset:0 sc1 lds
M v[84:87],a[76:79],a[44:47],v[84:87]
R a[104:107],v2,59392
R a[108:111],v2,60416
M v[84:87],a[80:83],a[48:51],v[84:87]
buffer_store_dwordx4 v[208:211], v7, s[8:11], s3 offen offset:2048 sc1
M v[84:87],a[84:87],a[52:55],v[84:87]
v_cndmask_b32 v83, 0, v8, s[72:73]
v_mov_b32 v36, 0
M v[84:87],a[88:91],a[56:59],v[84:87]
s_cmp_lt_u32 s20, 3
R a[112:115],v2,61440
R a[116:119],v2,62464
M v[84:87],a[92:95],a[60:63],v[84:87]
s_cselect_b64 s[82:83], -1, 0
buffer_load_dwordx4 v4, s[8:11], s26 offen offset:1024 sc1 lds
M v[80:83],a[92:95],a[28:31],v[80:83]
s_cmp_eq_u32 s20, 3
E v20,v70
M v[80:83],a[88:91],a[24:27],v[80:83]
s_cselect_b64 s[74:75], s[16:17], s[82:83]
R a[120:123],v2,63488
R a[124:127],v2,64512
M v[80:83],a[84:87],a[20:23],v[80:83]
s_cselect_b64 s[76:77], s[18:19], s[82:83]
buffer_load_dwordx4 v4, s[8:11], s26 offen offset:2048 sc1 lds
M v[80:83],a[80:83],a[16:19],v[80:83]
s_cselect_b64 s[78:79], s[48:49], s[82:83]
E v21,v71
M v[80:83],a[76:79],a[12:15],v[80:83]
s_cselect_b64 s[80:81], s[50:51], s[82:83]
buffer_store_dwordx4 v[216:219], v7, s[8:11], s3 offen offset:3072 sc1
M v[80:83],a[72:75],a[8:11],v[80:83]
SA s3,s93,794624
v_cndmask_b32 v88, 0, v8, s[74:75]
v_cndmask_b32 v89, 0, v8, s[76:77]
M v[80:83],a[68:71],a[4:7],v[80:83]
s_waitcnt vmcnt(24) lgkmcnt(0)
buffer_load_dwordx4 v4, s[8:11], s26 offen offset:3072 sc1 lds
M v[80:83],a[64:67],a[0:3],v[80:83]
s_barrier
M v[92:95],a[96:99],a[32:35],0
R a[64:67],v2,0
R a[68:71],v2,1024
M v[92:95],a[100:103],a[36:39],v[92:95]
buffer_store_dwordx4 v[224:227], v7, s[8:11], s3 offen offset:0 sc1
M v[92:95],a[104:107],a[40:43],v[92:95]
v_min_u32 v17, 896, v9
v_cndmask_b32 v90, 0, v8, s[78:79]
M v[92:95],a[108:111],a[44:47],v[92:95]
R a[72:75],v2,2048
R a[76:79],v2,3072
M v[92:95],a[112:115],a[48:51],v[92:95]
buffer_load_dword v5, v17, s[8:11], s46 offen sc1
M v[92:95],a[116:119],a[52:55],v[92:95]
buffer_store_dwordx4 v[232:235], v7, s[8:11], s3 offen offset:1024 sc1
M v[92:95],a[120:123],a[56:59],v[92:95]
R a[80:83],v2,4096
R a[84:87],v2,5120
v_cndmask_b32 v91, 0, v8, s[80:81]
M v[92:95],a[124:127],a[60:63],v[92:95]
v_mov_b32 v37, 0
v_mov_b32 v38, 0
M v[88:91],a[124:127],a[28:31],v[88:91]
buffer_store_dwordx4 v[240:243], v7, s[8:11], s3 offen offset:2048 sc1
M v[88:91],a[120:123],a[24:27],v[88:91]
R a[88:91],v2,6144
R a[92:95],v2,7168
M v[88:91],a[116:119],a[20:23],v[88:91]
v_mov_b32 v39, 0
AF v27,v18,v19
M v[88:91],a[112:115],a[16:19],v[88:91]
buffer_store_dwordx4 v[248:251], v7, s[8:11], s3 offen offset:3072 sc1
M v[88:91],a[108:111],a[12:15],v[88:91]
E v22,v64
M v[88:91],a[104:107],a[8:11],v[88:91]
E v23,v65
M v[88:91],a[100:103],a[4:7],v[88:91]
s_waitcnt lgkmcnt(0)
E v24,v66
M v[88:91],a[96:99],a[0:3],v[88:91]
E v25,v67
C v44,v18,v19
AF v27,v20,v27
C v45,v20,v21
AF v27,v21,v27
AF v26,v22,v23
C v40,v22,v23
E v18,v76
E v19,v77
AF v26,v24,v26
C v41,v24,v25
AF v26,v25,v26
E v20,v78
E v21,v79
AF v27,v18,v27
C v46,v18,v19
AF v27,v19,v27
E v22,v72
E v23,v73
AF v27,v20,v27
C v47,v20,v21
AF v27,v21,v27
E v24,v74
E v25,v75
AF v26,v22,v26
C v42,v22,v23
AF v26,v23,v26
AF v26,v24,v26
C v43,v24,v25
AF v26,v25,v26
v_mov_b32 v56, 0
v_mov_b32 v57, 0
v_mov_b32 v58, 0
v_mov_b32 v59, 0
s_mul_i32 s21, s41, 1048576
SA s21,s21,589824
s_lshl_b32 s84, s42, 1
s_sub_u32 s22, 11, s84
s_mov_b32 s23, 536870912
s_lshl_b32 s86, s20, 14
SA s86,s86,s34
SA s87,s86,4096
SA s88,s86,8192
SA s89,s86,12288
s_lshl_b32 s90, s20, 10
SA s90,s90,s34
SA s90,s90,65536
s_waitcnt vmcnt(3)
v_cmp_gt_u32 vcc, 2, v5
s_nop 0
s_cbranch_vccnz L_lsj0
L_lrj0:
SA m0,s28,98304
v_mov_b32 v10, v26
buffer_load_dwordx4 v3, s[8:11], s21 offen offset:0 sc1 lds
v_mov_b32 v11, v27
buffer_load_dwordx4 v3, s[8:11], s21 offen offset:1024 sc1 lds
v_mov_b32 v12, v10
v_mov_b32 v13, v11
buffer_load_dwordx4 v3, s[8:11], s21 offen offset:2048 sc1 lds
v_permlane16_swap_b32 v12, v10
v_permlane16_swap_b32 v13, v11
buffer_load_dwordx4 v3, s[8:11], s21 offen offset:3072 sc1 lds
v_max_f32 v10, v12, v10
SA m0,s28,102400
v_max_f32 v11, v13, v11
buffer_load_dwordx4 v4, s[8:11], s21 offen offset:0 sc1 lds
v_mov_b32 v12, v10
v_mov_b32 v13, v11
buffer_load_dwordx4 v4, s[8:11], s21 offen offset:1024 sc1 lds
v_permlane32_swap_b32 v12, v10
v_permlane32_swap_b32 v13, v11
buffer_load_dwordx4 v4, s[8:11], s21 offen offset:2048 sc1 lds
v_max_f32 v10, v12, v10
v_max_f32 v11, v13, v11
buffer_load_dwordx4 v4, s[8:11], s21 offen offset:3072 sc1 lds
SA s21,s21,32768
s_sub_u32 s22, s22, 1
s_cselect_b32 s21, s23, s21
v_min_f32 v10, v10, v11
v_cmp_gt_f32 vcc, s24, v10
s_nop 0
s_cbranch_vccnz L_stj0
L_rtj0:
s_cmp_gt_u32 s20, 3
s_cselect_b64 s[82:83], -1, 0
s_cmp_eq_u32 s20, 3
s_cselect_b64 s[66:67], s[16:17], s[82:83]
v_mfma_f32_32x32x16_bf16 v[128:143], v[56:59], v[56:59], 0
s_cselect_b64 s[68:69], s[18:19], s[82:83]
s_cselect_b64 s[70:71], s[48:49], s[82:83]
s_cselect_b64 s[72:73], s[50:51], s[82:83]
v_cndmask_b32 v100, v36, v8, s[66:67]
v_mfma_f32_32x32x16_bf16 v[144:159], v[56:59], v[56:59], 0
v_cndmask_b32 v101, v36, v8, s[68:69]
v_cndmask_b32 v102, v36, v8, s[70:71]
v_cndmask_b32 v103, v36, v8, s[72:73]
s_cmp_gt_u32 s20, 2
v_mfma_f32_32x32x16_bf16 v[160:175], v[56:59], v[56:59], 0
s_cselect_b64 s[82:83], -1, 0
s_cmp_eq_u32 s20, 2
s_cselect_b64 s[74:75], s[16:17], s[82:83]
s_cselect_b64 s[76:77], s[18:19], s[82:83]
v_mfma_f32_32x32x16_bf16 v[176:191], v[56:59], v[56:59], 0
s_cselect_b64 s[78:79], s[48:49], s[82:83]
s_cselect_b64 s[80:81], s[50:51], s[82:83]
v_cndmask_b32 v108, v36, v8, s[74:75]
v_cndmask_b32 v109, v36, v8, s[76:77]
v_mfma_f32_32x32x16_bf16 v[192:207], v[56:59], v[56:59], 0
v_cndmask_b32 v110, v36, v8, s[78:79]
v_cndmask_b32 v111, v36, v8, s[80:81]
s_cmp_gt_u32 s20, 1
s_cselect_b64 s[82:83], -1, 0
v_mfma_f32_32x32x16_bf16 v[208:223], v[56:59], v[56:59], 0
s_cmp_eq_u32 s20, 1
s_cselect_b64 s[66:67], s[16:17], s[82:83]
s_cselect_b64 s[68:69], s[18:19], s[82:83]
s_cselect_b64 s[70:71], s[48:49], s[82:83]
v_mfma_f32_32x32x16_bf16 v[224:239], v[56:59], v[56:59], 0
s_cselect_b64 s[72:73], s[50:51], s[82:83]
v_cndmask_b32 v116, v36, v8, s[66:67]
v_cndmask_b32 v117, v36, v8, s[68:69]
v_cndmask_b32 v118, v36, v8, s[70:71]
v_mfma_f32_32x32x16_bf16 v[240:255], v[56:59], v[56:59], 0
v_cndmask_b32 v119, v36, v8, s[72:73]
s_cmp_gt_u32 s20, 0
s_cselect_b64 s[82:83], -1, 0
s_cmp_eq_u32 s20, 0
s_cselect_b64 s[74:75], s[16:17], s[82:83]
s_cselect_b64 s[76:77], s[18:19], s[82:83]
s_cselect_b64 s[78:79], s[48:49], s[82:83]
s_cselect_b64 s[80:81], s[50:51], s[82:83]
v_cndmask_b32 v124, v36, v8, s[74:75]
v_cndmask_b32 v125, v36, v8, s[76:77]
v_cndmask_b32 v126, v36, v8, s[78:79]
v_cndmask_b32 v127, v36, v8, s[80:81]
s_branch L_d3h
.p2align 12
L_kv1:
s_and_b32 s31, s42, 7
s_lshl_b32 s30, s41, 3
SA s30,s30,s31
s_lshl_b32 s64, s30, 2
SA s64,s64,s20
s_mul_i32 s72, s64, 3584
v_mov_b32 v32, 536870912
v_cmp_gt_u32 vcc, 56, v0
s_lshl_b32 s67, s64, 2
s_nop 0
v_cndmask_b32 v32, v32, v7, vcc
buffer_load_dwordx4 a[176:179], v32, s[56:59], s72 offen offset:0
buffer_load_dwordx4 a[180:183], v32, s[56:59], s72 offen offset:896
buffer_load_dwordx4 a[184:187], v32, s[56:59], s72 offen offset:1792
buffer_load_dwordx4 a[188:191], v32, s[56:59], s72 offen offset:2688
buffer_load_dwordx4 a[192:195], v32, s[60:63], 0 offen
buffer_load_dwordx4 a[196:199], v32, s[68:71], 0 offen
SA m0,s24,16384
s_nop 0
buffer_load_dwordx4 v12, s[48:51], s22 offen offset:0   lds
buffer_load_dwordx4 v13, s[48:51], s22 offen offset:1024   lds
buffer_load_dwordx4 v14, s[48:51], s22 offen offset:2048   lds
buffer_load_dwordx4 v15, s[48:51], s22 offen offset:3072   lds
s_sub_u32 s22, s22, 1048448
SA m0,s23,32768
s_nop 0
buffer_load_dwordx4 v8, s[16:19], s21 offen offset:0  nt lds
buffer_load_dwordx4 v9, s[16:19], s21 offen offset:1024  nt lds
buffer_load_dwordx4 v10, s[16:19], s21 offen offset:2048  nt lds
buffer_load_dwordx4 v11, s[16:19], s21 offen offset:3072  nt lds
SA s21,s21,128
s_mov_b64 exec, 0
s_cmp_eq_u32 s20, 0
s_cbranch_scc1 L_w_kv11
s_cmp_eq_u32 s20, 1
s_cbranch_scc1 L_w_kv12
s_cmp_eq_u32 s20, 2
s_cbranch_scc1 L_w_kv13
s_branch L_w_kv14
L_wd2:
s_mov_b64 exec, -1
s_waitcnt vmcnt(14) lgkmcnt(0)
s_barrier
R a[160:163],v5,0
R a[164:167],v6,0
T a[96:97],v1,0
T a[98:99],v1,1024
T a[100:101],v1,8192
T a[102:103],v1,9216
T a[104:105],v2,0
T a[106:107],v2,1024
T a[108:109],v2,8192
T a[110:111],v2,9216
T a[112:113],v3,0
T a[114:115],v3,1024
T a[116:117],v3,8192
T a[118:119],v3,9216
T a[120:121],v4,0
T a[122:123],v4,1024
T a[124:125],v4,8192
T a[126:127],v4,9216
T a[128:129],v1,16384
T a[130:131],v1,17408
T a[132:133],v1,24576
T a[134:135],v1,25600
T a[136:137],v2,16384
T a[138:139],v2,17408
T a[140:141],v2,24576
T a[142:143],v2,25600
T a[144:145],v3,16384
T a[146:147],v3,17408
T a[148:149],v3,24576
T a[150:151],v3,25600
T a[152:153],v4,16384
T a[154:155],v4,17408
T a[156:157],v4,24576
T a[158:159],v4,25600
s_waitcnt lgkmcnt(15)
M a[0:3],a[160:163],a[96:99],0
SA m0,s23,49152
R a[168:171],v5,2048
R a[172:175],v6,2048
M a[0:3],a[164:167],a[100:103],a[0:3]
buffer_load_dwordx4 v8, s[16:19], s21 offen offset:0  nt lds
M a[4:7],a[164:167],a[108:111],0
M a[4:7],a[160:163],a[104:107],a[4:7]
M a[8:11],a[160:163],a[112:115],0
buffer_load_dwordx4 v9, s[16:19], s21 offen offset:1024  nt lds
M a[8:11],a[164:167],a[116:119],a[8:11]
s_waitcnt lgkmcnt(14)
M a[12:15],a[164:167],a[124:127],0
M a[12:15],a[160:163],a[120:123],a[12:15]
M a[16:19],a[160:163],a[128:131],0
buffer_load_dwordx4 v10, s[16:19], s21 offen offset:2048  nt lds
M a[16:19],a[164:167],a[132:135],a[16:19]
s_waitcnt lgkmcnt(6)
M a[20:23],a[164:167],a[140:143],0
M a[20:23],a[160:163],a[136:139],a[20:23]
buffer_load_dwordx4 v11, s[16:19], s21 offen offset:3072  nt lds
M a[24:27],a[160:163],a[144:147],0
SA s21,s21,524160
M a[24:27],a[164:167],a[148:151],a[24:27]
s_waitcnt lgkmcnt(0)
M a[28:31],a[164:167],a[156:159],0
SA m0,s24,32768
M a[28:31],a[160:163],a[152:155],a[28:31]
buffer_load_dwordx4 v12, s[48:51], s22 offen offset:0   lds
M v[32:35],a[168:171],a[96:99],0
R a[160:163],v5,4096
R a[164:167],v6,4096
M v[32:35],a[172:175],a[100:103],v[32:35]
M v[36:39],a[172:175],a[108:111],0
M v[36:39],a[168:171],a[104:107],v[36:39]
buffer_load_dwordx4 v13, s[48:51], s22 offen offset:1024   lds
M v[40:43],a[168:171],a[112:115],0
M v[40:43],a[172:175],a[116:119],v[40:43]
M v[44:47],a[172:175],a[124:127],0
buffer_load_dwordx4 v14, s[48:51], s22 offen offset:2048   lds
M v[44:47],a[168:171],a[120:123],v[44:47]
M v[48:51],a[168:171],a[128:131],0
M v[48:51],a[172:175],a[132:135],v[48:51]
M v[52:55],a[172:175],a[140:143],0
buffer_load_dwordx4 v15, s[48:51], s22 offen offset:3072   lds
M v[52:55],a[168:171],a[136:139],v[52:55]
SA s22,s22,1048576
M v[56:59],a[168:171],a[144:147],0
M v[56:59],a[172:175],a[148:151],v[56:59]
s_waitcnt lgkmcnt(0)
M v[60:63],a[172:175],a[156:159],0
M v[60:63],a[168:171],a[152:155],v[60:63]
M v[64:67],a[160:163],a[96:99],0
R a[168:171],v5,6144
R a[172:175],v6,6144
M v[64:67],a[164:167],a[100:103],v[64:67]
M v[68:71],a[164:167],a[108:111],0
M v[68:71],a[160:163],a[104:107],v[68:71]
M v[72:75],a[160:163],a[112:115],0
M v[72:75],a[164:167],a[116:119],v[72:75]
M v[76:79],a[164:167],a[124:127],0
M v[76:79],a[160:163],a[120:123],v[76:79]
M v[80:83],a[160:163],a[128:131],0
M v[80:83],a[164:167],a[132:135],v[80:83]
M v[84:87],a[164:167],a[140:143],0
M v[84:87],a[160:163],a[136:139],v[84:87]
M v[88:91],a[160:163],a[144:147],0
M v[88:91],a[164:167],a[148:151],v[88:91]
s_waitcnt lgkmcnt(0)
M v[92:95],a[164:167],a[156:159],0
s_waitcnt vmcnt(12)
M v[92:95],a[160:163],a[152:155],v[92:95]
s_barrier
M v[96:99],a[168:171],a[96:99],0
SA m0,s23,0
R a[160:163],v5,16384
R a[164:167],v6,16384
M v[96:99],a[172:175],a[100:103],v[96:99]
buffer_load_dwordx4 v8, s[16:19], s21 offen offset:0  nt lds
M v[100:103],a[172:175],a[108:111],0
v_lshlrev_b32 v26, 7, v0
v_and_b32 v27, 48, v0
M v[100:103],a[168:171],a[104:107],v[100:103]
v_lshl_add_u32 v26, v27, 24, v26
M v[104:107],a[168:171],a[112:115],0
buffer_load_dwordx4 v9, s[16:19], s21 offen offset:1024  nt lds
M v[104:107],a[172:175],a[116:119],v[104:107]
M v[108:111],a[172:175],a[124:127],0
M v[108:111],a[168:171],a[120:123],v[108:111]
buffer_load_dwordx4 v10, s[16:19], s21 offen offset:2048  nt lds
M v[112:115],a[168:171],a[128:131],0
M v[112:115],a[172:175],a[132:135],v[112:115]
M v[116:119],a[172:175],a[140:143],0
M v[116:119],a[168:171],a[136:139],v[116:119]
buffer_load_dwordx4 v11, s[16:19], s21 offen offset:3072  nt lds
M v[120:123],a[168:171],a[144:147],0
SA s21,s21,128
M v[120:123],a[172:175],a[148:151],v[120:123]
s_waitcnt lgkmcnt(0)
M v[124:127],a[172:175],a[156:159],0
SA m0,s24,49152
M v[124:127],a[168:171],a[152:155],v[124:127]
buffer_load_dwordx4 v12, s[48:51], s22 offen offset:0   lds
M v[128:131],a[160:163],a[96:99],0
R a[168:171],v5,18432
R a[172:175],v6,18432
M v[128:131],a[164:167],a[100:103],v[128:131]
buffer_load_dwordx4 v13, s[48:51], s22 offen offset:1024   lds
M v[132:135],a[164:167],a[108:111],0
M v[132:135],a[160:163],a[104:107],v[132:135]
M v[136:139],a[160:163],a[112:115],0
M v[136:139],a[164:167],a[116:119],v[136:139]
buffer_load_dwordx4 v14, s[48:51], s22 offen offset:2048   lds
M v[140:143],a[164:167],a[124:127],0
M v[140:143],a[160:163],a[120:123],v[140:143]
M v[144:147],a[160:163],a[128:131],0
buffer_load_dwordx4 v15, s[48:51], s22 offen offset:3072   lds
M v[144:147],a[164:167],a[132:135],v[144:147]
s_sub_u32 s22, s22, 1048448
M v[148:151],a[164:167],a[140:143],0
M v[148:151],a[160:163],a[136:139],v[148:151]
M v[152:155],a[160:163],a[144:147],0
M v[152:155],a[164:167],a[148:151],v[152:155]
s_waitcnt lgkmcnt(0)
M v[156:159],a[164:167],a[156:159],0
s_waitcnt vmcnt(12)
M v[156:159],a[160:163],a[152:155],v[156:159]
s_barrier
M v[160:163],a[168:171],a[96:99],0
SA m0,s23,16384
R a[160:163],v5,20480
R a[164:167],v6,20480
M v[160:163],a[172:175],a[100:103],v[160:163]
T a[32:33],v1,32768
T a[34:35],v1,33792
M v[164:167],a[172:175],a[108:111],0
T a[36:37],v1,40960
T a[38:39],v1,41984
M v[164:167],a[168:171],a[104:107],v[164:167]
T a[40:41],v2,32768
T a[42:43],v2,33792
M v[168:171],a[168:171],a[112:115],0
T a[44:45],v2,40960
T a[46:47],v2,41984
M v[168:171],a[172:175],a[116:119],v[168:171]
buffer_load_dwordx4 v8, s[16:19], s21 offen offset:0  nt lds
M v[172:175],a[172:175],a[124:127],0
s_nop 0
T a[48:49],v3,32768
T a[50:51],v3,33792
M v[172:175],a[168:171],a[120:123],v[172:175]
buffer_load_dwordx4 v9, s[16:19], s21 offen offset:1024  nt lds
M v[176:179],a[168:171],a[128:131],0
s_nop 0
T a[52:53],v3,40960
T a[54:55],v3,41984
M v[176:179],a[172:175],a[132:135],v[176:179]
T a[56:57],v4,32768
T a[58:59],v4,33792
M v[180:183],a[172:175],a[140:143],0
buffer_load_dwordx4 v10, s[16:19], s21 offen offset:2048  nt lds
M v[180:183],a[168:171],a[136:139],v[180:183]
s_nop 0
T a[60:61],v4,40960
T a[62:63],v4,41984
M v[184:187],a[168:171],a[144:147],0
buffer_load_dwordx4 v11, s[16:19], s21 offen offset:3072  nt lds
M v[184:187],a[172:175],a[148:151],v[184:187]
s_waitcnt lgkmcnt(15)
s_nop 0
T a[64:65],v1,49152
T a[66:67],v1,50176
M v[188:191],a[172:175],a[156:159],0
SA s21,s21,524160
T a[68:69],v1,57344
T a[70:71],v1,58368
M v[188:191],a[168:171],a[152:155],v[188:191]
SA m0,s24,0
M v[192:195],a[160:163],a[96:99],0
R a[168:171],v5,22528
R a[172:175],v6,22528
M v[192:195],a[164:167],a[100:103],v[192:195]
T a[72:73],v2,49152
T a[74:75],v2,50176
M v[196:199],a[164:167],a[108:111],0
T a[76:77],v2,57344
T a[78:79],v2,58368
M v[196:199],a[160:163],a[104:107],v[196:199]
T a[80:81],v3,49152
T a[82:83],v3,50176
M v[200:203],a[160:163],a[112:115],0
buffer_load_dwordx4 v12, s[48:51], s22 offen offset:0   lds
M v[200:203],a[164:167],a[116:119],v[200:203]
s_nop 0
T a[84:85],v3,57344
T a[86:87],v3,58368
M v[204:207],a[164:167],a[124:127],0
T a[88:89],v4,49152
T a[90:91],v4,50176
M v[204:207],a[160:163],a[120:123],v[204:207]
buffer_load_dwordx4 v13, s[48:51], s22 offen offset:1024   lds
M v[208:211],a[160:163],a[128:131],0
s_nop 0
T a[92:93],v4,57344
T a[94:95],v4,58368
M v[208:211],a[164:167],a[132:135],v[208:211]
buffer_load_dwordx4 v14, s[48:51], s22 offen offset:2048   lds
M v[212:215],a[164:167],a[140:143],0
buffer_load_dwordx4 v15, s[48:51], s22 offen offset:3072   lds
M v[212:215],a[160:163],a[136:139],v[212:215]
SA s22,s22,1048576
M v[216:219],a[160:163],a[144:147],0
M v[216:219],a[164:167],a[148:151],v[216:219]
s_waitcnt lgkmcnt(12)
M v[220:223],a[164:167],a[156:159],0
s_waitcnt vmcnt(12) lgkmcnt(0)
M v[220:223],a[160:163],a[152:155],v[220:223]
s_barrier
M v[224:227],a[168:171],a[96:99],0
SA m0,s23,32768
R a[160:163],v5,32768
R a[164:167],v6,32768
M v[224:227],a[172:175],a[100:103],v[224:227]
buffer_load_dwordx4 v8, s[16:19], s21 offen offset:0  nt lds
M v[228:231],a[172:175],a[108:111],0
M v[228:231],a[168:171],a[104:107],v[228:231]
M v[232:235],a[168:171],a[112:115],0
buffer_load_dwordx4 v9, s[16:19], s21 offen offset:1024  nt lds
M v[232:235],a[172:175],a[116:119],v[232:235]
M v[236:239],a[172:175],a[124:127],0
M v[236:239],a[168:171],a[120:123],v[236:239]
buffer_load_dwordx4 v10, s[16:19], s21 offen offset:2048  nt lds
M v[240:243],a[168:171],a[128:131],0
M v[240:243],a[172:175],a[132:135],v[240:243]
M v[244:247],a[172:175],a[140:143],0
buffer_load_dwordx4 v11, s[16:19], s21 offen offset:3072  nt lds
M v[244:247],a[168:171],a[136:139],v[244:247]
SA s21,s21,128
M v[248:251],a[168:171],a[144:147],0
M v[248:251],a[172:175],a[148:151],v[248:251]
s_waitcnt lgkmcnt(0)
M v[252:255],a[172:175],a[156:159],0
M v[252:255],a[168:171],a[152:155],v[252:255]
M a[0:3],a[160:163],a[32:35],a[0:3]
R a[168:171],v5,34816
R a[172:175],v6,34816
M a[0:3],a[164:167],a[36:39],a[0:3]
T a[96:97],v1,0
T a[98:99],v1,1024
M a[4:7],a[164:167],a[44:47],a[4:7]
SA m0,s24,16384
v_mov_b32 v16, 0
v_mov_b32 v17, 0
M a[4:7],a[160:163],a[40:43],a[4:7]
buffer_load_dwordx4 v12, s[48:51], s22 offen offset:0   lds
M a[8:11],a[160:163],a[48:51],a[8:11]
v_mov_b32 v18, 0
v_mov_b32 v19, 0
M a[8:11],a[164:167],a[52:55],a[8:11]
v_mov_b32 v20, 0
v_mov_b32 v21, 0
M a[12:15],a[164:167],a[60:63],a[12:15]
T a[100:101],v1,8192
T a[102:103],v1,9216
M a[12:15],a[160:163],a[56:59],a[12:15]
v_mov_b32 v22, 0
v_mov_b32 v23, 0
M a[16:19],a[160:163],a[64:67],a[16:19]
buffer_load_dwordx4 v13, s[48:51], s22 offen offset:1024   lds
M a[16:19],a[164:167],a[68:71],a[16:19]
G v28,a192
G v29,a196
M a[20:23],a[164:167],a[76:79],a[20:23]
v_lshlrev_b32 v24, 16, v28
v_lshlrev_b32 v25, 16, v29
M a[20:23],a[160:163],a[72:75],a[20:23]
T a[104:105],v2,0
T a[106:107],v2,1024
M a[24:27],a[160:163],a[80:83],a[24:27]
v_and_b32 v28, 0xffff0000, v28
v_and_b32 v29, 0xffff0000, v29
M a[24:27],a[164:167],a[84:87],a[24:27]
s_waitcnt lgkmcnt(6)
buffer_load_dwordx4 v14, s[48:51], s22 offen offset:2048   lds
M a[28:31],a[164:167],a[92:95],a[28:31]
G v30,a176
v_lshlrev_b32 v31, 16, v30
M a[28:31],a[160:163],a[88:91],a[28:31]
v_and_b32 v30, 0xffff0000, v30
v_fmac_f32 v16, v31, v24
M v[32:35],a[168:171],a[32:35],v[32:35]
R a[160:163],v5,36864
R a[164:167],v6,36864
M v[32:35],a[172:175],a[36:39],v[32:35]
T a[108:109],v2,8192
T a[110:111],v2,9216
M v[36:39],a[172:175],a[44:47],v[36:39]
buffer_load_dwordx4 v15, s[48:51], s22 offen offset:3072   lds
M v[36:39],a[168:171],a[40:43],v[36:39]
s_sub_u32 s22, s22, 1048448
v_fmac_f32 v20, v31, v25
v_fmac_f32 v16, v30, v28
M v[40:43],a[168:171],a[48:51],v[40:43]
v_fmac_f32 v20, v30, v29
G v30,a180
M v[40:43],a[172:175],a[52:55],v[40:43]
T a[112:113],v3,0
T a[114:115],v3,1024
M v[44:47],a[172:175],a[60:63],v[44:47]
SA m0,s23,49152
v_lshlrev_b32 v31, 16, v30
v_and_b32 v30, 0xffff0000, v30
M v[44:47],a[168:171],a[56:59],v[44:47]
buffer_load_dwordx4 v8, s[16:19], s21 offen offset:0  nt lds
M v[48:51],a[168:171],a[64:67],v[48:51]
v_fmac_f32 v17, v31, v24
v_fmac_f32 v21, v31, v25
M v[48:51],a[172:175],a[68:71],v[48:51]
v_fmac_f32 v17, v30, v28
v_fmac_f32 v21, v30, v29
M v[52:55],a[172:175],a[76:79],v[52:55]
T a[116:117],v3,8192
T a[118:119],v3,9216
M v[52:55],a[168:171],a[72:75],v[52:55]
G v30,a184
v_lshlrev_b32 v31, 16, v30
M v[56:59],a[168:171],a[80:83],v[56:59]
buffer_load_dwordx4 v9, s[16:19], s21 offen offset:1024  nt lds
M v[56:59],a[172:175],a[84:87],v[56:59]
s_waitcnt lgkmcnt(6)
v_and_b32 v30, 0xffff0000, v30
v_fmac_f32 v18, v31, v24
M v[60:63],a[172:175],a[92:95],v[60:63]
v_fmac_f32 v22, v31, v25
v_fmac_f32 v18, v30, v28
M v[60:63],a[168:171],a[88:91],v[60:63]
T a[120:121],v4,0
T a[122:123],v4,1024
M v[64:67],a[160:163],a[32:35],v[64:67]
R a[168:171],v5,38912
R a[172:175],v6,38912
M v[64:67],a[164:167],a[36:39],v[64:67]
buffer_load_dwordx4 v10, s[16:19], s21 offen offset:2048  nt lds
M v[68:71],a[164:167],a[44:47],v[68:71]
v_fmac_f32 v22, v30, v29
G v30,a188
M v[68:71],a[160:163],a[40:43],v[68:71]
v_lshlrev_b32 v31, 16, v30
v_and_b32 v30, 0xffff0000, v30
M v[72:75],a[160:163],a[48:51],v[72:75]
T a[124:125],v4,8192
T a[126:127],v4,9216
M v[72:75],a[164:167],a[52:55],v[72:75]
v_fmac_f32 v19, v31, v24
v_fmac_f32 v23, v31, v25
M v[76:79],a[164:167],a[60:63],v[76:79]
buffer_load_dwordx4 v11, s[16:19], s21 offen offset:3072  nt lds
M v[76:79],a[160:163],a[56:59],v[76:79]
SA s21,s21,524160
v_fmac_f32 v19, v30, v28
v_fmac_f32 v23, v30, v29
M v[80:83],a[160:163],a[64:67],v[80:83]
G v28,a193
G v29,a197
M v[80:83],a[164:167],a[68:71],v[80:83]
v_lshlrev_b32 v24, 16, v28
v_lshlrev_b32 v25, 16, v29
M v[84:87],a[164:167],a[76:79],v[84:87]
v_and_b32 v28, 0xffff0000, v28
v_and_b32 v29, 0xffff0000, v29
M v[84:87],a[160:163],a[72:75],v[84:87]
G v30,a177
v_lshlrev_b32 v31, 16, v30
M v[88:91],a[160:163],a[80:83],v[88:91]
v_and_b32 v30, 0xffff0000, v30
v_fmac_f32 v16, v31, v24
M v[88:91],a[164:167],a[84:87],v[88:91]
s_waitcnt lgkmcnt(2)
v_fmac_f32 v20, v31, v25
v_fmac_f32 v16, v30, v28
M v[92:95],a[164:167],a[92:95],v[92:95]
s_waitcnt vmcnt(16) lgkmcnt(0)
v_fmac_f32 v20, v30, v29
G v30,a181
M v[92:95],a[160:163],a[88:91],v[92:95]
s_barrier
M v[96:99],a[168:171],a[32:35],v[96:99]
R a[160:163],v5,49152
R a[164:167],v6,49152
M v[96:99],a[172:175],a[36:39],v[96:99]
v_lshlrev_b32 v31, 16, v30
v_and_b32 v30, 0xffff0000, v30
M v[100:103],a[172:175],a[44:47],v[100:103]
SA m0,s24,32768
T a[128:129],v1,16384
T a[130:131],v1,17408
M v[100:103],a[168:171],a[40:43],v[100:103]
buffer_load_dwordx4 v12, s[48:51], s22 offen offset:0   lds
M v[104:107],a[168:171],a[48:51],v[104:107]
v_fmac_f32 v17, v31, v24
v_fmac_f32 v21, v31, v25
M v[104:107],a[172:175],a[52:55],v[104:107]
v_fmac_f32 v17, v30, v28
v_fmac_f32 v21, v30, v29
M v[108:111],a[172:175],a[60:63],v[108:111]
G v30,a185
v_lshlrev_b32 v31, 16, v30
M v[108:111],a[168:171],a[56:59],v[108:111]
v_and_b32 v30, 0xffff0000, v30
v_fmac_f32 v18, v31, v24
M v[112:115],a[168:171],a[64:67],v[112:115]
v_fmac_f32 v22, v31, v25
v_fmac_f32 v18, v30, v28
M v[112:115],a[172:175],a[68:71],v[112:115]
T a[132:133],v1,24576
T a[134:135],v1,25600
M v[116:119],a[172:175],a[76:79],v[116:119]
buffer_load_dwordx4 v13, s[48:51], s22 offen offset:1024   lds
M v[116:119],a[168:171],a[72:75],v[116:119]
v_fmac_f32 v22, v30, v29
G v30,a189
M v[120:123],a[168:171],a[80:83],v[120:123]
v_lshlrev_b32 v31, 16, v30
v_and_b32 v30, 0xffff0000, v30
M v[120:123],a[172:175],a[84:87],v[120:123]
s_waitcnt lgkmcnt(4)
v_fmac_f32 v19, v31, v24
v_fmac_f32 v23, v31, v25
M v[124:127],a[172:175],a[92:95],v[124:127]
v_fmac_f32 v19, v30, v28
v_fmac_f32 v23, v30, v29
M v[124:127],a[168:171],a[88:91],v[124:127]
G v28,a194
G v29,a198
M v[128:131],a[160:163],a[32:35],v[128:131]
R a[168:171],v5,51200
R a[172:175],v6,51200
M v[128:131],a[164:167],a[36:39],v[128:131]
T a[136:137],v2,16384
T a[138:139],v2,17408
M v[132:135],a[164:167],a[44:47],v[132:135]
buffer_load_dwordx4 v14, s[48:51], s22 offen offset:2048   lds
M v[132:135],a[160:163],a[40:43],v[132:135]
v_lshlrev_b32 v24, 16, v28
v_lshlrev_b32 v25, 16, v29
M v[136:139],a[160:163],a[48:51],v[136:139]
v_and_b32 v28, 0xffff0000, v28
v_and_b32 v29, 0xffff0000, v29
M v[136:139],a[164:167],a[52:55],v[136:139]
G v30,a178
v_lshlrev_b32 v31, 16, v30
M v[140:143],a[164:167],a[60:63],v[140:143]
v_and_b32 v30, 0xffff0000, v30
v_fmac_f32 v16, v31, v24
M v[140:143],a[160:163],a[56:59],v[140:143]
T a[140:141],v2,24576
T a[142:143],v2,25600
M v[144:147],a[160:163],a[64:67],v[144:147]
buffer_load_dwordx4 v15, s[48:51], s22 offen offset:3072   lds
M v[144:147],a[164:167],a[68:71],v[144:147]
SA s22,s22,1048576
v_fmac_f32 v20, v31, v25
v_fmac_f32 v16, v30, v28
M v[148:151],a[164:167],a[76:79],v[148:151]
v_fmac_f32 v20, v30, v29
G v30,a182
M v[148:151],a[160:163],a[72:75],v[148:151]
v_lshlrev_b32 v31, 16, v30
v_and_b32 v30, 0xffff0000, v30
M v[152:155],a[160:163],a[80:83],v[152:155]
v_fmac_f32 v17, v31, v24
v_fmac_f32 v21, v31, v25
M v[152:155],a[164:167],a[84:87],v[152:155]
s_waitcnt lgkmcnt(4)
v_fmac_f32 v17, v30, v28
v_fmac_f32 v21, v30, v29
M v[156:159],a[164:167],a[92:95],v[156:159]
SA m0,s23,0
T a[144:145],v3,16384
T a[146:147],v3,17408
M v[156:159],a[160:163],a[88:91],v[156:159]
buffer_load_dwordx4 v8, s[16:19], s21 offen offset:0  nt lds
M v[160:163],a[168:171],a[32:35],v[160:163]
R a[160:163],v5,53248
R a[164:167],v6,53248
M v[160:163],a[172:175],a[36:39],v[160:163]
G v30,a186
v_lshlrev_b32 v31, 16, v30
M v[164:167],a[172:175],a[44:47],v[164:167]
v_and_b32 v30, 0xffff0000, v30
v_fmac_f32 v18, v31, v24
M v[164:167],a[168:171],a[40:43],v[164:167]
v_fmac_f32 v22, v31, v25
v_fmac_f32 v18, v30, v28
M v[168:171],a[168:171],a[48:51],v[168:171]
v_fmac_f32 v22, v30, v29
G v30,a190
M v[168:171],a[172:175],a[52:55],v[168:171]
L_w_kv11:
s_cbranch_execz L_w_kv15
T a[148:149],v3,24576
T a[150:151],v3,25600
M v[172:175],a[172:175],a[60:63],v[172:175]
buffer_load_dwordx4 v9, s[16:19], s21 offen offset:1024  nt lds
M v[172:175],a[168:171],a[56:59],v[172:175]
v_lshlrev_b32 v31, 16, v30
v_and_b32 v30, 0xffff0000, v30
M v[176:179],a[168:171],a[64:67],v[176:179]
v_fmac_f32 v19, v31, v24
v_fmac_f32 v23, v31, v25
M v[176:179],a[172:175],a[68:71],v[176:179]
v_fmac_f32 v19, v30, v28
v_fmac_f32 v23, v30, v29
M v[180:183],a[172:175],a[76:79],v[180:183]
M v[180:183],a[168:171],a[72:75],v[180:183]
M v[184:187],a[168:171],a[80:83],v[184:187]
s_nop 0
T a[152:153],v4,16384
T a[154:155],v4,17408
M v[184:187],a[172:175],a[84:87],v[184:187]
s_waitcnt lgkmcnt(4)
buffer_load_dwordx4 v10, s[16:19], s21 offen offset:2048  nt lds
M v[188:191],a[172:175],a[92:95],v[188:191]
M v[188:191],a[168:171],a[88:91],v[188:191]
M v[192:195],a[160:163],a[32:35],v[192:195]
R a[168:171],v5,55296
R a[172:175],v6,55296
M v[192:195],a[164:167],a[36:39],v[192:195]
M v[196:199],a[164:167],a[44:47],v[196:199]
M v[196:199],a[160:163],a[40:43],v[196:199]
s_nop 0
T a[156:157],v4,24576
T a[158:159],v4,25600
M v[200:203],a[160:163],a[48:51],v[200:203]
buffer_load_dwordx4 v11, s[16:19], s21 offen offset:3072  nt lds
M v[200:203],a[164:167],a[52:55],v[200:203]
SA s21,s21,128
M v[204:207],a[164:167],a[60:63],v[204:207]
M v[204:207],a[160:163],a[56:59],v[204:207]
M v[208:211],a[160:163],a[64:67],v[208:211]
M v[208:211],a[164:167],a[68:71],v[208:211]
M v[212:215],a[164:167],a[76:79],v[212:215]
M v[212:215],a[160:163],a[72:75],v[212:215]
M v[216:219],a[160:163],a[80:83],v[216:219]
M v[216:219],a[164:167],a[84:87],v[216:219]
s_waitcnt lgkmcnt(2)
M v[220:223],a[164:167],a[92:95],v[220:223]
s_waitcnt vmcnt(16) lgkmcnt(0)
M v[220:223],a[160:163],a[88:91],v[220:223]
s_barrier
M v[224:227],a[168:171],a[32:35],v[224:227]
R a[160:163],v5,0
R a[164:167],v6,0
M v[224:227],a[172:175],a[36:39],v[224:227]
M v[228:231],a[172:175],a[44:47],v[228:231]
M v[228:231],a[168:171],a[40:43],v[228:231]
M v[232:235],a[168:171],a[48:51],v[232:235]
M v[232:235],a[172:175],a[52:55],v[232:235]
M v[236:239],a[172:175],a[60:63],v[236:239]
M v[236:239],a[168:171],a[56:59],v[236:239]
M v[240:243],a[168:171],a[64:67],v[240:243]
M v[240:243],a[172:175],a[68:71],v[240:243]
M v[244:247],a[172:175],a[76:79],v[244:247]
M v[244:247],a[168:171],a[72:75],v[244:247]
M v[248:251],a[168:171],a[80:83],v[248:251]
M v[248:251],a[172:175],a[84:87],v[248:251]
s_waitcnt lgkmcnt(0)
M v[252:255],a[172:175],a[92:95],v[252:255]
M v[252:255],a[168:171],a[88:91],v[252:255]
M a[0:3],a[160:163],a[96:99],a[0:3]
R a[168:171],v5,2048
R a[172:175],v6,2048
M a[0:3],a[164:167],a[100:103],a[0:3]
T a[32:33],v1,32768
T a[34:35],v1,33792
M a[4:7],a[164:167],a[108:111],a[4:7]
SA m0,s24,49152
G v28,a195
G v29,a199
M a[4:7],a[160:163],a[104:107],a[4:7]
buffer_load_dwordx4 v12, s[48:51], s22 offen offset:0   lds
M a[8:11],a[160:163],a[112:115],a[8:11]
v_lshlrev_b32 v24, 16, v28
v_lshlrev_b32 v25, 16, v29
M a[8:11],a[164:167],a[116:119],a[8:11]
v_and_b32 v28, 0xffff0000, v28
v_and_b32 v29, 0xffff0000, v29
M a[12:15],a[164:167],a[124:127],a[12:15]
T a[36:37],v1,40960
T a[38:39],v1,41984
M a[12:15],a[160:163],a[120:123],a[12:15]
G v30,a179
v_lshlrev_b32 v31, 16, v30
M a[16:19],a[160:163],a[128:131],a[16:19]
buffer_load_dwordx4 v13, s[48:51], s22 offen offset:1024   lds
M a[16:19],a[164:167],a[132:135],a[16:19]
v_and_b32 v30, 0xffff0000, v30
v_fmac_f32 v16, v31, v24
M a[20:23],a[164:167],a[140:143],a[20:23]
v_fmac_f32 v20, v31, v25
v_fmac_f32 v16, v30, v28
M a[20:23],a[160:163],a[136:139],a[20:23]
T a[40:41],v2,32768
T a[42:43],v2,33792
M a[24:27],a[160:163],a[144:147],a[24:27]
v_fmac_f32 v20, v30, v29
G v30,a183
M a[24:27],a[164:167],a[148:151],a[24:27]
s_waitcnt lgkmcnt(6)
buffer_load_dwordx4 v14, s[48:51], s22 offen offset:2048   lds
M a[28:31],a[164:167],a[156:159],a[28:31]
v_lshlrev_b32 v31, 16, v30
v_and_b32 v30, 0xffff0000, v30
M a[28:31],a[160:163],a[152:155],a[28:31]
v_fmac_f32 v17, v31, v24
v_fmac_f32 v21, v31, v25
M v[32:35],a[168:171],a[96:99],v[32:35]
R a[160:163],v5,4096
R a[164:167],v6,4096
M v[32:35],a[172:175],a[100:103],v[32:35]
T a[44:45],v2,40960
T a[46:47],v2,41984
M v[36:39],a[172:175],a[108:111],v[36:39]
buffer_load_dwordx4 v15, s[48:51], s22 offen offset:3072   lds
M v[36:39],a[168:171],a[104:107],v[36:39]
s_sub_u32 s22, s22, 1048448
v_fmac_f32 v17, v30, v28
v_fmac_f32 v21, v30, v29
M v[40:43],a[168:171],a[112:115],v[40:43]
G v30,a187
v_lshlrev_b32 v31, 16, v30
M v[40:43],a[172:175],a[116:119],v[40:43]
T a[48:49],v3,32768
T a[50:51],v3,33792
M v[44:47],a[172:175],a[124:127],v[44:47]
SA m0,s23,16384
v_and_b32 v30, 0xffff0000, v30
v_fmac_f32 v18, v31, v24
M v[44:47],a[168:171],a[120:123],v[44:47]
buffer_load_dwordx4 v8, s[16:19], s21 offen offset:0  nt lds
M v[48:51],a[168:171],a[128:131],v[48:51]
v_fmac_f32 v22, v31, v25
v_fmac_f32 v18, v30, v28
M v[48:51],a[172:175],a[132:135],v[48:51]
v_fmac_f32 v22, v30, v29
G v30,a191
M v[52:55],a[172:175],a[140:143],v[52:55]
T a[52:53],v3,40960
T a[54:55],v3,41984
M v[52:55],a[168:171],a[136:139],v[52:55]
v_lshlrev_b32 v31, 16, v30
v_and_b32 v30, 0xffff0000, v30
M v[56:59],a[168:171],a[144:147],v[56:59]
buffer_load_dwordx4 v9, s[16:19], s21 offen offset:1024  nt lds
M v[56:59],a[172:175],a[148:151],v[56:59]
s_waitcnt lgkmcnt(6)
v_fmac_f32 v19, v31, v24
v_fmac_f32 v23, v31, v25
M v[60:63],a[172:175],a[156:159],v[60:63]
v_fmac_f32 v19, v30, v28
v_fmac_f32 v23, v30, v29
M v[60:63],a[168:171],a[152:155],v[60:63]
T a[56:57],v4,32768
T a[58:59],v4,33792
M v[64:67],a[160:163],a[96:99],v[64:67]
R a[168:171],v5,6144
R a[172:175],v6,6144
M v[64:67],a[164:167],a[100:103],v[64:67]
buffer_load_dwordx4 v10, s[16:19], s21 offen offset:2048  nt lds
M v[68:71],a[164:167],a[108:111],v[68:71]
v_permlane32_swap_b32 v16, v18
M v[68:71],a[160:163],a[104:107],v[68:71]
v_permlane32_swap_b32 v17, v19
M v[72:75],a[160:163],a[112:115],v[72:75]
s_nop 0
T a[60:61],v4,40960
T a[62:63],v4,41984
M v[72:75],a[164:167],a[116:119],v[72:75]
v_permlane32_swap_b32 v20, v22
M v[76:79],a[164:167],a[124:127],v[76:79]
buffer_load_dwordx4 v11, s[16:19], s21 offen offset:3072  nt lds
M v[76:79],a[160:163],a[120:123],v[76:79]
SA s21,s21,524160
v_permlane32_swap_b32 v21, v23
M v[80:83],a[160:163],a[128:131],v[80:83]
AF v16,v16,v18
AF v17,v17,v19
M v[80:83],a[164:167],a[132:135],v[80:83]
AF v20,v20,v22
AF v21,v21,v23
M v[84:87],a[164:167],a[140:143],v[84:87]
v_lshrrev_b32 v28, 4, v0
M v[84:87],a[160:163],a[136:139],v[84:87]
v_permlane16_swap_b32 v16, v17
M v[88:91],a[160:163],a[144:147],v[88:91]
v_permlane16_swap_b32 v20, v21
M v[88:91],a[164:167],a[148:151],v[88:91]
s_waitcnt lgkmcnt(2)
AF v16,v16,v17
AF v20,v20,v21
M v[92:95],a[164:167],a[156:159],v[92:95]
s_waitcnt vmcnt(16) lgkmcnt(0)
v_add_u32 v29, s67, v28
v_add_f32 v16, v16, v16 row_ror:8 row_mask:0xf bank_mask:0xf
M v[92:95],a[160:163],a[152:155],v[92:95]
s_barrier
M v[96:99],a[168:171],a[96:99],v[96:99]
R a[160:163],v5,16384
R a[164:167],v6,16384
M v[96:99],a[172:175],a[100:103],v[96:99]
v_add_f32 v20, v20, v20 row_ror:8 row_mask:0xf bank_mask:0xf
v_add_f32 v16, v16, v16 row_ror:4 row_mask:0xf bank_mask:0xf
M v[100:103],a[172:175],a[108:111],v[100:103]
SA m0,s24,0
T a[64:65],v1,49152
T a[66:67],v1,50176
M v[100:103],a[168:171],a[104:107],v[100:103]
buffer_load_dwordx4 v12, s[48:51], s22 offen offset:0   lds
M v[104:107],a[168:171],a[112:115],v[104:107]
v_add_f32 v20, v20, v20 row_ror:4 row_mask:0xf bank_mask:0xf
v_add_f32 v16, v16, v16 row_ror:2 row_mask:0xf bank_mask:0xf
M v[104:107],a[172:175],a[116:119],v[104:107]
v_add_f32 v20, v20, v20 row_ror:2 row_mask:0xf bank_mask:0xf
v_add_f32 v16, v16, v16 row_ror:1 row_mask:0xf bank_mask:0xf
M v[108:111],a[172:175],a[124:127],v[108:111]
v_add_f32 v20, v20, v20 row_ror:1 row_mask:0xf bank_mask:0xf
v_ashrrev_i32 v30, 31, v16
M v[108:111],a[168:171],a[120:123],v[108:111]
v_or_b32 v30, 0x80000000, v30
v_xor_b32 v30, v30, v16
M v[112:115],a[168:171],a[128:131],v[112:115]
v_and_b32 v30, 0xfffff800, v30
v_sub_u32 v29, 2047, v29
M v[112:115],a[172:175],a[132:135],v[112:115]
T a[68:69],v1,57344
T a[70:71],v1,58368
M v[116:119],a[172:175],a[140:143],v[116:119]
buffer_load_dwordx4 v13, s[48:51], s22 offen offset:1024   lds
M v[116:119],a[168:171],a[136:139],v[116:119]
v_or_b32 v30, v30, v29
v_max_u32 v30, 1, v30
M v[120:123],a[168:171],a[144:147],v[120:123]
MF v21,0xbfb8aa3b,v20
M v[120:123],a[172:175],a[148:151],v[120:123]
s_waitcnt lgkmcnt(4)
E v21,v21
M v[124:127],a[172:175],a[156:159],v[124:127]
AF v21,1.0,v21
M v[124:127],a[168:171],a[152:155],v[124:127]
v_rcp_f32 v20, v21
M v[128:131],a[160:163],a[96:99],v[128:131]
s_lshl_b32 s72, s20, 4
R a[168:171],v5,18432
R a[172:175],v6,18432
M v[128:131],a[164:167],a[100:103],v[128:131]
SA s72,s72,163584
T a[72:73],v2,49152
T a[74:75],v2,50176
M v[132:135],a[164:167],a[108:111],v[132:135]
buffer_load_dwordx4 v14, s[48:51], s22 offen offset:2048   lds
M v[132:135],a[160:163],a[104:107],v[132:135]
v_lshl_add_u32 v28, v28, 2, s72
ds_write_b32 v28, v30
M v[136:139],a[160:163],a[112:115],v[136:139]
ds_write_b32 v28, v16 offset:64
ds_write_b32 v28, v20 offset:128
M v[136:139],a[164:167],a[116:119],v[136:139]
M v[140:143],a[164:167],a[124:127],v[140:143]
M v[140:143],a[160:163],a[120:123],v[140:143]
s_nop 0
T a[76:77],v2,57344
T a[78:79],v2,58368
M v[144:147],a[160:163],a[128:131],v[144:147]
buffer_load_dwordx4 v15, s[48:51], s22 offen offset:3072   lds
M v[144:147],a[164:167],a[132:135],v[144:147]
SA s22,s22,1048576
M v[148:151],a[164:167],a[140:143],v[148:151]
M v[148:151],a[160:163],a[136:139],v[148:151]
M v[152:155],a[160:163],a[144:147],v[152:155]
M v[152:155],a[164:167],a[148:151],v[152:155]
s_waitcnt lgkmcnt(7)
M v[156:159],a[164:167],a[156:159],v[156:159]
SA m0,s23,32768
T a[80:81],v3,49152
T a[82:83],v3,50176
M v[156:159],a[160:163],a[152:155],v[156:159]
buffer_load_dwordx4 v8, s[16:19], s21 offen offset:0  nt lds
M v[160:163],a[168:171],a[96:99],v[160:163]
R a[160:163],v5,20480
R a[164:167],v6,20480
M v[160:163],a[172:175],a[100:103],v[160:163]
M v[164:167],a[172:175],a[108:111],v[164:167]
M v[164:167],a[168:171],a[104:107],v[164:167]
M v[168:171],a[168:171],a[112:115],v[168:171]
M v[168:171],a[172:175],a[116:119],v[168:171]
s_nop 0
T a[84:85],v3,57344
T a[86:87],v3,58368
M v[172:175],a[172:175],a[124:127],v[172:175]
buffer_load_dwordx4 v9, s[16:19], s21 offen offset:1024  nt lds
M v[172:175],a[168:171],a[120:123],v[172:175]
M v[176:179],a[168:171],a[128:131],v[176:179]
M v[176:179],a[172:175],a[132:135],v[176:179]
M v[180:183],a[172:175],a[140:143],v[180:183]
M v[180:183],a[168:171],a[136:139],v[180:183]
M v[184:187],a[168:171],a[144:147],v[184:187]
s_nop 0
T a[88:89],v4,49152
T a[90:91],v4,50176
M v[184:187],a[172:175],a[148:151],v[184:187]
s_waitcnt lgkmcnt(4)
buffer_load_dwordx4 v10, s[16:19], s21 offen offset:2048  nt lds
M v[188:191],a[172:175],a[156:159],v[188:191]
M v[188:191],a[168:171],a[152:155],v[188:191]
M v[192:195],a[160:163],a[96:99],v[192:195]
R a[168:171],v5,22528
R a[172:175],v6,22528
M v[192:195],a[164:167],a[100:103],v[192:195]
M v[196:199],a[164:167],a[108:111],v[196:199]
M v[196:199],a[160:163],a[104:107],v[196:199]
s_nop 0
T a[92:93],v4,57344
T a[94:95],v4,58368
M v[200:203],a[160:163],a[112:115],v[200:203]
buffer_load_dwordx4 v11, s[16:19], s21 offen offset:3072  nt lds
M v[200:203],a[164:167],a[116:119],v[200:203]
SA s21,s21,128
M v[204:207],a[164:167],a[124:127],v[204:207]
M v[204:207],a[160:163],a[120:123],v[204:207]
M v[208:211],a[160:163],a[128:131],v[208:211]
M v[208:211],a[164:167],a[132:135],v[208:211]
M v[212:215],a[164:167],a[140:143],v[212:215]
M v[212:215],a[160:163],a[136:139],v[212:215]
M v[216:219],a[160:163],a[144:147],v[216:219]
M v[216:219],a[164:167],a[148:151],v[216:219]
s_waitcnt lgkmcnt(2)
M v[220:223],a[164:167],a[156:159],v[220:223]
s_waitcnt vmcnt(16) lgkmcnt(0)
M v[220:223],a[160:163],a[152:155],v[220:223]
s_barrier
M v[224:227],a[168:171],a[96:99],v[224:227]
R a[160:163],v5,32768
R a[164:167],v6,32768
M v[224:227],a[172:175],a[100:103],v[224:227]
M v[228:231],a[172:175],a[108:111],v[228:231]
M v[228:231],a[168:171],a[104:107],v[228:231]
M v[232:235],a[168:171],a[112:115],v[232:235]
M v[232:235],a[172:175],a[116:119],v[232:235]
M v[236:239],a[172:175],a[124:127],v[236:239]
M v[236:239],a[168:171],a[120:123],v[236:239]
M v[240:243],a[168:171],a[128:131],v[240:243]
M v[240:243],a[172:175],a[132:135],v[240:243]
M v[244:247],a[172:175],a[140:143],v[244:247]
M v[244:247],a[168:171],a[136:139],v[244:247]
M v[248:251],a[168:171],a[144:147],v[248:251]
M v[248:251],a[172:175],a[148:151],v[248:251]
s_waitcnt lgkmcnt(0)
M v[252:255],a[172:175],a[156:159],v[252:255]
M v[252:255],a[168:171],a[152:155],v[252:255]
M a[0:3],a[160:163],a[32:35],a[0:3]
R a[168:171],v5,34816
R a[172:175],v6,34816
M a[0:3],a[164:167],a[36:39],a[0:3]
T a[96:97],v1,0
T a[98:99],v1,1024
M a[4:7],a[164:167],a[44:47],a[4:7]
SA m0,s24,16384
M a[4:7],a[160:163],a[40:43],a[4:7]
buffer_load_dwordx4 v12, s[48:51], s22 offen offset:0   lds
M a[8:11],a[160:163],a[48:51],a[8:11]
v_and_b32 v20, 31, v0
M a[8:11],a[164:167],a[52:55],a[8:11]
v_lshlrev_b32 v20, 2, v20
M a[12:15],a[164:167],a[60:63],a[12:15]
s_nop 0
T a[100:101],v1,8192
T a[102:103],v1,9216
M a[12:15],a[160:163],a[56:59],a[12:15]
v_add_u32 v21, 163584, v20
M a[16:19],a[160:163],a[64:67],a[16:19]
buffer_load_dwordx4 v13, s[48:51], s22 offen offset:1024   lds
M a[16:19],a[164:167],a[68:71],a[16:19]
ds_read_b32 v19, v21
M a[20:23],a[164:167],a[76:79],a[20:23]
ds_read_b32 v21, v21 offset:64
M a[20:23],a[160:163],a[72:75],a[20:23]
s_min_u32 s64, s20, 1
T a[104:105],v2,0
T a[106:107],v2,1024
M a[24:27],a[160:163],a[80:83],a[24:27]
s_lshl_b32 s64, s64, 29
v_and_b32 v22, 32, v0
M a[24:27],a[164:167],a[84:87],a[24:27]
s_waitcnt lgkmcnt(8)
buffer_load_dwordx4 v14, s[48:51], s22 offen offset:2048   lds
M a[28:31],a[164:167],a[92:95],a[28:31]
v_lshl_or_b32 v20, v22, 24, v20
M a[28:31],a[160:163],a[88:91],a[28:31]
v_or_b32 v20, s64, v20
M v[32:35],a[168:171],a[32:35],v[32:35]
R a[160:163],v5,36864
R a[164:167],v6,36864
M v[32:35],a[172:175],a[36:39],v[32:35]
T a[108:109],v2,8192
T a[110:111],v2,9216
M v[36:39],a[172:175],a[44:47],v[36:39]
buffer_load_dwordx4 v15, s[48:51], s22 offen offset:3072   lds
M v[36:39],a[168:171],a[40:43],v[36:39]
s_sub_u32 s22, s22, 1048448
v_and_b32 v22, 16, v0
M v[40:43],a[168:171],a[48:51],v[40:43]
v_lshl_or_b32 v18, v22, 25, v20
s_and_b32 s27, s42, 7
M v[40:43],a[172:175],a[52:55],v[40:43]
s_lshl_b32 s72, s30, 7
T a[112:113],v3,0
T a[114:115],v3,1024
M v[44:47],a[172:175],a[60:63],v[44:47]
SA m0,s23,49152
SA s72,s72,104857600
s_lshl_b32 s64, s41, 3
M v[44:47],a[168:171],a[56:59],v[44:47]
SA s27,s27,s64
buffer_load_dwordx4 v8, s[16:19], s21 offen offset:0  nt lds
M v[48:51],a[168:171],a[64:67],v[48:51]
s_lshl_b32 s27, s27, 2
M v[48:51],a[172:175],a[68:71],v[48:51]
SA s27,s27,s20
M v[52:55],a[172:175],a[76:79],v[52:55]
s_mul_i32 s27, s27, 7168
T a[116:117],v3,8192
T a[118:119],v3,9216
M v[52:55],a[168:171],a[72:75],v[52:55]
s_mov_b32 s60, s90
M v[56:59],a[168:171],a[80:83],v[56:59]
s_and_b32 s61, s91, 0xffff
buffer_load_dwordx4 v9, s[16:19], s21 offen offset:1024  nt lds
M v[56:59],a[172:175],a[84:87],v[56:59]
s_waitcnt lgkmcnt(6)
buffer_store_dword v21, v20, s[8:11], s72 offen sc1
M v[60:63],a[172:175],a[92:95],v[60:63]
s_mov_b32 s62, 3670016
M v[60:63],a[168:171],a[88:91],v[60:63]
s_mov_b32 s63, 0x20000
T a[120:121],v4,0
T a[122:123],v4,1024
M v[64:67],a[160:163],a[32:35],v[64:67]
R a[168:171],v5,38912
R a[172:175],v6,38912
M v[64:67],a[164:167],a[36:39],v[64:67]
buffer_load_dwordx4 v10, s[16:19], s21 offen offset:2048  nt lds
M v[68:71],a[164:167],a[44:47],v[68:71]
M v[68:71],a[160:163],a[40:43],v[68:71]
M v[72:75],a[160:163],a[48:51],v[72:75]
s_nop 0
T a[124:125],v4,8192
T a[126:127],v4,9216
M v[72:75],a[164:167],a[52:55],v[72:75]
M v[76:79],a[164:167],a[60:63],v[76:79]
buffer_load_dwordx4 v11, s[16:19], s21 offen offset:3072  nt lds
M v[76:79],a[160:163],a[56:59],v[76:79]
SA s21,s21,524160
M v[80:83],a[160:163],a[64:67],v[80:83]
M v[80:83],a[164:167],a[68:71],v[80:83]
M v[84:87],a[164:167],a[76:79],v[84:87]
M v[84:87],a[160:163],a[72:75],v[84:87]
M v[88:91],a[160:163],a[80:83],v[88:91]
M v[88:91],a[164:167],a[84:87],v[88:91]
s_waitcnt lgkmcnt(2)
M v[92:95],a[164:167],a[92:95],v[92:95]
s_waitcnt vmcnt(17) lgkmcnt(0)
M v[92:95],a[160:163],a[88:91],v[92:95]
s_barrier
M v[96:99],a[168:171],a[32:35],v[96:99]
R a[160:163],v5,49152
R a[164:167],v6,49152
M v[96:99],a[172:175],a[36:39],v[96:99]
M v[100:103],a[172:175],a[44:47],v[100:103]
SA m0,s24,32768
T a[128:129],v1,16384
T a[130:131],v1,17408
M v[100:103],a[168:171],a[40:43],v[100:103]
buffer_load_dwordx4 v12, s[48:51], s22 offen offset:0   lds
M v[104:107],a[168:171],a[48:51],v[104:107]
v_min_u32 v16, 40, v0
v_lshlrev_b32 v16, 2, v16
M v[104:107],a[172:175],a[52:55],v[104:107]
buffer_load_dword v17, v16, s[12:15], 0 offen sc1
M v[108:111],a[172:175],a[60:63],v[108:111]
M v[108:111],a[168:171],a[56:59],v[108:111]
M v[112:115],a[168:171],a[64:67],v[112:115]
M v[112:115],a[172:175],a[68:71],v[112:115]
s_nop 0
T a[132:133],v1,24576
T a[134:135],v1,25600
M v[116:119],a[172:175],a[76:79],v[116:119]
buffer_load_dwordx4 v13, s[48:51], s22 offen offset:1024   lds
M v[116:119],a[168:171],a[72:75],v[116:119]
M v[120:123],a[168:171],a[80:83],v[120:123]
M v[120:123],a[172:175],a[84:87],v[120:123]
s_waitcnt lgkmcnt(4)
M v[124:127],a[172:175],a[92:95],v[124:127]
M v[124:127],a[168:171],a[88:91],v[124:127]
M v[128:131],a[160:163],a[32:35],v[128:131]
R a[168:171],v5,51200
R a[172:175],v6,51200
M v[128:131],a[164:167],a[36:39],v[128:131]
T a[136:137],v2,16384
T a[138:139],v2,17408
M v[132:135],a[164:167],a[44:47],v[132:135]
buffer_load_dwordx4 v14, s[48:51], s22 offen offset:2048   lds
M v[132:135],a[160:163],a[40:43],v[132:135]
M v[136:139],a[160:163],a[48:51],v[136:139]
M v[136:139],a[164:167],a[52:55],v[136:139]
M v[140:143],a[164:167],a[60:63],v[140:143]
M v[140:143],a[160:163],a[56:59],v[140:143]
s_nop 0
T a[140:141],v2,24576
T a[142:143],v2,25600
M v[144:147],a[160:163],a[64:67],v[144:147]
buffer_load_dwordx4 v15, s[48:51], s22 offen offset:3072   lds
M v[144:147],a[164:167],a[68:71],v[144:147]
SA s22,s22,1048576
M v[148:151],a[164:167],a[76:79],v[148:151]
M v[148:151],a[160:163],a[72:75],v[148:151]
M v[152:155],a[160:163],a[80:83],v[152:155]
M v[152:155],a[164:167],a[84:87],v[152:155]
s_waitcnt lgkmcnt(4)
M v[156:159],a[164:167],a[92:95],v[156:159]
SA m0,s23,0
T a[144:145],v3,16384
T a[146:147],v3,17408
M v[156:159],a[160:163],a[88:91],v[156:159]
buffer_load_dwordx4 v8, s[16:19], s21 offen offset:0  nt lds
M v[160:163],a[168:171],a[32:35],v[160:163]
R a[160:163],v5,53248
R a[164:167],v6,53248
M v[160:163],a[172:175],a[36:39],v[160:163]
buffer_load_dword a240, v26, s[60:63], s27 offen offset:0
M v[164:167],a[172:175],a[44:47],v[164:167]
SA s27,s27,2048
M v[164:167],a[168:171],a[40:43],v[164:167]
M v[168:171],a[168:171],a[48:51],v[168:171]
M v[168:171],a[172:175],a[52:55],v[168:171]
s_nop 0
T a[148:149],v3,24576
T a[150:151],v3,25600
M v[172:175],a[172:175],a[60:63],v[172:175]
buffer_load_dwordx4 v9, s[16:19], s21 offen offset:1024  nt lds
M v[172:175],a[168:171],a[56:59],v[172:175]
M v[176:179],a[168:171],a[64:67],v[176:179]
M v[176:179],a[172:175],a[68:71],v[176:179]
M v[180:183],a[172:175],a[76:79],v[180:183]
M v[180:183],a[168:171],a[72:75],v[180:183]
M v[184:187],a[168:171],a[80:83],v[184:187]
s_nop 0
T a[152:153],v4,16384
T a[154:155],v4,17408
M v[184:187],a[172:175],a[84:87],v[184:187]
s_waitcnt lgkmcnt(4)
buffer_load_dwordx4 v10, s[16:19], s21 offen offset:2048  nt lds
M v[188:191],a[172:175],a[92:95],v[188:191]
M v[188:191],a[168:171],a[88:91],v[188:191]
M v[192:195],a[160:163],a[32:35],v[192:195]
L_w_kv12:
s_cbranch_execz L_w_kv16
R a[168:171],v5,55296
R a[172:175],v6,55296
M v[192:195],a[164:167],a[36:39],v[192:195]
M v[196:199],a[164:167],a[44:47],v[196:199]
M v[196:199],a[160:163],a[40:43],v[196:199]
s_nop 0
T a[156:157],v4,24576
T a[158:159],v4,25600
M v[200:203],a[160:163],a[48:51],v[200:203]
buffer_load_dwordx4 v11, s[16:19], s21 offen offset:3072  nt lds
M v[200:203],a[164:167],a[52:55],v[200:203]
SA s21,s21,128
M v[204:207],a[164:167],a[60:63],v[204:207]
M v[204:207],a[160:163],a[56:59],v[204:207]
M v[208:211],a[160:163],a[64:67],v[208:211]
M v[208:211],a[164:167],a[68:71],v[208:211]
M v[212:215],a[164:167],a[76:79],v[212:215]
M v[212:215],a[160:163],a[72:75],v[212:215]
M v[216:219],a[160:163],a[80:83],v[216:219]
M v[216:219],a[164:167],a[84:87],v[216:219]
s_waitcnt lgkmcnt(2)
M v[220:223],a[164:167],a[92:95],v[220:223]
s_waitcnt vmcnt(19) lgkmcnt(0)
M v[220:223],a[160:163],a[88:91],v[220:223]
s_barrier
M v[224:227],a[168:171],a[32:35],v[224:227]
R a[160:163],v5,0
R a[164:167],v6,0
M v[224:227],a[172:175],a[36:39],v[224:227]
M v[228:231],a[172:175],a[44:47],v[228:231]
M v[228:231],a[168:171],a[40:43],v[228:231]
M v[232:235],a[168:171],a[48:51],v[232:235]
M v[232:235],a[172:175],a[52:55],v[232:235]
M v[236:239],a[172:175],a[60:63],v[236:239]
M v[236:239],a[168:171],a[56:59],v[236:239]
M v[240:243],a[168:171],a[64:67],v[240:243]
M v[240:243],a[172:175],a[68:71],v[240:243]
M v[244:247],a[172:175],a[76:79],v[244:247]
M v[244:247],a[168:171],a[72:75],v[244:247]
M v[248:251],a[168:171],a[80:83],v[248:251]
M v[248:251],a[172:175],a[84:87],v[248:251]
s_waitcnt lgkmcnt(0)
M v[252:255],a[172:175],a[92:95],v[252:255]
M v[252:255],a[168:171],a[88:91],v[252:255]
M a[0:3],a[160:163],a[96:99],a[0:3]
R a[168:171],v5,2048
R a[172:175],v6,2048
M a[0:3],a[164:167],a[100:103],a[0:3]
T a[32:33],v1,32768
T a[34:35],v1,33792
M a[4:7],a[164:167],a[108:111],a[4:7]
SA m0,s24,49152
M a[4:7],a[160:163],a[104:107],a[4:7]
buffer_load_dwordx4 v12, s[48:51], s22 offen offset:0   lds
M a[8:11],a[160:163],a[112:115],a[8:11]
M a[8:11],a[164:167],a[116:119],a[8:11]
M a[12:15],a[164:167],a[124:127],a[12:15]
s_nop 0
T a[36:37],v1,40960
T a[38:39],v1,41984
M a[12:15],a[160:163],a[120:123],a[12:15]
M a[16:19],a[160:163],a[128:131],a[16:19]
buffer_load_dwordx4 v13, s[48:51], s22 offen offset:1024   lds
M a[16:19],a[164:167],a[132:135],a[16:19]
M a[20:23],a[164:167],a[140:143],a[20:23]
M a[20:23],a[160:163],a[136:139],a[20:23]
s_nop 0
T a[40:41],v2,32768
T a[42:43],v2,33792
M a[24:27],a[160:163],a[144:147],a[24:27]
M a[24:27],a[164:167],a[148:151],a[24:27]
s_waitcnt lgkmcnt(6)
buffer_load_dwordx4 v14, s[48:51], s22 offen offset:2048   lds
M a[28:31],a[164:167],a[156:159],a[28:31]
M a[28:31],a[160:163],a[152:155],a[28:31]
M v[32:35],a[168:171],a[96:99],v[32:35]
R a[160:163],v5,4096
R a[164:167],v6,4096
M v[32:35],a[172:175],a[100:103],v[32:35]
T a[44:45],v2,40960
T a[46:47],v2,41984
M v[36:39],a[172:175],a[108:111],v[36:39]
buffer_load_dwordx4 v15, s[48:51], s22 offen offset:3072   lds
M v[36:39],a[168:171],a[104:107],v[36:39]
s_sub_u32 s22, s22, 1048448
M v[40:43],a[168:171],a[112:115],v[40:43]
M v[40:43],a[172:175],a[116:119],v[40:43]
s_nop 0
T a[48:49],v3,32768
T a[50:51],v3,33792
M v[44:47],a[172:175],a[124:127],v[44:47]
SA m0,s23,16384
M v[44:47],a[168:171],a[120:123],v[44:47]
buffer_load_dwordx4 v8, s[16:19], s21 offen offset:0  nt lds
M v[48:51],a[168:171],a[128:131],v[48:51]
M v[48:51],a[172:175],a[132:135],v[48:51]
M v[52:55],a[172:175],a[140:143],v[52:55]
s_nop 0
T a[52:53],v3,40960
T a[54:55],v3,41984
M v[52:55],a[168:171],a[136:139],v[52:55]
M v[56:59],a[168:171],a[144:147],v[56:59]
buffer_load_dwordx4 v9, s[16:19], s21 offen offset:1024  nt lds
M v[56:59],a[172:175],a[148:151],v[56:59]
s_waitcnt lgkmcnt(6)
M v[60:63],a[172:175],a[156:159],v[60:63]
M v[60:63],a[168:171],a[152:155],v[60:63]
s_nop 0
T a[56:57],v4,32768
T a[58:59],v4,33792
M v[64:67],a[160:163],a[96:99],v[64:67]
R a[168:171],v5,6144
R a[172:175],v6,6144
M v[64:67],a[164:167],a[100:103],v[64:67]
buffer_load_dwordx4 v10, s[16:19], s21 offen offset:2048  nt lds
M v[68:71],a[164:167],a[108:111],v[68:71]
M v[68:71],a[160:163],a[104:107],v[68:71]
M v[72:75],a[160:163],a[112:115],v[72:75]
s_nop 0
T a[60:61],v4,40960
T a[62:63],v4,41984
M v[72:75],a[164:167],a[116:119],v[72:75]
M v[76:79],a[164:167],a[124:127],v[76:79]
buffer_load_dwordx4 v11, s[16:19], s21 offen offset:3072  nt lds
M v[76:79],a[160:163],a[120:123],v[76:79]
SA s21,s21,524160
M v[80:83],a[160:163],a[128:131],v[80:83]
M v[80:83],a[164:167],a[132:135],v[80:83]
M v[84:87],a[164:167],a[140:143],v[84:87]
M v[84:87],a[160:163],a[136:139],v[84:87]
M v[88:91],a[160:163],a[144:147],v[88:91]
M v[88:91],a[164:167],a[148:151],v[88:91]
s_waitcnt lgkmcnt(2)
M v[92:95],a[164:167],a[156:159],v[92:95]
s_waitcnt vmcnt(18) lgkmcnt(0)
M v[92:95],a[160:163],a[152:155],v[92:95]
s_barrier
M v[96:99],a[168:171],a[96:99],v[96:99]
R a[160:163],v5,16384
R a[164:167],v6,16384
M v[96:99],a[172:175],a[100:103],v[96:99]
M v[100:103],a[172:175],a[108:111],v[100:103]
SA m0,s24,0
T a[64:65],v1,49152
T a[66:67],v1,50176
M v[100:103],a[168:171],a[104:107],v[100:103]
buffer_load_dwordx4 v12, s[48:51], s22 offen offset:0   lds
M v[104:107],a[168:171],a[112:115],v[104:107]
M v[104:107],a[172:175],a[116:119],v[104:107]
M v[108:111],a[172:175],a[124:127],v[108:111]
M v[108:111],a[168:171],a[120:123],v[108:111]
M v[112:115],a[168:171],a[128:131],v[112:115]
M v[112:115],a[172:175],a[132:135],v[112:115]
s_nop 0
T a[68:69],v1,57344
T a[70:71],v1,58368
M v[116:119],a[172:175],a[140:143],v[116:119]
buffer_load_dwordx4 v13, s[48:51], s22 offen offset:1024   lds
M v[116:119],a[168:171],a[136:139],v[116:119]
M v[120:123],a[168:171],a[144:147],v[120:123]
M v[120:123],a[172:175],a[148:151],v[120:123]
s_waitcnt lgkmcnt(4)
M v[124:127],a[172:175],a[156:159],v[124:127]
M v[124:127],a[168:171],a[152:155],v[124:127]
M v[128:131],a[160:163],a[96:99],v[128:131]
R a[168:171],v5,18432
R a[172:175],v6,18432
M v[128:131],a[164:167],a[100:103],v[128:131]
T a[72:73],v2,49152
T a[74:75],v2,50176
M v[132:135],a[164:167],a[108:111],v[132:135]
buffer_load_dwordx4 v14, s[48:51], s22 offen offset:2048   lds
M v[132:135],a[160:163],a[104:107],v[132:135]
M v[136:139],a[160:163],a[112:115],v[136:139]
M v[136:139],a[164:167],a[116:119],v[136:139]
M v[140:143],a[164:167],a[124:127],v[140:143]
M v[140:143],a[160:163],a[120:123],v[140:143]
s_nop 0
T a[76:77],v2,57344
T a[78:79],v2,58368
M v[144:147],a[160:163],a[128:131],v[144:147]
buffer_load_dwordx4 v15, s[48:51], s22 offen offset:3072   lds
M v[144:147],a[164:167],a[132:135],v[144:147]
SA s22,s22,1048576
M v[148:151],a[164:167],a[140:143],v[148:151]
M v[148:151],a[160:163],a[136:139],v[148:151]
M v[152:155],a[160:163],a[144:147],v[152:155]
M v[152:155],a[164:167],a[148:151],v[152:155]
s_waitcnt lgkmcnt(4)
M v[156:159],a[164:167],a[156:159],v[156:159]
SA m0,s23,32768
T a[80:81],v3,49152
T a[82:83],v3,50176
M v[156:159],a[160:163],a[152:155],v[156:159]
buffer_load_dwordx4 v8, s[16:19], s21 offen offset:0  nt lds
M v[160:163],a[168:171],a[96:99],v[160:163]
R a[160:163],v5,20480
R a[164:167],v6,20480
M v[160:163],a[172:175],a[100:103],v[160:163]
buffer_load_dword a240, v26, s[60:63], s27 offen offset:0
M v[164:167],a[172:175],a[108:111],v[164:167]
SA s27,s27,2048
M v[164:167],a[168:171],a[104:107],v[164:167]
M v[168:171],a[168:171],a[112:115],v[168:171]
M v[168:171],a[172:175],a[116:119],v[168:171]
s_nop 0
T a[84:85],v3,57344
T a[86:87],v3,58368
M v[172:175],a[172:175],a[124:127],v[172:175]
buffer_load_dwordx4 v9, s[16:19], s21 offen offset:1024  nt lds
M v[172:175],a[168:171],a[120:123],v[172:175]
M v[176:179],a[168:171],a[128:131],v[176:179]
M v[176:179],a[172:175],a[132:135],v[176:179]
M v[180:183],a[172:175],a[140:143],v[180:183]
M v[180:183],a[168:171],a[136:139],v[180:183]
M v[184:187],a[168:171],a[144:147],v[184:187]
s_nop 0
T a[88:89],v4,49152
T a[90:91],v4,50176
M v[184:187],a[172:175],a[148:151],v[184:187]
s_waitcnt lgkmcnt(4)
buffer_load_dwordx4 v10, s[16:19], s21 offen offset:2048  nt lds
M v[188:191],a[172:175],a[156:159],v[188:191]
M v[188:191],a[168:171],a[152:155],v[188:191]
M v[192:195],a[160:163],a[96:99],v[192:195]
R a[168:171],v5,22528
R a[172:175],v6,22528
M v[192:195],a[164:167],a[100:103],v[192:195]
M v[196:199],a[164:167],a[108:111],v[196:199]
M v[196:199],a[160:163],a[104:107],v[196:199]
s_nop 0
T a[92:93],v4,57344
T a[94:95],v4,58368
M v[200:203],a[160:163],a[112:115],v[200:203]
buffer_load_dwordx4 v11, s[16:19], s21 offen offset:3072  nt lds
M v[200:203],a[164:167],a[116:119],v[200:203]
SA s21,s21,128
M v[204:207],a[164:167],a[124:127],v[204:207]
M v[204:207],a[160:163],a[120:123],v[204:207]
M v[208:211],a[160:163],a[128:131],v[208:211]
M v[208:211],a[164:167],a[132:135],v[208:211]
M v[212:215],a[164:167],a[140:143],v[212:215]
M v[212:215],a[160:163],a[136:139],v[212:215]
M v[216:219],a[160:163],a[144:147],v[216:219]
M v[216:219],a[164:167],a[148:151],v[216:219]
s_waitcnt lgkmcnt(2)
M v[220:223],a[164:167],a[156:159],v[220:223]
s_waitcnt vmcnt(17) lgkmcnt(0)
M v[220:223],a[160:163],a[152:155],v[220:223]
s_barrier
M v[224:227],a[168:171],a[96:99],v[224:227]
R a[160:163],v5,32768
R a[164:167],v6,32768
M v[224:227],a[172:175],a[100:103],v[224:227]
v_cmp_ne_u32 vcc, 1, v17
M v[228:231],a[172:175],a[108:111],v[228:231]
s_nop 0
M v[228:231],a[168:171],a[104:107],v[228:231]
s_cbranch_vccnz L_zs1
L_zr1:
M v[232:235],a[168:171],a[112:115],v[232:235]
M v[232:235],a[172:175],a[116:119],v[232:235]
s_lshl_b32 s72, s30, 6
M v[236:239],a[172:175],a[124:127],v[236:239]
SA s72,s72,104914944
M v[236:239],a[168:171],a[120:123],v[236:239]
buffer_store_dword v19, v18, s[8:11], s72 offen sc1
M v[240:243],a[168:171],a[128:131],v[240:243]
M v[240:243],a[172:175],a[132:135],v[240:243]
M v[244:247],a[172:175],a[140:143],v[244:247]
M v[244:247],a[168:171],a[136:139],v[244:247]
M v[248:251],a[168:171],a[144:147],v[248:251]
M v[248:251],a[172:175],a[148:151],v[248:251]
s_waitcnt lgkmcnt(0)
M v[252:255],a[172:175],a[156:159],v[252:255]
M v[252:255],a[168:171],a[152:155],v[252:255]
M a[0:3],a[160:163],a[32:35],a[0:3]
R a[168:171],v5,34816
R a[172:175],v6,34816
M a[0:3],a[164:167],a[36:39],a[0:3]
T a[96:97],v1,0
T a[98:99],v1,1024
M a[4:7],a[164:167],a[44:47],a[4:7]
SA m0,s24,16384
M a[4:7],a[160:163],a[40:43],a[4:7]
buffer_load_dwordx4 v12, s[48:51], s22 offen offset:0   lds
M a[8:11],a[160:163],a[48:51],a[8:11]
M a[8:11],a[164:167],a[52:55],a[8:11]
s_mul_i32 s64, s41, 229376
M a[12:15],a[164:167],a[60:63],a[12:15]
SA s72,s90,s64
T a[100:101],v1,8192
T a[102:103],v1,9216
M a[12:15],a[160:163],a[56:59],a[12:15]
s_addc_u32 s73, s91, 0
M a[16:19],a[160:163],a[64:67],a[16:19]
s_sub_u32 s75, 3670016, s64
buffer_load_dwordx4 v13, s[48:51], s22 offen offset:1024   lds
M a[16:19],a[164:167],a[68:71],a[16:19]
s_mov_b32 s12, s72
M a[20:23],a[164:167],a[76:79],a[20:23]
s_and_b32 s13, s73, 0xffff
M a[20:23],a[160:163],a[72:75],a[20:23]
s_mov_b32 s14, s75
T a[104:105],v2,0
T a[106:107],v2,1024
M a[24:27],a[160:163],a[80:83],a[24:27]
s_mov_b32 s15, 0x20000
M a[24:27],a[164:167],a[84:87],a[24:27]
s_waitcnt lgkmcnt(6)
buffer_load_dwordx4 v14, s[48:51], s22 offen offset:2048   lds
M a[28:31],a[164:167],a[92:95],a[28:31]
M a[28:31],a[160:163],a[88:91],a[28:31]
M v[32:35],a[168:171],a[32:35],v[32:35]
R a[160:163],v5,36864
R a[164:167],v6,36864
M v[32:35],a[172:175],a[36:39],v[32:35]
T a[108:109],v2,8192
T a[110:111],v2,9216
M v[36:39],a[172:175],a[44:47],v[36:39]
buffer_load_dwordx4 v15, s[48:51], s22 offen offset:3072   lds
M v[36:39],a[168:171],a[40:43],v[36:39]
s_sub_u32 s22, s22, 1048448
M v[40:43],a[168:171],a[48:51],v[40:43]
M v[40:43],a[172:175],a[52:55],v[40:43]
s_nop 0
T a[112:113],v3,0
T a[114:115],v3,1024
M v[44:47],a[172:175],a[60:63],v[44:47]
SA m0,s23,49152
M v[44:47],a[168:171],a[56:59],v[44:47]
buffer_load_dwordx4 v8, s[16:19], s21 offen offset:0  nt lds
M v[48:51],a[168:171],a[64:67],v[48:51]
M v[48:51],a[172:175],a[68:71],v[48:51]
M v[52:55],a[172:175],a[76:79],v[52:55]
s_nop 0
T a[116:117],v3,8192
T a[118:119],v3,9216
M v[52:55],a[168:171],a[72:75],v[52:55]
M v[56:59],a[168:171],a[80:83],v[56:59]
buffer_load_dwordx4 v9, s[16:19], s21 offen offset:1024  nt lds
M v[56:59],a[172:175],a[84:87],v[56:59]
s_waitcnt lgkmcnt(6)
M v[60:63],a[172:175],a[92:95],v[60:63]
M v[60:63],a[168:171],a[88:91],v[60:63]
s_nop 0
T a[120:121],v4,0
T a[122:123],v4,1024
M v[64:67],a[160:163],a[32:35],v[64:67]
R a[168:171],v5,38912
R a[172:175],v6,38912
M v[64:67],a[164:167],a[36:39],v[64:67]
buffer_load_dwordx4 v10, s[16:19], s21 offen offset:2048  nt lds
M v[68:71],a[164:167],a[44:47],v[68:71]
M v[68:71],a[160:163],a[40:43],v[68:71]
M v[72:75],a[160:163],a[48:51],v[72:75]
s_nop 0
T a[124:125],v4,8192
T a[126:127],v4,9216
M v[72:75],a[164:167],a[52:55],v[72:75]
M v[76:79],a[164:167],a[60:63],v[76:79]
buffer_load_dwordx4 v11, s[16:19], s21 offen offset:3072  nt lds
M v[76:79],a[160:163],a[56:59],v[76:79]
SA s21,s21,524160
M v[80:83],a[160:163],a[64:67],v[80:83]
M v[80:83],a[164:167],a[68:71],v[80:83]
M v[84:87],a[164:167],a[76:79],v[84:87]
M v[84:87],a[160:163],a[72:75],v[84:87]
M v[88:91],a[160:163],a[80:83],v[88:91]
M v[88:91],a[164:167],a[84:87],v[88:91]
s_waitcnt lgkmcnt(2)
M v[92:95],a[164:167],a[92:95],v[92:95]
s_waitcnt vmcnt(18) lgkmcnt(0)
M v[92:95],a[160:163],a[88:91],v[92:95]
s_barrier
M v[96:99],a[168:171],a[32:35],v[96:99]
R a[160:163],v5,49152
R a[164:167],v6,49152
M v[96:99],a[172:175],a[36:39],v[96:99]
M v[100:103],a[172:175],a[44:47],v[100:103]
SA m0,s24,32768
T a[128:129],v1,16384
T a[130:131],v1,17408
M v[100:103],a[168:171],a[40:43],v[100:103]
buffer_load_dwordx4 v12, s[48:51], s22 offen offset:0   lds
M v[104:107],a[168:171],a[48:51],v[104:107]
M v[104:107],a[172:175],a[52:55],v[104:107]
M v[108:111],a[172:175],a[60:63],v[108:111]
M v[108:111],a[168:171],a[56:59],v[108:111]
M v[112:115],a[168:171],a[64:67],v[112:115]
M v[112:115],a[172:175],a[68:71],v[112:115]
s_nop 0
T a[132:133],v1,24576
T a[134:135],v1,25600
M v[116:119],a[172:175],a[76:79],v[116:119]
buffer_load_dwordx4 v13, s[48:51], s22 offen offset:1024   lds
M v[116:119],a[168:171],a[72:75],v[116:119]
M v[120:123],a[168:171],a[80:83],v[120:123]
M v[120:123],a[172:175],a[84:87],v[120:123]
s_waitcnt lgkmcnt(4)
M v[124:127],a[172:175],a[92:95],v[124:127]
M v[124:127],a[168:171],a[88:91],v[124:127]
M v[128:131],a[160:163],a[32:35],v[128:131]
R a[168:171],v5,51200
R a[172:175],v6,51200
M v[128:131],a[164:167],a[36:39],v[128:131]
T a[136:137],v2,16384
T a[138:139],v2,17408
M v[132:135],a[164:167],a[44:47],v[132:135]
buffer_load_dwordx4 v14, s[48:51], s22 offen offset:2048   lds
M v[132:135],a[160:163],a[40:43],v[132:135]
M v[136:139],a[160:163],a[48:51],v[136:139]
M v[136:139],a[164:167],a[52:55],v[136:139]
M v[140:143],a[164:167],a[60:63],v[140:143]
M v[140:143],a[160:163],a[56:59],v[140:143]
s_nop 0
T a[140:141],v2,24576
T a[142:143],v2,25600
M v[144:147],a[160:163],a[64:67],v[144:147]
buffer_load_dwordx4 v15, s[48:51], s22 offen offset:3072   lds
M v[144:147],a[164:167],a[68:71],v[144:147]
SA s22,s22,1048576
M v[148:151],a[164:167],a[76:79],v[148:151]
M v[148:151],a[160:163],a[72:75],v[148:151]
M v[152:155],a[160:163],a[80:83],v[152:155]
M v[152:155],a[164:167],a[84:87],v[152:155]
s_waitcnt lgkmcnt(4)
M v[156:159],a[164:167],a[92:95],v[156:159]
SA m0,s23,0
T a[144:145],v3,16384
T a[146:147],v3,17408
M v[156:159],a[160:163],a[88:91],v[156:159]
buffer_load_dwordx4 v8, s[16:19], s21 offen offset:0  nt lds
M v[160:163],a[168:171],a[32:35],v[160:163]
R a[160:163],v5,53248
R a[164:167],v6,53248
M v[160:163],a[172:175],a[36:39],v[160:163]
buffer_load_dword a240, v26, s[60:63], s27 offen offset:0
M v[164:167],a[172:175],a[44:47],v[164:167]
SA s27,s27,2048
M v[164:167],a[168:171],a[40:43],v[164:167]
M v[168:171],a[168:171],a[48:51],v[168:171]
M v[168:171],a[172:175],a[52:55],v[168:171]
s_nop 0
T a[148:149],v3,24576
T a[150:151],v3,25600
M v[172:175],a[172:175],a[60:63],v[172:175]
buffer_load_dwordx4 v9, s[16:19], s21 offen offset:1024  nt lds
M v[172:175],a[168:171],a[56:59],v[172:175]
M v[176:179],a[168:171],a[64:67],v[176:179]
M v[176:179],a[172:175],a[68:71],v[176:179]
M v[180:183],a[172:175],a[76:79],v[180:183]
M v[180:183],a[168:171],a[72:75],v[180:183]
M v[184:187],a[168:171],a[80:83],v[184:187]
s_nop 0
T a[152:153],v4,16384
T a[154:155],v4,17408
M v[184:187],a[172:175],a[84:87],v[184:187]
s_waitcnt lgkmcnt(4)
buffer_load_dwordx4 v10, s[16:19], s21 offen offset:2048  nt lds
M v[188:191],a[172:175],a[92:95],v[188:191]
M v[188:191],a[168:171],a[88:91],v[188:191]
M v[192:195],a[160:163],a[32:35],v[192:195]
R a[168:171],v5,55296
R a[172:175],v6,55296
M v[192:195],a[164:167],a[36:39],v[192:195]
M v[196:199],a[164:167],a[44:47],v[196:199]
M v[196:199],a[160:163],a[40:43],v[196:199]
s_nop 0
T a[156:157],v4,24576
T a[158:159],v4,25600
M v[200:203],a[160:163],a[48:51],v[200:203]
buffer_load_dwordx4 v11, s[16:19], s21 offen offset:3072  nt lds
M v[200:203],a[164:167],a[52:55],v[200:203]
SA s21,s21,128
M v[204:207],a[164:167],a[60:63],v[204:207]
M v[204:207],a[160:163],a[56:59],v[204:207]
M v[208:211],a[160:163],a[64:67],v[208:211]
M v[208:211],a[164:167],a[68:71],v[208:211]
M v[212:215],a[164:167],a[76:79],v[212:215]
M v[212:215],a[160:163],a[72:75],v[212:215]
M v[216:219],a[160:163],a[80:83],v[216:219]
M v[216:219],a[164:167],a[84:87],v[216:219]
s_waitcnt lgkmcnt(2)
M v[220:223],a[164:167],a[92:95],v[220:223]
s_waitcnt vmcnt(18) lgkmcnt(0)
M v[220:223],a[160:163],a[88:91],v[220:223]
s_barrier
M v[224:227],a[168:171],a[32:35],v[224:227]
R a[160:163],v5,0
R a[164:167],v6,0
M v[224:227],a[172:175],a[36:39],v[224:227]
M v[228:231],a[172:175],a[44:47],v[228:231]
M v[228:231],a[168:171],a[40:43],v[228:231]
M v[232:235],a[168:171],a[48:51],v[232:235]
M v[232:235],a[172:175],a[52:55],v[232:235]
M v[236:239],a[172:175],a[60:63],v[236:239]
M v[236:239],a[168:171],a[56:59],v[236:239]
M v[240:243],a[168:171],a[64:67],v[240:243]
M v[240:243],a[172:175],a[68:71],v[240:243]
M v[244:247],a[172:175],a[76:79],v[244:247]
M v[244:247],a[168:171],a[72:75],v[244:247]
M v[248:251],a[168:171],a[80:83],v[248:251]
M v[248:251],a[172:175],a[84:87],v[248:251]
s_waitcnt lgkmcnt(0)
M v[252:255],a[172:175],a[92:95],v[252:255]
M v[252:255],a[168:171],a[88:91],v[252:255]
M a[0:3],a[160:163],a[96:99],a[0:3]
R a[168:171],v5,2048
R a[172:175],v6,2048
M a[0:3],a[164:167],a[100:103],a[0:3]
T a[32:33],v1,32768
T a[34:35],v1,33792
M a[4:7],a[164:167],a[108:111],a[4:7]
SA m0,s24,49152
M a[4:7],a[160:163],a[104:107],a[4:7]
buffer_load_dwordx4 v12, s[48:51], s22 offen offset:0   lds
M a[8:11],a[160:163],a[112:115],a[8:11]
M a[8:11],a[164:167],a[116:119],a[8:11]
M a[12:15],a[164:167],a[124:127],a[12:15]
s_nop 0
T a[36:37],v1,40960
T a[38:39],v1,41984
M a[12:15],a[160:163],a[120:123],a[12:15]
M a[16:19],a[160:163],a[128:131],a[16:19]
buffer_load_dwordx4 v13, s[48:51], s22 offen offset:1024   lds
M a[16:19],a[164:167],a[132:135],a[16:19]
M a[20:23],a[164:167],a[140:143],a[20:23]
M a[20:23],a[160:163],a[136:139],a[20:23]
s_nop 0
T a[40:41],v2,32768
T a[42:43],v2,33792
M a[24:27],a[160:163],a[144:147],a[24:27]
M a[24:27],a[164:167],a[148:151],a[24:27]
s_waitcnt lgkmcnt(6)
buffer_load_dwordx4 v14, s[48:51], s22 offen offset:2048   lds
M a[28:31],a[164:167],a[156:159],a[28:31]
M a[28:31],a[160:163],a[152:155],a[28:31]
M v[32:35],a[168:171],a[96:99],v[32:35]
R a[160:163],v5,4096
R a[164:167],v6,4096
M v[32:35],a[172:175],a[100:103],v[32:35]
T a[44:45],v2,40960
T a[46:47],v2,41984
L_w_kv13:
s_cbranch_execz L_w_kv17
M v[36:39],a[172:175],a[108:111],v[36:39]
buffer_load_dwordx4 v15, s[48:51], s22 offen offset:3072   lds
M v[36:39],a[168:171],a[104:107],v[36:39]
s_sub_u32 s22, s22, 1048448
M v[40:43],a[168:171],a[112:115],v[40:43]
M v[40:43],a[172:175],a[116:119],v[40:43]
s_nop 0
T a[48:49],v3,32768
T a[50:51],v3,33792
M v[44:47],a[172:175],a[124:127],v[44:47]
SA m0,s23,16384
M v[44:47],a[168:171],a[120:123],v[44:47]
buffer_load_dwordx4 v8, s[16:19], s21 offen offset:0  nt lds
M v[48:51],a[168:171],a[128:131],v[48:51]
M v[48:51],a[172:175],a[132:135],v[48:51]
M v[52:55],a[172:175],a[140:143],v[52:55]
s_nop 0
T a[52:53],v3,40960
T a[54:55],v3,41984
M v[52:55],a[168:171],a[136:139],v[52:55]
M v[56:59],a[168:171],a[144:147],v[56:59]
buffer_load_dwordx4 v9, s[16:19], s21 offen offset:1024  nt lds
M v[56:59],a[172:175],a[148:151],v[56:59]
s_waitcnt lgkmcnt(6)
M v[60:63],a[172:175],a[156:159],v[60:63]
M v[60:63],a[168:171],a[152:155],v[60:63]
s_nop 0
T a[56:57],v4,32768
T a[58:59],v4,33792
M v[64:67],a[160:163],a[96:99],v[64:67]
R a[168:171],v5,6144
R a[172:175],v6,6144
M v[64:67],a[164:167],a[100:103],v[64:67]
buffer_load_dwordx4 v10, s[16:19], s21 offen offset:2048  nt lds
M v[68:71],a[164:167],a[108:111],v[68:71]
M v[68:71],a[160:163],a[104:107],v[68:71]
M v[72:75],a[160:163],a[112:115],v[72:75]
s_nop 0
T a[60:61],v4,40960
T a[62:63],v4,41984
M v[72:75],a[164:167],a[116:119],v[72:75]
M v[76:79],a[164:167],a[124:127],v[76:79]
buffer_load_dwordx4 v11, s[16:19], s21 offen offset:3072  nt lds
M v[76:79],a[160:163],a[120:123],v[76:79]
SA s21,s21,524160
M v[80:83],a[160:163],a[128:131],v[80:83]
M v[80:83],a[164:167],a[132:135],v[80:83]
M v[84:87],a[164:167],a[140:143],v[84:87]
M v[84:87],a[160:163],a[136:139],v[84:87]
M v[88:91],a[160:163],a[144:147],v[88:91]
M v[88:91],a[164:167],a[148:151],v[88:91]
s_waitcnt lgkmcnt(2)
M v[92:95],a[164:167],a[156:159],v[92:95]
s_waitcnt vmcnt(17) lgkmcnt(0)
M v[92:95],a[160:163],a[152:155],v[92:95]
s_barrier
M v[96:99],a[168:171],a[96:99],v[96:99]
R a[160:163],v5,16384
R a[164:167],v6,16384
M v[96:99],a[172:175],a[100:103],v[96:99]
M v[100:103],a[172:175],a[108:111],v[100:103]
SA m0,s24,0
T a[64:65],v1,49152
T a[66:67],v1,50176
M v[100:103],a[168:171],a[104:107],v[100:103]
buffer_load_dwordx4 v12, s[48:51], s22 offen offset:0   lds
M v[104:107],a[168:171],a[112:115],v[104:107]
M v[104:107],a[172:175],a[116:119],v[104:107]
M v[108:111],a[172:175],a[124:127],v[108:111]
M v[108:111],a[168:171],a[120:123],v[108:111]
M v[112:115],a[168:171],a[128:131],v[112:115]
M v[112:115],a[172:175],a[132:135],v[112:115]
s_nop 0
T a[68:69],v1,57344
T a[70:71],v1,58368
M v[116:119],a[172:175],a[140:143],v[116:119]
buffer_load_dwordx4 v13, s[48:51], s22 offen offset:1024   lds
M v[116:119],a[168:171],a[136:139],v[116:119]
M v[120:123],a[168:171],a[144:147],v[120:123]
M v[120:123],a[172:175],a[148:151],v[120:123]
s_waitcnt lgkmcnt(4)
M v[124:127],a[172:175],a[156:159],v[124:127]
M v[124:127],a[168:171],a[152:155],v[124:127]
M v[128:131],a[160:163],a[96:99],v[128:131]
R a[168:171],v5,18432
R a[172:175],v6,18432
M v[128:131],a[164:167],a[100:103],v[128:131]
T a[72:73],v2,49152
T a[74:75],v2,50176
M v[132:135],a[164:167],a[108:111],v[132:135]
buffer_load_dwordx4 v14, s[48:51], s22 offen offset:2048   lds
M v[132:135],a[160:163],a[104:107],v[132:135]
M v[136:139],a[160:163],a[112:115],v[136:139]
M v[136:139],a[164:167],a[116:119],v[136:139]
M v[140:143],a[164:167],a[124:127],v[140:143]
M v[140:143],a[160:163],a[120:123],v[140:143]
s_nop 0
T a[76:77],v2,57344
T a[78:79],v2,58368
M v[144:147],a[160:163],a[128:131],v[144:147]
buffer_load_dwordx4 v15, s[48:51], s22 offen offset:3072   lds
M v[144:147],a[164:167],a[132:135],v[144:147]
SA s22,s22,1048576
M v[148:151],a[164:167],a[140:143],v[148:151]
M v[148:151],a[160:163],a[136:139],v[148:151]
M v[152:155],a[160:163],a[144:147],v[152:155]
M v[152:155],a[164:167],a[148:151],v[152:155]
s_waitcnt lgkmcnt(4)
M v[156:159],a[164:167],a[156:159],v[156:159]
SA m0,s23,32768
T a[80:81],v3,49152
T a[82:83],v3,50176
M v[156:159],a[160:163],a[152:155],v[156:159]
buffer_load_dwordx4 v8, s[16:19], s21 offen offset:0  nt lds
M v[160:163],a[168:171],a[96:99],v[160:163]
R a[160:163],v5,20480
R a[164:167],v6,20480
M v[160:163],a[172:175],a[100:103],v[160:163]
buffer_load_dword a240, v26, s[60:63], s27 offen offset:0
M v[164:167],a[172:175],a[108:111],v[164:167]
SA s27,s27,2048
M v[164:167],a[168:171],a[104:107],v[164:167]
M v[168:171],a[168:171],a[112:115],v[168:171]
M v[168:171],a[172:175],a[116:119],v[168:171]
s_nop 0
T a[84:85],v3,57344
T a[86:87],v3,58368
M v[172:175],a[172:175],a[124:127],v[172:175]
buffer_load_dwordx4 v9, s[16:19], s21 offen offset:1024  nt lds
M v[172:175],a[168:171],a[120:123],v[172:175]
M v[176:179],a[168:171],a[128:131],v[176:179]
M v[176:179],a[172:175],a[132:135],v[176:179]
M v[180:183],a[172:175],a[140:143],v[180:183]
M v[180:183],a[168:171],a[136:139],v[180:183]
M v[184:187],a[168:171],a[144:147],v[184:187]
s_nop 0
T a[88:89],v4,49152
T a[90:91],v4,50176
M v[184:187],a[172:175],a[148:151],v[184:187]
s_waitcnt lgkmcnt(4)
buffer_load_dwordx4 v10, s[16:19], s21 offen offset:2048  nt lds
M v[188:191],a[172:175],a[156:159],v[188:191]
M v[188:191],a[168:171],a[152:155],v[188:191]
M v[192:195],a[160:163],a[96:99],v[192:195]
R a[168:171],v5,22528
R a[172:175],v6,22528
M v[192:195],a[164:167],a[100:103],v[192:195]
M v[196:199],a[164:167],a[108:111],v[196:199]
M v[196:199],a[160:163],a[104:107],v[196:199]
s_nop 0
T a[92:93],v4,57344
T a[94:95],v4,58368
M v[200:203],a[160:163],a[112:115],v[200:203]
buffer_load_dwordx4 v11, s[16:19], s21 offen offset:3072  nt lds
M v[200:203],a[164:167],a[116:119],v[200:203]
SA s21,s21,128
M v[204:207],a[164:167],a[124:127],v[204:207]
M v[204:207],a[160:163],a[120:123],v[204:207]
M v[208:211],a[160:163],a[128:131],v[208:211]
M v[208:211],a[164:167],a[132:135],v[208:211]
M v[212:215],a[164:167],a[140:143],v[212:215]
M v[212:215],a[160:163],a[136:139],v[212:215]
M v[216:219],a[160:163],a[144:147],v[216:219]
M v[216:219],a[164:167],a[148:151],v[216:219]
s_waitcnt lgkmcnt(2)
M v[220:223],a[164:167],a[156:159],v[220:223]
s_waitcnt vmcnt(17) lgkmcnt(0)
M v[220:223],a[160:163],a[152:155],v[220:223]
s_barrier
M v[224:227],a[168:171],a[96:99],v[224:227]
R a[160:163],v5,32768
R a[164:167],v6,32768
M v[224:227],a[172:175],a[100:103],v[224:227]
M v[228:231],a[172:175],a[108:111],v[228:231]
M v[228:231],a[168:171],a[104:107],v[228:231]
M v[232:235],a[168:171],a[112:115],v[232:235]
M v[232:235],a[172:175],a[116:119],v[232:235]
M v[236:239],a[172:175],a[124:127],v[236:239]
M v[236:239],a[168:171],a[120:123],v[236:239]
M v[240:243],a[168:171],a[128:131],v[240:243]
M v[240:243],a[172:175],a[132:135],v[240:243]
M v[244:247],a[172:175],a[140:143],v[244:247]
M v[244:247],a[168:171],a[136:139],v[244:247]
M v[248:251],a[168:171],a[144:147],v[248:251]
M v[248:251],a[172:175],a[148:151],v[248:251]
s_waitcnt lgkmcnt(0)
M v[252:255],a[172:175],a[156:159],v[252:255]
M v[252:255],a[168:171],a[152:155],v[252:255]
M a[0:3],a[160:163],a[32:35],a[0:3]
R a[168:171],v5,34816
R a[172:175],v6,34816
M a[0:3],a[164:167],a[36:39],a[0:3]
T a[96:97],v1,0
T a[98:99],v1,1024
M a[4:7],a[164:167],a[44:47],a[4:7]
SA m0,s24,16384
M a[4:7],a[160:163],a[40:43],a[4:7]
buffer_load_dwordx4 v12, s[48:51], s22 offen offset:0   lds
M a[8:11],a[160:163],a[48:51],a[8:11]
M a[8:11],a[164:167],a[52:55],a[8:11]
M a[12:15],a[164:167],a[60:63],a[12:15]
s_nop 0
T a[100:101],v1,8192
T a[102:103],v1,9216
M a[12:15],a[160:163],a[56:59],a[12:15]
M a[16:19],a[160:163],a[64:67],a[16:19]
buffer_load_dwordx4 v13, s[48:51], s22 offen offset:1024   lds
M a[16:19],a[164:167],a[68:71],a[16:19]
M a[20:23],a[164:167],a[76:79],a[20:23]
M a[20:23],a[160:163],a[72:75],a[20:23]
s_nop 0
T a[104:105],v2,0
T a[106:107],v2,1024
M a[24:27],a[160:163],a[80:83],a[24:27]
M a[24:27],a[164:167],a[84:87],a[24:27]
s_waitcnt lgkmcnt(6)
buffer_load_dwordx4 v14, s[48:51], s22 offen offset:2048   lds
M a[28:31],a[164:167],a[92:95],a[28:31]
M a[28:31],a[160:163],a[88:91],a[28:31]
M v[32:35],a[168:171],a[32:35],v[32:35]
R a[160:163],v5,36864
R a[164:167],v6,36864
M v[32:35],a[172:175],a[36:39],v[32:35]
T a[108:109],v2,8192
T a[110:111],v2,9216
M v[36:39],a[172:175],a[44:47],v[36:39]
buffer_load_dwordx4 v15, s[48:51], s22 offen offset:3072   lds
M v[36:39],a[168:171],a[40:43],v[36:39]
s_sub_u32 s22, s22, 1048448
M v[40:43],a[168:171],a[48:51],v[40:43]
M v[40:43],a[172:175],a[52:55],v[40:43]
s_nop 0
T a[112:113],v3,0
T a[114:115],v3,1024
M v[44:47],a[172:175],a[60:63],v[44:47]
SA m0,s23,49152
M v[44:47],a[168:171],a[56:59],v[44:47]
buffer_load_dwordx4 v8, s[16:19], s21 offen offset:0  nt lds
M v[48:51],a[168:171],a[64:67],v[48:51]
M v[48:51],a[172:175],a[68:71],v[48:51]
M v[52:55],a[172:175],a[76:79],v[52:55]
s_nop 0
T a[116:117],v3,8192
T a[118:119],v3,9216
M v[52:55],a[168:171],a[72:75],v[52:55]
M v[56:59],a[168:171],a[80:83],v[56:59]
buffer_load_dwordx4 v9, s[16:19], s21 offen offset:1024  nt lds
M v[56:59],a[172:175],a[84:87],v[56:59]
s_waitcnt lgkmcnt(6)
M v[60:63],a[172:175],a[92:95],v[60:63]
M v[60:63],a[168:171],a[88:91],v[60:63]
s_nop 0
T a[120:121],v4,0
T a[122:123],v4,1024
M v[64:67],a[160:163],a[32:35],v[64:67]
R a[168:171],v5,38912
R a[172:175],v6,38912
M v[64:67],a[164:167],a[36:39],v[64:67]
buffer_load_dwordx4 v10, s[16:19], s21 offen offset:2048  nt lds
M v[68:71],a[164:167],a[44:47],v[68:71]
M v[68:71],a[160:163],a[40:43],v[68:71]
M v[72:75],a[160:163],a[48:51],v[72:75]
s_nop 0
T a[124:125],v4,8192
T a[126:127],v4,9216
M v[72:75],a[164:167],a[52:55],v[72:75]
M v[76:79],a[164:167],a[60:63],v[76:79]
buffer_load_dwordx4 v11, s[16:19], s21 offen offset:3072  nt lds
M v[76:79],a[160:163],a[56:59],v[76:79]
SA s21,s21,524160
M v[80:83],a[160:163],a[64:67],v[80:83]
M v[80:83],a[164:167],a[68:71],v[80:83]
M v[84:87],a[164:167],a[76:79],v[84:87]
M v[84:87],a[160:163],a[72:75],v[84:87]
M v[88:91],a[160:163],a[80:83],v[88:91]
M v[88:91],a[164:167],a[84:87],v[88:91]
s_waitcnt lgkmcnt(2)
M v[92:95],a[164:167],a[92:95],v[92:95]
s_waitcnt vmcnt(17) lgkmcnt(0)
M v[92:95],a[160:163],a[88:91],v[92:95]
s_barrier
M v[96:99],a[168:171],a[32:35],v[96:99]
R a[160:163],v5,49152
R a[164:167],v6,49152
M v[96:99],a[172:175],a[36:39],v[96:99]
M v[100:103],a[172:175],a[44:47],v[100:103]
SA m0,s24,32768
T a[128:129],v1,16384
T a[130:131],v1,17408
M v[100:103],a[168:171],a[40:43],v[100:103]
buffer_load_dwordx4 v12, s[48:51], s22 offen offset:0   lds
M v[104:107],a[168:171],a[48:51],v[104:107]
M v[104:107],a[172:175],a[52:55],v[104:107]
M v[108:111],a[172:175],a[60:63],v[108:111]
M v[108:111],a[168:171],a[56:59],v[108:111]
M v[112:115],a[168:171],a[64:67],v[112:115]
M v[112:115],a[172:175],a[68:71],v[112:115]
s_nop 0
T a[132:133],v1,24576
T a[134:135],v1,25600
M v[116:119],a[172:175],a[76:79],v[116:119]
buffer_load_dwordx4 v13, s[48:51], s22 offen offset:1024   lds
M v[116:119],a[168:171],a[72:75],v[116:119]
M v[120:123],a[168:171],a[80:83],v[120:123]
s_and_b32 s64, s42, 7
s_lshl_b32 s64, s64, 2
M v[120:123],a[172:175],a[84:87],v[120:123]
s_waitcnt lgkmcnt(4)
SA s64,s64,s20
M v[124:127],a[172:175],a[92:95],v[124:127]
s_mul_i32 s64, s64, 114688
v_bfe_u32 v28, v0, 2, 2
v_and_b32 v29, 3, v0
M v[124:127],a[168:171],a[88:91],v[124:127]
v_lshlrev_b32 v29, 7, v29
v_lshl_add_u32 v28, v28, 13, v29
M v[128:131],a[160:163],a[32:35],v[128:131]
R a[168:171],v5,51200
R a[172:175],v6,51200
M v[128:131],a[164:167],a[36:39],v[128:131]
T a[136:137],v2,16384
T a[138:139],v2,17408
M v[132:135],a[164:167],a[44:47],v[132:135]
buffer_load_dwordx4 v14, s[48:51], s22 offen offset:2048   lds
M v[132:135],a[160:163],a[40:43],v[132:135]
v_add_u32 v23, s64, v28
v_and_b32 v28, 48, v0
M v[136:139],a[160:163],a[48:51],v[136:139]
v_lshl_add_u32 v23, v28, 24, v23
M v[136:139],a[164:167],a[52:55],v[136:139]
M v[140:143],a[164:167],a[60:63],v[140:143]
M v[140:143],a[160:163],a[56:59],v[140:143]
s_nop 0
T a[140:141],v2,24576
T a[142:143],v2,25600
M v[144:147],a[160:163],a[64:67],v[144:147]
buffer_load_dwordx4 v15, s[48:51], s22 offen offset:3072   lds
M v[144:147],a[164:167],a[68:71],v[144:147]
SA s22,s22,1048576
M v[148:151],a[164:167],a[76:79],v[148:151]
M v[148:151],a[160:163],a[72:75],v[148:151]
M v[152:155],a[160:163],a[80:83],v[152:155]
M v[152:155],a[164:167],a[84:87],v[152:155]
s_waitcnt lgkmcnt(4)
M v[156:159],a[164:167],a[92:95],v[156:159]
SA m0,s23,0
T a[144:145],v3,16384
T a[146:147],v3,17408
M v[156:159],a[160:163],a[88:91],v[156:159]
buffer_load_dwordx4 v8, s[16:19], s21 offen offset:0  nt lds
M v[160:163],a[168:171],a[32:35],v[160:163]
R a[160:163],v5,53248
R a[164:167],v6,53248
M v[160:163],a[172:175],a[36:39],v[160:163]
M v[164:167],a[172:175],a[44:47],v[164:167]
M v[164:167],a[168:171],a[40:43],v[164:167]
M v[168:171],a[168:171],a[48:51],v[168:171]
M v[168:171],a[172:175],a[52:55],v[168:171]
s_nop 0
T a[148:149],v3,24576
T a[150:151],v3,25600
M v[172:175],a[172:175],a[60:63],v[172:175]
buffer_load_dwordx4 v9, s[16:19], s21 offen offset:1024  nt lds
M v[172:175],a[168:171],a[56:59],v[172:175]
M v[176:179],a[168:171],a[64:67],v[176:179]
M v[176:179],a[172:175],a[68:71],v[176:179]
M v[180:183],a[172:175],a[76:79],v[180:183]
M v[180:183],a[168:171],a[72:75],v[180:183]
M v[184:187],a[168:171],a[80:83],v[184:187]
s_nop 0
T a[152:153],v4,16384
T a[154:155],v4,17408
M v[184:187],a[172:175],a[84:87],v[184:187]
s_waitcnt lgkmcnt(4)
buffer_load_dwordx4 v10, s[16:19], s21 offen offset:2048  nt lds
M v[188:191],a[172:175],a[92:95],v[188:191]
M v[188:191],a[168:171],a[88:91],v[188:191]
M v[192:195],a[160:163],a[32:35],v[192:195]
R a[168:171],v5,55296
R a[172:175],v6,55296
M v[192:195],a[164:167],a[36:39],v[192:195]
M v[196:199],a[164:167],a[44:47],v[196:199]
M v[196:199],a[160:163],a[40:43],v[196:199]
s_nop 0
T a[156:157],v4,24576
T a[158:159],v4,25600
M v[200:203],a[160:163],a[48:51],v[200:203]
buffer_load_dwordx4 v11, s[16:19], s21 offen offset:3072  nt lds
M v[200:203],a[164:167],a[52:55],v[200:203]
SA s21,s21,128
M v[204:207],a[164:167],a[60:63],v[204:207]
M v[204:207],a[160:163],a[56:59],v[204:207]
M v[208:211],a[160:163],a[64:67],v[208:211]
M v[208:211],a[164:167],a[68:71],v[208:211]
M v[212:215],a[164:167],a[76:79],v[212:215]
M v[212:215],a[160:163],a[72:75],v[212:215]
M v[216:219],a[160:163],a[80:83],v[216:219]
M v[216:219],a[164:167],a[84:87],v[216:219]
s_waitcnt lgkmcnt(2)
M v[220:223],a[164:167],a[92:95],v[220:223]
s_waitcnt vmcnt(16) lgkmcnt(0)
M v[220:223],a[160:163],a[88:91],v[220:223]
s_barrier
M v[224:227],a[168:171],a[32:35],v[224:227]
R a[160:163],v5,0
R a[164:167],v6,0
M v[224:227],a[172:175],a[36:39],v[224:227]
buffer_load_dword a240, v23, s[52:55], 0 offen offset:0
M v[228:231],a[172:175],a[44:47],v[228:231]
v_add_u32 v23, 32768, v23
M v[228:231],a[168:171],a[40:43],v[228:231]
M v[232:235],a[168:171],a[48:51],v[232:235]
M v[232:235],a[172:175],a[52:55],v[232:235]
M v[236:239],a[172:175],a[60:63],v[236:239]
M v[236:239],a[168:171],a[56:59],v[236:239]
M v[240:243],a[168:171],a[64:67],v[240:243]
M v[240:243],a[172:175],a[68:71],v[240:243]
M v[244:247],a[172:175],a[76:79],v[244:247]
M v[244:247],a[168:171],a[72:75],v[244:247]
M v[248:251],a[168:171],a[80:83],v[248:251]
M v[248:251],a[172:175],a[84:87],v[248:251]
s_waitcnt lgkmcnt(0)
M v[252:255],a[172:175],a[92:95],v[252:255]
M v[252:255],a[168:171],a[88:91],v[252:255]
M a[0:3],a[160:163],a[96:99],a[0:3]
R a[168:171],v5,2048
R a[172:175],v6,2048
M a[0:3],a[164:167],a[100:103],a[0:3]
T a[32:33],v1,32768
T a[34:35],v1,33792
M a[4:7],a[164:167],a[108:111],a[4:7]
SA m0,s24,49152
M a[4:7],a[160:163],a[104:107],a[4:7]
buffer_load_dwordx4 v12, s[48:51], s22 offen offset:0   lds
M a[8:11],a[160:163],a[112:115],a[8:11]
M a[8:11],a[164:167],a[116:119],a[8:11]
M a[12:15],a[164:167],a[124:127],a[12:15]
s_nop 0
T a[36:37],v1,40960
T a[38:39],v1,41984
M a[12:15],a[160:163],a[120:123],a[12:15]
M a[16:19],a[160:163],a[128:131],a[16:19]
buffer_load_dwordx4 v13, s[48:51], s22 offen offset:1024   lds
M a[16:19],a[164:167],a[132:135],a[16:19]
M a[20:23],a[164:167],a[140:143],a[20:23]
M a[20:23],a[160:163],a[136:139],a[20:23]
s_nop 0
T a[40:41],v2,32768
T a[42:43],v2,33792
M a[24:27],a[160:163],a[144:147],a[24:27]
M a[24:27],a[164:167],a[148:151],a[24:27]
s_waitcnt lgkmcnt(6)
buffer_load_dwordx4 v14, s[48:51], s22 offen offset:2048   lds
M a[28:31],a[164:167],a[156:159],a[28:31]
M a[28:31],a[160:163],a[152:155],a[28:31]
M v[32:35],a[168:171],a[96:99],v[32:35]
R a[160:163],v5,4096
R a[164:167],v6,4096
M v[32:35],a[172:175],a[100:103],v[32:35]
T a[44:45],v2,40960
T a[46:47],v2,41984
M v[36:39],a[172:175],a[108:111],v[36:39]
buffer_load_dwordx4 v15, s[48:51], s22 offen offset:3072   lds
M v[36:39],a[168:171],a[104:107],v[36:39]
s_sub_u32 s22, s22, 1048448
M v[40:43],a[168:171],a[112:115],v[40:43]
M v[40:43],a[172:175],a[116:119],v[40:43]
s_nop 0
T a[48:49],v3,32768
T a[50:51],v3,33792
M v[44:47],a[172:175],a[124:127],v[44:47]
SA m0,s23,16384
M v[44:47],a[168:171],a[120:123],v[44:47]
buffer_load_dwordx4 v8, s[16:19], s21 offen offset:0  nt lds
M v[48:51],a[168:171],a[128:131],v[48:51]
M v[48:51],a[172:175],a[132:135],v[48:51]
M v[52:55],a[172:175],a[140:143],v[52:55]
s_nop 0
T a[52:53],v3,40960
T a[54:55],v3,41984
M v[52:55],a[168:171],a[136:139],v[52:55]
M v[56:59],a[168:171],a[144:147],v[56:59]
buffer_load_dwordx4 v9, s[16:19], s21 offen offset:1024  nt lds
M v[56:59],a[172:175],a[148:151],v[56:59]
s_waitcnt lgkmcnt(6)
M v[60:63],a[172:175],a[156:159],v[60:63]
M v[60:63],a[168:171],a[152:155],v[60:63]
s_nop 0
T a[56:57],v4,32768
T a[58:59],v4,33792
M v[64:67],a[160:163],a[96:99],v[64:67]
R a[168:171],v5,6144
R a[172:175],v6,6144
M v[64:67],a[164:167],a[100:103],v[64:67]
buffer_load_dwordx4 v10, s[16:19], s21 offen offset:2048  nt lds
M v[68:71],a[164:167],a[108:111],v[68:71]
M v[68:71],a[160:163],a[104:107],v[68:71]
M v[72:75],a[160:163],a[112:115],v[72:75]
s_nop 0
T a[60:61],v4,40960
T a[62:63],v4,41984
M v[72:75],a[164:167],a[116:119],v[72:75]
M v[76:79],a[164:167],a[124:127],v[76:79]
buffer_load_dwordx4 v11, s[16:19], s21 offen offset:3072  nt lds
M v[76:79],a[160:163],a[120:123],v[76:79]
SA s21,s21,524160
M v[80:83],a[160:163],a[128:131],v[80:83]
M v[80:83],a[164:167],a[132:135],v[80:83]
M v[84:87],a[164:167],a[140:143],v[84:87]
M v[84:87],a[160:163],a[136:139],v[84:87]
M v[88:91],a[160:163],a[144:147],v[88:91]
M v[88:91],a[164:167],a[148:151],v[88:91]
s_waitcnt lgkmcnt(2)
M v[92:95],a[164:167],a[156:159],v[92:95]
s_waitcnt vmcnt(17) lgkmcnt(0)
M v[92:95],a[160:163],a[152:155],v[92:95]
s_barrier
M v[96:99],a[168:171],a[96:99],v[96:99]
R a[160:163],v5,16384
R a[164:167],v6,16384
M v[96:99],a[172:175],a[100:103],v[96:99]
M v[100:103],a[172:175],a[108:111],v[100:103]
SA m0,s24,0
T a[64:65],v1,49152
T a[66:67],v1,50176
M v[100:103],a[168:171],a[104:107],v[100:103]
buffer_load_dwordx4 v12, s[48:51], s22 offen offset:0   lds
M v[104:107],a[168:171],a[112:115],v[104:107]
M v[104:107],a[172:175],a[116:119],v[104:107]
M v[108:111],a[172:175],a[124:127],v[108:111]
M v[108:111],a[168:171],a[120:123],v[108:111]
M v[112:115],a[168:171],a[128:131],v[112:115]
M v[112:115],a[172:175],a[132:135],v[112:115]
s_nop 0
T a[68:69],v1,57344
T a[70:71],v1,58368
M v[116:119],a[172:175],a[140:143],v[116:119]
buffer_load_dwordx4 v13, s[48:51], s22 offen offset:1024   lds
M v[116:119],a[168:171],a[136:139],v[116:119]
M v[120:123],a[168:171],a[144:147],v[120:123]
M v[120:123],a[172:175],a[148:151],v[120:123]
s_waitcnt lgkmcnt(4)
M v[124:127],a[172:175],a[156:159],v[124:127]
M v[124:127],a[168:171],a[152:155],v[124:127]
L_w_kv14:
s_cbranch_execz L_w_kv18
M v[128:131],a[160:163],a[96:99],v[128:131]
R a[168:171],v5,18432
R a[172:175],v6,18432
M v[128:131],a[164:167],a[100:103],v[128:131]
T a[72:73],v2,49152
T a[74:75],v2,50176
M v[132:135],a[164:167],a[108:111],v[132:135]
buffer_load_dwordx4 v14, s[48:51], s22 offen offset:2048   lds
M v[132:135],a[160:163],a[104:107],v[132:135]
M v[136:139],a[160:163],a[112:115],v[136:139]
M v[136:139],a[164:167],a[116:119],v[136:139]
M v[140:143],a[164:167],a[124:127],v[140:143]
M v[140:143],a[160:163],a[120:123],v[140:143]
s_nop 0
T a[76:77],v2,57344
T a[78:79],v2,58368
M v[144:147],a[160:163],a[128:131],v[144:147]
buffer_load_dwordx4 v15, s[48:51], s22 offen offset:3072   lds
M v[144:147],a[164:167],a[132:135],v[144:147]
SA s22,s22,1048576
M v[148:151],a[164:167],a[140:143],v[148:151]
M v[148:151],a[160:163],a[136:139],v[148:151]
M v[152:155],a[160:163],a[144:147],v[152:155]
M v[152:155],a[164:167],a[148:151],v[152:155]
s_waitcnt lgkmcnt(4)
M v[156:159],a[164:167],a[156:159],v[156:159]
SA m0,s23,32768
T a[80:81],v3,49152
T a[82:83],v3,50176
M v[156:159],a[160:163],a[152:155],v[156:159]
buffer_load_dwordx4 v8, s[16:19], s21 offen offset:0  nt lds
M v[160:163],a[168:171],a[96:99],v[160:163]
R a[160:163],v5,20480
R a[164:167],v6,20480
M v[160:163],a[172:175],a[100:103],v[160:163]
M v[164:167],a[172:175],a[108:111],v[164:167]
M v[164:167],a[168:171],a[104:107],v[164:167]
M v[168:171],a[168:171],a[112:115],v[168:171]
M v[168:171],a[172:175],a[116:119],v[168:171]
s_nop 0
T a[84:85],v3,57344
T a[86:87],v3,58368
M v[172:175],a[172:175],a[124:127],v[172:175]
buffer_load_dwordx4 v9, s[16:19], s21 offen offset:1024  nt lds
M v[172:175],a[168:171],a[120:123],v[172:175]
M v[176:179],a[168:171],a[128:131],v[176:179]
M v[176:179],a[172:175],a[132:135],v[176:179]
M v[180:183],a[172:175],a[140:143],v[180:183]
M v[180:183],a[168:171],a[136:139],v[180:183]
M v[184:187],a[168:171],a[144:147],v[184:187]
s_nop 0
T a[88:89],v4,49152
T a[90:91],v4,50176
M v[184:187],a[172:175],a[148:151],v[184:187]
s_waitcnt lgkmcnt(4)
buffer_load_dwordx4 v10, s[16:19], s21 offen offset:2048  nt lds
M v[188:191],a[172:175],a[156:159],v[188:191]
M v[188:191],a[168:171],a[152:155],v[188:191]
M v[192:195],a[160:163],a[96:99],v[192:195]
R a[168:171],v5,22528
R a[172:175],v6,22528
M v[192:195],a[164:167],a[100:103],v[192:195]
M v[196:199],a[164:167],a[108:111],v[196:199]
M v[196:199],a[160:163],a[104:107],v[196:199]
s_nop 0
T a[92:93],v4,57344
T a[94:95],v4,58368
M v[200:203],a[160:163],a[112:115],v[200:203]
buffer_load_dwordx4 v11, s[16:19], s21 offen offset:3072  nt lds
M v[200:203],a[164:167],a[116:119],v[200:203]
SA s21,s21,128
M v[204:207],a[164:167],a[124:127],v[204:207]
M v[204:207],a[160:163],a[120:123],v[204:207]
M v[208:211],a[160:163],a[128:131],v[208:211]
M v[208:211],a[164:167],a[132:135],v[208:211]
M v[212:215],a[164:167],a[140:143],v[212:215]
M v[212:215],a[160:163],a[136:139],v[212:215]
M v[216:219],a[160:163],a[144:147],v[216:219]
M v[216:219],a[164:167],a[148:151],v[216:219]
s_waitcnt lgkmcnt(2)
M v[220:223],a[164:167],a[156:159],v[220:223]
s_waitcnt vmcnt(17) lgkmcnt(0)
M v[220:223],a[160:163],a[152:155],v[220:223]
s_barrier
M v[224:227],a[168:171],a[96:99],v[224:227]
R a[160:163],v5,32768
R a[164:167],v6,32768
M v[224:227],a[172:175],a[100:103],v[224:227]
buffer_load_dword a240, v23, s[52:55], 0 offen offset:0
M v[228:231],a[172:175],a[108:111],v[228:231]
v_add_u32 v23, 32768, v23
M v[228:231],a[168:171],a[104:107],v[228:231]
M v[232:235],a[168:171],a[112:115],v[232:235]
M v[232:235],a[172:175],a[116:119],v[232:235]
M v[236:239],a[172:175],a[124:127],v[236:239]
M v[236:239],a[168:171],a[120:123],v[236:239]
M v[240:243],a[168:171],a[128:131],v[240:243]
M v[240:243],a[172:175],a[132:135],v[240:243]
M v[244:247],a[172:175],a[140:143],v[244:247]
M v[244:247],a[168:171],a[136:139],v[244:247]
M v[248:251],a[168:171],a[144:147],v[248:251]
M v[248:251],a[172:175],a[148:151],v[248:251]
s_waitcnt lgkmcnt(0)
M v[252:255],a[172:175],a[156:159],v[252:255]
M v[252:255],a[168:171],a[152:155],v[252:255]
M a[0:3],a[160:163],a[32:35],a[0:3]
R a[168:171],v5,34816
R a[172:175],v6,34816
M a[0:3],a[164:167],a[36:39],a[0:3]
T a[96:97],v1,0
T a[98:99],v1,1024
M a[4:7],a[164:167],a[44:47],a[4:7]
SA m0,s24,16384
M a[4:7],a[160:163],a[40:43],a[4:7]
buffer_load_dwordx4 v12, s[48:51], s22 offen offset:0   lds
M a[8:11],a[160:163],a[48:51],a[8:11]
M a[8:11],a[164:167],a[52:55],a[8:11]
M a[12:15],a[164:167],a[60:63],a[12:15]
s_nop 0
T a[100:101],v1,8192
T a[102:103],v1,9216
M a[12:15],a[160:163],a[56:59],a[12:15]
M a[16:19],a[160:163],a[64:67],a[16:19]
buffer_load_dwordx4 v13, s[48:51], s22 offen offset:1024   lds
M a[16:19],a[164:167],a[68:71],a[16:19]
M a[20:23],a[164:167],a[76:79],a[20:23]
M a[20:23],a[160:163],a[72:75],a[20:23]
s_nop 0
T a[104:105],v2,0
T a[106:107],v2,1024
M a[24:27],a[160:163],a[80:83],a[24:27]
M a[24:27],a[164:167],a[84:87],a[24:27]
s_waitcnt lgkmcnt(6)
buffer_load_dwordx4 v14, s[48:51], s22 offen offset:2048   lds
M a[28:31],a[164:167],a[92:95],a[28:31]
M a[28:31],a[160:163],a[88:91],a[28:31]
M v[32:35],a[168:171],a[32:35],v[32:35]
R a[160:163],v5,36864
R a[164:167],v6,36864
M v[32:35],a[172:175],a[36:39],v[32:35]
T a[108:109],v2,8192
T a[110:111],v2,9216
M v[36:39],a[172:175],a[44:47],v[36:39]
buffer_load_dwordx4 v15, s[48:51], s22 offen offset:3072   lds
M v[36:39],a[168:171],a[40:43],v[36:39]
s_sub_u32 s22, s22, 1048448
M v[40:43],a[168:171],a[48:51],v[40:43]
M v[40:43],a[172:175],a[52:55],v[40:43]
s_nop 0
T a[112:113],v3,0
T a[114:115],v3,1024
M v[44:47],a[172:175],a[60:63],v[44:47]
SA m0,s23,49152
M v[44:47],a[168:171],a[56:59],v[44:47]
buffer_load_dwordx4 v8, s[16:19], s21 offen offset:0  nt lds
M v[48:51],a[168:171],a[64:67],v[48:51]
M v[48:51],a[172:175],a[68:71],v[48:51]
M v[52:55],a[172:175],a[76:79],v[52:55]
s_nop 0
T a[116:117],v3,8192
T a[118:119],v3,9216
M v[52:55],a[168:171],a[72:75],v[52:55]
M v[56:59],a[168:171],a[80:83],v[56:59]
buffer_load_dwordx4 v9, s[16:19], s21 offen offset:1024  nt lds
M v[56:59],a[172:175],a[84:87],v[56:59]
s_waitcnt lgkmcnt(6)
M v[60:63],a[172:175],a[92:95],v[60:63]
M v[60:63],a[168:171],a[88:91],v[60:63]
s_nop 0
T a[120:121],v4,0
T a[122:123],v4,1024
M v[64:67],a[160:163],a[32:35],v[64:67]
R a[168:171],v5,38912
R a[172:175],v6,38912
M v[64:67],a[164:167],a[36:39],v[64:67]
buffer_load_dwordx4 v10, s[16:19], s21 offen offset:2048  nt lds
M v[68:71],a[164:167],a[44:47],v[68:71]
M v[68:71],a[160:163],a[40:43],v[68:71]
M v[72:75],a[160:163],a[48:51],v[72:75]
s_nop 0
T a[124:125],v4,8192
T a[126:127],v4,9216
M v[72:75],a[164:167],a[52:55],v[72:75]
M v[76:79],a[164:167],a[60:63],v[76:79]
buffer_load_dwordx4 v11, s[16:19], s21 offen offset:3072  nt lds
M v[76:79],a[160:163],a[56:59],v[76:79]
SA s21,s21,524160
M v[80:83],a[160:163],a[64:67],v[80:83]
M v[80:83],a[164:167],a[68:71],v[80:83]
M v[84:87],a[164:167],a[76:79],v[84:87]
M v[84:87],a[160:163],a[72:75],v[84:87]
M v[88:91],a[160:163],a[80:83],v[88:91]
M v[88:91],a[164:167],a[84:87],v[88:91]
s_waitcnt lgkmcnt(2)
M v[92:95],a[164:167],a[92:95],v[92:95]
s_waitcnt vmcnt(17) lgkmcnt(0)
M v[92:95],a[160:163],a[88:91],v[92:95]
s_barrier
M v[96:99],a[168:171],a[32:35],v[96:99]
R a[160:163],v5,49152
R a[164:167],v6,49152
M v[96:99],a[172:175],a[36:39],v[96:99]
M v[100:103],a[172:175],a[44:47],v[100:103]
SA m0,s24,32768
T a[128:129],v1,16384
T a[130:131],v1,17408
M v[100:103],a[168:171],a[40:43],v[100:103]
buffer_load_dwordx4 v12, s[48:51], s22 offen offset:0   lds
M v[104:107],a[168:171],a[48:51],v[104:107]
M v[104:107],a[172:175],a[52:55],v[104:107]
M v[108:111],a[172:175],a[60:63],v[108:111]
M v[108:111],a[168:171],a[56:59],v[108:111]
M v[112:115],a[168:171],a[64:67],v[112:115]
M v[112:115],a[172:175],a[68:71],v[112:115]
s_nop 0
T a[132:133],v1,24576
T a[134:135],v1,25600
M v[116:119],a[172:175],a[76:79],v[116:119]
buffer_load_dwordx4 v13, s[48:51], s22 offen offset:1024   lds
M v[116:119],a[168:171],a[72:75],v[116:119]
M v[120:123],a[168:171],a[80:83],v[120:123]
M v[120:123],a[172:175],a[84:87],v[120:123]
s_waitcnt lgkmcnt(4)
M v[124:127],a[172:175],a[92:95],v[124:127]
M v[124:127],a[168:171],a[88:91],v[124:127]
M v[128:131],a[160:163],a[32:35],v[128:131]
R a[168:171],v5,51200
R a[172:175],v6,51200
M v[128:131],a[164:167],a[36:39],v[128:131]
T a[136:137],v2,16384
T a[138:139],v2,17408
M v[132:135],a[164:167],a[44:47],v[132:135]
buffer_load_dwordx4 v14, s[48:51], s22 offen offset:2048   lds
M v[132:135],a[160:163],a[40:43],v[132:135]
M v[136:139],a[160:163],a[48:51],v[136:139]
M v[136:139],a[164:167],a[52:55],v[136:139]
M v[140:143],a[164:167],a[60:63],v[140:143]
M v[140:143],a[160:163],a[56:59],v[140:143]
s_nop 0
T a[140:141],v2,24576
T a[142:143],v2,25600
M v[144:147],a[160:163],a[64:67],v[144:147]
buffer_load_dwordx4 v15, s[48:51], s22 offen offset:3072   lds
M v[144:147],a[164:167],a[68:71],v[144:147]
SA s22,s22,1048576
M v[148:151],a[164:167],a[76:79],v[148:151]
M v[148:151],a[160:163],a[72:75],v[148:151]
M v[152:155],a[160:163],a[80:83],v[152:155]
M v[152:155],a[164:167],a[84:87],v[152:155]
s_waitcnt lgkmcnt(4)
M v[156:159],a[164:167],a[92:95],v[156:159]
SA m0,s23,0
T a[144:145],v3,16384
T a[146:147],v3,17408
M v[156:159],a[160:163],a[88:91],v[156:159]
buffer_load_dwordx4 v8, s[16:19], s21 offen offset:0  nt lds
M v[160:163],a[168:171],a[32:35],v[160:163]
R a[160:163],v5,53248
R a[164:167],v6,53248
M v[160:163],a[172:175],a[36:39],v[160:163]
M v[164:167],a[172:175],a[44:47],v[164:167]
M v[164:167],a[168:171],a[40:43],v[164:167]
M v[168:171],a[168:171],a[48:51],v[168:171]
M v[168:171],a[172:175],a[52:55],v[168:171]
s_nop 0
T a[148:149],v3,24576
T a[150:151],v3,25600
M v[172:175],a[172:175],a[60:63],v[172:175]
buffer_load_dwordx4 v9, s[16:19], s21 offen offset:1024  nt lds
M v[172:175],a[168:171],a[56:59],v[172:175]
M v[176:179],a[168:171],a[64:67],v[176:179]
M v[176:179],a[172:175],a[68:71],v[176:179]
M v[180:183],a[172:175],a[76:79],v[180:183]
M v[180:183],a[168:171],a[72:75],v[180:183]
M v[184:187],a[168:171],a[80:83],v[184:187]
s_nop 0
T a[152:153],v4,16384
T a[154:155],v4,17408
M v[184:187],a[172:175],a[84:87],v[184:187]
s_waitcnt lgkmcnt(4)
buffer_load_dwordx4 v10, s[16:19], s21 offen offset:2048  nt lds
M v[188:191],a[172:175],a[92:95],v[188:191]
M v[188:191],a[168:171],a[88:91],v[188:191]
M v[192:195],a[160:163],a[32:35],v[192:195]
R a[168:171],v5,55296
R a[172:175],v6,55296
M v[192:195],a[164:167],a[36:39],v[192:195]
M v[196:199],a[164:167],a[44:47],v[196:199]
M v[196:199],a[160:163],a[40:43],v[196:199]
s_nop 0
T a[156:157],v4,24576
T a[158:159],v4,25600
M v[200:203],a[160:163],a[48:51],v[200:203]
buffer_load_dwordx4 v11, s[16:19], s21 offen offset:3072  nt lds
M v[200:203],a[164:167],a[52:55],v[200:203]
SA s21,s21,128
M v[204:207],a[164:167],a[60:63],v[204:207]
M v[204:207],a[160:163],a[56:59],v[204:207]
M v[208:211],a[160:163],a[64:67],v[208:211]
M v[208:211],a[164:167],a[68:71],v[208:211]
M v[212:215],a[164:167],a[76:79],v[212:215]
M v[212:215],a[160:163],a[72:75],v[212:215]
M v[216:219],a[160:163],a[80:83],v[216:219]
M v[216:219],a[164:167],a[84:87],v[216:219]
s_waitcnt lgkmcnt(2)
M v[220:223],a[164:167],a[92:95],v[220:223]
s_waitcnt vmcnt(17) lgkmcnt(0)
M v[220:223],a[160:163],a[88:91],v[220:223]
s_barrier
M v[224:227],a[168:171],a[32:35],v[224:227]
R a[160:163],v5,0
R a[164:167],v6,0
M v[224:227],a[172:175],a[36:39],v[224:227]
buffer_load_dword a240, v23, s[52:55], 0 offen offset:0
M v[228:231],a[172:175],a[44:47],v[228:231]
v_add_u32 v23, 16384, v23
M v[228:231],a[168:171],a[40:43],v[228:231]
M v[232:235],a[168:171],a[48:51],v[232:235]
M v[232:235],a[172:175],a[52:55],v[232:235]
M v[236:239],a[172:175],a[60:63],v[236:239]
M v[236:239],a[168:171],a[56:59],v[236:239]
M v[240:243],a[168:171],a[64:67],v[240:243]
M v[240:243],a[172:175],a[68:71],v[240:243]
M v[244:247],a[172:175],a[76:79],v[244:247]
M v[244:247],a[168:171],a[72:75],v[244:247]
M v[248:251],a[168:171],a[80:83],v[248:251]
M v[248:251],a[172:175],a[84:87],v[248:251]
s_waitcnt lgkmcnt(0)
M v[252:255],a[172:175],a[92:95],v[252:255]
M v[252:255],a[168:171],a[88:91],v[252:255]
M a[0:3],a[160:163],a[96:99],a[0:3]
R a[168:171],v5,2048
R a[172:175],v6,2048
M a[0:3],a[164:167],a[100:103],a[0:3]
T a[32:33],v1,32768
T a[34:35],v1,33792
M a[4:7],a[164:167],a[108:111],a[4:7]
SA m0,s24,49152
M a[4:7],a[160:163],a[104:107],a[4:7]
buffer_load_dwordx4 v12, s[48:51], s22 offen offset:0   lds
M a[8:11],a[160:163],a[112:115],a[8:11]
M a[8:11],a[164:167],a[116:119],a[8:11]
M a[12:15],a[164:167],a[124:127],a[12:15]
s_nop 0
T a[36:37],v1,40960
T a[38:39],v1,41984
M a[12:15],a[160:163],a[120:123],a[12:15]
M a[16:19],a[160:163],a[128:131],a[16:19]
buffer_load_dwordx4 v13, s[48:51], s22 offen offset:1024   lds
M a[16:19],a[164:167],a[132:135],a[16:19]
M a[20:23],a[164:167],a[140:143],a[20:23]
M a[20:23],a[160:163],a[136:139],a[20:23]
s_nop 0
T a[40:41],v2,32768
T a[42:43],v2,33792
M a[24:27],a[160:163],a[144:147],a[24:27]
M a[24:27],a[164:167],a[148:151],a[24:27]
s_waitcnt lgkmcnt(6)
buffer_load_dwordx4 v14, s[48:51], s22 offen offset:2048   lds
M a[28:31],a[164:167],a[156:159],a[28:31]
M a[28:31],a[160:163],a[152:155],a[28:31]
M v[32:35],a[168:171],a[96:99],v[32:35]
R a[160:163],v5,4096
R a[164:167],v6,4096
M v[32:35],a[172:175],a[100:103],v[32:35]
T a[44:45],v2,40960
T a[46:47],v2,41984
M v[36:39],a[172:175],a[108:111],v[36:39]
buffer_load_dwordx4 v15, s[48:51], s22 offen offset:3072   lds
M v[36:39],a[168:171],a[104:107],v[36:39]
s_sub_u32 s22, s22, 1048448
M v[40:43],a[168:171],a[112:115],v[40:43]
M v[40:43],a[172:175],a[116:119],v[40:43]
s_nop 0
T a[48:49],v3,32768
T a[50:51],v3,33792
M v[44:47],a[172:175],a[124:127],v[44:47]
SA m0,s23,16384
M v[44:47],a[168:171],a[120:123],v[44:47]
buffer_load_dwordx4 v8, s[16:19], s21 offen offset:0  nt lds
M v[48:51],a[168:171],a[128:131],v[48:51]
M v[48:51],a[172:175],a[132:135],v[48:51]
M v[52:55],a[172:175],a[140:143],v[52:55]
s_nop 0
T a[52:53],v3,40960
T a[54:55],v3,41984
M v[52:55],a[168:171],a[136:139],v[52:55]
M v[56:59],a[168:171],a[144:147],v[56:59]
buffer_load_dwordx4 v9, s[16:19], s21 offen offset:1024  nt lds
M v[56:59],a[172:175],a[148:151],v[56:59]
s_waitcnt lgkmcnt(6)
M v[60:63],a[172:175],a[156:159],v[60:63]
M v[60:63],a[168:171],a[152:155],v[60:63]
s_nop 0
T a[56:57],v4,32768
T a[58:59],v4,33792
M v[64:67],a[160:163],a[96:99],v[64:67]
R a[168:171],v5,6144
R a[172:175],v6,6144
M v[64:67],a[164:167],a[100:103],v[64:67]
buffer_load_dwordx4 v10, s[16:19], s21 offen offset:2048  nt lds
M v[68:71],a[164:167],a[108:111],v[68:71]
M v[68:71],a[160:163],a[104:107],v[68:71]
M v[72:75],a[160:163],a[112:115],v[72:75]
s_nop 0
T a[60:61],v4,40960
T a[62:63],v4,41984
M v[72:75],a[164:167],a[116:119],v[72:75]
M v[76:79],a[164:167],a[124:127],v[76:79]
buffer_load_dwordx4 v11, s[16:19], s21 offen offset:3072  nt lds
M v[76:79],a[160:163],a[120:123],v[76:79]
SA s21,s21,524160
M v[80:83],a[160:163],a[128:131],v[80:83]
M v[80:83],a[164:167],a[132:135],v[80:83]
M v[84:87],a[164:167],a[140:143],v[84:87]
M v[84:87],a[160:163],a[136:139],v[84:87]
M v[88:91],a[160:163],a[144:147],v[88:91]
M v[88:91],a[164:167],a[148:151],v[88:91]
s_waitcnt lgkmcnt(2)
M v[92:95],a[164:167],a[156:159],v[92:95]
s_waitcnt vmcnt(17) lgkmcnt(0)
M v[92:95],a[160:163],a[152:155],v[92:95]
s_barrier
M v[96:99],a[168:171],a[96:99],v[96:99]
R a[160:163],v5,16384
R a[164:167],v6,16384
M v[96:99],a[172:175],a[100:103],v[96:99]
M v[100:103],a[172:175],a[108:111],v[100:103]
SA m0,s24,0
T a[64:65],v1,49152
T a[66:67],v1,50176
M v[100:103],a[168:171],a[104:107],v[100:103]
buffer_load_dwordx4 v12, s[48:51], s22 offen offset:0   lds
M v[104:107],a[168:171],a[112:115],v[104:107]
M v[104:107],a[172:175],a[116:119],v[104:107]
M v[108:111],a[172:175],a[124:127],v[108:111]
M v[108:111],a[168:171],a[120:123],v[108:111]
M v[112:115],a[168:171],a[128:131],v[112:115]
M v[112:115],a[172:175],a[132:135],v[112:115]
s_nop 0
T a[68:69],v1,57344
T a[70:71],v1,58368
M v[116:119],a[172:175],a[140:143],v[116:119]
buffer_load_dwordx4 v13, s[48:51], s22 offen offset:1024   lds
M v[116:119],a[168:171],a[136:139],v[116:119]
M v[120:123],a[168:171],a[144:147],v[120:123]
M v[120:123],a[172:175],a[148:151],v[120:123]
s_waitcnt lgkmcnt(4)
M v[124:127],a[172:175],a[156:159],v[124:127]
M v[124:127],a[168:171],a[152:155],v[124:127]
M v[128:131],a[160:163],a[96:99],v[128:131]
R a[168:171],v5,18432
R a[172:175],v6,18432
M v[128:131],a[164:167],a[100:103],v[128:131]
T a[72:73],v2,49152
T a[74:75],v2,50176
M v[132:135],a[164:167],a[108:111],v[132:135]
buffer_load_dwordx4 v14, s[48:51], s22 offen offset:2048   lds
M v[132:135],a[160:163],a[104:107],v[132:135]
M v[136:139],a[160:163],a[112:115],v[136:139]
M v[136:139],a[164:167],a[116:119],v[136:139]
M v[140:143],a[164:167],a[124:127],v[140:143]
M v[140:143],a[160:163],a[120:123],v[140:143]
s_nop 0
T a[76:77],v2,57344
T a[78:79],v2,58368
M v[144:147],a[160:163],a[128:131],v[144:147]
buffer_load_dwordx4 v15, s[48:51], s22 offen offset:3072   lds
M v[144:147],a[164:167],a[132:135],v[144:147]
SA s22,s22,1048576
M v[148:151],a[164:167],a[140:143],v[148:151]
M v[148:151],a[160:163],a[136:139],v[148:151]
M v[152:155],a[160:163],a[144:147],v[152:155]
M v[152:155],a[164:167],a[148:151],v[152:155]
s_waitcnt lgkmcnt(4)
M v[156:159],a[164:167],a[156:159],v[156:159]
SA m0,s23,32768
T a[80:81],v3,49152
T a[82:83],v3,50176
M v[156:159],a[160:163],a[152:155],v[156:159]
buffer_load_dwordx4 v8, s[16:19], s21 offen offset:0  nt lds
M v[160:163],a[168:171],a[96:99],v[160:163]
R a[160:163],v5,20480
R a[164:167],v6,20480
M v[160:163],a[172:175],a[100:103],v[160:163]
M v[164:167],a[172:175],a[108:111],v[164:167]
M v[164:167],a[168:171],a[104:107],v[164:167]
M v[168:171],a[168:171],a[112:115],v[168:171]
M v[168:171],a[172:175],a[116:119],v[168:171]
s_nop 0
T a[84:85],v3,57344
T a[86:87],v3,58368
M v[172:175],a[172:175],a[124:127],v[172:175]
buffer_load_dwordx4 v9, s[16:19], s21 offen offset:1024  nt lds
M v[172:175],a[168:171],a[120:123],v[172:175]
M v[176:179],a[168:171],a[128:131],v[176:179]
M v[176:179],a[172:175],a[132:135],v[176:179]
M v[180:183],a[172:175],a[140:143],v[180:183]
M v[180:183],a[168:171],a[136:139],v[180:183]
M v[184:187],a[168:171],a[144:147],v[184:187]
s_nop 0
T a[88:89],v4,49152
T a[90:91],v4,50176
M v[184:187],a[172:175],a[148:151],v[184:187]
s_waitcnt lgkmcnt(4)
buffer_load_dwordx4 v10, s[16:19], s21 offen offset:2048  nt lds
M v[188:191],a[172:175],a[156:159],v[188:191]
M v[188:191],a[168:171],a[152:155],v[188:191]
M v[192:195],a[160:163],a[96:99],v[192:195]
R a[168:171],v5,22528
R a[172:175],v6,22528
M v[192:195],a[164:167],a[100:103],v[192:195]
M v[196:199],a[164:167],a[108:111],v[196:199]
M v[196:199],a[160:163],a[104:107],v[196:199]
s_nop 0
T a[92:93],v4,57344
T a[94:95],v4,58368
M v[200:203],a[160:163],a[112:115],v[200:203]
buffer_load_dwordx4 v11, s[16:19], s21 offen offset:3072  nt lds
M v[200:203],a[164:167],a[116:119],v[200:203]
SA s21,s21,128
M v[204:207],a[164:167],a[124:127],v[204:207]
M v[204:207],a[160:163],a[120:123],v[204:207]
M v[208:211],a[160:163],a[128:131],v[208:211]
M v[208:211],a[164:167],a[132:135],v[208:211]
M v[212:215],a[164:167],a[140:143],v[212:215]
M v[212:215],a[160:163],a[136:139],v[212:215]
M v[216:219],a[160:163],a[144:147],v[216:219]
M v[216:219],a[164:167],a[148:151],v[216:219]
s_waitcnt lgkmcnt(2)
M v[220:223],a[164:167],a[156:159],v[220:223]
s_waitcnt vmcnt(17) lgkmcnt(0)
M v[220:223],a[160:163],a[152:155],v[220:223]
s_barrier
M v[224:227],a[168:171],a[96:99],v[224:227]
R a[160:163],v5,32768
R a[164:167],v6,32768
M v[224:227],a[172:175],a[100:103],v[224:227]
buffer_load_dword a240, v23, s[52:55], 0 offen offset:0
M v[228:231],a[172:175],a[108:111],v[228:231]
L_w_kv15:
s_cbranch_execz L_wd2
v_add_u32 v23, 16384, v23
M v[228:231],a[168:171],a[104:107],v[228:231]
M v[232:235],a[168:171],a[112:115],v[232:235]
M v[232:235],a[172:175],a[116:119],v[232:235]
M v[236:239],a[172:175],a[124:127],v[236:239]
M v[236:239],a[168:171],a[120:123],v[236:239]
M v[240:243],a[168:171],a[128:131],v[240:243]
M v[240:243],a[172:175],a[132:135],v[240:243]
M v[244:247],a[172:175],a[140:143],v[244:247]
M v[244:247],a[168:171],a[136:139],v[244:247]
M v[248:251],a[168:171],a[144:147],v[248:251]
M v[248:251],a[172:175],a[148:151],v[248:251]
s_waitcnt lgkmcnt(0)
M v[252:255],a[172:175],a[156:159],v[252:255]
M v[252:255],a[168:171],a[152:155],v[252:255]
M a[0:3],a[160:163],a[32:35],a[0:3]
R a[168:171],v5,34816
R a[172:175],v6,34816
M a[0:3],a[164:167],a[36:39],a[0:3]
T a[96:97],v1,0
T a[98:99],v1,1024
M a[4:7],a[164:167],a[44:47],a[4:7]
SA m0,s24,16384
M a[4:7],a[160:163],a[40:43],a[4:7]
buffer_load_dwordx4 v12, s[48:51], s22 offen offset:0   lds
M a[8:11],a[160:163],a[48:51],a[8:11]
M a[8:11],a[164:167],a[52:55],a[8:11]
M a[12:15],a[164:167],a[60:63],a[12:15]
s_nop 0
T a[100:101],v1,8192
T a[102:103],v1,9216
M a[12:15],a[160:163],a[56:59],a[12:15]
M a[16:19],a[160:163],a[64:67],a[16:19]
buffer_load_dwordx4 v13, s[48:51], s22 offen offset:1024   lds
M a[16:19],a[164:167],a[68:71],a[16:19]
M a[20:23],a[164:167],a[76:79],a[20:23]
M a[20:23],a[160:163],a[72:75],a[20:23]
s_nop 0
T a[104:105],v2,0
T a[106:107],v2,1024
M a[24:27],a[160:163],a[80:83],a[24:27]
M a[24:27],a[164:167],a[84:87],a[24:27]
s_waitcnt lgkmcnt(6)
buffer_load_dwordx4 v14, s[48:51], s22 offen offset:2048   lds
M a[28:31],a[164:167],a[92:95],a[28:31]
M a[28:31],a[160:163],a[88:91],a[28:31]
M v[32:35],a[168:171],a[32:35],v[32:35]
R a[160:163],v5,36864
R a[164:167],v6,36864
M v[32:35],a[172:175],a[36:39],v[32:35]
T a[108:109],v2,8192
T a[110:111],v2,9216
M v[36:39],a[172:175],a[44:47],v[36:39]
buffer_load_dwordx4 v15, s[48:51], s22 offen offset:3072   lds
M v[36:39],a[168:171],a[40:43],v[36:39]
s_sub_u32 s22, s22, 1048448
M v[40:43],a[168:171],a[48:51],v[40:43]
M v[40:43],a[172:175],a[52:55],v[40:43]
s_nop 0
T a[112:113],v3,0
T a[114:115],v3,1024
M v[44:47],a[172:175],a[60:63],v[44:47]
SA m0,s23,49152
M v[44:47],a[168:171],a[56:59],v[44:47]
buffer_load_dwordx4 v8, s[16:19], s21 offen offset:0  nt lds
M v[48:51],a[168:171],a[64:67],v[48:51]
M v[48:51],a[172:175],a[68:71],v[48:51]
M v[52:55],a[172:175],a[76:79],v[52:55]
s_nop 0
T a[116:117],v3,8192
T a[118:119],v3,9216
M v[52:55],a[168:171],a[72:75],v[52:55]
M v[56:59],a[168:171],a[80:83],v[56:59]
buffer_load_dwordx4 v9, s[16:19], s21 offen offset:1024  nt lds
M v[56:59],a[172:175],a[84:87],v[56:59]
s_waitcnt lgkmcnt(6)
M v[60:63],a[172:175],a[92:95],v[60:63]
M v[60:63],a[168:171],a[88:91],v[60:63]
s_nop 0
T a[120:121],v4,0
T a[122:123],v4,1024
M v[64:67],a[160:163],a[32:35],v[64:67]
R a[168:171],v5,38912
R a[172:175],v6,38912
M v[64:67],a[164:167],a[36:39],v[64:67]
buffer_load_dwordx4 v10, s[16:19], s21 offen offset:2048  nt lds
M v[68:71],a[164:167],a[44:47],v[68:71]
M v[68:71],a[160:163],a[40:43],v[68:71]
M v[72:75],a[160:163],a[48:51],v[72:75]
s_nop 0
T a[124:125],v4,8192
T a[126:127],v4,9216
M v[72:75],a[164:167],a[52:55],v[72:75]
M v[76:79],a[164:167],a[60:63],v[76:79]
buffer_load_dwordx4 v11, s[16:19], s21 offen offset:3072  nt lds
M v[76:79],a[160:163],a[56:59],v[76:79]
SA s21,s21,524160
M v[80:83],a[160:163],a[64:67],v[80:83]
M v[80:83],a[164:167],a[68:71],v[80:83]
M v[84:87],a[164:167],a[76:79],v[84:87]
M v[84:87],a[160:163],a[72:75],v[84:87]
M v[88:91],a[160:163],a[80:83],v[88:91]
M v[88:91],a[164:167],a[84:87],v[88:91]
s_waitcnt lgkmcnt(2)
M v[92:95],a[164:167],a[92:95],v[92:95]
s_waitcnt vmcnt(17) lgkmcnt(0)
M v[92:95],a[160:163],a[88:91],v[92:95]
s_barrier
M v[96:99],a[168:171],a[32:35],v[96:99]
R a[160:163],v5,49152
R a[164:167],v6,49152
M v[96:99],a[172:175],a[36:39],v[96:99]
M v[100:103],a[172:175],a[44:47],v[100:103]
SA m0,s24,32768
T a[128:129],v1,16384
T a[130:131],v1,17408
M v[100:103],a[168:171],a[40:43],v[100:103]
buffer_load_dwordx4 v12, s[48:51], s22 offen offset:0   lds
M v[104:107],a[168:171],a[48:51],v[104:107]
M v[104:107],a[172:175],a[52:55],v[104:107]
M v[108:111],a[172:175],a[60:63],v[108:111]
M v[108:111],a[168:171],a[56:59],v[108:111]
M v[112:115],a[168:171],a[64:67],v[112:115]
M v[112:115],a[172:175],a[68:71],v[112:115]
s_nop 0
T a[132:133],v1,24576
T a[134:135],v1,25600
M v[116:119],a[172:175],a[76:79],v[116:119]
buffer_load_dwordx4 v13, s[48:51], s22 offen offset:1024   lds
M v[116:119],a[168:171],a[72:75],v[116:119]
M v[120:123],a[168:171],a[80:83],v[120:123]
M v[120:123],a[172:175],a[84:87],v[120:123]
s_waitcnt lgkmcnt(4)
M v[124:127],a[172:175],a[92:95],v[124:127]
M v[124:127],a[168:171],a[88:91],v[124:127]
M v[128:131],a[160:163],a[32:35],v[128:131]
R a[168:171],v5,51200
R a[172:175],v6,51200
M v[128:131],a[164:167],a[36:39],v[128:131]
T a[136:137],v2,16384
T a[138:139],v2,17408
M v[132:135],a[164:167],a[44:47],v[132:135]
buffer_load_dwordx4 v14, s[48:51], s22 offen offset:2048   lds
M v[132:135],a[160:163],a[40:43],v[132:135]
M v[136:139],a[160:163],a[48:51],v[136:139]
M v[136:139],a[164:167],a[52:55],v[136:139]
M v[140:143],a[164:167],a[60:63],v[140:143]
M v[140:143],a[160:163],a[56:59],v[140:143]
s_nop 0
T a[140:141],v2,24576
T a[142:143],v2,25600
M v[144:147],a[160:163],a[64:67],v[144:147]
buffer_load_dwordx4 v15, s[48:51], s22 offen offset:3072   lds
M v[144:147],a[164:167],a[68:71],v[144:147]
SA s22,s22,1048576
M v[148:151],a[164:167],a[76:79],v[148:151]
M v[148:151],a[160:163],a[72:75],v[148:151]
M v[152:155],a[160:163],a[80:83],v[152:155]
M v[152:155],a[164:167],a[84:87],v[152:155]
s_waitcnt lgkmcnt(4)
M v[156:159],a[164:167],a[92:95],v[156:159]
SA m0,s23,0
T a[144:145],v3,16384
T a[146:147],v3,17408
M v[156:159],a[160:163],a[88:91],v[156:159]
buffer_load_dwordx4 v8, s[16:19], s21 offen offset:0  nt lds
M v[160:163],a[168:171],a[32:35],v[160:163]
R a[160:163],v5,53248
R a[164:167],v6,53248
M v[160:163],a[172:175],a[36:39],v[160:163]
M v[164:167],a[172:175],a[44:47],v[164:167]
M v[164:167],a[168:171],a[40:43],v[164:167]
M v[168:171],a[168:171],a[48:51],v[168:171]
M v[168:171],a[172:175],a[52:55],v[168:171]
s_nop 0
T a[148:149],v3,24576
T a[150:151],v3,25600
M v[172:175],a[172:175],a[60:63],v[172:175]
buffer_load_dwordx4 v9, s[16:19], s21 offen offset:1024  nt lds
M v[172:175],a[168:171],a[56:59],v[172:175]
M v[176:179],a[168:171],a[64:67],v[176:179]
M v[176:179],a[172:175],a[68:71],v[176:179]
M v[180:183],a[172:175],a[76:79],v[180:183]
M v[180:183],a[168:171],a[72:75],v[180:183]
M v[184:187],a[168:171],a[80:83],v[184:187]
s_nop 0
T a[152:153],v4,16384
T a[154:155],v4,17408
M v[184:187],a[172:175],a[84:87],v[184:187]
s_waitcnt lgkmcnt(4)
buffer_load_dwordx4 v10, s[16:19], s21 offen offset:2048  nt lds
M v[188:191],a[172:175],a[92:95],v[188:191]
M v[188:191],a[168:171],a[88:91],v[188:191]
M v[192:195],a[160:163],a[32:35],v[192:195]
R a[168:171],v5,55296
R a[172:175],v6,55296
M v[192:195],a[164:167],a[36:39],v[192:195]
M v[196:199],a[164:167],a[44:47],v[196:199]
M v[196:199],a[160:163],a[40:43],v[196:199]
s_nop 0
T a[156:157],v4,24576
T a[158:159],v4,25600
M v[200:203],a[160:163],a[48:51],v[200:203]
buffer_load_dwordx4 v11, s[16:19], s21 offen offset:3072  nt lds
M v[200:203],a[164:167],a[52:55],v[200:203]
SA s21,s21,128
M v[204:207],a[164:167],a[60:63],v[204:207]
M v[204:207],a[160:163],a[56:59],v[204:207]
M v[208:211],a[160:163],a[64:67],v[208:211]
M v[208:211],a[164:167],a[68:71],v[208:211]
M v[212:215],a[164:167],a[76:79],v[212:215]
M v[212:215],a[160:163],a[72:75],v[212:215]
M v[216:219],a[160:163],a[80:83],v[216:219]
M v[216:219],a[164:167],a[84:87],v[216:219]
s_waitcnt lgkmcnt(2)
M v[220:223],a[164:167],a[92:95],v[220:223]
s_waitcnt vmcnt(17) lgkmcnt(0)
M v[220:223],a[160:163],a[88:91],v[220:223]
s_barrier
M v[224:227],a[168:171],a[32:35],v[224:227]
R a[160:163],v5,0
R a[164:167],v6,0
M v[224:227],a[172:175],a[36:39],v[224:227]
M v[228:231],a[172:175],a[44:47],v[228:231]
M v[228:231],a[168:171],a[40:43],v[228:231]
M v[232:235],a[168:171],a[48:51],v[232:235]
M v[232:235],a[172:175],a[52:55],v[232:235]
M v[236:239],a[172:175],a[60:63],v[236:239]
M v[236:239],a[168:171],a[56:59],v[236:239]
M v[240:243],a[168:171],a[64:67],v[240:243]
M v[240:243],a[172:175],a[68:71],v[240:243]
M v[244:247],a[172:175],a[76:79],v[244:247]
M v[244:247],a[168:171],a[72:75],v[244:247]
M v[248:251],a[168:171],a[80:83],v[248:251]
M v[248:251],a[172:175],a[84:87],v[248:251]
s_waitcnt lgkmcnt(0)
M v[252:255],a[172:175],a[92:95],v[252:255]
M v[252:255],a[168:171],a[88:91],v[252:255]
M a[0:3],a[160:163],a[96:99],a[0:3]
R a[168:171],v5,2048
R a[172:175],v6,2048
M a[0:3],a[164:167],a[100:103],a[0:3]
T a[32:33],v1,32768
T a[34:35],v1,33792
M a[4:7],a[164:167],a[108:111],a[4:7]
SA m0,s24,49152
v_lshrrev_b32 v28, 4, v0
v_and_b32 v29, 7, v0
M a[4:7],a[160:163],a[104:107],a[4:7]
buffer_load_dwordx4 v12, s[48:51], s22 offen offset:0   lds
M a[8:11],a[160:163],a[112:115],a[8:11]
v_xor_b32 v28, v28, v29
v_lshlrev_b32 v28, 4, v28
M a[8:11],a[164:167],a[116:119],a[8:11]
v_lshrrev_b32 v29, 3, v0
v_mul_u32_u24 v29, 896, v29
M a[12:15],a[164:167],a[124:127],a[12:15]
T a[36:37],v1,40960
T a[38:39],v1,41984
M a[12:15],a[160:163],a[120:123],a[12:15]
v_add_u32 v22, v28, v29
v_xor_b32 v28, 64, v28
M a[16:19],a[160:163],a[128:131],a[16:19]
s_mul_i32 s64, s20, 14336
buffer_load_dwordx4 v13, s[48:51], s22 offen offset:1024   lds
M a[16:19],a[164:167],a[132:135],a[16:19]
s_sub_u32 s65, 98304, s64
M a[20:23],a[164:167],a[140:143],a[20:23]
SA s30,s29,s65
M a[20:23],a[160:163],a[136:139],a[20:23]
SA s29,s29,s64
T a[40:41],v2,32768
T a[42:43],v2,33792
M a[24:27],a[160:163],a[144:147],a[24:27]
v_add_u32 v29, 6144, v29
v_add_u32 v23, v28, v29
M a[24:27],a[164:167],a[148:151],a[24:27]
s_waitcnt lgkmcnt(6)
buffer_load_dwordx4 v14, s[48:51], s22 offen offset:2048   lds
M a[28:31],a[164:167],a[156:159],a[28:31]
s_and_b32 s64, s20, 1
M a[28:31],a[160:163],a[152:155],a[28:31]
s_lshl_b32 s64, s64, 12
M v[32:35],a[168:171],a[96:99],v[32:35]
SA s64,s64,65536
R a[160:163],v5,4096
R a[164:167],v6,4096
M v[32:35],a[172:175],a[100:103],v[32:35]
T a[44:45],v2,40960
T a[46:47],v2,41984
M v[36:39],a[172:175],a[108:111],v[36:39]
buffer_load_dwordx4 v15, s[48:51], s22 offen offset:3072   lds
M v[36:39],a[168:171],a[104:107],v[36:39]
s_sub_u32 s22, s22, 1048448
v_add_u32 v20, s64, v5
v_add_u32 v21, s64, v6
M v[40:43],a[168:171],a[112:115],v[40:43]
M v[40:43],a[172:175],a[116:119],v[40:43]
s_nop 0
T a[48:49],v3,32768
T a[50:51],v3,33792
M v[44:47],a[172:175],a[124:127],v[44:47]
SA m0,s23,16384
M v[44:47],a[168:171],a[120:123],v[44:47]
buffer_load_dwordx4 v8, s[16:19], s21 offen offset:0  nt lds
M v[48:51],a[168:171],a[128:131],v[48:51]
M v[48:51],a[172:175],a[132:135],v[48:51]
M v[52:55],a[172:175],a[140:143],v[52:55]
s_nop 0
T a[52:53],v3,40960
T a[54:55],v3,41984
M v[52:55],a[168:171],a[136:139],v[52:55]
M v[56:59],a[168:171],a[144:147],v[56:59]
buffer_load_dwordx4 v9, s[16:19], s21 offen offset:1024  nt lds
M v[56:59],a[172:175],a[148:151],v[56:59]
s_waitcnt lgkmcnt(6)
M v[60:63],a[172:175],a[156:159],v[60:63]
M v[60:63],a[168:171],a[152:155],v[60:63]
s_nop 0
T a[56:57],v4,32768
T a[58:59],v4,33792
M v[64:67],a[160:163],a[96:99],v[64:67]
R a[168:171],v5,6144
R a[172:175],v6,6144
M v[64:67],a[164:167],a[100:103],v[64:67]
buffer_load_dwordx4 v10, s[16:19], s21 offen offset:2048  nt lds
M v[68:71],a[164:167],a[108:111],v[68:71]
M v[68:71],a[160:163],a[104:107],v[68:71]
M v[72:75],a[160:163],a[112:115],v[72:75]
s_nop 0
T a[60:61],v4,40960
T a[62:63],v4,41984
M v[72:75],a[164:167],a[116:119],v[72:75]
M v[76:79],a[164:167],a[124:127],v[76:79]
buffer_load_dwordx4 v11, s[16:19], s21 offen offset:3072  nt lds
M v[76:79],a[160:163],a[120:123],v[76:79]
SA s21,s21,524160
M v[80:83],a[160:163],a[128:131],v[80:83]
M v[80:83],a[164:167],a[132:135],v[80:83]
M v[84:87],a[164:167],a[140:143],v[84:87]
M v[84:87],a[160:163],a[136:139],v[84:87]
M v[88:91],a[160:163],a[144:147],v[88:91]
M v[88:91],a[164:167],a[148:151],v[88:91]
s_waitcnt lgkmcnt(2)
M v[92:95],a[164:167],a[156:159],v[92:95]
s_waitcnt vmcnt(16) lgkmcnt(0)
M v[92:95],a[160:163],a[152:155],v[92:95]
s_barrier
M v[96:99],a[168:171],a[96:99],v[96:99]
R a[160:163],v5,16384
R a[164:167],v6,16384
M v[96:99],a[172:175],a[100:103],v[96:99]
SA m0,s23,131072
M v[100:103],a[172:175],a[108:111],v[100:103]
s_nop 0
T a[64:65],v1,49152
T a[66:67],v1,50176
M v[100:103],a[168:171],a[104:107],v[100:103]
buffer_load_dwordx4 v22, s[56:59], s29 offen offset:0 lds
M v[104:107],a[168:171],a[112:115],v[104:107]
M v[104:107],a[172:175],a[116:119],v[104:107]
M v[108:111],a[172:175],a[124:127],v[108:111]
buffer_load_dwordx4 v23, s[56:59], s29 offen offset:1024 lds
M v[108:111],a[168:171],a[120:123],v[108:111]
M v[112:115],a[168:171],a[128:131],v[112:115]
M v[112:115],a[172:175],a[132:135],v[112:115]
s_nop 0
T a[68:69],v1,57344
T a[70:71],v1,58368
M v[116:119],a[172:175],a[140:143],v[116:119]
buffer_load_dwordx4 v22, s[56:59], s30 offen offset:2048 lds
M v[116:119],a[168:171],a[136:139],v[116:119]
M v[120:123],a[168:171],a[144:147],v[120:123]
M v[120:123],a[172:175],a[148:151],v[120:123]
s_waitcnt lgkmcnt(4)
M v[124:127],a[172:175],a[156:159],v[124:127]
M v[124:127],a[168:171],a[152:155],v[124:127]
buffer_load_dwordx4 v23, s[56:59], s30 offen offset:3072 lds
M v[128:131],a[160:163],a[96:99],v[128:131]
R a[168:171],v5,18432
R a[172:175],v6,18432
M v[128:131],a[164:167],a[100:103],v[128:131]
SA s29,s29,128
T a[72:73],v2,49152
T a[74:75],v2,50176
M v[132:135],a[164:167],a[108:111],v[132:135]
SA s30,s30,128
M v[132:135],a[160:163],a[104:107],v[132:135]
SA m0,s24,0
M v[136:139],a[160:163],a[112:115],v[136:139]
buffer_load_dwordx4 v12, s[48:51], s22 offen offset:0   lds
M v[136:139],a[164:167],a[116:119],v[136:139]
M v[140:143],a[164:167],a[124:127],v[140:143]
M v[140:143],a[160:163],a[120:123],v[140:143]
s_nop 0
T a[76:77],v2,57344
T a[78:79],v2,58368
M v[144:147],a[160:163],a[128:131],v[144:147]
buffer_load_dwordx4 v13, s[48:51], s22 offen offset:1024   lds
M v[144:147],a[164:167],a[132:135],v[144:147]
M v[148:151],a[164:167],a[140:143],v[148:151]
M v[148:151],a[160:163],a[136:139],v[148:151]
M v[152:155],a[160:163],a[144:147],v[152:155]
M v[152:155],a[164:167],a[148:151],v[152:155]
s_waitcnt lgkmcnt(4)
buffer_load_dwordx4 v14, s[48:51], s22 offen offset:2048   lds
M v[156:159],a[164:167],a[156:159],v[156:159]
s_nop 0
T a[80:81],v3,49152
T a[82:83],v3,50176
M v[156:159],a[160:163],a[152:155],v[156:159]
M v[160:163],a[168:171],a[96:99],v[160:163]
R a[160:163],v5,20480
R a[164:167],v6,20480
M v[160:163],a[172:175],a[100:103],v[160:163]
M v[164:167],a[172:175],a[108:111],v[164:167]
buffer_load_dwordx4 v15, s[48:51], s22 offen offset:3072   lds
M v[164:167],a[168:171],a[104:107],v[164:167]
M v[168:171],a[168:171],a[112:115],v[168:171]
M v[168:171],a[172:175],a[116:119],v[168:171]
SA s22,s22,1048576
T a[84:85],v3,57344
T a[86:87],v3,58368
M v[172:175],a[172:175],a[124:127],v[172:175]
SA m0,s23,32768
M v[172:175],a[168:171],a[120:123],v[172:175]
buffer_load_dwordx4 v8, s[16:19], s21 offen offset:0  nt lds
M v[176:179],a[168:171],a[128:131],v[176:179]
M v[176:179],a[172:175],a[132:135],v[176:179]
M v[180:183],a[172:175],a[140:143],v[180:183]
M v[180:183],a[168:171],a[136:139],v[180:183]
buffer_load_dwordx4 v9, s[16:19], s21 offen offset:1024  nt lds
M v[184:187],a[168:171],a[144:147],v[184:187]
s_nop 0
T a[88:89],v4,49152
T a[90:91],v4,50176
M v[184:187],a[172:175],a[148:151],v[184:187]
s_waitcnt lgkmcnt(4)
M v[188:191],a[172:175],a[156:159],v[188:191]
M v[188:191],a[168:171],a[152:155],v[188:191]
M v[192:195],a[160:163],a[96:99],v[192:195]
R a[168:171],v5,22528
R a[172:175],v6,22528
M v[192:195],a[164:167],a[100:103],v[192:195]
buffer_load_dwordx4 v10, s[16:19], s21 offen offset:2048  nt lds
M v[196:199],a[164:167],a[108:111],v[196:199]
M v[196:199],a[160:163],a[104:107],v[196:199]
s_nop 0
T a[92:93],v4,57344
T a[94:95],v4,58368
M v[200:203],a[160:163],a[112:115],v[200:203]
M v[200:203],a[164:167],a[116:119],v[200:203]
buffer_load_dwordx4 v11, s[16:19], s21 offen offset:3072  nt lds
M v[204:207],a[164:167],a[124:127],v[204:207]
M v[204:207],a[160:163],a[120:123],v[204:207]
M v[208:211],a[160:163],a[128:131],v[208:211]
M v[208:211],a[164:167],a[132:135],v[208:211]
M v[212:215],a[164:167],a[140:143],v[212:215]
SA s21,s21,128
M v[212:215],a[160:163],a[136:139],v[212:215]
M v[216:219],a[160:163],a[144:147],v[216:219]
M v[216:219],a[164:167],a[148:151],v[216:219]
s_waitcnt lgkmcnt(2)
M v[220:223],a[164:167],a[156:159],v[220:223]
s_waitcnt vmcnt(20) lgkmcnt(0)
M v[220:223],a[160:163],a[152:155],v[220:223]
s_barrier
M v[224:227],a[168:171],a[96:99],v[224:227]
R a[160:163],v5,32768
R a[164:167],v6,32768
M v[224:227],a[172:175],a[100:103],v[224:227]
M v[228:231],a[172:175],a[108:111],v[228:231]
M v[228:231],a[168:171],a[104:107],v[228:231]
M v[232:235],a[168:171],a[112:115],v[232:235]
M v[232:235],a[172:175],a[116:119],v[232:235]
M v[236:239],a[172:175],a[124:127],v[236:239]
M v[236:239],a[168:171],a[120:123],v[236:239]
M v[240:243],a[168:171],a[128:131],v[240:243]
M v[240:243],a[172:175],a[132:135],v[240:243]
M v[244:247],a[172:175],a[140:143],v[244:247]
M v[244:247],a[168:171],a[136:139],v[244:247]
M v[248:251],a[168:171],a[144:147],v[248:251]
M v[248:251],a[172:175],a[148:151],v[248:251]
s_waitcnt lgkmcnt(0)
M v[252:255],a[172:175],a[156:159],v[252:255]
M v[252:255],a[168:171],a[152:155],v[252:255]
M a[0:3],a[160:163],a[32:35],a[0:3]
R a[168:171],v5,34816
R a[172:175],v6,34816
M a[0:3],a[164:167],a[36:39],a[0:3]
SA m0,s23,147456
T a[96:97],v1,0
T a[98:99],v1,1024
M a[4:7],a[164:167],a[44:47],a[4:7]
buffer_load_dwordx4 v22, s[56:59], s29 offen offset:0 lds
M a[4:7],a[160:163],a[40:43],a[4:7]
M a[8:11],a[160:163],a[48:51],a[8:11]
M a[8:11],a[164:167],a[52:55],a[8:11]
buffer_load_dwordx4 v23, s[56:59], s29 offen offset:1024 lds
M a[12:15],a[164:167],a[60:63],a[12:15]
s_nop 0
T a[100:101],v1,8192
T a[102:103],v1,9216
M a[12:15],a[160:163],a[56:59],a[12:15]
M a[16:19],a[160:163],a[64:67],a[16:19]
buffer_load_dwordx4 v22, s[56:59], s30 offen offset:2048 lds
M a[16:19],a[164:167],a[68:71],a[16:19]
M a[20:23],a[164:167],a[76:79],a[20:23]
M a[20:23],a[160:163],a[72:75],a[20:23]
s_nop 0
T a[104:105],v2,0
T a[106:107],v2,1024
M a[24:27],a[160:163],a[80:83],a[24:27]
buffer_load_dwordx4 v23, s[56:59], s30 offen offset:3072 lds
M a[24:27],a[164:167],a[84:87],a[24:27]
s_waitcnt lgkmcnt(6)
M a[28:31],a[164:167],a[92:95],a[28:31]
SA s29,s29,128
M a[28:31],a[160:163],a[88:91],a[28:31]
SA s30,s30,128
M v[32:35],a[168:171],a[32:35],v[32:35]
SA m0,s24,16384
R a[160:163],v5,36864
R a[164:167],v6,36864
M v[32:35],a[172:175],a[36:39],v[32:35]
T a[108:109],v2,8192
T a[110:111],v2,9216
M v[36:39],a[172:175],a[44:47],v[36:39]
buffer_load_dwordx4 v12, s[48:51], s22 offen offset:0   lds
M v[36:39],a[168:171],a[40:43],v[36:39]
M v[40:43],a[168:171],a[48:51],v[40:43]
M v[40:43],a[172:175],a[52:55],v[40:43]
s_nop 0
T a[112:113],v3,0
T a[114:115],v3,1024
M v[44:47],a[172:175],a[60:63],v[44:47]
buffer_load_dwordx4 v13, s[48:51], s22 offen offset:1024   lds
M v[44:47],a[168:171],a[56:59],v[44:47]
M v[48:51],a[168:171],a[64:67],v[48:51]
M v[48:51],a[172:175],a[68:71],v[48:51]
buffer_load_dwordx4 v14, s[48:51], s22 offen offset:2048   lds
M v[52:55],a[172:175],a[76:79],v[52:55]
s_nop 0
T a[116:117],v3,8192
T a[118:119],v3,9216
L_w_kv16:
s_cbranch_execz L_wd2
M v[52:55],a[168:171],a[72:75],v[52:55]
M v[56:59],a[168:171],a[80:83],v[56:59]
buffer_load_dwordx4 v15, s[48:51], s22 offen offset:3072   lds
M v[56:59],a[172:175],a[84:87],v[56:59]
s_waitcnt lgkmcnt(6)
M v[60:63],a[172:175],a[92:95],v[60:63]
s_sub_u32 s22, s22, 1048448
M v[60:63],a[168:171],a[88:91],v[60:63]
SA m0,s23,49152
T a[120:121],v4,0
T a[122:123],v4,1024
M v[64:67],a[160:163],a[32:35],v[64:67]
R a[168:171],v5,38912
R a[172:175],v6,38912
M v[64:67],a[164:167],a[36:39],v[64:67]
buffer_load_dwordx4 v8, s[16:19], s21 offen offset:0  nt lds
M v[68:71],a[164:167],a[44:47],v[68:71]
M v[68:71],a[160:163],a[40:43],v[68:71]
M v[72:75],a[160:163],a[48:51],v[72:75]
s_waitcnt vmcnt(17)
s_nop 0
T a[124:125],v4,8192
T a[126:127],v4,9216
M v[72:75],a[164:167],a[52:55],v[72:75]
buffer_load_dwordx4 v9, s[16:19], s21 offen offset:1024  nt lds
M v[76:79],a[164:167],a[60:63],v[76:79]
R a[176:179],v20,0
R a[180:183],v20,2048
M v[76:79],a[160:163],a[56:59],v[76:79]
R a[184:187],v21,0
R a[188:191],v21,2048
M v[80:83],a[160:163],a[64:67],v[80:83]
buffer_load_dwordx4 v10, s[16:19], s21 offen offset:2048  nt lds
M v[80:83],a[164:167],a[68:71],v[80:83]
M v[84:87],a[164:167],a[76:79],v[84:87]
M v[84:87],a[160:163],a[72:75],v[84:87]
buffer_load_dwordx4 v11, s[16:19], s21 offen offset:3072  nt lds
M v[88:91],a[160:163],a[80:83],v[88:91]
SA s21,s21,524160
M v[88:91],a[164:167],a[84:87],v[88:91]
s_waitcnt lgkmcnt(6)
M v[92:95],a[164:167],a[92:95],v[92:95]
s_waitcnt lgkmcnt(0)
M v[92:95],a[160:163],a[88:91],v[92:95]
s_barrier
M v[96:99],a[168:171],a[32:35],v[96:99]
s_lshl_b32 s4, s20, 10
R a[160:163],v5,49152
R a[164:167],v6,49152
M v[96:99],a[172:175],a[36:39],v[96:99]
SA m0,s23,131072
v_bfe_u32 v28, v0, 3, 2
M v[100:103],a[172:175],a[44:47],v[100:103]
s_nop 0
T a[128:129],v1,16384
T a[130:131],v1,17408
M v[100:103],a[168:171],a[40:43],v[100:103]
buffer_load_dwordx4 v22, s[56:59], s29 offen offset:0 lds
M v[104:107],a[168:171],a[48:51],v[104:107]
v_lshrrev_b32 v29, 5, v0
v_lshl_add_u32 v28, v29, 3, v28
M v[104:107],a[172:175],a[52:55],v[104:107]
M v[108:111],a[172:175],a[60:63],v[108:111]
buffer_load_dwordx4 v23, s[56:59], s29 offen offset:1024 lds
M v[108:111],a[168:171],a[56:59],v[108:111]
v_lshlrev_b32 v28, 13, v28
M v[112:115],a[168:171],a[64:67],v[112:115]
v_lshrrev_b32 v29, 4, v0
M v[112:115],a[172:175],a[68:71],v[112:115]
s_nop 0
T a[132:133],v1,24576
T a[134:135],v1,25600
M v[116:119],a[172:175],a[76:79],v[116:119]
buffer_load_dwordx4 v22, s[56:59], s30 offen offset:2048 lds
M v[116:119],a[168:171],a[72:75],v[116:119]
v_lshlrev_b32 v29, 1, v29
M v[120:123],a[168:171],a[80:83],v[120:123]
v_and_b32 v30, 7, v0
M v[120:123],a[172:175],a[84:87],v[120:123]
s_waitcnt lgkmcnt(4)
M v[124:127],a[172:175],a[92:95],v[124:127]
v_xor_b32 v29, v29, v30
M v[124:127],a[168:171],a[88:91],v[124:127]
buffer_load_dwordx4 v23, s[56:59], s30 offen offset:3072 lds
M v[128:131],a[160:163],a[32:35],v[128:131]
R a[168:171],v5,51200
R a[172:175],v6,51200
M v[128:131],a[164:167],a[36:39],v[128:131]
SA s29,s29,128
T a[136:137],v2,16384
T a[138:139],v2,17408
M v[132:135],a[164:167],a[44:47],v[132:135]
SA s30,s30,128
v_lshl_add_u32 v28, v29, 4, v28
M v[132:135],a[160:163],a[40:43],v[132:135]
s_and_b32 s64, s20, 1
M v[136:139],a[160:163],a[48:51],v[136:139]
s_lshl_b32 s64, s64, 17
M v[136:139],a[164:167],a[52:55],v[136:139]
s_lshr_b32 s65, s20, 1
M v[140:143],a[164:167],a[60:63],v[140:143]
s_lshl_b32 s65, s65, 15
SA s64,s64,s65
v_add_u32 v8, s64, v28
M v[140:143],a[160:163],a[56:59],v[140:143]
SA m0,s24,32768
T a[140:141],v2,24576
T a[142:143],v2,25600
M v[144:147],a[160:163],a[64:67],v[144:147]
buffer_load_dwordx4 v12, s[48:51], s22 offen offset:0   lds
M v[144:147],a[164:167],a[68:71],v[144:147]
M v[148:151],a[164:167],a[76:79],v[148:151]
M v[148:151],a[160:163],a[72:75],v[148:151]
buffer_load_dwordx4 v13, s[48:51], s22 offen offset:1024   lds
M v[152:155],a[160:163],a[80:83],v[152:155]
M v[152:155],a[164:167],a[84:87],v[152:155]
s_waitcnt lgkmcnt(4)
M v[156:159],a[164:167],a[92:95],v[156:159]
s_nop 0
T a[144:145],v3,16384
T a[146:147],v3,17408
M v[156:159],a[160:163],a[88:91],v[156:159]
buffer_load_dwordx4 v14, s[48:51], s22 offen offset:2048   lds
M v[160:163],a[168:171],a[32:35],v[160:163]
R a[160:163],v5,53248
R a[164:167],v6,53248
M v[160:163],a[172:175],a[36:39],v[160:163]
M v[164:167],a[172:175],a[44:47],v[164:167]
buffer_load_dwordx4 v15, s[48:51], s22 offen offset:3072   lds
M v[164:167],a[168:171],a[40:43],v[164:167]
M v[168:171],a[168:171],a[48:51],v[168:171]
SA s22,s22,1048576
M v[168:171],a[172:175],a[52:55],v[168:171]
s_mov_b32 s25, 0
T a[148:149],v3,24576
T a[150:151],v3,25600
M v[172:175],a[172:175],a[60:63],v[172:175]
SA m0,s4,0
M v[172:175],a[168:171],a[56:59],v[172:175]
buffer_load_dwordx4 v8, s[52:55], s25 offen lds
M v[176:179],a[168:171],a[64:67],v[176:179]
M v[176:179],a[172:175],a[68:71],v[176:179]
s_mov_b32 s25, 262144
M v[180:183],a[172:175],a[76:79],v[180:183]
SA m0,s4,4096
M v[180:183],a[168:171],a[72:75],v[180:183]
buffer_load_dwordx4 v8, s[52:55], s25 offen lds
M v[184:187],a[168:171],a[80:83],v[184:187]
s_nop 0
T a[152:153],v4,16384
T a[154:155],v4,17408
M v[184:187],a[172:175],a[84:87],v[184:187]
s_waitcnt lgkmcnt(4)
M v[188:191],a[172:175],a[92:95],v[188:191]
s_mov_b32 s25, 524288
M v[188:191],a[168:171],a[88:91],v[188:191]
SA m0,s4,8192
M v[192:195],a[160:163],a[32:35],v[192:195]
R a[168:171],v5,55296
R a[172:175],v6,55296
M v[192:195],a[164:167],a[36:39],v[192:195]
buffer_load_dwordx4 v8, s[52:55], s25 offen lds
M v[196:199],a[164:167],a[44:47],v[196:199]
M v[196:199],a[160:163],a[40:43],v[196:199]
s_mov_b32 s25, 786432
T a[156:157],v4,24576
T a[158:159],v4,25600
M v[200:203],a[160:163],a[48:51],v[200:203]
SA m0,s4,12288
M v[200:203],a[164:167],a[52:55],v[200:203]
s_waitcnt vmcnt(19)
buffer_load_dwordx4 v8, s[52:55], s25 offen lds
M v[204:207],a[164:167],a[60:63],v[204:207]
R a[192:195],v20,16384
R a[196:199],v20,18432
M v[204:207],a[160:163],a[56:59],v[204:207]
R a[200:203],v21,16384
R a[204:207],v21,18432
M v[208:211],a[160:163],a[64:67],v[208:211]
M v[208:211],a[164:167],a[68:71],v[208:211]
M v[212:215],a[164:167],a[76:79],v[212:215]
M v[212:215],a[160:163],a[72:75],v[212:215]
M v[216:219],a[160:163],a[80:83],v[216:219]
M v[216:219],a[164:167],a[84:87],v[216:219]
s_waitcnt lgkmcnt(6)
M v[220:223],a[164:167],a[92:95],v[220:223]
s_waitcnt lgkmcnt(0)
M v[220:223],a[160:163],a[88:91],v[220:223]
s_barrier
M v[224:227],a[168:171],a[32:35],v[224:227]
R a[160:163],v5,0
R a[164:167],v6,0
M v[224:227],a[172:175],a[36:39],v[224:227]
M v[228:231],a[172:175],a[44:47],v[228:231]
M v[228:231],a[168:171],a[40:43],v[228:231]
M v[232:235],a[168:171],a[48:51],v[232:235]
M v[232:235],a[172:175],a[52:55],v[232:235]
M v[236:239],a[172:175],a[60:63],v[236:239]
M v[236:239],a[168:171],a[56:59],v[236:239]
M v[240:243],a[168:171],a[64:67],v[240:243]
M v[240:243],a[172:175],a[68:71],v[240:243]
M v[244:247],a[172:175],a[76:79],v[244:247]
M v[244:247],a[168:171],a[72:75],v[244:247]
M v[248:251],a[168:171],a[80:83],v[248:251]
M v[248:251],a[172:175],a[84:87],v[248:251]
s_waitcnt lgkmcnt(0)
M v[252:255],a[172:175],a[92:95],v[252:255]
M v[252:255],a[168:171],a[88:91],v[252:255]
M a[0:3],a[160:163],a[96:99],a[0:3]
R a[168:171],v5,2048
R a[172:175],v6,2048
M a[0:3],a[164:167],a[100:103],a[0:3]
SA m0,s23,147456
T a[32:33],v1,32768
T a[34:35],v1,33792
M a[4:7],a[164:167],a[108:111],a[4:7]
buffer_load_dwordx4 v22, s[56:59], s29 offen offset:0 lds
M a[4:7],a[160:163],a[104:107],a[4:7]
M a[8:11],a[160:163],a[112:115],a[8:11]
M a[8:11],a[164:167],a[116:119],a[8:11]
buffer_load_dwordx4 v23, s[56:59], s29 offen offset:1024 lds
M a[12:15],a[164:167],a[124:127],a[12:15]
s_nop 0
T a[36:37],v1,40960
T a[38:39],v1,41984
M a[12:15],a[160:163],a[120:123],a[12:15]
M a[16:19],a[160:163],a[128:131],a[16:19]
buffer_load_dwordx4 v22, s[56:59], s30 offen offset:2048 lds
M a[16:19],a[164:167],a[132:135],a[16:19]
M a[20:23],a[164:167],a[140:143],a[20:23]
M a[20:23],a[160:163],a[136:139],a[20:23]
s_nop 0
T a[40:41],v2,32768
T a[42:43],v2,33792
M a[24:27],a[160:163],a[144:147],a[24:27]
buffer_load_dwordx4 v23, s[56:59], s30 offen offset:3072 lds
M a[24:27],a[164:167],a[148:151],a[24:27]
s_waitcnt lgkmcnt(6)
M a[28:31],a[164:167],a[156:159],a[28:31]
SA s29,s29,128
M a[28:31],a[160:163],a[152:155],a[28:31]
SA s30,s30,128
M v[32:35],a[168:171],a[96:99],v[32:35]
SA m0,s24,49152
R a[160:163],v5,4096
R a[164:167],v6,4096
M v[32:35],a[172:175],a[100:103],v[32:35]
T a[44:45],v2,40960
T a[46:47],v2,41984
M v[36:39],a[172:175],a[108:111],v[36:39]
buffer_load_dwordx4 v12, s[48:51], s22 offen offset:0   lds
M v[36:39],a[168:171],a[104:107],v[36:39]
M v[40:43],a[168:171],a[112:115],v[40:43]
M v[40:43],a[172:175],a[116:119],v[40:43]
s_nop 0
T a[48:49],v3,32768
T a[50:51],v3,33792
M v[44:47],a[172:175],a[124:127],v[44:47]
buffer_load_dwordx4 v13, s[48:51], s22 offen offset:1024   lds
M v[44:47],a[168:171],a[120:123],v[44:47]
M v[48:51],a[168:171],a[128:131],v[48:51]
M v[48:51],a[172:175],a[132:135],v[48:51]
buffer_load_dwordx4 v14, s[48:51], s22 offen offset:2048   lds
M v[52:55],a[172:175],a[140:143],v[52:55]
s_nop 0
T a[52:53],v3,40960
T a[54:55],v3,41984
M v[52:55],a[168:171],a[136:139],v[52:55]
M v[56:59],a[168:171],a[144:147],v[56:59]
buffer_load_dwordx4 v15, s[48:51], s22 offen offset:3072   lds
M v[56:59],a[172:175],a[148:151],v[56:59]
s_waitcnt lgkmcnt(6)
M v[60:63],a[172:175],a[156:159],v[60:63]
s_sub_u32 s22, s22, 1048448
M v[60:63],a[168:171],a[152:155],v[60:63]
s_mov_b32 s25, 1048576
T a[56:57],v4,32768
T a[58:59],v4,33792
M v[64:67],a[160:163],a[96:99],v[64:67]
SA m0,s4,16384
R a[168:171],v5,6144
R a[172:175],v6,6144
M v[64:67],a[164:167],a[100:103],v[64:67]
buffer_load_dwordx4 v8, s[52:55], s25 offen lds
M v[68:71],a[164:167],a[108:111],v[68:71]
s_mov_b32 s25, 1310720
M v[68:71],a[160:163],a[104:107],v[68:71]
SA m0,s4,20480
M v[72:75],a[160:163],a[112:115],v[72:75]
s_waitcnt vmcnt(17)
s_nop 0
T a[60:61],v4,40960
T a[62:63],v4,41984
M v[72:75],a[164:167],a[116:119],v[72:75]
buffer_load_dwordx4 v8, s[52:55], s25 offen lds
M v[76:79],a[164:167],a[124:127],v[76:79]
s_mov_b32 s25, 1572864
R a[208:211],v20,0
R a[212:215],v20,2048
M v[76:79],a[160:163],a[120:123],v[76:79]
SA m0,s4,24576
R a[216:219],v21,0
R a[220:223],v21,2048
M v[80:83],a[160:163],a[128:131],v[80:83]
buffer_load_dwordx4 v8, s[52:55], s25 offen lds
M v[80:83],a[164:167],a[132:135],v[80:83]
s_mov_b32 s25, 1835008
M v[84:87],a[164:167],a[140:143],v[84:87]
SA m0,s4,28672
M v[84:87],a[160:163],a[136:139],v[84:87]
buffer_load_dwordx4 v8, s[52:55], s25 offen lds
M v[88:91],a[160:163],a[144:147],v[88:91]
M v[88:91],a[164:167],a[148:151],v[88:91]
s_waitcnt lgkmcnt(6)
M v[92:95],a[164:167],a[156:159],v[92:95]
s_waitcnt lgkmcnt(0)
M v[92:95],a[160:163],a[152:155],v[92:95]
s_barrier
M v[96:99],a[168:171],a[96:99],v[96:99]
R a[160:163],v5,16384
R a[164:167],v6,16384
M v[96:99],a[172:175],a[100:103],v[96:99]
SA m0,s23,32768
M v[100:103],a[172:175],a[108:111],v[100:103]
s_nop 0
T a[64:65],v1,49152
T a[66:67],v1,50176
M v[100:103],a[168:171],a[104:107],v[100:103]
buffer_load_dwordx4 v22, s[56:59], s29 offen offset:0 lds
M v[104:107],a[168:171],a[112:115],v[104:107]
v_lshrrev_b32 v28, 2, v0
v_lshlrev_b32 v28, 7, v28
M v[104:107],a[172:175],a[116:119],v[104:107]
M v[108:111],a[172:175],a[124:127],v[108:111]
buffer_load_dwordx4 v23, s[56:59], s29 offen offset:1024 lds
M v[108:111],a[168:171],a[120:123],v[108:111]
v_and_b32 v29, 3, v0
M v[112:115],a[168:171],a[128:131],v[112:115]
v_lshl_add_u32 v28, v29, 3, v28
M v[112:115],a[172:175],a[132:135],v[112:115]
s_nop 0
T a[68:69],v1,57344
T a[70:71],v1,58368
M v[116:119],a[172:175],a[140:143],v[116:119]
buffer_load_dwordx4 v22, s[56:59], s30 offen offset:2048 lds
M v[116:119],a[168:171],a[136:139],v[116:119]
v_bfe_u32 v29, v0, 3, 2
M v[120:123],a[168:171],a[144:147],v[120:123]
M v[120:123],a[172:175],a[148:151],v[120:123]
s_waitcnt lgkmcnt(4)
v_lshl_add_u32 v16, v29, 5, v28
M v[124:127],a[172:175],a[156:159],v[124:127]
M v[124:127],a[168:171],a[152:155],v[124:127]
buffer_load_dwordx4 v23, s[56:59], s30 offen offset:3072 lds
M v[128:131],a[160:163],a[96:99],v[128:131]
R a[168:171],v5,18432
R a[172:175],v6,18432
M v[128:131],a[164:167],a[100:103],v[128:131]
SA s29,s29,128
T a[72:73],v2,49152
T a[74:75],v2,50176
M v[132:135],a[164:167],a[108:111],v[132:135]
SA s30,s30,128
v_xor_b32 v17, 32, v16
v_xor_b32 v18, 64, v16
M v[132:135],a[160:163],a[104:107],v[132:135]
SA m0,s23,65536
M v[136:139],a[160:163],a[112:115],v[136:139]
buffer_load_dwordx4 v22, s[56:59], s29 offen offset:0 lds
M v[136:139],a[164:167],a[116:119],v[136:139]
v_xor_b32 v19, 0x60, v16
M v[140:143],a[164:167],a[124:127],v[140:143]
v_add_u32 v12, 0x20000, v16
M v[140:143],a[160:163],a[120:123],v[140:143]
s_nop 0
T a[76:77],v2,57344
T a[78:79],v2,58368
M v[144:147],a[160:163],a[128:131],v[144:147]
buffer_load_dwordx4 v23, s[56:59], s29 offen offset:1024 lds
M v[144:147],a[164:167],a[132:135],v[144:147]
v_add_u32 v13, 0x20000, v17
M v[148:151],a[164:167],a[140:143],v[148:151]
M v[148:151],a[160:163],a[136:139],v[148:151]
v_add_u32 v14, 0x20000, v18
M v[152:155],a[160:163],a[144:147],v[152:155]
M v[152:155],a[164:167],a[148:151],v[152:155]
s_waitcnt lgkmcnt(4)
buffer_load_dwordx4 v22, s[56:59], s30 offen offset:2048 lds
M v[156:159],a[164:167],a[156:159],v[156:159]
s_nop 0
T a[80:81],v3,49152
T a[82:83],v3,50176
M v[156:159],a[160:163],a[152:155],v[156:159]
v_add_u32 v15, 0x20000, v19
M v[160:163],a[168:171],a[96:99],v[160:163]
R a[160:163],v5,20480
R a[164:167],v6,20480
M v[160:163],a[172:175],a[100:103],v[160:163]
M v[164:167],a[172:175],a[108:111],v[164:167]
buffer_load_dwordx4 v23, s[56:59], s30 offen offset:3072 lds
M v[164:167],a[168:171],a[104:107],v[164:167]
SA s29,s29,128
M v[168:171],a[168:171],a[112:115],v[168:171]
SA s30,s30,128
M v[168:171],a[172:175],a[116:119],v[168:171]
s_mov_b32 s25, 2097152
T a[84:85],v3,57344
T a[86:87],v3,58368
M v[172:175],a[172:175],a[124:127],v[172:175]
SA m0,s4,131072
M v[172:175],a[168:171],a[120:123],v[172:175]
buffer_load_dwordx4 v8, s[52:55], s25 offen lds
M v[176:179],a[168:171],a[128:131],v[176:179]
M v[176:179],a[172:175],a[132:135],v[176:179]
s_mov_b32 s25, 2359296
M v[180:183],a[172:175],a[140:143],v[180:183]
SA m0,s4,135168
M v[180:183],a[168:171],a[136:139],v[180:183]
buffer_load_dwordx4 v8, s[52:55], s25 offen lds
M v[184:187],a[168:171],a[144:147],v[184:187]
s_nop 0
T a[88:89],v4,49152
T a[90:91],v4,50176
M v[184:187],a[172:175],a[148:151],v[184:187]
s_waitcnt lgkmcnt(4)
M v[188:191],a[172:175],a[156:159],v[188:191]
s_mov_b32 s25, 2621440
M v[188:191],a[168:171],a[152:155],v[188:191]
SA m0,s4,139264
M v[192:195],a[160:163],a[96:99],v[192:195]
R a[168:171],v5,22528
R a[172:175],v6,22528
M v[192:195],a[164:167],a[100:103],v[192:195]
buffer_load_dwordx4 v8, s[52:55], s25 offen lds
M v[196:199],a[164:167],a[108:111],v[196:199]
M v[196:199],a[160:163],a[104:107],v[196:199]
s_mov_b32 s25, 2883584
T a[92:93],v4,57344
T a[94:95],v4,58368
M v[200:203],a[160:163],a[112:115],v[200:203]
SA m0,s4,143360
M v[200:203],a[164:167],a[116:119],v[200:203]
s_waitcnt vmcnt(19)
buffer_load_dwordx4 v8, s[52:55], s25 offen lds
M v[204:207],a[164:167],a[124:127],v[204:207]
R a[224:227],v20,16384
R a[228:231],v20,18432
M v[204:207],a[160:163],a[120:123],v[204:207]
R a[232:235],v21,16384
R a[236:239],v21,18432
M v[208:211],a[160:163],a[128:131],v[208:211]
v_subrev_u32 v20, 98304, v20
v_subrev_u32 v21, 98304, v21
M v[208:211],a[164:167],a[132:135],v[208:211]
M v[212:215],a[164:167],a[140:143],v[212:215]
M v[212:215],a[160:163],a[136:139],v[212:215]
M v[216:219],a[160:163],a[144:147],v[216:219]
M v[216:219],a[164:167],a[148:151],v[216:219]
s_waitcnt lgkmcnt(6)
M v[220:223],a[164:167],a[156:159],v[220:223]
s_waitcnt lgkmcnt(0)
M v[220:223],a[160:163],a[152:155],v[220:223]
s_barrier
M v[224:227],a[168:171],a[96:99],v[224:227]
R a[160:163],v5,32768
R a[164:167],v6,32768
M v[224:227],a[172:175],a[100:103],v[224:227]
M v[228:231],a[172:175],a[108:111],v[228:231]
M v[228:231],a[168:171],a[104:107],v[228:231]
M v[232:235],a[168:171],a[112:115],v[232:235]
M v[232:235],a[172:175],a[116:119],v[232:235]
M v[236:239],a[172:175],a[124:127],v[236:239]
M v[236:239],a[168:171],a[120:123],v[236:239]
M v[240:243],a[168:171],a[128:131],v[240:243]
M v[240:243],a[172:175],a[132:135],v[240:243]
M v[244:247],a[172:175],a[140:143],v[244:247]
M v[244:247],a[168:171],a[136:139],v[244:247]
M v[248:251],a[168:171],a[144:147],v[248:251]
M v[248:251],a[172:175],a[148:151],v[248:251]
s_waitcnt lgkmcnt(0)
M v[252:255],a[172:175],a[156:159],v[252:255]
M v[252:255],a[168:171],a[152:155],v[252:255]
M a[0:3],a[160:163],a[32:35],a[0:3]
R a[168:171],v5,34816
R a[172:175],v6,34816
M a[0:3],a[164:167],a[36:39],a[0:3]
SA m0,s23,81920
M a[4:7],a[164:167],a[44:47],a[4:7]
buffer_load_dwordx4 v22, s[56:59], s29 offen offset:0 lds
M a[4:7],a[160:163],a[40:43],a[4:7]
M a[8:11],a[160:163],a[48:51],a[8:11]
M a[8:11],a[164:167],a[52:55],a[8:11]
buffer_load_dwordx4 v23, s[56:59], s29 offen offset:1024 lds
M a[12:15],a[164:167],a[60:63],a[12:15]
M a[12:15],a[160:163],a[56:59],a[12:15]
M a[16:19],a[160:163],a[64:67],a[16:19]
M a[16:19],a[164:167],a[68:71],a[16:19]
buffer_load_dwordx4 v22, s[56:59], s30 offen offset:2048 lds
M a[20:23],a[164:167],a[76:79],a[20:23]
M a[20:23],a[160:163],a[72:75],a[20:23]
M a[24:27],a[160:163],a[80:83],a[24:27]
M a[24:27],a[164:167],a[84:87],a[24:27]
s_waitcnt lgkmcnt(0)
buffer_load_dwordx4 v23, s[56:59], s30 offen offset:3072 lds
M a[28:31],a[164:167],a[92:95],a[28:31]
SA s29,s29,128
M a[28:31],a[160:163],a[88:91],a[28:31]
SA s30,s30,128
M v[32:35],a[168:171],a[32:35],v[32:35]
s_mov_b32 s25, 3145728
R a[160:163],v5,36864
R a[164:167],v6,36864
M v[32:35],a[172:175],a[36:39],v[32:35]
SA m0,s4,147456
M v[36:39],a[172:175],a[44:47],v[36:39]
buffer_load_dwordx4 v8, s[52:55], s25 offen lds
M v[36:39],a[168:171],a[40:43],v[36:39]
s_mov_b32 s25, 3407872
M v[40:43],a[168:171],a[48:51],v[40:43]
SA m0,s4,151552
M v[40:43],a[172:175],a[52:55],v[40:43]
buffer_load_dwordx4 v8, s[52:55], s25 offen lds
M v[44:47],a[172:175],a[60:63],v[44:47]
G v24,a0
G v25,a1
M v[44:47],a[168:171],a[56:59],v[44:47]
s_mov_b32 s25, 128
G v26,a2
G v27,a3
M v[48:51],a[168:171],a[64:67],v[48:51]
SA m0,s4,49152
C v24,v24,v25
C v25,v26,v27
M v[48:51],a[172:175],a[68:71],v[48:51]
buffer_load_dwordx4 v8, s[52:55], s25 offen lds
M v[52:55],a[172:175],a[76:79],v[52:55]
C v26,v32,v33
C v27,v34,v35
M v[52:55],a[168:171],a[72:75],v[52:55]
SA s3,s93,0
M v[56:59],a[168:171],a[80:83],v[56:59]
s_mov_b32 s25, 262272
buffer_store_dwordx4 v[24:27], v7, s[8:11], s3 offen offset:0 sc1
M v[56:59],a[172:175],a[84:87],v[56:59]
L_w_kv17:
s_cbranch_execz L_wd2
s_waitcnt lgkmcnt(0)
G v28,a4
G v29,a5
M v[60:63],a[172:175],a[92:95],v[60:63]
SA m0,s4,53248
G v30,a6
G v31,a7
M v[60:63],a[168:171],a[88:91],v[60:63]
s_waitcnt vmcnt(16)
buffer_load_dwordx4 v8, s[52:55], s25 offen lds
M v[64:67],a[160:163],a[32:35],v[64:67]
s_mov_b32 s25, 524416
R a[168:171],v5,38912
R a[172:175],v6,38912
M v[64:67],a[164:167],a[36:39],v[64:67]
SA m0,s4,57344
C v28,v28,v29
C v29,v30,v31
M v[68:71],a[164:167],a[44:47],v[68:71]
buffer_load_dwordx4 v8, s[52:55], s25 offen lds
M v[68:71],a[160:163],a[40:43],v[68:71]
s_mov_b32 s25, 786560
C v30,v36,v37
C v31,v38,v39
M v[72:75],a[160:163],a[48:51],v[72:75]
SA m0,s4,61440
buffer_store_dwordx4 v[28:31], v7, s[8:11], s3 offen offset:2048 sc1
M v[72:75],a[164:167],a[52:55],v[72:75]
G v24,a8
G v25,a9
M v[76:79],a[164:167],a[60:63],v[76:79]
G v26,a10
G v27,a11
M v[76:79],a[160:163],a[56:59],v[76:79]
buffer_load_dwordx4 v8, s[52:55], s25 offen lds
M v[80:83],a[160:163],a[64:67],v[80:83]
C v24,v24,v25
C v25,v26,v27
M v[80:83],a[164:167],a[68:71],v[80:83]
C v26,v40,v41
C v27,v42,v43
M v[84:87],a[164:167],a[76:79],v[84:87]
SA s3,s93,4096
buffer_store_dwordx4 v[24:27], v7, s[8:11], s3 offen offset:0 sc1
M v[84:87],a[160:163],a[72:75],v[84:87]
R a[96:99],v20,0
R a[100:103],v20,2048
M v[88:91],a[160:163],a[80:83],v[88:91]
R a[104:107],v21,0
R a[108:111],v21,2048
M v[88:91],a[164:167],a[84:87],v[88:91]
s_waitcnt lgkmcnt(4)
G v28,a12
G v29,a13
M v[92:95],a[164:167],a[92:95],v[92:95]
s_waitcnt lgkmcnt(0)
G v30,a14
G v31,a15
M v[92:95],a[160:163],a[88:91],v[92:95]
s_barrier
M v[96:99],a[168:171],a[32:35],v[96:99]
R a[160:163],v5,49152
R a[164:167],v6,49152
M v[96:99],a[172:175],a[36:39],v[96:99]
s_mov_b32 s25, 1048704
C v28,v28,v29
C v29,v30,v31
M v[100:103],a[172:175],a[44:47],v[100:103]
SA m0,s4,98304
C v30,v44,v45
C v31,v46,v47
M v[100:103],a[168:171],a[40:43],v[100:103]
s_waitcnt vmcnt(17)
buffer_store_dwordx4 v[28:31], v7, s[8:11], s3 offen offset:2048 sc1
M v[104:107],a[168:171],a[48:51],v[104:107]
G v24,a16
G v25,a17
M v[104:107],a[172:175],a[52:55],v[104:107]
G v26,a18
G v27,a19
M v[108:111],a[172:175],a[60:63],v[108:111]
buffer_load_dwordx4 v8, s[52:55], s25 offen lds
M v[108:111],a[168:171],a[56:59],v[108:111]
C v24,v24,v25
C v25,v26,v27
M v[112:115],a[168:171],a[64:67],v[112:115]
C v26,v48,v49
C v27,v50,v51
M v[112:115],a[172:175],a[68:71],v[112:115]
SA s3,s93,8192
buffer_store_dwordx4 v[24:27], v7, s[8:11], s3 offen offset:0 sc1
M v[116:119],a[172:175],a[76:79],v[116:119]
s_mov_b32 s25, 1310848
R a[112:115],v20,32768
R a[116:119],v20,34816
M v[116:119],a[168:171],a[72:75],v[116:119]
SA m0,s4,102400
R a[120:123],v21,32768
R a[124:127],v21,34816
M v[120:123],a[168:171],a[80:83],v[120:123]
C v64,v64,v65
C v65,v66,v67
M v[120:123],a[172:175],a[84:87],v[120:123]
s_waitcnt lgkmcnt(4)
buffer_load_dwordx4 v8, s[52:55], s25 offen lds
M v[124:127],a[172:175],a[92:95],v[124:127]
C v66,v96,v97
C v67,v98,v99
M v[124:127],a[168:171],a[88:91],v[124:127]
G v28,a20
G v29,a21
M v[128:131],a[160:163],a[32:35],v[128:131]
R a[168:171],v5,51200
R a[172:175],v6,51200
M v[128:131],a[164:167],a[36:39],v[128:131]
G v30,a22
G v31,a23
M v[132:135],a[164:167],a[44:47],v[132:135]
C v28,v28,v29
C v29,v30,v31
M v[132:135],a[160:163],a[40:43],v[132:135]
s_mov_b32 s25, 1572992
C v30,v52,v53
C v31,v54,v55
M v[136:139],a[160:163],a[48:51],v[136:139]
SA m0,s4,106496
buffer_store_dwordx4 v[28:31], v7, s[8:11], s3 offen offset:2048 sc1
M v[136:139],a[164:167],a[52:55],v[136:139]
C v68,v68,v69
C v69,v70,v71
M v[140:143],a[164:167],a[60:63],v[140:143]
C v70,v100,v101
C v71,v102,v103
M v[140:143],a[160:163],a[56:59],v[140:143]
C v72,v72,v73
C v73,v74,v75
M v[144:147],a[160:163],a[64:67],v[144:147]
buffer_load_dwordx4 v8, s[52:55], s25 offen lds
M v[144:147],a[164:167],a[68:71],v[144:147]
C v74,v104,v105
C v75,v106,v107
M v[148:151],a[164:167],a[76:79],v[148:151]
C v76,v76,v77
C v77,v78,v79
M v[148:151],a[160:163],a[72:75],v[148:151]
C v78,v108,v109
C v79,v110,v111
M v[152:155],a[160:163],a[80:83],v[152:155]
C v80,v80,v81
C v81,v82,v83
M v[152:155],a[164:167],a[84:87],v[152:155]
s_waitcnt lgkmcnt(0)
C v82,v112,v113
C v83,v114,v115
M v[156:159],a[164:167],a[92:95],v[156:159]
s_mov_b32 s25, 1835136
C v84,v84,v85
C v85,v86,v87
M v[156:159],a[160:163],a[88:91],v[156:159]
SA m0,s4,110592
C v86,v116,v117
C v87,v118,v119
M v[160:163],a[168:171],a[32:35],v[160:163]
R a[160:163],v5,53248
R a[164:167],v6,53248
M v[160:163],a[172:175],a[36:39],v[160:163]
buffer_load_dwordx4 v8, s[52:55], s25 offen lds
M v[164:167],a[172:175],a[44:47],v[164:167]
G v24,a24
G v25,a25
M v[164:167],a[168:171],a[40:43],v[164:167]
G v26,a26
G v27,a27
M v[168:171],a[168:171],a[48:51],v[168:171]
C v24,v24,v25
C v25,v26,v27
M v[168:171],a[172:175],a[52:55],v[168:171]
C v26,v56,v57
C v27,v58,v59
M v[172:175],a[172:175],a[60:63],v[172:175]
SA s3,s93,12288
buffer_store_dwordx4 v[24:27], v7, s[8:11], s3 offen offset:0 sc1
M v[172:175],a[168:171],a[56:59],v[172:175]
C v88,v88,v89
C v89,v90,v91
M v[176:179],a[168:171],a[64:67],v[176:179]
C v90,v120,v121
C v91,v122,v123
M v[176:179],a[172:175],a[68:71],v[176:179]
C v92,v92,v93
C v93,v94,v95
M v[180:183],a[172:175],a[76:79],v[180:183]
C v94,v124,v125
C v95,v126,v127
M v[180:183],a[168:171],a[72:75],v[180:183]
G v28,a28
G v29,a29
M v[184:187],a[168:171],a[80:83],v[184:187]
G v30,a30
G v31,a31
M v[184:187],a[172:175],a[84:87],v[184:187]
s_waitcnt lgkmcnt(0)
C v28,v28,v29
C v29,v30,v31
M v[188:191],a[172:175],a[92:95],v[188:191]
C v30,v60,v61
C v31,v62,v63
M v[188:191],a[168:171],a[88:91],v[188:191]
buffer_store_dwordx4 v[28:31], v7, s[8:11], s3 offen offset:2048 sc1
M v[192:195],a[160:163],a[32:35],v[192:195]
s_waitcnt vmcnt(18)
R a[168:171],v5,55296
R a[172:175],v6,55296
M v[192:195],a[164:167],a[36:39],v[192:195]
C v128,v128,v129
C v129,v130,v131
M v[196:199],a[164:167],a[44:47],v[196:199]
C v130,v160,v161
C v131,v162,v163
M v[196:199],a[160:163],a[40:43],v[196:199]
C v132,v132,v133
C v133,v134,v135
M v[200:203],a[160:163],a[48:51],v[200:203]
C v134,v164,v165
C v135,v166,v167
M v[200:203],a[164:167],a[52:55],v[200:203]
C v136,v136,v137
C v137,v138,v139
M v[204:207],a[164:167],a[60:63],v[204:207]
C v138,v168,v169
C v139,v170,v171
M v[204:207],a[160:163],a[56:59],v[204:207]
C v140,v140,v141
C v141,v142,v143
M v[208:211],a[160:163],a[64:67],v[208:211]
C v142,v172,v173
C v143,v174,v175
M v[208:211],a[164:167],a[68:71],v[208:211]
C v144,v144,v145
C v145,v146,v147
M v[212:215],a[164:167],a[76:79],v[212:215]
R a[128:131],v20,49152
R a[132:135],v20,51200
R a[136:139],v21,49152
R a[140:143],v21,51200
M v[212:215],a[160:163],a[72:75],v[212:215]
C v146,v176,v177
C v147,v178,v179
M v[216:219],a[160:163],a[80:83],v[216:219]
C v148,v148,v149
C v149,v150,v151
M v[216:219],a[164:167],a[84:87],v[216:219]
s_waitcnt lgkmcnt(4)
C v150,v180,v181
C v151,v182,v183
M v[220:223],a[164:167],a[92:95],v[220:223]
s_waitcnt vmcnt(16) lgkmcnt(0)
C v152,v152,v153
C v153,v154,v155
M v[220:223],a[160:163],a[88:91],v[220:223]
s_barrier
M v[224:227],a[168:171],a[32:35],v[224:227]
s_nop 0
T v[32:33],v16,0
T v[34:35],v16,2048
M v[224:227],a[172:175],a[36:39],v[224:227]
C v154,v184,v185
C v155,v186,v187
M v[228:231],a[172:175],a[44:47],v[228:231]
T v[36:37],v16,4096
T v[38:39],v16,6144
M v[228:231],a[168:171],a[40:43],v[228:231]
T v[40:41],v16,8192
T v[42:43],v16,10240
M v[232:235],a[168:171],a[48:51],v[232:235]
C v156,v156,v157
C v157,v158,v159
M v[232:235],a[172:175],a[52:55],v[232:235]
T v[44:45],v16,12288
T v[46:47],v16,14336
M v[236:239],a[172:175],a[60:63],v[236:239]
T v[48:49],v16,16384
T v[50:51],v16,18432
M v[236:239],a[168:171],a[56:59],v[236:239]
C v158,v188,v189
C v159,v190,v191
M v[240:243],a[168:171],a[64:67],v[240:243]
T v[52:53],v16,20480
T v[54:55],v16,22528
M v[240:243],a[172:175],a[68:71],v[240:243]
T v[56:57],v16,24576
T v[58:59],v16,26624
M v[244:247],a[172:175],a[76:79],v[244:247]
C v192,v192,v193
C v193,v194,v195
M v[244:247],a[168:171],a[72:75],v[244:247]
C v194,v224,v225
C v195,v226,v227
M v[248:251],a[168:171],a[80:83],v[248:251]
C v196,v196,v197
C v197,v198,v199
M v[248:251],a[172:175],a[84:87],v[248:251]
C v198,v228,v229
C v199,v230,v231
M v[252:255],a[172:175],a[92:95],v[252:255]
C v200,v200,v201
C v201,v202,v203
M v[252:255],a[168:171],a[88:91],v[252:255]
s_waitcnt lgkmcnt(6)
C v202,v232,v233
C v203,v234,v235
M v[96:99],v[32:35],a[176:179],0
s_mul_i32 s72, s41, 4352
T a[144:145],v17,0
T a[146:147],v17,2048
M v[96:99],v[36:39],a[184:187],v[96:99]
SA s46,s72,104923136
C v204,v204,v205
C v205,v206,v207
M v[96:99],v[40:43],a[192:195],v[96:99]
s_waitcnt lgkmcnt(2)
T a[148:149],v17,4096
T a[150:151],v17,6144
M v[96:99],v[44:47],a[200:203],v[96:99]
s_mov_b32 s25, 2097280
T a[152:153],v17,8192
T a[154:155],v17,10240
M v[96:99],v[48:51],a[208:211],v[96:99]
SA m0,s4,114688
C v206,v236,v237
C v207,v238,v239
M v[96:99],v[52:55],a[216:219],v[96:99]
s_lshl_b32 s45, s42, 7
T a[156:157],v17,12288
T a[158:159],v17,14336
M v[96:99],v[56:59],a[224:227],v[96:99]
SA s45,s45,s46
T a[160:161],v17,16384
T a[162:163],v17,18432
M v[100:103],v[56:59],a[228:231],0
s_lshl_b32 s72, s20, 2
buffer_load_dwordx4 v8, s[52:55], s25 offen lds
M v[100:103],v[52:55],a[220:223],v[100:103]
SA s72,s72,s45
T a[164:165],v17,20480
T a[166:167],v17,22528
M v[100:103],v[48:51],a[212:215],v[100:103]
T a[168:169],v17,24576
T a[170:171],v17,26624
M v[100:103],v[44:47],a[204:207],v[100:103]
s_mov_b32 s25, 2359424
C v208,v208,v209
C v209,v210,v211
M v[100:103],v[40:43],a[196:199],v[100:103]
SA m0,s4,118784
C v210,v240,v241
C v211,v242,v243
M v[100:103],v[36:39],a[188:191],v[100:103]
buffer_load_dwordx4 v8, s[52:55], s25 offen lds
M v[100:103],v[32:35],a[180:183],v[100:103]
s_waitcnt lgkmcnt(6)
C v212,v212,v213
C v213,v214,v215
M v[104:107],a[144:147],a[176:179],0
T v[32:33],v18,0
T v[34:35],v18,2048
M v[104:107],a[148:151],a[184:187],v[104:107]
s_mov_b32 s25, 2621568
C v214,v244,v245
C v215,v246,v247
M v[104:107],a[152:155],a[192:195],v[104:107]
s_waitcnt lgkmcnt(2)
T v[36:37],v18,4096
T v[38:39],v18,6144
M v[104:107],a[156:159],a[200:203],v[104:107]
SA m0,s4,122880
T v[40:41],v18,8192
T v[42:43],v18,10240
M v[104:107],a[160:163],a[208:211],v[104:107]
buffer_load_dwordx4 v8, s[52:55], s25 offen lds
M v[104:107],a[164:167],a[216:219],v[104:107]
s_nop 0
T v[44:45],v18,12288
T v[46:47],v18,14336
M v[104:107],a[168:171],a[224:227],v[104:107]
T v[48:49],v18,16384
T v[50:51],v18,18432
M v[108:111],a[168:171],a[228:231],0
s_mov_b32 s25, 2883712
C v216,v216,v217
C v217,v218,v219
M v[108:111],a[164:167],a[220:223],v[108:111]
SA m0,s4,126976
T v[52:53],v18,20480
T v[54:55],v18,22528
M v[108:111],a[160:163],a[212:215],v[108:111]
T v[56:57],v18,24576
T v[58:59],v18,26624
M v[108:111],a[156:159],a[204:207],v[108:111]
buffer_load_dwordx4 v8, s[52:55], s25 offen lds
M v[108:111],a[152:155],a[196:199],v[108:111]
C v218,v248,v249
C v219,v250,v251
M v[108:111],a[148:151],a[188:191],v[108:111]
C v220,v220,v221
C v221,v222,v223
M v[108:111],a[144:147],a[180:183],v[108:111]
s_waitcnt lgkmcnt(6)
C v222,v252,v253
C v223,v254,v255
M v[112:115],v[32:35],a[176:179],0
s_mov_b32 s25, 3145856
T a[144:145],v19,0
T a[146:147],v19,2048
M v[112:115],v[36:39],a[184:187],v[112:115]
SA m0,s4,32768
v_min_u32 v29, 1, v0
v_lshlrev_b32 v29, 29, v29
M v[112:115],v[40:43],a[192:195],v[112:115]
s_waitcnt lgkmcnt(2)
T a[148:149],v19,4096
T a[150:151],v19,6144
M v[112:115],v[44:47],a[200:203],v[112:115]
T a[152:153],v19,8192
T a[154:155],v19,10240
M v[112:115],v[48:51],a[208:211],v[112:115]
buffer_load_dwordx4 v8, s[52:55], s25 offen lds
M v[112:115],v[52:55],a[216:219],v[112:115]
s_nop 0
T a[156:157],v19,12288
T a[158:159],v19,14336
M v[112:115],v[56:59],a[224:227],v[112:115]
T a[160:161],v19,16384
T a[162:163],v19,18432
M v[116:119],v[56:59],a[228:231],0
s_mov_b32 s25, 3408000
v_mov_b32 v30, 1
v_add_u32 v20, 0x10000, v16
M v[116:119],v[52:55],a[220:223],v[116:119]
SA m0,s4,36864
T a[164:165],v19,20480
T a[166:167],v19,22528
M v[116:119],v[48:51],a[212:215],v[116:119]
s_waitcnt vmcnt(5)
T a[168:169],v19,24576
T a[170:171],v19,26624
M v[116:119],v[44:47],a[204:207],v[116:119]
SA s3,s93,524288
buffer_load_dwordx4 v8, s[52:55], s25 offen lds
M v[116:119],v[40:43],a[196:199],v[116:119]
buffer_store_dword v30, v29, s[8:11], s72 offen offset:4 sc1
M v[116:119],v[36:39],a[188:191],v[116:119]
v_add_u32 v21, 0x10000, v17
v_add_u32 v22, 0x10000, v18
M v[116:119],v[32:35],a[180:183],v[116:119]
s_waitcnt lgkmcnt(6)
buffer_store_dwordx4 v[64:67], v7, s[8:11], s3 offen offset:0 sc1
M v[120:123],a[144:147],a[176:179],0
s_mov_b32 s25, 256
T v[32:33],v16,28672
T v[34:35],v16,30720
M v[120:123],a[148:151],a[184:187],v[120:123]
SA m0,s4,65536
v_add_u32 v23, 0x10000, v19
v_or_b32 v1, s20, v0
M v[120:123],a[152:155],a[192:195],v[120:123]
s_waitcnt lgkmcnt(2)
T v[36:37],v12,0
T v[38:39],v12,2048
M v[120:123],a[156:159],a[200:203],v[120:123]
T v[40:41],v12,4096
T v[42:43],v12,6144
M v[120:123],a[160:163],a[208:211],v[120:123]
buffer_load_dwordx4 v8, s[52:55], s25 offen lds
M v[120:123],a[164:167],a[216:219],v[120:123]
s_nop 0
T v[44:45],v12,8192
T v[46:47],v12,10240
M v[120:123],a[168:171],a[224:227],v[120:123]
T v[48:49],v12,12288
T v[50:51],v12,14336
M v[124:127],a[168:171],a[228:231],0
s_mov_b32 s25, 262400
buffer_store_dwordx4 v[68:71], v7, s[8:11], s3 offen offset:2048 sc1
M v[124:127],a[164:167],a[220:223],v[124:127]
SA m0,s4,69632
T v[52:53],v12,16384
T v[54:55],v12,18432
M v[124:127],a[160:163],a[212:215],v[124:127]
T v[56:57],v12,20480
T v[58:59],v12,22528
M v[124:127],a[156:159],a[204:207],v[124:127]
buffer_load_dwordx4 v8, s[52:55], s25 offen lds
M v[124:127],a[152:155],a[196:199],v[124:127]
v_min_u32 v1, 1, v1
v_lshlrev_b32 v1, 29, v1
M v[124:127],a[148:151],a[188:191],v[124:127]
v_min_u32 v9, 15, v0
v_lshlrev_b32 v9, 7, v9
M v[124:127],a[144:147],a[180:183],v[124:127]
s_waitcnt lgkmcnt(6)
M v[96:99],v[32:35],a[232:235],v[96:99]
s_mov_b32 s25, 524544
T a[144:145],v17,28672
T a[146:147],v17,30720
M v[96:99],v[36:39],a[96:99],v[96:99]
SA m0,s4,73728
M v[96:99],v[40:43],a[104:107],v[96:99]
s_waitcnt lgkmcnt(2)
s_nop 0
T a[148:149],v13,0
T a[150:151],v13,2048
M v[96:99],v[44:47],a[112:115],v[96:99]
SA s3,s93,528384
T a[152:153],v13,4096
T a[154:155],v13,6144
M v[96:99],v[48:51],a[120:123],v[96:99]
s_sub_u32 s66, 15, s42
buffer_load_dwordx4 v8, s[52:55], s25 offen lds
M v[96:99],v[52:55],a[128:131],v[96:99]
s_max_u32 s67, s66, s42
T a[156:157],v13,8192
T a[158:159],v13,10240
M v[96:99],v[56:59],a[136:139],v[96:99]
s_min_u32 s66, s66, s42
T a[160:161],v13,12288
T a[162:163],v13,14336
M v[100:103],v[56:59],a[140:143],v[100:103]
s_mov_b32 s25, 786688
buffer_store_dwordx4 v[72:75], v7, s[8:11], s3 offen offset:0 sc1
M v[100:103],v[52:55],a[132:135],v[100:103]
SA m0,s4,77824
T a[164:165],v13,16384
L_w_kv18:
s_cbranch_execz L_wd2
T a[166:167],v13,18432
M v[100:103],v[48:51],a[124:127],v[100:103]
s_mul_i32 s21, s41, 1048576
T a[168:169],v13,20480
T a[170:171],v13,22528
M v[100:103],v[44:47],a[116:119],v[100:103]
s_lshl_b32 s64, s67, 16
buffer_load_dwordx4 v8, s[52:55], s25 offen lds
M v[100:103],v[40:43],a[108:111],v[100:103]
SA s32,s21,s64
M v[100:103],v[36:39],a[100:103],v[100:103]
s_lshl_b32 s64, s20, 14
buffer_store_dwordx4 v[76:79], v7, s[8:11], s3 offen offset:2048 sc1
M v[100:103],v[32:35],a[236:239],v[100:103]
s_waitcnt lgkmcnt(6)
M v[104:107],a[144:147],a[232:235],v[104:107]
s_mov_b32 s25, 1048832
T v[32:33],v18,28672
T v[34:35],v18,30720
M v[104:107],a[148:151],a[96:99],v[104:107]
SA m0,s4,81920
M v[104:107],a[152:155],a[104:107],v[104:107]
s_waitcnt lgkmcnt(2)
s_nop 0
T v[36:37],v14,0
T v[38:39],v14,2048
M v[104:107],a[156:159],a[112:115],v[104:107]
SA s32,s32,s64
T v[40:41],v14,4096
T v[42:43],v14,6144
M v[104:107],a[160:163],a[120:123],v[104:107]
SA s32,s32,33554432
buffer_load_dwordx4 v8, s[52:55], s25 offen lds
M v[104:107],a[164:167],a[128:131],v[104:107]
s_sub_u32 s64, s42, 10
T v[44:45],v14,8192
T v[46:47],v14,10240
M v[104:107],a[168:171],a[136:139],v[104:107]
s_and_b32 s35, s64, 536870912
T v[48:49],v14,12288
T v[50:51],v14,14336
M v[108:111],a[168:171],a[140:143],v[108:111]
s_mov_b32 s25, 1310976
v_or_b32 v6, s35, v7
M v[108:111],a[164:167],a[132:135],v[108:111]
SA m0,s4,86016
T v[52:53],v14,16384
T v[54:55],v14,18432
M v[108:111],a[160:163],a[124:127],v[108:111]
s_lshl_b32 s28, s20, 13
T v[56:57],v14,20480
T v[58:59],v14,22528
M v[108:111],a[156:159],a[116:119],v[108:111]
buffer_load_dwordx4 v8, s[52:55], s25 offen lds
M v[108:111],a[152:155],a[108:111],v[108:111]
v_add_u32 v2, 0x10000, v7
v_add_u32 v3, s28, v7
M v[108:111],a[148:151],a[100:103],v[108:111]
v_add_u32 v4, 0x1000, v3
MF v96,s5,v96
M v[108:111],a[144:147],a[236:239],v[108:111]
s_waitcnt lgkmcnt(6)
MF v97,s5,v97
MF v98,s5,v98
M v[112:115],v[32:35],a[232:235],v[112:115]
s_mov_b32 s25, 1573120
T a[144:145],v19,28672
T a[146:147],v19,30720
M v[112:115],v[36:39],a[96:99],v[112:115]
SA m0,s4,90112
MF v99,s5,v99
MF v104,s5,v104
M v[112:115],v[40:43],a[104:107],v[112:115]
s_waitcnt lgkmcnt(2)
T a[148:149],v15,0
T a[150:151],v15,2048
M v[112:115],v[44:47],a[112:115],v[112:115]
s_lshl_b32 s64, s42, 16
T a[152:153],v15,4096
T a[154:155],v15,6144
M v[112:115],v[48:51],a[120:123],v[112:115]
SA s23,s21,s64
buffer_load_dwordx4 v8, s[52:55], s25 offen lds
M v[112:115],v[52:55],a[128:131],v[112:115]
SA s43,s23,16777216
T a[156:157],v15,8192
T a[158:159],v15,10240
M v[112:115],v[56:59],a[136:139],v[112:115]
SA s26,s21,16777216
T a[160:161],v15,12288
T a[162:163],v15,14336
M v[116:119],v[56:59],a[140:143],v[116:119]
s_mov_b32 s25, 1835264
MF v105,s5,v105
MF v106,s5,v106
M v[116:119],v[52:55],a[132:135],v[116:119]
SA m0,s4,94208
T a[164:165],v15,16384
T a[166:167],v15,18432
M v[116:119],v[48:51],a[124:127],v[116:119]
s_min_u32 s27, s42, 9
T a[168:169],v15,20480
T a[170:171],v15,22528
M v[116:119],v[44:47],a[116:119],v[116:119]
s_lshl_b32 s22, s27, 1
buffer_load_dwordx4 v8, s[52:55], s25 offen lds
M v[116:119],v[40:43],a[108:111],v[116:119]
s_sub_u32 s22, s22, 1
MF v107,s5,v107
C v96,v96,v97
M v[116:119],v[36:39],a[100:103],v[116:119]
s_waitcnt vmcnt(13) lgkmcnt(0)
C v97,v98,v99
C v98,v104,v105
M v[116:119],v[32:35],a[236:239],v[116:119]
s_barrier
M v[120:123],a[144:147],a[232:235],v[120:123]
s_mov_b32 s25, 2097408
T v[32:33],v16,49152
T v[34:35],v16,51200
M v[120:123],a[148:151],a[96:99],v[120:123]
SA m0,s4,155648
C v99,v106,v107
W a0,v96
M v[120:123],a[152:155],a[104:107],v[120:123]
s_sub_u32 s27, s27, 2
T v[36:37],v16,53248
T v[38:39],v16,55296
M v[120:123],a[156:159],a[112:115],v[120:123]
s_mov_b32 s31, 0x4b800000
T v[40:41],v16,57344
T v[42:43],v16,59392
M v[120:123],a[160:163],a[120:123],v[120:123]
s_mov_b32 s24, 0x33800000
buffer_load_dwordx4 v8, s[52:55], s25 offen lds
M v[120:123],a[164:167],a[128:131],v[120:123]
s_lshl_b32 s47, s66, 7
T v[44:45],v16,61440
T v[46:47],v16,63488
M v[120:123],a[168:171],a[136:139],v[120:123]
SA s47,s47,s46
T v[48:49],v20,32768
T v[50:51],v20,34816
M v[124:127],a[168:171],a[140:143],v[124:127]
s_mov_b32 s25, 2359552
W a1,v97
W a2,v98
M v[124:127],a[164:167],a[132:135],v[124:127]
SA m0,s4,159744
T v[52:53],v20,36864
T v[54:55],v20,38912
M v[124:127],a[160:163],a[124:127],v[124:127]
s_lshl_b32 s64, s20, 5
T v[56:57],v20,40960
T v[58:59],v20,43008
M v[124:127],a[156:159],a[116:119],v[124:127]
SA s47,s47,s64
buffer_load_dwordx4 v8, s[52:55], s25 offen lds
M v[124:127],a[152:155],a[108:111],v[124:127]
SA s47,s47,2048
W a3,v99
MF v100,s5,v100
M v[124:127],a[148:151],a[100:103],v[124:127]
SA s30,s32,0
buffer_store_dwordx4 a[0:3], v6, s[8:11], s30 offen offset:0 sc1
M v[124:127],a[144:147],a[236:239],v[124:127]
s_waitcnt lgkmcnt(6)
MF v101,s5,v101
MF v102,s5,v102
M v[160:163],v[32:35],a[176:179],0
s_lshl_b32 s65, s41, 3
T a[144:145],v17,49152
T a[146:147],v17,51200
M v[160:163],v[36:39],a[184:187],v[160:163]
SA s65,s65,s66
MF v103,s5,v103
MF v108,s5,v108
M v[160:163],v[40:43],a[192:195],v[160:163]
s_waitcnt lgkmcnt(2)
T a[148:149],v17,53248
T a[150:151],v17,55296
M v[160:163],v[44:47],a[200:203],v[160:163]
s_mul_i32 s34, s65, 73728
T a[152:153],v17,57344
T a[154:155],v17,59392
M v[160:163],v[48:51],a[208:211],v[160:163]
SA s34,s34,136314880
MF v109,s5,v109
MF v110,s5,v110
M v[160:163],v[52:55],a[216:219],v[160:163]
s_lshl_b32 s65, s42, 4
T a[156:157],v17,61440
T a[158:159],v17,63488
M v[160:163],v[56:59],a[224:227],v[160:163]
SA s65,s65,s41
T a[160:161],v21,32768
T a[162:163],v21,34816
M v[164:167],v[56:59],a[228:231],0
s_mul_i32 s33, s65, 114688
MF v111,s5,v111
C v100,v100,v101
M v[164:167],v[52:55],a[220:223],v[164:167]
s_mul_i32 s65, s20, 28672
T a[164:165],v21,36864
T a[166:167],v21,38912
M v[164:167],v[48:51],a[212:215],v[164:167]
SA s33,s33,s65
T a[168:169],v21,40960
T a[170:171],v21,43008
M v[164:167],v[44:47],a[204:207],v[164:167]
SA s33,s33,67108864
C v101,v102,v103
C v102,v108,v109
M v[164:167],v[40:43],a[196:199],v[164:167]
s_mov_b32 s6, 0
C v103,v110,v111
W a32,v100
M v[164:167],v[36:39],a[188:191],v[164:167]
s_mov_b32 s7, 1
W a33,v101
W a34,v102
M v[164:167],v[32:35],a[180:183],v[164:167]
s_waitcnt lgkmcnt(6)
W a35,v103
MF v112,s5,v112
M v[168:171],a[144:147],a[176:179],0
SA s30,s32,8192
T v[32:33],v18,49152
T v[34:35],v18,51200
M v[168:171],a[148:151],a[184:187],v[168:171]
s_mov_b32 s40, 1
buffer_store_dwordx4 a[32:35], v6, s[8:11], s30 offen offset:0 sc1
M v[168:171],a[152:155],a[192:195],v[168:171]
s_waitcnt lgkmcnt(2)
s_nop 0
T v[36:37],v18,53248
T v[38:39],v18,55296
M v[168:171],a[156:159],a[200:203],v[168:171]
s_cmp_eq_u32 s20, 0
T v[40:41],v18,57344
T v[42:43],v18,59392
M v[168:171],a[160:163],a[208:211],v[168:171]
s_cselect_b32 s39, 6, 0
MF v113,s5,v113
MF v114,s5,v114
M v[168:171],a[164:167],a[216:219],v[168:171]
s_cmp_eq_u32 s42, 8
T v[44:45],v18,61440
T v[46:47],v18,63488
M v[168:171],a[168:171],a[224:227],v[168:171]
s_cselect_b32 s64, 0, 0
T v[48:49],v22,32768
T v[50:51],v22,34816
M v[172:175],a[168:171],a[228:231],0
s_or_b32 s39, s39, s64
MF v115,s5,v115
MF v120,s5,v120
M v[172:175],a[164:167],a[220:223],v[172:175]
s_mov_b64 s[60:61], s[76:77]
T v[52:53],v22,36864
T v[54:55],v22,38912
M v[172:175],a[160:163],a[212:215],v[172:175]
s_mov_b32 s62, s78
T v[56:57],v22,40960
T v[58:59],v22,43008
M v[172:175],a[156:159],a[204:207],v[172:175]
s_mov_b32 s63, 0x20000
v_lshrrev_b32 v24, 4, v0
v_lshlrev_b32 v24, 2, v24
M v[172:175],a[152:155],a[196:199],v[172:175]
s_mov_b32 s25, 2621696
v_and_b32 v25, 15, v0
v_sub_u32 v24, v24, v25
M v[172:175],a[148:151],a[188:191],v[172:175]
SA m0,s4,131072
v_cmp_lt_i32 s[16:17], 0, v24
v_cmp_lt_i32 s[18:19], -1, v24
M v[172:175],a[144:147],a[180:183],v[172:175]
s_waitcnt lgkmcnt(6)
buffer_load_dwordx4 v8, s[52:55], s25 offen lds
M v[176:179],v[32:35],a[176:179],0
SA s3,s93,532480
T a[144:145],v19,49152
T a[146:147],v19,51200
M v[176:179],v[36:39],a[184:187],v[176:179]
v_cmp_lt_i32 s[48:49], -2, v24
v_cmp_lt_i32 s[50:51], -3, v24
M v[176:179],v[40:43],a[192:195],v[176:179]
s_waitcnt lgkmcnt(2)
T a[148:149],v19,53248
T a[150:151],v19,55296
M v[176:179],v[44:47],a[200:203],v[176:179]
s_mov_b32 s25, 2883840
T a[152:153],v19,57344
T a[154:155],v19,59392
M v[176:179],v[48:51],a[208:211],v[176:179]
SA m0,s4,135168
buffer_store_dwordx4 v[80:83], v7, s[8:11], s3 offen offset:0 sc1
M v[176:179],v[52:55],a[216:219],v[176:179]
s_nop 0
T a[156:157],v19,61440
T a[158:159],v19,63488
M v[176:179],v[56:59],a[224:227],v[176:179]
T a[160:161],v23,32768
T a[162:163],v23,34816
M v[180:183],v[56:59],a[228:231],0
buffer_load_dwordx4 v8, s[52:55], s25 offen lds
M v[180:183],v[52:55],a[220:223],v[180:183]
s_nop 0
T a[164:165],v23,36864
T a[166:167],v23,38912
M v[180:183],v[48:51],a[212:215],v[180:183]
T a[168:169],v23,40960
T a[170:171],v23,43008
M v[180:183],v[44:47],a[204:207],v[180:183]
s_mov_b32 s25, 3145984
buffer_store_dwordx4 v[84:87], v7, s[8:11], s3 offen offset:2048 sc1
M v[180:183],v[40:43],a[196:199],v[180:183]
SA m0,s4,139264
v_lshl_add_u32 v25, v0, 7, s95
v_and_b32 v0, 48, v0
M v[180:183],v[36:39],a[188:191],v[180:183]
buffer_load_dwordx4 v8, s[52:55], s25 offen lds
M v[180:183],v[32:35],a[180:183],v[180:183]
s_waitcnt lgkmcnt(6)
MF v121,s5,v121
MF v122,s5,v122
M v[184:187],a[144:147],a[176:179],0
T v[32:33],v20,45056
T v[34:35],v20,47104
M v[184:187],a[148:151],a[184:187],v[184:187]
s_mov_b32 s25, 3408128
MF v123,s5,v123
C v112,v112,v113
M v[184:187],a[152:155],a[192:195],v[184:187]
s_waitcnt lgkmcnt(2)
T v[36:37],v20,49152
T v[38:39],v20,51200
M v[184:187],a[156:159],a[200:203],v[184:187]
SA m0,s4,143360
T v[40:41],v20,53248
T v[42:43],v20,55296
M v[184:187],a[160:163],a[208:211],v[184:187]
SA s3,s93,536576
buffer_load_dwordx4 v8, s[52:55], s25 offen lds
M v[184:187],a[164:167],a[216:219],v[184:187]
s_nop 0
T v[44:45],v20,57344
T v[46:47],v20,59392
M v[184:187],a[168:171],a[224:227],v[184:187]
T v[48:49],v20,61440
T v[50:51],v20,63488
M v[188:191],a[168:171],a[228:231],0
s_mov_b32 s25, 384
buffer_store_dwordx4 v[88:91], v7, s[8:11], s3 offen offset:0 sc1
M v[188:191],a[164:167],a[220:223],v[188:191]
SA m0,s4,0
T v[52:53],v16,32768
T v[54:55],v16,34816
M v[188:191],a[160:163],a[212:215],v[188:191]
T v[56:57],v16,36864
T v[58:59],v16,38912
M v[188:191],a[156:159],a[204:207],v[188:191]
buffer_load_dwordx4 v8, s[52:55], s25 offen lds
M v[188:191],a[152:155],a[196:199],v[188:191]
C v113,v114,v115
C v114,v120,v121
M v[188:191],a[148:151],a[188:191],v[188:191]
buffer_store_dwordx4 v[92:95], v7, s[8:11], s3 offen offset:2048 sc1
M v[188:191],a[144:147],a[180:183],v[188:191]
s_waitcnt lgkmcnt(6)
C v115,v122,v123
W a4,v112
M v[160:163],v[32:35],a[232:235],v[160:163]
s_mov_b32 s25, 262528
T a[144:145],v21,45056
T a[146:147],v21,47104
M v[160:163],v[36:39],a[96:99],v[160:163]
SA m0,s4,4096
W a5,v113
W a6,v114
M v[160:163],v[40:43],a[104:107],v[160:163]
s_waitcnt lgkmcnt(2)
T a[148:149],v21,49152
T a[150:151],v21,51200
M v[160:163],v[44:47],a[112:115],v[160:163]
T a[152:153],v21,53248
T a[154:155],v21,55296
M v[160:163],v[48:51],a[120:123],v[160:163]
buffer_load_dwordx4 v8, s[52:55], s25 offen lds
M v[160:163],v[52:55],a[128:131],v[160:163]
s_nop 0
T a[156:157],v21,57344
T a[158:159],v21,59392
M v[160:163],v[56:59],a[136:139],v[160:163]
T a[160:161],v21,61440
T a[162:163],v21,63488
M v[164:167],v[56:59],a[140:143],v[164:167]
s_mov_b32 s25, 524672
W a7,v115
v_lshl_add_u32 v0, v0, 24, v25
M v[164:167],v[52:55],a[132:135],v[164:167]
SA s30,s32,0
T a[164:165],v17,32768
T a[166:167],v17,34816
M v[164:167],v[48:51],a[124:127],v[164:167]
SA m0,s4,8192
T a[168:169],v17,36864
T a[170:171],v17,38912
M v[164:167],v[44:47],a[116:119],v[164:167]
buffer_store_dwordx4 a[4:7], v6, s[8:11], s30 offen offset:1024 sc1
M v[164:167],v[40:43],a[108:111],v[164:167]
v_mov_b32 v24, 0x3f80
MF v116,s5,v116
M v[164:167],v[36:39],a[100:103],v[164:167]
buffer_load_dwordx4 v8, s[52:55], s25 offen lds
M v[164:167],v[32:35],a[236:239],v[164:167]
s_waitcnt lgkmcnt(6)
MF v117,s5,v117
MF v118,s5,v118
M v[168:171],a[144:147],a[232:235],v[168:171]
T v[32:33],v22,45056
T v[34:35],v22,47104
M v[168:171],a[148:151],a[96:99],v[168:171]
s_mov_b32 s25, 786816
MF v119,s5,v119
MF v124,s5,v124
M v[168:171],a[152:155],a[104:107],v[168:171]
s_waitcnt lgkmcnt(2)
T v[36:37],v22,49152
T v[38:39],v22,51200
M v[168:171],a[156:159],a[112:115],v[168:171]
SA m0,s4,12288
T v[40:41],v22,53248
T v[42:43],v22,55296
M v[168:171],a[160:163],a[120:123],v[168:171]
buffer_load_dwordx4 v8, s[52:55], s25 offen lds
M v[168:171],a[164:167],a[128:131],v[168:171]
s_nop 0
T v[44:45],v22,57344
T v[46:47],v22,59392
M v[168:171],a[168:171],a[136:139],v[168:171]
T v[48:49],v22,61440
T v[50:51],v22,63488
M v[172:175],a[168:171],a[140:143],v[172:175]
s_mov_b32 s25, 1048960
MF v125,s5,v125
MF v126,s5,v126
M v[172:175],a[164:167],a[132:135],v[172:175]
SA m0,s4,16384
T v[52:53],v18,32768
T v[54:55],v18,34816
M v[172:175],a[160:163],a[124:127],v[172:175]
T v[56:57],v18,36864
T v[58:59],v18,38912
M v[172:175],a[156:159],a[116:119],v[172:175]
buffer_load_dwordx4 v8, s[52:55], s25 offen lds
M v[172:175],a[152:155],a[108:111],v[172:175]
MF v127,s5,v127
C v116,v116,v117
M v[172:175],a[148:151],a[100:103],v[172:175]
v_lshrrev_b32 v25, 8, v7
v_bfe_u32 v26, v7, 6, 2
v_and_b32 v27, 16, v7
v_lshlrev_b32 v27, v27, v24
v_cmp_eq_u32 vcc, v25, v26
v_and_b32 v28, 32, v7
W a244,0
v_cndmask_b32 v27, 0, v27, vcc
v_cmp_eq_u32 vcc, 0, v28
W a245,0
W a248,0
v_cndmask_b32 v25, 0, v27, vcc
v_sub_u32 v26, v27, v25
W a249,0
W a246,v25
W a247,v26
M v[172:175],a[144:147],a[236:239],v[172:175]
s_waitcnt lgkmcnt(6)
C v117,v118,v119
C v118,v124,v125
M v[176:179],v[32:35],a[232:235],v[176:179]
s_mov_b32 s25, 1311104
T a[144:145],v23,45056
T a[146:147],v23,47104
M v[176:179],v[36:39],a[96:99],v[176:179]
SA m0,s4,20480
C v119,v126,v127
W a36,v116
M v[176:179],v[40:43],a[104:107],v[176:179]
s_waitcnt lgkmcnt(2)
T a[148:149],v23,49152
T a[150:151],v23,51200
M v[176:179],v[44:47],a[112:115],v[176:179]
T a[152:153],v23,53248
T a[154:155],v23,55296
M v[176:179],v[48:51],a[120:123],v[176:179]
buffer_load_dwordx4 v8, s[52:55], s25 offen lds
M v[176:179],v[52:55],a[128:131],v[176:179]
s_nop 0
T a[156:157],v23,57344
T a[158:159],v23,59392
M v[176:179],v[56:59],a[136:139],v[176:179]
T a[160:161],v23,61440
T a[162:163],v23,63488
M v[180:183],v[56:59],a[140:143],v[180:183]
s_mov_b32 s25, 1573248
W a37,v117
W a38,v118
M v[180:183],v[52:55],a[132:135],v[180:183]
SA m0,s4,24576
T a[164:165],v19,32768
T a[166:167],v19,34816
M v[180:183],v[48:51],a[124:127],v[180:183]
T a[168:169],v19,36864
T a[170:171],v19,38912
M v[180:183],v[44:47],a[116:119],v[180:183]
buffer_load_dwordx4 v8, s[52:55], s25 offen lds
M v[180:183],v[40:43],a[108:111],v[180:183]
W a39,v119
MF v160,s5,v160
M v[180:183],v[36:39],a[100:103],v[180:183]
s_waitcnt vmcnt(10) lgkmcnt(0)
MF v161,s5,v161
MF v162,s5,v162
M v[180:183],v[32:35],a[236:239],v[180:183]
s_barrier
M v[184:187],a[144:147],a[232:235],v[184:187]
SA s30,s32,8192
T v[32:33],v20,0
T v[34:35],v20,2048
M v[184:187],a[148:151],a[96:99],v[184:187]
s_mov_b32 s25, 1835392
buffer_store_dwordx4 a[36:39], v6, s[8:11], s30 offen offset:1024 sc1
M v[184:187],a[152:155],a[104:107],v[184:187]
SA m0,s4,28672
T v[36:37],v20,4096
T v[38:39],v20,6144
M v[184:187],a[156:159],a[112:115],v[184:187]
T v[40:41],v20,8192
T v[42:43],v20,10240
M v[184:187],a[160:163],a[120:123],v[184:187]
buffer_load_dwordx4 v8, s[52:55], s25 offen lds
M v[184:187],a[164:167],a[128:131],v[184:187]
s_nop 0
T v[44:45],v20,12288
T v[46:47],v20,14336
M v[184:187],a[168:171],a[136:139],v[184:187]
T v[48:49],v20,16384
T v[50:51],v20,18432
M v[188:191],a[168:171],a[140:143],v[188:191]
s_mov_b32 s25, 2097536
MF v163,s5,v163
MF v168,s5,v168
M v[188:191],a[164:167],a[132:135],v[188:191]
SA m0,s4,40960
T v[52:53],v20,20480
T v[54:55],v20,22528
M v[188:191],a[160:163],a[124:127],v[188:191]
T v[56:57],v20,24576
T v[58:59],v20,26624
M v[188:191],a[156:159],a[116:119],v[188:191]
buffer_load_dwordx4 v8, s[52:55], s25 offen lds
M v[188:191],a[152:155],a[108:111],v[188:191]
MF v169,s5,v169
MF v170,s5,v170
M v[188:191],a[148:151],a[100:103],v[188:191]
MF v171,s5,v171
C v160,v160,v161
M v[188:191],a[144:147],a[236:239],v[188:191]
s_waitcnt lgkmcnt(6)
C v161,v162,v163
C v162,v168,v169
M v[96:99],v[32:35],a[176:179],0
s_mov_b32 s25, 2359680
T a[144:145],v21,0
T a[146:147],v21,2048
M v[96:99],v[36:39],a[184:187],v[96:99]
SA m0,s4,45056
C v163,v170,v171
W a8,v160
M v[96:99],v[40:43],a[192:195],v[96:99]
s_waitcnt lgkmcnt(2)
T a[148:149],v21,4096
T a[150:151],v21,6144
M v[96:99],v[44:47],a[200:203],v[96:99]
T a[152:153],v21,8192
T a[154:155],v21,10240
M v[96:99],v[48:51],a[208:211],v[96:99]
buffer_load_dwordx4 v8, s[52:55], s25 offen lds
M v[96:99],v[52:55],a[216:219],v[96:99]
s_nop 0
T a[156:157],v21,12288
T a[158:159],v21,14336
M v[96:99],v[56:59],a[224:227],v[96:99]
T a[160:161],v21,16384
T a[162:163],v21,18432
M v[100:103],v[56:59],a[228:231],0
s_mov_b32 s25, 2621824
W a9,v161
W a10,v162
M v[100:103],v[52:55],a[220:223],v[100:103]
SA m0,s4,49152
T a[164:165],v21,20480
T a[166:167],v21,22528
M v[100:103],v[48:51],a[212:215],v[100:103]
T a[168:169],v21,24576
T a[170:171],v21,26624
M v[100:103],v[44:47],a[204:207],v[100:103]
buffer_load_dwordx4 v8, s[52:55], s25 offen lds
M v[100:103],v[40:43],a[196:199],v[100:103]
W a11,v163
v_lshrrev_b32 v31, 6, v7
M v[100:103],v[36:39],a[188:191],v[100:103]
SA s30,s32,0
buffer_store_dwordx4 a[8:11], v6, s[8:11], s30 offen offset:2048 sc1
M v[100:103],v[32:35],a[180:183],v[100:103]
s_waitcnt lgkmcnt(6)
v_bfe_u32 v28, v7, 4, 2
v_lshlrev_b32 v31, 5, v31
M v[104:107],a[144:147],a[176:179],0
s_mov_b32 s25, 2883968
T v[32:33],v22,0
T v[34:35],v22,2048
M v[104:107],a[148:151],a[184:187],v[104:107]
SA m0,s4,53248
v_add_lshl_u32 v31, v31, v28, 2
MF v164,s5,v164
M v[104:107],a[152:155],a[192:195],v[104:107]
s_waitcnt lgkmcnt(2)
T v[36:37],v22,4096
T v[38:39],v22,6144
M v[104:107],a[156:159],a[200:203],v[104:107]
T v[40:41],v22,8192
T v[42:43],v22,10240
M v[104:107],a[160:163],a[208:211],v[104:107]
buffer_load_dword v5, v31, s[8:11], s46 offen offset:4 sc1
M v[104:107],a[164:167],a[216:219],v[104:107]
s_nop 0
T v[44:45],v22,12288
T v[46:47],v22,14336
M v[104:107],a[168:171],a[224:227],v[104:107]
T v[48:49],v22,16384
T v[50:51],v22,18432
M v[108:111],a[168:171],a[228:231],0
buffer_load_dwordx4 v8, s[52:55], s25 offen lds
M v[108:111],a[164:167],a[220:223],v[108:111]
s_nop 0
T v[52:53],v22,20480
T v[54:55],v22,22528
M v[108:111],a[160:163],a[212:215],v[108:111]
T v[56:57],v22,24576
T v[58:59],v22,26624
M v[108:111],a[156:159],a[204:207],v[108:111]
s_mov_b32 s25, 3146112
MF v165,s5,v165
MF v166,s5,v166
M v[108:111],a[152:155],a[196:199],v[108:111]
SA m0,s4,57344
MF v167,s5,v167
MF v172,s5,v172
M v[108:111],a[148:151],a[188:191],v[108:111]
buffer_load_dwordx4 v8, s[52:55], s25 offen lds
M v[108:111],a[144:147],a[180:183],v[108:111]
s_waitcnt lgkmcnt(6)
MF v173,s5,v173
MF v174,s5,v174
M v[112:115],v[32:35],a[176:179],0
T a[144:145],v23,0
T a[146:147],v23,2048
M v[112:115],v[36:39],a[184:187],v[112:115]
s_mov_b32 s25, 3408256
MF v175,s5,v175
C v164,v164,v165
M v[112:115],v[40:43],a[192:195],v[112:115]
s_waitcnt lgkmcnt(2)
T a[148:149],v23,4096
T a[150:151],v23,6144
M v[112:115],v[44:47],a[200:203],v[112:115]
SA m0,s4,61440
T a[152:153],v23,8192
T a[154:155],v23,10240
M v[112:115],v[48:51],a[208:211],v[112:115]
buffer_load_dwordx4 v8, s[52:55], s25 offen lds
M v[112:115],v[52:55],a[216:219],v[112:115]
s_nop 0
T a[156:157],v23,12288
T a[158:159],v23,14336
M v[112:115],v[56:59],a[224:227],v[112:115]
T a[160:161],v23,16384
T a[162:163],v23,18432
M v[116:119],v[56:59],a[228:231],0
C v165,v166,v167
C v166,v172,v173
M v[116:119],v[52:55],a[220:223],v[116:119]
T a[164:165],v23,20480
T a[166:167],v23,22528
M v[116:119],v[48:51],a[212:215],v[116:119]
T a[168:169],v23,24576
T a[170:171],v23,26624
M v[116:119],v[44:47],a[204:207],v[116:119]
C v167,v174,v175
W a40,v164
M v[116:119],v[40:43],a[196:199],v[116:119]
W a41,v165
W a42,v166
M v[116:119],v[36:39],a[188:191],v[116:119]
W a43,v167
v_mov_b32 v8, 0xff800000
M v[116:119],v[32:35],a[180:183],v[116:119]
s_waitcnt lgkmcnt(6)
MF v176,s5,v176
MF v177,s5,v177
M v[120:123],a[144:147],a[176:179],0
SA s30,s32,8192
T v[32:33],v20,28672
T v[34:35],v20,30720
M v[120:123],a[148:151],a[184:187],v[120:123]
buffer_store_dwordx4 a[40:43], v6, s[8:11], s30 offen offset:2048 sc1
M v[120:123],a[152:155],a[192:195],v[120:123]
s_waitcnt lgkmcnt(2)
s_nop 0
T v[36:37],v12,24576
T v[38:39],v12,26624
M v[120:123],a[156:159],a[200:203],v[120:123]
T v[40:41],v12,28672
T v[42:43],v12,30720
M v[120:123],a[160:163],a[208:211],v[120:123]
MF v178,s5,v178
MF v179,s5,v179
M v[120:123],a[164:167],a[216:219],v[120:123]
T v[44:45],v12,0
T v[46:47],v12,2048
M v[120:123],a[168:171],a[224:227],v[120:123]
T v[48:49],v12,4096
T v[50:51],v12,6144
M v[124:127],a[168:171],a[228:231],0
MF v184,s5,v184
MF v185,s5,v185
M v[124:127],a[164:167],a[220:223],v[124:127]
T v[52:53],v12,8192
T v[54:55],v12,10240
M v[124:127],a[160:163],a[212:215],v[124:127]
T v[56:57],v12,12288
T v[58:59],v12,14336
M v[124:127],a[156:159],a[204:207],v[124:127]
MF v186,s5,v186
MF v187,s5,v187
M v[124:127],a[152:155],a[196:199],v[124:127]
C v176,v176,v177
C v177,v178,v179
M v[124:127],a[148:151],a[188:191],v[124:127]
C v178,v184,v185
C v179,v186,v187
M v[124:127],a[144:147],a[180:183],v[124:127]
s_waitcnt lgkmcnt(6)
W a12,v176
W a13,v177
M v[96:99],v[32:35],a[232:235],v[96:99]
T a[144:145],v21,28672
T a[146:147],v21,30720
M v[96:99],v[36:39],a[96:99],v[96:99]
W a14,v178
W a15,v179
M v[96:99],v[40:43],a[104:107],v[96:99]
s_waitcnt lgkmcnt(2)
T a[148:149],v13,24576
T a[150:151],v13,26624
M v[96:99],v[44:47],a[112:115],v[96:99]
SA s30,s32,0
T a[152:153],v13,28672
T a[154:155],v13,30720
M v[96:99],v[48:51],a[120:123],v[96:99]
buffer_store_dwordx4 a[12:15], v6, s[8:11], s30 offen offset:3072 sc1
M v[96:99],v[52:55],a[128:131],v[96:99]
s_nop 0
T a[156:157],v13,0
T a[158:159],v13,2048
M v[96:99],v[56:59],a[136:139],v[96:99]
T a[160:161],v13,4096
T a[162:163],v13,6144
M v[100:103],v[56:59],a[140:143],v[100:103]
MF v180,s5,v180
MF v181,s5,v181
M v[100:103],v[52:55],a[132:135],v[100:103]
T a[164:165],v13,8192
T a[166:167],v13,10240
M v[100:103],v[48:51],a[124:127],v[100:103]
T a[168:169],v13,12288
T a[170:171],v13,14336
M v[100:103],v[44:47],a[116:119],v[100:103]
MF v182,s5,v182
MF v183,s5,v183
M v[100:103],v[40:43],a[108:111],v[100:103]
MF v188,s5,v188
MF v189,s5,v189
M v[100:103],v[36:39],a[100:103],v[100:103]
MF v190,s5,v190
MF v191,s5,v191
M v[100:103],v[32:35],a[236:239],v[100:103]
s_waitcnt lgkmcnt(6)
C v180,v180,v181
C v181,v182,v183
M v[104:107],a[144:147],a[232:235],v[104:107]
T v[32:33],v22,28672
T v[34:35],v22,30720
M v[104:107],a[148:151],a[96:99],v[104:107]
C v182,v188,v189
C v183,v190,v191
M v[104:107],a[152:155],a[104:107],v[104:107]
s_waitcnt lgkmcnt(2)
T v[36:37],v14,24576
T v[38:39],v14,26624
M v[104:107],a[156:159],a[112:115],v[104:107]
T v[40:41],v14,28672
T v[42:43],v14,30720
M v[104:107],a[160:163],a[120:123],v[104:107]
W a44,v180
W a45,v181
M v[104:107],a[164:167],a[128:131],v[104:107]
T v[44:45],v14,0
T v[46:47],v14,2048
M v[104:107],a[168:171],a[136:139],v[104:107]
T v[48:49],v14,4096
T v[50:51],v14,6144
M v[108:111],a[168:171],a[140:143],v[108:111]
W a46,v182
W a47,v183
M v[108:111],a[164:167],a[132:135],v[108:111]
SA s30,s32,8192
T v[52:53],v14,8192
T v[54:55],v14,10240
M v[108:111],a[160:163],a[124:127],v[108:111]
T v[56:57],v14,12288
T v[58:59],v14,14336
M v[108:111],a[156:159],a[116:119],v[108:111]
buffer_store_dwordx4 a[44:47], v6, s[8:11], s30 offen offset:3072 sc1
M v[108:111],a[152:155],a[108:111],v[108:111]
s_waitcnt vmcnt(6)
v_cmp_ne_u32 vcc, 1, v5
MF v96,s5,v96
M v[108:111],a[148:151],a[100:103],v[108:111]
s_nop 0
MF v97,s5,v97
MF v98,s5,v98
M v[108:111],a[144:147],a[236:239],v[108:111]
s_waitcnt lgkmcnt(6)
MF v99,s5,v99
MF v104,s5,v104
M v[112:115],v[32:35],a[232:235],v[112:115]
s_cmp_lg_u32 vcc_lo, 0
T a[144:145],v23,28672
T a[146:147],v23,30720
M v[112:115],v[36:39],a[96:99],v[112:115]
s_cbranch_scc1 L_wsq1
L_wrq1:
MF v105,s5,v105
MF v106,s5,v106
M v[112:115],v[40:43],a[104:107],v[112:115]
s_waitcnt lgkmcnt(2)
T a[148:149],v15,24576
T a[150:151],v15,26624
M v[112:115],v[44:47],a[112:115],v[112:115]
SA m0,s28,98304
T a[152:153],v15,28672
T a[154:155],v15,30720
M v[112:115],v[48:51],a[120:123],v[112:115]
buffer_load_dwordx4 v3, s[8:11], s21 offen offset:0 sc1 lds
M v[112:115],v[52:55],a[128:131],v[112:115]
s_nop 0
T a[156:157],v15,0
T a[158:159],v15,2048
M v[112:115],v[56:59],a[136:139],v[112:115]
T a[160:161],v15,4096
T a[162:163],v15,6144
M v[116:119],v[56:59],a[140:143],v[116:119]
buffer_load_dwordx4 v3, s[8:11], s21 offen offset:1024 sc1 lds
M v[116:119],v[52:55],a[132:135],v[116:119]
s_nop 0
T a[164:165],v15,8192
T a[166:167],v15,10240
M v[116:119],v[48:51],a[124:127],v[116:119]
T a[168:169],v15,12288
T a[170:171],v15,14336
M v[116:119],v[44:47],a[116:119],v[116:119]
buffer_load_dwordx4 v3, s[8:11], s21 offen offset:2048 sc1 lds
M v[116:119],v[40:43],a[108:111],v[116:119]
MF v107,s5,v107
C v96,v96,v97
M v[116:119],v[36:39],a[100:103],v[116:119]
s_waitcnt vmcnt(6) lgkmcnt(0)
buffer_load_dwordx4 v3, s[8:11], s21 offen offset:3072 sc1 lds
M v[116:119],v[32:35],a[236:239],v[116:119]
s_barrier
M v[120:123],a[144:147],a[232:235],v[120:123]
SA m0,s28,102400
T v[32:33],v16,0
T v[34:35],v16,2048
M v[120:123],a[148:151],a[96:99],v[120:123]
buffer_load_dwordx4 v4, s[8:11], s21 offen offset:0 sc1 lds
M v[120:123],a[152:155],a[104:107],v[120:123]
s_nop 0
T v[36:37],v16,4096
T v[38:39],v16,6144
M v[120:123],a[156:159],a[112:115],v[120:123]
T v[40:41],v16,8192
T v[42:43],v16,10240
M v[120:123],a[160:163],a[120:123],v[120:123]
buffer_load_dwordx4 v4, s[8:11], s21 offen offset:1024 sc1 lds
M v[120:123],a[164:167],a[128:131],v[120:123]
s_nop 0
T v[44:45],v16,12288
T v[46:47],v16,14336
M v[120:123],a[168:171],a[136:139],v[120:123]
T v[48:49],v16,16384
T v[50:51],v16,18432
M v[124:127],a[168:171],a[140:143],v[124:127]
buffer_load_dwordx4 v4, s[8:11], s21 offen offset:2048 sc1 lds
M v[124:127],a[164:167],a[132:135],v[124:127]
s_nop 0
T v[52:53],v16,20480
T v[54:55],v16,22528
M v[124:127],a[160:163],a[124:127],v[124:127]
T v[56:57],v16,24576
T v[58:59],v16,26624
M v[124:127],a[156:159],a[116:119],v[124:127]
buffer_load_dwordx4 v4, s[8:11], s21 offen offset:3072 sc1 lds
M v[124:127],a[152:155],a[108:111],v[124:127]
SA s21,s21,32768
C v97,v98,v99
C v98,v104,v105
M v[124:127],a[148:151],a[100:103],v[124:127]
s_sub_u32 s22, s22, 1
C v99,v106,v107
W a16,v96
M v[124:127],a[144:147],a[236:239],v[124:127]
s_waitcnt lgkmcnt(6)
W a17,v97
W a18,v98
M v[160:163],v[32:35],a[176:179],0
s_cselect_b32 s21, s23, s21
T a[144:145],v17,0
T a[146:147],v17,2048
M v[160:163],v[36:39],a[184:187],v[160:163]
SA m0,s28,65536
W a19,v99
MF v100,s5,v100
M v[160:163],v[40:43],a[192:195],v[160:163]
s_waitcnt lgkmcnt(2)
T a[148:149],v17,4096
T a[150:151],v17,6144
M v[160:163],v[44:47],a[200:203],v[160:163]
SA s30,s32,4096
T a[152:153],v17,8192
T a[154:155],v17,10240
M v[160:163],v[48:51],a[208:211],v[160:163]
buffer_store_dwordx4 a[16:19], v6, s[8:11], s30 offen offset:0 sc1
M v[160:163],v[52:55],a[216:219],v[160:163]
s_nop 0
T a[156:157],v17,12288
T a[158:159],v17,14336
M v[160:163],v[56:59],a[224:227],v[160:163]
T a[160:161],v17,16384
T a[162:163],v17,18432
M v[164:167],v[56:59],a[228:231],0
buffer_load_dwordx4 v3, s[8:11], s21 offen offset:0 sc1 lds
M v[164:167],v[52:55],a[220:223],v[164:167]
s_nop 0
T a[164:165],v17,20480
T a[166:167],v17,22528
M v[164:167],v[48:51],a[212:215],v[164:167]
T a[168:169],v17,24576
T a[170:171],v17,26624
M v[164:167],v[44:47],a[204:207],v[164:167]
buffer_load_dwordx4 v3, s[8:11], s21 offen offset:1024 sc1 lds
M v[164:167],v[40:43],a[196:199],v[164:167]
buffer_load_dword v5, v31, s[8:11], s46 offen offset:4 sc1
M v[164:167],v[36:39],a[188:191],v[164:167]
buffer_load_dwordx4 v3, s[8:11], s21 offen offset:2048 sc1 lds
M v[164:167],v[32:35],a[180:183],v[164:167]
s_waitcnt lgkmcnt(6)
MF v101,s5,v101
MF v102,s5,v102
M v[168:171],a[144:147],a[176:179],0
T v[32:33],v18,0
T v[34:35],v18,2048
M v[168:171],a[148:151],a[184:187],v[168:171]
buffer_load_dwordx4 v3, s[8:11], s21 offen offset:3072 sc1 lds
M v[168:171],a[152:155],a[192:195],v[168:171]
s_waitcnt lgkmcnt(2)
s_nop 0
T v[36:37],v18,4096
T v[38:39],v18,6144
M v[168:171],a[156:159],a[200:203],v[168:171]
SA m0,s28,69632
T v[40:41],v18,8192
T v[42:43],v18,10240
M v[168:171],a[160:163],a[208:211],v[168:171]
buffer_load_dwordx4 v4, s[8:11], s21 offen offset:0 sc1 lds
M v[168:171],a[164:167],a[216:219],v[168:171]
s_nop 0
T v[44:45],v18,12288
T v[46:47],v18,14336
M v[168:171],a[168:171],a[224:227],v[168:171]
T v[48:49],v18,16384
T v[50:51],v18,18432
M v[172:175],a[168:171],a[228:231],0
buffer_load_dwordx4 v4, s[8:11], s21 offen offset:1024 sc1 lds
M v[172:175],a[164:167],a[220:223],v[172:175]
s_nop 0
T v[52:53],v18,20480
T v[54:55],v18,22528
M v[172:175],a[160:163],a[212:215],v[172:175]
T v[56:57],v18,24576
T v[58:59],v18,26624
M v[172:175],a[156:159],a[204:207],v[172:175]
buffer_load_dwordx4 v4, s[8:11], s21 offen offset:2048 sc1 lds
M v[172:175],a[152:155],a[196:199],v[172:175]
MF v103,s5,v103
MF v108,s5,v108
M v[172:175],a[148:151],a[188:191],v[172:175]
buffer_load_dwordx4 v4, s[8:11], s21 offen offset:3072 sc1 lds
M v[172:175],a[144:147],a[180:183],v[172:175]
s_waitcnt lgkmcnt(6)
MF v109,s5,v109
MF v110,s5,v110
M v[176:179],v[32:35],a[176:179],0
SA s21,s21,32768
T a[144:145],v19,0
T a[146:147],v19,2048
M v[176:179],v[36:39],a[184:187],v[176:179]
s_sub_u32 s22, s22, 1
MF v111,s5,v111
C v100,v100,v101
M v[176:179],v[40:43],a[192:195],v[176:179]
s_waitcnt lgkmcnt(2)
T a[148:149],v19,4096
T a[150:151],v19,6144
M v[176:179],v[44:47],a[200:203],v[176:179]
s_cselect_b32 s21, s23, s21
T a[152:153],v19,8192
T a[154:155],v19,10240
M v[176:179],v[48:51],a[208:211],v[176:179]
C v101,v102,v103
C v102,v108,v109
M v[176:179],v[52:55],a[216:219],v[176:179]
T a[156:157],v19,12288
T a[158:159],v19,14336
M v[176:179],v[56:59],a[224:227],v[176:179]
T a[160:161],v19,16384
T a[162:163],v19,18432
M v[180:183],v[56:59],a[228:231],0
C v103,v110,v111
W a48,v100
M v[180:183],v[52:55],a[220:223],v[180:183]
T a[164:165],v19,20480
T a[166:167],v19,22528
M v[180:183],v[48:51],a[212:215],v[180:183]
T a[168:169],v19,24576
T a[170:171],v19,26624
M v[180:183],v[44:47],a[204:207],v[180:183]
W a49,v101
W a50,v102
M v[180:183],v[40:43],a[196:199],v[180:183]
W a51,v103
MF v112,s5,v112
M v[180:183],v[36:39],a[188:191],v[180:183]
SA s30,s32,12288
buffer_store_dwordx4 a[48:51], v6, s[8:11], s30 offen offset:0 sc1
M v[180:183],v[32:35],a[180:183],v[180:183]
s_waitcnt lgkmcnt(6)
MF v113,s5,v113
MF v114,s5,v114
M v[184:187],a[144:147],a[176:179],0
T v[32:33],v16,28672
T v[34:35],v16,30720
M v[184:187],a[148:151],a[184:187],v[184:187]
MF v115,s5,v115
MF v120,s5,v120
M v[184:187],a[152:155],a[192:195],v[184:187]
s_waitcnt lgkmcnt(2)
T v[36:37],v16,40960
T v[38:39],v16,43008
M v[184:187],a[156:159],a[200:203],v[184:187]
T v[40:41],v16,45056
T v[42:43],v16,47104
M v[184:187],a[160:163],a[208:211],v[184:187]
MF v121,s5,v121
MF v122,s5,v122
M v[184:187],a[164:167],a[216:219],v[184:187]
T v[44:45],v16,49152
T v[46:47],v16,51200
M v[184:187],a[168:171],a[224:227],v[184:187]
T v[48:49],v16,53248
T v[50:51],v16,55296
M v[188:191],a[168:171],a[228:231],0
MF v123,s5,v123
C v112,v112,v113
M v[188:191],a[164:167],a[220:223],v[188:191]
T v[52:53],v16,57344
T v[54:55],v16,59392
M v[188:191],a[160:163],a[212:215],v[188:191]
T v[56:57],v16,61440
T v[58:59],v16,63488
M v[188:191],a[156:159],a[204:207],v[188:191]
C v113,v114,v115
C v114,v120,v121
M v[188:191],a[152:155],a[196:199],v[188:191]
C v115,v122,v123
W a20,v112
M v[188:191],a[148:151],a[188:191],v[188:191]
W a21,v113
W a22,v114
M v[188:191],a[144:147],a[180:183],v[188:191]
s_waitcnt lgkmcnt(6)
W a23,v115
MF v116,s5,v116
M v[160:163],v[32:35],a[232:235],v[160:163]
SA s30,s32,4096
T a[144:145],v17,28672
T a[146:147],v17,30720
M v[160:163],v[36:39],a[96:99],v[160:163]
buffer_store_dwordx4 a[20:23], v6, s[8:11], s30 offen offset:1024 sc1
M v[160:163],v[40:43],a[104:107],v[160:163]
s_waitcnt lgkmcnt(2)
s_nop 0
T a[148:149],v17,40960
T a[150:151],v17,43008
M v[160:163],v[44:47],a[112:115],v[160:163]
T a[152:153],v17,45056
T a[154:155],v17,47104
M v[160:163],v[48:51],a[120:123],v[160:163]
MF v117,s5,v117
MF v118,s5,v118
M v[160:163],v[52:55],a[128:131],v[160:163]
T a[156:157],v17,49152
T a[158:159],v17,51200
M v[160:163],v[56:59],a[136:139],v[160:163]
T a[160:161],v17,53248
T a[162:163],v17,55296
M v[164:167],v[56:59],a[140:143],v[164:167]
MF v119,s5,v119
MF v124,s5,v124
M v[164:167],v[52:55],a[132:135],v[164:167]
T a[164:165],v17,57344
T a[166:167],v17,59392
M v[164:167],v[48:51],a[124:127],v[164:167]
T a[168:169],v17,61440
T a[170:171],v17,63488
M v[164:167],v[44:47],a[116:119],v[164:167]
MF v125,s5,v125
MF v126,s5,v126
M v[164:167],v[40:43],a[108:111],v[164:167]
MF v127,s5,v127
C v116,v116,v117
M v[164:167],v[36:39],a[100:103],v[164:167]
C v117,v118,v119
C v118,v124,v125
M v[164:167],v[32:35],a[236:239],v[164:167]
s_waitcnt lgkmcnt(6)
C v119,v126,v127
W a52,v116
M v[168:171],a[144:147],a[232:235],v[168:171]
T v[32:33],v18,28672
T v[34:35],v18,30720
M v[168:171],a[148:151],a[96:99],v[168:171]
W a53,v117
W a54,v118
M v[168:171],a[152:155],a[104:107],v[168:171]
s_waitcnt lgkmcnt(2)
T v[36:37],v18,40960
T v[38:39],v18,43008
M v[168:171],a[156:159],a[112:115],v[168:171]
T v[40:41],v18,45056
T v[42:43],v18,47104
M v[168:171],a[160:163],a[120:123],v[168:171]
W a55,v119
s_waitcnt vmcnt(8)
v_cmp_ne_u32 vcc, 1, v5
M v[168:171],a[164:167],a[128:131],v[168:171]
SA s30,s32,12288
T v[44:45],v18,49152
T v[46:47],v18,51200
M v[168:171],a[168:171],a[136:139],v[168:171]
s_nop 0
T v[48:49],v18,53248
T v[50:51],v18,55296
M v[172:175],a[168:171],a[140:143],v[172:175]
s_cmp_lg_u32 vcc_hi, 0
buffer_store_dwordx4 a[52:55], v6, s[8:11], s30 offen offset:1024 sc1
M v[172:175],a[164:167],a[132:135],v[172:175]
s_cbranch_scc1 L_wsr1
L_wrr1:
T v[52:53],v18,57344
T v[54:55],v18,59392
M v[172:175],a[160:163],a[124:127],v[172:175]
SA m0,s28,131072
T v[56:57],v18,61440
T v[58:59],v18,63488
M v[172:175],a[156:159],a[116:119],v[172:175]
buffer_load_dwordx4 v3, s[8:11], s26 offen offset:0 sc1 lds
M v[172:175],a[152:155],a[108:111],v[172:175]
MF v160,s5,v160
MF v161,s5,v161
M v[172:175],a[148:151],a[100:103],v[172:175]
buffer_load_dwordx4 v3, s[8:11], s26 offen offset:1024 sc1 lds
M v[172:175],a[144:147],a[236:239],v[172:175]
s_waitcnt lgkmcnt(6)
MF v162,s5,v162
MF v163,s5,v163
M v[176:179],v[32:35],a[232:235],v[176:179]
T a[144:145],v19,28672
T a[146:147],v19,30720
M v[176:179],v[36:39],a[96:99],v[176:179]
buffer_load_dwordx4 v3, s[8:11], s26 offen offset:2048 sc1 lds
M v[176:179],v[40:43],a[104:107],v[176:179]
s_waitcnt lgkmcnt(2)
s_nop 0
T a[148:149],v19,40960
T a[150:151],v19,43008
M v[176:179],v[44:47],a[112:115],v[176:179]
T a[152:153],v19,45056
T a[154:155],v19,47104
M v[176:179],v[48:51],a[120:123],v[176:179]
buffer_load_dwordx4 v3, s[8:11], s26 offen offset:3072 sc1 lds
M v[176:179],v[52:55],a[128:131],v[176:179]
SA m0,s28,135168
T a[156:157],v19,49152
T a[158:159],v19,51200
M v[176:179],v[56:59],a[136:139],v[176:179]
T a[160:161],v19,53248
T a[162:163],v19,55296
M v[180:183],v[56:59],a[140:143],v[180:183]
buffer_load_dwordx4 v4, s[8:11], s26 offen offset:0 sc1 lds
M v[180:183],v[52:55],a[132:135],v[180:183]
s_nop 0
T a[164:165],v19,57344
T a[166:167],v19,59392
M v[180:183],v[48:51],a[124:127],v[180:183]
T a[168:169],v19,61440
T a[170:171],v19,63488
M v[180:183],v[44:47],a[116:119],v[180:183]
buffer_load_dwordx4 v4, s[8:11], s26 offen offset:1024 sc1 lds
M v[180:183],v[40:43],a[108:111],v[180:183]
MF v168,s5,v168
MF v169,s5,v169
M v[180:183],v[36:39],a[100:103],v[180:183]
s_waitcnt lgkmcnt(0)
buffer_load_dwordx4 v4, s[8:11], s26 offen offset:2048 sc1 lds
M v[180:183],v[32:35],a[236:239],v[180:183]
s_barrier
M v[184:187],a[144:147],a[232:235],v[184:187]
R a[64:67],v2,32768
R a[68:71],v2,33792
M v[184:187],a[148:151],a[96:99],v[184:187]
buffer_load_dwordx4 v4, s[8:11], s26 offen offset:3072 sc1 lds
M v[184:187],a[152:155],a[104:107],v[184:187]
SA s26,s26,32768
MF v170,s5,v170
MF v171,s5,v171
M v[184:187],a[156:159],a[112:115],v[184:187]
R a[72:75],v2,34816
R a[76:79],v2,35840
M v[184:187],a[160:163],a[120:123],v[184:187]
C v160,v160,v161
C v161,v162,v163
M v[184:187],a[164:167],a[128:131],v[184:187]
C v162,v168,v169
C v163,v170,v171
M v[184:187],a[168:171],a[136:139],v[184:187]
R a[80:83],v2,36864
R a[84:87],v2,37888
M v[188:191],a[168:171],a[140:143],v[188:191]
W a24,v160
W a25,v161
M v[188:191],a[164:167],a[132:135],v[188:191]
W a26,v162
W a27,v163
M v[188:191],a[160:163],a[124:127],v[188:191]
SA s30,s32,4096
R a[88:91],v2,38912
R a[92:95],v2,39936
M v[188:191],a[156:159],a[116:119],v[188:191]
buffer_store_dwordx4 a[24:27], v6, s[8:11], s30 offen offset:2048 sc1
M v[188:191],a[152:155],a[108:111],v[188:191]
MF v164,s5,v164
MF v165,s5,v165
M v[188:191],a[148:151],a[100:103],v[188:191]
MF v166,s5,v166
MF v167,s5,v167
M v[188:191],a[144:147],a[236:239],v[188:191]
s_waitcnt lgkmcnt(0)
MF v172,s5,v172
MF v173,s5,v173
MF v174,s5,v174
MF v175,s5,v175
C v164,v164,v165
C v165,v166,v167
C v166,v172,v173
C v167,v174,v175
W a56,v164
W a57,v165
W a58,v166
W a59,v167
SA s30,s32,12288
buffer_store_dwordx4 a[56:59], v6, s[8:11], s30 offen offset:2048 sc1
v_mov_b32 v30, 2
buffer_store_dword v30, v1, s[8:11], s45 offen sc1
M v[64:67],a[64:67],a[0:3],0
R a[96:99],v2,40960
R a[100:103],v2,41984
M v[64:67],a[68:71],a[4:7],v[64:67]
MF v176,s5,v176
MF v177,s5,v177
M v[64:67],a[72:75],a[8:11],v[64:67]
MF v178,s5,v178
MF v179,s5,v179
M v[64:67],a[76:79],a[12:15],v[64:67]
R a[104:107],v2,43008
R a[108:111],v2,44032
M v[64:67],a[80:83],a[16:19],v[64:67]
MF v184,s5,v184
MF v185,s5,v185
MF v186,s5,v186
MF v187,s5,v187
C v176,v176,v177
C v177,v178,v179
C v178,v184,v185
C v179,v186,v187
W a28,v176
W a29,v177
W a30,v178
W a31,v179
M v[64:67],a[84:87],a[20:23],v[64:67]
MF v180,s5,v180
MF v181,s5,v181
M v[64:67],a[88:91],a[24:27],v[64:67]
R a[112:115],v2,45056
R a[116:119],v2,46080
M v[64:67],a[92:95],a[28:31],v[64:67]
MF v182,s5,v182
MF v183,s5,v183
M v[68:71],a[64:67],a[32:35],0
MF v188,s5,v188
MF v189,s5,v189
M v[68:71],a[68:71],a[36:39],v[68:71]
R a[120:123],v2,47104
R a[124:127],v2,48128
M v[68:71],a[72:75],a[40:43],v[68:71]
SA m0,s28,32768
MF v190,s5,v190
MF v191,s5,v191
M v[68:71],a[76:79],a[44:47],v[68:71]
buffer_load_dwordx4 v3, s[8:11], s26 offen offset:0 sc1 lds
M v[68:71],a[80:83],a[48:51],v[68:71]
C v180,v180,v181
C v181,v182,v183
C v182,v188,v189
C v183,v190,v191
W a60,v180
W a61,v181
W a62,v182
W a63,v183
M v[68:71],a[84:87],a[52:55],v[68:71]
SA s30,s32,4096
buffer_store_dwordx4 a[28:31], v6, s[8:11], s30 offen offset:3072 sc1
M v[68:71],a[88:91],a[56:59],v[68:71]
SA s30,s32,12288
E v18,v64
M v[68:71],a[92:95],a[60:63],v[68:71]
s_waitcnt lgkmcnt(0)
buffer_store_dwordx4 a[60:63], v6, s[8:11], s30 offen offset:3072 sc1
M v[72:75],a[96:99],a[0:3],0
R a[64:67],v2,49152
R a[68:71],v2,50176
M v[72:75],a[100:103],a[4:7],v[72:75]
E v19,v65
M v[72:75],a[104:107],a[8:11],v[72:75]
buffer_load_dwordx4 v3, s[8:11], s26 offen offset:1024 sc1 lds
M v[72:75],a[108:111],a[12:15],v[72:75]
R a[72:75],v2,51200
R a[76:79],v2,52224
M v[72:75],a[112:115],a[16:19],v[72:75]
E v20,v66
M v[72:75],a[116:119],a[20:23],v[72:75]
buffer_load_dwordx4 v3, s[8:11], s26 offen offset:2048 sc1 lds
M v[72:75],a[120:123],a[24:27],v[72:75]
R a[80:83],v2,53248
R a[84:87],v2,54272
M v[72:75],a[124:127],a[28:31],v[72:75]
E v21,v67
M v[76:79],a[124:127],a[60:63],0
buffer_load_dwordx4 v3, s[8:11], s26 offen offset:3072 sc1 lds
M v[76:79],a[120:123],a[56:59],v[76:79]
SA m0,s28,36864
R a[88:91],v2,55296
R a[92:95],v2,56320
M v[76:79],a[116:119],a[52:55],v[76:79]
E v22,v68
M v[76:79],a[112:115],a[48:51],v[76:79]
buffer_load_dwordx4 v4, s[8:11], s26 offen offset:0 sc1 lds
M v[76:79],a[108:111],a[44:47],v[76:79]
E v23,v69
M v[76:79],a[104:107],a[40:43],v[76:79]
AF v26,v18,v19
C v40,v18,v19
M v[76:79],a[100:103],a[36:39],v[76:79]
buffer_load_dwordx4 v4, s[8:11], s26 offen offset:1024 sc1 lds
M v[76:79],a[96:99],a[32:35],v[76:79]
s_waitcnt lgkmcnt(0)
v_add_u32 v16, 0x20000, v7
AF v26,v20,v26
M v[80:83],a[64:67],a[0:3],0
R a[96:99],v2,57344
R a[100:103],v2,58368
M v[80:83],a[68:71],a[4:7],v[80:83]
buffer_load_dwordx4 v4, s[8:11], s26 offen offset:2048 sc1 lds
M v[80:83],a[72:75],a[8:11],v[80:83]
E v24,v70
M v[80:83],a[76:79],a[12:15],v[80:83]
R a[104:107],v2,59392
R a[108:111],v2,60416
M v[80:83],a[80:83],a[16:19],v[80:83]
buffer_load_dwordx4 v4, s[8:11], s26 offen offset:3072 sc1 lds
M v[80:83],a[84:87],a[20:23],v[80:83]
SA s26,s26,32768
E v25,v71
M v[80:83],a[88:91],a[24:27],v[80:83]
R a[112:115],v2,61440
R a[116:119],v2,62464
M v[80:83],a[92:95],a[28:31],v[80:83]
E v18,v72
M v[84:87],a[92:95],a[60:63],0
E v19,v73
M v[84:87],a[88:91],a[56:59],v[84:87]
R a[120:123],v2,63488
R a[124:127],v2,64512
M v[84:87],a[84:87],a[52:55],v[84:87]
C v41,v20,v21
AF v26,v21,v26
M v[84:87],a[80:83],a[48:51],v[84:87]
E v20,v74
M v[84:87],a[76:79],a[44:47],v[84:87]
AF v27,v22,v23
C v44,v22,v23
M v[84:87],a[72:75],a[40:43],v[84:87]
AF v27,v24,v27
C v45,v24,v25
M v[84:87],a[68:71],a[36:39],v[84:87]
s_waitcnt vmcnt(24) lgkmcnt(0)
E v21,v75
M v[84:87],a[64:67],a[32:35],v[84:87]
s_barrier
M v[88:91],a[96:99],a[0:3],0
R a[64:67],v2,0
R a[68:71],v2,1024
M v[88:91],a[100:103],a[4:7],v[88:91]
E v22,v76
M v[88:91],a[104:107],a[8:11],v[88:91]
AF v27,v25,v27
AF v26,v18,v26
M v[88:91],a[108:111],a[12:15],v[88:91]
R a[72:75],v2,2048
R a[76:79],v2,3072
M v[88:91],a[112:115],a[16:19],v[88:91]
E v23,v77
M v[88:91],a[116:119],a[20:23],v[88:91]
C v42,v18,v19
AF v26,v19,v26
M v[88:91],a[120:123],a[24:27],v[88:91]
R a[80:83],v2,4096
R a[84:87],v2,5120
M v[88:91],a[124:127],a[28:31],v[88:91]
E v24,v78
M v[92:95],a[124:127],a[60:63],0
AF v26,v20,v26
C v43,v20,v21
M v[92:95],a[120:123],a[56:59],v[92:95]
R a[88:91],v2,6144
R a[92:95],v2,7168
M v[92:95],a[116:119],a[52:55],v[92:95]
E v25,v79
M v[92:95],a[112:115],a[48:51],v[92:95]
AF v26,v21,v26
AF v27,v22,v27
M v[92:95],a[108:111],a[44:47],v[92:95]
C v46,v22,v23
AF v27,v23,v27
M v[92:95],a[104:107],a[40:43],v[92:95]
AF v27,v24,v27
C v47,v24,v25
M v[92:95],a[100:103],a[36:39],v[92:95]
s_waitcnt lgkmcnt(0)
AF v27,v25,v27
M v[92:95],a[96:99],a[32:35],v[92:95]
M v[96:99],a[64:67],a[0:3],0
R a[96:99],v2,8192
R a[100:103],v2,9216
M v[96:99],a[68:71],a[4:7],v[96:99]
SA m0,s28,98304
W a128,v128
W a129,v129
M v[96:99],a[72:75],a[8:11],v[96:99]
buffer_load_dwordx4 v3, s[8:11], s21 offen offset:0 sc1 lds
M v[96:99],a[76:79],a[12:15],v[96:99]
R a[104:107],v2,10240
R a[108:111],v2,11264
M v[96:99],a[80:83],a[16:19],v[96:99]
W a130,v130
v_mov_b32 v30, 0
M v[96:99],a[84:87],a[20:23],v[96:99]
W a131,v131
M v[96:99],a[88:91],a[24:27],v[96:99]
R a[112:115],v2,12288
R a[116:119],v2,13312
M v[96:99],a[92:95],a[28:31],v[96:99]
buffer_load_dwordx4 v3, s[8:11], s21 offen offset:1024 sc1 lds
M v[100:103],a[92:95],a[60:63],0
W a132,v132
v_mov_b32 v31, 0
M v[100:103],a[88:91],a[56:59],v[100:103]
R a[120:123],v2,14336
R a[124:127],v2,15360
M v[100:103],a[84:87],a[52:55],v[100:103]
W a133,v133
W a134,v134
M v[100:103],a[80:83],a[48:51],v[100:103]
buffer_load_dwordx4 v3, s[8:11], s21 offen offset:2048 sc1 lds
M v[100:103],a[76:79],a[44:47],v[100:103]
W a135,v135
M v[100:103],a[72:75],a[40:43],v[100:103]
v_mov_b32 v32, 0
M v[100:103],a[68:71],a[36:39],v[100:103]
W a136,v136
M v[100:103],a[64:67],a[32:35],v[100:103]
s_waitcnt lgkmcnt(0)
buffer_load_dwordx4 v3, s[8:11], s21 offen offset:3072 sc1 lds
M v[104:107],a[96:99],a[0:3],0
SA m0,s28,102400
R a[64:67],v2,16384
R a[68:71],v2,17408
M v[104:107],a[100:103],a[4:7],v[104:107]
W a137,v137
v_mov_b32 v33, 0
M v[104:107],a[104:107],a[8:11],v[104:107]
W a138,v138
M v[104:107],a[108:111],a[12:15],v[104:107]
R a[72:75],v2,18432
R a[76:79],v2,19456
M v[104:107],a[112:115],a[16:19],v[104:107]
buffer_load_dwordx4 v4, s[8:11], s21 offen offset:0 sc1 lds
M v[104:107],a[116:119],a[20:23],v[104:107]
W a139,v139
W a140,v140
M v[104:107],a[120:123],a[24:27],v[104:107]
R a[80:83],v2,20480
R a[84:87],v2,21504
M v[104:107],a[124:127],a[28:31],v[104:107]
buffer_load_dwordx4 v4, s[8:11], s21 offen offset:1024 sc1 lds
M v[108:111],a[124:127],a[60:63],0
v_mov_b32 v34, 0
W a141,v141
M v[108:111],a[120:123],a[56:59],v[108:111]
R a[88:91],v2,22528
R a[92:95],v2,23552
M v[108:111],a[116:119],a[52:55],v[108:111]
buffer_load_dwordx4 v4, s[8:11], s21 offen offset:2048 sc1 lds
M v[108:111],a[112:115],a[48:51],v[108:111]
W a142,v142
W a143,v143
M v[108:111],a[108:111],a[44:47],v[108:111]
v_mov_b32 v35, 0
W a144,v144
M v[108:111],a[104:107],a[40:43],v[108:111]
W a145,v145
M v[108:111],a[100:103],a[36:39],v[108:111]
buffer_load_dwordx4 v4, s[8:11], s21 offen offset:3072 sc1 lds
M v[108:111],a[96:99],a[32:35],v[108:111]
s_waitcnt lgkmcnt(0)
v_mov_b32 v36, 0
W a146,v146
M v[112:115],a[64:67],a[0:3],0
SA s21,s21,32768
R a[96:99],v2,24576
R a[100:103],v2,25600
M v[112:115],a[68:71],a[4:7],v[112:115]
s_sub_u32 s22, s22, 1
W a147,v147
M v[112:115],a[72:75],a[8:11],v[112:115]
s_cselect_b32 s21, s23, s21
E v18,v80
M v[112:115],a[76:79],a[12:15],v[112:115]
R a[104:107],v2,26624
R a[108:111],v2,27648
M v[112:115],a[80:83],a[16:19],v[112:115]
W a148,v148
v_mov_b32 v37, 0
M v[112:115],a[84:87],a[20:23],v[112:115]
W a149,v149
M v[112:115],a[88:91],a[24:27],v[112:115]
R a[112:115],v2,28672
R a[116:119],v2,29696
M v[112:115],a[92:95],a[28:31],v[112:115]
W a150,v150
M v[116:119],a[92:95],a[60:63],0
v_mov_b32 v38, 0
W a151,v151
M v[116:119],a[88:91],a[56:59],v[116:119]
R a[120:123],v2,30720
R a[124:127],v2,31744
M v[116:119],a[84:87],a[52:55],v[116:119]
W a152,v152
M v[116:119],a[80:83],a[48:51],v[116:119]
W a153,v153
M v[116:119],a[76:79],a[44:47],v[116:119]
E v19,v81
M v[116:119],a[72:75],a[40:43],v[116:119]
v_mov_b32 v39, 0
W a154,v154
M v[116:119],a[68:71],a[36:39],v[116:119]
s_waitcnt vmcnt(21) lgkmcnt(0)
E v20,v82
M v[116:119],a[64:67],a[32:35],v[116:119]
s_barrier
M v[120:123],a[96:99],a[0:3],0
R a[64:67],v16,0
R a[68:71],v16,1024
M v[120:123],a[100:103],a[4:7],v[120:123]
W a155,v155
W a156,v156
M v[120:123],a[104:107],a[8:11],v[120:123]
W a157,v157
AF v26,v18,v26
M v[120:123],a[108:111],a[12:15],v[120:123]
R a[72:75],v16,2048
R a[76:79],v16,3072
M v[120:123],a[112:115],a[16:19],v[120:123]
W a158,v158
C v56,v18,v19
M v[120:123],a[116:119],a[20:23],v[120:123]
E v21,v83
M v[120:123],a[120:123],a[24:27],v[120:123]
R a[80:83],v16,4096
R a[84:87],v16,5120
M v[120:123],a[124:127],a[28:31],v[120:123]
W a159,v159
AF v26,v19,v26
M v[124:127],a[124:127],a[60:63],0
E v22,v88
M v[124:127],a[120:123],a[56:59],v[124:127]
R a[88:91],v16,6144
R a[92:95],v16,7168
M v[124:127],a[116:119],a[52:55],v[124:127]
E v23,v89
M v[124:127],a[112:115],a[48:51],v[124:127]
E v24,v90
M v[124:127],a[108:111],a[44:47],v[124:127]
E v25,v91
M v[124:127],a[104:107],a[40:43],v[124:127]
E v18,v84
M v[124:127],a[100:103],a[36:39],v[124:127]
s_waitcnt lgkmcnt(0)
E v19,v85
M v[124:127],a[96:99],a[32:35],v[124:127]
AF v26,v20,v26
C v57,v20,v21
AF v26,v21,v26
AF v26,v22,v26
C v58,v22,v23
AF v26,v23,v26
AF v26,v24,v26
C v59,v24,v25
AF v26,v25,v26
E v20,v86
E v21,v87
AF v27,v18,v27
C v60,v18,v19
AF v27,v19,v27
E v22,v92
E v23,v93
AF v27,v20,v27
C v61,v20,v21
AF v27,v21,v27
E v24,v94
E v25,v95
AF v27,v22,v27
C v62,v22,v23
AF v27,v23,v27
AF v27,v24,v27
C v63,v24,v25
AF v27,v25,v27
v_max_f32 v10, v26, v27
v_min_f32 v11, v26, v27
v_cmp_lt_f32 vcc, s31, v10
v_cmp_gt_f32 s[64:65], s24, v11
s_nop 0
s_or_b64 vcc, vcc, s[64:65]
s_cbranch_vccnz L_stv1
L_rtv1:
M v[128:131],a[64:67],v[40:43],0
R a[96:99],v16,8192
R a[100:103],v16,9216
M v[128:131],a[68:71],v[56:59],v[128:131]
SA m0,s28,65536
W a160,v192
W a161,v193
M v[132:135],a[68:71],v[60:63],0
buffer_load_dwordx4 v3, s[8:11], s21 offen offset:0 sc1 lds
M v[132:135],a[64:67],v[44:47],v[132:135]
R a[104:107],v16,10240
R a[108:111],v16,11264
M v[136:139],a[72:75],v[40:43],0
W a162,v194
W a163,v195
M v[136:139],a[76:79],v[56:59],v[136:139]
W a164,v196
W a165,v197
M v[140:143],a[76:79],v[60:63],0
R a[112:115],v16,12288
R a[116:119],v16,13312
M v[140:143],a[72:75],v[44:47],v[140:143]
buffer_load_dwordx4 v3, s[8:11], s21 offen offset:1024 sc1 lds
M v[144:147],a[80:83],v[40:43],0
W a166,v198
W a167,v199
M v[144:147],a[84:87],v[56:59],v[144:147]
R a[120:123],v16,14336
R a[124:127],v16,15360
M v[148:151],a[84:87],v[60:63],0
W a168,v200
W a169,v201
M v[148:151],a[80:83],v[44:47],v[148:151]
buffer_load_dwordx4 v3, s[8:11], s21 offen offset:2048 sc1 lds
M v[152:155],a[88:91],v[40:43],0
W a170,v202
W a171,v203
M v[152:155],a[92:95],v[56:59],v[152:155]
W a172,v204
W a173,v205
M v[156:159],a[92:95],v[60:63],0
W a174,v206
W a175,v207
M v[156:159],a[88:91],v[44:47],v[156:159]
s_waitcnt lgkmcnt(0)
buffer_load_dwordx4 v3, s[8:11], s21 offen offset:3072 sc1 lds
M v[160:163],a[96:99],v[40:43],0
SA m0,s28,69632
R a[64:67],v16,16384
R a[68:71],v16,17408
M v[160:163],a[100:103],v[56:59],v[160:163]
W a176,v208
W a177,v209
M v[164:167],a[100:103],v[60:63],0
W a178,v210
W a179,v211
M v[164:167],a[96:99],v[44:47],v[164:167]
R a[72:75],v16,18432
R a[76:79],v16,19456
M v[168:171],a[104:107],v[40:43],0
buffer_load_dwordx4 v4, s[8:11], s21 offen offset:0 sc1 lds
M v[168:171],a[108:111],v[56:59],v[168:171]
W a180,v212
W a181,v213
M v[172:175],a[108:111],v[60:63],0
R a[80:83],v16,20480
R a[84:87],v16,21504
M v[172:175],a[104:107],v[44:47],v[172:175]
buffer_load_dwordx4 v4, s[8:11], s21 offen offset:1024 sc1 lds
M v[176:179],a[112:115],v[40:43],0
W a182,v214
W a183,v215
M v[176:179],a[116:119],v[56:59],v[176:179]
R a[88:91],v16,22528
R a[92:95],v16,23552
M v[180:183],a[116:119],v[60:63],0
buffer_load_dwordx4 v4, s[8:11], s21 offen offset:2048 sc1 lds
M v[180:183],a[112:115],v[44:47],v[180:183]
W a184,v216
W a185,v217
M v[184:187],a[120:123],v[40:43],0
W a186,v218
W a187,v219
W a188,v220
W a189,v221
W a190,v222
W a191,v223
M v[184:187],a[124:127],v[56:59],v[184:187]
E v18,v96
M v[188:191],a[124:127],v[60:63],0
buffer_load_dwordx4 v4, s[8:11], s21 offen offset:3072 sc1 lds
M v[188:191],a[120:123],v[44:47],v[188:191]
s_waitcnt lgkmcnt(0)
v_min_u32 v17, 1, v7
v_lshlrev_b32 v17, 29, v17
M v[192:195],a[64:67],v[40:43],0
SA s21,s21,32768
R a[96:99],v16,24576
R a[100:103],v16,25600
M v[192:195],a[68:71],v[56:59],v[192:195]
s_sub_u32 s22, s22, 1
v_mov_b32 v15, 1
AF v30,v26,v30
M v[196:199],a[68:71],v[60:63],0
s_cselect_b32 s21, s23, s21
E v19,v97
M v[196:199],a[64:67],v[44:47],v[196:199]
SA s84,s47,16
R a[104:107],v16,26624
R a[108:111],v16,27648
M v[200:203],a[72:75],v[40:43],0
SA s3,s93,262144
buffer_store_dwordx4 a[128:131], v7, s[8:11], s3 offen offset:0 sc1
M v[200:203],a[76:79],v[56:59],v[200:203]
E v20,v98
M v[204:207],a[76:79],v[60:63],0
R a[112:115],v16,28672
R a[116:119],v16,29696
M v[204:207],a[72:75],v[44:47],v[204:207]
E v21,v99
M v[208:211],a[80:83],v[40:43],0
E v22,v104
M v[208:211],a[84:87],v[56:59],v[208:211]
R a[120:123],v16,30720
R a[124:127],v16,31744
M v[212:215],a[84:87],v[60:63],0
buffer_store_dwordx4 a[132:135], v7, s[8:11], s3 offen offset:2048 sc1
M v[212:215],a[80:83],v[44:47],v[212:215]
E v23,v105
M v[216:219],a[88:91],v[40:43],0
AF v31,v27,v31
AF v28,v18,v19
M v[216:219],a[92:95],v[56:59],v[216:219]
E v24,v106
M v[220:223],a[92:95],v[60:63],0
s_waitcnt vmcnt(10) lgkmcnt(0)
E v25,v107
M v[220:223],a[88:91],v[44:47],v[220:223]
s_barrier
M v[224:227],a[96:99],v[40:43],0
R a[64:67],v2,32768
R a[68:71],v2,33792
M v[224:227],a[100:103],v[56:59],v[224:227]
buffer_store_dword v15, v17, s[8:11], s84 offen sc1
M v[228:231],a[100:103],v[60:63],0
SA s3,s93,266240
C v48,v18,v19
AF v28,v20,v28
M v[228:231],a[96:99],v[44:47],v[228:231]
R a[72:75],v2,34816
R a[76:79],v2,35840
M v[232:235],a[104:107],v[40:43],0
buffer_store_dwordx4 a[136:139], v7, s[8:11], s3 offen offset:0 sc1
M v[232:235],a[108:111],v[56:59],v[232:235]
E v18,v100
M v[236:239],a[108:111],v[60:63],0
R a[80:83],v2,36864
R a[84:87],v2,37888
M v[236:239],a[104:107],v[44:47],v[236:239]
E v19,v101
M v[240:243],a[112:115],v[40:43],0
C v49,v20,v21
AF v28,v21,v28
M v[240:243],a[116:119],v[56:59],v[240:243]
R a[88:91],v2,38912
R a[92:95],v2,39936
M v[244:247],a[116:119],v[60:63],0
E v20,v102
M v[244:247],a[112:115],v[44:47],v[244:247]
E v21,v103
M v[248:251],a[120:123],v[40:43],0
AF v28,v22,v28
C v50,v22,v23
M v[248:251],a[124:127],v[56:59],v[248:251]
AF v28,v23,v28
AF v28,v24,v28
M v[252:255],a[124:127],v[60:63],0
s_waitcnt lgkmcnt(0)
E v22,v108
M v[252:255],a[120:123],v[44:47],v[252:255]
E v23,v109
C v51,v24,v25
AF v28,v25,v28
AF v29,v18,v19
C v52,v18,v19
AF v29,v20,v29
C v53,v20,v21
AF v29,v21,v29
E v24,v110
E v25,v111
AF v29,v22,v29
C v54,v22,v23
AF v29,v23,v29
AF v29,v24,v29
C v55,v24,v25
AF v29,v25,v29
M v[64:67],a[64:67],a[0:3],v[32:35]
R a[96:99],v2,40960
R a[100:103],v2,41984
M v[64:67],a[68:71],a[4:7],v[64:67]
SA m0,s28,0
E v18,v112
M v[64:67],a[72:75],a[8:11],v[64:67]
buffer_load_dwordx4 v3, s[8:11], s26 offen offset:0 sc1 lds
M v[64:67],a[76:79],a[12:15],v[64:67]
R a[104:107],v2,43008
R a[108:111],v2,44032
M v[64:67],a[80:83],a[16:19],v[64:67]
E v19,v113
M v[64:67],a[84:87],a[20:23],v[64:67]
AF v28,v18,v28
C v56,v18,v19
M v[64:67],a[88:91],a[24:27],v[64:67]
R a[112:115],v2,45056
R a[116:119],v2,46080
M v[64:67],a[92:95],a[28:31],v[64:67]
buffer_load_dwordx4 v3, s[8:11], s26 offen offset:1024 sc1 lds
M v[68:71],a[92:95],a[60:63],v[36:39]
E v20,v114
M v[68:71],a[88:91],a[56:59],v[68:71]
R a[120:123],v2,47104
R a[124:127],v2,48128
M v[68:71],a[84:87],a[52:55],v[68:71]
E v21,v115
M v[68:71],a[80:83],a[48:51],v[68:71]
buffer_load_dwordx4 v3, s[8:11], s26 offen offset:2048 sc1 lds
M v[68:71],a[76:79],a[44:47],v[68:71]
AF v28,v19,v28
AF v28,v20,v28
M v[68:71],a[72:75],a[40:43],v[68:71]
C v57,v20,v21
AF v28,v21,v28
M v[68:71],a[68:71],a[36:39],v[68:71]
E v22,v120
M v[68:71],a[64:67],a[32:35],v[68:71]
s_waitcnt lgkmcnt(0)
buffer_load_dwordx4 v3, s[8:11], s26 offen offset:3072 sc1 lds
M v[72:75],a[96:99],a[0:3],v[32:35]
SA m0,s28,4096
R a[64:67],v2,49152
R a[68:71],v2,50176
M v[72:75],a[100:103],a[4:7],v[72:75]
E v23,v121
M v[72:75],a[104:107],a[8:11],v[72:75]
AF v28,v22,v28
C v58,v22,v23
M v[72:75],a[108:111],a[12:15],v[72:75]
R a[72:75],v2,51200
R a[76:79],v2,52224
M v[72:75],a[112:115],a[16:19],v[72:75]
buffer_load_dwordx4 v4, s[8:11], s26 offen offset:0 sc1 lds
M v[72:75],a[116:119],a[20:23],v[72:75]
E v24,v122
M v[72:75],a[120:123],a[24:27],v[72:75]
R a[80:83],v2,53248
R a[84:87],v2,54272
M v[72:75],a[124:127],a[28:31],v[72:75]
buffer_load_dwordx4 v4, s[8:11], s26 offen offset:1024 sc1 lds
M v[76:79],a[124:127],a[60:63],v[36:39]
E v25,v123
M v[76:79],a[120:123],a[56:59],v[76:79]
R a[88:91],v2,55296
R a[92:95],v2,56320
M v[76:79],a[116:119],a[52:55],v[76:79]
buffer_load_dwordx4 v4, s[8:11], s26 offen offset:2048 sc1 lds
M v[76:79],a[112:115],a[48:51],v[76:79]
AF v28,v23,v28
AF v28,v24,v28
M v[76:79],a[108:111],a[44:47],v[76:79]
E v18,v116
M v[76:79],a[104:107],a[40:43],v[76:79]
C v59,v24,v25
AF v28,v25,v28
M v[76:79],a[100:103],a[36:39],v[76:79]
buffer_load_dwordx4 v4, s[8:11], s26 offen offset:3072 sc1 lds
M v[76:79],a[96:99],a[32:35],v[76:79]
s_waitcnt lgkmcnt(0)
E v19,v117
M v[80:83],a[64:67],a[0:3],v[32:35]
SA s26,s26,32768
R a[96:99],v2,57344
R a[100:103],v2,58368
M v[80:83],a[68:71],a[4:7],v[80:83]
AF v29,v18,v29
C v60,v18,v19
M v[80:83],a[72:75],a[8:11],v[80:83]
SA s3,s93,266240
buffer_store_dwordx4 a[140:143], v7, s[8:11], s3 offen offset:2048 sc1
M v[80:83],a[76:79],a[12:15],v[80:83]
R a[104:107],v2,59392
R a[108:111],v2,60416
M v[80:83],a[80:83],a[16:19],v[80:83]
E v20,v118
M v[80:83],a[84:87],a[20:23],v[80:83]
AF v29,v19,v29
M v[80:83],a[88:91],a[24:27],v[80:83]
R a[112:115],v2,61440
R a[116:119],v2,62464
M v[80:83],a[92:95],a[28:31],v[80:83]
E v21,v119
M v[84:87],a[92:95],a[60:63],v[36:39]
AF v29,v20,v29
C v61,v20,v21
M v[84:87],a[88:91],a[56:59],v[84:87]
SA s3,s93,270336
R a[120:123],v2,63488
R a[124:127],v2,64512
M v[84:87],a[84:87],a[52:55],v[84:87]
buffer_store_dwordx4 a[144:147], v7, s[8:11], s3 offen offset:0 sc1
M v[84:87],a[80:83],a[48:51],v[84:87]
E v22,v124
M v[84:87],a[76:79],a[44:47],v[84:87]
AF v29,v21,v29
M v[84:87],a[72:75],a[40:43],v[84:87]
E v23,v125
M v[84:87],a[68:71],a[36:39],v[84:87]
s_waitcnt lgkmcnt(0)
AF v29,v22,v29
C v62,v22,v23
M v[84:87],a[64:67],a[32:35],v[84:87]
s_barrier
M v[88:91],a[96:99],a[0:3],v[32:35]
R a[64:67],v7,32768
R a[68:71],v7,33792
M v[88:91],a[100:103],a[4:7],v[88:91]
E v24,v126
M v[88:91],a[104:107],a[8:11],v[88:91]
AF v29,v23,v29
M v[88:91],a[108:111],a[12:15],v[88:91]
R a[72:75],v7,34816
R a[76:79],v7,35840
M v[88:91],a[112:115],a[16:19],v[88:91]
buffer_store_dwordx4 a[148:151], v7, s[8:11], s3 offen offset:2048 sc1
M v[88:91],a[116:119],a[20:23],v[88:91]
E v25,v127
M v[88:91],a[120:123],a[24:27],v[88:91]
R a[80:83],v7,36864
R a[84:87],v7,37888
M v[88:91],a[124:127],a[28:31],v[88:91]
AF v29,v24,v29
C v63,v24,v25
M v[92:95],a[124:127],a[60:63],v[36:39]
AF v29,v25,v29
M v[92:95],a[120:123],a[56:59],v[92:95]
R a[88:91],v7,38912
R a[92:95],v7,39936
M v[92:95],a[116:119],a[52:55],v[92:95]
v_max_f32 v10, v28, v29
M v[92:95],a[112:115],a[48:51],v[92:95]
v_cmp_lt_f32 vcc, s31, v10
M v[92:95],a[108:111],a[44:47],v[92:95]
M v[92:95],a[104:107],a[40:43],v[92:95]
M v[92:95],a[100:103],a[36:39],v[92:95]
s_waitcnt lgkmcnt(0)
M v[92:95],a[96:99],a[32:35],v[92:95]
s_cbranch_vccnz L_stv2
L_rtv2:
M v[128:131],a[64:67],v[48:51],v[128:131]
R a[96:99],v7,40960
R a[100:103],v7,41984
M v[128:131],a[68:71],v[56:59],v[128:131]
SA m0,s28,98304
E v18,v64
M v[132:135],a[68:71],v[60:63],v[132:135]
buffer_load_dwordx4 v3, s[8:11], s21 offen offset:0 sc1 lds
M v[132:135],a[64:67],v[52:55],v[132:135]
R a[104:107],v7,43008
R a[108:111],v7,44032
M v[136:139],a[72:75],v[48:51],v[136:139]
E v19,v65
M v[136:139],a[76:79],v[56:59],v[136:139]
AF v30,v28,v30
AF v31,v29,v31
M v[140:143],a[76:79],v[60:63],v[140:143]
R a[112:115],v7,45056
R a[116:119],v7,46080
M v[140:143],a[72:75],v[52:55],v[140:143]
buffer_load_dwordx4 v3, s[8:11], s21 offen offset:1024 sc1 lds
M v[144:147],a[80:83],v[48:51],v[144:147]
E v20,v66
M v[144:147],a[84:87],v[56:59],v[144:147]
R a[120:123],v7,47104
R a[124:127],v7,48128
M v[148:151],a[84:87],v[60:63],v[148:151]
AF v26,v18,v19
C v40,v18,v19
M v[148:151],a[80:83],v[52:55],v[148:151]
buffer_load_dwordx4 v3, s[8:11], s21 offen offset:2048 sc1 lds
M v[152:155],a[88:91],v[48:51],v[152:155]
E v21,v67
M v[152:155],a[92:95],v[56:59],v[152:155]
AF v26,v20,v26
C v41,v20,v21
M v[156:159],a[92:95],v[60:63],v[156:159]
AF v26,v21,v26
M v[156:159],a[88:91],v[52:55],v[156:159]
s_waitcnt lgkmcnt(0)
buffer_load_dwordx4 v3, s[8:11], s21 offen offset:3072 sc1 lds
M v[160:163],a[96:99],v[48:51],v[160:163]
SA m0,s28,102400
R a[64:67],v7,49152
R a[68:71],v7,50176
M v[160:163],a[100:103],v[56:59],v[160:163]
E v22,v72
M v[164:167],a[100:103],v[60:63],v[164:167]
E v23,v73
M v[164:167],a[96:99],v[52:55],v[164:167]
R a[72:75],v7,51200
R a[76:79],v7,52224
M v[168:171],a[104:107],v[48:51],v[168:171]
buffer_load_dwordx4 v4, s[8:11], s21 offen offset:0 sc1 lds
M v[168:171],a[108:111],v[56:59],v[168:171]
AF v26,v22,v26
C v42,v22,v23
M v[172:175],a[108:111],v[60:63],v[172:175]
R a[80:83],v7,53248
R a[84:87],v7,54272
M v[172:175],a[104:107],v[52:55],v[172:175]
buffer_load_dwordx4 v4, s[8:11], s21 offen offset:1024 sc1 lds
M v[176:179],a[112:115],v[48:51],v[176:179]
E v24,v74
M v[176:179],a[116:119],v[56:59],v[176:179]
R a[88:91],v7,55296
R a[92:95],v7,56320
M v[180:183],a[116:119],v[60:63],v[180:183]
buffer_load_dwordx4 v4, s[8:11], s21 offen offset:2048 sc1 lds
M v[180:183],a[112:115],v[52:55],v[180:183]
E v25,v75
M v[184:187],a[120:123],v[48:51],v[184:187]
AF v26,v23,v26
AF v26,v24,v26
M v[184:187],a[124:127],v[56:59],v[184:187]
C v43,v24,v25
AF v26,v25,v26
M v[188:191],a[124:127],v[60:63],v[188:191]
buffer_load_dwordx4 v4, s[8:11], s21 offen offset:3072 sc1 lds
M v[188:191],a[120:123],v[52:55],v[188:191]
s_waitcnt lgkmcnt(0)
E v18,v68
M v[192:195],a[64:67],v[48:51],v[192:195]
SA s21,s21,32768
R a[96:99],v7,57344
R a[100:103],v7,58368
M v[192:195],a[68:71],v[56:59],v[192:195]
s_sub_u32 s22, s22, 1
E v19,v69
M v[196:199],a[68:71],v[60:63],v[196:199]
s_cselect_b32 s21, s23, s21
AF v27,v18,v19
C v44,v18,v19
M v[196:199],a[64:67],v[52:55],v[196:199]
SA s3,s93,274432
R a[104:107],v7,59392
R a[108:111],v7,60416
M v[200:203],a[72:75],v[48:51],v[200:203]
buffer_store_dwordx4 a[152:155], v7, s[8:11], s3 offen offset:0 sc1
M v[200:203],a[76:79],v[56:59],v[200:203]
E v20,v70
M v[204:207],a[76:79],v[60:63],v[204:207]
R a[112:115],v7,61440
R a[116:119],v7,62464
M v[204:207],a[72:75],v[52:55],v[204:207]
M v[208:211],a[80:83],v[48:51],v[208:211]
M v[208:211],a[84:87],v[56:59],v[208:211]
R a[120:123],v7,63488
R a[124:127],v7,64512
M v[212:215],a[84:87],v[60:63],v[212:215]
buffer_store_dwordx4 a[156:159], v7, s[8:11], s3 offen offset:2048 sc1
M v[212:215],a[80:83],v[52:55],v[212:215]
E v21,v71
M v[216:219],a[88:91],v[48:51],v[216:219]
AF v27,v20,v27
C v45,v20,v21
M v[216:219],a[92:95],v[56:59],v[216:219]
E v22,v76
M v[220:223],a[92:95],v[60:63],v[220:223]
s_waitcnt vmcnt(25) lgkmcnt(0)
AF v27,v21,v27
M v[220:223],a[88:91],v[52:55],v[220:223]
s_barrier
M v[224:227],a[96:99],v[48:51],v[224:227]
R a[64:67],v2,0
R a[68:71],v2,1024
M v[224:227],a[100:103],v[56:59],v[224:227]
E v23,v77
M v[228:231],a[100:103],v[60:63],v[228:231]
SA s3,s93,786432
AF v27,v22,v27
C v46,v22,v23
M v[228:231],a[96:99],v[52:55],v[228:231]
R a[72:75],v2,2048
R a[76:79],v2,3072
M v[232:235],a[104:107],v[48:51],v[232:235]
buffer_store_dwordx4 a[160:163], v7, s[8:11], s3 offen offset:0 sc1
M v[232:235],a[108:111],v[56:59],v[232:235]
E v24,v78
M v[236:239],a[108:111],v[60:63],v[236:239]
R a[80:83],v2,4096
R a[84:87],v2,5120
M v[236:239],a[104:107],v[52:55],v[236:239]
AF v27,v23,v27
M v[240:243],a[112:115],v[48:51],v[240:243]
E v25,v79
M v[240:243],a[116:119],v[56:59],v[240:243]
R a[88:91],v2,6144
R a[92:95],v2,7168
M v[244:247],a[116:119],v[60:63],v[244:247]
AF v27,v24,v27
C v47,v24,v25
M v[244:247],a[112:115],v[52:55],v[244:247]
AF v27,v25,v27
M v[248:251],a[120:123],v[48:51],v[248:251]
M v[248:251],a[124:127],v[56:59],v[248:251]
M v[252:255],a[124:127],v[60:63],v[252:255]
s_waitcnt lgkmcnt(0)
M v[252:255],a[120:123],v[52:55],v[252:255]
M v[96:99],a[64:67],a[0:3],v[32:35]
R a[96:99],v2,8192
R a[100:103],v2,9216
M v[96:99],a[68:71],a[4:7],v[96:99]
SA m0,s28,32768
E v18,v80
M v[96:99],a[72:75],a[8:11],v[96:99]
buffer_load_dwordx4 v3, s[8:11], s26 offen offset:0 sc1 lds
M v[96:99],a[76:79],a[12:15],v[96:99]
R a[104:107],v2,10240
R a[108:111],v2,11264
M v[96:99],a[80:83],a[16:19],v[96:99]
E v19,v81
M v[96:99],a[84:87],a[20:23],v[96:99]
AF v26,v18,v26
C v56,v18,v19
M v[96:99],a[88:91],a[24:27],v[96:99]
R a[112:115],v2,12288
R a[116:119],v2,13312
M v[96:99],a[92:95],a[28:31],v[96:99]
buffer_load_dwordx4 v3, s[8:11], s26 offen offset:1024 sc1 lds
M v[100:103],a[92:95],a[60:63],v[36:39]
E v20,v82
M v[100:103],a[88:91],a[56:59],v[100:103]
R a[120:123],v2,14336
R a[124:127],v2,15360
M v[100:103],a[84:87],a[52:55],v[100:103]
E v21,v83
M v[100:103],a[80:83],a[48:51],v[100:103]
buffer_load_dwordx4 v3, s[8:11], s26 offen offset:2048 sc1 lds
M v[100:103],a[76:79],a[44:47],v[100:103]
AF v26,v19,v26
AF v26,v20,v26
M v[100:103],a[72:75],a[40:43],v[100:103]
C v57,v20,v21
AF v26,v21,v26
M v[100:103],a[68:71],a[36:39],v[100:103]
E v22,v88
M v[100:103],a[64:67],a[32:35],v[100:103]
s_waitcnt lgkmcnt(0)
buffer_load_dwordx4 v3, s[8:11], s26 offen offset:3072 sc1 lds
M v[104:107],a[96:99],a[0:3],v[32:35]
SA m0,s28,36864
R a[64:67],v2,16384
R a[68:71],v2,17408
M v[104:107],a[100:103],a[4:7],v[104:107]
E v23,v89
M v[104:107],a[104:107],a[8:11],v[104:107]
AF v26,v22,v26
C v58,v22,v23
M v[104:107],a[108:111],a[12:15],v[104:107]
R a[72:75],v2,18432
R a[76:79],v2,19456
M v[104:107],a[112:115],a[16:19],v[104:107]
buffer_load_dwordx4 v4, s[8:11], s26 offen offset:0 sc1 lds
M v[104:107],a[116:119],a[20:23],v[104:107]
E v24,v90
M v[104:107],a[120:123],a[24:27],v[104:107]
R a[80:83],v2,20480
R a[84:87],v2,21504
M v[104:107],a[124:127],a[28:31],v[104:107]
buffer_load_dwordx4 v4, s[8:11], s26 offen offset:1024 sc1 lds
M v[108:111],a[124:127],a[60:63],v[36:39]
E v25,v91
M v[108:111],a[120:123],a[56:59],v[108:111]
R a[88:91],v2,22528
R a[92:95],v2,23552
M v[108:111],a[116:119],a[52:55],v[108:111]
buffer_load_dwordx4 v4, s[8:11], s26 offen offset:2048 sc1 lds
M v[108:111],a[112:115],a[48:51],v[108:111]
AF v26,v23,v26
AF v26,v24,v26
M v[108:111],a[108:111],a[44:47],v[108:111]
E v18,v84
M v[108:111],a[104:107],a[40:43],v[108:111]
C v59,v24,v25
AF v26,v25,v26
M v[108:111],a[100:103],a[36:39],v[108:111]
buffer_load_dwordx4 v4, s[8:11], s26 offen offset:3072 sc1 lds
M v[108:111],a[96:99],a[32:35],v[108:111]
s_waitcnt lgkmcnt(0)
E v19,v85
M v[112:115],a[64:67],a[0:3],v[32:35]
SA s26,s26,32768
R a[96:99],v2,24576
R a[100:103],v2,25600
M v[112:115],a[68:71],a[4:7],v[112:115]
AF v27,v18,v27
C v60,v18,v19
M v[112:115],a[72:75],a[8:11],v[112:115]
SA s3,s93,786432
buffer_store_dwordx4 a[164:167], v7, s[8:11], s3 offen offset:2048 sc1
M v[112:115],a[76:79],a[12:15],v[112:115]
R a[104:107],v2,26624
R a[108:111],v2,27648
M v[112:115],a[80:83],a[16:19],v[112:115]
E v20,v86
M v[112:115],a[84:87],a[20:23],v[112:115]
AF v27,v19,v27
M v[112:115],a[88:91],a[24:27],v[112:115]
R a[112:115],v2,28672
R a[116:119],v2,29696
M v[112:115],a[92:95],a[28:31],v[112:115]
SA s3,s93,790528
E v21,v87
M v[116:119],a[92:95],a[60:63],v[36:39]
buffer_store_dwordx4 a[168:171], v7, s[8:11], s3 offen offset:0 sc1
M v[116:119],a[88:91],a[56:59],v[116:119]
R a[120:123],v2,30720
R a[124:127],v2,31744
M v[116:119],a[84:87],a[52:55],v[116:119]
E v22,v92
M v[116:119],a[80:83],a[48:51],v[116:119]
AF v27,v20,v27
C v61,v20,v21
M v[116:119],a[76:79],a[44:47],v[116:119]
AF v27,v21,v27
M v[116:119],a[72:75],a[40:43],v[116:119]
E v23,v93
M v[116:119],a[68:71],a[36:39],v[116:119]
s_waitcnt vmcnt(24) lgkmcnt(0)
AF v27,v22,v27
C v62,v22,v23
M v[116:119],a[64:67],a[32:35],v[116:119]
s_barrier
M v[120:123],a[96:99],a[0:3],v[32:35]
R a[64:67],v7,0
R a[68:71],v7,1024
M v[120:123],a[100:103],a[4:7],v[120:123]
buffer_store_dwordx4 a[172:175], v7, s[8:11], s3 offen offset:2048 sc1
M v[120:123],a[104:107],a[8:11],v[120:123]
E v24,v94
M v[120:123],a[108:111],a[12:15],v[120:123]
R a[72:75],v7,2048
R a[76:79],v7,3072
M v[120:123],a[112:115],a[16:19],v[120:123]
SA s3,s93,794624
E v25,v95
M v[120:123],a[116:119],a[20:23],v[120:123]
buffer_store_dwordx4 a[176:179], v7, s[8:11], s3 offen offset:0 sc1
M v[120:123],a[120:123],a[24:27],v[120:123]
R a[80:83],v7,4096
R a[84:87],v7,5120
M v[120:123],a[124:127],a[28:31],v[120:123]
AF v27,v23,v27
AF v27,v24,v27
M v[124:127],a[124:127],a[60:63],v[36:39]
C v63,v24,v25
AF v27,v25,v27
M v[124:127],a[120:123],a[56:59],v[124:127]
R a[88:91],v7,6144
R a[92:95],v7,7168
M v[124:127],a[116:119],a[52:55],v[124:127]
v_max_f32 v10, v26, v27
M v[124:127],a[112:115],a[48:51],v[124:127]
v_cmp_lt_f32 vcc, s31, v10
M v[124:127],a[108:111],a[44:47],v[124:127]
M v[124:127],a[104:107],a[40:43],v[124:127]
M v[124:127],a[100:103],a[36:39],v[124:127]
s_waitcnt lgkmcnt(0)
M v[124:127],a[96:99],a[32:35],v[124:127]
s_cbranch_vccnz L_stv3
L_rtv3:
M v[128:131],a[64:67],v[40:43],v[128:131]
R a[96:99],v7,8192
R a[100:103],v7,9216
M v[128:131],a[68:71],v[56:59],v[128:131]
SA m0,s28,65536
E v18,v96
M v[132:135],a[68:71],v[60:63],v[132:135]
buffer_load_dwordx4 v3, s[8:11], s21 offen offset:0 sc1 lds
M v[132:135],a[64:67],v[44:47],v[132:135]
R a[104:107],v7,10240
R a[108:111],v7,11264
M v[136:139],a[72:75],v[40:43],v[136:139]
E v19,v97
M v[136:139],a[76:79],v[56:59],v[136:139]
AF v30,v26,v30
AF v31,v27,v31
M v[140:143],a[76:79],v[60:63],v[140:143]
R a[112:115],v7,12288
R a[116:119],v7,13312
M v[140:143],a[72:75],v[44:47],v[140:143]
buffer_load_dwordx4 v3, s[8:11], s21 offen offset:1024 sc1 lds
M v[144:147],a[80:83],v[40:43],v[144:147]
E v20,v98
M v[144:147],a[84:87],v[56:59],v[144:147]
R a[120:123],v7,14336
R a[124:127],v7,15360
M v[148:151],a[84:87],v[60:63],v[148:151]
AF v28,v18,v19
C v48,v18,v19
M v[148:151],a[80:83],v[44:47],v[148:151]
buffer_load_dwordx4 v3, s[8:11], s21 offen offset:2048 sc1 lds
M v[152:155],a[88:91],v[40:43],v[152:155]
E v21,v99
M v[152:155],a[92:95],v[56:59],v[152:155]
AF v28,v20,v28
C v49,v20,v21
M v[156:159],a[92:95],v[60:63],v[156:159]
AF v28,v21,v28
M v[156:159],a[88:91],v[44:47],v[156:159]
s_waitcnt lgkmcnt(0)
buffer_load_dwordx4 v3, s[8:11], s21 offen offset:3072 sc1 lds
M v[160:163],a[96:99],v[40:43],v[160:163]
SA m0,s28,69632
R a[64:67],v7,16384
R a[68:71],v7,17408
M v[160:163],a[100:103],v[56:59],v[160:163]
E v22,v104
M v[164:167],a[100:103],v[60:63],v[164:167]
E v23,v105
M v[164:167],a[96:99],v[44:47],v[164:167]
R a[72:75],v7,18432
R a[76:79],v7,19456
M v[168:171],a[104:107],v[40:43],v[168:171]
buffer_load_dwordx4 v4, s[8:11], s21 offen offset:0 sc1 lds
M v[168:171],a[108:111],v[56:59],v[168:171]
AF v28,v22,v28
C v50,v22,v23
M v[172:175],a[108:111],v[60:63],v[172:175]
R a[80:83],v7,20480
R a[84:87],v7,21504
M v[172:175],a[104:107],v[44:47],v[172:175]
buffer_load_dwordx4 v4, s[8:11], s21 offen offset:1024 sc1 lds
M v[176:179],a[112:115],v[40:43],v[176:179]
E v24,v106
M v[176:179],a[116:119],v[56:59],v[176:179]
R a[88:91],v7,22528
R a[92:95],v7,23552
M v[180:183],a[116:119],v[60:63],v[180:183]
buffer_load_dwordx4 v4, s[8:11], s21 offen offset:2048 sc1 lds
M v[180:183],a[112:115],v[44:47],v[180:183]
E v25,v107
M v[184:187],a[120:123],v[40:43],v[184:187]
AF v28,v23,v28
AF v28,v24,v28
M v[184:187],a[124:127],v[56:59],v[184:187]
C v51,v24,v25
AF v28,v25,v28
M v[188:191],a[124:127],v[60:63],v[188:191]
buffer_load_dwordx4 v4, s[8:11], s21 offen offset:3072 sc1 lds
M v[188:191],a[120:123],v[44:47],v[188:191]
s_waitcnt lgkmcnt(0)
E v18,v100
M v[192:195],a[64:67],v[40:43],v[192:195]
SA s21,s21,32768
R a[96:99],v7,24576
R a[100:103],v7,25600
M v[192:195],a[68:71],v[56:59],v[192:195]
s_sub_u32 s22, s22, 1
E v19,v101
M v[196:199],a[68:71],v[60:63],v[196:199]
s_cselect_b32 s21, s23, s21
AF v29,v18,v19
C v52,v18,v19
M v[196:199],a[64:67],v[44:47],v[196:199]
SA s3,s93,794624
R a[104:107],v7,26624
R a[108:111],v7,27648
M v[200:203],a[72:75],v[40:43],v[200:203]
buffer_store_dwordx4 a[180:183], v7, s[8:11], s3 offen offset:2048 sc1
M v[200:203],a[76:79],v[56:59],v[200:203]
E v20,v102
M v[204:207],a[76:79],v[60:63],v[204:207]
R a[112:115],v7,28672
R a[116:119],v7,29696
M v[204:207],a[72:75],v[44:47],v[204:207]
M v[208:211],a[80:83],v[40:43],v[208:211]
M v[208:211],a[84:87],v[56:59],v[208:211]
SA s3,s93,798720
R a[120:123],v7,30720
R a[124:127],v7,31744
M v[212:215],a[84:87],v[60:63],v[212:215]
buffer_store_dwordx4 a[184:187], v7, s[8:11], s3 offen offset:0 sc1
M v[212:215],a[80:83],v[44:47],v[212:215]
E v21,v103
M v[216:219],a[88:91],v[40:43],v[216:219]
AF v29,v20,v29
C v53,v20,v21
M v[216:219],a[92:95],v[56:59],v[216:219]
E v22,v108
M v[220:223],a[92:95],v[60:63],v[220:223]
s_waitcnt vmcnt(25) lgkmcnt(0)
AF v29,v21,v29
M v[220:223],a[88:91],v[44:47],v[220:223]
s_barrier
M v[224:227],a[96:99],v[40:43],v[224:227]
R a[64:67],v2,32768
R a[68:71],v2,33792
M v[224:227],a[100:103],v[56:59],v[224:227]
E v23,v109
M v[228:231],a[100:103],v[60:63],v[228:231]
AF v29,v22,v29
C v54,v22,v23
M v[228:231],a[96:99],v[44:47],v[228:231]
R a[72:75],v2,34816
R a[76:79],v2,35840
M v[232:235],a[104:107],v[40:43],v[232:235]
buffer_store_dwordx4 a[188:191], v7, s[8:11], s3 offen offset:2048 sc1
M v[232:235],a[108:111],v[56:59],v[232:235]
E v24,v110
M v[236:239],a[108:111],v[60:63],v[236:239]
R a[80:83],v2,36864
R a[84:87],v2,37888
M v[236:239],a[104:107],v[44:47],v[236:239]
AF v29,v23,v29
M v[240:243],a[112:115],v[40:43],v[240:243]
E v25,v111
M v[240:243],a[116:119],v[56:59],v[240:243]
R a[88:91],v2,38912
R a[92:95],v2,39936
M v[244:247],a[116:119],v[60:63],v[244:247]
AF v29,v24,v29
C v55,v24,v25
M v[244:247],a[112:115],v[44:47],v[244:247]
AF v29,v25,v29
M v[248:251],a[120:123],v[40:43],v[248:251]
M v[248:251],a[124:127],v[56:59],v[248:251]
M v[252:255],a[124:127],v[60:63],v[252:255]
s_waitcnt lgkmcnt(0)
M v[252:255],a[120:123],v[44:47],v[252:255]
s_branch L_loop_top
L_st0:
s_call_b64 s[36:37], L_slow0
s_branch L_rt0
L_st1:
s_call_b64 s[36:37], L_slow1
s_branch L_rt1
L_stv1:
s_call_b64 s[36:37], L_slowf
s_branch L_rtv1
L_stk1:
s_call_b64 s[36:37], L_slowf
s_branch L_rtk1
L_sth1:
s_call_b64 s[36:37], L_slowf
s_branch L_rth1
L_stj0:
s_call_b64 s[36:37], L_slowj
s_branch L_rtj0
L_stv2:
s_call_b64 s[36:37], L_slow1
s_branch L_rtv2
L_stv3:
s_call_b64 s[36:37], L_slow0
s_branch L_rtv3
L_std1:
s_call_b64 s[36:37], L_slow1
s_branch L_rtd1
L_std3n:
s_call_b64 s[36:37], L_slow0
s_branch L_rtd3n
L_std3h:
s_call_b64 s[36:37], L_slow0
s_branch L_rtd3h
L_std4n:
s_call_b64 s[36:37], L_slowb
s_branch L_rtd4n
L_std4h:
s_call_b64 s[36:37], L_slowb
s_branch L_rtd4h
L_stfh:
s_call_b64 s[36:37], L_slow1n
s_branch L_rtfh
L_stc:
s_call_b64 s[36:37], L_comb
s_branch L_rtc
L_slow0:
s_nop 7
s_nop 3
v_max3_f32 v10, v64, v65, v66
v_max3_f32 v10, v67, v72, v10
v_max3_f32 v10, v73, v74, v10
v_max3_f32 v10, v75, v80, v10
v_max3_f32 v10, v81, v82, v10
v_max3_f32 v10, v83, v88, v10
v_max3_f32 v10, v89, v90, v10
v_max_f32 v10, v91, v10
v_max3_f32 v11, v68, v69, v70
v_max3_f32 v11, v71, v76, v11
v_max3_f32 v11, v77, v78, v11
v_max3_f32 v11, v79, v84, v11
v_max3_f32 v11, v85, v86, v11
v_max3_f32 v11, v87, v92, v11
v_max3_f32 v11, v93, v94, v11
v_max_f32 v11, v95, v11
v_mov_b32 v12, v10
v_mov_b32 v13, v11
s_nop 0
v_permlane16_swap_b32 v12, v10
v_permlane16_swap_b32 v13, v11
v_max_f32 v10, v12, v10
v_max_f32 v11, v13, v11
v_mov_b32 v12, v10
v_mov_b32 v13, v11
s_nop 0
v_permlane32_swap_b32 v12, v10
v_permlane32_swap_b32 v13, v11
v_max_f32 v10, v12, v10
v_max_f32 v11, v13, v11
v_ceil_f32 v10, v10
v_ceil_f32 v11, v11
v_max_f32 v10, 0, v10
v_max_f32 v11, 0, v11
v_sub_f32 v64, v64, v10
v_sub_f32 v65, v65, v10
v_sub_f32 v66, v66, v10
v_sub_f32 v67, v67, v10
v_sub_f32 v68, v68, v11
v_sub_f32 v69, v69, v11
v_sub_f32 v70, v70, v11
v_sub_f32 v71, v71, v11
v_sub_f32 v72, v72, v10
v_sub_f32 v73, v73, v10
v_sub_f32 v74, v74, v10
v_sub_f32 v75, v75, v10
v_sub_f32 v76, v76, v11
v_sub_f32 v77, v77, v11
v_sub_f32 v78, v78, v11
v_sub_f32 v79, v79, v11
v_sub_f32 v80, v80, v10
v_sub_f32 v81, v81, v10
v_sub_f32 v82, v82, v10
v_sub_f32 v83, v83, v10
v_sub_f32 v84, v84, v11
v_sub_f32 v85, v85, v11
v_sub_f32 v86, v86, v11
v_sub_f32 v87, v87, v11
v_sub_f32 v88, v88, v10
v_sub_f32 v89, v89, v10
v_sub_f32 v90, v90, v10
v_sub_f32 v91, v91, v10
v_sub_f32 v92, v92, v11
v_sub_f32 v93, v93, v11
v_sub_f32 v94, v94, v11
v_sub_f32 v95, v95, v11
v_sub_f32 v96, v96, v10
v_sub_f32 v97, v97, v10
v_sub_f32 v98, v98, v10
v_sub_f32 v99, v99, v10
v_sub_f32 v100, v100, v11
v_sub_f32 v101, v101, v11
v_sub_f32 v102, v102, v11
v_sub_f32 v103, v103, v11
v_sub_f32 v104, v104, v10
v_sub_f32 v105, v105, v10
v_sub_f32 v106, v106, v10
v_sub_f32 v107, v107, v10
v_sub_f32 v108, v108, v11
v_sub_f32 v109, v109, v11
v_sub_f32 v110, v110, v11
v_sub_f32 v111, v111, v11
v_sub_f32 v112, v112, v10
v_sub_f32 v113, v113, v10
v_sub_f32 v114, v114, v10
v_sub_f32 v115, v115, v10
v_sub_f32 v116, v116, v11
v_sub_f32 v117, v117, v11
v_sub_f32 v118, v118, v11
v_sub_f32 v119, v119, v11
v_sub_f32 v120, v120, v10
v_sub_f32 v121, v121, v10
v_sub_f32 v122, v122, v10
v_sub_f32 v123, v123, v10
v_sub_f32 v124, v124, v11
v_sub_f32 v125, v125, v11
v_sub_f32 v126, v126, v11
v_sub_f32 v127, v127, v11
v_sub_f32 v32, v32, v10
v_sub_f32 v33, v33, v10
v_sub_f32 v34, v34, v10
v_sub_f32 v35, v35, v10
v_sub_f32 v36, v36, v11
v_sub_f32 v37, v37, v11
v_sub_f32 v38, v38, v11
v_sub_f32 v39, v39, v11
E v12,-v10
E v13,-v11
MF v30,v12,v30
MF v31,v13,v31
MF v128,v12,v128
MF v129,v12,v129
MF v130,v12,v130
MF v131,v12,v131
MF v132,v13,v132
MF v133,v13,v133
MF v134,v13,v134
MF v135,v13,v135
MF v136,v12,v136
MF v137,v12,v137
MF v138,v12,v138
MF v139,v12,v139
MF v140,v13,v140
MF v141,v13,v141
MF v142,v13,v142
MF v143,v13,v143
MF v144,v12,v144
MF v145,v12,v145
MF v146,v12,v146
MF v147,v12,v147
MF v148,v13,v148
MF v149,v13,v149
MF v150,v13,v150
MF v151,v13,v151
MF v152,v12,v152
MF v153,v12,v153
MF v154,v12,v154
MF v155,v12,v155
MF v156,v13,v156
MF v157,v13,v157
MF v158,v13,v158
MF v159,v13,v159
MF v160,v12,v160
MF v161,v12,v161
MF v162,v12,v162
MF v163,v12,v163
MF v164,v13,v164
MF v165,v13,v165
MF v166,v13,v166
MF v167,v13,v167
MF v168,v12,v168
MF v169,v12,v169
MF v170,v12,v170
MF v171,v12,v171
MF v172,v13,v172
MF v173,v13,v173
MF v174,v13,v174
MF v175,v13,v175
MF v176,v12,v176
MF v177,v12,v177
MF v178,v12,v178
MF v179,v12,v179
MF v180,v13,v180
MF v181,v13,v181
MF v182,v13,v182
MF v183,v13,v183
MF v184,v12,v184
MF v185,v12,v185
MF v186,v12,v186
MF v187,v12,v187
MF v188,v13,v188
MF v189,v13,v189
MF v190,v13,v190
MF v191,v13,v191
MF v192,v12,v192
MF v193,v12,v193
MF v194,v12,v194
MF v195,v12,v195
MF v196,v13,v196
MF v197,v13,v197
MF v198,v13,v198
MF v199,v13,v199
MF v200,v12,v200
MF v201,v12,v201
MF v202,v12,v202
MF v203,v12,v203
MF v204,v13,v204
MF v205,v13,v205
MF v206,v13,v206
MF v207,v13,v207
MF v208,v12,v208
MF v209,v12,v209
MF v210,v12,v210
MF v211,v12,v211
MF v212,v13,v212
MF v213,v13,v213
MF v214,v13,v214
MF v215,v13,v215
MF v216,v12,v216
MF v217,v12,v217
MF v218,v12,v218
MF v219,v12,v219
MF v220,v13,v220
MF v221,v13,v221
MF v222,v13,v222
MF v223,v13,v223
MF v224,v12,v224
MF v225,v12,v225
MF v226,v12,v226
MF v227,v12,v227
MF v228,v13,v228
MF v229,v13,v229
MF v230,v13,v230
MF v231,v13,v231
MF v232,v12,v232
MF v233,v12,v233
MF v234,v12,v234
MF v235,v12,v235
MF v236,v13,v236
MF v237,v13,v237
MF v238,v13,v238
MF v239,v13,v239
MF v240,v12,v240
MF v241,v12,v241
MF v242,v12,v242
MF v243,v12,v243
MF v244,v13,v244
MF v245,v13,v245
MF v246,v13,v246
MF v247,v13,v247
MF v248,v12,v248
MF v249,v12,v249
MF v250,v12,v250
MF v251,v12,v251
MF v252,v13,v252
MF v253,v13,v253
MF v254,v13,v254
MF v255,v13,v255
E v18,v64
E v19,v65
E v20,v66
AF v26,v18,v19
C v40,v18,v19
E v21,v67
E v22,v72
AF v26,v20,v26
C v41,v20,v21
E v23,v73
AF v26,v21,v26
E v24,v74
AF v26,v22,v26
C v42,v22,v23
E v25,v75
AF v26,v23,v26
E v18,v68
AF v26,v24,v26
C v43,v24,v25
E v19,v69
AF v26,v25,v26
E v20,v70
AF v27,v18,v19
C v44,v18,v19
E v21,v71
E v22,v76
AF v27,v20,v27
C v45,v20,v21
E v23,v77
AF v27,v21,v27
E v24,v78
AF v27,v22,v27
C v46,v22,v23
E v25,v79
AF v27,v23,v27
AF v27,v24,v27
C v47,v24,v25
AF v27,v25,v27
E v18,v80
E v19,v81
E v20,v82
AF v26,v18,v26
C v56,v18,v19
E v21,v83
AF v26,v19,v26
E v22,v88
AF v26,v20,v26
C v57,v20,v21
E v23,v89
AF v26,v21,v26
E v24,v90
AF v26,v22,v26
C v58,v22,v23
E v25,v91
AF v26,v23,v26
E v18,v84
AF v26,v24,v26
C v59,v24,v25
E v19,v85
AF v26,v25,v26
E v20,v86
AF v27,v18,v27
C v60,v18,v19
E v21,v87
AF v27,v19,v27
E v22,v92
AF v27,v20,v27
C v61,v20,v21
E v23,v93
AF v27,v21,v27
E v24,v94
AF v27,v22,v27
C v62,v22,v23
E v25,v95
AF v27,v23,v27
AF v27,v24,v27
C v63,v24,v25
AF v27,v25,v27
s_nop 3
s_setpc_b64 s[36:37]
L_slow1:
s_nop 7
s_nop 3
v_max3_f32 v10, v96, v97, v98
v_max3_f32 v10, v99, v104, v10
v_max3_f32 v10, v105, v106, v10
v_max3_f32 v10, v107, v112, v10
v_max3_f32 v10, v113, v114, v10
v_max3_f32 v10, v115, v120, v10
v_max3_f32 v10, v121, v122, v10
v_max_f32 v10, v123, v10
v_max3_f32 v11, v100, v101, v102
v_max3_f32 v11, v103, v108, v11
v_max3_f32 v11, v109, v110, v11
v_max3_f32 v11, v111, v116, v11
v_max3_f32 v11, v117, v118, v11
v_max3_f32 v11, v119, v124, v11
v_max3_f32 v11, v125, v126, v11
v_max_f32 v11, v127, v11
v_mov_b32 v12, v10
v_mov_b32 v13, v11
s_nop 0
v_permlane16_swap_b32 v12, v10
v_permlane16_swap_b32 v13, v11
v_max_f32 v10, v12, v10
v_max_f32 v11, v13, v11
v_mov_b32 v12, v10
v_mov_b32 v13, v11
s_nop 0
v_permlane32_swap_b32 v12, v10
v_permlane32_swap_b32 v13, v11
v_max_f32 v10, v12, v10
v_max_f32 v11, v13, v11
v_ceil_f32 v10, v10
v_ceil_f32 v11, v11
v_max_f32 v10, 0, v10
v_max_f32 v11, 0, v11
v_sub_f32 v96, v96, v10
v_sub_f32 v97, v97, v10
v_sub_f32 v98, v98, v10
v_sub_f32 v99, v99, v10
v_sub_f32 v100, v100, v11
v_sub_f32 v101, v101, v11
v_sub_f32 v102, v102, v11
v_sub_f32 v103, v103, v11
v_sub_f32 v104, v104, v10
v_sub_f32 v105, v105, v10
v_sub_f32 v106, v106, v10
v_sub_f32 v107, v107, v10
v_sub_f32 v108, v108, v11
v_sub_f32 v109, v109, v11
v_sub_f32 v110, v110, v11
v_sub_f32 v111, v111, v11
v_sub_f32 v112, v112, v10
v_sub_f32 v113, v113, v10
v_sub_f32 v114, v114, v10
v_sub_f32 v115, v115, v10
v_sub_f32 v116, v116, v11
v_sub_f32 v117, v117, v11
v_sub_f32 v118, v118, v11
v_sub_f32 v119, v119, v11
v_sub_f32 v120, v120, v10
v_sub_f32 v121, v121, v10
v_sub_f32 v122, v122, v10
v_sub_f32 v123, v123, v10
v_sub_f32 v124, v124, v11
v_sub_f32 v125, v125, v11
v_sub_f32 v126, v126, v11
v_sub_f32 v127, v127, v11
v_sub_f32 v64, v64, v10
v_sub_f32 v65, v65, v10
v_sub_f32 v66, v66, v10
v_sub_f32 v67, v67, v10
v_sub_f32 v68, v68, v11
v_sub_f32 v69, v69, v11
v_sub_f32 v70, v70, v11
v_sub_f32 v71, v71, v11
v_sub_f32 v72, v72, v10
v_sub_f32 v73, v73, v10
v_sub_f32 v74, v74, v10
v_sub_f32 v75, v75, v10
v_sub_f32 v76, v76, v11
v_sub_f32 v77, v77, v11
v_sub_f32 v78, v78, v11
v_sub_f32 v79, v79, v11
v_sub_f32 v80, v80, v10
v_sub_f32 v81, v81, v10
v_sub_f32 v82, v82, v10
v_sub_f32 v83, v83, v10
v_sub_f32 v84, v84, v11
v_sub_f32 v85, v85, v11
v_sub_f32 v86, v86, v11
v_sub_f32 v87, v87, v11
v_sub_f32 v88, v88, v10
v_sub_f32 v89, v89, v10
v_sub_f32 v90, v90, v10
v_sub_f32 v91, v91, v10
v_sub_f32 v92, v92, v11
v_sub_f32 v93, v93, v11
v_sub_f32 v94, v94, v11
v_sub_f32 v95, v95, v11
v_sub_f32 v32, v32, v10
v_sub_f32 v33, v33, v10
v_sub_f32 v34, v34, v10
v_sub_f32 v35, v35, v10
v_sub_f32 v36, v36, v11
v_sub_f32 v37, v37, v11
v_sub_f32 v38, v38, v11
v_sub_f32 v39, v39, v11
E v12,-v10
E v13,-v11
MF v30,v12,v30
MF v31,v13,v31
MF v128,v12,v128
MF v129,v12,v129
MF v130,v12,v130
MF v131,v12,v131
MF v132,v13,v132
MF v133,v13,v133
MF v134,v13,v134
MF v135,v13,v135
MF v136,v12,v136
MF v137,v12,v137
MF v138,v12,v138
MF v139,v12,v139
MF v140,v13,v140
MF v141,v13,v141
MF v142,v13,v142
MF v143,v13,v143
MF v144,v12,v144
MF v145,v12,v145
MF v146,v12,v146
MF v147,v12,v147
MF v148,v13,v148
MF v149,v13,v149
MF v150,v13,v150
MF v151,v13,v151
MF v152,v12,v152
MF v153,v12,v153
MF v154,v12,v154
MF v155,v12,v155
MF v156,v13,v156
MF v157,v13,v157
MF v158,v13,v158
MF v159,v13,v159
MF v160,v12,v160
MF v161,v12,v161
MF v162,v12,v162
MF v163,v12,v163
MF v164,v13,v164
MF v165,v13,v165
MF v166,v13,v166
MF v167,v13,v167
MF v168,v12,v168
MF v169,v12,v169
MF v170,v12,v170
MF v171,v12,v171
MF v172,v13,v172
MF v173,v13,v173
MF v174,v13,v174
MF v175,v13,v175
MF v176,v12,v176
MF v177,v12,v177
MF v178,v12,v178
MF v179,v12,v179
MF v180,v13,v180
MF v181,v13,v181
MF v182,v13,v182
MF v183,v13,v183
MF v184,v12,v184
MF v185,v12,v185
MF v186,v12,v186
MF v187,v12,v187
MF v188,v13,v188
MF v189,v13,v189
MF v190,v13,v190
MF v191,v13,v191
MF v192,v12,v192
MF v193,v12,v193
MF v194,v12,v194
MF v195,v12,v195
MF v196,v13,v196
MF v197,v13,v197
MF v198,v13,v198
MF v199,v13,v199
MF v200,v12,v200
MF v201,v12,v201
MF v202,v12,v202
MF v203,v12,v203
MF v204,v13,v204
MF v205,v13,v205
MF v206,v13,v206
MF v207,v13,v207
MF v208,v12,v208
MF v209,v12,v209
MF v210,v12,v210
MF v211,v12,v211
MF v212,v13,v212
MF v213,v13,v213
MF v214,v13,v214
MF v215,v13,v215
MF v216,v12,v216
MF v217,v12,v217
MF v218,v12,v218
MF v219,v12,v219
MF v220,v13,v220
MF v221,v13,v221
MF v222,v13,v222
MF v223,v13,v223
MF v224,v12,v224
MF v225,v12,v225
MF v226,v12,v226
MF v227,v12,v227
MF v228,v13,v228
MF v229,v13,v229
MF v230,v13,v230
MF v231,v13,v231
MF v232,v12,v232
MF v233,v12,v233
MF v234,v12,v234
MF v235,v12,v235
MF v236,v13,v236
MF v237,v13,v237
MF v238,v13,v238
MF v239,v13,v239
MF v240,v12,v240
MF v241,v12,v241
MF v242,v12,v242
MF v243,v12,v243
MF v244,v13,v244
MF v245,v13,v245
MF v246,v13,v246
MF v247,v13,v247
MF v248,v12,v248
MF v249,v12,v249
MF v250,v12,v250
MF v251,v12,v251
MF v252,v13,v252
MF v253,v13,v253
MF v254,v13,v254
MF v255,v13,v255
E v18,v96
E v19,v97
E v20,v98
AF v28,v18,v19
C v48,v18,v19
E v21,v99
E v22,v104
AF v28,v20,v28
C v49,v20,v21
E v23,v105
AF v28,v21,v28
E v24,v106
AF v28,v22,v28
C v50,v22,v23
E v25,v107
AF v28,v23,v28
E v18,v100
AF v28,v24,v28
C v51,v24,v25
E v19,v101
AF v28,v25,v28
E v20,v102
AF v29,v18,v19
C v52,v18,v19
E v21,v103
E v22,v108
AF v29,v20,v29
C v53,v20,v21
E v23,v109
AF v29,v21,v29
E v24,v110
AF v29,v22,v29
C v54,v22,v23
E v25,v111
AF v29,v23,v29
AF v29,v24,v29
C v55,v24,v25
AF v29,v25,v29
E v18,v112
E v19,v113
E v20,v114
AF v28,v18,v28
C v56,v18,v19
E v21,v115
AF v28,v19,v28
E v22,v120
AF v28,v20,v28
C v57,v20,v21
E v23,v121
AF v28,v21,v28
E v24,v122
AF v28,v22,v28
C v58,v22,v23
E v25,v123
AF v28,v23,v28
E v18,v116
AF v28,v24,v28
C v59,v24,v25
E v19,v117
AF v28,v25,v28
E v20,v118
AF v29,v18,v29
C v60,v18,v19
E v21,v119
AF v29,v19,v29
E v22,v124
AF v29,v20,v29
C v61,v20,v21
E v23,v125
AF v29,v21,v29
E v24,v126
AF v29,v22,v29
C v62,v22,v23
E v25,v127
AF v29,v23,v29
AF v29,v24,v29
C v63,v24,v25
AF v29,v25,v29
s_nop 3
s_setpc_b64 s[36:37]
L_slow1n:
s_nop 7
s_nop 3
v_max3_f32 v10, v96, v97, v98
v_max3_f32 v10, v99, v104, v10
v_max3_f32 v10, v105, v106, v10
v_max3_f32 v10, v107, v112, v10
v_max3_f32 v10, v113, v114, v10
v_max3_f32 v10, v115, v120, v10
v_max3_f32 v10, v121, v122, v10
v_max_f32 v10, v123, v10
v_max3_f32 v11, v100, v101, v102
v_max3_f32 v11, v103, v108, v11
v_max3_f32 v11, v109, v110, v11
v_max3_f32 v11, v111, v116, v11
v_max3_f32 v11, v117, v118, v11
v_max3_f32 v11, v119, v124, v11
v_max3_f32 v11, v125, v126, v11
v_max_f32 v11, v127, v11
v_mov_b32 v12, v10
v_mov_b32 v13, v11
s_nop 0
v_permlane16_swap_b32 v12, v10
v_permlane16_swap_b32 v13, v11
v_max_f32 v10, v12, v10
v_max_f32 v11, v13, v11
v_mov_b32 v12, v10
v_mov_b32 v13, v11
s_nop 0
v_permlane32_swap_b32 v12, v10
v_permlane32_swap_b32 v13, v11
v_max_f32 v10, v12, v10
v_max_f32 v11, v13, v11
v_ceil_f32 v10, v10
v_ceil_f32 v11, v11
v_max_f32 v10, 0, v10
v_max_f32 v11, 0, v11
v_sub_f32 v96, v96, v10
v_sub_f32 v97, v97, v10
v_sub_f32 v98, v98, v10
v_sub_f32 v99, v99, v10
v_sub_f32 v100, v100, v11
v_sub_f32 v101, v101, v11
v_sub_f32 v102, v102, v11
v_sub_f32 v103, v103, v11
v_sub_f32 v104, v104, v10
v_sub_f32 v105, v105, v10
v_sub_f32 v106, v106, v10
v_sub_f32 v107, v107, v10
v_sub_f32 v108, v108, v11
v_sub_f32 v109, v109, v11
v_sub_f32 v110, v110, v11
v_sub_f32 v111, v111, v11
v_sub_f32 v112, v112, v10
v_sub_f32 v113, v113, v10
v_sub_f32 v114, v114, v10
v_sub_f32 v115, v115, v10
v_sub_f32 v116, v116, v11
v_sub_f32 v117, v117, v11
v_sub_f32 v118, v118, v11
v_sub_f32 v119, v119, v11
v_sub_f32 v120, v120, v10
v_sub_f32 v121, v121, v10
v_sub_f32 v122, v122, v10
v_sub_f32 v123, v123, v10
v_sub_f32 v124, v124, v11
v_sub_f32 v125, v125, v11
v_sub_f32 v126, v126, v11
v_sub_f32 v127, v127, v11
v_sub_f32 v32, v32, v10
v_sub_f32 v33, v33, v10
v_sub_f32 v34, v34, v10
v_sub_f32 v35, v35, v10
v_sub_f32 v36, v36, v11
v_sub_f32 v37, v37, v11
v_sub_f32 v38, v38, v11
v_sub_f32 v39, v39, v11
E v12,-v10
E v13,-v11
MF v30,v12,v30
MF v31,v13,v31
MF v128,v12,v128
MF v129,v12,v129
MF v130,v12,v130
MF v131,v12,v131
MF v132,v13,v132
MF v133,v13,v133
MF v134,v13,v134
MF v135,v13,v135
MF v136,v12,v136
MF v137,v12,v137
MF v138,v12,v138
MF v139,v12,v139
MF v140,v13,v140
MF v141,v13,v141
MF v142,v13,v142
MF v143,v13,v143
MF v144,v12,v144
MF v145,v12,v145
MF v146,v12,v146
MF v147,v12,v147
MF v148,v13,v148
MF v149,v13,v149
MF v150,v13,v150
MF v151,v13,v151
MF v152,v12,v152
MF v153,v12,v153
MF v154,v12,v154
MF v155,v12,v155
MF v156,v13,v156
MF v157,v13,v157
MF v158,v13,v158
MF v159,v13,v159
MF v160,v12,v160
MF v161,v12,v161
MF v162,v12,v162
MF v163,v12,v163
MF v164,v13,v164
MF v165,v13,v165
MF v166,v13,v166
MF v167,v13,v167
MF v168,v12,v168
MF v169,v12,v169
MF v170,v12,v170
MF v171,v12,v171
MF v172,v13,v172
MF v173,v13,v173
MF v174,v13,v174
MF v175,v13,v175
MF v176,v12,v176
MF v177,v12,v177
MF v178,v12,v178
MF v179,v12,v179
MF v180,v13,v180
MF v181,v13,v181
MF v182,v13,v182
MF v183,v13,v183
MF v184,v12,v184
MF v185,v12,v185
MF v186,v12,v186
MF v187,v12,v187
MF v188,v13,v188
MF v189,v13,v189
MF v190,v13,v190
MF v191,v13,v191
MF v192,v12,v192
MF v193,v12,v193
MF v194,v12,v194
MF v195,v12,v195
MF v196,v13,v196
MF v197,v13,v197
MF v198,v13,v198
MF v199,v13,v199
MF v200,v12,v200
MF v201,v12,v201
MF v202,v12,v202
MF v203,v12,v203
MF v204,v13,v204
MF v205,v13,v205
MF v206,v13,v206
MF v207,v13,v207
MF v208,v12,v208
MF v209,v12,v209
MF v210,v12,v210
MF v211,v12,v211
MF v212,v13,v212
MF v213,v13,v213
MF v214,v13,v214
MF v215,v13,v215
MF v216,v12,v216
MF v217,v12,v217
MF v218,v12,v218
MF v219,v12,v219
MF v220,v13,v220
MF v221,v13,v221
MF v222,v13,v222
MF v223,v13,v223
MF v224,v12,v224
MF v225,v12,v225
MF v226,v12,v226
MF v227,v12,v227
MF v228,v13,v228
MF v229,v13,v229
MF v230,v13,v230
MF v231,v13,v231
MF v232,v12,v232
MF v233,v12,v233
MF v234,v12,v234
MF v235,v12,v235
MF v236,v13,v236
MF v237,v13,v237
MF v238,v13,v238
MF v239,v13,v239
MF v240,v12,v240
MF v241,v12,v241
MF v242,v12,v242
MF v243,v12,v243
MF v244,v13,v244
MF v245,v13,v245
MF v246,v13,v246
MF v247,v13,v247
MF v248,v12,v248
MF v249,v12,v249
MF v250,v12,v250
MF v251,v12,v251
MF v252,v13,v252
MF v253,v13,v253
MF v254,v13,v254
MF v255,v13,v255
E v18,v96
E v19,v97
E v20,v98
AF v28,v18,v19
C v48,v18,v19
E v21,v99
E v22,v104
AF v28,v20,v28
C v49,v20,v21
E v23,v105
AF v28,v21,v28
E v24,v106
AF v28,v22,v28
C v50,v22,v23
E v25,v107
AF v28,v23,v28
E v18,v100
AF v28,v24,v28
C v51,v24,v25
E v19,v101
AF v28,v25,v28
E v20,v102
AF v29,v18,v19
C v52,v18,v19
E v21,v103
E v22,v108
AF v29,v20,v29
C v53,v20,v21
E v23,v109
AF v29,v21,v29
E v24,v110
AF v29,v22,v29
C v54,v22,v23
E v25,v111
AF v29,v23,v29
AF v29,v24,v29
C v55,v24,v25
AF v29,v25,v29
E v18,v112
E v19,v113
E v20,v114
AF v28,v18,v28
C v56,v18,v19
E v21,v115
AF v28,v19,v28
E v22,v120
AF v28,v20,v28
C v57,v20,v21
E v23,v121
AF v28,v21,v28
E v24,v122
AF v28,v22,v28
C v58,v22,v23
E v25,v123
AF v28,v23,v28
E v18,v116
AF v28,v24,v28
C v59,v24,v25
E v19,v117
AF v28,v25,v28
E v20,v118
AF v29,v18,v29
C v60,v18,v19
E v21,v119
AF v29,v19,v29
E v22,v124
AF v29,v20,v29
C v61,v20,v21
E v23,v125
AF v29,v21,v29
E v24,v126
AF v29,v22,v29
C v62,v22,v23
E v25,v127
AF v29,v23,v29
AF v29,v24,v29
C v63,v24,v25
AF v29,v25,v29
s_nop 3
s_setpc_b64 s[36:37]
L_slowf:
s_nop 7
s_nop 3
v_max3_f32 v10, v64, v65, v66
v_max3_f32 v10, v67, v72, v10
v_max3_f32 v10, v73, v74, v10
v_max3_f32 v10, v75, v80, v10
v_max3_f32 v10, v81, v82, v10
v_max3_f32 v10, v83, v88, v10
v_max3_f32 v10, v89, v90, v10
v_max_f32 v10, v91, v10
v_max3_f32 v11, v68, v69, v70
v_max3_f32 v11, v71, v76, v11
v_max3_f32 v11, v77, v78, v11
v_max3_f32 v11, v79, v84, v11
v_max3_f32 v11, v85, v86, v11
v_max3_f32 v11, v87, v92, v11
v_max3_f32 v11, v93, v94, v11
v_max_f32 v11, v95, v11
v_mov_b32 v12, v10
v_mov_b32 v13, v11
s_nop 0
v_permlane16_swap_b32 v12, v10
v_permlane16_swap_b32 v13, v11
v_max_f32 v10, v12, v10
v_max_f32 v11, v13, v11
v_mov_b32 v12, v10
v_mov_b32 v13, v11
s_nop 0
v_permlane32_swap_b32 v12, v10
v_permlane32_swap_b32 v13, v11
v_max_f32 v10, v12, v10
v_max_f32 v11, v13, v11
v_ceil_f32 v10, v10
v_ceil_f32 v11, v11
v_sub_f32 v64, v64, v10
v_sub_f32 v65, v65, v10
v_sub_f32 v66, v66, v10
v_sub_f32 v67, v67, v10
v_sub_f32 v68, v68, v11
v_sub_f32 v69, v69, v11
v_sub_f32 v70, v70, v11
v_sub_f32 v71, v71, v11
v_sub_f32 v72, v72, v10
v_sub_f32 v73, v73, v10
v_sub_f32 v74, v74, v10
v_sub_f32 v75, v75, v10
v_sub_f32 v76, v76, v11
v_sub_f32 v77, v77, v11
v_sub_f32 v78, v78, v11
v_sub_f32 v79, v79, v11
v_sub_f32 v80, v80, v10
v_sub_f32 v81, v81, v10
v_sub_f32 v82, v82, v10
v_sub_f32 v83, v83, v10
v_sub_f32 v84, v84, v11
v_sub_f32 v85, v85, v11
v_sub_f32 v86, v86, v11
v_sub_f32 v87, v87, v11
v_sub_f32 v88, v88, v10
v_sub_f32 v89, v89, v10
v_sub_f32 v90, v90, v10
v_sub_f32 v91, v91, v10
v_sub_f32 v92, v92, v11
v_sub_f32 v93, v93, v11
v_sub_f32 v94, v94, v11
v_sub_f32 v95, v95, v11
v_sub_f32 v96, v96, v10
v_sub_f32 v97, v97, v10
v_sub_f32 v98, v98, v10
v_sub_f32 v99, v99, v10
v_sub_f32 v100, v100, v11
v_sub_f32 v101, v101, v11
v_sub_f32 v102, v102, v11
v_sub_f32 v103, v103, v11
v_sub_f32 v104, v104, v10
v_sub_f32 v105, v105, v10
v_sub_f32 v106, v106, v10
v_sub_f32 v107, v107, v10
v_sub_f32 v108, v108, v11
v_sub_f32 v109, v109, v11
v_sub_f32 v110, v110, v11
v_sub_f32 v111, v111, v11
v_sub_f32 v112, v112, v10
v_sub_f32 v113, v113, v10
v_sub_f32 v114, v114, v10
v_sub_f32 v115, v115, v10
v_sub_f32 v116, v116, v11
v_sub_f32 v117, v117, v11
v_sub_f32 v118, v118, v11
v_sub_f32 v119, v119, v11
v_sub_f32 v120, v120, v10
v_sub_f32 v121, v121, v10
v_sub_f32 v122, v122, v10
v_sub_f32 v123, v123, v10
v_sub_f32 v124, v124, v11
v_sub_f32 v125, v125, v11
v_sub_f32 v126, v126, v11
v_sub_f32 v127, v127, v11
v_sub_f32 v32, v32, v10
v_sub_f32 v33, v33, v10
v_sub_f32 v34, v34, v10
v_sub_f32 v35, v35, v10
v_sub_f32 v36, v36, v11
v_sub_f32 v37, v37, v11
v_sub_f32 v38, v38, v11
v_sub_f32 v39, v39, v11
E v18,v64
E v19,v65
E v20,v66
AF v26,v18,v19
C v40,v18,v19
E v21,v67
E v22,v72
AF v26,v20,v26
C v41,v20,v21
E v23,v73
AF v26,v21,v26
E v24,v74
AF v26,v22,v26
C v42,v22,v23
E v25,v75
AF v26,v23,v26
E v18,v68
AF v26,v24,v26
C v43,v24,v25
E v19,v69
AF v26,v25,v26
E v20,v70
AF v27,v18,v19
C v44,v18,v19
E v21,v71
E v22,v76
AF v27,v20,v27
C v45,v20,v21
E v23,v77
AF v27,v21,v27
E v24,v78
AF v27,v22,v27
C v46,v22,v23
E v25,v79
AF v27,v23,v27
AF v27,v24,v27
C v47,v24,v25
AF v27,v25,v27
E v18,v80
E v19,v81
E v20,v82
AF v26,v18,v26
C v56,v18,v19
E v21,v83
AF v26,v19,v26
E v22,v88
AF v26,v20,v26
C v57,v20,v21
E v23,v89
AF v26,v21,v26
E v24,v90
AF v26,v22,v26
C v58,v22,v23
E v25,v91
AF v26,v23,v26
E v18,v84
AF v26,v24,v26
C v59,v24,v25
E v19,v85
AF v26,v25,v26
E v20,v86
AF v27,v18,v27
C v60,v18,v19
E v21,v87
AF v27,v19,v27
E v22,v92
AF v27,v20,v27
C v61,v20,v21
E v23,v93
AF v27,v21,v27
E v24,v94
AF v27,v22,v27
C v62,v22,v23
E v25,v95
AF v27,v23,v27
AF v27,v24,v27
C v63,v24,v25
AF v27,v25,v27
s_nop 3
s_setpc_b64 s[36:37]
L_slowj:
s_nop 7
s_nop 3
v_max3_f32 v10, v64, v65, v66
v_max3_f32 v10, v67, v72, v10
v_max3_f32 v10, v73, v74, v10
v_max3_f32 v10, v75, v80, v10
v_max3_f32 v10, v81, v82, v10
v_max3_f32 v10, v83, v88, v10
v_max3_f32 v10, v89, v90, v10
v_max_f32 v10, v91, v10
v_max3_f32 v11, v68, v69, v70
v_max3_f32 v11, v71, v76, v11
v_max3_f32 v11, v77, v78, v11
v_max3_f32 v11, v79, v84, v11
v_max3_f32 v11, v85, v86, v11
v_max3_f32 v11, v87, v92, v11
v_max3_f32 v11, v93, v94, v11
v_max_f32 v11, v95, v11
v_mov_b32 v12, v10
v_mov_b32 v13, v11
s_nop 0
v_permlane16_swap_b32 v12, v10
v_permlane16_swap_b32 v13, v11
v_max_f32 v10, v12, v10
v_max_f32 v11, v13, v11
v_mov_b32 v12, v10
v_mov_b32 v13, v11
s_nop 0
v_permlane32_swap_b32 v12, v10
v_permlane32_swap_b32 v13, v11
v_max_f32 v10, v12, v10
v_max_f32 v11, v13, v11
v_ceil_f32 v10, v10
v_ceil_f32 v11, v11
v_sub_f32 v64, v64, v10
v_sub_f32 v65, v65, v10
v_sub_f32 v66, v66, v10
v_sub_f32 v67, v67, v10
v_sub_f32 v68, v68, v11
v_sub_f32 v69, v69, v11
v_sub_f32 v70, v70, v11
v_sub_f32 v71, v71, v11
v_sub_f32 v72, v72, v10
v_sub_f32 v73, v73, v10
v_sub_f32 v74, v74, v10
v_sub_f32 v75, v75, v10
v_sub_f32 v76, v76, v11
v_sub_f32 v77, v77, v11
v_sub_f32 v78, v78, v11
v_sub_f32 v79, v79, v11
v_sub_f32 v80, v80, v10
v_sub_f32 v81, v81, v10
v_sub_f32 v82, v82, v10
v_sub_f32 v83, v83, v10
v_sub_f32 v84, v84, v11
v_sub_f32 v85, v85, v11
v_sub_f32 v86, v86, v11
v_sub_f32 v87, v87, v11
v_sub_f32 v88, v88, v10
v_sub_f32 v89, v89, v10
v_sub_f32 v90, v90, v10
v_sub_f32 v91, v91, v10
v_sub_f32 v92, v92, v11
v_sub_f32 v93, v93, v11
v_sub_f32 v94, v94, v11
v_sub_f32 v95, v95, v11
v_sub_f32 v32, v32, v10
v_sub_f32 v33, v33, v10
v_sub_f32 v34, v34, v10
v_sub_f32 v35, v35, v10
v_sub_f32 v36, v36, v11
v_sub_f32 v37, v37, v11
v_sub_f32 v38, v38, v11
v_sub_f32 v39, v39, v11
E v18,v64
E v19,v65
E v20,v66
AF v26,v18,v19
C v40,v18,v19
E v21,v67
E v22,v72
AF v26,v20,v26
C v41,v20,v21
E v23,v73
AF v26,v21,v26
E v24,v74
AF v26,v22,v26
C v42,v22,v23
E v25,v75
AF v26,v23,v26
E v18,v68
AF v26,v24,v26
C v43,v24,v25
E v19,v69
AF v26,v25,v26
E v20,v70
AF v27,v18,v19
C v44,v18,v19
E v21,v71
E v22,v76
AF v27,v20,v27
C v45,v20,v21
E v23,v77
AF v27,v21,v27
E v24,v78
AF v27,v22,v27
C v46,v22,v23
E v25,v79
AF v27,v23,v27
AF v27,v24,v27
C v47,v24,v25
AF v27,v25,v27
s_nop 3
s_setpc_b64 s[36:37]
L_slowb:
s_nop 7
s_nop 3
v_max3_f32 v11, v100, v101, v102
v_max3_f32 v11, v103, v108, v11
v_max3_f32 v11, v109, v110, v11
v_max3_f32 v11, v111, v116, v11
v_max3_f32 v11, v117, v118, v11
v_max3_f32 v11, v119, v124, v11
v_max3_f32 v11, v125, v126, v11
v_max_f32 v11, v127, v11
v_mov_b32 v13, v11
s_nop 1
v_permlane16_swap_b32 v13, v11
v_max_f32 v11, v13, v11
v_mov_b32 v13, v11
s_nop 1
v_permlane32_swap_b32 v13, v11
v_max_f32 v11, v13, v11
v_ceil_f32 v11, v11
v_max_f32 v11, 0, v11
v_mov_b32 v10, 0
v_sub_f32 v100, v100, v11
v_sub_f32 v101, v101, v11
v_sub_f32 v102, v102, v11
v_sub_f32 v103, v103, v11
v_sub_f32 v108, v108, v11
v_sub_f32 v109, v109, v11
v_sub_f32 v110, v110, v11
v_sub_f32 v111, v111, v11
v_sub_f32 v116, v116, v11
v_sub_f32 v117, v117, v11
v_sub_f32 v118, v118, v11
v_sub_f32 v119, v119, v11
v_sub_f32 v124, v124, v11
v_sub_f32 v125, v125, v11
v_sub_f32 v126, v126, v11
v_sub_f32 v127, v127, v11
v_sub_f32 v32, v32, v10
v_sub_f32 v33, v33, v10
v_sub_f32 v34, v34, v10
v_sub_f32 v35, v35, v10
v_sub_f32 v36, v36, v11
v_sub_f32 v37, v37, v11
v_sub_f32 v38, v38, v11
v_sub_f32 v39, v39, v11
E v12,-v10
E v13,-v11
MF v30,v12,v30
MF v31,v13,v31
MF v128,v12,v128
MF v129,v12,v129
MF v130,v12,v130
MF v131,v12,v131
MF v132,v13,v132
MF v133,v13,v133
MF v134,v13,v134
MF v135,v13,v135
MF v136,v12,v136
MF v137,v12,v137
MF v138,v12,v138
MF v139,v12,v139
MF v140,v13,v140
MF v141,v13,v141
MF v142,v13,v142
MF v143,v13,v143
MF v144,v12,v144
MF v145,v12,v145
MF v146,v12,v146
MF v147,v12,v147
MF v148,v13,v148
MF v149,v13,v149
MF v150,v13,v150
MF v151,v13,v151
MF v152,v12,v152
MF v153,v12,v153
MF v154,v12,v154
MF v155,v12,v155
MF v156,v13,v156
MF v157,v13,v157
MF v158,v13,v158
MF v159,v13,v159
MF v160,v12,v160
MF v161,v12,v161
MF v162,v12,v162
MF v163,v12,v163
MF v164,v13,v164
MF v165,v13,v165
MF v166,v13,v166
MF v167,v13,v167
MF v168,v12,v168
MF v169,v12,v169
MF v170,v12,v170
MF v171,v12,v171
MF v172,v13,v172
MF v173,v13,v173
MF v174,v13,v174
MF v175,v13,v175
MF v176,v12,v176
MF v177,v12,v177
MF v178,v12,v178
MF v179,v12,v179
MF v180,v13,v180
MF v181,v13,v181
MF v182,v13,v182
MF v183,v13,v183
MF v184,v12,v184
MF v185,v12,v185
MF v186,v12,v186
MF v187,v12,v187
MF v188,v13,v188
MF v189,v13,v189
MF v190,v13,v190
MF v191,v13,v191
MF v192,v12,v192
MF v193,v12,v193
MF v194,v12,v194
MF v195,v12,v195
MF v196,v13,v196
MF v197,v13,v197
MF v198,v13,v198
MF v199,v13,v199
MF v200,v12,v200
MF v201,v12,v201
MF v202,v12,v202
MF v203,v12,v203
MF v204,v13,v204
MF v205,v13,v205
MF v206,v13,v206
MF v207,v13,v207
MF v208,v12,v208
MF v209,v12,v209
MF v210,v12,v210
MF v211,v12,v211
MF v212,v13,v212
MF v213,v13,v213
MF v214,v13,v214
MF v215,v13,v215
MF v216,v12,v216
MF v217,v12,v217
MF v218,v12,v218
MF v219,v12,v219
MF v220,v13,v220
MF v221,v13,v221
MF v222,v13,v222
MF v223,v13,v223
MF v224,v12,v224
MF v225,v12,v225
MF v226,v12,v226
MF v227,v12,v227
MF v228,v13,v228
MF v229,v13,v229
MF v230,v13,v230
MF v231,v13,v231
MF v232,v12,v232
MF v233,v12,v233
MF v234,v12,v234
MF v235,v12,v235
MF v236,v13,v236
MF v237,v13,v237
MF v238,v13,v238
MF v239,v13,v239
MF v240,v12,v240
MF v241,v12,v241
MF v242,v12,v242
MF v243,v12,v243
MF v244,v13,v244
MF v245,v13,v245
MF v246,v13,v246
MF v247,v13,v247
MF v248,v12,v248
MF v249,v12,v249
MF v250,v12,v250
MF v251,v12,v251
MF v252,v13,v252
MF v253,v13,v253
MF v254,v13,v254
MF v255,v13,v255
E v18,v100
E v19,v101
E v20,v102
AF v29,v18,v19
C v52,v18,v19
E v21,v103
E v22,v108
AF v29,v20,v29
C v53,v20,v21
E v23,v109
AF v29,v21,v29
E v24,v110
AF v29,v22,v29
C v54,v22,v23
E v25,v111
AF v29,v23,v29
E v18,v116
AF v29,v24,v29
C v55,v24,v25
E v19,v117
AF v29,v25,v29
E v20,v118
AF v29,v18,v29
C v48,v18,v19
E v21,v119
AF v29,v19,v29
E v22,v124
AF v29,v20,v29
C v49,v20,v21
E v23,v125
AF v29,v21,v29
E v24,v126
AF v29,v22,v29
C v50,v22,v23
E v25,v127
AF v29,v23,v29
AF v29,v24,v29
C v51,v24,v25
AF v29,v25,v29
s_nop 3
s_setpc_b64 s[36:37]
L_comb:
s_waitcnt vmcnt(0)
s_nop 7
v_sub_f32 v10, v32, v14
v_sub_f32 v11, v36, v15
v_max_f32 v10, 0, v10
v_max_f32 v11, 0, v11
v_sub_f32 v100, v100, v11
v_sub_f32 v101, v101, v11
v_sub_f32 v102, v102, v11
v_sub_f32 v103, v103, v11
v_sub_f32 v108, v108, v11
v_sub_f32 v109, v109, v11
v_sub_f32 v110, v110, v11
v_sub_f32 v111, v111, v11
v_sub_f32 v116, v116, v11
v_sub_f32 v117, v117, v11
v_sub_f32 v118, v118, v11
v_sub_f32 v119, v119, v11
v_sub_f32 v124, v124, v11
v_sub_f32 v125, v125, v11
v_sub_f32 v126, v126, v11
v_sub_f32 v127, v127, v11
v_sub_f32 v32, v32, v10
v_sub_f32 v33, v33, v10
v_sub_f32 v34, v34, v10
v_sub_f32 v35, v35, v10
v_sub_f32 v36, v36, v11
v_sub_f32 v37, v37, v11
v_sub_f32 v38, v38, v11
v_sub_f32 v39, v39, v11
E v12,-v10
E v13,-v11
MF v30,v12,v30
MF v31,v13,v31
MF v128,v12,v128
MF v129,v12,v129
MF v130,v12,v130
MF v131,v12,v131
MF v132,v13,v132
MF v133,v13,v133
MF v134,v13,v134
MF v135,v13,v135
MF v136,v12,v136
MF v137,v12,v137
MF v138,v12,v138
MF v139,v12,v139
MF v140,v13,v140
MF v141,v13,v141
MF v142,v13,v142
MF v143,v13,v143
MF v144,v12,v144
MF v145,v12,v145
MF v146,v12,v146
MF v147,v12,v147
MF v148,v13,v148
MF v149,v13,v149
MF v150,v13,v150
MF v151,v13,v151
MF v152,v12,v152
MF v153,v12,v153
MF v154,v12,v154
MF v155,v12,v155
MF v156,v13,v156
MF v157,v13,v157
MF v158,v13,v158
MF v159,v13,v159
MF v160,v12,v160
MF v161,v12,v161
MF v162,v12,v162
MF v163,v12,v163
MF v164,v13,v164
MF v165,v13,v165
MF v166,v13,v166
MF v167,v13,v167
MF v168,v12,v168
MF v169,v12,v169
MF v170,v12,v170
MF v171,v12,v171
MF v172,v13,v172
MF v173,v13,v173
MF v174,v13,v174
MF v175,v13,v175
MF v176,v12,v176
MF v177,v12,v177
MF v178,v12,v178
MF v179,v12,v179
MF v180,v13,v180
MF v181,v13,v181
MF v182,v13,v182
MF v183,v13,v183
MF v184,v12,v184
MF v185,v12,v185
MF v186,v12,v186
MF v187,v12,v187
MF v188,v13,v188
MF v189,v13,v189
MF v190,v13,v190
MF v191,v13,v191
MF v192,v12,v192
MF v193,v12,v193
MF v194,v12,v194
MF v195,v12,v195
MF v196,v13,v196
MF v197,v13,v197
MF v198,v13,v198
MF v199,v13,v199
MF v200,v12,v200
MF v201,v12,v201
MF v202,v12,v202
MF v203,v12,v203
MF v204,v13,v204
MF v205,v13,v205
MF v206,v13,v206
MF v207,v13,v207
MF v208,v12,v208
MF v209,v12,v209
MF v210,v12,v210
MF v211,v12,v211
MF v212,v13,v212
MF v213,v13,v213
MF v214,v13,v214
MF v215,v13,v215
MF v216,v12,v216
MF v217,v12,v217
MF v218,v12,v218
MF v219,v12,v219
MF v220,v13,v220
MF v221,v13,v221
MF v222,v13,v222
MF v223,v13,v223
MF v224,v12,v224
MF v225,v12,v225
MF v226,v12,v226
MF v227,v12,v227
MF v228,v13,v228
MF v229,v13,v229
MF v230,v13,v230
MF v231,v13,v231
MF v232,v12,v232
MF v233,v12,v233
MF v234,v12,v234
MF v235,v12,v235
MF v236,v13,v236
MF v237,v13,v237
MF v238,v13,v238
MF v239,v13,v239
MF v240,v12,v240
MF v241,v12,v241
MF v242,v12,v242
MF v243,v12,v243
MF v244,v13,v244
MF v245,v13,v245
MF v246,v13,v246
MF v247,v13,v247
MF v248,v12,v248
MF v249,v12,v249
MF v250,v12,v250
MF v251,v12,v251
MF v252,v13,v252
MF v253,v13,v253
MF v254,v13,v254
MF v255,v13,v255
E v18,v100
E v19,v101
E v20,v102
AF v29,v18,v19
C v52,v18,v19
E v21,v103
E v22,v108
AF v29,v20,v29
C v53,v20,v21
E v23,v109
AF v29,v21,v29
E v24,v110
AF v29,v22,v29
C v54,v22,v23
E v25,v111
AF v29,v23,v29
E v18,v116
AF v29,v24,v29
C v55,v24,v25
E v19,v117
AF v29,v25,v29
E v20,v118
AF v29,v18,v29
C v48,v18,v19
E v21,v119
AF v29,v19,v29
E v22,v124
AF v29,v20,v29
C v49,v20,v21
E v23,v125
AF v29,v21,v29
E v24,v126
AF v29,v22,v29
C v50,v22,v23
E v25,v127
AF v29,v23,v29
AF v29,v24,v29
C v51,v24,v25
AF v29,v25,v29
v_sub_f32 v10, v32, v14
v_sub_f32 v11, v36, v15
E v10,v10
E v11,v11
s_nop 0
MF v16,v10,v16
MF v17,v11,v17
G v64,a128
v_and_b32 v65, 0xffff0000, v64
v_lshlrev_b32 v64, 16, v64
MF v64,v10,v64
MF v65,v10,v65
C v64,v64,v65
W a128,v64
G v66,a129
v_and_b32 v67, 0xffff0000, v66
v_lshlrev_b32 v66, 16, v66
MF v66,v10,v66
MF v67,v10,v67
C v66,v66,v67
W a129,v66
G v68,a130
v_and_b32 v69, 0xffff0000, v68
v_lshlrev_b32 v68, 16, v68
MF v68,v10,v68
MF v69,v10,v69
C v68,v68,v69
W a130,v68
G v70,a131
v_and_b32 v71, 0xffff0000, v70
v_lshlrev_b32 v70, 16, v70
MF v70,v10,v70
MF v71,v10,v71
C v70,v70,v71
W a131,v70
G v72,a132
v_and_b32 v73, 0xffff0000, v72
v_lshlrev_b32 v72, 16, v72
MF v72,v10,v72
MF v73,v10,v73
C v72,v72,v73
W a132,v72
G v74,a133
v_and_b32 v75, 0xffff0000, v74
v_lshlrev_b32 v74, 16, v74
MF v74,v10,v74
MF v75,v10,v75
C v74,v74,v75
W a133,v74
G v76,a134
v_and_b32 v77, 0xffff0000, v76
v_lshlrev_b32 v76, 16, v76
MF v76,v10,v76
MF v77,v10,v77
C v76,v76,v77
W a134,v76
G v78,a135
v_and_b32 v79, 0xffff0000, v78
v_lshlrev_b32 v78, 16, v78
MF v78,v10,v78
MF v79,v10,v79
C v78,v78,v79
W a135,v78
G v64,a136
v_and_b32 v65, 0xffff0000, v64
v_lshlrev_b32 v64, 16, v64
MF v64,v10,v64
MF v65,v10,v65
C v64,v64,v65
W a136,v64
G v66,a137
v_and_b32 v67, 0xffff0000, v66
v_lshlrev_b32 v66, 16, v66
MF v66,v10,v66
MF v67,v10,v67
C v66,v66,v67
W a137,v66
G v68,a138
v_and_b32 v69, 0xffff0000, v68
v_lshlrev_b32 v68, 16, v68
MF v68,v10,v68
MF v69,v10,v69
C v68,v68,v69
W a138,v68
G v70,a139
v_and_b32 v71, 0xffff0000, v70
v_lshlrev_b32 v70, 16, v70
MF v70,v10,v70
MF v71,v10,v71
C v70,v70,v71
W a139,v70
G v72,a140
v_and_b32 v73, 0xffff0000, v72
v_lshlrev_b32 v72, 16, v72
MF v72,v10,v72
MF v73,v10,v73
C v72,v72,v73
W a140,v72
G v74,a141
v_and_b32 v75, 0xffff0000, v74
v_lshlrev_b32 v74, 16, v74
MF v74,v10,v74
MF v75,v10,v75
C v74,v74,v75
W a141,v74
G v76,a142
v_and_b32 v77, 0xffff0000, v76
v_lshlrev_b32 v76, 16, v76
MF v76,v10,v76
MF v77,v10,v77
C v76,v76,v77
W a142,v76
G v78,a143
v_and_b32 v79, 0xffff0000, v78
v_lshlrev_b32 v78, 16, v78
MF v78,v10,v78
MF v79,v10,v79
C v78,v78,v79
W a143,v78
G v64,a144
v_and_b32 v65, 0xffff0000, v64
v_lshlrev_b32 v64, 16, v64
MF v64,v10,v64
MF v65,v10,v65
C v64,v64,v65
W a144,v64
G v66,a145
v_and_b32 v67, 0xffff0000, v66
v_lshlrev_b32 v66, 16, v66
MF v66,v10,v66
MF v67,v10,v67
C v66,v66,v67
W a145,v66
G v68,a146
v_and_b32 v69, 0xffff0000, v68
v_lshlrev_b32 v68, 16, v68
MF v68,v10,v68
MF v69,v10,v69
C v68,v68,v69
W a146,v68
G v70,a147
v_and_b32 v71, 0xffff0000, v70
v_lshlrev_b32 v70, 16, v70
MF v70,v10,v70
MF v71,v10,v71
C v70,v70,v71
W a147,v70
G v72,a148
v_and_b32 v73, 0xffff0000, v72
v_lshlrev_b32 v72, 16, v72
MF v72,v10,v72
MF v73,v10,v73
C v72,v72,v73
W a148,v72
G v74,a149
v_and_b32 v75, 0xffff0000, v74
v_lshlrev_b32 v74, 16, v74
MF v74,v10,v74
MF v75,v10,v75
C v74,v74,v75
W a149,v74
G v76,a150
v_and_b32 v77, 0xffff0000, v76
v_lshlrev_b32 v76, 16, v76
MF v76,v10,v76
MF v77,v10,v77
C v76,v76,v77
W a150,v76
G v78,a151
v_and_b32 v79, 0xffff0000, v78
v_lshlrev_b32 v78, 16, v78
MF v78,v10,v78
MF v79,v10,v79
C v78,v78,v79
W a151,v78
G v64,a152
v_and_b32 v65, 0xffff0000, v64
v_lshlrev_b32 v64, 16, v64
MF v64,v10,v64
MF v65,v10,v65
C v64,v64,v65
W a152,v64
G v66,a153
v_and_b32 v67, 0xffff0000, v66
v_lshlrev_b32 v66, 16, v66
MF v66,v10,v66
MF v67,v10,v67
C v66,v66,v67
W a153,v66
G v68,a154
v_and_b32 v69, 0xffff0000, v68
v_lshlrev_b32 v68, 16, v68
MF v68,v10,v68
MF v69,v10,v69
C v68,v68,v69
W a154,v68
G v70,a155
v_and_b32 v71, 0xffff0000, v70
v_lshlrev_b32 v70, 16, v70
MF v70,v10,v70
MF v71,v10,v71
C v70,v70,v71
W a155,v70
G v72,a156
v_and_b32 v73, 0xffff0000, v72
v_lshlrev_b32 v72, 16, v72
MF v72,v10,v72
MF v73,v10,v73
C v72,v72,v73
W a156,v72
G v74,a157
v_and_b32 v75, 0xffff0000, v74
v_lshlrev_b32 v74, 16, v74
MF v74,v10,v74
MF v75,v10,v75
C v74,v74,v75
W a157,v74
G v76,a158
v_and_b32 v77, 0xffff0000, v76
v_lshlrev_b32 v76, 16, v76
MF v76,v10,v76
MF v77,v10,v77
C v76,v76,v77
W a158,v76
G v78,a159
v_and_b32 v79, 0xffff0000, v78
v_lshlrev_b32 v78, 16, v78
MF v78,v10,v78
MF v79,v10,v79
C v78,v78,v79
W a159,v78
G v64,a160
v_and_b32 v65, 0xffff0000, v64
v_lshlrev_b32 v64, 16, v64
MF v64,v11,v64
MF v65,v11,v65
C v64,v64,v65
W a160,v64
G v66,a161
v_and_b32 v67, 0xffff0000, v66
v_lshlrev_b32 v66, 16, v66
MF v66,v11,v66
MF v67,v11,v67
C v66,v66,v67
W a161,v66
G v68,a162
v_and_b32 v69, 0xffff0000, v68
v_lshlrev_b32 v68, 16, v68
MF v68,v11,v68
MF v69,v11,v69
C v68,v68,v69
W a162,v68
G v70,a163
v_and_b32 v71, 0xffff0000, v70
v_lshlrev_b32 v70, 16, v70
MF v70,v11,v70
MF v71,v11,v71
C v70,v70,v71
W a163,v70
G v72,a164
v_and_b32 v73, 0xffff0000, v72
v_lshlrev_b32 v72, 16, v72
MF v72,v11,v72
MF v73,v11,v73
C v72,v72,v73
W a164,v72
G v74,a165
v_and_b32 v75, 0xffff0000, v74
v_lshlrev_b32 v74, 16, v74
MF v74,v11,v74
MF v75,v11,v75
C v74,v74,v75
W a165,v74
G v76,a166
v_and_b32 v77, 0xffff0000, v76
v_lshlrev_b32 v76, 16, v76
MF v76,v11,v76
MF v77,v11,v77
C v76,v76,v77
W a166,v76
G v78,a167
v_and_b32 v79, 0xffff0000, v78
v_lshlrev_b32 v78, 16, v78
MF v78,v11,v78
MF v79,v11,v79
C v78,v78,v79
W a167,v78
G v64,a168
v_and_b32 v65, 0xffff0000, v64
v_lshlrev_b32 v64, 16, v64
MF v64,v11,v64
MF v65,v11,v65
C v64,v64,v65
W a168,v64
G v66,a169
v_and_b32 v67, 0xffff0000, v66
v_lshlrev_b32 v66, 16, v66
MF v66,v11,v66
MF v67,v11,v67
C v66,v66,v67
W a169,v66
G v68,a170
v_and_b32 v69, 0xffff0000, v68
v_lshlrev_b32 v68, 16, v68
MF v68,v11,v68
MF v69,v11,v69
C v68,v68,v69
W a170,v68
G v70,a171
v_and_b32 v71, 0xffff0000, v70
v_lshlrev_b32 v70, 16, v70
MF v70,v11,v70
MF v71,v11,v71
C v70,v70,v71
W a171,v70
G v72,a172
v_and_b32 v73, 0xffff0000, v72
v_lshlrev_b32 v72, 16, v72
MF v72,v11,v72
MF v73,v11,v73
C v72,v72,v73
W a172,v72
G v74,a173
v_and_b32 v75, 0xffff0000, v74
v_lshlrev_b32 v74, 16, v74
MF v74,v11,v74
MF v75,v11,v75
C v74,v74,v75
W a173,v74
G v76,a174
v_and_b32 v77, 0xffff0000, v76
v_lshlrev_b32 v76, 16, v76
MF v76,v11,v76
MF v77,v11,v77
C v76,v76,v77
W a174,v76
G v78,a175
v_and_b32 v79, 0xffff0000, v78
v_lshlrev_b32 v78, 16, v78
MF v78,v11,v78
MF v79,v11,v79
C v78,v78,v79
W a175,v78
G v64,a176
v_and_b32 v65, 0xffff0000, v64
v_lshlrev_b32 v64, 16, v64
MF v64,v11,v64
MF v65,v11,v65
C v64,v64,v65
W a176,v64
G v66,a177
v_and_b32 v67, 0xffff0000, v66
v_lshlrev_b32 v66, 16, v66
MF v66,v11,v66
MF v67,v11,v67
C v66,v66,v67
W a177,v66
G v68,a178
v_and_b32 v69, 0xffff0000, v68
v_lshlrev_b32 v68, 16, v68
MF v68,v11,v68
MF v69,v11,v69
C v68,v68,v69
W a178,v68
G v70,a179
v_and_b32 v71, 0xffff0000, v70
v_lshlrev_b32 v70, 16, v70
MF v70,v11,v70
MF v71,v11,v71
C v70,v70,v71
W a179,v70
G v72,a180
v_and_b32 v73, 0xffff0000, v72
v_lshlrev_b32 v72, 16, v72
MF v72,v11,v72
MF v73,v11,v73
C v72,v72,v73
W a180,v72
G v74,a181
v_and_b32 v75, 0xffff0000, v74
v_lshlrev_b32 v74, 16, v74
MF v74,v11,v74
MF v75,v11,v75
C v74,v74,v75
W a181,v74
G v76,a182
v_and_b32 v77, 0xffff0000, v76
v_lshlrev_b32 v76, 16, v76
MF v76,v11,v76
MF v77,v11,v77
C v76,v76,v77
W a182,v76
G v78,a183
v_and_b32 v79, 0xffff0000, v78
v_lshlrev_b32 v78, 16, v78
MF v78,v11,v78
MF v79,v11,v79
C v78,v78,v79
W a183,v78
G v64,a184
v_and_b32 v65, 0xffff0000, v64
v_lshlrev_b32 v64, 16, v64
MF v64,v11,v64
MF v65,v11,v65
C v64,v64,v65
W a184,v64
G v66,a185
v_and_b32 v67, 0xffff0000, v66
v_lshlrev_b32 v66, 16, v66
MF v66,v11,v66
MF v67,v11,v67
C v66,v66,v67
W a185,v66
G v68,a186
v_and_b32 v69, 0xffff0000, v68
v_lshlrev_b32 v68, 16, v68
MF v68,v11,v68
MF v69,v11,v69
C v68,v68,v69
W a186,v68
G v70,a187
v_and_b32 v71, 0xffff0000, v70
v_lshlrev_b32 v70, 16, v70
MF v70,v11,v70
MF v71,v11,v71
C v70,v70,v71
W a187,v70
G v72,a188
v_and_b32 v73, 0xffff0000, v72
v_lshlrev_b32 v72, 16, v72
MF v72,v11,v72
MF v73,v11,v73
C v72,v72,v73
W a188,v72
G v74,a189
v_and_b32 v75, 0xffff0000, v74
v_lshlrev_b32 v74, 16, v74
MF v74,v11,v74
MF v75,v11,v75
C v74,v74,v75
W a189,v74
G v76,a190
v_and_b32 v77, 0xffff0000, v76
v_lshlrev_b32 v76, 16, v76
MF v76,v11,v76
MF v77,v11,v77
C v76,v76,v77
W a190,v76
G v78,a191
v_and_b32 v79, 0xffff0000, v78
v_lshlrev_b32 v78, 16, v78
MF v78,v11,v78
MF v79,v11,v79
C v78,v78,v79
W a191,v78
s_nop 3
s_setpc_b64 s[36:37]
L_zs0:
s_mov_b32 s64, 65536
L_zs0_l:
s_sleep 2
buffer_load_dword v17, v16, s[12:15], 0 offen sc1
s_sub_u32 s64, s64, 1
s_cbranch_scc1 L_zs0_x
s_waitcnt vmcnt(0)
v_cmp_ne_u32 vcc, 1, v17
s_nop 0
s_cbranch_vccnz L_zs0_l
L_zs0_x:
s_waitcnt vmcnt(0)
s_branch L_zr0
L_zs1:
s_mov_b32 s64, 65536
L_zs1_l:
s_sleep 2
buffer_load_dword v17, v16, s[12:15], 0 offen sc1
s_sub_u32 s64, s64, 1
s_cbranch_scc1 L_zs1_x
s_waitcnt vmcnt(0)
v_cmp_ne_u32 vcc, 1, v17
s_nop 0
s_cbranch_vccnz L_zs1_l
L_zs1_x:
s_waitcnt vmcnt(0)
s_branch L_zr1
L_hs:
s_mov_b32 s91, 65536
L_hs_l:
buffer_load_dwordx4 v[16:19], v7, s[8:11], s67 offen offset:0 sc1
buffer_load_dwordx4 v[20:23], v7, s[8:11], s67 offen offset:1024 sc1
s_waitcnt vmcnt(0)
s_sub_u32 s91, s91, 1
s_cbranch_scc1 L_hr
v_min3_u32 v28, v16, v17, v18
v_min3_u32 v28, v28, v19, v20
v_min3_u32 v28, v28, v21, v22
v_min_u32 v28, v28, v23
v_cmp_eq_u32 vcc, 0, v28
s_nop 0
s_cbranch_vccnz L_hs_l
s_branch L_hr
L_lsj0:
s_mov_b32 s91, 65536
L_lsj0_l:
s_sleep 2
buffer_load_dword v5, v17, s[8:11], s46 offen sc1
s_sub_u32 s91, s91, 1
s_cbranch_scc1 L_lsj0_x
s_waitcnt vmcnt(0)
v_cmp_gt_u32 vcc, 2, v5
s_nop 0
s_cbranch_vccnz L_lsj0_l
L_lsj0_x:
s_waitcnt vmcnt(0)
s_branch L_lrj0
L_lsh2:
s_mov_b32 s91, 65536
L_lsh2_l:
s_sleep 2
buffer_load_dword v5, v17, s[8:11], s46 offen sc1
s_sub_u32 s91, s91, 1
s_cbranch_scc1 L_lsh2_x
s_waitcnt vmcnt(0)
v_cmp_gt_u32 vcc, 2, v5
s_nop 0
s_cbranch_vccnz L_lsh2_l
L_lsh2_x:
s_waitcnt vmcnt(0)
s_branch L_lrh2
L_lsh4:
s_mov_b32 s91, 65536
L_lsh4_l:
s_sleep 2
buffer_load_dword v5, v9, s[8:11], s46 offen sc1
s_sub_u32 s91, s91, 1
s_cbranch_scc1 L_lsh4_x
s_waitcnt vmcnt(0)
v_cmp_gt_u32 vcc, s84, v5
s_nop 0
s_cbranch_vccnz L_lsh4_l
L_lsh4_x:
s_waitcnt vmcnt(0)
s_branch L_lrh4
L_wsq0:
s_mov_b32 s91, 65536
L_wsq0_l:
s_sleep 2
buffer_load_dword v5, v31, s[8:11], s46 offen offset:4 sc1
s_sub_u32 s91, s91, 1
s_cbranch_scc1 L_wsq0_x
s_waitcnt vmcnt(0)
v_cmp_ne_u32 vcc, 1, v5
s_nop 0
s_mov_b32 vcc_hi, 0
s_cbranch_vccnz L_wsq0_l
L_wsq0_x:
s_waitcnt vmcnt(0)
s_branch L_wrq0
L_wsr0:
s_mov_b32 s91, 65536
L_wsr0_l:
s_sleep 2
buffer_load_dword v5, v31, s[8:11], s46 offen offset:4 sc1
s_sub_u32 s91, s91, 1
s_cbranch_scc1 L_wsr0_x
s_waitcnt vmcnt(0)
v_cmp_ne_u32 vcc, 1, v5
s_nop 0
s_mov_b32 vcc_lo, 0
s_cbranch_vccnz L_wsr0_l
L_wsr0_x:
s_waitcnt vmcnt(0)
s_branch L_wrr0
L_wsq1:
s_mov_b32 s91, 65536
L_wsq1_l:
s_sleep 2
buffer_load_dword v5, v31, s[8:11], s46 offen offset:4 sc1
s_sub_u32 s91, s91, 1
s_cbranch_scc1 L_wsq1_x
s_waitcnt vmcnt(0)
v_cmp_ne_u32 vcc, 1, v5
s_nop 0
s_mov_b32 vcc_hi, 0
s_cbranch_vccnz L_wsq1_l
L_wsq1_x:
s_waitcnt vmcnt(0)
s_branch L_wrq1
L_wsr1:
s_mov_b32 s91, 65536
L_wsr1_l:
s_sleep 2
buffer_load_dword v5, v31, s[8:11], s46 offen offset:4 sc1
s_sub_u32 s91, s91, 1
s_cbranch_scc1 L_wsr1_x
s_waitcnt vmcnt(0)
v_cmp_ne_u32 vcc, 1, v5
s_nop 0
s_mov_b32 vcc_lo, 0
s_cbranch_vccnz L_wsr1_l
L_wsr1_x:
s_waitcnt vmcnt(0)
s_branch L_wrr1
L_fll:
s_cmp_eq_u32 s42, 8
s_cbranch_scc1 L_fl8
L_fl0:
s_cmp_lg_u32 s20, 0
s_cbranch_scc1 L_fl3
s_lshr_b32 s64, s42, 3
s_cmp_eq_u32 s7, s64
s_cbranch_scc0 L_fl1
v_mov_b32 v15, 4
buffer_store_dword v15, v1, s[8:11], s45 offen sc1
L_fl1:
s_cmp_lt_u32 s7, s40
s_cbranch_scc1 L_fllr
s_cmp_eq_u32 s7, s40
s_cselect_b32 s64, 0x380, -1
v_min_u32 v17, s64, v9
s_mov_b32 s6, 4
buffer_load_dword v5, v17, s[8:11], s46 offen sc1
s_branch L_fllr
L_fl8:
s_mul_i32 s64, s20, 57344
s_sub_u32 s65, s7, 1
s_lshl_b32 s65, s65, 14
SA s64,s64,s65
SA s65,s64,8192
v_lshlrev_b32 v11, 3, v7
s_bitcmp1_b32 0, s7
s_cbranch_scc0 L_fl0
buffer_load_dword a240, v11, s[12:15], s64 offen offset:0
s_waitcnt vmcnt(0)
buffer_load_dword a240, v11, s[12:15], s65 offen offset:0
s_cmp_gt_u32 s7, 2
s_cbranch_scc1 L_fllr
s_cmp_lg_u32 s20, 0
s_cbranch_scc1 L_fllr
s_branch L_fl0
L_fl3:
s_cmp_eq_u32 s7, 1
s_cbranch_scc1 L_y2
s_cmp_eq_u32 s7, 2
s_cbranch_scc1 L_y3
s_cmp_eq_u32 s7, 3
s_cbranch_scc1 L_y4
s_branch L_y5
s_waitcnt vmcnt(0)
L_fps:
s_cmp_lg_u32 s35, 0
s_cbranch_scc1 L_fpr
L_fps2:
s_mov_b32 s91, 65536
L_fps2_l:
s_sleep 2
buffer_load_dword v6, off, s[8:11], s47 sc1
s_sub_u32 s91, s91, 1
s_cbranch_scc1 L_fps2_x
s_waitcnt vmcnt(0)
v_cmp_ne_u32 vcc, 1, v6
s_nop 0
s_cbranch_vccnz L_fps2_l
L_fps2_x:
s_waitcnt vmcnt(0)
s_branch L_fpr
L_fqs:
s_mov_b32 s91, 65536
L_fqs_l:
s_sleep 2
buffer_load_dword v6, off, s[8:11], s47 offset:16 sc1
s_sub_u32 s91, s91, 1
s_cbranch_scc1 L_fqs_x
s_waitcnt vmcnt(0)
v_cmp_ne_u32 vcc, 1, v6
s_nop 0
s_cbranch_vccnz L_fqs_l
L_fqs_x:
s_waitcnt vmcnt(0)
s_branch L_fqr
L_fls0:
s_mov_b32 s91, 65536
L_fls0_l:
s_sleep 2
buffer_load_dword v5, v17, s[8:11], s46 offen sc1
s_sub_u32 s91, s91, 1
s_cbranch_scc1 L_fls0_x
s_waitcnt vmcnt(0)
v_cmp_gt_u32 vcc, s6, v5
s_nop 0
s_cbranch_vccnz L_fls0_l
L_fls0_x:
s_waitcnt vmcnt(0)
s_branch L_flr0
L_y2:
v_lshrrev_b32 v11, 7, v7
v_mul_u32_u24 v11, 4352, v11
v_and_b32 v12, 0x70, v7
v_lshl_add_u32 v11, v12, 3, v11
s_mov_b32 s64, 104923136
s_mov_b32 s65, 104957952
buffer_load_dword a128, v11, s[8:11], s64 offen sc1
buffer_load_dword a129, v11, s[8:11], s65 offen sc1
s_branch L_fllr
s_waitcnt vmcnt(0)
L_y3:
s_mov_b32 s91, 65536
L_y3c:
G v12,a128
G v13,a129
v_min_u32 v12, v12, v13
v_cmp_gt_u32 vcc, 2, v12
s_sub_u32 s91, s91, 1
s_cbranch_scc1 L_y3x
s_cbranch_vccz L_y3x
v_lshrrev_b32 v11, 7, v7
v_mul_u32_u24 v11, 4352, v11
v_and_b32 v12, 0x70, v7
v_lshl_add_u32 v11, v12, 3, v11
s_mov_b32 s64, 104923136
s_mov_b32 s65, 104957952
buffer_load_dword a128, v11, s[8:11], s64 offen sc1
buffer_load_dword a129, v11, s[8:11], s65 offen sc1
s_waitcnt vmcnt(0)
s_branch L_y3c
L_y3x:
s_lshl_b32 s66, s41, 1
SA s66,s66,s20
s_sub_u32 s66, s66, 2
s_cmp_lt_u32 s66, 14
s_cselect_b32 s64, 8, 12
SA s64,s64,104890368
buffer_load_dword a130, off, s[8:11], s64 sc1
v_lshrrev_b32 v11, 7, v7
v_mul_u32_u24 v11, 3584, v11
v_and_b32 v12, 0x70, v7
v_add_u32 v11, v12, v11
s_lshl_b32 s65, s66, 7
SA s65,s65,105906176
buffer_load_dwordx4 a[132:135], v11, s[8:11], s65 offen sc1
SA s65,s65,28672
buffer_load_dwordx4 a[136:139], v11, s[8:11], s65 offen sc1
SA s65,s65,28672
buffer_load_dwordx4 a[140:143], v11, s[8:11], s65 offen sc1
SA s65,s65,28672
buffer_load_dwordx4 a[144:147], v11, s[8:11], s65 offen sc1
SA s65,s65,28672
buffer_load_dwordx4 a[148:151], v11, s[8:11], s65 offen sc1
SA s65,s65,28672
buffer_load_dwordx4 a[152:155], v11, s[8:11], s65 offen sc1
SA s65,s65,28672
buffer_load_dwordx4 a[156:159], v11, s[8:11], s65 offen sc1
SA s65,s65,28672
buffer_load_dwordx4 a[160:163], v11, s[8:11], s65 offen sc1
SA s65,s65,28672
buffer_load_dwordx4 a[164:167], v11, s[8:11], s65 offen sc1
SA s65,s65,28672
buffer_load_dwordx4 a[168:171], v11, s[8:11], s65 offen sc1
SA s65,s65,28672
buffer_load_dwordx4 a[172:175], v11, s[8:11], s65 offen sc1
SA s65,s65,28672
buffer_load_dwordx4 a[176:179], v11, s[8:11], s65 offen sc1
SA s65,s65,28672
buffer_load_dwordx4 a[180:183], v11, s[8:11], s65 offen sc1
SA s65,s65,28672
buffer_load_dwordx4 a[184:187], v11, s[8:11], s65 offen sc1
SA s65,s65,28672
s_branch L_fllr
s_waitcnt vmcnt(0)
L_y4:
G v12,a132
G v13,a133
G v14,a134
G v15,a135
G v16,a136
G v17,a137
AF v12,v16,v12
AF v13,v17,v13
G v16,a138
G v17,a139
AF v14,v16,v14
AF v15,v17,v15
G v16,a140
G v17,a141
AF v12,v16,v12
AF v13,v17,v13
G v16,a142
G v17,a143
AF v14,v16,v14
AF v15,v17,v15
G v16,a144
G v17,a145
AF v12,v16,v12
AF v13,v17,v13
G v16,a146
G v17,a147
AF v14,v16,v14
AF v15,v17,v15
G v16,a148
G v17,a149
AF v12,v16,v12
AF v13,v17,v13
G v16,a150
G v17,a151
AF v14,v16,v14
AF v15,v17,v15
G v16,a152
G v17,a153
AF v12,v16,v12
AF v13,v17,v13
G v16,a154
G v17,a155
AF v14,v16,v14
AF v15,v17,v15
G v16,a156
G v17,a157
AF v12,v16,v12
AF v13,v17,v13
G v16,a158
G v17,a159
AF v14,v16,v14
AF v15,v17,v15
G v16,a160
G v17,a161
AF v12,v16,v12
AF v13,v17,v13
G v16,a162
G v17,a163
AF v14,v16,v14
AF v15,v17,v15
G v16,a164
G v17,a165
AF v12,v16,v12
AF v13,v17,v13
G v16,a166
G v17,a167
AF v14,v16,v14
AF v15,v17,v15
G v16,a168
G v17,a169
AF v12,v16,v12
AF v13,v17,v13
G v16,a170
G v17,a171
AF v14,v16,v14
AF v15,v17,v15
G v16,a172
G v17,a173
AF v12,v16,v12
AF v13,v17,v13
G v16,a174
G v17,a175
AF v14,v16,v14
AF v15,v17,v15
G v16,a176
G v17,a177
AF v12,v16,v12
AF v13,v17,v13
G v16,a178
G v17,a179
AF v14,v16,v14
AF v15,v17,v15
G v16,a180
G v17,a181
AF v12,v16,v12
AF v13,v17,v13
G v16,a182
G v17,a183
AF v14,v16,v14
AF v15,v17,v15
G v16,a184
G v17,a185
AF v12,v16,v12
AF v13,v17,v13
G v16,a186
G v17,a187
AF v14,v16,v14
AF v15,v17,v15
v_add_f32 v12, v12, v12 row_ror:8 row_mask:0xf bank_mask:0xf
v_add_f32 v13, v13, v13 row_ror:8 row_mask:0xf bank_mask:0xf
v_add_f32 v14, v14, v14 row_ror:8 row_mask:0xf bank_mask:0xf
v_add_f32 v15, v15, v15 row_ror:8 row_mask:0xf bank_mask:0xf
v_mov_b32 v11, v12
s_nop 1
v_permlane16_swap_b32 v11, v12
AF v12,v11,v12
v_mov_b32 v11, v13
s_nop 1
v_permlane16_swap_b32 v11, v13
AF v13,v11,v13
v_mov_b32 v11, v14
s_nop 1
v_permlane16_swap_b32 v11, v14
AF v14,v11,v14
v_mov_b32 v11, v15
s_nop 1
v_permlane16_swap_b32 v11, v15
AF v15,v11,v15
v_mov_b32 v11, v12
s_nop 1
v_permlane32_swap_b32 v11, v12
AF v12,v11,v12
v_mov_b32 v11, v13
s_nop 1
v_permlane32_swap_b32 v11, v13
AF v13,v11,v13
v_mov_b32 v11, v14
s_nop 1
v_permlane32_swap_b32 v11, v14
AF v14,v11,v14
v_mov_b32 v11, v15
s_nop 1
v_permlane32_swap_b32 v11, v15
AF v15,v11,v15
G v16,a130
C v11,v12,v13
v_lshlrev_b32 v12, 16, v11
v_and_b32 v13, 0xffff0000, v11
C v11,v14,v15
v_lshlrev_b32 v14, 16, v11
v_and_b32 v15, 0xffff0000, v11
MF v12,v16,v12
MF v13,v16,v13
MF v14,v16,v14
MF v15,v16,v15
C v11,v12,v13
v_lshlrev_b32 v12, 16, v11
v_and_b32 v13, 0xffff0000, v11
C v11,v14,v15
v_lshlrev_b32 v14, 16, v11
v_and_b32 v15, 0xffff0000, v11
s_lshl_b32 s66, s41, 1
SA s66,s66,s20
s_sub_u32 s66, s66, 2
s_lshl_b32 s65, s66, 7
SA s65,s65,104898560
s_mov_b64 exec, 0xff
buffer_store_dwordx4 v[12:15], v7, s[8:11], s65 offen sc1
s_mov_b64 exec, -1
s_nop 1
s_branch L_fllr
L_y5:
s_lshl_b32 s66, s41, 1
SA s66,s66,s20
s_sub_u32 s66, s66, 2
s_lshl_b32 s66, s66, 2
SA s66,s66,105062912
v_mov_b32 v11, 1
s_mov_b64 exec, 1
buffer_store_dword v11, off, s[8:11], s66 sc1
s_mov_b64 exec, -1
s_branch L_fllr
.p2align 12
L_loop_top:
M v[64:67],a[64:67],a[0:3],v[32:35]
SA m0,s28,0
R a[96:99],v2,40960
M v[64:67],a[68:71],a[4:7],v[64:67]
buffer_load_dword a240, v0, s[60:63], 0 offen offset:0
M v[64:67],a[72:75],a[8:11],v[64:67]
R a[100:103],v2,41984
M v[64:67],a[76:79],a[12:15],v[64:67]
s_waitcnt lgkmcnt(2)
buffer_load_dwordx4 v3, s[8:11], s26 offen offset:0 sc1 lds
M v[64:67],a[80:83],a[16:19],v[64:67]
R a[104:107],v2,43008
M v[64:67],a[84:87],a[20:23],v[64:67]
E v18,v112
M v[64:67],a[88:91],a[24:27],v[64:67]
R a[108:111],v2,44032
M v[64:67],a[92:95],a[28:31],v[64:67]
buffer_load_dwordx4 v3, s[8:11], s26 offen offset:1024 sc1 lds
M v[68:71],a[92:95],a[60:63],v[36:39]
R a[112:115],v2,45056
M v[68:71],a[88:91],a[56:59],v[68:71]
E v19,v113
M v[68:71],a[84:87],a[52:55],v[68:71]
R a[116:119],v2,46080
AF v28,v18,v28
M v[68:71],a[80:83],a[48:51],v[68:71]
E v20,v114
M v[68:71],a[76:79],a[44:47],v[68:71]
R a[120:123],v2,47104
C v56,v18,v19
M v[68:71],a[72:75],a[40:43],v[68:71]
buffer_load_dwordx4 v3, s[8:11], s26 offen offset:2048 sc1 lds
M v[68:71],a[68:71],a[36:39],v[68:71]
R a[124:127],v2,48128
AF v28,v19,v28
M v[68:71],a[64:67],a[32:35],v[68:71]
s_waitcnt lgkmcnt(4)
E v21,v115
M v[72:75],a[96:99],a[0:3],v[32:35]
R a[64:67],v2,49152
AF v28,v20,v28
M v[72:75],a[100:103],a[4:7],v[72:75]
buffer_load_dwordx4 v3, s[8:11], s26 offen offset:3072 sc1 lds
M v[72:75],a[104:107],a[8:11],v[72:75]
R a[68:71],v2,50176
C v57,v20,v21
M v[72:75],a[108:111],a[12:15],v[72:75]
s_waitcnt lgkmcnt(2)
E v22,v120
M v[72:75],a[112:115],a[16:19],v[72:75]
R a[72:75],v2,51200
AF v28,v21,v28
M v[72:75],a[116:119],a[20:23],v[72:75]
E v23,v121
M v[72:75],a[120:123],a[24:27],v[72:75]
SA m0,s28,4096
R a[76:79],v2,52224
AF v28,v22,v28
M v[72:75],a[124:127],a[28:31],v[72:75]
buffer_load_dwordx4 v4, s[8:11], s26 offen offset:0 sc1 lds
M v[76:79],a[124:127],a[60:63],v[36:39]
R a[80:83],v2,53248
C v58,v22,v23
M v[76:79],a[120:123],a[56:59],v[76:79]
E v24,v122
M v[76:79],a[116:119],a[52:55],v[76:79]
R a[84:87],v2,54272
AF v28,v23,v28
M v[76:79],a[112:115],a[48:51],v[76:79]
E v25,v123
M v[76:79],a[108:111],a[44:47],v[76:79]
R a[88:91],v2,55296
AF v28,v24,v28
M v[76:79],a[104:107],a[40:43],v[76:79]
buffer_load_dwordx4 v4, s[8:11], s26 offen offset:1024 sc1 lds
M v[76:79],a[100:103],a[36:39],v[76:79]
R a[92:95],v2,56320
C v59,v24,v25
M v[76:79],a[96:99],a[32:35],v[76:79]
s_waitcnt lgkmcnt(4)
E v18,v116
M v[80:83],a[64:67],a[0:3],v[32:35]
R a[96:99],v2,57344
AF v28,v25,v28
M v[80:83],a[68:71],a[4:7],v[80:83]
R a[100:103],v2,58368
M v[80:83],a[72:75],a[8:11],v[80:83]
buffer_load_dwordx4 v4, s[8:11], s26 offen offset:2048 sc1 lds
M v[80:83],a[76:79],a[12:15],v[80:83]
s_waitcnt lgkmcnt(2)
R a[104:107],v2,59392
M v[80:83],a[80:83],a[16:19],v[80:83]
R a[108:111],v2,60416
M v[80:83],a[84:87],a[20:23],v[80:83]
E v19,v117
M v[80:83],a[88:91],a[24:27],v[80:83]
R a[112:115],v2,61440
AF v29,v18,v29
M v[80:83],a[92:95],a[28:31],v[80:83]
R a[116:119],v2,62464
C v60,v18,v19
M v[84:87],a[92:95],a[60:63],v[36:39]
buffer_load_dwordx4 v4, s[8:11], s26 offen offset:3072 sc1 lds
M v[84:87],a[88:91],a[56:59],v[84:87]
SA s26,s26,32768
R a[120:123],v2,63488
AF v29,v19,v29
M v[84:87],a[84:87],a[52:55],v[84:87]
R a[124:127],v2,64512
M v[84:87],a[80:83],a[48:51],v[84:87]
E v20,v118
M v[84:87],a[76:79],a[44:47],v[84:87]
E v21,v119
M v[84:87],a[72:75],a[40:43],v[84:87]
E v22,v124
M v[84:87],a[68:71],a[36:39],v[84:87]
s_waitcnt vmcnt(17) lgkmcnt(0)
E v23,v125
M v[84:87],a[64:67],a[32:35],v[84:87]
s_barrier
M v[88:91],a[96:99],a[0:3],v[32:35]
R a[64:67],v7,32768
AF v29,v20,v29
M v[88:91],a[100:103],a[4:7],v[88:91]
E v24,v126
M v[88:91],a[104:107],a[8:11],v[88:91]
R a[68:71],v7,33792
C v61,v20,v21
M v[88:91],a[108:111],a[12:15],v[88:91]
AF v29,v21,v29
AF v29,v22,v29
M v[88:91],a[112:115],a[16:19],v[88:91]
R a[72:75],v7,34816
C v62,v22,v23
M v[88:91],a[116:119],a[20:23],v[88:91]
E v25,v127
M v[88:91],a[120:123],a[24:27],v[88:91]
R a[76:79],v7,35840
AF v29,v23,v29
M v[88:91],a[124:127],a[28:31],v[88:91]
AF v29,v24,v29
C v63,v24,v25
M v[92:95],a[124:127],a[60:63],v[36:39]
R a[80:83],v7,36864
AF v29,v25,v29
M v[92:95],a[120:123],a[56:59],v[92:95]
M v[92:95],a[116:119],a[52:55],v[92:95]
R a[84:87],v7,37888
v_max_f32 v10, v28, v29
M v[92:95],a[112:115],a[48:51],v[92:95]
v_cmp_lt_f32 vcc, s31, v10
M v[92:95],a[108:111],a[44:47],v[92:95]
R a[88:91],v7,38912
M v[92:95],a[104:107],a[40:43],v[92:95]
M v[92:95],a[100:103],a[36:39],v[92:95]
s_waitcnt lgkmcnt(3)
R a[92:95],v7,39936
M v[92:95],a[96:99],a[32:35],v[92:95]
s_cbranch_vccnz L_st1
L_rt1:
M v[128:131],a[64:67],v[48:51],v[128:131]
SA m0,s28,98304
R a[96:99],v7,40960
AF v30,v28,v30
M v[128:131],a[68:71],v[56:59],v[128:131]
buffer_load_dwordx4 v3, s[8:11], s21 offen offset:0 sc1 lds
M v[132:135],a[68:71],v[60:63],v[132:135]
R a[100:103],v7,41984
AF v31,v29,v31
M v[132:135],a[64:67],v[52:55],v[132:135]
s_waitcnt lgkmcnt(2)
E v18,v64
M v[136:139],a[72:75],v[48:51],v[136:139]
R a[104:107],v7,43008
M v[136:139],a[76:79],v[56:59],v[136:139]
buffer_load_dwordx4 v3, s[8:11], s21 offen offset:1024 sc1 lds
M v[140:143],a[76:79],v[60:63],v[140:143]
R a[108:111],v7,44032
M v[140:143],a[72:75],v[52:55],v[140:143]
E v19,v65
M v[144:147],a[80:83],v[48:51],v[144:147]
R a[112:115],v7,45056
AF v26,v18,v19
M v[144:147],a[84:87],v[56:59],v[144:147]
E v20,v66
M v[148:151],a[84:87],v[60:63],v[148:151]
R a[116:119],v7,46080
C v40,v18,v19
M v[148:151],a[80:83],v[52:55],v[148:151]
buffer_load_dwordx4 v3, s[8:11], s21 offen offset:2048 sc1 lds
M v[152:155],a[88:91],v[48:51],v[152:155]
R a[120:123],v7,47104
M v[152:155],a[92:95],v[56:59],v[152:155]
E v21,v67
M v[156:159],a[92:95],v[60:63],v[156:159]
R a[124:127],v7,48128
AF v26,v20,v26
M v[156:159],a[88:91],v[52:55],v[156:159]
s_waitcnt lgkmcnt(4)
buffer_load_dwordx4 v3, s[8:11], s21 offen offset:3072 sc1 lds
M v[160:163],a[96:99],v[48:51],v[160:163]
R a[64:67],v7,49152
C v41,v20,v21
M v[160:163],a[100:103],v[56:59],v[160:163]
E v22,v72
M v[164:167],a[100:103],v[60:63],v[164:167]
SA m0,s28,102400
R a[68:71],v7,50176
AF v26,v21,v26
M v[164:167],a[96:99],v[52:55],v[164:167]
s_waitcnt lgkmcnt(2)
buffer_load_dwordx4 v4, s[8:11], s21 offen offset:0 sc1 lds
M v[168:171],a[104:107],v[48:51],v[168:171]
R a[72:75],v7,51200
M v[168:171],a[108:111],v[56:59],v[168:171]
E v23,v73
M v[172:175],a[108:111],v[60:63],v[172:175]
R a[76:79],v7,52224
AF v26,v22,v26
M v[172:175],a[104:107],v[52:55],v[172:175]
E v24,v74
M v[176:179],a[112:115],v[48:51],v[176:179]
R a[80:83],v7,53248
C v42,v22,v23
M v[176:179],a[116:119],v[56:59],v[176:179]
buffer_load_dwordx4 v4, s[8:11], s21 offen offset:1024 sc1 lds
M v[180:183],a[116:119],v[60:63],v[180:183]
R a[84:87],v7,54272
AF v26,v23,v26
M v[180:183],a[112:115],v[52:55],v[180:183]
E v25,v75
M v[184:187],a[120:123],v[48:51],v[184:187]
R a[88:91],v7,55296
AF v26,v24,v26
M v[184:187],a[124:127],v[56:59],v[184:187]
buffer_load_dwordx4 v4, s[8:11], s21 offen offset:2048 sc1 lds
M v[188:191],a[124:127],v[60:63],v[188:191]
R a[92:95],v7,56320
C v43,v24,v25
M v[188:191],a[120:123],v[52:55],v[188:191]
s_waitcnt lgkmcnt(4)
E v18,v68
M v[192:195],a[64:67],v[48:51],v[192:195]
R a[96:99],v7,57344
AF v26,v25,v26
M v[192:195],a[68:71],v[56:59],v[192:195]
R a[100:103],v7,58368
M v[196:199],a[68:71],v[60:63],v[196:199]
buffer_load_dwordx4 v4, s[8:11], s21 offen offset:3072 sc1 lds
M v[196:199],a[64:67],v[52:55],v[196:199]
s_waitcnt lgkmcnt(2)
R a[104:107],v7,59392
M v[200:203],a[72:75],v[48:51],v[200:203]
SA s21,s21,32768
R a[108:111],v7,60416
M v[200:203],a[76:79],v[56:59],v[200:203]
s_sub_u32 s22, s22, 1
E v19,v69
M v[204:207],a[76:79],v[60:63],v[204:207]
s_cselect_b32 s21, s23, s21
R a[112:115],v7,61440
AF v27,v18,v19
M v[204:207],a[72:75],v[52:55],v[204:207]
R a[116:119],v7,62464
C v44,v18,v19
M v[208:211],a[80:83],v[48:51],v[208:211]
E v20,v70
M v[208:211],a[84:87],v[56:59],v[208:211]
R a[120:123],v7,63488
M v[212:215],a[84:87],v[60:63],v[212:215]
R a[124:127],v7,64512
M v[212:215],a[80:83],v[52:55],v[212:215]
E v21,v71
M v[216:219],a[88:91],v[48:51],v[216:219]
E v22,v76
M v[216:219],a[92:95],v[56:59],v[216:219]
AF v27,v20,v27
C v45,v20,v21
M v[220:223],a[92:95],v[60:63],v[220:223]
s_waitcnt vmcnt(17) lgkmcnt(0)
AF v27,v21,v27
M v[220:223],a[88:91],v[52:55],v[220:223]
s_barrier
M v[224:227],a[96:99],v[48:51],v[224:227]
R a[64:67],v2,0
M v[224:227],a[100:103],v[56:59],v[224:227]
E v23,v77
M v[228:231],a[100:103],v[60:63],v[228:231]
R a[68:71],v2,1024
AF v27,v22,v27
M v[228:231],a[96:99],v[52:55],v[228:231]
E v24,v78
M v[232:235],a[104:107],v[48:51],v[232:235]
R a[72:75],v2,2048
C v46,v22,v23
M v[232:235],a[108:111],v[56:59],v[232:235]
AF v27,v23,v27
M v[236:239],a[108:111],v[60:63],v[236:239]
R a[76:79],v2,3072
M v[236:239],a[104:107],v[52:55],v[236:239]
E v25,v79
M v[240:243],a[112:115],v[48:51],v[240:243]
R a[80:83],v2,4096
AF v27,v24,v27
M v[240:243],a[116:119],v[56:59],v[240:243]
C v47,v24,v25
AF v27,v25,v27
M v[244:247],a[116:119],v[60:63],v[244:247]
R a[84:87],v2,5120
M v[244:247],a[112:115],v[52:55],v[244:247]
M v[248:251],a[120:123],v[48:51],v[248:251]
R a[88:91],v2,6144
M v[248:251],a[124:127],v[56:59],v[248:251]
M v[252:255],a[124:127],v[60:63],v[252:255]
s_waitcnt lgkmcnt(3)
R a[92:95],v2,7168
M v[252:255],a[120:123],v[52:55],v[252:255]
M v[96:99],a[64:67],a[0:3],v[32:35]
s_bitcmp1_b32 s39, s7
R a[96:99],v2,8192
M v[96:99],a[68:71],a[4:7],v[96:99]
s_cbranch_scc1 L_fll
L_fllr:
E v18,v80
M v[96:99],a[72:75],a[8:11],v[96:99]
SA m0,s28,32768
R a[100:103],v2,9216
M v[96:99],a[76:79],a[12:15],v[96:99]
s_waitcnt lgkmcnt(2)
buffer_load_dwordx4 v3, s[8:11], s26 offen offset:0 sc1 lds
M v[96:99],a[80:83],a[16:19],v[96:99]
R a[104:107],v2,10240
M v[96:99],a[84:87],a[20:23],v[96:99]
E v19,v81
M v[96:99],a[88:91],a[24:27],v[96:99]
R a[108:111],v2,11264
AF v26,v18,v26
M v[96:99],a[92:95],a[28:31],v[96:99]
E v20,v82
M v[100:103],a[92:95],a[60:63],v[36:39]
R a[112:115],v2,12288
C v56,v18,v19
M v[100:103],a[88:91],a[56:59],v[100:103]
buffer_load_dwordx4 v3, s[8:11], s26 offen offset:1024 sc1 lds
M v[100:103],a[84:87],a[52:55],v[100:103]
R a[116:119],v2,13312
AF v26,v19,v26
M v[100:103],a[80:83],a[48:51],v[100:103]
E v21,v83
M v[100:103],a[76:79],a[44:47],v[100:103]
R a[120:123],v2,14336
AF v26,v20,v26
M v[100:103],a[72:75],a[40:43],v[100:103]
buffer_load_dwordx4 v3, s[8:11], s26 offen offset:2048 sc1 lds
M v[100:103],a[68:71],a[36:39],v[100:103]
R a[124:127],v2,15360
C v57,v20,v21
M v[100:103],a[64:67],a[32:35],v[100:103]
s_waitcnt lgkmcnt(4)
E v22,v88
M v[104:107],a[96:99],a[0:3],v[32:35]
R a[64:67],v2,16384
AF v26,v21,v26
M v[104:107],a[100:103],a[4:7],v[104:107]
E v23,v89
M v[104:107],a[104:107],a[8:11],v[104:107]
R a[68:71],v2,17408
AF v26,v22,v26
M v[104:107],a[108:111],a[12:15],v[104:107]
s_waitcnt lgkmcnt(2)
buffer_load_dwordx4 v3, s[8:11], s26 offen offset:3072 sc1 lds
M v[104:107],a[112:115],a[16:19],v[104:107]
R a[72:75],v2,18432
C v58,v22,v23
M v[104:107],a[116:119],a[20:23],v[104:107]
E v24,v90
M v[104:107],a[120:123],a[24:27],v[104:107]
R a[76:79],v2,19456
AF v26,v23,v26
M v[104:107],a[124:127],a[28:31],v[104:107]
SA m0,s28,36864
M v[108:111],a[124:127],a[60:63],v[36:39]
R a[80:83],v2,20480
M v[108:111],a[120:123],a[56:59],v[108:111]
buffer_load_dwordx4 v4, s[8:11], s26 offen offset:0 sc1 lds
M v[108:111],a[116:119],a[52:55],v[108:111]
R a[84:87],v2,21504
M v[108:111],a[112:115],a[48:51],v[108:111]
E v25,v91
M v[108:111],a[108:111],a[44:47],v[108:111]
R a[88:91],v2,22528
AF v26,v24,v26
M v[108:111],a[104:107],a[40:43],v[108:111]
buffer_load_dwordx4 v4, s[8:11], s26 offen offset:1024 sc1 lds
M v[108:111],a[100:103],a[36:39],v[108:111]
R a[92:95],v2,23552
C v59,v24,v25
M v[108:111],a[96:99],a[32:35],v[108:111]
s_waitcnt lgkmcnt(4)
E v18,v84
M v[112:115],a[64:67],a[0:3],v[32:35]
R a[96:99],v2,24576
AF v26,v25,v26
M v[112:115],a[68:71],a[4:7],v[112:115]
R a[100:103],v2,25600
M v[112:115],a[72:75],a[8:11],v[112:115]
buffer_load_dwordx4 v4, s[8:11], s26 offen offset:2048 sc1 lds
M v[112:115],a[76:79],a[12:15],v[112:115]
s_waitcnt lgkmcnt(2)
R a[104:107],v2,26624
M v[112:115],a[80:83],a[16:19],v[112:115]
R a[108:111],v2,27648
M v[112:115],a[84:87],a[20:23],v[112:115]
E v19,v85
M v[112:115],a[88:91],a[24:27],v[112:115]
R a[112:115],v2,28672
AF v27,v18,v27
M v[112:115],a[92:95],a[28:31],v[112:115]
R a[116:119],v2,29696
C v60,v18,v19
M v[116:119],a[92:95],a[60:63],v[36:39]
buffer_load_dwordx4 v4, s[8:11], s26 offen offset:3072 sc1 lds
M v[116:119],a[88:91],a[56:59],v[116:119]
SA s26,s26,32768
R a[120:123],v2,30720
AF v27,v19,v27
M v[116:119],a[84:87],a[52:55],v[116:119]
R a[124:127],v2,31744
M v[116:119],a[80:83],a[48:51],v[116:119]
E v20,v86
M v[116:119],a[76:79],a[44:47],v[116:119]
E v21,v87
M v[116:119],a[72:75],a[40:43],v[116:119]
E v22,v92
M v[116:119],a[68:71],a[36:39],v[116:119]
s_waitcnt vmcnt(16) lgkmcnt(0)
E v23,v93
M v[116:119],a[64:67],a[32:35],v[116:119]
s_barrier
M v[120:123],a[96:99],a[0:3],v[32:35]
R a[64:67],v7,0
AF v27,v20,v27
M v[120:123],a[100:103],a[4:7],v[120:123]
E v24,v94
M v[120:123],a[104:107],a[8:11],v[120:123]
R a[68:71],v7,1024
C v61,v20,v21
M v[120:123],a[108:111],a[12:15],v[120:123]
AF v27,v21,v27
AF v27,v22,v27
M v[120:123],a[112:115],a[16:19],v[120:123]
R a[72:75],v7,2048
C v62,v22,v23
M v[120:123],a[116:119],a[20:23],v[120:123]
E v25,v95
M v[120:123],a[120:123],a[24:27],v[120:123]
R a[76:79],v7,3072
AF v27,v23,v27
M v[120:123],a[124:127],a[28:31],v[120:123]
AF v27,v24,v27
C v63,v24,v25
M v[124:127],a[124:127],a[60:63],v[36:39]
R a[80:83],v7,4096
AF v27,v25,v27
M v[124:127],a[120:123],a[56:59],v[124:127]
M v[124:127],a[116:119],a[52:55],v[124:127]
R a[84:87],v7,5120
v_max_f32 v10, v26, v27
M v[124:127],a[112:115],a[48:51],v[124:127]
v_cmp_lt_f32 vcc, s31, v10
M v[124:127],a[108:111],a[44:47],v[124:127]
R a[88:91],v7,6144
M v[124:127],a[104:107],a[40:43],v[124:127]
M v[124:127],a[100:103],a[36:39],v[124:127]
s_waitcnt lgkmcnt(3)
R a[92:95],v7,7168
M v[124:127],a[96:99],a[32:35],v[124:127]
s_cbranch_vccnz L_st0
L_rt0:
M v[128:131],a[64:67],v[40:43],v[128:131]
SA m0,s28,65536
R a[96:99],v7,8192
AF v30,v26,v30
M v[128:131],a[68:71],v[56:59],v[128:131]
buffer_load_dwordx4 v3, s[8:11], s21 offen offset:0 sc1 lds
M v[132:135],a[68:71],v[60:63],v[132:135]
R a[100:103],v7,9216
AF v31,v27,v31
M v[132:135],a[64:67],v[44:47],v[132:135]
s_waitcnt lgkmcnt(2)
E v18,v96
M v[136:139],a[72:75],v[40:43],v[136:139]
R a[104:107],v7,10240
M v[136:139],a[76:79],v[56:59],v[136:139]
buffer_load_dwordx4 v3, s[8:11], s21 offen offset:1024 sc1 lds
M v[140:143],a[76:79],v[60:63],v[140:143]
R a[108:111],v7,11264
M v[140:143],a[72:75],v[44:47],v[140:143]
E v19,v97
M v[144:147],a[80:83],v[40:43],v[144:147]
R a[112:115],v7,12288
AF v28,v18,v19
M v[144:147],a[84:87],v[56:59],v[144:147]
E v20,v98
M v[148:151],a[84:87],v[60:63],v[148:151]
R a[116:119],v7,13312
C v48,v18,v19
M v[148:151],a[80:83],v[44:47],v[148:151]
buffer_load_dwordx4 v3, s[8:11], s21 offen offset:2048 sc1 lds
M v[152:155],a[88:91],v[40:43],v[152:155]
R a[120:123],v7,14336
M v[152:155],a[92:95],v[56:59],v[152:155]
E v21,v99
M v[156:159],a[92:95],v[60:63],v[156:159]
R a[124:127],v7,15360
AF v28,v20,v28
M v[156:159],a[88:91],v[44:47],v[156:159]
s_waitcnt lgkmcnt(4)
buffer_load_dwordx4 v3, s[8:11], s21 offen offset:3072 sc1 lds
M v[160:163],a[96:99],v[40:43],v[160:163]
R a[64:67],v7,16384
C v49,v20,v21
M v[160:163],a[100:103],v[56:59],v[160:163]
E v22,v104
M v[164:167],a[100:103],v[60:63],v[164:167]
SA m0,s28,69632
R a[68:71],v7,17408
AF v28,v21,v28
M v[164:167],a[96:99],v[44:47],v[164:167]
s_waitcnt lgkmcnt(2)
buffer_load_dwordx4 v4, s[8:11], s21 offen offset:0 sc1 lds
M v[168:171],a[104:107],v[40:43],v[168:171]
R a[72:75],v7,18432
M v[168:171],a[108:111],v[56:59],v[168:171]
E v23,v105
M v[172:175],a[108:111],v[60:63],v[172:175]
R a[76:79],v7,19456
AF v28,v22,v28
M v[172:175],a[104:107],v[44:47],v[172:175]
E v24,v106
M v[176:179],a[112:115],v[40:43],v[176:179]
R a[80:83],v7,20480
C v50,v22,v23
M v[176:179],a[116:119],v[56:59],v[176:179]
buffer_load_dwordx4 v4, s[8:11], s21 offen offset:1024 sc1 lds
M v[180:183],a[116:119],v[60:63],v[180:183]
R a[84:87],v7,21504
AF v28,v23,v28
M v[180:183],a[112:115],v[44:47],v[180:183]
E v25,v107
M v[184:187],a[120:123],v[40:43],v[184:187]
R a[88:91],v7,22528
AF v28,v24,v28
M v[184:187],a[124:127],v[56:59],v[184:187]
buffer_load_dwordx4 v4, s[8:11], s21 offen offset:2048 sc1 lds
M v[188:191],a[124:127],v[60:63],v[188:191]
R a[92:95],v7,23552
C v51,v24,v25
M v[188:191],a[120:123],v[44:47],v[188:191]
s_waitcnt lgkmcnt(4)
E v18,v100
M v[192:195],a[64:67],v[40:43],v[192:195]
R a[96:99],v7,24576
AF v28,v25,v28
M v[192:195],a[68:71],v[56:59],v[192:195]
R a[100:103],v7,25600
M v[196:199],a[68:71],v[60:63],v[196:199]
buffer_load_dwordx4 v4, s[8:11], s21 offen offset:3072 sc1 lds
M v[196:199],a[64:67],v[44:47],v[196:199]
s_waitcnt lgkmcnt(2)
R a[104:107],v7,26624
M v[200:203],a[72:75],v[40:43],v[200:203]
SA s21,s21,32768
R a[108:111],v7,27648
M v[200:203],a[76:79],v[56:59],v[200:203]
s_sub_u32 s22, s22, 1
E v19,v101
M v[204:207],a[76:79],v[60:63],v[204:207]
s_cselect_b32 s21, s23, s21
R a[112:115],v7,28672
AF v29,v18,v19
M v[204:207],a[72:75],v[44:47],v[204:207]
R a[116:119],v7,29696
C v52,v18,v19
M v[208:211],a[80:83],v[40:43],v[208:211]
E v20,v102
M v[208:211],a[84:87],v[56:59],v[208:211]
R a[120:123],v7,30720
M v[212:215],a[84:87],v[60:63],v[212:215]
R a[124:127],v7,31744
M v[212:215],a[80:83],v[44:47],v[212:215]
E v21,v103
M v[216:219],a[88:91],v[40:43],v[216:219]
E v22,v108
M v[216:219],a[92:95],v[56:59],v[216:219]
AF v29,v20,v29
C v53,v20,v21
M v[220:223],a[92:95],v[60:63],v[220:223]
s_waitcnt vmcnt(16) lgkmcnt(0)
AF v29,v21,v29
M v[220:223],a[88:91],v[44:47],v[220:223]
s_barrier
M v[224:227],a[96:99],v[40:43],v[224:227]
R a[64:67],v2,32768
M v[224:227],a[100:103],v[56:59],v[224:227]
E v23,v109
M v[228:231],a[100:103],v[60:63],v[228:231]
R a[68:71],v2,33792
v_cmp_gt_u32 vcc, s6, v5
M v[228:231],a[96:99],v[44:47],v[228:231]
E v24,v110
M v[232:235],a[104:107],v[40:43],v[232:235]
R a[72:75],v2,34816
AF v29,v22,v29
M v[232:235],a[108:111],v[56:59],v[232:235]
s_cbranch_vccnz L_fls0
L_flr0:
C v54,v22,v23
AF v29,v23,v29
M v[236:239],a[108:111],v[60:63],v[236:239]
s_mov_b32 s6, 0
R a[76:79],v2,35840
M v[236:239],a[104:107],v[44:47],v[236:239]
SA s7,s7,1
E v25,v111
M v[240:243],a[112:115],v[40:43],v[240:243]
R a[80:83],v2,36864
AF v29,v24,v29
M v[240:243],a[116:119],v[56:59],v[240:243]
C v55,v24,v25
AF v29,v25,v29
M v[244:247],a[116:119],v[60:63],v[244:247]
R a[84:87],v2,37888
M v[244:247],a[112:115],v[44:47],v[244:247]
M v[248:251],a[120:123],v[40:43],v[248:251]
s_sub_u32 s27, s27, 1
R a[88:91],v2,38912
M v[248:251],a[124:127],v[56:59],v[248:251]
s_cmp_lg_u32 s27, 0
M v[252:255],a[124:127],v[60:63],v[252:255]
s_waitcnt lgkmcnt(3)
R a[92:95],v2,39936
M v[252:255],a[120:123],v[44:47],v[252:255]
s_cbranch_scc1 L_loop_top
s_cmp_eq_u32 s40, 0
s_cbranch_scc1 L_final_h
L_d1s:
M v[68:71],a[64:67],a[32:35],v[36:39]
s_cmp_lt_u32 s20, 0
R a[96:99],v2,40960
R a[100:103],v2,41984
M v[68:71],a[68:71],a[36:39],v[68:71]
s_cselect_b64 s[82:83], -1, 0
E v18,v112
M v[68:71],a[72:75],a[40:43],v[68:71]
s_cmp_eq_u32 s20, 0
M v[68:71],a[76:79],a[44:47],v[68:71]
s_cselect_b64 s[66:67], s[16:17], s[82:83]
R a[104:107],v2,43008
R a[108:111],v2,44032
s_waitcnt lgkmcnt(7)
M v[68:71],a[80:83],a[48:51],v[68:71]
s_cselect_b64 s[68:69], s[18:19], s[82:83]
E v19,v113
s_waitcnt lgkmcnt(6)
M v[68:71],a[84:87],a[52:55],v[68:71]
s_cselect_b64 s[70:71], s[48:49], s[82:83]
AF v28,v18,v28
C v56,v18,v19
s_waitcnt lgkmcnt(5)
M v[68:71],a[88:91],a[56:59],v[68:71]
s_cselect_b64 s[72:73], s[50:51], s[82:83]
R a[112:115],v2,45056
R a[116:119],v2,46080
v_cndmask_b32 v64, v32, v8, s[66:67]
v_cndmask_b32 v65, v32, v8, s[68:69]
v_cndmask_b32 v66, v32, v8, s[70:71]
v_cndmask_b32 v67, v32, v8, s[72:73]
s_waitcnt lgkmcnt(6)
M v[68:71],a[92:95],a[60:63],v[68:71]
s_mov_b32 s26, s43
v_min_u32 v17, 896, v9
AF v28,v19,v28
M v[64:67],a[92:95],a[28:31],v[64:67]
s_cmp_lt_u32 s20, 1
buffer_load_dword v5, v17, s[8:11], s46 offen sc1
M v[64:67],a[88:91],a[24:27],v[64:67]
s_cselect_b64 s[82:83], -1, 0
R a[120:123],v2,47104
R a[124:127],v2,48128
M v[64:67],a[84:87],a[20:23],v[64:67]
SA m0,s28,0
E v20,v114
M v[64:67],a[80:83],a[16:19],v[64:67]
s_cmp_eq_u32 s20, 1
buffer_load_dwordx4 v3, s[8:11], s26 offen offset:0 sc1 lds
M v[64:67],a[76:79],a[12:15],v[64:67]
s_cselect_b64 s[74:75], s[16:17], s[82:83]
E v21,v115
M v[64:67],a[72:75],a[8:11],v[64:67]
s_cselect_b64 s[76:77], s[18:19], s[82:83]
AF v28,v20,v28
C v57,v20,v21
M v[64:67],a[68:71],a[4:7],v[64:67]
s_cselect_b64 s[78:79], s[48:49], s[82:83]
E v22,v120
M v[64:67],a[64:67],a[0:3],v[64:67]
s_waitcnt lgkmcnt(0)
buffer_load_dwordx4 v3, s[8:11], s26 offen offset:1024 sc1 lds
M v[76:79],a[96:99],a[32:35],v[36:39]
s_cselect_b64 s[80:81], s[50:51], s[82:83]
R a[64:67],v2,49152
R a[68:71],v2,50176
M v[76:79],a[100:103],a[36:39],v[76:79]
v_cndmask_b32 v72, v32, v8, s[74:75]
v_cndmask_b32 v73, v32, v8, s[76:77]
M v[76:79],a[104:107],a[40:43],v[76:79]
v_cndmask_b32 v74, v32, v8, s[78:79]
AF v28,v21,v28
M v[76:79],a[108:111],a[44:47],v[76:79]
R a[72:75],v2,51200
R a[76:79],v2,52224
M v[76:79],a[112:115],a[48:51],v[76:79]
buffer_load_dwordx4 v3, s[8:11], s26 offen offset:2048 sc1 lds
M v[76:79],a[116:119],a[52:55],v[76:79]
v_cndmask_b32 v75, v32, v8, s[80:81]
M v[76:79],a[120:123],a[56:59],v[76:79]
s_cmp_lt_u32 s20, 2
R a[80:83],v2,53248
R a[84:87],v2,54272
M v[76:79],a[124:127],a[60:63],v[76:79]
s_cselect_b64 s[82:83], -1, 0
E v23,v121
M v[72:75],a[124:127],a[28:31],v[72:75]
s_cmp_eq_u32 s20, 2
buffer_load_dwordx4 v3, s[8:11], s26 offen offset:3072 sc1 lds
M v[72:75],a[120:123],a[24:27],v[72:75]
s_cselect_b64 s[66:67], s[16:17], s[82:83]
R a[88:91],v2,55296
R a[92:95],v2,56320
M v[72:75],a[116:119],a[20:23],v[72:75]
s_cselect_b64 s[68:69], s[18:19], s[82:83]
E v24,v122
M v[72:75],a[112:115],a[16:19],v[72:75]
s_cselect_b64 s[70:71], s[48:49], s[82:83]
E v25,v123
M v[72:75],a[108:111],a[12:15],v[72:75]
s_cselect_b64 s[72:73], s[50:51], s[82:83]
v_cndmask_b32 v80, v32, v8, s[66:67]
v_cndmask_b32 v81, v32, v8, s[68:69]
M v[72:75],a[104:107],a[8:11],v[72:75]
SA m0,s28,4096
E v18,v116
M v[72:75],a[100:103],a[4:7],v[72:75]
s_lshl_b32 s86, s20, 14
buffer_load_dwordx4 v4, s[8:11], s26 offen offset:0 sc1 lds
M v[72:75],a[96:99],a[0:3],v[72:75]
s_waitcnt lgkmcnt(0)
v_cndmask_b32 v82, v32, v8, s[70:71]
AF v28,v22,v28
M v[84:87],a[64:67],a[32:35],v[36:39]
SA s86,s86,s34
R a[96:99],v2,57344
R a[100:103],v2,58368
M v[84:87],a[68:71],a[36:39],v[84:87]
SA s87,s86,4096
buffer_load_dwordx4 v4, s[8:11], s26 offen offset:1024 sc1 lds
M v[84:87],a[72:75],a[40:43],v[84:87]
SA s88,s86,8192
v_cndmask_b32 v83, v32, v8, s[72:73]
C v58,v22,v23
M v[84:87],a[76:79],a[44:47],v[84:87]
s_cmp_lt_u32 s20, 3
R a[104:107],v2,59392
R a[108:111],v2,60416
M v[84:87],a[80:83],a[48:51],v[84:87]
s_cselect_b64 s[82:83], -1, 0
E v19,v117
M v[84:87],a[84:87],a[52:55],v[84:87]
SA s89,s86,12288
buffer_load_dwordx4 v4, s[8:11], s26 offen offset:2048 sc1 lds
M v[84:87],a[88:91],a[56:59],v[84:87]
s_lshl_b32 s90, s20, 10
R a[112:115],v2,61440
R a[116:119],v2,62464
M v[84:87],a[92:95],a[60:63],v[84:87]
SA s90,s90,s34
E v20,v118
M v[80:83],a[92:95],a[28:31],v[80:83]
SA s90,s90,65536
E v21,v119
M v[80:83],a[88:91],a[24:27],v[80:83]
s_cmp_eq_u32 s20, 3
R a[120:123],v2,63488
R a[124:127],v2,64512
M v[80:83],a[84:87],a[20:23],v[80:83]
s_cselect_b64 s[74:75], s[16:17], s[82:83]
buffer_load_dwordx4 v4, s[8:11], s26 offen offset:3072 sc1 lds
M v[80:83],a[80:83],a[16:19],v[80:83]
s_cselect_b64 s[76:77], s[18:19], s[82:83]
AF v28,v23,v28
AF v28,v24,v28
M v[80:83],a[76:79],a[12:15],v[80:83]
s_cselect_b64 s[78:79], s[48:49], s[82:83]
E v22,v124
M v[80:83],a[72:75],a[8:11],v[80:83]
s_cselect_b64 s[80:81], s[50:51], s[82:83]
v_cndmask_b32 v88, v32, v8, s[74:75]
v_cndmask_b32 v89, v32, v8, s[76:77]
M v[80:83],a[68:71],a[4:7],v[80:83]
s_waitcnt vmcnt(17) lgkmcnt(0)
v_cndmask_b32 v90, v32, v8, s[78:79]
v_cndmask_b32 v91, v32, v8, s[80:81]
M v[80:83],a[64:67],a[0:3],v[80:83]
s_barrier
M v[92:95],a[96:99],a[32:35],v[36:39]
SA s26,s26,32768
R a[64:67],v7,32768
R a[68:71],v7,33792
M v[92:95],a[100:103],a[36:39],v[92:95]
SA m0,s28,131072
E v23,v125
M v[92:95],a[104:107],a[40:43],v[92:95]
buffer_load_dwordx4 v3, s[8:11], s26 offen offset:0 sc1 lds
M v[92:95],a[108:111],a[44:47],v[92:95]
R a[72:75],v7,34816
R a[76:79],v7,35840
M v[92:95],a[112:115],a[48:51],v[92:95]
C v59,v24,v25
AF v28,v25,v28
M v[92:95],a[116:119],a[52:55],v[92:95]
buffer_load_dwordx4 v3, s[8:11], s26 offen offset:1024 sc1 lds
M v[92:95],a[120:123],a[56:59],v[92:95]
R a[80:83],v7,36864
R a[84:87],v7,37888
M v[92:95],a[124:127],a[60:63],v[92:95]
E v24,v126
M v[88:91],a[124:127],a[28:31],v[88:91]
buffer_load_dwordx4 v3, s[8:11], s26 offen offset:2048 sc1 lds
M v[88:91],a[120:123],a[24:27],v[88:91]
R a[88:91],v7,38912
R a[92:95],v7,39936
M v[88:91],a[116:119],a[20:23],v[88:91]
E v25,v127
M v[88:91],a[112:115],a[16:19],v[88:91]
buffer_load_dwordx4 v3, s[8:11], s26 offen offset:3072 sc1 lds
M v[88:91],a[108:111],a[12:15],v[88:91]
AF v29,v18,v29
C v60,v18,v19
M v[88:91],a[104:107],a[8:11],v[88:91]
AF v29,v19,v29
AF v29,v20,v29
M v[88:91],a[100:103],a[4:7],v[88:91]
s_waitcnt lgkmcnt(0)
C v61,v20,v21
AF v29,v21,v29
M v[88:91],a[96:99],a[0:3],v[88:91]
AF v29,v22,v29
C v62,v22,v23
AF v29,v23,v29
AF v29,v24,v29
C v63,v24,v25
AF v29,v25,v29
v_max_f32 v10, v28, v29
v_cmp_lt_f32 vcc, s31, v10
s_nop 0
s_cbranch_vccnz L_std1
L_rtd1:
s_cmp_lt_u32 s42, 6
s_cbranch_scc1 L_d2h
M v[128:131],a[64:67],v[48:51],v[128:131]
R a[96:99],v7,40960
R a[100:103],v7,41984
M v[128:131],a[68:71],v[56:59],v[128:131]
SA m0,s28,135168
E v18,v64
M v[132:135],a[68:71],v[60:63],v[132:135]
buffer_load_dwordx4 v4, s[8:11], s26 offen offset:0 sc1 lds
M v[132:135],a[64:67],v[52:55],v[132:135]
R a[104:107],v7,43008
R a[108:111],v7,44032
M v[136:139],a[72:75],v[48:51],v[136:139]
s_cmp_gt_u32 s20, 3
E v19,v65
M v[136:139],a[76:79],v[56:59],v[136:139]
s_cselect_b64 s[82:83], -1, 0
AF v30,v28,v30
AF v31,v29,v31
M v[140:143],a[76:79],v[60:63],v[140:143]
s_cmp_eq_u32 s20, 3
R a[112:115],v7,45056
R a[116:119],v7,46080
M v[140:143],a[72:75],v[52:55],v[140:143]
s_cselect_b64 s[66:67], s[16:17], s[82:83]
buffer_load_dwordx4 v4, s[8:11], s26 offen offset:1024 sc1 lds
M v[144:147],a[80:83],v[48:51],v[144:147]
s_cselect_b64 s[68:69], s[18:19], s[82:83]
E v20,v66
M v[144:147],a[84:87],v[56:59],v[144:147]
s_cselect_b64 s[70:71], s[48:49], s[82:83]
R a[120:123],v7,47104
R a[124:127],v7,48128
M v[148:151],a[84:87],v[60:63],v[148:151]
s_cselect_b64 s[72:73], s[50:51], s[82:83]
v_cndmask_b32 v100, v36, v8, s[66:67]
v_cndmask_b32 v101, v36, v8, s[68:69]
M v[148:151],a[80:83],v[52:55],v[148:151]
buffer_load_dwordx4 v4, s[8:11], s26 offen offset:2048 sc1 lds
M v[152:155],a[88:91],v[48:51],v[152:155]
v_cndmask_b32 v102, v36, v8, s[70:71]
AF v26,v18,v19
M v[152:155],a[92:95],v[56:59],v[152:155]
E v21,v67
M v[156:159],a[92:95],v[60:63],v[156:159]
v_cndmask_b32 v103, v36, v8, s[72:73]
C v40,v18,v19
M v[156:159],a[88:91],v[52:55],v[156:159]
s_waitcnt lgkmcnt(0)
buffer_load_dwordx4 v4, s[8:11], s26 offen offset:3072 sc1 lds
M v[160:163],a[96:99],v[48:51],v[160:163]
s_cmp_gt_u32 s20, 2
R a[64:67],v7,49152
R a[68:71],v7,50176
M v[160:163],a[100:103],v[56:59],v[160:163]
s_cselect_b64 s[82:83], -1, 0
v_lshrrev_b32 v14, 7, v7
AF v26,v20,v26
M v[164:167],a[100:103],v[60:63],v[164:167]
s_cmp_eq_u32 s20, 2
v_mul_u32_u24 v14, 896, v14
C v41,v20,v21
M v[164:167],a[96:99],v[52:55],v[164:167]
s_cselect_b64 s[74:75], s[16:17], s[82:83]
R a[72:75],v7,51200
R a[76:79],v7,52224
M v[168:171],a[104:107],v[48:51],v[168:171]
s_cselect_b64 s[76:77], s[18:19], s[82:83]
v_lshrrev_b32 v15, 8, v7
AF v26,v21,v26
M v[168:171],a[108:111],v[56:59],v[168:171]
s_cselect_b64 s[78:79], s[48:49], s[82:83]
v_lshlrev_b32 v15, 5, v15
M v[172:175],a[108:111],v[60:63],v[172:175]
s_cselect_b64 s[80:81], s[50:51], s[82:83]
R a[80:83],v7,53248
R a[84:87],v7,54272
M v[172:175],a[104:107],v[52:55],v[172:175]
v_cndmask_b32 v108, v36, v8, s[74:75]
v_cndmask_b32 v109, v36, v8, s[76:77]
M v[176:179],a[112:115],v[48:51],v[176:179]
v_xor_b32 v15, v15, v7
M v[176:179],a[116:119],v[56:59],v[176:179]
R a[88:91],v7,55296
R a[92:95],v7,56320
M v[180:183],a[116:119],v[60:63],v[180:183]
v_and_b32 v15, 0x70, v15
v_cndmask_b32 v110, v36, v8, s[78:79]
M v[180:183],a[112:115],v[52:55],v[180:183]
v_add_u32 v0, v14, v15
M v[184:187],a[120:123],v[48:51],v[184:187]
s_mul_i32 s38, s20, 57344
v_cndmask_b32 v111, v36, v8, s[80:81]
M v[184:187],a[124:127],v[56:59],v[184:187]
s_cmp_gt_u32 s20, 1
E v22,v72
M v[188:191],a[124:127],v[60:63],v[188:191]
s_cselect_b64 s[82:83], -1, 0
E v23,v73
M v[188:191],a[120:123],v[52:55],v[188:191]
s_waitcnt lgkmcnt(0)
E v24,v74
M v[192:195],a[64:67],v[48:51],v[192:195]
SA m0,s28,98304
R a[96:99],v7,57344
R a[100:103],v7,58368
M v[192:195],a[68:71],v[56:59],v[192:195]
s_cmp_eq_u32 s20, 1
E v25,v75
M v[196:199],a[68:71],v[60:63],v[196:199]
s_cselect_b64 s[66:67], s[16:17], s[82:83]
E v18,v68
M v[196:199],a[64:67],v[52:55],v[196:199]
s_cselect_b64 s[68:69], s[18:19], s[82:83]
R a[104:107],v7,59392
R a[108:111],v7,60416
M v[200:203],a[72:75],v[48:51],v[200:203]
s_cselect_b64 s[70:71], s[48:49], s[82:83]
E v19,v69
M v[200:203],a[76:79],v[56:59],v[200:203]
s_cselect_b64 s[72:73], s[50:51], s[82:83]
v_cndmask_b32 v116, v36, v8, s[66:67]
v_cndmask_b32 v117, v36, v8, s[68:69]
M v[204:207],a[76:79],v[60:63],v[204:207]
SA s85,s38,0
R a[112:115],v7,61440
R a[116:119],v7,62464
M v[204:207],a[72:75],v[52:55],v[204:207]
buffer_load_dwordx4 v0, s[12:15], s85 offen offset:0 lds
M v[208:211],a[80:83],v[48:51],v[208:211]
SA s85,s38,6144
v_cndmask_b32 v118, v36, v8, s[70:71]
AF v26,v22,v26
M v[208:211],a[84:87],v[56:59],v[208:211]
R a[120:123],v7,63488
R a[124:127],v7,64512
M v[212:215],a[84:87],v[60:63],v[212:215]
buffer_load_dwordx4 v0, s[12:15], s85 offen offset:1024 lds
M v[212:215],a[80:83],v[52:55],v[212:215]
SA s85,s38,12288
v_cndmask_b32 v119, v36, v8, s[72:73]
C v42,v22,v23
M v[216:219],a[88:91],v[48:51],v[216:219]
s_cmp_gt_u32 s20, 0
E v20,v70
M v[216:219],a[92:95],v[56:59],v[216:219]
s_cselect_b64 s[82:83], -1, 0
buffer_load_dwordx4 v0, s[12:15], s85 offen offset:2048 lds
M v[220:223],a[92:95],v[60:63],v[220:223]
s_waitcnt vmcnt(20) lgkmcnt(0)
E v21,v71
M v[220:223],a[88:91],v[52:55],v[220:223]
s_barrier
M v[224:227],a[96:99],v[48:51],v[224:227]
SA s85,s38,18432
R a[64:67],v2,0
R a[68:71],v2,1024
M v[224:227],a[100:103],v[56:59],v[224:227]
s_cmp_eq_u32 s20, 0
buffer_load_dwordx4 v0, s[12:15], s85 offen offset:3072 lds
M v[228:231],a[100:103],v[60:63],v[228:231]
s_cselect_b64 s[74:75], s[16:17], s[82:83]
AF v26,v23,v26
AF v26,v24,v26
M v[228:231],a[96:99],v[52:55],v[228:231]
s_cselect_b64 s[76:77], s[18:19], s[82:83]
R a[72:75],v2,2048
R a[76:79],v2,3072
M v[232:235],a[104:107],v[48:51],v[232:235]
s_cselect_b64 s[78:79], s[48:49], s[82:83]
E v22,v76
M v[232:235],a[108:111],v[56:59],v[232:235]
s_cselect_b64 s[80:81], s[50:51], s[82:83]
v_cndmask_b32 v124, v36, v8, s[74:75]
v_cndmask_b32 v125, v36, v8, s[76:77]
M v[236:239],a[108:111],v[60:63],v[236:239]
SA m0,s28,102400
R a[80:83],v2,4096
R a[84:87],v2,5120
M v[236:239],a[104:107],v[52:55],v[236:239]
SA s85,s38,28672
buffer_load_dwordx4 v0, s[12:15], s85 offen offset:0 lds
M v[240:243],a[112:115],v[48:51],v[240:243]
SA s85,s38,34816
v_cndmask_b32 v126, v36, v8, s[78:79]
v_cndmask_b32 v127, v36, v8, s[80:81]
M v[240:243],a[116:119],v[56:59],v[240:243]
R a[88:91],v2,6144
R a[92:95],v2,7168
M v[244:247],a[116:119],v[60:63],v[244:247]
buffer_load_dwordx4 v0, s[12:15], s85 offen offset:1024 lds
M v[244:247],a[112:115],v[52:55],v[244:247]
SA s85,s38,40960
E v23,v77
M v[248:251],a[120:123],v[48:51],v[248:251]
buffer_load_dwordx4 v0, s[12:15], s85 offen offset:2048 lds
M v[248:251],a[124:127],v[56:59],v[248:251]
SA s85,s38,47104
C v43,v24,v25
AF v26,v25,v26
M v[252:255],a[124:127],v[60:63],v[252:255]
s_waitcnt lgkmcnt(0)
E v24,v78
M v[252:255],a[120:123],v[52:55],v[252:255]
buffer_load_dwordx4 v0, s[12:15], s85 offen offset:3072 lds
SA s38,s38,128
AF v27,v18,v19
C v44,v18,v19
AF v27,v20,v27
C v45,v20,v21
AF v27,v21,v27
E v25,v79
AF v27,v22,v27
C v46,v22,v23
AF v27,v23,v27
AF v27,v24,v27
C v47,v24,v25
AF v27,v25,v27
M v[100:103],a[64:67],a[32:35],v[100:103]
R a[96:99],v2,8192
R a[100:103],v2,9216
M v[100:103],a[68:71],a[36:39],v[100:103]
R a[104:107],v2,10240
R a[108:111],v2,11264
M v[100:103],a[72:75],a[40:43],v[100:103]
R a[112:115],v2,12288
R a[116:119],v2,13312
M v[100:103],a[76:79],a[44:47],v[100:103]
R a[120:123],v2,14336
R a[124:127],v2,15360
M v[100:103],a[80:83],a[48:51],v[100:103]
v_add_u32 v8, 0x20000, v7
M v[100:103],a[84:87],a[52:55],v[100:103]
SA m0,s28,32768
E v18,v80
M v[100:103],a[88:91],a[56:59],v[100:103]
SA s85,s38,0
buffer_load_dwordx4 v0, s[12:15], s85 offen offset:0 lds
M v[100:103],a[92:95],a[60:63],v[100:103]
s_waitcnt lgkmcnt(0)
E v19,v81
M v[108:111],a[96:99],a[32:35],v[108:111]
SA s85,s38,6144
R a[64:67],v2,16384
R a[68:71],v2,17408
M v[108:111],a[100:103],a[36:39],v[108:111]
R a[72:75],v2,18432
R a[76:79],v2,19456
M v[108:111],a[104:107],a[40:43],v[108:111]
R a[80:83],v2,20480
R a[84:87],v2,21504
M v[108:111],a[108:111],a[44:47],v[108:111]
R a[88:91],v2,22528
R a[92:95],v2,23552
M v[108:111],a[112:115],a[48:51],v[108:111]
buffer_load_dwordx4 v0, s[12:15], s85 offen offset:1024 lds
M v[108:111],a[116:119],a[52:55],v[108:111]
SA s85,s38,12288
E v20,v82
M v[108:111],a[120:123],a[56:59],v[108:111]
buffer_load_dwordx4 v0, s[12:15], s85 offen offset:2048 lds
M v[108:111],a[124:127],a[60:63],v[108:111]
s_waitcnt lgkmcnt(0)
E v21,v83
M v[116:119],a[64:67],a[32:35],v[116:119]
SA s85,s38,18432
R a[96:99],v2,24576
R a[100:103],v2,25600
M v[116:119],a[68:71],a[36:39],v[116:119]
R a[104:107],v2,26624
R a[108:111],v2,27648
M v[116:119],a[72:75],a[40:43],v[116:119]
R a[112:115],v2,28672
R a[116:119],v2,29696
M v[116:119],a[76:79],a[44:47],v[116:119]
R a[120:123],v2,30720
R a[124:127],v2,31744
M v[116:119],a[80:83],a[48:51],v[116:119]
buffer_load_dwordx4 v0, s[12:15], s85 offen offset:3072 lds
M v[116:119],a[84:87],a[52:55],v[116:119]
buffer_load_dword v6, off, s[8:11], s47 sc1
M v[116:119],a[88:91],a[56:59],v[116:119]
s_waitcnt vmcnt(21) lgkmcnt(0)
E v22,v88
M v[116:119],a[92:95],a[60:63],v[116:119]
s_barrier
M v[124:127],a[96:99],a[32:35],v[124:127]
R a[64:67],v7,0
R a[68:71],v7,1024
M v[124:127],a[100:103],a[36:39],v[124:127]
R a[72:75],v7,2048
R a[76:79],v7,3072
M v[124:127],a[104:107],a[40:43],v[124:127]
R a[80:83],v7,4096
R a[84:87],v7,5120
M v[124:127],a[108:111],a[44:47],v[124:127]
R a[88:91],v7,6144
R a[92:95],v7,7168
M v[124:127],a[112:115],a[48:51],v[124:127]
E v23,v89
M v[124:127],a[116:119],a[52:55],v[124:127]
E v24,v90
M v[124:127],a[120:123],a[56:59],v[124:127]
s_waitcnt lgkmcnt(0)
E v25,v91
M v[124:127],a[124:127],a[60:63],v[124:127]
AF v26,v18,v26
C v56,v18,v19
AF v26,v19,v26
AF v26,v20,v26
C v57,v20,v21
AF v26,v21,v26
AF v26,v22,v26
C v58,v22,v23
AF v26,v23,v26
E v18,v84
E v19,v85
AF v26,v24,v26
C v59,v24,v25
AF v26,v25,v26
E v20,v86
E v21,v87
AF v27,v18,v27
C v60,v18,v19
AF v27,v19,v27
E v22,v92
E v23,v93
AF v27,v20,v27
C v61,v20,v21
AF v27,v21,v27
E v24,v94
E v25,v95
AF v27,v22,v27
C v62,v22,v23
AF v27,v23,v27
AF v27,v24,v27
C v63,v24,v25
AF v27,v25,v27
v_max_f32 v10, v26, v27
v_cmp_lt_f32 vcc, s31, v10
s_nop 0
s_cbranch_vccnz L_std3n
L_rtd3n:
M v[128:131],a[64:67],v[40:43],v[128:131]
R a[96:99],v7,8192
R a[100:103],v7,9216
M v[128:131],a[68:71],v[56:59],v[128:131]
v_or_b32 v9, s35, v7
s_waitcnt vmcnt(0)
v_cmp_ne_u32 vcc, 1, v6
M v[132:135],a[68:71],v[60:63],v[132:135]
s_cbranch_vccnz L_fps
L_fpr:
E v18,v100
M v[132:135],a[64:67],v[44:47],v[132:135]
R a[104:107],v7,10240
R a[108:111],v7,11264
M v[136:139],a[72:75],v[40:43],v[136:139]
buffer_load_dwordx4 v[14:17], v9, s[8:11], s90 offen sc1
M v[136:139],a[76:79],v[56:59],v[136:139]
E v19,v101
M v[140:143],a[76:79],v[60:63],v[140:143]
R a[112:115],v7,12288
R a[116:119],v7,13312
M v[140:143],a[72:75],v[44:47],v[140:143]
buffer_load_dwordx4 a[160:163], v9, s[8:11], s88 offen offset:0 sc1
M v[144:147],a[80:83],v[40:43],v[144:147]
E v20,v102
M v[144:147],a[84:87],v[56:59],v[144:147]
R a[120:123],v7,14336
R a[124:127],v7,15360
M v[148:151],a[84:87],v[60:63],v[148:151]
buffer_load_dwordx4 a[128:131], v9, s[8:11], s86 offen offset:0 sc1
M v[148:151],a[80:83],v[44:47],v[148:151]
E v21,v103
M v[152:155],a[88:91],v[40:43],v[152:155]
AF v30,v26,v30
AF v31,v27,v31
M v[152:155],a[92:95],v[56:59],v[152:155]
buffer_load_dwordx4 a[164:167], v9, s[8:11], s88 offen offset:1024 sc1
M v[156:159],a[92:95],v[60:63],v[156:159]
AF v29,v18,v19
C v52,v18,v19
M v[156:159],a[88:91],v[44:47],v[156:159]
s_waitcnt lgkmcnt(0)
E v22,v108
M v[160:163],a[96:99],v[40:43],v[160:163]
R a[64:67],v7,16384
R a[68:71],v7,17408
M v[160:163],a[100:103],v[56:59],v[160:163]
buffer_load_dwordx4 a[132:135], v9, s[8:11], s86 offen offset:1024 sc1
M v[164:167],a[100:103],v[60:63],v[164:167]
E v23,v109
M v[164:167],a[96:99],v[44:47],v[164:167]
R a[72:75],v7,18432
R a[76:79],v7,19456
M v[168:171],a[104:107],v[40:43],v[168:171]
buffer_load_dwordx4 a[168:171], v9, s[8:11], s88 offen offset:2048 sc1
M v[168:171],a[108:111],v[56:59],v[168:171]
AF v29,v20,v29
C v53,v20,v21
M v[172:175],a[108:111],v[60:63],v[172:175]
R a[80:83],v7,20480
R a[84:87],v7,21504
M v[172:175],a[104:107],v[44:47],v[172:175]
buffer_load_dwordx4 a[136:139], v9, s[8:11], s86 offen offset:2048 sc1
M v[176:179],a[112:115],v[40:43],v[176:179]
E v24,v110
M v[176:179],a[116:119],v[56:59],v[176:179]
R a[88:91],v7,22528
R a[92:95],v7,23552
M v[180:183],a[116:119],v[60:63],v[180:183]
buffer_load_dwordx4 a[172:175], v9, s[8:11], s88 offen offset:3072 sc1
M v[180:183],a[112:115],v[44:47],v[180:183]
E v25,v111
M v[184:187],a[120:123],v[40:43],v[184:187]
AF v29,v21,v29
AF v29,v22,v29
M v[184:187],a[124:127],v[56:59],v[184:187]
buffer_load_dwordx4 a[140:143], v9, s[8:11], s86 offen offset:3072 sc1
M v[188:191],a[124:127],v[60:63],v[188:191]
E v18,v116
M v[188:191],a[120:123],v[44:47],v[188:191]
s_waitcnt lgkmcnt(0)
C v54,v22,v23
AF v29,v23,v29
M v[192:195],a[64:67],v[40:43],v[192:195]
R a[96:99],v7,24576
R a[100:103],v7,25600
M v[192:195],a[68:71],v[56:59],v[192:195]
buffer_load_dwordx4 a[176:179], v9, s[8:11], s89 offen offset:0 sc1
M v[196:199],a[68:71],v[60:63],v[196:199]
E v19,v117
M v[196:199],a[64:67],v[44:47],v[196:199]
R a[104:107],v7,26624
R a[108:111],v7,27648
M v[200:203],a[72:75],v[40:43],v[200:203]
buffer_load_dwordx4 a[144:147], v9, s[8:11], s87 offen offset:0 sc1
M v[200:203],a[76:79],v[56:59],v[200:203]
E v20,v118
M v[204:207],a[76:79],v[60:63],v[204:207]
R a[112:115],v7,28672
R a[116:119],v7,29696
M v[204:207],a[72:75],v[44:47],v[204:207]
buffer_load_dwordx4 a[180:183], v9, s[8:11], s89 offen offset:1024 sc1
M v[208:211],a[80:83],v[40:43],v[208:211]
AF v29,v24,v29
C v55,v24,v25
M v[208:211],a[84:87],v[56:59],v[208:211]
R a[120:123],v7,30720
R a[124:127],v7,31744
M v[212:215],a[84:87],v[60:63],v[212:215]
buffer_load_dwordx4 a[148:151], v9, s[8:11], s87 offen offset:1024 sc1
M v[212:215],a[80:83],v[44:47],v[212:215]
E v21,v119
M v[216:219],a[88:91],v[40:43],v[216:219]
AF v29,v25,v29
AF v29,v18,v29
M v[216:219],a[92:95],v[56:59],v[216:219]
buffer_load_dwordx4 a[184:187], v9, s[8:11], s89 offen offset:2048 sc1
M v[220:223],a[92:95],v[60:63],v[220:223]
s_waitcnt lgkmcnt(0)
E v22,v124
M v[220:223],a[88:91],v[44:47],v[220:223]
s_barrier
M v[224:227],a[96:99],v[40:43],v[224:227]
R a[64:67],v8,0
R a[68:71],v8,1024
M v[224:227],a[100:103],v[56:59],v[224:227]
buffer_load_dwordx4 a[152:155], v9, s[8:11], s87 offen offset:2048 sc1
M v[228:231],a[100:103],v[60:63],v[228:231]
E v23,v125
M v[228:231],a[96:99],v[44:47],v[228:231]
R a[72:75],v8,2048
R a[76:79],v8,3072
M v[232:235],a[104:107],v[40:43],v[232:235]
buffer_load_dwordx4 a[188:191], v9, s[8:11], s89 offen offset:3072 sc1
M v[232:235],a[108:111],v[56:59],v[232:235]
E v24,v126
M v[236:239],a[108:111],v[60:63],v[236:239]
R a[80:83],v8,4096
R a[84:87],v8,5120
M v[236:239],a[104:107],v[44:47],v[236:239]
buffer_load_dwordx4 a[156:159], v9, s[8:11], s87 offen offset:3072 sc1
M v[240:243],a[112:115],v[40:43],v[240:243]
E v25,v127
M v[240:243],a[116:119],v[56:59],v[240:243]
R a[88:91],v8,6144
R a[92:95],v8,7168
M v[244:247],a[116:119],v[60:63],v[244:247]
C v48,v18,v19
AF v29,v19,v29
M v[244:247],a[112:115],v[44:47],v[244:247]
AF v29,v20,v29
C v49,v20,v21
M v[248:251],a[120:123],v[40:43],v[248:251]
AF v29,v21,v29
AF v29,v22,v29
M v[248:251],a[124:127],v[56:59],v[248:251]
C v50,v22,v23
AF v29,v23,v29
M v[252:255],a[124:127],v[60:63],v[252:255]
s_waitcnt lgkmcnt(0)
AF v29,v24,v29
C v51,v24,v25
M v[252:255],a[120:123],v[44:47],v[252:255]
AF v29,v25,v29
v_cmp_lt_f32 vcc, s31, v29
s_nop 0
s_cbranch_vccnz L_std4n
L_rtd4n:
s_waitcnt vmcnt(16)
v_cmp_neq_f32 vcc, v32, v14
v_cmp_neq_f32 s[64:65], v36, v15
s_cmp_eq_u32 s35, 0
s_cselect_b64 s[66:67], -1, 0
s_or_b64 vcc, vcc, s[64:65]
s_and_b64 vcc, vcc, s[66:67]
s_cbranch_vccnz L_stc
L_rtc:
M v[132:135],a[64:67],v[52:55],v[132:135]
R a[96:99],v8,8192
R a[100:103],v8,9216
M v[132:135],a[68:71],v[48:51],v[132:135]
s_waitcnt vmcnt(12)
AF v30,v16,v30
AF v31,v17,v31
M v[132:135],a[246:249],a[160:163],v[132:135]
SA m0,s28,36864
AF v31,v29,v31
v_mov_b32 v10, v30
M v[128:131],a[246:249],a[128:131],v[128:131]
SA s85,s38,28672
R a[104:107],v8,10240
R a[108:111],v8,11264
M v[140:143],a[72:75],v[52:55],v[140:143]
buffer_load_dwordx4 v0, s[12:15], s85 offen offset:0 lds
M v[140:143],a[76:79],v[48:51],v[140:143]
SA s85,s38,34816
v_mov_b32 v11, v31
M v[140:143],a[244:247],a[160:163],v[140:143]
R a[112:115],v8,12288
R a[116:119],v8,13312
M v[136:139],a[244:247],a[128:131],v[136:139]
v_permlane16_swap_b32 v10, v30
M v[148:151],a[80:83],v[52:55],v[148:151]
v_permlane16_swap_b32 v11, v31
M v[148:151],a[84:87],v[48:51],v[148:151]
R a[120:123],v8,14336
R a[124:127],v8,15360
M v[148:151],a[246:249],a[164:167],v[148:151]
buffer_load_dwordx4 v0, s[12:15], s85 offen offset:1024 lds
M v[144:147],a[246:249],a[132:135],v[144:147]
SA s85,s38,40960
AF v30,v10,v30
AF v31,v11,v31
M v[156:159],a[88:91],v[52:55],v[156:159]
v_mov_b32 v10, v30
v_mov_b32 v11, v31
M v[156:159],a[92:95],v[48:51],v[156:159]
buffer_load_dwordx4 v0, s[12:15], s85 offen offset:2048 lds
M v[156:159],a[244:247],a[164:167],v[156:159]
s_waitcnt vmcnt(11)
v_permlane32_swap_b32 v10, v30
M v[152:155],a[244:247],a[132:135],v[152:155]
s_waitcnt lgkmcnt(0)
v_permlane32_swap_b32 v11, v31
M v[164:167],a[96:99],v[52:55],v[164:167]
SA s85,s38,47104
R a[64:67],v8,16384
R a[68:71],v8,17408
M v[164:167],a[100:103],v[48:51],v[164:167]
buffer_load_dwordx4 v0, s[12:15], s85 offen offset:3072 lds
M v[164:167],a[246:249],a[168:171],v[164:167]
SA s38,s38,128
C v132,v132,v133
C v133,v134,v135
M v[160:163],a[246:249],a[136:139],v[160:163]
SA m0,s28,65536
R a[72:75],v8,18432
R a[76:79],v8,19456
AF v30,v10,v30
AF v31,v11,v31
v_rcp_f32 v5, v30
v_rcp_f32 v6, v31
M v[172:175],a[104:107],v[52:55],v[172:175]
SA s85,s38,0
buffer_load_dwordx4 v0, s[12:15], s85 offen offset:0 lds
M v[172:175],a[108:111],v[48:51],v[172:175]
SA s85,s38,6144
C v134,v140,v141
C v135,v142,v143
M v[172:175],a[244:247],a[168:171],v[172:175]
R a[80:83],v8,20480
R a[84:87],v8,21504
M v[168:171],a[244:247],a[136:139],v[168:171]
buffer_load_dwordx4 v0, s[12:15], s85 offen offset:1024 lds
M v[180:183],a[112:115],v[52:55],v[180:183]
SA s85,s38,12288
C v128,v128,v129
C v129,v130,v131
M v[180:183],a[116:119],v[48:51],v[180:183]
R a[88:91],v8,22528
R a[92:95],v8,23552
M v[180:183],a[246:249],a[172:175],v[180:183]
buffer_load_dwordx4 v0, s[12:15], s85 offen offset:2048 lds
M v[176:179],a[246:249],a[140:143],v[176:179]
SA s85,s38,18432
C v130,v136,v137
C v131,v138,v139
M v[188:191],a[120:123],v[52:55],v[188:191]
C v148,v148,v149
C v149,v150,v151
M v[188:191],a[124:127],v[48:51],v[188:191]
buffer_load_dwordx4 v0, s[12:15], s85 offen offset:3072 lds
M v[188:191],a[244:247],a[172:175],v[188:191]
s_waitcnt vmcnt(12)
C v150,v156,v157
C v151,v158,v159
M v[184:187],a[244:247],a[140:143],v[184:187]
s_waitcnt lgkmcnt(0)
C v144,v144,v145
C v145,v146,v147
M v[196:199],a[64:67],v[52:55],v[196:199]
SA m0,s28,69632
R a[96:99],v8,24576
R a[100:103],v8,25600
M v[196:199],a[68:71],v[48:51],v[196:199]
SA s85,s38,28672
buffer_load_dwordx4 v0, s[12:15], s85 offen offset:0 lds
M v[196:199],a[246:249],a[176:179],v[196:199]
SA s85,s38,34816
C v146,v152,v153
C v147,v154,v155
M v[192:195],a[246:249],a[144:147],v[192:195]
R a[104:107],v8,26624
R a[108:111],v8,27648
M v[204:207],a[72:75],v[52:55],v[204:207]
buffer_load_dwordx4 v0, s[12:15], s85 offen offset:1024 lds
M v[204:207],a[76:79],v[48:51],v[204:207]
SA s85,s38,40960
v_lshrrev_b32 v16, 4, v7
v_lshrrev_b32 v14, 2, v16
M v[204:207],a[244:247],a[176:179],v[204:207]
R a[112:115],v8,28672
R a[116:119],v8,29696
M v[200:203],a[244:247],a[144:147],v[200:203]
buffer_load_dwordx4 v0, s[12:15], s85 offen offset:2048 lds
M v[212:215],a[80:83],v[52:55],v[212:215]
SA s85,s38,47104
v_lshlrev_b32 v14, 7, v14
v_and_b32 v15, 3, v16
M v[212:215],a[84:87],v[48:51],v[212:215]
R a[120:123],v8,30720
R a[124:127],v8,31744
M v[212:215],a[246:249],a[180:183],v[212:215]
buffer_load_dwordx4 v0, s[12:15], s85 offen offset:3072 lds
M v[208:211],a[246:249],a[148:151],v[208:211]
SA s38,s38,128
v_lshl_add_u32 v14, v15, 3, v14
C v164,v164,v165
M v[220:223],a[88:91],v[52:55],v[220:223]
C v165,v166,v167
C v166,v172,v173
M v[220:223],a[92:95],v[48:51],v[220:223]
s_waitcnt vmcnt(12)
C v167,v174,v175
C v160,v160,v161
M v[220:223],a[244:247],a[180:183],v[220:223]
s_waitcnt lgkmcnt(0)
v_bfe_u32 v15, v16, 3, 2
v_lshl_add_u32 v18, v15, 5, v14
v_xor_b32 v19, 32, v18
v_xor_b32 v20, 64, v18
v_xor_b32 v21, 0x60, v18
v_add_u32 v22, 0x10000, v18
v_add_u32 v23, 0x10000, v19
v_add_u32 v24, 0x10000, v20
v_add_u32 v25, 0x10000, v21
M v[216:219],a[244:247],a[148:151],v[216:219]
s_barrier
M v[228:231],a[96:99],v[52:55],v[228:231]
s_nop 0
T a[64:65],v22,32768
T a[66:67],v22,34816
M v[228:231],a[100:103],v[48:51],v[228:231]
T a[68:69],v22,36864
T a[70:71],v22,38912
M v[228:231],a[246:249],a[184:187],v[228:231]
C v161,v162,v163
C v162,v168,v169
M v[224:227],a[246:249],a[152:155],v[224:227]
T a[72:73],v22,40960
T a[74:75],v22,43008
M v[236:239],a[104:107],v[52:55],v[236:239]
T a[76:77],v22,45056
T a[78:79],v22,47104
M v[236:239],a[108:111],v[48:51],v[236:239]
C v163,v170,v171
C v180,v180,v181
M v[236:239],a[244:247],a[184:187],v[236:239]
T a[80:81],v22,49152
T a[82:83],v22,51200
M v[232:235],a[244:247],a[152:155],v[232:235]
T a[84:85],v22,53248
T a[86:87],v22,55296
M v[244:247],a[112:115],v[52:55],v[244:247]
C v181,v182,v183
C v182,v188,v189
M v[244:247],a[116:119],v[48:51],v[244:247]
T a[88:89],v22,57344
T a[90:91],v22,59392
M v[244:247],a[246:249],a[188:191],v[244:247]
T a[92:93],v22,61440
T a[94:95],v22,63488
M v[240:243],a[246:249],a[156:159],v[240:243]
C v183,v190,v191
C v176,v176,v177
M v[252:255],a[120:123],v[52:55],v[252:255]
C v177,v178,v179
C v178,v184,v185
M v[252:255],a[124:127],v[48:51],v[252:255]
C v179,v186,v187
C v196,v196,v197
M v[252:255],a[244:247],a[188:191],v[252:255]
s_waitcnt lgkmcnt(0)
C v197,v198,v199
C v198,v204,v205
M v[248:251],a[244:247],a[156:159],v[248:251]
C v199,v206,v207
C v192,v192,v193
C v193,v194,v195
C v194,v200,v201
C v195,v202,v203
C v212,v212,v213
C v213,v214,v215
C v214,v220,v221
C v215,v222,v223
C v208,v208,v209
C v209,v210,v211
C v210,v216,v217
C v211,v218,v219
C v228,v228,v229
C v229,v230,v231
C v230,v236,v237
C v231,v238,v239
C v224,v224,v225
C v225,v226,v227
C v226,v232,v233
C v227,v234,v235
C v244,v244,v245
C v245,v246,v247
C v246,v252,v253
C v247,v254,v255
C v240,v240,v241
C v241,v242,v243
C v242,v248,v249
C v243,v250,v251
M v[64:67],a[64:67],v[128:131],0
s_sub_u32 s64, 15, s42
T a[96:97],v23,32768
T a[98:99],v23,34816
M v[64:67],a[68:71],v[144:147],v[64:67]
s_min_u32 s64, s64, s42
T a[100:101],v23,36864
T a[102:103],v23,38912
M v[64:67],a[72:75],v[160:163],v[64:67]
s_mul_i32 s45, s64, 8704
M v[64:67],a[76:79],v[176:179],v[64:67]
s_lshl_b32 s64, s41, 2
T a[104:105],v23,40960
T a[106:107],v23,43008
M v[64:67],a[80:83],v[192:195],v[64:67]
SA s45,s45,s64
T a[108:109],v23,45056
T a[110:111],v23,47104
M v[64:67],a[84:87],v[208:211],v[64:67]
s_lshl_b32 s64, s20, 8
M v[64:67],a[88:91],v[224:227],v[64:67]
SA s45,s45,s64
T a[112:113],v23,49152
T a[114:115],v23,51200
M v[64:67],a[92:95],v[240:243],v[64:67]
SA s45,s45,104992768
T a[116:117],v23,53248
T a[118:119],v23,55296
M v[68:71],a[92:95],v[244:247],0
s_mov_b32 s64, 1024
M v[68:71],a[88:91],v[228:231],v[68:71]
s_mov_b32 s66, 4096
T a[120:121],v23,57344
T a[122:123],v23,59392
M v[68:71],a[84:87],v[212:215],v[68:71]
s_cmp_lt_u32 s42, 8
T a[124:125],v23,61440
T a[126:127],v23,63488
M v[68:71],a[80:83],v[196:199],v[68:71]
s_cselect_b32 s64, 4352, s64
M v[68:71],a[76:79],v[180:183],v[68:71]
s_cselect_b32 s65, 0, 64
M v[68:71],a[72:75],v[164:167],v[68:71]
s_cselect_b32 s66, 536870912, s66
M v[68:71],a[68:71],v[148:151],v[68:71]
SA s3,s45,s64
M v[68:71],a[64:67],v[132:135],v[68:71]
s_waitcnt lgkmcnt(0)
M v[72:75],a[96:99],v[128:131],0
SA s45,s45,s65
T a[64:65],v24,32768
T a[66:67],v24,34816
M v[72:75],a[100:103],v[144:147],v[72:75]
SA m0,s28,0
T a[68:69],v24,36864
T a[70:71],v24,38912
M v[72:75],a[104:107],v[160:163],v[72:75]
SA s85,s38,0
buffer_load_dwordx4 v0, s[12:15], s85 offen offset:0 lds
M v[72:75],a[108:111],v[176:179],v[72:75]
SA s85,s38,6144
T a[72:73],v24,40960
T a[74:75],v24,43008
M v[72:75],a[112:115],v[192:195],v[72:75]
SA s29,s33,0
T a[76:77],v24,45056
T a[78:79],v24,47104
M v[72:75],a[116:119],v[208:211],v[72:75]
SA s30,s33,14336
buffer_load_dwordx4 v0, s[12:15], s85 offen offset:1024 lds
M v[72:75],a[120:123],v[224:227],v[72:75]
SA s85,s38,12288
T a[80:81],v24,49152
T a[82:83],v24,51200
M v[72:75],a[124:127],v[240:243],v[72:75]
T a[84:85],v24,53248
T a[86:87],v24,55296
M v[76:79],a[124:127],v[244:247],0
buffer_load_dwordx4 v0, s[12:15], s85 offen offset:2048 lds
M v[76:79],a[120:123],v[228:231],v[76:79]
SA s85,s38,18432
T a[88:89],v24,57344
T a[90:91],v24,59392
M v[76:79],a[116:119],v[212:215],v[76:79]
T a[92:93],v24,61440
T a[94:95],v24,63488
M v[76:79],a[112:115],v[196:199],v[76:79]
buffer_load_dwordx4 v0, s[12:15], s85 offen offset:3072 lds
M v[76:79],a[108:111],v[180:183],v[76:79]
SA m0,s28,4096
v_lshrrev_b32 v17, 5, v7
v_min_u32 v15, 1, v17
M v[76:79],a[104:107],v[164:167],v[76:79]
SA s85,s38,28672
buffer_load_dwordx4 v0, s[12:15], s85 offen offset:0 lds
M v[76:79],a[100:103],v[148:151],v[76:79]
SA s85,s38,34816
v_lshlrev_b32 v14, 3, v7
v_lshl_or_b32 v16, v15, 29, v14
M v[76:79],a[96:99],v[132:135],v[76:79]
s_waitcnt lgkmcnt(0)
buffer_load_dwordx4 v0, s[12:15], s85 offen offset:1024 lds
M v[80:83],a[64:67],v[128:131],0
SA s85,s38,40960
T a[96:97],v25,32768
T a[98:99],v25,34816
M v[80:83],a[68:71],v[144:147],v[80:83]
T a[100:101],v25,36864
T a[102:103],v25,38912
M v[80:83],a[72:75],v[160:163],v[80:83]
buffer_load_dwordx4 v0, s[12:15], s85 offen offset:2048 lds
M v[80:83],a[76:79],v[176:179],v[80:83]
SA s85,s38,47104
T a[104:105],v25,40960
T a[106:107],v25,43008
M v[80:83],a[80:83],v[192:195],v[80:83]
T a[108:109],v25,45056
T a[110:111],v25,47104
M v[80:83],a[84:87],v[208:211],v[80:83]
buffer_load_dwordx4 v0, s[12:15], s85 offen offset:3072 lds
M v[80:83],a[88:91],v[224:227],v[80:83]
SA s38,s38,128
T a[112:113],v25,49152
T a[114:115],v25,51200
M v[80:83],a[92:95],v[240:243],v[80:83]
SA m0,s28,131072
T a[116:117],v25,53248
T a[118:119],v25,55296
M v[84:87],a[92:95],v[244:247],0
SA s85,s38,0
buffer_load_dwordx4 v0, s[12:15], s85 offen offset:0 lds
M v[84:87],a[88:91],v[228:231],v[84:87]
SA s85,s38,6144
T a[120:121],v25,57344
T a[122:123],v25,59392
M v[84:87],a[84:87],v[212:215],v[84:87]
T a[124:125],v25,61440
T a[126:127],v25,63488
M v[84:87],a[80:83],v[196:199],v[84:87]
buffer_load_dwordx4 v0, s[12:15], s85 offen offset:1024 lds
M v[84:87],a[76:79],v[180:183],v[84:87]
SA s85,s38,12288
v_cmp_eq_u32 vcc, 1, v17
v_add_u32 v14, s66, v14
M v[84:87],a[72:75],v[164:167],v[84:87]
buffer_load_dwordx4 v0, s[12:15], s85 offen offset:2048 lds
M v[84:87],a[68:71],v[148:151],v[84:87]
s_waitcnt vmcnt(19) lgkmcnt(0)
v_mov_b32 v15, 1
v_cndmask_b32 v17, v16, v14, vcc
M v[84:87],a[64:67],v[132:135],v[84:87]
s_barrier
M v[88:91],a[96:99],v[128:131],0
SA s85,s38,18432
T a[64:65],v18,32768
T a[66:67],v18,34816
M v[88:91],a[100:103],v[144:147],v[88:91]
T a[68:69],v18,36864
T a[70:71],v18,38912
M v[88:91],a[104:107],v[160:163],v[88:91]
buffer_load_dwordx4 v0, s[12:15], s85 offen offset:3072 lds
M v[88:91],a[108:111],v[176:179],v[88:91]
SA m0,s28,135168
T a[72:73],v18,40960
T a[74:75],v18,43008
M v[88:91],a[112:115],v[192:195],v[88:91]
SA s85,s38,28672
T a[76:77],v18,45056
T a[78:79],v18,47104
M v[88:91],a[116:119],v[208:211],v[88:91]
buffer_load_dwordx4 v0, s[12:15], s85 offen offset:0 lds
M v[88:91],a[120:123],v[224:227],v[88:91]
SA s85,s38,34816
T a[80:81],v18,49152
T a[82:83],v18,51200
M v[88:91],a[124:127],v[240:243],v[88:91]
T a[84:85],v18,53248
T a[86:87],v18,55296
M v[92:95],a[124:127],v[244:247],0
buffer_load_dwordx4 v0, s[12:15], s85 offen offset:1024 lds
M v[92:95],a[120:123],v[228:231],v[92:95]
SA s85,s38,40960
T a[88:89],v18,57344
T a[90:91],v18,59392
M v[92:95],a[116:119],v[212:215],v[92:95]
T a[92:93],v18,61440
T a[94:95],v18,63488
M v[92:95],a[112:115],v[196:199],v[92:95]
buffer_load_dwordx4 v0, s[12:15], s85 offen offset:2048 lds
M v[92:95],a[108:111],v[180:183],v[92:95]
SA s85,s38,47104
v_add_u32 v40, 0x20000, v18
v_add_u32 v41, 0x20000, v19
M v[92:95],a[104:107],v[164:167],v[92:95]
buffer_load_dwordx4 v0, s[12:15], s85 offen offset:3072 lds
M v[92:95],a[100:103],v[148:151],v[92:95]
s_waitcnt lgkmcnt(0)
v_add_u32 v42, 0x20000, v20
v_add_u32 v43, 0x20000, v21
M v[92:95],a[96:99],v[132:135],v[92:95]
SA s38,s38,128
MF v64,v5,v64
MF v65,v5,v65
MF v66,v5,v66
MF v67,v5,v67
MF v72,v5,v72
MF v73,v5,v73
MF v74,v5,v74
MF v75,v5,v75
C v64,v64,v65
C v65,v66,v67
C v66,v72,v73
C v67,v74,v75
buffer_store_dwordx4 v[64:67], v7, s[8:11], s29 offen offset:0 sc1
MF v68,v6,v68
MF v69,v6,v69
MF v70,v6,v70
MF v71,v6,v71
MF v76,v6,v76
MF v77,v6,v77
MF v78,v6,v78
MF v79,v6,v79
C v68,v68,v69
C v69,v70,v71
C v70,v76,v77
C v71,v78,v79
buffer_store_dwordx4 v[68:71], v7, s[8:11], s30 offen offset:0 sc1
M v[96:99],a[64:67],v[128:131],0
s_nop 0
T a[96:97],v19,32768
T a[98:99],v19,34816
M v[96:99],a[68:71],v[144:147],v[96:99]
SA m0,s28,98304
T a[100:101],v19,36864
T a[102:103],v19,38912
M v[96:99],a[72:75],v[160:163],v[96:99]
SA s85,s38,0
buffer_load_dwordx4 v0, s[12:15], s85 offen offset:0 lds
M v[96:99],a[76:79],v[176:179],v[96:99]
s_nop 0
T a[104:105],v19,40960
T a[106:107],v19,43008
M v[96:99],a[80:83],v[192:195],v[96:99]
T a[108:109],v19,45056
T a[110:111],v19,47104
M v[96:99],a[84:87],v[208:211],v[96:99]
SA s85,s38,6144
MF v80,v5,v80
MF v81,v5,v81
M v[96:99],a[88:91],v[224:227],v[96:99]
T a[112:113],v19,49152
T a[114:115],v19,51200
M v[96:99],a[92:95],v[240:243],v[96:99]
T a[116:117],v19,53248
T a[118:119],v19,55296
M v[100:103],a[92:95],v[244:247],0
buffer_load_dwordx4 v0, s[12:15], s85 offen offset:1024 lds
M v[100:103],a[88:91],v[228:231],v[100:103]
s_nop 0
T a[120:121],v19,57344
T a[122:123],v19,59392
M v[100:103],a[84:87],v[212:215],v[100:103]
T a[124:125],v19,61440
T a[126:127],v19,63488
M v[100:103],a[80:83],v[196:199],v[100:103]
SA s85,s38,12288
MF v82,v5,v82
MF v83,v5,v83
M v[100:103],a[76:79],v[180:183],v[100:103]
buffer_load_dwordx4 v0, s[12:15], s85 offen offset:2048 lds
M v[100:103],a[72:75],v[164:167],v[100:103]
MF v88,v5,v88
MF v89,v5,v89
M v[100:103],a[68:71],v[148:151],v[100:103]
MF v90,v5,v90
MF v91,v5,v91
M v[100:103],a[64:67],v[132:135],v[100:103]
s_waitcnt lgkmcnt(0)
C v80,v80,v81
C v81,v82,v83
M v[104:107],a[96:99],v[128:131],0
SA s85,s38,18432
T a[64:65],v20,32768
T a[66:67],v20,34816
M v[104:107],a[100:103],v[144:147],v[104:107]
T a[68:69],v20,36864
T a[70:71],v20,38912
M v[104:107],a[104:107],v[160:163],v[104:107]
buffer_load_dwordx4 v0, s[12:15], s85 offen offset:3072 lds
M v[104:107],a[108:111],v[176:179],v[104:107]
s_nop 0
T a[72:73],v20,40960
T a[74:75],v20,43008
M v[104:107],a[112:115],v[192:195],v[104:107]
T a[76:77],v20,45056
T a[78:79],v20,47104
M v[104:107],a[116:119],v[208:211],v[104:107]
SA m0,s28,102400
C v82,v88,v89
C v83,v90,v91
M v[104:107],a[120:123],v[224:227],v[104:107]
SA s85,s38,28672
T a[80:81],v20,49152
T a[82:83],v20,51200
M v[104:107],a[124:127],v[240:243],v[104:107]
T a[84:85],v20,53248
T a[86:87],v20,55296
M v[108:111],a[124:127],v[244:247],0
buffer_store_dwordx4 v[80:83], v7, s[8:11], s29 offen offset:1024 sc1
M v[108:111],a[120:123],v[228:231],v[108:111]
s_nop 0
T a[88:89],v20,57344
T a[90:91],v20,59392
M v[108:111],a[116:119],v[212:215],v[108:111]
T a[92:93],v20,61440
T a[94:95],v20,63488
M v[108:111],a[112:115],v[196:199],v[108:111]
buffer_load_dwordx4 v0, s[12:15], s85 offen offset:0 lds
M v[108:111],a[108:111],v[180:183],v[108:111]
SA s85,s38,34816
MF v84,v6,v84
MF v85,v6,v85
M v[108:111],a[104:107],v[164:167],v[108:111]
MF v86,v6,v86
MF v87,v6,v87
M v[108:111],a[100:103],v[148:151],v[108:111]
buffer_load_dwordx4 v0, s[12:15], s85 offen offset:1024 lds
M v[108:111],a[96:99],v[132:135],v[108:111]
s_waitcnt lgkmcnt(0)
MF v92,v6,v92
MF v93,v6,v93
M v[112:115],a[64:67],v[128:131],0
T a[96:97],v21,32768
T a[98:99],v21,34816
M v[112:115],a[68:71],v[144:147],v[112:115]
SA s85,s38,40960
T a[100:101],v21,36864
T a[102:103],v21,38912
M v[112:115],a[72:75],v[160:163],v[112:115]
buffer_load_dwordx4 v0, s[12:15], s85 offen offset:2048 lds
M v[112:115],a[76:79],v[176:179],v[112:115]
s_nop 0
T a[104:105],v21,40960
T a[106:107],v21,43008
M v[112:115],a[80:83],v[192:195],v[112:115]
T a[108:109],v21,45056
T a[110:111],v21,47104
M v[112:115],a[84:87],v[208:211],v[112:115]
MF v94,v6,v94
MF v95,v6,v95
M v[112:115],a[88:91],v[224:227],v[112:115]
SA s85,s38,47104
T a[112:113],v21,49152
T a[114:115],v21,51200
M v[112:115],a[92:95],v[240:243],v[112:115]
T a[116:117],v21,53248
T a[118:119],v21,55296
M v[116:119],a[92:95],v[244:247],0
buffer_load_dwordx4 v0, s[12:15], s85 offen offset:3072 lds
M v[116:119],a[88:91],v[228:231],v[116:119]
s_nop 0
T a[120:121],v21,57344
T a[122:123],v21,59392
M v[116:119],a[84:87],v[212:215],v[116:119]
T a[124:125],v21,61440
T a[126:127],v21,63488
M v[116:119],a[80:83],v[196:199],v[116:119]
C v84,v84,v85
C v85,v86,v87
M v[116:119],a[76:79],v[180:183],v[116:119]
C v86,v92,v93
C v87,v94,v95
M v[116:119],a[72:75],v[164:167],v[116:119]
SA s38,s38,128
buffer_store_dwordx4 v[84:87], v7, s[8:11], s30 offen offset:1024 sc1
M v[116:119],a[68:71],v[148:151],v[116:119]
s_waitcnt vmcnt(28) lgkmcnt(0)
M v[116:119],a[64:67],v[132:135],v[116:119]
s_barrier
M v[120:123],a[96:99],v[128:131],0
SA s29,s33,2048
T a[64:65],v22,0
T a[66:67],v22,2048
M v[120:123],a[100:103],v[144:147],v[120:123]
SA s30,s33,16384
T a[68:69],v22,4096
T a[70:71],v22,6144
M v[120:123],a[104:107],v[160:163],v[120:123]
MF v96,v5,v96
MF v97,v5,v97
M v[120:123],a[108:111],v[176:179],v[120:123]
T a[72:73],v22,8192
T a[74:75],v22,10240
M v[120:123],a[112:115],v[192:195],v[120:123]
T a[76:77],v22,12288
T a[78:79],v22,14336
M v[120:123],a[116:119],v[208:211],v[120:123]
MF v98,v5,v98
MF v99,v5,v99
M v[120:123],a[120:123],v[224:227],v[120:123]
T a[80:81],v22,16384
T a[82:83],v22,18432
M v[120:123],a[124:127],v[240:243],v[120:123]
T a[84:85],v22,20480
T a[86:87],v22,22528
M v[124:127],a[124:127],v[244:247],0
MF v104,v5,v104
MF v105,v5,v105
M v[124:127],a[120:123],v[228:231],v[124:127]
T a[88:89],v22,24576
T a[90:91],v22,26624
M v[124:127],a[116:119],v[212:215],v[124:127]
T a[92:93],v22,28672
T a[94:95],v22,30720
M v[124:127],a[112:115],v[196:199],v[124:127]
MF v106,v5,v106
MF v107,v5,v107
M v[124:127],a[108:111],v[180:183],v[124:127]
C v96,v96,v97
C v97,v98,v99
M v[124:127],a[104:107],v[164:167],v[124:127]
C v98,v104,v105
C v99,v106,v107
M v[124:127],a[100:103],v[148:151],v[124:127]
s_waitcnt lgkmcnt(0)
buffer_store_dwordx4 v[96:99], v7, s[8:11], s29 offen offset:0 sc1
M v[124:127],a[96:99],v[132:135],v[124:127]
MF v100,v6,v100
MF v101,v6,v101
MF v102,v6,v102
MF v103,v6,v103
MF v108,v6,v108
MF v109,v6,v109
MF v110,v6,v110
MF v111,v6,v111
C v100,v100,v101
C v101,v102,v103
C v102,v108,v109
C v103,v110,v111
buffer_store_dwordx4 v[100:103], v7, s[8:11], s30 offen offset:0 sc1
M v[64:67],a[64:67],v[128:131],0
s_nop 0
T a[96:97],v23,0
T a[98:99],v23,2048
M v[64:67],a[68:71],v[144:147],v[64:67]
SA m0,s28,32768
T a[100:101],v23,4096
T a[102:103],v23,6144
M v[64:67],a[72:75],v[160:163],v[64:67]
SA s85,s38,0
buffer_load_dwordx4 v0, s[12:15], s85 offen offset:0 lds
M v[64:67],a[76:79],v[176:179],v[64:67]
s_nop 0
T a[104:105],v23,8192
T a[106:107],v23,10240
M v[64:67],a[80:83],v[192:195],v[64:67]
T a[108:109],v23,12288
T a[110:111],v23,14336
M v[64:67],a[84:87],v[208:211],v[64:67]
SA s85,s38,6144
MF v112,v5,v112
MF v113,v5,v113
M v[64:67],a[88:91],v[224:227],v[64:67]
T a[112:113],v23,16384
T a[114:115],v23,18432
M v[64:67],a[92:95],v[240:243],v[64:67]
T a[116:117],v23,20480
T a[118:119],v23,22528
M v[68:71],a[92:95],v[244:247],0
buffer_load_dwordx4 v0, s[12:15], s85 offen offset:1024 lds
M v[68:71],a[88:91],v[228:231],v[68:71]
s_nop 0
T a[120:121],v23,24576
T a[122:123],v23,26624
M v[68:71],a[84:87],v[212:215],v[68:71]
T a[124:125],v23,28672
T a[126:127],v23,30720
M v[68:71],a[80:83],v[196:199],v[68:71]
SA s85,s38,12288
MF v114,v5,v114
MF v115,v5,v115
M v[68:71],a[76:79],v[180:183],v[68:71]
buffer_load_dwordx4 v0, s[12:15], s85 offen offset:2048 lds
M v[68:71],a[72:75],v[164:167],v[68:71]
MF v120,v5,v120
MF v121,v5,v121
M v[68:71],a[68:71],v[148:151],v[68:71]
MF v122,v5,v122
MF v123,v5,v123
M v[68:71],a[64:67],v[132:135],v[68:71]
s_waitcnt lgkmcnt(0)
C v112,v112,v113
C v113,v114,v115
M v[72:75],a[96:99],v[128:131],0
SA s85,s38,18432
T a[64:65],v24,0
T a[66:67],v24,2048
M v[72:75],a[100:103],v[144:147],v[72:75]
T a[68:69],v24,4096
T a[70:71],v24,6144
M v[72:75],a[104:107],v[160:163],v[72:75]
buffer_load_dwordx4 v0, s[12:15], s85 offen offset:3072 lds
M v[72:75],a[108:111],v[176:179],v[72:75]
s_nop 0
T a[72:73],v24,8192
T a[74:75],v24,10240
M v[72:75],a[112:115],v[192:195],v[72:75]
T a[76:77],v24,12288
T a[78:79],v24,14336
M v[72:75],a[116:119],v[208:211],v[72:75]
SA m0,s28,36864
C v114,v120,v121
C v115,v122,v123
M v[72:75],a[120:123],v[224:227],v[72:75]
SA s85,s38,28672
T a[80:81],v24,16384
T a[82:83],v24,18432
M v[72:75],a[124:127],v[240:243],v[72:75]
T a[84:85],v24,20480
T a[86:87],v24,22528
M v[76:79],a[124:127],v[244:247],0
buffer_store_dwordx4 v[112:115], v7, s[8:11], s29 offen offset:1024 sc1
M v[76:79],a[120:123],v[228:231],v[76:79]
s_nop 0
T a[88:89],v24,24576
T a[90:91],v24,26624
M v[76:79],a[116:119],v[212:215],v[76:79]
T a[92:93],v24,28672
T a[94:95],v24,30720
M v[76:79],a[112:115],v[196:199],v[76:79]
buffer_load_dwordx4 v0, s[12:15], s85 offen offset:0 lds
M v[76:79],a[108:111],v[180:183],v[76:79]
SA s85,s38,34816
MF v116,v6,v116
MF v117,v6,v117
M v[76:79],a[104:107],v[164:167],v[76:79]
MF v118,v6,v118
MF v119,v6,v119
M v[76:79],a[100:103],v[148:151],v[76:79]
buffer_load_dwordx4 v0, s[12:15], s85 offen offset:1024 lds
M v[76:79],a[96:99],v[132:135],v[76:79]
s_waitcnt lgkmcnt(0)
MF v124,v6,v124
MF v125,v6,v125
M v[80:83],a[64:67],v[128:131],0
T a[96:97],v25,0
T a[98:99],v25,2048
M v[80:83],a[68:71],v[144:147],v[80:83]
SA s85,s38,40960
T a[100:101],v25,4096
T a[102:103],v25,6144
M v[80:83],a[72:75],v[160:163],v[80:83]
buffer_load_dwordx4 v0, s[12:15], s85 offen offset:2048 lds
M v[80:83],a[76:79],v[176:179],v[80:83]
s_nop 0
T a[104:105],v25,8192
T a[106:107],v25,10240
M v[80:83],a[80:83],v[192:195],v[80:83]
T a[108:109],v25,12288
T a[110:111],v25,14336
M v[80:83],a[84:87],v[208:211],v[80:83]
MF v126,v6,v126
MF v127,v6,v127
M v[80:83],a[88:91],v[224:227],v[80:83]
SA s85,s38,47104
T a[112:113],v25,16384
T a[114:115],v25,18432
M v[80:83],a[92:95],v[240:243],v[80:83]
T a[116:117],v25,20480
T a[118:119],v25,22528
M v[84:87],a[92:95],v[244:247],0
buffer_load_dwordx4 v0, s[12:15], s85 offen offset:3072 lds
M v[84:87],a[88:91],v[228:231],v[84:87]
s_nop 0
T a[120:121],v25,24576
T a[122:123],v25,26624
M v[84:87],a[84:87],v[212:215],v[84:87]
T a[124:125],v25,28672
T a[126:127],v25,30720
M v[84:87],a[80:83],v[196:199],v[84:87]
C v116,v116,v117
C v117,v118,v119
M v[84:87],a[76:79],v[180:183],v[84:87]
C v118,v124,v125
C v119,v126,v127
M v[84:87],a[72:75],v[164:167],v[84:87]
SA s38,s38,128
buffer_store_dwordx4 v[116:119], v7, s[8:11], s30 offen offset:1024 sc1
M v[84:87],a[68:71],v[148:151],v[84:87]
s_waitcnt vmcnt(32) lgkmcnt(0)
M v[84:87],a[64:67],v[132:135],v[84:87]
s_barrier
M v[88:91],a[96:99],v[128:131],0
SA s29,s33,4096
T a[64:65],v18,0
T a[66:67],v18,2048
M v[88:91],a[100:103],v[144:147],v[88:91]
SA s30,s33,18432
T a[68:69],v18,4096
T a[70:71],v18,6144
M v[88:91],a[104:107],v[160:163],v[88:91]
MF v64,v5,v64
MF v65,v5,v65
M v[88:91],a[108:111],v[176:179],v[88:91]
T a[72:73],v18,8192
T a[74:75],v18,10240
M v[88:91],a[112:115],v[192:195],v[88:91]
T a[76:77],v18,12288
T a[78:79],v18,14336
M v[88:91],a[116:119],v[208:211],v[88:91]
MF v66,v5,v66
MF v67,v5,v67
M v[88:91],a[120:123],v[224:227],v[88:91]
T a[80:81],v18,16384
T a[82:83],v18,18432
M v[88:91],a[124:127],v[240:243],v[88:91]
T a[84:85],v18,20480
T a[86:87],v18,22528
M v[92:95],a[124:127],v[244:247],0
MF v72,v5,v72
MF v73,v5,v73
M v[92:95],a[120:123],v[228:231],v[92:95]
T a[88:89],v18,24576
T a[90:91],v18,26624
M v[92:95],a[116:119],v[212:215],v[92:95]
T a[92:93],v18,28672
T a[94:95],v18,30720
M v[92:95],a[112:115],v[196:199],v[92:95]
MF v74,v5,v74
MF v75,v5,v75
M v[92:95],a[108:111],v[180:183],v[92:95]
C v64,v64,v65
C v65,v66,v67
M v[92:95],a[104:107],v[164:167],v[92:95]
C v66,v72,v73
C v67,v74,v75
M v[92:95],a[100:103],v[148:151],v[92:95]
s_waitcnt lgkmcnt(0)
buffer_store_dwordx4 v[64:67], v7, s[8:11], s29 offen offset:0 sc1
M v[92:95],a[96:99],v[132:135],v[92:95]
MF v68,v6,v68
MF v69,v6,v69
MF v70,v6,v70
MF v71,v6,v71
MF v76,v6,v76
MF v77,v6,v77
MF v78,v6,v78
MF v79,v6,v79
C v68,v68,v69
C v69,v70,v71
C v70,v76,v77
C v71,v78,v79
buffer_store_dwordx4 v[68:71], v7, s[8:11], s30 offen offset:0 sc1
M v[96:99],a[64:67],v[128:131],0
s_nop 0
T a[96:97],v19,0
T a[98:99],v19,2048
M v[96:99],a[68:71],v[144:147],v[96:99]
T a[100:101],v19,4096
T a[102:103],v19,6144
M v[96:99],a[72:75],v[160:163],v[96:99]
MF v80,v5,v80
MF v81,v5,v81
M v[96:99],a[76:79],v[176:179],v[96:99]
T a[104:105],v19,8192
T a[106:107],v19,10240
M v[96:99],a[80:83],v[192:195],v[96:99]
T a[108:109],v19,12288
T a[110:111],v19,14336
M v[96:99],a[84:87],v[208:211],v[96:99]
MF v82,v5,v82
MF v83,v5,v83
M v[96:99],a[88:91],v[224:227],v[96:99]
T a[112:113],v19,16384
T a[114:115],v19,18432
M v[96:99],a[92:95],v[240:243],v[96:99]
T a[116:117],v19,20480
T a[118:119],v19,22528
M v[100:103],a[92:95],v[244:247],0
MF v88,v5,v88
MF v89,v5,v89
M v[100:103],a[88:91],v[228:231],v[100:103]
T a[120:121],v19,24576
T a[122:123],v19,26624
M v[100:103],a[84:87],v[212:215],v[100:103]
T a[124:125],v19,28672
T a[126:127],v19,30720
M v[100:103],a[80:83],v[196:199],v[100:103]
MF v90,v5,v90
MF v91,v5,v91
M v[100:103],a[76:79],v[180:183],v[100:103]
C v80,v80,v81
C v81,v82,v83
M v[100:103],a[72:75],v[164:167],v[100:103]
C v82,v88,v89
C v83,v90,v91
M v[100:103],a[68:71],v[148:151],v[100:103]
buffer_store_dwordx4 v[80:83], v7, s[8:11], s29 offen offset:1024 sc1
M v[100:103],a[64:67],v[132:135],v[100:103]
s_waitcnt lgkmcnt(0)
MF v84,v6,v84
MF v85,v6,v85
M v[104:107],a[96:99],v[128:131],0
T a[64:65],v20,0
T a[66:67],v20,2048
M v[104:107],a[100:103],v[144:147],v[104:107]
T a[68:69],v20,4096
T a[70:71],v20,6144
M v[104:107],a[104:107],v[160:163],v[104:107]
MF v86,v6,v86
MF v87,v6,v87
M v[104:107],a[108:111],v[176:179],v[104:107]
T a[72:73],v20,8192
T a[74:75],v20,10240
M v[104:107],a[112:115],v[192:195],v[104:107]
T a[76:77],v20,12288
T a[78:79],v20,14336
M v[104:107],a[116:119],v[208:211],v[104:107]
MF v92,v6,v92
MF v93,v6,v93
M v[104:107],a[120:123],v[224:227],v[104:107]
T a[80:81],v20,16384
T a[82:83],v20,18432
M v[104:107],a[124:127],v[240:243],v[104:107]
T a[84:85],v20,20480
T a[86:87],v20,22528
M v[108:111],a[124:127],v[244:247],0
MF v94,v6,v94
MF v95,v6,v95
M v[108:111],a[120:123],v[228:231],v[108:111]
T a[88:89],v20,24576
T a[90:91],v20,26624
M v[108:111],a[116:119],v[212:215],v[108:111]
T a[92:93],v20,28672
T a[94:95],v20,30720
M v[108:111],a[112:115],v[196:199],v[108:111]
C v84,v84,v85
C v85,v86,v87
M v[108:111],a[108:111],v[180:183],v[108:111]
C v86,v92,v93
C v87,v94,v95
M v[108:111],a[104:107],v[164:167],v[108:111]
buffer_store_dwordx4 v[84:87], v7, s[8:11], s30 offen offset:1024 sc1
M v[108:111],a[100:103],v[148:151],v[108:111]
SA s29,s33,6144
M v[108:111],a[96:99],v[132:135],v[108:111]
s_waitcnt lgkmcnt(0)
M v[112:115],a[64:67],v[128:131],0
SA s30,s33,20480
T a[96:97],v21,0
T a[98:99],v21,2048
M v[112:115],a[68:71],v[144:147],v[112:115]
T a[100:101],v21,4096
T a[102:103],v21,6144
M v[112:115],a[72:75],v[160:163],v[112:115]
MF v96,v5,v96
MF v97,v5,v97
M v[112:115],a[76:79],v[176:179],v[112:115]
T a[104:105],v21,8192
T a[106:107],v21,10240
M v[112:115],a[80:83],v[192:195],v[112:115]
T a[108:109],v21,12288
T a[110:111],v21,14336
M v[112:115],a[84:87],v[208:211],v[112:115]
MF v98,v5,v98
MF v99,v5,v99
M v[112:115],a[88:91],v[224:227],v[112:115]
T a[112:113],v21,16384
T a[114:115],v21,18432
M v[112:115],a[92:95],v[240:243],v[112:115]
T a[116:117],v21,20480
T a[118:119],v21,22528
M v[116:119],a[92:95],v[244:247],0
MF v104,v5,v104
MF v105,v5,v105
M v[116:119],a[88:91],v[228:231],v[116:119]
T a[120:121],v21,24576
T a[122:123],v21,26624
M v[116:119],a[84:87],v[212:215],v[116:119]
T a[124:125],v21,28672
T a[126:127],v21,30720
M v[116:119],a[80:83],v[196:199],v[116:119]
MF v106,v5,v106
MF v107,v5,v107
M v[116:119],a[76:79],v[180:183],v[116:119]
C v96,v96,v97
C v97,v98,v99
M v[116:119],a[72:75],v[164:167],v[116:119]
C v98,v104,v105
C v99,v106,v107
M v[116:119],a[68:71],v[148:151],v[116:119]
s_waitcnt vmcnt(28) lgkmcnt(0)
buffer_store_dwordx4 v[96:99], v7, s[8:11], s29 offen offset:0 sc1
M v[116:119],a[64:67],v[132:135],v[116:119]
s_barrier
M v[120:123],a[96:99],v[128:131],0
s_nop 0
T a[64:65],v40,0
T a[66:67],v40,2048
M v[120:123],a[100:103],v[144:147],v[120:123]
T a[68:69],v40,4096
T a[70:71],v40,6144
M v[120:123],a[104:107],v[160:163],v[120:123]
MF v100,v6,v100
MF v101,v6,v101
M v[120:123],a[108:111],v[176:179],v[120:123]
T a[72:73],v40,8192
T a[74:75],v40,10240
M v[120:123],a[112:115],v[192:195],v[120:123]
T a[76:77],v40,12288
T a[78:79],v40,14336
M v[120:123],a[116:119],v[208:211],v[120:123]
MF v102,v6,v102
MF v103,v6,v103
M v[120:123],a[120:123],v[224:227],v[120:123]
T a[80:81],v40,16384
T a[82:83],v40,18432
M v[120:123],a[124:127],v[240:243],v[120:123]
T a[84:85],v40,20480
T a[86:87],v40,22528
M v[124:127],a[124:127],v[244:247],0
MF v108,v6,v108
MF v109,v6,v109
M v[124:127],a[120:123],v[228:231],v[124:127]
T a[88:89],v40,24576
T a[90:91],v40,26624
M v[124:127],a[116:119],v[212:215],v[124:127]
T a[92:93],v40,28672
T a[94:95],v40,30720
M v[124:127],a[112:115],v[196:199],v[124:127]
MF v110,v6,v110
MF v111,v6,v111
M v[124:127],a[108:111],v[180:183],v[124:127]
C v100,v100,v101
C v101,v102,v103
M v[124:127],a[104:107],v[164:167],v[124:127]
C v102,v108,v109
C v103,v110,v111
M v[124:127],a[100:103],v[148:151],v[124:127]
s_waitcnt lgkmcnt(0)
buffer_store_dwordx4 v[100:103], v7, s[8:11], s30 offen offset:0 sc1
M v[124:127],a[96:99],v[132:135],v[124:127]
M v[64:67],a[64:67],v[128:131],0
s_nop 0
T a[96:97],v41,0
T a[98:99],v41,2048
M v[64:67],a[68:71],v[144:147],v[64:67]
T a[100:101],v41,4096
T a[102:103],v41,6144
M v[64:67],a[72:75],v[160:163],v[64:67]
v_lshrrev_b32 v32, 4, v7
MF v112,v5,v112
M v[64:67],a[76:79],v[176:179],v[64:67]
s_lshr_b32 s74, s41, 3
T a[104:105],v41,8192
T a[106:107],v41,10240
M v[64:67],a[80:83],v[192:195],v[64:67]
s_sub_u32 s64, 15, s42
T a[108:109],v41,12288
T a[110:111],v41,14336
M v[64:67],a[84:87],v[208:211],v[64:67]
s_mul_i32 s46, s64, 8704
MF v113,v5,v113
MF v114,v5,v114
M v[64:67],a[88:91],v[224:227],v[64:67]
s_and_b32 s72, s41, 7
T a[112:113],v41,16384
T a[114:115],v41,18432
M v[64:67],a[92:95],v[240:243],v[64:67]
s_lshl_b32 s65, s72, 7
T a[116:117],v41,20480
T a[118:119],v41,22528
M v[68:71],a[92:95],v[244:247],0
SA s46,s46,s65
MF v115,v5,v115
MF v120,v5,v120
M v[68:71],a[88:91],v[228:231],v[68:71]
SA s46,s46,104993792
T a[120:121],v41,24576
T a[122:123],v41,26624
M v[68:71],a[84:87],v[212:215],v[68:71]
T a[124:125],v41,28672
T a[126:127],v41,30720
M v[68:71],a[80:83],v[196:199],v[68:71]
v_and_b32 v33, 31, v32
MF v121,v5,v121
M v[68:71],a[76:79],v[180:183],v[68:71]
MF v122,v5,v122
MF v123,v5,v123
M v[68:71],a[72:75],v[164:167],v[68:71]
C v112,v112,v113
C v113,v114,v115
M v[68:71],a[68:71],v[148:151],v[68:71]
C v114,v120,v121
C v115,v122,v123
M v[68:71],a[64:67],v[132:135],v[68:71]
s_waitcnt lgkmcnt(0)
buffer_store_dwordx4 v[112:115], v7, s[8:11], s29 offen offset:1024 sc1
M v[72:75],a[96:99],v[128:131],0
s_nop 0
T a[64:65],v42,0
T a[66:67],v42,2048
M v[72:75],a[100:103],v[144:147],v[72:75]
T a[68:69],v42,4096
T a[70:71],v42,6144
M v[72:75],a[104:107],v[160:163],v[72:75]
MF v116,v6,v116
MF v117,v6,v117
M v[72:75],a[108:111],v[176:179],v[72:75]
T a[72:73],v42,8192
T a[74:75],v42,10240
M v[72:75],a[112:115],v[192:195],v[72:75]
T a[76:77],v42,12288
T a[78:79],v42,14336
M v[72:75],a[116:119],v[208:211],v[72:75]
MF v118,v6,v118
MF v119,v6,v119
M v[72:75],a[120:123],v[224:227],v[72:75]
T a[80:81],v42,16384
T a[82:83],v42,18432
M v[72:75],a[124:127],v[240:243],v[72:75]
T a[84:85],v42,20480
T a[86:87],v42,22528
M v[76:79],a[124:127],v[244:247],0
MF v124,v6,v124
MF v125,v6,v125
M v[76:79],a[120:123],v[228:231],v[76:79]
T a[88:89],v42,24576
T a[90:91],v42,26624
M v[76:79],a[116:119],v[212:215],v[76:79]
T a[92:93],v42,28672
T a[94:95],v42,30720
M v[76:79],a[112:115],v[196:199],v[76:79]
MF v126,v6,v126
MF v127,v6,v127
M v[76:79],a[108:111],v[180:183],v[76:79]
C v116,v116,v117
C v117,v118,v119
M v[76:79],a[104:107],v[164:167],v[76:79]
C v118,v124,v125
C v119,v126,v127
M v[76:79],a[100:103],v[148:151],v[76:79]
buffer_store_dwordx4 v[116:119], v7, s[8:11], s30 offen offset:1024 sc1
M v[76:79],a[96:99],v[132:135],v[76:79]
s_waitcnt lgkmcnt(0)
v_lshlrev_b32 v33, 2, v33
M v[80:83],a[64:67],v[128:131],0
SA s29,s33,8192
T a[96:97],v43,0
T a[98:99],v43,2048
M v[80:83],a[68:71],v[144:147],v[80:83]
SA s30,s33,22528
T a[100:101],v43,4096
T a[102:103],v43,6144
M v[80:83],a[72:75],v[160:163],v[80:83]
s_lshl_b32 s65, s41, 7
MF v64,v5,v64
MF v65,v5,v65
M v[80:83],a[76:79],v[176:179],v[80:83]
SA s65,s65,104890368
T a[104:105],v43,8192
T a[106:107],v43,10240
M v[80:83],a[80:83],v[192:195],v[80:83]
T a[108:109],v43,12288
T a[110:111],v43,14336
M v[80:83],a[84:87],v[208:211],v[80:83]
buffer_load_dword v31, v33, s[8:11], s65 offen sc1
M v[80:83],a[88:91],v[224:227],v[80:83]
s_nop 0
T a[112:113],v43,16384
T a[114:115],v43,18432
M v[80:83],a[92:95],v[240:243],v[80:83]
T a[116:117],v43,20480
T a[118:119],v43,22528
M v[84:87],a[92:95],v[244:247],0
s_cmp_ge_u32 s42, 8
v_bfe_u32 v34, v32, 4, 1
v_lshlrev_b32 v34, 1, v34
M v[84:87],a[88:91],v[228:231],v[84:87]
s_cselect_b32 s84, s45, 536870912
T a[120:121],v43,24576
T a[122:123],v43,26624
M v[84:87],a[84:87],v[212:215],v[84:87]
T a[124:125],v43,28672
T a[126:127],v43,30720
M v[84:87],a[80:83],v[196:199],v[84:87]
v_lshrrev_b32 v35, 5, v32
v_add_u32 v34, v34, v35
M v[84:87],a[76:79],v[180:183],v[84:87]
s_mov_b32 s52, s96
MF v66,v5,v66
MF v67,v5,v67
M v[84:87],a[72:75],v[164:167],v[84:87]
s_and_b32 s53, s97, 0xffff
MF v72,v5,v72
MF v73,v5,v73
M v[84:87],a[68:71],v[148:151],v[84:87]
s_waitcnt vmcnt(22) lgkmcnt(0)
MF v74,v5,v74
MF v75,v5,v75
M v[84:87],a[64:67],v[132:135],v[84:87]
s_barrier
M v[88:91],a[96:99],v[128:131],0
s_mov_b32 s54, 1835008
T a[64:65],v22,32768
T a[66:67],v22,34816
M v[88:91],a[100:103],v[144:147],v[88:91]
s_mov_b32 s55, 0x20000
T a[68:69],v22,36864
T a[70:71],v22,38912
M v[88:91],a[104:107],v[160:163],v[88:91]
s_mul_i32 s77, s42, 1835008
C v64,v64,v65
C v65,v66,v67
M v[88:91],a[108:111],v[176:179],v[88:91]
s_mul_i32 s78, s72, 14336
T a[72:73],v22,40960
T a[74:75],v22,43008
M v[88:91],a[112:115],v[192:195],v[88:91]
SA s77,s77,s78
T a[76:77],v22,45056
T a[78:79],v22,47104
M v[88:91],a[116:119],v[208:211],v[88:91]
SA s77,s77,67108864
C v66,v72,v73
C v67,v74,v75
M v[88:91],a[120:123],v[224:227],v[88:91]
s_lshl_b32 s79, s74, 2
T a[80:81],v22,49152
T a[82:83],v22,51200
M v[88:91],a[124:127],v[240:243],v[88:91]
SA s79,s79,s20
T a[84:85],v22,53248
T a[86:87],v22,55296
M v[92:95],a[124:127],v[244:247],0
SA s79,s79,6
buffer_store_dwordx4 v[64:67], v7, s[8:11], s29 offen offset:0 sc1
M v[92:95],a[120:123],v[228:231],v[92:95]
s_sub_u32 s67, 13, s79
T a[88:89],v22,57344
T a[90:91],v22,59392
M v[92:95],a[116:119],v[212:215],v[92:95]
s_and_b32 s67, s67, 536870912
T a[92:93],v22,61440
T a[94:95],v22,63488
M v[92:95],a[112:115],v[196:199],v[92:95]
s_lshl_b32 s78, s79, 10
MF v68,v6,v68
MF v69,v6,v69
M v[92:95],a[108:111],v[180:183],v[92:95]
SA s78,s78,s77
MF v70,v6,v70
MF v71,v6,v71
M v[92:95],a[104:107],v[164:167],v[92:95]
s_lshl_b32 s79, s79, 6
MF v76,v6,v76
MF v77,v6,v77
M v[92:95],a[100:103],v[148:151],v[92:95]
s_waitcnt lgkmcnt(0)
MF v78,v6,v78
MF v79,v6,v79
M v[92:95],a[96:99],v[132:135],v[92:95]
s_or_b32 s79, s79, s67
v_or_b32 v27, s67, v7
s_lshr_b32 s73, s72, 1
s_sub_u32 s65, 7, s73
s_bitcmp1_b32 s72, 0
s_cselect_b32 s73, s65, s73
s_lshl_b32 s73, s73, 4
s_lshl_b32 s65, s42, 7
SA s73,s73,s65
v_and_b32 v29, 15, v32
v_add_u32 v29, s73, v29
s_mov_b32 s64, 104857664
v_mul_u32_u24 v28, 896, v29
v_lshl_add_u32 v28, v34, 4, v28
C v68,v68,v69
C v69,v70,v71
C v70,v76,v77
C v71,v78,v79
buffer_store_dwordx4 v[68:71], v7, s[8:11], s30 offen offset:0 sc1
v_lshrrev_b32 v35, 4, v29
v_lshlrev_b32 v35, 5, v35
v_and_b32 v36, 15, v29
v_add_lshl_u32 v35, v35, v36, 2
buffer_load_dword v26, v35, s[8:11], s64 offen sc1
s_waitcnt vmcnt(8)
buffer_store_dword v15, v17, s[8:11], s84 offen sc1
buffer_load_dwordx4 v[44:47], v28, s[56:59], s79 offen
M v[96:99],a[64:67],v[128:131],0
s_nop 0
T a[96:97],v23,32768
T a[98:99],v23,34816
M v[96:99],a[68:71],v[144:147],v[96:99]
T a[100:101],v23,36864
T a[102:103],v23,38912
M v[96:99],a[72:75],v[160:163],v[96:99]
MF v80,v5,v80
MF v81,v5,v81
M v[96:99],a[76:79],v[176:179],v[96:99]
T a[104:105],v23,40960
T a[106:107],v23,43008
M v[96:99],a[80:83],v[192:195],v[96:99]
T a[108:109],v23,45056
T a[110:111],v23,47104
M v[96:99],a[84:87],v[208:211],v[96:99]
MF v82,v5,v82
MF v83,v5,v83
M v[96:99],a[88:91],v[224:227],v[96:99]
T a[112:113],v23,49152
T a[114:115],v23,51200
M v[96:99],a[92:95],v[240:243],v[96:99]
T a[116:117],v23,53248
T a[118:119],v23,55296
M v[100:103],a[92:95],v[244:247],0
MF v88,v5,v88
MF v89,v5,v89
M v[100:103],a[88:91],v[228:231],v[100:103]
T a[120:121],v23,57344
T a[122:123],v23,59392
M v[100:103],a[84:87],v[212:215],v[100:103]
T a[124:125],v23,61440
T a[126:127],v23,63488
M v[100:103],a[80:83],v[196:199],v[100:103]
MF v90,v5,v90
MF v91,v5,v91
M v[100:103],a[76:79],v[180:183],v[100:103]
C v80,v80,v81
C v81,v82,v83
M v[100:103],a[72:75],v[164:167],v[100:103]
C v82,v88,v89
C v83,v90,v91
M v[100:103],a[68:71],v[148:151],v[100:103]
buffer_store_dwordx4 v[80:83], v7, s[8:11], s29 offen offset:1024 sc1
M v[100:103],a[64:67],v[132:135],v[100:103]
s_waitcnt lgkmcnt(0)
MF v84,v6,v84
MF v85,v6,v85
M v[104:107],a[96:99],v[128:131],0
T a[64:65],v24,32768
T a[66:67],v24,34816
M v[104:107],a[100:103],v[144:147],v[104:107]
T a[68:69],v24,36864
T a[70:71],v24,38912
M v[104:107],a[104:107],v[160:163],v[104:107]
MF v86,v6,v86
MF v87,v6,v87
M v[104:107],a[108:111],v[176:179],v[104:107]
T a[72:73],v24,40960
T a[74:75],v24,43008
M v[104:107],a[112:115],v[192:195],v[104:107]
T a[76:77],v24,45056
T a[78:79],v24,47104
M v[104:107],a[116:119],v[208:211],v[104:107]
MF v92,v6,v92
MF v93,v6,v93
M v[104:107],a[120:123],v[224:227],v[104:107]
T a[80:81],v24,49152
T a[82:83],v24,51200
M v[104:107],a[124:127],v[240:243],v[104:107]
T a[84:85],v24,53248
T a[86:87],v24,55296
M v[108:111],a[124:127],v[244:247],0
MF v94,v6,v94
MF v95,v6,v95
M v[108:111],a[120:123],v[228:231],v[108:111]
T a[88:89],v24,57344
T a[90:91],v24,59392
M v[108:111],a[116:119],v[212:215],v[108:111]
T a[92:93],v24,61440
T a[94:95],v24,63488
M v[108:111],a[112:115],v[196:199],v[108:111]
C v84,v84,v85
C v85,v86,v87
M v[108:111],a[108:111],v[180:183],v[108:111]
C v86,v92,v93
C v87,v94,v95
M v[108:111],a[104:107],v[164:167],v[108:111]
buffer_store_dwordx4 v[84:87], v7, s[8:11], s30 offen offset:1024 sc1
M v[108:111],a[100:103],v[148:151],v[108:111]
SA s29,s33,10240
M v[108:111],a[96:99],v[132:135],v[108:111]
s_waitcnt lgkmcnt(0)
M v[112:115],a[64:67],v[128:131],0
SA s30,s33,24576
T a[96:97],v25,32768
T a[98:99],v25,34816
M v[112:115],a[68:71],v[144:147],v[112:115]
T a[100:101],v25,36864
T a[102:103],v25,38912
M v[112:115],a[72:75],v[160:163],v[112:115]
MF v96,v5,v96
MF v97,v5,v97
M v[112:115],a[76:79],v[176:179],v[112:115]
T a[104:105],v25,40960
T a[106:107],v25,43008
M v[112:115],a[80:83],v[192:195],v[112:115]
T a[108:109],v25,45056
T a[110:111],v25,47104
M v[112:115],a[84:87],v[208:211],v[112:115]
MF v98,v5,v98
MF v99,v5,v99
M v[112:115],a[88:91],v[224:227],v[112:115]
T a[112:113],v25,49152
T a[114:115],v25,51200
M v[112:115],a[92:95],v[240:243],v[112:115]
T a[116:117],v25,53248
T a[118:119],v25,55296
M v[116:119],a[92:95],v[244:247],0
s_cmp_lt_u32 s42, 8
MF v104,v5,v104
MF v105,v5,v105
M v[116:119],a[88:91],v[228:231],v[116:119]
s_cselect_b32 s84, s45, 536870912
T a[120:121],v25,57344
T a[122:123],v25,59392
M v[116:119],a[84:87],v[212:215],v[116:119]
T a[124:125],v25,61440
T a[126:127],v25,63488
M v[116:119],a[80:83],v[196:199],v[116:119]
MF v106,v5,v106
MF v107,v5,v107
M v[116:119],a[76:79],v[180:183],v[116:119]
C v96,v96,v97
C v97,v98,v99
M v[116:119],a[72:75],v[164:167],v[116:119]
C v98,v104,v105
C v99,v106,v107
M v[116:119],a[68:71],v[148:151],v[116:119]
s_waitcnt lgkmcnt(0)
buffer_store_dwordx4 v[96:99], v7, s[8:11], s29 offen offset:0 sc1
M v[116:119],a[64:67],v[132:135],v[116:119]
s_barrier
M v[120:123],a[96:99],v[128:131],0
s_nop 0
T a[64:65],v18,32768
T a[66:67],v18,34816
M v[120:123],a[100:103],v[144:147],v[120:123]
T a[68:69],v18,36864
T a[70:71],v18,38912
M v[120:123],a[104:107],v[160:163],v[120:123]
MF v100,v6,v100
MF v101,v6,v101
M v[120:123],a[108:111],v[176:179],v[120:123]
T a[72:73],v18,40960
T a[74:75],v18,43008
M v[120:123],a[112:115],v[192:195],v[120:123]
s_waitcnt vmcnt(9)
T a[76:77],v18,45056
T a[78:79],v18,47104
M v[120:123],a[116:119],v[208:211],v[120:123]
buffer_store_dword v15, v17, s[8:11], s84 offen sc1
M v[120:123],a[120:123],v[224:227],v[120:123]
s_nop 0
T a[80:81],v18,49152
T a[82:83],v18,51200
M v[120:123],a[124:127],v[240:243],v[120:123]
T a[84:85],v18,53248
T a[86:87],v18,55296
M v[124:127],a[124:127],v[244:247],0
MF v102,v6,v102
MF v103,v6,v103
M v[124:127],a[120:123],v[228:231],v[124:127]
T a[88:89],v18,57344
T a[90:91],v18,59392
M v[124:127],a[116:119],v[212:215],v[124:127]
T a[92:93],v18,61440
T a[94:95],v18,63488
M v[124:127],a[112:115],v[196:199],v[124:127]
MF v108,v6,v108
MF v109,v6,v109
M v[124:127],a[108:111],v[180:183],v[124:127]
MF v110,v6,v110
MF v111,v6,v111
M v[124:127],a[104:107],v[164:167],v[124:127]
C v100,v100,v101
C v101,v102,v103
M v[124:127],a[100:103],v[148:151],v[124:127]
s_waitcnt lgkmcnt(0)
C v102,v108,v109
C v103,v110,v111
M v[124:127],a[96:99],v[132:135],v[124:127]
buffer_store_dwordx4 v[100:103], v7, s[8:11], s30 offen offset:0 sc1
M v[64:67],a[64:67],v[128:131],0
s_nop 0
T a[96:97],v19,32768
T a[98:99],v19,34816
M v[64:67],a[68:71],v[144:147],v[64:67]
T a[100:101],v19,36864
T a[102:103],v19,38912
M v[64:67],a[72:75],v[160:163],v[64:67]
MF v112,v5,v112
MF v113,v5,v113
M v[64:67],a[76:79],v[176:179],v[64:67]
T a[104:105],v19,40960
T a[106:107],v19,43008
M v[64:67],a[80:83],v[192:195],v[64:67]
T a[108:109],v19,45056
T a[110:111],v19,47104
M v[64:67],a[84:87],v[208:211],v[64:67]
MF v114,v5,v114
MF v115,v5,v115
M v[64:67],a[88:91],v[224:227],v[64:67]
T a[112:113],v19,49152
T a[114:115],v19,51200
M v[64:67],a[92:95],v[240:243],v[64:67]
T a[116:117],v19,53248
T a[118:119],v19,55296
M v[68:71],a[92:95],v[244:247],0
MF v120,v5,v120
MF v121,v5,v121
M v[68:71],a[88:91],v[228:231],v[68:71]
T a[120:121],v19,57344
T a[122:123],v19,59392
M v[68:71],a[84:87],v[212:215],v[68:71]
T a[124:125],v19,61440
T a[126:127],v19,63488
M v[68:71],a[80:83],v[196:199],v[68:71]
MF v122,v5,v122
MF v123,v5,v123
M v[68:71],a[76:79],v[180:183],v[68:71]
C v112,v112,v113
C v113,v114,v115
M v[68:71],a[72:75],v[164:167],v[68:71]
C v114,v120,v121
C v115,v122,v123
M v[68:71],a[68:71],v[148:151],v[68:71]
buffer_store_dwordx4 v[112:115], v7, s[8:11], s29 offen offset:1024 sc1
M v[68:71],a[64:67],v[132:135],v[68:71]
s_waitcnt lgkmcnt(0)
MF v116,v6,v116
MF v117,v6,v117
M v[72:75],a[96:99],v[128:131],0
T a[64:65],v20,32768
T a[66:67],v20,34816
M v[72:75],a[100:103],v[144:147],v[72:75]
T a[68:69],v20,36864
T a[70:71],v20,38912
M v[72:75],a[104:107],v[160:163],v[72:75]
MF v118,v6,v118
MF v119,v6,v119
M v[72:75],a[108:111],v[176:179],v[72:75]
T a[72:73],v20,40960
T a[74:75],v20,43008
M v[72:75],a[112:115],v[192:195],v[72:75]
T a[76:77],v20,45056
T a[78:79],v20,47104
M v[72:75],a[116:119],v[208:211],v[72:75]
MF v124,v6,v124
MF v125,v6,v125
M v[72:75],a[120:123],v[224:227],v[72:75]
T a[80:81],v20,49152
T a[82:83],v20,51200
M v[72:75],a[124:127],v[240:243],v[72:75]
T a[84:85],v20,53248
T a[86:87],v20,55296
M v[76:79],a[124:127],v[244:247],0
MF v126,v6,v126
MF v127,v6,v127
M v[76:79],a[120:123],v[228:231],v[76:79]
T a[88:89],v20,57344
T a[90:91],v20,59392
M v[76:79],a[116:119],v[212:215],v[76:79]
T a[92:93],v20,61440
T a[94:95],v20,63488
M v[76:79],a[112:115],v[196:199],v[76:79]
C v116,v116,v117
C v117,v118,v119
M v[76:79],a[108:111],v[180:183],v[76:79]
C v118,v124,v125
C v119,v126,v127
M v[76:79],a[104:107],v[164:167],v[76:79]
buffer_store_dwordx4 v[116:119], v7, s[8:11], s30 offen offset:1024 sc1
M v[76:79],a[100:103],v[148:151],v[76:79]
SA s29,s33,12288
s_waitcnt vmcnt(12)
v_readlane_b32 s92, v31, 0
v_readlane_b32 s94, v31, 1
M v[76:79],a[96:99],v[132:135],v[76:79]
s_waitcnt lgkmcnt(0)
s_waitcnt vmcnt(9)
v_sub_f32 v30, 1.0, v26
s_waitcnt vmcnt(7)
v_lshlrev_b32 v48, 16, v44
M v[80:83],a[64:67],v[128:131],0
SA s30,s33,26624
T a[96:97],v21,32768
T a[98:99],v21,34816
M v[80:83],a[68:71],v[144:147],v[80:83]
T a[100:101],v21,36864
T a[102:103],v21,38912
M v[80:83],a[72:75],v[160:163],v[80:83]
v_and_b32 v49, 0xffff0000, v44
v_lshlrev_b32 v50, 16, v45
M v[80:83],a[76:79],v[176:179],v[80:83]
T a[104:105],v21,40960
T a[106:107],v21,43008
M v[80:83],a[80:83],v[192:195],v[80:83]
T a[108:109],v21,45056
T a[110:111],v21,47104
M v[80:83],a[84:87],v[208:211],v[80:83]
MF v64,v5,v64
MF v65,v5,v65
M v[80:83],a[88:91],v[224:227],v[80:83]
T a[112:113],v21,49152
T a[114:115],v21,51200
M v[80:83],a[92:95],v[240:243],v[80:83]
T a[116:117],v21,53248
T a[118:119],v21,55296
M v[84:87],a[92:95],v[244:247],0
MF v66,v5,v66
MF v67,v5,v67
M v[84:87],a[88:91],v[228:231],v[84:87]
T a[120:121],v21,57344
T a[122:123],v21,59392
M v[84:87],a[84:87],v[212:215],v[84:87]
T a[124:125],v21,61440
T a[126:127],v21,63488
M v[84:87],a[80:83],v[196:199],v[84:87]
MF v72,v5,v72
MF v73,v5,v73
M v[84:87],a[76:79],v[180:183],v[84:87]
MF v74,v5,v74
MF v75,v5,v75
M v[84:87],a[72:75],v[164:167],v[84:87]
C v64,v64,v65
C v65,v66,v67
M v[84:87],a[68:71],v[148:151],v[84:87]
C v66,v72,v73
C v67,v74,v75
M v[84:87],a[64:67],v[132:135],v[84:87]
s_waitcnt lgkmcnt(0)
buffer_store_dwordx4 v[64:67], v7, s[8:11], s29 offen offset:0 sc1
M v[88:91],a[96:99],v[128:131],0
v_and_b32 v51, 0xffff0000, v45
v_lshlrev_b32 v52, 16, v46
M v[88:91],a[100:103],v[144:147],v[88:91]
MF v68,v6,v68
MF v69,v6,v69
M v[88:91],a[104:107],v[160:163],v[88:91]
MF v70,v6,v70
MF v71,v6,v71
M v[88:91],a[108:111],v[176:179],v[88:91]
MF v76,v6,v76
MF v77,v6,v77
M v[88:91],a[112:115],v[192:195],v[88:91]
MF v78,v6,v78
MF v79,v6,v79
M v[88:91],a[116:119],v[208:211],v[88:91]
C v68,v68,v69
C v69,v70,v71
M v[88:91],a[120:123],v[224:227],v[88:91]
C v70,v76,v77
C v71,v78,v79
M v[88:91],a[124:127],v[240:243],v[88:91]
buffer_store_dwordx4 v[68:71], v7, s[8:11], s30 offen offset:0 sc1
M v[92:95],a[124:127],v[244:247],0
v_and_b32 v53, 0xffff0000, v46
v_lshlrev_b32 v54, 16, v47
M v[92:95],a[120:123],v[228:231],v[92:95]
v_and_b32 v55, 0xffff0000, v47
v_cmp_eq_u32 s[80:81], s92, v29
M v[92:95],a[116:119],v[212:215],v[92:95]
v_cmp_eq_u32 s[82:83], s94, v29
M v[92:95],a[112:115],v[196:199],v[92:95]
MF v80,v5,v80
MF v81,v5,v81
M v[92:95],a[108:111],v[180:183],v[92:95]
MF v82,v5,v82
MF v83,v5,v83
M v[92:95],a[104:107],v[164:167],v[92:95]
MF v88,v5,v88
MF v89,v5,v89
M v[92:95],a[100:103],v[148:151],v[92:95]
MF v90,v5,v90
MF v91,v5,v91
M v[92:95],a[96:99],v[132:135],v[92:95]
C v80,v80,v81
C v81,v82,v83
C v82,v88,v89
C v83,v90,v91
buffer_store_dwordx4 v[80:83], v7, s[8:11], s29 offen offset:1024 sc1
MF v84,v6,v84
MF v85,v6,v85
MF v86,v6,v86
MF v87,v6,v87
MF v92,v6,v92
MF v93,v6,v93
MF v94,v6,v94
MF v95,v6,v95
C v84,v84,v85
C v85,v86,v87
C v86,v92,v93
C v87,v94,v95
buffer_store_dwordx4 v[84:87], v7, s[8:11], s30 offen offset:1024 sc1
buffer_load_dword v9, v33, s[8:11], s46 offen sc1
s_waitcnt vmcnt(1)
buffer_store_dword v15, v16, s[8:11], s3 offen sc1
s_cmp_lt_u32 s42, 8
s_cbranch_scc1 L_red
s_waitcnt vmcnt(1)
v_cmp_eq_u32 vcc, 1, v9
s_mov_b32 s91, 65536
s_lshl_b32 s70, 1, s41
s_mov_b32 s69, 0xffff
s_or_b32 s70, s70, vcc_lo
s_mov_b32 s68, s70
s_barrier
s_cmp_lg_u32 s70, 0
s_cbranch_scc1 L_vk0
s_call_b64 s[36:37], L_rpoll
L_vk0:
s_ff1_i32_b32 s71, s70
s_bitset0_b32 s70, s71
s_mul_i32 s71, s71, 114688
SA s16,s71,s78
buffer_load_dwordx4 v[128:131], v27, s[8:11], s16 offen sc1
s_cmp_lg_u32 s70, 0
s_cbranch_scc1 L_vk1
s_call_b64 s[36:37], L_rpoll
L_vk1:
s_ff1_i32_b32 s71, s70
s_bitset0_b32 s70, s71
s_mul_i32 s71, s71, 114688
SA s17,s71,s78
buffer_load_dwordx4 v[132:135], v27, s[8:11], s17 offen sc1
s_cmp_lg_u32 s70, 0
s_cbranch_scc1 L_vk2
s_call_b64 s[36:37], L_rpoll
L_vk2:
s_ff1_i32_b32 s71, s70
s_bitset0_b32 s70, s71
s_mul_i32 s71, s71, 114688
SA s18,s71,s78
buffer_load_dwordx4 v[136:139], v27, s[8:11], s18 offen sc1
s_cmp_lg_u32 s70, 0
s_cbranch_scc1 L_vk3
s_call_b64 s[36:37], L_rpoll
L_vk3:
s_ff1_i32_b32 s71, s70
s_bitset0_b32 s70, s71
s_mul_i32 s71, s71, 114688
SA s19,s71,s78
buffer_load_dwordx4 v[140:143], v27, s[8:11], s19 offen sc1
s_cmp_lg_u32 s70, 0
s_cbranch_scc1 L_vk4
s_call_b64 s[36:37], L_rpoll
L_vk4:
s_ff1_i32_b32 s71, s70
s_bitset0_b32 s70, s71
s_mul_i32 s71, s71, 114688
SA s48,s71,s78
buffer_load_dwordx4 v[144:147], v27, s[8:11], s48 offen sc1
s_cmp_lg_u32 s70, 0
s_cbranch_scc1 L_vk5
s_call_b64 s[36:37], L_rpoll
L_vk5:
s_ff1_i32_b32 s71, s70
s_bitset0_b32 s70, s71
s_mul_i32 s71, s71, 114688
SA s49,s71,s78
buffer_load_dwordx4 v[148:151], v27, s[8:11], s49 offen sc1
s_cmp_lg_u32 s70, 0
s_cbranch_scc1 L_vk6
s_call_b64 s[36:37], L_rpoll
L_vk6:
s_ff1_i32_b32 s71, s70
s_bitset0_b32 s70, s71
s_mul_i32 s71, s71, 114688
SA s50,s71,s78
buffer_load_dwordx4 v[152:155], v27, s[8:11], s50 offen sc1
s_cmp_lg_u32 s70, 0
s_cbranch_scc1 L_vk7
s_call_b64 s[36:37], L_rpoll
L_vk7:
s_ff1_i32_b32 s71, s70
s_bitset0_b32 s70, s71
s_mul_i32 s71, s71, 114688
SA s51,s71,s78
buffer_load_dwordx4 v[156:159], v27, s[8:11], s51 offen sc1
s_or_b64 vcc, s[80:81], s[82:83]
s_cbranch_vccnz L_moe2
L_moe_ret2:
MF v48,v30,v48
MF v49,v30,v49
MF v50,v30,v50
MF v51,v30,v51
MF v52,v30,v52
MF v53,v30,v53
MF v54,v30,v54
MF v55,v30,v55
s_cmp_lg_u32 s70, 0
s_cbranch_scc1 L_vk8
s_call_b64 s[36:37], L_rpoll
L_vk8:
s_ff1_i32_b32 s71, s70
s_bitset0_b32 s70, s71
s_mul_i32 s71, s71, 114688
SA s21,s71,s78
buffer_load_dwordx4 v[160:163], v27, s[8:11], s21 offen sc1
s_waitcnt vmcnt(8)
M v[56:59],a[246:249],v[128:131],0
M v[60:63],a[244:247],v[128:131],0
s_cmp_lg_u32 s70, 0
s_cbranch_scc1 L_vk9
s_call_b64 s[36:37], L_rpoll
L_vk9:
s_ff1_i32_b32 s71, s70
s_bitset0_b32 s70, s71
s_mul_i32 s71, s71, 114688
SA s22,s71,s78
buffer_load_dwordx4 v[164:167], v27, s[8:11], s22 offen sc1
s_waitcnt vmcnt(8)
M v[56:59],a[246:249],v[132:135],v[56:59]
M v[60:63],a[244:247],v[132:135],v[60:63]
s_cmp_lg_u32 s70, 0
s_cbranch_scc1 L_vk10
s_call_b64 s[36:37], L_rpoll
L_vk10:
s_ff1_i32_b32 s71, s70
s_bitset0_b32 s70, s71
s_mul_i32 s71, s71, 114688
SA s23,s71,s78
buffer_load_dwordx4 v[168:171], v27, s[8:11], s23 offen sc1
s_waitcnt vmcnt(8)
M v[56:59],a[246:249],v[136:139],v[56:59]
M v[60:63],a[244:247],v[136:139],v[60:63]
s_cmp_lg_u32 s70, 0
s_cbranch_scc1 L_vk11
s_call_b64 s[36:37], L_rpoll
L_vk11:
s_ff1_i32_b32 s71, s70
s_bitset0_b32 s70, s71
s_mul_i32 s71, s71, 114688
SA s24,s71,s78
buffer_load_dwordx4 v[172:175], v27, s[8:11], s24 offen sc1
s_waitcnt vmcnt(8)
M v[56:59],a[246:249],v[140:143],v[56:59]
M v[60:63],a[244:247],v[140:143],v[60:63]
s_cmp_lg_u32 s70, 0
s_cbranch_scc1 L_vk12
s_call_b64 s[36:37], L_rpoll
L_vk12:
s_ff1_i32_b32 s71, s70
s_bitset0_b32 s70, s71
s_mul_i32 s71, s71, 114688
SA s25,s71,s78
buffer_load_dwordx4 v[176:179], v27, s[8:11], s25 offen sc1
s_waitcnt vmcnt(8)
M v[56:59],a[246:249],v[144:147],v[56:59]
M v[60:63],a[244:247],v[144:147],v[60:63]
s_cmp_lg_u32 s70, 0
s_cbranch_scc1 L_vk13
s_call_b64 s[36:37], L_rpoll
L_vk13:
s_ff1_i32_b32 s71, s70
s_bitset0_b32 s70, s71
s_mul_i32 s71, s71, 114688
SA s26,s71,s78
buffer_load_dwordx4 v[180:183], v27, s[8:11], s26 offen sc1
s_waitcnt vmcnt(8)
M v[56:59],a[246:249],v[148:151],v[56:59]
M v[60:63],a[244:247],v[148:151],v[60:63]
s_cmp_lg_u32 s70, 0
s_cbranch_scc1 L_vk14
s_call_b64 s[36:37], L_rpoll
L_vk14:
s_ff1_i32_b32 s71, s70
s_bitset0_b32 s70, s71
s_mul_i32 s71, s71, 114688
SA s27,s71,s78
buffer_load_dwordx4 v[184:187], v27, s[8:11], s27 offen sc1
s_waitcnt vmcnt(8)
M v[56:59],a[246:249],v[152:155],v[56:59]
M v[60:63],a[244:247],v[152:155],v[60:63]
s_cmp_lg_u32 s70, 0
s_cbranch_scc1 L_vk15
s_call_b64 s[36:37], L_rpoll
L_vk15:
s_ff1_i32_b32 s71, s70
s_bitset0_b32 s70, s71
s_mul_i32 s71, s71, 114688
SA s28,s71,s78
buffer_load_dwordx4 v[188:191], v27, s[8:11], s28 offen sc1
s_waitcnt vmcnt(8)
M v[56:59],a[246:249],v[156:159],v[56:59]
M v[60:63],a[244:247],v[156:159],v[60:63]
s_waitcnt vmcnt(7)
M v[56:59],a[246:249],v[160:163],v[56:59]
M v[60:63],a[244:247],v[160:163],v[60:63]
s_waitcnt vmcnt(6)
M v[56:59],a[246:249],v[164:167],v[56:59]
M v[60:63],a[244:247],v[164:167],v[60:63]
s_waitcnt vmcnt(5)
M v[56:59],a[246:249],v[168:171],v[56:59]
M v[60:63],a[244:247],v[168:171],v[60:63]
s_waitcnt vmcnt(4)
M v[56:59],a[246:249],v[172:175],v[56:59]
M v[60:63],a[244:247],v[172:175],v[60:63]
s_waitcnt vmcnt(3)
M v[56:59],a[246:249],v[176:179],v[56:59]
M v[60:63],a[244:247],v[176:179],v[60:63]
s_waitcnt vmcnt(2)
M v[56:59],a[246:249],v[180:183],v[56:59]
M v[60:63],a[244:247],v[180:183],v[60:63]
s_waitcnt vmcnt(1)
M v[56:59],a[246:249],v[184:187],v[56:59]
M v[60:63],a[244:247],v[184:187],v[60:63]
s_waitcnt vmcnt(0)
M v[56:59],a[246:249],v[188:191],v[56:59]
M v[60:63],a[244:247],v[188:191],v[60:63]
s_nop 7
v_permlane16_swap_b32 v56, v60
v_permlane16_swap_b32 v57, v61
v_permlane16_swap_b32 v58, v62
v_permlane16_swap_b32 v59, v63
v_fmac_f32 v48, v26, v56
v_fmac_f32 v49, v26, v57
v_fmac_f32 v50, v26, v58
v_fmac_f32 v51, v26, v59
v_fmac_f32 v52, v26, v60
v_fmac_f32 v53, v26, v61
v_fmac_f32 v54, v26, v62
v_fmac_f32 v55, v26, v63
C v44,v48,v49
C v45,v50,v51
C v46,v52,v53
C v47,v54,v55
buffer_store_dwordx4 v[44:47], v28, s[52:55], s79 offen sc1
s_endpgm
L_d2h:
M v[128:131],a[64:67],v[48:51],v[128:131]
R a[96:99],v7,40960
R a[100:103],v7,41984
M v[128:131],a[68:71],v[56:59],v[128:131]
SA m0,s28,135168
E v18,v64
M v[132:135],a[68:71],v[60:63],v[132:135]
buffer_load_dwordx4 v4, s[8:11], s26 offen offset:0 sc1 lds
M v[132:135],a[64:67],v[52:55],v[132:135]
R a[104:107],v7,43008
R a[108:111],v7,44032
M v[136:139],a[72:75],v[48:51],v[136:139]
s_cmp_gt_u32 s20, 3
E v19,v65
M v[136:139],a[76:79],v[56:59],v[136:139]
s_cselect_b64 s[82:83], -1, 0
AF v30,v28,v30
AF v31,v29,v31
M v[140:143],a[76:79],v[60:63],v[140:143]
s_cmp_eq_u32 s20, 3
R a[112:115],v7,45056
R a[116:119],v7,46080
M v[140:143],a[72:75],v[52:55],v[140:143]
s_cselect_b64 s[66:67], s[16:17], s[82:83]
buffer_load_dwordx4 v4, s[8:11], s26 offen offset:1024 sc1 lds
M v[144:147],a[80:83],v[48:51],v[144:147]
s_cselect_b64 s[68:69], s[18:19], s[82:83]
E v20,v66
M v[144:147],a[84:87],v[56:59],v[144:147]
s_cselect_b64 s[70:71], s[48:49], s[82:83]
R a[120:123],v7,47104
R a[124:127],v7,48128
M v[148:151],a[84:87],v[60:63],v[148:151]
s_cselect_b64 s[72:73], s[50:51], s[82:83]
v_cndmask_b32 v100, v36, v8, s[66:67]
v_cndmask_b32 v101, v36, v8, s[68:69]
M v[148:151],a[80:83],v[52:55],v[148:151]
buffer_load_dwordx4 v4, s[8:11], s26 offen offset:2048 sc1 lds
M v[152:155],a[88:91],v[48:51],v[152:155]
v_cndmask_b32 v102, v36, v8, s[70:71]
AF v26,v18,v19
M v[152:155],a[92:95],v[56:59],v[152:155]
E v21,v67
M v[156:159],a[92:95],v[60:63],v[156:159]
v_cndmask_b32 v103, v36, v8, s[72:73]
C v40,v18,v19
M v[156:159],a[88:91],v[52:55],v[156:159]
s_waitcnt lgkmcnt(0)
buffer_load_dwordx4 v4, s[8:11], s26 offen offset:3072 sc1 lds
M v[160:163],a[96:99],v[48:51],v[160:163]
s_cmp_gt_u32 s20, 2
R a[64:67],v7,49152
R a[68:71],v7,50176
M v[160:163],a[100:103],v[56:59],v[160:163]
s_cselect_b64 s[82:83], -1, 0
E v22,v72
M v[164:167],a[100:103],v[60:63],v[164:167]
s_cmp_eq_u32 s20, 2
AF v26,v20,v26
C v41,v20,v21
M v[164:167],a[96:99],v[52:55],v[164:167]
s_mul_i32 s21, s41, 1048576
R a[72:75],v7,51200
R a[76:79],v7,52224
M v[168:171],a[104:107],v[48:51],v[168:171]
s_cselect_b64 s[74:75], s[16:17], s[82:83]
E v23,v73
M v[168:171],a[108:111],v[56:59],v[168:171]
s_cselect_b64 s[76:77], s[18:19], s[82:83]
AF v26,v21,v26
AF v26,v22,v26
M v[172:175],a[108:111],v[60:63],v[172:175]
s_cselect_b64 s[78:79], s[48:49], s[82:83]
R a[80:83],v7,53248
R a[84:87],v7,54272
M v[172:175],a[104:107],v[52:55],v[172:175]
s_cselect_b64 s[80:81], s[50:51], s[82:83]
v_cndmask_b32 v108, v36, v8, s[74:75]
v_cndmask_b32 v109, v36, v8, s[76:77]
M v[176:179],a[112:115],v[48:51],v[176:179]
SA s21,s21,589824
E v24,v74
M v[176:179],a[116:119],v[56:59],v[176:179]
s_lshl_b32 s84, s42, 1
R a[88:91],v7,55296
R a[92:95],v7,56320
M v[180:183],a[116:119],v[60:63],v[180:183]
s_sub_u32 s22, 11, s84
v_cndmask_b32 v110, v36, v8, s[78:79]
C v42,v22,v23
M v[180:183],a[112:115],v[52:55],v[180:183]
s_mov_b32 s23, 536870912
s_waitcnt vmcnt(16)
v_cmp_gt_u32 vcc, 2, v5
AF v26,v23,v26
M v[184:187],a[120:123],v[48:51],v[184:187]
s_cbranch_vccnz L_lsh2
L_lrh2:
v_cndmask_b32 v111, v36, v8, s[80:81]
M v[184:187],a[124:127],v[56:59],v[184:187]
SA m0,s28,98304
E v25,v75
M v[188:191],a[124:127],v[60:63],v[188:191]
s_cmp_gt_u32 s20, 1
buffer_load_dwordx4 v3, s[8:11], s21 offen offset:0 sc1 lds
M v[188:191],a[120:123],v[52:55],v[188:191]
s_waitcnt lgkmcnt(0)
E v18,v68
M v[192:195],a[64:67],v[48:51],v[192:195]
s_cselect_b64 s[82:83], -1, 0
R a[96:99],v7,57344
R a[100:103],v7,58368
M v[192:195],a[68:71],v[56:59],v[192:195]
s_cmp_eq_u32 s20, 1
buffer_load_dwordx4 v3, s[8:11], s21 offen offset:1024 sc1 lds
M v[196:199],a[68:71],v[60:63],v[196:199]
s_cselect_b64 s[66:67], s[16:17], s[82:83]
E v19,v69
M v[196:199],a[64:67],v[52:55],v[196:199]
s_cselect_b64 s[68:69], s[18:19], s[82:83]
R a[104:107],v7,59392
R a[108:111],v7,60416
M v[200:203],a[72:75],v[48:51],v[200:203]
s_cselect_b64 s[70:71], s[48:49], s[82:83]
buffer_load_dwordx4 v3, s[8:11], s21 offen offset:2048 sc1 lds
M v[200:203],a[76:79],v[56:59],v[200:203]
s_cselect_b64 s[72:73], s[50:51], s[82:83]
v_cndmask_b32 v116, v36, v8, s[66:67]
v_cndmask_b32 v117, v36, v8, s[68:69]
M v[204:207],a[76:79],v[60:63],v[204:207]
R a[112:115],v7,61440
R a[116:119],v7,62464
M v[204:207],a[72:75],v[52:55],v[204:207]
v_cndmask_b32 v118, v36, v8, s[70:71]
AF v26,v24,v26
M v[208:211],a[80:83],v[48:51],v[208:211]
buffer_load_dwordx4 v3, s[8:11], s21 offen offset:3072 sc1 lds
M v[208:211],a[84:87],v[56:59],v[208:211]
SA m0,s28,102400
R a[120:123],v7,63488
R a[124:127],v7,64512
M v[212:215],a[84:87],v[60:63],v[212:215]
v_cndmask_b32 v119, v36, v8, s[72:73]
C v43,v24,v25
M v[212:215],a[80:83],v[52:55],v[212:215]
s_cmp_gt_u32 s20, 0
E v20,v70
M v[216:219],a[88:91],v[48:51],v[216:219]
s_cselect_b64 s[82:83], -1, 0
buffer_load_dwordx4 v4, s[8:11], s21 offen offset:0 sc1 lds
M v[216:219],a[92:95],v[56:59],v[216:219]
s_cmp_eq_u32 s20, 0
E v21,v71
M v[220:223],a[92:95],v[60:63],v[220:223]
s_waitcnt lgkmcnt(0)
E v22,v76
M v[220:223],a[88:91],v[52:55],v[220:223]
s_barrier
M v[224:227],a[96:99],v[48:51],v[224:227]
s_cselect_b64 s[74:75], s[16:17], s[82:83]
R a[64:67],v2,0
R a[68:71],v2,1024
M v[224:227],a[100:103],v[56:59],v[224:227]
s_cselect_b64 s[76:77], s[18:19], s[82:83]
buffer_load_dwordx4 v4, s[8:11], s21 offen offset:1024 sc1 lds
M v[228:231],a[100:103],v[60:63],v[228:231]
s_cselect_b64 s[78:79], s[48:49], s[82:83]
E v23,v77
M v[228:231],a[96:99],v[52:55],v[228:231]
s_cselect_b64 s[80:81], s[50:51], s[82:83]
R a[72:75],v2,2048
R a[76:79],v2,3072
M v[232:235],a[104:107],v[48:51],v[232:235]
v_cndmask_b32 v124, v36, v8, s[74:75]
v_cndmask_b32 v125, v36, v8, s[76:77]
M v[232:235],a[108:111],v[56:59],v[232:235]
buffer_load_dwordx4 v4, s[8:11], s21 offen offset:2048 sc1 lds
M v[236:239],a[108:111],v[60:63],v[236:239]
R a[80:83],v2,4096
R a[84:87],v2,5120
M v[236:239],a[104:107],v[52:55],v[236:239]
v_cndmask_b32 v126, v36, v8, s[78:79]
AF v26,v25,v26
M v[240:243],a[112:115],v[48:51],v[240:243]
v_cndmask_b32 v127, v36, v8, s[80:81]
AF v27,v18,v19
M v[240:243],a[116:119],v[56:59],v[240:243]
R a[88:91],v2,6144
R a[92:95],v2,7168
M v[244:247],a[116:119],v[60:63],v[244:247]
buffer_load_dwordx4 v4, s[8:11], s21 offen offset:3072 sc1 lds
M v[244:247],a[112:115],v[52:55],v[244:247]
SA s21,s21,32768
E v24,v78
M v[248:251],a[120:123],v[48:51],v[248:251]
s_sub_u32 s22, s22, 1
E v25,v79
M v[248:251],a[124:127],v[56:59],v[248:251]
s_cselect_b32 s21, s23, s21
C v44,v18,v19
AF v27,v20,v27
M v[252:255],a[124:127],v[60:63],v[252:255]
s_waitcnt lgkmcnt(0)
C v45,v20,v21
AF v27,v21,v27
M v[252:255],a[120:123],v[52:55],v[252:255]
AF v27,v22,v27
C v46,v22,v23
AF v27,v23,v27
AF v27,v24,v27
C v47,v24,v25
AF v27,v25,v27
L_d3h:
M v[100:103],a[64:67],a[32:35],v[100:103]
R a[96:99],v2,8192
R a[100:103],v2,9216
M v[100:103],a[68:71],a[36:39],v[100:103]
R a[104:107],v2,10240
R a[108:111],v2,11264
M v[100:103],a[72:75],a[40:43],v[100:103]
R a[112:115],v2,12288
R a[116:119],v2,13312
M v[100:103],a[76:79],a[44:47],v[100:103]
R a[120:123],v2,14336
R a[124:127],v2,15360
M v[100:103],a[80:83],a[48:51],v[100:103]
v_add_u32 v8, 0x20000, v7
M v[100:103],a[84:87],a[52:55],v[100:103]
buffer_load_dword v5, v9, s[8:11], s46 offen sc1
M v[100:103],a[88:91],a[56:59],v[100:103]
buffer_load_dword v6, off, s[8:11], s47 offset:16 sc1
M v[100:103],a[92:95],a[60:63],v[100:103]
s_waitcnt lgkmcnt(0)
E v18,v80
M v[108:111],a[96:99],a[32:35],v[108:111]
R a[64:67],v2,16384
R a[68:71],v2,17408
M v[108:111],a[100:103],a[36:39],v[108:111]
R a[72:75],v2,18432
R a[76:79],v2,19456
M v[108:111],a[104:107],a[40:43],v[108:111]
R a[80:83],v2,20480
R a[84:87],v2,21504
M v[108:111],a[108:111],a[44:47],v[108:111]
R a[88:91],v2,22528
R a[92:95],v2,23552
M v[108:111],a[112:115],a[48:51],v[108:111]
E v19,v81
M v[108:111],a[116:119],a[52:55],v[108:111]
E v20,v82
M v[108:111],a[120:123],a[56:59],v[108:111]
E v21,v83
M v[108:111],a[124:127],a[60:63],v[108:111]
s_waitcnt lgkmcnt(0)
E v22,v88
M v[116:119],a[64:67],a[32:35],v[116:119]
R a[96:99],v2,24576
R a[100:103],v2,25600
M v[116:119],a[68:71],a[36:39],v[116:119]
R a[104:107],v2,26624
R a[108:111],v2,27648
M v[116:119],a[72:75],a[40:43],v[116:119]
R a[112:115],v2,28672
R a[116:119],v2,29696
M v[116:119],a[76:79],a[44:47],v[116:119]
R a[120:123],v2,30720
R a[124:127],v2,31744
M v[116:119],a[80:83],a[48:51],v[116:119]
E v23,v89
M v[116:119],a[84:87],a[52:55],v[116:119]
E v24,v90
M v[116:119],a[88:91],a[56:59],v[116:119]
s_waitcnt vmcnt(18) lgkmcnt(0)
E v25,v91
M v[116:119],a[92:95],a[60:63],v[116:119]
s_barrier
M v[124:127],a[96:99],a[32:35],v[124:127]
R a[64:67],v7,0
R a[68:71],v7,1024
M v[124:127],a[100:103],a[36:39],v[124:127]
R a[72:75],v7,2048
R a[76:79],v7,3072
M v[124:127],a[104:107],a[40:43],v[124:127]
R a[80:83],v7,4096
R a[84:87],v7,5120
M v[124:127],a[108:111],a[44:47],v[124:127]
R a[88:91],v7,6144
R a[92:95],v7,7168
M v[124:127],a[112:115],a[48:51],v[124:127]
AF v26,v18,v26
C v56,v18,v19
M v[124:127],a[116:119],a[52:55],v[124:127]
AF v26,v19,v26
AF v26,v20,v26
M v[124:127],a[120:123],a[56:59],v[124:127]
s_waitcnt lgkmcnt(0)
E v18,v84
M v[124:127],a[124:127],a[60:63],v[124:127]
E v19,v85
C v57,v20,v21
AF v26,v21,v26
AF v26,v22,v26
C v58,v22,v23
AF v26,v23,v26
AF v26,v24,v26
C v59,v24,v25
AF v26,v25,v26
E v20,v86
E v21,v87
AF v27,v18,v27
C v60,v18,v19
AF v27,v19,v27
E v22,v92
E v23,v93
AF v27,v20,v27
C v61,v20,v21
AF v27,v21,v27
E v24,v94
E v25,v95
AF v27,v22,v27
C v62,v22,v23
AF v27,v23,v27
AF v27,v24,v27
C v63,v24,v25
AF v27,v25,v27
v_max_f32 v10, v26, v27
v_cmp_lt_f32 vcc, s31, v10
s_nop 0
s_cbranch_vccnz L_std3h
L_rtd3h:
M v[128:131],a[64:67],v[40:43],v[128:131]
R a[96:99],v7,8192
R a[100:103],v7,9216
M v[128:131],a[68:71],v[56:59],v[128:131]
s_waitcnt vmcnt(0)
v_cmp_ne_u32 vcc, 1, v6
AF v30,v26,v30
M v[132:135],a[68:71],v[60:63],v[132:135]
s_cbranch_vccnz L_fqs
L_fqr:
E v18,v100
M v[132:135],a[64:67],v[44:47],v[132:135]
SA s73,s32,4096
R a[104:107],v7,10240
R a[108:111],v7,11264
M v[136:139],a[72:75],v[40:43],v[136:139]
SA s74,s32,8192
E v19,v101
M v[136:139],a[76:79],v[56:59],v[136:139]
SA s75,s32,12288
buffer_load_dwordx4 a[0:3], v7, s[8:11], s32 offen offset:0 sc1
M v[140:143],a[76:79],v[60:63],v[140:143]
R a[112:115],v7,12288
R a[116:119],v7,13312
M v[140:143],a[72:75],v[44:47],v[140:143]
E v20,v102
M v[144:147],a[80:83],v[40:43],v[144:147]
buffer_load_dwordx4 a[4:7], v7, s[8:11], s32 offen offset:1024 sc1
M v[144:147],a[84:87],v[56:59],v[144:147]
R a[120:123],v7,14336
R a[124:127],v7,15360
M v[148:151],a[84:87],v[60:63],v[148:151]
AF v31,v27,v31
AF v29,v18,v19
M v[148:151],a[80:83],v[44:47],v[148:151]
buffer_load_dwordx4 a[8:11], v7, s[8:11], s32 offen offset:2048 sc1
M v[152:155],a[88:91],v[40:43],v[152:155]
E v21,v103
M v[152:155],a[92:95],v[56:59],v[152:155]
C v52,v18,v19
AF v29,v20,v29
M v[156:159],a[92:95],v[60:63],v[156:159]
buffer_load_dwordx4 a[12:15], v7, s[8:11], s32 offen offset:3072 sc1
M v[156:159],a[88:91],v[44:47],v[156:159]
s_waitcnt lgkmcnt(0)
E v22,v108
M v[160:163],a[96:99],v[40:43],v[160:163]
R a[64:67],v7,16384
R a[68:71],v7,17408
M v[160:163],a[100:103],v[56:59],v[160:163]
buffer_load_dwordx4 a[16:19], v7, s[8:11], s73 offen offset:0 sc1
M v[164:167],a[100:103],v[60:63],v[164:167]
E v23,v109
M v[164:167],a[96:99],v[44:47],v[164:167]
R a[72:75],v7,18432
R a[76:79],v7,19456
M v[168:171],a[104:107],v[40:43],v[168:171]
buffer_load_dwordx4 a[20:23], v7, s[8:11], s73 offen offset:1024 sc1
M v[168:171],a[108:111],v[56:59],v[168:171]
C v53,v20,v21
AF v29,v21,v29
M v[172:175],a[108:111],v[60:63],v[172:175]
R a[80:83],v7,20480
R a[84:87],v7,21504
M v[172:175],a[104:107],v[44:47],v[172:175]
buffer_load_dwordx4 a[24:27], v7, s[8:11], s73 offen offset:2048 sc1
M v[176:179],a[112:115],v[40:43],v[176:179]
E v24,v110
M v[176:179],a[116:119],v[56:59],v[176:179]
R a[88:91],v7,22528
R a[92:95],v7,23552
M v[180:183],a[116:119],v[60:63],v[180:183]
buffer_load_dwordx4 a[28:31], v7, s[8:11], s73 offen offset:3072 sc1
M v[180:183],a[112:115],v[44:47],v[180:183]
E v25,v111
M v[184:187],a[120:123],v[40:43],v[184:187]
AF v29,v22,v29
C v54,v22,v23
M v[184:187],a[124:127],v[56:59],v[184:187]
buffer_load_dwordx4 a[32:35], v7, s[8:11], s74 offen offset:0 sc1
M v[188:191],a[124:127],v[60:63],v[188:191]
E v18,v116
M v[188:191],a[120:123],v[44:47],v[188:191]
s_waitcnt lgkmcnt(0)
AF v29,v23,v29
AF v29,v24,v29
M v[192:195],a[64:67],v[40:43],v[192:195]
R a[96:99],v7,24576
R a[100:103],v7,25600
M v[192:195],a[68:71],v[56:59],v[192:195]
buffer_load_dwordx4 a[36:39], v7, s[8:11], s74 offen offset:1024 sc1
M v[196:199],a[68:71],v[60:63],v[196:199]
E v19,v117
M v[196:199],a[64:67],v[44:47],v[196:199]
R a[104:107],v7,26624
R a[108:111],v7,27648
M v[200:203],a[72:75],v[40:43],v[200:203]
buffer_load_dwordx4 a[40:43], v7, s[8:11], s74 offen offset:2048 sc1
M v[200:203],a[76:79],v[56:59],v[200:203]
E v20,v118
M v[204:207],a[76:79],v[60:63],v[204:207]
R a[112:115],v7,28672
R a[116:119],v7,29696
M v[204:207],a[72:75],v[44:47],v[204:207]
buffer_load_dwordx4 a[44:47], v7, s[8:11], s74 offen offset:3072 sc1
M v[208:211],a[80:83],v[40:43],v[208:211]
C v55,v24,v25
AF v29,v25,v29
M v[208:211],a[84:87],v[56:59],v[208:211]
R a[120:123],v7,30720
R a[124:127],v7,31744
M v[212:215],a[84:87],v[60:63],v[212:215]
buffer_load_dwordx4 a[48:51], v7, s[8:11], s75 offen offset:0 sc1
M v[212:215],a[80:83],v[44:47],v[212:215]
E v21,v119
M v[216:219],a[88:91],v[40:43],v[216:219]
AF v29,v18,v29
C v48,v18,v19
M v[216:219],a[92:95],v[56:59],v[216:219]
buffer_load_dwordx4 a[52:55], v7, s[8:11], s75 offen offset:1024 sc1
M v[220:223],a[92:95],v[60:63],v[220:223]
s_waitcnt lgkmcnt(0)
E v22,v124
M v[220:223],a[88:91],v[44:47],v[220:223]
s_barrier
M v[224:227],a[96:99],v[40:43],v[224:227]
R a[64:67],v8,0
R a[68:71],v8,1024
M v[224:227],a[100:103],v[56:59],v[224:227]
buffer_load_dwordx4 a[56:59], v7, s[8:11], s75 offen offset:2048 sc1
M v[228:231],a[100:103],v[60:63],v[228:231]
v_mov_b32 v15, 4
AF v29,v19,v29
M v[228:231],a[96:99],v[44:47],v[228:231]
R a[72:75],v8,2048
R a[76:79],v8,3072
M v[232:235],a[104:107],v[40:43],v[232:235]
buffer_store_dword v15, v1, s[8:11], s45 offen sc1
M v[232:235],a[108:111],v[56:59],v[232:235]
buffer_load_dwordx4 a[60:63], v7, s[8:11], s75 offen offset:3072 sc1
M v[236:239],a[108:111],v[60:63],v[236:239]
s_cmp_ge_u32 s42, 2
R a[80:83],v8,4096
R a[84:87],v8,5120
M v[236:239],a[104:107],v[44:47],v[236:239]
s_cselect_b32 s84, 4, 2
v_cmp_gt_u32 vcc, s84, v5
AF v29,v20,v29
M v[240:243],a[112:115],v[40:43],v[240:243]
s_cbranch_vccnz L_lsh4
L_lrh4:
E v23,v125
M v[240:243],a[116:119],v[56:59],v[240:243]
R a[88:91],v8,6144
R a[92:95],v8,7168
M v[244:247],a[116:119],v[60:63],v[244:247]
E v24,v126
M v[244:247],a[112:115],v[44:47],v[244:247]
E v25,v127
M v[248:251],a[120:123],v[40:43],v[248:251]
C v49,v20,v21
AF v29,v21,v29
M v[248:251],a[124:127],v[56:59],v[248:251]
AF v29,v22,v29
C v50,v22,v23
M v[252:255],a[124:127],v[60:63],v[252:255]
s_waitcnt lgkmcnt(0)
AF v29,v23,v29
AF v29,v24,v29
M v[252:255],a[120:123],v[44:47],v[252:255]
C v51,v24,v25
AF v29,v25,v29
v_cmp_lt_f32 vcc, s31, v29
s_nop 0
s_cbranch_vccnz L_std4h
L_rtd4h:
M v[132:135],a[64:67],v[52:55],v[132:135]
R a[96:99],v8,8192
R a[100:103],v8,9216
M v[132:135],a[68:71],v[48:51],v[132:135]
R a[104:107],v8,10240
R a[108:111],v8,11264
M v[140:143],a[72:75],v[52:55],v[140:143]
SA m0,s28,65536
R a[112:115],v8,12288
R a[116:119],v8,13312
M v[140:143],a[76:79],v[48:51],v[140:143]
R a[120:123],v8,14336
R a[124:127],v8,15360
M v[148:151],a[80:83],v[52:55],v[148:151]
buffer_load_dwordx4 v3, s[8:11], s21 offen offset:0 sc1 lds
M v[148:151],a[84:87],v[48:51],v[148:151]
AF v31,v29,v31
v_mov_b32 v10, v30
M v[156:159],a[88:91],v[52:55],v[156:159]
v_mov_b32 v11, v31
C v128,v128,v129
M v[156:159],a[92:95],v[48:51],v[156:159]
s_waitcnt lgkmcnt(0)
v_permlane16_swap_b32 v10, v30
M v[164:167],a[96:99],v[52:55],v[164:167]
R a[64:67],v8,16384
R a[68:71],v8,17408
M v[164:167],a[100:103],v[48:51],v[164:167]
R a[72:75],v8,18432
R a[76:79],v8,19456
M v[172:175],a[104:107],v[52:55],v[172:175]
R a[80:83],v8,20480
R a[84:87],v8,21504
M v[172:175],a[108:111],v[48:51],v[172:175]
R a[88:91],v8,22528
R a[92:95],v8,23552
M v[180:183],a[112:115],v[52:55],v[180:183]
buffer_load_dwordx4 v3, s[8:11], s21 offen offset:1024 sc1 lds
M v[180:183],a[116:119],v[48:51],v[180:183]
v_permlane16_swap_b32 v11, v31
M v[188:191],a[120:123],v[52:55],v[188:191]
AF v30,v10,v30
AF v31,v11,v31
M v[188:191],a[124:127],v[48:51],v[188:191]
s_waitcnt lgkmcnt(0)
buffer_load_dwordx4 v3, s[8:11], s21 offen offset:2048 sc1 lds
M v[196:199],a[64:67],v[52:55],v[196:199]
R a[96:99],v8,24576
R a[100:103],v8,25600
M v[196:199],a[68:71],v[48:51],v[196:199]
R a[104:107],v8,26624
R a[108:111],v8,27648
M v[204:207],a[72:75],v[52:55],v[204:207]
R a[112:115],v8,28672
R a[116:119],v8,29696
M v[204:207],a[76:79],v[48:51],v[204:207]
R a[120:123],v8,30720
R a[124:127],v8,31744
M v[212:215],a[80:83],v[52:55],v[212:215]
buffer_load_dwordx4 v3, s[8:11], s21 offen offset:3072 sc1 lds
M v[212:215],a[84:87],v[48:51],v[212:215]
SA m0,s28,69632
v_mov_b32 v10, v30
v_mov_b32 v11, v31
M v[220:223],a[88:91],v[52:55],v[220:223]
s_waitcnt lgkmcnt(0)
v_permlane32_swap_b32 v10, v30
M v[220:223],a[92:95],v[48:51],v[220:223]
s_barrier
M v[228:231],a[96:99],v[52:55],v[228:231]
R a[64:67],v2,32768
R a[68:71],v2,33792
M v[228:231],a[100:103],v[48:51],v[228:231]
R a[72:75],v2,34816
R a[76:79],v2,35840
M v[236:239],a[104:107],v[52:55],v[236:239]
R a[80:83],v2,36864
R a[84:87],v2,37888
M v[236:239],a[108:111],v[48:51],v[236:239]
R a[88:91],v2,38912
R a[92:95],v2,39936
M v[244:247],a[112:115],v[52:55],v[244:247]
v_permlane32_swap_b32 v11, v31
M v[244:247],a[116:119],v[48:51],v[244:247]
s_waitcnt vmcnt(4)
buffer_load_dwordx4 v4, s[8:11], s21 offen offset:0 sc1 lds
M v[252:255],a[120:123],v[52:55],v[252:255]
s_waitcnt lgkmcnt(0)
AF v30,v10,v30
AF v31,v11,v31
M v[252:255],a[124:127],v[48:51],v[252:255]
v_rcp_f32 v5, v30
M v[64:67],a[64:67],a[0:3],0
R a[96:99],v2,40960
R a[100:103],v2,41984
M v[64:67],a[68:71],a[4:7],v[64:67]
v_rcp_f32 v6, v31
M v[64:67],a[72:75],a[8:11],v[64:67]
buffer_load_dwordx4 v4, s[8:11], s21 offen offset:1024 sc1 lds
M v[64:67],a[76:79],a[12:15],v[64:67]
R a[104:107],v2,43008
R a[108:111],v2,44032
M v[64:67],a[80:83],a[16:19],v[64:67]
W a192,v5
W a193,v6
M v[64:67],a[84:87],a[20:23],v[64:67]
buffer_load_dwordx4 v4, s[8:11], s21 offen offset:2048 sc1 lds
M v[64:67],a[88:91],a[24:27],v[64:67]
R a[112:115],v2,45056
R a[116:119],v2,46080
M v[64:67],a[92:95],a[28:31],v[64:67]
v_mov_b32 v30, 0
v_mov_b32 v31, 0
M v[68:71],a[92:95],a[60:63],0
buffer_load_dwordx4 v4, s[8:11], s21 offen offset:3072 sc1 lds
M v[68:71],a[88:91],a[56:59],v[68:71]
SA s21,s21,32768
R a[120:123],v2,47104
R a[124:127],v2,48128
M v[68:71],a[84:87],a[52:55],v[68:71]
s_sub_u32 s22, s22, 1
v_mov_b32 v32, 0
v_mov_b32 v33, 0
M v[68:71],a[80:83],a[48:51],v[68:71]
s_cselect_b32 s21, s23, s21
v_mov_b32 v34, 0
v_mov_b32 v35, 0
M v[68:71],a[76:79],a[44:47],v[68:71]
s_mul_i32 s26, s41, 1048576
v_mov_b32 v36, 0
v_mov_b32 v37, 0
M v[68:71],a[72:75],a[40:43],v[68:71]
SA s26,s26,17367040
v_mov_b32 v38, 0
v_mov_b32 v39, 0
M v[68:71],a[68:71],a[36:39],v[68:71]
SA m0,s28,0
E v18,v64
M v[68:71],a[64:67],a[32:35],v[68:71]
s_waitcnt lgkmcnt(0)
buffer_load_dwordx4 v3, s[8:11], s26 offen offset:0 sc1 lds
M v[72:75],a[96:99],a[0:3],0
R a[64:67],v2,49152
R a[68:71],v2,50176
M v[72:75],a[100:103],a[4:7],v[72:75]
E v19,v65
M v[72:75],a[104:107],a[8:11],v[72:75]
buffer_load_dwordx4 v3, s[8:11], s26 offen offset:1024 sc1 lds
M v[72:75],a[108:111],a[12:15],v[72:75]
R a[72:75],v2,51200
R a[76:79],v2,52224
M v[72:75],a[112:115],a[16:19],v[72:75]
E v20,v66
M v[72:75],a[116:119],a[20:23],v[72:75]
buffer_load_dwordx4 v3, s[8:11], s26 offen offset:2048 sc1 lds
M v[72:75],a[120:123],a[24:27],v[72:75]
R a[80:83],v2,53248
R a[84:87],v2,54272
M v[72:75],a[124:127],a[28:31],v[72:75]
E v21,v67
M v[76:79],a[124:127],a[60:63],0
buffer_load_dwordx4 v3, s[8:11], s26 offen offset:3072 sc1 lds
M v[76:79],a[120:123],a[56:59],v[76:79]
SA m0,s28,4096
R a[88:91],v2,55296
R a[92:95],v2,56320
M v[76:79],a[116:119],a[52:55],v[76:79]
E v22,v68
M v[76:79],a[112:115],a[48:51],v[76:79]
E v23,v69
M v[76:79],a[108:111],a[44:47],v[76:79]
buffer_load_dwordx4 v4, s[8:11], s26 offen offset:0 sc1 lds
M v[76:79],a[104:107],a[40:43],v[76:79]
AF v26,v18,v19
C v40,v18,v19
M v[76:79],a[100:103],a[36:39],v[76:79]
E v24,v70
M v[76:79],a[96:99],a[32:35],v[76:79]
s_waitcnt lgkmcnt(0)
AF v26,v20,v26
C v41,v20,v21
M v[80:83],a[64:67],a[0:3],0
R a[96:99],v2,57344
R a[100:103],v2,58368
M v[80:83],a[68:71],a[4:7],v[80:83]
buffer_load_dwordx4 v4, s[8:11], s26 offen offset:1024 sc1 lds
M v[80:83],a[72:75],a[8:11],v[80:83]
E v25,v71
M v[80:83],a[76:79],a[12:15],v[80:83]
R a[104:107],v2,59392
R a[108:111],v2,60416
M v[80:83],a[80:83],a[16:19],v[80:83]
AF v26,v21,v26
AF v27,v22,v23
M v[80:83],a[84:87],a[20:23],v[80:83]
buffer_load_dwordx4 v4, s[8:11], s26 offen offset:2048 sc1 lds
M v[80:83],a[88:91],a[24:27],v[80:83]
R a[112:115],v2,61440
R a[116:119],v2,62464
M v[80:83],a[92:95],a[28:31],v[80:83]
E v18,v72
M v[84:87],a[92:95],a[60:63],0
E v19,v73
M v[84:87],a[88:91],a[56:59],v[84:87]
R a[120:123],v2,63488
R a[124:127],v2,64512
M v[84:87],a[84:87],a[52:55],v[84:87]
buffer_load_dwordx4 v4, s[8:11], s26 offen offset:3072 sc1 lds
M v[84:87],a[80:83],a[48:51],v[84:87]
SA s26,s26,32768
E v20,v74
M v[84:87],a[76:79],a[44:47],v[84:87]
SA m0,s28,32768
C v44,v22,v23
AF v27,v24,v27
M v[84:87],a[72:75],a[40:43],v[84:87]
C v45,v24,v25
AF v27,v25,v27
M v[84:87],a[68:71],a[36:39],v[84:87]
s_waitcnt vmcnt(8) lgkmcnt(0)
buffer_load_dwordx4 v3, s[8:11], s26 offen offset:0 sc1 lds
M v[84:87],a[64:67],a[32:35],v[84:87]
s_barrier
M v[88:91],a[96:99],a[0:3],0
R a[64:67],v2,0
R a[68:71],v2,1024
M v[88:91],a[100:103],a[4:7],v[88:91]
E v21,v75
M v[88:91],a[104:107],a[8:11],v[88:91]
buffer_load_dwordx4 v3, s[8:11], s26 offen offset:1024 sc1 lds
M v[88:91],a[108:111],a[12:15],v[88:91]
R a[72:75],v2,2048
R a[76:79],v2,3072
M v[88:91],a[112:115],a[16:19],v[88:91]
E v22,v76
M v[88:91],a[116:119],a[20:23],v[88:91]
E v23,v77
M v[88:91],a[120:123],a[24:27],v[88:91]
R a[80:83],v2,4096
R a[84:87],v2,5120
M v[88:91],a[124:127],a[28:31],v[88:91]
buffer_load_dwordx4 v3, s[8:11], s26 offen offset:2048 sc1 lds
M v[92:95],a[124:127],a[60:63],0
E v24,v78
M v[92:95],a[120:123],a[56:59],v[92:95]
R a[88:91],v2,6144
R a[92:95],v2,7168
M v[92:95],a[116:119],a[52:55],v[92:95]
E v25,v79
M v[92:95],a[112:115],a[48:51],v[92:95]
buffer_load_dwordx4 v3, s[8:11], s26 offen offset:3072 sc1 lds
M v[92:95],a[108:111],a[44:47],v[92:95]
AF v26,v18,v26
C v42,v18,v19
M v[92:95],a[104:107],a[40:43],v[92:95]
AF v26,v19,v26
AF v26,v20,v26
M v[92:95],a[100:103],a[36:39],v[92:95]
s_waitcnt lgkmcnt(0)
C v43,v20,v21
AF v26,v21,v26
M v[92:95],a[96:99],a[32:35],v[92:95]
AF v27,v22,v27
C v46,v22,v23
AF v27,v23,v27
AF v27,v24,v27
C v47,v24,v25
AF v27,v25,v27
M v[96:99],a[64:67],a[0:3],0
R a[96:99],v2,8192
R a[100:103],v2,9216
M v[96:99],a[68:71],a[4:7],v[96:99]
SA m0,s28,98304
E v18,v80
M v[96:99],a[72:75],a[8:11],v[96:99]
buffer_load_dwordx4 v3, s[8:11], s21 offen offset:0 sc1 lds
M v[96:99],a[76:79],a[12:15],v[96:99]
R a[104:107],v2,10240
R a[108:111],v2,11264
M v[96:99],a[80:83],a[16:19],v[96:99]
E v19,v81
M v[96:99],a[84:87],a[20:23],v[96:99]
AF v26,v18,v26
C v56,v18,v19
M v[96:99],a[88:91],a[24:27],v[96:99]
R a[112:115],v2,12288
R a[116:119],v2,13312
M v[96:99],a[92:95],a[28:31],v[96:99]
buffer_load_dwordx4 v3, s[8:11], s21 offen offset:1024 sc1 lds
M v[100:103],a[92:95],a[60:63],0
E v20,v82
M v[100:103],a[88:91],a[56:59],v[100:103]
R a[120:123],v2,14336
R a[124:127],v2,15360
M v[100:103],a[84:87],a[52:55],v[100:103]
E v21,v83
M v[100:103],a[80:83],a[48:51],v[100:103]
buffer_load_dwordx4 v3, s[8:11], s21 offen offset:2048 sc1 lds
M v[100:103],a[76:79],a[44:47],v[100:103]
AF v26,v19,v26
AF v26,v20,v26
M v[100:103],a[72:75],a[40:43],v[100:103]
E v22,v88
M v[100:103],a[68:71],a[36:39],v[100:103]
C v57,v20,v21
AF v26,v21,v26
M v[100:103],a[64:67],a[32:35],v[100:103]
s_waitcnt lgkmcnt(0)
buffer_load_dwordx4 v3, s[8:11], s21 offen offset:3072 sc1 lds
M v[104:107],a[96:99],a[0:3],0
R a[64:67],v2,16384
R a[68:71],v2,17408
M v[104:107],a[100:103],a[4:7],v[104:107]
E v23,v89
M v[104:107],a[104:107],a[8:11],v[104:107]
SA m0,s28,102400
AF v26,v22,v26
C v58,v22,v23
M v[104:107],a[108:111],a[12:15],v[104:107]
R a[72:75],v2,18432
R a[76:79],v2,19456
M v[104:107],a[112:115],a[16:19],v[104:107]
buffer_load_dwordx4 v4, s[8:11], s21 offen offset:0 sc1 lds
M v[104:107],a[116:119],a[20:23],v[104:107]
E v24,v90
M v[104:107],a[120:123],a[24:27],v[104:107]
R a[80:83],v2,20480
R a[84:87],v2,21504
M v[104:107],a[124:127],a[28:31],v[104:107]
E v25,v91
M v[108:111],a[124:127],a[60:63],0
buffer_load_dwordx4 v4, s[8:11], s21 offen offset:1024 sc1 lds
M v[108:111],a[120:123],a[56:59],v[108:111]
R a[88:91],v2,22528
R a[92:95],v2,23552
M v[108:111],a[116:119],a[52:55],v[108:111]
AF v26,v23,v26
AF v26,v24,v26
M v[108:111],a[112:115],a[48:51],v[108:111]
E v18,v84
M v[108:111],a[108:111],a[44:47],v[108:111]
buffer_load_dwordx4 v4, s[8:11], s21 offen offset:2048 sc1 lds
M v[108:111],a[104:107],a[40:43],v[108:111]
C v59,v24,v25
AF v26,v25,v26
M v[108:111],a[100:103],a[36:39],v[108:111]
E v19,v85
M v[108:111],a[96:99],a[32:35],v[108:111]
s_waitcnt lgkmcnt(0)
AF v27,v18,v27
C v60,v18,v19
M v[112:115],a[64:67],a[0:3],0
R a[96:99],v2,24576
R a[100:103],v2,25600
M v[112:115],a[68:71],a[4:7],v[112:115]
buffer_load_dwordx4 v4, s[8:11], s21 offen offset:3072 sc1 lds
M v[112:115],a[72:75],a[8:11],v[112:115]
SA s21,s21,32768
E v20,v86
M v[112:115],a[76:79],a[12:15],v[112:115]
s_sub_u32 s22, s22, 1
R a[104:107],v2,26624
R a[108:111],v2,27648
M v[112:115],a[80:83],a[16:19],v[112:115]
s_cselect_b32 s21, s23, s21
AF v27,v19,v27
C v129,v130,v131
M v[112:115],a[84:87],a[20:23],v[112:115]
SA m0,s28,36864
E v21,v87
M v[112:115],a[88:91],a[24:27],v[112:115]
R a[112:115],v2,28672
R a[116:119],v2,29696
M v[112:115],a[92:95],a[28:31],v[112:115]
buffer_load_dwordx4 v4, s[8:11], s26 offen offset:0 sc1 lds
M v[116:119],a[92:95],a[60:63],0
E v22,v92
M v[116:119],a[88:91],a[56:59],v[116:119]
R a[120:123],v2,30720
R a[124:127],v2,31744
M v[116:119],a[84:87],a[52:55],v[116:119]
AF v27,v20,v27
C v61,v20,v21
M v[116:119],a[80:83],a[48:51],v[116:119]
buffer_load_dwordx4 v4, s[8:11], s26 offen offset:1024 sc1 lds
M v[116:119],a[76:79],a[44:47],v[116:119]
E v23,v93
M v[116:119],a[72:75],a[40:43],v[116:119]
AF v27,v21,v27
AF v27,v22,v27
M v[116:119],a[68:71],a[36:39],v[116:119]
s_waitcnt vmcnt(14) lgkmcnt(0)
C v62,v22,v23
AF v27,v23,v27
M v[116:119],a[64:67],a[32:35],v[116:119]
s_barrier
M v[120:123],a[96:99],a[0:3],0
R a[64:67],v7,0
R a[68:71],v7,1024
M v[120:123],a[100:103],a[4:7],v[120:123]
buffer_load_dwordx4 v4, s[8:11], s26 offen offset:2048 sc1 lds
M v[120:123],a[104:107],a[8:11],v[120:123]
E v24,v94
M v[120:123],a[108:111],a[12:15],v[120:123]
R a[72:75],v7,2048
R a[76:79],v7,3072
M v[120:123],a[112:115],a[16:19],v[120:123]
E v25,v95
M v[120:123],a[116:119],a[20:23],v[120:123]
buffer_load_dwordx4 v4, s[8:11], s26 offen offset:3072 sc1 lds
M v[120:123],a[120:123],a[24:27],v[120:123]
R a[80:83],v7,4096
R a[84:87],v7,5120
M v[120:123],a[124:127],a[28:31],v[120:123]
AF v27,v24,v27
C v63,v24,v25
M v[124:127],a[124:127],a[60:63],0
SA s26,s26,32768
AF v27,v25,v27
C v130,v136,v137
M v[124:127],a[120:123],a[56:59],v[124:127]
R a[88:91],v7,6144
R a[92:95],v7,7168
C v131,v138,v139
W a128,v128
W a129,v129
W a130,v130
W a131,v131
C v144,v144,v145
C v145,v146,v147
C v146,v152,v153
C v147,v154,v155
W a132,v144
W a133,v145
W a134,v146
W a135,v147
C v132,v132,v133
C v133,v134,v135
C v134,v140,v141
C v135,v142,v143
W a160,v132
W a161,v133
W a162,v134
W a163,v135
C v160,v160,v161
C v161,v162,v163
C v162,v168,v169
C v163,v170,v171
W a136,v160
W a137,v161
W a138,v162
W a139,v163
C v148,v148,v149
C v149,v150,v151
C v150,v156,v157
C v151,v158,v159
W a164,v148
W a165,v149
W a166,v150
W a167,v151
C v176,v176,v177
C v177,v178,v179
C v178,v184,v185
C v179,v186,v187
W a140,v176
W a141,v177
W a142,v178
W a143,v179
C v164,v164,v165
C v165,v166,v167
C v166,v172,v173
C v167,v174,v175
W a168,v164
W a169,v165
W a170,v166
W a171,v167
C v192,v192,v193
C v193,v194,v195
C v194,v200,v201
C v195,v202,v203
W a144,v192
W a145,v193
W a146,v194
W a147,v195
C v180,v180,v181
C v181,v182,v183
C v182,v188,v189
C v183,v190,v191
W a172,v180
W a173,v181
W a174,v182
W a175,v183
C v208,v208,v209
C v209,v210,v211
C v210,v216,v217
C v211,v218,v219
W a148,v208
W a149,v209
W a150,v210
W a151,v211
C v196,v196,v197
C v197,v198,v199
C v198,v204,v205
C v199,v206,v207
W a176,v196
W a177,v197
W a178,v198
W a179,v199
C v224,v224,v225
C v225,v226,v227
C v226,v232,v233
C v227,v234,v235
W a152,v224
W a153,v225
W a154,v226
W a155,v227
C v212,v212,v213
C v213,v214,v215
C v214,v220,v221
C v215,v222,v223
W a180,v212
W a181,v213
W a182,v214
W a183,v215
C v240,v240,v241
C v241,v242,v243
C v242,v248,v249
C v243,v250,v251
W a156,v240
W a157,v241
W a158,v242
W a159,v243
C v228,v228,v229
C v229,v230,v231
C v230,v236,v237
C v231,v238,v239
W a184,v228
W a185,v229
W a186,v230
W a187,v231
C v244,v244,v245
C v245,v246,v247
C v246,v252,v253
C v247,v254,v255
W a188,v244
W a189,v245
W a190,v246
W a191,v247
M v[124:127],a[116:119],a[52:55],v[124:127]
M v[124:127],a[112:115],a[48:51],v[124:127]
M v[124:127],a[108:111],a[44:47],v[124:127]
M v[124:127],a[104:107],a[40:43],v[124:127]
M v[124:127],a[100:103],a[36:39],v[124:127]
s_waitcnt lgkmcnt(0)
M v[124:127],a[96:99],a[32:35],v[124:127]
v_max_f32 v10, v26, v27
v_min_f32 v11, v26, v27
v_cmp_lt_f32 vcc, s31, v10
v_cmp_gt_f32 s[64:65], s24, v11
s_nop 0
s_or_b64 vcc, vcc, s[64:65]
s_cbranch_vccnz L_sth1
L_rth1:
M v[128:131],a[64:67],v[40:43],0
R a[96:99],v7,8192
R a[100:103],v7,9216
M v[128:131],a[68:71],v[56:59],v[128:131]
SA m0,s28,65536
E v18,v96
M v[132:135],a[68:71],v[60:63],0
buffer_load_dwordx4 v3, s[8:11], s21 offen offset:0 sc1 lds
M v[132:135],a[64:67],v[44:47],v[132:135]
R a[104:107],v7,10240
R a[108:111],v7,11264
M v[136:139],a[72:75],v[40:43],0
E v19,v97
M v[136:139],a[76:79],v[56:59],v[136:139]
AF v30,v26,v30
AF v31,v27,v31
M v[140:143],a[76:79],v[60:63],0
R a[112:115],v7,12288
R a[116:119],v7,13312
M v[140:143],a[72:75],v[44:47],v[140:143]
buffer_load_dwordx4 v3, s[8:11], s21 offen offset:1024 sc1 lds
M v[144:147],a[80:83],v[40:43],0
E v20,v98
M v[144:147],a[84:87],v[56:59],v[144:147]
R a[120:123],v7,14336
R a[124:127],v7,15360
M v[148:151],a[84:87],v[60:63],0
s_mov_b32 s40, 0
AF v28,v18,v19
C v48,v18,v19
M v[148:151],a[80:83],v[44:47],v[148:151]
s_mov_b32 s7, 0
buffer_load_dwordx4 v3, s[8:11], s21 offen offset:2048 sc1 lds
M v[152:155],a[88:91],v[40:43],0
s_and_b32 s39, s39, 3
E v21,v99
M v[152:155],a[92:95],v[56:59],v[152:155]
s_sub_u32 s27, 5, s42
AF v28,v20,v28
C v49,v20,v21
M v[156:159],a[92:95],v[60:63],0
AF v28,v21,v28
M v[156:159],a[88:91],v[44:47],v[156:159]
s_waitcnt lgkmcnt(0)
buffer_load_dwordx4 v3, s[8:11], s21 offen offset:3072 sc1 lds
M v[160:163],a[96:99],v[40:43],0
SA m0,s28,69632
R a[64:67],v7,16384
R a[68:71],v7,17408
M v[160:163],a[100:103],v[56:59],v[160:163]
E v22,v104
M v[164:167],a[100:103],v[60:63],0
E v23,v105
M v[164:167],a[96:99],v[44:47],v[164:167]
R a[72:75],v7,18432
R a[76:79],v7,19456
M v[168:171],a[104:107],v[40:43],0
buffer_load_dwordx4 v4, s[8:11], s21 offen offset:0 sc1 lds
M v[168:171],a[108:111],v[56:59],v[168:171]
AF v28,v22,v28
C v50,v22,v23
M v[172:175],a[108:111],v[60:63],0
R a[80:83],v7,20480
R a[84:87],v7,21504
M v[172:175],a[104:107],v[44:47],v[172:175]
buffer_load_dwordx4 v4, s[8:11], s21 offen offset:1024 sc1 lds
M v[176:179],a[112:115],v[40:43],0
E v24,v106
M v[176:179],a[116:119],v[56:59],v[176:179]
R a[88:91],v7,22528
R a[92:95],v7,23552
M v[180:183],a[116:119],v[60:63],0
buffer_load_dwordx4 v4, s[8:11], s21 offen offset:2048 sc1 lds
M v[180:183],a[112:115],v[44:47],v[180:183]
E v25,v107
M v[184:187],a[120:123],v[40:43],0
AF v28,v23,v28
AF v28,v24,v28
M v[184:187],a[124:127],v[56:59],v[184:187]
C v51,v24,v25
AF v28,v25,v28
M v[188:191],a[124:127],v[60:63],0
buffer_load_dwordx4 v4, s[8:11], s21 offen offset:3072 sc1 lds
M v[188:191],a[120:123],v[44:47],v[188:191]
s_waitcnt lgkmcnt(0)
E v18,v100
M v[192:195],a[64:67],v[40:43],0
SA s21,s21,32768
R a[96:99],v7,24576
R a[100:103],v7,25600
M v[192:195],a[68:71],v[56:59],v[192:195]
s_sub_u32 s22, s22, 1
E v19,v101
M v[196:199],a[68:71],v[60:63],0
s_cselect_b32 s21, s23, s21
AF v29,v18,v19
C v52,v18,v19
M v[196:199],a[64:67],v[44:47],v[196:199]
R a[104:107],v7,26624
R a[108:111],v7,27648
M v[200:203],a[72:75],v[40:43],0
M v[200:203],a[76:79],v[56:59],v[200:203]
E v20,v102
M v[204:207],a[76:79],v[60:63],0
R a[112:115],v7,28672
R a[116:119],v7,29696
M v[204:207],a[72:75],v[44:47],v[204:207]
M v[208:211],a[80:83],v[40:43],0
M v[208:211],a[84:87],v[56:59],v[208:211]
R a[120:123],v7,30720
R a[124:127],v7,31744
M v[212:215],a[84:87],v[60:63],0
E v21,v103
M v[212:215],a[80:83],v[44:47],v[212:215]
AF v29,v20,v29
C v53,v20,v21
M v[216:219],a[88:91],v[40:43],0
AF v29,v21,v29
M v[216:219],a[92:95],v[56:59],v[216:219]
E v22,v108
M v[220:223],a[92:95],v[60:63],0
s_waitcnt vmcnt(12) lgkmcnt(0)
M v[220:223],a[88:91],v[44:47],v[220:223]
s_barrier
M v[224:227],a[96:99],v[40:43],0
R a[64:67],v2,32768
R a[68:71],v2,33792
M v[224:227],a[100:103],v[56:59],v[224:227]
E v23,v109
M v[228:231],a[100:103],v[60:63],0
AF v29,v22,v29
C v54,v22,v23
M v[228:231],a[96:99],v[44:47],v[228:231]
R a[72:75],v2,34816
R a[76:79],v2,35840
M v[232:235],a[104:107],v[40:43],0
E v24,v110
M v[232:235],a[108:111],v[56:59],v[232:235]
AF v29,v23,v29
M v[236:239],a[108:111],v[60:63],0
R a[80:83],v2,36864
R a[84:87],v2,37888
M v[236:239],a[104:107],v[44:47],v[236:239]
M v[240:243],a[112:115],v[40:43],0
E v25,v111
M v[240:243],a[116:119],v[56:59],v[240:243]
R a[88:91],v2,38912
R a[92:95],v2,39936
M v[244:247],a[116:119],v[60:63],0
AF v29,v24,v29
C v55,v24,v25
M v[244:247],a[112:115],v[44:47],v[244:247]
AF v29,v25,v29
M v[248:251],a[120:123],v[40:43],0
M v[248:251],a[124:127],v[56:59],v[248:251]
M v[252:255],a[124:127],v[60:63],0
s_waitcnt lgkmcnt(0)
M v[252:255],a[120:123],v[44:47],v[252:255]
s_cmp_lg_u32 s27, 0
s_cbranch_scc1 L_loop_top
L_final_h:
s_waitcnt vmcnt(8) lgkmcnt(0)
s_barrier
R a[64:67],v7,32768
R a[68:71],v7,33792
R a[72:75],v7,34816
R a[76:79],v7,35840
R a[80:83],v7,36864
R a[84:87],v7,37888
R a[88:91],v7,38912
R a[92:95],v7,39936
v_lshrrev_b32 v14, 7, v7
v_mul_u32_u24 v14, 896, v14
v_lshrrev_b32 v15, 8, v7
v_lshlrev_b32 v15, 5, v15
v_xor_b32 v15, v15, v7
v_and_b32 v15, 0x70, v15
v_add_u32 v0, v14, v15
s_mul_i32 s38, s20, 57344
SA m0,s28,98304
SA s85,s38,0
E v18,v112
buffer_load_dwordx4 v0, s[12:15], s85 offen offset:0 lds
E v19,v113
E v20,v114
AF v28,v18,v28
SA s85,s38,6144
C v56,v18,v19
buffer_load_dwordx4 v0, s[12:15], s85 offen offset:1024 lds
E v21,v115
AF v28,v19,v28
E v22,v120
AF v28,v20,v28
SA s85,s38,12288
C v57,v20,v21
buffer_load_dwordx4 v0, s[12:15], s85 offen offset:2048 lds
E v23,v121
AF v28,v21,v28
E v24,v122
AF v28,v22,v28
SA s85,s38,18432
C v58,v22,v23
buffer_load_dwordx4 v0, s[12:15], s85 offen offset:3072 lds
E v25,v123
AF v28,v23,v28
E v18,v116
AF v28,v24,v28
SA m0,s28,102400
SA s85,s38,28672
C v59,v24,v25
buffer_load_dwordx4 v0, s[12:15], s85 offen offset:0 lds
E v19,v117
AF v28,v25,v28
E v20,v118
AF v29,v18,v29
SA s85,s38,34816
C v60,v18,v19
buffer_load_dwordx4 v0, s[12:15], s85 offen offset:1024 lds
E v21,v119
AF v29,v19,v29
E v22,v124
AF v29,v20,v29
SA s85,s38,40960
C v61,v20,v21
buffer_load_dwordx4 v0, s[12:15], s85 offen offset:2048 lds
E v23,v125
AF v29,v21,v29
E v24,v126
AF v29,v22,v29
SA s85,s38,47104
C v62,v22,v23
buffer_load_dwordx4 v0, s[12:15], s85 offen offset:3072 lds
SA s38,s38,128
E v25,v127
AF v29,v23,v29
AF v29,v24,v29
C v63,v24,v25
AF v29,v25,v29
v_max_f32 v10, v28, v29
v_cmp_lt_f32 vcc, s31, v10
s_nop 0
s_cbranch_vccnz L_stfh
L_rtfh:
AF v30,v28,v30
AF v31,v29,v31
v_mov_b32 v10, v32
v_mov_b32 v11, v36
v_mov_b32 v12, v30
v_mov_b32 v13, v31
buffer_store_dwordx4 v[10:13], v7, s[8:11], s90 offen sc1
s_waitcnt lgkmcnt(0)
M v[128:131],a[64:67],v[48:51],v[128:131]
SA m0,s28,65536
R a[96:99],v7,40960
R a[100:103],v7,41984
M v[128:131],a[68:71],v[56:59],v[128:131]
SA s85,s38,0
buffer_load_dwordx4 v0, s[12:15], s85 offen offset:0 lds
M v[132:135],a[68:71],v[60:63],v[132:135]
SA s85,s38,6144
v_lshrrev_b32 v16, 4, v7
v_lshrrev_b32 v14, 2, v16
M v[132:135],a[64:67],v[52:55],v[132:135]
R a[104:107],v7,43008
R a[108:111],v7,44032
M v[136:139],a[72:75],v[48:51],v[136:139]
buffer_load_dwordx4 v0, s[12:15], s85 offen offset:1024 lds
M v[136:139],a[76:79],v[56:59],v[136:139]
SA s85,s38,12288
v_lshlrev_b32 v14, 7, v14
v_and_b32 v15, 3, v16
M v[140:143],a[76:79],v[60:63],v[140:143]
R a[112:115],v7,45056
R a[116:119],v7,46080
M v[140:143],a[72:75],v[52:55],v[140:143]
buffer_load_dwordx4 v0, s[12:15], s85 offen offset:2048 lds
M v[144:147],a[80:83],v[48:51],v[144:147]
SA s85,s38,18432
v_lshl_add_u32 v14, v15, 3, v14
v_bfe_u32 v15, v16, 3, 2
M v[144:147],a[84:87],v[56:59],v[144:147]
R a[120:123],v7,47104
R a[124:127],v7,48128
M v[148:151],a[84:87],v[60:63],v[148:151]
buffer_load_dwordx4 v0, s[12:15], s85 offen offset:3072 lds
M v[148:151],a[80:83],v[52:55],v[148:151]
v_lshl_add_u32 v18, v15, 5, v14
v_xor_b32 v19, 32, v18
M v[152:155],a[88:91],v[48:51],v[152:155]
v_xor_b32 v20, 64, v18
v_xor_b32 v21, 0x60, v18
M v[152:155],a[92:95],v[56:59],v[152:155]
v_add_u32 v22, 0x10000, v18
v_add_u32 v23, 0x10000, v19
M v[156:159],a[92:95],v[60:63],v[156:159]
v_add_u32 v24, 0x10000, v20
v_add_u32 v25, 0x10000, v21
M v[156:159],a[88:91],v[52:55],v[156:159]
s_waitcnt lgkmcnt(0)
C v128,v128,v129
C v129,v130,v131
M v[160:163],a[96:99],v[48:51],v[160:163]
R a[64:67],v7,49152
R a[68:71],v7,50176
M v[160:163],a[100:103],v[56:59],v[160:163]
C v130,v136,v137
C v131,v138,v139
M v[164:167],a[100:103],v[60:63],v[164:167]
buffer_store_dwordx4 v[128:131], v7, s[8:11], s86 offen offset:0 sc1
M v[164:167],a[96:99],v[52:55],v[164:167]
R a[72:75],v7,51200
R a[76:79],v7,52224
M v[168:171],a[104:107],v[48:51],v[168:171]
C v132,v132,v133
C v133,v134,v135
M v[168:171],a[108:111],v[56:59],v[168:171]
C v134,v140,v141
C v135,v142,v143
M v[172:175],a[108:111],v[60:63],v[172:175]
R a[80:83],v7,53248
R a[84:87],v7,54272
M v[172:175],a[104:107],v[52:55],v[172:175]
buffer_store_dwordx4 v[132:135], v7, s[8:11], s88 offen offset:0 sc1
M v[176:179],a[112:115],v[48:51],v[176:179]
C v144,v144,v145
C v145,v146,v147
M v[176:179],a[116:119],v[56:59],v[176:179]
R a[88:91],v7,55296
R a[92:95],v7,56320
M v[180:183],a[116:119],v[60:63],v[180:183]
C v146,v152,v153
C v147,v154,v155
M v[180:183],a[112:115],v[52:55],v[180:183]
buffer_store_dwordx4 v[144:147], v7, s[8:11], s86 offen offset:1024 sc1
M v[184:187],a[120:123],v[48:51],v[184:187]
C v148,v148,v149
C v149,v150,v151
M v[184:187],a[124:127],v[56:59],v[184:187]
C v150,v156,v157
C v151,v158,v159
M v[188:191],a[124:127],v[60:63],v[188:191]
buffer_store_dwordx4 v[148:151], v7, s[8:11], s88 offen offset:1024 sc1
M v[188:191],a[120:123],v[52:55],v[188:191]
s_waitcnt lgkmcnt(0)
C v160,v160,v161
C v161,v162,v163
M v[192:195],a[64:67],v[48:51],v[192:195]
R a[96:99],v7,57344
R a[100:103],v7,58368
M v[192:195],a[68:71],v[56:59],v[192:195]
C v162,v168,v169
C v163,v170,v171
M v[196:199],a[68:71],v[60:63],v[196:199]
buffer_store_dwordx4 v[160:163], v7, s[8:11], s86 offen offset:2048 sc1
M v[196:199],a[64:67],v[52:55],v[196:199]
R a[104:107],v7,59392
R a[108:111],v7,60416
M v[200:203],a[72:75],v[48:51],v[200:203]
C v164,v164,v165
C v165,v166,v167
M v[200:203],a[76:79],v[56:59],v[200:203]
C v166,v172,v173
C v167,v174,v175
M v[204:207],a[76:79],v[60:63],v[204:207]
R a[112:115],v7,61440
R a[116:119],v7,62464
M v[204:207],a[72:75],v[52:55],v[204:207]
buffer_store_dwordx4 v[164:167], v7, s[8:11], s88 offen offset:2048 sc1
M v[208:211],a[80:83],v[48:51],v[208:211]
C v176,v176,v177
C v177,v178,v179
M v[208:211],a[84:87],v[56:59],v[208:211]
R a[120:123],v7,63488
R a[124:127],v7,64512
M v[212:215],a[84:87],v[60:63],v[212:215]
C v178,v184,v185
C v179,v186,v187
M v[212:215],a[80:83],v[52:55],v[212:215]
buffer_store_dwordx4 v[176:179], v7, s[8:11], s86 offen offset:3072 sc1
M v[216:219],a[88:91],v[48:51],v[216:219]
C v180,v180,v181
C v181,v182,v183
M v[216:219],a[92:95],v[56:59],v[216:219]
C v182,v188,v189
C v183,v190,v191
M v[220:223],a[92:95],v[60:63],v[220:223]
s_waitcnt vmcnt(12) lgkmcnt(0)
buffer_store_dwordx4 v[180:183], v7, s[8:11], s88 offen offset:3072 sc1
M v[220:223],a[88:91],v[52:55],v[220:223]
s_barrier
M v[224:227],a[96:99],v[48:51],v[224:227]
s_nop 0
T a[64:65],v22,32768
T a[66:67],v22,34816
M v[224:227],a[100:103],v[56:59],v[224:227]
T a[68:69],v22,36864
T a[70:71],v22,38912
M v[228:231],a[100:103],v[60:63],v[228:231]
C v192,v192,v193
C v193,v194,v195
M v[228:231],a[96:99],v[52:55],v[228:231]
T a[72:73],v22,40960
T a[74:75],v22,43008
M v[232:235],a[104:107],v[48:51],v[232:235]
T a[76:77],v22,45056
T a[78:79],v22,47104
M v[232:235],a[108:111],v[56:59],v[232:235]
C v194,v200,v201
C v195,v202,v203
M v[236:239],a[108:111],v[60:63],v[236:239]
T a[80:81],v22,49152
T a[82:83],v22,51200
M v[236:239],a[104:107],v[52:55],v[236:239]
T a[84:85],v22,53248
T a[86:87],v22,55296
M v[240:243],a[112:115],v[48:51],v[240:243]
buffer_store_dwordx4 v[192:195], v7, s[8:11], s87 offen offset:0 sc1
M v[240:243],a[116:119],v[56:59],v[240:243]
s_nop 0
T a[88:89],v22,57344
T a[90:91],v22,59392
M v[244:247],a[116:119],v[60:63],v[244:247]
T a[92:93],v22,61440
T a[94:95],v22,63488
M v[244:247],a[112:115],v[52:55],v[244:247]
C v196,v196,v197
C v197,v198,v199
M v[248:251],a[120:123],v[48:51],v[248:251]
C v198,v204,v205
C v199,v206,v207
M v[248:251],a[124:127],v[56:59],v[248:251]
buffer_store_dwordx4 v[196:199], v7, s[8:11], s89 offen offset:0 sc1
M v[252:255],a[124:127],v[60:63],v[252:255]
s_waitcnt lgkmcnt(0)
C v208,v208,v209
C v209,v210,v211
M v[252:255],a[120:123],v[52:55],v[252:255]
C v210,v216,v217
C v211,v218,v219
buffer_store_dwordx4 v[208:211], v7, s[8:11], s87 offen offset:1024 sc1
C v212,v212,v213
C v213,v214,v215
C v214,v220,v221
C v215,v222,v223
buffer_store_dwordx4 v[212:215], v7, s[8:11], s89 offen offset:1024 sc1
C v224,v224,v225
C v225,v226,v227
C v226,v232,v233
C v227,v234,v235
buffer_store_dwordx4 v[224:227], v7, s[8:11], s87 offen offset:2048 sc1
C v228,v228,v229
C v229,v230,v231
C v230,v236,v237
C v231,v238,v239
buffer_store_dwordx4 v[228:231], v7, s[8:11], s89 offen offset:2048 sc1
C v240,v240,v241
C v241,v242,v243
C v242,v248,v249
C v243,v250,v251
buffer_store_dwordx4 v[240:243], v7, s[8:11], s87 offen offset:3072 sc1
C v244,v244,v245
C v245,v246,v247
C v246,v252,v253
C v247,v254,v255
buffer_store_dwordx4 v[244:247], v7, s[8:11], s89 offen offset:3072 sc1
M v[64:67],a[64:67],a[128:131],0
s_nop 0
T a[96:97],v23,32768
T a[98:99],v23,34816
M v[64:67],a[68:71],a[132:135],v[64:67]
SA m0,s28,69632
T a[100:101],v23,36864
T a[102:103],v23,38912
M v[64:67],a[72:75],a[136:139],v[64:67]
SA s85,s38,28672
buffer_load_dwordx4 v0, s[12:15], s85 offen offset:0 lds
M v[64:67],a[76:79],a[140:143],v[64:67]
SA s85,s38,34816
T a[104:105],v23,40960
T a[106:107],v23,43008
M v[64:67],a[80:83],a[144:147],v[64:67]
SA s29,s33,0
T a[108:109],v23,45056
T a[110:111],v23,47104
M v[64:67],a[84:87],a[148:151],v[64:67]
SA s30,s33,14336
buffer_load_dwordx4 v0, s[12:15], s85 offen offset:1024 lds
M v[64:67],a[88:91],a[152:155],v[64:67]
SA s85,s38,40960
T a[112:113],v23,49152
T a[114:115],v23,51200
M v[64:67],a[92:95],a[156:159],v[64:67]
T a[116:117],v23,53248
T a[118:119],v23,55296
M v[68:71],a[92:95],a[188:191],0
buffer_load_dwordx4 v0, s[12:15], s85 offen offset:2048 lds
M v[68:71],a[88:91],a[184:187],v[68:71]
SA s85,s38,47104
T a[120:121],v23,57344
T a[122:123],v23,59392
M v[68:71],a[84:87],a[180:183],v[68:71]
T a[124:125],v23,61440
T a[126:127],v23,63488
M v[68:71],a[80:83],a[176:179],v[68:71]
buffer_load_dwordx4 v0, s[12:15], s85 offen offset:3072 lds
M v[68:71],a[76:79],a[172:175],v[68:71]
SA s38,s38,128
G v5,a192
G v6,a193
M v[68:71],a[72:75],a[168:171],v[68:71]
s_sub_u32 s64, 15, s42
M v[68:71],a[68:71],a[164:167],v[68:71]
s_min_u32 s64, s64, s42
M v[68:71],a[64:67],a[160:163],v[68:71]
s_waitcnt lgkmcnt(0)
M v[72:75],a[96:99],a[128:131],0
s_mul_i32 s45, s64, 8704
T a[64:65],v24,32768
T a[66:67],v24,34816
M v[72:75],a[100:103],a[132:135],v[72:75]
s_lshl_b32 s64, s41, 2
T a[68:69],v24,36864
T a[70:71],v24,38912
M v[72:75],a[104:107],a[136:139],v[72:75]
SA s45,s45,s64
M v[72:75],a[108:111],a[140:143],v[72:75]
s_lshl_b32 s64, s20, 8
T a[72:73],v24,40960
T a[74:75],v24,43008
M v[72:75],a[112:115],a[144:147],v[72:75]
SA s45,s45,s64
T a[76:77],v24,45056
T a[78:79],v24,47104
M v[72:75],a[116:119],a[148:151],v[72:75]
SA s45,s45,104992768
M v[72:75],a[120:123],a[152:155],v[72:75]
s_mov_b32 s64, 1024
T a[80:81],v24,49152
T a[82:83],v24,51200
M v[72:75],a[124:127],a[156:159],v[72:75]
s_mov_b32 s66, 4096
T a[84:85],v24,53248
T a[86:87],v24,55296
M v[76:79],a[124:127],a[188:191],0
s_cmp_lt_u32 s42, 8
M v[76:79],a[120:123],a[184:187],v[76:79]
s_cselect_b32 s64, 4352, s64
T a[88:89],v24,57344
T a[90:91],v24,59392
M v[76:79],a[116:119],a[180:183],v[76:79]
s_cselect_b32 s65, 0, 64
T a[92:93],v24,61440
T a[94:95],v24,63488
M v[76:79],a[112:115],a[176:179],v[76:79]
s_cselect_b32 s66, 536870912, s66
MF v64,v5,v64
MF v65,v5,v65
M v[76:79],a[108:111],a[172:175],v[76:79]
SA s3,s45,s64
MF v66,v5,v66
MF v67,v5,v67
M v[76:79],a[104:107],a[168:171],v[76:79]
SA s45,s45,s65
v_lshrrev_b32 v17, 5, v7
v_min_u32 v15, 1, v17
M v[76:79],a[100:103],a[164:167],v[76:79]
SA m0,s28,0
v_lshlrev_b32 v14, 3, v7
v_lshl_or_b32 v16, v15, 29, v14
M v[76:79],a[96:99],a[160:163],v[76:79]
s_waitcnt lgkmcnt(0)
v_cmp_eq_u32 vcc, 1, v17
v_add_u32 v14, s66, v14
M v[80:83],a[64:67],a[128:131],0
SA s85,s38,0
T a[96:97],v25,32768
T a[98:99],v25,34816
M v[80:83],a[68:71],a[132:135],v[80:83]
T a[100:101],v25,36864
T a[102:103],v25,38912
M v[80:83],a[72:75],a[136:139],v[80:83]
buffer_load_dwordx4 v0, s[12:15], s85 offen offset:0 lds
M v[80:83],a[76:79],a[140:143],v[80:83]
SA s85,s38,6144
T a[104:105],v25,40960
T a[106:107],v25,43008
M v[80:83],a[80:83],a[144:147],v[80:83]
T a[108:109],v25,45056
T a[110:111],v25,47104
M v[80:83],a[84:87],a[148:151],v[80:83]
buffer_load_dwordx4 v0, s[12:15], s85 offen offset:1024 lds
M v[80:83],a[88:91],a[152:155],v[80:83]
SA s85,s38,12288
T a[112:113],v25,49152
T a[114:115],v25,51200
M v[80:83],a[92:95],a[156:159],v[80:83]
T a[116:117],v25,53248
T a[118:119],v25,55296
M v[84:87],a[92:95],a[188:191],0
buffer_load_dwordx4 v0, s[12:15], s85 offen offset:2048 lds
M v[84:87],a[88:91],a[184:187],v[84:87]
SA s85,s38,18432
T a[120:121],v25,57344
T a[122:123],v25,59392
M v[84:87],a[84:87],a[180:183],v[84:87]
T a[124:125],v25,61440
T a[126:127],v25,63488
M v[84:87],a[80:83],a[176:179],v[84:87]
buffer_load_dwordx4 v0, s[12:15], s85 offen offset:3072 lds
M v[84:87],a[76:79],a[172:175],v[84:87]
SA m0,s28,4096
v_mov_b32 v15, 1
v_cndmask_b32 v17, v16, v14, vcc
M v[84:87],a[72:75],a[168:171],v[84:87]
SA s85,s38,28672
buffer_load_dwordx4 v0, s[12:15], s85 offen offset:0 lds
M v[84:87],a[68:71],a[164:167],v[84:87]
s_waitcnt vmcnt(5) lgkmcnt(0)
v_min_u32 v10, 1, v7
v_lshlrev_b32 v10, 29, v10
M v[84:87],a[64:67],a[160:163],v[84:87]
s_barrier
M v[88:91],a[96:99],a[128:131],0
SA s85,s38,34816
T a[64:65],v22,0
T a[66:67],v22,2048
M v[88:91],a[100:103],a[132:135],v[88:91]
T a[68:69],v22,4096
T a[70:71],v22,6144
M v[88:91],a[104:107],a[136:139],v[88:91]
buffer_load_dwordx4 v0, s[12:15], s85 offen offset:1024 lds
M v[88:91],a[108:111],a[140:143],v[88:91]
SA s85,s38,40960
T a[72:73],v22,8192
T a[74:75],v22,10240
M v[88:91],a[112:115],a[144:147],v[88:91]
T a[76:77],v22,12288
T a[78:79],v22,14336
M v[88:91],a[116:119],a[148:151],v[88:91]
buffer_load_dwordx4 v0, s[12:15], s85 offen offset:2048 lds
M v[88:91],a[120:123],a[152:155],v[88:91]
SA s85,s38,47104
T a[80:81],v22,16384
T a[82:83],v22,18432
M v[88:91],a[124:127],a[156:159],v[88:91]
T a[84:85],v22,20480
T a[86:87],v22,22528
M v[92:95],a[124:127],a[188:191],0
buffer_store_dword v15, v10, s[8:11], s47 offen sc1
M v[92:95],a[120:123],a[184:187],v[92:95]
s_nop 0
T a[88:89],v22,24576
T a[90:91],v22,26624
M v[92:95],a[116:119],a[180:183],v[92:95]
T a[92:93],v22,28672
T a[94:95],v22,30720
M v[92:95],a[112:115],a[176:179],v[92:95]
buffer_load_dwordx4 v0, s[12:15], s85 offen offset:3072 lds
M v[92:95],a[108:111],a[172:175],v[92:95]
SA s38,s38,128
MF v72,v5,v72
MF v73,v5,v73
M v[92:95],a[104:107],a[168:171],v[92:95]
SA m0,s28,131072
MF v74,v5,v74
MF v75,v5,v75
M v[92:95],a[100:103],a[164:167],v[92:95]
s_waitcnt lgkmcnt(0)
C v64,v64,v65
C v65,v66,v67
M v[92:95],a[96:99],a[160:163],v[92:95]
SA s85,s38,0
C v66,v72,v73
C v67,v74,v75
buffer_store_dwordx4 v[64:67], v7, s[8:11], s29 offen offset:0 sc1
buffer_load_dwordx4 v0, s[12:15], s85 offen offset:0 lds
v_add_u32 v40, 0x20000, v18
v_add_u32 v41, 0x20000, v19
v_add_u32 v42, 0x20000, v20
v_add_u32 v43, 0x20000, v21
SA s85,s38,6144
MF v68,v6,v68
MF v69,v6,v69
MF v70,v6,v70
MF v71,v6,v71
MF v76,v6,v76
MF v77,v6,v77
MF v78,v6,v78
MF v79,v6,v79
C v68,v68,v69
C v69,v70,v71
C v70,v76,v77
C v71,v78,v79
buffer_store_dwordx4 v[68:71], v7, s[8:11], s30 offen offset:0 sc1
buffer_load_dwordx4 v0, s[12:15], s85 offen offset:1024 lds
SA s85,s38,12288
buffer_load_dwordx4 v0, s[12:15], s85 offen offset:2048 lds
SA s85,s38,18432
buffer_load_dwordx4 v0, s[12:15], s85 offen offset:3072 lds
M v[96:99],a[64:67],a[128:131],0
s_nop 0
T a[96:97],v23,0
T a[98:99],v23,2048
M v[96:99],a[68:71],a[132:135],v[96:99]
SA m0,s28,135168
T a[100:101],v23,4096
T a[102:103],v23,6144
M v[96:99],a[72:75],a[136:139],v[96:99]
SA s85,s38,28672
buffer_load_dwordx4 v0, s[12:15], s85 offen offset:0 lds
M v[96:99],a[76:79],a[140:143],v[96:99]
SA s85,s38,34816
T a[104:105],v23,8192
T a[106:107],v23,10240
M v[96:99],a[80:83],a[144:147],v[96:99]
T a[108:109],v23,12288
T a[110:111],v23,14336
M v[96:99],a[84:87],a[148:151],v[96:99]
buffer_load_dwordx4 v0, s[12:15], s85 offen offset:1024 lds
M v[96:99],a[88:91],a[152:155],v[96:99]
SA s85,s38,40960
T a[112:113],v23,16384
T a[114:115],v23,18432
M v[96:99],a[92:95],a[156:159],v[96:99]
T a[116:117],v23,20480
T a[118:119],v23,22528
M v[100:103],a[92:95],a[188:191],0
buffer_load_dwordx4 v0, s[12:15], s85 offen offset:2048 lds
M v[100:103],a[88:91],a[184:187],v[100:103]
SA s85,s38,47104
T a[120:121],v23,24576
T a[122:123],v23,26624
M v[100:103],a[84:87],a[180:183],v[100:103]
T a[124:125],v23,28672
T a[126:127],v23,30720
M v[100:103],a[80:83],a[176:179],v[100:103]
buffer_load_dwordx4 v0, s[12:15], s85 offen offset:3072 lds
M v[100:103],a[76:79],a[172:175],v[100:103]
SA s38,s38,128
MF v80,v5,v80
MF v81,v5,v81
M v[100:103],a[72:75],a[168:171],v[100:103]
SA m0,s28,32768
MF v82,v5,v82
MF v83,v5,v83
M v[100:103],a[68:71],a[164:167],v[100:103]
SA s85,s38,0
buffer_load_dwordx4 v0, s[12:15], s85 offen offset:0 lds
M v[100:103],a[64:67],a[160:163],v[100:103]
s_waitcnt lgkmcnt(0)
MF v88,v5,v88
MF v89,v5,v89
M v[104:107],a[96:99],a[128:131],0
SA s85,s38,6144
T a[64:65],v24,0
T a[66:67],v24,2048
M v[104:107],a[100:103],a[132:135],v[104:107]
T a[68:69],v24,4096
T a[70:71],v24,6144
M v[104:107],a[104:107],a[136:139],v[104:107]
buffer_load_dwordx4 v0, s[12:15], s85 offen offset:1024 lds
M v[104:107],a[108:111],a[140:143],v[104:107]
SA s85,s38,12288
T a[72:73],v24,8192
T a[74:75],v24,10240
M v[104:107],a[112:115],a[144:147],v[104:107]
T a[76:77],v24,12288
T a[78:79],v24,14336
M v[104:107],a[116:119],a[148:151],v[104:107]
buffer_load_dwordx4 v0, s[12:15], s85 offen offset:2048 lds
M v[104:107],a[120:123],a[152:155],v[104:107]
SA s85,s38,18432
T a[80:81],v24,16384
T a[82:83],v24,18432
M v[104:107],a[124:127],a[156:159],v[104:107]
T a[84:85],v24,20480
T a[86:87],v24,22528
M v[108:111],a[124:127],a[188:191],0
buffer_load_dwordx4 v0, s[12:15], s85 offen offset:3072 lds
M v[108:111],a[120:123],a[184:187],v[108:111]
SA m0,s28,36864
T a[88:89],v24,24576
T a[90:91],v24,26624
M v[108:111],a[116:119],a[180:183],v[108:111]
SA s85,s38,28672
T a[92:93],v24,28672
T a[94:95],v24,30720
M v[108:111],a[112:115],a[176:179],v[108:111]
buffer_load_dwordx4 v0, s[12:15], s85 offen offset:0 lds
M v[108:111],a[108:111],a[172:175],v[108:111]
SA s85,s38,34816
MF v90,v5,v90
MF v91,v5,v91
M v[108:111],a[104:107],a[168:171],v[108:111]
C v80,v80,v81
C v81,v82,v83
M v[108:111],a[100:103],a[164:167],v[108:111]
buffer_load_dwordx4 v0, s[12:15], s85 offen offset:1024 lds
M v[108:111],a[96:99],a[160:163],v[108:111]
s_waitcnt lgkmcnt(0)
C v82,v88,v89
C v83,v90,v91
M v[112:115],a[64:67],a[128:131],0
SA s85,s38,40960
T a[96:97],v25,0
T a[98:99],v25,2048
M v[112:115],a[68:71],a[132:135],v[112:115]
T a[100:101],v25,4096
T a[102:103],v25,6144
M v[112:115],a[72:75],a[136:139],v[112:115]
buffer_store_dwordx4 v[80:83], v7, s[8:11], s29 offen offset:1024 sc1
M v[112:115],a[76:79],a[140:143],v[112:115]
s_nop 0
T a[104:105],v25,8192
T a[106:107],v25,10240
M v[112:115],a[80:83],a[144:147],v[112:115]
T a[108:109],v25,12288
T a[110:111],v25,14336
M v[112:115],a[84:87],a[148:151],v[112:115]
buffer_load_dwordx4 v0, s[12:15], s85 offen offset:2048 lds
M v[112:115],a[88:91],a[152:155],v[112:115]
SA s85,s38,47104
T a[112:113],v25,16384
T a[114:115],v25,18432
M v[112:115],a[92:95],a[156:159],v[112:115]
T a[116:117],v25,20480
T a[118:119],v25,22528
M v[116:119],a[92:95],a[188:191],0
buffer_load_dwordx4 v0, s[12:15], s85 offen offset:3072 lds
M v[116:119],a[88:91],a[184:187],v[116:119]
SA s38,s38,128
T a[120:121],v25,24576
T a[122:123],v25,26624
M v[116:119],a[84:87],a[180:183],v[116:119]
SA m0,s28,98304
T a[124:125],v25,28672
T a[126:127],v25,30720
M v[116:119],a[80:83],a[176:179],v[116:119]
SA s85,s38,0
buffer_load_dwordx4 v0, s[12:15], s85 offen offset:0 lds
M v[116:119],a[76:79],a[172:175],v[116:119]
SA s85,s38,6144
MF v84,v6,v84
MF v85,v6,v85
M v[116:119],a[72:75],a[168:171],v[116:119]
buffer_load_dwordx4 v0, s[12:15], s85 offen offset:1024 lds
M v[116:119],a[68:71],a[164:167],v[116:119]
s_waitcnt vmcnt(21) lgkmcnt(0)
MF v86,v6,v86
MF v87,v6,v87
M v[116:119],a[64:67],a[160:163],v[116:119]
s_barrier
M v[120:123],a[96:99],a[128:131],0
SA s85,s38,12288
T a[64:65],v18,0
T a[66:67],v18,2048
M v[120:123],a[100:103],a[132:135],v[120:123]
T a[68:69],v18,4096
T a[70:71],v18,6144
M v[120:123],a[104:107],a[136:139],v[120:123]
buffer_load_dwordx4 v0, s[12:15], s85 offen offset:2048 lds
M v[120:123],a[108:111],a[140:143],v[120:123]
SA s85,s38,18432
T a[72:73],v18,8192
T a[74:75],v18,10240
M v[120:123],a[112:115],a[144:147],v[120:123]
T a[76:77],v18,12288
T a[78:79],v18,14336
M v[120:123],a[116:119],a[148:151],v[120:123]
buffer_load_dwordx4 v0, s[12:15], s85 offen offset:3072 lds
M v[120:123],a[120:123],a[152:155],v[120:123]
s_nop 0
T a[80:81],v18,16384
T a[82:83],v18,18432
M v[120:123],a[124:127],a[156:159],v[120:123]
T a[84:85],v18,20480
T a[86:87],v18,22528
M v[124:127],a[124:127],a[188:191],0
MF v92,v6,v92
MF v93,v6,v93
M v[124:127],a[120:123],a[184:187],v[124:127]
T a[88:89],v18,24576
T a[90:91],v18,26624
M v[124:127],a[116:119],a[180:183],v[124:127]
T a[92:93],v18,28672
T a[94:95],v18,30720
M v[124:127],a[112:115],a[176:179],v[124:127]
MF v94,v6,v94
MF v95,v6,v95
M v[124:127],a[108:111],a[172:175],v[124:127]
C v84,v84,v85
C v85,v86,v87
M v[124:127],a[104:107],a[168:171],v[124:127]
C v86,v92,v93
C v87,v94,v95
M v[124:127],a[100:103],a[164:167],v[124:127]
s_waitcnt lgkmcnt(0)
buffer_store_dwordx4 v[84:87], v7, s[8:11], s30 offen offset:1024 sc1
M v[124:127],a[96:99],a[160:163],v[124:127]
SA s29,s33,2048
SA s30,s33,16384
MF v96,v5,v96
MF v97,v5,v97
MF v98,v5,v98
MF v99,v5,v99
MF v104,v5,v104
MF v105,v5,v105
MF v106,v5,v106
MF v107,v5,v107
C v96,v96,v97
C v97,v98,v99
C v98,v104,v105
C v99,v106,v107
buffer_store_dwordx4 v[96:99], v7, s[8:11], s29 offen offset:0 sc1
MF v100,v6,v100
MF v101,v6,v101
MF v102,v6,v102
MF v103,v6,v103
MF v108,v6,v108
MF v109,v6,v109
MF v110,v6,v110
MF v111,v6,v111
C v100,v100,v101
C v101,v102,v103
C v102,v108,v109
C v103,v110,v111
buffer_store_dwordx4 v[100:103], v7, s[8:11], s30 offen offset:0 sc1
M v[64:67],a[64:67],a[128:131],0
s_nop 0
T a[96:97],v19,0
T a[98:99],v19,2048
M v[64:67],a[68:71],a[132:135],v[64:67]
SA m0,s28,102400
T a[100:101],v19,4096
T a[102:103],v19,6144
M v[64:67],a[72:75],a[136:139],v[64:67]
SA s85,s38,28672
buffer_load_dwordx4 v0, s[12:15], s85 offen offset:0 lds
M v[64:67],a[76:79],a[140:143],v[64:67]
SA s85,s38,34816
T a[104:105],v19,8192
T a[106:107],v19,10240
M v[64:67],a[80:83],a[144:147],v[64:67]
T a[108:109],v19,12288
T a[110:111],v19,14336
M v[64:67],a[84:87],a[148:151],v[64:67]
buffer_load_dwordx4 v0, s[12:15], s85 offen offset:1024 lds
M v[64:67],a[88:91],a[152:155],v[64:67]
s_nop 0
T a[112:113],v19,16384
T a[114:115],v19,18432
M v[64:67],a[92:95],a[156:159],v[64:67]
SA s85,s38,40960
T a[116:117],v19,20480
T a[118:119],v19,22528
M v[68:71],a[92:95],a[188:191],0
buffer_load_dwordx4 v0, s[12:15], s85 offen offset:2048 lds
M v[68:71],a[88:91],a[184:187],v[68:71]
s_nop 0
T a[120:121],v19,24576
T a[122:123],v19,26624
M v[68:71],a[84:87],a[180:183],v[68:71]
T a[124:125],v19,28672
T a[126:127],v19,30720
M v[68:71],a[80:83],a[176:179],v[68:71]
SA s85,s38,47104
MF v112,v5,v112
MF v113,v5,v113
M v[68:71],a[76:79],a[172:175],v[68:71]
buffer_load_dwordx4 v0, s[12:15], s85 offen offset:3072 lds
M v[68:71],a[72:75],a[168:171],v[68:71]
SA s38,s38,128
MF v114,v5,v114
MF v115,v5,v115
M v[68:71],a[68:71],a[164:167],v[68:71]
SA m0,s28,65536
MF v120,v5,v120
MF v121,v5,v121
M v[68:71],a[64:67],a[160:163],v[68:71]
s_waitcnt lgkmcnt(0)
MF v122,v5,v122
MF v123,v5,v123
M v[72:75],a[96:99],a[128:131],0
SA s85,s38,0
T a[64:65],v20,0
T a[66:67],v20,2048
M v[72:75],a[100:103],a[132:135],v[72:75]
T a[68:69],v20,4096
T a[70:71],v20,6144
M v[72:75],a[104:107],a[136:139],v[72:75]
buffer_load_dwordx4 v0, s[12:15], s85 offen offset:0 lds
M v[72:75],a[108:111],a[140:143],v[72:75]
SA s85,s38,6144
T a[72:73],v20,8192
T a[74:75],v20,10240
M v[72:75],a[112:115],a[144:147],v[72:75]
T a[76:77],v20,12288
T a[78:79],v20,14336
M v[72:75],a[116:119],a[148:151],v[72:75]
buffer_load_dwordx4 v0, s[12:15], s85 offen offset:1024 lds
M v[72:75],a[120:123],a[152:155],v[72:75]
SA s85,s38,12288
T a[80:81],v20,16384
T a[82:83],v20,18432
M v[72:75],a[124:127],a[156:159],v[72:75]
T a[84:85],v20,20480
T a[86:87],v20,22528
M v[76:79],a[124:127],a[188:191],0
buffer_load_dwordx4 v0, s[12:15], s85 offen offset:2048 lds
M v[76:79],a[120:123],a[184:187],v[76:79]
SA s85,s38,18432
T a[88:89],v20,24576
T a[90:91],v20,26624
M v[76:79],a[116:119],a[180:183],v[76:79]
T a[92:93],v20,28672
T a[94:95],v20,30720
M v[76:79],a[112:115],a[176:179],v[76:79]
buffer_load_dwordx4 v0, s[12:15], s85 offen offset:3072 lds
M v[76:79],a[108:111],a[172:175],v[76:79]
SA m0,s28,69632
C v112,v112,v113
C v113,v114,v115
M v[76:79],a[104:107],a[168:171],v[76:79]
SA s85,s38,28672
C v114,v120,v121
C v115,v122,v123
M v[76:79],a[100:103],a[164:167],v[76:79]
buffer_store_dwordx4 v[112:115], v7, s[8:11], s29 offen offset:1024 sc1
M v[76:79],a[96:99],a[160:163],v[76:79]
s_waitcnt lgkmcnt(0)
MF v116,v6,v116
MF v117,v6,v117
M v[80:83],a[64:67],a[128:131],0
T a[96:97],v21,0
T a[98:99],v21,2048
M v[80:83],a[68:71],a[132:135],v[80:83]
T a[100:101],v21,4096
T a[102:103],v21,6144
M v[80:83],a[72:75],a[136:139],v[80:83]
buffer_load_dwordx4 v0, s[12:15], s85 offen offset:0 lds
M v[80:83],a[76:79],a[140:143],v[80:83]
SA s85,s38,34816
T a[104:105],v21,8192
T a[106:107],v21,10240
M v[80:83],a[80:83],a[144:147],v[80:83]
T a[108:109],v21,12288
T a[110:111],v21,14336
M v[80:83],a[84:87],a[148:151],v[80:83]
buffer_load_dwordx4 v0, s[12:15], s85 offen offset:1024 lds
M v[80:83],a[88:91],a[152:155],v[80:83]
SA s85,s38,40960
T a[112:113],v21,16384
T a[114:115],v21,18432
M v[80:83],a[92:95],a[156:159],v[80:83]
T a[116:117],v21,20480
T a[118:119],v21,22528
M v[84:87],a[92:95],a[188:191],0
buffer_load_dwordx4 v0, s[12:15], s85 offen offset:2048 lds
M v[84:87],a[88:91],a[184:187],v[84:87]
SA s85,s38,47104
T a[120:121],v21,24576
T a[122:123],v21,26624
M v[84:87],a[84:87],a[180:183],v[84:87]
T a[124:125],v21,28672
T a[126:127],v21,30720
M v[84:87],a[80:83],a[176:179],v[84:87]
buffer_load_dwordx4 v0, s[12:15], s85 offen offset:3072 lds
M v[84:87],a[76:79],a[172:175],v[84:87]
MF v118,v6,v118
MF v119,v6,v119
M v[84:87],a[72:75],a[168:171],v[84:87]
SA s38,s38,128
MF v124,v6,v124
MF v125,v6,v125
M v[84:87],a[68:71],a[164:167],v[84:87]
s_waitcnt vmcnt(29) lgkmcnt(0)
MF v126,v6,v126
MF v127,v6,v127
M v[84:87],a[64:67],a[160:163],v[84:87]
s_barrier
M v[88:91],a[96:99],a[128:131],0
s_nop 0
T a[64:65],v40,0
T a[66:67],v40,2048
M v[88:91],a[100:103],a[132:135],v[88:91]
T a[68:69],v40,4096
T a[70:71],v40,6144
M v[88:91],a[104:107],a[136:139],v[88:91]
C v116,v116,v117
C v117,v118,v119
M v[88:91],a[108:111],a[140:143],v[88:91]
T a[72:73],v40,8192
T a[74:75],v40,10240
M v[88:91],a[112:115],a[144:147],v[88:91]
T a[76:77],v40,12288
T a[78:79],v40,14336
M v[88:91],a[116:119],a[148:151],v[88:91]
C v118,v124,v125
C v119,v126,v127
M v[88:91],a[120:123],a[152:155],v[88:91]
T a[80:81],v40,16384
T a[82:83],v40,18432
M v[88:91],a[124:127],a[156:159],v[88:91]
T a[84:85],v40,20480
T a[86:87],v40,22528
M v[92:95],a[124:127],a[188:191],0
buffer_store_dwordx4 v[116:119], v7, s[8:11], s30 offen offset:1024 sc1
M v[92:95],a[120:123],a[184:187],v[92:95]
SA s29,s33,4096
T a[88:89],v40,24576
T a[90:91],v40,26624
M v[92:95],a[116:119],a[180:183],v[92:95]
SA s30,s33,18432
T a[92:93],v40,28672
T a[94:95],v40,30720
M v[92:95],a[112:115],a[176:179],v[92:95]
MF v64,v5,v64
MF v65,v5,v65
M v[92:95],a[108:111],a[172:175],v[92:95]
MF v66,v5,v66
MF v67,v5,v67
M v[92:95],a[104:107],a[168:171],v[92:95]
MF v72,v5,v72
MF v73,v5,v73
M v[92:95],a[100:103],a[164:167],v[92:95]
s_waitcnt lgkmcnt(0)
MF v74,v5,v74
MF v75,v5,v75
M v[92:95],a[96:99],a[160:163],v[92:95]
C v64,v64,v65
C v65,v66,v67
C v66,v72,v73
C v67,v74,v75
buffer_store_dwordx4 v[64:67], v7, s[8:11], s29 offen offset:0 sc1
MF v68,v6,v68
MF v69,v6,v69
MF v70,v6,v70
MF v71,v6,v71
MF v76,v6,v76
MF v77,v6,v77
MF v78,v6,v78
MF v79,v6,v79
C v68,v68,v69
C v69,v70,v71
C v70,v76,v77
C v71,v78,v79
buffer_store_dwordx4 v[68:71], v7, s[8:11], s30 offen offset:0 sc1
M v[96:99],a[64:67],a[128:131],0
s_nop 0
T a[96:97],v41,0
T a[98:99],v41,2048
M v[96:99],a[68:71],a[132:135],v[96:99]
T a[100:101],v41,4096
T a[102:103],v41,6144
M v[96:99],a[72:75],a[136:139],v[96:99]
MF v80,v5,v80
MF v81,v5,v81
M v[96:99],a[76:79],a[140:143],v[96:99]
T a[104:105],v41,8192
T a[106:107],v41,10240
M v[96:99],a[80:83],a[144:147],v[96:99]
T a[108:109],v41,12288
T a[110:111],v41,14336
M v[96:99],a[84:87],a[148:151],v[96:99]
MF v82,v5,v82
MF v83,v5,v83
M v[96:99],a[88:91],a[152:155],v[96:99]
T a[112:113],v41,16384
T a[114:115],v41,18432
M v[96:99],a[92:95],a[156:159],v[96:99]
T a[116:117],v41,20480
T a[118:119],v41,22528
M v[100:103],a[92:95],a[188:191],0
MF v88,v5,v88
MF v89,v5,v89
M v[100:103],a[88:91],a[184:187],v[100:103]
T a[120:121],v41,24576
T a[122:123],v41,26624
M v[100:103],a[84:87],a[180:183],v[100:103]
T a[124:125],v41,28672
T a[126:127],v41,30720
M v[100:103],a[80:83],a[176:179],v[100:103]
MF v90,v5,v90
MF v91,v5,v91
M v[100:103],a[76:79],a[172:175],v[100:103]
C v80,v80,v81
C v81,v82,v83
M v[100:103],a[72:75],a[168:171],v[100:103]
C v82,v88,v89
C v83,v90,v91
M v[100:103],a[68:71],a[164:167],v[100:103]
buffer_store_dwordx4 v[80:83], v7, s[8:11], s29 offen offset:1024 sc1
M v[100:103],a[64:67],a[160:163],v[100:103]
s_waitcnt lgkmcnt(0)
MF v84,v6,v84
MF v85,v6,v85
M v[104:107],a[96:99],a[128:131],0
T a[64:65],v42,0
T a[66:67],v42,2048
M v[104:107],a[100:103],a[132:135],v[104:107]
T a[68:69],v42,4096
T a[70:71],v42,6144
M v[104:107],a[104:107],a[136:139],v[104:107]
MF v86,v6,v86
MF v87,v6,v87
M v[104:107],a[108:111],a[140:143],v[104:107]
T a[72:73],v42,8192
T a[74:75],v42,10240
M v[104:107],a[112:115],a[144:147],v[104:107]
T a[76:77],v42,12288
T a[78:79],v42,14336
M v[104:107],a[116:119],a[148:151],v[104:107]
MF v92,v6,v92
MF v93,v6,v93
M v[104:107],a[120:123],a[152:155],v[104:107]
T a[80:81],v42,16384
T a[82:83],v42,18432
M v[104:107],a[124:127],a[156:159],v[104:107]
T a[84:85],v42,20480
T a[86:87],v42,22528
M v[108:111],a[124:127],a[188:191],0
MF v94,v6,v94
MF v95,v6,v95
M v[108:111],a[120:123],a[184:187],v[108:111]
T a[88:89],v42,24576
T a[90:91],v42,26624
M v[108:111],a[116:119],a[180:183],v[108:111]
T a[92:93],v42,28672
T a[94:95],v42,30720
M v[108:111],a[112:115],a[176:179],v[108:111]
C v84,v84,v85
C v85,v86,v87
M v[108:111],a[108:111],a[172:175],v[108:111]
C v86,v92,v93
C v87,v94,v95
M v[108:111],a[104:107],a[168:171],v[108:111]
buffer_store_dwordx4 v[84:87], v7, s[8:11], s30 offen offset:1024 sc1
M v[108:111],a[100:103],a[164:167],v[108:111]
SA s29,s33,6144
M v[108:111],a[96:99],a[160:163],v[108:111]
s_waitcnt lgkmcnt(0)
M v[112:115],a[64:67],a[128:131],0
SA s30,s33,20480
T a[96:97],v43,0
T a[98:99],v43,2048
M v[112:115],a[68:71],a[132:135],v[112:115]
T a[100:101],v43,4096
T a[102:103],v43,6144
M v[112:115],a[72:75],a[136:139],v[112:115]
MF v96,v5,v96
MF v97,v5,v97
M v[112:115],a[76:79],a[140:143],v[112:115]
T a[104:105],v43,8192
T a[106:107],v43,10240
M v[112:115],a[80:83],a[144:147],v[112:115]
T a[108:109],v43,12288
T a[110:111],v43,14336
M v[112:115],a[84:87],a[148:151],v[112:115]
MF v98,v5,v98
MF v99,v5,v99
M v[112:115],a[88:91],a[152:155],v[112:115]
T a[112:113],v43,16384
T a[114:115],v43,18432
M v[112:115],a[92:95],a[156:159],v[112:115]
T a[116:117],v43,20480
T a[118:119],v43,22528
M v[116:119],a[92:95],a[188:191],0
MF v104,v5,v104
MF v105,v5,v105
M v[116:119],a[88:91],a[184:187],v[116:119]
T a[120:121],v43,24576
T a[122:123],v43,26624
M v[116:119],a[84:87],a[180:183],v[116:119]
T a[124:125],v43,28672
T a[126:127],v43,30720
M v[116:119],a[80:83],a[176:179],v[116:119]
MF v106,v5,v106
MF v107,v5,v107
M v[116:119],a[76:79],a[172:175],v[116:119]
C v96,v96,v97
C v97,v98,v99
M v[116:119],a[72:75],a[168:171],v[116:119]
C v98,v104,v105
C v99,v106,v107
M v[116:119],a[68:71],a[164:167],v[116:119]
s_waitcnt vmcnt(25) lgkmcnt(0)
buffer_store_dwordx4 v[96:99], v7, s[8:11], s29 offen offset:0 sc1
M v[116:119],a[64:67],a[160:163],v[116:119]
s_barrier
M v[120:123],a[96:99],a[128:131],0
s_nop 0
T a[64:65],v18,32768
T a[66:67],v18,34816
M v[120:123],a[100:103],a[132:135],v[120:123]
T a[68:69],v18,36864
T a[70:71],v18,38912
M v[120:123],a[104:107],a[136:139],v[120:123]
MF v100,v6,v100
MF v101,v6,v101
M v[120:123],a[108:111],a[140:143],v[120:123]
T a[72:73],v18,40960
T a[74:75],v18,43008
M v[120:123],a[112:115],a[144:147],v[120:123]
T a[76:77],v18,45056
T a[78:79],v18,47104
M v[120:123],a[116:119],a[148:151],v[120:123]
MF v102,v6,v102
MF v103,v6,v103
M v[120:123],a[120:123],a[152:155],v[120:123]
T a[80:81],v18,49152
T a[82:83],v18,51200
M v[120:123],a[124:127],a[156:159],v[120:123]
T a[84:85],v18,53248
T a[86:87],v18,55296
M v[124:127],a[124:127],a[188:191],0
MF v108,v6,v108
MF v109,v6,v109
M v[124:127],a[120:123],a[184:187],v[124:127]
T a[88:89],v18,57344
T a[90:91],v18,59392
M v[124:127],a[116:119],a[180:183],v[124:127]
T a[92:93],v18,61440
T a[94:95],v18,63488
M v[124:127],a[112:115],a[176:179],v[124:127]
MF v110,v6,v110
MF v111,v6,v111
M v[124:127],a[108:111],a[172:175],v[124:127]
C v100,v100,v101
C v101,v102,v103
M v[124:127],a[104:107],a[168:171],v[124:127]
C v102,v108,v109
C v103,v110,v111
M v[124:127],a[100:103],a[164:167],v[124:127]
s_waitcnt lgkmcnt(0)
buffer_store_dwordx4 v[100:103], v7, s[8:11], s30 offen offset:0 sc1
M v[124:127],a[96:99],a[160:163],v[124:127]
M v[64:67],a[64:67],a[128:131],0
s_nop 0
T a[96:97],v19,32768
T a[98:99],v19,34816
M v[64:67],a[68:71],a[132:135],v[64:67]
T a[100:101],v19,36864
T a[102:103],v19,38912
M v[64:67],a[72:75],a[136:139],v[64:67]
v_lshrrev_b32 v32, 4, v7
MF v112,v5,v112
M v[64:67],a[76:79],a[140:143],v[64:67]
s_lshr_b32 s74, s41, 3
T a[104:105],v19,40960
T a[106:107],v19,43008
M v[64:67],a[80:83],a[144:147],v[64:67]
s_lshl_b32 s64, s42, 1
T a[108:109],v19,45056
T a[110:111],v19,47104
M v[64:67],a[84:87],a[148:151],v[64:67]
SA s46,s64,s74
MF v113,v5,v113
MF v114,v5,v114
M v[64:67],a[88:91],a[152:155],v[64:67]
s_mul_i32 s46, s46, 4352
T a[112:113],v19,49152
T a[114:115],v19,51200
M v[64:67],a[92:95],a[156:159],v[64:67]
s_and_b32 s72, s41, 7
T a[116:117],v19,53248
T a[118:119],v19,55296
M v[68:71],a[92:95],a[188:191],0
s_lshl_b32 s65, s72, 7
MF v115,v5,v115
MF v120,v5,v120
M v[68:71],a[88:91],a[184:187],v[68:71]
SA s46,s46,s65
T a[120:121],v19,57344
T a[122:123],v19,59392
M v[68:71],a[84:87],a[180:183],v[68:71]
SA s46,s46,104992768
T a[124:125],v19,61440
T a[126:127],v19,63488
M v[68:71],a[80:83],a[176:179],v[68:71]
v_and_b32 v33, 31, v32
MF v121,v5,v121
M v[68:71],a[76:79],a[172:175],v[68:71]
MF v122,v5,v122
MF v123,v5,v123
M v[68:71],a[72:75],a[168:171],v[68:71]
C v112,v112,v113
C v113,v114,v115
M v[68:71],a[68:71],a[164:167],v[68:71]
C v114,v120,v121
C v115,v122,v123
M v[68:71],a[64:67],a[160:163],v[68:71]
s_waitcnt lgkmcnt(0)
buffer_store_dwordx4 v[112:115], v7, s[8:11], s29 offen offset:1024 sc1
M v[72:75],a[96:99],a[128:131],0
s_nop 0
T a[64:65],v20,32768
T a[66:67],v20,34816
M v[72:75],a[100:103],a[132:135],v[72:75]
T a[68:69],v20,36864
T a[70:71],v20,38912
M v[72:75],a[104:107],a[136:139],v[72:75]
MF v116,v6,v116
MF v117,v6,v117
M v[72:75],a[108:111],a[140:143],v[72:75]
T a[72:73],v20,40960
T a[74:75],v20,43008
M v[72:75],a[112:115],a[144:147],v[72:75]
T a[76:77],v20,45056
T a[78:79],v20,47104
M v[72:75],a[116:119],a[148:151],v[72:75]
MF v118,v6,v118
MF v119,v6,v119
M v[72:75],a[120:123],a[152:155],v[72:75]
T a[80:81],v20,49152
T a[82:83],v20,51200
M v[72:75],a[124:127],a[156:159],v[72:75]
T a[84:85],v20,53248
T a[86:87],v20,55296
M v[76:79],a[124:127],a[188:191],0
MF v124,v6,v124
MF v125,v6,v125
M v[76:79],a[120:123],a[184:187],v[76:79]
T a[88:89],v20,57344
T a[90:91],v20,59392
M v[76:79],a[116:119],a[180:183],v[76:79]
T a[92:93],v20,61440
T a[94:95],v20,63488
M v[76:79],a[112:115],a[176:179],v[76:79]
MF v126,v6,v126
MF v127,v6,v127
M v[76:79],a[108:111],a[172:175],v[76:79]
C v116,v116,v117
C v117,v118,v119
M v[76:79],a[104:107],a[168:171],v[76:79]
C v118,v124,v125
C v119,v126,v127
M v[76:79],a[100:103],a[164:167],v[76:79]
buffer_store_dwordx4 v[116:119], v7, s[8:11], s30 offen offset:1024 sc1
M v[76:79],a[96:99],a[160:163],v[76:79]
s_waitcnt lgkmcnt(0)
v_lshlrev_b32 v33, 2, v33
M v[80:83],a[64:67],a[128:131],0
SA s29,s33,8192
T a[96:97],v21,32768
T a[98:99],v21,34816
M v[80:83],a[68:71],a[132:135],v[80:83]
SA s30,s33,22528
T a[100:101],v21,36864
T a[102:103],v21,38912
M v[80:83],a[72:75],a[136:139],v[80:83]
s_lshl_b32 s65, s41, 7
MF v64,v5,v64
MF v65,v5,v65
M v[80:83],a[76:79],a[140:143],v[80:83]
SA s65,s65,104890368
T a[104:105],v21,40960
T a[106:107],v21,43008
M v[80:83],a[80:83],a[144:147],v[80:83]
T a[108:109],v21,45056
T a[110:111],v21,47104
M v[80:83],a[84:87],a[148:151],v[80:83]
buffer_load_dword v31, v33, s[8:11], s65 offen sc1
M v[80:83],a[88:91],a[152:155],v[80:83]
s_nop 0
T a[112:113],v21,49152
T a[114:115],v21,51200
M v[80:83],a[92:95],a[156:159],v[80:83]
T a[116:117],v21,53248
T a[118:119],v21,55296
M v[84:87],a[92:95],a[188:191],0
v_bfe_u32 v34, v32, 4, 1
v_lshlrev_b32 v34, 1, v34
M v[84:87],a[88:91],a[184:187],v[84:87]
T a[120:121],v21,57344
T a[122:123],v21,59392
M v[84:87],a[84:87],a[180:183],v[84:87]
T a[124:125],v21,61440
T a[126:127],v21,63488
M v[84:87],a[80:83],a[176:179],v[84:87]
v_lshrrev_b32 v35, 5, v32
v_add_u32 v34, v34, v35
M v[84:87],a[76:79],a[172:175],v[84:87]
s_mov_b32 s52, s96
MF v66,v5,v66
MF v67,v5,v67
M v[84:87],a[72:75],a[168:171],v[84:87]
s_and_b32 s53, s97, 0xffff
MF v72,v5,v72
MF v73,v5,v73
M v[84:87],a[68:71],a[164:167],v[84:87]
s_waitcnt vmcnt(19) lgkmcnt(0)
MF v74,v5,v74
MF v75,v5,v75
M v[84:87],a[64:67],a[160:163],v[84:87]
s_barrier
M v[88:91],a[96:99],a[128:131],0
s_mov_b32 s54, 1835008
T a[64:65],v22,32768
T a[66:67],v22,34816
M v[88:91],a[100:103],a[132:135],v[88:91]
s_mov_b32 s55, 0x20000
T a[68:69],v22,36864
T a[70:71],v22,38912
M v[88:91],a[104:107],a[136:139],v[88:91]
s_mul_i32 s77, s42, 1835008
C v64,v64,v65
C v65,v66,v67
M v[88:91],a[108:111],a[140:143],v[88:91]
s_mul_i32 s78, s72, 14336
T a[72:73],v22,40960
T a[74:75],v22,43008
M v[88:91],a[112:115],a[144:147],v[88:91]
SA s77,s77,s78
T a[76:77],v22,45056
T a[78:79],v22,47104
M v[88:91],a[116:119],a[148:151],v[88:91]
SA s77,s77,67108864
C v66,v72,v73
C v67,v74,v75
M v[88:91],a[120:123],a[152:155],v[88:91]
s_lshl_b32 s79, s74, 1
T a[80:81],v22,49152
T a[82:83],v22,51200
M v[88:91],a[124:127],a[156:159],v[88:91]
SA s79,s79,s20
T a[84:85],v22,53248
T a[86:87],v22,55296
M v[92:95],a[124:127],a[188:191],0
s_lshl_b32 s71, s74, 1
buffer_store_dwordx4 v[64:67], v7, s[8:11], s29 offen offset:0 sc1
M v[92:95],a[120:123],a[184:187],v[92:95]
SA s71,s71,1
T a[88:89],v22,57344
T a[90:91],v22,59392
M v[92:95],a[116:119],a[180:183],v[92:95]
s_sub_u32 s71, s71, s20
T a[92:93],v22,61440
T a[94:95],v22,63488
M v[92:95],a[112:115],a[176:179],v[92:95]
s_and_b32 s71, s71, 536870912
MF v68,v6,v68
MF v69,v6,v69
M v[92:95],a[108:111],a[172:175],v[92:95]
s_sub_u32 s64, 15, s64
MF v70,v6,v70
MF v71,v6,v71
M v[92:95],a[104:107],a[168:171],v[92:95]
s_sub_u32 s78, s64, 1
MF v76,v6,v76
MF v77,v6,v77
M v[92:95],a[100:103],a[164:167],v[92:95]
s_waitcnt lgkmcnt(0)
MF v78,v6,v78
MF v79,v6,v79
M v[92:95],a[96:99],a[160:163],v[92:95]
s_mul_i32 s78, s78, 1835008
SA s78,s78,s77
s_lshl_b32 s65, s79, 10
SA s78,s78,s65
SA s78,s78,s71
s_lshl_b32 s79, s79, 6
s_or_b32 s79, s79, s71
s_mul_i32 s67, s74, -2
s_lshl_b32 s74, s74, 3
SA s74,s74,s20
s_lshl_b32 s75, s74, 6
SA s76,s75,256
SA s67,s67,3
s_sub_u32 s67, s67, s20
s_and_b32 s67, s67, 536870912
s_or_b32 s76, s76, s67
v_or_b32 v27, s67, v7
v_add_u32 v27, 4096, v27
s_lshl_b32 s65, s74, 10
SA s77,s77,s65
s_lshl_b32 s64, s64, 7
s_lshr_b32 s73, s72, 1
s_sub_u32 s65, 7, s73
s_bitcmp1_b32 s72, 0
s_cselect_b32 s73, s65, s73
s_lshl_b32 s73, s73, 4
s_lshl_b32 s65, s42, 7
SA s73,s73,s65
v_and_b32 v37, 15, v32
v_add_u32 v37, s73, v37
v_add_u32 v29, s64, v37
s_mov_b32 s64, 104857664
v_mul_u32_u24 v38, 896, v37
v_lshl_add_u32 v38, v34, 4, v38
v_lshrrev_b32 v35, 4, v37
v_lshlrev_b32 v35, 5, v35
v_and_b32 v36, 15, v37
v_add_lshl_u32 v35, v35, v36, 2
buffer_load_dword v39, v35, s[8:11], s64 offen sc1
C v68,v68,v69
C v69,v70,v71
C v70,v76,v77
C v71,v78,v79
buffer_store_dwordx4 v[68:71], v7, s[8:11], s30 offen offset:0 sc1
buffer_load_dwordx4 v[48:51], v38, s[56:59], s75 offen
buffer_load_dwordx4 v[52:55], v38, s[56:59], s76 offen
v_mul_u32_u24 v28, 896, v29
v_lshl_add_u32 v28, v34, 4, v28
v_lshrrev_b32 v35, 4, v29
v_lshlrev_b32 v35, 5, v35
v_and_b32 v36, 15, v29
v_add_lshl_u32 v35, v35, v36, 2
buffer_load_dword v26, v35, s[8:11], s64 offen sc1
buffer_load_dwordx4 v[44:47], v28, s[56:59], s79 offen
M v[96:99],a[64:67],a[128:131],0
s_nop 0
T a[96:97],v23,32768
T a[98:99],v23,34816
M v[96:99],a[68:71],a[132:135],v[96:99]
T a[100:101],v23,36864
T a[102:103],v23,38912
M v[96:99],a[72:75],a[136:139],v[96:99]
MF v80,v5,v80
MF v81,v5,v81
M v[96:99],a[76:79],a[140:143],v[96:99]
T a[104:105],v23,40960
T a[106:107],v23,43008
M v[96:99],a[80:83],a[144:147],v[96:99]
T a[108:109],v23,45056
T a[110:111],v23,47104
M v[96:99],a[84:87],a[148:151],v[96:99]
MF v82,v5,v82
MF v83,v5,v83
M v[96:99],a[88:91],a[152:155],v[96:99]
T a[112:113],v23,49152
T a[114:115],v23,51200
M v[96:99],a[92:95],a[156:159],v[96:99]
T a[116:117],v23,53248
T a[118:119],v23,55296
M v[100:103],a[92:95],a[188:191],0
MF v88,v5,v88
MF v89,v5,v89
M v[100:103],a[88:91],a[184:187],v[100:103]
T a[120:121],v23,57344
T a[122:123],v23,59392
M v[100:103],a[84:87],a[180:183],v[100:103]
T a[124:125],v23,61440
T a[126:127],v23,63488
M v[100:103],a[80:83],a[176:179],v[100:103]
MF v90,v5,v90
MF v91,v5,v91
M v[100:103],a[76:79],a[172:175],v[100:103]
C v80,v80,v81
C v81,v82,v83
M v[100:103],a[72:75],a[168:171],v[100:103]
C v82,v88,v89
C v83,v90,v91
M v[100:103],a[68:71],a[164:167],v[100:103]
buffer_store_dwordx4 v[80:83], v7, s[8:11], s29 offen offset:1024 sc1
M v[100:103],a[64:67],a[160:163],v[100:103]
s_waitcnt lgkmcnt(0)
MF v84,v6,v84
MF v85,v6,v85
M v[104:107],a[96:99],a[128:131],0
T a[64:65],v24,32768
T a[66:67],v24,34816
M v[104:107],a[100:103],a[132:135],v[104:107]
T a[68:69],v24,36864
T a[70:71],v24,38912
M v[104:107],a[104:107],a[136:139],v[104:107]
MF v86,v6,v86
MF v87,v6,v87
M v[104:107],a[108:111],a[140:143],v[104:107]
T a[72:73],v24,40960
T a[74:75],v24,43008
M v[104:107],a[112:115],a[144:147],v[104:107]
T a[76:77],v24,45056
T a[78:79],v24,47104
M v[104:107],a[116:119],a[148:151],v[104:107]
MF v92,v6,v92
MF v93,v6,v93
M v[104:107],a[120:123],a[152:155],v[104:107]
T a[80:81],v24,49152
T a[82:83],v24,51200
M v[104:107],a[124:127],a[156:159],v[104:107]
T a[84:85],v24,53248
T a[86:87],v24,55296
M v[108:111],a[124:127],a[188:191],0
MF v94,v6,v94
MF v95,v6,v95
M v[108:111],a[120:123],a[184:187],v[108:111]
T a[88:89],v24,57344
T a[90:91],v24,59392
M v[108:111],a[116:119],a[180:183],v[108:111]
T a[92:93],v24,61440
T a[94:95],v24,63488
M v[108:111],a[112:115],a[176:179],v[108:111]
C v84,v84,v85
C v85,v86,v87
M v[108:111],a[108:111],a[172:175],v[108:111]
C v86,v92,v93
C v87,v94,v95
M v[108:111],a[104:107],a[168:171],v[108:111]
buffer_store_dwordx4 v[84:87], v7, s[8:11], s30 offen offset:1024 sc1
M v[108:111],a[100:103],a[164:167],v[108:111]
SA s29,s33,10240
M v[108:111],a[96:99],a[160:163],v[108:111]
s_waitcnt lgkmcnt(0)
M v[112:115],a[64:67],a[128:131],0
SA s30,s33,24576
T a[96:97],v25,32768
T a[98:99],v25,34816
M v[112:115],a[68:71],a[132:135],v[112:115]
T a[100:101],v25,36864
T a[102:103],v25,38912
M v[112:115],a[72:75],a[136:139],v[112:115]
MF v96,v5,v96
MF v97,v5,v97
M v[112:115],a[76:79],a[140:143],v[112:115]
T a[104:105],v25,40960
T a[106:107],v25,43008
M v[112:115],a[80:83],a[144:147],v[112:115]
T a[108:109],v25,45056
T a[110:111],v25,47104
M v[112:115],a[84:87],a[148:151],v[112:115]
MF v98,v5,v98
MF v99,v5,v99
M v[112:115],a[88:91],a[152:155],v[112:115]
T a[112:113],v25,49152
T a[114:115],v25,51200
M v[112:115],a[92:95],a[156:159],v[112:115]
T a[116:117],v25,53248
T a[118:119],v25,55296
M v[116:119],a[92:95],a[188:191],0
s_mov_b32 s84, s45
MF v104,v5,v104
MF v105,v5,v105
M v[116:119],a[88:91],a[184:187],v[116:119]
T a[120:121],v25,57344
T a[122:123],v25,59392
M v[116:119],a[84:87],a[180:183],v[116:119]
T a[124:125],v25,61440
T a[126:127],v25,63488
M v[116:119],a[80:83],a[176:179],v[116:119]
MF v106,v5,v106
MF v107,v5,v107
M v[116:119],a[76:79],a[172:175],v[116:119]
C v96,v96,v97
C v97,v98,v99
M v[116:119],a[72:75],a[168:171],v[116:119]
C v98,v104,v105
C v99,v106,v107
M v[116:119],a[68:71],a[164:167],v[116:119]
s_waitcnt vmcnt(19) lgkmcnt(0)
buffer_store_dwordx4 v[96:99], v7, s[8:11], s29 offen offset:0 sc1
M v[116:119],a[64:67],a[160:163],v[116:119]
s_barrier
M v[120:123],a[96:99],a[128:131],0
s_nop 0
T a[64:65],v22,0
T a[66:67],v22,2048
M v[120:123],a[100:103],a[132:135],v[120:123]
T a[68:69],v22,4096
T a[70:71],v22,6144
M v[120:123],a[104:107],a[136:139],v[120:123]
MF v100,v6,v100
MF v101,v6,v101
M v[120:123],a[108:111],a[140:143],v[120:123]
T a[72:73],v22,8192
T a[74:75],v22,10240
M v[120:123],a[112:115],a[144:147],v[120:123]
s_waitcnt vmcnt(11)
T a[76:77],v22,12288
T a[78:79],v22,14336
M v[120:123],a[116:119],a[148:151],v[120:123]
buffer_store_dword v15, v17, s[8:11], s84 offen sc1
M v[120:123],a[120:123],a[152:155],v[120:123]
s_nop 0
T a[80:81],v22,16384
T a[82:83],v22,18432
M v[120:123],a[124:127],a[156:159],v[120:123]
T a[84:85],v22,20480
T a[86:87],v22,22528
M v[124:127],a[124:127],a[188:191],0
MF v102,v6,v102
MF v103,v6,v103
M v[124:127],a[120:123],a[184:187],v[124:127]
T a[88:89],v22,24576
T a[90:91],v22,26624
M v[124:127],a[116:119],a[180:183],v[124:127]
T a[92:93],v22,28672
T a[94:95],v22,30720
M v[124:127],a[112:115],a[176:179],v[124:127]
MF v108,v6,v108
MF v109,v6,v109
M v[124:127],a[108:111],a[172:175],v[124:127]
MF v110,v6,v110
MF v111,v6,v111
M v[124:127],a[104:107],a[168:171],v[124:127]
C v100,v100,v101
C v101,v102,v103
M v[124:127],a[100:103],a[164:167],v[124:127]
s_waitcnt lgkmcnt(0)
C v102,v108,v109
C v103,v110,v111
M v[124:127],a[96:99],a[160:163],v[124:127]
buffer_store_dwordx4 v[100:103], v7, s[8:11], s30 offen offset:0 sc1
M v[64:67],a[64:67],a[128:131],0
s_nop 0
T a[96:97],v23,0
T a[98:99],v23,2048
M v[64:67],a[68:71],a[132:135],v[64:67]
T a[100:101],v23,4096
T a[102:103],v23,6144
M v[64:67],a[72:75],a[136:139],v[64:67]
MF v112,v5,v112
MF v113,v5,v113
M v[64:67],a[76:79],a[140:143],v[64:67]
T a[104:105],v23,8192
T a[106:107],v23,10240
M v[64:67],a[80:83],a[144:147],v[64:67]
T a[108:109],v23,12288
T a[110:111],v23,14336
M v[64:67],a[84:87],a[148:151],v[64:67]
MF v114,v5,v114
MF v115,v5,v115
M v[64:67],a[88:91],a[152:155],v[64:67]
T a[112:113],v23,16384
T a[114:115],v23,18432
M v[64:67],a[92:95],a[156:159],v[64:67]
T a[116:117],v23,20480
T a[118:119],v23,22528
M v[68:71],a[92:95],a[188:191],0
MF v120,v5,v120
MF v121,v5,v121
M v[68:71],a[88:91],a[184:187],v[68:71]
T a[120:121],v23,24576
T a[122:123],v23,26624
M v[68:71],a[84:87],a[180:183],v[68:71]
T a[124:125],v23,28672
T a[126:127],v23,30720
M v[68:71],a[80:83],a[176:179],v[68:71]
MF v122,v5,v122
MF v123,v5,v123
M v[68:71],a[76:79],a[172:175],v[68:71]
C v112,v112,v113
C v113,v114,v115
M v[68:71],a[72:75],a[168:171],v[68:71]
C v114,v120,v121
C v115,v122,v123
M v[68:71],a[68:71],a[164:167],v[68:71]
buffer_store_dwordx4 v[112:115], v7, s[8:11], s29 offen offset:1024 sc1
M v[68:71],a[64:67],a[160:163],v[68:71]
s_waitcnt lgkmcnt(0)
MF v116,v6,v116
MF v117,v6,v117
M v[72:75],a[96:99],a[128:131],0
T a[64:65],v24,0
T a[66:67],v24,2048
M v[72:75],a[100:103],a[132:135],v[72:75]
T a[68:69],v24,4096
T a[70:71],v24,6144
M v[72:75],a[104:107],a[136:139],v[72:75]
MF v118,v6,v118
MF v119,v6,v119
M v[72:75],a[108:111],a[140:143],v[72:75]
T a[72:73],v24,8192
T a[74:75],v24,10240
M v[72:75],a[112:115],a[144:147],v[72:75]
T a[76:77],v24,12288
T a[78:79],v24,14336
M v[72:75],a[116:119],a[148:151],v[72:75]
MF v124,v6,v124
MF v125,v6,v125
M v[72:75],a[120:123],a[152:155],v[72:75]
T a[80:81],v24,16384
T a[82:83],v24,18432
M v[72:75],a[124:127],a[156:159],v[72:75]
T a[84:85],v24,20480
T a[86:87],v24,22528
M v[76:79],a[124:127],a[188:191],0
MF v126,v6,v126
MF v127,v6,v127
M v[76:79],a[120:123],a[184:187],v[76:79]
T a[88:89],v24,24576
T a[90:91],v24,26624
M v[76:79],a[116:119],a[180:183],v[76:79]
T a[92:93],v24,28672
T a[94:95],v24,30720
M v[76:79],a[112:115],a[176:179],v[76:79]
C v116,v116,v117
C v117,v118,v119
M v[76:79],a[108:111],a[172:175],v[76:79]
C v118,v124,v125
C v119,v126,v127
M v[76:79],a[104:107],a[168:171],v[76:79]
buffer_store_dwordx4 v[116:119], v7, s[8:11], s30 offen offset:1024 sc1
M v[76:79],a[100:103],a[164:167],v[76:79]
SA s29,s33,12288
M v[76:79],a[96:99],a[160:163],v[76:79]
s_waitcnt lgkmcnt(0)
M v[80:83],a[64:67],a[128:131],0
SA s30,s33,26624
T a[96:97],v25,0
T a[98:99],v25,2048
M v[80:83],a[68:71],a[132:135],v[80:83]
T a[100:101],v25,4096
T a[102:103],v25,6144
M v[80:83],a[72:75],a[136:139],v[80:83]
MF v64,v5,v64
MF v65,v5,v65
M v[80:83],a[76:79],a[140:143],v[80:83]
T a[104:105],v25,8192
T a[106:107],v25,10240
M v[80:83],a[80:83],a[144:147],v[80:83]
T a[108:109],v25,12288
T a[110:111],v25,14336
M v[80:83],a[84:87],a[148:151],v[80:83]
MF v66,v5,v66
MF v67,v5,v67
M v[80:83],a[88:91],a[152:155],v[80:83]
T a[112:113],v25,16384
T a[114:115],v25,18432
M v[80:83],a[92:95],a[156:159],v[80:83]
T a[116:117],v25,20480
T a[118:119],v25,22528
M v[84:87],a[92:95],a[188:191],0
MF v72,v5,v72
MF v73,v5,v73
M v[84:87],a[88:91],a[184:187],v[84:87]
T a[120:121],v25,24576
T a[122:123],v25,26624
M v[84:87],a[84:87],a[180:183],v[84:87]
T a[124:125],v25,28672
T a[126:127],v25,30720
M v[84:87],a[80:83],a[176:179],v[84:87]
MF v74,v5,v74
MF v75,v5,v75
M v[84:87],a[76:79],a[172:175],v[84:87]
C v64,v64,v65
C v65,v66,v67
M v[84:87],a[72:75],a[168:171],v[84:87]
C v66,v72,v73
C v67,v74,v75
M v[84:87],a[68:71],a[164:167],v[84:87]
buffer_store_dwordx4 v[64:67], v7, s[8:11], s29 offen offset:0 sc1
M v[84:87],a[64:67],a[160:163],v[84:87]
s_waitcnt lgkmcnt(0)
MF v68,v6,v68
MF v69,v6,v69
M v[88:91],a[96:99],a[128:131],0
MF v70,v6,v70
MF v71,v6,v71
M v[88:91],a[100:103],a[132:135],v[88:91]
MF v76,v6,v76
MF v77,v6,v77
M v[88:91],a[104:107],a[136:139],v[88:91]
MF v78,v6,v78
MF v79,v6,v79
M v[88:91],a[108:111],a[140:143],v[88:91]
C v68,v68,v69
C v69,v70,v71
M v[88:91],a[112:115],a[144:147],v[88:91]
C v70,v76,v77
C v71,v78,v79
M v[88:91],a[116:119],a[148:151],v[88:91]
buffer_store_dwordx4 v[68:71], v7, s[8:11], s30 offen offset:0 sc1
M v[88:91],a[120:123],a[152:155],v[88:91]
M v[88:91],a[124:127],a[156:159],v[88:91]
M v[92:95],a[124:127],a[188:191],0
M v[92:95],a[120:123],a[184:187],v[92:95]
M v[92:95],a[116:119],a[180:183],v[92:95]
M v[92:95],a[112:115],a[176:179],v[92:95]
MF v80,v5,v80
MF v81,v5,v81
M v[92:95],a[108:111],a[172:175],v[92:95]
MF v82,v5,v82
MF v83,v5,v83
M v[92:95],a[104:107],a[168:171],v[92:95]
MF v88,v5,v88
MF v89,v5,v89
M v[92:95],a[100:103],a[164:167],v[92:95]
MF v90,v5,v90
MF v91,v5,v91
M v[92:95],a[96:99],a[160:163],v[92:95]
C v80,v80,v81
C v81,v82,v83
C v82,v88,v89
C v83,v90,v91
buffer_store_dwordx4 v[80:83], v7, s[8:11], s29 offen offset:1024 sc1
MF v84,v6,v84
MF v85,v6,v85
MF v86,v6,v86
MF v87,v6,v87
MF v92,v6,v92
MF v93,v6,v93
MF v94,v6,v94
MF v95,v6,v95
C v84,v84,v85
C v85,v86,v87
C v86,v92,v93
C v87,v94,v95
buffer_store_dwordx4 v[84:87], v7, s[8:11], s30 offen offset:1024 sc1
buffer_load_dword v9, v33, s[8:11], s46 offen sc1
s_waitcnt vmcnt(1)
buffer_store_dword v15, v16, s[8:11], s3 offen sc1
L_red1:
s_waitcnt vmcnt(0)
v_cmp_eq_u32 vcc, 1, v9
s_mov_b32 s91, 65536
s_mov_b32 s69, 0xffff
s_and_b32 s70, vcc_lo, s69
s_mov_b32 s68, s70
s_cmp_lg_u32 s70, 0
s_cbranch_scc1 L_rk0
s_call_b64 s[36:37], L_rpoll
L_rk0:
s_ff1_i32_b32 s71, s70
s_bitset0_b32 s70, s71
s_mul_i32 s71, s71, 114688
SA s72,s71,s77
buffer_load_dwordx4 v[128:131], v7, s[8:11], s72 offen sc1
buffer_load_dwordx4 v[132:135], v27, s[8:11], s72 offen sc1
s_cmp_lg_u32 s70, 0
s_cbranch_scc1 L_rk1
s_call_b64 s[36:37], L_rpoll
L_rk1:
s_ff1_i32_b32 s71, s70
s_bitset0_b32 s70, s71
s_mul_i32 s71, s71, 114688
SA s72,s71,s77
buffer_load_dwordx4 v[136:139], v7, s[8:11], s72 offen sc1
buffer_load_dwordx4 v[140:143], v27, s[8:11], s72 offen sc1
s_cmp_lg_u32 s70, 0
s_cbranch_scc1 L_rk2
s_call_b64 s[36:37], L_rpoll
L_rk2:
s_ff1_i32_b32 s71, s70
s_bitset0_b32 s70, s71
s_mul_i32 s71, s71, 114688
SA s72,s71,s77
buffer_load_dwordx4 v[144:147], v7, s[8:11], s72 offen sc1
buffer_load_dwordx4 v[148:151], v27, s[8:11], s72 offen sc1
v_readlane_b32 s92, v31, 0
v_readlane_b32 s94, v31, 1
v_lshlrev_b32 v64, 16, v48
v_and_b32 v65, 0xffff0000, v48
v_lshlrev_b32 v66, 16, v49
v_and_b32 v67, 0xffff0000, v49
v_lshlrev_b32 v68, 16, v50
v_and_b32 v69, 0xffff0000, v50
v_lshlrev_b32 v70, 16, v51
v_and_b32 v71, 0xffff0000, v51
v_lshlrev_b32 v72, 16, v52
v_and_b32 v73, 0xffff0000, v52
v_lshlrev_b32 v74, 16, v53
v_and_b32 v75, 0xffff0000, v53
v_lshlrev_b32 v76, 16, v54
v_and_b32 v77, 0xffff0000, v54
v_lshlrev_b32 v78, 16, v55
v_and_b32 v79, 0xffff0000, v55
v_sub_f32 v30, 1.0, v39
v_cmp_eq_u32 s[80:81], s92, v37
v_cmp_eq_u32 s[82:83], s94, v37
s_nop 0
s_or_b64 vcc, s[80:81], s[82:83]
s_cbranch_vccnz L_moe0
L_moe_ret0:
MF v64,v30,v64
MF v65,v30,v65
MF v66,v30,v66
MF v67,v30,v67
MF v68,v30,v68
MF v69,v30,v69
MF v70,v30,v70
MF v71,v30,v71
MF v72,v30,v72
MF v73,v30,v73
MF v74,v30,v74
MF v75,v30,v75
MF v76,v30,v76
MF v77,v30,v77
MF v78,v30,v78
MF v79,v30,v79
s_cmp_lg_u32 s70, 0
s_cbranch_scc1 L_rk3
s_call_b64 s[36:37], L_rpoll
L_rk3:
s_ff1_i32_b32 s71, s70
s_bitset0_b32 s70, s71
s_mul_i32 s71, s71, 114688
SA s72,s71,s77
buffer_load_dwordx4 v[152:155], v7, s[8:11], s72 offen sc1
buffer_load_dwordx4 v[156:159], v27, s[8:11], s72 offen sc1
v_lshlrev_b32 v80, 16, v44
v_and_b32 v81, 0xffff0000, v44
v_lshlrev_b32 v82, 16, v45
v_and_b32 v83, 0xffff0000, v45
v_lshlrev_b32 v84, 16, v46
v_and_b32 v85, 0xffff0000, v46
v_lshlrev_b32 v86, 16, v47
v_and_b32 v87, 0xffff0000, v47
v_sub_f32 v30, 1.0, v26
v_cmp_eq_u32 s[80:81], s92, v29
v_cmp_eq_u32 s[82:83], s94, v29
s_nop 0
s_or_b64 vcc, s[80:81], s[82:83]
s_cbranch_vccnz L_moe1
L_moe_ret1:
MF v80,v30,v80
MF v81,v30,v81
MF v82,v30,v82
MF v83,v30,v83
MF v84,v30,v84
MF v85,v30,v85
MF v86,v30,v86
MF v87,v30,v87
s_waitcnt vmcnt(7)
M v[96:99],a[246:249],v[128:131],0
M v[100:103],a[244:247],v[128:131],0
s_waitcnt vmcnt(6)
M v[104:107],a[246:249],v[132:135],0
M v[108:111],a[244:247],v[132:135],0
s_cmp_lg_u32 s70, 0
s_cbranch_scc1 L_rk4
s_call_b64 s[36:37], L_rpoll
L_rk4:
s_ff1_i32_b32 s71, s70
s_bitset0_b32 s70, s71
s_mul_i32 s71, s71, 114688
SA s72,s71,s77
buffer_load_dwordx4 v[160:163], v7, s[8:11], s72 offen sc1
buffer_load_dwordx4 v[164:167], v27, s[8:11], s72 offen sc1
s_waitcnt vmcnt(7)
M v[96:99],a[246:249],v[136:139],v[96:99]
M v[100:103],a[244:247],v[136:139],v[100:103]
s_waitcnt vmcnt(6)
M v[104:107],a[246:249],v[140:143],v[104:107]
M v[108:111],a[244:247],v[140:143],v[108:111]
s_cmp_lg_u32 s70, 0
s_cbranch_scc1 L_rk5
s_call_b64 s[36:37], L_rpoll
L_rk5:
s_ff1_i32_b32 s71, s70
s_bitset0_b32 s70, s71
s_mul_i32 s71, s71, 114688
SA s72,s71,s77
buffer_load_dwordx4 v[168:171], v7, s[8:11], s72 offen sc1
buffer_load_dwordx4 v[172:175], v27, s[8:11], s72 offen sc1
s_waitcnt vmcnt(7)
M v[96:99],a[246:249],v[144:147],v[96:99]
M v[100:103],a[244:247],v[144:147],v[100:103]
s_waitcnt vmcnt(6)
M v[104:107],a[246:249],v[148:151],v[104:107]
M v[108:111],a[244:247],v[148:151],v[108:111]
s_cmp_lg_u32 s70, 0
s_cbranch_scc1 L_rk6
s_call_b64 s[36:37], L_rpoll
L_rk6:
s_ff1_i32_b32 s71, s70
s_bitset0_b32 s70, s71
s_mul_i32 s71, s71, 114688
SA s72,s71,s77
buffer_load_dwordx4 v[176:179], v7, s[8:11], s72 offen sc1
buffer_load_dwordx4 v[180:183], v27, s[8:11], s72 offen sc1
s_waitcnt vmcnt(7)
M v[96:99],a[246:249],v[152:155],v[96:99]
M v[100:103],a[244:247],v[152:155],v[100:103]
s_waitcnt vmcnt(6)
M v[104:107],a[246:249],v[156:159],v[104:107]
M v[108:111],a[244:247],v[156:159],v[108:111]
s_cmp_lg_u32 s70, 0
s_cbranch_scc1 L_rk7
s_call_b64 s[36:37], L_rpoll
L_rk7:
s_ff1_i32_b32 s71, s70
s_bitset0_b32 s70, s71
s_mul_i32 s71, s71, 114688
SA s72,s71,s77
buffer_load_dwordx4 v[184:187], v7, s[8:11], s72 offen sc1
buffer_load_dwordx4 v[188:191], v27, s[8:11], s72 offen sc1
s_waitcnt vmcnt(7)
M v[96:99],a[246:249],v[160:163],v[96:99]
M v[100:103],a[244:247],v[160:163],v[100:103]
s_waitcnt vmcnt(6)
M v[104:107],a[246:249],v[164:167],v[104:107]
M v[108:111],a[244:247],v[164:167],v[108:111]
s_cmp_lg_u32 s70, 0
s_cbranch_scc1 L_rk8
s_call_b64 s[36:37], L_rpoll
L_rk8:
s_ff1_i32_b32 s71, s70
s_bitset0_b32 s70, s71
s_mul_i32 s71, s71, 114688
SA s72,s71,s77
buffer_load_dwordx4 v[128:131], v7, s[8:11], s72 offen sc1
buffer_load_dwordx4 v[132:135], v27, s[8:11], s72 offen sc1
s_waitcnt vmcnt(7)
M v[96:99],a[246:249],v[168:171],v[96:99]
M v[100:103],a[244:247],v[168:171],v[100:103]
s_waitcnt vmcnt(6)
M v[104:107],a[246:249],v[172:175],v[104:107]
M v[108:111],a[244:247],v[172:175],v[108:111]
s_cmp_lg_u32 s70, 0
s_cbranch_scc1 L_rk9
s_call_b64 s[36:37], L_rpoll
L_rk9:
s_ff1_i32_b32 s71, s70
s_bitset0_b32 s70, s71
s_mul_i32 s71, s71, 114688
SA s72,s71,s77
buffer_load_dwordx4 v[136:139], v7, s[8:11], s72 offen sc1
buffer_load_dwordx4 v[140:143], v27, s[8:11], s72 offen sc1
s_waitcnt vmcnt(7)
M v[96:99],a[246:249],v[176:179],v[96:99]
M v[100:103],a[244:247],v[176:179],v[100:103]
s_waitcnt vmcnt(6)
M v[104:107],a[246:249],v[180:183],v[104:107]
M v[108:111],a[244:247],v[180:183],v[108:111]
s_cmp_lg_u32 s70, 0
s_cbranch_scc1 L_rk10
s_call_b64 s[36:37], L_rpoll
L_rk10:
s_ff1_i32_b32 s71, s70
s_bitset0_b32 s70, s71
s_mul_i32 s71, s71, 114688
SA s72,s71,s77
buffer_load_dwordx4 v[144:147], v7, s[8:11], s72 offen sc1
buffer_load_dwordx4 v[148:151], v27, s[8:11], s72 offen sc1
s_waitcnt vmcnt(7)
M v[96:99],a[246:249],v[184:187],v[96:99]
M v[100:103],a[244:247],v[184:187],v[100:103]
s_waitcnt vmcnt(6)
M v[104:107],a[246:249],v[188:191],v[104:107]
M v[108:111],a[244:247],v[188:191],v[108:111]
s_cmp_lg_u32 s70, 0
s_cbranch_scc1 L_rk11
s_call_b64 s[36:37], L_rpoll
L_rk11:
s_ff1_i32_b32 s71, s70
s_bitset0_b32 s70, s71
s_mul_i32 s71, s71, 114688
SA s72,s71,s77
buffer_load_dwordx4 v[152:155], v7, s[8:11], s72 offen sc1
buffer_load_dwordx4 v[156:159], v27, s[8:11], s72 offen sc1
s_waitcnt vmcnt(7)
M v[96:99],a[246:249],v[128:131],v[96:99]
M v[100:103],a[244:247],v[128:131],v[100:103]
s_waitcnt vmcnt(6)
M v[104:107],a[246:249],v[132:135],v[104:107]
M v[108:111],a[244:247],v[132:135],v[108:111]
s_cmp_lg_u32 s70, 0
s_cbranch_scc1 L_rk12
s_call_b64 s[36:37], L_rpoll
L_rk12:
s_ff1_i32_b32 s71, s70
s_bitset0_b32 s70, s71
s_mul_i32 s71, s71, 114688
SA s72,s71,s77
buffer_load_dwordx4 v[160:163], v7, s[8:11], s72 offen sc1
buffer_load_dwordx4 v[164:167], v27, s[8:11], s72 offen sc1
buffer_load_dword v8, v33, s[8:11], s46 offen sc1
s_waitcnt vmcnt(8)
M v[96:99],a[246:249],v[136:139],v[96:99]
M v[100:103],a[244:247],v[136:139],v[100:103]
s_waitcnt vmcnt(7)
M v[104:107],a[246:249],v[140:143],v[104:107]
M v[108:111],a[244:247],v[140:143],v[108:111]
s_cmp_lg_u32 s70, 0
s_cbranch_scc1 L_rk13
s_call_b64 s[36:37], L_rpoll
L_rk13:
s_ff1_i32_b32 s71, s70
s_bitset0_b32 s70, s71
s_mul_i32 s71, s71, 114688
SA s72,s71,s77
buffer_load_dwordx4 v[168:171], v7, s[8:11], s72 offen sc1
buffer_load_dwordx4 v[172:175], v27, s[8:11], s72 offen sc1
s_waitcnt vmcnt(8)
M v[96:99],a[246:249],v[144:147],v[96:99]
M v[100:103],a[244:247],v[144:147],v[100:103]
s_waitcnt vmcnt(7)
M v[104:107],a[246:249],v[148:151],v[104:107]
M v[108:111],a[244:247],v[148:151],v[108:111]
s_cmp_lg_u32 s70, 0
s_cbranch_scc1 L_rk14
s_call_b64 s[36:37], L_rpoll
L_rk14:
s_ff1_i32_b32 s71, s70
s_bitset0_b32 s70, s71
s_mul_i32 s71, s71, 114688
SA s72,s71,s77
buffer_load_dwordx4 v[176:179], v7, s[8:11], s72 offen sc1
buffer_load_dwordx4 v[180:183], v27, s[8:11], s72 offen sc1
s_waitcnt vmcnt(8)
M v[96:99],a[246:249],v[152:155],v[96:99]
M v[100:103],a[244:247],v[152:155],v[100:103]
s_waitcnt vmcnt(7)
M v[104:107],a[246:249],v[156:159],v[104:107]
M v[108:111],a[244:247],v[156:159],v[108:111]
s_cmp_lg_u32 s70, 0
s_cbranch_scc1 L_rk15
s_call_b64 s[36:37], L_rpoll
L_rk15:
s_ff1_i32_b32 s71, s70
s_bitset0_b32 s70, s71
s_mul_i32 s71, s71, 114688
SA s72,s71,s77
buffer_load_dwordx4 v[184:187], v7, s[8:11], s72 offen sc1
buffer_load_dwordx4 v[188:191], v27, s[8:11], s72 offen sc1
s_waitcnt vmcnt(8)
M v[96:99],a[246:249],v[160:163],v[96:99]
M v[100:103],a[244:247],v[160:163],v[100:103]
s_waitcnt vmcnt(7)
M v[104:107],a[246:249],v[164:167],v[104:107]
M v[108:111],a[244:247],v[164:167],v[108:111]
s_waitcnt vmcnt(6)
v_cmp_eq_u32 vcc, 1, v8
s_mov_b32 s69, 0xffff0000
s_and_b32 s70, vcc_lo, s69
s_mov_b32 s68, s70
s_cmp_lg_u32 s70, 0
s_cbranch_scc1 L_rk16
s_call_b64 s[36:37], L_rpoll
L_rk16:
s_ff1_i32_b32 s71, s70
s_bitset0_b32 s70, s71
s_mul_i32 s71, s71, 114688
SA s72,s71,s78
buffer_load_dwordx4 v[192:195], v7, s[8:11], s72 offen sc1
s_waitcnt vmcnt(6)
M v[96:99],a[246:249],v[168:171],v[96:99]
M v[100:103],a[244:247],v[168:171],v[100:103]
s_waitcnt vmcnt(5)
M v[104:107],a[246:249],v[172:175],v[104:107]
M v[108:111],a[244:247],v[172:175],v[108:111]
s_cmp_lg_u32 s70, 0
s_cbranch_scc1 L_rk17
s_call_b64 s[36:37], L_rpoll
L_rk17:
s_ff1_i32_b32 s71, s70
s_bitset0_b32 s70, s71
s_mul_i32 s71, s71, 114688
SA s72,s71,s78
buffer_load_dwordx4 v[196:199], v7, s[8:11], s72 offen sc1
s_waitcnt vmcnt(5)
M v[96:99],a[246:249],v[176:179],v[96:99]
M v[100:103],a[244:247],v[176:179],v[100:103]
s_waitcnt vmcnt(4)
M v[104:107],a[246:249],v[180:183],v[104:107]
M v[108:111],a[244:247],v[180:183],v[108:111]
s_cmp_lg_u32 s70, 0
s_cbranch_scc1 L_rk18
s_call_b64 s[36:37], L_rpoll
L_rk18:
s_ff1_i32_b32 s71, s70
s_bitset0_b32 s70, s71
s_mul_i32 s71, s71, 114688
SA s72,s71,s78
buffer_load_dwordx4 v[200:203], v7, s[8:11], s72 offen sc1
s_waitcnt vmcnt(4)
M v[96:99],a[246:249],v[184:187],v[96:99]
M v[100:103],a[244:247],v[184:187],v[100:103]
s_waitcnt vmcnt(3)
M v[104:107],a[246:249],v[188:191],v[104:107]
M v[108:111],a[244:247],v[188:191],v[108:111]
s_nop 4
v_permlane16_swap_b32 v96, v100
v_permlane16_swap_b32 v97, v101
v_permlane16_swap_b32 v98, v102
v_permlane16_swap_b32 v99, v103
v_permlane16_swap_b32 v104, v108
v_permlane16_swap_b32 v105, v109
v_permlane16_swap_b32 v106, v110
v_permlane16_swap_b32 v107, v111
v_fmac_f32 v64, v39, v96
v_fmac_f32 v65, v39, v97
v_fmac_f32 v66, v39, v98
v_fmac_f32 v67, v39, v99
v_fmac_f32 v68, v39, v100
v_fmac_f32 v69, v39, v101
v_fmac_f32 v70, v39, v102
v_fmac_f32 v71, v39, v103
C v48,v64,v65
C v49,v66,v67
C v50,v68,v69
C v51,v70,v71
buffer_store_dwordx4 v[48:51], v38, s[52:55], s75 offen sc1
v_fmac_f32 v72, v39, v104
v_fmac_f32 v73, v39, v105
v_fmac_f32 v74, v39, v106
v_fmac_f32 v75, v39, v107
v_fmac_f32 v76, v39, v108
v_fmac_f32 v77, v39, v109
v_fmac_f32 v78, v39, v110
v_fmac_f32 v79, v39, v111
C v52,v72,v73
C v53,v74,v75
C v54,v76,v77
C v55,v78,v79
buffer_store_dwordx4 v[52:55], v38, s[52:55], s76 offen sc1
s_cmp_lg_u32 s70, 0
s_cbranch_scc1 L_rk19
s_call_b64 s[36:37], L_rpoll
L_rk19:
s_ff1_i32_b32 s71, s70
s_bitset0_b32 s70, s71
s_mul_i32 s71, s71, 114688
SA s72,s71,s78
buffer_load_dwordx4 v[204:207], v7, s[8:11], s72 offen sc1
s_cmp_lg_u32 s70, 0
s_cbranch_scc1 L_rk20
s_call_b64 s[36:37], L_rpoll
L_rk20:
s_ff1_i32_b32 s71, s70
s_bitset0_b32 s70, s71
s_mul_i32 s71, s71, 114688
SA s72,s71,s78
buffer_load_dwordx4 v[208:211], v7, s[8:11], s72 offen sc1
s_cmp_lg_u32 s70, 0
s_cbranch_scc1 L_rk21
s_call_b64 s[36:37], L_rpoll
L_rk21:
s_ff1_i32_b32 s71, s70
s_bitset0_b32 s70, s71
s_mul_i32 s71, s71, 114688
SA s72,s71,s78
buffer_load_dwordx4 v[212:215], v7, s[8:11], s72 offen sc1
s_cmp_lg_u32 s70, 0
s_cbranch_scc1 L_rk22
s_call_b64 s[36:37], L_rpoll
L_rk22:
s_ff1_i32_b32 s71, s70
s_bitset0_b32 s70, s71
s_mul_i32 s71, s71, 114688
SA s72,s71,s78
buffer_load_dwordx4 v[216:219], v7, s[8:11], s72 offen sc1
s_cmp_lg_u32 s70, 0
s_cbranch_scc1 L_rk23
s_call_b64 s[36:37], L_rpoll
L_rk23:
s_ff1_i32_b32 s71, s70
s_bitset0_b32 s70, s71
s_mul_i32 s71, s71, 114688
SA s72,s71,s78
buffer_load_dwordx4 v[220:223], v7, s[8:11], s72 offen sc1
s_cmp_lg_u32 s70, 0
s_cbranch_scc1 L_rk24
s_call_b64 s[36:37], L_rpoll
L_rk24:
s_ff1_i32_b32 s71, s70
s_bitset0_b32 s70, s71
s_mul_i32 s71, s71, 114688
SA s72,s71,s78
buffer_load_dwordx4 v[224:227], v7, s[8:11], s72 offen sc1
s_cmp_lg_u32 s70, 0
s_cbranch_scc1 L_rk25
s_call_b64 s[36:37], L_rpoll
L_rk25:
s_ff1_i32_b32 s71, s70
s_bitset0_b32 s70, s71
s_mul_i32 s71, s71, 114688
SA s72,s71,s78
buffer_load_dwordx4 v[228:231], v7, s[8:11], s72 offen sc1
s_cmp_lg_u32 s70, 0
s_cbranch_scc1 L_rk26
s_call_b64 s[36:37], L_rpoll
L_rk26:
s_ff1_i32_b32 s71, s70
s_bitset0_b32 s70, s71
s_mul_i32 s71, s71, 114688
SA s72,s71,s78
buffer_load_dwordx4 v[232:235], v7, s[8:11], s72 offen sc1
s_cmp_lg_u32 s70, 0
s_cbranch_scc1 L_rk27
s_call_b64 s[36:37], L_rpoll
L_rk27:
s_ff1_i32_b32 s71, s70
s_bitset0_b32 s70, s71
s_mul_i32 s71, s71, 114688
SA s72,s71,s78
buffer_load_dwordx4 v[236:239], v7, s[8:11], s72 offen sc1
s_waitcnt vmcnt(13)
M v[112:115],a[246:249],v[192:195],0
M v[116:119],a[244:247],v[192:195],0
s_cmp_lg_u32 s70, 0
s_cbranch_scc1 L_rk28
s_call_b64 s[36:37], L_rpoll
L_rk28:
s_ff1_i32_b32 s71, s70
s_bitset0_b32 s70, s71
s_mul_i32 s71, s71, 114688
SA s72,s71,s78
buffer_load_dwordx4 v[240:243], v7, s[8:11], s72 offen sc1
s_waitcnt vmcnt(13)
M v[112:115],a[246:249],v[196:199],v[112:115]
M v[116:119],a[244:247],v[196:199],v[116:119]
s_cmp_lg_u32 s70, 0
s_cbranch_scc1 L_rk29
s_call_b64 s[36:37], L_rpoll
L_rk29:
s_ff1_i32_b32 s71, s70
s_bitset0_b32 s70, s71
s_mul_i32 s71, s71, 114688
SA s72,s71,s78
buffer_load_dwordx4 v[244:247], v7, s[8:11], s72 offen sc1
s_waitcnt vmcnt(13)
M v[112:115],a[246:249],v[200:203],v[112:115]
M v[116:119],a[244:247],v[200:203],v[116:119]
s_cmp_lg_u32 s70, 0
s_cbranch_scc1 L_rk30
s_call_b64 s[36:37], L_rpoll
L_rk30:
s_ff1_i32_b32 s71, s70
s_bitset0_b32 s70, s71
s_mul_i32 s71, s71, 114688
SA s72,s71,s78
buffer_load_dwordx4 v[248:251], v7, s[8:11], s72 offen sc1
s_waitcnt vmcnt(11)
M v[112:115],a[246:249],v[204:207],v[112:115]
M v[116:119],a[244:247],v[204:207],v[116:119]
s_cmp_lg_u32 s70, 0
s_cbranch_scc1 L_rk31
s_call_b64 s[36:37], L_rpoll
L_rk31:
s_ff1_i32_b32 s71, s70
s_bitset0_b32 s70, s71
s_mul_i32 s71, s71, 114688
SA s72,s71,s78
buffer_load_dwordx4 v[252:255], v7, s[8:11], s72 offen sc1
s_waitcnt vmcnt(11)
M v[112:115],a[246:249],v[208:211],v[112:115]
M v[116:119],a[244:247],v[208:211],v[116:119]
s_waitcnt vmcnt(10)
M v[112:115],a[246:249],v[212:215],v[112:115]
M v[116:119],a[244:247],v[212:215],v[116:119]
s_waitcnt vmcnt(9)
M v[112:115],a[246:249],v[216:219],v[112:115]
M v[116:119],a[244:247],v[216:219],v[116:119]
s_waitcnt vmcnt(8)
M v[112:115],a[246:249],v[220:223],v[112:115]
M v[116:119],a[244:247],v[220:223],v[116:119]
s_waitcnt vmcnt(7)
M v[112:115],a[246:249],v[224:227],v[112:115]
M v[116:119],a[244:247],v[224:227],v[116:119]
s_waitcnt vmcnt(6)
M v[112:115],a[246:249],v[228:231],v[112:115]
M v[116:119],a[244:247],v[228:231],v[116:119]
s_waitcnt vmcnt(5)
M v[112:115],a[246:249],v[232:235],v[112:115]
M v[116:119],a[244:247],v[232:235],v[116:119]
s_waitcnt vmcnt(4)
M v[112:115],a[246:249],v[236:239],v[112:115]
M v[116:119],a[244:247],v[236:239],v[116:119]
s_waitcnt vmcnt(3)
M v[112:115],a[246:249],v[240:243],v[112:115]
M v[116:119],a[244:247],v[240:243],v[116:119]
s_waitcnt vmcnt(2)
M v[112:115],a[246:249],v[244:247],v[112:115]
M v[116:119],a[244:247],v[244:247],v[116:119]
s_waitcnt vmcnt(1)
M v[112:115],a[246:249],v[248:251],v[112:115]
M v[116:119],a[244:247],v[248:251],v[116:119]
s_waitcnt vmcnt(0)
M v[112:115],a[246:249],v[252:255],v[112:115]
M v[116:119],a[244:247],v[252:255],v[116:119]
s_nop 7
v_permlane16_swap_b32 v112, v116
v_permlane16_swap_b32 v113, v117
v_permlane16_swap_b32 v114, v118
v_permlane16_swap_b32 v115, v119
v_fmac_f32 v80, v26, v112
v_fmac_f32 v81, v26, v113
v_fmac_f32 v82, v26, v114
v_fmac_f32 v83, v26, v115
v_fmac_f32 v84, v26, v116
v_fmac_f32 v85, v26, v117
v_fmac_f32 v86, v26, v118
v_fmac_f32 v87, v26, v119
C v44,v80,v81
C v45,v82,v83
C v46,v84,v85
C v47,v86,v87
buffer_store_dwordx4 v[44:47], v28, s[52:55], s79 offen sc1
s_endpgm
L_rpoll0:
s_sleep 1
L_rpoll:
buffer_load_dword v9, v33, s[8:11], s46 offen sc1
s_waitcnt vmcnt(0)
v_cmp_eq_u32 vcc, 1, v9
s_sub_u32 s91, s91, 1
s_cselect_b32 s70, -1, 0
s_or_b32 s70, s70, vcc_lo
s_and_b32 s70, s70, s69
s_andn2_b32 s70, s70, s68
s_cbranch_scc0 L_rpoll0
s_or_b32 s68, s68, s70
s_setpc_b64 s[36:37]
L_moe0:
s_lshl_b32 s88, s75, 1
s_call_b64 s[36:37], L_moe
AF v64,v2,v64
AF v65,v3,v65
AF v66,v4,v66
AF v67,v5,v67
AF v68,v10,v68
AF v69,v11,v69
AF v70,v12,v70
AF v71,v13,v71
AF v72,v14,v72
AF v73,v15,v73
AF v74,v16,v74
AF v75,v17,v75
AF v76,v18,v76
AF v77,v19,v77
AF v78,v20,v78
AF v79,v21,v79
s_mov_b64 exec, -1
s_branch L_moe_ret0
L_moe1:
s_lshl_b32 s88, s79, 1
s_call_b64 s[36:37], L_moe
AF v80,v2,v80
AF v81,v3,v81
AF v82,v4,v82
AF v83,v5,v83
AF v84,v10,v84
AF v85,v11,v85
AF v86,v12,v86
AF v87,v13,v87
s_mov_b64 exec, -1
s_branch L_moe_ret1
L_moe2:
s_lshl_b32 s88, s79, 1
s_call_b64 s[36:37], L_moe
AF v48,v2,v48
AF v49,v3,v49
AF v50,v4,v50
AF v51,v5,v51
AF v52,v10,v52
AF v53,v11,v53
AF v54,v12,v54
AF v55,v13,v55
s_mov_b64 exec, -1
s_branch L_moe_ret2
L_moe:
v_min_u32 v0, 27, v32
v_lshlrev_b32 v0, 2, v0
s_mov_b32 s64, 105062912
s_mov_b32 s65, 65536
s_mov_b32 exec_lo, 0xffffffff
s_mov_b32 exec_hi, 0xffffffff
L_pfy:
buffer_load_dword v1, v0, s[8:11], s64 offen sc1
s_sub_u32 s65, s65, 1
s_cbranch_scc1 L_pfy_x
s_waitcnt vmcnt(0)
v_cmp_ne_u32 vcc, 1, v1
s_nop 0
s_cbranch_vccz L_pfy_x
s_sleep 2
s_branch L_pfy
L_pfy_x:
s_waitcnt vmcnt(0)
s_mov_b64 exec, -1
s_or_b64 exec, s[80:81], s[82:83]
v_mov_b32 v0, 1792
v_cndmask_b32 v0, v0, 0, s[80:81]
v_lshl_add_u32 v0, v34, 5, v0
SA s88,s88,104898560
buffer_load_dwordx4 v[2:5], v0, s[8:11], s88 offen sc1
buffer_load_dwordx4 v[10:13], v0, s[8:11], s88 offen offset:16 sc1
buffer_load_dwordx4 v[14:17], v0, s[8:11], s88 offen offset:512 sc1
buffer_load_dwordx4 v[18:21], v0, s[8:11], s88 offen offset:528 sc1
s_waitcnt vmcnt(0)
s_setpc_b64 s[36:37]
L_red:
v_lshrrev_b32 v32, 4, v7
s_lshr_b32 s74, s41, 3
s_lshl_b32 s64, s42, 1
SA s46,s64,s74
s_mul_i32 s46, s46, 4352
s_and_b32 s72, s41, 7
s_lshl_b32 s65, s72, 7
SA s46,s46,s65
SA s46,s46,104992768
v_and_b32 v33, 31, v32
v_lshlrev_b32 v33, 2, v33
s_lshl_b32 s65, s41, 7
SA s65,s65,104890368
buffer_load_dword v31, v33, s[8:11], s65 offen sc1
v_bfe_u32 v34, v32, 4, 1
v_lshlrev_b32 v34, 1, v34
v_lshrrev_b32 v35, 5, v32
v_add_u32 v34, v34, v35
s_mov_b32 s52, s96
s_and_b32 s53, s97, 0xffff
s_mov_b32 s54, 1835008
s_mov_b32 s55, 0x20000
s_mul_i32 s77, s42, 1835008
s_mul_i32 s78, s72, 14336
SA s77,s77,s78
SA s77,s77,67108864
s_lshl_b32 s79, s74, 1
SA s79,s79,s20
s_lshl_b32 s71, s74, 1
SA s71,s71,1
s_sub_u32 s71, s71, s20
s_and_b32 s71, s71, 536870912
s_sub_u32 s64, 15, s64
s_sub_u32 s78, s64, 1
s_mul_i32 s78, s78, 1835008
SA s78,s78,s77
s_lshl_b32 s65, s79, 10
SA s78,s78,s65
SA s78,s78,s71
s_lshl_b32 s79, s79, 6
s_or_b32 s79, s79, s71
s_mul_i32 s67, s74, -2
s_lshl_b32 s74, s74, 3
SA s74,s74,s20
s_lshl_b32 s75, s74, 6
SA s76,s75,256
SA s67,s67,3
s_sub_u32 s67, s67, s20
s_and_b32 s67, s67, 536870912
s_or_b32 s76, s76, s67
v_or_b32 v27, s67, v7
v_add_u32 v27, 4096, v27
s_lshl_b32 s65, s74, 10
SA s77,s77,s65
s_lshl_b32 s64, s64, 7
s_lshr_b32 s73, s72, 1
s_sub_u32 s65, 7, s73
s_bitcmp1_b32 s72, 0
s_cselect_b32 s73, s65, s73
s_lshl_b32 s73, s73, 4
s_lshl_b32 s65, s42, 7
SA s73,s73,s65
v_and_b32 v37, 15, v32
v_add_u32 v37, s73, v37
v_add_u32 v29, s64, v37
s_mov_b32 s64, 104857664
v_mul_u32_u24 v38, 896, v37
v_lshl_add_u32 v38, v34, 4, v38
v_lshrrev_b32 v35, 4, v37
v_lshlrev_b32 v35, 5, v35
v_and_b32 v36, 15, v37
v_add_lshl_u32 v35, v35, v36, 2
buffer_load_dword v39, v35, s[8:11], s64 offen sc1
buffer_load_dwordx4 v[48:51], v38, s[56:59], s75 offen
buffer_load_dwordx4 v[52:55], v38, s[56:59], s76 offen
v_mul_u32_u24 v28, 896, v29
v_lshl_add_u32 v28, v34, 4, v28
v_lshrrev_b32 v35, 4, v29
v_lshlrev_b32 v35, 5, v35
v_and_b32 v36, 15, v29
v_add_lshl_u32 v35, v35, v36, 2
buffer_load_dword v26, v35, s[8:11], s64 offen sc1
buffer_load_dwordx4 v[44:47], v28, s[56:59], s79 offen
s_waitcnt vmcnt(7)
buffer_load_dword v9, v33, s[8:11], s46 offen sc1
s_branch L_red1
L_code_end:
.section .rodata,"a"
.p2align 6
.amdhsa_kernel gated_mix__compressed_kv_cla__moe_arch_mod__prompt_kernel
  .amdhsa_next_free_vgpr 512
  .amdhsa_next_free_sgpr 102
  .amdhsa_accum_offset 256
  .amdhsa_group_segment_fixed_size 0
  .amdhsa_kernarg_size 120
  .amdhsa_user_sgpr_count 2
  .amdhsa_user_sgpr_kernarg_segment_ptr 1
  .amdhsa_system_sgpr_workgroup_id_x 1
  .amdhsa_float_denorm_mode_32 3
.end_amdhsa_kernel
```

```asm
; @launch grid=(256,1,1) block=(256,1,1) lds=163840
.amdgcn_target "amdgcn-amd-amdhsa--gfx950"
.text
.macro M a, b, c, d
v_mfma_f32_16x16x32_bf16 \a, \b, \c, \d
.endm
.macro R a, b, c
ds_read_b128 \a, \b offset:\c
.endm
.macro T a, b, c
ds_read_b64_tr_b16 \a, \b offset:\c
.endm
.macro C a, b, c
v_cvt_pk_bf16_f32 \a, \b, \c
.endm
.macro E a, b
v_exp_f32 \a, \b
.endm
.macro W a, b
v_accvgpr_write_b32 \a, \b
.endm
.macro G a, b
v_accvgpr_read_b32 \a, \b
.endm
.macro AF a, b, c
v_add_f32 \a, \b, \c
.endm
.macro MF a, b, c
v_mul_f32 \a, \b, \c
.endm
.macro SA a, b, c
s_add_u32 \a, \b, \c
.endm
.globl gated_mix__compressed_kv_cla__moe_arch_mod__prompt_kernel
.p2align 8
.type gated_mix__compressed_kv_cla__moe_arch_mod__prompt_kernel,@function
gated_mix__compressed_kv_cla__moe_arch_mod__prompt_kernel:
s_cmp_lt_u32 s2, 256
s_cbranch_scc1 L_go
s_endpgm
L_go:
s_load_dwordx8 s[80:87], s[0:1], 0
s_load_dwordx4 s[88:91], s[0:1], 32
s_getpc_b64 s[76:77]
L_pc0:
s_lshr_b32 s42, s2, 3
s_mov_b32 s79, 0x20000
s_lshl_b32 s67, s42, 13
s_mov_b32 s78, L_code_end-L_pc0
s_and_b32 s77, s77, 0xffff
v_lshl_add_u32 v31, v0, 5, s67
buffer_load_dword a240, v31, s[76:79], 0 offen offset:0
v_lshrrev_b32 v24, 6, v0
v_and_b32 v0, 63, v0
s_and_b32 s41, s2, 7
v_readfirstlane_b32 s20, v24
s_lshr_b32 s64, s2, 4
v_and_b32 v24, 15, v0
v_lshrrev_b32 v25, 4, v0
s_and_b32 s64, s64, 8
s_or_b32 s41, s41, s64
v_lshlrev_b32 v28, 1, v25
v_xor_b32 v28, v28, v24
v_and_b32 v29, 8, v28
v_and_b32 v28, 7, v28
v_lshlrev_b32 v28, 4, v28
v_lshl_add_u32 v28, v29, 5, v28
v_lshl_add_u32 v28, v25, 13, v28
s_lshl_b32 s64, s20, 17
v_add_u32 v8, s64, v28
v_xor_b32 v28, 0x100, v8
v_add_u32 v9, 31744, v8
v_add_u32 v10, 63488, v28
v_add_u32 v11, 95232, v28
s_mov_b32 s21, 0
s_lshl_b32 s23, s20, 12
s_lshl_b32 s74, s41, 9
s_sub_u32 s18, 8388608, s74
s_mov_b32 s19, s79
s_bitcmp0_b32 s2, 6
s_waitcnt lgkmcnt(0)
s_cselect_b64 s[72:73], s[86:87], s[88:89]
SA s16,s72,s74
s_addc_u32 s73, s73, 0
s_and_b32 s17, s73, 0xffff
SA m0,s23,0
s_nop 0
buffer_load_dwordx4 v8, s[16:19], s21 offen offset:0  nt lds
buffer_load_dwordx4 v9, s[16:19], s21 offen offset:1024  nt lds
buffer_load_dwordx4 v10, s[16:19], s21 offen offset:2048  nt lds
buffer_load_dwordx4 v11, s[16:19], s21 offen offset:3072  nt lds
SA s21,s21,128
s_and_b32 s42, s42, 15
s_lshr_b32 s45, s42, 3
s_and_b32 s65, s20, 1
s_lshr_b32 s66, s20, 1
v_and_b32 v29, 7, v0
v_xor_b32 v28, v25, v29
v_lshlrev_b32 v28, 4, v28
v_lshrrev_b32 v29, 3, v0
v_lshl_add_u32 v30, v29, 11, v28
s_lshl_b32 s64, s66, 19
s_lshl_b32 s67, s65, 21
SA s64,s64,s67
v_add_u32 v12, s64, v30
v_xor_b32 v30, 64, v12
v_add_u32 v14, 30720, v12
v_add_u32 v13, 15360, v30
v_add_u32 v15, 46080, v30
s_mov_b32 s22, 0
SA s24,s23,65536
s_and_b32 s64, s42, 7
s_lshl_b32 s64, s64, 16
s_sub_u32 s50, 4194304, s64
s_mov_b32 s51, s79
SA s48,s82,s64
s_addc_u32 s73, s83, 0
s_and_b32 s49, s73, 0xffff
SA m0,s23,16384
s_nop 0
buffer_load_dwordx4 v8, s[16:19], s21 offen offset:0  nt lds
buffer_load_dwordx4 v9, s[16:19], s21 offen offset:1024  nt lds
buffer_load_dwordx4 v10, s[16:19], s21 offen offset:2048  nt lds
buffer_load_dwordx4 v11, s[16:19], s21 offen offset:3072  nt lds
SA s21,s21,524160
SA m0,s24,0
s_nop 0
buffer_load_dwordx4 v12, s[48:51], s22 offen offset:0   lds
buffer_load_dwordx4 v13, s[48:51], s22 offen offset:1024   lds
buffer_load_dwordx4 v14, s[48:51], s22 offen offset:2048   lds
buffer_load_dwordx4 v15, s[48:51], s22 offen offset:3072   lds
SA s22,s22,1048576
s_load_dwordx2 s[92:93], s[0:1], 56
s_load_dwordx2 s[94:95], s[0:1], 88
s_load_dwordx4 s[4:7], s[0:1], 104
v_lshlrev_b32 v7, 4, v0
v_lshrrev_b32 v26, 2, v24
v_and_b32 v28, 1, v25
v_lshl_or_b32 v28, v28, 2, v26
v_lshl_add_u32 v29, v25, 3, v26
v_lshlrev_b32 v29, 8, v29
v_and_b32 v30, 3, v0
v_lshl_add_u32 v29, v30, 3, v29
s_lshl_b32 s64, s65, 2
SA s64,s64,0
v_xor_b32 v30, s64, v28
v_lshl_add_u32 v1, v30, 5, v29
s_lshl_b32 s64, s65, 2
SA s64,s64,1
v_xor_b32 v30, s64, v28
v_lshl_add_u32 v2, v30, 5, v29
s_lshl_b32 s64, s65, 2
SA s64,s64,2
v_xor_b32 v30, s64, v28
v_lshl_add_u32 v3, v30, 5, v29
s_lshl_b32 s64, s65, 2
SA s64,s64,3
v_xor_b32 v30, s64, v28
v_lshl_add_u32 v4, v30, 5, v29
v_add_u32 v28, 0, v25
v_lshrrev_b32 v29, 1, v24
v_xor_b32 v28, v28, v29
v_lshlrev_b32 v28, 4, v28
v_lshl_add_u32 v28, v24, 7, v28
s_lshl_b32 s64, s66, 13
SA s64,s64,65536
v_add_u32 v5, s64, v28
v_add_u32 v28, 4, v25
v_lshrrev_b32 v29, 1, v24
v_xor_b32 v28, v28, v29
v_lshlrev_b32 v28, 4, v28
v_lshl_add_u32 v28, v24, 7, v28
s_lshl_b32 s64, s66, 13
SA s64,s64,65536
v_add_u32 v6, s64, v28
s_mov_b32 s56, s80
s_and_b32 s57, s81, 0xffff
s_mov_b32 s58, 1835008
s_mov_b32 s59, 0x20000
s_waitcnt lgkmcnt(0)
s_mov_b32 s60, s92
s_and_b32 s61, s93, 0xffff
s_mov_b32 s62, 896
s_mov_b32 s63, 0x20000
s_mov_b32 s68, s94
s_and_b32 s69, s95, 0xffff
s_mov_b32 s70, 896
s_mov_b32 s71, 0x20000
s_lshl_b32 s95, s20, 11
s_lshr_b32 s64, s2, 3
s_lshl_b32 s64, s64, 13
SA s95,s95,s64
s_mov_b32 s8, s6
s_and_b32 s9, s7, 0xffff
s_mov_b32 s10, 268435456
s_mov_b32 s11, 0x20000
s_mov_b32 s12, s4
s_and_b32 s13, s5, 0xffff
s_mov_b32 s14, 256
s_mov_b32 s15, 0x20000
SA s72,s84,s74
s_addc_u32 s73, s85, 0
s_sub_u32 s75, 3670016, s74
s_mov_b32 s52, s72
s_and_b32 s53, s73, 0xffff
s_mov_b32 s54, s75
s_mov_b32 s55, 0x20000
s_mul_i32 s29, s42, 114688
s_mov_b32 s5, 0x3db8aa3b
s_mul_i32 s72, s45, 16777216
s_mul_i32 s73, s41, 1048576
SA s72,s72,s73
s_bfe_u32 s64, s42, 0x20001
s_lshl_b32 s64, s64, 15
SA s72,s72,s64
s_lshl_b32 s64, s66, 17
SA s72,s72,s64
s_and_b32 s67, s42, 1
s_cmp_eq_u32 s45, 0
s_cselect_b32 s64, 12, 14
s_cselect_b32 s75, 14, 10
s_lshl_b32 s67, s67, s75
SA s72,s72,s67
s_lshl_b32 s64, s65, s64
SA s93,s72,s64
s_load_dwordx4 s[80:83], s[0:1], 64
s_load_dwordx2 s[84:85], s[0:1], 80
s_load_dwordx2 s[96:97], s[0:1], 96
s_cmp_eq_u32 s45, 0
s_cbranch_scc0 L_kv1
s_branch L_kv0
.p2align 12
L_kv0:
s_and_b32 s31, s42, 7
s_lshl_b32 s64, s42, 4
SA s64,s64,s41
s_lshl_b32 s64, s64, 2
SA s64,s64,s20
s_cmp_lt_u32 s64, 41
s_cselect_b32 s39, 0, 536870912
s_min_u32 s64, s64, 41
s_lshl_b32 s38, s64, 2
s_max_u32 s67, s64, 8
s_sub_u32 s67, s67, 8
s_mul_i32 s67, s67, 3328
s_lshl_b32 s64, s64, 10
SA s64,s64,s67
SA s73,s64,104914944
v_or_b32 v64, s39, v7
v_mov_b32 v68, 0
v_mov_b32 v69, 0
v_mov_b32 v70, 0
v_mov_b32 v71, 0
buffer_store_dwordx4 v[68:71], v64, s[8:11], s73 offen offset:0 sc1
buffer_store_dwordx4 v[68:71], v64, s[8:11], s73 offen offset:1024 sc1
buffer_store_dwordx4 v[68:71], v64, s[8:11], s73 offen offset:2048 sc1
SA m0,s24,16384
s_nop 0
buffer_load_dwordx4 v12, s[48:51], s22 offen offset:0   lds
buffer_load_dwordx4 v13, s[48:51], s22 offen offset:1024   lds
buffer_load_dwordx4 v14, s[48:51], s22 offen offset:2048   lds
buffer_load_dwordx4 v15, s[48:51], s22 offen offset:3072   lds
s_sub_u32 s22, s22, 1048448
SA m0,s23,32768
s_nop 0
buffer_load_dwordx4 v8, s[16:19], s21 offen offset:0  nt lds
buffer_load_dwordx4 v9, s[16:19], s21 offen offset:1024  nt lds
buffer_load_dwordx4 v10, s[16:19], s21 offen offset:2048  nt lds
buffer_load_dwordx4 v11, s[16:19], s21 offen offset:3072  nt lds
SA s21,s21,128
s_mov_b64 exec, 0
s_cmp_eq_u32 s20, 0
s_cbranch_scc1 L_w_kv01
s_cmp_eq_u32 s20, 1
s_cbranch_scc1 L_w_kv02
s_cmp_eq_u32 s20, 2
s_cbranch_scc1 L_w_kv03
s_branch L_w_kv04
L_wd1:
s_mov_b64 exec, -1
s_waitcnt vmcnt(11) lgkmcnt(0)
s_barrier
R a[160:163],v5,0
R a[164:167],v6,0
T a[96:97],v1,0
T a[98:99],v1,1024
T a[100:101],v1,8192
T a[102:103],v1,9216
T a[104:105],v2,0
T a[106:107],v2,1024
T a[108:109],v2,8192
T a[110:111],v2,9216
T a[112:113],v3,0
T a[114:115],v3,1024
T a[116:117],v3,8192
T a[118:119],v3,9216
T a[120:121],v4,0
T a[122:123],v4,1024
T a[124:125],v4,8192
T a[126:127],v4,9216
T a[128:129],v1,16384
T a[130:131],v1,17408
T a[132:133],v1,24576
T a[134:135],v1,25600
T a[136:137],v2,16384
T a[138:139],v2,17408
T a[140:141],v2,24576
T a[142:143],v2,25600
T a[144:145],v3,16384
T a[146:147],v3,17408
T a[148:149],v3,24576
T a[150:151],v3,25600
T a[152:153],v4,16384
T a[154:155],v4,17408
T a[156:157],v4,24576
T a[158:159],v4,25600
s_waitcnt lgkmcnt(15)
M a[0:3],a[96:99],a[160:163],0
SA m0,s23,49152
R a[168:171],v5,2048
R a[172:175],v6,2048
M a[0:3],a[100:103],a[164:167],a[0:3]
buffer_load_dwordx4 v8, s[16:19], s21 offen offset:0  nt lds
M a[4:7],a[108:111],a[164:167],0
M a[4:7],a[104:107],a[160:163],a[4:7]
M a[8:11],a[112:115],a[160:163],0
buffer_load_dwordx4 v9, s[16:19], s21 offen offset:1024  nt lds
M a[8:11],a[116:119],a[164:167],a[8:11]
s_waitcnt lgkmcnt(14)
M a[12:15],a[124:127],a[164:167],0
M a[12:15],a[120:123],a[160:163],a[12:15]
M a[16:19],a[128:131],a[160:163],0
buffer_load_dwordx4 v10, s[16:19], s21 offen offset:2048  nt lds
M a[16:19],a[132:135],a[164:167],a[16:19]
s_waitcnt lgkmcnt(6)
M a[20:23],a[140:143],a[164:167],0
M a[20:23],a[136:139],a[160:163],a[20:23]
buffer_load_dwordx4 v11, s[16:19], s21 offen offset:3072  nt lds
M a[24:27],a[144:147],a[160:163],0
SA s21,s21,524160
M a[24:27],a[148:151],a[164:167],a[24:27]
s_waitcnt lgkmcnt(0)
M a[28:31],a[156:159],a[164:167],0
SA m0,s24,32768
M a[28:31],a[152:155],a[160:163],a[28:31]
buffer_load_dwordx4 v12, s[48:51], s22 offen offset:0   lds
M v[32:35],a[96:99],a[168:171],0
R a[160:163],v5,4096
R a[164:167],v6,4096
M v[32:35],a[100:103],a[172:175],v[32:35]
M v[36:39],a[108:111],a[172:175],0
M v[36:39],a[104:107],a[168:171],v[36:39]
buffer_load_dwordx4 v13, s[48:51], s22 offen offset:1024   lds
M v[40:43],a[112:115],a[168:171],0
M v[40:43],a[116:119],a[172:175],v[40:43]
M v[44:47],a[124:127],a[172:175],0
buffer_load_dwordx4 v14, s[48:51], s22 offen offset:2048   lds
M v[44:47],a[120:123],a[168:171],v[44:47]
M v[48:51],a[128:131],a[168:171],0
M v[48:51],a[132:135],a[172:175],v[48:51]
M v[52:55],a[140:143],a[172:175],0
buffer_load_dwordx4 v15, s[48:51], s22 offen offset:3072   lds
M v[52:55],a[136:139],a[168:171],v[52:55]
SA s22,s22,1048576
M v[56:59],a[144:147],a[168:171],0
M v[56:59],a[148:151],a[172:175],v[56:59]
s_waitcnt lgkmcnt(0)
M v[60:63],a[156:159],a[172:175],0
M v[60:63],a[152:155],a[168:171],v[60:63]
M v[64:67],a[96:99],a[160:163],0
R a[168:171],v5,6144
R a[172:175],v6,6144
M v[64:67],a[100:103],a[164:167],v[64:67]
M v[68:71],a[108:111],a[164:167],0
M v[68:71],a[104:107],a[160:163],v[68:71]
M v[72:75],a[112:115],a[160:163],0
M v[72:75],a[116:119],a[164:167],v[72:75]
M v[76:79],a[124:127],a[164:167],0
M v[76:79],a[120:123],a[160:163],v[76:79]
M v[80:83],a[128:131],a[160:163],0
M v[80:83],a[132:135],a[164:167],v[80:83]
M v[84:87],a[140:143],a[164:167],0
M v[84:87],a[136:139],a[160:163],v[84:87]
M v[88:91],a[144:147],a[160:163],0
M v[88:91],a[148:151],a[164:167],v[88:91]
s_waitcnt lgkmcnt(0)
M v[92:95],a[156:159],a[164:167],0
s_waitcnt vmcnt(12)
M v[92:95],a[152:155],a[160:163],v[92:95]
s_barrier
M v[96:99],a[96:99],a[168:171],0
SA m0,s23,0
R a[160:163],v5,16384
R a[164:167],v6,16384
M v[96:99],a[100:103],a[172:175],v[96:99]
buffer_load_dwordx4 v8, s[16:19], s21 offen offset:0  nt lds
M v[100:103],a[108:111],a[172:175],0
v_lshlrev_b32 v26, 7, v0
v_and_b32 v27, 48, v0
M v[100:103],a[104:107],a[168:171],v[100:103]
v_lshl_add_u32 v26, v27, 24, v26
M v[104:107],a[112:115],a[168:171],0
buffer_load_dwordx4 v9, s[16:19], s21 offen offset:1024  nt lds
M v[104:107],a[116:119],a[172:175],v[104:107]
M v[108:111],a[124:127],a[172:175],0
M v[108:111],a[120:123],a[168:171],v[108:111]
buffer_load_dwordx4 v10, s[16:19], s21 offen offset:2048  nt lds
M v[112:115],a[128:131],a[168:171],0
M v[112:115],a[132:135],a[172:175],v[112:115]
M v[116:119],a[140:143],a[172:175],0
M v[116:119],a[136:139],a[168:171],v[116:119]
buffer_load_dwordx4 v11, s[16:19], s21 offen offset:3072  nt lds
M v[120:123],a[144:147],a[168:171],0
SA s21,s21,128
M v[120:123],a[148:151],a[172:175],v[120:123]
s_waitcnt lgkmcnt(0)
M v[124:127],a[156:159],a[172:175],0
SA m0,s24,49152
M v[124:127],a[152:155],a[168:171],v[124:127]
buffer_load_dwordx4 v12, s[48:51], s22 offen offset:0   lds
M v[128:131],a[96:99],a[160:163],0
R a[168:171],v5,18432
R a[172:175],v6,18432
M v[128:131],a[100:103],a[164:167],v[128:131]
buffer_load_dwordx4 v13, s[48:51], s22 offen offset:1024   lds
M v[132:135],a[108:111],a[164:167],0
M v[132:135],a[104:107],a[160:163],v[132:135]
M v[136:139],a[112:115],a[160:163],0
M v[136:139],a[116:119],a[164:167],v[136:139]
buffer_load_dwordx4 v14, s[48:51], s22 offen offset:2048   lds
M v[140:143],a[124:127],a[164:167],0
M v[140:143],a[120:123],a[160:163],v[140:143]
M v[144:147],a[128:131],a[160:163],0
buffer_load_dwordx4 v15, s[48:51], s22 offen offset:3072   lds
M v[144:147],a[132:135],a[164:167],v[144:147]
s_sub_u32 s22, s22, 1048448
M v[148:151],a[140:143],a[164:167],0
M v[148:151],a[136:139],a[160:163],v[148:151]
M v[152:155],a[144:147],a[160:163],0
M v[152:155],a[148:151],a[164:167],v[152:155]
s_waitcnt lgkmcnt(0)
M v[156:159],a[156:159],a[164:167],0
s_waitcnt vmcnt(12)
M v[156:159],a[152:155],a[160:163],v[156:159]
s_barrier
M v[160:163],a[96:99],a[168:171],0
SA m0,s23,16384
R a[160:163],v5,20480
R a[164:167],v6,20480
M v[160:163],a[100:103],a[172:175],v[160:163]
T a[32:33],v1,32768
T a[34:35],v1,33792
M v[164:167],a[108:111],a[172:175],0
T a[36:37],v1,40960
T a[38:39],v1,41984
M v[164:167],a[104:107],a[168:171],v[164:167]
T a[40:41],v2,32768
T a[42:43],v2,33792
M v[168:171],a[112:115],a[168:171],0
T a[44:45],v2,40960
T a[46:47],v2,41984
M v[168:171],a[116:119],a[172:175],v[168:171]
buffer_load_dwordx4 v8, s[16:19], s21 offen offset:0  nt lds
M v[172:175],a[124:127],a[172:175],0
s_nop 0
T a[48:49],v3,32768
T a[50:51],v3,33792
M v[172:175],a[120:123],a[168:171],v[172:175]
buffer_load_dwordx4 v9, s[16:19], s21 offen offset:1024  nt lds
M v[176:179],a[128:131],a[168:171],0
s_nop 0
T a[52:53],v3,40960
T a[54:55],v3,41984
M v[176:179],a[132:135],a[172:175],v[176:179]
T a[56:57],v4,32768
T a[58:59],v4,33792
M v[180:183],a[140:143],a[172:175],0
buffer_load_dwordx4 v10, s[16:19], s21 offen offset:2048  nt lds
M v[180:183],a[136:139],a[168:171],v[180:183]
s_nop 0
T a[60:61],v4,40960
T a[62:63],v4,41984
M v[184:187],a[144:147],a[168:171],0
buffer_load_dwordx4 v11, s[16:19], s21 offen offset:3072  nt lds
M v[184:187],a[148:151],a[172:175],v[184:187]
s_waitcnt lgkmcnt(15)
s_nop 0
T a[64:65],v1,49152
T a[66:67],v1,50176
M v[188:191],a[156:159],a[172:175],0
SA s21,s21,524160
T a[68:69],v1,57344
T a[70:71],v1,58368
M v[188:191],a[152:155],a[168:171],v[188:191]
SA m0,s24,0
M v[192:195],a[96:99],a[160:163],0
R a[168:171],v5,22528
R a[172:175],v6,22528
M v[192:195],a[100:103],a[164:167],v[192:195]
T a[72:73],v2,49152
T a[74:75],v2,50176
M v[196:199],a[108:111],a[164:167],0
T a[76:77],v2,57344
T a[78:79],v2,58368
M v[196:199],a[104:107],a[160:163],v[196:199]
T a[80:81],v3,49152
T a[82:83],v3,50176
M v[200:203],a[112:115],a[160:163],0
buffer_load_dwordx4 v12, s[48:51], s22 offen offset:0   lds
M v[200:203],a[116:119],a[164:167],v[200:203]
s_nop 0
T a[84:85],v3,57344
T a[86:87],v3,58368
M v[204:207],a[124:127],a[164:167],0
T a[88:89],v4,49152
T a[90:91],v4,50176
M v[204:207],a[120:123],a[160:163],v[204:207]
buffer_load_dwordx4 v13, s[48:51], s22 offen offset:1024   lds
M v[208:211],a[128:131],a[160:163],0
s_nop 0
T a[92:93],v4,57344
T a[94:95],v4,58368
M v[208:211],a[132:135],a[164:167],v[208:211]
buffer_load_dwordx4 v14, s[48:51], s22 offen offset:2048   lds
M v[212:215],a[140:143],a[164:167],0
buffer_load_dwordx4 v15, s[48:51], s22 offen offset:3072   lds
M v[212:215],a[136:139],a[160:163],v[212:215]
SA s22,s22,1048576
M v[216:219],a[144:147],a[160:163],0
M v[216:219],a[148:151],a[164:167],v[216:219]
s_waitcnt lgkmcnt(12)
M v[220:223],a[156:159],a[164:167],0
s_waitcnt vmcnt(12) lgkmcnt(0)
M v[220:223],a[152:155],a[160:163],v[220:223]
s_barrier
M v[224:227],a[96:99],a[168:171],0
SA m0,s23,32768
R a[160:163],v5,32768
R a[164:167],v6,32768
M v[224:227],a[100:103],a[172:175],v[224:227]
buffer_load_dwordx4 v8, s[16:19], s21 offen offset:0  nt lds
M v[228:231],a[108:111],a[172:175],0
M v[228:231],a[104:107],a[168:171],v[228:231]
M v[232:235],a[112:115],a[168:171],0
buffer_load_dwordx4 v9, s[16:19], s21 offen offset:1024  nt lds
M v[232:235],a[116:119],a[172:175],v[232:235]
M v[236:239],a[124:127],a[172:175],0
M v[236:239],a[120:123],a[168:171],v[236:239]
buffer_load_dwordx4 v10, s[16:19], s21 offen offset:2048  nt lds
M v[240:243],a[128:131],a[168:171],0
M v[240:243],a[132:135],a[172:175],v[240:243]
M v[244:247],a[140:143],a[172:175],0
buffer_load_dwordx4 v11, s[16:19], s21 offen offset:3072  nt lds
M v[244:247],a[136:139],a[168:171],v[244:247]
SA s21,s21,128
M v[248:251],a[144:147],a[168:171],0
M v[248:251],a[148:151],a[172:175],v[248:251]
s_waitcnt lgkmcnt(0)
M v[252:255],a[156:159],a[172:175],0
M v[252:255],a[152:155],a[168:171],v[252:255]
M a[0:3],a[32:35],a[160:163],a[0:3]
R a[168:171],v5,34816
R a[172:175],v6,34816
M a[0:3],a[36:39],a[164:167],a[0:3]
T a[96:97],v1,0
T a[98:99],v1,1024
M a[4:7],a[44:47],a[164:167],a[4:7]
SA m0,s24,16384
M a[4:7],a[40:43],a[160:163],a[4:7]
buffer_load_dwordx4 v12, s[48:51], s22 offen offset:0   lds
M a[8:11],a[48:51],a[160:163],a[8:11]
M a[8:11],a[52:55],a[164:167],a[8:11]
M a[12:15],a[60:63],a[164:167],a[12:15]
s_nop 0
T a[100:101],v1,8192
T a[102:103],v1,9216
M a[12:15],a[56:59],a[160:163],a[12:15]
M a[16:19],a[64:67],a[160:163],a[16:19]
buffer_load_dwordx4 v13, s[48:51], s22 offen offset:1024   lds
M a[16:19],a[68:71],a[164:167],a[16:19]
M a[20:23],a[76:79],a[164:167],a[20:23]
M a[20:23],a[72:75],a[160:163],a[20:23]
s_nop 0
T a[104:105],v2,0
T a[106:107],v2,1024
M a[24:27],a[80:83],a[160:163],a[24:27]
M a[24:27],a[84:87],a[164:167],a[24:27]
s_waitcnt lgkmcnt(6)
buffer_load_dwordx4 v14, s[48:51], s22 offen offset:2048   lds
M a[28:31],a[92:95],a[164:167],a[28:31]
M a[28:31],a[88:91],a[160:163],a[28:31]
M v[32:35],a[32:35],a[168:171],v[32:35]
R a[160:163],v5,36864
R a[164:167],v6,36864
M v[32:35],a[36:39],a[172:175],v[32:35]
T a[108:109],v2,8192
T a[110:111],v2,9216
M v[36:39],a[44:47],a[172:175],v[36:39]
buffer_load_dwordx4 v15, s[48:51], s22 offen offset:3072   lds
M v[36:39],a[40:43],a[168:171],v[36:39]
s_sub_u32 s22, s22, 1048448
M v[40:43],a[48:51],a[168:171],v[40:43]
M v[40:43],a[52:55],a[172:175],v[40:43]
s_nop 0
T a[112:113],v3,0
T a[114:115],v3,1024
M v[44:47],a[60:63],a[172:175],v[44:47]
SA m0,s23,49152
M v[44:47],a[56:59],a[168:171],v[44:47]
buffer_load_dwordx4 v8, s[16:19], s21 offen offset:0  nt lds
M v[48:51],a[64:67],a[168:171],v[48:51]
M v[48:51],a[68:71],a[172:175],v[48:51]
M v[52:55],a[76:79],a[172:175],v[52:55]
s_nop 0
T a[116:117],v3,8192
T a[118:119],v3,9216
M v[52:55],a[72:75],a[168:171],v[52:55]
M v[56:59],a[80:83],a[168:171],v[56:59]
buffer_load_dwordx4 v9, s[16:19], s21 offen offset:1024  nt lds
M v[56:59],a[84:87],a[172:175],v[56:59]
s_waitcnt lgkmcnt(6)
M v[60:63],a[92:95],a[172:175],v[60:63]
M v[60:63],a[88:91],a[168:171],v[60:63]
s_nop 0
T a[120:121],v4,0
T a[122:123],v4,1024
M v[64:67],a[32:35],a[160:163],v[64:67]
R a[168:171],v5,38912
R a[172:175],v6,38912
M v[64:67],a[36:39],a[164:167],v[64:67]
buffer_load_dwordx4 v10, s[16:19], s21 offen offset:2048  nt lds
M v[68:71],a[44:47],a[164:167],v[68:71]
M v[68:71],a[40:43],a[160:163],v[68:71]
M v[72:75],a[48:51],a[160:163],v[72:75]
s_nop 0
T a[124:125],v4,8192
T a[126:127],v4,9216
M v[72:75],a[52:55],a[164:167],v[72:75]
M v[76:79],a[60:63],a[164:167],v[76:79]
buffer_load_dwordx4 v11, s[16:19], s21 offen offset:3072  nt lds
M v[76:79],a[56:59],a[160:163],v[76:79]
SA s21,s21,524160
M v[80:83],a[64:67],a[160:163],v[80:83]
M v[80:83],a[68:71],a[164:167],v[80:83]
M v[84:87],a[76:79],a[164:167],v[84:87]
M v[84:87],a[72:75],a[160:163],v[84:87]
M v[88:91],a[80:83],a[160:163],v[88:91]
M v[88:91],a[84:87],a[164:167],v[88:91]
s_waitcnt lgkmcnt(2)
M v[92:95],a[92:95],a[164:167],v[92:95]
s_waitcnt vmcnt(16) lgkmcnt(0)
M v[92:95],a[88:91],a[160:163],v[92:95]
s_barrier
M v[96:99],a[32:35],a[168:171],v[96:99]
R a[160:163],v5,49152
R a[164:167],v6,49152
M v[96:99],a[36:39],a[172:175],v[96:99]
M v[100:103],a[44:47],a[172:175],v[100:103]
SA m0,s24,32768
T a[128:129],v1,16384
T a[130:131],v1,17408
M v[100:103],a[40:43],a[168:171],v[100:103]
buffer_load_dwordx4 v12, s[48:51], s22 offen offset:0   lds
M v[104:107],a[48:51],a[168:171],v[104:107]
M v[104:107],a[52:55],a[172:175],v[104:107]
M v[108:111],a[60:63],a[172:175],v[108:111]
M v[108:111],a[56:59],a[168:171],v[108:111]
M v[112:115],a[64:67],a[168:171],v[112:115]
M v[112:115],a[68:71],a[172:175],v[112:115]
s_nop 0
T a[132:133],v1,24576
T a[134:135],v1,25600
M v[116:119],a[76:79],a[172:175],v[116:119]
buffer_load_dwordx4 v13, s[48:51], s22 offen offset:1024   lds
M v[116:119],a[72:75],a[168:171],v[116:119]
M v[120:123],a[80:83],a[168:171],v[120:123]
M v[120:123],a[84:87],a[172:175],v[120:123]
s_waitcnt lgkmcnt(4)
M v[124:127],a[92:95],a[172:175],v[124:127]
M v[124:127],a[88:91],a[168:171],v[124:127]
M v[128:131],a[32:35],a[160:163],v[128:131]
R a[168:171],v5,51200
R a[172:175],v6,51200
M v[128:131],a[36:39],a[164:167],v[128:131]
T a[136:137],v2,16384
T a[138:139],v2,17408
M v[132:135],a[44:47],a[164:167],v[132:135]
buffer_load_dwordx4 v14, s[48:51], s22 offen offset:2048   lds
M v[132:135],a[40:43],a[160:163],v[132:135]
M v[136:139],a[48:51],a[160:163],v[136:139]
M v[136:139],a[52:55],a[164:167],v[136:139]
M v[140:143],a[60:63],a[164:167],v[140:143]
M v[140:143],a[56:59],a[160:163],v[140:143]
s_nop 0
T a[140:141],v2,24576
T a[142:143],v2,25600
M v[144:147],a[64:67],a[160:163],v[144:147]
buffer_load_dwordx4 v15, s[48:51], s22 offen offset:3072   lds
M v[144:147],a[68:71],a[164:167],v[144:147]
SA s22,s22,1048576
M v[148:151],a[76:79],a[164:167],v[148:151]
M v[148:151],a[72:75],a[160:163],v[148:151]
M v[152:155],a[80:83],a[160:163],v[152:155]
M v[152:155],a[84:87],a[164:167],v[152:155]
s_waitcnt lgkmcnt(4)
M v[156:159],a[92:95],a[164:167],v[156:159]
SA m0,s23,0
T a[144:145],v3,16384
T a[146:147],v3,17408
M v[156:159],a[88:91],a[160:163],v[156:159]
buffer_load_dwordx4 v8, s[16:19], s21 offen offset:0  nt lds
M v[160:163],a[32:35],a[168:171],v[160:163]
R a[160:163],v5,53248
R a[164:167],v6,53248
M v[160:163],a[36:39],a[172:175],v[160:163]
M v[164:167],a[44:47],a[172:175],v[164:167]
M v[164:167],a[40:43],a[168:171],v[164:167]
M v[168:171],a[48:51],a[168:171],v[168:171]
M v[168:171],a[52:55],a[172:175],v[168:171]
s_nop 0
T a[148:149],v3,24576
T a[150:151],v3,25600
M v[172:175],a[60:63],a[172:175],v[172:175]
buffer_load_dwordx4 v9, s[16:19], s21 offen offset:1024  nt lds
M v[172:175],a[56:59],a[168:171],v[172:175]
M v[176:179],a[64:67],a[168:171],v[176:179]
M v[176:179],a[68:71],a[172:175],v[176:179]
M v[180:183],a[76:79],a[172:175],v[180:183]
M v[180:183],a[72:75],a[168:171],v[180:183]
M v[184:187],a[80:83],a[168:171],v[184:187]
s_nop 0
T a[152:153],v4,16384
T a[154:155],v4,17408
M v[184:187],a[84:87],a[172:175],v[184:187]
s_waitcnt lgkmcnt(4)
buffer_load_dwordx4 v10, s[16:19], s21 offen offset:2048  nt lds
M v[188:191],a[92:95],a[172:175],v[188:191]
M v[188:191],a[88:91],a[168:171],v[188:191]
M v[192:195],a[32:35],a[160:163],v[192:195]
R a[168:171],v5,55296
R a[172:175],v6,55296
M v[192:195],a[36:39],a[164:167],v[192:195]
M v[196:199],a[44:47],a[164:167],v[196:199]
M v[196:199],a[40:43],a[160:163],v[196:199]
s_nop 0
T a[156:157],v4,24576
T a[158:159],v4,25600
M v[200:203],a[48:51],a[160:163],v[200:203]
buffer_load_dwordx4 v11, s[16:19], s21 offen offset:3072  nt lds
M v[200:203],a[52:55],a[164:167],v[200:203]
SA s21,s21,128
M v[204:207],a[60:63],a[164:167],v[204:207]
M v[204:207],a[56:59],a[160:163],v[204:207]
M v[208:211],a[64:67],a[160:163],v[208:211]
M v[208:211],a[68:71],a[164:167],v[208:211]
M v[212:215],a[76:79],a[164:167],v[212:215]
M v[212:215],a[72:75],a[160:163],v[212:215]
M v[216:219],a[80:83],a[160:163],v[216:219]
M v[216:219],a[84:87],a[164:167],v[216:219]
s_waitcnt lgkmcnt(2)
M v[220:223],a[92:95],a[164:167],v[220:223]
s_waitcnt vmcnt(16) lgkmcnt(0)
M v[220:223],a[88:91],a[160:163],v[220:223]
s_barrier
M v[224:227],a[32:35],a[168:171],v[224:227]
R a[160:163],v5,0
R a[164:167],v6,0
M v[224:227],a[36:39],a[172:175],v[224:227]
v_min_u32 v16, 1, v0
v_lshlrev_b32 v16, 29, v16
M v[228:231],a[44:47],a[172:175],v[228:231]
v_or_b32 v16, s39, v16
v_mov_b32 v17, 1
M v[228:231],a[40:43],a[168:171],v[228:231]
buffer_store_dword v17, v16, s[12:15], s38 offen sc1
M v[232:235],a[48:51],a[168:171],v[232:235]
M v[232:235],a[52:55],a[172:175],v[232:235]
M v[236:239],a[60:63],a[172:175],v[236:239]
M v[236:239],a[56:59],a[168:171],v[236:239]
M v[240:243],a[64:67],a[168:171],v[240:243]
M v[240:243],a[68:71],a[172:175],v[240:243]
M v[244:247],a[76:79],a[172:175],v[244:247]
M v[244:247],a[72:75],a[168:171],v[244:247]
M v[248:251],a[80:83],a[168:171],v[248:251]
M v[248:251],a[84:87],a[172:175],v[248:251]
s_waitcnt lgkmcnt(0)
M v[252:255],a[92:95],a[172:175],v[252:255]
M v[252:255],a[88:91],a[168:171],v[252:255]
M a[0:3],a[96:99],a[160:163],a[0:3]
L_w_kv01:
s_cbranch_execz L_w_kv05
R a[168:171],v5,2048
R a[172:175],v6,2048
M a[0:3],a[100:103],a[164:167],a[0:3]
T a[32:33],v1,32768
T a[34:35],v1,33792
M a[4:7],a[108:111],a[164:167],a[4:7]
SA m0,s24,49152
M a[4:7],a[104:107],a[160:163],a[4:7]
buffer_load_dwordx4 v12, s[48:51], s22 offen offset:0   lds
M a[8:11],a[112:115],a[160:163],a[8:11]
M a[8:11],a[116:119],a[164:167],a[8:11]
M a[12:15],a[124:127],a[164:167],a[12:15]
s_nop 0
T a[36:37],v1,40960
T a[38:39],v1,41984
M a[12:15],a[120:123],a[160:163],a[12:15]
M a[16:19],a[128:131],a[160:163],a[16:19]
buffer_load_dwordx4 v13, s[48:51], s22 offen offset:1024   lds
M a[16:19],a[132:135],a[164:167],a[16:19]
M a[20:23],a[140:143],a[164:167],a[20:23]
M a[20:23],a[136:139],a[160:163],a[20:23]
s_nop 0
T a[40:41],v2,32768
T a[42:43],v2,33792
M a[24:27],a[144:147],a[160:163],a[24:27]
M a[24:27],a[148:151],a[164:167],a[24:27]
s_waitcnt lgkmcnt(6)
buffer_load_dwordx4 v14, s[48:51], s22 offen offset:2048   lds
M a[28:31],a[156:159],a[164:167],a[28:31]
M a[28:31],a[152:155],a[160:163],a[28:31]
M v[32:35],a[96:99],a[168:171],v[32:35]
R a[160:163],v5,4096
R a[164:167],v6,4096
M v[32:35],a[100:103],a[172:175],v[32:35]
T a[44:45],v2,40960
T a[46:47],v2,41984
M v[36:39],a[108:111],a[172:175],v[36:39]
buffer_load_dwordx4 v15, s[48:51], s22 offen offset:3072   lds
M v[36:39],a[104:107],a[168:171],v[36:39]
s_sub_u32 s22, s22, 1048448
M v[40:43],a[112:115],a[168:171],v[40:43]
M v[40:43],a[116:119],a[172:175],v[40:43]
s_nop 0
T a[48:49],v3,32768
T a[50:51],v3,33792
M v[44:47],a[124:127],a[172:175],v[44:47]
SA m0,s23,16384
M v[44:47],a[120:123],a[168:171],v[44:47]
buffer_load_dwordx4 v8, s[16:19], s21 offen offset:0  nt lds
M v[48:51],a[128:131],a[168:171],v[48:51]
M v[48:51],a[132:135],a[172:175],v[48:51]
M v[52:55],a[140:143],a[172:175],v[52:55]
s_nop 0
T a[52:53],v3,40960
T a[54:55],v3,41984
M v[52:55],a[136:139],a[168:171],v[52:55]
M v[56:59],a[144:147],a[168:171],v[56:59]
buffer_load_dwordx4 v9, s[16:19], s21 offen offset:1024  nt lds
M v[56:59],a[148:151],a[172:175],v[56:59]
s_waitcnt lgkmcnt(6)
M v[60:63],a[156:159],a[172:175],v[60:63]
M v[60:63],a[152:155],a[168:171],v[60:63]
s_nop 0
T a[56:57],v4,32768
T a[58:59],v4,33792
M v[64:67],a[96:99],a[160:163],v[64:67]
R a[168:171],v5,6144
R a[172:175],v6,6144
M v[64:67],a[100:103],a[164:167],v[64:67]
buffer_load_dwordx4 v10, s[16:19], s21 offen offset:2048  nt lds
M v[68:71],a[108:111],a[164:167],v[68:71]
M v[68:71],a[104:107],a[160:163],v[68:71]
M v[72:75],a[112:115],a[160:163],v[72:75]
s_nop 0
T a[60:61],v4,40960
T a[62:63],v4,41984
M v[72:75],a[116:119],a[164:167],v[72:75]
M v[76:79],a[124:127],a[164:167],v[76:79]
buffer_load_dwordx4 v11, s[16:19], s21 offen offset:3072  nt lds
M v[76:79],a[120:123],a[160:163],v[76:79]
SA s21,s21,524160
M v[80:83],a[128:131],a[160:163],v[80:83]
M v[80:83],a[132:135],a[164:167],v[80:83]
M v[84:87],a[140:143],a[164:167],v[84:87]
M v[84:87],a[136:139],a[160:163],v[84:87]
s_and_b32 s86, s41, 7
M v[88:91],a[144:147],a[160:163],v[88:91]
s_mul_i32 s86, s86, 14
s_lshr_b32 s64, s41, 3
s_mul_i32 s64, s64, 7
M v[88:91],a[148:151],a[164:167],v[88:91]
s_waitcnt lgkmcnt(2)
SA s86,s86,s64
s_min_u32 s64, s31, 6
M v[92:95],a[156:159],a[164:167],v[92:95]
s_waitcnt vmcnt(17) lgkmcnt(0)
SA s86,s86,s64
s_sub_u32 s64, 6, s31
M v[92:95],a[152:155],a[160:163],v[92:95]
s_barrier
M v[96:99],a[96:99],a[168:171],v[96:99]
R a[160:163],v5,16384
R a[164:167],v6,16384
M v[96:99],a[100:103],a[172:175],v[96:99]
s_and_b32 s88, s64, 536870912
s_mul_i32 s87, s20, 7168
M v[100:103],a[108:111],a[172:175],v[100:103]
SA m0,s24,0
T a[64:65],v1,49152
T a[66:67],v1,50176
M v[100:103],a[104:107],a[168:171],v[100:103]
buffer_load_dwordx4 v12, s[48:51], s22 offen offset:0   lds
M v[104:107],a[112:115],a[168:171],v[104:107]
SA s87,s87,131072
M v[104:107],a[116:119],a[172:175],v[104:107]
s_cmp_lt_u32 s20, 2
M v[108:111],a[124:127],a[172:175],v[108:111]
s_cselect_b64 s[72:73], s[80:81], s[82:83]
M v[108:111],a[120:123],a[168:171],v[108:111]
s_mov_b32 s60, s72
M v[112:115],a[128:131],a[168:171],v[112:115]
s_and_b32 s61, s73, 0xffff
M v[112:115],a[132:135],a[172:175],v[112:115]
s_mov_b32 s62, 1605632
T a[68:69],v1,57344
T a[70:71],v1,58368
M v[116:119],a[140:143],a[172:175],v[116:119]
s_mov_b32 s63, 0x20000
buffer_load_dwordx4 v13, s[48:51], s22 offen offset:1024   lds
M v[116:119],a[136:139],a[168:171],v[116:119]
s_mov_b32 s68, s84
M v[120:123],a[144:147],a[168:171],v[120:123]
s_and_b32 s69, s85, 0xffff
s_mov_b32 s70, 1605632
s_mov_b32 s71, 0x20000
M v[120:123],a[148:151],a[172:175],v[120:123]
s_waitcnt lgkmcnt(4)
s_lshl_b32 s89, s86, 5
M v[124:127],a[156:159],a[172:175],v[124:127]
s_and_b32 s64, s20, 1
M v[124:127],a[152:155],a[168:171],v[124:127]
s_mul_i32 s64, s64, 802816
M v[128:131],a[96:99],a[160:163],v[128:131]
SA s89,s89,s64
R a[168:171],v5,18432
R a[172:175],v6,18432
M v[128:131],a[100:103],a[164:167],v[128:131]
T a[72:73],v2,49152
T a[74:75],v2,50176
M v[132:135],a[108:111],a[164:167],v[132:135]
buffer_load_dwordx4 v14, s[48:51], s22 offen offset:2048   lds
M v[132:135],a[104:107],a[160:163],v[132:135]
v_lshrrev_b32 v28, 1, v0
v_mul_u32_u24 v28, 3584, v28
M v[136:139],a[112:115],a[160:163],v[136:139]
v_and_b32 v29, 1, v0
v_lshl_add_u32 v25, v29, 4, v28
M v[136:139],a[116:119],a[164:167],v[136:139]
v_or_b32 v25, s88, v25
M v[140:143],a[124:127],a[164:167],v[140:143]
M v[140:143],a[120:123],a[160:163],v[140:143]
s_nop 0
T a[76:77],v2,57344
T a[78:79],v2,58368
M v[144:147],a[128:131],a[160:163],v[144:147]
buffer_load_dwordx4 v15, s[48:51], s22 offen offset:3072   lds
M v[144:147],a[132:135],a[164:167],v[144:147]
SA s22,s22,1048576
M v[148:151],a[140:143],a[164:167],v[148:151]
M v[148:151],a[136:139],a[160:163],v[148:151]
M v[152:155],a[144:147],a[160:163],v[152:155]
M v[152:155],a[148:151],a[164:167],v[152:155]
s_waitcnt lgkmcnt(4)
M v[156:159],a[156:159],a[164:167],v[156:159]
SA m0,s23,32768
T a[80:81],v3,49152
T a[82:83],v3,50176
M v[156:159],a[152:155],a[160:163],v[156:159]
buffer_load_dwordx4 v8, s[16:19], s21 offen offset:0  nt lds
M v[160:163],a[96:99],a[168:171],v[160:163]
R a[160:163],v5,20480
R a[164:167],v6,20480
M v[160:163],a[100:103],a[172:175],v[160:163]
M v[164:167],a[108:111],a[172:175],v[164:167]
M v[164:167],a[104:107],a[168:171],v[164:167]
M v[168:171],a[112:115],a[168:171],v[168:171]
M v[168:171],a[116:119],a[172:175],v[168:171]
s_nop 0
T a[84:85],v3,57344
T a[86:87],v3,58368
M v[172:175],a[124:127],a[172:175],v[172:175]
buffer_load_dwordx4 v9, s[16:19], s21 offen offset:1024  nt lds
M v[172:175],a[120:123],a[168:171],v[172:175]
M v[176:179],a[128:131],a[168:171],v[176:179]
M v[176:179],a[132:135],a[172:175],v[176:179]
M v[180:183],a[140:143],a[172:175],v[180:183]
M v[180:183],a[136:139],a[168:171],v[180:183]
M v[184:187],a[144:147],a[168:171],v[184:187]
s_nop 0
T a[88:89],v4,49152
T a[90:91],v4,50176
M v[184:187],a[148:151],a[172:175],v[184:187]
s_waitcnt lgkmcnt(4)
buffer_load_dwordx4 v10, s[16:19], s21 offen offset:2048  nt lds
M v[188:191],a[156:159],a[172:175],v[188:191]
M v[188:191],a[152:155],a[168:171],v[188:191]
M v[192:195],a[96:99],a[160:163],v[192:195]
R a[168:171],v5,22528
R a[172:175],v6,22528
M v[192:195],a[100:103],a[164:167],v[192:195]
M v[196:199],a[108:111],a[164:167],v[196:199]
M v[196:199],a[104:107],a[160:163],v[196:199]
s_nop 0
T a[92:93],v4,57344
T a[94:95],v4,58368
M v[200:203],a[112:115],a[160:163],v[200:203]
buffer_load_dwordx4 v11, s[16:19], s21 offen offset:3072  nt lds
M v[200:203],a[116:119],a[164:167],v[200:203]
SA s21,s21,128
M v[204:207],a[124:127],a[164:167],v[204:207]
M v[204:207],a[120:123],a[160:163],v[204:207]
M v[208:211],a[128:131],a[160:163],v[208:211]
M v[208:211],a[132:135],a[164:167],v[208:211]
M v[212:215],a[140:143],a[164:167],v[212:215]
M v[212:215],a[136:139],a[160:163],v[212:215]
M v[216:219],a[144:147],a[160:163],v[216:219]
M v[216:219],a[148:151],a[164:167],v[216:219]
s_waitcnt lgkmcnt(2)
M v[220:223],a[156:159],a[164:167],v[220:223]
s_waitcnt vmcnt(17) lgkmcnt(0)
M v[220:223],a[152:155],a[160:163],v[220:223]
s_barrier
M v[224:227],a[96:99],a[168:171],v[224:227]
R a[160:163],v5,32768
R a[164:167],v6,32768
M v[224:227],a[100:103],a[172:175],v[224:227]
M v[228:231],a[108:111],a[172:175],v[228:231]
M v[228:231],a[104:107],a[168:171],v[228:231]
M v[232:235],a[112:115],a[168:171],v[232:235]
M v[232:235],a[116:119],a[172:175],v[232:235]
M v[236:239],a[124:127],a[172:175],v[236:239]
M v[236:239],a[120:123],a[168:171],v[236:239]
M v[240:243],a[128:131],a[168:171],v[240:243]
M v[240:243],a[132:135],a[172:175],v[240:243]
M v[244:247],a[140:143],a[172:175],v[244:247]
M v[244:247],a[136:139],a[168:171],v[244:247]
M v[248:251],a[144:147],a[168:171],v[248:251]
M v[248:251],a[148:151],a[172:175],v[248:251]
s_waitcnt lgkmcnt(0)
M v[252:255],a[156:159],a[172:175],v[252:255]
M v[252:255],a[152:155],a[168:171],v[252:255]
M a[0:3],a[32:35],a[160:163],a[0:3]
R a[168:171],v5,34816
R a[172:175],v6,34816
M a[0:3],a[36:39],a[164:167],a[0:3]
T a[96:97],v1,0
T a[98:99],v1,1024
M a[4:7],a[44:47],a[164:167],a[4:7]
SA m0,s24,16384
M a[4:7],a[40:43],a[160:163],a[4:7]
buffer_load_dwordx4 v12, s[48:51], s22 offen offset:0   lds
M a[8:11],a[48:51],a[160:163],a[8:11]
M a[8:11],a[52:55],a[164:167],a[8:11]
M a[12:15],a[60:63],a[164:167],a[12:15]
s_nop 0
T a[100:101],v1,8192
T a[102:103],v1,9216
M a[12:15],a[56:59],a[160:163],a[12:15]
M a[16:19],a[64:67],a[160:163],a[16:19]
buffer_load_dwordx4 v13, s[48:51], s22 offen offset:1024   lds
M a[16:19],a[68:71],a[164:167],a[16:19]
M a[20:23],a[76:79],a[164:167],a[20:23]
M a[20:23],a[72:75],a[160:163],a[20:23]
s_nop 0
T a[104:105],v2,0
T a[106:107],v2,1024
M a[24:27],a[80:83],a[160:163],a[24:27]
M a[24:27],a[84:87],a[164:167],a[24:27]
s_waitcnt lgkmcnt(6)
buffer_load_dwordx4 v14, s[48:51], s22 offen offset:2048   lds
M a[28:31],a[92:95],a[164:167],a[28:31]
M a[28:31],a[88:91],a[160:163],a[28:31]
M v[32:35],a[32:35],a[168:171],v[32:35]
R a[160:163],v5,36864
R a[164:167],v6,36864
M v[32:35],a[36:39],a[172:175],v[32:35]
T a[108:109],v2,8192
T a[110:111],v2,9216
M v[36:39],a[44:47],a[172:175],v[36:39]
buffer_load_dwordx4 v15, s[48:51], s22 offen offset:3072   lds
M v[36:39],a[40:43],a[168:171],v[36:39]
s_sub_u32 s22, s22, 1048448
M v[40:43],a[48:51],a[168:171],v[40:43]
M v[40:43],a[52:55],a[172:175],v[40:43]
s_nop 0
T a[112:113],v3,0
T a[114:115],v3,1024
M v[44:47],a[60:63],a[172:175],v[44:47]
SA m0,s23,49152
M v[44:47],a[56:59],a[168:171],v[44:47]
buffer_load_dwordx4 v8, s[16:19], s21 offen offset:0  nt lds
M v[48:51],a[64:67],a[168:171],v[48:51]
M v[48:51],a[68:71],a[172:175],v[48:51]
M v[52:55],a[76:79],a[172:175],v[52:55]
s_nop 0
T a[116:117],v3,8192
T a[118:119],v3,9216
M v[52:55],a[72:75],a[168:171],v[52:55]
M v[56:59],a[80:83],a[168:171],v[56:59]
buffer_load_dwordx4 v9, s[16:19], s21 offen offset:1024  nt lds
M v[56:59],a[84:87],a[172:175],v[56:59]
s_waitcnt lgkmcnt(6)
M v[60:63],a[92:95],a[172:175],v[60:63]
M v[60:63],a[88:91],a[168:171],v[60:63]
s_nop 0
T a[120:121],v4,0
T a[122:123],v4,1024
M v[64:67],a[32:35],a[160:163],v[64:67]
R a[168:171],v5,38912
R a[172:175],v6,38912
M v[64:67],a[36:39],a[164:167],v[64:67]
buffer_load_dwordx4 v10, s[16:19], s21 offen offset:2048  nt lds
M v[68:71],a[44:47],a[164:167],v[68:71]
M v[68:71],a[40:43],a[160:163],v[68:71]
M v[72:75],a[48:51],a[160:163],v[72:75]
s_nop 0
T a[124:125],v4,8192
T a[126:127],v4,9216
M v[72:75],a[52:55],a[164:167],v[72:75]
M v[76:79],a[60:63],a[164:167],v[76:79]
buffer_load_dwordx4 v11, s[16:19], s21 offen offset:3072  nt lds
M v[76:79],a[56:59],a[160:163],v[76:79]
SA s21,s21,524160
M v[80:83],a[64:67],a[160:163],v[80:83]
M v[80:83],a[68:71],a[164:167],v[80:83]
M v[84:87],a[76:79],a[164:167],v[84:87]
M v[84:87],a[72:75],a[160:163],v[84:87]
M v[88:91],a[80:83],a[160:163],v[88:91]
M v[88:91],a[84:87],a[164:167],v[88:91]
s_waitcnt lgkmcnt(2)
M v[92:95],a[92:95],a[164:167],v[92:95]
s_waitcnt vmcnt(16) lgkmcnt(0)
M v[92:95],a[88:91],a[160:163],v[92:95]
s_barrier
M v[96:99],a[32:35],a[168:171],v[96:99]
R a[160:163],v5,49152
R a[164:167],v6,49152
M v[96:99],a[36:39],a[172:175],v[96:99]
M v[100:103],a[44:47],a[172:175],v[100:103]
SA m0,s24,32768
T a[128:129],v1,16384
T a[130:131],v1,17408
M v[100:103],a[40:43],a[168:171],v[100:103]
buffer_load_dwordx4 v12, s[48:51], s22 offen offset:0   lds
M v[104:107],a[48:51],a[168:171],v[104:107]
v_min_u32 v16, 40, v0
v_lshlrev_b32 v16, 2, v16
M v[104:107],a[52:55],a[172:175],v[104:107]
buffer_load_dword v17, v16, s[12:15], 0 offen sc1
M v[108:111],a[60:63],a[172:175],v[108:111]
M v[108:111],a[56:59],a[168:171],v[108:111]
M v[112:115],a[64:67],a[168:171],v[112:115]
buffer_load_dwordx4 v13, s[48:51], s22 offen offset:1024   lds
M v[112:115],a[68:71],a[172:175],v[112:115]
s_nop 0
T a[132:133],v1,24576
T a[134:135],v1,25600
M v[116:119],a[76:79],a[172:175],v[116:119]
M v[116:119],a[72:75],a[168:171],v[116:119]
M v[120:123],a[80:83],a[168:171],v[120:123]
M v[120:123],a[84:87],a[172:175],v[120:123]
s_waitcnt lgkmcnt(4)
M v[124:127],a[92:95],a[172:175],v[124:127]
buffer_load_dwordx4 v14, s[48:51], s22 offen offset:2048   lds
M v[124:127],a[88:91],a[168:171],v[124:127]
M v[128:131],a[32:35],a[160:163],v[128:131]
R a[168:171],v5,51200
R a[172:175],v6,51200
M v[128:131],a[36:39],a[164:167],v[128:131]
T a[136:137],v2,16384
T a[138:139],v2,17408
M v[132:135],a[44:47],a[164:167],v[132:135]
M v[132:135],a[40:43],a[160:163],v[132:135]
M v[136:139],a[48:51],a[160:163],v[136:139]
buffer_load_dwordx4 v15, s[48:51], s22 offen offset:3072   lds
M v[136:139],a[52:55],a[164:167],v[136:139]
SA s22,s22,1048576
M v[140:143],a[60:63],a[164:167],v[140:143]
M v[140:143],a[56:59],a[160:163],v[140:143]
s_nop 0
T a[140:141],v2,24576
T a[142:143],v2,25600
M v[144:147],a[64:67],a[160:163],v[144:147]
SA m0,s23,0
M v[144:147],a[68:71],a[164:167],v[144:147]
buffer_load_dwordx4 v8, s[16:19], s21 offen offset:0  nt lds
M v[148:151],a[76:79],a[164:167],v[148:151]
M v[148:151],a[72:75],a[160:163],v[148:151]
M v[152:155],a[80:83],a[160:163],v[152:155]
M v[152:155],a[84:87],a[164:167],v[152:155]
s_waitcnt lgkmcnt(4)
M v[156:159],a[92:95],a[164:167],v[156:159]
s_nop 0
T a[144:145],v3,16384
T a[146:147],v3,17408
M v[156:159],a[88:91],a[160:163],v[156:159]
buffer_load_dwordx4 v9, s[16:19], s21 offen offset:1024  nt lds
M v[160:163],a[32:35],a[168:171],v[160:163]
R a[160:163],v5,53248
R a[164:167],v6,53248
M v[160:163],a[36:39],a[172:175],v[160:163]
M v[164:167],a[44:47],a[172:175],v[164:167]
M v[164:167],a[40:43],a[168:171],v[164:167]
M v[168:171],a[48:51],a[168:171],v[168:171]
M v[168:171],a[52:55],a[172:175],v[168:171]
s_nop 0
T a[148:149],v3,24576
T a[150:151],v3,25600
M v[172:175],a[60:63],a[172:175],v[172:175]
buffer_load_dwordx4 v10, s[16:19], s21 offen offset:2048  nt lds
M v[172:175],a[56:59],a[168:171],v[172:175]
M v[176:179],a[64:67],a[168:171],v[176:179]
M v[176:179],a[68:71],a[172:175],v[176:179]
M v[180:183],a[76:79],a[172:175],v[180:183]
buffer_load_dwordx4 v11, s[16:19], s21 offen offset:3072  nt lds
M v[180:183],a[72:75],a[168:171],v[180:183]
SA s21,s21,128
M v[184:187],a[80:83],a[168:171],v[184:187]
s_nop 0
T a[152:153],v4,16384
T a[154:155],v4,17408
M v[184:187],a[84:87],a[172:175],v[184:187]
s_waitcnt lgkmcnt(4)
M v[188:191],a[92:95],a[172:175],v[188:191]
M v[188:191],a[88:91],a[168:171],v[188:191]
SA m0,s87,0
M v[192:195],a[32:35],a[160:163],v[192:195]
R a[168:171],v5,55296
R a[172:175],v6,55296
M v[192:195],a[36:39],a[164:167],v[192:195]
buffer_load_dwordx4 v25, s[60:63], s89 offen offset:0 nt lds
M v[196:199],a[44:47],a[164:167],v[196:199]
SA s89,s89,114688
M v[196:199],a[40:43],a[160:163],v[196:199]
s_nop 0
T a[156:157],v4,24576
T a[158:159],v4,25600
M v[200:203],a[48:51],a[160:163],v[200:203]
M v[200:203],a[52:55],a[164:167],v[200:203]
SA m0,s87,1024
M v[204:207],a[60:63],a[164:167],v[204:207]
buffer_load_dwordx4 v25, s[60:63], s89 offen offset:0 nt lds
M v[204:207],a[56:59],a[160:163],v[204:207]
SA s89,s89,114688
M v[208:211],a[64:67],a[160:163],v[208:211]
M v[208:211],a[68:71],a[164:167],v[208:211]
M v[212:215],a[76:79],a[164:167],v[212:215]
M v[212:215],a[72:75],a[160:163],v[212:215]
M v[216:219],a[80:83],a[160:163],v[216:219]
M v[216:219],a[84:87],a[164:167],v[216:219]
s_waitcnt lgkmcnt(2)
M v[220:223],a[92:95],a[164:167],v[220:223]
s_waitcnt vmcnt(19) lgkmcnt(0)
M v[220:223],a[88:91],a[160:163],v[220:223]
s_barrier
M v[224:227],a[32:35],a[168:171],v[224:227]
R a[160:163],v5,0
R a[164:167],v6,0
M v[224:227],a[36:39],a[172:175],v[224:227]
M v[228:231],a[44:47],a[172:175],v[228:231]
M v[228:231],a[40:43],a[168:171],v[228:231]
M v[232:235],a[48:51],a[168:171],v[232:235]
M v[232:235],a[52:55],a[172:175],v[232:235]
M v[236:239],a[60:63],a[172:175],v[236:239]
M v[236:239],a[56:59],a[168:171],v[236:239]
M v[240:243],a[64:67],a[168:171],v[240:243]
M v[240:243],a[68:71],a[172:175],v[240:243]
M v[244:247],a[76:79],a[172:175],v[244:247]
M v[244:247],a[72:75],a[168:171],v[244:247]
M v[248:251],a[80:83],a[168:171],v[248:251]
M v[248:251],a[84:87],a[172:175],v[248:251]
s_waitcnt lgkmcnt(0)
M v[252:255],a[92:95],a[172:175],v[252:255]
M v[252:255],a[88:91],a[168:171],v[252:255]
M a[0:3],a[96:99],a[160:163],a[0:3]
R a[168:171],v5,2048
R a[172:175],v6,2048
M a[0:3],a[100:103],a[164:167],a[0:3]
T a[32:33],v1,32768
T a[34:35],v1,33792
M a[4:7],a[108:111],a[164:167],a[4:7]
SA m0,s24,49152
M a[4:7],a[104:107],a[160:163],a[4:7]
buffer_load_dwordx4 v12, s[48:51], s22 offen offset:0   lds
M a[8:11],a[112:115],a[160:163],a[8:11]
M a[8:11],a[116:119],a[164:167],a[8:11]
M a[12:15],a[124:127],a[164:167],a[12:15]
s_nop 0
T a[36:37],v1,40960
T a[38:39],v1,41984
M a[12:15],a[120:123],a[160:163],a[12:15]
M a[16:19],a[128:131],a[160:163],a[16:19]
buffer_load_dwordx4 v13, s[48:51], s22 offen offset:1024   lds
M a[16:19],a[132:135],a[164:167],a[16:19]
M a[20:23],a[140:143],a[164:167],a[20:23]
M a[20:23],a[136:139],a[160:163],a[20:23]
s_nop 0
T a[40:41],v2,32768
T a[42:43],v2,33792
M a[24:27],a[144:147],a[160:163],a[24:27]
M a[24:27],a[148:151],a[164:167],a[24:27]
s_waitcnt lgkmcnt(6)
buffer_load_dwordx4 v14, s[48:51], s22 offen offset:2048   lds
M a[28:31],a[156:159],a[164:167],a[28:31]
M a[28:31],a[152:155],a[160:163],a[28:31]
M v[32:35],a[96:99],a[168:171],v[32:35]
R a[160:163],v5,4096
R a[164:167],v6,4096
M v[32:35],a[100:103],a[172:175],v[32:35]
T a[44:45],v2,40960
T a[46:47],v2,41984
M v[36:39],a[108:111],a[172:175],v[36:39]
buffer_load_dwordx4 v15, s[48:51], s22 offen offset:3072   lds
M v[36:39],a[104:107],a[168:171],v[36:39]
s_sub_u32 s22, s22, 1048448
M v[40:43],a[112:115],a[168:171],v[40:43]
M v[40:43],a[116:119],a[172:175],v[40:43]
s_nop 0
T a[48:49],v3,32768
T a[50:51],v3,33792
M v[44:47],a[124:127],a[172:175],v[44:47]
SA m0,s23,16384
M v[44:47],a[120:123],a[168:171],v[44:47]
buffer_load_dwordx4 v8, s[16:19], s21 offen offset:0  nt lds
M v[48:51],a[128:131],a[168:171],v[48:51]
M v[48:51],a[132:135],a[172:175],v[48:51]
M v[52:55],a[140:143],a[172:175],v[52:55]
s_nop 0
T a[52:53],v3,40960
T a[54:55],v3,41984
M v[52:55],a[136:139],a[168:171],v[52:55]
M v[56:59],a[144:147],a[168:171],v[56:59]
buffer_load_dwordx4 v9, s[16:19], s21 offen offset:1024  nt lds
M v[56:59],a[148:151],a[172:175],v[56:59]
s_waitcnt lgkmcnt(6)
M v[60:63],a[156:159],a[172:175],v[60:63]
M v[60:63],a[152:155],a[168:171],v[60:63]
s_nop 0
T a[56:57],v4,32768
L_w_kv02:
s_cbranch_execz L_w_kv06
T a[58:59],v4,33792
M v[64:67],a[96:99],a[160:163],v[64:67]
R a[168:171],v5,6144
R a[172:175],v6,6144
M v[64:67],a[100:103],a[164:167],v[64:67]
buffer_load_dwordx4 v10, s[16:19], s21 offen offset:2048  nt lds
M v[68:71],a[108:111],a[164:167],v[68:71]
M v[68:71],a[104:107],a[160:163],v[68:71]
M v[72:75],a[112:115],a[160:163],v[72:75]
s_nop 0
T a[60:61],v4,40960
T a[62:63],v4,41984
M v[72:75],a[116:119],a[164:167],v[72:75]
M v[76:79],a[124:127],a[164:167],v[76:79]
buffer_load_dwordx4 v11, s[16:19], s21 offen offset:3072  nt lds
M v[76:79],a[120:123],a[160:163],v[76:79]
SA s21,s21,524160
M v[80:83],a[128:131],a[160:163],v[80:83]
M v[80:83],a[132:135],a[164:167],v[80:83]
M v[84:87],a[140:143],a[164:167],v[84:87]
M v[84:87],a[136:139],a[160:163],v[84:87]
M v[88:91],a[144:147],a[160:163],v[88:91]
M v[88:91],a[148:151],a[164:167],v[88:91]
s_waitcnt lgkmcnt(2)
M v[92:95],a[156:159],a[164:167],v[92:95]
s_waitcnt vmcnt(19) lgkmcnt(0)
M v[92:95],a[152:155],a[160:163],v[92:95]
s_barrier
M v[96:99],a[96:99],a[168:171],v[96:99]
R a[160:163],v5,16384
R a[164:167],v6,16384
M v[96:99],a[100:103],a[172:175],v[96:99]
M v[100:103],a[108:111],a[172:175],v[100:103]
SA m0,s24,0
T a[64:65],v1,49152
T a[66:67],v1,50176
M v[100:103],a[104:107],a[168:171],v[100:103]
buffer_load_dwordx4 v12, s[48:51], s22 offen offset:0   lds
M v[104:107],a[112:115],a[168:171],v[104:107]
M v[104:107],a[116:119],a[172:175],v[104:107]
M v[108:111],a[124:127],a[172:175],v[108:111]
M v[108:111],a[120:123],a[168:171],v[108:111]
M v[112:115],a[128:131],a[168:171],v[112:115]
buffer_load_dwordx4 v13, s[48:51], s22 offen offset:1024   lds
M v[112:115],a[132:135],a[172:175],v[112:115]
s_nop 0
T a[68:69],v1,57344
T a[70:71],v1,58368
M v[116:119],a[140:143],a[172:175],v[116:119]
M v[116:119],a[136:139],a[168:171],v[116:119]
M v[120:123],a[144:147],a[168:171],v[120:123]
M v[120:123],a[148:151],a[172:175],v[120:123]
s_waitcnt lgkmcnt(4)
M v[124:127],a[156:159],a[172:175],v[124:127]
buffer_load_dwordx4 v14, s[48:51], s22 offen offset:2048   lds
M v[124:127],a[152:155],a[168:171],v[124:127]
M v[128:131],a[96:99],a[160:163],v[128:131]
R a[168:171],v5,18432
R a[172:175],v6,18432
M v[128:131],a[100:103],a[164:167],v[128:131]
T a[72:73],v2,49152
T a[74:75],v2,50176
M v[132:135],a[108:111],a[164:167],v[132:135]
M v[132:135],a[104:107],a[160:163],v[132:135]
M v[136:139],a[112:115],a[160:163],v[136:139]
buffer_load_dwordx4 v15, s[48:51], s22 offen offset:3072   lds
M v[136:139],a[116:119],a[164:167],v[136:139]
SA s22,s22,1048576
M v[140:143],a[124:127],a[164:167],v[140:143]
M v[140:143],a[120:123],a[160:163],v[140:143]
s_nop 0
T a[76:77],v2,57344
T a[78:79],v2,58368
M v[144:147],a[128:131],a[160:163],v[144:147]
SA m0,s23,32768
M v[144:147],a[132:135],a[164:167],v[144:147]
buffer_load_dwordx4 v8, s[16:19], s21 offen offset:0  nt lds
M v[148:151],a[140:143],a[164:167],v[148:151]
M v[148:151],a[136:139],a[160:163],v[148:151]
M v[152:155],a[144:147],a[160:163],v[152:155]
M v[152:155],a[148:151],a[164:167],v[152:155]
s_waitcnt lgkmcnt(4)
M v[156:159],a[156:159],a[164:167],v[156:159]
s_nop 0
T a[80:81],v3,49152
T a[82:83],v3,50176
M v[156:159],a[152:155],a[160:163],v[156:159]
buffer_load_dwordx4 v9, s[16:19], s21 offen offset:1024  nt lds
M v[160:163],a[96:99],a[168:171],v[160:163]
R a[160:163],v5,20480
R a[164:167],v6,20480
M v[160:163],a[100:103],a[172:175],v[160:163]
M v[164:167],a[108:111],a[172:175],v[164:167]
M v[164:167],a[104:107],a[168:171],v[164:167]
M v[168:171],a[112:115],a[168:171],v[168:171]
M v[168:171],a[116:119],a[172:175],v[168:171]
s_nop 0
T a[84:85],v3,57344
T a[86:87],v3,58368
M v[172:175],a[124:127],a[172:175],v[172:175]
buffer_load_dwordx4 v10, s[16:19], s21 offen offset:2048  nt lds
M v[172:175],a[120:123],a[168:171],v[172:175]
M v[176:179],a[128:131],a[168:171],v[176:179]
M v[176:179],a[132:135],a[172:175],v[176:179]
M v[180:183],a[140:143],a[172:175],v[180:183]
buffer_load_dwordx4 v11, s[16:19], s21 offen offset:3072  nt lds
M v[180:183],a[136:139],a[168:171],v[180:183]
SA s21,s21,128
M v[184:187],a[144:147],a[168:171],v[184:187]
s_nop 0
T a[88:89],v4,49152
T a[90:91],v4,50176
M v[184:187],a[148:151],a[172:175],v[184:187]
s_waitcnt lgkmcnt(4)
M v[188:191],a[156:159],a[172:175],v[188:191]
M v[188:191],a[152:155],a[168:171],v[188:191]
SA m0,s87,2048
M v[192:195],a[96:99],a[160:163],v[192:195]
R a[168:171],v5,22528
R a[172:175],v6,22528
M v[192:195],a[100:103],a[164:167],v[192:195]
buffer_load_dwordx4 v25, s[60:63], s89 offen offset:0 nt lds
M v[196:199],a[108:111],a[164:167],v[196:199]
SA s89,s89,114688
M v[196:199],a[104:107],a[160:163],v[196:199]
s_nop 0
T a[92:93],v4,57344
T a[94:95],v4,58368
M v[200:203],a[112:115],a[160:163],v[200:203]
M v[200:203],a[116:119],a[164:167],v[200:203]
SA m0,s87,3072
M v[204:207],a[124:127],a[164:167],v[204:207]
buffer_load_dwordx4 v25, s[60:63], s89 offen offset:0 nt lds
M v[204:207],a[120:123],a[160:163],v[204:207]
SA s89,s89,114688
M v[208:211],a[128:131],a[160:163],v[208:211]
M v[208:211],a[132:135],a[164:167],v[208:211]
M v[212:215],a[140:143],a[164:167],v[212:215]
M v[212:215],a[136:139],a[160:163],v[212:215]
M v[216:219],a[144:147],a[160:163],v[216:219]
M v[216:219],a[148:151],a[164:167],v[216:219]
s_waitcnt lgkmcnt(2)
M v[220:223],a[156:159],a[164:167],v[220:223]
s_waitcnt vmcnt(20) lgkmcnt(0)
M v[220:223],a[152:155],a[160:163],v[220:223]
s_barrier
M v[224:227],a[96:99],a[168:171],v[224:227]
R a[160:163],v5,32768
R a[164:167],v6,32768
M v[224:227],a[100:103],a[172:175],v[224:227]
v_cmp_ne_u32 vcc, 1, v17
M v[228:231],a[108:111],a[172:175],v[228:231]
s_nop 0
M v[228:231],a[104:107],a[168:171],v[228:231]
s_cbranch_vccnz L_zs0
L_zr0:
M v[232:235],a[112:115],a[168:171],v[232:235]
M v[232:235],a[116:119],a[172:175],v[232:235]
M v[236:239],a[124:127],a[172:175],v[236:239]
M v[236:239],a[120:123],a[168:171],v[236:239]
M v[240:243],a[128:131],a[168:171],v[240:243]
M v[240:243],a[132:135],a[172:175],v[240:243]
M v[244:247],a[140:143],a[172:175],v[244:247]
M v[244:247],a[136:139],a[168:171],v[244:247]
M v[248:251],a[144:147],a[168:171],v[248:251]
M v[248:251],a[148:151],a[172:175],v[248:251]
s_waitcnt lgkmcnt(0)
M v[252:255],a[156:159],a[172:175],v[252:255]
M v[252:255],a[152:155],a[168:171],v[252:255]
M a[0:3],a[32:35],a[160:163],a[0:3]
R a[168:171],v5,34816
R a[172:175],v6,34816
M a[0:3],a[36:39],a[164:167],a[0:3]
T a[96:97],v1,0
T a[98:99],v1,1024
M a[4:7],a[44:47],a[164:167],a[4:7]
SA m0,s24,16384
M a[4:7],a[40:43],a[160:163],a[4:7]
buffer_load_dwordx4 v12, s[48:51], s22 offen offset:0   lds
M a[8:11],a[48:51],a[160:163],a[8:11]
M a[8:11],a[52:55],a[164:167],a[8:11]
s_mul_i32 s64, s41, 229376
M a[12:15],a[60:63],a[164:167],a[12:15]
SA s72,s90,s64
T a[100:101],v1,8192
T a[102:103],v1,9216
M a[12:15],a[56:59],a[160:163],a[12:15]
s_addc_u32 s73, s91, 0
M a[16:19],a[64:67],a[160:163],a[16:19]
s_sub_u32 s75, 3670016, s64
buffer_load_dwordx4 v13, s[48:51], s22 offen offset:1024   lds
M a[16:19],a[68:71],a[164:167],a[16:19]
s_mov_b32 s12, s72
M a[20:23],a[76:79],a[164:167],a[20:23]
s_and_b32 s13, s73, 0xffff
M a[20:23],a[72:75],a[160:163],a[20:23]
s_mov_b32 s14, s75
T a[104:105],v2,0
T a[106:107],v2,1024
M a[24:27],a[80:83],a[160:163],a[24:27]
s_mov_b32 s15, 0x20000
M a[24:27],a[84:87],a[164:167],a[24:27]
s_waitcnt lgkmcnt(6)
buffer_load_dwordx4 v14, s[48:51], s22 offen offset:2048   lds
M a[28:31],a[92:95],a[164:167],a[28:31]
M a[28:31],a[88:91],a[160:163],a[28:31]
M v[32:35],a[32:35],a[168:171],v[32:35]
R a[160:163],v5,36864
R a[164:167],v6,36864
M v[32:35],a[36:39],a[172:175],v[32:35]
T a[108:109],v2,8192
T a[110:111],v2,9216
M v[36:39],a[44:47],a[172:175],v[36:39]
buffer_load_dwordx4 v15, s[48:51], s22 offen offset:3072   lds
M v[36:39],a[40:43],a[168:171],v[36:39]
s_sub_u32 s22, s22, 1048448
M v[40:43],a[48:51],a[168:171],v[40:43]
M v[40:43],a[52:55],a[172:175],v[40:43]
s_nop 0
T a[112:113],v3,0
T a[114:115],v3,1024
M v[44:47],a[60:63],a[172:175],v[44:47]
SA m0,s23,49152
M v[44:47],a[56:59],a[168:171],v[44:47]
buffer_load_dwordx4 v8, s[16:19], s21 offen offset:0  nt lds
M v[48:51],a[64:67],a[168:171],v[48:51]
M v[48:51],a[68:71],a[172:175],v[48:51]
M v[52:55],a[76:79],a[172:175],v[52:55]
s_nop 0
T a[116:117],v3,8192
T a[118:119],v3,9216
M v[52:55],a[72:75],a[168:171],v[52:55]
M v[56:59],a[80:83],a[168:171],v[56:59]
buffer_load_dwordx4 v9, s[16:19], s21 offen offset:1024  nt lds
M v[56:59],a[84:87],a[172:175],v[56:59]
s_waitcnt lgkmcnt(6)
M v[60:63],a[92:95],a[172:175],v[60:63]
M v[60:63],a[88:91],a[168:171],v[60:63]
s_nop 0
T a[120:121],v4,0
T a[122:123],v4,1024
M v[64:67],a[32:35],a[160:163],v[64:67]
R a[168:171],v5,38912
R a[172:175],v6,38912
M v[64:67],a[36:39],a[164:167],v[64:67]
buffer_load_dwordx4 v10, s[16:19], s21 offen offset:2048  nt lds
M v[68:71],a[44:47],a[164:167],v[68:71]
M v[68:71],a[40:43],a[160:163],v[68:71]
M v[72:75],a[48:51],a[160:163],v[72:75]
s_nop 0
T a[124:125],v4,8192
T a[126:127],v4,9216
M v[72:75],a[52:55],a[164:167],v[72:75]
M v[76:79],a[60:63],a[164:167],v[76:79]
buffer_load_dwordx4 v11, s[16:19], s21 offen offset:3072  nt lds
M v[76:79],a[56:59],a[160:163],v[76:79]
SA s21,s21,524160
M v[80:83],a[64:67],a[160:163],v[80:83]
M v[80:83],a[68:71],a[164:167],v[80:83]
M v[84:87],a[76:79],a[164:167],v[84:87]
M v[84:87],a[72:75],a[160:163],v[84:87]
M v[88:91],a[80:83],a[160:163],v[88:91]
M v[88:91],a[84:87],a[164:167],v[88:91]
s_waitcnt lgkmcnt(2)
M v[92:95],a[92:95],a[164:167],v[92:95]
s_waitcnt vmcnt(18) lgkmcnt(0)
M v[92:95],a[88:91],a[160:163],v[92:95]
s_barrier
M v[96:99],a[32:35],a[168:171],v[96:99]
R a[160:163],v5,49152
R a[164:167],v6,49152
M v[96:99],a[36:39],a[172:175],v[96:99]
M v[100:103],a[44:47],a[172:175],v[100:103]
SA m0,s24,32768
T a[128:129],v1,16384
T a[130:131],v1,17408
M v[100:103],a[40:43],a[168:171],v[100:103]
buffer_load_dwordx4 v12, s[48:51], s22 offen offset:0   lds
M v[104:107],a[48:51],a[168:171],v[104:107]
M v[104:107],a[52:55],a[172:175],v[104:107]
M v[108:111],a[60:63],a[172:175],v[108:111]
M v[108:111],a[56:59],a[168:171],v[108:111]
M v[112:115],a[64:67],a[168:171],v[112:115]
buffer_load_dwordx4 v13, s[48:51], s22 offen offset:1024   lds
M v[112:115],a[68:71],a[172:175],v[112:115]
s_nop 0
T a[132:133],v1,24576
T a[134:135],v1,25600
M v[116:119],a[76:79],a[172:175],v[116:119]
M v[116:119],a[72:75],a[168:171],v[116:119]
M v[120:123],a[80:83],a[168:171],v[120:123]
M v[120:123],a[84:87],a[172:175],v[120:123]
s_waitcnt lgkmcnt(4)
M v[124:127],a[92:95],a[172:175],v[124:127]
buffer_load_dwordx4 v14, s[48:51], s22 offen offset:2048   lds
M v[124:127],a[88:91],a[168:171],v[124:127]
M v[128:131],a[32:35],a[160:163],v[128:131]
R a[168:171],v5,51200
R a[172:175],v6,51200
M v[128:131],a[36:39],a[164:167],v[128:131]
T a[136:137],v2,16384
T a[138:139],v2,17408
M v[132:135],a[44:47],a[164:167],v[132:135]
M v[132:135],a[40:43],a[160:163],v[132:135]
M v[136:139],a[48:51],a[160:163],v[136:139]
buffer_load_dwordx4 v15, s[48:51], s22 offen offset:3072   lds
M v[136:139],a[52:55],a[164:167],v[136:139]
SA s22,s22,1048576
M v[140:143],a[60:63],a[164:167],v[140:143]
M v[140:143],a[56:59],a[160:163],v[140:143]
s_nop 0
T a[140:141],v2,24576
T a[142:143],v2,25600
M v[144:147],a[64:67],a[160:163],v[144:147]
SA m0,s23,0
M v[144:147],a[68:71],a[164:167],v[144:147]
buffer_load_dwordx4 v8, s[16:19], s21 offen offset:0  nt lds
M v[148:151],a[76:79],a[164:167],v[148:151]
M v[148:151],a[72:75],a[160:163],v[148:151]
M v[152:155],a[80:83],a[160:163],v[152:155]
M v[152:155],a[84:87],a[164:167],v[152:155]
s_waitcnt lgkmcnt(4)
M v[156:159],a[92:95],a[164:167],v[156:159]
s_nop 0
T a[144:145],v3,16384
T a[146:147],v3,17408
M v[156:159],a[88:91],a[160:163],v[156:159]
buffer_load_dwordx4 v9, s[16:19], s21 offen offset:1024  nt lds
M v[160:163],a[32:35],a[168:171],v[160:163]
R a[160:163],v5,53248
R a[164:167],v6,53248
M v[160:163],a[36:39],a[172:175],v[160:163]
M v[164:167],a[44:47],a[172:175],v[164:167]
M v[164:167],a[40:43],a[168:171],v[164:167]
M v[168:171],a[48:51],a[168:171],v[168:171]
M v[168:171],a[52:55],a[172:175],v[168:171]
s_nop 0
T a[148:149],v3,24576
T a[150:151],v3,25600
M v[172:175],a[60:63],a[172:175],v[172:175]
buffer_load_dwordx4 v10, s[16:19], s21 offen offset:2048  nt lds
M v[172:175],a[56:59],a[168:171],v[172:175]
M v[176:179],a[64:67],a[168:171],v[176:179]
M v[176:179],a[68:71],a[172:175],v[176:179]
M v[180:183],a[76:79],a[172:175],v[180:183]
buffer_load_dwordx4 v11, s[16:19], s21 offen offset:3072  nt lds
M v[180:183],a[72:75],a[168:171],v[180:183]
SA s21,s21,128
M v[184:187],a[80:83],a[168:171],v[184:187]
s_nop 0
T a[152:153],v4,16384
T a[154:155],v4,17408
M v[184:187],a[84:87],a[172:175],v[184:187]
s_waitcnt lgkmcnt(4)
M v[188:191],a[92:95],a[172:175],v[188:191]
M v[188:191],a[88:91],a[168:171],v[188:191]
SA m0,s87,4096
M v[192:195],a[32:35],a[160:163],v[192:195]
R a[168:171],v5,55296
R a[172:175],v6,55296
M v[192:195],a[36:39],a[164:167],v[192:195]
buffer_load_dwordx4 v25, s[60:63], s89 offen offset:0 nt lds
M v[196:199],a[44:47],a[164:167],v[196:199]
SA s89,s89,114688
M v[196:199],a[40:43],a[160:163],v[196:199]
s_nop 0
T a[156:157],v4,24576
T a[158:159],v4,25600
M v[200:203],a[48:51],a[160:163],v[200:203]
M v[200:203],a[52:55],a[164:167],v[200:203]
SA m0,s87,5120
M v[204:207],a[60:63],a[164:167],v[204:207]
buffer_load_dwordx4 v25, s[60:63], s89 offen offset:0 nt lds
M v[204:207],a[56:59],a[160:163],v[204:207]
SA s89,s89,114688
M v[208:211],a[64:67],a[160:163],v[208:211]
M v[208:211],a[68:71],a[164:167],v[208:211]
M v[212:215],a[76:79],a[164:167],v[212:215]
M v[212:215],a[72:75],a[160:163],v[212:215]
M v[216:219],a[80:83],a[160:163],v[216:219]
M v[216:219],a[84:87],a[164:167],v[216:219]
s_waitcnt lgkmcnt(2)
M v[220:223],a[92:95],a[164:167],v[220:223]
s_waitcnt vmcnt(20) lgkmcnt(0)
M v[220:223],a[88:91],a[160:163],v[220:223]
s_barrier
M v[224:227],a[32:35],a[168:171],v[224:227]
R a[160:163],v5,0
R a[164:167],v6,0
M v[224:227],a[36:39],a[172:175],v[224:227]
M v[228:231],a[44:47],a[172:175],v[228:231]
M v[228:231],a[40:43],a[168:171],v[228:231]
M v[232:235],a[48:51],a[168:171],v[232:235]
M v[232:235],a[52:55],a[172:175],v[232:235]
M v[236:239],a[60:63],a[172:175],v[236:239]
M v[236:239],a[56:59],a[168:171],v[236:239]
M v[240:243],a[64:67],a[168:171],v[240:243]
M v[240:243],a[68:71],a[172:175],v[240:243]
M v[244:247],a[76:79],a[172:175],v[244:247]
M v[244:247],a[72:75],a[168:171],v[244:247]
M v[248:251],a[80:83],a[168:171],v[248:251]
M v[248:251],a[84:87],a[172:175],v[248:251]
s_waitcnt lgkmcnt(0)
M v[252:255],a[92:95],a[172:175],v[252:255]
M v[252:255],a[88:91],a[168:171],v[252:255]
M a[0:3],a[96:99],a[160:163],a[0:3]
R a[168:171],v5,2048
R a[172:175],v6,2048
M a[0:3],a[100:103],a[164:167],a[0:3]
T a[32:33],v1,32768
T a[34:35],v1,33792
M a[4:7],a[108:111],a[164:167],a[4:7]
SA m0,s24,49152
M a[4:7],a[104:107],a[160:163],a[4:7]
buffer_load_dwordx4 v12, s[48:51], s22 offen offset:0   lds
M a[8:11],a[112:115],a[160:163],a[8:11]
M a[8:11],a[116:119],a[164:167],a[8:11]
M a[12:15],a[124:127],a[164:167],a[12:15]
s_nop 0
T a[36:37],v1,40960
T a[38:39],v1,41984
M a[12:15],a[120:123],a[160:163],a[12:15]
M a[16:19],a[128:131],a[160:163],a[16:19]
buffer_load_dwordx4 v13, s[48:51], s22 offen offset:1024   lds
M a[16:19],a[132:135],a[164:167],a[16:19]
M a[20:23],a[140:143],a[164:167],a[20:23]
M a[20:23],a[136:139],a[160:163],a[20:23]
s_nop 0
T a[40:41],v2,32768
T a[42:43],v2,33792
M a[24:27],a[144:147],a[160:163],a[24:27]
M a[24:27],a[148:151],a[164:167],a[24:27]
s_waitcnt lgkmcnt(6)
buffer_load_dwordx4 v14, s[48:51], s22 offen offset:2048   lds
M a[28:31],a[156:159],a[164:167],a[28:31]
M a[28:31],a[152:155],a[160:163],a[28:31]
M v[32:35],a[96:99],a[168:171],v[32:35]
R a[160:163],v5,4096
R a[164:167],v6,4096
M v[32:35],a[100:103],a[172:175],v[32:35]
T a[44:45],v2,40960
T a[46:47],v2,41984
M v[36:39],a[108:111],a[172:175],v[36:39]
buffer_load_dwordx4 v15, s[48:51], s22 offen offset:3072   lds
M v[36:39],a[104:107],a[168:171],v[36:39]
s_sub_u32 s22, s22, 1048448
M v[40:43],a[112:115],a[168:171],v[40:43]
M v[40:43],a[116:119],a[172:175],v[40:43]
s_nop 0
T a[48:49],v3,32768
T a[50:51],v3,33792
M v[44:47],a[124:127],a[172:175],v[44:47]
SA m0,s23,16384
M v[44:47],a[120:123],a[168:171],v[44:47]
buffer_load_dwordx4 v8, s[16:19], s21 offen offset:0  nt lds
M v[48:51],a[128:131],a[168:171],v[48:51]
M v[48:51],a[132:135],a[172:175],v[48:51]
M v[52:55],a[140:143],a[172:175],v[52:55]
s_nop 0
T a[52:53],v3,40960
T a[54:55],v3,41984
M v[52:55],a[136:139],a[168:171],v[52:55]
M v[56:59],a[144:147],a[168:171],v[56:59]
buffer_load_dwordx4 v9, s[16:19], s21 offen offset:1024  nt lds
M v[56:59],a[148:151],a[172:175],v[56:59]
s_waitcnt lgkmcnt(6)
M v[60:63],a[156:159],a[172:175],v[60:63]
M v[60:63],a[152:155],a[168:171],v[60:63]
s_nop 0
T a[56:57],v4,32768
T a[58:59],v4,33792
M v[64:67],a[96:99],a[160:163],v[64:67]
R a[168:171],v5,6144
R a[172:175],v6,6144
M v[64:67],a[100:103],a[164:167],v[64:67]
buffer_load_dwordx4 v10, s[16:19], s21 offen offset:2048  nt lds
M v[68:71],a[108:111],a[164:167],v[68:71]
M v[68:71],a[104:107],a[160:163],v[68:71]
M v[72:75],a[112:115],a[160:163],v[72:75]
s_nop 0
T a[60:61],v4,40960
T a[62:63],v4,41984
M v[72:75],a[116:119],a[164:167],v[72:75]
M v[76:79],a[124:127],a[164:167],v[76:79]
buffer_load_dwordx4 v11, s[16:19], s21 offen offset:3072  nt lds
M v[76:79],a[120:123],a[160:163],v[76:79]
SA s21,s21,524160
M v[80:83],a[128:131],a[160:163],v[80:83]
M v[80:83],a[132:135],a[164:167],v[80:83]
M v[84:87],a[140:143],a[164:167],v[84:87]
M v[84:87],a[136:139],a[160:163],v[84:87]
M v[88:91],a[144:147],a[160:163],v[88:91]
M v[88:91],a[148:151],a[164:167],v[88:91]
s_waitcnt lgkmcnt(2)
M v[92:95],a[156:159],a[164:167],v[92:95]
s_waitcnt vmcnt(18) lgkmcnt(0)
M v[92:95],a[152:155],a[160:163],v[92:95]
s_barrier
M v[96:99],a[96:99],a[168:171],v[96:99]
R a[160:163],v5,16384
R a[164:167],v6,16384
M v[96:99],a[100:103],a[172:175],v[96:99]
M v[100:103],a[108:111],a[172:175],v[100:103]
SA m0,s24,0
T a[64:65],v1,49152
T a[66:67],v1,50176
M v[100:103],a[104:107],a[168:171],v[100:103]
buffer_load_dwordx4 v12, s[48:51], s22 offen offset:0   lds
M v[104:107],a[112:115],a[168:171],v[104:107]
M v[104:107],a[116:119],a[172:175],v[104:107]
M v[108:111],a[124:127],a[172:175],v[108:111]
M v[108:111],a[120:123],a[168:171],v[108:111]
M v[112:115],a[128:131],a[168:171],v[112:115]
M v[112:115],a[132:135],a[172:175],v[112:115]
s_nop 0
T a[68:69],v1,57344
T a[70:71],v1,58368
M v[116:119],a[140:143],a[172:175],v[116:119]
buffer_load_dwordx4 v13, s[48:51], s22 offen offset:1024   lds
M v[116:119],a[136:139],a[168:171],v[116:119]
M v[120:123],a[144:147],a[168:171],v[120:123]
M v[120:123],a[148:151],a[172:175],v[120:123]
s_waitcnt lgkmcnt(4)
M v[124:127],a[156:159],a[172:175],v[124:127]
M v[124:127],a[152:155],a[168:171],v[124:127]
buffer_load_dwordx4 v14, s[48:51], s22 offen offset:2048   lds
M v[128:131],a[96:99],a[160:163],v[128:131]
R a[168:171],v5,18432
R a[172:175],v6,18432
M v[128:131],a[100:103],a[164:167],v[128:131]
s_lshl_b32 s67, s20, 11
T a[72:73],v2,49152
T a[74:75],v2,50176
M v[132:135],a[108:111],a[164:167],v[132:135]
SA s67,s67,104914944
buffer_load_dwordx4 v[16:19], v7, s[8:11], s67 offen offset:0 sc1
M v[132:135],a[104:107],a[160:163],v[132:135]
M v[136:139],a[112:115],a[160:163],v[136:139]
buffer_load_dwordx4 v[20:23], v7, s[8:11], s67 offen offset:1024 sc1
M v[136:139],a[116:119],a[164:167],v[136:139]
M v[140:143],a[124:127],a[164:167],v[140:143]
buffer_load_dwordx4 v15, s[48:51], s22 offen offset:3072   lds
M v[140:143],a[120:123],a[160:163],v[140:143]
SA s22,s22,1048576
L_w_kv03:
s_cbranch_execz L_w_kv07
T a[76:77],v2,57344
T a[78:79],v2,58368
M v[144:147],a[128:131],a[160:163],v[144:147]
M v[144:147],a[132:135],a[164:167],v[144:147]
M v[148:151],a[140:143],a[164:167],v[148:151]
M v[148:151],a[136:139],a[160:163],v[148:151]
SA m0,s23,32768
M v[152:155],a[144:147],a[160:163],v[152:155]
buffer_load_dwordx4 v8, s[16:19], s21 offen offset:0  nt lds
M v[152:155],a[148:151],a[164:167],v[152:155]
s_waitcnt lgkmcnt(4)
M v[156:159],a[156:159],a[164:167],v[156:159]
s_nop 0
T a[80:81],v3,49152
T a[82:83],v3,50176
M v[156:159],a[152:155],a[160:163],v[156:159]
M v[160:163],a[96:99],a[168:171],v[160:163]
R a[160:163],v5,20480
R a[164:167],v6,20480
M v[160:163],a[100:103],a[172:175],v[160:163]
M v[164:167],a[108:111],a[172:175],v[164:167]
buffer_load_dwordx4 v9, s[16:19], s21 offen offset:1024  nt lds
M v[164:167],a[104:107],a[168:171],v[164:167]
M v[168:171],a[112:115],a[168:171],v[168:171]
M v[168:171],a[116:119],a[172:175],v[168:171]
s_nop 0
T a[84:85],v3,57344
T a[86:87],v3,58368
M v[172:175],a[124:127],a[172:175],v[172:175]
M v[172:175],a[120:123],a[168:171],v[172:175]
M v[176:179],a[128:131],a[168:171],v[176:179]
M v[176:179],a[132:135],a[172:175],v[176:179]
buffer_load_dwordx4 v10, s[16:19], s21 offen offset:2048  nt lds
M v[180:183],a[140:143],a[172:175],v[180:183]
M v[180:183],a[136:139],a[168:171],v[180:183]
M v[184:187],a[144:147],a[168:171],v[184:187]
s_nop 0
T a[88:89],v4,49152
T a[90:91],v4,50176
M v[184:187],a[148:151],a[172:175],v[184:187]
s_waitcnt lgkmcnt(4)
M v[188:191],a[156:159],a[172:175],v[188:191]
M v[188:191],a[152:155],a[168:171],v[188:191]
buffer_load_dwordx4 v11, s[16:19], s21 offen offset:3072  nt lds
M v[192:195],a[96:99],a[160:163],v[192:195]
SA s21,s21,128
R a[168:171],v5,22528
R a[172:175],v6,22528
M v[192:195],a[100:103],a[164:167],v[192:195]
M v[196:199],a[108:111],a[164:167],v[196:199]
M v[196:199],a[104:107],a[160:163],v[196:199]
s_nop 0
T a[92:93],v4,57344
T a[94:95],v4,58368
M v[200:203],a[112:115],a[160:163],v[200:203]
SA m0,s87,6144
M v[200:203],a[116:119],a[164:167],v[200:203]
buffer_load_dwordx4 v25, s[60:63], s89 offen offset:0 nt lds
M v[204:207],a[124:127],a[164:167],v[204:207]
SA s89,s89,114688
M v[204:207],a[120:123],a[160:163],v[204:207]
M v[208:211],a[128:131],a[160:163],v[208:211]
M v[208:211],a[132:135],a[164:167],v[208:211]
M v[212:215],a[140:143],a[164:167],v[212:215]
M v[212:215],a[136:139],a[160:163],v[212:215]
M v[216:219],a[144:147],a[160:163],v[216:219]
M v[216:219],a[148:151],a[164:167],v[216:219]
s_waitcnt lgkmcnt(2)
M v[220:223],a[156:159],a[164:167],v[220:223]
s_waitcnt vmcnt(21) lgkmcnt(0)
M v[220:223],a[152:155],a[160:163],v[220:223]
s_barrier
M v[224:227],a[96:99],a[168:171],v[224:227]
R a[160:163],v5,32768
R a[164:167],v6,32768
M v[224:227],a[100:103],a[172:175],v[224:227]
M v[228:231],a[108:111],a[172:175],v[228:231]
M v[228:231],a[104:107],a[168:171],v[228:231]
M v[232:235],a[112:115],a[168:171],v[232:235]
M v[232:235],a[116:119],a[172:175],v[232:235]
M v[236:239],a[124:127],a[172:175],v[236:239]
M v[236:239],a[120:123],a[168:171],v[236:239]
M v[240:243],a[128:131],a[168:171],v[240:243]
M v[240:243],a[132:135],a[172:175],v[240:243]
M v[244:247],a[140:143],a[172:175],v[244:247]
M v[244:247],a[136:139],a[168:171],v[244:247]
M v[248:251],a[144:147],a[168:171],v[248:251]
M v[248:251],a[148:151],a[172:175],v[248:251]
s_waitcnt lgkmcnt(0)
M v[252:255],a[156:159],a[172:175],v[252:255]
M v[252:255],a[152:155],a[168:171],v[252:255]
M a[0:3],a[32:35],a[160:163],a[0:3]
R a[168:171],v5,34816
R a[172:175],v6,34816
M a[0:3],a[36:39],a[164:167],a[0:3]
T a[96:97],v1,0
T a[98:99],v1,1024
M a[4:7],a[44:47],a[164:167],a[4:7]
SA m0,s24,16384
M a[4:7],a[40:43],a[160:163],a[4:7]
buffer_load_dwordx4 v12, s[48:51], s22 offen offset:0   lds
M a[8:11],a[48:51],a[160:163],a[8:11]
M a[8:11],a[52:55],a[164:167],a[8:11]
M a[12:15],a[60:63],a[164:167],a[12:15]
s_nop 0
T a[100:101],v1,8192
T a[102:103],v1,9216
M a[12:15],a[56:59],a[160:163],a[12:15]
M a[16:19],a[64:67],a[160:163],a[16:19]
buffer_load_dwordx4 v13, s[48:51], s22 offen offset:1024   lds
M a[16:19],a[68:71],a[164:167],a[16:19]
M a[20:23],a[76:79],a[164:167],a[20:23]
s_waitcnt vmcnt(9)
v_min3_u32 v28, v16, v17, v18
M a[20:23],a[72:75],a[160:163],a[20:23]
s_nop 0
T a[104:105],v2,0
T a[106:107],v2,1024
M a[24:27],a[80:83],a[160:163],a[24:27]
s_waitcnt vmcnt(8)
v_min3_u32 v28, v28, v19, v20
M a[24:27],a[84:87],a[164:167],a[24:27]
s_waitcnt lgkmcnt(6)
buffer_load_dwordx4 v14, s[48:51], s22 offen offset:2048   lds
M a[28:31],a[92:95],a[164:167],a[28:31]
v_min3_u32 v28, v28, v21, v22
M a[28:31],a[88:91],a[160:163],a[28:31]
v_min_u32 v28, v28, v23
M v[32:35],a[32:35],a[168:171],v[32:35]
R a[160:163],v5,36864
R a[164:167],v6,36864
M v[32:35],a[36:39],a[172:175],v[32:35]
T a[108:109],v2,8192
T a[110:111],v2,9216
M v[36:39],a[44:47],a[172:175],v[36:39]
buffer_load_dwordx4 v15, s[48:51], s22 offen offset:3072   lds
M v[36:39],a[40:43],a[168:171],v[36:39]
s_sub_u32 s22, s22, 1048448
v_cmp_eq_u32 vcc, 0, v28
M v[40:43],a[48:51],a[168:171],v[40:43]
s_nop 0
M v[40:43],a[52:55],a[172:175],v[40:43]
s_cbranch_vccnz L_hs
L_hr:
T a[112:113],v3,0
T a[114:115],v3,1024
M v[44:47],a[60:63],a[172:175],v[44:47]
SA m0,s23,49152
v_max_u32 v28, v16, v17
M v[44:47],a[56:59],a[168:171],v[44:47]
buffer_load_dwordx4 v8, s[16:19], s21 offen offset:0  nt lds
M v[48:51],a[64:67],a[168:171],v[48:51]
v_min_u32 v29, v16, v17
M v[48:51],a[68:71],a[172:175],v[48:51]
v_med3_u32 v29, v28, v29, v18
M v[52:55],a[76:79],a[172:175],v[52:55]
s_nop 0
T a[116:117],v3,8192
T a[118:119],v3,9216
M v[52:55],a[72:75],a[168:171],v[52:55]
v_max_u32 v28, v28, v18
M v[56:59],a[80:83],a[168:171],v[56:59]
buffer_load_dwordx4 v9, s[16:19], s21 offen offset:1024  nt lds
M v[56:59],a[84:87],a[172:175],v[56:59]
s_waitcnt lgkmcnt(6)
v_med3_u32 v29, v28, v29, v19
M v[60:63],a[92:95],a[172:175],v[60:63]
v_max_u32 v28, v28, v19
M v[60:63],a[88:91],a[168:171],v[60:63]
s_nop 0
T a[120:121],v4,0
T a[122:123],v4,1024
M v[64:67],a[32:35],a[160:163],v[64:67]
R a[168:171],v5,38912
R a[172:175],v6,38912
M v[64:67],a[36:39],a[164:167],v[64:67]
buffer_load_dwordx4 v10, s[16:19], s21 offen offset:2048  nt lds
M v[68:71],a[44:47],a[164:167],v[68:71]
v_med3_u32 v29, v28, v29, v20
M v[68:71],a[40:43],a[160:163],v[68:71]
v_max_u32 v28, v28, v20
M v[72:75],a[48:51],a[160:163],v[72:75]
s_nop 0
T a[124:125],v4,8192
T a[126:127],v4,9216
M v[72:75],a[52:55],a[164:167],v[72:75]
v_med3_u32 v29, v28, v29, v21
M v[76:79],a[60:63],a[164:167],v[76:79]
buffer_load_dwordx4 v11, s[16:19], s21 offen offset:3072  nt lds
M v[76:79],a[56:59],a[160:163],v[76:79]
SA s21,s21,524160
v_max_u32 v28, v28, v21
M v[80:83],a[64:67],a[160:163],v[80:83]
v_med3_u32 v29, v28, v29, v22
M v[80:83],a[68:71],a[164:167],v[80:83]
v_max_u32 v28, v28, v22
M v[84:87],a[76:79],a[164:167],v[84:87]
v_med3_u32 v29, v28, v29, v23
M v[84:87],a[72:75],a[160:163],v[84:87]
v_max_u32 v28, v28, v23
M v[88:91],a[80:83],a[160:163],v[88:91]
s_nop 0
v_mov_b32 v30, v28 row_ror:8 row_mask:0xf bank_mask:0xf
M v[88:91],a[84:87],a[164:167],v[88:91]
s_waitcnt lgkmcnt(2)
v_mov_b32 v31, v29 row_ror:8 row_mask:0xf bank_mask:0xf
M v[92:95],a[92:95],a[164:167],v[92:95]
s_waitcnt lgkmcnt(0)
v_min_u32 v16, v28, v30
M v[92:95],a[88:91],a[160:163],v[92:95]
s_barrier
M v[96:99],a[32:35],a[168:171],v[96:99]
R a[160:163],v5,49152
R a[164:167],v6,49152
M v[96:99],a[36:39],a[172:175],v[96:99]
v_max_u32 v28, v28, v30
M v[100:103],a[44:47],a[172:175],v[100:103]
SA m0,s24,32768
T a[128:129],v1,16384
T a[130:131],v1,17408
M v[100:103],a[40:43],a[168:171],v[100:103]
buffer_load_dwordx4 v12, s[48:51], s22 offen offset:0   lds
M v[104:107],a[48:51],a[168:171],v[104:107]
v_max3_u32 v29, v29, v31, v16
M v[104:107],a[52:55],a[172:175],v[104:107]
v_mov_b32 v30, v28 row_ror:4 row_mask:0xf bank_mask:0xf
M v[108:111],a[60:63],a[172:175],v[108:111]
v_mov_b32 v31, v29 row_ror:4 row_mask:0xf bank_mask:0xf
M v[108:111],a[56:59],a[168:171],v[108:111]
v_min_u32 v16, v28, v30
M v[112:115],a[64:67],a[168:171],v[112:115]
v_max_u32 v28, v28, v30
M v[112:115],a[68:71],a[172:175],v[112:115]
s_nop 0
T a[132:133],v1,24576
T a[134:135],v1,25600
M v[116:119],a[76:79],a[172:175],v[116:119]
buffer_load_dwordx4 v13, s[48:51], s22 offen offset:1024   lds
M v[116:119],a[72:75],a[168:171],v[116:119]
v_max3_u32 v29, v29, v31, v16
M v[120:123],a[80:83],a[168:171],v[120:123]
v_mov_b32 v30, v28 row_ror:2 row_mask:0xf bank_mask:0xf
M v[120:123],a[84:87],a[172:175],v[120:123]
s_waitcnt lgkmcnt(4)
v_mov_b32 v31, v29 row_ror:2 row_mask:0xf bank_mask:0xf
M v[124:127],a[92:95],a[172:175],v[124:127]
v_min_u32 v16, v28, v30
M v[124:127],a[88:91],a[168:171],v[124:127]
v_max_u32 v28, v28, v30
M v[128:131],a[32:35],a[160:163],v[128:131]
R a[168:171],v5,51200
R a[172:175],v6,51200
M v[128:131],a[36:39],a[164:167],v[128:131]
T a[136:137],v2,16384
T a[138:139],v2,17408
M v[132:135],a[44:47],a[164:167],v[132:135]
buffer_load_dwordx4 v14, s[48:51], s22 offen offset:2048   lds
M v[132:135],a[40:43],a[160:163],v[132:135]
v_max3_u32 v29, v29, v31, v16
M v[136:139],a[48:51],a[160:163],v[136:139]
v_mov_b32 v30, v28 row_ror:1 row_mask:0xf bank_mask:0xf
M v[136:139],a[52:55],a[164:167],v[136:139]
v_mov_b32 v31, v29 row_ror:1 row_mask:0xf bank_mask:0xf
M v[140:143],a[60:63],a[164:167],v[140:143]
v_min_u32 v16, v28, v30
M v[140:143],a[56:59],a[160:163],v[140:143]
s_nop 0
T a[140:141],v2,24576
T a[142:143],v2,25600
M v[144:147],a[64:67],a[160:163],v[144:147]
buffer_load_dwordx4 v15, s[48:51], s22 offen offset:3072   lds
M v[144:147],a[68:71],a[164:167],v[144:147]
SA s22,s22,1048576
v_max_u32 v28, v28, v30
M v[148:151],a[76:79],a[164:167],v[148:151]
v_max3_u32 v29, v29, v31, v16
M v[148:151],a[72:75],a[160:163],v[148:151]
v_mov_b32 v30, v28
M v[152:155],a[80:83],a[160:163],v[152:155]
v_mov_b32 v31, v29
M v[152:155],a[84:87],a[164:167],v[152:155]
s_waitcnt lgkmcnt(4)
v_permlane16_swap_b32 v30, v28
M v[156:159],a[92:95],a[164:167],v[156:159]
SA m0,s23,0
T a[144:145],v3,16384
T a[146:147],v3,17408
M v[156:159],a[88:91],a[160:163],v[156:159]
buffer_load_dwordx4 v8, s[16:19], s21 offen offset:0  nt lds
M v[160:163],a[32:35],a[168:171],v[160:163]
R a[160:163],v5,53248
R a[164:167],v6,53248
M v[160:163],a[36:39],a[172:175],v[160:163]
v_permlane16_swap_b32 v31, v29
M v[164:167],a[44:47],a[172:175],v[164:167]
v_min_u32 v16, v28, v30
M v[164:167],a[40:43],a[168:171],v[164:167]
v_max_u32 v28, v28, v30
M v[168:171],a[48:51],a[168:171],v[168:171]
v_max3_u32 v29, v29, v31, v16
M v[168:171],a[52:55],a[172:175],v[168:171]
s_nop 0
T a[148:149],v3,24576
T a[150:151],v3,25600
M v[172:175],a[60:63],a[172:175],v[172:175]
buffer_load_dwordx4 v9, s[16:19], s21 offen offset:1024  nt lds
M v[172:175],a[56:59],a[168:171],v[172:175]
v_mov_b32 v30, v28
M v[176:179],a[64:67],a[168:171],v[176:179]
v_mov_b32 v31, v29
M v[176:179],a[68:71],a[172:175],v[176:179]
v_permlane32_swap_b32 v30, v28
M v[180:183],a[76:79],a[172:175],v[180:183]
v_permlane32_swap_b32 v31, v29
M v[180:183],a[72:75],a[168:171],v[180:183]
v_min_u32 v16, v28, v30
M v[184:187],a[80:83],a[168:171],v[184:187]
s_nop 0
T a[152:153],v4,16384
T a[154:155],v4,17408
M v[184:187],a[84:87],a[172:175],v[184:187]
s_waitcnt lgkmcnt(4)
buffer_load_dwordx4 v10, s[16:19], s21 offen offset:2048  nt lds
M v[188:191],a[92:95],a[172:175],v[188:191]
v_max_u32 v28, v28, v30
M v[188:191],a[88:91],a[168:171],v[188:191]
v_max3_u32 v29, v29, v31, v16
M v[192:195],a[32:35],a[160:163],v[192:195]
s_lshl_b32 s64, s20, 3
R a[168:171],v5,55296
R a[172:175],v6,55296
M v[192:195],a[36:39],a[164:167],v[192:195]
SA s64,s64,159744
v_mov_b32 v16, s64
M v[196:199],a[44:47],a[164:167],v[196:199]
ds_write_b64 v16, v[28:29]
M v[196:199],a[40:43],a[160:163],v[196:199]
s_nop 0
T a[156:157],v4,24576
T a[158:159],v4,25600
M v[200:203],a[48:51],a[160:163],v[200:203]
buffer_load_dwordx4 v11, s[16:19], s21 offen offset:3072  nt lds
M v[200:203],a[52:55],a[164:167],v[200:203]
SA s21,s21,128
M v[204:207],a[60:63],a[164:167],v[204:207]
M v[204:207],a[56:59],a[160:163],v[204:207]
M v[208:211],a[64:67],a[160:163],v[208:211]
M v[208:211],a[68:71],a[164:167],v[208:211]
M v[212:215],a[76:79],a[164:167],v[212:215]
M v[212:215],a[72:75],a[160:163],v[212:215]
M v[216:219],a[80:83],a[160:163],v[216:219]
M v[216:219],a[84:87],a[164:167],v[216:219]
s_waitcnt lgkmcnt(3)
M v[220:223],a[92:95],a[164:167],v[220:223]
s_waitcnt vmcnt(17) lgkmcnt(0)
M v[220:223],a[88:91],a[160:163],v[220:223]
s_barrier
M v[224:227],a[32:35],a[168:171],v[224:227]
R a[160:163],v5,0
R a[164:167],v6,0
M v[224:227],a[36:39],a[172:175],v[224:227]
M v[228:231],a[44:47],a[172:175],v[228:231]
M v[228:231],a[40:43],a[168:171],v[228:231]
M v[232:235],a[48:51],a[168:171],v[232:235]
M v[232:235],a[52:55],a[172:175],v[232:235]
M v[236:239],a[60:63],a[172:175],v[236:239]
M v[236:239],a[56:59],a[168:171],v[236:239]
M v[240:243],a[64:67],a[168:171],v[240:243]
M v[240:243],a[68:71],a[172:175],v[240:243]
M v[244:247],a[76:79],a[172:175],v[244:247]
M v[244:247],a[72:75],a[168:171],v[244:247]
M v[248:251],a[80:83],a[168:171],v[248:251]
M v[248:251],a[84:87],a[172:175],v[248:251]
s_waitcnt lgkmcnt(0)
M v[252:255],a[92:95],a[172:175],v[252:255]
M v[252:255],a[88:91],a[168:171],v[252:255]
M a[0:3],a[96:99],a[160:163],a[0:3]
R a[168:171],v5,2048
R a[172:175],v6,2048
M a[0:3],a[100:103],a[164:167],a[0:3]
T a[32:33],v1,32768
T a[34:35],v1,33792
M a[4:7],a[108:111],a[164:167],a[4:7]
SA m0,s24,49152
M a[4:7],a[104:107],a[160:163],a[4:7]
buffer_load_dwordx4 v12, s[48:51], s22 offen offset:0   lds
M a[8:11],a[112:115],a[160:163],a[8:11]
v_mov_b32 v28, 159744
M a[8:11],a[116:119],a[164:167],a[8:11]
ds_read_b128 v[16:19], v28
M a[12:15],a[124:127],a[164:167],a[12:15]
s_nop 0
T a[36:37],v1,40960
T a[38:39],v1,41984
M a[12:15],a[120:123],a[160:163],a[12:15]
R v[20:23],v28,16
M a[16:19],a[128:131],a[160:163],a[16:19]
buffer_load_dwordx4 v13, s[48:51], s22 offen offset:1024   lds
M a[16:19],a[132:135],a[164:167],a[16:19]
M a[20:23],a[140:143],a[164:167],a[20:23]
M a[20:23],a[136:139],a[160:163],a[20:23]
s_nop 0
T a[40:41],v2,32768
T a[42:43],v2,33792
M a[24:27],a[144:147],a[160:163],a[24:27]
M a[24:27],a[148:151],a[164:167],a[24:27]
s_waitcnt lgkmcnt(8)
buffer_load_dwordx4 v14, s[48:51], s22 offen offset:2048   lds
M a[28:31],a[156:159],a[164:167],a[28:31]
M a[28:31],a[152:155],a[160:163],a[28:31]
M v[32:35],a[96:99],a[168:171],v[32:35]
R a[160:163],v5,4096
R a[164:167],v6,4096
M v[32:35],a[100:103],a[172:175],v[32:35]
T a[44:45],v2,40960
T a[46:47],v2,41984
M v[36:39],a[108:111],a[172:175],v[36:39]
buffer_load_dwordx4 v15, s[48:51], s22 offen offset:3072   lds
M v[36:39],a[104:107],a[168:171],v[36:39]
s_sub_u32 s22, s22, 1048448
s_waitcnt lgkmcnt(9)
v_min_u32 v28, v16, v18
M v[40:43],a[112:115],a[168:171],v[40:43]
v_max_u32 v16, v16, v18
M v[40:43],a[116:119],a[172:175],v[40:43]
s_nop 0
T a[48:49],v3,32768
T a[50:51],v3,33792
M v[44:47],a[124:127],a[172:175],v[44:47]
SA m0,s23,16384
v_max3_u32 v17, v17, v19, v28
M v[44:47],a[120:123],a[168:171],v[44:47]
buffer_load_dwordx4 v8, s[16:19], s21 offen offset:0  nt lds
M v[48:51],a[128:131],a[168:171],v[48:51]
s_waitcnt lgkmcnt(8)
v_min_u32 v29, v20, v22
M v[48:51],a[132:135],a[172:175],v[48:51]
v_max_u32 v20, v20, v22
M v[52:55],a[140:143],a[172:175],v[52:55]
s_nop 0
T a[52:53],v3,40960
T a[54:55],v3,41984
M v[52:55],a[136:139],a[168:171],v[52:55]
v_max3_u32 v21, v21, v23, v29
M v[56:59],a[144:147],a[168:171],v[56:59]
buffer_load_dwordx4 v9, s[16:19], s21 offen offset:1024  nt lds
M v[56:59],a[148:151],a[172:175],v[56:59]
s_waitcnt lgkmcnt(6)
v_min_u32 v28, v16, v20
M v[60:63],a[156:159],a[172:175],v[60:63]
v_max_u32 v16, v16, v20
M v[60:63],a[152:155],a[168:171],v[60:63]
s_nop 0
T a[56:57],v4,32768
T a[58:59],v4,33792
M v[64:67],a[96:99],a[160:163],v[64:67]
R a[168:171],v5,6144
R a[172:175],v6,6144
M v[64:67],a[100:103],a[164:167],v[64:67]
buffer_load_dwordx4 v10, s[16:19], s21 offen offset:2048  nt lds
M v[68:71],a[108:111],a[164:167],v[68:71]
v_max3_u32 v17, v17, v21, v28
M v[68:71],a[104:107],a[160:163],v[68:71]
v_and_b32 v28, 1, v0
M v[72:75],a[112:115],a[160:163],v[72:75]
s_nop 0
T a[60:61],v4,40960
T a[62:63],v4,41984
M v[72:75],a[116:119],a[164:167],v[72:75]
v_cmp_eq_u32 vcc, 0, v28
M v[76:79],a[124:127],a[164:167],v[76:79]
s_and_b32 s64, s20, 1
buffer_load_dwordx4 v11, s[16:19], s21 offen offset:3072  nt lds
M v[76:79],a[120:123],a[160:163],v[76:79]
SA s21,s21,524160
s_mul_i32 s64, s64, 448
v_cndmask_b32 v24, v17, v16, vcc
M v[80:83],a[128:131],a[160:163],v[80:83]
v_and_b32 v24, 0x7ff, v24
M v[80:83],a[132:135],a[164:167],v[80:83]
v_sub_u32 v24, 2047, v24
M v[84:87],a[140:143],a[164:167],v[84:87]
v_mul_u32_u24 v28, 896, v24
M v[84:87],a[136:139],a[160:163],v[84:87]
v_lshrrev_b32 v29, 4, v0
M v[88:91],a[144:147],a[160:163],v[88:91]
v_lshl_add_u32 v28, v29, 4, v28
M v[88:91],a[148:151],a[164:167],v[88:91]
s_waitcnt lgkmcnt(2)
v_bfe_u32 v30, v0, 1, 3
M v[92:95],a[156:159],a[164:167],v[92:95]
s_waitcnt vmcnt(16) lgkmcnt(0)
v_lshl_or_b32 v28, v30, 26, v28
M v[92:95],a[152:155],a[160:163],v[92:95]
s_barrier
M v[96:99],a[96:99],a[168:171],v[96:99]
R a[160:163],v5,16384
R a[164:167],v6,16384
M v[96:99],a[100:103],a[172:175],v[96:99]
buffer_load_dwordx4 a[208:211], v28, s[56:59], s64 offen offset:0
M v[100:103],a[108:111],a[172:175],v[100:103]
SA m0,s24,0
T a[64:65],v1,49152
T a[66:67],v1,50176
M v[100:103],a[104:107],a[168:171],v[100:103]
buffer_load_dwordx4 v12, s[48:51], s22 offen offset:0   lds
M v[104:107],a[112:115],a[168:171],v[104:107]
M v[104:107],a[116:119],a[172:175],v[104:107]
M v[108:111],a[124:127],a[172:175],v[108:111]
buffer_load_dwordx4 a[212:215], v28, s[56:59], s64 offen offset:64
M v[108:111],a[120:123],a[168:171],v[108:111]
M v[112:115],a[128:131],a[168:171],v[112:115]
buffer_load_dwordx4 a[216:219], v28, s[56:59], s64 offen offset:128
M v[112:115],a[132:135],a[172:175],v[112:115]
s_nop 0
T a[68:69],v1,57344
T a[70:71],v1,58368
M v[116:119],a[140:143],a[172:175],v[116:119]
buffer_load_dwordx4 v13, s[48:51], s22 offen offset:1024   lds
M v[116:119],a[136:139],a[168:171],v[116:119]
M v[120:123],a[144:147],a[168:171],v[120:123]
M v[120:123],a[148:151],a[172:175],v[120:123]
s_waitcnt lgkmcnt(4)
M v[124:127],a[156:159],a[172:175],v[124:127]
buffer_load_dwordx4 a[220:223], v28, s[56:59], s64 offen offset:192
M v[124:127],a[152:155],a[168:171],v[124:127]
M v[128:131],a[96:99],a[160:163],v[128:131]
R a[168:171],v5,18432
R a[172:175],v6,18432
M v[128:131],a[100:103],a[164:167],v[128:131]
T a[72:73],v2,49152
T a[74:75],v2,50176
M v[132:135],a[108:111],a[164:167],v[132:135]
buffer_load_dwordx4 v14, s[48:51], s22 offen offset:2048   lds
M v[132:135],a[104:107],a[160:163],v[132:135]
M v[136:139],a[112:115],a[160:163],v[136:139]
buffer_load_dwordx4 a[224:227], v28, s[56:59], s64 offen offset:256
M v[136:139],a[116:119],a[164:167],v[136:139]
M v[140:143],a[124:127],a[164:167],v[140:143]
buffer_load_dwordx4 a[228:231], v28, s[56:59], s64 offen offset:320
M v[140:143],a[120:123],a[160:163],v[140:143]
s_nop 0
T a[76:77],v2,57344
T a[78:79],v2,58368
M v[144:147],a[128:131],a[160:163],v[144:147]
buffer_load_dwordx4 v15, s[48:51], s22 offen offset:3072   lds
M v[144:147],a[132:135],a[164:167],v[144:147]
SA s22,s22,1048576
M v[148:151],a[140:143],a[164:167],v[148:151]
M v[148:151],a[136:139],a[160:163],v[148:151]
buffer_load_dwordx4 a[232:235], v28, s[56:59], s64 offen offset:384
M v[152:155],a[144:147],a[160:163],v[152:155]
v_lshrrev_b32 v28, 4, v24
M v[152:155],a[148:151],a[164:167],v[152:155]
s_waitcnt lgkmcnt(4)
v_lshlrev_b32 v28, 5, v28
M v[156:159],a[156:159],a[164:167],v[156:159]
SA m0,s23,32768
T a[80:81],v3,49152
T a[82:83],v3,50176
M v[156:159],a[152:155],a[160:163],v[156:159]
buffer_load_dwordx4 v8, s[16:19], s21 offen offset:0  nt lds
M v[160:163],a[96:99],a[168:171],v[160:163]
L_w_kv04:
s_cbranch_execz L_w_kv08
R a[160:163],v5,20480
R a[164:167],v6,20480
M v[160:163],a[100:103],a[172:175],v[160:163]
v_and_b32 v30, 15, v24
M v[164:167],a[108:111],a[172:175],v[164:167]
v_add_lshl_u32 v28, v28, v30, 2
M v[164:167],a[104:107],a[168:171],v[164:167]
v_lshrrev_b32 v30, 1, v0
M v[168:171],a[112:115],a[168:171],v[168:171]
v_min_u32 v30, 1, v30
M v[168:171],a[116:119],a[172:175],v[168:171]
s_nop 0
T a[84:85],v3,57344
T a[86:87],v3,58368
M v[172:175],a[124:127],a[172:175],v[172:175]
buffer_load_dwordx4 v9, s[16:19], s21 offen offset:1024  nt lds
M v[172:175],a[120:123],a[168:171],v[172:175]
v_lshl_or_b32 v28, v30, 29, v28
M v[176:179],a[128:131],a[168:171],v[176:179]
s_or_b32 s64, s31, s20
M v[176:179],a[132:135],a[172:175],v[176:179]
s_min_u32 s64, s64, 1
M v[180:183],a[140:143],a[172:175],v[180:183]
s_lshl_b32 s64, s64, 29
M v[180:183],a[136:139],a[168:171],v[180:183]
SA s64,s64,104857600
buffer_load_dword v23, v28, s[8:11], s64 offen sc1
M v[184:187],a[144:147],a[168:171],v[184:187]
s_nop 0
T a[88:89],v4,49152
T a[90:91],v4,50176
M v[184:187],a[148:151],a[172:175],v[184:187]
s_waitcnt lgkmcnt(4)
buffer_load_dwordx4 v10, s[16:19], s21 offen offset:2048  nt lds
M v[188:191],a[156:159],a[172:175],v[188:191]
v_bfe_u32 v28, v0, 2, 2
M v[188:191],a[152:155],a[168:171],v[188:191]
v_lshl_add_u32 v28, v29, 3, v28
M v[192:195],a[96:99],a[160:163],v[192:195]
R a[168:171],v5,22528
R a[172:175],v6,22528
M v[192:195],a[100:103],a[164:167],v[192:195]
v_lshlrev_b32 v28, 5, v28
M v[196:199],a[108:111],a[164:167],v[196:199]
v_and_b32 v30, 3, v0
M v[196:199],a[104:107],a[160:163],v[196:199]
s_nop 0
T a[92:93],v4,57344
T a[94:95],v4,58368
M v[200:203],a[112:115],a[160:163],v[200:203]
buffer_load_dwordx4 v11, s[16:19], s21 offen offset:3072  nt lds
M v[200:203],a[116:119],a[164:167],v[200:203]
SA s21,s21,128
v_lshl_add_u32 v28, v30, 3, v28
M v[204:207],a[124:127],a[164:167],v[204:207]
v_add_u32 v22, s87, v28
M v[204:207],a[120:123],a[160:163],v[204:207]
M v[208:211],a[128:131],a[160:163],v[208:211]
M v[208:211],a[132:135],a[164:167],v[208:211]
M v[212:215],a[140:143],a[164:167],v[212:215]
M v[212:215],a[136:139],a[160:163],v[212:215]
M v[216:219],a[144:147],a[160:163],v[216:219]
M v[216:219],a[148:151],a[164:167],v[216:219]
s_waitcnt lgkmcnt(2)
M v[220:223],a[156:159],a[164:167],v[220:223]
s_waitcnt vmcnt(24) lgkmcnt(0)
M v[220:223],a[152:155],a[160:163],v[220:223]
s_barrier
M v[224:227],a[96:99],a[168:171],v[224:227]
R a[160:163],v5,32768
R a[164:167],v6,32768
M v[224:227],a[100:103],a[172:175],v[224:227]
M v[228:231],a[108:111],a[172:175],v[228:231]
M v[228:231],a[104:107],a[168:171],v[228:231]
M v[232:235],a[112:115],a[168:171],v[232:235]
M v[232:235],a[116:119],a[172:175],v[232:235]
M v[236:239],a[124:127],a[172:175],v[236:239]
M v[236:239],a[120:123],a[168:171],v[236:239]
M v[240:243],a[128:131],a[168:171],v[240:243]
M v[240:243],a[132:135],a[172:175],v[240:243]
M v[244:247],a[140:143],a[172:175],v[244:247]
M v[244:247],a[136:139],a[168:171],v[244:247]
M v[248:251],a[144:147],a[168:171],v[248:251]
M v[248:251],a[148:151],a[172:175],v[248:251]
s_waitcnt lgkmcnt(0)
M v[252:255],a[156:159],a[172:175],v[252:255]
M v[252:255],a[152:155],a[168:171],v[252:255]
M a[0:3],a[32:35],a[160:163],a[0:3]
R a[168:171],v5,34816
R a[172:175],v6,34816
M a[0:3],a[36:39],a[164:167],a[0:3]
T a[96:97],v1,0
T a[98:99],v1,1024
M a[4:7],a[44:47],a[164:167],a[4:7]
SA m0,s24,16384
M a[4:7],a[40:43],a[160:163],a[4:7]
buffer_load_dwordx4 v12, s[48:51], s22 offen offset:0   lds
M a[8:11],a[48:51],a[160:163],a[8:11]
M a[8:11],a[52:55],a[164:167],a[8:11]
M a[12:15],a[60:63],a[164:167],a[12:15]
s_nop 0
T a[100:101],v1,8192
T a[102:103],v1,9216
M a[12:15],a[56:59],a[160:163],a[12:15]
M a[16:19],a[64:67],a[160:163],a[16:19]
buffer_load_dwordx4 v13, s[48:51], s22 offen offset:1024   lds
M a[16:19],a[68:71],a[164:167],a[16:19]
M a[20:23],a[76:79],a[164:167],a[20:23]
M a[20:23],a[72:75],a[160:163],a[20:23]
s_nop 0
T a[104:105],v2,0
T a[106:107],v2,1024
M a[24:27],a[80:83],a[160:163],a[24:27]
M a[24:27],a[84:87],a[164:167],a[24:27]
s_waitcnt lgkmcnt(6)
buffer_load_dwordx4 v14, s[48:51], s22 offen offset:2048   lds
M a[28:31],a[92:95],a[164:167],a[28:31]
M a[28:31],a[88:91],a[160:163],a[28:31]
M v[32:35],a[32:35],a[168:171],v[32:35]
R a[160:163],v5,36864
R a[164:167],v6,36864
M v[32:35],a[36:39],a[172:175],v[32:35]
T a[108:109],v2,8192
T a[110:111],v2,9216
M v[36:39],a[44:47],a[172:175],v[36:39]
buffer_load_dwordx4 v15, s[48:51], s22 offen offset:3072   lds
M v[36:39],a[40:43],a[168:171],v[36:39]
s_sub_u32 s22, s22, 1048448
M v[40:43],a[48:51],a[168:171],v[40:43]
M v[40:43],a[52:55],a[172:175],v[40:43]
s_nop 0
T a[112:113],v3,0
T a[114:115],v3,1024
M v[44:47],a[60:63],a[172:175],v[44:47]
SA m0,s23,49152
M v[44:47],a[56:59],a[168:171],v[44:47]
buffer_load_dwordx4 v8, s[16:19], s21 offen offset:0  nt lds
M v[48:51],a[64:67],a[168:171],v[48:51]
M v[48:51],a[68:71],a[172:175],v[48:51]
M v[52:55],a[76:79],a[172:175],v[52:55]
s_nop 0
T a[116:117],v3,8192
T a[118:119],v3,9216
M v[52:55],a[72:75],a[168:171],v[52:55]
M v[56:59],a[80:83],a[168:171],v[56:59]
buffer_load_dwordx4 v9, s[16:19], s21 offen offset:1024  nt lds
M v[56:59],a[84:87],a[172:175],v[56:59]
s_waitcnt lgkmcnt(6)
M v[60:63],a[92:95],a[172:175],v[60:63]
M v[60:63],a[88:91],a[168:171],v[60:63]
s_nop 0
T a[120:121],v4,0
T a[122:123],v4,1024
M v[64:67],a[32:35],a[160:163],v[64:67]
R a[168:171],v5,38912
R a[172:175],v6,38912
M v[64:67],a[36:39],a[164:167],v[64:67]
buffer_load_dwordx4 v10, s[16:19], s21 offen offset:2048  nt lds
M v[68:71],a[44:47],a[164:167],v[68:71]
M v[68:71],a[40:43],a[160:163],v[68:71]
M v[72:75],a[48:51],a[160:163],v[72:75]
s_nop 0
T a[124:125],v4,8192
T a[126:127],v4,9216
M v[72:75],a[52:55],a[164:167],v[72:75]
M v[76:79],a[60:63],a[164:167],v[76:79]
buffer_load_dwordx4 v11, s[16:19], s21 offen offset:3072  nt lds
M v[76:79],a[56:59],a[160:163],v[76:79]
SA s21,s21,524160
M v[80:83],a[64:67],a[160:163],v[80:83]
M v[80:83],a[68:71],a[164:167],v[80:83]
M v[84:87],a[76:79],a[164:167],v[84:87]
M v[84:87],a[72:75],a[160:163],v[84:87]
M v[88:91],a[80:83],a[160:163],v[88:91]
M v[88:91],a[84:87],a[164:167],v[88:91]
s_waitcnt lgkmcnt(2)
M v[92:95],a[92:95],a[164:167],v[92:95]
s_waitcnt vmcnt(24) lgkmcnt(0)
M v[92:95],a[88:91],a[160:163],v[92:95]
s_barrier
M v[96:99],a[32:35],a[168:171],v[96:99]
R a[160:163],v5,49152
R a[164:167],v6,49152
M v[96:99],a[36:39],a[172:175],v[96:99]
M v[100:103],a[44:47],a[172:175],v[100:103]
SA m0,s24,32768
T a[128:129],v1,16384
T a[130:131],v1,17408
M v[100:103],a[40:43],a[168:171],v[100:103]
buffer_load_dwordx4 v12, s[48:51], s22 offen offset:0   lds
M v[104:107],a[48:51],a[168:171],v[104:107]
s_nop 0
T a[176:177],v22,0
T a[178:179],v22,128
M v[104:107],a[52:55],a[172:175],v[104:107]
T a[180:181],v22,1024
T a[182:183],v22,1152
M v[108:111],a[60:63],a[172:175],v[108:111]
T a[184:185],v22,2048
T a[186:187],v22,2176
M v[108:111],a[56:59],a[168:171],v[108:111]
T a[188:189],v22,3072
T a[190:191],v22,3200
M v[112:115],a[64:67],a[168:171],v[112:115]
M v[112:115],a[68:71],a[172:175],v[112:115]
s_nop 0
T a[132:133],v1,24576
T a[134:135],v1,25600
M v[116:119],a[76:79],a[172:175],v[116:119]
buffer_load_dwordx4 v13, s[48:51], s22 offen offset:1024   lds
M v[116:119],a[72:75],a[168:171],v[116:119]
M v[120:123],a[80:83],a[168:171],v[120:123]
M v[120:123],a[84:87],a[172:175],v[120:123]
s_waitcnt lgkmcnt(12)
M v[124:127],a[92:95],a[172:175],v[124:127]
M v[124:127],a[88:91],a[168:171],v[124:127]
M v[128:131],a[32:35],a[160:163],v[128:131]
R a[168:171],v5,51200
R a[172:175],v6,51200
M v[128:131],a[36:39],a[164:167],v[128:131]
T a[136:137],v2,16384
T a[138:139],v2,17408
M v[132:135],a[44:47],a[164:167],v[132:135]
buffer_load_dwordx4 v14, s[48:51], s22 offen offset:2048   lds
M v[132:135],a[40:43],a[160:163],v[132:135]
M v[136:139],a[48:51],a[160:163],v[136:139]
M v[136:139],a[52:55],a[164:167],v[136:139]
M v[140:143],a[60:63],a[164:167],v[140:143]
M v[140:143],a[56:59],a[160:163],v[140:143]
s_nop 0
T a[140:141],v2,24576
T a[142:143],v2,25600
M v[144:147],a[64:67],a[160:163],v[144:147]
buffer_load_dwordx4 v15, s[48:51], s22 offen offset:3072   lds
M v[144:147],a[68:71],a[164:167],v[144:147]
SA s22,s22,1048576
M v[148:151],a[76:79],a[164:167],v[148:151]
M v[148:151],a[72:75],a[160:163],v[148:151]
M v[152:155],a[80:83],a[160:163],v[152:155]
M v[152:155],a[84:87],a[164:167],v[152:155]
s_waitcnt lgkmcnt(4)
M v[156:159],a[92:95],a[164:167],v[156:159]
SA m0,s23,0
T a[144:145],v3,16384
T a[146:147],v3,17408
M v[156:159],a[88:91],a[160:163],v[156:159]
buffer_load_dwordx4 v8, s[16:19], s21 offen offset:0  nt lds
s_waitcnt vmcnt(28)
M v[16:19],a[176:179],a[208:211],0
s_waitcnt vmcnt(26)
M v[16:19],a[180:183],a[212:215],v[16:19]
s_waitcnt vmcnt(25)
M v[16:19],a[184:187],a[216:219],v[16:19]
s_waitcnt vmcnt(23)
M v[16:19],a[188:191],a[220:223],v[16:19]
M v[160:163],a[32:35],a[168:171],v[160:163]
R a[160:163],v5,53248
R a[164:167],v6,53248
M v[160:163],a[36:39],a[172:175],v[160:163]
T a[176:177],v22,4096
T a[178:179],v22,4224
M v[164:167],a[44:47],a[172:175],v[164:167]
T a[180:181],v22,5120
T a[182:183],v22,5248
M v[164:167],a[40:43],a[168:171],v[164:167]
T a[184:185],v22,6144
T a[186:187],v22,6272
M v[168:171],a[48:51],a[168:171],v[168:171]
M v[168:171],a[52:55],a[172:175],v[168:171]
s_nop 0
T a[148:149],v3,24576
T a[150:151],v3,25600
M v[172:175],a[60:63],a[172:175],v[172:175]
buffer_load_dwordx4 v9, s[16:19], s21 offen offset:1024  nt lds
M v[172:175],a[56:59],a[168:171],v[172:175]
M v[176:179],a[64:67],a[168:171],v[176:179]
M v[176:179],a[68:71],a[172:175],v[176:179]
M v[180:183],a[76:79],a[172:175],v[180:183]
M v[180:183],a[72:75],a[168:171],v[180:183]
M v[184:187],a[80:83],a[168:171],v[184:187]
s_nop 0
T a[152:153],v4,16384
T a[154:155],v4,17408
M v[184:187],a[84:87],a[172:175],v[184:187]
s_waitcnt lgkmcnt(10)
buffer_load_dwordx4 v10, s[16:19], s21 offen offset:2048  nt lds
M v[188:191],a[92:95],a[172:175],v[188:191]
M v[188:191],a[88:91],a[168:171],v[188:191]
M v[192:195],a[32:35],a[160:163],v[192:195]
R a[168:171],v5,55296
R a[172:175],v6,55296
M v[192:195],a[36:39],a[164:167],v[192:195]
M v[196:199],a[44:47],a[164:167],v[196:199]
M v[196:199],a[40:43],a[160:163],v[196:199]
s_nop 0
T a[156:157],v4,24576
T a[158:159],v4,25600
M v[200:203],a[48:51],a[160:163],v[200:203]
buffer_load_dwordx4 v11, s[16:19], s21 offen offset:3072  nt lds
M v[200:203],a[52:55],a[164:167],v[200:203]
SA s21,s21,128
M v[204:207],a[60:63],a[164:167],v[204:207]
M v[204:207],a[56:59],a[160:163],v[204:207]
M v[208:211],a[64:67],a[160:163],v[208:211]
M v[208:211],a[68:71],a[164:167],v[208:211]
M v[212:215],a[76:79],a[164:167],v[212:215]
M v[212:215],a[72:75],a[160:163],v[212:215]
M v[216:219],a[80:83],a[160:163],v[216:219]
M v[216:219],a[84:87],a[164:167],v[216:219]
s_waitcnt lgkmcnt(2)
M v[220:223],a[92:95],a[164:167],v[220:223]
s_waitcnt vmcnt(16) lgkmcnt(0)
M v[220:223],a[88:91],a[160:163],v[220:223]
s_barrier
M v[16:19],a[176:179],a[224:227],v[16:19]
M v[16:19],a[180:183],a[228:231],v[16:19]
M v[16:19],a[184:187],a[232:235],v[16:19]
M v[224:227],a[32:35],a[168:171],v[224:227]
R a[160:163],v5,0
R a[164:167],v6,0
M v[224:227],a[36:39],a[172:175],v[224:227]
M v[228:231],a[44:47],a[172:175],v[228:231]
M v[228:231],a[40:43],a[168:171],v[228:231]
M v[232:235],a[48:51],a[168:171],v[232:235]
M v[232:235],a[52:55],a[172:175],v[232:235]
M v[236:239],a[60:63],a[172:175],v[236:239]
M v[236:239],a[56:59],a[168:171],v[236:239]
M v[240:243],a[64:67],a[168:171],v[240:243]
M v[240:243],a[68:71],a[172:175],v[240:243]
M v[244:247],a[76:79],a[172:175],v[244:247]
M v[244:247],a[72:75],a[168:171],v[244:247]
M v[248:251],a[80:83],a[168:171],v[248:251]
M v[248:251],a[84:87],a[172:175],v[248:251]
s_waitcnt lgkmcnt(0)
M v[252:255],a[92:95],a[172:175],v[252:255]
M v[252:255],a[88:91],a[168:171],v[252:255]
M a[0:3],a[96:99],a[160:163],a[0:3]
R a[168:171],v5,2048
R a[172:175],v6,2048
M a[0:3],a[100:103],a[164:167],a[0:3]
T a[32:33],v1,32768
T a[34:35],v1,33792
M a[4:7],a[108:111],a[164:167],a[4:7]
SA m0,s24,49152
M a[4:7],a[104:107],a[160:163],a[4:7]
buffer_load_dwordx4 v12, s[48:51], s22 offen offset:0   lds
M a[8:11],a[112:115],a[160:163],a[8:11]
M a[8:11],a[116:119],a[164:167],a[8:11]
s_lshl_b32 s64, s20, 10
M a[12:15],a[124:127],a[164:167],a[12:15]
SA s64,s64,159744
T a[36:37],v1,40960
T a[38:39],v1,41984
M a[12:15],a[120:123],a[160:163],a[12:15]
v_add_u32 v21, s64, v7
ds_write_b128 v21, v[16:19]
M a[16:19],a[128:131],a[160:163],a[16:19]
s_mul_i32 s67, s86, 14336
buffer_load_dwordx4 v13, s[48:51], s22 offen offset:1024   lds
M a[16:19],a[132:135],a[164:167],a[16:19]
s_mul_i32 s64, s20, 224
M a[20:23],a[140:143],a[164:167],a[20:23]
SA s67,s67,s64
v_lshrrev_b32 v28, 4, v0
v_mul_u32_u24 v28, 896, v28
M a[20:23],a[136:139],a[160:163],a[20:23]
T a[40:41],v2,32768
T a[42:43],v2,33792
M a[24:27],a[144:147],a[160:163],a[24:27]
v_and_b32 v29, 15, v0
v_lshl_add_u32 v28, v29, 4, v28
M a[24:27],a[148:151],a[164:167],a[24:27]
s_waitcnt lgkmcnt(7)
buffer_load_dwordx4 v14, s[48:51], s22 offen offset:2048   lds
M a[28:31],a[156:159],a[164:167],a[28:31]
v_mov_b32 v30, 536870912
v_cmp_gt_u32 vcc, 14, v29
M a[28:31],a[152:155],a[160:163],a[28:31]
s_nop 0
M v[32:35],a[96:99],a[168:171],v[32:35]
s_nop 0
R a[160:163],v5,4096
R a[164:167],v6,4096
M v[32:35],a[100:103],a[172:175],v[32:35]
T a[44:45],v2,40960
T a[46:47],v2,41984
M v[36:39],a[108:111],a[172:175],v[36:39]
buffer_load_dwordx4 v15, s[48:51], s22 offen offset:3072   lds
M v[36:39],a[104:107],a[168:171],v[36:39]
s_sub_u32 s22, s22, 1048448
v_cndmask_b32 v28, v30, v28, vcc
v_add_u32 v29, 2560, v28
M v[40:43],a[112:115],a[168:171],v[40:43]
v_add_u32 v30, 5120, v28
v_add_u32 v31, 7680, v28
M v[40:43],a[116:119],a[172:175],v[40:43]
T a[48:49],v3,32768
T a[50:51],v3,33792
M v[44:47],a[124:127],a[172:175],v[44:47]
SA m0,s23,16384
M v[44:47],a[120:123],a[168:171],v[44:47]
buffer_load_dwordx4 v8, s[16:19], s21 offen offset:0  nt lds
M v[48:51],a[128:131],a[168:171],v[48:51]
M v[48:51],a[132:135],a[172:175],v[48:51]
M v[52:55],a[140:143],a[172:175],v[52:55]
s_nop 0
T a[52:53],v3,40960
T a[54:55],v3,41984
M v[52:55],a[136:139],a[168:171],v[52:55]
M v[56:59],a[144:147],a[168:171],v[56:59]
buffer_load_dwordx4 v9, s[16:19], s21 offen offset:1024  nt lds
M v[56:59],a[148:151],a[172:175],v[56:59]
s_waitcnt lgkmcnt(6)
M v[60:63],a[156:159],a[172:175],v[60:63]
M v[60:63],a[152:155],a[168:171],v[60:63]
s_nop 0
T a[56:57],v4,32768
T a[58:59],v4,33792
M v[64:67],a[96:99],a[160:163],v[64:67]
R a[168:171],v5,6144
R a[172:175],v6,6144
M v[64:67],a[100:103],a[164:167],v[64:67]
buffer_load_dwordx4 v10, s[16:19], s21 offen offset:2048  nt lds
M v[68:71],a[108:111],a[164:167],v[68:71]
M v[68:71],a[104:107],a[160:163],v[68:71]
M v[72:75],a[112:115],a[160:163],v[72:75]
s_nop 0
T a[60:61],v4,40960
T a[62:63],v4,41984
M v[72:75],a[116:119],a[164:167],v[72:75]
M v[76:79],a[124:127],a[164:167],v[76:79]
buffer_load_dwordx4 v11, s[16:19], s21 offen offset:3072  nt lds
M v[76:79],a[120:123],a[160:163],v[76:79]
SA s21,s21,524160
M v[80:83],a[128:131],a[160:163],v[80:83]
M v[80:83],a[132:135],a[164:167],v[80:83]
M v[84:87],a[140:143],a[164:167],v[84:87]
M v[84:87],a[136:139],a[160:163],v[84:87]
M v[88:91],a[144:147],a[160:163],v[88:91]
M v[88:91],a[148:151],a[164:167],v[88:91]
s_waitcnt lgkmcnt(2)
M v[92:95],a[156:159],a[164:167],v[92:95]
s_waitcnt vmcnt(16) lgkmcnt(0)
M v[92:95],a[152:155],a[160:163],v[92:95]
s_barrier
M v[96:99],a[96:99],a[168:171],v[96:99]
R a[160:163],v5,16384
R a[164:167],v6,16384
M v[96:99],a[100:103],a[172:175],v[96:99]
M v[100:103],a[108:111],a[172:175],v[100:103]
SA m0,s24,0
T a[64:65],v1,49152
T a[66:67],v1,50176
M v[100:103],a[104:107],a[168:171],v[100:103]
buffer_load_dwordx4 v12, s[48:51], s22 offen offset:0   lds
M v[104:107],a[112:115],a[168:171],v[104:107]
M v[104:107],a[116:119],a[172:175],v[104:107]
M v[108:111],a[124:127],a[172:175],v[108:111]
M v[108:111],a[120:123],a[168:171],v[108:111]
buffer_load_dwordx4 v13, s[48:51], s22 offen offset:1024   lds
M v[112:115],a[128:131],a[168:171],v[112:115]
M v[112:115],a[132:135],a[172:175],v[112:115]
s_nop 0
T a[68:69],v1,57344
T a[70:71],v1,58368
M v[116:119],a[140:143],a[172:175],v[116:119]
M v[116:119],a[136:139],a[168:171],v[116:119]
M v[120:123],a[144:147],a[168:171],v[120:123]
buffer_load_dwordx4 v14, s[48:51], s22 offen offset:2048   lds
M v[120:123],a[148:151],a[172:175],v[120:123]
s_waitcnt lgkmcnt(4)
M v[124:127],a[156:159],a[172:175],v[124:127]
M v[124:127],a[152:155],a[168:171],v[124:127]
M v[128:131],a[96:99],a[160:163],v[128:131]
R a[168:171],v5,18432
R a[172:175],v6,18432
M v[128:131],a[100:103],a[164:167],v[128:131]
T a[72:73],v2,49152
T a[74:75],v2,50176
M v[132:135],a[108:111],a[164:167],v[132:135]
buffer_load_dwordx4 v15, s[48:51], s22 offen offset:3072   lds
M v[132:135],a[104:107],a[160:163],v[132:135]
SA s22,s22,1048576
M v[136:139],a[112:115],a[160:163],v[136:139]
M v[136:139],a[116:119],a[164:167],v[136:139]
SA m0,s23,32768
M v[140:143],a[124:127],a[164:167],v[140:143]
buffer_load_dwordx4 v8, s[16:19], s21 offen offset:0  nt lds
M v[140:143],a[120:123],a[160:163],v[140:143]
s_nop 0
T a[76:77],v2,57344
T a[78:79],v2,58368
M v[144:147],a[128:131],a[160:163],v[144:147]
M v[144:147],a[132:135],a[164:167],v[144:147]
M v[148:151],a[140:143],a[164:167],v[148:151]
buffer_load_dwordx4 v9, s[16:19], s21 offen offset:1024  nt lds
M v[148:151],a[136:139],a[160:163],v[148:151]
M v[152:155],a[144:147],a[160:163],v[152:155]
M v[152:155],a[148:151],a[164:167],v[152:155]
s_waitcnt lgkmcnt(4)
M v[156:159],a[156:159],a[164:167],v[156:159]
s_nop 0
T a[80:81],v3,49152
T a[82:83],v3,50176
M v[156:159],a[152:155],a[160:163],v[156:159]
buffer_load_dwordx4 v10, s[16:19], s21 offen offset:2048  nt lds
M v[160:163],a[96:99],a[168:171],v[160:163]
R a[160:163],v5,20480
R a[164:167],v6,20480
M v[160:163],a[100:103],a[172:175],v[160:163]
M v[164:167],a[108:111],a[172:175],v[164:167]
M v[164:167],a[104:107],a[168:171],v[164:167]
M v[168:171],a[112:115],a[168:171],v[168:171]
buffer_load_dwordx4 v11, s[16:19], s21 offen offset:3072  nt lds
M v[168:171],a[116:119],a[172:175],v[168:171]
SA s21,s21,128
T a[84:85],v3,57344
T a[86:87],v3,58368
M v[172:175],a[124:127],a[172:175],v[172:175]
M v[172:175],a[120:123],a[168:171],v[172:175]
M v[176:179],a[128:131],a[168:171],v[176:179]
SA m0,s87,0
M v[176:179],a[132:135],a[172:175],v[176:179]
buffer_load_dwordx4 v28, s[68:71], s67 offen offset:0 nt lds
M v[180:183],a[140:143],a[172:175],v[180:183]
M v[180:183],a[136:139],a[168:171],v[180:183]
M v[184:187],a[144:147],a[168:171],v[184:187]
s_nop 0
T a[88:89],v4,49152
T a[90:91],v4,50176
M v[184:187],a[148:151],a[172:175],v[184:187]
s_waitcnt lgkmcnt(4)
buffer_load_dwordx4 v29, s[68:71], s67 offen offset:1024 nt lds
M v[188:191],a[156:159],a[172:175],v[188:191]
M v[188:191],a[152:155],a[168:171],v[188:191]
M v[192:195],a[96:99],a[160:163],v[192:195]
R a[168:171],v5,22528
R a[172:175],v6,22528
M v[192:195],a[100:103],a[164:167],v[192:195]
M v[196:199],a[108:111],a[164:167],v[196:199]
buffer_load_dwordx4 v30, s[68:71], s67 offen offset:2048 nt lds
M v[196:199],a[104:107],a[160:163],v[196:199]
s_nop 0
T a[92:93],v4,57344
T a[94:95],v4,58368
M v[200:203],a[112:115],a[160:163],v[200:203]
M v[200:203],a[116:119],a[164:167],v[200:203]
M v[204:207],a[124:127],a[164:167],v[204:207]
L_w_kv05:
s_cbranch_execz L_wd1
M v[204:207],a[120:123],a[160:163],v[204:207]
buffer_load_dwordx4 v31, s[68:71], s67 offen offset:3072 nt lds
M v[208:211],a[128:131],a[160:163],v[208:211]
SA s67,s67,0
M v[208:211],a[132:135],a[164:167],v[208:211]
M v[212:215],a[140:143],a[164:167],v[212:215]
M v[212:215],a[136:139],a[160:163],v[212:215]
M v[216:219],a[144:147],a[160:163],v[216:219]
M v[216:219],a[148:151],a[164:167],v[216:219]
s_waitcnt lgkmcnt(2)
M v[220:223],a[156:159],a[164:167],v[220:223]
s_waitcnt vmcnt(20) lgkmcnt(0)
M v[220:223],a[152:155],a[160:163],v[220:223]
s_barrier
M v[224:227],a[96:99],a[168:171],v[224:227]
R a[160:163],v5,32768
R a[164:167],v6,32768
M v[224:227],a[100:103],a[172:175],v[224:227]
M v[228:231],a[108:111],a[172:175],v[228:231]
M v[228:231],a[104:107],a[168:171],v[228:231]
M v[232:235],a[112:115],a[168:171],v[232:235]
M v[232:235],a[116:119],a[172:175],v[232:235]
M v[236:239],a[124:127],a[172:175],v[236:239]
M v[236:239],a[120:123],a[168:171],v[236:239]
M v[240:243],a[128:131],a[168:171],v[240:243]
M v[240:243],a[132:135],a[172:175],v[240:243]
M v[244:247],a[140:143],a[172:175],v[244:247]
M v[244:247],a[136:139],a[168:171],v[244:247]
M v[248:251],a[144:147],a[168:171],v[248:251]
M v[248:251],a[148:151],a[172:175],v[248:251]
s_waitcnt lgkmcnt(0)
M v[252:255],a[156:159],a[172:175],v[252:255]
M v[252:255],a[152:155],a[168:171],v[252:255]
M a[0:3],a[32:35],a[160:163],a[0:3]
R a[168:171],v5,34816
R a[172:175],v6,34816
M a[0:3],a[36:39],a[164:167],a[0:3]
T a[96:97],v1,0
T a[98:99],v1,1024
M a[4:7],a[44:47],a[164:167],a[4:7]
SA m0,s24,16384
C v23,v23,v23
M a[4:7],a[40:43],a[160:163],a[4:7]
buffer_load_dwordx4 v12, s[48:51], s22 offen offset:0   lds
M a[8:11],a[48:51],a[160:163],a[8:11]
v_and_b32 v23, 0xffff0000, v23
M a[8:11],a[52:55],a[164:167],a[8:11]
MF v22,0xbfb8aa3b,v23
M a[12:15],a[60:63],a[164:167],a[12:15]
s_nop 0
T a[100:101],v1,8192
T a[102:103],v1,9216
M a[12:15],a[56:59],a[160:163],a[12:15]
E v22,v22
M a[16:19],a[64:67],a[160:163],a[16:19]
buffer_load_dwordx4 v13, s[48:51], s22 offen offset:1024   lds
M a[16:19],a[68:71],a[164:167],a[16:19]
AF v22,1.0,v22
M a[20:23],a[76:79],a[164:167],a[20:23]
v_rcp_f32 v23, v22
M a[20:23],a[72:75],a[160:163],a[20:23]
s_or_b32 s64, s31, s20
T a[104:105],v2,0
T a[106:107],v2,1024
M a[24:27],a[80:83],a[160:163],a[24:27]
s_min_u32 s64, s64, 1
s_lshl_b32 s64, s64, 29
v_lshrrev_b32 v22, 1, v0
M a[24:27],a[84:87],a[164:167],a[24:27]
s_waitcnt lgkmcnt(6)
buffer_load_dwordx4 v14, s[48:51], s22 offen offset:2048   lds
M a[28:31],a[92:95],a[164:167],a[28:31]
v_min_u32 v22, 1, v22
M a[28:31],a[88:91],a[160:163],a[28:31]
v_lshlrev_b32 v22, 29, v22
M v[32:35],a[32:35],a[168:171],v[32:35]
R a[160:163],v5,36864
R a[164:167],v6,36864
M v[32:35],a[36:39],a[172:175],v[32:35]
T a[108:109],v2,8192
T a[110:111],v2,9216
M v[36:39],a[44:47],a[172:175],v[36:39]
buffer_load_dwordx4 v15, s[48:51], s22 offen offset:3072   lds
M v[36:39],a[40:43],a[168:171],v[36:39]
s_sub_u32 s22, s22, 1048448
v_lshl_or_b32 v22, v0, 2, v22
M v[40:43],a[48:51],a[168:171],v[40:43]
v_or_b32 v22, s64, v22
M v[40:43],a[52:55],a[172:175],v[40:43]
s_nop 0
T a[112:113],v3,0
T a[114:115],v3,1024
M v[44:47],a[60:63],a[172:175],v[44:47]
SA m0,s23,49152
C v23,v23,v23
M v[44:47],a[56:59],a[168:171],v[44:47]
buffer_load_dwordx4 v8, s[16:19], s21 offen offset:0  nt lds
M v[48:51],a[64:67],a[168:171],v[48:51]
v_and_b32 v23, 0xffff0000, v23
M v[48:51],a[68:71],a[172:175],v[48:51]
s_lshl_b32 s64, s41, 7
M v[52:55],a[76:79],a[172:175],v[52:55]
SA s64,s64,104890368
T a[116:117],v3,8192
T a[118:119],v3,9216
M v[52:55],a[72:75],a[168:171],v[52:55]
buffer_store_dword v24, v22, s[8:11], s64 offen sc1
M v[56:59],a[80:83],a[168:171],v[56:59]
buffer_load_dwordx4 v9, s[16:19], s21 offen offset:1024  nt lds
M v[56:59],a[84:87],a[172:175],v[56:59]
s_waitcnt lgkmcnt(6)
buffer_store_dword v23, v22, s[8:11], s64 offen offset:8 sc1
M v[60:63],a[92:95],a[172:175],v[60:63]
v_add_u32 v25, 159744, v7
M v[60:63],a[88:91],a[168:171],v[60:63]
s_nop 0
T a[120:121],v4,0
T a[122:123],v4,1024
M v[64:67],a[32:35],a[160:163],v[64:67]
R a[168:171],v5,38912
R a[172:175],v6,38912
M v[64:67],a[36:39],a[164:167],v[64:67]
buffer_load_dwordx4 v10, s[16:19], s21 offen offset:2048  nt lds
M v[68:71],a[44:47],a[164:167],v[68:71]
ds_read_b128 v[16:19], v25
M v[68:71],a[40:43],a[160:163],v[68:71]
R v[28:31],v25,1024
M v[72:75],a[48:51],a[160:163],v[72:75]
s_nop 0
T a[124:125],v4,8192
T a[126:127],v4,9216
M v[72:75],a[52:55],a[164:167],v[72:75]
R v[20:23],v25,2048
M v[76:79],a[60:63],a[164:167],v[76:79]
buffer_load_dwordx4 v11, s[16:19], s21 offen offset:3072  nt lds
M v[76:79],a[56:59],a[160:163],v[76:79]
SA s21,s21,524160
M v[80:83],a[64:67],a[160:163],v[80:83]
M v[80:83],a[68:71],a[164:167],v[80:83]
M v[84:87],a[76:79],a[164:167],v[84:87]
M v[84:87],a[72:75],a[160:163],v[84:87]
M v[88:91],a[80:83],a[160:163],v[88:91]
M v[88:91],a[84:87],a[164:167],v[88:91]
s_waitcnt lgkmcnt(5)
s_waitcnt lgkmcnt(3)
AF v16,v28,v16
M v[92:95],a[92:95],a[164:167],v[92:95]
s_waitcnt vmcnt(22) lgkmcnt(0)
AF v17,v29,v17
M v[92:95],a[88:91],a[160:163],v[92:95]
s_barrier
M v[96:99],a[32:35],a[168:171],v[96:99]
R a[160:163],v5,49152
R a[164:167],v6,49152
M v[96:99],a[36:39],a[172:175],v[96:99]
AF v18,v30,v18
M v[100:103],a[44:47],a[172:175],v[100:103]
SA m0,s24,32768
T a[128:129],v1,16384
T a[130:131],v1,17408
M v[100:103],a[40:43],a[168:171],v[100:103]
buffer_load_dwordx4 v12, s[48:51], s22 offen offset:0   lds
M v[104:107],a[48:51],a[168:171],v[104:107]
AF v19,v31,v19
M v[104:107],a[52:55],a[172:175],v[104:107]
R v[28:31],v25,3072
M v[108:111],a[60:63],a[172:175],v[108:111]
C v25,v16,v17
M v[108:111],a[56:59],a[168:171],v[108:111]
v_lshlrev_b32 v16, 16, v25
M v[112:115],a[64:67],a[168:171],v[112:115]
v_and_b32 v17, 0xffff0000, v25
M v[112:115],a[68:71],a[172:175],v[112:115]
s_nop 0
T a[132:133],v1,24576
T a[134:135],v1,25600
M v[116:119],a[76:79],a[172:175],v[116:119]
buffer_load_dwordx4 v13, s[48:51], s22 offen offset:1024   lds
M v[116:119],a[72:75],a[168:171],v[116:119]
C v25,v18,v19
M v[120:123],a[80:83],a[168:171],v[120:123]
v_lshlrev_b32 v18, 16, v25
M v[120:123],a[84:87],a[172:175],v[120:123]
s_waitcnt lgkmcnt(5)
v_and_b32 v19, 0xffff0000, v25
M v[124:127],a[92:95],a[172:175],v[124:127]
s_waitcnt lgkmcnt(2)
AF v20,v28,v20
M v[124:127],a[88:91],a[168:171],v[124:127]
AF v21,v29,v21
M v[128:131],a[32:35],a[160:163],v[128:131]
R a[168:171],v5,51200
R a[172:175],v6,51200
M v[128:131],a[36:39],a[164:167],v[128:131]
T a[136:137],v2,16384
T a[138:139],v2,17408
M v[132:135],a[44:47],a[164:167],v[132:135]
buffer_load_dwordx4 v14, s[48:51], s22 offen offset:2048   lds
M v[132:135],a[40:43],a[160:163],v[132:135]
AF v22,v30,v22
M v[136:139],a[48:51],a[160:163],v[136:139]
AF v23,v31,v23
M v[136:139],a[52:55],a[164:167],v[136:139]
MF v28,0xbfb8aa3b,v16
M v[140:143],a[60:63],a[164:167],v[140:143]
MF v29,0xbfb8aa3b,v17
M v[140:143],a[56:59],a[160:163],v[140:143]
s_nop 0
T a[140:141],v2,24576
T a[142:143],v2,25600
M v[144:147],a[64:67],a[160:163],v[144:147]
buffer_load_dwordx4 v15, s[48:51], s22 offen offset:3072   lds
M v[144:147],a[68:71],a[164:167],v[144:147]
SA s22,s22,1048576
MF v30,0xbfb8aa3b,v18
M v[148:151],a[76:79],a[164:167],v[148:151]
MF v31,0xbfb8aa3b,v19
M v[148:151],a[72:75],a[160:163],v[148:151]
E v28,v28
M v[152:155],a[80:83],a[160:163],v[152:155]
E v29,v29
M v[152:155],a[84:87],a[164:167],v[152:155]
s_waitcnt lgkmcnt(4)
E v30,v30
M v[156:159],a[92:95],a[164:167],v[156:159]
SA m0,s23,0
T a[144:145],v3,16384
T a[146:147],v3,17408
M v[156:159],a[88:91],a[160:163],v[156:159]
buffer_load_dwordx4 v8, s[16:19], s21 offen offset:0  nt lds
M v[160:163],a[32:35],a[168:171],v[160:163]
R a[160:163],v5,53248
R a[164:167],v6,53248
M v[160:163],a[36:39],a[172:175],v[160:163]
E v31,v31
M v[164:167],a[44:47],a[172:175],v[164:167]
C v25,v20,v21
M v[164:167],a[40:43],a[168:171],v[164:167]
v_lshlrev_b32 v20, 16, v25
M v[168:171],a[48:51],a[168:171],v[168:171]
v_and_b32 v21, 0xffff0000, v25
M v[168:171],a[52:55],a[172:175],v[168:171]
s_nop 0
T a[148:149],v3,24576
T a[150:151],v3,25600
M v[172:175],a[60:63],a[172:175],v[172:175]
buffer_load_dwordx4 v9, s[16:19], s21 offen offset:1024  nt lds
M v[172:175],a[56:59],a[168:171],v[172:175]
C v25,v22,v23
M v[176:179],a[64:67],a[168:171],v[176:179]
v_lshlrev_b32 v22, 16, v25
M v[176:179],a[68:71],a[172:175],v[176:179]
v_and_b32 v23, 0xffff0000, v25
M v[180:183],a[76:79],a[172:175],v[180:183]
AF v28,1.0,v28
M v[180:183],a[72:75],a[168:171],v[180:183]
AF v29,1.0,v29
M v[184:187],a[80:83],a[168:171],v[184:187]
s_nop 0
T a[152:153],v4,16384
T a[154:155],v4,17408
M v[184:187],a[84:87],a[172:175],v[184:187]
s_waitcnt lgkmcnt(4)
buffer_load_dwordx4 v10, s[16:19], s21 offen offset:2048  nt lds
M v[188:191],a[92:95],a[172:175],v[188:191]
AF v30,1.0,v30
M v[188:191],a[88:91],a[168:171],v[188:191]
AF v31,1.0,v31
M v[192:195],a[32:35],a[160:163],v[192:195]
R a[168:171],v5,55296
R a[172:175],v6,55296
M v[192:195],a[36:39],a[164:167],v[192:195]
v_rcp_f32 v28, v28
M v[196:199],a[44:47],a[164:167],v[196:199]
v_rcp_f32 v29, v29
M v[196:199],a[40:43],a[160:163],v[196:199]
T a[156:157],v4,24576
T a[158:159],v4,25600
M v[200:203],a[48:51],a[160:163],v[200:203]
buffer_load_dwordx4 v11, s[16:19], s21 offen offset:3072  nt lds
M v[200:203],a[52:55],a[164:167],v[200:203]
SA s21,s21,128
v_rcp_f32 v30, v30
M v[204:207],a[60:63],a[164:167],v[204:207]
v_rcp_f32 v31, v31
M v[204:207],a[56:59],a[160:163],v[204:207]
MF v16,v28,v16
M v[208:211],a[64:67],a[160:163],v[208:211]
MF v17,v29,v17
M v[208:211],a[68:71],a[164:167],v[208:211]
MF v18,v30,v18
M v[212:215],a[76:79],a[164:167],v[212:215]
MF v19,v31,v19
M v[212:215],a[72:75],a[160:163],v[212:215]
C v25,v16,v17
M v[216:219],a[80:83],a[160:163],v[216:219]
v_lshlrev_b32 v16, 16, v25
M v[216:219],a[84:87],a[164:167],v[216:219]
s_waitcnt lgkmcnt(2)
v_and_b32 v17, 0xffff0000, v25
M v[220:223],a[92:95],a[164:167],v[220:223]
s_waitcnt vmcnt(22) lgkmcnt(0)
C v25,v18,v19
M v[220:223],a[88:91],a[160:163],v[220:223]
s_barrier
M v[224:227],a[32:35],a[168:171],v[224:227]
R a[160:163],v5,0
R a[164:167],v6,0
M v[224:227],a[36:39],a[172:175],v[224:227]
v_lshlrev_b32 v18, 16, v25
M v[228:231],a[44:47],a[172:175],v[228:231]
v_and_b32 v19, 0xffff0000, v25
M v[228:231],a[40:43],a[168:171],v[228:231]
MF v16,v20,v16
M v[232:235],a[48:51],a[168:171],v[232:235]
MF v17,v21,v17
M v[232:235],a[52:55],a[172:175],v[232:235]
MF v18,v22,v18
M v[236:239],a[60:63],a[172:175],v[236:239]
MF v19,v23,v19
M v[236:239],a[56:59],a[168:171],v[236:239]
C v16,v16,v17
M v[240:243],a[64:67],a[168:171],v[240:243]
C v17,v18,v19
M v[240:243],a[68:71],a[172:175],v[240:243]
M v[244:247],a[76:79],a[172:175],v[244:247]
M v[244:247],a[72:75],a[168:171],v[244:247]
M v[248:251],a[80:83],a[168:171],v[248:251]
M v[248:251],a[84:87],a[172:175],v[248:251]
s_waitcnt lgkmcnt(0)
M v[252:255],a[92:95],a[172:175],v[252:255]
M v[252:255],a[88:91],a[168:171],v[252:255]
M a[0:3],a[96:99],a[160:163],a[0:3]
R a[168:171],v5,2048
R a[172:175],v6,2048
M a[0:3],a[100:103],a[164:167],a[0:3]
T a[32:33],v1,32768
T a[34:35],v1,33792
M a[4:7],a[108:111],a[164:167],a[4:7]
SA m0,s24,49152
v_lshrrev_b32 v28, 4, v0
v_and_b32 v29, 7, v0
M a[4:7],a[104:107],a[160:163],a[4:7]
buffer_load_dwordx4 v12, s[48:51], s22 offen offset:0   lds
M a[8:11],a[112:115],a[160:163],a[8:11]
v_xor_b32 v28, v28, v29
v_lshlrev_b32 v28, 4, v28
M a[8:11],a[116:119],a[164:167],a[8:11]
v_lshrrev_b32 v29, 3, v0
v_mul_u32_u24 v29, 896, v29
M a[12:15],a[124:127],a[164:167],a[12:15]
T a[36:37],v1,40960
T a[38:39],v1,41984
M a[12:15],a[120:123],a[160:163],a[12:15]
v_add_u32 v22, v28, v29
v_xor_b32 v28, 64, v28
M a[16:19],a[128:131],a[160:163],a[16:19]
s_mul_i32 s64, s20, 14336
buffer_load_dwordx4 v13, s[48:51], s22 offen offset:1024   lds
M a[16:19],a[132:135],a[164:167],a[16:19]
s_sub_u32 s65, 98304, s64
M a[20:23],a[140:143],a[164:167],a[20:23]
SA s30,s29,s65
M a[20:23],a[136:139],a[160:163],a[20:23]
SA s29,s29,s64
T a[40:41],v2,32768
T a[42:43],v2,33792
M a[24:27],a[144:147],a[160:163],a[24:27]
v_add_u32 v29, 6144, v29
v_add_u32 v23, v28, v29
M a[24:27],a[148:151],a[164:167],a[24:27]
s_waitcnt lgkmcnt(6)
buffer_load_dwordx4 v14, s[48:51], s22 offen offset:2048   lds
M a[28:31],a[156:159],a[164:167],a[28:31]
s_and_b32 s64, s20, 1
M a[28:31],a[152:155],a[160:163],a[28:31]
s_lshl_b32 s64, s64, 12
M v[32:35],a[96:99],a[168:171],v[32:35]
SA s64,s64,65536
R a[160:163],v5,4096
R a[164:167],v6,4096
M v[32:35],a[100:103],a[172:175],v[32:35]
T a[44:45],v2,40960
T a[46:47],v2,41984
M v[36:39],a[108:111],a[172:175],v[36:39]
buffer_load_dwordx4 v15, s[48:51], s22 offen offset:3072   lds
M v[36:39],a[104:107],a[168:171],v[36:39]
s_sub_u32 s22, s22, 1048448
v_add_u32 v20, s64, v5
v_add_u32 v21, s64, v6
M v[40:43],a[112:115],a[168:171],v[40:43]
v_lshrrev_b32 v28, 2, v0
v_lshlrev_b32 v28, 8, v28
M v[40:43],a[116:119],a[172:175],v[40:43]
T a[48:49],v3,32768
T a[50:51],v3,33792
M v[44:47],a[124:127],a[172:175],v[44:47]
SA m0,s23,16384
v_and_b32 v29, 3, v0
v_lshl_add_u32 v28, v29, 3, v28
M v[44:47],a[120:123],a[168:171],v[44:47]
buffer_load_dwordx4 v8, s[16:19], s21 offen offset:0  nt lds
M v[48:51],a[128:131],a[168:171],v[48:51]
v_add_u32 v28, s87, v28
M v[48:51],a[132:135],a[172:175],v[48:51]
s_waitcnt vmcnt(23)
s_nop 0
T a[176:177],v28,0
T a[178:179],v28,32
M v[52:55],a[140:143],a[172:175],v[52:55]
T a[52:53],v3,40960
T a[54:55],v3,41984
M v[52:55],a[136:139],a[168:171],v[52:55]
T a[180:181],v28,64
T a[182:183],v28,96
M v[56:59],a[144:147],a[168:171],v[56:59]
buffer_load_dwordx4 v9, s[16:19], s21 offen offset:1024  nt lds
M v[56:59],a[148:151],a[172:175],v[56:59]
s_waitcnt lgkmcnt(10)
s_nop 0
T a[184:185],v28,128
T a[186:187],v28,160
M v[60:63],a[156:159],a[172:175],v[60:63]
T a[188:189],v28,192
M v[60:63],a[152:155],a[168:171],v[60:63]
s_nop 0
T a[56:57],v4,32768
T a[58:59],v4,33792
M v[64:67],a[96:99],a[160:163],v[64:67]
R a[168:171],v5,6144
R a[172:175],v6,6144
M v[64:67],a[100:103],a[164:167],v[64:67]
buffer_load_dwordx4 v10, s[16:19], s21 offen offset:2048  nt lds
s_waitcnt lgkmcnt(12)
v_mfma_f32_16x16x16_bf16 a[192:195], a[176:177], v[16:17], 0
M v[68:71],a[108:111],a[164:167],v[68:71]
v_mov_b32 v18, v16 row_shr:2 row_mask:0xf bank_mask:0xf bound_ctrl:0
v_mov_b32 v19, v17 row_shr:2 row_mask:0xf bank_mask:0xf bound_ctrl:0
M v[68:71],a[104:107],a[160:163],v[68:71]
M v[72:75],a[112:115],a[160:163],v[72:75]
s_nop 0
T a[60:61],v4,40960
T a[62:63],v4,41984
M v[72:75],a[116:119],a[164:167],v[72:75]
s_waitcnt lgkmcnt(13)
v_mfma_f32_16x16x16_bf16 a[192:195], a[178:179], v[18:19], a[192:195]
M v[76:79],a[124:127],a[164:167],v[76:79]
buffer_load_dwordx4 v11, s[16:19], s21 offen offset:3072  nt lds
M v[76:79],a[120:123],a[160:163],v[76:79]
SA s21,s21,524160
v_mov_b32 v16, v18 row_shr:2 row_mask:0xf bank_mask:0xf bound_ctrl:0
v_mov_b32 v17, v19 row_shr:2 row_mask:0xf bank_mask:0xf bound_ctrl:0
M v[80:83],a[128:131],a[160:163],v[80:83]
M v[80:83],a[132:135],a[164:167],v[80:83]
s_waitcnt lgkmcnt(10)
v_mfma_f32_16x16x16_bf16 a[192:195], a[180:181], v[16:17], a[192:195]
M v[84:87],a[140:143],a[164:167],v[84:87]
v_mov_b32 v18, v16 row_shr:2 row_mask:0xf bank_mask:0xf bound_ctrl:0
v_mov_b32 v19, v17 row_shr:2 row_mask:0xf bank_mask:0xf bound_ctrl:0
M v[84:87],a[136:139],a[160:163],v[84:87]
M v[88:91],a[144:147],a[160:163],v[88:91]
M v[88:91],a[148:151],a[164:167],v[88:91]
s_waitcnt lgkmcnt(2)
v_mfma_f32_16x16x16_bf16 a[192:195], a[182:183], v[18:19], a[192:195]
M v[92:95],a[156:159],a[164:167],v[92:95]
s_waitcnt vmcnt(16) lgkmcnt(0)
v_mov_b32 v16, v18 row_shr:2 row_mask:0xf bank_mask:0xf bound_ctrl:0
v_mov_b32 v17, v19 row_shr:2 row_mask:0xf bank_mask:0xf bound_ctrl:0
M v[92:95],a[152:155],a[160:163],v[92:95]
s_barrier
M v[96:99],a[96:99],a[168:171],v[96:99]
R a[160:163],v5,16384
R a[164:167],v6,16384
M v[96:99],a[100:103],a[172:175],v[96:99]
SA m0,s23,131072
v_mfma_f32_16x16x16_bf16 a[192:195], a[184:185], v[16:17], a[192:195]
M v[100:103],a[108:111],a[172:175],v[100:103]
s_nop 0
T a[64:65],v1,49152
T a[66:67],v1,50176
M v[100:103],a[104:107],a[168:171],v[100:103]
v_mov_b32 v18, v16 row_shr:2 row_mask:0xf bank_mask:0xf bound_ctrl:0
v_mov_b32 v19, v17 row_shr:2 row_mask:0xf bank_mask:0xf bound_ctrl:0
M v[104:107],a[112:115],a[168:171],v[104:107]
buffer_load_dwordx4 v22, s[56:59], s29 offen offset:0 lds
M v[104:107],a[116:119],a[172:175],v[104:107]
v_mfma_f32_16x16x16_bf16 a[192:195], a[186:187], v[18:19], a[192:195]
M v[108:111],a[124:127],a[172:175],v[108:111]
v_mov_b32 v16, v18 row_shr:2 row_mask:0xf bank_mask:0xf bound_ctrl:0
v_mov_b32 v17, v19 row_shr:2 row_mask:0xf bank_mask:0xf bound_ctrl:0
M v[108:111],a[120:123],a[168:171],v[108:111]
buffer_load_dwordx4 v23, s[56:59], s29 offen offset:1024 lds
M v[112:115],a[128:131],a[168:171],v[112:115]
M v[112:115],a[132:135],a[172:175],v[112:115]
s_nop 0
T a[68:69],v1,57344
T a[70:71],v1,58368
v_mfma_f32_16x16x16_bf16 a[192:195], a[188:189], v[16:17], a[192:195]
M v[116:119],a[140:143],a[172:175],v[116:119]
buffer_load_dwordx4 v22, s[56:59], s30 offen offset:2048 lds
M v[116:119],a[136:139],a[168:171],v[116:119]
v_and_b32 v29, 1, v0
v_mul_u32_u24 v30, 1792, v29
M v[120:123],a[144:147],a[168:171],v[120:123]
v_lshrrev_b32 v31, 4, v0
v_lshl_add_u32 v30, v31, 4, v30
M v[120:123],a[148:151],a[172:175],v[120:123]
s_waitcnt lgkmcnt(4)
v_bfe_u32 v29, v0, 1, 3
v_lshl_add_u32 v30, v29, 6, v30
M v[124:127],a[156:159],a[172:175],v[124:127]
v_add_u32 v29, 1, v29
v_lshrrev_b32 v29, 3, v29
M v[124:127],a[152:155],a[168:171],v[124:127]
v_lshl_or_b32 v30, v29, 29, v30
v_or_b32 v30, s88, v30
M v[128:131],a[96:99],a[160:163],v[128:131]
s_mul_i32 s89, s86, 3584
R a[168:171],v5,18432
R a[172:175],v6,18432
M v[128:131],a[100:103],a[164:167],v[128:131]
s_mul_i32 s64, s20, 448
T a[72:73],v2,49152
T a[74:75],v2,50176
M v[132:135],a[108:111],a[164:167],v[132:135]
SA s89,s89,s64
M v[132:135],a[104:107],a[160:163],v[132:135]
SA s89,s89,105906176
buffer_store_dwordx4 a[192:195], v30, s[8:11], s89 offen sc1
M v[136:139],a[112:115],a[160:163],v[136:139]
M v[136:139],a[116:119],a[164:167],v[136:139]
M v[140:143],a[124:127],a[164:167],v[140:143]
buffer_load_dwordx4 v23, s[56:59], s30 offen offset:3072 lds
M v[140:143],a[120:123],a[160:163],v[140:143]
SA s29,s29,128
T a[76:77],v2,57344
T a[78:79],v2,58368
M v[144:147],a[128:131],a[160:163],v[144:147]
SA s30,s30,128
M v[144:147],a[132:135],a[164:167],v[144:147]
SA m0,s24,0
M v[148:151],a[140:143],a[164:167],v[148:151]
buffer_load_dwordx4 v12, s[48:51], s22 offen offset:0   lds
M v[148:151],a[136:139],a[160:163],v[148:151]
M v[152:155],a[144:147],a[160:163],v[152:155]
M v[152:155],a[148:151],a[164:167],v[152:155]
s_waitcnt lgkmcnt(4)
buffer_load_dwordx4 v13, s[48:51], s22 offen offset:1024   lds
M v[156:159],a[156:159],a[164:167],v[156:159]
s_nop 0
T a[80:81],v3,49152
T a[82:83],v3,50176
M v[156:159],a[152:155],a[160:163],v[156:159]
M v[160:163],a[96:99],a[168:171],v[160:163]
R a[160:163],v5,20480
R a[164:167],v6,20480
M v[160:163],a[100:103],a[172:175],v[160:163]
buffer_load_dwordx4 v14, s[48:51], s22 offen offset:2048   lds
M v[164:167],a[108:111],a[172:175],v[164:167]
M v[164:167],a[104:107],a[168:171],v[164:167]
M v[168:171],a[112:115],a[168:171],v[168:171]
buffer_load_dwordx4 v15, s[48:51], s22 offen offset:3072   lds
M v[168:171],a[116:119],a[172:175],v[168:171]
SA s22,s22,1048576
T a[84:85],v3,57344
T a[86:87],v3,58368
M v[172:175],a[124:127],a[172:175],v[172:175]
SA m0,s23,32768
M v[172:175],a[120:123],a[168:171],v[172:175]
buffer_load_dwordx4 v8, s[16:19], s21 offen offset:0  nt lds
L_w_kv06:
s_cbranch_execz L_wd1
M v[176:179],a[128:131],a[168:171],v[176:179]
M v[176:179],a[132:135],a[172:175],v[176:179]
M v[180:183],a[140:143],a[172:175],v[180:183]
M v[180:183],a[136:139],a[168:171],v[180:183]
buffer_load_dwordx4 v9, s[16:19], s21 offen offset:1024  nt lds
M v[184:187],a[144:147],a[168:171],v[184:187]
s_nop 0
T a[88:89],v4,49152
T a[90:91],v4,50176
M v[184:187],a[148:151],a[172:175],v[184:187]
s_waitcnt lgkmcnt(4)
M v[188:191],a[156:159],a[172:175],v[188:191]
M v[188:191],a[152:155],a[168:171],v[188:191]
M v[192:195],a[96:99],a[160:163],v[192:195]
R a[168:171],v5,22528
R a[172:175],v6,22528
M v[192:195],a[100:103],a[164:167],v[192:195]
buffer_load_dwordx4 v10, s[16:19], s21 offen offset:2048  nt lds
M v[196:199],a[108:111],a[164:167],v[196:199]
M v[196:199],a[104:107],a[160:163],v[196:199]
s_nop 0
T a[92:93],v4,57344
T a[94:95],v4,58368
M v[200:203],a[112:115],a[160:163],v[200:203]
M v[200:203],a[116:119],a[164:167],v[200:203]
buffer_load_dwordx4 v11, s[16:19], s21 offen offset:3072  nt lds
M v[204:207],a[124:127],a[164:167],v[204:207]
M v[204:207],a[120:123],a[160:163],v[204:207]
M v[208:211],a[128:131],a[160:163],v[208:211]
M v[208:211],a[132:135],a[164:167],v[208:211]
M v[212:215],a[140:143],a[164:167],v[212:215]
SA s21,s21,128
M v[212:215],a[136:139],a[160:163],v[212:215]
M v[216:219],a[144:147],a[160:163],v[216:219]
M v[216:219],a[148:151],a[164:167],v[216:219]
s_waitcnt lgkmcnt(2)
M v[220:223],a[156:159],a[164:167],v[220:223]
s_waitcnt vmcnt(21) lgkmcnt(0)
M v[220:223],a[152:155],a[160:163],v[220:223]
s_barrier
M v[224:227],a[96:99],a[168:171],v[224:227]
R a[160:163],v5,32768
R a[164:167],v6,32768
M v[224:227],a[100:103],a[172:175],v[224:227]
M v[228:231],a[108:111],a[172:175],v[228:231]
M v[228:231],a[104:107],a[168:171],v[228:231]
M v[232:235],a[112:115],a[168:171],v[232:235]
M v[232:235],a[116:119],a[172:175],v[232:235]
M v[236:239],a[124:127],a[172:175],v[236:239]
M v[236:239],a[120:123],a[168:171],v[236:239]
M v[240:243],a[128:131],a[168:171],v[240:243]
M v[240:243],a[132:135],a[172:175],v[240:243]
M v[244:247],a[140:143],a[172:175],v[244:247]
M v[244:247],a[136:139],a[168:171],v[244:247]
M v[248:251],a[144:147],a[168:171],v[248:251]
M v[248:251],a[148:151],a[172:175],v[248:251]
s_waitcnt lgkmcnt(0)
M v[252:255],a[156:159],a[172:175],v[252:255]
M v[252:255],a[152:155],a[168:171],v[252:255]
M a[0:3],a[32:35],a[160:163],a[0:3]
R a[168:171],v5,34816
R a[172:175],v6,34816
M a[0:3],a[36:39],a[164:167],a[0:3]
SA m0,s23,147456
T a[96:97],v1,0
T a[98:99],v1,1024
M a[4:7],a[44:47],a[164:167],a[4:7]
buffer_load_dwordx4 v22, s[56:59], s29 offen offset:0 lds
M a[4:7],a[40:43],a[160:163],a[4:7]
M a[8:11],a[48:51],a[160:163],a[8:11]
M a[8:11],a[52:55],a[164:167],a[8:11]
buffer_load_dwordx4 v23, s[56:59], s29 offen offset:1024 lds
M a[12:15],a[60:63],a[164:167],a[12:15]
s_nop 0
T a[100:101],v1,8192
T a[102:103],v1,9216
M a[12:15],a[56:59],a[160:163],a[12:15]
M a[16:19],a[64:67],a[160:163],a[16:19]
buffer_load_dwordx4 v22, s[56:59], s30 offen offset:2048 lds
M a[16:19],a[68:71],a[164:167],a[16:19]
M a[20:23],a[76:79],a[164:167],a[20:23]
M a[20:23],a[72:75],a[160:163],a[20:23]
s_nop 0
T a[104:105],v2,0
T a[106:107],v2,1024
M a[24:27],a[80:83],a[160:163],a[24:27]
buffer_load_dwordx4 v23, s[56:59], s30 offen offset:3072 lds
M a[24:27],a[84:87],a[164:167],a[24:27]
s_waitcnt lgkmcnt(6)
M a[28:31],a[92:95],a[164:167],a[28:31]
SA s29,s29,128
M a[28:31],a[88:91],a[160:163],a[28:31]
SA s30,s30,128
M v[32:35],a[32:35],a[168:171],v[32:35]
SA m0,s24,16384
R a[160:163],v5,36864
R a[164:167],v6,36864
M v[32:35],a[36:39],a[172:175],v[32:35]
T a[108:109],v2,8192
T a[110:111],v2,9216
M v[36:39],a[44:47],a[172:175],v[36:39]
buffer_load_dwordx4 v12, s[48:51], s22 offen offset:0   lds
M v[36:39],a[40:43],a[168:171],v[36:39]
M v[40:43],a[48:51],a[168:171],v[40:43]
M v[40:43],a[52:55],a[172:175],v[40:43]
s_nop 0
T a[112:113],v3,0
T a[114:115],v3,1024
M v[44:47],a[60:63],a[172:175],v[44:47]
buffer_load_dwordx4 v13, s[48:51], s22 offen offset:1024   lds
M v[44:47],a[56:59],a[168:171],v[44:47]
M v[48:51],a[64:67],a[168:171],v[48:51]
M v[48:51],a[68:71],a[172:175],v[48:51]
buffer_load_dwordx4 v14, s[48:51], s22 offen offset:2048   lds
M v[52:55],a[76:79],a[172:175],v[52:55]
s_nop 0
T a[116:117],v3,8192
T a[118:119],v3,9216
M v[52:55],a[72:75],a[168:171],v[52:55]
M v[56:59],a[80:83],a[168:171],v[56:59]
buffer_load_dwordx4 v15, s[48:51], s22 offen offset:3072   lds
M v[56:59],a[84:87],a[172:175],v[56:59]
s_waitcnt lgkmcnt(6)
M v[60:63],a[92:95],a[172:175],v[60:63]
s_sub_u32 s22, s22, 1048448
M v[60:63],a[88:91],a[168:171],v[60:63]
SA m0,s23,49152
T a[120:121],v4,0
T a[122:123],v4,1024
M v[64:67],a[32:35],a[160:163],v[64:67]
R a[168:171],v5,38912
R a[172:175],v6,38912
M v[64:67],a[36:39],a[164:167],v[64:67]
buffer_load_dwordx4 v8, s[16:19], s21 offen offset:0  nt lds
M v[68:71],a[44:47],a[164:167],v[68:71]
M v[68:71],a[40:43],a[160:163],v[68:71]
M v[72:75],a[48:51],a[160:163],v[72:75]
s_waitcnt vmcnt(17)
s_nop 0
T a[124:125],v4,8192
T a[126:127],v4,9216
M v[72:75],a[52:55],a[164:167],v[72:75]
buffer_load_dwordx4 v9, s[16:19], s21 offen offset:1024  nt lds
M v[76:79],a[60:63],a[164:167],v[76:79]
R a[176:179],v20,0
R a[180:183],v20,2048
M v[76:79],a[56:59],a[160:163],v[76:79]
R a[184:187],v21,0
R a[188:191],v21,2048
M v[80:83],a[64:67],a[160:163],v[80:83]
buffer_load_dwordx4 v10, s[16:19], s21 offen offset:2048  nt lds
M v[80:83],a[68:71],a[164:167],v[80:83]
M v[84:87],a[76:79],a[164:167],v[84:87]
M v[84:87],a[72:75],a[160:163],v[84:87]
buffer_load_dwordx4 v11, s[16:19], s21 offen offset:3072  nt lds
M v[88:91],a[80:83],a[160:163],v[88:91]
SA s21,s21,524160
M v[88:91],a[84:87],a[164:167],v[88:91]
s_waitcnt lgkmcnt(6)
M v[92:95],a[92:95],a[164:167],v[92:95]
s_waitcnt lgkmcnt(0)
M v[92:95],a[88:91],a[160:163],v[92:95]
s_barrier
M v[96:99],a[32:35],a[168:171],v[96:99]
s_lshl_b32 s4, s20, 10
R a[160:163],v5,49152
R a[164:167],v6,49152
M v[96:99],a[36:39],a[172:175],v[96:99]
SA m0,s23,131072
v_bfe_u32 v28, v0, 3, 2
M v[100:103],a[44:47],a[172:175],v[100:103]
s_nop 0
T a[128:129],v1,16384
T a[130:131],v1,17408
M v[100:103],a[40:43],a[168:171],v[100:103]
buffer_load_dwordx4 v22, s[56:59], s29 offen offset:0 lds
M v[104:107],a[48:51],a[168:171],v[104:107]
v_lshrrev_b32 v29, 5, v0
v_lshl_add_u32 v28, v29, 3, v28
M v[104:107],a[52:55],a[172:175],v[104:107]
M v[108:111],a[60:63],a[172:175],v[108:111]
buffer_load_dwordx4 v23, s[56:59], s29 offen offset:1024 lds
M v[108:111],a[56:59],a[168:171],v[108:111]
v_lshlrev_b32 v28, 13, v28
M v[112:115],a[64:67],a[168:171],v[112:115]
v_lshrrev_b32 v29, 4, v0
M v[112:115],a[68:71],a[172:175],v[112:115]
s_nop 0
T a[132:133],v1,24576
T a[134:135],v1,25600
M v[116:119],a[76:79],a[172:175],v[116:119]
buffer_load_dwordx4 v22, s[56:59], s30 offen offset:2048 lds
M v[116:119],a[72:75],a[168:171],v[116:119]
v_lshlrev_b32 v29, 1, v29
M v[120:123],a[80:83],a[168:171],v[120:123]
v_and_b32 v30, 7, v0
M v[120:123],a[84:87],a[172:175],v[120:123]
s_waitcnt lgkmcnt(4)
M v[124:127],a[92:95],a[172:175],v[124:127]
v_xor_b32 v29, v29, v30
M v[124:127],a[88:91],a[168:171],v[124:127]
buffer_load_dwordx4 v23, s[56:59], s30 offen offset:3072 lds
M v[128:131],a[32:35],a[160:163],v[128:131]
R a[168:171],v5,51200
R a[172:175],v6,51200
M v[128:131],a[36:39],a[164:167],v[128:131]
SA s29,s29,128
T a[136:137],v2,16384
T a[138:139],v2,17408
M v[132:135],a[44:47],a[164:167],v[132:135]
SA s30,s30,128
v_lshl_add_u32 v28, v29, 4, v28
M v[132:135],a[40:43],a[160:163],v[132:135]
s_and_b32 s64, s20, 1
M v[136:139],a[48:51],a[160:163],v[136:139]
s_lshl_b32 s64, s64, 17
M v[136:139],a[52:55],a[164:167],v[136:139]
s_lshr_b32 s65, s20, 1
M v[140:143],a[60:63],a[164:167],v[140:143]
s_lshl_b32 s65, s65, 15
SA s64,s64,s65
v_add_u32 v8, s64, v28
M v[140:143],a[56:59],a[160:163],v[140:143]
SA m0,s24,32768
T a[140:141],v2,24576
T a[142:143],v2,25600
M v[144:147],a[64:67],a[160:163],v[144:147]
buffer_load_dwordx4 v12, s[48:51], s22 offen offset:0   lds
M v[144:147],a[68:71],a[164:167],v[144:147]
M v[148:151],a[76:79],a[164:167],v[148:151]
M v[148:151],a[72:75],a[160:163],v[148:151]
buffer_load_dwordx4 v13, s[48:51], s22 offen offset:1024   lds
M v[152:155],a[80:83],a[160:163],v[152:155]
M v[152:155],a[84:87],a[164:167],v[152:155]
s_waitcnt lgkmcnt(4)
M v[156:159],a[92:95],a[164:167],v[156:159]
s_nop 0
T a[144:145],v3,16384
T a[146:147],v3,17408
M v[156:159],a[88:91],a[160:163],v[156:159]
buffer_load_dwordx4 v14, s[48:51], s22 offen offset:2048   lds
M v[160:163],a[32:35],a[168:171],v[160:163]
R a[160:163],v5,53248
R a[164:167],v6,53248
M v[160:163],a[36:39],a[172:175],v[160:163]
M v[164:167],a[44:47],a[172:175],v[164:167]
buffer_load_dwordx4 v15, s[48:51], s22 offen offset:3072   lds
M v[164:167],a[40:43],a[168:171],v[164:167]
M v[168:171],a[48:51],a[168:171],v[168:171]
SA s22,s22,1048576
M v[168:171],a[52:55],a[172:175],v[168:171]
s_mov_b32 s25, 0
T a[148:149],v3,24576
T a[150:151],v3,25600
M v[172:175],a[60:63],a[172:175],v[172:175]
SA m0,s4,0
M v[172:175],a[56:59],a[168:171],v[172:175]
buffer_load_dwordx4 v8, s[52:55], s25 offen lds
M v[176:179],a[64:67],a[168:171],v[176:179]
M v[176:179],a[68:71],a[172:175],v[176:179]
s_mov_b32 s25, 262144
M v[180:183],a[76:79],a[172:175],v[180:183]
SA m0,s4,4096
M v[180:183],a[72:75],a[168:171],v[180:183]
buffer_load_dwordx4 v8, s[52:55], s25 offen lds
M v[184:187],a[80:83],a[168:171],v[184:187]
s_nop 0
T a[152:153],v4,16384
T a[154:155],v4,17408
M v[184:187],a[84:87],a[172:175],v[184:187]
s_waitcnt lgkmcnt(4)
M v[188:191],a[92:95],a[172:175],v[188:191]
s_mov_b32 s25, 524288
M v[188:191],a[88:91],a[168:171],v[188:191]
SA m0,s4,8192
M v[192:195],a[32:35],a[160:163],v[192:195]
R a[168:171],v5,55296
R a[172:175],v6,55296
M v[192:195],a[36:39],a[164:167],v[192:195]
buffer_load_dwordx4 v8, s[52:55], s25 offen lds
M v[196:199],a[44:47],a[164:167],v[196:199]
M v[196:199],a[40:43],a[160:163],v[196:199]
s_mov_b32 s25, 786432
T a[156:157],v4,24576
T a[158:159],v4,25600
M v[200:203],a[48:51],a[160:163],v[200:203]
SA m0,s4,12288
M v[200:203],a[52:55],a[164:167],v[200:203]
s_waitcnt vmcnt(19)
buffer_load_dwordx4 v8, s[52:55], s25 offen lds
M v[204:207],a[60:63],a[164:167],v[204:207]
R a[192:195],v20,16384
R a[196:199],v20,18432
M v[204:207],a[56:59],a[160:163],v[204:207]
R a[200:203],v21,16384
R a[204:207],v21,18432
M v[208:211],a[64:67],a[160:163],v[208:211]
M v[208:211],a[68:71],a[164:167],v[208:211]
M v[212:215],a[76:79],a[164:167],v[212:215]
M v[212:215],a[72:75],a[160:163],v[212:215]
M v[216:219],a[80:83],a[160:163],v[216:219]
M v[216:219],a[84:87],a[164:167],v[216:219]
s_waitcnt lgkmcnt(6)
M v[220:223],a[92:95],a[164:167],v[220:223]
s_waitcnt lgkmcnt(0)
M v[220:223],a[88:91],a[160:163],v[220:223]
s_barrier
M v[224:227],a[32:35],a[168:171],v[224:227]
R a[160:163],v5,0
R a[164:167],v6,0
M v[224:227],a[36:39],a[172:175],v[224:227]
M v[228:231],a[44:47],a[172:175],v[228:231]
M v[228:231],a[40:43],a[168:171],v[228:231]
M v[232:235],a[48:51],a[168:171],v[232:235]
M v[232:235],a[52:55],a[172:175],v[232:235]
M v[236:239],a[60:63],a[172:175],v[236:239]
M v[236:239],a[56:59],a[168:171],v[236:239]
M v[240:243],a[64:67],a[168:171],v[240:243]
M v[240:243],a[68:71],a[172:175],v[240:243]
M v[244:247],a[76:79],a[172:175],v[244:247]
M v[244:247],a[72:75],a[168:171],v[244:247]
M v[248:251],a[80:83],a[168:171],v[248:251]
M v[248:251],a[84:87],a[172:175],v[248:251]
s_waitcnt lgkmcnt(0)
M v[252:255],a[92:95],a[172:175],v[252:255]
M v[252:255],a[88:91],a[168:171],v[252:255]
M a[0:3],a[96:99],a[160:163],a[0:3]
R a[168:171],v5,2048
R a[172:175],v6,2048
M a[0:3],a[100:103],a[164:167],a[0:3]
SA m0,s23,147456
T a[32:33],v1,32768
T a[34:35],v1,33792
M a[4:7],a[108:111],a[164:167],a[4:7]
buffer_load_dwordx4 v22, s[56:59], s29 offen offset:0 lds
M a[4:7],a[104:107],a[160:163],a[4:7]
M a[8:11],a[112:115],a[160:163],a[8:11]
M a[8:11],a[116:119],a[164:167],a[8:11]
buffer_load_dwordx4 v23, s[56:59], s29 offen offset:1024 lds
M a[12:15],a[124:127],a[164:167],a[12:15]
s_nop 0
T a[36:37],v1,40960
T a[38:39],v1,41984
M a[12:15],a[120:123],a[160:163],a[12:15]
M a[16:19],a[128:131],a[160:163],a[16:19]
buffer_load_dwordx4 v22, s[56:59], s30 offen offset:2048 lds
M a[16:19],a[132:135],a[164:167],a[16:19]
M a[20:23],a[140:143],a[164:167],a[20:23]
M a[20:23],a[136:139],a[160:163],a[20:23]
s_nop 0
T a[40:41],v2,32768
T a[42:43],v2,33792
M a[24:27],a[144:147],a[160:163],a[24:27]
buffer_load_dwordx4 v23, s[56:59], s30 offen offset:3072 lds
M a[24:27],a[148:151],a[164:167],a[24:27]
s_waitcnt lgkmcnt(6)
M a[28:31],a[156:159],a[164:167],a[28:31]
SA s29,s29,128
M a[28:31],a[152:155],a[160:163],a[28:31]
SA s30,s30,128
M v[32:35],a[96:99],a[168:171],v[32:35]
SA m0,s24,49152
R a[160:163],v5,4096
R a[164:167],v6,4096
M v[32:35],a[100:103],a[172:175],v[32:35]
T a[44:45],v2,40960
T a[46:47],v2,41984
M v[36:39],a[108:111],a[172:175],v[36:39]
buffer_load_dwordx4 v12, s[48:51], s22 offen offset:0   lds
M v[36:39],a[104:107],a[168:171],v[36:39]
M v[40:43],a[112:115],a[168:171],v[40:43]
M v[40:43],a[116:119],a[172:175],v[40:43]
s_nop 0
T a[48:49],v3,32768
T a[50:51],v3,33792
M v[44:47],a[124:127],a[172:175],v[44:47]
buffer_load_dwordx4 v13, s[48:51], s22 offen offset:1024   lds
M v[44:47],a[120:123],a[168:171],v[44:47]
M v[48:51],a[128:131],a[168:171],v[48:51]
M v[48:51],a[132:135],a[172:175],v[48:51]
buffer_load_dwordx4 v14, s[48:51], s22 offen offset:2048   lds
M v[52:55],a[140:143],a[172:175],v[52:55]
s_nop 0
T a[52:53],v3,40960
T a[54:55],v3,41984
M v[52:55],a[136:139],a[168:171],v[52:55]
M v[56:59],a[144:147],a[168:171],v[56:59]
buffer_load_dwordx4 v15, s[48:51], s22 offen offset:3072   lds
M v[56:59],a[148:151],a[172:175],v[56:59]
s_waitcnt lgkmcnt(6)
M v[60:63],a[156:159],a[172:175],v[60:63]
s_sub_u32 s22, s22, 1048448
M v[60:63],a[152:155],a[168:171],v[60:63]
s_mov_b32 s25, 1048576
T a[56:57],v4,32768
T a[58:59],v4,33792
M v[64:67],a[96:99],a[160:163],v[64:67]
SA m0,s4,16384
R a[168:171],v5,6144
R a[172:175],v6,6144
M v[64:67],a[100:103],a[164:167],v[64:67]
buffer_load_dwordx4 v8, s[52:55], s25 offen lds
M v[68:71],a[108:111],a[164:167],v[68:71]
s_mov_b32 s25, 1310720
M v[68:71],a[104:107],a[160:163],v[68:71]
SA m0,s4,20480
M v[72:75],a[112:115],a[160:163],v[72:75]
s_waitcnt vmcnt(17)
s_nop 0
T a[60:61],v4,40960
T a[62:63],v4,41984
M v[72:75],a[116:119],a[164:167],v[72:75]
buffer_load_dwordx4 v8, s[52:55], s25 offen lds
M v[76:79],a[124:127],a[164:167],v[76:79]
s_mov_b32 s25, 1572864
R a[208:211],v20,0
R a[212:215],v20,2048
M v[76:79],a[120:123],a[160:163],v[76:79]
SA m0,s4,24576
R a[216:219],v21,0
R a[220:223],v21,2048
M v[80:83],a[128:131],a[160:163],v[80:83]
buffer_load_dwordx4 v8, s[52:55], s25 offen lds
M v[80:83],a[132:135],a[164:167],v[80:83]
s_mov_b32 s25, 1835008
M v[84:87],a[140:143],a[164:167],v[84:87]
SA m0,s4,28672
M v[84:87],a[136:139],a[160:163],v[84:87]
buffer_load_dwordx4 v8, s[52:55], s25 offen lds
M v[88:91],a[144:147],a[160:163],v[88:91]
M v[88:91],a[148:151],a[164:167],v[88:91]
s_waitcnt lgkmcnt(6)
M v[92:95],a[156:159],a[164:167],v[92:95]
s_waitcnt lgkmcnt(0)
M v[92:95],a[152:155],a[160:163],v[92:95]
s_barrier
M v[96:99],a[96:99],a[168:171],v[96:99]
R a[160:163],v5,16384
R a[164:167],v6,16384
M v[96:99],a[100:103],a[172:175],v[96:99]
SA m0,s23,32768
M v[100:103],a[108:111],a[172:175],v[100:103]
s_nop 0
T a[64:65],v1,49152
T a[66:67],v1,50176
M v[100:103],a[104:107],a[168:171],v[100:103]
buffer_load_dwordx4 v22, s[56:59], s29 offen offset:0 lds
M v[104:107],a[112:115],a[168:171],v[104:107]
v_lshrrev_b32 v28, 2, v0
v_lshlrev_b32 v28, 7, v28
M v[104:107],a[116:119],a[172:175],v[104:107]
M v[108:111],a[124:127],a[172:175],v[108:111]
buffer_load_dwordx4 v23, s[56:59], s29 offen offset:1024 lds
M v[108:111],a[120:123],a[168:171],v[108:111]
v_and_b32 v29, 3, v0
M v[112:115],a[128:131],a[168:171],v[112:115]
v_lshl_add_u32 v28, v29, 3, v28
M v[112:115],a[132:135],a[172:175],v[112:115]
s_nop 0
T a[68:69],v1,57344
T a[70:71],v1,58368
M v[116:119],a[140:143],a[172:175],v[116:119]
buffer_load_dwordx4 v22, s[56:59], s30 offen offset:2048 lds
M v[116:119],a[136:139],a[168:171],v[116:119]
v_bfe_u32 v29, v0, 3, 2
M v[120:123],a[144:147],a[168:171],v[120:123]
M v[120:123],a[148:151],a[172:175],v[120:123]
s_waitcnt lgkmcnt(4)
v_lshl_add_u32 v16, v29, 5, v28
M v[124:127],a[156:159],a[172:175],v[124:127]
M v[124:127],a[152:155],a[168:171],v[124:127]
buffer_load_dwordx4 v23, s[56:59], s30 offen offset:3072 lds
M v[128:131],a[96:99],a[160:163],v[128:131]
R a[168:171],v5,18432
R a[172:175],v6,18432
M v[128:131],a[100:103],a[164:167],v[128:131]
SA s29,s29,128
T a[72:73],v2,49152
T a[74:75],v2,50176
M v[132:135],a[108:111],a[164:167],v[132:135]
SA s30,s30,128
v_xor_b32 v17, 32, v16
v_xor_b32 v18, 64, v16
M v[132:135],a[104:107],a[160:163],v[132:135]
SA m0,s23,65536
M v[136:139],a[112:115],a[160:163],v[136:139]
buffer_load_dwordx4 v22, s[56:59], s29 offen offset:0 lds
M v[136:139],a[116:119],a[164:167],v[136:139]
v_xor_b32 v19, 0x60, v16
M v[140:143],a[124:127],a[164:167],v[140:143]
v_add_u32 v12, 0x20000, v16
M v[140:143],a[120:123],a[160:163],v[140:143]
s_nop 0
T a[76:77],v2,57344
T a[78:79],v2,58368
M v[144:147],a[128:131],a[160:163],v[144:147]
buffer_load_dwordx4 v23, s[56:59], s29 offen offset:1024 lds
M v[144:147],a[132:135],a[164:167],v[144:147]
v_add_u32 v13, 0x20000, v17
M v[148:151],a[140:143],a[164:167],v[148:151]
M v[148:151],a[136:139],a[160:163],v[148:151]
v_add_u32 v14, 0x20000, v18
M v[152:155],a[144:147],a[160:163],v[152:155]
M v[152:155],a[148:151],a[164:167],v[152:155]
s_waitcnt lgkmcnt(4)
buffer_load_dwordx4 v22, s[56:59], s30 offen offset:2048 lds
M v[156:159],a[156:159],a[164:167],v[156:159]
s_nop 0
T a[80:81],v3,49152
T a[82:83],v3,50176
M v[156:159],a[152:155],a[160:163],v[156:159]
v_add_u32 v15, 0x20000, v19
M v[160:163],a[96:99],a[168:171],v[160:163]
R a[160:163],v5,20480
R a[164:167],v6,20480
M v[160:163],a[100:103],a[172:175],v[160:163]
M v[164:167],a[108:111],a[172:175],v[164:167]
buffer_load_dwordx4 v23, s[56:59], s30 offen offset:3072 lds
M v[164:167],a[104:107],a[168:171],v[164:167]
SA s29,s29,128
M v[168:171],a[112:115],a[168:171],v[168:171]
SA s30,s30,128
M v[168:171],a[116:119],a[172:175],v[168:171]
s_mov_b32 s25, 2097152
T a[84:85],v3,57344
T a[86:87],v3,58368
M v[172:175],a[124:127],a[172:175],v[172:175]
SA m0,s4,131072
M v[172:175],a[120:123],a[168:171],v[172:175]
buffer_load_dwordx4 v8, s[52:55], s25 offen lds
M v[176:179],a[128:131],a[168:171],v[176:179]
M v[176:179],a[132:135],a[172:175],v[176:179]
s_mov_b32 s25, 2359296
M v[180:183],a[140:143],a[172:175],v[180:183]
SA m0,s4,135168
M v[180:183],a[136:139],a[168:171],v[180:183]
buffer_load_dwordx4 v8, s[52:55], s25 offen lds
M v[184:187],a[144:147],a[168:171],v[184:187]
s_nop 0
T a[88:89],v4,49152
T a[90:91],v4,50176
M v[184:187],a[148:151],a[172:175],v[184:187]
s_waitcnt lgkmcnt(4)
M v[188:191],a[156:159],a[172:175],v[188:191]
s_mov_b32 s25, 2621440
M v[188:191],a[152:155],a[168:171],v[188:191]
L_w_kv07:
s_cbranch_execz L_wd1
SA m0,s4,139264
M v[192:195],a[96:99],a[160:163],v[192:195]
R a[168:171],v5,22528
R a[172:175],v6,22528
M v[192:195],a[100:103],a[164:167],v[192:195]
buffer_load_dwordx4 v8, s[52:55], s25 offen lds
M v[196:199],a[108:111],a[164:167],v[196:199]
M v[196:199],a[104:107],a[160:163],v[196:199]
s_mov_b32 s25, 2883584
T a[92:93],v4,57344
T a[94:95],v4,58368
M v[200:203],a[112:115],a[160:163],v[200:203]
SA m0,s4,143360
M v[200:203],a[116:119],a[164:167],v[200:203]
s_waitcnt vmcnt(19)
buffer_load_dwordx4 v8, s[52:55], s25 offen lds
M v[204:207],a[124:127],a[164:167],v[204:207]
R a[224:227],v20,16384
R a[228:231],v20,18432
M v[204:207],a[120:123],a[160:163],v[204:207]
R a[232:235],v21,16384
R a[236:239],v21,18432
M v[208:211],a[128:131],a[160:163],v[208:211]
v_subrev_u32 v20, 98304, v20
v_subrev_u32 v21, 98304, v21
M v[208:211],a[132:135],a[164:167],v[208:211]
M v[212:215],a[140:143],a[164:167],v[212:215]
M v[212:215],a[136:139],a[160:163],v[212:215]
M v[216:219],a[144:147],a[160:163],v[216:219]
M v[216:219],a[148:151],a[164:167],v[216:219]
s_waitcnt lgkmcnt(6)
M v[220:223],a[156:159],a[164:167],v[220:223]
s_waitcnt lgkmcnt(0)
M v[220:223],a[152:155],a[160:163],v[220:223]
s_barrier
M v[224:227],a[96:99],a[168:171],v[224:227]
R a[160:163],v5,32768
R a[164:167],v6,32768
M v[224:227],a[100:103],a[172:175],v[224:227]
M v[228:231],a[108:111],a[172:175],v[228:231]
M v[228:231],a[104:107],a[168:171],v[228:231]
M v[232:235],a[112:115],a[168:171],v[232:235]
M v[232:235],a[116:119],a[172:175],v[232:235]
M v[236:239],a[124:127],a[172:175],v[236:239]
M v[236:239],a[120:123],a[168:171],v[236:239]
M v[240:243],a[128:131],a[168:171],v[240:243]
M v[240:243],a[132:135],a[172:175],v[240:243]
M v[244:247],a[140:143],a[172:175],v[244:247]
M v[244:247],a[136:139],a[168:171],v[244:247]
M v[248:251],a[144:147],a[168:171],v[248:251]
M v[248:251],a[148:151],a[172:175],v[248:251]
s_waitcnt lgkmcnt(0)
M v[252:255],a[156:159],a[172:175],v[252:255]
M v[252:255],a[152:155],a[168:171],v[252:255]
M a[0:3],a[32:35],a[160:163],a[0:3]
R a[168:171],v5,34816
R a[172:175],v6,34816
M a[0:3],a[36:39],a[164:167],a[0:3]
SA m0,s23,81920
M a[4:7],a[44:47],a[164:167],a[4:7]
buffer_load_dwordx4 v22, s[56:59], s29 offen offset:0 lds
M a[4:7],a[40:43],a[160:163],a[4:7]
M a[8:11],a[48:51],a[160:163],a[8:11]
M a[8:11],a[52:55],a[164:167],a[8:11]
buffer_load_dwordx4 v23, s[56:59], s29 offen offset:1024 lds
M a[12:15],a[60:63],a[164:167],a[12:15]
M a[12:15],a[56:59],a[160:163],a[12:15]
G v24,a0
G v25,a1
M a[16:19],a[64:67],a[160:163],a[16:19]
G v26,a2
G v27,a3
M a[16:19],a[68:71],a[164:167],a[16:19]
buffer_load_dwordx4 v22, s[56:59], s30 offen offset:2048 lds
M a[20:23],a[76:79],a[164:167],a[20:23]
G v28,a4
G v29,a5
M a[20:23],a[72:75],a[160:163],a[20:23]
G v30,a6
G v31,a7
M a[24:27],a[80:83],a[160:163],a[24:27]
C v24,v24,v25
C v25,v26,v27
M a[24:27],a[84:87],a[164:167],a[24:27]
s_waitcnt lgkmcnt(0)
buffer_load_dwordx4 v23, s[56:59], s30 offen offset:3072 lds
M a[28:31],a[92:95],a[164:167],a[28:31]
SA s29,s29,128
C v26,v28,v29
C v27,v30,v31
M a[28:31],a[88:91],a[160:163],a[28:31]
SA s3,s93,0
buffer_store_dwordx4 v[24:27], v7, s[8:11], s3 offen offset:0 sc1
M v[32:35],a[32:35],a[168:171],v[32:35]
SA s30,s30,128
R a[160:163],v5,36864
R a[164:167],v6,36864
M v[32:35],a[36:39],a[172:175],v[32:35]
s_mov_b32 s25, 3145728
G v24,a8
G v25,a9
M v[36:39],a[44:47],a[172:175],v[36:39]
SA m0,s4,147456
G v26,a10
G v27,a11
M v[36:39],a[40:43],a[168:171],v[36:39]
buffer_load_dwordx4 v8, s[52:55], s25 offen lds
M v[40:43],a[48:51],a[168:171],v[40:43]
s_mov_b32 s25, 3407872
G v28,a12
G v29,a13
M v[40:43],a[52:55],a[172:175],v[40:43]
SA m0,s4,151552
G v30,a14
G v31,a15
M v[44:47],a[60:63],a[172:175],v[44:47]
buffer_load_dwordx4 v8, s[52:55], s25 offen lds
M v[44:47],a[56:59],a[168:171],v[44:47]
s_mov_b32 s25, 128
C v24,v24,v25
C v25,v26,v27
M v[48:51],a[64:67],a[168:171],v[48:51]
SA m0,s4,49152
C v26,v28,v29
C v27,v30,v31
M v[48:51],a[68:71],a[172:175],v[48:51]
buffer_store_dwordx4 v[24:27], v7, s[8:11], s3 offen offset:1024 sc1
M v[52:55],a[76:79],a[172:175],v[52:55]
s_nop 0
G v24,a16
G v25,a17
M v[52:55],a[72:75],a[168:171],v[52:55]
G v26,a18
G v27,a19
M v[56:59],a[80:83],a[168:171],v[56:59]
buffer_load_dwordx4 v8, s[52:55], s25 offen lds
M v[56:59],a[84:87],a[172:175],v[56:59]
s_waitcnt lgkmcnt(0)
G v28,a20
G v29,a21
M v[60:63],a[92:95],a[172:175],v[60:63]
s_mov_b32 s25, 262272
G v30,a22
G v31,a23
M v[60:63],a[88:91],a[168:171],v[60:63]
SA m0,s4,53248
C v24,v24,v25
C v25,v26,v27
M v[64:67],a[32:35],a[160:163],v[64:67]
s_waitcnt vmcnt(17)
R a[168:171],v5,38912
R a[172:175],v6,38912
M v[64:67],a[36:39],a[164:167],v[64:67]
buffer_load_dwordx4 v8, s[52:55], s25 offen lds
M v[68:71],a[44:47],a[164:167],v[68:71]
s_mov_b32 s25, 524416
C v26,v28,v29
C v27,v30,v31
M v[68:71],a[40:43],a[160:163],v[68:71]
SA m0,s4,57344
buffer_store_dwordx4 v[24:27], v7, s[8:11], s3 offen offset:2048 sc1
M v[72:75],a[48:51],a[160:163],v[72:75]
R a[96:99],v20,0
R a[100:103],v20,2048
M v[72:75],a[52:55],a[164:167],v[72:75]
R a[104:107],v21,0
R a[108:111],v21,2048
M v[76:79],a[60:63],a[164:167],v[76:79]
buffer_load_dwordx4 v8, s[52:55], s25 offen lds
M v[76:79],a[56:59],a[160:163],v[76:79]
s_mov_b32 s25, 786560
G v24,a24
G v25,a25
M v[80:83],a[64:67],a[160:163],v[80:83]
SA m0,s4,61440
G v26,a26
G v27,a27
M v[80:83],a[68:71],a[164:167],v[80:83]
buffer_load_dwordx4 v8, s[52:55], s25 offen lds
M v[84:87],a[76:79],a[164:167],v[84:87]
G v28,a28
G v29,a29
M v[84:87],a[72:75],a[160:163],v[84:87]
G v30,a30
G v31,a31
M v[88:91],a[80:83],a[160:163],v[88:91]
C v24,v24,v25
C v25,v26,v27
M v[88:91],a[84:87],a[164:167],v[88:91]
s_waitcnt lgkmcnt(4)
C v26,v28,v29
C v27,v30,v31
M v[92:95],a[92:95],a[164:167],v[92:95]
s_waitcnt lgkmcnt(0)
buffer_store_dwordx4 v[24:27], v7, s[8:11], s3 offen offset:3072 sc1
M v[92:95],a[88:91],a[160:163],v[92:95]
s_barrier
M v[96:99],a[32:35],a[168:171],v[96:99]
R a[160:163],v5,49152
R a[164:167],v6,49152
M v[96:99],a[36:39],a[172:175],v[96:99]
s_mov_b32 s25, 1048704
C v64,v64,v65
C v65,v66,v67
M v[100:103],a[44:47],a[172:175],v[100:103]
SA m0,s4,98304
C v66,v68,v69
C v67,v70,v71
M v[100:103],a[40:43],a[168:171],v[100:103]
s_waitcnt vmcnt(18)
buffer_load_dwordx4 v8, s[52:55], s25 offen lds
M v[104:107],a[48:51],a[168:171],v[104:107]
C v72,v72,v73
C v73,v74,v75
M v[104:107],a[52:55],a[172:175],v[104:107]
C v74,v76,v77
C v75,v78,v79
M v[108:111],a[60:63],a[172:175],v[108:111]
C v32,v32,v33
C v33,v34,v35
M v[108:111],a[56:59],a[168:171],v[108:111]
C v34,v36,v37
C v35,v38,v39
M v[112:115],a[64:67],a[168:171],v[112:115]
SA s3,s93,8192
buffer_store_dwordx4 v[32:35], v7, s[8:11], s3 offen offset:0 sc1
M v[112:115],a[68:71],a[172:175],v[112:115]
s_mov_b32 s25, 1310848
C v80,v80,v81
C v81,v82,v83
M v[116:119],a[76:79],a[172:175],v[116:119]
SA m0,s4,102400
C v82,v84,v85
C v83,v86,v87
M v[116:119],a[72:75],a[168:171],v[116:119]
R a[112:115],v20,32768
R a[116:119],v20,34816
M v[120:123],a[80:83],a[168:171],v[120:123]
buffer_load_dwordx4 v8, s[52:55], s25 offen lds
M v[120:123],a[84:87],a[172:175],v[120:123]
s_waitcnt lgkmcnt(2)
R a[120:123],v21,32768
R a[124:127],v21,34816
M v[124:127],a[92:95],a[172:175],v[124:127]
C v88,v88,v89
C v89,v90,v91
M v[124:127],a[88:91],a[168:171],v[124:127]
C v90,v92,v93
C v91,v94,v95
M v[128:131],a[32:35],a[160:163],v[128:131]
R a[168:171],v5,51200
R a[172:175],v6,51200
M v[128:131],a[36:39],a[164:167],v[128:131]
C v40,v40,v41
C v41,v42,v43
M v[132:135],a[44:47],a[164:167],v[132:135]
C v42,v44,v45
C v43,v46,v47
M v[132:135],a[40:43],a[160:163],v[132:135]
s_mov_b32 s25, 1572992
buffer_store_dwordx4 v[40:43], v7, s[8:11], s3 offen offset:1024 sc1
M v[136:139],a[48:51],a[160:163],v[136:139]
SA m0,s4,106496
C v96,v96,v97
C v97,v98,v99
M v[136:139],a[52:55],a[164:167],v[136:139]
C v98,v100,v101
C v99,v102,v103
M v[140:143],a[60:63],a[164:167],v[140:143]
C v104,v104,v105
C v105,v106,v107
M v[140:143],a[56:59],a[160:163],v[140:143]
buffer_load_dwordx4 v8, s[52:55], s25 offen lds
M v[144:147],a[64:67],a[160:163],v[144:147]
C v106,v108,v109
C v107,v110,v111
M v[144:147],a[68:71],a[164:167],v[144:147]
C v112,v112,v113
C v113,v114,v115
M v[148:151],a[76:79],a[164:167],v[148:151]
C v114,v116,v117
C v115,v118,v119
M v[148:151],a[72:75],a[160:163],v[148:151]
C v48,v48,v49
C v49,v50,v51
M v[152:155],a[80:83],a[160:163],v[152:155]
C v50,v52,v53
C v51,v54,v55
M v[152:155],a[84:87],a[164:167],v[152:155]
s_waitcnt lgkmcnt(0)
buffer_store_dwordx4 v[48:51], v7, s[8:11], s3 offen offset:2048 sc1
M v[156:159],a[92:95],a[164:167],v[156:159]
s_mov_b32 s25, 1835136
C v120,v120,v121
C v121,v122,v123
M v[156:159],a[88:91],a[160:163],v[156:159]
SA m0,s4,110592
C v122,v124,v125
C v123,v126,v127
M v[160:163],a[32:35],a[168:171],v[160:163]
R a[160:163],v5,53248
R a[164:167],v6,53248
M v[160:163],a[36:39],a[172:175],v[160:163]
buffer_load_dwordx4 v8, s[52:55], s25 offen lds
M v[164:167],a[44:47],a[172:175],v[164:167]
C v128,v128,v129
C v129,v130,v131
M v[164:167],a[40:43],a[168:171],v[164:167]
C v130,v132,v133
C v131,v134,v135
M v[168:171],a[48:51],a[168:171],v[168:171]
C v56,v56,v57
C v57,v58,v59
M v[168:171],a[52:55],a[172:175],v[168:171]
C v58,v60,v61
C v59,v62,v63
M v[172:175],a[60:63],a[172:175],v[172:175]
buffer_store_dwordx4 v[56:59], v7, s[8:11], s3 offen offset:3072 sc1
M v[172:175],a[56:59],a[168:171],v[172:175]
C v136,v136,v137
C v137,v138,v139
M v[176:179],a[64:67],a[168:171],v[176:179]
C v138,v140,v141
C v139,v142,v143
M v[176:179],a[68:71],a[172:175],v[176:179]
C v144,v144,v145
C v145,v146,v147
M v[180:183],a[76:79],a[172:175],v[180:183]
C v146,v148,v149
C v147,v150,v151
M v[180:183],a[72:75],a[168:171],v[180:183]
C v152,v152,v153
C v153,v154,v155
M v[184:187],a[80:83],a[168:171],v[184:187]
C v154,v156,v157
C v155,v158,v159
M v[184:187],a[84:87],a[172:175],v[184:187]
s_waitcnt lgkmcnt(0)
C v160,v160,v161
C v161,v162,v163
M v[188:191],a[92:95],a[172:175],v[188:191]
C v162,v164,v165
C v163,v166,v167
M v[188:191],a[88:91],a[168:171],v[188:191]
C v168,v168,v169
C v169,v170,v171
M v[192:195],a[32:35],a[160:163],v[192:195]
s_waitcnt vmcnt(18)
R a[168:171],v5,55296
R a[172:175],v6,55296
M v[192:195],a[36:39],a[164:167],v[192:195]
C v170,v172,v173
C v171,v174,v175
M v[196:199],a[44:47],a[164:167],v[196:199]
C v176,v176,v177
C v177,v178,v179
M v[196:199],a[40:43],a[160:163],v[196:199]
C v178,v180,v181
C v179,v182,v183
M v[200:203],a[48:51],a[160:163],v[200:203]
R a[128:131],v20,49152
R a[132:135],v20,51200
M v[200:203],a[52:55],a[164:167],v[200:203]
R a[136:139],v21,49152
R a[140:143],v21,51200
M v[204:207],a[60:63],a[164:167],v[204:207]
C v184,v184,v185
C v185,v186,v187
M v[204:207],a[56:59],a[160:163],v[204:207]
C v186,v188,v189
C v187,v190,v191
M v[208:211],a[64:67],a[160:163],v[208:211]
C v192,v192,v193
C v193,v194,v195
M v[208:211],a[68:71],a[164:167],v[208:211]
C v194,v196,v197
C v195,v198,v199
M v[212:215],a[76:79],a[164:167],v[212:215]
M v[212:215],a[72:75],a[160:163],v[212:215]
C v200,v200,v201
C v201,v202,v203
M v[216:219],a[80:83],a[160:163],v[216:219]
C v202,v204,v205
C v203,v206,v207
M v[216:219],a[84:87],a[164:167],v[216:219]
s_waitcnt lgkmcnt(4)
M v[220:223],a[92:95],a[164:167],v[220:223]
s_waitcnt vmcnt(15) lgkmcnt(0)
M v[220:223],a[88:91],a[160:163],v[220:223]
s_barrier
M v[224:227],a[32:35],a[168:171],v[224:227]
s_nop 0
T v[32:33],v16,0
T v[34:35],v16,2048
M v[224:227],a[36:39],a[172:175],v[224:227]
C v208,v208,v209
C v209,v210,v211
M v[228:231],a[44:47],a[172:175],v[228:231]
T v[36:37],v16,4096
T v[38:39],v16,6144
M v[228:231],a[40:43],a[168:171],v[228:231]
T v[40:41],v16,8192
T v[42:43],v16,10240
M v[232:235],a[48:51],a[168:171],v[232:235]
C v210,v212,v213
C v211,v214,v215
M v[232:235],a[52:55],a[172:175],v[232:235]
T v[44:45],v16,12288
T v[46:47],v16,14336
M v[236:239],a[60:63],a[172:175],v[236:239]
T v[48:49],v16,16384
T v[50:51],v16,18432
M v[236:239],a[56:59],a[168:171],v[236:239]
C v216,v216,v217
C v217,v218,v219
M v[240:243],a[64:67],a[168:171],v[240:243]
T v[52:53],v16,20480
T v[54:55],v16,22528
M v[240:243],a[68:71],a[172:175],v[240:243]
T v[56:57],v16,24576
T v[58:59],v16,26624
M v[244:247],a[76:79],a[172:175],v[244:247]
C v218,v220,v221
C v219,v222,v223
M v[244:247],a[72:75],a[168:171],v[244:247]
C v224,v224,v225
C v225,v226,v227
M v[248:251],a[80:83],a[168:171],v[248:251]
C v226,v228,v229
C v227,v230,v231
M v[248:251],a[84:87],a[172:175],v[248:251]
C v232,v232,v233
C v233,v234,v235
M v[252:255],a[92:95],a[172:175],v[252:255]
C v234,v236,v237
C v235,v238,v239
M v[252:255],a[88:91],a[168:171],v[252:255]
s_waitcnt lgkmcnt(6)
C v240,v240,v241
C v241,v242,v243
M v[68:71],v[32:35],a[176:179],0
s_mul_i32 s72, s41, 4352
T a[144:145],v17,0
T a[146:147],v17,2048
M v[68:71],v[36:39],a[184:187],v[68:71]
SA s46,s72,104923136
C v242,v244,v245
C v243,v246,v247
M v[68:71],v[40:43],a[192:195],v[68:71]
s_waitcnt lgkmcnt(2)
T a[148:149],v17,4096
T a[150:151],v17,6144
M v[68:71],v[44:47],a[200:203],v[68:71]
s_mov_b32 s25, 2097280
T a[152:153],v17,8192
T a[154:155],v17,10240
M v[68:71],v[48:51],a[208:211],v[68:71]
SA m0,s4,114688
C v248,v248,v249
C v249,v250,v251
M v[68:71],v[52:55],a[216:219],v[68:71]
s_lshl_b32 s45, s42, 7
T a[156:157],v17,12288
T a[158:159],v17,14336
M v[68:71],v[56:59],a[224:227],v[68:71]
SA s45,s45,s46
T a[160:161],v17,16384
T a[162:163],v17,18432
M v[76:79],v[56:59],a[228:231],0
s_lshl_b32 s72, s20, 2
buffer_load_dwordx4 v8, s[52:55], s25 offen lds
M v[76:79],v[52:55],a[220:223],v[76:79]
SA s72,s72,s45
T a[164:165],v17,20480
T a[166:167],v17,22528
M v[76:79],v[48:51],a[212:215],v[76:79]
T a[168:169],v17,24576
T a[170:171],v17,26624
M v[76:79],v[44:47],a[204:207],v[76:79]
s_mov_b32 s25, 2359424
C v250,v252,v253
C v251,v254,v255
M v[76:79],v[40:43],a[196:199],v[76:79]
SA m0,s4,118784
v_min_u32 v29, 1, v0
v_lshlrev_b32 v29, 29, v29
M v[76:79],v[36:39],a[188:191],v[76:79]
buffer_load_dwordx4 v8, s[52:55], s25 offen lds
M v[76:79],v[32:35],a[180:183],v[76:79]
s_waitcnt lgkmcnt(6)
v_mov_b32 v30, 1
M v[84:87],a[144:147],a[176:179],0
s_nop 0
T v[32:33],v18,0
T v[34:35],v18,2048
M v[84:87],a[148:151],a[184:187],v[84:87]
s_mov_b32 s25, 2621568
M v[84:87],a[152:155],a[192:195],v[84:87]
s_waitcnt lgkmcnt(2)
s_nop 0
T v[36:37],v18,4096
T v[38:39],v18,6144
M v[84:87],a[156:159],a[200:203],v[84:87]
SA m0,s4,122880
T v[40:41],v18,8192
T v[42:43],v18,10240
M v[84:87],a[160:163],a[208:211],v[84:87]
buffer_load_dwordx4 v8, s[52:55], s25 offen lds
M v[84:87],a[164:167],a[216:219],v[84:87]
s_nop 0
T v[44:45],v18,12288
T v[46:47],v18,14336
M v[84:87],a[168:171],a[224:227],v[84:87]
s_waitcnt vmcnt(3)
T v[48:49],v18,16384
T v[50:51],v18,18432
M v[92:95],a[168:171],a[228:231],0
s_mov_b32 s25, 2883712
buffer_store_dword v30, v29, s[8:11], s72 offen offset:4 sc1
M v[92:95],a[164:167],a[220:223],v[92:95]
SA m0,s4,126976
T v[52:53],v18,20480
T v[54:55],v18,22528
M v[92:95],a[160:163],a[212:215],v[92:95]
T v[56:57],v18,24576
T v[58:59],v18,26624
M v[92:95],a[156:159],a[204:207],v[92:95]
buffer_load_dwordx4 v8, s[52:55], s25 offen lds
M v[92:95],a[152:155],a[196:199],v[92:95]
v_add_u32 v20, 0x10000, v16
L_w_kv08:
s_cbranch_execz L_wd1
v_add_u32 v21, 0x10000, v17
M v[92:95],a[148:151],a[188:191],v[92:95]
M v[92:95],a[144:147],a[180:183],v[92:95]
s_waitcnt lgkmcnt(6)
v_add_u32 v22, 0x10000, v18
M v[100:103],v[32:35],a[176:179],0
s_mov_b32 s25, 3145856
T a[144:145],v19,0
T a[146:147],v19,2048
M v[100:103],v[36:39],a[184:187],v[100:103]
SA m0,s4,32768
M v[100:103],v[40:43],a[192:195],v[100:103]
s_waitcnt lgkmcnt(2)
s_nop 0
T a[148:149],v19,4096
T a[150:151],v19,6144
M v[100:103],v[44:47],a[200:203],v[100:103]
T a[152:153],v19,8192
T a[154:155],v19,10240
M v[100:103],v[48:51],a[208:211],v[100:103]
buffer_load_dwordx4 v8, s[52:55], s25 offen lds
M v[100:103],v[52:55],a[216:219],v[100:103]
s_nop 0
T a[156:157],v19,12288
T a[158:159],v19,14336
M v[100:103],v[56:59],a[224:227],v[100:103]
T a[160:161],v19,16384
T a[162:163],v19,18432
M v[108:111],v[56:59],a[228:231],0
s_mov_b32 s25, 3408000
v_add_u32 v23, 0x10000, v19
v_or_b32 v1, s20, v0
M v[108:111],v[52:55],a[220:223],v[108:111]
SA m0,s4,36864
T a[164:165],v19,20480
T a[166:167],v19,22528
M v[108:111],v[48:51],a[212:215],v[108:111]
SA s3,s93,524288
T a[168:169],v19,24576
T a[170:171],v19,26624
M v[108:111],v[44:47],a[204:207],v[108:111]
buffer_load_dwordx4 v8, s[52:55], s25 offen lds
M v[108:111],v[40:43],a[196:199],v[108:111]
v_min_u32 v1, 1, v1
M v[108:111],v[36:39],a[188:191],v[108:111]
M v[108:111],v[32:35],a[180:183],v[108:111]
s_waitcnt lgkmcnt(6)
buffer_store_dwordx4 v[64:67], v7, s[8:11], s3 offen offset:0 sc1
M v[116:119],a[144:147],a[176:179],0
s_mov_b32 s25, 256
T v[32:33],v16,28672
T v[34:35],v16,30720
M v[116:119],a[148:151],a[184:187],v[116:119]
SA m0,s4,65536
v_lshlrev_b32 v1, 29, v1
M v[116:119],a[152:155],a[192:195],v[116:119]
s_waitcnt lgkmcnt(2)
s_nop 0
T v[36:37],v12,0
T v[38:39],v12,2048
M v[116:119],a[156:159],a[200:203],v[116:119]
T v[40:41],v12,4096
T v[42:43],v12,6144
M v[116:119],a[160:163],a[208:211],v[116:119]
buffer_load_dwordx4 v8, s[52:55], s25 offen lds
M v[116:119],a[164:167],a[216:219],v[116:119]
s_nop 0
T v[44:45],v12,8192
T v[46:47],v12,10240
M v[116:119],a[168:171],a[224:227],v[116:119]
T v[48:49],v12,12288
T v[50:51],v12,14336
M v[124:127],a[168:171],a[228:231],0
s_mov_b32 s25, 262400
buffer_store_dwordx4 v[72:75], v7, s[8:11], s3 offen offset:1024 sc1
M v[124:127],a[164:167],a[220:223],v[124:127]
SA m0,s4,69632
T v[52:53],v12,16384
T v[54:55],v12,18432
M v[124:127],a[160:163],a[212:215],v[124:127]
T v[56:57],v12,20480
T v[58:59],v12,22528
M v[124:127],a[156:159],a[204:207],v[124:127]
buffer_load_dwordx4 v8, s[52:55], s25 offen lds
M v[124:127],a[152:155],a[196:199],v[124:127]
v_min_u32 v9, 15, v0
v_lshlrev_b32 v9, 7, v9
M v[124:127],a[148:151],a[188:191],v[124:127]
s_sub_u32 s66, 15, s42
buffer_store_dwordx4 v[80:83], v7, s[8:11], s3 offen offset:2048 sc1
M v[124:127],a[144:147],a[180:183],v[124:127]
s_waitcnt lgkmcnt(6)
M v[68:71],v[32:35],a[232:235],v[68:71]
s_mov_b32 s25, 524544
T a[144:145],v17,28672
T a[146:147],v17,30720
M v[68:71],v[36:39],a[96:99],v[68:71]
SA m0,s4,73728
buffer_store_dwordx4 v[88:91], v7, s[8:11], s3 offen offset:3072 sc1
M v[68:71],v[40:43],a[104:107],v[68:71]
s_waitcnt lgkmcnt(2)
s_nop 0
T a[148:149],v13,0
T a[150:151],v13,2048
M v[68:71],v[44:47],a[112:115],v[68:71]
s_max_u32 s67, s66, s42
T a[152:153],v13,4096
T a[154:155],v13,6144
M v[68:71],v[48:51],a[120:123],v[68:71]
s_min_u32 s66, s66, s42
buffer_load_dwordx4 v8, s[52:55], s25 offen lds
M v[68:71],v[52:55],a[128:131],v[68:71]
s_mul_i32 s21, s41, 1048576
T a[156:157],v13,8192
T a[158:159],v13,10240
M v[68:71],v[56:59],a[136:139],v[68:71]
s_lshl_b32 s64, s67, 16
T a[160:161],v13,12288
T a[162:163],v13,14336
M v[76:79],v[56:59],a[140:143],v[76:79]
s_mov_b32 s25, 786688
M v[76:79],v[52:55],a[132:135],v[76:79]
SA m0,s4,77824
T a[164:165],v13,16384
T a[166:167],v13,18432
M v[76:79],v[48:51],a[124:127],v[76:79]
SA s32,s21,s64
T a[168:169],v13,20480
T a[170:171],v13,22528
M v[76:79],v[44:47],a[116:119],v[76:79]
s_lshl_b32 s64, s20, 14
buffer_load_dwordx4 v8, s[52:55], s25 offen lds
M v[76:79],v[40:43],a[108:111],v[76:79]
SA s32,s32,s64
M v[76:79],v[36:39],a[100:103],v[76:79]
SA s32,s32,33554432
M v[76:79],v[32:35],a[236:239],v[76:79]
s_waitcnt lgkmcnt(6)
M v[84:87],a[144:147],a[232:235],v[84:87]
s_mov_b32 s25, 1048832
T v[32:33],v18,28672
T v[34:35],v18,30720
M v[84:87],a[148:151],a[96:99],v[84:87]
SA m0,s4,81920
M v[84:87],a[152:155],a[104:107],v[84:87]
s_waitcnt lgkmcnt(2)
s_nop 0
T v[36:37],v14,0
T v[38:39],v14,2048
M v[84:87],a[156:159],a[112:115],v[84:87]
s_sub_u32 s64, s42, 10
T v[40:41],v14,4096
T v[42:43],v14,6144
M v[84:87],a[160:163],a[120:123],v[84:87]
s_and_b32 s35, s64, 536870912
buffer_load_dwordx4 v8, s[52:55], s25 offen lds
M v[84:87],a[164:167],a[128:131],v[84:87]
s_nop 0
T v[44:45],v14,8192
T v[46:47],v14,10240
M v[84:87],a[168:171],a[136:139],v[84:87]
T v[48:49],v14,12288
T v[50:51],v14,14336
M v[92:95],a[168:171],a[140:143],v[92:95]
s_mov_b32 s25, 1310976
v_or_b32 v6, s35, v7
M v[92:95],a[164:167],a[132:135],v[92:95]
SA m0,s4,86016
T v[52:53],v14,16384
T v[54:55],v14,18432
M v[92:95],a[160:163],a[124:127],v[92:95]
s_lshl_b32 s28, s20, 13
T v[56:57],v14,20480
T v[58:59],v14,22528
M v[92:95],a[156:159],a[116:119],v[92:95]
buffer_load_dwordx4 v8, s[52:55], s25 offen lds
M v[92:95],a[152:155],a[108:111],v[92:95]
v_add_u32 v2, 0x10000, v7
v_add_u32 v3, s28, v7
M v[92:95],a[148:151],a[100:103],v[92:95]
v_add_u32 v4, 0x1000, v3
MF v68,s5,v68
M v[92:95],a[144:147],a[236:239],v[92:95]
s_waitcnt lgkmcnt(6)
MF v69,s5,v69
MF v70,s5,v70
M v[100:103],v[32:35],a[232:235],v[100:103]
s_mov_b32 s25, 1573120
T a[144:145],v19,28672
T a[146:147],v19,30720
M v[100:103],v[36:39],a[96:99],v[100:103]
SA m0,s4,90112
MF v71,s5,v71
MF v84,s5,v84
M v[100:103],v[40:43],a[104:107],v[100:103]
s_waitcnt lgkmcnt(2)
T a[148:149],v15,0
T a[150:151],v15,2048
M v[100:103],v[44:47],a[112:115],v[100:103]
s_lshl_b32 s64, s42, 16
T a[152:153],v15,4096
T a[154:155],v15,6144
M v[100:103],v[48:51],a[120:123],v[100:103]
SA s23,s21,s64
buffer_load_dwordx4 v8, s[52:55], s25 offen lds
M v[100:103],v[52:55],a[128:131],v[100:103]
SA s43,s23,16777216
T a[156:157],v15,8192
T a[158:159],v15,10240
M v[100:103],v[56:59],a[136:139],v[100:103]
SA s26,s21,16777216
T a[160:161],v15,12288
T a[162:163],v15,14336
M v[108:111],v[56:59],a[140:143],v[108:111]
s_mov_b32 s25, 1835264
MF v85,s5,v85
MF v86,s5,v86
M v[108:111],v[52:55],a[132:135],v[108:111]
SA m0,s4,94208
T a[164:165],v15,16384
T a[166:167],v15,18432
M v[108:111],v[48:51],a[124:127],v[108:111]
s_mov_b32 s22, 0x7fff
T a[168:169],v15,20480
T a[170:171],v15,22528
M v[108:111],v[44:47],a[116:119],v[108:111]
s_sub_u32 s27, s42, 1
buffer_load_dwordx4 v8, s[52:55], s25 offen lds
M v[108:111],v[40:43],a[108:111],v[108:111]
s_cmp_eq_u32 s42, 0
MF v87,s5,v87
C v68,v68,v69
M v[108:111],v[36:39],a[100:103],v[108:111]
s_waitcnt vmcnt(12) lgkmcnt(0)
C v69,v70,v71
C v70,v84,v85
M v[108:111],v[32:35],a[236:239],v[108:111]
s_barrier
M v[116:119],a[144:147],a[232:235],v[116:119]
s_mov_b32 s25, 2097408
T v[32:33],v16,49152
T v[34:35],v16,51200
M v[116:119],a[148:151],a[96:99],v[116:119]
s_cselect_b32 s64, 32768, 0
C v71,v86,v87
W a0,v68
M v[116:119],a[152:155],a[104:107],v[116:119]
SA m0,s4,155648
T v[36:37],v16,53248
T v[38:39],v16,55296
M v[116:119],a[156:159],a[112:115],v[116:119]
SA s26,s26,s64
T v[40:41],v16,57344
T v[42:43],v16,59392
M v[116:119],a[160:163],a[120:123],v[116:119]
s_mov_b32 s31, 0x4b800000
buffer_load_dwordx4 v8, s[52:55], s25 offen lds
M v[116:119],a[164:167],a[128:131],v[116:119]
s_mov_b32 s24, 0x33800000
T v[44:45],v16,61440
T v[46:47],v16,63488
M v[116:119],a[168:171],a[136:139],v[116:119]
s_lshl_b32 s47, s66, 7
T v[48:49],v20,32768
T v[50:51],v20,34816
M v[124:127],a[168:171],a[140:143],v[124:127]
s_mov_b32 s25, 2359552
W a1,v69
W a2,v70
M v[124:127],a[164:167],a[132:135],v[124:127]
SA m0,s4,159744
T v[52:53],v20,36864
T v[54:55],v20,38912
M v[124:127],a[160:163],a[124:127],v[124:127]
SA s47,s47,s46
T v[56:57],v20,40960
T v[58:59],v20,43008
M v[124:127],a[156:159],a[116:119],v[124:127]
s_lshl_b32 s64, s20, 5
buffer_load_dwordx4 v8, s[52:55], s25 offen lds
M v[124:127],a[152:155],a[108:111],v[124:127]
SA s47,s47,s64
W a3,v71
MF v76,s5,v76
M v[124:127],a[148:151],a[100:103],v[124:127]
SA s47,s47,2048
MF v77,s5,v77
MF v78,s5,v78
M v[124:127],a[144:147],a[236:239],v[124:127]
s_waitcnt lgkmcnt(6)
MF v79,s5,v79
MF v92,s5,v92
M v[132:135],v[32:35],a[176:179],0
s_lshl_b32 s65, s41, 3
T a[144:145],v17,49152
T a[146:147],v17,51200
M v[132:135],v[36:39],a[184:187],v[132:135]
SA s65,s65,s66
MF v93,s5,v93
MF v94,s5,v94
M v[132:135],v[40:43],a[192:195],v[132:135]
s_waitcnt lgkmcnt(2)
T a[148:149],v17,53248
T a[150:151],v17,55296
M v[132:135],v[44:47],a[200:203],v[132:135]
s_mul_i32 s34, s65, 73728
T a[152:153],v17,57344
T a[154:155],v17,59392
M v[132:135],v[48:51],a[208:211],v[132:135]
SA s34,s34,136314880
MF v95,s5,v95
C v76,v76,v77
M v[132:135],v[52:55],a[216:219],v[132:135]
s_lshl_b32 s65, s42, 4
T a[156:157],v17,61440
T a[158:159],v17,63488
M v[132:135],v[56:59],a[224:227],v[132:135]
SA s65,s65,s41
T a[160:161],v21,32768
T a[162:163],v21,34816
M v[140:143],v[56:59],a[228:231],0
s_mul_i32 s33, s65, 114688
C v77,v78,v79
C v78,v92,v93
M v[140:143],v[52:55],a[220:223],v[140:143]
s_mul_i32 s65, s20, 28672
T a[164:165],v21,36864
T a[166:167],v21,38912
M v[140:143],v[48:51],a[212:215],v[140:143]
SA s33,s33,s65
T a[168:169],v21,40960
T a[170:171],v21,43008
M v[140:143],v[44:47],a[204:207],v[140:143]
SA s33,s33,67108864
C v79,v94,v95
W a32,v76
M v[140:143],v[40:43],a[196:199],v[140:143]
s_mov_b32 s6, 0
W a33,v77
W a34,v78
M v[140:143],v[36:39],a[188:191],v[140:143]
s_mov_b32 s7, 0
W a35,v79
MF v100,s5,v100
M v[140:143],v[32:35],a[180:183],v[140:143]
s_waitcnt lgkmcnt(6)
MF v101,s5,v101
MF v102,s5,v102
M v[148:151],a[144:147],a[176:179],0
s_mov_b32 s40, 1
T v[32:33],v18,49152
T v[34:35],v18,51200
M v[148:151],a[148:151],a[184:187],v[148:151]
s_cmp_eq_u32 s20, 0
MF v103,s5,v103
MF v116,s5,v116
M v[148:151],a[152:155],a[192:195],v[148:151]
s_waitcnt lgkmcnt(2)
T v[36:37],v18,53248
T v[38:39],v18,55296
M v[148:151],a[156:159],a[200:203],v[148:151]
s_cselect_b32 s39, 7, 4
T v[40:41],v18,57344
T v[42:43],v18,59392
M v[148:151],a[160:163],a[208:211],v[148:151]
s_lshl_b32 s64, s41, 1
MF v117,s5,v117
MF v118,s5,v118
M v[148:151],a[164:167],a[216:219],v[148:151]
SA s64,s64,s20
T v[44:45],v18,61440
T v[46:47],v18,63488
M v[148:151],a[168:171],a[224:227],v[148:151]
s_cmp_lt_u32 s64, 30
T v[48:49],v22,32768
T v[50:51],v22,34816
M v[156:159],a[168:171],a[228:231],0
s_cselect_b32 s64, 32798, 0
MF v119,s5,v119
C v100,v100,v101
M v[156:159],a[164:167],a[220:223],v[156:159]
s_cmp_ge_u32 s20, 2
T v[52:53],v22,36864
T v[54:55],v22,38912
M v[156:159],a[160:163],a[212:215],v[156:159]
s_cselect_b32 s64, s64, 0
T v[56:57],v22,40960
T v[58:59],v22,43008
M v[156:159],a[156:159],a[204:207],v[156:159]
s_cmp_eq_u32 s42, 6
C v101,v102,v103
C v102,v116,v117
M v[156:159],a[152:155],a[196:199],v[156:159]
s_cselect_b32 s64, s64, 0
C v103,v118,v119
W a4,v100
M v[156:159],a[148:151],a[188:191],v[156:159]
s_or_b32 s39, s39, s64
W a5,v101
W a6,v102
M v[156:159],a[144:147],a[180:183],v[156:159]
s_waitcnt lgkmcnt(6)
W a7,v103
MF v108,s5,v108
M v[164:167],v[32:35],a[176:179],0
s_mov_b64 s[60:61], s[76:77]
T a[144:145],v19,49152
T a[146:147],v19,51200
M v[164:167],v[36:39],a[184:187],v[164:167]
s_mov_b32 s62, s78
MF v109,s5,v109
MF v110,s5,v110
M v[164:167],v[40:43],a[192:195],v[164:167]
s_waitcnt lgkmcnt(2)
T a[148:149],v19,53248
T a[150:151],v19,55296
M v[164:167],v[44:47],a[200:203],v[164:167]
s_mov_b32 s63, 0x20000
T a[152:153],v19,57344
T a[154:155],v19,59392
M v[164:167],v[48:51],a[208:211],v[164:167]
s_mov_b32 s25, 2621696
v_lshrrev_b32 v24, 4, v0
v_lshlrev_b32 v24, 2, v24
M v[164:167],v[52:55],a[216:219],v[164:167]
SA m0,s4,131072
T a[156:157],v19,61440
T a[158:159],v19,63488
M v[164:167],v[56:59],a[224:227],v[164:167]
SA s3,s93,532480
T a[160:161],v23,32768
T a[162:163],v23,34816
M v[172:175],v[56:59],a[228:231],0
buffer_load_dwordx4 v8, s[52:55], s25 offen lds
M v[172:175],v[52:55],a[220:223],v[172:175]
s_nop 0
T a[164:165],v23,36864
T a[166:167],v23,38912
M v[172:175],v[48:51],a[212:215],v[172:175]
T a[168:169],v23,40960
T a[170:171],v23,43008
M v[172:175],v[44:47],a[204:207],v[172:175]
s_mov_b32 s25, 2883840
buffer_store_dwordx4 v[96:99], v7, s[8:11], s3 offen offset:0 sc1
M v[172:175],v[40:43],a[196:199],v[172:175]
SA m0,s4,135168
v_and_b32 v25, 15, v0
v_sub_u32 v24, v24, v25
M v[172:175],v[36:39],a[188:191],v[172:175]
buffer_load_dwordx4 v8, s[52:55], s25 offen lds
M v[172:175],v[32:35],a[180:183],v[172:175]
s_waitcnt lgkmcnt(6)
v_cmp_lt_i32 s[16:17], 0, v24
v_cmp_lt_i32 s[18:19], -1, v24
M v[180:183],a[144:147],a[176:179],0
T v[32:33],v20,45056
T v[34:35],v20,47104
M v[180:183],a[148:151],a[184:187],v[180:183]
s_mov_b32 s25, 3145984
buffer_store_dwordx4 v[104:107], v7, s[8:11], s3 offen offset:1024 sc1
M v[180:183],a[152:155],a[192:195],v[180:183]
s_waitcnt lgkmcnt(2)
s_nop 0
T v[36:37],v20,49152
T v[38:39],v20,51200
M v[180:183],a[156:159],a[200:203],v[180:183]
SA m0,s4,139264
T v[40:41],v20,53248
T v[42:43],v20,55296
M v[180:183],a[160:163],a[208:211],v[180:183]
buffer_load_dwordx4 v8, s[52:55], s25 offen lds
M v[180:183],a[164:167],a[216:219],v[180:183]
s_nop 0
T v[44:45],v20,57344
T v[46:47],v20,59392
M v[180:183],a[168:171],a[224:227],v[180:183]
T v[48:49],v20,61440
T v[50:51],v20,63488
M v[188:191],a[168:171],a[228:231],0
s_mov_b32 s25, 3408128
buffer_store_dwordx4 v[112:115], v7, s[8:11], s3 offen offset:2048 sc1
M v[188:191],a[164:167],a[220:223],v[188:191]
SA m0,s4,143360
T v[52:53],v16,32768
T v[54:55],v16,34816
M v[188:191],a[160:163],a[212:215],v[188:191]
T v[56:57],v16,36864
T v[58:59],v16,38912
M v[188:191],a[156:159],a[204:207],v[188:191]
buffer_load_dwordx4 v8, s[52:55], s25 offen lds
M v[188:191],a[152:155],a[196:199],v[188:191]
v_cmp_lt_i32 s[48:49], -2, v24
v_cmp_lt_i32 s[50:51], -3, v24
M v[188:191],a[148:151],a[188:191],v[188:191]
buffer_store_dwordx4 v[120:123], v7, s[8:11], s3 offen offset:3072 sc1
M v[188:191],a[144:147],a[180:183],v[188:191]
s_waitcnt lgkmcnt(6)
v_lshl_add_u32 v25, v0, 7, s95
v_and_b32 v0, 48, v0
M v[132:135],v[32:35],a[232:235],v[132:135]
s_mov_b32 s25, 384
T a[144:145],v21,45056
T a[146:147],v21,47104
M v[132:135],v[36:39],a[96:99],v[132:135]
SA m0,s4,0
v_lshl_add_u32 v0, v0, 24, v25
v_mov_b32 v24, 0x3f80
M v[132:135],v[40:43],a[104:107],v[132:135]
s_waitcnt lgkmcnt(2)
T a[148:149],v21,49152
T a[150:151],v21,51200
M v[132:135],v[44:47],a[112:115],v[132:135]
T a[152:153],v21,53248
T a[154:155],v21,55296
M v[132:135],v[48:51],a[120:123],v[132:135]
buffer_load_dwordx4 v8, s[52:55], s25 offen lds
M v[132:135],v[52:55],a[128:131],v[132:135]
s_nop 0
T a[156:157],v21,57344
T a[158:159],v21,59392
M v[132:135],v[56:59],a[136:139],v[132:135]
T a[160:161],v21,61440
T a[162:163],v21,63488
M v[140:143],v[56:59],a[140:143],v[140:143]
s_mov_b32 s25, 262528
MF v111,s5,v111
MF v124,s5,v124
M v[140:143],v[52:55],a[132:135],v[140:143]
SA m0,s4,4096
T a[164:165],v17,32768
T a[166:167],v17,34816
M v[140:143],v[48:51],a[124:127],v[140:143]
T a[168:169],v17,36864
T a[170:171],v17,38912
M v[140:143],v[44:47],a[116:119],v[140:143]
buffer_load_dwordx4 v8, s[52:55], s25 offen lds
M v[140:143],v[40:43],a[108:111],v[140:143]
MF v125,s5,v125
MF v126,s5,v126
M v[140:143],v[36:39],a[100:103],v[140:143]
MF v127,s5,v127
C v108,v108,v109
M v[140:143],v[32:35],a[236:239],v[140:143]
s_waitcnt lgkmcnt(6)
C v109,v110,v111
C v110,v124,v125
M v[148:151],a[144:147],a[232:235],v[148:151]
s_mov_b32 s25, 524672
T v[32:33],v22,45056
T v[34:35],v22,47104
M v[148:151],a[148:151],a[96:99],v[148:151]
SA m0,s4,8192
C v111,v126,v127
W a36,v108
M v[148:151],a[152:155],a[104:107],v[148:151]
s_waitcnt lgkmcnt(2)
T v[36:37],v22,49152
T v[38:39],v22,51200
M v[148:151],a[156:159],a[112:115],v[148:151]
T v[40:41],v22,53248
T v[42:43],v22,55296
M v[148:151],a[160:163],a[120:123],v[148:151]
buffer_load_dwordx4 v8, s[52:55], s25 offen lds
M v[148:151],a[164:167],a[128:131],v[148:151]
s_nop 0
T v[44:45],v22,57344
T v[46:47],v22,59392
M v[148:151],a[168:171],a[136:139],v[148:151]
T v[48:49],v22,61440
T v[50:51],v22,63488
M v[156:159],a[168:171],a[140:143],v[156:159]
s_mov_b32 s25, 786816
W a37,v109
W a38,v110
M v[156:159],a[164:167],a[132:135],v[156:159]
SA m0,s4,12288
T v[52:53],v18,32768
T v[54:55],v18,34816
M v[156:159],a[160:163],a[124:127],v[156:159]
T v[56:57],v18,36864
T v[58:59],v18,38912
M v[156:159],a[156:159],a[116:119],v[156:159]
buffer_load_dwordx4 v8, s[52:55], s25 offen lds
M v[156:159],a[152:155],a[108:111],v[156:159]
W a39,v111
v_lshrrev_b32 v25, 8, v7
M v[156:159],a[148:151],a[100:103],v[156:159]
v_bfe_u32 v26, v7, 6, 2
v_and_b32 v27, 16, v7
v_lshlrev_b32 v27, v27, v24
v_cmp_eq_u32 vcc, v25, v26
v_and_b32 v28, 32, v7
W a244,0
v_cndmask_b32 v27, 0, v27, vcc
v_cmp_eq_u32 vcc, 0, v28
W a245,0
W a248,0
v_cndmask_b32 v25, 0, v27, vcc
v_sub_u32 v26, v27, v25
W a249,0
W a246,v25
W a247,v26
M v[156:159],a[144:147],a[236:239],v[156:159]
s_waitcnt lgkmcnt(6)
MF v132,s5,v132
MF v133,s5,v133
M v[164:167],v[32:35],a[232:235],v[164:167]
s_mov_b32 s25, 1048960
T a[144:145],v23,45056
T a[146:147],v23,47104
M v[164:167],v[36:39],a[96:99],v[164:167]
SA m0,s4,16384
MF v134,s5,v134
MF v135,s5,v135
M v[164:167],v[40:43],a[104:107],v[164:167]
s_waitcnt lgkmcnt(2)
T a[148:149],v23,49152
T a[150:151],v23,51200
M v[164:167],v[44:47],a[112:115],v[164:167]
T a[152:153],v23,53248
T a[154:155],v23,55296
M v[164:167],v[48:51],a[120:123],v[164:167]
buffer_load_dwordx4 v8, s[52:55], s25 offen lds
M v[164:167],v[52:55],a[128:131],v[164:167]
s_nop 0
T a[156:157],v23,57344
T a[158:159],v23,59392
M v[164:167],v[56:59],a[136:139],v[164:167]
T a[160:161],v23,61440
T a[162:163],v23,63488
M v[172:175],v[56:59],a[140:143],v[172:175]
s_mov_b32 s25, 1311104
MF v148,s5,v148
MF v149,s5,v149
M v[172:175],v[52:55],a[132:135],v[172:175]
SA m0,s4,20480
T a[164:165],v19,32768
T a[166:167],v19,34816
M v[172:175],v[48:51],a[124:127],v[172:175]
T a[168:169],v19,36864
T a[170:171],v19,38912
M v[172:175],v[44:47],a[116:119],v[172:175]
buffer_load_dwordx4 v8, s[52:55], s25 offen lds
M v[172:175],v[40:43],a[108:111],v[172:175]
MF v150,s5,v150
MF v151,s5,v151
M v[172:175],v[36:39],a[100:103],v[172:175]
s_waitcnt vmcnt(7) lgkmcnt(0)
C v132,v132,v133
C v133,v134,v135
M v[172:175],v[32:35],a[236:239],v[172:175]
s_barrier
M v[180:183],a[144:147],a[232:235],v[180:183]
s_mov_b32 s25, 1573248
T v[32:33],v20,0
T v[34:35],v20,2048
M v[180:183],a[148:151],a[96:99],v[180:183]
SA m0,s4,24576
C v134,v148,v149
C v135,v150,v151
M v[180:183],a[152:155],a[104:107],v[180:183]
T v[36:37],v20,4096
T v[38:39],v20,6144
M v[180:183],a[156:159],a[112:115],v[180:183]
T v[40:41],v20,8192
T v[42:43],v20,10240
M v[180:183],a[160:163],a[120:123],v[180:183]
buffer_load_dwordx4 v8, s[52:55], s25 offen lds
M v[180:183],a[164:167],a[128:131],v[180:183]
s_nop 0
T v[44:45],v20,12288
T v[46:47],v20,14336
M v[180:183],a[168:171],a[136:139],v[180:183]
T v[48:49],v20,16384
T v[50:51],v20,18432
M v[188:191],a[168:171],a[140:143],v[188:191]
s_mov_b32 s25, 1835392
W a8,v132
W a9,v133
M v[188:191],a[164:167],a[132:135],v[188:191]
SA m0,s4,28672
T v[52:53],v20,20480
T v[54:55],v20,22528
M v[188:191],a[160:163],a[124:127],v[188:191]
T v[56:57],v20,24576
T v[58:59],v20,26624
M v[188:191],a[156:159],a[116:119],v[188:191]
buffer_load_dwordx4 v8, s[52:55], s25 offen lds
M v[188:191],a[152:155],a[108:111],v[188:191]
W a10,v134
W a11,v135
M v[188:191],a[148:151],a[100:103],v[188:191]
v_lshrrev_b32 v31, 6, v7
v_bfe_u32 v28, v7, 4, 2
M v[188:191],a[144:147],a[236:239],v[188:191]
s_waitcnt lgkmcnt(6)
v_lshlrev_b32 v31, 5, v31
v_add_lshl_u32 v31, v31, v28, 2
M v[68:71],v[32:35],a[176:179],0
s_mov_b32 s25, 2097536
T a[144:145],v21,0
T a[146:147],v21,2048
M v[68:71],v[36:39],a[184:187],v[68:71]
SA m0,s4,40960
buffer_load_dword v5, v31, s[8:11], s46 offen offset:4 sc1
M v[68:71],v[40:43],a[192:195],v[68:71]
s_waitcnt lgkmcnt(2)
s_nop 0
T a[148:149],v21,4096
T a[150:151],v21,6144
M v[68:71],v[44:47],a[200:203],v[68:71]
T a[152:153],v21,8192
T a[154:155],v21,10240
M v[68:71],v[48:51],a[208:211],v[68:71]
buffer_load_dwordx4 v8, s[52:55], s25 offen lds
M v[68:71],v[52:55],a[216:219],v[68:71]
s_nop 0
T a[156:157],v21,12288
T a[158:159],v21,14336
M v[68:71],v[56:59],a[224:227],v[68:71]
T a[160:161],v21,16384
T a[162:163],v21,18432
M v[76:79],v[56:59],a[228:231],0
s_mov_b32 s25, 2359680
MF v140,s5,v140
MF v141,s5,v141
M v[76:79],v[52:55],a[220:223],v[76:79]
SA m0,s4,45056
T a[164:165],v21,20480
T a[166:167],v21,22528
M v[76:79],v[48:51],a[212:215],v[76:79]
T a[168:169],v21,24576
T a[170:171],v21,26624
M v[76:79],v[44:47],a[204:207],v[76:79]
buffer_load_dwordx4 v8, s[52:55], s25 offen lds
M v[76:79],v[40:43],a[196:199],v[76:79]
MF v142,s5,v142
MF v143,s5,v143
M v[76:79],v[36:39],a[188:191],v[76:79]
MF v156,s5,v156
MF v157,s5,v157
M v[76:79],v[32:35],a[180:183],v[76:79]
s_waitcnt lgkmcnt(6)
MF v158,s5,v158
MF v159,s5,v159
M v[84:87],a[144:147],a[176:179],0
s_mov_b32 s25, 2621824
T v[32:33],v22,0
T v[34:35],v22,2048
M v[84:87],a[148:151],a[184:187],v[84:87]
SA m0,s4,49152
C v140,v140,v141
C v141,v142,v143
M v[84:87],a[152:155],a[192:195],v[84:87]
s_waitcnt lgkmcnt(2)
T v[36:37],v22,4096
T v[38:39],v22,6144
M v[84:87],a[156:159],a[200:203],v[84:87]
SA s3,s93,262144
T v[40:41],v22,8192
T v[42:43],v22,10240
M v[84:87],a[160:163],a[208:211],v[84:87]
buffer_load_dwordx4 v8, s[52:55], s25 offen lds
M v[84:87],a[164:167],a[216:219],v[84:87]
s_nop 0
T v[44:45],v22,12288
T v[46:47],v22,14336
M v[84:87],a[168:171],a[224:227],v[84:87]
T v[48:49],v22,16384
T v[50:51],v22,18432
M v[92:95],a[168:171],a[228:231],0
s_mov_b32 s25, 2883968
buffer_store_dwordx4 v[128:131], v7, s[8:11], s3 offen offset:0 sc1
M v[92:95],a[164:167],a[220:223],v[92:95]
SA m0,s4,53248
T v[52:53],v22,20480
T v[54:55],v22,22528
M v[92:95],a[160:163],a[212:215],v[92:95]
T v[56:57],v22,24576
T v[58:59],v22,26624
M v[92:95],a[156:159],a[204:207],v[92:95]
buffer_load_dwordx4 v8, s[52:55], s25 offen lds
M v[92:95],a[152:155],a[196:199],v[92:95]
C v142,v156,v157
C v143,v158,v159
M v[92:95],a[148:151],a[188:191],v[92:95]
buffer_store_dwordx4 v[136:139], v7, s[8:11], s3 offen offset:1024 sc1
M v[92:95],a[144:147],a[180:183],v[92:95]
s_waitcnt lgkmcnt(6)
W a40,v140
W a41,v141
M v[100:103],v[32:35],a[176:179],0
s_mov_b32 s25, 3146112
T a[144:145],v23,0
T a[146:147],v23,2048
M v[100:103],v[36:39],a[184:187],v[100:103]
SA m0,s4,57344
buffer_store_dwordx4 v[144:147], v7, s[8:11], s3 offen offset:2048 sc1
M v[100:103],v[40:43],a[192:195],v[100:103]
s_waitcnt lgkmcnt(2)
s_nop 0
T a[148:149],v23,4096
T a[150:151],v23,6144
M v[100:103],v[44:47],a[200:203],v[100:103]
T a[152:153],v23,8192
T a[154:155],v23,10240
M v[100:103],v[48:51],a[208:211],v[100:103]
buffer_load_dwordx4 v8, s[52:55], s25 offen lds
M v[100:103],v[52:55],a[216:219],v[100:103]
s_nop 0
T a[156:157],v23,12288
T a[158:159],v23,14336
M v[100:103],v[56:59],a[224:227],v[100:103]
T a[160:161],v23,16384
T a[162:163],v23,18432
M v[108:111],v[56:59],a[228:231],0
s_mov_b32 s25, 3408256
buffer_store_dwordx4 v[152:155], v7, s[8:11], s3 offen offset:3072 sc1
M v[108:111],v[52:55],a[220:223],v[108:111]
SA m0,s4,61440
T a[164:165],v23,20480
T a[166:167],v23,22528
M v[108:111],v[48:51],a[212:215],v[108:111]
T a[168:169],v23,24576
T a[170:171],v23,26624
M v[108:111],v[44:47],a[204:207],v[108:111]
buffer_load_dwordx4 v8, s[52:55], s25 offen lds
M v[108:111],v[40:43],a[196:199],v[108:111]
W a42,v142
W a43,v143
M v[108:111],v[36:39],a[188:191],v[108:111]
v_mov_b32 v8, 0xff800000
MF v164,s5,v164
M v[108:111],v[32:35],a[180:183],v[108:111]
s_waitcnt lgkmcnt(6)
MF v165,s5,v165
MF v166,s5,v166
M v[116:119],a[144:147],a[176:179],0
T v[32:33],v20,28672
T v[34:35],v20,30720
M v[116:119],a[148:151],a[184:187],v[116:119]
MF v167,s5,v167
MF v180,s5,v180
M v[116:119],a[152:155],a[192:195],v[116:119]
s_waitcnt lgkmcnt(2)
T v[36:37],v12,24576
T v[38:39],v12,26624
M v[116:119],a[156:159],a[200:203],v[116:119]
T v[40:41],v12,28672
T v[42:43],v12,30720
M v[116:119],a[160:163],a[208:211],v[116:119]
MF v181,s5,v181
MF v182,s5,v182
M v[116:119],a[164:167],a[216:219],v[116:119]
T v[44:45],v12,0
T v[46:47],v12,2048
M v[116:119],a[168:171],a[224:227],v[116:119]
T v[48:49],v12,4096
T v[50:51],v12,6144
M v[124:127],a[168:171],a[228:231],0
MF v183,s5,v183
C v164,v164,v165
M v[124:127],a[164:167],a[220:223],v[124:127]
T v[52:53],v12,8192
T v[54:55],v12,10240
M v[124:127],a[160:163],a[212:215],v[124:127]
T v[56:57],v12,12288
T v[58:59],v12,14336
M v[124:127],a[156:159],a[204:207],v[124:127]
C v165,v166,v167
C v166,v180,v181
M v[124:127],a[152:155],a[196:199],v[124:127]
C v167,v182,v183
W a12,v164
M v[124:127],a[148:151],a[188:191],v[124:127]
W a13,v165
W a14,v166
M v[124:127],a[144:147],a[180:183],v[124:127]
s_waitcnt lgkmcnt(6)
W a15,v167
MF v172,s5,v172
M v[68:71],v[32:35],a[232:235],v[68:71]
T a[144:145],v21,28672
T a[146:147],v21,30720
M v[68:71],v[36:39],a[96:99],v[68:71]
MF v173,s5,v173
MF v174,s5,v174
M v[68:71],v[40:43],a[104:107],v[68:71]
s_waitcnt lgkmcnt(2)
T a[148:149],v13,24576
T a[150:151],v13,26624
M v[68:71],v[44:47],a[112:115],v[68:71]
T a[152:153],v13,28672
T a[154:155],v13,30720
M v[68:71],v[48:51],a[120:123],v[68:71]
MF v175,s5,v175
MF v188,s5,v188
M v[68:71],v[52:55],a[128:131],v[68:71]
T a[156:157],v13,0
T a[158:159],v13,2048
M v[68:71],v[56:59],a[136:139],v[68:71]
T a[160:161],v13,4096
T a[162:163],v13,6144
M v[76:79],v[56:59],a[140:143],v[76:79]
MF v189,s5,v189
MF v190,s5,v190
M v[76:79],v[52:55],a[132:135],v[76:79]
T a[164:165],v13,8192
T a[166:167],v13,10240
M v[76:79],v[48:51],a[124:127],v[76:79]
T a[168:169],v13,12288
T a[170:171],v13,14336
M v[76:79],v[44:47],a[116:119],v[76:79]
MF v191,s5,v191
C v172,v172,v173
M v[76:79],v[40:43],a[108:111],v[76:79]
C v173,v174,v175
C v174,v188,v189
M v[76:79],v[36:39],a[100:103],v[76:79]
C v175,v190,v191
W a44,v172
M v[76:79],v[32:35],a[236:239],v[76:79]
s_waitcnt lgkmcnt(6)
W a45,v173
W a46,v174
M v[84:87],a[144:147],a[232:235],v[84:87]
T v[32:33],v22,28672
T v[34:35],v22,30720
M v[84:87],a[148:151],a[96:99],v[84:87]
W a47,v175
s_waitcnt vmcnt(10)
v_cmp_ne_u32 vcc, 1, v5
M v[84:87],a[152:155],a[104:107],v[84:87]
s_waitcnt lgkmcnt(2)
T v[36:37],v14,24576
T v[38:39],v14,26624
M v[84:87],a[156:159],a[112:115],v[84:87]
s_nop 0
T v[40:41],v14,28672
T v[42:43],v14,30720
M v[84:87],a[160:163],a[120:123],v[84:87]
s_cmp_lg_u32 vcc_lo, 0
M v[84:87],a[164:167],a[128:131],v[84:87]
s_cbranch_scc1 L_wsq0
L_wrq0:
T v[44:45],v14,0
T v[46:47],v14,2048
M v[84:87],a[168:171],a[136:139],v[84:87]
SA m0,s28,98304
T v[48:49],v14,4096
T v[50:51],v14,6144
M v[92:95],a[168:171],a[140:143],v[92:95]
buffer_load_dwordx4 v3, s[8:11], s21 offen offset:0 sc1 lds
M v[92:95],a[164:167],a[132:135],v[92:95]
s_nop 0
T v[52:53],v14,8192
T v[54:55],v14,10240
M v[92:95],a[160:163],a[124:127],v[92:95]
T v[56:57],v14,12288
T v[58:59],v14,14336
M v[92:95],a[156:159],a[116:119],v[92:95]
buffer_load_dwordx4 v3, s[8:11], s21 offen offset:1024 sc1 lds
M v[92:95],a[152:155],a[108:111],v[92:95]
MF v68,s5,v68
MF v69,s5,v69
M v[92:95],a[148:151],a[100:103],v[92:95]
buffer_load_dwordx4 v3, s[8:11], s21 offen offset:2048 sc1 lds
M v[92:95],a[144:147],a[236:239],v[92:95]
s_waitcnt lgkmcnt(6)
MF v70,s5,v70
MF v71,s5,v71
M v[100:103],v[32:35],a[232:235],v[100:103]
T a[144:145],v23,28672
T a[146:147],v23,30720
M v[100:103],v[36:39],a[96:99],v[100:103]
buffer_load_dwordx4 v3, s[8:11], s21 offen offset:3072 sc1 lds
M v[100:103],v[40:43],a[104:107],v[100:103]
s_waitcnt lgkmcnt(2)
s_nop 0
T a[148:149],v15,24576
T a[150:151],v15,26624
M v[100:103],v[44:47],a[112:115],v[100:103]
SA m0,s28,102400
T a[152:153],v15,28672
T a[154:155],v15,30720
M v[100:103],v[48:51],a[120:123],v[100:103]
buffer_load_dwordx4 v4, s[8:11], s21 offen offset:0 sc1 lds
M v[100:103],v[52:55],a[128:131],v[100:103]
s_nop 0
T a[156:157],v15,0
T a[158:159],v15,2048
M v[100:103],v[56:59],a[136:139],v[100:103]
T a[160:161],v15,4096
T a[162:163],v15,6144
M v[108:111],v[56:59],a[140:143],v[108:111]
buffer_load_dwordx4 v4, s[8:11], s21 offen offset:1024 sc1 lds
M v[108:111],v[52:55],a[132:135],v[108:111]
s_nop 0
T a[164:165],v15,8192
T a[166:167],v15,10240
M v[108:111],v[48:51],a[124:127],v[108:111]
T a[168:169],v15,12288
T a[170:171],v15,14336
M v[108:111],v[44:47],a[116:119],v[108:111]
buffer_load_dwordx4 v4, s[8:11], s21 offen offset:2048 sc1 lds
M v[108:111],v[40:43],a[108:111],v[108:111]
MF v84,s5,v84
MF v85,s5,v85
M v[108:111],v[36:39],a[100:103],v[108:111]
s_waitcnt vmcnt(7) lgkmcnt(0)
buffer_load_dwordx4 v4, s[8:11], s21 offen offset:3072 sc1 lds
M v[108:111],v[32:35],a[236:239],v[108:111]
s_barrier
M v[116:119],a[144:147],a[232:235],v[116:119]
SA s21,s21,32768
T v[32:33],v16,0
T v[34:35],v16,2048
M v[116:119],a[148:151],a[96:99],v[116:119]
s_sub_u32 s22, s22, 1
MF v86,s5,v86
MF v87,s5,v87
M v[116:119],a[152:155],a[104:107],v[116:119]
s_cselect_b32 s21, s23, s21
T v[36:37],v16,4096
T v[38:39],v16,6144
M v[116:119],a[156:159],a[112:115],v[116:119]
SA m0,s28,65536
T v[40:41],v16,8192
T v[42:43],v16,10240
M v[116:119],a[160:163],a[120:123],v[116:119]
buffer_load_dwordx4 v3, s[8:11], s21 offen offset:0 sc1 lds
M v[116:119],a[164:167],a[128:131],v[116:119]
s_nop 0
T v[44:45],v16,12288
T v[46:47],v16,14336
M v[116:119],a[168:171],a[136:139],v[116:119]
T v[48:49],v16,16384
T v[50:51],v16,18432
M v[124:127],a[168:171],a[140:143],v[124:127]
buffer_load_dwordx4 v3, s[8:11], s21 offen offset:1024 sc1 lds
M v[124:127],a[164:167],a[132:135],v[124:127]
s_nop 0
T v[52:53],v16,20480
T v[54:55],v16,22528
M v[124:127],a[160:163],a[124:127],v[124:127]
T v[56:57],v16,24576
T v[58:59],v16,26624
M v[124:127],a[156:159],a[116:119],v[124:127]
buffer_load_dword v5, v31, s[8:11], s46 offen offset:4 sc1
M v[124:127],a[152:155],a[108:111],v[124:127]
buffer_load_dwordx4 v3, s[8:11], s21 offen offset:2048 sc1 lds
M v[124:127],a[148:151],a[100:103],v[124:127]
C v68,v68,v69
C v69,v70,v71
M v[124:127],a[144:147],a[236:239],v[124:127]
s_waitcnt lgkmcnt(6)
buffer_load_dwordx4 v3, s[8:11], s21 offen offset:3072 sc1 lds
M v[132:135],v[32:35],a[176:179],0
SA m0,s28,69632
T a[144:145],v17,0
T a[146:147],v17,2048
M v[132:135],v[36:39],a[184:187],v[132:135]
buffer_load_dwordx4 v4, s[8:11], s21 offen offset:0 sc1 lds
M v[132:135],v[40:43],a[192:195],v[132:135]
s_waitcnt lgkmcnt(2)
s_nop 0
T a[148:149],v17,4096
T a[150:151],v17,6144
M v[132:135],v[44:47],a[200:203],v[132:135]
T a[152:153],v17,8192
T a[154:155],v17,10240
M v[132:135],v[48:51],a[208:211],v[132:135]
buffer_load_dwordx4 v4, s[8:11], s21 offen offset:1024 sc1 lds
M v[132:135],v[52:55],a[216:219],v[132:135]
s_nop 0
T a[156:157],v17,12288
T a[158:159],v17,14336
M v[132:135],v[56:59],a[224:227],v[132:135]
T a[160:161],v17,16384
T a[162:163],v17,18432
M v[140:143],v[56:59],a[228:231],0
buffer_load_dwordx4 v4, s[8:11], s21 offen offset:2048 sc1 lds
M v[140:143],v[52:55],a[220:223],v[140:143]
s_nop 0
T a[164:165],v17,20480
T a[166:167],v17,22528
M v[140:143],v[48:51],a[212:215],v[140:143]
T a[168:169],v17,24576
T a[170:171],v17,26624
M v[140:143],v[44:47],a[204:207],v[140:143]
buffer_load_dwordx4 v4, s[8:11], s21 offen offset:3072 sc1 lds
M v[140:143],v[40:43],a[196:199],v[140:143]
SA s21,s21,32768
C v70,v84,v85
C v71,v86,v87
M v[140:143],v[36:39],a[188:191],v[140:143]
s_sub_u32 s22, s22, 1
W a16,v68
W a17,v69
M v[140:143],v[32:35],a[180:183],v[140:143]
s_waitcnt lgkmcnt(6)
W a18,v70
W a19,v71
M v[148:151],a[144:147],a[176:179],0
s_cselect_b32 s21, s23, s21
T v[32:33],v18,0
T v[34:35],v18,2048
M v[148:151],a[148:151],a[184:187],v[148:151]
MF v76,s5,v76
MF v77,s5,v77
M v[148:151],a[152:155],a[192:195],v[148:151]
s_waitcnt lgkmcnt(2)
T v[36:37],v18,4096
T v[38:39],v18,6144
M v[148:151],a[156:159],a[200:203],v[148:151]
T v[40:41],v18,8192
T v[42:43],v18,10240
M v[148:151],a[160:163],a[208:211],v[148:151]
MF v78,s5,v78
MF v79,s5,v79
M v[148:151],a[164:167],a[216:219],v[148:151]
T v[44:45],v18,12288
T v[46:47],v18,14336
M v[148:151],a[168:171],a[224:227],v[148:151]
T v[48:49],v18,16384
T v[50:51],v18,18432
M v[156:159],a[168:171],a[228:231],0
MF v92,s5,v92
MF v93,s5,v93
M v[156:159],a[164:167],a[220:223],v[156:159]
T v[52:53],v18,20480
T v[54:55],v18,22528
M v[156:159],a[160:163],a[212:215],v[156:159]
T v[56:57],v18,24576
T v[58:59],v18,26624
M v[156:159],a[156:159],a[204:207],v[156:159]
MF v94,s5,v94
MF v95,s5,v95
M v[156:159],a[152:155],a[196:199],v[156:159]
C v76,v76,v77
C v77,v78,v79
M v[156:159],a[148:151],a[188:191],v[156:159]
C v78,v92,v93
C v79,v94,v95
M v[156:159],a[144:147],a[180:183],v[156:159]
s_waitcnt lgkmcnt(6)
W a48,v76
W a49,v77
M v[164:167],v[32:35],a[176:179],0
T a[144:145],v19,0
T a[146:147],v19,2048
M v[164:167],v[36:39],a[184:187],v[164:167]
W a50,v78
W a51,v79
M v[164:167],v[40:43],a[192:195],v[164:167]
s_waitcnt lgkmcnt(2)
T a[148:149],v19,4096
T a[150:151],v19,6144
M v[164:167],v[44:47],a[200:203],v[164:167]
T a[152:153],v19,8192
T a[154:155],v19,10240
M v[164:167],v[48:51],a[208:211],v[164:167]
v_mov_b32 v30, 2
MF v100,s5,v100
M v[164:167],v[52:55],a[216:219],v[164:167]
T a[156:157],v19,12288
T a[158:159],v19,14336
M v[164:167],v[56:59],a[224:227],v[164:167]
T a[160:161],v19,16384
T a[162:163],v19,18432
M v[172:175],v[56:59],a[228:231],0
buffer_store_dword v30, v1, s[8:11], s45 offen sc1
M v[172:175],v[52:55],a[220:223],v[172:175]
s_nop 0
T a[164:165],v19,20480
T a[166:167],v19,22528
M v[172:175],v[48:51],a[212:215],v[172:175]
T a[168:169],v19,24576
T a[170:171],v19,26624
M v[172:175],v[44:47],a[204:207],v[172:175]
MF v101,s5,v101
MF v102,s5,v102
M v[172:175],v[40:43],a[196:199],v[172:175]
MF v103,s5,v103
MF v116,s5,v116
M v[172:175],v[36:39],a[188:191],v[172:175]
MF v117,s5,v117
MF v118,s5,v118
M v[172:175],v[32:35],a[180:183],v[172:175]
s_waitcnt lgkmcnt(6)
MF v119,s5,v119
C v100,v100,v101
M v[180:183],a[144:147],a[176:179],0
T v[32:33],v16,28672
T v[34:35],v16,30720
M v[180:183],a[148:151],a[184:187],v[180:183]
C v101,v102,v103
C v102,v116,v117
M v[180:183],a[152:155],a[192:195],v[180:183]
s_waitcnt lgkmcnt(2)
T v[36:37],v16,40960
T v[38:39],v16,43008
M v[180:183],a[156:159],a[200:203],v[180:183]
SA s3,s93,270336
T v[40:41],v16,45056
T v[42:43],v16,47104
M v[180:183],a[160:163],a[208:211],v[180:183]
buffer_store_dwordx4 v[160:163], v7, s[8:11], s3 offen offset:0 sc1
M v[180:183],a[164:167],a[216:219],v[180:183]
s_nop 0
T v[44:45],v16,49152
T v[46:47],v16,51200
M v[180:183],a[168:171],a[224:227],v[180:183]
T v[48:49],v16,53248
T v[50:51],v16,55296
M v[188:191],a[168:171],a[228:231],0
buffer_store_dwordx4 v[168:171], v7, s[8:11], s3 offen offset:1024 sc1
M v[188:191],a[164:167],a[220:223],v[188:191]
s_nop 0
T v[52:53],v16,57344
T v[54:55],v16,59392
M v[188:191],a[160:163],a[212:215],v[188:191]
T v[56:57],v16,61440
T v[58:59],v16,63488
M v[188:191],a[156:159],a[204:207],v[188:191]
buffer_store_dwordx4 v[176:179], v7, s[8:11], s3 offen offset:2048 sc1
M v[188:191],a[152:155],a[196:199],v[188:191]
C v103,v118,v119
W a20,v100
M v[188:191],a[148:151],a[188:191],v[188:191]
buffer_store_dwordx4 v[184:187], v7, s[8:11], s3 offen offset:3072 sc1
M v[188:191],a[144:147],a[180:183],v[188:191]
s_waitcnt lgkmcnt(6)
W a21,v101
W a22,v102
M v[132:135],v[32:35],a[232:235],v[132:135]
T a[144:145],v17,28672
T a[146:147],v17,30720
M v[132:135],v[36:39],a[96:99],v[132:135]
W a23,v103
MF v108,s5,v108
M v[132:135],v[40:43],a[104:107],v[132:135]
s_waitcnt lgkmcnt(2)
T a[148:149],v17,40960
T a[150:151],v17,43008
M v[132:135],v[44:47],a[112:115],v[132:135]
T a[152:153],v17,45056
T a[154:155],v17,47104
M v[132:135],v[48:51],a[120:123],v[132:135]
MF v109,s5,v109
MF v110,s5,v110
M v[132:135],v[52:55],a[128:131],v[132:135]
T a[156:157],v17,49152
T a[158:159],v17,51200
M v[132:135],v[56:59],a[136:139],v[132:135]
T a[160:161],v17,53248
T a[162:163],v17,55296
M v[140:143],v[56:59],a[140:143],v[140:143]
MF v111,s5,v111
MF v124,s5,v124
M v[140:143],v[52:55],a[132:135],v[140:143]
T a[164:165],v17,57344
T a[166:167],v17,59392
M v[140:143],v[48:51],a[124:127],v[140:143]
T a[168:169],v17,61440
T a[170:171],v17,63488
M v[140:143],v[44:47],a[116:119],v[140:143]
MF v125,s5,v125
MF v126,s5,v126
M v[140:143],v[40:43],a[108:111],v[140:143]
MF v127,s5,v127
C v108,v108,v109
M v[140:143],v[36:39],a[100:103],v[140:143]
C v109,v110,v111
C v110,v124,v125
M v[140:143],v[32:35],a[236:239],v[140:143]
s_waitcnt lgkmcnt(6)
C v111,v126,v127
W a52,v108
M v[148:151],a[144:147],a[232:235],v[148:151]
T v[32:33],v18,28672
T v[34:35],v18,30720
M v[148:151],a[148:151],a[96:99],v[148:151]
W a53,v109
W a54,v110
M v[148:151],a[152:155],a[104:107],v[148:151]
s_waitcnt lgkmcnt(2)
T v[36:37],v18,40960
T v[38:39],v18,43008
M v[148:151],a[156:159],a[112:115],v[148:151]
T v[40:41],v18,45056
T v[42:43],v18,47104
M v[148:151],a[160:163],a[120:123],v[148:151]
W a55,v111
s_waitcnt vmcnt(11)
v_cmp_ne_u32 vcc, 1, v5
M v[148:151],a[164:167],a[128:131],v[148:151]
s_nop 0
T v[44:45],v18,49152
T v[46:47],v18,51200
M v[148:151],a[168:171],a[136:139],v[148:151]
s_cmp_lg_u32 vcc_hi, 0
T v[48:49],v18,53248
T v[50:51],v18,55296
M v[156:159],a[168:171],a[140:143],v[156:159]
s_cbranch_scc1 L_wsr0
L_wrr0:
M v[156:159],a[164:167],a[132:135],v[156:159]
SA m0,s28,131072
T v[52:53],v18,57344
T v[54:55],v18,59392
M v[156:159],a[160:163],a[124:127],v[156:159]
T v[56:57],v18,61440
T v[58:59],v18,63488
M v[156:159],a[156:159],a[116:119],v[156:159]
buffer_load_dwordx4 v3, s[8:11], s26 offen offset:0 sc1 lds
M v[156:159],a[152:155],a[108:111],v[156:159]
MF v132,s5,v132
MF v133,s5,v133
M v[156:159],a[148:151],a[100:103],v[156:159]
buffer_load_dwordx4 v3, s[8:11], s26 offen offset:1024 sc1 lds
M v[156:159],a[144:147],a[236:239],v[156:159]
s_waitcnt lgkmcnt(6)
MF v134,s5,v134
MF v135,s5,v135
M v[164:167],v[32:35],a[232:235],v[164:167]
T a[144:145],v19,28672
T a[146:147],v19,30720
M v[164:167],v[36:39],a[96:99],v[164:167]
buffer_load_dwordx4 v3, s[8:11], s26 offen offset:2048 sc1 lds
M v[164:167],v[40:43],a[104:107],v[164:167]
s_waitcnt lgkmcnt(2)
s_nop 0
T a[148:149],v19,40960
T a[150:151],v19,43008
M v[164:167],v[44:47],a[112:115],v[164:167]
T a[152:153],v19,45056
T a[154:155],v19,47104
M v[164:167],v[48:51],a[120:123],v[164:167]
buffer_load_dwordx4 v3, s[8:11], s26 offen offset:3072 sc1 lds
M v[164:167],v[52:55],a[128:131],v[164:167]
SA m0,s28,135168
T a[156:157],v19,49152
T a[158:159],v19,51200
M v[164:167],v[56:59],a[136:139],v[164:167]
T a[160:161],v19,53248
T a[162:163],v19,55296
M v[172:175],v[56:59],a[140:143],v[172:175]
buffer_load_dwordx4 v4, s[8:11], s26 offen offset:0 sc1 lds
M v[172:175],v[52:55],a[132:135],v[172:175]
s_nop 0
T a[164:165],v19,57344
T a[166:167],v19,59392
M v[172:175],v[48:51],a[124:127],v[172:175]
T a[168:169],v19,61440
T a[170:171],v19,63488
M v[172:175],v[44:47],a[116:119],v[172:175]
buffer_load_dwordx4 v4, s[8:11], s26 offen offset:1024 sc1 lds
M v[172:175],v[40:43],a[108:111],v[172:175]
MF v148,s5,v148
MF v149,s5,v149
M v[172:175],v[36:39],a[100:103],v[172:175]
s_waitcnt lgkmcnt(0)
buffer_load_dwordx4 v4, s[8:11], s26 offen offset:2048 sc1 lds
M v[172:175],v[32:35],a[236:239],v[172:175]
s_barrier
M v[180:183],a[144:147],a[232:235],v[180:183]
R a[64:67],v2,32768
R a[68:71],v2,33792
M v[180:183],a[148:151],a[96:99],v[180:183]
buffer_load_dwordx4 v4, s[8:11], s26 offen offset:3072 sc1 lds
M v[180:183],a[152:155],a[104:107],v[180:183]
SA s26,s26,32768
MF v150,s5,v150
MF v151,s5,v151
M v[180:183],a[156:159],a[112:115],v[180:183]
R a[72:75],v2,34816
R a[76:79],v2,35840
M v[180:183],a[160:163],a[120:123],v[180:183]
C v132,v132,v133
C v133,v134,v135
M v[180:183],a[164:167],a[128:131],v[180:183]
C v134,v148,v149
C v135,v150,v151
M v[180:183],a[168:171],a[136:139],v[180:183]
R a[80:83],v2,36864
R a[84:87],v2,37888
M v[188:191],a[168:171],a[140:143],v[188:191]
W a24,v132
W a25,v133
M v[188:191],a[164:167],a[132:135],v[188:191]
W a26,v134
W a27,v135
M v[188:191],a[160:163],a[124:127],v[188:191]
R a[88:91],v2,38912
R a[92:95],v2,39936
M v[188:191],a[156:159],a[116:119],v[188:191]
MF v140,s5,v140
MF v141,s5,v141
M v[188:191],a[152:155],a[108:111],v[188:191]
MF v142,s5,v142
MF v143,s5,v143
M v[188:191],a[148:151],a[100:103],v[188:191]
MF v156,s5,v156
MF v157,s5,v157
M v[188:191],a[144:147],a[236:239],v[188:191]
s_waitcnt lgkmcnt(0)
MF v158,s5,v158
MF v159,s5,v159
C v140,v140,v141
C v141,v142,v143
C v142,v156,v157
C v143,v158,v159
W a56,v140
W a57,v141
W a58,v142
W a59,v143
s_cmp_eq_u32 s42, 0
s_cbranch_scc1 L_j0
M v[64:67],a[64:67],a[0:3],0
R a[96:99],v2,40960
R a[100:103],v2,41984
M v[64:67],a[68:71],a[4:7],v[64:67]
MF v164,s5,v164
MF v165,s5,v165
M v[64:67],a[72:75],a[8:11],v[64:67]
MF v166,s5,v166
MF v167,s5,v167
M v[64:67],a[76:79],a[12:15],v[64:67]
R a[104:107],v2,43008
R a[108:111],v2,44032
M v[64:67],a[80:83],a[16:19],v[64:67]
MF v180,s5,v180
MF v181,s5,v181
MF v182,s5,v182
MF v183,s5,v183
C v164,v164,v165
C v165,v166,v167
C v166,v180,v181
C v167,v182,v183
W a28,v164
W a29,v165
W a30,v166
W a31,v167
M v[64:67],a[84:87],a[20:23],v[64:67]
MF v172,s5,v172
MF v173,s5,v173
M v[64:67],a[88:91],a[24:27],v[64:67]
R a[112:115],v2,45056
R a[116:119],v2,46080
M v[64:67],a[92:95],a[28:31],v[64:67]
MF v174,s5,v174
MF v175,s5,v175
M v[68:71],a[64:67],a[32:35],0
MF v188,s5,v188
MF v189,s5,v189
M v[68:71],a[68:71],a[36:39],v[68:71]
R a[120:123],v2,47104
R a[124:127],v2,48128
M v[68:71],a[72:75],a[40:43],v[68:71]
SA m0,s28,32768
MF v190,s5,v190
MF v191,s5,v191
M v[68:71],a[76:79],a[44:47],v[68:71]
buffer_load_dwordx4 v3, s[8:11], s26 offen offset:0 sc1 lds
M v[68:71],a[80:83],a[48:51],v[68:71]
C v172,v172,v173
C v173,v174,v175
C v174,v188,v189
C v175,v190,v191
W a60,v172
W a61,v173
W a62,v174
W a63,v175
M v[68:71],a[84:87],a[52:55],v[68:71]
E v18,v64
M v[68:71],a[88:91],a[56:59],v[68:71]
M v[68:71],a[92:95],a[60:63],v[68:71]
s_waitcnt lgkmcnt(0)
buffer_load_dwordx4 v3, s[8:11], s26 offen offset:1024 sc1 lds
M v[72:75],a[96:99],a[0:3],0
R a[64:67],v2,49152
R a[68:71],v2,50176
M v[72:75],a[100:103],a[4:7],v[72:75]
E v19,v65
M v[72:75],a[104:107],a[8:11],v[72:75]
E v20,v66
M v[72:75],a[108:111],a[12:15],v[72:75]
R a[72:75],v2,51200
R a[76:79],v2,52224
M v[72:75],a[112:115],a[16:19],v[72:75]
buffer_load_dwordx4 v3, s[8:11], s26 offen offset:2048 sc1 lds
M v[72:75],a[116:119],a[20:23],v[72:75]
E v21,v67
M v[72:75],a[120:123],a[24:27],v[72:75]
R a[80:83],v2,53248
R a[84:87],v2,54272
M v[72:75],a[124:127],a[28:31],v[72:75]
buffer_load_dwordx4 v3, s[8:11], s26 offen offset:3072 sc1 lds
M v[76:79],a[124:127],a[60:63],0
SA m0,s28,36864
E v22,v68
M v[76:79],a[120:123],a[56:59],v[76:79]
R a[88:91],v2,55296
R a[92:95],v2,56320
M v[76:79],a[116:119],a[52:55],v[76:79]
buffer_load_dwordx4 v4, s[8:11], s26 offen offset:0 sc1 lds
M v[76:79],a[112:115],a[48:51],v[76:79]
E v23,v69
M v[76:79],a[108:111],a[44:47],v[76:79]
AF v26,v18,v19
C v40,v18,v19
M v[76:79],a[104:107],a[40:43],v[76:79]
buffer_load_dwordx4 v4, s[8:11], s26 offen offset:1024 sc1 lds
M v[76:79],a[100:103],a[36:39],v[76:79]
v_add_u32 v16, 0x20000, v7
AF v26,v20,v26
M v[76:79],a[96:99],a[32:35],v[76:79]
s_waitcnt lgkmcnt(0)
E v24,v70
M v[80:83],a[64:67],a[0:3],0
R a[96:99],v2,57344
R a[100:103],v2,58368
M v[80:83],a[68:71],a[4:7],v[80:83]
buffer_load_dwordx4 v4, s[8:11], s26 offen offset:2048 sc1 lds
M v[80:83],a[72:75],a[8:11],v[80:83]
SA s3,s93,786432
E v25,v71
M v[80:83],a[76:79],a[12:15],v[80:83]
R a[104:107],v2,59392
R a[108:111],v2,60416
M v[80:83],a[80:83],a[16:19],v[80:83]
buffer_load_dwordx4 v4, s[8:11], s26 offen offset:3072 sc1 lds
M v[80:83],a[84:87],a[20:23],v[80:83]
SA s26,s26,32768
E v18,v72
M v[80:83],a[88:91],a[24:27],v[80:83]
R a[112:115],v2,61440
R a[116:119],v2,62464
M v[80:83],a[92:95],a[28:31],v[80:83]
buffer_store_dwordx4 v[192:195], v7, s[8:11], s3 offen offset:0 sc1
M v[84:87],a[92:95],a[60:63],0
E v19,v73
M v[84:87],a[88:91],a[56:59],v[84:87]
R a[120:123],v2,63488
R a[124:127],v2,64512
M v[84:87],a[84:87],a[52:55],v[84:87]
C v41,v20,v21
AF v26,v21,v26
M v[84:87],a[80:83],a[48:51],v[84:87]
buffer_store_dwordx4 v[200:203], v7, s[8:11], s3 offen offset:1024 sc1
M v[84:87],a[76:79],a[44:47],v[84:87]
E v20,v74
M v[84:87],a[72:75],a[40:43],v[84:87]
AF v27,v22,v23
C v44,v22,v23
M v[84:87],a[68:71],a[36:39],v[84:87]
s_waitcnt vmcnt(23) lgkmcnt(0)
E v21,v75
M v[84:87],a[64:67],a[32:35],v[84:87]
s_barrier
M v[88:91],a[96:99],a[0:3],0
R a[64:67],v2,0
R a[68:71],v2,1024
M v[88:91],a[100:103],a[4:7],v[88:91]
E v22,v76
M v[88:91],a[104:107],a[8:11],v[88:91]
AF v27,v24,v27
C v45,v24,v25
M v[88:91],a[108:111],a[12:15],v[88:91]
R a[72:75],v2,2048
R a[76:79],v2,3072
M v[88:91],a[112:115],a[16:19],v[88:91]
buffer_store_dwordx4 v[208:211], v7, s[8:11], s3 offen offset:2048 sc1
M v[88:91],a[116:119],a[20:23],v[88:91]
E v23,v77
M v[88:91],a[120:123],a[24:27],v[88:91]
R a[80:83],v2,4096
R a[84:87],v2,5120
M v[88:91],a[124:127],a[28:31],v[88:91]
AF v27,v25,v27
AF v26,v18,v26
M v[92:95],a[124:127],a[60:63],0
E v24,v78
M v[92:95],a[120:123],a[56:59],v[92:95]
R a[88:91],v2,6144
R a[92:95],v2,7168
M v[92:95],a[116:119],a[52:55],v[92:95]
E v25,v79
M v[92:95],a[112:115],a[48:51],v[92:95]
C v42,v18,v19
AF v26,v19,v26
M v[92:95],a[108:111],a[44:47],v[92:95]
AF v26,v20,v26
C v43,v20,v21
M v[92:95],a[104:107],a[40:43],v[92:95]
AF v26,v21,v26
AF v27,v22,v27
M v[92:95],a[100:103],a[36:39],v[92:95]
s_waitcnt lgkmcnt(0)
C v46,v22,v23
AF v27,v23,v27
M v[92:95],a[96:99],a[32:35],v[92:95]
AF v27,v24,v27
C v47,v24,v25
AF v27,v25,v27
M v[96:99],a[64:67],a[0:3],0
R a[96:99],v2,8192
R a[100:103],v2,9216
M v[96:99],a[68:71],a[4:7],v[96:99]
SA m0,s28,98304
E v18,v80
M v[96:99],a[72:75],a[8:11],v[96:99]
buffer_load_dwordx4 v3, s[8:11], s21 offen offset:0 sc1 lds
M v[96:99],a[76:79],a[12:15],v[96:99]
R a[104:107],v2,10240
R a[108:111],v2,11264
M v[96:99],a[80:83],a[16:19],v[96:99]
v_mov_b32 v30, 0
M v[96:99],a[84:87],a[20:23],v[96:99]
E v19,v81
M v[96:99],a[88:91],a[24:27],v[96:99]
R a[112:115],v2,12288
R a[116:119],v2,13312
M v[96:99],a[92:95],a[28:31],v[96:99]
buffer_load_dwordx4 v3, s[8:11], s21 offen offset:1024 sc1 lds
M v[100:103],a[92:95],a[60:63],0
v_mov_b32 v31, 0
AF v26,v18,v26
M v[100:103],a[88:91],a[56:59],v[100:103]
R a[120:123],v2,14336
R a[124:127],v2,15360
M v[100:103],a[84:87],a[52:55],v[100:103]
E v20,v82
M v[100:103],a[80:83],a[48:51],v[100:103]
buffer_load_dwordx4 v3, s[8:11], s21 offen offset:2048 sc1 lds
M v[100:103],a[76:79],a[44:47],v[100:103]
E v21,v83
M v[100:103],a[72:75],a[40:43],v[100:103]
v_mov_b32 v32, 0
C v56,v18,v19
M v[100:103],a[68:71],a[36:39],v[100:103]
E v22,v88
M v[100:103],a[64:67],a[32:35],v[100:103]
s_waitcnt lgkmcnt(0)
buffer_load_dwordx4 v3, s[8:11], s21 offen offset:3072 sc1 lds
M v[104:107],a[96:99],a[0:3],0
SA m0,s28,102400
R a[64:67],v2,16384
R a[68:71],v2,17408
M v[104:107],a[100:103],a[4:7],v[104:107]
v_mov_b32 v33, 0
AF v26,v19,v26
M v[104:107],a[104:107],a[8:11],v[104:107]
E v23,v89
M v[104:107],a[108:111],a[12:15],v[104:107]
R a[72:75],v2,18432
R a[76:79],v2,19456
M v[104:107],a[112:115],a[16:19],v[104:107]
buffer_load_dwordx4 v4, s[8:11], s21 offen offset:0 sc1 lds
M v[104:107],a[116:119],a[20:23],v[104:107]
E v24,v90
M v[104:107],a[120:123],a[24:27],v[104:107]
R a[80:83],v2,20480
R a[84:87],v2,21504
M v[104:107],a[124:127],a[28:31],v[104:107]
buffer_load_dwordx4 v4, s[8:11], s21 offen offset:1024 sc1 lds
M v[108:111],a[124:127],a[60:63],0
v_mov_b32 v34, 0
AF v26,v20,v26
M v[108:111],a[120:123],a[56:59],v[108:111]
R a[88:91],v2,22528
R a[92:95],v2,23552
M v[108:111],a[116:119],a[52:55],v[108:111]
buffer_load_dwordx4 v4, s[8:11], s21 offen offset:2048 sc1 lds
M v[108:111],a[112:115],a[48:51],v[108:111]
v_mov_b32 v35, 0
C v57,v20,v21
M v[108:111],a[108:111],a[44:47],v[108:111]
E v25,v91
M v[108:111],a[104:107],a[40:43],v[108:111]
E v18,v84
M v[108:111],a[100:103],a[36:39],v[108:111]
buffer_load_dwordx4 v4, s[8:11], s21 offen offset:3072 sc1 lds
M v[108:111],a[96:99],a[32:35],v[108:111]
s_waitcnt lgkmcnt(0)
v_mov_b32 v36, 0
AF v26,v21,v26
M v[112:115],a[64:67],a[0:3],0
SA s21,s21,32768
R a[96:99],v2,24576
R a[100:103],v2,25600
M v[112:115],a[68:71],a[4:7],v[112:115]
s_sub_u32 s22, s22, 1
E v19,v85
M v[112:115],a[72:75],a[8:11],v[112:115]
s_cselect_b32 s21, s23, s21
E v20,v86
M v[112:115],a[76:79],a[12:15],v[112:115]
SA s3,s93,786432
R a[104:107],v2,26624
R a[108:111],v2,27648
M v[112:115],a[80:83],a[16:19],v[112:115]
buffer_store_dwordx4 v[216:219], v7, s[8:11], s3 offen offset:3072 sc1
M v[112:115],a[84:87],a[20:23],v[112:115]
v_mov_b32 v37, 0
AF v26,v22,v26
M v[112:115],a[88:91],a[24:27],v[112:115]
R a[112:115],v2,28672
R a[116:119],v2,29696
M v[112:115],a[92:95],a[28:31],v[112:115]
E v21,v87
M v[116:119],a[92:95],a[60:63],0
v_mov_b32 v38, 0
C v58,v22,v23
M v[116:119],a[88:91],a[56:59],v[116:119]
SA s3,s93,794624
R a[120:123],v2,30720
R a[124:127],v2,31744
M v[116:119],a[84:87],a[52:55],v[116:119]
buffer_store_dwordx4 v[224:227], v7, s[8:11], s3 offen offset:0 sc1
M v[116:119],a[80:83],a[48:51],v[116:119]
AF v26,v23,v26
AF v26,v24,v26
M v[116:119],a[76:79],a[44:47],v[116:119]
E v22,v92
M v[116:119],a[72:75],a[40:43],v[116:119]
v_mov_b32 v39, 0
C v59,v24,v25
M v[116:119],a[68:71],a[36:39],v[116:119]
s_waitcnt vmcnt(21) lgkmcnt(0)
E v23,v93
M v[116:119],a[64:67],a[32:35],v[116:119]
s_barrier
M v[120:123],a[96:99],a[0:3],0
R a[64:67],v16,0
R a[68:71],v16,1024
M v[120:123],a[100:103],a[4:7],v[120:123]
AF v26,v25,v26
AF v27,v18,v27
M v[120:123],a[104:107],a[8:11],v[120:123]
E v24,v94
M v[120:123],a[108:111],a[12:15],v[120:123]
R a[72:75],v16,2048
R a[76:79],v16,3072
M v[120:123],a[112:115],a[16:19],v[120:123]
buffer_store_dwordx4 v[232:235], v7, s[8:11], s3 offen offset:1024 sc1
M v[120:123],a[116:119],a[20:23],v[120:123]
E v25,v95
M v[120:123],a[120:123],a[24:27],v[120:123]
R a[80:83],v16,4096
R a[84:87],v16,5120
M v[120:123],a[124:127],a[28:31],v[120:123]
C v60,v18,v19
AF v27,v19,v27
M v[124:127],a[124:127],a[60:63],0
AF v27,v20,v27
C v61,v20,v21
M v[124:127],a[120:123],a[56:59],v[124:127]
R a[88:91],v16,6144
R a[92:95],v16,7168
M v[124:127],a[116:119],a[52:55],v[124:127]
AF v27,v21,v27
AF v27,v22,v27
M v[124:127],a[112:115],a[48:51],v[124:127]
C v62,v22,v23
AF v27,v23,v27
M v[124:127],a[108:111],a[44:47],v[124:127]
AF v27,v24,v27
C v63,v24,v25
M v[124:127],a[104:107],a[40:43],v[124:127]
AF v27,v25,v27
M v[124:127],a[100:103],a[36:39],v[124:127]
s_waitcnt lgkmcnt(0)
M v[124:127],a[96:99],a[32:35],v[124:127]
v_max_f32 v10, v26, v27
v_min_f32 v11, v26, v27
v_cmp_lt_f32 vcc, s31, v10
v_cmp_gt_f32 s[64:65], s24, v11
s_nop 0
s_or_b64 vcc, vcc, s[64:65]
s_cbranch_vccnz L_stk1
L_rtk1:
M v[128:131],a[64:67],v[40:43],0
R a[96:99],v16,8192
R a[100:103],v16,9216
M v[128:131],a[68:71],v[56:59],v[128:131]
SA m0,s28,65536
E v18,v96
M v[132:135],a[68:71],v[60:63],0
buffer_load_dwordx4 v3, s[8:11], s21 offen offset:0 sc1 lds
M v[132:135],a[64:67],v[44:47],v[132:135]
R a[104:107],v16,10240
R a[108:111],v16,11264
M v[136:139],a[72:75],v[40:43],0
SA s3,s93,794624
E v19,v97
M v[136:139],a[76:79],v[56:59],v[136:139]
AF v30,v26,v30
AF v31,v27,v31
M v[140:143],a[76:79],v[60:63],0
R a[112:115],v16,12288
R a[116:119],v16,13312
M v[140:143],a[72:75],v[44:47],v[140:143]
buffer_load_dwordx4 v3, s[8:11], s21 offen offset:1024 sc1 lds
M v[144:147],a[80:83],v[40:43],0
E v20,v98
M v[144:147],a[84:87],v[56:59],v[144:147]
R a[120:123],v16,14336
R a[124:127],v16,15360
M v[148:151],a[84:87],v[60:63],0
buffer_store_dwordx4 v[240:243], v7, s[8:11], s3 offen offset:2048 sc1
M v[148:151],a[80:83],v[44:47],v[148:151]
E v21,v99
M v[152:155],a[88:91],v[40:43],0
AF v28,v18,v19
C v48,v18,v19
M v[152:155],a[92:95],v[56:59],v[152:155]
buffer_load_dwordx4 v3, s[8:11], s21 offen offset:2048 sc1 lds
M v[156:159],a[92:95],v[60:63],0
AF v28,v20,v28
C v49,v20,v21
M v[156:159],a[88:91],v[44:47],v[156:159]
s_waitcnt lgkmcnt(0)
E v22,v104
M v[160:163],a[96:99],v[40:43],0
R a[64:67],v16,16384
R a[68:71],v16,17408
M v[160:163],a[100:103],v[56:59],v[160:163]
buffer_load_dwordx4 v3, s[8:11], s21 offen offset:3072 sc1 lds
M v[164:167],a[100:103],v[60:63],0
SA m0,s28,69632
E v23,v105
M v[164:167],a[96:99],v[44:47],v[164:167]
R a[72:75],v16,18432
R a[76:79],v16,19456
M v[168:171],a[104:107],v[40:43],0
buffer_load_dwordx4 v4, s[8:11], s21 offen offset:0 sc1 lds
M v[168:171],a[108:111],v[56:59],v[168:171]
AF v28,v21,v28
AF v28,v22,v28
M v[172:175],a[108:111],v[60:63],0
R a[80:83],v16,20480
R a[84:87],v16,21504
M v[172:175],a[104:107],v[44:47],v[172:175]
buffer_store_dwordx4 v[248:251], v7, s[8:11], s3 offen offset:3072 sc1
M v[176:179],a[112:115],v[40:43],0
E v24,v106
M v[176:179],a[116:119],v[56:59],v[176:179]
R a[88:91],v16,22528
R a[92:95],v16,23552
M v[180:183],a[116:119],v[60:63],0
buffer_load_dwordx4 v4, s[8:11], s21 offen offset:1024 sc1 lds
M v[180:183],a[112:115],v[44:47],v[180:183]
E v25,v107
M v[184:187],a[120:123],v[40:43],0
C v50,v22,v23
AF v28,v23,v28
M v[184:187],a[124:127],v[56:59],v[184:187]
buffer_load_dwordx4 v4, s[8:11], s21 offen offset:2048 sc1 lds
M v[188:191],a[124:127],v[60:63],0
E v18,v100
M v[188:191],a[120:123],v[44:47],v[188:191]
s_waitcnt lgkmcnt(0)
AF v28,v24,v28
C v51,v24,v25
M v[192:195],a[64:67],v[40:43],0
R a[96:99],v16,24576
R a[100:103],v16,25600
M v[192:195],a[68:71],v[56:59],v[192:195]
buffer_load_dwordx4 v4, s[8:11], s21 offen offset:3072 sc1 lds
M v[196:199],a[68:71],v[60:63],0
SA s21,s21,32768
E v19,v101
M v[196:199],a[64:67],v[44:47],v[196:199]
s_sub_u32 s22, s22, 1
R a[104:107],v16,26624
R a[108:111],v16,27648
M v[200:203],a[72:75],v[40:43],0
s_cselect_b32 s21, s23, s21
AF v28,v25,v28
AF v29,v18,v19
M v[200:203],a[76:79],v[56:59],v[200:203]
E v20,v102
M v[204:207],a[76:79],v[60:63],0
R a[112:115],v16,28672
R a[116:119],v16,29696
M v[204:207],a[72:75],v[44:47],v[204:207]
C v52,v18,v19
M v[208:211],a[80:83],v[40:43],0
M v[208:211],a[84:87],v[56:59],v[208:211]
R a[120:123],v16,30720
R a[124:127],v16,31744
M v[212:215],a[84:87],v[60:63],0
E v21,v103
M v[212:215],a[80:83],v[44:47],v[212:215]
AF v29,v20,v29
C v53,v20,v21
M v[216:219],a[88:91],v[40:43],0
AF v29,v21,v29
M v[216:219],a[92:95],v[56:59],v[216:219]
E v22,v108
M v[220:223],a[92:95],v[60:63],0
s_waitcnt vmcnt(13) lgkmcnt(0)
M v[220:223],a[88:91],v[44:47],v[220:223]
s_barrier
M v[224:227],a[96:99],v[40:43],0
R a[64:67],v2,32768
R a[68:71],v2,33792
M v[224:227],a[100:103],v[56:59],v[224:227]
E v23,v109
M v[228:231],a[100:103],v[60:63],0
AF v29,v22,v29
C v54,v22,v23
M v[228:231],a[96:99],v[44:47],v[228:231]
R a[72:75],v2,34816
R a[76:79],v2,35840
M v[232:235],a[104:107],v[40:43],0
E v24,v110
M v[232:235],a[108:111],v[56:59],v[232:235]
AF v29,v23,v29
M v[236:239],a[108:111],v[60:63],0
R a[80:83],v2,36864
R a[84:87],v2,37888
M v[236:239],a[104:107],v[44:47],v[236:239]
M v[240:243],a[112:115],v[40:43],0
E v25,v111
M v[240:243],a[116:119],v[56:59],v[240:243]
R a[88:91],v2,38912
R a[92:95],v2,39936
M v[244:247],a[116:119],v[60:63],0
AF v29,v24,v29
C v55,v24,v25
M v[244:247],a[112:115],v[44:47],v[244:247]
AF v29,v25,v29
M v[248:251],a[120:123],v[40:43],0
M v[248:251],a[124:127],v[56:59],v[248:251]
M v[252:255],a[124:127],v[60:63],0
s_waitcnt lgkmcnt(0)
M v[252:255],a[120:123],v[44:47],v[252:255]
s_cmp_lg_u32 s27, 0
s_cbranch_scc1 L_loop_top
s_branch L_d1s
L_j0:
M v[68:71],a[64:67],a[32:35],0
s_cmp_lt_u32 s20, 0
R a[96:99],v2,40960
R a[100:103],v2,41984
M v[68:71],a[68:71],a[36:39],v[68:71]
s_cselect_b64 s[82:83], -1, 0
v_mov_b32 v30, 0
MF v172,s5,v172
M v[68:71],a[72:75],a[40:43],v[68:71]
s_cmp_eq_u32 s20, 0
MF v173,s5,v173
MF v174,s5,v174
M v[68:71],a[76:79],a[44:47],v[68:71]
s_cselect_b64 s[66:67], s[16:17], s[82:83]
R a[104:107],v2,43008
R a[108:111],v2,44032
M v[68:71],a[80:83],a[48:51],v[68:71]
s_cselect_b64 s[68:69], s[18:19], s[82:83]
MF v175,s5,v175
MF v188,s5,v188
M v[68:71],a[84:87],a[52:55],v[68:71]
s_cselect_b64 s[70:71], s[48:49], s[82:83]
MF v189,s5,v189
MF v190,s5,v190
MF v191,s5,v191
C v172,v172,v173
C v173,v174,v175
C v174,v188,v189
C v175,v190,v191
W a60,v172
W a61,v173
W a62,v174
W a63,v175
M v[68:71],a[88:91],a[56:59],v[68:71]
s_cselect_b64 s[72:73], s[50:51], s[82:83]
R a[112:115],v2,45056
R a[116:119],v2,46080
v_cndmask_b32 v64, 0, v8, s[66:67]
v_cndmask_b32 v65, 0, v8, s[68:69]
v_cndmask_b32 v66, 0, v8, s[70:71]
v_cndmask_b32 v67, 0, v8, s[72:73]
M v[68:71],a[92:95],a[60:63],v[68:71]
s_cmp_lt_u32 s20, 1
MF v164,s5,v164
MF v165,s5,v165
M v[64:67],a[64:67],a[0:3],v[64:67]
s_cselect_b64 s[82:83], -1, 0
MF v166,s5,v166
MF v167,s5,v167
M v[64:67],a[68:71],a[4:7],v[64:67]
s_cmp_eq_u32 s20, 1
R a[120:123],v2,47104
R a[124:127],v2,48128
M v[64:67],a[72:75],a[8:11],v[64:67]
s_cselect_b64 s[74:75], s[16:17], s[82:83]
MF v180,s5,v180
MF v181,s5,v181
M v[64:67],a[76:79],a[12:15],v[64:67]
s_cselect_b64 s[76:77], s[18:19], s[82:83]
MF v182,s5,v182
MF v183,s5,v183
M v[64:67],a[80:83],a[16:19],v[64:67]
s_cselect_b64 s[78:79], s[48:49], s[82:83]
C v164,v164,v165
C v165,v166,v167
C v166,v180,v181
C v167,v182,v183
W a28,v164
W a29,v165
W a30,v166
W a31,v167
M v[64:67],a[84:87],a[20:23],v[64:67]
s_cselect_b64 s[80:81], s[50:51], s[82:83]
v_mov_b32 v31, 0
v_cndmask_b32 v72, 0, v8, s[74:75]
M v[64:67],a[88:91],a[24:27],v[64:67]
s_mov_b32 s26, s43
v_mov_b32 v32, 0
M v[64:67],a[92:95],a[28:31],v[64:67]
s_waitcnt lgkmcnt(0)
v_cndmask_b32 v73, 0, v8, s[76:77]
M v[76:79],a[96:99],a[32:35],0
SA m0,s28,0
R a[64:67],v2,49152
R a[68:71],v2,50176
M v[76:79],a[100:103],a[36:39],v[76:79]
SA s3,s93,786432
buffer_load_dwordx4 v3, s[8:11], s26 offen offset:0 sc1 lds
M v[76:79],a[104:107],a[40:43],v[76:79]
v_cndmask_b32 v74, 0, v8, s[78:79]
v_mov_b32 v33, 0
M v[76:79],a[108:111],a[44:47],v[76:79]
R a[72:75],v2,51200
R a[76:79],v2,52224
M v[76:79],a[112:115],a[48:51],v[76:79]
buffer_store_dwordx4 v[192:195], v7, s[8:11], s3 offen offset:0 sc1
M v[76:79],a[116:119],a[52:55],v[76:79]
v_cndmask_b32 v75, 0, v8, s[80:81]
M v[76:79],a[120:123],a[56:59],v[76:79]
s_cmp_lt_u32 s20, 2
R a[80:83],v2,53248
R a[84:87],v2,54272
M v[76:79],a[124:127],a[60:63],v[76:79]
s_cselect_b64 s[82:83], -1, 0
buffer_load_dwordx4 v3, s[8:11], s26 offen offset:1024 sc1 lds
M v[72:75],a[124:127],a[28:31],v[72:75]
s_cmp_eq_u32 s20, 2
E v18,v68
M v[72:75],a[120:123],a[24:27],v[72:75]
s_cselect_b64 s[66:67], s[16:17], s[82:83]
R a[88:91],v2,55296
R a[92:95],v2,56320
M v[72:75],a[116:119],a[20:23],v[72:75]
s_cselect_b64 s[68:69], s[18:19], s[82:83]
buffer_load_dwordx4 v3, s[8:11], s26 offen offset:2048 sc1 lds
M v[72:75],a[112:115],a[16:19],v[72:75]
s_cselect_b64 s[70:71], s[48:49], s[82:83]
v_mov_b32 v34, 0
M v[72:75],a[108:111],a[12:15],v[72:75]
s_cselect_b64 s[72:73], s[50:51], s[82:83]
v_cndmask_b32 v80, 0, v8, s[66:67]
v_cndmask_b32 v81, 0, v8, s[68:69]
M v[72:75],a[104:107],a[8:11],v[72:75]
buffer_store_dwordx4 v[200:203], v7, s[8:11], s3 offen offset:1024 sc1
M v[72:75],a[100:103],a[4:7],v[72:75]
E v19,v69
M v[72:75],a[96:99],a[0:3],v[72:75]
s_waitcnt lgkmcnt(0)
buffer_load_dwordx4 v3, s[8:11], s26 offen offset:3072 sc1 lds
M v[84:87],a[64:67],a[32:35],0
SA m0,s28,4096
R a[96:99],v2,57344
R a[100:103],v2,58368
M v[84:87],a[68:71],a[36:39],v[84:87]
v_cndmask_b32 v82, 0, v8, s[70:71]
v_mov_b32 v35, 0
M v[84:87],a[72:75],a[40:43],v[84:87]
buffer_load_dwordx4 v4, s[8:11], s26 offen offset:0 sc1 lds
M v[84:87],a[76:79],a[44:47],v[84:87]
R a[104:107],v2,59392
R a[108:111],v2,60416
M v[84:87],a[80:83],a[48:51],v[84:87]
buffer_store_dwordx4 v[208:211], v7, s[8:11], s3 offen offset:2048 sc1
M v[84:87],a[84:87],a[52:55],v[84:87]
v_cndmask_b32 v83, 0, v8, s[72:73]
v_mov_b32 v36, 0
M v[84:87],a[88:91],a[56:59],v[84:87]
s_cmp_lt_u32 s20, 3
R a[112:115],v2,61440
R a[116:119],v2,62464
M v[84:87],a[92:95],a[60:63],v[84:87]
s_cselect_b64 s[82:83], -1, 0
buffer_load_dwordx4 v4, s[8:11], s26 offen offset:1024 sc1 lds
M v[80:83],a[92:95],a[28:31],v[80:83]
s_cmp_eq_u32 s20, 3
E v20,v70
M v[80:83],a[88:91],a[24:27],v[80:83]
s_cselect_b64 s[74:75], s[16:17], s[82:83]
R a[120:123],v2,63488
R a[124:127],v2,64512
M v[80:83],a[84:87],a[20:23],v[80:83]
s_cselect_b64 s[76:77], s[18:19], s[82:83]
buffer_load_dwordx4 v4, s[8:11], s26 offen offset:2048 sc1 lds
M v[80:83],a[80:83],a[16:19],v[80:83]
s_cselect_b64 s[78:79], s[48:49], s[82:83]
E v21,v71
M v[80:83],a[76:79],a[12:15],v[80:83]
s_cselect_b64 s[80:81], s[50:51], s[82:83]
buffer_store_dwordx4 v[216:219], v7, s[8:11], s3 offen offset:3072 sc1
M v[80:83],a[72:75],a[8:11],v[80:83]
SA s3,s93,794624
v_cndmask_b32 v88, 0, v8, s[74:75]
v_cndmask_b32 v89, 0, v8, s[76:77]
M v[80:83],a[68:71],a[4:7],v[80:83]
s_waitcnt vmcnt(24) lgkmcnt(0)
buffer_load_dwordx4 v4, s[8:11], s26 offen offset:3072 sc1 lds
M v[80:83],a[64:67],a[0:3],v[80:83]
s_barrier
M v[92:95],a[96:99],a[32:35],0
R a[64:67],v2,0
R a[68:71],v2,1024
M v[92:95],a[100:103],a[36:39],v[92:95]
buffer_store_dwordx4 v[224:227], v7, s[8:11], s3 offen offset:0 sc1
M v[92:95],a[104:107],a[40:43],v[92:95]
v_min_u32 v17, 896, v9
v_cndmask_b32 v90, 0, v8, s[78:79]
M v[92:95],a[108:111],a[44:47],v[92:95]
R a[72:75],v2,2048
R a[76:79],v2,3072
M v[92:95],a[112:115],a[48:51],v[92:95]
buffer_load_dword v5, v17, s[8:11], s46 offen sc1
M v[92:95],a[116:119],a[52:55],v[92:95]
buffer_store_dwordx4 v[232:235], v7, s[8:11], s3 offen offset:1024 sc1
M v[92:95],a[120:123],a[56:59],v[92:95]
R a[80:83],v2,4096
R a[84:87],v2,5120
v_cndmask_b32 v91, 0, v8, s[80:81]
M v[92:95],a[124:127],a[60:63],v[92:95]
v_mov_b32 v37, 0
v_mov_b32 v38, 0
M v[88:91],a[124:127],a[28:31],v[88:91]
buffer_store_dwordx4 v[240:243], v7, s[8:11], s3 offen offset:2048 sc1
M v[88:91],a[120:123],a[24:27],v[88:91]
R a[88:91],v2,6144
R a[92:95],v2,7168
M v[88:91],a[116:119],a[20:23],v[88:91]
v_mov_b32 v39, 0
AF v27,v18,v19
M v[88:91],a[112:115],a[16:19],v[88:91]
buffer_store_dwordx4 v[248:251], v7, s[8:11], s3 offen offset:3072 sc1
M v[88:91],a[108:111],a[12:15],v[88:91]
E v22,v64
M v[88:91],a[104:107],a[8:11],v[88:91]
E v23,v65
M v[88:91],a[100:103],a[4:7],v[88:91]
s_waitcnt lgkmcnt(0)
E v24,v66
M v[88:91],a[96:99],a[0:3],v[88:91]
E v25,v67
C v44,v18,v19
AF v27,v20,v27
C v45,v20,v21
AF v27,v21,v27
AF v26,v22,v23
C v40,v22,v23
E v18,v76
E v19,v77
AF v26,v24,v26
C v41,v24,v25
AF v26,v25,v26
E v20,v78
E v21,v79
AF v27,v18,v27
C v46,v18,v19
AF v27,v19,v27
E v22,v72
E v23,v73
AF v27,v20,v27
C v47,v20,v21
AF v27,v21,v27
E v24,v74
E v25,v75
AF v26,v22,v26
C v42,v22,v23
AF v26,v23,v26
AF v26,v24,v26
C v43,v24,v25
AF v26,v25,v26
v_mov_b32 v56, 0
v_mov_b32 v57, 0
v_mov_b32 v58, 0
v_mov_b32 v59, 0
s_mul_i32 s21, s41, 1048576
SA s21,s21,589824
s_lshl_b32 s84, s42, 1
s_sub_u32 s22, 11, s84
s_mov_b32 s23, 536870912
s_lshl_b32 s86, s20, 14
SA s86,s86,s34
SA s87,s86,4096
SA s88,s86,8192
SA s89,s86,12288
s_lshl_b32 s90, s20, 10
SA s90,s90,s34
SA s90,s90,65536
s_waitcnt vmcnt(3)
v_cmp_gt_u32 vcc, 2, v5
s_nop 0
s_cbranch_vccnz L_lsj0
L_lrj0:
SA m0,s28,98304
v_mov_b32 v10, v26
buffer_load_dwordx4 v3, s[8:11], s21 offen offset:0 sc1 lds
v_mov_b32 v11, v27
buffer_load_dwordx4 v3, s[8:11], s21 offen offset:1024 sc1 lds
v_mov_b32 v12, v10
v_mov_b32 v13, v11
buffer_load_dwordx4 v3, s[8:11], s21 offen offset:2048 sc1 lds
v_permlane16_swap_b32 v12, v10
v_permlane16_swap_b32 v13, v11
buffer_load_dwordx4 v3, s[8:11], s21 offen offset:3072 sc1 lds
v_max_f32 v10, v12, v10
SA m0,s28,102400
v_max_f32 v11, v13, v11
buffer_load_dwordx4 v4, s[8:11], s21 offen offset:0 sc1 lds
v_mov_b32 v12, v10
v_mov_b32 v13, v11
buffer_load_dwordx4 v4, s[8:11], s21 offen offset:1024 sc1 lds
v_permlane32_swap_b32 v12, v10
v_permlane32_swap_b32 v13, v11
buffer_load_dwordx4 v4, s[8:11], s21 offen offset:2048 sc1 lds
v_max_f32 v10, v12, v10
v_max_f32 v11, v13, v11
buffer_load_dwordx4 v4, s[8:11], s21 offen offset:3072 sc1 lds
SA s21,s21,32768
s_sub_u32 s22, s22, 1
s_cselect_b32 s21, s23, s21
v_min_f32 v10, v10, v11
v_cmp_gt_f32 vcc, s24, v10
s_nop 0
s_cbranch_vccnz L_stj0
L_rtj0:
s_cmp_gt_u32 s20, 3
s_cselect_b64 s[82:83], -1, 0
s_cmp_eq_u32 s20, 3
s_cselect_b64 s[66:67], s[16:17], s[82:83]
v_mfma_f32_32x32x16_bf16 v[128:143], v[56:59], v[56:59], 0
s_cselect_b64 s[68:69], s[18:19], s[82:83]
s_cselect_b64 s[70:71], s[48:49], s[82:83]
s_cselect_b64 s[72:73], s[50:51], s[82:83]
v_cndmask_b32 v100, v36, v8, s[66:67]
v_mfma_f32_32x32x16_bf16 v[144:159], v[56:59], v[56:59], 0
v_cndmask_b32 v101, v36, v8, s[68:69]
v_cndmask_b32 v102, v36, v8, s[70:71]
v_cndmask_b32 v103, v36, v8, s[72:73]
s_cmp_gt_u32 s20, 2
v_mfma_f32_32x32x16_bf16 v[160:175], v[56:59], v[56:59], 0
s_cselect_b64 s[82:83], -1, 0
s_cmp_eq_u32 s20, 2
s_cselect_b64 s[74:75], s[16:17], s[82:83]
s_cselect_b64 s[76:77], s[18:19], s[82:83]
v_mfma_f32_32x32x16_bf16 v[176:191], v[56:59], v[56:59], 0
s_cselect_b64 s[78:79], s[48:49], s[82:83]
s_cselect_b64 s[80:81], s[50:51], s[82:83]
v_cndmask_b32 v108, v36, v8, s[74:75]
v_cndmask_b32 v109, v36, v8, s[76:77]
v_mfma_f32_32x32x16_bf16 v[192:207], v[56:59], v[56:59], 0
v_cndmask_b32 v110, v36, v8, s[78:79]
v_cndmask_b32 v111, v36, v8, s[80:81]
s_cmp_gt_u32 s20, 1
s_cselect_b64 s[82:83], -1, 0
v_mfma_f32_32x32x16_bf16 v[208:223], v[56:59], v[56:59], 0
s_cmp_eq_u32 s20, 1
s_cselect_b64 s[66:67], s[16:17], s[82:83]
s_cselect_b64 s[68:69], s[18:19], s[82:83]
s_cselect_b64 s[70:71], s[48:49], s[82:83]
v_mfma_f32_32x32x16_bf16 v[224:239], v[56:59], v[56:59], 0
s_cselect_b64 s[72:73], s[50:51], s[82:83]
v_cndmask_b32 v116, v36, v8, s[66:67]
v_cndmask_b32 v117, v36, v8, s[68:69]
v_cndmask_b32 v118, v36, v8, s[70:71]
v_mfma_f32_32x32x16_bf16 v[240:255], v[56:59], v[56:59], 0
v_cndmask_b32 v119, v36, v8, s[72:73]
s_cmp_gt_u32 s20, 0
s_cselect_b64 s[82:83], -1, 0
s_cmp_eq_u32 s20, 0
s_cselect_b64 s[74:75], s[16:17], s[82:83]
s_cselect_b64 s[76:77], s[18:19], s[82:83]
s_cselect_b64 s[78:79], s[48:49], s[82:83]
s_cselect_b64 s[80:81], s[50:51], s[82:83]
v_cndmask_b32 v124, v36, v8, s[74:75]
v_cndmask_b32 v125, v36, v8, s[76:77]
v_cndmask_b32 v126, v36, v8, s[78:79]
v_cndmask_b32 v127, v36, v8, s[80:81]
s_branch L_d3h
.p2align 12
L_kv1:
s_and_b32 s31, s42, 7
s_lshl_b32 s30, s41, 3
SA s30,s30,s31
s_lshl_b32 s64, s30, 2
SA s64,s64,s20
s_mul_i32 s72, s64, 3584
v_mov_b32 v32, 536870912
v_cmp_gt_u32 vcc, 56, v0
s_lshl_b32 s67, s64, 2
s_nop 0
v_cndmask_b32 v32, v32, v7, vcc
buffer_load_dwordx4 a[176:179], v32, s[56:59], s72 offen offset:0
buffer_load_dwordx4 a[180:183], v32, s[56:59], s72 offen offset:896
buffer_load_dwordx4 a[184:187], v32, s[56:59], s72 offen offset:1792
buffer_load_dwordx4 a[188:191], v32, s[56:59], s72 offen offset:2688
buffer_load_dwordx4 a[192:195], v32, s[60:63], 0 offen
buffer_load_dwordx4 a[196:199], v32, s[68:71], 0 offen
SA m0,s24,16384
s_nop 0
buffer_load_dwordx4 v12, s[48:51], s22 offen offset:0   lds
buffer_load_dwordx4 v13, s[48:51], s22 offen offset:1024   lds
buffer_load_dwordx4 v14, s[48:51], s22 offen offset:2048   lds
buffer_load_dwordx4 v15, s[48:51], s22 offen offset:3072   lds
s_sub_u32 s22, s22, 1048448
SA m0,s23,32768
s_nop 0
buffer_load_dwordx4 v8, s[16:19], s21 offen offset:0  nt lds
buffer_load_dwordx4 v9, s[16:19], s21 offen offset:1024  nt lds
buffer_load_dwordx4 v10, s[16:19], s21 offen offset:2048  nt lds
buffer_load_dwordx4 v11, s[16:19], s21 offen offset:3072  nt lds
SA s21,s21,128
s_mov_b64 exec, 0
s_cmp_eq_u32 s20, 0
s_cbranch_scc1 L_w_kv11
s_cmp_eq_u32 s20, 1
s_cbranch_scc1 L_w_kv12
s_cmp_eq_u32 s20, 2
s_cbranch_scc1 L_w_kv13
s_branch L_w_kv14
L_wd2:
s_mov_b64 exec, -1
s_waitcnt vmcnt(14) lgkmcnt(0)
s_barrier
R a[160:163],v5,0
R a[164:167],v6,0
T a[96:97],v1,0
T a[98:99],v1,1024
T a[100:101],v1,8192
T a[102:103],v1,9216
T a[104:105],v2,0
T a[106:107],v2,1024
T a[108:109],v2,8192
T a[110:111],v2,9216
T a[112:113],v3,0
T a[114:115],v3,1024
T a[116:117],v3,8192
T a[118:119],v3,9216
T a[120:121],v4,0
T a[122:123],v4,1024
T a[124:125],v4,8192
T a[126:127],v4,9216
T a[128:129],v1,16384
T a[130:131],v1,17408
T a[132:133],v1,24576
T a[134:135],v1,25600
T a[136:137],v2,16384
T a[138:139],v2,17408
T a[140:141],v2,24576
T a[142:143],v2,25600
T a[144:145],v3,16384
T a[146:147],v3,17408
T a[148:149],v3,24576
T a[150:151],v3,25600
T a[152:153],v4,16384
T a[154:155],v4,17408
T a[156:157],v4,24576
T a[158:159],v4,25600
s_waitcnt lgkmcnt(15)
M a[0:3],a[160:163],a[96:99],0
SA m0,s23,49152
R a[168:171],v5,2048
R a[172:175],v6,2048
M a[0:3],a[164:167],a[100:103],a[0:3]
buffer_load_dwordx4 v8, s[16:19], s21 offen offset:0  nt lds
M a[4:7],a[164:167],a[108:111],0
M a[4:7],a[160:163],a[104:107],a[4:7]
M a[8:11],a[160:163],a[112:115],0
buffer_load_dwordx4 v9, s[16:19], s21 offen offset:1024  nt lds
M a[8:11],a[164:167],a[116:119],a[8:11]
s_waitcnt lgkmcnt(14)
M a[12:15],a[164:167],a[124:127],0
M a[12:15],a[160:163],a[120:123],a[12:15]
M a[16:19],a[160:163],a[128:131],0
buffer_load_dwordx4 v10, s[16:19], s21 offen offset:2048  nt lds
M a[16:19],a[164:167],a[132:135],a[16:19]
s_waitcnt lgkmcnt(6)
M a[20:23],a[164:167],a[140:143],0
M a[20:23],a[160:163],a[136:139],a[20:23]
buffer_load_dwordx4 v11, s[16:19], s21 offen offset:3072  nt lds
M a[24:27],a[160:163],a[144:147],0
SA s21,s21,524160
M a[24:27],a[164:167],a[148:151],a[24:27]
s_waitcnt lgkmcnt(0)
M a[28:31],a[164:167],a[156:159],0
SA m0,s24,32768
M a[28:31],a[160:163],a[152:155],a[28:31]
buffer_load_dwordx4 v12, s[48:51], s22 offen offset:0   lds
M v[32:35],a[168:171],a[96:99],0
R a[160:163],v5,4096
R a[164:167],v6,4096
M v[32:35],a[172:175],a[100:103],v[32:35]
M v[36:39],a[172:175],a[108:111],0
M v[36:39],a[168:171],a[104:107],v[36:39]
buffer_load_dwordx4 v13, s[48:51], s22 offen offset:1024   lds
M v[40:43],a[168:171],a[112:115],0
M v[40:43],a[172:175],a[116:119],v[40:43]
M v[44:47],a[172:175],a[124:127],0
buffer_load_dwordx4 v14, s[48:51], s22 offen offset:2048   lds
M v[44:47],a[168:171],a[120:123],v[44:47]
M v[48:51],a[168:171],a[128:131],0
M v[48:51],a[172:175],a[132:135],v[48:51]
M v[52:55],a[172:175],a[140:143],0
buffer_load_dwordx4 v15, s[48:51], s22 offen offset:3072   lds
M v[52:55],a[168:171],a[136:139],v[52:55]
SA s22,s22,1048576
M v[56:59],a[168:171],a[144:147],0
M v[56:59],a[172:175],a[148:151],v[56:59]
s_waitcnt lgkmcnt(0)
M v[60:63],a[172:175],a[156:159],0
M v[60:63],a[168:171],a[152:155],v[60:63]
M v[64:67],a[160:163],a[96:99],0
R a[168:171],v5,6144
R a[172:175],v6,6144
M v[64:67],a[164:167],a[100:103],v[64:67]
M v[68:71],a[164:167],a[108:111],0
M v[68:71],a[160:163],a[104:107],v[68:71]
M v[72:75],a[160:163],a[112:115],0
M v[72:75],a[164:167],a[116:119],v[72:75]
M v[76:79],a[164:167],a[124:127],0
M v[76:79],a[160:163],a[120:123],v[76:79]
M v[80:83],a[160:163],a[128:131],0
M v[80:83],a[164:167],a[132:135],v[80:83]
M v[84:87],a[164:167],a[140:143],0
M v[84:87],a[160:163],a[136:139],v[84:87]
M v[88:91],a[160:163],a[144:147],0
M v[88:91],a[164:167],a[148:151],v[88:91]
s_waitcnt lgkmcnt(0)
M v[92:95],a[164:167],a[156:159],0
s_waitcnt vmcnt(12)
M v[92:95],a[160:163],a[152:155],v[92:95]
s_barrier
M v[96:99],a[168:171],a[96:99],0
SA m0,s23,0
R a[160:163],v5,16384
R a[164:167],v6,16384
M v[96:99],a[172:175],a[100:103],v[96:99]
buffer_load_dwordx4 v8, s[16:19], s21 offen offset:0  nt lds
M v[100:103],a[172:175],a[108:111],0
v_lshlrev_b32 v26, 7, v0
v_and_b32 v27, 48, v0
M v[100:103],a[168:171],a[104:107],v[100:103]
v_lshl_add_u32 v26, v27, 24, v26
M v[104:107],a[168:171],a[112:115],0
buffer_load_dwordx4 v9, s[16:19], s21 offen offset:1024  nt lds
M v[104:107],a[172:175],a[116:119],v[104:107]
M v[108:111],a[172:175],a[124:127],0
M v[108:111],a[168:171],a[120:123],v[108:111]
buffer_load_dwordx4 v10, s[16:19], s21 offen offset:2048  nt lds
M v[112:115],a[168:171],a[128:131],0
M v[112:115],a[172:175],a[132:135],v[112:115]
M v[116:119],a[172:175],a[140:143],0
M v[116:119],a[168:171],a[136:139],v[116:119]
buffer_load_dwordx4 v11, s[16:19], s21 offen offset:3072  nt lds
M v[120:123],a[168:171],a[144:147],0
SA s21,s21,128
M v[120:123],a[172:175],a[148:151],v[120:123]
s_waitcnt lgkmcnt(0)
M v[124:127],a[172:175],a[156:159],0
SA m0,s24,49152
M v[124:127],a[168:171],a[152:155],v[124:127]
buffer_load_dwordx4 v12, s[48:51], s22 offen offset:0   lds
M v[128:131],a[160:163],a[96:99],0
R a[168:171],v5,18432
R a[172:175],v6,18432
M v[128:131],a[164:167],a[100:103],v[128:131]
buffer_load_dwordx4 v13, s[48:51], s22 offen offset:1024   lds
M v[132:135],a[164:167],a[108:111],0
M v[132:135],a[160:163],a[104:107],v[132:135]
M v[136:139],a[160:163],a[112:115],0
M v[136:139],a[164:167],a[116:119],v[136:139]
buffer_load_dwordx4 v14, s[48:51], s22 offen offset:2048   lds
M v[140:143],a[164:167],a[124:127],0
M v[140:143],a[160:163],a[120:123],v[140:143]
M v[144:147],a[160:163],a[128:131],0
buffer_load_dwordx4 v15, s[48:51], s22 offen offset:3072   lds
M v[144:147],a[164:167],a[132:135],v[144:147]
s_sub_u32 s22, s22, 1048448
M v[148:151],a[164:167],a[140:143],0
M v[148:151],a[160:163],a[136:139],v[148:151]
M v[152:155],a[160:163],a[144:147],0
M v[152:155],a[164:167],a[148:151],v[152:155]
s_waitcnt lgkmcnt(0)
M v[156:159],a[164:167],a[156:159],0
s_waitcnt vmcnt(12)
M v[156:159],a[160:163],a[152:155],v[156:159]
s_barrier
M v[160:163],a[168:171],a[96:99],0
SA m0,s23,16384
R a[160:163],v5,20480
R a[164:167],v6,20480
M v[160:163],a[172:175],a[100:103],v[160:163]
T a[32:33],v1,32768
T a[34:35],v1,33792
M v[164:167],a[172:175],a[108:111],0
T a[36:37],v1,40960
T a[38:39],v1,41984
M v[164:167],a[168:171],a[104:107],v[164:167]
T a[40:41],v2,32768
T a[42:43],v2,33792
M v[168:171],a[168:171],a[112:115],0
T a[44:45],v2,40960
T a[46:47],v2,41984
M v[168:171],a[172:175],a[116:119],v[168:171]
buffer_load_dwordx4 v8, s[16:19], s21 offen offset:0  nt lds
M v[172:175],a[172:175],a[124:127],0
s_nop 0
T a[48:49],v3,32768
T a[50:51],v3,33792
M v[172:175],a[168:171],a[120:123],v[172:175]
buffer_load_dwordx4 v9, s[16:19], s21 offen offset:1024  nt lds
M v[176:179],a[168:171],a[128:131],0
s_nop 0
T a[52:53],v3,40960
T a[54:55],v3,41984
M v[176:179],a[172:175],a[132:135],v[176:179]
T a[56:57],v4,32768
T a[58:59],v4,33792
M v[180:183],a[172:175],a[140:143],0
buffer_load_dwordx4 v10, s[16:19], s21 offen offset:2048  nt lds
M v[180:183],a[168:171],a[136:139],v[180:183]
s_nop 0
T a[60:61],v4,40960
T a[62:63],v4,41984
M v[184:187],a[168:171],a[144:147],0
buffer_load_dwordx4 v11, s[16:19], s21 offen offset:3072  nt lds
M v[184:187],a[172:175],a[148:151],v[184:187]
s_waitcnt lgkmcnt(15)
s_nop 0
T a[64:65],v1,49152
T a[66:67],v1,50176
M v[188:191],a[172:175],a[156:159],0
SA s21,s21,524160
T a[68:69],v1,57344
T a[70:71],v1,58368
M v[188:191],a[168:171],a[152:155],v[188:191]
SA m0,s24,0
M v[192:195],a[160:163],a[96:99],0
R a[168:171],v5,22528
R a[172:175],v6,22528
M v[192:195],a[164:167],a[100:103],v[192:195]
T a[72:73],v2,49152
T a[74:75],v2,50176
M v[196:199],a[164:167],a[108:111],0
T a[76:77],v2,57344
T a[78:79],v2,58368
M v[196:199],a[160:163],a[104:107],v[196:199]
T a[80:81],v3,49152
T a[82:83],v3,50176
M v[200:203],a[160:163],a[112:115],0
buffer_load_dwordx4 v12, s[48:51], s22 offen offset:0   lds
M v[200:203],a[164:167],a[116:119],v[200:203]
s_nop 0
T a[84:85],v3,57344
T a[86:87],v3,58368
M v[204:207],a[164:167],a[124:127],0
T a[88:89],v4,49152
T a[90:91],v4,50176
M v[204:207],a[160:163],a[120:123],v[204:207]
buffer_load_dwordx4 v13, s[48:51], s22 offen offset:1024   lds
M v[208:211],a[160:163],a[128:131],0
s_nop 0
T a[92:93],v4,57344
T a[94:95],v4,58368
M v[208:211],a[164:167],a[132:135],v[208:211]
buffer_load_dwordx4 v14, s[48:51], s22 offen offset:2048   lds
M v[212:215],a[164:167],a[140:143],0
buffer_load_dwordx4 v15, s[48:51], s22 offen offset:3072   lds
M v[212:215],a[160:163],a[136:139],v[212:215]
SA s22,s22,1048576
M v[216:219],a[160:163],a[144:147],0
M v[216:219],a[164:167],a[148:151],v[216:219]
s_waitcnt lgkmcnt(12)
M v[220:223],a[164:167],a[156:159],0
s_waitcnt vmcnt(12) lgkmcnt(0)
M v[220:223],a[160:163],a[152:155],v[220:223]
s_barrier
M v[224:227],a[168:171],a[96:99],0
SA m0,s23,32768
R a[160:163],v5,32768
R a[164:167],v6,32768
M v[224:227],a[172:175],a[100:103],v[224:227]
buffer_load_dwordx4 v8, s[16:19], s21 offen offset:0  nt lds
M v[228:231],a[172:175],a[108:111],0
M v[228:231],a[168:171],a[104:107],v[228:231]
M v[232:235],a[168:171],a[112:115],0
buffer_load_dwordx4 v9, s[16:19], s21 offen offset:1024  nt lds
M v[232:235],a[172:175],a[116:119],v[232:235]
M v[236:239],a[172:175],a[124:127],0
M v[236:239],a[168:171],a[120:123],v[236:239]
buffer_load_dwordx4 v10, s[16:19], s21 offen offset:2048  nt lds
M v[240:243],a[168:171],a[128:131],0
M v[240:243],a[172:175],a[132:135],v[240:243]
M v[244:247],a[172:175],a[140:143],0
buffer_load_dwordx4 v11, s[16:19], s21 offen offset:3072  nt lds
M v[244:247],a[168:171],a[136:139],v[244:247]
SA s21,s21,128
M v[248:251],a[168:171],a[144:147],0
M v[248:251],a[172:175],a[148:151],v[248:251]
s_waitcnt lgkmcnt(0)
M v[252:255],a[172:175],a[156:159],0
M v[252:255],a[168:171],a[152:155],v[252:255]
M a[0:3],a[160:163],a[32:35],a[0:3]
R a[168:171],v5,34816
R a[172:175],v6,34816
M a[0:3],a[164:167],a[36:39],a[0:3]
T a[96:97],v1,0
T a[98:99],v1,1024
M a[4:7],a[164:167],a[44:47],a[4:7]
SA m0,s24,16384
v_mov_b32 v16, 0
v_mov_b32 v17, 0
M a[4:7],a[160:163],a[40:43],a[4:7]
buffer_load_dwordx4 v12, s[48:51], s22 offen offset:0   lds
M a[8:11],a[160:163],a[48:51],a[8:11]
v_mov_b32 v18, 0
v_mov_b32 v19, 0
M a[8:11],a[164:167],a[52:55],a[8:11]
v_mov_b32 v20, 0
v_mov_b32 v21, 0
M a[12:15],a[164:167],a[60:63],a[12:15]
T a[100:101],v1,8192
T a[102:103],v1,9216
M a[12:15],a[160:163],a[56:59],a[12:15]
v_mov_b32 v22, 0
v_mov_b32 v23, 0
M a[16:19],a[160:163],a[64:67],a[16:19]
buffer_load_dwordx4 v13, s[48:51], s22 offen offset:1024   lds
M a[16:19],a[164:167],a[68:71],a[16:19]
G v28,a192
G v29,a196
M a[20:23],a[164:167],a[76:79],a[20:23]
v_lshlrev_b32 v24, 16, v28
v_lshlrev_b32 v25, 16, v29
M a[20:23],a[160:163],a[72:75],a[20:23]
T a[104:105],v2,0
T a[106:107],v2,1024
M a[24:27],a[160:163],a[80:83],a[24:27]
v_and_b32 v28, 0xffff0000, v28
v_and_b32 v29, 0xffff0000, v29
M a[24:27],a[164:167],a[84:87],a[24:27]
s_waitcnt lgkmcnt(6)
buffer_load_dwordx4 v14, s[48:51], s22 offen offset:2048   lds
M a[28:31],a[164:167],a[92:95],a[28:31]
G v30,a176
v_lshlrev_b32 v31, 16, v30
M a[28:31],a[160:163],a[88:91],a[28:31]
v_and_b32 v30, 0xffff0000, v30
v_fmac_f32 v16, v31, v24
M v[32:35],a[168:171],a[32:35],v[32:35]
R a[160:163],v5,36864
R a[164:167],v6,36864
M v[32:35],a[172:175],a[36:39],v[32:35]
T a[108:109],v2,8192
T a[110:111],v2,9216
M v[36:39],a[172:175],a[44:47],v[36:39]
buffer_load_dwordx4 v15, s[48:51], s22 offen offset:3072   lds
M v[36:39],a[168:171],a[40:43],v[36:39]
s_sub_u32 s22, s22, 1048448
v_fmac_f32 v20, v31, v25
v_fmac_f32 v16, v30, v28
M v[40:43],a[168:171],a[48:51],v[40:43]
v_fmac_f32 v20, v30, v29
G v30,a180
M v[40:43],a[172:175],a[52:55],v[40:43]
T a[112:113],v3,0
T a[114:115],v3,1024
M v[44:47],a[172:175],a[60:63],v[44:47]
SA m0,s23,49152
v_lshlrev_b32 v31, 16, v30
v_and_b32 v30, 0xffff0000, v30
M v[44:47],a[168:171],a[56:59],v[44:47]
buffer_load_dwordx4 v8, s[16:19], s21 offen offset:0  nt lds
M v[48:51],a[168:171],a[64:67],v[48:51]
v_fmac_f32 v17, v31, v24
v_fmac_f32 v21, v31, v25
M v[48:51],a[172:175],a[68:71],v[48:51]
v_fmac_f32 v17, v30, v28
v_fmac_f32 v21, v30, v29
M v[52:55],a[172:175],a[76:79],v[52:55]
T a[116:117],v3,8192
T a[118:119],v3,9216
M v[52:55],a[168:171],a[72:75],v[52:55]
G v30,a184
v_lshlrev_b32 v31, 16, v30
M v[56:59],a[168:171],a[80:83],v[56:59]
buffer_load_dwordx4 v9, s[16:19], s21 offen offset:1024  nt lds
M v[56:59],a[172:175],a[84:87],v[56:59]
s_waitcnt lgkmcnt(6)
v_and_b32 v30, 0xffff0000, v30
v_fmac_f32 v18, v31, v24
M v[60:63],a[172:175],a[92:95],v[60:63]
v_fmac_f32 v22, v31, v25
v_fmac_f32 v18, v30, v28
M v[60:63],a[168:171],a[88:91],v[60:63]
T a[120:121],v4,0
T a[122:123],v4,1024
M v[64:67],a[160:163],a[32:35],v[64:67]
R a[168:171],v5,38912
R a[172:175],v6,38912
M v[64:67],a[164:167],a[36:39],v[64:67]
buffer_load_dwordx4 v10, s[16:19], s21 offen offset:2048  nt lds
M v[68:71],a[164:167],a[44:47],v[68:71]
v_fmac_f32 v22, v30, v29
G v30,a188
M v[68:71],a[160:163],a[40:43],v[68:71]
v_lshlrev_b32 v31, 16, v30
v_and_b32 v30, 0xffff0000, v30
M v[72:75],a[160:163],a[48:51],v[72:75]
T a[124:125],v4,8192
T a[126:127],v4,9216
M v[72:75],a[164:167],a[52:55],v[72:75]
v_fmac_f32 v19, v31, v24
v_fmac_f32 v23, v31, v25
M v[76:79],a[164:167],a[60:63],v[76:79]
buffer_load_dwordx4 v11, s[16:19], s21 offen offset:3072  nt lds
M v[76:79],a[160:163],a[56:59],v[76:79]
SA s21,s21,524160
v_fmac_f32 v19, v30, v28
v_fmac_f32 v23, v30, v29
M v[80:83],a[160:163],a[64:67],v[80:83]
G v28,a193
G v29,a197
M v[80:83],a[164:167],a[68:71],v[80:83]
v_lshlrev_b32 v24, 16, v28
v_lshlrev_b32 v25, 16, v29
M v[84:87],a[164:167],a[76:79],v[84:87]
v_and_b32 v28, 0xffff0000, v28
v_and_b32 v29, 0xffff0000, v29
M v[84:87],a[160:163],a[72:75],v[84:87]
G v30,a177
v_lshlrev_b32 v31, 16, v30
M v[88:91],a[160:163],a[80:83],v[88:91]
v_and_b32 v30, 0xffff0000, v30
v_fmac_f32 v16, v31, v24
M v[88:91],a[164:167],a[84:87],v[88:91]
s_waitcnt lgkmcnt(2)
v_fmac_f32 v20, v31, v25
v_fmac_f32 v16, v30, v28
M v[92:95],a[164:167],a[92:95],v[92:95]
s_waitcnt vmcnt(16) lgkmcnt(0)
v_fmac_f32 v20, v30, v29
G v30,a181
M v[92:95],a[160:163],a[88:91],v[92:95]
s_barrier
M v[96:99],a[168:171],a[32:35],v[96:99]
R a[160:163],v5,49152
R a[164:167],v6,49152
M v[96:99],a[172:175],a[36:39],v[96:99]
v_lshlrev_b32 v31, 16, v30
v_and_b32 v30, 0xffff0000, v30
M v[100:103],a[172:175],a[44:47],v[100:103]
SA m0,s24,32768
T a[128:129],v1,16384
T a[130:131],v1,17408
M v[100:103],a[168:171],a[40:43],v[100:103]
buffer_load_dwordx4 v12, s[48:51], s22 offen offset:0   lds
M v[104:107],a[168:171],a[48:51],v[104:107]
v_fmac_f32 v17, v31, v24
v_fmac_f32 v21, v31, v25
M v[104:107],a[172:175],a[52:55],v[104:107]
v_fmac_f32 v17, v30, v28
v_fmac_f32 v21, v30, v29
M v[108:111],a[172:175],a[60:63],v[108:111]
G v30,a185
v_lshlrev_b32 v31, 16, v30
M v[108:111],a[168:171],a[56:59],v[108:111]
v_and_b32 v30, 0xffff0000, v30
v_fmac_f32 v18, v31, v24
M v[112:115],a[168:171],a[64:67],v[112:115]
v_fmac_f32 v22, v31, v25
v_fmac_f32 v18, v30, v28
M v[112:115],a[172:175],a[68:71],v[112:115]
T a[132:133],v1,24576
T a[134:135],v1,25600
M v[116:119],a[172:175],a[76:79],v[116:119]
buffer_load_dwordx4 v13, s[48:51], s22 offen offset:1024   lds
M v[116:119],a[168:171],a[72:75],v[116:119]
v_fmac_f32 v22, v30, v29
G v30,a189
M v[120:123],a[168:171],a[80:83],v[120:123]
v_lshlrev_b32 v31, 16, v30
v_and_b32 v30, 0xffff0000, v30
M v[120:123],a[172:175],a[84:87],v[120:123]
s_waitcnt lgkmcnt(4)
v_fmac_f32 v19, v31, v24
v_fmac_f32 v23, v31, v25
M v[124:127],a[172:175],a[92:95],v[124:127]
v_fmac_f32 v19, v30, v28
v_fmac_f32 v23, v30, v29
M v[124:127],a[168:171],a[88:91],v[124:127]
G v28,a194
G v29,a198
M v[128:131],a[160:163],a[32:35],v[128:131]
R a[168:171],v5,51200
R a[172:175],v6,51200
M v[128:131],a[164:167],a[36:39],v[128:131]
T a[136:137],v2,16384
T a[138:139],v2,17408
M v[132:135],a[164:167],a[44:47],v[132:135]
buffer_load_dwordx4 v14, s[48:51], s22 offen offset:2048   lds
M v[132:135],a[160:163],a[40:43],v[132:135]
v_lshlrev_b32 v24, 16, v28
v_lshlrev_b32 v25, 16, v29
M v[136:139],a[160:163],a[48:51],v[136:139]
v_and_b32 v28, 0xffff0000, v28
v_and_b32 v29, 0xffff0000, v29
M v[136:139],a[164:167],a[52:55],v[136:139]
G v30,a178
v_lshlrev_b32 v31, 16, v30
M v[140:143],a[164:167],a[60:63],v[140:143]
v_and_b32 v30, 0xffff0000, v30
v_fmac_f32 v16, v31, v24
M v[140:143],a[160:163],a[56:59],v[140:143]
T a[140:141],v2,24576
T a[142:143],v2,25600
M v[144:147],a[160:163],a[64:67],v[144:147]
buffer_load_dwordx4 v15, s[48:51], s22 offen offset:3072   lds
M v[144:147],a[164:167],a[68:71],v[144:147]
SA s22,s22,1048576
v_fmac_f32 v20, v31, v25
v_fmac_f32 v16, v30, v28
M v[148:151],a[164:167],a[76:79],v[148:151]
v_fmac_f32 v20, v30, v29
G v30,a182
M v[148:151],a[160:163],a[72:75],v[148:151]
v_lshlrev_b32 v31, 16, v30
v_and_b32 v30, 0xffff0000, v30
M v[152:155],a[160:163],a[80:83],v[152:155]
v_fmac_f32 v17, v31, v24
v_fmac_f32 v21, v31, v25
M v[152:155],a[164:167],a[84:87],v[152:155]
s_waitcnt lgkmcnt(4)
v_fmac_f32 v17, v30, v28
v_fmac_f32 v21, v30, v29
M v[156:159],a[164:167],a[92:95],v[156:159]
SA m0,s23,0
T a[144:145],v3,16384
T a[146:147],v3,17408
M v[156:159],a[160:163],a[88:91],v[156:159]
buffer_load_dwordx4 v8, s[16:19], s21 offen offset:0  nt lds
M v[160:163],a[168:171],a[32:35],v[160:163]
R a[160:163],v5,53248
R a[164:167],v6,53248
M v[160:163],a[172:175],a[36:39],v[160:163]
G v30,a186
v_lshlrev_b32 v31, 16, v30
M v[164:167],a[172:175],a[44:47],v[164:167]
v_and_b32 v30, 0xffff0000, v30
v_fmac_f32 v18, v31, v24
M v[164:167],a[168:171],a[40:43],v[164:167]
v_fmac_f32 v22, v31, v25
v_fmac_f32 v18, v30, v28
M v[168:171],a[168:171],a[48:51],v[168:171]
v_fmac_f32 v22, v30, v29
G v30,a190
M v[168:171],a[172:175],a[52:55],v[168:171]
L_w_kv11:
s_cbranch_execz L_w_kv15
T a[148:149],v3,24576
T a[150:151],v3,25600
M v[172:175],a[172:175],a[60:63],v[172:175]
buffer_load_dwordx4 v9, s[16:19], s21 offen offset:1024  nt lds
M v[172:175],a[168:171],a[56:59],v[172:175]
v_lshlrev_b32 v31, 16, v30
v_and_b32 v30, 0xffff0000, v30
M v[176:179],a[168:171],a[64:67],v[176:179]
v_fmac_f32 v19, v31, v24
v_fmac_f32 v23, v31, v25
M v[176:179],a[172:175],a[68:71],v[176:179]
v_fmac_f32 v19, v30, v28
v_fmac_f32 v23, v30, v29
M v[180:183],a[172:175],a[76:79],v[180:183]
M v[180:183],a[168:171],a[72:75],v[180:183]
M v[184:187],a[168:171],a[80:83],v[184:187]
s_nop 0
T a[152:153],v4,16384
T a[154:155],v4,17408
M v[184:187],a[172:175],a[84:87],v[184:187]
s_waitcnt lgkmcnt(4)
buffer_load_dwordx4 v10, s[16:19], s21 offen offset:2048  nt lds
M v[188:191],a[172:175],a[92:95],v[188:191]
M v[188:191],a[168:171],a[88:91],v[188:191]
M v[192:195],a[160:163],a[32:35],v[192:195]
R a[168:171],v5,55296
R a[172:175],v6,55296
M v[192:195],a[164:167],a[36:39],v[192:195]
M v[196:199],a[164:167],a[44:47],v[196:199]
M v[196:199],a[160:163],a[40:43],v[196:199]
s_nop 0
T a[156:157],v4,24576
T a[158:159],v4,25600
M v[200:203],a[160:163],a[48:51],v[200:203]
buffer_load_dwordx4 v11, s[16:19], s21 offen offset:3072  nt lds
M v[200:203],a[164:167],a[52:55],v[200:203]
SA s21,s21,128
M v[204:207],a[164:167],a[60:63],v[204:207]
M v[204:207],a[160:163],a[56:59],v[204:207]
M v[208:211],a[160:163],a[64:67],v[208:211]
M v[208:211],a[164:167],a[68:71],v[208:211]
M v[212:215],a[164:167],a[76:79],v[212:215]
M v[212:215],a[160:163],a[72:75],v[212:215]
M v[216:219],a[160:163],a[80:83],v[216:219]
M v[216:219],a[164:167],a[84:87],v[216:219]
s_waitcnt lgkmcnt(2)
M v[220:223],a[164:167],a[92:95],v[220:223]
s_waitcnt vmcnt(16) lgkmcnt(0)
M v[220:223],a[160:163],a[88:91],v[220:223]
s_barrier
M v[224:227],a[168:171],a[32:35],v[224:227]
R a[160:163],v5,0
R a[164:167],v6,0
M v[224:227],a[172:175],a[36:39],v[224:227]
M v[228:231],a[172:175],a[44:47],v[228:231]
M v[228:231],a[168:171],a[40:43],v[228:231]
M v[232:235],a[168:171],a[48:51],v[232:235]
M v[232:235],a[172:175],a[52:55],v[232:235]
M v[236:239],a[172:175],a[60:63],v[236:239]
M v[236:239],a[168:171],a[56:59],v[236:239]
M v[240:243],a[168:171],a[64:67],v[240:243]
M v[240:243],a[172:175],a[68:71],v[240:243]
M v[244:247],a[172:175],a[76:79],v[244:247]
M v[244:247],a[168:171],a[72:75],v[244:247]
M v[248:251],a[168:171],a[80:83],v[248:251]
M v[248:251],a[172:175],a[84:87],v[248:251]
s_waitcnt lgkmcnt(0)
M v[252:255],a[172:175],a[92:95],v[252:255]
M v[252:255],a[168:171],a[88:91],v[252:255]
M a[0:3],a[160:163],a[96:99],a[0:3]
R a[168:171],v5,2048
R a[172:175],v6,2048
M a[0:3],a[164:167],a[100:103],a[0:3]
T a[32:33],v1,32768
T a[34:35],v1,33792
M a[4:7],a[164:167],a[108:111],a[4:7]
SA m0,s24,49152
G v28,a195
G v29,a199
M a[4:7],a[160:163],a[104:107],a[4:7]
buffer_load_dwordx4 v12, s[48:51], s22 offen offset:0   lds
M a[8:11],a[160:163],a[112:115],a[8:11]
v_lshlrev_b32 v24, 16, v28
v_lshlrev_b32 v25, 16, v29
M a[8:11],a[164:167],a[116:119],a[8:11]
v_and_b32 v28, 0xffff0000, v28
v_and_b32 v29, 0xffff0000, v29
M a[12:15],a[164:167],a[124:127],a[12:15]
T a[36:37],v1,40960
T a[38:39],v1,41984
M a[12:15],a[160:163],a[120:123],a[12:15]
G v30,a179
v_lshlrev_b32 v31, 16, v30
M a[16:19],a[160:163],a[128:131],a[16:19]
buffer_load_dwordx4 v13, s[48:51], s22 offen offset:1024   lds
M a[16:19],a[164:167],a[132:135],a[16:19]
v_and_b32 v30, 0xffff0000, v30
v_fmac_f32 v16, v31, v24
M a[20:23],a[164:167],a[140:143],a[20:23]
v_fmac_f32 v20, v31, v25
v_fmac_f32 v16, v30, v28
M a[20:23],a[160:163],a[136:139],a[20:23]
T a[40:41],v2,32768
T a[42:43],v2,33792
M a[24:27],a[160:163],a[144:147],a[24:27]
v_fmac_f32 v20, v30, v29
G v30,a183
M a[24:27],a[164:167],a[148:151],a[24:27]
s_waitcnt lgkmcnt(6)
buffer_load_dwordx4 v14, s[48:51], s22 offen offset:2048   lds
M a[28:31],a[164:167],a[156:159],a[28:31]
v_lshlrev_b32 v31, 16, v30
v_and_b32 v30, 0xffff0000, v30
M a[28:31],a[160:163],a[152:155],a[28:31]
v_fmac_f32 v17, v31, v24
v_fmac_f32 v21, v31, v25
M v[32:35],a[168:171],a[96:99],v[32:35]
R a[160:163],v5,4096
R a[164:167],v6,4096
M v[32:35],a[172:175],a[100:103],v[32:35]
T a[44:45],v2,40960
T a[46:47],v2,41984
M v[36:39],a[172:175],a[108:111],v[36:39]
buffer_load_dwordx4 v15, s[48:51], s22 offen offset:3072   lds
M v[36:39],a[168:171],a[104:107],v[36:39]
s_sub_u32 s22, s22, 1048448
v_fmac_f32 v17, v30, v28
v_fmac_f32 v21, v30, v29
M v[40:43],a[168:171],a[112:115],v[40:43]
G v30,a187
v_lshlrev_b32 v31, 16, v30
M v[40:43],a[172:175],a[116:119],v[40:43]
T a[48:49],v3,32768
T a[50:51],v3,33792
M v[44:47],a[172:175],a[124:127],v[44:47]
SA m0,s23,16384
v_and_b32 v30, 0xffff0000, v30
v_fmac_f32 v18, v31, v24
M v[44:47],a[168:171],a[120:123],v[44:47]
buffer_load_dwordx4 v8, s[16:19], s21 offen offset:0  nt lds
M v[48:51],a[168:171],a[128:131],v[48:51]
v_fmac_f32 v22, v31, v25
v_fmac_f32 v18, v30, v28
M v[48:51],a[172:175],a[132:135],v[48:51]
v_fmac_f32 v22, v30, v29
G v30,a191
M v[52:55],a[172:175],a[140:143],v[52:55]
T a[52:53],v3,40960
T a[54:55],v3,41984
M v[52:55],a[168:171],a[136:139],v[52:55]
v_lshlrev_b32 v31, 16, v30
v_and_b32 v30, 0xffff0000, v30
M v[56:59],a[168:171],a[144:147],v[56:59]
buffer_load_dwordx4 v9, s[16:19], s21 offen offset:1024  nt lds
M v[56:59],a[172:175],a[148:151],v[56:59]
s_waitcnt lgkmcnt(6)
v_fmac_f32 v19, v31, v24
v_fmac_f32 v23, v31, v25
M v[60:63],a[172:175],a[156:159],v[60:63]
v_fmac_f32 v19, v30, v28
v_fmac_f32 v23, v30, v29
M v[60:63],a[168:171],a[152:155],v[60:63]
T a[56:57],v4,32768
T a[58:59],v4,33792
M v[64:67],a[160:163],a[96:99],v[64:67]
R a[168:171],v5,6144
R a[172:175],v6,6144
M v[64:67],a[164:167],a[100:103],v[64:67]
buffer_load_dwordx4 v10, s[16:19], s21 offen offset:2048  nt lds
M v[68:71],a[164:167],a[108:111],v[68:71]
v_permlane32_swap_b32 v16, v18
M v[68:71],a[160:163],a[104:107],v[68:71]
v_permlane32_swap_b32 v17, v19
M v[72:75],a[160:163],a[112:115],v[72:75]
s_nop 0
T a[60:61],v4,40960
T a[62:63],v4,41984
M v[72:75],a[164:167],a[116:119],v[72:75]
v_permlane32_swap_b32 v20, v22
M v[76:79],a[164:167],a[124:127],v[76:79]
buffer_load_dwordx4 v11, s[16:19], s21 offen offset:3072  nt lds
M v[76:79],a[160:163],a[120:123],v[76:79]
SA s21,s21,524160
v_permlane32_swap_b32 v21, v23
M v[80:83],a[160:163],a[128:131],v[80:83]
AF v16,v16,v18
AF v17,v17,v19
M v[80:83],a[164:167],a[132:135],v[80:83]
AF v20,v20,v22
AF v21,v21,v23
M v[84:87],a[164:167],a[140:143],v[84:87]
v_lshrrev_b32 v28, 4, v0
M v[84:87],a[160:163],a[136:139],v[84:87]
v_permlane16_swap_b32 v16, v17
M v[88:91],a[160:163],a[144:147],v[88:91]
v_permlane16_swap_b32 v20, v21
M v[88:91],a[164:167],a[148:151],v[88:91]
s_waitcnt lgkmcnt(2)
AF v16,v16,v17
AF v20,v20,v21
M v[92:95],a[164:167],a[156:159],v[92:95]
s_waitcnt vmcnt(16) lgkmcnt(0)
v_add_u32 v29, s67, v28
v_add_f32 v16, v16, v16 row_ror:8 row_mask:0xf bank_mask:0xf
M v[92:95],a[160:163],a[152:155],v[92:95]
s_barrier
M v[96:99],a[168:171],a[96:99],v[96:99]
R a[160:163],v5,16384
R a[164:167],v6,16384
M v[96:99],a[172:175],a[100:103],v[96:99]
v_add_f32 v20, v20, v20 row_ror:8 row_mask:0xf bank_mask:0xf
v_add_f32 v16, v16, v16 row_ror:4 row_mask:0xf bank_mask:0xf
M v[100:103],a[172:175],a[108:111],v[100:103]
SA m0,s24,0
T a[64:65],v1,49152
T a[66:67],v1,50176
M v[100:103],a[168:171],a[104:107],v[100:103]
buffer_load_dwordx4 v12, s[48:51], s22 offen offset:0   lds
M v[104:107],a[168:171],a[112:115],v[104:107]
v_add_f32 v20, v20, v20 row_ror:4 row_mask:0xf bank_mask:0xf
v_add_f32 v16, v16, v16 row_ror:2 row_mask:0xf bank_mask:0xf
M v[104:107],a[172:175],a[116:119],v[104:107]
v_add_f32 v20, v20, v20 row_ror:2 row_mask:0xf bank_mask:0xf
v_add_f32 v16, v16, v16 row_ror:1 row_mask:0xf bank_mask:0xf
M v[108:111],a[172:175],a[124:127],v[108:111]
v_add_f32 v20, v20, v20 row_ror:1 row_mask:0xf bank_mask:0xf
v_ashrrev_i32 v30, 31, v16
M v[108:111],a[168:171],a[120:123],v[108:111]
v_or_b32 v30, 0x80000000, v30
v_xor_b32 v30, v30, v16
M v[112:115],a[168:171],a[128:131],v[112:115]
v_and_b32 v30, 0xfffff800, v30
v_sub_u32 v29, 2047, v29
M v[112:115],a[172:175],a[132:135],v[112:115]
T a[68:69],v1,57344
T a[70:71],v1,58368
M v[116:119],a[172:175],a[140:143],v[116:119]
buffer_load_dwordx4 v13, s[48:51], s22 offen offset:1024   lds
M v[116:119],a[168:171],a[136:139],v[116:119]
v_or_b32 v30, v30, v29
v_max_u32 v30, 1, v30
M v[120:123],a[168:171],a[144:147],v[120:123]
MF v21,0xbfb8aa3b,v20
M v[120:123],a[172:175],a[148:151],v[120:123]
s_waitcnt lgkmcnt(4)
E v21,v21
M v[124:127],a[172:175],a[156:159],v[124:127]
AF v21,1.0,v21
M v[124:127],a[168:171],a[152:155],v[124:127]
v_rcp_f32 v20, v21
M v[128:131],a[160:163],a[96:99],v[128:131]
s_lshl_b32 s72, s20, 4
R a[168:171],v5,18432
R a[172:175],v6,18432
M v[128:131],a[164:167],a[100:103],v[128:131]
SA s72,s72,163584
T a[72:73],v2,49152
T a[74:75],v2,50176
M v[132:135],a[164:167],a[108:111],v[132:135]
buffer_load_dwordx4 v14, s[48:51], s22 offen offset:2048   lds
M v[132:135],a[160:163],a[104:107],v[132:135]
v_lshl_add_u32 v28, v28, 2, s72
ds_write_b32 v28, v30
M v[136:139],a[160:163],a[112:115],v[136:139]
ds_write_b32 v28, v16 offset:64
ds_write_b32 v28, v20 offset:128
M v[136:139],a[164:167],a[116:119],v[136:139]
M v[140:143],a[164:167],a[124:127],v[140:143]
M v[140:143],a[160:163],a[120:123],v[140:143]
s_nop 0
T a[76:77],v2,57344
T a[78:79],v2,58368
M v[144:147],a[160:163],a[128:131],v[144:147]
buffer_load_dwordx4 v15, s[48:51], s22 offen offset:3072   lds
M v[144:147],a[164:167],a[132:135],v[144:147]
SA s22,s22,1048576
M v[148:151],a[164:167],a[140:143],v[148:151]
M v[148:151],a[160:163],a[136:139],v[148:151]
M v[152:155],a[160:163],a[144:147],v[152:155]
M v[152:155],a[164:167],a[148:151],v[152:155]
s_waitcnt lgkmcnt(7)
M v[156:159],a[164:167],a[156:159],v[156:159]
SA m0,s23,32768
T a[80:81],v3,49152
T a[82:83],v3,50176
M v[156:159],a[160:163],a[152:155],v[156:159]
buffer_load_dwordx4 v8, s[16:19], s21 offen offset:0  nt lds
M v[160:163],a[168:171],a[96:99],v[160:163]
R a[160:163],v5,20480
R a[164:167],v6,20480
M v[160:163],a[172:175],a[100:103],v[160:163]
M v[164:167],a[172:175],a[108:111],v[164:167]
M v[164:167],a[168:171],a[104:107],v[164:167]
M v[168:171],a[168:171],a[112:115],v[168:171]
M v[168:171],a[172:175],a[116:119],v[168:171]
s_nop 0
T a[84:85],v3,57344
T a[86:87],v3,58368
M v[172:175],a[172:175],a[124:127],v[172:175]
buffer_load_dwordx4 v9, s[16:19], s21 offen offset:1024  nt lds
M v[172:175],a[168:171],a[120:123],v[172:175]
M v[176:179],a[168:171],a[128:131],v[176:179]
M v[176:179],a[172:175],a[132:135],v[176:179]
M v[180:183],a[172:175],a[140:143],v[180:183]
M v[180:183],a[168:171],a[136:139],v[180:183]
M v[184:187],a[168:171],a[144:147],v[184:187]
s_nop 0
T a[88:89],v4,49152
T a[90:91],v4,50176
M v[184:187],a[172:175],a[148:151],v[184:187]
s_waitcnt lgkmcnt(4)
buffer_load_dwordx4 v10, s[16:19], s21 offen offset:2048  nt lds
M v[188:191],a[172:175],a[156:159],v[188:191]
M v[188:191],a[168:171],a[152:155],v[188:191]
M v[192:195],a[160:163],a[96:99],v[192:195]
R a[168:171],v5,22528
R a[172:175],v6,22528
M v[192:195],a[164:167],a[100:103],v[192:195]
M v[196:199],a[164:167],a[108:111],v[196:199]
M v[196:199],a[160:163],a[104:107],v[196:199]
s_nop 0
T a[92:93],v4,57344
T a[94:95],v4,58368
M v[200:203],a[160:163],a[112:115],v[200:203]
buffer_load_dwordx4 v11, s[16:19], s21 offen offset:3072  nt lds
M v[200:203],a[164:167],a[116:119],v[200:203]
SA s21,s21,128
M v[204:207],a[164:167],a[124:127],v[204:207]
M v[204:207],a[160:163],a[120:123],v[204:207]
M v[208:211],a[160:163],a[128:131],v[208:211]
M v[208:211],a[164:167],a[132:135],v[208:211]
M v[212:215],a[164:167],a[140:143],v[212:215]
M v[212:215],a[160:163],a[136:139],v[212:215]
M v[216:219],a[160:163],a[144:147],v[216:219]
M v[216:219],a[164:167],a[148:151],v[216:219]
s_waitcnt lgkmcnt(2)
M v[220:223],a[164:167],a[156:159],v[220:223]
s_waitcnt vmcnt(16) lgkmcnt(0)
M v[220:223],a[160:163],a[152:155],v[220:223]
s_barrier
M v[224:227],a[168:171],a[96:99],v[224:227]
R a[160:163],v5,32768
R a[164:167],v6,32768
M v[224:227],a[172:175],a[100:103],v[224:227]
M v[228:231],a[172:175],a[108:111],v[228:231]
M v[228:231],a[168:171],a[104:107],v[228:231]
M v[232:235],a[168:171],a[112:115],v[232:235]
M v[232:235],a[172:175],a[116:119],v[232:235]
M v[236:239],a[172:175],a[124:127],v[236:239]
M v[236:239],a[168:171],a[120:123],v[236:239]
M v[240:243],a[168:171],a[128:131],v[240:243]
M v[240:243],a[172:175],a[132:135],v[240:243]
M v[244:247],a[172:175],a[140:143],v[244:247]
M v[244:247],a[168:171],a[136:139],v[244:247]
M v[248:251],a[168:171],a[144:147],v[248:251]
M v[248:251],a[172:175],a[148:151],v[248:251]
s_waitcnt lgkmcnt(0)
M v[252:255],a[172:175],a[156:159],v[252:255]
M v[252:255],a[168:171],a[152:155],v[252:255]
M a[0:3],a[160:163],a[32:35],a[0:3]
R a[168:171],v5,34816
R a[172:175],v6,34816
M a[0:3],a[164:167],a[36:39],a[0:3]
T a[96:97],v1,0
T a[98:99],v1,1024
M a[4:7],a[164:167],a[44:47],a[4:7]
SA m0,s24,16384
M a[4:7],a[160:163],a[40:43],a[4:7]
buffer_load_dwordx4 v12, s[48:51], s22 offen offset:0   lds
M a[8:11],a[160:163],a[48:51],a[8:11]
v_and_b32 v20, 31, v0
M a[8:11],a[164:167],a[52:55],a[8:11]
v_lshlrev_b32 v20, 2, v20
M a[12:15],a[164:167],a[60:63],a[12:15]
s_nop 0
T a[100:101],v1,8192
T a[102:103],v1,9216
M a[12:15],a[160:163],a[56:59],a[12:15]
v_add_u32 v21, 163584, v20
M a[16:19],a[160:163],a[64:67],a[16:19]
buffer_load_dwordx4 v13, s[48:51], s22 offen offset:1024   lds
M a[16:19],a[164:167],a[68:71],a[16:19]
ds_read_b32 v19, v21
M a[20:23],a[164:167],a[76:79],a[20:23]
ds_read_b32 v21, v21 offset:64
M a[20:23],a[160:163],a[72:75],a[20:23]
s_min_u32 s64, s20, 1
T a[104:105],v2,0
T a[106:107],v2,1024
M a[24:27],a[160:163],a[80:83],a[24:27]
s_lshl_b32 s64, s64, 29
v_and_b32 v22, 32, v0
M a[24:27],a[164:167],a[84:87],a[24:27]
s_waitcnt lgkmcnt(8)
buffer_load_dwordx4 v14, s[48:51], s22 offen offset:2048   lds
M a[28:31],a[164:167],a[92:95],a[28:31]
v_lshl_or_b32 v20, v22, 24, v20
M a[28:31],a[160:163],a[88:91],a[28:31]
v_or_b32 v20, s64, v20
M v[32:35],a[168:171],a[32:35],v[32:35]
R a[160:163],v5,36864
R a[164:167],v6,36864
M v[32:35],a[172:175],a[36:39],v[32:35]
T a[108:109],v2,8192
T a[110:111],v2,9216
M v[36:39],a[172:175],a[44:47],v[36:39]
buffer_load_dwordx4 v15, s[48:51], s22 offen offset:3072   lds
M v[36:39],a[168:171],a[40:43],v[36:39]
s_sub_u32 s22, s22, 1048448
v_and_b32 v22, 16, v0
M v[40:43],a[168:171],a[48:51],v[40:43]
v_lshl_or_b32 v18, v22, 25, v20
s_and_b32 s27, s42, 7
M v[40:43],a[172:175],a[52:55],v[40:43]
s_lshl_b32 s72, s30, 7
T a[112:113],v3,0
T a[114:115],v3,1024
M v[44:47],a[172:175],a[60:63],v[44:47]
SA m0,s23,49152
SA s72,s72,104857600
s_lshl_b32 s64, s41, 3
M v[44:47],a[168:171],a[56:59],v[44:47]
SA s27,s27,s64
buffer_load_dwordx4 v8, s[16:19], s21 offen offset:0  nt lds
M v[48:51],a[168:171],a[64:67],v[48:51]
s_lshl_b32 s27, s27, 2
M v[48:51],a[172:175],a[68:71],v[48:51]
SA s27,s27,s20
M v[52:55],a[172:175],a[76:79],v[52:55]
s_mul_i32 s27, s27, 7168
T a[116:117],v3,8192
T a[118:119],v3,9216
M v[52:55],a[168:171],a[72:75],v[52:55]
s_mov_b32 s60, s90
M v[56:59],a[168:171],a[80:83],v[56:59]
s_and_b32 s61, s91, 0xffff
buffer_load_dwordx4 v9, s[16:19], s21 offen offset:1024  nt lds
M v[56:59],a[172:175],a[84:87],v[56:59]
s_waitcnt lgkmcnt(6)
buffer_store_dword v21, v20, s[8:11], s72 offen sc1
M v[60:63],a[172:175],a[92:95],v[60:63]
s_mov_b32 s62, 3670016
M v[60:63],a[168:171],a[88:91],v[60:63]
s_mov_b32 s63, 0x20000
T a[120:121],v4,0
T a[122:123],v4,1024
M v[64:67],a[160:163],a[32:35],v[64:67]
R a[168:171],v5,38912
R a[172:175],v6,38912
M v[64:67],a[164:167],a[36:39],v[64:67]
buffer_load_dwordx4 v10, s[16:19], s21 offen offset:2048  nt lds
M v[68:71],a[164:167],a[44:47],v[68:71]
M v[68:71],a[160:163],a[40:43],v[68:71]
M v[72:75],a[160:163],a[48:51],v[72:75]
s_nop 0
T a[124:125],v4,8192
T a[126:127],v4,9216
M v[72:75],a[164:167],a[52:55],v[72:75]
M v[76:79],a[164:167],a[60:63],v[76:79]
buffer_load_dwordx4 v11, s[16:19], s21 offen offset:3072  nt lds
M v[76:79],a[160:163],a[56:59],v[76:79]
SA s21,s21,524160
M v[80:83],a[160:163],a[64:67],v[80:83]
M v[80:83],a[164:167],a[68:71],v[80:83]
M v[84:87],a[164:167],a[76:79],v[84:87]
M v[84:87],a[160:163],a[72:75],v[84:87]
M v[88:91],a[160:163],a[80:83],v[88:91]
M v[88:91],a[164:167],a[84:87],v[88:91]
s_waitcnt lgkmcnt(2)
M v[92:95],a[164:167],a[92:95],v[92:95]
s_waitcnt vmcnt(17) lgkmcnt(0)
M v[92:95],a[160:163],a[88:91],v[92:95]
s_barrier
M v[96:99],a[168:171],a[32:35],v[96:99]
R a[160:163],v5,49152
R a[164:167],v6,49152
M v[96:99],a[172:175],a[36:39],v[96:99]
M v[100:103],a[172:175],a[44:47],v[100:103]
SA m0,s24,32768
T a[128:129],v1,16384
T a[130:131],v1,17408
M v[100:103],a[168:171],a[40:43],v[100:103]
buffer_load_dwordx4 v12, s[48:51], s22 offen offset:0   lds
M v[104:107],a[168:171],a[48:51],v[104:107]
v_min_u32 v16, 40, v0
v_lshlrev_b32 v16, 2, v16
M v[104:107],a[172:175],a[52:55],v[104:107]
buffer_load_dword v17, v16, s[12:15], 0 offen sc1
M v[108:111],a[172:175],a[60:63],v[108:111]
M v[108:111],a[168:171],a[56:59],v[108:111]
M v[112:115],a[168:171],a[64:67],v[112:115]
M v[112:115],a[172:175],a[68:71],v[112:115]
s_nop 0
T a[132:133],v1,24576
T a[134:135],v1,25600
M v[116:119],a[172:175],a[76:79],v[116:119]
buffer_load_dwordx4 v13, s[48:51], s22 offen offset:1024   lds
M v[116:119],a[168:171],a[72:75],v[116:119]
M v[120:123],a[168:171],a[80:83],v[120:123]
M v[120:123],a[172:175],a[84:87],v[120:123]
s_waitcnt lgkmcnt(4)
M v[124:127],a[172:175],a[92:95],v[124:127]
M v[124:127],a[168:171],a[88:91],v[124:127]
M v[128:131],a[160:163],a[32:35],v[128:131]
R a[168:171],v5,51200
R a[172:175],v6,51200
M v[128:131],a[164:167],a[36:39],v[128:131]
T a[136:137],v2,16384
T a[138:139],v2,17408
M v[132:135],a[164:167],a[44:47],v[132:135]
buffer_load_dwordx4 v14, s[48:51], s22 offen offset:2048   lds
M v[132:135],a[160:163],a[40:43],v[132:135]
M v[136:139],a[160:163],a[48:51],v[136:139]
M v[136:139],a[164:167],a[52:55],v[136:139]
M v[140:143],a[164:167],a[60:63],v[140:143]
M v[140:143],a[160:163],a[56:59],v[140:143]
s_nop 0
T a[140:141],v2,24576
T a[142:143],v2,25600
M v[144:147],a[160:163],a[64:67],v[144:147]
buffer_load_dwordx4 v15, s[48:51], s22 offen offset:3072   lds
M v[144:147],a[164:167],a[68:71],v[144:147]
SA s22,s22,1048576
M v[148:151],a[164:167],a[76:79],v[148:151]
M v[148:151],a[160:163],a[72:75],v[148:151]
M v[152:155],a[160:163],a[80:83],v[152:155]
M v[152:155],a[164:167],a[84:87],v[152:155]
s_waitcnt lgkmcnt(4)
M v[156:159],a[164:167],a[92:95],v[156:159]
SA m0,s23,0
T a[144:145],v3,16384
T a[146:147],v3,17408
M v[156:159],a[160:163],a[88:91],v[156:159]
buffer_load_dwordx4 v8, s[16:19], s21 offen offset:0  nt lds
M v[160:163],a[168:171],a[32:35],v[160:163]
R a[160:163],v5,53248
R a[164:167],v6,53248
M v[160:163],a[172:175],a[36:39],v[160:163]
buffer_load_dword a240, v26, s[60:63], s27 offen offset:0
M v[164:167],a[172:175],a[44:47],v[164:167]
SA s27,s27,2048
M v[164:167],a[168:171],a[40:43],v[164:167]
M v[168:171],a[168:171],a[48:51],v[168:171]
M v[168:171],a[172:175],a[52:55],v[168:171]
s_nop 0
T a[148:149],v3,24576
T a[150:151],v3,25600
M v[172:175],a[172:175],a[60:63],v[172:175]
buffer_load_dwordx4 v9, s[16:19], s21 offen offset:1024  nt lds
M v[172:175],a[168:171],a[56:59],v[172:175]
M v[176:179],a[168:171],a[64:67],v[176:179]
M v[176:179],a[172:175],a[68:71],v[176:179]
M v[180:183],a[172:175],a[76:79],v[180:183]
M v[180:183],a[168:171],a[72:75],v[180:183]
M v[184:187],a[168:171],a[80:83],v[184:187]
s_nop 0
T a[152:153],v4,16384
T a[154:155],v4,17408
M v[184:187],a[172:175],a[84:87],v[184:187]
s_waitcnt lgkmcnt(4)
buffer_load_dwordx4 v10, s[16:19], s21 offen offset:2048  nt lds
M v[188:191],a[172:175],a[92:95],v[188:191]
M v[188:191],a[168:171],a[88:91],v[188:191]
M v[192:195],a[160:163],a[32:35],v[192:195]
L_w_kv12:
s_cbranch_execz L_w_kv16
R a[168:171],v5,55296
R a[172:175],v6,55296
M v[192:195],a[164:167],a[36:39],v[192:195]
M v[196:199],a[164:167],a[44:47],v[196:199]
M v[196:199],a[160:163],a[40:43],v[196:199]
s_nop 0
T a[156:157],v4,24576
T a[158:159],v4,25600
M v[200:203],a[160:163],a[48:51],v[200:203]
buffer_load_dwordx4 v11, s[16:19], s21 offen offset:3072  nt lds
M v[200:203],a[164:167],a[52:55],v[200:203]
SA s21,s21,128
M v[204:207],a[164:167],a[60:63],v[204:207]
M v[204:207],a[160:163],a[56:59],v[204:207]
M v[208:211],a[160:163],a[64:67],v[208:211]
M v[208:211],a[164:167],a[68:71],v[208:211]
M v[212:215],a[164:167],a[76:79],v[212:215]
M v[212:215],a[160:163],a[72:75],v[212:215]
M v[216:219],a[160:163],a[80:83],v[216:219]
M v[216:219],a[164:167],a[84:87],v[216:219]
s_waitcnt lgkmcnt(2)
M v[220:223],a[164:167],a[92:95],v[220:223]
s_waitcnt vmcnt(19) lgkmcnt(0)
M v[220:223],a[160:163],a[88:91],v[220:223]
s_barrier
M v[224:227],a[168:171],a[32:35],v[224:227]
R a[160:163],v5,0
R a[164:167],v6,0
M v[224:227],a[172:175],a[36:39],v[224:227]
M v[228:231],a[172:175],a[44:47],v[228:231]
M v[228:231],a[168:171],a[40:43],v[228:231]
M v[232:235],a[168:171],a[48:51],v[232:235]
M v[232:235],a[172:175],a[52:55],v[232:235]
M v[236:239],a[172:175],a[60:63],v[236:239]
M v[236:239],a[168:171],a[56:59],v[236:239]
M v[240:243],a[168:171],a[64:67],v[240:243]
M v[240:243],a[172:175],a[68:71],v[240:243]
M v[244:247],a[172:175],a[76:79],v[244:247]
M v[244:247],a[168:171],a[72:75],v[244:247]
M v[248:251],a[168:171],a[80:83],v[248:251]
M v[248:251],a[172:175],a[84:87],v[248:251]
s_waitcnt lgkmcnt(0)
M v[252:255],a[172:175],a[92:95],v[252:255]
M v[252:255],a[168:171],a[88:91],v[252:255]
M a[0:3],a[160:163],a[96:99],a[0:3]
R a[168:171],v5,2048
R a[172:175],v6,2048
M a[0:3],a[164:167],a[100:103],a[0:3]
T a[32:33],v1,32768
T a[34:35],v1,33792
M a[4:7],a[164:167],a[108:111],a[4:7]
SA m0,s24,49152
M a[4:7],a[160:163],a[104:107],a[4:7]
buffer_load_dwordx4 v12, s[48:51], s22 offen offset:0   lds
M a[8:11],a[160:163],a[112:115],a[8:11]
M a[8:11],a[164:167],a[116:119],a[8:11]
M a[12:15],a[164:167],a[124:127],a[12:15]
s_nop 0
T a[36:37],v1,40960
T a[38:39],v1,41984
M a[12:15],a[160:163],a[120:123],a[12:15]
M a[16:19],a[160:163],a[128:131],a[16:19]
buffer_load_dwordx4 v13, s[48:51], s22 offen offset:1024   lds
M a[16:19],a[164:167],a[132:135],a[16:19]
M a[20:23],a[164:167],a[140:143],a[20:23]
M a[20:23],a[160:163],a[136:139],a[20:23]
s_nop 0
T a[40:41],v2,32768
T a[42:43],v2,33792
M a[24:27],a[160:163],a[144:147],a[24:27]
M a[24:27],a[164:167],a[148:151],a[24:27]
s_waitcnt lgkmcnt(6)
buffer_load_dwordx4 v14, s[48:51], s22 offen offset:2048   lds
M a[28:31],a[164:167],a[156:159],a[28:31]
M a[28:31],a[160:163],a[152:155],a[28:31]
M v[32:35],a[168:171],a[96:99],v[32:35]
R a[160:163],v5,4096
R a[164:167],v6,4096
M v[32:35],a[172:175],a[100:103],v[32:35]
T a[44:45],v2,40960
T a[46:47],v2,41984
M v[36:39],a[172:175],a[108:111],v[36:39]
buffer_load_dwordx4 v15, s[48:51], s22 offen offset:3072   lds
M v[36:39],a[168:171],a[104:107],v[36:39]
s_sub_u32 s22, s22, 1048448
M v[40:43],a[168:171],a[112:115],v[40:43]
M v[40:43],a[172:175],a[116:119],v[40:43]
s_nop 0
T a[48:49],v3,32768
T a[50:51],v3,33792
M v[44:47],a[172:175],a[124:127],v[44:47]
SA m0,s23,16384
M v[44:47],a[168:171],a[120:123],v[44:47]
buffer_load_dwordx4 v8, s[16:19], s21 offen offset:0  nt lds
M v[48:51],a[168:171],a[128:131],v[48:51]
M v[48:51],a[172:175],a[132:135],v[48:51]
M v[52:55],a[172:175],a[140:143],v[52:55]
s_nop 0
T a[52:53],v3,40960
T a[54:55],v3,41984
M v[52:55],a[168:171],a[136:139],v[52:55]
M v[56:59],a[168:171],a[144:147],v[56:59]
buffer_load_dwordx4 v9, s[16:19], s21 offen offset:1024  nt lds
M v[56:59],a[172:175],a[148:151],v[56:59]
s_waitcnt lgkmcnt(6)
M v[60:63],a[172:175],a[156:159],v[60:63]
M v[60:63],a[168:171],a[152:155],v[60:63]
s_nop 0
T a[56:57],v4,32768
T a[58:59],v4,33792
M v[64:67],a[160:163],a[96:99],v[64:67]
R a[168:171],v5,6144
R a[172:175],v6,6144
M v[64:67],a[164:167],a[100:103],v[64:67]
buffer_load_dwordx4 v10, s[16:19], s21 offen offset:2048  nt lds
M v[68:71],a[164:167],a[108:111],v[68:71]
M v[68:71],a[160:163],a[104:107],v[68:71]
M v[72:75],a[160:163],a[112:115],v[72:75]
s_nop 0
T a[60:61],v4,40960
T a[62:63],v4,41984
M v[72:75],a[164:167],a[116:119],v[72:75]
M v[76:79],a[164:167],a[124:127],v[76:79]
buffer_load_dwordx4 v11, s[16:19], s21 offen offset:3072  nt lds
M v[76:79],a[160:163],a[120:123],v[76:79]
SA s21,s21,524160
M v[80:83],a[160:163],a[128:131],v[80:83]
M v[80:83],a[164:167],a[132:135],v[80:83]
M v[84:87],a[164:167],a[140:143],v[84:87]
M v[84:87],a[160:163],a[136:139],v[84:87]
M v[88:91],a[160:163],a[144:147],v[88:91]
M v[88:91],a[164:167],a[148:151],v[88:91]
s_waitcnt lgkmcnt(2)
M v[92:95],a[164:167],a[156:159],v[92:95]
s_waitcnt vmcnt(18) lgkmcnt(0)
M v[92:95],a[160:163],a[152:155],v[92:95]
s_barrier
M v[96:99],a[168:171],a[96:99],v[96:99]
R a[160:163],v5,16384
R a[164:167],v6,16384
M v[96:99],a[172:175],a[100:103],v[96:99]
M v[100:103],a[172:175],a[108:111],v[100:103]
SA m0,s24,0
T a[64:65],v1,49152
T a[66:67],v1,50176
M v[100:103],a[168:171],a[104:107],v[100:103]
buffer_load_dwordx4 v12, s[48:51], s22 offen offset:0   lds
M v[104:107],a[168:171],a[112:115],v[104:107]
M v[104:107],a[172:175],a[116:119],v[104:107]
M v[108:111],a[172:175],a[124:127],v[108:111]
M v[108:111],a[168:171],a[120:123],v[108:111]
M v[112:115],a[168:171],a[128:131],v[112:115]
M v[112:115],a[172:175],a[132:135],v[112:115]
s_nop 0
T a[68:69],v1,57344
T a[70:71],v1,58368
M v[116:119],a[172:175],a[140:143],v[116:119]
buffer_load_dwordx4 v13, s[48:51], s22 offen offset:1024   lds
M v[116:119],a[168:171],a[136:139],v[116:119]
M v[120:123],a[168:171],a[144:147],v[120:123]
M v[120:123],a[172:175],a[148:151],v[120:123]
s_waitcnt lgkmcnt(4)
M v[124:127],a[172:175],a[156:159],v[124:127]
M v[124:127],a[168:171],a[152:155],v[124:127]
M v[128:131],a[160:163],a[96:99],v[128:131]
R a[168:171],v5,18432
R a[172:175],v6,18432
M v[128:131],a[164:167],a[100:103],v[128:131]
T a[72:73],v2,49152
T a[74:75],v2,50176
M v[132:135],a[164:167],a[108:111],v[132:135]
buffer_load_dwordx4 v14, s[48:51], s22 offen offset:2048   lds
M v[132:135],a[160:163],a[104:107],v[132:135]
M v[136:139],a[160:163],a[112:115],v[136:139]
M v[136:139],a[164:167],a[116:119],v[136:139]
M v[140:143],a[164:167],a[124:127],v[140:143]
M v[140:143],a[160:163],a[120:123],v[140:143]
s_nop 0
T a[76:77],v2,57344
T a[78:79],v2,58368
M v[144:147],a[160:163],a[128:131],v[144:147]
buffer_load_dwordx4 v15, s[48:51], s22 offen offset:3072   lds
M v[144:147],a[164:167],a[132:135],v[144:147]
SA s22,s22,1048576
M v[148:151],a[164:167],a[140:143],v[148:151]
M v[148:151],a[160:163],a[136:139],v[148:151]
M v[152:155],a[160:163],a[144:147],v[152:155]
M v[152:155],a[164:167],a[148:151],v[152:155]
s_waitcnt lgkmcnt(4)
M v[156:159],a[164:167],a[156:159],v[156:159]
SA m0,s23,32768
T a[80:81],v3,49152
T a[82:83],v3,50176
M v[156:159],a[160:163],a[152:155],v[156:159]
buffer_load_dwordx4 v8, s[16:19], s21 offen offset:0  nt lds
M v[160:163],a[168:171],a[96:99],v[160:163]
R a[160:163],v5,20480
R a[164:167],v6,20480
M v[160:163],a[172:175],a[100:103],v[160:163]
buffer_load_dword a240, v26, s[60:63], s27 offen offset:0
M v[164:167],a[172:175],a[108:111],v[164:167]
SA s27,s27,2048
M v[164:167],a[168:171],a[104:107],v[164:167]
M v[168:171],a[168:171],a[112:115],v[168:171]
M v[168:171],a[172:175],a[116:119],v[168:171]
s_nop 0
T a[84:85],v3,57344
T a[86:87],v3,58368
M v[172:175],a[172:175],a[124:127],v[172:175]
buffer_load_dwordx4 v9, s[16:19], s21 offen offset:1024  nt lds
M v[172:175],a[168:171],a[120:123],v[172:175]
M v[176:179],a[168:171],a[128:131],v[176:179]
M v[176:179],a[172:175],a[132:135],v[176:179]
M v[180:183],a[172:175],a[140:143],v[180:183]
M v[180:183],a[168:171],a[136:139],v[180:183]
M v[184:187],a[168:171],a[144:147],v[184:187]
s_nop 0
T a[88:89],v4,49152
T a[90:91],v4,50176
M v[184:187],a[172:175],a[148:151],v[184:187]
s_waitcnt lgkmcnt(4)
buffer_load_dwordx4 v10, s[16:19], s21 offen offset:2048  nt lds
M v[188:191],a[172:175],a[156:159],v[188:191]
M v[188:191],a[168:171],a[152:155],v[188:191]
M v[192:195],a[160:163],a[96:99],v[192:195]
R a[168:171],v5,22528
R a[172:175],v6,22528
M v[192:195],a[164:167],a[100:103],v[192:195]
M v[196:199],a[164:167],a[108:111],v[196:199]
M v[196:199],a[160:163],a[104:107],v[196:199]
s_nop 0
T a[92:93],v4,57344
T a[94:95],v4,58368
M v[200:203],a[160:163],a[112:115],v[200:203]
buffer_load_dwordx4 v11, s[16:19], s21 offen offset:3072  nt lds
M v[200:203],a[164:167],a[116:119],v[200:203]
SA s21,s21,128
M v[204:207],a[164:167],a[124:127],v[204:207]
M v[204:207],a[160:163],a[120:123],v[204:207]
M v[208:211],a[160:163],a[128:131],v[208:211]
M v[208:211],a[164:167],a[132:135],v[208:211]
M v[212:215],a[164:167],a[140:143],v[212:215]
M v[212:215],a[160:163],a[136:139],v[212:215]
M v[216:219],a[160:163],a[144:147],v[216:219]
M v[216:219],a[164:167],a[148:151],v[216:219]
s_waitcnt lgkmcnt(2)
M v[220:223],a[164:167],a[156:159],v[220:223]
s_waitcnt vmcnt(17) lgkmcnt(0)
M v[220:223],a[160:163],a[152:155],v[220:223]
s_barrier
M v[224:227],a[168:171],a[96:99],v[224:227]
R a[160:163],v5,32768
R a[164:167],v6,32768
M v[224:227],a[172:175],a[100:103],v[224:227]
v_cmp_ne_u32 vcc, 1, v17
M v[228:231],a[172:175],a[108:111],v[228:231]
s_nop 0
M v[228:231],a[168:171],a[104:107],v[228:231]
s_cbranch_vccnz L_zs1
L_zr1:
M v[232:235],a[168:171],a[112:115],v[232:235]
M v[232:235],a[172:175],a[116:119],v[232:235]
s_lshl_b32 s72, s30, 6
M v[236:239],a[172:175],a[124:127],v[236:239]
SA s72,s72,104914944
M v[236:239],a[168:171],a[120:123],v[236:239]
buffer_store_dword v19, v18, s[8:11], s72 offen sc1
M v[240:243],a[168:171],a[128:131],v[240:243]
M v[240:243],a[172:175],a[132:135],v[240:243]
M v[244:247],a[172:175],a[140:143],v[244:247]
M v[244:247],a[168:171],a[136:139],v[244:247]
M v[248:251],a[168:171],a[144:147],v[248:251]
M v[248:251],a[172:175],a[148:151],v[248:251]
s_waitcnt lgkmcnt(0)
M v[252:255],a[172:175],a[156:159],v[252:255]
M v[252:255],a[168:171],a[152:155],v[252:255]
M a[0:3],a[160:163],a[32:35],a[0:3]
R a[168:171],v5,34816
R a[172:175],v6,34816
M a[0:3],a[164:167],a[36:39],a[0:3]
T a[96:97],v1,0
T a[98:99],v1,1024
M a[4:7],a[164:167],a[44:47],a[4:7]
SA m0,s24,16384
M a[4:7],a[160:163],a[40:43],a[4:7]
buffer_load_dwordx4 v12, s[48:51], s22 offen offset:0   lds
M a[8:11],a[160:163],a[48:51],a[8:11]
M a[8:11],a[164:167],a[52:55],a[8:11]
s_mul_i32 s64, s41, 229376
M a[12:15],a[164:167],a[60:63],a[12:15]
SA s72,s90,s64
T a[100:101],v1,8192
T a[102:103],v1,9216
M a[12:15],a[160:163],a[56:59],a[12:15]
s_addc_u32 s73, s91, 0
M a[16:19],a[160:163],a[64:67],a[16:19]
s_sub_u32 s75, 3670016, s64
buffer_load_dwordx4 v13, s[48:51], s22 offen offset:1024   lds
M a[16:19],a[164:167],a[68:71],a[16:19]
s_mov_b32 s12, s72
M a[20:23],a[164:167],a[76:79],a[20:23]
s_and_b32 s13, s73, 0xffff
M a[20:23],a[160:163],a[72:75],a[20:23]
s_mov_b32 s14, s75
T a[104:105],v2,0
T a[106:107],v2,1024
M a[24:27],a[160:163],a[80:83],a[24:27]
s_mov_b32 s15, 0x20000
M a[24:27],a[164:167],a[84:87],a[24:27]
s_waitcnt lgkmcnt(6)
buffer_load_dwordx4 v14, s[48:51], s22 offen offset:2048   lds
M a[28:31],a[164:167],a[92:95],a[28:31]
M a[28:31],a[160:163],a[88:91],a[28:31]
M v[32:35],a[168:171],a[32:35],v[32:35]
R a[160:163],v5,36864
R a[164:167],v6,36864
M v[32:35],a[172:175],a[36:39],v[32:35]
T a[108:109],v2,8192
T a[110:111],v2,9216
M v[36:39],a[172:175],a[44:47],v[36:39]
buffer_load_dwordx4 v15, s[48:51], s22 offen offset:3072   lds
M v[36:39],a[168:171],a[40:43],v[36:39]
s_sub_u32 s22, s22, 1048448
M v[40:43],a[168:171],a[48:51],v[40:43]
M v[40:43],a[172:175],a[52:55],v[40:43]
s_nop 0
T a[112:113],v3,0
T a[114:115],v3,1024
M v[44:47],a[172:175],a[60:63],v[44:47]
SA m0,s23,49152
M v[44:47],a[168:171],a[56:59],v[44:47]
buffer_load_dwordx4 v8, s[16:19], s21 offen offset:0  nt lds
M v[48:51],a[168:171],a[64:67],v[48:51]
M v[48:51],a[172:175],a[68:71],v[48:51]
M v[52:55],a[172:175],a[76:79],v[52:55]
s_nop 0
T a[116:117],v3,8192
T a[118:119],v3,9216
M v[52:55],a[168:171],a[72:75],v[52:55]
M v[56:59],a[168:171],a[80:83],v[56:59]
buffer_load_dwordx4 v9, s[16:19], s21 offen offset:1024  nt lds
M v[56:59],a[172:175],a[84:87],v[56:59]
s_waitcnt lgkmcnt(6)
M v[60:63],a[172:175],a[92:95],v[60:63]
M v[60:63],a[168:171],a[88:91],v[60:63]
s_nop 0
T a[120:121],v4,0
T a[122:123],v4,1024
M v[64:67],a[160:163],a[32:35],v[64:67]
R a[168:171],v5,38912
R a[172:175],v6,38912
M v[64:67],a[164:167],a[36:39],v[64:67]
buffer_load_dwordx4 v10, s[16:19], s21 offen offset:2048  nt lds
M v[68:71],a[164:167],a[44:47],v[68:71]
M v[68:71],a[160:163],a[40:43],v[68:71]
M v[72:75],a[160:163],a[48:51],v[72:75]
s_nop 0
T a[124:125],v4,8192
T a[126:127],v4,9216
M v[72:75],a[164:167],a[52:55],v[72:75]
M v[76:79],a[164:167],a[60:63],v[76:79]
buffer_load_dwordx4 v11, s[16:19], s21 offen offset:3072  nt lds
M v[76:79],a[160:163],a[56:59],v[76:79]
SA s21,s21,524160
M v[80:83],a[160:163],a[64:67],v[80:83]
M v[80:83],a[164:167],a[68:71],v[80:83]
M v[84:87],a[164:167],a[76:79],v[84:87]
M v[84:87],a[160:163],a[72:75],v[84:87]
M v[88:91],a[160:163],a[80:83],v[88:91]
M v[88:91],a[164:167],a[84:87],v[88:91]
s_waitcnt lgkmcnt(2)
M v[92:95],a[164:167],a[92:95],v[92:95]
s_waitcnt vmcnt(18) lgkmcnt(0)
M v[92:95],a[160:163],a[88:91],v[92:95]
s_barrier
M v[96:99],a[168:171],a[32:35],v[96:99]
R a[160:163],v5,49152
R a[164:167],v6,49152
M v[96:99],a[172:175],a[36:39],v[96:99]
M v[100:103],a[172:175],a[44:47],v[100:103]
SA m0,s24,32768
T a[128:129],v1,16384
T a[130:131],v1,17408
M v[100:103],a[168:171],a[40:43],v[100:103]
buffer_load_dwordx4 v12, s[48:51], s22 offen offset:0   lds
M v[104:107],a[168:171],a[48:51],v[104:107]
M v[104:107],a[172:175],a[52:55],v[104:107]
M v[108:111],a[172:175],a[60:63],v[108:111]
M v[108:111],a[168:171],a[56:59],v[108:111]
M v[112:115],a[168:171],a[64:67],v[112:115]
M v[112:115],a[172:175],a[68:71],v[112:115]
s_nop 0
T a[132:133],v1,24576
T a[134:135],v1,25600
M v[116:119],a[172:175],a[76:79],v[116:119]
buffer_load_dwordx4 v13, s[48:51], s22 offen offset:1024   lds
M v[116:119],a[168:171],a[72:75],v[116:119]
M v[120:123],a[168:171],a[80:83],v[120:123]
M v[120:123],a[172:175],a[84:87],v[120:123]
s_waitcnt lgkmcnt(4)
M v[124:127],a[172:175],a[92:95],v[124:127]
M v[124:127],a[168:171],a[88:91],v[124:127]
M v[128:131],a[160:163],a[32:35],v[128:131]
R a[168:171],v5,51200
R a[172:175],v6,51200
M v[128:131],a[164:167],a[36:39],v[128:131]
T a[136:137],v2,16384
T a[138:139],v2,17408
M v[132:135],a[164:167],a[44:47],v[132:135]
buffer_load_dwordx4 v14, s[48:51], s22 offen offset:2048   lds
M v[132:135],a[160:163],a[40:43],v[132:135]
M v[136:139],a[160:163],a[48:51],v[136:139]
M v[136:139],a[164:167],a[52:55],v[136:139]
M v[140:143],a[164:167],a[60:63],v[140:143]
M v[140:143],a[160:163],a[56:59],v[140:143]
s_nop 0
T a[140:141],v2,24576
T a[142:143],v2,25600
M v[144:147],a[160:163],a[64:67],v[144:147]
buffer_load_dwordx4 v15, s[48:51], s22 offen offset:3072   lds
M v[144:147],a[164:167],a[68:71],v[144:147]
SA s22,s22,1048576
M v[148:151],a[164:167],a[76:79],v[148:151]
M v[148:151],a[160:163],a[72:75],v[148:151]
M v[152:155],a[160:163],a[80:83],v[152:155]
M v[152:155],a[164:167],a[84:87],v[152:155]
s_waitcnt lgkmcnt(4)
M v[156:159],a[164:167],a[92:95],v[156:159]
SA m0,s23,0
T a[144:145],v3,16384
T a[146:147],v3,17408
M v[156:159],a[160:163],a[88:91],v[156:159]
buffer_load_dwordx4 v8, s[16:19], s21 offen offset:0  nt lds
M v[160:163],a[168:171],a[32:35],v[160:163]
R a[160:163],v5,53248
R a[164:167],v6,53248
M v[160:163],a[172:175],a[36:39],v[160:163]
buffer_load_dword a240, v26, s[60:63], s27 offen offset:0
M v[164:167],a[172:175],a[44:47],v[164:167]
SA s27,s27,2048
M v[164:167],a[168:171],a[40:43],v[164:167]
M v[168:171],a[168:171],a[48:51],v[168:171]
M v[168:171],a[172:175],a[52:55],v[168:171]
s_nop 0
T a[148:149],v3,24576
T a[150:151],v3,25600
M v[172:175],a[172:175],a[60:63],v[172:175]
buffer_load_dwordx4 v9, s[16:19], s21 offen offset:1024  nt lds
M v[172:175],a[168:171],a[56:59],v[172:175]
M v[176:179],a[168:171],a[64:67],v[176:179]
M v[176:179],a[172:175],a[68:71],v[176:179]
M v[180:183],a[172:175],a[76:79],v[180:183]
M v[180:183],a[168:171],a[72:75],v[180:183]
M v[184:187],a[168:171],a[80:83],v[184:187]
s_nop 0
T a[152:153],v4,16384
T a[154:155],v4,17408
M v[184:187],a[172:175],a[84:87],v[184:187]
s_waitcnt lgkmcnt(4)
buffer_load_dwordx4 v10, s[16:19], s21 offen offset:2048  nt lds
M v[188:191],a[172:175],a[92:95],v[188:191]
M v[188:191],a[168:171],a[88:91],v[188:191]
M v[192:195],a[160:163],a[32:35],v[192:195]
R a[168:171],v5,55296
R a[172:175],v6,55296
M v[192:195],a[164:167],a[36:39],v[192:195]
M v[196:199],a[164:167],a[44:47],v[196:199]
M v[196:199],a[160:163],a[40:43],v[196:199]
s_nop 0
T a[156:157],v4,24576
T a[158:159],v4,25600
M v[200:203],a[160:163],a[48:51],v[200:203]
buffer_load_dwordx4 v11, s[16:19], s21 offen offset:3072  nt lds
M v[200:203],a[164:167],a[52:55],v[200:203]
SA s21,s21,128
M v[204:207],a[164:167],a[60:63],v[204:207]
M v[204:207],a[160:163],a[56:59],v[204:207]
M v[208:211],a[160:163],a[64:67],v[208:211]
M v[208:211],a[164:167],a[68:71],v[208:211]
M v[212:215],a[164:167],a[76:79],v[212:215]
M v[212:215],a[160:163],a[72:75],v[212:215]
M v[216:219],a[160:163],a[80:83],v[216:219]
M v[216:219],a[164:167],a[84:87],v[216:219]
s_waitcnt lgkmcnt(2)
M v[220:223],a[164:167],a[92:95],v[220:223]
s_waitcnt vmcnt(18) lgkmcnt(0)
M v[220:223],a[160:163],a[88:91],v[220:223]
s_barrier
M v[224:227],a[168:171],a[32:35],v[224:227]
R a[160:163],v5,0
R a[164:167],v6,0
M v[224:227],a[172:175],a[36:39],v[224:227]
M v[228:231],a[172:175],a[44:47],v[228:231]
M v[228:231],a[168:171],a[40:43],v[228:231]
M v[232:235],a[168:171],a[48:51],v[232:235]
M v[232:235],a[172:175],a[52:55],v[232:235]
M v[236:239],a[172:175],a[60:63],v[236:239]
M v[236:239],a[168:171],a[56:59],v[236:239]
M v[240:243],a[168:171],a[64:67],v[240:243]
M v[240:243],a[172:175],a[68:71],v[240:243]
M v[244:247],a[172:175],a[76:79],v[244:247]
M v[244:247],a[168:171],a[72:75],v[244:247]
M v[248:251],a[168:171],a[80:83],v[248:251]
M v[248:251],a[172:175],a[84:87],v[248:251]
s_waitcnt lgkmcnt(0)
M v[252:255],a[172:175],a[92:95],v[252:255]
M v[252:255],a[168:171],a[88:91],v[252:255]
M a[0:3],a[160:163],a[96:99],a[0:3]
R a[168:171],v5,2048
R a[172:175],v6,2048
M a[0:3],a[164:167],a[100:103],a[0:3]
T a[32:33],v1,32768
T a[34:35],v1,33792
M a[4:7],a[164:167],a[108:111],a[4:7]
SA m0,s24,49152
M a[4:7],a[160:163],a[104:107],a[4:7]
buffer_load_dwordx4 v12, s[48:51], s22 offen offset:0   lds
M a[8:11],a[160:163],a[112:115],a[8:11]
M a[8:11],a[164:167],a[116:119],a[8:11]
M a[12:15],a[164:167],a[124:127],a[12:15]
s_nop 0
T a[36:37],v1,40960
T a[38:39],v1,41984
M a[12:15],a[160:163],a[120:123],a[12:15]
M a[16:19],a[160:163],a[128:131],a[16:19]
buffer_load_dwordx4 v13, s[48:51], s22 offen offset:1024   lds
M a[16:19],a[164:167],a[132:135],a[16:19]
M a[20:23],a[164:167],a[140:143],a[20:23]
M a[20:23],a[160:163],a[136:139],a[20:23]
s_nop 0
T a[40:41],v2,32768
T a[42:43],v2,33792
M a[24:27],a[160:163],a[144:147],a[24:27]
M a[24:27],a[164:167],a[148:151],a[24:27]
s_waitcnt lgkmcnt(6)
buffer_load_dwordx4 v14, s[48:51], s22 offen offset:2048   lds
M a[28:31],a[164:167],a[156:159],a[28:31]
M a[28:31],a[160:163],a[152:155],a[28:31]
M v[32:35],a[168:171],a[96:99],v[32:35]
R a[160:163],v5,4096
R a[164:167],v6,4096
M v[32:35],a[172:175],a[100:103],v[32:35]
T a[44:45],v2,40960
T a[46:47],v2,41984
L_w_kv13:
s_cbranch_execz L_w_kv17
M v[36:39],a[172:175],a[108:111],v[36:39]
buffer_load_dwordx4 v15, s[48:51], s22 offen offset:3072   lds
M v[36:39],a[168:171],a[104:107],v[36:39]
s_sub_u32 s22, s22, 1048448
M v[40:43],a[168:171],a[112:115],v[40:43]
M v[40:43],a[172:175],a[116:119],v[40:43]
s_nop 0
T a[48:49],v3,32768
T a[50:51],v3,33792
M v[44:47],a[172:175],a[124:127],v[44:47]
SA m0,s23,16384
M v[44:47],a[168:171],a[120:123],v[44:47]
buffer_load_dwordx4 v8, s[16:19], s21 offen offset:0  nt lds
M v[48:51],a[168:171],a[128:131],v[48:51]
M v[48:51],a[172:175],a[132:135],v[48:51]
M v[52:55],a[172:175],a[140:143],v[52:55]
s_nop 0
T a[52:53],v3,40960
T a[54:55],v3,41984
M v[52:55],a[168:171],a[136:139],v[52:55]
M v[56:59],a[168:171],a[144:147],v[56:59]
buffer_load_dwordx4 v9, s[16:19], s21 offen offset:1024  nt lds
M v[56:59],a[172:175],a[148:151],v[56:59]
s_waitcnt lgkmcnt(6)
M v[60:63],a[172:175],a[156:159],v[60:63]
M v[60:63],a[168:171],a[152:155],v[60:63]
s_nop 0
T a[56:57],v4,32768
T a[58:59],v4,33792
M v[64:67],a[160:163],a[96:99],v[64:67]
R a[168:171],v5,6144
R a[172:175],v6,6144
M v[64:67],a[164:167],a[100:103],v[64:67]
buffer_load_dwordx4 v10, s[16:19], s21 offen offset:2048  nt lds
M v[68:71],a[164:167],a[108:111],v[68:71]
M v[68:71],a[160:163],a[104:107],v[68:71]
M v[72:75],a[160:163],a[112:115],v[72:75]
s_nop 0
T a[60:61],v4,40960
T a[62:63],v4,41984
M v[72:75],a[164:167],a[116:119],v[72:75]
M v[76:79],a[164:167],a[124:127],v[76:79]
buffer_load_dwordx4 v11, s[16:19], s21 offen offset:3072  nt lds
M v[76:79],a[160:163],a[120:123],v[76:79]
SA s21,s21,524160
M v[80:83],a[160:163],a[128:131],v[80:83]
M v[80:83],a[164:167],a[132:135],v[80:83]
M v[84:87],a[164:167],a[140:143],v[84:87]
M v[84:87],a[160:163],a[136:139],v[84:87]
M v[88:91],a[160:163],a[144:147],v[88:91]
M v[88:91],a[164:167],a[148:151],v[88:91]
s_waitcnt lgkmcnt(2)
M v[92:95],a[164:167],a[156:159],v[92:95]
s_waitcnt vmcnt(17) lgkmcnt(0)
M v[92:95],a[160:163],a[152:155],v[92:95]
s_barrier
M v[96:99],a[168:171],a[96:99],v[96:99]
R a[160:163],v5,16384
R a[164:167],v6,16384
M v[96:99],a[172:175],a[100:103],v[96:99]
M v[100:103],a[172:175],a[108:111],v[100:103]
SA m0,s24,0
T a[64:65],v1,49152
T a[66:67],v1,50176
M v[100:103],a[168:171],a[104:107],v[100:103]
buffer_load_dwordx4 v12, s[48:51], s22 offen offset:0   lds
M v[104:107],a[168:171],a[112:115],v[104:107]
M v[104:107],a[172:175],a[116:119],v[104:107]
M v[108:111],a[172:175],a[124:127],v[108:111]
M v[108:111],a[168:171],a[120:123],v[108:111]
M v[112:115],a[168:171],a[128:131],v[112:115]
M v[112:115],a[172:175],a[132:135],v[112:115]
s_nop 0
T a[68:69],v1,57344
T a[70:71],v1,58368
M v[116:119],a[172:175],a[140:143],v[116:119]
buffer_load_dwordx4 v13, s[48:51], s22 offen offset:1024   lds
M v[116:119],a[168:171],a[136:139],v[116:119]
M v[120:123],a[168:171],a[144:147],v[120:123]
M v[120:123],a[172:175],a[148:151],v[120:123]
s_waitcnt lgkmcnt(4)
M v[124:127],a[172:175],a[156:159],v[124:127]
M v[124:127],a[168:171],a[152:155],v[124:127]
M v[128:131],a[160:163],a[96:99],v[128:131]
R a[168:171],v5,18432
R a[172:175],v6,18432
M v[128:131],a[164:167],a[100:103],v[128:131]
T a[72:73],v2,49152
T a[74:75],v2,50176
M v[132:135],a[164:167],a[108:111],v[132:135]
buffer_load_dwordx4 v14, s[48:51], s22 offen offset:2048   lds
M v[132:135],a[160:163],a[104:107],v[132:135]
M v[136:139],a[160:163],a[112:115],v[136:139]
M v[136:139],a[164:167],a[116:119],v[136:139]
M v[140:143],a[164:167],a[124:127],v[140:143]
M v[140:143],a[160:163],a[120:123],v[140:143]
s_nop 0
T a[76:77],v2,57344
T a[78:79],v2,58368
M v[144:147],a[160:163],a[128:131],v[144:147]
buffer_load_dwordx4 v15, s[48:51], s22 offen offset:3072   lds
M v[144:147],a[164:167],a[132:135],v[144:147]
SA s22,s22,1048576
M v[148:151],a[164:167],a[140:143],v[148:151]
M v[148:151],a[160:163],a[136:139],v[148:151]
M v[152:155],a[160:163],a[144:147],v[152:155]
M v[152:155],a[164:167],a[148:151],v[152:155]
s_waitcnt lgkmcnt(4)
M v[156:159],a[164:167],a[156:159],v[156:159]
SA m0,s23,32768
T a[80:81],v3,49152
T a[82:83],v3,50176
M v[156:159],a[160:163],a[152:155],v[156:159]
buffer_load_dwordx4 v8, s[16:19], s21 offen offset:0  nt lds
M v[160:163],a[168:171],a[96:99],v[160:163]
R a[160:163],v5,20480
R a[164:167],v6,20480
M v[160:163],a[172:175],a[100:103],v[160:163]
buffer_load_dword a240, v26, s[60:63], s27 offen offset:0
M v[164:167],a[172:175],a[108:111],v[164:167]
SA s27,s27,2048
M v[164:167],a[168:171],a[104:107],v[164:167]
M v[168:171],a[168:171],a[112:115],v[168:171]
M v[168:171],a[172:175],a[116:119],v[168:171]
s_nop 0
T a[84:85],v3,57344
T a[86:87],v3,58368
M v[172:175],a[172:175],a[124:127],v[172:175]
buffer_load_dwordx4 v9, s[16:19], s21 offen offset:1024  nt lds
M v[172:175],a[168:171],a[120:123],v[172:175]
M v[176:179],a[168:171],a[128:131],v[176:179]
M v[176:179],a[172:175],a[132:135],v[176:179]
M v[180:183],a[172:175],a[140:143],v[180:183]
M v[180:183],a[168:171],a[136:139],v[180:183]
M v[184:187],a[168:171],a[144:147],v[184:187]
s_nop 0
T a[88:89],v4,49152
T a[90:91],v4,50176
M v[184:187],a[172:175],a[148:151],v[184:187]
s_waitcnt lgkmcnt(4)
buffer_load_dwordx4 v10, s[16:19], s21 offen offset:2048  nt lds
M v[188:191],a[172:175],a[156:159],v[188:191]
M v[188:191],a[168:171],a[152:155],v[188:191]
M v[192:195],a[160:163],a[96:99],v[192:195]
R a[168:171],v5,22528
R a[172:175],v6,22528
M v[192:195],a[164:167],a[100:103],v[192:195]
M v[196:199],a[164:167],a[108:111],v[196:199]
M v[196:199],a[160:163],a[104:107],v[196:199]
s_nop 0
T a[92:93],v4,57344
T a[94:95],v4,58368
M v[200:203],a[160:163],a[112:115],v[200:203]
buffer_load_dwordx4 v11, s[16:19], s21 offen offset:3072  nt lds
M v[200:203],a[164:167],a[116:119],v[200:203]
SA s21,s21,128
M v[204:207],a[164:167],a[124:127],v[204:207]
M v[204:207],a[160:163],a[120:123],v[204:207]
M v[208:211],a[160:163],a[128:131],v[208:211]
M v[208:211],a[164:167],a[132:135],v[208:211]
M v[212:215],a[164:167],a[140:143],v[212:215]
M v[212:215],a[160:163],a[136:139],v[212:215]
M v[216:219],a[160:163],a[144:147],v[216:219]
M v[216:219],a[164:167],a[148:151],v[216:219]
s_waitcnt lgkmcnt(2)
M v[220:223],a[164:167],a[156:159],v[220:223]
s_waitcnt vmcnt(17) lgkmcnt(0)
M v[220:223],a[160:163],a[152:155],v[220:223]
s_barrier
M v[224:227],a[168:171],a[96:99],v[224:227]
R a[160:163],v5,32768
R a[164:167],v6,32768
M v[224:227],a[172:175],a[100:103],v[224:227]
M v[228:231],a[172:175],a[108:111],v[228:231]
M v[228:231],a[168:171],a[104:107],v[228:231]
M v[232:235],a[168:171],a[112:115],v[232:235]
M v[232:235],a[172:175],a[116:119],v[232:235]
M v[236:239],a[172:175],a[124:127],v[236:239]
M v[236:239],a[168:171],a[120:123],v[236:239]
M v[240:243],a[168:171],a[128:131],v[240:243]
M v[240:243],a[172:175],a[132:135],v[240:243]
M v[244:247],a[172:175],a[140:143],v[244:247]
M v[244:247],a[168:171],a[136:139],v[244:247]
M v[248:251],a[168:171],a[144:147],v[248:251]
M v[248:251],a[172:175],a[148:151],v[248:251]
s_waitcnt lgkmcnt(0)
M v[252:255],a[172:175],a[156:159],v[252:255]
M v[252:255],a[168:171],a[152:155],v[252:255]
M a[0:3],a[160:163],a[32:35],a[0:3]
R a[168:171],v5,34816
R a[172:175],v6,34816
M a[0:3],a[164:167],a[36:39],a[0:3]
T a[96:97],v1,0
T a[98:99],v1,1024
M a[4:7],a[164:167],a[44:47],a[4:7]
SA m0,s24,16384
M a[4:7],a[160:163],a[40:43],a[4:7]
buffer_load_dwordx4 v12, s[48:51], s22 offen offset:0   lds
M a[8:11],a[160:163],a[48:51],a[8:11]
M a[8:11],a[164:167],a[52:55],a[8:11]
M a[12:15],a[164:167],a[60:63],a[12:15]
s_nop 0
T a[100:101],v1,8192
T a[102:103],v1,9216
M a[12:15],a[160:163],a[56:59],a[12:15]
M a[16:19],a[160:163],a[64:67],a[16:19]
buffer_load_dwordx4 v13, s[48:51], s22 offen offset:1024   lds
M a[16:19],a[164:167],a[68:71],a[16:19]
M a[20:23],a[164:167],a[76:79],a[20:23]
M a[20:23],a[160:163],a[72:75],a[20:23]
s_nop 0
T a[104:105],v2,0
T a[106:107],v2,1024
M a[24:27],a[160:163],a[80:83],a[24:27]
M a[24:27],a[164:167],a[84:87],a[24:27]
s_waitcnt lgkmcnt(6)
buffer_load_dwordx4 v14, s[48:51], s22 offen offset:2048   lds
M a[28:31],a[164:167],a[92:95],a[28:31]
M a[28:31],a[160:163],a[88:91],a[28:31]
M v[32:35],a[168:171],a[32:35],v[32:35]
R a[160:163],v5,36864
R a[164:167],v6,36864
M v[32:35],a[172:175],a[36:39],v[32:35]
T a[108:109],v2,8192
T a[110:111],v2,9216
M v[36:39],a[172:175],a[44:47],v[36:39]
buffer_load_dwordx4 v15, s[48:51], s22 offen offset:3072   lds
M v[36:39],a[168:171],a[40:43],v[36:39]
s_sub_u32 s22, s22, 1048448
M v[40:43],a[168:171],a[48:51],v[40:43]
M v[40:43],a[172:175],a[52:55],v[40:43]
s_nop 0
T a[112:113],v3,0
T a[114:115],v3,1024
M v[44:47],a[172:175],a[60:63],v[44:47]
SA m0,s23,49152
M v[44:47],a[168:171],a[56:59],v[44:47]
buffer_load_dwordx4 v8, s[16:19], s21 offen offset:0  nt lds
M v[48:51],a[168:171],a[64:67],v[48:51]
M v[48:51],a[172:175],a[68:71],v[48:51]
M v[52:55],a[172:175],a[76:79],v[52:55]
s_nop 0
T a[116:117],v3,8192
T a[118:119],v3,9216
M v[52:55],a[168:171],a[72:75],v[52:55]
M v[56:59],a[168:171],a[80:83],v[56:59]
buffer_load_dwordx4 v9, s[16:19], s21 offen offset:1024  nt lds
M v[56:59],a[172:175],a[84:87],v[56:59]
s_waitcnt lgkmcnt(6)
M v[60:63],a[172:175],a[92:95],v[60:63]
M v[60:63],a[168:171],a[88:91],v[60:63]
s_nop 0
T a[120:121],v4,0
T a[122:123],v4,1024
M v[64:67],a[160:163],a[32:35],v[64:67]
R a[168:171],v5,38912
R a[172:175],v6,38912
M v[64:67],a[164:167],a[36:39],v[64:67]
buffer_load_dwordx4 v10, s[16:19], s21 offen offset:2048  nt lds
M v[68:71],a[164:167],a[44:47],v[68:71]
M v[68:71],a[160:163],a[40:43],v[68:71]
M v[72:75],a[160:163],a[48:51],v[72:75]
s_nop 0
T a[124:125],v4,8192
T a[126:127],v4,9216
M v[72:75],a[164:167],a[52:55],v[72:75]
M v[76:79],a[164:167],a[60:63],v[76:79]
buffer_load_dwordx4 v11, s[16:19], s21 offen offset:3072  nt lds
M v[76:79],a[160:163],a[56:59],v[76:79]
SA s21,s21,524160
M v[80:83],a[160:163],a[64:67],v[80:83]
M v[80:83],a[164:167],a[68:71],v[80:83]
M v[84:87],a[164:167],a[76:79],v[84:87]
M v[84:87],a[160:163],a[72:75],v[84:87]
M v[88:91],a[160:163],a[80:83],v[88:91]
M v[88:91],a[164:167],a[84:87],v[88:91]
s_waitcnt lgkmcnt(2)
M v[92:95],a[164:167],a[92:95],v[92:95]
s_waitcnt vmcnt(17) lgkmcnt(0)
M v[92:95],a[160:163],a[88:91],v[92:95]
s_barrier
M v[96:99],a[168:171],a[32:35],v[96:99]
R a[160:163],v5,49152
R a[164:167],v6,49152
M v[96:99],a[172:175],a[36:39],v[96:99]
M v[100:103],a[172:175],a[44:47],v[100:103]
SA m0,s24,32768
T a[128:129],v1,16384
T a[130:131],v1,17408
M v[100:103],a[168:171],a[40:43],v[100:103]
buffer_load_dwordx4 v12, s[48:51], s22 offen offset:0   lds
M v[104:107],a[168:171],a[48:51],v[104:107]
M v[104:107],a[172:175],a[52:55],v[104:107]
M v[108:111],a[172:175],a[60:63],v[108:111]
M v[108:111],a[168:171],a[56:59],v[108:111]
M v[112:115],a[168:171],a[64:67],v[112:115]
M v[112:115],a[172:175],a[68:71],v[112:115]
s_nop 0
T a[132:133],v1,24576
T a[134:135],v1,25600
M v[116:119],a[172:175],a[76:79],v[116:119]
buffer_load_dwordx4 v13, s[48:51], s22 offen offset:1024   lds
M v[116:119],a[168:171],a[72:75],v[116:119]
M v[120:123],a[168:171],a[80:83],v[120:123]
s_and_b32 s64, s42, 7
s_lshl_b32 s64, s64, 2
M v[120:123],a[172:175],a[84:87],v[120:123]
s_waitcnt lgkmcnt(4)
SA s64,s64,s20
M v[124:127],a[172:175],a[92:95],v[124:127]
s_mul_i32 s64, s64, 114688
v_bfe_u32 v28, v0, 2, 2
v_and_b32 v29, 3, v0
M v[124:127],a[168:171],a[88:91],v[124:127]
v_lshlrev_b32 v29, 7, v29
v_lshl_add_u32 v28, v28, 13, v29
M v[128:131],a[160:163],a[32:35],v[128:131]
R a[168:171],v5,51200
R a[172:175],v6,51200
M v[128:131],a[164:167],a[36:39],v[128:131]
T a[136:137],v2,16384
T a[138:139],v2,17408
M v[132:135],a[164:167],a[44:47],v[132:135]
buffer_load_dwordx4 v14, s[48:51], s22 offen offset:2048   lds
M v[132:135],a[160:163],a[40:43],v[132:135]
v_add_u32 v23, s64, v28
v_and_b32 v28, 48, v0
M v[136:139],a[160:163],a[48:51],v[136:139]
v_lshl_add_u32 v23, v28, 24, v23
M v[136:139],a[164:167],a[52:55],v[136:139]
M v[140:143],a[164:167],a[60:63],v[140:143]
M v[140:143],a[160:163],a[56:59],v[140:143]
s_nop 0
T a[140:141],v2,24576
T a[142:143],v2,25600
M v[144:147],a[160:163],a[64:67],v[144:147]
buffer_load_dwordx4 v15, s[48:51], s22 offen offset:3072   lds
M v[144:147],a[164:167],a[68:71],v[144:147]
SA s22,s22,1048576
M v[148:151],a[164:167],a[76:79],v[148:151]
M v[148:151],a[160:163],a[72:75],v[148:151]
M v[152:155],a[160:163],a[80:83],v[152:155]
M v[152:155],a[164:167],a[84:87],v[152:155]
s_waitcnt lgkmcnt(4)
M v[156:159],a[164:167],a[92:95],v[156:159]
SA m0,s23,0
T a[144:145],v3,16384
T a[146:147],v3,17408
M v[156:159],a[160:163],a[88:91],v[156:159]
buffer_load_dwordx4 v8, s[16:19], s21 offen offset:0  nt lds
M v[160:163],a[168:171],a[32:35],v[160:163]
R a[160:163],v5,53248
R a[164:167],v6,53248
M v[160:163],a[172:175],a[36:39],v[160:163]
M v[164:167],a[172:175],a[44:47],v[164:167]
M v[164:167],a[168:171],a[40:43],v[164:167]
M v[168:171],a[168:171],a[48:51],v[168:171]
M v[168:171],a[172:175],a[52:55],v[168:171]
s_nop 0
T a[148:149],v3,24576
T a[150:151],v3,25600
M v[172:175],a[172:175],a[60:63],v[172:175]
buffer_load_dwordx4 v9, s[16:19], s21 offen offset:1024  nt lds
M v[172:175],a[168:171],a[56:59],v[172:175]
M v[176:179],a[168:171],a[64:67],v[176:179]
M v[176:179],a[172:175],a[68:71],v[176:179]
M v[180:183],a[172:175],a[76:79],v[180:183]
M v[180:183],a[168:171],a[72:75],v[180:183]
M v[184:187],a[168:171],a[80:83],v[184:187]
s_nop 0
T a[152:153],v4,16384
T a[154:155],v4,17408
M v[184:187],a[172:175],a[84:87],v[184:187]
s_waitcnt lgkmcnt(4)
buffer_load_dwordx4 v10, s[16:19], s21 offen offset:2048  nt lds
M v[188:191],a[172:175],a[92:95],v[188:191]
M v[188:191],a[168:171],a[88:91],v[188:191]
M v[192:195],a[160:163],a[32:35],v[192:195]
R a[168:171],v5,55296
R a[172:175],v6,55296
M v[192:195],a[164:167],a[36:39],v[192:195]
M v[196:199],a[164:167],a[44:47],v[196:199]
M v[196:199],a[160:163],a[40:43],v[196:199]
s_nop 0
T a[156:157],v4,24576
T a[158:159],v4,25600
M v[200:203],a[160:163],a[48:51],v[200:203]
buffer_load_dwordx4 v11, s[16:19], s21 offen offset:3072  nt lds
M v[200:203],a[164:167],a[52:55],v[200:203]
SA s21,s21,128
M v[204:207],a[164:167],a[60:63],v[204:207]
M v[204:207],a[160:163],a[56:59],v[204:207]
M v[208:211],a[160:163],a[64:67],v[208:211]
M v[208:211],a[164:167],a[68:71],v[208:211]
M v[212:215],a[164:167],a[76:79],v[212:215]
M v[212:215],a[160:163],a[72:75],v[212:215]
M v[216:219],a[160:163],a[80:83],v[216:219]
M v[216:219],a[164:167],a[84:87],v[216:219]
s_waitcnt lgkmcnt(2)
M v[220:223],a[164:167],a[92:95],v[220:223]
s_waitcnt vmcnt(16) lgkmcnt(0)
M v[220:223],a[160:163],a[88:91],v[220:223]
s_barrier
M v[224:227],a[168:171],a[32:35],v[224:227]
R a[160:163],v5,0
R a[164:167],v6,0
M v[224:227],a[172:175],a[36:39],v[224:227]
buffer_load_dword a240, v23, s[52:55], 0 offen offset:0
M v[228:231],a[172:175],a[44:47],v[228:231]
v_add_u32 v23, 32768, v23
M v[228:231],a[168:171],a[40:43],v[228:231]
M v[232:235],a[168:171],a[48:51],v[232:235]
M v[232:235],a[172:175],a[52:55],v[232:235]
M v[236:239],a[172:175],a[60:63],v[236:239]
M v[236:239],a[168:171],a[56:59],v[236:239]
M v[240:243],a[168:171],a[64:67],v[240:243]
M v[240:243],a[172:175],a[68:71],v[240:243]
M v[244:247],a[172:175],a[76:79],v[244:247]
M v[244:247],a[168:171],a[72:75],v[244:247]
M v[248:251],a[168:171],a[80:83],v[248:251]
M v[248:251],a[172:175],a[84:87],v[248:251]
s_waitcnt lgkmcnt(0)
M v[252:255],a[172:175],a[92:95],v[252:255]
M v[252:255],a[168:171],a[88:91],v[252:255]
M a[0:3],a[160:163],a[96:99],a[0:3]
R a[168:171],v5,2048
R a[172:175],v6,2048
M a[0:3],a[164:167],a[100:103],a[0:3]
T a[32:33],v1,32768
T a[34:35],v1,33792
M a[4:7],a[164:167],a[108:111],a[4:7]
SA m0,s24,49152
M a[4:7],a[160:163],a[104:107],a[4:7]
buffer_load_dwordx4 v12, s[48:51], s22 offen offset:0   lds
M a[8:11],a[160:163],a[112:115],a[8:11]
M a[8:11],a[164:167],a[116:119],a[8:11]
M a[12:15],a[164:167],a[124:127],a[12:15]
s_nop 0
T a[36:37],v1,40960
T a[38:39],v1,41984
M a[12:15],a[160:163],a[120:123],a[12:15]
M a[16:19],a[160:163],a[128:131],a[16:19]
buffer_load_dwordx4 v13, s[48:51], s22 offen offset:1024   lds
M a[16:19],a[164:167],a[132:135],a[16:19]
M a[20:23],a[164:167],a[140:143],a[20:23]
M a[20:23],a[160:163],a[136:139],a[20:23]
s_nop 0
T a[40:41],v2,32768
T a[42:43],v2,33792
M a[24:27],a[160:163],a[144:147],a[24:27]
M a[24:27],a[164:167],a[148:151],a[24:27]
s_waitcnt lgkmcnt(6)
buffer_load_dwordx4 v14, s[48:51], s22 offen offset:2048   lds
M a[28:31],a[164:167],a[156:159],a[28:31]
M a[28:31],a[160:163],a[152:155],a[28:31]
M v[32:35],a[168:171],a[96:99],v[32:35]
R a[160:163],v5,4096
R a[164:167],v6,4096
M v[32:35],a[172:175],a[100:103],v[32:35]
T a[44:45],v2,40960
T a[46:47],v2,41984
M v[36:39],a[172:175],a[108:111],v[36:39]
buffer_load_dwordx4 v15, s[48:51], s22 offen offset:3072   lds
M v[36:39],a[168:171],a[104:107],v[36:39]
s_sub_u32 s22, s22, 1048448
M v[40:43],a[168:171],a[112:115],v[40:43]
M v[40:43],a[172:175],a[116:119],v[40:43]
s_nop 0
T a[48:49],v3,32768
T a[50:51],v3,33792
M v[44:47],a[172:175],a[124:127],v[44:47]
SA m0,s23,16384
M v[44:47],a[168:171],a[120:123],v[44:47]
buffer_load_dwordx4 v8, s[16:19], s21 offen offset:0  nt lds
M v[48:51],a[168:171],a[128:131],v[48:51]
M v[48:51],a[172:175],a[132:135],v[48:51]
M v[52:55],a[172:175],a[140:143],v[52:55]
s_nop 0
T a[52:53],v3,40960
T a[54:55],v3,41984
M v[52:55],a[168:171],a[136:139],v[52:55]
M v[56:59],a[168:171],a[144:147],v[56:59]
buffer_load_dwordx4 v9, s[16:19], s21 offen offset:1024  nt lds
M v[56:59],a[172:175],a[148:151],v[56:59]
s_waitcnt lgkmcnt(6)
M v[60:63],a[172:175],a[156:159],v[60:63]
M v[60:63],a[168:171],a[152:155],v[60:63]
s_nop 0
T a[56:57],v4,32768
T a[58:59],v4,33792
M v[64:67],a[160:163],a[96:99],v[64:67]
R a[168:171],v5,6144
R a[172:175],v6,6144
M v[64:67],a[164:167],a[100:103],v[64:67]
buffer_load_dwordx4 v10, s[16:19], s21 offen offset:2048  nt lds
M v[68:71],a[164:167],a[108:111],v[68:71]
M v[68:71],a[160:163],a[104:107],v[68:71]
M v[72:75],a[160:163],a[112:115],v[72:75]
s_nop 0
T a[60:61],v4,40960
T a[62:63],v4,41984
M v[72:75],a[164:167],a[116:119],v[72:75]
M v[76:79],a[164:167],a[124:127],v[76:79]
buffer_load_dwordx4 v11, s[16:19], s21 offen offset:3072  nt lds
M v[76:79],a[160:163],a[120:123],v[76:79]
SA s21,s21,524160
M v[80:83],a[160:163],a[128:131],v[80:83]
M v[80:83],a[164:167],a[132:135],v[80:83]
M v[84:87],a[164:167],a[140:143],v[84:87]
M v[84:87],a[160:163],a[136:139],v[84:87]
M v[88:91],a[160:163],a[144:147],v[88:91]
M v[88:91],a[164:167],a[148:151],v[88:91]
s_waitcnt lgkmcnt(2)
M v[92:95],a[164:167],a[156:159],v[92:95]
s_waitcnt vmcnt(17) lgkmcnt(0)
M v[92:95],a[160:163],a[152:155],v[92:95]
s_barrier
M v[96:99],a[168:171],a[96:99],v[96:99]
R a[160:163],v5,16384
R a[164:167],v6,16384
M v[96:99],a[172:175],a[100:103],v[96:99]
M v[100:103],a[172:175],a[108:111],v[100:103]
SA m0,s24,0
T a[64:65],v1,49152
T a[66:67],v1,50176
M v[100:103],a[168:171],a[104:107],v[100:103]
buffer_load_dwordx4 v12, s[48:51], s22 offen offset:0   lds
M v[104:107],a[168:171],a[112:115],v[104:107]
M v[104:107],a[172:175],a[116:119],v[104:107]
M v[108:111],a[172:175],a[124:127],v[108:111]
M v[108:111],a[168:171],a[120:123],v[108:111]
M v[112:115],a[168:171],a[128:131],v[112:115]
M v[112:115],a[172:175],a[132:135],v[112:115]
s_nop 0
T a[68:69],v1,57344
T a[70:71],v1,58368
M v[116:119],a[172:175],a[140:143],v[116:119]
buffer_load_dwordx4 v13, s[48:51], s22 offen offset:1024   lds
M v[116:119],a[168:171],a[136:139],v[116:119]
M v[120:123],a[168:171],a[144:147],v[120:123]
M v[120:123],a[172:175],a[148:151],v[120:123]
s_waitcnt lgkmcnt(4)
M v[124:127],a[172:175],a[156:159],v[124:127]
M v[124:127],a[168:171],a[152:155],v[124:127]
L_w_kv14:
s_cbranch_execz L_w_kv18
M v[128:131],a[160:163],a[96:99],v[128:131]
R a[168:171],v5,18432
R a[172:175],v6,18432
M v[128:131],a[164:167],a[100:103],v[128:131]
T a[72:73],v2,49152
T a[74:75],v2,50176
M v[132:135],a[164:167],a[108:111],v[132:135]
buffer_load_dwordx4 v14, s[48:51], s22 offen offset:2048   lds
M v[132:135],a[160:163],a[104:107],v[132:135]
M v[136:139],a[160:163],a[112:115],v[136:139]
M v[136:139],a[164:167],a[116:119],v[136:139]
M v[140:143],a[164:167],a[124:127],v[140:143]
M v[140:143],a[160:163],a[120:123],v[140:143]
s_nop 0
T a[76:77],v2,57344
T a[78:79],v2,58368
M v[144:147],a[160:163],a[128:131],v[144:147]
buffer_load_dwordx4 v15, s[48:51], s22 offen offset:3072   lds
M v[144:147],a[164:167],a[132:135],v[144:147]
SA s22,s22,1048576
M v[148:151],a[164:167],a[140:143],v[148:151]
M v[148:151],a[160:163],a[136:139],v[148:151]
M v[152:155],a[160:163],a[144:147],v[152:155]
M v[152:155],a[164:167],a[148:151],v[152:155]
s_waitcnt lgkmcnt(4)
M v[156:159],a[164:167],a[156:159],v[156:159]
SA m0,s23,32768
T a[80:81],v3,49152
T a[82:83],v3,50176
M v[156:159],a[160:163],a[152:155],v[156:159]
buffer_load_dwordx4 v8, s[16:19], s21 offen offset:0  nt lds
M v[160:163],a[168:171],a[96:99],v[160:163]
R a[160:163],v5,20480
R a[164:167],v6,20480
M v[160:163],a[172:175],a[100:103],v[160:163]
M v[164:167],a[172:175],a[108:111],v[164:167]
M v[164:167],a[168:171],a[104:107],v[164:167]
M v[168:171],a[168:171],a[112:115],v[168:171]
M v[168:171],a[172:175],a[116:119],v[168:171]
s_nop 0
T a[84:85],v3,57344
T a[86:87],v3,58368
M v[172:175],a[172:175],a[124:127],v[172:175]
buffer_load_dwordx4 v9, s[16:19], s21 offen offset:1024  nt lds
M v[172:175],a[168:171],a[120:123],v[172:175]
M v[176:179],a[168:171],a[128:131],v[176:179]
M v[176:179],a[172:175],a[132:135],v[176:179]
M v[180:183],a[172:175],a[140:143],v[180:183]
M v[180:183],a[168:171],a[136:139],v[180:183]
M v[184:187],a[168:171],a[144:147],v[184:187]
s_nop 0
T a[88:89],v4,49152
T a[90:91],v4,50176
M v[184:187],a[172:175],a[148:151],v[184:187]
s_waitcnt lgkmcnt(4)
buffer_load_dwordx4 v10, s[16:19], s21 offen offset:2048  nt lds
M v[188:191],a[172:175],a[156:159],v[188:191]
M v[188:191],a[168:171],a[152:155],v[188:191]
M v[192:195],a[160:163],a[96:99],v[192:195]
R a[168:171],v5,22528
R a[172:175],v6,22528
M v[192:195],a[164:167],a[100:103],v[192:195]
M v[196:199],a[164:167],a[108:111],v[196:199]
M v[196:199],a[160:163],a[104:107],v[196:199]
s_nop 0
T a[92:93],v4,57344
T a[94:95],v4,58368
M v[200:203],a[160:163],a[112:115],v[200:203]
buffer_load_dwordx4 v11, s[16:19], s21 offen offset:3072  nt lds
M v[200:203],a[164:167],a[116:119],v[200:203]
SA s21,s21,128
M v[204:207],a[164:167],a[124:127],v[204:207]
M v[204:207],a[160:163],a[120:123],v[204:207]
M v[208:211],a[160:163],a[128:131],v[208:211]
M v[208:211],a[164:167],a[132:135],v[208:211]
M v[212:215],a[164:167],a[140:143],v[212:215]
M v[212:215],a[160:163],a[136:139],v[212:215]
M v[216:219],a[160:163],a[144:147],v[216:219]
M v[216:219],a[164:167],a[148:151],v[216:219]
s_waitcnt lgkmcnt(2)
M v[220:223],a[164:167],a[156:159],v[220:223]
s_waitcnt vmcnt(17) lgkmcnt(0)
M v[220:223],a[160:163],a[152:155],v[220:223]
s_barrier
M v[224:227],a[168:171],a[96:99],v[224:227]
R a[160:163],v5,32768
R a[164:167],v6,32768
M v[224:227],a[172:175],a[100:103],v[224:227]
buffer_load_dword a240, v23, s[52:55], 0 offen offset:0
M v[228:231],a[172:175],a[108:111],v[228:231]
v_add_u32 v23, 32768, v23
M v[228:231],a[168:171],a[104:107],v[228:231]
M v[232:235],a[168:171],a[112:115],v[232:235]
M v[232:235],a[172:175],a[116:119],v[232:235]
M v[236:239],a[172:175],a[124:127],v[236:239]
M v[236:239],a[168:171],a[120:123],v[236:239]
M v[240:243],a[168:171],a[128:131],v[240:243]
M v[240:243],a[172:175],a[132:135],v[240:243]
M v[244:247],a[172:175],a[140:143],v[244:247]
M v[244:247],a[168:171],a[136:139],v[244:247]
M v[248:251],a[168:171],a[144:147],v[248:251]
M v[248:251],a[172:175],a[148:151],v[248:251]
s_waitcnt lgkmcnt(0)
M v[252:255],a[172:175],a[156:159],v[252:255]
M v[252:255],a[168:171],a[152:155],v[252:255]
M a[0:3],a[160:163],a[32:35],a[0:3]
R a[168:171],v5,34816
R a[172:175],v6,34816
M a[0:3],a[164:167],a[36:39],a[0:3]
T a[96:97],v1,0
T a[98:99],v1,1024
M a[4:7],a[164:167],a[44:47],a[4:7]
SA m0,s24,16384
M a[4:7],a[160:163],a[40:43],a[4:7]
buffer_load_dwordx4 v12, s[48:51], s22 offen offset:0   lds
M a[8:11],a[160:163],a[48:51],a[8:11]
M a[8:11],a[164:167],a[52:55],a[8:11]
M a[12:15],a[164:167],a[60:63],a[12:15]
s_nop 0
T a[100:101],v1,8192
T a[102:103],v1,9216
M a[12:15],a[160:163],a[56:59],a[12:15]
M a[16:19],a[160:163],a[64:67],a[16:19]
buffer_load_dwordx4 v13, s[48:51], s22 offen offset:1024   lds
M a[16:19],a[164:167],a[68:71],a[16:19]
M a[20:23],a[164:167],a[76:79],a[20:23]
M a[20:23],a[160:163],a[72:75],a[20:23]
s_nop 0
T a[104:105],v2,0
T a[106:107],v2,1024
M a[24:27],a[160:163],a[80:83],a[24:27]
M a[24:27],a[164:167],a[84:87],a[24:27]
s_waitcnt lgkmcnt(6)
buffer_load_dwordx4 v14, s[48:51], s22 offen offset:2048   lds
M a[28:31],a[164:167],a[92:95],a[28:31]
M a[28:31],a[160:163],a[88:91],a[28:31]
M v[32:35],a[168:171],a[32:35],v[32:35]
R a[160:163],v5,36864
R a[164:167],v6,36864
M v[32:35],a[172:175],a[36:39],v[32:35]
T a[108:109],v2,8192
T a[110:111],v2,9216
M v[36:39],a[172:175],a[44:47],v[36:39]
buffer_load_dwordx4 v15, s[48:51], s22 offen offset:3072   lds
M v[36:39],a[168:171],a[40:43],v[36:39]
s_sub_u32 s22, s22, 1048448
M v[40:43],a[168:171],a[48:51],v[40:43]
M v[40:43],a[172:175],a[52:55],v[40:43]
s_nop 0
T a[112:113],v3,0
T a[114:115],v3,1024
M v[44:47],a[172:175],a[60:63],v[44:47]
SA m0,s23,49152
M v[44:47],a[168:171],a[56:59],v[44:47]
buffer_load_dwordx4 v8, s[16:19], s21 offen offset:0  nt lds
M v[48:51],a[168:171],a[64:67],v[48:51]
M v[48:51],a[172:175],a[68:71],v[48:51]
M v[52:55],a[172:175],a[76:79],v[52:55]
s_nop 0
T a[116:117],v3,8192
T a[118:119],v3,9216
M v[52:55],a[168:171],a[72:75],v[52:55]
M v[56:59],a[168:171],a[80:83],v[56:59]
buffer_load_dwordx4 v9, s[16:19], s21 offen offset:1024  nt lds
M v[56:59],a[172:175],a[84:87],v[56:59]
s_waitcnt lgkmcnt(6)
M v[60:63],a[172:175],a[92:95],v[60:63]
M v[60:63],a[168:171],a[88:91],v[60:63]
s_nop 0
T a[120:121],v4,0
T a[122:123],v4,1024
M v[64:67],a[160:163],a[32:35],v[64:67]
R a[168:171],v5,38912
R a[172:175],v6,38912
M v[64:67],a[164:167],a[36:39],v[64:67]
buffer_load_dwordx4 v10, s[16:19], s21 offen offset:2048  nt lds
M v[68:71],a[164:167],a[44:47],v[68:71]
M v[68:71],a[160:163],a[40:43],v[68:71]
M v[72:75],a[160:163],a[48:51],v[72:75]
s_nop 0
T a[124:125],v4,8192
T a[126:127],v4,9216
M v[72:75],a[164:167],a[52:55],v[72:75]
M v[76:79],a[164:167],a[60:63],v[76:79]
buffer_load_dwordx4 v11, s[16:19], s21 offen offset:3072  nt lds
M v[76:79],a[160:163],a[56:59],v[76:79]
SA s21,s21,524160
M v[80:83],a[160:163],a[64:67],v[80:83]
M v[80:83],a[164:167],a[68:71],v[80:83]
M v[84:87],a[164:167],a[76:79],v[84:87]
M v[84:87],a[160:163],a[72:75],v[84:87]
M v[88:91],a[160:163],a[80:83],v[88:91]
M v[88:91],a[164:167],a[84:87],v[88:91]
s_waitcnt lgkmcnt(2)
M v[92:95],a[164:167],a[92:95],v[92:95]
s_waitcnt vmcnt(17) lgkmcnt(0)
M v[92:95],a[160:163],a[88:91],v[92:95]
s_barrier
M v[96:99],a[168:171],a[32:35],v[96:99]
R a[160:163],v5,49152
R a[164:167],v6,49152
M v[96:99],a[172:175],a[36:39],v[96:99]
M v[100:103],a[172:175],a[44:47],v[100:103]
SA m0,s24,32768
T a[128:129],v1,16384
T a[130:131],v1,17408
M v[100:103],a[168:171],a[40:43],v[100:103]
buffer_load_dwordx4 v12, s[48:51], s22 offen offset:0   lds
M v[104:107],a[168:171],a[48:51],v[104:107]
M v[104:107],a[172:175],a[52:55],v[104:107]
M v[108:111],a[172:175],a[60:63],v[108:111]
M v[108:111],a[168:171],a[56:59],v[108:111]
M v[112:115],a[168:171],a[64:67],v[112:115]
M v[112:115],a[172:175],a[68:71],v[112:115]
s_nop 0
T a[132:133],v1,24576
T a[134:135],v1,25600
M v[116:119],a[172:175],a[76:79],v[116:119]
buffer_load_dwordx4 v13, s[48:51], s22 offen offset:1024   lds
M v[116:119],a[168:171],a[72:75],v[116:119]
M v[120:123],a[168:171],a[80:83],v[120:123]
M v[120:123],a[172:175],a[84:87],v[120:123]
s_waitcnt lgkmcnt(4)
M v[124:127],a[172:175],a[92:95],v[124:127]
M v[124:127],a[168:171],a[88:91],v[124:127]
M v[128:131],a[160:163],a[32:35],v[128:131]
R a[168:171],v5,51200
R a[172:175],v6,51200
M v[128:131],a[164:167],a[36:39],v[128:131]
T a[136:137],v2,16384
T a[138:139],v2,17408
M v[132:135],a[164:167],a[44:47],v[132:135]
buffer_load_dwordx4 v14, s[48:51], s22 offen offset:2048   lds
M v[132:135],a[160:163],a[40:43],v[132:135]
M v[136:139],a[160:163],a[48:51],v[136:139]
M v[136:139],a[164:167],a[52:55],v[136:139]
M v[140:143],a[164:167],a[60:63],v[140:143]
M v[140:143],a[160:163],a[56:59],v[140:143]
s_nop 0
T a[140:141],v2,24576
T a[142:143],v2,25600
M v[144:147],a[160:163],a[64:67],v[144:147]
buffer_load_dwordx4 v15, s[48:51], s22 offen offset:3072   lds
M v[144:147],a[164:167],a[68:71],v[144:147]
SA s22,s22,1048576
M v[148:151],a[164:167],a[76:79],v[148:151]
M v[148:151],a[160:163],a[72:75],v[148:151]
M v[152:155],a[160:163],a[80:83],v[152:155]
M v[152:155],a[164:167],a[84:87],v[152:155]
s_waitcnt lgkmcnt(4)
M v[156:159],a[164:167],a[92:95],v[156:159]
SA m0,s23,0
T a[144:145],v3,16384
T a[146:147],v3,17408
M v[156:159],a[160:163],a[88:91],v[156:159]
buffer_load_dwordx4 v8, s[16:19], s21 offen offset:0  nt lds
M v[160:163],a[168:171],a[32:35],v[160:163]
R a[160:163],v5,53248
R a[164:167],v6,53248
M v[160:163],a[172:175],a[36:39],v[160:163]
M v[164:167],a[172:175],a[44:47],v[164:167]
M v[164:167],a[168:171],a[40:43],v[164:167]
M v[168:171],a[168:171],a[48:51],v[168:171]
M v[168:171],a[172:175],a[52:55],v[168:171]
s_nop 0
T a[148:149],v3,24576
T a[150:151],v3,25600
M v[172:175],a[172:175],a[60:63],v[172:175]
buffer_load_dwordx4 v9, s[16:19], s21 offen offset:1024  nt lds
M v[172:175],a[168:171],a[56:59],v[172:175]
M v[176:179],a[168:171],a[64:67],v[176:179]
M v[176:179],a[172:175],a[68:71],v[176:179]
M v[180:183],a[172:175],a[76:79],v[180:183]
M v[180:183],a[168:171],a[72:75],v[180:183]
M v[184:187],a[168:171],a[80:83],v[184:187]
s_nop 0
T a[152:153],v4,16384
T a[154:155],v4,17408
M v[184:187],a[172:175],a[84:87],v[184:187]
s_waitcnt lgkmcnt(4)
buffer_load_dwordx4 v10, s[16:19], s21 offen offset:2048  nt lds
M v[188:191],a[172:175],a[92:95],v[188:191]
M v[188:191],a[168:171],a[88:91],v[188:191]
M v[192:195],a[160:163],a[32:35],v[192:195]
R a[168:171],v5,55296
R a[172:175],v6,55296
M v[192:195],a[164:167],a[36:39],v[192:195]
M v[196:199],a[164:167],a[44:47],v[196:199]
M v[196:199],a[160:163],a[40:43],v[196:199]
s_nop 0
T a[156:157],v4,24576
T a[158:159],v4,25600
M v[200:203],a[160:163],a[48:51],v[200:203]
buffer_load_dwordx4 v11, s[16:19], s21 offen offset:3072  nt lds
M v[200:203],a[164:167],a[52:55],v[200:203]
SA s21,s21,128
M v[204:207],a[164:167],a[60:63],v[204:207]
M v[204:207],a[160:163],a[56:59],v[204:207]
M v[208:211],a[160:163],a[64:67],v[208:211]
M v[208:211],a[164:167],a[68:71],v[208:211]
M v[212:215],a[164:167],a[76:79],v[212:215]
M v[212:215],a[160:163],a[72:75],v[212:215]
M v[216:219],a[160:163],a[80:83],v[216:219]
M v[216:219],a[164:167],a[84:87],v[216:219]
s_waitcnt lgkmcnt(2)
M v[220:223],a[164:167],a[92:95],v[220:223]
s_waitcnt vmcnt(17) lgkmcnt(0)
M v[220:223],a[160:163],a[88:91],v[220:223]
s_barrier
M v[224:227],a[168:171],a[32:35],v[224:227]
R a[160:163],v5,0
R a[164:167],v6,0
M v[224:227],a[172:175],a[36:39],v[224:227]
buffer_load_dword a240, v23, s[52:55], 0 offen offset:0
M v[228:231],a[172:175],a[44:47],v[228:231]
v_add_u32 v23, 16384, v23
M v[228:231],a[168:171],a[40:43],v[228:231]
M v[232:235],a[168:171],a[48:51],v[232:235]
M v[232:235],a[172:175],a[52:55],v[232:235]
M v[236:239],a[172:175],a[60:63],v[236:239]
M v[236:239],a[168:171],a[56:59],v[236:239]
M v[240:243],a[168:171],a[64:67],v[240:243]
M v[240:243],a[172:175],a[68:71],v[240:243]
M v[244:247],a[172:175],a[76:79],v[244:247]
M v[244:247],a[168:171],a[72:75],v[244:247]
M v[248:251],a[168:171],a[80:83],v[248:251]
M v[248:251],a[172:175],a[84:87],v[248:251]
s_waitcnt lgkmcnt(0)
M v[252:255],a[172:175],a[92:95],v[252:255]
M v[252:255],a[168:171],a[88:91],v[252:255]
M a[0:3],a[160:163],a[96:99],a[0:3]
R a[168:171],v5,2048
R a[172:175],v6,2048
M a[0:3],a[164:167],a[100:103],a[0:3]
T a[32:33],v1,32768
T a[34:35],v1,33792
M a[4:7],a[164:167],a[108:111],a[4:7]
SA m0,s24,49152
M a[4:7],a[160:163],a[104:107],a[4:7]
buffer_load_dwordx4 v12, s[48:51], s22 offen offset:0   lds
M a[8:11],a[160:163],a[112:115],a[8:11]
M a[8:11],a[164:167],a[116:119],a[8:11]
M a[12:15],a[164:167],a[124:127],a[12:15]
s_nop 0
T a[36:37],v1,40960
T a[38:39],v1,41984
M a[12:15],a[160:163],a[120:123],a[12:15]
M a[16:19],a[160:163],a[128:131],a[16:19]
buffer_load_dwordx4 v13, s[48:51], s22 offen offset:1024   lds
M a[16:19],a[164:167],a[132:135],a[16:19]
M a[20:23],a[164:167],a[140:143],a[20:23]
M a[20:23],a[160:163],a[136:139],a[20:23]
s_nop 0
T a[40:41],v2,32768
T a[42:43],v2,33792
M a[24:27],a[160:163],a[144:147],a[24:27]
M a[24:27],a[164:167],a[148:151],a[24:27]
s_waitcnt lgkmcnt(6)
buffer_load_dwordx4 v14, s[48:51], s22 offen offset:2048   lds
M a[28:31],a[164:167],a[156:159],a[28:31]
M a[28:31],a[160:163],a[152:155],a[28:31]
M v[32:35],a[168:171],a[96:99],v[32:35]
R a[160:163],v5,4096
R a[164:167],v6,4096
M v[32:35],a[172:175],a[100:103],v[32:35]
T a[44:45],v2,40960
T a[46:47],v2,41984
M v[36:39],a[172:175],a[108:111],v[36:39]
buffer_load_dwordx4 v15, s[48:51], s22 offen offset:3072   lds
M v[36:39],a[168:171],a[104:107],v[36:39]
s_sub_u32 s22, s22, 1048448
M v[40:43],a[168:171],a[112:115],v[40:43]
M v[40:43],a[172:175],a[116:119],v[40:43]
s_nop 0
T a[48:49],v3,32768
T a[50:51],v3,33792
M v[44:47],a[172:175],a[124:127],v[44:47]
SA m0,s23,16384
M v[44:47],a[168:171],a[120:123],v[44:47]
buffer_load_dwordx4 v8, s[16:19], s21 offen offset:0  nt lds
M v[48:51],a[168:171],a[128:131],v[48:51]
M v[48:51],a[172:175],a[132:135],v[48:51]
M v[52:55],a[172:175],a[140:143],v[52:55]
s_nop 0
T a[52:53],v3,40960
T a[54:55],v3,41984
M v[52:55],a[168:171],a[136:139],v[52:55]
M v[56:59],a[168:171],a[144:147],v[56:59]
buffer_load_dwordx4 v9, s[16:19], s21 offen offset:1024  nt lds
M v[56:59],a[172:175],a[148:151],v[56:59]
s_waitcnt lgkmcnt(6)
M v[60:63],a[172:175],a[156:159],v[60:63]
M v[60:63],a[168:171],a[152:155],v[60:63]
s_nop 0
T a[56:57],v4,32768
T a[58:59],v4,33792
M v[64:67],a[160:163],a[96:99],v[64:67]
R a[168:171],v5,6144
R a[172:175],v6,6144
M v[64:67],a[164:167],a[100:103],v[64:67]
buffer_load_dwordx4 v10, s[16:19], s21 offen offset:2048  nt lds
M v[68:71],a[164:167],a[108:111],v[68:71]
M v[68:71],a[160:163],a[104:107],v[68:71]
M v[72:75],a[160:163],a[112:115],v[72:75]
s_nop 0
T a[60:61],v4,40960
T a[62:63],v4,41984
M v[72:75],a[164:167],a[116:119],v[72:75]
M v[76:79],a[164:167],a[124:127],v[76:79]
buffer_load_dwordx4 v11, s[16:19], s21 offen offset:3072  nt lds
M v[76:79],a[160:163],a[120:123],v[76:79]
SA s21,s21,524160
M v[80:83],a[160:163],a[128:131],v[80:83]
M v[80:83],a[164:167],a[132:135],v[80:83]
M v[84:87],a[164:167],a[140:143],v[84:87]
M v[84:87],a[160:163],a[136:139],v[84:87]
M v[88:91],a[160:163],a[144:147],v[88:91]
M v[88:91],a[164:167],a[148:151],v[88:91]
s_waitcnt lgkmcnt(2)
M v[92:95],a[164:167],a[156:159],v[92:95]
s_waitcnt vmcnt(17) lgkmcnt(0)
M v[92:95],a[160:163],a[152:155],v[92:95]
s_barrier
M v[96:99],a[168:171],a[96:99],v[96:99]
R a[160:163],v5,16384
R a[164:167],v6,16384
M v[96:99],a[172:175],a[100:103],v[96:99]
M v[100:103],a[172:175],a[108:111],v[100:103]
SA m0,s24,0
T a[64:65],v1,49152
T a[66:67],v1,50176
M v[100:103],a[168:171],a[104:107],v[100:103]
buffer_load_dwordx4 v12, s[48:51], s22 offen offset:0   lds
M v[104:107],a[168:171],a[112:115],v[104:107]
M v[104:107],a[172:175],a[116:119],v[104:107]
M v[108:111],a[172:175],a[124:127],v[108:111]
M v[108:111],a[168:171],a[120:123],v[108:111]
M v[112:115],a[168:171],a[128:131],v[112:115]
M v[112:115],a[172:175],a[132:135],v[112:115]
s_nop 0
T a[68:69],v1,57344
T a[70:71],v1,58368
M v[116:119],a[172:175],a[140:143],v[116:119]
buffer_load_dwordx4 v13, s[48:51], s22 offen offset:1024   lds
M v[116:119],a[168:171],a[136:139],v[116:119]
M v[120:123],a[168:171],a[144:147],v[120:123]
M v[120:123],a[172:175],a[148:151],v[120:123]
s_waitcnt lgkmcnt(4)
M v[124:127],a[172:175],a[156:159],v[124:127]
M v[124:127],a[168:171],a[152:155],v[124:127]
M v[128:131],a[160:163],a[96:99],v[128:131]
R a[168:171],v5,18432
R a[172:175],v6,18432
M v[128:131],a[164:167],a[100:103],v[128:131]
T a[72:73],v2,49152
T a[74:75],v2,50176
M v[132:135],a[164:167],a[108:111],v[132:135]
buffer_load_dwordx4 v14, s[48:51], s22 offen offset:2048   lds
M v[132:135],a[160:163],a[104:107],v[132:135]
M v[136:139],a[160:163],a[112:115],v[136:139]
M v[136:139],a[164:167],a[116:119],v[136:139]
M v[140:143],a[164:167],a[124:127],v[140:143]
M v[140:143],a[160:163],a[120:123],v[140:143]
s_nop 0
T a[76:77],v2,57344
T a[78:79],v2,58368
M v[144:147],a[160:163],a[128:131],v[144:147]
buffer_load_dwordx4 v15, s[48:51], s22 offen offset:3072   lds
M v[144:147],a[164:167],a[132:135],v[144:147]
SA s22,s22,1048576
M v[148:151],a[164:167],a[140:143],v[148:151]
M v[148:151],a[160:163],a[136:139],v[148:151]
M v[152:155],a[160:163],a[144:147],v[152:155]
M v[152:155],a[164:167],a[148:151],v[152:155]
s_waitcnt lgkmcnt(4)
M v[156:159],a[164:167],a[156:159],v[156:159]
SA m0,s23,32768
T a[80:81],v3,49152
T a[82:83],v3,50176
M v[156:159],a[160:163],a[152:155],v[156:159]
buffer_load_dwordx4 v8, s[16:19], s21 offen offset:0  nt lds
M v[160:163],a[168:171],a[96:99],v[160:163]
R a[160:163],v5,20480
R a[164:167],v6,20480
M v[160:163],a[172:175],a[100:103],v[160:163]
M v[164:167],a[172:175],a[108:111],v[164:167]
M v[164:167],a[168:171],a[104:107],v[164:167]
M v[168:171],a[168:171],a[112:115],v[168:171]
M v[168:171],a[172:175],a[116:119],v[168:171]
s_nop 0
T a[84:85],v3,57344
T a[86:87],v3,58368
M v[172:175],a[172:175],a[124:127],v[172:175]
buffer_load_dwordx4 v9, s[16:19], s21 offen offset:1024  nt lds
M v[172:175],a[168:171],a[120:123],v[172:175]
M v[176:179],a[168:171],a[128:131],v[176:179]
M v[176:179],a[172:175],a[132:135],v[176:179]
M v[180:183],a[172:175],a[140:143],v[180:183]
M v[180:183],a[168:171],a[136:139],v[180:183]
M v[184:187],a[168:171],a[144:147],v[184:187]
s_nop 0
T a[88:89],v4,49152
T a[90:91],v4,50176
M v[184:187],a[172:175],a[148:151],v[184:187]
s_waitcnt lgkmcnt(4)
buffer_load_dwordx4 v10, s[16:19], s21 offen offset:2048  nt lds
M v[188:191],a[172:175],a[156:159],v[188:191]
M v[188:191],a[168:171],a[152:155],v[188:191]
M v[192:195],a[160:163],a[96:99],v[192:195]
R a[168:171],v5,22528
R a[172:175],v6,22528
M v[192:195],a[164:167],a[100:103],v[192:195]
M v[196:199],a[164:167],a[108:111],v[196:199]
M v[196:199],a[160:163],a[104:107],v[196:199]
s_nop 0
T a[92:93],v4,57344
T a[94:95],v4,58368
M v[200:203],a[160:163],a[112:115],v[200:203]
buffer_load_dwordx4 v11, s[16:19], s21 offen offset:3072  nt lds
M v[200:203],a[164:167],a[116:119],v[200:203]
SA s21,s21,128
M v[204:207],a[164:167],a[124:127],v[204:207]
M v[204:207],a[160:163],a[120:123],v[204:207]
M v[208:211],a[160:163],a[128:131],v[208:211]
M v[208:211],a[164:167],a[132:135],v[208:211]
M v[212:215],a[164:167],a[140:143],v[212:215]
M v[212:215],a[160:163],a[136:139],v[212:215]
M v[216:219],a[160:163],a[144:147],v[216:219]
M v[216:219],a[164:167],a[148:151],v[216:219]
s_waitcnt lgkmcnt(2)
M v[220:223],a[164:167],a[156:159],v[220:223]
s_waitcnt vmcnt(17) lgkmcnt(0)
M v[220:223],a[160:163],a[152:155],v[220:223]
s_barrier
M v[224:227],a[168:171],a[96:99],v[224:227]
R a[160:163],v5,32768
R a[164:167],v6,32768
M v[224:227],a[172:175],a[100:103],v[224:227]
buffer_load_dword a240, v23, s[52:55], 0 offen offset:0
M v[228:231],a[172:175],a[108:111],v[228:231]
L_w_kv15:
s_cbranch_execz L_wd2
v_add_u32 v23, 16384, v23
M v[228:231],a[168:171],a[104:107],v[228:231]
M v[232:235],a[168:171],a[112:115],v[232:235]
M v[232:235],a[172:175],a[116:119],v[232:235]
M v[236:239],a[172:175],a[124:127],v[236:239]
M v[236:239],a[168:171],a[120:123],v[236:239]
M v[240:243],a[168:171],a[128:131],v[240:243]
M v[240:243],a[172:175],a[132:135],v[240:243]
M v[244:247],a[172:175],a[140:143],v[244:247]
M v[244:247],a[168:171],a[136:139],v[244:247]
M v[248:251],a[168:171],a[144:147],v[248:251]
M v[248:251],a[172:175],a[148:151],v[248:251]
s_waitcnt lgkmcnt(0)
M v[252:255],a[172:175],a[156:159],v[252:255]
M v[252:255],a[168:171],a[152:155],v[252:255]
M a[0:3],a[160:163],a[32:35],a[0:3]
R a[168:171],v5,34816
R a[172:175],v6,34816
M a[0:3],a[164:167],a[36:39],a[0:3]
T a[96:97],v1,0
T a[98:99],v1,1024
M a[4:7],a[164:167],a[44:47],a[4:7]
SA m0,s24,16384
M a[4:7],a[160:163],a[40:43],a[4:7]
buffer_load_dwordx4 v12, s[48:51], s22 offen offset:0   lds
M a[8:11],a[160:163],a[48:51],a[8:11]
M a[8:11],a[164:167],a[52:55],a[8:11]
M a[12:15],a[164:167],a[60:63],a[12:15]
s_nop 0
T a[100:101],v1,8192
T a[102:103],v1,9216
M a[12:15],a[160:163],a[56:59],a[12:15]
M a[16:19],a[160:163],a[64:67],a[16:19]
buffer_load_dwordx4 v13, s[48:51], s22 offen offset:1024   lds
M a[16:19],a[164:167],a[68:71],a[16:19]
M a[20:23],a[164:167],a[76:79],a[20:23]
M a[20:23],a[160:163],a[72:75],a[20:23]
s_nop 0
T a[104:105],v2,0
T a[106:107],v2,1024
M a[24:27],a[160:163],a[80:83],a[24:27]
M a[24:27],a[164:167],a[84:87],a[24:27]
s_waitcnt lgkmcnt(6)
buffer_load_dwordx4 v14, s[48:51], s22 offen offset:2048   lds
M a[28:31],a[164:167],a[92:95],a[28:31]
M a[28:31],a[160:163],a[88:91],a[28:31]
M v[32:35],a[168:171],a[32:35],v[32:35]
R a[160:163],v5,36864
R a[164:167],v6,36864
M v[32:35],a[172:175],a[36:39],v[32:35]
T a[108:109],v2,8192
T a[110:111],v2,9216
M v[36:39],a[172:175],a[44:47],v[36:39]
buffer_load_dwordx4 v15, s[48:51], s22 offen offset:3072   lds
M v[36:39],a[168:171],a[40:43],v[36:39]
s_sub_u32 s22, s22, 1048448
M v[40:43],a[168:171],a[48:51],v[40:43]
M v[40:43],a[172:175],a[52:55],v[40:43]
s_nop 0
T a[112:113],v3,0
T a[114:115],v3,1024
M v[44:47],a[172:175],a[60:63],v[44:47]
SA m0,s23,49152
M v[44:47],a[168:171],a[56:59],v[44:47]
buffer_load_dwordx4 v8, s[16:19], s21 offen offset:0  nt lds
M v[48:51],a[168:171],a[64:67],v[48:51]
M v[48:51],a[172:175],a[68:71],v[48:51]
M v[52:55],a[172:175],a[76:79],v[52:55]
s_nop 0
T a[116:117],v3,8192
T a[118:119],v3,9216
M v[52:55],a[168:171],a[72:75],v[52:55]
M v[56:59],a[168:171],a[80:83],v[56:59]
buffer_load_dwordx4 v9, s[16:19], s21 offen offset:1024  nt lds
M v[56:59],a[172:175],a[84:87],v[56:59]
s_waitcnt lgkmcnt(6)
M v[60:63],a[172:175],a[92:95],v[60:63]
M v[60:63],a[168:171],a[88:91],v[60:63]
s_nop 0
T a[120:121],v4,0
T a[122:123],v4,1024
M v[64:67],a[160:163],a[32:35],v[64:67]
R a[168:171],v5,38912
R a[172:175],v6,38912
M v[64:67],a[164:167],a[36:39],v[64:67]
buffer_load_dwordx4 v10, s[16:19], s21 offen offset:2048  nt lds
M v[68:71],a[164:167],a[44:47],v[68:71]
M v[68:71],a[160:163],a[40:43],v[68:71]
M v[72:75],a[160:163],a[48:51],v[72:75]
s_nop 0
T a[124:125],v4,8192
T a[126:127],v4,9216
M v[72:75],a[164:167],a[52:55],v[72:75]
M v[76:79],a[164:167],a[60:63],v[76:79]
buffer_load_dwordx4 v11, s[16:19], s21 offen offset:3072  nt lds
M v[76:79],a[160:163],a[56:59],v[76:79]
SA s21,s21,524160
M v[80:83],a[160:163],a[64:67],v[80:83]
M v[80:83],a[164:167],a[68:71],v[80:83]
M v[84:87],a[164:167],a[76:79],v[84:87]
M v[84:87],a[160:163],a[72:75],v[84:87]
M v[88:91],a[160:163],a[80:83],v[88:91]
M v[88:91],a[164:167],a[84:87],v[88:91]
s_waitcnt lgkmcnt(2)
M v[92:95],a[164:167],a[92:95],v[92:95]
s_waitcnt vmcnt(17) lgkmcnt(0)
M v[92:95],a[160:163],a[88:91],v[92:95]
s_barrier
M v[96:99],a[168:171],a[32:35],v[96:99]
R a[160:163],v5,49152
R a[164:167],v6,49152
M v[96:99],a[172:175],a[36:39],v[96:99]
M v[100:103],a[172:175],a[44:47],v[100:103]
SA m0,s24,32768
T a[128:129],v1,16384
T a[130:131],v1,17408
M v[100:103],a[168:171],a[40:43],v[100:103]
buffer_load_dwordx4 v12, s[48:51], s22 offen offset:0   lds
M v[104:107],a[168:171],a[48:51],v[104:107]
M v[104:107],a[172:175],a[52:55],v[104:107]
M v[108:111],a[172:175],a[60:63],v[108:111]
M v[108:111],a[168:171],a[56:59],v[108:111]
M v[112:115],a[168:171],a[64:67],v[112:115]
M v[112:115],a[172:175],a[68:71],v[112:115]
s_nop 0
T a[132:133],v1,24576
T a[134:135],v1,25600
M v[116:119],a[172:175],a[76:79],v[116:119]
buffer_load_dwordx4 v13, s[48:51], s22 offen offset:1024   lds
M v[116:119],a[168:171],a[72:75],v[116:119]
M v[120:123],a[168:171],a[80:83],v[120:123]
M v[120:123],a[172:175],a[84:87],v[120:123]
s_waitcnt lgkmcnt(4)
M v[124:127],a[172:175],a[92:95],v[124:127]
M v[124:127],a[168:171],a[88:91],v[124:127]
M v[128:131],a[160:163],a[32:35],v[128:131]
R a[168:171],v5,51200
R a[172:175],v6,51200
M v[128:131],a[164:167],a[36:39],v[128:131]
T a[136:137],v2,16384
T a[138:139],v2,17408
M v[132:135],a[164:167],a[44:47],v[132:135]
buffer_load_dwordx4 v14, s[48:51], s22 offen offset:2048   lds
M v[132:135],a[160:163],a[40:43],v[132:135]
M v[136:139],a[160:163],a[48:51],v[136:139]
M v[136:139],a[164:167],a[52:55],v[136:139]
M v[140:143],a[164:167],a[60:63],v[140:143]
M v[140:143],a[160:163],a[56:59],v[140:143]
s_nop 0
T a[140:141],v2,24576
T a[142:143],v2,25600
M v[144:147],a[160:163],a[64:67],v[144:147]
buffer_load_dwordx4 v15, s[48:51], s22 offen offset:3072   lds
M v[144:147],a[164:167],a[68:71],v[144:147]
SA s22,s22,1048576
M v[148:151],a[164:167],a[76:79],v[148:151]
M v[148:151],a[160:163],a[72:75],v[148:151]
M v[152:155],a[160:163],a[80:83],v[152:155]
M v[152:155],a[164:167],a[84:87],v[152:155]
s_waitcnt lgkmcnt(4)
M v[156:159],a[164:167],a[92:95],v[156:159]
SA m0,s23,0
T a[144:145],v3,16384
T a[146:147],v3,17408
M v[156:159],a[160:163],a[88:91],v[156:159]
buffer_load_dwordx4 v8, s[16:19], s21 offen offset:0  nt lds
M v[160:163],a[168:171],a[32:35],v[160:163]
R a[160:163],v5,53248
R a[164:167],v6,53248
M v[160:163],a[172:175],a[36:39],v[160:163]
M v[164:167],a[172:175],a[44:47],v[164:167]
M v[164:167],a[168:171],a[40:43],v[164:167]
M v[168:171],a[168:171],a[48:51],v[168:171]
M v[168:171],a[172:175],a[52:55],v[168:171]
s_nop 0
T a[148:149],v3,24576
T a[150:151],v3,25600
M v[172:175],a[172:175],a[60:63],v[172:175]
buffer_load_dwordx4 v9, s[16:19], s21 offen offset:1024  nt lds
M v[172:175],a[168:171],a[56:59],v[172:175]
M v[176:179],a[168:171],a[64:67],v[176:179]
M v[176:179],a[172:175],a[68:71],v[176:179]
M v[180:183],a[172:175],a[76:79],v[180:183]
M v[180:183],a[168:171],a[72:75],v[180:183]
M v[184:187],a[168:171],a[80:83],v[184:187]
s_nop 0
T a[152:153],v4,16384
T a[154:155],v4,17408
M v[184:187],a[172:175],a[84:87],v[184:187]
s_waitcnt lgkmcnt(4)
buffer_load_dwordx4 v10, s[16:19], s21 offen offset:2048  nt lds
M v[188:191],a[172:175],a[92:95],v[188:191]
M v[188:191],a[168:171],a[88:91],v[188:191]
M v[192:195],a[160:163],a[32:35],v[192:195]
R a[168:171],v5,55296
R a[172:175],v6,55296
M v[192:195],a[164:167],a[36:39],v[192:195]
M v[196:199],a[164:167],a[44:47],v[196:199]
M v[196:199],a[160:163],a[40:43],v[196:199]
s_nop 0
T a[156:157],v4,24576
T a[158:159],v4,25600
M v[200:203],a[160:163],a[48:51],v[200:203]
buffer_load_dwordx4 v11, s[16:19], s21 offen offset:3072  nt lds
M v[200:203],a[164:167],a[52:55],v[200:203]
SA s21,s21,128
M v[204:207],a[164:167],a[60:63],v[204:207]
M v[204:207],a[160:163],a[56:59],v[204:207]
M v[208:211],a[160:163],a[64:67],v[208:211]
M v[208:211],a[164:167],a[68:71],v[208:211]
M v[212:215],a[164:167],a[76:79],v[212:215]
M v[212:215],a[160:163],a[72:75],v[212:215]
M v[216:219],a[160:163],a[80:83],v[216:219]
M v[216:219],a[164:167],a[84:87],v[216:219]
s_waitcnt lgkmcnt(2)
M v[220:223],a[164:167],a[92:95],v[220:223]
s_waitcnt vmcnt(17) lgkmcnt(0)
M v[220:223],a[160:163],a[88:91],v[220:223]
s_barrier
M v[224:227],a[168:171],a[32:35],v[224:227]
R a[160:163],v5,0
R a[164:167],v6,0
M v[224:227],a[172:175],a[36:39],v[224:227]
M v[228:231],a[172:175],a[44:47],v[228:231]
M v[228:231],a[168:171],a[40:43],v[228:231]
M v[232:235],a[168:171],a[48:51],v[232:235]
M v[232:235],a[172:175],a[52:55],v[232:235]
M v[236:239],a[172:175],a[60:63],v[236:239]
M v[236:239],a[168:171],a[56:59],v[236:239]
M v[240:243],a[168:171],a[64:67],v[240:243]
M v[240:243],a[172:175],a[68:71],v[240:243]
M v[244:247],a[172:175],a[76:79],v[244:247]
M v[244:247],a[168:171],a[72:75],v[244:247]
M v[248:251],a[168:171],a[80:83],v[248:251]
M v[248:251],a[172:175],a[84:87],v[248:251]
s_waitcnt lgkmcnt(0)
M v[252:255],a[172:175],a[92:95],v[252:255]
M v[252:255],a[168:171],a[88:91],v[252:255]
M a[0:3],a[160:163],a[96:99],a[0:3]
R a[168:171],v5,2048
R a[172:175],v6,2048
M a[0:3],a[164:167],a[100:103],a[0:3]
T a[32:33],v1,32768
T a[34:35],v1,33792
M a[4:7],a[164:167],a[108:111],a[4:7]
SA m0,s24,49152
v_lshrrev_b32 v28, 4, v0
v_and_b32 v29, 7, v0
M a[4:7],a[160:163],a[104:107],a[4:7]
buffer_load_dwordx4 v12, s[48:51], s22 offen offset:0   lds
M a[8:11],a[160:163],a[112:115],a[8:11]
v_xor_b32 v28, v28, v29
v_lshlrev_b32 v28, 4, v28
M a[8:11],a[164:167],a[116:119],a[8:11]
v_lshrrev_b32 v29, 3, v0
v_mul_u32_u24 v29, 896, v29
M a[12:15],a[164:167],a[124:127],a[12:15]
T a[36:37],v1,40960
T a[38:39],v1,41984
M a[12:15],a[160:163],a[120:123],a[12:15]
v_add_u32 v22, v28, v29
v_xor_b32 v28, 64, v28
M a[16:19],a[160:163],a[128:131],a[16:19]
s_mul_i32 s64, s20, 14336
buffer_load_dwordx4 v13, s[48:51], s22 offen offset:1024   lds
M a[16:19],a[164:167],a[132:135],a[16:19]
s_sub_u32 s65, 98304, s64
M a[20:23],a[164:167],a[140:143],a[20:23]
SA s30,s29,s65
M a[20:23],a[160:163],a[136:139],a[20:23]
SA s29,s29,s64
T a[40:41],v2,32768
T a[42:43],v2,33792
M a[24:27],a[160:163],a[144:147],a[24:27]
v_add_u32 v29, 6144, v29
v_add_u32 v23, v28, v29
M a[24:27],a[164:167],a[148:151],a[24:27]
s_waitcnt lgkmcnt(6)
buffer_load_dwordx4 v14, s[48:51], s22 offen offset:2048   lds
M a[28:31],a[164:167],a[156:159],a[28:31]
s_and_b32 s64, s20, 1
M a[28:31],a[160:163],a[152:155],a[28:31]
s_lshl_b32 s64, s64, 12
M v[32:35],a[168:171],a[96:99],v[32:35]
SA s64,s64,65536
R a[160:163],v5,4096
R a[164:167],v6,4096
M v[32:35],a[172:175],a[100:103],v[32:35]
T a[44:45],v2,40960
T a[46:47],v2,41984
M v[36:39],a[172:175],a[108:111],v[36:39]
buffer_load_dwordx4 v15, s[48:51], s22 offen offset:3072   lds
M v[36:39],a[168:171],a[104:107],v[36:39]
s_sub_u32 s22, s22, 1048448
v_add_u32 v20, s64, v5
v_add_u32 v21, s64, v6
M v[40:43],a[168:171],a[112:115],v[40:43]
M v[40:43],a[172:175],a[116:119],v[40:43]
s_nop 0
T a[48:49],v3,32768
T a[50:51],v3,33792
M v[44:47],a[172:175],a[124:127],v[44:47]
SA m0,s23,16384
M v[44:47],a[168:171],a[120:123],v[44:47]
buffer_load_dwordx4 v8, s[16:19], s21 offen offset:0  nt lds
M v[48:51],a[168:171],a[128:131],v[48:51]
M v[48:51],a[172:175],a[132:135],v[48:51]
M v[52:55],a[172:175],a[140:143],v[52:55]
s_nop 0
T a[52:53],v3,40960
T a[54:55],v3,41984
M v[52:55],a[168:171],a[136:139],v[52:55]
M v[56:59],a[168:171],a[144:147],v[56:59]
buffer_load_dwordx4 v9, s[16:19], s21 offen offset:1024  nt lds
M v[56:59],a[172:175],a[148:151],v[56:59]
s_waitcnt lgkmcnt(6)
M v[60:63],a[172:175],a[156:159],v[60:63]
M v[60:63],a[168:171],a[152:155],v[60:63]
s_nop 0
T a[56:57],v4,32768
T a[58:59],v4,33792
M v[64:67],a[160:163],a[96:99],v[64:67]
R a[168:171],v5,6144
R a[172:175],v6,6144
M v[64:67],a[164:167],a[100:103],v[64:67]
buffer_load_dwordx4 v10, s[16:19], s21 offen offset:2048  nt lds
M v[68:71],a[164:167],a[108:111],v[68:71]
M v[68:71],a[160:163],a[104:107],v[68:71]
M v[72:75],a[160:163],a[112:115],v[72:75]
s_nop 0
T a[60:61],v4,40960
T a[62:63],v4,41984
M v[72:75],a[164:167],a[116:119],v[72:75]
M v[76:79],a[164:167],a[124:127],v[76:79]
buffer_load_dwordx4 v11, s[16:19], s21 offen offset:3072  nt lds
M v[76:79],a[160:163],a[120:123],v[76:79]
SA s21,s21,524160
M v[80:83],a[160:163],a[128:131],v[80:83]
M v[80:83],a[164:167],a[132:135],v[80:83]
M v[84:87],a[164:167],a[140:143],v[84:87]
M v[84:87],a[160:163],a[136:139],v[84:87]
M v[88:91],a[160:163],a[144:147],v[88:91]
M v[88:91],a[164:167],a[148:151],v[88:91]
s_waitcnt lgkmcnt(2)
M v[92:95],a[164:167],a[156:159],v[92:95]
s_waitcnt vmcnt(16) lgkmcnt(0)
M v[92:95],a[160:163],a[152:155],v[92:95]
s_barrier
M v[96:99],a[168:171],a[96:99],v[96:99]
R a[160:163],v5,16384
R a[164:167],v6,16384
M v[96:99],a[172:175],a[100:103],v[96:99]
SA m0,s23,131072
M v[100:103],a[172:175],a[108:111],v[100:103]
s_nop 0
T a[64:65],v1,49152
T a[66:67],v1,50176
M v[100:103],a[168:171],a[104:107],v[100:103]
buffer_load_dwordx4 v22, s[56:59], s29 offen offset:0 lds
M v[104:107],a[168:171],a[112:115],v[104:107]
M v[104:107],a[172:175],a[116:119],v[104:107]
M v[108:111],a[172:175],a[124:127],v[108:111]
buffer_load_dwordx4 v23, s[56:59], s29 offen offset:1024 lds
M v[108:111],a[168:171],a[120:123],v[108:111]
M v[112:115],a[168:171],a[128:131],v[112:115]
M v[112:115],a[172:175],a[132:135],v[112:115]
s_nop 0
T a[68:69],v1,57344
T a[70:71],v1,58368
M v[116:119],a[172:175],a[140:143],v[116:119]
buffer_load_dwordx4 v22, s[56:59], s30 offen offset:2048 lds
M v[116:119],a[168:171],a[136:139],v[116:119]
M v[120:123],a[168:171],a[144:147],v[120:123]
M v[120:123],a[172:175],a[148:151],v[120:123]
s_waitcnt lgkmcnt(4)
M v[124:127],a[172:175],a[156:159],v[124:127]
M v[124:127],a[168:171],a[152:155],v[124:127]
buffer_load_dwordx4 v23, s[56:59], s30 offen offset:3072 lds
M v[128:131],a[160:163],a[96:99],v[128:131]
R a[168:171],v5,18432
R a[172:175],v6,18432
M v[128:131],a[164:167],a[100:103],v[128:131]
SA s29,s29,128
T a[72:73],v2,49152
T a[74:75],v2,50176
M v[132:135],a[164:167],a[108:111],v[132:135]
SA s30,s30,128
M v[132:135],a[160:163],a[104:107],v[132:135]
SA m0,s24,0
M v[136:139],a[160:163],a[112:115],v[136:139]
buffer_load_dwordx4 v12, s[48:51], s22 offen offset:0   lds
M v[136:139],a[164:167],a[116:119],v[136:139]
M v[140:143],a[164:167],a[124:127],v[140:143]
M v[140:143],a[160:163],a[120:123],v[140:143]
s_nop 0
T a[76:77],v2,57344
T a[78:79],v2,58368
M v[144:147],a[160:163],a[128:131],v[144:147]
buffer_load_dwordx4 v13, s[48:51], s22 offen offset:1024   lds
M v[144:147],a[164:167],a[132:135],v[144:147]
M v[148:151],a[164:167],a[140:143],v[148:151]
M v[148:151],a[160:163],a[136:139],v[148:151]
M v[152:155],a[160:163],a[144:147],v[152:155]
M v[152:155],a[164:167],a[148:151],v[152:155]
s_waitcnt lgkmcnt(4)
buffer_load_dwordx4 v14, s[48:51], s22 offen offset:2048   lds
M v[156:159],a[164:167],a[156:159],v[156:159]
s_nop 0
T a[80:81],v3,49152
T a[82:83],v3,50176
M v[156:159],a[160:163],a[152:155],v[156:159]
M v[160:163],a[168:171],a[96:99],v[160:163]
R a[160:163],v5,20480
R a[164:167],v6,20480
M v[160:163],a[172:175],a[100:103],v[160:163]
M v[164:167],a[172:175],a[108:111],v[164:167]
buffer_load_dwordx4 v15, s[48:51], s22 offen offset:3072   lds
M v[164:167],a[168:171],a[104:107],v[164:167]
M v[168:171],a[168:171],a[112:115],v[168:171]
M v[168:171],a[172:175],a[116:119],v[168:171]
SA s22,s22,1048576
T a[84:85],v3,57344
T a[86:87],v3,58368
M v[172:175],a[172:175],a[124:127],v[172:175]
SA m0,s23,32768
M v[172:175],a[168:171],a[120:123],v[172:175]
buffer_load_dwordx4 v8, s[16:19], s21 offen offset:0  nt lds
M v[176:179],a[168:171],a[128:131],v[176:179]
M v[176:179],a[172:175],a[132:135],v[176:179]
M v[180:183],a[172:175],a[140:143],v[180:183]
M v[180:183],a[168:171],a[136:139],v[180:183]
buffer_load_dwordx4 v9, s[16:19], s21 offen offset:1024  nt lds
M v[184:187],a[168:171],a[144:147],v[184:187]
s_nop 0
T a[88:89],v4,49152
T a[90:91],v4,50176
M v[184:187],a[172:175],a[148:151],v[184:187]
s_waitcnt lgkmcnt(4)
M v[188:191],a[172:175],a[156:159],v[188:191]
M v[188:191],a[168:171],a[152:155],v[188:191]
M v[192:195],a[160:163],a[96:99],v[192:195]
R a[168:171],v5,22528
R a[172:175],v6,22528
M v[192:195],a[164:167],a[100:103],v[192:195]
buffer_load_dwordx4 v10, s[16:19], s21 offen offset:2048  nt lds
M v[196:199],a[164:167],a[108:111],v[196:199]
M v[196:199],a[160:163],a[104:107],v[196:199]
s_nop 0
T a[92:93],v4,57344
T a[94:95],v4,58368
M v[200:203],a[160:163],a[112:115],v[200:203]
M v[200:203],a[164:167],a[116:119],v[200:203]
buffer_load_dwordx4 v11, s[16:19], s21 offen offset:3072  nt lds
M v[204:207],a[164:167],a[124:127],v[204:207]
M v[204:207],a[160:163],a[120:123],v[204:207]
M v[208:211],a[160:163],a[128:131],v[208:211]
M v[208:211],a[164:167],a[132:135],v[208:211]
M v[212:215],a[164:167],a[140:143],v[212:215]
SA s21,s21,128
M v[212:215],a[160:163],a[136:139],v[212:215]
M v[216:219],a[160:163],a[144:147],v[216:219]
M v[216:219],a[164:167],a[148:151],v[216:219]
s_waitcnt lgkmcnt(2)
M v[220:223],a[164:167],a[156:159],v[220:223]
s_waitcnt vmcnt(20) lgkmcnt(0)
M v[220:223],a[160:163],a[152:155],v[220:223]
s_barrier
M v[224:227],a[168:171],a[96:99],v[224:227]
R a[160:163],v5,32768
R a[164:167],v6,32768
M v[224:227],a[172:175],a[100:103],v[224:227]
M v[228:231],a[172:175],a[108:111],v[228:231]
M v[228:231],a[168:171],a[104:107],v[228:231]
M v[232:235],a[168:171],a[112:115],v[232:235]
M v[232:235],a[172:175],a[116:119],v[232:235]
M v[236:239],a[172:175],a[124:127],v[236:239]
M v[236:239],a[168:171],a[120:123],v[236:239]
M v[240:243],a[168:171],a[128:131],v[240:243]
M v[240:243],a[172:175],a[132:135],v[240:243]
M v[244:247],a[172:175],a[140:143],v[244:247]
M v[244:247],a[168:171],a[136:139],v[244:247]
M v[248:251],a[168:171],a[144:147],v[248:251]
M v[248:251],a[172:175],a[148:151],v[248:251]
s_waitcnt lgkmcnt(0)
M v[252:255],a[172:175],a[156:159],v[252:255]
M v[252:255],a[168:171],a[152:155],v[252:255]
M a[0:3],a[160:163],a[32:35],a[0:3]
R a[168:171],v5,34816
R a[172:175],v6,34816
M a[0:3],a[164:167],a[36:39],a[0:3]
SA m0,s23,147456
T a[96:97],v1,0
T a[98:99],v1,1024
M a[4:7],a[164:167],a[44:47],a[4:7]
buffer_load_dwordx4 v22, s[56:59], s29 offen offset:0 lds
M a[4:7],a[160:163],a[40:43],a[4:7]
M a[8:11],a[160:163],a[48:51],a[8:11]
M a[8:11],a[164:167],a[52:55],a[8:11]
buffer_load_dwordx4 v23, s[56:59], s29 offen offset:1024 lds
M a[12:15],a[164:167],a[60:63],a[12:15]
s_nop 0
T a[100:101],v1,8192
T a[102:103],v1,9216
M a[12:15],a[160:163],a[56:59],a[12:15]
M a[16:19],a[160:163],a[64:67],a[16:19]
buffer_load_dwordx4 v22, s[56:59], s30 offen offset:2048 lds
M a[16:19],a[164:167],a[68:71],a[16:19]
M a[20:23],a[164:167],a[76:79],a[20:23]
M a[20:23],a[160:163],a[72:75],a[20:23]
s_nop 0
T a[104:105],v2,0
T a[106:107],v2,1024
M a[24:27],a[160:163],a[80:83],a[24:27]
buffer_load_dwordx4 v23, s[56:59], s30 offen offset:3072 lds
M a[24:27],a[164:167],a[84:87],a[24:27]
s_waitcnt lgkmcnt(6)
M a[28:31],a[164:167],a[92:95],a[28:31]
SA s29,s29,128
M a[28:31],a[160:163],a[88:91],a[28:31]
SA s30,s30,128
M v[32:35],a[168:171],a[32:35],v[32:35]
SA m0,s24,16384
R a[160:163],v5,36864
R a[164:167],v6,36864
M v[32:35],a[172:175],a[36:39],v[32:35]
T a[108:109],v2,8192
T a[110:111],v2,9216
M v[36:39],a[172:175],a[44:47],v[36:39]
buffer_load_dwordx4 v12, s[48:51], s22 offen offset:0   lds
M v[36:39],a[168:171],a[40:43],v[36:39]
M v[40:43],a[168:171],a[48:51],v[40:43]
M v[40:43],a[172:175],a[52:55],v[40:43]
s_nop 0
T a[112:113],v3,0
T a[114:115],v3,1024
M v[44:47],a[172:175],a[60:63],v[44:47]
buffer_load_dwordx4 v13, s[48:51], s22 offen offset:1024   lds
M v[44:47],a[168:171],a[56:59],v[44:47]
M v[48:51],a[168:171],a[64:67],v[48:51]
M v[48:51],a[172:175],a[68:71],v[48:51]
buffer_load_dwordx4 v14, s[48:51], s22 offen offset:2048   lds
M v[52:55],a[172:175],a[76:79],v[52:55]
s_nop 0
T a[116:117],v3,8192
T a[118:119],v3,9216
L_w_kv16:
s_cbranch_execz L_wd2
M v[52:55],a[168:171],a[72:75],v[52:55]
M v[56:59],a[168:171],a[80:83],v[56:59]
buffer_load_dwordx4 v15, s[48:51], s22 offen offset:3072   lds
M v[56:59],a[172:175],a[84:87],v[56:59]
s_waitcnt lgkmcnt(6)
M v[60:63],a[172:175],a[92:95],v[60:63]
s_sub_u32 s22, s22, 1048448
M v[60:63],a[168:171],a[88:91],v[60:63]
SA m0,s23,49152
T a[120:121],v4,0
T a[122:123],v4,1024
M v[64:67],a[160:163],a[32:35],v[64:67]
R a[168:171],v5,38912
R a[172:175],v6,38912
M v[64:67],a[164:167],a[36:39],v[64:67]
buffer_load_dwordx4 v8, s[16:19], s21 offen offset:0  nt lds
M v[68:71],a[164:167],a[44:47],v[68:71]
M v[68:71],a[160:163],a[40:43],v[68:71]
M v[72:75],a[160:163],a[48:51],v[72:75]
s_waitcnt vmcnt(17)
s_nop 0
T a[124:125],v4,8192
T a[126:127],v4,9216
M v[72:75],a[164:167],a[52:55],v[72:75]
buffer_load_dwordx4 v9, s[16:19], s21 offen offset:1024  nt lds
M v[76:79],a[164:167],a[60:63],v[76:79]
R a[176:179],v20,0
R a[180:183],v20,2048
M v[76:79],a[160:163],a[56:59],v[76:79]
R a[184:187],v21,0
R a[188:191],v21,2048
M v[80:83],a[160:163],a[64:67],v[80:83]
buffer_load_dwordx4 v10, s[16:19], s21 offen offset:2048  nt lds
M v[80:83],a[164:167],a[68:71],v[80:83]
M v[84:87],a[164:167],a[76:79],v[84:87]
M v[84:87],a[160:163],a[72:75],v[84:87]
buffer_load_dwordx4 v11, s[16:19], s21 offen offset:3072  nt lds
M v[88:91],a[160:163],a[80:83],v[88:91]
SA s21,s21,524160
M v[88:91],a[164:167],a[84:87],v[88:91]
s_waitcnt lgkmcnt(6)
M v[92:95],a[164:167],a[92:95],v[92:95]
s_waitcnt lgkmcnt(0)
M v[92:95],a[160:163],a[88:91],v[92:95]
s_barrier
M v[96:99],a[168:171],a[32:35],v[96:99]
s_lshl_b32 s4, s20, 10
R a[160:163],v5,49152
R a[164:167],v6,49152
M v[96:99],a[172:175],a[36:39],v[96:99]
SA m0,s23,131072
v_bfe_u32 v28, v0, 3, 2
M v[100:103],a[172:175],a[44:47],v[100:103]
s_nop 0
T a[128:129],v1,16384
T a[130:131],v1,17408
M v[100:103],a[168:171],a[40:43],v[100:103]
buffer_load_dwordx4 v22, s[56:59], s29 offen offset:0 lds
M v[104:107],a[168:171],a[48:51],v[104:107]
v_lshrrev_b32 v29, 5, v0
v_lshl_add_u32 v28, v29, 3, v28
M v[104:107],a[172:175],a[52:55],v[104:107]
M v[108:111],a[172:175],a[60:63],v[108:111]
buffer_load_dwordx4 v23, s[56:59], s29 offen offset:1024 lds
M v[108:111],a[168:171],a[56:59],v[108:111]
v_lshlrev_b32 v28, 13, v28
M v[112:115],a[168:171],a[64:67],v[112:115]
v_lshrrev_b32 v29, 4, v0
M v[112:115],a[172:175],a[68:71],v[112:115]
s_nop 0
T a[132:133],v1,24576
T a[134:135],v1,25600
M v[116:119],a[172:175],a[76:79],v[116:119]
buffer_load_dwordx4 v22, s[56:59], s30 offen offset:2048 lds
M v[116:119],a[168:171],a[72:75],v[116:119]
v_lshlrev_b32 v29, 1, v29
M v[120:123],a[168:171],a[80:83],v[120:123]
v_and_b32 v30, 7, v0
M v[120:123],a[172:175],a[84:87],v[120:123]
s_waitcnt lgkmcnt(4)
M v[124:127],a[172:175],a[92:95],v[124:127]
v_xor_b32 v29, v29, v30
M v[124:127],a[168:171],a[88:91],v[124:127]
buffer_load_dwordx4 v23, s[56:59], s30 offen offset:3072 lds
M v[128:131],a[160:163],a[32:35],v[128:131]
R a[168:171],v5,51200
R a[172:175],v6,51200
M v[128:131],a[164:167],a[36:39],v[128:131]
SA s29,s29,128
T a[136:137],v2,16384
T a[138:139],v2,17408
M v[132:135],a[164:167],a[44:47],v[132:135]
SA s30,s30,128
v_lshl_add_u32 v28, v29, 4, v28
M v[132:135],a[160:163],a[40:43],v[132:135]
s_and_b32 s64, s20, 1
M v[136:139],a[160:163],a[48:51],v[136:139]
s_lshl_b32 s64, s64, 17
M v[136:139],a[164:167],a[52:55],v[136:139]
s_lshr_b32 s65, s20, 1
M v[140:143],a[164:167],a[60:63],v[140:143]
s_lshl_b32 s65, s65, 15
SA s64,s64,s65
v_add_u32 v8, s64, v28
M v[140:143],a[160:163],a[56:59],v[140:143]
SA m0,s24,32768
T a[140:141],v2,24576
T a[142:143],v2,25600
M v[144:147],a[160:163],a[64:67],v[144:147]
buffer_load_dwordx4 v12, s[48:51], s22 offen offset:0   lds
M v[144:147],a[164:167],a[68:71],v[144:147]
M v[148:151],a[164:167],a[76:79],v[148:151]
M v[148:151],a[160:163],a[72:75],v[148:151]
buffer_load_dwordx4 v13, s[48:51], s22 offen offset:1024   lds
M v[152:155],a[160:163],a[80:83],v[152:155]
M v[152:155],a[164:167],a[84:87],v[152:155]
s_waitcnt lgkmcnt(4)
M v[156:159],a[164:167],a[92:95],v[156:159]
s_nop 0
T a[144:145],v3,16384
T a[146:147],v3,17408
M v[156:159],a[160:163],a[88:91],v[156:159]
buffer_load_dwordx4 v14, s[48:51], s22 offen offset:2048   lds
M v[160:163],a[168:171],a[32:35],v[160:163]
R a[160:163],v5,53248
R a[164:167],v6,53248
M v[160:163],a[172:175],a[36:39],v[160:163]
M v[164:167],a[172:175],a[44:47],v[164:167]
buffer_load_dwordx4 v15, s[48:51], s22 offen offset:3072   lds
M v[164:167],a[168:171],a[40:43],v[164:167]
M v[168:171],a[168:171],a[48:51],v[168:171]
SA s22,s22,1048576
M v[168:171],a[172:175],a[52:55],v[168:171]
s_mov_b32 s25, 0
T a[148:149],v3,24576
T a[150:151],v3,25600
M v[172:175],a[172:175],a[60:63],v[172:175]
SA m0,s4,0
M v[172:175],a[168:171],a[56:59],v[172:175]
buffer_load_dwordx4 v8, s[52:55], s25 offen lds
M v[176:179],a[168:171],a[64:67],v[176:179]
M v[176:179],a[172:175],a[68:71],v[176:179]
s_mov_b32 s25, 262144
M v[180:183],a[172:175],a[76:79],v[180:183]
SA m0,s4,4096
M v[180:183],a[168:171],a[72:75],v[180:183]
buffer_load_dwordx4 v8, s[52:55], s25 offen lds
M v[184:187],a[168:171],a[80:83],v[184:187]
s_nop 0
T a[152:153],v4,16384
T a[154:155],v4,17408
M v[184:187],a[172:175],a[84:87],v[184:187]
s_waitcnt lgkmcnt(4)
M v[188:191],a[172:175],a[92:95],v[188:191]
s_mov_b32 s25, 524288
M v[188:191],a[168:171],a[88:91],v[188:191]
SA m0,s4,8192
M v[192:195],a[160:163],a[32:35],v[192:195]
R a[168:171],v5,55296
R a[172:175],v6,55296
M v[192:195],a[164:167],a[36:39],v[192:195]
buffer_load_dwordx4 v8, s[52:55], s25 offen lds
M v[196:199],a[164:167],a[44:47],v[196:199]
M v[196:199],a[160:163],a[40:43],v[196:199]
s_mov_b32 s25, 786432
T a[156:157],v4,24576
T a[158:159],v4,25600
M v[200:203],a[160:163],a[48:51],v[200:203]
SA m0,s4,12288
M v[200:203],a[164:167],a[52:55],v[200:203]
s_waitcnt vmcnt(19)
buffer_load_dwordx4 v8, s[52:55], s25 offen lds
M v[204:207],a[164:167],a[60:63],v[204:207]
R a[192:195],v20,16384
R a[196:199],v20,18432
M v[204:207],a[160:163],a[56:59],v[204:207]
R a[200:203],v21,16384
R a[204:207],v21,18432
M v[208:211],a[160:163],a[64:67],v[208:211]
M v[208:211],a[164:167],a[68:71],v[208:211]
M v[212:215],a[164:167],a[76:79],v[212:215]
M v[212:215],a[160:163],a[72:75],v[212:215]
M v[216:219],a[160:163],a[80:83],v[216:219]
M v[216:219],a[164:167],a[84:87],v[216:219]
s_waitcnt lgkmcnt(6)
M v[220:223],a[164:167],a[92:95],v[220:223]
s_waitcnt lgkmcnt(0)
M v[220:223],a[160:163],a[88:91],v[220:223]
s_barrier
M v[224:227],a[168:171],a[32:35],v[224:227]
R a[160:163],v5,0
R a[164:167],v6,0
M v[224:227],a[172:175],a[36:39],v[224:227]
M v[228:231],a[172:175],a[44:47],v[228:231]
M v[228:231],a[168:171],a[40:43],v[228:231]
M v[232:235],a[168:171],a[48:51],v[232:235]
M v[232:235],a[172:175],a[52:55],v[232:235]
M v[236:239],a[172:175],a[60:63],v[236:239]
M v[236:239],a[168:171],a[56:59],v[236:239]
M v[240:243],a[168:171],a[64:67],v[240:243]
M v[240:243],a[172:175],a[68:71],v[240:243]
M v[244:247],a[172:175],a[76:79],v[244:247]
M v[244:247],a[168:171],a[72:75],v[244:247]
M v[248:251],a[168:171],a[80:83],v[248:251]
M v[248:251],a[172:175],a[84:87],v[248:251]
s_waitcnt lgkmcnt(0)
M v[252:255],a[172:175],a[92:95],v[252:255]
M v[252:255],a[168:171],a[88:91],v[252:255]
M a[0:3],a[160:163],a[96:99],a[0:3]
R a[168:171],v5,2048
R a[172:175],v6,2048
M a[0:3],a[164:167],a[100:103],a[0:3]
SA m0,s23,147456
T a[32:33],v1,32768
T a[34:35],v1,33792
M a[4:7],a[164:167],a[108:111],a[4:7]
buffer_load_dwordx4 v22, s[56:59], s29 offen offset:0 lds
M a[4:7],a[160:163],a[104:107],a[4:7]
M a[8:11],a[160:163],a[112:115],a[8:11]
M a[8:11],a[164:167],a[116:119],a[8:11]
buffer_load_dwordx4 v23, s[56:59], s29 offen offset:1024 lds
M a[12:15],a[164:167],a[124:127],a[12:15]
s_nop 0
T a[36:37],v1,40960
T a[38:39],v1,41984
M a[12:15],a[160:163],a[120:123],a[12:15]
M a[16:19],a[160:163],a[128:131],a[16:19]
buffer_load_dwordx4 v22, s[56:59], s30 offen offset:2048 lds
M a[16:19],a[164:167],a[132:135],a[16:19]
M a[20:23],a[164:167],a[140:143],a[20:23]
M a[20:23],a[160:163],a[136:139],a[20:23]
s_nop 0
T a[40:41],v2,32768
T a[42:43],v2,33792
M a[24:27],a[160:163],a[144:147],a[24:27]
buffer_load_dwordx4 v23, s[56:59], s30 offen offset:3072 lds
M a[24:27],a[164:167],a[148:151],a[24:27]
s_waitcnt lgkmcnt(6)
M a[28:31],a[164:167],a[156:159],a[28:31]
SA s29,s29,128
M a[28:31],a[160:163],a[152:155],a[28:31]
SA s30,s30,128
M v[32:35],a[168:171],a[96:99],v[32:35]
SA m0,s24,49152
R a[160:163],v5,4096
R a[164:167],v6,4096
M v[32:35],a[172:175],a[100:103],v[32:35]
T a[44:45],v2,40960
T a[46:47],v2,41984
M v[36:39],a[172:175],a[108:111],v[36:39]
buffer_load_dwordx4 v12, s[48:51], s22 offen offset:0   lds
M v[36:39],a[168:171],a[104:107],v[36:39]
M v[40:43],a[168:171],a[112:115],v[40:43]
M v[40:43],a[172:175],a[116:119],v[40:43]
s_nop 0
T a[48:49],v3,32768
T a[50:51],v3,33792
M v[44:47],a[172:175],a[124:127],v[44:47]
buffer_load_dwordx4 v13, s[48:51], s22 offen offset:1024   lds
M v[44:47],a[168:171],a[120:123],v[44:47]
M v[48:51],a[168:171],a[128:131],v[48:51]
M v[48:51],a[172:175],a[132:135],v[48:51]
buffer_load_dwordx4 v14, s[48:51], s22 offen offset:2048   lds
M v[52:55],a[172:175],a[140:143],v[52:55]
s_nop 0
T a[52:53],v3,40960
T a[54:55],v3,41984
M v[52:55],a[168:171],a[136:139],v[52:55]
M v[56:59],a[168:171],a[144:147],v[56:59]
buffer_load_dwordx4 v15, s[48:51], s22 offen offset:3072   lds
M v[56:59],a[172:175],a[148:151],v[56:59]
s_waitcnt lgkmcnt(6)
M v[60:63],a[172:175],a[156:159],v[60:63]
s_sub_u32 s22, s22, 1048448
M v[60:63],a[168:171],a[152:155],v[60:63]
s_mov_b32 s25, 1048576
T a[56:57],v4,32768
T a[58:59],v4,33792
M v[64:67],a[160:163],a[96:99],v[64:67]
SA m0,s4,16384
R a[168:171],v5,6144
R a[172:175],v6,6144
M v[64:67],a[164:167],a[100:103],v[64:67]
buffer_load_dwordx4 v8, s[52:55], s25 offen lds
M v[68:71],a[164:167],a[108:111],v[68:71]
s_mov_b32 s25, 1310720
M v[68:71],a[160:163],a[104:107],v[68:71]
SA m0,s4,20480
M v[72:75],a[160:163],a[112:115],v[72:75]
s_waitcnt vmcnt(17)
s_nop 0
T a[60:61],v4,40960
T a[62:63],v4,41984
M v[72:75],a[164:167],a[116:119],v[72:75]
buffer_load_dwordx4 v8, s[52:55], s25 offen lds
M v[76:79],a[164:167],a[124:127],v[76:79]
s_mov_b32 s25, 1572864
R a[208:211],v20,0
R a[212:215],v20,2048
M v[76:79],a[160:163],a[120:123],v[76:79]
SA m0,s4,24576
R a[216:219],v21,0
R a[220:223],v21,2048
M v[80:83],a[160:163],a[128:131],v[80:83]
buffer_load_dwordx4 v8, s[52:55], s25 offen lds
M v[80:83],a[164:167],a[132:135],v[80:83]
s_mov_b32 s25, 1835008
M v[84:87],a[164:167],a[140:143],v[84:87]
SA m0,s4,28672
M v[84:87],a[160:163],a[136:139],v[84:87]
buffer_load_dwordx4 v8, s[52:55], s25 offen lds
M v[88:91],a[160:163],a[144:147],v[88:91]
M v[88:91],a[164:167],a[148:151],v[88:91]
s_waitcnt lgkmcnt(6)
M v[92:95],a[164:167],a[156:159],v[92:95]
s_waitcnt lgkmcnt(0)
M v[92:95],a[160:163],a[152:155],v[92:95]
s_barrier
M v[96:99],a[168:171],a[96:99],v[96:99]
R a[160:163],v5,16384
R a[164:167],v6,16384
M v[96:99],a[172:175],a[100:103],v[96:99]
SA m0,s23,32768
M v[100:103],a[172:175],a[108:111],v[100:103]
s_nop 0
T a[64:65],v1,49152
T a[66:67],v1,50176
M v[100:103],a[168:171],a[104:107],v[100:103]
buffer_load_dwordx4 v22, s[56:59], s29 offen offset:0 lds
M v[104:107],a[168:171],a[112:115],v[104:107]
v_lshrrev_b32 v28, 2, v0
v_lshlrev_b32 v28, 7, v28
M v[104:107],a[172:175],a[116:119],v[104:107]
M v[108:111],a[172:175],a[124:127],v[108:111]
buffer_load_dwordx4 v23, s[56:59], s29 offen offset:1024 lds
M v[108:111],a[168:171],a[120:123],v[108:111]
v_and_b32 v29, 3, v0
M v[112:115],a[168:171],a[128:131],v[112:115]
v_lshl_add_u32 v28, v29, 3, v28
M v[112:115],a[172:175],a[132:135],v[112:115]
s_nop 0
T a[68:69],v1,57344
T a[70:71],v1,58368
M v[116:119],a[172:175],a[140:143],v[116:119]
buffer_load_dwordx4 v22, s[56:59], s30 offen offset:2048 lds
M v[116:119],a[168:171],a[136:139],v[116:119]
v_bfe_u32 v29, v0, 3, 2
M v[120:123],a[168:171],a[144:147],v[120:123]
M v[120:123],a[172:175],a[148:151],v[120:123]
s_waitcnt lgkmcnt(4)
v_lshl_add_u32 v16, v29, 5, v28
M v[124:127],a[172:175],a[156:159],v[124:127]
M v[124:127],a[168:171],a[152:155],v[124:127]
buffer_load_dwordx4 v23, s[56:59], s30 offen offset:3072 lds
M v[128:131],a[160:163],a[96:99],v[128:131]
R a[168:171],v5,18432
R a[172:175],v6,18432
M v[128:131],a[164:167],a[100:103],v[128:131]
SA s29,s29,128
T a[72:73],v2,49152
T a[74:75],v2,50176
M v[132:135],a[164:167],a[108:111],v[132:135]
SA s30,s30,128
v_xor_b32 v17, 32, v16
v_xor_b32 v18, 64, v16
M v[132:135],a[160:163],a[104:107],v[132:135]
SA m0,s23,65536
M v[136:139],a[160:163],a[112:115],v[136:139]
buffer_load_dwordx4 v22, s[56:59], s29 offen offset:0 lds
M v[136:139],a[164:167],a[116:119],v[136:139]
v_xor_b32 v19, 0x60, v16
M v[140:143],a[164:167],a[124:127],v[140:143]
v_add_u32 v12, 0x20000, v16
M v[140:143],a[160:163],a[120:123],v[140:143]
s_nop 0
T a[76:77],v2,57344
T a[78:79],v2,58368
M v[144:147],a[160:163],a[128:131],v[144:147]
buffer_load_dwordx4 v23, s[56:59], s29 offen offset:1024 lds
M v[144:147],a[164:167],a[132:135],v[144:147]
v_add_u32 v13, 0x20000, v17
M v[148:151],a[164:167],a[140:143],v[148:151]
M v[148:151],a[160:163],a[136:139],v[148:151]
v_add_u32 v14, 0x20000, v18
M v[152:155],a[160:163],a[144:147],v[152:155]
M v[152:155],a[164:167],a[148:151],v[152:155]
s_waitcnt lgkmcnt(4)
buffer_load_dwordx4 v22, s[56:59], s30 offen offset:2048 lds
M v[156:159],a[164:167],a[156:159],v[156:159]
s_nop 0
T a[80:81],v3,49152
T a[82:83],v3,50176
M v[156:159],a[160:163],a[152:155],v[156:159]
v_add_u32 v15, 0x20000, v19
M v[160:163],a[168:171],a[96:99],v[160:163]
R a[160:163],v5,20480
R a[164:167],v6,20480
M v[160:163],a[172:175],a[100:103],v[160:163]
M v[164:167],a[172:175],a[108:111],v[164:167]
buffer_load_dwordx4 v23, s[56:59], s30 offen offset:3072 lds
M v[164:167],a[168:171],a[104:107],v[164:167]
SA s29,s29,128
M v[168:171],a[168:171],a[112:115],v[168:171]
SA s30,s30,128
M v[168:171],a[172:175],a[116:119],v[168:171]
s_mov_b32 s25, 2097152
T a[84:85],v3,57344
T a[86:87],v3,58368
M v[172:175],a[172:175],a[124:127],v[172:175]
SA m0,s4,131072
M v[172:175],a[168:171],a[120:123],v[172:175]
buffer_load_dwordx4 v8, s[52:55], s25 offen lds
M v[176:179],a[168:171],a[128:131],v[176:179]
M v[176:179],a[172:175],a[132:135],v[176:179]
s_mov_b32 s25, 2359296
M v[180:183],a[172:175],a[140:143],v[180:183]
SA m0,s4,135168
M v[180:183],a[168:171],a[136:139],v[180:183]
buffer_load_dwordx4 v8, s[52:55], s25 offen lds
M v[184:187],a[168:171],a[144:147],v[184:187]
s_nop 0
T a[88:89],v4,49152
T a[90:91],v4,50176
M v[184:187],a[172:175],a[148:151],v[184:187]
s_waitcnt lgkmcnt(4)
M v[188:191],a[172:175],a[156:159],v[188:191]
s_mov_b32 s25, 2621440
M v[188:191],a[168:171],a[152:155],v[188:191]
SA m0,s4,139264
M v[192:195],a[160:163],a[96:99],v[192:195]
R a[168:171],v5,22528
R a[172:175],v6,22528
M v[192:195],a[164:167],a[100:103],v[192:195]
buffer_load_dwordx4 v8, s[52:55], s25 offen lds
M v[196:199],a[164:167],a[108:111],v[196:199]
M v[196:199],a[160:163],a[104:107],v[196:199]
s_mov_b32 s25, 2883584
T a[92:93],v4,57344
T a[94:95],v4,58368
M v[200:203],a[160:163],a[112:115],v[200:203]
SA m0,s4,143360
M v[200:203],a[164:167],a[116:119],v[200:203]
s_waitcnt vmcnt(19)
buffer_load_dwordx4 v8, s[52:55], s25 offen lds
M v[204:207],a[164:167],a[124:127],v[204:207]
R a[224:227],v20,16384
R a[228:231],v20,18432
M v[204:207],a[160:163],a[120:123],v[204:207]
R a[232:235],v21,16384
R a[236:239],v21,18432
M v[208:211],a[160:163],a[128:131],v[208:211]
v_subrev_u32 v20, 98304, v20
v_subrev_u32 v21, 98304, v21
M v[208:211],a[164:167],a[132:135],v[208:211]
M v[212:215],a[164:167],a[140:143],v[212:215]
M v[212:215],a[160:163],a[136:139],v[212:215]
M v[216:219],a[160:163],a[144:147],v[216:219]
M v[216:219],a[164:167],a[148:151],v[216:219]
s_waitcnt lgkmcnt(6)
M v[220:223],a[164:167],a[156:159],v[220:223]
s_waitcnt lgkmcnt(0)
M v[220:223],a[160:163],a[152:155],v[220:223]
s_barrier
M v[224:227],a[168:171],a[96:99],v[224:227]
R a[160:163],v5,32768
R a[164:167],v6,32768
M v[224:227],a[172:175],a[100:103],v[224:227]
M v[228:231],a[172:175],a[108:111],v[228:231]
M v[228:231],a[168:171],a[104:107],v[228:231]
M v[232:235],a[168:171],a[112:115],v[232:235]
M v[232:235],a[172:175],a[116:119],v[232:235]
M v[236:239],a[172:175],a[124:127],v[236:239]
M v[236:239],a[168:171],a[120:123],v[236:239]
M v[240:243],a[168:171],a[128:131],v[240:243]
M v[240:243],a[172:175],a[132:135],v[240:243]
M v[244:247],a[172:175],a[140:143],v[244:247]
M v[244:247],a[168:171],a[136:139],v[244:247]
M v[248:251],a[168:171],a[144:147],v[248:251]
M v[248:251],a[172:175],a[148:151],v[248:251]
s_waitcnt lgkmcnt(0)
M v[252:255],a[172:175],a[156:159],v[252:255]
M v[252:255],a[168:171],a[152:155],v[252:255]
M a[0:3],a[160:163],a[32:35],a[0:3]
R a[168:171],v5,34816
R a[172:175],v6,34816
M a[0:3],a[164:167],a[36:39],a[0:3]
SA m0,s23,81920
M a[4:7],a[164:167],a[44:47],a[4:7]
buffer_load_dwordx4 v22, s[56:59], s29 offen offset:0 lds
M a[4:7],a[160:163],a[40:43],a[4:7]
M a[8:11],a[160:163],a[48:51],a[8:11]
M a[8:11],a[164:167],a[52:55],a[8:11]
buffer_load_dwordx4 v23, s[56:59], s29 offen offset:1024 lds
M a[12:15],a[164:167],a[60:63],a[12:15]
M a[12:15],a[160:163],a[56:59],a[12:15]
M a[16:19],a[160:163],a[64:67],a[16:19]
M a[16:19],a[164:167],a[68:71],a[16:19]
buffer_load_dwordx4 v22, s[56:59], s30 offen offset:2048 lds
M a[20:23],a[164:167],a[76:79],a[20:23]
M a[20:23],a[160:163],a[72:75],a[20:23]
M a[24:27],a[160:163],a[80:83],a[24:27]
M a[24:27],a[164:167],a[84:87],a[24:27]
s_waitcnt lgkmcnt(0)
buffer_load_dwordx4 v23, s[56:59], s30 offen offset:3072 lds
M a[28:31],a[164:167],a[92:95],a[28:31]
SA s29,s29,128
M a[28:31],a[160:163],a[88:91],a[28:31]
SA s30,s30,128
M v[32:35],a[168:171],a[32:35],v[32:35]
s_mov_b32 s25, 3145728
R a[160:163],v5,36864
R a[164:167],v6,36864
M v[32:35],a[172:175],a[36:39],v[32:35]
SA m0,s4,147456
M v[36:39],a[172:175],a[44:47],v[36:39]
buffer_load_dwordx4 v8, s[52:55], s25 offen lds
M v[36:39],a[168:171],a[40:43],v[36:39]
s_mov_b32 s25, 3407872
M v[40:43],a[168:171],a[48:51],v[40:43]
SA m0,s4,151552
M v[40:43],a[172:175],a[52:55],v[40:43]
buffer_load_dwordx4 v8, s[52:55], s25 offen lds
M v[44:47],a[172:175],a[60:63],v[44:47]
G v24,a0
G v25,a1
M v[44:47],a[168:171],a[56:59],v[44:47]
s_mov_b32 s25, 128
G v26,a2
G v27,a3
M v[48:51],a[168:171],a[64:67],v[48:51]
SA m0,s4,49152
C v24,v24,v25
C v25,v26,v27
M v[48:51],a[172:175],a[68:71],v[48:51]
buffer_load_dwordx4 v8, s[52:55], s25 offen lds
M v[52:55],a[172:175],a[76:79],v[52:55]
C v26,v32,v33
C v27,v34,v35
M v[52:55],a[168:171],a[72:75],v[52:55]
SA s3,s93,0
M v[56:59],a[168:171],a[80:83],v[56:59]
s_mov_b32 s25, 262272
buffer_store_dwordx4 v[24:27], v7, s[8:11], s3 offen offset:0 sc1
M v[56:59],a[172:175],a[84:87],v[56:59]
L_w_kv17:
s_cbranch_execz L_wd2
s_waitcnt lgkmcnt(0)
G v28,a4
G v29,a5
M v[60:63],a[172:175],a[92:95],v[60:63]
SA m0,s4,53248
G v30,a6
G v31,a7
M v[60:63],a[168:171],a[88:91],v[60:63]
s_waitcnt vmcnt(16)
buffer_load_dwordx4 v8, s[52:55], s25 offen lds
M v[64:67],a[160:163],a[32:35],v[64:67]
s_mov_b32 s25, 524416
R a[168:171],v5,38912
R a[172:175],v6,38912
M v[64:67],a[164:167],a[36:39],v[64:67]
SA m0,s4,57344
C v28,v28,v29
C v29,v30,v31
M v[68:71],a[164:167],a[44:47],v[68:71]
buffer_load_dwordx4 v8, s[52:55], s25 offen lds
M v[68:71],a[160:163],a[40:43],v[68:71]
s_mov_b32 s25, 786560
C v30,v36,v37
C v31,v38,v39
M v[72:75],a[160:163],a[48:51],v[72:75]
SA m0,s4,61440
buffer_store_dwordx4 v[28:31], v7, s[8:11], s3 offen offset:2048 sc1
M v[72:75],a[164:167],a[52:55],v[72:75]
G v24,a8
G v25,a9
M v[76:79],a[164:167],a[60:63],v[76:79]
G v26,a10
G v27,a11
M v[76:79],a[160:163],a[56:59],v[76:79]
buffer_load_dwordx4 v8, s[52:55], s25 offen lds
M v[80:83],a[160:163],a[64:67],v[80:83]
C v24,v24,v25
C v25,v26,v27
M v[80:83],a[164:167],a[68:71],v[80:83]
C v26,v40,v41
C v27,v42,v43
M v[84:87],a[164:167],a[76:79],v[84:87]
SA s3,s93,4096
buffer_store_dwordx4 v[24:27], v7, s[8:11], s3 offen offset:0 sc1
M v[84:87],a[160:163],a[72:75],v[84:87]
R a[96:99],v20,0
R a[100:103],v20,2048
M v[88:91],a[160:163],a[80:83],v[88:91]
R a[104:107],v21,0
R a[108:111],v21,2048
M v[88:91],a[164:167],a[84:87],v[88:91]
s_waitcnt lgkmcnt(4)
G v28,a12
G v29,a13
M v[92:95],a[164:167],a[92:95],v[92:95]
s_waitcnt lgkmcnt(0)
G v30,a14
G v31,a15
M v[92:95],a[160:163],a[88:91],v[92:95]
s_barrier
M v[96:99],a[168:171],a[32:35],v[96:99]
R a[160:163],v5,49152
R a[164:167],v6,49152
M v[96:99],a[172:175],a[36:39],v[96:99]
s_mov_b32 s25, 1048704
C v28,v28,v29
C v29,v30,v31
M v[100:103],a[172:175],a[44:47],v[100:103]
SA m0,s4,98304
C v30,v44,v45
C v31,v46,v47
M v[100:103],a[168:171],a[40:43],v[100:103]
s_waitcnt vmcnt(17)
buffer_store_dwordx4 v[28:31], v7, s[8:11], s3 offen offset:2048 sc1
M v[104:107],a[168:171],a[48:51],v[104:107]
G v24,a16
G v25,a17
M v[104:107],a[172:175],a[52:55],v[104:107]
G v26,a18
G v27,a19
M v[108:111],a[172:175],a[60:63],v[108:111]
buffer_load_dwordx4 v8, s[52:55], s25 offen lds
M v[108:111],a[168:171],a[56:59],v[108:111]
C v24,v24,v25
C v25,v26,v27
M v[112:115],a[168:171],a[64:67],v[112:115]
C v26,v48,v49
C v27,v50,v51
M v[112:115],a[172:175],a[68:71],v[112:115]
SA s3,s93,8192
buffer_store_dwordx4 v[24:27], v7, s[8:11], s3 offen offset:0 sc1
M v[116:119],a[172:175],a[76:79],v[116:119]
s_mov_b32 s25, 1310848
R a[112:115],v20,32768
R a[116:119],v20,34816
M v[116:119],a[168:171],a[72:75],v[116:119]
SA m0,s4,102400
R a[120:123],v21,32768
R a[124:127],v21,34816
M v[120:123],a[168:171],a[80:83],v[120:123]
C v64,v64,v65
C v65,v66,v67
M v[120:123],a[172:175],a[84:87],v[120:123]
s_waitcnt lgkmcnt(4)
buffer_load_dwordx4 v8, s[52:55], s25 offen lds
M v[124:127],a[172:175],a[92:95],v[124:127]
C v66,v96,v97
C v67,v98,v99
M v[124:127],a[168:171],a[88:91],v[124:127]
G v28,a20
G v29,a21
M v[128:131],a[160:163],a[32:35],v[128:131]
R a[168:171],v5,51200
R a[172:175],v6,51200
M v[128:131],a[164:167],a[36:39],v[128:131]
G v30,a22
G v31,a23
M v[132:135],a[164:167],a[44:47],v[132:135]
C v28,v28,v29
C v29,v30,v31
M v[132:135],a[160:163],a[40:43],v[132:135]
s_mov_b32 s25, 1572992
C v30,v52,v53
C v31,v54,v55
M v[136:139],a[160:163],a[48:51],v[136:139]
SA m0,s4,106496
buffer_store_dwordx4 v[28:31], v7, s[8:11], s3 offen offset:2048 sc1
M v[136:139],a[164:167],a[52:55],v[136:139]
C v68,v68,v69
C v69,v70,v71
M v[140:143],a[164:167],a[60:63],v[140:143]
C v70,v100,v101
C v71,v102,v103
M v[140:143],a[160:163],a[56:59],v[140:143]
C v72,v72,v73
C v73,v74,v75
M v[144:147],a[160:163],a[64:67],v[144:147]
buffer_load_dwordx4 v8, s[52:55], s25 offen lds
M v[144:147],a[164:167],a[68:71],v[144:147]
C v74,v104,v105
C v75,v106,v107
M v[148:151],a[164:167],a[76:79],v[148:151]
C v76,v76,v77
C v77,v78,v79
M v[148:151],a[160:163],a[72:75],v[148:151]
C v78,v108,v109
C v79,v110,v111
M v[152:155],a[160:163],a[80:83],v[152:155]
C v80,v80,v81
C v81,v82,v83
M v[152:155],a[164:167],a[84:87],v[152:155]
s_waitcnt lgkmcnt(0)
C v82,v112,v113
C v83,v114,v115
M v[156:159],a[164:167],a[92:95],v[156:159]
s_mov_b32 s25, 1835136
C v84,v84,v85
C v85,v86,v87
M v[156:159],a[160:163],a[88:91],v[156:159]
SA m0,s4,110592
C v86,v116,v117
C v87,v118,v119
M v[160:163],a[168:171],a[32:35],v[160:163]
R a[160:163],v5,53248
R a[164:167],v6,53248
M v[160:163],a[172:175],a[36:39],v[160:163]
buffer_load_dwordx4 v8, s[52:55], s25 offen lds
M v[164:167],a[172:175],a[44:47],v[164:167]
G v24,a24
G v25,a25
M v[164:167],a[168:171],a[40:43],v[164:167]
G v26,a26
G v27,a27
M v[168:171],a[168:171],a[48:51],v[168:171]
C v24,v24,v25
C v25,v26,v27
M v[168:171],a[172:175],a[52:55],v[168:171]
C v26,v56,v57
C v27,v58,v59
M v[172:175],a[172:175],a[60:63],v[172:175]
SA s3,s93,12288
buffer_store_dwordx4 v[24:27], v7, s[8:11], s3 offen offset:0 sc1
M v[172:175],a[168:171],a[56:59],v[172:175]
C v88,v88,v89
C v89,v90,v91
M v[176:179],a[168:171],a[64:67],v[176:179]
C v90,v120,v121
C v91,v122,v123
M v[176:179],a[172:175],a[68:71],v[176:179]
C v92,v92,v93
C v93,v94,v95
M v[180:183],a[172:175],a[76:79],v[180:183]
C v94,v124,v125
C v95,v126,v127
M v[180:183],a[168:171],a[72:75],v[180:183]
G v28,a28
G v29,a29
M v[184:187],a[168:171],a[80:83],v[184:187]
G v30,a30
G v31,a31
M v[184:187],a[172:175],a[84:87],v[184:187]
s_waitcnt lgkmcnt(0)
C v28,v28,v29
C v29,v30,v31
M v[188:191],a[172:175],a[92:95],v[188:191]
C v30,v60,v61
C v31,v62,v63
M v[188:191],a[168:171],a[88:91],v[188:191]
buffer_store_dwordx4 v[28:31], v7, s[8:11], s3 offen offset:2048 sc1
M v[192:195],a[160:163],a[32:35],v[192:195]
s_waitcnt vmcnt(18)
R a[168:171],v5,55296
R a[172:175],v6,55296
M v[192:195],a[164:167],a[36:39],v[192:195]
C v128,v128,v129
C v129,v130,v131
M v[196:199],a[164:167],a[44:47],v[196:199]
C v130,v160,v161
C v131,v162,v163
M v[196:199],a[160:163],a[40:43],v[196:199]
C v132,v132,v133
C v133,v134,v135
M v[200:203],a[160:163],a[48:51],v[200:203]
C v134,v164,v165
C v135,v166,v167
M v[200:203],a[164:167],a[52:55],v[200:203]
C v136,v136,v137
C v137,v138,v139
M v[204:207],a[164:167],a[60:63],v[204:207]
C v138,v168,v169
C v139,v170,v171
M v[204:207],a[160:163],a[56:59],v[204:207]
C v140,v140,v141
C v141,v142,v143
M v[208:211],a[160:163],a[64:67],v[208:211]
C v142,v172,v173
C v143,v174,v175
M v[208:211],a[164:167],a[68:71],v[208:211]
C v144,v144,v145
C v145,v146,v147
M v[212:215],a[164:167],a[76:79],v[212:215]
R a[128:131],v20,49152
R a[132:135],v20,51200
R a[136:139],v21,49152
R a[140:143],v21,51200
M v[212:215],a[160:163],a[72:75],v[212:215]
C v146,v176,v177
C v147,v178,v179
M v[216:219],a[160:163],a[80:83],v[216:219]
C v148,v148,v149
C v149,v150,v151
M v[216:219],a[164:167],a[84:87],v[216:219]
s_waitcnt lgkmcnt(4)
C v150,v180,v181
C v151,v182,v183
M v[220:223],a[164:167],a[92:95],v[220:223]
s_waitcnt vmcnt(16) lgkmcnt(0)
C v152,v152,v153
C v153,v154,v155
M v[220:223],a[160:163],a[88:91],v[220:223]
s_barrier
M v[224:227],a[168:171],a[32:35],v[224:227]
s_nop 0
T v[32:33],v16,0
T v[34:35],v16,2048
M v[224:227],a[172:175],a[36:39],v[224:227]
C v154,v184,v185
C v155,v186,v187
M v[228:231],a[172:175],a[44:47],v[228:231]
T v[36:37],v16,4096
T v[38:39],v16,6144
M v[228:231],a[168:171],a[40:43],v[228:231]
T v[40:41],v16,8192
T v[42:43],v16,10240
M v[232:235],a[168:171],a[48:51],v[232:235]
C v156,v156,v157
C v157,v158,v159
M v[232:235],a[172:175],a[52:55],v[232:235]
T v[44:45],v16,12288
T v[46:47],v16,14336
M v[236:239],a[172:175],a[60:63],v[236:239]
T v[48:49],v16,16384
T v[50:51],v16,18432
M v[236:239],a[168:171],a[56:59],v[236:239]
C v158,v188,v189
C v159,v190,v191
M v[240:243],a[168:171],a[64:67],v[240:243]
T v[52:53],v16,20480
T v[54:55],v16,22528
M v[240:243],a[172:175],a[68:71],v[240:243]
T v[56:57],v16,24576
T v[58:59],v16,26624
M v[244:247],a[172:175],a[76:79],v[244:247]
C v192,v192,v193
C v193,v194,v195
M v[244:247],a[168:171],a[72:75],v[244:247]
C v194,v224,v225
C v195,v226,v227
M v[248:251],a[168:171],a[80:83],v[248:251]
C v196,v196,v197
C v197,v198,v199
M v[248:251],a[172:175],a[84:87],v[248:251]
C v198,v228,v229
C v199,v230,v231
M v[252:255],a[172:175],a[92:95],v[252:255]
C v200,v200,v201
C v201,v202,v203
M v[252:255],a[168:171],a[88:91],v[252:255]
s_waitcnt lgkmcnt(6)
C v202,v232,v233
C v203,v234,v235
M v[96:99],v[32:35],a[176:179],0
s_mul_i32 s72, s41, 4352
T a[144:145],v17,0
T a[146:147],v17,2048
M v[96:99],v[36:39],a[184:187],v[96:99]
SA s46,s72,104923136
C v204,v204,v205
C v205,v206,v207
M v[96:99],v[40:43],a[192:195],v[96:99]
s_waitcnt lgkmcnt(2)
T a[148:149],v17,4096
T a[150:151],v17,6144
M v[96:99],v[44:47],a[200:203],v[96:99]
s_mov_b32 s25, 2097280
T a[152:153],v17,8192
T a[154:155],v17,10240
M v[96:99],v[48:51],a[208:211],v[96:99]
SA m0,s4,114688
C v206,v236,v237
C v207,v238,v239
M v[96:99],v[52:55],a[216:219],v[96:99]
s_lshl_b32 s45, s42, 7
T a[156:157],v17,12288
T a[158:159],v17,14336
M v[96:99],v[56:59],a[224:227],v[96:99]
SA s45,s45,s46
T a[160:161],v17,16384
T a[162:163],v17,18432
M v[100:103],v[56:59],a[228:231],0
s_lshl_b32 s72, s20, 2
buffer_load_dwordx4 v8, s[52:55], s25 offen lds
M v[100:103],v[52:55],a[220:223],v[100:103]
SA s72,s72,s45
T a[164:165],v17,20480
T a[166:167],v17,22528
M v[100:103],v[48:51],a[212:215],v[100:103]
T a[168:169],v17,24576
T a[170:171],v17,26624
M v[100:103],v[44:47],a[204:207],v[100:103]
s_mov_b32 s25, 2359424
C v208,v208,v209
C v209,v210,v211
M v[100:103],v[40:43],a[196:199],v[100:103]
SA m0,s4,118784
C v210,v240,v241
C v211,v242,v243
M v[100:103],v[36:39],a[188:191],v[100:103]
buffer_load_dwordx4 v8, s[52:55], s25 offen lds
M v[100:103],v[32:35],a[180:183],v[100:103]
s_waitcnt lgkmcnt(6)
C v212,v212,v213
C v213,v214,v215
M v[104:107],a[144:147],a[176:179],0
T v[32:33],v18,0
T v[34:35],v18,2048
M v[104:107],a[148:151],a[184:187],v[104:107]
s_mov_b32 s25, 2621568
C v214,v244,v245
C v215,v246,v247
M v[104:107],a[152:155],a[192:195],v[104:107]
s_waitcnt lgkmcnt(2)
T v[36:37],v18,4096
T v[38:39],v18,6144
M v[104:107],a[156:159],a[200:203],v[104:107]
SA m0,s4,122880
T v[40:41],v18,8192
T v[42:43],v18,10240
M v[104:107],a[160:163],a[208:211],v[104:107]
buffer_load_dwordx4 v8, s[52:55], s25 offen lds
M v[104:107],a[164:167],a[216:219],v[104:107]
s_nop 0
T v[44:45],v18,12288
T v[46:47],v18,14336
M v[104:107],a[168:171],a[224:227],v[104:107]
T v[48:49],v18,16384
T v[50:51],v18,18432
M v[108:111],a[168:171],a[228:231],0
s_mov_b32 s25, 2883712
C v216,v216,v217
C v217,v218,v219
M v[108:111],a[164:167],a[220:223],v[108:111]
SA m0,s4,126976
T v[52:53],v18,20480
T v[54:55],v18,22528
M v[108:111],a[160:163],a[212:215],v[108:111]
T v[56:57],v18,24576
T v[58:59],v18,26624
M v[108:111],a[156:159],a[204:207],v[108:111]
buffer_load_dwordx4 v8, s[52:55], s25 offen lds
M v[108:111],a[152:155],a[196:199],v[108:111]
C v218,v248,v249
C v219,v250,v251
M v[108:111],a[148:151],a[188:191],v[108:111]
C v220,v220,v221
C v221,v222,v223
M v[108:111],a[144:147],a[180:183],v[108:111]
s_waitcnt lgkmcnt(6)
C v222,v252,v253
C v223,v254,v255
M v[112:115],v[32:35],a[176:179],0
s_mov_b32 s25, 3145856
T a[144:145],v19,0
T a[146:147],v19,2048
M v[112:115],v[36:39],a[184:187],v[112:115]
SA m0,s4,32768
v_min_u32 v29, 1, v0
v_lshlrev_b32 v29, 29, v29
M v[112:115],v[40:43],a[192:195],v[112:115]
s_waitcnt lgkmcnt(2)
T a[148:149],v19,4096
T a[150:151],v19,6144
M v[112:115],v[44:47],a[200:203],v[112:115]
T a[152:153],v19,8192
T a[154:155],v19,10240
M v[112:115],v[48:51],a[208:211],v[112:115]
buffer_load_dwordx4 v8, s[52:55], s25 offen lds
M v[112:115],v[52:55],a[216:219],v[112:115]
s_nop 0
T a[156:157],v19,12288
T a[158:159],v19,14336
M v[112:115],v[56:59],a[224:227],v[112:115]
T a[160:161],v19,16384
T a[162:163],v19,18432
M v[116:119],v[56:59],a[228:231],0
s_mov_b32 s25, 3408000
v_mov_b32 v30, 1
v_add_u32 v20, 0x10000, v16
M v[116:119],v[52:55],a[220:223],v[116:119]
SA m0,s4,36864
T a[164:165],v19,20480
T a[166:167],v19,22528
M v[116:119],v[48:51],a[212:215],v[116:119]
s_waitcnt vmcnt(5)
T a[168:169],v19,24576
T a[170:171],v19,26624
M v[116:119],v[44:47],a[204:207],v[116:119]
SA s3,s93,524288
buffer_load_dwordx4 v8, s[52:55], s25 offen lds
M v[116:119],v[40:43],a[196:199],v[116:119]
buffer_store_dword v30, v29, s[8:11], s72 offen offset:4 sc1
M v[116:119],v[36:39],a[188:191],v[116:119]
v_add_u32 v21, 0x10000, v17
v_add_u32 v22, 0x10000, v18
M v[116:119],v[32:35],a[180:183],v[116:119]
s_waitcnt lgkmcnt(6)
buffer_store_dwordx4 v[64:67], v7, s[8:11], s3 offen offset:0 sc1
M v[120:123],a[144:147],a[176:179],0
s_mov_b32 s25, 256
T v[32:33],v16,28672
T v[34:35],v16,30720
M v[120:123],a[148:151],a[184:187],v[120:123]
SA m0,s4,65536
v_add_u32 v23, 0x10000, v19
v_or_b32 v1, s20, v0
M v[120:123],a[152:155],a[192:195],v[120:123]
s_waitcnt lgkmcnt(2)
T v[36:37],v12,0
T v[38:39],v12,2048
M v[120:123],a[156:159],a[200:203],v[120:123]
T v[40:41],v12,4096
T v[42:43],v12,6144
M v[120:123],a[160:163],a[208:211],v[120:123]
buffer_load_dwordx4 v8, s[52:55], s25 offen lds
M v[120:123],a[164:167],a[216:219],v[120:123]
s_nop 0
T v[44:45],v12,8192
T v[46:47],v12,10240
M v[120:123],a[168:171],a[224:227],v[120:123]
T v[48:49],v12,12288
T v[50:51],v12,14336
M v[124:127],a[168:171],a[228:231],0
s_mov_b32 s25, 262400
buffer_store_dwordx4 v[68:71], v7, s[8:11], s3 offen offset:2048 sc1
M v[124:127],a[164:167],a[220:223],v[124:127]
SA m0,s4,69632
T v[52:53],v12,16384
T v[54:55],v12,18432
M v[124:127],a[160:163],a[212:215],v[124:127]
T v[56:57],v12,20480
T v[58:59],v12,22528
M v[124:127],a[156:159],a[204:207],v[124:127]
buffer_load_dwordx4 v8, s[52:55], s25 offen lds
M v[124:127],a[152:155],a[196:199],v[124:127]
v_min_u32 v1, 1, v1
v_lshlrev_b32 v1, 29, v1
M v[124:127],a[148:151],a[188:191],v[124:127]
v_min_u32 v9, 15, v0
v_lshlrev_b32 v9, 7, v9
M v[124:127],a[144:147],a[180:183],v[124:127]
s_waitcnt lgkmcnt(6)
M v[96:99],v[32:35],a[232:235],v[96:99]
s_mov_b32 s25, 524544
T a[144:145],v17,28672
T a[146:147],v17,30720
M v[96:99],v[36:39],a[96:99],v[96:99]
SA m0,s4,73728
M v[96:99],v[40:43],a[104:107],v[96:99]
s_waitcnt lgkmcnt(2)
s_nop 0
T a[148:149],v13,0
T a[150:151],v13,2048
M v[96:99],v[44:47],a[112:115],v[96:99]
SA s3,s93,528384
T a[152:153],v13,4096
T a[154:155],v13,6144
M v[96:99],v[48:51],a[120:123],v[96:99]
s_sub_u32 s66, 15, s42
buffer_load_dwordx4 v8, s[52:55], s25 offen lds
M v[96:99],v[52:55],a[128:131],v[96:99]
s_max_u32 s67, s66, s42
T a[156:157],v13,8192
T a[158:159],v13,10240
M v[96:99],v[56:59],a[136:139],v[96:99]
s_min_u32 s66, s66, s42
T a[160:161],v13,12288
T a[162:163],v13,14336
M v[100:103],v[56:59],a[140:143],v[100:103]
s_mov_b32 s25, 786688
buffer_store_dwordx4 v[72:75], v7, s[8:11], s3 offen offset:0 sc1
M v[100:103],v[52:55],a[132:135],v[100:103]
SA m0,s4,77824
T a[164:165],v13,16384
L_w_kv18:
s_cbranch_execz L_wd2
T a[166:167],v13,18432
M v[100:103],v[48:51],a[124:127],v[100:103]
s_mul_i32 s21, s41, 1048576
T a[168:169],v13,20480
T a[170:171],v13,22528
M v[100:103],v[44:47],a[116:119],v[100:103]
s_lshl_b32 s64, s67, 16
buffer_load_dwordx4 v8, s[52:55], s25 offen lds
M v[100:103],v[40:43],a[108:111],v[100:103]
SA s32,s21,s64
M v[100:103],v[36:39],a[100:103],v[100:103]
s_lshl_b32 s64, s20, 14
buffer_store_dwordx4 v[76:79], v7, s[8:11], s3 offen offset:2048 sc1
M v[100:103],v[32:35],a[236:239],v[100:103]
s_waitcnt lgkmcnt(6)
M v[104:107],a[144:147],a[232:235],v[104:107]
s_mov_b32 s25, 1048832
T v[32:33],v18,28672
T v[34:35],v18,30720
M v[104:107],a[148:151],a[96:99],v[104:107]
SA m0,s4,81920
M v[104:107],a[152:155],a[104:107],v[104:107]
s_waitcnt lgkmcnt(2)
s_nop 0
T v[36:37],v14,0
T v[38:39],v14,2048
M v[104:107],a[156:159],a[112:115],v[104:107]
SA s32,s32,s64
T v[40:41],v14,4096
T v[42:43],v14,6144
M v[104:107],a[160:163],a[120:123],v[104:107]
SA s32,s32,33554432
buffer_load_dwordx4 v8, s[52:55], s25 offen lds
M v[104:107],a[164:167],a[128:131],v[104:107]
s_sub_u32 s64, s42, 10
T v[44:45],v14,8192
T v[46:47],v14,10240
M v[104:107],a[168:171],a[136:139],v[104:107]
s_and_b32 s35, s64, 536870912
T v[48:49],v14,12288
T v[50:51],v14,14336
M v[108:111],a[168:171],a[140:143],v[108:111]
s_mov_b32 s25, 1310976
v_or_b32 v6, s35, v7
M v[108:111],a[164:167],a[132:135],v[108:111]
SA m0,s4,86016
T v[52:53],v14,16384
T v[54:55],v14,18432
M v[108:111],a[160:163],a[124:127],v[108:111]
s_lshl_b32 s28, s20, 13
T v[56:57],v14,20480
T v[58:59],v14,22528
M v[108:111],a[156:159],a[116:119],v[108:111]
buffer_load_dwordx4 v8, s[52:55], s25 offen lds
M v[108:111],a[152:155],a[108:111],v[108:111]
v_add_u32 v2, 0x10000, v7
v_add_u32 v3, s28, v7
M v[108:111],a[148:151],a[100:103],v[108:111]
v_add_u32 v4, 0x1000, v3
MF v96,s5,v96
M v[108:111],a[144:147],a[236:239],v[108:111]
s_waitcnt lgkmcnt(6)
MF v97,s5,v97
MF v98,s5,v98
M v[112:115],v[32:35],a[232:235],v[112:115]
s_mov_b32 s25, 1573120
T a[144:145],v19,28672
T a[146:147],v19,30720
M v[112:115],v[36:39],a[96:99],v[112:115]
SA m0,s4,90112
MF v99,s5,v99
MF v104,s5,v104
M v[112:115],v[40:43],a[104:107],v[112:115]
s_waitcnt lgkmcnt(2)
T a[148:149],v15,0
T a[150:151],v15,2048
M v[112:115],v[44:47],a[112:115],v[112:115]
s_lshl_b32 s64, s42, 16
T a[152:153],v15,4096
T a[154:155],v15,6144
M v[112:115],v[48:51],a[120:123],v[112:115]
SA s23,s21,s64
buffer_load_dwordx4 v8, s[52:55], s25 offen lds
M v[112:115],v[52:55],a[128:131],v[112:115]
SA s43,s23,16777216
T a[156:157],v15,8192
T a[158:159],v15,10240
M v[112:115],v[56:59],a[136:139],v[112:115]
SA s26,s21,16777216
T a[160:161],v15,12288
T a[162:163],v15,14336
M v[116:119],v[56:59],a[140:143],v[116:119]
s_mov_b32 s25, 1835264
MF v105,s5,v105
MF v106,s5,v106
M v[116:119],v[52:55],a[132:135],v[116:119]
SA m0,s4,94208
T a[164:165],v15,16384
T a[166:167],v15,18432
M v[116:119],v[48:51],a[124:127],v[116:119]
s_min_u32 s27, s42, 9
T a[168:169],v15,20480
T a[170:171],v15,22528
M v[116:119],v[44:47],a[116:119],v[116:119]
s_lshl_b32 s22, s27, 1
buffer_load_dwordx4 v8, s[52:55], s25 offen lds
M v[116:119],v[40:43],a[108:111],v[116:119]
s_sub_u32 s22, s22, 1
MF v107,s5,v107
C v96,v96,v97
M v[116:119],v[36:39],a[100:103],v[116:119]
s_waitcnt vmcnt(13) lgkmcnt(0)
C v97,v98,v99
C v98,v104,v105
M v[116:119],v[32:35],a[236:239],v[116:119]
s_barrier
M v[120:123],a[144:147],a[232:235],v[120:123]
s_mov_b32 s25, 2097408
T v[32:33],v16,49152
T v[34:35],v16,51200
M v[120:123],a[148:151],a[96:99],v[120:123]
SA m0,s4,155648
C v99,v106,v107
W a0,v96
M v[120:123],a[152:155],a[104:107],v[120:123]
s_sub_u32 s27, s27, 2
T v[36:37],v16,53248
T v[38:39],v16,55296
M v[120:123],a[156:159],a[112:115],v[120:123]
s_mov_b32 s31, 0x4b800000
T v[40:41],v16,57344
T v[42:43],v16,59392
M v[120:123],a[160:163],a[120:123],v[120:123]
s_mov_b32 s24, 0x33800000
buffer_load_dwordx4 v8, s[52:55], s25 offen lds
M v[120:123],a[164:167],a[128:131],v[120:123]
s_lshl_b32 s47, s66, 7
T v[44:45],v16,61440
T v[46:47],v16,63488
M v[120:123],a[168:171],a[136:139],v[120:123]
SA s47,s47,s46
T v[48:49],v20,32768
T v[50:51],v20,34816
M v[124:127],a[168:171],a[140:143],v[124:127]
s_mov_b32 s25, 2359552
W a1,v97
W a2,v98
M v[124:127],a[164:167],a[132:135],v[124:127]
SA m0,s4,159744
T v[52:53],v20,36864
T v[54:55],v20,38912
M v[124:127],a[160:163],a[124:127],v[124:127]
s_lshl_b32 s64, s20, 5
T v[56:57],v20,40960
T v[58:59],v20,43008
M v[124:127],a[156:159],a[116:119],v[124:127]
SA s47,s47,s64
buffer_load_dwordx4 v8, s[52:55], s25 offen lds
M v[124:127],a[152:155],a[108:111],v[124:127]
SA s47,s47,2048
W a3,v99
MF v100,s5,v100
M v[124:127],a[148:151],a[100:103],v[124:127]
SA s30,s32,0
buffer_store_dwordx4 a[0:3], v6, s[8:11], s30 offen offset:0 sc1
M v[124:127],a[144:147],a[236:239],v[124:127]
s_waitcnt lgkmcnt(6)
MF v101,s5,v101
MF v102,s5,v102
M v[160:163],v[32:35],a[176:179],0
s_lshl_b32 s65, s41, 3
T a[144:145],v17,49152
T a[146:147],v17,51200
M v[160:163],v[36:39],a[184:187],v[160:163]
SA s65,s65,s66
MF v103,s5,v103
MF v108,s5,v108
M v[160:163],v[40:43],a[192:195],v[160:163]
s_waitcnt lgkmcnt(2)
T a[148:149],v17,53248
T a[150:151],v17,55296
M v[160:163],v[44:47],a[200:203],v[160:163]
s_mul_i32 s34, s65, 73728
T a[152:153],v17,57344
T a[154:155],v17,59392
M v[160:163],v[48:51],a[208:211],v[160:163]
SA s34,s34,136314880
MF v109,s5,v109
MF v110,s5,v110
M v[160:163],v[52:55],a[216:219],v[160:163]
s_lshl_b32 s65, s42, 4
T a[156:157],v17,61440
T a[158:159],v17,63488
M v[160:163],v[56:59],a[224:227],v[160:163]
SA s65,s65,s41
T a[160:161],v21,32768
T a[162:163],v21,34816
M v[164:167],v[56:59],a[228:231],0
s_mul_i32 s33, s65, 114688
MF v111,s5,v111
C v100,v100,v101
M v[164:167],v[52:55],a[220:223],v[164:167]
s_mul_i32 s65, s20, 28672
T a[164:165],v21,36864
T a[166:167],v21,38912
M v[164:167],v[48:51],a[212:215],v[164:167]
SA s33,s33,s65
T a[168:169],v21,40960
T a[170:171],v21,43008
M v[164:167],v[44:47],a[204:207],v[164:167]
SA s33,s33,67108864
C v101,v102,v103
C v102,v108,v109
M v[164:167],v[40:43],a[196:199],v[164:167]
s_mov_b32 s6, 0
C v103,v110,v111
W a32,v100
M v[164:167],v[36:39],a[188:191],v[164:167]
s_mov_b32 s7, 1
W a33,v101
W a34,v102
M v[164:167],v[32:35],a[180:183],v[164:167]
s_waitcnt lgkmcnt(6)
W a35,v103
MF v112,s5,v112
M v[168:171],a[144:147],a[176:179],0
SA s30,s32,8192
T v[32:33],v18,49152
T v[34:35],v18,51200
M v[168:171],a[148:151],a[184:187],v[168:171]
s_mov_b32 s40, 1
buffer_store_dwordx4 a[32:35], v6, s[8:11], s30 offen offset:0 sc1
M v[168:171],a[152:155],a[192:195],v[168:171]
s_waitcnt lgkmcnt(2)
s_nop 0
T v[36:37],v18,53248
T v[38:39],v18,55296
M v[168:171],a[156:159],a[200:203],v[168:171]
s_cmp_eq_u32 s20, 0
T v[40:41],v18,57344
T v[42:43],v18,59392
M v[168:171],a[160:163],a[208:211],v[168:171]
s_cselect_b32 s39, 6, 4
MF v113,s5,v113
MF v114,s5,v114
M v[168:171],a[164:167],a[216:219],v[168:171]
s_mov_b64 s[60:61], s[76:77]
T v[44:45],v18,61440
T v[46:47],v18,63488
M v[168:171],a[168:171],a[224:227],v[168:171]
s_mov_b32 s62, s78
T v[48:49],v22,32768
T v[50:51],v22,34816
M v[172:175],a[168:171],a[228:231],0
s_mov_b32 s63, 0x20000
v_lshrrev_b32 v24, 4, v0
v_lshlrev_b32 v24, 2, v24
M v[172:175],a[164:167],a[220:223],v[172:175]
s_mov_b32 s25, 2621696
T v[52:53],v22,36864
T v[54:55],v22,38912
M v[172:175],a[160:163],a[212:215],v[172:175]
SA m0,s4,131072
T v[56:57],v22,40960
T v[58:59],v22,43008
M v[172:175],a[156:159],a[204:207],v[172:175]
buffer_load_dwordx4 v8, s[52:55], s25 offen lds
M v[172:175],a[152:155],a[196:199],v[172:175]
v_and_b32 v25, 15, v0
v_sub_u32 v24, v24, v25
M v[172:175],a[148:151],a[188:191],v[172:175]
v_cmp_lt_i32 s[16:17], 0, v24
v_cmp_lt_i32 s[18:19], -1, v24
M v[172:175],a[144:147],a[180:183],v[172:175]
s_waitcnt lgkmcnt(6)
v_cmp_lt_i32 s[48:49], -2, v24
v_cmp_lt_i32 s[50:51], -3, v24
M v[176:179],v[32:35],a[176:179],0
s_mov_b32 s25, 2883840
T a[144:145],v19,49152
T a[146:147],v19,51200
M v[176:179],v[36:39],a[184:187],v[176:179]
SA m0,s4,135168
v_lshl_add_u32 v25, v0, 7, s95
v_and_b32 v0, 48, v0
M v[176:179],v[40:43],a[192:195],v[176:179]
s_waitcnt lgkmcnt(2)
T a[148:149],v19,53248
T a[150:151],v19,55296
M v[176:179],v[44:47],a[200:203],v[176:179]
SA s3,s93,532480
T a[152:153],v19,57344
T a[154:155],v19,59392
M v[176:179],v[48:51],a[208:211],v[176:179]
buffer_load_dwordx4 v8, s[52:55], s25 offen lds
M v[176:179],v[52:55],a[216:219],v[176:179]
s_nop 0
T a[156:157],v19,61440
T a[158:159],v19,63488
M v[176:179],v[56:59],a[224:227],v[176:179]
T a[160:161],v23,32768
T a[162:163],v23,34816
M v[180:183],v[56:59],a[228:231],0
s_mov_b32 s25, 3145984
buffer_store_dwordx4 v[80:83], v7, s[8:11], s3 offen offset:0 sc1
M v[180:183],v[52:55],a[220:223],v[180:183]
SA m0,s4,139264
T a[164:165],v23,36864
T a[166:167],v23,38912
M v[180:183],v[48:51],a[212:215],v[180:183]
T a[168:169],v23,40960
T a[170:171],v23,43008
M v[180:183],v[44:47],a[204:207],v[180:183]
buffer_load_dwordx4 v8, s[52:55], s25 offen lds
M v[180:183],v[40:43],a[196:199],v[180:183]
MF v115,s5,v115
MF v120,s5,v120
M v[180:183],v[36:39],a[188:191],v[180:183]
buffer_store_dwordx4 v[84:87], v7, s[8:11], s3 offen offset:2048 sc1
M v[180:183],v[32:35],a[180:183],v[180:183]
s_waitcnt lgkmcnt(6)
MF v121,s5,v121
MF v122,s5,v122
M v[184:187],a[144:147],a[176:179],0
s_mov_b32 s25, 3408128
T v[32:33],v20,45056
T v[34:35],v20,47104
M v[184:187],a[148:151],a[184:187],v[184:187]
SA m0,s4,143360
MF v123,s5,v123
C v112,v112,v113
M v[184:187],a[152:155],a[192:195],v[184:187]
s_waitcnt lgkmcnt(2)
T v[36:37],v20,49152
T v[38:39],v20,51200
M v[184:187],a[156:159],a[200:203],v[184:187]
T v[40:41],v20,53248
T v[42:43],v20,55296
M v[184:187],a[160:163],a[208:211],v[184:187]
SA s3,s93,536576
buffer_load_dwordx4 v8, s[52:55], s25 offen lds
M v[184:187],a[164:167],a[216:219],v[184:187]
s_nop 0
T v[44:45],v20,57344
T v[46:47],v20,59392
M v[184:187],a[168:171],a[224:227],v[184:187]
T v[48:49],v20,61440
T v[50:51],v20,63488
M v[188:191],a[168:171],a[228:231],0
s_mov_b32 s25, 384
buffer_store_dwordx4 v[88:91], v7, s[8:11], s3 offen offset:0 sc1
M v[188:191],a[164:167],a[220:223],v[188:191]
SA m0,s4,0
T v[52:53],v16,32768
T v[54:55],v16,34816
M v[188:191],a[160:163],a[212:215],v[188:191]
T v[56:57],v16,36864
T v[58:59],v16,38912
M v[188:191],a[156:159],a[204:207],v[188:191]
buffer_load_dwordx4 v8, s[52:55], s25 offen lds
M v[188:191],a[152:155],a[196:199],v[188:191]
C v113,v114,v115
C v114,v120,v121
M v[188:191],a[148:151],a[188:191],v[188:191]
buffer_store_dwordx4 v[92:95], v7, s[8:11], s3 offen offset:2048 sc1
M v[188:191],a[144:147],a[180:183],v[188:191]
s_waitcnt lgkmcnt(6)
C v115,v122,v123
W a4,v112
M v[160:163],v[32:35],a[232:235],v[160:163]
s_mov_b32 s25, 262528
T a[144:145],v21,45056
T a[146:147],v21,47104
M v[160:163],v[36:39],a[96:99],v[160:163]
SA m0,s4,4096
W a5,v113
W a6,v114
M v[160:163],v[40:43],a[104:107],v[160:163]
s_waitcnt lgkmcnt(2)
T a[148:149],v21,49152
T a[150:151],v21,51200
M v[160:163],v[44:47],a[112:115],v[160:163]
T a[152:153],v21,53248
T a[154:155],v21,55296
M v[160:163],v[48:51],a[120:123],v[160:163]
buffer_load_dwordx4 v8, s[52:55], s25 offen lds
M v[160:163],v[52:55],a[128:131],v[160:163]
s_nop 0
T a[156:157],v21,57344
T a[158:159],v21,59392
M v[160:163],v[56:59],a[136:139],v[160:163]
T a[160:161],v21,61440
T a[162:163],v21,63488
M v[164:167],v[56:59],a[140:143],v[164:167]
s_mov_b32 s25, 524672
W a7,v115
v_lshl_add_u32 v0, v0, 24, v25
M v[164:167],v[52:55],a[132:135],v[164:167]
SA s30,s32,0
T a[164:165],v17,32768
T a[166:167],v17,34816
M v[164:167],v[48:51],a[124:127],v[164:167]
SA m0,s4,8192
T a[168:169],v17,36864
T a[170:171],v17,38912
M v[164:167],v[44:47],a[116:119],v[164:167]
buffer_store_dwordx4 a[4:7], v6, s[8:11], s30 offen offset:1024 sc1
M v[164:167],v[40:43],a[108:111],v[164:167]
v_mov_b32 v24, 0x3f80
MF v116,s5,v116
M v[164:167],v[36:39],a[100:103],v[164:167]
buffer_load_dwordx4 v8, s[52:55], s25 offen lds
M v[164:167],v[32:35],a[236:239],v[164:167]
s_waitcnt lgkmcnt(6)
MF v117,s5,v117
MF v118,s5,v118
M v[168:171],a[144:147],a[232:235],v[168:171]
T v[32:33],v22,45056
T v[34:35],v22,47104
M v[168:171],a[148:151],a[96:99],v[168:171]
s_mov_b32 s25, 786816
MF v119,s5,v119
MF v124,s5,v124
M v[168:171],a[152:155],a[104:107],v[168:171]
s_waitcnt lgkmcnt(2)
T v[36:37],v22,49152
T v[38:39],v22,51200
M v[168:171],a[156:159],a[112:115],v[168:171]
SA m0,s4,12288
T v[40:41],v22,53248
T v[42:43],v22,55296
M v[168:171],a[160:163],a[120:123],v[168:171]
buffer_load_dwordx4 v8, s[52:55], s25 offen lds
M v[168:171],a[164:167],a[128:131],v[168:171]
s_nop 0
T v[44:45],v22,57344
T v[46:47],v22,59392
M v[168:171],a[168:171],a[136:139],v[168:171]
T v[48:49],v22,61440
T v[50:51],v22,63488
M v[172:175],a[168:171],a[140:143],v[172:175]
s_mov_b32 s25, 1048960
MF v125,s5,v125
MF v126,s5,v126
M v[172:175],a[164:167],a[132:135],v[172:175]
SA m0,s4,16384
T v[52:53],v18,32768
T v[54:55],v18,34816
M v[172:175],a[160:163],a[124:127],v[172:175]
T v[56:57],v18,36864
T v[58:59],v18,38912
M v[172:175],a[156:159],a[116:119],v[172:175]
buffer_load_dwordx4 v8, s[52:55], s25 offen lds
M v[172:175],a[152:155],a[108:111],v[172:175]
MF v127,s5,v127
C v116,v116,v117
M v[172:175],a[148:151],a[100:103],v[172:175]
v_lshrrev_b32 v25, 8, v7
v_bfe_u32 v26, v7, 6, 2
v_and_b32 v27, 16, v7
v_lshlrev_b32 v27, v27, v24
v_cmp_eq_u32 vcc, v25, v26
v_and_b32 v28, 32, v7
W a244,0
v_cndmask_b32 v27, 0, v27, vcc
v_cmp_eq_u32 vcc, 0, v28
W a245,0
W a248,0
v_cndmask_b32 v25, 0, v27, vcc
v_sub_u32 v26, v27, v25
W a249,0
W a246,v25
W a247,v26
M v[172:175],a[144:147],a[236:239],v[172:175]
s_waitcnt lgkmcnt(6)
C v117,v118,v119
C v118,v124,v125
M v[176:179],v[32:35],a[232:235],v[176:179]
s_mov_b32 s25, 1311104
T a[144:145],v23,45056
T a[146:147],v23,47104
M v[176:179],v[36:39],a[96:99],v[176:179]
SA m0,s4,20480
C v119,v126,v127
W a36,v116
M v[176:179],v[40:43],a[104:107],v[176:179]
s_waitcnt lgkmcnt(2)
T a[148:149],v23,49152
T a[150:151],v23,51200
M v[176:179],v[44:47],a[112:115],v[176:179]
T a[152:153],v23,53248
T a[154:155],v23,55296
M v[176:179],v[48:51],a[120:123],v[176:179]
buffer_load_dwordx4 v8, s[52:55], s25 offen lds
M v[176:179],v[52:55],a[128:131],v[176:179]
s_nop 0
T a[156:157],v23,57344
T a[158:159],v23,59392
M v[176:179],v[56:59],a[136:139],v[176:179]
T a[160:161],v23,61440
T a[162:163],v23,63488
M v[180:183],v[56:59],a[140:143],v[180:183]
s_mov_b32 s25, 1573248
W a37,v117
W a38,v118
M v[180:183],v[52:55],a[132:135],v[180:183]
SA m0,s4,24576
T a[164:165],v19,32768
T a[166:167],v19,34816
M v[180:183],v[48:51],a[124:127],v[180:183]
T a[168:169],v19,36864
T a[170:171],v19,38912
M v[180:183],v[44:47],a[116:119],v[180:183]
buffer_load_dwordx4 v8, s[52:55], s25 offen lds
M v[180:183],v[40:43],a[108:111],v[180:183]
W a39,v119
MF v160,s5,v160
M v[180:183],v[36:39],a[100:103],v[180:183]
s_waitcnt vmcnt(10) lgkmcnt(0)
MF v161,s5,v161
MF v162,s5,v162
M v[180:183],v[32:35],a[236:239],v[180:183]
s_barrier
M v[184:187],a[144:147],a[232:235],v[184:187]
SA s30,s32,8192
T v[32:33],v20,0
T v[34:35],v20,2048
M v[184:187],a[148:151],a[96:99],v[184:187]
s_mov_b32 s25, 1835392
buffer_store_dwordx4 a[36:39], v6, s[8:11], s30 offen offset:1024 sc1
M v[184:187],a[152:155],a[104:107],v[184:187]
SA m0,s4,28672
T v[36:37],v20,4096
T v[38:39],v20,6144
M v[184:187],a[156:159],a[112:115],v[184:187]
T v[40:41],v20,8192
T v[42:43],v20,10240
M v[184:187],a[160:163],a[120:123],v[184:187]
buffer_load_dwordx4 v8, s[52:55], s25 offen lds
M v[184:187],a[164:167],a[128:131],v[184:187]
s_nop 0
T v[44:45],v20,12288
T v[46:47],v20,14336
M v[184:187],a[168:171],a[136:139],v[184:187]
T v[48:49],v20,16384
T v[50:51],v20,18432
M v[188:191],a[168:171],a[140:143],v[188:191]
s_mov_b32 s25, 2097536
MF v163,s5,v163
MF v168,s5,v168
M v[188:191],a[164:167],a[132:135],v[188:191]
SA m0,s4,40960
T v[52:53],v20,20480
T v[54:55],v20,22528
M v[188:191],a[160:163],a[124:127],v[188:191]
T v[56:57],v20,24576
T v[58:59],v20,26624
M v[188:191],a[156:159],a[116:119],v[188:191]
buffer_load_dwordx4 v8, s[52:55], s25 offen lds
M v[188:191],a[152:155],a[108:111],v[188:191]
MF v169,s5,v169
MF v170,s5,v170
M v[188:191],a[148:151],a[100:103],v[188:191]
MF v171,s5,v171
C v160,v160,v161
M v[188:191],a[144:147],a[236:239],v[188:191]
s_waitcnt lgkmcnt(6)
C v161,v162,v163
C v162,v168,v169
M v[96:99],v[32:35],a[176:179],0
s_mov_b32 s25, 2359680
T a[144:145],v21,0
T a[146:147],v21,2048
M v[96:99],v[36:39],a[184:187],v[96:99]
SA m0,s4,45056
C v163,v170,v171
W a8,v160
M v[96:99],v[40:43],a[192:195],v[96:99]
s_waitcnt lgkmcnt(2)
T a[148:149],v21,4096
T a[150:151],v21,6144
M v[96:99],v[44:47],a[200:203],v[96:99]
T a[152:153],v21,8192
T a[154:155],v21,10240
M v[96:99],v[48:51],a[208:211],v[96:99]
buffer_load_dwordx4 v8, s[52:55], s25 offen lds
M v[96:99],v[52:55],a[216:219],v[96:99]
s_nop 0
T a[156:157],v21,12288
T a[158:159],v21,14336
M v[96:99],v[56:59],a[224:227],v[96:99]
T a[160:161],v21,16384
T a[162:163],v21,18432
M v[100:103],v[56:59],a[228:231],0
s_mov_b32 s25, 2621824
W a9,v161
W a10,v162
M v[100:103],v[52:55],a[220:223],v[100:103]
SA m0,s4,49152
T a[164:165],v21,20480
T a[166:167],v21,22528
M v[100:103],v[48:51],a[212:215],v[100:103]
T a[168:169],v21,24576
T a[170:171],v21,26624
M v[100:103],v[44:47],a[204:207],v[100:103]
buffer_load_dwordx4 v8, s[52:55], s25 offen lds
M v[100:103],v[40:43],a[196:199],v[100:103]
W a11,v163
v_lshrrev_b32 v31, 6, v7
M v[100:103],v[36:39],a[188:191],v[100:103]
SA s30,s32,0
buffer_store_dwordx4 a[8:11], v6, s[8:11], s30 offen offset:2048 sc1
M v[100:103],v[32:35],a[180:183],v[100:103]
s_waitcnt lgkmcnt(6)
v_bfe_u32 v28, v7, 4, 2
v_lshlrev_b32 v31, 5, v31
M v[104:107],a[144:147],a[176:179],0
s_mov_b32 s25, 2883968
T v[32:33],v22,0
T v[34:35],v22,2048
M v[104:107],a[148:151],a[184:187],v[104:107]
SA m0,s4,53248
v_add_lshl_u32 v31, v31, v28, 2
MF v164,s5,v164
M v[104:107],a[152:155],a[192:195],v[104:107]
s_waitcnt lgkmcnt(2)
T v[36:37],v22,4096
T v[38:39],v22,6144
M v[104:107],a[156:159],a[200:203],v[104:107]
T v[40:41],v22,8192
T v[42:43],v22,10240
M v[104:107],a[160:163],a[208:211],v[104:107]
buffer_load_dword v5, v31, s[8:11], s46 offen offset:4 sc1
M v[104:107],a[164:167],a[216:219],v[104:107]
s_nop 0
T v[44:45],v22,12288
T v[46:47],v22,14336
M v[104:107],a[168:171],a[224:227],v[104:107]
T v[48:49],v22,16384
T v[50:51],v22,18432
M v[108:111],a[168:171],a[228:231],0
buffer_load_dwordx4 v8, s[52:55], s25 offen lds
M v[108:111],a[164:167],a[220:223],v[108:111]
s_nop 0
T v[52:53],v22,20480
T v[54:55],v22,22528
M v[108:111],a[160:163],a[212:215],v[108:111]
T v[56:57],v22,24576
T v[58:59],v22,26624
M v[108:111],a[156:159],a[204:207],v[108:111]
s_mov_b32 s25, 3146112
MF v165,s5,v165
MF v166,s5,v166
M v[108:111],a[152:155],a[196:199],v[108:111]
SA m0,s4,57344
MF v167,s5,v167
MF v172,s5,v172
M v[108:111],a[148:151],a[188:191],v[108:111]
buffer_load_dwordx4 v8, s[52:55], s25 offen lds
M v[108:111],a[144:147],a[180:183],v[108:111]
s_waitcnt lgkmcnt(6)
MF v173,s5,v173
MF v174,s5,v174
M v[112:115],v[32:35],a[176:179],0
T a[144:145],v23,0
T a[146:147],v23,2048
M v[112:115],v[36:39],a[184:187],v[112:115]
s_mov_b32 s25, 3408256
MF v175,s5,v175
C v164,v164,v165
M v[112:115],v[40:43],a[192:195],v[112:115]
s_waitcnt lgkmcnt(2)
T a[148:149],v23,4096
T a[150:151],v23,6144
M v[112:115],v[44:47],a[200:203],v[112:115]
SA m0,s4,61440
T a[152:153],v23,8192
T a[154:155],v23,10240
M v[112:115],v[48:51],a[208:211],v[112:115]
buffer_load_dwordx4 v8, s[52:55], s25 offen lds
M v[112:115],v[52:55],a[216:219],v[112:115]
s_nop 0
T a[156:157],v23,12288
T a[158:159],v23,14336
M v[112:115],v[56:59],a[224:227],v[112:115]
T a[160:161],v23,16384
T a[162:163],v23,18432
M v[116:119],v[56:59],a[228:231],0
C v165,v166,v167
C v166,v172,v173
M v[116:119],v[52:55],a[220:223],v[116:119]
T a[164:165],v23,20480
T a[166:167],v23,22528
M v[116:119],v[48:51],a[212:215],v[116:119]
T a[168:169],v23,24576
T a[170:171],v23,26624
M v[116:119],v[44:47],a[204:207],v[116:119]
C v167,v174,v175
W a40,v164
M v[116:119],v[40:43],a[196:199],v[116:119]
W a41,v165
W a42,v166
M v[116:119],v[36:39],a[188:191],v[116:119]
W a43,v167
v_mov_b32 v8, 0xff800000
M v[116:119],v[32:35],a[180:183],v[116:119]
s_waitcnt lgkmcnt(6)
MF v176,s5,v176
MF v177,s5,v177
M v[120:123],a[144:147],a[176:179],0
SA s30,s32,8192
T v[32:33],v20,28672
T v[34:35],v20,30720
M v[120:123],a[148:151],a[184:187],v[120:123]
buffer_store_dwordx4 a[40:43], v6, s[8:11], s30 offen offset:2048 sc1
M v[120:123],a[152:155],a[192:195],v[120:123]
s_waitcnt lgkmcnt(2)
s_nop 0
T v[36:37],v12,24576
T v[38:39],v12,26624
M v[120:123],a[156:159],a[200:203],v[120:123]
T v[40:41],v12,28672
T v[42:43],v12,30720
M v[120:123],a[160:163],a[208:211],v[120:123]
MF v178,s5,v178
MF v179,s5,v179
M v[120:123],a[164:167],a[216:219],v[120:123]
T v[44:45],v12,0
T v[46:47],v12,2048
M v[120:123],a[168:171],a[224:227],v[120:123]
T v[48:49],v12,4096
T v[50:51],v12,6144
M v[124:127],a[168:171],a[228:231],0
MF v184,s5,v184
MF v185,s5,v185
M v[124:127],a[164:167],a[220:223],v[124:127]
T v[52:53],v12,8192
T v[54:55],v12,10240
M v[124:127],a[160:163],a[212:215],v[124:127]
T v[56:57],v12,12288
T v[58:59],v12,14336
M v[124:127],a[156:159],a[204:207],v[124:127]
MF v186,s5,v186
MF v187,s5,v187
M v[124:127],a[152:155],a[196:199],v[124:127]
C v176,v176,v177
C v177,v178,v179
M v[124:127],a[148:151],a[188:191],v[124:127]
C v178,v184,v185
C v179,v186,v187
M v[124:127],a[144:147],a[180:183],v[124:127]
s_waitcnt lgkmcnt(6)
W a12,v176
W a13,v177
M v[96:99],v[32:35],a[232:235],v[96:99]
T a[144:145],v21,28672
T a[146:147],v21,30720
M v[96:99],v[36:39],a[96:99],v[96:99]
W a14,v178
W a15,v179
M v[96:99],v[40:43],a[104:107],v[96:99]
s_waitcnt lgkmcnt(2)
T a[148:149],v13,24576
T a[150:151],v13,26624
M v[96:99],v[44:47],a[112:115],v[96:99]
SA s30,s32,0
T a[152:153],v13,28672
T a[154:155],v13,30720
M v[96:99],v[48:51],a[120:123],v[96:99]
buffer_store_dwordx4 a[12:15], v6, s[8:11], s30 offen offset:3072 sc1
M v[96:99],v[52:55],a[128:131],v[96:99]
s_nop 0
T a[156:157],v13,0
T a[158:159],v13,2048
M v[96:99],v[56:59],a[136:139],v[96:99]
T a[160:161],v13,4096
T a[162:163],v13,6144
M v[100:103],v[56:59],a[140:143],v[100:103]
MF v180,s5,v180
MF v181,s5,v181
M v[100:103],v[52:55],a[132:135],v[100:103]
T a[164:165],v13,8192
T a[166:167],v13,10240
M v[100:103],v[48:51],a[124:127],v[100:103]
T a[168:169],v13,12288
T a[170:171],v13,14336
M v[100:103],v[44:47],a[116:119],v[100:103]
MF v182,s5,v182
MF v183,s5,v183
M v[100:103],v[40:43],a[108:111],v[100:103]
MF v188,s5,v188
MF v189,s5,v189
M v[100:103],v[36:39],a[100:103],v[100:103]
MF v190,s5,v190
MF v191,s5,v191
M v[100:103],v[32:35],a[236:239],v[100:103]
s_waitcnt lgkmcnt(6)
C v180,v180,v181
C v181,v182,v183
M v[104:107],a[144:147],a[232:235],v[104:107]
T v[32:33],v22,28672
T v[34:35],v22,30720
M v[104:107],a[148:151],a[96:99],v[104:107]
C v182,v188,v189
C v183,v190,v191
M v[104:107],a[152:155],a[104:107],v[104:107]
s_waitcnt lgkmcnt(2)
T v[36:37],v14,24576
T v[38:39],v14,26624
M v[104:107],a[156:159],a[112:115],v[104:107]
T v[40:41],v14,28672
T v[42:43],v14,30720
M v[104:107],a[160:163],a[120:123],v[104:107]
W a44,v180
W a45,v181
M v[104:107],a[164:167],a[128:131],v[104:107]
T v[44:45],v14,0
T v[46:47],v14,2048
M v[104:107],a[168:171],a[136:139],v[104:107]
T v[48:49],v14,4096
T v[50:51],v14,6144
M v[108:111],a[168:171],a[140:143],v[108:111]
W a46,v182
W a47,v183
M v[108:111],a[164:167],a[132:135],v[108:111]
SA s30,s32,8192
T v[52:53],v14,8192
T v[54:55],v14,10240
M v[108:111],a[160:163],a[124:127],v[108:111]
T v[56:57],v14,12288
T v[58:59],v14,14336
M v[108:111],a[156:159],a[116:119],v[108:111]
buffer_store_dwordx4 a[44:47], v6, s[8:11], s30 offen offset:3072 sc1
M v[108:111],a[152:155],a[108:111],v[108:111]
s_waitcnt vmcnt(6)
v_cmp_ne_u32 vcc, 1, v5
MF v96,s5,v96
M v[108:111],a[148:151],a[100:103],v[108:111]
s_nop 0
MF v97,s5,v97
MF v98,s5,v98
M v[108:111],a[144:147],a[236:239],v[108:111]
s_waitcnt lgkmcnt(6)
MF v99,s5,v99
MF v104,s5,v104
M v[112:115],v[32:35],a[232:235],v[112:115]
s_cmp_lg_u32 vcc_lo, 0
T a[144:145],v23,28672
T a[146:147],v23,30720
M v[112:115],v[36:39],a[96:99],v[112:115]
s_cbranch_scc1 L_wsq1
L_wrq1:
MF v105,s5,v105
MF v106,s5,v106
M v[112:115],v[40:43],a[104:107],v[112:115]
s_waitcnt lgkmcnt(2)
T a[148:149],v15,24576
T a[150:151],v15,26624
M v[112:115],v[44:47],a[112:115],v[112:115]
SA m0,s28,98304
T a[152:153],v15,28672
T a[154:155],v15,30720
M v[112:115],v[48:51],a[120:123],v[112:115]
buffer_load_dwordx4 v3, s[8:11], s21 offen offset:0 sc1 lds
M v[112:115],v[52:55],a[128:131],v[112:115]
s_nop 0
T a[156:157],v15,0
T a[158:159],v15,2048
M v[112:115],v[56:59],a[136:139],v[112:115]
T a[160:161],v15,4096
T a[162:163],v15,6144
M v[116:119],v[56:59],a[140:143],v[116:119]
buffer_load_dwordx4 v3, s[8:11], s21 offen offset:1024 sc1 lds
M v[116:119],v[52:55],a[132:135],v[116:119]
s_nop 0
T a[164:165],v15,8192
T a[166:167],v15,10240
M v[116:119],v[48:51],a[124:127],v[116:119]
T a[168:169],v15,12288
T a[170:171],v15,14336
M v[116:119],v[44:47],a[116:119],v[116:119]
buffer_load_dwordx4 v3, s[8:11], s21 offen offset:2048 sc1 lds
M v[116:119],v[40:43],a[108:111],v[116:119]
MF v107,s5,v107
C v96,v96,v97
M v[116:119],v[36:39],a[100:103],v[116:119]
s_waitcnt vmcnt(6) lgkmcnt(0)
buffer_load_dwordx4 v3, s[8:11], s21 offen offset:3072 sc1 lds
M v[116:119],v[32:35],a[236:239],v[116:119]
s_barrier
M v[120:123],a[144:147],a[232:235],v[120:123]
SA m0,s28,102400
T v[32:33],v16,0
T v[34:35],v16,2048
M v[120:123],a[148:151],a[96:99],v[120:123]
buffer_load_dwordx4 v4, s[8:11], s21 offen offset:0 sc1 lds
M v[120:123],a[152:155],a[104:107],v[120:123]
s_nop 0
T v[36:37],v16,4096
T v[38:39],v16,6144
M v[120:123],a[156:159],a[112:115],v[120:123]
T v[40:41],v16,8192
T v[42:43],v16,10240
M v[120:123],a[160:163],a[120:123],v[120:123]
buffer_load_dwordx4 v4, s[8:11], s21 offen offset:1024 sc1 lds
M v[120:123],a[164:167],a[128:131],v[120:123]
s_nop 0
T v[44:45],v16,12288
T v[46:47],v16,14336
M v[120:123],a[168:171],a[136:139],v[120:123]
T v[48:49],v16,16384
T v[50:51],v16,18432
M v[124:127],a[168:171],a[140:143],v[124:127]
buffer_load_dwordx4 v4, s[8:11], s21 offen offset:2048 sc1 lds
M v[124:127],a[164:167],a[132:135],v[124:127]
s_nop 0
T v[52:53],v16,20480
T v[54:55],v16,22528
M v[124:127],a[160:163],a[124:127],v[124:127]
T v[56:57],v16,24576
T v[58:59],v16,26624
M v[124:127],a[156:159],a[116:119],v[124:127]
buffer_load_dwordx4 v4, s[8:11], s21 offen offset:3072 sc1 lds
M v[124:127],a[152:155],a[108:111],v[124:127]
SA s21,s21,32768
C v97,v98,v99
C v98,v104,v105
M v[124:127],a[148:151],a[100:103],v[124:127]
s_sub_u32 s22, s22, 1
C v99,v106,v107
W a16,v96
M v[124:127],a[144:147],a[236:239],v[124:127]
s_waitcnt lgkmcnt(6)
W a17,v97
W a18,v98
M v[160:163],v[32:35],a[176:179],0
s_cselect_b32 s21, s23, s21
T a[144:145],v17,0
T a[146:147],v17,2048
M v[160:163],v[36:39],a[184:187],v[160:163]
SA m0,s28,65536
W a19,v99
MF v100,s5,v100
M v[160:163],v[40:43],a[192:195],v[160:163]
s_waitcnt lgkmcnt(2)
T a[148:149],v17,4096
T a[150:151],v17,6144
M v[160:163],v[44:47],a[200:203],v[160:163]
SA s30,s32,4096
T a[152:153],v17,8192
T a[154:155],v17,10240
M v[160:163],v[48:51],a[208:211],v[160:163]
buffer_store_dwordx4 a[16:19], v6, s[8:11], s30 offen offset:0 sc1
M v[160:163],v[52:55],a[216:219],v[160:163]
s_nop 0
T a[156:157],v17,12288
T a[158:159],v17,14336
M v[160:163],v[56:59],a[224:227],v[160:163]
T a[160:161],v17,16384
T a[162:163],v17,18432
M v[164:167],v[56:59],a[228:231],0
buffer_load_dwordx4 v3, s[8:11], s21 offen offset:0 sc1 lds
M v[164:167],v[52:55],a[220:223],v[164:167]
s_nop 0
T a[164:165],v17,20480
T a[166:167],v17,22528
M v[164:167],v[48:51],a[212:215],v[164:167]
T a[168:169],v17,24576
T a[170:171],v17,26624
M v[164:167],v[44:47],a[204:207],v[164:167]
buffer_load_dwordx4 v3, s[8:11], s21 offen offset:1024 sc1 lds
M v[164:167],v[40:43],a[196:199],v[164:167]
buffer_load_dword v5, v31, s[8:11], s46 offen offset:4 sc1
M v[164:167],v[36:39],a[188:191],v[164:167]
buffer_load_dwordx4 v3, s[8:11], s21 offen offset:2048 sc1 lds
M v[164:167],v[32:35],a[180:183],v[164:167]
s_waitcnt lgkmcnt(6)
MF v101,s5,v101
MF v102,s5,v102
M v[168:171],a[144:147],a[176:179],0
T v[32:33],v18,0
T v[34:35],v18,2048
M v[168:171],a[148:151],a[184:187],v[168:171]
buffer_load_dwordx4 v3, s[8:11], s21 offen offset:3072 sc1 lds
M v[168:171],a[152:155],a[192:195],v[168:171]
s_waitcnt lgkmcnt(2)
s_nop 0
T v[36:37],v18,4096
T v[38:39],v18,6144
M v[168:171],a[156:159],a[200:203],v[168:171]
SA m0,s28,69632
T v[40:41],v18,8192
T v[42:43],v18,10240
M v[168:171],a[160:163],a[208:211],v[168:171]
buffer_load_dwordx4 v4, s[8:11], s21 offen offset:0 sc1 lds
M v[168:171],a[164:167],a[216:219],v[168:171]
s_nop 0
T v[44:45],v18,12288
T v[46:47],v18,14336
M v[168:171],a[168:171],a[224:227],v[168:171]
T v[48:49],v18,16384
T v[50:51],v18,18432
M v[172:175],a[168:171],a[228:231],0
buffer_load_dwordx4 v4, s[8:11], s21 offen offset:1024 sc1 lds
M v[172:175],a[164:167],a[220:223],v[172:175]
s_nop 0
T v[52:53],v18,20480
T v[54:55],v18,22528
M v[172:175],a[160:163],a[212:215],v[172:175]
T v[56:57],v18,24576
T v[58:59],v18,26624
M v[172:175],a[156:159],a[204:207],v[172:175]
buffer_load_dwordx4 v4, s[8:11], s21 offen offset:2048 sc1 lds
M v[172:175],a[152:155],a[196:199],v[172:175]
MF v103,s5,v103
MF v108,s5,v108
M v[172:175],a[148:151],a[188:191],v[172:175]
buffer_load_dwordx4 v4, s[8:11], s21 offen offset:3072 sc1 lds
M v[172:175],a[144:147],a[180:183],v[172:175]
s_waitcnt lgkmcnt(6)
MF v109,s5,v109
MF v110,s5,v110
M v[176:179],v[32:35],a[176:179],0
SA s21,s21,32768
T a[144:145],v19,0
T a[146:147],v19,2048
M v[176:179],v[36:39],a[184:187],v[176:179]
s_sub_u32 s22, s22, 1
MF v111,s5,v111
C v100,v100,v101
M v[176:179],v[40:43],a[192:195],v[176:179]
s_waitcnt lgkmcnt(2)
T a[148:149],v19,4096
T a[150:151],v19,6144
M v[176:179],v[44:47],a[200:203],v[176:179]
s_cselect_b32 s21, s23, s21
T a[152:153],v19,8192
T a[154:155],v19,10240
M v[176:179],v[48:51],a[208:211],v[176:179]
C v101,v102,v103
C v102,v108,v109
M v[176:179],v[52:55],a[216:219],v[176:179]
T a[156:157],v19,12288
T a[158:159],v19,14336
M v[176:179],v[56:59],a[224:227],v[176:179]
T a[160:161],v19,16384
T a[162:163],v19,18432
M v[180:183],v[56:59],a[228:231],0
C v103,v110,v111
W a48,v100
M v[180:183],v[52:55],a[220:223],v[180:183]
T a[164:165],v19,20480
T a[166:167],v19,22528
M v[180:183],v[48:51],a[212:215],v[180:183]
T a[168:169],v19,24576
T a[170:171],v19,26624
M v[180:183],v[44:47],a[204:207],v[180:183]
W a49,v101
W a50,v102
M v[180:183],v[40:43],a[196:199],v[180:183]
W a51,v103
MF v112,s5,v112
M v[180:183],v[36:39],a[188:191],v[180:183]
SA s30,s32,12288
buffer_store_dwordx4 a[48:51], v6, s[8:11], s30 offen offset:0 sc1
M v[180:183],v[32:35],a[180:183],v[180:183]
s_waitcnt lgkmcnt(6)
MF v113,s5,v113
MF v114,s5,v114
M v[184:187],a[144:147],a[176:179],0
T v[32:33],v16,28672
T v[34:35],v16,30720
M v[184:187],a[148:151],a[184:187],v[184:187]
MF v115,s5,v115
MF v120,s5,v120
M v[184:187],a[152:155],a[192:195],v[184:187]
s_waitcnt lgkmcnt(2)
T v[36:37],v16,40960
T v[38:39],v16,43008
M v[184:187],a[156:159],a[200:203],v[184:187]
T v[40:41],v16,45056
T v[42:43],v16,47104
M v[184:187],a[160:163],a[208:211],v[184:187]
MF v121,s5,v121
MF v122,s5,v122
M v[184:187],a[164:167],a[216:219],v[184:187]
T v[44:45],v16,49152
T v[46:47],v16,51200
M v[184:187],a[168:171],a[224:227],v[184:187]
T v[48:49],v16,53248
T v[50:51],v16,55296
M v[188:191],a[168:171],a[228:231],0
MF v123,s5,v123
C v112,v112,v113
M v[188:191],a[164:167],a[220:223],v[188:191]
T v[52:53],v16,57344
T v[54:55],v16,59392
M v[188:191],a[160:163],a[212:215],v[188:191]
T v[56:57],v16,61440
T v[58:59],v16,63488
M v[188:191],a[156:159],a[204:207],v[188:191]
C v113,v114,v115
C v114,v120,v121
M v[188:191],a[152:155],a[196:199],v[188:191]
C v115,v122,v123
W a20,v112
M v[188:191],a[148:151],a[188:191],v[188:191]
W a21,v113
W a22,v114
M v[188:191],a[144:147],a[180:183],v[188:191]
s_waitcnt lgkmcnt(6)
W a23,v115
MF v116,s5,v116
M v[160:163],v[32:35],a[232:235],v[160:163]
SA s30,s32,4096
T a[144:145],v17,28672
T a[146:147],v17,30720
M v[160:163],v[36:39],a[96:99],v[160:163]
buffer_store_dwordx4 a[20:23], v6, s[8:11], s30 offen offset:1024 sc1
M v[160:163],v[40:43],a[104:107],v[160:163]
s_waitcnt lgkmcnt(2)
s_nop 0
T a[148:149],v17,40960
T a[150:151],v17,43008
M v[160:163],v[44:47],a[112:115],v[160:163]
T a[152:153],v17,45056
T a[154:155],v17,47104
M v[160:163],v[48:51],a[120:123],v[160:163]
MF v117,s5,v117
MF v118,s5,v118
M v[160:163],v[52:55],a[128:131],v[160:163]
T a[156:157],v17,49152
T a[158:159],v17,51200
M v[160:163],v[56:59],a[136:139],v[160:163]
T a[160:161],v17,53248
T a[162:163],v17,55296
M v[164:167],v[56:59],a[140:143],v[164:167]
MF v119,s5,v119
MF v124,s5,v124
M v[164:167],v[52:55],a[132:135],v[164:167]
T a[164:165],v17,57344
T a[166:167],v17,59392
M v[164:167],v[48:51],a[124:127],v[164:167]
T a[168:169],v17,61440
T a[170:171],v17,63488
M v[164:167],v[44:47],a[116:119],v[164:167]
MF v125,s5,v125
MF v126,s5,v126
M v[164:167],v[40:43],a[108:111],v[164:167]
MF v127,s5,v127
C v116,v116,v117
M v[164:167],v[36:39],a[100:103],v[164:167]
C v117,v118,v119
C v118,v124,v125
M v[164:167],v[32:35],a[236:239],v[164:167]
s_waitcnt lgkmcnt(6)
C v119,v126,v127
W a52,v116
M v[168:171],a[144:147],a[232:235],v[168:171]
T v[32:33],v18,28672
T v[34:35],v18,30720
M v[168:171],a[148:151],a[96:99],v[168:171]
W a53,v117
W a54,v118
M v[168:171],a[152:155],a[104:107],v[168:171]
s_waitcnt lgkmcnt(2)
T v[36:37],v18,40960
T v[38:39],v18,43008
M v[168:171],a[156:159],a[112:115],v[168:171]
T v[40:41],v18,45056
T v[42:43],v18,47104
M v[168:171],a[160:163],a[120:123],v[168:171]
W a55,v119
s_waitcnt vmcnt(8)
v_cmp_ne_u32 vcc, 1, v5
M v[168:171],a[164:167],a[128:131],v[168:171]
SA s30,s32,12288
T v[44:45],v18,49152
T v[46:47],v18,51200
M v[168:171],a[168:171],a[136:139],v[168:171]
s_nop 0
T v[48:49],v18,53248
T v[50:51],v18,55296
M v[172:175],a[168:171],a[140:143],v[172:175]
s_cmp_lg_u32 vcc_hi, 0
buffer_store_dwordx4 a[52:55], v6, s[8:11], s30 offen offset:1024 sc1
M v[172:175],a[164:167],a[132:135],v[172:175]
s_cbranch_scc1 L_wsr1
L_wrr1:
T v[52:53],v18,57344
T v[54:55],v18,59392
M v[172:175],a[160:163],a[124:127],v[172:175]
SA m0,s28,131072
T v[56:57],v18,61440
T v[58:59],v18,63488
M v[172:175],a[156:159],a[116:119],v[172:175]
buffer_load_dwordx4 v3, s[8:11], s26 offen offset:0 sc1 lds
M v[172:175],a[152:155],a[108:111],v[172:175]
MF v160,s5,v160
MF v161,s5,v161
M v[172:175],a[148:151],a[100:103],v[172:175]
buffer_load_dwordx4 v3, s[8:11], s26 offen offset:1024 sc1 lds
M v[172:175],a[144:147],a[236:239],v[172:175]
s_waitcnt lgkmcnt(6)
MF v162,s5,v162
MF v163,s5,v163
M v[176:179],v[32:35],a[232:235],v[176:179]
T a[144:145],v19,28672
T a[146:147],v19,30720
M v[176:179],v[36:39],a[96:99],v[176:179]
buffer_load_dwordx4 v3, s[8:11], s26 offen offset:2048 sc1 lds
M v[176:179],v[40:43],a[104:107],v[176:179]
s_waitcnt lgkmcnt(2)
s_nop 0
T a[148:149],v19,40960
T a[150:151],v19,43008
M v[176:179],v[44:47],a[112:115],v[176:179]
T a[152:153],v19,45056
T a[154:155],v19,47104
M v[176:179],v[48:51],a[120:123],v[176:179]
buffer_load_dwordx4 v3, s[8:11], s26 offen offset:3072 sc1 lds
M v[176:179],v[52:55],a[128:131],v[176:179]
SA m0,s28,135168
T a[156:157],v19,49152
T a[158:159],v19,51200
M v[176:179],v[56:59],a[136:139],v[176:179]
T a[160:161],v19,53248
T a[162:163],v19,55296
M v[180:183],v[56:59],a[140:143],v[180:183]
buffer_load_dwordx4 v4, s[8:11], s26 offen offset:0 sc1 lds
M v[180:183],v[52:55],a[132:135],v[180:183]
s_nop 0
T a[164:165],v19,57344
T a[166:167],v19,59392
M v[180:183],v[48:51],a[124:127],v[180:183]
T a[168:169],v19,61440
T a[170:171],v19,63488
M v[180:183],v[44:47],a[116:119],v[180:183]
buffer_load_dwordx4 v4, s[8:11], s26 offen offset:1024 sc1 lds
M v[180:183],v[40:43],a[108:111],v[180:183]
MF v168,s5,v168
MF v169,s5,v169
M v[180:183],v[36:39],a[100:103],v[180:183]
s_waitcnt lgkmcnt(0)
buffer_load_dwordx4 v4, s[8:11], s26 offen offset:2048 sc1 lds
M v[180:183],v[32:35],a[236:239],v[180:183]
s_barrier
M v[184:187],a[144:147],a[232:235],v[184:187]
R a[64:67],v2,32768
R a[68:71],v2,33792
M v[184:187],a[148:151],a[96:99],v[184:187]
buffer_load_dwordx4 v4, s[8:11], s26 offen offset:3072 sc1 lds
M v[184:187],a[152:155],a[104:107],v[184:187]
SA s26,s26,32768
MF v170,s5,v170
MF v171,s5,v171
M v[184:187],a[156:159],a[112:115],v[184:187]
R a[72:75],v2,34816
R a[76:79],v2,35840
M v[184:187],a[160:163],a[120:123],v[184:187]
C v160,v160,v161
C v161,v162,v163
M v[184:187],a[164:167],a[128:131],v[184:187]
C v162,v168,v169
C v163,v170,v171
M v[184:187],a[168:171],a[136:139],v[184:187]
R a[80:83],v2,36864
R a[84:87],v2,37888
M v[188:191],a[168:171],a[140:143],v[188:191]
W a24,v160
W a25,v161
M v[188:191],a[164:167],a[132:135],v[188:191]
W a26,v162
W a27,v163
M v[188:191],a[160:163],a[124:127],v[188:191]
SA s30,s32,4096
R a[88:91],v2,38912
R a[92:95],v2,39936
M v[188:191],a[156:159],a[116:119],v[188:191]
buffer_store_dwordx4 a[24:27], v6, s[8:11], s30 offen offset:2048 sc1
M v[188:191],a[152:155],a[108:111],v[188:191]
MF v164,s5,v164
MF v165,s5,v165
M v[188:191],a[148:151],a[100:103],v[188:191]
MF v166,s5,v166
MF v167,s5,v167
M v[188:191],a[144:147],a[236:239],v[188:191]
s_waitcnt lgkmcnt(0)
MF v172,s5,v172
MF v173,s5,v173
MF v174,s5,v174
MF v175,s5,v175
C v164,v164,v165
C v165,v166,v167
C v166,v172,v173
C v167,v174,v175
W a56,v164
W a57,v165
W a58,v166
W a59,v167
SA s30,s32,12288
buffer_store_dwordx4 a[56:59], v6, s[8:11], s30 offen offset:2048 sc1
v_mov_b32 v30, 2
buffer_store_dword v30, v1, s[8:11], s45 offen sc1
M v[64:67],a[64:67],a[0:3],0
R a[96:99],v2,40960
R a[100:103],v2,41984
M v[64:67],a[68:71],a[4:7],v[64:67]
MF v176,s5,v176
MF v177,s5,v177
M v[64:67],a[72:75],a[8:11],v[64:67]
MF v178,s5,v178
MF v179,s5,v179
M v[64:67],a[76:79],a[12:15],v[64:67]
R a[104:107],v2,43008
R a[108:111],v2,44032
M v[64:67],a[80:83],a[16:19],v[64:67]
MF v184,s5,v184
MF v185,s5,v185
MF v186,s5,v186
MF v187,s5,v187
C v176,v176,v177
C v177,v178,v179
C v178,v184,v185
C v179,v186,v187
W a28,v176
W a29,v177
W a30,v178
W a31,v179
M v[64:67],a[84:87],a[20:23],v[64:67]
MF v180,s5,v180
MF v181,s5,v181
M v[64:67],a[88:91],a[24:27],v[64:67]
R a[112:115],v2,45056
R a[116:119],v2,46080
M v[64:67],a[92:95],a[28:31],v[64:67]
MF v182,s5,v182
MF v183,s5,v183
M v[68:71],a[64:67],a[32:35],0
MF v188,s5,v188
MF v189,s5,v189
M v[68:71],a[68:71],a[36:39],v[68:71]
R a[120:123],v2,47104
R a[124:127],v2,48128
M v[68:71],a[72:75],a[40:43],v[68:71]
SA m0,s28,32768
MF v190,s5,v190
MF v191,s5,v191
M v[68:71],a[76:79],a[44:47],v[68:71]
buffer_load_dwordx4 v3, s[8:11], s26 offen offset:0 sc1 lds
M v[68:71],a[80:83],a[48:51],v[68:71]
C v180,v180,v181
C v181,v182,v183
C v182,v188,v189
C v183,v190,v191
W a60,v180
W a61,v181
W a62,v182
W a63,v183
M v[68:71],a[84:87],a[52:55],v[68:71]
SA s30,s32,4096
buffer_store_dwordx4 a[28:31], v6, s[8:11], s30 offen offset:3072 sc1
M v[68:71],a[88:91],a[56:59],v[68:71]
SA s30,s32,12288
E v18,v64
M v[68:71],a[92:95],a[60:63],v[68:71]
s_waitcnt lgkmcnt(0)
buffer_store_dwordx4 a[60:63], v6, s[8:11], s30 offen offset:3072 sc1
M v[72:75],a[96:99],a[0:3],0
R a[64:67],v2,49152
R a[68:71],v2,50176
M v[72:75],a[100:103],a[4:7],v[72:75]
E v19,v65
M v[72:75],a[104:107],a[8:11],v[72:75]
buffer_load_dwordx4 v3, s[8:11], s26 offen offset:1024 sc1 lds
M v[72:75],a[108:111],a[12:15],v[72:75]
R a[72:75],v2,51200
R a[76:79],v2,52224
M v[72:75],a[112:115],a[16:19],v[72:75]
E v20,v66
M v[72:75],a[116:119],a[20:23],v[72:75]
buffer_load_dwordx4 v3, s[8:11], s26 offen offset:2048 sc1 lds
M v[72:75],a[120:123],a[24:27],v[72:75]
R a[80:83],v2,53248
R a[84:87],v2,54272
M v[72:75],a[124:127],a[28:31],v[72:75]
E v21,v67
M v[76:79],a[124:127],a[60:63],0
buffer_load_dwordx4 v3, s[8:11], s26 offen offset:3072 sc1 lds
M v[76:79],a[120:123],a[56:59],v[76:79]
SA m0,s28,36864
R a[88:91],v2,55296
R a[92:95],v2,56320
M v[76:79],a[116:119],a[52:55],v[76:79]
E v22,v68
M v[76:79],a[112:115],a[48:51],v[76:79]
buffer_load_dwordx4 v4, s[8:11], s26 offen offset:0 sc1 lds
M v[76:79],a[108:111],a[44:47],v[76:79]
E v23,v69
M v[76:79],a[104:107],a[40:43],v[76:79]
AF v26,v18,v19
C v40,v18,v19
M v[76:79],a[100:103],a[36:39],v[76:79]
buffer_load_dwordx4 v4, s[8:11], s26 offen offset:1024 sc1 lds
M v[76:79],a[96:99],a[32:35],v[76:79]
s_waitcnt lgkmcnt(0)
v_add_u32 v16, 0x20000, v7
AF v26,v20,v26
M v[80:83],a[64:67],a[0:3],0
R a[96:99],v2,57344
R a[100:103],v2,58368
M v[80:83],a[68:71],a[4:7],v[80:83]
buffer_load_dwordx4 v4, s[8:11], s26 offen offset:2048 sc1 lds
M v[80:83],a[72:75],a[8:11],v[80:83]
E v24,v70
M v[80:83],a[76:79],a[12:15],v[80:83]
R a[104:107],v2,59392
R a[108:111],v2,60416
M v[80:83],a[80:83],a[16:19],v[80:83]
buffer_load_dwordx4 v4, s[8:11], s26 offen offset:3072 sc1 lds
M v[80:83],a[84:87],a[20:23],v[80:83]
SA s26,s26,32768
E v25,v71
M v[80:83],a[88:91],a[24:27],v[80:83]
R a[112:115],v2,61440
R a[116:119],v2,62464
M v[80:83],a[92:95],a[28:31],v[80:83]
E v18,v72
M v[84:87],a[92:95],a[60:63],0
E v19,v73
M v[84:87],a[88:91],a[56:59],v[84:87]
R a[120:123],v2,63488
R a[124:127],v2,64512
M v[84:87],a[84:87],a[52:55],v[84:87]
C v41,v20,v21
AF v26,v21,v26
M v[84:87],a[80:83],a[48:51],v[84:87]
E v20,v74
M v[84:87],a[76:79],a[44:47],v[84:87]
AF v27,v22,v23
C v44,v22,v23
M v[84:87],a[72:75],a[40:43],v[84:87]
AF v27,v24,v27
C v45,v24,v25
M v[84:87],a[68:71],a[36:39],v[84:87]
s_waitcnt vmcnt(24) lgkmcnt(0)
E v21,v75
M v[84:87],a[64:67],a[32:35],v[84:87]
s_barrier
M v[88:91],a[96:99],a[0:3],0
R a[64:67],v2,0
R a[68:71],v2,1024
M v[88:91],a[100:103],a[4:7],v[88:91]
E v22,v76
M v[88:91],a[104:107],a[8:11],v[88:91]
AF v27,v25,v27
AF v26,v18,v26
M v[88:91],a[108:111],a[12:15],v[88:91]
R a[72:75],v2,2048
R a[76:79],v2,3072
M v[88:91],a[112:115],a[16:19],v[88:91]
E v23,v77
M v[88:91],a[116:119],a[20:23],v[88:91]
C v42,v18,v19
AF v26,v19,v26
M v[88:91],a[120:123],a[24:27],v[88:91]
R a[80:83],v2,4096
R a[84:87],v2,5120
M v[88:91],a[124:127],a[28:31],v[88:91]
E v24,v78
M v[92:95],a[124:127],a[60:63],0
AF v26,v20,v26
C v43,v20,v21
M v[92:95],a[120:123],a[56:59],v[92:95]
R a[88:91],v2,6144
R a[92:95],v2,7168
M v[92:95],a[116:119],a[52:55],v[92:95]
E v25,v79
M v[92:95],a[112:115],a[48:51],v[92:95]
AF v26,v21,v26
AF v27,v22,v27
M v[92:95],a[108:111],a[44:47],v[92:95]
C v46,v22,v23
AF v27,v23,v27
M v[92:95],a[104:107],a[40:43],v[92:95]
AF v27,v24,v27
C v47,v24,v25
M v[92:95],a[100:103],a[36:39],v[92:95]
s_waitcnt lgkmcnt(0)
AF v27,v25,v27
M v[92:95],a[96:99],a[32:35],v[92:95]
M v[96:99],a[64:67],a[0:3],0
R a[96:99],v2,8192
R a[100:103],v2,9216
M v[96:99],a[68:71],a[4:7],v[96:99]
SA m0,s28,98304
W a128,v128
W a129,v129
M v[96:99],a[72:75],a[8:11],v[96:99]
buffer_load_dwordx4 v3, s[8:11], s21 offen offset:0 sc1 lds
M v[96:99],a[76:79],a[12:15],v[96:99]
R a[104:107],v2,10240
R a[108:111],v2,11264
M v[96:99],a[80:83],a[16:19],v[96:99]
W a130,v130
v_mov_b32 v30, 0
M v[96:99],a[84:87],a[20:23],v[96:99]
W a131,v131
M v[96:99],a[88:91],a[24:27],v[96:99]
R a[112:115],v2,12288
R a[116:119],v2,13312
M v[96:99],a[92:95],a[28:31],v[96:99]
buffer_load_dwordx4 v3, s[8:11], s21 offen offset:1024 sc1 lds
M v[100:103],a[92:95],a[60:63],0
W a132,v132
v_mov_b32 v31, 0
M v[100:103],a[88:91],a[56:59],v[100:103]
R a[120:123],v2,14336
R a[124:127],v2,15360
M v[100:103],a[84:87],a[52:55],v[100:103]
W a133,v133
W a134,v134
M v[100:103],a[80:83],a[48:51],v[100:103]
buffer_load_dwordx4 v3, s[8:11], s21 offen offset:2048 sc1 lds
M v[100:103],a[76:79],a[44:47],v[100:103]
W a135,v135
M v[100:103],a[72:75],a[40:43],v[100:103]
v_mov_b32 v32, 0
M v[100:103],a[68:71],a[36:39],v[100:103]
W a136,v136
M v[100:103],a[64:67],a[32:35],v[100:103]
s_waitcnt lgkmcnt(0)
buffer_load_dwordx4 v3, s[8:11], s21 offen offset:3072 sc1 lds
M v[104:107],a[96:99],a[0:3],0
SA m0,s28,102400
R a[64:67],v2,16384
R a[68:71],v2,17408
M v[104:107],a[100:103],a[4:7],v[104:107]
W a137,v137
v_mov_b32 v33, 0
M v[104:107],a[104:107],a[8:11],v[104:107]
W a138,v138
M v[104:107],a[108:111],a[12:15],v[104:107]
R a[72:75],v2,18432
R a[76:79],v2,19456
M v[104:107],a[112:115],a[16:19],v[104:107]
buffer_load_dwordx4 v4, s[8:11], s21 offen offset:0 sc1 lds
M v[104:107],a[116:119],a[20:23],v[104:107]
W a139,v139
W a140,v140
M v[104:107],a[120:123],a[24:27],v[104:107]
R a[80:83],v2,20480
R a[84:87],v2,21504
M v[104:107],a[124:127],a[28:31],v[104:107]
buffer_load_dwordx4 v4, s[8:11], s21 offen offset:1024 sc1 lds
M v[108:111],a[124:127],a[60:63],0
v_mov_b32 v34, 0
W a141,v141
M v[108:111],a[120:123],a[56:59],v[108:111]
R a[88:91],v2,22528
R a[92:95],v2,23552
M v[108:111],a[116:119],a[52:55],v[108:111]
buffer_load_dwordx4 v4, s[8:11], s21 offen offset:2048 sc1 lds
M v[108:111],a[112:115],a[48:51],v[108:111]
W a142,v142
W a143,v143
M v[108:111],a[108:111],a[44:47],v[108:111]
v_mov_b32 v35, 0
W a144,v144
M v[108:111],a[104:107],a[40:43],v[108:111]
W a145,v145
M v[108:111],a[100:103],a[36:39],v[108:111]
buffer_load_dwordx4 v4, s[8:11], s21 offen offset:3072 sc1 lds
M v[108:111],a[96:99],a[32:35],v[108:111]
s_waitcnt lgkmcnt(0)
v_mov_b32 v36, 0
W a146,v146
M v[112:115],a[64:67],a[0:3],0
SA s21,s21,32768
R a[96:99],v2,24576
R a[100:103],v2,25600
M v[112:115],a[68:71],a[4:7],v[112:115]
s_sub_u32 s22, s22, 1
W a147,v147
M v[112:115],a[72:75],a[8:11],v[112:115]
s_cselect_b32 s21, s23, s21
E v18,v80
M v[112:115],a[76:79],a[12:15],v[112:115]
R a[104:107],v2,26624
R a[108:111],v2,27648
M v[112:115],a[80:83],a[16:19],v[112:115]
W a148,v148
v_mov_b32 v37, 0
M v[112:115],a[84:87],a[20:23],v[112:115]
W a149,v149
M v[112:115],a[88:91],a[24:27],v[112:115]
R a[112:115],v2,28672
R a[116:119],v2,29696
M v[112:115],a[92:95],a[28:31],v[112:115]
W a150,v150
M v[116:119],a[92:95],a[60:63],0
v_mov_b32 v38, 0
W a151,v151
M v[116:119],a[88:91],a[56:59],v[116:119]
R a[120:123],v2,30720
R a[124:127],v2,31744
M v[116:119],a[84:87],a[52:55],v[116:119]
W a152,v152
M v[116:119],a[80:83],a[48:51],v[116:119]
W a153,v153
M v[116:119],a[76:79],a[44:47],v[116:119]
E v19,v81
M v[116:119],a[72:75],a[40:43],v[116:119]
v_mov_b32 v39, 0
W a154,v154
M v[116:119],a[68:71],a[36:39],v[116:119]
s_waitcnt vmcnt(21) lgkmcnt(0)
E v20,v82
M v[116:119],a[64:67],a[32:35],v[116:119]
s_barrier
M v[120:123],a[96:99],a[0:3],0
R a[64:67],v16,0
R a[68:71],v16,1024
M v[120:123],a[100:103],a[4:7],v[120:123]
W a155,v155
W a156,v156
M v[120:123],a[104:107],a[8:11],v[120:123]
W a157,v157
AF v26,v18,v26
M v[120:123],a[108:111],a[12:15],v[120:123]
R a[72:75],v16,2048
R a[76:79],v16,3072
M v[120:123],a[112:115],a[16:19],v[120:123]
W a158,v158
C v56,v18,v19
M v[120:123],a[116:119],a[20:23],v[120:123]
E v21,v83
M v[120:123],a[120:123],a[24:27],v[120:123]
R a[80:83],v16,4096
R a[84:87],v16,5120
M v[120:123],a[124:127],a[28:31],v[120:123]
W a159,v159
AF v26,v19,v26
M v[124:127],a[124:127],a[60:63],0
E v22,v88
M v[124:127],a[120:123],a[56:59],v[124:127]
R a[88:91],v16,6144
R a[92:95],v16,7168
M v[124:127],a[116:119],a[52:55],v[124:127]
E v23,v89
M v[124:127],a[112:115],a[48:51],v[124:127]
E v24,v90
M v[124:127],a[108:111],a[44:47],v[124:127]
E v25,v91
M v[124:127],a[104:107],a[40:43],v[124:127]
E v18,v84
M v[124:127],a[100:103],a[36:39],v[124:127]
s_waitcnt lgkmcnt(0)
E v19,v85
M v[124:127],a[96:99],a[32:35],v[124:127]
AF v26,v20,v26
C v57,v20,v21
AF v26,v21,v26
AF v26,v22,v26
C v58,v22,v23
AF v26,v23,v26
AF v26,v24,v26
C v59,v24,v25
AF v26,v25,v26
E v20,v86
E v21,v87
AF v27,v18,v27
C v60,v18,v19
AF v27,v19,v27
E v22,v92
E v23,v93
AF v27,v20,v27
C v61,v20,v21
AF v27,v21,v27
E v24,v94
E v25,v95
AF v27,v22,v27
C v62,v22,v23
AF v27,v23,v27
AF v27,v24,v27
C v63,v24,v25
AF v27,v25,v27
v_max_f32 v10, v26, v27
v_min_f32 v11, v26, v27
v_cmp_lt_f32 vcc, s31, v10
v_cmp_gt_f32 s[64:65], s24, v11
s_nop 0
s_or_b64 vcc, vcc, s[64:65]
s_cbranch_vccnz L_stv1
L_rtv1:
M v[128:131],a[64:67],v[40:43],0
R a[96:99],v16,8192
R a[100:103],v16,9216
M v[128:131],a[68:71],v[56:59],v[128:131]
SA m0,s28,65536
W a160,v192
W a161,v193
M v[132:135],a[68:71],v[60:63],0
buffer_load_dwordx4 v3, s[8:11], s21 offen offset:0 sc1 lds
M v[132:135],a[64:67],v[44:47],v[132:135]
R a[104:107],v16,10240
R a[108:111],v16,11264
M v[136:139],a[72:75],v[40:43],0
W a162,v194
W a163,v195
M v[136:139],a[76:79],v[56:59],v[136:139]
W a164,v196
W a165,v197
M v[140:143],a[76:79],v[60:63],0
R a[112:115],v16,12288
R a[116:119],v16,13312
M v[140:143],a[72:75],v[44:47],v[140:143]
buffer_load_dwordx4 v3, s[8:11], s21 offen offset:1024 sc1 lds
M v[144:147],a[80:83],v[40:43],0
W a166,v198
W a167,v199
M v[144:147],a[84:87],v[56:59],v[144:147]
R a[120:123],v16,14336
R a[124:127],v16,15360
M v[148:151],a[84:87],v[60:63],0
W a168,v200
W a169,v201
M v[148:151],a[80:83],v[44:47],v[148:151]
buffer_load_dwordx4 v3, s[8:11], s21 offen offset:2048 sc1 lds
M v[152:155],a[88:91],v[40:43],0
W a170,v202
W a171,v203
M v[152:155],a[92:95],v[56:59],v[152:155]
W a172,v204
W a173,v205
M v[156:159],a[92:95],v[60:63],0
W a174,v206
W a175,v207
M v[156:159],a[88:91],v[44:47],v[156:159]
s_waitcnt lgkmcnt(0)
buffer_load_dwordx4 v3, s[8:11], s21 offen offset:3072 sc1 lds
M v[160:163],a[96:99],v[40:43],0
SA m0,s28,69632
R a[64:67],v16,16384
R a[68:71],v16,17408
M v[160:163],a[100:103],v[56:59],v[160:163]
W a176,v208
W a177,v209
M v[164:167],a[100:103],v[60:63],0
W a178,v210
W a179,v211
M v[164:167],a[96:99],v[44:47],v[164:167]
R a[72:75],v16,18432
R a[76:79],v16,19456
M v[168:171],a[104:107],v[40:43],0
buffer_load_dwordx4 v4, s[8:11], s21 offen offset:0 sc1 lds
M v[168:171],a[108:111],v[56:59],v[168:171]
W a180,v212
W a181,v213
M v[172:175],a[108:111],v[60:63],0
R a[80:83],v16,20480
R a[84:87],v16,21504
M v[172:175],a[104:107],v[44:47],v[172:175]
buffer_load_dwordx4 v4, s[8:11], s21 offen offset:1024 sc1 lds
M v[176:179],a[112:115],v[40:43],0
W a182,v214
W a183,v215
M v[176:179],a[116:119],v[56:59],v[176:179]
R a[88:91],v16,22528
R a[92:95],v16,23552
M v[180:183],a[116:119],v[60:63],0
buffer_load_dwordx4 v4, s[8:11], s21 offen offset:2048 sc1 lds
M v[180:183],a[112:115],v[44:47],v[180:183]
W a184,v216
W a185,v217
M v[184:187],a[120:123],v[40:43],0
W a186,v218
W a187,v219
W a188,v220
W a189,v221
W a190,v222
W a191,v223
M v[184:187],a[124:127],v[56:59],v[184:187]
E v18,v96
M v[188:191],a[124:127],v[60:63],0
buffer_load_dwordx4 v4, s[8:11], s21 offen offset:3072 sc1 lds
M v[188:191],a[120:123],v[44:47],v[188:191]
s_waitcnt lgkmcnt(0)
v_min_u32 v17, 1, v7
v_lshlrev_b32 v17, 29, v17
M v[192:195],a[64:67],v[40:43],0
SA s21,s21,32768
R a[96:99],v16,24576
R a[100:103],v16,25600
M v[192:195],a[68:71],v[56:59],v[192:195]
s_sub_u32 s22, s22, 1
v_mov_b32 v15, 1
AF v30,v26,v30
M v[196:199],a[68:71],v[60:63],0
s_cselect_b32 s21, s23, s21
E v19,v97
M v[196:199],a[64:67],v[44:47],v[196:199]
SA s84,s47,16
R a[104:107],v16,26624
R a[108:111],v16,27648
M v[200:203],a[72:75],v[40:43],0
SA s3,s93,262144
buffer_store_dwordx4 a[128:131], v7, s[8:11], s3 offen offset:0 sc1
M v[200:203],a[76:79],v[56:59],v[200:203]
E v20,v98
M v[204:207],a[76:79],v[60:63],0
R a[112:115],v16,28672
R a[116:119],v16,29696
M v[204:207],a[72:75],v[44:47],v[204:207]
E v21,v99
M v[208:211],a[80:83],v[40:43],0
E v22,v104
M v[208:211],a[84:87],v[56:59],v[208:211]
R a[120:123],v16,30720
R a[124:127],v16,31744
M v[212:215],a[84:87],v[60:63],0
buffer_store_dwordx4 a[132:135], v7, s[8:11], s3 offen offset:2048 sc1
M v[212:215],a[80:83],v[44:47],v[212:215]
E v23,v105
M v[216:219],a[88:91],v[40:43],0
AF v31,v27,v31
AF v28,v18,v19
M v[216:219],a[92:95],v[56:59],v[216:219]
E v24,v106
M v[220:223],a[92:95],v[60:63],0
s_waitcnt vmcnt(10) lgkmcnt(0)
E v25,v107
M v[220:223],a[88:91],v[44:47],v[220:223]
s_barrier
M v[224:227],a[96:99],v[40:43],0
R a[64:67],v2,32768
R a[68:71],v2,33792
M v[224:227],a[100:103],v[56:59],v[224:227]
buffer_store_dword v15, v17, s[8:11], s84 offen sc1
M v[228:231],a[100:103],v[60:63],0
SA s3,s93,266240
C v48,v18,v19
AF v28,v20,v28
M v[228:231],a[96:99],v[44:47],v[228:231]
R a[72:75],v2,34816
R a[76:79],v2,35840
M v[232:235],a[104:107],v[40:43],0
buffer_store_dwordx4 a[136:139], v7, s[8:11], s3 offen offset:0 sc1
M v[232:235],a[108:111],v[56:59],v[232:235]
E v18,v100
M v[236:239],a[108:111],v[60:63],0
R a[80:83],v2,36864
R a[84:87],v2,37888
M v[236:239],a[104:107],v[44:47],v[236:239]
E v19,v101
M v[240:243],a[112:115],v[40:43],0
C v49,v20,v21
AF v28,v21,v28
M v[240:243],a[116:119],v[56:59],v[240:243]
R a[88:91],v2,38912
R a[92:95],v2,39936
M v[244:247],a[116:119],v[60:63],0
E v20,v102
M v[244:247],a[112:115],v[44:47],v[244:247]
E v21,v103
M v[248:251],a[120:123],v[40:43],0
AF v28,v22,v28
C v50,v22,v23
M v[248:251],a[124:127],v[56:59],v[248:251]
AF v28,v23,v28
AF v28,v24,v28
M v[252:255],a[124:127],v[60:63],0
s_waitcnt lgkmcnt(0)
E v22,v108
M v[252:255],a[120:123],v[44:47],v[252:255]
E v23,v109
C v51,v24,v25
AF v28,v25,v28
AF v29,v18,v19
C v52,v18,v19
AF v29,v20,v29
C v53,v20,v21
AF v29,v21,v29
E v24,v110
E v25,v111
AF v29,v22,v29
C v54,v22,v23
AF v29,v23,v29
AF v29,v24,v29
C v55,v24,v25
AF v29,v25,v29
M v[64:67],a[64:67],a[0:3],v[32:35]
R a[96:99],v2,40960
R a[100:103],v2,41984
M v[64:67],a[68:71],a[4:7],v[64:67]
SA m0,s28,0
E v18,v112
M v[64:67],a[72:75],a[8:11],v[64:67]
buffer_load_dwordx4 v3, s[8:11], s26 offen offset:0 sc1 lds
M v[64:67],a[76:79],a[12:15],v[64:67]
R a[104:107],v2,43008
R a[108:111],v2,44032
M v[64:67],a[80:83],a[16:19],v[64:67]
E v19,v113
M v[64:67],a[84:87],a[20:23],v[64:67]
AF v28,v18,v28
C v56,v18,v19
M v[64:67],a[88:91],a[24:27],v[64:67]
R a[112:115],v2,45056
R a[116:119],v2,46080
M v[64:67],a[92:95],a[28:31],v[64:67]
buffer_load_dwordx4 v3, s[8:11], s26 offen offset:1024 sc1 lds
M v[68:71],a[92:95],a[60:63],v[36:39]
E v20,v114
M v[68:71],a[88:91],a[56:59],v[68:71]
R a[120:123],v2,47104
R a[124:127],v2,48128
M v[68:71],a[84:87],a[52:55],v[68:71]
E v21,v115
M v[68:71],a[80:83],a[48:51],v[68:71]
buffer_load_dwordx4 v3, s[8:11], s26 offen offset:2048 sc1 lds
M v[68:71],a[76:79],a[44:47],v[68:71]
AF v28,v19,v28
AF v28,v20,v28
M v[68:71],a[72:75],a[40:43],v[68:71]
C v57,v20,v21
AF v28,v21,v28
M v[68:71],a[68:71],a[36:39],v[68:71]
E v22,v120
M v[68:71],a[64:67],a[32:35],v[68:71]
s_waitcnt lgkmcnt(0)
buffer_load_dwordx4 v3, s[8:11], s26 offen offset:3072 sc1 lds
M v[72:75],a[96:99],a[0:3],v[32:35]
SA m0,s28,4096
R a[64:67],v2,49152
R a[68:71],v2,50176
M v[72:75],a[100:103],a[4:7],v[72:75]
E v23,v121
M v[72:75],a[104:107],a[8:11],v[72:75]
AF v28,v22,v28
C v58,v22,v23
M v[72:75],a[108:111],a[12:15],v[72:75]
R a[72:75],v2,51200
R a[76:79],v2,52224
M v[72:75],a[112:115],a[16:19],v[72:75]
buffer_load_dwordx4 v4, s[8:11], s26 offen offset:0 sc1 lds
M v[72:75],a[116:119],a[20:23],v[72:75]
E v24,v122
M v[72:75],a[120:123],a[24:27],v[72:75]
R a[80:83],v2,53248
R a[84:87],v2,54272
M v[72:75],a[124:127],a[28:31],v[72:75]
buffer_load_dwordx4 v4, s[8:11], s26 offen offset:1024 sc1 lds
M v[76:79],a[124:127],a[60:63],v[36:39]
E v25,v123
M v[76:79],a[120:123],a[56:59],v[76:79]
R a[88:91],v2,55296
R a[92:95],v2,56320
M v[76:79],a[116:119],a[52:55],v[76:79]
buffer_load_dwordx4 v4, s[8:11], s26 offen offset:2048 sc1 lds
M v[76:79],a[112:115],a[48:51],v[76:79]
AF v28,v23,v28
AF v28,v24,v28
M v[76:79],a[108:111],a[44:47],v[76:79]
E v18,v116
M v[76:79],a[104:107],a[40:43],v[76:79]
C v59,v24,v25
AF v28,v25,v28
M v[76:79],a[100:103],a[36:39],v[76:79]
buffer_load_dwordx4 v4, s[8:11], s26 offen offset:3072 sc1 lds
M v[76:79],a[96:99],a[32:35],v[76:79]
s_waitcnt lgkmcnt(0)
E v19,v117
M v[80:83],a[64:67],a[0:3],v[32:35]
SA s26,s26,32768
R a[96:99],v2,57344
R a[100:103],v2,58368
M v[80:83],a[68:71],a[4:7],v[80:83]
AF v29,v18,v29
C v60,v18,v19
M v[80:83],a[72:75],a[8:11],v[80:83]
SA s3,s93,266240
buffer_store_dwordx4 a[140:143], v7, s[8:11], s3 offen offset:2048 sc1
M v[80:83],a[76:79],a[12:15],v[80:83]
R a[104:107],v2,59392
R a[108:111],v2,60416
M v[80:83],a[80:83],a[16:19],v[80:83]
E v20,v118
M v[80:83],a[84:87],a[20:23],v[80:83]
AF v29,v19,v29
M v[80:83],a[88:91],a[24:27],v[80:83]
R a[112:115],v2,61440
R a[116:119],v2,62464
M v[80:83],a[92:95],a[28:31],v[80:83]
E v21,v119
M v[84:87],a[92:95],a[60:63],v[36:39]
AF v29,v20,v29
C v61,v20,v21
M v[84:87],a[88:91],a[56:59],v[84:87]
SA s3,s93,270336
R a[120:123],v2,63488
R a[124:127],v2,64512
M v[84:87],a[84:87],a[52:55],v[84:87]
buffer_store_dwordx4 a[144:147], v7, s[8:11], s3 offen offset:0 sc1
M v[84:87],a[80:83],a[48:51],v[84:87]
E v22,v124
M v[84:87],a[76:79],a[44:47],v[84:87]
AF v29,v21,v29
M v[84:87],a[72:75],a[40:43],v[84:87]
E v23,v125
M v[84:87],a[68:71],a[36:39],v[84:87]
s_waitcnt lgkmcnt(0)
AF v29,v22,v29
C v62,v22,v23
M v[84:87],a[64:67],a[32:35],v[84:87]
s_barrier
M v[88:91],a[96:99],a[0:3],v[32:35]
R a[64:67],v7,32768
R a[68:71],v7,33792
M v[88:91],a[100:103],a[4:7],v[88:91]
E v24,v126
M v[88:91],a[104:107],a[8:11],v[88:91]
AF v29,v23,v29
M v[88:91],a[108:111],a[12:15],v[88:91]
R a[72:75],v7,34816
R a[76:79],v7,35840
M v[88:91],a[112:115],a[16:19],v[88:91]
buffer_store_dwordx4 a[148:151], v7, s[8:11], s3 offen offset:2048 sc1
M v[88:91],a[116:119],a[20:23],v[88:91]
E v25,v127
M v[88:91],a[120:123],a[24:27],v[88:91]
R a[80:83],v7,36864
R a[84:87],v7,37888
M v[88:91],a[124:127],a[28:31],v[88:91]
AF v29,v24,v29
C v63,v24,v25
M v[92:95],a[124:127],a[60:63],v[36:39]
AF v29,v25,v29
M v[92:95],a[120:123],a[56:59],v[92:95]
R a[88:91],v7,38912
R a[92:95],v7,39936
M v[92:95],a[116:119],a[52:55],v[92:95]
v_max_f32 v10, v28, v29
M v[92:95],a[112:115],a[48:51],v[92:95]
v_cmp_lt_f32 vcc, s31, v10
M v[92:95],a[108:111],a[44:47],v[92:95]
M v[92:95],a[104:107],a[40:43],v[92:95]
M v[92:95],a[100:103],a[36:39],v[92:95]
s_waitcnt lgkmcnt(0)
M v[92:95],a[96:99],a[32:35],v[92:95]
s_cbranch_vccnz L_stv2
L_rtv2:
M v[128:131],a[64:67],v[48:51],v[128:131]
R a[96:99],v7,40960
R a[100:103],v7,41984
M v[128:131],a[68:71],v[56:59],v[128:131]
SA m0,s28,98304
E v18,v64
M v[132:135],a[68:71],v[60:63],v[132:135]
buffer_load_dwordx4 v3, s[8:11], s21 offen offset:0 sc1 lds
M v[132:135],a[64:67],v[52:55],v[132:135]
R a[104:107],v7,43008
R a[108:111],v7,44032
M v[136:139],a[72:75],v[48:51],v[136:139]
E v19,v65
M v[136:139],a[76:79],v[56:59],v[136:139]
AF v30,v28,v30
AF v31,v29,v31
M v[140:143],a[76:79],v[60:63],v[140:143]
R a[112:115],v7,45056
R a[116:119],v7,46080
M v[140:143],a[72:75],v[52:55],v[140:143]
buffer_load_dwordx4 v3, s[8:11], s21 offen offset:1024 sc1 lds
M v[144:147],a[80:83],v[48:51],v[144:147]
E v20,v66
M v[144:147],a[84:87],v[56:59],v[144:147]
R a[120:123],v7,47104
R a[124:127],v7,48128
M v[148:151],a[84:87],v[60:63],v[148:151]
AF v26,v18,v19
C v40,v18,v19
M v[148:151],a[80:83],v[52:55],v[148:151]
buffer_load_dwordx4 v3, s[8:11], s21 offen offset:2048 sc1 lds
M v[152:155],a[88:91],v[48:51],v[152:155]
E v21,v67
M v[152:155],a[92:95],v[56:59],v[152:155]
AF v26,v20,v26
C v41,v20,v21
M v[156:159],a[92:95],v[60:63],v[156:159]
AF v26,v21,v26
M v[156:159],a[88:91],v[52:55],v[156:159]
s_waitcnt lgkmcnt(0)
buffer_load_dwordx4 v3, s[8:11], s21 offen offset:3072 sc1 lds
M v[160:163],a[96:99],v[48:51],v[160:163]
SA m0,s28,102400
R a[64:67],v7,49152
R a[68:71],v7,50176
M v[160:163],a[100:103],v[56:59],v[160:163]
E v22,v72
M v[164:167],a[100:103],v[60:63],v[164:167]
E v23,v73
M v[164:167],a[96:99],v[52:55],v[164:167]
R a[72:75],v7,51200
R a[76:79],v7,52224
M v[168:171],a[104:107],v[48:51],v[168:171]
buffer_load_dwordx4 v4, s[8:11], s21 offen offset:0 sc1 lds
M v[168:171],a[108:111],v[56:59],v[168:171]
AF v26,v22,v26
C v42,v22,v23
M v[172:175],a[108:111],v[60:63],v[172:175]
R a[80:83],v7,53248
R a[84:87],v7,54272
M v[172:175],a[104:107],v[52:55],v[172:175]
buffer_load_dwordx4 v4, s[8:11], s21 offen offset:1024 sc1 lds
M v[176:179],a[112:115],v[48:51],v[176:179]
E v24,v74
M v[176:179],a[116:119],v[56:59],v[176:179]
R a[88:91],v7,55296
R a[92:95],v7,56320
M v[180:183],a[116:119],v[60:63],v[180:183]
buffer_load_dwordx4 v4, s[8:11], s21 offen offset:2048 sc1 lds
M v[180:183],a[112:115],v[52:55],v[180:183]
E v25,v75
M v[184:187],a[120:123],v[48:51],v[184:187]
AF v26,v23,v26
AF v26,v24,v26
M v[184:187],a[124:127],v[56:59],v[184:187]
C v43,v24,v25
AF v26,v25,v26
M v[188:191],a[124:127],v[60:63],v[188:191]
buffer_load_dwordx4 v4, s[8:11], s21 offen offset:3072 sc1 lds
M v[188:191],a[120:123],v[52:55],v[188:191]
s_waitcnt lgkmcnt(0)
E v18,v68
M v[192:195],a[64:67],v[48:51],v[192:195]
SA s21,s21,32768
R a[96:99],v7,57344
R a[100:103],v7,58368
M v[192:195],a[68:71],v[56:59],v[192:195]
s_sub_u32 s22, s22, 1
E v19,v69
M v[196:199],a[68:71],v[60:63],v[196:199]
s_cselect_b32 s21, s23, s21
AF v27,v18,v19
C v44,v18,v19
M v[196:199],a[64:67],v[52:55],v[196:199]
SA s3,s93,274432
R a[104:107],v7,59392
R a[108:111],v7,60416
M v[200:203],a[72:75],v[48:51],v[200:203]
buffer_store_dwordx4 a[152:155], v7, s[8:11], s3 offen offset:0 sc1
M v[200:203],a[76:79],v[56:59],v[200:203]
E v20,v70
M v[204:207],a[76:79],v[60:63],v[204:207]
R a[112:115],v7,61440
R a[116:119],v7,62464
M v[204:207],a[72:75],v[52:55],v[204:207]
M v[208:211],a[80:83],v[48:51],v[208:211]
M v[208:211],a[84:87],v[56:59],v[208:211]
R a[120:123],v7,63488
R a[124:127],v7,64512
M v[212:215],a[84:87],v[60:63],v[212:215]
buffer_store_dwordx4 a[156:159], v7, s[8:11], s3 offen offset:2048 sc1
M v[212:215],a[80:83],v[52:55],v[212:215]
E v21,v71
M v[216:219],a[88:91],v[48:51],v[216:219]
AF v27,v20,v27
C v45,v20,v21
M v[216:219],a[92:95],v[56:59],v[216:219]
E v22,v76
M v[220:223],a[92:95],v[60:63],v[220:223]
s_waitcnt vmcnt(25) lgkmcnt(0)
AF v27,v21,v27
M v[220:223],a[88:91],v[52:55],v[220:223]
s_barrier
M v[224:227],a[96:99],v[48:51],v[224:227]
R a[64:67],v2,0
R a[68:71],v2,1024
M v[224:227],a[100:103],v[56:59],v[224:227]
E v23,v77
M v[228:231],a[100:103],v[60:63],v[228:231]
SA s3,s93,786432
AF v27,v22,v27
C v46,v22,v23
M v[228:231],a[96:99],v[52:55],v[228:231]
R a[72:75],v2,2048
R a[76:79],v2,3072
M v[232:235],a[104:107],v[48:51],v[232:235]
buffer_store_dwordx4 a[160:163], v7, s[8:11], s3 offen offset:0 sc1
M v[232:235],a[108:111],v[56:59],v[232:235]
E v24,v78
M v[236:239],a[108:111],v[60:63],v[236:239]
R a[80:83],v2,4096
R a[84:87],v2,5120
M v[236:239],a[104:107],v[52:55],v[236:239]
AF v27,v23,v27
M v[240:243],a[112:115],v[48:51],v[240:243]
E v25,v79
M v[240:243],a[116:119],v[56:59],v[240:243]
R a[88:91],v2,6144
R a[92:95],v2,7168
M v[244:247],a[116:119],v[60:63],v[244:247]
AF v27,v24,v27
C v47,v24,v25
M v[244:247],a[112:115],v[52:55],v[244:247]
AF v27,v25,v27
M v[248:251],a[120:123],v[48:51],v[248:251]
M v[248:251],a[124:127],v[56:59],v[248:251]
M v[252:255],a[124:127],v[60:63],v[252:255]
s_waitcnt lgkmcnt(0)
M v[252:255],a[120:123],v[52:55],v[252:255]
M v[96:99],a[64:67],a[0:3],v[32:35]
R a[96:99],v2,8192
R a[100:103],v2,9216
M v[96:99],a[68:71],a[4:7],v[96:99]
SA m0,s28,32768
E v18,v80
M v[96:99],a[72:75],a[8:11],v[96:99]
buffer_load_dwordx4 v3, s[8:11], s26 offen offset:0 sc1 lds
M v[96:99],a[76:79],a[12:15],v[96:99]
R a[104:107],v2,10240
R a[108:111],v2,11264
M v[96:99],a[80:83],a[16:19],v[96:99]
E v19,v81
M v[96:99],a[84:87],a[20:23],v[96:99]
AF v26,v18,v26
C v56,v18,v19
M v[96:99],a[88:91],a[24:27],v[96:99]
R a[112:115],v2,12288
R a[116:119],v2,13312
M v[96:99],a[92:95],a[28:31],v[96:99]
buffer_load_dwordx4 v3, s[8:11], s26 offen offset:1024 sc1 lds
M v[100:103],a[92:95],a[60:63],v[36:39]
E v20,v82
M v[100:103],a[88:91],a[56:59],v[100:103]
R a[120:123],v2,14336
R a[124:127],v2,15360
M v[100:103],a[84:87],a[52:55],v[100:103]
E v21,v83
M v[100:103],a[80:83],a[48:51],v[100:103]
buffer_load_dwordx4 v3, s[8:11], s26 offen offset:2048 sc1 lds
M v[100:103],a[76:79],a[44:47],v[100:103]
AF v26,v19,v26
AF v26,v20,v26
M v[100:103],a[72:75],a[40:43],v[100:103]
C v57,v20,v21
AF v26,v21,v26
M v[100:103],a[68:71],a[36:39],v[100:103]
E v22,v88
M v[100:103],a[64:67],a[32:35],v[100:103]
s_waitcnt lgkmcnt(0)
buffer_load_dwordx4 v3, s[8:11], s26 offen offset:3072 sc1 lds
M v[104:107],a[96:99],a[0:3],v[32:35]
SA m0,s28,36864
R a[64:67],v2,16384
R a[68:71],v2,17408
M v[104:107],a[100:103],a[4:7],v[104:107]
E v23,v89
M v[104:107],a[104:107],a[8:11],v[104:107]
AF v26,v22,v26
C v58,v22,v23
M v[104:107],a[108:111],a[12:15],v[104:107]
R a[72:75],v2,18432
R a[76:79],v2,19456
M v[104:107],a[112:115],a[16:19],v[104:107]
buffer_load_dwordx4 v4, s[8:11], s26 offen offset:0 sc1 lds
M v[104:107],a[116:119],a[20:23],v[104:107]
E v24,v90
M v[104:107],a[120:123],a[24:27],v[104:107]
R a[80:83],v2,20480
R a[84:87],v2,21504
M v[104:107],a[124:127],a[28:31],v[104:107]
buffer_load_dwordx4 v4, s[8:11], s26 offen offset:1024 sc1 lds
M v[108:111],a[124:127],a[60:63],v[36:39]
E v25,v91
M v[108:111],a[120:123],a[56:59],v[108:111]
R a[88:91],v2,22528
R a[92:95],v2,23552
M v[108:111],a[116:119],a[52:55],v[108:111]
buffer_load_dwordx4 v4, s[8:11], s26 offen offset:2048 sc1 lds
M v[108:111],a[112:115],a[48:51],v[108:111]
AF v26,v23,v26
AF v26,v24,v26
M v[108:111],a[108:111],a[44:47],v[108:111]
E v18,v84
M v[108:111],a[104:107],a[40:43],v[108:111]
C v59,v24,v25
AF v26,v25,v26
M v[108:111],a[100:103],a[36:39],v[108:111]
buffer_load_dwordx4 v4, s[8:11], s26 offen offset:3072 sc1 lds
M v[108:111],a[96:99],a[32:35],v[108:111]
s_waitcnt lgkmcnt(0)
E v19,v85
M v[112:115],a[64:67],a[0:3],v[32:35]
SA s26,s26,32768
R a[96:99],v2,24576
R a[100:103],v2,25600
M v[112:115],a[68:71],a[4:7],v[112:115]
AF v27,v18,v27
C v60,v18,v19
M v[112:115],a[72:75],a[8:11],v[112:115]
SA s3,s93,786432
buffer_store_dwordx4 a[164:167], v7, s[8:11], s3 offen offset:2048 sc1
M v[112:115],a[76:79],a[12:15],v[112:115]
R a[104:107],v2,26624
R a[108:111],v2,27648
M v[112:115],a[80:83],a[16:19],v[112:115]
E v20,v86
M v[112:115],a[84:87],a[20:23],v[112:115]
AF v27,v19,v27
M v[112:115],a[88:91],a[24:27],v[112:115]
R a[112:115],v2,28672
R a[116:119],v2,29696
M v[112:115],a[92:95],a[28:31],v[112:115]
SA s3,s93,790528
E v21,v87
M v[116:119],a[92:95],a[60:63],v[36:39]
buffer_store_dwordx4 a[168:171], v7, s[8:11], s3 offen offset:0 sc1
M v[116:119],a[88:91],a[56:59],v[116:119]
R a[120:123],v2,30720
R a[124:127],v2,31744
M v[116:119],a[84:87],a[52:55],v[116:119]
E v22,v92
M v[116:119],a[80:83],a[48:51],v[116:119]
AF v27,v20,v27
C v61,v20,v21
M v[116:119],a[76:79],a[44:47],v[116:119]
AF v27,v21,v27
M v[116:119],a[72:75],a[40:43],v[116:119]
E v23,v93
M v[116:119],a[68:71],a[36:39],v[116:119]
s_waitcnt vmcnt(24) lgkmcnt(0)
AF v27,v22,v27
C v62,v22,v23
M v[116:119],a[64:67],a[32:35],v[116:119]
s_barrier
M v[120:123],a[96:99],a[0:3],v[32:35]
R a[64:67],v7,0
R a[68:71],v7,1024
M v[120:123],a[100:103],a[4:7],v[120:123]
buffer_store_dwordx4 a[172:175], v7, s[8:11], s3 offen offset:2048 sc1
M v[120:123],a[104:107],a[8:11],v[120:123]
E v24,v94
M v[120:123],a[108:111],a[12:15],v[120:123]
R a[72:75],v7,2048
R a[76:79],v7,3072
M v[120:123],a[112:115],a[16:19],v[120:123]
SA s3,s93,794624
E v25,v95
M v[120:123],a[116:119],a[20:23],v[120:123]
buffer_store_dwordx4 a[176:179], v7, s[8:11], s3 offen offset:0 sc1
M v[120:123],a[120:123],a[24:27],v[120:123]
R a[80:83],v7,4096
R a[84:87],v7,5120
M v[120:123],a[124:127],a[28:31],v[120:123]
AF v27,v23,v27
AF v27,v24,v27
M v[124:127],a[124:127],a[60:63],v[36:39]
C v63,v24,v25
AF v27,v25,v27
M v[124:127],a[120:123],a[56:59],v[124:127]
R a[88:91],v7,6144
R a[92:95],v7,7168
M v[124:127],a[116:119],a[52:55],v[124:127]
v_max_f32 v10, v26, v27
M v[124:127],a[112:115],a[48:51],v[124:127]
v_cmp_lt_f32 vcc, s31, v10
M v[124:127],a[108:111],a[44:47],v[124:127]
M v[124:127],a[104:107],a[40:43],v[124:127]
M v[124:127],a[100:103],a[36:39],v[124:127]
s_waitcnt lgkmcnt(0)
M v[124:127],a[96:99],a[32:35],v[124:127]
s_cbranch_vccnz L_stv3
L_rtv3:
M v[128:131],a[64:67],v[40:43],v[128:131]
R a[96:99],v7,8192
R a[100:103],v7,9216
M v[128:131],a[68:71],v[56:59],v[128:131]
SA m0,s28,65536
E v18,v96
M v[132:135],a[68:71],v[60:63],v[132:135]
buffer_load_dwordx4 v3, s[8:11], s21 offen offset:0 sc1 lds
M v[132:135],a[64:67],v[44:47],v[132:135]
R a[104:107],v7,10240
R a[108:111],v7,11264
M v[136:139],a[72:75],v[40:43],v[136:139]
E v19,v97
M v[136:139],a[76:79],v[56:59],v[136:139]
AF v30,v26,v30
AF v31,v27,v31
M v[140:143],a[76:79],v[60:63],v[140:143]
R a[112:115],v7,12288
R a[116:119],v7,13312
M v[140:143],a[72:75],v[44:47],v[140:143]
buffer_load_dwordx4 v3, s[8:11], s21 offen offset:1024 sc1 lds
M v[144:147],a[80:83],v[40:43],v[144:147]
E v20,v98
M v[144:147],a[84:87],v[56:59],v[144:147]
R a[120:123],v7,14336
R a[124:127],v7,15360
M v[148:151],a[84:87],v[60:63],v[148:151]
AF v28,v18,v19
C v48,v18,v19
M v[148:151],a[80:83],v[44:47],v[148:151]
buffer_load_dwordx4 v3, s[8:11], s21 offen offset:2048 sc1 lds
M v[152:155],a[88:91],v[40:43],v[152:155]
E v21,v99
M v[152:155],a[92:95],v[56:59],v[152:155]
AF v28,v20,v28
C v49,v20,v21
M v[156:159],a[92:95],v[60:63],v[156:159]
AF v28,v21,v28
M v[156:159],a[88:91],v[44:47],v[156:159]
s_waitcnt lgkmcnt(0)
buffer_load_dwordx4 v3, s[8:11], s21 offen offset:3072 sc1 lds
M v[160:163],a[96:99],v[40:43],v[160:163]
SA m0,s28,69632
R a[64:67],v7,16384
R a[68:71],v7,17408
M v[160:163],a[100:103],v[56:59],v[160:163]
E v22,v104
M v[164:167],a[100:103],v[60:63],v[164:167]
E v23,v105
M v[164:167],a[96:99],v[44:47],v[164:167]
R a[72:75],v7,18432
R a[76:79],v7,19456
M v[168:171],a[104:107],v[40:43],v[168:171]
buffer_load_dwordx4 v4, s[8:11], s21 offen offset:0 sc1 lds
M v[168:171],a[108:111],v[56:59],v[168:171]
AF v28,v22,v28
C v50,v22,v23
M v[172:175],a[108:111],v[60:63],v[172:175]
R a[80:83],v7,20480
R a[84:87],v7,21504
M v[172:175],a[104:107],v[44:47],v[172:175]
buffer_load_dwordx4 v4, s[8:11], s21 offen offset:1024 sc1 lds
M v[176:179],a[112:115],v[40:43],v[176:179]
E v24,v106
M v[176:179],a[116:119],v[56:59],v[176:179]
R a[88:91],v7,22528
R a[92:95],v7,23552
M v[180:183],a[116:119],v[60:63],v[180:183]
buffer_load_dwordx4 v4, s[8:11], s21 offen offset:2048 sc1 lds
M v[180:183],a[112:115],v[44:47],v[180:183]
E v25,v107
M v[184:187],a[120:123],v[40:43],v[184:187]
AF v28,v23,v28
AF v28,v24,v28
M v[184:187],a[124:127],v[56:59],v[184:187]
C v51,v24,v25
AF v28,v25,v28
M v[188:191],a[124:127],v[60:63],v[188:191]
buffer_load_dwordx4 v4, s[8:11], s21 offen offset:3072 sc1 lds
M v[188:191],a[120:123],v[44:47],v[188:191]
s_waitcnt lgkmcnt(0)
E v18,v100
M v[192:195],a[64:67],v[40:43],v[192:195]
SA s21,s21,32768
R a[96:99],v7,24576
R a[100:103],v7,25600
M v[192:195],a[68:71],v[56:59],v[192:195]
s_sub_u32 s22, s22, 1
E v19,v101
M v[196:199],a[68:71],v[60:63],v[196:199]
s_cselect_b32 s21, s23, s21
AF v29,v18,v19
C v52,v18,v19
M v[196:199],a[64:67],v[44:47],v[196:199]
SA s3,s93,794624
R a[104:107],v7,26624
R a[108:111],v7,27648
M v[200:203],a[72:75],v[40:43],v[200:203]
buffer_store_dwordx4 a[180:183], v7, s[8:11], s3 offen offset:2048 sc1
M v[200:203],a[76:79],v[56:59],v[200:203]
E v20,v102
M v[204:207],a[76:79],v[60:63],v[204:207]
R a[112:115],v7,28672
R a[116:119],v7,29696
M v[204:207],a[72:75],v[44:47],v[204:207]
M v[208:211],a[80:83],v[40:43],v[208:211]
M v[208:211],a[84:87],v[56:59],v[208:211]
SA s3,s93,798720
R a[120:123],v7,30720
R a[124:127],v7,31744
M v[212:215],a[84:87],v[60:63],v[212:215]
buffer_store_dwordx4 a[184:187], v7, s[8:11], s3 offen offset:0 sc1
M v[212:215],a[80:83],v[44:47],v[212:215]
E v21,v103
M v[216:219],a[88:91],v[40:43],v[216:219]
AF v29,v20,v29
C v53,v20,v21
M v[216:219],a[92:95],v[56:59],v[216:219]
E v22,v108
M v[220:223],a[92:95],v[60:63],v[220:223]
s_waitcnt vmcnt(25) lgkmcnt(0)
AF v29,v21,v29
M v[220:223],a[88:91],v[44:47],v[220:223]
s_barrier
M v[224:227],a[96:99],v[40:43],v[224:227]
R a[64:67],v2,32768
R a[68:71],v2,33792
M v[224:227],a[100:103],v[56:59],v[224:227]
E v23,v109
M v[228:231],a[100:103],v[60:63],v[228:231]
AF v29,v22,v29
C v54,v22,v23
M v[228:231],a[96:99],v[44:47],v[228:231]
R a[72:75],v2,34816
R a[76:79],v2,35840
M v[232:235],a[104:107],v[40:43],v[232:235]
buffer_store_dwordx4 a[188:191], v7, s[8:11], s3 offen offset:2048 sc1
M v[232:235],a[108:111],v[56:59],v[232:235]
E v24,v110
M v[236:239],a[108:111],v[60:63],v[236:239]
R a[80:83],v2,36864
R a[84:87],v2,37888
M v[236:239],a[104:107],v[44:47],v[236:239]
AF v29,v23,v29
M v[240:243],a[112:115],v[40:43],v[240:243]
E v25,v111
M v[240:243],a[116:119],v[56:59],v[240:243]
R a[88:91],v2,38912
R a[92:95],v2,39936
M v[244:247],a[116:119],v[60:63],v[244:247]
AF v29,v24,v29
C v55,v24,v25
M v[244:247],a[112:115],v[44:47],v[244:247]
AF v29,v25,v29
M v[248:251],a[120:123],v[40:43],v[248:251]
M v[248:251],a[124:127],v[56:59],v[248:251]
M v[252:255],a[124:127],v[60:63],v[252:255]
s_waitcnt lgkmcnt(0)
M v[252:255],a[120:123],v[44:47],v[252:255]
s_branch L_loop_top
L_st0:
s_call_b64 s[36:37], L_slow0
s_branch L_rt0
L_st1:
s_call_b64 s[36:37], L_slow1
s_branch L_rt1
L_stv1:
s_call_b64 s[36:37], L_slowf
s_branch L_rtv1
L_stk1:
s_call_b64 s[36:37], L_slowf
s_branch L_rtk1
L_sth1:
s_call_b64 s[36:37], L_slowf
s_branch L_rth1
L_stj0:
s_call_b64 s[36:37], L_slowj
s_branch L_rtj0
L_stv2:
s_call_b64 s[36:37], L_slow1
s_branch L_rtv2
L_stv3:
s_call_b64 s[36:37], L_slow0
s_branch L_rtv3
L_std1:
s_call_b64 s[36:37], L_slow1
s_branch L_rtd1
L_std3n:
s_call_b64 s[36:37], L_slow0
s_branch L_rtd3n
L_std3h:
s_call_b64 s[36:37], L_slow0
s_branch L_rtd3h
L_std4n:
s_call_b64 s[36:37], L_slowb
s_branch L_rtd4n
L_std4h:
s_call_b64 s[36:37], L_slowb
s_branch L_rtd4h
L_stfh:
s_call_b64 s[36:37], L_slow1n
s_branch L_rtfh
L_stc:
s_call_b64 s[36:37], L_comb
s_branch L_rtc
L_slow0:
s_nop 7
s_nop 3
v_max3_f32 v10, v64, v65, v66
v_max3_f32 v10, v67, v72, v10
v_max3_f32 v10, v73, v74, v10
v_max3_f32 v10, v75, v80, v10
v_max3_f32 v10, v81, v82, v10
v_max3_f32 v10, v83, v88, v10
v_max3_f32 v10, v89, v90, v10
v_max_f32 v10, v91, v10
v_max3_f32 v11, v68, v69, v70
v_max3_f32 v11, v71, v76, v11
v_max3_f32 v11, v77, v78, v11
v_max3_f32 v11, v79, v84, v11
v_max3_f32 v11, v85, v86, v11
v_max3_f32 v11, v87, v92, v11
v_max3_f32 v11, v93, v94, v11
v_max_f32 v11, v95, v11
v_mov_b32 v12, v10
v_mov_b32 v13, v11
s_nop 0
v_permlane16_swap_b32 v12, v10
v_permlane16_swap_b32 v13, v11
v_max_f32 v10, v12, v10
v_max_f32 v11, v13, v11
v_mov_b32 v12, v10
v_mov_b32 v13, v11
s_nop 0
v_permlane32_swap_b32 v12, v10
v_permlane32_swap_b32 v13, v11
v_max_f32 v10, v12, v10
v_max_f32 v11, v13, v11
v_ceil_f32 v10, v10
v_ceil_f32 v11, v11
v_max_f32 v10, 0, v10
v_max_f32 v11, 0, v11
v_sub_f32 v64, v64, v10
v_sub_f32 v65, v65, v10
v_sub_f32 v66, v66, v10
v_sub_f32 v67, v67, v10
v_sub_f32 v68, v68, v11
v_sub_f32 v69, v69, v11
v_sub_f32 v70, v70, v11
v_sub_f32 v71, v71, v11
v_sub_f32 v72, v72, v10
v_sub_f32 v73, v73, v10
v_sub_f32 v74, v74, v10
v_sub_f32 v75, v75, v10
v_sub_f32 v76, v76, v11
v_sub_f32 v77, v77, v11
v_sub_f32 v78, v78, v11
v_sub_f32 v79, v79, v11
v_sub_f32 v80, v80, v10
v_sub_f32 v81, v81, v10
v_sub_f32 v82, v82, v10
v_sub_f32 v83, v83, v10
v_sub_f32 v84, v84, v11
v_sub_f32 v85, v85, v11
v_sub_f32 v86, v86, v11
v_sub_f32 v87, v87, v11
v_sub_f32 v88, v88, v10
v_sub_f32 v89, v89, v10
v_sub_f32 v90, v90, v10
v_sub_f32 v91, v91, v10
v_sub_f32 v92, v92, v11
v_sub_f32 v93, v93, v11
v_sub_f32 v94, v94, v11
v_sub_f32 v95, v95, v11
v_sub_f32 v96, v96, v10
v_sub_f32 v97, v97, v10
v_sub_f32 v98, v98, v10
v_sub_f32 v99, v99, v10
v_sub_f32 v100, v100, v11
v_sub_f32 v101, v101, v11
v_sub_f32 v102, v102, v11
v_sub_f32 v103, v103, v11
v_sub_f32 v104, v104, v10
v_sub_f32 v105, v105, v10
v_sub_f32 v106, v106, v10
v_sub_f32 v107, v107, v10
v_sub_f32 v108, v108, v11
v_sub_f32 v109, v109, v11
v_sub_f32 v110, v110, v11
v_sub_f32 v111, v111, v11
v_sub_f32 v112, v112, v10
v_sub_f32 v113, v113, v10
v_sub_f32 v114, v114, v10
v_sub_f32 v115, v115, v10
v_sub_f32 v116, v116, v11
v_sub_f32 v117, v117, v11
v_sub_f32 v118, v118, v11
v_sub_f32 v119, v119, v11
v_sub_f32 v120, v120, v10
v_sub_f32 v121, v121, v10
v_sub_f32 v122, v122, v10
v_sub_f32 v123, v123, v10
v_sub_f32 v124, v124, v11
v_sub_f32 v125, v125, v11
v_sub_f32 v126, v126, v11
v_sub_f32 v127, v127, v11
v_sub_f32 v32, v32, v10
v_sub_f32 v33, v33, v10
v_sub_f32 v34, v34, v10
v_sub_f32 v35, v35, v10
v_sub_f32 v36, v36, v11
v_sub_f32 v37, v37, v11
v_sub_f32 v38, v38, v11
v_sub_f32 v39, v39, v11
E v12,-v10
E v13,-v11
MF v30,v12,v30
MF v31,v13,v31
MF v128,v12,v128
MF v129,v12,v129
MF v130,v12,v130
MF v131,v12,v131
MF v132,v13,v132
MF v133,v13,v133
MF v134,v13,v134
MF v135,v13,v135
MF v136,v12,v136
MF v137,v12,v137
MF v138,v12,v138
MF v139,v12,v139
MF v140,v13,v140
MF v141,v13,v141
MF v142,v13,v142
MF v143,v13,v143
MF v144,v12,v144
MF v145,v12,v145
MF v146,v12,v146
MF v147,v12,v147
MF v148,v13,v148
MF v149,v13,v149
MF v150,v13,v150
MF v151,v13,v151
MF v152,v12,v152
MF v153,v12,v153
MF v154,v12,v154
MF v155,v12,v155
MF v156,v13,v156
MF v157,v13,v157
MF v158,v13,v158
MF v159,v13,v159
MF v160,v12,v160
MF v161,v12,v161
MF v162,v12,v162
MF v163,v12,v163
MF v164,v13,v164
MF v165,v13,v165
MF v166,v13,v166
MF v167,v13,v167
MF v168,v12,v168
MF v169,v12,v169
MF v170,v12,v170
MF v171,v12,v171
MF v172,v13,v172
MF v173,v13,v173
MF v174,v13,v174
MF v175,v13,v175
MF v176,v12,v176
MF v177,v12,v177
MF v178,v12,v178
MF v179,v12,v179
MF v180,v13,v180
MF v181,v13,v181
MF v182,v13,v182
MF v183,v13,v183
MF v184,v12,v184
MF v185,v12,v185
MF v186,v12,v186
MF v187,v12,v187
MF v188,v13,v188
MF v189,v13,v189
MF v190,v13,v190
MF v191,v13,v191
MF v192,v12,v192
MF v193,v12,v193
MF v194,v12,v194
MF v195,v12,v195
MF v196,v13,v196
MF v197,v13,v197
MF v198,v13,v198
MF v199,v13,v199
MF v200,v12,v200
MF v201,v12,v201
MF v202,v12,v202
MF v203,v12,v203
MF v204,v13,v204
MF v205,v13,v205
MF v206,v13,v206
MF v207,v13,v207
MF v208,v12,v208
MF v209,v12,v209
MF v210,v12,v210
MF v211,v12,v211
MF v212,v13,v212
MF v213,v13,v213
MF v214,v13,v214
MF v215,v13,v215
MF v216,v12,v216
MF v217,v12,v217
MF v218,v12,v218
MF v219,v12,v219
MF v220,v13,v220
MF v221,v13,v221
MF v222,v13,v222
MF v223,v13,v223
MF v224,v12,v224
MF v225,v12,v225
MF v226,v12,v226
MF v227,v12,v227
MF v228,v13,v228
MF v229,v13,v229
MF v230,v13,v230
MF v231,v13,v231
MF v232,v12,v232
MF v233,v12,v233
MF v234,v12,v234
MF v235,v12,v235
MF v236,v13,v236
MF v237,v13,v237
MF v238,v13,v238
MF v239,v13,v239
MF v240,v12,v240
MF v241,v12,v241
MF v242,v12,v242
MF v243,v12,v243
MF v244,v13,v244
MF v245,v13,v245
MF v246,v13,v246
MF v247,v13,v247
MF v248,v12,v248
MF v249,v12,v249
MF v250,v12,v250
MF v251,v12,v251
MF v252,v13,v252
MF v253,v13,v253
MF v254,v13,v254
MF v255,v13,v255
E v18,v64
E v19,v65
E v20,v66
AF v26,v18,v19
C v40,v18,v19
E v21,v67
E v22,v72
AF v26,v20,v26
C v41,v20,v21
E v23,v73
AF v26,v21,v26
E v24,v74
AF v26,v22,v26
C v42,v22,v23
E v25,v75
AF v26,v23,v26
E v18,v68
AF v26,v24,v26
C v43,v24,v25
E v19,v69
AF v26,v25,v26
E v20,v70
AF v27,v18,v19
C v44,v18,v19
E v21,v71
E v22,v76
AF v27,v20,v27
C v45,v20,v21
E v23,v77
AF v27,v21,v27
E v24,v78
AF v27,v22,v27
C v46,v22,v23
E v25,v79
AF v27,v23,v27
AF v27,v24,v27
C v47,v24,v25
AF v27,v25,v27
E v18,v80
E v19,v81
E v20,v82
AF v26,v18,v26
C v56,v18,v19
E v21,v83
AF v26,v19,v26
E v22,v88
AF v26,v20,v26
C v57,v20,v21
E v23,v89
AF v26,v21,v26
E v24,v90
AF v26,v22,v26
C v58,v22,v23
E v25,v91
AF v26,v23,v26
E v18,v84
AF v26,v24,v26
C v59,v24,v25
E v19,v85
AF v26,v25,v26
E v20,v86
AF v27,v18,v27
C v60,v18,v19
E v21,v87
AF v27,v19,v27
E v22,v92
AF v27,v20,v27
C v61,v20,v21
E v23,v93
AF v27,v21,v27
E v24,v94
AF v27,v22,v27
C v62,v22,v23
E v25,v95
AF v27,v23,v27
AF v27,v24,v27
C v63,v24,v25
AF v27,v25,v27
s_nop 3
s_setpc_b64 s[36:37]
L_slow1:
s_nop 7
s_nop 3
v_max3_f32 v10, v96, v97, v98
v_max3_f32 v10, v99, v104, v10
v_max3_f32 v10, v105, v106, v10
v_max3_f32 v10, v107, v112, v10
v_max3_f32 v10, v113, v114, v10
v_max3_f32 v10, v115, v120, v10
v_max3_f32 v10, v121, v122, v10
v_max_f32 v10, v123, v10
v_max3_f32 v11, v100, v101, v102
v_max3_f32 v11, v103, v108, v11
v_max3_f32 v11, v109, v110, v11
v_max3_f32 v11, v111, v116, v11
v_max3_f32 v11, v117, v118, v11
v_max3_f32 v11, v119, v124, v11
v_max3_f32 v11, v125, v126, v11
v_max_f32 v11, v127, v11
v_mov_b32 v12, v10
v_mov_b32 v13, v11
s_nop 0
v_permlane16_swap_b32 v12, v10
v_permlane16_swap_b32 v13, v11
v_max_f32 v10, v12, v10
v_max_f32 v11, v13, v11
v_mov_b32 v12, v10
v_mov_b32 v13, v11
s_nop 0
v_permlane32_swap_b32 v12, v10
v_permlane32_swap_b32 v13, v11
v_max_f32 v10, v12, v10
v_max_f32 v11, v13, v11
v_ceil_f32 v10, v10
v_ceil_f32 v11, v11
v_max_f32 v10, 0, v10
v_max_f32 v11, 0, v11
v_sub_f32 v96, v96, v10
v_sub_f32 v97, v97, v10
v_sub_f32 v98, v98, v10
v_sub_f32 v99, v99, v10
v_sub_f32 v100, v100, v11
v_sub_f32 v101, v101, v11
v_sub_f32 v102, v102, v11
v_sub_f32 v103, v103, v11
v_sub_f32 v104, v104, v10
v_sub_f32 v105, v105, v10
v_sub_f32 v106, v106, v10
v_sub_f32 v107, v107, v10
v_sub_f32 v108, v108, v11
v_sub_f32 v109, v109, v11
v_sub_f32 v110, v110, v11
v_sub_f32 v111, v111, v11
v_sub_f32 v112, v112, v10
v_sub_f32 v113, v113, v10
v_sub_f32 v114, v114, v10
v_sub_f32 v115, v115, v10
v_sub_f32 v116, v116, v11
v_sub_f32 v117, v117, v11
v_sub_f32 v118, v118, v11
v_sub_f32 v119, v119, v11
v_sub_f32 v120, v120, v10
v_sub_f32 v121, v121, v10
v_sub_f32 v122, v122, v10
v_sub_f32 v123, v123, v10
v_sub_f32 v124, v124, v11
v_sub_f32 v125, v125, v11
v_sub_f32 v126, v126, v11
v_sub_f32 v127, v127, v11
v_sub_f32 v64, v64, v10
v_sub_f32 v65, v65, v10
v_sub_f32 v66, v66, v10
v_sub_f32 v67, v67, v10
v_sub_f32 v68, v68, v11
v_sub_f32 v69, v69, v11
v_sub_f32 v70, v70, v11
v_sub_f32 v71, v71, v11
v_sub_f32 v72, v72, v10
v_sub_f32 v73, v73, v10
v_sub_f32 v74, v74, v10
v_sub_f32 v75, v75, v10
v_sub_f32 v76, v76, v11
v_sub_f32 v77, v77, v11
v_sub_f32 v78, v78, v11
v_sub_f32 v79, v79, v11
v_sub_f32 v80, v80, v10
v_sub_f32 v81, v81, v10
v_sub_f32 v82, v82, v10
v_sub_f32 v83, v83, v10
v_sub_f32 v84, v84, v11
v_sub_f32 v85, v85, v11
v_sub_f32 v86, v86, v11
v_sub_f32 v87, v87, v11
v_sub_f32 v88, v88, v10
v_sub_f32 v89, v89, v10
v_sub_f32 v90, v90, v10
v_sub_f32 v91, v91, v10
v_sub_f32 v92, v92, v11
v_sub_f32 v93, v93, v11
v_sub_f32 v94, v94, v11
v_sub_f32 v95, v95, v11
v_sub_f32 v32, v32, v10
v_sub_f32 v33, v33, v10
v_sub_f32 v34, v34, v10
v_sub_f32 v35, v35, v10
v_sub_f32 v36, v36, v11
v_sub_f32 v37, v37, v11
v_sub_f32 v38, v38, v11
v_sub_f32 v39, v39, v11
E v12,-v10
E v13,-v11
MF v30,v12,v30
MF v31,v13,v31
MF v128,v12,v128
MF v129,v12,v129
MF v130,v12,v130
MF v131,v12,v131
MF v132,v13,v132
MF v133,v13,v133
MF v134,v13,v134
MF v135,v13,v135
MF v136,v12,v136
MF v137,v12,v137
MF v138,v12,v138
MF v139,v12,v139
MF v140,v13,v140
MF v141,v13,v141
MF v142,v13,v142
MF v143,v13,v143
MF v144,v12,v144
MF v145,v12,v145
MF v146,v12,v146
MF v147,v12,v147
MF v148,v13,v148
MF v149,v13,v149
MF v150,v13,v150
MF v151,v13,v151
MF v152,v12,v152
MF v153,v12,v153
MF v154,v12,v154
MF v155,v12,v155
MF v156,v13,v156
MF v157,v13,v157
MF v158,v13,v158
MF v159,v13,v159
MF v160,v12,v160
MF v161,v12,v161
MF v162,v12,v162
MF v163,v12,v163
MF v164,v13,v164
MF v165,v13,v165
MF v166,v13,v166
MF v167,v13,v167
MF v168,v12,v168
MF v169,v12,v169
MF v170,v12,v170
MF v171,v12,v171
MF v172,v13,v172
MF v173,v13,v173
MF v174,v13,v174
MF v175,v13,v175
MF v176,v12,v176
MF v177,v12,v177
MF v178,v12,v178
MF v179,v12,v179
MF v180,v13,v180
MF v181,v13,v181
MF v182,v13,v182
MF v183,v13,v183
MF v184,v12,v184
MF v185,v12,v185
MF v186,v12,v186
MF v187,v12,v187
MF v188,v13,v188
MF v189,v13,v189
MF v190,v13,v190
MF v191,v13,v191
MF v192,v12,v192
MF v193,v12,v193
MF v194,v12,v194
MF v195,v12,v195
MF v196,v13,v196
MF v197,v13,v197
MF v198,v13,v198
MF v199,v13,v199
MF v200,v12,v200
MF v201,v12,v201
MF v202,v12,v202
MF v203,v12,v203
MF v204,v13,v204
MF v205,v13,v205
MF v206,v13,v206
MF v207,v13,v207
MF v208,v12,v208
MF v209,v12,v209
MF v210,v12,v210
MF v211,v12,v211
MF v212,v13,v212
MF v213,v13,v213
MF v214,v13,v214
MF v215,v13,v215
MF v216,v12,v216
MF v217,v12,v217
MF v218,v12,v218
MF v219,v12,v219
MF v220,v13,v220
MF v221,v13,v221
MF v222,v13,v222
MF v223,v13,v223
MF v224,v12,v224
MF v225,v12,v225
MF v226,v12,v226
MF v227,v12,v227
MF v228,v13,v228
MF v229,v13,v229
MF v230,v13,v230
MF v231,v13,v231
MF v232,v12,v232
MF v233,v12,v233
MF v234,v12,v234
MF v235,v12,v235
MF v236,v13,v236
MF v237,v13,v237
MF v238,v13,v238
MF v239,v13,v239
MF v240,v12,v240
MF v241,v12,v241
MF v242,v12,v242
MF v243,v12,v243
MF v244,v13,v244
MF v245,v13,v245
MF v246,v13,v246
MF v247,v13,v247
MF v248,v12,v248
MF v249,v12,v249
MF v250,v12,v250
MF v251,v12,v251
MF v252,v13,v252
MF v253,v13,v253
MF v254,v13,v254
MF v255,v13,v255
E v18,v96
E v19,v97
E v20,v98
AF v28,v18,v19
C v48,v18,v19
E v21,v99
E v22,v104
AF v28,v20,v28
C v49,v20,v21
E v23,v105
AF v28,v21,v28
E v24,v106
AF v28,v22,v28
C v50,v22,v23
E v25,v107
AF v28,v23,v28
E v18,v100
AF v28,v24,v28
C v51,v24,v25
E v19,v101
AF v28,v25,v28
E v20,v102
AF v29,v18,v19
C v52,v18,v19
E v21,v103
E v22,v108
AF v29,v20,v29
C v53,v20,v21
E v23,v109
AF v29,v21,v29
E v24,v110
AF v29,v22,v29
C v54,v22,v23
E v25,v111
AF v29,v23,v29
AF v29,v24,v29
C v55,v24,v25
AF v29,v25,v29
E v18,v112
E v19,v113
E v20,v114
AF v28,v18,v28
C v56,v18,v19
E v21,v115
AF v28,v19,v28
E v22,v120
AF v28,v20,v28
C v57,v20,v21
E v23,v121
AF v28,v21,v28
E v24,v122
AF v28,v22,v28
C v58,v22,v23
E v25,v123
AF v28,v23,v28
E v18,v116
AF v28,v24,v28
C v59,v24,v25
E v19,v117
AF v28,v25,v28
E v20,v118
AF v29,v18,v29
C v60,v18,v19
E v21,v119
AF v29,v19,v29
E v22,v124
AF v29,v20,v29
C v61,v20,v21
E v23,v125
AF v29,v21,v29
E v24,v126
AF v29,v22,v29
C v62,v22,v23
E v25,v127
AF v29,v23,v29
AF v29,v24,v29
C v63,v24,v25
AF v29,v25,v29
s_nop 3
s_setpc_b64 s[36:37]
L_slow1n:
s_nop 7
s_nop 3
v_max3_f32 v10, v96, v97, v98
v_max3_f32 v10, v99, v104, v10
v_max3_f32 v10, v105, v106, v10
v_max3_f32 v10, v107, v112, v10
v_max3_f32 v10, v113, v114, v10
v_max3_f32 v10, v115, v120, v10
v_max3_f32 v10, v121, v122, v10
v_max_f32 v10, v123, v10
v_max3_f32 v11, v100, v101, v102
v_max3_f32 v11, v103, v108, v11
v_max3_f32 v11, v109, v110, v11
v_max3_f32 v11, v111, v116, v11
v_max3_f32 v11, v117, v118, v11
v_max3_f32 v11, v119, v124, v11
v_max3_f32 v11, v125, v126, v11
v_max_f32 v11, v127, v11
v_mov_b32 v12, v10
v_mov_b32 v13, v11
s_nop 0
v_permlane16_swap_b32 v12, v10
v_permlane16_swap_b32 v13, v11
v_max_f32 v10, v12, v10
v_max_f32 v11, v13, v11
v_mov_b32 v12, v10
v_mov_b32 v13, v11
s_nop 0
v_permlane32_swap_b32 v12, v10
v_permlane32_swap_b32 v13, v11
v_max_f32 v10, v12, v10
v_max_f32 v11, v13, v11
v_ceil_f32 v10, v10
v_ceil_f32 v11, v11
v_max_f32 v10, 0, v10
v_max_f32 v11, 0, v11
v_sub_f32 v96, v96, v10
v_sub_f32 v97, v97, v10
v_sub_f32 v98, v98, v10
v_sub_f32 v99, v99, v10
v_sub_f32 v100, v100, v11
v_sub_f32 v101, v101, v11
v_sub_f32 v102, v102, v11
v_sub_f32 v103, v103, v11
v_sub_f32 v104, v104, v10
v_sub_f32 v105, v105, v10
v_sub_f32 v106, v106, v10
v_sub_f32 v107, v107, v10
v_sub_f32 v108, v108, v11
v_sub_f32 v109, v109, v11
v_sub_f32 v110, v110, v11
v_sub_f32 v111, v111, v11
v_sub_f32 v112, v112, v10
v_sub_f32 v113, v113, v10
v_sub_f32 v114, v114, v10
v_sub_f32 v115, v115, v10
v_sub_f32 v116, v116, v11
v_sub_f32 v117, v117, v11
v_sub_f32 v118, v118, v11
v_sub_f32 v119, v119, v11
v_sub_f32 v120, v120, v10
v_sub_f32 v121, v121, v10
v_sub_f32 v122, v122, v10
v_sub_f32 v123, v123, v10
v_sub_f32 v124, v124, v11
v_sub_f32 v125, v125, v11
v_sub_f32 v126, v126, v11
v_sub_f32 v127, v127, v11
v_sub_f32 v32, v32, v10
v_sub_f32 v33, v33, v10
v_sub_f32 v34, v34, v10
v_sub_f32 v35, v35, v10
v_sub_f32 v36, v36, v11
v_sub_f32 v37, v37, v11
v_sub_f32 v38, v38, v11
v_sub_f32 v39, v39, v11
E v12,-v10
E v13,-v11
MF v30,v12,v30
MF v31,v13,v31
MF v128,v12,v128
MF v129,v12,v129
MF v130,v12,v130
MF v131,v12,v131
MF v132,v13,v132
MF v133,v13,v133
MF v134,v13,v134
MF v135,v13,v135
MF v136,v12,v136
MF v137,v12,v137
MF v138,v12,v138
MF v139,v12,v139
MF v140,v13,v140
MF v141,v13,v141
MF v142,v13,v142
MF v143,v13,v143
MF v144,v12,v144
MF v145,v12,v145
MF v146,v12,v146
MF v147,v12,v147
MF v148,v13,v148
MF v149,v13,v149
MF v150,v13,v150
MF v151,v13,v151
MF v152,v12,v152
MF v153,v12,v153
MF v154,v12,v154
MF v155,v12,v155
MF v156,v13,v156
MF v157,v13,v157
MF v158,v13,v158
MF v159,v13,v159
MF v160,v12,v160
MF v161,v12,v161
MF v162,v12,v162
MF v163,v12,v163
MF v164,v13,v164
MF v165,v13,v165
MF v166,v13,v166
MF v167,v13,v167
MF v168,v12,v168
MF v169,v12,v169
MF v170,v12,v170
MF v171,v12,v171
MF v172,v13,v172
MF v173,v13,v173
MF v174,v13,v174
MF v175,v13,v175
MF v176,v12,v176
MF v177,v12,v177
MF v178,v12,v178
MF v179,v12,v179
MF v180,v13,v180
MF v181,v13,v181
MF v182,v13,v182
MF v183,v13,v183
MF v184,v12,v184
MF v185,v12,v185
MF v186,v12,v186
MF v187,v12,v187
MF v188,v13,v188
MF v189,v13,v189
MF v190,v13,v190
MF v191,v13,v191
MF v192,v12,v192
MF v193,v12,v193
MF v194,v12,v194
MF v195,v12,v195
MF v196,v13,v196
MF v197,v13,v197
MF v198,v13,v198
MF v199,v13,v199
MF v200,v12,v200
MF v201,v12,v201
MF v202,v12,v202
MF v203,v12,v203
MF v204,v13,v204
MF v205,v13,v205
MF v206,v13,v206
MF v207,v13,v207
MF v208,v12,v208
MF v209,v12,v209
MF v210,v12,v210
MF v211,v12,v211
MF v212,v13,v212
MF v213,v13,v213
MF v214,v13,v214
MF v215,v13,v215
MF v216,v12,v216
MF v217,v12,v217
MF v218,v12,v218
MF v219,v12,v219
MF v220,v13,v220
MF v221,v13,v221
MF v222,v13,v222
MF v223,v13,v223
MF v224,v12,v224
MF v225,v12,v225
MF v226,v12,v226
MF v227,v12,v227
MF v228,v13,v228
MF v229,v13,v229
MF v230,v13,v230
MF v231,v13,v231
MF v232,v12,v232
MF v233,v12,v233
MF v234,v12,v234
MF v235,v12,v235
MF v236,v13,v236
MF v237,v13,v237
MF v238,v13,v238
MF v239,v13,v239
MF v240,v12,v240
MF v241,v12,v241
MF v242,v12,v242
MF v243,v12,v243
MF v244,v13,v244
MF v245,v13,v245
MF v246,v13,v246
MF v247,v13,v247
MF v248,v12,v248
MF v249,v12,v249
MF v250,v12,v250
MF v251,v12,v251
MF v252,v13,v252
MF v253,v13,v253
MF v254,v13,v254
MF v255,v13,v255
E v18,v96
E v19,v97
E v20,v98
AF v28,v18,v19
C v48,v18,v19
E v21,v99
E v22,v104
AF v28,v20,v28
C v49,v20,v21
E v23,v105
AF v28,v21,v28
E v24,v106
AF v28,v22,v28
C v50,v22,v23
E v25,v107
AF v28,v23,v28
E v18,v100
AF v28,v24,v28
C v51,v24,v25
E v19,v101
AF v28,v25,v28
E v20,v102
AF v29,v18,v19
C v52,v18,v19
E v21,v103
E v22,v108
AF v29,v20,v29
C v53,v20,v21
E v23,v109
AF v29,v21,v29
E v24,v110
AF v29,v22,v29
C v54,v22,v23
E v25,v111
AF v29,v23,v29
AF v29,v24,v29
C v55,v24,v25
AF v29,v25,v29
E v18,v112
E v19,v113
E v20,v114
AF v28,v18,v28
C v56,v18,v19
E v21,v115
AF v28,v19,v28
E v22,v120
AF v28,v20,v28
C v57,v20,v21
E v23,v121
AF v28,v21,v28
E v24,v122
AF v28,v22,v28
C v58,v22,v23
E v25,v123
AF v28,v23,v28
E v18,v116
AF v28,v24,v28
C v59,v24,v25
E v19,v117
AF v28,v25,v28
E v20,v118
AF v29,v18,v29
C v60,v18,v19
E v21,v119
AF v29,v19,v29
E v22,v124
AF v29,v20,v29
C v61,v20,v21
E v23,v125
AF v29,v21,v29
E v24,v126
AF v29,v22,v29
C v62,v22,v23
E v25,v127
AF v29,v23,v29
AF v29,v24,v29
C v63,v24,v25
AF v29,v25,v29
s_nop 3
s_setpc_b64 s[36:37]
L_slowf:
s_nop 7
s_nop 3
v_max3_f32 v10, v64, v65, v66
v_max3_f32 v10, v67, v72, v10
v_max3_f32 v10, v73, v74, v10
v_max3_f32 v10, v75, v80, v10
v_max3_f32 v10, v81, v82, v10
v_max3_f32 v10, v83, v88, v10
v_max3_f32 v10, v89, v90, v10
v_max_f32 v10, v91, v10
v_max3_f32 v11, v68, v69, v70
v_max3_f32 v11, v71, v76, v11
v_max3_f32 v11, v77, v78, v11
v_max3_f32 v11, v79, v84, v11
v_max3_f32 v11, v85, v86, v11
v_max3_f32 v11, v87, v92, v11
v_max3_f32 v11, v93, v94, v11
v_max_f32 v11, v95, v11
v_mov_b32 v12, v10
v_mov_b32 v13, v11
s_nop 0
v_permlane16_swap_b32 v12, v10
v_permlane16_swap_b32 v13, v11
v_max_f32 v10, v12, v10
v_max_f32 v11, v13, v11
v_mov_b32 v12, v10
v_mov_b32 v13, v11
s_nop 0
v_permlane32_swap_b32 v12, v10
v_permlane32_swap_b32 v13, v11
v_max_f32 v10, v12, v10
v_max_f32 v11, v13, v11
v_ceil_f32 v10, v10
v_ceil_f32 v11, v11
v_sub_f32 v64, v64, v10
v_sub_f32 v65, v65, v10
v_sub_f32 v66, v66, v10
v_sub_f32 v67, v67, v10
v_sub_f32 v68, v68, v11
v_sub_f32 v69, v69, v11
v_sub_f32 v70, v70, v11
v_sub_f32 v71, v71, v11
v_sub_f32 v72, v72, v10
v_sub_f32 v73, v73, v10
v_sub_f32 v74, v74, v10
v_sub_f32 v75, v75, v10
v_sub_f32 v76, v76, v11
v_sub_f32 v77, v77, v11
v_sub_f32 v78, v78, v11
v_sub_f32 v79, v79, v11
v_sub_f32 v80, v80, v10
v_sub_f32 v81, v81, v10
v_sub_f32 v82, v82, v10
v_sub_f32 v83, v83, v10
v_sub_f32 v84, v84, v11
v_sub_f32 v85, v85, v11
v_sub_f32 v86, v86, v11
v_sub_f32 v87, v87, v11
v_sub_f32 v88, v88, v10
v_sub_f32 v89, v89, v10
v_sub_f32 v90, v90, v10
v_sub_f32 v91, v91, v10
v_sub_f32 v92, v92, v11
v_sub_f32 v93, v93, v11
v_sub_f32 v94, v94, v11
v_sub_f32 v95, v95, v11
v_sub_f32 v96, v96, v10
v_sub_f32 v97, v97, v10
v_sub_f32 v98, v98, v10
v_sub_f32 v99, v99, v10
v_sub_f32 v100, v100, v11
v_sub_f32 v101, v101, v11
v_sub_f32 v102, v102, v11
v_sub_f32 v103, v103, v11
v_sub_f32 v104, v104, v10
v_sub_f32 v105, v105, v10
v_sub_f32 v106, v106, v10
v_sub_f32 v107, v107, v10
v_sub_f32 v108, v108, v11
v_sub_f32 v109, v109, v11
v_sub_f32 v110, v110, v11
v_sub_f32 v111, v111, v11
v_sub_f32 v112, v112, v10
v_sub_f32 v113, v113, v10
v_sub_f32 v114, v114, v10
v_sub_f32 v115, v115, v10
v_sub_f32 v116, v116, v11
v_sub_f32 v117, v117, v11
v_sub_f32 v118, v118, v11
v_sub_f32 v119, v119, v11
v_sub_f32 v120, v120, v10
v_sub_f32 v121, v121, v10
v_sub_f32 v122, v122, v10
v_sub_f32 v123, v123, v10
v_sub_f32 v124, v124, v11
v_sub_f32 v125, v125, v11
v_sub_f32 v126, v126, v11
v_sub_f32 v127, v127, v11
v_sub_f32 v32, v32, v10
v_sub_f32 v33, v33, v10
v_sub_f32 v34, v34, v10
v_sub_f32 v35, v35, v10
v_sub_f32 v36, v36, v11
v_sub_f32 v37, v37, v11
v_sub_f32 v38, v38, v11
v_sub_f32 v39, v39, v11
E v18,v64
E v19,v65
E v20,v66
AF v26,v18,v19
C v40,v18,v19
E v21,v67
E v22,v72
AF v26,v20,v26
C v41,v20,v21
E v23,v73
AF v26,v21,v26
E v24,v74
AF v26,v22,v26
C v42,v22,v23
E v25,v75
AF v26,v23,v26
E v18,v68
AF v26,v24,v26
C v43,v24,v25
E v19,v69
AF v26,v25,v26
E v20,v70
AF v27,v18,v19
C v44,v18,v19
E v21,v71
E v22,v76
AF v27,v20,v27
C v45,v20,v21
E v23,v77
AF v27,v21,v27
E v24,v78
AF v27,v22,v27
C v46,v22,v23
E v25,v79
AF v27,v23,v27
AF v27,v24,v27
C v47,v24,v25
AF v27,v25,v27
E v18,v80
E v19,v81
E v20,v82
AF v26,v18,v26
C v56,v18,v19
E v21,v83
AF v26,v19,v26
E v22,v88
AF v26,v20,v26
C v57,v20,v21
E v23,v89
AF v26,v21,v26
E v24,v90
AF v26,v22,v26
C v58,v22,v23
E v25,v91
AF v26,v23,v26
E v18,v84
AF v26,v24,v26
C v59,v24,v25
E v19,v85
AF v26,v25,v26
E v20,v86
AF v27,v18,v27
C v60,v18,v19
E v21,v87
AF v27,v19,v27
E v22,v92
AF v27,v20,v27
C v61,v20,v21
E v23,v93
AF v27,v21,v27
E v24,v94
AF v27,v22,v27
C v62,v22,v23
E v25,v95
AF v27,v23,v27
AF v27,v24,v27
C v63,v24,v25
AF v27,v25,v27
s_nop 3
s_setpc_b64 s[36:37]
L_slowj:
s_nop 7
s_nop 3
v_max3_f32 v10, v64, v65, v66
v_max3_f32 v10, v67, v72, v10
v_max3_f32 v10, v73, v74, v10
v_max3_f32 v10, v75, v80, v10
v_max3_f32 v10, v81, v82, v10
v_max3_f32 v10, v83, v88, v10
v_max3_f32 v10, v89, v90, v10
v_max_f32 v10, v91, v10
v_max3_f32 v11, v68, v69, v70
v_max3_f32 v11, v71, v76, v11
v_max3_f32 v11, v77, v78, v11
v_max3_f32 v11, v79, v84, v11
v_max3_f32 v11, v85, v86, v11
v_max3_f32 v11, v87, v92, v11
v_max3_f32 v11, v93, v94, v11
v_max_f32 v11, v95, v11
v_mov_b32 v12, v10
v_mov_b32 v13, v11
s_nop 0
v_permlane16_swap_b32 v12, v10
v_permlane16_swap_b32 v13, v11
v_max_f32 v10, v12, v10
v_max_f32 v11, v13, v11
v_mov_b32 v12, v10
v_mov_b32 v13, v11
s_nop 0
v_permlane32_swap_b32 v12, v10
v_permlane32_swap_b32 v13, v11
v_max_f32 v10, v12, v10
v_max_f32 v11, v13, v11
v_ceil_f32 v10, v10
v_ceil_f32 v11, v11
v_sub_f32 v64, v64, v10
v_sub_f32 v65, v65, v10
v_sub_f32 v66, v66, v10
v_sub_f32 v67, v67, v10
v_sub_f32 v68, v68, v11
v_sub_f32 v69, v69, v11
v_sub_f32 v70, v70, v11
v_sub_f32 v71, v71, v11
v_sub_f32 v72, v72, v10
v_sub_f32 v73, v73, v10
v_sub_f32 v74, v74, v10
v_sub_f32 v75, v75, v10
v_sub_f32 v76, v76, v11
v_sub_f32 v77, v77, v11
v_sub_f32 v78, v78, v11
v_sub_f32 v79, v79, v11
v_sub_f32 v80, v80, v10
v_sub_f32 v81, v81, v10
v_sub_f32 v82, v82, v10
v_sub_f32 v83, v83, v10
v_sub_f32 v84, v84, v11
v_sub_f32 v85, v85, v11
v_sub_f32 v86, v86, v11
v_sub_f32 v87, v87, v11
v_sub_f32 v88, v88, v10
v_sub_f32 v89, v89, v10
v_sub_f32 v90, v90, v10
v_sub_f32 v91, v91, v10
v_sub_f32 v92, v92, v11
v_sub_f32 v93, v93, v11
v_sub_f32 v94, v94, v11
v_sub_f32 v95, v95, v11
v_sub_f32 v32, v32, v10
v_sub_f32 v33, v33, v10
v_sub_f32 v34, v34, v10
v_sub_f32 v35, v35, v10
v_sub_f32 v36, v36, v11
v_sub_f32 v37, v37, v11
v_sub_f32 v38, v38, v11
v_sub_f32 v39, v39, v11
E v18,v64
E v19,v65
E v20,v66
AF v26,v18,v19
C v40,v18,v19
E v21,v67
E v22,v72
AF v26,v20,v26
C v41,v20,v21
E v23,v73
AF v26,v21,v26
E v24,v74
AF v26,v22,v26
C v42,v22,v23
E v25,v75
AF v26,v23,v26
E v18,v68
AF v26,v24,v26
C v43,v24,v25
E v19,v69
AF v26,v25,v26
E v20,v70
AF v27,v18,v19
C v44,v18,v19
E v21,v71
E v22,v76
AF v27,v20,v27
C v45,v20,v21
E v23,v77
AF v27,v21,v27
E v24,v78
AF v27,v22,v27
C v46,v22,v23
E v25,v79
AF v27,v23,v27
AF v27,v24,v27
C v47,v24,v25
AF v27,v25,v27
s_nop 3
s_setpc_b64 s[36:37]
L_slowb:
s_nop 7
s_nop 3
v_max3_f32 v11, v100, v101, v102
v_max3_f32 v11, v103, v108, v11
v_max3_f32 v11, v109, v110, v11
v_max3_f32 v11, v111, v116, v11
v_max3_f32 v11, v117, v118, v11
v_max3_f32 v11, v119, v124, v11
v_max3_f32 v11, v125, v126, v11
v_max_f32 v11, v127, v11
v_mov_b32 v13, v11
s_nop 1
v_permlane16_swap_b32 v13, v11
v_max_f32 v11, v13, v11
v_mov_b32 v13, v11
s_nop 1
v_permlane32_swap_b32 v13, v11
v_max_f32 v11, v13, v11
v_ceil_f32 v11, v11
v_max_f32 v11, 0, v11
v_mov_b32 v10, 0
v_sub_f32 v100, v100, v11
v_sub_f32 v101, v101, v11
v_sub_f32 v102, v102, v11
v_sub_f32 v103, v103, v11
v_sub_f32 v108, v108, v11
v_sub_f32 v109, v109, v11
v_sub_f32 v110, v110, v11
v_sub_f32 v111, v111, v11
v_sub_f32 v116, v116, v11
v_sub_f32 v117, v117, v11
v_sub_f32 v118, v118, v11
v_sub_f32 v119, v119, v11
v_sub_f32 v124, v124, v11
v_sub_f32 v125, v125, v11
v_sub_f32 v126, v126, v11
v_sub_f32 v127, v127, v11
v_sub_f32 v32, v32, v10
v_sub_f32 v33, v33, v10
v_sub_f32 v34, v34, v10
v_sub_f32 v35, v35, v10
v_sub_f32 v36, v36, v11
v_sub_f32 v37, v37, v11
v_sub_f32 v38, v38, v11
v_sub_f32 v39, v39, v11
E v12,-v10
E v13,-v11
MF v30,v12,v30
MF v31,v13,v31
MF v128,v12,v128
MF v129,v12,v129
MF v130,v12,v130
MF v131,v12,v131
MF v132,v13,v132
MF v133,v13,v133
MF v134,v13,v134
MF v135,v13,v135
MF v136,v12,v136
MF v137,v12,v137
MF v138,v12,v138
MF v139,v12,v139
MF v140,v13,v140
MF v141,v13,v141
MF v142,v13,v142
MF v143,v13,v143
MF v144,v12,v144
MF v145,v12,v145
MF v146,v12,v146
MF v147,v12,v147
MF v148,v13,v148
MF v149,v13,v149
MF v150,v13,v150
MF v151,v13,v151
MF v152,v12,v152
MF v153,v12,v153
MF v154,v12,v154
MF v155,v12,v155
MF v156,v13,v156
MF v157,v13,v157
MF v158,v13,v158
MF v159,v13,v159
MF v160,v12,v160
MF v161,v12,v161
MF v162,v12,v162
MF v163,v12,v163
MF v164,v13,v164
MF v165,v13,v165
MF v166,v13,v166
MF v167,v13,v167
MF v168,v12,v168
MF v169,v12,v169
MF v170,v12,v170
MF v171,v12,v171
MF v172,v13,v172
MF v173,v13,v173
MF v174,v13,v174
MF v175,v13,v175
MF v176,v12,v176
MF v177,v12,v177
MF v178,v12,v178
MF v179,v12,v179
MF v180,v13,v180
MF v181,v13,v181
MF v182,v13,v182
MF v183,v13,v183
MF v184,v12,v184
MF v185,v12,v185
MF v186,v12,v186
MF v187,v12,v187
MF v188,v13,v188
MF v189,v13,v189
MF v190,v13,v190
MF v191,v13,v191
MF v192,v12,v192
MF v193,v12,v193
MF v194,v12,v194
MF v195,v12,v195
MF v196,v13,v196
MF v197,v13,v197
MF v198,v13,v198
MF v199,v13,v199
MF v200,v12,v200
MF v201,v12,v201
MF v202,v12,v202
MF v203,v12,v203
MF v204,v13,v204
MF v205,v13,v205
MF v206,v13,v206
MF v207,v13,v207
MF v208,v12,v208
MF v209,v12,v209
MF v210,v12,v210
MF v211,v12,v211
MF v212,v13,v212
MF v213,v13,v213
MF v214,v13,v214
MF v215,v13,v215
MF v216,v12,v216
MF v217,v12,v217
MF v218,v12,v218
MF v219,v12,v219
MF v220,v13,v220
MF v221,v13,v221
MF v222,v13,v222
MF v223,v13,v223
MF v224,v12,v224
MF v225,v12,v225
MF v226,v12,v226
MF v227,v12,v227
MF v228,v13,v228
MF v229,v13,v229
MF v230,v13,v230
MF v231,v13,v231
MF v232,v12,v232
MF v233,v12,v233
MF v234,v12,v234
MF v235,v12,v235
MF v236,v13,v236
MF v237,v13,v237
MF v238,v13,v238
MF v239,v13,v239
MF v240,v12,v240
MF v241,v12,v241
MF v242,v12,v242
MF v243,v12,v243
MF v244,v13,v244
MF v245,v13,v245
MF v246,v13,v246
MF v247,v13,v247
MF v248,v12,v248
MF v249,v12,v249
MF v250,v12,v250
MF v251,v12,v251
MF v252,v13,v252
MF v253,v13,v253
MF v254,v13,v254
MF v255,v13,v255
E v18,v100
E v19,v101
E v20,v102
AF v29,v18,v19
C v52,v18,v19
E v21,v103
E v22,v108
AF v29,v20,v29
C v53,v20,v21
E v23,v109
AF v29,v21,v29
E v24,v110
AF v29,v22,v29
C v54,v22,v23
E v25,v111
AF v29,v23,v29
E v18,v116
AF v29,v24,v29
C v55,v24,v25
E v19,v117
AF v29,v25,v29
E v20,v118
AF v29,v18,v29
C v48,v18,v19
E v21,v119
AF v29,v19,v29
E v22,v124
AF v29,v20,v29
C v49,v20,v21
E v23,v125
AF v29,v21,v29
E v24,v126
AF v29,v22,v29
C v50,v22,v23
E v25,v127
AF v29,v23,v29
AF v29,v24,v29
C v51,v24,v25
AF v29,v25,v29
s_nop 3
s_setpc_b64 s[36:37]
L_comb:
s_waitcnt vmcnt(0)
s_nop 7
v_sub_f32 v10, v32, v14
v_sub_f32 v11, v36, v15
v_max_f32 v10, 0, v10
v_max_f32 v11, 0, v11
v_sub_f32 v100, v100, v11
v_sub_f32 v101, v101, v11
v_sub_f32 v102, v102, v11
v_sub_f32 v103, v103, v11
v_sub_f32 v108, v108, v11
v_sub_f32 v109, v109, v11
v_sub_f32 v110, v110, v11
v_sub_f32 v111, v111, v11
v_sub_f32 v116, v116, v11
v_sub_f32 v117, v117, v11
v_sub_f32 v118, v118, v11
v_sub_f32 v119, v119, v11
v_sub_f32 v124, v124, v11
v_sub_f32 v125, v125, v11
v_sub_f32 v126, v126, v11
v_sub_f32 v127, v127, v11
v_sub_f32 v32, v32, v10
v_sub_f32 v33, v33, v10
v_sub_f32 v34, v34, v10
v_sub_f32 v35, v35, v10
v_sub_f32 v36, v36, v11
v_sub_f32 v37, v37, v11
v_sub_f32 v38, v38, v11
v_sub_f32 v39, v39, v11
E v12,-v10
E v13,-v11
MF v30,v12,v30
MF v31,v13,v31
MF v128,v12,v128
MF v129,v12,v129
MF v130,v12,v130
MF v131,v12,v131
MF v132,v13,v132
MF v133,v13,v133
MF v134,v13,v134
MF v135,v13,v135
MF v136,v12,v136
MF v137,v12,v137
MF v138,v12,v138
MF v139,v12,v139
MF v140,v13,v140
MF v141,v13,v141
MF v142,v13,v142
MF v143,v13,v143
MF v144,v12,v144
MF v145,v12,v145
MF v146,v12,v146
MF v147,v12,v147
MF v148,v13,v148
MF v149,v13,v149
MF v150,v13,v150
MF v151,v13,v151
MF v152,v12,v152
MF v153,v12,v153
MF v154,v12,v154
MF v155,v12,v155
MF v156,v13,v156
MF v157,v13,v157
MF v158,v13,v158
MF v159,v13,v159
MF v160,v12,v160
MF v161,v12,v161
MF v162,v12,v162
MF v163,v12,v163
MF v164,v13,v164
MF v165,v13,v165
MF v166,v13,v166
MF v167,v13,v167
MF v168,v12,v168
MF v169,v12,v169
MF v170,v12,v170
MF v171,v12,v171
MF v172,v13,v172
MF v173,v13,v173
MF v174,v13,v174
MF v175,v13,v175
MF v176,v12,v176
MF v177,v12,v177
MF v178,v12,v178
MF v179,v12,v179
MF v180,v13,v180
MF v181,v13,v181
MF v182,v13,v182
MF v183,v13,v183
MF v184,v12,v184
MF v185,v12,v185
MF v186,v12,v186
MF v187,v12,v187
MF v188,v13,v188
MF v189,v13,v189
MF v190,v13,v190
MF v191,v13,v191
MF v192,v12,v192
MF v193,v12,v193
MF v194,v12,v194
MF v195,v12,v195
MF v196,v13,v196
MF v197,v13,v197
MF v198,v13,v198
MF v199,v13,v199
MF v200,v12,v200
MF v201,v12,v201
MF v202,v12,v202
MF v203,v12,v203
MF v204,v13,v204
MF v205,v13,v205
MF v206,v13,v206
MF v207,v13,v207
MF v208,v12,v208
MF v209,v12,v209
MF v210,v12,v210
MF v211,v12,v211
MF v212,v13,v212
MF v213,v13,v213
MF v214,v13,v214
MF v215,v13,v215
MF v216,v12,v216
MF v217,v12,v217
MF v218,v12,v218
MF v219,v12,v219
MF v220,v13,v220
MF v221,v13,v221
MF v222,v13,v222
MF v223,v13,v223
MF v224,v12,v224
MF v225,v12,v225
MF v226,v12,v226
MF v227,v12,v227
MF v228,v13,v228
MF v229,v13,v229
MF v230,v13,v230
MF v231,v13,v231
MF v232,v12,v232
MF v233,v12,v233
MF v234,v12,v234
MF v235,v12,v235
MF v236,v13,v236
MF v237,v13,v237
MF v238,v13,v238
MF v239,v13,v239
MF v240,v12,v240
MF v241,v12,v241
MF v242,v12,v242
MF v243,v12,v243
MF v244,v13,v244
MF v245,v13,v245
MF v246,v13,v246
MF v247,v13,v247
MF v248,v12,v248
MF v249,v12,v249
MF v250,v12,v250
MF v251,v12,v251
MF v252,v13,v252
MF v253,v13,v253
MF v254,v13,v254
MF v255,v13,v255
E v18,v100
E v19,v101
E v20,v102
AF v29,v18,v19
C v52,v18,v19
E v21,v103
E v22,v108
AF v29,v20,v29
C v53,v20,v21
E v23,v109
AF v29,v21,v29
E v24,v110
AF v29,v22,v29
C v54,v22,v23
E v25,v111
AF v29,v23,v29
E v18,v116
AF v29,v24,v29
C v55,v24,v25
E v19,v117
AF v29,v25,v29
E v20,v118
AF v29,v18,v29
C v48,v18,v19
E v21,v119
AF v29,v19,v29
E v22,v124
AF v29,v20,v29
C v49,v20,v21
E v23,v125
AF v29,v21,v29
E v24,v126
AF v29,v22,v29
C v50,v22,v23
E v25,v127
AF v29,v23,v29
AF v29,v24,v29
C v51,v24,v25
AF v29,v25,v29
v_sub_f32 v10, v32, v14
v_sub_f32 v11, v36, v15
E v10,v10
E v11,v11
s_nop 0
MF v16,v10,v16
MF v17,v11,v17
G v64,a128
v_and_b32 v65, 0xffff0000, v64
v_lshlrev_b32 v64, 16, v64
MF v64,v10,v64
MF v65,v10,v65
C v64,v64,v65
W a128,v64
G v66,a129
v_and_b32 v67, 0xffff0000, v66
v_lshlrev_b32 v66, 16, v66
MF v66,v10,v66
MF v67,v10,v67
C v66,v66,v67
W a129,v66
G v68,a130
v_and_b32 v69, 0xffff0000, v68
v_lshlrev_b32 v68, 16, v68
MF v68,v10,v68
MF v69,v10,v69
C v68,v68,v69
W a130,v68
G v70,a131
v_and_b32 v71, 0xffff0000, v70
v_lshlrev_b32 v70, 16, v70
MF v70,v10,v70
MF v71,v10,v71
C v70,v70,v71
W a131,v70
G v72,a132
v_and_b32 v73, 0xffff0000, v72
v_lshlrev_b32 v72, 16, v72
MF v72,v10,v72
MF v73,v10,v73
C v72,v72,v73
W a132,v72
G v74,a133
v_and_b32 v75, 0xffff0000, v74
v_lshlrev_b32 v74, 16, v74
MF v74,v10,v74
MF v75,v10,v75
C v74,v74,v75
W a133,v74
G v76,a134
v_and_b32 v77, 0xffff0000, v76
v_lshlrev_b32 v76, 16, v76
MF v76,v10,v76
MF v77,v10,v77
C v76,v76,v77
W a134,v76
G v78,a135
v_and_b32 v79, 0xffff0000, v78
v_lshlrev_b32 v78, 16, v78
MF v78,v10,v78
MF v79,v10,v79
C v78,v78,v79
W a135,v78
G v64,a136
v_and_b32 v65, 0xffff0000, v64
v_lshlrev_b32 v64, 16, v64
MF v64,v10,v64
MF v65,v10,v65
C v64,v64,v65
W a136,v64
G v66,a137
v_and_b32 v67, 0xffff0000, v66
v_lshlrev_b32 v66, 16, v66
MF v66,v10,v66
MF v67,v10,v67
C v66,v66,v67
W a137,v66
G v68,a138
v_and_b32 v69, 0xffff0000, v68
v_lshlrev_b32 v68, 16, v68
MF v68,v10,v68
MF v69,v10,v69
C v68,v68,v69
W a138,v68
G v70,a139
v_and_b32 v71, 0xffff0000, v70
v_lshlrev_b32 v70, 16, v70
MF v70,v10,v70
MF v71,v10,v71
C v70,v70,v71
W a139,v70
G v72,a140
v_and_b32 v73, 0xffff0000, v72
v_lshlrev_b32 v72, 16, v72
MF v72,v10,v72
MF v73,v10,v73
C v72,v72,v73
W a140,v72
G v74,a141
v_and_b32 v75, 0xffff0000, v74
v_lshlrev_b32 v74, 16, v74
MF v74,v10,v74
MF v75,v10,v75
C v74,v74,v75
W a141,v74
G v76,a142
v_and_b32 v77, 0xffff0000, v76
v_lshlrev_b32 v76, 16, v76
MF v76,v10,v76
MF v77,v10,v77
C v76,v76,v77
W a142,v76
G v78,a143
v_and_b32 v79, 0xffff0000, v78
v_lshlrev_b32 v78, 16, v78
MF v78,v10,v78
MF v79,v10,v79
C v78,v78,v79
W a143,v78
G v64,a144
v_and_b32 v65, 0xffff0000, v64
v_lshlrev_b32 v64, 16, v64
MF v64,v10,v64
MF v65,v10,v65
C v64,v64,v65
W a144,v64
G v66,a145
v_and_b32 v67, 0xffff0000, v66
v_lshlrev_b32 v66, 16, v66
MF v66,v10,v66
MF v67,v10,v67
C v66,v66,v67
W a145,v66
G v68,a146
v_and_b32 v69, 0xffff0000, v68
v_lshlrev_b32 v68, 16, v68
MF v68,v10,v68
MF v69,v10,v69
C v68,v68,v69
W a146,v68
G v70,a147
v_and_b32 v71, 0xffff0000, v70
v_lshlrev_b32 v70, 16, v70
MF v70,v10,v70
MF v71,v10,v71
C v70,v70,v71
W a147,v70
G v72,a148
v_and_b32 v73, 0xffff0000, v72
v_lshlrev_b32 v72, 16, v72
MF v72,v10,v72
MF v73,v10,v73
C v72,v72,v73
W a148,v72
G v74,a149
v_and_b32 v75, 0xffff0000, v74
v_lshlrev_b32 v74, 16, v74
MF v74,v10,v74
MF v75,v10,v75
C v74,v74,v75
W a149,v74
G v76,a150
v_and_b32 v77, 0xffff0000, v76
v_lshlrev_b32 v76, 16, v76
MF v76,v10,v76
MF v77,v10,v77
C v76,v76,v77
W a150,v76
G v78,a151
v_and_b32 v79, 0xffff0000, v78
v_lshlrev_b32 v78, 16, v78
MF v78,v10,v78
MF v79,v10,v79
C v78,v78,v79
W a151,v78
G v64,a152
v_and_b32 v65, 0xffff0000, v64
v_lshlrev_b32 v64, 16, v64
MF v64,v10,v64
MF v65,v10,v65
C v64,v64,v65
W a152,v64
G v66,a153
v_and_b32 v67, 0xffff0000, v66
v_lshlrev_b32 v66, 16, v66
MF v66,v10,v66
MF v67,v10,v67
C v66,v66,v67
W a153,v66
G v68,a154
v_and_b32 v69, 0xffff0000, v68
v_lshlrev_b32 v68, 16, v68
MF v68,v10,v68
MF v69,v10,v69
C v68,v68,v69
W a154,v68
G v70,a155
v_and_b32 v71, 0xffff0000, v70
v_lshlrev_b32 v70, 16, v70
MF v70,v10,v70
MF v71,v10,v71
C v70,v70,v71
W a155,v70
G v72,a156
v_and_b32 v73, 0xffff0000, v72
v_lshlrev_b32 v72, 16, v72
MF v72,v10,v72
MF v73,v10,v73
C v72,v72,v73
W a156,v72
G v74,a157
v_and_b32 v75, 0xffff0000, v74
v_lshlrev_b32 v74, 16, v74
MF v74,v10,v74
MF v75,v10,v75
C v74,v74,v75
W a157,v74
G v76,a158
v_and_b32 v77, 0xffff0000, v76
v_lshlrev_b32 v76, 16, v76
MF v76,v10,v76
MF v77,v10,v77
C v76,v76,v77
W a158,v76
G v78,a159
v_and_b32 v79, 0xffff0000, v78
v_lshlrev_b32 v78, 16, v78
MF v78,v10,v78
MF v79,v10,v79
C v78,v78,v79
W a159,v78
G v64,a160
v_and_b32 v65, 0xffff0000, v64
v_lshlrev_b32 v64, 16, v64
MF v64,v11,v64
MF v65,v11,v65
C v64,v64,v65
W a160,v64
G v66,a161
v_and_b32 v67, 0xffff0000, v66
v_lshlrev_b32 v66, 16, v66
MF v66,v11,v66
MF v67,v11,v67
C v66,v66,v67
W a161,v66
G v68,a162
v_and_b32 v69, 0xffff0000, v68
v_lshlrev_b32 v68, 16, v68
MF v68,v11,v68
MF v69,v11,v69
C v68,v68,v69
W a162,v68
G v70,a163
v_and_b32 v71, 0xffff0000, v70
v_lshlrev_b32 v70, 16, v70
MF v70,v11,v70
MF v71,v11,v71
C v70,v70,v71
W a163,v70
G v72,a164
v_and_b32 v73, 0xffff0000, v72
v_lshlrev_b32 v72, 16, v72
MF v72,v11,v72
MF v73,v11,v73
C v72,v72,v73
W a164,v72
G v74,a165
v_and_b32 v75, 0xffff0000, v74
v_lshlrev_b32 v74, 16, v74
MF v74,v11,v74
MF v75,v11,v75
C v74,v74,v75
W a165,v74
G v76,a166
v_and_b32 v77, 0xffff0000, v76
v_lshlrev_b32 v76, 16, v76
MF v76,v11,v76
MF v77,v11,v77
C v76,v76,v77
W a166,v76
G v78,a167
v_and_b32 v79, 0xffff0000, v78
v_lshlrev_b32 v78, 16, v78
MF v78,v11,v78
MF v79,v11,v79
C v78,v78,v79
W a167,v78
G v64,a168
v_and_b32 v65, 0xffff0000, v64
v_lshlrev_b32 v64, 16, v64
MF v64,v11,v64
MF v65,v11,v65
C v64,v64,v65
W a168,v64
G v66,a169
v_and_b32 v67, 0xffff0000, v66
v_lshlrev_b32 v66, 16, v66
MF v66,v11,v66
MF v67,v11,v67
C v66,v66,v67
W a169,v66
G v68,a170
v_and_b32 v69, 0xffff0000, v68
v_lshlrev_b32 v68, 16, v68
MF v68,v11,v68
MF v69,v11,v69
C v68,v68,v69
W a170,v68
G v70,a171
v_and_b32 v71, 0xffff0000, v70
v_lshlrev_b32 v70, 16, v70
MF v70,v11,v70
MF v71,v11,v71
C v70,v70,v71
W a171,v70
G v72,a172
v_and_b32 v73, 0xffff0000, v72
v_lshlrev_b32 v72, 16, v72
MF v72,v11,v72
MF v73,v11,v73
C v72,v72,v73
W a172,v72
G v74,a173
v_and_b32 v75, 0xffff0000, v74
v_lshlrev_b32 v74, 16, v74
MF v74,v11,v74
MF v75,v11,v75
C v74,v74,v75
W a173,v74
G v76,a174
v_and_b32 v77, 0xffff0000, v76
v_lshlrev_b32 v76, 16, v76
MF v76,v11,v76
MF v77,v11,v77
C v76,v76,v77
W a174,v76
G v78,a175
v_and_b32 v79, 0xffff0000, v78
v_lshlrev_b32 v78, 16, v78
MF v78,v11,v78
MF v79,v11,v79
C v78,v78,v79
W a175,v78
G v64,a176
v_and_b32 v65, 0xffff0000, v64
v_lshlrev_b32 v64, 16, v64
MF v64,v11,v64
MF v65,v11,v65
C v64,v64,v65
W a176,v64
G v66,a177
v_and_b32 v67, 0xffff0000, v66
v_lshlrev_b32 v66, 16, v66
MF v66,v11,v66
MF v67,v11,v67
C v66,v66,v67
W a177,v66
G v68,a178
v_and_b32 v69, 0xffff0000, v68
v_lshlrev_b32 v68, 16, v68
MF v68,v11,v68
MF v69,v11,v69
C v68,v68,v69
W a178,v68
G v70,a179
v_and_b32 v71, 0xffff0000, v70
v_lshlrev_b32 v70, 16, v70
MF v70,v11,v70
MF v71,v11,v71
C v70,v70,v71
W a179,v70
G v72,a180
v_and_b32 v73, 0xffff0000, v72
v_lshlrev_b32 v72, 16, v72
MF v72,v11,v72
MF v73,v11,v73
C v72,v72,v73
W a180,v72
G v74,a181
v_and_b32 v75, 0xffff0000, v74
v_lshlrev_b32 v74, 16, v74
MF v74,v11,v74
MF v75,v11,v75
C v74,v74,v75
W a181,v74
G v76,a182
v_and_b32 v77, 0xffff0000, v76
v_lshlrev_b32 v76, 16, v76
MF v76,v11,v76
MF v77,v11,v77
C v76,v76,v77
W a182,v76
G v78,a183
v_and_b32 v79, 0xffff0000, v78
v_lshlrev_b32 v78, 16, v78
MF v78,v11,v78
MF v79,v11,v79
C v78,v78,v79
W a183,v78
G v64,a184
v_and_b32 v65, 0xffff0000, v64
v_lshlrev_b32 v64, 16, v64
MF v64,v11,v64
MF v65,v11,v65
C v64,v64,v65
W a184,v64
G v66,a185
v_and_b32 v67, 0xffff0000, v66
v_lshlrev_b32 v66, 16, v66
MF v66,v11,v66
MF v67,v11,v67
C v66,v66,v67
W a185,v66
G v68,a186
v_and_b32 v69, 0xffff0000, v68
v_lshlrev_b32 v68, 16, v68
MF v68,v11,v68
MF v69,v11,v69
C v68,v68,v69
W a186,v68
G v70,a187
v_and_b32 v71, 0xffff0000, v70
v_lshlrev_b32 v70, 16, v70
MF v70,v11,v70
MF v71,v11,v71
C v70,v70,v71
W a187,v70
G v72,a188
v_and_b32 v73, 0xffff0000, v72
v_lshlrev_b32 v72, 16, v72
MF v72,v11,v72
MF v73,v11,v73
C v72,v72,v73
W a188,v72
G v74,a189
v_and_b32 v75, 0xffff0000, v74
v_lshlrev_b32 v74, 16, v74
MF v74,v11,v74
MF v75,v11,v75
C v74,v74,v75
W a189,v74
G v76,a190
v_and_b32 v77, 0xffff0000, v76
v_lshlrev_b32 v76, 16, v76
MF v76,v11,v76
MF v77,v11,v77
C v76,v76,v77
W a190,v76
G v78,a191
v_and_b32 v79, 0xffff0000, v78
v_lshlrev_b32 v78, 16, v78
MF v78,v11,v78
MF v79,v11,v79
C v78,v78,v79
W a191,v78
s_nop 3
s_setpc_b64 s[36:37]
L_zs0:
s_mov_b32 s64, 65536
L_zs0_l:
s_sleep 2
buffer_load_dword v17, v16, s[12:15], 0 offen sc1
s_sub_u32 s64, s64, 1
s_cbranch_scc1 L_zs0_x
s_waitcnt vmcnt(0)
v_cmp_ne_u32 vcc, 1, v17
s_nop 0
s_cbranch_vccnz L_zs0_l
L_zs0_x:
s_waitcnt vmcnt(0)
s_branch L_zr0
L_zs1:
s_mov_b32 s64, 65536
L_zs1_l:
s_sleep 2
buffer_load_dword v17, v16, s[12:15], 0 offen sc1
s_sub_u32 s64, s64, 1
s_cbranch_scc1 L_zs1_x
s_waitcnt vmcnt(0)
v_cmp_ne_u32 vcc, 1, v17
s_nop 0
s_cbranch_vccnz L_zs1_l
L_zs1_x:
s_waitcnt vmcnt(0)
s_branch L_zr1
L_hs:
s_mov_b32 s91, 65536
L_hs_l:
buffer_load_dwordx4 v[16:19], v7, s[8:11], s67 offen offset:0 sc1
buffer_load_dwordx4 v[20:23], v7, s[8:11], s67 offen offset:1024 sc1
s_waitcnt vmcnt(0)
s_sub_u32 s91, s91, 1
s_cbranch_scc1 L_hr
v_min3_u32 v28, v16, v17, v18
v_min3_u32 v28, v28, v19, v20
v_min3_u32 v28, v28, v21, v22
v_min_u32 v28, v28, v23
v_cmp_eq_u32 vcc, 0, v28
s_nop 0
s_cbranch_vccnz L_hs_l
s_branch L_hr
L_lsj0:
s_mov_b32 s91, 65536
L_lsj0_l:
s_sleep 2
buffer_load_dword v5, v17, s[8:11], s46 offen sc1
s_sub_u32 s91, s91, 1
s_cbranch_scc1 L_lsj0_x
s_waitcnt vmcnt(0)
v_cmp_gt_u32 vcc, 2, v5
s_nop 0
s_cbranch_vccnz L_lsj0_l
L_lsj0_x:
s_waitcnt vmcnt(0)
s_branch L_lrj0
L_lsh2:
s_mov_b32 s91, 65536
L_lsh2_l:
s_sleep 2
buffer_load_dword v5, v17, s[8:11], s46 offen sc1
s_sub_u32 s91, s91, 1
s_cbranch_scc1 L_lsh2_x
s_waitcnt vmcnt(0)
v_cmp_gt_u32 vcc, 2, v5
s_nop 0
s_cbranch_vccnz L_lsh2_l
L_lsh2_x:
s_waitcnt vmcnt(0)
s_branch L_lrh2
L_lsh4:
s_mov_b32 s91, 65536
L_lsh4_l:
s_sleep 2
buffer_load_dword v5, v9, s[8:11], s46 offen sc1
s_sub_u32 s91, s91, 1
s_cbranch_scc1 L_lsh4_x
s_waitcnt vmcnt(0)
v_cmp_gt_u32 vcc, s84, v5
s_nop 0
s_cbranch_vccnz L_lsh4_l
L_lsh4_x:
s_waitcnt vmcnt(0)
s_branch L_lrh4
L_wsq0:
s_mov_b32 s91, 65536
L_wsq0_l:
s_sleep 2
buffer_load_dword v5, v31, s[8:11], s46 offen offset:4 sc1
s_sub_u32 s91, s91, 1
s_cbranch_scc1 L_wsq0_x
s_waitcnt vmcnt(0)
v_cmp_ne_u32 vcc, 1, v5
s_nop 0
s_mov_b32 vcc_hi, 0
s_cbranch_vccnz L_wsq0_l
L_wsq0_x:
s_waitcnt vmcnt(0)
s_branch L_wrq0
L_wsr0:
s_mov_b32 s91, 65536
L_wsr0_l:
s_sleep 2
buffer_load_dword v5, v31, s[8:11], s46 offen offset:4 sc1
s_sub_u32 s91, s91, 1
s_cbranch_scc1 L_wsr0_x
s_waitcnt vmcnt(0)
v_cmp_ne_u32 vcc, 1, v5
s_nop 0
s_mov_b32 vcc_lo, 0
s_cbranch_vccnz L_wsr0_l
L_wsr0_x:
s_waitcnt vmcnt(0)
s_branch L_wrr0
L_wsq1:
s_mov_b32 s91, 65536
L_wsq1_l:
s_sleep 2
buffer_load_dword v5, v31, s[8:11], s46 offen offset:4 sc1
s_sub_u32 s91, s91, 1
s_cbranch_scc1 L_wsq1_x
s_waitcnt vmcnt(0)
v_cmp_ne_u32 vcc, 1, v5
s_nop 0
s_mov_b32 vcc_hi, 0
s_cbranch_vccnz L_wsq1_l
L_wsq1_x:
s_waitcnt vmcnt(0)
s_branch L_wrq1
L_wsr1:
s_mov_b32 s91, 65536
L_wsr1_l:
s_sleep 2
buffer_load_dword v5, v31, s[8:11], s46 offen offset:4 sc1
s_sub_u32 s91, s91, 1
s_cbranch_scc1 L_wsr1_x
s_waitcnt vmcnt(0)
v_cmp_ne_u32 vcc, 1, v5
s_nop 0
s_mov_b32 vcc_lo, 0
s_cbranch_vccnz L_wsr1_l
L_wsr1_x:
s_waitcnt vmcnt(0)
s_branch L_wrr1
L_fll:
s_sub_u32 s65, s7, s40
s_mov_b32 s64, -1
s_cmp_eq_u32 s65, 1
s_cbranch_scc1 L_fl2
s_cmp_lg_u32 s20, 0
s_cbranch_scc1 L_fl3
s_lshr_b32 s64, s42, 3
s_cmp_eq_u32 s7, s64
s_cbranch_scc0 L_fl1
v_mov_b32 v15, 4
buffer_store_dword v15, v1, s[8:11], s45 offen sc1
L_fl1:
s_cmp_lg_u32 s65, 0
s_cbranch_scc1 L_fllr
s_movk_i32 s64, 0x380
L_fl2:
v_min_u32 v17, s64, v9
s_mov_b32 s6, 4
buffer_load_dword v5, v17, s[8:11], s46 offen sc1
s_bitcmp1_b32 s39, 15
s_cbranch_scc0 L_fllr
L_fl3:
s_cmp_eq_u32 s7, 1
s_cbranch_scc1 L_y2
s_cmp_eq_u32 s7, 2
s_cbranch_scc1 L_y3
s_cmp_eq_u32 s7, 3
s_cbranch_scc1 L_y4
s_branch L_y5
s_waitcnt vmcnt(0)
L_fps:
s_cmp_lg_u32 s35, 0
s_cbranch_scc1 L_fpr
L_fps2:
s_mov_b32 s91, 65536
L_fps2_l:
s_sleep 2
buffer_load_dword v6, off, s[8:11], s47 sc1
s_sub_u32 s91, s91, 1
s_cbranch_scc1 L_fps2_x
s_waitcnt vmcnt(0)
v_cmp_ne_u32 vcc, 1, v6
s_nop 0
s_cbranch_vccnz L_fps2_l
L_fps2_x:
s_waitcnt vmcnt(0)
s_branch L_fpr
L_fqs:
s_mov_b32 s91, 65536
L_fqs_l:
s_sleep 2
buffer_load_dword v6, off, s[8:11], s47 offset:16 sc1
s_sub_u32 s91, s91, 1
s_cbranch_scc1 L_fqs_x
s_waitcnt vmcnt(0)
v_cmp_ne_u32 vcc, 1, v6
s_nop 0
s_cbranch_vccnz L_fqs_l
L_fqs_x:
s_waitcnt vmcnt(0)
s_branch L_fqr
L_fls0:
s_mov_b32 s91, 65536
L_fls0_l:
s_sleep 2
buffer_load_dword v5, v17, s[8:11], s46 offen sc1
s_sub_u32 s91, s91, 1
s_cbranch_scc1 L_fls0_x
s_waitcnt vmcnt(0)
v_cmp_gt_u32 vcc, s6, v5
s_nop 0
s_cbranch_vccnz L_fls0_l
L_fls0_x:
s_waitcnt vmcnt(0)
s_branch L_flr0
L_y2:
v_lshrrev_b32 v11, 7, v7
v_mul_u32_u24 v11, 4352, v11
v_and_b32 v12, 0x70, v7
v_lshl_add_u32 v11, v12, 3, v11
s_mov_b32 s64, 104923136
s_mov_b32 s65, 104957952
buffer_load_dword a128, v11, s[8:11], s64 offen sc1
buffer_load_dword a129, v11, s[8:11], s65 offen sc1
s_branch L_fllr
s_waitcnt vmcnt(0)
L_y3:
s_mov_b32 s91, 65536
L_y3c:
G v12,a128
G v13,a129
v_min_u32 v12, v12, v13
v_cmp_gt_u32 vcc, 2, v12
s_sub_u32 s91, s91, 1
s_cbranch_scc1 L_y3x
s_cbranch_vccz L_y3x
v_lshrrev_b32 v11, 7, v7
v_mul_u32_u24 v11, 4352, v11
v_and_b32 v12, 0x70, v7
v_lshl_add_u32 v11, v12, 3, v11
s_mov_b32 s64, 104923136
s_mov_b32 s65, 104957952
buffer_load_dword a128, v11, s[8:11], s64 offen sc1
buffer_load_dword a129, v11, s[8:11], s65 offen sc1
s_waitcnt vmcnt(0)
s_branch L_y3c
L_y3x:
s_lshl_b32 s66, s41, 1
SA s66,s66,s20
s_sub_u32 s66, s66, 2
s_cmp_lt_u32 s66, 14
s_cselect_b32 s64, 8, 12
SA s64,s64,104890368
buffer_load_dword a130, off, s[8:11], s64 sc1
v_lshrrev_b32 v11, 7, v7
v_mul_u32_u24 v11, 3584, v11
v_and_b32 v12, 0x70, v7
v_add_u32 v11, v12, v11
s_lshl_b32 s65, s66, 7
SA s65,s65,105906176
buffer_load_dwordx4 a[132:135], v11, s[8:11], s65 offen sc1
SA s65,s65,28672
buffer_load_dwordx4 a[136:139], v11, s[8:11], s65 offen sc1
SA s65,s65,28672
buffer_load_dwordx4 a[140:143], v11, s[8:11], s65 offen sc1
SA s65,s65,28672
buffer_load_dwordx4 a[144:147], v11, s[8:11], s65 offen sc1
SA s65,s65,28672
buffer_load_dwordx4 a[148:151], v11, s[8:11], s65 offen sc1
SA s65,s65,28672
buffer_load_dwordx4 a[152:155], v11, s[8:11], s65 offen sc1
SA s65,s65,28672
buffer_load_dwordx4 a[156:159], v11, s[8:11], s65 offen sc1
SA s65,s65,28672
buffer_load_dwordx4 a[160:163], v11, s[8:11], s65 offen sc1
SA s65,s65,28672
buffer_load_dwordx4 a[164:167], v11, s[8:11], s65 offen sc1
SA s65,s65,28672
buffer_load_dwordx4 a[168:171], v11, s[8:11], s65 offen sc1
SA s65,s65,28672
buffer_load_dwordx4 a[172:175], v11, s[8:11], s65 offen sc1
SA s65,s65,28672
buffer_load_dwordx4 a[176:179], v11, s[8:11], s65 offen sc1
SA s65,s65,28672
buffer_load_dwordx4 a[180:183], v11, s[8:11], s65 offen sc1
SA s65,s65,28672
buffer_load_dwordx4 a[184:187], v11, s[8:11], s65 offen sc1
SA s65,s65,28672
s_branch L_fllr
s_waitcnt vmcnt(0)
L_y4:
G v12,a132
G v13,a133
G v14,a134
G v15,a135
G v16,a136
G v17,a137
AF v12,v16,v12
AF v13,v17,v13
G v16,a138
G v17,a139
AF v14,v16,v14
AF v15,v17,v15
G v16,a140
G v17,a141
AF v12,v16,v12
AF v13,v17,v13
G v16,a142
G v17,a143
AF v14,v16,v14
AF v15,v17,v15
G v16,a144
G v17,a145
AF v12,v16,v12
AF v13,v17,v13
G v16,a146
G v17,a147
AF v14,v16,v14
AF v15,v17,v15
G v16,a148
G v17,a149
AF v12,v16,v12
AF v13,v17,v13
G v16,a150
G v17,a151
AF v14,v16,v14
AF v15,v17,v15
G v16,a152
G v17,a153
AF v12,v16,v12
AF v13,v17,v13
G v16,a154
G v17,a155
AF v14,v16,v14
AF v15,v17,v15
G v16,a156
G v17,a157
AF v12,v16,v12
AF v13,v17,v13
G v16,a158
G v17,a159
AF v14,v16,v14
AF v15,v17,v15
G v16,a160
G v17,a161
AF v12,v16,v12
AF v13,v17,v13
G v16,a162
G v17,a163
AF v14,v16,v14
AF v15,v17,v15
G v16,a164
G v17,a165
AF v12,v16,v12
AF v13,v17,v13
G v16,a166
G v17,a167
AF v14,v16,v14
AF v15,v17,v15
G v16,a168
G v17,a169
AF v12,v16,v12
AF v13,v17,v13
G v16,a170
G v17,a171
AF v14,v16,v14
AF v15,v17,v15
G v16,a172
G v17,a173
AF v12,v16,v12
AF v13,v17,v13
G v16,a174
G v17,a175
AF v14,v16,v14
AF v15,v17,v15
G v16,a176
G v17,a177
AF v12,v16,v12
AF v13,v17,v13
G v16,a178
G v17,a179
AF v14,v16,v14
AF v15,v17,v15
G v16,a180
G v17,a181
AF v12,v16,v12
AF v13,v17,v13
G v16,a182
G v17,a183
AF v14,v16,v14
AF v15,v17,v15
G v16,a184
G v17,a185
AF v12,v16,v12
AF v13,v17,v13
G v16,a186
G v17,a187
AF v14,v16,v14
AF v15,v17,v15
v_add_f32 v12, v12, v12 row_ror:8 row_mask:0xf bank_mask:0xf
v_add_f32 v13, v13, v13 row_ror:8 row_mask:0xf bank_mask:0xf
v_add_f32 v14, v14, v14 row_ror:8 row_mask:0xf bank_mask:0xf
v_add_f32 v15, v15, v15 row_ror:8 row_mask:0xf bank_mask:0xf
v_mov_b32 v11, v12
s_nop 1
v_permlane16_swap_b32 v11, v12
AF v12,v11,v12
v_mov_b32 v11, v13
s_nop 1
v_permlane16_swap_b32 v11, v13
AF v13,v11,v13
v_mov_b32 v11, v14
s_nop 1
v_permlane16_swap_b32 v11, v14
AF v14,v11,v14
v_mov_b32 v11, v15
s_nop 1
v_permlane16_swap_b32 v11, v15
AF v15,v11,v15
v_mov_b32 v11, v12
s_nop 1
v_permlane32_swap_b32 v11, v12
AF v12,v11,v12
v_mov_b32 v11, v13
s_nop 1
v_permlane32_swap_b32 v11, v13
AF v13,v11,v13
v_mov_b32 v11, v14
s_nop 1
v_permlane32_swap_b32 v11, v14
AF v14,v11,v14
v_mov_b32 v11, v15
s_nop 1
v_permlane32_swap_b32 v11, v15
AF v15,v11,v15
G v16,a130
C v11,v12,v13
v_lshlrev_b32 v12, 16, v11
v_and_b32 v13, 0xffff0000, v11
C v11,v14,v15
v_lshlrev_b32 v14, 16, v11
v_and_b32 v15, 0xffff0000, v11
MF v12,v16,v12
MF v13,v16,v13
MF v14,v16,v14
MF v15,v16,v15
C v11,v12,v13
v_lshlrev_b32 v12, 16, v11
v_and_b32 v13, 0xffff0000, v11
C v11,v14,v15
v_lshlrev_b32 v14, 16, v11
v_and_b32 v15, 0xffff0000, v11
s_lshl_b32 s66, s41, 1
SA s66,s66,s20
s_sub_u32 s66, s66, 2
s_lshl_b32 s65, s66, 7
SA s65,s65,104898560
s_mov_b64 exec, 0xff
buffer_store_dwordx4 v[12:15], v7, s[8:11], s65 offen sc1
s_mov_b64 exec, -1
s_nop 1
s_branch L_fllr
L_y5:
s_lshl_b32 s66, s41, 1
SA s66,s66,s20
s_sub_u32 s66, s66, 2
s_lshl_b32 s66, s66, 2
SA s66,s66,105062912
v_mov_b32 v11, 1
s_mov_b64 exec, 1
buffer_store_dword v11, off, s[8:11], s66 sc1
s_mov_b64 exec, -1
s_branch L_fllr
.p2align 12
L_loop_top:
M v[64:67],a[64:67],a[0:3],v[32:35]
SA m0,s28,0
R a[96:99],v2,40960
M v[64:67],a[68:71],a[4:7],v[64:67]
buffer_load_dword a240, v0, s[60:63], 0 offen offset:0
M v[64:67],a[72:75],a[8:11],v[64:67]
R a[100:103],v2,41984
M v[64:67],a[76:79],a[12:15],v[64:67]
s_waitcnt lgkmcnt(2)
buffer_load_dwordx4 v3, s[8:11], s26 offen offset:0 sc1 lds
M v[64:67],a[80:83],a[16:19],v[64:67]
R a[104:107],v2,43008
M v[64:67],a[84:87],a[20:23],v[64:67]
E v18,v112
M v[64:67],a[88:91],a[24:27],v[64:67]
R a[108:111],v2,44032
M v[64:67],a[92:95],a[28:31],v[64:67]
buffer_load_dwordx4 v3, s[8:11], s26 offen offset:1024 sc1 lds
M v[68:71],a[92:95],a[60:63],v[36:39]
R a[112:115],v2,45056
M v[68:71],a[88:91],a[56:59],v[68:71]
E v19,v113
M v[68:71],a[84:87],a[52:55],v[68:71]
R a[116:119],v2,46080
AF v28,v18,v28
M v[68:71],a[80:83],a[48:51],v[68:71]
E v20,v114
M v[68:71],a[76:79],a[44:47],v[68:71]
R a[120:123],v2,47104
C v56,v18,v19
M v[68:71],a[72:75],a[40:43],v[68:71]
buffer_load_dwordx4 v3, s[8:11], s26 offen offset:2048 sc1 lds
M v[68:71],a[68:71],a[36:39],v[68:71]
R a[124:127],v2,48128
AF v28,v19,v28
M v[68:71],a[64:67],a[32:35],v[68:71]
s_waitcnt lgkmcnt(4)
E v21,v115
M v[72:75],a[96:99],a[0:3],v[32:35]
R a[64:67],v2,49152
AF v28,v20,v28
M v[72:75],a[100:103],a[4:7],v[72:75]
buffer_load_dwordx4 v3, s[8:11], s26 offen offset:3072 sc1 lds
M v[72:75],a[104:107],a[8:11],v[72:75]
R a[68:71],v2,50176
C v57,v20,v21
M v[72:75],a[108:111],a[12:15],v[72:75]
s_waitcnt lgkmcnt(2)
E v22,v120
M v[72:75],a[112:115],a[16:19],v[72:75]
R a[72:75],v2,51200
AF v28,v21,v28
M v[72:75],a[116:119],a[20:23],v[72:75]
E v23,v121
M v[72:75],a[120:123],a[24:27],v[72:75]
SA m0,s28,4096
R a[76:79],v2,52224
AF v28,v22,v28
M v[72:75],a[124:127],a[28:31],v[72:75]
buffer_load_dwordx4 v4, s[8:11], s26 offen offset:0 sc1 lds
M v[76:79],a[124:127],a[60:63],v[36:39]
R a[80:83],v2,53248
C v58,v22,v23
M v[76:79],a[120:123],a[56:59],v[76:79]
E v24,v122
M v[76:79],a[116:119],a[52:55],v[76:79]
R a[84:87],v2,54272
AF v28,v23,v28
M v[76:79],a[112:115],a[48:51],v[76:79]
E v25,v123
M v[76:79],a[108:111],a[44:47],v[76:79]
R a[88:91],v2,55296
AF v28,v24,v28
M v[76:79],a[104:107],a[40:43],v[76:79]
buffer_load_dwordx4 v4, s[8:11], s26 offen offset:1024 sc1 lds
M v[76:79],a[100:103],a[36:39],v[76:79]
R a[92:95],v2,56320
C v59,v24,v25
M v[76:79],a[96:99],a[32:35],v[76:79]
s_waitcnt lgkmcnt(4)
E v18,v116
M v[80:83],a[64:67],a[0:3],v[32:35]
R a[96:99],v2,57344
AF v28,v25,v28
M v[80:83],a[68:71],a[4:7],v[80:83]
R a[100:103],v2,58368
M v[80:83],a[72:75],a[8:11],v[80:83]
buffer_load_dwordx4 v4, s[8:11], s26 offen offset:2048 sc1 lds
M v[80:83],a[76:79],a[12:15],v[80:83]
s_waitcnt lgkmcnt(2)
R a[104:107],v2,59392
M v[80:83],a[80:83],a[16:19],v[80:83]
R a[108:111],v2,60416
M v[80:83],a[84:87],a[20:23],v[80:83]
E v19,v117
M v[80:83],a[88:91],a[24:27],v[80:83]
R a[112:115],v2,61440
AF v29,v18,v29
M v[80:83],a[92:95],a[28:31],v[80:83]
R a[116:119],v2,62464
C v60,v18,v19
M v[84:87],a[92:95],a[60:63],v[36:39]
buffer_load_dwordx4 v4, s[8:11], s26 offen offset:3072 sc1 lds
M v[84:87],a[88:91],a[56:59],v[84:87]
SA s26,s26,32768
R a[120:123],v2,63488
AF v29,v19,v29
M v[84:87],a[84:87],a[52:55],v[84:87]
R a[124:127],v2,64512
M v[84:87],a[80:83],a[48:51],v[84:87]
E v20,v118
M v[84:87],a[76:79],a[44:47],v[84:87]
E v21,v119
M v[84:87],a[72:75],a[40:43],v[84:87]
E v22,v124
M v[84:87],a[68:71],a[36:39],v[84:87]
s_waitcnt vmcnt(17) lgkmcnt(0)
E v23,v125
M v[84:87],a[64:67],a[32:35],v[84:87]
s_barrier
M v[88:91],a[96:99],a[0:3],v[32:35]
R a[64:67],v7,32768
AF v29,v20,v29
M v[88:91],a[100:103],a[4:7],v[88:91]
E v24,v126
M v[88:91],a[104:107],a[8:11],v[88:91]
R a[68:71],v7,33792
C v61,v20,v21
M v[88:91],a[108:111],a[12:15],v[88:91]
AF v29,v21,v29
AF v29,v22,v29
M v[88:91],a[112:115],a[16:19],v[88:91]
R a[72:75],v7,34816
C v62,v22,v23
M v[88:91],a[116:119],a[20:23],v[88:91]
E v25,v127
M v[88:91],a[120:123],a[24:27],v[88:91]
R a[76:79],v7,35840
AF v29,v23,v29
M v[88:91],a[124:127],a[28:31],v[88:91]
AF v29,v24,v29
C v63,v24,v25
M v[92:95],a[124:127],a[60:63],v[36:39]
R a[80:83],v7,36864
AF v29,v25,v29
M v[92:95],a[120:123],a[56:59],v[92:95]
M v[92:95],a[116:119],a[52:55],v[92:95]
R a[84:87],v7,37888
v_max_f32 v10, v28, v29
M v[92:95],a[112:115],a[48:51],v[92:95]
v_cmp_lt_f32 vcc, s31, v10
M v[92:95],a[108:111],a[44:47],v[92:95]
R a[88:91],v7,38912
M v[92:95],a[104:107],a[40:43],v[92:95]
M v[92:95],a[100:103],a[36:39],v[92:95]
s_waitcnt lgkmcnt(3)
R a[92:95],v7,39936
M v[92:95],a[96:99],a[32:35],v[92:95]
s_cbranch_vccnz L_st1
L_rt1:
M v[128:131],a[64:67],v[48:51],v[128:131]
SA m0,s28,98304
R a[96:99],v7,40960
AF v30,v28,v30
M v[128:131],a[68:71],v[56:59],v[128:131]
buffer_load_dwordx4 v3, s[8:11], s21 offen offset:0 sc1 lds
M v[132:135],a[68:71],v[60:63],v[132:135]
R a[100:103],v7,41984
AF v31,v29,v31
M v[132:135],a[64:67],v[52:55],v[132:135]
s_waitcnt lgkmcnt(2)
E v18,v64
M v[136:139],a[72:75],v[48:51],v[136:139]
R a[104:107],v7,43008
M v[136:139],a[76:79],v[56:59],v[136:139]
buffer_load_dwordx4 v3, s[8:11], s21 offen offset:1024 sc1 lds
M v[140:143],a[76:79],v[60:63],v[140:143]
R a[108:111],v7,44032
M v[140:143],a[72:75],v[52:55],v[140:143]
E v19,v65
M v[144:147],a[80:83],v[48:51],v[144:147]
R a[112:115],v7,45056
AF v26,v18,v19
M v[144:147],a[84:87],v[56:59],v[144:147]
E v20,v66
M v[148:151],a[84:87],v[60:63],v[148:151]
R a[116:119],v7,46080
C v40,v18,v19
M v[148:151],a[80:83],v[52:55],v[148:151]
buffer_load_dwordx4 v3, s[8:11], s21 offen offset:2048 sc1 lds
M v[152:155],a[88:91],v[48:51],v[152:155]
R a[120:123],v7,47104
M v[152:155],a[92:95],v[56:59],v[152:155]
E v21,v67
M v[156:159],a[92:95],v[60:63],v[156:159]
R a[124:127],v7,48128
AF v26,v20,v26
M v[156:159],a[88:91],v[52:55],v[156:159]
s_waitcnt lgkmcnt(4)
buffer_load_dwordx4 v3, s[8:11], s21 offen offset:3072 sc1 lds
M v[160:163],a[96:99],v[48:51],v[160:163]
R a[64:67],v7,49152
C v41,v20,v21
M v[160:163],a[100:103],v[56:59],v[160:163]
E v22,v72
M v[164:167],a[100:103],v[60:63],v[164:167]
SA m0,s28,102400
R a[68:71],v7,50176
AF v26,v21,v26
M v[164:167],a[96:99],v[52:55],v[164:167]
s_waitcnt lgkmcnt(2)
buffer_load_dwordx4 v4, s[8:11], s21 offen offset:0 sc1 lds
M v[168:171],a[104:107],v[48:51],v[168:171]
R a[72:75],v7,51200
M v[168:171],a[108:111],v[56:59],v[168:171]
E v23,v73
M v[172:175],a[108:111],v[60:63],v[172:175]
R a[76:79],v7,52224
AF v26,v22,v26
M v[172:175],a[104:107],v[52:55],v[172:175]
E v24,v74
M v[176:179],a[112:115],v[48:51],v[176:179]
R a[80:83],v7,53248
C v42,v22,v23
M v[176:179],a[116:119],v[56:59],v[176:179]
buffer_load_dwordx4 v4, s[8:11], s21 offen offset:1024 sc1 lds
M v[180:183],a[116:119],v[60:63],v[180:183]
R a[84:87],v7,54272
AF v26,v23,v26
M v[180:183],a[112:115],v[52:55],v[180:183]
E v25,v75
M v[184:187],a[120:123],v[48:51],v[184:187]
R a[88:91],v7,55296
AF v26,v24,v26
M v[184:187],a[124:127],v[56:59],v[184:187]
buffer_load_dwordx4 v4, s[8:11], s21 offen offset:2048 sc1 lds
M v[188:191],a[124:127],v[60:63],v[188:191]
R a[92:95],v7,56320
C v43,v24,v25
M v[188:191],a[120:123],v[52:55],v[188:191]
s_waitcnt lgkmcnt(4)
E v18,v68
M v[192:195],a[64:67],v[48:51],v[192:195]
R a[96:99],v7,57344
AF v26,v25,v26
M v[192:195],a[68:71],v[56:59],v[192:195]
R a[100:103],v7,58368
M v[196:199],a[68:71],v[60:63],v[196:199]
buffer_load_dwordx4 v4, s[8:11], s21 offen offset:3072 sc1 lds
M v[196:199],a[64:67],v[52:55],v[196:199]
s_waitcnt lgkmcnt(2)
R a[104:107],v7,59392
M v[200:203],a[72:75],v[48:51],v[200:203]
SA s21,s21,32768
R a[108:111],v7,60416
M v[200:203],a[76:79],v[56:59],v[200:203]
s_sub_u32 s22, s22, 1
E v19,v69
M v[204:207],a[76:79],v[60:63],v[204:207]
s_cselect_b32 s21, s23, s21
R a[112:115],v7,61440
AF v27,v18,v19
M v[204:207],a[72:75],v[52:55],v[204:207]
R a[116:119],v7,62464
C v44,v18,v19
M v[208:211],a[80:83],v[48:51],v[208:211]
E v20,v70
M v[208:211],a[84:87],v[56:59],v[208:211]
R a[120:123],v7,63488
M v[212:215],a[84:87],v[60:63],v[212:215]
R a[124:127],v7,64512
M v[212:215],a[80:83],v[52:55],v[212:215]
E v21,v71
M v[216:219],a[88:91],v[48:51],v[216:219]
E v22,v76
M v[216:219],a[92:95],v[56:59],v[216:219]
AF v27,v20,v27
C v45,v20,v21
M v[220:223],a[92:95],v[60:63],v[220:223]
s_waitcnt vmcnt(17) lgkmcnt(0)
AF v27,v21,v27
M v[220:223],a[88:91],v[52:55],v[220:223]
s_barrier
M v[224:227],a[96:99],v[48:51],v[224:227]
R a[64:67],v2,0
M v[224:227],a[100:103],v[56:59],v[224:227]
E v23,v77
M v[228:231],a[100:103],v[60:63],v[228:231]
R a[68:71],v2,1024
AF v27,v22,v27
M v[228:231],a[96:99],v[52:55],v[228:231]
E v24,v78
M v[232:235],a[104:107],v[48:51],v[232:235]
R a[72:75],v2,2048
C v46,v22,v23
M v[232:235],a[108:111],v[56:59],v[232:235]
AF v27,v23,v27
M v[236:239],a[108:111],v[60:63],v[236:239]
R a[76:79],v2,3072
M v[236:239],a[104:107],v[52:55],v[236:239]
E v25,v79
M v[240:243],a[112:115],v[48:51],v[240:243]
R a[80:83],v2,4096
AF v27,v24,v27
M v[240:243],a[116:119],v[56:59],v[240:243]
C v47,v24,v25
AF v27,v25,v27
M v[244:247],a[116:119],v[60:63],v[244:247]
R a[84:87],v2,5120
M v[244:247],a[112:115],v[52:55],v[244:247]
M v[248:251],a[120:123],v[48:51],v[248:251]
R a[88:91],v2,6144
M v[248:251],a[124:127],v[56:59],v[248:251]
M v[252:255],a[124:127],v[60:63],v[252:255]
s_waitcnt lgkmcnt(3)
R a[92:95],v2,7168
M v[252:255],a[120:123],v[52:55],v[252:255]
M v[96:99],a[64:67],a[0:3],v[32:35]
s_bitcmp1_b32 s39, s7
R a[96:99],v2,8192
M v[96:99],a[68:71],a[4:7],v[96:99]
s_cbranch_scc1 L_fll
L_fllr:
E v18,v80
M v[96:99],a[72:75],a[8:11],v[96:99]
SA m0,s28,32768
R a[100:103],v2,9216
M v[96:99],a[76:79],a[12:15],v[96:99]
s_waitcnt lgkmcnt(2)
buffer_load_dwordx4 v3, s[8:11], s26 offen offset:0 sc1 lds
M v[96:99],a[80:83],a[16:19],v[96:99]
R a[104:107],v2,10240
M v[96:99],a[84:87],a[20:23],v[96:99]
E v19,v81
M v[96:99],a[88:91],a[24:27],v[96:99]
R a[108:111],v2,11264
AF v26,v18,v26
M v[96:99],a[92:95],a[28:31],v[96:99]
E v20,v82
M v[100:103],a[92:95],a[60:63],v[36:39]
R a[112:115],v2,12288
C v56,v18,v19
M v[100:103],a[88:91],a[56:59],v[100:103]
buffer_load_dwordx4 v3, s[8:11], s26 offen offset:1024 sc1 lds
M v[100:103],a[84:87],a[52:55],v[100:103]
R a[116:119],v2,13312
AF v26,v19,v26
M v[100:103],a[80:83],a[48:51],v[100:103]
E v21,v83
M v[100:103],a[76:79],a[44:47],v[100:103]
R a[120:123],v2,14336
AF v26,v20,v26
M v[100:103],a[72:75],a[40:43],v[100:103]
buffer_load_dwordx4 v3, s[8:11], s26 offen offset:2048 sc1 lds
M v[100:103],a[68:71],a[36:39],v[100:103]
R a[124:127],v2,15360
C v57,v20,v21
M v[100:103],a[64:67],a[32:35],v[100:103]
s_waitcnt lgkmcnt(4)
E v22,v88
M v[104:107],a[96:99],a[0:3],v[32:35]
R a[64:67],v2,16384
AF v26,v21,v26
M v[104:107],a[100:103],a[4:7],v[104:107]
E v23,v89
M v[104:107],a[104:107],a[8:11],v[104:107]
R a[68:71],v2,17408
AF v26,v22,v26
M v[104:107],a[108:111],a[12:15],v[104:107]
s_waitcnt lgkmcnt(2)
buffer_load_dwordx4 v3, s[8:11], s26 offen offset:3072 sc1 lds
M v[104:107],a[112:115],a[16:19],v[104:107]
R a[72:75],v2,18432
C v58,v22,v23
M v[104:107],a[116:119],a[20:23],v[104:107]
E v24,v90
M v[104:107],a[120:123],a[24:27],v[104:107]
R a[76:79],v2,19456
AF v26,v23,v26
M v[104:107],a[124:127],a[28:31],v[104:107]
SA m0,s28,36864
M v[108:111],a[124:127],a[60:63],v[36:39]
R a[80:83],v2,20480
M v[108:111],a[120:123],a[56:59],v[108:111]
buffer_load_dwordx4 v4, s[8:11], s26 offen offset:0 sc1 lds
M v[108:111],a[116:119],a[52:55],v[108:111]
R a[84:87],v2,21504
M v[108:111],a[112:115],a[48:51],v[108:111]
E v25,v91
M v[108:111],a[108:111],a[44:47],v[108:111]
R a[88:91],v2,22528
AF v26,v24,v26
M v[108:111],a[104:107],a[40:43],v[108:111]
buffer_load_dwordx4 v4, s[8:11], s26 offen offset:1024 sc1 lds
M v[108:111],a[100:103],a[36:39],v[108:111]
R a[92:95],v2,23552
C v59,v24,v25
M v[108:111],a[96:99],a[32:35],v[108:111]
s_waitcnt lgkmcnt(4)
E v18,v84
M v[112:115],a[64:67],a[0:3],v[32:35]
R a[96:99],v2,24576
AF v26,v25,v26
M v[112:115],a[68:71],a[4:7],v[112:115]
R a[100:103],v2,25600
M v[112:115],a[72:75],a[8:11],v[112:115]
buffer_load_dwordx4 v4, s[8:11], s26 offen offset:2048 sc1 lds
M v[112:115],a[76:79],a[12:15],v[112:115]
s_waitcnt lgkmcnt(2)
R a[104:107],v2,26624
M v[112:115],a[80:83],a[16:19],v[112:115]
R a[108:111],v2,27648
M v[112:115],a[84:87],a[20:23],v[112:115]
E v19,v85
M v[112:115],a[88:91],a[24:27],v[112:115]
R a[112:115],v2,28672
AF v27,v18,v27
M v[112:115],a[92:95],a[28:31],v[112:115]
R a[116:119],v2,29696
C v60,v18,v19
M v[116:119],a[92:95],a[60:63],v[36:39]
buffer_load_dwordx4 v4, s[8:11], s26 offen offset:3072 sc1 lds
M v[116:119],a[88:91],a[56:59],v[116:119]
SA s26,s26,32768
R a[120:123],v2,30720
AF v27,v19,v27
M v[116:119],a[84:87],a[52:55],v[116:119]
R a[124:127],v2,31744
M v[116:119],a[80:83],a[48:51],v[116:119]
E v20,v86
M v[116:119],a[76:79],a[44:47],v[116:119]
E v21,v87
M v[116:119],a[72:75],a[40:43],v[116:119]
E v22,v92
M v[116:119],a[68:71],a[36:39],v[116:119]
s_waitcnt vmcnt(16) lgkmcnt(0)
E v23,v93
M v[116:119],a[64:67],a[32:35],v[116:119]
s_barrier
M v[120:123],a[96:99],a[0:3],v[32:35]
R a[64:67],v7,0
AF v27,v20,v27
M v[120:123],a[100:103],a[4:7],v[120:123]
E v24,v94
M v[120:123],a[104:107],a[8:11],v[120:123]
R a[68:71],v7,1024
C v61,v20,v21
M v[120:123],a[108:111],a[12:15],v[120:123]
AF v27,v21,v27
AF v27,v22,v27
M v[120:123],a[112:115],a[16:19],v[120:123]
R a[72:75],v7,2048
C v62,v22,v23
M v[120:123],a[116:119],a[20:23],v[120:123]
E v25,v95
M v[120:123],a[120:123],a[24:27],v[120:123]
R a[76:79],v7,3072
AF v27,v23,v27
M v[120:123],a[124:127],a[28:31],v[120:123]
AF v27,v24,v27
C v63,v24,v25
M v[124:127],a[124:127],a[60:63],v[36:39]
R a[80:83],v7,4096
AF v27,v25,v27
M v[124:127],a[120:123],a[56:59],v[124:127]
M v[124:127],a[116:119],a[52:55],v[124:127]
R a[84:87],v7,5120
v_max_f32 v10, v26, v27
M v[124:127],a[112:115],a[48:51],v[124:127]
v_cmp_lt_f32 vcc, s31, v10
M v[124:127],a[108:111],a[44:47],v[124:127]
R a[88:91],v7,6144
M v[124:127],a[104:107],a[40:43],v[124:127]
M v[124:127],a[100:103],a[36:39],v[124:127]
s_waitcnt lgkmcnt(3)
R a[92:95],v7,7168
M v[124:127],a[96:99],a[32:35],v[124:127]
s_cbranch_vccnz L_st0
L_rt0:
M v[128:131],a[64:67],v[40:43],v[128:131]
SA m0,s28,65536
R a[96:99],v7,8192
AF v30,v26,v30
M v[128:131],a[68:71],v[56:59],v[128:131]
buffer_load_dwordx4 v3, s[8:11], s21 offen offset:0 sc1 lds
M v[132:135],a[68:71],v[60:63],v[132:135]
R a[100:103],v7,9216
AF v31,v27,v31
M v[132:135],a[64:67],v[44:47],v[132:135]
s_waitcnt lgkmcnt(2)
E v18,v96
M v[136:139],a[72:75],v[40:43],v[136:139]
R a[104:107],v7,10240
M v[136:139],a[76:79],v[56:59],v[136:139]
buffer_load_dwordx4 v3, s[8:11], s21 offen offset:1024 sc1 lds
M v[140:143],a[76:79],v[60:63],v[140:143]
R a[108:111],v7,11264
M v[140:143],a[72:75],v[44:47],v[140:143]
E v19,v97
M v[144:147],a[80:83],v[40:43],v[144:147]
R a[112:115],v7,12288
AF v28,v18,v19
M v[144:147],a[84:87],v[56:59],v[144:147]
E v20,v98
M v[148:151],a[84:87],v[60:63],v[148:151]
R a[116:119],v7,13312
C v48,v18,v19
M v[148:151],a[80:83],v[44:47],v[148:151]
buffer_load_dwordx4 v3, s[8:11], s21 offen offset:2048 sc1 lds
M v[152:155],a[88:91],v[40:43],v[152:155]
R a[120:123],v7,14336
M v[152:155],a[92:95],v[56:59],v[152:155]
E v21,v99
M v[156:159],a[92:95],v[60:63],v[156:159]
R a[124:127],v7,15360
AF v28,v20,v28
M v[156:159],a[88:91],v[44:47],v[156:159]
s_waitcnt lgkmcnt(4)
buffer_load_dwordx4 v3, s[8:11], s21 offen offset:3072 sc1 lds
M v[160:163],a[96:99],v[40:43],v[160:163]
R a[64:67],v7,16384
C v49,v20,v21
M v[160:163],a[100:103],v[56:59],v[160:163]
E v22,v104
M v[164:167],a[100:103],v[60:63],v[164:167]
SA m0,s28,69632
R a[68:71],v7,17408
AF v28,v21,v28
M v[164:167],a[96:99],v[44:47],v[164:167]
s_waitcnt lgkmcnt(2)
buffer_load_dwordx4 v4, s[8:11], s21 offen offset:0 sc1 lds
M v[168:171],a[104:107],v[40:43],v[168:171]
R a[72:75],v7,18432
M v[168:171],a[108:111],v[56:59],v[168:171]
E v23,v105
M v[172:175],a[108:111],v[60:63],v[172:175]
R a[76:79],v7,19456
AF v28,v22,v28
M v[172:175],a[104:107],v[44:47],v[172:175]
E v24,v106
M v[176:179],a[112:115],v[40:43],v[176:179]
R a[80:83],v7,20480
C v50,v22,v23
M v[176:179],a[116:119],v[56:59],v[176:179]
buffer_load_dwordx4 v4, s[8:11], s21 offen offset:1024 sc1 lds
M v[180:183],a[116:119],v[60:63],v[180:183]
R a[84:87],v7,21504
AF v28,v23,v28
M v[180:183],a[112:115],v[44:47],v[180:183]
E v25,v107
M v[184:187],a[120:123],v[40:43],v[184:187]
R a[88:91],v7,22528
AF v28,v24,v28
M v[184:187],a[124:127],v[56:59],v[184:187]
buffer_load_dwordx4 v4, s[8:11], s21 offen offset:2048 sc1 lds
M v[188:191],a[124:127],v[60:63],v[188:191]
R a[92:95],v7,23552
C v51,v24,v25
M v[188:191],a[120:123],v[44:47],v[188:191]
s_waitcnt lgkmcnt(4)
E v18,v100
M v[192:195],a[64:67],v[40:43],v[192:195]
R a[96:99],v7,24576
AF v28,v25,v28
M v[192:195],a[68:71],v[56:59],v[192:195]
R a[100:103],v7,25600
M v[196:199],a[68:71],v[60:63],v[196:199]
buffer_load_dwordx4 v4, s[8:11], s21 offen offset:3072 sc1 lds
M v[196:199],a[64:67],v[44:47],v[196:199]
s_waitcnt lgkmcnt(2)
R a[104:107],v7,26624
M v[200:203],a[72:75],v[40:43],v[200:203]
SA s21,s21,32768
R a[108:111],v7,27648
M v[200:203],a[76:79],v[56:59],v[200:203]
s_sub_u32 s22, s22, 1
E v19,v101
M v[204:207],a[76:79],v[60:63],v[204:207]
s_cselect_b32 s21, s23, s21
R a[112:115],v7,28672
AF v29,v18,v19
M v[204:207],a[72:75],v[44:47],v[204:207]
R a[116:119],v7,29696
C v52,v18,v19
M v[208:211],a[80:83],v[40:43],v[208:211]
E v20,v102
M v[208:211],a[84:87],v[56:59],v[208:211]
R a[120:123],v7,30720
M v[212:215],a[84:87],v[60:63],v[212:215]
R a[124:127],v7,31744
M v[212:215],a[80:83],v[44:47],v[212:215]
E v21,v103
M v[216:219],a[88:91],v[40:43],v[216:219]
E v22,v108
M v[216:219],a[92:95],v[56:59],v[216:219]
AF v29,v20,v29
C v53,v20,v21
M v[220:223],a[92:95],v[60:63],v[220:223]
s_waitcnt vmcnt(16) lgkmcnt(0)
AF v29,v21,v29
M v[220:223],a[88:91],v[44:47],v[220:223]
s_barrier
M v[224:227],a[96:99],v[40:43],v[224:227]
R a[64:67],v2,32768
M v[224:227],a[100:103],v[56:59],v[224:227]
E v23,v109
M v[228:231],a[100:103],v[60:63],v[228:231]
R a[68:71],v2,33792
v_cmp_gt_u32 vcc, s6, v5
M v[228:231],a[96:99],v[44:47],v[228:231]
E v24,v110
M v[232:235],a[104:107],v[40:43],v[232:235]
R a[72:75],v2,34816
AF v29,v22,v29
M v[232:235],a[108:111],v[56:59],v[232:235]
s_cbranch_vccnz L_fls0
L_flr0:
C v54,v22,v23
AF v29,v23,v29
M v[236:239],a[108:111],v[60:63],v[236:239]
s_mov_b32 s6, 0
R a[76:79],v2,35840
M v[236:239],a[104:107],v[44:47],v[236:239]
SA s7,s7,1
E v25,v111
M v[240:243],a[112:115],v[40:43],v[240:243]
R a[80:83],v2,36864
AF v29,v24,v29
M v[240:243],a[116:119],v[56:59],v[240:243]
C v55,v24,v25
AF v29,v25,v29
M v[244:247],a[116:119],v[60:63],v[244:247]
R a[84:87],v2,37888
M v[244:247],a[112:115],v[44:47],v[244:247]
M v[248:251],a[120:123],v[40:43],v[248:251]
s_sub_u32 s27, s27, 1
R a[88:91],v2,38912
M v[248:251],a[124:127],v[56:59],v[248:251]
s_cmp_lg_u32 s27, 0
M v[252:255],a[124:127],v[60:63],v[252:255]
s_waitcnt lgkmcnt(3)
R a[92:95],v2,39936
M v[252:255],a[120:123],v[44:47],v[252:255]
s_cbranch_scc1 L_loop_top
s_cmp_eq_u32 s40, 0
s_cbranch_scc1 L_final_h
L_d1s:
M v[68:71],a[64:67],a[32:35],v[36:39]
s_cmp_lt_u32 s20, 0
R a[96:99],v2,40960
R a[100:103],v2,41984
M v[68:71],a[68:71],a[36:39],v[68:71]
s_cselect_b64 s[82:83], -1, 0
E v18,v112
M v[68:71],a[72:75],a[40:43],v[68:71]
s_cmp_eq_u32 s20, 0
M v[68:71],a[76:79],a[44:47],v[68:71]
s_cselect_b64 s[66:67], s[16:17], s[82:83]
R a[104:107],v2,43008
R a[108:111],v2,44032
s_waitcnt lgkmcnt(7)
M v[68:71],a[80:83],a[48:51],v[68:71]
s_cselect_b64 s[68:69], s[18:19], s[82:83]
E v19,v113
s_waitcnt lgkmcnt(6)
M v[68:71],a[84:87],a[52:55],v[68:71]
s_cselect_b64 s[70:71], s[48:49], s[82:83]
AF v28,v18,v28
C v56,v18,v19
s_waitcnt lgkmcnt(5)
M v[68:71],a[88:91],a[56:59],v[68:71]
s_cselect_b64 s[72:73], s[50:51], s[82:83]
R a[112:115],v2,45056
R a[116:119],v2,46080
v_cndmask_b32 v64, v32, v8, s[66:67]
v_cndmask_b32 v65, v32, v8, s[68:69]
v_cndmask_b32 v66, v32, v8, s[70:71]
v_cndmask_b32 v67, v32, v8, s[72:73]
s_waitcnt lgkmcnt(6)
M v[68:71],a[92:95],a[60:63],v[68:71]
s_mov_b32 s26, s43
v_min_u32 v17, 896, v9
AF v28,v19,v28
M v[64:67],a[92:95],a[28:31],v[64:67]
s_cmp_lt_u32 s20, 1
buffer_load_dword v5, v17, s[8:11], s46 offen sc1
M v[64:67],a[88:91],a[24:27],v[64:67]
s_cselect_b64 s[82:83], -1, 0
R a[120:123],v2,47104
R a[124:127],v2,48128
M v[64:67],a[84:87],a[20:23],v[64:67]
SA m0,s28,0
E v20,v114
M v[64:67],a[80:83],a[16:19],v[64:67]
s_cmp_eq_u32 s20, 1
buffer_load_dwordx4 v3, s[8:11], s26 offen offset:0 sc1 lds
M v[64:67],a[76:79],a[12:15],v[64:67]
s_cselect_b64 s[74:75], s[16:17], s[82:83]
E v21,v115
M v[64:67],a[72:75],a[8:11],v[64:67]
s_cselect_b64 s[76:77], s[18:19], s[82:83]
AF v28,v20,v28
C v57,v20,v21
M v[64:67],a[68:71],a[4:7],v[64:67]
s_cselect_b64 s[78:79], s[48:49], s[82:83]
E v22,v120
M v[64:67],a[64:67],a[0:3],v[64:67]
s_waitcnt lgkmcnt(0)
buffer_load_dwordx4 v3, s[8:11], s26 offen offset:1024 sc1 lds
M v[76:79],a[96:99],a[32:35],v[36:39]
s_cselect_b64 s[80:81], s[50:51], s[82:83]
R a[64:67],v2,49152
R a[68:71],v2,50176
M v[76:79],a[100:103],a[36:39],v[76:79]
v_cndmask_b32 v72, v32, v8, s[74:75]
v_cndmask_b32 v73, v32, v8, s[76:77]
M v[76:79],a[104:107],a[40:43],v[76:79]
v_cndmask_b32 v74, v32, v8, s[78:79]
AF v28,v21,v28
M v[76:79],a[108:111],a[44:47],v[76:79]
R a[72:75],v2,51200
R a[76:79],v2,52224
M v[76:79],a[112:115],a[48:51],v[76:79]
buffer_load_dwordx4 v3, s[8:11], s26 offen offset:2048 sc1 lds
M v[76:79],a[116:119],a[52:55],v[76:79]
v_cndmask_b32 v75, v32, v8, s[80:81]
M v[76:79],a[120:123],a[56:59],v[76:79]
s_cmp_lt_u32 s20, 2
R a[80:83],v2,53248
R a[84:87],v2,54272
M v[76:79],a[124:127],a[60:63],v[76:79]
s_cselect_b64 s[82:83], -1, 0
E v23,v121
M v[72:75],a[124:127],a[28:31],v[72:75]
s_cmp_eq_u32 s20, 2
buffer_load_dwordx4 v3, s[8:11], s26 offen offset:3072 sc1 lds
M v[72:75],a[120:123],a[24:27],v[72:75]
s_cselect_b64 s[66:67], s[16:17], s[82:83]
R a[88:91],v2,55296
R a[92:95],v2,56320
M v[72:75],a[116:119],a[20:23],v[72:75]
s_cselect_b64 s[68:69], s[18:19], s[82:83]
E v24,v122
M v[72:75],a[112:115],a[16:19],v[72:75]
s_cselect_b64 s[70:71], s[48:49], s[82:83]
E v25,v123
M v[72:75],a[108:111],a[12:15],v[72:75]
s_cselect_b64 s[72:73], s[50:51], s[82:83]
v_cndmask_b32 v80, v32, v8, s[66:67]
v_cndmask_b32 v81, v32, v8, s[68:69]
M v[72:75],a[104:107],a[8:11],v[72:75]
SA m0,s28,4096
E v18,v116
M v[72:75],a[100:103],a[4:7],v[72:75]
s_lshl_b32 s86, s20, 14
buffer_load_dwordx4 v4, s[8:11], s26 offen offset:0 sc1 lds
M v[72:75],a[96:99],a[0:3],v[72:75]
s_waitcnt lgkmcnt(0)
v_cndmask_b32 v82, v32, v8, s[70:71]
AF v28,v22,v28
M v[84:87],a[64:67],a[32:35],v[36:39]
SA s86,s86,s34
R a[96:99],v2,57344
R a[100:103],v2,58368
M v[84:87],a[68:71],a[36:39],v[84:87]
SA s87,s86,4096
buffer_load_dwordx4 v4, s[8:11], s26 offen offset:1024 sc1 lds
M v[84:87],a[72:75],a[40:43],v[84:87]
SA s88,s86,8192
v_cndmask_b32 v83, v32, v8, s[72:73]
C v58,v22,v23
M v[84:87],a[76:79],a[44:47],v[84:87]
s_cmp_lt_u32 s20, 3
R a[104:107],v2,59392
R a[108:111],v2,60416
M v[84:87],a[80:83],a[48:51],v[84:87]
s_cselect_b64 s[82:83], -1, 0
E v19,v117
M v[84:87],a[84:87],a[52:55],v[84:87]
SA s89,s86,12288
buffer_load_dwordx4 v4, s[8:11], s26 offen offset:2048 sc1 lds
M v[84:87],a[88:91],a[56:59],v[84:87]
s_lshl_b32 s90, s20, 10
R a[112:115],v2,61440
R a[116:119],v2,62464
M v[84:87],a[92:95],a[60:63],v[84:87]
SA s90,s90,s34
E v20,v118
M v[80:83],a[92:95],a[28:31],v[80:83]
SA s90,s90,65536
E v21,v119
M v[80:83],a[88:91],a[24:27],v[80:83]
s_cmp_eq_u32 s20, 3
R a[120:123],v2,63488
R a[124:127],v2,64512
M v[80:83],a[84:87],a[20:23],v[80:83]
s_cselect_b64 s[74:75], s[16:17], s[82:83]
buffer_load_dwordx4 v4, s[8:11], s26 offen offset:3072 sc1 lds
M v[80:83],a[80:83],a[16:19],v[80:83]
s_cselect_b64 s[76:77], s[18:19], s[82:83]
AF v28,v23,v28
AF v28,v24,v28
M v[80:83],a[76:79],a[12:15],v[80:83]
s_cselect_b64 s[78:79], s[48:49], s[82:83]
E v22,v124
M v[80:83],a[72:75],a[8:11],v[80:83]
s_cselect_b64 s[80:81], s[50:51], s[82:83]
v_cndmask_b32 v88, v32, v8, s[74:75]
v_cndmask_b32 v89, v32, v8, s[76:77]
M v[80:83],a[68:71],a[4:7],v[80:83]
s_waitcnt vmcnt(17) lgkmcnt(0)
v_cndmask_b32 v90, v32, v8, s[78:79]
v_cndmask_b32 v91, v32, v8, s[80:81]
M v[80:83],a[64:67],a[0:3],v[80:83]
s_barrier
M v[92:95],a[96:99],a[32:35],v[36:39]
SA s26,s26,32768
R a[64:67],v7,32768
R a[68:71],v7,33792
M v[92:95],a[100:103],a[36:39],v[92:95]
SA m0,s28,131072
E v23,v125
M v[92:95],a[104:107],a[40:43],v[92:95]
buffer_load_dwordx4 v3, s[8:11], s26 offen offset:0 sc1 lds
M v[92:95],a[108:111],a[44:47],v[92:95]
R a[72:75],v7,34816
R a[76:79],v7,35840
M v[92:95],a[112:115],a[48:51],v[92:95]
C v59,v24,v25
AF v28,v25,v28
M v[92:95],a[116:119],a[52:55],v[92:95]
buffer_load_dwordx4 v3, s[8:11], s26 offen offset:1024 sc1 lds
M v[92:95],a[120:123],a[56:59],v[92:95]
R a[80:83],v7,36864
R a[84:87],v7,37888
M v[92:95],a[124:127],a[60:63],v[92:95]
E v24,v126
M v[88:91],a[124:127],a[28:31],v[88:91]
buffer_load_dwordx4 v3, s[8:11], s26 offen offset:2048 sc1 lds
M v[88:91],a[120:123],a[24:27],v[88:91]
R a[88:91],v7,38912
R a[92:95],v7,39936
M v[88:91],a[116:119],a[20:23],v[88:91]
E v25,v127
M v[88:91],a[112:115],a[16:19],v[88:91]
buffer_load_dwordx4 v3, s[8:11], s26 offen offset:3072 sc1 lds
M v[88:91],a[108:111],a[12:15],v[88:91]
AF v29,v18,v29
C v60,v18,v19
M v[88:91],a[104:107],a[8:11],v[88:91]
AF v29,v19,v29
AF v29,v20,v29
M v[88:91],a[100:103],a[4:7],v[88:91]
s_waitcnt lgkmcnt(0)
C v61,v20,v21
AF v29,v21,v29
M v[88:91],a[96:99],a[0:3],v[88:91]
AF v29,v22,v29
C v62,v22,v23
AF v29,v23,v29
AF v29,v24,v29
C v63,v24,v25
AF v29,v25,v29
v_max_f32 v10, v28, v29
v_cmp_lt_f32 vcc, s31, v10
s_nop 0
s_cbranch_vccnz L_std1
L_rtd1:
s_cmp_lt_u32 s42, 6
s_cbranch_scc1 L_d2h
M v[128:131],a[64:67],v[48:51],v[128:131]
R a[96:99],v7,40960
R a[100:103],v7,41984
M v[128:131],a[68:71],v[56:59],v[128:131]
SA m0,s28,135168
E v18,v64
M v[132:135],a[68:71],v[60:63],v[132:135]
buffer_load_dwordx4 v4, s[8:11], s26 offen offset:0 sc1 lds
M v[132:135],a[64:67],v[52:55],v[132:135]
R a[104:107],v7,43008
R a[108:111],v7,44032
M v[136:139],a[72:75],v[48:51],v[136:139]
s_cmp_gt_u32 s20, 3
E v19,v65
M v[136:139],a[76:79],v[56:59],v[136:139]
s_cselect_b64 s[82:83], -1, 0
AF v30,v28,v30
AF v31,v29,v31
M v[140:143],a[76:79],v[60:63],v[140:143]
s_cmp_eq_u32 s20, 3
R a[112:115],v7,45056
R a[116:119],v7,46080
M v[140:143],a[72:75],v[52:55],v[140:143]
s_cselect_b64 s[66:67], s[16:17], s[82:83]
buffer_load_dwordx4 v4, s[8:11], s26 offen offset:1024 sc1 lds
M v[144:147],a[80:83],v[48:51],v[144:147]
s_cselect_b64 s[68:69], s[18:19], s[82:83]
E v20,v66
M v[144:147],a[84:87],v[56:59],v[144:147]
s_cselect_b64 s[70:71], s[48:49], s[82:83]
R a[120:123],v7,47104
R a[124:127],v7,48128
M v[148:151],a[84:87],v[60:63],v[148:151]
s_cselect_b64 s[72:73], s[50:51], s[82:83]
v_cndmask_b32 v100, v36, v8, s[66:67]
v_cndmask_b32 v101, v36, v8, s[68:69]
M v[148:151],a[80:83],v[52:55],v[148:151]
buffer_load_dwordx4 v4, s[8:11], s26 offen offset:2048 sc1 lds
M v[152:155],a[88:91],v[48:51],v[152:155]
v_cndmask_b32 v102, v36, v8, s[70:71]
AF v26,v18,v19
M v[152:155],a[92:95],v[56:59],v[152:155]
E v21,v67
M v[156:159],a[92:95],v[60:63],v[156:159]
v_cndmask_b32 v103, v36, v8, s[72:73]
C v40,v18,v19
M v[156:159],a[88:91],v[52:55],v[156:159]
s_waitcnt lgkmcnt(0)
buffer_load_dwordx4 v4, s[8:11], s26 offen offset:3072 sc1 lds
M v[160:163],a[96:99],v[48:51],v[160:163]
s_cmp_gt_u32 s20, 2
R a[64:67],v7,49152
R a[68:71],v7,50176
M v[160:163],a[100:103],v[56:59],v[160:163]
s_cselect_b64 s[82:83], -1, 0
v_lshrrev_b32 v14, 7, v7
AF v26,v20,v26
M v[164:167],a[100:103],v[60:63],v[164:167]
s_cmp_eq_u32 s20, 2
v_mul_u32_u24 v14, 896, v14
C v41,v20,v21
M v[164:167],a[96:99],v[52:55],v[164:167]
s_cselect_b64 s[74:75], s[16:17], s[82:83]
R a[72:75],v7,51200
R a[76:79],v7,52224
M v[168:171],a[104:107],v[48:51],v[168:171]
s_cselect_b64 s[76:77], s[18:19], s[82:83]
v_lshrrev_b32 v15, 8, v7
AF v26,v21,v26
M v[168:171],a[108:111],v[56:59],v[168:171]
s_cselect_b64 s[78:79], s[48:49], s[82:83]
v_lshlrev_b32 v15, 5, v15
M v[172:175],a[108:111],v[60:63],v[172:175]
s_cselect_b64 s[80:81], s[50:51], s[82:83]
R a[80:83],v7,53248
R a[84:87],v7,54272
M v[172:175],a[104:107],v[52:55],v[172:175]
v_cndmask_b32 v108, v36, v8, s[74:75]
v_cndmask_b32 v109, v36, v8, s[76:77]
M v[176:179],a[112:115],v[48:51],v[176:179]
v_xor_b32 v15, v15, v7
M v[176:179],a[116:119],v[56:59],v[176:179]
R a[88:91],v7,55296
R a[92:95],v7,56320
M v[180:183],a[116:119],v[60:63],v[180:183]
v_and_b32 v15, 0x70, v15
v_cndmask_b32 v110, v36, v8, s[78:79]
M v[180:183],a[112:115],v[52:55],v[180:183]
v_add_u32 v0, v14, v15
M v[184:187],a[120:123],v[48:51],v[184:187]
s_mul_i32 s38, s20, 57344
v_cndmask_b32 v111, v36, v8, s[80:81]
M v[184:187],a[124:127],v[56:59],v[184:187]
s_cmp_gt_u32 s20, 1
E v22,v72
M v[188:191],a[124:127],v[60:63],v[188:191]
s_cselect_b64 s[82:83], -1, 0
E v23,v73
M v[188:191],a[120:123],v[52:55],v[188:191]
s_waitcnt lgkmcnt(0)
E v24,v74
M v[192:195],a[64:67],v[48:51],v[192:195]
SA m0,s28,98304
R a[96:99],v7,57344
R a[100:103],v7,58368
M v[192:195],a[68:71],v[56:59],v[192:195]
s_cmp_eq_u32 s20, 1
E v25,v75
M v[196:199],a[68:71],v[60:63],v[196:199]
s_cselect_b64 s[66:67], s[16:17], s[82:83]
E v18,v68
M v[196:199],a[64:67],v[52:55],v[196:199]
s_cselect_b64 s[68:69], s[18:19], s[82:83]
R a[104:107],v7,59392
R a[108:111],v7,60416
M v[200:203],a[72:75],v[48:51],v[200:203]
s_cselect_b64 s[70:71], s[48:49], s[82:83]
E v19,v69
M v[200:203],a[76:79],v[56:59],v[200:203]
s_cselect_b64 s[72:73], s[50:51], s[82:83]
v_cndmask_b32 v116, v36, v8, s[66:67]
v_cndmask_b32 v117, v36, v8, s[68:69]
M v[204:207],a[76:79],v[60:63],v[204:207]
SA s85,s38,0
R a[112:115],v7,61440
R a[116:119],v7,62464
M v[204:207],a[72:75],v[52:55],v[204:207]
buffer_load_dwordx4 v0, s[12:15], s85 offen offset:0 lds
M v[208:211],a[80:83],v[48:51],v[208:211]
SA s85,s38,6144
v_cndmask_b32 v118, v36, v8, s[70:71]
AF v26,v22,v26
M v[208:211],a[84:87],v[56:59],v[208:211]
R a[120:123],v7,63488
R a[124:127],v7,64512
M v[212:215],a[84:87],v[60:63],v[212:215]
buffer_load_dwordx4 v0, s[12:15], s85 offen offset:1024 lds
M v[212:215],a[80:83],v[52:55],v[212:215]
SA s85,s38,12288
v_cndmask_b32 v119, v36, v8, s[72:73]
C v42,v22,v23
M v[216:219],a[88:91],v[48:51],v[216:219]
s_cmp_gt_u32 s20, 0
E v20,v70
M v[216:219],a[92:95],v[56:59],v[216:219]
s_cselect_b64 s[82:83], -1, 0
buffer_load_dwordx4 v0, s[12:15], s85 offen offset:2048 lds
M v[220:223],a[92:95],v[60:63],v[220:223]
s_waitcnt vmcnt(20) lgkmcnt(0)
E v21,v71
M v[220:223],a[88:91],v[52:55],v[220:223]
s_barrier
M v[224:227],a[96:99],v[48:51],v[224:227]
SA s85,s38,18432
R a[64:67],v2,0
R a[68:71],v2,1024
M v[224:227],a[100:103],v[56:59],v[224:227]
s_cmp_eq_u32 s20, 0
buffer_load_dwordx4 v0, s[12:15], s85 offen offset:3072 lds
M v[228:231],a[100:103],v[60:63],v[228:231]
s_cselect_b64 s[74:75], s[16:17], s[82:83]
AF v26,v23,v26
AF v26,v24,v26
M v[228:231],a[96:99],v[52:55],v[228:231]
s_cselect_b64 s[76:77], s[18:19], s[82:83]
R a[72:75],v2,2048
R a[76:79],v2,3072
M v[232:235],a[104:107],v[48:51],v[232:235]
s_cselect_b64 s[78:79], s[48:49], s[82:83]
E v22,v76
M v[232:235],a[108:111],v[56:59],v[232:235]
s_cselect_b64 s[80:81], s[50:51], s[82:83]
v_cndmask_b32 v124, v36, v8, s[74:75]
v_cndmask_b32 v125, v36, v8, s[76:77]
M v[236:239],a[108:111],v[60:63],v[236:239]
SA m0,s28,102400
R a[80:83],v2,4096
R a[84:87],v2,5120
M v[236:239],a[104:107],v[52:55],v[236:239]
SA s85,s38,28672
buffer_load_dwordx4 v0, s[12:15], s85 offen offset:0 lds
M v[240:243],a[112:115],v[48:51],v[240:243]
SA s85,s38,34816
v_cndmask_b32 v126, v36, v8, s[78:79]
v_cndmask_b32 v127, v36, v8, s[80:81]
M v[240:243],a[116:119],v[56:59],v[240:243]
R a[88:91],v2,6144
R a[92:95],v2,7168
M v[244:247],a[116:119],v[60:63],v[244:247]
buffer_load_dwordx4 v0, s[12:15], s85 offen offset:1024 lds
M v[244:247],a[112:115],v[52:55],v[244:247]
SA s85,s38,40960
E v23,v77
M v[248:251],a[120:123],v[48:51],v[248:251]
buffer_load_dwordx4 v0, s[12:15], s85 offen offset:2048 lds
M v[248:251],a[124:127],v[56:59],v[248:251]
SA s85,s38,47104
C v43,v24,v25
AF v26,v25,v26
M v[252:255],a[124:127],v[60:63],v[252:255]
s_waitcnt lgkmcnt(0)
E v24,v78
M v[252:255],a[120:123],v[52:55],v[252:255]
buffer_load_dwordx4 v0, s[12:15], s85 offen offset:3072 lds
SA s38,s38,128
AF v27,v18,v19
C v44,v18,v19
AF v27,v20,v27
C v45,v20,v21
AF v27,v21,v27
E v25,v79
AF v27,v22,v27
C v46,v22,v23
AF v27,v23,v27
AF v27,v24,v27
C v47,v24,v25
AF v27,v25,v27
M v[100:103],a[64:67],a[32:35],v[100:103]
R a[96:99],v2,8192
R a[100:103],v2,9216
M v[100:103],a[68:71],a[36:39],v[100:103]
R a[104:107],v2,10240
R a[108:111],v2,11264
M v[100:103],a[72:75],a[40:43],v[100:103]
R a[112:115],v2,12288
R a[116:119],v2,13312
M v[100:103],a[76:79],a[44:47],v[100:103]
R a[120:123],v2,14336
R a[124:127],v2,15360
M v[100:103],a[80:83],a[48:51],v[100:103]
v_add_u32 v8, 0x20000, v7
M v[100:103],a[84:87],a[52:55],v[100:103]
SA m0,s28,32768
E v18,v80
M v[100:103],a[88:91],a[56:59],v[100:103]
SA s85,s38,0
buffer_load_dwordx4 v0, s[12:15], s85 offen offset:0 lds
M v[100:103],a[92:95],a[60:63],v[100:103]
s_waitcnt lgkmcnt(0)
E v19,v81
M v[108:111],a[96:99],a[32:35],v[108:111]
SA s85,s38,6144
R a[64:67],v2,16384
R a[68:71],v2,17408
M v[108:111],a[100:103],a[36:39],v[108:111]
R a[72:75],v2,18432
R a[76:79],v2,19456
M v[108:111],a[104:107],a[40:43],v[108:111]
R a[80:83],v2,20480
R a[84:87],v2,21504
M v[108:111],a[108:111],a[44:47],v[108:111]
R a[88:91],v2,22528
R a[92:95],v2,23552
M v[108:111],a[112:115],a[48:51],v[108:111]
buffer_load_dwordx4 v0, s[12:15], s85 offen offset:1024 lds
M v[108:111],a[116:119],a[52:55],v[108:111]
SA s85,s38,12288
E v20,v82
M v[108:111],a[120:123],a[56:59],v[108:111]
buffer_load_dwordx4 v0, s[12:15], s85 offen offset:2048 lds
M v[108:111],a[124:127],a[60:63],v[108:111]
s_waitcnt lgkmcnt(0)
E v21,v83
M v[116:119],a[64:67],a[32:35],v[116:119]
SA s85,s38,18432
R a[96:99],v2,24576
R a[100:103],v2,25600
M v[116:119],a[68:71],a[36:39],v[116:119]
R a[104:107],v2,26624
R a[108:111],v2,27648
M v[116:119],a[72:75],a[40:43],v[116:119]
R a[112:115],v2,28672
R a[116:119],v2,29696
M v[116:119],a[76:79],a[44:47],v[116:119]
R a[120:123],v2,30720
R a[124:127],v2,31744
M v[116:119],a[80:83],a[48:51],v[116:119]
buffer_load_dwordx4 v0, s[12:15], s85 offen offset:3072 lds
M v[116:119],a[84:87],a[52:55],v[116:119]
buffer_load_dword v6, off, s[8:11], s47 sc1
M v[116:119],a[88:91],a[56:59],v[116:119]
s_waitcnt vmcnt(21) lgkmcnt(0)
E v22,v88
M v[116:119],a[92:95],a[60:63],v[116:119]
s_barrier
M v[124:127],a[96:99],a[32:35],v[124:127]
R a[64:67],v7,0
R a[68:71],v7,1024
M v[124:127],a[100:103],a[36:39],v[124:127]
R a[72:75],v7,2048
R a[76:79],v7,3072
M v[124:127],a[104:107],a[40:43],v[124:127]
R a[80:83],v7,4096
R a[84:87],v7,5120
M v[124:127],a[108:111],a[44:47],v[124:127]
R a[88:91],v7,6144
R a[92:95],v7,7168
M v[124:127],a[112:115],a[48:51],v[124:127]
E v23,v89
M v[124:127],a[116:119],a[52:55],v[124:127]
E v24,v90
M v[124:127],a[120:123],a[56:59],v[124:127]
s_waitcnt lgkmcnt(0)
E v25,v91
M v[124:127],a[124:127],a[60:63],v[124:127]
AF v26,v18,v26
C v56,v18,v19
AF v26,v19,v26
AF v26,v20,v26
C v57,v20,v21
AF v26,v21,v26
AF v26,v22,v26
C v58,v22,v23
AF v26,v23,v26
E v18,v84
E v19,v85
AF v26,v24,v26
C v59,v24,v25
AF v26,v25,v26
E v20,v86
E v21,v87
AF v27,v18,v27
C v60,v18,v19
AF v27,v19,v27
E v22,v92
E v23,v93
AF v27,v20,v27
C v61,v20,v21
AF v27,v21,v27
E v24,v94
E v25,v95
AF v27,v22,v27
C v62,v22,v23
AF v27,v23,v27
AF v27,v24,v27
C v63,v24,v25
AF v27,v25,v27
v_max_f32 v10, v26, v27
v_cmp_lt_f32 vcc, s31, v10
s_nop 0
s_cbranch_vccnz L_std3n
L_rtd3n:
M v[128:131],a[64:67],v[40:43],v[128:131]
R a[96:99],v7,8192
R a[100:103],v7,9216
M v[128:131],a[68:71],v[56:59],v[128:131]
v_or_b32 v9, s35, v7
s_waitcnt vmcnt(0)
v_cmp_ne_u32 vcc, 1, v6
M v[132:135],a[68:71],v[60:63],v[132:135]
s_cbranch_vccnz L_fps
L_fpr:
E v18,v100
M v[132:135],a[64:67],v[44:47],v[132:135]
R a[104:107],v7,10240
R a[108:111],v7,11264
M v[136:139],a[72:75],v[40:43],v[136:139]
buffer_load_dwordx4 v[14:17], v9, s[8:11], s90 offen sc1
M v[136:139],a[76:79],v[56:59],v[136:139]
E v19,v101
M v[140:143],a[76:79],v[60:63],v[140:143]
R a[112:115],v7,12288
R a[116:119],v7,13312
M v[140:143],a[72:75],v[44:47],v[140:143]
buffer_load_dwordx4 a[160:163], v9, s[8:11], s88 offen offset:0 sc1
M v[144:147],a[80:83],v[40:43],v[144:147]
E v20,v102
M v[144:147],a[84:87],v[56:59],v[144:147]
R a[120:123],v7,14336
R a[124:127],v7,15360
M v[148:151],a[84:87],v[60:63],v[148:151]
buffer_load_dwordx4 a[128:131], v9, s[8:11], s86 offen offset:0 sc1
M v[148:151],a[80:83],v[44:47],v[148:151]
E v21,v103
M v[152:155],a[88:91],v[40:43],v[152:155]
AF v30,v26,v30
AF v31,v27,v31
M v[152:155],a[92:95],v[56:59],v[152:155]
buffer_load_dwordx4 a[164:167], v9, s[8:11], s88 offen offset:1024 sc1
M v[156:159],a[92:95],v[60:63],v[156:159]
AF v29,v18,v19
C v52,v18,v19
M v[156:159],a[88:91],v[44:47],v[156:159]
s_waitcnt lgkmcnt(0)
E v22,v108
M v[160:163],a[96:99],v[40:43],v[160:163]
R a[64:67],v7,16384
R a[68:71],v7,17408
M v[160:163],a[100:103],v[56:59],v[160:163]
buffer_load_dwordx4 a[132:135], v9, s[8:11], s86 offen offset:1024 sc1
M v[164:167],a[100:103],v[60:63],v[164:167]
E v23,v109
M v[164:167],a[96:99],v[44:47],v[164:167]
R a[72:75],v7,18432
R a[76:79],v7,19456
M v[168:171],a[104:107],v[40:43],v[168:171]
buffer_load_dwordx4 a[168:171], v9, s[8:11], s88 offen offset:2048 sc1
M v[168:171],a[108:111],v[56:59],v[168:171]
AF v29,v20,v29
C v53,v20,v21
M v[172:175],a[108:111],v[60:63],v[172:175]
R a[80:83],v7,20480
R a[84:87],v7,21504
M v[172:175],a[104:107],v[44:47],v[172:175]
buffer_load_dwordx4 a[136:139], v9, s[8:11], s86 offen offset:2048 sc1
M v[176:179],a[112:115],v[40:43],v[176:179]
E v24,v110
M v[176:179],a[116:119],v[56:59],v[176:179]
R a[88:91],v7,22528
R a[92:95],v7,23552
M v[180:183],a[116:119],v[60:63],v[180:183]
buffer_load_dwordx4 a[172:175], v9, s[8:11], s88 offen offset:3072 sc1
M v[180:183],a[112:115],v[44:47],v[180:183]
E v25,v111
M v[184:187],a[120:123],v[40:43],v[184:187]
AF v29,v21,v29
AF v29,v22,v29
M v[184:187],a[124:127],v[56:59],v[184:187]
buffer_load_dwordx4 a[140:143], v9, s[8:11], s86 offen offset:3072 sc1
M v[188:191],a[124:127],v[60:63],v[188:191]
E v18,v116
M v[188:191],a[120:123],v[44:47],v[188:191]
s_waitcnt lgkmcnt(0)
C v54,v22,v23
AF v29,v23,v29
M v[192:195],a[64:67],v[40:43],v[192:195]
R a[96:99],v7,24576
R a[100:103],v7,25600
M v[192:195],a[68:71],v[56:59],v[192:195]
buffer_load_dwordx4 a[176:179], v9, s[8:11], s89 offen offset:0 sc1
M v[196:199],a[68:71],v[60:63],v[196:199]
E v19,v117
M v[196:199],a[64:67],v[44:47],v[196:199]
R a[104:107],v7,26624
R a[108:111],v7,27648
M v[200:203],a[72:75],v[40:43],v[200:203]
buffer_load_dwordx4 a[144:147], v9, s[8:11], s87 offen offset:0 sc1
M v[200:203],a[76:79],v[56:59],v[200:203]
E v20,v118
M v[204:207],a[76:79],v[60:63],v[204:207]
R a[112:115],v7,28672
R a[116:119],v7,29696
M v[204:207],a[72:75],v[44:47],v[204:207]
buffer_load_dwordx4 a[180:183], v9, s[8:11], s89 offen offset:1024 sc1
M v[208:211],a[80:83],v[40:43],v[208:211]
AF v29,v24,v29
C v55,v24,v25
M v[208:211],a[84:87],v[56:59],v[208:211]
R a[120:123],v7,30720
R a[124:127],v7,31744
M v[212:215],a[84:87],v[60:63],v[212:215]
buffer_load_dwordx4 a[148:151], v9, s[8:11], s87 offen offset:1024 sc1
M v[212:215],a[80:83],v[44:47],v[212:215]
E v21,v119
M v[216:219],a[88:91],v[40:43],v[216:219]
AF v29,v25,v29
AF v29,v18,v29
M v[216:219],a[92:95],v[56:59],v[216:219]
buffer_load_dwordx4 a[184:187], v9, s[8:11], s89 offen offset:2048 sc1
M v[220:223],a[92:95],v[60:63],v[220:223]
s_waitcnt lgkmcnt(0)
E v22,v124
M v[220:223],a[88:91],v[44:47],v[220:223]
s_barrier
M v[224:227],a[96:99],v[40:43],v[224:227]
R a[64:67],v8,0
R a[68:71],v8,1024
M v[224:227],a[100:103],v[56:59],v[224:227]
buffer_load_dwordx4 a[152:155], v9, s[8:11], s87 offen offset:2048 sc1
M v[228:231],a[100:103],v[60:63],v[228:231]
E v23,v125
M v[228:231],a[96:99],v[44:47],v[228:231]
R a[72:75],v8,2048
R a[76:79],v8,3072
M v[232:235],a[104:107],v[40:43],v[232:235]
buffer_load_dwordx4 a[188:191], v9, s[8:11], s89 offen offset:3072 sc1
M v[232:235],a[108:111],v[56:59],v[232:235]
E v24,v126
M v[236:239],a[108:111],v[60:63],v[236:239]
R a[80:83],v8,4096
R a[84:87],v8,5120
M v[236:239],a[104:107],v[44:47],v[236:239]
buffer_load_dwordx4 a[156:159], v9, s[8:11], s87 offen offset:3072 sc1
M v[240:243],a[112:115],v[40:43],v[240:243]
E v25,v127
M v[240:243],a[116:119],v[56:59],v[240:243]
R a[88:91],v8,6144
R a[92:95],v8,7168
M v[244:247],a[116:119],v[60:63],v[244:247]
C v48,v18,v19
AF v29,v19,v29
M v[244:247],a[112:115],v[44:47],v[244:247]
AF v29,v20,v29
C v49,v20,v21
M v[248:251],a[120:123],v[40:43],v[248:251]
AF v29,v21,v29
AF v29,v22,v29
M v[248:251],a[124:127],v[56:59],v[248:251]
C v50,v22,v23
AF v29,v23,v29
M v[252:255],a[124:127],v[60:63],v[252:255]
s_waitcnt lgkmcnt(0)
AF v29,v24,v29
C v51,v24,v25
M v[252:255],a[120:123],v[44:47],v[252:255]
AF v29,v25,v29
v_cmp_lt_f32 vcc, s31, v29
s_nop 0
s_cbranch_vccnz L_std4n
L_rtd4n:
s_waitcnt vmcnt(16)
v_cmp_neq_f32 vcc, v32, v14
v_cmp_neq_f32 s[64:65], v36, v15
s_cmp_eq_u32 s35, 0
s_cselect_b64 s[66:67], -1, 0
s_or_b64 vcc, vcc, s[64:65]
s_and_b64 vcc, vcc, s[66:67]
s_cbranch_vccnz L_stc
L_rtc:
M v[132:135],a[64:67],v[52:55],v[132:135]
R a[96:99],v8,8192
R a[100:103],v8,9216
M v[132:135],a[68:71],v[48:51],v[132:135]
s_waitcnt vmcnt(12)
AF v30,v16,v30
AF v31,v17,v31
M v[132:135],a[246:249],a[160:163],v[132:135]
SA m0,s28,36864
AF v31,v29,v31
v_mov_b32 v10, v30
M v[128:131],a[246:249],a[128:131],v[128:131]
SA s85,s38,28672
R a[104:107],v8,10240
R a[108:111],v8,11264
M v[140:143],a[72:75],v[52:55],v[140:143]
buffer_load_dwordx4 v0, s[12:15], s85 offen offset:0 lds
M v[140:143],a[76:79],v[48:51],v[140:143]
SA s85,s38,34816
v_mov_b32 v11, v31
M v[140:143],a[244:247],a[160:163],v[140:143]
R a[112:115],v8,12288
R a[116:119],v8,13312
M v[136:139],a[244:247],a[128:131],v[136:139]
v_permlane16_swap_b32 v10, v30
M v[148:151],a[80:83],v[52:55],v[148:151]
v_permlane16_swap_b32 v11, v31
M v[148:151],a[84:87],v[48:51],v[148:151]
R a[120:123],v8,14336
R a[124:127],v8,15360
M v[148:151],a[246:249],a[164:167],v[148:151]
buffer_load_dwordx4 v0, s[12:15], s85 offen offset:1024 lds
M v[144:147],a[246:249],a[132:135],v[144:147]
SA s85,s38,40960
AF v30,v10,v30
AF v31,v11,v31
M v[156:159],a[88:91],v[52:55],v[156:159]
v_mov_b32 v10, v30
v_mov_b32 v11, v31
M v[156:159],a[92:95],v[48:51],v[156:159]
buffer_load_dwordx4 v0, s[12:15], s85 offen offset:2048 lds
M v[156:159],a[244:247],a[164:167],v[156:159]
s_waitcnt vmcnt(11)
v_permlane32_swap_b32 v10, v30
M v[152:155],a[244:247],a[132:135],v[152:155]
s_waitcnt lgkmcnt(0)
v_permlane32_swap_b32 v11, v31
M v[164:167],a[96:99],v[52:55],v[164:167]
SA s85,s38,47104
R a[64:67],v8,16384
R a[68:71],v8,17408
M v[164:167],a[100:103],v[48:51],v[164:167]
buffer_load_dwordx4 v0, s[12:15], s85 offen offset:3072 lds
M v[164:167],a[246:249],a[168:171],v[164:167]
SA s38,s38,128
C v132,v132,v133
C v133,v134,v135
M v[160:163],a[246:249],a[136:139],v[160:163]
SA m0,s28,65536
R a[72:75],v8,18432
R a[76:79],v8,19456
AF v30,v10,v30
AF v31,v11,v31
v_rcp_f32 v5, v30
v_rcp_f32 v6, v31
M v[172:175],a[104:107],v[52:55],v[172:175]
SA s85,s38,0
buffer_load_dwordx4 v0, s[12:15], s85 offen offset:0 lds
M v[172:175],a[108:111],v[48:51],v[172:175]
SA s85,s38,6144
C v134,v140,v141
C v135,v142,v143
M v[172:175],a[244:247],a[168:171],v[172:175]
R a[80:83],v8,20480
R a[84:87],v8,21504
M v[168:171],a[244:247],a[136:139],v[168:171]
buffer_load_dwordx4 v0, s[12:15], s85 offen offset:1024 lds
M v[180:183],a[112:115],v[52:55],v[180:183]
SA s85,s38,12288
C v128,v128,v129
C v129,v130,v131
M v[180:183],a[116:119],v[48:51],v[180:183]
R a[88:91],v8,22528
R a[92:95],v8,23552
M v[180:183],a[246:249],a[172:175],v[180:183]
buffer_load_dwordx4 v0, s[12:15], s85 offen offset:2048 lds
M v[176:179],a[246:249],a[140:143],v[176:179]
SA s85,s38,18432
C v130,v136,v137
C v131,v138,v139
M v[188:191],a[120:123],v[52:55],v[188:191]
C v148,v148,v149
C v149,v150,v151
M v[188:191],a[124:127],v[48:51],v[188:191]
buffer_load_dwordx4 v0, s[12:15], s85 offen offset:3072 lds
M v[188:191],a[244:247],a[172:175],v[188:191]
s_waitcnt vmcnt(12)
C v150,v156,v157
C v151,v158,v159
M v[184:187],a[244:247],a[140:143],v[184:187]
s_waitcnt lgkmcnt(0)
C v144,v144,v145
C v145,v146,v147
M v[196:199],a[64:67],v[52:55],v[196:199]
SA m0,s28,69632
R a[96:99],v8,24576
R a[100:103],v8,25600
M v[196:199],a[68:71],v[48:51],v[196:199]
SA s85,s38,28672
buffer_load_dwordx4 v0, s[12:15], s85 offen offset:0 lds
M v[196:199],a[246:249],a[176:179],v[196:199]
SA s85,s38,34816
C v146,v152,v153
C v147,v154,v155
M v[192:195],a[246:249],a[144:147],v[192:195]
R a[104:107],v8,26624
R a[108:111],v8,27648
M v[204:207],a[72:75],v[52:55],v[204:207]
buffer_load_dwordx4 v0, s[12:15], s85 offen offset:1024 lds
M v[204:207],a[76:79],v[48:51],v[204:207]
SA s85,s38,40960
v_lshrrev_b32 v16, 4, v7
v_lshrrev_b32 v14, 2, v16
M v[204:207],a[244:247],a[176:179],v[204:207]
R a[112:115],v8,28672
R a[116:119],v8,29696
M v[200:203],a[244:247],a[144:147],v[200:203]
buffer_load_dwordx4 v0, s[12:15], s85 offen offset:2048 lds
M v[212:215],a[80:83],v[52:55],v[212:215]
SA s85,s38,47104
v_lshlrev_b32 v14, 7, v14
v_and_b32 v15, 3, v16
M v[212:215],a[84:87],v[48:51],v[212:215]
R a[120:123],v8,30720
R a[124:127],v8,31744
M v[212:215],a[246:249],a[180:183],v[212:215]
buffer_load_dwordx4 v0, s[12:15], s85 offen offset:3072 lds
M v[208:211],a[246:249],a[148:151],v[208:211]
SA s38,s38,128
v_lshl_add_u32 v14, v15, 3, v14
C v164,v164,v165
M v[220:223],a[88:91],v[52:55],v[220:223]
C v165,v166,v167
C v166,v172,v173
M v[220:223],a[92:95],v[48:51],v[220:223]
s_waitcnt vmcnt(12)
C v167,v174,v175
C v160,v160,v161
M v[220:223],a[244:247],a[180:183],v[220:223]
s_waitcnt lgkmcnt(0)
v_bfe_u32 v15, v16, 3, 2
v_lshl_add_u32 v18, v15, 5, v14
v_xor_b32 v19, 32, v18
v_xor_b32 v20, 64, v18
v_xor_b32 v21, 0x60, v18
v_add_u32 v22, 0x10000, v18
v_add_u32 v23, 0x10000, v19
v_add_u32 v24, 0x10000, v20
v_add_u32 v25, 0x10000, v21
M v[216:219],a[244:247],a[148:151],v[216:219]
s_barrier
M v[228:231],a[96:99],v[52:55],v[228:231]
s_nop 0
T a[64:65],v22,32768
T a[66:67],v22,34816
M v[228:231],a[100:103],v[48:51],v[228:231]
T a[68:69],v22,36864
T a[70:71],v22,38912
M v[228:231],a[246:249],a[184:187],v[228:231]
C v161,v162,v163
C v162,v168,v169
M v[224:227],a[246:249],a[152:155],v[224:227]
T a[72:73],v22,40960
T a[74:75],v22,43008
M v[236:239],a[104:107],v[52:55],v[236:239]
T a[76:77],v22,45056
T a[78:79],v22,47104
M v[236:239],a[108:111],v[48:51],v[236:239]
C v163,v170,v171
C v180,v180,v181
M v[236:239],a[244:247],a[184:187],v[236:239]
T a[80:81],v22,49152
T a[82:83],v22,51200
M v[232:235],a[244:247],a[152:155],v[232:235]
T a[84:85],v22,53248
T a[86:87],v22,55296
M v[244:247],a[112:115],v[52:55],v[244:247]
C v181,v182,v183
C v182,v188,v189
M v[244:247],a[116:119],v[48:51],v[244:247]
T a[88:89],v22,57344
T a[90:91],v22,59392
M v[244:247],a[246:249],a[188:191],v[244:247]
T a[92:93],v22,61440
T a[94:95],v22,63488
M v[240:243],a[246:249],a[156:159],v[240:243]
C v183,v190,v191
C v176,v176,v177
M v[252:255],a[120:123],v[52:55],v[252:255]
C v177,v178,v179
C v178,v184,v185
M v[252:255],a[124:127],v[48:51],v[252:255]
C v179,v186,v187
C v196,v196,v197
M v[252:255],a[244:247],a[188:191],v[252:255]
s_waitcnt lgkmcnt(0)
C v197,v198,v199
C v198,v204,v205
M v[248:251],a[244:247],a[156:159],v[248:251]
C v199,v206,v207
C v192,v192,v193
C v193,v194,v195
C v194,v200,v201
C v195,v202,v203
C v212,v212,v213
C v213,v214,v215
C v214,v220,v221
C v215,v222,v223
C v208,v208,v209
C v209,v210,v211
C v210,v216,v217
C v211,v218,v219
C v228,v228,v229
C v229,v230,v231
C v230,v236,v237
C v231,v238,v239
C v224,v224,v225
C v225,v226,v227
C v226,v232,v233
C v227,v234,v235
C v244,v244,v245
C v245,v246,v247
C v246,v252,v253
C v247,v254,v255
C v240,v240,v241
C v241,v242,v243
C v242,v248,v249
C v243,v250,v251
M v[64:67],a[64:67],v[128:131],0
s_sub_u32 s64, 15, s42
T a[96:97],v23,32768
T a[98:99],v23,34816
M v[64:67],a[68:71],v[144:147],v[64:67]
s_min_u32 s64, s64, s42
T a[100:101],v23,36864
T a[102:103],v23,38912
M v[64:67],a[72:75],v[160:163],v[64:67]
s_mul_i32 s45, s64, 8704
M v[64:67],a[76:79],v[176:179],v[64:67]
s_lshl_b32 s64, s41, 2
T a[104:105],v23,40960
T a[106:107],v23,43008
M v[64:67],a[80:83],v[192:195],v[64:67]
SA s45,s45,s64
T a[108:109],v23,45056
T a[110:111],v23,47104
M v[64:67],a[84:87],v[208:211],v[64:67]
s_lshl_b32 s64, s20, 8
M v[64:67],a[88:91],v[224:227],v[64:67]
SA s45,s45,s64
T a[112:113],v23,49152
T a[114:115],v23,51200
M v[64:67],a[92:95],v[240:243],v[64:67]
SA s45,s45,104992768
T a[116:117],v23,53248
T a[118:119],v23,55296
M v[68:71],a[92:95],v[244:247],0
s_mov_b32 s64, 1024
M v[68:71],a[88:91],v[228:231],v[68:71]
s_mov_b32 s66, 4096
T a[120:121],v23,57344
T a[122:123],v23,59392
M v[68:71],a[84:87],v[212:215],v[68:71]
s_cmp_lt_u32 s42, 8
T a[124:125],v23,61440
T a[126:127],v23,63488
M v[68:71],a[80:83],v[196:199],v[68:71]
s_cselect_b32 s64, 4352, s64
M v[68:71],a[76:79],v[180:183],v[68:71]
s_cselect_b32 s65, 0, 64
M v[68:71],a[72:75],v[164:167],v[68:71]
s_cselect_b32 s66, 536870912, s66
M v[68:71],a[68:71],v[148:151],v[68:71]
SA s3,s45,s64
M v[68:71],a[64:67],v[132:135],v[68:71]
s_waitcnt lgkmcnt(0)
M v[72:75],a[96:99],v[128:131],0
SA s45,s45,s65
T a[64:65],v24,32768
T a[66:67],v24,34816
M v[72:75],a[100:103],v[144:147],v[72:75]
SA m0,s28,0
T a[68:69],v24,36864
T a[70:71],v24,38912
M v[72:75],a[104:107],v[160:163],v[72:75]
SA s85,s38,0
buffer_load_dwordx4 v0, s[12:15], s85 offen offset:0 lds
M v[72:75],a[108:111],v[176:179],v[72:75]
SA s85,s38,6144
T a[72:73],v24,40960
T a[74:75],v24,43008
M v[72:75],a[112:115],v[192:195],v[72:75]
SA s29,s33,0
T a[76:77],v24,45056
T a[78:79],v24,47104
M v[72:75],a[116:119],v[208:211],v[72:75]
SA s30,s33,14336
buffer_load_dwordx4 v0, s[12:15], s85 offen offset:1024 lds
M v[72:75],a[120:123],v[224:227],v[72:75]
SA s85,s38,12288
T a[80:81],v24,49152
T a[82:83],v24,51200
M v[72:75],a[124:127],v[240:243],v[72:75]
T a[84:85],v24,53248
T a[86:87],v24,55296
M v[76:79],a[124:127],v[244:247],0
buffer_load_dwordx4 v0, s[12:15], s85 offen offset:2048 lds
M v[76:79],a[120:123],v[228:231],v[76:79]
SA s85,s38,18432
T a[88:89],v24,57344
T a[90:91],v24,59392
M v[76:79],a[116:119],v[212:215],v[76:79]
T a[92:93],v24,61440
T a[94:95],v24,63488
M v[76:79],a[112:115],v[196:199],v[76:79]
buffer_load_dwordx4 v0, s[12:15], s85 offen offset:3072 lds
M v[76:79],a[108:111],v[180:183],v[76:79]
SA m0,s28,4096
v_lshrrev_b32 v17, 5, v7
v_min_u32 v15, 1, v17
M v[76:79],a[104:107],v[164:167],v[76:79]
SA s85,s38,28672
buffer_load_dwordx4 v0, s[12:15], s85 offen offset:0 lds
M v[76:79],a[100:103],v[148:151],v[76:79]
SA s85,s38,34816
v_lshlrev_b32 v14, 3, v7
v_lshl_or_b32 v16, v15, 29, v14
M v[76:79],a[96:99],v[132:135],v[76:79]
s_waitcnt lgkmcnt(0)
buffer_load_dwordx4 v0, s[12:15], s85 offen offset:1024 lds
M v[80:83],a[64:67],v[128:131],0
SA s85,s38,40960
T a[96:97],v25,32768
T a[98:99],v25,34816
M v[80:83],a[68:71],v[144:147],v[80:83]
T a[100:101],v25,36864
T a[102:103],v25,38912
M v[80:83],a[72:75],v[160:163],v[80:83]
buffer_load_dwordx4 v0, s[12:15], s85 offen offset:2048 lds
M v[80:83],a[76:79],v[176:179],v[80:83]
SA s85,s38,47104
T a[104:105],v25,40960
T a[106:107],v25,43008
M v[80:83],a[80:83],v[192:195],v[80:83]
T a[108:109],v25,45056
T a[110:111],v25,47104
M v[80:83],a[84:87],v[208:211],v[80:83]
buffer_load_dwordx4 v0, s[12:15], s85 offen offset:3072 lds
M v[80:83],a[88:91],v[224:227],v[80:83]
SA s38,s38,128
T a[112:113],v25,49152
T a[114:115],v25,51200
M v[80:83],a[92:95],v[240:243],v[80:83]
SA m0,s28,131072
T a[116:117],v25,53248
T a[118:119],v25,55296
M v[84:87],a[92:95],v[244:247],0
SA s85,s38,0
buffer_load_dwordx4 v0, s[12:15], s85 offen offset:0 lds
M v[84:87],a[88:91],v[228:231],v[84:87]
SA s85,s38,6144
T a[120:121],v25,57344
T a[122:123],v25,59392
M v[84:87],a[84:87],v[212:215],v[84:87]
T a[124:125],v25,61440
T a[126:127],v25,63488
M v[84:87],a[80:83],v[196:199],v[84:87]
buffer_load_dwordx4 v0, s[12:15], s85 offen offset:1024 lds
M v[84:87],a[76:79],v[180:183],v[84:87]
SA s85,s38,12288
v_cmp_eq_u32 vcc, 1, v17
v_add_u32 v14, s66, v14
M v[84:87],a[72:75],v[164:167],v[84:87]
buffer_load_dwordx4 v0, s[12:15], s85 offen offset:2048 lds
M v[84:87],a[68:71],v[148:151],v[84:87]
s_waitcnt vmcnt(19) lgkmcnt(0)
v_mov_b32 v15, 1
v_cndmask_b32 v17, v16, v14, vcc
M v[84:87],a[64:67],v[132:135],v[84:87]
s_barrier
M v[88:91],a[96:99],v[128:131],0
SA s85,s38,18432
T a[64:65],v18,32768
T a[66:67],v18,34816
M v[88:91],a[100:103],v[144:147],v[88:91]
T a[68:69],v18,36864
T a[70:71],v18,38912
M v[88:91],a[104:107],v[160:163],v[88:91]
buffer_load_dwordx4 v0, s[12:15], s85 offen offset:3072 lds
M v[88:91],a[108:111],v[176:179],v[88:91]
SA m0,s28,135168
T a[72:73],v18,40960
T a[74:75],v18,43008
M v[88:91],a[112:115],v[192:195],v[88:91]
SA s85,s38,28672
T a[76:77],v18,45056
T a[78:79],v18,47104
M v[88:91],a[116:119],v[208:211],v[88:91]
buffer_load_dwordx4 v0, s[12:15], s85 offen offset:0 lds
M v[88:91],a[120:123],v[224:227],v[88:91]
SA s85,s38,34816
T a[80:81],v18,49152
T a[82:83],v18,51200
M v[88:91],a[124:127],v[240:243],v[88:91]
T a[84:85],v18,53248
T a[86:87],v18,55296
M v[92:95],a[124:127],v[244:247],0
buffer_load_dwordx4 v0, s[12:15], s85 offen offset:1024 lds
M v[92:95],a[120:123],v[228:231],v[92:95]
SA s85,s38,40960
T a[88:89],v18,57344
T a[90:91],v18,59392
M v[92:95],a[116:119],v[212:215],v[92:95]
T a[92:93],v18,61440
T a[94:95],v18,63488
M v[92:95],a[112:115],v[196:199],v[92:95]
buffer_load_dwordx4 v0, s[12:15], s85 offen offset:2048 lds
M v[92:95],a[108:111],v[180:183],v[92:95]
SA s85,s38,47104
v_add_u32 v40, 0x20000, v18
v_add_u32 v41, 0x20000, v19
M v[92:95],a[104:107],v[164:167],v[92:95]
buffer_load_dwordx4 v0, s[12:15], s85 offen offset:3072 lds
M v[92:95],a[100:103],v[148:151],v[92:95]
s_waitcnt lgkmcnt(0)
v_add_u32 v42, 0x20000, v20
v_add_u32 v43, 0x20000, v21
M v[92:95],a[96:99],v[132:135],v[92:95]
SA s38,s38,128
MF v64,v5,v64
MF v65,v5,v65
MF v66,v5,v66
MF v67,v5,v67
MF v72,v5,v72
MF v73,v5,v73
MF v74,v5,v74
MF v75,v5,v75
C v64,v64,v65
C v65,v66,v67
C v66,v72,v73
C v67,v74,v75
buffer_store_dwordx4 v[64:67], v7, s[8:11], s29 offen offset:0 sc1
MF v68,v6,v68
MF v69,v6,v69
MF v70,v6,v70
MF v71,v6,v71
MF v76,v6,v76
MF v77,v6,v77
MF v78,v6,v78
MF v79,v6,v79
C v68,v68,v69
C v69,v70,v71
C v70,v76,v77
C v71,v78,v79
buffer_store_dwordx4 v[68:71], v7, s[8:11], s30 offen offset:0 sc1
M v[96:99],a[64:67],v[128:131],0
s_nop 0
T a[96:97],v19,32768
T a[98:99],v19,34816
M v[96:99],a[68:71],v[144:147],v[96:99]
SA m0,s28,98304
T a[100:101],v19,36864
T a[102:103],v19,38912
M v[96:99],a[72:75],v[160:163],v[96:99]
SA s85,s38,0
buffer_load_dwordx4 v0, s[12:15], s85 offen offset:0 lds
M v[96:99],a[76:79],v[176:179],v[96:99]
s_nop 0
T a[104:105],v19,40960
T a[106:107],v19,43008
M v[96:99],a[80:83],v[192:195],v[96:99]
T a[108:109],v19,45056
T a[110:111],v19,47104
M v[96:99],a[84:87],v[208:211],v[96:99]
SA s85,s38,6144
MF v80,v5,v80
MF v81,v5,v81
M v[96:99],a[88:91],v[224:227],v[96:99]
T a[112:113],v19,49152
T a[114:115],v19,51200
M v[96:99],a[92:95],v[240:243],v[96:99]
T a[116:117],v19,53248
T a[118:119],v19,55296
M v[100:103],a[92:95],v[244:247],0
buffer_load_dwordx4 v0, s[12:15], s85 offen offset:1024 lds
M v[100:103],a[88:91],v[228:231],v[100:103]
s_nop 0
T a[120:121],v19,57344
T a[122:123],v19,59392
M v[100:103],a[84:87],v[212:215],v[100:103]
T a[124:125],v19,61440
T a[126:127],v19,63488
M v[100:103],a[80:83],v[196:199],v[100:103]
SA s85,s38,12288
MF v82,v5,v82
MF v83,v5,v83
M v[100:103],a[76:79],v[180:183],v[100:103]
buffer_load_dwordx4 v0, s[12:15], s85 offen offset:2048 lds
M v[100:103],a[72:75],v[164:167],v[100:103]
MF v88,v5,v88
MF v89,v5,v89
M v[100:103],a[68:71],v[148:151],v[100:103]
MF v90,v5,v90
MF v91,v5,v91
M v[100:103],a[64:67],v[132:135],v[100:103]
s_waitcnt lgkmcnt(0)
C v80,v80,v81
C v81,v82,v83
M v[104:107],a[96:99],v[128:131],0
SA s85,s38,18432
T a[64:65],v20,32768
T a[66:67],v20,34816
M v[104:107],a[100:103],v[144:147],v[104:107]
T a[68:69],v20,36864
T a[70:71],v20,38912
M v[104:107],a[104:107],v[160:163],v[104:107]
buffer_load_dwordx4 v0, s[12:15], s85 offen offset:3072 lds
M v[104:107],a[108:111],v[176:179],v[104:107]
s_nop 0
T a[72:73],v20,40960
T a[74:75],v20,43008
M v[104:107],a[112:115],v[192:195],v[104:107]
T a[76:77],v20,45056
T a[78:79],v20,47104
M v[104:107],a[116:119],v[208:211],v[104:107]
SA m0,s28,102400
C v82,v88,v89
C v83,v90,v91
M v[104:107],a[120:123],v[224:227],v[104:107]
SA s85,s38,28672
T a[80:81],v20,49152
T a[82:83],v20,51200
M v[104:107],a[124:127],v[240:243],v[104:107]
T a[84:85],v20,53248
T a[86:87],v20,55296
M v[108:111],a[124:127],v[244:247],0
buffer_store_dwordx4 v[80:83], v7, s[8:11], s29 offen offset:1024 sc1
M v[108:111],a[120:123],v[228:231],v[108:111]
s_nop 0
T a[88:89],v20,57344
T a[90:91],v20,59392
M v[108:111],a[116:119],v[212:215],v[108:111]
T a[92:93],v20,61440
T a[94:95],v20,63488
M v[108:111],a[112:115],v[196:199],v[108:111]
buffer_load_dwordx4 v0, s[12:15], s85 offen offset:0 lds
M v[108:111],a[108:111],v[180:183],v[108:111]
SA s85,s38,34816
MF v84,v6,v84
MF v85,v6,v85
M v[108:111],a[104:107],v[164:167],v[108:111]
MF v86,v6,v86
MF v87,v6,v87
M v[108:111],a[100:103],v[148:151],v[108:111]
buffer_load_dwordx4 v0, s[12:15], s85 offen offset:1024 lds
M v[108:111],a[96:99],v[132:135],v[108:111]
s_waitcnt lgkmcnt(0)
MF v92,v6,v92
MF v93,v6,v93
M v[112:115],a[64:67],v[128:131],0
T a[96:97],v21,32768
T a[98:99],v21,34816
M v[112:115],a[68:71],v[144:147],v[112:115]
SA s85,s38,40960
T a[100:101],v21,36864
T a[102:103],v21,38912
M v[112:115],a[72:75],v[160:163],v[112:115]
buffer_load_dwordx4 v0, s[12:15], s85 offen offset:2048 lds
M v[112:115],a[76:79],v[176:179],v[112:115]
s_nop 0
T a[104:105],v21,40960
T a[106:107],v21,43008
M v[112:115],a[80:83],v[192:195],v[112:115]
T a[108:109],v21,45056
T a[110:111],v21,47104
M v[112:115],a[84:87],v[208:211],v[112:115]
MF v94,v6,v94
MF v95,v6,v95
M v[112:115],a[88:91],v[224:227],v[112:115]
SA s85,s38,47104
T a[112:113],v21,49152
T a[114:115],v21,51200
M v[112:115],a[92:95],v[240:243],v[112:115]
T a[116:117],v21,53248
T a[118:119],v21,55296
M v[116:119],a[92:95],v[244:247],0
buffer_load_dwordx4 v0, s[12:15], s85 offen offset:3072 lds
M v[116:119],a[88:91],v[228:231],v[116:119]
s_nop 0
T a[120:121],v21,57344
T a[122:123],v21,59392
M v[116:119],a[84:87],v[212:215],v[116:119]
T a[124:125],v21,61440
T a[126:127],v21,63488
M v[116:119],a[80:83],v[196:199],v[116:119]
C v84,v84,v85
C v85,v86,v87
M v[116:119],a[76:79],v[180:183],v[116:119]
C v86,v92,v93
C v87,v94,v95
M v[116:119],a[72:75],v[164:167],v[116:119]
SA s38,s38,128
buffer_store_dwordx4 v[84:87], v7, s[8:11], s30 offen offset:1024 sc1
M v[116:119],a[68:71],v[148:151],v[116:119]
s_waitcnt vmcnt(28) lgkmcnt(0)
M v[116:119],a[64:67],v[132:135],v[116:119]
s_barrier
M v[120:123],a[96:99],v[128:131],0
SA s29,s33,2048
T a[64:65],v22,0
T a[66:67],v22,2048
M v[120:123],a[100:103],v[144:147],v[120:123]
SA s30,s33,16384
T a[68:69],v22,4096
T a[70:71],v22,6144
M v[120:123],a[104:107],v[160:163],v[120:123]
MF v96,v5,v96
MF v97,v5,v97
M v[120:123],a[108:111],v[176:179],v[120:123]
T a[72:73],v22,8192
T a[74:75],v22,10240
M v[120:123],a[112:115],v[192:195],v[120:123]
T a[76:77],v22,12288
T a[78:79],v22,14336
M v[120:123],a[116:119],v[208:211],v[120:123]
MF v98,v5,v98
MF v99,v5,v99
M v[120:123],a[120:123],v[224:227],v[120:123]
T a[80:81],v22,16384
T a[82:83],v22,18432
M v[120:123],a[124:127],v[240:243],v[120:123]
T a[84:85],v22,20480
T a[86:87],v22,22528
M v[124:127],a[124:127],v[244:247],0
MF v104,v5,v104
MF v105,v5,v105
M v[124:127],a[120:123],v[228:231],v[124:127]
T a[88:89],v22,24576
T a[90:91],v22,26624
M v[124:127],a[116:119],v[212:215],v[124:127]
T a[92:93],v22,28672
T a[94:95],v22,30720
M v[124:127],a[112:115],v[196:199],v[124:127]
MF v106,v5,v106
MF v107,v5,v107
M v[124:127],a[108:111],v[180:183],v[124:127]
C v96,v96,v97
C v97,v98,v99
M v[124:127],a[104:107],v[164:167],v[124:127]
C v98,v104,v105
C v99,v106,v107
M v[124:127],a[100:103],v[148:151],v[124:127]
s_waitcnt lgkmcnt(0)
buffer_store_dwordx4 v[96:99], v7, s[8:11], s29 offen offset:0 sc1
M v[124:127],a[96:99],v[132:135],v[124:127]
MF v100,v6,v100
MF v101,v6,v101
MF v102,v6,v102
MF v103,v6,v103
MF v108,v6,v108
MF v109,v6,v109
MF v110,v6,v110
MF v111,v6,v111
C v100,v100,v101
C v101,v102,v103
C v102,v108,v109
C v103,v110,v111
buffer_store_dwordx4 v[100:103], v7, s[8:11], s30 offen offset:0 sc1
M v[64:67],a[64:67],v[128:131],0
s_nop 0
T a[96:97],v23,0
T a[98:99],v23,2048
M v[64:67],a[68:71],v[144:147],v[64:67]
SA m0,s28,32768
T a[100:101],v23,4096
T a[102:103],v23,6144
M v[64:67],a[72:75],v[160:163],v[64:67]
SA s85,s38,0
buffer_load_dwordx4 v0, s[12:15], s85 offen offset:0 lds
M v[64:67],a[76:79],v[176:179],v[64:67]
s_nop 0
T a[104:105],v23,8192
T a[106:107],v23,10240
M v[64:67],a[80:83],v[192:195],v[64:67]
T a[108:109],v23,12288
T a[110:111],v23,14336
M v[64:67],a[84:87],v[208:211],v[64:67]
SA s85,s38,6144
MF v112,v5,v112
MF v113,v5,v113
M v[64:67],a[88:91],v[224:227],v[64:67]
T a[112:113],v23,16384
T a[114:115],v23,18432
M v[64:67],a[92:95],v[240:243],v[64:67]
T a[116:117],v23,20480
T a[118:119],v23,22528
M v[68:71],a[92:95],v[244:247],0
buffer_load_dwordx4 v0, s[12:15], s85 offen offset:1024 lds
M v[68:71],a[88:91],v[228:231],v[68:71]
s_nop 0
T a[120:121],v23,24576
T a[122:123],v23,26624
M v[68:71],a[84:87],v[212:215],v[68:71]
T a[124:125],v23,28672
T a[126:127],v23,30720
M v[68:71],a[80:83],v[196:199],v[68:71]
SA s85,s38,12288
MF v114,v5,v114
MF v115,v5,v115
M v[68:71],a[76:79],v[180:183],v[68:71]
buffer_load_dwordx4 v0, s[12:15], s85 offen offset:2048 lds
M v[68:71],a[72:75],v[164:167],v[68:71]
MF v120,v5,v120
MF v121,v5,v121
M v[68:71],a[68:71],v[148:151],v[68:71]
MF v122,v5,v122
MF v123,v5,v123
M v[68:71],a[64:67],v[132:135],v[68:71]
s_waitcnt lgkmcnt(0)
C v112,v112,v113
C v113,v114,v115
M v[72:75],a[96:99],v[128:131],0
SA s85,s38,18432
T a[64:65],v24,0
T a[66:67],v24,2048
M v[72:75],a[100:103],v[144:147],v[72:75]
T a[68:69],v24,4096
T a[70:71],v24,6144
M v[72:75],a[104:107],v[160:163],v[72:75]
buffer_load_dwordx4 v0, s[12:15], s85 offen offset:3072 lds
M v[72:75],a[108:111],v[176:179],v[72:75]
s_nop 0
T a[72:73],v24,8192
T a[74:75],v24,10240
M v[72:75],a[112:115],v[192:195],v[72:75]
T a[76:77],v24,12288
T a[78:79],v24,14336
M v[72:75],a[116:119],v[208:211],v[72:75]
SA m0,s28,36864
C v114,v120,v121
C v115,v122,v123
M v[72:75],a[120:123],v[224:227],v[72:75]
SA s85,s38,28672
T a[80:81],v24,16384
T a[82:83],v24,18432
M v[72:75],a[124:127],v[240:243],v[72:75]
T a[84:85],v24,20480
T a[86:87],v24,22528
M v[76:79],a[124:127],v[244:247],0
buffer_store_dwordx4 v[112:115], v7, s[8:11], s29 offen offset:1024 sc1
M v[76:79],a[120:123],v[228:231],v[76:79]
s_nop 0
T a[88:89],v24,24576
T a[90:91],v24,26624
M v[76:79],a[116:119],v[212:215],v[76:79]
T a[92:93],v24,28672
T a[94:95],v24,30720
M v[76:79],a[112:115],v[196:199],v[76:79]
buffer_load_dwordx4 v0, s[12:15], s85 offen offset:0 lds
M v[76:79],a[108:111],v[180:183],v[76:79]
SA s85,s38,34816
MF v116,v6,v116
MF v117,v6,v117
M v[76:79],a[104:107],v[164:167],v[76:79]
MF v118,v6,v118
MF v119,v6,v119
M v[76:79],a[100:103],v[148:151],v[76:79]
buffer_load_dwordx4 v0, s[12:15], s85 offen offset:1024 lds
M v[76:79],a[96:99],v[132:135],v[76:79]
s_waitcnt lgkmcnt(0)
MF v124,v6,v124
MF v125,v6,v125
M v[80:83],a[64:67],v[128:131],0
T a[96:97],v25,0
T a[98:99],v25,2048
M v[80:83],a[68:71],v[144:147],v[80:83]
SA s85,s38,40960
T a[100:101],v25,4096
T a[102:103],v25,6144
M v[80:83],a[72:75],v[160:163],v[80:83]
buffer_load_dwordx4 v0, s[12:15], s85 offen offset:2048 lds
M v[80:83],a[76:79],v[176:179],v[80:83]
s_nop 0
T a[104:105],v25,8192
T a[106:107],v25,10240
M v[80:83],a[80:83],v[192:195],v[80:83]
T a[108:109],v25,12288
T a[110:111],v25,14336
M v[80:83],a[84:87],v[208:211],v[80:83]
MF v126,v6,v126
MF v127,v6,v127
M v[80:83],a[88:91],v[224:227],v[80:83]
SA s85,s38,47104
T a[112:113],v25,16384
T a[114:115],v25,18432
M v[80:83],a[92:95],v[240:243],v[80:83]
T a[116:117],v25,20480
T a[118:119],v25,22528
M v[84:87],a[92:95],v[244:247],0
buffer_load_dwordx4 v0, s[12:15], s85 offen offset:3072 lds
M v[84:87],a[88:91],v[228:231],v[84:87]
s_nop 0
T a[120:121],v25,24576
T a[122:123],v25,26624
M v[84:87],a[84:87],v[212:215],v[84:87]
T a[124:125],v25,28672
T a[126:127],v25,30720
M v[84:87],a[80:83],v[196:199],v[84:87]
C v116,v116,v117
C v117,v118,v119
M v[84:87],a[76:79],v[180:183],v[84:87]
C v118,v124,v125
C v119,v126,v127
M v[84:87],a[72:75],v[164:167],v[84:87]
SA s38,s38,128
buffer_store_dwordx4 v[116:119], v7, s[8:11], s30 offen offset:1024 sc1
M v[84:87],a[68:71],v[148:151],v[84:87]
s_waitcnt vmcnt(32) lgkmcnt(0)
M v[84:87],a[64:67],v[132:135],v[84:87]
s_barrier
M v[88:91],a[96:99],v[128:131],0
SA s29,s33,4096
T a[64:65],v18,0
T a[66:67],v18,2048
M v[88:91],a[100:103],v[144:147],v[88:91]
SA s30,s33,18432
T a[68:69],v18,4096
T a[70:71],v18,6144
M v[88:91],a[104:107],v[160:163],v[88:91]
MF v64,v5,v64
MF v65,v5,v65
M v[88:91],a[108:111],v[176:179],v[88:91]
T a[72:73],v18,8192
T a[74:75],v18,10240
M v[88:91],a[112:115],v[192:195],v[88:91]
T a[76:77],v18,12288
T a[78:79],v18,14336
M v[88:91],a[116:119],v[208:211],v[88:91]
MF v66,v5,v66
MF v67,v5,v67
M v[88:91],a[120:123],v[224:227],v[88:91]
T a[80:81],v18,16384
T a[82:83],v18,18432
M v[88:91],a[124:127],v[240:243],v[88:91]
T a[84:85],v18,20480
T a[86:87],v18,22528
M v[92:95],a[124:127],v[244:247],0
MF v72,v5,v72
MF v73,v5,v73
M v[92:95],a[120:123],v[228:231],v[92:95]
T a[88:89],v18,24576
T a[90:91],v18,26624
M v[92:95],a[116:119],v[212:215],v[92:95]
T a[92:93],v18,28672
T a[94:95],v18,30720
M v[92:95],a[112:115],v[196:199],v[92:95]
MF v74,v5,v74
MF v75,v5,v75
M v[92:95],a[108:111],v[180:183],v[92:95]
C v64,v64,v65
C v65,v66,v67
M v[92:95],a[104:107],v[164:167],v[92:95]
C v66,v72,v73
C v67,v74,v75
M v[92:95],a[100:103],v[148:151],v[92:95]
s_waitcnt lgkmcnt(0)
buffer_store_dwordx4 v[64:67], v7, s[8:11], s29 offen offset:0 sc1
M v[92:95],a[96:99],v[132:135],v[92:95]
MF v68,v6,v68
MF v69,v6,v69
MF v70,v6,v70
MF v71,v6,v71
MF v76,v6,v76
MF v77,v6,v77
MF v78,v6,v78
MF v79,v6,v79
C v68,v68,v69
C v69,v70,v71
C v70,v76,v77
C v71,v78,v79
buffer_store_dwordx4 v[68:71], v7, s[8:11], s30 offen offset:0 sc1
M v[96:99],a[64:67],v[128:131],0
s_nop 0
T a[96:97],v19,0
T a[98:99],v19,2048
M v[96:99],a[68:71],v[144:147],v[96:99]
T a[100:101],v19,4096
T a[102:103],v19,6144
M v[96:99],a[72:75],v[160:163],v[96:99]
MF v80,v5,v80
MF v81,v5,v81
M v[96:99],a[76:79],v[176:179],v[96:99]
T a[104:105],v19,8192
T a[106:107],v19,10240
M v[96:99],a[80:83],v[192:195],v[96:99]
T a[108:109],v19,12288
T a[110:111],v19,14336
M v[96:99],a[84:87],v[208:211],v[96:99]
MF v82,v5,v82
MF v83,v5,v83
M v[96:99],a[88:91],v[224:227],v[96:99]
T a[112:113],v19,16384
T a[114:115],v19,18432
M v[96:99],a[92:95],v[240:243],v[96:99]
T a[116:117],v19,20480
T a[118:119],v19,22528
M v[100:103],a[92:95],v[244:247],0
MF v88,v5,v88
MF v89,v5,v89
M v[100:103],a[88:91],v[228:231],v[100:103]
T a[120:121],v19,24576
T a[122:123],v19,26624
M v[100:103],a[84:87],v[212:215],v[100:103]
T a[124:125],v19,28672
T a[126:127],v19,30720
M v[100:103],a[80:83],v[196:199],v[100:103]
MF v90,v5,v90
MF v91,v5,v91
M v[100:103],a[76:79],v[180:183],v[100:103]
C v80,v80,v81
C v81,v82,v83
M v[100:103],a[72:75],v[164:167],v[100:103]
C v82,v88,v89
C v83,v90,v91
M v[100:103],a[68:71],v[148:151],v[100:103]
buffer_store_dwordx4 v[80:83], v7, s[8:11], s29 offen offset:1024 sc1
M v[100:103],a[64:67],v[132:135],v[100:103]
s_waitcnt lgkmcnt(0)
MF v84,v6,v84
MF v85,v6,v85
M v[104:107],a[96:99],v[128:131],0
T a[64:65],v20,0
T a[66:67],v20,2048
M v[104:107],a[100:103],v[144:147],v[104:107]
T a[68:69],v20,4096
T a[70:71],v20,6144
M v[104:107],a[104:107],v[160:163],v[104:107]
MF v86,v6,v86
MF v87,v6,v87
M v[104:107],a[108:111],v[176:179],v[104:107]
T a[72:73],v20,8192
T a[74:75],v20,10240
M v[104:107],a[112:115],v[192:195],v[104:107]
T a[76:77],v20,12288
T a[78:79],v20,14336
M v[104:107],a[116:119],v[208:211],v[104:107]
MF v92,v6,v92
MF v93,v6,v93
M v[104:107],a[120:123],v[224:227],v[104:107]
T a[80:81],v20,16384
T a[82:83],v20,18432
M v[104:107],a[124:127],v[240:243],v[104:107]
T a[84:85],v20,20480
T a[86:87],v20,22528
M v[108:111],a[124:127],v[244:247],0
MF v94,v6,v94
MF v95,v6,v95
M v[108:111],a[120:123],v[228:231],v[108:111]
T a[88:89],v20,24576
T a[90:91],v20,26624
M v[108:111],a[116:119],v[212:215],v[108:111]
T a[92:93],v20,28672
T a[94:95],v20,30720
M v[108:111],a[112:115],v[196:199],v[108:111]
C v84,v84,v85
C v85,v86,v87
M v[108:111],a[108:111],v[180:183],v[108:111]
C v86,v92,v93
C v87,v94,v95
M v[108:111],a[104:107],v[164:167],v[108:111]
buffer_store_dwordx4 v[84:87], v7, s[8:11], s30 offen offset:1024 sc1
M v[108:111],a[100:103],v[148:151],v[108:111]
SA s29,s33,6144
M v[108:111],a[96:99],v[132:135],v[108:111]
s_waitcnt lgkmcnt(0)
M v[112:115],a[64:67],v[128:131],0
SA s30,s33,20480
T a[96:97],v21,0
T a[98:99],v21,2048
M v[112:115],a[68:71],v[144:147],v[112:115]
T a[100:101],v21,4096
T a[102:103],v21,6144
M v[112:115],a[72:75],v[160:163],v[112:115]
MF v96,v5,v96
MF v97,v5,v97
M v[112:115],a[76:79],v[176:179],v[112:115]
T a[104:105],v21,8192
T a[106:107],v21,10240
M v[112:115],a[80:83],v[192:195],v[112:115]
T a[108:109],v21,12288
T a[110:111],v21,14336
M v[112:115],a[84:87],v[208:211],v[112:115]
MF v98,v5,v98
MF v99,v5,v99
M v[112:115],a[88:91],v[224:227],v[112:115]
T a[112:113],v21,16384
T a[114:115],v21,18432
M v[112:115],a[92:95],v[240:243],v[112:115]
T a[116:117],v21,20480
T a[118:119],v21,22528
M v[116:119],a[92:95],v[244:247],0
MF v104,v5,v104
MF v105,v5,v105
M v[116:119],a[88:91],v[228:231],v[116:119]
T a[120:121],v21,24576
T a[122:123],v21,26624
M v[116:119],a[84:87],v[212:215],v[116:119]
T a[124:125],v21,28672
T a[126:127],v21,30720
M v[116:119],a[80:83],v[196:199],v[116:119]
MF v106,v5,v106
MF v107,v5,v107
M v[116:119],a[76:79],v[180:183],v[116:119]
C v96,v96,v97
C v97,v98,v99
M v[116:119],a[72:75],v[164:167],v[116:119]
C v98,v104,v105
C v99,v106,v107
M v[116:119],a[68:71],v[148:151],v[116:119]
s_waitcnt vmcnt(28) lgkmcnt(0)
buffer_store_dwordx4 v[96:99], v7, s[8:11], s29 offen offset:0 sc1
M v[116:119],a[64:67],v[132:135],v[116:119]
s_barrier
M v[120:123],a[96:99],v[128:131],0
s_nop 0
T a[64:65],v40,0
T a[66:67],v40,2048
M v[120:123],a[100:103],v[144:147],v[120:123]
T a[68:69],v40,4096
T a[70:71],v40,6144
M v[120:123],a[104:107],v[160:163],v[120:123]
MF v100,v6,v100
MF v101,v6,v101
M v[120:123],a[108:111],v[176:179],v[120:123]
T a[72:73],v40,8192
T a[74:75],v40,10240
M v[120:123],a[112:115],v[192:195],v[120:123]
T a[76:77],v40,12288
T a[78:79],v40,14336
M v[120:123],a[116:119],v[208:211],v[120:123]
MF v102,v6,v102
MF v103,v6,v103
M v[120:123],a[120:123],v[224:227],v[120:123]
T a[80:81],v40,16384
T a[82:83],v40,18432
M v[120:123],a[124:127],v[240:243],v[120:123]
T a[84:85],v40,20480
T a[86:87],v40,22528
M v[124:127],a[124:127],v[244:247],0
MF v108,v6,v108
MF v109,v6,v109
M v[124:127],a[120:123],v[228:231],v[124:127]
T a[88:89],v40,24576
T a[90:91],v40,26624
M v[124:127],a[116:119],v[212:215],v[124:127]
T a[92:93],v40,28672
T a[94:95],v40,30720
M v[124:127],a[112:115],v[196:199],v[124:127]
MF v110,v6,v110
MF v111,v6,v111
M v[124:127],a[108:111],v[180:183],v[124:127]
C v100,v100,v101
C v101,v102,v103
M v[124:127],a[104:107],v[164:167],v[124:127]
C v102,v108,v109
C v103,v110,v111
M v[124:127],a[100:103],v[148:151],v[124:127]
s_waitcnt lgkmcnt(0)
buffer_store_dwordx4 v[100:103], v7, s[8:11], s30 offen offset:0 sc1
M v[124:127],a[96:99],v[132:135],v[124:127]
M v[64:67],a[64:67],v[128:131],0
s_nop 0
T a[96:97],v41,0
T a[98:99],v41,2048
M v[64:67],a[68:71],v[144:147],v[64:67]
T a[100:101],v41,4096
T a[102:103],v41,6144
M v[64:67],a[72:75],v[160:163],v[64:67]
v_lshrrev_b32 v32, 4, v7
MF v112,v5,v112
M v[64:67],a[76:79],v[176:179],v[64:67]
s_lshr_b32 s74, s41, 3
T a[104:105],v41,8192
T a[106:107],v41,10240
M v[64:67],a[80:83],v[192:195],v[64:67]
s_sub_u32 s64, 15, s42
T a[108:109],v41,12288
T a[110:111],v41,14336
M v[64:67],a[84:87],v[208:211],v[64:67]
s_mul_i32 s46, s64, 8704
MF v113,v5,v113
MF v114,v5,v114
M v[64:67],a[88:91],v[224:227],v[64:67]
s_and_b32 s72, s41, 7
T a[112:113],v41,16384
T a[114:115],v41,18432
M v[64:67],a[92:95],v[240:243],v[64:67]
s_lshl_b32 s65, s72, 7
T a[116:117],v41,20480
T a[118:119],v41,22528
M v[68:71],a[92:95],v[244:247],0
SA s46,s46,s65
MF v115,v5,v115
MF v120,v5,v120
M v[68:71],a[88:91],v[228:231],v[68:71]
SA s46,s46,104993792
T a[120:121],v41,24576
T a[122:123],v41,26624
M v[68:71],a[84:87],v[212:215],v[68:71]
T a[124:125],v41,28672
T a[126:127],v41,30720
M v[68:71],a[80:83],v[196:199],v[68:71]
v_and_b32 v33, 31, v32
MF v121,v5,v121
M v[68:71],a[76:79],v[180:183],v[68:71]
MF v122,v5,v122
MF v123,v5,v123
M v[68:71],a[72:75],v[164:167],v[68:71]
C v112,v112,v113
C v113,v114,v115
M v[68:71],a[68:71],v[148:151],v[68:71]
C v114,v120,v121
C v115,v122,v123
M v[68:71],a[64:67],v[132:135],v[68:71]
s_waitcnt lgkmcnt(0)
buffer_store_dwordx4 v[112:115], v7, s[8:11], s29 offen offset:1024 sc1
M v[72:75],a[96:99],v[128:131],0
s_nop 0
T a[64:65],v42,0
T a[66:67],v42,2048
M v[72:75],a[100:103],v[144:147],v[72:75]
T a[68:69],v42,4096
T a[70:71],v42,6144
M v[72:75],a[104:107],v[160:163],v[72:75]
MF v116,v6,v116
MF v117,v6,v117
M v[72:75],a[108:111],v[176:179],v[72:75]
T a[72:73],v42,8192
T a[74:75],v42,10240
M v[72:75],a[112:115],v[192:195],v[72:75]
T a[76:77],v42,12288
T a[78:79],v42,14336
M v[72:75],a[116:119],v[208:211],v[72:75]
MF v118,v6,v118
MF v119,v6,v119
M v[72:75],a[120:123],v[224:227],v[72:75]
T a[80:81],v42,16384
T a[82:83],v42,18432
M v[72:75],a[124:127],v[240:243],v[72:75]
T a[84:85],v42,20480
T a[86:87],v42,22528
M v[76:79],a[124:127],v[244:247],0
MF v124,v6,v124
MF v125,v6,v125
M v[76:79],a[120:123],v[228:231],v[76:79]
T a[88:89],v42,24576
T a[90:91],v42,26624
M v[76:79],a[116:119],v[212:215],v[76:79]
T a[92:93],v42,28672
T a[94:95],v42,30720
M v[76:79],a[112:115],v[196:199],v[76:79]
MF v126,v6,v126
MF v127,v6,v127
M v[76:79],a[108:111],v[180:183],v[76:79]
C v116,v116,v117
C v117,v118,v119
M v[76:79],a[104:107],v[164:167],v[76:79]
C v118,v124,v125
C v119,v126,v127
M v[76:79],a[100:103],v[148:151],v[76:79]
buffer_store_dwordx4 v[116:119], v7, s[8:11], s30 offen offset:1024 sc1
M v[76:79],a[96:99],v[132:135],v[76:79]
s_waitcnt lgkmcnt(0)
v_lshlrev_b32 v33, 2, v33
M v[80:83],a[64:67],v[128:131],0
SA s29,s33,8192
T a[96:97],v43,0
T a[98:99],v43,2048
M v[80:83],a[68:71],v[144:147],v[80:83]
SA s30,s33,22528
T a[100:101],v43,4096
T a[102:103],v43,6144
M v[80:83],a[72:75],v[160:163],v[80:83]
s_lshl_b32 s65, s41, 7
MF v64,v5,v64
MF v65,v5,v65
M v[80:83],a[76:79],v[176:179],v[80:83]
SA s65,s65,104890368
T a[104:105],v43,8192
T a[106:107],v43,10240
M v[80:83],a[80:83],v[192:195],v[80:83]
T a[108:109],v43,12288
T a[110:111],v43,14336
M v[80:83],a[84:87],v[208:211],v[80:83]
buffer_load_dword v31, v33, s[8:11], s65 offen sc1
M v[80:83],a[88:91],v[224:227],v[80:83]
s_nop 0
T a[112:113],v43,16384
T a[114:115],v43,18432
M v[80:83],a[92:95],v[240:243],v[80:83]
T a[116:117],v43,20480
T a[118:119],v43,22528
M v[84:87],a[92:95],v[244:247],0
s_cmp_ge_u32 s42, 8
v_bfe_u32 v34, v32, 4, 1
v_lshlrev_b32 v34, 1, v34
M v[84:87],a[88:91],v[228:231],v[84:87]
s_cselect_b32 s84, s45, 536870912
T a[120:121],v43,24576
T a[122:123],v43,26624
M v[84:87],a[84:87],v[212:215],v[84:87]
T a[124:125],v43,28672
T a[126:127],v43,30720
M v[84:87],a[80:83],v[196:199],v[84:87]
v_lshrrev_b32 v35, 5, v32
v_add_u32 v34, v34, v35
M v[84:87],a[76:79],v[180:183],v[84:87]
s_mov_b32 s52, s96
MF v66,v5,v66
MF v67,v5,v67
M v[84:87],a[72:75],v[164:167],v[84:87]
s_and_b32 s53, s97, 0xffff
MF v72,v5,v72
MF v73,v5,v73
M v[84:87],a[68:71],v[148:151],v[84:87]
s_waitcnt vmcnt(22) lgkmcnt(0)
MF v74,v5,v74
MF v75,v5,v75
M v[84:87],a[64:67],v[132:135],v[84:87]
s_barrier
M v[88:91],a[96:99],v[128:131],0
s_mov_b32 s54, 1835008
T a[64:65],v22,32768
T a[66:67],v22,34816
M v[88:91],a[100:103],v[144:147],v[88:91]
s_mov_b32 s55, 0x20000
T a[68:69],v22,36864
T a[70:71],v22,38912
M v[88:91],a[104:107],v[160:163],v[88:91]
s_mul_i32 s77, s42, 1835008
C v64,v64,v65
C v65,v66,v67
M v[88:91],a[108:111],v[176:179],v[88:91]
s_mul_i32 s78, s72, 14336
T a[72:73],v22,40960
T a[74:75],v22,43008
M v[88:91],a[112:115],v[192:195],v[88:91]
SA s77,s77,s78
T a[76:77],v22,45056
T a[78:79],v22,47104
M v[88:91],a[116:119],v[208:211],v[88:91]
SA s77,s77,67108864
C v66,v72,v73
C v67,v74,v75
M v[88:91],a[120:123],v[224:227],v[88:91]
s_lshl_b32 s79, s74, 2
T a[80:81],v22,49152
T a[82:83],v22,51200
M v[88:91],a[124:127],v[240:243],v[88:91]
SA s79,s79,s20
T a[84:85],v22,53248
T a[86:87],v22,55296
M v[92:95],a[124:127],v[244:247],0
SA s79,s79,6
buffer_store_dwordx4 v[64:67], v7, s[8:11], s29 offen offset:0 sc1
M v[92:95],a[120:123],v[228:231],v[92:95]
s_sub_u32 s67, 13, s79
T a[88:89],v22,57344
T a[90:91],v22,59392
M v[92:95],a[116:119],v[212:215],v[92:95]
s_and_b32 s67, s67, 536870912
T a[92:93],v22,61440
T a[94:95],v22,63488
M v[92:95],a[112:115],v[196:199],v[92:95]
s_lshl_b32 s78, s79, 10
MF v68,v6,v68
MF v69,v6,v69
M v[92:95],a[108:111],v[180:183],v[92:95]
SA s78,s78,s77
MF v70,v6,v70
MF v71,v6,v71
M v[92:95],a[104:107],v[164:167],v[92:95]
s_lshl_b32 s79, s79, 6
MF v76,v6,v76
MF v77,v6,v77
M v[92:95],a[100:103],v[148:151],v[92:95]
s_waitcnt lgkmcnt(0)
MF v78,v6,v78
MF v79,v6,v79
M v[92:95],a[96:99],v[132:135],v[92:95]
s_or_b32 s79, s79, s67
v_or_b32 v27, s67, v7
s_lshr_b32 s73, s72, 1
s_sub_u32 s65, 7, s73
s_bitcmp1_b32 s72, 0
s_cselect_b32 s73, s65, s73
s_lshl_b32 s73, s73, 4
s_lshl_b32 s65, s42, 7
SA s73,s73,s65
v_and_b32 v29, 15, v32
v_add_u32 v29, s73, v29
s_mov_b32 s64, 104857664
v_mul_u32_u24 v28, 896, v29
v_lshl_add_u32 v28, v34, 4, v28
C v68,v68,v69
C v69,v70,v71
C v70,v76,v77
C v71,v78,v79
buffer_store_dwordx4 v[68:71], v7, s[8:11], s30 offen offset:0 sc1
v_lshrrev_b32 v35, 4, v29
v_lshlrev_b32 v35, 5, v35
v_and_b32 v36, 15, v29
v_add_lshl_u32 v35, v35, v36, 2
buffer_load_dword v26, v35, s[8:11], s64 offen sc1
s_waitcnt vmcnt(8)
buffer_store_dword v15, v17, s[8:11], s84 offen sc1
buffer_load_dwordx4 v[44:47], v28, s[56:59], s79 offen
M v[96:99],a[64:67],v[128:131],0
s_nop 0
T a[96:97],v23,32768
T a[98:99],v23,34816
M v[96:99],a[68:71],v[144:147],v[96:99]
T a[100:101],v23,36864
T a[102:103],v23,38912
M v[96:99],a[72:75],v[160:163],v[96:99]
MF v80,v5,v80
MF v81,v5,v81
M v[96:99],a[76:79],v[176:179],v[96:99]
T a[104:105],v23,40960
T a[106:107],v23,43008
M v[96:99],a[80:83],v[192:195],v[96:99]
T a[108:109],v23,45056
T a[110:111],v23,47104
M v[96:99],a[84:87],v[208:211],v[96:99]
MF v82,v5,v82
MF v83,v5,v83
M v[96:99],a[88:91],v[224:227],v[96:99]
T a[112:113],v23,49152
T a[114:115],v23,51200
M v[96:99],a[92:95],v[240:243],v[96:99]
T a[116:117],v23,53248
T a[118:119],v23,55296
M v[100:103],a[92:95],v[244:247],0
MF v88,v5,v88
MF v89,v5,v89
M v[100:103],a[88:91],v[228:231],v[100:103]
T a[120:121],v23,57344
T a[122:123],v23,59392
M v[100:103],a[84:87],v[212:215],v[100:103]
T a[124:125],v23,61440
T a[126:127],v23,63488
M v[100:103],a[80:83],v[196:199],v[100:103]
MF v90,v5,v90
MF v91,v5,v91
M v[100:103],a[76:79],v[180:183],v[100:103]
C v80,v80,v81
C v81,v82,v83
M v[100:103],a[72:75],v[164:167],v[100:103]
C v82,v88,v89
C v83,v90,v91
M v[100:103],a[68:71],v[148:151],v[100:103]
buffer_store_dwordx4 v[80:83], v7, s[8:11], s29 offen offset:1024 sc1
M v[100:103],a[64:67],v[132:135],v[100:103]
s_waitcnt lgkmcnt(0)
MF v84,v6,v84
MF v85,v6,v85
M v[104:107],a[96:99],v[128:131],0
T a[64:65],v24,32768
T a[66:67],v24,34816
M v[104:107],a[100:103],v[144:147],v[104:107]
T a[68:69],v24,36864
T a[70:71],v24,38912
M v[104:107],a[104:107],v[160:163],v[104:107]
MF v86,v6,v86
MF v87,v6,v87
M v[104:107],a[108:111],v[176:179],v[104:107]
T a[72:73],v24,40960
T a[74:75],v24,43008
M v[104:107],a[112:115],v[192:195],v[104:107]
T a[76:77],v24,45056
T a[78:79],v24,47104
M v[104:107],a[116:119],v[208:211],v[104:107]
MF v92,v6,v92
MF v93,v6,v93
M v[104:107],a[120:123],v[224:227],v[104:107]
T a[80:81],v24,49152
T a[82:83],v24,51200
M v[104:107],a[124:127],v[240:243],v[104:107]
T a[84:85],v24,53248
T a[86:87],v24,55296
M v[108:111],a[124:127],v[244:247],0
MF v94,v6,v94
MF v95,v6,v95
M v[108:111],a[120:123],v[228:231],v[108:111]
T a[88:89],v24,57344
T a[90:91],v24,59392
M v[108:111],a[116:119],v[212:215],v[108:111]
T a[92:93],v24,61440
T a[94:95],v24,63488
M v[108:111],a[112:115],v[196:199],v[108:111]
C v84,v84,v85
C v85,v86,v87
M v[108:111],a[108:111],v[180:183],v[108:111]
C v86,v92,v93
C v87,v94,v95
M v[108:111],a[104:107],v[164:167],v[108:111]
buffer_store_dwordx4 v[84:87], v7, s[8:11], s30 offen offset:1024 sc1
M v[108:111],a[100:103],v[148:151],v[108:111]
SA s29,s33,10240
M v[108:111],a[96:99],v[132:135],v[108:111]
s_waitcnt lgkmcnt(0)
M v[112:115],a[64:67],v[128:131],0
SA s30,s33,24576
T a[96:97],v25,32768
T a[98:99],v25,34816
M v[112:115],a[68:71],v[144:147],v[112:115]
T a[100:101],v25,36864
T a[102:103],v25,38912
M v[112:115],a[72:75],v[160:163],v[112:115]
MF v96,v5,v96
MF v97,v5,v97
M v[112:115],a[76:79],v[176:179],v[112:115]
T a[104:105],v25,40960
T a[106:107],v25,43008
M v[112:115],a[80:83],v[192:195],v[112:115]
T a[108:109],v25,45056
T a[110:111],v25,47104
M v[112:115],a[84:87],v[208:211],v[112:115]
MF v98,v5,v98
MF v99,v5,v99
M v[112:115],a[88:91],v[224:227],v[112:115]
T a[112:113],v25,49152
T a[114:115],v25,51200
M v[112:115],a[92:95],v[240:243],v[112:115]
T a[116:117],v25,53248
T a[118:119],v25,55296
M v[116:119],a[92:95],v[244:247],0
s_cmp_lt_u32 s42, 8
MF v104,v5,v104
MF v105,v5,v105
M v[116:119],a[88:91],v[228:231],v[116:119]
s_cselect_b32 s84, s45, 536870912
T a[120:121],v25,57344
T a[122:123],v25,59392
M v[116:119],a[84:87],v[212:215],v[116:119]
T a[124:125],v25,61440
T a[126:127],v25,63488
M v[116:119],a[80:83],v[196:199],v[116:119]
MF v106,v5,v106
MF v107,v5,v107
M v[116:119],a[76:79],v[180:183],v[116:119]
C v96,v96,v97
C v97,v98,v99
M v[116:119],a[72:75],v[164:167],v[116:119]
C v98,v104,v105
C v99,v106,v107
M v[116:119],a[68:71],v[148:151],v[116:119]
s_waitcnt lgkmcnt(0)
buffer_store_dwordx4 v[96:99], v7, s[8:11], s29 offen offset:0 sc1
M v[116:119],a[64:67],v[132:135],v[116:119]
s_barrier
M v[120:123],a[96:99],v[128:131],0
s_nop 0
T a[64:65],v18,32768
T a[66:67],v18,34816
M v[120:123],a[100:103],v[144:147],v[120:123]
T a[68:69],v18,36864
T a[70:71],v18,38912
M v[120:123],a[104:107],v[160:163],v[120:123]
MF v100,v6,v100
MF v101,v6,v101
M v[120:123],a[108:111],v[176:179],v[120:123]
T a[72:73],v18,40960
T a[74:75],v18,43008
M v[120:123],a[112:115],v[192:195],v[120:123]
s_waitcnt vmcnt(9)
T a[76:77],v18,45056
T a[78:79],v18,47104
M v[120:123],a[116:119],v[208:211],v[120:123]
buffer_store_dword v15, v17, s[8:11], s84 offen sc1
M v[120:123],a[120:123],v[224:227],v[120:123]
s_nop 0
T a[80:81],v18,49152
T a[82:83],v18,51200
M v[120:123],a[124:127],v[240:243],v[120:123]
T a[84:85],v18,53248
T a[86:87],v18,55296
M v[124:127],a[124:127],v[244:247],0
MF v102,v6,v102
MF v103,v6,v103
M v[124:127],a[120:123],v[228:231],v[124:127]
T a[88:89],v18,57344
T a[90:91],v18,59392
M v[124:127],a[116:119],v[212:215],v[124:127]
T a[92:93],v18,61440
T a[94:95],v18,63488
M v[124:127],a[112:115],v[196:199],v[124:127]
MF v108,v6,v108
MF v109,v6,v109
M v[124:127],a[108:111],v[180:183],v[124:127]
MF v110,v6,v110
MF v111,v6,v111
M v[124:127],a[104:107],v[164:167],v[124:127]
C v100,v100,v101
C v101,v102,v103
M v[124:127],a[100:103],v[148:151],v[124:127]
s_waitcnt lgkmcnt(0)
C v102,v108,v109
C v103,v110,v111
M v[124:127],a[96:99],v[132:135],v[124:127]
buffer_store_dwordx4 v[100:103], v7, s[8:11], s30 offen offset:0 sc1
M v[64:67],a[64:67],v[128:131],0
s_nop 0
T a[96:97],v19,32768
T a[98:99],v19,34816
M v[64:67],a[68:71],v[144:147],v[64:67]
T a[100:101],v19,36864
T a[102:103],v19,38912
M v[64:67],a[72:75],v[160:163],v[64:67]
MF v112,v5,v112
MF v113,v5,v113
M v[64:67],a[76:79],v[176:179],v[64:67]
T a[104:105],v19,40960
T a[106:107],v19,43008
M v[64:67],a[80:83],v[192:195],v[64:67]
T a[108:109],v19,45056
T a[110:111],v19,47104
M v[64:67],a[84:87],v[208:211],v[64:67]
MF v114,v5,v114
MF v115,v5,v115
M v[64:67],a[88:91],v[224:227],v[64:67]
T a[112:113],v19,49152
T a[114:115],v19,51200
M v[64:67],a[92:95],v[240:243],v[64:67]
T a[116:117],v19,53248
T a[118:119],v19,55296
M v[68:71],a[92:95],v[244:247],0
MF v120,v5,v120
MF v121,v5,v121
M v[68:71],a[88:91],v[228:231],v[68:71]
T a[120:121],v19,57344
T a[122:123],v19,59392
M v[68:71],a[84:87],v[212:215],v[68:71]
T a[124:125],v19,61440
T a[126:127],v19,63488
M v[68:71],a[80:83],v[196:199],v[68:71]
MF v122,v5,v122
MF v123,v5,v123
M v[68:71],a[76:79],v[180:183],v[68:71]
C v112,v112,v113
C v113,v114,v115
M v[68:71],a[72:75],v[164:167],v[68:71]
C v114,v120,v121
C v115,v122,v123
M v[68:71],a[68:71],v[148:151],v[68:71]
buffer_store_dwordx4 v[112:115], v7, s[8:11], s29 offen offset:1024 sc1
M v[68:71],a[64:67],v[132:135],v[68:71]
s_waitcnt lgkmcnt(0)
MF v116,v6,v116
MF v117,v6,v117
M v[72:75],a[96:99],v[128:131],0
T a[64:65],v20,32768
T a[66:67],v20,34816
M v[72:75],a[100:103],v[144:147],v[72:75]
T a[68:69],v20,36864
T a[70:71],v20,38912
M v[72:75],a[104:107],v[160:163],v[72:75]
MF v118,v6,v118
MF v119,v6,v119
M v[72:75],a[108:111],v[176:179],v[72:75]
T a[72:73],v20,40960
T a[74:75],v20,43008
M v[72:75],a[112:115],v[192:195],v[72:75]
T a[76:77],v20,45056
T a[78:79],v20,47104
M v[72:75],a[116:119],v[208:211],v[72:75]
MF v124,v6,v124
MF v125,v6,v125
M v[72:75],a[120:123],v[224:227],v[72:75]
T a[80:81],v20,49152
T a[82:83],v20,51200
M v[72:75],a[124:127],v[240:243],v[72:75]
T a[84:85],v20,53248
T a[86:87],v20,55296
M v[76:79],a[124:127],v[244:247],0
MF v126,v6,v126
MF v127,v6,v127
M v[76:79],a[120:123],v[228:231],v[76:79]
T a[88:89],v20,57344
T a[90:91],v20,59392
M v[76:79],a[116:119],v[212:215],v[76:79]
T a[92:93],v20,61440
T a[94:95],v20,63488
M v[76:79],a[112:115],v[196:199],v[76:79]
C v116,v116,v117
C v117,v118,v119
M v[76:79],a[108:111],v[180:183],v[76:79]
C v118,v124,v125
C v119,v126,v127
M v[76:79],a[104:107],v[164:167],v[76:79]
buffer_store_dwordx4 v[116:119], v7, s[8:11], s30 offen offset:1024 sc1
M v[76:79],a[100:103],v[148:151],v[76:79]
SA s29,s33,12288
s_waitcnt vmcnt(12)
v_readlane_b32 s92, v31, 0
v_readlane_b32 s94, v31, 1
M v[76:79],a[96:99],v[132:135],v[76:79]
s_waitcnt lgkmcnt(0)
s_waitcnt vmcnt(9)
v_sub_f32 v30, 1.0, v26
s_waitcnt vmcnt(7)
v_lshlrev_b32 v48, 16, v44
M v[80:83],a[64:67],v[128:131],0
SA s30,s33,26624
T a[96:97],v21,32768
T a[98:99],v21,34816
M v[80:83],a[68:71],v[144:147],v[80:83]
T a[100:101],v21,36864
T a[102:103],v21,38912
M v[80:83],a[72:75],v[160:163],v[80:83]
v_and_b32 v49, 0xffff0000, v44
v_lshlrev_b32 v50, 16, v45
M v[80:83],a[76:79],v[176:179],v[80:83]
T a[104:105],v21,40960
T a[106:107],v21,43008
M v[80:83],a[80:83],v[192:195],v[80:83]
T a[108:109],v21,45056
T a[110:111],v21,47104
M v[80:83],a[84:87],v[208:211],v[80:83]
MF v64,v5,v64
MF v65,v5,v65
M v[80:83],a[88:91],v[224:227],v[80:83]
T a[112:113],v21,49152
T a[114:115],v21,51200
M v[80:83],a[92:95],v[240:243],v[80:83]
T a[116:117],v21,53248
T a[118:119],v21,55296
M v[84:87],a[92:95],v[244:247],0
MF v66,v5,v66
MF v67,v5,v67
M v[84:87],a[88:91],v[228:231],v[84:87]
T a[120:121],v21,57344
T a[122:123],v21,59392
M v[84:87],a[84:87],v[212:215],v[84:87]
T a[124:125],v21,61440
T a[126:127],v21,63488
M v[84:87],a[80:83],v[196:199],v[84:87]
MF v72,v5,v72
MF v73,v5,v73
M v[84:87],a[76:79],v[180:183],v[84:87]
MF v74,v5,v74
MF v75,v5,v75
M v[84:87],a[72:75],v[164:167],v[84:87]
C v64,v64,v65
C v65,v66,v67
M v[84:87],a[68:71],v[148:151],v[84:87]
C v66,v72,v73
C v67,v74,v75
M v[84:87],a[64:67],v[132:135],v[84:87]
s_waitcnt lgkmcnt(0)
buffer_store_dwordx4 v[64:67], v7, s[8:11], s29 offen offset:0 sc1
M v[88:91],a[96:99],v[128:131],0
v_and_b32 v51, 0xffff0000, v45
v_lshlrev_b32 v52, 16, v46
M v[88:91],a[100:103],v[144:147],v[88:91]
MF v68,v6,v68
MF v69,v6,v69
M v[88:91],a[104:107],v[160:163],v[88:91]
MF v70,v6,v70
MF v71,v6,v71
M v[88:91],a[108:111],v[176:179],v[88:91]
MF v76,v6,v76
MF v77,v6,v77
M v[88:91],a[112:115],v[192:195],v[88:91]
MF v78,v6,v78
MF v79,v6,v79
M v[88:91],a[116:119],v[208:211],v[88:91]
C v68,v68,v69
C v69,v70,v71
M v[88:91],a[120:123],v[224:227],v[88:91]
C v70,v76,v77
C v71,v78,v79
M v[88:91],a[124:127],v[240:243],v[88:91]
buffer_store_dwordx4 v[68:71], v7, s[8:11], s30 offen offset:0 sc1
M v[92:95],a[124:127],v[244:247],0
v_and_b32 v53, 0xffff0000, v46
v_lshlrev_b32 v54, 16, v47
M v[92:95],a[120:123],v[228:231],v[92:95]
v_and_b32 v55, 0xffff0000, v47
v_cmp_eq_u32 s[80:81], s92, v29
M v[92:95],a[116:119],v[212:215],v[92:95]
v_cmp_eq_u32 s[82:83], s94, v29
M v[92:95],a[112:115],v[196:199],v[92:95]
MF v80,v5,v80
MF v81,v5,v81
M v[92:95],a[108:111],v[180:183],v[92:95]
MF v82,v5,v82
MF v83,v5,v83
M v[92:95],a[104:107],v[164:167],v[92:95]
MF v88,v5,v88
MF v89,v5,v89
M v[92:95],a[100:103],v[148:151],v[92:95]
MF v90,v5,v90
MF v91,v5,v91
M v[92:95],a[96:99],v[132:135],v[92:95]
C v80,v80,v81
C v81,v82,v83
C v82,v88,v89
C v83,v90,v91
buffer_store_dwordx4 v[80:83], v7, s[8:11], s29 offen offset:1024 sc1
MF v84,v6,v84
MF v85,v6,v85
MF v86,v6,v86
MF v87,v6,v87
MF v92,v6,v92
MF v93,v6,v93
MF v94,v6,v94
MF v95,v6,v95
C v84,v84,v85
C v85,v86,v87
C v86,v92,v93
C v87,v94,v95
buffer_store_dwordx4 v[84:87], v7, s[8:11], s30 offen offset:1024 sc1
buffer_load_dword v9, v33, s[8:11], s46 offen sc1
s_waitcnt vmcnt(1)
buffer_store_dword v15, v16, s[8:11], s3 offen sc1
s_cmp_lt_u32 s42, 8
s_cbranch_scc1 L_red
s_waitcnt vmcnt(1)
v_cmp_eq_u32 vcc, 1, v9
s_mov_b32 s91, 65536
s_lshl_b32 s70, 1, s41
s_mov_b32 s69, 0xffff
s_or_b32 s70, s70, vcc_lo
s_mov_b32 s68, s70
s_barrier
s_cmp_lg_u32 s70, 0
s_cbranch_scc1 L_vk0
s_call_b64 s[36:37], L_rpoll
L_vk0:
s_ff1_i32_b32 s71, s70
s_bitset0_b32 s70, s71
s_mul_i32 s71, s71, 114688
SA s16,s71,s78
buffer_load_dwordx4 v[128:131], v27, s[8:11], s16 offen sc1
s_cmp_lg_u32 s70, 0
s_cbranch_scc1 L_vk1
s_call_b64 s[36:37], L_rpoll
L_vk1:
s_ff1_i32_b32 s71, s70
s_bitset0_b32 s70, s71
s_mul_i32 s71, s71, 114688
SA s17,s71,s78
buffer_load_dwordx4 v[132:135], v27, s[8:11], s17 offen sc1
s_cmp_lg_u32 s70, 0
s_cbranch_scc1 L_vk2
s_call_b64 s[36:37], L_rpoll
L_vk2:
s_ff1_i32_b32 s71, s70
s_bitset0_b32 s70, s71
s_mul_i32 s71, s71, 114688
SA s18,s71,s78
buffer_load_dwordx4 v[136:139], v27, s[8:11], s18 offen sc1
s_cmp_lg_u32 s70, 0
s_cbranch_scc1 L_vk3
s_call_b64 s[36:37], L_rpoll
L_vk3:
s_ff1_i32_b32 s71, s70
s_bitset0_b32 s70, s71
s_mul_i32 s71, s71, 114688
SA s19,s71,s78
buffer_load_dwordx4 v[140:143], v27, s[8:11], s19 offen sc1
s_cmp_lg_u32 s70, 0
s_cbranch_scc1 L_vk4
s_call_b64 s[36:37], L_rpoll
L_vk4:
s_ff1_i32_b32 s71, s70
s_bitset0_b32 s70, s71
s_mul_i32 s71, s71, 114688
SA s48,s71,s78
buffer_load_dwordx4 v[144:147], v27, s[8:11], s48 offen sc1
s_cmp_lg_u32 s70, 0
s_cbranch_scc1 L_vk5
s_call_b64 s[36:37], L_rpoll
L_vk5:
s_ff1_i32_b32 s71, s70
s_bitset0_b32 s70, s71
s_mul_i32 s71, s71, 114688
SA s49,s71,s78
buffer_load_dwordx4 v[148:151], v27, s[8:11], s49 offen sc1
s_cmp_lg_u32 s70, 0
s_cbranch_scc1 L_vk6
s_call_b64 s[36:37], L_rpoll
L_vk6:
s_ff1_i32_b32 s71, s70
s_bitset0_b32 s70, s71
s_mul_i32 s71, s71, 114688
SA s50,s71,s78
buffer_load_dwordx4 v[152:155], v27, s[8:11], s50 offen sc1
s_cmp_lg_u32 s70, 0
s_cbranch_scc1 L_vk7
s_call_b64 s[36:37], L_rpoll
L_vk7:
s_ff1_i32_b32 s71, s70
s_bitset0_b32 s70, s71
s_mul_i32 s71, s71, 114688
SA s51,s71,s78
buffer_load_dwordx4 v[156:159], v27, s[8:11], s51 offen sc1
s_or_b64 vcc, s[80:81], s[82:83]
s_cbranch_vccnz L_moe2
L_moe_ret2:
MF v48,v30,v48
MF v49,v30,v49
MF v50,v30,v50
MF v51,v30,v51
MF v52,v30,v52
MF v53,v30,v53
MF v54,v30,v54
MF v55,v30,v55
s_cmp_lg_u32 s70, 0
s_cbranch_scc1 L_vk8
s_call_b64 s[36:37], L_rpoll
L_vk8:
s_ff1_i32_b32 s71, s70
s_bitset0_b32 s70, s71
s_mul_i32 s71, s71, 114688
SA s21,s71,s78
buffer_load_dwordx4 v[160:163], v27, s[8:11], s21 offen sc1
s_waitcnt vmcnt(8)
M v[56:59],a[246:249],v[128:131],0
M v[60:63],a[244:247],v[128:131],0
s_cmp_lg_u32 s70, 0
s_cbranch_scc1 L_vk9
s_call_b64 s[36:37], L_rpoll
L_vk9:
s_ff1_i32_b32 s71, s70
s_bitset0_b32 s70, s71
s_mul_i32 s71, s71, 114688
SA s22,s71,s78
buffer_load_dwordx4 v[164:167], v27, s[8:11], s22 offen sc1
s_waitcnt vmcnt(8)
M v[56:59],a[246:249],v[132:135],v[56:59]
M v[60:63],a[244:247],v[132:135],v[60:63]
s_cmp_lg_u32 s70, 0
s_cbranch_scc1 L_vk10
s_call_b64 s[36:37], L_rpoll
L_vk10:
s_ff1_i32_b32 s71, s70
s_bitset0_b32 s70, s71
s_mul_i32 s71, s71, 114688
SA s23,s71,s78
buffer_load_dwordx4 v[168:171], v27, s[8:11], s23 offen sc1
s_waitcnt vmcnt(8)
M v[56:59],a[246:249],v[136:139],v[56:59]
M v[60:63],a[244:247],v[136:139],v[60:63]
s_cmp_lg_u32 s70, 0
s_cbranch_scc1 L_vk11
s_call_b64 s[36:37], L_rpoll
L_vk11:
s_ff1_i32_b32 s71, s70
s_bitset0_b32 s70, s71
s_mul_i32 s71, s71, 114688
SA s24,s71,s78
buffer_load_dwordx4 v[172:175], v27, s[8:11], s24 offen sc1
s_waitcnt vmcnt(8)
M v[56:59],a[246:249],v[140:143],v[56:59]
M v[60:63],a[244:247],v[140:143],v[60:63]
s_cmp_lg_u32 s70, 0
s_cbranch_scc1 L_vk12
s_call_b64 s[36:37], L_rpoll
L_vk12:
s_ff1_i32_b32 s71, s70
s_bitset0_b32 s70, s71
s_mul_i32 s71, s71, 114688
SA s25,s71,s78
buffer_load_dwordx4 v[176:179], v27, s[8:11], s25 offen sc1
s_waitcnt vmcnt(8)
M v[56:59],a[246:249],v[144:147],v[56:59]
M v[60:63],a[244:247],v[144:147],v[60:63]
s_cmp_lg_u32 s70, 0
s_cbranch_scc1 L_vk13
s_call_b64 s[36:37], L_rpoll
L_vk13:
s_ff1_i32_b32 s71, s70
s_bitset0_b32 s70, s71
s_mul_i32 s71, s71, 114688
SA s26,s71,s78
buffer_load_dwordx4 v[180:183], v27, s[8:11], s26 offen sc1
s_waitcnt vmcnt(8)
M v[56:59],a[246:249],v[148:151],v[56:59]
M v[60:63],a[244:247],v[148:151],v[60:63]
s_cmp_lg_u32 s70, 0
s_cbranch_scc1 L_vk14
s_call_b64 s[36:37], L_rpoll
L_vk14:
s_ff1_i32_b32 s71, s70
s_bitset0_b32 s70, s71
s_mul_i32 s71, s71, 114688
SA s27,s71,s78
buffer_load_dwordx4 v[184:187], v27, s[8:11], s27 offen sc1
s_waitcnt vmcnt(8)
M v[56:59],a[246:249],v[152:155],v[56:59]
M v[60:63],a[244:247],v[152:155],v[60:63]
s_cmp_lg_u32 s70, 0
s_cbranch_scc1 L_vk15
s_call_b64 s[36:37], L_rpoll
L_vk15:
s_ff1_i32_b32 s71, s70
s_bitset0_b32 s70, s71
s_mul_i32 s71, s71, 114688
SA s28,s71,s78
buffer_load_dwordx4 v[188:191], v27, s[8:11], s28 offen sc1
s_waitcnt vmcnt(8)
M v[56:59],a[246:249],v[156:159],v[56:59]
M v[60:63],a[244:247],v[156:159],v[60:63]
s_waitcnt vmcnt(7)
M v[56:59],a[246:249],v[160:163],v[56:59]
M v[60:63],a[244:247],v[160:163],v[60:63]
s_waitcnt vmcnt(6)
M v[56:59],a[246:249],v[164:167],v[56:59]
M v[60:63],a[244:247],v[164:167],v[60:63]
s_waitcnt vmcnt(5)
M v[56:59],a[246:249],v[168:171],v[56:59]
M v[60:63],a[244:247],v[168:171],v[60:63]
s_waitcnt vmcnt(4)
M v[56:59],a[246:249],v[172:175],v[56:59]
M v[60:63],a[244:247],v[172:175],v[60:63]
s_waitcnt vmcnt(3)
M v[56:59],a[246:249],v[176:179],v[56:59]
M v[60:63],a[244:247],v[176:179],v[60:63]
s_waitcnt vmcnt(2)
M v[56:59],a[246:249],v[180:183],v[56:59]
M v[60:63],a[244:247],v[180:183],v[60:63]
s_waitcnt vmcnt(1)
M v[56:59],a[246:249],v[184:187],v[56:59]
M v[60:63],a[244:247],v[184:187],v[60:63]
s_waitcnt vmcnt(0)
M v[56:59],a[246:249],v[188:191],v[56:59]
M v[60:63],a[244:247],v[188:191],v[60:63]
s_nop 7
v_permlane16_swap_b32 v56, v60
v_permlane16_swap_b32 v57, v61
v_permlane16_swap_b32 v58, v62
v_permlane16_swap_b32 v59, v63
v_fmac_f32 v48, v26, v56
v_fmac_f32 v49, v26, v57
v_fmac_f32 v50, v26, v58
v_fmac_f32 v51, v26, v59
v_fmac_f32 v52, v26, v60
v_fmac_f32 v53, v26, v61
v_fmac_f32 v54, v26, v62
v_fmac_f32 v55, v26, v63
C v44,v48,v49
C v45,v50,v51
C v46,v52,v53
C v47,v54,v55
buffer_store_dwordx4 v[44:47], v28, s[52:55], s79 offen sc1
s_endpgm
L_d2h:
M v[128:131],a[64:67],v[48:51],v[128:131]
R a[96:99],v7,40960
R a[100:103],v7,41984
M v[128:131],a[68:71],v[56:59],v[128:131]
SA m0,s28,135168
E v18,v64
M v[132:135],a[68:71],v[60:63],v[132:135]
buffer_load_dwordx4 v4, s[8:11], s26 offen offset:0 sc1 lds
M v[132:135],a[64:67],v[52:55],v[132:135]
R a[104:107],v7,43008
R a[108:111],v7,44032
M v[136:139],a[72:75],v[48:51],v[136:139]
s_cmp_gt_u32 s20, 3
E v19,v65
M v[136:139],a[76:79],v[56:59],v[136:139]
s_cselect_b64 s[82:83], -1, 0
AF v30,v28,v30
AF v31,v29,v31
M v[140:143],a[76:79],v[60:63],v[140:143]
s_cmp_eq_u32 s20, 3
R a[112:115],v7,45056
R a[116:119],v7,46080
M v[140:143],a[72:75],v[52:55],v[140:143]
s_cselect_b64 s[66:67], s[16:17], s[82:83]
buffer_load_dwordx4 v4, s[8:11], s26 offen offset:1024 sc1 lds
M v[144:147],a[80:83],v[48:51],v[144:147]
s_cselect_b64 s[68:69], s[18:19], s[82:83]
E v20,v66
M v[144:147],a[84:87],v[56:59],v[144:147]
s_cselect_b64 s[70:71], s[48:49], s[82:83]
R a[120:123],v7,47104
R a[124:127],v7,48128
M v[148:151],a[84:87],v[60:63],v[148:151]
s_cselect_b64 s[72:73], s[50:51], s[82:83]
v_cndmask_b32 v100, v36, v8, s[66:67]
v_cndmask_b32 v101, v36, v8, s[68:69]
M v[148:151],a[80:83],v[52:55],v[148:151]
buffer_load_dwordx4 v4, s[8:11], s26 offen offset:2048 sc1 lds
M v[152:155],a[88:91],v[48:51],v[152:155]
v_cndmask_b32 v102, v36, v8, s[70:71]
AF v26,v18,v19
M v[152:155],a[92:95],v[56:59],v[152:155]
E v21,v67
M v[156:159],a[92:95],v[60:63],v[156:159]
v_cndmask_b32 v103, v36, v8, s[72:73]
C v40,v18,v19
M v[156:159],a[88:91],v[52:55],v[156:159]
s_waitcnt lgkmcnt(0)
buffer_load_dwordx4 v4, s[8:11], s26 offen offset:3072 sc1 lds
M v[160:163],a[96:99],v[48:51],v[160:163]
s_cmp_gt_u32 s20, 2
R a[64:67],v7,49152
R a[68:71],v7,50176
M v[160:163],a[100:103],v[56:59],v[160:163]
s_cselect_b64 s[82:83], -1, 0
E v22,v72
M v[164:167],a[100:103],v[60:63],v[164:167]
s_cmp_eq_u32 s20, 2
AF v26,v20,v26
C v41,v20,v21
M v[164:167],a[96:99],v[52:55],v[164:167]
s_mul_i32 s21, s41, 1048576
R a[72:75],v7,51200
R a[76:79],v7,52224
M v[168:171],a[104:107],v[48:51],v[168:171]
s_cselect_b64 s[74:75], s[16:17], s[82:83]
E v23,v73
M v[168:171],a[108:111],v[56:59],v[168:171]
s_cselect_b64 s[76:77], s[18:19], s[82:83]
AF v26,v21,v26
AF v26,v22,v26
M v[172:175],a[108:111],v[60:63],v[172:175]
s_cselect_b64 s[78:79], s[48:49], s[82:83]
R a[80:83],v7,53248
R a[84:87],v7,54272
M v[172:175],a[104:107],v[52:55],v[172:175]
s_cselect_b64 s[80:81], s[50:51], s[82:83]
v_cndmask_b32 v108, v36, v8, s[74:75]
v_cndmask_b32 v109, v36, v8, s[76:77]
M v[176:179],a[112:115],v[48:51],v[176:179]
SA s21,s21,589824
E v24,v74
M v[176:179],a[116:119],v[56:59],v[176:179]
s_lshl_b32 s84, s42, 1
R a[88:91],v7,55296
R a[92:95],v7,56320
M v[180:183],a[116:119],v[60:63],v[180:183]
s_sub_u32 s22, 11, s84
v_cndmask_b32 v110, v36, v8, s[78:79]
C v42,v22,v23
M v[180:183],a[112:115],v[52:55],v[180:183]
s_mov_b32 s23, 536870912
s_waitcnt vmcnt(16)
v_cmp_gt_u32 vcc, 2, v5
AF v26,v23,v26
M v[184:187],a[120:123],v[48:51],v[184:187]
s_cbranch_vccnz L_lsh2
L_lrh2:
v_cndmask_b32 v111, v36, v8, s[80:81]
M v[184:187],a[124:127],v[56:59],v[184:187]
SA m0,s28,98304
E v25,v75
M v[188:191],a[124:127],v[60:63],v[188:191]
s_cmp_gt_u32 s20, 1
buffer_load_dwordx4 v3, s[8:11], s21 offen offset:0 sc1 lds
M v[188:191],a[120:123],v[52:55],v[188:191]
s_waitcnt lgkmcnt(0)
E v18,v68
M v[192:195],a[64:67],v[48:51],v[192:195]
s_cselect_b64 s[82:83], -1, 0
R a[96:99],v7,57344
R a[100:103],v7,58368
M v[192:195],a[68:71],v[56:59],v[192:195]
s_cmp_eq_u32 s20, 1
buffer_load_dwordx4 v3, s[8:11], s21 offen offset:1024 sc1 lds
M v[196:199],a[68:71],v[60:63],v[196:199]
s_cselect_b64 s[66:67], s[16:17], s[82:83]
E v19,v69
M v[196:199],a[64:67],v[52:55],v[196:199]
s_cselect_b64 s[68:69], s[18:19], s[82:83]
R a[104:107],v7,59392
R a[108:111],v7,60416
M v[200:203],a[72:75],v[48:51],v[200:203]
s_cselect_b64 s[70:71], s[48:49], s[82:83]
buffer_load_dwordx4 v3, s[8:11], s21 offen offset:2048 sc1 lds
M v[200:203],a[76:79],v[56:59],v[200:203]
s_cselect_b64 s[72:73], s[50:51], s[82:83]
v_cndmask_b32 v116, v36, v8, s[66:67]
v_cndmask_b32 v117, v36, v8, s[68:69]
M v[204:207],a[76:79],v[60:63],v[204:207]
R a[112:115],v7,61440
R a[116:119],v7,62464
M v[204:207],a[72:75],v[52:55],v[204:207]
v_cndmask_b32 v118, v36, v8, s[70:71]
AF v26,v24,v26
M v[208:211],a[80:83],v[48:51],v[208:211]
buffer_load_dwordx4 v3, s[8:11], s21 offen offset:3072 sc1 lds
M v[208:211],a[84:87],v[56:59],v[208:211]
SA m0,s28,102400
R a[120:123],v7,63488
R a[124:127],v7,64512
M v[212:215],a[84:87],v[60:63],v[212:215]
v_cndmask_b32 v119, v36, v8, s[72:73]
C v43,v24,v25
M v[212:215],a[80:83],v[52:55],v[212:215]
s_cmp_gt_u32 s20, 0
E v20,v70
M v[216:219],a[88:91],v[48:51],v[216:219]
s_cselect_b64 s[82:83], -1, 0
buffer_load_dwordx4 v4, s[8:11], s21 offen offset:0 sc1 lds
M v[216:219],a[92:95],v[56:59],v[216:219]
s_cmp_eq_u32 s20, 0
E v21,v71
M v[220:223],a[92:95],v[60:63],v[220:223]
s_waitcnt lgkmcnt(0)
E v22,v76
M v[220:223],a[88:91],v[52:55],v[220:223]
s_barrier
M v[224:227],a[96:99],v[48:51],v[224:227]
s_cselect_b64 s[74:75], s[16:17], s[82:83]
R a[64:67],v2,0
R a[68:71],v2,1024
M v[224:227],a[100:103],v[56:59],v[224:227]
s_cselect_b64 s[76:77], s[18:19], s[82:83]
buffer_load_dwordx4 v4, s[8:11], s21 offen offset:1024 sc1 lds
M v[228:231],a[100:103],v[60:63],v[228:231]
s_cselect_b64 s[78:79], s[48:49], s[82:83]
E v23,v77
M v[228:231],a[96:99],v[52:55],v[228:231]
s_cselect_b64 s[80:81], s[50:51], s[82:83]
R a[72:75],v2,2048
R a[76:79],v2,3072
M v[232:235],a[104:107],v[48:51],v[232:235]
v_cndmask_b32 v124, v36, v8, s[74:75]
v_cndmask_b32 v125, v36, v8, s[76:77]
M v[232:235],a[108:111],v[56:59],v[232:235]
buffer_load_dwordx4 v4, s[8:11], s21 offen offset:2048 sc1 lds
M v[236:239],a[108:111],v[60:63],v[236:239]
R a[80:83],v2,4096
R a[84:87],v2,5120
M v[236:239],a[104:107],v[52:55],v[236:239]
v_cndmask_b32 v126, v36, v8, s[78:79]
AF v26,v25,v26
M v[240:243],a[112:115],v[48:51],v[240:243]
v_cndmask_b32 v127, v36, v8, s[80:81]
AF v27,v18,v19
M v[240:243],a[116:119],v[56:59],v[240:243]
R a[88:91],v2,6144
R a[92:95],v2,7168
M v[244:247],a[116:119],v[60:63],v[244:247]
buffer_load_dwordx4 v4, s[8:11], s21 offen offset:3072 sc1 lds
M v[244:247],a[112:115],v[52:55],v[244:247]
SA s21,s21,32768
E v24,v78
M v[248:251],a[120:123],v[48:51],v[248:251]
s_sub_u32 s22, s22, 1
E v25,v79
M v[248:251],a[124:127],v[56:59],v[248:251]
s_cselect_b32 s21, s23, s21
C v44,v18,v19
AF v27,v20,v27
M v[252:255],a[124:127],v[60:63],v[252:255]
s_waitcnt lgkmcnt(0)
C v45,v20,v21
AF v27,v21,v27
M v[252:255],a[120:123],v[52:55],v[252:255]
AF v27,v22,v27
C v46,v22,v23
AF v27,v23,v27
AF v27,v24,v27
C v47,v24,v25
AF v27,v25,v27
L_d3h:
M v[100:103],a[64:67],a[32:35],v[100:103]
R a[96:99],v2,8192
R a[100:103],v2,9216
M v[100:103],a[68:71],a[36:39],v[100:103]
R a[104:107],v2,10240
R a[108:111],v2,11264
M v[100:103],a[72:75],a[40:43],v[100:103]
R a[112:115],v2,12288
R a[116:119],v2,13312
M v[100:103],a[76:79],a[44:47],v[100:103]
R a[120:123],v2,14336
R a[124:127],v2,15360
M v[100:103],a[80:83],a[48:51],v[100:103]
v_add_u32 v8, 0x20000, v7
M v[100:103],a[84:87],a[52:55],v[100:103]
buffer_load_dword v5, v9, s[8:11], s46 offen sc1
M v[100:103],a[88:91],a[56:59],v[100:103]
buffer_load_dword v6, off, s[8:11], s47 offset:16 sc1
M v[100:103],a[92:95],a[60:63],v[100:103]
s_waitcnt lgkmcnt(0)
E v18,v80
M v[108:111],a[96:99],a[32:35],v[108:111]
R a[64:67],v2,16384
R a[68:71],v2,17408
M v[108:111],a[100:103],a[36:39],v[108:111]
R a[72:75],v2,18432
R a[76:79],v2,19456
M v[108:111],a[104:107],a[40:43],v[108:111]
R a[80:83],v2,20480
R a[84:87],v2,21504
M v[108:111],a[108:111],a[44:47],v[108:111]
R a[88:91],v2,22528
R a[92:95],v2,23552
M v[108:111],a[112:115],a[48:51],v[108:111]
E v19,v81
M v[108:111],a[116:119],a[52:55],v[108:111]
E v20,v82
M v[108:111],a[120:123],a[56:59],v[108:111]
E v21,v83
M v[108:111],a[124:127],a[60:63],v[108:111]
s_waitcnt lgkmcnt(0)
E v22,v88
M v[116:119],a[64:67],a[32:35],v[116:119]
R a[96:99],v2,24576
R a[100:103],v2,25600
M v[116:119],a[68:71],a[36:39],v[116:119]
R a[104:107],v2,26624
R a[108:111],v2,27648
M v[116:119],a[72:75],a[40:43],v[116:119]
R a[112:115],v2,28672
R a[116:119],v2,29696
M v[116:119],a[76:79],a[44:47],v[116:119]
R a[120:123],v2,30720
R a[124:127],v2,31744
M v[116:119],a[80:83],a[48:51],v[116:119]
E v23,v89
M v[116:119],a[84:87],a[52:55],v[116:119]
E v24,v90
M v[116:119],a[88:91],a[56:59],v[116:119]
s_waitcnt vmcnt(18) lgkmcnt(0)
E v25,v91
M v[116:119],a[92:95],a[60:63],v[116:119]
s_barrier
M v[124:127],a[96:99],a[32:35],v[124:127]
R a[64:67],v7,0
R a[68:71],v7,1024
M v[124:127],a[100:103],a[36:39],v[124:127]
R a[72:75],v7,2048
R a[76:79],v7,3072
M v[124:127],a[104:107],a[40:43],v[124:127]
R a[80:83],v7,4096
R a[84:87],v7,5120
M v[124:127],a[108:111],a[44:47],v[124:127]
R a[88:91],v7,6144
R a[92:95],v7,7168
M v[124:127],a[112:115],a[48:51],v[124:127]
AF v26,v18,v26
C v56,v18,v19
M v[124:127],a[116:119],a[52:55],v[124:127]
AF v26,v19,v26
AF v26,v20,v26
M v[124:127],a[120:123],a[56:59],v[124:127]
s_waitcnt lgkmcnt(0)
E v18,v84
M v[124:127],a[124:127],a[60:63],v[124:127]
E v19,v85
C v57,v20,v21
AF v26,v21,v26
AF v26,v22,v26
C v58,v22,v23
AF v26,v23,v26
AF v26,v24,v26
C v59,v24,v25
AF v26,v25,v26
E v20,v86
E v21,v87
AF v27,v18,v27
C v60,v18,v19
AF v27,v19,v27
E v22,v92
E v23,v93
AF v27,v20,v27
C v61,v20,v21
AF v27,v21,v27
E v24,v94
E v25,v95
AF v27,v22,v27
C v62,v22,v23
AF v27,v23,v27
AF v27,v24,v27
C v63,v24,v25
AF v27,v25,v27
v_max_f32 v10, v26, v27
v_cmp_lt_f32 vcc, s31, v10
s_nop 0
s_cbranch_vccnz L_std3h
L_rtd3h:
M v[128:131],a[64:67],v[40:43],v[128:131]
R a[96:99],v7,8192
R a[100:103],v7,9216
M v[128:131],a[68:71],v[56:59],v[128:131]
s_waitcnt vmcnt(0)
v_cmp_ne_u32 vcc, 1, v6
AF v30,v26,v30
M v[132:135],a[68:71],v[60:63],v[132:135]
s_cbranch_vccnz L_fqs
L_fqr:
E v18,v100
M v[132:135],a[64:67],v[44:47],v[132:135]
SA s73,s32,4096
R a[104:107],v7,10240
R a[108:111],v7,11264
M v[136:139],a[72:75],v[40:43],v[136:139]
SA s74,s32,8192
E v19,v101
M v[136:139],a[76:79],v[56:59],v[136:139]
SA s75,s32,12288
buffer_load_dwordx4 a[0:3], v7, s[8:11], s32 offen offset:0 sc1
M v[140:143],a[76:79],v[60:63],v[140:143]
R a[112:115],v7,12288
R a[116:119],v7,13312
M v[140:143],a[72:75],v[44:47],v[140:143]
E v20,v102
M v[144:147],a[80:83],v[40:43],v[144:147]
buffer_load_dwordx4 a[4:7], v7, s[8:11], s32 offen offset:1024 sc1
M v[144:147],a[84:87],v[56:59],v[144:147]
R a[120:123],v7,14336
R a[124:127],v7,15360
M v[148:151],a[84:87],v[60:63],v[148:151]
AF v31,v27,v31
AF v29,v18,v19
M v[148:151],a[80:83],v[44:47],v[148:151]
buffer_load_dwordx4 a[8:11], v7, s[8:11], s32 offen offset:2048 sc1
M v[152:155],a[88:91],v[40:43],v[152:155]
E v21,v103
M v[152:155],a[92:95],v[56:59],v[152:155]
C v52,v18,v19
AF v29,v20,v29
M v[156:159],a[92:95],v[60:63],v[156:159]
buffer_load_dwordx4 a[12:15], v7, s[8:11], s32 offen offset:3072 sc1
M v[156:159],a[88:91],v[44:47],v[156:159]
s_waitcnt lgkmcnt(0)
E v22,v108
M v[160:163],a[96:99],v[40:43],v[160:163]
R a[64:67],v7,16384
R a[68:71],v7,17408
M v[160:163],a[100:103],v[56:59],v[160:163]
buffer_load_dwordx4 a[16:19], v7, s[8:11], s73 offen offset:0 sc1
M v[164:167],a[100:103],v[60:63],v[164:167]
E v23,v109
M v[164:167],a[96:99],v[44:47],v[164:167]
R a[72:75],v7,18432
R a[76:79],v7,19456
M v[168:171],a[104:107],v[40:43],v[168:171]
buffer_load_dwordx4 a[20:23], v7, s[8:11], s73 offen offset:1024 sc1
M v[168:171],a[108:111],v[56:59],v[168:171]
C v53,v20,v21
AF v29,v21,v29
M v[172:175],a[108:111],v[60:63],v[172:175]
R a[80:83],v7,20480
R a[84:87],v7,21504
M v[172:175],a[104:107],v[44:47],v[172:175]
buffer_load_dwordx4 a[24:27], v7, s[8:11], s73 offen offset:2048 sc1
M v[176:179],a[112:115],v[40:43],v[176:179]
E v24,v110
M v[176:179],a[116:119],v[56:59],v[176:179]
R a[88:91],v7,22528
R a[92:95],v7,23552
M v[180:183],a[116:119],v[60:63],v[180:183]
buffer_load_dwordx4 a[28:31], v7, s[8:11], s73 offen offset:3072 sc1
M v[180:183],a[112:115],v[44:47],v[180:183]
E v25,v111
M v[184:187],a[120:123],v[40:43],v[184:187]
AF v29,v22,v29
C v54,v22,v23
M v[184:187],a[124:127],v[56:59],v[184:187]
buffer_load_dwordx4 a[32:35], v7, s[8:11], s74 offen offset:0 sc1
M v[188:191],a[124:127],v[60:63],v[188:191]
E v18,v116
M v[188:191],a[120:123],v[44:47],v[188:191]
s_waitcnt lgkmcnt(0)
AF v29,v23,v29
AF v29,v24,v29
M v[192:195],a[64:67],v[40:43],v[192:195]
R a[96:99],v7,24576
R a[100:103],v7,25600
M v[192:195],a[68:71],v[56:59],v[192:195]
buffer_load_dwordx4 a[36:39], v7, s[8:11], s74 offen offset:1024 sc1
M v[196:199],a[68:71],v[60:63],v[196:199]
E v19,v117
M v[196:199],a[64:67],v[44:47],v[196:199]
R a[104:107],v7,26624
R a[108:111],v7,27648
M v[200:203],a[72:75],v[40:43],v[200:203]
buffer_load_dwordx4 a[40:43], v7, s[8:11], s74 offen offset:2048 sc1
M v[200:203],a[76:79],v[56:59],v[200:203]
E v20,v118
M v[204:207],a[76:79],v[60:63],v[204:207]
R a[112:115],v7,28672
R a[116:119],v7,29696
M v[204:207],a[72:75],v[44:47],v[204:207]
buffer_load_dwordx4 a[44:47], v7, s[8:11], s74 offen offset:3072 sc1
M v[208:211],a[80:83],v[40:43],v[208:211]
C v55,v24,v25
AF v29,v25,v29
M v[208:211],a[84:87],v[56:59],v[208:211]
R a[120:123],v7,30720
R a[124:127],v7,31744
M v[212:215],a[84:87],v[60:63],v[212:215]
buffer_load_dwordx4 a[48:51], v7, s[8:11], s75 offen offset:0 sc1
M v[212:215],a[80:83],v[44:47],v[212:215]
E v21,v119
M v[216:219],a[88:91],v[40:43],v[216:219]
AF v29,v18,v29
C v48,v18,v19
M v[216:219],a[92:95],v[56:59],v[216:219]
buffer_load_dwordx4 a[52:55], v7, s[8:11], s75 offen offset:1024 sc1
M v[220:223],a[92:95],v[60:63],v[220:223]
s_waitcnt lgkmcnt(0)
E v22,v124
M v[220:223],a[88:91],v[44:47],v[220:223]
s_barrier
M v[224:227],a[96:99],v[40:43],v[224:227]
R a[64:67],v8,0
R a[68:71],v8,1024
M v[224:227],a[100:103],v[56:59],v[224:227]
buffer_load_dwordx4 a[56:59], v7, s[8:11], s75 offen offset:2048 sc1
M v[228:231],a[100:103],v[60:63],v[228:231]
v_mov_b32 v15, 4
AF v29,v19,v29
M v[228:231],a[96:99],v[44:47],v[228:231]
R a[72:75],v8,2048
R a[76:79],v8,3072
M v[232:235],a[104:107],v[40:43],v[232:235]
buffer_store_dword v15, v1, s[8:11], s45 offen sc1
M v[232:235],a[108:111],v[56:59],v[232:235]
buffer_load_dwordx4 a[60:63], v7, s[8:11], s75 offen offset:3072 sc1
M v[236:239],a[108:111],v[60:63],v[236:239]
s_cmp_ge_u32 s42, 2
R a[80:83],v8,4096
R a[84:87],v8,5120
M v[236:239],a[104:107],v[44:47],v[236:239]
s_cselect_b32 s84, 4, 2
v_cmp_gt_u32 vcc, s84, v5
AF v29,v20,v29
M v[240:243],a[112:115],v[40:43],v[240:243]
s_cbranch_vccnz L_lsh4
L_lrh4:
E v23,v125
M v[240:243],a[116:119],v[56:59],v[240:243]
R a[88:91],v8,6144
R a[92:95],v8,7168
M v[244:247],a[116:119],v[60:63],v[244:247]
E v24,v126
M v[244:247],a[112:115],v[44:47],v[244:247]
E v25,v127
M v[248:251],a[120:123],v[40:43],v[248:251]
C v49,v20,v21
AF v29,v21,v29
M v[248:251],a[124:127],v[56:59],v[248:251]
AF v29,v22,v29
C v50,v22,v23
M v[252:255],a[124:127],v[60:63],v[252:255]
s_waitcnt lgkmcnt(0)
AF v29,v23,v29
AF v29,v24,v29
M v[252:255],a[120:123],v[44:47],v[252:255]
C v51,v24,v25
AF v29,v25,v29
v_cmp_lt_f32 vcc, s31, v29
s_nop 0
s_cbranch_vccnz L_std4h
L_rtd4h:
M v[132:135],a[64:67],v[52:55],v[132:135]
R a[96:99],v8,8192
R a[100:103],v8,9216
M v[132:135],a[68:71],v[48:51],v[132:135]
R a[104:107],v8,10240
R a[108:111],v8,11264
M v[140:143],a[72:75],v[52:55],v[140:143]
SA m0,s28,65536
R a[112:115],v8,12288
R a[116:119],v8,13312
M v[140:143],a[76:79],v[48:51],v[140:143]
R a[120:123],v8,14336
R a[124:127],v8,15360
M v[148:151],a[80:83],v[52:55],v[148:151]
buffer_load_dwordx4 v3, s[8:11], s21 offen offset:0 sc1 lds
M v[148:151],a[84:87],v[48:51],v[148:151]
AF v31,v29,v31
v_mov_b32 v10, v30
M v[156:159],a[88:91],v[52:55],v[156:159]
v_mov_b32 v11, v31
C v128,v128,v129
M v[156:159],a[92:95],v[48:51],v[156:159]
s_waitcnt lgkmcnt(0)
v_permlane16_swap_b32 v10, v30
M v[164:167],a[96:99],v[52:55],v[164:167]
R a[64:67],v8,16384
R a[68:71],v8,17408
M v[164:167],a[100:103],v[48:51],v[164:167]
R a[72:75],v8,18432
R a[76:79],v8,19456
M v[172:175],a[104:107],v[52:55],v[172:175]
R a[80:83],v8,20480
R a[84:87],v8,21504
M v[172:175],a[108:111],v[48:51],v[172:175]
R a[88:91],v8,22528
R a[92:95],v8,23552
M v[180:183],a[112:115],v[52:55],v[180:183]
buffer_load_dwordx4 v3, s[8:11], s21 offen offset:1024 sc1 lds
M v[180:183],a[116:119],v[48:51],v[180:183]
v_permlane16_swap_b32 v11, v31
M v[188:191],a[120:123],v[52:55],v[188:191]
AF v30,v10,v30
AF v31,v11,v31
M v[188:191],a[124:127],v[48:51],v[188:191]
s_waitcnt lgkmcnt(0)
buffer_load_dwordx4 v3, s[8:11], s21 offen offset:2048 sc1 lds
M v[196:199],a[64:67],v[52:55],v[196:199]
R a[96:99],v8,24576
R a[100:103],v8,25600
M v[196:199],a[68:71],v[48:51],v[196:199]
R a[104:107],v8,26624
R a[108:111],v8,27648
M v[204:207],a[72:75],v[52:55],v[204:207]
R a[112:115],v8,28672
R a[116:119],v8,29696
M v[204:207],a[76:79],v[48:51],v[204:207]
R a[120:123],v8,30720
R a[124:127],v8,31744
M v[212:215],a[80:83],v[52:55],v[212:215]
buffer_load_dwordx4 v3, s[8:11], s21 offen offset:3072 sc1 lds
M v[212:215],a[84:87],v[48:51],v[212:215]
SA m0,s28,69632
v_mov_b32 v10, v30
v_mov_b32 v11, v31
M v[220:223],a[88:91],v[52:55],v[220:223]
s_waitcnt lgkmcnt(0)
v_permlane32_swap_b32 v10, v30
M v[220:223],a[92:95],v[48:51],v[220:223]
s_barrier
M v[228:231],a[96:99],v[52:55],v[228:231]
R a[64:67],v2,32768
R a[68:71],v2,33792
M v[228:231],a[100:103],v[48:51],v[228:231]
R a[72:75],v2,34816
R a[76:79],v2,35840
M v[236:239],a[104:107],v[52:55],v[236:239]
R a[80:83],v2,36864
R a[84:87],v2,37888
M v[236:239],a[108:111],v[48:51],v[236:239]
R a[88:91],v2,38912
R a[92:95],v2,39936
M v[244:247],a[112:115],v[52:55],v[244:247]
v_permlane32_swap_b32 v11, v31
M v[244:247],a[116:119],v[48:51],v[244:247]
s_waitcnt vmcnt(4)
buffer_load_dwordx4 v4, s[8:11], s21 offen offset:0 sc1 lds
M v[252:255],a[120:123],v[52:55],v[252:255]
s_waitcnt lgkmcnt(0)
AF v30,v10,v30
AF v31,v11,v31
M v[252:255],a[124:127],v[48:51],v[252:255]
v_rcp_f32 v5, v30
M v[64:67],a[64:67],a[0:3],0
R a[96:99],v2,40960
R a[100:103],v2,41984
M v[64:67],a[68:71],a[4:7],v[64:67]
v_rcp_f32 v6, v31
M v[64:67],a[72:75],a[8:11],v[64:67]
buffer_load_dwordx4 v4, s[8:11], s21 offen offset:1024 sc1 lds
M v[64:67],a[76:79],a[12:15],v[64:67]
R a[104:107],v2,43008
R a[108:111],v2,44032
M v[64:67],a[80:83],a[16:19],v[64:67]
W a192,v5
W a193,v6
M v[64:67],a[84:87],a[20:23],v[64:67]
buffer_load_dwordx4 v4, s[8:11], s21 offen offset:2048 sc1 lds
M v[64:67],a[88:91],a[24:27],v[64:67]
R a[112:115],v2,45056
R a[116:119],v2,46080
M v[64:67],a[92:95],a[28:31],v[64:67]
v_mov_b32 v30, 0
v_mov_b32 v31, 0
M v[68:71],a[92:95],a[60:63],0
buffer_load_dwordx4 v4, s[8:11], s21 offen offset:3072 sc1 lds
M v[68:71],a[88:91],a[56:59],v[68:71]
SA s21,s21,32768
R a[120:123],v2,47104
R a[124:127],v2,48128
M v[68:71],a[84:87],a[52:55],v[68:71]
s_sub_u32 s22, s22, 1
v_mov_b32 v32, 0
v_mov_b32 v33, 0
M v[68:71],a[80:83],a[48:51],v[68:71]
s_cselect_b32 s21, s23, s21
v_mov_b32 v34, 0
v_mov_b32 v35, 0
M v[68:71],a[76:79],a[44:47],v[68:71]
s_mul_i32 s26, s41, 1048576
v_mov_b32 v36, 0
v_mov_b32 v37, 0
M v[68:71],a[72:75],a[40:43],v[68:71]
SA s26,s26,17367040
v_mov_b32 v38, 0
v_mov_b32 v39, 0
M v[68:71],a[68:71],a[36:39],v[68:71]
SA m0,s28,0
E v18,v64
M v[68:71],a[64:67],a[32:35],v[68:71]
s_waitcnt lgkmcnt(0)
buffer_load_dwordx4 v3, s[8:11], s26 offen offset:0 sc1 lds
M v[72:75],a[96:99],a[0:3],0
R a[64:67],v2,49152
R a[68:71],v2,50176
M v[72:75],a[100:103],a[4:7],v[72:75]
E v19,v65
M v[72:75],a[104:107],a[8:11],v[72:75]
buffer_load_dwordx4 v3, s[8:11], s26 offen offset:1024 sc1 lds
M v[72:75],a[108:111],a[12:15],v[72:75]
R a[72:75],v2,51200
R a[76:79],v2,52224
M v[72:75],a[112:115],a[16:19],v[72:75]
E v20,v66
M v[72:75],a[116:119],a[20:23],v[72:75]
buffer_load_dwordx4 v3, s[8:11], s26 offen offset:2048 sc1 lds
M v[72:75],a[120:123],a[24:27],v[72:75]
R a[80:83],v2,53248
R a[84:87],v2,54272
M v[72:75],a[124:127],a[28:31],v[72:75]
E v21,v67
M v[76:79],a[124:127],a[60:63],0
buffer_load_dwordx4 v3, s[8:11], s26 offen offset:3072 sc1 lds
M v[76:79],a[120:123],a[56:59],v[76:79]
SA m0,s28,4096
R a[88:91],v2,55296
R a[92:95],v2,56320
M v[76:79],a[116:119],a[52:55],v[76:79]
E v22,v68
M v[76:79],a[112:115],a[48:51],v[76:79]
E v23,v69
M v[76:79],a[108:111],a[44:47],v[76:79]
buffer_load_dwordx4 v4, s[8:11], s26 offen offset:0 sc1 lds
M v[76:79],a[104:107],a[40:43],v[76:79]
AF v26,v18,v19
C v40,v18,v19
M v[76:79],a[100:103],a[36:39],v[76:79]
E v24,v70
M v[76:79],a[96:99],a[32:35],v[76:79]
s_waitcnt lgkmcnt(0)
AF v26,v20,v26
C v41,v20,v21
M v[80:83],a[64:67],a[0:3],0
R a[96:99],v2,57344
R a[100:103],v2,58368
M v[80:83],a[68:71],a[4:7],v[80:83]
buffer_load_dwordx4 v4, s[8:11], s26 offen offset:1024 sc1 lds
M v[80:83],a[72:75],a[8:11],v[80:83]
E v25,v71
M v[80:83],a[76:79],a[12:15],v[80:83]
R a[104:107],v2,59392
R a[108:111],v2,60416
M v[80:83],a[80:83],a[16:19],v[80:83]
AF v26,v21,v26
AF v27,v22,v23
M v[80:83],a[84:87],a[20:23],v[80:83]
buffer_load_dwordx4 v4, s[8:11], s26 offen offset:2048 sc1 lds
M v[80:83],a[88:91],a[24:27],v[80:83]
R a[112:115],v2,61440
R a[116:119],v2,62464
M v[80:83],a[92:95],a[28:31],v[80:83]
E v18,v72
M v[84:87],a[92:95],a[60:63],0
E v19,v73
M v[84:87],a[88:91],a[56:59],v[84:87]
R a[120:123],v2,63488
R a[124:127],v2,64512
M v[84:87],a[84:87],a[52:55],v[84:87]
buffer_load_dwordx4 v4, s[8:11], s26 offen offset:3072 sc1 lds
M v[84:87],a[80:83],a[48:51],v[84:87]
SA s26,s26,32768
E v20,v74
M v[84:87],a[76:79],a[44:47],v[84:87]
SA m0,s28,32768
C v44,v22,v23
AF v27,v24,v27
M v[84:87],a[72:75],a[40:43],v[84:87]
C v45,v24,v25
AF v27,v25,v27
M v[84:87],a[68:71],a[36:39],v[84:87]
s_waitcnt vmcnt(8) lgkmcnt(0)
buffer_load_dwordx4 v3, s[8:11], s26 offen offset:0 sc1 lds
M v[84:87],a[64:67],a[32:35],v[84:87]
s_barrier
M v[88:91],a[96:99],a[0:3],0
R a[64:67],v2,0
R a[68:71],v2,1024
M v[88:91],a[100:103],a[4:7],v[88:91]
E v21,v75
M v[88:91],a[104:107],a[8:11],v[88:91]
buffer_load_dwordx4 v3, s[8:11], s26 offen offset:1024 sc1 lds
M v[88:91],a[108:111],a[12:15],v[88:91]
R a[72:75],v2,2048
R a[76:79],v2,3072
M v[88:91],a[112:115],a[16:19],v[88:91]
E v22,v76
M v[88:91],a[116:119],a[20:23],v[88:91]
E v23,v77
M v[88:91],a[120:123],a[24:27],v[88:91]
R a[80:83],v2,4096
R a[84:87],v2,5120
M v[88:91],a[124:127],a[28:31],v[88:91]
buffer_load_dwordx4 v3, s[8:11], s26 offen offset:2048 sc1 lds
M v[92:95],a[124:127],a[60:63],0
E v24,v78
M v[92:95],a[120:123],a[56:59],v[92:95]
R a[88:91],v2,6144
R a[92:95],v2,7168
M v[92:95],a[116:119],a[52:55],v[92:95]
E v25,v79
M v[92:95],a[112:115],a[48:51],v[92:95]
buffer_load_dwordx4 v3, s[8:11], s26 offen offset:3072 sc1 lds
M v[92:95],a[108:111],a[44:47],v[92:95]
AF v26,v18,v26
C v42,v18,v19
M v[92:95],a[104:107],a[40:43],v[92:95]
AF v26,v19,v26
AF v26,v20,v26
M v[92:95],a[100:103],a[36:39],v[92:95]
s_waitcnt lgkmcnt(0)
C v43,v20,v21
AF v26,v21,v26
M v[92:95],a[96:99],a[32:35],v[92:95]
AF v27,v22,v27
C v46,v22,v23
AF v27,v23,v27
AF v27,v24,v27
C v47,v24,v25
AF v27,v25,v27
M v[96:99],a[64:67],a[0:3],0
R a[96:99],v2,8192
R a[100:103],v2,9216
M v[96:99],a[68:71],a[4:7],v[96:99]
SA m0,s28,98304
E v18,v80
M v[96:99],a[72:75],a[8:11],v[96:99]
buffer_load_dwordx4 v3, s[8:11], s21 offen offset:0 sc1 lds
M v[96:99],a[76:79],a[12:15],v[96:99]
R a[104:107],v2,10240
R a[108:111],v2,11264
M v[96:99],a[80:83],a[16:19],v[96:99]
E v19,v81
M v[96:99],a[84:87],a[20:23],v[96:99]
AF v26,v18,v26
C v56,v18,v19
M v[96:99],a[88:91],a[24:27],v[96:99]
R a[112:115],v2,12288
R a[116:119],v2,13312
M v[96:99],a[92:95],a[28:31],v[96:99]
buffer_load_dwordx4 v3, s[8:11], s21 offen offset:1024 sc1 lds
M v[100:103],a[92:95],a[60:63],0
E v20,v82
M v[100:103],a[88:91],a[56:59],v[100:103]
R a[120:123],v2,14336
R a[124:127],v2,15360
M v[100:103],a[84:87],a[52:55],v[100:103]
E v21,v83
M v[100:103],a[80:83],a[48:51],v[100:103]
buffer_load_dwordx4 v3, s[8:11], s21 offen offset:2048 sc1 lds
M v[100:103],a[76:79],a[44:47],v[100:103]
AF v26,v19,v26
AF v26,v20,v26
M v[100:103],a[72:75],a[40:43],v[100:103]
E v22,v88
M v[100:103],a[68:71],a[36:39],v[100:103]
C v57,v20,v21
AF v26,v21,v26
M v[100:103],a[64:67],a[32:35],v[100:103]
s_waitcnt lgkmcnt(0)
buffer_load_dwordx4 v3, s[8:11], s21 offen offset:3072 sc1 lds
M v[104:107],a[96:99],a[0:3],0
R a[64:67],v2,16384
R a[68:71],v2,17408
M v[104:107],a[100:103],a[4:7],v[104:107]
E v23,v89
M v[104:107],a[104:107],a[8:11],v[104:107]
SA m0,s28,102400
AF v26,v22,v26
C v58,v22,v23
M v[104:107],a[108:111],a[12:15],v[104:107]
R a[72:75],v2,18432
R a[76:79],v2,19456
M v[104:107],a[112:115],a[16:19],v[104:107]
buffer_load_dwordx4 v4, s[8:11], s21 offen offset:0 sc1 lds
M v[104:107],a[116:119],a[20:23],v[104:107]
E v24,v90
M v[104:107],a[120:123],a[24:27],v[104:107]
R a[80:83],v2,20480
R a[84:87],v2,21504
M v[104:107],a[124:127],a[28:31],v[104:107]
E v25,v91
M v[108:111],a[124:127],a[60:63],0
buffer_load_dwordx4 v4, s[8:11], s21 offen offset:1024 sc1 lds
M v[108:111],a[120:123],a[56:59],v[108:111]
R a[88:91],v2,22528
R a[92:95],v2,23552
M v[108:111],a[116:119],a[52:55],v[108:111]
AF v26,v23,v26
AF v26,v24,v26
M v[108:111],a[112:115],a[48:51],v[108:111]
E v18,v84
M v[108:111],a[108:111],a[44:47],v[108:111]
buffer_load_dwordx4 v4, s[8:11], s21 offen offset:2048 sc1 lds
M v[108:111],a[104:107],a[40:43],v[108:111]
C v59,v24,v25
AF v26,v25,v26
M v[108:111],a[100:103],a[36:39],v[108:111]
E v19,v85
M v[108:111],a[96:99],a[32:35],v[108:111]
s_waitcnt lgkmcnt(0)
AF v27,v18,v27
C v60,v18,v19
M v[112:115],a[64:67],a[0:3],0
R a[96:99],v2,24576
R a[100:103],v2,25600
M v[112:115],a[68:71],a[4:7],v[112:115]
buffer_load_dwordx4 v4, s[8:11], s21 offen offset:3072 sc1 lds
M v[112:115],a[72:75],a[8:11],v[112:115]
SA s21,s21,32768
E v20,v86
M v[112:115],a[76:79],a[12:15],v[112:115]
s_sub_u32 s22, s22, 1
R a[104:107],v2,26624
R a[108:111],v2,27648
M v[112:115],a[80:83],a[16:19],v[112:115]
s_cselect_b32 s21, s23, s21
AF v27,v19,v27
C v129,v130,v131
M v[112:115],a[84:87],a[20:23],v[112:115]
SA m0,s28,36864
E v21,v87
M v[112:115],a[88:91],a[24:27],v[112:115]
R a[112:115],v2,28672
R a[116:119],v2,29696
M v[112:115],a[92:95],a[28:31],v[112:115]
buffer_load_dwordx4 v4, s[8:11], s26 offen offset:0 sc1 lds
M v[116:119],a[92:95],a[60:63],0
E v22,v92
M v[116:119],a[88:91],a[56:59],v[116:119]
R a[120:123],v2,30720
R a[124:127],v2,31744
M v[116:119],a[84:87],a[52:55],v[116:119]
AF v27,v20,v27
C v61,v20,v21
M v[116:119],a[80:83],a[48:51],v[116:119]
buffer_load_dwordx4 v4, s[8:11], s26 offen offset:1024 sc1 lds
M v[116:119],a[76:79],a[44:47],v[116:119]
E v23,v93
M v[116:119],a[72:75],a[40:43],v[116:119]
AF v27,v21,v27
AF v27,v22,v27
M v[116:119],a[68:71],a[36:39],v[116:119]
s_waitcnt vmcnt(14) lgkmcnt(0)
C v62,v22,v23
AF v27,v23,v27
M v[116:119],a[64:67],a[32:35],v[116:119]
s_barrier
M v[120:123],a[96:99],a[0:3],0
R a[64:67],v7,0
R a[68:71],v7,1024
M v[120:123],a[100:103],a[4:7],v[120:123]
buffer_load_dwordx4 v4, s[8:11], s26 offen offset:2048 sc1 lds
M v[120:123],a[104:107],a[8:11],v[120:123]
E v24,v94
M v[120:123],a[108:111],a[12:15],v[120:123]
R a[72:75],v7,2048
R a[76:79],v7,3072
M v[120:123],a[112:115],a[16:19],v[120:123]
E v25,v95
M v[120:123],a[116:119],a[20:23],v[120:123]
buffer_load_dwordx4 v4, s[8:11], s26 offen offset:3072 sc1 lds
M v[120:123],a[120:123],a[24:27],v[120:123]
R a[80:83],v7,4096
R a[84:87],v7,5120
M v[120:123],a[124:127],a[28:31],v[120:123]
AF v27,v24,v27
C v63,v24,v25
M v[124:127],a[124:127],a[60:63],0
SA s26,s26,32768
AF v27,v25,v27
C v130,v136,v137
M v[124:127],a[120:123],a[56:59],v[124:127]
R a[88:91],v7,6144
R a[92:95],v7,7168
C v131,v138,v139
W a128,v128
W a129,v129
W a130,v130
W a131,v131
C v144,v144,v145
C v145,v146,v147
C v146,v152,v153
C v147,v154,v155
W a132,v144
W a133,v145
W a134,v146
W a135,v147
C v132,v132,v133
C v133,v134,v135
C v134,v140,v141
C v135,v142,v143
W a160,v132
W a161,v133
W a162,v134
W a163,v135
C v160,v160,v161
C v161,v162,v163
C v162,v168,v169
C v163,v170,v171
W a136,v160
W a137,v161
W a138,v162
W a139,v163
C v148,v148,v149
C v149,v150,v151
C v150,v156,v157
C v151,v158,v159
W a164,v148
W a165,v149
W a166,v150
W a167,v151
C v176,v176,v177
C v177,v178,v179
C v178,v184,v185
C v179,v186,v187
W a140,v176
W a141,v177
W a142,v178
W a143,v179
C v164,v164,v165
C v165,v166,v167
C v166,v172,v173
C v167,v174,v175
W a168,v164
W a169,v165
W a170,v166
W a171,v167
C v192,v192,v193
C v193,v194,v195
C v194,v200,v201
C v195,v202,v203
W a144,v192
W a145,v193
W a146,v194
W a147,v195
C v180,v180,v181
C v181,v182,v183
C v182,v188,v189
C v183,v190,v191
W a172,v180
W a173,v181
W a174,v182
W a175,v183
C v208,v208,v209
C v209,v210,v211
C v210,v216,v217
C v211,v218,v219
W a148,v208
W a149,v209
W a150,v210
W a151,v211
C v196,v196,v197
C v197,v198,v199
C v198,v204,v205
C v199,v206,v207
W a176,v196
W a177,v197
W a178,v198
W a179,v199
C v224,v224,v225
C v225,v226,v227
C v226,v232,v233
C v227,v234,v235
W a152,v224
W a153,v225
W a154,v226
W a155,v227
C v212,v212,v213
C v213,v214,v215
C v214,v220,v221
C v215,v222,v223
W a180,v212
W a181,v213
W a182,v214
W a183,v215
C v240,v240,v241
C v241,v242,v243
C v242,v248,v249
C v243,v250,v251
W a156,v240
W a157,v241
W a158,v242
W a159,v243
C v228,v228,v229
C v229,v230,v231
C v230,v236,v237
C v231,v238,v239
W a184,v228
W a185,v229
W a186,v230
W a187,v231
C v244,v244,v245
C v245,v246,v247
C v246,v252,v253
C v247,v254,v255
W a188,v244
W a189,v245
W a190,v246
W a191,v247
M v[124:127],a[116:119],a[52:55],v[124:127]
M v[124:127],a[112:115],a[48:51],v[124:127]
M v[124:127],a[108:111],a[44:47],v[124:127]
M v[124:127],a[104:107],a[40:43],v[124:127]
M v[124:127],a[100:103],a[36:39],v[124:127]
s_waitcnt lgkmcnt(0)
M v[124:127],a[96:99],a[32:35],v[124:127]
v_max_f32 v10, v26, v27
v_min_f32 v11, v26, v27
v_cmp_lt_f32 vcc, s31, v10
v_cmp_gt_f32 s[64:65], s24, v11
s_nop 0
s_or_b64 vcc, vcc, s[64:65]
s_cbranch_vccnz L_sth1
L_rth1:
M v[128:131],a[64:67],v[40:43],0
R a[96:99],v7,8192
R a[100:103],v7,9216
M v[128:131],a[68:71],v[56:59],v[128:131]
SA m0,s28,65536
E v18,v96
M v[132:135],a[68:71],v[60:63],0
buffer_load_dwordx4 v3, s[8:11], s21 offen offset:0 sc1 lds
M v[132:135],a[64:67],v[44:47],v[132:135]
R a[104:107],v7,10240
R a[108:111],v7,11264
M v[136:139],a[72:75],v[40:43],0
E v19,v97
M v[136:139],a[76:79],v[56:59],v[136:139]
AF v30,v26,v30
AF v31,v27,v31
M v[140:143],a[76:79],v[60:63],0
R a[112:115],v7,12288
R a[116:119],v7,13312
M v[140:143],a[72:75],v[44:47],v[140:143]
buffer_load_dwordx4 v3, s[8:11], s21 offen offset:1024 sc1 lds
M v[144:147],a[80:83],v[40:43],0
E v20,v98
M v[144:147],a[84:87],v[56:59],v[144:147]
R a[120:123],v7,14336
R a[124:127],v7,15360
M v[148:151],a[84:87],v[60:63],0
s_mov_b32 s40, 0
AF v28,v18,v19
C v48,v18,v19
M v[148:151],a[80:83],v[44:47],v[148:151]
s_mov_b32 s7, 0
buffer_load_dwordx4 v3, s[8:11], s21 offen offset:2048 sc1 lds
M v[152:155],a[88:91],v[40:43],0
s_and_b32 s39, s39, 1
E v21,v99
M v[152:155],a[92:95],v[56:59],v[152:155]
s_or_b32 s39, s39, 2
AF v28,v20,v28
C v49,v20,v21
M v[156:159],a[92:95],v[60:63],0
s_sub_u32 s27, 5, s42
AF v28,v21,v28
M v[156:159],a[88:91],v[44:47],v[156:159]
s_waitcnt lgkmcnt(0)
buffer_load_dwordx4 v3, s[8:11], s21 offen offset:3072 sc1 lds
M v[160:163],a[96:99],v[40:43],0
SA m0,s28,69632
R a[64:67],v7,16384
R a[68:71],v7,17408
M v[160:163],a[100:103],v[56:59],v[160:163]
E v22,v104
M v[164:167],a[100:103],v[60:63],0
E v23,v105
M v[164:167],a[96:99],v[44:47],v[164:167]
R a[72:75],v7,18432
R a[76:79],v7,19456
M v[168:171],a[104:107],v[40:43],0
buffer_load_dwordx4 v4, s[8:11], s21 offen offset:0 sc1 lds
M v[168:171],a[108:111],v[56:59],v[168:171]
AF v28,v22,v28
C v50,v22,v23
M v[172:175],a[108:111],v[60:63],0
R a[80:83],v7,20480
R a[84:87],v7,21504
M v[172:175],a[104:107],v[44:47],v[172:175]
buffer_load_dwordx4 v4, s[8:11], s21 offen offset:1024 sc1 lds
M v[176:179],a[112:115],v[40:43],0
E v24,v106
M v[176:179],a[116:119],v[56:59],v[176:179]
R a[88:91],v7,22528
R a[92:95],v7,23552
M v[180:183],a[116:119],v[60:63],0
buffer_load_dwordx4 v4, s[8:11], s21 offen offset:2048 sc1 lds
M v[180:183],a[112:115],v[44:47],v[180:183]
E v25,v107
M v[184:187],a[120:123],v[40:43],0
AF v28,v23,v28
AF v28,v24,v28
M v[184:187],a[124:127],v[56:59],v[184:187]
C v51,v24,v25
AF v28,v25,v28
M v[188:191],a[124:127],v[60:63],0
buffer_load_dwordx4 v4, s[8:11], s21 offen offset:3072 sc1 lds
M v[188:191],a[120:123],v[44:47],v[188:191]
s_waitcnt lgkmcnt(0)
E v18,v100
M v[192:195],a[64:67],v[40:43],0
SA s21,s21,32768
R a[96:99],v7,24576
R a[100:103],v7,25600
M v[192:195],a[68:71],v[56:59],v[192:195]
s_sub_u32 s22, s22, 1
E v19,v101
M v[196:199],a[68:71],v[60:63],0
s_cselect_b32 s21, s23, s21
AF v29,v18,v19
C v52,v18,v19
M v[196:199],a[64:67],v[44:47],v[196:199]
R a[104:107],v7,26624
R a[108:111],v7,27648
M v[200:203],a[72:75],v[40:43],0
M v[200:203],a[76:79],v[56:59],v[200:203]
E v20,v102
M v[204:207],a[76:79],v[60:63],0
R a[112:115],v7,28672
R a[116:119],v7,29696
M v[204:207],a[72:75],v[44:47],v[204:207]
M v[208:211],a[80:83],v[40:43],0
M v[208:211],a[84:87],v[56:59],v[208:211]
R a[120:123],v7,30720
R a[124:127],v7,31744
M v[212:215],a[84:87],v[60:63],0
E v21,v103
M v[212:215],a[80:83],v[44:47],v[212:215]
AF v29,v20,v29
C v53,v20,v21
M v[216:219],a[88:91],v[40:43],0
AF v29,v21,v29
M v[216:219],a[92:95],v[56:59],v[216:219]
E v22,v108
M v[220:223],a[92:95],v[60:63],0
s_waitcnt vmcnt(12) lgkmcnt(0)
M v[220:223],a[88:91],v[44:47],v[220:223]
s_barrier
M v[224:227],a[96:99],v[40:43],0
R a[64:67],v2,32768
R a[68:71],v2,33792
M v[224:227],a[100:103],v[56:59],v[224:227]
E v23,v109
M v[228:231],a[100:103],v[60:63],0
AF v29,v22,v29
C v54,v22,v23
M v[228:231],a[96:99],v[44:47],v[228:231]
R a[72:75],v2,34816
R a[76:79],v2,35840
M v[232:235],a[104:107],v[40:43],0
E v24,v110
M v[232:235],a[108:111],v[56:59],v[232:235]
AF v29,v23,v29
M v[236:239],a[108:111],v[60:63],0
R a[80:83],v2,36864
R a[84:87],v2,37888
M v[236:239],a[104:107],v[44:47],v[236:239]
M v[240:243],a[112:115],v[40:43],0
E v25,v111
M v[240:243],a[116:119],v[56:59],v[240:243]
R a[88:91],v2,38912
R a[92:95],v2,39936
M v[244:247],a[116:119],v[60:63],0
AF v29,v24,v29
C v55,v24,v25
M v[244:247],a[112:115],v[44:47],v[244:247]
AF v29,v25,v29
M v[248:251],a[120:123],v[40:43],0
M v[248:251],a[124:127],v[56:59],v[248:251]
M v[252:255],a[124:127],v[60:63],0
s_waitcnt lgkmcnt(0)
M v[252:255],a[120:123],v[44:47],v[252:255]
s_cmp_lg_u32 s27, 0
s_cbranch_scc1 L_loop_top
L_final_h:
s_waitcnt vmcnt(8) lgkmcnt(0)
s_barrier
R a[64:67],v7,32768
R a[68:71],v7,33792
R a[72:75],v7,34816
R a[76:79],v7,35840
R a[80:83],v7,36864
R a[84:87],v7,37888
R a[88:91],v7,38912
R a[92:95],v7,39936
v_lshrrev_b32 v14, 7, v7
v_mul_u32_u24 v14, 896, v14
v_lshrrev_b32 v15, 8, v7
v_lshlrev_b32 v15, 5, v15
v_xor_b32 v15, v15, v7
v_and_b32 v15, 0x70, v15
v_add_u32 v0, v14, v15
s_mul_i32 s38, s20, 57344
SA m0,s28,98304
SA s85,s38,0
E v18,v112
buffer_load_dwordx4 v0, s[12:15], s85 offen offset:0 lds
E v19,v113
E v20,v114
AF v28,v18,v28
SA s85,s38,6144
C v56,v18,v19
buffer_load_dwordx4 v0, s[12:15], s85 offen offset:1024 lds
E v21,v115
AF v28,v19,v28
E v22,v120
AF v28,v20,v28
SA s85,s38,12288
C v57,v20,v21
buffer_load_dwordx4 v0, s[12:15], s85 offen offset:2048 lds
E v23,v121
AF v28,v21,v28
E v24,v122
AF v28,v22,v28
SA s85,s38,18432
C v58,v22,v23
buffer_load_dwordx4 v0, s[12:15], s85 offen offset:3072 lds
E v25,v123
AF v28,v23,v28
E v18,v116
AF v28,v24,v28
SA m0,s28,102400
SA s85,s38,28672
C v59,v24,v25
buffer_load_dwordx4 v0, s[12:15], s85 offen offset:0 lds
E v19,v117
AF v28,v25,v28
E v20,v118
AF v29,v18,v29
SA s85,s38,34816
C v60,v18,v19
buffer_load_dwordx4 v0, s[12:15], s85 offen offset:1024 lds
E v21,v119
AF v29,v19,v29
E v22,v124
AF v29,v20,v29
SA s85,s38,40960
C v61,v20,v21
buffer_load_dwordx4 v0, s[12:15], s85 offen offset:2048 lds
E v23,v125
AF v29,v21,v29
E v24,v126
AF v29,v22,v29
SA s85,s38,47104
C v62,v22,v23
buffer_load_dwordx4 v0, s[12:15], s85 offen offset:3072 lds
SA s38,s38,128
E v25,v127
AF v29,v23,v29
AF v29,v24,v29
C v63,v24,v25
AF v29,v25,v29
v_max_f32 v10, v28, v29
v_cmp_lt_f32 vcc, s31, v10
s_nop 0
s_cbranch_vccnz L_stfh
L_rtfh:
AF v30,v28,v30
AF v31,v29,v31
v_mov_b32 v10, v32
v_mov_b32 v11, v36
v_mov_b32 v12, v30
v_mov_b32 v13, v31
buffer_store_dwordx4 v[10:13], v7, s[8:11], s90 offen sc1
s_waitcnt lgkmcnt(0)
M v[128:131],a[64:67],v[48:51],v[128:131]
SA m0,s28,65536
R a[96:99],v7,40960
R a[100:103],v7,41984
M v[128:131],a[68:71],v[56:59],v[128:131]
SA s85,s38,0
buffer_load_dwordx4 v0, s[12:15], s85 offen offset:0 lds
M v[132:135],a[68:71],v[60:63],v[132:135]
SA s85,s38,6144
v_lshrrev_b32 v16, 4, v7
v_lshrrev_b32 v14, 2, v16
M v[132:135],a[64:67],v[52:55],v[132:135]
R a[104:107],v7,43008
R a[108:111],v7,44032
M v[136:139],a[72:75],v[48:51],v[136:139]
buffer_load_dwordx4 v0, s[12:15], s85 offen offset:1024 lds
M v[136:139],a[76:79],v[56:59],v[136:139]
SA s85,s38,12288
v_lshlrev_b32 v14, 7, v14
v_and_b32 v15, 3, v16
M v[140:143],a[76:79],v[60:63],v[140:143]
R a[112:115],v7,45056
R a[116:119],v7,46080
M v[140:143],a[72:75],v[52:55],v[140:143]
buffer_load_dwordx4 v0, s[12:15], s85 offen offset:2048 lds
M v[144:147],a[80:83],v[48:51],v[144:147]
SA s85,s38,18432
v_lshl_add_u32 v14, v15, 3, v14
v_bfe_u32 v15, v16, 3, 2
M v[144:147],a[84:87],v[56:59],v[144:147]
R a[120:123],v7,47104
R a[124:127],v7,48128
M v[148:151],a[84:87],v[60:63],v[148:151]
buffer_load_dwordx4 v0, s[12:15], s85 offen offset:3072 lds
M v[148:151],a[80:83],v[52:55],v[148:151]
v_lshl_add_u32 v18, v15, 5, v14
v_xor_b32 v19, 32, v18
M v[152:155],a[88:91],v[48:51],v[152:155]
v_xor_b32 v20, 64, v18
v_xor_b32 v21, 0x60, v18
M v[152:155],a[92:95],v[56:59],v[152:155]
v_add_u32 v22, 0x10000, v18
v_add_u32 v23, 0x10000, v19
M v[156:159],a[92:95],v[60:63],v[156:159]
v_add_u32 v24, 0x10000, v20
v_add_u32 v25, 0x10000, v21
M v[156:159],a[88:91],v[52:55],v[156:159]
s_waitcnt lgkmcnt(0)
C v128,v128,v129
C v129,v130,v131
M v[160:163],a[96:99],v[48:51],v[160:163]
R a[64:67],v7,49152
R a[68:71],v7,50176
M v[160:163],a[100:103],v[56:59],v[160:163]
C v130,v136,v137
C v131,v138,v139
M v[164:167],a[100:103],v[60:63],v[164:167]
buffer_store_dwordx4 v[128:131], v7, s[8:11], s86 offen offset:0 sc1
M v[164:167],a[96:99],v[52:55],v[164:167]
R a[72:75],v7,51200
R a[76:79],v7,52224
M v[168:171],a[104:107],v[48:51],v[168:171]
C v132,v132,v133
C v133,v134,v135
M v[168:171],a[108:111],v[56:59],v[168:171]
C v134,v140,v141
C v135,v142,v143
M v[172:175],a[108:111],v[60:63],v[172:175]
R a[80:83],v7,53248
R a[84:87],v7,54272
M v[172:175],a[104:107],v[52:55],v[172:175]
buffer_store_dwordx4 v[132:135], v7, s[8:11], s88 offen offset:0 sc1
M v[176:179],a[112:115],v[48:51],v[176:179]
C v144,v144,v145
C v145,v146,v147
M v[176:179],a[116:119],v[56:59],v[176:179]
R a[88:91],v7,55296
R a[92:95],v7,56320
M v[180:183],a[116:119],v[60:63],v[180:183]
C v146,v152,v153
C v147,v154,v155
M v[180:183],a[112:115],v[52:55],v[180:183]
buffer_store_dwordx4 v[144:147], v7, s[8:11], s86 offen offset:1024 sc1
M v[184:187],a[120:123],v[48:51],v[184:187]
C v148,v148,v149
C v149,v150,v151
M v[184:187],a[124:127],v[56:59],v[184:187]
C v150,v156,v157
C v151,v158,v159
M v[188:191],a[124:127],v[60:63],v[188:191]
buffer_store_dwordx4 v[148:151], v7, s[8:11], s88 offen offset:1024 sc1
M v[188:191],a[120:123],v[52:55],v[188:191]
s_waitcnt lgkmcnt(0)
C v160,v160,v161
C v161,v162,v163
M v[192:195],a[64:67],v[48:51],v[192:195]
R a[96:99],v7,57344
R a[100:103],v7,58368
M v[192:195],a[68:71],v[56:59],v[192:195]
C v162,v168,v169
C v163,v170,v171
M v[196:199],a[68:71],v[60:63],v[196:199]
buffer_store_dwordx4 v[160:163], v7, s[8:11], s86 offen offset:2048 sc1
M v[196:199],a[64:67],v[52:55],v[196:199]
R a[104:107],v7,59392
R a[108:111],v7,60416
M v[200:203],a[72:75],v[48:51],v[200:203]
C v164,v164,v165
C v165,v166,v167
M v[200:203],a[76:79],v[56:59],v[200:203]
C v166,v172,v173
C v167,v174,v175
M v[204:207],a[76:79],v[60:63],v[204:207]
R a[112:115],v7,61440
R a[116:119],v7,62464
M v[204:207],a[72:75],v[52:55],v[204:207]
buffer_store_dwordx4 v[164:167], v7, s[8:11], s88 offen offset:2048 sc1
M v[208:211],a[80:83],v[48:51],v[208:211]
C v176,v176,v177
C v177,v178,v179
M v[208:211],a[84:87],v[56:59],v[208:211]
R a[120:123],v7,63488
R a[124:127],v7,64512
M v[212:215],a[84:87],v[60:63],v[212:215]
C v178,v184,v185
C v179,v186,v187
M v[212:215],a[80:83],v[52:55],v[212:215]
buffer_store_dwordx4 v[176:179], v7, s[8:11], s86 offen offset:3072 sc1
M v[216:219],a[88:91],v[48:51],v[216:219]
C v180,v180,v181
C v181,v182,v183
M v[216:219],a[92:95],v[56:59],v[216:219]
C v182,v188,v189
C v183,v190,v191
M v[220:223],a[92:95],v[60:63],v[220:223]
s_waitcnt vmcnt(12) lgkmcnt(0)
buffer_store_dwordx4 v[180:183], v7, s[8:11], s88 offen offset:3072 sc1
M v[220:223],a[88:91],v[52:55],v[220:223]
s_barrier
M v[224:227],a[96:99],v[48:51],v[224:227]
s_nop 0
T a[64:65],v22,32768
T a[66:67],v22,34816
M v[224:227],a[100:103],v[56:59],v[224:227]
T a[68:69],v22,36864
T a[70:71],v22,38912
M v[228:231],a[100:103],v[60:63],v[228:231]
C v192,v192,v193
C v193,v194,v195
M v[228:231],a[96:99],v[52:55],v[228:231]
T a[72:73],v22,40960
T a[74:75],v22,43008
M v[232:235],a[104:107],v[48:51],v[232:235]
T a[76:77],v22,45056
T a[78:79],v22,47104
M v[232:235],a[108:111],v[56:59],v[232:235]
C v194,v200,v201
C v195,v202,v203
M v[236:239],a[108:111],v[60:63],v[236:239]
T a[80:81],v22,49152
T a[82:83],v22,51200
M v[236:239],a[104:107],v[52:55],v[236:239]
T a[84:85],v22,53248
T a[86:87],v22,55296
M v[240:243],a[112:115],v[48:51],v[240:243]
buffer_store_dwordx4 v[192:195], v7, s[8:11], s87 offen offset:0 sc1
M v[240:243],a[116:119],v[56:59],v[240:243]
s_nop 0
T a[88:89],v22,57344
T a[90:91],v22,59392
M v[244:247],a[116:119],v[60:63],v[244:247]
T a[92:93],v22,61440
T a[94:95],v22,63488
M v[244:247],a[112:115],v[52:55],v[244:247]
C v196,v196,v197
C v197,v198,v199
M v[248:251],a[120:123],v[48:51],v[248:251]
C v198,v204,v205
C v199,v206,v207
M v[248:251],a[124:127],v[56:59],v[248:251]
buffer_store_dwordx4 v[196:199], v7, s[8:11], s89 offen offset:0 sc1
M v[252:255],a[124:127],v[60:63],v[252:255]
s_waitcnt lgkmcnt(0)
C v208,v208,v209
C v209,v210,v211
M v[252:255],a[120:123],v[52:55],v[252:255]
C v210,v216,v217
C v211,v218,v219
buffer_store_dwordx4 v[208:211], v7, s[8:11], s87 offen offset:1024 sc1
C v212,v212,v213
C v213,v214,v215
C v214,v220,v221
C v215,v222,v223
buffer_store_dwordx4 v[212:215], v7, s[8:11], s89 offen offset:1024 sc1
C v224,v224,v225
C v225,v226,v227
C v226,v232,v233
C v227,v234,v235
buffer_store_dwordx4 v[224:227], v7, s[8:11], s87 offen offset:2048 sc1
C v228,v228,v229
C v229,v230,v231
C v230,v236,v237
C v231,v238,v239
buffer_store_dwordx4 v[228:231], v7, s[8:11], s89 offen offset:2048 sc1
C v240,v240,v241
C v241,v242,v243
C v242,v248,v249
C v243,v250,v251
buffer_store_dwordx4 v[240:243], v7, s[8:11], s87 offen offset:3072 sc1
C v244,v244,v245
C v245,v246,v247
C v246,v252,v253
C v247,v254,v255
buffer_store_dwordx4 v[244:247], v7, s[8:11], s89 offen offset:3072 sc1
M v[64:67],a[64:67],a[128:131],0
s_nop 0
T a[96:97],v23,32768
T a[98:99],v23,34816
M v[64:67],a[68:71],a[132:135],v[64:67]
SA m0,s28,69632
T a[100:101],v23,36864
T a[102:103],v23,38912
M v[64:67],a[72:75],a[136:139],v[64:67]
SA s85,s38,28672
buffer_load_dwordx4 v0, s[12:15], s85 offen offset:0 lds
M v[64:67],a[76:79],a[140:143],v[64:67]
SA s85,s38,34816
T a[104:105],v23,40960
T a[106:107],v23,43008
M v[64:67],a[80:83],a[144:147],v[64:67]
SA s29,s33,0
T a[108:109],v23,45056
T a[110:111],v23,47104
M v[64:67],a[84:87],a[148:151],v[64:67]
SA s30,s33,14336
buffer_load_dwordx4 v0, s[12:15], s85 offen offset:1024 lds
M v[64:67],a[88:91],a[152:155],v[64:67]
SA s85,s38,40960
T a[112:113],v23,49152
T a[114:115],v23,51200
M v[64:67],a[92:95],a[156:159],v[64:67]
T a[116:117],v23,53248
T a[118:119],v23,55296
M v[68:71],a[92:95],a[188:191],0
buffer_load_dwordx4 v0, s[12:15], s85 offen offset:2048 lds
M v[68:71],a[88:91],a[184:187],v[68:71]
SA s85,s38,47104
T a[120:121],v23,57344
T a[122:123],v23,59392
M v[68:71],a[84:87],a[180:183],v[68:71]
T a[124:125],v23,61440
T a[126:127],v23,63488
M v[68:71],a[80:83],a[176:179],v[68:71]
buffer_load_dwordx4 v0, s[12:15], s85 offen offset:3072 lds
M v[68:71],a[76:79],a[172:175],v[68:71]
SA s38,s38,128
G v5,a192
G v6,a193
M v[68:71],a[72:75],a[168:171],v[68:71]
s_sub_u32 s64, 15, s42
M v[68:71],a[68:71],a[164:167],v[68:71]
s_min_u32 s64, s64, s42
M v[68:71],a[64:67],a[160:163],v[68:71]
s_waitcnt lgkmcnt(0)
M v[72:75],a[96:99],a[128:131],0
s_mul_i32 s45, s64, 8704
T a[64:65],v24,32768
T a[66:67],v24,34816
M v[72:75],a[100:103],a[132:135],v[72:75]
s_lshl_b32 s64, s41, 2
T a[68:69],v24,36864
T a[70:71],v24,38912
M v[72:75],a[104:107],a[136:139],v[72:75]
SA s45,s45,s64
M v[72:75],a[108:111],a[140:143],v[72:75]
s_lshl_b32 s64, s20, 8
T a[72:73],v24,40960
T a[74:75],v24,43008
M v[72:75],a[112:115],a[144:147],v[72:75]
SA s45,s45,s64
T a[76:77],v24,45056
T a[78:79],v24,47104
M v[72:75],a[116:119],a[148:151],v[72:75]
SA s45,s45,104992768
M v[72:75],a[120:123],a[152:155],v[72:75]
s_mov_b32 s64, 1024
T a[80:81],v24,49152
T a[82:83],v24,51200
M v[72:75],a[124:127],a[156:159],v[72:75]
s_mov_b32 s66, 4096
T a[84:85],v24,53248
T a[86:87],v24,55296
M v[76:79],a[124:127],a[188:191],0
s_cmp_lt_u32 s42, 8
M v[76:79],a[120:123],a[184:187],v[76:79]
s_cselect_b32 s64, 4352, s64
T a[88:89],v24,57344
T a[90:91],v24,59392
M v[76:79],a[116:119],a[180:183],v[76:79]
s_cselect_b32 s65, 0, 64
T a[92:93],v24,61440
T a[94:95],v24,63488
M v[76:79],a[112:115],a[176:179],v[76:79]
s_cselect_b32 s66, 536870912, s66
MF v64,v5,v64
MF v65,v5,v65
M v[76:79],a[108:111],a[172:175],v[76:79]
SA s3,s45,s64
MF v66,v5,v66
MF v67,v5,v67
M v[76:79],a[104:107],a[168:171],v[76:79]
SA s45,s45,s65
v_lshrrev_b32 v17, 5, v7
v_min_u32 v15, 1, v17
M v[76:79],a[100:103],a[164:167],v[76:79]
SA m0,s28,0
v_lshlrev_b32 v14, 3, v7
v_lshl_or_b32 v16, v15, 29, v14
M v[76:79],a[96:99],a[160:163],v[76:79]
s_waitcnt lgkmcnt(0)
v_cmp_eq_u32 vcc, 1, v17
v_add_u32 v14, s66, v14
M v[80:83],a[64:67],a[128:131],0
SA s85,s38,0
T a[96:97],v25,32768
T a[98:99],v25,34816
M v[80:83],a[68:71],a[132:135],v[80:83]
T a[100:101],v25,36864
T a[102:103],v25,38912
M v[80:83],a[72:75],a[136:139],v[80:83]
buffer_load_dwordx4 v0, s[12:15], s85 offen offset:0 lds
M v[80:83],a[76:79],a[140:143],v[80:83]
SA s85,s38,6144
T a[104:105],v25,40960
T a[106:107],v25,43008
M v[80:83],a[80:83],a[144:147],v[80:83]
T a[108:109],v25,45056
T a[110:111],v25,47104
M v[80:83],a[84:87],a[148:151],v[80:83]
buffer_load_dwordx4 v0, s[12:15], s85 offen offset:1024 lds
M v[80:83],a[88:91],a[152:155],v[80:83]
SA s85,s38,12288
T a[112:113],v25,49152
T a[114:115],v25,51200
M v[80:83],a[92:95],a[156:159],v[80:83]
T a[116:117],v25,53248
T a[118:119],v25,55296
M v[84:87],a[92:95],a[188:191],0
buffer_load_dwordx4 v0, s[12:15], s85 offen offset:2048 lds
M v[84:87],a[88:91],a[184:187],v[84:87]
SA s85,s38,18432
T a[120:121],v25,57344
T a[122:123],v25,59392
M v[84:87],a[84:87],a[180:183],v[84:87]
T a[124:125],v25,61440
T a[126:127],v25,63488
M v[84:87],a[80:83],a[176:179],v[84:87]
buffer_load_dwordx4 v0, s[12:15], s85 offen offset:3072 lds
M v[84:87],a[76:79],a[172:175],v[84:87]
SA m0,s28,4096
v_mov_b32 v15, 1
v_cndmask_b32 v17, v16, v14, vcc
M v[84:87],a[72:75],a[168:171],v[84:87]
SA s85,s38,28672
buffer_load_dwordx4 v0, s[12:15], s85 offen offset:0 lds
M v[84:87],a[68:71],a[164:167],v[84:87]
s_waitcnt vmcnt(5) lgkmcnt(0)
v_min_u32 v10, 1, v7
v_lshlrev_b32 v10, 29, v10
M v[84:87],a[64:67],a[160:163],v[84:87]
s_barrier
M v[88:91],a[96:99],a[128:131],0
SA s85,s38,34816
T a[64:65],v22,0
T a[66:67],v22,2048
M v[88:91],a[100:103],a[132:135],v[88:91]
T a[68:69],v22,4096
T a[70:71],v22,6144
M v[88:91],a[104:107],a[136:139],v[88:91]
buffer_load_dwordx4 v0, s[12:15], s85 offen offset:1024 lds
M v[88:91],a[108:111],a[140:143],v[88:91]
SA s85,s38,40960
T a[72:73],v22,8192
T a[74:75],v22,10240
M v[88:91],a[112:115],a[144:147],v[88:91]
T a[76:77],v22,12288
T a[78:79],v22,14336
M v[88:91],a[116:119],a[148:151],v[88:91]
buffer_load_dwordx4 v0, s[12:15], s85 offen offset:2048 lds
M v[88:91],a[120:123],a[152:155],v[88:91]
SA s85,s38,47104
T a[80:81],v22,16384
T a[82:83],v22,18432
M v[88:91],a[124:127],a[156:159],v[88:91]
T a[84:85],v22,20480
T a[86:87],v22,22528
M v[92:95],a[124:127],a[188:191],0
buffer_store_dword v15, v10, s[8:11], s47 offen sc1
M v[92:95],a[120:123],a[184:187],v[92:95]
s_nop 0
T a[88:89],v22,24576
T a[90:91],v22,26624
M v[92:95],a[116:119],a[180:183],v[92:95]
T a[92:93],v22,28672
T a[94:95],v22,30720
M v[92:95],a[112:115],a[176:179],v[92:95]
buffer_load_dwordx4 v0, s[12:15], s85 offen offset:3072 lds
M v[92:95],a[108:111],a[172:175],v[92:95]
SA s38,s38,128
MF v72,v5,v72
MF v73,v5,v73
M v[92:95],a[104:107],a[168:171],v[92:95]
SA m0,s28,131072
MF v74,v5,v74
MF v75,v5,v75
M v[92:95],a[100:103],a[164:167],v[92:95]
s_waitcnt lgkmcnt(0)
C v64,v64,v65
C v65,v66,v67
M v[92:95],a[96:99],a[160:163],v[92:95]
SA s85,s38,0
C v66,v72,v73
C v67,v74,v75
buffer_store_dwordx4 v[64:67], v7, s[8:11], s29 offen offset:0 sc1
buffer_load_dwordx4 v0, s[12:15], s85 offen offset:0 lds
v_add_u32 v40, 0x20000, v18
v_add_u32 v41, 0x20000, v19
v_add_u32 v42, 0x20000, v20
v_add_u32 v43, 0x20000, v21
SA s85,s38,6144
MF v68,v6,v68
MF v69,v6,v69
MF v70,v6,v70
MF v71,v6,v71
MF v76,v6,v76
MF v77,v6,v77
MF v78,v6,v78
MF v79,v6,v79
C v68,v68,v69
C v69,v70,v71
C v70,v76,v77
C v71,v78,v79
buffer_store_dwordx4 v[68:71], v7, s[8:11], s30 offen offset:0 sc1
buffer_load_dwordx4 v0, s[12:15], s85 offen offset:1024 lds
SA s85,s38,12288
buffer_load_dwordx4 v0, s[12:15], s85 offen offset:2048 lds
SA s85,s38,18432
buffer_load_dwordx4 v0, s[12:15], s85 offen offset:3072 lds
M v[96:99],a[64:67],a[128:131],0
s_nop 0
T a[96:97],v23,0
T a[98:99],v23,2048
M v[96:99],a[68:71],a[132:135],v[96:99]
SA m0,s28,135168
T a[100:101],v23,4096
T a[102:103],v23,6144
M v[96:99],a[72:75],a[136:139],v[96:99]
SA s85,s38,28672
buffer_load_dwordx4 v0, s[12:15], s85 offen offset:0 lds
M v[96:99],a[76:79],a[140:143],v[96:99]
SA s85,s38,34816
T a[104:105],v23,8192
T a[106:107],v23,10240
M v[96:99],a[80:83],a[144:147],v[96:99]
T a[108:109],v23,12288
T a[110:111],v23,14336
M v[96:99],a[84:87],a[148:151],v[96:99]
buffer_load_dwordx4 v0, s[12:15], s85 offen offset:1024 lds
M v[96:99],a[88:91],a[152:155],v[96:99]
SA s85,s38,40960
T a[112:113],v23,16384
T a[114:115],v23,18432
M v[96:99],a[92:95],a[156:159],v[96:99]
T a[116:117],v23,20480
T a[118:119],v23,22528
M v[100:103],a[92:95],a[188:191],0
buffer_load_dwordx4 v0, s[12:15], s85 offen offset:2048 lds
M v[100:103],a[88:91],a[184:187],v[100:103]
SA s85,s38,47104
T a[120:121],v23,24576
T a[122:123],v23,26624
M v[100:103],a[84:87],a[180:183],v[100:103]
T a[124:125],v23,28672
T a[126:127],v23,30720
M v[100:103],a[80:83],a[176:179],v[100:103]
buffer_load_dwordx4 v0, s[12:15], s85 offen offset:3072 lds
M v[100:103],a[76:79],a[172:175],v[100:103]
SA s38,s38,128
MF v80,v5,v80
MF v81,v5,v81
M v[100:103],a[72:75],a[168:171],v[100:103]
SA m0,s28,32768
MF v82,v5,v82
MF v83,v5,v83
M v[100:103],a[68:71],a[164:167],v[100:103]
SA s85,s38,0
buffer_load_dwordx4 v0, s[12:15], s85 offen offset:0 lds
M v[100:103],a[64:67],a[160:163],v[100:103]
s_waitcnt lgkmcnt(0)
MF v88,v5,v88
MF v89,v5,v89
M v[104:107],a[96:99],a[128:131],0
SA s85,s38,6144
T a[64:65],v24,0
T a[66:67],v24,2048
M v[104:107],a[100:103],a[132:135],v[104:107]
T a[68:69],v24,4096
T a[70:71],v24,6144
M v[104:107],a[104:107],a[136:139],v[104:107]
buffer_load_dwordx4 v0, s[12:15], s85 offen offset:1024 lds
M v[104:107],a[108:111],a[140:143],v[104:107]
SA s85,s38,12288
T a[72:73],v24,8192
T a[74:75],v24,10240
M v[104:107],a[112:115],a[144:147],v[104:107]
T a[76:77],v24,12288
T a[78:79],v24,14336
M v[104:107],a[116:119],a[148:151],v[104:107]
buffer_load_dwordx4 v0, s[12:15], s85 offen offset:2048 lds
M v[104:107],a[120:123],a[152:155],v[104:107]
SA s85,s38,18432
T a[80:81],v24,16384
T a[82:83],v24,18432
M v[104:107],a[124:127],a[156:159],v[104:107]
T a[84:85],v24,20480
T a[86:87],v24,22528
M v[108:111],a[124:127],a[188:191],0
buffer_load_dwordx4 v0, s[12:15], s85 offen offset:3072 lds
M v[108:111],a[120:123],a[184:187],v[108:111]
SA m0,s28,36864
T a[88:89],v24,24576
T a[90:91],v24,26624
M v[108:111],a[116:119],a[180:183],v[108:111]
SA s85,s38,28672
T a[92:93],v24,28672
T a[94:95],v24,30720
M v[108:111],a[112:115],a[176:179],v[108:111]
buffer_load_dwordx4 v0, s[12:15], s85 offen offset:0 lds
M v[108:111],a[108:111],a[172:175],v[108:111]
SA s85,s38,34816
MF v90,v5,v90
MF v91,v5,v91
M v[108:111],a[104:107],a[168:171],v[108:111]
C v80,v80,v81
C v81,v82,v83
M v[108:111],a[100:103],a[164:167],v[108:111]
buffer_load_dwordx4 v0, s[12:15], s85 offen offset:1024 lds
M v[108:111],a[96:99],a[160:163],v[108:111]
s_waitcnt lgkmcnt(0)
C v82,v88,v89
C v83,v90,v91
M v[112:115],a[64:67],a[128:131],0
SA s85,s38,40960
T a[96:97],v25,0
T a[98:99],v25,2048
M v[112:115],a[68:71],a[132:135],v[112:115]
T a[100:101],v25,4096
T a[102:103],v25,6144
M v[112:115],a[72:75],a[136:139],v[112:115]
buffer_store_dwordx4 v[80:83], v7, s[8:11], s29 offen offset:1024 sc1
M v[112:115],a[76:79],a[140:143],v[112:115]
s_nop 0
T a[104:105],v25,8192
T a[106:107],v25,10240
M v[112:115],a[80:83],a[144:147],v[112:115]
T a[108:109],v25,12288
T a[110:111],v25,14336
M v[112:115],a[84:87],a[148:151],v[112:115]
buffer_load_dwordx4 v0, s[12:15], s85 offen offset:2048 lds
M v[112:115],a[88:91],a[152:155],v[112:115]
SA s85,s38,47104
T a[112:113],v25,16384
T a[114:115],v25,18432
M v[112:115],a[92:95],a[156:159],v[112:115]
T a[116:117],v25,20480
T a[118:119],v25,22528
M v[116:119],a[92:95],a[188:191],0
buffer_load_dwordx4 v0, s[12:15], s85 offen offset:3072 lds
M v[116:119],a[88:91],a[184:187],v[116:119]
SA s38,s38,128
T a[120:121],v25,24576
T a[122:123],v25,26624
M v[116:119],a[84:87],a[180:183],v[116:119]
SA m0,s28,98304
T a[124:125],v25,28672
T a[126:127],v25,30720
M v[116:119],a[80:83],a[176:179],v[116:119]
SA s85,s38,0
buffer_load_dwordx4 v0, s[12:15], s85 offen offset:0 lds
M v[116:119],a[76:79],a[172:175],v[116:119]
SA s85,s38,6144
MF v84,v6,v84
MF v85,v6,v85
M v[116:119],a[72:75],a[168:171],v[116:119]
buffer_load_dwordx4 v0, s[12:15], s85 offen offset:1024 lds
M v[116:119],a[68:71],a[164:167],v[116:119]
s_waitcnt vmcnt(21) lgkmcnt(0)
MF v86,v6,v86
MF v87,v6,v87
M v[116:119],a[64:67],a[160:163],v[116:119]
s_barrier
M v[120:123],a[96:99],a[128:131],0
SA s85,s38,12288
T a[64:65],v18,0
T a[66:67],v18,2048
M v[120:123],a[100:103],a[132:135],v[120:123]
T a[68:69],v18,4096
T a[70:71],v18,6144
M v[120:123],a[104:107],a[136:139],v[120:123]
buffer_load_dwordx4 v0, s[12:15], s85 offen offset:2048 lds
M v[120:123],a[108:111],a[140:143],v[120:123]
SA s85,s38,18432
T a[72:73],v18,8192
T a[74:75],v18,10240
M v[120:123],a[112:115],a[144:147],v[120:123]
T a[76:77],v18,12288
T a[78:79],v18,14336
M v[120:123],a[116:119],a[148:151],v[120:123]
buffer_load_dwordx4 v0, s[12:15], s85 offen offset:3072 lds
M v[120:123],a[120:123],a[152:155],v[120:123]
s_nop 0
T a[80:81],v18,16384
T a[82:83],v18,18432
M v[120:123],a[124:127],a[156:159],v[120:123]
T a[84:85],v18,20480
T a[86:87],v18,22528
M v[124:127],a[124:127],a[188:191],0
MF v92,v6,v92
MF v93,v6,v93
M v[124:127],a[120:123],a[184:187],v[124:127]
T a[88:89],v18,24576
T a[90:91],v18,26624
M v[124:127],a[116:119],a[180:183],v[124:127]
T a[92:93],v18,28672
T a[94:95],v18,30720
M v[124:127],a[112:115],a[176:179],v[124:127]
MF v94,v6,v94
MF v95,v6,v95
M v[124:127],a[108:111],a[172:175],v[124:127]
C v84,v84,v85
C v85,v86,v87
M v[124:127],a[104:107],a[168:171],v[124:127]
C v86,v92,v93
C v87,v94,v95
M v[124:127],a[100:103],a[164:167],v[124:127]
s_waitcnt lgkmcnt(0)
buffer_store_dwordx4 v[84:87], v7, s[8:11], s30 offen offset:1024 sc1
M v[124:127],a[96:99],a[160:163],v[124:127]
SA s29,s33,2048
SA s30,s33,16384
MF v96,v5,v96
MF v97,v5,v97
MF v98,v5,v98
MF v99,v5,v99
MF v104,v5,v104
MF v105,v5,v105
MF v106,v5,v106
MF v107,v5,v107
C v96,v96,v97
C v97,v98,v99
C v98,v104,v105
C v99,v106,v107
buffer_store_dwordx4 v[96:99], v7, s[8:11], s29 offen offset:0 sc1
MF v100,v6,v100
MF v101,v6,v101
MF v102,v6,v102
MF v103,v6,v103
MF v108,v6,v108
MF v109,v6,v109
MF v110,v6,v110
MF v111,v6,v111
C v100,v100,v101
C v101,v102,v103
C v102,v108,v109
C v103,v110,v111
buffer_store_dwordx4 v[100:103], v7, s[8:11], s30 offen offset:0 sc1
M v[64:67],a[64:67],a[128:131],0
s_nop 0
T a[96:97],v19,0
T a[98:99],v19,2048
M v[64:67],a[68:71],a[132:135],v[64:67]
SA m0,s28,102400
T a[100:101],v19,4096
T a[102:103],v19,6144
M v[64:67],a[72:75],a[136:139],v[64:67]
SA s85,s38,28672
buffer_load_dwordx4 v0, s[12:15], s85 offen offset:0 lds
M v[64:67],a[76:79],a[140:143],v[64:67]
SA s85,s38,34816
T a[104:105],v19,8192
T a[106:107],v19,10240
M v[64:67],a[80:83],a[144:147],v[64:67]
T a[108:109],v19,12288
T a[110:111],v19,14336
M v[64:67],a[84:87],a[148:151],v[64:67]
buffer_load_dwordx4 v0, s[12:15], s85 offen offset:1024 lds
M v[64:67],a[88:91],a[152:155],v[64:67]
s_nop 0
T a[112:113],v19,16384
T a[114:115],v19,18432
M v[64:67],a[92:95],a[156:159],v[64:67]
SA s85,s38,40960
T a[116:117],v19,20480
T a[118:119],v19,22528
M v[68:71],a[92:95],a[188:191],0
buffer_load_dwordx4 v0, s[12:15], s85 offen offset:2048 lds
M v[68:71],a[88:91],a[184:187],v[68:71]
s_nop 0
T a[120:121],v19,24576
T a[122:123],v19,26624
M v[68:71],a[84:87],a[180:183],v[68:71]
T a[124:125],v19,28672
T a[126:127],v19,30720
M v[68:71],a[80:83],a[176:179],v[68:71]
SA s85,s38,47104
MF v112,v5,v112
MF v113,v5,v113
M v[68:71],a[76:79],a[172:175],v[68:71]
buffer_load_dwordx4 v0, s[12:15], s85 offen offset:3072 lds
M v[68:71],a[72:75],a[168:171],v[68:71]
SA s38,s38,128
MF v114,v5,v114
MF v115,v5,v115
M v[68:71],a[68:71],a[164:167],v[68:71]
SA m0,s28,65536
MF v120,v5,v120
MF v121,v5,v121
M v[68:71],a[64:67],a[160:163],v[68:71]
s_waitcnt lgkmcnt(0)
MF v122,v5,v122
MF v123,v5,v123
M v[72:75],a[96:99],a[128:131],0
SA s85,s38,0
T a[64:65],v20,0
T a[66:67],v20,2048
M v[72:75],a[100:103],a[132:135],v[72:75]
T a[68:69],v20,4096
T a[70:71],v20,6144
M v[72:75],a[104:107],a[136:139],v[72:75]
buffer_load_dwordx4 v0, s[12:15], s85 offen offset:0 lds
M v[72:75],a[108:111],a[140:143],v[72:75]
SA s85,s38,6144
T a[72:73],v20,8192
T a[74:75],v20,10240
M v[72:75],a[112:115],a[144:147],v[72:75]
T a[76:77],v20,12288
T a[78:79],v20,14336
M v[72:75],a[116:119],a[148:151],v[72:75]
buffer_load_dwordx4 v0, s[12:15], s85 offen offset:1024 lds
M v[72:75],a[120:123],a[152:155],v[72:75]
SA s85,s38,12288
T a[80:81],v20,16384
T a[82:83],v20,18432
M v[72:75],a[124:127],a[156:159],v[72:75]
T a[84:85],v20,20480
T a[86:87],v20,22528
M v[76:79],a[124:127],a[188:191],0
buffer_load_dwordx4 v0, s[12:15], s85 offen offset:2048 lds
M v[76:79],a[120:123],a[184:187],v[76:79]
SA s85,s38,18432
T a[88:89],v20,24576
T a[90:91],v20,26624
M v[76:79],a[116:119],a[180:183],v[76:79]
T a[92:93],v20,28672
T a[94:95],v20,30720
M v[76:79],a[112:115],a[176:179],v[76:79]
buffer_load_dwordx4 v0, s[12:15], s85 offen offset:3072 lds
M v[76:79],a[108:111],a[172:175],v[76:79]
SA m0,s28,69632
C v112,v112,v113
C v113,v114,v115
M v[76:79],a[104:107],a[168:171],v[76:79]
SA s85,s38,28672
C v114,v120,v121
C v115,v122,v123
M v[76:79],a[100:103],a[164:167],v[76:79]
buffer_store_dwordx4 v[112:115], v7, s[8:11], s29 offen offset:1024 sc1
M v[76:79],a[96:99],a[160:163],v[76:79]
s_waitcnt lgkmcnt(0)
MF v116,v6,v116
MF v117,v6,v117
M v[80:83],a[64:67],a[128:131],0
T a[96:97],v21,0
T a[98:99],v21,2048
M v[80:83],a[68:71],a[132:135],v[80:83]
T a[100:101],v21,4096
T a[102:103],v21,6144
M v[80:83],a[72:75],a[136:139],v[80:83]
buffer_load_dwordx4 v0, s[12:15], s85 offen offset:0 lds
M v[80:83],a[76:79],a[140:143],v[80:83]
SA s85,s38,34816
T a[104:105],v21,8192
T a[106:107],v21,10240
M v[80:83],a[80:83],a[144:147],v[80:83]
T a[108:109],v21,12288
T a[110:111],v21,14336
M v[80:83],a[84:87],a[148:151],v[80:83]
buffer_load_dwordx4 v0, s[12:15], s85 offen offset:1024 lds
M v[80:83],a[88:91],a[152:155],v[80:83]
SA s85,s38,40960
T a[112:113],v21,16384
T a[114:115],v21,18432
M v[80:83],a[92:95],a[156:159],v[80:83]
T a[116:117],v21,20480
T a[118:119],v21,22528
M v[84:87],a[92:95],a[188:191],0
buffer_load_dwordx4 v0, s[12:15], s85 offen offset:2048 lds
M v[84:87],a[88:91],a[184:187],v[84:87]
SA s85,s38,47104
T a[120:121],v21,24576
T a[122:123],v21,26624
M v[84:87],a[84:87],a[180:183],v[84:87]
T a[124:125],v21,28672
T a[126:127],v21,30720
M v[84:87],a[80:83],a[176:179],v[84:87]
buffer_load_dwordx4 v0, s[12:15], s85 offen offset:3072 lds
M v[84:87],a[76:79],a[172:175],v[84:87]
MF v118,v6,v118
MF v119,v6,v119
M v[84:87],a[72:75],a[168:171],v[84:87]
SA s38,s38,128
MF v124,v6,v124
MF v125,v6,v125
M v[84:87],a[68:71],a[164:167],v[84:87]
s_waitcnt vmcnt(29) lgkmcnt(0)
MF v126,v6,v126
MF v127,v6,v127
M v[84:87],a[64:67],a[160:163],v[84:87]
s_barrier
M v[88:91],a[96:99],a[128:131],0
s_nop 0
T a[64:65],v40,0
T a[66:67],v40,2048
M v[88:91],a[100:103],a[132:135],v[88:91]
T a[68:69],v40,4096
T a[70:71],v40,6144
M v[88:91],a[104:107],a[136:139],v[88:91]
C v116,v116,v117
C v117,v118,v119
M v[88:91],a[108:111],a[140:143],v[88:91]
T a[72:73],v40,8192
T a[74:75],v40,10240
M v[88:91],a[112:115],a[144:147],v[88:91]
T a[76:77],v40,12288
T a[78:79],v40,14336
M v[88:91],a[116:119],a[148:151],v[88:91]
C v118,v124,v125
C v119,v126,v127
M v[88:91],a[120:123],a[152:155],v[88:91]
T a[80:81],v40,16384
T a[82:83],v40,18432
M v[88:91],a[124:127],a[156:159],v[88:91]
T a[84:85],v40,20480
T a[86:87],v40,22528
M v[92:95],a[124:127],a[188:191],0
buffer_store_dwordx4 v[116:119], v7, s[8:11], s30 offen offset:1024 sc1
M v[92:95],a[120:123],a[184:187],v[92:95]
SA s29,s33,4096
T a[88:89],v40,24576
T a[90:91],v40,26624
M v[92:95],a[116:119],a[180:183],v[92:95]
SA s30,s33,18432
T a[92:93],v40,28672
T a[94:95],v40,30720
M v[92:95],a[112:115],a[176:179],v[92:95]
MF v64,v5,v64
MF v65,v5,v65
M v[92:95],a[108:111],a[172:175],v[92:95]
MF v66,v5,v66
MF v67,v5,v67
M v[92:95],a[104:107],a[168:171],v[92:95]
MF v72,v5,v72
MF v73,v5,v73
M v[92:95],a[100:103],a[164:167],v[92:95]
s_waitcnt lgkmcnt(0)
MF v74,v5,v74
MF v75,v5,v75
M v[92:95],a[96:99],a[160:163],v[92:95]
C v64,v64,v65
C v65,v66,v67
C v66,v72,v73
C v67,v74,v75
buffer_store_dwordx4 v[64:67], v7, s[8:11], s29 offen offset:0 sc1
MF v68,v6,v68
MF v69,v6,v69
MF v70,v6,v70
MF v71,v6,v71
MF v76,v6,v76
MF v77,v6,v77
MF v78,v6,v78
MF v79,v6,v79
C v68,v68,v69
C v69,v70,v71
C v70,v76,v77
C v71,v78,v79
buffer_store_dwordx4 v[68:71], v7, s[8:11], s30 offen offset:0 sc1
M v[96:99],a[64:67],a[128:131],0
s_nop 0
T a[96:97],v41,0
T a[98:99],v41,2048
M v[96:99],a[68:71],a[132:135],v[96:99]
T a[100:101],v41,4096
T a[102:103],v41,6144
M v[96:99],a[72:75],a[136:139],v[96:99]
MF v80,v5,v80
MF v81,v5,v81
M v[96:99],a[76:79],a[140:143],v[96:99]
T a[104:105],v41,8192
T a[106:107],v41,10240
M v[96:99],a[80:83],a[144:147],v[96:99]
T a[108:109],v41,12288
T a[110:111],v41,14336
M v[96:99],a[84:87],a[148:151],v[96:99]
MF v82,v5,v82
MF v83,v5,v83
M v[96:99],a[88:91],a[152:155],v[96:99]
T a[112:113],v41,16384
T a[114:115],v41,18432
M v[96:99],a[92:95],a[156:159],v[96:99]
T a[116:117],v41,20480
T a[118:119],v41,22528
M v[100:103],a[92:95],a[188:191],0
MF v88,v5,v88
MF v89,v5,v89
M v[100:103],a[88:91],a[184:187],v[100:103]
T a[120:121],v41,24576
T a[122:123],v41,26624
M v[100:103],a[84:87],a[180:183],v[100:103]
T a[124:125],v41,28672
T a[126:127],v41,30720
M v[100:103],a[80:83],a[176:179],v[100:103]
MF v90,v5,v90
MF v91,v5,v91
M v[100:103],a[76:79],a[172:175],v[100:103]
C v80,v80,v81
C v81,v82,v83
M v[100:103],a[72:75],a[168:171],v[100:103]
C v82,v88,v89
C v83,v90,v91
M v[100:103],a[68:71],a[164:167],v[100:103]
buffer_store_dwordx4 v[80:83], v7, s[8:11], s29 offen offset:1024 sc1
M v[100:103],a[64:67],a[160:163],v[100:103]
s_waitcnt lgkmcnt(0)
MF v84,v6,v84
MF v85,v6,v85
M v[104:107],a[96:99],a[128:131],0
T a[64:65],v42,0
T a[66:67],v42,2048
M v[104:107],a[100:103],a[132:135],v[104:107]
T a[68:69],v42,4096
T a[70:71],v42,6144
M v[104:107],a[104:107],a[136:139],v[104:107]
MF v86,v6,v86
MF v87,v6,v87
M v[104:107],a[108:111],a[140:143],v[104:107]
T a[72:73],v42,8192
T a[74:75],v42,10240
M v[104:107],a[112:115],a[144:147],v[104:107]
T a[76:77],v42,12288
T a[78:79],v42,14336
M v[104:107],a[116:119],a[148:151],v[104:107]
MF v92,v6,v92
MF v93,v6,v93
M v[104:107],a[120:123],a[152:155],v[104:107]
T a[80:81],v42,16384
T a[82:83],v42,18432
M v[104:107],a[124:127],a[156:159],v[104:107]
T a[84:85],v42,20480
T a[86:87],v42,22528
M v[108:111],a[124:127],a[188:191],0
MF v94,v6,v94
MF v95,v6,v95
M v[108:111],a[120:123],a[184:187],v[108:111]
T a[88:89],v42,24576
T a[90:91],v42,26624
M v[108:111],a[116:119],a[180:183],v[108:111]
T a[92:93],v42,28672
T a[94:95],v42,30720
M v[108:111],a[112:115],a[176:179],v[108:111]
C v84,v84,v85
C v85,v86,v87
M v[108:111],a[108:111],a[172:175],v[108:111]
C v86,v92,v93
C v87,v94,v95
M v[108:111],a[104:107],a[168:171],v[108:111]
buffer_store_dwordx4 v[84:87], v7, s[8:11], s30 offen offset:1024 sc1
M v[108:111],a[100:103],a[164:167],v[108:111]
SA s29,s33,6144
M v[108:111],a[96:99],a[160:163],v[108:111]
s_waitcnt lgkmcnt(0)
M v[112:115],a[64:67],a[128:131],0
SA s30,s33,20480
T a[96:97],v43,0
T a[98:99],v43,2048
M v[112:115],a[68:71],a[132:135],v[112:115]
T a[100:101],v43,4096
T a[102:103],v43,6144
M v[112:115],a[72:75],a[136:139],v[112:115]
MF v96,v5,v96
MF v97,v5,v97
M v[112:115],a[76:79],a[140:143],v[112:115]
T a[104:105],v43,8192
T a[106:107],v43,10240
M v[112:115],a[80:83],a[144:147],v[112:115]
T a[108:109],v43,12288
T a[110:111],v43,14336
M v[112:115],a[84:87],a[148:151],v[112:115]
MF v98,v5,v98
MF v99,v5,v99
M v[112:115],a[88:91],a[152:155],v[112:115]
T a[112:113],v43,16384
T a[114:115],v43,18432
M v[112:115],a[92:95],a[156:159],v[112:115]
T a[116:117],v43,20480
T a[118:119],v43,22528
M v[116:119],a[92:95],a[188:191],0
MF v104,v5,v104
MF v105,v5,v105
M v[116:119],a[88:91],a[184:187],v[116:119]
T a[120:121],v43,24576
T a[122:123],v43,26624
M v[116:119],a[84:87],a[180:183],v[116:119]
T a[124:125],v43,28672
T a[126:127],v43,30720
M v[116:119],a[80:83],a[176:179],v[116:119]
MF v106,v5,v106
MF v107,v5,v107
M v[116:119],a[76:79],a[172:175],v[116:119]
C v96,v96,v97
C v97,v98,v99
M v[116:119],a[72:75],a[168:171],v[116:119]
C v98,v104,v105
C v99,v106,v107
M v[116:119],a[68:71],a[164:167],v[116:119]
s_waitcnt vmcnt(25) lgkmcnt(0)
buffer_store_dwordx4 v[96:99], v7, s[8:11], s29 offen offset:0 sc1
M v[116:119],a[64:67],a[160:163],v[116:119]
s_barrier
M v[120:123],a[96:99],a[128:131],0
s_nop 0
T a[64:65],v18,32768
T a[66:67],v18,34816
M v[120:123],a[100:103],a[132:135],v[120:123]
T a[68:69],v18,36864
T a[70:71],v18,38912
M v[120:123],a[104:107],a[136:139],v[120:123]
MF v100,v6,v100
MF v101,v6,v101
M v[120:123],a[108:111],a[140:143],v[120:123]
T a[72:73],v18,40960
T a[74:75],v18,43008
M v[120:123],a[112:115],a[144:147],v[120:123]
T a[76:77],v18,45056
T a[78:79],v18,47104
M v[120:123],a[116:119],a[148:151],v[120:123]
MF v102,v6,v102
MF v103,v6,v103
M v[120:123],a[120:123],a[152:155],v[120:123]
T a[80:81],v18,49152
T a[82:83],v18,51200
M v[120:123],a[124:127],a[156:159],v[120:123]
T a[84:85],v18,53248
T a[86:87],v18,55296
M v[124:127],a[124:127],a[188:191],0
MF v108,v6,v108
MF v109,v6,v109
M v[124:127],a[120:123],a[184:187],v[124:127]
T a[88:89],v18,57344
T a[90:91],v18,59392
M v[124:127],a[116:119],a[180:183],v[124:127]
T a[92:93],v18,61440
T a[94:95],v18,63488
M v[124:127],a[112:115],a[176:179],v[124:127]
MF v110,v6,v110
MF v111,v6,v111
M v[124:127],a[108:111],a[172:175],v[124:127]
C v100,v100,v101
C v101,v102,v103
M v[124:127],a[104:107],a[168:171],v[124:127]
C v102,v108,v109
C v103,v110,v111
M v[124:127],a[100:103],a[164:167],v[124:127]
s_waitcnt lgkmcnt(0)
buffer_store_dwordx4 v[100:103], v7, s[8:11], s30 offen offset:0 sc1
M v[124:127],a[96:99],a[160:163],v[124:127]
M v[64:67],a[64:67],a[128:131],0
s_nop 0
T a[96:97],v19,32768
T a[98:99],v19,34816
M v[64:67],a[68:71],a[132:135],v[64:67]
T a[100:101],v19,36864
T a[102:103],v19,38912
M v[64:67],a[72:75],a[136:139],v[64:67]
v_lshrrev_b32 v32, 4, v7
MF v112,v5,v112
M v[64:67],a[76:79],a[140:143],v[64:67]
s_lshr_b32 s74, s41, 3
T a[104:105],v19,40960
T a[106:107],v19,43008
M v[64:67],a[80:83],a[144:147],v[64:67]
s_lshl_b32 s64, s42, 1
T a[108:109],v19,45056
T a[110:111],v19,47104
M v[64:67],a[84:87],a[148:151],v[64:67]
SA s46,s64,s74
MF v113,v5,v113
MF v114,v5,v114
M v[64:67],a[88:91],a[152:155],v[64:67]
s_mul_i32 s46, s46, 4352
T a[112:113],v19,49152
T a[114:115],v19,51200
M v[64:67],a[92:95],a[156:159],v[64:67]
s_and_b32 s72, s41, 7
T a[116:117],v19,53248
T a[118:119],v19,55296
M v[68:71],a[92:95],a[188:191],0
s_lshl_b32 s65, s72, 7
MF v115,v5,v115
MF v120,v5,v120
M v[68:71],a[88:91],a[184:187],v[68:71]
SA s46,s46,s65
T a[120:121],v19,57344
T a[122:123],v19,59392
M v[68:71],a[84:87],a[180:183],v[68:71]
SA s46,s46,104992768
T a[124:125],v19,61440
T a[126:127],v19,63488
M v[68:71],a[80:83],a[176:179],v[68:71]
v_and_b32 v33, 31, v32
MF v121,v5,v121
M v[68:71],a[76:79],a[172:175],v[68:71]
MF v122,v5,v122
MF v123,v5,v123
M v[68:71],a[72:75],a[168:171],v[68:71]
C v112,v112,v113
C v113,v114,v115
M v[68:71],a[68:71],a[164:167],v[68:71]
C v114,v120,v121
C v115,v122,v123
M v[68:71],a[64:67],a[160:163],v[68:71]
s_waitcnt lgkmcnt(0)
buffer_store_dwordx4 v[112:115], v7, s[8:11], s29 offen offset:1024 sc1
M v[72:75],a[96:99],a[128:131],0
s_nop 0
T a[64:65],v20,32768
T a[66:67],v20,34816
M v[72:75],a[100:103],a[132:135],v[72:75]
T a[68:69],v20,36864
T a[70:71],v20,38912
M v[72:75],a[104:107],a[136:139],v[72:75]
MF v116,v6,v116
MF v117,v6,v117
M v[72:75],a[108:111],a[140:143],v[72:75]
T a[72:73],v20,40960
T a[74:75],v20,43008
M v[72:75],a[112:115],a[144:147],v[72:75]
T a[76:77],v20,45056
T a[78:79],v20,47104
M v[72:75],a[116:119],a[148:151],v[72:75]
MF v118,v6,v118
MF v119,v6,v119
M v[72:75],a[120:123],a[152:155],v[72:75]
T a[80:81],v20,49152
T a[82:83],v20,51200
M v[72:75],a[124:127],a[156:159],v[72:75]
T a[84:85],v20,53248
T a[86:87],v20,55296
M v[76:79],a[124:127],a[188:191],0
MF v124,v6,v124
MF v125,v6,v125
M v[76:79],a[120:123],a[184:187],v[76:79]
T a[88:89],v20,57344
T a[90:91],v20,59392
M v[76:79],a[116:119],a[180:183],v[76:79]
T a[92:93],v20,61440
T a[94:95],v20,63488
M v[76:79],a[112:115],a[176:179],v[76:79]
MF v126,v6,v126
MF v127,v6,v127
M v[76:79],a[108:111],a[172:175],v[76:79]
C v116,v116,v117
C v117,v118,v119
M v[76:79],a[104:107],a[168:171],v[76:79]
C v118,v124,v125
C v119,v126,v127
M v[76:79],a[100:103],a[164:167],v[76:79]
buffer_store_dwordx4 v[116:119], v7, s[8:11], s30 offen offset:1024 sc1
M v[76:79],a[96:99],a[160:163],v[76:79]
s_waitcnt lgkmcnt(0)
v_lshlrev_b32 v33, 2, v33
M v[80:83],a[64:67],a[128:131],0
SA s29,s33,8192
T a[96:97],v21,32768
T a[98:99],v21,34816
M v[80:83],a[68:71],a[132:135],v[80:83]
SA s30,s33,22528
T a[100:101],v21,36864
T a[102:103],v21,38912
M v[80:83],a[72:75],a[136:139],v[80:83]
s_lshl_b32 s65, s41, 7
MF v64,v5,v64
MF v65,v5,v65
M v[80:83],a[76:79],a[140:143],v[80:83]
SA s65,s65,104890368
T a[104:105],v21,40960
T a[106:107],v21,43008
M v[80:83],a[80:83],a[144:147],v[80:83]
T a[108:109],v21,45056
T a[110:111],v21,47104
M v[80:83],a[84:87],a[148:151],v[80:83]
buffer_load_dword v31, v33, s[8:11], s65 offen sc1
M v[80:83],a[88:91],a[152:155],v[80:83]
s_nop 0
T a[112:113],v21,49152
T a[114:115],v21,51200
M v[80:83],a[92:95],a[156:159],v[80:83]
T a[116:117],v21,53248
T a[118:119],v21,55296
M v[84:87],a[92:95],a[188:191],0
v_bfe_u32 v34, v32, 4, 1
v_lshlrev_b32 v34, 1, v34
M v[84:87],a[88:91],a[184:187],v[84:87]
T a[120:121],v21,57344
T a[122:123],v21,59392
M v[84:87],a[84:87],a[180:183],v[84:87]
T a[124:125],v21,61440
T a[126:127],v21,63488
M v[84:87],a[80:83],a[176:179],v[84:87]
v_lshrrev_b32 v35, 5, v32
v_add_u32 v34, v34, v35
M v[84:87],a[76:79],a[172:175],v[84:87]
s_mov_b32 s52, s96
MF v66,v5,v66
MF v67,v5,v67
M v[84:87],a[72:75],a[168:171],v[84:87]
s_and_b32 s53, s97, 0xffff
MF v72,v5,v72
MF v73,v5,v73
M v[84:87],a[68:71],a[164:167],v[84:87]
s_waitcnt vmcnt(19) lgkmcnt(0)
MF v74,v5,v74
MF v75,v5,v75
M v[84:87],a[64:67],a[160:163],v[84:87]
s_barrier
M v[88:91],a[96:99],a[128:131],0
s_mov_b32 s54, 1835008
T a[64:65],v22,32768
T a[66:67],v22,34816
M v[88:91],a[100:103],a[132:135],v[88:91]
s_mov_b32 s55, 0x20000
T a[68:69],v22,36864
T a[70:71],v22,38912
M v[88:91],a[104:107],a[136:139],v[88:91]
s_mul_i32 s77, s42, 1835008
C v64,v64,v65
C v65,v66,v67
M v[88:91],a[108:111],a[140:143],v[88:91]
s_mul_i32 s78, s72, 14336
T a[72:73],v22,40960
T a[74:75],v22,43008
M v[88:91],a[112:115],a[144:147],v[88:91]
SA s77,s77,s78
T a[76:77],v22,45056
T a[78:79],v22,47104
M v[88:91],a[116:119],a[148:151],v[88:91]
SA s77,s77,67108864
C v66,v72,v73
C v67,v74,v75
M v[88:91],a[120:123],a[152:155],v[88:91]
s_lshl_b32 s79, s74, 1
T a[80:81],v22,49152
T a[82:83],v22,51200
M v[88:91],a[124:127],a[156:159],v[88:91]
SA s79,s79,s20
T a[84:85],v22,53248
T a[86:87],v22,55296
M v[92:95],a[124:127],a[188:191],0
s_lshl_b32 s71, s74, 1
buffer_store_dwordx4 v[64:67], v7, s[8:11], s29 offen offset:0 sc1
M v[92:95],a[120:123],a[184:187],v[92:95]
SA s71,s71,1
T a[88:89],v22,57344
T a[90:91],v22,59392
M v[92:95],a[116:119],a[180:183],v[92:95]
s_sub_u32 s71, s71, s20
T a[92:93],v22,61440
T a[94:95],v22,63488
M v[92:95],a[112:115],a[176:179],v[92:95]
s_and_b32 s71, s71, 536870912
MF v68,v6,v68
MF v69,v6,v69
M v[92:95],a[108:111],a[172:175],v[92:95]
s_sub_u32 s64, 15, s64
MF v70,v6,v70
MF v71,v6,v71
M v[92:95],a[104:107],a[168:171],v[92:95]
s_sub_u32 s78, s64, 1
MF v76,v6,v76
MF v77,v6,v77
M v[92:95],a[100:103],a[164:167],v[92:95]
s_waitcnt lgkmcnt(0)
MF v78,v6,v78
MF v79,v6,v79
M v[92:95],a[96:99],a[160:163],v[92:95]
s_mul_i32 s78, s78, 1835008
SA s78,s78,s77
s_lshl_b32 s65, s79, 10
SA s78,s78,s65
SA s78,s78,s71
s_lshl_b32 s79, s79, 6
s_or_b32 s79, s79, s71
s_mul_i32 s67, s74, -2
s_lshl_b32 s74, s74, 3
SA s74,s74,s20
s_lshl_b32 s75, s74, 6
SA s76,s75,256
SA s67,s67,3
s_sub_u32 s67, s67, s20
s_and_b32 s67, s67, 536870912
s_or_b32 s76, s76, s67
v_or_b32 v27, s67, v7
v_add_u32 v27, 4096, v27
s_lshl_b32 s65, s74, 10
SA s77,s77,s65
s_lshl_b32 s64, s64, 7
s_lshr_b32 s73, s72, 1
s_sub_u32 s65, 7, s73
s_bitcmp1_b32 s72, 0
s_cselect_b32 s73, s65, s73
s_lshl_b32 s73, s73, 4
s_lshl_b32 s65, s42, 7
SA s73,s73,s65
v_and_b32 v37, 15, v32
v_add_u32 v37, s73, v37
v_add_u32 v29, s64, v37
s_mov_b32 s64, 104857664
v_mul_u32_u24 v38, 896, v37
v_lshl_add_u32 v38, v34, 4, v38
v_lshrrev_b32 v35, 4, v37
v_lshlrev_b32 v35, 5, v35
v_and_b32 v36, 15, v37
v_add_lshl_u32 v35, v35, v36, 2
buffer_load_dword v39, v35, s[8:11], s64 offen sc1
C v68,v68,v69
C v69,v70,v71
C v70,v76,v77
C v71,v78,v79
buffer_store_dwordx4 v[68:71], v7, s[8:11], s30 offen offset:0 sc1
buffer_load_dwordx4 v[48:51], v38, s[56:59], s75 offen
buffer_load_dwordx4 v[52:55], v38, s[56:59], s76 offen
v_mul_u32_u24 v28, 896, v29
v_lshl_add_u32 v28, v34, 4, v28
v_lshrrev_b32 v35, 4, v29
v_lshlrev_b32 v35, 5, v35
v_and_b32 v36, 15, v29
v_add_lshl_u32 v35, v35, v36, 2
buffer_load_dword v26, v35, s[8:11], s64 offen sc1
buffer_load_dwordx4 v[44:47], v28, s[56:59], s79 offen
M v[96:99],a[64:67],a[128:131],0
s_nop 0
T a[96:97],v23,32768
T a[98:99],v23,34816
M v[96:99],a[68:71],a[132:135],v[96:99]
T a[100:101],v23,36864
T a[102:103],v23,38912
M v[96:99],a[72:75],a[136:139],v[96:99]
MF v80,v5,v80
MF v81,v5,v81
M v[96:99],a[76:79],a[140:143],v[96:99]
T a[104:105],v23,40960
T a[106:107],v23,43008
M v[96:99],a[80:83],a[144:147],v[96:99]
T a[108:109],v23,45056
T a[110:111],v23,47104
M v[96:99],a[84:87],a[148:151],v[96:99]
MF v82,v5,v82
MF v83,v5,v83
M v[96:99],a[88:91],a[152:155],v[96:99]
T a[112:113],v23,49152
T a[114:115],v23,51200
M v[96:99],a[92:95],a[156:159],v[96:99]
T a[116:117],v23,53248
T a[118:119],v23,55296
M v[100:103],a[92:95],a[188:191],0
MF v88,v5,v88
MF v89,v5,v89
M v[100:103],a[88:91],a[184:187],v[100:103]
T a[120:121],v23,57344
T a[122:123],v23,59392
M v[100:103],a[84:87],a[180:183],v[100:103]
T a[124:125],v23,61440
T a[126:127],v23,63488
M v[100:103],a[80:83],a[176:179],v[100:103]
MF v90,v5,v90
MF v91,v5,v91
M v[100:103],a[76:79],a[172:175],v[100:103]
C v80,v80,v81
C v81,v82,v83
M v[100:103],a[72:75],a[168:171],v[100:103]
C v82,v88,v89
C v83,v90,v91
M v[100:103],a[68:71],a[164:167],v[100:103]
buffer_store_dwordx4 v[80:83], v7, s[8:11], s29 offen offset:1024 sc1
M v[100:103],a[64:67],a[160:163],v[100:103]
s_waitcnt lgkmcnt(0)
MF v84,v6,v84
MF v85,v6,v85
M v[104:107],a[96:99],a[128:131],0
T a[64:65],v24,32768
T a[66:67],v24,34816
M v[104:107],a[100:103],a[132:135],v[104:107]
T a[68:69],v24,36864
T a[70:71],v24,38912
M v[104:107],a[104:107],a[136:139],v[104:107]
MF v86,v6,v86
MF v87,v6,v87
M v[104:107],a[108:111],a[140:143],v[104:107]
T a[72:73],v24,40960
T a[74:75],v24,43008
M v[104:107],a[112:115],a[144:147],v[104:107]
T a[76:77],v24,45056
T a[78:79],v24,47104
M v[104:107],a[116:119],a[148:151],v[104:107]
MF v92,v6,v92
MF v93,v6,v93
M v[104:107],a[120:123],a[152:155],v[104:107]
T a[80:81],v24,49152
T a[82:83],v24,51200
M v[104:107],a[124:127],a[156:159],v[104:107]
T a[84:85],v24,53248
T a[86:87],v24,55296
M v[108:111],a[124:127],a[188:191],0
MF v94,v6,v94
MF v95,v6,v95
M v[108:111],a[120:123],a[184:187],v[108:111]
T a[88:89],v24,57344
T a[90:91],v24,59392
M v[108:111],a[116:119],a[180:183],v[108:111]
T a[92:93],v24,61440
T a[94:95],v24,63488
M v[108:111],a[112:115],a[176:179],v[108:111]
C v84,v84,v85
C v85,v86,v87
M v[108:111],a[108:111],a[172:175],v[108:111]
C v86,v92,v93
C v87,v94,v95
M v[108:111],a[104:107],a[168:171],v[108:111]
buffer_store_dwordx4 v[84:87], v7, s[8:11], s30 offen offset:1024 sc1
M v[108:111],a[100:103],a[164:167],v[108:111]
SA s29,s33,10240
M v[108:111],a[96:99],a[160:163],v[108:111]
s_waitcnt lgkmcnt(0)
M v[112:115],a[64:67],a[128:131],0
SA s30,s33,24576
T a[96:97],v25,32768
T a[98:99],v25,34816
M v[112:115],a[68:71],a[132:135],v[112:115]
T a[100:101],v25,36864
T a[102:103],v25,38912
M v[112:115],a[72:75],a[136:139],v[112:115]
MF v96,v5,v96
MF v97,v5,v97
M v[112:115],a[76:79],a[140:143],v[112:115]
T a[104:105],v25,40960
T a[106:107],v25,43008
M v[112:115],a[80:83],a[144:147],v[112:115]
T a[108:109],v25,45056
T a[110:111],v25,47104
M v[112:115],a[84:87],a[148:151],v[112:115]
MF v98,v5,v98
MF v99,v5,v99
M v[112:115],a[88:91],a[152:155],v[112:115]
T a[112:113],v25,49152
T a[114:115],v25,51200
M v[112:115],a[92:95],a[156:159],v[112:115]
T a[116:117],v25,53248
T a[118:119],v25,55296
M v[116:119],a[92:95],a[188:191],0
s_mov_b32 s84, s45
MF v104,v5,v104
MF v105,v5,v105
M v[116:119],a[88:91],a[184:187],v[116:119]
T a[120:121],v25,57344
T a[122:123],v25,59392
M v[116:119],a[84:87],a[180:183],v[116:119]
T a[124:125],v25,61440
T a[126:127],v25,63488
M v[116:119],a[80:83],a[176:179],v[116:119]
MF v106,v5,v106
MF v107,v5,v107
M v[116:119],a[76:79],a[172:175],v[116:119]
C v96,v96,v97
C v97,v98,v99
M v[116:119],a[72:75],a[168:171],v[116:119]
C v98,v104,v105
C v99,v106,v107
M v[116:119],a[68:71],a[164:167],v[116:119]
s_waitcnt vmcnt(19) lgkmcnt(0)
buffer_store_dwordx4 v[96:99], v7, s[8:11], s29 offen offset:0 sc1
M v[116:119],a[64:67],a[160:163],v[116:119]
s_barrier
M v[120:123],a[96:99],a[128:131],0
s_nop 0
T a[64:65],v22,0
T a[66:67],v22,2048
M v[120:123],a[100:103],a[132:135],v[120:123]
T a[68:69],v22,4096
T a[70:71],v22,6144
M v[120:123],a[104:107],a[136:139],v[120:123]
MF v100,v6,v100
MF v101,v6,v101
M v[120:123],a[108:111],a[140:143],v[120:123]
T a[72:73],v22,8192
T a[74:75],v22,10240
M v[120:123],a[112:115],a[144:147],v[120:123]
s_waitcnt vmcnt(11)
T a[76:77],v22,12288
T a[78:79],v22,14336
M v[120:123],a[116:119],a[148:151],v[120:123]
buffer_store_dword v15, v17, s[8:11], s84 offen sc1
M v[120:123],a[120:123],a[152:155],v[120:123]
s_nop 0
T a[80:81],v22,16384
T a[82:83],v22,18432
M v[120:123],a[124:127],a[156:159],v[120:123]
T a[84:85],v22,20480
T a[86:87],v22,22528
M v[124:127],a[124:127],a[188:191],0
MF v102,v6,v102
MF v103,v6,v103
M v[124:127],a[120:123],a[184:187],v[124:127]
T a[88:89],v22,24576
T a[90:91],v22,26624
M v[124:127],a[116:119],a[180:183],v[124:127]
T a[92:93],v22,28672
T a[94:95],v22,30720
M v[124:127],a[112:115],a[176:179],v[124:127]
MF v108,v6,v108
MF v109,v6,v109
M v[124:127],a[108:111],a[172:175],v[124:127]
MF v110,v6,v110
MF v111,v6,v111
M v[124:127],a[104:107],a[168:171],v[124:127]
C v100,v100,v101
C v101,v102,v103
M v[124:127],a[100:103],a[164:167],v[124:127]
s_waitcnt lgkmcnt(0)
C v102,v108,v109
C v103,v110,v111
M v[124:127],a[96:99],a[160:163],v[124:127]
buffer_store_dwordx4 v[100:103], v7, s[8:11], s30 offen offset:0 sc1
M v[64:67],a[64:67],a[128:131],0
s_nop 0
T a[96:97],v23,0
T a[98:99],v23,2048
M v[64:67],a[68:71],a[132:135],v[64:67]
T a[100:101],v23,4096
T a[102:103],v23,6144
M v[64:67],a[72:75],a[136:139],v[64:67]
MF v112,v5,v112
MF v113,v5,v113
M v[64:67],a[76:79],a[140:143],v[64:67]
T a[104:105],v23,8192
T a[106:107],v23,10240
M v[64:67],a[80:83],a[144:147],v[64:67]
T a[108:109],v23,12288
T a[110:111],v23,14336
M v[64:67],a[84:87],a[148:151],v[64:67]
MF v114,v5,v114
MF v115,v5,v115
M v[64:67],a[88:91],a[152:155],v[64:67]
T a[112:113],v23,16384
T a[114:115],v23,18432
M v[64:67],a[92:95],a[156:159],v[64:67]
T a[116:117],v23,20480
T a[118:119],v23,22528
M v[68:71],a[92:95],a[188:191],0
MF v120,v5,v120
MF v121,v5,v121
M v[68:71],a[88:91],a[184:187],v[68:71]
T a[120:121],v23,24576
T a[122:123],v23,26624
M v[68:71],a[84:87],a[180:183],v[68:71]
T a[124:125],v23,28672
T a[126:127],v23,30720
M v[68:71],a[80:83],a[176:179],v[68:71]
MF v122,v5,v122
MF v123,v5,v123
M v[68:71],a[76:79],a[172:175],v[68:71]
C v112,v112,v113
C v113,v114,v115
M v[68:71],a[72:75],a[168:171],v[68:71]
C v114,v120,v121
C v115,v122,v123
M v[68:71],a[68:71],a[164:167],v[68:71]
buffer_store_dwordx4 v[112:115], v7, s[8:11], s29 offen offset:1024 sc1
M v[68:71],a[64:67],a[160:163],v[68:71]
s_waitcnt lgkmcnt(0)
MF v116,v6,v116
MF v117,v6,v117
M v[72:75],a[96:99],a[128:131],0
T a[64:65],v24,0
T a[66:67],v24,2048
M v[72:75],a[100:103],a[132:135],v[72:75]
T a[68:69],v24,4096
T a[70:71],v24,6144
M v[72:75],a[104:107],a[136:139],v[72:75]
MF v118,v6,v118
MF v119,v6,v119
M v[72:75],a[108:111],a[140:143],v[72:75]
T a[72:73],v24,8192
T a[74:75],v24,10240
M v[72:75],a[112:115],a[144:147],v[72:75]
T a[76:77],v24,12288
T a[78:79],v24,14336
M v[72:75],a[116:119],a[148:151],v[72:75]
MF v124,v6,v124
MF v125,v6,v125
M v[72:75],a[120:123],a[152:155],v[72:75]
T a[80:81],v24,16384
T a[82:83],v24,18432
M v[72:75],a[124:127],a[156:159],v[72:75]
T a[84:85],v24,20480
T a[86:87],v24,22528
M v[76:79],a[124:127],a[188:191],0
MF v126,v6,v126
MF v127,v6,v127
M v[76:79],a[120:123],a[184:187],v[76:79]
T a[88:89],v24,24576
T a[90:91],v24,26624
M v[76:79],a[116:119],a[180:183],v[76:79]
T a[92:93],v24,28672
T a[94:95],v24,30720
M v[76:79],a[112:115],a[176:179],v[76:79]
C v116,v116,v117
C v117,v118,v119
M v[76:79],a[108:111],a[172:175],v[76:79]
C v118,v124,v125
C v119,v126,v127
M v[76:79],a[104:107],a[168:171],v[76:79]
buffer_store_dwordx4 v[116:119], v7, s[8:11], s30 offen offset:1024 sc1
M v[76:79],a[100:103],a[164:167],v[76:79]
SA s29,s33,12288
M v[76:79],a[96:99],a[160:163],v[76:79]
s_waitcnt lgkmcnt(0)
M v[80:83],a[64:67],a[128:131],0
SA s30,s33,26624
T a[96:97],v25,0
T a[98:99],v25,2048
M v[80:83],a[68:71],a[132:135],v[80:83]
T a[100:101],v25,4096
T a[102:103],v25,6144
M v[80:83],a[72:75],a[136:139],v[80:83]
MF v64,v5,v64
MF v65,v5,v65
M v[80:83],a[76:79],a[140:143],v[80:83]
T a[104:105],v25,8192
T a[106:107],v25,10240
M v[80:83],a[80:83],a[144:147],v[80:83]
T a[108:109],v25,12288
T a[110:111],v25,14336
M v[80:83],a[84:87],a[148:151],v[80:83]
MF v66,v5,v66
MF v67,v5,v67
M v[80:83],a[88:91],a[152:155],v[80:83]
T a[112:113],v25,16384
T a[114:115],v25,18432
M v[80:83],a[92:95],a[156:159],v[80:83]
T a[116:117],v25,20480
T a[118:119],v25,22528
M v[84:87],a[92:95],a[188:191],0
MF v72,v5,v72
MF v73,v5,v73
M v[84:87],a[88:91],a[184:187],v[84:87]
T a[120:121],v25,24576
T a[122:123],v25,26624
M v[84:87],a[84:87],a[180:183],v[84:87]
T a[124:125],v25,28672
T a[126:127],v25,30720
M v[84:87],a[80:83],a[176:179],v[84:87]
MF v74,v5,v74
MF v75,v5,v75
M v[84:87],a[76:79],a[172:175],v[84:87]
C v64,v64,v65
C v65,v66,v67
M v[84:87],a[72:75],a[168:171],v[84:87]
C v66,v72,v73
C v67,v74,v75
M v[84:87],a[68:71],a[164:167],v[84:87]
buffer_store_dwordx4 v[64:67], v7, s[8:11], s29 offen offset:0 sc1
M v[84:87],a[64:67],a[160:163],v[84:87]
s_waitcnt lgkmcnt(0)
MF v68,v6,v68
MF v69,v6,v69
M v[88:91],a[96:99],a[128:131],0
MF v70,v6,v70
MF v71,v6,v71
M v[88:91],a[100:103],a[132:135],v[88:91]
MF v76,v6,v76
MF v77,v6,v77
M v[88:91],a[104:107],a[136:139],v[88:91]
MF v78,v6,v78
MF v79,v6,v79
M v[88:91],a[108:111],a[140:143],v[88:91]
C v68,v68,v69
C v69,v70,v71
M v[88:91],a[112:115],a[144:147],v[88:91]
C v70,v76,v77
C v71,v78,v79
M v[88:91],a[116:119],a[148:151],v[88:91]
buffer_store_dwordx4 v[68:71], v7, s[8:11], s30 offen offset:0 sc1
M v[88:91],a[120:123],a[152:155],v[88:91]
M v[88:91],a[124:127],a[156:159],v[88:91]
M v[92:95],a[124:127],a[188:191],0
M v[92:95],a[120:123],a[184:187],v[92:95]
M v[92:95],a[116:119],a[180:183],v[92:95]
M v[92:95],a[112:115],a[176:179],v[92:95]
MF v80,v5,v80
MF v81,v5,v81
M v[92:95],a[108:111],a[172:175],v[92:95]
MF v82,v5,v82
MF v83,v5,v83
M v[92:95],a[104:107],a[168:171],v[92:95]
MF v88,v5,v88
MF v89,v5,v89
M v[92:95],a[100:103],a[164:167],v[92:95]
MF v90,v5,v90
MF v91,v5,v91
M v[92:95],a[96:99],a[160:163],v[92:95]
C v80,v80,v81
C v81,v82,v83
C v82,v88,v89
C v83,v90,v91
buffer_store_dwordx4 v[80:83], v7, s[8:11], s29 offen offset:1024 sc1
MF v84,v6,v84
MF v85,v6,v85
MF v86,v6,v86
MF v87,v6,v87
MF v92,v6,v92
MF v93,v6,v93
MF v94,v6,v94
MF v95,v6,v95
C v84,v84,v85
C v85,v86,v87
C v86,v92,v93
C v87,v94,v95
buffer_store_dwordx4 v[84:87], v7, s[8:11], s30 offen offset:1024 sc1
buffer_load_dword v9, v33, s[8:11], s46 offen sc1
s_waitcnt vmcnt(1)
buffer_store_dword v15, v16, s[8:11], s3 offen sc1
L_red1:
s_waitcnt vmcnt(0)
v_cmp_eq_u32 vcc, 1, v9
s_mov_b32 s91, 65536
s_mov_b32 s69, 0xffff
s_and_b32 s70, vcc_lo, s69
s_mov_b32 s68, s70
s_cmp_lg_u32 s70, 0
s_cbranch_scc1 L_rk0
s_call_b64 s[36:37], L_rpoll
L_rk0:
s_ff1_i32_b32 s71, s70
s_bitset0_b32 s70, s71
s_mul_i32 s71, s71, 114688
SA s72,s71,s77
buffer_load_dwordx4 v[128:131], v7, s[8:11], s72 offen sc1
buffer_load_dwordx4 v[132:135], v27, s[8:11], s72 offen sc1
s_cmp_lg_u32 s70, 0
s_cbranch_scc1 L_rk1
s_call_b64 s[36:37], L_rpoll
L_rk1:
s_ff1_i32_b32 s71, s70
s_bitset0_b32 s70, s71
s_mul_i32 s71, s71, 114688
SA s72,s71,s77
buffer_load_dwordx4 v[136:139], v7, s[8:11], s72 offen sc1
buffer_load_dwordx4 v[140:143], v27, s[8:11], s72 offen sc1
s_cmp_lg_u32 s70, 0
s_cbranch_scc1 L_rk2
s_call_b64 s[36:37], L_rpoll
L_rk2:
s_ff1_i32_b32 s71, s70
s_bitset0_b32 s70, s71
s_mul_i32 s71, s71, 114688
SA s72,s71,s77
buffer_load_dwordx4 v[144:147], v7, s[8:11], s72 offen sc1
buffer_load_dwordx4 v[148:151], v27, s[8:11], s72 offen sc1
v_readlane_b32 s92, v31, 0
v_readlane_b32 s94, v31, 1
v_lshlrev_b32 v64, 16, v48
v_and_b32 v65, 0xffff0000, v48
v_lshlrev_b32 v66, 16, v49
v_and_b32 v67, 0xffff0000, v49
v_lshlrev_b32 v68, 16, v50
v_and_b32 v69, 0xffff0000, v50
v_lshlrev_b32 v70, 16, v51
v_and_b32 v71, 0xffff0000, v51
v_lshlrev_b32 v72, 16, v52
v_and_b32 v73, 0xffff0000, v52
v_lshlrev_b32 v74, 16, v53
v_and_b32 v75, 0xffff0000, v53
v_lshlrev_b32 v76, 16, v54
v_and_b32 v77, 0xffff0000, v54
v_lshlrev_b32 v78, 16, v55
v_and_b32 v79, 0xffff0000, v55
v_sub_f32 v30, 1.0, v39
v_cmp_eq_u32 s[80:81], s92, v37
v_cmp_eq_u32 s[82:83], s94, v37
s_nop 0
s_or_b64 vcc, s[80:81], s[82:83]
s_cbranch_vccnz L_moe0
L_moe_ret0:
MF v64,v30,v64
MF v65,v30,v65
MF v66,v30,v66
MF v67,v30,v67
MF v68,v30,v68
MF v69,v30,v69
MF v70,v30,v70
MF v71,v30,v71
MF v72,v30,v72
MF v73,v30,v73
MF v74,v30,v74
MF v75,v30,v75
MF v76,v30,v76
MF v77,v30,v77
MF v78,v30,v78
MF v79,v30,v79
s_cmp_lg_u32 s70, 0
s_cbranch_scc1 L_rk3
s_call_b64 s[36:37], L_rpoll
L_rk3:
s_ff1_i32_b32 s71, s70
s_bitset0_b32 s70, s71
s_mul_i32 s71, s71, 114688
SA s72,s71,s77
buffer_load_dwordx4 v[152:155], v7, s[8:11], s72 offen sc1
buffer_load_dwordx4 v[156:159], v27, s[8:11], s72 offen sc1
v_lshlrev_b32 v80, 16, v44
v_and_b32 v81, 0xffff0000, v44
v_lshlrev_b32 v82, 16, v45
v_and_b32 v83, 0xffff0000, v45
v_lshlrev_b32 v84, 16, v46
v_and_b32 v85, 0xffff0000, v46
v_lshlrev_b32 v86, 16, v47
v_and_b32 v87, 0xffff0000, v47
v_sub_f32 v30, 1.0, v26
v_cmp_eq_u32 s[80:81], s92, v29
v_cmp_eq_u32 s[82:83], s94, v29
s_nop 0
s_or_b64 vcc, s[80:81], s[82:83]
s_cbranch_vccnz L_moe1
L_moe_ret1:
MF v80,v30,v80
MF v81,v30,v81
MF v82,v30,v82
MF v83,v30,v83
MF v84,v30,v84
MF v85,v30,v85
MF v86,v30,v86
MF v87,v30,v87
s_waitcnt vmcnt(7)
M v[96:99],a[246:249],v[128:131],0
M v[100:103],a[244:247],v[128:131],0
s_waitcnt vmcnt(6)
M v[104:107],a[246:249],v[132:135],0
M v[108:111],a[244:247],v[132:135],0
s_cmp_lg_u32 s70, 0
s_cbranch_scc1 L_rk4
s_call_b64 s[36:37], L_rpoll
L_rk4:
s_ff1_i32_b32 s71, s70
s_bitset0_b32 s70, s71
s_mul_i32 s71, s71, 114688
SA s72,s71,s77
buffer_load_dwordx4 v[160:163], v7, s[8:11], s72 offen sc1
buffer_load_dwordx4 v[164:167], v27, s[8:11], s72 offen sc1
s_waitcnt vmcnt(7)
M v[96:99],a[246:249],v[136:139],v[96:99]
M v[100:103],a[244:247],v[136:139],v[100:103]
s_waitcnt vmcnt(6)
M v[104:107],a[246:249],v[140:143],v[104:107]
M v[108:111],a[244:247],v[140:143],v[108:111]
s_cmp_lg_u32 s70, 0
s_cbranch_scc1 L_rk5
s_call_b64 s[36:37], L_rpoll
L_rk5:
s_ff1_i32_b32 s71, s70
s_bitset0_b32 s70, s71
s_mul_i32 s71, s71, 114688
SA s72,s71,s77
buffer_load_dwordx4 v[168:171], v7, s[8:11], s72 offen sc1
buffer_load_dwordx4 v[172:175], v27, s[8:11], s72 offen sc1
s_waitcnt vmcnt(7)
M v[96:99],a[246:249],v[144:147],v[96:99]
M v[100:103],a[244:247],v[144:147],v[100:103]
s_waitcnt vmcnt(6)
M v[104:107],a[246:249],v[148:151],v[104:107]
M v[108:111],a[244:247],v[148:151],v[108:111]
s_cmp_lg_u32 s70, 0
s_cbranch_scc1 L_rk6
s_call_b64 s[36:37], L_rpoll
L_rk6:
s_ff1_i32_b32 s71, s70
s_bitset0_b32 s70, s71
s_mul_i32 s71, s71, 114688
SA s72,s71,s77
buffer_load_dwordx4 v[176:179], v7, s[8:11], s72 offen sc1
buffer_load_dwordx4 v[180:183], v27, s[8:11], s72 offen sc1
s_waitcnt vmcnt(7)
M v[96:99],a[246:249],v[152:155],v[96:99]
M v[100:103],a[244:247],v[152:155],v[100:103]
s_waitcnt vmcnt(6)
M v[104:107],a[246:249],v[156:159],v[104:107]
M v[108:111],a[244:247],v[156:159],v[108:111]
s_cmp_lg_u32 s70, 0
s_cbranch_scc1 L_rk7
s_call_b64 s[36:37], L_rpoll
L_rk7:
s_ff1_i32_b32 s71, s70
s_bitset0_b32 s70, s71
s_mul_i32 s71, s71, 114688
SA s72,s71,s77
buffer_load_dwordx4 v[184:187], v7, s[8:11], s72 offen sc1
buffer_load_dwordx4 v[188:191], v27, s[8:11], s72 offen sc1
s_waitcnt vmcnt(7)
M v[96:99],a[246:249],v[160:163],v[96:99]
M v[100:103],a[244:247],v[160:163],v[100:103]
s_waitcnt vmcnt(6)
M v[104:107],a[246:249],v[164:167],v[104:107]
M v[108:111],a[244:247],v[164:167],v[108:111]
s_cmp_lg_u32 s70, 0
s_cbranch_scc1 L_rk8
s_call_b64 s[36:37], L_rpoll
L_rk8:
s_ff1_i32_b32 s71, s70
s_bitset0_b32 s70, s71
s_mul_i32 s71, s71, 114688
SA s72,s71,s77
buffer_load_dwordx4 v[128:131], v7, s[8:11], s72 offen sc1
buffer_load_dwordx4 v[132:135], v27, s[8:11], s72 offen sc1
s_waitcnt vmcnt(7)
M v[96:99],a[246:249],v[168:171],v[96:99]
M v[100:103],a[244:247],v[168:171],v[100:103]
s_waitcnt vmcnt(6)
M v[104:107],a[246:249],v[172:175],v[104:107]
M v[108:111],a[244:247],v[172:175],v[108:111]
s_cmp_lg_u32 s70, 0
s_cbranch_scc1 L_rk9
s_call_b64 s[36:37], L_rpoll
L_rk9:
s_ff1_i32_b32 s71, s70
s_bitset0_b32 s70, s71
s_mul_i32 s71, s71, 114688
SA s72,s71,s77
buffer_load_dwordx4 v[136:139], v7, s[8:11], s72 offen sc1
buffer_load_dwordx4 v[140:143], v27, s[8:11], s72 offen sc1
s_waitcnt vmcnt(7)
M v[96:99],a[246:249],v[176:179],v[96:99]
M v[100:103],a[244:247],v[176:179],v[100:103]
s_waitcnt vmcnt(6)
M v[104:107],a[246:249],v[180:183],v[104:107]
M v[108:111],a[244:247],v[180:183],v[108:111]
s_cmp_lg_u32 s70, 0
s_cbranch_scc1 L_rk10
s_call_b64 s[36:37], L_rpoll
L_rk10:
s_ff1_i32_b32 s71, s70
s_bitset0_b32 s70, s71
s_mul_i32 s71, s71, 114688
SA s72,s71,s77
buffer_load_dwordx4 v[144:147], v7, s[8:11], s72 offen sc1
buffer_load_dwordx4 v[148:151], v27, s[8:11], s72 offen sc1
s_waitcnt vmcnt(7)
M v[96:99],a[246:249],v[184:187],v[96:99]
M v[100:103],a[244:247],v[184:187],v[100:103]
s_waitcnt vmcnt(6)
M v[104:107],a[246:249],v[188:191],v[104:107]
M v[108:111],a[244:247],v[188:191],v[108:111]
s_cmp_lg_u32 s70, 0
s_cbranch_scc1 L_rk11
s_call_b64 s[36:37], L_rpoll
L_rk11:
s_ff1_i32_b32 s71, s70
s_bitset0_b32 s70, s71
s_mul_i32 s71, s71, 114688
SA s72,s71,s77
buffer_load_dwordx4 v[152:155], v7, s[8:11], s72 offen sc1
buffer_load_dwordx4 v[156:159], v27, s[8:11], s72 offen sc1
s_waitcnt vmcnt(7)
M v[96:99],a[246:249],v[128:131],v[96:99]
M v[100:103],a[244:247],v[128:131],v[100:103]
s_waitcnt vmcnt(6)
M v[104:107],a[246:249],v[132:135],v[104:107]
M v[108:111],a[244:247],v[132:135],v[108:111]
s_cmp_lg_u32 s70, 0
s_cbranch_scc1 L_rk12
s_call_b64 s[36:37], L_rpoll
L_rk12:
s_ff1_i32_b32 s71, s70
s_bitset0_b32 s70, s71
s_mul_i32 s71, s71, 114688
SA s72,s71,s77
buffer_load_dwordx4 v[160:163], v7, s[8:11], s72 offen sc1
buffer_load_dwordx4 v[164:167], v27, s[8:11], s72 offen sc1
buffer_load_dword v8, v33, s[8:11], s46 offen sc1
s_waitcnt vmcnt(8)
M v[96:99],a[246:249],v[136:139],v[96:99]
M v[100:103],a[244:247],v[136:139],v[100:103]
s_waitcnt vmcnt(7)
M v[104:107],a[246:249],v[140:143],v[104:107]
M v[108:111],a[244:247],v[140:143],v[108:111]
s_cmp_lg_u32 s70, 0
s_cbranch_scc1 L_rk13
s_call_b64 s[36:37], L_rpoll
L_rk13:
s_ff1_i32_b32 s71, s70
s_bitset0_b32 s70, s71
s_mul_i32 s71, s71, 114688
SA s72,s71,s77
buffer_load_dwordx4 v[168:171], v7, s[8:11], s72 offen sc1
buffer_load_dwordx4 v[172:175], v27, s[8:11], s72 offen sc1
s_waitcnt vmcnt(8)
M v[96:99],a[246:249],v[144:147],v[96:99]
M v[100:103],a[244:247],v[144:147],v[100:103]
s_waitcnt vmcnt(7)
M v[104:107],a[246:249],v[148:151],v[104:107]
M v[108:111],a[244:247],v[148:151],v[108:111]
s_cmp_lg_u32 s70, 0
s_cbranch_scc1 L_rk14
s_call_b64 s[36:37], L_rpoll
L_rk14:
s_ff1_i32_b32 s71, s70
s_bitset0_b32 s70, s71
s_mul_i32 s71, s71, 114688
SA s72,s71,s77
buffer_load_dwordx4 v[176:179], v7, s[8:11], s72 offen sc1
buffer_load_dwordx4 v[180:183], v27, s[8:11], s72 offen sc1
s_waitcnt vmcnt(8)
M v[96:99],a[246:249],v[152:155],v[96:99]
M v[100:103],a[244:247],v[152:155],v[100:103]
s_waitcnt vmcnt(7)
M v[104:107],a[246:249],v[156:159],v[104:107]
M v[108:111],a[244:247],v[156:159],v[108:111]
s_cmp_lg_u32 s70, 0
s_cbranch_scc1 L_rk15
s_call_b64 s[36:37], L_rpoll
L_rk15:
s_ff1_i32_b32 s71, s70
s_bitset0_b32 s70, s71
s_mul_i32 s71, s71, 114688
SA s72,s71,s77
buffer_load_dwordx4 v[184:187], v7, s[8:11], s72 offen sc1
buffer_load_dwordx4 v[188:191], v27, s[8:11], s72 offen sc1
s_waitcnt vmcnt(8)
M v[96:99],a[246:249],v[160:163],v[96:99]
M v[100:103],a[244:247],v[160:163],v[100:103]
s_waitcnt vmcnt(7)
M v[104:107],a[246:249],v[164:167],v[104:107]
M v[108:111],a[244:247],v[164:167],v[108:111]
s_waitcnt vmcnt(6)
v_cmp_eq_u32 vcc, 1, v8
s_mov_b32 s69, 0xffff0000
s_and_b32 s70, vcc_lo, s69
s_mov_b32 s68, s70
s_cmp_lg_u32 s70, 0
s_cbranch_scc1 L_rk16
s_call_b64 s[36:37], L_rpoll
L_rk16:
s_ff1_i32_b32 s71, s70
s_bitset0_b32 s70, s71
s_mul_i32 s71, s71, 114688
SA s72,s71,s78
buffer_load_dwordx4 v[192:195], v7, s[8:11], s72 offen sc1
s_waitcnt vmcnt(6)
M v[96:99],a[246:249],v[168:171],v[96:99]
M v[100:103],a[244:247],v[168:171],v[100:103]
s_waitcnt vmcnt(5)
M v[104:107],a[246:249],v[172:175],v[104:107]
M v[108:111],a[244:247],v[172:175],v[108:111]
s_cmp_lg_u32 s70, 0
s_cbranch_scc1 L_rk17
s_call_b64 s[36:37], L_rpoll
L_rk17:
s_ff1_i32_b32 s71, s70
s_bitset0_b32 s70, s71
s_mul_i32 s71, s71, 114688
SA s72,s71,s78
buffer_load_dwordx4 v[196:199], v7, s[8:11], s72 offen sc1
s_waitcnt vmcnt(5)
M v[96:99],a[246:249],v[176:179],v[96:99]
M v[100:103],a[244:247],v[176:179],v[100:103]
s_waitcnt vmcnt(4)
M v[104:107],a[246:249],v[180:183],v[104:107]
M v[108:111],a[244:247],v[180:183],v[108:111]
s_cmp_lg_u32 s70, 0
s_cbranch_scc1 L_rk18
s_call_b64 s[36:37], L_rpoll
L_rk18:
s_ff1_i32_b32 s71, s70
s_bitset0_b32 s70, s71
s_mul_i32 s71, s71, 114688
SA s72,s71,s78
buffer_load_dwordx4 v[200:203], v7, s[8:11], s72 offen sc1
s_waitcnt vmcnt(4)
M v[96:99],a[246:249],v[184:187],v[96:99]
M v[100:103],a[244:247],v[184:187],v[100:103]
s_waitcnt vmcnt(3)
M v[104:107],a[246:249],v[188:191],v[104:107]
M v[108:111],a[244:247],v[188:191],v[108:111]
s_nop 4
v_permlane16_swap_b32 v96, v100
v_permlane16_swap_b32 v97, v101
v_permlane16_swap_b32 v98, v102
v_permlane16_swap_b32 v99, v103
v_permlane16_swap_b32 v104, v108
v_permlane16_swap_b32 v105, v109
v_permlane16_swap_b32 v106, v110
v_permlane16_swap_b32 v107, v111
v_fmac_f32 v64, v39, v96
v_fmac_f32 v65, v39, v97
v_fmac_f32 v66, v39, v98
v_fmac_f32 v67, v39, v99
v_fmac_f32 v68, v39, v100
v_fmac_f32 v69, v39, v101
v_fmac_f32 v70, v39, v102
v_fmac_f32 v71, v39, v103
C v48,v64,v65
C v49,v66,v67
C v50,v68,v69
C v51,v70,v71
buffer_store_dwordx4 v[48:51], v38, s[52:55], s75 offen sc1
v_fmac_f32 v72, v39, v104
v_fmac_f32 v73, v39, v105
v_fmac_f32 v74, v39, v106
v_fmac_f32 v75, v39, v107
v_fmac_f32 v76, v39, v108
v_fmac_f32 v77, v39, v109
v_fmac_f32 v78, v39, v110
v_fmac_f32 v79, v39, v111
C v52,v72,v73
C v53,v74,v75
C v54,v76,v77
C v55,v78,v79
buffer_store_dwordx4 v[52:55], v38, s[52:55], s76 offen sc1
s_cmp_lg_u32 s70, 0
s_cbranch_scc1 L_rk19
s_call_b64 s[36:37], L_rpoll
L_rk19:
s_ff1_i32_b32 s71, s70
s_bitset0_b32 s70, s71
s_mul_i32 s71, s71, 114688
SA s72,s71,s78
buffer_load_dwordx4 v[204:207], v7, s[8:11], s72 offen sc1
s_cmp_lg_u32 s70, 0
s_cbranch_scc1 L_rk20
s_call_b64 s[36:37], L_rpoll
L_rk20:
s_ff1_i32_b32 s71, s70
s_bitset0_b32 s70, s71
s_mul_i32 s71, s71, 114688
SA s72,s71,s78
buffer_load_dwordx4 v[208:211], v7, s[8:11], s72 offen sc1
s_cmp_lg_u32 s70, 0
s_cbranch_scc1 L_rk21
s_call_b64 s[36:37], L_rpoll
L_rk21:
s_ff1_i32_b32 s71, s70
s_bitset0_b32 s70, s71
s_mul_i32 s71, s71, 114688
SA s72,s71,s78
buffer_load_dwordx4 v[212:215], v7, s[8:11], s72 offen sc1
s_cmp_lg_u32 s70, 0
s_cbranch_scc1 L_rk22
s_call_b64 s[36:37], L_rpoll
L_rk22:
s_ff1_i32_b32 s71, s70
s_bitset0_b32 s70, s71
s_mul_i32 s71, s71, 114688
SA s72,s71,s78
buffer_load_dwordx4 v[216:219], v7, s[8:11], s72 offen sc1
s_cmp_lg_u32 s70, 0
s_cbranch_scc1 L_rk23
s_call_b64 s[36:37], L_rpoll
L_rk23:
s_ff1_i32_b32 s71, s70
s_bitset0_b32 s70, s71
s_mul_i32 s71, s71, 114688
SA s72,s71,s78
buffer_load_dwordx4 v[220:223], v7, s[8:11], s72 offen sc1
s_cmp_lg_u32 s70, 0
s_cbranch_scc1 L_rk24
s_call_b64 s[36:37], L_rpoll
L_rk24:
s_ff1_i32_b32 s71, s70
s_bitset0_b32 s70, s71
s_mul_i32 s71, s71, 114688
SA s72,s71,s78
buffer_load_dwordx4 v[224:227], v7, s[8:11], s72 offen sc1
s_cmp_lg_u32 s70, 0
s_cbranch_scc1 L_rk25
s_call_b64 s[36:37], L_rpoll
L_rk25:
s_ff1_i32_b32 s71, s70
s_bitset0_b32 s70, s71
s_mul_i32 s71, s71, 114688
SA s72,s71,s78
buffer_load_dwordx4 v[228:231], v7, s[8:11], s72 offen sc1
s_cmp_lg_u32 s70, 0
s_cbranch_scc1 L_rk26
s_call_b64 s[36:37], L_rpoll
L_rk26:
s_ff1_i32_b32 s71, s70
s_bitset0_b32 s70, s71
s_mul_i32 s71, s71, 114688
SA s72,s71,s78
buffer_load_dwordx4 v[232:235], v7, s[8:11], s72 offen sc1
s_cmp_lg_u32 s70, 0
s_cbranch_scc1 L_rk27
s_call_b64 s[36:37], L_rpoll
L_rk27:
s_ff1_i32_b32 s71, s70
s_bitset0_b32 s70, s71
s_mul_i32 s71, s71, 114688
SA s72,s71,s78
buffer_load_dwordx4 v[236:239], v7, s[8:11], s72 offen sc1
s_waitcnt vmcnt(13)
M v[112:115],a[246:249],v[192:195],0
M v[116:119],a[244:247],v[192:195],0
s_cmp_lg_u32 s70, 0
s_cbranch_scc1 L_rk28
s_call_b64 s[36:37], L_rpoll
L_rk28:
s_ff1_i32_b32 s71, s70
s_bitset0_b32 s70, s71
s_mul_i32 s71, s71, 114688
SA s72,s71,s78
buffer_load_dwordx4 v[240:243], v7, s[8:11], s72 offen sc1
s_waitcnt vmcnt(13)
M v[112:115],a[246:249],v[196:199],v[112:115]
M v[116:119],a[244:247],v[196:199],v[116:119]
s_cmp_lg_u32 s70, 0
s_cbranch_scc1 L_rk29
s_call_b64 s[36:37], L_rpoll
L_rk29:
s_ff1_i32_b32 s71, s70
s_bitset0_b32 s70, s71
s_mul_i32 s71, s71, 114688
SA s72,s71,s78
buffer_load_dwordx4 v[244:247], v7, s[8:11], s72 offen sc1
s_waitcnt vmcnt(13)
M v[112:115],a[246:249],v[200:203],v[112:115]
M v[116:119],a[244:247],v[200:203],v[116:119]
s_cmp_lg_u32 s70, 0
s_cbranch_scc1 L_rk30
s_call_b64 s[36:37], L_rpoll
L_rk30:
s_ff1_i32_b32 s71, s70
s_bitset0_b32 s70, s71
s_mul_i32 s71, s71, 114688
SA s72,s71,s78
buffer_load_dwordx4 v[248:251], v7, s[8:11], s72 offen sc1
s_waitcnt vmcnt(11)
M v[112:115],a[246:249],v[204:207],v[112:115]
M v[116:119],a[244:247],v[204:207],v[116:119]
s_cmp_lg_u32 s70, 0
s_cbranch_scc1 L_rk31
s_call_b64 s[36:37], L_rpoll
L_rk31:
s_ff1_i32_b32 s71, s70
s_bitset0_b32 s70, s71
s_mul_i32 s71, s71, 114688
SA s72,s71,s78
buffer_load_dwordx4 v[252:255], v7, s[8:11], s72 offen sc1
s_waitcnt vmcnt(11)
M v[112:115],a[246:249],v[208:211],v[112:115]
M v[116:119],a[244:247],v[208:211],v[116:119]
s_waitcnt vmcnt(10)
M v[112:115],a[246:249],v[212:215],v[112:115]
M v[116:119],a[244:247],v[212:215],v[116:119]
s_waitcnt vmcnt(9)
M v[112:115],a[246:249],v[216:219],v[112:115]
M v[116:119],a[244:247],v[216:219],v[116:119]
s_waitcnt vmcnt(8)
M v[112:115],a[246:249],v[220:223],v[112:115]
M v[116:119],a[244:247],v[220:223],v[116:119]
s_waitcnt vmcnt(7)
M v[112:115],a[246:249],v[224:227],v[112:115]
M v[116:119],a[244:247],v[224:227],v[116:119]
s_waitcnt vmcnt(6)
M v[112:115],a[246:249],v[228:231],v[112:115]
M v[116:119],a[244:247],v[228:231],v[116:119]
s_waitcnt vmcnt(5)
M v[112:115],a[246:249],v[232:235],v[112:115]
M v[116:119],a[244:247],v[232:235],v[116:119]
s_waitcnt vmcnt(4)
M v[112:115],a[246:249],v[236:239],v[112:115]
M v[116:119],a[244:247],v[236:239],v[116:119]
s_waitcnt vmcnt(3)
M v[112:115],a[246:249],v[240:243],v[112:115]
M v[116:119],a[244:247],v[240:243],v[116:119]
s_waitcnt vmcnt(2)
M v[112:115],a[246:249],v[244:247],v[112:115]
M v[116:119],a[244:247],v[244:247],v[116:119]
s_waitcnt vmcnt(1)
M v[112:115],a[246:249],v[248:251],v[112:115]
M v[116:119],a[244:247],v[248:251],v[116:119]
s_waitcnt vmcnt(0)
M v[112:115],a[246:249],v[252:255],v[112:115]
M v[116:119],a[244:247],v[252:255],v[116:119]
s_nop 7
v_permlane16_swap_b32 v112, v116
v_permlane16_swap_b32 v113, v117
v_permlane16_swap_b32 v114, v118
v_permlane16_swap_b32 v115, v119
v_fmac_f32 v80, v26, v112
v_fmac_f32 v81, v26, v113
v_fmac_f32 v82, v26, v114
v_fmac_f32 v83, v26, v115
v_fmac_f32 v84, v26, v116
v_fmac_f32 v85, v26, v117
v_fmac_f32 v86, v26, v118
v_fmac_f32 v87, v26, v119
C v44,v80,v81
C v45,v82,v83
C v46,v84,v85
C v47,v86,v87
buffer_store_dwordx4 v[44:47], v28, s[52:55], s79 offen sc1
s_endpgm
L_rpoll0:
s_sleep 1
L_rpoll:
buffer_load_dword v9, v33, s[8:11], s46 offen sc1
s_waitcnt vmcnt(0)
v_cmp_eq_u32 vcc, 1, v9
s_sub_u32 s91, s91, 1
s_cselect_b32 s70, -1, 0
s_or_b32 s70, s70, vcc_lo
s_and_b32 s70, s70, s69
s_andn2_b32 s70, s70, s68
s_cbranch_scc0 L_rpoll0
s_or_b32 s68, s68, s70
s_setpc_b64 s[36:37]
L_moe0:
s_lshl_b32 s88, s75, 1
s_call_b64 s[36:37], L_moe
AF v64,v2,v64
AF v65,v3,v65
AF v66,v4,v66
AF v67,v5,v67
AF v68,v10,v68
AF v69,v11,v69
AF v70,v12,v70
AF v71,v13,v71
AF v72,v14,v72
AF v73,v15,v73
AF v74,v16,v74
AF v75,v17,v75
AF v76,v18,v76
AF v77,v19,v77
AF v78,v20,v78
AF v79,v21,v79
s_mov_b64 exec, -1
s_branch L_moe_ret0
L_moe1:
s_lshl_b32 s88, s79, 1
s_call_b64 s[36:37], L_moe
AF v80,v2,v80
AF v81,v3,v81
AF v82,v4,v82
AF v83,v5,v83
AF v84,v10,v84
AF v85,v11,v85
AF v86,v12,v86
AF v87,v13,v87
s_mov_b64 exec, -1
s_branch L_moe_ret1
L_moe2:
s_lshl_b32 s88, s79, 1
s_call_b64 s[36:37], L_moe
AF v48,v2,v48
AF v49,v3,v49
AF v50,v4,v50
AF v51,v5,v51
AF v52,v10,v52
AF v53,v11,v53
AF v54,v12,v54
AF v55,v13,v55
s_mov_b64 exec, -1
s_branch L_moe_ret2
L_moe:
v_min_u32 v0, 27, v32
v_lshlrev_b32 v0, 2, v0
s_mov_b32 s64, 105062912
s_mov_b32 s65, 65536
s_mov_b32 exec_lo, 0xffffffff
s_mov_b32 exec_hi, 0xffffffff
L_pfy:
buffer_load_dword v1, v0, s[8:11], s64 offen sc1
s_sub_u32 s65, s65, 1
s_cbranch_scc1 L_pfy_x
s_waitcnt vmcnt(0)
v_cmp_ne_u32 vcc, 1, v1
s_nop 0
s_cbranch_vccz L_pfy_x
s_sleep 2
s_branch L_pfy
L_pfy_x:
s_waitcnt vmcnt(0)
s_mov_b64 exec, -1
s_or_b64 exec, s[80:81], s[82:83]
v_mov_b32 v0, 1792
v_cndmask_b32 v0, v0, 0, s[80:81]
v_lshl_add_u32 v0, v34, 5, v0
SA s88,s88,104898560
buffer_load_dwordx4 v[2:5], v0, s[8:11], s88 offen sc1
buffer_load_dwordx4 v[10:13], v0, s[8:11], s88 offen offset:16 sc1
buffer_load_dwordx4 v[14:17], v0, s[8:11], s88 offen offset:512 sc1
buffer_load_dwordx4 v[18:21], v0, s[8:11], s88 offen offset:528 sc1
s_waitcnt vmcnt(0)
s_setpc_b64 s[36:37]
L_red:
v_lshrrev_b32 v32, 4, v7
s_lshr_b32 s74, s41, 3
s_lshl_b32 s64, s42, 1
SA s46,s64,s74
s_mul_i32 s46, s46, 4352
s_and_b32 s72, s41, 7
s_lshl_b32 s65, s72, 7
SA s46,s46,s65
SA s46,s46,104992768
v_and_b32 v33, 31, v32
v_lshlrev_b32 v33, 2, v33
s_lshl_b32 s65, s41, 7
SA s65,s65,104890368
buffer_load_dword v31, v33, s[8:11], s65 offen sc1
v_bfe_u32 v34, v32, 4, 1
v_lshlrev_b32 v34, 1, v34
v_lshrrev_b32 v35, 5, v32
v_add_u32 v34, v34, v35
s_mov_b32 s52, s96
s_and_b32 s53, s97, 0xffff
s_mov_b32 s54, 1835008
s_mov_b32 s55, 0x20000
s_mul_i32 s77, s42, 1835008
s_mul_i32 s78, s72, 14336
SA s77,s77,s78
SA s77,s77,67108864
s_lshl_b32 s79, s74, 1
SA s79,s79,s20
s_lshl_b32 s71, s74, 1
SA s71,s71,1
s_sub_u32 s71, s71, s20
s_and_b32 s71, s71, 536870912
s_sub_u32 s64, 15, s64
s_sub_u32 s78, s64, 1
s_mul_i32 s78, s78, 1835008
SA s78,s78,s77
s_lshl_b32 s65, s79, 10
SA s78,s78,s65
SA s78,s78,s71
s_lshl_b32 s79, s79, 6
s_or_b32 s79, s79, s71
s_mul_i32 s67, s74, -2
s_lshl_b32 s74, s74, 3
SA s74,s74,s20
s_lshl_b32 s75, s74, 6
SA s76,s75,256
SA s67,s67,3
s_sub_u32 s67, s67, s20
s_and_b32 s67, s67, 536870912
s_or_b32 s76, s76, s67
v_or_b32 v27, s67, v7
v_add_u32 v27, 4096, v27
s_lshl_b32 s65, s74, 10
SA s77,s77,s65
s_lshl_b32 s64, s64, 7
s_lshr_b32 s73, s72, 1
s_sub_u32 s65, 7, s73
s_bitcmp1_b32 s72, 0
s_cselect_b32 s73, s65, s73
s_lshl_b32 s73, s73, 4
s_lshl_b32 s65, s42, 7
SA s73,s73,s65
v_and_b32 v37, 15, v32
v_add_u32 v37, s73, v37
v_add_u32 v29, s64, v37
s_mov_b32 s64, 104857664
v_mul_u32_u24 v38, 896, v37
v_lshl_add_u32 v38, v34, 4, v38
v_lshrrev_b32 v35, 4, v37
v_lshlrev_b32 v35, 5, v35
v_and_b32 v36, 15, v37
v_add_lshl_u32 v35, v35, v36, 2
buffer_load_dword v39, v35, s[8:11], s64 offen sc1
buffer_load_dwordx4 v[48:51], v38, s[56:59], s75 offen
buffer_load_dwordx4 v[52:55], v38, s[56:59], s76 offen
v_mul_u32_u24 v28, 896, v29
v_lshl_add_u32 v28, v34, 4, v28
v_lshrrev_b32 v35, 4, v29
v_lshlrev_b32 v35, 5, v35
v_and_b32 v36, 15, v29
v_add_lshl_u32 v35, v35, v36, 2
buffer_load_dword v26, v35, s[8:11], s64 offen sc1
buffer_load_dwordx4 v[44:47], v28, s[56:59], s79 offen
s_waitcnt vmcnt(7)
buffer_load_dword v9, v33, s[8:11], s46 offen sc1
s_branch L_red1
L_code_end:
.section .rodata,"a"
.p2align 6
.amdhsa_kernel gated_mix__compressed_kv_cla__moe_arch_mod__prompt_kernel
  .amdhsa_next_free_vgpr 512
  .amdhsa_next_free_sgpr 102
  .amdhsa_accum_offset 256
  .amdhsa_group_segment_fixed_size 0
  .amdhsa_kernarg_size 120
  .amdhsa_user_sgpr_count 2
  .amdhsa_user_sgpr_kernarg_segment_ptr 1
  .amdhsa_system_sgpr_workgroup_id_x 1
  .amdhsa_float_denorm_mode_32 3
.end_amdhsa_kernel
```

```asm
; @launch grid=(256,1,1) block=(256,1,1) lds=163840
.amdgcn_target "amdgcn-amd-amdhsa--gfx950"
.text
.macro M a, b, c, d
v_mfma_f32_16x16x32_bf16 \a, \b, \c, \d
.endm
.macro R a, b, c
ds_read_b128 \a, \b offset:\c
.endm
.macro T a, b, c
ds_read_b64_tr_b16 \a, \b offset:\c
.endm
.macro C a, b, c
v_cvt_pk_bf16_f32 \a, \b, \c
.endm
.macro E a, b
v_exp_f32 \a, \b
.endm
.macro W a, b
v_accvgpr_write_b32 \a, \b
.endm
.macro G a, b
v_accvgpr_read_b32 \a, \b
.endm
.macro AF a, b, c
v_add_f32 \a, \b, \c
.endm
.macro MF a, b, c
v_mul_f32 \a, \b, \c
.endm
.macro SA a, b, c
s_add_u32 \a, \b, \c
.endm
.globl gated_mix__compressed_kv_cla__moe_arch_mod__prompt_kernel
.p2align 8
.type gated_mix__compressed_kv_cla__moe_arch_mod__prompt_kernel,@function
gated_mix__compressed_kv_cla__moe_arch_mod__prompt_kernel:
s_cmp_lt_u32 s2, 256
s_cbranch_scc1 L_go
s_endpgm
L_go:
s_load_dwordx8 s[80:87], s[0:1], 0
s_load_dwordx4 s[88:91], s[0:1], 32
s_getpc_b64 s[76:77]
L_pc0:
s_lshr_b32 s42, s2, 3
s_mov_b32 s79, 0x20000
s_lshl_b32 s67, s42, 13
s_mov_b32 s78, L_code_end-L_pc0
s_and_b32 s77, s77, 0xffff
v_lshl_add_u32 v31, v0, 5, s67
buffer_load_dword a240, v31, s[76:79], 0 offen offset:0
v_lshrrev_b32 v24, 6, v0
v_and_b32 v0, 63, v0
s_and_b32 s41, s2, 7
v_readfirstlane_b32 s20, v24
s_lshr_b32 s64, s2, 4
v_and_b32 v24, 15, v0
v_lshrrev_b32 v25, 4, v0
s_and_b32 s64, s64, 8
s_or_b32 s41, s41, s64
v_lshlrev_b32 v28, 1, v25
v_xor_b32 v28, v28, v24
v_and_b32 v29, 8, v28
v_and_b32 v28, 7, v28
v_lshlrev_b32 v28, 4, v28
v_lshl_add_u32 v28, v29, 5, v28
v_lshl_add_u32 v28, v25, 13, v28
s_lshl_b32 s64, s20, 17
v_add_u32 v8, s64, v28
v_xor_b32 v28, 0x100, v8
v_add_u32 v9, 31744, v8
v_add_u32 v10, 63488, v28
v_add_u32 v11, 95232, v28
s_mov_b32 s21, 0
s_lshl_b32 s23, s20, 12
s_lshl_b32 s74, s41, 9
s_sub_u32 s18, 8388608, s74
s_mov_b32 s19, s79
s_bitcmp0_b32 s2, 6
s_waitcnt lgkmcnt(0)
s_cselect_b64 s[72:73], s[86:87], s[88:89]
SA s16,s72,s74
s_addc_u32 s73, s73, 0
s_and_b32 s17, s73, 0xffff
SA m0,s23,0
s_nop 0
buffer_load_dwordx4 v8, s[16:19], s21 offen offset:0  nt lds
buffer_load_dwordx4 v9, s[16:19], s21 offen offset:1024  nt lds
buffer_load_dwordx4 v10, s[16:19], s21 offen offset:2048  nt lds
buffer_load_dwordx4 v11, s[16:19], s21 offen offset:3072  nt lds
SA s21,s21,128
s_and_b32 s42, s42, 15
s_lshr_b32 s45, s42, 3
s_and_b32 s65, s20, 1
s_lshr_b32 s66, s20, 1
v_and_b32 v29, 7, v0
v_xor_b32 v28, v25, v29
v_lshlrev_b32 v28, 4, v28
v_lshrrev_b32 v29, 3, v0
v_lshl_add_u32 v30, v29, 11, v28
s_lshl_b32 s64, s66, 19
s_lshl_b32 s67, s65, 21
SA s64,s64,s67
v_add_u32 v12, s64, v30
v_xor_b32 v30, 64, v12
v_add_u32 v14, 30720, v12
v_add_u32 v13, 15360, v30
v_add_u32 v15, 46080, v30
s_mov_b32 s22, 0
SA s24,s23,65536
s_and_b32 s64, s42, 7
s_lshl_b32 s64, s64, 16
s_sub_u32 s50, 4194304, s64
s_mov_b32 s51, s79
SA s48,s82,s64
s_addc_u32 s73, s83, 0
s_and_b32 s49, s73, 0xffff
SA m0,s23,16384
s_nop 0
buffer_load_dwordx4 v8, s[16:19], s21 offen offset:0  nt lds
buffer_load_dwordx4 v9, s[16:19], s21 offen offset:1024  nt lds
buffer_load_dwordx4 v10, s[16:19], s21 offen offset:2048  nt lds
buffer_load_dwordx4 v11, s[16:19], s21 offen offset:3072  nt lds
SA s21,s21,524160
SA m0,s24,0
s_nop 0
buffer_load_dwordx4 v12, s[48:51], s22 offen offset:0   lds
buffer_load_dwordx4 v13, s[48:51], s22 offen offset:1024   lds
buffer_load_dwordx4 v14, s[48:51], s22 offen offset:2048   lds
buffer_load_dwordx4 v15, s[48:51], s22 offen offset:3072   lds
SA s22,s22,1048576
s_load_dwordx2 s[92:93], s[0:1], 56
s_load_dwordx2 s[94:95], s[0:1], 88
s_load_dwordx4 s[4:7], s[0:1], 104
v_lshlrev_b32 v7, 4, v0
v_lshrrev_b32 v26, 2, v24
v_and_b32 v28, 1, v25
v_lshl_or_b32 v28, v28, 2, v26
v_lshl_add_u32 v29, v25, 3, v26
v_lshlrev_b32 v29, 8, v29
v_and_b32 v30, 3, v0
v_lshl_add_u32 v29, v30, 3, v29
s_lshl_b32 s64, s65, 2
SA s64,s64,0
v_xor_b32 v30, s64, v28
v_lshl_add_u32 v1, v30, 5, v29
s_lshl_b32 s64, s65, 2
SA s64,s64,1
v_xor_b32 v30, s64, v28
v_lshl_add_u32 v2, v30, 5, v29
s_lshl_b32 s64, s65, 2
SA s64,s64,2
v_xor_b32 v30, s64, v28
v_lshl_add_u32 v3, v30, 5, v29
s_lshl_b32 s64, s65, 2
SA s64,s64,3
v_xor_b32 v30, s64, v28
v_lshl_add_u32 v4, v30, 5, v29
v_add_u32 v28, 0, v25
v_lshrrev_b32 v29, 1, v24
v_xor_b32 v28, v28, v29
v_lshlrev_b32 v28, 4, v28
v_lshl_add_u32 v28, v24, 7, v28
s_lshl_b32 s64, s66, 13
SA s64,s64,65536
v_add_u32 v5, s64, v28
v_add_u32 v28, 4, v25
v_lshrrev_b32 v29, 1, v24
v_xor_b32 v28, v28, v29
v_lshlrev_b32 v28, 4, v28
v_lshl_add_u32 v28, v24, 7, v28
s_lshl_b32 s64, s66, 13
SA s64,s64,65536
v_add_u32 v6, s64, v28
s_mov_b32 s56, s80
s_and_b32 s57, s81, 0xffff
s_mov_b32 s58, 1835008
s_mov_b32 s59, 0x20000
s_waitcnt lgkmcnt(0)
s_mov_b32 s60, s92
s_and_b32 s61, s93, 0xffff
s_mov_b32 s62, 896
s_mov_b32 s63, 0x20000
s_mov_b32 s68, s94
s_and_b32 s69, s95, 0xffff
s_mov_b32 s70, 896
s_mov_b32 s71, 0x20000
s_lshl_b32 s95, s20, 11
s_lshr_b32 s64, s2, 3
s_lshl_b32 s64, s64, 13
SA s95,s95,s64
s_mov_b32 s8, s6
s_and_b32 s9, s7, 0xffff
s_mov_b32 s10, 268435456
s_mov_b32 s11, 0x20000
s_mov_b32 s12, s4
s_and_b32 s13, s5, 0xffff
s_mov_b32 s14, 256
s_mov_b32 s15, 0x20000
SA s72,s84,s74
s_addc_u32 s73, s85, 0
s_sub_u32 s75, 3670016, s74
s_mov_b32 s52, s72
s_and_b32 s53, s73, 0xffff
s_mov_b32 s54, s75
s_mov_b32 s55, 0x20000
s_mul_i32 s29, s42, 114688
s_mov_b32 s5, 0x3db8aa3b
s_mul_i32 s72, s45, 16777216
s_mul_i32 s73, s41, 1048576
SA s72,s72,s73
s_bfe_u32 s64, s42, 0x20001
s_lshl_b32 s64, s64, 15
SA s72,s72,s64
s_lshl_b32 s64, s66, 17
SA s72,s72,s64
s_and_b32 s67, s42, 1
s_cmp_eq_u32 s45, 0
s_cselect_b32 s64, 12, 14
s_cselect_b32 s75, 14, 10
s_lshl_b32 s67, s67, s75
SA s72,s72,s67
s_lshl_b32 s64, s65, s64
SA s93,s72,s64
s_load_dwordx4 s[80:83], s[0:1], 64
s_load_dwordx2 s[84:85], s[0:1], 80
s_load_dwordx2 s[96:97], s[0:1], 96
s_cmp_eq_u32 s45, 0
s_cbranch_scc0 L_kv1
s_branch L_kv0
.p2align 12
L_kv0:
s_and_b32 s31, s42, 7
s_lshl_b32 s64, s42, 4
SA s64,s64,s41
s_lshl_b32 s64, s64, 2
SA s64,s64,s20
s_cmp_lt_u32 s64, 41
s_cselect_b32 s39, 0, 536870912
s_min_u32 s64, s64, 41
s_lshl_b32 s38, s64, 2
s_max_u32 s67, s64, 8
s_sub_u32 s67, s67, 8
s_mul_i32 s67, s67, 3328
s_lshl_b32 s64, s64, 10
SA s64,s64,s67
SA s73,s64,104914944
v_or_b32 v64, s39, v7
v_mov_b32 v68, 0
v_mov_b32 v69, 0
v_mov_b32 v70, 0
v_mov_b32 v71, 0
buffer_store_dwordx4 v[68:71], v64, s[8:11], s73 offen offset:0 sc1
buffer_store_dwordx4 v[68:71], v64, s[8:11], s73 offen offset:1024 sc1
buffer_store_dwordx4 v[68:71], v64, s[8:11], s73 offen offset:2048 sc1
SA m0,s24,16384
s_nop 0
buffer_load_dwordx4 v12, s[48:51], s22 offen offset:0   lds
buffer_load_dwordx4 v13, s[48:51], s22 offen offset:1024   lds
buffer_load_dwordx4 v14, s[48:51], s22 offen offset:2048   lds
buffer_load_dwordx4 v15, s[48:51], s22 offen offset:3072   lds
s_sub_u32 s22, s22, 1048448
SA m0,s23,32768
s_nop 0
buffer_load_dwordx4 v8, s[16:19], s21 offen offset:0  nt lds
buffer_load_dwordx4 v9, s[16:19], s21 offen offset:1024  nt lds
buffer_load_dwordx4 v10, s[16:19], s21 offen offset:2048  nt lds
buffer_load_dwordx4 v11, s[16:19], s21 offen offset:3072  nt lds
SA s21,s21,128
s_mov_b64 exec, 0
s_cmp_eq_u32 s20, 0
s_cbranch_scc1 L_w_kv01
s_cmp_eq_u32 s20, 1
s_cbranch_scc1 L_w_kv02
s_cmp_eq_u32 s20, 2
s_cbranch_scc1 L_w_kv03
s_branch L_w_kv04
L_wd1:
s_mov_b64 exec, -1
s_waitcnt vmcnt(11) lgkmcnt(0)
s_barrier
R a[160:163],v5,0
R a[164:167],v6,0
T a[96:97],v1,0
T a[98:99],v1,1024
T a[100:101],v1,8192
T a[102:103],v1,9216
T a[104:105],v2,0
T a[106:107],v2,1024
T a[108:109],v2,8192
T a[110:111],v2,9216
T a[112:113],v3,0
T a[114:115],v3,1024
T a[116:117],v3,8192
T a[118:119],v3,9216
T a[120:121],v4,0
T a[122:123],v4,1024
T a[124:125],v4,8192
T a[126:127],v4,9216
T a[128:129],v1,16384
T a[130:131],v1,17408
T a[132:133],v1,24576
T a[134:135],v1,25600
T a[136:137],v2,16384
T a[138:139],v2,17408
T a[140:141],v2,24576
T a[142:143],v2,25600
T a[144:145],v3,16384
T a[146:147],v3,17408
T a[148:149],v3,24576
T a[150:151],v3,25600
T a[152:153],v4,16384
T a[154:155],v4,17408
T a[156:157],v4,24576
T a[158:159],v4,25600
s_waitcnt lgkmcnt(15)
M a[0:3],a[96:99],a[160:163],0
SA m0,s23,49152
R a[168:171],v5,2048
R a[172:175],v6,2048
M a[0:3],a[100:103],a[164:167],a[0:3]
buffer_load_dwordx4 v8, s[16:19], s21 offen offset:0  nt lds
M a[4:7],a[108:111],a[164:167],0
M a[4:7],a[104:107],a[160:163],a[4:7]
M a[8:11],a[112:115],a[160:163],0
buffer_load_dwordx4 v9, s[16:19], s21 offen offset:1024  nt lds
M a[8:11],a[116:119],a[164:167],a[8:11]
s_waitcnt lgkmcnt(14)
M a[12:15],a[124:127],a[164:167],0
M a[12:15],a[120:123],a[160:163],a[12:15]
M a[16:19],a[128:131],a[160:163],0
buffer_load_dwordx4 v10, s[16:19], s21 offen offset:2048  nt lds
M a[16:19],a[132:135],a[164:167],a[16:19]
s_waitcnt lgkmcnt(6)
M a[20:23],a[140:143],a[164:167],0
M a[20:23],a[136:139],a[160:163],a[20:23]
buffer_load_dwordx4 v11, s[16:19], s21 offen offset:3072  nt lds
M a[24:27],a[144:147],a[160:163],0
SA s21,s21,524160
M a[24:27],a[148:151],a[164:167],a[24:27]
s_waitcnt lgkmcnt(0)
M a[28:31],a[156:159],a[164:167],0
SA m0,s24,32768
M a[28:31],a[152:155],a[160:163],a[28:31]
buffer_load_dwordx4 v12, s[48:51], s22 offen offset:0   lds
M v[32:35],a[96:99],a[168:171],0
R a[160:163],v5,4096
R a[164:167],v6,4096
M v[32:35],a[100:103],a[172:175],v[32:35]
M v[36:39],a[108:111],a[172:175],0
M v[36:39],a[104:107],a[168:171],v[36:39]
buffer_load_dwordx4 v13, s[48:51], s22 offen offset:1024   lds
M v[40:43],a[112:115],a[168:171],0
M v[40:43],a[116:119],a[172:175],v[40:43]
M v[44:47],a[124:127],a[172:175],0
buffer_load_dwordx4 v14, s[48:51], s22 offen offset:2048   lds
M v[44:47],a[120:123],a[168:171],v[44:47]
M v[48:51],a[128:131],a[168:171],0
M v[48:51],a[132:135],a[172:175],v[48:51]
M v[52:55],a[140:143],a[172:175],0
buffer_load_dwordx4 v15, s[48:51], s22 offen offset:3072   lds
M v[52:55],a[136:139],a[168:171],v[52:55]
SA s22,s22,1048576
M v[56:59],a[144:147],a[168:171],0
M v[56:59],a[148:151],a[172:175],v[56:59]
s_waitcnt lgkmcnt(0)
M v[60:63],a[156:159],a[172:175],0
M v[60:63],a[152:155],a[168:171],v[60:63]
M v[64:67],a[96:99],a[160:163],0
R a[168:171],v5,6144
R a[172:175],v6,6144
M v[64:67],a[100:103],a[164:167],v[64:67]
M v[68:71],a[108:111],a[164:167],0
M v[68:71],a[104:107],a[160:163],v[68:71]
M v[72:75],a[112:115],a[160:163],0
M v[72:75],a[116:119],a[164:167],v[72:75]
M v[76:79],a[124:127],a[164:167],0
M v[76:79],a[120:123],a[160:163],v[76:79]
M v[80:83],a[128:131],a[160:163],0
M v[80:83],a[132:135],a[164:167],v[80:83]
M v[84:87],a[140:143],a[164:167],0
M v[84:87],a[136:139],a[160:163],v[84:87]
M v[88:91],a[144:147],a[160:163],0
M v[88:91],a[148:151],a[164:167],v[88:91]
s_waitcnt lgkmcnt(0)
M v[92:95],a[156:159],a[164:167],0
s_waitcnt vmcnt(12)
M v[92:95],a[152:155],a[160:163],v[92:95]
s_barrier
M v[96:99],a[96:99],a[168:171],0
SA m0,s23,0
R a[160:163],v5,16384
R a[164:167],v6,16384
M v[96:99],a[100:103],a[172:175],v[96:99]
buffer_load_dwordx4 v8, s[16:19], s21 offen offset:0  nt lds
M v[100:103],a[108:111],a[172:175],0
v_lshlrev_b32 v26, 7, v0
v_and_b32 v27, 48, v0
M v[100:103],a[104:107],a[168:171],v[100:103]
v_lshl_add_u32 v26, v27, 24, v26
M v[104:107],a[112:115],a[168:171],0
buffer_load_dwordx4 v9, s[16:19], s21 offen offset:1024  nt lds
M v[104:107],a[116:119],a[172:175],v[104:107]
M v[108:111],a[124:127],a[172:175],0
M v[108:111],a[120:123],a[168:171],v[108:111]
buffer_load_dwordx4 v10, s[16:19], s21 offen offset:2048  nt lds
M v[112:115],a[128:131],a[168:171],0
M v[112:115],a[132:135],a[172:175],v[112:115]
M v[116:119],a[140:143],a[172:175],0
M v[116:119],a[136:139],a[168:171],v[116:119]
buffer_load_dwordx4 v11, s[16:19], s21 offen offset:3072  nt lds
M v[120:123],a[144:147],a[168:171],0
SA s21,s21,128
M v[120:123],a[148:151],a[172:175],v[120:123]
s_waitcnt lgkmcnt(0)
M v[124:127],a[156:159],a[172:175],0
SA m0,s24,49152
M v[124:127],a[152:155],a[168:171],v[124:127]
buffer_load_dwordx4 v12, s[48:51], s22 offen offset:0   lds
M v[128:131],a[96:99],a[160:163],0
R a[168:171],v5,18432
R a[172:175],v6,18432
M v[128:131],a[100:103],a[164:167],v[128:131]
buffer_load_dwordx4 v13, s[48:51], s22 offen offset:1024   lds
M v[132:135],a[108:111],a[164:167],0
M v[132:135],a[104:107],a[160:163],v[132:135]
M v[136:139],a[112:115],a[160:163],0
M v[136:139],a[116:119],a[164:167],v[136:139]
buffer_load_dwordx4 v14, s[48:51], s22 offen offset:2048   lds
M v[140:143],a[124:127],a[164:167],0
M v[140:143],a[120:123],a[160:163],v[140:143]
M v[144:147],a[128:131],a[160:163],0
buffer_load_dwordx4 v15, s[48:51], s22 offen offset:3072   lds
M v[144:147],a[132:135],a[164:167],v[144:147]
s_sub_u32 s22, s22, 1048448
M v[148:151],a[140:143],a[164:167],0
M v[148:151],a[136:139],a[160:163],v[148:151]
M v[152:155],a[144:147],a[160:163],0
M v[152:155],a[148:151],a[164:167],v[152:155]
s_waitcnt lgkmcnt(0)
M v[156:159],a[156:159],a[164:167],0
s_waitcnt vmcnt(12)
M v[156:159],a[152:155],a[160:163],v[156:159]
s_barrier
M v[160:163],a[96:99],a[168:171],0
SA m0,s23,16384
R a[160:163],v5,20480
R a[164:167],v6,20480
M v[160:163],a[100:103],a[172:175],v[160:163]
T a[32:33],v1,32768
T a[34:35],v1,33792
M v[164:167],a[108:111],a[172:175],0
T a[36:37],v1,40960
T a[38:39],v1,41984
M v[164:167],a[104:107],a[168:171],v[164:167]
T a[40:41],v2,32768
T a[42:43],v2,33792
M v[168:171],a[112:115],a[168:171],0
T a[44:45],v2,40960
T a[46:47],v2,41984
M v[168:171],a[116:119],a[172:175],v[168:171]
buffer_load_dwordx4 v8, s[16:19], s21 offen offset:0  nt lds
M v[172:175],a[124:127],a[172:175],0
s_nop 0
T a[48:49],v3,32768
T a[50:51],v3,33792
M v[172:175],a[120:123],a[168:171],v[172:175]
buffer_load_dwordx4 v9, s[16:19], s21 offen offset:1024  nt lds
M v[176:179],a[128:131],a[168:171],0
s_nop 0
T a[52:53],v3,40960
T a[54:55],v3,41984
M v[176:179],a[132:135],a[172:175],v[176:179]
T a[56:57],v4,32768
T a[58:59],v4,33792
M v[180:183],a[140:143],a[172:175],0
buffer_load_dwordx4 v10, s[16:19], s21 offen offset:2048  nt lds
M v[180:183],a[136:139],a[168:171],v[180:183]
s_nop 0
T a[60:61],v4,40960
T a[62:63],v4,41984
M v[184:187],a[144:147],a[168:171],0
buffer_load_dwordx4 v11, s[16:19], s21 offen offset:3072  nt lds
M v[184:187],a[148:151],a[172:175],v[184:187]
s_waitcnt lgkmcnt(15)
s_nop 0
T a[64:65],v1,49152
T a[66:67],v1,50176
M v[188:191],a[156:159],a[172:175],0
SA s21,s21,524160
T a[68:69],v1,57344
T a[70:71],v1,58368
M v[188:191],a[152:155],a[168:171],v[188:191]
SA m0,s24,0
M v[192:195],a[96:99],a[160:163],0
R a[168:171],v5,22528
R a[172:175],v6,22528
M v[192:195],a[100:103],a[164:167],v[192:195]
T a[72:73],v2,49152
T a[74:75],v2,50176
M v[196:199],a[108:111],a[164:167],0
T a[76:77],v2,57344
T a[78:79],v2,58368
M v[196:199],a[104:107],a[160:163],v[196:199]
T a[80:81],v3,49152
T a[82:83],v3,50176
M v[200:203],a[112:115],a[160:163],0
buffer_load_dwordx4 v12, s[48:51], s22 offen offset:0   lds
M v[200:203],a[116:119],a[164:167],v[200:203]
s_nop 0
T a[84:85],v3,57344
T a[86:87],v3,58368
M v[204:207],a[124:127],a[164:167],0
T a[88:89],v4,49152
T a[90:91],v4,50176
M v[204:207],a[120:123],a[160:163],v[204:207]
buffer_load_dwordx4 v13, s[48:51], s22 offen offset:1024   lds
M v[208:211],a[128:131],a[160:163],0
s_nop 0
T a[92:93],v4,57344
T a[94:95],v4,58368
M v[208:211],a[132:135],a[164:167],v[208:211]
buffer_load_dwordx4 v14, s[48:51], s22 offen offset:2048   lds
M v[212:215],a[140:143],a[164:167],0
buffer_load_dwordx4 v15, s[48:51], s22 offen offset:3072   lds
M v[212:215],a[136:139],a[160:163],v[212:215]
SA s22,s22,1048576
M v[216:219],a[144:147],a[160:163],0
M v[216:219],a[148:151],a[164:167],v[216:219]
s_waitcnt lgkmcnt(12)
M v[220:223],a[156:159],a[164:167],0
s_waitcnt vmcnt(12) lgkmcnt(0)
M v[220:223],a[152:155],a[160:163],v[220:223]
s_barrier
M v[224:227],a[96:99],a[168:171],0
SA m0,s23,32768
R a[160:163],v5,32768
R a[164:167],v6,32768
M v[224:227],a[100:103],a[172:175],v[224:227]
buffer_load_dwordx4 v8, s[16:19], s21 offen offset:0  nt lds
M v[228:231],a[108:111],a[172:175],0
M v[228:231],a[104:107],a[168:171],v[228:231]
M v[232:235],a[112:115],a[168:171],0
buffer_load_dwordx4 v9, s[16:19], s21 offen offset:1024  nt lds
M v[232:235],a[116:119],a[172:175],v[232:235]
M v[236:239],a[124:127],a[172:175],0
M v[236:239],a[120:123],a[168:171],v[236:239]
buffer_load_dwordx4 v10, s[16:19], s21 offen offset:2048  nt lds
M v[240:243],a[128:131],a[168:171],0
M v[240:243],a[132:135],a[172:175],v[240:243]
M v[244:247],a[140:143],a[172:175],0
buffer_load_dwordx4 v11, s[16:19], s21 offen offset:3072  nt lds
M v[244:247],a[136:139],a[168:171],v[244:247]
SA s21,s21,128
M v[248:251],a[144:147],a[168:171],0
M v[248:251],a[148:151],a[172:175],v[248:251]
s_waitcnt lgkmcnt(0)
M v[252:255],a[156:159],a[172:175],0
M v[252:255],a[152:155],a[168:171],v[252:255]
M a[0:3],a[32:35],a[160:163],a[0:3]
R a[168:171],v5,34816
R a[172:175],v6,34816
M a[0:3],a[36:39],a[164:167],a[0:3]
T a[96:97],v1,0
T a[98:99],v1,1024
M a[4:7],a[44:47],a[164:167],a[4:7]
SA m0,s24,16384
M a[4:7],a[40:43],a[160:163],a[4:7]
buffer_load_dwordx4 v12, s[48:51], s22 offen offset:0   lds
M a[8:11],a[48:51],a[160:163],a[8:11]
M a[8:11],a[52:55],a[164:167],a[8:11]
M a[12:15],a[60:63],a[164:167],a[12:15]
s_nop 0
T a[100:101],v1,8192
T a[102:103],v1,9216
M a[12:15],a[56:59],a[160:163],a[12:15]
M a[16:19],a[64:67],a[160:163],a[16:19]
buffer_load_dwordx4 v13, s[48:51], s22 offen offset:1024   lds
M a[16:19],a[68:71],a[164:167],a[16:19]
M a[20:23],a[76:79],a[164:167],a[20:23]
M a[20:23],a[72:75],a[160:163],a[20:23]
s_nop 0
T a[104:105],v2,0
T a[106:107],v2,1024
M a[24:27],a[80:83],a[160:163],a[24:27]
M a[24:27],a[84:87],a[164:167],a[24:27]
s_waitcnt lgkmcnt(6)
buffer_load_dwordx4 v14, s[48:51], s22 offen offset:2048   lds
M a[28:31],a[92:95],a[164:167],a[28:31]
M a[28:31],a[88:91],a[160:163],a[28:31]
M v[32:35],a[32:35],a[168:171],v[32:35]
R a[160:163],v5,36864
R a[164:167],v6,36864
M v[32:35],a[36:39],a[172:175],v[32:35]
T a[108:109],v2,8192
T a[110:111],v2,9216
M v[36:39],a[44:47],a[172:175],v[36:39]
buffer_load_dwordx4 v15, s[48:51], s22 offen offset:3072   lds
M v[36:39],a[40:43],a[168:171],v[36:39]
s_sub_u32 s22, s22, 1048448
M v[40:43],a[48:51],a[168:171],v[40:43]
M v[40:43],a[52:55],a[172:175],v[40:43]
s_nop 0
T a[112:113],v3,0
T a[114:115],v3,1024
M v[44:47],a[60:63],a[172:175],v[44:47]
SA m0,s23,49152
M v[44:47],a[56:59],a[168:171],v[44:47]
buffer_load_dwordx4 v8, s[16:19], s21 offen offset:0  nt lds
M v[48:51],a[64:67],a[168:171],v[48:51]
M v[48:51],a[68:71],a[172:175],v[48:51]
M v[52:55],a[76:79],a[172:175],v[52:55]
s_nop 0
T a[116:117],v3,8192
T a[118:119],v3,9216
M v[52:55],a[72:75],a[168:171],v[52:55]
M v[56:59],a[80:83],a[168:171],v[56:59]
buffer_load_dwordx4 v9, s[16:19], s21 offen offset:1024  nt lds
M v[56:59],a[84:87],a[172:175],v[56:59]
s_waitcnt lgkmcnt(6)
M v[60:63],a[92:95],a[172:175],v[60:63]
M v[60:63],a[88:91],a[168:171],v[60:63]
s_nop 0
T a[120:121],v4,0
T a[122:123],v4,1024
M v[64:67],a[32:35],a[160:163],v[64:67]
R a[168:171],v5,38912
R a[172:175],v6,38912
M v[64:67],a[36:39],a[164:167],v[64:67]
buffer_load_dwordx4 v10, s[16:19], s21 offen offset:2048  nt lds
M v[68:71],a[44:47],a[164:167],v[68:71]
M v[68:71],a[40:43],a[160:163],v[68:71]
M v[72:75],a[48:51],a[160:163],v[72:75]
s_nop 0
T a[124:125],v4,8192
T a[126:127],v4,9216
M v[72:75],a[52:55],a[164:167],v[72:75]
M v[76:79],a[60:63],a[164:167],v[76:79]
buffer_load_dwordx4 v11, s[16:19], s21 offen offset:3072  nt lds
M v[76:79],a[56:59],a[160:163],v[76:79]
SA s21,s21,524160
M v[80:83],a[64:67],a[160:163],v[80:83]
M v[80:83],a[68:71],a[164:167],v[80:83]
M v[84:87],a[76:79],a[164:167],v[84:87]
M v[84:87],a[72:75],a[160:163],v[84:87]
M v[88:91],a[80:83],a[160:163],v[88:91]
M v[88:91],a[84:87],a[164:167],v[88:91]
s_waitcnt lgkmcnt(2)
M v[92:95],a[92:95],a[164:167],v[92:95]
s_waitcnt vmcnt(16) lgkmcnt(0)
M v[92:95],a[88:91],a[160:163],v[92:95]
s_barrier
M v[96:99],a[32:35],a[168:171],v[96:99]
R a[160:163],v5,49152
R a[164:167],v6,49152
M v[96:99],a[36:39],a[172:175],v[96:99]
M v[100:103],a[44:47],a[172:175],v[100:103]
SA m0,s24,32768
T a[128:129],v1,16384
T a[130:131],v1,17408
M v[100:103],a[40:43],a[168:171],v[100:103]
buffer_load_dwordx4 v12, s[48:51], s22 offen offset:0   lds
M v[104:107],a[48:51],a[168:171],v[104:107]
M v[104:107],a[52:55],a[172:175],v[104:107]
M v[108:111],a[60:63],a[172:175],v[108:111]
M v[108:111],a[56:59],a[168:171],v[108:111]
M v[112:115],a[64:67],a[168:171],v[112:115]
M v[112:115],a[68:71],a[172:175],v[112:115]
s_nop 0
T a[132:133],v1,24576
T a[134:135],v1,25600
M v[116:119],a[76:79],a[172:175],v[116:119]
buffer_load_dwordx4 v13, s[48:51], s22 offen offset:1024   lds
M v[116:119],a[72:75],a[168:171],v[116:119]
M v[120:123],a[80:83],a[168:171],v[120:123]
M v[120:123],a[84:87],a[172:175],v[120:123]
s_waitcnt lgkmcnt(4)
M v[124:127],a[92:95],a[172:175],v[124:127]
M v[124:127],a[88:91],a[168:171],v[124:127]
M v[128:131],a[32:35],a[160:163],v[128:131]
R a[168:171],v5,51200
R a[172:175],v6,51200
M v[128:131],a[36:39],a[164:167],v[128:131]
T a[136:137],v2,16384
T a[138:139],v2,17408
M v[132:135],a[44:47],a[164:167],v[132:135]
buffer_load_dwordx4 v14, s[48:51], s22 offen offset:2048   lds
M v[132:135],a[40:43],a[160:163],v[132:135]
M v[136:139],a[48:51],a[160:163],v[136:139]
M v[136:139],a[52:55],a[164:167],v[136:139]
M v[140:143],a[60:63],a[164:167],v[140:143]
M v[140:143],a[56:59],a[160:163],v[140:143]
s_nop 0
T a[140:141],v2,24576
T a[142:143],v2,25600
M v[144:147],a[64:67],a[160:163],v[144:147]
buffer_load_dwordx4 v15, s[48:51], s22 offen offset:3072   lds
M v[144:147],a[68:71],a[164:167],v[144:147]
SA s22,s22,1048576
M v[148:151],a[76:79],a[164:167],v[148:151]
M v[148:151],a[72:75],a[160:163],v[148:151]
M v[152:155],a[80:83],a[160:163],v[152:155]
M v[152:155],a[84:87],a[164:167],v[152:155]
s_waitcnt lgkmcnt(4)
M v[156:159],a[92:95],a[164:167],v[156:159]
SA m0,s23,0
T a[144:145],v3,16384
T a[146:147],v3,17408
M v[156:159],a[88:91],a[160:163],v[156:159]
buffer_load_dwordx4 v8, s[16:19], s21 offen offset:0  nt lds
M v[160:163],a[32:35],a[168:171],v[160:163]
R a[160:163],v5,53248
R a[164:167],v6,53248
M v[160:163],a[36:39],a[172:175],v[160:163]
M v[164:167],a[44:47],a[172:175],v[164:167]
M v[164:167],a[40:43],a[168:171],v[164:167]
M v[168:171],a[48:51],a[168:171],v[168:171]
M v[168:171],a[52:55],a[172:175],v[168:171]
s_nop 0
T a[148:149],v3,24576
T a[150:151],v3,25600
M v[172:175],a[60:63],a[172:175],v[172:175]
buffer_load_dwordx4 v9, s[16:19], s21 offen offset:1024  nt lds
M v[172:175],a[56:59],a[168:171],v[172:175]
M v[176:179],a[64:67],a[168:171],v[176:179]
M v[176:179],a[68:71],a[172:175],v[176:179]
M v[180:183],a[76:79],a[172:175],v[180:183]
M v[180:183],a[72:75],a[168:171],v[180:183]
M v[184:187],a[80:83],a[168:171],v[184:187]
s_nop 0
T a[152:153],v4,16384
T a[154:155],v4,17408
M v[184:187],a[84:87],a[172:175],v[184:187]
s_waitcnt lgkmcnt(4)
buffer_load_dwordx4 v10, s[16:19], s21 offen offset:2048  nt lds
M v[188:191],a[92:95],a[172:175],v[188:191]
M v[188:191],a[88:91],a[168:171],v[188:191]
M v[192:195],a[32:35],a[160:163],v[192:195]
R a[168:171],v5,55296
R a[172:175],v6,55296
M v[192:195],a[36:39],a[164:167],v[192:195]
M v[196:199],a[44:47],a[164:167],v[196:199]
M v[196:199],a[40:43],a[160:163],v[196:199]
s_nop 0
T a[156:157],v4,24576
T a[158:159],v4,25600
M v[200:203],a[48:51],a[160:163],v[200:203]
buffer_load_dwordx4 v11, s[16:19], s21 offen offset:3072  nt lds
M v[200:203],a[52:55],a[164:167],v[200:203]
SA s21,s21,128
M v[204:207],a[60:63],a[164:167],v[204:207]
M v[204:207],a[56:59],a[160:163],v[204:207]
M v[208:211],a[64:67],a[160:163],v[208:211]
M v[208:211],a[68:71],a[164:167],v[208:211]
M v[212:215],a[76:79],a[164:167],v[212:215]
M v[212:215],a[72:75],a[160:163],v[212:215]
M v[216:219],a[80:83],a[160:163],v[216:219]
M v[216:219],a[84:87],a[164:167],v[216:219]
s_waitcnt lgkmcnt(2)
M v[220:223],a[92:95],a[164:167],v[220:223]
s_waitcnt vmcnt(16) lgkmcnt(0)
M v[220:223],a[88:91],a[160:163],v[220:223]
s_barrier
M v[224:227],a[32:35],a[168:171],v[224:227]
R a[160:163],v5,0
R a[164:167],v6,0
M v[224:227],a[36:39],a[172:175],v[224:227]
v_min_u32 v16, 1, v0
v_lshlrev_b32 v16, 29, v16
M v[228:231],a[44:47],a[172:175],v[228:231]
v_or_b32 v16, s39, v16
v_mov_b32 v17, 1
M v[228:231],a[40:43],a[168:171],v[228:231]
buffer_store_dword v17, v16, s[12:15], s38 offen sc1
M v[232:235],a[48:51],a[168:171],v[232:235]
M v[232:235],a[52:55],a[172:175],v[232:235]
M v[236:239],a[60:63],a[172:175],v[236:239]
M v[236:239],a[56:59],a[168:171],v[236:239]
M v[240:243],a[64:67],a[168:171],v[240:243]
M v[240:243],a[68:71],a[172:175],v[240:243]
M v[244:247],a[76:79],a[172:175],v[244:247]
M v[244:247],a[72:75],a[168:171],v[244:247]
M v[248:251],a[80:83],a[168:171],v[248:251]
M v[248:251],a[84:87],a[172:175],v[248:251]
s_waitcnt lgkmcnt(0)
M v[252:255],a[92:95],a[172:175],v[252:255]
M v[252:255],a[88:91],a[168:171],v[252:255]
M a[0:3],a[96:99],a[160:163],a[0:3]
L_w_kv01:
s_cbranch_execz L_w_kv05
R a[168:171],v5,2048
R a[172:175],v6,2048
M a[0:3],a[100:103],a[164:167],a[0:3]
T a[32:33],v1,32768
T a[34:35],v1,33792
M a[4:7],a[108:111],a[164:167],a[4:7]
SA m0,s24,49152
M a[4:7],a[104:107],a[160:163],a[4:7]
buffer_load_dwordx4 v12, s[48:51], s22 offen offset:0   lds
M a[8:11],a[112:115],a[160:163],a[8:11]
M a[8:11],a[116:119],a[164:167],a[8:11]
M a[12:15],a[124:127],a[164:167],a[12:15]
s_nop 0
T a[36:37],v1,40960
T a[38:39],v1,41984
M a[12:15],a[120:123],a[160:163],a[12:15]
M a[16:19],a[128:131],a[160:163],a[16:19]
buffer_load_dwordx4 v13, s[48:51], s22 offen offset:1024   lds
M a[16:19],a[132:135],a[164:167],a[16:19]
M a[20:23],a[140:143],a[164:167],a[20:23]
M a[20:23],a[136:139],a[160:163],a[20:23]
s_nop 0
T a[40:41],v2,32768
T a[42:43],v2,33792
M a[24:27],a[144:147],a[160:163],a[24:27]
M a[24:27],a[148:151],a[164:167],a[24:27]
s_waitcnt lgkmcnt(6)
buffer_load_dwordx4 v14, s[48:51], s22 offen offset:2048   lds
M a[28:31],a[156:159],a[164:167],a[28:31]
M a[28:31],a[152:155],a[160:163],a[28:31]
M v[32:35],a[96:99],a[168:171],v[32:35]
R a[160:163],v5,4096
R a[164:167],v6,4096
M v[32:35],a[100:103],a[172:175],v[32:35]
T a[44:45],v2,40960
T a[46:47],v2,41984
M v[36:39],a[108:111],a[172:175],v[36:39]
buffer_load_dwordx4 v15, s[48:51], s22 offen offset:3072   lds
M v[36:39],a[104:107],a[168:171],v[36:39]
s_sub_u32 s22, s22, 1048448
M v[40:43],a[112:115],a[168:171],v[40:43]
M v[40:43],a[116:119],a[172:175],v[40:43]
s_nop 0
T a[48:49],v3,32768
T a[50:51],v3,33792
M v[44:47],a[124:127],a[172:175],v[44:47]
SA m0,s23,16384
M v[44:47],a[120:123],a[168:171],v[44:47]
buffer_load_dwordx4 v8, s[16:19], s21 offen offset:0  nt lds
M v[48:51],a[128:131],a[168:171],v[48:51]
M v[48:51],a[132:135],a[172:175],v[48:51]
M v[52:55],a[140:143],a[172:175],v[52:55]
s_nop 0
T a[52:53],v3,40960
T a[54:55],v3,41984
M v[52:55],a[136:139],a[168:171],v[52:55]
M v[56:59],a[144:147],a[168:171],v[56:59]
buffer_load_dwordx4 v9, s[16:19], s21 offen offset:1024  nt lds
M v[56:59],a[148:151],a[172:175],v[56:59]
s_waitcnt lgkmcnt(6)
M v[60:63],a[156:159],a[172:175],v[60:63]
M v[60:63],a[152:155],a[168:171],v[60:63]
s_nop 0
T a[56:57],v4,32768
T a[58:59],v4,33792
M v[64:67],a[96:99],a[160:163],v[64:67]
R a[168:171],v5,6144
R a[172:175],v6,6144
M v[64:67],a[100:103],a[164:167],v[64:67]
buffer_load_dwordx4 v10, s[16:19], s21 offen offset:2048  nt lds
M v[68:71],a[108:111],a[164:167],v[68:71]
M v[68:71],a[104:107],a[160:163],v[68:71]
M v[72:75],a[112:115],a[160:163],v[72:75]
s_nop 0
T a[60:61],v4,40960
T a[62:63],v4,41984
M v[72:75],a[116:119],a[164:167],v[72:75]
M v[76:79],a[124:127],a[164:167],v[76:79]
buffer_load_dwordx4 v11, s[16:19], s21 offen offset:3072  nt lds
M v[76:79],a[120:123],a[160:163],v[76:79]
SA s21,s21,524160
M v[80:83],a[128:131],a[160:163],v[80:83]
M v[80:83],a[132:135],a[164:167],v[80:83]
M v[84:87],a[140:143],a[164:167],v[84:87]
M v[84:87],a[136:139],a[160:163],v[84:87]
s_and_b32 s86, s41, 7
M v[88:91],a[144:147],a[160:163],v[88:91]
s_mul_i32 s86, s86, 14
s_lshr_b32 s64, s41, 3
s_mul_i32 s64, s64, 7
M v[88:91],a[148:151],a[164:167],v[88:91]
s_waitcnt lgkmcnt(2)
SA s86,s86,s64
s_min_u32 s64, s31, 6
M v[92:95],a[156:159],a[164:167],v[92:95]
s_waitcnt vmcnt(17) lgkmcnt(0)
SA s86,s86,s64
s_sub_u32 s64, 6, s31
M v[92:95],a[152:155],a[160:163],v[92:95]
s_barrier
M v[96:99],a[96:99],a[168:171],v[96:99]
R a[160:163],v5,16384
R a[164:167],v6,16384
M v[96:99],a[100:103],a[172:175],v[96:99]
s_and_b32 s88, s64, 536870912
s_mul_i32 s87, s20, 7168
M v[100:103],a[108:111],a[172:175],v[100:103]
SA m0,s24,0
T a[64:65],v1,49152
T a[66:67],v1,50176
M v[100:103],a[104:107],a[168:171],v[100:103]
buffer_load_dwordx4 v12, s[48:51], s22 offen offset:0   lds
M v[104:107],a[112:115],a[168:171],v[104:107]
SA s87,s87,131072
M v[104:107],a[116:119],a[172:175],v[104:107]
s_cmp_lt_u32 s20, 2
M v[108:111],a[124:127],a[172:175],v[108:111]
s_cselect_b64 s[72:73], s[80:81], s[82:83]
M v[108:111],a[120:123],a[168:171],v[108:111]
s_mov_b32 s60, s72
M v[112:115],a[128:131],a[168:171],v[112:115]
s_and_b32 s61, s73, 0xffff
M v[112:115],a[132:135],a[172:175],v[112:115]
s_mov_b32 s62, 1605632
T a[68:69],v1,57344
T a[70:71],v1,58368
M v[116:119],a[140:143],a[172:175],v[116:119]
s_mov_b32 s63, 0x20000
buffer_load_dwordx4 v13, s[48:51], s22 offen offset:1024   lds
M v[116:119],a[136:139],a[168:171],v[116:119]
s_mov_b32 s68, s84
M v[120:123],a[144:147],a[168:171],v[120:123]
s_and_b32 s69, s85, 0xffff
s_mov_b32 s70, 1605632
s_mov_b32 s71, 0x20000
M v[120:123],a[148:151],a[172:175],v[120:123]
s_waitcnt lgkmcnt(4)
s_lshl_b32 s89, s86, 5
M v[124:127],a[156:159],a[172:175],v[124:127]
s_and_b32 s64, s20, 1
M v[124:127],a[152:155],a[168:171],v[124:127]
s_mul_i32 s64, s64, 802816
M v[128:131],a[96:99],a[160:163],v[128:131]
SA s89,s89,s64
R a[168:171],v5,18432
R a[172:175],v6,18432
M v[128:131],a[100:103],a[164:167],v[128:131]
T a[72:73],v2,49152
T a[74:75],v2,50176
M v[132:135],a[108:111],a[164:167],v[132:135]
buffer_load_dwordx4 v14, s[48:51], s22 offen offset:2048   lds
M v[132:135],a[104:107],a[160:163],v[132:135]
v_lshrrev_b32 v28, 1, v0
v_mul_u32_u24 v28, 3584, v28
M v[136:139],a[112:115],a[160:163],v[136:139]
v_and_b32 v29, 1, v0
v_lshl_add_u32 v25, v29, 4, v28
M v[136:139],a[116:119],a[164:167],v[136:139]
v_or_b32 v25, s88, v25
M v[140:143],a[124:127],a[164:167],v[140:143]
M v[140:143],a[120:123],a[160:163],v[140:143]
s_nop 0
T a[76:77],v2,57344
T a[78:79],v2,58368
M v[144:147],a[128:131],a[160:163],v[144:147]
buffer_load_dwordx4 v15, s[48:51], s22 offen offset:3072   lds
M v[144:147],a[132:135],a[164:167],v[144:147]
SA s22,s22,1048576
M v[148:151],a[140:143],a[164:167],v[148:151]
M v[148:151],a[136:139],a[160:163],v[148:151]
M v[152:155],a[144:147],a[160:163],v[152:155]
M v[152:155],a[148:151],a[164:167],v[152:155]
s_waitcnt lgkmcnt(4)
M v[156:159],a[156:159],a[164:167],v[156:159]
SA m0,s23,32768
T a[80:81],v3,49152
T a[82:83],v3,50176
M v[156:159],a[152:155],a[160:163],v[156:159]
buffer_load_dwordx4 v8, s[16:19], s21 offen offset:0  nt lds
M v[160:163],a[96:99],a[168:171],v[160:163]
R a[160:163],v5,20480
R a[164:167],v6,20480
M v[160:163],a[100:103],a[172:175],v[160:163]
M v[164:167],a[108:111],a[172:175],v[164:167]
M v[164:167],a[104:107],a[168:171],v[164:167]
M v[168:171],a[112:115],a[168:171],v[168:171]
M v[168:171],a[116:119],a[172:175],v[168:171]
s_nop 0
T a[84:85],v3,57344
T a[86:87],v3,58368
M v[172:175],a[124:127],a[172:175],v[172:175]
buffer_load_dwordx4 v9, s[16:19], s21 offen offset:1024  nt lds
M v[172:175],a[120:123],a[168:171],v[172:175]
M v[176:179],a[128:131],a[168:171],v[176:179]
M v[176:179],a[132:135],a[172:175],v[176:179]
M v[180:183],a[140:143],a[172:175],v[180:183]
M v[180:183],a[136:139],a[168:171],v[180:183]
M v[184:187],a[144:147],a[168:171],v[184:187]
s_nop 0
T a[88:89],v4,49152
T a[90:91],v4,50176
M v[184:187],a[148:151],a[172:175],v[184:187]
s_waitcnt lgkmcnt(4)
buffer_load_dwordx4 v10, s[16:19], s21 offen offset:2048  nt lds
M v[188:191],a[156:159],a[172:175],v[188:191]
M v[188:191],a[152:155],a[168:171],v[188:191]
M v[192:195],a[96:99],a[160:163],v[192:195]
R a[168:171],v5,22528
R a[172:175],v6,22528
M v[192:195],a[100:103],a[164:167],v[192:195]
M v[196:199],a[108:111],a[164:167],v[196:199]
M v[196:199],a[104:107],a[160:163],v[196:199]
s_nop 0
T a[92:93],v4,57344
T a[94:95],v4,58368
M v[200:203],a[112:115],a[160:163],v[200:203]
buffer_load_dwordx4 v11, s[16:19], s21 offen offset:3072  nt lds
M v[200:203],a[116:119],a[164:167],v[200:203]
SA s21,s21,128
M v[204:207],a[124:127],a[164:167],v[204:207]
M v[204:207],a[120:123],a[160:163],v[204:207]
M v[208:211],a[128:131],a[160:163],v[208:211]
M v[208:211],a[132:135],a[164:167],v[208:211]
M v[212:215],a[140:143],a[164:167],v[212:215]
M v[212:215],a[136:139],a[160:163],v[212:215]
M v[216:219],a[144:147],a[160:163],v[216:219]
M v[216:219],a[148:151],a[164:167],v[216:219]
s_waitcnt lgkmcnt(2)
M v[220:223],a[156:159],a[164:167],v[220:223]
s_waitcnt vmcnt(17) lgkmcnt(0)
M v[220:223],a[152:155],a[160:163],v[220:223]
s_barrier
M v[224:227],a[96:99],a[168:171],v[224:227]
R a[160:163],v5,32768
R a[164:167],v6,32768
M v[224:227],a[100:103],a[172:175],v[224:227]
M v[228:231],a[108:111],a[172:175],v[228:231]
M v[228:231],a[104:107],a[168:171],v[228:231]
M v[232:235],a[112:115],a[168:171],v[232:235]
M v[232:235],a[116:119],a[172:175],v[232:235]
M v[236:239],a[124:127],a[172:175],v[236:239]
M v[236:239],a[120:123],a[168:171],v[236:239]
M v[240:243],a[128:131],a[168:171],v[240:243]
M v[240:243],a[132:135],a[172:175],v[240:243]
M v[244:247],a[140:143],a[172:175],v[244:247]
M v[244:247],a[136:139],a[168:171],v[244:247]
M v[248:251],a[144:147],a[168:171],v[248:251]
M v[248:251],a[148:151],a[172:175],v[248:251]
s_waitcnt lgkmcnt(0)
M v[252:255],a[156:159],a[172:175],v[252:255]
M v[252:255],a[152:155],a[168:171],v[252:255]
M a[0:3],a[32:35],a[160:163],a[0:3]
R a[168:171],v5,34816
R a[172:175],v6,34816
M a[0:3],a[36:39],a[164:167],a[0:3]
T a[96:97],v1,0
T a[98:99],v1,1024
M a[4:7],a[44:47],a[164:167],a[4:7]
SA m0,s24,16384
M a[4:7],a[40:43],a[160:163],a[4:7]
buffer_load_dwordx4 v12, s[48:51], s22 offen offset:0   lds
M a[8:11],a[48:51],a[160:163],a[8:11]
M a[8:11],a[52:55],a[164:167],a[8:11]
M a[12:15],a[60:63],a[164:167],a[12:15]
s_nop 0
T a[100:101],v1,8192
T a[102:103],v1,9216
M a[12:15],a[56:59],a[160:163],a[12:15]
M a[16:19],a[64:67],a[160:163],a[16:19]
buffer_load_dwordx4 v13, s[48:51], s22 offen offset:1024   lds
M a[16:19],a[68:71],a[164:167],a[16:19]
M a[20:23],a[76:79],a[164:167],a[20:23]
M a[20:23],a[72:75],a[160:163],a[20:23]
s_nop 0
T a[104:105],v2,0
T a[106:107],v2,1024
M a[24:27],a[80:83],a[160:163],a[24:27]
M a[24:27],a[84:87],a[164:167],a[24:27]
s_waitcnt lgkmcnt(6)
buffer_load_dwordx4 v14, s[48:51], s22 offen offset:2048   lds
M a[28:31],a[92:95],a[164:167],a[28:31]
M a[28:31],a[88:91],a[160:163],a[28:31]
M v[32:35],a[32:35],a[168:171],v[32:35]
R a[160:163],v5,36864
R a[164:167],v6,36864
M v[32:35],a[36:39],a[172:175],v[32:35]
T a[108:109],v2,8192
T a[110:111],v2,9216
M v[36:39],a[44:47],a[172:175],v[36:39]
buffer_load_dwordx4 v15, s[48:51], s22 offen offset:3072   lds
M v[36:39],a[40:43],a[168:171],v[36:39]
s_sub_u32 s22, s22, 1048448
M v[40:43],a[48:51],a[168:171],v[40:43]
M v[40:43],a[52:55],a[172:175],v[40:43]
s_nop 0
T a[112:113],v3,0
T a[114:115],v3,1024
M v[44:47],a[60:63],a[172:175],v[44:47]
SA m0,s23,49152
M v[44:47],a[56:59],a[168:171],v[44:47]
buffer_load_dwordx4 v8, s[16:19], s21 offen offset:0  nt lds
M v[48:51],a[64:67],a[168:171],v[48:51]
M v[48:51],a[68:71],a[172:175],v[48:51]
M v[52:55],a[76:79],a[172:175],v[52:55]
s_nop 0
T a[116:117],v3,8192
T a[118:119],v3,9216
M v[52:55],a[72:75],a[168:171],v[52:55]
M v[56:59],a[80:83],a[168:171],v[56:59]
buffer_load_dwordx4 v9, s[16:19], s21 offen offset:1024  nt lds
M v[56:59],a[84:87],a[172:175],v[56:59]
s_waitcnt lgkmcnt(6)
M v[60:63],a[92:95],a[172:175],v[60:63]
M v[60:63],a[88:91],a[168:171],v[60:63]
s_nop 0
T a[120:121],v4,0
T a[122:123],v4,1024
M v[64:67],a[32:35],a[160:163],v[64:67]
R a[168:171],v5,38912
R a[172:175],v6,38912
M v[64:67],a[36:39],a[164:167],v[64:67]
buffer_load_dwordx4 v10, s[16:19], s21 offen offset:2048  nt lds
M v[68:71],a[44:47],a[164:167],v[68:71]
M v[68:71],a[40:43],a[160:163],v[68:71]
M v[72:75],a[48:51],a[160:163],v[72:75]
s_nop 0
T a[124:125],v4,8192
T a[126:127],v4,9216
M v[72:75],a[52:55],a[164:167],v[72:75]
M v[76:79],a[60:63],a[164:167],v[76:79]
buffer_load_dwordx4 v11, s[16:19], s21 offen offset:3072  nt lds
M v[76:79],a[56:59],a[160:163],v[76:79]
SA s21,s21,524160
M v[80:83],a[64:67],a[160:163],v[80:83]
M v[80:83],a[68:71],a[164:167],v[80:83]
M v[84:87],a[76:79],a[164:167],v[84:87]
M v[84:87],a[72:75],a[160:163],v[84:87]
M v[88:91],a[80:83],a[160:163],v[88:91]
M v[88:91],a[84:87],a[164:167],v[88:91]
s_waitcnt lgkmcnt(2)
M v[92:95],a[92:95],a[164:167],v[92:95]
s_waitcnt vmcnt(16) lgkmcnt(0)
M v[92:95],a[88:91],a[160:163],v[92:95]
s_barrier
M v[96:99],a[32:35],a[168:171],v[96:99]
R a[160:163],v5,49152
R a[164:167],v6,49152
M v[96:99],a[36:39],a[172:175],v[96:99]
M v[100:103],a[44:47],a[172:175],v[100:103]
SA m0,s24,32768
T a[128:129],v1,16384
T a[130:131],v1,17408
M v[100:103],a[40:43],a[168:171],v[100:103]
buffer_load_dwordx4 v12, s[48:51], s22 offen offset:0   lds
M v[104:107],a[48:51],a[168:171],v[104:107]
v_min_u32 v16, 40, v0
v_lshlrev_b32 v16, 2, v16
M v[104:107],a[52:55],a[172:175],v[104:107]
buffer_load_dword v17, v16, s[12:15], 0 offen sc1
M v[108:111],a[60:63],a[172:175],v[108:111]
M v[108:111],a[56:59],a[168:171],v[108:111]
M v[112:115],a[64:67],a[168:171],v[112:115]
buffer_load_dwordx4 v13, s[48:51], s22 offen offset:1024   lds
M v[112:115],a[68:71],a[172:175],v[112:115]
s_nop 0
T a[132:133],v1,24576
T a[134:135],v1,25600
M v[116:119],a[76:79],a[172:175],v[116:119]
M v[116:119],a[72:75],a[168:171],v[116:119]
M v[120:123],a[80:83],a[168:171],v[120:123]
M v[120:123],a[84:87],a[172:175],v[120:123]
s_waitcnt lgkmcnt(4)
M v[124:127],a[92:95],a[172:175],v[124:127]
buffer_load_dwordx4 v14, s[48:51], s22 offen offset:2048   lds
M v[124:127],a[88:91],a[168:171],v[124:127]
M v[128:131],a[32:35],a[160:163],v[128:131]
R a[168:171],v5,51200
R a[172:175],v6,51200
M v[128:131],a[36:39],a[164:167],v[128:131]
T a[136:137],v2,16384
T a[138:139],v2,17408
M v[132:135],a[44:47],a[164:167],v[132:135]
M v[132:135],a[40:43],a[160:163],v[132:135]
M v[136:139],a[48:51],a[160:163],v[136:139]
buffer_load_dwordx4 v15, s[48:51], s22 offen offset:3072   lds
M v[136:139],a[52:55],a[164:167],v[136:139]
SA s22,s22,1048576
M v[140:143],a[60:63],a[164:167],v[140:143]
M v[140:143],a[56:59],a[160:163],v[140:143]
s_nop 0
T a[140:141],v2,24576
T a[142:143],v2,25600
M v[144:147],a[64:67],a[160:163],v[144:147]
SA m0,s23,0
M v[144:147],a[68:71],a[164:167],v[144:147]
buffer_load_dwordx4 v8, s[16:19], s21 offen offset:0  nt lds
M v[148:151],a[76:79],a[164:167],v[148:151]
M v[148:151],a[72:75],a[160:163],v[148:151]
M v[152:155],a[80:83],a[160:163],v[152:155]
M v[152:155],a[84:87],a[164:167],v[152:155]
s_waitcnt lgkmcnt(4)
M v[156:159],a[92:95],a[164:167],v[156:159]
s_nop 0
T a[144:145],v3,16384
T a[146:147],v3,17408
M v[156:159],a[88:91],a[160:163],v[156:159]
buffer_load_dwordx4 v9, s[16:19], s21 offen offset:1024  nt lds
M v[160:163],a[32:35],a[168:171],v[160:163]
R a[160:163],v5,53248
R a[164:167],v6,53248
M v[160:163],a[36:39],a[172:175],v[160:163]
M v[164:167],a[44:47],a[172:175],v[164:167]
M v[164:167],a[40:43],a[168:171],v[164:167]
M v[168:171],a[48:51],a[168:171],v[168:171]
M v[168:171],a[52:55],a[172:175],v[168:171]
s_nop 0
T a[148:149],v3,24576
T a[150:151],v3,25600
M v[172:175],a[60:63],a[172:175],v[172:175]
buffer_load_dwordx4 v10, s[16:19], s21 offen offset:2048  nt lds
M v[172:175],a[56:59],a[168:171],v[172:175]
M v[176:179],a[64:67],a[168:171],v[176:179]
M v[176:179],a[68:71],a[172:175],v[176:179]
M v[180:183],a[76:79],a[172:175],v[180:183]
buffer_load_dwordx4 v11, s[16:19], s21 offen offset:3072  nt lds
M v[180:183],a[72:75],a[168:171],v[180:183]
SA s21,s21,128
M v[184:187],a[80:83],a[168:171],v[184:187]
s_nop 0
T a[152:153],v4,16384
T a[154:155],v4,17408
M v[184:187],a[84:87],a[172:175],v[184:187]
s_waitcnt lgkmcnt(4)
M v[188:191],a[92:95],a[172:175],v[188:191]
M v[188:191],a[88:91],a[168:171],v[188:191]
SA m0,s87,0
M v[192:195],a[32:35],a[160:163],v[192:195]
R a[168:171],v5,55296
R a[172:175],v6,55296
M v[192:195],a[36:39],a[164:167],v[192:195]
buffer_load_dwordx4 v25, s[60:63], s89 offen offset:0 nt lds
M v[196:199],a[44:47],a[164:167],v[196:199]
SA s89,s89,114688
M v[196:199],a[40:43],a[160:163],v[196:199]
s_nop 0
T a[156:157],v4,24576
T a[158:159],v4,25600
M v[200:203],a[48:51],a[160:163],v[200:203]
M v[200:203],a[52:55],a[164:167],v[200:203]
SA m0,s87,1024
M v[204:207],a[60:63],a[164:167],v[204:207]
buffer_load_dwordx4 v25, s[60:63], s89 offen offset:0 nt lds
M v[204:207],a[56:59],a[160:163],v[204:207]
SA s89,s89,114688
M v[208:211],a[64:67],a[160:163],v[208:211]
M v[208:211],a[68:71],a[164:167],v[208:211]
M v[212:215],a[76:79],a[164:167],v[212:215]
M v[212:215],a[72:75],a[160:163],v[212:215]
M v[216:219],a[80:83],a[160:163],v[216:219]
M v[216:219],a[84:87],a[164:167],v[216:219]
s_waitcnt lgkmcnt(2)
M v[220:223],a[92:95],a[164:167],v[220:223]
s_waitcnt vmcnt(19) lgkmcnt(0)
M v[220:223],a[88:91],a[160:163],v[220:223]
s_barrier
M v[224:227],a[32:35],a[168:171],v[224:227]
R a[160:163],v5,0
R a[164:167],v6,0
M v[224:227],a[36:39],a[172:175],v[224:227]
M v[228:231],a[44:47],a[172:175],v[228:231]
M v[228:231],a[40:43],a[168:171],v[228:231]
M v[232:235],a[48:51],a[168:171],v[232:235]
M v[232:235],a[52:55],a[172:175],v[232:235]
M v[236:239],a[60:63],a[172:175],v[236:239]
M v[236:239],a[56:59],a[168:171],v[236:239]
M v[240:243],a[64:67],a[168:171],v[240:243]
M v[240:243],a[68:71],a[172:175],v[240:243]
M v[244:247],a[76:79],a[172:175],v[244:247]
M v[244:247],a[72:75],a[168:171],v[244:247]
M v[248:251],a[80:83],a[168:171],v[248:251]
M v[248:251],a[84:87],a[172:175],v[248:251]
s_waitcnt lgkmcnt(0)
M v[252:255],a[92:95],a[172:175],v[252:255]
M v[252:255],a[88:91],a[168:171],v[252:255]
M a[0:3],a[96:99],a[160:163],a[0:3]
R a[168:171],v5,2048
R a[172:175],v6,2048
M a[0:3],a[100:103],a[164:167],a[0:3]
T a[32:33],v1,32768
T a[34:35],v1,33792
M a[4:7],a[108:111],a[164:167],a[4:7]
SA m0,s24,49152
M a[4:7],a[104:107],a[160:163],a[4:7]
buffer_load_dwordx4 v12, s[48:51], s22 offen offset:0   lds
M a[8:11],a[112:115],a[160:163],a[8:11]
M a[8:11],a[116:119],a[164:167],a[8:11]
M a[12:15],a[124:127],a[164:167],a[12:15]
s_nop 0
T a[36:37],v1,40960
T a[38:39],v1,41984
M a[12:15],a[120:123],a[160:163],a[12:15]
M a[16:19],a[128:131],a[160:163],a[16:19]
buffer_load_dwordx4 v13, s[48:51], s22 offen offset:1024   lds
M a[16:19],a[132:135],a[164:167],a[16:19]
M a[20:23],a[140:143],a[164:167],a[20:23]
M a[20:23],a[136:139],a[160:163],a[20:23]
s_nop 0
T a[40:41],v2,32768
T a[42:43],v2,33792
M a[24:27],a[144:147],a[160:163],a[24:27]
M a[24:27],a[148:151],a[164:167],a[24:27]
s_waitcnt lgkmcnt(6)
buffer_load_dwordx4 v14, s[48:51], s22 offen offset:2048   lds
M a[28:31],a[156:159],a[164:167],a[28:31]
M a[28:31],a[152:155],a[160:163],a[28:31]
M v[32:35],a[96:99],a[168:171],v[32:35]
R a[160:163],v5,4096
R a[164:167],v6,4096
M v[32:35],a[100:103],a[172:175],v[32:35]
T a[44:45],v2,40960
T a[46:47],v2,41984
M v[36:39],a[108:111],a[172:175],v[36:39]
buffer_load_dwordx4 v15, s[48:51], s22 offen offset:3072   lds
M v[36:39],a[104:107],a[168:171],v[36:39]
s_sub_u32 s22, s22, 1048448
M v[40:43],a[112:115],a[168:171],v[40:43]
M v[40:43],a[116:119],a[172:175],v[40:43]
s_nop 0
T a[48:49],v3,32768
T a[50:51],v3,33792
M v[44:47],a[124:127],a[172:175],v[44:47]
SA m0,s23,16384
M v[44:47],a[120:123],a[168:171],v[44:47]
buffer_load_dwordx4 v8, s[16:19], s21 offen offset:0  nt lds
M v[48:51],a[128:131],a[168:171],v[48:51]
M v[48:51],a[132:135],a[172:175],v[48:51]
M v[52:55],a[140:143],a[172:175],v[52:55]
s_nop 0
T a[52:53],v3,40960
T a[54:55],v3,41984
M v[52:55],a[136:139],a[168:171],v[52:55]
M v[56:59],a[144:147],a[168:171],v[56:59]
buffer_load_dwordx4 v9, s[16:19], s21 offen offset:1024  nt lds
M v[56:59],a[148:151],a[172:175],v[56:59]
s_waitcnt lgkmcnt(6)
M v[60:63],a[156:159],a[172:175],v[60:63]
M v[60:63],a[152:155],a[168:171],v[60:63]
s_nop 0
T a[56:57],v4,32768
L_w_kv02:
s_cbranch_execz L_w_kv06
T a[58:59],v4,33792
M v[64:67],a[96:99],a[160:163],v[64:67]
R a[168:171],v5,6144
R a[172:175],v6,6144
M v[64:67],a[100:103],a[164:167],v[64:67]
buffer_load_dwordx4 v10, s[16:19], s21 offen offset:2048  nt lds
M v[68:71],a[108:111],a[164:167],v[68:71]
M v[68:71],a[104:107],a[160:163],v[68:71]
M v[72:75],a[112:115],a[160:163],v[72:75]
s_nop 0
T a[60:61],v4,40960
T a[62:63],v4,41984
M v[72:75],a[116:119],a[164:167],v[72:75]
M v[76:79],a[124:127],a[164:167],v[76:79]
buffer_load_dwordx4 v11, s[16:19], s21 offen offset:3072  nt lds
M v[76:79],a[120:123],a[160:163],v[76:79]
SA s21,s21,524160
M v[80:83],a[128:131],a[160:163],v[80:83]
M v[80:83],a[132:135],a[164:167],v[80:83]
M v[84:87],a[140:143],a[164:167],v[84:87]
M v[84:87],a[136:139],a[160:163],v[84:87]
M v[88:91],a[144:147],a[160:163],v[88:91]
M v[88:91],a[148:151],a[164:167],v[88:91]
s_waitcnt lgkmcnt(2)
M v[92:95],a[156:159],a[164:167],v[92:95]
s_waitcnt vmcnt(19) lgkmcnt(0)
M v[92:95],a[152:155],a[160:163],v[92:95]
s_barrier
M v[96:99],a[96:99],a[168:171],v[96:99]
R a[160:163],v5,16384
R a[164:167],v6,16384
M v[96:99],a[100:103],a[172:175],v[96:99]
M v[100:103],a[108:111],a[172:175],v[100:103]
SA m0,s24,0
T a[64:65],v1,49152
T a[66:67],v1,50176
M v[100:103],a[104:107],a[168:171],v[100:103]
buffer_load_dwordx4 v12, s[48:51], s22 offen offset:0   lds
M v[104:107],a[112:115],a[168:171],v[104:107]
M v[104:107],a[116:119],a[172:175],v[104:107]
M v[108:111],a[124:127],a[172:175],v[108:111]
M v[108:111],a[120:123],a[168:171],v[108:111]
M v[112:115],a[128:131],a[168:171],v[112:115]
buffer_load_dwordx4 v13, s[48:51], s22 offen offset:1024   lds
M v[112:115],a[132:135],a[172:175],v[112:115]
s_nop 0
T a[68:69],v1,57344
T a[70:71],v1,58368
M v[116:119],a[140:143],a[172:175],v[116:119]
M v[116:119],a[136:139],a[168:171],v[116:119]
M v[120:123],a[144:147],a[168:171],v[120:123]
M v[120:123],a[148:151],a[172:175],v[120:123]
s_waitcnt lgkmcnt(4)
M v[124:127],a[156:159],a[172:175],v[124:127]
buffer_load_dwordx4 v14, s[48:51], s22 offen offset:2048   lds
M v[124:127],a[152:155],a[168:171],v[124:127]
M v[128:131],a[96:99],a[160:163],v[128:131]
R a[168:171],v5,18432
R a[172:175],v6,18432
M v[128:131],a[100:103],a[164:167],v[128:131]
T a[72:73],v2,49152
T a[74:75],v2,50176
M v[132:135],a[108:111],a[164:167],v[132:135]
M v[132:135],a[104:107],a[160:163],v[132:135]
M v[136:139],a[112:115],a[160:163],v[136:139]
buffer_load_dwordx4 v15, s[48:51], s22 offen offset:3072   lds
M v[136:139],a[116:119],a[164:167],v[136:139]
SA s22,s22,1048576
M v[140:143],a[124:127],a[164:167],v[140:143]
M v[140:143],a[120:123],a[160:163],v[140:143]
s_nop 0
T a[76:77],v2,57344
T a[78:79],v2,58368
M v[144:147],a[128:131],a[160:163],v[144:147]
SA m0,s23,32768
M v[144:147],a[132:135],a[164:167],v[144:147]
buffer_load_dwordx4 v8, s[16:19], s21 offen offset:0  nt lds
M v[148:151],a[140:143],a[164:167],v[148:151]
M v[148:151],a[136:139],a[160:163],v[148:151]
M v[152:155],a[144:147],a[160:163],v[152:155]
M v[152:155],a[148:151],a[164:167],v[152:155]
s_waitcnt lgkmcnt(4)
M v[156:159],a[156:159],a[164:167],v[156:159]
s_nop 0
T a[80:81],v3,49152
T a[82:83],v3,50176
M v[156:159],a[152:155],a[160:163],v[156:159]
buffer_load_dwordx4 v9, s[16:19], s21 offen offset:1024  nt lds
M v[160:163],a[96:99],a[168:171],v[160:163]
R a[160:163],v5,20480
R a[164:167],v6,20480
M v[160:163],a[100:103],a[172:175],v[160:163]
M v[164:167],a[108:111],a[172:175],v[164:167]
M v[164:167],a[104:107],a[168:171],v[164:167]
M v[168:171],a[112:115],a[168:171],v[168:171]
M v[168:171],a[116:119],a[172:175],v[168:171]
s_nop 0
T a[84:85],v3,57344
T a[86:87],v3,58368
M v[172:175],a[124:127],a[172:175],v[172:175]
buffer_load_dwordx4 v10, s[16:19], s21 offen offset:2048  nt lds
M v[172:175],a[120:123],a[168:171],v[172:175]
M v[176:179],a[128:131],a[168:171],v[176:179]
M v[176:179],a[132:135],a[172:175],v[176:179]
M v[180:183],a[140:143],a[172:175],v[180:183]
buffer_load_dwordx4 v11, s[16:19], s21 offen offset:3072  nt lds
M v[180:183],a[136:139],a[168:171],v[180:183]
SA s21,s21,128
M v[184:187],a[144:147],a[168:171],v[184:187]
s_nop 0
T a[88:89],v4,49152
T a[90:91],v4,50176
M v[184:187],a[148:151],a[172:175],v[184:187]
s_waitcnt lgkmcnt(4)
M v[188:191],a[156:159],a[172:175],v[188:191]
M v[188:191],a[152:155],a[168:171],v[188:191]
SA m0,s87,2048
M v[192:195],a[96:99],a[160:163],v[192:195]
R a[168:171],v5,22528
R a[172:175],v6,22528
M v[192:195],a[100:103],a[164:167],v[192:195]
buffer_load_dwordx4 v25, s[60:63], s89 offen offset:0 nt lds
M v[196:199],a[108:111],a[164:167],v[196:199]
SA s89,s89,114688
M v[196:199],a[104:107],a[160:163],v[196:199]
s_nop 0
T a[92:93],v4,57344
T a[94:95],v4,58368
M v[200:203],a[112:115],a[160:163],v[200:203]
M v[200:203],a[116:119],a[164:167],v[200:203]
SA m0,s87,3072
M v[204:207],a[124:127],a[164:167],v[204:207]
buffer_load_dwordx4 v25, s[60:63], s89 offen offset:0 nt lds
M v[204:207],a[120:123],a[160:163],v[204:207]
SA s89,s89,114688
M v[208:211],a[128:131],a[160:163],v[208:211]
M v[208:211],a[132:135],a[164:167],v[208:211]
M v[212:215],a[140:143],a[164:167],v[212:215]
M v[212:215],a[136:139],a[160:163],v[212:215]
M v[216:219],a[144:147],a[160:163],v[216:219]
M v[216:219],a[148:151],a[164:167],v[216:219]
s_waitcnt lgkmcnt(2)
M v[220:223],a[156:159],a[164:167],v[220:223]
s_waitcnt vmcnt(20) lgkmcnt(0)
M v[220:223],a[152:155],a[160:163],v[220:223]
s_barrier
M v[224:227],a[96:99],a[168:171],v[224:227]
R a[160:163],v5,32768
R a[164:167],v6,32768
M v[224:227],a[100:103],a[172:175],v[224:227]
v_cmp_ne_u32 vcc, 1, v17
M v[228:231],a[108:111],a[172:175],v[228:231]
s_nop 0
M v[228:231],a[104:107],a[168:171],v[228:231]
s_cbranch_vccnz L_zs0
L_zr0:
M v[232:235],a[112:115],a[168:171],v[232:235]
M v[232:235],a[116:119],a[172:175],v[232:235]
M v[236:239],a[124:127],a[172:175],v[236:239]
M v[236:239],a[120:123],a[168:171],v[236:239]
M v[240:243],a[128:131],a[168:171],v[240:243]
M v[240:243],a[132:135],a[172:175],v[240:243]
M v[244:247],a[140:143],a[172:175],v[244:247]
M v[244:247],a[136:139],a[168:171],v[244:247]
M v[248:251],a[144:147],a[168:171],v[248:251]
M v[248:251],a[148:151],a[172:175],v[248:251]
s_waitcnt lgkmcnt(0)
M v[252:255],a[156:159],a[172:175],v[252:255]
M v[252:255],a[152:155],a[168:171],v[252:255]
M a[0:3],a[32:35],a[160:163],a[0:3]
R a[168:171],v5,34816
R a[172:175],v6,34816
M a[0:3],a[36:39],a[164:167],a[0:3]
T a[96:97],v1,0
T a[98:99],v1,1024
M a[4:7],a[44:47],a[164:167],a[4:7]
SA m0,s24,16384
M a[4:7],a[40:43],a[160:163],a[4:7]
buffer_load_dwordx4 v12, s[48:51], s22 offen offset:0   lds
M a[8:11],a[48:51],a[160:163],a[8:11]
M a[8:11],a[52:55],a[164:167],a[8:11]
s_mul_i32 s64, s41, 229376
M a[12:15],a[60:63],a[164:167],a[12:15]
SA s72,s90,s64
T a[100:101],v1,8192
T a[102:103],v1,9216
M a[12:15],a[56:59],a[160:163],a[12:15]
s_addc_u32 s73, s91, 0
M a[16:19],a[64:67],a[160:163],a[16:19]
s_sub_u32 s75, 3670016, s64
buffer_load_dwordx4 v13, s[48:51], s22 offen offset:1024   lds
M a[16:19],a[68:71],a[164:167],a[16:19]
s_mov_b32 s12, s72
M a[20:23],a[76:79],a[164:167],a[20:23]
s_and_b32 s13, s73, 0xffff
M a[20:23],a[72:75],a[160:163],a[20:23]
s_mov_b32 s14, s75
T a[104:105],v2,0
T a[106:107],v2,1024
M a[24:27],a[80:83],a[160:163],a[24:27]
s_mov_b32 s15, 0x20000
M a[24:27],a[84:87],a[164:167],a[24:27]
s_waitcnt lgkmcnt(6)
buffer_load_dwordx4 v14, s[48:51], s22 offen offset:2048   lds
M a[28:31],a[92:95],a[164:167],a[28:31]
M a[28:31],a[88:91],a[160:163],a[28:31]
M v[32:35],a[32:35],a[168:171],v[32:35]
R a[160:163],v5,36864
R a[164:167],v6,36864
M v[32:35],a[36:39],a[172:175],v[32:35]
T a[108:109],v2,8192
T a[110:111],v2,9216
M v[36:39],a[44:47],a[172:175],v[36:39]
buffer_load_dwordx4 v15, s[48:51], s22 offen offset:3072   lds
M v[36:39],a[40:43],a[168:171],v[36:39]
s_sub_u32 s22, s22, 1048448
M v[40:43],a[48:51],a[168:171],v[40:43]
M v[40:43],a[52:55],a[172:175],v[40:43]
s_nop 0
T a[112:113],v3,0
T a[114:115],v3,1024
M v[44:47],a[60:63],a[172:175],v[44:47]
SA m0,s23,49152
M v[44:47],a[56:59],a[168:171],v[44:47]
buffer_load_dwordx4 v8, s[16:19], s21 offen offset:0  nt lds
M v[48:51],a[64:67],a[168:171],v[48:51]
M v[48:51],a[68:71],a[172:175],v[48:51]
M v[52:55],a[76:79],a[172:175],v[52:55]
s_nop 0
T a[116:117],v3,8192
T a[118:119],v3,9216
M v[52:55],a[72:75],a[168:171],v[52:55]
M v[56:59],a[80:83],a[168:171],v[56:59]
buffer_load_dwordx4 v9, s[16:19], s21 offen offset:1024  nt lds
M v[56:59],a[84:87],a[172:175],v[56:59]
s_waitcnt lgkmcnt(6)
M v[60:63],a[92:95],a[172:175],v[60:63]
M v[60:63],a[88:91],a[168:171],v[60:63]
s_nop 0
T a[120:121],v4,0
T a[122:123],v4,1024
M v[64:67],a[32:35],a[160:163],v[64:67]
R a[168:171],v5,38912
R a[172:175],v6,38912
M v[64:67],a[36:39],a[164:167],v[64:67]
buffer_load_dwordx4 v10, s[16:19], s21 offen offset:2048  nt lds
M v[68:71],a[44:47],a[164:167],v[68:71]
M v[68:71],a[40:43],a[160:163],v[68:71]
M v[72:75],a[48:51],a[160:163],v[72:75]
s_nop 0
T a[124:125],v4,8192
T a[126:127],v4,9216
M v[72:75],a[52:55],a[164:167],v[72:75]
M v[76:79],a[60:63],a[164:167],v[76:79]
buffer_load_dwordx4 v11, s[16:19], s21 offen offset:3072  nt lds
M v[76:79],a[56:59],a[160:163],v[76:79]
SA s21,s21,524160
M v[80:83],a[64:67],a[160:163],v[80:83]
M v[80:83],a[68:71],a[164:167],v[80:83]
M v[84:87],a[76:79],a[164:167],v[84:87]
M v[84:87],a[72:75],a[160:163],v[84:87]
M v[88:91],a[80:83],a[160:163],v[88:91]
M v[88:91],a[84:87],a[164:167],v[88:91]
s_waitcnt lgkmcnt(2)
M v[92:95],a[92:95],a[164:167],v[92:95]
s_waitcnt vmcnt(18) lgkmcnt(0)
M v[92:95],a[88:91],a[160:163],v[92:95]
s_barrier
M v[96:99],a[32:35],a[168:171],v[96:99]
R a[160:163],v5,49152
R a[164:167],v6,49152
M v[96:99],a[36:39],a[172:175],v[96:99]
M v[100:103],a[44:47],a[172:175],v[100:103]
SA m0,s24,32768
T a[128:129],v1,16384
T a[130:131],v1,17408
M v[100:103],a[40:43],a[168:171],v[100:103]
buffer_load_dwordx4 v12, s[48:51], s22 offen offset:0   lds
M v[104:107],a[48:51],a[168:171],v[104:107]
M v[104:107],a[52:55],a[172:175],v[104:107]
M v[108:111],a[60:63],a[172:175],v[108:111]
M v[108:111],a[56:59],a[168:171],v[108:111]
M v[112:115],a[64:67],a[168:171],v[112:115]
buffer_load_dwordx4 v13, s[48:51], s22 offen offset:1024   lds
M v[112:115],a[68:71],a[172:175],v[112:115]
s_nop 0
T a[132:133],v1,24576
T a[134:135],v1,25600
M v[116:119],a[76:79],a[172:175],v[116:119]
M v[116:119],a[72:75],a[168:171],v[116:119]
M v[120:123],a[80:83],a[168:171],v[120:123]
M v[120:123],a[84:87],a[172:175],v[120:123]
s_waitcnt lgkmcnt(4)
M v[124:127],a[92:95],a[172:175],v[124:127]
buffer_load_dwordx4 v14, s[48:51], s22 offen offset:2048   lds
M v[124:127],a[88:91],a[168:171],v[124:127]
M v[128:131],a[32:35],a[160:163],v[128:131]
R a[168:171],v5,51200
R a[172:175],v6,51200
M v[128:131],a[36:39],a[164:167],v[128:131]
T a[136:137],v2,16384
T a[138:139],v2,17408
M v[132:135],a[44:47],a[164:167],v[132:135]
M v[132:135],a[40:43],a[160:163],v[132:135]
M v[136:139],a[48:51],a[160:163],v[136:139]
buffer_load_dwordx4 v15, s[48:51], s22 offen offset:3072   lds
M v[136:139],a[52:55],a[164:167],v[136:139]
SA s22,s22,1048576
M v[140:143],a[60:63],a[164:167],v[140:143]
M v[140:143],a[56:59],a[160:163],v[140:143]
s_nop 0
T a[140:141],v2,24576
T a[142:143],v2,25600
M v[144:147],a[64:67],a[160:163],v[144:147]
SA m0,s23,0
M v[144:147],a[68:71],a[164:167],v[144:147]
buffer_load_dwordx4 v8, s[16:19], s21 offen offset:0  nt lds
M v[148:151],a[76:79],a[164:167],v[148:151]
M v[148:151],a[72:75],a[160:163],v[148:151]
M v[152:155],a[80:83],a[160:163],v[152:155]
M v[152:155],a[84:87],a[164:167],v[152:155]
s_waitcnt lgkmcnt(4)
M v[156:159],a[92:95],a[164:167],v[156:159]
s_nop 0
T a[144:145],v3,16384
T a[146:147],v3,17408
M v[156:159],a[88:91],a[160:163],v[156:159]
buffer_load_dwordx4 v9, s[16:19], s21 offen offset:1024  nt lds
M v[160:163],a[32:35],a[168:171],v[160:163]
R a[160:163],v5,53248
R a[164:167],v6,53248
M v[160:163],a[36:39],a[172:175],v[160:163]
M v[164:167],a[44:47],a[172:175],v[164:167]
M v[164:167],a[40:43],a[168:171],v[164:167]
M v[168:171],a[48:51],a[168:171],v[168:171]
M v[168:171],a[52:55],a[172:175],v[168:171]
s_nop 0
T a[148:149],v3,24576
T a[150:151],v3,25600
M v[172:175],a[60:63],a[172:175],v[172:175]
buffer_load_dwordx4 v10, s[16:19], s21 offen offset:2048  nt lds
M v[172:175],a[56:59],a[168:171],v[172:175]
M v[176:179],a[64:67],a[168:171],v[176:179]
M v[176:179],a[68:71],a[172:175],v[176:179]
M v[180:183],a[76:79],a[172:175],v[180:183]
buffer_load_dwordx4 v11, s[16:19], s21 offen offset:3072  nt lds
M v[180:183],a[72:75],a[168:171],v[180:183]
SA s21,s21,128
M v[184:187],a[80:83],a[168:171],v[184:187]
s_nop 0
T a[152:153],v4,16384
T a[154:155],v4,17408
M v[184:187],a[84:87],a[172:175],v[184:187]
s_waitcnt lgkmcnt(4)
M v[188:191],a[92:95],a[172:175],v[188:191]
M v[188:191],a[88:91],a[168:171],v[188:191]
SA m0,s87,4096
M v[192:195],a[32:35],a[160:163],v[192:195]
R a[168:171],v5,55296
R a[172:175],v6,55296
M v[192:195],a[36:39],a[164:167],v[192:195]
buffer_load_dwordx4 v25, s[60:63], s89 offen offset:0 nt lds
M v[196:199],a[44:47],a[164:167],v[196:199]
SA s89,s89,114688
M v[196:199],a[40:43],a[160:163],v[196:199]
s_nop 0
T a[156:157],v4,24576
T a[158:159],v4,25600
M v[200:203],a[48:51],a[160:163],v[200:203]
M v[200:203],a[52:55],a[164:167],v[200:203]
SA m0,s87,5120
M v[204:207],a[60:63],a[164:167],v[204:207]
buffer_load_dwordx4 v25, s[60:63], s89 offen offset:0 nt lds
M v[204:207],a[56:59],a[160:163],v[204:207]
SA s89,s89,114688
M v[208:211],a[64:67],a[160:163],v[208:211]
M v[208:211],a[68:71],a[164:167],v[208:211]
M v[212:215],a[76:79],a[164:167],v[212:215]
M v[212:215],a[72:75],a[160:163],v[212:215]
M v[216:219],a[80:83],a[160:163],v[216:219]
M v[216:219],a[84:87],a[164:167],v[216:219]
s_waitcnt lgkmcnt(2)
M v[220:223],a[92:95],a[164:167],v[220:223]
s_waitcnt vmcnt(20) lgkmcnt(0)
M v[220:223],a[88:91],a[160:163],v[220:223]
s_barrier
M v[224:227],a[32:35],a[168:171],v[224:227]
R a[160:163],v5,0
R a[164:167],v6,0
M v[224:227],a[36:39],a[172:175],v[224:227]
M v[228:231],a[44:47],a[172:175],v[228:231]
M v[228:231],a[40:43],a[168:171],v[228:231]
M v[232:235],a[48:51],a[168:171],v[232:235]
M v[232:235],a[52:55],a[172:175],v[232:235]
M v[236:239],a[60:63],a[172:175],v[236:239]
M v[236:239],a[56:59],a[168:171],v[236:239]
M v[240:243],a[64:67],a[168:171],v[240:243]
M v[240:243],a[68:71],a[172:175],v[240:243]
M v[244:247],a[76:79],a[172:175],v[244:247]
M v[244:247],a[72:75],a[168:171],v[244:247]
M v[248:251],a[80:83],a[168:171],v[248:251]
M v[248:251],a[84:87],a[172:175],v[248:251]
s_waitcnt lgkmcnt(0)
M v[252:255],a[92:95],a[172:175],v[252:255]
M v[252:255],a[88:91],a[168:171],v[252:255]
M a[0:3],a[96:99],a[160:163],a[0:3]
R a[168:171],v5,2048
R a[172:175],v6,2048
M a[0:3],a[100:103],a[164:167],a[0:3]
T a[32:33],v1,32768
T a[34:35],v1,33792
M a[4:7],a[108:111],a[164:167],a[4:7]
SA m0,s24,49152
M a[4:7],a[104:107],a[160:163],a[4:7]
buffer_load_dwordx4 v12, s[48:51], s22 offen offset:0   lds
M a[8:11],a[112:115],a[160:163],a[8:11]
M a[8:11],a[116:119],a[164:167],a[8:11]
M a[12:15],a[124:127],a[164:167],a[12:15]
s_nop 0
T a[36:37],v1,40960
T a[38:39],v1,41984
M a[12:15],a[120:123],a[160:163],a[12:15]
M a[16:19],a[128:131],a[160:163],a[16:19]
buffer_load_dwordx4 v13, s[48:51], s22 offen offset:1024   lds
M a[16:19],a[132:135],a[164:167],a[16:19]
M a[20:23],a[140:143],a[164:167],a[20:23]
M a[20:23],a[136:139],a[160:163],a[20:23]
s_nop 0
T a[40:41],v2,32768
T a[42:43],v2,33792
M a[24:27],a[144:147],a[160:163],a[24:27]
M a[24:27],a[148:151],a[164:167],a[24:27]
s_waitcnt lgkmcnt(6)
buffer_load_dwordx4 v14, s[48:51], s22 offen offset:2048   lds
M a[28:31],a[156:159],a[164:167],a[28:31]
M a[28:31],a[152:155],a[160:163],a[28:31]
M v[32:35],a[96:99],a[168:171],v[32:35]
R a[160:163],v5,4096
R a[164:167],v6,4096
M v[32:35],a[100:103],a[172:175],v[32:35]
T a[44:45],v2,40960
T a[46:47],v2,41984
M v[36:39],a[108:111],a[172:175],v[36:39]
buffer_load_dwordx4 v15, s[48:51], s22 offen offset:3072   lds
M v[36:39],a[104:107],a[168:171],v[36:39]
s_sub_u32 s22, s22, 1048448
M v[40:43],a[112:115],a[168:171],v[40:43]
M v[40:43],a[116:119],a[172:175],v[40:43]
s_nop 0
T a[48:49],v3,32768
T a[50:51],v3,33792
M v[44:47],a[124:127],a[172:175],v[44:47]
SA m0,s23,16384
M v[44:47],a[120:123],a[168:171],v[44:47]
buffer_load_dwordx4 v8, s[16:19], s21 offen offset:0  nt lds
M v[48:51],a[128:131],a[168:171],v[48:51]
M v[48:51],a[132:135],a[172:175],v[48:51]
M v[52:55],a[140:143],a[172:175],v[52:55]
s_nop 0
T a[52:53],v3,40960
T a[54:55],v3,41984
M v[52:55],a[136:139],a[168:171],v[52:55]
M v[56:59],a[144:147],a[168:171],v[56:59]
buffer_load_dwordx4 v9, s[16:19], s21 offen offset:1024  nt lds
M v[56:59],a[148:151],a[172:175],v[56:59]
s_waitcnt lgkmcnt(6)
M v[60:63],a[156:159],a[172:175],v[60:63]
M v[60:63],a[152:155],a[168:171],v[60:63]
s_nop 0
T a[56:57],v4,32768
T a[58:59],v4,33792
M v[64:67],a[96:99],a[160:163],v[64:67]
R a[168:171],v5,6144
R a[172:175],v6,6144
M v[64:67],a[100:103],a[164:167],v[64:67]
buffer_load_dwordx4 v10, s[16:19], s21 offen offset:2048  nt lds
M v[68:71],a[108:111],a[164:167],v[68:71]
M v[68:71],a[104:107],a[160:163],v[68:71]
M v[72:75],a[112:115],a[160:163],v[72:75]
s_nop 0
T a[60:61],v4,40960
T a[62:63],v4,41984
M v[72:75],a[116:119],a[164:167],v[72:75]
M v[76:79],a[124:127],a[164:167],v[76:79]
buffer_load_dwordx4 v11, s[16:19], s21 offen offset:3072  nt lds
M v[76:79],a[120:123],a[160:163],v[76:79]
SA s21,s21,524160
M v[80:83],a[128:131],a[160:163],v[80:83]
M v[80:83],a[132:135],a[164:167],v[80:83]
M v[84:87],a[140:143],a[164:167],v[84:87]
M v[84:87],a[136:139],a[160:163],v[84:87]
M v[88:91],a[144:147],a[160:163],v[88:91]
M v[88:91],a[148:151],a[164:167],v[88:91]
s_waitcnt lgkmcnt(2)
M v[92:95],a[156:159],a[164:167],v[92:95]
s_waitcnt vmcnt(18) lgkmcnt(0)
M v[92:95],a[152:155],a[160:163],v[92:95]
s_barrier
M v[96:99],a[96:99],a[168:171],v[96:99]
R a[160:163],v5,16384
R a[164:167],v6,16384
M v[96:99],a[100:103],a[172:175],v[96:99]
M v[100:103],a[108:111],a[172:175],v[100:103]
SA m0,s24,0
T a[64:65],v1,49152
T a[66:67],v1,50176
M v[100:103],a[104:107],a[168:171],v[100:103]
buffer_load_dwordx4 v12, s[48:51], s22 offen offset:0   lds
M v[104:107],a[112:115],a[168:171],v[104:107]
M v[104:107],a[116:119],a[172:175],v[104:107]
M v[108:111],a[124:127],a[172:175],v[108:111]
M v[108:111],a[120:123],a[168:171],v[108:111]
M v[112:115],a[128:131],a[168:171],v[112:115]
M v[112:115],a[132:135],a[172:175],v[112:115]
s_nop 0
T a[68:69],v1,57344
T a[70:71],v1,58368
M v[116:119],a[140:143],a[172:175],v[116:119]
buffer_load_dwordx4 v13, s[48:51], s22 offen offset:1024   lds
M v[116:119],a[136:139],a[168:171],v[116:119]
M v[120:123],a[144:147],a[168:171],v[120:123]
M v[120:123],a[148:151],a[172:175],v[120:123]
s_waitcnt lgkmcnt(4)
M v[124:127],a[156:159],a[172:175],v[124:127]
M v[124:127],a[152:155],a[168:171],v[124:127]
buffer_load_dwordx4 v14, s[48:51], s22 offen offset:2048   lds
M v[128:131],a[96:99],a[160:163],v[128:131]
R a[168:171],v5,18432
R a[172:175],v6,18432
M v[128:131],a[100:103],a[164:167],v[128:131]
s_lshl_b32 s67, s20, 11
T a[72:73],v2,49152
T a[74:75],v2,50176
M v[132:135],a[108:111],a[164:167],v[132:135]
SA s67,s67,104914944
buffer_load_dwordx4 v[16:19], v7, s[8:11], s67 offen offset:0 sc1
M v[132:135],a[104:107],a[160:163],v[132:135]
M v[136:139],a[112:115],a[160:163],v[136:139]
buffer_load_dwordx4 v[20:23], v7, s[8:11], s67 offen offset:1024 sc1
M v[136:139],a[116:119],a[164:167],v[136:139]
M v[140:143],a[124:127],a[164:167],v[140:143]
buffer_load_dwordx4 v15, s[48:51], s22 offen offset:3072   lds
M v[140:143],a[120:123],a[160:163],v[140:143]
SA s22,s22,1048576
L_w_kv03:
s_cbranch_execz L_w_kv07
T a[76:77],v2,57344
T a[78:79],v2,58368
M v[144:147],a[128:131],a[160:163],v[144:147]
M v[144:147],a[132:135],a[164:167],v[144:147]
M v[148:151],a[140:143],a[164:167],v[148:151]
M v[148:151],a[136:139],a[160:163],v[148:151]
SA m0,s23,32768
M v[152:155],a[144:147],a[160:163],v[152:155]
buffer_load_dwordx4 v8, s[16:19], s21 offen offset:0  nt lds
M v[152:155],a[148:151],a[164:167],v[152:155]
s_waitcnt lgkmcnt(4)
M v[156:159],a[156:159],a[164:167],v[156:159]
s_nop 0
T a[80:81],v3,49152
T a[82:83],v3,50176
M v[156:159],a[152:155],a[160:163],v[156:159]
M v[160:163],a[96:99],a[168:171],v[160:163]
R a[160:163],v5,20480
R a[164:167],v6,20480
M v[160:163],a[100:103],a[172:175],v[160:163]
M v[164:167],a[108:111],a[172:175],v[164:167]
buffer_load_dwordx4 v9, s[16:19], s21 offen offset:1024  nt lds
M v[164:167],a[104:107],a[168:171],v[164:167]
M v[168:171],a[112:115],a[168:171],v[168:171]
M v[168:171],a[116:119],a[172:175],v[168:171]
s_nop 0
T a[84:85],v3,57344
T a[86:87],v3,58368
M v[172:175],a[124:127],a[172:175],v[172:175]
M v[172:175],a[120:123],a[168:171],v[172:175]
M v[176:179],a[128:131],a[168:171],v[176:179]
M v[176:179],a[132:135],a[172:175],v[176:179]
buffer_load_dwordx4 v10, s[16:19], s21 offen offset:2048  nt lds
M v[180:183],a[140:143],a[172:175],v[180:183]
M v[180:183],a[136:139],a[168:171],v[180:183]
M v[184:187],a[144:147],a[168:171],v[184:187]
s_nop 0
T a[88:89],v4,49152
T a[90:91],v4,50176
M v[184:187],a[148:151],a[172:175],v[184:187]
s_waitcnt lgkmcnt(4)
M v[188:191],a[156:159],a[172:175],v[188:191]
M v[188:191],a[152:155],a[168:171],v[188:191]
buffer_load_dwordx4 v11, s[16:19], s21 offen offset:3072  nt lds
M v[192:195],a[96:99],a[160:163],v[192:195]
SA s21,s21,128
R a[168:171],v5,22528
R a[172:175],v6,22528
M v[192:195],a[100:103],a[164:167],v[192:195]
M v[196:199],a[108:111],a[164:167],v[196:199]
M v[196:199],a[104:107],a[160:163],v[196:199]
s_nop 0
T a[92:93],v4,57344
T a[94:95],v4,58368
M v[200:203],a[112:115],a[160:163],v[200:203]
SA m0,s87,6144
M v[200:203],a[116:119],a[164:167],v[200:203]
buffer_load_dwordx4 v25, s[60:63], s89 offen offset:0 nt lds
M v[204:207],a[124:127],a[164:167],v[204:207]
SA s89,s89,114688
M v[204:207],a[120:123],a[160:163],v[204:207]
M v[208:211],a[128:131],a[160:163],v[208:211]
M v[208:211],a[132:135],a[164:167],v[208:211]
M v[212:215],a[140:143],a[164:167],v[212:215]
M v[212:215],a[136:139],a[160:163],v[212:215]
M v[216:219],a[144:147],a[160:163],v[216:219]
M v[216:219],a[148:151],a[164:167],v[216:219]
s_waitcnt lgkmcnt(2)
M v[220:223],a[156:159],a[164:167],v[220:223]
s_waitcnt vmcnt(21) lgkmcnt(0)
M v[220:223],a[152:155],a[160:163],v[220:223]
s_barrier
M v[224:227],a[96:99],a[168:171],v[224:227]
R a[160:163],v5,32768
R a[164:167],v6,32768
M v[224:227],a[100:103],a[172:175],v[224:227]
M v[228:231],a[108:111],a[172:175],v[228:231]
M v[228:231],a[104:107],a[168:171],v[228:231]
M v[232:235],a[112:115],a[168:171],v[232:235]
M v[232:235],a[116:119],a[172:175],v[232:235]
M v[236:239],a[124:127],a[172:175],v[236:239]
M v[236:239],a[120:123],a[168:171],v[236:239]
M v[240:243],a[128:131],a[168:171],v[240:243]
M v[240:243],a[132:135],a[172:175],v[240:243]
M v[244:247],a[140:143],a[172:175],v[244:247]
M v[244:247],a[136:139],a[168:171],v[244:247]
M v[248:251],a[144:147],a[168:171],v[248:251]
M v[248:251],a[148:151],a[172:175],v[248:251]
s_waitcnt lgkmcnt(0)
M v[252:255],a[156:159],a[172:175],v[252:255]
M v[252:255],a[152:155],a[168:171],v[252:255]
M a[0:3],a[32:35],a[160:163],a[0:3]
R a[168:171],v5,34816
R a[172:175],v6,34816
M a[0:3],a[36:39],a[164:167],a[0:3]
T a[96:97],v1,0
T a[98:99],v1,1024
M a[4:7],a[44:47],a[164:167],a[4:7]
SA m0,s24,16384
M a[4:7],a[40:43],a[160:163],a[4:7]
buffer_load_dwordx4 v12, s[48:51], s22 offen offset:0   lds
M a[8:11],a[48:51],a[160:163],a[8:11]
M a[8:11],a[52:55],a[164:167],a[8:11]
M a[12:15],a[60:63],a[164:167],a[12:15]
s_nop 0
T a[100:101],v1,8192
T a[102:103],v1,9216
M a[12:15],a[56:59],a[160:163],a[12:15]
M a[16:19],a[64:67],a[160:163],a[16:19]
buffer_load_dwordx4 v13, s[48:51], s22 offen offset:1024   lds
M a[16:19],a[68:71],a[164:167],a[16:19]
M a[20:23],a[76:79],a[164:167],a[20:23]
s_waitcnt vmcnt(9)
v_min3_u32 v28, v16, v17, v18
M a[20:23],a[72:75],a[160:163],a[20:23]
s_nop 0
T a[104:105],v2,0
T a[106:107],v2,1024
M a[24:27],a[80:83],a[160:163],a[24:27]
s_waitcnt vmcnt(8)
v_min3_u32 v28, v28, v19, v20
M a[24:27],a[84:87],a[164:167],a[24:27]
s_waitcnt lgkmcnt(6)
buffer_load_dwordx4 v14, s[48:51], s22 offen offset:2048   lds
M a[28:31],a[92:95],a[164:167],a[28:31]
v_min3_u32 v28, v28, v21, v22
M a[28:31],a[88:91],a[160:163],a[28:31]
v_min_u32 v28, v28, v23
M v[32:35],a[32:35],a[168:171],v[32:35]
R a[160:163],v5,36864
R a[164:167],v6,36864
M v[32:35],a[36:39],a[172:175],v[32:35]
T a[108:109],v2,8192
T a[110:111],v2,9216
M v[36:39],a[44:47],a[172:175],v[36:39]
buffer_load_dwordx4 v15, s[48:51], s22 offen offset:3072   lds
M v[36:39],a[40:43],a[168:171],v[36:39]
s_sub_u32 s22, s22, 1048448
v_cmp_eq_u32 vcc, 0, v28
M v[40:43],a[48:51],a[168:171],v[40:43]
s_nop 0
M v[40:43],a[52:55],a[172:175],v[40:43]
s_cbranch_vccnz L_hs
L_hr:
T a[112:113],v3,0
T a[114:115],v3,1024
M v[44:47],a[60:63],a[172:175],v[44:47]
SA m0,s23,49152
v_max_u32 v28, v16, v17
M v[44:47],a[56:59],a[168:171],v[44:47]
buffer_load_dwordx4 v8, s[16:19], s21 offen offset:0  nt lds
M v[48:51],a[64:67],a[168:171],v[48:51]
v_min_u32 v29, v16, v17
M v[48:51],a[68:71],a[172:175],v[48:51]
v_med3_u32 v29, v28, v29, v18
M v[52:55],a[76:79],a[172:175],v[52:55]
s_nop 0
T a[116:117],v3,8192
T a[118:119],v3,9216
M v[52:55],a[72:75],a[168:171],v[52:55]
v_max_u32 v28, v28, v18
M v[56:59],a[80:83],a[168:171],v[56:59]
buffer_load_dwordx4 v9, s[16:19], s21 offen offset:1024  nt lds
M v[56:59],a[84:87],a[172:175],v[56:59]
s_waitcnt lgkmcnt(6)
v_med3_u32 v29, v28, v29, v19
M v[60:63],a[92:95],a[172:175],v[60:63]
v_max_u32 v28, v28, v19
M v[60:63],a[88:91],a[168:171],v[60:63]
s_nop 0
T a[120:121],v4,0
T a[122:123],v4,1024
M v[64:67],a[32:35],a[160:163],v[64:67]
R a[168:171],v5,38912
R a[172:175],v6,38912
M v[64:67],a[36:39],a[164:167],v[64:67]
buffer_load_dwordx4 v10, s[16:19], s21 offen offset:2048  nt lds
M v[68:71],a[44:47],a[164:167],v[68:71]
v_med3_u32 v29, v28, v29, v20
M v[68:71],a[40:43],a[160:163],v[68:71]
v_max_u32 v28, v28, v20
M v[72:75],a[48:51],a[160:163],v[72:75]
s_nop 0
T a[124:125],v4,8192
T a[126:127],v4,9216
M v[72:75],a[52:55],a[164:167],v[72:75]
v_med3_u32 v29, v28, v29, v21
M v[76:79],a[60:63],a[164:167],v[76:79]
buffer_load_dwordx4 v11, s[16:19], s21 offen offset:3072  nt lds
M v[76:79],a[56:59],a[160:163],v[76:79]
SA s21,s21,524160
v_max_u32 v28, v28, v21
M v[80:83],a[64:67],a[160:163],v[80:83]
v_med3_u32 v29, v28, v29, v22
M v[80:83],a[68:71],a[164:167],v[80:83]
v_max_u32 v28, v28, v22
M v[84:87],a[76:79],a[164:167],v[84:87]
v_med3_u32 v29, v28, v29, v23
M v[84:87],a[72:75],a[160:163],v[84:87]
v_max_u32 v28, v28, v23
M v[88:91],a[80:83],a[160:163],v[88:91]
s_nop 0
v_mov_b32 v30, v28 row_ror:8 row_mask:0xf bank_mask:0xf
M v[88:91],a[84:87],a[164:167],v[88:91]
s_waitcnt lgkmcnt(2)
v_mov_b32 v31, v29 row_ror:8 row_mask:0xf bank_mask:0xf
M v[92:95],a[92:95],a[164:167],v[92:95]
s_waitcnt lgkmcnt(0)
v_min_u32 v16, v28, v30
M v[92:95],a[88:91],a[160:163],v[92:95]
s_barrier
M v[96:99],a[32:35],a[168:171],v[96:99]
R a[160:163],v5,49152
R a[164:167],v6,49152
M v[96:99],a[36:39],a[172:175],v[96:99]
v_max_u32 v28, v28, v30
M v[100:103],a[44:47],a[172:175],v[100:103]
SA m0,s24,32768
T a[128:129],v1,16384
T a[130:131],v1,17408
M v[100:103],a[40:43],a[168:171],v[100:103]
buffer_load_dwordx4 v12, s[48:51], s22 offen offset:0   lds
M v[104:107],a[48:51],a[168:171],v[104:107]
v_max3_u32 v29, v29, v31, v16
M v[104:107],a[52:55],a[172:175],v[104:107]
v_mov_b32 v30, v28 row_ror:4 row_mask:0xf bank_mask:0xf
M v[108:111],a[60:63],a[172:175],v[108:111]
v_mov_b32 v31, v29 row_ror:4 row_mask:0xf bank_mask:0xf
M v[108:111],a[56:59],a[168:171],v[108:111]
v_min_u32 v16, v28, v30
M v[112:115],a[64:67],a[168:171],v[112:115]
v_max_u32 v28, v28, v30
M v[112:115],a[68:71],a[172:175],v[112:115]
s_nop 0
T a[132:133],v1,24576
T a[134:135],v1,25600
M v[116:119],a[76:79],a[172:175],v[116:119]
buffer_load_dwordx4 v13, s[48:51], s22 offen offset:1024   lds
M v[116:119],a[72:75],a[168:171],v[116:119]
v_max3_u32 v29, v29, v31, v16
M v[120:123],a[80:83],a[168:171],v[120:123]
v_mov_b32 v30, v28 row_ror:2 row_mask:0xf bank_mask:0xf
M v[120:123],a[84:87],a[172:175],v[120:123]
s_waitcnt lgkmcnt(4)
v_mov_b32 v31, v29 row_ror:2 row_mask:0xf bank_mask:0xf
M v[124:127],a[92:95],a[172:175],v[124:127]
v_min_u32 v16, v28, v30
M v[124:127],a[88:91],a[168:171],v[124:127]
v_max_u32 v28, v28, v30
M v[128:131],a[32:35],a[160:163],v[128:131]
R a[168:171],v5,51200
R a[172:175],v6,51200
M v[128:131],a[36:39],a[164:167],v[128:131]
T a[136:137],v2,16384
T a[138:139],v2,17408
M v[132:135],a[44:47],a[164:167],v[132:135]
buffer_load_dwordx4 v14, s[48:51], s22 offen offset:2048   lds
M v[132:135],a[40:43],a[160:163],v[132:135]
v_max3_u32 v29, v29, v31, v16
M v[136:139],a[48:51],a[160:163],v[136:139]
v_mov_b32 v30, v28 row_ror:1 row_mask:0xf bank_mask:0xf
M v[136:139],a[52:55],a[164:167],v[136:139]
v_mov_b32 v31, v29 row_ror:1 row_mask:0xf bank_mask:0xf
M v[140:143],a[60:63],a[164:167],v[140:143]
v_min_u32 v16, v28, v30
M v[140:143],a[56:59],a[160:163],v[140:143]
s_nop 0
T a[140:141],v2,24576
T a[142:143],v2,25600
M v[144:147],a[64:67],a[160:163],v[144:147]
buffer_load_dwordx4 v15, s[48:51], s22 offen offset:3072   lds
M v[144:147],a[68:71],a[164:167],v[144:147]
SA s22,s22,1048576
v_max_u32 v28, v28, v30
M v[148:151],a[76:79],a[164:167],v[148:151]
v_max3_u32 v29, v29, v31, v16
M v[148:151],a[72:75],a[160:163],v[148:151]
v_mov_b32 v30, v28
M v[152:155],a[80:83],a[160:163],v[152:155]
v_mov_b32 v31, v29
M v[152:155],a[84:87],a[164:167],v[152:155]
s_waitcnt lgkmcnt(4)
v_permlane16_swap_b32 v30, v28
M v[156:159],a[92:95],a[164:167],v[156:159]
SA m0,s23,0
T a[144:145],v3,16384
T a[146:147],v3,17408
M v[156:159],a[88:91],a[160:163],v[156:159]
buffer_load_dwordx4 v8, s[16:19], s21 offen offset:0  nt lds
M v[160:163],a[32:35],a[168:171],v[160:163]
R a[160:163],v5,53248
R a[164:167],v6,53248
M v[160:163],a[36:39],a[172:175],v[160:163]
v_permlane16_swap_b32 v31, v29
M v[164:167],a[44:47],a[172:175],v[164:167]
v_min_u32 v16, v28, v30
M v[164:167],a[40:43],a[168:171],v[164:167]
v_max_u32 v28, v28, v30
M v[168:171],a[48:51],a[168:171],v[168:171]
v_max3_u32 v29, v29, v31, v16
M v[168:171],a[52:55],a[172:175],v[168:171]
s_nop 0
T a[148:149],v3,24576
T a[150:151],v3,25600
M v[172:175],a[60:63],a[172:175],v[172:175]
buffer_load_dwordx4 v9, s[16:19], s21 offen offset:1024  nt lds
M v[172:175],a[56:59],a[168:171],v[172:175]
v_mov_b32 v30, v28
M v[176:179],a[64:67],a[168:171],v[176:179]
v_mov_b32 v31, v29
M v[176:179],a[68:71],a[172:175],v[176:179]
v_permlane32_swap_b32 v30, v28
M v[180:183],a[76:79],a[172:175],v[180:183]
v_permlane32_swap_b32 v31, v29
M v[180:183],a[72:75],a[168:171],v[180:183]
v_min_u32 v16, v28, v30
M v[184:187],a[80:83],a[168:171],v[184:187]
s_nop 0
T a[152:153],v4,16384
T a[154:155],v4,17408
M v[184:187],a[84:87],a[172:175],v[184:187]
s_waitcnt lgkmcnt(4)
buffer_load_dwordx4 v10, s[16:19], s21 offen offset:2048  nt lds
M v[188:191],a[92:95],a[172:175],v[188:191]
v_max_u32 v28, v28, v30
M v[188:191],a[88:91],a[168:171],v[188:191]
v_max3_u32 v29, v29, v31, v16
M v[192:195],a[32:35],a[160:163],v[192:195]
s_lshl_b32 s64, s20, 3
R a[168:171],v5,55296
R a[172:175],v6,55296
M v[192:195],a[36:39],a[164:167],v[192:195]
SA s64,s64,159744
v_mov_b32 v16, s64
M v[196:199],a[44:47],a[164:167],v[196:199]
ds_write_b64 v16, v[28:29]
M v[196:199],a[40:43],a[160:163],v[196:199]
s_nop 0
T a[156:157],v4,24576
T a[158:159],v4,25600
M v[200:203],a[48:51],a[160:163],v[200:203]
buffer_load_dwordx4 v11, s[16:19], s21 offen offset:3072  nt lds
M v[200:203],a[52:55],a[164:167],v[200:203]
SA s21,s21,128
M v[204:207],a[60:63],a[164:167],v[204:207]
M v[204:207],a[56:59],a[160:163],v[204:207]
M v[208:211],a[64:67],a[160:163],v[208:211]
M v[208:211],a[68:71],a[164:167],v[208:211]
M v[212:215],a[76:79],a[164:167],v[212:215]
M v[212:215],a[72:75],a[160:163],v[212:215]
M v[216:219],a[80:83],a[160:163],v[216:219]
M v[216:219],a[84:87],a[164:167],v[216:219]
s_waitcnt lgkmcnt(3)
M v[220:223],a[92:95],a[164:167],v[220:223]
s_waitcnt vmcnt(17) lgkmcnt(0)
M v[220:223],a[88:91],a[160:163],v[220:223]
s_barrier
M v[224:227],a[32:35],a[168:171],v[224:227]
R a[160:163],v5,0
R a[164:167],v6,0
M v[224:227],a[36:39],a[172:175],v[224:227]
M v[228:231],a[44:47],a[172:175],v[228:231]
M v[228:231],a[40:43],a[168:171],v[228:231]
M v[232:235],a[48:51],a[168:171],v[232:235]
M v[232:235],a[52:55],a[172:175],v[232:235]
M v[236:239],a[60:63],a[172:175],v[236:239]
M v[236:239],a[56:59],a[168:171],v[236:239]
M v[240:243],a[64:67],a[168:171],v[240:243]
M v[240:243],a[68:71],a[172:175],v[240:243]
M v[244:247],a[76:79],a[172:175],v[244:247]
M v[244:247],a[72:75],a[168:171],v[244:247]
M v[248:251],a[80:83],a[168:171],v[248:251]
M v[248:251],a[84:87],a[172:175],v[248:251]
s_waitcnt lgkmcnt(0)
M v[252:255],a[92:95],a[172:175],v[252:255]
M v[252:255],a[88:91],a[168:171],v[252:255]
M a[0:3],a[96:99],a[160:163],a[0:3]
R a[168:171],v5,2048
R a[172:175],v6,2048
M a[0:3],a[100:103],a[164:167],a[0:3]
T a[32:33],v1,32768
T a[34:35],v1,33792
M a[4:7],a[108:111],a[164:167],a[4:7]
SA m0,s24,49152
M a[4:7],a[104:107],a[160:163],a[4:7]
buffer_load_dwordx4 v12, s[48:51], s22 offen offset:0   lds
M a[8:11],a[112:115],a[160:163],a[8:11]
v_mov_b32 v28, 159744
M a[8:11],a[116:119],a[164:167],a[8:11]
ds_read_b128 v[16:19], v28
M a[12:15],a[124:127],a[164:167],a[12:15]
s_nop 0
T a[36:37],v1,40960
T a[38:39],v1,41984
M a[12:15],a[120:123],a[160:163],a[12:15]
R v[20:23],v28,16
M a[16:19],a[128:131],a[160:163],a[16:19]
buffer_load_dwordx4 v13, s[48:51], s22 offen offset:1024   lds
M a[16:19],a[132:135],a[164:167],a[16:19]
M a[20:23],a[140:143],a[164:167],a[20:23]
M a[20:23],a[136:139],a[160:163],a[20:23]
s_nop 0
T a[40:41],v2,32768
T a[42:43],v2,33792
M a[24:27],a[144:147],a[160:163],a[24:27]
M a[24:27],a[148:151],a[164:167],a[24:27]
s_waitcnt lgkmcnt(8)
buffer_load_dwordx4 v14, s[48:51], s22 offen offset:2048   lds
M a[28:31],a[156:159],a[164:167],a[28:31]
M a[28:31],a[152:155],a[160:163],a[28:31]
M v[32:35],a[96:99],a[168:171],v[32:35]
R a[160:163],v5,4096
R a[164:167],v6,4096
M v[32:35],a[100:103],a[172:175],v[32:35]
T a[44:45],v2,40960
T a[46:47],v2,41984
M v[36:39],a[108:111],a[172:175],v[36:39]
buffer_load_dwordx4 v15, s[48:51], s22 offen offset:3072   lds
M v[36:39],a[104:107],a[168:171],v[36:39]
s_sub_u32 s22, s22, 1048448
s_waitcnt lgkmcnt(9)
v_min_u32 v28, v16, v18
M v[40:43],a[112:115],a[168:171],v[40:43]
v_max_u32 v16, v16, v18
M v[40:43],a[116:119],a[172:175],v[40:43]
s_nop 0
T a[48:49],v3,32768
T a[50:51],v3,33792
M v[44:47],a[124:127],a[172:175],v[44:47]
SA m0,s23,16384
v_max3_u32 v17, v17, v19, v28
M v[44:47],a[120:123],a[168:171],v[44:47]
buffer_load_dwordx4 v8, s[16:19], s21 offen offset:0  nt lds
M v[48:51],a[128:131],a[168:171],v[48:51]
s_waitcnt lgkmcnt(8)
v_min_u32 v29, v20, v22
M v[48:51],a[132:135],a[172:175],v[48:51]
v_max_u32 v20, v20, v22
M v[52:55],a[140:143],a[172:175],v[52:55]
s_nop 0
T a[52:53],v3,40960
T a[54:55],v3,41984
M v[52:55],a[136:139],a[168:171],v[52:55]
v_max3_u32 v21, v21, v23, v29
M v[56:59],a[144:147],a[168:171],v[56:59]
buffer_load_dwordx4 v9, s[16:19], s21 offen offset:1024  nt lds
M v[56:59],a[148:151],a[172:175],v[56:59]
s_waitcnt lgkmcnt(6)
v_min_u32 v28, v16, v20
M v[60:63],a[156:159],a[172:175],v[60:63]
v_max_u32 v16, v16, v20
M v[60:63],a[152:155],a[168:171],v[60:63]
s_nop 0
T a[56:57],v4,32768
T a[58:59],v4,33792
M v[64:67],a[96:99],a[160:163],v[64:67]
R a[168:171],v5,6144
R a[172:175],v6,6144
M v[64:67],a[100:103],a[164:167],v[64:67]
buffer_load_dwordx4 v10, s[16:19], s21 offen offset:2048  nt lds
M v[68:71],a[108:111],a[164:167],v[68:71]
v_max3_u32 v17, v17, v21, v28
M v[68:71],a[104:107],a[160:163],v[68:71]
v_and_b32 v28, 1, v0
M v[72:75],a[112:115],a[160:163],v[72:75]
s_nop 0
T a[60:61],v4,40960
T a[62:63],v4,41984
M v[72:75],a[116:119],a[164:167],v[72:75]
v_cmp_eq_u32 vcc, 0, v28
M v[76:79],a[124:127],a[164:167],v[76:79]
s_and_b32 s64, s20, 1
buffer_load_dwordx4 v11, s[16:19], s21 offen offset:3072  nt lds
M v[76:79],a[120:123],a[160:163],v[76:79]
SA s21,s21,524160
s_mul_i32 s64, s64, 448
v_cndmask_b32 v24, v17, v16, vcc
M v[80:83],a[128:131],a[160:163],v[80:83]
v_and_b32 v24, 0x7ff, v24
M v[80:83],a[132:135],a[164:167],v[80:83]
v_sub_u32 v24, 2047, v24
M v[84:87],a[140:143],a[164:167],v[84:87]
v_mul_u32_u24 v28, 896, v24
M v[84:87],a[136:139],a[160:163],v[84:87]
v_lshrrev_b32 v29, 4, v0
M v[88:91],a[144:147],a[160:163],v[88:91]
v_lshl_add_u32 v28, v29, 4, v28
M v[88:91],a[148:151],a[164:167],v[88:91]
s_waitcnt lgkmcnt(2)
v_bfe_u32 v30, v0, 1, 3
M v[92:95],a[156:159],a[164:167],v[92:95]
s_waitcnt vmcnt(16) lgkmcnt(0)
v_lshl_or_b32 v28, v30, 26, v28
M v[92:95],a[152:155],a[160:163],v[92:95]
s_barrier
M v[96:99],a[96:99],a[168:171],v[96:99]
R a[160:163],v5,16384
R a[164:167],v6,16384
M v[96:99],a[100:103],a[172:175],v[96:99]
buffer_load_dwordx4 a[208:211], v28, s[56:59], s64 offen offset:0
M v[100:103],a[108:111],a[172:175],v[100:103]
SA m0,s24,0
T a[64:65],v1,49152
T a[66:67],v1,50176
M v[100:103],a[104:107],a[168:171],v[100:103]
buffer_load_dwordx4 v12, s[48:51], s22 offen offset:0   lds
M v[104:107],a[112:115],a[168:171],v[104:107]
M v[104:107],a[116:119],a[172:175],v[104:107]
M v[108:111],a[124:127],a[172:175],v[108:111]
buffer_load_dwordx4 a[212:215], v28, s[56:59], s64 offen offset:64
M v[108:111],a[120:123],a[168:171],v[108:111]
M v[112:115],a[128:131],a[168:171],v[112:115]
buffer_load_dwordx4 a[216:219], v28, s[56:59], s64 offen offset:128
M v[112:115],a[132:135],a[172:175],v[112:115]
s_nop 0
T a[68:69],v1,57344
T a[70:71],v1,58368
M v[116:119],a[140:143],a[172:175],v[116:119]
buffer_load_dwordx4 v13, s[48:51], s22 offen offset:1024   lds
M v[116:119],a[136:139],a[168:171],v[116:119]
M v[120:123],a[144:147],a[168:171],v[120:123]
M v[120:123],a[148:151],a[172:175],v[120:123]
s_waitcnt lgkmcnt(4)
M v[124:127],a[156:159],a[172:175],v[124:127]
buffer_load_dwordx4 a[220:223], v28, s[56:59], s64 offen offset:192
M v[124:127],a[152:155],a[168:171],v[124:127]
M v[128:131],a[96:99],a[160:163],v[128:131]
R a[168:171],v5,18432
R a[172:175],v6,18432
M v[128:131],a[100:103],a[164:167],v[128:131]
T a[72:73],v2,49152
T a[74:75],v2,50176
M v[132:135],a[108:111],a[164:167],v[132:135]
buffer_load_dwordx4 v14, s[48:51], s22 offen offset:2048   lds
M v[132:135],a[104:107],a[160:163],v[132:135]
M v[136:139],a[112:115],a[160:163],v[136:139]
buffer_load_dwordx4 a[224:227], v28, s[56:59], s64 offen offset:256
M v[136:139],a[116:119],a[164:167],v[136:139]
M v[140:143],a[124:127],a[164:167],v[140:143]
buffer_load_dwordx4 a[228:231], v28, s[56:59], s64 offen offset:320
M v[140:143],a[120:123],a[160:163],v[140:143]
s_nop 0
T a[76:77],v2,57344
T a[78:79],v2,58368
M v[144:147],a[128:131],a[160:163],v[144:147]
buffer_load_dwordx4 v15, s[48:51], s22 offen offset:3072   lds
M v[144:147],a[132:135],a[164:167],v[144:147]
SA s22,s22,1048576
M v[148:151],a[140:143],a[164:167],v[148:151]
M v[148:151],a[136:139],a[160:163],v[148:151]
buffer_load_dwordx4 a[232:235], v28, s[56:59], s64 offen offset:384
M v[152:155],a[144:147],a[160:163],v[152:155]
v_lshrrev_b32 v28, 4, v24
M v[152:155],a[148:151],a[164:167],v[152:155]
s_waitcnt lgkmcnt(4)
v_lshlrev_b32 v28, 5, v28
M v[156:159],a[156:159],a[164:167],v[156:159]
SA m0,s23,32768
T a[80:81],v3,49152
T a[82:83],v3,50176
M v[156:159],a[152:155],a[160:163],v[156:159]
buffer_load_dwordx4 v8, s[16:19], s21 offen offset:0  nt lds
M v[160:163],a[96:99],a[168:171],v[160:163]
L_w_kv04:
s_cbranch_execz L_w_kv08
R a[160:163],v5,20480
R a[164:167],v6,20480
M v[160:163],a[100:103],a[172:175],v[160:163]
v_and_b32 v30, 15, v24
M v[164:167],a[108:111],a[172:175],v[164:167]
v_add_lshl_u32 v28, v28, v30, 2
M v[164:167],a[104:107],a[168:171],v[164:167]
v_lshrrev_b32 v30, 1, v0
M v[168:171],a[112:115],a[168:171],v[168:171]
v_min_u32 v30, 1, v30
M v[168:171],a[116:119],a[172:175],v[168:171]
s_nop 0
T a[84:85],v3,57344
T a[86:87],v3,58368
M v[172:175],a[124:127],a[172:175],v[172:175]
buffer_load_dwordx4 v9, s[16:19], s21 offen offset:1024  nt lds
M v[172:175],a[120:123],a[168:171],v[172:175]
v_lshl_or_b32 v28, v30, 29, v28
M v[176:179],a[128:131],a[168:171],v[176:179]
s_or_b32 s64, s31, s20
M v[176:179],a[132:135],a[172:175],v[176:179]
s_min_u32 s64, s64, 1
M v[180:183],a[140:143],a[172:175],v[180:183]
s_lshl_b32 s64, s64, 29
M v[180:183],a[136:139],a[168:171],v[180:183]
SA s64,s64,104857600
buffer_load_dword v23, v28, s[8:11], s64 offen sc1
M v[184:187],a[144:147],a[168:171],v[184:187]
s_nop 0
T a[88:89],v4,49152
T a[90:91],v4,50176
M v[184:187],a[148:151],a[172:175],v[184:187]
s_waitcnt lgkmcnt(4)
buffer_load_dwordx4 v10, s[16:19], s21 offen offset:2048  nt lds
M v[188:191],a[156:159],a[172:175],v[188:191]
v_bfe_u32 v28, v0, 2, 2
M v[188:191],a[152:155],a[168:171],v[188:191]
v_lshl_add_u32 v28, v29, 3, v28
M v[192:195],a[96:99],a[160:163],v[192:195]
R a[168:171],v5,22528
R a[172:175],v6,22528
M v[192:195],a[100:103],a[164:167],v[192:195]
v_lshlrev_b32 v28, 5, v28
M v[196:199],a[108:111],a[164:167],v[196:199]
v_and_b32 v30, 3, v0
M v[196:199],a[104:107],a[160:163],v[196:199]
s_nop 0
T a[92:93],v4,57344
T a[94:95],v4,58368
M v[200:203],a[112:115],a[160:163],v[200:203]
buffer_load_dwordx4 v11, s[16:19], s21 offen offset:3072  nt lds
M v[200:203],a[116:119],a[164:167],v[200:203]
SA s21,s21,128
v_lshl_add_u32 v28, v30, 3, v28
M v[204:207],a[124:127],a[164:167],v[204:207]
v_add_u32 v22, s87, v28
M v[204:207],a[120:123],a[160:163],v[204:207]
M v[208:211],a[128:131],a[160:163],v[208:211]
M v[208:211],a[132:135],a[164:167],v[208:211]
M v[212:215],a[140:143],a[164:167],v[212:215]
M v[212:215],a[136:139],a[160:163],v[212:215]
M v[216:219],a[144:147],a[160:163],v[216:219]
M v[216:219],a[148:151],a[164:167],v[216:219]
s_waitcnt lgkmcnt(2)
M v[220:223],a[156:159],a[164:167],v[220:223]
s_waitcnt vmcnt(24) lgkmcnt(0)
M v[220:223],a[152:155],a[160:163],v[220:223]
s_barrier
M v[224:227],a[96:99],a[168:171],v[224:227]
R a[160:163],v5,32768
R a[164:167],v6,32768
M v[224:227],a[100:103],a[172:175],v[224:227]
M v[228:231],a[108:111],a[172:175],v[228:231]
M v[228:231],a[104:107],a[168:171],v[228:231]
M v[232:235],a[112:115],a[168:171],v[232:235]
M v[232:235],a[116:119],a[172:175],v[232:235]
M v[236:239],a[124:127],a[172:175],v[236:239]
M v[236:239],a[120:123],a[168:171],v[236:239]
M v[240:243],a[128:131],a[168:171],v[240:243]
M v[240:243],a[132:135],a[172:175],v[240:243]
M v[244:247],a[140:143],a[172:175],v[244:247]
M v[244:247],a[136:139],a[168:171],v[244:247]
M v[248:251],a[144:147],a[168:171],v[248:251]
M v[248:251],a[148:151],a[172:175],v[248:251]
s_waitcnt lgkmcnt(0)
M v[252:255],a[156:159],a[172:175],v[252:255]
M v[252:255],a[152:155],a[168:171],v[252:255]
M a[0:3],a[32:35],a[160:163],a[0:3]
R a[168:171],v5,34816
R a[172:175],v6,34816
M a[0:3],a[36:39],a[164:167],a[0:3]
T a[96:97],v1,0
T a[98:99],v1,1024
M a[4:7],a[44:47],a[164:167],a[4:7]
SA m0,s24,16384
M a[4:7],a[40:43],a[160:163],a[4:7]
buffer_load_dwordx4 v12, s[48:51], s22 offen offset:0   lds
M a[8:11],a[48:51],a[160:163],a[8:11]
M a[8:11],a[52:55],a[164:167],a[8:11]
M a[12:15],a[60:63],a[164:167],a[12:15]
s_nop 0
T a[100:101],v1,8192
T a[102:103],v1,9216
M a[12:15],a[56:59],a[160:163],a[12:15]
M a[16:19],a[64:67],a[160:163],a[16:19]
buffer_load_dwordx4 v13, s[48:51], s22 offen offset:1024   lds
M a[16:19],a[68:71],a[164:167],a[16:19]
M a[20:23],a[76:79],a[164:167],a[20:23]
M a[20:23],a[72:75],a[160:163],a[20:23]
s_nop 0
T a[104:105],v2,0
T a[106:107],v2,1024
M a[24:27],a[80:83],a[160:163],a[24:27]
M a[24:27],a[84:87],a[164:167],a[24:27]
s_waitcnt lgkmcnt(6)
buffer_load_dwordx4 v14, s[48:51], s22 offen offset:2048   lds
M a[28:31],a[92:95],a[164:167],a[28:31]
M a[28:31],a[88:91],a[160:163],a[28:31]
M v[32:35],a[32:35],a[168:171],v[32:35]
R a[160:163],v5,36864
R a[164:167],v6,36864
M v[32:35],a[36:39],a[172:175],v[32:35]
T a[108:109],v2,8192
T a[110:111],v2,9216
M v[36:39],a[44:47],a[172:175],v[36:39]
buffer_load_dwordx4 v15, s[48:51], s22 offen offset:3072   lds
M v[36:39],a[40:43],a[168:171],v[36:39]
s_sub_u32 s22, s22, 1048448
M v[40:43],a[48:51],a[168:171],v[40:43]
M v[40:43],a[52:55],a[172:175],v[40:43]
s_nop 0
T a[112:113],v3,0
T a[114:115],v3,1024
M v[44:47],a[60:63],a[172:175],v[44:47]
SA m0,s23,49152
M v[44:47],a[56:59],a[168:171],v[44:47]
buffer_load_dwordx4 v8, s[16:19], s21 offen offset:0  nt lds
M v[48:51],a[64:67],a[168:171],v[48:51]
M v[48:51],a[68:71],a[172:175],v[48:51]
M v[52:55],a[76:79],a[172:175],v[52:55]
s_nop 0
T a[116:117],v3,8192
T a[118:119],v3,9216
M v[52:55],a[72:75],a[168:171],v[52:55]
M v[56:59],a[80:83],a[168:171],v[56:59]
buffer_load_dwordx4 v9, s[16:19], s21 offen offset:1024  nt lds
M v[56:59],a[84:87],a[172:175],v[56:59]
s_waitcnt lgkmcnt(6)
M v[60:63],a[92:95],a[172:175],v[60:63]
M v[60:63],a[88:91],a[168:171],v[60:63]
s_nop 0
T a[120:121],v4,0
T a[122:123],v4,1024
M v[64:67],a[32:35],a[160:163],v[64:67]
R a[168:171],v5,38912
R a[172:175],v6,38912
M v[64:67],a[36:39],a[164:167],v[64:67]
buffer_load_dwordx4 v10, s[16:19], s21 offen offset:2048  nt lds
M v[68:71],a[44:47],a[164:167],v[68:71]
M v[68:71],a[40:43],a[160:163],v[68:71]
M v[72:75],a[48:51],a[160:163],v[72:75]
s_nop 0
T a[124:125],v4,8192
T a[126:127],v4,9216
M v[72:75],a[52:55],a[164:167],v[72:75]
M v[76:79],a[60:63],a[164:167],v[76:79]
buffer_load_dwordx4 v11, s[16:19], s21 offen offset:3072  nt lds
M v[76:79],a[56:59],a[160:163],v[76:79]
SA s21,s21,524160
M v[80:83],a[64:67],a[160:163],v[80:83]
M v[80:83],a[68:71],a[164:167],v[80:83]
M v[84:87],a[76:79],a[164:167],v[84:87]
M v[84:87],a[72:75],a[160:163],v[84:87]
M v[88:91],a[80:83],a[160:163],v[88:91]
M v[88:91],a[84:87],a[164:167],v[88:91]
s_waitcnt lgkmcnt(2)
M v[92:95],a[92:95],a[164:167],v[92:95]
s_waitcnt vmcnt(24) lgkmcnt(0)
M v[92:95],a[88:91],a[160:163],v[92:95]
s_barrier
M v[96:99],a[32:35],a[168:171],v[96:99]
R a[160:163],v5,49152
R a[164:167],v6,49152
M v[96:99],a[36:39],a[172:175],v[96:99]
M v[100:103],a[44:47],a[172:175],v[100:103]
SA m0,s24,32768
T a[128:129],v1,16384
T a[130:131],v1,17408
M v[100:103],a[40:43],a[168:171],v[100:103]
buffer_load_dwordx4 v12, s[48:51], s22 offen offset:0   lds
M v[104:107],a[48:51],a[168:171],v[104:107]
s_nop 0
T a[176:177],v22,0
T a[178:179],v22,128
M v[104:107],a[52:55],a[172:175],v[104:107]
T a[180:181],v22,1024
T a[182:183],v22,1152
M v[108:111],a[60:63],a[172:175],v[108:111]
T a[184:185],v22,2048
T a[186:187],v22,2176
M v[108:111],a[56:59],a[168:171],v[108:111]
T a[188:189],v22,3072
T a[190:191],v22,3200
M v[112:115],a[64:67],a[168:171],v[112:115]
M v[112:115],a[68:71],a[172:175],v[112:115]
s_nop 0
T a[132:133],v1,24576
T a[134:135],v1,25600
M v[116:119],a[76:79],a[172:175],v[116:119]
buffer_load_dwordx4 v13, s[48:51], s22 offen offset:1024   lds
M v[116:119],a[72:75],a[168:171],v[116:119]
M v[120:123],a[80:83],a[168:171],v[120:123]
M v[120:123],a[84:87],a[172:175],v[120:123]
s_waitcnt lgkmcnt(12)
M v[124:127],a[92:95],a[172:175],v[124:127]
M v[124:127],a[88:91],a[168:171],v[124:127]
M v[128:131],a[32:35],a[160:163],v[128:131]
R a[168:171],v5,51200
R a[172:175],v6,51200
M v[128:131],a[36:39],a[164:167],v[128:131]
T a[136:137],v2,16384
T a[138:139],v2,17408
M v[132:135],a[44:47],a[164:167],v[132:135]
buffer_load_dwordx4 v14, s[48:51], s22 offen offset:2048   lds
M v[132:135],a[40:43],a[160:163],v[132:135]
M v[136:139],a[48:51],a[160:163],v[136:139]
M v[136:139],a[52:55],a[164:167],v[136:139]
M v[140:143],a[60:63],a[164:167],v[140:143]
M v[140:143],a[56:59],a[160:163],v[140:143]
s_nop 0
T a[140:141],v2,24576
T a[142:143],v2,25600
M v[144:147],a[64:67],a[160:163],v[144:147]
buffer_load_dwordx4 v15, s[48:51], s22 offen offset:3072   lds
M v[144:147],a[68:71],a[164:167],v[144:147]
SA s22,s22,1048576
M v[148:151],a[76:79],a[164:167],v[148:151]
M v[148:151],a[72:75],a[160:163],v[148:151]
M v[152:155],a[80:83],a[160:163],v[152:155]
M v[152:155],a[84:87],a[164:167],v[152:155]
s_waitcnt lgkmcnt(4)
M v[156:159],a[92:95],a[164:167],v[156:159]
SA m0,s23,0
T a[144:145],v3,16384
T a[146:147],v3,17408
M v[156:159],a[88:91],a[160:163],v[156:159]
buffer_load_dwordx4 v8, s[16:19], s21 offen offset:0  nt lds
s_waitcnt vmcnt(28)
M v[16:19],a[176:179],a[208:211],0
s_waitcnt vmcnt(26)
M v[16:19],a[180:183],a[212:215],v[16:19]
s_waitcnt vmcnt(25)
M v[16:19],a[184:187],a[216:219],v[16:19]
s_waitcnt vmcnt(23)
M v[16:19],a[188:191],a[220:223],v[16:19]
M v[160:163],a[32:35],a[168:171],v[160:163]
R a[160:163],v5,53248
R a[164:167],v6,53248
M v[160:163],a[36:39],a[172:175],v[160:163]
T a[176:177],v22,4096
T a[178:179],v22,4224
M v[164:167],a[44:47],a[172:175],v[164:167]
T a[180:181],v22,5120
T a[182:183],v22,5248
M v[164:167],a[40:43],a[168:171],v[164:167]
T a[184:185],v22,6144
T a[186:187],v22,6272
M v[168:171],a[48:51],a[168:171],v[168:171]
M v[168:171],a[52:55],a[172:175],v[168:171]
s_nop 0
T a[148:149],v3,24576
T a[150:151],v3,25600
M v[172:175],a[60:63],a[172:175],v[172:175]
buffer_load_dwordx4 v9, s[16:19], s21 offen offset:1024  nt lds
M v[172:175],a[56:59],a[168:171],v[172:175]
M v[176:179],a[64:67],a[168:171],v[176:179]
M v[176:179],a[68:71],a[172:175],v[176:179]
M v[180:183],a[76:79],a[172:175],v[180:183]
M v[180:183],a[72:75],a[168:171],v[180:183]
M v[184:187],a[80:83],a[168:171],v[184:187]
s_nop 0
T a[152:153],v4,16384
T a[154:155],v4,17408
M v[184:187],a[84:87],a[172:175],v[184:187]
s_waitcnt lgkmcnt(10)
buffer_load_dwordx4 v10, s[16:19], s21 offen offset:2048  nt lds
M v[188:191],a[92:95],a[172:175],v[188:191]
M v[188:191],a[88:91],a[168:171],v[188:191]
M v[192:195],a[32:35],a[160:163],v[192:195]
R a[168:171],v5,55296
R a[172:175],v6,55296
M v[192:195],a[36:39],a[164:167],v[192:195]
M v[196:199],a[44:47],a[164:167],v[196:199]
M v[196:199],a[40:43],a[160:163],v[196:199]
s_nop 0
T a[156:157],v4,24576
T a[158:159],v4,25600
M v[200:203],a[48:51],a[160:163],v[200:203]
buffer_load_dwordx4 v11, s[16:19], s21 offen offset:3072  nt lds
M v[200:203],a[52:55],a[164:167],v[200:203]
SA s21,s21,128
M v[204:207],a[60:63],a[164:167],v[204:207]
M v[204:207],a[56:59],a[160:163],v[204:207]
M v[208:211],a[64:67],a[160:163],v[208:211]
M v[208:211],a[68:71],a[164:167],v[208:211]
M v[212:215],a[76:79],a[164:167],v[212:215]
M v[212:215],a[72:75],a[160:163],v[212:215]
M v[216:219],a[80:83],a[160:163],v[216:219]
M v[216:219],a[84:87],a[164:167],v[216:219]
s_waitcnt lgkmcnt(2)
M v[220:223],a[92:95],a[164:167],v[220:223]
s_waitcnt vmcnt(16) lgkmcnt(0)
M v[220:223],a[88:91],a[160:163],v[220:223]
s_barrier
M v[16:19],a[176:179],a[224:227],v[16:19]
M v[16:19],a[180:183],a[228:231],v[16:19]
M v[16:19],a[184:187],a[232:235],v[16:19]
M v[224:227],a[32:35],a[168:171],v[224:227]
R a[160:163],v5,0
R a[164:167],v6,0
M v[224:227],a[36:39],a[172:175],v[224:227]
M v[228:231],a[44:47],a[172:175],v[228:231]
M v[228:231],a[40:43],a[168:171],v[228:231]
M v[232:235],a[48:51],a[168:171],v[232:235]
M v[232:235],a[52:55],a[172:175],v[232:235]
M v[236:239],a[60:63],a[172:175],v[236:239]
M v[236:239],a[56:59],a[168:171],v[236:239]
M v[240:243],a[64:67],a[168:171],v[240:243]
M v[240:243],a[68:71],a[172:175],v[240:243]
M v[244:247],a[76:79],a[172:175],v[244:247]
M v[244:247],a[72:75],a[168:171],v[244:247]
M v[248:251],a[80:83],a[168:171],v[248:251]
M v[248:251],a[84:87],a[172:175],v[248:251]
s_waitcnt lgkmcnt(0)
M v[252:255],a[92:95],a[172:175],v[252:255]
M v[252:255],a[88:91],a[168:171],v[252:255]
M a[0:3],a[96:99],a[160:163],a[0:3]
R a[168:171],v5,2048
R a[172:175],v6,2048
M a[0:3],a[100:103],a[164:167],a[0:3]
T a[32:33],v1,32768
T a[34:35],v1,33792
M a[4:7],a[108:111],a[164:167],a[4:7]
SA m0,s24,49152
M a[4:7],a[104:107],a[160:163],a[4:7]
buffer_load_dwordx4 v12, s[48:51], s22 offen offset:0   lds
M a[8:11],a[112:115],a[160:163],a[8:11]
M a[8:11],a[116:119],a[164:167],a[8:11]
s_lshl_b32 s64, s20, 10
M a[12:15],a[124:127],a[164:167],a[12:15]
SA s64,s64,159744
T a[36:37],v1,40960
T a[38:39],v1,41984
M a[12:15],a[120:123],a[160:163],a[12:15]
v_add_u32 v21, s64, v7
ds_write_b128 v21, v[16:19]
M a[16:19],a[128:131],a[160:163],a[16:19]
s_mul_i32 s67, s86, 14336
buffer_load_dwordx4 v13, s[48:51], s22 offen offset:1024   lds
M a[16:19],a[132:135],a[164:167],a[16:19]
s_mul_i32 s64, s20, 224
M a[20:23],a[140:143],a[164:167],a[20:23]
SA s67,s67,s64
v_lshrrev_b32 v28, 4, v0
v_mul_u32_u24 v28, 896, v28
M a[20:23],a[136:139],a[160:163],a[20:23]
T a[40:41],v2,32768
T a[42:43],v2,33792
M a[24:27],a[144:147],a[160:163],a[24:27]
v_and_b32 v29, 15, v0
v_lshl_add_u32 v28, v29, 4, v28
M a[24:27],a[148:151],a[164:167],a[24:27]
s_waitcnt lgkmcnt(7)
buffer_load_dwordx4 v14, s[48:51], s22 offen offset:2048   lds
M a[28:31],a[156:159],a[164:167],a[28:31]
v_mov_b32 v30, 536870912
v_cmp_gt_u32 vcc, 14, v29
M a[28:31],a[152:155],a[160:163],a[28:31]
s_nop 0
M v[32:35],a[96:99],a[168:171],v[32:35]
s_nop 0
R a[160:163],v5,4096
R a[164:167],v6,4096
M v[32:35],a[100:103],a[172:175],v[32:35]
T a[44:45],v2,40960
T a[46:47],v2,41984
M v[36:39],a[108:111],a[172:175],v[36:39]
buffer_load_dwordx4 v15, s[48:51], s22 offen offset:3072   lds
M v[36:39],a[104:107],a[168:171],v[36:39]
s_sub_u32 s22, s22, 1048448
v_cndmask_b32 v28, v30, v28, vcc
v_add_u32 v29, 2560, v28
M v[40:43],a[112:115],a[168:171],v[40:43]
v_add_u32 v30, 5120, v28
v_add_u32 v31, 7680, v28
M v[40:43],a[116:119],a[172:175],v[40:43]
T a[48:49],v3,32768
T a[50:51],v3,33792
M v[44:47],a[124:127],a[172:175],v[44:47]
SA m0,s23,16384
M v[44:47],a[120:123],a[168:171],v[44:47]
buffer_load_dwordx4 v8, s[16:19], s21 offen offset:0  nt lds
M v[48:51],a[128:131],a[168:171],v[48:51]
M v[48:51],a[132:135],a[172:175],v[48:51]
M v[52:55],a[140:143],a[172:175],v[52:55]
s_nop 0
T a[52:53],v3,40960
T a[54:55],v3,41984
M v[52:55],a[136:139],a[168:171],v[52:55]
M v[56:59],a[144:147],a[168:171],v[56:59]
buffer_load_dwordx4 v9, s[16:19], s21 offen offset:1024  nt lds
M v[56:59],a[148:151],a[172:175],v[56:59]
s_waitcnt lgkmcnt(6)
M v[60:63],a[156:159],a[172:175],v[60:63]
M v[60:63],a[152:155],a[168:171],v[60:63]
s_nop 0
T a[56:57],v4,32768
T a[58:59],v4,33792
M v[64:67],a[96:99],a[160:163],v[64:67]
R a[168:171],v5,6144
R a[172:175],v6,6144
M v[64:67],a[100:103],a[164:167],v[64:67]
buffer_load_dwordx4 v10, s[16:19], s21 offen offset:2048  nt lds
M v[68:71],a[108:111],a[164:167],v[68:71]
M v[68:71],a[104:107],a[160:163],v[68:71]
M v[72:75],a[112:115],a[160:163],v[72:75]
s_nop 0
T a[60:61],v4,40960
T a[62:63],v4,41984
M v[72:75],a[116:119],a[164:167],v[72:75]
M v[76:79],a[124:127],a[164:167],v[76:79]
buffer_load_dwordx4 v11, s[16:19], s21 offen offset:3072  nt lds
M v[76:79],a[120:123],a[160:163],v[76:79]
SA s21,s21,524160
M v[80:83],a[128:131],a[160:163],v[80:83]
M v[80:83],a[132:135],a[164:167],v[80:83]
M v[84:87],a[140:143],a[164:167],v[84:87]
M v[84:87],a[136:139],a[160:163],v[84:87]
M v[88:91],a[144:147],a[160:163],v[88:91]
M v[88:91],a[148:151],a[164:167],v[88:91]
s_waitcnt lgkmcnt(2)
M v[92:95],a[156:159],a[164:167],v[92:95]
s_waitcnt vmcnt(16) lgkmcnt(0)
M v[92:95],a[152:155],a[160:163],v[92:95]
s_barrier
M v[96:99],a[96:99],a[168:171],v[96:99]
R a[160:163],v5,16384
R a[164:167],v6,16384
M v[96:99],a[100:103],a[172:175],v[96:99]
M v[100:103],a[108:111],a[172:175],v[100:103]
SA m0,s24,0
T a[64:65],v1,49152
T a[66:67],v1,50176
M v[100:103],a[104:107],a[168:171],v[100:103]
buffer_load_dwordx4 v12, s[48:51], s22 offen offset:0   lds
M v[104:107],a[112:115],a[168:171],v[104:107]
M v[104:107],a[116:119],a[172:175],v[104:107]
M v[108:111],a[124:127],a[172:175],v[108:111]
M v[108:111],a[120:123],a[168:171],v[108:111]
buffer_load_dwordx4 v13, s[48:51], s22 offen offset:1024   lds
M v[112:115],a[128:131],a[168:171],v[112:115]
M v[112:115],a[132:135],a[172:175],v[112:115]
s_nop 0
T a[68:69],v1,57344
T a[70:71],v1,58368
M v[116:119],a[140:143],a[172:175],v[116:119]
M v[116:119],a[136:139],a[168:171],v[116:119]
M v[120:123],a[144:147],a[168:171],v[120:123]
buffer_load_dwordx4 v14, s[48:51], s22 offen offset:2048   lds
M v[120:123],a[148:151],a[172:175],v[120:123]
s_waitcnt lgkmcnt(4)
M v[124:127],a[156:159],a[172:175],v[124:127]
M v[124:127],a[152:155],a[168:171],v[124:127]
M v[128:131],a[96:99],a[160:163],v[128:131]
R a[168:171],v5,18432
R a[172:175],v6,18432
M v[128:131],a[100:103],a[164:167],v[128:131]
T a[72:73],v2,49152
T a[74:75],v2,50176
M v[132:135],a[108:111],a[164:167],v[132:135]
buffer_load_dwordx4 v15, s[48:51], s22 offen offset:3072   lds
M v[132:135],a[104:107],a[160:163],v[132:135]
SA s22,s22,1048576
M v[136:139],a[112:115],a[160:163],v[136:139]
M v[136:139],a[116:119],a[164:167],v[136:139]
SA m0,s23,32768
M v[140:143],a[124:127],a[164:167],v[140:143]
buffer_load_dwordx4 v8, s[16:19], s21 offen offset:0  nt lds
M v[140:143],a[120:123],a[160:163],v[140:143]
s_nop 0
T a[76:77],v2,57344
T a[78:79],v2,58368
M v[144:147],a[128:131],a[160:163],v[144:147]
M v[144:147],a[132:135],a[164:167],v[144:147]
M v[148:151],a[140:143],a[164:167],v[148:151]
buffer_load_dwordx4 v9, s[16:19], s21 offen offset:1024  nt lds
M v[148:151],a[136:139],a[160:163],v[148:151]
M v[152:155],a[144:147],a[160:163],v[152:155]
M v[152:155],a[148:151],a[164:167],v[152:155]
s_waitcnt lgkmcnt(4)
M v[156:159],a[156:159],a[164:167],v[156:159]
s_nop 0
T a[80:81],v3,49152
T a[82:83],v3,50176
M v[156:159],a[152:155],a[160:163],v[156:159]
buffer_load_dwordx4 v10, s[16:19], s21 offen offset:2048  nt lds
M v[160:163],a[96:99],a[168:171],v[160:163]
R a[160:163],v5,20480
R a[164:167],v6,20480
M v[160:163],a[100:103],a[172:175],v[160:163]
M v[164:167],a[108:111],a[172:175],v[164:167]
M v[164:167],a[104:107],a[168:171],v[164:167]
M v[168:171],a[112:115],a[168:171],v[168:171]
buffer_load_dwordx4 v11, s[16:19], s21 offen offset:3072  nt lds
M v[168:171],a[116:119],a[172:175],v[168:171]
SA s21,s21,128
T a[84:85],v3,57344
T a[86:87],v3,58368
M v[172:175],a[124:127],a[172:175],v[172:175]
M v[172:175],a[120:123],a[168:171],v[172:175]
M v[176:179],a[128:131],a[168:171],v[176:179]
SA m0,s87,0
M v[176:179],a[132:135],a[172:175],v[176:179]
buffer_load_dwordx4 v28, s[68:71], s67 offen offset:0 nt lds
M v[180:183],a[140:143],a[172:175],v[180:183]
M v[180:183],a[136:139],a[168:171],v[180:183]
M v[184:187],a[144:147],a[168:171],v[184:187]
s_nop 0
T a[88:89],v4,49152
T a[90:91],v4,50176
M v[184:187],a[148:151],a[172:175],v[184:187]
s_waitcnt lgkmcnt(4)
buffer_load_dwordx4 v29, s[68:71], s67 offen offset:1024 nt lds
M v[188:191],a[156:159],a[172:175],v[188:191]
M v[188:191],a[152:155],a[168:171],v[188:191]
M v[192:195],a[96:99],a[160:163],v[192:195]
R a[168:171],v5,22528
R a[172:175],v6,22528
M v[192:195],a[100:103],a[164:167],v[192:195]
M v[196:199],a[108:111],a[164:167],v[196:199]
buffer_load_dwordx4 v30, s[68:71], s67 offen offset:2048 nt lds
M v[196:199],a[104:107],a[160:163],v[196:199]
s_nop 0
T a[92:93],v4,57344
T a[94:95],v4,58368
M v[200:203],a[112:115],a[160:163],v[200:203]
M v[200:203],a[116:119],a[164:167],v[200:203]
M v[204:207],a[124:127],a[164:167],v[204:207]
L_w_kv05:
s_cbranch_execz L_wd1
M v[204:207],a[120:123],a[160:163],v[204:207]
buffer_load_dwordx4 v31, s[68:71], s67 offen offset:3072 nt lds
M v[208:211],a[128:131],a[160:163],v[208:211]
SA s67,s67,0
M v[208:211],a[132:135],a[164:167],v[208:211]
M v[212:215],a[140:143],a[164:167],v[212:215]
M v[212:215],a[136:139],a[160:163],v[212:215]
M v[216:219],a[144:147],a[160:163],v[216:219]
M v[216:219],a[148:151],a[164:167],v[216:219]
s_waitcnt lgkmcnt(2)
M v[220:223],a[156:159],a[164:167],v[220:223]
s_waitcnt vmcnt(20) lgkmcnt(0)
M v[220:223],a[152:155],a[160:163],v[220:223]
s_barrier
M v[224:227],a[96:99],a[168:171],v[224:227]
R a[160:163],v5,32768
R a[164:167],v6,32768
M v[224:227],a[100:103],a[172:175],v[224:227]
M v[228:231],a[108:111],a[172:175],v[228:231]
M v[228:231],a[104:107],a[168:171],v[228:231]
M v[232:235],a[112:115],a[168:171],v[232:235]
M v[232:235],a[116:119],a[172:175],v[232:235]
M v[236:239],a[124:127],a[172:175],v[236:239]
M v[236:239],a[120:123],a[168:171],v[236:239]
M v[240:243],a[128:131],a[168:171],v[240:243]
M v[240:243],a[132:135],a[172:175],v[240:243]
M v[244:247],a[140:143],a[172:175],v[244:247]
M v[244:247],a[136:139],a[168:171],v[244:247]
M v[248:251],a[144:147],a[168:171],v[248:251]
M v[248:251],a[148:151],a[172:175],v[248:251]
s_waitcnt lgkmcnt(0)
M v[252:255],a[156:159],a[172:175],v[252:255]
M v[252:255],a[152:155],a[168:171],v[252:255]
M a[0:3],a[32:35],a[160:163],a[0:3]
R a[168:171],v5,34816
R a[172:175],v6,34816
M a[0:3],a[36:39],a[164:167],a[0:3]
T a[96:97],v1,0
T a[98:99],v1,1024
M a[4:7],a[44:47],a[164:167],a[4:7]
SA m0,s24,16384
C v23,v23,v23
M a[4:7],a[40:43],a[160:163],a[4:7]
buffer_load_dwordx4 v12, s[48:51], s22 offen offset:0   lds
M a[8:11],a[48:51],a[160:163],a[8:11]
v_and_b32 v23, 0xffff0000, v23
M a[8:11],a[52:55],a[164:167],a[8:11]
MF v22,0xbfb8aa3b,v23
M a[12:15],a[60:63],a[164:167],a[12:15]
s_nop 0
T a[100:101],v1,8192
T a[102:103],v1,9216
M a[12:15],a[56:59],a[160:163],a[12:15]
E v22,v22
M a[16:19],a[64:67],a[160:163],a[16:19]
buffer_load_dwordx4 v13, s[48:51], s22 offen offset:1024   lds
M a[16:19],a[68:71],a[164:167],a[16:19]
AF v22,1.0,v22
M a[20:23],a[76:79],a[164:167],a[20:23]
v_rcp_f32 v23, v22
M a[20:23],a[72:75],a[160:163],a[20:23]
s_or_b32 s64, s31, s20
T a[104:105],v2,0
T a[106:107],v2,1024
M a[24:27],a[80:83],a[160:163],a[24:27]
s_min_u32 s64, s64, 1
s_lshl_b32 s64, s64, 29
v_lshrrev_b32 v22, 1, v0
M a[24:27],a[84:87],a[164:167],a[24:27]
s_waitcnt lgkmcnt(6)
buffer_load_dwordx4 v14, s[48:51], s22 offen offset:2048   lds
M a[28:31],a[92:95],a[164:167],a[28:31]
v_min_u32 v22, 1, v22
M a[28:31],a[88:91],a[160:163],a[28:31]
v_lshlrev_b32 v22, 29, v22
M v[32:35],a[32:35],a[168:171],v[32:35]
R a[160:163],v5,36864
R a[164:167],v6,36864
M v[32:35],a[36:39],a[172:175],v[32:35]
T a[108:109],v2,8192
T a[110:111],v2,9216
M v[36:39],a[44:47],a[172:175],v[36:39]
buffer_load_dwordx4 v15, s[48:51], s22 offen offset:3072   lds
M v[36:39],a[40:43],a[168:171],v[36:39]
s_sub_u32 s22, s22, 1048448
v_lshl_or_b32 v22, v0, 2, v22
M v[40:43],a[48:51],a[168:171],v[40:43]
v_or_b32 v22, s64, v22
M v[40:43],a[52:55],a[172:175],v[40:43]
s_nop 0
T a[112:113],v3,0
T a[114:115],v3,1024
M v[44:47],a[60:63],a[172:175],v[44:47]
SA m0,s23,49152
C v23,v23,v23
M v[44:47],a[56:59],a[168:171],v[44:47]
buffer_load_dwordx4 v8, s[16:19], s21 offen offset:0  nt lds
M v[48:51],a[64:67],a[168:171],v[48:51]
v_and_b32 v23, 0xffff0000, v23
M v[48:51],a[68:71],a[172:175],v[48:51]
s_lshl_b32 s64, s41, 7
M v[52:55],a[76:79],a[172:175],v[52:55]
SA s64,s64,104890368
T a[116:117],v3,8192
T a[118:119],v3,9216
M v[52:55],a[72:75],a[168:171],v[52:55]
buffer_store_dword v24, v22, s[8:11], s64 offen sc1
M v[56:59],a[80:83],a[168:171],v[56:59]
buffer_load_dwordx4 v9, s[16:19], s21 offen offset:1024  nt lds
M v[56:59],a[84:87],a[172:175],v[56:59]
s_waitcnt lgkmcnt(6)
buffer_store_dword v23, v22, s[8:11], s64 offen offset:8 sc1
M v[60:63],a[92:95],a[172:175],v[60:63]
v_add_u32 v25, 159744, v7
M v[60:63],a[88:91],a[168:171],v[60:63]
s_nop 0
T a[120:121],v4,0
T a[122:123],v4,1024
M v[64:67],a[32:35],a[160:163],v[64:67]
R a[168:171],v5,38912
R a[172:175],v6,38912
M v[64:67],a[36:39],a[164:167],v[64:67]
buffer_load_dwordx4 v10, s[16:19], s21 offen offset:2048  nt lds
M v[68:71],a[44:47],a[164:167],v[68:71]
ds_read_b128 v[16:19], v25
M v[68:71],a[40:43],a[160:163],v[68:71]
R v[28:31],v25,1024
M v[72:75],a[48:51],a[160:163],v[72:75]
s_nop 0
T a[124:125],v4,8192
T a[126:127],v4,9216
M v[72:75],a[52:55],a[164:167],v[72:75]
R v[20:23],v25,2048
M v[76:79],a[60:63],a[164:167],v[76:79]
buffer_load_dwordx4 v11, s[16:19], s21 offen offset:3072  nt lds
M v[76:79],a[56:59],a[160:163],v[76:79]
SA s21,s21,524160
M v[80:83],a[64:67],a[160:163],v[80:83]
M v[80:83],a[68:71],a[164:167],v[80:83]
M v[84:87],a[76:79],a[164:167],v[84:87]
M v[84:87],a[72:75],a[160:163],v[84:87]
M v[88:91],a[80:83],a[160:163],v[88:91]
M v[88:91],a[84:87],a[164:167],v[88:91]
s_waitcnt lgkmcnt(5)
s_waitcnt lgkmcnt(3)
AF v16,v28,v16
M v[92:95],a[92:95],a[164:167],v[92:95]
s_waitcnt vmcnt(22) lgkmcnt(0)
AF v17,v29,v17
M v[92:95],a[88:91],a[160:163],v[92:95]
s_barrier
M v[96:99],a[32:35],a[168:171],v[96:99]
R a[160:163],v5,49152
R a[164:167],v6,49152
M v[96:99],a[36:39],a[172:175],v[96:99]
AF v18,v30,v18
M v[100:103],a[44:47],a[172:175],v[100:103]
SA m0,s24,32768
T a[128:129],v1,16384
T a[130:131],v1,17408
M v[100:103],a[40:43],a[168:171],v[100:103]
buffer_load_dwordx4 v12, s[48:51], s22 offen offset:0   lds
M v[104:107],a[48:51],a[168:171],v[104:107]
AF v19,v31,v19
M v[104:107],a[52:55],a[172:175],v[104:107]
R v[28:31],v25,3072
M v[108:111],a[60:63],a[172:175],v[108:111]
C v25,v16,v17
M v[108:111],a[56:59],a[168:171],v[108:111]
v_lshlrev_b32 v16, 16, v25
M v[112:115],a[64:67],a[168:171],v[112:115]
v_and_b32 v17, 0xffff0000, v25
M v[112:115],a[68:71],a[172:175],v[112:115]
s_nop 0
T a[132:133],v1,24576
T a[134:135],v1,25600
M v[116:119],a[76:79],a[172:175],v[116:119]
buffer_load_dwordx4 v13, s[48:51], s22 offen offset:1024   lds
M v[116:119],a[72:75],a[168:171],v[116:119]
C v25,v18,v19
M v[120:123],a[80:83],a[168:171],v[120:123]
v_lshlrev_b32 v18, 16, v25
M v[120:123],a[84:87],a[172:175],v[120:123]
s_waitcnt lgkmcnt(5)
v_and_b32 v19, 0xffff0000, v25
M v[124:127],a[92:95],a[172:175],v[124:127]
s_waitcnt lgkmcnt(2)
AF v20,v28,v20
M v[124:127],a[88:91],a[168:171],v[124:127]
AF v21,v29,v21
M v[128:131],a[32:35],a[160:163],v[128:131]
R a[168:171],v5,51200
R a[172:175],v6,51200
M v[128:131],a[36:39],a[164:167],v[128:131]
T a[136:137],v2,16384
T a[138:139],v2,17408
M v[132:135],a[44:47],a[164:167],v[132:135]
buffer_load_dwordx4 v14, s[48:51], s22 offen offset:2048   lds
M v[132:135],a[40:43],a[160:163],v[132:135]
AF v22,v30,v22
M v[136:139],a[48:51],a[160:163],v[136:139]
AF v23,v31,v23
M v[136:139],a[52:55],a[164:167],v[136:139]
MF v28,0xbfb8aa3b,v16
M v[140:143],a[60:63],a[164:167],v[140:143]
MF v29,0xbfb8aa3b,v17
M v[140:143],a[56:59],a[160:163],v[140:143]
s_nop 0
T a[140:141],v2,24576
T a[142:143],v2,25600
M v[144:147],a[64:67],a[160:163],v[144:147]
buffer_load_dwordx4 v15, s[48:51], s22 offen offset:3072   lds
M v[144:147],a[68:71],a[164:167],v[144:147]
SA s22,s22,1048576
MF v30,0xbfb8aa3b,v18
M v[148:151],a[76:79],a[164:167],v[148:151]
MF v31,0xbfb8aa3b,v19
M v[148:151],a[72:75],a[160:163],v[148:151]
E v28,v28
M v[152:155],a[80:83],a[160:163],v[152:155]
E v29,v29
M v[152:155],a[84:87],a[164:167],v[152:155]
s_waitcnt lgkmcnt(4)
E v30,v30
M v[156:159],a[92:95],a[164:167],v[156:159]
SA m0,s23,0
T a[144:145],v3,16384
T a[146:147],v3,17408
M v[156:159],a[88:91],a[160:163],v[156:159]
buffer_load_dwordx4 v8, s[16:19], s21 offen offset:0  nt lds
M v[160:163],a[32:35],a[168:171],v[160:163]
R a[160:163],v5,53248
R a[164:167],v6,53248
M v[160:163],a[36:39],a[172:175],v[160:163]
E v31,v31
M v[164:167],a[44:47],a[172:175],v[164:167]
C v25,v20,v21
M v[164:167],a[40:43],a[168:171],v[164:167]
v_lshlrev_b32 v20, 16, v25
M v[168:171],a[48:51],a[168:171],v[168:171]
v_and_b32 v21, 0xffff0000, v25
M v[168:171],a[52:55],a[172:175],v[168:171]
s_nop 0
T a[148:149],v3,24576
T a[150:151],v3,25600
M v[172:175],a[60:63],a[172:175],v[172:175]
buffer_load_dwordx4 v9, s[16:19], s21 offen offset:1024  nt lds
M v[172:175],a[56:59],a[168:171],v[172:175]
C v25,v22,v23
M v[176:179],a[64:67],a[168:171],v[176:179]
v_lshlrev_b32 v22, 16, v25
M v[176:179],a[68:71],a[172:175],v[176:179]
v_and_b32 v23, 0xffff0000, v25
M v[180:183],a[76:79],a[172:175],v[180:183]
AF v28,1.0,v28
M v[180:183],a[72:75],a[168:171],v[180:183]
AF v29,1.0,v29
M v[184:187],a[80:83],a[168:171],v[184:187]
s_nop 0
T a[152:153],v4,16384
T a[154:155],v4,17408
M v[184:187],a[84:87],a[172:175],v[184:187]
s_waitcnt lgkmcnt(4)
buffer_load_dwordx4 v10, s[16:19], s21 offen offset:2048  nt lds
M v[188:191],a[92:95],a[172:175],v[188:191]
AF v30,1.0,v30
M v[188:191],a[88:91],a[168:171],v[188:191]
AF v31,1.0,v31
M v[192:195],a[32:35],a[160:163],v[192:195]
R a[168:171],v5,55296
R a[172:175],v6,55296
M v[192:195],a[36:39],a[164:167],v[192:195]
v_rcp_f32 v28, v28
M v[196:199],a[44:47],a[164:167],v[196:199]
v_rcp_f32 v29, v29
M v[196:199],a[40:43],a[160:163],v[196:199]
T a[156:157],v4,24576
T a[158:159],v4,25600
M v[200:203],a[48:51],a[160:163],v[200:203]
buffer_load_dwordx4 v11, s[16:19], s21 offen offset:3072  nt lds
M v[200:203],a[52:55],a[164:167],v[200:203]
SA s21,s21,128
v_rcp_f32 v30, v30
M v[204:207],a[60:63],a[164:167],v[204:207]
v_rcp_f32 v31, v31
M v[204:207],a[56:59],a[160:163],v[204:207]
MF v16,v28,v16
M v[208:211],a[64:67],a[160:163],v[208:211]
MF v17,v29,v17
M v[208:211],a[68:71],a[164:167],v[208:211]
MF v18,v30,v18
M v[212:215],a[76:79],a[164:167],v[212:215]
MF v19,v31,v19
M v[212:215],a[72:75],a[160:163],v[212:215]
C v25,v16,v17
M v[216:219],a[80:83],a[160:163],v[216:219]
v_lshlrev_b32 v16, 16, v25
M v[216:219],a[84:87],a[164:167],v[216:219]
s_waitcnt lgkmcnt(2)
v_and_b32 v17, 0xffff0000, v25
M v[220:223],a[92:95],a[164:167],v[220:223]
s_waitcnt vmcnt(22) lgkmcnt(0)
C v25,v18,v19
M v[220:223],a[88:91],a[160:163],v[220:223]
s_barrier
M v[224:227],a[32:35],a[168:171],v[224:227]
R a[160:163],v5,0
R a[164:167],v6,0
M v[224:227],a[36:39],a[172:175],v[224:227]
v_lshlrev_b32 v18, 16, v25
M v[228:231],a[44:47],a[172:175],v[228:231]
v_and_b32 v19, 0xffff0000, v25
M v[228:231],a[40:43],a[168:171],v[228:231]
MF v16,v20,v16
M v[232:235],a[48:51],a[168:171],v[232:235]
MF v17,v21,v17
M v[232:235],a[52:55],a[172:175],v[232:235]
MF v18,v22,v18
M v[236:239],a[60:63],a[172:175],v[236:239]
MF v19,v23,v19
M v[236:239],a[56:59],a[168:171],v[236:239]
C v16,v16,v17
M v[240:243],a[64:67],a[168:171],v[240:243]
C v17,v18,v19
M v[240:243],a[68:71],a[172:175],v[240:243]
M v[244:247],a[76:79],a[172:175],v[244:247]
M v[244:247],a[72:75],a[168:171],v[244:247]
M v[248:251],a[80:83],a[168:171],v[248:251]
M v[248:251],a[84:87],a[172:175],v[248:251]
s_waitcnt lgkmcnt(0)
M v[252:255],a[92:95],a[172:175],v[252:255]
M v[252:255],a[88:91],a[168:171],v[252:255]
M a[0:3],a[96:99],a[160:163],a[0:3]
R a[168:171],v5,2048
R a[172:175],v6,2048
M a[0:3],a[100:103],a[164:167],a[0:3]
T a[32:33],v1,32768
T a[34:35],v1,33792
M a[4:7],a[108:111],a[164:167],a[4:7]
SA m0,s24,49152
v_lshrrev_b32 v28, 4, v0
v_and_b32 v29, 7, v0
M a[4:7],a[104:107],a[160:163],a[4:7]
buffer_load_dwordx4 v12, s[48:51], s22 offen offset:0   lds
M a[8:11],a[112:115],a[160:163],a[8:11]
v_xor_b32 v28, v28, v29
v_lshlrev_b32 v28, 4, v28
M a[8:11],a[116:119],a[164:167],a[8:11]
v_lshrrev_b32 v29, 3, v0
v_mul_u32_u24 v29, 896, v29
M a[12:15],a[124:127],a[164:167],a[12:15]
T a[36:37],v1,40960
T a[38:39],v1,41984
M a[12:15],a[120:123],a[160:163],a[12:15]
v_add_u32 v22, v28, v29
v_xor_b32 v28, 64, v28
M a[16:19],a[128:131],a[160:163],a[16:19]
s_mul_i32 s64, s20, 14336
buffer_load_dwordx4 v13, s[48:51], s22 offen offset:1024   lds
M a[16:19],a[132:135],a[164:167],a[16:19]
s_sub_u32 s65, 98304, s64
M a[20:23],a[140:143],a[164:167],a[20:23]
SA s30,s29,s65
M a[20:23],a[136:139],a[160:163],a[20:23]
SA s29,s29,s64
T a[40:41],v2,32768
T a[42:43],v2,33792
M a[24:27],a[144:147],a[160:163],a[24:27]
v_add_u32 v29, 6144, v29
v_add_u32 v23, v28, v29
M a[24:27],a[148:151],a[164:167],a[24:27]
s_waitcnt lgkmcnt(6)
buffer_load_dwordx4 v14, s[48:51], s22 offen offset:2048   lds
M a[28:31],a[156:159],a[164:167],a[28:31]
s_and_b32 s64, s20, 1
M a[28:31],a[152:155],a[160:163],a[28:31]
s_lshl_b32 s64, s64, 12
M v[32:35],a[96:99],a[168:171],v[32:35]
SA s64,s64,65536
R a[160:163],v5,4096
R a[164:167],v6,4096
M v[32:35],a[100:103],a[172:175],v[32:35]
T a[44:45],v2,40960
T a[46:47],v2,41984
M v[36:39],a[108:111],a[172:175],v[36:39]
buffer_load_dwordx4 v15, s[48:51], s22 offen offset:3072   lds
M v[36:39],a[104:107],a[168:171],v[36:39]
s_sub_u32 s22, s22, 1048448
v_add_u32 v20, s64, v5
v_add_u32 v21, s64, v6
M v[40:43],a[112:115],a[168:171],v[40:43]
v_lshrrev_b32 v28, 2, v0
v_lshlrev_b32 v28, 8, v28
M v[40:43],a[116:119],a[172:175],v[40:43]
T a[48:49],v3,32768
T a[50:51],v3,33792
M v[44:47],a[124:127],a[172:175],v[44:47]
SA m0,s23,16384
v_and_b32 v29, 3, v0
v_lshl_add_u32 v28, v29, 3, v28
M v[44:47],a[120:123],a[168:171],v[44:47]
buffer_load_dwordx4 v8, s[16:19], s21 offen offset:0  nt lds
M v[48:51],a[128:131],a[168:171],v[48:51]
v_add_u32 v28, s87, v28
M v[48:51],a[132:135],a[172:175],v[48:51]
s_waitcnt vmcnt(23)
s_nop 0
T a[176:177],v28,0
T a[178:179],v28,32
M v[52:55],a[140:143],a[172:175],v[52:55]
T a[52:53],v3,40960
T a[54:55],v3,41984
M v[52:55],a[136:139],a[168:171],v[52:55]
T a[180:181],v28,64
T a[182:183],v28,96
M v[56:59],a[144:147],a[168:171],v[56:59]
buffer_load_dwordx4 v9, s[16:19], s21 offen offset:1024  nt lds
M v[56:59],a[148:151],a[172:175],v[56:59]
s_waitcnt lgkmcnt(10)
s_nop 0
T a[184:185],v28,128
T a[186:187],v28,160
M v[60:63],a[156:159],a[172:175],v[60:63]
T a[188:189],v28,192
M v[60:63],a[152:155],a[168:171],v[60:63]
s_nop 0
T a[56:57],v4,32768
T a[58:59],v4,33792
M v[64:67],a[96:99],a[160:163],v[64:67]
R a[168:171],v5,6144
R a[172:175],v6,6144
M v[64:67],a[100:103],a[164:167],v[64:67]
buffer_load_dwordx4 v10, s[16:19], s21 offen offset:2048  nt lds
s_waitcnt lgkmcnt(12)
v_mfma_f32_16x16x16_bf16 a[192:195], a[176:177], v[16:17], 0
M v[68:71],a[108:111],a[164:167],v[68:71]
v_mov_b32 v18, v16 row_shr:2 row_mask:0xf bank_mask:0xf bound_ctrl:0
v_mov_b32 v19, v17 row_shr:2 row_mask:0xf bank_mask:0xf bound_ctrl:0
M v[68:71],a[104:107],a[160:163],v[68:71]
M v[72:75],a[112:115],a[160:163],v[72:75]
s_nop 0
T a[60:61],v4,40960
T a[62:63],v4,41984
M v[72:75],a[116:119],a[164:167],v[72:75]
s_waitcnt lgkmcnt(13)
v_mfma_f32_16x16x16_bf16 a[192:195], a[178:179], v[18:19], a[192:195]
M v[76:79],a[124:127],a[164:167],v[76:79]
buffer_load_dwordx4 v11, s[16:19], s21 offen offset:3072  nt lds
M v[76:79],a[120:123],a[160:163],v[76:79]
SA s21,s21,524160
v_mov_b32 v16, v18 row_shr:2 row_mask:0xf bank_mask:0xf bound_ctrl:0
v_mov_b32 v17, v19 row_shr:2 row_mask:0xf bank_mask:0xf bound_ctrl:0
M v[80:83],a[128:131],a[160:163],v[80:83]
M v[80:83],a[132:135],a[164:167],v[80:83]
s_waitcnt lgkmcnt(10)
v_mfma_f32_16x16x16_bf16 a[192:195], a[180:181], v[16:17], a[192:195]
M v[84:87],a[140:143],a[164:167],v[84:87]
v_mov_b32 v18, v16 row_shr:2 row_mask:0xf bank_mask:0xf bound_ctrl:0
v_mov_b32 v19, v17 row_shr:2 row_mask:0xf bank_mask:0xf bound_ctrl:0
M v[84:87],a[136:139],a[160:163],v[84:87]
M v[88:91],a[144:147],a[160:163],v[88:91]
M v[88:91],a[148:151],a[164:167],v[88:91]
s_waitcnt lgkmcnt(2)
v_mfma_f32_16x16x16_bf16 a[192:195], a[182:183], v[18:19], a[192:195]
M v[92:95],a[156:159],a[164:167],v[92:95]
s_waitcnt vmcnt(16) lgkmcnt(0)
v_mov_b32 v16, v18 row_shr:2 row_mask:0xf bank_mask:0xf bound_ctrl:0
v_mov_b32 v17, v19 row_shr:2 row_mask:0xf bank_mask:0xf bound_ctrl:0
M v[92:95],a[152:155],a[160:163],v[92:95]
s_barrier
M v[96:99],a[96:99],a[168:171],v[96:99]
R a[160:163],v5,16384
R a[164:167],v6,16384
M v[96:99],a[100:103],a[172:175],v[96:99]
SA m0,s23,131072
v_mfma_f32_16x16x16_bf16 a[192:195], a[184:185], v[16:17], a[192:195]
M v[100:103],a[108:111],a[172:175],v[100:103]
s_nop 0
T a[64:65],v1,49152
T a[66:67],v1,50176
M v[100:103],a[104:107],a[168:171],v[100:103]
v_mov_b32 v18, v16 row_shr:2 row_mask:0xf bank_mask:0xf bound_ctrl:0
v_mov_b32 v19, v17 row_shr:2 row_mask:0xf bank_mask:0xf bound_ctrl:0
M v[104:107],a[112:115],a[168:171],v[104:107]
buffer_load_dwordx4 v22, s[56:59], s29 offen offset:0 lds
M v[104:107],a[116:119],a[172:175],v[104:107]
v_mfma_f32_16x16x16_bf16 a[192:195], a[186:187], v[18:19], a[192:195]
M v[108:111],a[124:127],a[172:175],v[108:111]
v_mov_b32 v16, v18 row_shr:2 row_mask:0xf bank_mask:0xf bound_ctrl:0
v_mov_b32 v17, v19 row_shr:2 row_mask:0xf bank_mask:0xf bound_ctrl:0
M v[108:111],a[120:123],a[168:171],v[108:111]
buffer_load_dwordx4 v23, s[56:59], s29 offen offset:1024 lds
M v[112:115],a[128:131],a[168:171],v[112:115]
M v[112:115],a[132:135],a[172:175],v[112:115]
s_nop 0
T a[68:69],v1,57344
T a[70:71],v1,58368
v_mfma_f32_16x16x16_bf16 a[192:195], a[188:189], v[16:17], a[192:195]
M v[116:119],a[140:143],a[172:175],v[116:119]
buffer_load_dwordx4 v22, s[56:59], s30 offen offset:2048 lds
M v[116:119],a[136:139],a[168:171],v[116:119]
v_and_b32 v29, 1, v0
v_mul_u32_u24 v30, 1792, v29
M v[120:123],a[144:147],a[168:171],v[120:123]
v_lshrrev_b32 v31, 4, v0
v_lshl_add_u32 v30, v31, 4, v30
M v[120:123],a[148:151],a[172:175],v[120:123]
s_waitcnt lgkmcnt(4)
v_bfe_u32 v29, v0, 1, 3
v_lshl_add_u32 v30, v29, 6, v30
M v[124:127],a[156:159],a[172:175],v[124:127]
v_add_u32 v29, 1, v29
v_lshrrev_b32 v29, 3, v29
M v[124:127],a[152:155],a[168:171],v[124:127]
v_lshl_or_b32 v30, v29, 29, v30
v_or_b32 v30, s88, v30
M v[128:131],a[96:99],a[160:163],v[128:131]
s_mul_i32 s89, s86, 3584
R a[168:171],v5,18432
R a[172:175],v6,18432
M v[128:131],a[100:103],a[164:167],v[128:131]
s_mul_i32 s64, s20, 448
T a[72:73],v2,49152
T a[74:75],v2,50176
M v[132:135],a[108:111],a[164:167],v[132:135]
SA s89,s89,s64
M v[132:135],a[104:107],a[160:163],v[132:135]
SA s89,s89,105906176
buffer_store_dwordx4 a[192:195], v30, s[8:11], s89 offen sc1
M v[136:139],a[112:115],a[160:163],v[136:139]
M v[136:139],a[116:119],a[164:167],v[136:139]
M v[140:143],a[124:127],a[164:167],v[140:143]
buffer_load_dwordx4 v23, s[56:59], s30 offen offset:3072 lds
M v[140:143],a[120:123],a[160:163],v[140:143]
SA s29,s29,128
T a[76:77],v2,57344
T a[78:79],v2,58368
M v[144:147],a[128:131],a[160:163],v[144:147]
SA s30,s30,128
M v[144:147],a[132:135],a[164:167],v[144:147]
SA m0,s24,0
M v[148:151],a[140:143],a[164:167],v[148:151]
buffer_load_dwordx4 v12, s[48:51], s22 offen offset:0   lds
M v[148:151],a[136:139],a[160:163],v[148:151]
M v[152:155],a[144:147],a[160:163],v[152:155]
M v[152:155],a[148:151],a[164:167],v[152:155]
s_waitcnt lgkmcnt(4)
buffer_load_dwordx4 v13, s[48:51], s22 offen offset:1024   lds
M v[156:159],a[156:159],a[164:167],v[156:159]
s_nop 0
T a[80:81],v3,49152
T a[82:83],v3,50176
M v[156:159],a[152:155],a[160:163],v[156:159]
M v[160:163],a[96:99],a[168:171],v[160:163]
R a[160:163],v5,20480
R a[164:167],v6,20480
M v[160:163],a[100:103],a[172:175],v[160:163]
buffer_load_dwordx4 v14, s[48:51], s22 offen offset:2048   lds
M v[164:167],a[108:111],a[172:175],v[164:167]
M v[164:167],a[104:107],a[168:171],v[164:167]
M v[168:171],a[112:115],a[168:171],v[168:171]
buffer_load_dwordx4 v15, s[48:51], s22 offen offset:3072   lds
M v[168:171],a[116:119],a[172:175],v[168:171]
SA s22,s22,1048576
T a[84:85],v3,57344
T a[86:87],v3,58368
M v[172:175],a[124:127],a[172:175],v[172:175]
SA m0,s23,32768
M v[172:175],a[120:123],a[168:171],v[172:175]
buffer_load_dwordx4 v8, s[16:19], s21 offen offset:0  nt lds
L_w_kv06:
s_cbranch_execz L_wd1
M v[176:179],a[128:131],a[168:171],v[176:179]
M v[176:179],a[132:135],a[172:175],v[176:179]
M v[180:183],a[140:143],a[172:175],v[180:183]
M v[180:183],a[136:139],a[168:171],v[180:183]
buffer_load_dwordx4 v9, s[16:19], s21 offen offset:1024  nt lds
M v[184:187],a[144:147],a[168:171],v[184:187]
s_nop 0
T a[88:89],v4,49152
T a[90:91],v4,50176
M v[184:187],a[148:151],a[172:175],v[184:187]
s_waitcnt lgkmcnt(4)
M v[188:191],a[156:159],a[172:175],v[188:191]
M v[188:191],a[152:155],a[168:171],v[188:191]
M v[192:195],a[96:99],a[160:163],v[192:195]
R a[168:171],v5,22528
R a[172:175],v6,22528
M v[192:195],a[100:103],a[164:167],v[192:195]
buffer_load_dwordx4 v10, s[16:19], s21 offen offset:2048  nt lds
M v[196:199],a[108:111],a[164:167],v[196:199]
M v[196:199],a[104:107],a[160:163],v[196:199]
s_nop 0
T a[92:93],v4,57344
T a[94:95],v4,58368
M v[200:203],a[112:115],a[160:163],v[200:203]
M v[200:203],a[116:119],a[164:167],v[200:203]
buffer_load_dwordx4 v11, s[16:19], s21 offen offset:3072  nt lds
M v[204:207],a[124:127],a[164:167],v[204:207]
M v[204:207],a[120:123],a[160:163],v[204:207]
M v[208:211],a[128:131],a[160:163],v[208:211]
M v[208:211],a[132:135],a[164:167],v[208:211]
M v[212:215],a[140:143],a[164:167],v[212:215]
SA s21,s21,128
M v[212:215],a[136:139],a[160:163],v[212:215]
M v[216:219],a[144:147],a[160:163],v[216:219]
M v[216:219],a[148:151],a[164:167],v[216:219]
s_waitcnt lgkmcnt(2)
M v[220:223],a[156:159],a[164:167],v[220:223]
s_waitcnt vmcnt(21) lgkmcnt(0)
M v[220:223],a[152:155],a[160:163],v[220:223]
s_barrier
M v[224:227],a[96:99],a[168:171],v[224:227]
R a[160:163],v5,32768
R a[164:167],v6,32768
M v[224:227],a[100:103],a[172:175],v[224:227]
M v[228:231],a[108:111],a[172:175],v[228:231]
M v[228:231],a[104:107],a[168:171],v[228:231]
M v[232:235],a[112:115],a[168:171],v[232:235]
M v[232:235],a[116:119],a[172:175],v[232:235]
M v[236:239],a[124:127],a[172:175],v[236:239]
M v[236:239],a[120:123],a[168:171],v[236:239]
M v[240:243],a[128:131],a[168:171],v[240:243]
M v[240:243],a[132:135],a[172:175],v[240:243]
M v[244:247],a[140:143],a[172:175],v[244:247]
M v[244:247],a[136:139],a[168:171],v[244:247]
M v[248:251],a[144:147],a[168:171],v[248:251]
M v[248:251],a[148:151],a[172:175],v[248:251]
s_waitcnt lgkmcnt(0)
M v[252:255],a[156:159],a[172:175],v[252:255]
M v[252:255],a[152:155],a[168:171],v[252:255]
M a[0:3],a[32:35],a[160:163],a[0:3]
R a[168:171],v5,34816
R a[172:175],v6,34816
M a[0:3],a[36:39],a[164:167],a[0:3]
SA m0,s23,147456
T a[96:97],v1,0
T a[98:99],v1,1024
M a[4:7],a[44:47],a[164:167],a[4:7]
buffer_load_dwordx4 v22, s[56:59], s29 offen offset:0 lds
M a[4:7],a[40:43],a[160:163],a[4:7]
M a[8:11],a[48:51],a[160:163],a[8:11]
M a[8:11],a[52:55],a[164:167],a[8:11]
buffer_load_dwordx4 v23, s[56:59], s29 offen offset:1024 lds
M a[12:15],a[60:63],a[164:167],a[12:15]
s_nop 0
T a[100:101],v1,8192
T a[102:103],v1,9216
M a[12:15],a[56:59],a[160:163],a[12:15]
M a[16:19],a[64:67],a[160:163],a[16:19]
buffer_load_dwordx4 v22, s[56:59], s30 offen offset:2048 lds
M a[16:19],a[68:71],a[164:167],a[16:19]
M a[20:23],a[76:79],a[164:167],a[20:23]
M a[20:23],a[72:75],a[160:163],a[20:23]
s_nop 0
T a[104:105],v2,0
T a[106:107],v2,1024
M a[24:27],a[80:83],a[160:163],a[24:27]
buffer_load_dwordx4 v23, s[56:59], s30 offen offset:3072 lds
M a[24:27],a[84:87],a[164:167],a[24:27]
s_waitcnt lgkmcnt(6)
M a[28:31],a[92:95],a[164:167],a[28:31]
SA s29,s29,128
M a[28:31],a[88:91],a[160:163],a[28:31]
SA s30,s30,128
M v[32:35],a[32:35],a[168:171],v[32:35]
SA m0,s24,16384
R a[160:163],v5,36864
R a[164:167],v6,36864
M v[32:35],a[36:39],a[172:175],v[32:35]
T a[108:109],v2,8192
T a[110:111],v2,9216
M v[36:39],a[44:47],a[172:175],v[36:39]
buffer_load_dwordx4 v12, s[48:51], s22 offen offset:0   lds
M v[36:39],a[40:43],a[168:171],v[36:39]
M v[40:43],a[48:51],a[168:171],v[40:43]
M v[40:43],a[52:55],a[172:175],v[40:43]
s_nop 0
T a[112:113],v3,0
T a[114:115],v3,1024
M v[44:47],a[60:63],a[172:175],v[44:47]
buffer_load_dwordx4 v13, s[48:51], s22 offen offset:1024   lds
M v[44:47],a[56:59],a[168:171],v[44:47]
M v[48:51],a[64:67],a[168:171],v[48:51]
M v[48:51],a[68:71],a[172:175],v[48:51]
buffer_load_dwordx4 v14, s[48:51], s22 offen offset:2048   lds
M v[52:55],a[76:79],a[172:175],v[52:55]
s_nop 0
T a[116:117],v3,8192
T a[118:119],v3,9216
M v[52:55],a[72:75],a[168:171],v[52:55]
M v[56:59],a[80:83],a[168:171],v[56:59]
buffer_load_dwordx4 v15, s[48:51], s22 offen offset:3072   lds
M v[56:59],a[84:87],a[172:175],v[56:59]
s_waitcnt lgkmcnt(6)
M v[60:63],a[92:95],a[172:175],v[60:63]
s_sub_u32 s22, s22, 1048448
M v[60:63],a[88:91],a[168:171],v[60:63]
SA m0,s23,49152
T a[120:121],v4,0
T a[122:123],v4,1024
M v[64:67],a[32:35],a[160:163],v[64:67]
R a[168:171],v5,38912
R a[172:175],v6,38912
M v[64:67],a[36:39],a[164:167],v[64:67]
buffer_load_dwordx4 v8, s[16:19], s21 offen offset:0  nt lds
M v[68:71],a[44:47],a[164:167],v[68:71]
M v[68:71],a[40:43],a[160:163],v[68:71]
M v[72:75],a[48:51],a[160:163],v[72:75]
s_waitcnt vmcnt(17)
s_nop 0
T a[124:125],v4,8192
T a[126:127],v4,9216
M v[72:75],a[52:55],a[164:167],v[72:75]
buffer_load_dwordx4 v9, s[16:19], s21 offen offset:1024  nt lds
M v[76:79],a[60:63],a[164:167],v[76:79]
R a[176:179],v20,0
R a[180:183],v20,2048
M v[76:79],a[56:59],a[160:163],v[76:79]
R a[184:187],v21,0
R a[188:191],v21,2048
M v[80:83],a[64:67],a[160:163],v[80:83]
buffer_load_dwordx4 v10, s[16:19], s21 offen offset:2048  nt lds
M v[80:83],a[68:71],a[164:167],v[80:83]
M v[84:87],a[76:79],a[164:167],v[84:87]
M v[84:87],a[72:75],a[160:163],v[84:87]
buffer_load_dwordx4 v11, s[16:19], s21 offen offset:3072  nt lds
M v[88:91],a[80:83],a[160:163],v[88:91]
SA s21,s21,524160
M v[88:91],a[84:87],a[164:167],v[88:91]
s_waitcnt lgkmcnt(6)
M v[92:95],a[92:95],a[164:167],v[92:95]
s_waitcnt lgkmcnt(0)
M v[92:95],a[88:91],a[160:163],v[92:95]
s_barrier
M v[96:99],a[32:35],a[168:171],v[96:99]
s_lshl_b32 s4, s20, 10
R a[160:163],v5,49152
R a[164:167],v6,49152
M v[96:99],a[36:39],a[172:175],v[96:99]
SA m0,s23,131072
v_bfe_u32 v28, v0, 3, 2
M v[100:103],a[44:47],a[172:175],v[100:103]
s_nop 0
T a[128:129],v1,16384
T a[130:131],v1,17408
M v[100:103],a[40:43],a[168:171],v[100:103]
buffer_load_dwordx4 v22, s[56:59], s29 offen offset:0 lds
M v[104:107],a[48:51],a[168:171],v[104:107]
v_lshrrev_b32 v29, 5, v0
v_lshl_add_u32 v28, v29, 3, v28
M v[104:107],a[52:55],a[172:175],v[104:107]
M v[108:111],a[60:63],a[172:175],v[108:111]
buffer_load_dwordx4 v23, s[56:59], s29 offen offset:1024 lds
M v[108:111],a[56:59],a[168:171],v[108:111]
v_lshlrev_b32 v28, 13, v28
M v[112:115],a[64:67],a[168:171],v[112:115]
v_lshrrev_b32 v29, 4, v0
M v[112:115],a[68:71],a[172:175],v[112:115]
s_nop 0
T a[132:133],v1,24576
T a[134:135],v1,25600
M v[116:119],a[76:79],a[172:175],v[116:119]
buffer_load_dwordx4 v22, s[56:59], s30 offen offset:2048 lds
M v[116:119],a[72:75],a[168:171],v[116:119]
v_lshlrev_b32 v29, 1, v29
M v[120:123],a[80:83],a[168:171],v[120:123]
v_and_b32 v30, 7, v0
M v[120:123],a[84:87],a[172:175],v[120:123]
s_waitcnt lgkmcnt(4)
M v[124:127],a[92:95],a[172:175],v[124:127]
v_xor_b32 v29, v29, v30
M v[124:127],a[88:91],a[168:171],v[124:127]
buffer_load_dwordx4 v23, s[56:59], s30 offen offset:3072 lds
M v[128:131],a[32:35],a[160:163],v[128:131]
R a[168:171],v5,51200
R a[172:175],v6,51200
M v[128:131],a[36:39],a[164:167],v[128:131]
SA s29,s29,128
T a[136:137],v2,16384
T a[138:139],v2,17408
M v[132:135],a[44:47],a[164:167],v[132:135]
SA s30,s30,128
v_lshl_add_u32 v28, v29, 4, v28
M v[132:135],a[40:43],a[160:163],v[132:135]
s_and_b32 s64, s20, 1
M v[136:139],a[48:51],a[160:163],v[136:139]
s_lshl_b32 s64, s64, 17
M v[136:139],a[52:55],a[164:167],v[136:139]
s_lshr_b32 s65, s20, 1
M v[140:143],a[60:63],a[164:167],v[140:143]
s_lshl_b32 s65, s65, 15
SA s64,s64,s65
v_add_u32 v8, s64, v28
M v[140:143],a[56:59],a[160:163],v[140:143]
SA m0,s24,32768
T a[140:141],v2,24576
T a[142:143],v2,25600
M v[144:147],a[64:67],a[160:163],v[144:147]
buffer_load_dwordx4 v12, s[48:51], s22 offen offset:0   lds
M v[144:147],a[68:71],a[164:167],v[144:147]
M v[148:151],a[76:79],a[164:167],v[148:151]
M v[148:151],a[72:75],a[160:163],v[148:151]
buffer_load_dwordx4 v13, s[48:51], s22 offen offset:1024   lds
M v[152:155],a[80:83],a[160:163],v[152:155]
M v[152:155],a[84:87],a[164:167],v[152:155]
s_waitcnt lgkmcnt(4)
M v[156:159],a[92:95],a[164:167],v[156:159]
s_nop 0
T a[144:145],v3,16384
T a[146:147],v3,17408
M v[156:159],a[88:91],a[160:163],v[156:159]
buffer_load_dwordx4 v14, s[48:51], s22 offen offset:2048   lds
M v[160:163],a[32:35],a[168:171],v[160:163]
R a[160:163],v5,53248
R a[164:167],v6,53248
M v[160:163],a[36:39],a[172:175],v[160:163]
M v[164:167],a[44:47],a[172:175],v[164:167]
buffer_load_dwordx4 v15, s[48:51], s22 offen offset:3072   lds
M v[164:167],a[40:43],a[168:171],v[164:167]
M v[168:171],a[48:51],a[168:171],v[168:171]
SA s22,s22,1048576
M v[168:171],a[52:55],a[172:175],v[168:171]
s_mov_b32 s25, 0
T a[148:149],v3,24576
T a[150:151],v3,25600
M v[172:175],a[60:63],a[172:175],v[172:175]
SA m0,s4,0
M v[172:175],a[56:59],a[168:171],v[172:175]
buffer_load_dwordx4 v8, s[52:55], s25 offen lds
M v[176:179],a[64:67],a[168:171],v[176:179]
M v[176:179],a[68:71],a[172:175],v[176:179]
s_mov_b32 s25, 262144
M v[180:183],a[76:79],a[172:175],v[180:183]
SA m0,s4,4096
M v[180:183],a[72:75],a[168:171],v[180:183]
buffer_load_dwordx4 v8, s[52:55], s25 offen lds
M v[184:187],a[80:83],a[168:171],v[184:187]
s_nop 0
T a[152:153],v4,16384
T a[154:155],v4,17408
M v[184:187],a[84:87],a[172:175],v[184:187]
s_waitcnt lgkmcnt(4)
M v[188:191],a[92:95],a[172:175],v[188:191]
s_mov_b32 s25, 524288
M v[188:191],a[88:91],a[168:171],v[188:191]
SA m0,s4,8192
M v[192:195],a[32:35],a[160:163],v[192:195]
R a[168:171],v5,55296
R a[172:175],v6,55296
M v[192:195],a[36:39],a[164:167],v[192:195]
buffer_load_dwordx4 v8, s[52:55], s25 offen lds
M v[196:199],a[44:47],a[164:167],v[196:199]
M v[196:199],a[40:43],a[160:163],v[196:199]
s_mov_b32 s25, 786432
T a[156:157],v4,24576
T a[158:159],v4,25600
M v[200:203],a[48:51],a[160:163],v[200:203]
SA m0,s4,12288
M v[200:203],a[52:55],a[164:167],v[200:203]
s_waitcnt vmcnt(19)
buffer_load_dwordx4 v8, s[52:55], s25 offen lds
M v[204:207],a[60:63],a[164:167],v[204:207]
R a[192:195],v20,16384
R a[196:199],v20,18432
M v[204:207],a[56:59],a[160:163],v[204:207]
R a[200:203],v21,16384
R a[204:207],v21,18432
M v[208:211],a[64:67],a[160:163],v[208:211]
M v[208:211],a[68:71],a[164:167],v[208:211]
M v[212:215],a[76:79],a[164:167],v[212:215]
M v[212:215],a[72:75],a[160:163],v[212:215]
M v[216:219],a[80:83],a[160:163],v[216:219]
M v[216:219],a[84:87],a[164:167],v[216:219]
s_waitcnt lgkmcnt(6)
M v[220:223],a[92:95],a[164:167],v[220:223]
s_waitcnt lgkmcnt(0)
M v[220:223],a[88:91],a[160:163],v[220:223]
s_barrier
M v[224:227],a[32:35],a[168:171],v[224:227]
R a[160:163],v5,0
R a[164:167],v6,0
M v[224:227],a[36:39],a[172:175],v[224:227]
M v[228:231],a[44:47],a[172:175],v[228:231]
M v[228:231],a[40:43],a[168:171],v[228:231]
M v[232:235],a[48:51],a[168:171],v[232:235]
M v[232:235],a[52:55],a[172:175],v[232:235]
M v[236:239],a[60:63],a[172:175],v[236:239]
M v[236:239],a[56:59],a[168:171],v[236:239]
M v[240:243],a[64:67],a[168:171],v[240:243]
M v[240:243],a[68:71],a[172:175],v[240:243]
M v[244:247],a[76:79],a[172:175],v[244:247]
M v[244:247],a[72:75],a[168:171],v[244:247]
M v[248:251],a[80:83],a[168:171],v[248:251]
M v[248:251],a[84:87],a[172:175],v[248:251]
s_waitcnt lgkmcnt(0)
M v[252:255],a[92:95],a[172:175],v[252:255]
M v[252:255],a[88:91],a[168:171],v[252:255]
M a[0:3],a[96:99],a[160:163],a[0:3]
R a[168:171],v5,2048
R a[172:175],v6,2048
M a[0:3],a[100:103],a[164:167],a[0:3]
SA m0,s23,147456
T a[32:33],v1,32768
T a[34:35],v1,33792
M a[4:7],a[108:111],a[164:167],a[4:7]
buffer_load_dwordx4 v22, s[56:59], s29 offen offset:0 lds
M a[4:7],a[104:107],a[160:163],a[4:7]
M a[8:11],a[112:115],a[160:163],a[8:11]
M a[8:11],a[116:119],a[164:167],a[8:11]
buffer_load_dwordx4 v23, s[56:59], s29 offen offset:1024 lds
M a[12:15],a[124:127],a[164:167],a[12:15]
s_nop 0
T a[36:37],v1,40960
T a[38:39],v1,41984
M a[12:15],a[120:123],a[160:163],a[12:15]
M a[16:19],a[128:131],a[160:163],a[16:19]
buffer_load_dwordx4 v22, s[56:59], s30 offen offset:2048 lds
M a[16:19],a[132:135],a[164:167],a[16:19]
M a[20:23],a[140:143],a[164:167],a[20:23]
M a[20:23],a[136:139],a[160:163],a[20:23]
s_nop 0
T a[40:41],v2,32768
T a[42:43],v2,33792
M a[24:27],a[144:147],a[160:163],a[24:27]
buffer_load_dwordx4 v23, s[56:59], s30 offen offset:3072 lds
M a[24:27],a[148:151],a[164:167],a[24:27]
s_waitcnt lgkmcnt(6)
M a[28:31],a[156:159],a[164:167],a[28:31]
SA s29,s29,128
M a[28:31],a[152:155],a[160:163],a[28:31]
SA s30,s30,128
M v[32:35],a[96:99],a[168:171],v[32:35]
SA m0,s24,49152
R a[160:163],v5,4096
R a[164:167],v6,4096
M v[32:35],a[100:103],a[172:175],v[32:35]
T a[44:45],v2,40960
T a[46:47],v2,41984
M v[36:39],a[108:111],a[172:175],v[36:39]
buffer_load_dwordx4 v12, s[48:51], s22 offen offset:0   lds
M v[36:39],a[104:107],a[168:171],v[36:39]
M v[40:43],a[112:115],a[168:171],v[40:43]
M v[40:43],a[116:119],a[172:175],v[40:43]
s_nop 0
T a[48:49],v3,32768
T a[50:51],v3,33792
M v[44:47],a[124:127],a[172:175],v[44:47]
buffer_load_dwordx4 v13, s[48:51], s22 offen offset:1024   lds
M v[44:47],a[120:123],a[168:171],v[44:47]
M v[48:51],a[128:131],a[168:171],v[48:51]
M v[48:51],a[132:135],a[172:175],v[48:51]
buffer_load_dwordx4 v14, s[48:51], s22 offen offset:2048   lds
M v[52:55],a[140:143],a[172:175],v[52:55]
s_nop 0
T a[52:53],v3,40960
T a[54:55],v3,41984
M v[52:55],a[136:139],a[168:171],v[52:55]
M v[56:59],a[144:147],a[168:171],v[56:59]
buffer_load_dwordx4 v15, s[48:51], s22 offen offset:3072   lds
M v[56:59],a[148:151],a[172:175],v[56:59]
s_waitcnt lgkmcnt(6)
M v[60:63],a[156:159],a[172:175],v[60:63]
s_sub_u32 s22, s22, 1048448
M v[60:63],a[152:155],a[168:171],v[60:63]
s_mov_b32 s25, 1048576
T a[56:57],v4,32768
T a[58:59],v4,33792
M v[64:67],a[96:99],a[160:163],v[64:67]
SA m0,s4,16384
R a[168:171],v5,6144
R a[172:175],v6,6144
M v[64:67],a[100:103],a[164:167],v[64:67]
buffer_load_dwordx4 v8, s[52:55], s25 offen lds
M v[68:71],a[108:111],a[164:167],v[68:71]
s_mov_b32 s25, 1310720
M v[68:71],a[104:107],a[160:163],v[68:71]
SA m0,s4,20480
M v[72:75],a[112:115],a[160:163],v[72:75]
s_waitcnt vmcnt(17)
s_nop 0
T a[60:61],v4,40960
T a[62:63],v4,41984
M v[72:75],a[116:119],a[164:167],v[72:75]
buffer_load_dwordx4 v8, s[52:55], s25 offen lds
M v[76:79],a[124:127],a[164:167],v[76:79]
s_mov_b32 s25, 1572864
R a[208:211],v20,0
R a[212:215],v20,2048
M v[76:79],a[120:123],a[160:163],v[76:79]
SA m0,s4,24576
R a[216:219],v21,0
R a[220:223],v21,2048
M v[80:83],a[128:131],a[160:163],v[80:83]
buffer_load_dwordx4 v8, s[52:55], s25 offen lds
M v[80:83],a[132:135],a[164:167],v[80:83]
s_mov_b32 s25, 1835008
M v[84:87],a[140:143],a[164:167],v[84:87]
SA m0,s4,28672
M v[84:87],a[136:139],a[160:163],v[84:87]
buffer_load_dwordx4 v8, s[52:55], s25 offen lds
M v[88:91],a[144:147],a[160:163],v[88:91]
M v[88:91],a[148:151],a[164:167],v[88:91]
s_waitcnt lgkmcnt(6)
M v[92:95],a[156:159],a[164:167],v[92:95]
s_waitcnt lgkmcnt(0)
M v[92:95],a[152:155],a[160:163],v[92:95]
s_barrier
M v[96:99],a[96:99],a[168:171],v[96:99]
R a[160:163],v5,16384
R a[164:167],v6,16384
M v[96:99],a[100:103],a[172:175],v[96:99]
SA m0,s23,32768
M v[100:103],a[108:111],a[172:175],v[100:103]
s_nop 0
T a[64:65],v1,49152
T a[66:67],v1,50176
M v[100:103],a[104:107],a[168:171],v[100:103]
buffer_load_dwordx4 v22, s[56:59], s29 offen offset:0 lds
M v[104:107],a[112:115],a[168:171],v[104:107]
v_lshrrev_b32 v28, 2, v0
v_lshlrev_b32 v28, 7, v28
M v[104:107],a[116:119],a[172:175],v[104:107]
M v[108:111],a[124:127],a[172:175],v[108:111]
buffer_load_dwordx4 v23, s[56:59], s29 offen offset:1024 lds
M v[108:111],a[120:123],a[168:171],v[108:111]
v_and_b32 v29, 3, v0
M v[112:115],a[128:131],a[168:171],v[112:115]
v_lshl_add_u32 v28, v29, 3, v28
M v[112:115],a[132:135],a[172:175],v[112:115]
s_nop 0
T a[68:69],v1,57344
T a[70:71],v1,58368
M v[116:119],a[140:143],a[172:175],v[116:119]
buffer_load_dwordx4 v22, s[56:59], s30 offen offset:2048 lds
M v[116:119],a[136:139],a[168:171],v[116:119]
v_bfe_u32 v29, v0, 3, 2
M v[120:123],a[144:147],a[168:171],v[120:123]
M v[120:123],a[148:151],a[172:175],v[120:123]
s_waitcnt lgkmcnt(4)
v_lshl_add_u32 v16, v29, 5, v28
M v[124:127],a[156:159],a[172:175],v[124:127]
M v[124:127],a[152:155],a[168:171],v[124:127]
buffer_load_dwordx4 v23, s[56:59], s30 offen offset:3072 lds
M v[128:131],a[96:99],a[160:163],v[128:131]
R a[168:171],v5,18432
R a[172:175],v6,18432
M v[128:131],a[100:103],a[164:167],v[128:131]
SA s29,s29,128
T a[72:73],v2,49152
T a[74:75],v2,50176
M v[132:135],a[108:111],a[164:167],v[132:135]
SA s30,s30,128
v_xor_b32 v17, 32, v16
v_xor_b32 v18, 64, v16
M v[132:135],a[104:107],a[160:163],v[132:135]
SA m0,s23,65536
M v[136:139],a[112:115],a[160:163],v[136:139]
buffer_load_dwordx4 v22, s[56:59], s29 offen offset:0 lds
M v[136:139],a[116:119],a[164:167],v[136:139]
v_xor_b32 v19, 0x60, v16
M v[140:143],a[124:127],a[164:167],v[140:143]
v_add_u32 v12, 0x20000, v16
M v[140:143],a[120:123],a[160:163],v[140:143]
s_nop 0
T a[76:77],v2,57344
T a[78:79],v2,58368
M v[144:147],a[128:131],a[160:163],v[144:147]
buffer_load_dwordx4 v23, s[56:59], s29 offen offset:1024 lds
M v[144:147],a[132:135],a[164:167],v[144:147]
v_add_u32 v13, 0x20000, v17
M v[148:151],a[140:143],a[164:167],v[148:151]
M v[148:151],a[136:139],a[160:163],v[148:151]
v_add_u32 v14, 0x20000, v18
M v[152:155],a[144:147],a[160:163],v[152:155]
M v[152:155],a[148:151],a[164:167],v[152:155]
s_waitcnt lgkmcnt(4)
buffer_load_dwordx4 v22, s[56:59], s30 offen offset:2048 lds
M v[156:159],a[156:159],a[164:167],v[156:159]
s_nop 0
T a[80:81],v3,49152
T a[82:83],v3,50176
M v[156:159],a[152:155],a[160:163],v[156:159]
v_add_u32 v15, 0x20000, v19
M v[160:163],a[96:99],a[168:171],v[160:163]
R a[160:163],v5,20480
R a[164:167],v6,20480
M v[160:163],a[100:103],a[172:175],v[160:163]
M v[164:167],a[108:111],a[172:175],v[164:167]
buffer_load_dwordx4 v23, s[56:59], s30 offen offset:3072 lds
M v[164:167],a[104:107],a[168:171],v[164:167]
SA s29,s29,128
M v[168:171],a[112:115],a[168:171],v[168:171]
SA s30,s30,128
M v[168:171],a[116:119],a[172:175],v[168:171]
s_mov_b32 s25, 2097152
T a[84:85],v3,57344
T a[86:87],v3,58368
M v[172:175],a[124:127],a[172:175],v[172:175]
SA m0,s4,131072
M v[172:175],a[120:123],a[168:171],v[172:175]
buffer_load_dwordx4 v8, s[52:55], s25 offen lds
M v[176:179],a[128:131],a[168:171],v[176:179]
M v[176:179],a[132:135],a[172:175],v[176:179]
s_mov_b32 s25, 2359296
M v[180:183],a[140:143],a[172:175],v[180:183]
SA m0,s4,135168
M v[180:183],a[136:139],a[168:171],v[180:183]
buffer_load_dwordx4 v8, s[52:55], s25 offen lds
M v[184:187],a[144:147],a[168:171],v[184:187]
s_nop 0
T a[88:89],v4,49152
T a[90:91],v4,50176
M v[184:187],a[148:151],a[172:175],v[184:187]
s_waitcnt lgkmcnt(4)
M v[188:191],a[156:159],a[172:175],v[188:191]
s_mov_b32 s25, 2621440
M v[188:191],a[152:155],a[168:171],v[188:191]
L_w_kv07:
s_cbranch_execz L_wd1
SA m0,s4,139264
M v[192:195],a[96:99],a[160:163],v[192:195]
R a[168:171],v5,22528
R a[172:175],v6,22528
M v[192:195],a[100:103],a[164:167],v[192:195]
buffer_load_dwordx4 v8, s[52:55], s25 offen lds
M v[196:199],a[108:111],a[164:167],v[196:199]
M v[196:199],a[104:107],a[160:163],v[196:199]
s_mov_b32 s25, 2883584
T a[92:93],v4,57344
T a[94:95],v4,58368
M v[200:203],a[112:115],a[160:163],v[200:203]
SA m0,s4,143360
M v[200:203],a[116:119],a[164:167],v[200:203]
s_waitcnt vmcnt(19)
buffer_load_dwordx4 v8, s[52:55], s25 offen lds
M v[204:207],a[124:127],a[164:167],v[204:207]
R a[224:227],v20,16384
R a[228:231],v20,18432
M v[204:207],a[120:123],a[160:163],v[204:207]
R a[232:235],v21,16384
R a[236:239],v21,18432
M v[208:211],a[128:131],a[160:163],v[208:211]
v_subrev_u32 v20, 98304, v20
v_subrev_u32 v21, 98304, v21
M v[208:211],a[132:135],a[164:167],v[208:211]
M v[212:215],a[140:143],a[164:167],v[212:215]
M v[212:215],a[136:139],a[160:163],v[212:215]
M v[216:219],a[144:147],a[160:163],v[216:219]
M v[216:219],a[148:151],a[164:167],v[216:219]
s_waitcnt lgkmcnt(6)
M v[220:223],a[156:159],a[164:167],v[220:223]
s_waitcnt lgkmcnt(0)
M v[220:223],a[152:155],a[160:163],v[220:223]
s_barrier
M v[224:227],a[96:99],a[168:171],v[224:227]
R a[160:163],v5,32768
R a[164:167],v6,32768
M v[224:227],a[100:103],a[172:175],v[224:227]
M v[228:231],a[108:111],a[172:175],v[228:231]
M v[228:231],a[104:107],a[168:171],v[228:231]
M v[232:235],a[112:115],a[168:171],v[232:235]
M v[232:235],a[116:119],a[172:175],v[232:235]
M v[236:239],a[124:127],a[172:175],v[236:239]
M v[236:239],a[120:123],a[168:171],v[236:239]
M v[240:243],a[128:131],a[168:171],v[240:243]
M v[240:243],a[132:135],a[172:175],v[240:243]
M v[244:247],a[140:143],a[172:175],v[244:247]
M v[244:247],a[136:139],a[168:171],v[244:247]
M v[248:251],a[144:147],a[168:171],v[248:251]
M v[248:251],a[148:151],a[172:175],v[248:251]
s_waitcnt lgkmcnt(0)
M v[252:255],a[156:159],a[172:175],v[252:255]
M v[252:255],a[152:155],a[168:171],v[252:255]
M a[0:3],a[32:35],a[160:163],a[0:3]
R a[168:171],v5,34816
R a[172:175],v6,34816
M a[0:3],a[36:39],a[164:167],a[0:3]
SA m0,s23,81920
M a[4:7],a[44:47],a[164:167],a[4:7]
buffer_load_dwordx4 v22, s[56:59], s29 offen offset:0 lds
M a[4:7],a[40:43],a[160:163],a[4:7]
M a[8:11],a[48:51],a[160:163],a[8:11]
M a[8:11],a[52:55],a[164:167],a[8:11]
buffer_load_dwordx4 v23, s[56:59], s29 offen offset:1024 lds
M a[12:15],a[60:63],a[164:167],a[12:15]
M a[12:15],a[56:59],a[160:163],a[12:15]
G v24,a0
G v25,a1
M a[16:19],a[64:67],a[160:163],a[16:19]
G v26,a2
G v27,a3
M a[16:19],a[68:71],a[164:167],a[16:19]
buffer_load_dwordx4 v22, s[56:59], s30 offen offset:2048 lds
M a[20:23],a[76:79],a[164:167],a[20:23]
G v28,a4
G v29,a5
M a[20:23],a[72:75],a[160:163],a[20:23]
G v30,a6
G v31,a7
M a[24:27],a[80:83],a[160:163],a[24:27]
C v24,v24,v25
C v25,v26,v27
M a[24:27],a[84:87],a[164:167],a[24:27]
s_waitcnt lgkmcnt(0)
buffer_load_dwordx4 v23, s[56:59], s30 offen offset:3072 lds
M a[28:31],a[92:95],a[164:167],a[28:31]
SA s29,s29,128
C v26,v28,v29
C v27,v30,v31
M a[28:31],a[88:91],a[160:163],a[28:31]
SA s3,s93,0
buffer_store_dwordx4 v[24:27], v7, s[8:11], s3 offen offset:0 sc1
M v[32:35],a[32:35],a[168:171],v[32:35]
SA s30,s30,128
R a[160:163],v5,36864
R a[164:167],v6,36864
M v[32:35],a[36:39],a[172:175],v[32:35]
s_mov_b32 s25, 3145728
G v24,a8
G v25,a9
M v[36:39],a[44:47],a[172:175],v[36:39]
SA m0,s4,147456
G v26,a10
G v27,a11
M v[36:39],a[40:43],a[168:171],v[36:39]
buffer_load_dwordx4 v8, s[52:55], s25 offen lds
M v[40:43],a[48:51],a[168:171],v[40:43]
s_mov_b32 s25, 3407872
G v28,a12
G v29,a13
M v[40:43],a[52:55],a[172:175],v[40:43]
SA m0,s4,151552
G v30,a14
G v31,a15
M v[44:47],a[60:63],a[172:175],v[44:47]
buffer_load_dwordx4 v8, s[52:55], s25 offen lds
M v[44:47],a[56:59],a[168:171],v[44:47]
s_mov_b32 s25, 128
C v24,v24,v25
C v25,v26,v27
M v[48:51],a[64:67],a[168:171],v[48:51]
SA m0,s4,49152
C v26,v28,v29
C v27,v30,v31
M v[48:51],a[68:71],a[172:175],v[48:51]
buffer_store_dwordx4 v[24:27], v7, s[8:11], s3 offen offset:1024 sc1
M v[52:55],a[76:79],a[172:175],v[52:55]
s_nop 0
G v24,a16
G v25,a17
M v[52:55],a[72:75],a[168:171],v[52:55]
G v26,a18
G v27,a19
M v[56:59],a[80:83],a[168:171],v[56:59]
buffer_load_dwordx4 v8, s[52:55], s25 offen lds
M v[56:59],a[84:87],a[172:175],v[56:59]
s_waitcnt lgkmcnt(0)
G v28,a20
G v29,a21
M v[60:63],a[92:95],a[172:175],v[60:63]
s_mov_b32 s25, 262272
G v30,a22
G v31,a23
M v[60:63],a[88:91],a[168:171],v[60:63]
SA m0,s4,53248
C v24,v24,v25
C v25,v26,v27
M v[64:67],a[32:35],a[160:163],v[64:67]
s_waitcnt vmcnt(17)
R a[168:171],v5,38912
R a[172:175],v6,38912
M v[64:67],a[36:39],a[164:167],v[64:67]
buffer_load_dwordx4 v8, s[52:55], s25 offen lds
M v[68:71],a[44:47],a[164:167],v[68:71]
s_mov_b32 s25, 524416
C v26,v28,v29
C v27,v30,v31
M v[68:71],a[40:43],a[160:163],v[68:71]
SA m0,s4,57344
buffer_store_dwordx4 v[24:27], v7, s[8:11], s3 offen offset:2048 sc1
M v[72:75],a[48:51],a[160:163],v[72:75]
R a[96:99],v20,0
R a[100:103],v20,2048
M v[72:75],a[52:55],a[164:167],v[72:75]
R a[104:107],v21,0
R a[108:111],v21,2048
M v[76:79],a[60:63],a[164:167],v[76:79]
buffer_load_dwordx4 v8, s[52:55], s25 offen lds
M v[76:79],a[56:59],a[160:163],v[76:79]
s_mov_b32 s25, 786560
G v24,a24
G v25,a25
M v[80:83],a[64:67],a[160:163],v[80:83]
SA m0,s4,61440
G v26,a26
G v27,a27
M v[80:83],a[68:71],a[164:167],v[80:83]
buffer_load_dwordx4 v8, s[52:55], s25 offen lds
M v[84:87],a[76:79],a[164:167],v[84:87]
G v28,a28
G v29,a29
M v[84:87],a[72:75],a[160:163],v[84:87]
G v30,a30
G v31,a31
M v[88:91],a[80:83],a[160:163],v[88:91]
C v24,v24,v25
C v25,v26,v27
M v[88:91],a[84:87],a[164:167],v[88:91]
s_waitcnt lgkmcnt(4)
C v26,v28,v29
C v27,v30,v31
M v[92:95],a[92:95],a[164:167],v[92:95]
s_waitcnt lgkmcnt(0)
buffer_store_dwordx4 v[24:27], v7, s[8:11], s3 offen offset:3072 sc1
M v[92:95],a[88:91],a[160:163],v[92:95]
s_barrier
M v[96:99],a[32:35],a[168:171],v[96:99]
R a[160:163],v5,49152
R a[164:167],v6,49152
M v[96:99],a[36:39],a[172:175],v[96:99]
s_mov_b32 s25, 1048704
C v64,v64,v65
C v65,v66,v67
M v[100:103],a[44:47],a[172:175],v[100:103]
SA m0,s4,98304
C v66,v68,v69
C v67,v70,v71
M v[100:103],a[40:43],a[168:171],v[100:103]
s_waitcnt vmcnt(18)
buffer_load_dwordx4 v8, s[52:55], s25 offen lds
M v[104:107],a[48:51],a[168:171],v[104:107]
C v72,v72,v73
C v73,v74,v75
M v[104:107],a[52:55],a[172:175],v[104:107]
C v74,v76,v77
C v75,v78,v79
M v[108:111],a[60:63],a[172:175],v[108:111]
C v32,v32,v33
C v33,v34,v35
M v[108:111],a[56:59],a[168:171],v[108:111]
C v34,v36,v37
C v35,v38,v39
M v[112:115],a[64:67],a[168:171],v[112:115]
SA s3,s93,8192
buffer_store_dwordx4 v[32:35], v7, s[8:11], s3 offen offset:0 sc1
M v[112:115],a[68:71],a[172:175],v[112:115]
s_mov_b32 s25, 1310848
C v80,v80,v81
C v81,v82,v83
M v[116:119],a[76:79],a[172:175],v[116:119]
SA m0,s4,102400
C v82,v84,v85
C v83,v86,v87
M v[116:119],a[72:75],a[168:171],v[116:119]
R a[112:115],v20,32768
R a[116:119],v20,34816
M v[120:123],a[80:83],a[168:171],v[120:123]
buffer_load_dwordx4 v8, s[52:55], s25 offen lds
M v[120:123],a[84:87],a[172:175],v[120:123]
s_waitcnt lgkmcnt(2)
R a[120:123],v21,32768
R a[124:127],v21,34816
M v[124:127],a[92:95],a[172:175],v[124:127]
C v88,v88,v89
C v89,v90,v91
M v[124:127],a[88:91],a[168:171],v[124:127]
C v90,v92,v93
C v91,v94,v95
M v[128:131],a[32:35],a[160:163],v[128:131]
R a[168:171],v5,51200
R a[172:175],v6,51200
M v[128:131],a[36:39],a[164:167],v[128:131]
C v40,v40,v41
C v41,v42,v43
M v[132:135],a[44:47],a[164:167],v[132:135]
C v42,v44,v45
C v43,v46,v47
M v[132:135],a[40:43],a[160:163],v[132:135]
s_mov_b32 s25, 1572992
buffer_store_dwordx4 v[40:43], v7, s[8:11], s3 offen offset:1024 sc1
M v[136:139],a[48:51],a[160:163],v[136:139]
SA m0,s4,106496
C v96,v96,v97
C v97,v98,v99
M v[136:139],a[52:55],a[164:167],v[136:139]
C v98,v100,v101
C v99,v102,v103
M v[140:143],a[60:63],a[164:167],v[140:143]
C v104,v104,v105
C v105,v106,v107
M v[140:143],a[56:59],a[160:163],v[140:143]
buffer_load_dwordx4 v8, s[52:55], s25 offen lds
M v[144:147],a[64:67],a[160:163],v[144:147]
C v106,v108,v109
C v107,v110,v111
M v[144:147],a[68:71],a[164:167],v[144:147]
C v112,v112,v113
C v113,v114,v115
M v[148:151],a[76:79],a[164:167],v[148:151]
C v114,v116,v117
C v115,v118,v119
M v[148:151],a[72:75],a[160:163],v[148:151]
C v48,v48,v49
C v49,v50,v51
M v[152:155],a[80:83],a[160:163],v[152:155]
C v50,v52,v53
C v51,v54,v55
M v[152:155],a[84:87],a[164:167],v[152:155]
s_waitcnt lgkmcnt(0)
buffer_store_dwordx4 v[48:51], v7, s[8:11], s3 offen offset:2048 sc1
M v[156:159],a[92:95],a[164:167],v[156:159]
s_mov_b32 s25, 1835136
C v120,v120,v121
C v121,v122,v123
M v[156:159],a[88:91],a[160:163],v[156:159]
SA m0,s4,110592
C v122,v124,v125
C v123,v126,v127
M v[160:163],a[32:35],a[168:171],v[160:163]
R a[160:163],v5,53248
R a[164:167],v6,53248
M v[160:163],a[36:39],a[172:175],v[160:163]
buffer_load_dwordx4 v8, s[52:55], s25 offen lds
M v[164:167],a[44:47],a[172:175],v[164:167]
C v128,v128,v129
C v129,v130,v131
M v[164:167],a[40:43],a[168:171],v[164:167]
C v130,v132,v133
C v131,v134,v135
M v[168:171],a[48:51],a[168:171],v[168:171]
C v56,v56,v57
C v57,v58,v59
M v[168:171],a[52:55],a[172:175],v[168:171]
C v58,v60,v61
C v59,v62,v63
M v[172:175],a[60:63],a[172:175],v[172:175]
buffer_store_dwordx4 v[56:59], v7, s[8:11], s3 offen offset:3072 sc1
M v[172:175],a[56:59],a[168:171],v[172:175]
C v136,v136,v137
C v137,v138,v139
M v[176:179],a[64:67],a[168:171],v[176:179]
C v138,v140,v141
C v139,v142,v143
M v[176:179],a[68:71],a[172:175],v[176:179]
C v144,v144,v145
C v145,v146,v147
M v[180:183],a[76:79],a[172:175],v[180:183]
C v146,v148,v149
C v147,v150,v151
M v[180:183],a[72:75],a[168:171],v[180:183]
C v152,v152,v153
C v153,v154,v155
M v[184:187],a[80:83],a[168:171],v[184:187]
C v154,v156,v157
C v155,v158,v159
M v[184:187],a[84:87],a[172:175],v[184:187]
s_waitcnt lgkmcnt(0)
C v160,v160,v161
C v161,v162,v163
M v[188:191],a[92:95],a[172:175],v[188:191]
C v162,v164,v165
C v163,v166,v167
M v[188:191],a[88:91],a[168:171],v[188:191]
C v168,v168,v169
C v169,v170,v171
M v[192:195],a[32:35],a[160:163],v[192:195]
s_waitcnt vmcnt(18)
R a[168:171],v5,55296
R a[172:175],v6,55296
M v[192:195],a[36:39],a[164:167],v[192:195]
C v170,v172,v173
C v171,v174,v175
M v[196:199],a[44:47],a[164:167],v[196:199]
C v176,v176,v177
C v177,v178,v179
M v[196:199],a[40:43],a[160:163],v[196:199]
C v178,v180,v181
C v179,v182,v183
M v[200:203],a[48:51],a[160:163],v[200:203]
R a[128:131],v20,49152
R a[132:135],v20,51200
M v[200:203],a[52:55],a[164:167],v[200:203]
R a[136:139],v21,49152
R a[140:143],v21,51200
M v[204:207],a[60:63],a[164:167],v[204:207]
C v184,v184,v185
C v185,v186,v187
M v[204:207],a[56:59],a[160:163],v[204:207]
C v186,v188,v189
C v187,v190,v191
M v[208:211],a[64:67],a[160:163],v[208:211]
C v192,v192,v193
C v193,v194,v195
M v[208:211],a[68:71],a[164:167],v[208:211]
C v194,v196,v197
C v195,v198,v199
M v[212:215],a[76:79],a[164:167],v[212:215]
M v[212:215],a[72:75],a[160:163],v[212:215]
C v200,v200,v201
C v201,v202,v203
M v[216:219],a[80:83],a[160:163],v[216:219]
C v202,v204,v205
C v203,v206,v207
M v[216:219],a[84:87],a[164:167],v[216:219]
s_waitcnt lgkmcnt(4)
M v[220:223],a[92:95],a[164:167],v[220:223]
s_waitcnt vmcnt(15) lgkmcnt(0)
M v[220:223],a[88:91],a[160:163],v[220:223]
s_barrier
M v[224:227],a[32:35],a[168:171],v[224:227]
s_nop 0
T v[32:33],v16,0
T v[34:35],v16,2048
M v[224:227],a[36:39],a[172:175],v[224:227]
C v208,v208,v209
C v209,v210,v211
M v[228:231],a[44:47],a[172:175],v[228:231]
T v[36:37],v16,4096
T v[38:39],v16,6144
M v[228:231],a[40:43],a[168:171],v[228:231]
T v[40:41],v16,8192
T v[42:43],v16,10240
M v[232:235],a[48:51],a[168:171],v[232:235]
C v210,v212,v213
C v211,v214,v215
M v[232:235],a[52:55],a[172:175],v[232:235]
T v[44:45],v16,12288
T v[46:47],v16,14336
M v[236:239],a[60:63],a[172:175],v[236:239]
T v[48:49],v16,16384
T v[50:51],v16,18432
M v[236:239],a[56:59],a[168:171],v[236:239]
C v216,v216,v217
C v217,v218,v219
M v[240:243],a[64:67],a[168:171],v[240:243]
T v[52:53],v16,20480
T v[54:55],v16,22528
M v[240:243],a[68:71],a[172:175],v[240:243]
T v[56:57],v16,24576
T v[58:59],v16,26624
M v[244:247],a[76:79],a[172:175],v[244:247]
C v218,v220,v221
C v219,v222,v223
M v[244:247],a[72:75],a[168:171],v[244:247]
C v224,v224,v225
C v225,v226,v227
M v[248:251],a[80:83],a[168:171],v[248:251]
C v226,v228,v229
C v227,v230,v231
M v[248:251],a[84:87],a[172:175],v[248:251]
C v232,v232,v233
C v233,v234,v235
M v[252:255],a[92:95],a[172:175],v[252:255]
C v234,v236,v237
C v235,v238,v239
M v[252:255],a[88:91],a[168:171],v[252:255]
s_waitcnt lgkmcnt(6)
C v240,v240,v241
C v241,v242,v243
M v[68:71],v[32:35],a[176:179],0
s_mul_i32 s72, s41, 4352
T a[144:145],v17,0
T a[146:147],v17,2048
M v[68:71],v[36:39],a[184:187],v[68:71]
SA s46,s72,104923136
C v242,v244,v245
C v243,v246,v247
M v[68:71],v[40:43],a[192:195],v[68:71]
s_waitcnt lgkmcnt(2)
T a[148:149],v17,4096
T a[150:151],v17,6144
M v[68:71],v[44:47],a[200:203],v[68:71]
s_mov_b32 s25, 2097280
T a[152:153],v17,8192
T a[154:155],v17,10240
M v[68:71],v[48:51],a[208:211],v[68:71]
SA m0,s4,114688
C v248,v248,v249
C v249,v250,v251
M v[68:71],v[52:55],a[216:219],v[68:71]
s_lshl_b32 s45, s42, 7
T a[156:157],v17,12288
T a[158:159],v17,14336
M v[68:71],v[56:59],a[224:227],v[68:71]
SA s45,s45,s46
T a[160:161],v17,16384
T a[162:163],v17,18432
M v[76:79],v[56:59],a[228:231],0
s_lshl_b32 s72, s20, 2
buffer_load_dwordx4 v8, s[52:55], s25 offen lds
M v[76:79],v[52:55],a[220:223],v[76:79]
SA s72,s72,s45
T a[164:165],v17,20480
T a[166:167],v17,22528
M v[76:79],v[48:51],a[212:215],v[76:79]
T a[168:169],v17,24576
T a[170:171],v17,26624
M v[76:79],v[44:47],a[204:207],v[76:79]
s_mov_b32 s25, 2359424
C v250,v252,v253
C v251,v254,v255
M v[76:79],v[40:43],a[196:199],v[76:79]
SA m0,s4,118784
v_min_u32 v29, 1, v0
v_lshlrev_b32 v29, 29, v29
M v[76:79],v[36:39],a[188:191],v[76:79]
buffer_load_dwordx4 v8, s[52:55], s25 offen lds
M v[76:79],v[32:35],a[180:183],v[76:79]
s_waitcnt lgkmcnt(6)
v_mov_b32 v30, 1
M v[84:87],a[144:147],a[176:179],0
s_nop 0
T v[32:33],v18,0
T v[34:35],v18,2048
M v[84:87],a[148:151],a[184:187],v[84:87]
s_mov_b32 s25, 2621568
M v[84:87],a[152:155],a[192:195],v[84:87]
s_waitcnt lgkmcnt(2)
s_nop 0
T v[36:37],v18,4096
T v[38:39],v18,6144
M v[84:87],a[156:159],a[200:203],v[84:87]
SA m0,s4,122880
T v[40:41],v18,8192
T v[42:43],v18,10240
M v[84:87],a[160:163],a[208:211],v[84:87]
buffer_load_dwordx4 v8, s[52:55], s25 offen lds
M v[84:87],a[164:167],a[216:219],v[84:87]
s_nop 0
T v[44:45],v18,12288
T v[46:47],v18,14336
M v[84:87],a[168:171],a[224:227],v[84:87]
s_waitcnt vmcnt(3)
T v[48:49],v18,16384
T v[50:51],v18,18432
M v[92:95],a[168:171],a[228:231],0
s_mov_b32 s25, 2883712
buffer_store_dword v30, v29, s[8:11], s72 offen offset:4 sc1
M v[92:95],a[164:167],a[220:223],v[92:95]
SA m0,s4,126976
T v[52:53],v18,20480
T v[54:55],v18,22528
M v[92:95],a[160:163],a[212:215],v[92:95]
SA s3,s93,524288
T v[56:57],v18,24576
T v[58:59],v18,26624
M v[92:95],a[156:159],a[204:207],v[92:95]
buffer_load_dwordx4 v8, s[52:55], s25 offen lds
M v[92:95],a[152:155],a[196:199],v[92:95]
L_w_kv08:
s_cbranch_execz L_wd1
v_add_u32 v20, 0x10000, v16
v_add_u32 v21, 0x10000, v17
M v[92:95],a[148:151],a[188:191],v[92:95]
buffer_store_dwordx4 v[64:67], v7, s[8:11], s3 offen offset:0 sc1
M v[92:95],a[144:147],a[180:183],v[92:95]
s_waitcnt lgkmcnt(6)
v_add_u32 v22, 0x10000, v18
M v[100:103],v[32:35],a[176:179],0
s_mov_b32 s25, 3145856
T a[144:145],v19,0
T a[146:147],v19,2048
M v[100:103],v[36:39],a[184:187],v[100:103]
SA m0,s4,32768
buffer_store_dwordx4 v[72:75], v7, s[8:11], s3 offen offset:1024 sc1
M v[100:103],v[40:43],a[192:195],v[100:103]
s_waitcnt lgkmcnt(2)
s_nop 0
T a[148:149],v19,4096
T a[150:151],v19,6144
M v[100:103],v[44:47],a[200:203],v[100:103]
T a[152:153],v19,8192
T a[154:155],v19,10240
M v[100:103],v[48:51],a[208:211],v[100:103]
buffer_load_dwordx4 v8, s[52:55], s25 offen lds
M v[100:103],v[52:55],a[216:219],v[100:103]
s_nop 0
T a[156:157],v19,12288
T a[158:159],v19,14336
M v[100:103],v[56:59],a[224:227],v[100:103]
T a[160:161],v19,16384
T a[162:163],v19,18432
M v[108:111],v[56:59],a[228:231],0
s_mov_b32 s25, 3408000
buffer_store_dwordx4 v[80:83], v7, s[8:11], s3 offen offset:2048 sc1
M v[108:111],v[52:55],a[220:223],v[108:111]
SA m0,s4,36864
T a[164:165],v19,20480
T a[166:167],v19,22528
M v[108:111],v[48:51],a[212:215],v[108:111]
T a[168:169],v19,24576
T a[170:171],v19,26624
M v[108:111],v[44:47],a[204:207],v[108:111]
buffer_load_dwordx4 v8, s[52:55], s25 offen lds
M v[108:111],v[40:43],a[196:199],v[108:111]
v_add_u32 v23, 0x10000, v19
v_or_b32 v1, s20, v0
M v[108:111],v[36:39],a[188:191],v[108:111]
buffer_store_dwordx4 v[88:91], v7, s[8:11], s3 offen offset:3072 sc1
M v[108:111],v[32:35],a[180:183],v[108:111]
s_waitcnt lgkmcnt(6)
v_min_u32 v1, 1, v1
M v[116:119],a[144:147],a[176:179],0
s_mov_b32 s25, 256
T v[32:33],v16,28672
T v[34:35],v16,30720
M v[116:119],a[148:151],a[184:187],v[116:119]
SA m0,s4,65536
v_lshlrev_b32 v1, 29, v1
M v[116:119],a[152:155],a[192:195],v[116:119]
s_waitcnt lgkmcnt(2)
s_nop 0
T v[36:37],v12,0
T v[38:39],v12,2048
M v[116:119],a[156:159],a[200:203],v[116:119]
T v[40:41],v12,4096
T v[42:43],v12,6144
M v[116:119],a[160:163],a[208:211],v[116:119]
buffer_load_dwordx4 v8, s[52:55], s25 offen lds
M v[116:119],a[164:167],a[216:219],v[116:119]
s_nop 0
T v[44:45],v12,8192
T v[46:47],v12,10240
M v[116:119],a[168:171],a[224:227],v[116:119]
T v[48:49],v12,12288
T v[50:51],v12,14336
M v[124:127],a[168:171],a[228:231],0
s_mov_b32 s25, 262400
v_min_u32 v9, 15, v0
M v[124:127],a[164:167],a[220:223],v[124:127]
SA m0,s4,69632
T v[52:53],v12,16384
T v[54:55],v12,18432
M v[124:127],a[160:163],a[212:215],v[124:127]
T v[56:57],v12,20480
T v[58:59],v12,22528
M v[124:127],a[156:159],a[204:207],v[124:127]
buffer_load_dwordx4 v8, s[52:55], s25 offen lds
M v[124:127],a[152:155],a[196:199],v[124:127]
v_lshlrev_b32 v9, 7, v9
M v[124:127],a[148:151],a[188:191],v[124:127]
s_sub_u32 s66, 15, s42
M v[124:127],a[144:147],a[180:183],v[124:127]
s_waitcnt lgkmcnt(6)
M v[68:71],v[32:35],a[232:235],v[68:71]
s_mov_b32 s25, 524544
T a[144:145],v17,28672
T a[146:147],v17,30720
M v[68:71],v[36:39],a[96:99],v[68:71]
SA m0,s4,73728
M v[68:71],v[40:43],a[104:107],v[68:71]
s_waitcnt lgkmcnt(2)
s_nop 0
T a[148:149],v13,0
T a[150:151],v13,2048
M v[68:71],v[44:47],a[112:115],v[68:71]
s_max_u32 s67, s66, s42
T a[152:153],v13,4096
T a[154:155],v13,6144
M v[68:71],v[48:51],a[120:123],v[68:71]
s_min_u32 s66, s66, s42
buffer_load_dwordx4 v8, s[52:55], s25 offen lds
M v[68:71],v[52:55],a[128:131],v[68:71]
s_mul_i32 s21, s41, 1048576
T a[156:157],v13,8192
T a[158:159],v13,10240
M v[68:71],v[56:59],a[136:139],v[68:71]
s_lshl_b32 s64, s67, 16
T a[160:161],v13,12288
T a[162:163],v13,14336
M v[76:79],v[56:59],a[140:143],v[76:79]
s_mov_b32 s25, 786688
M v[76:79],v[52:55],a[132:135],v[76:79]
SA m0,s4,77824
T a[164:165],v13,16384
T a[166:167],v13,18432
M v[76:79],v[48:51],a[124:127],v[76:79]
SA s32,s21,s64
T a[168:169],v13,20480
T a[170:171],v13,22528
M v[76:79],v[44:47],a[116:119],v[76:79]
s_lshl_b32 s64, s20, 14
buffer_load_dwordx4 v8, s[52:55], s25 offen lds
M v[76:79],v[40:43],a[108:111],v[76:79]
SA s32,s32,s64
M v[76:79],v[36:39],a[100:103],v[76:79]
SA s32,s32,33554432
M v[76:79],v[32:35],a[236:239],v[76:79]
s_waitcnt lgkmcnt(6)
M v[84:87],a[144:147],a[232:235],v[84:87]
s_mov_b32 s25, 1048832
T v[32:33],v18,28672
T v[34:35],v18,30720
M v[84:87],a[148:151],a[96:99],v[84:87]
SA m0,s4,81920
M v[84:87],a[152:155],a[104:107],v[84:87]
s_waitcnt lgkmcnt(2)
s_nop 0
T v[36:37],v14,0
T v[38:39],v14,2048
M v[84:87],a[156:159],a[112:115],v[84:87]
s_sub_u32 s64, s42, 10
T v[40:41],v14,4096
T v[42:43],v14,6144
M v[84:87],a[160:163],a[120:123],v[84:87]
s_and_b32 s35, s64, 536870912
buffer_load_dwordx4 v8, s[52:55], s25 offen lds
M v[84:87],a[164:167],a[128:131],v[84:87]
s_nop 0
T v[44:45],v14,8192
T v[46:47],v14,10240
M v[84:87],a[168:171],a[136:139],v[84:87]
T v[48:49],v14,12288
T v[50:51],v14,14336
M v[92:95],a[168:171],a[140:143],v[92:95]
s_mov_b32 s25, 1310976
v_or_b32 v6, s35, v7
M v[92:95],a[164:167],a[132:135],v[92:95]
SA m0,s4,86016
T v[52:53],v14,16384
T v[54:55],v14,18432
M v[92:95],a[160:163],a[124:127],v[92:95]
s_lshl_b32 s28, s20, 13
T v[56:57],v14,20480
T v[58:59],v14,22528
M v[92:95],a[156:159],a[116:119],v[92:95]
buffer_load_dwordx4 v8, s[52:55], s25 offen lds
M v[92:95],a[152:155],a[108:111],v[92:95]
v_add_u32 v2, 0x10000, v7
v_add_u32 v3, s28, v7
M v[92:95],a[148:151],a[100:103],v[92:95]
v_add_u32 v4, 0x1000, v3
MF v68,s5,v68
M v[92:95],a[144:147],a[236:239],v[92:95]
s_waitcnt lgkmcnt(6)
MF v69,s5,v69
MF v70,s5,v70
M v[100:103],v[32:35],a[232:235],v[100:103]
s_mov_b32 s25, 1573120
T a[144:145],v19,28672
T a[146:147],v19,30720
M v[100:103],v[36:39],a[96:99],v[100:103]
SA m0,s4,90112
MF v71,s5,v71
MF v84,s5,v84
M v[100:103],v[40:43],a[104:107],v[100:103]
s_waitcnt lgkmcnt(2)
T a[148:149],v15,0
T a[150:151],v15,2048
M v[100:103],v[44:47],a[112:115],v[100:103]
s_lshl_b32 s64, s42, 16
T a[152:153],v15,4096
T a[154:155],v15,6144
M v[100:103],v[48:51],a[120:123],v[100:103]
SA s23,s21,s64
buffer_load_dwordx4 v8, s[52:55], s25 offen lds
M v[100:103],v[52:55],a[128:131],v[100:103]
SA s43,s23,16777216
T a[156:157],v15,8192
T a[158:159],v15,10240
M v[100:103],v[56:59],a[136:139],v[100:103]
SA s26,s21,16777216
T a[160:161],v15,12288
T a[162:163],v15,14336
M v[108:111],v[56:59],a[140:143],v[108:111]
s_mov_b32 s25, 1835264
MF v85,s5,v85
MF v86,s5,v86
M v[108:111],v[52:55],a[132:135],v[108:111]
SA m0,s4,94208
T a[164:165],v15,16384
T a[166:167],v15,18432
M v[108:111],v[48:51],a[124:127],v[108:111]
s_mov_b32 s22, 0x7fff
T a[168:169],v15,20480
T a[170:171],v15,22528
M v[108:111],v[44:47],a[116:119],v[108:111]
s_sub_u32 s27, s42, 1
buffer_load_dwordx4 v8, s[52:55], s25 offen lds
M v[108:111],v[40:43],a[108:111],v[108:111]
s_cmp_eq_u32 s42, 0
MF v87,s5,v87
C v68,v68,v69
M v[108:111],v[36:39],a[100:103],v[108:111]
s_waitcnt vmcnt(9) lgkmcnt(0)
C v69,v70,v71
C v70,v84,v85
M v[108:111],v[32:35],a[236:239],v[108:111]
s_barrier
M v[116:119],a[144:147],a[232:235],v[116:119]
s_mov_b32 s25, 2097408
T v[32:33],v16,49152
T v[34:35],v16,51200
M v[116:119],a[148:151],a[96:99],v[116:119]
s_cselect_b32 s64, 32768, 0
C v71,v86,v87
W a0,v68
M v[116:119],a[152:155],a[104:107],v[116:119]
SA m0,s4,155648
T v[36:37],v16,53248
T v[38:39],v16,55296
M v[116:119],a[156:159],a[112:115],v[116:119]
SA s26,s26,s64
T v[40:41],v16,57344
T v[42:43],v16,59392
M v[116:119],a[160:163],a[120:123],v[116:119]
s_mov_b32 s31, 0x4b800000
buffer_load_dwordx4 v8, s[52:55], s25 offen lds
M v[116:119],a[164:167],a[128:131],v[116:119]
s_mov_b32 s24, 0x33800000
T v[44:45],v16,61440
T v[46:47],v16,63488
M v[116:119],a[168:171],a[136:139],v[116:119]
s_lshl_b32 s47, s66, 7
T v[48:49],v20,32768
T v[50:51],v20,34816
M v[124:127],a[168:171],a[140:143],v[124:127]
s_mov_b32 s25, 2359552
W a1,v69
W a2,v70
M v[124:127],a[164:167],a[132:135],v[124:127]
SA m0,s4,159744
T v[52:53],v20,36864
T v[54:55],v20,38912
M v[124:127],a[160:163],a[124:127],v[124:127]
SA s47,s47,s46
T v[56:57],v20,40960
T v[58:59],v20,43008
M v[124:127],a[156:159],a[116:119],v[124:127]
s_lshl_b32 s64, s20, 5
buffer_load_dwordx4 v8, s[52:55], s25 offen lds
M v[124:127],a[152:155],a[108:111],v[124:127]
SA s47,s47,s64
W a3,v71
MF v76,s5,v76
M v[124:127],a[148:151],a[100:103],v[124:127]
SA s47,s47,2048
MF v77,s5,v77
MF v78,s5,v78
M v[124:127],a[144:147],a[236:239],v[124:127]
s_waitcnt lgkmcnt(6)
MF v79,s5,v79
MF v92,s5,v92
M v[132:135],v[32:35],a[176:179],0
s_lshl_b32 s65, s41, 3
T a[144:145],v17,49152
T a[146:147],v17,51200
M v[132:135],v[36:39],a[184:187],v[132:135]
SA s65,s65,s66
MF v93,s5,v93
MF v94,s5,v94
M v[132:135],v[40:43],a[192:195],v[132:135]
s_waitcnt lgkmcnt(2)
T a[148:149],v17,53248
T a[150:151],v17,55296
M v[132:135],v[44:47],a[200:203],v[132:135]
s_mul_i32 s34, s65, 73728
T a[152:153],v17,57344
T a[154:155],v17,59392
M v[132:135],v[48:51],a[208:211],v[132:135]
SA s34,s34,136314880
MF v95,s5,v95
C v76,v76,v77
M v[132:135],v[52:55],a[216:219],v[132:135]
s_lshl_b32 s65, s42, 4
T a[156:157],v17,61440
T a[158:159],v17,63488
M v[132:135],v[56:59],a[224:227],v[132:135]
SA s65,s65,s41
T a[160:161],v21,32768
T a[162:163],v21,34816
M v[140:143],v[56:59],a[228:231],0
s_mul_i32 s33, s65, 114688
C v77,v78,v79
C v78,v92,v93
M v[140:143],v[52:55],a[220:223],v[140:143]
s_mul_i32 s65, s20, 28672
T a[164:165],v21,36864
T a[166:167],v21,38912
M v[140:143],v[48:51],a[212:215],v[140:143]
SA s33,s33,s65
T a[168:169],v21,40960
T a[170:171],v21,43008
M v[140:143],v[44:47],a[204:207],v[140:143]
SA s33,s33,67108864
C v79,v94,v95
W a32,v76
M v[140:143],v[40:43],a[196:199],v[140:143]
s_mov_b32 s6, 0
W a33,v77
W a34,v78
M v[140:143],v[36:39],a[188:191],v[140:143]
s_mov_b32 s7, 0
W a35,v79
MF v100,s5,v100
M v[140:143],v[32:35],a[180:183],v[140:143]
s_waitcnt lgkmcnt(6)
MF v101,s5,v101
MF v102,s5,v102
M v[148:151],a[144:147],a[176:179],0
s_mov_b32 s40, 1
T v[32:33],v18,49152
T v[34:35],v18,51200
M v[148:151],a[148:151],a[184:187],v[148:151]
s_cmp_eq_u32 s20, 0
MF v103,s5,v103
MF v116,s5,v116
M v[148:151],a[152:155],a[192:195],v[148:151]
s_waitcnt lgkmcnt(2)
T v[36:37],v18,53248
T v[38:39],v18,55296
M v[148:151],a[156:159],a[200:203],v[148:151]
s_cselect_b32 s39, 7, 4
T v[40:41],v18,57344
T v[42:43],v18,59392
M v[148:151],a[160:163],a[208:211],v[148:151]
s_lshl_b32 s64, s41, 1
MF v117,s5,v117
MF v118,s5,v118
M v[148:151],a[164:167],a[216:219],v[148:151]
SA s64,s64,s20
T v[44:45],v18,61440
T v[46:47],v18,63488
M v[148:151],a[168:171],a[224:227],v[148:151]
s_cmp_lt_u32 s64, 30
T v[48:49],v22,32768
T v[50:51],v22,34816
M v[156:159],a[168:171],a[228:231],0
s_cselect_b32 s64, 32798, 0
MF v119,s5,v119
C v100,v100,v101
M v[156:159],a[164:167],a[220:223],v[156:159]
s_cmp_ge_u32 s20, 2
T v[52:53],v22,36864
T v[54:55],v22,38912
M v[156:159],a[160:163],a[212:215],v[156:159]
s_cselect_b32 s64, s64, 0
T v[56:57],v22,40960
T v[58:59],v22,43008
M v[156:159],a[156:159],a[204:207],v[156:159]
s_cmp_eq_u32 s42, 6
C v101,v102,v103
C v102,v116,v117
M v[156:159],a[152:155],a[196:199],v[156:159]
s_cselect_b32 s64, s64, 0
C v103,v118,v119
W a4,v100
M v[156:159],a[148:151],a[188:191],v[156:159]
s_or_b32 s39, s39, s64
W a5,v101
W a6,v102
M v[156:159],a[144:147],a[180:183],v[156:159]
s_waitcnt lgkmcnt(6)
W a7,v103
MF v108,s5,v108
M v[164:167],v[32:35],a[176:179],0
s_mov_b64 s[60:61], s[76:77]
T a[144:145],v19,49152
T a[146:147],v19,51200
M v[164:167],v[36:39],a[184:187],v[164:167]
s_mov_b32 s62, s78
MF v109,s5,v109
MF v110,s5,v110
M v[164:167],v[40:43],a[192:195],v[164:167]
s_waitcnt lgkmcnt(2)
T a[148:149],v19,53248
T a[150:151],v19,55296
M v[164:167],v[44:47],a[200:203],v[164:167]
s_mov_b32 s63, 0x20000
T a[152:153],v19,57344
T a[154:155],v19,59392
M v[164:167],v[48:51],a[208:211],v[164:167]
s_mov_b32 s25, 2621696
v_lshrrev_b32 v24, 4, v0
v_lshlrev_b32 v24, 2, v24
M v[164:167],v[52:55],a[216:219],v[164:167]
SA m0,s4,131072
T a[156:157],v19,61440
T a[158:159],v19,63488
M v[164:167],v[56:59],a[224:227],v[164:167]
SA s3,s93,532480
T a[160:161],v23,32768
T a[162:163],v23,34816
M v[172:175],v[56:59],a[228:231],0
buffer_load_dwordx4 v8, s[52:55], s25 offen lds
M v[172:175],v[52:55],a[220:223],v[172:175]
s_nop 0
T a[164:165],v23,36864
T a[166:167],v23,38912
M v[172:175],v[48:51],a[212:215],v[172:175]
T a[168:169],v23,40960
T a[170:171],v23,43008
M v[172:175],v[44:47],a[204:207],v[172:175]
s_mov_b32 s25, 2883840
buffer_store_dwordx4 v[96:99], v7, s[8:11], s3 offen offset:0 sc1
M v[172:175],v[40:43],a[196:199],v[172:175]
SA m0,s4,135168
v_and_b32 v25, 15, v0
v_sub_u32 v24, v24, v25
M v[172:175],v[36:39],a[188:191],v[172:175]
buffer_load_dwordx4 v8, s[52:55], s25 offen lds
M v[172:175],v[32:35],a[180:183],v[172:175]
s_waitcnt lgkmcnt(6)
v_cmp_lt_i32 s[16:17], 0, v24
v_cmp_lt_i32 s[18:19], -1, v24
M v[180:183],a[144:147],a[176:179],0
T v[32:33],v20,45056
T v[34:35],v20,47104
M v[180:183],a[148:151],a[184:187],v[180:183]
s_mov_b32 s25, 3145984
buffer_store_dwordx4 v[104:107], v7, s[8:11], s3 offen offset:1024 sc1
M v[180:183],a[152:155],a[192:195],v[180:183]
s_waitcnt lgkmcnt(2)
s_nop 0
T v[36:37],v20,49152
T v[38:39],v20,51200
M v[180:183],a[156:159],a[200:203],v[180:183]
SA m0,s4,139264
T v[40:41],v20,53248
T v[42:43],v20,55296
M v[180:183],a[160:163],a[208:211],v[180:183]
buffer_load_dwordx4 v8, s[52:55], s25 offen lds
M v[180:183],a[164:167],a[216:219],v[180:183]
s_nop 0
T v[44:45],v20,57344
T v[46:47],v20,59392
M v[180:183],a[168:171],a[224:227],v[180:183]
T v[48:49],v20,61440
T v[50:51],v20,63488
M v[188:191],a[168:171],a[228:231],0
s_mov_b32 s25, 3408128
buffer_store_dwordx4 v[112:115], v7, s[8:11], s3 offen offset:2048 sc1
M v[188:191],a[164:167],a[220:223],v[188:191]
SA m0,s4,143360
T v[52:53],v16,32768
T v[54:55],v16,34816
M v[188:191],a[160:163],a[212:215],v[188:191]
T v[56:57],v16,36864
T v[58:59],v16,38912
M v[188:191],a[156:159],a[204:207],v[188:191]
buffer_load_dwordx4 v8, s[52:55], s25 offen lds
M v[188:191],a[152:155],a[196:199],v[188:191]
v_cmp_lt_i32 s[48:49], -2, v24
v_cmp_lt_i32 s[50:51], -3, v24
M v[188:191],a[148:151],a[188:191],v[188:191]
buffer_store_dwordx4 v[120:123], v7, s[8:11], s3 offen offset:3072 sc1
M v[188:191],a[144:147],a[180:183],v[188:191]
s_waitcnt lgkmcnt(6)
v_lshl_add_u32 v25, v0, 7, s95
v_and_b32 v0, 48, v0
M v[132:135],v[32:35],a[232:235],v[132:135]
s_mov_b32 s25, 384
T a[144:145],v21,45056
T a[146:147],v21,47104
M v[132:135],v[36:39],a[96:99],v[132:135]
SA m0,s4,0
v_lshl_add_u32 v0, v0, 24, v25
v_mov_b32 v24, 0x3f80
M v[132:135],v[40:43],a[104:107],v[132:135]
s_waitcnt lgkmcnt(2)
T a[148:149],v21,49152
T a[150:151],v21,51200
M v[132:135],v[44:47],a[112:115],v[132:135]
T a[152:153],v21,53248
T a[154:155],v21,55296
M v[132:135],v[48:51],a[120:123],v[132:135]
buffer_load_dwordx4 v8, s[52:55], s25 offen lds
M v[132:135],v[52:55],a[128:131],v[132:135]
s_nop 0
T a[156:157],v21,57344
T a[158:159],v21,59392
M v[132:135],v[56:59],a[136:139],v[132:135]
T a[160:161],v21,61440
T a[162:163],v21,63488
M v[140:143],v[56:59],a[140:143],v[140:143]
s_mov_b32 s25, 262528
MF v111,s5,v111
MF v124,s5,v124
M v[140:143],v[52:55],a[132:135],v[140:143]
SA m0,s4,4096
T a[164:165],v17,32768
T a[166:167],v17,34816
M v[140:143],v[48:51],a[124:127],v[140:143]
T a[168:169],v17,36864
T a[170:171],v17,38912
M v[140:143],v[44:47],a[116:119],v[140:143]
buffer_load_dwordx4 v8, s[52:55], s25 offen lds
M v[140:143],v[40:43],a[108:111],v[140:143]
MF v125,s5,v125
MF v126,s5,v126
M v[140:143],v[36:39],a[100:103],v[140:143]
MF v127,s5,v127
C v108,v108,v109
M v[140:143],v[32:35],a[236:239],v[140:143]
s_waitcnt lgkmcnt(6)
C v109,v110,v111
C v110,v124,v125
M v[148:151],a[144:147],a[232:235],v[148:151]
s_mov_b32 s25, 524672
T v[32:33],v22,45056
T v[34:35],v22,47104
M v[148:151],a[148:151],a[96:99],v[148:151]
SA m0,s4,8192
C v111,v126,v127
W a36,v108
M v[148:151],a[152:155],a[104:107],v[148:151]
s_waitcnt lgkmcnt(2)
T v[36:37],v22,49152
T v[38:39],v22,51200
M v[148:151],a[156:159],a[112:115],v[148:151]
T v[40:41],v22,53248
T v[42:43],v22,55296
M v[148:151],a[160:163],a[120:123],v[148:151]
buffer_load_dwordx4 v8, s[52:55], s25 offen lds
M v[148:151],a[164:167],a[128:131],v[148:151]
s_nop 0
T v[44:45],v22,57344
T v[46:47],v22,59392
M v[148:151],a[168:171],a[136:139],v[148:151]
T v[48:49],v22,61440
T v[50:51],v22,63488
M v[156:159],a[168:171],a[140:143],v[156:159]
s_mov_b32 s25, 786816
W a37,v109
W a38,v110
M v[156:159],a[164:167],a[132:135],v[156:159]
SA m0,s4,12288
T v[52:53],v18,32768
T v[54:55],v18,34816
M v[156:159],a[160:163],a[124:127],v[156:159]
T v[56:57],v18,36864
T v[58:59],v18,38912
M v[156:159],a[156:159],a[116:119],v[156:159]
buffer_load_dwordx4 v8, s[52:55], s25 offen lds
M v[156:159],a[152:155],a[108:111],v[156:159]
W a39,v111
v_lshrrev_b32 v25, 8, v7
M v[156:159],a[148:151],a[100:103],v[156:159]
v_bfe_u32 v26, v7, 6, 2
v_and_b32 v27, 16, v7
v_lshlrev_b32 v27, v27, v24
v_cmp_eq_u32 vcc, v25, v26
v_and_b32 v28, 32, v7
W a244,0
v_cndmask_b32 v27, 0, v27, vcc
v_cmp_eq_u32 vcc, 0, v28
W a245,0
W a248,0
v_cndmask_b32 v25, 0, v27, vcc
v_sub_u32 v26, v27, v25
W a249,0
W a246,v25
W a247,v26
M v[156:159],a[144:147],a[236:239],v[156:159]
s_waitcnt lgkmcnt(6)
MF v132,s5,v132
MF v133,s5,v133
M v[164:167],v[32:35],a[232:235],v[164:167]
s_mov_b32 s25, 1048960
T a[144:145],v23,45056
T a[146:147],v23,47104
M v[164:167],v[36:39],a[96:99],v[164:167]
SA m0,s4,16384
MF v134,s5,v134
MF v135,s5,v135
M v[164:167],v[40:43],a[104:107],v[164:167]
s_waitcnt lgkmcnt(2)
T a[148:149],v23,49152
T a[150:151],v23,51200
M v[164:167],v[44:47],a[112:115],v[164:167]
T a[152:153],v23,53248
T a[154:155],v23,55296
M v[164:167],v[48:51],a[120:123],v[164:167]
buffer_load_dwordx4 v8, s[52:55], s25 offen lds
M v[164:167],v[52:55],a[128:131],v[164:167]
s_nop 0
T a[156:157],v23,57344
T a[158:159],v23,59392
M v[164:167],v[56:59],a[136:139],v[164:167]
T a[160:161],v23,61440
T a[162:163],v23,63488
M v[172:175],v[56:59],a[140:143],v[172:175]
s_mov_b32 s25, 1311104
MF v148,s5,v148
MF v149,s5,v149
M v[172:175],v[52:55],a[132:135],v[172:175]
SA m0,s4,20480
T a[164:165],v19,32768
T a[166:167],v19,34816
M v[172:175],v[48:51],a[124:127],v[172:175]
T a[168:169],v19,36864
T a[170:171],v19,38912
M v[172:175],v[44:47],a[116:119],v[172:175]
buffer_load_dwordx4 v8, s[52:55], s25 offen lds
M v[172:175],v[40:43],a[108:111],v[172:175]
MF v150,s5,v150
MF v151,s5,v151
M v[172:175],v[36:39],a[100:103],v[172:175]
s_waitcnt vmcnt(7) lgkmcnt(0)
C v132,v132,v133
C v133,v134,v135
M v[172:175],v[32:35],a[236:239],v[172:175]
s_barrier
M v[180:183],a[144:147],a[232:235],v[180:183]
s_mov_b32 s25, 1573248
T v[32:33],v20,0
T v[34:35],v20,2048
M v[180:183],a[148:151],a[96:99],v[180:183]
SA m0,s4,24576
C v134,v148,v149
C v135,v150,v151
M v[180:183],a[152:155],a[104:107],v[180:183]
T v[36:37],v20,4096
T v[38:39],v20,6144
M v[180:183],a[156:159],a[112:115],v[180:183]
T v[40:41],v20,8192
T v[42:43],v20,10240
M v[180:183],a[160:163],a[120:123],v[180:183]
buffer_load_dwordx4 v8, s[52:55], s25 offen lds
M v[180:183],a[164:167],a[128:131],v[180:183]
s_nop 0
T v[44:45],v20,12288
T v[46:47],v20,14336
M v[180:183],a[168:171],a[136:139],v[180:183]
T v[48:49],v20,16384
T v[50:51],v20,18432
M v[188:191],a[168:171],a[140:143],v[188:191]
s_mov_b32 s25, 1835392
W a8,v132
W a9,v133
M v[188:191],a[164:167],a[132:135],v[188:191]
SA m0,s4,28672
T v[52:53],v20,20480
T v[54:55],v20,22528
M v[188:191],a[160:163],a[124:127],v[188:191]
T v[56:57],v20,24576
T v[58:59],v20,26624
M v[188:191],a[156:159],a[116:119],v[188:191]
buffer_load_dwordx4 v8, s[52:55], s25 offen lds
M v[188:191],a[152:155],a[108:111],v[188:191]
W a10,v134
W a11,v135
M v[188:191],a[148:151],a[100:103],v[188:191]
v_lshrrev_b32 v31, 6, v7
v_bfe_u32 v28, v7, 4, 2
M v[188:191],a[144:147],a[236:239],v[188:191]
s_waitcnt lgkmcnt(6)
v_lshlrev_b32 v31, 5, v31
v_add_lshl_u32 v31, v31, v28, 2
M v[68:71],v[32:35],a[176:179],0
s_mov_b32 s25, 2097536
T a[144:145],v21,0
T a[146:147],v21,2048
M v[68:71],v[36:39],a[184:187],v[68:71]
SA m0,s4,40960
buffer_load_dword v5, v31, s[8:11], s46 offen offset:4 sc1
M v[68:71],v[40:43],a[192:195],v[68:71]
s_waitcnt lgkmcnt(2)
s_nop 0
T a[148:149],v21,4096
T a[150:151],v21,6144
M v[68:71],v[44:47],a[200:203],v[68:71]
T a[152:153],v21,8192
T a[154:155],v21,10240
M v[68:71],v[48:51],a[208:211],v[68:71]
buffer_load_dwordx4 v8, s[52:55], s25 offen lds
M v[68:71],v[52:55],a[216:219],v[68:71]
s_nop 0
T a[156:157],v21,12288
T a[158:159],v21,14336
M v[68:71],v[56:59],a[224:227],v[68:71]
T a[160:161],v21,16384
T a[162:163],v21,18432
M v[76:79],v[56:59],a[228:231],0
s_mov_b32 s25, 2359680
MF v140,s5,v140
MF v141,s5,v141
M v[76:79],v[52:55],a[220:223],v[76:79]
SA m0,s4,45056
T a[164:165],v21,20480
T a[166:167],v21,22528
M v[76:79],v[48:51],a[212:215],v[76:79]
T a[168:169],v21,24576
T a[170:171],v21,26624
M v[76:79],v[44:47],a[204:207],v[76:79]
SA s3,s93,262144
buffer_load_dwordx4 v8, s[52:55], s25 offen lds
M v[76:79],v[40:43],a[196:199],v[76:79]
MF v142,s5,v142
MF v143,s5,v143
M v[76:79],v[36:39],a[188:191],v[76:79]
MF v156,s5,v156
MF v157,s5,v157
M v[76:79],v[32:35],a[180:183],v[76:79]
s_waitcnt lgkmcnt(6)
MF v158,s5,v158
MF v159,s5,v159
M v[84:87],a[144:147],a[176:179],0
s_mov_b32 s25, 2621824
T v[32:33],v22,0
T v[34:35],v22,2048
M v[84:87],a[148:151],a[184:187],v[84:87]
SA m0,s4,49152
buffer_store_dwordx4 v[128:131], v7, s[8:11], s3 offen offset:0 sc1
M v[84:87],a[152:155],a[192:195],v[84:87]
s_waitcnt lgkmcnt(2)
s_nop 0
T v[36:37],v22,4096
T v[38:39],v22,6144
M v[84:87],a[156:159],a[200:203],v[84:87]
T v[40:41],v22,8192
T v[42:43],v22,10240
M v[84:87],a[160:163],a[208:211],v[84:87]
buffer_load_dwordx4 v8, s[52:55], s25 offen lds
M v[84:87],a[164:167],a[216:219],v[84:87]
s_nop 0
T v[44:45],v22,12288
T v[46:47],v22,14336
M v[84:87],a[168:171],a[224:227],v[84:87]
T v[48:49],v22,16384
T v[50:51],v22,18432
M v[92:95],a[168:171],a[228:231],0
s_mov_b32 s25, 2883968
buffer_store_dwordx4 v[136:139], v7, s[8:11], s3 offen offset:1024 sc1
M v[92:95],a[164:167],a[220:223],v[92:95]
SA m0,s4,53248
T v[52:53],v22,20480
T v[54:55],v22,22528
M v[92:95],a[160:163],a[212:215],v[92:95]
T v[56:57],v22,24576
T v[58:59],v22,26624
M v[92:95],a[156:159],a[204:207],v[92:95]
buffer_load_dwordx4 v8, s[52:55], s25 offen lds
M v[92:95],a[152:155],a[196:199],v[92:95]
C v140,v140,v141
C v141,v142,v143
M v[92:95],a[148:151],a[188:191],v[92:95]
buffer_store_dwordx4 v[144:147], v7, s[8:11], s3 offen offset:2048 sc1
M v[92:95],a[144:147],a[180:183],v[92:95]
s_waitcnt lgkmcnt(6)
C v142,v156,v157
C v143,v158,v159
M v[100:103],v[32:35],a[176:179],0
s_mov_b32 s25, 3146112
T a[144:145],v23,0
T a[146:147],v23,2048
M v[100:103],v[36:39],a[184:187],v[100:103]
SA m0,s4,57344
buffer_store_dwordx4 v[152:155], v7, s[8:11], s3 offen offset:3072 sc1
M v[100:103],v[40:43],a[192:195],v[100:103]
s_waitcnt lgkmcnt(2)
s_nop 0
T a[148:149],v23,4096
T a[150:151],v23,6144
M v[100:103],v[44:47],a[200:203],v[100:103]
T a[152:153],v23,8192
T a[154:155],v23,10240
M v[100:103],v[48:51],a[208:211],v[100:103]
buffer_load_dwordx4 v8, s[52:55], s25 offen lds
M v[100:103],v[52:55],a[216:219],v[100:103]
s_nop 0
T a[156:157],v23,12288
T a[158:159],v23,14336
M v[100:103],v[56:59],a[224:227],v[100:103]
T a[160:161],v23,16384
T a[162:163],v23,18432
M v[108:111],v[56:59],a[228:231],0
s_mov_b32 s25, 3408256
W a40,v140
W a41,v141
M v[108:111],v[52:55],a[220:223],v[108:111]
SA m0,s4,61440
T a[164:165],v23,20480
T a[166:167],v23,22528
M v[108:111],v[48:51],a[212:215],v[108:111]
T a[168:169],v23,24576
T a[170:171],v23,26624
M v[108:111],v[44:47],a[204:207],v[108:111]
buffer_load_dwordx4 v8, s[52:55], s25 offen lds
M v[108:111],v[40:43],a[196:199],v[108:111]
W a42,v142
W a43,v143
M v[108:111],v[36:39],a[188:191],v[108:111]
v_mov_b32 v8, 0xff800000
MF v164,s5,v164
M v[108:111],v[32:35],a[180:183],v[108:111]
s_waitcnt lgkmcnt(6)
MF v165,s5,v165
MF v166,s5,v166
M v[116:119],a[144:147],a[176:179],0
T v[32:33],v20,28672
T v[34:35],v20,30720
M v[116:119],a[148:151],a[184:187],v[116:119]
MF v167,s5,v167
MF v180,s5,v180
M v[116:119],a[152:155],a[192:195],v[116:119]
s_waitcnt lgkmcnt(2)
T v[36:37],v12,24576
T v[38:39],v12,26624
M v[116:119],a[156:159],a[200:203],v[116:119]
T v[40:41],v12,28672
T v[42:43],v12,30720
M v[116:119],a[160:163],a[208:211],v[116:119]
MF v181,s5,v181
MF v182,s5,v182
M v[116:119],a[164:167],a[216:219],v[116:119]
T v[44:45],v12,0
T v[46:47],v12,2048
M v[116:119],a[168:171],a[224:227],v[116:119]
T v[48:49],v12,4096
T v[50:51],v12,6144
M v[124:127],a[168:171],a[228:231],0
MF v183,s5,v183
C v164,v164,v165
M v[124:127],a[164:167],a[220:223],v[124:127]
T v[52:53],v12,8192
T v[54:55],v12,10240
M v[124:127],a[160:163],a[212:215],v[124:127]
T v[56:57],v12,12288
T v[58:59],v12,14336
M v[124:127],a[156:159],a[204:207],v[124:127]
C v165,v166,v167
C v166,v180,v181
M v[124:127],a[152:155],a[196:199],v[124:127]
C v167,v182,v183
W a12,v164
M v[124:127],a[148:151],a[188:191],v[124:127]
W a13,v165
W a14,v166
M v[124:127],a[144:147],a[180:183],v[124:127]
s_waitcnt lgkmcnt(6)
W a15,v167
MF v172,s5,v172
M v[68:71],v[32:35],a[232:235],v[68:71]
T a[144:145],v21,28672
T a[146:147],v21,30720
M v[68:71],v[36:39],a[96:99],v[68:71]
MF v173,s5,v173
MF v174,s5,v174
M v[68:71],v[40:43],a[104:107],v[68:71]
s_waitcnt lgkmcnt(2)
T a[148:149],v13,24576
T a[150:151],v13,26624
M v[68:71],v[44:47],a[112:115],v[68:71]
T a[152:153],v13,28672
T a[154:155],v13,30720
M v[68:71],v[48:51],a[120:123],v[68:71]
MF v175,s5,v175
MF v188,s5,v188
M v[68:71],v[52:55],a[128:131],v[68:71]
T a[156:157],v13,0
T a[158:159],v13,2048
M v[68:71],v[56:59],a[136:139],v[68:71]
T a[160:161],v13,4096
T a[162:163],v13,6144
M v[76:79],v[56:59],a[140:143],v[76:79]
MF v189,s5,v189
MF v190,s5,v190
M v[76:79],v[52:55],a[132:135],v[76:79]
T a[164:165],v13,8192
T a[166:167],v13,10240
M v[76:79],v[48:51],a[124:127],v[76:79]
T a[168:169],v13,12288
T a[170:171],v13,14336
M v[76:79],v[44:47],a[116:119],v[76:79]
MF v191,s5,v191
C v172,v172,v173
M v[76:79],v[40:43],a[108:111],v[76:79]
C v173,v174,v175
C v174,v188,v189
M v[76:79],v[36:39],a[100:103],v[76:79]
C v175,v190,v191
W a44,v172
M v[76:79],v[32:35],a[236:239],v[76:79]
s_waitcnt lgkmcnt(6)
W a45,v173
W a46,v174
M v[84:87],a[144:147],a[232:235],v[84:87]
T v[32:33],v22,28672
T v[34:35],v22,30720
M v[84:87],a[148:151],a[96:99],v[84:87]
W a47,v175
s_waitcnt vmcnt(10)
v_cmp_ne_u32 vcc, 1, v5
M v[84:87],a[152:155],a[104:107],v[84:87]
s_waitcnt lgkmcnt(2)
T v[36:37],v14,24576
T v[38:39],v14,26624
M v[84:87],a[156:159],a[112:115],v[84:87]
s_nop 0
T v[40:41],v14,28672
T v[42:43],v14,30720
M v[84:87],a[160:163],a[120:123],v[84:87]
s_cmp_lg_u32 vcc_lo, 0
M v[84:87],a[164:167],a[128:131],v[84:87]
s_cbranch_scc1 L_wsq0
L_wrq0:
T v[44:45],v14,0
T v[46:47],v14,2048
M v[84:87],a[168:171],a[136:139],v[84:87]
SA m0,s28,98304
T v[48:49],v14,4096
T v[50:51],v14,6144
M v[92:95],a[168:171],a[140:143],v[92:95]
buffer_load_dwordx4 v3, s[8:11], s21 offen offset:0 sc1 lds
M v[92:95],a[164:167],a[132:135],v[92:95]
s_nop 0
T v[52:53],v14,8192
T v[54:55],v14,10240
M v[92:95],a[160:163],a[124:127],v[92:95]
T v[56:57],v14,12288
T v[58:59],v14,14336
M v[92:95],a[156:159],a[116:119],v[92:95]
buffer_load_dwordx4 v3, s[8:11], s21 offen offset:1024 sc1 lds
M v[92:95],a[152:155],a[108:111],v[92:95]
MF v68,s5,v68
MF v69,s5,v69
M v[92:95],a[148:151],a[100:103],v[92:95]
buffer_load_dwordx4 v3, s[8:11], s21 offen offset:2048 sc1 lds
M v[92:95],a[144:147],a[236:239],v[92:95]
s_waitcnt lgkmcnt(6)
MF v70,s5,v70
MF v71,s5,v71
M v[100:103],v[32:35],a[232:235],v[100:103]
T a[144:145],v23,28672
T a[146:147],v23,30720
M v[100:103],v[36:39],a[96:99],v[100:103]
buffer_load_dwordx4 v3, s[8:11], s21 offen offset:3072 sc1 lds
M v[100:103],v[40:43],a[104:107],v[100:103]
s_waitcnt lgkmcnt(2)
s_nop 0
T a[148:149],v15,24576
T a[150:151],v15,26624
M v[100:103],v[44:47],a[112:115],v[100:103]
SA m0,s28,102400
T a[152:153],v15,28672
T a[154:155],v15,30720
M v[100:103],v[48:51],a[120:123],v[100:103]
buffer_load_dwordx4 v4, s[8:11], s21 offen offset:0 sc1 lds
M v[100:103],v[52:55],a[128:131],v[100:103]
s_nop 0
T a[156:157],v15,0
T a[158:159],v15,2048
M v[100:103],v[56:59],a[136:139],v[100:103]
T a[160:161],v15,4096
T a[162:163],v15,6144
M v[108:111],v[56:59],a[140:143],v[108:111]
buffer_load_dwordx4 v4, s[8:11], s21 offen offset:1024 sc1 lds
M v[108:111],v[52:55],a[132:135],v[108:111]
s_nop 0
T a[164:165],v15,8192
T a[166:167],v15,10240
M v[108:111],v[48:51],a[124:127],v[108:111]
T a[168:169],v15,12288
T a[170:171],v15,14336
M v[108:111],v[44:47],a[116:119],v[108:111]
buffer_load_dwordx4 v4, s[8:11], s21 offen offset:2048 sc1 lds
M v[108:111],v[40:43],a[108:111],v[108:111]
MF v84,s5,v84
MF v85,s5,v85
M v[108:111],v[36:39],a[100:103],v[108:111]
s_waitcnt vmcnt(7) lgkmcnt(0)
buffer_load_dwordx4 v4, s[8:11], s21 offen offset:3072 sc1 lds
M v[108:111],v[32:35],a[236:239],v[108:111]
s_barrier
M v[116:119],a[144:147],a[232:235],v[116:119]
SA s21,s21,32768
T v[32:33],v16,0
T v[34:35],v16,2048
M v[116:119],a[148:151],a[96:99],v[116:119]
s_sub_u32 s22, s22, 1
MF v86,s5,v86
MF v87,s5,v87
M v[116:119],a[152:155],a[104:107],v[116:119]
s_cselect_b32 s21, s23, s21
T v[36:37],v16,4096
T v[38:39],v16,6144
M v[116:119],a[156:159],a[112:115],v[116:119]
SA m0,s28,65536
T v[40:41],v16,8192
T v[42:43],v16,10240
M v[116:119],a[160:163],a[120:123],v[116:119]
buffer_load_dwordx4 v3, s[8:11], s21 offen offset:0 sc1 lds
M v[116:119],a[164:167],a[128:131],v[116:119]
s_nop 0
T v[44:45],v16,12288
T v[46:47],v16,14336
M v[116:119],a[168:171],a[136:139],v[116:119]
T v[48:49],v16,16384
T v[50:51],v16,18432
M v[124:127],a[168:171],a[140:143],v[124:127]
buffer_load_dwordx4 v3, s[8:11], s21 offen offset:1024 sc1 lds
M v[124:127],a[164:167],a[132:135],v[124:127]
s_nop 0
T v[52:53],v16,20480
T v[54:55],v16,22528
M v[124:127],a[160:163],a[124:127],v[124:127]
T v[56:57],v16,24576
T v[58:59],v16,26624
M v[124:127],a[156:159],a[116:119],v[124:127]
buffer_load_dword v5, v31, s[8:11], s46 offen offset:4 sc1
M v[124:127],a[152:155],a[108:111],v[124:127]
buffer_load_dwordx4 v3, s[8:11], s21 offen offset:2048 sc1 lds
M v[124:127],a[148:151],a[100:103],v[124:127]
C v68,v68,v69
C v69,v70,v71
M v[124:127],a[144:147],a[236:239],v[124:127]
s_waitcnt lgkmcnt(6)
buffer_load_dwordx4 v3, s[8:11], s21 offen offset:3072 sc1 lds
M v[132:135],v[32:35],a[176:179],0
SA m0,s28,69632
T a[144:145],v17,0
T a[146:147],v17,2048
M v[132:135],v[36:39],a[184:187],v[132:135]
buffer_load_dwordx4 v4, s[8:11], s21 offen offset:0 sc1 lds
M v[132:135],v[40:43],a[192:195],v[132:135]
s_waitcnt lgkmcnt(2)
s_nop 0
T a[148:149],v17,4096
T a[150:151],v17,6144
M v[132:135],v[44:47],a[200:203],v[132:135]
T a[152:153],v17,8192
T a[154:155],v17,10240
M v[132:135],v[48:51],a[208:211],v[132:135]
buffer_load_dwordx4 v4, s[8:11], s21 offen offset:1024 sc1 lds
M v[132:135],v[52:55],a[216:219],v[132:135]
s_nop 0
T a[156:157],v17,12288
T a[158:159],v17,14336
M v[132:135],v[56:59],a[224:227],v[132:135]
T a[160:161],v17,16384
T a[162:163],v17,18432
M v[140:143],v[56:59],a[228:231],0
buffer_load_dwordx4 v4, s[8:11], s21 offen offset:2048 sc1 lds
M v[140:143],v[52:55],a[220:223],v[140:143]
s_nop 0
T a[164:165],v17,20480
T a[166:167],v17,22528
M v[140:143],v[48:51],a[212:215],v[140:143]
T a[168:169],v17,24576
T a[170:171],v17,26624
M v[140:143],v[44:47],a[204:207],v[140:143]
SA s3,s93,270336
buffer_load_dwordx4 v4, s[8:11], s21 offen offset:3072 sc1 lds
M v[140:143],v[40:43],a[196:199],v[140:143]
SA s21,s21,32768
C v70,v84,v85
C v71,v86,v87
M v[140:143],v[36:39],a[188:191],v[140:143]
s_sub_u32 s22, s22, 1
W a16,v68
W a17,v69
M v[140:143],v[32:35],a[180:183],v[140:143]
s_waitcnt lgkmcnt(6)
W a18,v70
W a19,v71
M v[148:151],a[144:147],a[176:179],0
s_cselect_b32 s21, s23, s21
T v[32:33],v18,0
T v[34:35],v18,2048
M v[148:151],a[148:151],a[184:187],v[148:151]
buffer_store_dwordx4 v[160:163], v7, s[8:11], s3 offen offset:0 sc1
M v[148:151],a[152:155],a[192:195],v[148:151]
s_waitcnt lgkmcnt(2)
s_nop 0
T v[36:37],v18,4096
T v[38:39],v18,6144
M v[148:151],a[156:159],a[200:203],v[148:151]
T v[40:41],v18,8192
T v[42:43],v18,10240
M v[148:151],a[160:163],a[208:211],v[148:151]
buffer_store_dwordx4 v[168:171], v7, s[8:11], s3 offen offset:1024 sc1
M v[148:151],a[164:167],a[216:219],v[148:151]
s_nop 0
T v[44:45],v18,12288
T v[46:47],v18,14336
M v[148:151],a[168:171],a[224:227],v[148:151]
T v[48:49],v18,16384
T v[50:51],v18,18432
M v[156:159],a[168:171],a[228:231],0
buffer_store_dwordx4 v[176:179], v7, s[8:11], s3 offen offset:2048 sc1
M v[156:159],a[164:167],a[220:223],v[156:159]
s_nop 0
T v[52:53],v18,20480
T v[54:55],v18,22528
M v[156:159],a[160:163],a[212:215],v[156:159]
T v[56:57],v18,24576
T v[58:59],v18,26624
M v[156:159],a[156:159],a[204:207],v[156:159]
buffer_store_dwordx4 v[184:187], v7, s[8:11], s3 offen offset:3072 sc1
M v[156:159],a[152:155],a[196:199],v[156:159]
MF v76,s5,v76
MF v77,s5,v77
M v[156:159],a[148:151],a[188:191],v[156:159]
MF v78,s5,v78
MF v79,s5,v79
M v[156:159],a[144:147],a[180:183],v[156:159]
s_waitcnt lgkmcnt(6)
MF v92,s5,v92
MF v93,s5,v93
M v[164:167],v[32:35],a[176:179],0
T a[144:145],v19,0
T a[146:147],v19,2048
M v[164:167],v[36:39],a[184:187],v[164:167]
MF v94,s5,v94
MF v95,s5,v95
M v[164:167],v[40:43],a[192:195],v[164:167]
s_waitcnt lgkmcnt(2)
T a[148:149],v19,4096
T a[150:151],v19,6144
M v[164:167],v[44:47],a[200:203],v[164:167]
T a[152:153],v19,8192
T a[154:155],v19,10240
M v[164:167],v[48:51],a[208:211],v[164:167]
C v76,v76,v77
C v77,v78,v79
M v[164:167],v[52:55],a[216:219],v[164:167]
T a[156:157],v19,12288
T a[158:159],v19,14336
M v[164:167],v[56:59],a[224:227],v[164:167]
T a[160:161],v19,16384
T a[162:163],v19,18432
M v[172:175],v[56:59],a[228:231],0
C v78,v92,v93
C v79,v94,v95
M v[172:175],v[52:55],a[220:223],v[172:175]
T a[164:165],v19,20480
T a[166:167],v19,22528
M v[172:175],v[48:51],a[212:215],v[172:175]
T a[168:169],v19,24576
T a[170:171],v19,26624
M v[172:175],v[44:47],a[204:207],v[172:175]
W a48,v76
W a49,v77
M v[172:175],v[40:43],a[196:199],v[172:175]
W a50,v78
W a51,v79
M v[172:175],v[36:39],a[188:191],v[172:175]
v_mov_b32 v30, 2
MF v100,s5,v100
M v[172:175],v[32:35],a[180:183],v[172:175]
s_waitcnt lgkmcnt(6)
buffer_store_dword v30, v1, s[8:11], s45 offen sc1
M v[180:183],a[144:147],a[176:179],0
s_nop 0
T v[32:33],v16,28672
T v[34:35],v16,30720
M v[180:183],a[148:151],a[184:187],v[180:183]
MF v101,s5,v101
MF v102,s5,v102
M v[180:183],a[152:155],a[192:195],v[180:183]
s_waitcnt lgkmcnt(2)
T v[36:37],v16,40960
T v[38:39],v16,43008
M v[180:183],a[156:159],a[200:203],v[180:183]
T v[40:41],v16,45056
T v[42:43],v16,47104
M v[180:183],a[160:163],a[208:211],v[180:183]
MF v103,s5,v103
MF v116,s5,v116
M v[180:183],a[164:167],a[216:219],v[180:183]
T v[44:45],v16,49152
T v[46:47],v16,51200
M v[180:183],a[168:171],a[224:227],v[180:183]
T v[48:49],v16,53248
T v[50:51],v16,55296
M v[188:191],a[168:171],a[228:231],0
MF v117,s5,v117
MF v118,s5,v118
M v[188:191],a[164:167],a[220:223],v[188:191]
T v[52:53],v16,57344
T v[54:55],v16,59392
M v[188:191],a[160:163],a[212:215],v[188:191]
T v[56:57],v16,61440
T v[58:59],v16,63488
M v[188:191],a[156:159],a[204:207],v[188:191]
MF v119,s5,v119
C v100,v100,v101
M v[188:191],a[152:155],a[196:199],v[188:191]
C v101,v102,v103
C v102,v116,v117
M v[188:191],a[148:151],a[188:191],v[188:191]
C v103,v118,v119
W a20,v100
M v[188:191],a[144:147],a[180:183],v[188:191]
s_waitcnt lgkmcnt(6)
W a21,v101
W a22,v102
M v[132:135],v[32:35],a[232:235],v[132:135]
T a[144:145],v17,28672
T a[146:147],v17,30720
M v[132:135],v[36:39],a[96:99],v[132:135]
W a23,v103
MF v108,s5,v108
M v[132:135],v[40:43],a[104:107],v[132:135]
s_waitcnt lgkmcnt(2)
T a[148:149],v17,40960
T a[150:151],v17,43008
M v[132:135],v[44:47],a[112:115],v[132:135]
T a[152:153],v17,45056
T a[154:155],v17,47104
M v[132:135],v[48:51],a[120:123],v[132:135]
MF v109,s5,v109
MF v110,s5,v110
M v[132:135],v[52:55],a[128:131],v[132:135]
T a[156:157],v17,49152
T a[158:159],v17,51200
M v[132:135],v[56:59],a[136:139],v[132:135]
T a[160:161],v17,53248
T a[162:163],v17,55296
M v[140:143],v[56:59],a[140:143],v[140:143]
MF v111,s5,v111
MF v124,s5,v124
M v[140:143],v[52:55],a[132:135],v[140:143]
T a[164:165],v17,57344
T a[166:167],v17,59392
M v[140:143],v[48:51],a[124:127],v[140:143]
T a[168:169],v17,61440
T a[170:171],v17,63488
M v[140:143],v[44:47],a[116:119],v[140:143]
MF v125,s5,v125
MF v126,s5,v126
M v[140:143],v[40:43],a[108:111],v[140:143]
MF v127,s5,v127
C v108,v108,v109
M v[140:143],v[36:39],a[100:103],v[140:143]
C v109,v110,v111
C v110,v124,v125
M v[140:143],v[32:35],a[236:239],v[140:143]
s_waitcnt lgkmcnt(6)
C v111,v126,v127
W a52,v108
M v[148:151],a[144:147],a[232:235],v[148:151]
T v[32:33],v18,28672
T v[34:35],v18,30720
M v[148:151],a[148:151],a[96:99],v[148:151]
W a53,v109
W a54,v110
M v[148:151],a[152:155],a[104:107],v[148:151]
s_waitcnt lgkmcnt(2)
T v[36:37],v18,40960
T v[38:39],v18,43008
M v[148:151],a[156:159],a[112:115],v[148:151]
T v[40:41],v18,45056
T v[42:43],v18,47104
M v[148:151],a[160:163],a[120:123],v[148:151]
W a55,v111
s_waitcnt vmcnt(11)
v_cmp_ne_u32 vcc, 1, v5
M v[148:151],a[164:167],a[128:131],v[148:151]
s_nop 0
T v[44:45],v18,49152
T v[46:47],v18,51200
M v[148:151],a[168:171],a[136:139],v[148:151]
s_cmp_lg_u32 vcc_hi, 0
T v[48:49],v18,53248
T v[50:51],v18,55296
M v[156:159],a[168:171],a[140:143],v[156:159]
s_cbranch_scc1 L_wsr0
L_wrr0:
M v[156:159],a[164:167],a[132:135],v[156:159]
SA m0,s28,131072
T v[52:53],v18,57344
T v[54:55],v18,59392
M v[156:159],a[160:163],a[124:127],v[156:159]
T v[56:57],v18,61440
T v[58:59],v18,63488
M v[156:159],a[156:159],a[116:119],v[156:159]
buffer_load_dwordx4 v3, s[8:11], s26 offen offset:0 sc1 lds
M v[156:159],a[152:155],a[108:111],v[156:159]
MF v132,s5,v132
MF v133,s5,v133
M v[156:159],a[148:151],a[100:103],v[156:159]
buffer_load_dwordx4 v3, s[8:11], s26 offen offset:1024 sc1 lds
M v[156:159],a[144:147],a[236:239],v[156:159]
s_waitcnt lgkmcnt(6)
MF v134,s5,v134
MF v135,s5,v135
M v[164:167],v[32:35],a[232:235],v[164:167]
T a[144:145],v19,28672
T a[146:147],v19,30720
M v[164:167],v[36:39],a[96:99],v[164:167]
buffer_load_dwordx4 v3, s[8:11], s26 offen offset:2048 sc1 lds
M v[164:167],v[40:43],a[104:107],v[164:167]
s_waitcnt lgkmcnt(2)
s_nop 0
T a[148:149],v19,40960
T a[150:151],v19,43008
M v[164:167],v[44:47],a[112:115],v[164:167]
T a[152:153],v19,45056
T a[154:155],v19,47104
M v[164:167],v[48:51],a[120:123],v[164:167]
buffer_load_dwordx4 v3, s[8:11], s26 offen offset:3072 sc1 lds
M v[164:167],v[52:55],a[128:131],v[164:167]
SA m0,s28,135168
T a[156:157],v19,49152
T a[158:159],v19,51200
M v[164:167],v[56:59],a[136:139],v[164:167]
T a[160:161],v19,53248
T a[162:163],v19,55296
M v[172:175],v[56:59],a[140:143],v[172:175]
buffer_load_dwordx4 v4, s[8:11], s26 offen offset:0 sc1 lds
M v[172:175],v[52:55],a[132:135],v[172:175]
s_nop 0
T a[164:165],v19,57344
T a[166:167],v19,59392
M v[172:175],v[48:51],a[124:127],v[172:175]
T a[168:169],v19,61440
T a[170:171],v19,63488
M v[172:175],v[44:47],a[116:119],v[172:175]
buffer_load_dwordx4 v4, s[8:11], s26 offen offset:1024 sc1 lds
M v[172:175],v[40:43],a[108:111],v[172:175]
MF v148,s5,v148
MF v149,s5,v149
M v[172:175],v[36:39],a[100:103],v[172:175]
s_waitcnt lgkmcnt(0)
buffer_load_dwordx4 v4, s[8:11], s26 offen offset:2048 sc1 lds
M v[172:175],v[32:35],a[236:239],v[172:175]
s_barrier
M v[180:183],a[144:147],a[232:235],v[180:183]
R a[64:67],v2,32768
R a[68:71],v2,33792
M v[180:183],a[148:151],a[96:99],v[180:183]
buffer_load_dwordx4 v4, s[8:11], s26 offen offset:3072 sc1 lds
M v[180:183],a[152:155],a[104:107],v[180:183]
SA s26,s26,32768
MF v150,s5,v150
MF v151,s5,v151
M v[180:183],a[156:159],a[112:115],v[180:183]
R a[72:75],v2,34816
R a[76:79],v2,35840
M v[180:183],a[160:163],a[120:123],v[180:183]
C v132,v132,v133
C v133,v134,v135
M v[180:183],a[164:167],a[128:131],v[180:183]
C v134,v148,v149
C v135,v150,v151
M v[180:183],a[168:171],a[136:139],v[180:183]
R a[80:83],v2,36864
R a[84:87],v2,37888
M v[188:191],a[168:171],a[140:143],v[188:191]
W a24,v132
W a25,v133
M v[188:191],a[164:167],a[132:135],v[188:191]
W a26,v134
W a27,v135
M v[188:191],a[160:163],a[124:127],v[188:191]
R a[88:91],v2,38912
R a[92:95],v2,39936
M v[188:191],a[156:159],a[116:119],v[188:191]
MF v140,s5,v140
MF v141,s5,v141
M v[188:191],a[152:155],a[108:111],v[188:191]
MF v142,s5,v142
MF v143,s5,v143
M v[188:191],a[148:151],a[100:103],v[188:191]
MF v156,s5,v156
MF v157,s5,v157
M v[188:191],a[144:147],a[236:239],v[188:191]
s_waitcnt lgkmcnt(0)
MF v158,s5,v158
MF v159,s5,v159
C v140,v140,v141
C v141,v142,v143
C v142,v156,v157
C v143,v158,v159
W a56,v140
W a57,v141
W a58,v142
W a59,v143
s_cmp_eq_u32 s42, 0
s_cbranch_scc1 L_j0
M v[64:67],a[64:67],a[0:3],0
R a[96:99],v2,40960
R a[100:103],v2,41984
M v[64:67],a[68:71],a[4:7],v[64:67]
MF v164,s5,v164
MF v165,s5,v165
M v[64:67],a[72:75],a[8:11],v[64:67]
MF v166,s5,v166
MF v167,s5,v167
M v[64:67],a[76:79],a[12:15],v[64:67]
R a[104:107],v2,43008
R a[108:111],v2,44032
M v[64:67],a[80:83],a[16:19],v[64:67]
MF v180,s5,v180
MF v181,s5,v181
MF v182,s5,v182
MF v183,s5,v183
C v164,v164,v165
C v165,v166,v167
C v166,v180,v181
C v167,v182,v183
W a28,v164
W a29,v165
W a30,v166
W a31,v167
M v[64:67],a[84:87],a[20:23],v[64:67]
MF v172,s5,v172
MF v173,s5,v173
M v[64:67],a[88:91],a[24:27],v[64:67]
R a[112:115],v2,45056
R a[116:119],v2,46080
M v[64:67],a[92:95],a[28:31],v[64:67]
MF v174,s5,v174
MF v175,s5,v175
M v[68:71],a[64:67],a[32:35],0
MF v188,s5,v188
MF v189,s5,v189
M v[68:71],a[68:71],a[36:39],v[68:71]
R a[120:123],v2,47104
R a[124:127],v2,48128
M v[68:71],a[72:75],a[40:43],v[68:71]
SA m0,s28,32768
MF v190,s5,v190
MF v191,s5,v191
M v[68:71],a[76:79],a[44:47],v[68:71]
SA s3,s93,786432
buffer_load_dwordx4 v3, s[8:11], s26 offen offset:0 sc1 lds
M v[68:71],a[80:83],a[48:51],v[68:71]
C v172,v172,v173
C v173,v174,v175
C v174,v188,v189
C v175,v190,v191
W a60,v172
W a61,v173
W a62,v174
W a63,v175
M v[68:71],a[84:87],a[52:55],v[68:71]
E v18,v64
M v[68:71],a[88:91],a[56:59],v[68:71]
buffer_store_dwordx4 v[192:195], v7, s[8:11], s3 offen offset:0 sc1
M v[68:71],a[92:95],a[60:63],v[68:71]
s_waitcnt lgkmcnt(0)
E v19,v65
M v[72:75],a[96:99],a[0:3],0
R a[64:67],v2,49152
R a[68:71],v2,50176
M v[72:75],a[100:103],a[4:7],v[72:75]
buffer_load_dwordx4 v3, s[8:11], s26 offen offset:1024 sc1 lds
M v[72:75],a[104:107],a[8:11],v[72:75]
E v20,v66
M v[72:75],a[108:111],a[12:15],v[72:75]
R a[72:75],v2,51200
R a[76:79],v2,52224
M v[72:75],a[112:115],a[16:19],v[72:75]
buffer_load_dwordx4 v3, s[8:11], s26 offen offset:2048 sc1 lds
M v[72:75],a[116:119],a[20:23],v[72:75]
E v21,v67
M v[72:75],a[120:123],a[24:27],v[72:75]
R a[80:83],v2,53248
R a[84:87],v2,54272
M v[72:75],a[124:127],a[28:31],v[72:75]
buffer_load_dwordx4 v3, s[8:11], s26 offen offset:3072 sc1 lds
M v[76:79],a[124:127],a[60:63],0
SA m0,s28,36864
E v22,v68
M v[76:79],a[120:123],a[56:59],v[76:79]
R a[88:91],v2,55296
R a[92:95],v2,56320
M v[76:79],a[116:119],a[52:55],v[76:79]
buffer_load_dwordx4 v4, s[8:11], s26 offen offset:0 sc1 lds
M v[76:79],a[112:115],a[48:51],v[76:79]
E v23,v69
M v[76:79],a[108:111],a[44:47],v[76:79]
AF v26,v18,v19
C v40,v18,v19
M v[76:79],a[104:107],a[40:43],v[76:79]
buffer_load_dwordx4 v4, s[8:11], s26 offen offset:1024 sc1 lds
M v[76:79],a[100:103],a[36:39],v[76:79]
v_add_u32 v16, 0x20000, v7
AF v26,v20,v26
M v[76:79],a[96:99],a[32:35],v[76:79]
s_waitcnt lgkmcnt(0)
E v24,v70
M v[80:83],a[64:67],a[0:3],0
R a[96:99],v2,57344
R a[100:103],v2,58368
M v[80:83],a[68:71],a[4:7],v[80:83]
buffer_load_dwordx4 v4, s[8:11], s26 offen offset:2048 sc1 lds
M v[80:83],a[72:75],a[8:11],v[80:83]
E v25,v71
M v[80:83],a[76:79],a[12:15],v[80:83]
R a[104:107],v2,59392
R a[108:111],v2,60416
M v[80:83],a[80:83],a[16:19],v[80:83]
buffer_store_dwordx4 v[200:203], v7, s[8:11], s3 offen offset:1024 sc1
M v[80:83],a[84:87],a[20:23],v[80:83]
E v18,v72
M v[80:83],a[88:91],a[24:27],v[80:83]
R a[112:115],v2,61440
R a[116:119],v2,62464
M v[80:83],a[92:95],a[28:31],v[80:83]
buffer_load_dwordx4 v4, s[8:11], s26 offen offset:3072 sc1 lds
M v[84:87],a[92:95],a[60:63],0
SA s26,s26,32768
E v19,v73
M v[84:87],a[88:91],a[56:59],v[84:87]
R a[120:123],v2,63488
R a[124:127],v2,64512
M v[84:87],a[84:87],a[52:55],v[84:87]
C v41,v20,v21
AF v26,v21,v26
M v[84:87],a[80:83],a[48:51],v[84:87]
buffer_store_dwordx4 v[208:211], v7, s[8:11], s3 offen offset:2048 sc1
M v[84:87],a[76:79],a[44:47],v[84:87]
E v20,v74
M v[84:87],a[72:75],a[40:43],v[84:87]
AF v27,v22,v23
C v44,v22,v23
M v[84:87],a[68:71],a[36:39],v[84:87]
s_waitcnt vmcnt(24) lgkmcnt(0)
E v21,v75
M v[84:87],a[64:67],a[32:35],v[84:87]
s_barrier
M v[88:91],a[96:99],a[0:3],0
R a[64:67],v2,0
R a[68:71],v2,1024
M v[88:91],a[100:103],a[4:7],v[88:91]
E v22,v76
M v[88:91],a[104:107],a[8:11],v[88:91]
AF v27,v24,v27
C v45,v24,v25
M v[88:91],a[108:111],a[12:15],v[88:91]
R a[72:75],v2,2048
R a[76:79],v2,3072
M v[88:91],a[112:115],a[16:19],v[88:91]
E v23,v77
M v[88:91],a[116:119],a[20:23],v[88:91]
AF v27,v25,v27
AF v26,v18,v26
M v[88:91],a[120:123],a[24:27],v[88:91]
R a[80:83],v2,4096
R a[84:87],v2,5120
M v[88:91],a[124:127],a[28:31],v[88:91]
E v24,v78
M v[92:95],a[124:127],a[60:63],0
C v42,v18,v19
AF v26,v19,v26
M v[92:95],a[120:123],a[56:59],v[92:95]
R a[88:91],v2,6144
R a[92:95],v2,7168
M v[92:95],a[116:119],a[52:55],v[92:95]
E v25,v79
M v[92:95],a[112:115],a[48:51],v[92:95]
AF v26,v20,v26
C v43,v20,v21
M v[92:95],a[108:111],a[44:47],v[92:95]
AF v26,v21,v26
AF v27,v22,v27
M v[92:95],a[104:107],a[40:43],v[92:95]
C v46,v22,v23
AF v27,v23,v27
M v[92:95],a[100:103],a[36:39],v[92:95]
s_waitcnt lgkmcnt(0)
AF v27,v24,v27
C v47,v24,v25
M v[92:95],a[96:99],a[32:35],v[92:95]
AF v27,v25,v27
M v[96:99],a[64:67],a[0:3],0
R a[96:99],v2,8192
R a[100:103],v2,9216
M v[96:99],a[68:71],a[4:7],v[96:99]
SA m0,s28,98304
E v18,v80
M v[96:99],a[72:75],a[8:11],v[96:99]
buffer_load_dwordx4 v3, s[8:11], s21 offen offset:0 sc1 lds
M v[96:99],a[76:79],a[12:15],v[96:99]
R a[104:107],v2,10240
R a[108:111],v2,11264
M v[96:99],a[80:83],a[16:19],v[96:99]
v_mov_b32 v30, 0
M v[96:99],a[84:87],a[20:23],v[96:99]
E v19,v81
M v[96:99],a[88:91],a[24:27],v[96:99]
R a[112:115],v2,12288
R a[116:119],v2,13312
M v[96:99],a[92:95],a[28:31],v[96:99]
buffer_load_dwordx4 v3, s[8:11], s21 offen offset:1024 sc1 lds
M v[100:103],a[92:95],a[60:63],0
v_mov_b32 v31, 0
AF v26,v18,v26
M v[100:103],a[88:91],a[56:59],v[100:103]
R a[120:123],v2,14336
R a[124:127],v2,15360
M v[100:103],a[84:87],a[52:55],v[100:103]
SA s3,s93,786432
E v20,v82
M v[100:103],a[80:83],a[48:51],v[100:103]
buffer_load_dwordx4 v3, s[8:11], s21 offen offset:2048 sc1 lds
M v[100:103],a[76:79],a[44:47],v[100:103]
E v21,v83
M v[100:103],a[72:75],a[40:43],v[100:103]
v_mov_b32 v32, 0
C v56,v18,v19
M v[100:103],a[68:71],a[36:39],v[100:103]
buffer_store_dwordx4 v[216:219], v7, s[8:11], s3 offen offset:3072 sc1
M v[100:103],a[64:67],a[32:35],v[100:103]
s_waitcnt lgkmcnt(0)
E v22,v88
M v[104:107],a[96:99],a[0:3],0
R a[64:67],v2,16384
R a[68:71],v2,17408
M v[104:107],a[100:103],a[4:7],v[104:107]
buffer_load_dwordx4 v3, s[8:11], s21 offen offset:3072 sc1 lds
M v[104:107],a[104:107],a[8:11],v[104:107]
SA m0,s28,102400
v_mov_b32 v33, 0
AF v26,v19,v26
M v[104:107],a[108:111],a[12:15],v[104:107]
R a[72:75],v2,18432
R a[76:79],v2,19456
M v[104:107],a[112:115],a[16:19],v[104:107]
buffer_load_dwordx4 v4, s[8:11], s21 offen offset:0 sc1 lds
M v[104:107],a[116:119],a[20:23],v[104:107]
E v23,v89
M v[104:107],a[120:123],a[24:27],v[104:107]
R a[80:83],v2,20480
R a[84:87],v2,21504
M v[104:107],a[124:127],a[28:31],v[104:107]
buffer_load_dwordx4 v4, s[8:11], s21 offen offset:1024 sc1 lds
M v[108:111],a[124:127],a[60:63],0
v_mov_b32 v34, 0
AF v26,v20,v26
M v[108:111],a[120:123],a[56:59],v[108:111]
SA s3,s93,794624
R a[88:91],v2,22528
R a[92:95],v2,23552
M v[108:111],a[116:119],a[52:55],v[108:111]
buffer_load_dwordx4 v4, s[8:11], s21 offen offset:2048 sc1 lds
M v[108:111],a[112:115],a[48:51],v[108:111]
v_mov_b32 v35, 0
C v57,v20,v21
M v[108:111],a[108:111],a[44:47],v[108:111]
E v24,v90
M v[108:111],a[104:107],a[40:43],v[108:111]
E v25,v91
M v[108:111],a[100:103],a[36:39],v[108:111]
buffer_load_dwordx4 v4, s[8:11], s21 offen offset:3072 sc1 lds
M v[108:111],a[96:99],a[32:35],v[108:111]
s_waitcnt lgkmcnt(0)
v_mov_b32 v36, 0
AF v26,v21,v26
M v[112:115],a[64:67],a[0:3],0
SA s21,s21,32768
R a[96:99],v2,24576
R a[100:103],v2,25600
M v[112:115],a[68:71],a[4:7],v[112:115]
s_sub_u32 s22, s22, 1
buffer_store_dwordx4 v[224:227], v7, s[8:11], s3 offen offset:0 sc1
M v[112:115],a[72:75],a[8:11],v[112:115]
s_cselect_b32 s21, s23, s21
E v18,v84
M v[112:115],a[76:79],a[12:15],v[112:115]
R a[104:107],v2,26624
R a[108:111],v2,27648
M v[112:115],a[80:83],a[16:19],v[112:115]
v_mov_b32 v37, 0
AF v26,v22,v26
M v[112:115],a[84:87],a[20:23],v[112:115]
E v19,v85
M v[112:115],a[88:91],a[24:27],v[112:115]
R a[112:115],v2,28672
R a[116:119],v2,29696
M v[112:115],a[92:95],a[28:31],v[112:115]
E v20,v86
M v[116:119],a[92:95],a[60:63],0
v_mov_b32 v38, 0
C v58,v22,v23
M v[116:119],a[88:91],a[56:59],v[116:119]
R a[120:123],v2,30720
R a[124:127],v2,31744
M v[116:119],a[84:87],a[52:55],v[116:119]
E v21,v87
M v[116:119],a[80:83],a[48:51],v[116:119]
buffer_store_dwordx4 v[232:235], v7, s[8:11], s3 offen offset:1024 sc1
M v[116:119],a[76:79],a[44:47],v[116:119]
AF v26,v23,v26
AF v26,v24,v26
M v[116:119],a[72:75],a[40:43],v[116:119]
v_mov_b32 v39, 0
C v59,v24,v25
M v[116:119],a[68:71],a[36:39],v[116:119]
s_waitcnt vmcnt(22) lgkmcnt(0)
E v22,v92
M v[116:119],a[64:67],a[32:35],v[116:119]
s_barrier
M v[120:123],a[96:99],a[0:3],0
R a[64:67],v16,0
R a[68:71],v16,1024
M v[120:123],a[100:103],a[4:7],v[120:123]
E v23,v93
M v[120:123],a[104:107],a[8:11],v[120:123]
AF v26,v25,v26
AF v27,v18,v27
M v[120:123],a[108:111],a[12:15],v[120:123]
R a[72:75],v16,2048
R a[76:79],v16,3072
M v[120:123],a[112:115],a[16:19],v[120:123]
E v24,v94
M v[120:123],a[116:119],a[20:23],v[120:123]
E v25,v95
M v[120:123],a[120:123],a[24:27],v[120:123]
R a[80:83],v16,4096
R a[84:87],v16,5120
M v[120:123],a[124:127],a[28:31],v[120:123]
C v60,v18,v19
AF v27,v19,v27
M v[124:127],a[124:127],a[60:63],0
AF v27,v20,v27
C v61,v20,v21
M v[124:127],a[120:123],a[56:59],v[124:127]
R a[88:91],v16,6144
R a[92:95],v16,7168
M v[124:127],a[116:119],a[52:55],v[124:127]
AF v27,v21,v27
AF v27,v22,v27
M v[124:127],a[112:115],a[48:51],v[124:127]
C v62,v22,v23
AF v27,v23,v27
M v[124:127],a[108:111],a[44:47],v[124:127]
AF v27,v24,v27
C v63,v24,v25
M v[124:127],a[104:107],a[40:43],v[124:127]
AF v27,v25,v27
M v[124:127],a[100:103],a[36:39],v[124:127]
s_waitcnt lgkmcnt(0)
M v[124:127],a[96:99],a[32:35],v[124:127]
v_max_f32 v10, v26, v27
v_min_f32 v11, v26, v27
v_cmp_lt_f32 vcc, s31, v10
v_cmp_gt_f32 s[64:65], s24, v11
s_nop 0
s_or_b64 vcc, vcc, s[64:65]
s_cbranch_vccnz L_stk1
L_rtk1:
M v[128:131],a[64:67],v[40:43],0
R a[96:99],v16,8192
R a[100:103],v16,9216
M v[128:131],a[68:71],v[56:59],v[128:131]
SA m0,s28,65536
E v18,v96
M v[132:135],a[68:71],v[60:63],0
buffer_load_dwordx4 v3, s[8:11], s21 offen offset:0 sc1 lds
M v[132:135],a[64:67],v[44:47],v[132:135]
R a[104:107],v16,10240
R a[108:111],v16,11264
M v[136:139],a[72:75],v[40:43],0
SA s3,s93,794624
E v19,v97
M v[136:139],a[76:79],v[56:59],v[136:139]
AF v30,v26,v30
AF v31,v27,v31
M v[140:143],a[76:79],v[60:63],0
R a[112:115],v16,12288
R a[116:119],v16,13312
M v[140:143],a[72:75],v[44:47],v[140:143]
buffer_load_dwordx4 v3, s[8:11], s21 offen offset:1024 sc1 lds
M v[144:147],a[80:83],v[40:43],0
E v20,v98
M v[144:147],a[84:87],v[56:59],v[144:147]
R a[120:123],v16,14336
R a[124:127],v16,15360
M v[148:151],a[84:87],v[60:63],0
buffer_store_dwordx4 v[240:243], v7, s[8:11], s3 offen offset:2048 sc1
M v[148:151],a[80:83],v[44:47],v[148:151]
E v21,v99
M v[152:155],a[88:91],v[40:43],0
AF v28,v18,v19
C v48,v18,v19
M v[152:155],a[92:95],v[56:59],v[152:155]
buffer_load_dwordx4 v3, s[8:11], s21 offen offset:2048 sc1 lds
M v[156:159],a[92:95],v[60:63],0
AF v28,v20,v28
C v49,v20,v21
M v[156:159],a[88:91],v[44:47],v[156:159]
s_waitcnt lgkmcnt(0)
E v22,v104
M v[160:163],a[96:99],v[40:43],0
R a[64:67],v16,16384
R a[68:71],v16,17408
M v[160:163],a[100:103],v[56:59],v[160:163]
buffer_load_dwordx4 v3, s[8:11], s21 offen offset:3072 sc1 lds
M v[164:167],a[100:103],v[60:63],0
SA m0,s28,69632
E v23,v105
M v[164:167],a[96:99],v[44:47],v[164:167]
R a[72:75],v16,18432
R a[76:79],v16,19456
M v[168:171],a[104:107],v[40:43],0
buffer_load_dwordx4 v4, s[8:11], s21 offen offset:0 sc1 lds
M v[168:171],a[108:111],v[56:59],v[168:171]
AF v28,v21,v28
AF v28,v22,v28
M v[172:175],a[108:111],v[60:63],0
R a[80:83],v16,20480
R a[84:87],v16,21504
M v[172:175],a[104:107],v[44:47],v[172:175]
buffer_store_dwordx4 v[248:251], v7, s[8:11], s3 offen offset:3072 sc1
M v[176:179],a[112:115],v[40:43],0
E v24,v106
M v[176:179],a[116:119],v[56:59],v[176:179]
R a[88:91],v16,22528
R a[92:95],v16,23552
M v[180:183],a[116:119],v[60:63],0
buffer_load_dwordx4 v4, s[8:11], s21 offen offset:1024 sc1 lds
M v[180:183],a[112:115],v[44:47],v[180:183]
E v25,v107
M v[184:187],a[120:123],v[40:43],0
C v50,v22,v23
AF v28,v23,v28
M v[184:187],a[124:127],v[56:59],v[184:187]
buffer_load_dwordx4 v4, s[8:11], s21 offen offset:2048 sc1 lds
M v[188:191],a[124:127],v[60:63],0
E v18,v100
M v[188:191],a[120:123],v[44:47],v[188:191]
s_waitcnt lgkmcnt(0)
AF v28,v24,v28
C v51,v24,v25
M v[192:195],a[64:67],v[40:43],0
R a[96:99],v16,24576
R a[100:103],v16,25600
M v[192:195],a[68:71],v[56:59],v[192:195]
buffer_load_dwordx4 v4, s[8:11], s21 offen offset:3072 sc1 lds
M v[196:199],a[68:71],v[60:63],0
SA s21,s21,32768
E v19,v101
M v[196:199],a[64:67],v[44:47],v[196:199]
s_sub_u32 s22, s22, 1
R a[104:107],v16,26624
R a[108:111],v16,27648
M v[200:203],a[72:75],v[40:43],0
s_cselect_b32 s21, s23, s21
AF v28,v25,v28
AF v29,v18,v19
M v[200:203],a[76:79],v[56:59],v[200:203]
E v20,v102
M v[204:207],a[76:79],v[60:63],0
R a[112:115],v16,28672
R a[116:119],v16,29696
M v[204:207],a[72:75],v[44:47],v[204:207]
C v52,v18,v19
M v[208:211],a[80:83],v[40:43],0
M v[208:211],a[84:87],v[56:59],v[208:211]
R a[120:123],v16,30720
R a[124:127],v16,31744
M v[212:215],a[84:87],v[60:63],0
E v21,v103
M v[212:215],a[80:83],v[44:47],v[212:215]
AF v29,v20,v29
C v53,v20,v21
M v[216:219],a[88:91],v[40:43],0
AF v29,v21,v29
M v[216:219],a[92:95],v[56:59],v[216:219]
E v22,v108
M v[220:223],a[92:95],v[60:63],0
s_waitcnt vmcnt(12) lgkmcnt(0)
M v[220:223],a[88:91],v[44:47],v[220:223]
s_barrier
M v[224:227],a[96:99],v[40:43],0
R a[64:67],v2,32768
R a[68:71],v2,33792
M v[224:227],a[100:103],v[56:59],v[224:227]
E v23,v109
M v[228:231],a[100:103],v[60:63],0
AF v29,v22,v29
C v54,v22,v23
M v[228:231],a[96:99],v[44:47],v[228:231]
R a[72:75],v2,34816
R a[76:79],v2,35840
M v[232:235],a[104:107],v[40:43],0
E v24,v110
M v[232:235],a[108:111],v[56:59],v[232:235]
AF v29,v23,v29
M v[236:239],a[108:111],v[60:63],0
R a[80:83],v2,36864
R a[84:87],v2,37888
M v[236:239],a[104:107],v[44:47],v[236:239]
M v[240:243],a[112:115],v[40:43],0
E v25,v111
M v[240:243],a[116:119],v[56:59],v[240:243]
R a[88:91],v2,38912
R a[92:95],v2,39936
M v[244:247],a[116:119],v[60:63],0
AF v29,v24,v29
C v55,v24,v25
M v[244:247],a[112:115],v[44:47],v[244:247]
AF v29,v25,v29
M v[248:251],a[120:123],v[40:43],0
M v[248:251],a[124:127],v[56:59],v[248:251]
M v[252:255],a[124:127],v[60:63],0
s_waitcnt lgkmcnt(0)
M v[252:255],a[120:123],v[44:47],v[252:255]
s_cmp_lg_u32 s27, 0
s_cbranch_scc1 L_loop_top
s_branch L_d1s
L_j0:
M v[68:71],a[64:67],a[32:35],0
s_cmp_lt_u32 s20, 0
R a[96:99],v2,40960
R a[100:103],v2,41984
M v[68:71],a[68:71],a[36:39],v[68:71]
s_cselect_b64 s[82:83], -1, 0
v_mov_b32 v30, 0
MF v172,s5,v172
M v[68:71],a[72:75],a[40:43],v[68:71]
s_cmp_eq_u32 s20, 0
MF v173,s5,v173
MF v174,s5,v174
M v[68:71],a[76:79],a[44:47],v[68:71]
s_cselect_b64 s[66:67], s[16:17], s[82:83]
R a[104:107],v2,43008
R a[108:111],v2,44032
M v[68:71],a[80:83],a[48:51],v[68:71]
s_cselect_b64 s[68:69], s[18:19], s[82:83]
MF v175,s5,v175
MF v188,s5,v188
M v[68:71],a[84:87],a[52:55],v[68:71]
s_cselect_b64 s[70:71], s[48:49], s[82:83]
MF v189,s5,v189
MF v190,s5,v190
MF v191,s5,v191
C v172,v172,v173
C v173,v174,v175
C v174,v188,v189
C v175,v190,v191
W a60,v172
W a61,v173
W a62,v174
W a63,v175
M v[68:71],a[88:91],a[56:59],v[68:71]
s_cselect_b64 s[72:73], s[50:51], s[82:83]
R a[112:115],v2,45056
R a[116:119],v2,46080
v_cndmask_b32 v64, 0, v8, s[66:67]
v_cndmask_b32 v65, 0, v8, s[68:69]
v_cndmask_b32 v66, 0, v8, s[70:71]
v_cndmask_b32 v67, 0, v8, s[72:73]
M v[68:71],a[92:95],a[60:63],v[68:71]
s_cmp_lt_u32 s20, 1
MF v164,s5,v164
MF v165,s5,v165
M v[64:67],a[64:67],a[0:3],v[64:67]
s_cselect_b64 s[82:83], -1, 0
MF v166,s5,v166
MF v167,s5,v167
M v[64:67],a[68:71],a[4:7],v[64:67]
s_cmp_eq_u32 s20, 1
R a[120:123],v2,47104
R a[124:127],v2,48128
M v[64:67],a[72:75],a[8:11],v[64:67]
s_cselect_b64 s[74:75], s[16:17], s[82:83]
MF v180,s5,v180
MF v181,s5,v181
M v[64:67],a[76:79],a[12:15],v[64:67]
s_cselect_b64 s[76:77], s[18:19], s[82:83]
MF v182,s5,v182
MF v183,s5,v183
M v[64:67],a[80:83],a[16:19],v[64:67]
s_cselect_b64 s[78:79], s[48:49], s[82:83]
C v164,v164,v165
C v165,v166,v167
C v166,v180,v181
C v167,v182,v183
W a28,v164
W a29,v165
W a30,v166
W a31,v167
M v[64:67],a[84:87],a[20:23],v[64:67]
s_cselect_b64 s[80:81], s[50:51], s[82:83]
v_mov_b32 v31, 0
v_cndmask_b32 v72, 0, v8, s[74:75]
M v[64:67],a[88:91],a[24:27],v[64:67]
s_mov_b32 s26, s43
v_mov_b32 v32, 0
M v[64:67],a[92:95],a[28:31],v[64:67]
s_waitcnt lgkmcnt(0)
v_cndmask_b32 v73, 0, v8, s[76:77]
M v[76:79],a[96:99],a[32:35],0
SA m0,s28,0
R a[64:67],v2,49152
R a[68:71],v2,50176
M v[76:79],a[100:103],a[36:39],v[76:79]
SA s3,s93,786432
buffer_load_dwordx4 v3, s[8:11], s26 offen offset:0 sc1 lds
M v[76:79],a[104:107],a[40:43],v[76:79]
v_cndmask_b32 v74, 0, v8, s[78:79]
v_mov_b32 v33, 0
M v[76:79],a[108:111],a[44:47],v[76:79]
R a[72:75],v2,51200
R a[76:79],v2,52224
M v[76:79],a[112:115],a[48:51],v[76:79]
buffer_store_dwordx4 v[192:195], v7, s[8:11], s3 offen offset:0 sc1
M v[76:79],a[116:119],a[52:55],v[76:79]
v_cndmask_b32 v75, 0, v8, s[80:81]
M v[76:79],a[120:123],a[56:59],v[76:79]
s_cmp_lt_u32 s20, 2
R a[80:83],v2,53248
R a[84:87],v2,54272
M v[76:79],a[124:127],a[60:63],v[76:79]
s_cselect_b64 s[82:83], -1, 0
buffer_load_dwordx4 v3, s[8:11], s26 offen offset:1024 sc1 lds
M v[72:75],a[124:127],a[28:31],v[72:75]
s_cmp_eq_u32 s20, 2
E v18,v68
M v[72:75],a[120:123],a[24:27],v[72:75]
s_cselect_b64 s[66:67], s[16:17], s[82:83]
R a[88:91],v2,55296
R a[92:95],v2,56320
M v[72:75],a[116:119],a[20:23],v[72:75]
s_cselect_b64 s[68:69], s[18:19], s[82:83]
buffer_load_dwordx4 v3, s[8:11], s26 offen offset:2048 sc1 lds
M v[72:75],a[112:115],a[16:19],v[72:75]
s_cselect_b64 s[70:71], s[48:49], s[82:83]
v_mov_b32 v34, 0
M v[72:75],a[108:111],a[12:15],v[72:75]
s_cselect_b64 s[72:73], s[50:51], s[82:83]
v_cndmask_b32 v80, 0, v8, s[66:67]
v_cndmask_b32 v81, 0, v8, s[68:69]
M v[72:75],a[104:107],a[8:11],v[72:75]
buffer_store_dwordx4 v[200:203], v7, s[8:11], s3 offen offset:1024 sc1
M v[72:75],a[100:103],a[4:7],v[72:75]
E v19,v69
M v[72:75],a[96:99],a[0:3],v[72:75]
s_waitcnt lgkmcnt(0)
buffer_load_dwordx4 v3, s[8:11], s26 offen offset:3072 sc1 lds
M v[84:87],a[64:67],a[32:35],0
SA m0,s28,4096
R a[96:99],v2,57344
R a[100:103],v2,58368
M v[84:87],a[68:71],a[36:39],v[84:87]
v_cndmask_b32 v82, 0, v8, s[70:71]
v_mov_b32 v35, 0
M v[84:87],a[72:75],a[40:43],v[84:87]
buffer_load_dwordx4 v4, s[8:11], s26 offen offset:0 sc1 lds
M v[84:87],a[76:79],a[44:47],v[84:87]
R a[104:107],v2,59392
R a[108:111],v2,60416
M v[84:87],a[80:83],a[48:51],v[84:87]
buffer_store_dwordx4 v[208:211], v7, s[8:11], s3 offen offset:2048 sc1
M v[84:87],a[84:87],a[52:55],v[84:87]
v_cndmask_b32 v83, 0, v8, s[72:73]
v_mov_b32 v36, 0
M v[84:87],a[88:91],a[56:59],v[84:87]
s_cmp_lt_u32 s20, 3
R a[112:115],v2,61440
R a[116:119],v2,62464
M v[84:87],a[92:95],a[60:63],v[84:87]
s_cselect_b64 s[82:83], -1, 0
buffer_load_dwordx4 v4, s[8:11], s26 offen offset:1024 sc1 lds
M v[80:83],a[92:95],a[28:31],v[80:83]
s_cmp_eq_u32 s20, 3
E v20,v70
M v[80:83],a[88:91],a[24:27],v[80:83]
s_cselect_b64 s[74:75], s[16:17], s[82:83]
R a[120:123],v2,63488
R a[124:127],v2,64512
M v[80:83],a[84:87],a[20:23],v[80:83]
s_cselect_b64 s[76:77], s[18:19], s[82:83]
buffer_load_dwordx4 v4, s[8:11], s26 offen offset:2048 sc1 lds
M v[80:83],a[80:83],a[16:19],v[80:83]
s_cselect_b64 s[78:79], s[48:49], s[82:83]
E v21,v71
M v[80:83],a[76:79],a[12:15],v[80:83]
s_cselect_b64 s[80:81], s[50:51], s[82:83]
buffer_store_dwordx4 v[216:219], v7, s[8:11], s3 offen offset:3072 sc1
M v[80:83],a[72:75],a[8:11],v[80:83]
SA s3,s93,794624
v_cndmask_b32 v88, 0, v8, s[74:75]
v_cndmask_b32 v89, 0, v8, s[76:77]
M v[80:83],a[68:71],a[4:7],v[80:83]
s_waitcnt vmcnt(24) lgkmcnt(0)
buffer_load_dwordx4 v4, s[8:11], s26 offen offset:3072 sc1 lds
M v[80:83],a[64:67],a[0:3],v[80:83]
s_barrier
M v[92:95],a[96:99],a[32:35],0
R a[64:67],v2,0
R a[68:71],v2,1024
M v[92:95],a[100:103],a[36:39],v[92:95]
buffer_store_dwordx4 v[224:227], v7, s[8:11], s3 offen offset:0 sc1
M v[92:95],a[104:107],a[40:43],v[92:95]
v_min_u32 v17, 896, v9
v_cndmask_b32 v90, 0, v8, s[78:79]
M v[92:95],a[108:111],a[44:47],v[92:95]
R a[72:75],v2,2048
R a[76:79],v2,3072
M v[92:95],a[112:115],a[48:51],v[92:95]
buffer_load_dword v5, v17, s[8:11], s46 offen sc1
M v[92:95],a[116:119],a[52:55],v[92:95]
buffer_store_dwordx4 v[232:235], v7, s[8:11], s3 offen offset:1024 sc1
M v[92:95],a[120:123],a[56:59],v[92:95]
R a[80:83],v2,4096
R a[84:87],v2,5120
v_cndmask_b32 v91, 0, v8, s[80:81]
M v[92:95],a[124:127],a[60:63],v[92:95]
v_mov_b32 v37, 0
v_mov_b32 v38, 0
M v[88:91],a[124:127],a[28:31],v[88:91]
buffer_store_dwordx4 v[240:243], v7, s[8:11], s3 offen offset:2048 sc1
M v[88:91],a[120:123],a[24:27],v[88:91]
R a[88:91],v2,6144
R a[92:95],v2,7168
M v[88:91],a[116:119],a[20:23],v[88:91]
v_mov_b32 v39, 0
AF v27,v18,v19
M v[88:91],a[112:115],a[16:19],v[88:91]
buffer_store_dwordx4 v[248:251], v7, s[8:11], s3 offen offset:3072 sc1
M v[88:91],a[108:111],a[12:15],v[88:91]
E v22,v64
M v[88:91],a[104:107],a[8:11],v[88:91]
E v23,v65
M v[88:91],a[100:103],a[4:7],v[88:91]
s_waitcnt lgkmcnt(0)
E v24,v66
M v[88:91],a[96:99],a[0:3],v[88:91]
E v25,v67
C v44,v18,v19
AF v27,v20,v27
C v45,v20,v21
AF v27,v21,v27
AF v26,v22,v23
C v40,v22,v23
E v18,v76
E v19,v77
AF v26,v24,v26
C v41,v24,v25
AF v26,v25,v26
E v20,v78
E v21,v79
AF v27,v18,v27
C v46,v18,v19
AF v27,v19,v27
E v22,v72
E v23,v73
AF v27,v20,v27
C v47,v20,v21
AF v27,v21,v27
E v24,v74
E v25,v75
AF v26,v22,v26
C v42,v22,v23
AF v26,v23,v26
AF v26,v24,v26
C v43,v24,v25
AF v26,v25,v26
v_mov_b32 v56, 0
v_mov_b32 v57, 0
v_mov_b32 v58, 0
v_mov_b32 v59, 0
s_mul_i32 s21, s41, 1048576
SA s21,s21,589824
s_lshl_b32 s84, s42, 1
s_sub_u32 s22, 11, s84
s_mov_b32 s23, 536870912
s_lshl_b32 s86, s20, 14
SA s86,s86,s34
SA s87,s86,4096
SA s88,s86,8192
SA s89,s86,12288
s_lshl_b32 s90, s20, 10
SA s90,s90,s34
SA s90,s90,65536
s_waitcnt vmcnt(3)
v_cmp_gt_u32 vcc, 2, v5
s_nop 0
s_cbranch_vccnz L_lsj0
L_lrj0:
SA m0,s28,98304
v_mov_b32 v10, v26
buffer_load_dwordx4 v3, s[8:11], s21 offen offset:0 sc1 lds
v_mov_b32 v11, v27
buffer_load_dwordx4 v3, s[8:11], s21 offen offset:1024 sc1 lds
v_mov_b32 v12, v10
v_mov_b32 v13, v11
buffer_load_dwordx4 v3, s[8:11], s21 offen offset:2048 sc1 lds
v_permlane16_swap_b32 v12, v10
v_permlane16_swap_b32 v13, v11
buffer_load_dwordx4 v3, s[8:11], s21 offen offset:3072 sc1 lds
v_max_f32 v10, v12, v10
SA m0,s28,102400
v_max_f32 v11, v13, v11
buffer_load_dwordx4 v4, s[8:11], s21 offen offset:0 sc1 lds
v_mov_b32 v12, v10
v_mov_b32 v13, v11
buffer_load_dwordx4 v4, s[8:11], s21 offen offset:1024 sc1 lds
v_permlane32_swap_b32 v12, v10
v_permlane32_swap_b32 v13, v11
buffer_load_dwordx4 v4, s[8:11], s21 offen offset:2048 sc1 lds
v_max_f32 v10, v12, v10
v_max_f32 v11, v13, v11
buffer_load_dwordx4 v4, s[8:11], s21 offen offset:3072 sc1 lds
SA s21,s21,32768
s_sub_u32 s22, s22, 1
s_cselect_b32 s21, s23, s21
v_min_f32 v10, v10, v11
v_cmp_gt_f32 vcc, s24, v10
s_nop 0
s_cbranch_vccnz L_stj0
L_rtj0:
s_cmp_gt_u32 s20, 3
s_cselect_b64 s[82:83], -1, 0
s_cmp_eq_u32 s20, 3
s_cselect_b64 s[66:67], s[16:17], s[82:83]
v_mfma_f32_32x32x16_bf16 v[128:143], v[56:59], v[56:59], 0
s_cselect_b64 s[68:69], s[18:19], s[82:83]
s_cselect_b64 s[70:71], s[48:49], s[82:83]
s_cselect_b64 s[72:73], s[50:51], s[82:83]
v_cndmask_b32 v100, v36, v8, s[66:67]
v_mfma_f32_32x32x16_bf16 v[144:159], v[56:59], v[56:59], 0
v_cndmask_b32 v101, v36, v8, s[68:69]
v_cndmask_b32 v102, v36, v8, s[70:71]
v_cndmask_b32 v103, v36, v8, s[72:73]
s_cmp_gt_u32 s20, 2
v_mfma_f32_32x32x16_bf16 v[160:175], v[56:59], v[56:59], 0
s_cselect_b64 s[82:83], -1, 0
s_cmp_eq_u32 s20, 2
s_cselect_b64 s[74:75], s[16:17], s[82:83]
s_cselect_b64 s[76:77], s[18:19], s[82:83]
v_mfma_f32_32x32x16_bf16 v[176:191], v[56:59], v[56:59], 0
s_cselect_b64 s[78:79], s[48:49], s[82:83]
s_cselect_b64 s[80:81], s[50:51], s[82:83]
v_cndmask_b32 v108, v36, v8, s[74:75]
v_cndmask_b32 v109, v36, v8, s[76:77]
v_mfma_f32_32x32x16_bf16 v[192:207], v[56:59], v[56:59], 0
v_cndmask_b32 v110, v36, v8, s[78:79]
v_cndmask_b32 v111, v36, v8, s[80:81]
s_cmp_gt_u32 s20, 1
s_cselect_b64 s[82:83], -1, 0
v_mfma_f32_32x32x16_bf16 v[208:223], v[56:59], v[56:59], 0
s_cmp_eq_u32 s20, 1
s_cselect_b64 s[66:67], s[16:17], s[82:83]
s_cselect_b64 s[68:69], s[18:19], s[82:83]
s_cselect_b64 s[70:71], s[48:49], s[82:83]
v_mfma_f32_32x32x16_bf16 v[224:239], v[56:59], v[56:59], 0
s_cselect_b64 s[72:73], s[50:51], s[82:83]
v_cndmask_b32 v116, v36, v8, s[66:67]
v_cndmask_b32 v117, v36, v8, s[68:69]
v_cndmask_b32 v118, v36, v8, s[70:71]
v_mfma_f32_32x32x16_bf16 v[240:255], v[56:59], v[56:59], 0
v_cndmask_b32 v119, v36, v8, s[72:73]
s_cmp_gt_u32 s20, 0
s_cselect_b64 s[82:83], -1, 0
s_cmp_eq_u32 s20, 0
s_cselect_b64 s[74:75], s[16:17], s[82:83]
s_cselect_b64 s[76:77], s[18:19], s[82:83]
s_cselect_b64 s[78:79], s[48:49], s[82:83]
s_cselect_b64 s[80:81], s[50:51], s[82:83]
v_cndmask_b32 v124, v36, v8, s[74:75]
v_cndmask_b32 v125, v36, v8, s[76:77]
v_cndmask_b32 v126, v36, v8, s[78:79]
v_cndmask_b32 v127, v36, v8, s[80:81]
s_branch L_d3h
.p2align 12
L_kv1:
s_and_b32 s31, s42, 7
s_lshl_b32 s30, s41, 3
SA s30,s30,s31
s_lshl_b32 s64, s30, 2
SA s64,s64,s20
s_mul_i32 s72, s64, 3584
v_mov_b32 v32, 536870912
v_cmp_gt_u32 vcc, 56, v0
s_lshl_b32 s67, s64, 2
s_nop 0
v_cndmask_b32 v32, v32, v7, vcc
buffer_load_dwordx4 a[176:179], v32, s[56:59], s72 offen offset:0
buffer_load_dwordx4 a[180:183], v32, s[56:59], s72 offen offset:896
buffer_load_dwordx4 a[184:187], v32, s[56:59], s72 offen offset:1792
buffer_load_dwordx4 a[188:191], v32, s[56:59], s72 offen offset:2688
buffer_load_dwordx4 a[192:195], v32, s[60:63], 0 offen
buffer_load_dwordx4 a[196:199], v32, s[68:71], 0 offen
SA m0,s24,16384
s_nop 0
buffer_load_dwordx4 v12, s[48:51], s22 offen offset:0   lds
buffer_load_dwordx4 v13, s[48:51], s22 offen offset:1024   lds
buffer_load_dwordx4 v14, s[48:51], s22 offen offset:2048   lds
buffer_load_dwordx4 v15, s[48:51], s22 offen offset:3072   lds
s_sub_u32 s22, s22, 1048448
SA m0,s23,32768
s_nop 0
buffer_load_dwordx4 v8, s[16:19], s21 offen offset:0  nt lds
buffer_load_dwordx4 v9, s[16:19], s21 offen offset:1024  nt lds
buffer_load_dwordx4 v10, s[16:19], s21 offen offset:2048  nt lds
buffer_load_dwordx4 v11, s[16:19], s21 offen offset:3072  nt lds
SA s21,s21,128
s_mov_b64 exec, 0
s_cmp_eq_u32 s20, 0
s_cbranch_scc1 L_w_kv11
s_cmp_eq_u32 s20, 1
s_cbranch_scc1 L_w_kv12
s_cmp_eq_u32 s20, 2
s_cbranch_scc1 L_w_kv13
s_branch L_w_kv14
L_wd2:
s_mov_b64 exec, -1
s_waitcnt vmcnt(14) lgkmcnt(0)
s_barrier
R a[160:163],v5,0
R a[164:167],v6,0
T a[96:97],v1,0
T a[98:99],v1,1024
T a[100:101],v1,8192
T a[102:103],v1,9216
T a[104:105],v2,0
T a[106:107],v2,1024
T a[108:109],v2,8192
T a[110:111],v2,9216
T a[112:113],v3,0
T a[114:115],v3,1024
T a[116:117],v3,8192
T a[118:119],v3,9216
T a[120:121],v4,0
T a[122:123],v4,1024
T a[124:125],v4,8192
T a[126:127],v4,9216
T a[128:129],v1,16384
T a[130:131],v1,17408
T a[132:133],v1,24576
T a[134:135],v1,25600
T a[136:137],v2,16384
T a[138:139],v2,17408
T a[140:141],v2,24576
T a[142:143],v2,25600
T a[144:145],v3,16384
T a[146:147],v3,17408
T a[148:149],v3,24576
T a[150:151],v3,25600
T a[152:153],v4,16384
T a[154:155],v4,17408
T a[156:157],v4,24576
T a[158:159],v4,25600
s_waitcnt lgkmcnt(15)
M a[0:3],a[160:163],a[96:99],0
SA m0,s23,49152
R a[168:171],v5,2048
R a[172:175],v6,2048
M a[0:3],a[164:167],a[100:103],a[0:3]
buffer_load_dwordx4 v8, s[16:19], s21 offen offset:0  nt lds
M a[4:7],a[164:167],a[108:111],0
M a[4:7],a[160:163],a[104:107],a[4:7]
M a[8:11],a[160:163],a[112:115],0
buffer_load_dwordx4 v9, s[16:19], s21 offen offset:1024  nt lds
M a[8:11],a[164:167],a[116:119],a[8:11]
s_waitcnt lgkmcnt(14)
M a[12:15],a[164:167],a[124:127],0
M a[12:15],a[160:163],a[120:123],a[12:15]
M a[16:19],a[160:163],a[128:131],0
buffer_load_dwordx4 v10, s[16:19], s21 offen offset:2048  nt lds
M a[16:19],a[164:167],a[132:135],a[16:19]
s_waitcnt lgkmcnt(6)
M a[20:23],a[164:167],a[140:143],0
M a[20:23],a[160:163],a[136:139],a[20:23]
buffer_load_dwordx4 v11, s[16:19], s21 offen offset:3072  nt lds
M a[24:27],a[160:163],a[144:147],0
SA s21,s21,524160
M a[24:27],a[164:167],a[148:151],a[24:27]
s_waitcnt lgkmcnt(0)
M a[28:31],a[164:167],a[156:159],0
SA m0,s24,32768
M a[28:31],a[160:163],a[152:155],a[28:31]
buffer_load_dwordx4 v12, s[48:51], s22 offen offset:0   lds
M v[32:35],a[168:171],a[96:99],0
R a[160:163],v5,4096
R a[164:167],v6,4096
M v[32:35],a[172:175],a[100:103],v[32:35]
M v[36:39],a[172:175],a[108:111],0
M v[36:39],a[168:171],a[104:107],v[36:39]
buffer_load_dwordx4 v13, s[48:51], s22 offen offset:1024   lds
M v[40:43],a[168:171],a[112:115],0
M v[40:43],a[172:175],a[116:119],v[40:43]
M v[44:47],a[172:175],a[124:127],0
buffer_load_dwordx4 v14, s[48:51], s22 offen offset:2048   lds
M v[44:47],a[168:171],a[120:123],v[44:47]
M v[48:51],a[168:171],a[128:131],0
M v[48:51],a[172:175],a[132:135],v[48:51]
M v[52:55],a[172:175],a[140:143],0
buffer_load_dwordx4 v15, s[48:51], s22 offen offset:3072   lds
M v[52:55],a[168:171],a[136:139],v[52:55]
SA s22,s22,1048576
M v[56:59],a[168:171],a[144:147],0
M v[56:59],a[172:175],a[148:151],v[56:59]
s_waitcnt lgkmcnt(0)
M v[60:63],a[172:175],a[156:159],0
M v[60:63],a[168:171],a[152:155],v[60:63]
M v[64:67],a[160:163],a[96:99],0
R a[168:171],v5,6144
R a[172:175],v6,6144
M v[64:67],a[164:167],a[100:103],v[64:67]
M v[68:71],a[164:167],a[108:111],0
M v[68:71],a[160:163],a[104:107],v[68:71]
M v[72:75],a[160:163],a[112:115],0
M v[72:75],a[164:167],a[116:119],v[72:75]
M v[76:79],a[164:167],a[124:127],0
M v[76:79],a[160:163],a[120:123],v[76:79]
M v[80:83],a[160:163],a[128:131],0
M v[80:83],a[164:167],a[132:135],v[80:83]
M v[84:87],a[164:167],a[140:143],0
M v[84:87],a[160:163],a[136:139],v[84:87]
M v[88:91],a[160:163],a[144:147],0
M v[88:91],a[164:167],a[148:151],v[88:91]
s_waitcnt lgkmcnt(0)
M v[92:95],a[164:167],a[156:159],0
s_waitcnt vmcnt(12)
M v[92:95],a[160:163],a[152:155],v[92:95]
s_barrier
M v[96:99],a[168:171],a[96:99],0
SA m0,s23,0
R a[160:163],v5,16384
R a[164:167],v6,16384
M v[96:99],a[172:175],a[100:103],v[96:99]
buffer_load_dwordx4 v8, s[16:19], s21 offen offset:0  nt lds
M v[100:103],a[172:175],a[108:111],0
v_lshlrev_b32 v26, 7, v0
v_and_b32 v27, 48, v0
M v[100:103],a[168:171],a[104:107],v[100:103]
v_lshl_add_u32 v26, v27, 24, v26
M v[104:107],a[168:171],a[112:115],0
buffer_load_dwordx4 v9, s[16:19], s21 offen offset:1024  nt lds
M v[104:107],a[172:175],a[116:119],v[104:107]
M v[108:111],a[172:175],a[124:127],0
M v[108:111],a[168:171],a[120:123],v[108:111]
buffer_load_dwordx4 v10, s[16:19], s21 offen offset:2048  nt lds
M v[112:115],a[168:171],a[128:131],0
M v[112:115],a[172:175],a[132:135],v[112:115]
M v[116:119],a[172:175],a[140:143],0
M v[116:119],a[168:171],a[136:139],v[116:119]
buffer_load_dwordx4 v11, s[16:19], s21 offen offset:3072  nt lds
M v[120:123],a[168:171],a[144:147],0
SA s21,s21,128
M v[120:123],a[172:175],a[148:151],v[120:123]
s_waitcnt lgkmcnt(0)
M v[124:127],a[172:175],a[156:159],0
SA m0,s24,49152
M v[124:127],a[168:171],a[152:155],v[124:127]
buffer_load_dwordx4 v12, s[48:51], s22 offen offset:0   lds
M v[128:131],a[160:163],a[96:99],0
R a[168:171],v5,18432
R a[172:175],v6,18432
M v[128:131],a[164:167],a[100:103],v[128:131]
buffer_load_dwordx4 v13, s[48:51], s22 offen offset:1024   lds
M v[132:135],a[164:167],a[108:111],0
M v[132:135],a[160:163],a[104:107],v[132:135]
M v[136:139],a[160:163],a[112:115],0
M v[136:139],a[164:167],a[116:119],v[136:139]
buffer_load_dwordx4 v14, s[48:51], s22 offen offset:2048   lds
M v[140:143],a[164:167],a[124:127],0
M v[140:143],a[160:163],a[120:123],v[140:143]
M v[144:147],a[160:163],a[128:131],0
buffer_load_dwordx4 v15, s[48:51], s22 offen offset:3072   lds
M v[144:147],a[164:167],a[132:135],v[144:147]
s_sub_u32 s22, s22, 1048448
M v[148:151],a[164:167],a[140:143],0
M v[148:151],a[160:163],a[136:139],v[148:151]
M v[152:155],a[160:163],a[144:147],0
M v[152:155],a[164:167],a[148:151],v[152:155]
s_waitcnt lgkmcnt(0)
M v[156:159],a[164:167],a[156:159],0
s_waitcnt vmcnt(12)
M v[156:159],a[160:163],a[152:155],v[156:159]
s_barrier
M v[160:163],a[168:171],a[96:99],0
SA m0,s23,16384
R a[160:163],v5,20480
R a[164:167],v6,20480
M v[160:163],a[172:175],a[100:103],v[160:163]
T a[32:33],v1,32768
T a[34:35],v1,33792
M v[164:167],a[172:175],a[108:111],0
T a[36:37],v1,40960
T a[38:39],v1,41984
M v[164:167],a[168:171],a[104:107],v[164:167]
T a[40:41],v2,32768
T a[42:43],v2,33792
M v[168:171],a[168:171],a[112:115],0
T a[44:45],v2,40960
T a[46:47],v2,41984
M v[168:171],a[172:175],a[116:119],v[168:171]
buffer_load_dwordx4 v8, s[16:19], s21 offen offset:0  nt lds
M v[172:175],a[172:175],a[124:127],0
s_nop 0
T a[48:49],v3,32768
T a[50:51],v3,33792
M v[172:175],a[168:171],a[120:123],v[172:175]
buffer_load_dwordx4 v9, s[16:19], s21 offen offset:1024  nt lds
M v[176:179],a[168:171],a[128:131],0
s_nop 0
T a[52:53],v3,40960
T a[54:55],v3,41984
M v[176:179],a[172:175],a[132:135],v[176:179]
T a[56:57],v4,32768
T a[58:59],v4,33792
M v[180:183],a[172:175],a[140:143],0
buffer_load_dwordx4 v10, s[16:19], s21 offen offset:2048  nt lds
M v[180:183],a[168:171],a[136:139],v[180:183]
s_nop 0
T a[60:61],v4,40960
T a[62:63],v4,41984
M v[184:187],a[168:171],a[144:147],0
buffer_load_dwordx4 v11, s[16:19], s21 offen offset:3072  nt lds
M v[184:187],a[172:175],a[148:151],v[184:187]
s_waitcnt lgkmcnt(15)
s_nop 0
T a[64:65],v1,49152
T a[66:67],v1,50176
M v[188:191],a[172:175],a[156:159],0
SA s21,s21,524160
T a[68:69],v1,57344
T a[70:71],v1,58368
M v[188:191],a[168:171],a[152:155],v[188:191]
SA m0,s24,0
M v[192:195],a[160:163],a[96:99],0
R a[168:171],v5,22528
R a[172:175],v6,22528
M v[192:195],a[164:167],a[100:103],v[192:195]
T a[72:73],v2,49152
T a[74:75],v2,50176
M v[196:199],a[164:167],a[108:111],0
T a[76:77],v2,57344
T a[78:79],v2,58368
M v[196:199],a[160:163],a[104:107],v[196:199]
T a[80:81],v3,49152
T a[82:83],v3,50176
M v[200:203],a[160:163],a[112:115],0
buffer_load_dwordx4 v12, s[48:51], s22 offen offset:0   lds
M v[200:203],a[164:167],a[116:119],v[200:203]
s_nop 0
T a[84:85],v3,57344
T a[86:87],v3,58368
M v[204:207],a[164:167],a[124:127],0
T a[88:89],v4,49152
T a[90:91],v4,50176
M v[204:207],a[160:163],a[120:123],v[204:207]
buffer_load_dwordx4 v13, s[48:51], s22 offen offset:1024   lds
M v[208:211],a[160:163],a[128:131],0
s_nop 0
T a[92:93],v4,57344
T a[94:95],v4,58368
M v[208:211],a[164:167],a[132:135],v[208:211]
buffer_load_dwordx4 v14, s[48:51], s22 offen offset:2048   lds
M v[212:215],a[164:167],a[140:143],0
buffer_load_dwordx4 v15, s[48:51], s22 offen offset:3072   lds
M v[212:215],a[160:163],a[136:139],v[212:215]
SA s22,s22,1048576
M v[216:219],a[160:163],a[144:147],0
M v[216:219],a[164:167],a[148:151],v[216:219]
s_waitcnt lgkmcnt(12)
M v[220:223],a[164:167],a[156:159],0
s_waitcnt vmcnt(12) lgkmcnt(0)
M v[220:223],a[160:163],a[152:155],v[220:223]
s_barrier
M v[224:227],a[168:171],a[96:99],0
SA m0,s23,32768
R a[160:163],v5,32768
R a[164:167],v6,32768
M v[224:227],a[172:175],a[100:103],v[224:227]
buffer_load_dwordx4 v8, s[16:19], s21 offen offset:0  nt lds
M v[228:231],a[172:175],a[108:111],0
M v[228:231],a[168:171],a[104:107],v[228:231]
M v[232:235],a[168:171],a[112:115],0
buffer_load_dwordx4 v9, s[16:19], s21 offen offset:1024  nt lds
M v[232:235],a[172:175],a[116:119],v[232:235]
M v[236:239],a[172:175],a[124:127],0
M v[236:239],a[168:171],a[120:123],v[236:239]
buffer_load_dwordx4 v10, s[16:19], s21 offen offset:2048  nt lds
M v[240:243],a[168:171],a[128:131],0
M v[240:243],a[172:175],a[132:135],v[240:243]
M v[244:247],a[172:175],a[140:143],0
buffer_load_dwordx4 v11, s[16:19], s21 offen offset:3072  nt lds
M v[244:247],a[168:171],a[136:139],v[244:247]
SA s21,s21,128
M v[248:251],a[168:171],a[144:147],0
M v[248:251],a[172:175],a[148:151],v[248:251]
s_waitcnt lgkmcnt(0)
M v[252:255],a[172:175],a[156:159],0
M v[252:255],a[168:171],a[152:155],v[252:255]
M a[0:3],a[160:163],a[32:35],a[0:3]
R a[168:171],v5,34816
R a[172:175],v6,34816
M a[0:3],a[164:167],a[36:39],a[0:3]
T a[96:97],v1,0
T a[98:99],v1,1024
M a[4:7],a[164:167],a[44:47],a[4:7]
SA m0,s24,16384
v_mov_b32 v16, 0
v_mov_b32 v17, 0
M a[4:7],a[160:163],a[40:43],a[4:7]
buffer_load_dwordx4 v12, s[48:51], s22 offen offset:0   lds
M a[8:11],a[160:163],a[48:51],a[8:11]
v_mov_b32 v18, 0
v_mov_b32 v19, 0
M a[8:11],a[164:167],a[52:55],a[8:11]
v_mov_b32 v20, 0
v_mov_b32 v21, 0
M a[12:15],a[164:167],a[60:63],a[12:15]
T a[100:101],v1,8192
T a[102:103],v1,9216
M a[12:15],a[160:163],a[56:59],a[12:15]
v_mov_b32 v22, 0
v_mov_b32 v23, 0
M a[16:19],a[160:163],a[64:67],a[16:19]
buffer_load_dwordx4 v13, s[48:51], s22 offen offset:1024   lds
M a[16:19],a[164:167],a[68:71],a[16:19]
G v28,a192
G v29,a196
M a[20:23],a[164:167],a[76:79],a[20:23]
v_lshlrev_b32 v24, 16, v28
v_lshlrev_b32 v25, 16, v29
M a[20:23],a[160:163],a[72:75],a[20:23]
T a[104:105],v2,0
T a[106:107],v2,1024
M a[24:27],a[160:163],a[80:83],a[24:27]
v_and_b32 v28, 0xffff0000, v28
v_and_b32 v29, 0xffff0000, v29
M a[24:27],a[164:167],a[84:87],a[24:27]
s_waitcnt lgkmcnt(6)
buffer_load_dwordx4 v14, s[48:51], s22 offen offset:2048   lds
M a[28:31],a[164:167],a[92:95],a[28:31]
G v30,a176
v_lshlrev_b32 v31, 16, v30
M a[28:31],a[160:163],a[88:91],a[28:31]
v_and_b32 v30, 0xffff0000, v30
v_fmac_f32 v16, v31, v24
M v[32:35],a[168:171],a[32:35],v[32:35]
R a[160:163],v5,36864
R a[164:167],v6,36864
M v[32:35],a[172:175],a[36:39],v[32:35]
T a[108:109],v2,8192
T a[110:111],v2,9216
M v[36:39],a[172:175],a[44:47],v[36:39]
buffer_load_dwordx4 v15, s[48:51], s22 offen offset:3072   lds
M v[36:39],a[168:171],a[40:43],v[36:39]
s_sub_u32 s22, s22, 1048448
v_fmac_f32 v20, v31, v25
v_fmac_f32 v16, v30, v28
M v[40:43],a[168:171],a[48:51],v[40:43]
v_fmac_f32 v20, v30, v29
G v30,a180
M v[40:43],a[172:175],a[52:55],v[40:43]
T a[112:113],v3,0
T a[114:115],v3,1024
M v[44:47],a[172:175],a[60:63],v[44:47]
SA m0,s23,49152
v_lshlrev_b32 v31, 16, v30
v_and_b32 v30, 0xffff0000, v30
M v[44:47],a[168:171],a[56:59],v[44:47]
buffer_load_dwordx4 v8, s[16:19], s21 offen offset:0  nt lds
M v[48:51],a[168:171],a[64:67],v[48:51]
v_fmac_f32 v17, v31, v24
v_fmac_f32 v21, v31, v25
M v[48:51],a[172:175],a[68:71],v[48:51]
v_fmac_f32 v17, v30, v28
v_fmac_f32 v21, v30, v29
M v[52:55],a[172:175],a[76:79],v[52:55]
T a[116:117],v3,8192
T a[118:119],v3,9216
M v[52:55],a[168:171],a[72:75],v[52:55]
G v30,a184
v_lshlrev_b32 v31, 16, v30
M v[56:59],a[168:171],a[80:83],v[56:59]
buffer_load_dwordx4 v9, s[16:19], s21 offen offset:1024  nt lds
M v[56:59],a[172:175],a[84:87],v[56:59]
s_waitcnt lgkmcnt(6)
v_and_b32 v30, 0xffff0000, v30
v_fmac_f32 v18, v31, v24
M v[60:63],a[172:175],a[92:95],v[60:63]
v_fmac_f32 v22, v31, v25
v_fmac_f32 v18, v30, v28
M v[60:63],a[168:171],a[88:91],v[60:63]
T a[120:121],v4,0
T a[122:123],v4,1024
M v[64:67],a[160:163],a[32:35],v[64:67]
R a[168:171],v5,38912
R a[172:175],v6,38912
M v[64:67],a[164:167],a[36:39],v[64:67]
buffer_load_dwordx4 v10, s[16:19], s21 offen offset:2048  nt lds
M v[68:71],a[164:167],a[44:47],v[68:71]
v_fmac_f32 v22, v30, v29
G v30,a188
M v[68:71],a[160:163],a[40:43],v[68:71]
v_lshlrev_b32 v31, 16, v30
v_and_b32 v30, 0xffff0000, v30
M v[72:75],a[160:163],a[48:51],v[72:75]
T a[124:125],v4,8192
T a[126:127],v4,9216
M v[72:75],a[164:167],a[52:55],v[72:75]
v_fmac_f32 v19, v31, v24
v_fmac_f32 v23, v31, v25
M v[76:79],a[164:167],a[60:63],v[76:79]
buffer_load_dwordx4 v11, s[16:19], s21 offen offset:3072  nt lds
M v[76:79],a[160:163],a[56:59],v[76:79]
SA s21,s21,524160
v_fmac_f32 v19, v30, v28
v_fmac_f32 v23, v30, v29
M v[80:83],a[160:163],a[64:67],v[80:83]
G v28,a193
G v29,a197
M v[80:83],a[164:167],a[68:71],v[80:83]
v_lshlrev_b32 v24, 16, v28
v_lshlrev_b32 v25, 16, v29
M v[84:87],a[164:167],a[76:79],v[84:87]
v_and_b32 v28, 0xffff0000, v28
v_and_b32 v29, 0xffff0000, v29
M v[84:87],a[160:163],a[72:75],v[84:87]
G v30,a177
v_lshlrev_b32 v31, 16, v30
M v[88:91],a[160:163],a[80:83],v[88:91]
v_and_b32 v30, 0xffff0000, v30
v_fmac_f32 v16, v31, v24
M v[88:91],a[164:167],a[84:87],v[88:91]
s_waitcnt lgkmcnt(2)
v_fmac_f32 v20, v31, v25
v_fmac_f32 v16, v30, v28
M v[92:95],a[164:167],a[92:95],v[92:95]
s_waitcnt vmcnt(16) lgkmcnt(0)
v_fmac_f32 v20, v30, v29
G v30,a181
M v[92:95],a[160:163],a[88:91],v[92:95]
s_barrier
M v[96:99],a[168:171],a[32:35],v[96:99]
R a[160:163],v5,49152
R a[164:167],v6,49152
M v[96:99],a[172:175],a[36:39],v[96:99]
v_lshlrev_b32 v31, 16, v30
v_and_b32 v30, 0xffff0000, v30
M v[100:103],a[172:175],a[44:47],v[100:103]
SA m0,s24,32768
T a[128:129],v1,16384
T a[130:131],v1,17408
M v[100:103],a[168:171],a[40:43],v[100:103]
buffer_load_dwordx4 v12, s[48:51], s22 offen offset:0   lds
M v[104:107],a[168:171],a[48:51],v[104:107]
v_fmac_f32 v17, v31, v24
v_fmac_f32 v21, v31, v25
M v[104:107],a[172:175],a[52:55],v[104:107]
v_fmac_f32 v17, v30, v28
v_fmac_f32 v21, v30, v29
M v[108:111],a[172:175],a[60:63],v[108:111]
G v30,a185
v_lshlrev_b32 v31, 16, v30
M v[108:111],a[168:171],a[56:59],v[108:111]
v_and_b32 v30, 0xffff0000, v30
v_fmac_f32 v18, v31, v24
M v[112:115],a[168:171],a[64:67],v[112:115]
v_fmac_f32 v22, v31, v25
v_fmac_f32 v18, v30, v28
M v[112:115],a[172:175],a[68:71],v[112:115]
T a[132:133],v1,24576
T a[134:135],v1,25600
M v[116:119],a[172:175],a[76:79],v[116:119]
buffer_load_dwordx4 v13, s[48:51], s22 offen offset:1024   lds
M v[116:119],a[168:171],a[72:75],v[116:119]
v_fmac_f32 v22, v30, v29
G v30,a189
M v[120:123],a[168:171],a[80:83],v[120:123]
v_lshlrev_b32 v31, 16, v30
v_and_b32 v30, 0xffff0000, v30
M v[120:123],a[172:175],a[84:87],v[120:123]
s_waitcnt lgkmcnt(4)
v_fmac_f32 v19, v31, v24
v_fmac_f32 v23, v31, v25
M v[124:127],a[172:175],a[92:95],v[124:127]
v_fmac_f32 v19, v30, v28
v_fmac_f32 v23, v30, v29
M v[124:127],a[168:171],a[88:91],v[124:127]
G v28,a194
G v29,a198
M v[128:131],a[160:163],a[32:35],v[128:131]
R a[168:171],v5,51200
R a[172:175],v6,51200
M v[128:131],a[164:167],a[36:39],v[128:131]
T a[136:137],v2,16384
T a[138:139],v2,17408
M v[132:135],a[164:167],a[44:47],v[132:135]
buffer_load_dwordx4 v14, s[48:51], s22 offen offset:2048   lds
M v[132:135],a[160:163],a[40:43],v[132:135]
v_lshlrev_b32 v24, 16, v28
v_lshlrev_b32 v25, 16, v29
M v[136:139],a[160:163],a[48:51],v[136:139]
v_and_b32 v28, 0xffff0000, v28
v_and_b32 v29, 0xffff0000, v29
M v[136:139],a[164:167],a[52:55],v[136:139]
G v30,a178
v_lshlrev_b32 v31, 16, v30
M v[140:143],a[164:167],a[60:63],v[140:143]
v_and_b32 v30, 0xffff0000, v30
v_fmac_f32 v16, v31, v24
M v[140:143],a[160:163],a[56:59],v[140:143]
T a[140:141],v2,24576
T a[142:143],v2,25600
M v[144:147],a[160:163],a[64:67],v[144:147]
buffer_load_dwordx4 v15, s[48:51], s22 offen offset:3072   lds
M v[144:147],a[164:167],a[68:71],v[144:147]
SA s22,s22,1048576
v_fmac_f32 v20, v31, v25
v_fmac_f32 v16, v30, v28
M v[148:151],a[164:167],a[76:79],v[148:151]
v_fmac_f32 v20, v30, v29
G v30,a182
M v[148:151],a[160:163],a[72:75],v[148:151]
v_lshlrev_b32 v31, 16, v30
v_and_b32 v30, 0xffff0000, v30
M v[152:155],a[160:163],a[80:83],v[152:155]
v_fmac_f32 v17, v31, v24
v_fmac_f32 v21, v31, v25
M v[152:155],a[164:167],a[84:87],v[152:155]
s_waitcnt lgkmcnt(4)
v_fmac_f32 v17, v30, v28
v_fmac_f32 v21, v30, v29
M v[156:159],a[164:167],a[92:95],v[156:159]
SA m0,s23,0
T a[144:145],v3,16384
T a[146:147],v3,17408
M v[156:159],a[160:163],a[88:91],v[156:159]
buffer_load_dwordx4 v8, s[16:19], s21 offen offset:0  nt lds
M v[160:163],a[168:171],a[32:35],v[160:163]
R a[160:163],v5,53248
R a[164:167],v6,53248
M v[160:163],a[172:175],a[36:39],v[160:163]
G v30,a186
v_lshlrev_b32 v31, 16, v30
M v[164:167],a[172:175],a[44:47],v[164:167]
v_and_b32 v30, 0xffff0000, v30
v_fmac_f32 v18, v31, v24
M v[164:167],a[168:171],a[40:43],v[164:167]
v_fmac_f32 v22, v31, v25
v_fmac_f32 v18, v30, v28
M v[168:171],a[168:171],a[48:51],v[168:171]
v_fmac_f32 v22, v30, v29
G v30,a190
M v[168:171],a[172:175],a[52:55],v[168:171]
L_w_kv11:
s_cbranch_execz L_w_kv15
T a[148:149],v3,24576
T a[150:151],v3,25600
M v[172:175],a[172:175],a[60:63],v[172:175]
buffer_load_dwordx4 v9, s[16:19], s21 offen offset:1024  nt lds
M v[172:175],a[168:171],a[56:59],v[172:175]
v_lshlrev_b32 v31, 16, v30
v_and_b32 v30, 0xffff0000, v30
M v[176:179],a[168:171],a[64:67],v[176:179]
v_fmac_f32 v19, v31, v24
v_fmac_f32 v23, v31, v25
M v[176:179],a[172:175],a[68:71],v[176:179]
v_fmac_f32 v19, v30, v28
v_fmac_f32 v23, v30, v29
M v[180:183],a[172:175],a[76:79],v[180:183]
M v[180:183],a[168:171],a[72:75],v[180:183]
M v[184:187],a[168:171],a[80:83],v[184:187]
s_nop 0
T a[152:153],v4,16384
T a[154:155],v4,17408
M v[184:187],a[172:175],a[84:87],v[184:187]
s_waitcnt lgkmcnt(4)
buffer_load_dwordx4 v10, s[16:19], s21 offen offset:2048  nt lds
M v[188:191],a[172:175],a[92:95],v[188:191]
M v[188:191],a[168:171],a[88:91],v[188:191]
M v[192:195],a[160:163],a[32:35],v[192:195]
R a[168:171],v5,55296
R a[172:175],v6,55296
M v[192:195],a[164:167],a[36:39],v[192:195]
M v[196:199],a[164:167],a[44:47],v[196:199]
M v[196:199],a[160:163],a[40:43],v[196:199]
s_nop 0
T a[156:157],v4,24576
T a[158:159],v4,25600
M v[200:203],a[160:163],a[48:51],v[200:203]
buffer_load_dwordx4 v11, s[16:19], s21 offen offset:3072  nt lds
M v[200:203],a[164:167],a[52:55],v[200:203]
SA s21,s21,128
M v[204:207],a[164:167],a[60:63],v[204:207]
M v[204:207],a[160:163],a[56:59],v[204:207]
M v[208:211],a[160:163],a[64:67],v[208:211]
M v[208:211],a[164:167],a[68:71],v[208:211]
M v[212:215],a[164:167],a[76:79],v[212:215]
M v[212:215],a[160:163],a[72:75],v[212:215]
M v[216:219],a[160:163],a[80:83],v[216:219]
M v[216:219],a[164:167],a[84:87],v[216:219]
s_waitcnt lgkmcnt(2)
M v[220:223],a[164:167],a[92:95],v[220:223]
s_waitcnt vmcnt(16) lgkmcnt(0)
M v[220:223],a[160:163],a[88:91],v[220:223]
s_barrier
M v[224:227],a[168:171],a[32:35],v[224:227]
R a[160:163],v5,0
R a[164:167],v6,0
M v[224:227],a[172:175],a[36:39],v[224:227]
M v[228:231],a[172:175],a[44:47],v[228:231]
M v[228:231],a[168:171],a[40:43],v[228:231]
M v[232:235],a[168:171],a[48:51],v[232:235]
M v[232:235],a[172:175],a[52:55],v[232:235]
M v[236:239],a[172:175],a[60:63],v[236:239]
M v[236:239],a[168:171],a[56:59],v[236:239]
M v[240:243],a[168:171],a[64:67],v[240:243]
M v[240:243],a[172:175],a[68:71],v[240:243]
M v[244:247],a[172:175],a[76:79],v[244:247]
M v[244:247],a[168:171],a[72:75],v[244:247]
M v[248:251],a[168:171],a[80:83],v[248:251]
M v[248:251],a[172:175],a[84:87],v[248:251]
s_waitcnt lgkmcnt(0)
M v[252:255],a[172:175],a[92:95],v[252:255]
M v[252:255],a[168:171],a[88:91],v[252:255]
M a[0:3],a[160:163],a[96:99],a[0:3]
R a[168:171],v5,2048
R a[172:175],v6,2048
M a[0:3],a[164:167],a[100:103],a[0:3]
T a[32:33],v1,32768
T a[34:35],v1,33792
M a[4:7],a[164:167],a[108:111],a[4:7]
SA m0,s24,49152
G v28,a195
G v29,a199
M a[4:7],a[160:163],a[104:107],a[4:7]
buffer_load_dwordx4 v12, s[48:51], s22 offen offset:0   lds
M a[8:11],a[160:163],a[112:115],a[8:11]
v_lshlrev_b32 v24, 16, v28
v_lshlrev_b32 v25, 16, v29
M a[8:11],a[164:167],a[116:119],a[8:11]
v_and_b32 v28, 0xffff0000, v28
v_and_b32 v29, 0xffff0000, v29
M a[12:15],a[164:167],a[124:127],a[12:15]
T a[36:37],v1,40960
T a[38:39],v1,41984
M a[12:15],a[160:163],a[120:123],a[12:15]
G v30,a179
v_lshlrev_b32 v31, 16, v30
M a[16:19],a[160:163],a[128:131],a[16:19]
buffer_load_dwordx4 v13, s[48:51], s22 offen offset:1024   lds
M a[16:19],a[164:167],a[132:135],a[16:19]
v_and_b32 v30, 0xffff0000, v30
v_fmac_f32 v16, v31, v24
M a[20:23],a[164:167],a[140:143],a[20:23]
v_fmac_f32 v20, v31, v25
v_fmac_f32 v16, v30, v28
M a[20:23],a[160:163],a[136:139],a[20:23]
T a[40:41],v2,32768
T a[42:43],v2,33792
M a[24:27],a[160:163],a[144:147],a[24:27]
v_fmac_f32 v20, v30, v29
G v30,a183
M a[24:27],a[164:167],a[148:151],a[24:27]
s_waitcnt lgkmcnt(6)
buffer_load_dwordx4 v14, s[48:51], s22 offen offset:2048   lds
M a[28:31],a[164:167],a[156:159],a[28:31]
v_lshlrev_b32 v31, 16, v30
v_and_b32 v30, 0xffff0000, v30
M a[28:31],a[160:163],a[152:155],a[28:31]
v_fmac_f32 v17, v31, v24
v_fmac_f32 v21, v31, v25
M v[32:35],a[168:171],a[96:99],v[32:35]
R a[160:163],v5,4096
R a[164:167],v6,4096
M v[32:35],a[172:175],a[100:103],v[32:35]
T a[44:45],v2,40960
T a[46:47],v2,41984
M v[36:39],a[172:175],a[108:111],v[36:39]
buffer_load_dwordx4 v15, s[48:51], s22 offen offset:3072   lds
M v[36:39],a[168:171],a[104:107],v[36:39]
s_sub_u32 s22, s22, 1048448
v_fmac_f32 v17, v30, v28
v_fmac_f32 v21, v30, v29
M v[40:43],a[168:171],a[112:115],v[40:43]
G v30,a187
v_lshlrev_b32 v31, 16, v30
M v[40:43],a[172:175],a[116:119],v[40:43]
T a[48:49],v3,32768
T a[50:51],v3,33792
M v[44:47],a[172:175],a[124:127],v[44:47]
SA m0,s23,16384
v_and_b32 v30, 0xffff0000, v30
v_fmac_f32 v18, v31, v24
M v[44:47],a[168:171],a[120:123],v[44:47]
buffer_load_dwordx4 v8, s[16:19], s21 offen offset:0  nt lds
M v[48:51],a[168:171],a[128:131],v[48:51]
v_fmac_f32 v22, v31, v25
v_fmac_f32 v18, v30, v28
M v[48:51],a[172:175],a[132:135],v[48:51]
v_fmac_f32 v22, v30, v29
G v30,a191
M v[52:55],a[172:175],a[140:143],v[52:55]
T a[52:53],v3,40960
T a[54:55],v3,41984
M v[52:55],a[168:171],a[136:139],v[52:55]
v_lshlrev_b32 v31, 16, v30
v_and_b32 v30, 0xffff0000, v30
M v[56:59],a[168:171],a[144:147],v[56:59]
buffer_load_dwordx4 v9, s[16:19], s21 offen offset:1024  nt lds
M v[56:59],a[172:175],a[148:151],v[56:59]
s_waitcnt lgkmcnt(6)
v_fmac_f32 v19, v31, v24
v_fmac_f32 v23, v31, v25
M v[60:63],a[172:175],a[156:159],v[60:63]
v_fmac_f32 v19, v30, v28
v_fmac_f32 v23, v30, v29
M v[60:63],a[168:171],a[152:155],v[60:63]
T a[56:57],v4,32768
T a[58:59],v4,33792
M v[64:67],a[160:163],a[96:99],v[64:67]
R a[168:171],v5,6144
R a[172:175],v6,6144
M v[64:67],a[164:167],a[100:103],v[64:67]
buffer_load_dwordx4 v10, s[16:19], s21 offen offset:2048  nt lds
M v[68:71],a[164:167],a[108:111],v[68:71]
v_permlane32_swap_b32 v16, v18
M v[68:71],a[160:163],a[104:107],v[68:71]
v_permlane32_swap_b32 v17, v19
M v[72:75],a[160:163],a[112:115],v[72:75]
s_nop 0
T a[60:61],v4,40960
T a[62:63],v4,41984
M v[72:75],a[164:167],a[116:119],v[72:75]
v_permlane32_swap_b32 v20, v22
M v[76:79],a[164:167],a[124:127],v[76:79]
buffer_load_dwordx4 v11, s[16:19], s21 offen offset:3072  nt lds
M v[76:79],a[160:163],a[120:123],v[76:79]
SA s21,s21,524160
v_permlane32_swap_b32 v21, v23
M v[80:83],a[160:163],a[128:131],v[80:83]
AF v16,v16,v18
AF v17,v17,v19
M v[80:83],a[164:167],a[132:135],v[80:83]
AF v20,v20,v22
AF v21,v21,v23
M v[84:87],a[164:167],a[140:143],v[84:87]
v_lshrrev_b32 v28, 4, v0
M v[84:87],a[160:163],a[136:139],v[84:87]
v_permlane16_swap_b32 v16, v17
M v[88:91],a[160:163],a[144:147],v[88:91]
v_permlane16_swap_b32 v20, v21
M v[88:91],a[164:167],a[148:151],v[88:91]
s_waitcnt lgkmcnt(2)
AF v16,v16,v17
AF v20,v20,v21
M v[92:95],a[164:167],a[156:159],v[92:95]
s_waitcnt vmcnt(16) lgkmcnt(0)
v_add_u32 v29, s67, v28
v_add_f32 v16, v16, v16 row_ror:8 row_mask:0xf bank_mask:0xf
M v[92:95],a[160:163],a[152:155],v[92:95]
s_barrier
M v[96:99],a[168:171],a[96:99],v[96:99]
R a[160:163],v5,16384
R a[164:167],v6,16384
M v[96:99],a[172:175],a[100:103],v[96:99]
v_add_f32 v20, v20, v20 row_ror:8 row_mask:0xf bank_mask:0xf
v_add_f32 v16, v16, v16 row_ror:4 row_mask:0xf bank_mask:0xf
M v[100:103],a[172:175],a[108:111],v[100:103]
SA m0,s24,0
T a[64:65],v1,49152
T a[66:67],v1,50176
M v[100:103],a[168:171],a[104:107],v[100:103]
buffer_load_dwordx4 v12, s[48:51], s22 offen offset:0   lds
M v[104:107],a[168:171],a[112:115],v[104:107]
v_add_f32 v20, v20, v20 row_ror:4 row_mask:0xf bank_mask:0xf
v_add_f32 v16, v16, v16 row_ror:2 row_mask:0xf bank_mask:0xf
M v[104:107],a[172:175],a[116:119],v[104:107]
v_add_f32 v20, v20, v20 row_ror:2 row_mask:0xf bank_mask:0xf
v_add_f32 v16, v16, v16 row_ror:1 row_mask:0xf bank_mask:0xf
M v[108:111],a[172:175],a[124:127],v[108:111]
v_add_f32 v20, v20, v20 row_ror:1 row_mask:0xf bank_mask:0xf
v_ashrrev_i32 v30, 31, v16
M v[108:111],a[168:171],a[120:123],v[108:111]
v_or_b32 v30, 0x80000000, v30
v_xor_b32 v30, v30, v16
M v[112:115],a[168:171],a[128:131],v[112:115]
v_and_b32 v30, 0xfffff800, v30
v_sub_u32 v29, 2047, v29
M v[112:115],a[172:175],a[132:135],v[112:115]
T a[68:69],v1,57344
T a[70:71],v1,58368
M v[116:119],a[172:175],a[140:143],v[116:119]
buffer_load_dwordx4 v13, s[48:51], s22 offen offset:1024   lds
M v[116:119],a[168:171],a[136:139],v[116:119]
v_or_b32 v30, v30, v29
v_max_u32 v30, 1, v30
M v[120:123],a[168:171],a[144:147],v[120:123]
MF v21,0xbfb8aa3b,v20
M v[120:123],a[172:175],a[148:151],v[120:123]
s_waitcnt lgkmcnt(4)
E v21,v21
M v[124:127],a[172:175],a[156:159],v[124:127]
AF v21,1.0,v21
M v[124:127],a[168:171],a[152:155],v[124:127]
v_rcp_f32 v20, v21
M v[128:131],a[160:163],a[96:99],v[128:131]
s_lshl_b32 s72, s20, 4
R a[168:171],v5,18432
R a[172:175],v6,18432
M v[128:131],a[164:167],a[100:103],v[128:131]
SA s72,s72,163584
T a[72:73],v2,49152
T a[74:75],v2,50176
M v[132:135],a[164:167],a[108:111],v[132:135]
buffer_load_dwordx4 v14, s[48:51], s22 offen offset:2048   lds
M v[132:135],a[160:163],a[104:107],v[132:135]
v_lshl_add_u32 v28, v28, 2, s72
ds_write_b32 v28, v30
M v[136:139],a[160:163],a[112:115],v[136:139]
ds_write_b32 v28, v16 offset:64
ds_write_b32 v28, v20 offset:128
M v[136:139],a[164:167],a[116:119],v[136:139]
M v[140:143],a[164:167],a[124:127],v[140:143]
M v[140:143],a[160:163],a[120:123],v[140:143]
s_nop 0
T a[76:77],v2,57344
T a[78:79],v2,58368
M v[144:147],a[160:163],a[128:131],v[144:147]
buffer_load_dwordx4 v15, s[48:51], s22 offen offset:3072   lds
M v[144:147],a[164:167],a[132:135],v[144:147]
SA s22,s22,1048576
M v[148:151],a[164:167],a[140:143],v[148:151]
M v[148:151],a[160:163],a[136:139],v[148:151]
M v[152:155],a[160:163],a[144:147],v[152:155]
M v[152:155],a[164:167],a[148:151],v[152:155]
s_waitcnt lgkmcnt(7)
M v[156:159],a[164:167],a[156:159],v[156:159]
SA m0,s23,32768
T a[80:81],v3,49152
T a[82:83],v3,50176
M v[156:159],a[160:163],a[152:155],v[156:159]
buffer_load_dwordx4 v8, s[16:19], s21 offen offset:0  nt lds
M v[160:163],a[168:171],a[96:99],v[160:163]
R a[160:163],v5,20480
R a[164:167],v6,20480
M v[160:163],a[172:175],a[100:103],v[160:163]
M v[164:167],a[172:175],a[108:111],v[164:167]
M v[164:167],a[168:171],a[104:107],v[164:167]
M v[168:171],a[168:171],a[112:115],v[168:171]
M v[168:171],a[172:175],a[116:119],v[168:171]
s_nop 0
T a[84:85],v3,57344
T a[86:87],v3,58368
M v[172:175],a[172:175],a[124:127],v[172:175]
buffer_load_dwordx4 v9, s[16:19], s21 offen offset:1024  nt lds
M v[172:175],a[168:171],a[120:123],v[172:175]
M v[176:179],a[168:171],a[128:131],v[176:179]
M v[176:179],a[172:175],a[132:135],v[176:179]
M v[180:183],a[172:175],a[140:143],v[180:183]
M v[180:183],a[168:171],a[136:139],v[180:183]
M v[184:187],a[168:171],a[144:147],v[184:187]
s_nop 0
T a[88:89],v4,49152
T a[90:91],v4,50176
M v[184:187],a[172:175],a[148:151],v[184:187]
s_waitcnt lgkmcnt(4)
buffer_load_dwordx4 v10, s[16:19], s21 offen offset:2048  nt lds
M v[188:191],a[172:175],a[156:159],v[188:191]
M v[188:191],a[168:171],a[152:155],v[188:191]
M v[192:195],a[160:163],a[96:99],v[192:195]
R a[168:171],v5,22528
R a[172:175],v6,22528
M v[192:195],a[164:167],a[100:103],v[192:195]
M v[196:199],a[164:167],a[108:111],v[196:199]
M v[196:199],a[160:163],a[104:107],v[196:199]
s_nop 0
T a[92:93],v4,57344
T a[94:95],v4,58368
M v[200:203],a[160:163],a[112:115],v[200:203]
buffer_load_dwordx4 v11, s[16:19], s21 offen offset:3072  nt lds
M v[200:203],a[164:167],a[116:119],v[200:203]
SA s21,s21,128
M v[204:207],a[164:167],a[124:127],v[204:207]
M v[204:207],a[160:163],a[120:123],v[204:207]
M v[208:211],a[160:163],a[128:131],v[208:211]
M v[208:211],a[164:167],a[132:135],v[208:211]
M v[212:215],a[164:167],a[140:143],v[212:215]
M v[212:215],a[160:163],a[136:139],v[212:215]
M v[216:219],a[160:163],a[144:147],v[216:219]
M v[216:219],a[164:167],a[148:151],v[216:219]
s_waitcnt lgkmcnt(2)
M v[220:223],a[164:167],a[156:159],v[220:223]
s_waitcnt vmcnt(16) lgkmcnt(0)
M v[220:223],a[160:163],a[152:155],v[220:223]
s_barrier
M v[224:227],a[168:171],a[96:99],v[224:227]
R a[160:163],v5,32768
R a[164:167],v6,32768
M v[224:227],a[172:175],a[100:103],v[224:227]
M v[228:231],a[172:175],a[108:111],v[228:231]
M v[228:231],a[168:171],a[104:107],v[228:231]
M v[232:235],a[168:171],a[112:115],v[232:235]
M v[232:235],a[172:175],a[116:119],v[232:235]
M v[236:239],a[172:175],a[124:127],v[236:239]
M v[236:239],a[168:171],a[120:123],v[236:239]
M v[240:243],a[168:171],a[128:131],v[240:243]
M v[240:243],a[172:175],a[132:135],v[240:243]
M v[244:247],a[172:175],a[140:143],v[244:247]
M v[244:247],a[168:171],a[136:139],v[244:247]
M v[248:251],a[168:171],a[144:147],v[248:251]
M v[248:251],a[172:175],a[148:151],v[248:251]
s_waitcnt lgkmcnt(0)
M v[252:255],a[172:175],a[156:159],v[252:255]
M v[252:255],a[168:171],a[152:155],v[252:255]
M a[0:3],a[160:163],a[32:35],a[0:3]
R a[168:171],v5,34816
R a[172:175],v6,34816
M a[0:3],a[164:167],a[36:39],a[0:3]
T a[96:97],v1,0
T a[98:99],v1,1024
M a[4:7],a[164:167],a[44:47],a[4:7]
SA m0,s24,16384
M a[4:7],a[160:163],a[40:43],a[4:7]
buffer_load_dwordx4 v12, s[48:51], s22 offen offset:0   lds
M a[8:11],a[160:163],a[48:51],a[8:11]
v_and_b32 v20, 31, v0
M a[8:11],a[164:167],a[52:55],a[8:11]
v_lshlrev_b32 v20, 2, v20
M a[12:15],a[164:167],a[60:63],a[12:15]
s_nop 0
T a[100:101],v1,8192
T a[102:103],v1,9216
M a[12:15],a[160:163],a[56:59],a[12:15]
v_add_u32 v21, 163584, v20
M a[16:19],a[160:163],a[64:67],a[16:19]
buffer_load_dwordx4 v13, s[48:51], s22 offen offset:1024   lds
M a[16:19],a[164:167],a[68:71],a[16:19]
ds_read_b32 v19, v21
M a[20:23],a[164:167],a[76:79],a[20:23]
ds_read_b32 v21, v21 offset:64
M a[20:23],a[160:163],a[72:75],a[20:23]
s_min_u32 s64, s20, 1
T a[104:105],v2,0
T a[106:107],v2,1024
M a[24:27],a[160:163],a[80:83],a[24:27]
s_lshl_b32 s64, s64, 29
v_and_b32 v22, 32, v0
M a[24:27],a[164:167],a[84:87],a[24:27]
s_waitcnt lgkmcnt(8)
buffer_load_dwordx4 v14, s[48:51], s22 offen offset:2048   lds
M a[28:31],a[164:167],a[92:95],a[28:31]
v_lshl_or_b32 v20, v22, 24, v20
M a[28:31],a[160:163],a[88:91],a[28:31]
v_or_b32 v20, s64, v20
M v[32:35],a[168:171],a[32:35],v[32:35]
R a[160:163],v5,36864
R a[164:167],v6,36864
M v[32:35],a[172:175],a[36:39],v[32:35]
T a[108:109],v2,8192
T a[110:111],v2,9216
M v[36:39],a[172:175],a[44:47],v[36:39]
buffer_load_dwordx4 v15, s[48:51], s22 offen offset:3072   lds
M v[36:39],a[168:171],a[40:43],v[36:39]
s_sub_u32 s22, s22, 1048448
v_and_b32 v22, 16, v0
M v[40:43],a[168:171],a[48:51],v[40:43]
v_lshl_or_b32 v18, v22, 25, v20
s_and_b32 s27, s42, 7
M v[40:43],a[172:175],a[52:55],v[40:43]
s_lshl_b32 s72, s30, 7
T a[112:113],v3,0
T a[114:115],v3,1024
M v[44:47],a[172:175],a[60:63],v[44:47]
SA m0,s23,49152
SA s72,s72,104857600
s_lshl_b32 s64, s41, 3
M v[44:47],a[168:171],a[56:59],v[44:47]
SA s27,s27,s64
buffer_load_dwordx4 v8, s[16:19], s21 offen offset:0  nt lds
M v[48:51],a[168:171],a[64:67],v[48:51]
s_lshl_b32 s27, s27, 2
M v[48:51],a[172:175],a[68:71],v[48:51]
SA s27,s27,s20
M v[52:55],a[172:175],a[76:79],v[52:55]
s_mul_i32 s27, s27, 7168
T a[116:117],v3,8192
T a[118:119],v3,9216
M v[52:55],a[168:171],a[72:75],v[52:55]
s_mov_b32 s60, s90
M v[56:59],a[168:171],a[80:83],v[56:59]
s_and_b32 s61, s91, 0xffff
buffer_load_dwordx4 v9, s[16:19], s21 offen offset:1024  nt lds
M v[56:59],a[172:175],a[84:87],v[56:59]
s_waitcnt lgkmcnt(6)
buffer_store_dword v21, v20, s[8:11], s72 offen sc1
M v[60:63],a[172:175],a[92:95],v[60:63]
s_mov_b32 s62, 3670016
M v[60:63],a[168:171],a[88:91],v[60:63]
s_mov_b32 s63, 0x20000
T a[120:121],v4,0
T a[122:123],v4,1024
M v[64:67],a[160:163],a[32:35],v[64:67]
R a[168:171],v5,38912
R a[172:175],v6,38912
M v[64:67],a[164:167],a[36:39],v[64:67]
buffer_load_dwordx4 v10, s[16:19], s21 offen offset:2048  nt lds
M v[68:71],a[164:167],a[44:47],v[68:71]
M v[68:71],a[160:163],a[40:43],v[68:71]
M v[72:75],a[160:163],a[48:51],v[72:75]
s_nop 0
T a[124:125],v4,8192
T a[126:127],v4,9216
M v[72:75],a[164:167],a[52:55],v[72:75]
M v[76:79],a[164:167],a[60:63],v[76:79]
buffer_load_dwordx4 v11, s[16:19], s21 offen offset:3072  nt lds
M v[76:79],a[160:163],a[56:59],v[76:79]
SA s21,s21,524160
M v[80:83],a[160:163],a[64:67],v[80:83]
M v[80:83],a[164:167],a[68:71],v[80:83]
M v[84:87],a[164:167],a[76:79],v[84:87]
M v[84:87],a[160:163],a[72:75],v[84:87]
M v[88:91],a[160:163],a[80:83],v[88:91]
M v[88:91],a[164:167],a[84:87],v[88:91]
s_waitcnt lgkmcnt(2)
M v[92:95],a[164:167],a[92:95],v[92:95]
s_waitcnt vmcnt(17) lgkmcnt(0)
M v[92:95],a[160:163],a[88:91],v[92:95]
s_barrier
M v[96:99],a[168:171],a[32:35],v[96:99]
R a[160:163],v5,49152
R a[164:167],v6,49152
M v[96:99],a[172:175],a[36:39],v[96:99]
M v[100:103],a[172:175],a[44:47],v[100:103]
SA m0,s24,32768
T a[128:129],v1,16384
T a[130:131],v1,17408
M v[100:103],a[168:171],a[40:43],v[100:103]
buffer_load_dwordx4 v12, s[48:51], s22 offen offset:0   lds
M v[104:107],a[168:171],a[48:51],v[104:107]
v_min_u32 v16, 40, v0
v_lshlrev_b32 v16, 2, v16
M v[104:107],a[172:175],a[52:55],v[104:107]
buffer_load_dword v17, v16, s[12:15], 0 offen sc1
M v[108:111],a[172:175],a[60:63],v[108:111]
M v[108:111],a[168:171],a[56:59],v[108:111]
M v[112:115],a[168:171],a[64:67],v[112:115]
M v[112:115],a[172:175],a[68:71],v[112:115]
s_nop 0
T a[132:133],v1,24576
T a[134:135],v1,25600
M v[116:119],a[172:175],a[76:79],v[116:119]
buffer_load_dwordx4 v13, s[48:51], s22 offen offset:1024   lds
M v[116:119],a[168:171],a[72:75],v[116:119]
M v[120:123],a[168:171],a[80:83],v[120:123]
M v[120:123],a[172:175],a[84:87],v[120:123]
s_waitcnt lgkmcnt(4)
M v[124:127],a[172:175],a[92:95],v[124:127]
M v[124:127],a[168:171],a[88:91],v[124:127]
M v[128:131],a[160:163],a[32:35],v[128:131]
R a[168:171],v5,51200
R a[172:175],v6,51200
M v[128:131],a[164:167],a[36:39],v[128:131]
T a[136:137],v2,16384
T a[138:139],v2,17408
M v[132:135],a[164:167],a[44:47],v[132:135]
buffer_load_dwordx4 v14, s[48:51], s22 offen offset:2048   lds
M v[132:135],a[160:163],a[40:43],v[132:135]
M v[136:139],a[160:163],a[48:51],v[136:139]
M v[136:139],a[164:167],a[52:55],v[136:139]
M v[140:143],a[164:167],a[60:63],v[140:143]
M v[140:143],a[160:163],a[56:59],v[140:143]
s_nop 0
T a[140:141],v2,24576
T a[142:143],v2,25600
M v[144:147],a[160:163],a[64:67],v[144:147]
buffer_load_dwordx4 v15, s[48:51], s22 offen offset:3072   lds
M v[144:147],a[164:167],a[68:71],v[144:147]
SA s22,s22,1048576
M v[148:151],a[164:167],a[76:79],v[148:151]
M v[148:151],a[160:163],a[72:75],v[148:151]
M v[152:155],a[160:163],a[80:83],v[152:155]
M v[152:155],a[164:167],a[84:87],v[152:155]
s_waitcnt lgkmcnt(4)
M v[156:159],a[164:167],a[92:95],v[156:159]
SA m0,s23,0
T a[144:145],v3,16384
T a[146:147],v3,17408
M v[156:159],a[160:163],a[88:91],v[156:159]
buffer_load_dwordx4 v8, s[16:19], s21 offen offset:0  nt lds
M v[160:163],a[168:171],a[32:35],v[160:163]
R a[160:163],v5,53248
R a[164:167],v6,53248
M v[160:163],a[172:175],a[36:39],v[160:163]
buffer_load_dword a240, v26, s[60:63], s27 offen offset:0
M v[164:167],a[172:175],a[44:47],v[164:167]
SA s27,s27,2048
M v[164:167],a[168:171],a[40:43],v[164:167]
M v[168:171],a[168:171],a[48:51],v[168:171]
M v[168:171],a[172:175],a[52:55],v[168:171]
s_nop 0
T a[148:149],v3,24576
T a[150:151],v3,25600
M v[172:175],a[172:175],a[60:63],v[172:175]
buffer_load_dwordx4 v9, s[16:19], s21 offen offset:1024  nt lds
M v[172:175],a[168:171],a[56:59],v[172:175]
M v[176:179],a[168:171],a[64:67],v[176:179]
M v[176:179],a[172:175],a[68:71],v[176:179]
M v[180:183],a[172:175],a[76:79],v[180:183]
M v[180:183],a[168:171],a[72:75],v[180:183]
M v[184:187],a[168:171],a[80:83],v[184:187]
s_nop 0
T a[152:153],v4,16384
T a[154:155],v4,17408
M v[184:187],a[172:175],a[84:87],v[184:187]
s_waitcnt lgkmcnt(4)
buffer_load_dwordx4 v10, s[16:19], s21 offen offset:2048  nt lds
M v[188:191],a[172:175],a[92:95],v[188:191]
M v[188:191],a[168:171],a[88:91],v[188:191]
M v[192:195],a[160:163],a[32:35],v[192:195]
L_w_kv12:
s_cbranch_execz L_w_kv16
R a[168:171],v5,55296
R a[172:175],v6,55296
M v[192:195],a[164:167],a[36:39],v[192:195]
M v[196:199],a[164:167],a[44:47],v[196:199]
M v[196:199],a[160:163],a[40:43],v[196:199]
s_nop 0
T a[156:157],v4,24576
T a[158:159],v4,25600
M v[200:203],a[160:163],a[48:51],v[200:203]
buffer_load_dwordx4 v11, s[16:19], s21 offen offset:3072  nt lds
M v[200:203],a[164:167],a[52:55],v[200:203]
SA s21,s21,128
M v[204:207],a[164:167],a[60:63],v[204:207]
M v[204:207],a[160:163],a[56:59],v[204:207]
M v[208:211],a[160:163],a[64:67],v[208:211]
M v[208:211],a[164:167],a[68:71],v[208:211]
M v[212:215],a[164:167],a[76:79],v[212:215]
M v[212:215],a[160:163],a[72:75],v[212:215]
M v[216:219],a[160:163],a[80:83],v[216:219]
M v[216:219],a[164:167],a[84:87],v[216:219]
s_waitcnt lgkmcnt(2)
M v[220:223],a[164:167],a[92:95],v[220:223]
s_waitcnt vmcnt(19) lgkmcnt(0)
M v[220:223],a[160:163],a[88:91],v[220:223]
s_barrier
M v[224:227],a[168:171],a[32:35],v[224:227]
R a[160:163],v5,0
R a[164:167],v6,0
M v[224:227],a[172:175],a[36:39],v[224:227]
M v[228:231],a[172:175],a[44:47],v[228:231]
M v[228:231],a[168:171],a[40:43],v[228:231]
M v[232:235],a[168:171],a[48:51],v[232:235]
M v[232:235],a[172:175],a[52:55],v[232:235]
M v[236:239],a[172:175],a[60:63],v[236:239]
M v[236:239],a[168:171],a[56:59],v[236:239]
M v[240:243],a[168:171],a[64:67],v[240:243]
M v[240:243],a[172:175],a[68:71],v[240:243]
M v[244:247],a[172:175],a[76:79],v[244:247]
M v[244:247],a[168:171],a[72:75],v[244:247]
M v[248:251],a[168:171],a[80:83],v[248:251]
M v[248:251],a[172:175],a[84:87],v[248:251]
s_waitcnt lgkmcnt(0)
M v[252:255],a[172:175],a[92:95],v[252:255]
M v[252:255],a[168:171],a[88:91],v[252:255]
M a[0:3],a[160:163],a[96:99],a[0:3]
R a[168:171],v5,2048
R a[172:175],v6,2048
M a[0:3],a[164:167],a[100:103],a[0:3]
T a[32:33],v1,32768
T a[34:35],v1,33792
M a[4:7],a[164:167],a[108:111],a[4:7]
SA m0,s24,49152
M a[4:7],a[160:163],a[104:107],a[4:7]
buffer_load_dwordx4 v12, s[48:51], s22 offen offset:0   lds
M a[8:11],a[160:163],a[112:115],a[8:11]
M a[8:11],a[164:167],a[116:119],a[8:11]
M a[12:15],a[164:167],a[124:127],a[12:15]
s_nop 0
T a[36:37],v1,40960
T a[38:39],v1,41984
M a[12:15],a[160:163],a[120:123],a[12:15]
M a[16:19],a[160:163],a[128:131],a[16:19]
buffer_load_dwordx4 v13, s[48:51], s22 offen offset:1024   lds
M a[16:19],a[164:167],a[132:135],a[16:19]
M a[20:23],a[164:167],a[140:143],a[20:23]
M a[20:23],a[160:163],a[136:139],a[20:23]
s_nop 0
T a[40:41],v2,32768
T a[42:43],v2,33792
M a[24:27],a[160:163],a[144:147],a[24:27]
M a[24:27],a[164:167],a[148:151],a[24:27]
s_waitcnt lgkmcnt(6)
buffer_load_dwordx4 v14, s[48:51], s22 offen offset:2048   lds
M a[28:31],a[164:167],a[156:159],a[28:31]
M a[28:31],a[160:163],a[152:155],a[28:31]
M v[32:35],a[168:171],a[96:99],v[32:35]
R a[160:163],v5,4096
R a[164:167],v6,4096
M v[32:35],a[172:175],a[100:103],v[32:35]
T a[44:45],v2,40960
T a[46:47],v2,41984
M v[36:39],a[172:175],a[108:111],v[36:39]
buffer_load_dwordx4 v15, s[48:51], s22 offen offset:3072   lds
M v[36:39],a[168:171],a[104:107],v[36:39]
s_sub_u32 s22, s22, 1048448
M v[40:43],a[168:171],a[112:115],v[40:43]
M v[40:43],a[172:175],a[116:119],v[40:43]
s_nop 0
T a[48:49],v3,32768
T a[50:51],v3,33792
M v[44:47],a[172:175],a[124:127],v[44:47]
SA m0,s23,16384
M v[44:47],a[168:171],a[120:123],v[44:47]
buffer_load_dwordx4 v8, s[16:19], s21 offen offset:0  nt lds
M v[48:51],a[168:171],a[128:131],v[48:51]
M v[48:51],a[172:175],a[132:135],v[48:51]
M v[52:55],a[172:175],a[140:143],v[52:55]
s_nop 0
T a[52:53],v3,40960
T a[54:55],v3,41984
M v[52:55],a[168:171],a[136:139],v[52:55]
M v[56:59],a[168:171],a[144:147],v[56:59]
buffer_load_dwordx4 v9, s[16:19], s21 offen offset:1024  nt lds
M v[56:59],a[172:175],a[148:151],v[56:59]
s_waitcnt lgkmcnt(6)
M v[60:63],a[172:175],a[156:159],v[60:63]
M v[60:63],a[168:171],a[152:155],v[60:63]
s_nop 0
T a[56:57],v4,32768
T a[58:59],v4,33792
M v[64:67],a[160:163],a[96:99],v[64:67]
R a[168:171],v5,6144
R a[172:175],v6,6144
M v[64:67],a[164:167],a[100:103],v[64:67]
buffer_load_dwordx4 v10, s[16:19], s21 offen offset:2048  nt lds
M v[68:71],a[164:167],a[108:111],v[68:71]
M v[68:71],a[160:163],a[104:107],v[68:71]
M v[72:75],a[160:163],a[112:115],v[72:75]
s_nop 0
T a[60:61],v4,40960
T a[62:63],v4,41984
M v[72:75],a[164:167],a[116:119],v[72:75]
M v[76:79],a[164:167],a[124:127],v[76:79]
buffer_load_dwordx4 v11, s[16:19], s21 offen offset:3072  nt lds
M v[76:79],a[160:163],a[120:123],v[76:79]
SA s21,s21,524160
M v[80:83],a[160:163],a[128:131],v[80:83]
M v[80:83],a[164:167],a[132:135],v[80:83]
M v[84:87],a[164:167],a[140:143],v[84:87]
M v[84:87],a[160:163],a[136:139],v[84:87]
M v[88:91],a[160:163],a[144:147],v[88:91]
M v[88:91],a[164:167],a[148:151],v[88:91]
s_waitcnt lgkmcnt(2)
M v[92:95],a[164:167],a[156:159],v[92:95]
s_waitcnt vmcnt(18) lgkmcnt(0)
M v[92:95],a[160:163],a[152:155],v[92:95]
s_barrier
M v[96:99],a[168:171],a[96:99],v[96:99]
R a[160:163],v5,16384
R a[164:167],v6,16384
M v[96:99],a[172:175],a[100:103],v[96:99]
M v[100:103],a[172:175],a[108:111],v[100:103]
SA m0,s24,0
T a[64:65],v1,49152
T a[66:67],v1,50176
M v[100:103],a[168:171],a[104:107],v[100:103]
buffer_load_dwordx4 v12, s[48:51], s22 offen offset:0   lds
M v[104:107],a[168:171],a[112:115],v[104:107]
M v[104:107],a[172:175],a[116:119],v[104:107]
M v[108:111],a[172:175],a[124:127],v[108:111]
M v[108:111],a[168:171],a[120:123],v[108:111]
M v[112:115],a[168:171],a[128:131],v[112:115]
M v[112:115],a[172:175],a[132:135],v[112:115]
s_nop 0
T a[68:69],v1,57344
T a[70:71],v1,58368
M v[116:119],a[172:175],a[140:143],v[116:119]
buffer_load_dwordx4 v13, s[48:51], s22 offen offset:1024   lds
M v[116:119],a[168:171],a[136:139],v[116:119]
M v[120:123],a[168:171],a[144:147],v[120:123]
M v[120:123],a[172:175],a[148:151],v[120:123]
s_waitcnt lgkmcnt(4)
M v[124:127],a[172:175],a[156:159],v[124:127]
M v[124:127],a[168:171],a[152:155],v[124:127]
M v[128:131],a[160:163],a[96:99],v[128:131]
R a[168:171],v5,18432
R a[172:175],v6,18432
M v[128:131],a[164:167],a[100:103],v[128:131]
T a[72:73],v2,49152
T a[74:75],v2,50176
M v[132:135],a[164:167],a[108:111],v[132:135]
buffer_load_dwordx4 v14, s[48:51], s22 offen offset:2048   lds
M v[132:135],a[160:163],a[104:107],v[132:135]
M v[136:139],a[160:163],a[112:115],v[136:139]
M v[136:139],a[164:167],a[116:119],v[136:139]
M v[140:143],a[164:167],a[124:127],v[140:143]
M v[140:143],a[160:163],a[120:123],v[140:143]
s_nop 0
T a[76:77],v2,57344
T a[78:79],v2,58368
M v[144:147],a[160:163],a[128:131],v[144:147]
buffer_load_dwordx4 v15, s[48:51], s22 offen offset:3072   lds
M v[144:147],a[164:167],a[132:135],v[144:147]
SA s22,s22,1048576
M v[148:151],a[164:167],a[140:143],v[148:151]
M v[148:151],a[160:163],a[136:139],v[148:151]
M v[152:155],a[160:163],a[144:147],v[152:155]
M v[152:155],a[164:167],a[148:151],v[152:155]
s_waitcnt lgkmcnt(4)
M v[156:159],a[164:167],a[156:159],v[156:159]
SA m0,s23,32768
T a[80:81],v3,49152
T a[82:83],v3,50176
M v[156:159],a[160:163],a[152:155],v[156:159]
buffer_load_dwordx4 v8, s[16:19], s21 offen offset:0  nt lds
M v[160:163],a[168:171],a[96:99],v[160:163]
R a[160:163],v5,20480
R a[164:167],v6,20480
M v[160:163],a[172:175],a[100:103],v[160:163]
buffer_load_dword a240, v26, s[60:63], s27 offen offset:0
M v[164:167],a[172:175],a[108:111],v[164:167]
SA s27,s27,2048
M v[164:167],a[168:171],a[104:107],v[164:167]
M v[168:171],a[168:171],a[112:115],v[168:171]
M v[168:171],a[172:175],a[116:119],v[168:171]
s_nop 0
T a[84:85],v3,57344
T a[86:87],v3,58368
M v[172:175],a[172:175],a[124:127],v[172:175]
buffer_load_dwordx4 v9, s[16:19], s21 offen offset:1024  nt lds
M v[172:175],a[168:171],a[120:123],v[172:175]
M v[176:179],a[168:171],a[128:131],v[176:179]
M v[176:179],a[172:175],a[132:135],v[176:179]
M v[180:183],a[172:175],a[140:143],v[180:183]
M v[180:183],a[168:171],a[136:139],v[180:183]
M v[184:187],a[168:171],a[144:147],v[184:187]
s_nop 0
T a[88:89],v4,49152
T a[90:91],v4,50176
M v[184:187],a[172:175],a[148:151],v[184:187]
s_waitcnt lgkmcnt(4)
buffer_load_dwordx4 v10, s[16:19], s21 offen offset:2048  nt lds
M v[188:191],a[172:175],a[156:159],v[188:191]
M v[188:191],a[168:171],a[152:155],v[188:191]
M v[192:195],a[160:163],a[96:99],v[192:195]
R a[168:171],v5,22528
R a[172:175],v6,22528
M v[192:195],a[164:167],a[100:103],v[192:195]
M v[196:199],a[164:167],a[108:111],v[196:199]
M v[196:199],a[160:163],a[104:107],v[196:199]
s_nop 0
T a[92:93],v4,57344
T a[94:95],v4,58368
M v[200:203],a[160:163],a[112:115],v[200:203]
buffer_load_dwordx4 v11, s[16:19], s21 offen offset:3072  nt lds
M v[200:203],a[164:167],a[116:119],v[200:203]
SA s21,s21,128
M v[204:207],a[164:167],a[124:127],v[204:207]
M v[204:207],a[160:163],a[120:123],v[204:207]
M v[208:211],a[160:163],a[128:131],v[208:211]
M v[208:211],a[164:167],a[132:135],v[208:211]
M v[212:215],a[164:167],a[140:143],v[212:215]
M v[212:215],a[160:163],a[136:139],v[212:215]
M v[216:219],a[160:163],a[144:147],v[216:219]
M v[216:219],a[164:167],a[148:151],v[216:219]
s_waitcnt lgkmcnt(2)
M v[220:223],a[164:167],a[156:159],v[220:223]
s_waitcnt vmcnt(17) lgkmcnt(0)
M v[220:223],a[160:163],a[152:155],v[220:223]
s_barrier
M v[224:227],a[168:171],a[96:99],v[224:227]
R a[160:163],v5,32768
R a[164:167],v6,32768
M v[224:227],a[172:175],a[100:103],v[224:227]
v_cmp_ne_u32 vcc, 1, v17
M v[228:231],a[172:175],a[108:111],v[228:231]
s_nop 0
M v[228:231],a[168:171],a[104:107],v[228:231]
s_cbranch_vccnz L_zs1
L_zr1:
M v[232:235],a[168:171],a[112:115],v[232:235]
M v[232:235],a[172:175],a[116:119],v[232:235]
s_lshl_b32 s72, s30, 6
M v[236:239],a[172:175],a[124:127],v[236:239]
SA s72,s72,104914944
M v[236:239],a[168:171],a[120:123],v[236:239]
buffer_store_dword v19, v18, s[8:11], s72 offen sc1
M v[240:243],a[168:171],a[128:131],v[240:243]
M v[240:243],a[172:175],a[132:135],v[240:243]
M v[244:247],a[172:175],a[140:143],v[244:247]
M v[244:247],a[168:171],a[136:139],v[244:247]
M v[248:251],a[168:171],a[144:147],v[248:251]
M v[248:251],a[172:175],a[148:151],v[248:251]
s_waitcnt lgkmcnt(0)
M v[252:255],a[172:175],a[156:159],v[252:255]
M v[252:255],a[168:171],a[152:155],v[252:255]
M a[0:3],a[160:163],a[32:35],a[0:3]
R a[168:171],v5,34816
R a[172:175],v6,34816
M a[0:3],a[164:167],a[36:39],a[0:3]
T a[96:97],v1,0
T a[98:99],v1,1024
M a[4:7],a[164:167],a[44:47],a[4:7]
SA m0,s24,16384
M a[4:7],a[160:163],a[40:43],a[4:7]
buffer_load_dwordx4 v12, s[48:51], s22 offen offset:0   lds
M a[8:11],a[160:163],a[48:51],a[8:11]
M a[8:11],a[164:167],a[52:55],a[8:11]
s_mul_i32 s64, s41, 229376
M a[12:15],a[164:167],a[60:63],a[12:15]
SA s72,s90,s64
T a[100:101],v1,8192
T a[102:103],v1,9216
M a[12:15],a[160:163],a[56:59],a[12:15]
s_addc_u32 s73, s91, 0
M a[16:19],a[160:163],a[64:67],a[16:19]
s_sub_u32 s75, 3670016, s64
buffer_load_dwordx4 v13, s[48:51], s22 offen offset:1024   lds
M a[16:19],a[164:167],a[68:71],a[16:19]
s_mov_b32 s12, s72
M a[20:23],a[164:167],a[76:79],a[20:23]
s_and_b32 s13, s73, 0xffff
M a[20:23],a[160:163],a[72:75],a[20:23]
s_mov_b32 s14, s75
T a[104:105],v2,0
T a[106:107],v2,1024
M a[24:27],a[160:163],a[80:83],a[24:27]
s_mov_b32 s15, 0x20000
M a[24:27],a[164:167],a[84:87],a[24:27]
s_waitcnt lgkmcnt(6)
buffer_load_dwordx4 v14, s[48:51], s22 offen offset:2048   lds
M a[28:31],a[164:167],a[92:95],a[28:31]
M a[28:31],a[160:163],a[88:91],a[28:31]
M v[32:35],a[168:171],a[32:35],v[32:35]
R a[160:163],v5,36864
R a[164:167],v6,36864
M v[32:35],a[172:175],a[36:39],v[32:35]
T a[108:109],v2,8192
T a[110:111],v2,9216
M v[36:39],a[172:175],a[44:47],v[36:39]
buffer_load_dwordx4 v15, s[48:51], s22 offen offset:3072   lds
M v[36:39],a[168:171],a[40:43],v[36:39]
s_sub_u32 s22, s22, 1048448
M v[40:43],a[168:171],a[48:51],v[40:43]
M v[40:43],a[172:175],a[52:55],v[40:43]
s_nop 0
T a[112:113],v3,0
T a[114:115],v3,1024
M v[44:47],a[172:175],a[60:63],v[44:47]
SA m0,s23,49152
M v[44:47],a[168:171],a[56:59],v[44:47]
buffer_load_dwordx4 v8, s[16:19], s21 offen offset:0  nt lds
M v[48:51],a[168:171],a[64:67],v[48:51]
M v[48:51],a[172:175],a[68:71],v[48:51]
M v[52:55],a[172:175],a[76:79],v[52:55]
s_nop 0
T a[116:117],v3,8192
T a[118:119],v3,9216
M v[52:55],a[168:171],a[72:75],v[52:55]
M v[56:59],a[168:171],a[80:83],v[56:59]
buffer_load_dwordx4 v9, s[16:19], s21 offen offset:1024  nt lds
M v[56:59],a[172:175],a[84:87],v[56:59]
s_waitcnt lgkmcnt(6)
M v[60:63],a[172:175],a[92:95],v[60:63]
M v[60:63],a[168:171],a[88:91],v[60:63]
s_nop 0
T a[120:121],v4,0
T a[122:123],v4,1024
M v[64:67],a[160:163],a[32:35],v[64:67]
R a[168:171],v5,38912
R a[172:175],v6,38912
M v[64:67],a[164:167],a[36:39],v[64:67]
buffer_load_dwordx4 v10, s[16:19], s21 offen offset:2048  nt lds
M v[68:71],a[164:167],a[44:47],v[68:71]
M v[68:71],a[160:163],a[40:43],v[68:71]
M v[72:75],a[160:163],a[48:51],v[72:75]
s_nop 0
T a[124:125],v4,8192
T a[126:127],v4,9216
M v[72:75],a[164:167],a[52:55],v[72:75]
M v[76:79],a[164:167],a[60:63],v[76:79]
buffer_load_dwordx4 v11, s[16:19], s21 offen offset:3072  nt lds
M v[76:79],a[160:163],a[56:59],v[76:79]
SA s21,s21,524160
M v[80:83],a[160:163],a[64:67],v[80:83]
M v[80:83],a[164:167],a[68:71],v[80:83]
M v[84:87],a[164:167],a[76:79],v[84:87]
M v[84:87],a[160:163],a[72:75],v[84:87]
M v[88:91],a[160:163],a[80:83],v[88:91]
M v[88:91],a[164:167],a[84:87],v[88:91]
s_waitcnt lgkmcnt(2)
M v[92:95],a[164:167],a[92:95],v[92:95]
s_waitcnt vmcnt(18) lgkmcnt(0)
M v[92:95],a[160:163],a[88:91],v[92:95]
s_barrier
M v[96:99],a[168:171],a[32:35],v[96:99]
R a[160:163],v5,49152
R a[164:167],v6,49152
M v[96:99],a[172:175],a[36:39],v[96:99]
M v[100:103],a[172:175],a[44:47],v[100:103]
SA m0,s24,32768
T a[128:129],v1,16384
T a[130:131],v1,17408
M v[100:103],a[168:171],a[40:43],v[100:103]
buffer_load_dwordx4 v12, s[48:51], s22 offen offset:0   lds
M v[104:107],a[168:171],a[48:51],v[104:107]
M v[104:107],a[172:175],a[52:55],v[104:107]
M v[108:111],a[172:175],a[60:63],v[108:111]
M v[108:111],a[168:171],a[56:59],v[108:111]
M v[112:115],a[168:171],a[64:67],v[112:115]
M v[112:115],a[172:175],a[68:71],v[112:115]
s_nop 0
T a[132:133],v1,24576
T a[134:135],v1,25600
M v[116:119],a[172:175],a[76:79],v[116:119]
buffer_load_dwordx4 v13, s[48:51], s22 offen offset:1024   lds
M v[116:119],a[168:171],a[72:75],v[116:119]
M v[120:123],a[168:171],a[80:83],v[120:123]
M v[120:123],a[172:175],a[84:87],v[120:123]
s_waitcnt lgkmcnt(4)
M v[124:127],a[172:175],a[92:95],v[124:127]
M v[124:127],a[168:171],a[88:91],v[124:127]
M v[128:131],a[160:163],a[32:35],v[128:131]
R a[168:171],v5,51200
R a[172:175],v6,51200
M v[128:131],a[164:167],a[36:39],v[128:131]
T a[136:137],v2,16384
T a[138:139],v2,17408
M v[132:135],a[164:167],a[44:47],v[132:135]
buffer_load_dwordx4 v14, s[48:51], s22 offen offset:2048   lds
M v[132:135],a[160:163],a[40:43],v[132:135]
M v[136:139],a[160:163],a[48:51],v[136:139]
M v[136:139],a[164:167],a[52:55],v[136:139]
M v[140:143],a[164:167],a[60:63],v[140:143]
M v[140:143],a[160:163],a[56:59],v[140:143]
s_nop 0
T a[140:141],v2,24576
T a[142:143],v2,25600
M v[144:147],a[160:163],a[64:67],v[144:147]
buffer_load_dwordx4 v15, s[48:51], s22 offen offset:3072   lds
M v[144:147],a[164:167],a[68:71],v[144:147]
SA s22,s22,1048576
M v[148:151],a[164:167],a[76:79],v[148:151]
M v[148:151],a[160:163],a[72:75],v[148:151]
M v[152:155],a[160:163],a[80:83],v[152:155]
M v[152:155],a[164:167],a[84:87],v[152:155]
s_waitcnt lgkmcnt(4)
M v[156:159],a[164:167],a[92:95],v[156:159]
SA m0,s23,0
T a[144:145],v3,16384
T a[146:147],v3,17408
M v[156:159],a[160:163],a[88:91],v[156:159]
buffer_load_dwordx4 v8, s[16:19], s21 offen offset:0  nt lds
M v[160:163],a[168:171],a[32:35],v[160:163]
R a[160:163],v5,53248
R a[164:167],v6,53248
M v[160:163],a[172:175],a[36:39],v[160:163]
buffer_load_dword a240, v26, s[60:63], s27 offen offset:0
M v[164:167],a[172:175],a[44:47],v[164:167]
SA s27,s27,2048
M v[164:167],a[168:171],a[40:43],v[164:167]
M v[168:171],a[168:171],a[48:51],v[168:171]
M v[168:171],a[172:175],a[52:55],v[168:171]
s_nop 0
T a[148:149],v3,24576
T a[150:151],v3,25600
M v[172:175],a[172:175],a[60:63],v[172:175]
buffer_load_dwordx4 v9, s[16:19], s21 offen offset:1024  nt lds
M v[172:175],a[168:171],a[56:59],v[172:175]
M v[176:179],a[168:171],a[64:67],v[176:179]
M v[176:179],a[172:175],a[68:71],v[176:179]
M v[180:183],a[172:175],a[76:79],v[180:183]
M v[180:183],a[168:171],a[72:75],v[180:183]
M v[184:187],a[168:171],a[80:83],v[184:187]
s_nop 0
T a[152:153],v4,16384
T a[154:155],v4,17408
M v[184:187],a[172:175],a[84:87],v[184:187]
s_waitcnt lgkmcnt(4)
buffer_load_dwordx4 v10, s[16:19], s21 offen offset:2048  nt lds
M v[188:191],a[172:175],a[92:95],v[188:191]
M v[188:191],a[168:171],a[88:91],v[188:191]
M v[192:195],a[160:163],a[32:35],v[192:195]
R a[168:171],v5,55296
R a[172:175],v6,55296
M v[192:195],a[164:167],a[36:39],v[192:195]
M v[196:199],a[164:167],a[44:47],v[196:199]
M v[196:199],a[160:163],a[40:43],v[196:199]
s_nop 0
T a[156:157],v4,24576
T a[158:159],v4,25600
M v[200:203],a[160:163],a[48:51],v[200:203]
buffer_load_dwordx4 v11, s[16:19], s21 offen offset:3072  nt lds
M v[200:203],a[164:167],a[52:55],v[200:203]
SA s21,s21,128
M v[204:207],a[164:167],a[60:63],v[204:207]
M v[204:207],a[160:163],a[56:59],v[204:207]
M v[208:211],a[160:163],a[64:67],v[208:211]
M v[208:211],a[164:167],a[68:71],v[208:211]
M v[212:215],a[164:167],a[76:79],v[212:215]
M v[212:215],a[160:163],a[72:75],v[212:215]
M v[216:219],a[160:163],a[80:83],v[216:219]
M v[216:219],a[164:167],a[84:87],v[216:219]
s_waitcnt lgkmcnt(2)
M v[220:223],a[164:167],a[92:95],v[220:223]
s_waitcnt vmcnt(18) lgkmcnt(0)
M v[220:223],a[160:163],a[88:91],v[220:223]
s_barrier
M v[224:227],a[168:171],a[32:35],v[224:227]
R a[160:163],v5,0
R a[164:167],v6,0
M v[224:227],a[172:175],a[36:39],v[224:227]
M v[228:231],a[172:175],a[44:47],v[228:231]
M v[228:231],a[168:171],a[40:43],v[228:231]
M v[232:235],a[168:171],a[48:51],v[232:235]
M v[232:235],a[172:175],a[52:55],v[232:235]
M v[236:239],a[172:175],a[60:63],v[236:239]
M v[236:239],a[168:171],a[56:59],v[236:239]
M v[240:243],a[168:171],a[64:67],v[240:243]
M v[240:243],a[172:175],a[68:71],v[240:243]
M v[244:247],a[172:175],a[76:79],v[244:247]
M v[244:247],a[168:171],a[72:75],v[244:247]
M v[248:251],a[168:171],a[80:83],v[248:251]
M v[248:251],a[172:175],a[84:87],v[248:251]
s_waitcnt lgkmcnt(0)
M v[252:255],a[172:175],a[92:95],v[252:255]
M v[252:255],a[168:171],a[88:91],v[252:255]
M a[0:3],a[160:163],a[96:99],a[0:3]
R a[168:171],v5,2048
R a[172:175],v6,2048
M a[0:3],a[164:167],a[100:103],a[0:3]
T a[32:33],v1,32768
T a[34:35],v1,33792
M a[4:7],a[164:167],a[108:111],a[4:7]
SA m0,s24,49152
M a[4:7],a[160:163],a[104:107],a[4:7]
buffer_load_dwordx4 v12, s[48:51], s22 offen offset:0   lds
M a[8:11],a[160:163],a[112:115],a[8:11]
M a[8:11],a[164:167],a[116:119],a[8:11]
M a[12:15],a[164:167],a[124:127],a[12:15]
s_nop 0
T a[36:37],v1,40960
T a[38:39],v1,41984
M a[12:15],a[160:163],a[120:123],a[12:15]
M a[16:19],a[160:163],a[128:131],a[16:19]
buffer_load_dwordx4 v13, s[48:51], s22 offen offset:1024   lds
M a[16:19],a[164:167],a[132:135],a[16:19]
M a[20:23],a[164:167],a[140:143],a[20:23]
M a[20:23],a[160:163],a[136:139],a[20:23]
s_nop 0
T a[40:41],v2,32768
T a[42:43],v2,33792
M a[24:27],a[160:163],a[144:147],a[24:27]
M a[24:27],a[164:167],a[148:151],a[24:27]
s_waitcnt lgkmcnt(6)
buffer_load_dwordx4 v14, s[48:51], s22 offen offset:2048   lds
M a[28:31],a[164:167],a[156:159],a[28:31]
M a[28:31],a[160:163],a[152:155],a[28:31]
M v[32:35],a[168:171],a[96:99],v[32:35]
R a[160:163],v5,4096
R a[164:167],v6,4096
M v[32:35],a[172:175],a[100:103],v[32:35]
T a[44:45],v2,40960
T a[46:47],v2,41984
L_w_kv13:
s_cbranch_execz L_w_kv17
M v[36:39],a[172:175],a[108:111],v[36:39]
buffer_load_dwordx4 v15, s[48:51], s22 offen offset:3072   lds
M v[36:39],a[168:171],a[104:107],v[36:39]
s_sub_u32 s22, s22, 1048448
M v[40:43],a[168:171],a[112:115],v[40:43]
M v[40:43],a[172:175],a[116:119],v[40:43]
s_nop 0
T a[48:49],v3,32768
T a[50:51],v3,33792
M v[44:47],a[172:175],a[124:127],v[44:47]
SA m0,s23,16384
M v[44:47],a[168:171],a[120:123],v[44:47]
buffer_load_dwordx4 v8, s[16:19], s21 offen offset:0  nt lds
M v[48:51],a[168:171],a[128:131],v[48:51]
M v[48:51],a[172:175],a[132:135],v[48:51]
M v[52:55],a[172:175],a[140:143],v[52:55]
s_nop 0
T a[52:53],v3,40960
T a[54:55],v3,41984
M v[52:55],a[168:171],a[136:139],v[52:55]
M v[56:59],a[168:171],a[144:147],v[56:59]
buffer_load_dwordx4 v9, s[16:19], s21 offen offset:1024  nt lds
M v[56:59],a[172:175],a[148:151],v[56:59]
s_waitcnt lgkmcnt(6)
M v[60:63],a[172:175],a[156:159],v[60:63]
M v[60:63],a[168:171],a[152:155],v[60:63]
s_nop 0
T a[56:57],v4,32768
T a[58:59],v4,33792
M v[64:67],a[160:163],a[96:99],v[64:67]
R a[168:171],v5,6144
R a[172:175],v6,6144
M v[64:67],a[164:167],a[100:103],v[64:67]
buffer_load_dwordx4 v10, s[16:19], s21 offen offset:2048  nt lds
M v[68:71],a[164:167],a[108:111],v[68:71]
M v[68:71],a[160:163],a[104:107],v[68:71]
M v[72:75],a[160:163],a[112:115],v[72:75]
s_nop 0
T a[60:61],v4,40960
T a[62:63],v4,41984
M v[72:75],a[164:167],a[116:119],v[72:75]
M v[76:79],a[164:167],a[124:127],v[76:79]
buffer_load_dwordx4 v11, s[16:19], s21 offen offset:3072  nt lds
M v[76:79],a[160:163],a[120:123],v[76:79]
SA s21,s21,524160
M v[80:83],a[160:163],a[128:131],v[80:83]
M v[80:83],a[164:167],a[132:135],v[80:83]
M v[84:87],a[164:167],a[140:143],v[84:87]
M v[84:87],a[160:163],a[136:139],v[84:87]
M v[88:91],a[160:163],a[144:147],v[88:91]
M v[88:91],a[164:167],a[148:151],v[88:91]
s_waitcnt lgkmcnt(2)
M v[92:95],a[164:167],a[156:159],v[92:95]
s_waitcnt vmcnt(17) lgkmcnt(0)
M v[92:95],a[160:163],a[152:155],v[92:95]
s_barrier
M v[96:99],a[168:171],a[96:99],v[96:99]
R a[160:163],v5,16384
R a[164:167],v6,16384
M v[96:99],a[172:175],a[100:103],v[96:99]
M v[100:103],a[172:175],a[108:111],v[100:103]
SA m0,s24,0
T a[64:65],v1,49152
T a[66:67],v1,50176
M v[100:103],a[168:171],a[104:107],v[100:103]
buffer_load_dwordx4 v12, s[48:51], s22 offen offset:0   lds
M v[104:107],a[168:171],a[112:115],v[104:107]
M v[104:107],a[172:175],a[116:119],v[104:107]
M v[108:111],a[172:175],a[124:127],v[108:111]
M v[108:111],a[168:171],a[120:123],v[108:111]
M v[112:115],a[168:171],a[128:131],v[112:115]
M v[112:115],a[172:175],a[132:135],v[112:115]
s_nop 0
T a[68:69],v1,57344
T a[70:71],v1,58368
M v[116:119],a[172:175],a[140:143],v[116:119]
buffer_load_dwordx4 v13, s[48:51], s22 offen offset:1024   lds
M v[116:119],a[168:171],a[136:139],v[116:119]
M v[120:123],a[168:171],a[144:147],v[120:123]
M v[120:123],a[172:175],a[148:151],v[120:123]
s_waitcnt lgkmcnt(4)
M v[124:127],a[172:175],a[156:159],v[124:127]
M v[124:127],a[168:171],a[152:155],v[124:127]
M v[128:131],a[160:163],a[96:99],v[128:131]
R a[168:171],v5,18432
R a[172:175],v6,18432
M v[128:131],a[164:167],a[100:103],v[128:131]
T a[72:73],v2,49152
T a[74:75],v2,50176
M v[132:135],a[164:167],a[108:111],v[132:135]
buffer_load_dwordx4 v14, s[48:51], s22 offen offset:2048   lds
M v[132:135],a[160:163],a[104:107],v[132:135]
M v[136:139],a[160:163],a[112:115],v[136:139]
M v[136:139],a[164:167],a[116:119],v[136:139]
M v[140:143],a[164:167],a[124:127],v[140:143]
M v[140:143],a[160:163],a[120:123],v[140:143]
s_nop 0
T a[76:77],v2,57344
T a[78:79],v2,58368
M v[144:147],a[160:163],a[128:131],v[144:147]
buffer_load_dwordx4 v15, s[48:51], s22 offen offset:3072   lds
M v[144:147],a[164:167],a[132:135],v[144:147]
SA s22,s22,1048576
M v[148:151],a[164:167],a[140:143],v[148:151]
M v[148:151],a[160:163],a[136:139],v[148:151]
M v[152:155],a[160:163],a[144:147],v[152:155]
M v[152:155],a[164:167],a[148:151],v[152:155]
s_waitcnt lgkmcnt(4)
M v[156:159],a[164:167],a[156:159],v[156:159]
SA m0,s23,32768
T a[80:81],v3,49152
T a[82:83],v3,50176
M v[156:159],a[160:163],a[152:155],v[156:159]
buffer_load_dwordx4 v8, s[16:19], s21 offen offset:0  nt lds
M v[160:163],a[168:171],a[96:99],v[160:163]
R a[160:163],v5,20480
R a[164:167],v6,20480
M v[160:163],a[172:175],a[100:103],v[160:163]
buffer_load_dword a240, v26, s[60:63], s27 offen offset:0
M v[164:167],a[172:175],a[108:111],v[164:167]
SA s27,s27,2048
M v[164:167],a[168:171],a[104:107],v[164:167]
M v[168:171],a[168:171],a[112:115],v[168:171]
M v[168:171],a[172:175],a[116:119],v[168:171]
s_nop 0
T a[84:85],v3,57344
T a[86:87],v3,58368
M v[172:175],a[172:175],a[124:127],v[172:175]
buffer_load_dwordx4 v9, s[16:19], s21 offen offset:1024  nt lds
M v[172:175],a[168:171],a[120:123],v[172:175]
M v[176:179],a[168:171],a[128:131],v[176:179]
M v[176:179],a[172:175],a[132:135],v[176:179]
M v[180:183],a[172:175],a[140:143],v[180:183]
M v[180:183],a[168:171],a[136:139],v[180:183]
M v[184:187],a[168:171],a[144:147],v[184:187]
s_nop 0
T a[88:89],v4,49152
T a[90:91],v4,50176
M v[184:187],a[172:175],a[148:151],v[184:187]
s_waitcnt lgkmcnt(4)
buffer_load_dwordx4 v10, s[16:19], s21 offen offset:2048  nt lds
M v[188:191],a[172:175],a[156:159],v[188:191]
M v[188:191],a[168:171],a[152:155],v[188:191]
M v[192:195],a[160:163],a[96:99],v[192:195]
R a[168:171],v5,22528
R a[172:175],v6,22528
M v[192:195],a[164:167],a[100:103],v[192:195]
M v[196:199],a[164:167],a[108:111],v[196:199]
M v[196:199],a[160:163],a[104:107],v[196:199]
s_nop 0
T a[92:93],v4,57344
T a[94:95],v4,58368
M v[200:203],a[160:163],a[112:115],v[200:203]
buffer_load_dwordx4 v11, s[16:19], s21 offen offset:3072  nt lds
M v[200:203],a[164:167],a[116:119],v[200:203]
SA s21,s21,128
M v[204:207],a[164:167],a[124:127],v[204:207]
M v[204:207],a[160:163],a[120:123],v[204:207]
M v[208:211],a[160:163],a[128:131],v[208:211]
M v[208:211],a[164:167],a[132:135],v[208:211]
M v[212:215],a[164:167],a[140:143],v[212:215]
M v[212:215],a[160:163],a[136:139],v[212:215]
M v[216:219],a[160:163],a[144:147],v[216:219]
M v[216:219],a[164:167],a[148:151],v[216:219]
s_waitcnt lgkmcnt(2)
M v[220:223],a[164:167],a[156:159],v[220:223]
s_waitcnt vmcnt(17) lgkmcnt(0)
M v[220:223],a[160:163],a[152:155],v[220:223]
s_barrier
M v[224:227],a[168:171],a[96:99],v[224:227]
R a[160:163],v5,32768
R a[164:167],v6,32768
M v[224:227],a[172:175],a[100:103],v[224:227]
M v[228:231],a[172:175],a[108:111],v[228:231]
M v[228:231],a[168:171],a[104:107],v[228:231]
M v[232:235],a[168:171],a[112:115],v[232:235]
M v[232:235],a[172:175],a[116:119],v[232:235]
M v[236:239],a[172:175],a[124:127],v[236:239]
M v[236:239],a[168:171],a[120:123],v[236:239]
M v[240:243],a[168:171],a[128:131],v[240:243]
M v[240:243],a[172:175],a[132:135],v[240:243]
M v[244:247],a[172:175],a[140:143],v[244:247]
M v[244:247],a[168:171],a[136:139],v[244:247]
M v[248:251],a[168:171],a[144:147],v[248:251]
M v[248:251],a[172:175],a[148:151],v[248:251]
s_waitcnt lgkmcnt(0)
M v[252:255],a[172:175],a[156:159],v[252:255]
M v[252:255],a[168:171],a[152:155],v[252:255]
M a[0:3],a[160:163],a[32:35],a[0:3]
R a[168:171],v5,34816
R a[172:175],v6,34816
M a[0:3],a[164:167],a[36:39],a[0:3]
T a[96:97],v1,0
T a[98:99],v1,1024
M a[4:7],a[164:167],a[44:47],a[4:7]
SA m0,s24,16384
M a[4:7],a[160:163],a[40:43],a[4:7]
buffer_load_dwordx4 v12, s[48:51], s22 offen offset:0   lds
M a[8:11],a[160:163],a[48:51],a[8:11]
M a[8:11],a[164:167],a[52:55],a[8:11]
M a[12:15],a[164:167],a[60:63],a[12:15]
s_nop 0
T a[100:101],v1,8192
T a[102:103],v1,9216
M a[12:15],a[160:163],a[56:59],a[12:15]
M a[16:19],a[160:163],a[64:67],a[16:19]
buffer_load_dwordx4 v13, s[48:51], s22 offen offset:1024   lds
M a[16:19],a[164:167],a[68:71],a[16:19]
M a[20:23],a[164:167],a[76:79],a[20:23]
M a[20:23],a[160:163],a[72:75],a[20:23]
s_nop 0
T a[104:105],v2,0
T a[106:107],v2,1024
M a[24:27],a[160:163],a[80:83],a[24:27]
M a[24:27],a[164:167],a[84:87],a[24:27]
s_waitcnt lgkmcnt(6)
buffer_load_dwordx4 v14, s[48:51], s22 offen offset:2048   lds
M a[28:31],a[164:167],a[92:95],a[28:31]
M a[28:31],a[160:163],a[88:91],a[28:31]
M v[32:35],a[168:171],a[32:35],v[32:35]
R a[160:163],v5,36864
R a[164:167],v6,36864
M v[32:35],a[172:175],a[36:39],v[32:35]
T a[108:109],v2,8192
T a[110:111],v2,9216
M v[36:39],a[172:175],a[44:47],v[36:39]
buffer_load_dwordx4 v15, s[48:51], s22 offen offset:3072   lds
M v[36:39],a[168:171],a[40:43],v[36:39]
s_sub_u32 s22, s22, 1048448
M v[40:43],a[168:171],a[48:51],v[40:43]
M v[40:43],a[172:175],a[52:55],v[40:43]
s_nop 0
T a[112:113],v3,0
T a[114:115],v3,1024
M v[44:47],a[172:175],a[60:63],v[44:47]
SA m0,s23,49152
M v[44:47],a[168:171],a[56:59],v[44:47]
buffer_load_dwordx4 v8, s[16:19], s21 offen offset:0  nt lds
M v[48:51],a[168:171],a[64:67],v[48:51]
M v[48:51],a[172:175],a[68:71],v[48:51]
M v[52:55],a[172:175],a[76:79],v[52:55]
s_nop 0
T a[116:117],v3,8192
T a[118:119],v3,9216
M v[52:55],a[168:171],a[72:75],v[52:55]
M v[56:59],a[168:171],a[80:83],v[56:59]
buffer_load_dwordx4 v9, s[16:19], s21 offen offset:1024  nt lds
M v[56:59],a[172:175],a[84:87],v[56:59]
s_waitcnt lgkmcnt(6)
M v[60:63],a[172:175],a[92:95],v[60:63]
M v[60:63],a[168:171],a[88:91],v[60:63]
s_nop 0
T a[120:121],v4,0
T a[122:123],v4,1024
M v[64:67],a[160:163],a[32:35],v[64:67]
R a[168:171],v5,38912
R a[172:175],v6,38912
M v[64:67],a[164:167],a[36:39],v[64:67]
buffer_load_dwordx4 v10, s[16:19], s21 offen offset:2048  nt lds
M v[68:71],a[164:167],a[44:47],v[68:71]
M v[68:71],a[160:163],a[40:43],v[68:71]
M v[72:75],a[160:163],a[48:51],v[72:75]
s_nop 0
T a[124:125],v4,8192
T a[126:127],v4,9216
M v[72:75],a[164:167],a[52:55],v[72:75]
M v[76:79],a[164:167],a[60:63],v[76:79]
buffer_load_dwordx4 v11, s[16:19], s21 offen offset:3072  nt lds
M v[76:79],a[160:163],a[56:59],v[76:79]
SA s21,s21,524160
M v[80:83],a[160:163],a[64:67],v[80:83]
M v[80:83],a[164:167],a[68:71],v[80:83]
M v[84:87],a[164:167],a[76:79],v[84:87]
M v[84:87],a[160:163],a[72:75],v[84:87]
M v[88:91],a[160:163],a[80:83],v[88:91]
M v[88:91],a[164:167],a[84:87],v[88:91]
s_waitcnt lgkmcnt(2)
M v[92:95],a[164:167],a[92:95],v[92:95]
s_waitcnt vmcnt(17) lgkmcnt(0)
M v[92:95],a[160:163],a[88:91],v[92:95]
s_barrier
M v[96:99],a[168:171],a[32:35],v[96:99]
R a[160:163],v5,49152
R a[164:167],v6,49152
M v[96:99],a[172:175],a[36:39],v[96:99]
M v[100:103],a[172:175],a[44:47],v[100:103]
SA m0,s24,32768
T a[128:129],v1,16384
T a[130:131],v1,17408
M v[100:103],a[168:171],a[40:43],v[100:103]
buffer_load_dwordx4 v12, s[48:51], s22 offen offset:0   lds
M v[104:107],a[168:171],a[48:51],v[104:107]
M v[104:107],a[172:175],a[52:55],v[104:107]
M v[108:111],a[172:175],a[60:63],v[108:111]
M v[108:111],a[168:171],a[56:59],v[108:111]
M v[112:115],a[168:171],a[64:67],v[112:115]
M v[112:115],a[172:175],a[68:71],v[112:115]
s_nop 0
T a[132:133],v1,24576
T a[134:135],v1,25600
M v[116:119],a[172:175],a[76:79],v[116:119]
buffer_load_dwordx4 v13, s[48:51], s22 offen offset:1024   lds
M v[116:119],a[168:171],a[72:75],v[116:119]
M v[120:123],a[168:171],a[80:83],v[120:123]
s_and_b32 s64, s42, 7
s_lshl_b32 s64, s64, 2
M v[120:123],a[172:175],a[84:87],v[120:123]
s_waitcnt lgkmcnt(4)
SA s64,s64,s20
M v[124:127],a[172:175],a[92:95],v[124:127]
s_mul_i32 s64, s64, 114688
v_bfe_u32 v28, v0, 2, 2
v_and_b32 v29, 3, v0
M v[124:127],a[168:171],a[88:91],v[124:127]
v_lshlrev_b32 v29, 7, v29
v_lshl_add_u32 v28, v28, 13, v29
M v[128:131],a[160:163],a[32:35],v[128:131]
R a[168:171],v5,51200
R a[172:175],v6,51200
M v[128:131],a[164:167],a[36:39],v[128:131]
T a[136:137],v2,16384
T a[138:139],v2,17408
M v[132:135],a[164:167],a[44:47],v[132:135]
buffer_load_dwordx4 v14, s[48:51], s22 offen offset:2048   lds
M v[132:135],a[160:163],a[40:43],v[132:135]
v_add_u32 v23, s64, v28
v_and_b32 v28, 48, v0
M v[136:139],a[160:163],a[48:51],v[136:139]
v_lshl_add_u32 v23, v28, 24, v23
M v[136:139],a[164:167],a[52:55],v[136:139]
M v[140:143],a[164:167],a[60:63],v[140:143]
M v[140:143],a[160:163],a[56:59],v[140:143]
s_nop 0
T a[140:141],v2,24576
T a[142:143],v2,25600
M v[144:147],a[160:163],a[64:67],v[144:147]
buffer_load_dwordx4 v15, s[48:51], s22 offen offset:3072   lds
M v[144:147],a[164:167],a[68:71],v[144:147]
SA s22,s22,1048576
M v[148:151],a[164:167],a[76:79],v[148:151]
M v[148:151],a[160:163],a[72:75],v[148:151]
M v[152:155],a[160:163],a[80:83],v[152:155]
M v[152:155],a[164:167],a[84:87],v[152:155]
s_waitcnt lgkmcnt(4)
M v[156:159],a[164:167],a[92:95],v[156:159]
SA m0,s23,0
T a[144:145],v3,16384
T a[146:147],v3,17408
M v[156:159],a[160:163],a[88:91],v[156:159]
buffer_load_dwordx4 v8, s[16:19], s21 offen offset:0  nt lds
M v[160:163],a[168:171],a[32:35],v[160:163]
R a[160:163],v5,53248
R a[164:167],v6,53248
M v[160:163],a[172:175],a[36:39],v[160:163]
M v[164:167],a[172:175],a[44:47],v[164:167]
M v[164:167],a[168:171],a[40:43],v[164:167]
M v[168:171],a[168:171],a[48:51],v[168:171]
M v[168:171],a[172:175],a[52:55],v[168:171]
s_nop 0
T a[148:149],v3,24576
T a[150:151],v3,25600
M v[172:175],a[172:175],a[60:63],v[172:175]
buffer_load_dwordx4 v9, s[16:19], s21 offen offset:1024  nt lds
M v[172:175],a[168:171],a[56:59],v[172:175]
M v[176:179],a[168:171],a[64:67],v[176:179]
M v[176:179],a[172:175],a[68:71],v[176:179]
M v[180:183],a[172:175],a[76:79],v[180:183]
M v[180:183],a[168:171],a[72:75],v[180:183]
M v[184:187],a[168:171],a[80:83],v[184:187]
s_nop 0
T a[152:153],v4,16384
T a[154:155],v4,17408
M v[184:187],a[172:175],a[84:87],v[184:187]
s_waitcnt lgkmcnt(4)
buffer_load_dwordx4 v10, s[16:19], s21 offen offset:2048  nt lds
M v[188:191],a[172:175],a[92:95],v[188:191]
M v[188:191],a[168:171],a[88:91],v[188:191]
M v[192:195],a[160:163],a[32:35],v[192:195]
R a[168:171],v5,55296
R a[172:175],v6,55296
M v[192:195],a[164:167],a[36:39],v[192:195]
M v[196:199],a[164:167],a[44:47],v[196:199]
M v[196:199],a[160:163],a[40:43],v[196:199]
s_nop 0
T a[156:157],v4,24576
T a[158:159],v4,25600
M v[200:203],a[160:163],a[48:51],v[200:203]
buffer_load_dwordx4 v11, s[16:19], s21 offen offset:3072  nt lds
M v[200:203],a[164:167],a[52:55],v[200:203]
SA s21,s21,128
M v[204:207],a[164:167],a[60:63],v[204:207]
M v[204:207],a[160:163],a[56:59],v[204:207]
M v[208:211],a[160:163],a[64:67],v[208:211]
M v[208:211],a[164:167],a[68:71],v[208:211]
M v[212:215],a[164:167],a[76:79],v[212:215]
M v[212:215],a[160:163],a[72:75],v[212:215]
M v[216:219],a[160:163],a[80:83],v[216:219]
M v[216:219],a[164:167],a[84:87],v[216:219]
s_waitcnt lgkmcnt(2)
M v[220:223],a[164:167],a[92:95],v[220:223]
s_waitcnt vmcnt(16) lgkmcnt(0)
M v[220:223],a[160:163],a[88:91],v[220:223]
s_barrier
M v[224:227],a[168:171],a[32:35],v[224:227]
R a[160:163],v5,0
R a[164:167],v6,0
M v[224:227],a[172:175],a[36:39],v[224:227]
buffer_load_dword a240, v23, s[52:55], 0 offen offset:0
M v[228:231],a[172:175],a[44:47],v[228:231]
v_add_u32 v23, 32768, v23
M v[228:231],a[168:171],a[40:43],v[228:231]
M v[232:235],a[168:171],a[48:51],v[232:235]
M v[232:235],a[172:175],a[52:55],v[232:235]
M v[236:239],a[172:175],a[60:63],v[236:239]
M v[236:239],a[168:171],a[56:59],v[236:239]
M v[240:243],a[168:171],a[64:67],v[240:243]
M v[240:243],a[172:175],a[68:71],v[240:243]
M v[244:247],a[172:175],a[76:79],v[244:247]
M v[244:247],a[168:171],a[72:75],v[244:247]
M v[248:251],a[168:171],a[80:83],v[248:251]
M v[248:251],a[172:175],a[84:87],v[248:251]
s_waitcnt lgkmcnt(0)
M v[252:255],a[172:175],a[92:95],v[252:255]
M v[252:255],a[168:171],a[88:91],v[252:255]
M a[0:3],a[160:163],a[96:99],a[0:3]
R a[168:171],v5,2048
R a[172:175],v6,2048
M a[0:3],a[164:167],a[100:103],a[0:3]
T a[32:33],v1,32768
T a[34:35],v1,33792
M a[4:7],a[164:167],a[108:111],a[4:7]
SA m0,s24,49152
M a[4:7],a[160:163],a[104:107],a[4:7]
buffer_load_dwordx4 v12, s[48:51], s22 offen offset:0   lds
M a[8:11],a[160:163],a[112:115],a[8:11]
M a[8:11],a[164:167],a[116:119],a[8:11]
M a[12:15],a[164:167],a[124:127],a[12:15]
s_nop 0
T a[36:37],v1,40960
T a[38:39],v1,41984
M a[12:15],a[160:163],a[120:123],a[12:15]
M a[16:19],a[160:163],a[128:131],a[16:19]
buffer_load_dwordx4 v13, s[48:51], s22 offen offset:1024   lds
M a[16:19],a[164:167],a[132:135],a[16:19]
M a[20:23],a[164:167],a[140:143],a[20:23]
M a[20:23],a[160:163],a[136:139],a[20:23]
s_nop 0
T a[40:41],v2,32768
T a[42:43],v2,33792
M a[24:27],a[160:163],a[144:147],a[24:27]
M a[24:27],a[164:167],a[148:151],a[24:27]
s_waitcnt lgkmcnt(6)
buffer_load_dwordx4 v14, s[48:51], s22 offen offset:2048   lds
M a[28:31],a[164:167],a[156:159],a[28:31]
M a[28:31],a[160:163],a[152:155],a[28:31]
M v[32:35],a[168:171],a[96:99],v[32:35]
R a[160:163],v5,4096
R a[164:167],v6,4096
M v[32:35],a[172:175],a[100:103],v[32:35]
T a[44:45],v2,40960
T a[46:47],v2,41984
M v[36:39],a[172:175],a[108:111],v[36:39]
buffer_load_dwordx4 v15, s[48:51], s22 offen offset:3072   lds
M v[36:39],a[168:171],a[104:107],v[36:39]
s_sub_u32 s22, s22, 1048448
M v[40:43],a[168:171],a[112:115],v[40:43]
M v[40:43],a[172:175],a[116:119],v[40:43]
s_nop 0
T a[48:49],v3,32768
T a[50:51],v3,33792
M v[44:47],a[172:175],a[124:127],v[44:47]
SA m0,s23,16384
M v[44:47],a[168:171],a[120:123],v[44:47]
buffer_load_dwordx4 v8, s[16:19], s21 offen offset:0  nt lds
M v[48:51],a[168:171],a[128:131],v[48:51]
M v[48:51],a[172:175],a[132:135],v[48:51]
M v[52:55],a[172:175],a[140:143],v[52:55]
s_nop 0
T a[52:53],v3,40960
T a[54:55],v3,41984
M v[52:55],a[168:171],a[136:139],v[52:55]
M v[56:59],a[168:171],a[144:147],v[56:59]
buffer_load_dwordx4 v9, s[16:19], s21 offen offset:1024  nt lds
M v[56:59],a[172:175],a[148:151],v[56:59]
s_waitcnt lgkmcnt(6)
M v[60:63],a[172:175],a[156:159],v[60:63]
M v[60:63],a[168:171],a[152:155],v[60:63]
s_nop 0
T a[56:57],v4,32768
T a[58:59],v4,33792
M v[64:67],a[160:163],a[96:99],v[64:67]
R a[168:171],v5,6144
R a[172:175],v6,6144
M v[64:67],a[164:167],a[100:103],v[64:67]
buffer_load_dwordx4 v10, s[16:19], s21 offen offset:2048  nt lds
M v[68:71],a[164:167],a[108:111],v[68:71]
M v[68:71],a[160:163],a[104:107],v[68:71]
M v[72:75],a[160:163],a[112:115],v[72:75]
s_nop 0
T a[60:61],v4,40960
T a[62:63],v4,41984
M v[72:75],a[164:167],a[116:119],v[72:75]
M v[76:79],a[164:167],a[124:127],v[76:79]
buffer_load_dwordx4 v11, s[16:19], s21 offen offset:3072  nt lds
M v[76:79],a[160:163],a[120:123],v[76:79]
SA s21,s21,524160
M v[80:83],a[160:163],a[128:131],v[80:83]
M v[80:83],a[164:167],a[132:135],v[80:83]
M v[84:87],a[164:167],a[140:143],v[84:87]
M v[84:87],a[160:163],a[136:139],v[84:87]
M v[88:91],a[160:163],a[144:147],v[88:91]
M v[88:91],a[164:167],a[148:151],v[88:91]
s_waitcnt lgkmcnt(2)
M v[92:95],a[164:167],a[156:159],v[92:95]
s_waitcnt vmcnt(17) lgkmcnt(0)
M v[92:95],a[160:163],a[152:155],v[92:95]
s_barrier
M v[96:99],a[168:171],a[96:99],v[96:99]
R a[160:163],v5,16384
R a[164:167],v6,16384
M v[96:99],a[172:175],a[100:103],v[96:99]
M v[100:103],a[172:175],a[108:111],v[100:103]
SA m0,s24,0
T a[64:65],v1,49152
T a[66:67],v1,50176
M v[100:103],a[168:171],a[104:107],v[100:103]
buffer_load_dwordx4 v12, s[48:51], s22 offen offset:0   lds
M v[104:107],a[168:171],a[112:115],v[104:107]
M v[104:107],a[172:175],a[116:119],v[104:107]
M v[108:111],a[172:175],a[124:127],v[108:111]
M v[108:111],a[168:171],a[120:123],v[108:111]
M v[112:115],a[168:171],a[128:131],v[112:115]
M v[112:115],a[172:175],a[132:135],v[112:115]
s_nop 0
T a[68:69],v1,57344
T a[70:71],v1,58368
M v[116:119],a[172:175],a[140:143],v[116:119]
buffer_load_dwordx4 v13, s[48:51], s22 offen offset:1024   lds
M v[116:119],a[168:171],a[136:139],v[116:119]
M v[120:123],a[168:171],a[144:147],v[120:123]
M v[120:123],a[172:175],a[148:151],v[120:123]
s_waitcnt lgkmcnt(4)
M v[124:127],a[172:175],a[156:159],v[124:127]
M v[124:127],a[168:171],a[152:155],v[124:127]
L_w_kv14:
s_cbranch_execz L_w_kv18
M v[128:131],a[160:163],a[96:99],v[128:131]
R a[168:171],v5,18432
R a[172:175],v6,18432
M v[128:131],a[164:167],a[100:103],v[128:131]
T a[72:73],v2,49152
T a[74:75],v2,50176
M v[132:135],a[164:167],a[108:111],v[132:135]
buffer_load_dwordx4 v14, s[48:51], s22 offen offset:2048   lds
M v[132:135],a[160:163],a[104:107],v[132:135]
M v[136:139],a[160:163],a[112:115],v[136:139]
M v[136:139],a[164:167],a[116:119],v[136:139]
M v[140:143],a[164:167],a[124:127],v[140:143]
M v[140:143],a[160:163],a[120:123],v[140:143]
s_nop 0
T a[76:77],v2,57344
T a[78:79],v2,58368
M v[144:147],a[160:163],a[128:131],v[144:147]
buffer_load_dwordx4 v15, s[48:51], s22 offen offset:3072   lds
M v[144:147],a[164:167],a[132:135],v[144:147]
SA s22,s22,1048576
M v[148:151],a[164:167],a[140:143],v[148:151]
M v[148:151],a[160:163],a[136:139],v[148:151]
M v[152:155],a[160:163],a[144:147],v[152:155]
M v[152:155],a[164:167],a[148:151],v[152:155]
s_waitcnt lgkmcnt(4)
M v[156:159],a[164:167],a[156:159],v[156:159]
SA m0,s23,32768
T a[80:81],v3,49152
T a[82:83],v3,50176
M v[156:159],a[160:163],a[152:155],v[156:159]
buffer_load_dwordx4 v8, s[16:19], s21 offen offset:0  nt lds
M v[160:163],a[168:171],a[96:99],v[160:163]
R a[160:163],v5,20480
R a[164:167],v6,20480
M v[160:163],a[172:175],a[100:103],v[160:163]
M v[164:167],a[172:175],a[108:111],v[164:167]
M v[164:167],a[168:171],a[104:107],v[164:167]
M v[168:171],a[168:171],a[112:115],v[168:171]
M v[168:171],a[172:175],a[116:119],v[168:171]
s_nop 0
T a[84:85],v3,57344
T a[86:87],v3,58368
M v[172:175],a[172:175],a[124:127],v[172:175]
buffer_load_dwordx4 v9, s[16:19], s21 offen offset:1024  nt lds
M v[172:175],a[168:171],a[120:123],v[172:175]
M v[176:179],a[168:171],a[128:131],v[176:179]
M v[176:179],a[172:175],a[132:135],v[176:179]
M v[180:183],a[172:175],a[140:143],v[180:183]
M v[180:183],a[168:171],a[136:139],v[180:183]
M v[184:187],a[168:171],a[144:147],v[184:187]
s_nop 0
T a[88:89],v4,49152
T a[90:91],v4,50176
M v[184:187],a[172:175],a[148:151],v[184:187]
s_waitcnt lgkmcnt(4)
buffer_load_dwordx4 v10, s[16:19], s21 offen offset:2048  nt lds
M v[188:191],a[172:175],a[156:159],v[188:191]
M v[188:191],a[168:171],a[152:155],v[188:191]
M v[192:195],a[160:163],a[96:99],v[192:195]
R a[168:171],v5,22528
R a[172:175],v6,22528
M v[192:195],a[164:167],a[100:103],v[192:195]
M v[196:199],a[164:167],a[108:111],v[196:199]
M v[196:199],a[160:163],a[104:107],v[196:199]
s_nop 0
T a[92:93],v4,57344
T a[94:95],v4,58368
M v[200:203],a[160:163],a[112:115],v[200:203]
buffer_load_dwordx4 v11, s[16:19], s21 offen offset:3072  nt lds
M v[200:203],a[164:167],a[116:119],v[200:203]
SA s21,s21,128
M v[204:207],a[164:167],a[124:127],v[204:207]
M v[204:207],a[160:163],a[120:123],v[204:207]
M v[208:211],a[160:163],a[128:131],v[208:211]
M v[208:211],a[164:167],a[132:135],v[208:211]
M v[212:215],a[164:167],a[140:143],v[212:215]
M v[212:215],a[160:163],a[136:139],v[212:215]
M v[216:219],a[160:163],a[144:147],v[216:219]
M v[216:219],a[164:167],a[148:151],v[216:219]
s_waitcnt lgkmcnt(2)
M v[220:223],a[164:167],a[156:159],v[220:223]
s_waitcnt vmcnt(17) lgkmcnt(0)
M v[220:223],a[160:163],a[152:155],v[220:223]
s_barrier
M v[224:227],a[168:171],a[96:99],v[224:227]
R a[160:163],v5,32768
R a[164:167],v6,32768
M v[224:227],a[172:175],a[100:103],v[224:227]
buffer_load_dword a240, v23, s[52:55], 0 offen offset:0
M v[228:231],a[172:175],a[108:111],v[228:231]
v_add_u32 v23, 32768, v23
M v[228:231],a[168:171],a[104:107],v[228:231]
M v[232:235],a[168:171],a[112:115],v[232:235]
M v[232:235],a[172:175],a[116:119],v[232:235]
M v[236:239],a[172:175],a[124:127],v[236:239]
M v[236:239],a[168:171],a[120:123],v[236:239]
M v[240:243],a[168:171],a[128:131],v[240:243]
M v[240:243],a[172:175],a[132:135],v[240:243]
M v[244:247],a[172:175],a[140:143],v[244:247]
M v[244:247],a[168:171],a[136:139],v[244:247]
M v[248:251],a[168:171],a[144:147],v[248:251]
M v[248:251],a[172:175],a[148:151],v[248:251]
s_waitcnt lgkmcnt(0)
M v[252:255],a[172:175],a[156:159],v[252:255]
M v[252:255],a[168:171],a[152:155],v[252:255]
M a[0:3],a[160:163],a[32:35],a[0:3]
R a[168:171],v5,34816
R a[172:175],v6,34816
M a[0:3],a[164:167],a[36:39],a[0:3]
T a[96:97],v1,0
T a[98:99],v1,1024
M a[4:7],a[164:167],a[44:47],a[4:7]
SA m0,s24,16384
M a[4:7],a[160:163],a[40:43],a[4:7]
buffer_load_dwordx4 v12, s[48:51], s22 offen offset:0   lds
M a[8:11],a[160:163],a[48:51],a[8:11]
M a[8:11],a[164:167],a[52:55],a[8:11]
M a[12:15],a[164:167],a[60:63],a[12:15]
s_nop 0
T a[100:101],v1,8192
T a[102:103],v1,9216
M a[12:15],a[160:163],a[56:59],a[12:15]
M a[16:19],a[160:163],a[64:67],a[16:19]
buffer_load_dwordx4 v13, s[48:51], s22 offen offset:1024   lds
M a[16:19],a[164:167],a[68:71],a[16:19]
M a[20:23],a[164:167],a[76:79],a[20:23]
M a[20:23],a[160:163],a[72:75],a[20:23]
s_nop 0
T a[104:105],v2,0
T a[106:107],v2,1024
M a[24:27],a[160:163],a[80:83],a[24:27]
M a[24:27],a[164:167],a[84:87],a[24:27]
s_waitcnt lgkmcnt(6)
buffer_load_dwordx4 v14, s[48:51], s22 offen offset:2048   lds
M a[28:31],a[164:167],a[92:95],a[28:31]
M a[28:31],a[160:163],a[88:91],a[28:31]
M v[32:35],a[168:171],a[32:35],v[32:35]
R a[160:163],v5,36864
R a[164:167],v6,36864
M v[32:35],a[172:175],a[36:39],v[32:35]
T a[108:109],v2,8192
T a[110:111],v2,9216
M v[36:39],a[172:175],a[44:47],v[36:39]
buffer_load_dwordx4 v15, s[48:51], s22 offen offset:3072   lds
M v[36:39],a[168:171],a[40:43],v[36:39]
s_sub_u32 s22, s22, 1048448
M v[40:43],a[168:171],a[48:51],v[40:43]
M v[40:43],a[172:175],a[52:55],v[40:43]
s_nop 0
T a[112:113],v3,0
T a[114:115],v3,1024
M v[44:47],a[172:175],a[60:63],v[44:47]
SA m0,s23,49152
M v[44:47],a[168:171],a[56:59],v[44:47]
buffer_load_dwordx4 v8, s[16:19], s21 offen offset:0  nt lds
M v[48:51],a[168:171],a[64:67],v[48:51]
M v[48:51],a[172:175],a[68:71],v[48:51]
M v[52:55],a[172:175],a[76:79],v[52:55]
s_nop 0
T a[116:117],v3,8192
T a[118:119],v3,9216
M v[52:55],a[168:171],a[72:75],v[52:55]
M v[56:59],a[168:171],a[80:83],v[56:59]
buffer_load_dwordx4 v9, s[16:19], s21 offen offset:1024  nt lds
M v[56:59],a[172:175],a[84:87],v[56:59]
s_waitcnt lgkmcnt(6)
M v[60:63],a[172:175],a[92:95],v[60:63]
M v[60:63],a[168:171],a[88:91],v[60:63]
s_nop 0
T a[120:121],v4,0
T a[122:123],v4,1024
M v[64:67],a[160:163],a[32:35],v[64:67]
R a[168:171],v5,38912
R a[172:175],v6,38912
M v[64:67],a[164:167],a[36:39],v[64:67]
buffer_load_dwordx4 v10, s[16:19], s21 offen offset:2048  nt lds
M v[68:71],a[164:167],a[44:47],v[68:71]
M v[68:71],a[160:163],a[40:43],v[68:71]
M v[72:75],a[160:163],a[48:51],v[72:75]
s_nop 0
T a[124:125],v4,8192
T a[126:127],v4,9216
M v[72:75],a[164:167],a[52:55],v[72:75]
M v[76:79],a[164:167],a[60:63],v[76:79]
buffer_load_dwordx4 v11, s[16:19], s21 offen offset:3072  nt lds
M v[76:79],a[160:163],a[56:59],v[76:79]
SA s21,s21,524160
M v[80:83],a[160:163],a[64:67],v[80:83]
M v[80:83],a[164:167],a[68:71],v[80:83]
M v[84:87],a[164:167],a[76:79],v[84:87]
M v[84:87],a[160:163],a[72:75],v[84:87]
M v[88:91],a[160:163],a[80:83],v[88:91]
M v[88:91],a[164:167],a[84:87],v[88:91]
s_waitcnt lgkmcnt(2)
M v[92:95],a[164:167],a[92:95],v[92:95]
s_waitcnt vmcnt(17) lgkmcnt(0)
M v[92:95],a[160:163],a[88:91],v[92:95]
s_barrier
M v[96:99],a[168:171],a[32:35],v[96:99]
R a[160:163],v5,49152
R a[164:167],v6,49152
M v[96:99],a[172:175],a[36:39],v[96:99]
M v[100:103],a[172:175],a[44:47],v[100:103]
SA m0,s24,32768
T a[128:129],v1,16384
T a[130:131],v1,17408
M v[100:103],a[168:171],a[40:43],v[100:103]
buffer_load_dwordx4 v12, s[48:51], s22 offen offset:0   lds
M v[104:107],a[168:171],a[48:51],v[104:107]
M v[104:107],a[172:175],a[52:55],v[104:107]
M v[108:111],a[172:175],a[60:63],v[108:111]
M v[108:111],a[168:171],a[56:59],v[108:111]
M v[112:115],a[168:171],a[64:67],v[112:115]
M v[112:115],a[172:175],a[68:71],v[112:115]
s_nop 0
T a[132:133],v1,24576
T a[134:135],v1,25600
M v[116:119],a[172:175],a[76:79],v[116:119]
buffer_load_dwordx4 v13, s[48:51], s22 offen offset:1024   lds
M v[116:119],a[168:171],a[72:75],v[116:119]
M v[120:123],a[168:171],a[80:83],v[120:123]
M v[120:123],a[172:175],a[84:87],v[120:123]
s_waitcnt lgkmcnt(4)
M v[124:127],a[172:175],a[92:95],v[124:127]
M v[124:127],a[168:171],a[88:91],v[124:127]
M v[128:131],a[160:163],a[32:35],v[128:131]
R a[168:171],v5,51200
R a[172:175],v6,51200
M v[128:131],a[164:167],a[36:39],v[128:131]
T a[136:137],v2,16384
T a[138:139],v2,17408
M v[132:135],a[164:167],a[44:47],v[132:135]
buffer_load_dwordx4 v14, s[48:51], s22 offen offset:2048   lds
M v[132:135],a[160:163],a[40:43],v[132:135]
M v[136:139],a[160:163],a[48:51],v[136:139]
M v[136:139],a[164:167],a[52:55],v[136:139]
M v[140:143],a[164:167],a[60:63],v[140:143]
M v[140:143],a[160:163],a[56:59],v[140:143]
s_nop 0
T a[140:141],v2,24576
T a[142:143],v2,25600
M v[144:147],a[160:163],a[64:67],v[144:147]
buffer_load_dwordx4 v15, s[48:51], s22 offen offset:3072   lds
M v[144:147],a[164:167],a[68:71],v[144:147]
SA s22,s22,1048576
M v[148:151],a[164:167],a[76:79],v[148:151]
M v[148:151],a[160:163],a[72:75],v[148:151]
M v[152:155],a[160:163],a[80:83],v[152:155]
M v[152:155],a[164:167],a[84:87],v[152:155]
s_waitcnt lgkmcnt(4)
M v[156:159],a[164:167],a[92:95],v[156:159]
SA m0,s23,0
T a[144:145],v3,16384
T a[146:147],v3,17408
M v[156:159],a[160:163],a[88:91],v[156:159]
buffer_load_dwordx4 v8, s[16:19], s21 offen offset:0  nt lds
M v[160:163],a[168:171],a[32:35],v[160:163]
R a[160:163],v5,53248
R a[164:167],v6,53248
M v[160:163],a[172:175],a[36:39],v[160:163]
M v[164:167],a[172:175],a[44:47],v[164:167]
M v[164:167],a[168:171],a[40:43],v[164:167]
M v[168:171],a[168:171],a[48:51],v[168:171]
M v[168:171],a[172:175],a[52:55],v[168:171]
s_nop 0
T a[148:149],v3,24576
T a[150:151],v3,25600
M v[172:175],a[172:175],a[60:63],v[172:175]
buffer_load_dwordx4 v9, s[16:19], s21 offen offset:1024  nt lds
M v[172:175],a[168:171],a[56:59],v[172:175]
M v[176:179],a[168:171],a[64:67],v[176:179]
M v[176:179],a[172:175],a[68:71],v[176:179]
M v[180:183],a[172:175],a[76:79],v[180:183]
M v[180:183],a[168:171],a[72:75],v[180:183]
M v[184:187],a[168:171],a[80:83],v[184:187]
s_nop 0
T a[152:153],v4,16384
T a[154:155],v4,17408
M v[184:187],a[172:175],a[84:87],v[184:187]
s_waitcnt lgkmcnt(4)
buffer_load_dwordx4 v10, s[16:19], s21 offen offset:2048  nt lds
M v[188:191],a[172:175],a[92:95],v[188:191]
M v[188:191],a[168:171],a[88:91],v[188:191]
M v[192:195],a[160:163],a[32:35],v[192:195]
R a[168:171],v5,55296
R a[172:175],v6,55296
M v[192:195],a[164:167],a[36:39],v[192:195]
M v[196:199],a[164:167],a[44:47],v[196:199]
M v[196:199],a[160:163],a[40:43],v[196:199]
s_nop 0
T a[156:157],v4,24576
T a[158:159],v4,25600
M v[200:203],a[160:163],a[48:51],v[200:203]
buffer_load_dwordx4 v11, s[16:19], s21 offen offset:3072  nt lds
M v[200:203],a[164:167],a[52:55],v[200:203]
SA s21,s21,128
M v[204:207],a[164:167],a[60:63],v[204:207]
M v[204:207],a[160:163],a[56:59],v[204:207]
M v[208:211],a[160:163],a[64:67],v[208:211]
M v[208:211],a[164:167],a[68:71],v[208:211]
M v[212:215],a[164:167],a[76:79],v[212:215]
M v[212:215],a[160:163],a[72:75],v[212:215]
M v[216:219],a[160:163],a[80:83],v[216:219]
M v[216:219],a[164:167],a[84:87],v[216:219]
s_waitcnt lgkmcnt(2)
M v[220:223],a[164:167],a[92:95],v[220:223]
s_waitcnt vmcnt(17) lgkmcnt(0)
M v[220:223],a[160:163],a[88:91],v[220:223]
s_barrier
M v[224:227],a[168:171],a[32:35],v[224:227]
R a[160:163],v5,0
R a[164:167],v6,0
M v[224:227],a[172:175],a[36:39],v[224:227]
buffer_load_dword a240, v23, s[52:55], 0 offen offset:0
M v[228:231],a[172:175],a[44:47],v[228:231]
v_add_u32 v23, 16384, v23
M v[228:231],a[168:171],a[40:43],v[228:231]
M v[232:235],a[168:171],a[48:51],v[232:235]
M v[232:235],a[172:175],a[52:55],v[232:235]
M v[236:239],a[172:175],a[60:63],v[236:239]
M v[236:239],a[168:171],a[56:59],v[236:239]
M v[240:243],a[168:171],a[64:67],v[240:243]
M v[240:243],a[172:175],a[68:71],v[240:243]
M v[244:247],a[172:175],a[76:79],v[244:247]
M v[244:247],a[168:171],a[72:75],v[244:247]
M v[248:251],a[168:171],a[80:83],v[248:251]
M v[248:251],a[172:175],a[84:87],v[248:251]
s_waitcnt lgkmcnt(0)
M v[252:255],a[172:175],a[92:95],v[252:255]
M v[252:255],a[168:171],a[88:91],v[252:255]
M a[0:3],a[160:163],a[96:99],a[0:3]
R a[168:171],v5,2048
R a[172:175],v6,2048
M a[0:3],a[164:167],a[100:103],a[0:3]
T a[32:33],v1,32768
T a[34:35],v1,33792
M a[4:7],a[164:167],a[108:111],a[4:7]
SA m0,s24,49152
M a[4:7],a[160:163],a[104:107],a[4:7]
buffer_load_dwordx4 v12, s[48:51], s22 offen offset:0   lds
M a[8:11],a[160:163],a[112:115],a[8:11]
M a[8:11],a[164:167],a[116:119],a[8:11]
M a[12:15],a[164:167],a[124:127],a[12:15]
s_nop 0
T a[36:37],v1,40960
T a[38:39],v1,41984
M a[12:15],a[160:163],a[120:123],a[12:15]
M a[16:19],a[160:163],a[128:131],a[16:19]
buffer_load_dwordx4 v13, s[48:51], s22 offen offset:1024   lds
M a[16:19],a[164:167],a[132:135],a[16:19]
M a[20:23],a[164:167],a[140:143],a[20:23]
M a[20:23],a[160:163],a[136:139],a[20:23]
s_nop 0
T a[40:41],v2,32768
T a[42:43],v2,33792
M a[24:27],a[160:163],a[144:147],a[24:27]
M a[24:27],a[164:167],a[148:151],a[24:27]
s_waitcnt lgkmcnt(6)
buffer_load_dwordx4 v14, s[48:51], s22 offen offset:2048   lds
M a[28:31],a[164:167],a[156:159],a[28:31]
M a[28:31],a[160:163],a[152:155],a[28:31]
M v[32:35],a[168:171],a[96:99],v[32:35]
R a[160:163],v5,4096
R a[164:167],v6,4096
M v[32:35],a[172:175],a[100:103],v[32:35]
T a[44:45],v2,40960
T a[46:47],v2,41984
M v[36:39],a[172:175],a[108:111],v[36:39]
buffer_load_dwordx4 v15, s[48:51], s22 offen offset:3072   lds
M v[36:39],a[168:171],a[104:107],v[36:39]
s_sub_u32 s22, s22, 1048448
M v[40:43],a[168:171],a[112:115],v[40:43]
M v[40:43],a[172:175],a[116:119],v[40:43]
s_nop 0
T a[48:49],v3,32768
T a[50:51],v3,33792
M v[44:47],a[172:175],a[124:127],v[44:47]
SA m0,s23,16384
M v[44:47],a[168:171],a[120:123],v[44:47]
buffer_load_dwordx4 v8, s[16:19], s21 offen offset:0  nt lds
M v[48:51],a[168:171],a[128:131],v[48:51]
M v[48:51],a[172:175],a[132:135],v[48:51]
M v[52:55],a[172:175],a[140:143],v[52:55]
s_nop 0
T a[52:53],v3,40960
T a[54:55],v3,41984
M v[52:55],a[168:171],a[136:139],v[52:55]
M v[56:59],a[168:171],a[144:147],v[56:59]
buffer_load_dwordx4 v9, s[16:19], s21 offen offset:1024  nt lds
M v[56:59],a[172:175],a[148:151],v[56:59]
s_waitcnt lgkmcnt(6)
M v[60:63],a[172:175],a[156:159],v[60:63]
M v[60:63],a[168:171],a[152:155],v[60:63]
s_nop 0
T a[56:57],v4,32768
T a[58:59],v4,33792
M v[64:67],a[160:163],a[96:99],v[64:67]
R a[168:171],v5,6144
R a[172:175],v6,6144
M v[64:67],a[164:167],a[100:103],v[64:67]
buffer_load_dwordx4 v10, s[16:19], s21 offen offset:2048  nt lds
M v[68:71],a[164:167],a[108:111],v[68:71]
M v[68:71],a[160:163],a[104:107],v[68:71]
M v[72:75],a[160:163],a[112:115],v[72:75]
s_nop 0
T a[60:61],v4,40960
T a[62:63],v4,41984
M v[72:75],a[164:167],a[116:119],v[72:75]
M v[76:79],a[164:167],a[124:127],v[76:79]
buffer_load_dwordx4 v11, s[16:19], s21 offen offset:3072  nt lds
M v[76:79],a[160:163],a[120:123],v[76:79]
SA s21,s21,524160
M v[80:83],a[160:163],a[128:131],v[80:83]
M v[80:83],a[164:167],a[132:135],v[80:83]
M v[84:87],a[164:167],a[140:143],v[84:87]
M v[84:87],a[160:163],a[136:139],v[84:87]
M v[88:91],a[160:163],a[144:147],v[88:91]
M v[88:91],a[164:167],a[148:151],v[88:91]
s_waitcnt lgkmcnt(2)
M v[92:95],a[164:167],a[156:159],v[92:95]
s_waitcnt vmcnt(17) lgkmcnt(0)
M v[92:95],a[160:163],a[152:155],v[92:95]
s_barrier
M v[96:99],a[168:171],a[96:99],v[96:99]
R a[160:163],v5,16384
R a[164:167],v6,16384
M v[96:99],a[172:175],a[100:103],v[96:99]
M v[100:103],a[172:175],a[108:111],v[100:103]
SA m0,s24,0
T a[64:65],v1,49152
T a[66:67],v1,50176
M v[100:103],a[168:171],a[104:107],v[100:103]
buffer_load_dwordx4 v12, s[48:51], s22 offen offset:0   lds
M v[104:107],a[168:171],a[112:115],v[104:107]
M v[104:107],a[172:175],a[116:119],v[104:107]
M v[108:111],a[172:175],a[124:127],v[108:111]
M v[108:111],a[168:171],a[120:123],v[108:111]
M v[112:115],a[168:171],a[128:131],v[112:115]
M v[112:115],a[172:175],a[132:135],v[112:115]
s_nop 0
T a[68:69],v1,57344
T a[70:71],v1,58368
M v[116:119],a[172:175],a[140:143],v[116:119]
buffer_load_dwordx4 v13, s[48:51], s22 offen offset:1024   lds
M v[116:119],a[168:171],a[136:139],v[116:119]
M v[120:123],a[168:171],a[144:147],v[120:123]
M v[120:123],a[172:175],a[148:151],v[120:123]
s_waitcnt lgkmcnt(4)
M v[124:127],a[172:175],a[156:159],v[124:127]
M v[124:127],a[168:171],a[152:155],v[124:127]
M v[128:131],a[160:163],a[96:99],v[128:131]
R a[168:171],v5,18432
R a[172:175],v6,18432
M v[128:131],a[164:167],a[100:103],v[128:131]
T a[72:73],v2,49152
T a[74:75],v2,50176
M v[132:135],a[164:167],a[108:111],v[132:135]
buffer_load_dwordx4 v14, s[48:51], s22 offen offset:2048   lds
M v[132:135],a[160:163],a[104:107],v[132:135]
M v[136:139],a[160:163],a[112:115],v[136:139]
M v[136:139],a[164:167],a[116:119],v[136:139]
M v[140:143],a[164:167],a[124:127],v[140:143]
M v[140:143],a[160:163],a[120:123],v[140:143]
s_nop 0
T a[76:77],v2,57344
T a[78:79],v2,58368
M v[144:147],a[160:163],a[128:131],v[144:147]
buffer_load_dwordx4 v15, s[48:51], s22 offen offset:3072   lds
M v[144:147],a[164:167],a[132:135],v[144:147]
SA s22,s22,1048576
M v[148:151],a[164:167],a[140:143],v[148:151]
M v[148:151],a[160:163],a[136:139],v[148:151]
M v[152:155],a[160:163],a[144:147],v[152:155]
M v[152:155],a[164:167],a[148:151],v[152:155]
s_waitcnt lgkmcnt(4)
M v[156:159],a[164:167],a[156:159],v[156:159]
SA m0,s23,32768
T a[80:81],v3,49152
T a[82:83],v3,50176
M v[156:159],a[160:163],a[152:155],v[156:159]
buffer_load_dwordx4 v8, s[16:19], s21 offen offset:0  nt lds
M v[160:163],a[168:171],a[96:99],v[160:163]
R a[160:163],v5,20480
R a[164:167],v6,20480
M v[160:163],a[172:175],a[100:103],v[160:163]
M v[164:167],a[172:175],a[108:111],v[164:167]
M v[164:167],a[168:171],a[104:107],v[164:167]
M v[168:171],a[168:171],a[112:115],v[168:171]
M v[168:171],a[172:175],a[116:119],v[168:171]
s_nop 0
T a[84:85],v3,57344
T a[86:87],v3,58368
M v[172:175],a[172:175],a[124:127],v[172:175]
buffer_load_dwordx4 v9, s[16:19], s21 offen offset:1024  nt lds
M v[172:175],a[168:171],a[120:123],v[172:175]
M v[176:179],a[168:171],a[128:131],v[176:179]
M v[176:179],a[172:175],a[132:135],v[176:179]
M v[180:183],a[172:175],a[140:143],v[180:183]
M v[180:183],a[168:171],a[136:139],v[180:183]
M v[184:187],a[168:171],a[144:147],v[184:187]
s_nop 0
T a[88:89],v4,49152
T a[90:91],v4,50176
M v[184:187],a[172:175],a[148:151],v[184:187]
s_waitcnt lgkmcnt(4)
buffer_load_dwordx4 v10, s[16:19], s21 offen offset:2048  nt lds
M v[188:191],a[172:175],a[156:159],v[188:191]
M v[188:191],a[168:171],a[152:155],v[188:191]
M v[192:195],a[160:163],a[96:99],v[192:195]
R a[168:171],v5,22528
R a[172:175],v6,22528
M v[192:195],a[164:167],a[100:103],v[192:195]
M v[196:199],a[164:167],a[108:111],v[196:199]
M v[196:199],a[160:163],a[104:107],v[196:199]
s_nop 0
T a[92:93],v4,57344
T a[94:95],v4,58368
M v[200:203],a[160:163],a[112:115],v[200:203]
buffer_load_dwordx4 v11, s[16:19], s21 offen offset:3072  nt lds
M v[200:203],a[164:167],a[116:119],v[200:203]
SA s21,s21,128
M v[204:207],a[164:167],a[124:127],v[204:207]
M v[204:207],a[160:163],a[120:123],v[204:207]
M v[208:211],a[160:163],a[128:131],v[208:211]
M v[208:211],a[164:167],a[132:135],v[208:211]
M v[212:215],a[164:167],a[140:143],v[212:215]
M v[212:215],a[160:163],a[136:139],v[212:215]
M v[216:219],a[160:163],a[144:147],v[216:219]
M v[216:219],a[164:167],a[148:151],v[216:219]
s_waitcnt lgkmcnt(2)
M v[220:223],a[164:167],a[156:159],v[220:223]
s_waitcnt vmcnt(17) lgkmcnt(0)
M v[220:223],a[160:163],a[152:155],v[220:223]
s_barrier
M v[224:227],a[168:171],a[96:99],v[224:227]
R a[160:163],v5,32768
R a[164:167],v6,32768
M v[224:227],a[172:175],a[100:103],v[224:227]
buffer_load_dword a240, v23, s[52:55], 0 offen offset:0
M v[228:231],a[172:175],a[108:111],v[228:231]
L_w_kv15:
s_cbranch_execz L_wd2
v_add_u32 v23, 16384, v23
M v[228:231],a[168:171],a[104:107],v[228:231]
M v[232:235],a[168:171],a[112:115],v[232:235]
M v[232:235],a[172:175],a[116:119],v[232:235]
M v[236:239],a[172:175],a[124:127],v[236:239]
M v[236:239],a[168:171],a[120:123],v[236:239]
M v[240:243],a[168:171],a[128:131],v[240:243]
M v[240:243],a[172:175],a[132:135],v[240:243]
M v[244:247],a[172:175],a[140:143],v[244:247]
M v[244:247],a[168:171],a[136:139],v[244:247]
M v[248:251],a[168:171],a[144:147],v[248:251]
M v[248:251],a[172:175],a[148:151],v[248:251]
s_waitcnt lgkmcnt(0)
M v[252:255],a[172:175],a[156:159],v[252:255]
M v[252:255],a[168:171],a[152:155],v[252:255]
M a[0:3],a[160:163],a[32:35],a[0:3]
R a[168:171],v5,34816
R a[172:175],v6,34816
M a[0:3],a[164:167],a[36:39],a[0:3]
T a[96:97],v1,0
T a[98:99],v1,1024
M a[4:7],a[164:167],a[44:47],a[4:7]
SA m0,s24,16384
M a[4:7],a[160:163],a[40:43],a[4:7]
buffer_load_dwordx4 v12, s[48:51], s22 offen offset:0   lds
M a[8:11],a[160:163],a[48:51],a[8:11]
M a[8:11],a[164:167],a[52:55],a[8:11]
M a[12:15],a[164:167],a[60:63],a[12:15]
s_nop 0
T a[100:101],v1,8192
T a[102:103],v1,9216
M a[12:15],a[160:163],a[56:59],a[12:15]
M a[16:19],a[160:163],a[64:67],a[16:19]
buffer_load_dwordx4 v13, s[48:51], s22 offen offset:1024   lds
M a[16:19],a[164:167],a[68:71],a[16:19]
M a[20:23],a[164:167],a[76:79],a[20:23]
M a[20:23],a[160:163],a[72:75],a[20:23]
s_nop 0
T a[104:105],v2,0
T a[106:107],v2,1024
M a[24:27],a[160:163],a[80:83],a[24:27]
M a[24:27],a[164:167],a[84:87],a[24:27]
s_waitcnt lgkmcnt(6)
buffer_load_dwordx4 v14, s[48:51], s22 offen offset:2048   lds
M a[28:31],a[164:167],a[92:95],a[28:31]
M a[28:31],a[160:163],a[88:91],a[28:31]
M v[32:35],a[168:171],a[32:35],v[32:35]
R a[160:163],v5,36864
R a[164:167],v6,36864
M v[32:35],a[172:175],a[36:39],v[32:35]
T a[108:109],v2,8192
T a[110:111],v2,9216
M v[36:39],a[172:175],a[44:47],v[36:39]
buffer_load_dwordx4 v15, s[48:51], s22 offen offset:3072   lds
M v[36:39],a[168:171],a[40:43],v[36:39]
s_sub_u32 s22, s22, 1048448
M v[40:43],a[168:171],a[48:51],v[40:43]
M v[40:43],a[172:175],a[52:55],v[40:43]
s_nop 0
T a[112:113],v3,0
T a[114:115],v3,1024
M v[44:47],a[172:175],a[60:63],v[44:47]
SA m0,s23,49152
M v[44:47],a[168:171],a[56:59],v[44:47]
buffer_load_dwordx4 v8, s[16:19], s21 offen offset:0  nt lds
M v[48:51],a[168:171],a[64:67],v[48:51]
M v[48:51],a[172:175],a[68:71],v[48:51]
M v[52:55],a[172:175],a[76:79],v[52:55]
s_nop 0
T a[116:117],v3,8192
T a[118:119],v3,9216
M v[52:55],a[168:171],a[72:75],v[52:55]
M v[56:59],a[168:171],a[80:83],v[56:59]
buffer_load_dwordx4 v9, s[16:19], s21 offen offset:1024  nt lds
M v[56:59],a[172:175],a[84:87],v[56:59]
s_waitcnt lgkmcnt(6)
M v[60:63],a[172:175],a[92:95],v[60:63]
M v[60:63],a[168:171],a[88:91],v[60:63]
s_nop 0
T a[120:121],v4,0
T a[122:123],v4,1024
M v[64:67],a[160:163],a[32:35],v[64:67]
R a[168:171],v5,38912
R a[172:175],v6,38912
M v[64:67],a[164:167],a[36:39],v[64:67]
buffer_load_dwordx4 v10, s[16:19], s21 offen offset:2048  nt lds
M v[68:71],a[164:167],a[44:47],v[68:71]
M v[68:71],a[160:163],a[40:43],v[68:71]
M v[72:75],a[160:163],a[48:51],v[72:75]
s_nop 0
T a[124:125],v4,8192
T a[126:127],v4,9216
M v[72:75],a[164:167],a[52:55],v[72:75]
M v[76:79],a[164:167],a[60:63],v[76:79]
buffer_load_dwordx4 v11, s[16:19], s21 offen offset:3072  nt lds
M v[76:79],a[160:163],a[56:59],v[76:79]
SA s21,s21,524160
M v[80:83],a[160:163],a[64:67],v[80:83]
M v[80:83],a[164:167],a[68:71],v[80:83]
M v[84:87],a[164:167],a[76:79],v[84:87]
M v[84:87],a[160:163],a[72:75],v[84:87]
M v[88:91],a[160:163],a[80:83],v[88:91]
M v[88:91],a[164:167],a[84:87],v[88:91]
s_waitcnt lgkmcnt(2)
M v[92:95],a[164:167],a[92:95],v[92:95]
s_waitcnt vmcnt(17) lgkmcnt(0)
M v[92:95],a[160:163],a[88:91],v[92:95]
s_barrier
M v[96:99],a[168:171],a[32:35],v[96:99]
R a[160:163],v5,49152
R a[164:167],v6,49152
M v[96:99],a[172:175],a[36:39],v[96:99]
M v[100:103],a[172:175],a[44:47],v[100:103]
SA m0,s24,32768
T a[128:129],v1,16384
T a[130:131],v1,17408
M v[100:103],a[168:171],a[40:43],v[100:103]
buffer_load_dwordx4 v12, s[48:51], s22 offen offset:0   lds
M v[104:107],a[168:171],a[48:51],v[104:107]
M v[104:107],a[172:175],a[52:55],v[104:107]
M v[108:111],a[172:175],a[60:63],v[108:111]
M v[108:111],a[168:171],a[56:59],v[108:111]
M v[112:115],a[168:171],a[64:67],v[112:115]
M v[112:115],a[172:175],a[68:71],v[112:115]
s_nop 0
T a[132:133],v1,24576
T a[134:135],v1,25600
M v[116:119],a[172:175],a[76:79],v[116:119]
buffer_load_dwordx4 v13, s[48:51], s22 offen offset:1024   lds
M v[116:119],a[168:171],a[72:75],v[116:119]
M v[120:123],a[168:171],a[80:83],v[120:123]
M v[120:123],a[172:175],a[84:87],v[120:123]
s_waitcnt lgkmcnt(4)
M v[124:127],a[172:175],a[92:95],v[124:127]
M v[124:127],a[168:171],a[88:91],v[124:127]
M v[128:131],a[160:163],a[32:35],v[128:131]
R a[168:171],v5,51200
R a[172:175],v6,51200
M v[128:131],a[164:167],a[36:39],v[128:131]
T a[136:137],v2,16384
T a[138:139],v2,17408
M v[132:135],a[164:167],a[44:47],v[132:135]
buffer_load_dwordx4 v14, s[48:51], s22 offen offset:2048   lds
M v[132:135],a[160:163],a[40:43],v[132:135]
M v[136:139],a[160:163],a[48:51],v[136:139]
M v[136:139],a[164:167],a[52:55],v[136:139]
M v[140:143],a[164:167],a[60:63],v[140:143]
M v[140:143],a[160:163],a[56:59],v[140:143]
s_nop 0
T a[140:141],v2,24576
T a[142:143],v2,25600
M v[144:147],a[160:163],a[64:67],v[144:147]
buffer_load_dwordx4 v15, s[48:51], s22 offen offset:3072   lds
M v[144:147],a[164:167],a[68:71],v[144:147]
SA s22,s22,1048576
M v[148:151],a[164:167],a[76:79],v[148:151]
M v[148:151],a[160:163],a[72:75],v[148:151]
M v[152:155],a[160:163],a[80:83],v[152:155]
M v[152:155],a[164:167],a[84:87],v[152:155]
s_waitcnt lgkmcnt(4)
M v[156:159],a[164:167],a[92:95],v[156:159]
SA m0,s23,0
T a[144:145],v3,16384
T a[146:147],v3,17408
M v[156:159],a[160:163],a[88:91],v[156:159]
buffer_load_dwordx4 v8, s[16:19], s21 offen offset:0  nt lds
M v[160:163],a[168:171],a[32:35],v[160:163]
R a[160:163],v5,53248
R a[164:167],v6,53248
M v[160:163],a[172:175],a[36:39],v[160:163]
M v[164:167],a[172:175],a[44:47],v[164:167]
M v[164:167],a[168:171],a[40:43],v[164:167]
M v[168:171],a[168:171],a[48:51],v[168:171]
M v[168:171],a[172:175],a[52:55],v[168:171]
s_nop 0
T a[148:149],v3,24576
T a[150:151],v3,25600
M v[172:175],a[172:175],a[60:63],v[172:175]
buffer_load_dwordx4 v9, s[16:19], s21 offen offset:1024  nt lds
M v[172:175],a[168:171],a[56:59],v[172:175]
M v[176:179],a[168:171],a[64:67],v[176:179]
M v[176:179],a[172:175],a[68:71],v[176:179]
M v[180:183],a[172:175],a[76:79],v[180:183]
M v[180:183],a[168:171],a[72:75],v[180:183]
M v[184:187],a[168:171],a[80:83],v[184:187]
s_nop 0
T a[152:153],v4,16384
T a[154:155],v4,17408
M v[184:187],a[172:175],a[84:87],v[184:187]
s_waitcnt lgkmcnt(4)
buffer_load_dwordx4 v10, s[16:19], s21 offen offset:2048  nt lds
M v[188:191],a[172:175],a[92:95],v[188:191]
M v[188:191],a[168:171],a[88:91],v[188:191]
M v[192:195],a[160:163],a[32:35],v[192:195]
R a[168:171],v5,55296
R a[172:175],v6,55296
M v[192:195],a[164:167],a[36:39],v[192:195]
M v[196:199],a[164:167],a[44:47],v[196:199]
M v[196:199],a[160:163],a[40:43],v[196:199]
s_nop 0
T a[156:157],v4,24576
T a[158:159],v4,25600
M v[200:203],a[160:163],a[48:51],v[200:203]
buffer_load_dwordx4 v11, s[16:19], s21 offen offset:3072  nt lds
M v[200:203],a[164:167],a[52:55],v[200:203]
SA s21,s21,128
M v[204:207],a[164:167],a[60:63],v[204:207]
M v[204:207],a[160:163],a[56:59],v[204:207]
M v[208:211],a[160:163],a[64:67],v[208:211]
M v[208:211],a[164:167],a[68:71],v[208:211]
M v[212:215],a[164:167],a[76:79],v[212:215]
M v[212:215],a[160:163],a[72:75],v[212:215]
M v[216:219],a[160:163],a[80:83],v[216:219]
M v[216:219],a[164:167],a[84:87],v[216:219]
s_waitcnt lgkmcnt(2)
M v[220:223],a[164:167],a[92:95],v[220:223]
s_waitcnt vmcnt(17) lgkmcnt(0)
M v[220:223],a[160:163],a[88:91],v[220:223]
s_barrier
M v[224:227],a[168:171],a[32:35],v[224:227]
R a[160:163],v5,0
R a[164:167],v6,0
M v[224:227],a[172:175],a[36:39],v[224:227]
M v[228:231],a[172:175],a[44:47],v[228:231]
M v[228:231],a[168:171],a[40:43],v[228:231]
M v[232:235],a[168:171],a[48:51],v[232:235]
M v[232:235],a[172:175],a[52:55],v[232:235]
M v[236:239],a[172:175],a[60:63],v[236:239]
M v[236:239],a[168:171],a[56:59],v[236:239]
M v[240:243],a[168:171],a[64:67],v[240:243]
M v[240:243],a[172:175],a[68:71],v[240:243]
M v[244:247],a[172:175],a[76:79],v[244:247]
M v[244:247],a[168:171],a[72:75],v[244:247]
M v[248:251],a[168:171],a[80:83],v[248:251]
M v[248:251],a[172:175],a[84:87],v[248:251]
s_waitcnt lgkmcnt(0)
M v[252:255],a[172:175],a[92:95],v[252:255]
M v[252:255],a[168:171],a[88:91],v[252:255]
M a[0:3],a[160:163],a[96:99],a[0:3]
R a[168:171],v5,2048
R a[172:175],v6,2048
M a[0:3],a[164:167],a[100:103],a[0:3]
T a[32:33],v1,32768
T a[34:35],v1,33792
M a[4:7],a[164:167],a[108:111],a[4:7]
SA m0,s24,49152
v_lshrrev_b32 v28, 4, v0
v_and_b32 v29, 7, v0
M a[4:7],a[160:163],a[104:107],a[4:7]
buffer_load_dwordx4 v12, s[48:51], s22 offen offset:0   lds
M a[8:11],a[160:163],a[112:115],a[8:11]
v_xor_b32 v28, v28, v29
v_lshlrev_b32 v28, 4, v28
M a[8:11],a[164:167],a[116:119],a[8:11]
v_lshrrev_b32 v29, 3, v0
v_mul_u32_u24 v29, 896, v29
M a[12:15],a[164:167],a[124:127],a[12:15]
T a[36:37],v1,40960
T a[38:39],v1,41984
M a[12:15],a[160:163],a[120:123],a[12:15]
v_add_u32 v22, v28, v29
v_xor_b32 v28, 64, v28
M a[16:19],a[160:163],a[128:131],a[16:19]
s_mul_i32 s64, s20, 14336
buffer_load_dwordx4 v13, s[48:51], s22 offen offset:1024   lds
M a[16:19],a[164:167],a[132:135],a[16:19]
s_sub_u32 s65, 98304, s64
M a[20:23],a[164:167],a[140:143],a[20:23]
SA s30,s29,s65
M a[20:23],a[160:163],a[136:139],a[20:23]
SA s29,s29,s64
T a[40:41],v2,32768
T a[42:43],v2,33792
M a[24:27],a[160:163],a[144:147],a[24:27]
v_add_u32 v29, 6144, v29
v_add_u32 v23, v28, v29
M a[24:27],a[164:167],a[148:151],a[24:27]
s_waitcnt lgkmcnt(6)
buffer_load_dwordx4 v14, s[48:51], s22 offen offset:2048   lds
M a[28:31],a[164:167],a[156:159],a[28:31]
s_and_b32 s64, s20, 1
M a[28:31],a[160:163],a[152:155],a[28:31]
s_lshl_b32 s64, s64, 12
M v[32:35],a[168:171],a[96:99],v[32:35]
SA s64,s64,65536
R a[160:163],v5,4096
R a[164:167],v6,4096
M v[32:35],a[172:175],a[100:103],v[32:35]
T a[44:45],v2,40960
T a[46:47],v2,41984
M v[36:39],a[172:175],a[108:111],v[36:39]
buffer_load_dwordx4 v15, s[48:51], s22 offen offset:3072   lds
M v[36:39],a[168:171],a[104:107],v[36:39]
s_sub_u32 s22, s22, 1048448
v_add_u32 v20, s64, v5
v_add_u32 v21, s64, v6
M v[40:43],a[168:171],a[112:115],v[40:43]
M v[40:43],a[172:175],a[116:119],v[40:43]
s_nop 0
T a[48:49],v3,32768
T a[50:51],v3,33792
M v[44:47],a[172:175],a[124:127],v[44:47]
SA m0,s23,16384
M v[44:47],a[168:171],a[120:123],v[44:47]
buffer_load_dwordx4 v8, s[16:19], s21 offen offset:0  nt lds
M v[48:51],a[168:171],a[128:131],v[48:51]
M v[48:51],a[172:175],a[132:135],v[48:51]
M v[52:55],a[172:175],a[140:143],v[52:55]
s_nop 0
T a[52:53],v3,40960
T a[54:55],v3,41984
M v[52:55],a[168:171],a[136:139],v[52:55]
M v[56:59],a[168:171],a[144:147],v[56:59]
buffer_load_dwordx4 v9, s[16:19], s21 offen offset:1024  nt lds
M v[56:59],a[172:175],a[148:151],v[56:59]
s_waitcnt lgkmcnt(6)
M v[60:63],a[172:175],a[156:159],v[60:63]
M v[60:63],a[168:171],a[152:155],v[60:63]
s_nop 0
T a[56:57],v4,32768
T a[58:59],v4,33792
M v[64:67],a[160:163],a[96:99],v[64:67]
R a[168:171],v5,6144
R a[172:175],v6,6144
M v[64:67],a[164:167],a[100:103],v[64:67]
buffer_load_dwordx4 v10, s[16:19], s21 offen offset:2048  nt lds
M v[68:71],a[164:167],a[108:111],v[68:71]
M v[68:71],a[160:163],a[104:107],v[68:71]
M v[72:75],a[160:163],a[112:115],v[72:75]
s_nop 0
T a[60:61],v4,40960
T a[62:63],v4,41984
M v[72:75],a[164:167],a[116:119],v[72:75]
M v[76:79],a[164:167],a[124:127],v[76:79]
buffer_load_dwordx4 v11, s[16:19], s21 offen offset:3072  nt lds
M v[76:79],a[160:163],a[120:123],v[76:79]
SA s21,s21,524160
M v[80:83],a[160:163],a[128:131],v[80:83]
M v[80:83],a[164:167],a[132:135],v[80:83]
M v[84:87],a[164:167],a[140:143],v[84:87]
M v[84:87],a[160:163],a[136:139],v[84:87]
M v[88:91],a[160:163],a[144:147],v[88:91]
M v[88:91],a[164:167],a[148:151],v[88:91]
s_waitcnt lgkmcnt(2)
M v[92:95],a[164:167],a[156:159],v[92:95]
s_waitcnt vmcnt(16) lgkmcnt(0)
M v[92:95],a[160:163],a[152:155],v[92:95]
s_barrier
M v[96:99],a[168:171],a[96:99],v[96:99]
R a[160:163],v5,16384
R a[164:167],v6,16384
M v[96:99],a[172:175],a[100:103],v[96:99]
SA m0,s23,131072
M v[100:103],a[172:175],a[108:111],v[100:103]
s_nop 0
T a[64:65],v1,49152
T a[66:67],v1,50176
M v[100:103],a[168:171],a[104:107],v[100:103]
buffer_load_dwordx4 v22, s[56:59], s29 offen offset:0 lds
M v[104:107],a[168:171],a[112:115],v[104:107]
M v[104:107],a[172:175],a[116:119],v[104:107]
M v[108:111],a[172:175],a[124:127],v[108:111]
buffer_load_dwordx4 v23, s[56:59], s29 offen offset:1024 lds
M v[108:111],a[168:171],a[120:123],v[108:111]
M v[112:115],a[168:171],a[128:131],v[112:115]
M v[112:115],a[172:175],a[132:135],v[112:115]
s_nop 0
T a[68:69],v1,57344
T a[70:71],v1,58368
M v[116:119],a[172:175],a[140:143],v[116:119]
buffer_load_dwordx4 v22, s[56:59], s30 offen offset:2048 lds
M v[116:119],a[168:171],a[136:139],v[116:119]
M v[120:123],a[168:171],a[144:147],v[120:123]
M v[120:123],a[172:175],a[148:151],v[120:123]
s_waitcnt lgkmcnt(4)
M v[124:127],a[172:175],a[156:159],v[124:127]
M v[124:127],a[168:171],a[152:155],v[124:127]
buffer_load_dwordx4 v23, s[56:59], s30 offen offset:3072 lds
M v[128:131],a[160:163],a[96:99],v[128:131]
R a[168:171],v5,18432
R a[172:175],v6,18432
M v[128:131],a[164:167],a[100:103],v[128:131]
SA s29,s29,128
T a[72:73],v2,49152
T a[74:75],v2,50176
M v[132:135],a[164:167],a[108:111],v[132:135]
SA s30,s30,128
M v[132:135],a[160:163],a[104:107],v[132:135]
SA m0,s24,0
M v[136:139],a[160:163],a[112:115],v[136:139]
buffer_load_dwordx4 v12, s[48:51], s22 offen offset:0   lds
M v[136:139],a[164:167],a[116:119],v[136:139]
M v[140:143],a[164:167],a[124:127],v[140:143]
M v[140:143],a[160:163],a[120:123],v[140:143]
s_nop 0
T a[76:77],v2,57344
T a[78:79],v2,58368
M v[144:147],a[160:163],a[128:131],v[144:147]
buffer_load_dwordx4 v13, s[48:51], s22 offen offset:1024   lds
M v[144:147],a[164:167],a[132:135],v[144:147]
M v[148:151],a[164:167],a[140:143],v[148:151]
M v[148:151],a[160:163],a[136:139],v[148:151]
M v[152:155],a[160:163],a[144:147],v[152:155]
M v[152:155],a[164:167],a[148:151],v[152:155]
s_waitcnt lgkmcnt(4)
buffer_load_dwordx4 v14, s[48:51], s22 offen offset:2048   lds
M v[156:159],a[164:167],a[156:159],v[156:159]
s_nop 0
T a[80:81],v3,49152
T a[82:83],v3,50176
M v[156:159],a[160:163],a[152:155],v[156:159]
M v[160:163],a[168:171],a[96:99],v[160:163]
R a[160:163],v5,20480
R a[164:167],v6,20480
M v[160:163],a[172:175],a[100:103],v[160:163]
M v[164:167],a[172:175],a[108:111],v[164:167]
buffer_load_dwordx4 v15, s[48:51], s22 offen offset:3072   lds
M v[164:167],a[168:171],a[104:107],v[164:167]
M v[168:171],a[168:171],a[112:115],v[168:171]
M v[168:171],a[172:175],a[116:119],v[168:171]
SA s22,s22,1048576
T a[84:85],v3,57344
T a[86:87],v3,58368
M v[172:175],a[172:175],a[124:127],v[172:175]
SA m0,s23,32768
M v[172:175],a[168:171],a[120:123],v[172:175]
buffer_load_dwordx4 v8, s[16:19], s21 offen offset:0  nt lds
M v[176:179],a[168:171],a[128:131],v[176:179]
M v[176:179],a[172:175],a[132:135],v[176:179]
M v[180:183],a[172:175],a[140:143],v[180:183]
M v[180:183],a[168:171],a[136:139],v[180:183]
buffer_load_dwordx4 v9, s[16:19], s21 offen offset:1024  nt lds
M v[184:187],a[168:171],a[144:147],v[184:187]
s_nop 0
T a[88:89],v4,49152
T a[90:91],v4,50176
M v[184:187],a[172:175],a[148:151],v[184:187]
s_waitcnt lgkmcnt(4)
M v[188:191],a[172:175],a[156:159],v[188:191]
M v[188:191],a[168:171],a[152:155],v[188:191]
M v[192:195],a[160:163],a[96:99],v[192:195]
R a[168:171],v5,22528
R a[172:175],v6,22528
M v[192:195],a[164:167],a[100:103],v[192:195]
buffer_load_dwordx4 v10, s[16:19], s21 offen offset:2048  nt lds
M v[196:199],a[164:167],a[108:111],v[196:199]
M v[196:199],a[160:163],a[104:107],v[196:199]
s_nop 0
T a[92:93],v4,57344
T a[94:95],v4,58368
M v[200:203],a[160:163],a[112:115],v[200:203]
M v[200:203],a[164:167],a[116:119],v[200:203]
buffer_load_dwordx4 v11, s[16:19], s21 offen offset:3072  nt lds
M v[204:207],a[164:167],a[124:127],v[204:207]
M v[204:207],a[160:163],a[120:123],v[204:207]
M v[208:211],a[160:163],a[128:131],v[208:211]
M v[208:211],a[164:167],a[132:135],v[208:211]
M v[212:215],a[164:167],a[140:143],v[212:215]
SA s21,s21,128
M v[212:215],a[160:163],a[136:139],v[212:215]
M v[216:219],a[160:163],a[144:147],v[216:219]
M v[216:219],a[164:167],a[148:151],v[216:219]
s_waitcnt lgkmcnt(2)
M v[220:223],a[164:167],a[156:159],v[220:223]
s_waitcnt vmcnt(20) lgkmcnt(0)
M v[220:223],a[160:163],a[152:155],v[220:223]
s_barrier
M v[224:227],a[168:171],a[96:99],v[224:227]
R a[160:163],v5,32768
R a[164:167],v6,32768
M v[224:227],a[172:175],a[100:103],v[224:227]
M v[228:231],a[172:175],a[108:111],v[228:231]
M v[228:231],a[168:171],a[104:107],v[228:231]
M v[232:235],a[168:171],a[112:115],v[232:235]
M v[232:235],a[172:175],a[116:119],v[232:235]
M v[236:239],a[172:175],a[124:127],v[236:239]
M v[236:239],a[168:171],a[120:123],v[236:239]
M v[240:243],a[168:171],a[128:131],v[240:243]
M v[240:243],a[172:175],a[132:135],v[240:243]
M v[244:247],a[172:175],a[140:143],v[244:247]
M v[244:247],a[168:171],a[136:139],v[244:247]
M v[248:251],a[168:171],a[144:147],v[248:251]
M v[248:251],a[172:175],a[148:151],v[248:251]
s_waitcnt lgkmcnt(0)
M v[252:255],a[172:175],a[156:159],v[252:255]
M v[252:255],a[168:171],a[152:155],v[252:255]
M a[0:3],a[160:163],a[32:35],a[0:3]
R a[168:171],v5,34816
R a[172:175],v6,34816
M a[0:3],a[164:167],a[36:39],a[0:3]
SA m0,s23,147456
T a[96:97],v1,0
T a[98:99],v1,1024
M a[4:7],a[164:167],a[44:47],a[4:7]
buffer_load_dwordx4 v22, s[56:59], s29 offen offset:0 lds
M a[4:7],a[160:163],a[40:43],a[4:7]
M a[8:11],a[160:163],a[48:51],a[8:11]
M a[8:11],a[164:167],a[52:55],a[8:11]
buffer_load_dwordx4 v23, s[56:59], s29 offen offset:1024 lds
M a[12:15],a[164:167],a[60:63],a[12:15]
s_nop 0
T a[100:101],v1,8192
T a[102:103],v1,9216
M a[12:15],a[160:163],a[56:59],a[12:15]
M a[16:19],a[160:163],a[64:67],a[16:19]
buffer_load_dwordx4 v22, s[56:59], s30 offen offset:2048 lds
M a[16:19],a[164:167],a[68:71],a[16:19]
M a[20:23],a[164:167],a[76:79],a[20:23]
M a[20:23],a[160:163],a[72:75],a[20:23]
s_nop 0
T a[104:105],v2,0
T a[106:107],v2,1024
M a[24:27],a[160:163],a[80:83],a[24:27]
buffer_load_dwordx4 v23, s[56:59], s30 offen offset:3072 lds
M a[24:27],a[164:167],a[84:87],a[24:27]
s_waitcnt lgkmcnt(6)
M a[28:31],a[164:167],a[92:95],a[28:31]
SA s29,s29,128
M a[28:31],a[160:163],a[88:91],a[28:31]
SA s30,s30,128
M v[32:35],a[168:171],a[32:35],v[32:35]
SA m0,s24,16384
R a[160:163],v5,36864
R a[164:167],v6,36864
M v[32:35],a[172:175],a[36:39],v[32:35]
T a[108:109],v2,8192
T a[110:111],v2,9216
M v[36:39],a[172:175],a[44:47],v[36:39]
buffer_load_dwordx4 v12, s[48:51], s22 offen offset:0   lds
M v[36:39],a[168:171],a[40:43],v[36:39]
M v[40:43],a[168:171],a[48:51],v[40:43]
M v[40:43],a[172:175],a[52:55],v[40:43]
s_nop 0
T a[112:113],v3,0
T a[114:115],v3,1024
M v[44:47],a[172:175],a[60:63],v[44:47]
buffer_load_dwordx4 v13, s[48:51], s22 offen offset:1024   lds
M v[44:47],a[168:171],a[56:59],v[44:47]
M v[48:51],a[168:171],a[64:67],v[48:51]
M v[48:51],a[172:175],a[68:71],v[48:51]
buffer_load_dwordx4 v14, s[48:51], s22 offen offset:2048   lds
M v[52:55],a[172:175],a[76:79],v[52:55]
s_nop 0
T a[116:117],v3,8192
T a[118:119],v3,9216
L_w_kv16:
s_cbranch_execz L_wd2
M v[52:55],a[168:171],a[72:75],v[52:55]
M v[56:59],a[168:171],a[80:83],v[56:59]
buffer_load_dwordx4 v15, s[48:51], s22 offen offset:3072   lds
M v[56:59],a[172:175],a[84:87],v[56:59]
s_waitcnt lgkmcnt(6)
M v[60:63],a[172:175],a[92:95],v[60:63]
s_sub_u32 s22, s22, 1048448
M v[60:63],a[168:171],a[88:91],v[60:63]
SA m0,s23,49152
T a[120:121],v4,0
T a[122:123],v4,1024
M v[64:67],a[160:163],a[32:35],v[64:67]
R a[168:171],v5,38912
R a[172:175],v6,38912
M v[64:67],a[164:167],a[36:39],v[64:67]
buffer_load_dwordx4 v8, s[16:19], s21 offen offset:0  nt lds
M v[68:71],a[164:167],a[44:47],v[68:71]
M v[68:71],a[160:163],a[40:43],v[68:71]
M v[72:75],a[160:163],a[48:51],v[72:75]
s_waitcnt vmcnt(17)
s_nop 0
T a[124:125],v4,8192
T a[126:127],v4,9216
M v[72:75],a[164:167],a[52:55],v[72:75]
buffer_load_dwordx4 v9, s[16:19], s21 offen offset:1024  nt lds
M v[76:79],a[164:167],a[60:63],v[76:79]
R a[176:179],v20,0
R a[180:183],v20,2048
M v[76:79],a[160:163],a[56:59],v[76:79]
R a[184:187],v21,0
R a[188:191],v21,2048
M v[80:83],a[160:163],a[64:67],v[80:83]
buffer_load_dwordx4 v10, s[16:19], s21 offen offset:2048  nt lds
M v[80:83],a[164:167],a[68:71],v[80:83]
M v[84:87],a[164:167],a[76:79],v[84:87]
M v[84:87],a[160:163],a[72:75],v[84:87]
buffer_load_dwordx4 v11, s[16:19], s21 offen offset:3072  nt lds
M v[88:91],a[160:163],a[80:83],v[88:91]
SA s21,s21,524160
M v[88:91],a[164:167],a[84:87],v[88:91]
s_waitcnt lgkmcnt(6)
M v[92:95],a[164:167],a[92:95],v[92:95]
s_waitcnt lgkmcnt(0)
M v[92:95],a[160:163],a[88:91],v[92:95]
s_barrier
M v[96:99],a[168:171],a[32:35],v[96:99]
s_lshl_b32 s4, s20, 10
R a[160:163],v5,49152
R a[164:167],v6,49152
M v[96:99],a[172:175],a[36:39],v[96:99]
SA m0,s23,131072
v_bfe_u32 v28, v0, 3, 2
M v[100:103],a[172:175],a[44:47],v[100:103]
s_nop 0
T a[128:129],v1,16384
T a[130:131],v1,17408
M v[100:103],a[168:171],a[40:43],v[100:103]
buffer_load_dwordx4 v22, s[56:59], s29 offen offset:0 lds
M v[104:107],a[168:171],a[48:51],v[104:107]
v_lshrrev_b32 v29, 5, v0
v_lshl_add_u32 v28, v29, 3, v28
M v[104:107],a[172:175],a[52:55],v[104:107]
M v[108:111],a[172:175],a[60:63],v[108:111]
buffer_load_dwordx4 v23, s[56:59], s29 offen offset:1024 lds
M v[108:111],a[168:171],a[56:59],v[108:111]
v_lshlrev_b32 v28, 13, v28
M v[112:115],a[168:171],a[64:67],v[112:115]
v_lshrrev_b32 v29, 4, v0
M v[112:115],a[172:175],a[68:71],v[112:115]
s_nop 0
T a[132:133],v1,24576
T a[134:135],v1,25600
M v[116:119],a[172:175],a[76:79],v[116:119]
buffer_load_dwordx4 v22, s[56:59], s30 offen offset:2048 lds
M v[116:119],a[168:171],a[72:75],v[116:119]
v_lshlrev_b32 v29, 1, v29
M v[120:123],a[168:171],a[80:83],v[120:123]
v_and_b32 v30, 7, v0
M v[120:123],a[172:175],a[84:87],v[120:123]
s_waitcnt lgkmcnt(4)
M v[124:127],a[172:175],a[92:95],v[124:127]
v_xor_b32 v29, v29, v30
M v[124:127],a[168:171],a[88:91],v[124:127]
buffer_load_dwordx4 v23, s[56:59], s30 offen offset:3072 lds
M v[128:131],a[160:163],a[32:35],v[128:131]
R a[168:171],v5,51200
R a[172:175],v6,51200
M v[128:131],a[164:167],a[36:39],v[128:131]
SA s29,s29,128
T a[136:137],v2,16384
T a[138:139],v2,17408
M v[132:135],a[164:167],a[44:47],v[132:135]
SA s30,s30,128
v_lshl_add_u32 v28, v29, 4, v28
M v[132:135],a[160:163],a[40:43],v[132:135]
s_and_b32 s64, s20, 1
M v[136:139],a[160:163],a[48:51],v[136:139]
s_lshl_b32 s64, s64, 17
M v[136:139],a[164:167],a[52:55],v[136:139]
s_lshr_b32 s65, s20, 1
M v[140:143],a[164:167],a[60:63],v[140:143]
s_lshl_b32 s65, s65, 15
SA s64,s64,s65
v_add_u32 v8, s64, v28
M v[140:143],a[160:163],a[56:59],v[140:143]
SA m0,s24,32768
T a[140:141],v2,24576
T a[142:143],v2,25600
M v[144:147],a[160:163],a[64:67],v[144:147]
buffer_load_dwordx4 v12, s[48:51], s22 offen offset:0   lds
M v[144:147],a[164:167],a[68:71],v[144:147]
M v[148:151],a[164:167],a[76:79],v[148:151]
M v[148:151],a[160:163],a[72:75],v[148:151]
buffer_load_dwordx4 v13, s[48:51], s22 offen offset:1024   lds
M v[152:155],a[160:163],a[80:83],v[152:155]
M v[152:155],a[164:167],a[84:87],v[152:155]
s_waitcnt lgkmcnt(4)
M v[156:159],a[164:167],a[92:95],v[156:159]
s_nop 0
T a[144:145],v3,16384
T a[146:147],v3,17408
M v[156:159],a[160:163],a[88:91],v[156:159]
buffer_load_dwordx4 v14, s[48:51], s22 offen offset:2048   lds
M v[160:163],a[168:171],a[32:35],v[160:163]
R a[160:163],v5,53248
R a[164:167],v6,53248
M v[160:163],a[172:175],a[36:39],v[160:163]
M v[164:167],a[172:175],a[44:47],v[164:167]
buffer_load_dwordx4 v15, s[48:51], s22 offen offset:3072   lds
M v[164:167],a[168:171],a[40:43],v[164:167]
M v[168:171],a[168:171],a[48:51],v[168:171]
SA s22,s22,1048576
M v[168:171],a[172:175],a[52:55],v[168:171]
s_mov_b32 s25, 0
T a[148:149],v3,24576
T a[150:151],v3,25600
M v[172:175],a[172:175],a[60:63],v[172:175]
SA m0,s4,0
M v[172:175],a[168:171],a[56:59],v[172:175]
buffer_load_dwordx4 v8, s[52:55], s25 offen lds
M v[176:179],a[168:171],a[64:67],v[176:179]
M v[176:179],a[172:175],a[68:71],v[176:179]
s_mov_b32 s25, 262144
M v[180:183],a[172:175],a[76:79],v[180:183]
SA m0,s4,4096
M v[180:183],a[168:171],a[72:75],v[180:183]
buffer_load_dwordx4 v8, s[52:55], s25 offen lds
M v[184:187],a[168:171],a[80:83],v[184:187]
s_nop 0
T a[152:153],v4,16384
T a[154:155],v4,17408
M v[184:187],a[172:175],a[84:87],v[184:187]
s_waitcnt lgkmcnt(4)
M v[188:191],a[172:175],a[92:95],v[188:191]
s_mov_b32 s25, 524288
M v[188:191],a[168:171],a[88:91],v[188:191]
SA m0,s4,8192
M v[192:195],a[160:163],a[32:35],v[192:195]
R a[168:171],v5,55296
R a[172:175],v6,55296
M v[192:195],a[164:167],a[36:39],v[192:195]
buffer_load_dwordx4 v8, s[52:55], s25 offen lds
M v[196:199],a[164:167],a[44:47],v[196:199]
M v[196:199],a[160:163],a[40:43],v[196:199]
s_mov_b32 s25, 786432
T a[156:157],v4,24576
T a[158:159],v4,25600
M v[200:203],a[160:163],a[48:51],v[200:203]
SA m0,s4,12288
M v[200:203],a[164:167],a[52:55],v[200:203]
s_waitcnt vmcnt(19)
buffer_load_dwordx4 v8, s[52:55], s25 offen lds
M v[204:207],a[164:167],a[60:63],v[204:207]
R a[192:195],v20,16384
R a[196:199],v20,18432
M v[204:207],a[160:163],a[56:59],v[204:207]
R a[200:203],v21,16384
R a[204:207],v21,18432
M v[208:211],a[160:163],a[64:67],v[208:211]
M v[208:211],a[164:167],a[68:71],v[208:211]
M v[212:215],a[164:167],a[76:79],v[212:215]
M v[212:215],a[160:163],a[72:75],v[212:215]
M v[216:219],a[160:163],a[80:83],v[216:219]
M v[216:219],a[164:167],a[84:87],v[216:219]
s_waitcnt lgkmcnt(6)
M v[220:223],a[164:167],a[92:95],v[220:223]
s_waitcnt lgkmcnt(0)
M v[220:223],a[160:163],a[88:91],v[220:223]
s_barrier
M v[224:227],a[168:171],a[32:35],v[224:227]
R a[160:163],v5,0
R a[164:167],v6,0
M v[224:227],a[172:175],a[36:39],v[224:227]
M v[228:231],a[172:175],a[44:47],v[228:231]
M v[228:231],a[168:171],a[40:43],v[228:231]
M v[232:235],a[168:171],a[48:51],v[232:235]
M v[232:235],a[172:175],a[52:55],v[232:235]
M v[236:239],a[172:175],a[60:63],v[236:239]
M v[236:239],a[168:171],a[56:59],v[236:239]
M v[240:243],a[168:171],a[64:67],v[240:243]
M v[240:243],a[172:175],a[68:71],v[240:243]
M v[244:247],a[172:175],a[76:79],v[244:247]
M v[244:247],a[168:171],a[72:75],v[244:247]
M v[248:251],a[168:171],a[80:83],v[248:251]
M v[248:251],a[172:175],a[84:87],v[248:251]
s_waitcnt lgkmcnt(0)
M v[252:255],a[172:175],a[92:95],v[252:255]
M v[252:255],a[168:171],a[88:91],v[252:255]
M a[0:3],a[160:163],a[96:99],a[0:3]
R a[168:171],v5,2048
R a[172:175],v6,2048
M a[0:3],a[164:167],a[100:103],a[0:3]
SA m0,s23,147456
T a[32:33],v1,32768
T a[34:35],v1,33792
M a[4:7],a[164:167],a[108:111],a[4:7]
buffer_load_dwordx4 v22, s[56:59], s29 offen offset:0 lds
M a[4:7],a[160:163],a[104:107],a[4:7]
M a[8:11],a[160:163],a[112:115],a[8:11]
M a[8:11],a[164:167],a[116:119],a[8:11]
buffer_load_dwordx4 v23, s[56:59], s29 offen offset:1024 lds
M a[12:15],a[164:167],a[124:127],a[12:15]
s_nop 0
T a[36:37],v1,40960
T a[38:39],v1,41984
M a[12:15],a[160:163],a[120:123],a[12:15]
M a[16:19],a[160:163],a[128:131],a[16:19]
buffer_load_dwordx4 v22, s[56:59], s30 offen offset:2048 lds
M a[16:19],a[164:167],a[132:135],a[16:19]
M a[20:23],a[164:167],a[140:143],a[20:23]
M a[20:23],a[160:163],a[136:139],a[20:23]
s_nop 0
T a[40:41],v2,32768
T a[42:43],v2,33792
M a[24:27],a[160:163],a[144:147],a[24:27]
buffer_load_dwordx4 v23, s[56:59], s30 offen offset:3072 lds
M a[24:27],a[164:167],a[148:151],a[24:27]
s_waitcnt lgkmcnt(6)
M a[28:31],a[164:167],a[156:159],a[28:31]
SA s29,s29,128
M a[28:31],a[160:163],a[152:155],a[28:31]
SA s30,s30,128
M v[32:35],a[168:171],a[96:99],v[32:35]
SA m0,s24,49152
R a[160:163],v5,4096
R a[164:167],v6,4096
M v[32:35],a[172:175],a[100:103],v[32:35]
T a[44:45],v2,40960
T a[46:47],v2,41984
M v[36:39],a[172:175],a[108:111],v[36:39]
buffer_load_dwordx4 v12, s[48:51], s22 offen offset:0   lds
M v[36:39],a[168:171],a[104:107],v[36:39]
M v[40:43],a[168:171],a[112:115],v[40:43]
M v[40:43],a[172:175],a[116:119],v[40:43]
s_nop 0
T a[48:49],v3,32768
T a[50:51],v3,33792
M v[44:47],a[172:175],a[124:127],v[44:47]
buffer_load_dwordx4 v13, s[48:51], s22 offen offset:1024   lds
M v[44:47],a[168:171],a[120:123],v[44:47]
M v[48:51],a[168:171],a[128:131],v[48:51]
M v[48:51],a[172:175],a[132:135],v[48:51]
buffer_load_dwordx4 v14, s[48:51], s22 offen offset:2048   lds
M v[52:55],a[172:175],a[140:143],v[52:55]
s_nop 0
T a[52:53],v3,40960
T a[54:55],v3,41984
M v[52:55],a[168:171],a[136:139],v[52:55]
M v[56:59],a[168:171],a[144:147],v[56:59]
buffer_load_dwordx4 v15, s[48:51], s22 offen offset:3072   lds
M v[56:59],a[172:175],a[148:151],v[56:59]
s_waitcnt lgkmcnt(6)
M v[60:63],a[172:175],a[156:159],v[60:63]
s_sub_u32 s22, s22, 1048448
M v[60:63],a[168:171],a[152:155],v[60:63]
s_mov_b32 s25, 1048576
T a[56:57],v4,32768
T a[58:59],v4,33792
M v[64:67],a[160:163],a[96:99],v[64:67]
SA m0,s4,16384
R a[168:171],v5,6144
R a[172:175],v6,6144
M v[64:67],a[164:167],a[100:103],v[64:67]
buffer_load_dwordx4 v8, s[52:55], s25 offen lds
M v[68:71],a[164:167],a[108:111],v[68:71]
s_mov_b32 s25, 1310720
M v[68:71],a[160:163],a[104:107],v[68:71]
SA m0,s4,20480
M v[72:75],a[160:163],a[112:115],v[72:75]
s_waitcnt vmcnt(17)
s_nop 0
T a[60:61],v4,40960
T a[62:63],v4,41984
M v[72:75],a[164:167],a[116:119],v[72:75]
buffer_load_dwordx4 v8, s[52:55], s25 offen lds
M v[76:79],a[164:167],a[124:127],v[76:79]
s_mov_b32 s25, 1572864
R a[208:211],v20,0
R a[212:215],v20,2048
M v[76:79],a[160:163],a[120:123],v[76:79]
SA m0,s4,24576
R a[216:219],v21,0
R a[220:223],v21,2048
M v[80:83],a[160:163],a[128:131],v[80:83]
buffer_load_dwordx4 v8, s[52:55], s25 offen lds
M v[80:83],a[164:167],a[132:135],v[80:83]
s_mov_b32 s25, 1835008
M v[84:87],a[164:167],a[140:143],v[84:87]
SA m0,s4,28672
M v[84:87],a[160:163],a[136:139],v[84:87]
buffer_load_dwordx4 v8, s[52:55], s25 offen lds
M v[88:91],a[160:163],a[144:147],v[88:91]
M v[88:91],a[164:167],a[148:151],v[88:91]
s_waitcnt lgkmcnt(6)
M v[92:95],a[164:167],a[156:159],v[92:95]
s_waitcnt lgkmcnt(0)
M v[92:95],a[160:163],a[152:155],v[92:95]
s_barrier
M v[96:99],a[168:171],a[96:99],v[96:99]
R a[160:163],v5,16384
R a[164:167],v6,16384
M v[96:99],a[172:175],a[100:103],v[96:99]
SA m0,s23,32768
M v[100:103],a[172:175],a[108:111],v[100:103]
s_nop 0
T a[64:65],v1,49152
T a[66:67],v1,50176
M v[100:103],a[168:171],a[104:107],v[100:103]
buffer_load_dwordx4 v22, s[56:59], s29 offen offset:0 lds
M v[104:107],a[168:171],a[112:115],v[104:107]
v_lshrrev_b32 v28, 2, v0
v_lshlrev_b32 v28, 7, v28
M v[104:107],a[172:175],a[116:119],v[104:107]
M v[108:111],a[172:175],a[124:127],v[108:111]
buffer_load_dwordx4 v23, s[56:59], s29 offen offset:1024 lds
M v[108:111],a[168:171],a[120:123],v[108:111]
v_and_b32 v29, 3, v0
M v[112:115],a[168:171],a[128:131],v[112:115]
v_lshl_add_u32 v28, v29, 3, v28
M v[112:115],a[172:175],a[132:135],v[112:115]
s_nop 0
T a[68:69],v1,57344
T a[70:71],v1,58368
M v[116:119],a[172:175],a[140:143],v[116:119]
buffer_load_dwordx4 v22, s[56:59], s30 offen offset:2048 lds
M v[116:119],a[168:171],a[136:139],v[116:119]
v_bfe_u32 v29, v0, 3, 2
M v[120:123],a[168:171],a[144:147],v[120:123]
M v[120:123],a[172:175],a[148:151],v[120:123]
s_waitcnt lgkmcnt(4)
v_lshl_add_u32 v16, v29, 5, v28
M v[124:127],a[172:175],a[156:159],v[124:127]
M v[124:127],a[168:171],a[152:155],v[124:127]
buffer_load_dwordx4 v23, s[56:59], s30 offen offset:3072 lds
M v[128:131],a[160:163],a[96:99],v[128:131]
R a[168:171],v5,18432
R a[172:175],v6,18432
M v[128:131],a[164:167],a[100:103],v[128:131]
SA s29,s29,128
T a[72:73],v2,49152
T a[74:75],v2,50176
M v[132:135],a[164:167],a[108:111],v[132:135]
SA s30,s30,128
v_xor_b32 v17, 32, v16
v_xor_b32 v18, 64, v16
M v[132:135],a[160:163],a[104:107],v[132:135]
SA m0,s23,65536
M v[136:139],a[160:163],a[112:115],v[136:139]
buffer_load_dwordx4 v22, s[56:59], s29 offen offset:0 lds
M v[136:139],a[164:167],a[116:119],v[136:139]
v_xor_b32 v19, 0x60, v16
M v[140:143],a[164:167],a[124:127],v[140:143]
v_add_u32 v12, 0x20000, v16
M v[140:143],a[160:163],a[120:123],v[140:143]
s_nop 0
T a[76:77],v2,57344
T a[78:79],v2,58368
M v[144:147],a[160:163],a[128:131],v[144:147]
buffer_load_dwordx4 v23, s[56:59], s29 offen offset:1024 lds
M v[144:147],a[164:167],a[132:135],v[144:147]
v_add_u32 v13, 0x20000, v17
M v[148:151],a[164:167],a[140:143],v[148:151]
M v[148:151],a[160:163],a[136:139],v[148:151]
v_add_u32 v14, 0x20000, v18
M v[152:155],a[160:163],a[144:147],v[152:155]
M v[152:155],a[164:167],a[148:151],v[152:155]
s_waitcnt lgkmcnt(4)
buffer_load_dwordx4 v22, s[56:59], s30 offen offset:2048 lds
M v[156:159],a[164:167],a[156:159],v[156:159]
s_nop 0
T a[80:81],v3,49152
T a[82:83],v3,50176
M v[156:159],a[160:163],a[152:155],v[156:159]
v_add_u32 v15, 0x20000, v19
M v[160:163],a[168:171],a[96:99],v[160:163]
R a[160:163],v5,20480
R a[164:167],v6,20480
M v[160:163],a[172:175],a[100:103],v[160:163]
M v[164:167],a[172:175],a[108:111],v[164:167]
buffer_load_dwordx4 v23, s[56:59], s30 offen offset:3072 lds
M v[164:167],a[168:171],a[104:107],v[164:167]
SA s29,s29,128
M v[168:171],a[168:171],a[112:115],v[168:171]
SA s30,s30,128
M v[168:171],a[172:175],a[116:119],v[168:171]
s_mov_b32 s25, 2097152
T a[84:85],v3,57344
T a[86:87],v3,58368
M v[172:175],a[172:175],a[124:127],v[172:175]
SA m0,s4,131072
M v[172:175],a[168:171],a[120:123],v[172:175]
buffer_load_dwordx4 v8, s[52:55], s25 offen lds
M v[176:179],a[168:171],a[128:131],v[176:179]
M v[176:179],a[172:175],a[132:135],v[176:179]
s_mov_b32 s25, 2359296
M v[180:183],a[172:175],a[140:143],v[180:183]
SA m0,s4,135168
M v[180:183],a[168:171],a[136:139],v[180:183]
buffer_load_dwordx4 v8, s[52:55], s25 offen lds
M v[184:187],a[168:171],a[144:147],v[184:187]
s_nop 0
T a[88:89],v4,49152
T a[90:91],v4,50176
M v[184:187],a[172:175],a[148:151],v[184:187]
s_waitcnt lgkmcnt(4)
M v[188:191],a[172:175],a[156:159],v[188:191]
s_mov_b32 s25, 2621440
M v[188:191],a[168:171],a[152:155],v[188:191]
SA m0,s4,139264
M v[192:195],a[160:163],a[96:99],v[192:195]
R a[168:171],v5,22528
R a[172:175],v6,22528
M v[192:195],a[164:167],a[100:103],v[192:195]
buffer_load_dwordx4 v8, s[52:55], s25 offen lds
M v[196:199],a[164:167],a[108:111],v[196:199]
M v[196:199],a[160:163],a[104:107],v[196:199]
s_mov_b32 s25, 2883584
T a[92:93],v4,57344
T a[94:95],v4,58368
M v[200:203],a[160:163],a[112:115],v[200:203]
SA m0,s4,143360
M v[200:203],a[164:167],a[116:119],v[200:203]
s_waitcnt vmcnt(19)
buffer_load_dwordx4 v8, s[52:55], s25 offen lds
M v[204:207],a[164:167],a[124:127],v[204:207]
R a[224:227],v20,16384
R a[228:231],v20,18432
M v[204:207],a[160:163],a[120:123],v[204:207]
R a[232:235],v21,16384
R a[236:239],v21,18432
M v[208:211],a[160:163],a[128:131],v[208:211]
v_subrev_u32 v20, 98304, v20
v_subrev_u32 v21, 98304, v21
M v[208:211],a[164:167],a[132:135],v[208:211]
M v[212:215],a[164:167],a[140:143],v[212:215]
M v[212:215],a[160:163],a[136:139],v[212:215]
M v[216:219],a[160:163],a[144:147],v[216:219]
M v[216:219],a[164:167],a[148:151],v[216:219]
s_waitcnt lgkmcnt(6)
M v[220:223],a[164:167],a[156:159],v[220:223]
s_waitcnt lgkmcnt(0)
M v[220:223],a[160:163],a[152:155],v[220:223]
s_barrier
M v[224:227],a[168:171],a[96:99],v[224:227]
R a[160:163],v5,32768
R a[164:167],v6,32768
M v[224:227],a[172:175],a[100:103],v[224:227]
M v[228:231],a[172:175],a[108:111],v[228:231]
M v[228:231],a[168:171],a[104:107],v[228:231]
M v[232:235],a[168:171],a[112:115],v[232:235]
M v[232:235],a[172:175],a[116:119],v[232:235]
M v[236:239],a[172:175],a[124:127],v[236:239]
M v[236:239],a[168:171],a[120:123],v[236:239]
M v[240:243],a[168:171],a[128:131],v[240:243]
M v[240:243],a[172:175],a[132:135],v[240:243]
M v[244:247],a[172:175],a[140:143],v[244:247]
M v[244:247],a[168:171],a[136:139],v[244:247]
M v[248:251],a[168:171],a[144:147],v[248:251]
M v[248:251],a[172:175],a[148:151],v[248:251]
s_waitcnt lgkmcnt(0)
M v[252:255],a[172:175],a[156:159],v[252:255]
M v[252:255],a[168:171],a[152:155],v[252:255]
M a[0:3],a[160:163],a[32:35],a[0:3]
R a[168:171],v5,34816
R a[172:175],v6,34816
M a[0:3],a[164:167],a[36:39],a[0:3]
SA m0,s23,81920
M a[4:7],a[164:167],a[44:47],a[4:7]
buffer_load_dwordx4 v22, s[56:59], s29 offen offset:0 lds
M a[4:7],a[160:163],a[40:43],a[4:7]
M a[8:11],a[160:163],a[48:51],a[8:11]
M a[8:11],a[164:167],a[52:55],a[8:11]
buffer_load_dwordx4 v23, s[56:59], s29 offen offset:1024 lds
M a[12:15],a[164:167],a[60:63],a[12:15]
M a[12:15],a[160:163],a[56:59],a[12:15]
M a[16:19],a[160:163],a[64:67],a[16:19]
M a[16:19],a[164:167],a[68:71],a[16:19]
buffer_load_dwordx4 v22, s[56:59], s30 offen offset:2048 lds
M a[20:23],a[164:167],a[76:79],a[20:23]
M a[20:23],a[160:163],a[72:75],a[20:23]
M a[24:27],a[160:163],a[80:83],a[24:27]
M a[24:27],a[164:167],a[84:87],a[24:27]
s_waitcnt lgkmcnt(0)
buffer_load_dwordx4 v23, s[56:59], s30 offen offset:3072 lds
M a[28:31],a[164:167],a[92:95],a[28:31]
SA s29,s29,128
M a[28:31],a[160:163],a[88:91],a[28:31]
SA s30,s30,128
M v[32:35],a[168:171],a[32:35],v[32:35]
s_mov_b32 s25, 3145728
R a[160:163],v5,36864
R a[164:167],v6,36864
M v[32:35],a[172:175],a[36:39],v[32:35]
SA m0,s4,147456
M v[36:39],a[172:175],a[44:47],v[36:39]
buffer_load_dwordx4 v8, s[52:55], s25 offen lds
M v[36:39],a[168:171],a[40:43],v[36:39]
s_mov_b32 s25, 3407872
M v[40:43],a[168:171],a[48:51],v[40:43]
SA m0,s4,151552
M v[40:43],a[172:175],a[52:55],v[40:43]
buffer_load_dwordx4 v8, s[52:55], s25 offen lds
M v[44:47],a[172:175],a[60:63],v[44:47]
G v24,a0
G v25,a1
M v[44:47],a[168:171],a[56:59],v[44:47]
s_mov_b32 s25, 128
G v26,a2
G v27,a3
M v[48:51],a[168:171],a[64:67],v[48:51]
SA m0,s4,49152
C v24,v24,v25
C v25,v26,v27
M v[48:51],a[172:175],a[68:71],v[48:51]
buffer_load_dwordx4 v8, s[52:55], s25 offen lds
M v[52:55],a[172:175],a[76:79],v[52:55]
C v26,v32,v33
C v27,v34,v35
M v[52:55],a[168:171],a[72:75],v[52:55]
SA s3,s93,0
M v[56:59],a[168:171],a[80:83],v[56:59]
s_mov_b32 s25, 262272
buffer_store_dwordx4 v[24:27], v7, s[8:11], s3 offen offset:0 sc1
M v[56:59],a[172:175],a[84:87],v[56:59]
L_w_kv17:
s_cbranch_execz L_wd2
s_waitcnt lgkmcnt(0)
G v28,a4
G v29,a5
M v[60:63],a[172:175],a[92:95],v[60:63]
SA m0,s4,53248
G v30,a6
G v31,a7
M v[60:63],a[168:171],a[88:91],v[60:63]
s_waitcnt vmcnt(16)
buffer_load_dwordx4 v8, s[52:55], s25 offen lds
M v[64:67],a[160:163],a[32:35],v[64:67]
s_mov_b32 s25, 524416
R a[168:171],v5,38912
R a[172:175],v6,38912
M v[64:67],a[164:167],a[36:39],v[64:67]
SA m0,s4,57344
C v28,v28,v29
C v29,v30,v31
M v[68:71],a[164:167],a[44:47],v[68:71]
buffer_load_dwordx4 v8, s[52:55], s25 offen lds
M v[68:71],a[160:163],a[40:43],v[68:71]
s_mov_b32 s25, 786560
C v30,v36,v37
C v31,v38,v39
M v[72:75],a[160:163],a[48:51],v[72:75]
SA m0,s4,61440
buffer_store_dwordx4 v[28:31], v7, s[8:11], s3 offen offset:2048 sc1
M v[72:75],a[164:167],a[52:55],v[72:75]
G v24,a8
G v25,a9
M v[76:79],a[164:167],a[60:63],v[76:79]
G v26,a10
G v27,a11
M v[76:79],a[160:163],a[56:59],v[76:79]
buffer_load_dwordx4 v8, s[52:55], s25 offen lds
M v[80:83],a[160:163],a[64:67],v[80:83]
C v24,v24,v25
C v25,v26,v27
M v[80:83],a[164:167],a[68:71],v[80:83]
C v26,v40,v41
C v27,v42,v43
M v[84:87],a[164:167],a[76:79],v[84:87]
SA s3,s93,4096
buffer_store_dwordx4 v[24:27], v7, s[8:11], s3 offen offset:0 sc1
M v[84:87],a[160:163],a[72:75],v[84:87]
R a[96:99],v20,0
R a[100:103],v20,2048
M v[88:91],a[160:163],a[80:83],v[88:91]
R a[104:107],v21,0
R a[108:111],v21,2048
M v[88:91],a[164:167],a[84:87],v[88:91]
s_waitcnt lgkmcnt(4)
G v28,a12
G v29,a13
M v[92:95],a[164:167],a[92:95],v[92:95]
s_waitcnt lgkmcnt(0)
G v30,a14
G v31,a15
M v[92:95],a[160:163],a[88:91],v[92:95]
s_barrier
M v[96:99],a[168:171],a[32:35],v[96:99]
R a[160:163],v5,49152
R a[164:167],v6,49152
M v[96:99],a[172:175],a[36:39],v[96:99]
s_mov_b32 s25, 1048704
C v28,v28,v29
C v29,v30,v31
M v[100:103],a[172:175],a[44:47],v[100:103]
SA m0,s4,98304
C v30,v44,v45
C v31,v46,v47
M v[100:103],a[168:171],a[40:43],v[100:103]
s_waitcnt vmcnt(17)
buffer_store_dwordx4 v[28:31], v7, s[8:11], s3 offen offset:2048 sc1
M v[104:107],a[168:171],a[48:51],v[104:107]
G v24,a16
G v25,a17
M v[104:107],a[172:175],a[52:55],v[104:107]
G v26,a18
G v27,a19
M v[108:111],a[172:175],a[60:63],v[108:111]
buffer_load_dwordx4 v8, s[52:55], s25 offen lds
M v[108:111],a[168:171],a[56:59],v[108:111]
C v24,v24,v25
C v25,v26,v27
M v[112:115],a[168:171],a[64:67],v[112:115]
C v26,v48,v49
C v27,v50,v51
M v[112:115],a[172:175],a[68:71],v[112:115]
SA s3,s93,8192
buffer_store_dwordx4 v[24:27], v7, s[8:11], s3 offen offset:0 sc1
M v[116:119],a[172:175],a[76:79],v[116:119]
s_mov_b32 s25, 1310848
R a[112:115],v20,32768
R a[116:119],v20,34816
M v[116:119],a[168:171],a[72:75],v[116:119]
SA m0,s4,102400
R a[120:123],v21,32768
R a[124:127],v21,34816
M v[120:123],a[168:171],a[80:83],v[120:123]
C v64,v64,v65
C v65,v66,v67
M v[120:123],a[172:175],a[84:87],v[120:123]
s_waitcnt lgkmcnt(4)
buffer_load_dwordx4 v8, s[52:55], s25 offen lds
M v[124:127],a[172:175],a[92:95],v[124:127]
C v66,v96,v97
C v67,v98,v99
M v[124:127],a[168:171],a[88:91],v[124:127]
G v28,a20
G v29,a21
M v[128:131],a[160:163],a[32:35],v[128:131]
R a[168:171],v5,51200
R a[172:175],v6,51200
M v[128:131],a[164:167],a[36:39],v[128:131]
G v30,a22
G v31,a23
M v[132:135],a[164:167],a[44:47],v[132:135]
C v28,v28,v29
C v29,v30,v31
M v[132:135],a[160:163],a[40:43],v[132:135]
s_mov_b32 s25, 1572992
C v30,v52,v53
C v31,v54,v55
M v[136:139],a[160:163],a[48:51],v[136:139]
SA m0,s4,106496
buffer_store_dwordx4 v[28:31], v7, s[8:11], s3 offen offset:2048 sc1
M v[136:139],a[164:167],a[52:55],v[136:139]
C v68,v68,v69
C v69,v70,v71
M v[140:143],a[164:167],a[60:63],v[140:143]
C v70,v100,v101
C v71,v102,v103
M v[140:143],a[160:163],a[56:59],v[140:143]
C v72,v72,v73
C v73,v74,v75
M v[144:147],a[160:163],a[64:67],v[144:147]
buffer_load_dwordx4 v8, s[52:55], s25 offen lds
M v[144:147],a[164:167],a[68:71],v[144:147]
C v74,v104,v105
C v75,v106,v107
M v[148:151],a[164:167],a[76:79],v[148:151]
C v76,v76,v77
C v77,v78,v79
M v[148:151],a[160:163],a[72:75],v[148:151]
C v78,v108,v109
C v79,v110,v111
M v[152:155],a[160:163],a[80:83],v[152:155]
C v80,v80,v81
C v81,v82,v83
M v[152:155],a[164:167],a[84:87],v[152:155]
s_waitcnt lgkmcnt(0)
C v82,v112,v113
C v83,v114,v115
M v[156:159],a[164:167],a[92:95],v[156:159]
s_mov_b32 s25, 1835136
C v84,v84,v85
C v85,v86,v87
M v[156:159],a[160:163],a[88:91],v[156:159]
SA m0,s4,110592
C v86,v116,v117
C v87,v118,v119
M v[160:163],a[168:171],a[32:35],v[160:163]
R a[160:163],v5,53248
R a[164:167],v6,53248
M v[160:163],a[172:175],a[36:39],v[160:163]
buffer_load_dwordx4 v8, s[52:55], s25 offen lds
M v[164:167],a[172:175],a[44:47],v[164:167]
G v24,a24
G v25,a25
M v[164:167],a[168:171],a[40:43],v[164:167]
G v26,a26
G v27,a27
M v[168:171],a[168:171],a[48:51],v[168:171]
C v24,v24,v25
C v25,v26,v27
M v[168:171],a[172:175],a[52:55],v[168:171]
C v26,v56,v57
C v27,v58,v59
M v[172:175],a[172:175],a[60:63],v[172:175]
SA s3,s93,12288
buffer_store_dwordx4 v[24:27], v7, s[8:11], s3 offen offset:0 sc1
M v[172:175],a[168:171],a[56:59],v[172:175]
C v88,v88,v89
C v89,v90,v91
M v[176:179],a[168:171],a[64:67],v[176:179]
C v90,v120,v121
C v91,v122,v123
M v[176:179],a[172:175],a[68:71],v[176:179]
C v92,v92,v93
C v93,v94,v95
M v[180:183],a[172:175],a[76:79],v[180:183]
C v94,v124,v125
C v95,v126,v127
M v[180:183],a[168:171],a[72:75],v[180:183]
G v28,a28
G v29,a29
M v[184:187],a[168:171],a[80:83],v[184:187]
G v30,a30
G v31,a31
M v[184:187],a[172:175],a[84:87],v[184:187]
s_waitcnt lgkmcnt(0)
C v28,v28,v29
C v29,v30,v31
M v[188:191],a[172:175],a[92:95],v[188:191]
C v30,v60,v61
C v31,v62,v63
M v[188:191],a[168:171],a[88:91],v[188:191]
buffer_store_dwordx4 v[28:31], v7, s[8:11], s3 offen offset:2048 sc1
M v[192:195],a[160:163],a[32:35],v[192:195]
s_waitcnt vmcnt(18)
R a[168:171],v5,55296
R a[172:175],v6,55296
M v[192:195],a[164:167],a[36:39],v[192:195]
C v128,v128,v129
C v129,v130,v131
M v[196:199],a[164:167],a[44:47],v[196:199]
C v130,v160,v161
C v131,v162,v163
M v[196:199],a[160:163],a[40:43],v[196:199]
C v132,v132,v133
C v133,v134,v135
M v[200:203],a[160:163],a[48:51],v[200:203]
C v134,v164,v165
C v135,v166,v167
M v[200:203],a[164:167],a[52:55],v[200:203]
C v136,v136,v137
C v137,v138,v139
M v[204:207],a[164:167],a[60:63],v[204:207]
C v138,v168,v169
C v139,v170,v171
M v[204:207],a[160:163],a[56:59],v[204:207]
C v140,v140,v141
C v141,v142,v143
M v[208:211],a[160:163],a[64:67],v[208:211]
C v142,v172,v173
C v143,v174,v175
M v[208:211],a[164:167],a[68:71],v[208:211]
C v144,v144,v145
C v145,v146,v147
M v[212:215],a[164:167],a[76:79],v[212:215]
R a[128:131],v20,49152
R a[132:135],v20,51200
R a[136:139],v21,49152
R a[140:143],v21,51200
M v[212:215],a[160:163],a[72:75],v[212:215]
C v146,v176,v177
C v147,v178,v179
M v[216:219],a[160:163],a[80:83],v[216:219]
C v148,v148,v149
C v149,v150,v151
M v[216:219],a[164:167],a[84:87],v[216:219]
s_waitcnt lgkmcnt(4)
C v150,v180,v181
C v151,v182,v183
M v[220:223],a[164:167],a[92:95],v[220:223]
s_waitcnt vmcnt(16) lgkmcnt(0)
C v152,v152,v153
C v153,v154,v155
M v[220:223],a[160:163],a[88:91],v[220:223]
s_barrier
M v[224:227],a[168:171],a[32:35],v[224:227]
s_nop 0
T v[32:33],v16,0
T v[34:35],v16,2048
M v[224:227],a[172:175],a[36:39],v[224:227]
C v154,v184,v185
C v155,v186,v187
M v[228:231],a[172:175],a[44:47],v[228:231]
T v[36:37],v16,4096
T v[38:39],v16,6144
M v[228:231],a[168:171],a[40:43],v[228:231]
T v[40:41],v16,8192
T v[42:43],v16,10240
M v[232:235],a[168:171],a[48:51],v[232:235]
C v156,v156,v157
C v157,v158,v159
M v[232:235],a[172:175],a[52:55],v[232:235]
T v[44:45],v16,12288
T v[46:47],v16,14336
M v[236:239],a[172:175],a[60:63],v[236:239]
T v[48:49],v16,16384
T v[50:51],v16,18432
M v[236:239],a[168:171],a[56:59],v[236:239]
C v158,v188,v189
C v159,v190,v191
M v[240:243],a[168:171],a[64:67],v[240:243]
T v[52:53],v16,20480
T v[54:55],v16,22528
M v[240:243],a[172:175],a[68:71],v[240:243]
T v[56:57],v16,24576
T v[58:59],v16,26624
M v[244:247],a[172:175],a[76:79],v[244:247]
C v192,v192,v193
C v193,v194,v195
M v[244:247],a[168:171],a[72:75],v[244:247]
C v194,v224,v225
C v195,v226,v227
M v[248:251],a[168:171],a[80:83],v[248:251]
C v196,v196,v197
C v197,v198,v199
M v[248:251],a[172:175],a[84:87],v[248:251]
C v198,v228,v229
C v199,v230,v231
M v[252:255],a[172:175],a[92:95],v[252:255]
C v200,v200,v201
C v201,v202,v203
M v[252:255],a[168:171],a[88:91],v[252:255]
s_waitcnt lgkmcnt(6)
C v202,v232,v233
C v203,v234,v235
M v[96:99],v[32:35],a[176:179],0
s_mul_i32 s72, s41, 4352
T a[144:145],v17,0
T a[146:147],v17,2048
M v[96:99],v[36:39],a[184:187],v[96:99]
SA s46,s72,104923136
C v204,v204,v205
C v205,v206,v207
M v[96:99],v[40:43],a[192:195],v[96:99]
s_waitcnt lgkmcnt(2)
T a[148:149],v17,4096
T a[150:151],v17,6144
M v[96:99],v[44:47],a[200:203],v[96:99]
s_mov_b32 s25, 2097280
T a[152:153],v17,8192
T a[154:155],v17,10240
M v[96:99],v[48:51],a[208:211],v[96:99]
SA m0,s4,114688
C v206,v236,v237
C v207,v238,v239
M v[96:99],v[52:55],a[216:219],v[96:99]
s_lshl_b32 s45, s42, 7
T a[156:157],v17,12288
T a[158:159],v17,14336
M v[96:99],v[56:59],a[224:227],v[96:99]
SA s45,s45,s46
T a[160:161],v17,16384
T a[162:163],v17,18432
M v[100:103],v[56:59],a[228:231],0
s_lshl_b32 s72, s20, 2
buffer_load_dwordx4 v8, s[52:55], s25 offen lds
M v[100:103],v[52:55],a[220:223],v[100:103]
SA s72,s72,s45
T a[164:165],v17,20480
T a[166:167],v17,22528
M v[100:103],v[48:51],a[212:215],v[100:103]
T a[168:169],v17,24576
T a[170:171],v17,26624
M v[100:103],v[44:47],a[204:207],v[100:103]
s_mov_b32 s25, 2359424
C v208,v208,v209
C v209,v210,v211
M v[100:103],v[40:43],a[196:199],v[100:103]
SA m0,s4,118784
C v210,v240,v241
C v211,v242,v243
M v[100:103],v[36:39],a[188:191],v[100:103]
buffer_load_dwordx4 v8, s[52:55], s25 offen lds
M v[100:103],v[32:35],a[180:183],v[100:103]
s_waitcnt lgkmcnt(6)
C v212,v212,v213
C v213,v214,v215
M v[104:107],a[144:147],a[176:179],0
T v[32:33],v18,0
T v[34:35],v18,2048
M v[104:107],a[148:151],a[184:187],v[104:107]
s_mov_b32 s25, 2621568
C v214,v244,v245
C v215,v246,v247
M v[104:107],a[152:155],a[192:195],v[104:107]
s_waitcnt lgkmcnt(2)
T v[36:37],v18,4096
T v[38:39],v18,6144
M v[104:107],a[156:159],a[200:203],v[104:107]
SA m0,s4,122880
T v[40:41],v18,8192
T v[42:43],v18,10240
M v[104:107],a[160:163],a[208:211],v[104:107]
buffer_load_dwordx4 v8, s[52:55], s25 offen lds
M v[104:107],a[164:167],a[216:219],v[104:107]
s_nop 0
T v[44:45],v18,12288
T v[46:47],v18,14336
M v[104:107],a[168:171],a[224:227],v[104:107]
T v[48:49],v18,16384
T v[50:51],v18,18432
M v[108:111],a[168:171],a[228:231],0
s_mov_b32 s25, 2883712
C v216,v216,v217
C v217,v218,v219
M v[108:111],a[164:167],a[220:223],v[108:111]
SA m0,s4,126976
T v[52:53],v18,20480
T v[54:55],v18,22528
M v[108:111],a[160:163],a[212:215],v[108:111]
SA s3,s93,524288
T v[56:57],v18,24576
T v[58:59],v18,26624
M v[108:111],a[156:159],a[204:207],v[108:111]
buffer_load_dwordx4 v8, s[52:55], s25 offen lds
M v[108:111],a[152:155],a[196:199],v[108:111]
C v218,v248,v249
C v219,v250,v251
M v[108:111],a[148:151],a[188:191],v[108:111]
buffer_store_dwordx4 v[64:67], v7, s[8:11], s3 offen offset:0 sc1
M v[108:111],a[144:147],a[180:183],v[108:111]
s_waitcnt lgkmcnt(6)
C v220,v220,v221
C v221,v222,v223
M v[112:115],v[32:35],a[176:179],0
s_mov_b32 s25, 3145856
T a[144:145],v19,0
T a[146:147],v19,2048
M v[112:115],v[36:39],a[184:187],v[112:115]
SA m0,s4,32768
buffer_store_dwordx4 v[68:71], v7, s[8:11], s3 offen offset:2048 sc1
M v[112:115],v[40:43],a[192:195],v[112:115]
s_waitcnt lgkmcnt(2)
s_nop 0
T a[148:149],v19,4096
T a[150:151],v19,6144
M v[112:115],v[44:47],a[200:203],v[112:115]
T a[152:153],v19,8192
T a[154:155],v19,10240
M v[112:115],v[48:51],a[208:211],v[112:115]
buffer_load_dwordx4 v8, s[52:55], s25 offen lds
M v[112:115],v[52:55],a[216:219],v[112:115]
s_nop 0
T a[156:157],v19,12288
T a[158:159],v19,14336
M v[112:115],v[56:59],a[224:227],v[112:115]
T a[160:161],v19,16384
T a[162:163],v19,18432
M v[116:119],v[56:59],a[228:231],0
s_mov_b32 s25, 3408000
C v222,v252,v253
C v223,v254,v255
M v[116:119],v[52:55],a[220:223],v[116:119]
SA m0,s4,36864
T a[164:165],v19,20480
T a[166:167],v19,22528
M v[116:119],v[48:51],a[212:215],v[116:119]
T a[168:169],v19,24576
T a[170:171],v19,26624
M v[116:119],v[44:47],a[204:207],v[116:119]
buffer_load_dwordx4 v8, s[52:55], s25 offen lds
M v[116:119],v[40:43],a[196:199],v[116:119]
v_min_u32 v29, 1, v0
v_lshlrev_b32 v29, 29, v29
M v[116:119],v[36:39],a[188:191],v[116:119]
v_mov_b32 v30, 1
v_add_u32 v20, 0x10000, v16
M v[116:119],v[32:35],a[180:183],v[116:119]
s_waitcnt lgkmcnt(6)
v_add_u32 v21, 0x10000, v17
v_add_u32 v22, 0x10000, v18
M v[120:123],a[144:147],a[176:179],0
s_mov_b32 s25, 256
T v[32:33],v16,28672
T v[34:35],v16,30720
M v[120:123],a[148:151],a[184:187],v[120:123]
SA m0,s4,65536
v_add_u32 v23, 0x10000, v19
v_or_b32 v1, s20, v0
M v[120:123],a[152:155],a[192:195],v[120:123]
s_waitcnt lgkmcnt(2)
T v[36:37],v12,0
T v[38:39],v12,2048
M v[120:123],a[156:159],a[200:203],v[120:123]
s_waitcnt vmcnt(8)
T v[40:41],v12,4096
T v[42:43],v12,6144
M v[120:123],a[160:163],a[208:211],v[120:123]
buffer_load_dwordx4 v8, s[52:55], s25 offen lds
M v[120:123],a[164:167],a[216:219],v[120:123]
s_nop 0
T v[44:45],v12,8192
T v[46:47],v12,10240
M v[120:123],a[168:171],a[224:227],v[120:123]
T v[48:49],v12,12288
T v[50:51],v12,14336
M v[124:127],a[168:171],a[228:231],0
s_mov_b32 s25, 262400
buffer_store_dword v30, v29, s[8:11], s72 offen offset:4 sc1
M v[124:127],a[164:167],a[220:223],v[124:127]
SA m0,s4,69632
T v[52:53],v12,16384
T v[54:55],v12,18432
M v[124:127],a[160:163],a[212:215],v[124:127]
T v[56:57],v12,20480
T v[58:59],v12,22528
M v[124:127],a[156:159],a[204:207],v[124:127]
buffer_load_dwordx4 v8, s[52:55], s25 offen lds
M v[124:127],a[152:155],a[196:199],v[124:127]
SA s3,s93,528384
v_min_u32 v1, 1, v1
v_lshlrev_b32 v1, 29, v1
M v[124:127],a[148:151],a[188:191],v[124:127]
buffer_store_dwordx4 v[72:75], v7, s[8:11], s3 offen offset:0 sc1
M v[124:127],a[144:147],a[180:183],v[124:127]
s_waitcnt lgkmcnt(6)
v_min_u32 v9, 15, v0
v_lshlrev_b32 v9, 7, v9
M v[96:99],v[32:35],a[232:235],v[96:99]
s_mov_b32 s25, 524544
T a[144:145],v17,28672
T a[146:147],v17,30720
M v[96:99],v[36:39],a[96:99],v[96:99]
SA m0,s4,73728
M v[96:99],v[40:43],a[104:107],v[96:99]
s_waitcnt lgkmcnt(2)
s_nop 0
T a[148:149],v13,0
T a[150:151],v13,2048
M v[96:99],v[44:47],a[112:115],v[96:99]
s_sub_u32 s66, 15, s42
T a[152:153],v13,4096
T a[154:155],v13,6144
M v[96:99],v[48:51],a[120:123],v[96:99]
s_max_u32 s67, s66, s42
buffer_load_dwordx4 v8, s[52:55], s25 offen lds
M v[96:99],v[52:55],a[128:131],v[96:99]
s_min_u32 s66, s66, s42
T a[156:157],v13,8192
T a[158:159],v13,10240
M v[96:99],v[56:59],a[136:139],v[96:99]
s_mul_i32 s21, s41, 1048576
T a[160:161],v13,12288
T a[162:163],v13,14336
M v[100:103],v[56:59],a[140:143],v[100:103]
s_mov_b32 s25, 786688
M v[100:103],v[52:55],a[132:135],v[100:103]
SA m0,s4,77824
L_w_kv18:
s_cbranch_execz L_wd2
T a[164:165],v13,16384
T a[166:167],v13,18432
M v[100:103],v[48:51],a[124:127],v[100:103]
s_lshl_b32 s64, s67, 16
T a[168:169],v13,20480
T a[170:171],v13,22528
M v[100:103],v[44:47],a[116:119],v[100:103]
SA s32,s21,s64
buffer_load_dwordx4 v8, s[52:55], s25 offen lds
M v[100:103],v[40:43],a[108:111],v[100:103]
s_lshl_b32 s64, s20, 14
M v[100:103],v[36:39],a[100:103],v[100:103]
SA s32,s32,s64
M v[100:103],v[32:35],a[236:239],v[100:103]
s_waitcnt lgkmcnt(6)
M v[104:107],a[144:147],a[232:235],v[104:107]
s_mov_b32 s25, 1048832
T v[32:33],v18,28672
T v[34:35],v18,30720
M v[104:107],a[148:151],a[96:99],v[104:107]
SA m0,s4,81920
M v[104:107],a[152:155],a[104:107],v[104:107]
s_waitcnt lgkmcnt(2)
s_nop 0
T v[36:37],v14,0
T v[38:39],v14,2048
M v[104:107],a[156:159],a[112:115],v[104:107]
SA s32,s32,33554432
T v[40:41],v14,4096
T v[42:43],v14,6144
M v[104:107],a[160:163],a[120:123],v[104:107]
s_sub_u32 s64, s42, 10
buffer_load_dwordx4 v8, s[52:55], s25 offen lds
M v[104:107],a[164:167],a[128:131],v[104:107]
s_and_b32 s35, s64, 536870912
T v[44:45],v14,8192
T v[46:47],v14,10240
M v[104:107],a[168:171],a[136:139],v[104:107]
T v[48:49],v14,12288
T v[50:51],v14,14336
M v[108:111],a[168:171],a[140:143],v[108:111]
s_mov_b32 s25, 1310976
v_or_b32 v6, s35, v7
M v[108:111],a[164:167],a[132:135],v[108:111]
SA m0,s4,86016
T v[52:53],v14,16384
T v[54:55],v14,18432
M v[108:111],a[160:163],a[124:127],v[108:111]
s_lshl_b32 s28, s20, 13
T v[56:57],v14,20480
T v[58:59],v14,22528
M v[108:111],a[156:159],a[116:119],v[108:111]
buffer_load_dwordx4 v8, s[52:55], s25 offen lds
M v[108:111],a[152:155],a[108:111],v[108:111]
v_add_u32 v2, 0x10000, v7
v_add_u32 v3, s28, v7
M v[108:111],a[148:151],a[100:103],v[108:111]
v_add_u32 v4, 0x1000, v3
MF v96,s5,v96
M v[108:111],a[144:147],a[236:239],v[108:111]
s_waitcnt lgkmcnt(6)
MF v97,s5,v97
MF v98,s5,v98
M v[112:115],v[32:35],a[232:235],v[112:115]
s_mov_b32 s25, 1573120
T a[144:145],v19,28672
T a[146:147],v19,30720
M v[112:115],v[36:39],a[96:99],v[112:115]
SA m0,s4,90112
MF v99,s5,v99
MF v104,s5,v104
M v[112:115],v[40:43],a[104:107],v[112:115]
s_waitcnt lgkmcnt(2)
T a[148:149],v15,0
T a[150:151],v15,2048
M v[112:115],v[44:47],a[112:115],v[112:115]
s_lshl_b32 s64, s42, 16
T a[152:153],v15,4096
T a[154:155],v15,6144
M v[112:115],v[48:51],a[120:123],v[112:115]
SA s23,s21,s64
buffer_load_dwordx4 v8, s[52:55], s25 offen lds
M v[112:115],v[52:55],a[128:131],v[112:115]
SA s43,s23,16777216
T a[156:157],v15,8192
T a[158:159],v15,10240
M v[112:115],v[56:59],a[136:139],v[112:115]
SA s26,s21,16777216
T a[160:161],v15,12288
T a[162:163],v15,14336
M v[116:119],v[56:59],a[140:143],v[116:119]
s_mov_b32 s25, 1835264
MF v105,s5,v105
MF v106,s5,v106
M v[116:119],v[52:55],a[132:135],v[116:119]
SA m0,s4,94208
T a[164:165],v15,16384
T a[166:167],v15,18432
M v[116:119],v[48:51],a[124:127],v[116:119]
s_min_u32 s27, s42, 9
T a[168:169],v15,20480
T a[170:171],v15,22528
M v[116:119],v[44:47],a[116:119],v[116:119]
s_lshl_b32 s22, s27, 1
buffer_load_dwordx4 v8, s[52:55], s25 offen lds
M v[116:119],v[40:43],a[108:111],v[116:119]
s_sub_u32 s22, s22, 1
MF v107,s5,v107
C v96,v96,v97
M v[116:119],v[36:39],a[100:103],v[116:119]
s_waitcnt vmcnt(10) lgkmcnt(0)
C v97,v98,v99
C v98,v104,v105
M v[116:119],v[32:35],a[236:239],v[116:119]
s_barrier
M v[120:123],a[144:147],a[232:235],v[120:123]
s_mov_b32 s25, 2097408
T v[32:33],v16,49152
T v[34:35],v16,51200
M v[120:123],a[148:151],a[96:99],v[120:123]
SA m0,s4,155648
C v99,v106,v107
W a0,v96
M v[120:123],a[152:155],a[104:107],v[120:123]
s_sub_u32 s27, s27, 2
T v[36:37],v16,53248
T v[38:39],v16,55296
M v[120:123],a[156:159],a[112:115],v[120:123]
s_mov_b32 s31, 0x4b800000
T v[40:41],v16,57344
T v[42:43],v16,59392
M v[120:123],a[160:163],a[120:123],v[120:123]
s_mov_b32 s24, 0x33800000
buffer_load_dwordx4 v8, s[52:55], s25 offen lds
M v[120:123],a[164:167],a[128:131],v[120:123]
s_lshl_b32 s47, s66, 7
T v[44:45],v16,61440
T v[46:47],v16,63488
M v[120:123],a[168:171],a[136:139],v[120:123]
SA s47,s47,s46
T v[48:49],v20,32768
T v[50:51],v20,34816
M v[124:127],a[168:171],a[140:143],v[124:127]
s_mov_b32 s25, 2359552
W a1,v97
W a2,v98
M v[124:127],a[164:167],a[132:135],v[124:127]
SA m0,s4,159744
T v[52:53],v20,36864
T v[54:55],v20,38912
M v[124:127],a[160:163],a[124:127],v[124:127]
s_lshl_b32 s64, s20, 5
T v[56:57],v20,40960
T v[58:59],v20,43008
M v[124:127],a[156:159],a[116:119],v[124:127]
SA s47,s47,s64
buffer_load_dwordx4 v8, s[52:55], s25 offen lds
M v[124:127],a[152:155],a[108:111],v[124:127]
SA s47,s47,2048
W a3,v99
MF v100,s5,v100
M v[124:127],a[148:151],a[100:103],v[124:127]
SA s30,s32,0
buffer_store_dwordx4 a[0:3], v6, s[8:11], s30 offen offset:0 sc1
M v[124:127],a[144:147],a[236:239],v[124:127]
s_waitcnt lgkmcnt(6)
MF v101,s5,v101
MF v102,s5,v102
M v[160:163],v[32:35],a[176:179],0
s_lshl_b32 s65, s41, 3
T a[144:145],v17,49152
T a[146:147],v17,51200
M v[160:163],v[36:39],a[184:187],v[160:163]
SA s65,s65,s66
MF v103,s5,v103
MF v108,s5,v108
M v[160:163],v[40:43],a[192:195],v[160:163]
s_waitcnt lgkmcnt(2)
T a[148:149],v17,53248
T a[150:151],v17,55296
M v[160:163],v[44:47],a[200:203],v[160:163]
s_mul_i32 s34, s65, 73728
T a[152:153],v17,57344
T a[154:155],v17,59392
M v[160:163],v[48:51],a[208:211],v[160:163]
SA s34,s34,136314880
MF v109,s5,v109
MF v110,s5,v110
M v[160:163],v[52:55],a[216:219],v[160:163]
s_lshl_b32 s65, s42, 4
T a[156:157],v17,61440
T a[158:159],v17,63488
M v[160:163],v[56:59],a[224:227],v[160:163]
SA s65,s65,s41
T a[160:161],v21,32768
T a[162:163],v21,34816
M v[164:167],v[56:59],a[228:231],0
s_mul_i32 s33, s65, 114688
MF v111,s5,v111
C v100,v100,v101
M v[164:167],v[52:55],a[220:223],v[164:167]
s_mul_i32 s65, s20, 28672
T a[164:165],v21,36864
T a[166:167],v21,38912
M v[164:167],v[48:51],a[212:215],v[164:167]
SA s33,s33,s65
T a[168:169],v21,40960
T a[170:171],v21,43008
M v[164:167],v[44:47],a[204:207],v[164:167]
SA s33,s33,67108864
C v101,v102,v103
C v102,v108,v109
M v[164:167],v[40:43],a[196:199],v[164:167]
s_mov_b32 s6, 0
C v103,v110,v111
W a32,v100
M v[164:167],v[36:39],a[188:191],v[164:167]
s_mov_b32 s7, 1
W a33,v101
W a34,v102
M v[164:167],v[32:35],a[180:183],v[164:167]
s_waitcnt lgkmcnt(6)
W a35,v103
MF v112,s5,v112
M v[168:171],a[144:147],a[176:179],0
s_mov_b32 s40, 1
T v[32:33],v18,49152
T v[34:35],v18,51200
M v[168:171],a[148:151],a[184:187],v[168:171]
s_cmp_eq_u32 s20, 0
MF v113,s5,v113
MF v114,s5,v114
M v[168:171],a[152:155],a[192:195],v[168:171]
s_waitcnt lgkmcnt(2)
T v[36:37],v18,53248
T v[38:39],v18,55296
M v[168:171],a[156:159],a[200:203],v[168:171]
s_cselect_b32 s39, 6, 4
T v[40:41],v18,57344
T v[42:43],v18,59392
M v[168:171],a[160:163],a[208:211],v[168:171]
s_mov_b64 s[60:61], s[76:77]
MF v115,s5,v115
MF v120,s5,v120
M v[168:171],a[164:167],a[216:219],v[168:171]
s_mov_b32 s62, s78
T v[44:45],v18,61440
T v[46:47],v18,63488
M v[168:171],a[168:171],a[224:227],v[168:171]
s_mov_b32 s63, 0x20000
T v[48:49],v22,32768
T v[50:51],v22,34816
M v[172:175],a[168:171],a[228:231],0
s_mov_b32 s25, 2621696
v_lshrrev_b32 v24, 4, v0
v_lshlrev_b32 v24, 2, v24
M v[172:175],a[164:167],a[220:223],v[172:175]
SA s30,s32,8192
T v[52:53],v22,36864
T v[54:55],v22,38912
M v[172:175],a[160:163],a[212:215],v[172:175]
SA m0,s4,131072
T v[56:57],v22,40960
T v[58:59],v22,43008
M v[172:175],a[156:159],a[204:207],v[172:175]
SA s3,s93,528384
buffer_store_dwordx4 a[32:35], v6, s[8:11], s30 offen offset:0 sc1
M v[172:175],a[152:155],a[196:199],v[172:175]
v_and_b32 v25, 15, v0
v_sub_u32 v24, v24, v25
M v[172:175],a[148:151],a[188:191],v[172:175]
buffer_load_dwordx4 v8, s[52:55], s25 offen lds
M v[172:175],a[144:147],a[180:183],v[172:175]
s_waitcnt lgkmcnt(6)
v_cmp_lt_i32 s[16:17], 0, v24
v_cmp_lt_i32 s[18:19], -1, v24
M v[176:179],v[32:35],a[176:179],0
T a[144:145],v19,49152
T a[146:147],v19,51200
M v[176:179],v[36:39],a[184:187],v[176:179]
s_mov_b32 s25, 2883840
buffer_store_dwordx4 v[76:79], v7, s[8:11], s3 offen offset:2048 sc1
M v[176:179],v[40:43],a[192:195],v[176:179]
s_waitcnt lgkmcnt(2)
s_nop 0
T a[148:149],v19,53248
T a[150:151],v19,55296
M v[176:179],v[44:47],a[200:203],v[176:179]
SA m0,s4,135168
T a[152:153],v19,57344
T a[154:155],v19,59392
M v[176:179],v[48:51],a[208:211],v[176:179]
buffer_load_dwordx4 v8, s[52:55], s25 offen lds
M v[176:179],v[52:55],a[216:219],v[176:179]
s_nop 0
T a[156:157],v19,61440
T a[158:159],v19,63488
M v[176:179],v[56:59],a[224:227],v[176:179]
T a[160:161],v23,32768
T a[162:163],v23,34816
M v[180:183],v[56:59],a[228:231],0
s_mov_b32 s25, 3145984
v_cmp_lt_i32 s[48:49], -2, v24
v_cmp_lt_i32 s[50:51], -3, v24
M v[180:183],v[52:55],a[220:223],v[180:183]
SA m0,s4,139264
T a[164:165],v23,36864
T a[166:167],v23,38912
M v[180:183],v[48:51],a[212:215],v[180:183]
T a[168:169],v23,40960
T a[170:171],v23,43008
M v[180:183],v[44:47],a[204:207],v[180:183]
buffer_load_dwordx4 v8, s[52:55], s25 offen lds
M v[180:183],v[40:43],a[196:199],v[180:183]
v_lshl_add_u32 v25, v0, 7, s95
v_and_b32 v0, 48, v0
M v[180:183],v[36:39],a[188:191],v[180:183]
MF v121,s5,v121
MF v122,s5,v122
M v[180:183],v[32:35],a[180:183],v[180:183]
s_waitcnt lgkmcnt(6)
MF v123,s5,v123
C v112,v112,v113
M v[184:187],a[144:147],a[176:179],0
s_mov_b32 s25, 3408128
T v[32:33],v20,45056
T v[34:35],v20,47104
M v[184:187],a[148:151],a[184:187],v[184:187]
SA m0,s4,143360
C v113,v114,v115
C v114,v120,v121
M v[184:187],a[152:155],a[192:195],v[184:187]
s_waitcnt lgkmcnt(2)
T v[36:37],v20,49152
T v[38:39],v20,51200
M v[184:187],a[156:159],a[200:203],v[184:187]
T v[40:41],v20,53248
T v[42:43],v20,55296
M v[184:187],a[160:163],a[208:211],v[184:187]
buffer_load_dwordx4 v8, s[52:55], s25 offen lds
M v[184:187],a[164:167],a[216:219],v[184:187]
s_nop 0
T v[44:45],v20,57344
T v[46:47],v20,59392
M v[184:187],a[168:171],a[224:227],v[184:187]
T v[48:49],v20,61440
T v[50:51],v20,63488
M v[188:191],a[168:171],a[228:231],0
s_mov_b32 s25, 384
C v115,v122,v123
W a4,v112
M v[188:191],a[164:167],a[220:223],v[188:191]
SA m0,s4,0
T v[52:53],v16,32768
T v[54:55],v16,34816
M v[188:191],a[160:163],a[212:215],v[188:191]
T v[56:57],v16,36864
T v[58:59],v16,38912
M v[188:191],a[156:159],a[204:207],v[188:191]
buffer_load_dwordx4 v8, s[52:55], s25 offen lds
M v[188:191],a[152:155],a[196:199],v[188:191]
SA s3,s93,532480
W a5,v113
W a6,v114
M v[188:191],a[148:151],a[188:191],v[188:191]
buffer_store_dwordx4 v[80:83], v7, s[8:11], s3 offen offset:0 sc1
M v[188:191],a[144:147],a[180:183],v[188:191]
s_waitcnt lgkmcnt(6)
W a7,v115
v_lshl_add_u32 v0, v0, 24, v25
M v[160:163],v[32:35],a[232:235],v[160:163]
SA s30,s32,0
T a[144:145],v21,45056
T a[146:147],v21,47104
M v[160:163],v[36:39],a[96:99],v[160:163]
s_mov_b32 s25, 262528
buffer_store_dwordx4 a[4:7], v6, s[8:11], s30 offen offset:1024 sc1
M v[160:163],v[40:43],a[104:107],v[160:163]
s_waitcnt lgkmcnt(2)
s_nop 0
T a[148:149],v21,49152
T a[150:151],v21,51200
M v[160:163],v[44:47],a[112:115],v[160:163]
SA m0,s4,4096
T a[152:153],v21,53248
T a[154:155],v21,55296
M v[160:163],v[48:51],a[120:123],v[160:163]
buffer_load_dwordx4 v8, s[52:55], s25 offen lds
M v[160:163],v[52:55],a[128:131],v[160:163]
s_nop 0
T a[156:157],v21,57344
T a[158:159],v21,59392
M v[160:163],v[56:59],a[136:139],v[160:163]
T a[160:161],v21,61440
T a[162:163],v21,63488
M v[164:167],v[56:59],a[140:143],v[164:167]
s_mov_b32 s25, 524672
buffer_store_dwordx4 v[84:87], v7, s[8:11], s3 offen offset:2048 sc1
M v[164:167],v[52:55],a[132:135],v[164:167]
SA m0,s4,8192
T a[164:165],v17,32768
T a[166:167],v17,34816
M v[164:167],v[48:51],a[124:127],v[164:167]
T a[168:169],v17,36864
T a[170:171],v17,38912
M v[164:167],v[44:47],a[116:119],v[164:167]
buffer_load_dwordx4 v8, s[52:55], s25 offen lds
M v[164:167],v[40:43],a[108:111],v[164:167]
v_mov_b32 v24, 0x3f80
MF v116,s5,v116
M v[164:167],v[36:39],a[100:103],v[164:167]
MF v117,s5,v117
MF v118,s5,v118
M v[164:167],v[32:35],a[236:239],v[164:167]
s_waitcnt lgkmcnt(6)
MF v119,s5,v119
MF v124,s5,v124
M v[168:171],a[144:147],a[232:235],v[168:171]
s_mov_b32 s25, 786816
T v[32:33],v22,45056
T v[34:35],v22,47104
M v[168:171],a[148:151],a[96:99],v[168:171]
SA m0,s4,12288
MF v125,s5,v125
MF v126,s5,v126
M v[168:171],a[152:155],a[104:107],v[168:171]
s_waitcnt lgkmcnt(2)
T v[36:37],v22,49152
T v[38:39],v22,51200
M v[168:171],a[156:159],a[112:115],v[168:171]
T v[40:41],v22,53248
T v[42:43],v22,55296
M v[168:171],a[160:163],a[120:123],v[168:171]
buffer_load_dwordx4 v8, s[52:55], s25 offen lds
M v[168:171],a[164:167],a[128:131],v[168:171]
s_nop 0
T v[44:45],v22,57344
T v[46:47],v22,59392
M v[168:171],a[168:171],a[136:139],v[168:171]
T v[48:49],v22,61440
T v[50:51],v22,63488
M v[172:175],a[168:171],a[140:143],v[172:175]
s_mov_b32 s25, 1048960
MF v127,s5,v127
C v116,v116,v117
M v[172:175],a[164:167],a[132:135],v[172:175]
SA m0,s4,16384
T v[52:53],v18,32768
T v[54:55],v18,34816
M v[172:175],a[160:163],a[124:127],v[172:175]
T v[56:57],v18,36864
T v[58:59],v18,38912
M v[172:175],a[156:159],a[116:119],v[172:175]
buffer_load_dwordx4 v8, s[52:55], s25 offen lds
M v[172:175],a[152:155],a[108:111],v[172:175]
C v117,v118,v119
C v118,v124,v125
M v[172:175],a[148:151],a[100:103],v[172:175]
v_lshrrev_b32 v25, 8, v7
v_bfe_u32 v26, v7, 6, 2
v_and_b32 v27, 16, v7
v_lshlrev_b32 v27, v27, v24
v_cmp_eq_u32 vcc, v25, v26
v_and_b32 v28, 32, v7
W a244,0
v_cndmask_b32 v27, 0, v27, vcc
v_cmp_eq_u32 vcc, 0, v28
W a245,0
W a248,0
v_cndmask_b32 v25, 0, v27, vcc
v_sub_u32 v26, v27, v25
W a249,0
W a246,v25
W a247,v26
M v[172:175],a[144:147],a[236:239],v[172:175]
s_waitcnt lgkmcnt(6)
C v119,v126,v127
W a36,v116
M v[176:179],v[32:35],a[232:235],v[176:179]
s_mov_b32 s25, 1311104
T a[144:145],v23,45056
T a[146:147],v23,47104
M v[176:179],v[36:39],a[96:99],v[176:179]
SA m0,s4,20480
W a37,v117
W a38,v118
M v[176:179],v[40:43],a[104:107],v[176:179]
s_waitcnt lgkmcnt(2)
T a[148:149],v23,49152
T a[150:151],v23,51200
M v[176:179],v[44:47],a[112:115],v[176:179]
T a[152:153],v23,53248
T a[154:155],v23,55296
M v[176:179],v[48:51],a[120:123],v[176:179]
buffer_load_dwordx4 v8, s[52:55], s25 offen lds
M v[176:179],v[52:55],a[128:131],v[176:179]
s_nop 0
T a[156:157],v23,57344
T a[158:159],v23,59392
M v[176:179],v[56:59],a[136:139],v[176:179]
T a[160:161],v23,61440
T a[162:163],v23,63488
M v[180:183],v[56:59],a[140:143],v[180:183]
s_mov_b32 s25, 1573248
W a39,v119
MF v160,s5,v160
M v[180:183],v[52:55],a[132:135],v[180:183]
SA s30,s32,8192
T a[164:165],v19,32768
T a[166:167],v19,34816
M v[180:183],v[48:51],a[124:127],v[180:183]
SA m0,s4,24576
T a[168:169],v19,36864
T a[170:171],v19,38912
M v[180:183],v[44:47],a[116:119],v[180:183]
buffer_store_dwordx4 a[36:39], v6, s[8:11], s30 offen offset:1024 sc1
M v[180:183],v[40:43],a[108:111],v[180:183]
MF v161,s5,v161
MF v162,s5,v162
M v[180:183],v[36:39],a[100:103],v[180:183]
s_waitcnt vmcnt(10) lgkmcnt(0)
buffer_load_dwordx4 v8, s[52:55], s25 offen lds
M v[180:183],v[32:35],a[236:239],v[180:183]
s_barrier
M v[184:187],a[144:147],a[232:235],v[184:187]
s_nop 0
T v[32:33],v20,0
T v[34:35],v20,2048
M v[184:187],a[148:151],a[96:99],v[184:187]
s_mov_b32 s25, 1835392
MF v163,s5,v163
MF v168,s5,v168
M v[184:187],a[152:155],a[104:107],v[184:187]
SA m0,s4,28672
T v[36:37],v20,4096
T v[38:39],v20,6144
M v[184:187],a[156:159],a[112:115],v[184:187]
T v[40:41],v20,8192
T v[42:43],v20,10240
M v[184:187],a[160:163],a[120:123],v[184:187]
buffer_load_dwordx4 v8, s[52:55], s25 offen lds
M v[184:187],a[164:167],a[128:131],v[184:187]
s_nop 0
T v[44:45],v20,12288
T v[46:47],v20,14336
M v[184:187],a[168:171],a[136:139],v[184:187]
T v[48:49],v20,16384
T v[50:51],v20,18432
M v[188:191],a[168:171],a[140:143],v[188:191]
s_mov_b32 s25, 2097536
MF v169,s5,v169
MF v170,s5,v170
M v[188:191],a[164:167],a[132:135],v[188:191]
SA m0,s4,40960
T v[52:53],v20,20480
T v[54:55],v20,22528
M v[188:191],a[160:163],a[124:127],v[188:191]
T v[56:57],v20,24576
T v[58:59],v20,26624
M v[188:191],a[156:159],a[116:119],v[188:191]
buffer_load_dwordx4 v8, s[52:55], s25 offen lds
M v[188:191],a[152:155],a[108:111],v[188:191]
MF v171,s5,v171
C v160,v160,v161
M v[188:191],a[148:151],a[100:103],v[188:191]
C v161,v162,v163
C v162,v168,v169
M v[188:191],a[144:147],a[236:239],v[188:191]
s_waitcnt lgkmcnt(6)
C v163,v170,v171
W a8,v160
M v[96:99],v[32:35],a[176:179],0
s_mov_b32 s25, 2359680
T a[144:145],v21,0
T a[146:147],v21,2048
M v[96:99],v[36:39],a[184:187],v[96:99]
SA m0,s4,45056
W a9,v161
W a10,v162
M v[96:99],v[40:43],a[192:195],v[96:99]
s_waitcnt lgkmcnt(2)
T a[148:149],v21,4096
T a[150:151],v21,6144
M v[96:99],v[44:47],a[200:203],v[96:99]
T a[152:153],v21,8192
T a[154:155],v21,10240
M v[96:99],v[48:51],a[208:211],v[96:99]
buffer_load_dwordx4 v8, s[52:55], s25 offen lds
M v[96:99],v[52:55],a[216:219],v[96:99]
s_nop 0
T a[156:157],v21,12288
T a[158:159],v21,14336
M v[96:99],v[56:59],a[224:227],v[96:99]
T a[160:161],v21,16384
T a[162:163],v21,18432
M v[100:103],v[56:59],a[228:231],0
s_mov_b32 s25, 2621824
W a11,v163
v_lshrrev_b32 v31, 6, v7
M v[100:103],v[52:55],a[220:223],v[100:103]
SA s30,s32,0
T a[164:165],v21,20480
T a[166:167],v21,22528
M v[100:103],v[48:51],a[212:215],v[100:103]
SA m0,s4,49152
T a[168:169],v21,24576
T a[170:171],v21,26624
M v[100:103],v[44:47],a[204:207],v[100:103]
SA s3,s93,536576
buffer_store_dwordx4 a[8:11], v6, s[8:11], s30 offen offset:2048 sc1
M v[100:103],v[40:43],a[196:199],v[100:103]
v_bfe_u32 v28, v7, 4, 2
v_lshlrev_b32 v31, 5, v31
M v[100:103],v[36:39],a[188:191],v[100:103]
buffer_load_dwordx4 v8, s[52:55], s25 offen lds
M v[100:103],v[32:35],a[180:183],v[100:103]
s_waitcnt lgkmcnt(6)
v_add_lshl_u32 v31, v31, v28, 2
MF v164,s5,v164
M v[104:107],a[144:147],a[176:179],0
T v[32:33],v22,0
T v[34:35],v22,2048
M v[104:107],a[148:151],a[184:187],v[104:107]
s_mov_b32 s25, 2883968
buffer_load_dword v5, v31, s[8:11], s46 offen offset:4 sc1
M v[104:107],a[152:155],a[192:195],v[104:107]
s_waitcnt lgkmcnt(2)
s_nop 0
T v[36:37],v22,4096
T v[38:39],v22,6144
M v[104:107],a[156:159],a[200:203],v[104:107]
SA m0,s4,53248
T v[40:41],v22,8192
T v[42:43],v22,10240
M v[104:107],a[160:163],a[208:211],v[104:107]
buffer_load_dwordx4 v8, s[52:55], s25 offen lds
M v[104:107],a[164:167],a[216:219],v[104:107]
s_nop 0
T v[44:45],v22,12288
T v[46:47],v22,14336
M v[104:107],a[168:171],a[224:227],v[104:107]
T v[48:49],v22,16384
T v[50:51],v22,18432
M v[108:111],a[168:171],a[228:231],0
s_mov_b32 s25, 3146112
buffer_store_dwordx4 v[88:91], v7, s[8:11], s3 offen offset:0 sc1
M v[108:111],a[164:167],a[220:223],v[108:111]
SA m0,s4,57344
T v[52:53],v22,20480
T v[54:55],v22,22528
M v[108:111],a[160:163],a[212:215],v[108:111]
T v[56:57],v22,24576
T v[58:59],v22,26624
M v[108:111],a[156:159],a[204:207],v[108:111]
buffer_load_dwordx4 v8, s[52:55], s25 offen lds
M v[108:111],a[152:155],a[196:199],v[108:111]
MF v165,s5,v165
MF v166,s5,v166
M v[108:111],a[148:151],a[188:191],v[108:111]
buffer_store_dwordx4 v[92:95], v7, s[8:11], s3 offen offset:2048 sc1
M v[108:111],a[144:147],a[180:183],v[108:111]
s_waitcnt lgkmcnt(6)
MF v167,s5,v167
MF v172,s5,v172
M v[112:115],v[32:35],a[176:179],0
s_mov_b32 s25, 3408256
T a[144:145],v23,0
T a[146:147],v23,2048
M v[112:115],v[36:39],a[184:187],v[112:115]
SA m0,s4,61440
MF v173,s5,v173
MF v174,s5,v174
M v[112:115],v[40:43],a[192:195],v[112:115]
s_waitcnt lgkmcnt(2)
T a[148:149],v23,4096
T a[150:151],v23,6144
M v[112:115],v[44:47],a[200:203],v[112:115]
T a[152:153],v23,8192
T a[154:155],v23,10240
M v[112:115],v[48:51],a[208:211],v[112:115]
buffer_load_dwordx4 v8, s[52:55], s25 offen lds
M v[112:115],v[52:55],a[216:219],v[112:115]
s_nop 0
T a[156:157],v23,12288
T a[158:159],v23,14336
M v[112:115],v[56:59],a[224:227],v[112:115]
T a[160:161],v23,16384
T a[162:163],v23,18432
M v[116:119],v[56:59],a[228:231],0
MF v175,s5,v175
C v164,v164,v165
M v[116:119],v[52:55],a[220:223],v[116:119]
T a[164:165],v23,20480
T a[166:167],v23,22528
M v[116:119],v[48:51],a[212:215],v[116:119]
T a[168:169],v23,24576
T a[170:171],v23,26624
M v[116:119],v[44:47],a[204:207],v[116:119]
C v165,v166,v167
C v166,v172,v173
M v[116:119],v[40:43],a[196:199],v[116:119]
C v167,v174,v175
W a40,v164
M v[116:119],v[36:39],a[188:191],v[116:119]
W a41,v165
W a42,v166
M v[116:119],v[32:35],a[180:183],v[116:119]
s_waitcnt lgkmcnt(6)
W a43,v167
v_mov_b32 v8, 0xff800000
M v[120:123],a[144:147],a[176:179],0
SA s30,s32,8192
T v[32:33],v20,28672
T v[34:35],v20,30720
M v[120:123],a[148:151],a[184:187],v[120:123]
buffer_store_dwordx4 a[40:43], v6, s[8:11], s30 offen offset:2048 sc1
M v[120:123],a[152:155],a[192:195],v[120:123]
s_waitcnt lgkmcnt(2)
s_nop 0
T v[36:37],v12,24576
T v[38:39],v12,26624
M v[120:123],a[156:159],a[200:203],v[120:123]
T v[40:41],v12,28672
T v[42:43],v12,30720
M v[120:123],a[160:163],a[208:211],v[120:123]
MF v176,s5,v176
MF v177,s5,v177
M v[120:123],a[164:167],a[216:219],v[120:123]
T v[44:45],v12,0
T v[46:47],v12,2048
M v[120:123],a[168:171],a[224:227],v[120:123]
T v[48:49],v12,4096
T v[50:51],v12,6144
M v[124:127],a[168:171],a[228:231],0
MF v178,s5,v178
MF v179,s5,v179
M v[124:127],a[164:167],a[220:223],v[124:127]
T v[52:53],v12,8192
T v[54:55],v12,10240
M v[124:127],a[160:163],a[212:215],v[124:127]
T v[56:57],v12,12288
T v[58:59],v12,14336
M v[124:127],a[156:159],a[204:207],v[124:127]
MF v184,s5,v184
MF v185,s5,v185
M v[124:127],a[152:155],a[196:199],v[124:127]
MF v186,s5,v186
MF v187,s5,v187
M v[124:127],a[148:151],a[188:191],v[124:127]
C v176,v176,v177
C v177,v178,v179
M v[124:127],a[144:147],a[180:183],v[124:127]
s_waitcnt lgkmcnt(6)
C v178,v184,v185
C v179,v186,v187
M v[96:99],v[32:35],a[232:235],v[96:99]
T a[144:145],v21,28672
T a[146:147],v21,30720
M v[96:99],v[36:39],a[96:99],v[96:99]
W a12,v176
W a13,v177
M v[96:99],v[40:43],a[104:107],v[96:99]
s_waitcnt lgkmcnt(2)
T a[148:149],v13,24576
T a[150:151],v13,26624
M v[96:99],v[44:47],a[112:115],v[96:99]
T a[152:153],v13,28672
T a[154:155],v13,30720
M v[96:99],v[48:51],a[120:123],v[96:99]
W a14,v178
W a15,v179
M v[96:99],v[52:55],a[128:131],v[96:99]
T a[156:157],v13,0
T a[158:159],v13,2048
M v[96:99],v[56:59],a[136:139],v[96:99]
T a[160:161],v13,4096
T a[162:163],v13,6144
M v[100:103],v[56:59],a[140:143],v[100:103]
MF v180,s5,v180
MF v181,s5,v181
M v[100:103],v[52:55],a[132:135],v[100:103]
T a[164:165],v13,8192
T a[166:167],v13,10240
M v[100:103],v[48:51],a[124:127],v[100:103]
T a[168:169],v13,12288
T a[170:171],v13,14336
M v[100:103],v[44:47],a[116:119],v[100:103]
MF v182,s5,v182
MF v183,s5,v183
M v[100:103],v[40:43],a[108:111],v[100:103]
SA s30,s32,0
buffer_store_dwordx4 a[12:15], v6, s[8:11], s30 offen offset:3072 sc1
M v[100:103],v[36:39],a[100:103],v[100:103]
MF v188,s5,v188
MF v189,s5,v189
M v[100:103],v[32:35],a[236:239],v[100:103]
s_waitcnt lgkmcnt(6)
MF v190,s5,v190
MF v191,s5,v191
M v[104:107],a[144:147],a[232:235],v[104:107]
T v[32:33],v22,28672
T v[34:35],v22,30720
M v[104:107],a[148:151],a[96:99],v[104:107]
C v180,v180,v181
C v181,v182,v183
M v[104:107],a[152:155],a[104:107],v[104:107]
s_waitcnt lgkmcnt(2)
T v[36:37],v14,24576
T v[38:39],v14,26624
M v[104:107],a[156:159],a[112:115],v[104:107]
T v[40:41],v14,28672
T v[42:43],v14,30720
M v[104:107],a[160:163],a[120:123],v[104:107]
C v182,v188,v189
C v183,v190,v191
M v[104:107],a[164:167],a[128:131],v[104:107]
T v[44:45],v14,0
T v[46:47],v14,2048
M v[104:107],a[168:171],a[136:139],v[104:107]
T v[48:49],v14,4096
T v[50:51],v14,6144
M v[108:111],a[168:171],a[140:143],v[108:111]
W a44,v180
W a45,v181
M v[108:111],a[164:167],a[132:135],v[108:111]
T v[52:53],v14,8192
T v[54:55],v14,10240
M v[108:111],a[160:163],a[124:127],v[108:111]
T v[56:57],v14,12288
T v[58:59],v14,14336
M v[108:111],a[156:159],a[116:119],v[108:111]
W a46,v182
W a47,v183
M v[108:111],a[152:155],a[108:111],v[108:111]
s_waitcnt vmcnt(7)
v_cmp_ne_u32 vcc, 1, v5
MF v96,s5,v96
M v[108:111],a[148:151],a[100:103],v[108:111]
s_nop 0
MF v97,s5,v97
MF v98,s5,v98
M v[108:111],a[144:147],a[236:239],v[108:111]
s_waitcnt lgkmcnt(6)
MF v99,s5,v99
MF v104,s5,v104
M v[112:115],v[32:35],a[232:235],v[112:115]
s_cmp_lg_u32 vcc_lo, 0
T a[144:145],v23,28672
T a[146:147],v23,30720
M v[112:115],v[36:39],a[96:99],v[112:115]
s_cbranch_scc1 L_wsq1
L_wrq1:
MF v105,s5,v105
MF v106,s5,v106
M v[112:115],v[40:43],a[104:107],v[112:115]
s_waitcnt lgkmcnt(2)
T a[148:149],v15,24576
T a[150:151],v15,26624
M v[112:115],v[44:47],a[112:115],v[112:115]
SA m0,s28,98304
T a[152:153],v15,28672
T a[154:155],v15,30720
M v[112:115],v[48:51],a[120:123],v[112:115]
buffer_load_dwordx4 v3, s[8:11], s21 offen offset:0 sc1 lds
M v[112:115],v[52:55],a[128:131],v[112:115]
s_nop 0
T a[156:157],v15,0
T a[158:159],v15,2048
M v[112:115],v[56:59],a[136:139],v[112:115]
T a[160:161],v15,4096
T a[162:163],v15,6144
M v[116:119],v[56:59],a[140:143],v[116:119]
SA s30,s32,8192
buffer_store_dwordx4 a[44:47], v6, s[8:11], s30 offen offset:3072 sc1
M v[116:119],v[52:55],a[132:135],v[116:119]
s_nop 0
T a[164:165],v15,8192
T a[166:167],v15,10240
M v[116:119],v[48:51],a[124:127],v[116:119]
T a[168:169],v15,12288
T a[170:171],v15,14336
M v[116:119],v[44:47],a[116:119],v[116:119]
buffer_load_dwordx4 v3, s[8:11], s21 offen offset:1024 sc1 lds
M v[116:119],v[40:43],a[108:111],v[116:119]
MF v107,s5,v107
C v96,v96,v97
M v[116:119],v[36:39],a[100:103],v[116:119]
s_waitcnt vmcnt(5) lgkmcnt(0)
buffer_load_dwordx4 v3, s[8:11], s21 offen offset:2048 sc1 lds
M v[116:119],v[32:35],a[236:239],v[116:119]
s_barrier
M v[120:123],a[144:147],a[232:235],v[120:123]
s_nop 0
T v[32:33],v16,0
T v[34:35],v16,2048
M v[120:123],a[148:151],a[96:99],v[120:123]
buffer_load_dwordx4 v3, s[8:11], s21 offen offset:3072 sc1 lds
M v[120:123],a[152:155],a[104:107],v[120:123]
SA m0,s28,102400
T v[36:37],v16,4096
T v[38:39],v16,6144
M v[120:123],a[156:159],a[112:115],v[120:123]
T v[40:41],v16,8192
T v[42:43],v16,10240
M v[120:123],a[160:163],a[120:123],v[120:123]
buffer_load_dwordx4 v4, s[8:11], s21 offen offset:0 sc1 lds
M v[120:123],a[164:167],a[128:131],v[120:123]
s_nop 0
T v[44:45],v16,12288
T v[46:47],v16,14336
M v[120:123],a[168:171],a[136:139],v[120:123]
T v[48:49],v16,16384
T v[50:51],v16,18432
M v[124:127],a[168:171],a[140:143],v[124:127]
buffer_load_dwordx4 v4, s[8:11], s21 offen offset:1024 sc1 lds
M v[124:127],a[164:167],a[132:135],v[124:127]
s_nop 0
T v[52:53],v16,20480
T v[54:55],v16,22528
M v[124:127],a[160:163],a[124:127],v[124:127]
T v[56:57],v16,24576
T v[58:59],v16,26624
M v[124:127],a[156:159],a[116:119],v[124:127]
buffer_load_dwordx4 v4, s[8:11], s21 offen offset:2048 sc1 lds
M v[124:127],a[152:155],a[108:111],v[124:127]
C v97,v98,v99
C v98,v104,v105
M v[124:127],a[148:151],a[100:103],v[124:127]
buffer_load_dwordx4 v4, s[8:11], s21 offen offset:3072 sc1 lds
M v[124:127],a[144:147],a[236:239],v[124:127]
s_waitcnt lgkmcnt(6)
C v99,v106,v107
W a16,v96
M v[160:163],v[32:35],a[176:179],0
SA s21,s21,32768
T a[144:145],v17,0
T a[146:147],v17,2048
M v[160:163],v[36:39],a[184:187],v[160:163]
s_sub_u32 s22, s22, 1
W a17,v97
W a18,v98
M v[160:163],v[40:43],a[192:195],v[160:163]
s_waitcnt lgkmcnt(2)
T a[148:149],v17,4096
T a[150:151],v17,6144
M v[160:163],v[44:47],a[200:203],v[160:163]
s_cselect_b32 s21, s23, s21
T a[152:153],v17,8192
T a[154:155],v17,10240
M v[160:163],v[48:51],a[208:211],v[160:163]
SA m0,s28,65536
W a19,v99
MF v100,s5,v100
M v[160:163],v[52:55],a[216:219],v[160:163]
SA s30,s32,4096
T a[156:157],v17,12288
T a[158:159],v17,14336
M v[160:163],v[56:59],a[224:227],v[160:163]
T a[160:161],v17,16384
T a[162:163],v17,18432
M v[164:167],v[56:59],a[228:231],0
buffer_store_dwordx4 a[16:19], v6, s[8:11], s30 offen offset:0 sc1
M v[164:167],v[52:55],a[220:223],v[164:167]
s_nop 0
T a[164:165],v17,20480
T a[166:167],v17,22528
M v[164:167],v[48:51],a[212:215],v[164:167]
T a[168:169],v17,24576
T a[170:171],v17,26624
M v[164:167],v[44:47],a[204:207],v[164:167]
buffer_load_dwordx4 v3, s[8:11], s21 offen offset:0 sc1 lds
M v[164:167],v[40:43],a[196:199],v[164:167]
MF v101,s5,v101
MF v102,s5,v102
M v[164:167],v[36:39],a[188:191],v[164:167]
buffer_load_dwordx4 v3, s[8:11], s21 offen offset:1024 sc1 lds
M v[164:167],v[32:35],a[180:183],v[164:167]
s_waitcnt lgkmcnt(6)
buffer_load_dword v5, v31, s[8:11], s46 offen offset:4 sc1
M v[168:171],a[144:147],a[176:179],0
s_nop 0
T v[32:33],v18,0
T v[34:35],v18,2048
M v[168:171],a[148:151],a[184:187],v[168:171]
buffer_load_dwordx4 v3, s[8:11], s21 offen offset:2048 sc1 lds
M v[168:171],a[152:155],a[192:195],v[168:171]
s_waitcnt lgkmcnt(2)
s_nop 0
T v[36:37],v18,4096
T v[38:39],v18,6144
M v[168:171],a[156:159],a[200:203],v[168:171]
T v[40:41],v18,8192
T v[42:43],v18,10240
M v[168:171],a[160:163],a[208:211],v[168:171]
buffer_load_dwordx4 v3, s[8:11], s21 offen offset:3072 sc1 lds
M v[168:171],a[164:167],a[216:219],v[168:171]
SA m0,s28,69632
T v[44:45],v18,12288
T v[46:47],v18,14336
M v[168:171],a[168:171],a[224:227],v[168:171]
T v[48:49],v18,16384
T v[50:51],v18,18432
M v[172:175],a[168:171],a[228:231],0
buffer_load_dwordx4 v4, s[8:11], s21 offen offset:0 sc1 lds
M v[172:175],a[164:167],a[220:223],v[172:175]
s_nop 0
T v[52:53],v18,20480
T v[54:55],v18,22528
M v[172:175],a[160:163],a[212:215],v[172:175]
T v[56:57],v18,24576
T v[58:59],v18,26624
M v[172:175],a[156:159],a[204:207],v[172:175]
buffer_load_dwordx4 v4, s[8:11], s21 offen offset:1024 sc1 lds
M v[172:175],a[152:155],a[196:199],v[172:175]
MF v103,s5,v103
MF v108,s5,v108
M v[172:175],a[148:151],a[188:191],v[172:175]
buffer_load_dwordx4 v4, s[8:11], s21 offen offset:2048 sc1 lds
M v[172:175],a[144:147],a[180:183],v[172:175]
s_waitcnt lgkmcnt(6)
MF v109,s5,v109
MF v110,s5,v110
M v[176:179],v[32:35],a[176:179],0
T a[144:145],v19,0
T a[146:147],v19,2048
M v[176:179],v[36:39],a[184:187],v[176:179]
buffer_load_dwordx4 v4, s[8:11], s21 offen offset:3072 sc1 lds
M v[176:179],v[40:43],a[192:195],v[176:179]
s_waitcnt lgkmcnt(2)
s_nop 0
T a[148:149],v19,4096
T a[150:151],v19,6144
M v[176:179],v[44:47],a[200:203],v[176:179]
SA s21,s21,32768
T a[152:153],v19,8192
T a[154:155],v19,10240
M v[176:179],v[48:51],a[208:211],v[176:179]
s_sub_u32 s22, s22, 1
MF v111,s5,v111
C v100,v100,v101
M v[176:179],v[52:55],a[216:219],v[176:179]
s_cselect_b32 s21, s23, s21
T a[156:157],v19,12288
T a[158:159],v19,14336
M v[176:179],v[56:59],a[224:227],v[176:179]
T a[160:161],v19,16384
T a[162:163],v19,18432
M v[180:183],v[56:59],a[228:231],0
C v101,v102,v103
C v102,v108,v109
M v[180:183],v[52:55],a[220:223],v[180:183]
T a[164:165],v19,20480
T a[166:167],v19,22528
M v[180:183],v[48:51],a[212:215],v[180:183]
T a[168:169],v19,24576
T a[170:171],v19,26624
M v[180:183],v[44:47],a[204:207],v[180:183]
C v103,v110,v111
W a48,v100
M v[180:183],v[40:43],a[196:199],v[180:183]
W a49,v101
W a50,v102
M v[180:183],v[36:39],a[188:191],v[180:183]
W a51,v103
MF v112,s5,v112
M v[180:183],v[32:35],a[180:183],v[180:183]
s_waitcnt lgkmcnt(6)
MF v113,s5,v113
MF v114,s5,v114
M v[184:187],a[144:147],a[176:179],0
SA s30,s32,12288
T v[32:33],v16,28672
T v[34:35],v16,30720
M v[184:187],a[148:151],a[184:187],v[184:187]
buffer_store_dwordx4 a[48:51], v6, s[8:11], s30 offen offset:0 sc1
M v[184:187],a[152:155],a[192:195],v[184:187]
s_waitcnt lgkmcnt(2)
s_nop 0
T v[36:37],v16,40960
T v[38:39],v16,43008
M v[184:187],a[156:159],a[200:203],v[184:187]
T v[40:41],v16,45056
T v[42:43],v16,47104
M v[184:187],a[160:163],a[208:211],v[184:187]
MF v115,s5,v115
MF v120,s5,v120
M v[184:187],a[164:167],a[216:219],v[184:187]
T v[44:45],v16,49152
T v[46:47],v16,51200
M v[184:187],a[168:171],a[224:227],v[184:187]
T v[48:49],v16,53248
T v[50:51],v16,55296
M v[188:191],a[168:171],a[228:231],0
MF v121,s5,v121
MF v122,s5,v122
M v[188:191],a[164:167],a[220:223],v[188:191]
T v[52:53],v16,57344
T v[54:55],v16,59392
M v[188:191],a[160:163],a[212:215],v[188:191]
T v[56:57],v16,61440
T v[58:59],v16,63488
M v[188:191],a[156:159],a[204:207],v[188:191]
MF v123,s5,v123
C v112,v112,v113
M v[188:191],a[152:155],a[196:199],v[188:191]
C v113,v114,v115
C v114,v120,v121
M v[188:191],a[148:151],a[188:191],v[188:191]
C v115,v122,v123
W a20,v112
M v[188:191],a[144:147],a[180:183],v[188:191]
s_waitcnt lgkmcnt(6)
W a21,v113
W a22,v114
M v[160:163],v[32:35],a[232:235],v[160:163]
T a[144:145],v17,28672
T a[146:147],v17,30720
M v[160:163],v[36:39],a[96:99],v[160:163]
W a23,v115
MF v116,s5,v116
M v[160:163],v[40:43],a[104:107],v[160:163]
s_waitcnt lgkmcnt(2)
T a[148:149],v17,40960
T a[150:151],v17,43008
M v[160:163],v[44:47],a[112:115],v[160:163]
T a[152:153],v17,45056
T a[154:155],v17,47104
M v[160:163],v[48:51],a[120:123],v[160:163]
MF v117,s5,v117
MF v118,s5,v118
M v[160:163],v[52:55],a[128:131],v[160:163]
T a[156:157],v17,49152
T a[158:159],v17,51200
M v[160:163],v[56:59],a[136:139],v[160:163]
T a[160:161],v17,53248
T a[162:163],v17,55296
M v[164:167],v[56:59],a[140:143],v[164:167]
MF v119,s5,v119
MF v124,s5,v124
M v[164:167],v[52:55],a[132:135],v[164:167]
T a[164:165],v17,57344
T a[166:167],v17,59392
M v[164:167],v[48:51],a[124:127],v[164:167]
T a[168:169],v17,61440
T a[170:171],v17,63488
M v[164:167],v[44:47],a[116:119],v[164:167]
MF v125,s5,v125
MF v126,s5,v126
M v[164:167],v[40:43],a[108:111],v[164:167]
SA s30,s32,4096
buffer_store_dwordx4 a[20:23], v6, s[8:11], s30 offen offset:1024 sc1
M v[164:167],v[36:39],a[100:103],v[164:167]
MF v127,s5,v127
C v116,v116,v117
M v[164:167],v[32:35],a[236:239],v[164:167]
s_waitcnt lgkmcnt(6)
C v117,v118,v119
C v118,v124,v125
M v[168:171],a[144:147],a[232:235],v[168:171]
T v[32:33],v18,28672
T v[34:35],v18,30720
M v[168:171],a[148:151],a[96:99],v[168:171]
C v119,v126,v127
W a52,v116
M v[168:171],a[152:155],a[104:107],v[168:171]
s_waitcnt lgkmcnt(2)
T v[36:37],v18,40960
T v[38:39],v18,43008
M v[168:171],a[156:159],a[112:115],v[168:171]
T v[40:41],v18,45056
T v[42:43],v18,47104
M v[168:171],a[160:163],a[120:123],v[168:171]
W a53,v117
W a54,v118
M v[168:171],a[164:167],a[128:131],v[168:171]
T v[44:45],v18,49152
T v[46:47],v18,51200
M v[168:171],a[168:171],a[136:139],v[168:171]
T v[48:49],v18,53248
T v[50:51],v18,55296
M v[172:175],a[168:171],a[140:143],v[172:175]
W a55,v119
s_waitcnt vmcnt(8)
v_cmp_ne_u32 vcc, 1, v5
M v[172:175],a[164:167],a[132:135],v[172:175]
s_nop 0
T v[52:53],v18,57344
T v[54:55],v18,59392
M v[172:175],a[160:163],a[124:127],v[172:175]
s_cmp_lg_u32 vcc_hi, 0
T v[56:57],v18,61440
T v[58:59],v18,63488
M v[172:175],a[156:159],a[116:119],v[172:175]
s_cbranch_scc1 L_wsr1
L_wrr1:
MF v160,s5,v160
MF v161,s5,v161
M v[172:175],a[152:155],a[108:111],v[172:175]
SA m0,s28,131072
MF v162,s5,v162
MF v163,s5,v163
M v[172:175],a[148:151],a[100:103],v[172:175]
buffer_load_dwordx4 v3, s[8:11], s26 offen offset:0 sc1 lds
M v[172:175],a[144:147],a[236:239],v[172:175]
s_waitcnt lgkmcnt(6)
MF v168,s5,v168
MF v169,s5,v169
M v[176:179],v[32:35],a[232:235],v[176:179]
T a[144:145],v19,28672
T a[146:147],v19,30720
M v[176:179],v[36:39],a[96:99],v[176:179]
buffer_load_dwordx4 v3, s[8:11], s26 offen offset:1024 sc1 lds
M v[176:179],v[40:43],a[104:107],v[176:179]
s_waitcnt lgkmcnt(2)
s_nop 0
T a[148:149],v19,40960
T a[150:151],v19,43008
M v[176:179],v[44:47],a[112:115],v[176:179]
T a[152:153],v19,45056
T a[154:155],v19,47104
M v[176:179],v[48:51],a[120:123],v[176:179]
buffer_load_dwordx4 v3, s[8:11], s26 offen offset:2048 sc1 lds
M v[176:179],v[52:55],a[128:131],v[176:179]
s_nop 0
T a[156:157],v19,49152
T a[158:159],v19,51200
M v[176:179],v[56:59],a[136:139],v[176:179]
T a[160:161],v19,53248
T a[162:163],v19,55296
M v[180:183],v[56:59],a[140:143],v[180:183]
SA s30,s32,12288
buffer_store_dwordx4 a[52:55], v6, s[8:11], s30 offen offset:1024 sc1
M v[180:183],v[52:55],a[132:135],v[180:183]
s_nop 0
T a[164:165],v19,57344
T a[166:167],v19,59392
M v[180:183],v[48:51],a[124:127],v[180:183]
T a[168:169],v19,61440
T a[170:171],v19,63488
M v[180:183],v[44:47],a[116:119],v[180:183]
buffer_load_dwordx4 v3, s[8:11], s26 offen offset:3072 sc1 lds
M v[180:183],v[40:43],a[108:111],v[180:183]
SA m0,s28,135168
MF v170,s5,v170
MF v171,s5,v171
M v[180:183],v[36:39],a[100:103],v[180:183]
s_waitcnt lgkmcnt(0)
buffer_load_dwordx4 v4, s[8:11], s26 offen offset:0 sc1 lds
M v[180:183],v[32:35],a[236:239],v[180:183]
s_barrier
M v[184:187],a[144:147],a[232:235],v[184:187]
R a[64:67],v2,32768
R a[68:71],v2,33792
M v[184:187],a[148:151],a[96:99],v[184:187]
buffer_load_dwordx4 v4, s[8:11], s26 offen offset:1024 sc1 lds
M v[184:187],a[152:155],a[104:107],v[184:187]
C v160,v160,v161
C v161,v162,v163
M v[184:187],a[156:159],a[112:115],v[184:187]
R a[72:75],v2,34816
R a[76:79],v2,35840
M v[184:187],a[160:163],a[120:123],v[184:187]
buffer_load_dwordx4 v4, s[8:11], s26 offen offset:2048 sc1 lds
M v[184:187],a[164:167],a[128:131],v[184:187]
C v162,v168,v169
C v163,v170,v171
M v[184:187],a[168:171],a[136:139],v[184:187]
R a[80:83],v2,36864
R a[84:87],v2,37888
M v[188:191],a[168:171],a[140:143],v[188:191]
buffer_load_dwordx4 v4, s[8:11], s26 offen offset:3072 sc1 lds
M v[188:191],a[164:167],a[132:135],v[188:191]
SA s26,s26,32768
W a24,v160
W a25,v161
M v[188:191],a[160:163],a[124:127],v[188:191]
R a[88:91],v2,38912
R a[92:95],v2,39936
M v[188:191],a[156:159],a[116:119],v[188:191]
W a26,v162
W a27,v163
M v[188:191],a[152:155],a[108:111],v[188:191]
MF v164,s5,v164
MF v165,s5,v165
M v[188:191],a[148:151],a[100:103],v[188:191]
MF v166,s5,v166
MF v167,s5,v167
M v[188:191],a[144:147],a[236:239],v[188:191]
s_waitcnt lgkmcnt(0)
SA s30,s32,4096
buffer_store_dwordx4 a[24:27], v6, s[8:11], s30 offen offset:2048 sc1
MF v172,s5,v172
MF v173,s5,v173
MF v174,s5,v174
MF v175,s5,v175
C v164,v164,v165
C v165,v166,v167
C v166,v172,v173
C v167,v174,v175
W a56,v164
W a57,v165
W a58,v166
W a59,v167
SA s30,s32,12288
buffer_store_dwordx4 a[56:59], v6, s[8:11], s30 offen offset:2048 sc1
v_mov_b32 v30, 2
buffer_store_dword v30, v1, s[8:11], s45 offen sc1
M v[64:67],a[64:67],a[0:3],0
R a[96:99],v2,40960
R a[100:103],v2,41984
M v[64:67],a[68:71],a[4:7],v[64:67]
MF v176,s5,v176
MF v177,s5,v177
M v[64:67],a[72:75],a[8:11],v[64:67]
MF v178,s5,v178
MF v179,s5,v179
M v[64:67],a[76:79],a[12:15],v[64:67]
R a[104:107],v2,43008
R a[108:111],v2,44032
M v[64:67],a[80:83],a[16:19],v[64:67]
MF v184,s5,v184
MF v185,s5,v185
MF v186,s5,v186
MF v187,s5,v187
C v176,v176,v177
C v177,v178,v179
C v178,v184,v185
C v179,v186,v187
W a28,v176
W a29,v177
W a30,v178
W a31,v179
M v[64:67],a[84:87],a[20:23],v[64:67]
MF v180,s5,v180
MF v181,s5,v181
M v[64:67],a[88:91],a[24:27],v[64:67]
R a[112:115],v2,45056
R a[116:119],v2,46080
M v[64:67],a[92:95],a[28:31],v[64:67]
MF v182,s5,v182
MF v183,s5,v183
M v[68:71],a[64:67],a[32:35],0
MF v188,s5,v188
MF v189,s5,v189
M v[68:71],a[68:71],a[36:39],v[68:71]
R a[120:123],v2,47104
R a[124:127],v2,48128
M v[68:71],a[72:75],a[40:43],v[68:71]
SA m0,s28,32768
MF v190,s5,v190
MF v191,s5,v191
M v[68:71],a[76:79],a[44:47],v[68:71]
buffer_load_dwordx4 v3, s[8:11], s26 offen offset:0 sc1 lds
M v[68:71],a[80:83],a[48:51],v[68:71]
C v180,v180,v181
C v181,v182,v183
C v182,v188,v189
C v183,v190,v191
W a60,v180
W a61,v181
W a62,v182
W a63,v183
M v[68:71],a[84:87],a[52:55],v[68:71]
SA s30,s32,4096
buffer_store_dwordx4 a[28:31], v6, s[8:11], s30 offen offset:3072 sc1
M v[68:71],a[88:91],a[56:59],v[68:71]
SA s30,s32,12288
E v18,v64
M v[68:71],a[92:95],a[60:63],v[68:71]
s_waitcnt lgkmcnt(0)
buffer_store_dwordx4 a[60:63], v6, s[8:11], s30 offen offset:3072 sc1
M v[72:75],a[96:99],a[0:3],0
R a[64:67],v2,49152
R a[68:71],v2,50176
M v[72:75],a[100:103],a[4:7],v[72:75]
E v19,v65
M v[72:75],a[104:107],a[8:11],v[72:75]
buffer_load_dwordx4 v3, s[8:11], s26 offen offset:1024 sc1 lds
M v[72:75],a[108:111],a[12:15],v[72:75]
R a[72:75],v2,51200
R a[76:79],v2,52224
M v[72:75],a[112:115],a[16:19],v[72:75]
E v20,v66
M v[72:75],a[116:119],a[20:23],v[72:75]
buffer_load_dwordx4 v3, s[8:11], s26 offen offset:2048 sc1 lds
M v[72:75],a[120:123],a[24:27],v[72:75]
R a[80:83],v2,53248
R a[84:87],v2,54272
M v[72:75],a[124:127],a[28:31],v[72:75]
E v21,v67
M v[76:79],a[124:127],a[60:63],0
buffer_load_dwordx4 v3, s[8:11], s26 offen offset:3072 sc1 lds
M v[76:79],a[120:123],a[56:59],v[76:79]
SA m0,s28,36864
R a[88:91],v2,55296
R a[92:95],v2,56320
M v[76:79],a[116:119],a[52:55],v[76:79]
E v22,v68
M v[76:79],a[112:115],a[48:51],v[76:79]
buffer_load_dwordx4 v4, s[8:11], s26 offen offset:0 sc1 lds
M v[76:79],a[108:111],a[44:47],v[76:79]
E v23,v69
M v[76:79],a[104:107],a[40:43],v[76:79]
AF v26,v18,v19
C v40,v18,v19
M v[76:79],a[100:103],a[36:39],v[76:79]
buffer_load_dwordx4 v4, s[8:11], s26 offen offset:1024 sc1 lds
M v[76:79],a[96:99],a[32:35],v[76:79]
s_waitcnt lgkmcnt(0)
v_add_u32 v16, 0x20000, v7
AF v26,v20,v26
M v[80:83],a[64:67],a[0:3],0
R a[96:99],v2,57344
R a[100:103],v2,58368
M v[80:83],a[68:71],a[4:7],v[80:83]
buffer_load_dwordx4 v4, s[8:11], s26 offen offset:2048 sc1 lds
M v[80:83],a[72:75],a[8:11],v[80:83]
E v24,v70
M v[80:83],a[76:79],a[12:15],v[80:83]
R a[104:107],v2,59392
R a[108:111],v2,60416
M v[80:83],a[80:83],a[16:19],v[80:83]
buffer_load_dwordx4 v4, s[8:11], s26 offen offset:3072 sc1 lds
M v[80:83],a[84:87],a[20:23],v[80:83]
SA s26,s26,32768
E v25,v71
M v[80:83],a[88:91],a[24:27],v[80:83]
R a[112:115],v2,61440
R a[116:119],v2,62464
M v[80:83],a[92:95],a[28:31],v[80:83]
E v18,v72
M v[84:87],a[92:95],a[60:63],0
E v19,v73
M v[84:87],a[88:91],a[56:59],v[84:87]
R a[120:123],v2,63488
R a[124:127],v2,64512
M v[84:87],a[84:87],a[52:55],v[84:87]
C v41,v20,v21
AF v26,v21,v26
M v[84:87],a[80:83],a[48:51],v[84:87]
E v20,v74
M v[84:87],a[76:79],a[44:47],v[84:87]
AF v27,v22,v23
C v44,v22,v23
M v[84:87],a[72:75],a[40:43],v[84:87]
AF v27,v24,v27
C v45,v24,v25
M v[84:87],a[68:71],a[36:39],v[84:87]
s_waitcnt vmcnt(24) lgkmcnt(0)
E v21,v75
M v[84:87],a[64:67],a[32:35],v[84:87]
s_barrier
M v[88:91],a[96:99],a[0:3],0
R a[64:67],v2,0
R a[68:71],v2,1024
M v[88:91],a[100:103],a[4:7],v[88:91]
E v22,v76
M v[88:91],a[104:107],a[8:11],v[88:91]
AF v27,v25,v27
AF v26,v18,v26
M v[88:91],a[108:111],a[12:15],v[88:91]
R a[72:75],v2,2048
R a[76:79],v2,3072
M v[88:91],a[112:115],a[16:19],v[88:91]
E v23,v77
M v[88:91],a[116:119],a[20:23],v[88:91]
C v42,v18,v19
AF v26,v19,v26
M v[88:91],a[120:123],a[24:27],v[88:91]
R a[80:83],v2,4096
R a[84:87],v2,5120
M v[88:91],a[124:127],a[28:31],v[88:91]
E v24,v78
M v[92:95],a[124:127],a[60:63],0
AF v26,v20,v26
C v43,v20,v21
M v[92:95],a[120:123],a[56:59],v[92:95]
R a[88:91],v2,6144
R a[92:95],v2,7168
M v[92:95],a[116:119],a[52:55],v[92:95]
E v25,v79
M v[92:95],a[112:115],a[48:51],v[92:95]
AF v26,v21,v26
AF v27,v22,v27
M v[92:95],a[108:111],a[44:47],v[92:95]
C v46,v22,v23
AF v27,v23,v27
M v[92:95],a[104:107],a[40:43],v[92:95]
AF v27,v24,v27
C v47,v24,v25
M v[92:95],a[100:103],a[36:39],v[92:95]
s_waitcnt lgkmcnt(0)
AF v27,v25,v27
M v[92:95],a[96:99],a[32:35],v[92:95]
M v[96:99],a[64:67],a[0:3],0
R a[96:99],v2,8192
R a[100:103],v2,9216
M v[96:99],a[68:71],a[4:7],v[96:99]
SA m0,s28,98304
W a128,v128
W a129,v129
M v[96:99],a[72:75],a[8:11],v[96:99]
buffer_load_dwordx4 v3, s[8:11], s21 offen offset:0 sc1 lds
M v[96:99],a[76:79],a[12:15],v[96:99]
R a[104:107],v2,10240
R a[108:111],v2,11264
M v[96:99],a[80:83],a[16:19],v[96:99]
W a130,v130
v_mov_b32 v30, 0
M v[96:99],a[84:87],a[20:23],v[96:99]
W a131,v131
M v[96:99],a[88:91],a[24:27],v[96:99]
R a[112:115],v2,12288
R a[116:119],v2,13312
M v[96:99],a[92:95],a[28:31],v[96:99]
buffer_load_dwordx4 v3, s[8:11], s21 offen offset:1024 sc1 lds
M v[100:103],a[92:95],a[60:63],0
W a132,v132
v_mov_b32 v31, 0
M v[100:103],a[88:91],a[56:59],v[100:103]
R a[120:123],v2,14336
R a[124:127],v2,15360
M v[100:103],a[84:87],a[52:55],v[100:103]
W a133,v133
W a134,v134
M v[100:103],a[80:83],a[48:51],v[100:103]
buffer_load_dwordx4 v3, s[8:11], s21 offen offset:2048 sc1 lds
M v[100:103],a[76:79],a[44:47],v[100:103]
W a135,v135
M v[100:103],a[72:75],a[40:43],v[100:103]
v_mov_b32 v32, 0
M v[100:103],a[68:71],a[36:39],v[100:103]
W a136,v136
M v[100:103],a[64:67],a[32:35],v[100:103]
s_waitcnt lgkmcnt(0)
buffer_load_dwordx4 v3, s[8:11], s21 offen offset:3072 sc1 lds
M v[104:107],a[96:99],a[0:3],0
SA m0,s28,102400
R a[64:67],v2,16384
R a[68:71],v2,17408
M v[104:107],a[100:103],a[4:7],v[104:107]
W a137,v137
v_mov_b32 v33, 0
M v[104:107],a[104:107],a[8:11],v[104:107]
W a138,v138
M v[104:107],a[108:111],a[12:15],v[104:107]
R a[72:75],v2,18432
R a[76:79],v2,19456
M v[104:107],a[112:115],a[16:19],v[104:107]
buffer_load_dwordx4 v4, s[8:11], s21 offen offset:0 sc1 lds
M v[104:107],a[116:119],a[20:23],v[104:107]
W a139,v139
W a140,v140
M v[104:107],a[120:123],a[24:27],v[104:107]
R a[80:83],v2,20480
R a[84:87],v2,21504
M v[104:107],a[124:127],a[28:31],v[104:107]
buffer_load_dwordx4 v4, s[8:11], s21 offen offset:1024 sc1 lds
M v[108:111],a[124:127],a[60:63],0
v_mov_b32 v34, 0
W a141,v141
M v[108:111],a[120:123],a[56:59],v[108:111]
R a[88:91],v2,22528
R a[92:95],v2,23552
M v[108:111],a[116:119],a[52:55],v[108:111]
buffer_load_dwordx4 v4, s[8:11], s21 offen offset:2048 sc1 lds
M v[108:111],a[112:115],a[48:51],v[108:111]
W a142,v142
W a143,v143
M v[108:111],a[108:111],a[44:47],v[108:111]
v_mov_b32 v35, 0
W a144,v144
M v[108:111],a[104:107],a[40:43],v[108:111]
W a145,v145
M v[108:111],a[100:103],a[36:39],v[108:111]
buffer_load_dwordx4 v4, s[8:11], s21 offen offset:3072 sc1 lds
M v[108:111],a[96:99],a[32:35],v[108:111]
s_waitcnt lgkmcnt(0)
v_mov_b32 v36, 0
W a146,v146
M v[112:115],a[64:67],a[0:3],0
SA s21,s21,32768
R a[96:99],v2,24576
R a[100:103],v2,25600
M v[112:115],a[68:71],a[4:7],v[112:115]
s_sub_u32 s22, s22, 1
W a147,v147
M v[112:115],a[72:75],a[8:11],v[112:115]
s_cselect_b32 s21, s23, s21
E v18,v80
M v[112:115],a[76:79],a[12:15],v[112:115]
R a[104:107],v2,26624
R a[108:111],v2,27648
M v[112:115],a[80:83],a[16:19],v[112:115]
W a148,v148
v_mov_b32 v37, 0
M v[112:115],a[84:87],a[20:23],v[112:115]
W a149,v149
M v[112:115],a[88:91],a[24:27],v[112:115]
R a[112:115],v2,28672
R a[116:119],v2,29696
M v[112:115],a[92:95],a[28:31],v[112:115]
W a150,v150
M v[116:119],a[92:95],a[60:63],0
v_mov_b32 v38, 0
W a151,v151
M v[116:119],a[88:91],a[56:59],v[116:119]
R a[120:123],v2,30720
R a[124:127],v2,31744
M v[116:119],a[84:87],a[52:55],v[116:119]
W a152,v152
M v[116:119],a[80:83],a[48:51],v[116:119]
W a153,v153
M v[116:119],a[76:79],a[44:47],v[116:119]
E v19,v81
M v[116:119],a[72:75],a[40:43],v[116:119]
v_mov_b32 v39, 0
W a154,v154
M v[116:119],a[68:71],a[36:39],v[116:119]
s_waitcnt vmcnt(21) lgkmcnt(0)
E v20,v82
M v[116:119],a[64:67],a[32:35],v[116:119]
s_barrier
M v[120:123],a[96:99],a[0:3],0
R a[64:67],v16,0
R a[68:71],v16,1024
M v[120:123],a[100:103],a[4:7],v[120:123]
W a155,v155
W a156,v156
M v[120:123],a[104:107],a[8:11],v[120:123]
W a157,v157
AF v26,v18,v26
M v[120:123],a[108:111],a[12:15],v[120:123]
R a[72:75],v16,2048
R a[76:79],v16,3072
M v[120:123],a[112:115],a[16:19],v[120:123]
W a158,v158
C v56,v18,v19
M v[120:123],a[116:119],a[20:23],v[120:123]
E v21,v83
M v[120:123],a[120:123],a[24:27],v[120:123]
R a[80:83],v16,4096
R a[84:87],v16,5120
M v[120:123],a[124:127],a[28:31],v[120:123]
W a159,v159
AF v26,v19,v26
M v[124:127],a[124:127],a[60:63],0
E v22,v88
M v[124:127],a[120:123],a[56:59],v[124:127]
R a[88:91],v16,6144
R a[92:95],v16,7168
M v[124:127],a[116:119],a[52:55],v[124:127]
E v23,v89
M v[124:127],a[112:115],a[48:51],v[124:127]
E v24,v90
M v[124:127],a[108:111],a[44:47],v[124:127]
E v25,v91
M v[124:127],a[104:107],a[40:43],v[124:127]
E v18,v84
M v[124:127],a[100:103],a[36:39],v[124:127]
s_waitcnt lgkmcnt(0)
E v19,v85
M v[124:127],a[96:99],a[32:35],v[124:127]
AF v26,v20,v26
C v57,v20,v21
AF v26,v21,v26
AF v26,v22,v26
C v58,v22,v23
AF v26,v23,v26
AF v26,v24,v26
C v59,v24,v25
AF v26,v25,v26
E v20,v86
E v21,v87
AF v27,v18,v27
C v60,v18,v19
AF v27,v19,v27
E v22,v92
E v23,v93
AF v27,v20,v27
C v61,v20,v21
AF v27,v21,v27
E v24,v94
E v25,v95
AF v27,v22,v27
C v62,v22,v23
AF v27,v23,v27
AF v27,v24,v27
C v63,v24,v25
AF v27,v25,v27
v_max_f32 v10, v26, v27
v_min_f32 v11, v26, v27
v_cmp_lt_f32 vcc, s31, v10
v_cmp_gt_f32 s[64:65], s24, v11
s_nop 0
s_or_b64 vcc, vcc, s[64:65]
s_cbranch_vccnz L_stv1
L_rtv1:
M v[128:131],a[64:67],v[40:43],0
R a[96:99],v16,8192
R a[100:103],v16,9216
M v[128:131],a[68:71],v[56:59],v[128:131]
SA m0,s28,65536
W a160,v192
W a161,v193
M v[132:135],a[68:71],v[60:63],0
buffer_load_dwordx4 v3, s[8:11], s21 offen offset:0 sc1 lds
M v[132:135],a[64:67],v[44:47],v[132:135]
R a[104:107],v16,10240
R a[108:111],v16,11264
M v[136:139],a[72:75],v[40:43],0
W a162,v194
W a163,v195
M v[136:139],a[76:79],v[56:59],v[136:139]
W a164,v196
W a165,v197
M v[140:143],a[76:79],v[60:63],0
R a[112:115],v16,12288
R a[116:119],v16,13312
M v[140:143],a[72:75],v[44:47],v[140:143]
buffer_load_dwordx4 v3, s[8:11], s21 offen offset:1024 sc1 lds
M v[144:147],a[80:83],v[40:43],0
W a166,v198
W a167,v199
M v[144:147],a[84:87],v[56:59],v[144:147]
R a[120:123],v16,14336
R a[124:127],v16,15360
M v[148:151],a[84:87],v[60:63],0
SA s3,s93,262144
W a168,v200
W a169,v201
M v[148:151],a[80:83],v[44:47],v[148:151]
buffer_load_dwordx4 v3, s[8:11], s21 offen offset:2048 sc1 lds
M v[152:155],a[88:91],v[40:43],0
W a170,v202
W a171,v203
M v[152:155],a[92:95],v[56:59],v[152:155]
W a172,v204
W a173,v205
M v[156:159],a[92:95],v[60:63],0
buffer_store_dwordx4 a[128:131], v7, s[8:11], s3 offen offset:0 sc1
M v[156:159],a[88:91],v[44:47],v[156:159]
s_waitcnt lgkmcnt(0)
W a174,v206
W a175,v207
M v[160:163],a[96:99],v[40:43],0
R a[64:67],v16,16384
R a[68:71],v16,17408
M v[160:163],a[100:103],v[56:59],v[160:163]
buffer_load_dwordx4 v3, s[8:11], s21 offen offset:3072 sc1 lds
M v[164:167],a[100:103],v[60:63],0
SA m0,s28,69632
W a176,v208
W a177,v209
M v[164:167],a[96:99],v[44:47],v[164:167]
R a[72:75],v16,18432
R a[76:79],v16,19456
M v[168:171],a[104:107],v[40:43],0
buffer_load_dwordx4 v4, s[8:11], s21 offen offset:0 sc1 lds
M v[168:171],a[108:111],v[56:59],v[168:171]
W a178,v210
W a179,v211
M v[172:175],a[108:111],v[60:63],0
R a[80:83],v16,20480
R a[84:87],v16,21504
M v[172:175],a[104:107],v[44:47],v[172:175]
buffer_load_dwordx4 v4, s[8:11], s21 offen offset:1024 sc1 lds
M v[176:179],a[112:115],v[40:43],0
W a180,v212
W a181,v213
M v[176:179],a[116:119],v[56:59],v[176:179]
R a[88:91],v16,22528
R a[92:95],v16,23552
M v[180:183],a[116:119],v[60:63],0
buffer_load_dwordx4 v4, s[8:11], s21 offen offset:2048 sc1 lds
M v[180:183],a[112:115],v[44:47],v[180:183]
W a182,v214
W a183,v215
M v[184:187],a[120:123],v[40:43],0
W a184,v216
W a185,v217
W a186,v218
W a187,v219
W a188,v220
W a189,v221
W a190,v222
W a191,v223
M v[184:187],a[124:127],v[56:59],v[184:187]
E v18,v96
M v[188:191],a[124:127],v[60:63],0
buffer_load_dwordx4 v4, s[8:11], s21 offen offset:3072 sc1 lds
M v[188:191],a[120:123],v[44:47],v[188:191]
s_waitcnt lgkmcnt(0)
v_min_u32 v17, 1, v7
v_lshlrev_b32 v17, 29, v17
M v[192:195],a[64:67],v[40:43],0
SA s21,s21,32768
R a[96:99],v16,24576
R a[100:103],v16,25600
M v[192:195],a[68:71],v[56:59],v[192:195]
s_sub_u32 s22, s22, 1
buffer_store_dwordx4 a[132:135], v7, s[8:11], s3 offen offset:2048 sc1
M v[196:199],a[68:71],v[60:63],0
s_cselect_b32 s21, s23, s21
v_mov_b32 v15, 1
AF v30,v26,v30
M v[196:199],a[64:67],v[44:47],v[196:199]
SA s84,s47,16
R a[104:107],v16,26624
R a[108:111],v16,27648
M v[200:203],a[72:75],v[40:43],0
E v19,v97
M v[200:203],a[76:79],v[56:59],v[200:203]
E v20,v98
M v[204:207],a[76:79],v[60:63],0
R a[112:115],v16,28672
R a[116:119],v16,29696
M v[204:207],a[72:75],v[44:47],v[204:207]
E v21,v99
M v[208:211],a[80:83],v[40:43],0
E v22,v104
M v[208:211],a[84:87],v[56:59],v[208:211]
R a[120:123],v16,30720
R a[124:127],v16,31744
M v[212:215],a[84:87],v[60:63],0
SA s3,s93,266240
E v23,v105
M v[212:215],a[80:83],v[44:47],v[212:215]
buffer_store_dwordx4 a[136:139], v7, s[8:11], s3 offen offset:0 sc1
M v[216:219],a[88:91],v[40:43],0
AF v31,v27,v31
AF v28,v18,v19
M v[216:219],a[92:95],v[56:59],v[216:219]
E v24,v106
M v[220:223],a[92:95],v[60:63],0
s_waitcnt vmcnt(11) lgkmcnt(0)
E v25,v107
M v[220:223],a[88:91],v[44:47],v[220:223]
s_barrier
M v[224:227],a[96:99],v[40:43],0
R a[64:67],v2,32768
R a[68:71],v2,33792
M v[224:227],a[100:103],v[56:59],v[224:227]
buffer_store_dword v15, v17, s[8:11], s84 offen sc1
M v[228:231],a[100:103],v[60:63],0
C v48,v18,v19
AF v28,v20,v28
M v[228:231],a[96:99],v[44:47],v[228:231]
R a[72:75],v2,34816
R a[76:79],v2,35840
M v[232:235],a[104:107],v[40:43],0
E v18,v100
M v[232:235],a[108:111],v[56:59],v[232:235]
E v19,v101
M v[236:239],a[108:111],v[60:63],0
R a[80:83],v2,36864
R a[84:87],v2,37888
M v[236:239],a[104:107],v[44:47],v[236:239]
C v49,v20,v21
AF v28,v21,v28
M v[240:243],a[112:115],v[40:43],0
E v20,v102
M v[240:243],a[116:119],v[56:59],v[240:243]
R a[88:91],v2,38912
R a[92:95],v2,39936
M v[244:247],a[116:119],v[60:63],0
E v21,v103
M v[244:247],a[112:115],v[44:47],v[244:247]
AF v28,v22,v28
C v50,v22,v23
M v[248:251],a[120:123],v[40:43],0
AF v28,v23,v28
AF v28,v24,v28
M v[248:251],a[124:127],v[56:59],v[248:251]
E v22,v108
M v[252:255],a[124:127],v[60:63],0
s_waitcnt lgkmcnt(0)
E v23,v109
M v[252:255],a[120:123],v[44:47],v[252:255]
C v51,v24,v25
AF v28,v25,v28
AF v29,v18,v19
C v52,v18,v19
AF v29,v20,v29
C v53,v20,v21
AF v29,v21,v29
E v24,v110
E v25,v111
AF v29,v22,v29
C v54,v22,v23
AF v29,v23,v29
AF v29,v24,v29
C v55,v24,v25
AF v29,v25,v29
M v[64:67],a[64:67],a[0:3],v[32:35]
R a[96:99],v2,40960
R a[100:103],v2,41984
M v[64:67],a[68:71],a[4:7],v[64:67]
SA m0,s28,0
E v18,v112
M v[64:67],a[72:75],a[8:11],v[64:67]
buffer_load_dwordx4 v3, s[8:11], s26 offen offset:0 sc1 lds
M v[64:67],a[76:79],a[12:15],v[64:67]
R a[104:107],v2,43008
R a[108:111],v2,44032
M v[64:67],a[80:83],a[16:19],v[64:67]
E v19,v113
M v[64:67],a[84:87],a[20:23],v[64:67]
AF v28,v18,v28
C v56,v18,v19
M v[64:67],a[88:91],a[24:27],v[64:67]
R a[112:115],v2,45056
R a[116:119],v2,46080
M v[64:67],a[92:95],a[28:31],v[64:67]
buffer_load_dwordx4 v3, s[8:11], s26 offen offset:1024 sc1 lds
M v[68:71],a[92:95],a[60:63],v[36:39]
E v20,v114
M v[68:71],a[88:91],a[56:59],v[68:71]
R a[120:123],v2,47104
R a[124:127],v2,48128
M v[68:71],a[84:87],a[52:55],v[68:71]
SA s3,s93,266240
E v21,v115
M v[68:71],a[80:83],a[48:51],v[68:71]
buffer_load_dwordx4 v3, s[8:11], s26 offen offset:2048 sc1 lds
M v[68:71],a[76:79],a[44:47],v[68:71]
AF v28,v19,v28
AF v28,v20,v28
M v[68:71],a[72:75],a[40:43],v[68:71]
C v57,v20,v21
AF v28,v21,v28
M v[68:71],a[68:71],a[36:39],v[68:71]
buffer_store_dwordx4 a[140:143], v7, s[8:11], s3 offen offset:2048 sc1
M v[68:71],a[64:67],a[32:35],v[68:71]
s_waitcnt lgkmcnt(0)
E v22,v120
M v[72:75],a[96:99],a[0:3],v[32:35]
R a[64:67],v2,49152
R a[68:71],v2,50176
M v[72:75],a[100:103],a[4:7],v[72:75]
buffer_load_dwordx4 v3, s[8:11], s26 offen offset:3072 sc1 lds
M v[72:75],a[104:107],a[8:11],v[72:75]
SA m0,s28,4096
E v23,v121
M v[72:75],a[108:111],a[12:15],v[72:75]
R a[72:75],v2,51200
R a[76:79],v2,52224
M v[72:75],a[112:115],a[16:19],v[72:75]
buffer_load_dwordx4 v4, s[8:11], s26 offen offset:0 sc1 lds
M v[72:75],a[116:119],a[20:23],v[72:75]
E v24,v122
M v[72:75],a[120:123],a[24:27],v[72:75]
R a[80:83],v2,53248
R a[84:87],v2,54272
M v[72:75],a[124:127],a[28:31],v[72:75]
buffer_load_dwordx4 v4, s[8:11], s26 offen offset:1024 sc1 lds
M v[76:79],a[124:127],a[60:63],v[36:39]
E v25,v123
M v[76:79],a[120:123],a[56:59],v[76:79]
SA s3,s93,270336
R a[88:91],v2,55296
R a[92:95],v2,56320
M v[76:79],a[116:119],a[52:55],v[76:79]
buffer_load_dwordx4 v4, s[8:11], s26 offen offset:2048 sc1 lds
M v[76:79],a[112:115],a[48:51],v[76:79]
AF v28,v22,v28
C v58,v22,v23
M v[76:79],a[108:111],a[44:47],v[76:79]
E v18,v116
M v[76:79],a[104:107],a[40:43],v[76:79]
AF v28,v23,v28
AF v28,v24,v28
M v[76:79],a[100:103],a[36:39],v[76:79]
buffer_load_dwordx4 v4, s[8:11], s26 offen offset:3072 sc1 lds
M v[76:79],a[96:99],a[32:35],v[76:79]
s_waitcnt lgkmcnt(0)
E v19,v117
M v[80:83],a[64:67],a[0:3],v[32:35]
SA s26,s26,32768
R a[96:99],v2,57344
R a[100:103],v2,58368
M v[80:83],a[68:71],a[4:7],v[80:83]
buffer_store_dwordx4 a[144:147], v7, s[8:11], s3 offen offset:0 sc1
M v[80:83],a[72:75],a[8:11],v[80:83]
C v59,v24,v25
AF v28,v25,v28
M v[80:83],a[76:79],a[12:15],v[80:83]
R a[104:107],v2,59392
R a[108:111],v2,60416
M v[80:83],a[80:83],a[16:19],v[80:83]
E v20,v118
M v[80:83],a[84:87],a[20:23],v[80:83]
AF v29,v18,v29
C v60,v18,v19
M v[80:83],a[88:91],a[24:27],v[80:83]
R a[112:115],v2,61440
R a[116:119],v2,62464
M v[80:83],a[92:95],a[28:31],v[80:83]
E v21,v119
M v[84:87],a[92:95],a[60:63],v[36:39]
AF v29,v19,v29
AF v29,v20,v29
M v[84:87],a[88:91],a[56:59],v[84:87]
R a[120:123],v2,63488
R a[124:127],v2,64512
M v[84:87],a[84:87],a[52:55],v[84:87]
E v22,v124
M v[84:87],a[80:83],a[48:51],v[84:87]
buffer_store_dwordx4 a[148:151], v7, s[8:11], s3 offen offset:2048 sc1
M v[84:87],a[76:79],a[44:47],v[84:87]
C v61,v20,v21
AF v29,v21,v29
M v[84:87],a[72:75],a[40:43],v[84:87]
E v23,v125
M v[84:87],a[68:71],a[36:39],v[84:87]
s_waitcnt lgkmcnt(0)
AF v29,v22,v29
C v62,v22,v23
M v[84:87],a[64:67],a[32:35],v[84:87]
s_barrier
M v[88:91],a[96:99],a[0:3],v[32:35]
R a[64:67],v7,32768
R a[68:71],v7,33792
M v[88:91],a[100:103],a[4:7],v[88:91]
E v24,v126
M v[88:91],a[104:107],a[8:11],v[88:91]
AF v29,v23,v29
M v[88:91],a[108:111],a[12:15],v[88:91]
R a[72:75],v7,34816
R a[76:79],v7,35840
M v[88:91],a[112:115],a[16:19],v[88:91]
E v25,v127
M v[88:91],a[116:119],a[20:23],v[88:91]
AF v29,v24,v29
C v63,v24,v25
M v[88:91],a[120:123],a[24:27],v[88:91]
R a[80:83],v7,36864
R a[84:87],v7,37888
M v[88:91],a[124:127],a[28:31],v[88:91]
AF v29,v25,v29
M v[92:95],a[124:127],a[60:63],v[36:39]
M v[92:95],a[120:123],a[56:59],v[92:95]
R a[88:91],v7,38912
R a[92:95],v7,39936
M v[92:95],a[116:119],a[52:55],v[92:95]
v_max_f32 v10, v28, v29
M v[92:95],a[112:115],a[48:51],v[92:95]
v_cmp_lt_f32 vcc, s31, v10
M v[92:95],a[108:111],a[44:47],v[92:95]
M v[92:95],a[104:107],a[40:43],v[92:95]
M v[92:95],a[100:103],a[36:39],v[92:95]
s_waitcnt lgkmcnt(0)
M v[92:95],a[96:99],a[32:35],v[92:95]
s_cbranch_vccnz L_stv2
L_rtv2:
M v[128:131],a[64:67],v[48:51],v[128:131]
R a[96:99],v7,40960
R a[100:103],v7,41984
M v[128:131],a[68:71],v[56:59],v[128:131]
SA m0,s28,98304
E v18,v64
M v[132:135],a[68:71],v[60:63],v[132:135]
buffer_load_dwordx4 v3, s[8:11], s21 offen offset:0 sc1 lds
M v[132:135],a[64:67],v[52:55],v[132:135]
R a[104:107],v7,43008
R a[108:111],v7,44032
M v[136:139],a[72:75],v[48:51],v[136:139]
E v19,v65
M v[136:139],a[76:79],v[56:59],v[136:139]
AF v30,v28,v30
AF v31,v29,v31
M v[140:143],a[76:79],v[60:63],v[140:143]
R a[112:115],v7,45056
R a[116:119],v7,46080
M v[140:143],a[72:75],v[52:55],v[140:143]
buffer_load_dwordx4 v3, s[8:11], s21 offen offset:1024 sc1 lds
M v[144:147],a[80:83],v[48:51],v[144:147]
E v20,v66
M v[144:147],a[84:87],v[56:59],v[144:147]
R a[120:123],v7,47104
R a[124:127],v7,48128
M v[148:151],a[84:87],v[60:63],v[148:151]
SA s3,s93,274432
AF v26,v18,v19
C v40,v18,v19
M v[148:151],a[80:83],v[52:55],v[148:151]
buffer_load_dwordx4 v3, s[8:11], s21 offen offset:2048 sc1 lds
M v[152:155],a[88:91],v[48:51],v[152:155]
E v21,v67
M v[152:155],a[92:95],v[56:59],v[152:155]
AF v26,v20,v26
C v41,v20,v21
M v[156:159],a[92:95],v[60:63],v[156:159]
buffer_store_dwordx4 a[152:155], v7, s[8:11], s3 offen offset:0 sc1
M v[156:159],a[88:91],v[52:55],v[156:159]
s_waitcnt lgkmcnt(0)
E v22,v72
M v[160:163],a[96:99],v[48:51],v[160:163]
R a[64:67],v7,49152
R a[68:71],v7,50176
M v[160:163],a[100:103],v[56:59],v[160:163]
buffer_load_dwordx4 v3, s[8:11], s21 offen offset:3072 sc1 lds
M v[164:167],a[100:103],v[60:63],v[164:167]
SA m0,s28,102400
E v23,v73
M v[164:167],a[96:99],v[52:55],v[164:167]
R a[72:75],v7,51200
R a[76:79],v7,52224
M v[168:171],a[104:107],v[48:51],v[168:171]
buffer_load_dwordx4 v4, s[8:11], s21 offen offset:0 sc1 lds
M v[168:171],a[108:111],v[56:59],v[168:171]
AF v26,v21,v26
AF v26,v22,v26
M v[172:175],a[108:111],v[60:63],v[172:175]
R a[80:83],v7,53248
R a[84:87],v7,54272
M v[172:175],a[104:107],v[52:55],v[172:175]
buffer_load_dwordx4 v4, s[8:11], s21 offen offset:1024 sc1 lds
M v[176:179],a[112:115],v[48:51],v[176:179]
E v24,v74
M v[176:179],a[116:119],v[56:59],v[176:179]
R a[88:91],v7,55296
R a[92:95],v7,56320
M v[180:183],a[116:119],v[60:63],v[180:183]
buffer_load_dwordx4 v4, s[8:11], s21 offen offset:2048 sc1 lds
M v[180:183],a[112:115],v[52:55],v[180:183]
E v25,v75
M v[184:187],a[120:123],v[48:51],v[184:187]
C v42,v22,v23
AF v26,v23,v26
M v[184:187],a[124:127],v[56:59],v[184:187]
AF v26,v24,v26
C v43,v24,v25
M v[188:191],a[124:127],v[60:63],v[188:191]
buffer_load_dwordx4 v4, s[8:11], s21 offen offset:3072 sc1 lds
M v[188:191],a[120:123],v[52:55],v[188:191]
s_waitcnt lgkmcnt(0)
E v18,v68
M v[192:195],a[64:67],v[48:51],v[192:195]
SA s21,s21,32768
R a[96:99],v7,57344
R a[100:103],v7,58368
M v[192:195],a[68:71],v[56:59],v[192:195]
s_sub_u32 s22, s22, 1
buffer_store_dwordx4 a[156:159], v7, s[8:11], s3 offen offset:2048 sc1
M v[196:199],a[68:71],v[60:63],v[196:199]
s_cselect_b32 s21, s23, s21
E v19,v69
M v[196:199],a[64:67],v[52:55],v[196:199]
R a[104:107],v7,59392
R a[108:111],v7,60416
M v[200:203],a[72:75],v[48:51],v[200:203]
AF v26,v25,v26
AF v27,v18,v19
M v[200:203],a[76:79],v[56:59],v[200:203]
E v20,v70
M v[204:207],a[76:79],v[60:63],v[204:207]
R a[112:115],v7,61440
R a[116:119],v7,62464
M v[204:207],a[72:75],v[52:55],v[204:207]
C v44,v18,v19
M v[208:211],a[80:83],v[48:51],v[208:211]
M v[208:211],a[84:87],v[56:59],v[208:211]
R a[120:123],v7,63488
R a[124:127],v7,64512
M v[212:215],a[84:87],v[60:63],v[212:215]
SA s3,s93,786432
E v21,v71
M v[212:215],a[80:83],v[52:55],v[212:215]
buffer_store_dwordx4 a[160:163], v7, s[8:11], s3 offen offset:0 sc1
M v[216:219],a[88:91],v[48:51],v[216:219]
AF v27,v20,v27
C v45,v20,v21
M v[216:219],a[92:95],v[56:59],v[216:219]
E v22,v76
M v[220:223],a[92:95],v[60:63],v[220:223]
s_waitcnt vmcnt(25) lgkmcnt(0)
AF v27,v21,v27
M v[220:223],a[88:91],v[52:55],v[220:223]
s_barrier
M v[224:227],a[96:99],v[48:51],v[224:227]
R a[64:67],v2,0
R a[68:71],v2,1024
M v[224:227],a[100:103],v[56:59],v[224:227]
E v23,v77
M v[228:231],a[100:103],v[60:63],v[228:231]
AF v27,v22,v27
C v46,v22,v23
M v[228:231],a[96:99],v[52:55],v[228:231]
R a[72:75],v2,2048
R a[76:79],v2,3072
M v[232:235],a[104:107],v[48:51],v[232:235]
E v24,v78
M v[232:235],a[108:111],v[56:59],v[232:235]
AF v27,v23,v27
M v[236:239],a[108:111],v[60:63],v[236:239]
R a[80:83],v2,4096
R a[84:87],v2,5120
M v[236:239],a[104:107],v[52:55],v[236:239]
M v[240:243],a[112:115],v[48:51],v[240:243]
E v25,v79
M v[240:243],a[116:119],v[56:59],v[240:243]
R a[88:91],v2,6144
R a[92:95],v2,7168
M v[244:247],a[116:119],v[60:63],v[244:247]
AF v27,v24,v27
C v47,v24,v25
M v[244:247],a[112:115],v[52:55],v[244:247]
AF v27,v25,v27
M v[248:251],a[120:123],v[48:51],v[248:251]
M v[248:251],a[124:127],v[56:59],v[248:251]
M v[252:255],a[124:127],v[60:63],v[252:255]
s_waitcnt lgkmcnt(0)
M v[252:255],a[120:123],v[52:55],v[252:255]
M v[96:99],a[64:67],a[0:3],v[32:35]
R a[96:99],v2,8192
R a[100:103],v2,9216
M v[96:99],a[68:71],a[4:7],v[96:99]
SA m0,s28,32768
E v18,v80
M v[96:99],a[72:75],a[8:11],v[96:99]
buffer_load_dwordx4 v3, s[8:11], s26 offen offset:0 sc1 lds
M v[96:99],a[76:79],a[12:15],v[96:99]
R a[104:107],v2,10240
R a[108:111],v2,11264
M v[96:99],a[80:83],a[16:19],v[96:99]
E v19,v81
M v[96:99],a[84:87],a[20:23],v[96:99]
AF v26,v18,v26
C v56,v18,v19
M v[96:99],a[88:91],a[24:27],v[96:99]
R a[112:115],v2,12288
R a[116:119],v2,13312
M v[96:99],a[92:95],a[28:31],v[96:99]
buffer_load_dwordx4 v3, s[8:11], s26 offen offset:1024 sc1 lds
M v[100:103],a[92:95],a[60:63],v[36:39]
E v20,v82
M v[100:103],a[88:91],a[56:59],v[100:103]
R a[120:123],v2,14336
R a[124:127],v2,15360
M v[100:103],a[84:87],a[52:55],v[100:103]
SA s3,s93,786432
E v21,v83
M v[100:103],a[80:83],a[48:51],v[100:103]
buffer_load_dwordx4 v3, s[8:11], s26 offen offset:2048 sc1 lds
M v[100:103],a[76:79],a[44:47],v[100:103]
AF v26,v19,v26
AF v26,v20,v26
M v[100:103],a[72:75],a[40:43],v[100:103]
C v57,v20,v21
AF v26,v21,v26
M v[100:103],a[68:71],a[36:39],v[100:103]
buffer_store_dwordx4 a[164:167], v7, s[8:11], s3 offen offset:2048 sc1
M v[100:103],a[64:67],a[32:35],v[100:103]
s_waitcnt lgkmcnt(0)
E v22,v88
M v[104:107],a[96:99],a[0:3],v[32:35]
R a[64:67],v2,16384
R a[68:71],v2,17408
M v[104:107],a[100:103],a[4:7],v[104:107]
buffer_load_dwordx4 v3, s[8:11], s26 offen offset:3072 sc1 lds
M v[104:107],a[104:107],a[8:11],v[104:107]
SA m0,s28,36864
E v23,v89
M v[104:107],a[108:111],a[12:15],v[104:107]
R a[72:75],v2,18432
R a[76:79],v2,19456
M v[104:107],a[112:115],a[16:19],v[104:107]
buffer_load_dwordx4 v4, s[8:11], s26 offen offset:0 sc1 lds
M v[104:107],a[116:119],a[20:23],v[104:107]
SA s3,s93,790528
E v24,v90
M v[104:107],a[120:123],a[24:27],v[104:107]
R a[80:83],v2,20480
R a[84:87],v2,21504
M v[104:107],a[124:127],a[28:31],v[104:107]
buffer_load_dwordx4 v4, s[8:11], s26 offen offset:1024 sc1 lds
M v[108:111],a[124:127],a[60:63],v[36:39]
E v25,v91
M v[108:111],a[120:123],a[56:59],v[108:111]
R a[88:91],v2,22528
R a[92:95],v2,23552
M v[108:111],a[116:119],a[52:55],v[108:111]
buffer_load_dwordx4 v4, s[8:11], s26 offen offset:2048 sc1 lds
M v[108:111],a[112:115],a[48:51],v[108:111]
AF v26,v22,v26
C v58,v22,v23
M v[108:111],a[108:111],a[44:47],v[108:111]
E v18,v84
M v[108:111],a[104:107],a[40:43],v[108:111]
buffer_store_dwordx4 a[168:171], v7, s[8:11], s3 offen offset:0 sc1
M v[108:111],a[100:103],a[36:39],v[108:111]
AF v26,v23,v26
AF v26,v24,v26
M v[108:111],a[96:99],a[32:35],v[108:111]
s_waitcnt lgkmcnt(0)
E v19,v85
M v[112:115],a[64:67],a[0:3],v[32:35]
R a[96:99],v2,24576
R a[100:103],v2,25600
M v[112:115],a[68:71],a[4:7],v[112:115]
buffer_load_dwordx4 v4, s[8:11], s26 offen offset:3072 sc1 lds
M v[112:115],a[72:75],a[8:11],v[112:115]
SA s26,s26,32768
C v59,v24,v25
AF v26,v25,v26
M v[112:115],a[76:79],a[12:15],v[112:115]
R a[104:107],v2,26624
R a[108:111],v2,27648
M v[112:115],a[80:83],a[16:19],v[112:115]
E v20,v86
M v[112:115],a[84:87],a[20:23],v[112:115]
buffer_store_dwordx4 a[172:175], v7, s[8:11], s3 offen offset:2048 sc1
M v[112:115],a[88:91],a[24:27],v[112:115]
R a[112:115],v2,28672
R a[116:119],v2,29696
M v[112:115],a[92:95],a[28:31],v[112:115]
E v21,v87
M v[116:119],a[92:95],a[60:63],v[36:39]
AF v27,v18,v27
C v60,v18,v19
M v[116:119],a[88:91],a[56:59],v[116:119]
R a[120:123],v2,30720
R a[124:127],v2,31744
M v[116:119],a[84:87],a[52:55],v[116:119]
E v22,v92
M v[116:119],a[80:83],a[48:51],v[116:119]
AF v27,v19,v27
AF v27,v20,v27
M v[116:119],a[76:79],a[44:47],v[116:119]
C v61,v20,v21
AF v27,v21,v27
M v[116:119],a[72:75],a[40:43],v[116:119]
E v23,v93
M v[116:119],a[68:71],a[36:39],v[116:119]
s_waitcnt vmcnt(24) lgkmcnt(0)
AF v27,v22,v27
C v62,v22,v23
M v[116:119],a[64:67],a[32:35],v[116:119]
s_barrier
M v[120:123],a[96:99],a[0:3],v[32:35]
SA s3,s93,794624
R a[64:67],v7,0
R a[68:71],v7,1024
M v[120:123],a[100:103],a[4:7],v[120:123]
buffer_store_dwordx4 a[176:179], v7, s[8:11], s3 offen offset:0 sc1
M v[120:123],a[104:107],a[8:11],v[120:123]
E v24,v94
M v[120:123],a[108:111],a[12:15],v[120:123]
R a[72:75],v7,2048
R a[76:79],v7,3072
M v[120:123],a[112:115],a[16:19],v[120:123]
E v25,v95
M v[120:123],a[116:119],a[20:23],v[120:123]
AF v27,v23,v27
AF v27,v24,v27
M v[120:123],a[120:123],a[24:27],v[120:123]
R a[80:83],v7,4096
R a[84:87],v7,5120
M v[120:123],a[124:127],a[28:31],v[120:123]
C v63,v24,v25
AF v27,v25,v27
M v[124:127],a[124:127],a[60:63],v[36:39]
M v[124:127],a[120:123],a[56:59],v[124:127]
R a[88:91],v7,6144
R a[92:95],v7,7168
M v[124:127],a[116:119],a[52:55],v[124:127]
v_max_f32 v10, v26, v27
M v[124:127],a[112:115],a[48:51],v[124:127]
v_cmp_lt_f32 vcc, s31, v10
M v[124:127],a[108:111],a[44:47],v[124:127]
M v[124:127],a[104:107],a[40:43],v[124:127]
M v[124:127],a[100:103],a[36:39],v[124:127]
s_waitcnt lgkmcnt(0)
M v[124:127],a[96:99],a[32:35],v[124:127]
s_cbranch_vccnz L_stv3
L_rtv3:
M v[128:131],a[64:67],v[40:43],v[128:131]
R a[96:99],v7,8192
R a[100:103],v7,9216
M v[128:131],a[68:71],v[56:59],v[128:131]
SA m0,s28,65536
E v18,v96
M v[132:135],a[68:71],v[60:63],v[132:135]
buffer_load_dwordx4 v3, s[8:11], s21 offen offset:0 sc1 lds
M v[132:135],a[64:67],v[44:47],v[132:135]
R a[104:107],v7,10240
R a[108:111],v7,11264
M v[136:139],a[72:75],v[40:43],v[136:139]
E v19,v97
M v[136:139],a[76:79],v[56:59],v[136:139]
AF v30,v26,v30
AF v31,v27,v31
M v[140:143],a[76:79],v[60:63],v[140:143]
R a[112:115],v7,12288
R a[116:119],v7,13312
M v[140:143],a[72:75],v[44:47],v[140:143]
buffer_load_dwordx4 v3, s[8:11], s21 offen offset:1024 sc1 lds
M v[144:147],a[80:83],v[40:43],v[144:147]
E v20,v98
M v[144:147],a[84:87],v[56:59],v[144:147]
R a[120:123],v7,14336
R a[124:127],v7,15360
M v[148:151],a[84:87],v[60:63],v[148:151]
SA s3,s93,794624
AF v28,v18,v19
C v48,v18,v19
M v[148:151],a[80:83],v[44:47],v[148:151]
buffer_load_dwordx4 v3, s[8:11], s21 offen offset:2048 sc1 lds
M v[152:155],a[88:91],v[40:43],v[152:155]
E v21,v99
M v[152:155],a[92:95],v[56:59],v[152:155]
AF v28,v20,v28
C v49,v20,v21
M v[156:159],a[92:95],v[60:63],v[156:159]
buffer_store_dwordx4 a[180:183], v7, s[8:11], s3 offen offset:2048 sc1
M v[156:159],a[88:91],v[44:47],v[156:159]
s_waitcnt lgkmcnt(0)
E v22,v104
M v[160:163],a[96:99],v[40:43],v[160:163]
R a[64:67],v7,16384
R a[68:71],v7,17408
M v[160:163],a[100:103],v[56:59],v[160:163]
buffer_load_dwordx4 v3, s[8:11], s21 offen offset:3072 sc1 lds
M v[164:167],a[100:103],v[60:63],v[164:167]
SA m0,s28,69632
E v23,v105
M v[164:167],a[96:99],v[44:47],v[164:167]
R a[72:75],v7,18432
R a[76:79],v7,19456
M v[168:171],a[104:107],v[40:43],v[168:171]
buffer_load_dwordx4 v4, s[8:11], s21 offen offset:0 sc1 lds
M v[168:171],a[108:111],v[56:59],v[168:171]
AF v28,v21,v28
AF v28,v22,v28
M v[172:175],a[108:111],v[60:63],v[172:175]
R a[80:83],v7,20480
R a[84:87],v7,21504
M v[172:175],a[104:107],v[44:47],v[172:175]
buffer_load_dwordx4 v4, s[8:11], s21 offen offset:1024 sc1 lds
M v[176:179],a[112:115],v[40:43],v[176:179]
E v24,v106
M v[176:179],a[116:119],v[56:59],v[176:179]
SA s3,s93,798720
R a[88:91],v7,22528
R a[92:95],v7,23552
M v[180:183],a[116:119],v[60:63],v[180:183]
buffer_load_dwordx4 v4, s[8:11], s21 offen offset:2048 sc1 lds
M v[180:183],a[112:115],v[44:47],v[180:183]
E v25,v107
M v[184:187],a[120:123],v[40:43],v[184:187]
C v50,v22,v23
AF v28,v23,v28
M v[184:187],a[124:127],v[56:59],v[184:187]
AF v28,v24,v28
C v51,v24,v25
M v[188:191],a[124:127],v[60:63],v[188:191]
buffer_load_dwordx4 v4, s[8:11], s21 offen offset:3072 sc1 lds
M v[188:191],a[120:123],v[44:47],v[188:191]
s_waitcnt lgkmcnt(0)
E v18,v100
M v[192:195],a[64:67],v[40:43],v[192:195]
SA s21,s21,32768
R a[96:99],v7,24576
R a[100:103],v7,25600
M v[192:195],a[68:71],v[56:59],v[192:195]
s_sub_u32 s22, s22, 1
buffer_store_dwordx4 a[184:187], v7, s[8:11], s3 offen offset:0 sc1
M v[196:199],a[68:71],v[60:63],v[196:199]
s_cselect_b32 s21, s23, s21
E v19,v101
M v[196:199],a[64:67],v[44:47],v[196:199]
R a[104:107],v7,26624
R a[108:111],v7,27648
M v[200:203],a[72:75],v[40:43],v[200:203]
AF v28,v25,v28
AF v29,v18,v19
M v[200:203],a[76:79],v[56:59],v[200:203]
E v20,v102
M v[204:207],a[76:79],v[60:63],v[204:207]
R a[112:115],v7,28672
R a[116:119],v7,29696
M v[204:207],a[72:75],v[44:47],v[204:207]
C v52,v18,v19
M v[208:211],a[80:83],v[40:43],v[208:211]
M v[208:211],a[84:87],v[56:59],v[208:211]
R a[120:123],v7,30720
R a[124:127],v7,31744
M v[212:215],a[84:87],v[60:63],v[212:215]
E v21,v103
M v[212:215],a[80:83],v[44:47],v[212:215]
buffer_store_dwordx4 a[188:191], v7, s[8:11], s3 offen offset:2048 sc1
M v[216:219],a[88:91],v[40:43],v[216:219]
AF v29,v20,v29
C v53,v20,v21
M v[216:219],a[92:95],v[56:59],v[216:219]
E v22,v108
M v[220:223],a[92:95],v[60:63],v[220:223]
s_waitcnt vmcnt(25) lgkmcnt(0)
AF v29,v21,v29
M v[220:223],a[88:91],v[44:47],v[220:223]
s_barrier
M v[224:227],a[96:99],v[40:43],v[224:227]
R a[64:67],v2,32768
R a[68:71],v2,33792
M v[224:227],a[100:103],v[56:59],v[224:227]
E v23,v109
M v[228:231],a[100:103],v[60:63],v[228:231]
AF v29,v22,v29
C v54,v22,v23
M v[228:231],a[96:99],v[44:47],v[228:231]
R a[72:75],v2,34816
R a[76:79],v2,35840
M v[232:235],a[104:107],v[40:43],v[232:235]
E v24,v110
M v[232:235],a[108:111],v[56:59],v[232:235]
AF v29,v23,v29
M v[236:239],a[108:111],v[60:63],v[236:239]
R a[80:83],v2,36864
R a[84:87],v2,37888
M v[236:239],a[104:107],v[44:47],v[236:239]
M v[240:243],a[112:115],v[40:43],v[240:243]
E v25,v111
M v[240:243],a[116:119],v[56:59],v[240:243]
R a[88:91],v2,38912
R a[92:95],v2,39936
M v[244:247],a[116:119],v[60:63],v[244:247]
AF v29,v24,v29
C v55,v24,v25
M v[244:247],a[112:115],v[44:47],v[244:247]
AF v29,v25,v29
M v[248:251],a[120:123],v[40:43],v[248:251]
M v[248:251],a[124:127],v[56:59],v[248:251]
M v[252:255],a[124:127],v[60:63],v[252:255]
s_waitcnt lgkmcnt(0)
M v[252:255],a[120:123],v[44:47],v[252:255]
s_branch L_loop_top
L_st0:
s_call_b64 s[36:37], L_slow0
s_branch L_rt0
L_st1:
s_call_b64 s[36:37], L_slow1
s_branch L_rt1
L_stv1:
s_call_b64 s[36:37], L_slowf
s_branch L_rtv1
L_stk1:
s_call_b64 s[36:37], L_slowf
s_branch L_rtk1
L_sth1:
s_call_b64 s[36:37], L_slowf
s_branch L_rth1
L_stj0:
s_call_b64 s[36:37], L_slowj
s_branch L_rtj0
L_stv2:
s_call_b64 s[36:37], L_slow1
s_branch L_rtv2
L_stv3:
s_call_b64 s[36:37], L_slow0
s_branch L_rtv3
L_std1:
s_call_b64 s[36:37], L_slow1
s_branch L_rtd1
L_std3n:
s_call_b64 s[36:37], L_slow0
s_branch L_rtd3n
L_std3h:
s_call_b64 s[36:37], L_slow0
s_branch L_rtd3h
L_std4n:
s_call_b64 s[36:37], L_slowb
s_branch L_rtd4n
L_std4h:
s_call_b64 s[36:37], L_slowb
s_branch L_rtd4h
L_stfh:
s_call_b64 s[36:37], L_slow1n
s_branch L_rtfh
L_stc:
s_call_b64 s[36:37], L_comb
s_branch L_rtc
L_slow0:
s_nop 7
s_nop 3
v_max3_f32 v10, v64, v65, v66
v_max3_f32 v10, v67, v72, v10
v_max3_f32 v10, v73, v74, v10
v_max3_f32 v10, v75, v80, v10
v_max3_f32 v10, v81, v82, v10
v_max3_f32 v10, v83, v88, v10
v_max3_f32 v10, v89, v90, v10
v_max_f32 v10, v91, v10
v_max3_f32 v11, v68, v69, v70
v_max3_f32 v11, v71, v76, v11
v_max3_f32 v11, v77, v78, v11
v_max3_f32 v11, v79, v84, v11
v_max3_f32 v11, v85, v86, v11
v_max3_f32 v11, v87, v92, v11
v_max3_f32 v11, v93, v94, v11
v_max_f32 v11, v95, v11
v_mov_b32 v12, v10
v_mov_b32 v13, v11
s_nop 0
v_permlane16_swap_b32 v12, v10
v_permlane16_swap_b32 v13, v11
v_max_f32 v10, v12, v10
v_max_f32 v11, v13, v11
v_mov_b32 v12, v10
v_mov_b32 v13, v11
s_nop 0
v_permlane32_swap_b32 v12, v10
v_permlane32_swap_b32 v13, v11
v_max_f32 v10, v12, v10
v_max_f32 v11, v13, v11
v_ceil_f32 v10, v10
v_ceil_f32 v11, v11
v_max_f32 v10, 0, v10
v_max_f32 v11, 0, v11
v_sub_f32 v64, v64, v10
v_sub_f32 v65, v65, v10
v_sub_f32 v66, v66, v10
v_sub_f32 v67, v67, v10
v_sub_f32 v68, v68, v11
v_sub_f32 v69, v69, v11
v_sub_f32 v70, v70, v11
v_sub_f32 v71, v71, v11
v_sub_f32 v72, v72, v10
v_sub_f32 v73, v73, v10
v_sub_f32 v74, v74, v10
v_sub_f32 v75, v75, v10
v_sub_f32 v76, v76, v11
v_sub_f32 v77, v77, v11
v_sub_f32 v78, v78, v11
v_sub_f32 v79, v79, v11
v_sub_f32 v80, v80, v10
v_sub_f32 v81, v81, v10
v_sub_f32 v82, v82, v10
v_sub_f32 v83, v83, v10
v_sub_f32 v84, v84, v11
v_sub_f32 v85, v85, v11
v_sub_f32 v86, v86, v11
v_sub_f32 v87, v87, v11
v_sub_f32 v88, v88, v10
v_sub_f32 v89, v89, v10
v_sub_f32 v90, v90, v10
v_sub_f32 v91, v91, v10
v_sub_f32 v92, v92, v11
v_sub_f32 v93, v93, v11
v_sub_f32 v94, v94, v11
v_sub_f32 v95, v95, v11
v_sub_f32 v96, v96, v10
v_sub_f32 v97, v97, v10
v_sub_f32 v98, v98, v10
v_sub_f32 v99, v99, v10
v_sub_f32 v100, v100, v11
v_sub_f32 v101, v101, v11
v_sub_f32 v102, v102, v11
v_sub_f32 v103, v103, v11
v_sub_f32 v104, v104, v10
v_sub_f32 v105, v105, v10
v_sub_f32 v106, v106, v10
v_sub_f32 v107, v107, v10
v_sub_f32 v108, v108, v11
v_sub_f32 v109, v109, v11
v_sub_f32 v110, v110, v11
v_sub_f32 v111, v111, v11
v_sub_f32 v112, v112, v10
v_sub_f32 v113, v113, v10
v_sub_f32 v114, v114, v10
v_sub_f32 v115, v115, v10
v_sub_f32 v116, v116, v11
v_sub_f32 v117, v117, v11
v_sub_f32 v118, v118, v11
v_sub_f32 v119, v119, v11
v_sub_f32 v120, v120, v10
v_sub_f32 v121, v121, v10
v_sub_f32 v122, v122, v10
v_sub_f32 v123, v123, v10
v_sub_f32 v124, v124, v11
v_sub_f32 v125, v125, v11
v_sub_f32 v126, v126, v11
v_sub_f32 v127, v127, v11
v_sub_f32 v32, v32, v10
v_sub_f32 v33, v33, v10
v_sub_f32 v34, v34, v10
v_sub_f32 v35, v35, v10
v_sub_f32 v36, v36, v11
v_sub_f32 v37, v37, v11
v_sub_f32 v38, v38, v11
v_sub_f32 v39, v39, v11
E v12,-v10
E v13,-v11
MF v30,v12,v30
MF v31,v13,v31
MF v128,v12,v128
MF v129,v12,v129
MF v130,v12,v130
MF v131,v12,v131
MF v132,v13,v132
MF v133,v13,v133
MF v134,v13,v134
MF v135,v13,v135
MF v136,v12,v136
MF v137,v12,v137
MF v138,v12,v138
MF v139,v12,v139
MF v140,v13,v140
MF v141,v13,v141
MF v142,v13,v142
MF v143,v13,v143
MF v144,v12,v144
MF v145,v12,v145
MF v146,v12,v146
MF v147,v12,v147
MF v148,v13,v148
MF v149,v13,v149
MF v150,v13,v150
MF v151,v13,v151
MF v152,v12,v152
MF v153,v12,v153
MF v154,v12,v154
MF v155,v12,v155
MF v156,v13,v156
MF v157,v13,v157
MF v158,v13,v158
MF v159,v13,v159
MF v160,v12,v160
MF v161,v12,v161
MF v162,v12,v162
MF v163,v12,v163
MF v164,v13,v164
MF v165,v13,v165
MF v166,v13,v166
MF v167,v13,v167
MF v168,v12,v168
MF v169,v12,v169
MF v170,v12,v170
MF v171,v12,v171
MF v172,v13,v172
MF v173,v13,v173
MF v174,v13,v174
MF v175,v13,v175
MF v176,v12,v176
MF v177,v12,v177
MF v178,v12,v178
MF v179,v12,v179
MF v180,v13,v180
MF v181,v13,v181
MF v182,v13,v182
MF v183,v13,v183
MF v184,v12,v184
MF v185,v12,v185
MF v186,v12,v186
MF v187,v12,v187
MF v188,v13,v188
MF v189,v13,v189
MF v190,v13,v190
MF v191,v13,v191
MF v192,v12,v192
MF v193,v12,v193
MF v194,v12,v194
MF v195,v12,v195
MF v196,v13,v196
MF v197,v13,v197
MF v198,v13,v198
MF v199,v13,v199
MF v200,v12,v200
MF v201,v12,v201
MF v202,v12,v202
MF v203,v12,v203
MF v204,v13,v204
MF v205,v13,v205
MF v206,v13,v206
MF v207,v13,v207
MF v208,v12,v208
MF v209,v12,v209
MF v210,v12,v210
MF v211,v12,v211
MF v212,v13,v212
MF v213,v13,v213
MF v214,v13,v214
MF v215,v13,v215
MF v216,v12,v216
MF v217,v12,v217
MF v218,v12,v218
MF v219,v12,v219
MF v220,v13,v220
MF v221,v13,v221
MF v222,v13,v222
MF v223,v13,v223
MF v224,v12,v224
MF v225,v12,v225
MF v226,v12,v226
MF v227,v12,v227
MF v228,v13,v228
MF v229,v13,v229
MF v230,v13,v230
MF v231,v13,v231
MF v232,v12,v232
MF v233,v12,v233
MF v234,v12,v234
MF v235,v12,v235
MF v236,v13,v236
MF v237,v13,v237
MF v238,v13,v238
MF v239,v13,v239
MF v240,v12,v240
MF v241,v12,v241
MF v242,v12,v242
MF v243,v12,v243
MF v244,v13,v244
MF v245,v13,v245
MF v246,v13,v246
MF v247,v13,v247
MF v248,v12,v248
MF v249,v12,v249
MF v250,v12,v250
MF v251,v12,v251
MF v252,v13,v252
MF v253,v13,v253
MF v254,v13,v254
MF v255,v13,v255
E v18,v64
E v19,v65
E v20,v66
AF v26,v18,v19
C v40,v18,v19
E v21,v67
E v22,v72
AF v26,v20,v26
C v41,v20,v21
E v23,v73
AF v26,v21,v26
E v24,v74
AF v26,v22,v26
C v42,v22,v23
E v25,v75
AF v26,v23,v26
E v18,v68
AF v26,v24,v26
C v43,v24,v25
E v19,v69
AF v26,v25,v26
E v20,v70
AF v27,v18,v19
C v44,v18,v19
E v21,v71
E v22,v76
AF v27,v20,v27
C v45,v20,v21
E v23,v77
AF v27,v21,v27
E v24,v78
AF v27,v22,v27
C v46,v22,v23
E v25,v79
AF v27,v23,v27
AF v27,v24,v27
C v47,v24,v25
AF v27,v25,v27
E v18,v80
E v19,v81
E v20,v82
AF v26,v18,v26
C v56,v18,v19
E v21,v83
AF v26,v19,v26
E v22,v88
AF v26,v20,v26
C v57,v20,v21
E v23,v89
AF v26,v21,v26
E v24,v90
AF v26,v22,v26
C v58,v22,v23
E v25,v91
AF v26,v23,v26
E v18,v84
AF v26,v24,v26
C v59,v24,v25
E v19,v85
AF v26,v25,v26
E v20,v86
AF v27,v18,v27
C v60,v18,v19
E v21,v87
AF v27,v19,v27
E v22,v92
AF v27,v20,v27
C v61,v20,v21
E v23,v93
AF v27,v21,v27
E v24,v94
AF v27,v22,v27
C v62,v22,v23
E v25,v95
AF v27,v23,v27
AF v27,v24,v27
C v63,v24,v25
AF v27,v25,v27
s_nop 3
s_setpc_b64 s[36:37]
L_slow1:
s_nop 7
s_nop 3
v_max3_f32 v10, v96, v97, v98
v_max3_f32 v10, v99, v104, v10
v_max3_f32 v10, v105, v106, v10
v_max3_f32 v10, v107, v112, v10
v_max3_f32 v10, v113, v114, v10
v_max3_f32 v10, v115, v120, v10
v_max3_f32 v10, v121, v122, v10
v_max_f32 v10, v123, v10
v_max3_f32 v11, v100, v101, v102
v_max3_f32 v11, v103, v108, v11
v_max3_f32 v11, v109, v110, v11
v_max3_f32 v11, v111, v116, v11
v_max3_f32 v11, v117, v118, v11
v_max3_f32 v11, v119, v124, v11
v_max3_f32 v11, v125, v126, v11
v_max_f32 v11, v127, v11
v_mov_b32 v12, v10
v_mov_b32 v13, v11
s_nop 0
v_permlane16_swap_b32 v12, v10
v_permlane16_swap_b32 v13, v11
v_max_f32 v10, v12, v10
v_max_f32 v11, v13, v11
v_mov_b32 v12, v10
v_mov_b32 v13, v11
s_nop 0
v_permlane32_swap_b32 v12, v10
v_permlane32_swap_b32 v13, v11
v_max_f32 v10, v12, v10
v_max_f32 v11, v13, v11
v_ceil_f32 v10, v10
v_ceil_f32 v11, v11
v_max_f32 v10, 0, v10
v_max_f32 v11, 0, v11
v_sub_f32 v96, v96, v10
v_sub_f32 v97, v97, v10
v_sub_f32 v98, v98, v10
v_sub_f32 v99, v99, v10
v_sub_f32 v100, v100, v11
v_sub_f32 v101, v101, v11
v_sub_f32 v102, v102, v11
v_sub_f32 v103, v103, v11
v_sub_f32 v104, v104, v10
v_sub_f32 v105, v105, v10
v_sub_f32 v106, v106, v10
v_sub_f32 v107, v107, v10
v_sub_f32 v108, v108, v11
v_sub_f32 v109, v109, v11
v_sub_f32 v110, v110, v11
v_sub_f32 v111, v111, v11
v_sub_f32 v112, v112, v10
v_sub_f32 v113, v113, v10
v_sub_f32 v114, v114, v10
v_sub_f32 v115, v115, v10
v_sub_f32 v116, v116, v11
v_sub_f32 v117, v117, v11
v_sub_f32 v118, v118, v11
v_sub_f32 v119, v119, v11
v_sub_f32 v120, v120, v10
v_sub_f32 v121, v121, v10
v_sub_f32 v122, v122, v10
v_sub_f32 v123, v123, v10
v_sub_f32 v124, v124, v11
v_sub_f32 v125, v125, v11
v_sub_f32 v126, v126, v11
v_sub_f32 v127, v127, v11
v_sub_f32 v64, v64, v10
v_sub_f32 v65, v65, v10
v_sub_f32 v66, v66, v10
v_sub_f32 v67, v67, v10
v_sub_f32 v68, v68, v11
v_sub_f32 v69, v69, v11
v_sub_f32 v70, v70, v11
v_sub_f32 v71, v71, v11
v_sub_f32 v72, v72, v10
v_sub_f32 v73, v73, v10
v_sub_f32 v74, v74, v10
v_sub_f32 v75, v75, v10
v_sub_f32 v76, v76, v11
v_sub_f32 v77, v77, v11
v_sub_f32 v78, v78, v11
v_sub_f32 v79, v79, v11
v_sub_f32 v80, v80, v10
v_sub_f32 v81, v81, v10
v_sub_f32 v82, v82, v10
v_sub_f32 v83, v83, v10
v_sub_f32 v84, v84, v11
v_sub_f32 v85, v85, v11
v_sub_f32 v86, v86, v11
v_sub_f32 v87, v87, v11
v_sub_f32 v88, v88, v10
v_sub_f32 v89, v89, v10
v_sub_f32 v90, v90, v10
v_sub_f32 v91, v91, v10
v_sub_f32 v92, v92, v11
v_sub_f32 v93, v93, v11
v_sub_f32 v94, v94, v11
v_sub_f32 v95, v95, v11
v_sub_f32 v32, v32, v10
v_sub_f32 v33, v33, v10
v_sub_f32 v34, v34, v10
v_sub_f32 v35, v35, v10
v_sub_f32 v36, v36, v11
v_sub_f32 v37, v37, v11
v_sub_f32 v38, v38, v11
v_sub_f32 v39, v39, v11
E v12,-v10
E v13,-v11
MF v30,v12,v30
MF v31,v13,v31
MF v128,v12,v128
MF v129,v12,v129
MF v130,v12,v130
MF v131,v12,v131
MF v132,v13,v132
MF v133,v13,v133
MF v134,v13,v134
MF v135,v13,v135
MF v136,v12,v136
MF v137,v12,v137
MF v138,v12,v138
MF v139,v12,v139
MF v140,v13,v140
MF v141,v13,v141
MF v142,v13,v142
MF v143,v13,v143
MF v144,v12,v144
MF v145,v12,v145
MF v146,v12,v146
MF v147,v12,v147
MF v148,v13,v148
MF v149,v13,v149
MF v150,v13,v150
MF v151,v13,v151
MF v152,v12,v152
MF v153,v12,v153
MF v154,v12,v154
MF v155,v12,v155
MF v156,v13,v156
MF v157,v13,v157
MF v158,v13,v158
MF v159,v13,v159
MF v160,v12,v160
MF v161,v12,v161
MF v162,v12,v162
MF v163,v12,v163
MF v164,v13,v164
MF v165,v13,v165
MF v166,v13,v166
MF v167,v13,v167
MF v168,v12,v168
MF v169,v12,v169
MF v170,v12,v170
MF v171,v12,v171
MF v172,v13,v172
MF v173,v13,v173
MF v174,v13,v174
MF v175,v13,v175
MF v176,v12,v176
MF v177,v12,v177
MF v178,v12,v178
MF v179,v12,v179
MF v180,v13,v180
MF v181,v13,v181
MF v182,v13,v182
MF v183,v13,v183
MF v184,v12,v184
MF v185,v12,v185
MF v186,v12,v186
MF v187,v12,v187
MF v188,v13,v188
MF v189,v13,v189
MF v190,v13,v190
MF v191,v13,v191
MF v192,v12,v192
MF v193,v12,v193
MF v194,v12,v194
MF v195,v12,v195
MF v196,v13,v196
MF v197,v13,v197
MF v198,v13,v198
MF v199,v13,v199
MF v200,v12,v200
MF v201,v12,v201
MF v202,v12,v202
MF v203,v12,v203
MF v204,v13,v204
MF v205,v13,v205
MF v206,v13,v206
MF v207,v13,v207
MF v208,v12,v208
MF v209,v12,v209
MF v210,v12,v210
MF v211,v12,v211
MF v212,v13,v212
MF v213,v13,v213
MF v214,v13,v214
MF v215,v13,v215
MF v216,v12,v216
MF v217,v12,v217
MF v218,v12,v218
MF v219,v12,v219
MF v220,v13,v220
MF v221,v13,v221
MF v222,v13,v222
MF v223,v13,v223
MF v224,v12,v224
MF v225,v12,v225
MF v226,v12,v226
MF v227,v12,v227
MF v228,v13,v228
MF v229,v13,v229
MF v230,v13,v230
MF v231,v13,v231
MF v232,v12,v232
MF v233,v12,v233
MF v234,v12,v234
MF v235,v12,v235
MF v236,v13,v236
MF v237,v13,v237
MF v238,v13,v238
MF v239,v13,v239
MF v240,v12,v240
MF v241,v12,v241
MF v242,v12,v242
MF v243,v12,v243
MF v244,v13,v244
MF v245,v13,v245
MF v246,v13,v246
MF v247,v13,v247
MF v248,v12,v248
MF v249,v12,v249
MF v250,v12,v250
MF v251,v12,v251
MF v252,v13,v252
MF v253,v13,v253
MF v254,v13,v254
MF v255,v13,v255
E v18,v96
E v19,v97
E v20,v98
AF v28,v18,v19
C v48,v18,v19
E v21,v99
E v22,v104
AF v28,v20,v28
C v49,v20,v21
E v23,v105
AF v28,v21,v28
E v24,v106
AF v28,v22,v28
C v50,v22,v23
E v25,v107
AF v28,v23,v28
E v18,v100
AF v28,v24,v28
C v51,v24,v25
E v19,v101
AF v28,v25,v28
E v20,v102
AF v29,v18,v19
C v52,v18,v19
E v21,v103
E v22,v108
AF v29,v20,v29
C v53,v20,v21
E v23,v109
AF v29,v21,v29
E v24,v110
AF v29,v22,v29
C v54,v22,v23
E v25,v111
AF v29,v23,v29
AF v29,v24,v29
C v55,v24,v25
AF v29,v25,v29
E v18,v112
E v19,v113
E v20,v114
AF v28,v18,v28
C v56,v18,v19
E v21,v115
AF v28,v19,v28
E v22,v120
AF v28,v20,v28
C v57,v20,v21
E v23,v121
AF v28,v21,v28
E v24,v122
AF v28,v22,v28
C v58,v22,v23
E v25,v123
AF v28,v23,v28
E v18,v116
AF v28,v24,v28
C v59,v24,v25
E v19,v117
AF v28,v25,v28
E v20,v118
AF v29,v18,v29
C v60,v18,v19
E v21,v119
AF v29,v19,v29
E v22,v124
AF v29,v20,v29
C v61,v20,v21
E v23,v125
AF v29,v21,v29
E v24,v126
AF v29,v22,v29
C v62,v22,v23
E v25,v127
AF v29,v23,v29
AF v29,v24,v29
C v63,v24,v25
AF v29,v25,v29
s_nop 3
s_setpc_b64 s[36:37]
L_slow1n:
s_nop 7
s_nop 3
v_max3_f32 v10, v96, v97, v98
v_max3_f32 v10, v99, v104, v10
v_max3_f32 v10, v105, v106, v10
v_max3_f32 v10, v107, v112, v10
v_max3_f32 v10, v113, v114, v10
v_max3_f32 v10, v115, v120, v10
v_max3_f32 v10, v121, v122, v10
v_max_f32 v10, v123, v10
v_max3_f32 v11, v100, v101, v102
v_max3_f32 v11, v103, v108, v11
v_max3_f32 v11, v109, v110, v11
v_max3_f32 v11, v111, v116, v11
v_max3_f32 v11, v117, v118, v11
v_max3_f32 v11, v119, v124, v11
v_max3_f32 v11, v125, v126, v11
v_max_f32 v11, v127, v11
v_mov_b32 v12, v10
v_mov_b32 v13, v11
s_nop 0
v_permlane16_swap_b32 v12, v10
v_permlane16_swap_b32 v13, v11
v_max_f32 v10, v12, v10
v_max_f32 v11, v13, v11
v_mov_b32 v12, v10
v_mov_b32 v13, v11
s_nop 0
v_permlane32_swap_b32 v12, v10
v_permlane32_swap_b32 v13, v11
v_max_f32 v10, v12, v10
v_max_f32 v11, v13, v11
v_ceil_f32 v10, v10
v_ceil_f32 v11, v11
v_max_f32 v10, 0, v10
v_max_f32 v11, 0, v11
v_sub_f32 v96, v96, v10
v_sub_f32 v97, v97, v10
v_sub_f32 v98, v98, v10
v_sub_f32 v99, v99, v10
v_sub_f32 v100, v100, v11
v_sub_f32 v101, v101, v11
v_sub_f32 v102, v102, v11
v_sub_f32 v103, v103, v11
v_sub_f32 v104, v104, v10
v_sub_f32 v105, v105, v10
v_sub_f32 v106, v106, v10
v_sub_f32 v107, v107, v10
v_sub_f32 v108, v108, v11
v_sub_f32 v109, v109, v11
v_sub_f32 v110, v110, v11
v_sub_f32 v111, v111, v11
v_sub_f32 v112, v112, v10
v_sub_f32 v113, v113, v10
v_sub_f32 v114, v114, v10
v_sub_f32 v115, v115, v10
v_sub_f32 v116, v116, v11
v_sub_f32 v117, v117, v11
v_sub_f32 v118, v118, v11
v_sub_f32 v119, v119, v11
v_sub_f32 v120, v120, v10
v_sub_f32 v121, v121, v10
v_sub_f32 v122, v122, v10
v_sub_f32 v123, v123, v10
v_sub_f32 v124, v124, v11
v_sub_f32 v125, v125, v11
v_sub_f32 v126, v126, v11
v_sub_f32 v127, v127, v11
v_sub_f32 v32, v32, v10
v_sub_f32 v33, v33, v10
v_sub_f32 v34, v34, v10
v_sub_f32 v35, v35, v10
v_sub_f32 v36, v36, v11
v_sub_f32 v37, v37, v11
v_sub_f32 v38, v38, v11
v_sub_f32 v39, v39, v11
E v12,-v10
E v13,-v11
MF v30,v12,v30
MF v31,v13,v31
MF v128,v12,v128
MF v129,v12,v129
MF v130,v12,v130
MF v131,v12,v131
MF v132,v13,v132
MF v133,v13,v133
MF v134,v13,v134
MF v135,v13,v135
MF v136,v12,v136
MF v137,v12,v137
MF v138,v12,v138
MF v139,v12,v139
MF v140,v13,v140
MF v141,v13,v141
MF v142,v13,v142
MF v143,v13,v143
MF v144,v12,v144
MF v145,v12,v145
MF v146,v12,v146
MF v147,v12,v147
MF v148,v13,v148
MF v149,v13,v149
MF v150,v13,v150
MF v151,v13,v151
MF v152,v12,v152
MF v153,v12,v153
MF v154,v12,v154
MF v155,v12,v155
MF v156,v13,v156
MF v157,v13,v157
MF v158,v13,v158
MF v159,v13,v159
MF v160,v12,v160
MF v161,v12,v161
MF v162,v12,v162
MF v163,v12,v163
MF v164,v13,v164
MF v165,v13,v165
MF v166,v13,v166
MF v167,v13,v167
MF v168,v12,v168
MF v169,v12,v169
MF v170,v12,v170
MF v171,v12,v171
MF v172,v13,v172
MF v173,v13,v173
MF v174,v13,v174
MF v175,v13,v175
MF v176,v12,v176
MF v177,v12,v177
MF v178,v12,v178
MF v179,v12,v179
MF v180,v13,v180
MF v181,v13,v181
MF v182,v13,v182
MF v183,v13,v183
MF v184,v12,v184
MF v185,v12,v185
MF v186,v12,v186
MF v187,v12,v187
MF v188,v13,v188
MF v189,v13,v189
MF v190,v13,v190
MF v191,v13,v191
MF v192,v12,v192
MF v193,v12,v193
MF v194,v12,v194
MF v195,v12,v195
MF v196,v13,v196
MF v197,v13,v197
MF v198,v13,v198
MF v199,v13,v199
MF v200,v12,v200
MF v201,v12,v201
MF v202,v12,v202
MF v203,v12,v203
MF v204,v13,v204
MF v205,v13,v205
MF v206,v13,v206
MF v207,v13,v207
MF v208,v12,v208
MF v209,v12,v209
MF v210,v12,v210
MF v211,v12,v211
MF v212,v13,v212
MF v213,v13,v213
MF v214,v13,v214
MF v215,v13,v215
MF v216,v12,v216
MF v217,v12,v217
MF v218,v12,v218
MF v219,v12,v219
MF v220,v13,v220
MF v221,v13,v221
MF v222,v13,v222
MF v223,v13,v223
MF v224,v12,v224
MF v225,v12,v225
MF v226,v12,v226
MF v227,v12,v227
MF v228,v13,v228
MF v229,v13,v229
MF v230,v13,v230
MF v231,v13,v231
MF v232,v12,v232
MF v233,v12,v233
MF v234,v12,v234
MF v235,v12,v235
MF v236,v13,v236
MF v237,v13,v237
MF v238,v13,v238
MF v239,v13,v239
MF v240,v12,v240
MF v241,v12,v241
MF v242,v12,v242
MF v243,v12,v243
MF v244,v13,v244
MF v245,v13,v245
MF v246,v13,v246
MF v247,v13,v247
MF v248,v12,v248
MF v249,v12,v249
MF v250,v12,v250
MF v251,v12,v251
MF v252,v13,v252
MF v253,v13,v253
MF v254,v13,v254
MF v255,v13,v255
E v18,v96
E v19,v97
E v20,v98
AF v28,v18,v19
C v48,v18,v19
E v21,v99
E v22,v104
AF v28,v20,v28
C v49,v20,v21
E v23,v105
AF v28,v21,v28
E v24,v106
AF v28,v22,v28
C v50,v22,v23
E v25,v107
AF v28,v23,v28
E v18,v100
AF v28,v24,v28
C v51,v24,v25
E v19,v101
AF v28,v25,v28
E v20,v102
AF v29,v18,v19
C v52,v18,v19
E v21,v103
E v22,v108
AF v29,v20,v29
C v53,v20,v21
E v23,v109
AF v29,v21,v29
E v24,v110
AF v29,v22,v29
C v54,v22,v23
E v25,v111
AF v29,v23,v29
AF v29,v24,v29
C v55,v24,v25
AF v29,v25,v29
E v18,v112
E v19,v113
E v20,v114
AF v28,v18,v28
C v56,v18,v19
E v21,v115
AF v28,v19,v28
E v22,v120
AF v28,v20,v28
C v57,v20,v21
E v23,v121
AF v28,v21,v28
E v24,v122
AF v28,v22,v28
C v58,v22,v23
E v25,v123
AF v28,v23,v28
E v18,v116
AF v28,v24,v28
C v59,v24,v25
E v19,v117
AF v28,v25,v28
E v20,v118
AF v29,v18,v29
C v60,v18,v19
E v21,v119
AF v29,v19,v29
E v22,v124
AF v29,v20,v29
C v61,v20,v21
E v23,v125
AF v29,v21,v29
E v24,v126
AF v29,v22,v29
C v62,v22,v23
E v25,v127
AF v29,v23,v29
AF v29,v24,v29
C v63,v24,v25
AF v29,v25,v29
s_nop 3
s_setpc_b64 s[36:37]
L_slowf:
s_nop 7
s_nop 3
v_max3_f32 v10, v64, v65, v66
v_max3_f32 v10, v67, v72, v10
v_max3_f32 v10, v73, v74, v10
v_max3_f32 v10, v75, v80, v10
v_max3_f32 v10, v81, v82, v10
v_max3_f32 v10, v83, v88, v10
v_max3_f32 v10, v89, v90, v10
v_max_f32 v10, v91, v10
v_max3_f32 v11, v68, v69, v70
v_max3_f32 v11, v71, v76, v11
v_max3_f32 v11, v77, v78, v11
v_max3_f32 v11, v79, v84, v11
v_max3_f32 v11, v85, v86, v11
v_max3_f32 v11, v87, v92, v11
v_max3_f32 v11, v93, v94, v11
v_max_f32 v11, v95, v11
v_mov_b32 v12, v10
v_mov_b32 v13, v11
s_nop 0
v_permlane16_swap_b32 v12, v10
v_permlane16_swap_b32 v13, v11
v_max_f32 v10, v12, v10
v_max_f32 v11, v13, v11
v_mov_b32 v12, v10
v_mov_b32 v13, v11
s_nop 0
v_permlane32_swap_b32 v12, v10
v_permlane32_swap_b32 v13, v11
v_max_f32 v10, v12, v10
v_max_f32 v11, v13, v11
v_ceil_f32 v10, v10
v_ceil_f32 v11, v11
v_sub_f32 v64, v64, v10
v_sub_f32 v65, v65, v10
v_sub_f32 v66, v66, v10
v_sub_f32 v67, v67, v10
v_sub_f32 v68, v68, v11
v_sub_f32 v69, v69, v11
v_sub_f32 v70, v70, v11
v_sub_f32 v71, v71, v11
v_sub_f32 v72, v72, v10
v_sub_f32 v73, v73, v10
v_sub_f32 v74, v74, v10
v_sub_f32 v75, v75, v10
v_sub_f32 v76, v76, v11
v_sub_f32 v77, v77, v11
v_sub_f32 v78, v78, v11
v_sub_f32 v79, v79, v11
v_sub_f32 v80, v80, v10
v_sub_f32 v81, v81, v10
v_sub_f32 v82, v82, v10
v_sub_f32 v83, v83, v10
v_sub_f32 v84, v84, v11
v_sub_f32 v85, v85, v11
v_sub_f32 v86, v86, v11
v_sub_f32 v87, v87, v11
v_sub_f32 v88, v88, v10
v_sub_f32 v89, v89, v10
v_sub_f32 v90, v90, v10
v_sub_f32 v91, v91, v10
v_sub_f32 v92, v92, v11
v_sub_f32 v93, v93, v11
v_sub_f32 v94, v94, v11
v_sub_f32 v95, v95, v11
v_sub_f32 v96, v96, v10
v_sub_f32 v97, v97, v10
v_sub_f32 v98, v98, v10
v_sub_f32 v99, v99, v10
v_sub_f32 v100, v100, v11
v_sub_f32 v101, v101, v11
v_sub_f32 v102, v102, v11
v_sub_f32 v103, v103, v11
v_sub_f32 v104, v104, v10
v_sub_f32 v105, v105, v10
v_sub_f32 v106, v106, v10
v_sub_f32 v107, v107, v10
v_sub_f32 v108, v108, v11
v_sub_f32 v109, v109, v11
v_sub_f32 v110, v110, v11
v_sub_f32 v111, v111, v11
v_sub_f32 v112, v112, v10
v_sub_f32 v113, v113, v10
v_sub_f32 v114, v114, v10
v_sub_f32 v115, v115, v10
v_sub_f32 v116, v116, v11
v_sub_f32 v117, v117, v11
v_sub_f32 v118, v118, v11
v_sub_f32 v119, v119, v11
v_sub_f32 v120, v120, v10
v_sub_f32 v121, v121, v10
v_sub_f32 v122, v122, v10
v_sub_f32 v123, v123, v10
v_sub_f32 v124, v124, v11
v_sub_f32 v125, v125, v11
v_sub_f32 v126, v126, v11
v_sub_f32 v127, v127, v11
v_sub_f32 v32, v32, v10
v_sub_f32 v33, v33, v10
v_sub_f32 v34, v34, v10
v_sub_f32 v35, v35, v10
v_sub_f32 v36, v36, v11
v_sub_f32 v37, v37, v11
v_sub_f32 v38, v38, v11
v_sub_f32 v39, v39, v11
E v18,v64
E v19,v65
E v20,v66
AF v26,v18,v19
C v40,v18,v19
E v21,v67
E v22,v72
AF v26,v20,v26
C v41,v20,v21
E v23,v73
AF v26,v21,v26
E v24,v74
AF v26,v22,v26
C v42,v22,v23
E v25,v75
AF v26,v23,v26
E v18,v68
AF v26,v24,v26
C v43,v24,v25
E v19,v69
AF v26,v25,v26
E v20,v70
AF v27,v18,v19
C v44,v18,v19
E v21,v71
E v22,v76
AF v27,v20,v27
C v45,v20,v21
E v23,v77
AF v27,v21,v27
E v24,v78
AF v27,v22,v27
C v46,v22,v23
E v25,v79
AF v27,v23,v27
AF v27,v24,v27
C v47,v24,v25
AF v27,v25,v27
E v18,v80
E v19,v81
E v20,v82
AF v26,v18,v26
C v56,v18,v19
E v21,v83
AF v26,v19,v26
E v22,v88
AF v26,v20,v26
C v57,v20,v21
E v23,v89
AF v26,v21,v26
E v24,v90
AF v26,v22,v26
C v58,v22,v23
E v25,v91
AF v26,v23,v26
E v18,v84
AF v26,v24,v26
C v59,v24,v25
E v19,v85
AF v26,v25,v26
E v20,v86
AF v27,v18,v27
C v60,v18,v19
E v21,v87
AF v27,v19,v27
E v22,v92
AF v27,v20,v27
C v61,v20,v21
E v23,v93
AF v27,v21,v27
E v24,v94
AF v27,v22,v27
C v62,v22,v23
E v25,v95
AF v27,v23,v27
AF v27,v24,v27
C v63,v24,v25
AF v27,v25,v27
s_nop 3
s_setpc_b64 s[36:37]
L_slowj:
s_nop 7
s_nop 3
v_max3_f32 v10, v64, v65, v66
v_max3_f32 v10, v67, v72, v10
v_max3_f32 v10, v73, v74, v10
v_max3_f32 v10, v75, v80, v10
v_max3_f32 v10, v81, v82, v10
v_max3_f32 v10, v83, v88, v10
v_max3_f32 v10, v89, v90, v10
v_max_f32 v10, v91, v10
v_max3_f32 v11, v68, v69, v70
v_max3_f32 v11, v71, v76, v11
v_max3_f32 v11, v77, v78, v11
v_max3_f32 v11, v79, v84, v11
v_max3_f32 v11, v85, v86, v11
v_max3_f32 v11, v87, v92, v11
v_max3_f32 v11, v93, v94, v11
v_max_f32 v11, v95, v11
v_mov_b32 v12, v10
v_mov_b32 v13, v11
s_nop 0
v_permlane16_swap_b32 v12, v10
v_permlane16_swap_b32 v13, v11
v_max_f32 v10, v12, v10
v_max_f32 v11, v13, v11
v_mov_b32 v12, v10
v_mov_b32 v13, v11
s_nop 0
v_permlane32_swap_b32 v12, v10
v_permlane32_swap_b32 v13, v11
v_max_f32 v10, v12, v10
v_max_f32 v11, v13, v11
v_ceil_f32 v10, v10
v_ceil_f32 v11, v11
v_sub_f32 v64, v64, v10
v_sub_f32 v65, v65, v10
v_sub_f32 v66, v66, v10
v_sub_f32 v67, v67, v10
v_sub_f32 v68, v68, v11
v_sub_f32 v69, v69, v11
v_sub_f32 v70, v70, v11
v_sub_f32 v71, v71, v11
v_sub_f32 v72, v72, v10
v_sub_f32 v73, v73, v10
v_sub_f32 v74, v74, v10
v_sub_f32 v75, v75, v10
v_sub_f32 v76, v76, v11
v_sub_f32 v77, v77, v11
v_sub_f32 v78, v78, v11
v_sub_f32 v79, v79, v11
v_sub_f32 v80, v80, v10
v_sub_f32 v81, v81, v10
v_sub_f32 v82, v82, v10
v_sub_f32 v83, v83, v10
v_sub_f32 v84, v84, v11
v_sub_f32 v85, v85, v11
v_sub_f32 v86, v86, v11
v_sub_f32 v87, v87, v11
v_sub_f32 v88, v88, v10
v_sub_f32 v89, v89, v10
v_sub_f32 v90, v90, v10
v_sub_f32 v91, v91, v10
v_sub_f32 v92, v92, v11
v_sub_f32 v93, v93, v11
v_sub_f32 v94, v94, v11
v_sub_f32 v95, v95, v11
v_sub_f32 v32, v32, v10
v_sub_f32 v33, v33, v10
v_sub_f32 v34, v34, v10
v_sub_f32 v35, v35, v10
v_sub_f32 v36, v36, v11
v_sub_f32 v37, v37, v11
v_sub_f32 v38, v38, v11
v_sub_f32 v39, v39, v11
E v18,v64
E v19,v65
E v20,v66
AF v26,v18,v19
C v40,v18,v19
E v21,v67
E v22,v72
AF v26,v20,v26
C v41,v20,v21
E v23,v73
AF v26,v21,v26
E v24,v74
AF v26,v22,v26
C v42,v22,v23
E v25,v75
AF v26,v23,v26
E v18,v68
AF v26,v24,v26
C v43,v24,v25
E v19,v69
AF v26,v25,v26
E v20,v70
AF v27,v18,v19
C v44,v18,v19
E v21,v71
E v22,v76
AF v27,v20,v27
C v45,v20,v21
E v23,v77
AF v27,v21,v27
E v24,v78
AF v27,v22,v27
C v46,v22,v23
E v25,v79
AF v27,v23,v27
AF v27,v24,v27
C v47,v24,v25
AF v27,v25,v27
s_nop 3
s_setpc_b64 s[36:37]
L_slowb:
s_nop 7
s_nop 3
v_max3_f32 v11, v100, v101, v102
v_max3_f32 v11, v103, v108, v11
v_max3_f32 v11, v109, v110, v11
v_max3_f32 v11, v111, v116, v11
v_max3_f32 v11, v117, v118, v11
v_max3_f32 v11, v119, v124, v11
v_max3_f32 v11, v125, v126, v11
v_max_f32 v11, v127, v11
v_mov_b32 v13, v11
s_nop 1
v_permlane16_swap_b32 v13, v11
v_max_f32 v11, v13, v11
v_mov_b32 v13, v11
s_nop 1
v_permlane32_swap_b32 v13, v11
v_max_f32 v11, v13, v11
v_ceil_f32 v11, v11
v_max_f32 v11, 0, v11
v_mov_b32 v10, 0
v_sub_f32 v100, v100, v11
v_sub_f32 v101, v101, v11
v_sub_f32 v102, v102, v11
v_sub_f32 v103, v103, v11
v_sub_f32 v108, v108, v11
v_sub_f32 v109, v109, v11
v_sub_f32 v110, v110, v11
v_sub_f32 v111, v111, v11
v_sub_f32 v116, v116, v11
v_sub_f32 v117, v117, v11
v_sub_f32 v118, v118, v11
v_sub_f32 v119, v119, v11
v_sub_f32 v124, v124, v11
v_sub_f32 v125, v125, v11
v_sub_f32 v126, v126, v11
v_sub_f32 v127, v127, v11
v_sub_f32 v32, v32, v10
v_sub_f32 v33, v33, v10
v_sub_f32 v34, v34, v10
v_sub_f32 v35, v35, v10
v_sub_f32 v36, v36, v11
v_sub_f32 v37, v37, v11
v_sub_f32 v38, v38, v11
v_sub_f32 v39, v39, v11
E v12,-v10
E v13,-v11
MF v30,v12,v30
MF v31,v13,v31
MF v128,v12,v128
MF v129,v12,v129
MF v130,v12,v130
MF v131,v12,v131
MF v132,v13,v132
MF v133,v13,v133
MF v134,v13,v134
MF v135,v13,v135
MF v136,v12,v136
MF v137,v12,v137
MF v138,v12,v138
MF v139,v12,v139
MF v140,v13,v140
MF v141,v13,v141
MF v142,v13,v142
MF v143,v13,v143
MF v144,v12,v144
MF v145,v12,v145
MF v146,v12,v146
MF v147,v12,v147
MF v148,v13,v148
MF v149,v13,v149
MF v150,v13,v150
MF v151,v13,v151
MF v152,v12,v152
MF v153,v12,v153
MF v154,v12,v154
MF v155,v12,v155
MF v156,v13,v156
MF v157,v13,v157
MF v158,v13,v158
MF v159,v13,v159
MF v160,v12,v160
MF v161,v12,v161
MF v162,v12,v162
MF v163,v12,v163
MF v164,v13,v164
MF v165,v13,v165
MF v166,v13,v166
MF v167,v13,v167
MF v168,v12,v168
MF v169,v12,v169
MF v170,v12,v170
MF v171,v12,v171
MF v172,v13,v172
MF v173,v13,v173
MF v174,v13,v174
MF v175,v13,v175
MF v176,v12,v176
MF v177,v12,v177
MF v178,v12,v178
MF v179,v12,v179
MF v180,v13,v180
MF v181,v13,v181
MF v182,v13,v182
MF v183,v13,v183
MF v184,v12,v184
MF v185,v12,v185
MF v186,v12,v186
MF v187,v12,v187
MF v188,v13,v188
MF v189,v13,v189
MF v190,v13,v190
MF v191,v13,v191
MF v192,v12,v192
MF v193,v12,v193
MF v194,v12,v194
MF v195,v12,v195
MF v196,v13,v196
MF v197,v13,v197
MF v198,v13,v198
MF v199,v13,v199
MF v200,v12,v200
MF v201,v12,v201
MF v202,v12,v202
MF v203,v12,v203
MF v204,v13,v204
MF v205,v13,v205
MF v206,v13,v206
MF v207,v13,v207
MF v208,v12,v208
MF v209,v12,v209
MF v210,v12,v210
MF v211,v12,v211
MF v212,v13,v212
MF v213,v13,v213
MF v214,v13,v214
MF v215,v13,v215
MF v216,v12,v216
MF v217,v12,v217
MF v218,v12,v218
MF v219,v12,v219
MF v220,v13,v220
MF v221,v13,v221
MF v222,v13,v222
MF v223,v13,v223
MF v224,v12,v224
MF v225,v12,v225
MF v226,v12,v226
MF v227,v12,v227
MF v228,v13,v228
MF v229,v13,v229
MF v230,v13,v230
MF v231,v13,v231
MF v232,v12,v232
MF v233,v12,v233
MF v234,v12,v234
MF v235,v12,v235
MF v236,v13,v236
MF v237,v13,v237
MF v238,v13,v238
MF v239,v13,v239
MF v240,v12,v240
MF v241,v12,v241
MF v242,v12,v242
MF v243,v12,v243
MF v244,v13,v244
MF v245,v13,v245
MF v246,v13,v246
MF v247,v13,v247
MF v248,v12,v248
MF v249,v12,v249
MF v250,v12,v250
MF v251,v12,v251
MF v252,v13,v252
MF v253,v13,v253
MF v254,v13,v254
MF v255,v13,v255
E v18,v100
E v19,v101
E v20,v102
AF v29,v18,v19
C v52,v18,v19
E v21,v103
E v22,v108
AF v29,v20,v29
C v53,v20,v21
E v23,v109
AF v29,v21,v29
E v24,v110
AF v29,v22,v29
C v54,v22,v23
E v25,v111
AF v29,v23,v29
E v18,v116
AF v29,v24,v29
C v55,v24,v25
E v19,v117
AF v29,v25,v29
E v20,v118
AF v29,v18,v29
C v48,v18,v19
E v21,v119
AF v29,v19,v29
E v22,v124
AF v29,v20,v29
C v49,v20,v21
E v23,v125
AF v29,v21,v29
E v24,v126
AF v29,v22,v29
C v50,v22,v23
E v25,v127
AF v29,v23,v29
AF v29,v24,v29
C v51,v24,v25
AF v29,v25,v29
s_nop 3
s_setpc_b64 s[36:37]
L_comb:
s_waitcnt vmcnt(0)
s_nop 7
v_sub_f32 v10, v32, v14
v_sub_f32 v11, v36, v15
v_max_f32 v10, 0, v10
v_max_f32 v11, 0, v11
v_sub_f32 v100, v100, v11
v_sub_f32 v101, v101, v11
v_sub_f32 v102, v102, v11
v_sub_f32 v103, v103, v11
v_sub_f32 v108, v108, v11
v_sub_f32 v109, v109, v11
v_sub_f32 v110, v110, v11
v_sub_f32 v111, v111, v11
v_sub_f32 v116, v116, v11
v_sub_f32 v117, v117, v11
v_sub_f32 v118, v118, v11
v_sub_f32 v119, v119, v11
v_sub_f32 v124, v124, v11
v_sub_f32 v125, v125, v11
v_sub_f32 v126, v126, v11
v_sub_f32 v127, v127, v11
v_sub_f32 v32, v32, v10
v_sub_f32 v33, v33, v10
v_sub_f32 v34, v34, v10
v_sub_f32 v35, v35, v10
v_sub_f32 v36, v36, v11
v_sub_f32 v37, v37, v11
v_sub_f32 v38, v38, v11
v_sub_f32 v39, v39, v11
E v12,-v10
E v13,-v11
MF v30,v12,v30
MF v31,v13,v31
MF v128,v12,v128
MF v129,v12,v129
MF v130,v12,v130
MF v131,v12,v131
MF v132,v13,v132
MF v133,v13,v133
MF v134,v13,v134
MF v135,v13,v135
MF v136,v12,v136
MF v137,v12,v137
MF v138,v12,v138
MF v139,v12,v139
MF v140,v13,v140
MF v141,v13,v141
MF v142,v13,v142
MF v143,v13,v143
MF v144,v12,v144
MF v145,v12,v145
MF v146,v12,v146
MF v147,v12,v147
MF v148,v13,v148
MF v149,v13,v149
MF v150,v13,v150
MF v151,v13,v151
MF v152,v12,v152
MF v153,v12,v153
MF v154,v12,v154
MF v155,v12,v155
MF v156,v13,v156
MF v157,v13,v157
MF v158,v13,v158
MF v159,v13,v159
MF v160,v12,v160
MF v161,v12,v161
MF v162,v12,v162
MF v163,v12,v163
MF v164,v13,v164
MF v165,v13,v165
MF v166,v13,v166
MF v167,v13,v167
MF v168,v12,v168
MF v169,v12,v169
MF v170,v12,v170
MF v171,v12,v171
MF v172,v13,v172
MF v173,v13,v173
MF v174,v13,v174
MF v175,v13,v175
MF v176,v12,v176
MF v177,v12,v177
MF v178,v12,v178
MF v179,v12,v179
MF v180,v13,v180
MF v181,v13,v181
MF v182,v13,v182
MF v183,v13,v183
MF v184,v12,v184
MF v185,v12,v185
MF v186,v12,v186
MF v187,v12,v187
MF v188,v13,v188
MF v189,v13,v189
MF v190,v13,v190
MF v191,v13,v191
MF v192,v12,v192
MF v193,v12,v193
MF v194,v12,v194
MF v195,v12,v195
MF v196,v13,v196
MF v197,v13,v197
MF v198,v13,v198
MF v199,v13,v199
MF v200,v12,v200
MF v201,v12,v201
MF v202,v12,v202
MF v203,v12,v203
MF v204,v13,v204
MF v205,v13,v205
MF v206,v13,v206
MF v207,v13,v207
MF v208,v12,v208
MF v209,v12,v209
MF v210,v12,v210
MF v211,v12,v211
MF v212,v13,v212
MF v213,v13,v213
MF v214,v13,v214
MF v215,v13,v215
MF v216,v12,v216
MF v217,v12,v217
MF v218,v12,v218
MF v219,v12,v219
MF v220,v13,v220
MF v221,v13,v221
MF v222,v13,v222
MF v223,v13,v223
MF v224,v12,v224
MF v225,v12,v225
MF v226,v12,v226
MF v227,v12,v227
MF v228,v13,v228
MF v229,v13,v229
MF v230,v13,v230
MF v231,v13,v231
MF v232,v12,v232
MF v233,v12,v233
MF v234,v12,v234
MF v235,v12,v235
MF v236,v13,v236
MF v237,v13,v237
MF v238,v13,v238
MF v239,v13,v239
MF v240,v12,v240
MF v241,v12,v241
MF v242,v12,v242
MF v243,v12,v243
MF v244,v13,v244
MF v245,v13,v245
MF v246,v13,v246
MF v247,v13,v247
MF v248,v12,v248
MF v249,v12,v249
MF v250,v12,v250
MF v251,v12,v251
MF v252,v13,v252
MF v253,v13,v253
MF v254,v13,v254
MF v255,v13,v255
E v18,v100
E v19,v101
E v20,v102
AF v29,v18,v19
C v52,v18,v19
E v21,v103
E v22,v108
AF v29,v20,v29
C v53,v20,v21
E v23,v109
AF v29,v21,v29
E v24,v110
AF v29,v22,v29
C v54,v22,v23
E v25,v111
AF v29,v23,v29
E v18,v116
AF v29,v24,v29
C v55,v24,v25
E v19,v117
AF v29,v25,v29
E v20,v118
AF v29,v18,v29
C v48,v18,v19
E v21,v119
AF v29,v19,v29
E v22,v124
AF v29,v20,v29
C v49,v20,v21
E v23,v125
AF v29,v21,v29
E v24,v126
AF v29,v22,v29
C v50,v22,v23
E v25,v127
AF v29,v23,v29
AF v29,v24,v29
C v51,v24,v25
AF v29,v25,v29
v_sub_f32 v10, v32, v14
v_sub_f32 v11, v36, v15
E v10,v10
E v11,v11
s_nop 0
MF v16,v10,v16
MF v17,v11,v17
G v64,a128
v_and_b32 v65, 0xffff0000, v64
v_lshlrev_b32 v64, 16, v64
MF v64,v10,v64
MF v65,v10,v65
C v64,v64,v65
W a128,v64
G v66,a129
v_and_b32 v67, 0xffff0000, v66
v_lshlrev_b32 v66, 16, v66
MF v66,v10,v66
MF v67,v10,v67
C v66,v66,v67
W a129,v66
G v68,a130
v_and_b32 v69, 0xffff0000, v68
v_lshlrev_b32 v68, 16, v68
MF v68,v10,v68
MF v69,v10,v69
C v68,v68,v69
W a130,v68
G v70,a131
v_and_b32 v71, 0xffff0000, v70
v_lshlrev_b32 v70, 16, v70
MF v70,v10,v70
MF v71,v10,v71
C v70,v70,v71
W a131,v70
G v72,a132
v_and_b32 v73, 0xffff0000, v72
v_lshlrev_b32 v72, 16, v72
MF v72,v10,v72
MF v73,v10,v73
C v72,v72,v73
W a132,v72
G v74,a133
v_and_b32 v75, 0xffff0000, v74
v_lshlrev_b32 v74, 16, v74
MF v74,v10,v74
MF v75,v10,v75
C v74,v74,v75
W a133,v74
G v76,a134
v_and_b32 v77, 0xffff0000, v76
v_lshlrev_b32 v76, 16, v76
MF v76,v10,v76
MF v77,v10,v77
C v76,v76,v77
W a134,v76
G v78,a135
v_and_b32 v79, 0xffff0000, v78
v_lshlrev_b32 v78, 16, v78
MF v78,v10,v78
MF v79,v10,v79
C v78,v78,v79
W a135,v78
G v64,a136
v_and_b32 v65, 0xffff0000, v64
v_lshlrev_b32 v64, 16, v64
MF v64,v10,v64
MF v65,v10,v65
C v64,v64,v65
W a136,v64
G v66,a137
v_and_b32 v67, 0xffff0000, v66
v_lshlrev_b32 v66, 16, v66
MF v66,v10,v66
MF v67,v10,v67
C v66,v66,v67
W a137,v66
G v68,a138
v_and_b32 v69, 0xffff0000, v68
v_lshlrev_b32 v68, 16, v68
MF v68,v10,v68
MF v69,v10,v69
C v68,v68,v69
W a138,v68
G v70,a139
v_and_b32 v71, 0xffff0000, v70
v_lshlrev_b32 v70, 16, v70
MF v70,v10,v70
MF v71,v10,v71
C v70,v70,v71
W a139,v70
G v72,a140
v_and_b32 v73, 0xffff0000, v72
v_lshlrev_b32 v72, 16, v72
MF v72,v10,v72
MF v73,v10,v73
C v72,v72,v73
W a140,v72
G v74,a141
v_and_b32 v75, 0xffff0000, v74
v_lshlrev_b32 v74, 16, v74
MF v74,v10,v74
MF v75,v10,v75
C v74,v74,v75
W a141,v74
G v76,a142
v_and_b32 v77, 0xffff0000, v76
v_lshlrev_b32 v76, 16, v76
MF v76,v10,v76
MF v77,v10,v77
C v76,v76,v77
W a142,v76
G v78,a143
v_and_b32 v79, 0xffff0000, v78
v_lshlrev_b32 v78, 16, v78
MF v78,v10,v78
MF v79,v10,v79
C v78,v78,v79
W a143,v78
G v64,a144
v_and_b32 v65, 0xffff0000, v64
v_lshlrev_b32 v64, 16, v64
MF v64,v10,v64
MF v65,v10,v65
C v64,v64,v65
W a144,v64
G v66,a145
v_and_b32 v67, 0xffff0000, v66
v_lshlrev_b32 v66, 16, v66
MF v66,v10,v66
MF v67,v10,v67
C v66,v66,v67
W a145,v66
G v68,a146
v_and_b32 v69, 0xffff0000, v68
v_lshlrev_b32 v68, 16, v68
MF v68,v10,v68
MF v69,v10,v69
C v68,v68,v69
W a146,v68
G v70,a147
v_and_b32 v71, 0xffff0000, v70
v_lshlrev_b32 v70, 16, v70
MF v70,v10,v70
MF v71,v10,v71
C v70,v70,v71
W a147,v70
G v72,a148
v_and_b32 v73, 0xffff0000, v72
v_lshlrev_b32 v72, 16, v72
MF v72,v10,v72
MF v73,v10,v73
C v72,v72,v73
W a148,v72
G v74,a149
v_and_b32 v75, 0xffff0000, v74
v_lshlrev_b32 v74, 16, v74
MF v74,v10,v74
MF v75,v10,v75
C v74,v74,v75
W a149,v74
G v76,a150
v_and_b32 v77, 0xffff0000, v76
v_lshlrev_b32 v76, 16, v76
MF v76,v10,v76
MF v77,v10,v77
C v76,v76,v77
W a150,v76
G v78,a151
v_and_b32 v79, 0xffff0000, v78
v_lshlrev_b32 v78, 16, v78
MF v78,v10,v78
MF v79,v10,v79
C v78,v78,v79
W a151,v78
G v64,a152
v_and_b32 v65, 0xffff0000, v64
v_lshlrev_b32 v64, 16, v64
MF v64,v10,v64
MF v65,v10,v65
C v64,v64,v65
W a152,v64
G v66,a153
v_and_b32 v67, 0xffff0000, v66
v_lshlrev_b32 v66, 16, v66
MF v66,v10,v66
MF v67,v10,v67
C v66,v66,v67
W a153,v66
G v68,a154
v_and_b32 v69, 0xffff0000, v68
v_lshlrev_b32 v68, 16, v68
MF v68,v10,v68
MF v69,v10,v69
C v68,v68,v69
W a154,v68
G v70,a155
v_and_b32 v71, 0xffff0000, v70
v_lshlrev_b32 v70, 16, v70
MF v70,v10,v70
MF v71,v10,v71
C v70,v70,v71
W a155,v70
G v72,a156
v_and_b32 v73, 0xffff0000, v72
v_lshlrev_b32 v72, 16, v72
MF v72,v10,v72
MF v73,v10,v73
C v72,v72,v73
W a156,v72
G v74,a157
v_and_b32 v75, 0xffff0000, v74
v_lshlrev_b32 v74, 16, v74
MF v74,v10,v74
MF v75,v10,v75
C v74,v74,v75
W a157,v74
G v76,a158
v_and_b32 v77, 0xffff0000, v76
v_lshlrev_b32 v76, 16, v76
MF v76,v10,v76
MF v77,v10,v77
C v76,v76,v77
W a158,v76
G v78,a159
v_and_b32 v79, 0xffff0000, v78
v_lshlrev_b32 v78, 16, v78
MF v78,v10,v78
MF v79,v10,v79
C v78,v78,v79
W a159,v78
G v64,a160
v_and_b32 v65, 0xffff0000, v64
v_lshlrev_b32 v64, 16, v64
MF v64,v11,v64
MF v65,v11,v65
C v64,v64,v65
W a160,v64
G v66,a161
v_and_b32 v67, 0xffff0000, v66
v_lshlrev_b32 v66, 16, v66
MF v66,v11,v66
MF v67,v11,v67
C v66,v66,v67
W a161,v66
G v68,a162
v_and_b32 v69, 0xffff0000, v68
v_lshlrev_b32 v68, 16, v68
MF v68,v11,v68
MF v69,v11,v69
C v68,v68,v69
W a162,v68
G v70,a163
v_and_b32 v71, 0xffff0000, v70
v_lshlrev_b32 v70, 16, v70
MF v70,v11,v70
MF v71,v11,v71
C v70,v70,v71
W a163,v70
G v72,a164
v_and_b32 v73, 0xffff0000, v72
v_lshlrev_b32 v72, 16, v72
MF v72,v11,v72
MF v73,v11,v73
C v72,v72,v73
W a164,v72
G v74,a165
v_and_b32 v75, 0xffff0000, v74
v_lshlrev_b32 v74, 16, v74
MF v74,v11,v74
MF v75,v11,v75
C v74,v74,v75
W a165,v74
G v76,a166
v_and_b32 v77, 0xffff0000, v76
v_lshlrev_b32 v76, 16, v76
MF v76,v11,v76
MF v77,v11,v77
C v76,v76,v77
W a166,v76
G v78,a167
v_and_b32 v79, 0xffff0000, v78
v_lshlrev_b32 v78, 16, v78
MF v78,v11,v78
MF v79,v11,v79
C v78,v78,v79
W a167,v78
G v64,a168
v_and_b32 v65, 0xffff0000, v64
v_lshlrev_b32 v64, 16, v64
MF v64,v11,v64
MF v65,v11,v65
C v64,v64,v65
W a168,v64
G v66,a169
v_and_b32 v67, 0xffff0000, v66
v_lshlrev_b32 v66, 16, v66
MF v66,v11,v66
MF v67,v11,v67
C v66,v66,v67
W a169,v66
G v68,a170
v_and_b32 v69, 0xffff0000, v68
v_lshlrev_b32 v68, 16, v68
MF v68,v11,v68
MF v69,v11,v69
C v68,v68,v69
W a170,v68
G v70,a171
v_and_b32 v71, 0xffff0000, v70
v_lshlrev_b32 v70, 16, v70
MF v70,v11,v70
MF v71,v11,v71
C v70,v70,v71
W a171,v70
G v72,a172
v_and_b32 v73, 0xffff0000, v72
v_lshlrev_b32 v72, 16, v72
MF v72,v11,v72
MF v73,v11,v73
C v72,v72,v73
W a172,v72
G v74,a173
v_and_b32 v75, 0xffff0000, v74
v_lshlrev_b32 v74, 16, v74
MF v74,v11,v74
MF v75,v11,v75
C v74,v74,v75
W a173,v74
G v76,a174
v_and_b32 v77, 0xffff0000, v76
v_lshlrev_b32 v76, 16, v76
MF v76,v11,v76
MF v77,v11,v77
C v76,v76,v77
W a174,v76
G v78,a175
v_and_b32 v79, 0xffff0000, v78
v_lshlrev_b32 v78, 16, v78
MF v78,v11,v78
MF v79,v11,v79
C v78,v78,v79
W a175,v78
G v64,a176
v_and_b32 v65, 0xffff0000, v64
v_lshlrev_b32 v64, 16, v64
MF v64,v11,v64
MF v65,v11,v65
C v64,v64,v65
W a176,v64
G v66,a177
v_and_b32 v67, 0xffff0000, v66
v_lshlrev_b32 v66, 16, v66
MF v66,v11,v66
MF v67,v11,v67
C v66,v66,v67
W a177,v66
G v68,a178
v_and_b32 v69, 0xffff0000, v68
v_lshlrev_b32 v68, 16, v68
MF v68,v11,v68
MF v69,v11,v69
C v68,v68,v69
W a178,v68
G v70,a179
v_and_b32 v71, 0xffff0000, v70
v_lshlrev_b32 v70, 16, v70
MF v70,v11,v70
MF v71,v11,v71
C v70,v70,v71
W a179,v70
G v72,a180
v_and_b32 v73, 0xffff0000, v72
v_lshlrev_b32 v72, 16, v72
MF v72,v11,v72
MF v73,v11,v73
C v72,v72,v73
W a180,v72
G v74,a181
v_and_b32 v75, 0xffff0000, v74
v_lshlrev_b32 v74, 16, v74
MF v74,v11,v74
MF v75,v11,v75
C v74,v74,v75
W a181,v74
G v76,a182
v_and_b32 v77, 0xffff0000, v76
v_lshlrev_b32 v76, 16, v76
MF v76,v11,v76
MF v77,v11,v77
C v76,v76,v77
W a182,v76
G v78,a183
v_and_b32 v79, 0xffff0000, v78
v_lshlrev_b32 v78, 16, v78
MF v78,v11,v78
MF v79,v11,v79
C v78,v78,v79
W a183,v78
G v64,a184
v_and_b32 v65, 0xffff0000, v64
v_lshlrev_b32 v64, 16, v64
MF v64,v11,v64
MF v65,v11,v65
C v64,v64,v65
W a184,v64
G v66,a185
v_and_b32 v67, 0xffff0000, v66
v_lshlrev_b32 v66, 16, v66
MF v66,v11,v66
MF v67,v11,v67
C v66,v66,v67
W a185,v66
G v68,a186
v_and_b32 v69, 0xffff0000, v68
v_lshlrev_b32 v68, 16, v68
MF v68,v11,v68
MF v69,v11,v69
C v68,v68,v69
W a186,v68
G v70,a187
v_and_b32 v71, 0xffff0000, v70
v_lshlrev_b32 v70, 16, v70
MF v70,v11,v70
MF v71,v11,v71
C v70,v70,v71
W a187,v70
G v72,a188
v_and_b32 v73, 0xffff0000, v72
v_lshlrev_b32 v72, 16, v72
MF v72,v11,v72
MF v73,v11,v73
C v72,v72,v73
W a188,v72
G v74,a189
v_and_b32 v75, 0xffff0000, v74
v_lshlrev_b32 v74, 16, v74
MF v74,v11,v74
MF v75,v11,v75
C v74,v74,v75
W a189,v74
G v76,a190
v_and_b32 v77, 0xffff0000, v76
v_lshlrev_b32 v76, 16, v76
MF v76,v11,v76
MF v77,v11,v77
C v76,v76,v77
W a190,v76
G v78,a191
v_and_b32 v79, 0xffff0000, v78
v_lshlrev_b32 v78, 16, v78
MF v78,v11,v78
MF v79,v11,v79
C v78,v78,v79
W a191,v78
s_nop 3
s_setpc_b64 s[36:37]
L_zs0:
s_mov_b32 s64, 65536
L_zs0_l:
s_sleep 2
buffer_load_dword v17, v16, s[12:15], 0 offen sc1
s_sub_u32 s64, s64, 1
s_cbranch_scc1 L_zs0_x
s_waitcnt vmcnt(0)
v_cmp_ne_u32 vcc, 1, v17
s_nop 0
s_cbranch_vccnz L_zs0_l
L_zs0_x:
s_waitcnt vmcnt(0)
s_branch L_zr0
L_zs1:
s_mov_b32 s64, 65536
L_zs1_l:
s_sleep 2
buffer_load_dword v17, v16, s[12:15], 0 offen sc1
s_sub_u32 s64, s64, 1
s_cbranch_scc1 L_zs1_x
s_waitcnt vmcnt(0)
v_cmp_ne_u32 vcc, 1, v17
s_nop 0
s_cbranch_vccnz L_zs1_l
L_zs1_x:
s_waitcnt vmcnt(0)
s_branch L_zr1
L_hs:
s_mov_b32 s91, 65536
L_hs_l:
buffer_load_dwordx4 v[16:19], v7, s[8:11], s67 offen offset:0 sc1
buffer_load_dwordx4 v[20:23], v7, s[8:11], s67 offen offset:1024 sc1
s_waitcnt vmcnt(0)
s_sub_u32 s91, s91, 1
s_cbranch_scc1 L_hr
v_min3_u32 v28, v16, v17, v18
v_min3_u32 v28, v28, v19, v20
v_min3_u32 v28, v28, v21, v22
v_min_u32 v28, v28, v23
v_cmp_eq_u32 vcc, 0, v28
s_nop 0
s_cbranch_vccnz L_hs_l
s_branch L_hr
L_lsj0:
s_mov_b32 s91, 65536
L_lsj0_l:
s_sleep 2
buffer_load_dword v5, v17, s[8:11], s46 offen sc1
s_sub_u32 s91, s91, 1
s_cbranch_scc1 L_lsj0_x
s_waitcnt vmcnt(0)
v_cmp_gt_u32 vcc, 2, v5
s_nop 0
s_cbranch_vccnz L_lsj0_l
L_lsj0_x:
s_waitcnt vmcnt(0)
s_branch L_lrj0
L_lsh2:
s_mov_b32 s91, 65536
L_lsh2_l:
s_sleep 2
buffer_load_dword v5, v17, s[8:11], s46 offen sc1
s_sub_u32 s91, s91, 1
s_cbranch_scc1 L_lsh2_x
s_waitcnt vmcnt(0)
v_cmp_gt_u32 vcc, 2, v5
s_nop 0
s_cbranch_vccnz L_lsh2_l
L_lsh2_x:
s_waitcnt vmcnt(0)
s_branch L_lrh2
L_lsh4:
s_mov_b32 s91, 65536
L_lsh4_l:
s_sleep 2
buffer_load_dword v5, v9, s[8:11], s46 offen sc1
s_sub_u32 s91, s91, 1
s_cbranch_scc1 L_lsh4_x
s_waitcnt vmcnt(0)
v_cmp_gt_u32 vcc, s84, v5
s_nop 0
s_cbranch_vccnz L_lsh4_l
L_lsh4_x:
s_waitcnt vmcnt(0)
s_branch L_lrh4
L_wsq0:
s_mov_b32 s91, 65536
L_wsq0_l:
s_sleep 2
buffer_load_dword v5, v31, s[8:11], s46 offen offset:4 sc1
s_sub_u32 s91, s91, 1
s_cbranch_scc1 L_wsq0_x
s_waitcnt vmcnt(0)
v_cmp_ne_u32 vcc, 1, v5
s_nop 0
s_mov_b32 vcc_hi, 0
s_cbranch_vccnz L_wsq0_l
L_wsq0_x:
s_waitcnt vmcnt(0)
s_branch L_wrq0
L_wsr0:
s_mov_b32 s91, 65536
L_wsr0_l:
s_sleep 2
buffer_load_dword v5, v31, s[8:11], s46 offen offset:4 sc1
s_sub_u32 s91, s91, 1
s_cbranch_scc1 L_wsr0_x
s_waitcnt vmcnt(0)
v_cmp_ne_u32 vcc, 1, v5
s_nop 0
s_mov_b32 vcc_lo, 0
s_cbranch_vccnz L_wsr0_l
L_wsr0_x:
s_waitcnt vmcnt(0)
s_branch L_wrr0
L_wsq1:
s_mov_b32 s91, 65536
L_wsq1_l:
s_sleep 2
buffer_load_dword v5, v31, s[8:11], s46 offen offset:4 sc1
s_sub_u32 s91, s91, 1
s_cbranch_scc1 L_wsq1_x
s_waitcnt vmcnt(0)
v_cmp_ne_u32 vcc, 1, v5
s_nop 0
s_mov_b32 vcc_hi, 0
s_cbranch_vccnz L_wsq1_l
L_wsq1_x:
s_waitcnt vmcnt(0)
s_branch L_wrq1
L_wsr1:
s_mov_b32 s91, 65536
L_wsr1_l:
s_sleep 2
buffer_load_dword v5, v31, s[8:11], s46 offen offset:4 sc1
s_sub_u32 s91, s91, 1
s_cbranch_scc1 L_wsr1_x
s_waitcnt vmcnt(0)
v_cmp_ne_u32 vcc, 1, v5
s_nop 0
s_mov_b32 vcc_lo, 0
s_cbranch_vccnz L_wsr1_l
L_wsr1_x:
s_waitcnt vmcnt(0)
s_branch L_wrr1
L_fll:
s_sub_u32 s65, s7, s40
s_mov_b32 s64, -1
s_cmp_eq_u32 s65, 1
s_cbranch_scc1 L_fl2
s_cmp_lg_u32 s20, 0
s_cbranch_scc1 L_fl3
s_lshr_b32 s64, s42, 3
s_cmp_eq_u32 s7, s64
s_cbranch_scc0 L_fl1
v_mov_b32 v15, 4
buffer_store_dword v15, v1, s[8:11], s45 offen sc1
L_fl1:
s_cmp_lg_u32 s65, 0
s_cbranch_scc1 L_fllr
s_movk_i32 s64, 0x380
L_fl2:
v_min_u32 v17, s64, v9
s_mov_b32 s6, 4
buffer_load_dword v5, v17, s[8:11], s46 offen sc1
s_bitcmp1_b32 s39, 15
s_cbranch_scc0 L_fllr
L_fl3:
s_cmp_eq_u32 s7, 1
s_cbranch_scc1 L_y2
s_cmp_eq_u32 s7, 2
s_cbranch_scc1 L_y3
s_cmp_eq_u32 s7, 3
s_cbranch_scc1 L_y4
s_branch L_y5
s_waitcnt vmcnt(0)
L_fps:
s_cmp_lg_u32 s35, 0
s_cbranch_scc1 L_fpr
L_fps2:
s_mov_b32 s91, 65536
L_fps2_l:
s_sleep 2
buffer_load_dword v6, off, s[8:11], s47 sc1
s_sub_u32 s91, s91, 1
s_cbranch_scc1 L_fps2_x
s_waitcnt vmcnt(0)
v_cmp_ne_u32 vcc, 1, v6
s_nop 0
s_cbranch_vccnz L_fps2_l
L_fps2_x:
s_waitcnt vmcnt(0)
s_branch L_fpr
L_fqs:
s_mov_b32 s91, 65536
L_fqs_l:
s_sleep 2
buffer_load_dword v6, off, s[8:11], s47 offset:16 sc1
s_sub_u32 s91, s91, 1
s_cbranch_scc1 L_fqs_x
s_waitcnt vmcnt(0)
v_cmp_ne_u32 vcc, 1, v6
s_nop 0
s_cbranch_vccnz L_fqs_l
L_fqs_x:
s_waitcnt vmcnt(0)
s_branch L_fqr
L_fls0:
s_mov_b32 s91, 65536
L_fls0_l:
s_sleep 2
buffer_load_dword v5, v17, s[8:11], s46 offen sc1
s_sub_u32 s91, s91, 1
s_cbranch_scc1 L_fls0_x
s_waitcnt vmcnt(0)
v_cmp_gt_u32 vcc, s6, v5
s_nop 0
s_cbranch_vccnz L_fls0_l
L_fls0_x:
s_waitcnt vmcnt(0)
s_branch L_flr0
L_y2:
v_lshrrev_b32 v11, 7, v7
v_mul_u32_u24 v11, 4352, v11
v_and_b32 v12, 0x70, v7
v_lshl_add_u32 v11, v12, 3, v11
s_mov_b32 s64, 104923136
s_mov_b32 s65, 104957952
buffer_load_dword a128, v11, s[8:11], s64 offen sc1
buffer_load_dword a129, v11, s[8:11], s65 offen sc1
s_branch L_fllr
s_waitcnt vmcnt(0)
L_y3:
s_mov_b32 s91, 65536
L_y3c:
G v12,a128
G v13,a129
v_min_u32 v12, v12, v13
v_cmp_gt_u32 vcc, 2, v12
s_sub_u32 s91, s91, 1
s_cbranch_scc1 L_y3x
s_cbranch_vccz L_y3x
v_lshrrev_b32 v11, 7, v7
v_mul_u32_u24 v11, 4352, v11
v_and_b32 v12, 0x70, v7
v_lshl_add_u32 v11, v12, 3, v11
s_mov_b32 s64, 104923136
s_mov_b32 s65, 104957952
buffer_load_dword a128, v11, s[8:11], s64 offen sc1
buffer_load_dword a129, v11, s[8:11], s65 offen sc1
s_waitcnt vmcnt(0)
s_branch L_y3c
L_y3x:
s_lshl_b32 s66, s41, 1
SA s66,s66,s20
s_sub_u32 s66, s66, 2
s_cmp_lt_u32 s66, 14
s_cselect_b32 s64, 8, 12
SA s64,s64,104890368
buffer_load_dword a130, off, s[8:11], s64 sc1
v_lshrrev_b32 v11, 7, v7
v_mul_u32_u24 v11, 3584, v11
v_and_b32 v12, 0x70, v7
v_add_u32 v11, v12, v11
s_lshl_b32 s65, s66, 7
SA s65,s65,105906176
buffer_load_dwordx4 a[132:135], v11, s[8:11], s65 offen sc1
SA s65,s65,28672
buffer_load_dwordx4 a[136:139], v11, s[8:11], s65 offen sc1
SA s65,s65,28672
buffer_load_dwordx4 a[140:143], v11, s[8:11], s65 offen sc1
SA s65,s65,28672
buffer_load_dwordx4 a[144:147], v11, s[8:11], s65 offen sc1
SA s65,s65,28672
buffer_load_dwordx4 a[148:151], v11, s[8:11], s65 offen sc1
SA s65,s65,28672
buffer_load_dwordx4 a[152:155], v11, s[8:11], s65 offen sc1
SA s65,s65,28672
buffer_load_dwordx4 a[156:159], v11, s[8:11], s65 offen sc1
SA s65,s65,28672
buffer_load_dwordx4 a[160:163], v11, s[8:11], s65 offen sc1
SA s65,s65,28672
buffer_load_dwordx4 a[164:167], v11, s[8:11], s65 offen sc1
SA s65,s65,28672
buffer_load_dwordx4 a[168:171], v11, s[8:11], s65 offen sc1
SA s65,s65,28672
buffer_load_dwordx4 a[172:175], v11, s[8:11], s65 offen sc1
SA s65,s65,28672
buffer_load_dwordx4 a[176:179], v11, s[8:11], s65 offen sc1
SA s65,s65,28672
buffer_load_dwordx4 a[180:183], v11, s[8:11], s65 offen sc1
SA s65,s65,28672
buffer_load_dwordx4 a[184:187], v11, s[8:11], s65 offen sc1
SA s65,s65,28672
s_branch L_fllr
s_waitcnt vmcnt(0)
L_y4:
G v12,a132
G v13,a133
G v14,a134
G v15,a135
G v16,a136
G v17,a137
AF v12,v16,v12
AF v13,v17,v13
G v16,a138
G v17,a139
AF v14,v16,v14
AF v15,v17,v15
G v16,a140
G v17,a141
AF v12,v16,v12
AF v13,v17,v13
G v16,a142
G v17,a143
AF v14,v16,v14
AF v15,v17,v15
G v16,a144
G v17,a145
AF v12,v16,v12
AF v13,v17,v13
G v16,a146
G v17,a147
AF v14,v16,v14
AF v15,v17,v15
G v16,a148
G v17,a149
AF v12,v16,v12
AF v13,v17,v13
G v16,a150
G v17,a151
AF v14,v16,v14
AF v15,v17,v15
G v16,a152
G v17,a153
AF v12,v16,v12
AF v13,v17,v13
G v16,a154
G v17,a155
AF v14,v16,v14
AF v15,v17,v15
G v16,a156
G v17,a157
AF v12,v16,v12
AF v13,v17,v13
G v16,a158
G v17,a159
AF v14,v16,v14
AF v15,v17,v15
G v16,a160
G v17,a161
AF v12,v16,v12
AF v13,v17,v13
G v16,a162
G v17,a163
AF v14,v16,v14
AF v15,v17,v15
G v16,a164
G v17,a165
AF v12,v16,v12
AF v13,v17,v13
G v16,a166
G v17,a167
AF v14,v16,v14
AF v15,v17,v15
G v16,a168
G v17,a169
AF v12,v16,v12
AF v13,v17,v13
G v16,a170
G v17,a171
AF v14,v16,v14
AF v15,v17,v15
G v16,a172
G v17,a173
AF v12,v16,v12
AF v13,v17,v13
G v16,a174
G v17,a175
AF v14,v16,v14
AF v15,v17,v15
G v16,a176
G v17,a177
AF v12,v16,v12
AF v13,v17,v13
G v16,a178
G v17,a179
AF v14,v16,v14
AF v15,v17,v15
G v16,a180
G v17,a181
AF v12,v16,v12
AF v13,v17,v13
G v16,a182
G v17,a183
AF v14,v16,v14
AF v15,v17,v15
G v16,a184
G v17,a185
AF v12,v16,v12
AF v13,v17,v13
G v16,a186
G v17,a187
AF v14,v16,v14
AF v15,v17,v15
v_add_f32 v12, v12, v12 row_ror:8 row_mask:0xf bank_mask:0xf
v_add_f32 v13, v13, v13 row_ror:8 row_mask:0xf bank_mask:0xf
v_add_f32 v14, v14, v14 row_ror:8 row_mask:0xf bank_mask:0xf
v_add_f32 v15, v15, v15 row_ror:8 row_mask:0xf bank_mask:0xf
v_mov_b32 v11, v12
s_nop 1
v_permlane16_swap_b32 v11, v12
AF v12,v11,v12
v_mov_b32 v11, v13
s_nop 1
v_permlane16_swap_b32 v11, v13
AF v13,v11,v13
v_mov_b32 v11, v14
s_nop 1
v_permlane16_swap_b32 v11, v14
AF v14,v11,v14
v_mov_b32 v11, v15
s_nop 1
v_permlane16_swap_b32 v11, v15
AF v15,v11,v15
v_mov_b32 v11, v12
s_nop 1
v_permlane32_swap_b32 v11, v12
AF v12,v11,v12
v_mov_b32 v11, v13
s_nop 1
v_permlane32_swap_b32 v11, v13
AF v13,v11,v13
v_mov_b32 v11, v14
s_nop 1
v_permlane32_swap_b32 v11, v14
AF v14,v11,v14
v_mov_b32 v11, v15
s_nop 1
v_permlane32_swap_b32 v11, v15
AF v15,v11,v15
G v16,a130
C v11,v12,v13
v_lshlrev_b32 v12, 16, v11
v_and_b32 v13, 0xffff0000, v11
C v11,v14,v15
v_lshlrev_b32 v14, 16, v11
v_and_b32 v15, 0xffff0000, v11
MF v12,v16,v12
MF v13,v16,v13
MF v14,v16,v14
MF v15,v16,v15
C v11,v12,v13
v_lshlrev_b32 v12, 16, v11
v_and_b32 v13, 0xffff0000, v11
C v11,v14,v15
v_lshlrev_b32 v14, 16, v11
v_and_b32 v15, 0xffff0000, v11
s_lshl_b32 s66, s41, 1
SA s66,s66,s20
s_sub_u32 s66, s66, 2
s_lshl_b32 s65, s66, 7
SA s65,s65,104898560
s_mov_b64 exec, 0xff
buffer_store_dwordx4 v[12:15], v7, s[8:11], s65 offen sc1
s_mov_b64 exec, -1
s_nop 1
s_branch L_fllr
L_y5:
s_lshl_b32 s66, s41, 1
SA s66,s66,s20
s_sub_u32 s66, s66, 2
s_lshl_b32 s66, s66, 2
SA s66,s66,105062912
v_mov_b32 v11, 1
s_mov_b64 exec, 1
buffer_store_dword v11, off, s[8:11], s66 sc1
s_mov_b64 exec, -1
s_branch L_fllr
.p2align 12
L_loop_top:
M v[64:67],a[64:67],a[0:3],v[32:35]
SA m0,s28,0
R a[96:99],v2,40960
M v[64:67],a[68:71],a[4:7],v[64:67]
buffer_load_dword a240, v0, s[60:63], 0 offen offset:0
M v[64:67],a[72:75],a[8:11],v[64:67]
R a[100:103],v2,41984
M v[64:67],a[76:79],a[12:15],v[64:67]
s_waitcnt lgkmcnt(2)
buffer_load_dwordx4 v3, s[8:11], s26 offen offset:0 sc1 lds
M v[64:67],a[80:83],a[16:19],v[64:67]
R a[104:107],v2,43008
M v[64:67],a[84:87],a[20:23],v[64:67]
E v18,v112
M v[64:67],a[88:91],a[24:27],v[64:67]
R a[108:111],v2,44032
M v[64:67],a[92:95],a[28:31],v[64:67]
buffer_load_dwordx4 v3, s[8:11], s26 offen offset:1024 sc1 lds
M v[68:71],a[92:95],a[60:63],v[36:39]
R a[112:115],v2,45056
M v[68:71],a[88:91],a[56:59],v[68:71]
E v19,v113
M v[68:71],a[84:87],a[52:55],v[68:71]
R a[116:119],v2,46080
AF v28,v18,v28
M v[68:71],a[80:83],a[48:51],v[68:71]
E v20,v114
M v[68:71],a[76:79],a[44:47],v[68:71]
R a[120:123],v2,47104
C v56,v18,v19
M v[68:71],a[72:75],a[40:43],v[68:71]
buffer_load_dwordx4 v3, s[8:11], s26 offen offset:2048 sc1 lds
M v[68:71],a[68:71],a[36:39],v[68:71]
R a[124:127],v2,48128
AF v28,v19,v28
M v[68:71],a[64:67],a[32:35],v[68:71]
s_waitcnt lgkmcnt(4)
E v21,v115
M v[72:75],a[96:99],a[0:3],v[32:35]
R a[64:67],v2,49152
AF v28,v20,v28
M v[72:75],a[100:103],a[4:7],v[72:75]
buffer_load_dwordx4 v3, s[8:11], s26 offen offset:3072 sc1 lds
M v[72:75],a[104:107],a[8:11],v[72:75]
R a[68:71],v2,50176
C v57,v20,v21
M v[72:75],a[108:111],a[12:15],v[72:75]
s_waitcnt lgkmcnt(2)
E v22,v120
M v[72:75],a[112:115],a[16:19],v[72:75]
R a[72:75],v2,51200
AF v28,v21,v28
M v[72:75],a[116:119],a[20:23],v[72:75]
E v23,v121
M v[72:75],a[120:123],a[24:27],v[72:75]
SA m0,s28,4096
R a[76:79],v2,52224
AF v28,v22,v28
M v[72:75],a[124:127],a[28:31],v[72:75]
buffer_load_dwordx4 v4, s[8:11], s26 offen offset:0 sc1 lds
M v[76:79],a[124:127],a[60:63],v[36:39]
R a[80:83],v2,53248
C v58,v22,v23
M v[76:79],a[120:123],a[56:59],v[76:79]
E v24,v122
M v[76:79],a[116:119],a[52:55],v[76:79]
R a[84:87],v2,54272
AF v28,v23,v28
M v[76:79],a[112:115],a[48:51],v[76:79]
E v25,v123
M v[76:79],a[108:111],a[44:47],v[76:79]
R a[88:91],v2,55296
AF v28,v24,v28
M v[76:79],a[104:107],a[40:43],v[76:79]
buffer_load_dwordx4 v4, s[8:11], s26 offen offset:1024 sc1 lds
M v[76:79],a[100:103],a[36:39],v[76:79]
R a[92:95],v2,56320
C v59,v24,v25
M v[76:79],a[96:99],a[32:35],v[76:79]
s_waitcnt lgkmcnt(4)
E v18,v116
M v[80:83],a[64:67],a[0:3],v[32:35]
R a[96:99],v2,57344
AF v28,v25,v28
M v[80:83],a[68:71],a[4:7],v[80:83]
R a[100:103],v2,58368
M v[80:83],a[72:75],a[8:11],v[80:83]
buffer_load_dwordx4 v4, s[8:11], s26 offen offset:2048 sc1 lds
M v[80:83],a[76:79],a[12:15],v[80:83]
s_waitcnt lgkmcnt(2)
R a[104:107],v2,59392
M v[80:83],a[80:83],a[16:19],v[80:83]
R a[108:111],v2,60416
M v[80:83],a[84:87],a[20:23],v[80:83]
E v19,v117
M v[80:83],a[88:91],a[24:27],v[80:83]
R a[112:115],v2,61440
AF v29,v18,v29
M v[80:83],a[92:95],a[28:31],v[80:83]
R a[116:119],v2,62464
C v60,v18,v19
M v[84:87],a[92:95],a[60:63],v[36:39]
buffer_load_dwordx4 v4, s[8:11], s26 offen offset:3072 sc1 lds
M v[84:87],a[88:91],a[56:59],v[84:87]
SA s26,s26,32768
R a[120:123],v2,63488
AF v29,v19,v29
M v[84:87],a[84:87],a[52:55],v[84:87]
R a[124:127],v2,64512
M v[84:87],a[80:83],a[48:51],v[84:87]
E v20,v118
M v[84:87],a[76:79],a[44:47],v[84:87]
E v21,v119
M v[84:87],a[72:75],a[40:43],v[84:87]
E v22,v124
M v[84:87],a[68:71],a[36:39],v[84:87]
s_waitcnt vmcnt(17) lgkmcnt(0)
E v23,v125
M v[84:87],a[64:67],a[32:35],v[84:87]
s_barrier
M v[88:91],a[96:99],a[0:3],v[32:35]
R a[64:67],v7,32768
AF v29,v20,v29
M v[88:91],a[100:103],a[4:7],v[88:91]
E v24,v126
M v[88:91],a[104:107],a[8:11],v[88:91]
R a[68:71],v7,33792
C v61,v20,v21
M v[88:91],a[108:111],a[12:15],v[88:91]
AF v29,v21,v29
AF v29,v22,v29
M v[88:91],a[112:115],a[16:19],v[88:91]
R a[72:75],v7,34816
C v62,v22,v23
M v[88:91],a[116:119],a[20:23],v[88:91]
E v25,v127
M v[88:91],a[120:123],a[24:27],v[88:91]
R a[76:79],v7,35840
AF v29,v23,v29
M v[88:91],a[124:127],a[28:31],v[88:91]
AF v29,v24,v29
C v63,v24,v25
M v[92:95],a[124:127],a[60:63],v[36:39]
R a[80:83],v7,36864
AF v29,v25,v29
M v[92:95],a[120:123],a[56:59],v[92:95]
M v[92:95],a[116:119],a[52:55],v[92:95]
R a[84:87],v7,37888
v_max_f32 v10, v28, v29
M v[92:95],a[112:115],a[48:51],v[92:95]
v_cmp_lt_f32 vcc, s31, v10
M v[92:95],a[108:111],a[44:47],v[92:95]
R a[88:91],v7,38912
M v[92:95],a[104:107],a[40:43],v[92:95]
M v[92:95],a[100:103],a[36:39],v[92:95]
s_waitcnt lgkmcnt(3)
R a[92:95],v7,39936
M v[92:95],a[96:99],a[32:35],v[92:95]
s_cbranch_vccnz L_st1
L_rt1:
M v[128:131],a[64:67],v[48:51],v[128:131]
SA m0,s28,98304
R a[96:99],v7,40960
AF v30,v28,v30
M v[128:131],a[68:71],v[56:59],v[128:131]
buffer_load_dwordx4 v3, s[8:11], s21 offen offset:0 sc1 lds
M v[132:135],a[68:71],v[60:63],v[132:135]
R a[100:103],v7,41984
AF v31,v29,v31
M v[132:135],a[64:67],v[52:55],v[132:135]
s_waitcnt lgkmcnt(2)
E v18,v64
M v[136:139],a[72:75],v[48:51],v[136:139]
R a[104:107],v7,43008
M v[136:139],a[76:79],v[56:59],v[136:139]
buffer_load_dwordx4 v3, s[8:11], s21 offen offset:1024 sc1 lds
M v[140:143],a[76:79],v[60:63],v[140:143]
R a[108:111],v7,44032
M v[140:143],a[72:75],v[52:55],v[140:143]
E v19,v65
M v[144:147],a[80:83],v[48:51],v[144:147]
R a[112:115],v7,45056
AF v26,v18,v19
M v[144:147],a[84:87],v[56:59],v[144:147]
E v20,v66
M v[148:151],a[84:87],v[60:63],v[148:151]
R a[116:119],v7,46080
C v40,v18,v19
M v[148:151],a[80:83],v[52:55],v[148:151]
buffer_load_dwordx4 v3, s[8:11], s21 offen offset:2048 sc1 lds
M v[152:155],a[88:91],v[48:51],v[152:155]
R a[120:123],v7,47104
M v[152:155],a[92:95],v[56:59],v[152:155]
E v21,v67
M v[156:159],a[92:95],v[60:63],v[156:159]
R a[124:127],v7,48128
AF v26,v20,v26
M v[156:159],a[88:91],v[52:55],v[156:159]
s_waitcnt lgkmcnt(4)
buffer_load_dwordx4 v3, s[8:11], s21 offen offset:3072 sc1 lds
M v[160:163],a[96:99],v[48:51],v[160:163]
R a[64:67],v7,49152
C v41,v20,v21
M v[160:163],a[100:103],v[56:59],v[160:163]
E v22,v72
M v[164:167],a[100:103],v[60:63],v[164:167]
SA m0,s28,102400
R a[68:71],v7,50176
AF v26,v21,v26
M v[164:167],a[96:99],v[52:55],v[164:167]
s_waitcnt lgkmcnt(2)
buffer_load_dwordx4 v4, s[8:11], s21 offen offset:0 sc1 lds
M v[168:171],a[104:107],v[48:51],v[168:171]
R a[72:75],v7,51200
M v[168:171],a[108:111],v[56:59],v[168:171]
E v23,v73
M v[172:175],a[108:111],v[60:63],v[172:175]
R a[76:79],v7,52224
AF v26,v22,v26
M v[172:175],a[104:107],v[52:55],v[172:175]
E v24,v74
M v[176:179],a[112:115],v[48:51],v[176:179]
R a[80:83],v7,53248
C v42,v22,v23
M v[176:179],a[116:119],v[56:59],v[176:179]
buffer_load_dwordx4 v4, s[8:11], s21 offen offset:1024 sc1 lds
M v[180:183],a[116:119],v[60:63],v[180:183]
R a[84:87],v7,54272
AF v26,v23,v26
M v[180:183],a[112:115],v[52:55],v[180:183]
E v25,v75
M v[184:187],a[120:123],v[48:51],v[184:187]
R a[88:91],v7,55296
AF v26,v24,v26
M v[184:187],a[124:127],v[56:59],v[184:187]
buffer_load_dwordx4 v4, s[8:11], s21 offen offset:2048 sc1 lds
M v[188:191],a[124:127],v[60:63],v[188:191]
R a[92:95],v7,56320
C v43,v24,v25
M v[188:191],a[120:123],v[52:55],v[188:191]
s_waitcnt lgkmcnt(4)
E v18,v68
M v[192:195],a[64:67],v[48:51],v[192:195]
R a[96:99],v7,57344
AF v26,v25,v26
M v[192:195],a[68:71],v[56:59],v[192:195]
R a[100:103],v7,58368
M v[196:199],a[68:71],v[60:63],v[196:199]
buffer_load_dwordx4 v4, s[8:11], s21 offen offset:3072 sc1 lds
M v[196:199],a[64:67],v[52:55],v[196:199]
s_waitcnt lgkmcnt(2)
R a[104:107],v7,59392
M v[200:203],a[72:75],v[48:51],v[200:203]
SA s21,s21,32768
R a[108:111],v7,60416
M v[200:203],a[76:79],v[56:59],v[200:203]
s_sub_u32 s22, s22, 1
E v19,v69
M v[204:207],a[76:79],v[60:63],v[204:207]
s_cselect_b32 s21, s23, s21
R a[112:115],v7,61440
AF v27,v18,v19
M v[204:207],a[72:75],v[52:55],v[204:207]
R a[116:119],v7,62464
C v44,v18,v19
M v[208:211],a[80:83],v[48:51],v[208:211]
E v20,v70
M v[208:211],a[84:87],v[56:59],v[208:211]
R a[120:123],v7,63488
M v[212:215],a[84:87],v[60:63],v[212:215]
R a[124:127],v7,64512
M v[212:215],a[80:83],v[52:55],v[212:215]
E v21,v71
M v[216:219],a[88:91],v[48:51],v[216:219]
E v22,v76
M v[216:219],a[92:95],v[56:59],v[216:219]
AF v27,v20,v27
C v45,v20,v21
M v[220:223],a[92:95],v[60:63],v[220:223]
s_waitcnt vmcnt(17) lgkmcnt(0)
AF v27,v21,v27
M v[220:223],a[88:91],v[52:55],v[220:223]
s_barrier
M v[224:227],a[96:99],v[48:51],v[224:227]
R a[64:67],v2,0
M v[224:227],a[100:103],v[56:59],v[224:227]
E v23,v77
M v[228:231],a[100:103],v[60:63],v[228:231]
R a[68:71],v2,1024
AF v27,v22,v27
M v[228:231],a[96:99],v[52:55],v[228:231]
E v24,v78
M v[232:235],a[104:107],v[48:51],v[232:235]
R a[72:75],v2,2048
C v46,v22,v23
M v[232:235],a[108:111],v[56:59],v[232:235]
AF v27,v23,v27
M v[236:239],a[108:111],v[60:63],v[236:239]
R a[76:79],v2,3072
M v[236:239],a[104:107],v[52:55],v[236:239]
E v25,v79
M v[240:243],a[112:115],v[48:51],v[240:243]
R a[80:83],v2,4096
AF v27,v24,v27
M v[240:243],a[116:119],v[56:59],v[240:243]
C v47,v24,v25
AF v27,v25,v27
M v[244:247],a[116:119],v[60:63],v[244:247]
R a[84:87],v2,5120
M v[244:247],a[112:115],v[52:55],v[244:247]
M v[248:251],a[120:123],v[48:51],v[248:251]
R a[88:91],v2,6144
M v[248:251],a[124:127],v[56:59],v[248:251]
M v[252:255],a[124:127],v[60:63],v[252:255]
s_waitcnt lgkmcnt(3)
R a[92:95],v2,7168
M v[252:255],a[120:123],v[52:55],v[252:255]
M v[96:99],a[64:67],a[0:3],v[32:35]
s_bitcmp1_b32 s39, s7
R a[96:99],v2,8192
M v[96:99],a[68:71],a[4:7],v[96:99]
s_cbranch_scc1 L_fll
L_fllr:
E v18,v80
M v[96:99],a[72:75],a[8:11],v[96:99]
SA m0,s28,32768
R a[100:103],v2,9216
M v[96:99],a[76:79],a[12:15],v[96:99]
s_waitcnt lgkmcnt(2)
buffer_load_dwordx4 v3, s[8:11], s26 offen offset:0 sc1 lds
M v[96:99],a[80:83],a[16:19],v[96:99]
R a[104:107],v2,10240
M v[96:99],a[84:87],a[20:23],v[96:99]
E v19,v81
M v[96:99],a[88:91],a[24:27],v[96:99]
R a[108:111],v2,11264
AF v26,v18,v26
M v[96:99],a[92:95],a[28:31],v[96:99]
E v20,v82
M v[100:103],a[92:95],a[60:63],v[36:39]
R a[112:115],v2,12288
C v56,v18,v19
M v[100:103],a[88:91],a[56:59],v[100:103]
buffer_load_dwordx4 v3, s[8:11], s26 offen offset:1024 sc1 lds
M v[100:103],a[84:87],a[52:55],v[100:103]
R a[116:119],v2,13312
AF v26,v19,v26
M v[100:103],a[80:83],a[48:51],v[100:103]
E v21,v83
M v[100:103],a[76:79],a[44:47],v[100:103]
R a[120:123],v2,14336
AF v26,v20,v26
M v[100:103],a[72:75],a[40:43],v[100:103]
buffer_load_dwordx4 v3, s[8:11], s26 offen offset:2048 sc1 lds
M v[100:103],a[68:71],a[36:39],v[100:103]
R a[124:127],v2,15360
C v57,v20,v21
M v[100:103],a[64:67],a[32:35],v[100:103]
s_waitcnt lgkmcnt(4)
E v22,v88
M v[104:107],a[96:99],a[0:3],v[32:35]
R a[64:67],v2,16384
AF v26,v21,v26
M v[104:107],a[100:103],a[4:7],v[104:107]
E v23,v89
M v[104:107],a[104:107],a[8:11],v[104:107]
R a[68:71],v2,17408
AF v26,v22,v26
M v[104:107],a[108:111],a[12:15],v[104:107]
s_waitcnt lgkmcnt(2)
buffer_load_dwordx4 v3, s[8:11], s26 offen offset:3072 sc1 lds
M v[104:107],a[112:115],a[16:19],v[104:107]
R a[72:75],v2,18432
C v58,v22,v23
M v[104:107],a[116:119],a[20:23],v[104:107]
E v24,v90
M v[104:107],a[120:123],a[24:27],v[104:107]
R a[76:79],v2,19456
AF v26,v23,v26
M v[104:107],a[124:127],a[28:31],v[104:107]
SA m0,s28,36864
M v[108:111],a[124:127],a[60:63],v[36:39]
R a[80:83],v2,20480
M v[108:111],a[120:123],a[56:59],v[108:111]
buffer_load_dwordx4 v4, s[8:11], s26 offen offset:0 sc1 lds
M v[108:111],a[116:119],a[52:55],v[108:111]
R a[84:87],v2,21504
M v[108:111],a[112:115],a[48:51],v[108:111]
E v25,v91
M v[108:111],a[108:111],a[44:47],v[108:111]
R a[88:91],v2,22528
AF v26,v24,v26
M v[108:111],a[104:107],a[40:43],v[108:111]
buffer_load_dwordx4 v4, s[8:11], s26 offen offset:1024 sc1 lds
M v[108:111],a[100:103],a[36:39],v[108:111]
R a[92:95],v2,23552
C v59,v24,v25
M v[108:111],a[96:99],a[32:35],v[108:111]
s_waitcnt lgkmcnt(4)
E v18,v84
M v[112:115],a[64:67],a[0:3],v[32:35]
R a[96:99],v2,24576
AF v26,v25,v26
M v[112:115],a[68:71],a[4:7],v[112:115]
R a[100:103],v2,25600
M v[112:115],a[72:75],a[8:11],v[112:115]
buffer_load_dwordx4 v4, s[8:11], s26 offen offset:2048 sc1 lds
M v[112:115],a[76:79],a[12:15],v[112:115]
s_waitcnt lgkmcnt(2)
R a[104:107],v2,26624
M v[112:115],a[80:83],a[16:19],v[112:115]
R a[108:111],v2,27648
M v[112:115],a[84:87],a[20:23],v[112:115]
E v19,v85
M v[112:115],a[88:91],a[24:27],v[112:115]
R a[112:115],v2,28672
AF v27,v18,v27
M v[112:115],a[92:95],a[28:31],v[112:115]
R a[116:119],v2,29696
C v60,v18,v19
M v[116:119],a[92:95],a[60:63],v[36:39]
buffer_load_dwordx4 v4, s[8:11], s26 offen offset:3072 sc1 lds
M v[116:119],a[88:91],a[56:59],v[116:119]
SA s26,s26,32768
R a[120:123],v2,30720
AF v27,v19,v27
M v[116:119],a[84:87],a[52:55],v[116:119]
R a[124:127],v2,31744
M v[116:119],a[80:83],a[48:51],v[116:119]
E v20,v86
M v[116:119],a[76:79],a[44:47],v[116:119]
E v21,v87
M v[116:119],a[72:75],a[40:43],v[116:119]
E v22,v92
M v[116:119],a[68:71],a[36:39],v[116:119]
s_waitcnt vmcnt(16) lgkmcnt(0)
E v23,v93
M v[116:119],a[64:67],a[32:35],v[116:119]
s_barrier
M v[120:123],a[96:99],a[0:3],v[32:35]
R a[64:67],v7,0
AF v27,v20,v27
M v[120:123],a[100:103],a[4:7],v[120:123]
E v24,v94
M v[120:123],a[104:107],a[8:11],v[120:123]
R a[68:71],v7,1024
C v61,v20,v21
M v[120:123],a[108:111],a[12:15],v[120:123]
AF v27,v21,v27
AF v27,v22,v27
M v[120:123],a[112:115],a[16:19],v[120:123]
R a[72:75],v7,2048
C v62,v22,v23
M v[120:123],a[116:119],a[20:23],v[120:123]
E v25,v95
M v[120:123],a[120:123],a[24:27],v[120:123]
R a[76:79],v7,3072
AF v27,v23,v27
M v[120:123],a[124:127],a[28:31],v[120:123]
AF v27,v24,v27
C v63,v24,v25
M v[124:127],a[124:127],a[60:63],v[36:39]
R a[80:83],v7,4096
AF v27,v25,v27
M v[124:127],a[120:123],a[56:59],v[124:127]
M v[124:127],a[116:119],a[52:55],v[124:127]
R a[84:87],v7,5120
v_max_f32 v10, v26, v27
M v[124:127],a[112:115],a[48:51],v[124:127]
v_cmp_lt_f32 vcc, s31, v10
M v[124:127],a[108:111],a[44:47],v[124:127]
R a[88:91],v7,6144
M v[124:127],a[104:107],a[40:43],v[124:127]
M v[124:127],a[100:103],a[36:39],v[124:127]
s_waitcnt lgkmcnt(3)
R a[92:95],v7,7168
M v[124:127],a[96:99],a[32:35],v[124:127]
s_cbranch_vccnz L_st0
L_rt0:
M v[128:131],a[64:67],v[40:43],v[128:131]
SA m0,s28,65536
R a[96:99],v7,8192
AF v30,v26,v30
M v[128:131],a[68:71],v[56:59],v[128:131]
buffer_load_dwordx4 v3, s[8:11], s21 offen offset:0 sc1 lds
M v[132:135],a[68:71],v[60:63],v[132:135]
R a[100:103],v7,9216
AF v31,v27,v31
M v[132:135],a[64:67],v[44:47],v[132:135]
s_waitcnt lgkmcnt(2)
E v18,v96
M v[136:139],a[72:75],v[40:43],v[136:139]
R a[104:107],v7,10240
M v[136:139],a[76:79],v[56:59],v[136:139]
buffer_load_dwordx4 v3, s[8:11], s21 offen offset:1024 sc1 lds
M v[140:143],a[76:79],v[60:63],v[140:143]
R a[108:111],v7,11264
M v[140:143],a[72:75],v[44:47],v[140:143]
E v19,v97
M v[144:147],a[80:83],v[40:43],v[144:147]
R a[112:115],v7,12288
AF v28,v18,v19
M v[144:147],a[84:87],v[56:59],v[144:147]
E v20,v98
M v[148:151],a[84:87],v[60:63],v[148:151]
R a[116:119],v7,13312
C v48,v18,v19
M v[148:151],a[80:83],v[44:47],v[148:151]
buffer_load_dwordx4 v3, s[8:11], s21 offen offset:2048 sc1 lds
M v[152:155],a[88:91],v[40:43],v[152:155]
R a[120:123],v7,14336
M v[152:155],a[92:95],v[56:59],v[152:155]
E v21,v99
M v[156:159],a[92:95],v[60:63],v[156:159]
R a[124:127],v7,15360
AF v28,v20,v28
M v[156:159],a[88:91],v[44:47],v[156:159]
s_waitcnt lgkmcnt(4)
buffer_load_dwordx4 v3, s[8:11], s21 offen offset:3072 sc1 lds
M v[160:163],a[96:99],v[40:43],v[160:163]
R a[64:67],v7,16384
C v49,v20,v21
M v[160:163],a[100:103],v[56:59],v[160:163]
E v22,v104
M v[164:167],a[100:103],v[60:63],v[164:167]
SA m0,s28,69632
R a[68:71],v7,17408
AF v28,v21,v28
M v[164:167],a[96:99],v[44:47],v[164:167]
s_waitcnt lgkmcnt(2)
buffer_load_dwordx4 v4, s[8:11], s21 offen offset:0 sc1 lds
M v[168:171],a[104:107],v[40:43],v[168:171]
R a[72:75],v7,18432
M v[168:171],a[108:111],v[56:59],v[168:171]
E v23,v105
M v[172:175],a[108:111],v[60:63],v[172:175]
R a[76:79],v7,19456
AF v28,v22,v28
M v[172:175],a[104:107],v[44:47],v[172:175]
E v24,v106
M v[176:179],a[112:115],v[40:43],v[176:179]
R a[80:83],v7,20480
C v50,v22,v23
M v[176:179],a[116:119],v[56:59],v[176:179]
buffer_load_dwordx4 v4, s[8:11], s21 offen offset:1024 sc1 lds
M v[180:183],a[116:119],v[60:63],v[180:183]
R a[84:87],v7,21504
AF v28,v23,v28
M v[180:183],a[112:115],v[44:47],v[180:183]
E v25,v107
M v[184:187],a[120:123],v[40:43],v[184:187]
R a[88:91],v7,22528
AF v28,v24,v28
M v[184:187],a[124:127],v[56:59],v[184:187]
buffer_load_dwordx4 v4, s[8:11], s21 offen offset:2048 sc1 lds
M v[188:191],a[124:127],v[60:63],v[188:191]
R a[92:95],v7,23552
C v51,v24,v25
M v[188:191],a[120:123],v[44:47],v[188:191]
s_waitcnt lgkmcnt(4)
E v18,v100
M v[192:195],a[64:67],v[40:43],v[192:195]
R a[96:99],v7,24576
AF v28,v25,v28
M v[192:195],a[68:71],v[56:59],v[192:195]
R a[100:103],v7,25600
M v[196:199],a[68:71],v[60:63],v[196:199]
buffer_load_dwordx4 v4, s[8:11], s21 offen offset:3072 sc1 lds
M v[196:199],a[64:67],v[44:47],v[196:199]
s_waitcnt lgkmcnt(2)
R a[104:107],v7,26624
M v[200:203],a[72:75],v[40:43],v[200:203]
SA s21,s21,32768
R a[108:111],v7,27648
M v[200:203],a[76:79],v[56:59],v[200:203]
s_sub_u32 s22, s22, 1
E v19,v101
M v[204:207],a[76:79],v[60:63],v[204:207]
s_cselect_b32 s21, s23, s21
R a[112:115],v7,28672
AF v29,v18,v19
M v[204:207],a[72:75],v[44:47],v[204:207]
R a[116:119],v7,29696
C v52,v18,v19
M v[208:211],a[80:83],v[40:43],v[208:211]
E v20,v102
M v[208:211],a[84:87],v[56:59],v[208:211]
R a[120:123],v7,30720
M v[212:215],a[84:87],v[60:63],v[212:215]
R a[124:127],v7,31744
M v[212:215],a[80:83],v[44:47],v[212:215]
E v21,v103
M v[216:219],a[88:91],v[40:43],v[216:219]
E v22,v108
M v[216:219],a[92:95],v[56:59],v[216:219]
AF v29,v20,v29
C v53,v20,v21
M v[220:223],a[92:95],v[60:63],v[220:223]
s_waitcnt vmcnt(16) lgkmcnt(0)
AF v29,v21,v29
M v[220:223],a[88:91],v[44:47],v[220:223]
s_barrier
M v[224:227],a[96:99],v[40:43],v[224:227]
R a[64:67],v2,32768
M v[224:227],a[100:103],v[56:59],v[224:227]
E v23,v109
M v[228:231],a[100:103],v[60:63],v[228:231]
R a[68:71],v2,33792
v_cmp_gt_u32 vcc, s6, v5
M v[228:231],a[96:99],v[44:47],v[228:231]
E v24,v110
M v[232:235],a[104:107],v[40:43],v[232:235]
R a[72:75],v2,34816
AF v29,v22,v29
M v[232:235],a[108:111],v[56:59],v[232:235]
s_cbranch_vccnz L_fls0
L_flr0:
C v54,v22,v23
AF v29,v23,v29
M v[236:239],a[108:111],v[60:63],v[236:239]
s_mov_b32 s6, 0
R a[76:79],v2,35840
M v[236:239],a[104:107],v[44:47],v[236:239]
SA s7,s7,1
E v25,v111
M v[240:243],a[112:115],v[40:43],v[240:243]
R a[80:83],v2,36864
AF v29,v24,v29
M v[240:243],a[116:119],v[56:59],v[240:243]
C v55,v24,v25
AF v29,v25,v29
M v[244:247],a[116:119],v[60:63],v[244:247]
R a[84:87],v2,37888
M v[244:247],a[112:115],v[44:47],v[244:247]
M v[248:251],a[120:123],v[40:43],v[248:251]
s_sub_u32 s27, s27, 1
R a[88:91],v2,38912
M v[248:251],a[124:127],v[56:59],v[248:251]
s_cmp_lg_u32 s27, 0
M v[252:255],a[124:127],v[60:63],v[252:255]
s_waitcnt lgkmcnt(3)
R a[92:95],v2,39936
M v[252:255],a[120:123],v[44:47],v[252:255]
s_cbranch_scc1 L_loop_top
s_cmp_eq_u32 s40, 0
s_cbranch_scc1 L_final_h
L_d1s:
M v[68:71],a[64:67],a[32:35],v[36:39]
s_cmp_lt_u32 s20, 0
R a[96:99],v2,40960
R a[100:103],v2,41984
M v[68:71],a[68:71],a[36:39],v[68:71]
s_cselect_b64 s[82:83], -1, 0
E v18,v112
M v[68:71],a[72:75],a[40:43],v[68:71]
s_cmp_eq_u32 s20, 0
M v[68:71],a[76:79],a[44:47],v[68:71]
s_cselect_b64 s[66:67], s[16:17], s[82:83]
R a[104:107],v2,43008
R a[108:111],v2,44032
s_waitcnt lgkmcnt(7)
M v[68:71],a[80:83],a[48:51],v[68:71]
s_cselect_b64 s[68:69], s[18:19], s[82:83]
E v19,v113
s_waitcnt lgkmcnt(6)
M v[68:71],a[84:87],a[52:55],v[68:71]
s_cselect_b64 s[70:71], s[48:49], s[82:83]
AF v28,v18,v28
C v56,v18,v19
s_waitcnt lgkmcnt(5)
M v[68:71],a[88:91],a[56:59],v[68:71]
s_cselect_b64 s[72:73], s[50:51], s[82:83]
R a[112:115],v2,45056
R a[116:119],v2,46080
v_cndmask_b32 v64, v32, v8, s[66:67]
v_cndmask_b32 v65, v32, v8, s[68:69]
v_cndmask_b32 v66, v32, v8, s[70:71]
v_cndmask_b32 v67, v32, v8, s[72:73]
s_waitcnt lgkmcnt(6)
M v[68:71],a[92:95],a[60:63],v[68:71]
s_mov_b32 s26, s43
v_min_u32 v17, 896, v9
AF v28,v19,v28
M v[64:67],a[92:95],a[28:31],v[64:67]
s_cmp_lt_u32 s20, 1
buffer_load_dword v5, v17, s[8:11], s46 offen sc1
M v[64:67],a[88:91],a[24:27],v[64:67]
s_cselect_b64 s[82:83], -1, 0
R a[120:123],v2,47104
R a[124:127],v2,48128
M v[64:67],a[84:87],a[20:23],v[64:67]
SA m0,s28,0
E v20,v114
M v[64:67],a[80:83],a[16:19],v[64:67]
s_cmp_eq_u32 s20, 1
buffer_load_dwordx4 v3, s[8:11], s26 offen offset:0 sc1 lds
M v[64:67],a[76:79],a[12:15],v[64:67]
s_cselect_b64 s[74:75], s[16:17], s[82:83]
E v21,v115
M v[64:67],a[72:75],a[8:11],v[64:67]
s_cselect_b64 s[76:77], s[18:19], s[82:83]
AF v28,v20,v28
C v57,v20,v21
M v[64:67],a[68:71],a[4:7],v[64:67]
s_cselect_b64 s[78:79], s[48:49], s[82:83]
E v22,v120
M v[64:67],a[64:67],a[0:3],v[64:67]
s_waitcnt lgkmcnt(0)
buffer_load_dwordx4 v3, s[8:11], s26 offen offset:1024 sc1 lds
M v[76:79],a[96:99],a[32:35],v[36:39]
s_cselect_b64 s[80:81], s[50:51], s[82:83]
R a[64:67],v2,49152
R a[68:71],v2,50176
M v[76:79],a[100:103],a[36:39],v[76:79]
v_cndmask_b32 v72, v32, v8, s[74:75]
v_cndmask_b32 v73, v32, v8, s[76:77]
M v[76:79],a[104:107],a[40:43],v[76:79]
v_cndmask_b32 v74, v32, v8, s[78:79]
AF v28,v21,v28
M v[76:79],a[108:111],a[44:47],v[76:79]
R a[72:75],v2,51200
R a[76:79],v2,52224
M v[76:79],a[112:115],a[48:51],v[76:79]
buffer_load_dwordx4 v3, s[8:11], s26 offen offset:2048 sc1 lds
M v[76:79],a[116:119],a[52:55],v[76:79]
v_cndmask_b32 v75, v32, v8, s[80:81]
M v[76:79],a[120:123],a[56:59],v[76:79]
s_cmp_lt_u32 s20, 2
R a[80:83],v2,53248
R a[84:87],v2,54272
M v[76:79],a[124:127],a[60:63],v[76:79]
s_cselect_b64 s[82:83], -1, 0
E v23,v121
M v[72:75],a[124:127],a[28:31],v[72:75]
s_cmp_eq_u32 s20, 2
buffer_load_dwordx4 v3, s[8:11], s26 offen offset:3072 sc1 lds
M v[72:75],a[120:123],a[24:27],v[72:75]
s_cselect_b64 s[66:67], s[16:17], s[82:83]
R a[88:91],v2,55296
R a[92:95],v2,56320
M v[72:75],a[116:119],a[20:23],v[72:75]
s_cselect_b64 s[68:69], s[18:19], s[82:83]
E v24,v122
M v[72:75],a[112:115],a[16:19],v[72:75]
s_cselect_b64 s[70:71], s[48:49], s[82:83]
E v25,v123
M v[72:75],a[108:111],a[12:15],v[72:75]
s_cselect_b64 s[72:73], s[50:51], s[82:83]
v_cndmask_b32 v80, v32, v8, s[66:67]
v_cndmask_b32 v81, v32, v8, s[68:69]
M v[72:75],a[104:107],a[8:11],v[72:75]
SA m0,s28,4096
E v18,v116
M v[72:75],a[100:103],a[4:7],v[72:75]
s_lshl_b32 s86, s20, 14
buffer_load_dwordx4 v4, s[8:11], s26 offen offset:0 sc1 lds
M v[72:75],a[96:99],a[0:3],v[72:75]
s_waitcnt lgkmcnt(0)
v_cndmask_b32 v82, v32, v8, s[70:71]
AF v28,v22,v28
M v[84:87],a[64:67],a[32:35],v[36:39]
SA s86,s86,s34
R a[96:99],v2,57344
R a[100:103],v2,58368
M v[84:87],a[68:71],a[36:39],v[84:87]
SA s87,s86,4096
buffer_load_dwordx4 v4, s[8:11], s26 offen offset:1024 sc1 lds
M v[84:87],a[72:75],a[40:43],v[84:87]
SA s88,s86,8192
v_cndmask_b32 v83, v32, v8, s[72:73]
C v58,v22,v23
M v[84:87],a[76:79],a[44:47],v[84:87]
s_cmp_lt_u32 s20, 3
R a[104:107],v2,59392
R a[108:111],v2,60416
M v[84:87],a[80:83],a[48:51],v[84:87]
s_cselect_b64 s[82:83], -1, 0
E v19,v117
M v[84:87],a[84:87],a[52:55],v[84:87]
SA s89,s86,12288
buffer_load_dwordx4 v4, s[8:11], s26 offen offset:2048 sc1 lds
M v[84:87],a[88:91],a[56:59],v[84:87]
s_lshl_b32 s90, s20, 10
R a[112:115],v2,61440
R a[116:119],v2,62464
M v[84:87],a[92:95],a[60:63],v[84:87]
SA s90,s90,s34
E v20,v118
M v[80:83],a[92:95],a[28:31],v[80:83]
SA s90,s90,65536
E v21,v119
M v[80:83],a[88:91],a[24:27],v[80:83]
s_cmp_eq_u32 s20, 3
R a[120:123],v2,63488
R a[124:127],v2,64512
M v[80:83],a[84:87],a[20:23],v[80:83]
s_cselect_b64 s[74:75], s[16:17], s[82:83]
buffer_load_dwordx4 v4, s[8:11], s26 offen offset:3072 sc1 lds
M v[80:83],a[80:83],a[16:19],v[80:83]
s_cselect_b64 s[76:77], s[18:19], s[82:83]
AF v28,v23,v28
AF v28,v24,v28
M v[80:83],a[76:79],a[12:15],v[80:83]
s_cselect_b64 s[78:79], s[48:49], s[82:83]
E v22,v124
M v[80:83],a[72:75],a[8:11],v[80:83]
s_cselect_b64 s[80:81], s[50:51], s[82:83]
v_cndmask_b32 v88, v32, v8, s[74:75]
v_cndmask_b32 v89, v32, v8, s[76:77]
M v[80:83],a[68:71],a[4:7],v[80:83]
s_waitcnt vmcnt(17) lgkmcnt(0)
v_cndmask_b32 v90, v32, v8, s[78:79]
v_cndmask_b32 v91, v32, v8, s[80:81]
M v[80:83],a[64:67],a[0:3],v[80:83]
s_barrier
M v[92:95],a[96:99],a[32:35],v[36:39]
SA s26,s26,32768
R a[64:67],v7,32768
R a[68:71],v7,33792
M v[92:95],a[100:103],a[36:39],v[92:95]
SA m0,s28,131072
E v23,v125
M v[92:95],a[104:107],a[40:43],v[92:95]
buffer_load_dwordx4 v3, s[8:11], s26 offen offset:0 sc1 lds
M v[92:95],a[108:111],a[44:47],v[92:95]
R a[72:75],v7,34816
R a[76:79],v7,35840
M v[92:95],a[112:115],a[48:51],v[92:95]
C v59,v24,v25
AF v28,v25,v28
M v[92:95],a[116:119],a[52:55],v[92:95]
buffer_load_dwordx4 v3, s[8:11], s26 offen offset:1024 sc1 lds
M v[92:95],a[120:123],a[56:59],v[92:95]
R a[80:83],v7,36864
R a[84:87],v7,37888
M v[92:95],a[124:127],a[60:63],v[92:95]
E v24,v126
M v[88:91],a[124:127],a[28:31],v[88:91]
buffer_load_dwordx4 v3, s[8:11], s26 offen offset:2048 sc1 lds
M v[88:91],a[120:123],a[24:27],v[88:91]
R a[88:91],v7,38912
R a[92:95],v7,39936
M v[88:91],a[116:119],a[20:23],v[88:91]
E v25,v127
M v[88:91],a[112:115],a[16:19],v[88:91]
buffer_load_dwordx4 v3, s[8:11], s26 offen offset:3072 sc1 lds
M v[88:91],a[108:111],a[12:15],v[88:91]
AF v29,v18,v29
C v60,v18,v19
M v[88:91],a[104:107],a[8:11],v[88:91]
AF v29,v19,v29
AF v29,v20,v29
M v[88:91],a[100:103],a[4:7],v[88:91]
s_waitcnt lgkmcnt(0)
C v61,v20,v21
AF v29,v21,v29
M v[88:91],a[96:99],a[0:3],v[88:91]
AF v29,v22,v29
C v62,v22,v23
AF v29,v23,v29
AF v29,v24,v29
C v63,v24,v25
AF v29,v25,v29
v_max_f32 v10, v28, v29
v_cmp_lt_f32 vcc, s31, v10
s_nop 0
s_cbranch_vccnz L_std1
L_rtd1:
s_cmp_lt_u32 s42, 6
s_cbranch_scc1 L_d2h
M v[128:131],a[64:67],v[48:51],v[128:131]
R a[96:99],v7,40960
R a[100:103],v7,41984
M v[128:131],a[68:71],v[56:59],v[128:131]
SA m0,s28,135168
E v18,v64
M v[132:135],a[68:71],v[60:63],v[132:135]
buffer_load_dwordx4 v4, s[8:11], s26 offen offset:0 sc1 lds
M v[132:135],a[64:67],v[52:55],v[132:135]
R a[104:107],v7,43008
R a[108:111],v7,44032
M v[136:139],a[72:75],v[48:51],v[136:139]
s_cmp_gt_u32 s20, 3
E v19,v65
M v[136:139],a[76:79],v[56:59],v[136:139]
s_cselect_b64 s[82:83], -1, 0
AF v30,v28,v30
AF v31,v29,v31
M v[140:143],a[76:79],v[60:63],v[140:143]
s_cmp_eq_u32 s20, 3
R a[112:115],v7,45056
R a[116:119],v7,46080
M v[140:143],a[72:75],v[52:55],v[140:143]
s_cselect_b64 s[66:67], s[16:17], s[82:83]
buffer_load_dwordx4 v4, s[8:11], s26 offen offset:1024 sc1 lds
M v[144:147],a[80:83],v[48:51],v[144:147]
s_cselect_b64 s[68:69], s[18:19], s[82:83]
E v20,v66
M v[144:147],a[84:87],v[56:59],v[144:147]
s_cselect_b64 s[70:71], s[48:49], s[82:83]
R a[120:123],v7,47104
R a[124:127],v7,48128
M v[148:151],a[84:87],v[60:63],v[148:151]
s_cselect_b64 s[72:73], s[50:51], s[82:83]
v_cndmask_b32 v100, v36, v8, s[66:67]
v_cndmask_b32 v101, v36, v8, s[68:69]
M v[148:151],a[80:83],v[52:55],v[148:151]
buffer_load_dwordx4 v4, s[8:11], s26 offen offset:2048 sc1 lds
M v[152:155],a[88:91],v[48:51],v[152:155]
v_cndmask_b32 v102, v36, v8, s[70:71]
AF v26,v18,v19
M v[152:155],a[92:95],v[56:59],v[152:155]
E v21,v67
M v[156:159],a[92:95],v[60:63],v[156:159]
v_cndmask_b32 v103, v36, v8, s[72:73]
C v40,v18,v19
M v[156:159],a[88:91],v[52:55],v[156:159]
s_waitcnt lgkmcnt(0)
buffer_load_dwordx4 v4, s[8:11], s26 offen offset:3072 sc1 lds
M v[160:163],a[96:99],v[48:51],v[160:163]
s_cmp_gt_u32 s20, 2
R a[64:67],v7,49152
R a[68:71],v7,50176
M v[160:163],a[100:103],v[56:59],v[160:163]
s_cselect_b64 s[82:83], -1, 0
v_lshrrev_b32 v14, 7, v7
AF v26,v20,v26
M v[164:167],a[100:103],v[60:63],v[164:167]
s_cmp_eq_u32 s20, 2
v_mul_u32_u24 v14, 896, v14
C v41,v20,v21
M v[164:167],a[96:99],v[52:55],v[164:167]
s_cselect_b64 s[74:75], s[16:17], s[82:83]
R a[72:75],v7,51200
R a[76:79],v7,52224
M v[168:171],a[104:107],v[48:51],v[168:171]
s_cselect_b64 s[76:77], s[18:19], s[82:83]
v_lshrrev_b32 v15, 8, v7
AF v26,v21,v26
M v[168:171],a[108:111],v[56:59],v[168:171]
s_cselect_b64 s[78:79], s[48:49], s[82:83]
v_lshlrev_b32 v15, 5, v15
M v[172:175],a[108:111],v[60:63],v[172:175]
s_cselect_b64 s[80:81], s[50:51], s[82:83]
R a[80:83],v7,53248
R a[84:87],v7,54272
M v[172:175],a[104:107],v[52:55],v[172:175]
v_cndmask_b32 v108, v36, v8, s[74:75]
v_cndmask_b32 v109, v36, v8, s[76:77]
M v[176:179],a[112:115],v[48:51],v[176:179]
v_xor_b32 v15, v15, v7
M v[176:179],a[116:119],v[56:59],v[176:179]
R a[88:91],v7,55296
R a[92:95],v7,56320
M v[180:183],a[116:119],v[60:63],v[180:183]
v_and_b32 v15, 0x70, v15
v_cndmask_b32 v110, v36, v8, s[78:79]
M v[180:183],a[112:115],v[52:55],v[180:183]
v_add_u32 v0, v14, v15
M v[184:187],a[120:123],v[48:51],v[184:187]
s_mul_i32 s38, s20, 57344
v_cndmask_b32 v111, v36, v8, s[80:81]
M v[184:187],a[124:127],v[56:59],v[184:187]
s_cmp_gt_u32 s20, 1
E v22,v72
M v[188:191],a[124:127],v[60:63],v[188:191]
s_cselect_b64 s[82:83], -1, 0
E v23,v73
M v[188:191],a[120:123],v[52:55],v[188:191]
s_waitcnt lgkmcnt(0)
E v24,v74
M v[192:195],a[64:67],v[48:51],v[192:195]
SA m0,s28,98304
R a[96:99],v7,57344
R a[100:103],v7,58368
M v[192:195],a[68:71],v[56:59],v[192:195]
s_cmp_eq_u32 s20, 1
E v25,v75
M v[196:199],a[68:71],v[60:63],v[196:199]
s_cselect_b64 s[66:67], s[16:17], s[82:83]
E v18,v68
M v[196:199],a[64:67],v[52:55],v[196:199]
s_cselect_b64 s[68:69], s[18:19], s[82:83]
R a[104:107],v7,59392
R a[108:111],v7,60416
M v[200:203],a[72:75],v[48:51],v[200:203]
s_cselect_b64 s[70:71], s[48:49], s[82:83]
E v19,v69
M v[200:203],a[76:79],v[56:59],v[200:203]
s_cselect_b64 s[72:73], s[50:51], s[82:83]
v_cndmask_b32 v116, v36, v8, s[66:67]
v_cndmask_b32 v117, v36, v8, s[68:69]
M v[204:207],a[76:79],v[60:63],v[204:207]
SA s85,s38,0
R a[112:115],v7,61440
R a[116:119],v7,62464
M v[204:207],a[72:75],v[52:55],v[204:207]
buffer_load_dwordx4 v0, s[12:15], s85 offen offset:0 lds
M v[208:211],a[80:83],v[48:51],v[208:211]
SA s85,s38,6144
v_cndmask_b32 v118, v36, v8, s[70:71]
AF v26,v22,v26
M v[208:211],a[84:87],v[56:59],v[208:211]
R a[120:123],v7,63488
R a[124:127],v7,64512
M v[212:215],a[84:87],v[60:63],v[212:215]
buffer_load_dwordx4 v0, s[12:15], s85 offen offset:1024 lds
M v[212:215],a[80:83],v[52:55],v[212:215]
SA s85,s38,12288
v_cndmask_b32 v119, v36, v8, s[72:73]
C v42,v22,v23
M v[216:219],a[88:91],v[48:51],v[216:219]
s_cmp_gt_u32 s20, 0
E v20,v70
M v[216:219],a[92:95],v[56:59],v[216:219]
s_cselect_b64 s[82:83], -1, 0
buffer_load_dwordx4 v0, s[12:15], s85 offen offset:2048 lds
M v[220:223],a[92:95],v[60:63],v[220:223]
s_waitcnt vmcnt(20) lgkmcnt(0)
E v21,v71
M v[220:223],a[88:91],v[52:55],v[220:223]
s_barrier
M v[224:227],a[96:99],v[48:51],v[224:227]
SA s85,s38,18432
R a[64:67],v2,0
R a[68:71],v2,1024
M v[224:227],a[100:103],v[56:59],v[224:227]
s_cmp_eq_u32 s20, 0
buffer_load_dwordx4 v0, s[12:15], s85 offen offset:3072 lds
M v[228:231],a[100:103],v[60:63],v[228:231]
s_cselect_b64 s[74:75], s[16:17], s[82:83]
AF v26,v23,v26
AF v26,v24,v26
M v[228:231],a[96:99],v[52:55],v[228:231]
s_cselect_b64 s[76:77], s[18:19], s[82:83]
R a[72:75],v2,2048
R a[76:79],v2,3072
M v[232:235],a[104:107],v[48:51],v[232:235]
s_cselect_b64 s[78:79], s[48:49], s[82:83]
E v22,v76
M v[232:235],a[108:111],v[56:59],v[232:235]
s_cselect_b64 s[80:81], s[50:51], s[82:83]
v_cndmask_b32 v124, v36, v8, s[74:75]
v_cndmask_b32 v125, v36, v8, s[76:77]
M v[236:239],a[108:111],v[60:63],v[236:239]
SA m0,s28,102400
R a[80:83],v2,4096
R a[84:87],v2,5120
M v[236:239],a[104:107],v[52:55],v[236:239]
SA s85,s38,28672
buffer_load_dwordx4 v0, s[12:15], s85 offen offset:0 lds
M v[240:243],a[112:115],v[48:51],v[240:243]
SA s85,s38,34816
v_cndmask_b32 v126, v36, v8, s[78:79]
v_cndmask_b32 v127, v36, v8, s[80:81]
M v[240:243],a[116:119],v[56:59],v[240:243]
R a[88:91],v2,6144
R a[92:95],v2,7168
M v[244:247],a[116:119],v[60:63],v[244:247]
buffer_load_dwordx4 v0, s[12:15], s85 offen offset:1024 lds
M v[244:247],a[112:115],v[52:55],v[244:247]
SA s85,s38,40960
E v23,v77
M v[248:251],a[120:123],v[48:51],v[248:251]
buffer_load_dwordx4 v0, s[12:15], s85 offen offset:2048 lds
M v[248:251],a[124:127],v[56:59],v[248:251]
SA s85,s38,47104
C v43,v24,v25
AF v26,v25,v26
M v[252:255],a[124:127],v[60:63],v[252:255]
s_waitcnt lgkmcnt(0)
E v24,v78
M v[252:255],a[120:123],v[52:55],v[252:255]
buffer_load_dwordx4 v0, s[12:15], s85 offen offset:3072 lds
SA s38,s38,128
AF v27,v18,v19
C v44,v18,v19
AF v27,v20,v27
C v45,v20,v21
AF v27,v21,v27
E v25,v79
AF v27,v22,v27
C v46,v22,v23
AF v27,v23,v27
AF v27,v24,v27
C v47,v24,v25
AF v27,v25,v27
M v[100:103],a[64:67],a[32:35],v[100:103]
R a[96:99],v2,8192
R a[100:103],v2,9216
M v[100:103],a[68:71],a[36:39],v[100:103]
R a[104:107],v2,10240
R a[108:111],v2,11264
M v[100:103],a[72:75],a[40:43],v[100:103]
R a[112:115],v2,12288
R a[116:119],v2,13312
M v[100:103],a[76:79],a[44:47],v[100:103]
R a[120:123],v2,14336
R a[124:127],v2,15360
M v[100:103],a[80:83],a[48:51],v[100:103]
v_add_u32 v8, 0x20000, v7
M v[100:103],a[84:87],a[52:55],v[100:103]
SA m0,s28,32768
E v18,v80
M v[100:103],a[88:91],a[56:59],v[100:103]
SA s85,s38,0
buffer_load_dwordx4 v0, s[12:15], s85 offen offset:0 lds
M v[100:103],a[92:95],a[60:63],v[100:103]
s_waitcnt lgkmcnt(0)
E v19,v81
M v[108:111],a[96:99],a[32:35],v[108:111]
SA s85,s38,6144
R a[64:67],v2,16384
R a[68:71],v2,17408
M v[108:111],a[100:103],a[36:39],v[108:111]
R a[72:75],v2,18432
R a[76:79],v2,19456
M v[108:111],a[104:107],a[40:43],v[108:111]
R a[80:83],v2,20480
R a[84:87],v2,21504
M v[108:111],a[108:111],a[44:47],v[108:111]
R a[88:91],v2,22528
R a[92:95],v2,23552
M v[108:111],a[112:115],a[48:51],v[108:111]
buffer_load_dwordx4 v0, s[12:15], s85 offen offset:1024 lds
M v[108:111],a[116:119],a[52:55],v[108:111]
SA s85,s38,12288
E v20,v82
M v[108:111],a[120:123],a[56:59],v[108:111]
buffer_load_dwordx4 v0, s[12:15], s85 offen offset:2048 lds
M v[108:111],a[124:127],a[60:63],v[108:111]
s_waitcnt lgkmcnt(0)
E v21,v83
M v[116:119],a[64:67],a[32:35],v[116:119]
SA s85,s38,18432
R a[96:99],v2,24576
R a[100:103],v2,25600
M v[116:119],a[68:71],a[36:39],v[116:119]
R a[104:107],v2,26624
R a[108:111],v2,27648
M v[116:119],a[72:75],a[40:43],v[116:119]
R a[112:115],v2,28672
R a[116:119],v2,29696
M v[116:119],a[76:79],a[44:47],v[116:119]
R a[120:123],v2,30720
R a[124:127],v2,31744
M v[116:119],a[80:83],a[48:51],v[116:119]
buffer_load_dwordx4 v0, s[12:15], s85 offen offset:3072 lds
M v[116:119],a[84:87],a[52:55],v[116:119]
buffer_load_dword v6, off, s[8:11], s47 sc1
M v[116:119],a[88:91],a[56:59],v[116:119]
s_waitcnt vmcnt(21) lgkmcnt(0)
E v22,v88
M v[116:119],a[92:95],a[60:63],v[116:119]
s_barrier
M v[124:127],a[96:99],a[32:35],v[124:127]
R a[64:67],v7,0
R a[68:71],v7,1024
M v[124:127],a[100:103],a[36:39],v[124:127]
R a[72:75],v7,2048
R a[76:79],v7,3072
M v[124:127],a[104:107],a[40:43],v[124:127]
R a[80:83],v7,4096
R a[84:87],v7,5120
M v[124:127],a[108:111],a[44:47],v[124:127]
R a[88:91],v7,6144
R a[92:95],v7,7168
M v[124:127],a[112:115],a[48:51],v[124:127]
E v23,v89
M v[124:127],a[116:119],a[52:55],v[124:127]
E v24,v90
M v[124:127],a[120:123],a[56:59],v[124:127]
s_waitcnt lgkmcnt(0)
E v25,v91
M v[124:127],a[124:127],a[60:63],v[124:127]
AF v26,v18,v26
C v56,v18,v19
AF v26,v19,v26
AF v26,v20,v26
C v57,v20,v21
AF v26,v21,v26
AF v26,v22,v26
C v58,v22,v23
AF v26,v23,v26
E v18,v84
E v19,v85
AF v26,v24,v26
C v59,v24,v25
AF v26,v25,v26
E v20,v86
E v21,v87
AF v27,v18,v27
C v60,v18,v19
AF v27,v19,v27
E v22,v92
E v23,v93
AF v27,v20,v27
C v61,v20,v21
AF v27,v21,v27
E v24,v94
E v25,v95
AF v27,v22,v27
C v62,v22,v23
AF v27,v23,v27
AF v27,v24,v27
C v63,v24,v25
AF v27,v25,v27
v_max_f32 v10, v26, v27
v_cmp_lt_f32 vcc, s31, v10
s_nop 0
s_cbranch_vccnz L_std3n
L_rtd3n:
M v[128:131],a[64:67],v[40:43],v[128:131]
R a[96:99],v7,8192
R a[100:103],v7,9216
M v[128:131],a[68:71],v[56:59],v[128:131]
v_or_b32 v9, s35, v7
s_waitcnt vmcnt(0)
v_cmp_ne_u32 vcc, 1, v6
M v[132:135],a[68:71],v[60:63],v[132:135]
s_cbranch_vccnz L_fps
L_fpr:
E v18,v100
M v[132:135],a[64:67],v[44:47],v[132:135]
R a[104:107],v7,10240
R a[108:111],v7,11264
M v[136:139],a[72:75],v[40:43],v[136:139]
buffer_load_dwordx4 v[14:17], v9, s[8:11], s90 offen sc1
M v[136:139],a[76:79],v[56:59],v[136:139]
E v19,v101
M v[140:143],a[76:79],v[60:63],v[140:143]
R a[112:115],v7,12288
R a[116:119],v7,13312
M v[140:143],a[72:75],v[44:47],v[140:143]
buffer_load_dwordx4 a[160:163], v9, s[8:11], s88 offen offset:0 sc1
M v[144:147],a[80:83],v[40:43],v[144:147]
E v20,v102
M v[144:147],a[84:87],v[56:59],v[144:147]
R a[120:123],v7,14336
R a[124:127],v7,15360
M v[148:151],a[84:87],v[60:63],v[148:151]
buffer_load_dwordx4 a[128:131], v9, s[8:11], s86 offen offset:0 sc1
M v[148:151],a[80:83],v[44:47],v[148:151]
E v21,v103
M v[152:155],a[88:91],v[40:43],v[152:155]
AF v30,v26,v30
AF v31,v27,v31
M v[152:155],a[92:95],v[56:59],v[152:155]
buffer_load_dwordx4 a[164:167], v9, s[8:11], s88 offen offset:1024 sc1
M v[156:159],a[92:95],v[60:63],v[156:159]
AF v29,v18,v19
C v52,v18,v19
M v[156:159],a[88:91],v[44:47],v[156:159]
s_waitcnt lgkmcnt(0)
E v22,v108
M v[160:163],a[96:99],v[40:43],v[160:163]
R a[64:67],v7,16384
R a[68:71],v7,17408
M v[160:163],a[100:103],v[56:59],v[160:163]
buffer_load_dwordx4 a[132:135], v9, s[8:11], s86 offen offset:1024 sc1
M v[164:167],a[100:103],v[60:63],v[164:167]
E v23,v109
M v[164:167],a[96:99],v[44:47],v[164:167]
R a[72:75],v7,18432
R a[76:79],v7,19456
M v[168:171],a[104:107],v[40:43],v[168:171]
buffer_load_dwordx4 a[168:171], v9, s[8:11], s88 offen offset:2048 sc1
M v[168:171],a[108:111],v[56:59],v[168:171]
AF v29,v20,v29
C v53,v20,v21
M v[172:175],a[108:111],v[60:63],v[172:175]
R a[80:83],v7,20480
R a[84:87],v7,21504
M v[172:175],a[104:107],v[44:47],v[172:175]
buffer_load_dwordx4 a[136:139], v9, s[8:11], s86 offen offset:2048 sc1
M v[176:179],a[112:115],v[40:43],v[176:179]
E v24,v110
M v[176:179],a[116:119],v[56:59],v[176:179]
R a[88:91],v7,22528
R a[92:95],v7,23552
M v[180:183],a[116:119],v[60:63],v[180:183]
buffer_load_dwordx4 a[172:175], v9, s[8:11], s88 offen offset:3072 sc1
M v[180:183],a[112:115],v[44:47],v[180:183]
E v25,v111
M v[184:187],a[120:123],v[40:43],v[184:187]
AF v29,v21,v29
AF v29,v22,v29
M v[184:187],a[124:127],v[56:59],v[184:187]
buffer_load_dwordx4 a[140:143], v9, s[8:11], s86 offen offset:3072 sc1
M v[188:191],a[124:127],v[60:63],v[188:191]
E v18,v116
M v[188:191],a[120:123],v[44:47],v[188:191]
s_waitcnt lgkmcnt(0)
C v54,v22,v23
AF v29,v23,v29
M v[192:195],a[64:67],v[40:43],v[192:195]
R a[96:99],v7,24576
R a[100:103],v7,25600
M v[192:195],a[68:71],v[56:59],v[192:195]
buffer_load_dwordx4 a[176:179], v9, s[8:11], s89 offen offset:0 sc1
M v[196:199],a[68:71],v[60:63],v[196:199]
E v19,v117
M v[196:199],a[64:67],v[44:47],v[196:199]
R a[104:107],v7,26624
R a[108:111],v7,27648
M v[200:203],a[72:75],v[40:43],v[200:203]
buffer_load_dwordx4 a[144:147], v9, s[8:11], s87 offen offset:0 sc1
M v[200:203],a[76:79],v[56:59],v[200:203]
E v20,v118
M v[204:207],a[76:79],v[60:63],v[204:207]
R a[112:115],v7,28672
R a[116:119],v7,29696
M v[204:207],a[72:75],v[44:47],v[204:207]
buffer_load_dwordx4 a[180:183], v9, s[8:11], s89 offen offset:1024 sc1
M v[208:211],a[80:83],v[40:43],v[208:211]
AF v29,v24,v29
C v55,v24,v25
M v[208:211],a[84:87],v[56:59],v[208:211]
R a[120:123],v7,30720
R a[124:127],v7,31744
M v[212:215],a[84:87],v[60:63],v[212:215]
buffer_load_dwordx4 a[148:151], v9, s[8:11], s87 offen offset:1024 sc1
M v[212:215],a[80:83],v[44:47],v[212:215]
E v21,v119
M v[216:219],a[88:91],v[40:43],v[216:219]
AF v29,v25,v29
AF v29,v18,v29
M v[216:219],a[92:95],v[56:59],v[216:219]
buffer_load_dwordx4 a[184:187], v9, s[8:11], s89 offen offset:2048 sc1
M v[220:223],a[92:95],v[60:63],v[220:223]
s_waitcnt lgkmcnt(0)
E v22,v124
M v[220:223],a[88:91],v[44:47],v[220:223]
s_barrier
M v[224:227],a[96:99],v[40:43],v[224:227]
R a[64:67],v8,0
R a[68:71],v8,1024
M v[224:227],a[100:103],v[56:59],v[224:227]
buffer_load_dwordx4 a[152:155], v9, s[8:11], s87 offen offset:2048 sc1
M v[228:231],a[100:103],v[60:63],v[228:231]
E v23,v125
M v[228:231],a[96:99],v[44:47],v[228:231]
R a[72:75],v8,2048
R a[76:79],v8,3072
M v[232:235],a[104:107],v[40:43],v[232:235]
buffer_load_dwordx4 a[188:191], v9, s[8:11], s89 offen offset:3072 sc1
M v[232:235],a[108:111],v[56:59],v[232:235]
E v24,v126
M v[236:239],a[108:111],v[60:63],v[236:239]
R a[80:83],v8,4096
R a[84:87],v8,5120
M v[236:239],a[104:107],v[44:47],v[236:239]
buffer_load_dwordx4 a[156:159], v9, s[8:11], s87 offen offset:3072 sc1
M v[240:243],a[112:115],v[40:43],v[240:243]
E v25,v127
M v[240:243],a[116:119],v[56:59],v[240:243]
R a[88:91],v8,6144
R a[92:95],v8,7168
M v[244:247],a[116:119],v[60:63],v[244:247]
C v48,v18,v19
AF v29,v19,v29
M v[244:247],a[112:115],v[44:47],v[244:247]
AF v29,v20,v29
C v49,v20,v21
M v[248:251],a[120:123],v[40:43],v[248:251]
AF v29,v21,v29
AF v29,v22,v29
M v[248:251],a[124:127],v[56:59],v[248:251]
C v50,v22,v23
AF v29,v23,v29
M v[252:255],a[124:127],v[60:63],v[252:255]
s_waitcnt lgkmcnt(0)
AF v29,v24,v29
C v51,v24,v25
M v[252:255],a[120:123],v[44:47],v[252:255]
AF v29,v25,v29
v_cmp_lt_f32 vcc, s31, v29
s_nop 0
s_cbranch_vccnz L_std4n
L_rtd4n:
s_waitcnt vmcnt(16)
v_cmp_neq_f32 vcc, v32, v14
v_cmp_neq_f32 s[64:65], v36, v15
s_cmp_eq_u32 s35, 0
s_cselect_b64 s[66:67], -1, 0
s_or_b64 vcc, vcc, s[64:65]
s_and_b64 vcc, vcc, s[66:67]
s_cbranch_vccnz L_stc
L_rtc:
M v[132:135],a[64:67],v[52:55],v[132:135]
R a[96:99],v8,8192
R a[100:103],v8,9216
M v[132:135],a[68:71],v[48:51],v[132:135]
s_waitcnt vmcnt(12)
AF v30,v16,v30
AF v31,v17,v31
M v[132:135],a[246:249],a[160:163],v[132:135]
SA m0,s28,36864
AF v31,v29,v31
v_mov_b32 v10, v30
M v[128:131],a[246:249],a[128:131],v[128:131]
SA s85,s38,28672
R a[104:107],v8,10240
R a[108:111],v8,11264
M v[140:143],a[72:75],v[52:55],v[140:143]
buffer_load_dwordx4 v0, s[12:15], s85 offen offset:0 lds
M v[140:143],a[76:79],v[48:51],v[140:143]
SA s85,s38,34816
v_mov_b32 v11, v31
M v[140:143],a[244:247],a[160:163],v[140:143]
R a[112:115],v8,12288
R a[116:119],v8,13312
M v[136:139],a[244:247],a[128:131],v[136:139]
v_permlane16_swap_b32 v10, v30
M v[148:151],a[80:83],v[52:55],v[148:151]
v_permlane16_swap_b32 v11, v31
M v[148:151],a[84:87],v[48:51],v[148:151]
R a[120:123],v8,14336
R a[124:127],v8,15360
M v[148:151],a[246:249],a[164:167],v[148:151]
buffer_load_dwordx4 v0, s[12:15], s85 offen offset:1024 lds
M v[144:147],a[246:249],a[132:135],v[144:147]
SA s85,s38,40960
AF v30,v10,v30
AF v31,v11,v31
M v[156:159],a[88:91],v[52:55],v[156:159]
v_mov_b32 v10, v30
v_mov_b32 v11, v31
M v[156:159],a[92:95],v[48:51],v[156:159]
buffer_load_dwordx4 v0, s[12:15], s85 offen offset:2048 lds
M v[156:159],a[244:247],a[164:167],v[156:159]
s_waitcnt vmcnt(11)
v_permlane32_swap_b32 v10, v30
M v[152:155],a[244:247],a[132:135],v[152:155]
s_waitcnt lgkmcnt(0)
v_permlane32_swap_b32 v11, v31
M v[164:167],a[96:99],v[52:55],v[164:167]
SA s85,s38,47104
R a[64:67],v8,16384
R a[68:71],v8,17408
M v[164:167],a[100:103],v[48:51],v[164:167]
buffer_load_dwordx4 v0, s[12:15], s85 offen offset:3072 lds
M v[164:167],a[246:249],a[168:171],v[164:167]
SA s38,s38,128
C v132,v132,v133
C v133,v134,v135
M v[160:163],a[246:249],a[136:139],v[160:163]
SA m0,s28,65536
R a[72:75],v8,18432
R a[76:79],v8,19456
AF v30,v10,v30
AF v31,v11,v31
v_rcp_f32 v5, v30
v_rcp_f32 v6, v31
M v[172:175],a[104:107],v[52:55],v[172:175]
SA s85,s38,0
buffer_load_dwordx4 v0, s[12:15], s85 offen offset:0 lds
M v[172:175],a[108:111],v[48:51],v[172:175]
SA s85,s38,6144
C v134,v140,v141
C v135,v142,v143
M v[172:175],a[244:247],a[168:171],v[172:175]
R a[80:83],v8,20480
R a[84:87],v8,21504
M v[168:171],a[244:247],a[136:139],v[168:171]
buffer_load_dwordx4 v0, s[12:15], s85 offen offset:1024 lds
M v[180:183],a[112:115],v[52:55],v[180:183]
SA s85,s38,12288
C v128,v128,v129
C v129,v130,v131
M v[180:183],a[116:119],v[48:51],v[180:183]
R a[88:91],v8,22528
R a[92:95],v8,23552
M v[180:183],a[246:249],a[172:175],v[180:183]
buffer_load_dwordx4 v0, s[12:15], s85 offen offset:2048 lds
M v[176:179],a[246:249],a[140:143],v[176:179]
SA s85,s38,18432
C v130,v136,v137
C v131,v138,v139
M v[188:191],a[120:123],v[52:55],v[188:191]
C v148,v148,v149
C v149,v150,v151
M v[188:191],a[124:127],v[48:51],v[188:191]
buffer_load_dwordx4 v0, s[12:15], s85 offen offset:3072 lds
M v[188:191],a[244:247],a[172:175],v[188:191]
s_waitcnt vmcnt(12)
C v150,v156,v157
C v151,v158,v159
M v[184:187],a[244:247],a[140:143],v[184:187]
s_waitcnt lgkmcnt(0)
C v144,v144,v145
C v145,v146,v147
M v[196:199],a[64:67],v[52:55],v[196:199]
SA m0,s28,69632
R a[96:99],v8,24576
R a[100:103],v8,25600
M v[196:199],a[68:71],v[48:51],v[196:199]
SA s85,s38,28672
buffer_load_dwordx4 v0, s[12:15], s85 offen offset:0 lds
M v[196:199],a[246:249],a[176:179],v[196:199]
SA s85,s38,34816
C v146,v152,v153
C v147,v154,v155
M v[192:195],a[246:249],a[144:147],v[192:195]
R a[104:107],v8,26624
R a[108:111],v8,27648
M v[204:207],a[72:75],v[52:55],v[204:207]
buffer_load_dwordx4 v0, s[12:15], s85 offen offset:1024 lds
M v[204:207],a[76:79],v[48:51],v[204:207]
SA s85,s38,40960
v_lshrrev_b32 v16, 4, v7
v_lshrrev_b32 v14, 2, v16
M v[204:207],a[244:247],a[176:179],v[204:207]
R a[112:115],v8,28672
R a[116:119],v8,29696
M v[200:203],a[244:247],a[144:147],v[200:203]
buffer_load_dwordx4 v0, s[12:15], s85 offen offset:2048 lds
M v[212:215],a[80:83],v[52:55],v[212:215]
SA s85,s38,47104
v_lshlrev_b32 v14, 7, v14
v_and_b32 v15, 3, v16
M v[212:215],a[84:87],v[48:51],v[212:215]
R a[120:123],v8,30720
R a[124:127],v8,31744
M v[212:215],a[246:249],a[180:183],v[212:215]
buffer_load_dwordx4 v0, s[12:15], s85 offen offset:3072 lds
M v[208:211],a[246:249],a[148:151],v[208:211]
SA s38,s38,128
v_lshl_add_u32 v14, v15, 3, v14
C v164,v164,v165
M v[220:223],a[88:91],v[52:55],v[220:223]
C v165,v166,v167
C v166,v172,v173
M v[220:223],a[92:95],v[48:51],v[220:223]
s_waitcnt vmcnt(12)
C v167,v174,v175
C v160,v160,v161
M v[220:223],a[244:247],a[180:183],v[220:223]
s_waitcnt lgkmcnt(0)
v_bfe_u32 v15, v16, 3, 2
v_lshl_add_u32 v18, v15, 5, v14
v_xor_b32 v19, 32, v18
v_xor_b32 v20, 64, v18
v_xor_b32 v21, 0x60, v18
v_add_u32 v22, 0x10000, v18
v_add_u32 v23, 0x10000, v19
v_add_u32 v24, 0x10000, v20
v_add_u32 v25, 0x10000, v21
M v[216:219],a[244:247],a[148:151],v[216:219]
s_barrier
M v[228:231],a[96:99],v[52:55],v[228:231]
s_nop 0
T a[64:65],v22,32768
T a[66:67],v22,34816
M v[228:231],a[100:103],v[48:51],v[228:231]
T a[68:69],v22,36864
T a[70:71],v22,38912
M v[228:231],a[246:249],a[184:187],v[228:231]
C v161,v162,v163
C v162,v168,v169
M v[224:227],a[246:249],a[152:155],v[224:227]
T a[72:73],v22,40960
T a[74:75],v22,43008
M v[236:239],a[104:107],v[52:55],v[236:239]
T a[76:77],v22,45056
T a[78:79],v22,47104
M v[236:239],a[108:111],v[48:51],v[236:239]
C v163,v170,v171
C v180,v180,v181
M v[236:239],a[244:247],a[184:187],v[236:239]
T a[80:81],v22,49152
T a[82:83],v22,51200
M v[232:235],a[244:247],a[152:155],v[232:235]
T a[84:85],v22,53248
T a[86:87],v22,55296
M v[244:247],a[112:115],v[52:55],v[244:247]
C v181,v182,v183
C v182,v188,v189
M v[244:247],a[116:119],v[48:51],v[244:247]
T a[88:89],v22,57344
T a[90:91],v22,59392
M v[244:247],a[246:249],a[188:191],v[244:247]
T a[92:93],v22,61440
T a[94:95],v22,63488
M v[240:243],a[246:249],a[156:159],v[240:243]
C v183,v190,v191
C v176,v176,v177
M v[252:255],a[120:123],v[52:55],v[252:255]
C v177,v178,v179
C v178,v184,v185
M v[252:255],a[124:127],v[48:51],v[252:255]
C v179,v186,v187
C v196,v196,v197
M v[252:255],a[244:247],a[188:191],v[252:255]
s_waitcnt lgkmcnt(0)
C v197,v198,v199
C v198,v204,v205
M v[248:251],a[244:247],a[156:159],v[248:251]
C v199,v206,v207
C v192,v192,v193
C v193,v194,v195
C v194,v200,v201
C v195,v202,v203
C v212,v212,v213
C v213,v214,v215
C v214,v220,v221
C v215,v222,v223
C v208,v208,v209
C v209,v210,v211
C v210,v216,v217
C v211,v218,v219
C v228,v228,v229
C v229,v230,v231
C v230,v236,v237
C v231,v238,v239
C v224,v224,v225
C v225,v226,v227
C v226,v232,v233
C v227,v234,v235
C v244,v244,v245
C v245,v246,v247
C v246,v252,v253
C v247,v254,v255
C v240,v240,v241
C v241,v242,v243
C v242,v248,v249
C v243,v250,v251
M v[64:67],a[64:67],v[128:131],0
s_sub_u32 s64, 15, s42
T a[96:97],v23,32768
T a[98:99],v23,34816
M v[64:67],a[68:71],v[144:147],v[64:67]
s_min_u32 s64, s64, s42
T a[100:101],v23,36864
T a[102:103],v23,38912
M v[64:67],a[72:75],v[160:163],v[64:67]
s_mul_i32 s45, s64, 8704
M v[64:67],a[76:79],v[176:179],v[64:67]
s_lshl_b32 s64, s41, 2
T a[104:105],v23,40960
T a[106:107],v23,43008
M v[64:67],a[80:83],v[192:195],v[64:67]
SA s45,s45,s64
T a[108:109],v23,45056
T a[110:111],v23,47104
M v[64:67],a[84:87],v[208:211],v[64:67]
s_lshl_b32 s64, s20, 8
M v[64:67],a[88:91],v[224:227],v[64:67]
SA s45,s45,s64
T a[112:113],v23,49152
T a[114:115],v23,51200
M v[64:67],a[92:95],v[240:243],v[64:67]
SA s45,s45,104992768
T a[116:117],v23,53248
T a[118:119],v23,55296
M v[68:71],a[92:95],v[244:247],0
s_mov_b32 s64, 1024
M v[68:71],a[88:91],v[228:231],v[68:71]
s_mov_b32 s66, 4096
T a[120:121],v23,57344
T a[122:123],v23,59392
M v[68:71],a[84:87],v[212:215],v[68:71]
s_cmp_lt_u32 s42, 8
T a[124:125],v23,61440
T a[126:127],v23,63488
M v[68:71],a[80:83],v[196:199],v[68:71]
s_cselect_b32 s64, 4352, s64
M v[68:71],a[76:79],v[180:183],v[68:71]
s_cselect_b32 s65, 0, 64
M v[68:71],a[72:75],v[164:167],v[68:71]
s_cselect_b32 s66, 536870912, s66
M v[68:71],a[68:71],v[148:151],v[68:71]
SA s3,s45,s64
M v[68:71],a[64:67],v[132:135],v[68:71]
s_waitcnt lgkmcnt(0)
M v[72:75],a[96:99],v[128:131],0
SA s45,s45,s65
T a[64:65],v24,32768
T a[66:67],v24,34816
M v[72:75],a[100:103],v[144:147],v[72:75]
SA m0,s28,0
T a[68:69],v24,36864
T a[70:71],v24,38912
M v[72:75],a[104:107],v[160:163],v[72:75]
SA s85,s38,0
buffer_load_dwordx4 v0, s[12:15], s85 offen offset:0 lds
M v[72:75],a[108:111],v[176:179],v[72:75]
SA s85,s38,6144
T a[72:73],v24,40960
T a[74:75],v24,43008
M v[72:75],a[112:115],v[192:195],v[72:75]
SA s29,s33,0
T a[76:77],v24,45056
T a[78:79],v24,47104
M v[72:75],a[116:119],v[208:211],v[72:75]
SA s30,s33,14336
buffer_load_dwordx4 v0, s[12:15], s85 offen offset:1024 lds
M v[72:75],a[120:123],v[224:227],v[72:75]
SA s85,s38,12288
T a[80:81],v24,49152
T a[82:83],v24,51200
M v[72:75],a[124:127],v[240:243],v[72:75]
T a[84:85],v24,53248
T a[86:87],v24,55296
M v[76:79],a[124:127],v[244:247],0
buffer_load_dwordx4 v0, s[12:15], s85 offen offset:2048 lds
M v[76:79],a[120:123],v[228:231],v[76:79]
SA s85,s38,18432
T a[88:89],v24,57344
T a[90:91],v24,59392
M v[76:79],a[116:119],v[212:215],v[76:79]
T a[92:93],v24,61440
T a[94:95],v24,63488
M v[76:79],a[112:115],v[196:199],v[76:79]
buffer_load_dwordx4 v0, s[12:15], s85 offen offset:3072 lds
M v[76:79],a[108:111],v[180:183],v[76:79]
SA m0,s28,4096
v_lshrrev_b32 v17, 5, v7
v_min_u32 v15, 1, v17
M v[76:79],a[104:107],v[164:167],v[76:79]
SA s85,s38,28672
buffer_load_dwordx4 v0, s[12:15], s85 offen offset:0 lds
M v[76:79],a[100:103],v[148:151],v[76:79]
SA s85,s38,34816
v_lshlrev_b32 v14, 3, v7
v_lshl_or_b32 v16, v15, 29, v14
M v[76:79],a[96:99],v[132:135],v[76:79]
s_waitcnt lgkmcnt(0)
buffer_load_dwordx4 v0, s[12:15], s85 offen offset:1024 lds
M v[80:83],a[64:67],v[128:131],0
SA s85,s38,40960
T a[96:97],v25,32768
T a[98:99],v25,34816
M v[80:83],a[68:71],v[144:147],v[80:83]
T a[100:101],v25,36864
T a[102:103],v25,38912
M v[80:83],a[72:75],v[160:163],v[80:83]
buffer_load_dwordx4 v0, s[12:15], s85 offen offset:2048 lds
M v[80:83],a[76:79],v[176:179],v[80:83]
SA s85,s38,47104
T a[104:105],v25,40960
T a[106:107],v25,43008
M v[80:83],a[80:83],v[192:195],v[80:83]
T a[108:109],v25,45056
T a[110:111],v25,47104
M v[80:83],a[84:87],v[208:211],v[80:83]
buffer_load_dwordx4 v0, s[12:15], s85 offen offset:3072 lds
M v[80:83],a[88:91],v[224:227],v[80:83]
SA s38,s38,128
T a[112:113],v25,49152
T a[114:115],v25,51200
M v[80:83],a[92:95],v[240:243],v[80:83]
SA m0,s28,131072
T a[116:117],v25,53248
T a[118:119],v25,55296
M v[84:87],a[92:95],v[244:247],0
SA s85,s38,0
buffer_load_dwordx4 v0, s[12:15], s85 offen offset:0 lds
M v[84:87],a[88:91],v[228:231],v[84:87]
SA s85,s38,6144
T a[120:121],v25,57344
T a[122:123],v25,59392
M v[84:87],a[84:87],v[212:215],v[84:87]
T a[124:125],v25,61440
T a[126:127],v25,63488
M v[84:87],a[80:83],v[196:199],v[84:87]
buffer_load_dwordx4 v0, s[12:15], s85 offen offset:1024 lds
M v[84:87],a[76:79],v[180:183],v[84:87]
SA s85,s38,12288
v_cmp_eq_u32 vcc, 1, v17
v_add_u32 v14, s66, v14
M v[84:87],a[72:75],v[164:167],v[84:87]
buffer_load_dwordx4 v0, s[12:15], s85 offen offset:2048 lds
M v[84:87],a[68:71],v[148:151],v[84:87]
s_waitcnt vmcnt(19) lgkmcnt(0)
v_mov_b32 v15, 1
v_cndmask_b32 v17, v16, v14, vcc
M v[84:87],a[64:67],v[132:135],v[84:87]
s_barrier
M v[88:91],a[96:99],v[128:131],0
SA s85,s38,18432
T a[64:65],v18,32768
T a[66:67],v18,34816
M v[88:91],a[100:103],v[144:147],v[88:91]
T a[68:69],v18,36864
T a[70:71],v18,38912
M v[88:91],a[104:107],v[160:163],v[88:91]
buffer_load_dwordx4 v0, s[12:15], s85 offen offset:3072 lds
M v[88:91],a[108:111],v[176:179],v[88:91]
SA m0,s28,135168
T a[72:73],v18,40960
T a[74:75],v18,43008
M v[88:91],a[112:115],v[192:195],v[88:91]
SA s85,s38,28672
T a[76:77],v18,45056
T a[78:79],v18,47104
M v[88:91],a[116:119],v[208:211],v[88:91]
buffer_load_dwordx4 v0, s[12:15], s85 offen offset:0 lds
M v[88:91],a[120:123],v[224:227],v[88:91]
SA s85,s38,34816
T a[80:81],v18,49152
T a[82:83],v18,51200
M v[88:91],a[124:127],v[240:243],v[88:91]
T a[84:85],v18,53248
T a[86:87],v18,55296
M v[92:95],a[124:127],v[244:247],0
buffer_load_dwordx4 v0, s[12:15], s85 offen offset:1024 lds
M v[92:95],a[120:123],v[228:231],v[92:95]
SA s85,s38,40960
T a[88:89],v18,57344
T a[90:91],v18,59392
M v[92:95],a[116:119],v[212:215],v[92:95]
T a[92:93],v18,61440
T a[94:95],v18,63488
M v[92:95],a[112:115],v[196:199],v[92:95]
buffer_load_dwordx4 v0, s[12:15], s85 offen offset:2048 lds
M v[92:95],a[108:111],v[180:183],v[92:95]
SA s85,s38,47104
v_add_u32 v40, 0x20000, v18
v_add_u32 v41, 0x20000, v19
M v[92:95],a[104:107],v[164:167],v[92:95]
buffer_load_dwordx4 v0, s[12:15], s85 offen offset:3072 lds
M v[92:95],a[100:103],v[148:151],v[92:95]
s_waitcnt lgkmcnt(0)
v_add_u32 v42, 0x20000, v20
v_add_u32 v43, 0x20000, v21
M v[92:95],a[96:99],v[132:135],v[92:95]
SA s38,s38,128
MF v64,v5,v64
MF v65,v5,v65
MF v66,v5,v66
MF v67,v5,v67
MF v72,v5,v72
MF v73,v5,v73
MF v74,v5,v74
MF v75,v5,v75
C v64,v64,v65
C v65,v66,v67
C v66,v72,v73
C v67,v74,v75
buffer_store_dwordx4 v[64:67], v7, s[8:11], s29 offen offset:0 sc1
MF v68,v6,v68
MF v69,v6,v69
MF v70,v6,v70
MF v71,v6,v71
MF v76,v6,v76
MF v77,v6,v77
MF v78,v6,v78
MF v79,v6,v79
C v68,v68,v69
C v69,v70,v71
C v70,v76,v77
C v71,v78,v79
buffer_store_dwordx4 v[68:71], v7, s[8:11], s30 offen offset:0 sc1
M v[96:99],a[64:67],v[128:131],0
s_nop 0
T a[96:97],v19,32768
T a[98:99],v19,34816
M v[96:99],a[68:71],v[144:147],v[96:99]
SA m0,s28,98304
T a[100:101],v19,36864
T a[102:103],v19,38912
M v[96:99],a[72:75],v[160:163],v[96:99]
SA s85,s38,0
buffer_load_dwordx4 v0, s[12:15], s85 offen offset:0 lds
M v[96:99],a[76:79],v[176:179],v[96:99]
s_nop 0
T a[104:105],v19,40960
T a[106:107],v19,43008
M v[96:99],a[80:83],v[192:195],v[96:99]
T a[108:109],v19,45056
T a[110:111],v19,47104
M v[96:99],a[84:87],v[208:211],v[96:99]
SA s85,s38,6144
MF v80,v5,v80
MF v81,v5,v81
M v[96:99],a[88:91],v[224:227],v[96:99]
T a[112:113],v19,49152
T a[114:115],v19,51200
M v[96:99],a[92:95],v[240:243],v[96:99]
T a[116:117],v19,53248
T a[118:119],v19,55296
M v[100:103],a[92:95],v[244:247],0
buffer_load_dwordx4 v0, s[12:15], s85 offen offset:1024 lds
M v[100:103],a[88:91],v[228:231],v[100:103]
s_nop 0
T a[120:121],v19,57344
T a[122:123],v19,59392
M v[100:103],a[84:87],v[212:215],v[100:103]
T a[124:125],v19,61440
T a[126:127],v19,63488
M v[100:103],a[80:83],v[196:199],v[100:103]
SA s85,s38,12288
MF v82,v5,v82
MF v83,v5,v83
M v[100:103],a[76:79],v[180:183],v[100:103]
buffer_load_dwordx4 v0, s[12:15], s85 offen offset:2048 lds
M v[100:103],a[72:75],v[164:167],v[100:103]
MF v88,v5,v88
MF v89,v5,v89
M v[100:103],a[68:71],v[148:151],v[100:103]
MF v90,v5,v90
MF v91,v5,v91
M v[100:103],a[64:67],v[132:135],v[100:103]
s_waitcnt lgkmcnt(0)
C v80,v80,v81
C v81,v82,v83
M v[104:107],a[96:99],v[128:131],0
SA s85,s38,18432
T a[64:65],v20,32768
T a[66:67],v20,34816
M v[104:107],a[100:103],v[144:147],v[104:107]
T a[68:69],v20,36864
T a[70:71],v20,38912
M v[104:107],a[104:107],v[160:163],v[104:107]
buffer_load_dwordx4 v0, s[12:15], s85 offen offset:3072 lds
M v[104:107],a[108:111],v[176:179],v[104:107]
s_nop 0
T a[72:73],v20,40960
T a[74:75],v20,43008
M v[104:107],a[112:115],v[192:195],v[104:107]
T a[76:77],v20,45056
T a[78:79],v20,47104
M v[104:107],a[116:119],v[208:211],v[104:107]
SA m0,s28,102400
C v82,v88,v89
C v83,v90,v91
M v[104:107],a[120:123],v[224:227],v[104:107]
SA s85,s38,28672
T a[80:81],v20,49152
T a[82:83],v20,51200
M v[104:107],a[124:127],v[240:243],v[104:107]
T a[84:85],v20,53248
T a[86:87],v20,55296
M v[108:111],a[124:127],v[244:247],0
buffer_store_dwordx4 v[80:83], v7, s[8:11], s29 offen offset:1024 sc1
M v[108:111],a[120:123],v[228:231],v[108:111]
s_nop 0
T a[88:89],v20,57344
T a[90:91],v20,59392
M v[108:111],a[116:119],v[212:215],v[108:111]
T a[92:93],v20,61440
T a[94:95],v20,63488
M v[108:111],a[112:115],v[196:199],v[108:111]
buffer_load_dwordx4 v0, s[12:15], s85 offen offset:0 lds
M v[108:111],a[108:111],v[180:183],v[108:111]
SA s85,s38,34816
MF v84,v6,v84
MF v85,v6,v85
M v[108:111],a[104:107],v[164:167],v[108:111]
MF v86,v6,v86
MF v87,v6,v87
M v[108:111],a[100:103],v[148:151],v[108:111]
buffer_load_dwordx4 v0, s[12:15], s85 offen offset:1024 lds
M v[108:111],a[96:99],v[132:135],v[108:111]
s_waitcnt lgkmcnt(0)
MF v92,v6,v92
MF v93,v6,v93
M v[112:115],a[64:67],v[128:131],0
T a[96:97],v21,32768
T a[98:99],v21,34816
M v[112:115],a[68:71],v[144:147],v[112:115]
SA s85,s38,40960
T a[100:101],v21,36864
T a[102:103],v21,38912
M v[112:115],a[72:75],v[160:163],v[112:115]
buffer_load_dwordx4 v0, s[12:15], s85 offen offset:2048 lds
M v[112:115],a[76:79],v[176:179],v[112:115]
s_nop 0
T a[104:105],v21,40960
T a[106:107],v21,43008
M v[112:115],a[80:83],v[192:195],v[112:115]
T a[108:109],v21,45056
T a[110:111],v21,47104
M v[112:115],a[84:87],v[208:211],v[112:115]
MF v94,v6,v94
MF v95,v6,v95
M v[112:115],a[88:91],v[224:227],v[112:115]
SA s85,s38,47104
T a[112:113],v21,49152
T a[114:115],v21,51200
M v[112:115],a[92:95],v[240:243],v[112:115]
T a[116:117],v21,53248
T a[118:119],v21,55296
M v[116:119],a[92:95],v[244:247],0
buffer_load_dwordx4 v0, s[12:15], s85 offen offset:3072 lds
M v[116:119],a[88:91],v[228:231],v[116:119]
s_nop 0
T a[120:121],v21,57344
T a[122:123],v21,59392
M v[116:119],a[84:87],v[212:215],v[116:119]
T a[124:125],v21,61440
T a[126:127],v21,63488
M v[116:119],a[80:83],v[196:199],v[116:119]
C v84,v84,v85
C v85,v86,v87
M v[116:119],a[76:79],v[180:183],v[116:119]
C v86,v92,v93
C v87,v94,v95
M v[116:119],a[72:75],v[164:167],v[116:119]
SA s38,s38,128
buffer_store_dwordx4 v[84:87], v7, s[8:11], s30 offen offset:1024 sc1
M v[116:119],a[68:71],v[148:151],v[116:119]
s_waitcnt vmcnt(28) lgkmcnt(0)
M v[116:119],a[64:67],v[132:135],v[116:119]
s_barrier
M v[120:123],a[96:99],v[128:131],0
SA s29,s33,2048
T a[64:65],v22,0
T a[66:67],v22,2048
M v[120:123],a[100:103],v[144:147],v[120:123]
SA s30,s33,16384
T a[68:69],v22,4096
T a[70:71],v22,6144
M v[120:123],a[104:107],v[160:163],v[120:123]
MF v96,v5,v96
MF v97,v5,v97
M v[120:123],a[108:111],v[176:179],v[120:123]
T a[72:73],v22,8192
T a[74:75],v22,10240
M v[120:123],a[112:115],v[192:195],v[120:123]
T a[76:77],v22,12288
T a[78:79],v22,14336
M v[120:123],a[116:119],v[208:211],v[120:123]
MF v98,v5,v98
MF v99,v5,v99
M v[120:123],a[120:123],v[224:227],v[120:123]
T a[80:81],v22,16384
T a[82:83],v22,18432
M v[120:123],a[124:127],v[240:243],v[120:123]
T a[84:85],v22,20480
T a[86:87],v22,22528
M v[124:127],a[124:127],v[244:247],0
MF v104,v5,v104
MF v105,v5,v105
M v[124:127],a[120:123],v[228:231],v[124:127]
T a[88:89],v22,24576
T a[90:91],v22,26624
M v[124:127],a[116:119],v[212:215],v[124:127]
T a[92:93],v22,28672
T a[94:95],v22,30720
M v[124:127],a[112:115],v[196:199],v[124:127]
MF v106,v5,v106
MF v107,v5,v107
M v[124:127],a[108:111],v[180:183],v[124:127]
C v96,v96,v97
C v97,v98,v99
M v[124:127],a[104:107],v[164:167],v[124:127]
C v98,v104,v105
C v99,v106,v107
M v[124:127],a[100:103],v[148:151],v[124:127]
s_waitcnt lgkmcnt(0)
buffer_store_dwordx4 v[96:99], v7, s[8:11], s29 offen offset:0 sc1
M v[124:127],a[96:99],v[132:135],v[124:127]
MF v100,v6,v100
MF v101,v6,v101
MF v102,v6,v102
MF v103,v6,v103
MF v108,v6,v108
MF v109,v6,v109
MF v110,v6,v110
MF v111,v6,v111
C v100,v100,v101
C v101,v102,v103
C v102,v108,v109
C v103,v110,v111
buffer_store_dwordx4 v[100:103], v7, s[8:11], s30 offen offset:0 sc1
M v[64:67],a[64:67],v[128:131],0
s_nop 0
T a[96:97],v23,0
T a[98:99],v23,2048
M v[64:67],a[68:71],v[144:147],v[64:67]
SA m0,s28,32768
T a[100:101],v23,4096
T a[102:103],v23,6144
M v[64:67],a[72:75],v[160:163],v[64:67]
SA s85,s38,0
buffer_load_dwordx4 v0, s[12:15], s85 offen offset:0 lds
M v[64:67],a[76:79],v[176:179],v[64:67]
s_nop 0
T a[104:105],v23,8192
T a[106:107],v23,10240
M v[64:67],a[80:83],v[192:195],v[64:67]
T a[108:109],v23,12288
T a[110:111],v23,14336
M v[64:67],a[84:87],v[208:211],v[64:67]
SA s85,s38,6144
MF v112,v5,v112
MF v113,v5,v113
M v[64:67],a[88:91],v[224:227],v[64:67]
T a[112:113],v23,16384
T a[114:115],v23,18432
M v[64:67],a[92:95],v[240:243],v[64:67]
T a[116:117],v23,20480
T a[118:119],v23,22528
M v[68:71],a[92:95],v[244:247],0
buffer_load_dwordx4 v0, s[12:15], s85 offen offset:1024 lds
M v[68:71],a[88:91],v[228:231],v[68:71]
s_nop 0
T a[120:121],v23,24576
T a[122:123],v23,26624
M v[68:71],a[84:87],v[212:215],v[68:71]
T a[124:125],v23,28672
T a[126:127],v23,30720
M v[68:71],a[80:83],v[196:199],v[68:71]
SA s85,s38,12288
MF v114,v5,v114
MF v115,v5,v115
M v[68:71],a[76:79],v[180:183],v[68:71]
buffer_load_dwordx4 v0, s[12:15], s85 offen offset:2048 lds
M v[68:71],a[72:75],v[164:167],v[68:71]
MF v120,v5,v120
MF v121,v5,v121
M v[68:71],a[68:71],v[148:151],v[68:71]
MF v122,v5,v122
MF v123,v5,v123
M v[68:71],a[64:67],v[132:135],v[68:71]
s_waitcnt lgkmcnt(0)
C v112,v112,v113
C v113,v114,v115
M v[72:75],a[96:99],v[128:131],0
SA s85,s38,18432
T a[64:65],v24,0
T a[66:67],v24,2048
M v[72:75],a[100:103],v[144:147],v[72:75]
T a[68:69],v24,4096
T a[70:71],v24,6144
M v[72:75],a[104:107],v[160:163],v[72:75]
buffer_load_dwordx4 v0, s[12:15], s85 offen offset:3072 lds
M v[72:75],a[108:111],v[176:179],v[72:75]
s_nop 0
T a[72:73],v24,8192
T a[74:75],v24,10240
M v[72:75],a[112:115],v[192:195],v[72:75]
T a[76:77],v24,12288
T a[78:79],v24,14336
M v[72:75],a[116:119],v[208:211],v[72:75]
SA m0,s28,36864
C v114,v120,v121
C v115,v122,v123
M v[72:75],a[120:123],v[224:227],v[72:75]
SA s85,s38,28672
T a[80:81],v24,16384
T a[82:83],v24,18432
M v[72:75],a[124:127],v[240:243],v[72:75]
T a[84:85],v24,20480
T a[86:87],v24,22528
M v[76:79],a[124:127],v[244:247],0
buffer_store_dwordx4 v[112:115], v7, s[8:11], s29 offen offset:1024 sc1
M v[76:79],a[120:123],v[228:231],v[76:79]
s_nop 0
T a[88:89],v24,24576
T a[90:91],v24,26624
M v[76:79],a[116:119],v[212:215],v[76:79]
T a[92:93],v24,28672
T a[94:95],v24,30720
M v[76:79],a[112:115],v[196:199],v[76:79]
buffer_load_dwordx4 v0, s[12:15], s85 offen offset:0 lds
M v[76:79],a[108:111],v[180:183],v[76:79]
SA s85,s38,34816
MF v116,v6,v116
MF v117,v6,v117
M v[76:79],a[104:107],v[164:167],v[76:79]
MF v118,v6,v118
MF v119,v6,v119
M v[76:79],a[100:103],v[148:151],v[76:79]
buffer_load_dwordx4 v0, s[12:15], s85 offen offset:1024 lds
M v[76:79],a[96:99],v[132:135],v[76:79]
s_waitcnt lgkmcnt(0)
MF v124,v6,v124
MF v125,v6,v125
M v[80:83],a[64:67],v[128:131],0
T a[96:97],v25,0
T a[98:99],v25,2048
M v[80:83],a[68:71],v[144:147],v[80:83]
SA s85,s38,40960
T a[100:101],v25,4096
T a[102:103],v25,6144
M v[80:83],a[72:75],v[160:163],v[80:83]
buffer_load_dwordx4 v0, s[12:15], s85 offen offset:2048 lds
M v[80:83],a[76:79],v[176:179],v[80:83]
s_nop 0
T a[104:105],v25,8192
T a[106:107],v25,10240
M v[80:83],a[80:83],v[192:195],v[80:83]
T a[108:109],v25,12288
T a[110:111],v25,14336
M v[80:83],a[84:87],v[208:211],v[80:83]
MF v126,v6,v126
MF v127,v6,v127
M v[80:83],a[88:91],v[224:227],v[80:83]
SA s85,s38,47104
T a[112:113],v25,16384
T a[114:115],v25,18432
M v[80:83],a[92:95],v[240:243],v[80:83]
T a[116:117],v25,20480
T a[118:119],v25,22528
M v[84:87],a[92:95],v[244:247],0
buffer_load_dwordx4 v0, s[12:15], s85 offen offset:3072 lds
M v[84:87],a[88:91],v[228:231],v[84:87]
s_nop 0
T a[120:121],v25,24576
T a[122:123],v25,26624
M v[84:87],a[84:87],v[212:215],v[84:87]
T a[124:125],v25,28672
T a[126:127],v25,30720
M v[84:87],a[80:83],v[196:199],v[84:87]
C v116,v116,v117
C v117,v118,v119
M v[84:87],a[76:79],v[180:183],v[84:87]
C v118,v124,v125
C v119,v126,v127
M v[84:87],a[72:75],v[164:167],v[84:87]
SA s38,s38,128
buffer_store_dwordx4 v[116:119], v7, s[8:11], s30 offen offset:1024 sc1
M v[84:87],a[68:71],v[148:151],v[84:87]
s_waitcnt vmcnt(32) lgkmcnt(0)
M v[84:87],a[64:67],v[132:135],v[84:87]
s_barrier
M v[88:91],a[96:99],v[128:131],0
SA s29,s33,4096
T a[64:65],v18,0
T a[66:67],v18,2048
M v[88:91],a[100:103],v[144:147],v[88:91]
SA s30,s33,18432
T a[68:69],v18,4096
T a[70:71],v18,6144
M v[88:91],a[104:107],v[160:163],v[88:91]
MF v64,v5,v64
MF v65,v5,v65
M v[88:91],a[108:111],v[176:179],v[88:91]
T a[72:73],v18,8192
T a[74:75],v18,10240
M v[88:91],a[112:115],v[192:195],v[88:91]
T a[76:77],v18,12288
T a[78:79],v18,14336
M v[88:91],a[116:119],v[208:211],v[88:91]
MF v66,v5,v66
MF v67,v5,v67
M v[88:91],a[120:123],v[224:227],v[88:91]
T a[80:81],v18,16384
T a[82:83],v18,18432
M v[88:91],a[124:127],v[240:243],v[88:91]
T a[84:85],v18,20480
T a[86:87],v18,22528
M v[92:95],a[124:127],v[244:247],0
MF v72,v5,v72
MF v73,v5,v73
M v[92:95],a[120:123],v[228:231],v[92:95]
T a[88:89],v18,24576
T a[90:91],v18,26624
M v[92:95],a[116:119],v[212:215],v[92:95]
T a[92:93],v18,28672
T a[94:95],v18,30720
M v[92:95],a[112:115],v[196:199],v[92:95]
MF v74,v5,v74
MF v75,v5,v75
M v[92:95],a[108:111],v[180:183],v[92:95]
C v64,v64,v65
C v65,v66,v67
M v[92:95],a[104:107],v[164:167],v[92:95]
C v66,v72,v73
C v67,v74,v75
M v[92:95],a[100:103],v[148:151],v[92:95]
s_waitcnt lgkmcnt(0)
buffer_store_dwordx4 v[64:67], v7, s[8:11], s29 offen offset:0 sc1
M v[92:95],a[96:99],v[132:135],v[92:95]
MF v68,v6,v68
MF v69,v6,v69
MF v70,v6,v70
MF v71,v6,v71
MF v76,v6,v76
MF v77,v6,v77
MF v78,v6,v78
MF v79,v6,v79
C v68,v68,v69
C v69,v70,v71
C v70,v76,v77
C v71,v78,v79
buffer_store_dwordx4 v[68:71], v7, s[8:11], s30 offen offset:0 sc1
M v[96:99],a[64:67],v[128:131],0
s_nop 0
T a[96:97],v19,0
T a[98:99],v19,2048
M v[96:99],a[68:71],v[144:147],v[96:99]
T a[100:101],v19,4096
T a[102:103],v19,6144
M v[96:99],a[72:75],v[160:163],v[96:99]
MF v80,v5,v80
MF v81,v5,v81
M v[96:99],a[76:79],v[176:179],v[96:99]
T a[104:105],v19,8192
T a[106:107],v19,10240
M v[96:99],a[80:83],v[192:195],v[96:99]
T a[108:109],v19,12288
T a[110:111],v19,14336
M v[96:99],a[84:87],v[208:211],v[96:99]
MF v82,v5,v82
MF v83,v5,v83
M v[96:99],a[88:91],v[224:227],v[96:99]
T a[112:113],v19,16384
T a[114:115],v19,18432
M v[96:99],a[92:95],v[240:243],v[96:99]
T a[116:117],v19,20480
T a[118:119],v19,22528
M v[100:103],a[92:95],v[244:247],0
MF v88,v5,v88
MF v89,v5,v89
M v[100:103],a[88:91],v[228:231],v[100:103]
T a[120:121],v19,24576
T a[122:123],v19,26624
M v[100:103],a[84:87],v[212:215],v[100:103]
T a[124:125],v19,28672
T a[126:127],v19,30720
M v[100:103],a[80:83],v[196:199],v[100:103]
MF v90,v5,v90
MF v91,v5,v91
M v[100:103],a[76:79],v[180:183],v[100:103]
C v80,v80,v81
C v81,v82,v83
M v[100:103],a[72:75],v[164:167],v[100:103]
C v82,v88,v89
C v83,v90,v91
M v[100:103],a[68:71],v[148:151],v[100:103]
buffer_store_dwordx4 v[80:83], v7, s[8:11], s29 offen offset:1024 sc1
M v[100:103],a[64:67],v[132:135],v[100:103]
s_waitcnt lgkmcnt(0)
MF v84,v6,v84
MF v85,v6,v85
M v[104:107],a[96:99],v[128:131],0
T a[64:65],v20,0
T a[66:67],v20,2048
M v[104:107],a[100:103],v[144:147],v[104:107]
T a[68:69],v20,4096
T a[70:71],v20,6144
M v[104:107],a[104:107],v[160:163],v[104:107]
MF v86,v6,v86
MF v87,v6,v87
M v[104:107],a[108:111],v[176:179],v[104:107]
T a[72:73],v20,8192
T a[74:75],v20,10240
M v[104:107],a[112:115],v[192:195],v[104:107]
T a[76:77],v20,12288
T a[78:79],v20,14336
M v[104:107],a[116:119],v[208:211],v[104:107]
MF v92,v6,v92
MF v93,v6,v93
M v[104:107],a[120:123],v[224:227],v[104:107]
T a[80:81],v20,16384
T a[82:83],v20,18432
M v[104:107],a[124:127],v[240:243],v[104:107]
T a[84:85],v20,20480
T a[86:87],v20,22528
M v[108:111],a[124:127],v[244:247],0
MF v94,v6,v94
MF v95,v6,v95
M v[108:111],a[120:123],v[228:231],v[108:111]
T a[88:89],v20,24576
T a[90:91],v20,26624
M v[108:111],a[116:119],v[212:215],v[108:111]
T a[92:93],v20,28672
T a[94:95],v20,30720
M v[108:111],a[112:115],v[196:199],v[108:111]
C v84,v84,v85
C v85,v86,v87
M v[108:111],a[108:111],v[180:183],v[108:111]
C v86,v92,v93
C v87,v94,v95
M v[108:111],a[104:107],v[164:167],v[108:111]
buffer_store_dwordx4 v[84:87], v7, s[8:11], s30 offen offset:1024 sc1
M v[108:111],a[100:103],v[148:151],v[108:111]
SA s29,s33,6144
M v[108:111],a[96:99],v[132:135],v[108:111]
s_waitcnt lgkmcnt(0)
M v[112:115],a[64:67],v[128:131],0
SA s30,s33,20480
T a[96:97],v21,0
T a[98:99],v21,2048
M v[112:115],a[68:71],v[144:147],v[112:115]
T a[100:101],v21,4096
T a[102:103],v21,6144
M v[112:115],a[72:75],v[160:163],v[112:115]
MF v96,v5,v96
MF v97,v5,v97
M v[112:115],a[76:79],v[176:179],v[112:115]
T a[104:105],v21,8192
T a[106:107],v21,10240
M v[112:115],a[80:83],v[192:195],v[112:115]
T a[108:109],v21,12288
T a[110:111],v21,14336
M v[112:115],a[84:87],v[208:211],v[112:115]
MF v98,v5,v98
MF v99,v5,v99
M v[112:115],a[88:91],v[224:227],v[112:115]
T a[112:113],v21,16384
T a[114:115],v21,18432
M v[112:115],a[92:95],v[240:243],v[112:115]
T a[116:117],v21,20480
T a[118:119],v21,22528
M v[116:119],a[92:95],v[244:247],0
MF v104,v5,v104
MF v105,v5,v105
M v[116:119],a[88:91],v[228:231],v[116:119]
T a[120:121],v21,24576
T a[122:123],v21,26624
M v[116:119],a[84:87],v[212:215],v[116:119]
T a[124:125],v21,28672
T a[126:127],v21,30720
M v[116:119],a[80:83],v[196:199],v[116:119]
MF v106,v5,v106
MF v107,v5,v107
M v[116:119],a[76:79],v[180:183],v[116:119]
C v96,v96,v97
C v97,v98,v99
M v[116:119],a[72:75],v[164:167],v[116:119]
C v98,v104,v105
C v99,v106,v107
M v[116:119],a[68:71],v[148:151],v[116:119]
s_waitcnt vmcnt(28) lgkmcnt(0)
buffer_store_dwordx4 v[96:99], v7, s[8:11], s29 offen offset:0 sc1
M v[116:119],a[64:67],v[132:135],v[116:119]
s_barrier
M v[120:123],a[96:99],v[128:131],0
s_nop 0
T a[64:65],v40,0
T a[66:67],v40,2048
M v[120:123],a[100:103],v[144:147],v[120:123]
T a[68:69],v40,4096
T a[70:71],v40,6144
M v[120:123],a[104:107],v[160:163],v[120:123]
MF v100,v6,v100
MF v101,v6,v101
M v[120:123],a[108:111],v[176:179],v[120:123]
T a[72:73],v40,8192
T a[74:75],v40,10240
M v[120:123],a[112:115],v[192:195],v[120:123]
T a[76:77],v40,12288
T a[78:79],v40,14336
M v[120:123],a[116:119],v[208:211],v[120:123]
MF v102,v6,v102
MF v103,v6,v103
M v[120:123],a[120:123],v[224:227],v[120:123]
T a[80:81],v40,16384
T a[82:83],v40,18432
M v[120:123],a[124:127],v[240:243],v[120:123]
T a[84:85],v40,20480
T a[86:87],v40,22528
M v[124:127],a[124:127],v[244:247],0
MF v108,v6,v108
MF v109,v6,v109
M v[124:127],a[120:123],v[228:231],v[124:127]
T a[88:89],v40,24576
T a[90:91],v40,26624
M v[124:127],a[116:119],v[212:215],v[124:127]
T a[92:93],v40,28672
T a[94:95],v40,30720
M v[124:127],a[112:115],v[196:199],v[124:127]
MF v110,v6,v110
MF v111,v6,v111
M v[124:127],a[108:111],v[180:183],v[124:127]
C v100,v100,v101
C v101,v102,v103
M v[124:127],a[104:107],v[164:167],v[124:127]
C v102,v108,v109
C v103,v110,v111
M v[124:127],a[100:103],v[148:151],v[124:127]
s_waitcnt lgkmcnt(0)
buffer_store_dwordx4 v[100:103], v7, s[8:11], s30 offen offset:0 sc1
M v[124:127],a[96:99],v[132:135],v[124:127]
M v[64:67],a[64:67],v[128:131],0
s_nop 0
T a[96:97],v41,0
T a[98:99],v41,2048
M v[64:67],a[68:71],v[144:147],v[64:67]
T a[100:101],v41,4096
T a[102:103],v41,6144
M v[64:67],a[72:75],v[160:163],v[64:67]
v_lshrrev_b32 v32, 4, v7
MF v112,v5,v112
M v[64:67],a[76:79],v[176:179],v[64:67]
s_lshr_b32 s74, s41, 3
T a[104:105],v41,8192
T a[106:107],v41,10240
M v[64:67],a[80:83],v[192:195],v[64:67]
s_sub_u32 s64, 15, s42
T a[108:109],v41,12288
T a[110:111],v41,14336
M v[64:67],a[84:87],v[208:211],v[64:67]
s_mul_i32 s46, s64, 8704
MF v113,v5,v113
MF v114,v5,v114
M v[64:67],a[88:91],v[224:227],v[64:67]
s_and_b32 s72, s41, 7
T a[112:113],v41,16384
T a[114:115],v41,18432
M v[64:67],a[92:95],v[240:243],v[64:67]
s_lshl_b32 s65, s72, 7
T a[116:117],v41,20480
T a[118:119],v41,22528
M v[68:71],a[92:95],v[244:247],0
SA s46,s46,s65
MF v115,v5,v115
MF v120,v5,v120
M v[68:71],a[88:91],v[228:231],v[68:71]
SA s46,s46,104993792
T a[120:121],v41,24576
T a[122:123],v41,26624
M v[68:71],a[84:87],v[212:215],v[68:71]
T a[124:125],v41,28672
T a[126:127],v41,30720
M v[68:71],a[80:83],v[196:199],v[68:71]
v_and_b32 v33, 31, v32
MF v121,v5,v121
M v[68:71],a[76:79],v[180:183],v[68:71]
MF v122,v5,v122
MF v123,v5,v123
M v[68:71],a[72:75],v[164:167],v[68:71]
C v112,v112,v113
C v113,v114,v115
M v[68:71],a[68:71],v[148:151],v[68:71]
C v114,v120,v121
C v115,v122,v123
M v[68:71],a[64:67],v[132:135],v[68:71]
s_waitcnt lgkmcnt(0)
buffer_store_dwordx4 v[112:115], v7, s[8:11], s29 offen offset:1024 sc1
M v[72:75],a[96:99],v[128:131],0
s_nop 0
T a[64:65],v42,0
T a[66:67],v42,2048
M v[72:75],a[100:103],v[144:147],v[72:75]
T a[68:69],v42,4096
T a[70:71],v42,6144
M v[72:75],a[104:107],v[160:163],v[72:75]
MF v116,v6,v116
MF v117,v6,v117
M v[72:75],a[108:111],v[176:179],v[72:75]
T a[72:73],v42,8192
T a[74:75],v42,10240
M v[72:75],a[112:115],v[192:195],v[72:75]
T a[76:77],v42,12288
T a[78:79],v42,14336
M v[72:75],a[116:119],v[208:211],v[72:75]
MF v118,v6,v118
MF v119,v6,v119
M v[72:75],a[120:123],v[224:227],v[72:75]
T a[80:81],v42,16384
T a[82:83],v42,18432
M v[72:75],a[124:127],v[240:243],v[72:75]
T a[84:85],v42,20480
T a[86:87],v42,22528
M v[76:79],a[124:127],v[244:247],0
MF v124,v6,v124
MF v125,v6,v125
M v[76:79],a[120:123],v[228:231],v[76:79]
T a[88:89],v42,24576
T a[90:91],v42,26624
M v[76:79],a[116:119],v[212:215],v[76:79]
T a[92:93],v42,28672
T a[94:95],v42,30720
M v[76:79],a[112:115],v[196:199],v[76:79]
MF v126,v6,v126
MF v127,v6,v127
M v[76:79],a[108:111],v[180:183],v[76:79]
C v116,v116,v117
C v117,v118,v119
M v[76:79],a[104:107],v[164:167],v[76:79]
C v118,v124,v125
C v119,v126,v127
M v[76:79],a[100:103],v[148:151],v[76:79]
buffer_store_dwordx4 v[116:119], v7, s[8:11], s30 offen offset:1024 sc1
M v[76:79],a[96:99],v[132:135],v[76:79]
s_waitcnt lgkmcnt(0)
v_lshlrev_b32 v33, 2, v33
M v[80:83],a[64:67],v[128:131],0
SA s29,s33,8192
T a[96:97],v43,0
T a[98:99],v43,2048
M v[80:83],a[68:71],v[144:147],v[80:83]
SA s30,s33,22528
T a[100:101],v43,4096
T a[102:103],v43,6144
M v[80:83],a[72:75],v[160:163],v[80:83]
s_lshl_b32 s65, s41, 7
MF v64,v5,v64
MF v65,v5,v65
M v[80:83],a[76:79],v[176:179],v[80:83]
SA s65,s65,104890368
T a[104:105],v43,8192
T a[106:107],v43,10240
M v[80:83],a[80:83],v[192:195],v[80:83]
T a[108:109],v43,12288
T a[110:111],v43,14336
M v[80:83],a[84:87],v[208:211],v[80:83]
buffer_load_dword v31, v33, s[8:11], s65 offen sc1
M v[80:83],a[88:91],v[224:227],v[80:83]
s_nop 0
T a[112:113],v43,16384
T a[114:115],v43,18432
M v[80:83],a[92:95],v[240:243],v[80:83]
T a[116:117],v43,20480
T a[118:119],v43,22528
M v[84:87],a[92:95],v[244:247],0
s_cmp_ge_u32 s42, 8
v_bfe_u32 v34, v32, 4, 1
v_lshlrev_b32 v34, 1, v34
M v[84:87],a[88:91],v[228:231],v[84:87]
s_cselect_b32 s84, s45, 536870912
T a[120:121],v43,24576
T a[122:123],v43,26624
M v[84:87],a[84:87],v[212:215],v[84:87]
T a[124:125],v43,28672
T a[126:127],v43,30720
M v[84:87],a[80:83],v[196:199],v[84:87]
v_lshrrev_b32 v35, 5, v32
v_add_u32 v34, v34, v35
M v[84:87],a[76:79],v[180:183],v[84:87]
s_mov_b32 s52, s96
MF v66,v5,v66
MF v67,v5,v67
M v[84:87],a[72:75],v[164:167],v[84:87]
s_and_b32 s53, s97, 0xffff
MF v72,v5,v72
MF v73,v5,v73
M v[84:87],a[68:71],v[148:151],v[84:87]
s_waitcnt vmcnt(22) lgkmcnt(0)
MF v74,v5,v74
MF v75,v5,v75
M v[84:87],a[64:67],v[132:135],v[84:87]
s_barrier
M v[88:91],a[96:99],v[128:131],0
s_mov_b32 s54, 1835008
T a[64:65],v22,32768
T a[66:67],v22,34816
M v[88:91],a[100:103],v[144:147],v[88:91]
s_mov_b32 s55, 0x20000
T a[68:69],v22,36864
T a[70:71],v22,38912
M v[88:91],a[104:107],v[160:163],v[88:91]
s_mul_i32 s77, s42, 1835008
C v64,v64,v65
C v65,v66,v67
M v[88:91],a[108:111],v[176:179],v[88:91]
s_mul_i32 s78, s72, 14336
T a[72:73],v22,40960
T a[74:75],v22,43008
M v[88:91],a[112:115],v[192:195],v[88:91]
SA s77,s77,s78
T a[76:77],v22,45056
T a[78:79],v22,47104
M v[88:91],a[116:119],v[208:211],v[88:91]
SA s77,s77,67108864
C v66,v72,v73
C v67,v74,v75
M v[88:91],a[120:123],v[224:227],v[88:91]
s_lshl_b32 s79, s74, 2
T a[80:81],v22,49152
T a[82:83],v22,51200
M v[88:91],a[124:127],v[240:243],v[88:91]
SA s79,s79,s20
T a[84:85],v22,53248
T a[86:87],v22,55296
M v[92:95],a[124:127],v[244:247],0
SA s79,s79,6
buffer_store_dwordx4 v[64:67], v7, s[8:11], s29 offen offset:0 sc1
M v[92:95],a[120:123],v[228:231],v[92:95]
s_sub_u32 s67, 13, s79
T a[88:89],v22,57344
T a[90:91],v22,59392
M v[92:95],a[116:119],v[212:215],v[92:95]
s_and_b32 s67, s67, 536870912
T a[92:93],v22,61440
T a[94:95],v22,63488
M v[92:95],a[112:115],v[196:199],v[92:95]
s_lshl_b32 s78, s79, 10
MF v68,v6,v68
MF v69,v6,v69
M v[92:95],a[108:111],v[180:183],v[92:95]
SA s78,s78,s77
MF v70,v6,v70
MF v71,v6,v71
M v[92:95],a[104:107],v[164:167],v[92:95]
s_lshl_b32 s79, s79, 6
MF v76,v6,v76
MF v77,v6,v77
M v[92:95],a[100:103],v[148:151],v[92:95]
s_waitcnt lgkmcnt(0)
MF v78,v6,v78
MF v79,v6,v79
M v[92:95],a[96:99],v[132:135],v[92:95]
s_or_b32 s79, s79, s67
v_or_b32 v27, s67, v7
s_lshr_b32 s73, s72, 1
s_sub_u32 s65, 7, s73
s_bitcmp1_b32 s72, 0
s_cselect_b32 s73, s65, s73
s_lshl_b32 s73, s73, 4
s_lshl_b32 s65, s42, 7
SA s73,s73,s65
v_and_b32 v29, 15, v32
v_add_u32 v29, s73, v29
s_mov_b32 s64, 104857664
v_mul_u32_u24 v28, 896, v29
v_lshl_add_u32 v28, v34, 4, v28
C v68,v68,v69
C v69,v70,v71
C v70,v76,v77
C v71,v78,v79
buffer_store_dwordx4 v[68:71], v7, s[8:11], s30 offen offset:0 sc1
v_lshrrev_b32 v35, 4, v29
v_lshlrev_b32 v35, 5, v35
v_and_b32 v36, 15, v29
v_add_lshl_u32 v35, v35, v36, 2
buffer_load_dword v26, v35, s[8:11], s64 offen sc1
s_waitcnt vmcnt(8)
buffer_store_dword v15, v17, s[8:11], s84 offen sc1
buffer_load_dwordx4 v[44:47], v28, s[56:59], s79 offen
M v[96:99],a[64:67],v[128:131],0
s_nop 0
T a[96:97],v23,32768
T a[98:99],v23,34816
M v[96:99],a[68:71],v[144:147],v[96:99]
T a[100:101],v23,36864
T a[102:103],v23,38912
M v[96:99],a[72:75],v[160:163],v[96:99]
MF v80,v5,v80
MF v81,v5,v81
M v[96:99],a[76:79],v[176:179],v[96:99]
T a[104:105],v23,40960
T a[106:107],v23,43008
M v[96:99],a[80:83],v[192:195],v[96:99]
T a[108:109],v23,45056
T a[110:111],v23,47104
M v[96:99],a[84:87],v[208:211],v[96:99]
MF v82,v5,v82
MF v83,v5,v83
M v[96:99],a[88:91],v[224:227],v[96:99]
T a[112:113],v23,49152
T a[114:115],v23,51200
M v[96:99],a[92:95],v[240:243],v[96:99]
T a[116:117],v23,53248
T a[118:119],v23,55296
M v[100:103],a[92:95],v[244:247],0
MF v88,v5,v88
MF v89,v5,v89
M v[100:103],a[88:91],v[228:231],v[100:103]
T a[120:121],v23,57344
T a[122:123],v23,59392
M v[100:103],a[84:87],v[212:215],v[100:103]
T a[124:125],v23,61440
T a[126:127],v23,63488
M v[100:103],a[80:83],v[196:199],v[100:103]
MF v90,v5,v90
MF v91,v5,v91
M v[100:103],a[76:79],v[180:183],v[100:103]
C v80,v80,v81
C v81,v82,v83
M v[100:103],a[72:75],v[164:167],v[100:103]
C v82,v88,v89
C v83,v90,v91
M v[100:103],a[68:71],v[148:151],v[100:103]
buffer_store_dwordx4 v[80:83], v7, s[8:11], s29 offen offset:1024 sc1
M v[100:103],a[64:67],v[132:135],v[100:103]
s_waitcnt lgkmcnt(0)
MF v84,v6,v84
MF v85,v6,v85
M v[104:107],a[96:99],v[128:131],0
T a[64:65],v24,32768
T a[66:67],v24,34816
M v[104:107],a[100:103],v[144:147],v[104:107]
T a[68:69],v24,36864
T a[70:71],v24,38912
M v[104:107],a[104:107],v[160:163],v[104:107]
MF v86,v6,v86
MF v87,v6,v87
M v[104:107],a[108:111],v[176:179],v[104:107]
T a[72:73],v24,40960
T a[74:75],v24,43008
M v[104:107],a[112:115],v[192:195],v[104:107]
T a[76:77],v24,45056
T a[78:79],v24,47104
M v[104:107],a[116:119],v[208:211],v[104:107]
MF v92,v6,v92
MF v93,v6,v93
M v[104:107],a[120:123],v[224:227],v[104:107]
T a[80:81],v24,49152
T a[82:83],v24,51200
M v[104:107],a[124:127],v[240:243],v[104:107]
T a[84:85],v24,53248
T a[86:87],v24,55296
M v[108:111],a[124:127],v[244:247],0
MF v94,v6,v94
MF v95,v6,v95
M v[108:111],a[120:123],v[228:231],v[108:111]
T a[88:89],v24,57344
T a[90:91],v24,59392
M v[108:111],a[116:119],v[212:215],v[108:111]
T a[92:93],v24,61440
T a[94:95],v24,63488
M v[108:111],a[112:115],v[196:199],v[108:111]
C v84,v84,v85
C v85,v86,v87
M v[108:111],a[108:111],v[180:183],v[108:111]
C v86,v92,v93
C v87,v94,v95
M v[108:111],a[104:107],v[164:167],v[108:111]
buffer_store_dwordx4 v[84:87], v7, s[8:11], s30 offen offset:1024 sc1
M v[108:111],a[100:103],v[148:151],v[108:111]
SA s29,s33,10240
M v[108:111],a[96:99],v[132:135],v[108:111]
s_waitcnt lgkmcnt(0)
M v[112:115],a[64:67],v[128:131],0
SA s30,s33,24576
T a[96:97],v25,32768
T a[98:99],v25,34816
M v[112:115],a[68:71],v[144:147],v[112:115]
T a[100:101],v25,36864
T a[102:103],v25,38912
M v[112:115],a[72:75],v[160:163],v[112:115]
MF v96,v5,v96
MF v97,v5,v97
M v[112:115],a[76:79],v[176:179],v[112:115]
T a[104:105],v25,40960
T a[106:107],v25,43008
M v[112:115],a[80:83],v[192:195],v[112:115]
T a[108:109],v25,45056
T a[110:111],v25,47104
M v[112:115],a[84:87],v[208:211],v[112:115]
MF v98,v5,v98
MF v99,v5,v99
M v[112:115],a[88:91],v[224:227],v[112:115]
T a[112:113],v25,49152
T a[114:115],v25,51200
M v[112:115],a[92:95],v[240:243],v[112:115]
T a[116:117],v25,53248
T a[118:119],v25,55296
M v[116:119],a[92:95],v[244:247],0
s_cmp_lt_u32 s42, 8
MF v104,v5,v104
MF v105,v5,v105
M v[116:119],a[88:91],v[228:231],v[116:119]
s_cselect_b32 s84, s45, 536870912
T a[120:121],v25,57344
T a[122:123],v25,59392
M v[116:119],a[84:87],v[212:215],v[116:119]
T a[124:125],v25,61440
T a[126:127],v25,63488
M v[116:119],a[80:83],v[196:199],v[116:119]
MF v106,v5,v106
MF v107,v5,v107
M v[116:119],a[76:79],v[180:183],v[116:119]
C v96,v96,v97
C v97,v98,v99
M v[116:119],a[72:75],v[164:167],v[116:119]
C v98,v104,v105
C v99,v106,v107
M v[116:119],a[68:71],v[148:151],v[116:119]
s_waitcnt lgkmcnt(0)
buffer_store_dwordx4 v[96:99], v7, s[8:11], s29 offen offset:0 sc1
M v[116:119],a[64:67],v[132:135],v[116:119]
s_barrier
M v[120:123],a[96:99],v[128:131],0
s_nop 0
T a[64:65],v18,32768
T a[66:67],v18,34816
M v[120:123],a[100:103],v[144:147],v[120:123]
T a[68:69],v18,36864
T a[70:71],v18,38912
M v[120:123],a[104:107],v[160:163],v[120:123]
MF v100,v6,v100
MF v101,v6,v101
M v[120:123],a[108:111],v[176:179],v[120:123]
T a[72:73],v18,40960
T a[74:75],v18,43008
M v[120:123],a[112:115],v[192:195],v[120:123]
s_waitcnt vmcnt(9)
T a[76:77],v18,45056
T a[78:79],v18,47104
M v[120:123],a[116:119],v[208:211],v[120:123]
buffer_store_dword v15, v17, s[8:11], s84 offen sc1
M v[120:123],a[120:123],v[224:227],v[120:123]
s_nop 0
T a[80:81],v18,49152
T a[82:83],v18,51200
M v[120:123],a[124:127],v[240:243],v[120:123]
T a[84:85],v18,53248
T a[86:87],v18,55296
M v[124:127],a[124:127],v[244:247],0
MF v102,v6,v102
MF v103,v6,v103
M v[124:127],a[120:123],v[228:231],v[124:127]
T a[88:89],v18,57344
T a[90:91],v18,59392
M v[124:127],a[116:119],v[212:215],v[124:127]
T a[92:93],v18,61440
T a[94:95],v18,63488
M v[124:127],a[112:115],v[196:199],v[124:127]
MF v108,v6,v108
MF v109,v6,v109
M v[124:127],a[108:111],v[180:183],v[124:127]
MF v110,v6,v110
MF v111,v6,v111
M v[124:127],a[104:107],v[164:167],v[124:127]
C v100,v100,v101
C v101,v102,v103
M v[124:127],a[100:103],v[148:151],v[124:127]
s_waitcnt lgkmcnt(0)
C v102,v108,v109
C v103,v110,v111
M v[124:127],a[96:99],v[132:135],v[124:127]
buffer_store_dwordx4 v[100:103], v7, s[8:11], s30 offen offset:0 sc1
M v[64:67],a[64:67],v[128:131],0
s_nop 0
T a[96:97],v19,32768
T a[98:99],v19,34816
M v[64:67],a[68:71],v[144:147],v[64:67]
T a[100:101],v19,36864
T a[102:103],v19,38912
M v[64:67],a[72:75],v[160:163],v[64:67]
MF v112,v5,v112
MF v113,v5,v113
M v[64:67],a[76:79],v[176:179],v[64:67]
T a[104:105],v19,40960
T a[106:107],v19,43008
M v[64:67],a[80:83],v[192:195],v[64:67]
T a[108:109],v19,45056
T a[110:111],v19,47104
M v[64:67],a[84:87],v[208:211],v[64:67]
MF v114,v5,v114
MF v115,v5,v115
M v[64:67],a[88:91],v[224:227],v[64:67]
T a[112:113],v19,49152
T a[114:115],v19,51200
M v[64:67],a[92:95],v[240:243],v[64:67]
T a[116:117],v19,53248
T a[118:119],v19,55296
M v[68:71],a[92:95],v[244:247],0
MF v120,v5,v120
MF v121,v5,v121
M v[68:71],a[88:91],v[228:231],v[68:71]
T a[120:121],v19,57344
T a[122:123],v19,59392
M v[68:71],a[84:87],v[212:215],v[68:71]
T a[124:125],v19,61440
T a[126:127],v19,63488
M v[68:71],a[80:83],v[196:199],v[68:71]
MF v122,v5,v122
MF v123,v5,v123
M v[68:71],a[76:79],v[180:183],v[68:71]
C v112,v112,v113
C v113,v114,v115
M v[68:71],a[72:75],v[164:167],v[68:71]
C v114,v120,v121
C v115,v122,v123
M v[68:71],a[68:71],v[148:151],v[68:71]
buffer_store_dwordx4 v[112:115], v7, s[8:11], s29 offen offset:1024 sc1
M v[68:71],a[64:67],v[132:135],v[68:71]
s_waitcnt lgkmcnt(0)
MF v116,v6,v116
MF v117,v6,v117
M v[72:75],a[96:99],v[128:131],0
T a[64:65],v20,32768
T a[66:67],v20,34816
M v[72:75],a[100:103],v[144:147],v[72:75]
T a[68:69],v20,36864
T a[70:71],v20,38912
M v[72:75],a[104:107],v[160:163],v[72:75]
MF v118,v6,v118
MF v119,v6,v119
M v[72:75],a[108:111],v[176:179],v[72:75]
T a[72:73],v20,40960
T a[74:75],v20,43008
M v[72:75],a[112:115],v[192:195],v[72:75]
T a[76:77],v20,45056
T a[78:79],v20,47104
M v[72:75],a[116:119],v[208:211],v[72:75]
MF v124,v6,v124
MF v125,v6,v125
M v[72:75],a[120:123],v[224:227],v[72:75]
T a[80:81],v20,49152
T a[82:83],v20,51200
M v[72:75],a[124:127],v[240:243],v[72:75]
T a[84:85],v20,53248
T a[86:87],v20,55296
M v[76:79],a[124:127],v[244:247],0
MF v126,v6,v126
MF v127,v6,v127
M v[76:79],a[120:123],v[228:231],v[76:79]
T a[88:89],v20,57344
T a[90:91],v20,59392
M v[76:79],a[116:119],v[212:215],v[76:79]
T a[92:93],v20,61440
T a[94:95],v20,63488
M v[76:79],a[112:115],v[196:199],v[76:79]
C v116,v116,v117
C v117,v118,v119
M v[76:79],a[108:111],v[180:183],v[76:79]
C v118,v124,v125
C v119,v126,v127
M v[76:79],a[104:107],v[164:167],v[76:79]
buffer_store_dwordx4 v[116:119], v7, s[8:11], s30 offen offset:1024 sc1
M v[76:79],a[100:103],v[148:151],v[76:79]
SA s29,s33,12288
s_waitcnt vmcnt(12)
v_readlane_b32 s92, v31, 0
v_readlane_b32 s94, v31, 1
M v[76:79],a[96:99],v[132:135],v[76:79]
s_waitcnt lgkmcnt(0)
s_waitcnt vmcnt(9)
v_sub_f32 v30, 1.0, v26
s_waitcnt vmcnt(7)
v_lshlrev_b32 v48, 16, v44
M v[80:83],a[64:67],v[128:131],0
SA s30,s33,26624
T a[96:97],v21,32768
T a[98:99],v21,34816
M v[80:83],a[68:71],v[144:147],v[80:83]
T a[100:101],v21,36864
T a[102:103],v21,38912
M v[80:83],a[72:75],v[160:163],v[80:83]
v_and_b32 v49, 0xffff0000, v44
v_lshlrev_b32 v50, 16, v45
M v[80:83],a[76:79],v[176:179],v[80:83]
T a[104:105],v21,40960
T a[106:107],v21,43008
M v[80:83],a[80:83],v[192:195],v[80:83]
T a[108:109],v21,45056
T a[110:111],v21,47104
M v[80:83],a[84:87],v[208:211],v[80:83]
MF v64,v5,v64
MF v65,v5,v65
M v[80:83],a[88:91],v[224:227],v[80:83]
T a[112:113],v21,49152
T a[114:115],v21,51200
M v[80:83],a[92:95],v[240:243],v[80:83]
T a[116:117],v21,53248
T a[118:119],v21,55296
M v[84:87],a[92:95],v[244:247],0
MF v66,v5,v66
MF v67,v5,v67
M v[84:87],a[88:91],v[228:231],v[84:87]
T a[120:121],v21,57344
T a[122:123],v21,59392
M v[84:87],a[84:87],v[212:215],v[84:87]
T a[124:125],v21,61440
T a[126:127],v21,63488
M v[84:87],a[80:83],v[196:199],v[84:87]
MF v72,v5,v72
MF v73,v5,v73
M v[84:87],a[76:79],v[180:183],v[84:87]
MF v74,v5,v74
MF v75,v5,v75
M v[84:87],a[72:75],v[164:167],v[84:87]
C v64,v64,v65
C v65,v66,v67
M v[84:87],a[68:71],v[148:151],v[84:87]
C v66,v72,v73
C v67,v74,v75
M v[84:87],a[64:67],v[132:135],v[84:87]
s_waitcnt lgkmcnt(0)
buffer_store_dwordx4 v[64:67], v7, s[8:11], s29 offen offset:0 sc1
M v[88:91],a[96:99],v[128:131],0
v_and_b32 v51, 0xffff0000, v45
v_lshlrev_b32 v52, 16, v46
M v[88:91],a[100:103],v[144:147],v[88:91]
MF v68,v6,v68
MF v69,v6,v69
M v[88:91],a[104:107],v[160:163],v[88:91]
MF v70,v6,v70
MF v71,v6,v71
M v[88:91],a[108:111],v[176:179],v[88:91]
MF v76,v6,v76
MF v77,v6,v77
M v[88:91],a[112:115],v[192:195],v[88:91]
MF v78,v6,v78
MF v79,v6,v79
M v[88:91],a[116:119],v[208:211],v[88:91]
C v68,v68,v69
C v69,v70,v71
M v[88:91],a[120:123],v[224:227],v[88:91]
C v70,v76,v77
C v71,v78,v79
M v[88:91],a[124:127],v[240:243],v[88:91]
buffer_store_dwordx4 v[68:71], v7, s[8:11], s30 offen offset:0 sc1
M v[92:95],a[124:127],v[244:247],0
v_and_b32 v53, 0xffff0000, v46
v_lshlrev_b32 v54, 16, v47
M v[92:95],a[120:123],v[228:231],v[92:95]
v_and_b32 v55, 0xffff0000, v47
v_cmp_eq_u32 s[80:81], s92, v29
M v[92:95],a[116:119],v[212:215],v[92:95]
v_cmp_eq_u32 s[82:83], s94, v29
M v[92:95],a[112:115],v[196:199],v[92:95]
MF v80,v5,v80
MF v81,v5,v81
M v[92:95],a[108:111],v[180:183],v[92:95]
MF v82,v5,v82
MF v83,v5,v83
M v[92:95],a[104:107],v[164:167],v[92:95]
MF v88,v5,v88
MF v89,v5,v89
M v[92:95],a[100:103],v[148:151],v[92:95]
MF v90,v5,v90
MF v91,v5,v91
M v[92:95],a[96:99],v[132:135],v[92:95]
C v80,v80,v81
C v81,v82,v83
C v82,v88,v89
C v83,v90,v91
buffer_store_dwordx4 v[80:83], v7, s[8:11], s29 offen offset:1024 sc1
MF v84,v6,v84
MF v85,v6,v85
MF v86,v6,v86
MF v87,v6,v87
MF v92,v6,v92
MF v93,v6,v93
MF v94,v6,v94
MF v95,v6,v95
C v84,v84,v85
C v85,v86,v87
C v86,v92,v93
C v87,v94,v95
buffer_store_dwordx4 v[84:87], v7, s[8:11], s30 offen offset:1024 sc1
buffer_load_dword v9, v33, s[8:11], s46 offen sc1
s_waitcnt vmcnt(1)
buffer_store_dword v15, v16, s[8:11], s3 offen sc1
s_cmp_lt_u32 s42, 8
s_cbranch_scc1 L_red
s_waitcnt vmcnt(1)
v_cmp_eq_u32 vcc, 1, v9
s_mov_b32 s91, 65536
s_lshl_b32 s70, 1, s41
s_mov_b32 s69, 0xffff
s_or_b32 s70, s70, vcc_lo
s_mov_b32 s68, s70
s_barrier
s_cmp_lg_u32 s70, 0
s_cbranch_scc1 L_vk0
s_call_b64 s[36:37], L_rpoll
L_vk0:
s_ff1_i32_b32 s71, s70
s_bitset0_b32 s70, s71
s_mul_i32 s71, s71, 114688
SA s16,s71,s78
buffer_load_dwordx4 v[128:131], v27, s[8:11], s16 offen sc1
s_cmp_lg_u32 s70, 0
s_cbranch_scc1 L_vk1
s_call_b64 s[36:37], L_rpoll
L_vk1:
s_ff1_i32_b32 s71, s70
s_bitset0_b32 s70, s71
s_mul_i32 s71, s71, 114688
SA s17,s71,s78
buffer_load_dwordx4 v[132:135], v27, s[8:11], s17 offen sc1
s_cmp_lg_u32 s70, 0
s_cbranch_scc1 L_vk2
s_call_b64 s[36:37], L_rpoll
L_vk2:
s_ff1_i32_b32 s71, s70
s_bitset0_b32 s70, s71
s_mul_i32 s71, s71, 114688
SA s18,s71,s78
buffer_load_dwordx4 v[136:139], v27, s[8:11], s18 offen sc1
s_cmp_lg_u32 s70, 0
s_cbranch_scc1 L_vk3
s_call_b64 s[36:37], L_rpoll
L_vk3:
s_ff1_i32_b32 s71, s70
s_bitset0_b32 s70, s71
s_mul_i32 s71, s71, 114688
SA s19,s71,s78
buffer_load_dwordx4 v[140:143], v27, s[8:11], s19 offen sc1
s_cmp_lg_u32 s70, 0
s_cbranch_scc1 L_vk4
s_call_b64 s[36:37], L_rpoll
L_vk4:
s_ff1_i32_b32 s71, s70
s_bitset0_b32 s70, s71
s_mul_i32 s71, s71, 114688
SA s48,s71,s78
buffer_load_dwordx4 v[144:147], v27, s[8:11], s48 offen sc1
s_cmp_lg_u32 s70, 0
s_cbranch_scc1 L_vk5
s_call_b64 s[36:37], L_rpoll
L_vk5:
s_ff1_i32_b32 s71, s70
s_bitset0_b32 s70, s71
s_mul_i32 s71, s71, 114688
SA s49,s71,s78
buffer_load_dwordx4 v[148:151], v27, s[8:11], s49 offen sc1
s_cmp_lg_u32 s70, 0
s_cbranch_scc1 L_vk6
s_call_b64 s[36:37], L_rpoll
L_vk6:
s_ff1_i32_b32 s71, s70
s_bitset0_b32 s70, s71
s_mul_i32 s71, s71, 114688
SA s50,s71,s78
buffer_load_dwordx4 v[152:155], v27, s[8:11], s50 offen sc1
s_cmp_lg_u32 s70, 0
s_cbranch_scc1 L_vk7
s_call_b64 s[36:37], L_rpoll
L_vk7:
s_ff1_i32_b32 s71, s70
s_bitset0_b32 s70, s71
s_mul_i32 s71, s71, 114688
SA s51,s71,s78
buffer_load_dwordx4 v[156:159], v27, s[8:11], s51 offen sc1
s_or_b64 vcc, s[80:81], s[82:83]
s_cbranch_vccnz L_moe2
L_moe_ret2:
MF v48,v30,v48
MF v49,v30,v49
MF v50,v30,v50
MF v51,v30,v51
MF v52,v30,v52
MF v53,v30,v53
MF v54,v30,v54
MF v55,v30,v55
s_cmp_lg_u32 s70, 0
s_cbranch_scc1 L_vk8
s_call_b64 s[36:37], L_rpoll
L_vk8:
s_ff1_i32_b32 s71, s70
s_bitset0_b32 s70, s71
s_mul_i32 s71, s71, 114688
SA s21,s71,s78
buffer_load_dwordx4 v[160:163], v27, s[8:11], s21 offen sc1
s_waitcnt vmcnt(8)
M v[56:59],a[246:249],v[128:131],0
M v[60:63],a[244:247],v[128:131],0
s_cmp_lg_u32 s70, 0
s_cbranch_scc1 L_vk9
s_call_b64 s[36:37], L_rpoll
L_vk9:
s_ff1_i32_b32 s71, s70
s_bitset0_b32 s70, s71
s_mul_i32 s71, s71, 114688
SA s22,s71,s78
buffer_load_dwordx4 v[164:167], v27, s[8:11], s22 offen sc1
s_waitcnt vmcnt(8)
M v[56:59],a[246:249],v[132:135],v[56:59]
M v[60:63],a[244:247],v[132:135],v[60:63]
s_cmp_lg_u32 s70, 0
s_cbranch_scc1 L_vk10
s_call_b64 s[36:37], L_rpoll
L_vk10:
s_ff1_i32_b32 s71, s70
s_bitset0_b32 s70, s71
s_mul_i32 s71, s71, 114688
SA s23,s71,s78
buffer_load_dwordx4 v[168:171], v27, s[8:11], s23 offen sc1
s_waitcnt vmcnt(8)
M v[56:59],a[246:249],v[136:139],v[56:59]
M v[60:63],a[244:247],v[136:139],v[60:63]
s_cmp_lg_u32 s70, 0
s_cbranch_scc1 L_vk11
s_call_b64 s[36:37], L_rpoll
L_vk11:
s_ff1_i32_b32 s71, s70
s_bitset0_b32 s70, s71
s_mul_i32 s71, s71, 114688
SA s24,s71,s78
buffer_load_dwordx4 v[172:175], v27, s[8:11], s24 offen sc1
s_waitcnt vmcnt(8)
M v[56:59],a[246:249],v[140:143],v[56:59]
M v[60:63],a[244:247],v[140:143],v[60:63]
s_cmp_lg_u32 s70, 0
s_cbranch_scc1 L_vk12
s_call_b64 s[36:37], L_rpoll
L_vk12:
s_ff1_i32_b32 s71, s70
s_bitset0_b32 s70, s71
s_mul_i32 s71, s71, 114688
SA s25,s71,s78
buffer_load_dwordx4 v[176:179], v27, s[8:11], s25 offen sc1
s_waitcnt vmcnt(8)
M v[56:59],a[246:249],v[144:147],v[56:59]
M v[60:63],a[244:247],v[144:147],v[60:63]
s_cmp_lg_u32 s70, 0
s_cbranch_scc1 L_vk13
s_call_b64 s[36:37], L_rpoll
L_vk13:
s_ff1_i32_b32 s71, s70
s_bitset0_b32 s70, s71
s_mul_i32 s71, s71, 114688
SA s26,s71,s78
buffer_load_dwordx4 v[180:183], v27, s[8:11], s26 offen sc1
s_waitcnt vmcnt(8)
M v[56:59],a[246:249],v[148:151],v[56:59]
M v[60:63],a[244:247],v[148:151],v[60:63]
s_cmp_lg_u32 s70, 0
s_cbranch_scc1 L_vk14
s_call_b64 s[36:37], L_rpoll
L_vk14:
s_ff1_i32_b32 s71, s70
s_bitset0_b32 s70, s71
s_mul_i32 s71, s71, 114688
SA s27,s71,s78
buffer_load_dwordx4 v[184:187], v27, s[8:11], s27 offen sc1
s_waitcnt vmcnt(8)
M v[56:59],a[246:249],v[152:155],v[56:59]
M v[60:63],a[244:247],v[152:155],v[60:63]
s_cmp_lg_u32 s70, 0
s_cbranch_scc1 L_vk15
s_call_b64 s[36:37], L_rpoll
L_vk15:
s_ff1_i32_b32 s71, s70
s_bitset0_b32 s70, s71
s_mul_i32 s71, s71, 114688
SA s28,s71,s78
buffer_load_dwordx4 v[188:191], v27, s[8:11], s28 offen sc1
s_waitcnt vmcnt(8)
M v[56:59],a[246:249],v[156:159],v[56:59]
M v[60:63],a[244:247],v[156:159],v[60:63]
s_waitcnt vmcnt(7)
M v[56:59],a[246:249],v[160:163],v[56:59]
M v[60:63],a[244:247],v[160:163],v[60:63]
s_waitcnt vmcnt(6)
M v[56:59],a[246:249],v[164:167],v[56:59]
M v[60:63],a[244:247],v[164:167],v[60:63]
s_waitcnt vmcnt(5)
M v[56:59],a[246:249],v[168:171],v[56:59]
M v[60:63],a[244:247],v[168:171],v[60:63]
s_waitcnt vmcnt(4)
M v[56:59],a[246:249],v[172:175],v[56:59]
M v[60:63],a[244:247],v[172:175],v[60:63]
s_waitcnt vmcnt(3)
M v[56:59],a[246:249],v[176:179],v[56:59]
M v[60:63],a[244:247],v[176:179],v[60:63]
s_waitcnt vmcnt(2)
M v[56:59],a[246:249],v[180:183],v[56:59]
M v[60:63],a[244:247],v[180:183],v[60:63]
s_waitcnt vmcnt(1)
M v[56:59],a[246:249],v[184:187],v[56:59]
M v[60:63],a[244:247],v[184:187],v[60:63]
s_waitcnt vmcnt(0)
M v[56:59],a[246:249],v[188:191],v[56:59]
M v[60:63],a[244:247],v[188:191],v[60:63]
s_nop 7
v_permlane16_swap_b32 v56, v60
v_permlane16_swap_b32 v57, v61
v_permlane16_swap_b32 v58, v62
v_permlane16_swap_b32 v59, v63
v_fmac_f32 v48, v26, v56
v_fmac_f32 v49, v26, v57
v_fmac_f32 v50, v26, v58
v_fmac_f32 v51, v26, v59
v_fmac_f32 v52, v26, v60
v_fmac_f32 v53, v26, v61
v_fmac_f32 v54, v26, v62
v_fmac_f32 v55, v26, v63
C v44,v48,v49
C v45,v50,v51
C v46,v52,v53
C v47,v54,v55
buffer_store_dwordx4 v[44:47], v28, s[52:55], s79 offen sc1
s_endpgm
L_d2h:
M v[128:131],a[64:67],v[48:51],v[128:131]
R a[96:99],v7,40960
R a[100:103],v7,41984
M v[128:131],a[68:71],v[56:59],v[128:131]
SA m0,s28,135168
E v18,v64
M v[132:135],a[68:71],v[60:63],v[132:135]
buffer_load_dwordx4 v4, s[8:11], s26 offen offset:0 sc1 lds
M v[132:135],a[64:67],v[52:55],v[132:135]
R a[104:107],v7,43008
R a[108:111],v7,44032
M v[136:139],a[72:75],v[48:51],v[136:139]
s_cmp_gt_u32 s20, 3
E v19,v65
M v[136:139],a[76:79],v[56:59],v[136:139]
s_cselect_b64 s[82:83], -1, 0
AF v30,v28,v30
AF v31,v29,v31
M v[140:143],a[76:79],v[60:63],v[140:143]
s_cmp_eq_u32 s20, 3
R a[112:115],v7,45056
R a[116:119],v7,46080
M v[140:143],a[72:75],v[52:55],v[140:143]
s_cselect_b64 s[66:67], s[16:17], s[82:83]
buffer_load_dwordx4 v4, s[8:11], s26 offen offset:1024 sc1 lds
M v[144:147],a[80:83],v[48:51],v[144:147]
s_cselect_b64 s[68:69], s[18:19], s[82:83]
E v20,v66
M v[144:147],a[84:87],v[56:59],v[144:147]
s_cselect_b64 s[70:71], s[48:49], s[82:83]
R a[120:123],v7,47104
R a[124:127],v7,48128
M v[148:151],a[84:87],v[60:63],v[148:151]
s_cselect_b64 s[72:73], s[50:51], s[82:83]
v_cndmask_b32 v100, v36, v8, s[66:67]
v_cndmask_b32 v101, v36, v8, s[68:69]
M v[148:151],a[80:83],v[52:55],v[148:151]
buffer_load_dwordx4 v4, s[8:11], s26 offen offset:2048 sc1 lds
M v[152:155],a[88:91],v[48:51],v[152:155]
v_cndmask_b32 v102, v36, v8, s[70:71]
AF v26,v18,v19
M v[152:155],a[92:95],v[56:59],v[152:155]
E v21,v67
M v[156:159],a[92:95],v[60:63],v[156:159]
v_cndmask_b32 v103, v36, v8, s[72:73]
C v40,v18,v19
M v[156:159],a[88:91],v[52:55],v[156:159]
s_waitcnt lgkmcnt(0)
buffer_load_dwordx4 v4, s[8:11], s26 offen offset:3072 sc1 lds
M v[160:163],a[96:99],v[48:51],v[160:163]
s_cmp_gt_u32 s20, 2
R a[64:67],v7,49152
R a[68:71],v7,50176
M v[160:163],a[100:103],v[56:59],v[160:163]
s_cselect_b64 s[82:83], -1, 0
E v22,v72
M v[164:167],a[100:103],v[60:63],v[164:167]
s_cmp_eq_u32 s20, 2
AF v26,v20,v26
C v41,v20,v21
M v[164:167],a[96:99],v[52:55],v[164:167]
s_mul_i32 s21, s41, 1048576
R a[72:75],v7,51200
R a[76:79],v7,52224
M v[168:171],a[104:107],v[48:51],v[168:171]
s_cselect_b64 s[74:75], s[16:17], s[82:83]
E v23,v73
M v[168:171],a[108:111],v[56:59],v[168:171]
s_cselect_b64 s[76:77], s[18:19], s[82:83]
AF v26,v21,v26
AF v26,v22,v26
M v[172:175],a[108:111],v[60:63],v[172:175]
s_cselect_b64 s[78:79], s[48:49], s[82:83]
R a[80:83],v7,53248
R a[84:87],v7,54272
M v[172:175],a[104:107],v[52:55],v[172:175]
s_cselect_b64 s[80:81], s[50:51], s[82:83]
v_cndmask_b32 v108, v36, v8, s[74:75]
v_cndmask_b32 v109, v36, v8, s[76:77]
M v[176:179],a[112:115],v[48:51],v[176:179]
SA s21,s21,589824
E v24,v74
M v[176:179],a[116:119],v[56:59],v[176:179]
s_lshl_b32 s84, s42, 1
R a[88:91],v7,55296
R a[92:95],v7,56320
M v[180:183],a[116:119],v[60:63],v[180:183]
s_sub_u32 s22, 11, s84
v_cndmask_b32 v110, v36, v8, s[78:79]
C v42,v22,v23
M v[180:183],a[112:115],v[52:55],v[180:183]
s_mov_b32 s23, 536870912
s_waitcnt vmcnt(16)
v_cmp_gt_u32 vcc, 2, v5
AF v26,v23,v26
M v[184:187],a[120:123],v[48:51],v[184:187]
s_cbranch_vccnz L_lsh2
L_lrh2:
v_cndmask_b32 v111, v36, v8, s[80:81]
M v[184:187],a[124:127],v[56:59],v[184:187]
SA m0,s28,98304
E v25,v75
M v[188:191],a[124:127],v[60:63],v[188:191]
s_cmp_gt_u32 s20, 1
buffer_load_dwordx4 v3, s[8:11], s21 offen offset:0 sc1 lds
M v[188:191],a[120:123],v[52:55],v[188:191]
s_waitcnt lgkmcnt(0)
E v18,v68
M v[192:195],a[64:67],v[48:51],v[192:195]
s_cselect_b64 s[82:83], -1, 0
R a[96:99],v7,57344
R a[100:103],v7,58368
M v[192:195],a[68:71],v[56:59],v[192:195]
s_cmp_eq_u32 s20, 1
buffer_load_dwordx4 v3, s[8:11], s21 offen offset:1024 sc1 lds
M v[196:199],a[68:71],v[60:63],v[196:199]
s_cselect_b64 s[66:67], s[16:17], s[82:83]
E v19,v69
M v[196:199],a[64:67],v[52:55],v[196:199]
s_cselect_b64 s[68:69], s[18:19], s[82:83]
R a[104:107],v7,59392
R a[108:111],v7,60416
M v[200:203],a[72:75],v[48:51],v[200:203]
s_cselect_b64 s[70:71], s[48:49], s[82:83]
buffer_load_dwordx4 v3, s[8:11], s21 offen offset:2048 sc1 lds
M v[200:203],a[76:79],v[56:59],v[200:203]
s_cselect_b64 s[72:73], s[50:51], s[82:83]
v_cndmask_b32 v116, v36, v8, s[66:67]
v_cndmask_b32 v117, v36, v8, s[68:69]
M v[204:207],a[76:79],v[60:63],v[204:207]
R a[112:115],v7,61440
R a[116:119],v7,62464
M v[204:207],a[72:75],v[52:55],v[204:207]
v_cndmask_b32 v118, v36, v8, s[70:71]
AF v26,v24,v26
M v[208:211],a[80:83],v[48:51],v[208:211]
buffer_load_dwordx4 v3, s[8:11], s21 offen offset:3072 sc1 lds
M v[208:211],a[84:87],v[56:59],v[208:211]
SA m0,s28,102400
R a[120:123],v7,63488
R a[124:127],v7,64512
M v[212:215],a[84:87],v[60:63],v[212:215]
v_cndmask_b32 v119, v36, v8, s[72:73]
C v43,v24,v25
M v[212:215],a[80:83],v[52:55],v[212:215]
s_cmp_gt_u32 s20, 0
E v20,v70
M v[216:219],a[88:91],v[48:51],v[216:219]
s_cselect_b64 s[82:83], -1, 0
buffer_load_dwordx4 v4, s[8:11], s21 offen offset:0 sc1 lds
M v[216:219],a[92:95],v[56:59],v[216:219]
s_cmp_eq_u32 s20, 0
E v21,v71
M v[220:223],a[92:95],v[60:63],v[220:223]
s_waitcnt lgkmcnt(0)
E v22,v76
M v[220:223],a[88:91],v[52:55],v[220:223]
s_barrier
M v[224:227],a[96:99],v[48:51],v[224:227]
s_cselect_b64 s[74:75], s[16:17], s[82:83]
R a[64:67],v2,0
R a[68:71],v2,1024
M v[224:227],a[100:103],v[56:59],v[224:227]
s_cselect_b64 s[76:77], s[18:19], s[82:83]
buffer_load_dwordx4 v4, s[8:11], s21 offen offset:1024 sc1 lds
M v[228:231],a[100:103],v[60:63],v[228:231]
s_cselect_b64 s[78:79], s[48:49], s[82:83]
E v23,v77
M v[228:231],a[96:99],v[52:55],v[228:231]
s_cselect_b64 s[80:81], s[50:51], s[82:83]
R a[72:75],v2,2048
R a[76:79],v2,3072
M v[232:235],a[104:107],v[48:51],v[232:235]
v_cndmask_b32 v124, v36, v8, s[74:75]
v_cndmask_b32 v125, v36, v8, s[76:77]
M v[232:235],a[108:111],v[56:59],v[232:235]
buffer_load_dwordx4 v4, s[8:11], s21 offen offset:2048 sc1 lds
M v[236:239],a[108:111],v[60:63],v[236:239]
R a[80:83],v2,4096
R a[84:87],v2,5120
M v[236:239],a[104:107],v[52:55],v[236:239]
v_cndmask_b32 v126, v36, v8, s[78:79]
AF v26,v25,v26
M v[240:243],a[112:115],v[48:51],v[240:243]
v_cndmask_b32 v127, v36, v8, s[80:81]
AF v27,v18,v19
M v[240:243],a[116:119],v[56:59],v[240:243]
R a[88:91],v2,6144
R a[92:95],v2,7168
M v[244:247],a[116:119],v[60:63],v[244:247]
buffer_load_dwordx4 v4, s[8:11], s21 offen offset:3072 sc1 lds
M v[244:247],a[112:115],v[52:55],v[244:247]
SA s21,s21,32768
E v24,v78
M v[248:251],a[120:123],v[48:51],v[248:251]
s_sub_u32 s22, s22, 1
E v25,v79
M v[248:251],a[124:127],v[56:59],v[248:251]
s_cselect_b32 s21, s23, s21
C v44,v18,v19
AF v27,v20,v27
M v[252:255],a[124:127],v[60:63],v[252:255]
s_waitcnt lgkmcnt(0)
C v45,v20,v21
AF v27,v21,v27
M v[252:255],a[120:123],v[52:55],v[252:255]
AF v27,v22,v27
C v46,v22,v23
AF v27,v23,v27
AF v27,v24,v27
C v47,v24,v25
AF v27,v25,v27
L_d3h:
M v[100:103],a[64:67],a[32:35],v[100:103]
R a[96:99],v2,8192
R a[100:103],v2,9216
M v[100:103],a[68:71],a[36:39],v[100:103]
R a[104:107],v2,10240
R a[108:111],v2,11264
M v[100:103],a[72:75],a[40:43],v[100:103]
R a[112:115],v2,12288
R a[116:119],v2,13312
M v[100:103],a[76:79],a[44:47],v[100:103]
R a[120:123],v2,14336
R a[124:127],v2,15360
M v[100:103],a[80:83],a[48:51],v[100:103]
v_add_u32 v8, 0x20000, v7
M v[100:103],a[84:87],a[52:55],v[100:103]
buffer_load_dword v5, v9, s[8:11], s46 offen sc1
M v[100:103],a[88:91],a[56:59],v[100:103]
buffer_load_dword v6, off, s[8:11], s47 offset:16 sc1
M v[100:103],a[92:95],a[60:63],v[100:103]
s_waitcnt lgkmcnt(0)
E v18,v80
M v[108:111],a[96:99],a[32:35],v[108:111]
R a[64:67],v2,16384
R a[68:71],v2,17408
M v[108:111],a[100:103],a[36:39],v[108:111]
R a[72:75],v2,18432
R a[76:79],v2,19456
M v[108:111],a[104:107],a[40:43],v[108:111]
R a[80:83],v2,20480
R a[84:87],v2,21504
M v[108:111],a[108:111],a[44:47],v[108:111]
R a[88:91],v2,22528
R a[92:95],v2,23552
M v[108:111],a[112:115],a[48:51],v[108:111]
E v19,v81
M v[108:111],a[116:119],a[52:55],v[108:111]
E v20,v82
M v[108:111],a[120:123],a[56:59],v[108:111]
E v21,v83
M v[108:111],a[124:127],a[60:63],v[108:111]
s_waitcnt lgkmcnt(0)
E v22,v88
M v[116:119],a[64:67],a[32:35],v[116:119]
R a[96:99],v2,24576
R a[100:103],v2,25600
M v[116:119],a[68:71],a[36:39],v[116:119]
R a[104:107],v2,26624
R a[108:111],v2,27648
M v[116:119],a[72:75],a[40:43],v[116:119]
R a[112:115],v2,28672
R a[116:119],v2,29696
M v[116:119],a[76:79],a[44:47],v[116:119]
R a[120:123],v2,30720
R a[124:127],v2,31744
M v[116:119],a[80:83],a[48:51],v[116:119]
E v23,v89
M v[116:119],a[84:87],a[52:55],v[116:119]
E v24,v90
M v[116:119],a[88:91],a[56:59],v[116:119]
s_waitcnt vmcnt(18) lgkmcnt(0)
E v25,v91
M v[116:119],a[92:95],a[60:63],v[116:119]
s_barrier
M v[124:127],a[96:99],a[32:35],v[124:127]
R a[64:67],v7,0
R a[68:71],v7,1024
M v[124:127],a[100:103],a[36:39],v[124:127]
R a[72:75],v7,2048
R a[76:79],v7,3072
M v[124:127],a[104:107],a[40:43],v[124:127]
R a[80:83],v7,4096
R a[84:87],v7,5120
M v[124:127],a[108:111],a[44:47],v[124:127]
R a[88:91],v7,6144
R a[92:95],v7,7168
M v[124:127],a[112:115],a[48:51],v[124:127]
AF v26,v18,v26
C v56,v18,v19
M v[124:127],a[116:119],a[52:55],v[124:127]
AF v26,v19,v26
AF v26,v20,v26
M v[124:127],a[120:123],a[56:59],v[124:127]
s_waitcnt lgkmcnt(0)
E v18,v84
M v[124:127],a[124:127],a[60:63],v[124:127]
E v19,v85
C v57,v20,v21
AF v26,v21,v26
AF v26,v22,v26
C v58,v22,v23
AF v26,v23,v26
AF v26,v24,v26
C v59,v24,v25
AF v26,v25,v26
E v20,v86
E v21,v87
AF v27,v18,v27
C v60,v18,v19
AF v27,v19,v27
E v22,v92
E v23,v93
AF v27,v20,v27
C v61,v20,v21
AF v27,v21,v27
E v24,v94
E v25,v95
AF v27,v22,v27
C v62,v22,v23
AF v27,v23,v27
AF v27,v24,v27
C v63,v24,v25
AF v27,v25,v27
v_max_f32 v10, v26, v27
v_cmp_lt_f32 vcc, s31, v10
s_nop 0
s_cbranch_vccnz L_std3h
L_rtd3h:
M v[128:131],a[64:67],v[40:43],v[128:131]
R a[96:99],v7,8192
R a[100:103],v7,9216
M v[128:131],a[68:71],v[56:59],v[128:131]
s_waitcnt vmcnt(0)
v_cmp_ne_u32 vcc, 1, v6
AF v30,v26,v30
M v[132:135],a[68:71],v[60:63],v[132:135]
s_cbranch_vccnz L_fqs
L_fqr:
E v18,v100
M v[132:135],a[64:67],v[44:47],v[132:135]
SA s73,s32,4096
R a[104:107],v7,10240
R a[108:111],v7,11264
M v[136:139],a[72:75],v[40:43],v[136:139]
SA s74,s32,8192
E v19,v101
M v[136:139],a[76:79],v[56:59],v[136:139]
SA s75,s32,12288
buffer_load_dwordx4 a[0:3], v7, s[8:11], s32 offen offset:0 sc1
M v[140:143],a[76:79],v[60:63],v[140:143]
R a[112:115],v7,12288
R a[116:119],v7,13312
M v[140:143],a[72:75],v[44:47],v[140:143]
E v20,v102
M v[144:147],a[80:83],v[40:43],v[144:147]
buffer_load_dwordx4 a[4:7], v7, s[8:11], s32 offen offset:1024 sc1
M v[144:147],a[84:87],v[56:59],v[144:147]
R a[120:123],v7,14336
R a[124:127],v7,15360
M v[148:151],a[84:87],v[60:63],v[148:151]
AF v31,v27,v31
AF v29,v18,v19
M v[148:151],a[80:83],v[44:47],v[148:151]
buffer_load_dwordx4 a[8:11], v7, s[8:11], s32 offen offset:2048 sc1
M v[152:155],a[88:91],v[40:43],v[152:155]
E v21,v103
M v[152:155],a[92:95],v[56:59],v[152:155]
C v52,v18,v19
AF v29,v20,v29
M v[156:159],a[92:95],v[60:63],v[156:159]
buffer_load_dwordx4 a[12:15], v7, s[8:11], s32 offen offset:3072 sc1
M v[156:159],a[88:91],v[44:47],v[156:159]
s_waitcnt lgkmcnt(0)
E v22,v108
M v[160:163],a[96:99],v[40:43],v[160:163]
R a[64:67],v7,16384
R a[68:71],v7,17408
M v[160:163],a[100:103],v[56:59],v[160:163]
buffer_load_dwordx4 a[16:19], v7, s[8:11], s73 offen offset:0 sc1
M v[164:167],a[100:103],v[60:63],v[164:167]
E v23,v109
M v[164:167],a[96:99],v[44:47],v[164:167]
R a[72:75],v7,18432
R a[76:79],v7,19456
M v[168:171],a[104:107],v[40:43],v[168:171]
buffer_load_dwordx4 a[20:23], v7, s[8:11], s73 offen offset:1024 sc1
M v[168:171],a[108:111],v[56:59],v[168:171]
C v53,v20,v21
AF v29,v21,v29
M v[172:175],a[108:111],v[60:63],v[172:175]
R a[80:83],v7,20480
R a[84:87],v7,21504
M v[172:175],a[104:107],v[44:47],v[172:175]
buffer_load_dwordx4 a[24:27], v7, s[8:11], s73 offen offset:2048 sc1
M v[176:179],a[112:115],v[40:43],v[176:179]
E v24,v110
M v[176:179],a[116:119],v[56:59],v[176:179]
R a[88:91],v7,22528
R a[92:95],v7,23552
M v[180:183],a[116:119],v[60:63],v[180:183]
buffer_load_dwordx4 a[28:31], v7, s[8:11], s73 offen offset:3072 sc1
M v[180:183],a[112:115],v[44:47],v[180:183]
E v25,v111
M v[184:187],a[120:123],v[40:43],v[184:187]
AF v29,v22,v29
C v54,v22,v23
M v[184:187],a[124:127],v[56:59],v[184:187]
buffer_load_dwordx4 a[32:35], v7, s[8:11], s74 offen offset:0 sc1
M v[188:191],a[124:127],v[60:63],v[188:191]
E v18,v116
M v[188:191],a[120:123],v[44:47],v[188:191]
s_waitcnt lgkmcnt(0)
AF v29,v23,v29
AF v29,v24,v29
M v[192:195],a[64:67],v[40:43],v[192:195]
R a[96:99],v7,24576
R a[100:103],v7,25600
M v[192:195],a[68:71],v[56:59],v[192:195]
buffer_load_dwordx4 a[36:39], v7, s[8:11], s74 offen offset:1024 sc1
M v[196:199],a[68:71],v[60:63],v[196:199]
E v19,v117
M v[196:199],a[64:67],v[44:47],v[196:199]
R a[104:107],v7,26624
R a[108:111],v7,27648
M v[200:203],a[72:75],v[40:43],v[200:203]
buffer_load_dwordx4 a[40:43], v7, s[8:11], s74 offen offset:2048 sc1
M v[200:203],a[76:79],v[56:59],v[200:203]
E v20,v118
M v[204:207],a[76:79],v[60:63],v[204:207]
R a[112:115],v7,28672
R a[116:119],v7,29696
M v[204:207],a[72:75],v[44:47],v[204:207]
buffer_load_dwordx4 a[44:47], v7, s[8:11], s74 offen offset:3072 sc1
M v[208:211],a[80:83],v[40:43],v[208:211]
C v55,v24,v25
AF v29,v25,v29
M v[208:211],a[84:87],v[56:59],v[208:211]
R a[120:123],v7,30720
R a[124:127],v7,31744
M v[212:215],a[84:87],v[60:63],v[212:215]
buffer_load_dwordx4 a[48:51], v7, s[8:11], s75 offen offset:0 sc1
M v[212:215],a[80:83],v[44:47],v[212:215]
E v21,v119
M v[216:219],a[88:91],v[40:43],v[216:219]
AF v29,v18,v29
C v48,v18,v19
M v[216:219],a[92:95],v[56:59],v[216:219]
buffer_load_dwordx4 a[52:55], v7, s[8:11], s75 offen offset:1024 sc1
M v[220:223],a[92:95],v[60:63],v[220:223]
s_waitcnt lgkmcnt(0)
E v22,v124
M v[220:223],a[88:91],v[44:47],v[220:223]
s_barrier
M v[224:227],a[96:99],v[40:43],v[224:227]
R a[64:67],v8,0
R a[68:71],v8,1024
M v[224:227],a[100:103],v[56:59],v[224:227]
buffer_load_dwordx4 a[56:59], v7, s[8:11], s75 offen offset:2048 sc1
M v[228:231],a[100:103],v[60:63],v[228:231]
v_mov_b32 v15, 4
AF v29,v19,v29
M v[228:231],a[96:99],v[44:47],v[228:231]
R a[72:75],v8,2048
R a[76:79],v8,3072
M v[232:235],a[104:107],v[40:43],v[232:235]
buffer_store_dword v15, v1, s[8:11], s45 offen sc1
M v[232:235],a[108:111],v[56:59],v[232:235]
buffer_load_dwordx4 a[60:63], v7, s[8:11], s75 offen offset:3072 sc1
M v[236:239],a[108:111],v[60:63],v[236:239]
s_cmp_ge_u32 s42, 2
R a[80:83],v8,4096
R a[84:87],v8,5120
M v[236:239],a[104:107],v[44:47],v[236:239]
s_cselect_b32 s84, 4, 2
v_cmp_gt_u32 vcc, s84, v5
AF v29,v20,v29
M v[240:243],a[112:115],v[40:43],v[240:243]
s_cbranch_vccnz L_lsh4
L_lrh4:
E v23,v125
M v[240:243],a[116:119],v[56:59],v[240:243]
R a[88:91],v8,6144
R a[92:95],v8,7168
M v[244:247],a[116:119],v[60:63],v[244:247]
E v24,v126
M v[244:247],a[112:115],v[44:47],v[244:247]
E v25,v127
M v[248:251],a[120:123],v[40:43],v[248:251]
C v49,v20,v21
AF v29,v21,v29
M v[248:251],a[124:127],v[56:59],v[248:251]
AF v29,v22,v29
C v50,v22,v23
M v[252:255],a[124:127],v[60:63],v[252:255]
s_waitcnt lgkmcnt(0)
AF v29,v23,v29
AF v29,v24,v29
M v[252:255],a[120:123],v[44:47],v[252:255]
C v51,v24,v25
AF v29,v25,v29
v_cmp_lt_f32 vcc, s31, v29
s_nop 0
s_cbranch_vccnz L_std4h
L_rtd4h:
M v[132:135],a[64:67],v[52:55],v[132:135]
R a[96:99],v8,8192
R a[100:103],v8,9216
M v[132:135],a[68:71],v[48:51],v[132:135]
R a[104:107],v8,10240
R a[108:111],v8,11264
M v[140:143],a[72:75],v[52:55],v[140:143]
SA m0,s28,65536
R a[112:115],v8,12288
R a[116:119],v8,13312
M v[140:143],a[76:79],v[48:51],v[140:143]
R a[120:123],v8,14336
R a[124:127],v8,15360
M v[148:151],a[80:83],v[52:55],v[148:151]
buffer_load_dwordx4 v3, s[8:11], s21 offen offset:0 sc1 lds
M v[148:151],a[84:87],v[48:51],v[148:151]
AF v31,v29,v31
v_mov_b32 v10, v30
M v[156:159],a[88:91],v[52:55],v[156:159]
v_mov_b32 v11, v31
C v128,v128,v129
M v[156:159],a[92:95],v[48:51],v[156:159]
s_waitcnt lgkmcnt(0)
v_permlane16_swap_b32 v10, v30
M v[164:167],a[96:99],v[52:55],v[164:167]
R a[64:67],v8,16384
R a[68:71],v8,17408
M v[164:167],a[100:103],v[48:51],v[164:167]
R a[72:75],v8,18432
R a[76:79],v8,19456
M v[172:175],a[104:107],v[52:55],v[172:175]
R a[80:83],v8,20480
R a[84:87],v8,21504
M v[172:175],a[108:111],v[48:51],v[172:175]
R a[88:91],v8,22528
R a[92:95],v8,23552
M v[180:183],a[112:115],v[52:55],v[180:183]
buffer_load_dwordx4 v3, s[8:11], s21 offen offset:1024 sc1 lds
M v[180:183],a[116:119],v[48:51],v[180:183]
v_permlane16_swap_b32 v11, v31
M v[188:191],a[120:123],v[52:55],v[188:191]
AF v30,v10,v30
AF v31,v11,v31
M v[188:191],a[124:127],v[48:51],v[188:191]
s_waitcnt lgkmcnt(0)
buffer_load_dwordx4 v3, s[8:11], s21 offen offset:2048 sc1 lds
M v[196:199],a[64:67],v[52:55],v[196:199]
R a[96:99],v8,24576
R a[100:103],v8,25600
M v[196:199],a[68:71],v[48:51],v[196:199]
R a[104:107],v8,26624
R a[108:111],v8,27648
M v[204:207],a[72:75],v[52:55],v[204:207]
R a[112:115],v8,28672
R a[116:119],v8,29696
M v[204:207],a[76:79],v[48:51],v[204:207]
R a[120:123],v8,30720
R a[124:127],v8,31744
M v[212:215],a[80:83],v[52:55],v[212:215]
buffer_load_dwordx4 v3, s[8:11], s21 offen offset:3072 sc1 lds
M v[212:215],a[84:87],v[48:51],v[212:215]
SA m0,s28,69632
v_mov_b32 v10, v30
v_mov_b32 v11, v31
M v[220:223],a[88:91],v[52:55],v[220:223]
s_waitcnt lgkmcnt(0)
v_permlane32_swap_b32 v10, v30
M v[220:223],a[92:95],v[48:51],v[220:223]
s_barrier
M v[228:231],a[96:99],v[52:55],v[228:231]
R a[64:67],v2,32768
R a[68:71],v2,33792
M v[228:231],a[100:103],v[48:51],v[228:231]
R a[72:75],v2,34816
R a[76:79],v2,35840
M v[236:239],a[104:107],v[52:55],v[236:239]
R a[80:83],v2,36864
R a[84:87],v2,37888
M v[236:239],a[108:111],v[48:51],v[236:239]
R a[88:91],v2,38912
R a[92:95],v2,39936
M v[244:247],a[112:115],v[52:55],v[244:247]
v_permlane32_swap_b32 v11, v31
M v[244:247],a[116:119],v[48:51],v[244:247]
s_waitcnt vmcnt(4)
buffer_load_dwordx4 v4, s[8:11], s21 offen offset:0 sc1 lds
M v[252:255],a[120:123],v[52:55],v[252:255]
s_waitcnt lgkmcnt(0)
AF v30,v10,v30
AF v31,v11,v31
M v[252:255],a[124:127],v[48:51],v[252:255]
v_rcp_f32 v5, v30
M v[64:67],a[64:67],a[0:3],0
R a[96:99],v2,40960
R a[100:103],v2,41984
M v[64:67],a[68:71],a[4:7],v[64:67]
v_rcp_f32 v6, v31
M v[64:67],a[72:75],a[8:11],v[64:67]
buffer_load_dwordx4 v4, s[8:11], s21 offen offset:1024 sc1 lds
M v[64:67],a[76:79],a[12:15],v[64:67]
R a[104:107],v2,43008
R a[108:111],v2,44032
M v[64:67],a[80:83],a[16:19],v[64:67]
W a192,v5
W a193,v6
M v[64:67],a[84:87],a[20:23],v[64:67]
buffer_load_dwordx4 v4, s[8:11], s21 offen offset:2048 sc1 lds
M v[64:67],a[88:91],a[24:27],v[64:67]
R a[112:115],v2,45056
R a[116:119],v2,46080
M v[64:67],a[92:95],a[28:31],v[64:67]
v_mov_b32 v30, 0
v_mov_b32 v31, 0
M v[68:71],a[92:95],a[60:63],0
buffer_load_dwordx4 v4, s[8:11], s21 offen offset:3072 sc1 lds
M v[68:71],a[88:91],a[56:59],v[68:71]
SA s21,s21,32768
R a[120:123],v2,47104
R a[124:127],v2,48128
M v[68:71],a[84:87],a[52:55],v[68:71]
s_sub_u32 s22, s22, 1
v_mov_b32 v32, 0
v_mov_b32 v33, 0
M v[68:71],a[80:83],a[48:51],v[68:71]
s_cselect_b32 s21, s23, s21
v_mov_b32 v34, 0
v_mov_b32 v35, 0
M v[68:71],a[76:79],a[44:47],v[68:71]
s_mul_i32 s26, s41, 1048576
v_mov_b32 v36, 0
v_mov_b32 v37, 0
M v[68:71],a[72:75],a[40:43],v[68:71]
SA s26,s26,17367040
v_mov_b32 v38, 0
v_mov_b32 v39, 0
M v[68:71],a[68:71],a[36:39],v[68:71]
SA m0,s28,0
E v18,v64
M v[68:71],a[64:67],a[32:35],v[68:71]
s_waitcnt lgkmcnt(0)
buffer_load_dwordx4 v3, s[8:11], s26 offen offset:0 sc1 lds
M v[72:75],a[96:99],a[0:3],0
R a[64:67],v2,49152
R a[68:71],v2,50176
M v[72:75],a[100:103],a[4:7],v[72:75]
E v19,v65
M v[72:75],a[104:107],a[8:11],v[72:75]
buffer_load_dwordx4 v3, s[8:11], s26 offen offset:1024 sc1 lds
M v[72:75],a[108:111],a[12:15],v[72:75]
R a[72:75],v2,51200
R a[76:79],v2,52224
M v[72:75],a[112:115],a[16:19],v[72:75]
E v20,v66
M v[72:75],a[116:119],a[20:23],v[72:75]
buffer_load_dwordx4 v3, s[8:11], s26 offen offset:2048 sc1 lds
M v[72:75],a[120:123],a[24:27],v[72:75]
R a[80:83],v2,53248
R a[84:87],v2,54272
M v[72:75],a[124:127],a[28:31],v[72:75]
E v21,v67
M v[76:79],a[124:127],a[60:63],0
buffer_load_dwordx4 v3, s[8:11], s26 offen offset:3072 sc1 lds
M v[76:79],a[120:123],a[56:59],v[76:79]
SA m0,s28,4096
R a[88:91],v2,55296
R a[92:95],v2,56320
M v[76:79],a[116:119],a[52:55],v[76:79]
E v22,v68
M v[76:79],a[112:115],a[48:51],v[76:79]
E v23,v69
M v[76:79],a[108:111],a[44:47],v[76:79]
buffer_load_dwordx4 v4, s[8:11], s26 offen offset:0 sc1 lds
M v[76:79],a[104:107],a[40:43],v[76:79]
AF v26,v18,v19
C v40,v18,v19
M v[76:79],a[100:103],a[36:39],v[76:79]
E v24,v70
M v[76:79],a[96:99],a[32:35],v[76:79]
s_waitcnt lgkmcnt(0)
AF v26,v20,v26
C v41,v20,v21
M v[80:83],a[64:67],a[0:3],0
R a[96:99],v2,57344
R a[100:103],v2,58368
M v[80:83],a[68:71],a[4:7],v[80:83]
buffer_load_dwordx4 v4, s[8:11], s26 offen offset:1024 sc1 lds
M v[80:83],a[72:75],a[8:11],v[80:83]
E v25,v71
M v[80:83],a[76:79],a[12:15],v[80:83]
R a[104:107],v2,59392
R a[108:111],v2,60416
M v[80:83],a[80:83],a[16:19],v[80:83]
AF v26,v21,v26
AF v27,v22,v23
M v[80:83],a[84:87],a[20:23],v[80:83]
buffer_load_dwordx4 v4, s[8:11], s26 offen offset:2048 sc1 lds
M v[80:83],a[88:91],a[24:27],v[80:83]
R a[112:115],v2,61440
R a[116:119],v2,62464
M v[80:83],a[92:95],a[28:31],v[80:83]
E v18,v72
M v[84:87],a[92:95],a[60:63],0
E v19,v73
M v[84:87],a[88:91],a[56:59],v[84:87]
R a[120:123],v2,63488
R a[124:127],v2,64512
M v[84:87],a[84:87],a[52:55],v[84:87]
buffer_load_dwordx4 v4, s[8:11], s26 offen offset:3072 sc1 lds
M v[84:87],a[80:83],a[48:51],v[84:87]
SA s26,s26,32768
E v20,v74
M v[84:87],a[76:79],a[44:47],v[84:87]
SA m0,s28,32768
C v44,v22,v23
AF v27,v24,v27
M v[84:87],a[72:75],a[40:43],v[84:87]
C v45,v24,v25
AF v27,v25,v27
M v[84:87],a[68:71],a[36:39],v[84:87]
s_waitcnt vmcnt(8) lgkmcnt(0)
buffer_load_dwordx4 v3, s[8:11], s26 offen offset:0 sc1 lds
M v[84:87],a[64:67],a[32:35],v[84:87]
s_barrier
M v[88:91],a[96:99],a[0:3],0
R a[64:67],v2,0
R a[68:71],v2,1024
M v[88:91],a[100:103],a[4:7],v[88:91]
E v21,v75
M v[88:91],a[104:107],a[8:11],v[88:91]
buffer_load_dwordx4 v3, s[8:11], s26 offen offset:1024 sc1 lds
M v[88:91],a[108:111],a[12:15],v[88:91]
R a[72:75],v2,2048
R a[76:79],v2,3072
M v[88:91],a[112:115],a[16:19],v[88:91]
E v22,v76
M v[88:91],a[116:119],a[20:23],v[88:91]
E v23,v77
M v[88:91],a[120:123],a[24:27],v[88:91]
R a[80:83],v2,4096
R a[84:87],v2,5120
M v[88:91],a[124:127],a[28:31],v[88:91]
buffer_load_dwordx4 v3, s[8:11], s26 offen offset:2048 sc1 lds
M v[92:95],a[124:127],a[60:63],0
E v24,v78
M v[92:95],a[120:123],a[56:59],v[92:95]
R a[88:91],v2,6144
R a[92:95],v2,7168
M v[92:95],a[116:119],a[52:55],v[92:95]
E v25,v79
M v[92:95],a[112:115],a[48:51],v[92:95]
buffer_load_dwordx4 v3, s[8:11], s26 offen offset:3072 sc1 lds
M v[92:95],a[108:111],a[44:47],v[92:95]
AF v26,v18,v26
C v42,v18,v19
M v[92:95],a[104:107],a[40:43],v[92:95]
AF v26,v19,v26
AF v26,v20,v26
M v[92:95],a[100:103],a[36:39],v[92:95]
s_waitcnt lgkmcnt(0)
C v43,v20,v21
AF v26,v21,v26
M v[92:95],a[96:99],a[32:35],v[92:95]
AF v27,v22,v27
C v46,v22,v23
AF v27,v23,v27
AF v27,v24,v27
C v47,v24,v25
AF v27,v25,v27
M v[96:99],a[64:67],a[0:3],0
R a[96:99],v2,8192
R a[100:103],v2,9216
M v[96:99],a[68:71],a[4:7],v[96:99]
SA m0,s28,98304
E v18,v80
M v[96:99],a[72:75],a[8:11],v[96:99]
buffer_load_dwordx4 v3, s[8:11], s21 offen offset:0 sc1 lds
M v[96:99],a[76:79],a[12:15],v[96:99]
R a[104:107],v2,10240
R a[108:111],v2,11264
M v[96:99],a[80:83],a[16:19],v[96:99]
E v19,v81
M v[96:99],a[84:87],a[20:23],v[96:99]
AF v26,v18,v26
C v56,v18,v19
M v[96:99],a[88:91],a[24:27],v[96:99]
R a[112:115],v2,12288
R a[116:119],v2,13312
M v[96:99],a[92:95],a[28:31],v[96:99]
buffer_load_dwordx4 v3, s[8:11], s21 offen offset:1024 sc1 lds
M v[100:103],a[92:95],a[60:63],0
E v20,v82
M v[100:103],a[88:91],a[56:59],v[100:103]
R a[120:123],v2,14336
R a[124:127],v2,15360
M v[100:103],a[84:87],a[52:55],v[100:103]
E v21,v83
M v[100:103],a[80:83],a[48:51],v[100:103]
buffer_load_dwordx4 v3, s[8:11], s21 offen offset:2048 sc1 lds
M v[100:103],a[76:79],a[44:47],v[100:103]
AF v26,v19,v26
AF v26,v20,v26
M v[100:103],a[72:75],a[40:43],v[100:103]
E v22,v88
M v[100:103],a[68:71],a[36:39],v[100:103]
C v57,v20,v21
AF v26,v21,v26
M v[100:103],a[64:67],a[32:35],v[100:103]
s_waitcnt lgkmcnt(0)
buffer_load_dwordx4 v3, s[8:11], s21 offen offset:3072 sc1 lds
M v[104:107],a[96:99],a[0:3],0
R a[64:67],v2,16384
R a[68:71],v2,17408
M v[104:107],a[100:103],a[4:7],v[104:107]
E v23,v89
M v[104:107],a[104:107],a[8:11],v[104:107]
SA m0,s28,102400
AF v26,v22,v26
C v58,v22,v23
M v[104:107],a[108:111],a[12:15],v[104:107]
R a[72:75],v2,18432
R a[76:79],v2,19456
M v[104:107],a[112:115],a[16:19],v[104:107]
buffer_load_dwordx4 v4, s[8:11], s21 offen offset:0 sc1 lds
M v[104:107],a[116:119],a[20:23],v[104:107]
E v24,v90
M v[104:107],a[120:123],a[24:27],v[104:107]
R a[80:83],v2,20480
R a[84:87],v2,21504
M v[104:107],a[124:127],a[28:31],v[104:107]
E v25,v91
M v[108:111],a[124:127],a[60:63],0
buffer_load_dwordx4 v4, s[8:11], s21 offen offset:1024 sc1 lds
M v[108:111],a[120:123],a[56:59],v[108:111]
R a[88:91],v2,22528
R a[92:95],v2,23552
M v[108:111],a[116:119],a[52:55],v[108:111]
AF v26,v23,v26
AF v26,v24,v26
M v[108:111],a[112:115],a[48:51],v[108:111]
E v18,v84
M v[108:111],a[108:111],a[44:47],v[108:111]
buffer_load_dwordx4 v4, s[8:11], s21 offen offset:2048 sc1 lds
M v[108:111],a[104:107],a[40:43],v[108:111]
C v59,v24,v25
AF v26,v25,v26
M v[108:111],a[100:103],a[36:39],v[108:111]
E v19,v85
M v[108:111],a[96:99],a[32:35],v[108:111]
s_waitcnt lgkmcnt(0)
AF v27,v18,v27
C v60,v18,v19
M v[112:115],a[64:67],a[0:3],0
R a[96:99],v2,24576
R a[100:103],v2,25600
M v[112:115],a[68:71],a[4:7],v[112:115]
buffer_load_dwordx4 v4, s[8:11], s21 offen offset:3072 sc1 lds
M v[112:115],a[72:75],a[8:11],v[112:115]
SA s21,s21,32768
E v20,v86
M v[112:115],a[76:79],a[12:15],v[112:115]
s_sub_u32 s22, s22, 1
R a[104:107],v2,26624
R a[108:111],v2,27648
M v[112:115],a[80:83],a[16:19],v[112:115]
s_cselect_b32 s21, s23, s21
AF v27,v19,v27
C v129,v130,v131
M v[112:115],a[84:87],a[20:23],v[112:115]
SA m0,s28,36864
E v21,v87
M v[112:115],a[88:91],a[24:27],v[112:115]
R a[112:115],v2,28672
R a[116:119],v2,29696
M v[112:115],a[92:95],a[28:31],v[112:115]
buffer_load_dwordx4 v4, s[8:11], s26 offen offset:0 sc1 lds
M v[116:119],a[92:95],a[60:63],0
E v22,v92
M v[116:119],a[88:91],a[56:59],v[116:119]
R a[120:123],v2,30720
R a[124:127],v2,31744
M v[116:119],a[84:87],a[52:55],v[116:119]
AF v27,v20,v27
C v61,v20,v21
M v[116:119],a[80:83],a[48:51],v[116:119]
buffer_load_dwordx4 v4, s[8:11], s26 offen offset:1024 sc1 lds
M v[116:119],a[76:79],a[44:47],v[116:119]
E v23,v93
M v[116:119],a[72:75],a[40:43],v[116:119]
AF v27,v21,v27
AF v27,v22,v27
M v[116:119],a[68:71],a[36:39],v[116:119]
s_waitcnt vmcnt(14) lgkmcnt(0)
C v62,v22,v23
AF v27,v23,v27
M v[116:119],a[64:67],a[32:35],v[116:119]
s_barrier
M v[120:123],a[96:99],a[0:3],0
R a[64:67],v7,0
R a[68:71],v7,1024
M v[120:123],a[100:103],a[4:7],v[120:123]
buffer_load_dwordx4 v4, s[8:11], s26 offen offset:2048 sc1 lds
M v[120:123],a[104:107],a[8:11],v[120:123]
E v24,v94
M v[120:123],a[108:111],a[12:15],v[120:123]
R a[72:75],v7,2048
R a[76:79],v7,3072
M v[120:123],a[112:115],a[16:19],v[120:123]
E v25,v95
M v[120:123],a[116:119],a[20:23],v[120:123]
buffer_load_dwordx4 v4, s[8:11], s26 offen offset:3072 sc1 lds
M v[120:123],a[120:123],a[24:27],v[120:123]
R a[80:83],v7,4096
R a[84:87],v7,5120
M v[120:123],a[124:127],a[28:31],v[120:123]
AF v27,v24,v27
C v63,v24,v25
M v[124:127],a[124:127],a[60:63],0
SA s26,s26,32768
AF v27,v25,v27
C v130,v136,v137
M v[124:127],a[120:123],a[56:59],v[124:127]
R a[88:91],v7,6144
R a[92:95],v7,7168
C v131,v138,v139
W a128,v128
W a129,v129
W a130,v130
W a131,v131
C v144,v144,v145
C v145,v146,v147
C v146,v152,v153
C v147,v154,v155
W a132,v144
W a133,v145
W a134,v146
W a135,v147
C v132,v132,v133
C v133,v134,v135
C v134,v140,v141
C v135,v142,v143
W a160,v132
W a161,v133
W a162,v134
W a163,v135
C v160,v160,v161
C v161,v162,v163
C v162,v168,v169
C v163,v170,v171
W a136,v160
W a137,v161
W a138,v162
W a139,v163
C v148,v148,v149
C v149,v150,v151
C v150,v156,v157
C v151,v158,v159
W a164,v148
W a165,v149
W a166,v150
W a167,v151
C v176,v176,v177
C v177,v178,v179
C v178,v184,v185
C v179,v186,v187
W a140,v176
W a141,v177
W a142,v178
W a143,v179
C v164,v164,v165
C v165,v166,v167
C v166,v172,v173
C v167,v174,v175
W a168,v164
W a169,v165
W a170,v166
W a171,v167
C v192,v192,v193
C v193,v194,v195
C v194,v200,v201
C v195,v202,v203
W a144,v192
W a145,v193
W a146,v194
W a147,v195
C v180,v180,v181
C v181,v182,v183
C v182,v188,v189
C v183,v190,v191
W a172,v180
W a173,v181
W a174,v182
W a175,v183
C v208,v208,v209
C v209,v210,v211
C v210,v216,v217
C v211,v218,v219
W a148,v208
W a149,v209
W a150,v210
W a151,v211
C v196,v196,v197
C v197,v198,v199
C v198,v204,v205
C v199,v206,v207
W a176,v196
W a177,v197
W a178,v198
W a179,v199
C v224,v224,v225
C v225,v226,v227
C v226,v232,v233
C v227,v234,v235
W a152,v224
W a153,v225
W a154,v226
W a155,v227
C v212,v212,v213
C v213,v214,v215
C v214,v220,v221
C v215,v222,v223
W a180,v212
W a181,v213
W a182,v214
W a183,v215
C v240,v240,v241
C v241,v242,v243
C v242,v248,v249
C v243,v250,v251
W a156,v240
W a157,v241
W a158,v242
W a159,v243
C v228,v228,v229
C v229,v230,v231
C v230,v236,v237
C v231,v238,v239
W a184,v228
W a185,v229
W a186,v230
W a187,v231
C v244,v244,v245
C v245,v246,v247
C v246,v252,v253
C v247,v254,v255
W a188,v244
W a189,v245
W a190,v246
W a191,v247
M v[124:127],a[116:119],a[52:55],v[124:127]
M v[124:127],a[112:115],a[48:51],v[124:127]
M v[124:127],a[108:111],a[44:47],v[124:127]
M v[124:127],a[104:107],a[40:43],v[124:127]
M v[124:127],a[100:103],a[36:39],v[124:127]
s_waitcnt lgkmcnt(0)
M v[124:127],a[96:99],a[32:35],v[124:127]
v_max_f32 v10, v26, v27
v_min_f32 v11, v26, v27
v_cmp_lt_f32 vcc, s31, v10
v_cmp_gt_f32 s[64:65], s24, v11
s_nop 0
s_or_b64 vcc, vcc, s[64:65]
s_cbranch_vccnz L_sth1
L_rth1:
M v[128:131],a[64:67],v[40:43],0
R a[96:99],v7,8192
R a[100:103],v7,9216
M v[128:131],a[68:71],v[56:59],v[128:131]
SA m0,s28,65536
E v18,v96
M v[132:135],a[68:71],v[60:63],0
buffer_load_dwordx4 v3, s[8:11], s21 offen offset:0 sc1 lds
M v[132:135],a[64:67],v[44:47],v[132:135]
R a[104:107],v7,10240
R a[108:111],v7,11264
M v[136:139],a[72:75],v[40:43],0
E v19,v97
M v[136:139],a[76:79],v[56:59],v[136:139]
AF v30,v26,v30
AF v31,v27,v31
M v[140:143],a[76:79],v[60:63],0
R a[112:115],v7,12288
R a[116:119],v7,13312
M v[140:143],a[72:75],v[44:47],v[140:143]
buffer_load_dwordx4 v3, s[8:11], s21 offen offset:1024 sc1 lds
M v[144:147],a[80:83],v[40:43],0
E v20,v98
M v[144:147],a[84:87],v[56:59],v[144:147]
R a[120:123],v7,14336
R a[124:127],v7,15360
M v[148:151],a[84:87],v[60:63],0
s_mov_b32 s40, 0
AF v28,v18,v19
C v48,v18,v19
M v[148:151],a[80:83],v[44:47],v[148:151]
s_mov_b32 s7, 0
buffer_load_dwordx4 v3, s[8:11], s21 offen offset:2048 sc1 lds
M v[152:155],a[88:91],v[40:43],0
s_and_b32 s39, s39, 1
E v21,v99
M v[152:155],a[92:95],v[56:59],v[152:155]
s_or_b32 s39, s39, 2
AF v28,v20,v28
C v49,v20,v21
M v[156:159],a[92:95],v[60:63],0
s_sub_u32 s27, 5, s42
AF v28,v21,v28
M v[156:159],a[88:91],v[44:47],v[156:159]
s_waitcnt lgkmcnt(0)
buffer_load_dwordx4 v3, s[8:11], s21 offen offset:3072 sc1 lds
M v[160:163],a[96:99],v[40:43],0
SA m0,s28,69632
R a[64:67],v7,16384
R a[68:71],v7,17408
M v[160:163],a[100:103],v[56:59],v[160:163]
E v22,v104
M v[164:167],a[100:103],v[60:63],0
E v23,v105
M v[164:167],a[96:99],v[44:47],v[164:167]
R a[72:75],v7,18432
R a[76:79],v7,19456
M v[168:171],a[104:107],v[40:43],0
buffer_load_dwordx4 v4, s[8:11], s21 offen offset:0 sc1 lds
M v[168:171],a[108:111],v[56:59],v[168:171]
AF v28,v22,v28
C v50,v22,v23
M v[172:175],a[108:111],v[60:63],0
R a[80:83],v7,20480
R a[84:87],v7,21504
M v[172:175],a[104:107],v[44:47],v[172:175]
buffer_load_dwordx4 v4, s[8:11], s21 offen offset:1024 sc1 lds
M v[176:179],a[112:115],v[40:43],0
E v24,v106
M v[176:179],a[116:119],v[56:59],v[176:179]
R a[88:91],v7,22528
R a[92:95],v7,23552
M v[180:183],a[116:119],v[60:63],0
buffer_load_dwordx4 v4, s[8:11], s21 offen offset:2048 sc1 lds
M v[180:183],a[112:115],v[44:47],v[180:183]
E v25,v107
M v[184:187],a[120:123],v[40:43],0
AF v28,v23,v28
AF v28,v24,v28
M v[184:187],a[124:127],v[56:59],v[184:187]
C v51,v24,v25
AF v28,v25,v28
M v[188:191],a[124:127],v[60:63],0
buffer_load_dwordx4 v4, s[8:11], s21 offen offset:3072 sc1 lds
M v[188:191],a[120:123],v[44:47],v[188:191]
s_waitcnt lgkmcnt(0)
E v18,v100
M v[192:195],a[64:67],v[40:43],0
SA s21,s21,32768
R a[96:99],v7,24576
R a[100:103],v7,25600
M v[192:195],a[68:71],v[56:59],v[192:195]
s_sub_u32 s22, s22, 1
E v19,v101
M v[196:199],a[68:71],v[60:63],0
s_cselect_b32 s21, s23, s21
AF v29,v18,v19
C v52,v18,v19
M v[196:199],a[64:67],v[44:47],v[196:199]
R a[104:107],v7,26624
R a[108:111],v7,27648
M v[200:203],a[72:75],v[40:43],0
M v[200:203],a[76:79],v[56:59],v[200:203]
E v20,v102
M v[204:207],a[76:79],v[60:63],0
R a[112:115],v7,28672
R a[116:119],v7,29696
M v[204:207],a[72:75],v[44:47],v[204:207]
M v[208:211],a[80:83],v[40:43],0
M v[208:211],a[84:87],v[56:59],v[208:211]
R a[120:123],v7,30720
R a[124:127],v7,31744
M v[212:215],a[84:87],v[60:63],0
E v21,v103
M v[212:215],a[80:83],v[44:47],v[212:215]
AF v29,v20,v29
C v53,v20,v21
M v[216:219],a[88:91],v[40:43],0
AF v29,v21,v29
M v[216:219],a[92:95],v[56:59],v[216:219]
E v22,v108
M v[220:223],a[92:95],v[60:63],0
s_waitcnt vmcnt(12) lgkmcnt(0)
M v[220:223],a[88:91],v[44:47],v[220:223]
s_barrier
M v[224:227],a[96:99],v[40:43],0
R a[64:67],v2,32768
R a[68:71],v2,33792
M v[224:227],a[100:103],v[56:59],v[224:227]
E v23,v109
M v[228:231],a[100:103],v[60:63],0
AF v29,v22,v29
C v54,v22,v23
M v[228:231],a[96:99],v[44:47],v[228:231]
R a[72:75],v2,34816
R a[76:79],v2,35840
M v[232:235],a[104:107],v[40:43],0
E v24,v110
M v[232:235],a[108:111],v[56:59],v[232:235]
AF v29,v23,v29
M v[236:239],a[108:111],v[60:63],0
R a[80:83],v2,36864
R a[84:87],v2,37888
M v[236:239],a[104:107],v[44:47],v[236:239]
M v[240:243],a[112:115],v[40:43],0
E v25,v111
M v[240:243],a[116:119],v[56:59],v[240:243]
R a[88:91],v2,38912
R a[92:95],v2,39936
M v[244:247],a[116:119],v[60:63],0
AF v29,v24,v29
C v55,v24,v25
M v[244:247],a[112:115],v[44:47],v[244:247]
AF v29,v25,v29
M v[248:251],a[120:123],v[40:43],0
M v[248:251],a[124:127],v[56:59],v[248:251]
M v[252:255],a[124:127],v[60:63],0
s_waitcnt lgkmcnt(0)
M v[252:255],a[120:123],v[44:47],v[252:255]
s_cmp_lg_u32 s27, 0
s_cbranch_scc1 L_loop_top
L_final_h:
s_waitcnt vmcnt(8) lgkmcnt(0)
s_barrier
R a[64:67],v7,32768
R a[68:71],v7,33792
R a[72:75],v7,34816
R a[76:79],v7,35840
R a[80:83],v7,36864
R a[84:87],v7,37888
R a[88:91],v7,38912
R a[92:95],v7,39936
v_lshrrev_b32 v14, 7, v7
v_mul_u32_u24 v14, 896, v14
v_lshrrev_b32 v15, 8, v7
v_lshlrev_b32 v15, 5, v15
v_xor_b32 v15, v15, v7
v_and_b32 v15, 0x70, v15
v_add_u32 v0, v14, v15
s_mul_i32 s38, s20, 57344
SA m0,s28,98304
SA s85,s38,0
E v18,v112
buffer_load_dwordx4 v0, s[12:15], s85 offen offset:0 lds
E v19,v113
E v20,v114
AF v28,v18,v28
SA s85,s38,6144
C v56,v18,v19
buffer_load_dwordx4 v0, s[12:15], s85 offen offset:1024 lds
E v21,v115
AF v28,v19,v28
E v22,v120
AF v28,v20,v28
SA s85,s38,12288
C v57,v20,v21
buffer_load_dwordx4 v0, s[12:15], s85 offen offset:2048 lds
E v23,v121
AF v28,v21,v28
E v24,v122
AF v28,v22,v28
SA s85,s38,18432
C v58,v22,v23
buffer_load_dwordx4 v0, s[12:15], s85 offen offset:3072 lds
E v25,v123
AF v28,v23,v28
E v18,v116
AF v28,v24,v28
SA m0,s28,102400
SA s85,s38,28672
C v59,v24,v25
buffer_load_dwordx4 v0, s[12:15], s85 offen offset:0 lds
E v19,v117
AF v28,v25,v28
E v20,v118
AF v29,v18,v29
SA s85,s38,34816
C v60,v18,v19
buffer_load_dwordx4 v0, s[12:15], s85 offen offset:1024 lds
E v21,v119
AF v29,v19,v29
E v22,v124
AF v29,v20,v29
SA s85,s38,40960
C v61,v20,v21
buffer_load_dwordx4 v0, s[12:15], s85 offen offset:2048 lds
E v23,v125
AF v29,v21,v29
E v24,v126
AF v29,v22,v29
SA s85,s38,47104
C v62,v22,v23
buffer_load_dwordx4 v0, s[12:15], s85 offen offset:3072 lds
SA s38,s38,128
E v25,v127
AF v29,v23,v29
AF v29,v24,v29
C v63,v24,v25
AF v29,v25,v29
v_max_f32 v10, v28, v29
v_cmp_lt_f32 vcc, s31, v10
s_nop 0
s_cbranch_vccnz L_stfh
L_rtfh:
AF v30,v28,v30
AF v31,v29,v31
v_mov_b32 v10, v32
v_mov_b32 v11, v36
v_mov_b32 v12, v30
v_mov_b32 v13, v31
buffer_store_dwordx4 v[10:13], v7, s[8:11], s90 offen sc1
s_waitcnt lgkmcnt(0)
M v[128:131],a[64:67],v[48:51],v[128:131]
SA m0,s28,65536
R a[96:99],v7,40960
R a[100:103],v7,41984
M v[128:131],a[68:71],v[56:59],v[128:131]
SA s85,s38,0
buffer_load_dwordx4 v0, s[12:15], s85 offen offset:0 lds
M v[132:135],a[68:71],v[60:63],v[132:135]
SA s85,s38,6144
v_lshrrev_b32 v16, 4, v7
v_lshrrev_b32 v14, 2, v16
M v[132:135],a[64:67],v[52:55],v[132:135]
R a[104:107],v7,43008
R a[108:111],v7,44032
M v[136:139],a[72:75],v[48:51],v[136:139]
buffer_load_dwordx4 v0, s[12:15], s85 offen offset:1024 lds
M v[136:139],a[76:79],v[56:59],v[136:139]
SA s85,s38,12288
v_lshlrev_b32 v14, 7, v14
v_and_b32 v15, 3, v16
M v[140:143],a[76:79],v[60:63],v[140:143]
R a[112:115],v7,45056
R a[116:119],v7,46080
M v[140:143],a[72:75],v[52:55],v[140:143]
buffer_load_dwordx4 v0, s[12:15], s85 offen offset:2048 lds
M v[144:147],a[80:83],v[48:51],v[144:147]
SA s85,s38,18432
v_lshl_add_u32 v14, v15, 3, v14
v_bfe_u32 v15, v16, 3, 2
M v[144:147],a[84:87],v[56:59],v[144:147]
R a[120:123],v7,47104
R a[124:127],v7,48128
M v[148:151],a[84:87],v[60:63],v[148:151]
buffer_load_dwordx4 v0, s[12:15], s85 offen offset:3072 lds
M v[148:151],a[80:83],v[52:55],v[148:151]
v_lshl_add_u32 v18, v15, 5, v14
v_xor_b32 v19, 32, v18
M v[152:155],a[88:91],v[48:51],v[152:155]
v_xor_b32 v20, 64, v18
v_xor_b32 v21, 0x60, v18
M v[152:155],a[92:95],v[56:59],v[152:155]
v_add_u32 v22, 0x10000, v18
v_add_u32 v23, 0x10000, v19
M v[156:159],a[92:95],v[60:63],v[156:159]
v_add_u32 v24, 0x10000, v20
v_add_u32 v25, 0x10000, v21
M v[156:159],a[88:91],v[52:55],v[156:159]
s_waitcnt lgkmcnt(0)
C v128,v128,v129
C v129,v130,v131
M v[160:163],a[96:99],v[48:51],v[160:163]
R a[64:67],v7,49152
R a[68:71],v7,50176
M v[160:163],a[100:103],v[56:59],v[160:163]
C v130,v136,v137
C v131,v138,v139
M v[164:167],a[100:103],v[60:63],v[164:167]
buffer_store_dwordx4 v[128:131], v7, s[8:11], s86 offen offset:0 sc1
M v[164:167],a[96:99],v[52:55],v[164:167]
R a[72:75],v7,51200
R a[76:79],v7,52224
M v[168:171],a[104:107],v[48:51],v[168:171]
C v132,v132,v133
C v133,v134,v135
M v[168:171],a[108:111],v[56:59],v[168:171]
C v134,v140,v141
C v135,v142,v143
M v[172:175],a[108:111],v[60:63],v[172:175]
R a[80:83],v7,53248
R a[84:87],v7,54272
M v[172:175],a[104:107],v[52:55],v[172:175]
buffer_store_dwordx4 v[132:135], v7, s[8:11], s88 offen offset:0 sc1
M v[176:179],a[112:115],v[48:51],v[176:179]
C v144,v144,v145
C v145,v146,v147
M v[176:179],a[116:119],v[56:59],v[176:179]
R a[88:91],v7,55296
R a[92:95],v7,56320
M v[180:183],a[116:119],v[60:63],v[180:183]
C v146,v152,v153
C v147,v154,v155
M v[180:183],a[112:115],v[52:55],v[180:183]
buffer_store_dwordx4 v[144:147], v7, s[8:11], s86 offen offset:1024 sc1
M v[184:187],a[120:123],v[48:51],v[184:187]
C v148,v148,v149
C v149,v150,v151
M v[184:187],a[124:127],v[56:59],v[184:187]
C v150,v156,v157
C v151,v158,v159
M v[188:191],a[124:127],v[60:63],v[188:191]
buffer_store_dwordx4 v[148:151], v7, s[8:11], s88 offen offset:1024 sc1
M v[188:191],a[120:123],v[52:55],v[188:191]
s_waitcnt lgkmcnt(0)
C v160,v160,v161
C v161,v162,v163
M v[192:195],a[64:67],v[48:51],v[192:195]
R a[96:99],v7,57344
R a[100:103],v7,58368
M v[192:195],a[68:71],v[56:59],v[192:195]
C v162,v168,v169
C v163,v170,v171
M v[196:199],a[68:71],v[60:63],v[196:199]
buffer_store_dwordx4 v[160:163], v7, s[8:11], s86 offen offset:2048 sc1
M v[196:199],a[64:67],v[52:55],v[196:199]
R a[104:107],v7,59392
R a[108:111],v7,60416
M v[200:203],a[72:75],v[48:51],v[200:203]
C v164,v164,v165
C v165,v166,v167
M v[200:203],a[76:79],v[56:59],v[200:203]
C v166,v172,v173
C v167,v174,v175
M v[204:207],a[76:79],v[60:63],v[204:207]
R a[112:115],v7,61440
R a[116:119],v7,62464
M v[204:207],a[72:75],v[52:55],v[204:207]
buffer_store_dwordx4 v[164:167], v7, s[8:11], s88 offen offset:2048 sc1
M v[208:211],a[80:83],v[48:51],v[208:211]
C v176,v176,v177
C v177,v178,v179
M v[208:211],a[84:87],v[56:59],v[208:211]
R a[120:123],v7,63488
R a[124:127],v7,64512
M v[212:215],a[84:87],v[60:63],v[212:215]
C v178,v184,v185
C v179,v186,v187
M v[212:215],a[80:83],v[52:55],v[212:215]
buffer_store_dwordx4 v[176:179], v7, s[8:11], s86 offen offset:3072 sc1
M v[216:219],a[88:91],v[48:51],v[216:219]
C v180,v180,v181
C v181,v182,v183
M v[216:219],a[92:95],v[56:59],v[216:219]
C v182,v188,v189
C v183,v190,v191
M v[220:223],a[92:95],v[60:63],v[220:223]
s_waitcnt vmcnt(12) lgkmcnt(0)
buffer_store_dwordx4 v[180:183], v7, s[8:11], s88 offen offset:3072 sc1
M v[220:223],a[88:91],v[52:55],v[220:223]
s_barrier
M v[224:227],a[96:99],v[48:51],v[224:227]
s_nop 0
T a[64:65],v22,32768
T a[66:67],v22,34816
M v[224:227],a[100:103],v[56:59],v[224:227]
T a[68:69],v22,36864
T a[70:71],v22,38912
M v[228:231],a[100:103],v[60:63],v[228:231]
C v192,v192,v193
C v193,v194,v195
M v[228:231],a[96:99],v[52:55],v[228:231]
T a[72:73],v22,40960
T a[74:75],v22,43008
M v[232:235],a[104:107],v[48:51],v[232:235]
T a[76:77],v22,45056
T a[78:79],v22,47104
M v[232:235],a[108:111],v[56:59],v[232:235]
C v194,v200,v201
C v195,v202,v203
M v[236:239],a[108:111],v[60:63],v[236:239]
T a[80:81],v22,49152
T a[82:83],v22,51200
M v[236:239],a[104:107],v[52:55],v[236:239]
T a[84:85],v22,53248
T a[86:87],v22,55296
M v[240:243],a[112:115],v[48:51],v[240:243]
buffer_store_dwordx4 v[192:195], v7, s[8:11], s87 offen offset:0 sc1
M v[240:243],a[116:119],v[56:59],v[240:243]
s_nop 0
T a[88:89],v22,57344
T a[90:91],v22,59392
M v[244:247],a[116:119],v[60:63],v[244:247]
T a[92:93],v22,61440
T a[94:95],v22,63488
M v[244:247],a[112:115],v[52:55],v[244:247]
C v196,v196,v197
C v197,v198,v199
M v[248:251],a[120:123],v[48:51],v[248:251]
C v198,v204,v205
C v199,v206,v207
M v[248:251],a[124:127],v[56:59],v[248:251]
buffer_store_dwordx4 v[196:199], v7, s[8:11], s89 offen offset:0 sc1
M v[252:255],a[124:127],v[60:63],v[252:255]
s_waitcnt lgkmcnt(0)
C v208,v208,v209
C v209,v210,v211
M v[252:255],a[120:123],v[52:55],v[252:255]
C v210,v216,v217
C v211,v218,v219
buffer_store_dwordx4 v[208:211], v7, s[8:11], s87 offen offset:1024 sc1
C v212,v212,v213
C v213,v214,v215
C v214,v220,v221
C v215,v222,v223
buffer_store_dwordx4 v[212:215], v7, s[8:11], s89 offen offset:1024 sc1
C v224,v224,v225
C v225,v226,v227
C v226,v232,v233
C v227,v234,v235
buffer_store_dwordx4 v[224:227], v7, s[8:11], s87 offen offset:2048 sc1
C v228,v228,v229
C v229,v230,v231
C v230,v236,v237
C v231,v238,v239
buffer_store_dwordx4 v[228:231], v7, s[8:11], s89 offen offset:2048 sc1
C v240,v240,v241
C v241,v242,v243
C v242,v248,v249
C v243,v250,v251
buffer_store_dwordx4 v[240:243], v7, s[8:11], s87 offen offset:3072 sc1
C v244,v244,v245
C v245,v246,v247
C v246,v252,v253
C v247,v254,v255
buffer_store_dwordx4 v[244:247], v7, s[8:11], s89 offen offset:3072 sc1
M v[64:67],a[64:67],a[128:131],0
s_nop 0
T a[96:97],v23,32768
T a[98:99],v23,34816
M v[64:67],a[68:71],a[132:135],v[64:67]
SA m0,s28,69632
T a[100:101],v23,36864
T a[102:103],v23,38912
M v[64:67],a[72:75],a[136:139],v[64:67]
SA s85,s38,28672
buffer_load_dwordx4 v0, s[12:15], s85 offen offset:0 lds
M v[64:67],a[76:79],a[140:143],v[64:67]
SA s85,s38,34816
T a[104:105],v23,40960
T a[106:107],v23,43008
M v[64:67],a[80:83],a[144:147],v[64:67]
SA s29,s33,0
T a[108:109],v23,45056
T a[110:111],v23,47104
M v[64:67],a[84:87],a[148:151],v[64:67]
SA s30,s33,14336
buffer_load_dwordx4 v0, s[12:15], s85 offen offset:1024 lds
M v[64:67],a[88:91],a[152:155],v[64:67]
SA s85,s38,40960
T a[112:113],v23,49152
T a[114:115],v23,51200
M v[64:67],a[92:95],a[156:159],v[64:67]
T a[116:117],v23,53248
T a[118:119],v23,55296
M v[68:71],a[92:95],a[188:191],0
buffer_load_dwordx4 v0, s[12:15], s85 offen offset:2048 lds
M v[68:71],a[88:91],a[184:187],v[68:71]
SA s85,s38,47104
T a[120:121],v23,57344
T a[122:123],v23,59392
M v[68:71],a[84:87],a[180:183],v[68:71]
T a[124:125],v23,61440
T a[126:127],v23,63488
M v[68:71],a[80:83],a[176:179],v[68:71]
buffer_load_dwordx4 v0, s[12:15], s85 offen offset:3072 lds
M v[68:71],a[76:79],a[172:175],v[68:71]
SA s38,s38,128
G v5,a192
G v6,a193
M v[68:71],a[72:75],a[168:171],v[68:71]
s_sub_u32 s64, 15, s42
M v[68:71],a[68:71],a[164:167],v[68:71]
s_min_u32 s64, s64, s42
M v[68:71],a[64:67],a[160:163],v[68:71]
s_waitcnt lgkmcnt(0)
M v[72:75],a[96:99],a[128:131],0
s_mul_i32 s45, s64, 8704
T a[64:65],v24,32768
T a[66:67],v24,34816
M v[72:75],a[100:103],a[132:135],v[72:75]
s_lshl_b32 s64, s41, 2
T a[68:69],v24,36864
T a[70:71],v24,38912
M v[72:75],a[104:107],a[136:139],v[72:75]
SA s45,s45,s64
M v[72:75],a[108:111],a[140:143],v[72:75]
s_lshl_b32 s64, s20, 8
T a[72:73],v24,40960
T a[74:75],v24,43008
M v[72:75],a[112:115],a[144:147],v[72:75]
SA s45,s45,s64
T a[76:77],v24,45056
T a[78:79],v24,47104
M v[72:75],a[116:119],a[148:151],v[72:75]
SA s45,s45,104992768
M v[72:75],a[120:123],a[152:155],v[72:75]
s_mov_b32 s64, 1024
T a[80:81],v24,49152
T a[82:83],v24,51200
M v[72:75],a[124:127],a[156:159],v[72:75]
s_mov_b32 s66, 4096
T a[84:85],v24,53248
T a[86:87],v24,55296
M v[76:79],a[124:127],a[188:191],0
s_cmp_lt_u32 s42, 8
M v[76:79],a[120:123],a[184:187],v[76:79]
s_cselect_b32 s64, 4352, s64
T a[88:89],v24,57344
T a[90:91],v24,59392
M v[76:79],a[116:119],a[180:183],v[76:79]
s_cselect_b32 s65, 0, 64
T a[92:93],v24,61440
T a[94:95],v24,63488
M v[76:79],a[112:115],a[176:179],v[76:79]
s_cselect_b32 s66, 536870912, s66
MF v64,v5,v64
MF v65,v5,v65
M v[76:79],a[108:111],a[172:175],v[76:79]
SA s3,s45,s64
MF v66,v5,v66
MF v67,v5,v67
M v[76:79],a[104:107],a[168:171],v[76:79]
SA s45,s45,s65
v_lshrrev_b32 v17, 5, v7
v_min_u32 v15, 1, v17
M v[76:79],a[100:103],a[164:167],v[76:79]
SA m0,s28,0
v_lshlrev_b32 v14, 3, v7
v_lshl_or_b32 v16, v15, 29, v14
M v[76:79],a[96:99],a[160:163],v[76:79]
s_waitcnt lgkmcnt(0)
v_cmp_eq_u32 vcc, 1, v17
v_add_u32 v14, s66, v14
M v[80:83],a[64:67],a[128:131],0
SA s85,s38,0
T a[96:97],v25,32768
T a[98:99],v25,34816
M v[80:83],a[68:71],a[132:135],v[80:83]
T a[100:101],v25,36864
T a[102:103],v25,38912
M v[80:83],a[72:75],a[136:139],v[80:83]
buffer_load_dwordx4 v0, s[12:15], s85 offen offset:0 lds
M v[80:83],a[76:79],a[140:143],v[80:83]
SA s85,s38,6144
T a[104:105],v25,40960
T a[106:107],v25,43008
M v[80:83],a[80:83],a[144:147],v[80:83]
T a[108:109],v25,45056
T a[110:111],v25,47104
M v[80:83],a[84:87],a[148:151],v[80:83]
buffer_load_dwordx4 v0, s[12:15], s85 offen offset:1024 lds
M v[80:83],a[88:91],a[152:155],v[80:83]
SA s85,s38,12288
T a[112:113],v25,49152
T a[114:115],v25,51200
M v[80:83],a[92:95],a[156:159],v[80:83]
T a[116:117],v25,53248
T a[118:119],v25,55296
M v[84:87],a[92:95],a[188:191],0
buffer_load_dwordx4 v0, s[12:15], s85 offen offset:2048 lds
M v[84:87],a[88:91],a[184:187],v[84:87]
SA s85,s38,18432
T a[120:121],v25,57344
T a[122:123],v25,59392
M v[84:87],a[84:87],a[180:183],v[84:87]
T a[124:125],v25,61440
T a[126:127],v25,63488
M v[84:87],a[80:83],a[176:179],v[84:87]
buffer_load_dwordx4 v0, s[12:15], s85 offen offset:3072 lds
M v[84:87],a[76:79],a[172:175],v[84:87]
SA m0,s28,4096
v_mov_b32 v15, 1
v_cndmask_b32 v17, v16, v14, vcc
M v[84:87],a[72:75],a[168:171],v[84:87]
SA s85,s38,28672
buffer_load_dwordx4 v0, s[12:15], s85 offen offset:0 lds
M v[84:87],a[68:71],a[164:167],v[84:87]
s_waitcnt vmcnt(5) lgkmcnt(0)
v_min_u32 v10, 1, v7
v_lshlrev_b32 v10, 29, v10
M v[84:87],a[64:67],a[160:163],v[84:87]
s_barrier
M v[88:91],a[96:99],a[128:131],0
SA s85,s38,34816
T a[64:65],v22,0
T a[66:67],v22,2048
M v[88:91],a[100:103],a[132:135],v[88:91]
T a[68:69],v22,4096
T a[70:71],v22,6144
M v[88:91],a[104:107],a[136:139],v[88:91]
buffer_load_dwordx4 v0, s[12:15], s85 offen offset:1024 lds
M v[88:91],a[108:111],a[140:143],v[88:91]
SA s85,s38,40960
T a[72:73],v22,8192
T a[74:75],v22,10240
M v[88:91],a[112:115],a[144:147],v[88:91]
T a[76:77],v22,12288
T a[78:79],v22,14336
M v[88:91],a[116:119],a[148:151],v[88:91]
buffer_load_dwordx4 v0, s[12:15], s85 offen offset:2048 lds
M v[88:91],a[120:123],a[152:155],v[88:91]
SA s85,s38,47104
T a[80:81],v22,16384
T a[82:83],v22,18432
M v[88:91],a[124:127],a[156:159],v[88:91]
T a[84:85],v22,20480
T a[86:87],v22,22528
M v[92:95],a[124:127],a[188:191],0
buffer_store_dword v15, v10, s[8:11], s47 offen sc1
M v[92:95],a[120:123],a[184:187],v[92:95]
s_nop 0
T a[88:89],v22,24576
T a[90:91],v22,26624
M v[92:95],a[116:119],a[180:183],v[92:95]
T a[92:93],v22,28672
T a[94:95],v22,30720
M v[92:95],a[112:115],a[176:179],v[92:95]
buffer_load_dwordx4 v0, s[12:15], s85 offen offset:3072 lds
M v[92:95],a[108:111],a[172:175],v[92:95]
SA s38,s38,128
MF v72,v5,v72
MF v73,v5,v73
M v[92:95],a[104:107],a[168:171],v[92:95]
SA m0,s28,131072
MF v74,v5,v74
MF v75,v5,v75
M v[92:95],a[100:103],a[164:167],v[92:95]
s_waitcnt lgkmcnt(0)
C v64,v64,v65
C v65,v66,v67
M v[92:95],a[96:99],a[160:163],v[92:95]
SA s85,s38,0
C v66,v72,v73
C v67,v74,v75
buffer_store_dwordx4 v[64:67], v7, s[8:11], s29 offen offset:0 sc1
buffer_load_dwordx4 v0, s[12:15], s85 offen offset:0 lds
v_add_u32 v40, 0x20000, v18
v_add_u32 v41, 0x20000, v19
v_add_u32 v42, 0x20000, v20
v_add_u32 v43, 0x20000, v21
SA s85,s38,6144
MF v68,v6,v68
MF v69,v6,v69
MF v70,v6,v70
MF v71,v6,v71
MF v76,v6,v76
MF v77,v6,v77
MF v78,v6,v78
MF v79,v6,v79
C v68,v68,v69
C v69,v70,v71
C v70,v76,v77
C v71,v78,v79
buffer_store_dwordx4 v[68:71], v7, s[8:11], s30 offen offset:0 sc1
buffer_load_dwordx4 v0, s[12:15], s85 offen offset:1024 lds
SA s85,s38,12288
buffer_load_dwordx4 v0, s[12:15], s85 offen offset:2048 lds
SA s85,s38,18432
buffer_load_dwordx4 v0, s[12:15], s85 offen offset:3072 lds
M v[96:99],a[64:67],a[128:131],0
s_nop 0
T a[96:97],v23,0
T a[98:99],v23,2048
M v[96:99],a[68:71],a[132:135],v[96:99]
SA m0,s28,135168
T a[100:101],v23,4096
T a[102:103],v23,6144
M v[96:99],a[72:75],a[136:139],v[96:99]
SA s85,s38,28672
buffer_load_dwordx4 v0, s[12:15], s85 offen offset:0 lds
M v[96:99],a[76:79],a[140:143],v[96:99]
SA s85,s38,34816
T a[104:105],v23,8192
T a[106:107],v23,10240
M v[96:99],a[80:83],a[144:147],v[96:99]
T a[108:109],v23,12288
T a[110:111],v23,14336
M v[96:99],a[84:87],a[148:151],v[96:99]
buffer_load_dwordx4 v0, s[12:15], s85 offen offset:1024 lds
M v[96:99],a[88:91],a[152:155],v[96:99]
SA s85,s38,40960
T a[112:113],v23,16384
T a[114:115],v23,18432
M v[96:99],a[92:95],a[156:159],v[96:99]
T a[116:117],v23,20480
T a[118:119],v23,22528
M v[100:103],a[92:95],a[188:191],0
buffer_load_dwordx4 v0, s[12:15], s85 offen offset:2048 lds
M v[100:103],a[88:91],a[184:187],v[100:103]
SA s85,s38,47104
T a[120:121],v23,24576
T a[122:123],v23,26624
M v[100:103],a[84:87],a[180:183],v[100:103]
T a[124:125],v23,28672
T a[126:127],v23,30720
M v[100:103],a[80:83],a[176:179],v[100:103]
buffer_load_dwordx4 v0, s[12:15], s85 offen offset:3072 lds
M v[100:103],a[76:79],a[172:175],v[100:103]
SA s38,s38,128
MF v80,v5,v80
MF v81,v5,v81
M v[100:103],a[72:75],a[168:171],v[100:103]
SA m0,s28,32768
MF v82,v5,v82
MF v83,v5,v83
M v[100:103],a[68:71],a[164:167],v[100:103]
SA s85,s38,0
buffer_load_dwordx4 v0, s[12:15], s85 offen offset:0 lds
M v[100:103],a[64:67],a[160:163],v[100:103]
s_waitcnt lgkmcnt(0)
MF v88,v5,v88
MF v89,v5,v89
M v[104:107],a[96:99],a[128:131],0
SA s85,s38,6144
T a[64:65],v24,0
T a[66:67],v24,2048
M v[104:107],a[100:103],a[132:135],v[104:107]
T a[68:69],v24,4096
T a[70:71],v24,6144
M v[104:107],a[104:107],a[136:139],v[104:107]
buffer_load_dwordx4 v0, s[12:15], s85 offen offset:1024 lds
M v[104:107],a[108:111],a[140:143],v[104:107]
SA s85,s38,12288
T a[72:73],v24,8192
T a[74:75],v24,10240
M v[104:107],a[112:115],a[144:147],v[104:107]
T a[76:77],v24,12288
T a[78:79],v24,14336
M v[104:107],a[116:119],a[148:151],v[104:107]
buffer_load_dwordx4 v0, s[12:15], s85 offen offset:2048 lds
M v[104:107],a[120:123],a[152:155],v[104:107]
SA s85,s38,18432
T a[80:81],v24,16384
T a[82:83],v24,18432
M v[104:107],a[124:127],a[156:159],v[104:107]
T a[84:85],v24,20480
T a[86:87],v24,22528
M v[108:111],a[124:127],a[188:191],0
buffer_load_dwordx4 v0, s[12:15], s85 offen offset:3072 lds
M v[108:111],a[120:123],a[184:187],v[108:111]
SA m0,s28,36864
T a[88:89],v24,24576
T a[90:91],v24,26624
M v[108:111],a[116:119],a[180:183],v[108:111]
SA s85,s38,28672
T a[92:93],v24,28672
T a[94:95],v24,30720
M v[108:111],a[112:115],a[176:179],v[108:111]
buffer_load_dwordx4 v0, s[12:15], s85 offen offset:0 lds
M v[108:111],a[108:111],a[172:175],v[108:111]
SA s85,s38,34816
MF v90,v5,v90
MF v91,v5,v91
M v[108:111],a[104:107],a[168:171],v[108:111]
C v80,v80,v81
C v81,v82,v83
M v[108:111],a[100:103],a[164:167],v[108:111]
buffer_load_dwordx4 v0, s[12:15], s85 offen offset:1024 lds
M v[108:111],a[96:99],a[160:163],v[108:111]
s_waitcnt lgkmcnt(0)
C v82,v88,v89
C v83,v90,v91
M v[112:115],a[64:67],a[128:131],0
SA s85,s38,40960
T a[96:97],v25,0
T a[98:99],v25,2048
M v[112:115],a[68:71],a[132:135],v[112:115]
T a[100:101],v25,4096
T a[102:103],v25,6144
M v[112:115],a[72:75],a[136:139],v[112:115]
buffer_store_dwordx4 v[80:83], v7, s[8:11], s29 offen offset:1024 sc1
M v[112:115],a[76:79],a[140:143],v[112:115]
s_nop 0
T a[104:105],v25,8192
T a[106:107],v25,10240
M v[112:115],a[80:83],a[144:147],v[112:115]
T a[108:109],v25,12288
T a[110:111],v25,14336
M v[112:115],a[84:87],a[148:151],v[112:115]
buffer_load_dwordx4 v0, s[12:15], s85 offen offset:2048 lds
M v[112:115],a[88:91],a[152:155],v[112:115]
SA s85,s38,47104
T a[112:113],v25,16384
T a[114:115],v25,18432
M v[112:115],a[92:95],a[156:159],v[112:115]
T a[116:117],v25,20480
T a[118:119],v25,22528
M v[116:119],a[92:95],a[188:191],0
buffer_load_dwordx4 v0, s[12:15], s85 offen offset:3072 lds
M v[116:119],a[88:91],a[184:187],v[116:119]
SA s38,s38,128
T a[120:121],v25,24576
T a[122:123],v25,26624
M v[116:119],a[84:87],a[180:183],v[116:119]
SA m0,s28,98304
T a[124:125],v25,28672
T a[126:127],v25,30720
M v[116:119],a[80:83],a[176:179],v[116:119]
SA s85,s38,0
buffer_load_dwordx4 v0, s[12:15], s85 offen offset:0 lds
M v[116:119],a[76:79],a[172:175],v[116:119]
SA s85,s38,6144
MF v84,v6,v84
MF v85,v6,v85
M v[116:119],a[72:75],a[168:171],v[116:119]
buffer_load_dwordx4 v0, s[12:15], s85 offen offset:1024 lds
M v[116:119],a[68:71],a[164:167],v[116:119]
s_waitcnt vmcnt(21) lgkmcnt(0)
MF v86,v6,v86
MF v87,v6,v87
M v[116:119],a[64:67],a[160:163],v[116:119]
s_barrier
M v[120:123],a[96:99],a[128:131],0
SA s85,s38,12288
T a[64:65],v18,0
T a[66:67],v18,2048
M v[120:123],a[100:103],a[132:135],v[120:123]
T a[68:69],v18,4096
T a[70:71],v18,6144
M v[120:123],a[104:107],a[136:139],v[120:123]
buffer_load_dwordx4 v0, s[12:15], s85 offen offset:2048 lds
M v[120:123],a[108:111],a[140:143],v[120:123]
SA s85,s38,18432
T a[72:73],v18,8192
T a[74:75],v18,10240
M v[120:123],a[112:115],a[144:147],v[120:123]
T a[76:77],v18,12288
T a[78:79],v18,14336
M v[120:123],a[116:119],a[148:151],v[120:123]
buffer_load_dwordx4 v0, s[12:15], s85 offen offset:3072 lds
M v[120:123],a[120:123],a[152:155],v[120:123]
s_nop 0
T a[80:81],v18,16384
T a[82:83],v18,18432
M v[120:123],a[124:127],a[156:159],v[120:123]
T a[84:85],v18,20480
T a[86:87],v18,22528
M v[124:127],a[124:127],a[188:191],0
MF v92,v6,v92
MF v93,v6,v93
M v[124:127],a[120:123],a[184:187],v[124:127]
T a[88:89],v18,24576
T a[90:91],v18,26624
M v[124:127],a[116:119],a[180:183],v[124:127]
T a[92:93],v18,28672
T a[94:95],v18,30720
M v[124:127],a[112:115],a[176:179],v[124:127]
MF v94,v6,v94
MF v95,v6,v95
M v[124:127],a[108:111],a[172:175],v[124:127]
C v84,v84,v85
C v85,v86,v87
M v[124:127],a[104:107],a[168:171],v[124:127]
C v86,v92,v93
C v87,v94,v95
M v[124:127],a[100:103],a[164:167],v[124:127]
s_waitcnt lgkmcnt(0)
buffer_store_dwordx4 v[84:87], v7, s[8:11], s30 offen offset:1024 sc1
M v[124:127],a[96:99],a[160:163],v[124:127]
SA s29,s33,2048
SA s30,s33,16384
MF v96,v5,v96
MF v97,v5,v97
MF v98,v5,v98
MF v99,v5,v99
MF v104,v5,v104
MF v105,v5,v105
MF v106,v5,v106
MF v107,v5,v107
C v96,v96,v97
C v97,v98,v99
C v98,v104,v105
C v99,v106,v107
buffer_store_dwordx4 v[96:99], v7, s[8:11], s29 offen offset:0 sc1
MF v100,v6,v100
MF v101,v6,v101
MF v102,v6,v102
MF v103,v6,v103
MF v108,v6,v108
MF v109,v6,v109
MF v110,v6,v110
MF v111,v6,v111
C v100,v100,v101
C v101,v102,v103
C v102,v108,v109
C v103,v110,v111
buffer_store_dwordx4 v[100:103], v7, s[8:11], s30 offen offset:0 sc1
M v[64:67],a[64:67],a[128:131],0
s_nop 0
T a[96:97],v19,0
T a[98:99],v19,2048
M v[64:67],a[68:71],a[132:135],v[64:67]
SA m0,s28,102400
T a[100:101],v19,4096
T a[102:103],v19,6144
M v[64:67],a[72:75],a[136:139],v[64:67]
SA s85,s38,28672
buffer_load_dwordx4 v0, s[12:15], s85 offen offset:0 lds
M v[64:67],a[76:79],a[140:143],v[64:67]
SA s85,s38,34816
T a[104:105],v19,8192
T a[106:107],v19,10240
M v[64:67],a[80:83],a[144:147],v[64:67]
T a[108:109],v19,12288
T a[110:111],v19,14336
M v[64:67],a[84:87],a[148:151],v[64:67]
buffer_load_dwordx4 v0, s[12:15], s85 offen offset:1024 lds
M v[64:67],a[88:91],a[152:155],v[64:67]
s_nop 0
T a[112:113],v19,16384
T a[114:115],v19,18432
M v[64:67],a[92:95],a[156:159],v[64:67]
SA s85,s38,40960
T a[116:117],v19,20480
T a[118:119],v19,22528
M v[68:71],a[92:95],a[188:191],0
buffer_load_dwordx4 v0, s[12:15], s85 offen offset:2048 lds
M v[68:71],a[88:91],a[184:187],v[68:71]
s_nop 0
T a[120:121],v19,24576
T a[122:123],v19,26624
M v[68:71],a[84:87],a[180:183],v[68:71]
T a[124:125],v19,28672
T a[126:127],v19,30720
M v[68:71],a[80:83],a[176:179],v[68:71]
SA s85,s38,47104
MF v112,v5,v112
MF v113,v5,v113
M v[68:71],a[76:79],a[172:175],v[68:71]
buffer_load_dwordx4 v0, s[12:15], s85 offen offset:3072 lds
M v[68:71],a[72:75],a[168:171],v[68:71]
SA s38,s38,128
MF v114,v5,v114
MF v115,v5,v115
M v[68:71],a[68:71],a[164:167],v[68:71]
SA m0,s28,65536
MF v120,v5,v120
MF v121,v5,v121
M v[68:71],a[64:67],a[160:163],v[68:71]
s_waitcnt lgkmcnt(0)
MF v122,v5,v122
MF v123,v5,v123
M v[72:75],a[96:99],a[128:131],0
SA s85,s38,0
T a[64:65],v20,0
T a[66:67],v20,2048
M v[72:75],a[100:103],a[132:135],v[72:75]
T a[68:69],v20,4096
T a[70:71],v20,6144
M v[72:75],a[104:107],a[136:139],v[72:75]
buffer_load_dwordx4 v0, s[12:15], s85 offen offset:0 lds
M v[72:75],a[108:111],a[140:143],v[72:75]
SA s85,s38,6144
T a[72:73],v20,8192
T a[74:75],v20,10240
M v[72:75],a[112:115],a[144:147],v[72:75]
T a[76:77],v20,12288
T a[78:79],v20,14336
M v[72:75],a[116:119],a[148:151],v[72:75]
buffer_load_dwordx4 v0, s[12:15], s85 offen offset:1024 lds
M v[72:75],a[120:123],a[152:155],v[72:75]
SA s85,s38,12288
T a[80:81],v20,16384
T a[82:83],v20,18432
M v[72:75],a[124:127],a[156:159],v[72:75]
T a[84:85],v20,20480
T a[86:87],v20,22528
M v[76:79],a[124:127],a[188:191],0
buffer_load_dwordx4 v0, s[12:15], s85 offen offset:2048 lds
M v[76:79],a[120:123],a[184:187],v[76:79]
SA s85,s38,18432
T a[88:89],v20,24576
T a[90:91],v20,26624
M v[76:79],a[116:119],a[180:183],v[76:79]
T a[92:93],v20,28672
T a[94:95],v20,30720
M v[76:79],a[112:115],a[176:179],v[76:79]
buffer_load_dwordx4 v0, s[12:15], s85 offen offset:3072 lds
M v[76:79],a[108:111],a[172:175],v[76:79]
SA m0,s28,69632
C v112,v112,v113
C v113,v114,v115
M v[76:79],a[104:107],a[168:171],v[76:79]
SA s85,s38,28672
C v114,v120,v121
C v115,v122,v123
M v[76:79],a[100:103],a[164:167],v[76:79]
buffer_store_dwordx4 v[112:115], v7, s[8:11], s29 offen offset:1024 sc1
M v[76:79],a[96:99],a[160:163],v[76:79]
s_waitcnt lgkmcnt(0)
MF v116,v6,v116
MF v117,v6,v117
M v[80:83],a[64:67],a[128:131],0
T a[96:97],v21,0
T a[98:99],v21,2048
M v[80:83],a[68:71],a[132:135],v[80:83]
T a[100:101],v21,4096
T a[102:103],v21,6144
M v[80:83],a[72:75],a[136:139],v[80:83]
buffer_load_dwordx4 v0, s[12:15], s85 offen offset:0 lds
M v[80:83],a[76:79],a[140:143],v[80:83]
SA s85,s38,34816
T a[104:105],v21,8192
T a[106:107],v21,10240
M v[80:83],a[80:83],a[144:147],v[80:83]
T a[108:109],v21,12288
T a[110:111],v21,14336
M v[80:83],a[84:87],a[148:151],v[80:83]
buffer_load_dwordx4 v0, s[12:15], s85 offen offset:1024 lds
M v[80:83],a[88:91],a[152:155],v[80:83]
SA s85,s38,40960
T a[112:113],v21,16384
T a[114:115],v21,18432
M v[80:83],a[92:95],a[156:159],v[80:83]
T a[116:117],v21,20480
T a[118:119],v21,22528
M v[84:87],a[92:95],a[188:191],0
buffer_load_dwordx4 v0, s[12:15], s85 offen offset:2048 lds
M v[84:87],a[88:91],a[184:187],v[84:87]
SA s85,s38,47104
T a[120:121],v21,24576
T a[122:123],v21,26624
M v[84:87],a[84:87],a[180:183],v[84:87]
T a[124:125],v21,28672
T a[126:127],v21,30720
M v[84:87],a[80:83],a[176:179],v[84:87]
buffer_load_dwordx4 v0, s[12:15], s85 offen offset:3072 lds
M v[84:87],a[76:79],a[172:175],v[84:87]
MF v118,v6,v118
MF v119,v6,v119
M v[84:87],a[72:75],a[168:171],v[84:87]
SA s38,s38,128
MF v124,v6,v124
MF v125,v6,v125
M v[84:87],a[68:71],a[164:167],v[84:87]
s_waitcnt vmcnt(29) lgkmcnt(0)
MF v126,v6,v126
MF v127,v6,v127
M v[84:87],a[64:67],a[160:163],v[84:87]
s_barrier
M v[88:91],a[96:99],a[128:131],0
s_nop 0
T a[64:65],v40,0
T a[66:67],v40,2048
M v[88:91],a[100:103],a[132:135],v[88:91]
T a[68:69],v40,4096
T a[70:71],v40,6144
M v[88:91],a[104:107],a[136:139],v[88:91]
C v116,v116,v117
C v117,v118,v119
M v[88:91],a[108:111],a[140:143],v[88:91]
T a[72:73],v40,8192
T a[74:75],v40,10240
M v[88:91],a[112:115],a[144:147],v[88:91]
T a[76:77],v40,12288
T a[78:79],v40,14336
M v[88:91],a[116:119],a[148:151],v[88:91]
C v118,v124,v125
C v119,v126,v127
M v[88:91],a[120:123],a[152:155],v[88:91]
T a[80:81],v40,16384
T a[82:83],v40,18432
M v[88:91],a[124:127],a[156:159],v[88:91]
T a[84:85],v40,20480
T a[86:87],v40,22528
M v[92:95],a[124:127],a[188:191],0
buffer_store_dwordx4 v[116:119], v7, s[8:11], s30 offen offset:1024 sc1
M v[92:95],a[120:123],a[184:187],v[92:95]
SA s29,s33,4096
T a[88:89],v40,24576
T a[90:91],v40,26624
M v[92:95],a[116:119],a[180:183],v[92:95]
SA s30,s33,18432
T a[92:93],v40,28672
T a[94:95],v40,30720
M v[92:95],a[112:115],a[176:179],v[92:95]
MF v64,v5,v64
MF v65,v5,v65
M v[92:95],a[108:111],a[172:175],v[92:95]
MF v66,v5,v66
MF v67,v5,v67
M v[92:95],a[104:107],a[168:171],v[92:95]
MF v72,v5,v72
MF v73,v5,v73
M v[92:95],a[100:103],a[164:167],v[92:95]
s_waitcnt lgkmcnt(0)
MF v74,v5,v74
MF v75,v5,v75
M v[92:95],a[96:99],a[160:163],v[92:95]
C v64,v64,v65
C v65,v66,v67
C v66,v72,v73
C v67,v74,v75
buffer_store_dwordx4 v[64:67], v7, s[8:11], s29 offen offset:0 sc1
MF v68,v6,v68
MF v69,v6,v69
MF v70,v6,v70
MF v71,v6,v71
MF v76,v6,v76
MF v77,v6,v77
MF v78,v6,v78
MF v79,v6,v79
C v68,v68,v69
C v69,v70,v71
C v70,v76,v77
C v71,v78,v79
buffer_store_dwordx4 v[68:71], v7, s[8:11], s30 offen offset:0 sc1
M v[96:99],a[64:67],a[128:131],0
s_nop 0
T a[96:97],v41,0
T a[98:99],v41,2048
M v[96:99],a[68:71],a[132:135],v[96:99]
T a[100:101],v41,4096
T a[102:103],v41,6144
M v[96:99],a[72:75],a[136:139],v[96:99]
MF v80,v5,v80
MF v81,v5,v81
M v[96:99],a[76:79],a[140:143],v[96:99]
T a[104:105],v41,8192
T a[106:107],v41,10240
M v[96:99],a[80:83],a[144:147],v[96:99]
T a[108:109],v41,12288
T a[110:111],v41,14336
M v[96:99],a[84:87],a[148:151],v[96:99]
MF v82,v5,v82
MF v83,v5,v83
M v[96:99],a[88:91],a[152:155],v[96:99]
T a[112:113],v41,16384
T a[114:115],v41,18432
M v[96:99],a[92:95],a[156:159],v[96:99]
T a[116:117],v41,20480
T a[118:119],v41,22528
M v[100:103],a[92:95],a[188:191],0
MF v88,v5,v88
MF v89,v5,v89
M v[100:103],a[88:91],a[184:187],v[100:103]
T a[120:121],v41,24576
T a[122:123],v41,26624
M v[100:103],a[84:87],a[180:183],v[100:103]
T a[124:125],v41,28672
T a[126:127],v41,30720
M v[100:103],a[80:83],a[176:179],v[100:103]
MF v90,v5,v90
MF v91,v5,v91
M v[100:103],a[76:79],a[172:175],v[100:103]
C v80,v80,v81
C v81,v82,v83
M v[100:103],a[72:75],a[168:171],v[100:103]
C v82,v88,v89
C v83,v90,v91
M v[100:103],a[68:71],a[164:167],v[100:103]
buffer_store_dwordx4 v[80:83], v7, s[8:11], s29 offen offset:1024 sc1
M v[100:103],a[64:67],a[160:163],v[100:103]
s_waitcnt lgkmcnt(0)
MF v84,v6,v84
MF v85,v6,v85
M v[104:107],a[96:99],a[128:131],0
T a[64:65],v42,0
T a[66:67],v42,2048
M v[104:107],a[100:103],a[132:135],v[104:107]
T a[68:69],v42,4096
T a[70:71],v42,6144
M v[104:107],a[104:107],a[136:139],v[104:107]
MF v86,v6,v86
MF v87,v6,v87
M v[104:107],a[108:111],a[140:143],v[104:107]
T a[72:73],v42,8192
T a[74:75],v42,10240
M v[104:107],a[112:115],a[144:147],v[104:107]
T a[76:77],v42,12288
T a[78:79],v42,14336
M v[104:107],a[116:119],a[148:151],v[104:107]
MF v92,v6,v92
MF v93,v6,v93
M v[104:107],a[120:123],a[152:155],v[104:107]
T a[80:81],v42,16384
T a[82:83],v42,18432
M v[104:107],a[124:127],a[156:159],v[104:107]
T a[84:85],v42,20480
T a[86:87],v42,22528
M v[108:111],a[124:127],a[188:191],0
MF v94,v6,v94
MF v95,v6,v95
M v[108:111],a[120:123],a[184:187],v[108:111]
T a[88:89],v42,24576
T a[90:91],v42,26624
M v[108:111],a[116:119],a[180:183],v[108:111]
T a[92:93],v42,28672
T a[94:95],v42,30720
M v[108:111],a[112:115],a[176:179],v[108:111]
C v84,v84,v85
C v85,v86,v87
M v[108:111],a[108:111],a[172:175],v[108:111]
C v86,v92,v93
C v87,v94,v95
M v[108:111],a[104:107],a[168:171],v[108:111]
buffer_store_dwordx4 v[84:87], v7, s[8:11], s30 offen offset:1024 sc1
M v[108:111],a[100:103],a[164:167],v[108:111]
SA s29,s33,6144
M v[108:111],a[96:99],a[160:163],v[108:111]
s_waitcnt lgkmcnt(0)
M v[112:115],a[64:67],a[128:131],0
SA s30,s33,20480
T a[96:97],v43,0
T a[98:99],v43,2048
M v[112:115],a[68:71],a[132:135],v[112:115]
T a[100:101],v43,4096
T a[102:103],v43,6144
M v[112:115],a[72:75],a[136:139],v[112:115]
MF v96,v5,v96
MF v97,v5,v97
M v[112:115],a[76:79],a[140:143],v[112:115]
T a[104:105],v43,8192
T a[106:107],v43,10240
M v[112:115],a[80:83],a[144:147],v[112:115]
T a[108:109],v43,12288
T a[110:111],v43,14336
M v[112:115],a[84:87],a[148:151],v[112:115]
MF v98,v5,v98
MF v99,v5,v99
M v[112:115],a[88:91],a[152:155],v[112:115]
T a[112:113],v43,16384
T a[114:115],v43,18432
M v[112:115],a[92:95],a[156:159],v[112:115]
T a[116:117],v43,20480
T a[118:119],v43,22528
M v[116:119],a[92:95],a[188:191],0
MF v104,v5,v104
MF v105,v5,v105
M v[116:119],a[88:91],a[184:187],v[116:119]
T a[120:121],v43,24576
T a[122:123],v43,26624
M v[116:119],a[84:87],a[180:183],v[116:119]
T a[124:125],v43,28672
T a[126:127],v43,30720
M v[116:119],a[80:83],a[176:179],v[116:119]
MF v106,v5,v106
MF v107,v5,v107
M v[116:119],a[76:79],a[172:175],v[116:119]
C v96,v96,v97
C v97,v98,v99
M v[116:119],a[72:75],a[168:171],v[116:119]
C v98,v104,v105
C v99,v106,v107
M v[116:119],a[68:71],a[164:167],v[116:119]
s_waitcnt vmcnt(25) lgkmcnt(0)
buffer_store_dwordx4 v[96:99], v7, s[8:11], s29 offen offset:0 sc1
M v[116:119],a[64:67],a[160:163],v[116:119]
s_barrier
M v[120:123],a[96:99],a[128:131],0
s_nop 0
T a[64:65],v18,32768
T a[66:67],v18,34816
M v[120:123],a[100:103],a[132:135],v[120:123]
T a[68:69],v18,36864
T a[70:71],v18,38912
M v[120:123],a[104:107],a[136:139],v[120:123]
MF v100,v6,v100
MF v101,v6,v101
M v[120:123],a[108:111],a[140:143],v[120:123]
T a[72:73],v18,40960
T a[74:75],v18,43008
M v[120:123],a[112:115],a[144:147],v[120:123]
T a[76:77],v18,45056
T a[78:79],v18,47104
M v[120:123],a[116:119],a[148:151],v[120:123]
MF v102,v6,v102
MF v103,v6,v103
M v[120:123],a[120:123],a[152:155],v[120:123]
T a[80:81],v18,49152
T a[82:83],v18,51200
M v[120:123],a[124:127],a[156:159],v[120:123]
T a[84:85],v18,53248
T a[86:87],v18,55296
M v[124:127],a[124:127],a[188:191],0
MF v108,v6,v108
MF v109,v6,v109
M v[124:127],a[120:123],a[184:187],v[124:127]
T a[88:89],v18,57344
T a[90:91],v18,59392
M v[124:127],a[116:119],a[180:183],v[124:127]
T a[92:93],v18,61440
T a[94:95],v18,63488
M v[124:127],a[112:115],a[176:179],v[124:127]
MF v110,v6,v110
MF v111,v6,v111
M v[124:127],a[108:111],a[172:175],v[124:127]
C v100,v100,v101
C v101,v102,v103
M v[124:127],a[104:107],a[168:171],v[124:127]
C v102,v108,v109
C v103,v110,v111
M v[124:127],a[100:103],a[164:167],v[124:127]
s_waitcnt lgkmcnt(0)
buffer_store_dwordx4 v[100:103], v7, s[8:11], s30 offen offset:0 sc1
M v[124:127],a[96:99],a[160:163],v[124:127]
M v[64:67],a[64:67],a[128:131],0
s_nop 0
T a[96:97],v19,32768
T a[98:99],v19,34816
M v[64:67],a[68:71],a[132:135],v[64:67]
T a[100:101],v19,36864
T a[102:103],v19,38912
M v[64:67],a[72:75],a[136:139],v[64:67]
v_lshrrev_b32 v32, 4, v7
MF v112,v5,v112
M v[64:67],a[76:79],a[140:143],v[64:67]
s_lshr_b32 s74, s41, 3
T a[104:105],v19,40960
T a[106:107],v19,43008
M v[64:67],a[80:83],a[144:147],v[64:67]
s_lshl_b32 s64, s42, 1
T a[108:109],v19,45056
T a[110:111],v19,47104
M v[64:67],a[84:87],a[148:151],v[64:67]
SA s46,s64,s74
MF v113,v5,v113
MF v114,v5,v114
M v[64:67],a[88:91],a[152:155],v[64:67]
s_mul_i32 s46, s46, 4352
T a[112:113],v19,49152
T a[114:115],v19,51200
M v[64:67],a[92:95],a[156:159],v[64:67]
s_and_b32 s72, s41, 7
T a[116:117],v19,53248
T a[118:119],v19,55296
M v[68:71],a[92:95],a[188:191],0
s_lshl_b32 s65, s72, 7
MF v115,v5,v115
MF v120,v5,v120
M v[68:71],a[88:91],a[184:187],v[68:71]
SA s46,s46,s65
T a[120:121],v19,57344
T a[122:123],v19,59392
M v[68:71],a[84:87],a[180:183],v[68:71]
SA s46,s46,104992768
T a[124:125],v19,61440
T a[126:127],v19,63488
M v[68:71],a[80:83],a[176:179],v[68:71]
v_and_b32 v33, 31, v32
MF v121,v5,v121
M v[68:71],a[76:79],a[172:175],v[68:71]
MF v122,v5,v122
MF v123,v5,v123
M v[68:71],a[72:75],a[168:171],v[68:71]
C v112,v112,v113
C v113,v114,v115
M v[68:71],a[68:71],a[164:167],v[68:71]
C v114,v120,v121
C v115,v122,v123
M v[68:71],a[64:67],a[160:163],v[68:71]
s_waitcnt lgkmcnt(0)
buffer_store_dwordx4 v[112:115], v7, s[8:11], s29 offen offset:1024 sc1
M v[72:75],a[96:99],a[128:131],0
s_nop 0
T a[64:65],v20,32768
T a[66:67],v20,34816
M v[72:75],a[100:103],a[132:135],v[72:75]
T a[68:69],v20,36864
T a[70:71],v20,38912
M v[72:75],a[104:107],a[136:139],v[72:75]
MF v116,v6,v116
MF v117,v6,v117
M v[72:75],a[108:111],a[140:143],v[72:75]
T a[72:73],v20,40960
T a[74:75],v20,43008
M v[72:75],a[112:115],a[144:147],v[72:75]
T a[76:77],v20,45056
T a[78:79],v20,47104
M v[72:75],a[116:119],a[148:151],v[72:75]
MF v118,v6,v118
MF v119,v6,v119
M v[72:75],a[120:123],a[152:155],v[72:75]
T a[80:81],v20,49152
T a[82:83],v20,51200
M v[72:75],a[124:127],a[156:159],v[72:75]
T a[84:85],v20,53248
T a[86:87],v20,55296
M v[76:79],a[124:127],a[188:191],0
MF v124,v6,v124
MF v125,v6,v125
M v[76:79],a[120:123],a[184:187],v[76:79]
T a[88:89],v20,57344
T a[90:91],v20,59392
M v[76:79],a[116:119],a[180:183],v[76:79]
T a[92:93],v20,61440
T a[94:95],v20,63488
M v[76:79],a[112:115],a[176:179],v[76:79]
MF v126,v6,v126
MF v127,v6,v127
M v[76:79],a[108:111],a[172:175],v[76:79]
C v116,v116,v117
C v117,v118,v119
M v[76:79],a[104:107],a[168:171],v[76:79]
C v118,v124,v125
C v119,v126,v127
M v[76:79],a[100:103],a[164:167],v[76:79]
buffer_store_dwordx4 v[116:119], v7, s[8:11], s30 offen offset:1024 sc1
M v[76:79],a[96:99],a[160:163],v[76:79]
s_waitcnt lgkmcnt(0)
v_lshlrev_b32 v33, 2, v33
M v[80:83],a[64:67],a[128:131],0
SA s29,s33,8192
T a[96:97],v21,32768
T a[98:99],v21,34816
M v[80:83],a[68:71],a[132:135],v[80:83]
SA s30,s33,22528
T a[100:101],v21,36864
T a[102:103],v21,38912
M v[80:83],a[72:75],a[136:139],v[80:83]
s_lshl_b32 s65, s41, 7
MF v64,v5,v64
MF v65,v5,v65
M v[80:83],a[76:79],a[140:143],v[80:83]
SA s65,s65,104890368
T a[104:105],v21,40960
T a[106:107],v21,43008
M v[80:83],a[80:83],a[144:147],v[80:83]
T a[108:109],v21,45056
T a[110:111],v21,47104
M v[80:83],a[84:87],a[148:151],v[80:83]
buffer_load_dword v31, v33, s[8:11], s65 offen sc1
M v[80:83],a[88:91],a[152:155],v[80:83]
s_nop 0
T a[112:113],v21,49152
T a[114:115],v21,51200
M v[80:83],a[92:95],a[156:159],v[80:83]
T a[116:117],v21,53248
T a[118:119],v21,55296
M v[84:87],a[92:95],a[188:191],0
v_bfe_u32 v34, v32, 4, 1
v_lshlrev_b32 v34, 1, v34
M v[84:87],a[88:91],a[184:187],v[84:87]
T a[120:121],v21,57344
T a[122:123],v21,59392
M v[84:87],a[84:87],a[180:183],v[84:87]
T a[124:125],v21,61440
T a[126:127],v21,63488
M v[84:87],a[80:83],a[176:179],v[84:87]
v_lshrrev_b32 v35, 5, v32
v_add_u32 v34, v34, v35
M v[84:87],a[76:79],a[172:175],v[84:87]
s_mov_b32 s52, s96
MF v66,v5,v66
MF v67,v5,v67
M v[84:87],a[72:75],a[168:171],v[84:87]
s_and_b32 s53, s97, 0xffff
MF v72,v5,v72
MF v73,v5,v73
M v[84:87],a[68:71],a[164:167],v[84:87]
s_waitcnt vmcnt(19) lgkmcnt(0)
MF v74,v5,v74
MF v75,v5,v75
M v[84:87],a[64:67],a[160:163],v[84:87]
s_barrier
M v[88:91],a[96:99],a[128:131],0
s_mov_b32 s54, 1835008
T a[64:65],v22,32768
T a[66:67],v22,34816
M v[88:91],a[100:103],a[132:135],v[88:91]
s_mov_b32 s55, 0x20000
T a[68:69],v22,36864
T a[70:71],v22,38912
M v[88:91],a[104:107],a[136:139],v[88:91]
s_mul_i32 s77, s42, 1835008
C v64,v64,v65
C v65,v66,v67
M v[88:91],a[108:111],a[140:143],v[88:91]
s_mul_i32 s78, s72, 14336
T a[72:73],v22,40960
T a[74:75],v22,43008
M v[88:91],a[112:115],a[144:147],v[88:91]
SA s77,s77,s78
T a[76:77],v22,45056
T a[78:79],v22,47104
M v[88:91],a[116:119],a[148:151],v[88:91]
SA s77,s77,67108864
C v66,v72,v73
C v67,v74,v75
M v[88:91],a[120:123],a[152:155],v[88:91]
s_lshl_b32 s79, s74, 1
T a[80:81],v22,49152
T a[82:83],v22,51200
M v[88:91],a[124:127],a[156:159],v[88:91]
SA s79,s79,s20
T a[84:85],v22,53248
T a[86:87],v22,55296
M v[92:95],a[124:127],a[188:191],0
s_lshl_b32 s71, s74, 1
buffer_store_dwordx4 v[64:67], v7, s[8:11], s29 offen offset:0 sc1
M v[92:95],a[120:123],a[184:187],v[92:95]
SA s71,s71,1
T a[88:89],v22,57344
T a[90:91],v22,59392
M v[92:95],a[116:119],a[180:183],v[92:95]
s_sub_u32 s71, s71, s20
T a[92:93],v22,61440
T a[94:95],v22,63488
M v[92:95],a[112:115],a[176:179],v[92:95]
s_and_b32 s71, s71, 536870912
MF v68,v6,v68
MF v69,v6,v69
M v[92:95],a[108:111],a[172:175],v[92:95]
s_sub_u32 s64, 15, s64
MF v70,v6,v70
MF v71,v6,v71
M v[92:95],a[104:107],a[168:171],v[92:95]
s_sub_u32 s78, s64, 1
MF v76,v6,v76
MF v77,v6,v77
M v[92:95],a[100:103],a[164:167],v[92:95]
s_waitcnt lgkmcnt(0)
MF v78,v6,v78
MF v79,v6,v79
M v[92:95],a[96:99],a[160:163],v[92:95]
s_mul_i32 s78, s78, 1835008
SA s78,s78,s77
s_lshl_b32 s65, s79, 10
SA s78,s78,s65
SA s78,s78,s71
s_lshl_b32 s79, s79, 6
s_or_b32 s79, s79, s71
s_mul_i32 s67, s74, -2
s_lshl_b32 s74, s74, 3
SA s74,s74,s20
s_lshl_b32 s75, s74, 6
SA s76,s75,256
SA s67,s67,3
s_sub_u32 s67, s67, s20
s_and_b32 s67, s67, 536870912
s_or_b32 s76, s76, s67
v_or_b32 v27, s67, v7
v_add_u32 v27, 4096, v27
s_lshl_b32 s65, s74, 10
SA s77,s77,s65
s_lshl_b32 s64, s64, 7
s_lshr_b32 s73, s72, 1
s_sub_u32 s65, 7, s73
s_bitcmp1_b32 s72, 0
s_cselect_b32 s73, s65, s73
s_lshl_b32 s73, s73, 4
s_lshl_b32 s65, s42, 7
SA s73,s73,s65
v_and_b32 v37, 15, v32
v_add_u32 v37, s73, v37
v_add_u32 v29, s64, v37
s_mov_b32 s64, 104857664
v_mul_u32_u24 v38, 896, v37
v_lshl_add_u32 v38, v34, 4, v38
v_lshrrev_b32 v35, 4, v37
v_lshlrev_b32 v35, 5, v35
v_and_b32 v36, 15, v37
v_add_lshl_u32 v35, v35, v36, 2
buffer_load_dword v39, v35, s[8:11], s64 offen sc1
C v68,v68,v69
C v69,v70,v71
C v70,v76,v77
C v71,v78,v79
buffer_store_dwordx4 v[68:71], v7, s[8:11], s30 offen offset:0 sc1
buffer_load_dwordx4 v[48:51], v38, s[56:59], s75 offen
buffer_load_dwordx4 v[52:55], v38, s[56:59], s76 offen
v_mul_u32_u24 v28, 896, v29
v_lshl_add_u32 v28, v34, 4, v28
v_lshrrev_b32 v35, 4, v29
v_lshlrev_b32 v35, 5, v35
v_and_b32 v36, 15, v29
v_add_lshl_u32 v35, v35, v36, 2
buffer_load_dword v26, v35, s[8:11], s64 offen sc1
buffer_load_dwordx4 v[44:47], v28, s[56:59], s79 offen
M v[96:99],a[64:67],a[128:131],0
s_nop 0
T a[96:97],v23,32768
T a[98:99],v23,34816
M v[96:99],a[68:71],a[132:135],v[96:99]
T a[100:101],v23,36864
T a[102:103],v23,38912
M v[96:99],a[72:75],a[136:139],v[96:99]
MF v80,v5,v80
MF v81,v5,v81
M v[96:99],a[76:79],a[140:143],v[96:99]
T a[104:105],v23,40960
T a[106:107],v23,43008
M v[96:99],a[80:83],a[144:147],v[96:99]
T a[108:109],v23,45056
T a[110:111],v23,47104
M v[96:99],a[84:87],a[148:151],v[96:99]
MF v82,v5,v82
MF v83,v5,v83
M v[96:99],a[88:91],a[152:155],v[96:99]
T a[112:113],v23,49152
T a[114:115],v23,51200
M v[96:99],a[92:95],a[156:159],v[96:99]
T a[116:117],v23,53248
T a[118:119],v23,55296
M v[100:103],a[92:95],a[188:191],0
MF v88,v5,v88
MF v89,v5,v89
M v[100:103],a[88:91],a[184:187],v[100:103]
T a[120:121],v23,57344
T a[122:123],v23,59392
M v[100:103],a[84:87],a[180:183],v[100:103]
T a[124:125],v23,61440
T a[126:127],v23,63488
M v[100:103],a[80:83],a[176:179],v[100:103]
MF v90,v5,v90
MF v91,v5,v91
M v[100:103],a[76:79],a[172:175],v[100:103]
C v80,v80,v81
C v81,v82,v83
M v[100:103],a[72:75],a[168:171],v[100:103]
C v82,v88,v89
C v83,v90,v91
M v[100:103],a[68:71],a[164:167],v[100:103]
buffer_store_dwordx4 v[80:83], v7, s[8:11], s29 offen offset:1024 sc1
M v[100:103],a[64:67],a[160:163],v[100:103]
s_waitcnt lgkmcnt(0)
MF v84,v6,v84
MF v85,v6,v85
M v[104:107],a[96:99],a[128:131],0
T a[64:65],v24,32768
T a[66:67],v24,34816
M v[104:107],a[100:103],a[132:135],v[104:107]
T a[68:69],v24,36864
T a[70:71],v24,38912
M v[104:107],a[104:107],a[136:139],v[104:107]
MF v86,v6,v86
MF v87,v6,v87
M v[104:107],a[108:111],a[140:143],v[104:107]
T a[72:73],v24,40960
T a[74:75],v24,43008
M v[104:107],a[112:115],a[144:147],v[104:107]
T a[76:77],v24,45056
T a[78:79],v24,47104
M v[104:107],a[116:119],a[148:151],v[104:107]
MF v92,v6,v92
MF v93,v6,v93
M v[104:107],a[120:123],a[152:155],v[104:107]
T a[80:81],v24,49152
T a[82:83],v24,51200
M v[104:107],a[124:127],a[156:159],v[104:107]
T a[84:85],v24,53248
T a[86:87],v24,55296
M v[108:111],a[124:127],a[188:191],0
MF v94,v6,v94
MF v95,v6,v95
M v[108:111],a[120:123],a[184:187],v[108:111]
T a[88:89],v24,57344
T a[90:91],v24,59392
M v[108:111],a[116:119],a[180:183],v[108:111]
T a[92:93],v24,61440
T a[94:95],v24,63488
M v[108:111],a[112:115],a[176:179],v[108:111]
C v84,v84,v85
C v85,v86,v87
M v[108:111],a[108:111],a[172:175],v[108:111]
C v86,v92,v93
C v87,v94,v95
M v[108:111],a[104:107],a[168:171],v[108:111]
buffer_store_dwordx4 v[84:87], v7, s[8:11], s30 offen offset:1024 sc1
M v[108:111],a[100:103],a[164:167],v[108:111]
SA s29,s33,10240
M v[108:111],a[96:99],a[160:163],v[108:111]
s_waitcnt lgkmcnt(0)
M v[112:115],a[64:67],a[128:131],0
SA s30,s33,24576
T a[96:97],v25,32768
T a[98:99],v25,34816
M v[112:115],a[68:71],a[132:135],v[112:115]
T a[100:101],v25,36864
T a[102:103],v25,38912
M v[112:115],a[72:75],a[136:139],v[112:115]
MF v96,v5,v96
MF v97,v5,v97
M v[112:115],a[76:79],a[140:143],v[112:115]
T a[104:105],v25,40960
T a[106:107],v25,43008
M v[112:115],a[80:83],a[144:147],v[112:115]
T a[108:109],v25,45056
T a[110:111],v25,47104
M v[112:115],a[84:87],a[148:151],v[112:115]
MF v98,v5,v98
MF v99,v5,v99
M v[112:115],a[88:91],a[152:155],v[112:115]
T a[112:113],v25,49152
T a[114:115],v25,51200
M v[112:115],a[92:95],a[156:159],v[112:115]
T a[116:117],v25,53248
T a[118:119],v25,55296
M v[116:119],a[92:95],a[188:191],0
s_mov_b32 s84, s45
MF v104,v5,v104
MF v105,v5,v105
M v[116:119],a[88:91],a[184:187],v[116:119]
T a[120:121],v25,57344
T a[122:123],v25,59392
M v[116:119],a[84:87],a[180:183],v[116:119]
T a[124:125],v25,61440
T a[126:127],v25,63488
M v[116:119],a[80:83],a[176:179],v[116:119]
MF v106,v5,v106
MF v107,v5,v107
M v[116:119],a[76:79],a[172:175],v[116:119]
C v96,v96,v97
C v97,v98,v99
M v[116:119],a[72:75],a[168:171],v[116:119]
C v98,v104,v105
C v99,v106,v107
M v[116:119],a[68:71],a[164:167],v[116:119]
s_waitcnt vmcnt(19) lgkmcnt(0)
buffer_store_dwordx4 v[96:99], v7, s[8:11], s29 offen offset:0 sc1
M v[116:119],a[64:67],a[160:163],v[116:119]
s_barrier
M v[120:123],a[96:99],a[128:131],0
s_nop 0
T a[64:65],v22,0
T a[66:67],v22,2048
M v[120:123],a[100:103],a[132:135],v[120:123]
T a[68:69],v22,4096
T a[70:71],v22,6144
M v[120:123],a[104:107],a[136:139],v[120:123]
MF v100,v6,v100
MF v101,v6,v101
M v[120:123],a[108:111],a[140:143],v[120:123]
T a[72:73],v22,8192
T a[74:75],v22,10240
M v[120:123],a[112:115],a[144:147],v[120:123]
s_waitcnt vmcnt(11)
T a[76:77],v22,12288
T a[78:79],v22,14336
M v[120:123],a[116:119],a[148:151],v[120:123]
buffer_store_dword v15, v17, s[8:11], s84 offen sc1
M v[120:123],a[120:123],a[152:155],v[120:123]
s_nop 0
T a[80:81],v22,16384
T a[82:83],v22,18432
M v[120:123],a[124:127],a[156:159],v[120:123]
T a[84:85],v22,20480
T a[86:87],v22,22528
M v[124:127],a[124:127],a[188:191],0
MF v102,v6,v102
MF v103,v6,v103
M v[124:127],a[120:123],a[184:187],v[124:127]
T a[88:89],v22,24576
T a[90:91],v22,26624
M v[124:127],a[116:119],a[180:183],v[124:127]
T a[92:93],v22,28672
T a[94:95],v22,30720
M v[124:127],a[112:115],a[176:179],v[124:127]
MF v108,v6,v108
MF v109,v6,v109
M v[124:127],a[108:111],a[172:175],v[124:127]
MF v110,v6,v110
MF v111,v6,v111
M v[124:127],a[104:107],a[168:171],v[124:127]
C v100,v100,v101
C v101,v102,v103
M v[124:127],a[100:103],a[164:167],v[124:127]
s_waitcnt lgkmcnt(0)
C v102,v108,v109
C v103,v110,v111
M v[124:127],a[96:99],a[160:163],v[124:127]
buffer_store_dwordx4 v[100:103], v7, s[8:11], s30 offen offset:0 sc1
M v[64:67],a[64:67],a[128:131],0
s_nop 0
T a[96:97],v23,0
T a[98:99],v23,2048
M v[64:67],a[68:71],a[132:135],v[64:67]
T a[100:101],v23,4096
T a[102:103],v23,6144
M v[64:67],a[72:75],a[136:139],v[64:67]
MF v112,v5,v112
MF v113,v5,v113
M v[64:67],a[76:79],a[140:143],v[64:67]
T a[104:105],v23,8192
T a[106:107],v23,10240
M v[64:67],a[80:83],a[144:147],v[64:67]
T a[108:109],v23,12288
T a[110:111],v23,14336
M v[64:67],a[84:87],a[148:151],v[64:67]
MF v114,v5,v114
MF v115,v5,v115
M v[64:67],a[88:91],a[152:155],v[64:67]
T a[112:113],v23,16384
T a[114:115],v23,18432
M v[64:67],a[92:95],a[156:159],v[64:67]
T a[116:117],v23,20480
T a[118:119],v23,22528
M v[68:71],a[92:95],a[188:191],0
MF v120,v5,v120
MF v121,v5,v121
M v[68:71],a[88:91],a[184:187],v[68:71]
T a[120:121],v23,24576
T a[122:123],v23,26624
M v[68:71],a[84:87],a[180:183],v[68:71]
T a[124:125],v23,28672
T a[126:127],v23,30720
M v[68:71],a[80:83],a[176:179],v[68:71]
MF v122,v5,v122
MF v123,v5,v123
M v[68:71],a[76:79],a[172:175],v[68:71]
C v112,v112,v113
C v113,v114,v115
M v[68:71],a[72:75],a[168:171],v[68:71]
C v114,v120,v121
C v115,v122,v123
M v[68:71],a[68:71],a[164:167],v[68:71]
buffer_store_dwordx4 v[112:115], v7, s[8:11], s29 offen offset:1024 sc1
M v[68:71],a[64:67],a[160:163],v[68:71]
s_waitcnt lgkmcnt(0)
MF v116,v6,v116
MF v117,v6,v117
M v[72:75],a[96:99],a[128:131],0
T a[64:65],v24,0
T a[66:67],v24,2048
M v[72:75],a[100:103],a[132:135],v[72:75]
T a[68:69],v24,4096
T a[70:71],v24,6144
M v[72:75],a[104:107],a[136:139],v[72:75]
MF v118,v6,v118
MF v119,v6,v119
M v[72:75],a[108:111],a[140:143],v[72:75]
T a[72:73],v24,8192
T a[74:75],v24,10240
M v[72:75],a[112:115],a[144:147],v[72:75]
T a[76:77],v24,12288
T a[78:79],v24,14336
M v[72:75],a[116:119],a[148:151],v[72:75]
MF v124,v6,v124
MF v125,v6,v125
M v[72:75],a[120:123],a[152:155],v[72:75]
T a[80:81],v24,16384
T a[82:83],v24,18432
M v[72:75],a[124:127],a[156:159],v[72:75]
T a[84:85],v24,20480
T a[86:87],v24,22528
M v[76:79],a[124:127],a[188:191],0
MF v126,v6,v126
MF v127,v6,v127
M v[76:79],a[120:123],a[184:187],v[76:79]
T a[88:89],v24,24576
T a[90:91],v24,26624
M v[76:79],a[116:119],a[180:183],v[76:79]
T a[92:93],v24,28672
T a[94:95],v24,30720
M v[76:79],a[112:115],a[176:179],v[76:79]
C v116,v116,v117
C v117,v118,v119
M v[76:79],a[108:111],a[172:175],v[76:79]
C v118,v124,v125
C v119,v126,v127
M v[76:79],a[104:107],a[168:171],v[76:79]
buffer_store_dwordx4 v[116:119], v7, s[8:11], s30 offen offset:1024 sc1
M v[76:79],a[100:103],a[164:167],v[76:79]
SA s29,s33,12288
M v[76:79],a[96:99],a[160:163],v[76:79]
s_waitcnt lgkmcnt(0)
M v[80:83],a[64:67],a[128:131],0
SA s30,s33,26624
T a[96:97],v25,0
T a[98:99],v25,2048
M v[80:83],a[68:71],a[132:135],v[80:83]
T a[100:101],v25,4096
T a[102:103],v25,6144
M v[80:83],a[72:75],a[136:139],v[80:83]
MF v64,v5,v64
MF v65,v5,v65
M v[80:83],a[76:79],a[140:143],v[80:83]
T a[104:105],v25,8192
T a[106:107],v25,10240
M v[80:83],a[80:83],a[144:147],v[80:83]
T a[108:109],v25,12288
T a[110:111],v25,14336
M v[80:83],a[84:87],a[148:151],v[80:83]
MF v66,v5,v66
MF v67,v5,v67
M v[80:83],a[88:91],a[152:155],v[80:83]
T a[112:113],v25,16384
T a[114:115],v25,18432
M v[80:83],a[92:95],a[156:159],v[80:83]
T a[116:117],v25,20480
T a[118:119],v25,22528
M v[84:87],a[92:95],a[188:191],0
MF v72,v5,v72
MF v73,v5,v73
M v[84:87],a[88:91],a[184:187],v[84:87]
T a[120:121],v25,24576
T a[122:123],v25,26624
M v[84:87],a[84:87],a[180:183],v[84:87]
T a[124:125],v25,28672
T a[126:127],v25,30720
M v[84:87],a[80:83],a[176:179],v[84:87]
MF v74,v5,v74
MF v75,v5,v75
M v[84:87],a[76:79],a[172:175],v[84:87]
C v64,v64,v65
C v65,v66,v67
M v[84:87],a[72:75],a[168:171],v[84:87]
C v66,v72,v73
C v67,v74,v75
M v[84:87],a[68:71],a[164:167],v[84:87]
buffer_store_dwordx4 v[64:67], v7, s[8:11], s29 offen offset:0 sc1
M v[84:87],a[64:67],a[160:163],v[84:87]
s_waitcnt lgkmcnt(0)
MF v68,v6,v68
MF v69,v6,v69
M v[88:91],a[96:99],a[128:131],0
MF v70,v6,v70
MF v71,v6,v71
M v[88:91],a[100:103],a[132:135],v[88:91]
MF v76,v6,v76
MF v77,v6,v77
M v[88:91],a[104:107],a[136:139],v[88:91]
MF v78,v6,v78
MF v79,v6,v79
M v[88:91],a[108:111],a[140:143],v[88:91]
C v68,v68,v69
C v69,v70,v71
M v[88:91],a[112:115],a[144:147],v[88:91]
C v70,v76,v77
C v71,v78,v79
M v[88:91],a[116:119],a[148:151],v[88:91]
buffer_store_dwordx4 v[68:71], v7, s[8:11], s30 offen offset:0 sc1
M v[88:91],a[120:123],a[152:155],v[88:91]
M v[88:91],a[124:127],a[156:159],v[88:91]
M v[92:95],a[124:127],a[188:191],0
M v[92:95],a[120:123],a[184:187],v[92:95]
M v[92:95],a[116:119],a[180:183],v[92:95]
M v[92:95],a[112:115],a[176:179],v[92:95]
MF v80,v5,v80
MF v81,v5,v81
M v[92:95],a[108:111],a[172:175],v[92:95]
MF v82,v5,v82
MF v83,v5,v83
M v[92:95],a[104:107],a[168:171],v[92:95]
MF v88,v5,v88
MF v89,v5,v89
M v[92:95],a[100:103],a[164:167],v[92:95]
MF v90,v5,v90
MF v91,v5,v91
M v[92:95],a[96:99],a[160:163],v[92:95]
C v80,v80,v81
C v81,v82,v83
C v82,v88,v89
C v83,v90,v91
buffer_store_dwordx4 v[80:83], v7, s[8:11], s29 offen offset:1024 sc1
MF v84,v6,v84
MF v85,v6,v85
MF v86,v6,v86
MF v87,v6,v87
MF v92,v6,v92
MF v93,v6,v93
MF v94,v6,v94
MF v95,v6,v95
C v84,v84,v85
C v85,v86,v87
C v86,v92,v93
C v87,v94,v95
buffer_store_dwordx4 v[84:87], v7, s[8:11], s30 offen offset:1024 sc1
buffer_load_dword v9, v33, s[8:11], s46 offen sc1
s_waitcnt vmcnt(1)
buffer_store_dword v15, v16, s[8:11], s3 offen sc1
L_red1:
s_waitcnt vmcnt(0)
v_cmp_eq_u32 vcc, 1, v9
s_mov_b32 s91, 65536
s_mov_b32 s69, 0xffff
s_and_b32 s70, vcc_lo, s69
s_mov_b32 s68, s70
s_cmp_lg_u32 s70, 0
s_cbranch_scc1 L_rk0
s_call_b64 s[36:37], L_rpoll
L_rk0:
s_ff1_i32_b32 s71, s70
s_bitset0_b32 s70, s71
s_mul_i32 s71, s71, 114688
SA s72,s71,s77
buffer_load_dwordx4 v[128:131], v7, s[8:11], s72 offen sc1
buffer_load_dwordx4 v[132:135], v27, s[8:11], s72 offen sc1
s_cmp_lg_u32 s70, 0
s_cbranch_scc1 L_rk1
s_call_b64 s[36:37], L_rpoll
L_rk1:
s_ff1_i32_b32 s71, s70
s_bitset0_b32 s70, s71
s_mul_i32 s71, s71, 114688
SA s72,s71,s77
buffer_load_dwordx4 v[136:139], v7, s[8:11], s72 offen sc1
buffer_load_dwordx4 v[140:143], v27, s[8:11], s72 offen sc1
s_cmp_lg_u32 s70, 0
s_cbranch_scc1 L_rk2
s_call_b64 s[36:37], L_rpoll
L_rk2:
s_ff1_i32_b32 s71, s70
s_bitset0_b32 s70, s71
s_mul_i32 s71, s71, 114688
SA s72,s71,s77
buffer_load_dwordx4 v[144:147], v7, s[8:11], s72 offen sc1
buffer_load_dwordx4 v[148:151], v27, s[8:11], s72 offen sc1
v_readlane_b32 s92, v31, 0
v_readlane_b32 s94, v31, 1
v_lshlrev_b32 v64, 16, v48
v_and_b32 v65, 0xffff0000, v48
v_lshlrev_b32 v66, 16, v49
v_and_b32 v67, 0xffff0000, v49
v_lshlrev_b32 v68, 16, v50
v_and_b32 v69, 0xffff0000, v50
v_lshlrev_b32 v70, 16, v51
v_and_b32 v71, 0xffff0000, v51
v_lshlrev_b32 v72, 16, v52
v_and_b32 v73, 0xffff0000, v52
v_lshlrev_b32 v74, 16, v53
v_and_b32 v75, 0xffff0000, v53
v_lshlrev_b32 v76, 16, v54
v_and_b32 v77, 0xffff0000, v54
v_lshlrev_b32 v78, 16, v55
v_and_b32 v79, 0xffff0000, v55
v_sub_f32 v30, 1.0, v39
v_cmp_eq_u32 s[80:81], s92, v37
v_cmp_eq_u32 s[82:83], s94, v37
s_nop 0
s_or_b64 vcc, s[80:81], s[82:83]
s_cbranch_vccnz L_moe0
L_moe_ret0:
MF v64,v30,v64
MF v65,v30,v65
MF v66,v30,v66
MF v67,v30,v67
MF v68,v30,v68
MF v69,v30,v69
MF v70,v30,v70
MF v71,v30,v71
MF v72,v30,v72
MF v73,v30,v73
MF v74,v30,v74
MF v75,v30,v75
MF v76,v30,v76
MF v77,v30,v77
MF v78,v30,v78
MF v79,v30,v79
s_cmp_lg_u32 s70, 0
s_cbranch_scc1 L_rk3
s_call_b64 s[36:37], L_rpoll
L_rk3:
s_ff1_i32_b32 s71, s70
s_bitset0_b32 s70, s71
s_mul_i32 s71, s71, 114688
SA s72,s71,s77
buffer_load_dwordx4 v[152:155], v7, s[8:11], s72 offen sc1
buffer_load_dwordx4 v[156:159], v27, s[8:11], s72 offen sc1
v_lshlrev_b32 v80, 16, v44
v_and_b32 v81, 0xffff0000, v44
v_lshlrev_b32 v82, 16, v45
v_and_b32 v83, 0xffff0000, v45
v_lshlrev_b32 v84, 16, v46
v_and_b32 v85, 0xffff0000, v46
v_lshlrev_b32 v86, 16, v47
v_and_b32 v87, 0xffff0000, v47
v_sub_f32 v30, 1.0, v26
v_cmp_eq_u32 s[80:81], s92, v29
v_cmp_eq_u32 s[82:83], s94, v29
s_nop 0
s_or_b64 vcc, s[80:81], s[82:83]
s_cbranch_vccnz L_moe1
L_moe_ret1:
MF v80,v30,v80
MF v81,v30,v81
MF v82,v30,v82
MF v83,v30,v83
MF v84,v30,v84
MF v85,v30,v85
MF v86,v30,v86
MF v87,v30,v87
s_waitcnt vmcnt(7)
M v[96:99],a[246:249],v[128:131],0
M v[100:103],a[244:247],v[128:131],0
s_waitcnt vmcnt(6)
M v[104:107],a[246:249],v[132:135],0
M v[108:111],a[244:247],v[132:135],0
s_cmp_lg_u32 s70, 0
s_cbranch_scc1 L_rk4
s_call_b64 s[36:37], L_rpoll
L_rk4:
s_ff1_i32_b32 s71, s70
s_bitset0_b32 s70, s71
s_mul_i32 s71, s71, 114688
SA s72,s71,s77
buffer_load_dwordx4 v[160:163], v7, s[8:11], s72 offen sc1
buffer_load_dwordx4 v[164:167], v27, s[8:11], s72 offen sc1
s_waitcnt vmcnt(7)
M v[96:99],a[246:249],v[136:139],v[96:99]
M v[100:103],a[244:247],v[136:139],v[100:103]
s_waitcnt vmcnt(6)
M v[104:107],a[246:249],v[140:143],v[104:107]
M v[108:111],a[244:247],v[140:143],v[108:111]
s_cmp_lg_u32 s70, 0
s_cbranch_scc1 L_rk5
s_call_b64 s[36:37], L_rpoll
L_rk5:
s_ff1_i32_b32 s71, s70
s_bitset0_b32 s70, s71
s_mul_i32 s71, s71, 114688
SA s72,s71,s77
buffer_load_dwordx4 v[168:171], v7, s[8:11], s72 offen sc1
buffer_load_dwordx4 v[172:175], v27, s[8:11], s72 offen sc1
s_waitcnt vmcnt(7)
M v[96:99],a[246:249],v[144:147],v[96:99]
M v[100:103],a[244:247],v[144:147],v[100:103]
s_waitcnt vmcnt(6)
M v[104:107],a[246:249],v[148:151],v[104:107]
M v[108:111],a[244:247],v[148:151],v[108:111]
s_cmp_lg_u32 s70, 0
s_cbranch_scc1 L_rk6
s_call_b64 s[36:37], L_rpoll
L_rk6:
s_ff1_i32_b32 s71, s70
s_bitset0_b32 s70, s71
s_mul_i32 s71, s71, 114688
SA s72,s71,s77
buffer_load_dwordx4 v[176:179], v7, s[8:11], s72 offen sc1
buffer_load_dwordx4 v[180:183], v27, s[8:11], s72 offen sc1
s_waitcnt vmcnt(7)
M v[96:99],a[246:249],v[152:155],v[96:99]
M v[100:103],a[244:247],v[152:155],v[100:103]
s_waitcnt vmcnt(6)
M v[104:107],a[246:249],v[156:159],v[104:107]
M v[108:111],a[244:247],v[156:159],v[108:111]
s_cmp_lg_u32 s70, 0
s_cbranch_scc1 L_rk7
s_call_b64 s[36:37], L_rpoll
L_rk7:
s_ff1_i32_b32 s71, s70
s_bitset0_b32 s70, s71
s_mul_i32 s71, s71, 114688
SA s72,s71,s77
buffer_load_dwordx4 v[184:187], v7, s[8:11], s72 offen sc1
buffer_load_dwordx4 v[188:191], v27, s[8:11], s72 offen sc1
s_waitcnt vmcnt(7)
M v[96:99],a[246:249],v[160:163],v[96:99]
M v[100:103],a[244:247],v[160:163],v[100:103]
s_waitcnt vmcnt(6)
M v[104:107],a[246:249],v[164:167],v[104:107]
M v[108:111],a[244:247],v[164:167],v[108:111]
s_cmp_lg_u32 s70, 0
s_cbranch_scc1 L_rk8
s_call_b64 s[36:37], L_rpoll
L_rk8:
s_ff1_i32_b32 s71, s70
s_bitset0_b32 s70, s71
s_mul_i32 s71, s71, 114688
SA s72,s71,s77
buffer_load_dwordx4 v[128:131], v7, s[8:11], s72 offen sc1
buffer_load_dwordx4 v[132:135], v27, s[8:11], s72 offen sc1
s_waitcnt vmcnt(7)
M v[96:99],a[246:249],v[168:171],v[96:99]
M v[100:103],a[244:247],v[168:171],v[100:103]
s_waitcnt vmcnt(6)
M v[104:107],a[246:249],v[172:175],v[104:107]
M v[108:111],a[244:247],v[172:175],v[108:111]
s_cmp_lg_u32 s70, 0
s_cbranch_scc1 L_rk9
s_call_b64 s[36:37], L_rpoll
L_rk9:
s_ff1_i32_b32 s71, s70
s_bitset0_b32 s70, s71
s_mul_i32 s71, s71, 114688
SA s72,s71,s77
buffer_load_dwordx4 v[136:139], v7, s[8:11], s72 offen sc1
buffer_load_dwordx4 v[140:143], v27, s[8:11], s72 offen sc1
s_waitcnt vmcnt(7)
M v[96:99],a[246:249],v[176:179],v[96:99]
M v[100:103],a[244:247],v[176:179],v[100:103]
s_waitcnt vmcnt(6)
M v[104:107],a[246:249],v[180:183],v[104:107]
M v[108:111],a[244:247],v[180:183],v[108:111]
s_cmp_lg_u32 s70, 0
s_cbranch_scc1 L_rk10
s_call_b64 s[36:37], L_rpoll
L_rk10:
s_ff1_i32_b32 s71, s70
s_bitset0_b32 s70, s71
s_mul_i32 s71, s71, 114688
SA s72,s71,s77
buffer_load_dwordx4 v[144:147], v7, s[8:11], s72 offen sc1
buffer_load_dwordx4 v[148:151], v27, s[8:11], s72 offen sc1
s_waitcnt vmcnt(7)
M v[96:99],a[246:249],v[184:187],v[96:99]
M v[100:103],a[244:247],v[184:187],v[100:103]
s_waitcnt vmcnt(6)
M v[104:107],a[246:249],v[188:191],v[104:107]
M v[108:111],a[244:247],v[188:191],v[108:111]
s_cmp_lg_u32 s70, 0
s_cbranch_scc1 L_rk11
s_call_b64 s[36:37], L_rpoll
L_rk11:
s_ff1_i32_b32 s71, s70
s_bitset0_b32 s70, s71
s_mul_i32 s71, s71, 114688
SA s72,s71,s77
buffer_load_dwordx4 v[152:155], v7, s[8:11], s72 offen sc1
buffer_load_dwordx4 v[156:159], v27, s[8:11], s72 offen sc1
s_waitcnt vmcnt(7)
M v[96:99],a[246:249],v[128:131],v[96:99]
M v[100:103],a[244:247],v[128:131],v[100:103]
s_waitcnt vmcnt(6)
M v[104:107],a[246:249],v[132:135],v[104:107]
M v[108:111],a[244:247],v[132:135],v[108:111]
s_cmp_lg_u32 s70, 0
s_cbranch_scc1 L_rk12
s_call_b64 s[36:37], L_rpoll
L_rk12:
s_ff1_i32_b32 s71, s70
s_bitset0_b32 s70, s71
s_mul_i32 s71, s71, 114688
SA s72,s71,s77
buffer_load_dwordx4 v[160:163], v7, s[8:11], s72 offen sc1
buffer_load_dwordx4 v[164:167], v27, s[8:11], s72 offen sc1
buffer_load_dword v8, v33, s[8:11], s46 offen sc1
s_waitcnt vmcnt(8)
M v[96:99],a[246:249],v[136:139],v[96:99]
M v[100:103],a[244:247],v[136:139],v[100:103]
s_waitcnt vmcnt(7)
M v[104:107],a[246:249],v[140:143],v[104:107]
M v[108:111],a[244:247],v[140:143],v[108:111]
s_cmp_lg_u32 s70, 0
s_cbranch_scc1 L_rk13
s_call_b64 s[36:37], L_rpoll
L_rk13:
s_ff1_i32_b32 s71, s70
s_bitset0_b32 s70, s71
s_mul_i32 s71, s71, 114688
SA s72,s71,s77
buffer_load_dwordx4 v[168:171], v7, s[8:11], s72 offen sc1
buffer_load_dwordx4 v[172:175], v27, s[8:11], s72 offen sc1
s_waitcnt vmcnt(8)
M v[96:99],a[246:249],v[144:147],v[96:99]
M v[100:103],a[244:247],v[144:147],v[100:103]
s_waitcnt vmcnt(7)
M v[104:107],a[246:249],v[148:151],v[104:107]
M v[108:111],a[244:247],v[148:151],v[108:111]
s_cmp_lg_u32 s70, 0
s_cbranch_scc1 L_rk14
s_call_b64 s[36:37], L_rpoll
L_rk14:
s_ff1_i32_b32 s71, s70
s_bitset0_b32 s70, s71
s_mul_i32 s71, s71, 114688
SA s72,s71,s77
buffer_load_dwordx4 v[176:179], v7, s[8:11], s72 offen sc1
buffer_load_dwordx4 v[180:183], v27, s[8:11], s72 offen sc1
s_waitcnt vmcnt(8)
M v[96:99],a[246:249],v[152:155],v[96:99]
M v[100:103],a[244:247],v[152:155],v[100:103]
s_waitcnt vmcnt(7)
M v[104:107],a[246:249],v[156:159],v[104:107]
M v[108:111],a[244:247],v[156:159],v[108:111]
s_cmp_lg_u32 s70, 0
s_cbranch_scc1 L_rk15
s_call_b64 s[36:37], L_rpoll
L_rk15:
s_ff1_i32_b32 s71, s70
s_bitset0_b32 s70, s71
s_mul_i32 s71, s71, 114688
SA s72,s71,s77
buffer_load_dwordx4 v[184:187], v7, s[8:11], s72 offen sc1
buffer_load_dwordx4 v[188:191], v27, s[8:11], s72 offen sc1
s_waitcnt vmcnt(8)
M v[96:99],a[246:249],v[160:163],v[96:99]
M v[100:103],a[244:247],v[160:163],v[100:103]
s_waitcnt vmcnt(7)
M v[104:107],a[246:249],v[164:167],v[104:107]
M v[108:111],a[244:247],v[164:167],v[108:111]
s_waitcnt vmcnt(6)
v_cmp_eq_u32 vcc, 1, v8
s_mov_b32 s69, 0xffff0000
s_and_b32 s70, vcc_lo, s69
s_mov_b32 s68, s70
s_cmp_lg_u32 s70, 0
s_cbranch_scc1 L_rk16
s_call_b64 s[36:37], L_rpoll
L_rk16:
s_ff1_i32_b32 s71, s70
s_bitset0_b32 s70, s71
s_mul_i32 s71, s71, 114688
SA s72,s71,s78
buffer_load_dwordx4 v[192:195], v7, s[8:11], s72 offen sc1
s_waitcnt vmcnt(6)
M v[96:99],a[246:249],v[168:171],v[96:99]
M v[100:103],a[244:247],v[168:171],v[100:103]
s_waitcnt vmcnt(5)
M v[104:107],a[246:249],v[172:175],v[104:107]
M v[108:111],a[244:247],v[172:175],v[108:111]
s_cmp_lg_u32 s70, 0
s_cbranch_scc1 L_rk17
s_call_b64 s[36:37], L_rpoll
L_rk17:
s_ff1_i32_b32 s71, s70
s_bitset0_b32 s70, s71
s_mul_i32 s71, s71, 114688
SA s72,s71,s78
buffer_load_dwordx4 v[196:199], v7, s[8:11], s72 offen sc1
s_waitcnt vmcnt(5)
M v[96:99],a[246:249],v[176:179],v[96:99]
M v[100:103],a[244:247],v[176:179],v[100:103]
s_waitcnt vmcnt(4)
M v[104:107],a[246:249],v[180:183],v[104:107]
M v[108:111],a[244:247],v[180:183],v[108:111]
s_cmp_lg_u32 s70, 0
s_cbranch_scc1 L_rk18
s_call_b64 s[36:37], L_rpoll
L_rk18:
s_ff1_i32_b32 s71, s70
s_bitset0_b32 s70, s71
s_mul_i32 s71, s71, 114688
SA s72,s71,s78
buffer_load_dwordx4 v[200:203], v7, s[8:11], s72 offen sc1
s_waitcnt vmcnt(4)
M v[96:99],a[246:249],v[184:187],v[96:99]
M v[100:103],a[244:247],v[184:187],v[100:103]
s_waitcnt vmcnt(3)
M v[104:107],a[246:249],v[188:191],v[104:107]
M v[108:111],a[244:247],v[188:191],v[108:111]
s_nop 4
v_permlane16_swap_b32 v96, v100
v_permlane16_swap_b32 v97, v101
v_permlane16_swap_b32 v98, v102
v_permlane16_swap_b32 v99, v103
v_permlane16_swap_b32 v104, v108
v_permlane16_swap_b32 v105, v109
v_permlane16_swap_b32 v106, v110
v_permlane16_swap_b32 v107, v111
v_fmac_f32 v64, v39, v96
v_fmac_f32 v65, v39, v97
v_fmac_f32 v66, v39, v98
v_fmac_f32 v67, v39, v99
v_fmac_f32 v68, v39, v100
v_fmac_f32 v69, v39, v101
v_fmac_f32 v70, v39, v102
v_fmac_f32 v71, v39, v103
C v48,v64,v65
C v49,v66,v67
C v50,v68,v69
C v51,v70,v71
buffer_store_dwordx4 v[48:51], v38, s[52:55], s75 offen sc1
v_fmac_f32 v72, v39, v104
v_fmac_f32 v73, v39, v105
v_fmac_f32 v74, v39, v106
v_fmac_f32 v75, v39, v107
v_fmac_f32 v76, v39, v108
v_fmac_f32 v77, v39, v109
v_fmac_f32 v78, v39, v110
v_fmac_f32 v79, v39, v111
C v52,v72,v73
C v53,v74,v75
C v54,v76,v77
C v55,v78,v79
buffer_store_dwordx4 v[52:55], v38, s[52:55], s76 offen sc1
s_cmp_lg_u32 s70, 0
s_cbranch_scc1 L_rk19
s_call_b64 s[36:37], L_rpoll
L_rk19:
s_ff1_i32_b32 s71, s70
s_bitset0_b32 s70, s71
s_mul_i32 s71, s71, 114688
SA s72,s71,s78
buffer_load_dwordx4 v[204:207], v7, s[8:11], s72 offen sc1
s_cmp_lg_u32 s70, 0
s_cbranch_scc1 L_rk20
s_call_b64 s[36:37], L_rpoll
L_rk20:
s_ff1_i32_b32 s71, s70
s_bitset0_b32 s70, s71
s_mul_i32 s71, s71, 114688
SA s72,s71,s78
buffer_load_dwordx4 v[208:211], v7, s[8:11], s72 offen sc1
s_cmp_lg_u32 s70, 0
s_cbranch_scc1 L_rk21
s_call_b64 s[36:37], L_rpoll
L_rk21:
s_ff1_i32_b32 s71, s70
s_bitset0_b32 s70, s71
s_mul_i32 s71, s71, 114688
SA s72,s71,s78
buffer_load_dwordx4 v[212:215], v7, s[8:11], s72 offen sc1
s_cmp_lg_u32 s70, 0
s_cbranch_scc1 L_rk22
s_call_b64 s[36:37], L_rpoll
L_rk22:
s_ff1_i32_b32 s71, s70
s_bitset0_b32 s70, s71
s_mul_i32 s71, s71, 114688
SA s72,s71,s78
buffer_load_dwordx4 v[216:219], v7, s[8:11], s72 offen sc1
s_cmp_lg_u32 s70, 0
s_cbranch_scc1 L_rk23
s_call_b64 s[36:37], L_rpoll
L_rk23:
s_ff1_i32_b32 s71, s70
s_bitset0_b32 s70, s71
s_mul_i32 s71, s71, 114688
SA s72,s71,s78
buffer_load_dwordx4 v[220:223], v7, s[8:11], s72 offen sc1
s_cmp_lg_u32 s70, 0
s_cbranch_scc1 L_rk24
s_call_b64 s[36:37], L_rpoll
L_rk24:
s_ff1_i32_b32 s71, s70
s_bitset0_b32 s70, s71
s_mul_i32 s71, s71, 114688
SA s72,s71,s78
buffer_load_dwordx4 v[224:227], v7, s[8:11], s72 offen sc1
s_cmp_lg_u32 s70, 0
s_cbranch_scc1 L_rk25
s_call_b64 s[36:37], L_rpoll
L_rk25:
s_ff1_i32_b32 s71, s70
s_bitset0_b32 s70, s71
s_mul_i32 s71, s71, 114688
SA s72,s71,s78
buffer_load_dwordx4 v[228:231], v7, s[8:11], s72 offen sc1
s_cmp_lg_u32 s70, 0
s_cbranch_scc1 L_rk26
s_call_b64 s[36:37], L_rpoll
L_rk26:
s_ff1_i32_b32 s71, s70
s_bitset0_b32 s70, s71
s_mul_i32 s71, s71, 114688
SA s72,s71,s78
buffer_load_dwordx4 v[232:235], v7, s[8:11], s72 offen sc1
s_cmp_lg_u32 s70, 0
s_cbranch_scc1 L_rk27
s_call_b64 s[36:37], L_rpoll
L_rk27:
s_ff1_i32_b32 s71, s70
s_bitset0_b32 s70, s71
s_mul_i32 s71, s71, 114688
SA s72,s71,s78
buffer_load_dwordx4 v[236:239], v7, s[8:11], s72 offen sc1
s_waitcnt vmcnt(13)
M v[112:115],a[246:249],v[192:195],0
M v[116:119],a[244:247],v[192:195],0
s_cmp_lg_u32 s70, 0
s_cbranch_scc1 L_rk28
s_call_b64 s[36:37], L_rpoll
L_rk28:
s_ff1_i32_b32 s71, s70
s_bitset0_b32 s70, s71
s_mul_i32 s71, s71, 114688
SA s72,s71,s78
buffer_load_dwordx4 v[240:243], v7, s[8:11], s72 offen sc1
s_waitcnt vmcnt(13)
M v[112:115],a[246:249],v[196:199],v[112:115]
M v[116:119],a[244:247],v[196:199],v[116:119]
s_cmp_lg_u32 s70, 0
s_cbranch_scc1 L_rk29
s_call_b64 s[36:37], L_rpoll
L_rk29:
s_ff1_i32_b32 s71, s70
s_bitset0_b32 s70, s71
s_mul_i32 s71, s71, 114688
SA s72,s71,s78
buffer_load_dwordx4 v[244:247], v7, s[8:11], s72 offen sc1
s_waitcnt vmcnt(13)
M v[112:115],a[246:249],v[200:203],v[112:115]
M v[116:119],a[244:247],v[200:203],v[116:119]
s_cmp_lg_u32 s70, 0
s_cbranch_scc1 L_rk30
s_call_b64 s[36:37], L_rpoll
L_rk30:
s_ff1_i32_b32 s71, s70
s_bitset0_b32 s70, s71
s_mul_i32 s71, s71, 114688
SA s72,s71,s78
buffer_load_dwordx4 v[248:251], v7, s[8:11], s72 offen sc1
s_waitcnt vmcnt(11)
M v[112:115],a[246:249],v[204:207],v[112:115]
M v[116:119],a[244:247],v[204:207],v[116:119]
s_cmp_lg_u32 s70, 0
s_cbranch_scc1 L_rk31
s_call_b64 s[36:37], L_rpoll
L_rk31:
s_ff1_i32_b32 s71, s70
s_bitset0_b32 s70, s71
s_mul_i32 s71, s71, 114688
SA s72,s71,s78
buffer_load_dwordx4 v[252:255], v7, s[8:11], s72 offen sc1
s_waitcnt vmcnt(11)
M v[112:115],a[246:249],v[208:211],v[112:115]
M v[116:119],a[244:247],v[208:211],v[116:119]
s_waitcnt vmcnt(10)
M v[112:115],a[246:249],v[212:215],v[112:115]
M v[116:119],a[244:247],v[212:215],v[116:119]
s_waitcnt vmcnt(9)
M v[112:115],a[246:249],v[216:219],v[112:115]
M v[116:119],a[244:247],v[216:219],v[116:119]
s_waitcnt vmcnt(8)
M v[112:115],a[246:249],v[220:223],v[112:115]
M v[116:119],a[244:247],v[220:223],v[116:119]
s_waitcnt vmcnt(7)
M v[112:115],a[246:249],v[224:227],v[112:115]
M v[116:119],a[244:247],v[224:227],v[116:119]
s_waitcnt vmcnt(6)
M v[112:115],a[246:249],v[228:231],v[112:115]
M v[116:119],a[244:247],v[228:231],v[116:119]
s_waitcnt vmcnt(5)
M v[112:115],a[246:249],v[232:235],v[112:115]
M v[116:119],a[244:247],v[232:235],v[116:119]
s_waitcnt vmcnt(4)
M v[112:115],a[246:249],v[236:239],v[112:115]
M v[116:119],a[244:247],v[236:239],v[116:119]
s_waitcnt vmcnt(3)
M v[112:115],a[246:249],v[240:243],v[112:115]
M v[116:119],a[244:247],v[240:243],v[116:119]
s_waitcnt vmcnt(2)
M v[112:115],a[246:249],v[244:247],v[112:115]
M v[116:119],a[244:247],v[244:247],v[116:119]
s_waitcnt vmcnt(1)
M v[112:115],a[246:249],v[248:251],v[112:115]
M v[116:119],a[244:247],v[248:251],v[116:119]
s_waitcnt vmcnt(0)
M v[112:115],a[246:249],v[252:255],v[112:115]
M v[116:119],a[244:247],v[252:255],v[116:119]
s_nop 7
v_permlane16_swap_b32 v112, v116
v_permlane16_swap_b32 v113, v117
v_permlane16_swap_b32 v114, v118
v_permlane16_swap_b32 v115, v119
v_fmac_f32 v80, v26, v112
v_fmac_f32 v81, v26, v113
v_fmac_f32 v82, v26, v114
v_fmac_f32 v83, v26, v115
v_fmac_f32 v84, v26, v116
v_fmac_f32 v85, v26, v117
v_fmac_f32 v86, v26, v118
v_fmac_f32 v87, v26, v119
C v44,v80,v81
C v45,v82,v83
C v46,v84,v85
C v47,v86,v87
buffer_store_dwordx4 v[44:47], v28, s[52:55], s79 offen sc1
s_endpgm
L_rpoll0:
s_sleep 1
L_rpoll:
buffer_load_dword v9, v33, s[8:11], s46 offen sc1
s_waitcnt vmcnt(0)
v_cmp_eq_u32 vcc, 1, v9
s_sub_u32 s91, s91, 1
s_cselect_b32 s70, -1, 0
s_or_b32 s70, s70, vcc_lo
s_and_b32 s70, s70, s69
s_andn2_b32 s70, s70, s68
s_cbranch_scc0 L_rpoll0
s_or_b32 s68, s68, s70
s_setpc_b64 s[36:37]
L_moe0:
s_lshl_b32 s88, s75, 1
s_call_b64 s[36:37], L_moe
AF v64,v2,v64
AF v65,v3,v65
AF v66,v4,v66
AF v67,v5,v67
AF v68,v10,v68
AF v69,v11,v69
AF v70,v12,v70
AF v71,v13,v71
AF v72,v14,v72
AF v73,v15,v73
AF v74,v16,v74
AF v75,v17,v75
AF v76,v18,v76
AF v77,v19,v77
AF v78,v20,v78
AF v79,v21,v79
s_mov_b64 exec, -1
s_branch L_moe_ret0
L_moe1:
s_lshl_b32 s88, s79, 1
s_call_b64 s[36:37], L_moe
AF v80,v2,v80
AF v81,v3,v81
AF v82,v4,v82
AF v83,v5,v83
AF v84,v10,v84
AF v85,v11,v85
AF v86,v12,v86
AF v87,v13,v87
s_mov_b64 exec, -1
s_branch L_moe_ret1
L_moe2:
s_lshl_b32 s88, s79, 1
s_call_b64 s[36:37], L_moe
AF v48,v2,v48
AF v49,v3,v49
AF v50,v4,v50
AF v51,v5,v51
AF v52,v10,v52
AF v53,v11,v53
AF v54,v12,v54
AF v55,v13,v55
s_mov_b64 exec, -1
s_branch L_moe_ret2
L_moe:
v_min_u32 v0, 27, v32
v_lshlrev_b32 v0, 2, v0
s_mov_b32 s64, 105062912
s_mov_b32 s65, 65536
s_mov_b32 exec_lo, 0xffffffff
s_mov_b32 exec_hi, 0xffffffff
L_pfy:
buffer_load_dword v1, v0, s[8:11], s64 offen sc1
s_sub_u32 s65, s65, 1
s_cbranch_scc1 L_pfy_x
s_waitcnt vmcnt(0)
v_cmp_ne_u32 vcc, 1, v1
s_nop 0
s_cbranch_vccz L_pfy_x
s_sleep 2
s_branch L_pfy
L_pfy_x:
s_waitcnt vmcnt(0)
s_mov_b64 exec, -1
s_or_b64 exec, s[80:81], s[82:83]
v_mov_b32 v0, 1792
v_cndmask_b32 v0, v0, 0, s[80:81]
v_lshl_add_u32 v0, v34, 5, v0
SA s88,s88,104898560
buffer_load_dwordx4 v[2:5], v0, s[8:11], s88 offen sc1
buffer_load_dwordx4 v[10:13], v0, s[8:11], s88 offen offset:16 sc1
buffer_load_dwordx4 v[14:17], v0, s[8:11], s88 offen offset:512 sc1
buffer_load_dwordx4 v[18:21], v0, s[8:11], s88 offen offset:528 sc1
s_waitcnt vmcnt(0)
s_setpc_b64 s[36:37]
L_red:
v_lshrrev_b32 v32, 4, v7
s_lshr_b32 s74, s41, 3
s_lshl_b32 s64, s42, 1
SA s46,s64,s74
s_mul_i32 s46, s46, 4352
s_and_b32 s72, s41, 7
s_lshl_b32 s65, s72, 7
SA s46,s46,s65
SA s46,s46,104992768
v_and_b32 v33, 31, v32
v_lshlrev_b32 v33, 2, v33
s_lshl_b32 s65, s41, 7
SA s65,s65,104890368
buffer_load_dword v31, v33, s[8:11], s65 offen sc1
v_bfe_u32 v34, v32, 4, 1
v_lshlrev_b32 v34, 1, v34
v_lshrrev_b32 v35, 5, v32
v_add_u32 v34, v34, v35
s_mov_b32 s52, s96
s_and_b32 s53, s97, 0xffff
s_mov_b32 s54, 1835008
s_mov_b32 s55, 0x20000
s_mul_i32 s77, s42, 1835008
s_mul_i32 s78, s72, 14336
SA s77,s77,s78
SA s77,s77,67108864
s_lshl_b32 s79, s74, 1
SA s79,s79,s20
s_lshl_b32 s71, s74, 1
SA s71,s71,1
s_sub_u32 s71, s71, s20
s_and_b32 s71, s71, 536870912
s_sub_u32 s64, 15, s64
s_sub_u32 s78, s64, 1
s_mul_i32 s78, s78, 1835008
SA s78,s78,s77
s_lshl_b32 s65, s79, 10
SA s78,s78,s65
SA s78,s78,s71
s_lshl_b32 s79, s79, 6
s_or_b32 s79, s79, s71
s_mul_i32 s67, s74, -2
s_lshl_b32 s74, s74, 3
SA s74,s74,s20
s_lshl_b32 s75, s74, 6
SA s76,s75,256
SA s67,s67,3
s_sub_u32 s67, s67, s20
s_and_b32 s67, s67, 536870912
s_or_b32 s76, s76, s67
v_or_b32 v27, s67, v7
v_add_u32 v27, 4096, v27
s_lshl_b32 s65, s74, 10
SA s77,s77,s65
s_lshl_b32 s64, s64, 7
s_lshr_b32 s73, s72, 1
s_sub_u32 s65, 7, s73
s_bitcmp1_b32 s72, 0
s_cselect_b32 s73, s65, s73
s_lshl_b32 s73, s73, 4
s_lshl_b32 s65, s42, 7
SA s73,s73,s65
v_and_b32 v37, 15, v32
v_add_u32 v37, s73, v37
v_add_u32 v29, s64, v37
s_mov_b32 s64, 104857664
v_mul_u32_u24 v38, 896, v37
v_lshl_add_u32 v38, v34, 4, v38
v_lshrrev_b32 v35, 4, v37
v_lshlrev_b32 v35, 5, v35
v_and_b32 v36, 15, v37
v_add_lshl_u32 v35, v35, v36, 2
buffer_load_dword v39, v35, s[8:11], s64 offen sc1
buffer_load_dwordx4 v[48:51], v38, s[56:59], s75 offen
buffer_load_dwordx4 v[52:55], v38, s[56:59], s76 offen
v_mul_u32_u24 v28, 896, v29
v_lshl_add_u32 v28, v34, 4, v28
v_lshrrev_b32 v35, 4, v29
v_lshlrev_b32 v35, 5, v35
v_and_b32 v36, 15, v29
v_add_lshl_u32 v35, v35, v36, 2
buffer_load_dword v26, v35, s[8:11], s64 offen sc1
buffer_load_dwordx4 v[44:47], v28, s[56:59], s79 offen
s_waitcnt vmcnt(7)
buffer_load_dword v9, v33, s[8:11], s46 offen sc1
s_branch L_red1
L_code_end:
.section .rodata,"a"
.p2align 6
.amdhsa_kernel gated_mix__compressed_kv_cla__moe_arch_mod__prompt_kernel
  .amdhsa_next_free_vgpr 512
  .amdhsa_next_free_sgpr 102
  .amdhsa_accum_offset 256
  .amdhsa_group_segment_fixed_size 0
  .amdhsa_kernarg_size 120
  .amdhsa_user_sgpr_count 2
  .amdhsa_user_sgpr_kernarg_segment_ptr 1
  .amdhsa_system_sgpr_workgroup_id_x 1
  .amdhsa_float_denorm_mode_32 3
.end_amdhsa_kernel
```

```asm
; @launch grid=(256,1,1) block=(256,1,1) lds=163840
.amdgcn_target "amdgcn-amd-amdhsa--gfx950"
.text
.macro M a, b, c, d
v_mfma_f32_16x16x32_bf16 \a, \b, \c, \d
.endm
.macro R a, b, c
ds_read_b128 \a, \b offset:\c
.endm
.macro T a, b, c
ds_read_b64_tr_b16 \a, \b offset:\c
.endm
.macro C a, b, c
v_cvt_pk_bf16_f32 \a, \b, \c
.endm
.macro E a, b
v_exp_f32 \a, \b
.endm
.macro W a, b
v_accvgpr_write_b32 \a, \b
.endm
.macro G a, b
v_accvgpr_read_b32 \a, \b
.endm
.macro AF a, b, c
v_add_f32 \a, \b, \c
.endm
.macro MF a, b, c
v_mul_f32 \a, \b, \c
.endm
.macro SA a, b, c
s_add_u32 \a, \b, \c
.endm
.globl gated_mix__compressed_kv_cla__moe_arch_mod__prompt_kernel
.p2align 8
.type gated_mix__compressed_kv_cla__moe_arch_mod__prompt_kernel,@function
gated_mix__compressed_kv_cla__moe_arch_mod__prompt_kernel:
s_cmp_lt_u32 s2, 256
s_cbranch_scc1 L_go
s_endpgm
L_go:
s_load_dwordx8 s[80:87], s[0:1], 0
s_load_dwordx4 s[88:91], s[0:1], 32
s_getpc_b64 s[76:77]
L_pc0:
s_lshr_b32 s42, s2, 3
s_mov_b32 s79, 0x20000
s_lshl_b32 s67, s42, 13
s_mov_b32 s78, L_code_end-L_pc0
s_and_b32 s77, s77, 0xffff
v_lshl_add_u32 v31, v0, 5, s67
buffer_load_dword a240, v31, s[76:79], 0 offen offset:0
v_lshrrev_b32 v24, 6, v0
v_and_b32 v0, 63, v0
s_and_b32 s41, s2, 7
v_readfirstlane_b32 s20, v24
s_lshr_b32 s64, s2, 4
v_and_b32 v24, 15, v0
v_lshrrev_b32 v25, 4, v0
s_and_b32 s64, s64, 8
s_or_b32 s41, s41, s64
v_lshlrev_b32 v28, 1, v25
v_xor_b32 v28, v28, v24
v_and_b32 v29, 8, v28
v_and_b32 v28, 7, v28
v_lshlrev_b32 v28, 4, v28
v_lshl_add_u32 v28, v29, 5, v28
v_lshl_add_u32 v28, v25, 13, v28
s_lshl_b32 s64, s20, 17
v_add_u32 v8, s64, v28
v_xor_b32 v28, 0x100, v8
v_add_u32 v9, 31744, v8
v_add_u32 v10, 63488, v28
v_add_u32 v11, 95232, v28
s_mov_b32 s21, 0
s_lshl_b32 s23, s20, 12
s_lshl_b32 s74, s41, 9
s_sub_u32 s18, 8388608, s74
s_mov_b32 s19, s79
s_bitcmp0_b32 s2, 6
s_waitcnt lgkmcnt(0)
s_cselect_b64 s[72:73], s[86:87], s[88:89]
SA s16,s72,s74
s_addc_u32 s73, s73, 0
s_and_b32 s17, s73, 0xffff
SA m0,s23,0
s_nop 0
buffer_load_dwordx4 v8, s[16:19], s21 offen offset:0  nt lds
buffer_load_dwordx4 v9, s[16:19], s21 offen offset:1024  nt lds
buffer_load_dwordx4 v10, s[16:19], s21 offen offset:2048  nt lds
buffer_load_dwordx4 v11, s[16:19], s21 offen offset:3072  nt lds
SA s21,s21,128
s_and_b32 s42, s42, 15
s_lshr_b32 s45, s42, 3
s_and_b32 s65, s20, 1
s_lshr_b32 s66, s20, 1
v_and_b32 v29, 7, v0
v_xor_b32 v28, v25, v29
v_lshlrev_b32 v28, 4, v28
v_lshrrev_b32 v29, 3, v0
v_lshl_add_u32 v30, v29, 11, v28
s_lshl_b32 s64, s66, 19
s_lshl_b32 s67, s65, 21
SA s64,s64,s67
v_add_u32 v12, s64, v30
v_xor_b32 v30, 64, v12
v_add_u32 v14, 30720, v12
v_add_u32 v13, 15360, v30
v_add_u32 v15, 46080, v30
s_mov_b32 s22, 0
SA s24,s23,65536
s_and_b32 s64, s42, 7
s_lshl_b32 s64, s64, 16
s_sub_u32 s50, 4194304, s64
s_mov_b32 s51, s79
SA s48,s82,s64
s_addc_u32 s73, s83, 0
s_and_b32 s49, s73, 0xffff
SA m0,s23,16384
s_nop 0
buffer_load_dwordx4 v8, s[16:19], s21 offen offset:0  nt lds
buffer_load_dwordx4 v9, s[16:19], s21 offen offset:1024  nt lds
buffer_load_dwordx4 v10, s[16:19], s21 offen offset:2048  nt lds
buffer_load_dwordx4 v11, s[16:19], s21 offen offset:3072  nt lds
SA s21,s21,524160
SA m0,s24,0
s_nop 0
buffer_load_dwordx4 v12, s[48:51], s22 offen offset:0   lds
buffer_load_dwordx4 v13, s[48:51], s22 offen offset:1024   lds
buffer_load_dwordx4 v14, s[48:51], s22 offen offset:2048   lds
buffer_load_dwordx4 v15, s[48:51], s22 offen offset:3072   lds
SA s22,s22,1048576
s_load_dwordx2 s[92:93], s[0:1], 56
s_load_dwordx2 s[94:95], s[0:1], 88
s_load_dwordx4 s[4:7], s[0:1], 104
v_lshlrev_b32 v7, 4, v0
v_lshrrev_b32 v26, 2, v24
v_and_b32 v28, 1, v25
v_lshl_or_b32 v28, v28, 2, v26
v_lshl_add_u32 v29, v25, 3, v26
v_lshlrev_b32 v29, 8, v29
v_and_b32 v30, 3, v0
v_lshl_add_u32 v29, v30, 3, v29
s_lshl_b32 s64, s65, 2
SA s64,s64,0
v_xor_b32 v30, s64, v28
v_lshl_add_u32 v1, v30, 5, v29
s_lshl_b32 s64, s65, 2
SA s64,s64,1
v_xor_b32 v30, s64, v28
v_lshl_add_u32 v2, v30, 5, v29
s_lshl_b32 s64, s65, 2
SA s64,s64,2
v_xor_b32 v30, s64, v28
v_lshl_add_u32 v3, v30, 5, v29
s_lshl_b32 s64, s65, 2
SA s64,s64,3
v_xor_b32 v30, s64, v28
v_lshl_add_u32 v4, v30, 5, v29
v_add_u32 v28, 0, v25
v_lshrrev_b32 v29, 1, v24
v_xor_b32 v28, v28, v29
v_lshlrev_b32 v28, 4, v28
v_lshl_add_u32 v28, v24, 7, v28
s_lshl_b32 s64, s66, 13
SA s64,s64,65536
v_add_u32 v5, s64, v28
v_add_u32 v28, 4, v25
v_lshrrev_b32 v29, 1, v24
v_xor_b32 v28, v28, v29
v_lshlrev_b32 v28, 4, v28
v_lshl_add_u32 v28, v24, 7, v28
s_lshl_b32 s64, s66, 13
SA s64,s64,65536
v_add_u32 v6, s64, v28
s_mov_b32 s56, s80
s_and_b32 s57, s81, 0xffff
s_mov_b32 s58, 1835008
s_mov_b32 s59, 0x20000
s_waitcnt lgkmcnt(0)
s_mov_b32 s60, s92
s_and_b32 s61, s93, 0xffff
s_mov_b32 s62, 896
s_mov_b32 s63, 0x20000
s_mov_b32 s68, s94
s_and_b32 s69, s95, 0xffff
s_mov_b32 s70, 896
s_mov_b32 s71, 0x20000
s_lshl_b32 s95, s20, 11
s_lshr_b32 s64, s2, 3
s_lshl_b32 s64, s64, 13
SA s95,s95,s64
s_mov_b32 s8, s6
s_and_b32 s9, s7, 0xffff
s_mov_b32 s10, 268435456
s_mov_b32 s11, 0x20000
s_mov_b32 s12, s4
s_and_b32 s13, s5, 0xffff
s_mov_b32 s14, 256
s_mov_b32 s15, 0x20000
SA s72,s84,s74
s_addc_u32 s73, s85, 0
s_sub_u32 s75, 3670016, s74
s_mov_b32 s52, s72
s_and_b32 s53, s73, 0xffff
s_mov_b32 s54, s75
s_mov_b32 s55, 0x20000
s_mul_i32 s29, s42, 114688
s_mov_b32 s5, 0x3db8aa3b
s_mul_i32 s72, s45, 16777216
s_mul_i32 s73, s41, 1048576
SA s72,s72,s73
s_bfe_u32 s64, s42, 0x20001
s_lshl_b32 s64, s64, 15
SA s72,s72,s64
s_lshl_b32 s64, s66, 17
SA s72,s72,s64
s_and_b32 s67, s42, 1
s_cmp_eq_u32 s45, 0
s_cselect_b32 s64, 12, 14
s_cselect_b32 s75, 14, 10
s_lshl_b32 s67, s67, s75
SA s72,s72,s67
s_lshl_b32 s64, s65, s64
SA s93,s72,s64
s_load_dwordx4 s[80:83], s[0:1], 64
s_load_dwordx2 s[84:85], s[0:1], 80
s_load_dwordx2 s[96:97], s[0:1], 96
s_cmp_eq_u32 s45, 0
s_cbranch_scc0 L_kv1
s_branch L_kv0
.p2align 12
L_kv0:
s_and_b32 s31, s42, 7
s_lshl_b32 s64, s42, 4
SA s64,s64,s41
s_lshl_b32 s64, s64, 2
SA s64,s64,s20
s_cmp_lt_u32 s64, 41
s_cselect_b32 s39, 0, 536870912
s_min_u32 s64, s64, 41
s_lshl_b32 s38, s64, 2
s_max_u32 s67, s64, 8
s_sub_u32 s67, s67, 8
s_mul_i32 s67, s67, 3328
s_lshl_b32 s64, s64, 10
SA s64,s64,s67
SA s73,s64,104914944
v_or_b32 v64, s39, v7
v_mov_b32 v68, 0
v_mov_b32 v69, 0
v_mov_b32 v70, 0
v_mov_b32 v71, 0
buffer_store_dwordx4 v[68:71], v64, s[8:11], s73 offen offset:0 sc1
buffer_store_dwordx4 v[68:71], v64, s[8:11], s73 offen offset:1024 sc1
buffer_store_dwordx4 v[68:71], v64, s[8:11], s73 offen offset:2048 sc1
SA m0,s24,16384
s_nop 0
buffer_load_dwordx4 v12, s[48:51], s22 offen offset:0   lds
buffer_load_dwordx4 v13, s[48:51], s22 offen offset:1024   lds
buffer_load_dwordx4 v14, s[48:51], s22 offen offset:2048   lds
buffer_load_dwordx4 v15, s[48:51], s22 offen offset:3072   lds
s_sub_u32 s22, s22, 1048448
SA m0,s23,32768
s_nop 0
buffer_load_dwordx4 v8, s[16:19], s21 offen offset:0  nt lds
buffer_load_dwordx4 v9, s[16:19], s21 offen offset:1024  nt lds
buffer_load_dwordx4 v10, s[16:19], s21 offen offset:2048  nt lds
buffer_load_dwordx4 v11, s[16:19], s21 offen offset:3072  nt lds
SA s21,s21,128
s_mov_b64 exec, 0
s_cmp_eq_u32 s20, 0
s_cbranch_scc1 L_w_kv01
s_cmp_eq_u32 s20, 1
s_cbranch_scc1 L_w_kv02
s_cmp_eq_u32 s20, 2
s_cbranch_scc1 L_w_kv03
s_branch L_w_kv04
L_wd1:
s_mov_b64 exec, -1
s_waitcnt vmcnt(11) lgkmcnt(0)
s_barrier
R a[160:163],v5,0
R a[164:167],v6,0
T a[96:97],v1,0
T a[98:99],v1,1024
T a[100:101],v1,8192
T a[102:103],v1,9216
T a[104:105],v2,0
T a[106:107],v2,1024
T a[108:109],v2,8192
T a[110:111],v2,9216
T a[112:113],v3,0
T a[114:115],v3,1024
T a[116:117],v3,8192
T a[118:119],v3,9216
T a[120:121],v4,0
T a[122:123],v4,1024
T a[124:125],v4,8192
T a[126:127],v4,9216
T a[128:129],v1,16384
T a[130:131],v1,17408
T a[132:133],v1,24576
T a[134:135],v1,25600
T a[136:137],v2,16384
T a[138:139],v2,17408
T a[140:141],v2,24576
T a[142:143],v2,25600
T a[144:145],v3,16384
T a[146:147],v3,17408
T a[148:149],v3,24576
T a[150:151],v3,25600
T a[152:153],v4,16384
T a[154:155],v4,17408
T a[156:157],v4,24576
T a[158:159],v4,25600
s_waitcnt lgkmcnt(15)
M a[0:3],a[96:99],a[160:163],0
SA m0,s23,49152
R a[168:171],v5,2048
R a[172:175],v6,2048
M a[0:3],a[100:103],a[164:167],a[0:3]
buffer_load_dwordx4 v8, s[16:19], s21 offen offset:0  nt lds
M a[4:7],a[108:111],a[164:167],0
M a[4:7],a[104:107],a[160:163],a[4:7]
M a[8:11],a[112:115],a[160:163],0
buffer_load_dwordx4 v9, s[16:19], s21 offen offset:1024  nt lds
M a[8:11],a[116:119],a[164:167],a[8:11]
s_waitcnt lgkmcnt(14)
M a[12:15],a[124:127],a[164:167],0
M a[12:15],a[120:123],a[160:163],a[12:15]
M a[16:19],a[128:131],a[160:163],0
buffer_load_dwordx4 v10, s[16:19], s21 offen offset:2048  nt lds
M a[16:19],a[132:135],a[164:167],a[16:19]
s_waitcnt lgkmcnt(6)
M a[20:23],a[140:143],a[164:167],0
M a[20:23],a[136:139],a[160:163],a[20:23]
buffer_load_dwordx4 v11, s[16:19], s21 offen offset:3072  nt lds
M a[24:27],a[144:147],a[160:163],0
SA s21,s21,524160
M a[24:27],a[148:151],a[164:167],a[24:27]
s_waitcnt lgkmcnt(0)
M a[28:31],a[156:159],a[164:167],0
SA m0,s24,32768
M a[28:31],a[152:155],a[160:163],a[28:31]
buffer_load_dwordx4 v12, s[48:51], s22 offen offset:0   lds
M v[32:35],a[96:99],a[168:171],0
R a[160:163],v5,4096
R a[164:167],v6,4096
M v[32:35],a[100:103],a[172:175],v[32:35]
M v[36:39],a[108:111],a[172:175],0
M v[36:39],a[104:107],a[168:171],v[36:39]
buffer_load_dwordx4 v13, s[48:51], s22 offen offset:1024   lds
M v[40:43],a[112:115],a[168:171],0
M v[40:43],a[116:119],a[172:175],v[40:43]
M v[44:47],a[124:127],a[172:175],0
buffer_load_dwordx4 v14, s[48:51], s22 offen offset:2048   lds
M v[44:47],a[120:123],a[168:171],v[44:47]
M v[48:51],a[128:131],a[168:171],0
M v[48:51],a[132:135],a[172:175],v[48:51]
M v[52:55],a[140:143],a[172:175],0
buffer_load_dwordx4 v15, s[48:51], s22 offen offset:3072   lds
M v[52:55],a[136:139],a[168:171],v[52:55]
SA s22,s22,1048576
M v[56:59],a[144:147],a[168:171],0
M v[56:59],a[148:151],a[172:175],v[56:59]
s_waitcnt lgkmcnt(0)
M v[60:63],a[156:159],a[172:175],0
M v[60:63],a[152:155],a[168:171],v[60:63]
M v[64:67],a[96:99],a[160:163],0
R a[168:171],v5,6144
R a[172:175],v6,6144
M v[64:67],a[100:103],a[164:167],v[64:67]
M v[68:71],a[108:111],a[164:167],0
M v[68:71],a[104:107],a[160:163],v[68:71]
M v[72:75],a[112:115],a[160:163],0
M v[72:75],a[116:119],a[164:167],v[72:75]
M v[76:79],a[124:127],a[164:167],0
M v[76:79],a[120:123],a[160:163],v[76:79]
M v[80:83],a[128:131],a[160:163],0
M v[80:83],a[132:135],a[164:167],v[80:83]
M v[84:87],a[140:143],a[164:167],0
M v[84:87],a[136:139],a[160:163],v[84:87]
M v[88:91],a[144:147],a[160:163],0
M v[88:91],a[148:151],a[164:167],v[88:91]
s_waitcnt lgkmcnt(0)
M v[92:95],a[156:159],a[164:167],0
s_waitcnt vmcnt(12)
M v[92:95],a[152:155],a[160:163],v[92:95]
s_barrier
M v[96:99],a[96:99],a[168:171],0
SA m0,s23,0
R a[160:163],v5,16384
R a[164:167],v6,16384
M v[96:99],a[100:103],a[172:175],v[96:99]
buffer_load_dwordx4 v8, s[16:19], s21 offen offset:0  nt lds
M v[100:103],a[108:111],a[172:175],0
v_lshlrev_b32 v26, 7, v0
v_and_b32 v27, 48, v0
M v[100:103],a[104:107],a[168:171],v[100:103]
v_lshl_add_u32 v26, v27, 24, v26
M v[104:107],a[112:115],a[168:171],0
buffer_load_dwordx4 v9, s[16:19], s21 offen offset:1024  nt lds
M v[104:107],a[116:119],a[172:175],v[104:107]
M v[108:111],a[124:127],a[172:175],0
M v[108:111],a[120:123],a[168:171],v[108:111]
buffer_load_dwordx4 v10, s[16:19], s21 offen offset:2048  nt lds
M v[112:115],a[128:131],a[168:171],0
M v[112:115],a[132:135],a[172:175],v[112:115]
M v[116:119],a[140:143],a[172:175],0
M v[116:119],a[136:139],a[168:171],v[116:119]
buffer_load_dwordx4 v11, s[16:19], s21 offen offset:3072  nt lds
M v[120:123],a[144:147],a[168:171],0
SA s21,s21,128
M v[120:123],a[148:151],a[172:175],v[120:123]
s_waitcnt lgkmcnt(0)
M v[124:127],a[156:159],a[172:175],0
SA m0,s24,49152
M v[124:127],a[152:155],a[168:171],v[124:127]
buffer_load_dwordx4 v12, s[48:51], s22 offen offset:0   lds
M v[128:131],a[96:99],a[160:163],0
R a[168:171],v5,18432
R a[172:175],v6,18432
M v[128:131],a[100:103],a[164:167],v[128:131]
buffer_load_dwordx4 v13, s[48:51], s22 offen offset:1024   lds
M v[132:135],a[108:111],a[164:167],0
M v[132:135],a[104:107],a[160:163],v[132:135]
M v[136:139],a[112:115],a[160:163],0
M v[136:139],a[116:119],a[164:167],v[136:139]
buffer_load_dwordx4 v14, s[48:51], s22 offen offset:2048   lds
M v[140:143],a[124:127],a[164:167],0
M v[140:143],a[120:123],a[160:163],v[140:143]
M v[144:147],a[128:131],a[160:163],0
buffer_load_dwordx4 v15, s[48:51], s22 offen offset:3072   lds
M v[144:147],a[132:135],a[164:167],v[144:147]
s_sub_u32 s22, s22, 1048448
M v[148:151],a[140:143],a[164:167],0
M v[148:151],a[136:139],a[160:163],v[148:151]
M v[152:155],a[144:147],a[160:163],0
M v[152:155],a[148:151],a[164:167],v[152:155]
s_waitcnt lgkmcnt(0)
M v[156:159],a[156:159],a[164:167],0
s_waitcnt vmcnt(12)
M v[156:159],a[152:155],a[160:163],v[156:159]
s_barrier
M v[160:163],a[96:99],a[168:171],0
SA m0,s23,16384
R a[160:163],v5,20480
R a[164:167],v6,20480
M v[160:163],a[100:103],a[172:175],v[160:163]
T a[32:33],v1,32768
T a[34:35],v1,33792
M v[164:167],a[108:111],a[172:175],0
T a[36:37],v1,40960
T a[38:39],v1,41984
M v[164:167],a[104:107],a[168:171],v[164:167]
T a[40:41],v2,32768
T a[42:43],v2,33792
M v[168:171],a[112:115],a[168:171],0
T a[44:45],v2,40960
T a[46:47],v2,41984
M v[168:171],a[116:119],a[172:175],v[168:171]
buffer_load_dwordx4 v8, s[16:19], s21 offen offset:0  nt lds
M v[172:175],a[124:127],a[172:175],0
s_nop 0
T a[48:49],v3,32768
T a[50:51],v3,33792
M v[172:175],a[120:123],a[168:171],v[172:175]
buffer_load_dwordx4 v9, s[16:19], s21 offen offset:1024  nt lds
M v[176:179],a[128:131],a[168:171],0
s_nop 0
T a[52:53],v3,40960
T a[54:55],v3,41984
M v[176:179],a[132:135],a[172:175],v[176:179]
T a[56:57],v4,32768
T a[58:59],v4,33792
M v[180:183],a[140:143],a[172:175],0
buffer_load_dwordx4 v10, s[16:19], s21 offen offset:2048  nt lds
M v[180:183],a[136:139],a[168:171],v[180:183]
s_nop 0
T a[60:61],v4,40960
T a[62:63],v4,41984
M v[184:187],a[144:147],a[168:171],0
buffer_load_dwordx4 v11, s[16:19], s21 offen offset:3072  nt lds
M v[184:187],a[148:151],a[172:175],v[184:187]
s_waitcnt lgkmcnt(15)
s_nop 0
T a[64:65],v1,49152
T a[66:67],v1,50176
M v[188:191],a[156:159],a[172:175],0
SA s21,s21,524160
T a[68:69],v1,57344
T a[70:71],v1,58368
M v[188:191],a[152:155],a[168:171],v[188:191]
SA m0,s24,0
M v[192:195],a[96:99],a[160:163],0
R a[168:171],v5,22528
R a[172:175],v6,22528
M v[192:195],a[100:103],a[164:167],v[192:195]
T a[72:73],v2,49152
T a[74:75],v2,50176
M v[196:199],a[108:111],a[164:167],0
T a[76:77],v2,57344
T a[78:79],v2,58368
M v[196:199],a[104:107],a[160:163],v[196:199]
T a[80:81],v3,49152
T a[82:83],v3,50176
M v[200:203],a[112:115],a[160:163],0
buffer_load_dwordx4 v12, s[48:51], s22 offen offset:0   lds
M v[200:203],a[116:119],a[164:167],v[200:203]
s_nop 0
T a[84:85],v3,57344
T a[86:87],v3,58368
M v[204:207],a[124:127],a[164:167],0
T a[88:89],v4,49152
T a[90:91],v4,50176
M v[204:207],a[120:123],a[160:163],v[204:207]
buffer_load_dwordx4 v13, s[48:51], s22 offen offset:1024   lds
M v[208:211],a[128:131],a[160:163],0
s_nop 0
T a[92:93],v4,57344
T a[94:95],v4,58368
M v[208:211],a[132:135],a[164:167],v[208:211]
buffer_load_dwordx4 v14, s[48:51], s22 offen offset:2048   lds
M v[212:215],a[140:143],a[164:167],0
buffer_load_dwordx4 v15, s[48:51], s22 offen offset:3072   lds
M v[212:215],a[136:139],a[160:163],v[212:215]
SA s22,s22,1048576
M v[216:219],a[144:147],a[160:163],0
M v[216:219],a[148:151],a[164:167],v[216:219]
s_waitcnt lgkmcnt(12)
M v[220:223],a[156:159],a[164:167],0
s_waitcnt vmcnt(12) lgkmcnt(0)
M v[220:223],a[152:155],a[160:163],v[220:223]
s_barrier
M v[224:227],a[96:99],a[168:171],0
SA m0,s23,32768
R a[160:163],v5,32768
R a[164:167],v6,32768
M v[224:227],a[100:103],a[172:175],v[224:227]
buffer_load_dwordx4 v8, s[16:19], s21 offen offset:0  nt lds
M v[228:231],a[108:111],a[172:175],0
M v[228:231],a[104:107],a[168:171],v[228:231]
M v[232:235],a[112:115],a[168:171],0
buffer_load_dwordx4 v9, s[16:19], s21 offen offset:1024  nt lds
M v[232:235],a[116:119],a[172:175],v[232:235]
M v[236:239],a[124:127],a[172:175],0
M v[236:239],a[120:123],a[168:171],v[236:239]
buffer_load_dwordx4 v10, s[16:19], s21 offen offset:2048  nt lds
M v[240:243],a[128:131],a[168:171],0
M v[240:243],a[132:135],a[172:175],v[240:243]
M v[244:247],a[140:143],a[172:175],0
buffer_load_dwordx4 v11, s[16:19], s21 offen offset:3072  nt lds
M v[244:247],a[136:139],a[168:171],v[244:247]
SA s21,s21,128
M v[248:251],a[144:147],a[168:171],0
M v[248:251],a[148:151],a[172:175],v[248:251]
s_waitcnt lgkmcnt(0)
M v[252:255],a[156:159],a[172:175],0
M v[252:255],a[152:155],a[168:171],v[252:255]
M a[0:3],a[32:35],a[160:163],a[0:3]
R a[168:171],v5,34816
R a[172:175],v6,34816
M a[0:3],a[36:39],a[164:167],a[0:3]
T a[96:97],v1,0
T a[98:99],v1,1024
M a[4:7],a[44:47],a[164:167],a[4:7]
SA m0,s24,16384
M a[4:7],a[40:43],a[160:163],a[4:7]
buffer_load_dwordx4 v12, s[48:51], s22 offen offset:0   lds
M a[8:11],a[48:51],a[160:163],a[8:11]
M a[8:11],a[52:55],a[164:167],a[8:11]
M a[12:15],a[60:63],a[164:167],a[12:15]
s_nop 0
T a[100:101],v1,8192
T a[102:103],v1,9216
M a[12:15],a[56:59],a[160:163],a[12:15]
M a[16:19],a[64:67],a[160:163],a[16:19]
buffer_load_dwordx4 v13, s[48:51], s22 offen offset:1024   lds
M a[16:19],a[68:71],a[164:167],a[16:19]
M a[20:23],a[76:79],a[164:167],a[20:23]
M a[20:23],a[72:75],a[160:163],a[20:23]
s_nop 0
T a[104:105],v2,0
T a[106:107],v2,1024
M a[24:27],a[80:83],a[160:163],a[24:27]
M a[24:27],a[84:87],a[164:167],a[24:27]
s_waitcnt lgkmcnt(6)
buffer_load_dwordx4 v14, s[48:51], s22 offen offset:2048   lds
M a[28:31],a[92:95],a[164:167],a[28:31]
M a[28:31],a[88:91],a[160:163],a[28:31]
M v[60:63],a[88:91],a[168:171],v[60:63]
R a[160:163],v5,36864
R a[164:167],v6,36864
M v[60:63],a[92:95],a[172:175],v[60:63]
T a[108:109],v2,8192
T a[110:111],v2,9216
M v[56:59],a[84:87],a[172:175],v[56:59]
buffer_load_dwordx4 v15, s[48:51], s22 offen offset:3072   lds
M v[56:59],a[80:83],a[168:171],v[56:59]
s_sub_u32 s22, s22, 1048448
M v[52:55],a[72:75],a[168:171],v[52:55]
M v[52:55],a[76:79],a[172:175],v[52:55]
s_nop 0
T a[112:113],v3,0
T a[114:115],v3,1024
M v[48:51],a[68:71],a[172:175],v[48:51]
SA m0,s23,49152
M v[48:51],a[64:67],a[168:171],v[48:51]
buffer_load_dwordx4 v8, s[16:19], s21 offen offset:0  nt lds
M v[44:47],a[56:59],a[168:171],v[44:47]
M v[44:47],a[60:63],a[172:175],v[44:47]
M v[40:43],a[52:55],a[172:175],v[40:43]
s_nop 0
T a[116:117],v3,8192
T a[118:119],v3,9216
M v[40:43],a[48:51],a[168:171],v[40:43]
M v[36:39],a[40:43],a[168:171],v[36:39]
buffer_load_dwordx4 v9, s[16:19], s21 offen offset:1024  nt lds
M v[36:39],a[44:47],a[172:175],v[36:39]
s_waitcnt lgkmcnt(6)
M v[32:35],a[36:39],a[172:175],v[32:35]
M v[32:35],a[32:35],a[168:171],v[32:35]
s_nop 0
T a[120:121],v4,0
T a[122:123],v4,1024
M v[64:67],a[32:35],a[160:163],v[64:67]
R a[168:171],v5,38912
R a[172:175],v6,38912
M v[64:67],a[36:39],a[164:167],v[64:67]
buffer_load_dwordx4 v10, s[16:19], s21 offen offset:2048  nt lds
M v[68:71],a[44:47],a[164:167],v[68:71]
M v[68:71],a[40:43],a[160:163],v[68:71]
M v[72:75],a[48:51],a[160:163],v[72:75]
s_nop 0
T a[124:125],v4,8192
T a[126:127],v4,9216
M v[72:75],a[52:55],a[164:167],v[72:75]
M v[76:79],a[60:63],a[164:167],v[76:79]
buffer_load_dwordx4 v11, s[16:19], s21 offen offset:3072  nt lds
M v[76:79],a[56:59],a[160:163],v[76:79]
SA s21,s21,524160
M v[80:83],a[64:67],a[160:163],v[80:83]
M v[80:83],a[68:71],a[164:167],v[80:83]
M v[84:87],a[76:79],a[164:167],v[84:87]
M v[84:87],a[72:75],a[160:163],v[84:87]
M v[88:91],a[80:83],a[160:163],v[88:91]
M v[88:91],a[84:87],a[164:167],v[88:91]
s_waitcnt lgkmcnt(2)
M v[92:95],a[92:95],a[164:167],v[92:95]
s_waitcnt vmcnt(16) lgkmcnt(0)
M v[92:95],a[88:91],a[160:163],v[92:95]
s_barrier
M v[124:127],a[88:91],a[168:171],v[124:127]
R a[160:163],v5,49152
R a[164:167],v6,49152
M v[124:127],a[92:95],a[172:175],v[124:127]
M v[120:123],a[84:87],a[172:175],v[120:123]
SA m0,s24,32768
T a[128:129],v1,16384
T a[130:131],v1,17408
M v[120:123],a[80:83],a[168:171],v[120:123]
buffer_load_dwordx4 v12, s[48:51], s22 offen offset:0   lds
M v[116:119],a[72:75],a[168:171],v[116:119]
M v[116:119],a[76:79],a[172:175],v[116:119]
M v[112:115],a[68:71],a[172:175],v[112:115]
M v[112:115],a[64:67],a[168:171],v[112:115]
M v[108:111],a[56:59],a[168:171],v[108:111]
M v[108:111],a[60:63],a[172:175],v[108:111]
s_nop 0
T a[132:133],v1,24576
T a[134:135],v1,25600
M v[104:107],a[52:55],a[172:175],v[104:107]
buffer_load_dwordx4 v13, s[48:51], s22 offen offset:1024   lds
M v[104:107],a[48:51],a[168:171],v[104:107]
M v[100:103],a[40:43],a[168:171],v[100:103]
M v[100:103],a[44:47],a[172:175],v[100:103]
s_waitcnt lgkmcnt(4)
M v[96:99],a[36:39],a[172:175],v[96:99]
M v[96:99],a[32:35],a[168:171],v[96:99]
M v[128:131],a[32:35],a[160:163],v[128:131]
R a[168:171],v5,51200
R a[172:175],v6,51200
M v[128:131],a[36:39],a[164:167],v[128:131]
T a[136:137],v2,16384
T a[138:139],v2,17408
M v[132:135],a[44:47],a[164:167],v[132:135]
buffer_load_dwordx4 v14, s[48:51], s22 offen offset:2048   lds
M v[132:135],a[40:43],a[160:163],v[132:135]
M v[136:139],a[48:51],a[160:163],v[136:139]
M v[136:139],a[52:55],a[164:167],v[136:139]
M v[140:143],a[60:63],a[164:167],v[140:143]
M v[140:143],a[56:59],a[160:163],v[140:143]
s_nop 0
T a[140:141],v2,24576
T a[142:143],v2,25600
M v[144:147],a[64:67],a[160:163],v[144:147]
buffer_load_dwordx4 v15, s[48:51], s22 offen offset:3072   lds
M v[144:147],a[68:71],a[164:167],v[144:147]
SA s22,s22,1048576
M v[148:151],a[76:79],a[164:167],v[148:151]
M v[148:151],a[72:75],a[160:163],v[148:151]
M v[152:155],a[80:83],a[160:163],v[152:155]
M v[152:155],a[84:87],a[164:167],v[152:155]
s_waitcnt lgkmcnt(4)
M v[156:159],a[92:95],a[164:167],v[156:159]
SA m0,s23,0
T a[144:145],v3,16384
T a[146:147],v3,17408
M v[156:159],a[88:91],a[160:163],v[156:159]
buffer_load_dwordx4 v8, s[16:19], s21 offen offset:0  nt lds
M v[188:191],a[88:91],a[168:171],v[188:191]
R a[160:163],v5,53248
R a[164:167],v6,53248
M v[188:191],a[92:95],a[172:175],v[188:191]
M v[184:187],a[84:87],a[172:175],v[184:187]
M v[184:187],a[80:83],a[168:171],v[184:187]
M v[180:183],a[72:75],a[168:171],v[180:183]
M v[180:183],a[76:79],a[172:175],v[180:183]
s_nop 0
T a[148:149],v3,24576
T a[150:151],v3,25600
M v[176:179],a[68:71],a[172:175],v[176:179]
buffer_load_dwordx4 v9, s[16:19], s21 offen offset:1024  nt lds
M v[176:179],a[64:67],a[168:171],v[176:179]
M v[172:175],a[56:59],a[168:171],v[172:175]
M v[172:175],a[60:63],a[172:175],v[172:175]
M v[168:171],a[52:55],a[172:175],v[168:171]
M v[168:171],a[48:51],a[168:171],v[168:171]
M v[164:167],a[40:43],a[168:171],v[164:167]
s_nop 0
T a[152:153],v4,16384
T a[154:155],v4,17408
M v[164:167],a[44:47],a[172:175],v[164:167]
s_waitcnt lgkmcnt(4)
buffer_load_dwordx4 v10, s[16:19], s21 offen offset:2048  nt lds
M v[160:163],a[36:39],a[172:175],v[160:163]
M v[160:163],a[32:35],a[168:171],v[160:163]
M v[192:195],a[32:35],a[160:163],v[192:195]
R a[168:171],v5,55296
R a[172:175],v6,55296
M v[192:195],a[36:39],a[164:167],v[192:195]
M v[196:199],a[44:47],a[164:167],v[196:199]
M v[196:199],a[40:43],a[160:163],v[196:199]
s_nop 0
T a[156:157],v4,24576
T a[158:159],v4,25600
M v[200:203],a[48:51],a[160:163],v[200:203]
buffer_load_dwordx4 v11, s[16:19], s21 offen offset:3072  nt lds
M v[200:203],a[52:55],a[164:167],v[200:203]
SA s21,s21,128
M v[204:207],a[60:63],a[164:167],v[204:207]
M v[204:207],a[56:59],a[160:163],v[204:207]
M v[208:211],a[64:67],a[160:163],v[208:211]
M v[208:211],a[68:71],a[164:167],v[208:211]
M v[212:215],a[76:79],a[164:167],v[212:215]
M v[212:215],a[72:75],a[160:163],v[212:215]
M v[216:219],a[80:83],a[160:163],v[216:219]
M v[216:219],a[84:87],a[164:167],v[216:219]
s_waitcnt lgkmcnt(2)
M v[220:223],a[92:95],a[164:167],v[220:223]
s_waitcnt vmcnt(16) lgkmcnt(0)
M v[220:223],a[88:91],a[160:163],v[220:223]
s_barrier
M v[252:255],a[88:91],a[168:171],v[252:255]
R a[160:163],v5,0
R a[164:167],v6,0
M v[252:255],a[92:95],a[172:175],v[252:255]
v_min_u32 v16, 1, v0
v_lshlrev_b32 v16, 29, v16
M v[248:251],a[84:87],a[172:175],v[248:251]
v_or_b32 v16, s39, v16
v_mov_b32 v17, 1
M v[248:251],a[80:83],a[168:171],v[248:251]
buffer_store_dword v17, v16, s[12:15], s38 offen sc1
M v[244:247],a[72:75],a[168:171],v[244:247]
M v[244:247],a[76:79],a[172:175],v[244:247]
M v[240:243],a[68:71],a[172:175],v[240:243]
M v[240:243],a[64:67],a[168:171],v[240:243]
M v[236:239],a[56:59],a[168:171],v[236:239]
M v[236:239],a[60:63],a[172:175],v[236:239]
M v[232:235],a[52:55],a[172:175],v[232:235]
M v[232:235],a[48:51],a[168:171],v[232:235]
M v[228:231],a[40:43],a[168:171],v[228:231]
M v[228:231],a[44:47],a[172:175],v[228:231]
s_waitcnt lgkmcnt(0)
M v[224:227],a[36:39],a[172:175],v[224:227]
M v[224:227],a[32:35],a[168:171],v[224:227]
M a[0:3],a[96:99],a[160:163],a[0:3]
L_w_kv01:
s_cbranch_execz L_w_kv05
R a[168:171],v5,2048
R a[172:175],v6,2048
M a[0:3],a[100:103],a[164:167],a[0:3]
T a[32:33],v1,32768
T a[34:35],v1,33792
M a[4:7],a[108:111],a[164:167],a[4:7]
SA m0,s24,49152
M a[4:7],a[104:107],a[160:163],a[4:7]
buffer_load_dwordx4 v12, s[48:51], s22 offen offset:0   lds
M a[8:11],a[112:115],a[160:163],a[8:11]
M a[8:11],a[116:119],a[164:167],a[8:11]
M a[12:15],a[124:127],a[164:167],a[12:15]
s_nop 0
T a[36:37],v1,40960
T a[38:39],v1,41984
M a[12:15],a[120:123],a[160:163],a[12:15]
M a[16:19],a[128:131],a[160:163],a[16:19]
buffer_load_dwordx4 v13, s[48:51], s22 offen offset:1024   lds
M a[16:19],a[132:135],a[164:167],a[16:19]
M a[20:23],a[140:143],a[164:167],a[20:23]
M a[20:23],a[136:139],a[160:163],a[20:23]
s_nop 0
T a[40:41],v2,32768
T a[42:43],v2,33792
M a[24:27],a[144:147],a[160:163],a[24:27]
M a[24:27],a[148:151],a[164:167],a[24:27]
s_waitcnt lgkmcnt(6)
buffer_load_dwordx4 v14, s[48:51], s22 offen offset:2048   lds
M a[28:31],a[156:159],a[164:167],a[28:31]
M a[28:31],a[152:155],a[160:163],a[28:31]
M v[60:63],a[152:155],a[168:171],v[60:63]
R a[160:163],v5,4096
R a[164:167],v6,4096
M v[60:63],a[156:159],a[172:175],v[60:63]
T a[44:45],v2,40960
T a[46:47],v2,41984
M v[56:59],a[148:151],a[172:175],v[56:59]
buffer_load_dwordx4 v15, s[48:51], s22 offen offset:3072   lds
M v[56:59],a[144:147],a[168:171],v[56:59]
s_sub_u32 s22, s22, 1048448
M v[52:55],a[136:139],a[168:171],v[52:55]
M v[52:55],a[140:143],a[172:175],v[52:55]
s_nop 0
T a[48:49],v3,32768
T a[50:51],v3,33792
M v[48:51],a[132:135],a[172:175],v[48:51]
SA m0,s23,16384
M v[48:51],a[128:131],a[168:171],v[48:51]
buffer_load_dwordx4 v8, s[16:19], s21 offen offset:0  nt lds
M v[44:47],a[120:123],a[168:171],v[44:47]
M v[44:47],a[124:127],a[172:175],v[44:47]
M v[40:43],a[116:119],a[172:175],v[40:43]
s_nop 0
T a[52:53],v3,40960
T a[54:55],v3,41984
M v[40:43],a[112:115],a[168:171],v[40:43]
M v[36:39],a[104:107],a[168:171],v[36:39]
buffer_load_dwordx4 v9, s[16:19], s21 offen offset:1024  nt lds
M v[36:39],a[108:111],a[172:175],v[36:39]
s_waitcnt lgkmcnt(6)
M v[32:35],a[100:103],a[172:175],v[32:35]
M v[32:35],a[96:99],a[168:171],v[32:35]
s_nop 0
T a[56:57],v4,32768
T a[58:59],v4,33792
M v[64:67],a[96:99],a[160:163],v[64:67]
R a[168:171],v5,6144
R a[172:175],v6,6144
M v[64:67],a[100:103],a[164:167],v[64:67]
buffer_load_dwordx4 v10, s[16:19], s21 offen offset:2048  nt lds
M v[68:71],a[108:111],a[164:167],v[68:71]
M v[68:71],a[104:107],a[160:163],v[68:71]
M v[72:75],a[112:115],a[160:163],v[72:75]
s_nop 0
T a[60:61],v4,40960
T a[62:63],v4,41984
M v[72:75],a[116:119],a[164:167],v[72:75]
M v[76:79],a[124:127],a[164:167],v[76:79]
buffer_load_dwordx4 v11, s[16:19], s21 offen offset:3072  nt lds
M v[76:79],a[120:123],a[160:163],v[76:79]
SA s21,s21,524160
M v[80:83],a[128:131],a[160:163],v[80:83]
M v[80:83],a[132:135],a[164:167],v[80:83]
M v[84:87],a[140:143],a[164:167],v[84:87]
M v[84:87],a[136:139],a[160:163],v[84:87]
s_and_b32 s86, s41, 7
M v[88:91],a[144:147],a[160:163],v[88:91]
s_mul_i32 s86, s86, 14
s_lshr_b32 s64, s41, 3
s_mul_i32 s64, s64, 7
M v[88:91],a[148:151],a[164:167],v[88:91]
s_waitcnt lgkmcnt(2)
SA s86,s86,s64
s_min_u32 s64, s31, 6
M v[92:95],a[156:159],a[164:167],v[92:95]
s_waitcnt vmcnt(17) lgkmcnt(0)
SA s86,s86,s64
s_sub_u32 s64, 6, s31
M v[92:95],a[152:155],a[160:163],v[92:95]
s_barrier
M v[124:127],a[152:155],a[168:171],v[124:127]
R a[160:163],v5,16384
R a[164:167],v6,16384
M v[124:127],a[156:159],a[172:175],v[124:127]
s_and_b32 s88, s64, 536870912
s_mul_i32 s87, s20, 7168
M v[120:123],a[148:151],a[172:175],v[120:123]
SA m0,s24,0
T a[64:65],v1,49152
T a[66:67],v1,50176
M v[120:123],a[144:147],a[168:171],v[120:123]
buffer_load_dwordx4 v12, s[48:51], s22 offen offset:0   lds
M v[116:119],a[136:139],a[168:171],v[116:119]
SA s87,s87,131072
M v[116:119],a[140:143],a[172:175],v[116:119]
s_cmp_lt_u32 s20, 2
M v[112:115],a[132:135],a[172:175],v[112:115]
s_cselect_b64 s[72:73], s[80:81], s[82:83]
M v[112:115],a[128:131],a[168:171],v[112:115]
s_mov_b32 s60, s72
M v[108:111],a[120:123],a[168:171],v[108:111]
s_and_b32 s61, s73, 0xffff
M v[108:111],a[124:127],a[172:175],v[108:111]
s_mov_b32 s62, 1605632
T a[68:69],v1,57344
T a[70:71],v1,58368
M v[104:107],a[116:119],a[172:175],v[104:107]
s_mov_b32 s63, 0x20000
buffer_load_dwordx4 v13, s[48:51], s22 offen offset:1024   lds
M v[104:107],a[112:115],a[168:171],v[104:107]
s_mov_b32 s68, s84
M v[100:103],a[104:107],a[168:171],v[100:103]
s_and_b32 s69, s85, 0xffff
s_mov_b32 s70, 1605632
s_mov_b32 s71, 0x20000
M v[100:103],a[108:111],a[172:175],v[100:103]
s_waitcnt lgkmcnt(4)
s_lshl_b32 s89, s86, 5
M v[96:99],a[100:103],a[172:175],v[96:99]
s_and_b32 s64, s20, 1
M v[96:99],a[96:99],a[168:171],v[96:99]
s_mul_i32 s64, s64, 802816
M v[128:131],a[96:99],a[160:163],v[128:131]
SA s89,s89,s64
R a[168:171],v5,18432
R a[172:175],v6,18432
M v[128:131],a[100:103],a[164:167],v[128:131]
T a[72:73],v2,49152
T a[74:75],v2,50176
M v[132:135],a[108:111],a[164:167],v[132:135]
buffer_load_dwordx4 v14, s[48:51], s22 offen offset:2048   lds
M v[132:135],a[104:107],a[160:163],v[132:135]
v_lshrrev_b32 v28, 1, v0
v_mul_u32_u24 v28, 3584, v28
M v[136:139],a[112:115],a[160:163],v[136:139]
v_and_b32 v29, 1, v0
v_lshl_add_u32 v25, v29, 4, v28
M v[136:139],a[116:119],a[164:167],v[136:139]
v_or_b32 v25, s88, v25
M v[140:143],a[124:127],a[164:167],v[140:143]
M v[140:143],a[120:123],a[160:163],v[140:143]
s_nop 0
T a[76:77],v2,57344
T a[78:79],v2,58368
M v[144:147],a[128:131],a[160:163],v[144:147]
buffer_load_dwordx4 v15, s[48:51], s22 offen offset:3072   lds
M v[144:147],a[132:135],a[164:167],v[144:147]
SA s22,s22,1048576
M v[148:151],a[140:143],a[164:167],v[148:151]
M v[148:151],a[136:139],a[160:163],v[148:151]
M v[152:155],a[144:147],a[160:163],v[152:155]
M v[152:155],a[148:151],a[164:167],v[152:155]
s_waitcnt lgkmcnt(4)
M v[156:159],a[156:159],a[164:167],v[156:159]
SA m0,s23,32768
T a[80:81],v3,49152
T a[82:83],v3,50176
M v[156:159],a[152:155],a[160:163],v[156:159]
buffer_load_dwordx4 v8, s[16:19], s21 offen offset:0  nt lds
M v[188:191],a[152:155],a[168:171],v[188:191]
R a[160:163],v5,20480
R a[164:167],v6,20480
M v[188:191],a[156:159],a[172:175],v[188:191]
M v[184:187],a[148:151],a[172:175],v[184:187]
M v[184:187],a[144:147],a[168:171],v[184:187]
M v[180:183],a[136:139],a[168:171],v[180:183]
M v[180:183],a[140:143],a[172:175],v[180:183]
s_nop 0
T a[84:85],v3,57344
T a[86:87],v3,58368
M v[176:179],a[132:135],a[172:175],v[176:179]
buffer_load_dwordx4 v9, s[16:19], s21 offen offset:1024  nt lds
M v[176:179],a[128:131],a[168:171],v[176:179]
M v[172:175],a[120:123],a[168:171],v[172:175]
M v[172:175],a[124:127],a[172:175],v[172:175]
M v[168:171],a[116:119],a[172:175],v[168:171]
M v[168:171],a[112:115],a[168:171],v[168:171]
M v[164:167],a[104:107],a[168:171],v[164:167]
s_nop 0
T a[88:89],v4,49152
T a[90:91],v4,50176
M v[164:167],a[108:111],a[172:175],v[164:167]
s_waitcnt lgkmcnt(4)
buffer_load_dwordx4 v10, s[16:19], s21 offen offset:2048  nt lds
M v[160:163],a[100:103],a[172:175],v[160:163]
M v[160:163],a[96:99],a[168:171],v[160:163]
M v[192:195],a[96:99],a[160:163],v[192:195]
R a[168:171],v5,22528
R a[172:175],v6,22528
M v[192:195],a[100:103],a[164:167],v[192:195]
M v[196:199],a[108:111],a[164:167],v[196:199]
M v[196:199],a[104:107],a[160:163],v[196:199]
s_nop 0
T a[92:93],v4,57344
T a[94:95],v4,58368
M v[200:203],a[112:115],a[160:163],v[200:203]
buffer_load_dwordx4 v11, s[16:19], s21 offen offset:3072  nt lds
M v[200:203],a[116:119],a[164:167],v[200:203]
SA s21,s21,128
M v[204:207],a[124:127],a[164:167],v[204:207]
M v[204:207],a[120:123],a[160:163],v[204:207]
M v[208:211],a[128:131],a[160:163],v[208:211]
M v[208:211],a[132:135],a[164:167],v[208:211]
M v[212:215],a[140:143],a[164:167],v[212:215]
M v[212:215],a[136:139],a[160:163],v[212:215]
M v[216:219],a[144:147],a[160:163],v[216:219]
M v[216:219],a[148:151],a[164:167],v[216:219]
s_waitcnt lgkmcnt(2)
M v[220:223],a[156:159],a[164:167],v[220:223]
s_waitcnt vmcnt(17) lgkmcnt(0)
M v[220:223],a[152:155],a[160:163],v[220:223]
s_barrier
M v[252:255],a[152:155],a[168:171],v[252:255]
R a[160:163],v5,32768
R a[164:167],v6,32768
M v[252:255],a[156:159],a[172:175],v[252:255]
M v[248:251],a[148:151],a[172:175],v[248:251]
M v[248:251],a[144:147],a[168:171],v[248:251]
M v[244:247],a[136:139],a[168:171],v[244:247]
M v[244:247],a[140:143],a[172:175],v[244:247]
M v[240:243],a[132:135],a[172:175],v[240:243]
M v[240:243],a[128:131],a[168:171],v[240:243]
M v[236:239],a[120:123],a[168:171],v[236:239]
M v[236:239],a[124:127],a[172:175],v[236:239]
M v[232:235],a[116:119],a[172:175],v[232:235]
M v[232:235],a[112:115],a[168:171],v[232:235]
M v[228:231],a[104:107],a[168:171],v[228:231]
M v[228:231],a[108:111],a[172:175],v[228:231]
s_waitcnt lgkmcnt(0)
M v[224:227],a[100:103],a[172:175],v[224:227]
M v[224:227],a[96:99],a[168:171],v[224:227]
M a[0:3],a[32:35],a[160:163],a[0:3]
R a[168:171],v5,34816
R a[172:175],v6,34816
M a[0:3],a[36:39],a[164:167],a[0:3]
T a[96:97],v1,0
T a[98:99],v1,1024
M a[4:7],a[44:47],a[164:167],a[4:7]
SA m0,s24,16384
M a[4:7],a[40:43],a[160:163],a[4:7]
buffer_load_dwordx4 v12, s[48:51], s22 offen offset:0   lds
M a[8:11],a[48:51],a[160:163],a[8:11]
M a[8:11],a[52:55],a[164:167],a[8:11]
M a[12:15],a[60:63],a[164:167],a[12:15]
s_nop 0
T a[100:101],v1,8192
T a[102:103],v1,9216
M a[12:15],a[56:59],a[160:163],a[12:15]
M a[16:19],a[64:67],a[160:163],a[16:19]
buffer_load_dwordx4 v13, s[48:51], s22 offen offset:1024   lds
M a[16:19],a[68:71],a[164:167],a[16:19]
M a[20:23],a[76:79],a[164:167],a[20:23]
M a[20:23],a[72:75],a[160:163],a[20:23]
s_nop 0
T a[104:105],v2,0
T a[106:107],v2,1024
M a[24:27],a[80:83],a[160:163],a[24:27]
M a[24:27],a[84:87],a[164:167],a[24:27]
s_waitcnt lgkmcnt(6)
buffer_load_dwordx4 v14, s[48:51], s22 offen offset:2048   lds
M a[28:31],a[92:95],a[164:167],a[28:31]
M a[28:31],a[88:91],a[160:163],a[28:31]
M v[60:63],a[88:91],a[168:171],v[60:63]
R a[160:163],v5,36864
R a[164:167],v6,36864
M v[60:63],a[92:95],a[172:175],v[60:63]
T a[108:109],v2,8192
T a[110:111],v2,9216
M v[56:59],a[84:87],a[172:175],v[56:59]
buffer_load_dwordx4 v15, s[48:51], s22 offen offset:3072   lds
M v[56:59],a[80:83],a[168:171],v[56:59]
s_sub_u32 s22, s22, 1048448
M v[52:55],a[72:75],a[168:171],v[52:55]
M v[52:55],a[76:79],a[172:175],v[52:55]
s_nop 0
T a[112:113],v3,0
T a[114:115],v3,1024
M v[48:51],a[68:71],a[172:175],v[48:51]
SA m0,s23,49152
M v[48:51],a[64:67],a[168:171],v[48:51]
buffer_load_dwordx4 v8, s[16:19], s21 offen offset:0  nt lds
M v[44:47],a[56:59],a[168:171],v[44:47]
M v[44:47],a[60:63],a[172:175],v[44:47]
M v[40:43],a[52:55],a[172:175],v[40:43]
s_nop 0
T a[116:117],v3,8192
T a[118:119],v3,9216
M v[40:43],a[48:51],a[168:171],v[40:43]
M v[36:39],a[40:43],a[168:171],v[36:39]
buffer_load_dwordx4 v9, s[16:19], s21 offen offset:1024  nt lds
M v[36:39],a[44:47],a[172:175],v[36:39]
s_waitcnt lgkmcnt(6)
M v[32:35],a[36:39],a[172:175],v[32:35]
M v[32:35],a[32:35],a[168:171],v[32:35]
s_nop 0
T a[120:121],v4,0
T a[122:123],v4,1024
M v[64:67],a[32:35],a[160:163],v[64:67]
R a[168:171],v5,38912
R a[172:175],v6,38912
M v[64:67],a[36:39],a[164:167],v[64:67]
buffer_load_dwordx4 v10, s[16:19], s21 offen offset:2048  nt lds
M v[68:71],a[44:47],a[164:167],v[68:71]
M v[68:71],a[40:43],a[160:163],v[68:71]
M v[72:75],a[48:51],a[160:163],v[72:75]
s_nop 0
T a[124:125],v4,8192
T a[126:127],v4,9216
M v[72:75],a[52:55],a[164:167],v[72:75]
M v[76:79],a[60:63],a[164:167],v[76:79]
buffer_load_dwordx4 v11, s[16:19], s21 offen offset:3072  nt lds
M v[76:79],a[56:59],a[160:163],v[76:79]
SA s21,s21,524160
M v[80:83],a[64:67],a[160:163],v[80:83]
M v[80:83],a[68:71],a[164:167],v[80:83]
M v[84:87],a[76:79],a[164:167],v[84:87]
M v[84:87],a[72:75],a[160:163],v[84:87]
M v[88:91],a[80:83],a[160:163],v[88:91]
M v[88:91],a[84:87],a[164:167],v[88:91]
s_waitcnt lgkmcnt(2)
M v[92:95],a[92:95],a[164:167],v[92:95]
s_waitcnt vmcnt(16) lgkmcnt(0)
M v[92:95],a[88:91],a[160:163],v[92:95]
s_barrier
M v[124:127],a[88:91],a[168:171],v[124:127]
R a[160:163],v5,49152
R a[164:167],v6,49152
M v[124:127],a[92:95],a[172:175],v[124:127]
M v[120:123],a[84:87],a[172:175],v[120:123]
SA m0,s24,32768
T a[128:129],v1,16384
T a[130:131],v1,17408
M v[120:123],a[80:83],a[168:171],v[120:123]
buffer_load_dwordx4 v12, s[48:51], s22 offen offset:0   lds
M v[116:119],a[72:75],a[168:171],v[116:119]
v_min_u32 v16, 40, v0
v_lshlrev_b32 v16, 2, v16
M v[116:119],a[76:79],a[172:175],v[116:119]
buffer_load_dword v17, v16, s[12:15], 0 offen sc1
M v[112:115],a[68:71],a[172:175],v[112:115]
M v[112:115],a[64:67],a[168:171],v[112:115]
M v[108:111],a[56:59],a[168:171],v[108:111]
buffer_load_dwordx4 v13, s[48:51], s22 offen offset:1024   lds
M v[108:111],a[60:63],a[172:175],v[108:111]
s_nop 0
T a[132:133],v1,24576
T a[134:135],v1,25600
M v[104:107],a[52:55],a[172:175],v[104:107]
M v[104:107],a[48:51],a[168:171],v[104:107]
M v[100:103],a[40:43],a[168:171],v[100:103]
M v[100:103],a[44:47],a[172:175],v[100:103]
s_waitcnt lgkmcnt(4)
M v[96:99],a[36:39],a[172:175],v[96:99]
buffer_load_dwordx4 v14, s[48:51], s22 offen offset:2048   lds
M v[96:99],a[32:35],a[168:171],v[96:99]
M v[128:131],a[32:35],a[160:163],v[128:131]
R a[168:171],v5,51200
R a[172:175],v6,51200
M v[128:131],a[36:39],a[164:167],v[128:131]
T a[136:137],v2,16384
T a[138:139],v2,17408
M v[132:135],a[44:47],a[164:167],v[132:135]
M v[132:135],a[40:43],a[160:163],v[132:135]
M v[136:139],a[48:51],a[160:163],v[136:139]
buffer_load_dwordx4 v15, s[48:51], s22 offen offset:3072   lds
M v[136:139],a[52:55],a[164:167],v[136:139]
SA s22,s22,1048576
M v[140:143],a[60:63],a[164:167],v[140:143]
M v[140:143],a[56:59],a[160:163],v[140:143]
s_nop 0
T a[140:141],v2,24576
T a[142:143],v2,25600
M v[144:147],a[64:67],a[160:163],v[144:147]
SA m0,s23,0
M v[144:147],a[68:71],a[164:167],v[144:147]
buffer_load_dwordx4 v8, s[16:19], s21 offen offset:0  nt lds
M v[148:151],a[76:79],a[164:167],v[148:151]
M v[148:151],a[72:75],a[160:163],v[148:151]
M v[152:155],a[80:83],a[160:163],v[152:155]
M v[152:155],a[84:87],a[164:167],v[152:155]
s_waitcnt lgkmcnt(4)
M v[156:159],a[92:95],a[164:167],v[156:159]
s_nop 0
T a[144:145],v3,16384
T a[146:147],v3,17408
M v[156:159],a[88:91],a[160:163],v[156:159]
buffer_load_dwordx4 v9, s[16:19], s21 offen offset:1024  nt lds
M v[188:191],a[88:91],a[168:171],v[188:191]
R a[160:163],v5,53248
R a[164:167],v6,53248
M v[188:191],a[92:95],a[172:175],v[188:191]
M v[184:187],a[84:87],a[172:175],v[184:187]
M v[184:187],a[80:83],a[168:171],v[184:187]
M v[180:183],a[72:75],a[168:171],v[180:183]
M v[180:183],a[76:79],a[172:175],v[180:183]
s_nop 0
T a[148:149],v3,24576
T a[150:151],v3,25600
M v[176:179],a[68:71],a[172:175],v[176:179]
buffer_load_dwordx4 v10, s[16:19], s21 offen offset:2048  nt lds
M v[176:179],a[64:67],a[168:171],v[176:179]
M v[172:175],a[56:59],a[168:171],v[172:175]
M v[172:175],a[60:63],a[172:175],v[172:175]
M v[168:171],a[52:55],a[172:175],v[168:171]
buffer_load_dwordx4 v11, s[16:19], s21 offen offset:3072  nt lds
M v[168:171],a[48:51],a[168:171],v[168:171]
SA s21,s21,128
M v[164:167],a[40:43],a[168:171],v[164:167]
s_nop 0
T a[152:153],v4,16384
T a[154:155],v4,17408
M v[164:167],a[44:47],a[172:175],v[164:167]
s_waitcnt lgkmcnt(4)
M v[160:163],a[36:39],a[172:175],v[160:163]
M v[160:163],a[32:35],a[168:171],v[160:163]
SA m0,s87,0
M v[192:195],a[32:35],a[160:163],v[192:195]
R a[168:171],v5,55296
R a[172:175],v6,55296
M v[192:195],a[36:39],a[164:167],v[192:195]
buffer_load_dwordx4 v25, s[60:63], s89 offen offset:0 nt lds
M v[196:199],a[44:47],a[164:167],v[196:199]
SA s89,s89,114688
M v[196:199],a[40:43],a[160:163],v[196:199]
s_nop 0
T a[156:157],v4,24576
T a[158:159],v4,25600
M v[200:203],a[48:51],a[160:163],v[200:203]
M v[200:203],a[52:55],a[164:167],v[200:203]
SA m0,s87,1024
M v[204:207],a[60:63],a[164:167],v[204:207]
buffer_load_dwordx4 v25, s[60:63], s89 offen offset:0 nt lds
M v[204:207],a[56:59],a[160:163],v[204:207]
SA s89,s89,114688
M v[208:211],a[64:67],a[160:163],v[208:211]
M v[208:211],a[68:71],a[164:167],v[208:211]
M v[212:215],a[76:79],a[164:167],v[212:215]
M v[212:215],a[72:75],a[160:163],v[212:215]
M v[216:219],a[80:83],a[160:163],v[216:219]
M v[216:219],a[84:87],a[164:167],v[216:219]
s_waitcnt lgkmcnt(2)
M v[220:223],a[92:95],a[164:167],v[220:223]
s_waitcnt vmcnt(19) lgkmcnt(0)
M v[220:223],a[88:91],a[160:163],v[220:223]
s_barrier
M v[252:255],a[88:91],a[168:171],v[252:255]
R a[160:163],v5,0
R a[164:167],v6,0
M v[252:255],a[92:95],a[172:175],v[252:255]
M v[248:251],a[84:87],a[172:175],v[248:251]
M v[248:251],a[80:83],a[168:171],v[248:251]
M v[244:247],a[72:75],a[168:171],v[244:247]
M v[244:247],a[76:79],a[172:175],v[244:247]
M v[240:243],a[68:71],a[172:175],v[240:243]
M v[240:243],a[64:67],a[168:171],v[240:243]
M v[236:239],a[56:59],a[168:171],v[236:239]
M v[236:239],a[60:63],a[172:175],v[236:239]
M v[232:235],a[52:55],a[172:175],v[232:235]
M v[232:235],a[48:51],a[168:171],v[232:235]
M v[228:231],a[40:43],a[168:171],v[228:231]
M v[228:231],a[44:47],a[172:175],v[228:231]
s_waitcnt lgkmcnt(0)
M v[224:227],a[36:39],a[172:175],v[224:227]
M v[224:227],a[32:35],a[168:171],v[224:227]
M a[0:3],a[96:99],a[160:163],a[0:3]
R a[168:171],v5,2048
R a[172:175],v6,2048
M a[0:3],a[100:103],a[164:167],a[0:3]
T a[32:33],v1,32768
T a[34:35],v1,33792
M a[4:7],a[108:111],a[164:167],a[4:7]
SA m0,s24,49152
M a[4:7],a[104:107],a[160:163],a[4:7]
buffer_load_dwordx4 v12, s[48:51], s22 offen offset:0   lds
M a[8:11],a[112:115],a[160:163],a[8:11]
M a[8:11],a[116:119],a[164:167],a[8:11]
M a[12:15],a[124:127],a[164:167],a[12:15]
s_nop 0
T a[36:37],v1,40960
T a[38:39],v1,41984
M a[12:15],a[120:123],a[160:163],a[12:15]
M a[16:19],a[128:131],a[160:163],a[16:19]
buffer_load_dwordx4 v13, s[48:51], s22 offen offset:1024   lds
M a[16:19],a[132:135],a[164:167],a[16:19]
M a[20:23],a[140:143],a[164:167],a[20:23]
M a[20:23],a[136:139],a[160:163],a[20:23]
s_nop 0
T a[40:41],v2,32768
T a[42:43],v2,33792
M a[24:27],a[144:147],a[160:163],a[24:27]
M a[24:27],a[148:151],a[164:167],a[24:27]
s_waitcnt lgkmcnt(6)
buffer_load_dwordx4 v14, s[48:51], s22 offen offset:2048   lds
M a[28:31],a[156:159],a[164:167],a[28:31]
M a[28:31],a[152:155],a[160:163],a[28:31]
M v[60:63],a[152:155],a[168:171],v[60:63]
R a[160:163],v5,4096
R a[164:167],v6,4096
M v[60:63],a[156:159],a[172:175],v[60:63]
T a[44:45],v2,40960
T a[46:47],v2,41984
M v[56:59],a[148:151],a[172:175],v[56:59]
buffer_load_dwordx4 v15, s[48:51], s22 offen offset:3072   lds
M v[56:59],a[144:147],a[168:171],v[56:59]
s_sub_u32 s22, s22, 1048448
M v[52:55],a[136:139],a[168:171],v[52:55]
M v[52:55],a[140:143],a[172:175],v[52:55]
s_nop 0
T a[48:49],v3,32768
T a[50:51],v3,33792
M v[48:51],a[132:135],a[172:175],v[48:51]
SA m0,s23,16384
M v[48:51],a[128:131],a[168:171],v[48:51]
buffer_load_dwordx4 v8, s[16:19], s21 offen offset:0  nt lds
M v[44:47],a[120:123],a[168:171],v[44:47]
M v[44:47],a[124:127],a[172:175],v[44:47]
M v[40:43],a[116:119],a[172:175],v[40:43]
s_nop 0
T a[52:53],v3,40960
T a[54:55],v3,41984
M v[40:43],a[112:115],a[168:171],v[40:43]
M v[36:39],a[104:107],a[168:171],v[36:39]
buffer_load_dwordx4 v9, s[16:19], s21 offen offset:1024  nt lds
M v[36:39],a[108:111],a[172:175],v[36:39]
s_waitcnt lgkmcnt(6)
M v[32:35],a[100:103],a[172:175],v[32:35]
M v[32:35],a[96:99],a[168:171],v[32:35]
s_nop 0
T a[56:57],v4,32768
L_w_kv02:
s_cbranch_execz L_w_kv06
T a[58:59],v4,33792
M v[64:67],a[96:99],a[160:163],v[64:67]
R a[168:171],v5,6144
R a[172:175],v6,6144
M v[64:67],a[100:103],a[164:167],v[64:67]
buffer_load_dwordx4 v10, s[16:19], s21 offen offset:2048  nt lds
M v[68:71],a[108:111],a[164:167],v[68:71]
M v[68:71],a[104:107],a[160:163],v[68:71]
M v[72:75],a[112:115],a[160:163],v[72:75]
s_nop 0
T a[60:61],v4,40960
T a[62:63],v4,41984
M v[72:75],a[116:119],a[164:167],v[72:75]
M v[76:79],a[124:127],a[164:167],v[76:79]
buffer_load_dwordx4 v11, s[16:19], s21 offen offset:3072  nt lds
M v[76:79],a[120:123],a[160:163],v[76:79]
SA s21,s21,524160
M v[80:83],a[128:131],a[160:163],v[80:83]
M v[80:83],a[132:135],a[164:167],v[80:83]
M v[84:87],a[140:143],a[164:167],v[84:87]
M v[84:87],a[136:139],a[160:163],v[84:87]
M v[88:91],a[144:147],a[160:163],v[88:91]
M v[88:91],a[148:151],a[164:167],v[88:91]
s_waitcnt lgkmcnt(2)
M v[92:95],a[156:159],a[164:167],v[92:95]
s_waitcnt vmcnt(19) lgkmcnt(0)
M v[92:95],a[152:155],a[160:163],v[92:95]
s_barrier
M v[124:127],a[152:155],a[168:171],v[124:127]
R a[160:163],v5,16384
R a[164:167],v6,16384
M v[124:127],a[156:159],a[172:175],v[124:127]
M v[120:123],a[148:151],a[172:175],v[120:123]
SA m0,s24,0
T a[64:65],v1,49152
T a[66:67],v1,50176
M v[120:123],a[144:147],a[168:171],v[120:123]
buffer_load_dwordx4 v12, s[48:51], s22 offen offset:0   lds
M v[116:119],a[136:139],a[168:171],v[116:119]
M v[116:119],a[140:143],a[172:175],v[116:119]
M v[112:115],a[132:135],a[172:175],v[112:115]
M v[112:115],a[128:131],a[168:171],v[112:115]
M v[108:111],a[120:123],a[168:171],v[108:111]
buffer_load_dwordx4 v13, s[48:51], s22 offen offset:1024   lds
M v[108:111],a[124:127],a[172:175],v[108:111]
s_nop 0
T a[68:69],v1,57344
T a[70:71],v1,58368
M v[104:107],a[116:119],a[172:175],v[104:107]
M v[104:107],a[112:115],a[168:171],v[104:107]
M v[100:103],a[104:107],a[168:171],v[100:103]
M v[100:103],a[108:111],a[172:175],v[100:103]
s_waitcnt lgkmcnt(4)
M v[96:99],a[100:103],a[172:175],v[96:99]
buffer_load_dwordx4 v14, s[48:51], s22 offen offset:2048   lds
M v[96:99],a[96:99],a[168:171],v[96:99]
M v[128:131],a[96:99],a[160:163],v[128:131]
R a[168:171],v5,18432
R a[172:175],v6,18432
M v[128:131],a[100:103],a[164:167],v[128:131]
T a[72:73],v2,49152
T a[74:75],v2,50176
M v[132:135],a[108:111],a[164:167],v[132:135]
M v[132:135],a[104:107],a[160:163],v[132:135]
M v[136:139],a[112:115],a[160:163],v[136:139]
buffer_load_dwordx4 v15, s[48:51], s22 offen offset:3072   lds
M v[136:139],a[116:119],a[164:167],v[136:139]
SA s22,s22,1048576
M v[140:143],a[124:127],a[164:167],v[140:143]
M v[140:143],a[120:123],a[160:163],v[140:143]
s_nop 0
T a[76:77],v2,57344
T a[78:79],v2,58368
M v[144:147],a[128:131],a[160:163],v[144:147]
SA m0,s23,32768
M v[144:147],a[132:135],a[164:167],v[144:147]
buffer_load_dwordx4 v8, s[16:19], s21 offen offset:0  nt lds
M v[148:151],a[140:143],a[164:167],v[148:151]
M v[148:151],a[136:139],a[160:163],v[148:151]
M v[152:155],a[144:147],a[160:163],v[152:155]
M v[152:155],a[148:151],a[164:167],v[152:155]
s_waitcnt lgkmcnt(4)
M v[156:159],a[156:159],a[164:167],v[156:159]
s_nop 0
T a[80:81],v3,49152
T a[82:83],v3,50176
M v[156:159],a[152:155],a[160:163],v[156:159]
buffer_load_dwordx4 v9, s[16:19], s21 offen offset:1024  nt lds
M v[188:191],a[152:155],a[168:171],v[188:191]
R a[160:163],v5,20480
R a[164:167],v6,20480
M v[188:191],a[156:159],a[172:175],v[188:191]
M v[184:187],a[148:151],a[172:175],v[184:187]
M v[184:187],a[144:147],a[168:171],v[184:187]
M v[180:183],a[136:139],a[168:171],v[180:183]
M v[180:183],a[140:143],a[172:175],v[180:183]
s_nop 0
T a[84:85],v3,57344
T a[86:87],v3,58368
M v[176:179],a[132:135],a[172:175],v[176:179]
buffer_load_dwordx4 v10, s[16:19], s21 offen offset:2048  nt lds
M v[176:179],a[128:131],a[168:171],v[176:179]
M v[172:175],a[120:123],a[168:171],v[172:175]
M v[172:175],a[124:127],a[172:175],v[172:175]
M v[168:171],a[116:119],a[172:175],v[168:171]
buffer_load_dwordx4 v11, s[16:19], s21 offen offset:3072  nt lds
M v[168:171],a[112:115],a[168:171],v[168:171]
SA s21,s21,128
M v[164:167],a[104:107],a[168:171],v[164:167]
s_nop 0
T a[88:89],v4,49152
T a[90:91],v4,50176
M v[164:167],a[108:111],a[172:175],v[164:167]
s_waitcnt lgkmcnt(4)
M v[160:163],a[100:103],a[172:175],v[160:163]
M v[160:163],a[96:99],a[168:171],v[160:163]
SA m0,s87,2048
M v[192:195],a[96:99],a[160:163],v[192:195]
R a[168:171],v5,22528
R a[172:175],v6,22528
M v[192:195],a[100:103],a[164:167],v[192:195]
buffer_load_dwordx4 v25, s[60:63], s89 offen offset:0 nt lds
M v[196:199],a[108:111],a[164:167],v[196:199]
SA s89,s89,114688
M v[196:199],a[104:107],a[160:163],v[196:199]
s_nop 0
T a[92:93],v4,57344
T a[94:95],v4,58368
M v[200:203],a[112:115],a[160:163],v[200:203]
M v[200:203],a[116:119],a[164:167],v[200:203]
SA m0,s87,3072
M v[204:207],a[124:127],a[164:167],v[204:207]
buffer_load_dwordx4 v25, s[60:63], s89 offen offset:0 nt lds
M v[204:207],a[120:123],a[160:163],v[204:207]
SA s89,s89,114688
M v[208:211],a[128:131],a[160:163],v[208:211]
M v[208:211],a[132:135],a[164:167],v[208:211]
M v[212:215],a[140:143],a[164:167],v[212:215]
M v[212:215],a[136:139],a[160:163],v[212:215]
M v[216:219],a[144:147],a[160:163],v[216:219]
M v[216:219],a[148:151],a[164:167],v[216:219]
s_waitcnt lgkmcnt(2)
M v[220:223],a[156:159],a[164:167],v[220:223]
s_waitcnt vmcnt(20) lgkmcnt(0)
M v[220:223],a[152:155],a[160:163],v[220:223]
s_barrier
M v[252:255],a[152:155],a[168:171],v[252:255]
R a[160:163],v5,32768
R a[164:167],v6,32768
M v[252:255],a[156:159],a[172:175],v[252:255]
v_cmp_ne_u32 vcc, 1, v17
M v[248:251],a[148:151],a[172:175],v[248:251]
s_nop 0
M v[248:251],a[144:147],a[168:171],v[248:251]
s_cbranch_vccnz L_zs0
L_zr0:
M v[244:247],a[136:139],a[168:171],v[244:247]
M v[244:247],a[140:143],a[172:175],v[244:247]
M v[240:243],a[132:135],a[172:175],v[240:243]
M v[240:243],a[128:131],a[168:171],v[240:243]
M v[236:239],a[120:123],a[168:171],v[236:239]
M v[236:239],a[124:127],a[172:175],v[236:239]
M v[232:235],a[116:119],a[172:175],v[232:235]
M v[232:235],a[112:115],a[168:171],v[232:235]
M v[228:231],a[104:107],a[168:171],v[228:231]
M v[228:231],a[108:111],a[172:175],v[228:231]
s_waitcnt lgkmcnt(0)
M v[224:227],a[100:103],a[172:175],v[224:227]
M v[224:227],a[96:99],a[168:171],v[224:227]
M a[0:3],a[32:35],a[160:163],a[0:3]
R a[168:171],v5,34816
R a[172:175],v6,34816
M a[0:3],a[36:39],a[164:167],a[0:3]
T a[96:97],v1,0
T a[98:99],v1,1024
M a[4:7],a[44:47],a[164:167],a[4:7]
SA m0,s24,16384
M a[4:7],a[40:43],a[160:163],a[4:7]
buffer_load_dwordx4 v12, s[48:51], s22 offen offset:0   lds
M a[8:11],a[48:51],a[160:163],a[8:11]
M a[8:11],a[52:55],a[164:167],a[8:11]
s_mul_i32 s64, s41, 229376
M a[12:15],a[60:63],a[164:167],a[12:15]
SA s72,s90,s64
T a[100:101],v1,8192
T a[102:103],v1,9216
M a[12:15],a[56:59],a[160:163],a[12:15]
s_addc_u32 s73, s91, 0
M a[16:19],a[64:67],a[160:163],a[16:19]
s_sub_u32 s75, 3670016, s64
buffer_load_dwordx4 v13, s[48:51], s22 offen offset:1024   lds
M a[16:19],a[68:71],a[164:167],a[16:19]
s_mov_b32 s12, s72
M a[20:23],a[76:79],a[164:167],a[20:23]
s_and_b32 s13, s73, 0xffff
M a[20:23],a[72:75],a[160:163],a[20:23]
s_mov_b32 s14, s75
T a[104:105],v2,0
T a[106:107],v2,1024
M a[24:27],a[80:83],a[160:163],a[24:27]
s_mov_b32 s15, 0x20000
M a[24:27],a[84:87],a[164:167],a[24:27]
s_waitcnt lgkmcnt(6)
buffer_load_dwordx4 v14, s[48:51], s22 offen offset:2048   lds
M a[28:31],a[92:95],a[164:167],a[28:31]
M a[28:31],a[88:91],a[160:163],a[28:31]
M v[60:63],a[88:91],a[168:171],v[60:63]
R a[160:163],v5,36864
R a[164:167],v6,36864
M v[60:63],a[92:95],a[172:175],v[60:63]
T a[108:109],v2,8192
T a[110:111],v2,9216
M v[56:59],a[84:87],a[172:175],v[56:59]
buffer_load_dwordx4 v15, s[48:51], s22 offen offset:3072   lds
M v[56:59],a[80:83],a[168:171],v[56:59]
s_sub_u32 s22, s22, 1048448
M v[52:55],a[72:75],a[168:171],v[52:55]
M v[52:55],a[76:79],a[172:175],v[52:55]
s_nop 0
T a[112:113],v3,0
T a[114:115],v3,1024
M v[48:51],a[68:71],a[172:175],v[48:51]
SA m0,s23,49152
M v[48:51],a[64:67],a[168:171],v[48:51]
buffer_load_dwordx4 v8, s[16:19], s21 offen offset:0  nt lds
M v[44:47],a[56:59],a[168:171],v[44:47]
M v[44:47],a[60:63],a[172:175],v[44:47]
M v[40:43],a[52:55],a[172:175],v[40:43]
s_nop 0
T a[116:117],v3,8192
T a[118:119],v3,9216
M v[40:43],a[48:51],a[168:171],v[40:43]
M v[36:39],a[40:43],a[168:171],v[36:39]
buffer_load_dwordx4 v9, s[16:19], s21 offen offset:1024  nt lds
M v[36:39],a[44:47],a[172:175],v[36:39]
s_waitcnt lgkmcnt(6)
M v[32:35],a[36:39],a[172:175],v[32:35]
M v[32:35],a[32:35],a[168:171],v[32:35]
s_nop 0
T a[120:121],v4,0
T a[122:123],v4,1024
M v[64:67],a[32:35],a[160:163],v[64:67]
R a[168:171],v5,38912
R a[172:175],v6,38912
M v[64:67],a[36:39],a[164:167],v[64:67]
buffer_load_dwordx4 v10, s[16:19], s21 offen offset:2048  nt lds
M v[68:71],a[44:47],a[164:167],v[68:71]
M v[68:71],a[40:43],a[160:163],v[68:71]
M v[72:75],a[48:51],a[160:163],v[72:75]
s_nop 0
T a[124:125],v4,8192
T a[126:127],v4,9216
M v[72:75],a[52:55],a[164:167],v[72:75]
M v[76:79],a[60:63],a[164:167],v[76:79]
buffer_load_dwordx4 v11, s[16:19], s21 offen offset:3072  nt lds
M v[76:79],a[56:59],a[160:163],v[76:79]
SA s21,s21,524160
M v[80:83],a[64:67],a[160:163],v[80:83]
M v[80:83],a[68:71],a[164:167],v[80:83]
M v[84:87],a[76:79],a[164:167],v[84:87]
M v[84:87],a[72:75],a[160:163],v[84:87]
M v[88:91],a[80:83],a[160:163],v[88:91]
M v[88:91],a[84:87],a[164:167],v[88:91]
s_waitcnt lgkmcnt(2)
M v[92:95],a[92:95],a[164:167],v[92:95]
s_waitcnt vmcnt(18) lgkmcnt(0)
M v[92:95],a[88:91],a[160:163],v[92:95]
s_barrier
M v[124:127],a[88:91],a[168:171],v[124:127]
R a[160:163],v5,49152
R a[164:167],v6,49152
M v[124:127],a[92:95],a[172:175],v[124:127]
M v[120:123],a[84:87],a[172:175],v[120:123]
SA m0,s24,32768
T a[128:129],v1,16384
T a[130:131],v1,17408
M v[120:123],a[80:83],a[168:171],v[120:123]
buffer_load_dwordx4 v12, s[48:51], s22 offen offset:0   lds
M v[116:119],a[72:75],a[168:171],v[116:119]
M v[116:119],a[76:79],a[172:175],v[116:119]
M v[112:115],a[68:71],a[172:175],v[112:115]
M v[112:115],a[64:67],a[168:171],v[112:115]
M v[108:111],a[56:59],a[168:171],v[108:111]
buffer_load_dwordx4 v13, s[48:51], s22 offen offset:1024   lds
M v[108:111],a[60:63],a[172:175],v[108:111]
s_nop 0
T a[132:133],v1,24576
T a[134:135],v1,25600
M v[104:107],a[52:55],a[172:175],v[104:107]
M v[104:107],a[48:51],a[168:171],v[104:107]
M v[100:103],a[40:43],a[168:171],v[100:103]
M v[100:103],a[44:47],a[172:175],v[100:103]
s_waitcnt lgkmcnt(4)
M v[96:99],a[36:39],a[172:175],v[96:99]
buffer_load_dwordx4 v14, s[48:51], s22 offen offset:2048   lds
M v[96:99],a[32:35],a[168:171],v[96:99]
M v[128:131],a[32:35],a[160:163],v[128:131]
R a[168:171],v5,51200
R a[172:175],v6,51200
M v[128:131],a[36:39],a[164:167],v[128:131]
T a[136:137],v2,16384
T a[138:139],v2,17408
M v[132:135],a[44:47],a[164:167],v[132:135]
M v[132:135],a[40:43],a[160:163],v[132:135]
M v[136:139],a[48:51],a[160:163],v[136:139]
buffer_load_dwordx4 v15, s[48:51], s22 offen offset:3072   lds
M v[136:139],a[52:55],a[164:167],v[136:139]
SA s22,s22,1048576
M v[140:143],a[60:63],a[164:167],v[140:143]
M v[140:143],a[56:59],a[160:163],v[140:143]
s_nop 0
T a[140:141],v2,24576
T a[142:143],v2,25600
M v[144:147],a[64:67],a[160:163],v[144:147]
SA m0,s23,0
M v[144:147],a[68:71],a[164:167],v[144:147]
buffer_load_dwordx4 v8, s[16:19], s21 offen offset:0  nt lds
M v[148:151],a[76:79],a[164:167],v[148:151]
M v[148:151],a[72:75],a[160:163],v[148:151]
M v[152:155],a[80:83],a[160:163],v[152:155]
M v[152:155],a[84:87],a[164:167],v[152:155]
s_waitcnt lgkmcnt(4)
M v[156:159],a[92:95],a[164:167],v[156:159]
s_nop 0
T a[144:145],v3,16384
T a[146:147],v3,17408
M v[156:159],a[88:91],a[160:163],v[156:159]
buffer_load_dwordx4 v9, s[16:19], s21 offen offset:1024  nt lds
M v[188:191],a[88:91],a[168:171],v[188:191]
R a[160:163],v5,53248
R a[164:167],v6,53248
M v[188:191],a[92:95],a[172:175],v[188:191]
M v[184:187],a[84:87],a[172:175],v[184:187]
M v[184:187],a[80:83],a[168:171],v[184:187]
M v[180:183],a[72:75],a[168:171],v[180:183]
M v[180:183],a[76:79],a[172:175],v[180:183]
s_nop 0
T a[148:149],v3,24576
T a[150:151],v3,25600
M v[176:179],a[68:71],a[172:175],v[176:179]
buffer_load_dwordx4 v10, s[16:19], s21 offen offset:2048  nt lds
M v[176:179],a[64:67],a[168:171],v[176:179]
M v[172:175],a[56:59],a[168:171],v[172:175]
M v[172:175],a[60:63],a[172:175],v[172:175]
M v[168:171],a[52:55],a[172:175],v[168:171]
buffer_load_dwordx4 v11, s[16:19], s21 offen offset:3072  nt lds
M v[168:171],a[48:51],a[168:171],v[168:171]
SA s21,s21,128
M v[164:167],a[40:43],a[168:171],v[164:167]
s_nop 0
T a[152:153],v4,16384
T a[154:155],v4,17408
M v[164:167],a[44:47],a[172:175],v[164:167]
s_waitcnt lgkmcnt(4)
M v[160:163],a[36:39],a[172:175],v[160:163]
M v[160:163],a[32:35],a[168:171],v[160:163]
SA m0,s87,4096
M v[192:195],a[32:35],a[160:163],v[192:195]
R a[168:171],v5,55296
R a[172:175],v6,55296
M v[192:195],a[36:39],a[164:167],v[192:195]
buffer_load_dwordx4 v25, s[60:63], s89 offen offset:0 nt lds
M v[196:199],a[44:47],a[164:167],v[196:199]
SA s89,s89,114688
M v[196:199],a[40:43],a[160:163],v[196:199]
s_nop 0
T a[156:157],v4,24576
T a[158:159],v4,25600
M v[200:203],a[48:51],a[160:163],v[200:203]
M v[200:203],a[52:55],a[164:167],v[200:203]
SA m0,s87,5120
M v[204:207],a[60:63],a[164:167],v[204:207]
buffer_load_dwordx4 v25, s[60:63], s89 offen offset:0 nt lds
M v[204:207],a[56:59],a[160:163],v[204:207]
SA s89,s89,114688
M v[208:211],a[64:67],a[160:163],v[208:211]
M v[208:211],a[68:71],a[164:167],v[208:211]
M v[212:215],a[76:79],a[164:167],v[212:215]
M v[212:215],a[72:75],a[160:163],v[212:215]
M v[216:219],a[80:83],a[160:163],v[216:219]
M v[216:219],a[84:87],a[164:167],v[216:219]
s_waitcnt lgkmcnt(2)
M v[220:223],a[92:95],a[164:167],v[220:223]
s_waitcnt vmcnt(20) lgkmcnt(0)
M v[220:223],a[88:91],a[160:163],v[220:223]
s_barrier
M v[252:255],a[88:91],a[168:171],v[252:255]
R a[160:163],v5,0
R a[164:167],v6,0
M v[252:255],a[92:95],a[172:175],v[252:255]
M v[248:251],a[84:87],a[172:175],v[248:251]
M v[248:251],a[80:83],a[168:171],v[248:251]
M v[244:247],a[72:75],a[168:171],v[244:247]
M v[244:247],a[76:79],a[172:175],v[244:247]
M v[240:243],a[68:71],a[172:175],v[240:243]
M v[240:243],a[64:67],a[168:171],v[240:243]
M v[236:239],a[56:59],a[168:171],v[236:239]
M v[236:239],a[60:63],a[172:175],v[236:239]
M v[232:235],a[52:55],a[172:175],v[232:235]
M v[232:235],a[48:51],a[168:171],v[232:235]
M v[228:231],a[40:43],a[168:171],v[228:231]
M v[228:231],a[44:47],a[172:175],v[228:231]
s_waitcnt lgkmcnt(0)
M v[224:227],a[36:39],a[172:175],v[224:227]
M v[224:227],a[32:35],a[168:171],v[224:227]
M a[0:3],a[96:99],a[160:163],a[0:3]
R a[168:171],v5,2048
R a[172:175],v6,2048
M a[0:3],a[100:103],a[164:167],a[0:3]
T a[32:33],v1,32768
T a[34:35],v1,33792
M a[4:7],a[108:111],a[164:167],a[4:7]
SA m0,s24,49152
M a[4:7],a[104:107],a[160:163],a[4:7]
buffer_load_dwordx4 v12, s[48:51], s22 offen offset:0   lds
M a[8:11],a[112:115],a[160:163],a[8:11]
M a[8:11],a[116:119],a[164:167],a[8:11]
M a[12:15],a[124:127],a[164:167],a[12:15]
s_nop 0
T a[36:37],v1,40960
T a[38:39],v1,41984
M a[12:15],a[120:123],a[160:163],a[12:15]
M a[16:19],a[128:131],a[160:163],a[16:19]
buffer_load_dwordx4 v13, s[48:51], s22 offen offset:1024   lds
M a[16:19],a[132:135],a[164:167],a[16:19]
M a[20:23],a[140:143],a[164:167],a[20:23]
M a[20:23],a[136:139],a[160:163],a[20:23]
s_nop 0
T a[40:41],v2,32768
T a[42:43],v2,33792
M a[24:27],a[144:147],a[160:163],a[24:27]
M a[24:27],a[148:151],a[164:167],a[24:27]
s_waitcnt lgkmcnt(6)
buffer_load_dwordx4 v14, s[48:51], s22 offen offset:2048   lds
M a[28:31],a[156:159],a[164:167],a[28:31]
M a[28:31],a[152:155],a[160:163],a[28:31]
M v[60:63],a[152:155],a[168:171],v[60:63]
R a[160:163],v5,4096
R a[164:167],v6,4096
M v[60:63],a[156:159],a[172:175],v[60:63]
T a[44:45],v2,40960
T a[46:47],v2,41984
M v[56:59],a[148:151],a[172:175],v[56:59]
buffer_load_dwordx4 v15, s[48:51], s22 offen offset:3072   lds
M v[56:59],a[144:147],a[168:171],v[56:59]
s_sub_u32 s22, s22, 1048448
M v[52:55],a[136:139],a[168:171],v[52:55]
M v[52:55],a[140:143],a[172:175],v[52:55]
s_nop 0
T a[48:49],v3,32768
T a[50:51],v3,33792
M v[48:51],a[132:135],a[172:175],v[48:51]
SA m0,s23,16384
M v[48:51],a[128:131],a[168:171],v[48:51]
buffer_load_dwordx4 v8, s[16:19], s21 offen offset:0  nt lds
M v[44:47],a[120:123],a[168:171],v[44:47]
M v[44:47],a[124:127],a[172:175],v[44:47]
M v[40:43],a[116:119],a[172:175],v[40:43]
s_nop 0
T a[52:53],v3,40960
T a[54:55],v3,41984
M v[40:43],a[112:115],a[168:171],v[40:43]
M v[36:39],a[104:107],a[168:171],v[36:39]
buffer_load_dwordx4 v9, s[16:19], s21 offen offset:1024  nt lds
M v[36:39],a[108:111],a[172:175],v[36:39]
s_waitcnt lgkmcnt(6)
M v[32:35],a[100:103],a[172:175],v[32:35]
M v[32:35],a[96:99],a[168:171],v[32:35]
s_nop 0
T a[56:57],v4,32768
T a[58:59],v4,33792
M v[64:67],a[96:99],a[160:163],v[64:67]
R a[168:171],v5,6144
R a[172:175],v6,6144
M v[64:67],a[100:103],a[164:167],v[64:67]
buffer_load_dwordx4 v10, s[16:19], s21 offen offset:2048  nt lds
M v[68:71],a[108:111],a[164:167],v[68:71]
M v[68:71],a[104:107],a[160:163],v[68:71]
M v[72:75],a[112:115],a[160:163],v[72:75]
s_nop 0
T a[60:61],v4,40960
T a[62:63],v4,41984
M v[72:75],a[116:119],a[164:167],v[72:75]
M v[76:79],a[124:127],a[164:167],v[76:79]
buffer_load_dwordx4 v11, s[16:19], s21 offen offset:3072  nt lds
M v[76:79],a[120:123],a[160:163],v[76:79]
SA s21,s21,524160
M v[80:83],a[128:131],a[160:163],v[80:83]
M v[80:83],a[132:135],a[164:167],v[80:83]
M v[84:87],a[140:143],a[164:167],v[84:87]
M v[84:87],a[136:139],a[160:163],v[84:87]
M v[88:91],a[144:147],a[160:163],v[88:91]
M v[88:91],a[148:151],a[164:167],v[88:91]
s_waitcnt lgkmcnt(2)
M v[92:95],a[156:159],a[164:167],v[92:95]
s_waitcnt vmcnt(18) lgkmcnt(0)
M v[92:95],a[152:155],a[160:163],v[92:95]
s_barrier
M v[124:127],a[152:155],a[168:171],v[124:127]
R a[160:163],v5,16384
R a[164:167],v6,16384
M v[124:127],a[156:159],a[172:175],v[124:127]
M v[120:123],a[148:151],a[172:175],v[120:123]
SA m0,s24,0
T a[64:65],v1,49152
T a[66:67],v1,50176
M v[120:123],a[144:147],a[168:171],v[120:123]
buffer_load_dwordx4 v12, s[48:51], s22 offen offset:0   lds
M v[116:119],a[136:139],a[168:171],v[116:119]
M v[116:119],a[140:143],a[172:175],v[116:119]
M v[112:115],a[132:135],a[172:175],v[112:115]
M v[112:115],a[128:131],a[168:171],v[112:115]
M v[108:111],a[120:123],a[168:171],v[108:111]
M v[108:111],a[124:127],a[172:175],v[108:111]
s_nop 0
T a[68:69],v1,57344
T a[70:71],v1,58368
M v[104:107],a[116:119],a[172:175],v[104:107]
buffer_load_dwordx4 v13, s[48:51], s22 offen offset:1024   lds
M v[104:107],a[112:115],a[168:171],v[104:107]
M v[100:103],a[104:107],a[168:171],v[100:103]
M v[100:103],a[108:111],a[172:175],v[100:103]
s_waitcnt lgkmcnt(4)
M v[96:99],a[100:103],a[172:175],v[96:99]
M v[96:99],a[96:99],a[168:171],v[96:99]
buffer_load_dwordx4 v14, s[48:51], s22 offen offset:2048   lds
M v[128:131],a[96:99],a[160:163],v[128:131]
R a[168:171],v5,18432
R a[172:175],v6,18432
M v[128:131],a[100:103],a[164:167],v[128:131]
s_lshl_b32 s67, s20, 11
T a[72:73],v2,49152
T a[74:75],v2,50176
M v[132:135],a[108:111],a[164:167],v[132:135]
SA s67,s67,104914944
buffer_load_dwordx4 v[16:19], v7, s[8:11], s67 offen offset:0 sc1
M v[132:135],a[104:107],a[160:163],v[132:135]
M v[136:139],a[112:115],a[160:163],v[136:139]
buffer_load_dwordx4 v[20:23], v7, s[8:11], s67 offen offset:1024 sc1
M v[136:139],a[116:119],a[164:167],v[136:139]
M v[140:143],a[124:127],a[164:167],v[140:143]
buffer_load_dwordx4 v15, s[48:51], s22 offen offset:3072   lds
M v[140:143],a[120:123],a[160:163],v[140:143]
SA s22,s22,1048576
L_w_kv03:
s_cbranch_execz L_w_kv07
T a[76:77],v2,57344
T a[78:79],v2,58368
M v[144:147],a[128:131],a[160:163],v[144:147]
M v[144:147],a[132:135],a[164:167],v[144:147]
M v[148:151],a[140:143],a[164:167],v[148:151]
M v[148:151],a[136:139],a[160:163],v[148:151]
SA m0,s23,32768
M v[152:155],a[144:147],a[160:163],v[152:155]
buffer_load_dwordx4 v8, s[16:19], s21 offen offset:0  nt lds
M v[152:155],a[148:151],a[164:167],v[152:155]
s_waitcnt lgkmcnt(4)
M v[156:159],a[156:159],a[164:167],v[156:159]
s_nop 0
T a[80:81],v3,49152
T a[82:83],v3,50176
M v[156:159],a[152:155],a[160:163],v[156:159]
M v[188:191],a[152:155],a[168:171],v[188:191]
R a[160:163],v5,20480
R a[164:167],v6,20480
M v[188:191],a[156:159],a[172:175],v[188:191]
M v[184:187],a[148:151],a[172:175],v[184:187]
buffer_load_dwordx4 v9, s[16:19], s21 offen offset:1024  nt lds
M v[184:187],a[144:147],a[168:171],v[184:187]
M v[180:183],a[136:139],a[168:171],v[180:183]
M v[180:183],a[140:143],a[172:175],v[180:183]
s_nop 0
T a[84:85],v3,57344
T a[86:87],v3,58368
M v[176:179],a[132:135],a[172:175],v[176:179]
M v[176:179],a[128:131],a[168:171],v[176:179]
M v[172:175],a[120:123],a[168:171],v[172:175]
M v[172:175],a[124:127],a[172:175],v[172:175]
buffer_load_dwordx4 v10, s[16:19], s21 offen offset:2048  nt lds
M v[168:171],a[116:119],a[172:175],v[168:171]
M v[168:171],a[112:115],a[168:171],v[168:171]
M v[164:167],a[104:107],a[168:171],v[164:167]
s_nop 0
T a[88:89],v4,49152
T a[90:91],v4,50176
M v[164:167],a[108:111],a[172:175],v[164:167]
s_waitcnt lgkmcnt(4)
M v[160:163],a[100:103],a[172:175],v[160:163]
M v[160:163],a[96:99],a[168:171],v[160:163]
buffer_load_dwordx4 v11, s[16:19], s21 offen offset:3072  nt lds
M v[192:195],a[96:99],a[160:163],v[192:195]
SA s21,s21,128
R a[168:171],v5,22528
R a[172:175],v6,22528
M v[192:195],a[100:103],a[164:167],v[192:195]
M v[196:199],a[108:111],a[164:167],v[196:199]
M v[196:199],a[104:107],a[160:163],v[196:199]
s_nop 0
T a[92:93],v4,57344
T a[94:95],v4,58368
M v[200:203],a[112:115],a[160:163],v[200:203]
SA m0,s87,6144
M v[200:203],a[116:119],a[164:167],v[200:203]
buffer_load_dwordx4 v25, s[60:63], s89 offen offset:0 nt lds
M v[204:207],a[124:127],a[164:167],v[204:207]
SA s89,s89,114688
M v[204:207],a[120:123],a[160:163],v[204:207]
M v[208:211],a[128:131],a[160:163],v[208:211]
M v[208:211],a[132:135],a[164:167],v[208:211]
M v[212:215],a[140:143],a[164:167],v[212:215]
M v[212:215],a[136:139],a[160:163],v[212:215]
M v[216:219],a[144:147],a[160:163],v[216:219]
M v[216:219],a[148:151],a[164:167],v[216:219]
s_waitcnt lgkmcnt(2)
M v[220:223],a[156:159],a[164:167],v[220:223]
s_waitcnt vmcnt(21) lgkmcnt(0)
M v[220:223],a[152:155],a[160:163],v[220:223]
s_barrier
M v[252:255],a[152:155],a[168:171],v[252:255]
R a[160:163],v5,32768
R a[164:167],v6,32768
M v[252:255],a[156:159],a[172:175],v[252:255]
M v[248:251],a[148:151],a[172:175],v[248:251]
M v[248:251],a[144:147],a[168:171],v[248:251]
M v[244:247],a[136:139],a[168:171],v[244:247]
M v[244:247],a[140:143],a[172:175],v[244:247]
M v[240:243],a[132:135],a[172:175],v[240:243]
M v[240:243],a[128:131],a[168:171],v[240:243]
M v[236:239],a[120:123],a[168:171],v[236:239]
M v[236:239],a[124:127],a[172:175],v[236:239]
M v[232:235],a[116:119],a[172:175],v[232:235]
M v[232:235],a[112:115],a[168:171],v[232:235]
M v[228:231],a[104:107],a[168:171],v[228:231]
M v[228:231],a[108:111],a[172:175],v[228:231]
s_waitcnt lgkmcnt(0)
M v[224:227],a[100:103],a[172:175],v[224:227]
M v[224:227],a[96:99],a[168:171],v[224:227]
M a[0:3],a[32:35],a[160:163],a[0:3]
R a[168:171],v5,34816
R a[172:175],v6,34816
M a[0:3],a[36:39],a[164:167],a[0:3]
T a[96:97],v1,0
T a[98:99],v1,1024
M a[4:7],a[44:47],a[164:167],a[4:7]
SA m0,s24,16384
M a[4:7],a[40:43],a[160:163],a[4:7]
buffer_load_dwordx4 v12, s[48:51], s22 offen offset:0   lds
M a[8:11],a[48:51],a[160:163],a[8:11]
M a[8:11],a[52:55],a[164:167],a[8:11]
M a[12:15],a[60:63],a[164:167],a[12:15]
s_nop 0
T a[100:101],v1,8192
T a[102:103],v1,9216
M a[12:15],a[56:59],a[160:163],a[12:15]
M a[16:19],a[64:67],a[160:163],a[16:19]
buffer_load_dwordx4 v13, s[48:51], s22 offen offset:1024   lds
M a[16:19],a[68:71],a[164:167],a[16:19]
M a[20:23],a[76:79],a[164:167],a[20:23]
s_waitcnt vmcnt(9)
v_min3_u32 v28, v16, v17, v18
M a[20:23],a[72:75],a[160:163],a[20:23]
s_nop 0
T a[104:105],v2,0
T a[106:107],v2,1024
M a[24:27],a[80:83],a[160:163],a[24:27]
s_waitcnt vmcnt(8)
v_min3_u32 v28, v28, v19, v20
M a[24:27],a[84:87],a[164:167],a[24:27]
s_waitcnt lgkmcnt(6)
buffer_load_dwordx4 v14, s[48:51], s22 offen offset:2048   lds
M a[28:31],a[92:95],a[164:167],a[28:31]
v_min3_u32 v28, v28, v21, v22
M a[28:31],a[88:91],a[160:163],a[28:31]
v_min_u32 v28, v28, v23
M v[60:63],a[88:91],a[168:171],v[60:63]
R a[160:163],v5,36864
R a[164:167],v6,36864
M v[60:63],a[92:95],a[172:175],v[60:63]
T a[108:109],v2,8192
T a[110:111],v2,9216
M v[56:59],a[84:87],a[172:175],v[56:59]
buffer_load_dwordx4 v15, s[48:51], s22 offen offset:3072   lds
M v[56:59],a[80:83],a[168:171],v[56:59]
s_sub_u32 s22, s22, 1048448
v_cmp_eq_u32 vcc, 0, v28
M v[52:55],a[72:75],a[168:171],v[52:55]
s_nop 0
M v[52:55],a[76:79],a[172:175],v[52:55]
s_cbranch_vccnz L_hs
L_hr:
T a[112:113],v3,0
T a[114:115],v3,1024
M v[48:51],a[68:71],a[172:175],v[48:51]
SA m0,s23,49152
v_max_u32 v28, v16, v17
M v[48:51],a[64:67],a[168:171],v[48:51]
buffer_load_dwordx4 v8, s[16:19], s21 offen offset:0  nt lds
M v[44:47],a[56:59],a[168:171],v[44:47]
v_min_u32 v29, v16, v17
M v[44:47],a[60:63],a[172:175],v[44:47]
v_med3_u32 v29, v28, v29, v18
M v[40:43],a[52:55],a[172:175],v[40:43]
s_nop 0
T a[116:117],v3,8192
T a[118:119],v3,9216
M v[40:43],a[48:51],a[168:171],v[40:43]
v_max_u32 v28, v28, v18
M v[36:39],a[40:43],a[168:171],v[36:39]
buffer_load_dwordx4 v9, s[16:19], s21 offen offset:1024  nt lds
M v[36:39],a[44:47],a[172:175],v[36:39]
s_waitcnt lgkmcnt(6)
v_med3_u32 v29, v28, v29, v19
M v[32:35],a[36:39],a[172:175],v[32:35]
v_max_u32 v28, v28, v19
M v[32:35],a[32:35],a[168:171],v[32:35]
s_nop 0
T a[120:121],v4,0
T a[122:123],v4,1024
M v[64:67],a[32:35],a[160:163],v[64:67]
R a[168:171],v5,38912
R a[172:175],v6,38912
M v[64:67],a[36:39],a[164:167],v[64:67]
buffer_load_dwordx4 v10, s[16:19], s21 offen offset:2048  nt lds
M v[68:71],a[44:47],a[164:167],v[68:71]
v_med3_u32 v29, v28, v29, v20
M v[68:71],a[40:43],a[160:163],v[68:71]
v_max_u32 v28, v28, v20
M v[72:75],a[48:51],a[160:163],v[72:75]
s_nop 0
T a[124:125],v4,8192
T a[126:127],v4,9216
M v[72:75],a[52:55],a[164:167],v[72:75]
v_med3_u32 v29, v28, v29, v21
M v[76:79],a[60:63],a[164:167],v[76:79]
buffer_load_dwordx4 v11, s[16:19], s21 offen offset:3072  nt lds
M v[76:79],a[56:59],a[160:163],v[76:79]
SA s21,s21,524160
v_max_u32 v28, v28, v21
M v[80:83],a[64:67],a[160:163],v[80:83]
v_med3_u32 v29, v28, v29, v22
M v[80:83],a[68:71],a[164:167],v[80:83]
v_max_u32 v28, v28, v22
M v[84:87],a[76:79],a[164:167],v[84:87]
v_med3_u32 v29, v28, v29, v23
M v[84:87],a[72:75],a[160:163],v[84:87]
v_max_u32 v28, v28, v23
M v[88:91],a[80:83],a[160:163],v[88:91]
s_nop 0
v_mov_b32 v30, v28 row_ror:8 row_mask:0xf bank_mask:0xf
M v[88:91],a[84:87],a[164:167],v[88:91]
s_waitcnt lgkmcnt(2)
v_mov_b32 v31, v29 row_ror:8 row_mask:0xf bank_mask:0xf
M v[92:95],a[92:95],a[164:167],v[92:95]
s_waitcnt lgkmcnt(0)
v_min_u32 v16, v28, v30
M v[92:95],a[88:91],a[160:163],v[92:95]
s_barrier
M v[124:127],a[88:91],a[168:171],v[124:127]
R a[160:163],v5,49152
R a[164:167],v6,49152
M v[124:127],a[92:95],a[172:175],v[124:127]
v_max_u32 v28, v28, v30
M v[120:123],a[84:87],a[172:175],v[120:123]
SA m0,s24,32768
T a[128:129],v1,16384
T a[130:131],v1,17408
M v[120:123],a[80:83],a[168:171],v[120:123]
buffer_load_dwordx4 v12, s[48:51], s22 offen offset:0   lds
M v[116:119],a[72:75],a[168:171],v[116:119]
v_max3_u32 v29, v29, v31, v16
M v[116:119],a[76:79],a[172:175],v[116:119]
v_mov_b32 v30, v28 row_ror:4 row_mask:0xf bank_mask:0xf
M v[112:115],a[68:71],a[172:175],v[112:115]
v_mov_b32 v31, v29 row_ror:4 row_mask:0xf bank_mask:0xf
M v[112:115],a[64:67],a[168:171],v[112:115]
v_min_u32 v16, v28, v30
M v[108:111],a[56:59],a[168:171],v[108:111]
v_max_u32 v28, v28, v30
M v[108:111],a[60:63],a[172:175],v[108:111]
s_nop 0
T a[132:133],v1,24576
T a[134:135],v1,25600
M v[104:107],a[52:55],a[172:175],v[104:107]
buffer_load_dwordx4 v13, s[48:51], s22 offen offset:1024   lds
M v[104:107],a[48:51],a[168:171],v[104:107]
v_max3_u32 v29, v29, v31, v16
M v[100:103],a[40:43],a[168:171],v[100:103]
v_mov_b32 v30, v28 row_ror:2 row_mask:0xf bank_mask:0xf
M v[100:103],a[44:47],a[172:175],v[100:103]
s_waitcnt lgkmcnt(4)
v_mov_b32 v31, v29 row_ror:2 row_mask:0xf bank_mask:0xf
M v[96:99],a[36:39],a[172:175],v[96:99]
v_min_u32 v16, v28, v30
M v[96:99],a[32:35],a[168:171],v[96:99]
v_max_u32 v28, v28, v30
M v[128:131],a[32:35],a[160:163],v[128:131]
R a[168:171],v5,51200
R a[172:175],v6,51200
M v[128:131],a[36:39],a[164:167],v[128:131]
T a[136:137],v2,16384
T a[138:139],v2,17408
M v[132:135],a[44:47],a[164:167],v[132:135]
buffer_load_dwordx4 v14, s[48:51], s22 offen offset:2048   lds
M v[132:135],a[40:43],a[160:163],v[132:135]
v_max3_u32 v29, v29, v31, v16
M v[136:139],a[48:51],a[160:163],v[136:139]
v_mov_b32 v30, v28 row_ror:1 row_mask:0xf bank_mask:0xf
M v[136:139],a[52:55],a[164:167],v[136:139]
v_mov_b32 v31, v29 row_ror:1 row_mask:0xf bank_mask:0xf
M v[140:143],a[60:63],a[164:167],v[140:143]
v_min_u32 v16, v28, v30
M v[140:143],a[56:59],a[160:163],v[140:143]
s_nop 0
T a[140:141],v2,24576
T a[142:143],v2,25600
M v[144:147],a[64:67],a[160:163],v[144:147]
buffer_load_dwordx4 v15, s[48:51], s22 offen offset:3072   lds
M v[144:147],a[68:71],a[164:167],v[144:147]
SA s22,s22,1048576
v_max_u32 v28, v28, v30
M v[148:151],a[76:79],a[164:167],v[148:151]
v_max3_u32 v29, v29, v31, v16
M v[148:151],a[72:75],a[160:163],v[148:151]
v_mov_b32 v30, v28
M v[152:155],a[80:83],a[160:163],v[152:155]
v_mov_b32 v31, v29
M v[152:155],a[84:87],a[164:167],v[152:155]
s_waitcnt lgkmcnt(4)
v_permlane16_swap_b32 v30, v28
M v[156:159],a[92:95],a[164:167],v[156:159]
SA m0,s23,0
T a[144:145],v3,16384
T a[146:147],v3,17408
M v[156:159],a[88:91],a[160:163],v[156:159]
buffer_load_dwordx4 v8, s[16:19], s21 offen offset:0  nt lds
M v[188:191],a[88:91],a[168:171],v[188:191]
R a[160:163],v5,53248
R a[164:167],v6,53248
M v[188:191],a[92:95],a[172:175],v[188:191]
v_permlane16_swap_b32 v31, v29
M v[184:187],a[84:87],a[172:175],v[184:187]
v_min_u32 v16, v28, v30
M v[184:187],a[80:83],a[168:171],v[184:187]
v_max_u32 v28, v28, v30
M v[180:183],a[72:75],a[168:171],v[180:183]
v_max3_u32 v29, v29, v31, v16
M v[180:183],a[76:79],a[172:175],v[180:183]
s_nop 0
T a[148:149],v3,24576
T a[150:151],v3,25600
M v[176:179],a[68:71],a[172:175],v[176:179]
buffer_load_dwordx4 v9, s[16:19], s21 offen offset:1024  nt lds
M v[176:179],a[64:67],a[168:171],v[176:179]
v_mov_b32 v30, v28
M v[172:175],a[56:59],a[168:171],v[172:175]
v_mov_b32 v31, v29
M v[172:175],a[60:63],a[172:175],v[172:175]
v_permlane32_swap_b32 v30, v28
M v[168:171],a[52:55],a[172:175],v[168:171]
v_permlane32_swap_b32 v31, v29
M v[168:171],a[48:51],a[168:171],v[168:171]
v_min_u32 v16, v28, v30
M v[164:167],a[40:43],a[168:171],v[164:167]
s_nop 0
T a[152:153],v4,16384
T a[154:155],v4,17408
M v[164:167],a[44:47],a[172:175],v[164:167]
s_waitcnt lgkmcnt(4)
buffer_load_dwordx4 v10, s[16:19], s21 offen offset:2048  nt lds
M v[160:163],a[36:39],a[172:175],v[160:163]
v_max_u32 v28, v28, v30
M v[160:163],a[32:35],a[168:171],v[160:163]
v_max3_u32 v29, v29, v31, v16
M v[192:195],a[32:35],a[160:163],v[192:195]
s_lshl_b32 s64, s20, 3
R a[168:171],v5,55296
R a[172:175],v6,55296
M v[192:195],a[36:39],a[164:167],v[192:195]
SA s64,s64,159744
v_mov_b32 v16, s64
M v[196:199],a[44:47],a[164:167],v[196:199]
ds_write_b64 v16, v[28:29]
M v[196:199],a[40:43],a[160:163],v[196:199]
s_nop 0
T a[156:157],v4,24576
T a[158:159],v4,25600
M v[200:203],a[48:51],a[160:163],v[200:203]
buffer_load_dwordx4 v11, s[16:19], s21 offen offset:3072  nt lds
M v[200:203],a[52:55],a[164:167],v[200:203]
SA s21,s21,128
M v[204:207],a[60:63],a[164:167],v[204:207]
M v[204:207],a[56:59],a[160:163],v[204:207]
M v[208:211],a[64:67],a[160:163],v[208:211]
M v[208:211],a[68:71],a[164:167],v[208:211]
M v[212:215],a[76:79],a[164:167],v[212:215]
M v[212:215],a[72:75],a[160:163],v[212:215]
M v[216:219],a[80:83],a[160:163],v[216:219]
M v[216:219],a[84:87],a[164:167],v[216:219]
s_waitcnt lgkmcnt(3)
M v[220:223],a[92:95],a[164:167],v[220:223]
s_waitcnt vmcnt(17) lgkmcnt(0)
M v[220:223],a[88:91],a[160:163],v[220:223]
s_barrier
M v[252:255],a[88:91],a[168:171],v[252:255]
R a[160:163],v5,0
R a[164:167],v6,0
M v[252:255],a[92:95],a[172:175],v[252:255]
M v[248:251],a[84:87],a[172:175],v[248:251]
M v[248:251],a[80:83],a[168:171],v[248:251]
M v[244:247],a[72:75],a[168:171],v[244:247]
M v[244:247],a[76:79],a[172:175],v[244:247]
M v[240:243],a[68:71],a[172:175],v[240:243]
M v[240:243],a[64:67],a[168:171],v[240:243]
M v[236:239],a[56:59],a[168:171],v[236:239]
M v[236:239],a[60:63],a[172:175],v[236:239]
M v[232:235],a[52:55],a[172:175],v[232:235]
M v[232:235],a[48:51],a[168:171],v[232:235]
M v[228:231],a[40:43],a[168:171],v[228:231]
M v[228:231],a[44:47],a[172:175],v[228:231]
s_waitcnt lgkmcnt(0)
M v[224:227],a[36:39],a[172:175],v[224:227]
M v[224:227],a[32:35],a[168:171],v[224:227]
M a[0:3],a[96:99],a[160:163],a[0:3]
R a[168:171],v5,2048
R a[172:175],v6,2048
M a[0:3],a[100:103],a[164:167],a[0:3]
T a[32:33],v1,32768
T a[34:35],v1,33792
M a[4:7],a[108:111],a[164:167],a[4:7]
SA m0,s24,49152
M a[4:7],a[104:107],a[160:163],a[4:7]
buffer_load_dwordx4 v12, s[48:51], s22 offen offset:0   lds
M a[8:11],a[112:115],a[160:163],a[8:11]
v_mov_b32 v28, 159744
M a[8:11],a[116:119],a[164:167],a[8:11]
ds_read_b128 v[16:19], v28
M a[12:15],a[124:127],a[164:167],a[12:15]
s_nop 0
T a[36:37],v1,40960
T a[38:39],v1,41984
M a[12:15],a[120:123],a[160:163],a[12:15]
R v[20:23],v28,16
M a[16:19],a[128:131],a[160:163],a[16:19]
buffer_load_dwordx4 v13, s[48:51], s22 offen offset:1024   lds
M a[16:19],a[132:135],a[164:167],a[16:19]
M a[20:23],a[140:143],a[164:167],a[20:23]
M a[20:23],a[136:139],a[160:163],a[20:23]
s_nop 0
T a[40:41],v2,32768
T a[42:43],v2,33792
M a[24:27],a[144:147],a[160:163],a[24:27]
M a[24:27],a[148:151],a[164:167],a[24:27]
s_waitcnt lgkmcnt(8)
buffer_load_dwordx4 v14, s[48:51], s22 offen offset:2048   lds
M a[28:31],a[156:159],a[164:167],a[28:31]
M a[28:31],a[152:155],a[160:163],a[28:31]
M v[60:63],a[152:155],a[168:171],v[60:63]
R a[160:163],v5,4096
R a[164:167],v6,4096
M v[60:63],a[156:159],a[172:175],v[60:63]
T a[44:45],v2,40960
T a[46:47],v2,41984
M v[56:59],a[148:151],a[172:175],v[56:59]
buffer_load_dwordx4 v15, s[48:51], s22 offen offset:3072   lds
M v[56:59],a[144:147],a[168:171],v[56:59]
s_sub_u32 s22, s22, 1048448
s_waitcnt lgkmcnt(9)
v_min_u32 v28, v16, v18
M v[52:55],a[136:139],a[168:171],v[52:55]
v_max_u32 v16, v16, v18
M v[52:55],a[140:143],a[172:175],v[52:55]
s_nop 0
T a[48:49],v3,32768
T a[50:51],v3,33792
M v[48:51],a[132:135],a[172:175],v[48:51]
SA m0,s23,16384
v_max3_u32 v17, v17, v19, v28
M v[48:51],a[128:131],a[168:171],v[48:51]
buffer_load_dwordx4 v8, s[16:19], s21 offen offset:0  nt lds
M v[44:47],a[120:123],a[168:171],v[44:47]
s_waitcnt lgkmcnt(8)
v_min_u32 v29, v20, v22
M v[44:47],a[124:127],a[172:175],v[44:47]
v_max_u32 v20, v20, v22
M v[40:43],a[116:119],a[172:175],v[40:43]
s_nop 0
T a[52:53],v3,40960
T a[54:55],v3,41984
M v[40:43],a[112:115],a[168:171],v[40:43]
v_max3_u32 v21, v21, v23, v29
M v[36:39],a[104:107],a[168:171],v[36:39]
buffer_load_dwordx4 v9, s[16:19], s21 offen offset:1024  nt lds
M v[36:39],a[108:111],a[172:175],v[36:39]
s_waitcnt lgkmcnt(6)
v_min_u32 v28, v16, v20
M v[32:35],a[100:103],a[172:175],v[32:35]
v_max_u32 v16, v16, v20
M v[32:35],a[96:99],a[168:171],v[32:35]
s_nop 0
T a[56:57],v4,32768
T a[58:59],v4,33792
M v[64:67],a[96:99],a[160:163],v[64:67]
R a[168:171],v5,6144
R a[172:175],v6,6144
M v[64:67],a[100:103],a[164:167],v[64:67]
buffer_load_dwordx4 v10, s[16:19], s21 offen offset:2048  nt lds
M v[68:71],a[108:111],a[164:167],v[68:71]
v_max3_u32 v17, v17, v21, v28
M v[68:71],a[104:107],a[160:163],v[68:71]
v_and_b32 v28, 1, v0
M v[72:75],a[112:115],a[160:163],v[72:75]
s_nop 0
T a[60:61],v4,40960
T a[62:63],v4,41984
M v[72:75],a[116:119],a[164:167],v[72:75]
v_cmp_eq_u32 vcc, 0, v28
M v[76:79],a[124:127],a[164:167],v[76:79]
s_and_b32 s64, s20, 1
buffer_load_dwordx4 v11, s[16:19], s21 offen offset:3072  nt lds
M v[76:79],a[120:123],a[160:163],v[76:79]
SA s21,s21,524160
s_mul_i32 s64, s64, 448
v_cndmask_b32 v24, v17, v16, vcc
M v[80:83],a[128:131],a[160:163],v[80:83]
v_and_b32 v24, 0x7ff, v24
M v[80:83],a[132:135],a[164:167],v[80:83]
v_sub_u32 v24, 2047, v24
M v[84:87],a[140:143],a[164:167],v[84:87]
v_mul_u32_u24 v28, 896, v24
M v[84:87],a[136:139],a[160:163],v[84:87]
v_lshrrev_b32 v29, 4, v0
M v[88:91],a[144:147],a[160:163],v[88:91]
v_lshl_add_u32 v28, v29, 4, v28
M v[88:91],a[148:151],a[164:167],v[88:91]
s_waitcnt lgkmcnt(2)
v_bfe_u32 v30, v0, 1, 3
M v[92:95],a[156:159],a[164:167],v[92:95]
s_waitcnt vmcnt(16) lgkmcnt(0)
v_lshl_or_b32 v28, v30, 26, v28
M v[92:95],a[152:155],a[160:163],v[92:95]
s_barrier
M v[124:127],a[152:155],a[168:171],v[124:127]
R a[160:163],v5,16384
R a[164:167],v6,16384
M v[124:127],a[156:159],a[172:175],v[124:127]
buffer_load_dwordx4 a[208:211], v28, s[56:59], s64 offen offset:0
M v[120:123],a[148:151],a[172:175],v[120:123]
SA m0,s24,0
T a[64:65],v1,49152
T a[66:67],v1,50176
M v[120:123],a[144:147],a[168:171],v[120:123]
buffer_load_dwordx4 v12, s[48:51], s22 offen offset:0   lds
M v[116:119],a[136:139],a[168:171],v[116:119]
M v[116:119],a[140:143],a[172:175],v[116:119]
M v[112:115],a[132:135],a[172:175],v[112:115]
buffer_load_dwordx4 a[212:215], v28, s[56:59], s64 offen offset:64
M v[112:115],a[128:131],a[168:171],v[112:115]
M v[108:111],a[120:123],a[168:171],v[108:111]
buffer_load_dwordx4 a[216:219], v28, s[56:59], s64 offen offset:128
M v[108:111],a[124:127],a[172:175],v[108:111]
s_nop 0
T a[68:69],v1,57344
T a[70:71],v1,58368
M v[104:107],a[116:119],a[172:175],v[104:107]
buffer_load_dwordx4 v13, s[48:51], s22 offen offset:1024   lds
M v[104:107],a[112:115],a[168:171],v[104:107]
M v[100:103],a[104:107],a[168:171],v[100:103]
M v[100:103],a[108:111],a[172:175],v[100:103]
s_waitcnt lgkmcnt(4)
M v[96:99],a[100:103],a[172:175],v[96:99]
buffer_load_dwordx4 a[220:223], v28, s[56:59], s64 offen offset:192
M v[96:99],a[96:99],a[168:171],v[96:99]
M v[128:131],a[96:99],a[160:163],v[128:131]
R a[168:171],v5,18432
R a[172:175],v6,18432
M v[128:131],a[100:103],a[164:167],v[128:131]
T a[72:73],v2,49152
T a[74:75],v2,50176
M v[132:135],a[108:111],a[164:167],v[132:135]
buffer_load_dwordx4 v14, s[48:51], s22 offen offset:2048   lds
M v[132:135],a[104:107],a[160:163],v[132:135]
M v[136:139],a[112:115],a[160:163],v[136:139]
buffer_load_dwordx4 a[224:227], v28, s[56:59], s64 offen offset:256
M v[136:139],a[116:119],a[164:167],v[136:139]
M v[140:143],a[124:127],a[164:167],v[140:143]
buffer_load_dwordx4 a[228:231], v28, s[56:59], s64 offen offset:320
M v[140:143],a[120:123],a[160:163],v[140:143]
s_nop 0
T a[76:77],v2,57344
T a[78:79],v2,58368
M v[144:147],a[128:131],a[160:163],v[144:147]
buffer_load_dwordx4 v15, s[48:51], s22 offen offset:3072   lds
M v[144:147],a[132:135],a[164:167],v[144:147]
SA s22,s22,1048576
M v[148:151],a[140:143],a[164:167],v[148:151]
M v[148:151],a[136:139],a[160:163],v[148:151]
buffer_load_dwordx4 a[232:235], v28, s[56:59], s64 offen offset:384
M v[152:155],a[144:147],a[160:163],v[152:155]
v_lshrrev_b32 v28, 4, v24
M v[152:155],a[148:151],a[164:167],v[152:155]
s_waitcnt lgkmcnt(4)
v_lshlrev_b32 v28, 5, v28
M v[156:159],a[156:159],a[164:167],v[156:159]
SA m0,s23,32768
T a[80:81],v3,49152
T a[82:83],v3,50176
M v[156:159],a[152:155],a[160:163],v[156:159]
buffer_load_dwordx4 v8, s[16:19], s21 offen offset:0  nt lds
M v[188:191],a[152:155],a[168:171],v[188:191]
L_w_kv04:
s_cbranch_execz L_w_kv08
R a[160:163],v5,20480
R a[164:167],v6,20480
M v[188:191],a[156:159],a[172:175],v[188:191]
v_and_b32 v30, 15, v24
M v[184:187],a[148:151],a[172:175],v[184:187]
v_add_lshl_u32 v28, v28, v30, 2
M v[184:187],a[144:147],a[168:171],v[184:187]
v_lshrrev_b32 v30, 1, v0
M v[180:183],a[136:139],a[168:171],v[180:183]
v_min_u32 v30, 1, v30
M v[180:183],a[140:143],a[172:175],v[180:183]
s_nop 0
T a[84:85],v3,57344
T a[86:87],v3,58368
M v[176:179],a[132:135],a[172:175],v[176:179]
buffer_load_dwordx4 v9, s[16:19], s21 offen offset:1024  nt lds
M v[176:179],a[128:131],a[168:171],v[176:179]
v_lshl_or_b32 v28, v30, 29, v28
M v[172:175],a[120:123],a[168:171],v[172:175]
s_or_b32 s64, s31, s20
M v[172:175],a[124:127],a[172:175],v[172:175]
s_min_u32 s64, s64, 1
M v[168:171],a[116:119],a[172:175],v[168:171]
s_lshl_b32 s64, s64, 29
M v[168:171],a[112:115],a[168:171],v[168:171]
SA s64,s64,104857600
buffer_load_dword v23, v28, s[8:11], s64 offen sc1
M v[164:167],a[104:107],a[168:171],v[164:167]
s_nop 0
T a[88:89],v4,49152
T a[90:91],v4,50176
M v[164:167],a[108:111],a[172:175],v[164:167]
s_waitcnt lgkmcnt(4)
buffer_load_dwordx4 v10, s[16:19], s21 offen offset:2048  nt lds
M v[160:163],a[100:103],a[172:175],v[160:163]
v_bfe_u32 v28, v0, 2, 2
M v[160:163],a[96:99],a[168:171],v[160:163]
v_lshl_add_u32 v28, v29, 3, v28
M v[192:195],a[96:99],a[160:163],v[192:195]
R a[168:171],v5,22528
R a[172:175],v6,22528
M v[192:195],a[100:103],a[164:167],v[192:195]
v_lshlrev_b32 v28, 5, v28
M v[196:199],a[108:111],a[164:167],v[196:199]
v_and_b32 v30, 3, v0
M v[196:199],a[104:107],a[160:163],v[196:199]
s_nop 0
T a[92:93],v4,57344
T a[94:95],v4,58368
M v[200:203],a[112:115],a[160:163],v[200:203]
buffer_load_dwordx4 v11, s[16:19], s21 offen offset:3072  nt lds
M v[200:203],a[116:119],a[164:167],v[200:203]
SA s21,s21,128
v_lshl_add_u32 v28, v30, 3, v28
M v[204:207],a[124:127],a[164:167],v[204:207]
v_add_u32 v22, s87, v28
M v[204:207],a[120:123],a[160:163],v[204:207]
M v[208:211],a[128:131],a[160:163],v[208:211]
M v[208:211],a[132:135],a[164:167],v[208:211]
M v[212:215],a[140:143],a[164:167],v[212:215]
M v[212:215],a[136:139],a[160:163],v[212:215]
M v[216:219],a[144:147],a[160:163],v[216:219]
M v[216:219],a[148:151],a[164:167],v[216:219]
s_waitcnt lgkmcnt(2)
M v[220:223],a[156:159],a[164:167],v[220:223]
s_waitcnt vmcnt(24) lgkmcnt(0)
M v[220:223],a[152:155],a[160:163],v[220:223]
s_barrier
M v[252:255],a[152:155],a[168:171],v[252:255]
R a[160:163],v5,32768
R a[164:167],v6,32768
M v[252:255],a[156:159],a[172:175],v[252:255]
M v[248:251],a[148:151],a[172:175],v[248:251]
M v[248:251],a[144:147],a[168:171],v[248:251]
M v[244:247],a[136:139],a[168:171],v[244:247]
M v[244:247],a[140:143],a[172:175],v[244:247]
M v[240:243],a[132:135],a[172:175],v[240:243]
M v[240:243],a[128:131],a[168:171],v[240:243]
M v[236:239],a[120:123],a[168:171],v[236:239]
M v[236:239],a[124:127],a[172:175],v[236:239]
M v[232:235],a[116:119],a[172:175],v[232:235]
M v[232:235],a[112:115],a[168:171],v[232:235]
M v[228:231],a[104:107],a[168:171],v[228:231]
M v[228:231],a[108:111],a[172:175],v[228:231]
s_waitcnt lgkmcnt(0)
M v[224:227],a[100:103],a[172:175],v[224:227]
M v[224:227],a[96:99],a[168:171],v[224:227]
M a[0:3],a[32:35],a[160:163],a[0:3]
R a[168:171],v5,34816
R a[172:175],v6,34816
M a[0:3],a[36:39],a[164:167],a[0:3]
T a[96:97],v1,0
T a[98:99],v1,1024
M a[4:7],a[44:47],a[164:167],a[4:7]
SA m0,s24,16384
M a[4:7],a[40:43],a[160:163],a[4:7]
buffer_load_dwordx4 v12, s[48:51], s22 offen offset:0   lds
M a[8:11],a[48:51],a[160:163],a[8:11]
M a[8:11],a[52:55],a[164:167],a[8:11]
M a[12:15],a[60:63],a[164:167],a[12:15]
s_nop 0
T a[100:101],v1,8192
T a[102:103],v1,9216
M a[12:15],a[56:59],a[160:163],a[12:15]
M a[16:19],a[64:67],a[160:163],a[16:19]
buffer_load_dwordx4 v13, s[48:51], s22 offen offset:1024   lds
M a[16:19],a[68:71],a[164:167],a[16:19]
M a[20:23],a[76:79],a[164:167],a[20:23]
M a[20:23],a[72:75],a[160:163],a[20:23]
s_nop 0
T a[104:105],v2,0
T a[106:107],v2,1024
M a[24:27],a[80:83],a[160:163],a[24:27]
M a[24:27],a[84:87],a[164:167],a[24:27]
s_waitcnt lgkmcnt(6)
buffer_load_dwordx4 v14, s[48:51], s22 offen offset:2048   lds
M a[28:31],a[92:95],a[164:167],a[28:31]
M a[28:31],a[88:91],a[160:163],a[28:31]
M v[60:63],a[88:91],a[168:171],v[60:63]
R a[160:163],v5,36864
R a[164:167],v6,36864
M v[60:63],a[92:95],a[172:175],v[60:63]
T a[108:109],v2,8192
T a[110:111],v2,9216
M v[56:59],a[84:87],a[172:175],v[56:59]
buffer_load_dwordx4 v15, s[48:51], s22 offen offset:3072   lds
M v[56:59],a[80:83],a[168:171],v[56:59]
s_sub_u32 s22, s22, 1048448
M v[52:55],a[72:75],a[168:171],v[52:55]
M v[52:55],a[76:79],a[172:175],v[52:55]
s_nop 0
T a[112:113],v3,0
T a[114:115],v3,1024
M v[48:51],a[68:71],a[172:175],v[48:51]
SA m0,s23,49152
M v[48:51],a[64:67],a[168:171],v[48:51]
buffer_load_dwordx4 v8, s[16:19], s21 offen offset:0  nt lds
M v[44:47],a[56:59],a[168:171],v[44:47]
M v[44:47],a[60:63],a[172:175],v[44:47]
M v[40:43],a[52:55],a[172:175],v[40:43]
s_nop 0
T a[116:117],v3,8192
T a[118:119],v3,9216
M v[40:43],a[48:51],a[168:171],v[40:43]
M v[36:39],a[40:43],a[168:171],v[36:39]
buffer_load_dwordx4 v9, s[16:19], s21 offen offset:1024  nt lds
M v[36:39],a[44:47],a[172:175],v[36:39]
s_waitcnt lgkmcnt(6)
M v[32:35],a[36:39],a[172:175],v[32:35]
M v[32:35],a[32:35],a[168:171],v[32:35]
s_nop 0
T a[120:121],v4,0
T a[122:123],v4,1024
M v[64:67],a[32:35],a[160:163],v[64:67]
R a[168:171],v5,38912
R a[172:175],v6,38912
M v[64:67],a[36:39],a[164:167],v[64:67]
buffer_load_dwordx4 v10, s[16:19], s21 offen offset:2048  nt lds
M v[68:71],a[44:47],a[164:167],v[68:71]
M v[68:71],a[40:43],a[160:163],v[68:71]
M v[72:75],a[48:51],a[160:163],v[72:75]
s_nop 0
T a[124:125],v4,8192
T a[126:127],v4,9216
M v[72:75],a[52:55],a[164:167],v[72:75]
M v[76:79],a[60:63],a[164:167],v[76:79]
buffer_load_dwordx4 v11, s[16:19], s21 offen offset:3072  nt lds
M v[76:79],a[56:59],a[160:163],v[76:79]
SA s21,s21,524160
M v[80:83],a[64:67],a[160:163],v[80:83]
M v[80:83],a[68:71],a[164:167],v[80:83]
M v[84:87],a[76:79],a[164:167],v[84:87]
M v[84:87],a[72:75],a[160:163],v[84:87]
M v[88:91],a[80:83],a[160:163],v[88:91]
M v[88:91],a[84:87],a[164:167],v[88:91]
s_waitcnt lgkmcnt(2)
M v[92:95],a[92:95],a[164:167],v[92:95]
s_waitcnt vmcnt(24) lgkmcnt(0)
M v[92:95],a[88:91],a[160:163],v[92:95]
s_barrier
M v[124:127],a[88:91],a[168:171],v[124:127]
R a[160:163],v5,49152
R a[164:167],v6,49152
M v[124:127],a[92:95],a[172:175],v[124:127]
M v[120:123],a[84:87],a[172:175],v[120:123]
SA m0,s24,32768
T a[128:129],v1,16384
T a[130:131],v1,17408
M v[120:123],a[80:83],a[168:171],v[120:123]
buffer_load_dwordx4 v12, s[48:51], s22 offen offset:0   lds
M v[116:119],a[72:75],a[168:171],v[116:119]
s_nop 0
T a[176:177],v22,0
T a[178:179],v22,128
M v[116:119],a[76:79],a[172:175],v[116:119]
T a[180:181],v22,1024
T a[182:183],v22,1152
M v[112:115],a[68:71],a[172:175],v[112:115]
T a[184:185],v22,2048
T a[186:187],v22,2176
M v[112:115],a[64:67],a[168:171],v[112:115]
T a[188:189],v22,3072
T a[190:191],v22,3200
M v[108:111],a[56:59],a[168:171],v[108:111]
M v[108:111],a[60:63],a[172:175],v[108:111]
s_nop 0
T a[132:133],v1,24576
T a[134:135],v1,25600
M v[104:107],a[52:55],a[172:175],v[104:107]
buffer_load_dwordx4 v13, s[48:51], s22 offen offset:1024   lds
M v[104:107],a[48:51],a[168:171],v[104:107]
M v[100:103],a[40:43],a[168:171],v[100:103]
M v[100:103],a[44:47],a[172:175],v[100:103]
s_waitcnt lgkmcnt(12)
M v[96:99],a[36:39],a[172:175],v[96:99]
M v[96:99],a[32:35],a[168:171],v[96:99]
M v[128:131],a[32:35],a[160:163],v[128:131]
R a[168:171],v5,51200
R a[172:175],v6,51200
M v[128:131],a[36:39],a[164:167],v[128:131]
T a[136:137],v2,16384
T a[138:139],v2,17408
M v[132:135],a[44:47],a[164:167],v[132:135]
buffer_load_dwordx4 v14, s[48:51], s22 offen offset:2048   lds
M v[132:135],a[40:43],a[160:163],v[132:135]
M v[136:139],a[48:51],a[160:163],v[136:139]
M v[136:139],a[52:55],a[164:167],v[136:139]
M v[140:143],a[60:63],a[164:167],v[140:143]
M v[140:143],a[56:59],a[160:163],v[140:143]
s_nop 0
T a[140:141],v2,24576
T a[142:143],v2,25600
M v[144:147],a[64:67],a[160:163],v[144:147]
buffer_load_dwordx4 v15, s[48:51], s22 offen offset:3072   lds
M v[144:147],a[68:71],a[164:167],v[144:147]
SA s22,s22,1048576
M v[148:151],a[76:79],a[164:167],v[148:151]
M v[148:151],a[72:75],a[160:163],v[148:151]
M v[152:155],a[80:83],a[160:163],v[152:155]
M v[152:155],a[84:87],a[164:167],v[152:155]
s_waitcnt lgkmcnt(4)
M v[156:159],a[92:95],a[164:167],v[156:159]
SA m0,s23,0
T a[144:145],v3,16384
T a[146:147],v3,17408
M v[156:159],a[88:91],a[160:163],v[156:159]
buffer_load_dwordx4 v8, s[16:19], s21 offen offset:0  nt lds
s_waitcnt vmcnt(28)
M v[16:19],a[176:179],a[208:211],0
s_waitcnt vmcnt(26)
M v[16:19],a[180:183],a[212:215],v[16:19]
s_waitcnt vmcnt(25)
M v[16:19],a[184:187],a[216:219],v[16:19]
s_waitcnt vmcnt(23)
M v[16:19],a[188:191],a[220:223],v[16:19]
M v[188:191],a[88:91],a[168:171],v[188:191]
R a[160:163],v5,53248
R a[164:167],v6,53248
M v[188:191],a[92:95],a[172:175],v[188:191]
T a[176:177],v22,4096
T a[178:179],v22,4224
M v[184:187],a[84:87],a[172:175],v[184:187]
T a[180:181],v22,5120
T a[182:183],v22,5248
M v[184:187],a[80:83],a[168:171],v[184:187]
T a[184:185],v22,6144
T a[186:187],v22,6272
M v[180:183],a[72:75],a[168:171],v[180:183]
M v[180:183],a[76:79],a[172:175],v[180:183]
s_nop 0
T a[148:149],v3,24576
T a[150:151],v3,25600
M v[176:179],a[68:71],a[172:175],v[176:179]
buffer_load_dwordx4 v9, s[16:19], s21 offen offset:1024  nt lds
M v[176:179],a[64:67],a[168:171],v[176:179]
M v[172:175],a[56:59],a[168:171],v[172:175]
M v[172:175],a[60:63],a[172:175],v[172:175]
M v[168:171],a[52:55],a[172:175],v[168:171]
M v[168:171],a[48:51],a[168:171],v[168:171]
M v[164:167],a[40:43],a[168:171],v[164:167]
s_nop 0
T a[152:153],v4,16384
T a[154:155],v4,17408
M v[164:167],a[44:47],a[172:175],v[164:167]
s_waitcnt lgkmcnt(10)
buffer_load_dwordx4 v10, s[16:19], s21 offen offset:2048  nt lds
M v[160:163],a[36:39],a[172:175],v[160:163]
M v[160:163],a[32:35],a[168:171],v[160:163]
M v[192:195],a[32:35],a[160:163],v[192:195]
R a[168:171],v5,55296
R a[172:175],v6,55296
M v[192:195],a[36:39],a[164:167],v[192:195]
M v[196:199],a[44:47],a[164:167],v[196:199]
M v[196:199],a[40:43],a[160:163],v[196:199]
s_nop 0
T a[156:157],v4,24576
T a[158:159],v4,25600
M v[200:203],a[48:51],a[160:163],v[200:203]
buffer_load_dwordx4 v11, s[16:19], s21 offen offset:3072  nt lds
M v[200:203],a[52:55],a[164:167],v[200:203]
SA s21,s21,128
M v[204:207],a[60:63],a[164:167],v[204:207]
M v[204:207],a[56:59],a[160:163],v[204:207]
M v[208:211],a[64:67],a[160:163],v[208:211]
M v[208:211],a[68:71],a[164:167],v[208:211]
M v[212:215],a[76:79],a[164:167],v[212:215]
M v[212:215],a[72:75],a[160:163],v[212:215]
M v[216:219],a[80:83],a[160:163],v[216:219]
M v[216:219],a[84:87],a[164:167],v[216:219]
s_waitcnt lgkmcnt(2)
M v[220:223],a[92:95],a[164:167],v[220:223]
s_waitcnt vmcnt(16) lgkmcnt(0)
M v[220:223],a[88:91],a[160:163],v[220:223]
s_barrier
M v[16:19],a[176:179],a[224:227],v[16:19]
M v[16:19],a[180:183],a[228:231],v[16:19]
M v[16:19],a[184:187],a[232:235],v[16:19]
M v[252:255],a[88:91],a[168:171],v[252:255]
R a[160:163],v5,0
R a[164:167],v6,0
M v[252:255],a[92:95],a[172:175],v[252:255]
M v[248:251],a[84:87],a[172:175],v[248:251]
M v[248:251],a[80:83],a[168:171],v[248:251]
M v[244:247],a[72:75],a[168:171],v[244:247]
M v[244:247],a[76:79],a[172:175],v[244:247]
M v[240:243],a[68:71],a[172:175],v[240:243]
M v[240:243],a[64:67],a[168:171],v[240:243]
M v[236:239],a[56:59],a[168:171],v[236:239]
M v[236:239],a[60:63],a[172:175],v[236:239]
M v[232:235],a[52:55],a[172:175],v[232:235]
M v[232:235],a[48:51],a[168:171],v[232:235]
M v[228:231],a[40:43],a[168:171],v[228:231]
M v[228:231],a[44:47],a[172:175],v[228:231]
s_waitcnt lgkmcnt(0)
M v[224:227],a[36:39],a[172:175],v[224:227]
M v[224:227],a[32:35],a[168:171],v[224:227]
M a[0:3],a[96:99],a[160:163],a[0:3]
R a[168:171],v5,2048
R a[172:175],v6,2048
M a[0:3],a[100:103],a[164:167],a[0:3]
T a[32:33],v1,32768
T a[34:35],v1,33792
M a[4:7],a[108:111],a[164:167],a[4:7]
SA m0,s24,49152
M a[4:7],a[104:107],a[160:163],a[4:7]
buffer_load_dwordx4 v12, s[48:51], s22 offen offset:0   lds
M a[8:11],a[112:115],a[160:163],a[8:11]
M a[8:11],a[116:119],a[164:167],a[8:11]
s_lshl_b32 s64, s20, 10
M a[12:15],a[124:127],a[164:167],a[12:15]
SA s64,s64,159744
T a[36:37],v1,40960
T a[38:39],v1,41984
M a[12:15],a[120:123],a[160:163],a[12:15]
v_add_u32 v21, s64, v7
ds_write_b128 v21, v[16:19]
M a[16:19],a[128:131],a[160:163],a[16:19]
s_mul_i32 s67, s86, 14336
buffer_load_dwordx4 v13, s[48:51], s22 offen offset:1024   lds
M a[16:19],a[132:135],a[164:167],a[16:19]
s_mul_i32 s64, s20, 224
M a[20:23],a[140:143],a[164:167],a[20:23]
SA s67,s67,s64
v_lshrrev_b32 v28, 4, v0
v_mul_u32_u24 v28, 896, v28
M a[20:23],a[136:139],a[160:163],a[20:23]
T a[40:41],v2,32768
T a[42:43],v2,33792
M a[24:27],a[144:147],a[160:163],a[24:27]
v_and_b32 v29, 15, v0
v_lshl_add_u32 v28, v29, 4, v28
M a[24:27],a[148:151],a[164:167],a[24:27]
s_waitcnt lgkmcnt(7)
buffer_load_dwordx4 v14, s[48:51], s22 offen offset:2048   lds
M a[28:31],a[156:159],a[164:167],a[28:31]
v_mov_b32 v30, 536870912
v_cmp_gt_u32 vcc, 14, v29
M a[28:31],a[152:155],a[160:163],a[28:31]
s_nop 0
M v[60:63],a[152:155],a[168:171],v[60:63]
s_nop 0
R a[160:163],v5,4096
R a[164:167],v6,4096
M v[60:63],a[156:159],a[172:175],v[60:63]
T a[44:45],v2,40960
T a[46:47],v2,41984
M v[56:59],a[148:151],a[172:175],v[56:59]
buffer_load_dwordx4 v15, s[48:51], s22 offen offset:3072   lds
M v[56:59],a[144:147],a[168:171],v[56:59]
s_sub_u32 s22, s22, 1048448
v_cndmask_b32 v28, v30, v28, vcc
v_add_u32 v29, 2560, v28
M v[52:55],a[136:139],a[168:171],v[52:55]
v_add_u32 v30, 5120, v28
v_add_u32 v31, 7680, v28
M v[52:55],a[140:143],a[172:175],v[52:55]
T a[48:49],v3,32768
T a[50:51],v3,33792
M v[48:51],a[132:135],a[172:175],v[48:51]
SA m0,s23,16384
M v[48:51],a[128:131],a[168:171],v[48:51]
buffer_load_dwordx4 v8, s[16:19], s21 offen offset:0  nt lds
M v[44:47],a[120:123],a[168:171],v[44:47]
M v[44:47],a[124:127],a[172:175],v[44:47]
M v[40:43],a[116:119],a[172:175],v[40:43]
s_nop 0
T a[52:53],v3,40960
T a[54:55],v3,41984
M v[40:43],a[112:115],a[168:171],v[40:43]
M v[36:39],a[104:107],a[168:171],v[36:39]
buffer_load_dwordx4 v9, s[16:19], s21 offen offset:1024  nt lds
M v[36:39],a[108:111],a[172:175],v[36:39]
s_waitcnt lgkmcnt(6)
M v[32:35],a[100:103],a[172:175],v[32:35]
M v[32:35],a[96:99],a[168:171],v[32:35]
s_nop 0
T a[56:57],v4,32768
T a[58:59],v4,33792
M v[64:67],a[96:99],a[160:163],v[64:67]
R a[168:171],v5,6144
R a[172:175],v6,6144
M v[64:67],a[100:103],a[164:167],v[64:67]
buffer_load_dwordx4 v10, s[16:19], s21 offen offset:2048  nt lds
M v[68:71],a[108:111],a[164:167],v[68:71]
M v[68:71],a[104:107],a[160:163],v[68:71]
M v[72:75],a[112:115],a[160:163],v[72:75]
s_nop 0
T a[60:61],v4,40960
T a[62:63],v4,41984
M v[72:75],a[116:119],a[164:167],v[72:75]
M v[76:79],a[124:127],a[164:167],v[76:79]
buffer_load_dwordx4 v11, s[16:19], s21 offen offset:3072  nt lds
M v[76:79],a[120:123],a[160:163],v[76:79]
SA s21,s21,524160
M v[80:83],a[128:131],a[160:163],v[80:83]
M v[80:83],a[132:135],a[164:167],v[80:83]
M v[84:87],a[140:143],a[164:167],v[84:87]
M v[84:87],a[136:139],a[160:163],v[84:87]
M v[88:91],a[144:147],a[160:163],v[88:91]
M v[88:91],a[148:151],a[164:167],v[88:91]
s_waitcnt lgkmcnt(2)
M v[92:95],a[156:159],a[164:167],v[92:95]
s_waitcnt vmcnt(16) lgkmcnt(0)
M v[92:95],a[152:155],a[160:163],v[92:95]
s_barrier
M v[124:127],a[152:155],a[168:171],v[124:127]
R a[160:163],v5,16384
R a[164:167],v6,16384
M v[124:127],a[156:159],a[172:175],v[124:127]
M v[120:123],a[148:151],a[172:175],v[120:123]
SA m0,s24,0
T a[64:65],v1,49152
T a[66:67],v1,50176
M v[120:123],a[144:147],a[168:171],v[120:123]
buffer_load_dwordx4 v12, s[48:51], s22 offen offset:0   lds
M v[116:119],a[136:139],a[168:171],v[116:119]
M v[116:119],a[140:143],a[172:175],v[116:119]
M v[112:115],a[132:135],a[172:175],v[112:115]
M v[112:115],a[128:131],a[168:171],v[112:115]
buffer_load_dwordx4 v13, s[48:51], s22 offen offset:1024   lds
M v[108:111],a[120:123],a[168:171],v[108:111]
M v[108:111],a[124:127],a[172:175],v[108:111]
s_nop 0
T a[68:69],v1,57344
T a[70:71],v1,58368
M v[104:107],a[116:119],a[172:175],v[104:107]
M v[104:107],a[112:115],a[168:171],v[104:107]
M v[100:103],a[104:107],a[168:171],v[100:103]
buffer_load_dwordx4 v14, s[48:51], s22 offen offset:2048   lds
M v[100:103],a[108:111],a[172:175],v[100:103]
s_waitcnt lgkmcnt(4)
M v[96:99],a[100:103],a[172:175],v[96:99]
M v[96:99],a[96:99],a[168:171],v[96:99]
M v[128:131],a[96:99],a[160:163],v[128:131]
R a[168:171],v5,18432
R a[172:175],v6,18432
M v[128:131],a[100:103],a[164:167],v[128:131]
T a[72:73],v2,49152
T a[74:75],v2,50176
M v[132:135],a[108:111],a[164:167],v[132:135]
buffer_load_dwordx4 v15, s[48:51], s22 offen offset:3072   lds
M v[132:135],a[104:107],a[160:163],v[132:135]
SA s22,s22,1048576
M v[136:139],a[112:115],a[160:163],v[136:139]
M v[136:139],a[116:119],a[164:167],v[136:139]
SA m0,s23,32768
M v[140:143],a[124:127],a[164:167],v[140:143]
buffer_load_dwordx4 v8, s[16:19], s21 offen offset:0  nt lds
M v[140:143],a[120:123],a[160:163],v[140:143]
s_nop 0
T a[76:77],v2,57344
T a[78:79],v2,58368
M v[144:147],a[128:131],a[160:163],v[144:147]
M v[144:147],a[132:135],a[164:167],v[144:147]
M v[148:151],a[140:143],a[164:167],v[148:151]
buffer_load_dwordx4 v9, s[16:19], s21 offen offset:1024  nt lds
M v[148:151],a[136:139],a[160:163],v[148:151]
M v[152:155],a[144:147],a[160:163],v[152:155]
M v[152:155],a[148:151],a[164:167],v[152:155]
s_waitcnt lgkmcnt(4)
M v[156:159],a[156:159],a[164:167],v[156:159]
s_nop 0
T a[80:81],v3,49152
T a[82:83],v3,50176
M v[156:159],a[152:155],a[160:163],v[156:159]
buffer_load_dwordx4 v10, s[16:19], s21 offen offset:2048  nt lds
M v[188:191],a[152:155],a[168:171],v[188:191]
R a[160:163],v5,20480
R a[164:167],v6,20480
M v[188:191],a[156:159],a[172:175],v[188:191]
M v[184:187],a[148:151],a[172:175],v[184:187]
M v[184:187],a[144:147],a[168:171],v[184:187]
M v[180:183],a[136:139],a[168:171],v[180:183]
buffer_load_dwordx4 v11, s[16:19], s21 offen offset:3072  nt lds
M v[180:183],a[140:143],a[172:175],v[180:183]
SA s21,s21,128
T a[84:85],v3,57344
T a[86:87],v3,58368
M v[176:179],a[132:135],a[172:175],v[176:179]
M v[176:179],a[128:131],a[168:171],v[176:179]
M v[172:175],a[120:123],a[168:171],v[172:175]
SA m0,s87,0
M v[172:175],a[124:127],a[172:175],v[172:175]
buffer_load_dwordx4 v28, s[68:71], s67 offen offset:0 nt lds
M v[168:171],a[116:119],a[172:175],v[168:171]
M v[168:171],a[112:115],a[168:171],v[168:171]
M v[164:167],a[104:107],a[168:171],v[164:167]
s_nop 0
T a[88:89],v4,49152
T a[90:91],v4,50176
M v[164:167],a[108:111],a[172:175],v[164:167]
s_waitcnt lgkmcnt(4)
buffer_load_dwordx4 v29, s[68:71], s67 offen offset:1024 nt lds
M v[160:163],a[100:103],a[172:175],v[160:163]
M v[160:163],a[96:99],a[168:171],v[160:163]
M v[192:195],a[96:99],a[160:163],v[192:195]
R a[168:171],v5,22528
R a[172:175],v6,22528
M v[192:195],a[100:103],a[164:167],v[192:195]
M v[196:199],a[108:111],a[164:167],v[196:199]
buffer_load_dwordx4 v30, s[68:71], s67 offen offset:2048 nt lds
M v[196:199],a[104:107],a[160:163],v[196:199]
s_nop 0
T a[92:93],v4,57344
T a[94:95],v4,58368
M v[200:203],a[112:115],a[160:163],v[200:203]
M v[200:203],a[116:119],a[164:167],v[200:203]
M v[204:207],a[124:127],a[164:167],v[204:207]
L_w_kv05:
s_cbranch_execz L_wd1
M v[204:207],a[120:123],a[160:163],v[204:207]
buffer_load_dwordx4 v31, s[68:71], s67 offen offset:3072 nt lds
M v[208:211],a[128:131],a[160:163],v[208:211]
SA s67,s67,0
M v[208:211],a[132:135],a[164:167],v[208:211]
M v[212:215],a[140:143],a[164:167],v[212:215]
M v[212:215],a[136:139],a[160:163],v[212:215]
M v[216:219],a[144:147],a[160:163],v[216:219]
M v[216:219],a[148:151],a[164:167],v[216:219]
s_waitcnt lgkmcnt(2)
M v[220:223],a[156:159],a[164:167],v[220:223]
s_waitcnt vmcnt(20) lgkmcnt(0)
M v[220:223],a[152:155],a[160:163],v[220:223]
s_barrier
M v[252:255],a[152:155],a[168:171],v[252:255]
R a[160:163],v5,32768
R a[164:167],v6,32768
M v[252:255],a[156:159],a[172:175],v[252:255]
M v[248:251],a[148:151],a[172:175],v[248:251]
M v[248:251],a[144:147],a[168:171],v[248:251]
M v[244:247],a[136:139],a[168:171],v[244:247]
M v[244:247],a[140:143],a[172:175],v[244:247]
M v[240:243],a[132:135],a[172:175],v[240:243]
M v[240:243],a[128:131],a[168:171],v[240:243]
M v[236:239],a[120:123],a[168:171],v[236:239]
M v[236:239],a[124:127],a[172:175],v[236:239]
M v[232:235],a[116:119],a[172:175],v[232:235]
M v[232:235],a[112:115],a[168:171],v[232:235]
M v[228:231],a[104:107],a[168:171],v[228:231]
M v[228:231],a[108:111],a[172:175],v[228:231]
s_waitcnt lgkmcnt(0)
M v[224:227],a[100:103],a[172:175],v[224:227]
M v[224:227],a[96:99],a[168:171],v[224:227]
M a[0:3],a[32:35],a[160:163],a[0:3]
R a[168:171],v5,34816
R a[172:175],v6,34816
M a[0:3],a[36:39],a[164:167],a[0:3]
T a[96:97],v1,0
T a[98:99],v1,1024
M a[4:7],a[44:47],a[164:167],a[4:7]
SA m0,s24,16384
C v23,v23,v23
M a[4:7],a[40:43],a[160:163],a[4:7]
buffer_load_dwordx4 v12, s[48:51], s22 offen offset:0   lds
M a[8:11],a[48:51],a[160:163],a[8:11]
v_and_b32 v23, 0xffff0000, v23
M a[8:11],a[52:55],a[164:167],a[8:11]
MF v22,0xbfb8aa3b,v23
M a[12:15],a[60:63],a[164:167],a[12:15]
s_nop 0
T a[100:101],v1,8192
T a[102:103],v1,9216
M a[12:15],a[56:59],a[160:163],a[12:15]
E v22,v22
M a[16:19],a[64:67],a[160:163],a[16:19]
buffer_load_dwordx4 v13, s[48:51], s22 offen offset:1024   lds
M a[16:19],a[68:71],a[164:167],a[16:19]
AF v22,1.0,v22
M a[20:23],a[76:79],a[164:167],a[20:23]
v_rcp_f32 v23, v22
M a[20:23],a[72:75],a[160:163],a[20:23]
s_or_b32 s64, s31, s20
T a[104:105],v2,0
T a[106:107],v2,1024
M a[24:27],a[80:83],a[160:163],a[24:27]
s_min_u32 s64, s64, 1
s_lshl_b32 s64, s64, 29
v_lshrrev_b32 v22, 1, v0
M a[24:27],a[84:87],a[164:167],a[24:27]
s_waitcnt lgkmcnt(6)
buffer_load_dwordx4 v14, s[48:51], s22 offen offset:2048   lds
M a[28:31],a[92:95],a[164:167],a[28:31]
v_min_u32 v22, 1, v22
M a[28:31],a[88:91],a[160:163],a[28:31]
v_lshlrev_b32 v22, 29, v22
M v[60:63],a[88:91],a[168:171],v[60:63]
R a[160:163],v5,36864
R a[164:167],v6,36864
M v[60:63],a[92:95],a[172:175],v[60:63]
T a[108:109],v2,8192
T a[110:111],v2,9216
M v[56:59],a[84:87],a[172:175],v[56:59]
buffer_load_dwordx4 v15, s[48:51], s22 offen offset:3072   lds
M v[56:59],a[80:83],a[168:171],v[56:59]
s_sub_u32 s22, s22, 1048448
v_lshl_or_b32 v22, v0, 2, v22
M v[52:55],a[72:75],a[168:171],v[52:55]
v_or_b32 v22, s64, v22
M v[52:55],a[76:79],a[172:175],v[52:55]
s_nop 0
T a[112:113],v3,0
T a[114:115],v3,1024
M v[48:51],a[68:71],a[172:175],v[48:51]
SA m0,s23,49152
C v23,v23,v23
M v[48:51],a[64:67],a[168:171],v[48:51]
buffer_load_dwordx4 v8, s[16:19], s21 offen offset:0  nt lds
M v[44:47],a[56:59],a[168:171],v[44:47]
v_and_b32 v23, 0xffff0000, v23
M v[44:47],a[60:63],a[172:175],v[44:47]
s_lshl_b32 s64, s41, 7
M v[40:43],a[52:55],a[172:175],v[40:43]
SA s64,s64,104890368
T a[116:117],v3,8192
T a[118:119],v3,9216
M v[40:43],a[48:51],a[168:171],v[40:43]
buffer_store_dword v24, v22, s[8:11], s64 offen sc1
M v[36:39],a[40:43],a[168:171],v[36:39]
buffer_load_dwordx4 v9, s[16:19], s21 offen offset:1024  nt lds
M v[36:39],a[44:47],a[172:175],v[36:39]
s_waitcnt lgkmcnt(6)
buffer_store_dword v23, v22, s[8:11], s64 offen offset:8 sc1
M v[32:35],a[36:39],a[172:175],v[32:35]
v_add_u32 v25, 159744, v7
M v[32:35],a[32:35],a[168:171],v[32:35]
s_nop 0
T a[120:121],v4,0
T a[122:123],v4,1024
M v[64:67],a[32:35],a[160:163],v[64:67]
R a[168:171],v5,38912
R a[172:175],v6,38912
M v[64:67],a[36:39],a[164:167],v[64:67]
buffer_load_dwordx4 v10, s[16:19], s21 offen offset:2048  nt lds
M v[68:71],a[44:47],a[164:167],v[68:71]
ds_read_b128 v[16:19], v25
M v[68:71],a[40:43],a[160:163],v[68:71]
R v[28:31],v25,1024
M v[72:75],a[48:51],a[160:163],v[72:75]
s_nop 0
T a[124:125],v4,8192
T a[126:127],v4,9216
M v[72:75],a[52:55],a[164:167],v[72:75]
R v[20:23],v25,2048
M v[76:79],a[60:63],a[164:167],v[76:79]
buffer_load_dwordx4 v11, s[16:19], s21 offen offset:3072  nt lds
M v[76:79],a[56:59],a[160:163],v[76:79]
SA s21,s21,524160
M v[80:83],a[64:67],a[160:163],v[80:83]
M v[80:83],a[68:71],a[164:167],v[80:83]
M v[84:87],a[76:79],a[164:167],v[84:87]
M v[84:87],a[72:75],a[160:163],v[84:87]
M v[88:91],a[80:83],a[160:163],v[88:91]
M v[88:91],a[84:87],a[164:167],v[88:91]
s_waitcnt lgkmcnt(5)
s_waitcnt lgkmcnt(3)
AF v16,v28,v16
M v[92:95],a[92:95],a[164:167],v[92:95]
s_waitcnt vmcnt(22) lgkmcnt(0)
AF v17,v29,v17
M v[92:95],a[88:91],a[160:163],v[92:95]
s_barrier
M v[124:127],a[88:91],a[168:171],v[124:127]
R a[160:163],v5,49152
R a[164:167],v6,49152
M v[124:127],a[92:95],a[172:175],v[124:127]
AF v18,v30,v18
M v[120:123],a[84:87],a[172:175],v[120:123]
SA m0,s24,32768
T a[128:129],v1,16384
T a[130:131],v1,17408
M v[120:123],a[80:83],a[168:171],v[120:123]
buffer_load_dwordx4 v12, s[48:51], s22 offen offset:0   lds
M v[116:119],a[72:75],a[168:171],v[116:119]
AF v19,v31,v19
M v[116:119],a[76:79],a[172:175],v[116:119]
R v[28:31],v25,3072
M v[112:115],a[68:71],a[172:175],v[112:115]
C v25,v16,v17
M v[112:115],a[64:67],a[168:171],v[112:115]
v_lshlrev_b32 v16, 16, v25
M v[108:111],a[56:59],a[168:171],v[108:111]
v_and_b32 v17, 0xffff0000, v25
M v[108:111],a[60:63],a[172:175],v[108:111]
s_nop 0
T a[132:133],v1,24576
T a[134:135],v1,25600
M v[104:107],a[52:55],a[172:175],v[104:107]
buffer_load_dwordx4 v13, s[48:51], s22 offen offset:1024   lds
M v[104:107],a[48:51],a[168:171],v[104:107]
C v25,v18,v19
M v[100:103],a[40:43],a[168:171],v[100:103]
v_lshlrev_b32 v18, 16, v25
M v[100:103],a[44:47],a[172:175],v[100:103]
s_waitcnt lgkmcnt(5)
v_and_b32 v19, 0xffff0000, v25
M v[96:99],a[36:39],a[172:175],v[96:99]
s_waitcnt lgkmcnt(2)
AF v20,v28,v20
M v[96:99],a[32:35],a[168:171],v[96:99]
AF v21,v29,v21
M v[128:131],a[32:35],a[160:163],v[128:131]
R a[168:171],v5,51200
R a[172:175],v6,51200
M v[128:131],a[36:39],a[164:167],v[128:131]
T a[136:137],v2,16384
T a[138:139],v2,17408
M v[132:135],a[44:47],a[164:167],v[132:135]
buffer_load_dwordx4 v14, s[48:51], s22 offen offset:2048   lds
M v[132:135],a[40:43],a[160:163],v[132:135]
AF v22,v30,v22
M v[136:139],a[48:51],a[160:163],v[136:139]
AF v23,v31,v23
M v[136:139],a[52:55],a[164:167],v[136:139]
MF v28,0xbfb8aa3b,v16
M v[140:143],a[60:63],a[164:167],v[140:143]
MF v29,0xbfb8aa3b,v17
M v[140:143],a[56:59],a[160:163],v[140:143]
s_nop 0
T a[140:141],v2,24576
T a[142:143],v2,25600
M v[144:147],a[64:67],a[160:163],v[144:147]
buffer_load_dwordx4 v15, s[48:51], s22 offen offset:3072   lds
M v[144:147],a[68:71],a[164:167],v[144:147]
SA s22,s22,1048576
MF v30,0xbfb8aa3b,v18
M v[148:151],a[76:79],a[164:167],v[148:151]
MF v31,0xbfb8aa3b,v19
M v[148:151],a[72:75],a[160:163],v[148:151]
E v28,v28
M v[152:155],a[80:83],a[160:163],v[152:155]
E v29,v29
M v[152:155],a[84:87],a[164:167],v[152:155]
s_waitcnt lgkmcnt(4)
E v30,v30
M v[156:159],a[92:95],a[164:167],v[156:159]
SA m0,s23,0
T a[144:145],v3,16384
T a[146:147],v3,17408
M v[156:159],a[88:91],a[160:163],v[156:159]
buffer_load_dwordx4 v8, s[16:19], s21 offen offset:0  nt lds
M v[188:191],a[88:91],a[168:171],v[188:191]
R a[160:163],v5,53248
R a[164:167],v6,53248
M v[188:191],a[92:95],a[172:175],v[188:191]
E v31,v31
M v[184:187],a[84:87],a[172:175],v[184:187]
C v25,v20,v21
M v[184:187],a[80:83],a[168:171],v[184:187]
v_lshlrev_b32 v20, 16, v25
M v[180:183],a[72:75],a[168:171],v[180:183]
v_and_b32 v21, 0xffff0000, v25
M v[180:183],a[76:79],a[172:175],v[180:183]
s_nop 0
T a[148:149],v3,24576
T a[150:151],v3,25600
M v[176:179],a[68:71],a[172:175],v[176:179]
buffer_load_dwordx4 v9, s[16:19], s21 offen offset:1024  nt lds
M v[176:179],a[64:67],a[168:171],v[176:179]
C v25,v22,v23
M v[172:175],a[56:59],a[168:171],v[172:175]
v_lshlrev_b32 v22, 16, v25
M v[172:175],a[60:63],a[172:175],v[172:175]
v_and_b32 v23, 0xffff0000, v25
M v[168:171],a[52:55],a[172:175],v[168:171]
AF v28,1.0,v28
M v[168:171],a[48:51],a[168:171],v[168:171]
AF v29,1.0,v29
M v[164:167],a[40:43],a[168:171],v[164:167]
s_nop 0
T a[152:153],v4,16384
T a[154:155],v4,17408
M v[164:167],a[44:47],a[172:175],v[164:167]
s_waitcnt lgkmcnt(4)
buffer_load_dwordx4 v10, s[16:19], s21 offen offset:2048  nt lds
M v[160:163],a[36:39],a[172:175],v[160:163]
AF v30,1.0,v30
M v[160:163],a[32:35],a[168:171],v[160:163]
AF v31,1.0,v31
M v[192:195],a[32:35],a[160:163],v[192:195]
R a[168:171],v5,55296
R a[172:175],v6,55296
M v[192:195],a[36:39],a[164:167],v[192:195]
v_rcp_f32 v28, v28
M v[196:199],a[44:47],a[164:167],v[196:199]
v_rcp_f32 v29, v29
M v[196:199],a[40:43],a[160:163],v[196:199]
T a[156:157],v4,24576
T a[158:159],v4,25600
M v[200:203],a[48:51],a[160:163],v[200:203]
buffer_load_dwordx4 v11, s[16:19], s21 offen offset:3072  nt lds
M v[200:203],a[52:55],a[164:167],v[200:203]
SA s21,s21,128
v_rcp_f32 v30, v30
M v[204:207],a[60:63],a[164:167],v[204:207]
v_rcp_f32 v31, v31
M v[204:207],a[56:59],a[160:163],v[204:207]
MF v16,v28,v16
M v[208:211],a[64:67],a[160:163],v[208:211]
MF v17,v29,v17
M v[208:211],a[68:71],a[164:167],v[208:211]
MF v18,v30,v18
M v[212:215],a[76:79],a[164:167],v[212:215]
MF v19,v31,v19
M v[212:215],a[72:75],a[160:163],v[212:215]
C v25,v16,v17
M v[216:219],a[80:83],a[160:163],v[216:219]
v_lshlrev_b32 v16, 16, v25
M v[216:219],a[84:87],a[164:167],v[216:219]
s_waitcnt lgkmcnt(2)
v_and_b32 v17, 0xffff0000, v25
M v[220:223],a[92:95],a[164:167],v[220:223]
s_waitcnt vmcnt(22) lgkmcnt(0)
C v25,v18,v19
M v[220:223],a[88:91],a[160:163],v[220:223]
s_barrier
M v[252:255],a[88:91],a[168:171],v[252:255]
R a[160:163],v5,0
R a[164:167],v6,0
M v[252:255],a[92:95],a[172:175],v[252:255]
v_lshlrev_b32 v18, 16, v25
M v[248:251],a[84:87],a[172:175],v[248:251]
v_and_b32 v19, 0xffff0000, v25
M v[248:251],a[80:83],a[168:171],v[248:251]
MF v16,v20,v16
M v[244:247],a[72:75],a[168:171],v[244:247]
MF v17,v21,v17
M v[244:247],a[76:79],a[172:175],v[244:247]
MF v18,v22,v18
M v[240:243],a[68:71],a[172:175],v[240:243]
MF v19,v23,v19
M v[240:243],a[64:67],a[168:171],v[240:243]
C v16,v16,v17
M v[236:239],a[56:59],a[168:171],v[236:239]
C v17,v18,v19
M v[236:239],a[60:63],a[172:175],v[236:239]
M v[232:235],a[52:55],a[172:175],v[232:235]
M v[232:235],a[48:51],a[168:171],v[232:235]
M v[228:231],a[40:43],a[168:171],v[228:231]
M v[228:231],a[44:47],a[172:175],v[228:231]
s_waitcnt lgkmcnt(0)
M v[224:227],a[36:39],a[172:175],v[224:227]
M v[224:227],a[32:35],a[168:171],v[224:227]
M a[0:3],a[96:99],a[160:163],a[0:3]
R a[168:171],v5,2048
R a[172:175],v6,2048
M a[0:3],a[100:103],a[164:167],a[0:3]
T a[32:33],v1,32768
T a[34:35],v1,33792
M a[4:7],a[108:111],a[164:167],a[4:7]
SA m0,s24,49152
v_lshrrev_b32 v28, 4, v0
v_and_b32 v29, 7, v0
M a[4:7],a[104:107],a[160:163],a[4:7]
buffer_load_dwordx4 v12, s[48:51], s22 offen offset:0   lds
M a[8:11],a[112:115],a[160:163],a[8:11]
v_xor_b32 v28, v28, v29
v_lshlrev_b32 v28, 4, v28
M a[8:11],a[116:119],a[164:167],a[8:11]
v_lshrrev_b32 v29, 3, v0
v_mul_u32_u24 v29, 896, v29
M a[12:15],a[124:127],a[164:167],a[12:15]
T a[36:37],v1,40960
T a[38:39],v1,41984
M a[12:15],a[120:123],a[160:163],a[12:15]
v_add_u32 v22, v28, v29
v_xor_b32 v28, 64, v28
M a[16:19],a[128:131],a[160:163],a[16:19]
s_mul_i32 s64, s20, 14336
buffer_load_dwordx4 v13, s[48:51], s22 offen offset:1024   lds
M a[16:19],a[132:135],a[164:167],a[16:19]
s_sub_u32 s65, 98304, s64
M a[20:23],a[140:143],a[164:167],a[20:23]
SA s30,s29,s65
M a[20:23],a[136:139],a[160:163],a[20:23]
SA s29,s29,s64
T a[40:41],v2,32768
T a[42:43],v2,33792
M a[24:27],a[144:147],a[160:163],a[24:27]
v_add_u32 v29, 6144, v29
v_add_u32 v23, v28, v29
M a[24:27],a[148:151],a[164:167],a[24:27]
s_waitcnt lgkmcnt(6)
buffer_load_dwordx4 v14, s[48:51], s22 offen offset:2048   lds
M a[28:31],a[156:159],a[164:167],a[28:31]
s_and_b32 s64, s20, 1
M a[28:31],a[152:155],a[160:163],a[28:31]
s_lshl_b32 s64, s64, 12
M v[60:63],a[152:155],a[168:171],v[60:63]
SA s64,s64,65536
R a[160:163],v5,4096
R a[164:167],v6,4096
M v[60:63],a[156:159],a[172:175],v[60:63]
T a[44:45],v2,40960
T a[46:47],v2,41984
M v[56:59],a[148:151],a[172:175],v[56:59]
buffer_load_dwordx4 v15, s[48:51], s22 offen offset:3072   lds
M v[56:59],a[144:147],a[168:171],v[56:59]
s_sub_u32 s22, s22, 1048448
v_add_u32 v20, s64, v5
v_add_u32 v21, s64, v6
M v[52:55],a[136:139],a[168:171],v[52:55]
v_lshrrev_b32 v28, 2, v0
v_lshlrev_b32 v28, 8, v28
M v[52:55],a[140:143],a[172:175],v[52:55]
T a[48:49],v3,32768
T a[50:51],v3,33792
M v[48:51],a[132:135],a[172:175],v[48:51]
SA m0,s23,16384
v_and_b32 v29, 3, v0
v_lshl_add_u32 v28, v29, 3, v28
M v[48:51],a[128:131],a[168:171],v[48:51]
buffer_load_dwordx4 v8, s[16:19], s21 offen offset:0  nt lds
M v[44:47],a[120:123],a[168:171],v[44:47]
v_add_u32 v28, s87, v28
M v[44:47],a[124:127],a[172:175],v[44:47]
s_waitcnt vmcnt(23)
s_nop 0
T a[176:177],v28,0
T a[178:179],v28,32
M v[40:43],a[116:119],a[172:175],v[40:43]
T a[52:53],v3,40960
T a[54:55],v3,41984
M v[40:43],a[112:115],a[168:171],v[40:43]
T a[180:181],v28,64
T a[182:183],v28,96
M v[36:39],a[104:107],a[168:171],v[36:39]
buffer_load_dwordx4 v9, s[16:19], s21 offen offset:1024  nt lds
M v[36:39],a[108:111],a[172:175],v[36:39]
s_waitcnt lgkmcnt(10)
s_nop 0
T a[184:185],v28,128
T a[186:187],v28,160
M v[32:35],a[100:103],a[172:175],v[32:35]
T a[188:189],v28,192
M v[32:35],a[96:99],a[168:171],v[32:35]
s_nop 0
T a[56:57],v4,32768
T a[58:59],v4,33792
M v[64:67],a[96:99],a[160:163],v[64:67]
R a[168:171],v5,6144
R a[172:175],v6,6144
M v[64:67],a[100:103],a[164:167],v[64:67]
buffer_load_dwordx4 v10, s[16:19], s21 offen offset:2048  nt lds
s_waitcnt lgkmcnt(12)
v_mfma_f32_16x16x16_bf16 a[192:195], a[176:177], v[16:17], 0
M v[68:71],a[108:111],a[164:167],v[68:71]
v_mov_b32 v18, v16 row_shr:2 row_mask:0xf bank_mask:0xf bound_ctrl:0
v_mov_b32 v19, v17 row_shr:2 row_mask:0xf bank_mask:0xf bound_ctrl:0
M v[68:71],a[104:107],a[160:163],v[68:71]
M v[72:75],a[112:115],a[160:163],v[72:75]
s_nop 0
T a[60:61],v4,40960
T a[62:63],v4,41984
M v[72:75],a[116:119],a[164:167],v[72:75]
s_waitcnt lgkmcnt(13)
v_mfma_f32_16x16x16_bf16 a[192:195], a[178:179], v[18:19], a[192:195]
M v[76:79],a[124:127],a[164:167],v[76:79]
buffer_load_dwordx4 v11, s[16:19], s21 offen offset:3072  nt lds
M v[76:79],a[120:123],a[160:163],v[76:79]
SA s21,s21,524160
v_mov_b32 v16, v18 row_shr:2 row_mask:0xf bank_mask:0xf bound_ctrl:0
v_mov_b32 v17, v19 row_shr:2 row_mask:0xf bank_mask:0xf bound_ctrl:0
M v[80:83],a[128:131],a[160:163],v[80:83]
M v[80:83],a[132:135],a[164:167],v[80:83]
s_waitcnt lgkmcnt(10)
v_mfma_f32_16x16x16_bf16 a[192:195], a[180:181], v[16:17], a[192:195]
M v[84:87],a[140:143],a[164:167],v[84:87]
v_mov_b32 v18, v16 row_shr:2 row_mask:0xf bank_mask:0xf bound_ctrl:0
v_mov_b32 v19, v17 row_shr:2 row_mask:0xf bank_mask:0xf bound_ctrl:0
M v[84:87],a[136:139],a[160:163],v[84:87]
M v[88:91],a[144:147],a[160:163],v[88:91]
M v[88:91],a[148:151],a[164:167],v[88:91]
s_waitcnt lgkmcnt(2)
v_mfma_f32_16x16x16_bf16 a[192:195], a[182:183], v[18:19], a[192:195]
M v[92:95],a[156:159],a[164:167],v[92:95]
s_waitcnt vmcnt(16) lgkmcnt(0)
v_mov_b32 v16, v18 row_shr:2 row_mask:0xf bank_mask:0xf bound_ctrl:0
v_mov_b32 v17, v19 row_shr:2 row_mask:0xf bank_mask:0xf bound_ctrl:0
M v[92:95],a[152:155],a[160:163],v[92:95]
s_barrier
M v[124:127],a[152:155],a[168:171],v[124:127]
R a[160:163],v5,16384
R a[164:167],v6,16384
M v[124:127],a[156:159],a[172:175],v[124:127]
SA m0,s23,131072
v_mfma_f32_16x16x16_bf16 a[192:195], a[184:185], v[16:17], a[192:195]
M v[120:123],a[148:151],a[172:175],v[120:123]
s_nop 0
T a[64:65],v1,49152
T a[66:67],v1,50176
M v[120:123],a[144:147],a[168:171],v[120:123]
v_mov_b32 v18, v16 row_shr:2 row_mask:0xf bank_mask:0xf bound_ctrl:0
v_mov_b32 v19, v17 row_shr:2 row_mask:0xf bank_mask:0xf bound_ctrl:0
M v[116:119],a[136:139],a[168:171],v[116:119]
buffer_load_dwordx4 v22, s[56:59], s29 offen offset:0 lds
M v[116:119],a[140:143],a[172:175],v[116:119]
v_mfma_f32_16x16x16_bf16 a[192:195], a[186:187], v[18:19], a[192:195]
M v[112:115],a[132:135],a[172:175],v[112:115]
v_mov_b32 v16, v18 row_shr:2 row_mask:0xf bank_mask:0xf bound_ctrl:0
v_mov_b32 v17, v19 row_shr:2 row_mask:0xf bank_mask:0xf bound_ctrl:0
M v[112:115],a[128:131],a[168:171],v[112:115]
buffer_load_dwordx4 v23, s[56:59], s29 offen offset:1024 lds
M v[108:111],a[120:123],a[168:171],v[108:111]
M v[108:111],a[124:127],a[172:175],v[108:111]
s_nop 0
T a[68:69],v1,57344
T a[70:71],v1,58368
v_mfma_f32_16x16x16_bf16 a[192:195], a[188:189], v[16:17], a[192:195]
M v[104:107],a[116:119],a[172:175],v[104:107]
buffer_load_dwordx4 v22, s[56:59], s30 offen offset:2048 lds
M v[104:107],a[112:115],a[168:171],v[104:107]
v_and_b32 v29, 1, v0
v_mul_u32_u24 v30, 1792, v29
M v[100:103],a[104:107],a[168:171],v[100:103]
v_lshrrev_b32 v31, 4, v0
v_lshl_add_u32 v30, v31, 4, v30
M v[100:103],a[108:111],a[172:175],v[100:103]
s_waitcnt lgkmcnt(4)
v_bfe_u32 v29, v0, 1, 3
v_lshl_add_u32 v30, v29, 6, v30
M v[96:99],a[100:103],a[172:175],v[96:99]
v_add_u32 v29, 1, v29
v_lshrrev_b32 v29, 3, v29
M v[96:99],a[96:99],a[168:171],v[96:99]
v_lshl_or_b32 v30, v29, 29, v30
v_or_b32 v30, s88, v30
M v[128:131],a[96:99],a[160:163],v[128:131]
s_mul_i32 s89, s86, 3584
R a[168:171],v5,18432
R a[172:175],v6,18432
M v[128:131],a[100:103],a[164:167],v[128:131]
s_mul_i32 s64, s20, 448
T a[72:73],v2,49152
T a[74:75],v2,50176
M v[132:135],a[108:111],a[164:167],v[132:135]
SA s89,s89,s64
M v[132:135],a[104:107],a[160:163],v[132:135]
SA s89,s89,105906176
buffer_store_dwordx4 a[192:195], v30, s[8:11], s89 offen sc1
M v[136:139],a[112:115],a[160:163],v[136:139]
M v[136:139],a[116:119],a[164:167],v[136:139]
M v[140:143],a[124:127],a[164:167],v[140:143]
buffer_load_dwordx4 v23, s[56:59], s30 offen offset:3072 lds
M v[140:143],a[120:123],a[160:163],v[140:143]
SA s29,s29,128
T a[76:77],v2,57344
T a[78:79],v2,58368
M v[144:147],a[128:131],a[160:163],v[144:147]
SA s30,s30,128
M v[144:147],a[132:135],a[164:167],v[144:147]
SA m0,s24,0
M v[148:151],a[140:143],a[164:167],v[148:151]
buffer_load_dwordx4 v12, s[48:51], s22 offen offset:0   lds
M v[148:151],a[136:139],a[160:163],v[148:151]
M v[152:155],a[144:147],a[160:163],v[152:155]
M v[152:155],a[148:151],a[164:167],v[152:155]
s_waitcnt lgkmcnt(4)
buffer_load_dwordx4 v13, s[48:51], s22 offen offset:1024   lds
M v[156:159],a[156:159],a[164:167],v[156:159]
s_nop 0
T a[80:81],v3,49152
T a[82:83],v3,50176
M v[156:159],a[152:155],a[160:163],v[156:159]
M v[188:191],a[152:155],a[168:171],v[188:191]
R a[160:163],v5,20480
R a[164:167],v6,20480
M v[188:191],a[156:159],a[172:175],v[188:191]
buffer_load_dwordx4 v14, s[48:51], s22 offen offset:2048   lds
M v[184:187],a[148:151],a[172:175],v[184:187]
M v[184:187],a[144:147],a[168:171],v[184:187]
M v[180:183],a[136:139],a[168:171],v[180:183]
buffer_load_dwordx4 v15, s[48:51], s22 offen offset:3072   lds
M v[180:183],a[140:143],a[172:175],v[180:183]
SA s22,s22,1048576
T a[84:85],v3,57344
T a[86:87],v3,58368
M v[176:179],a[132:135],a[172:175],v[176:179]
SA m0,s23,32768
M v[176:179],a[128:131],a[168:171],v[176:179]
buffer_load_dwordx4 v8, s[16:19], s21 offen offset:0  nt lds
L_w_kv06:
s_cbranch_execz L_wd1
M v[172:175],a[120:123],a[168:171],v[172:175]
M v[172:175],a[124:127],a[172:175],v[172:175]
M v[168:171],a[116:119],a[172:175],v[168:171]
M v[168:171],a[112:115],a[168:171],v[168:171]
buffer_load_dwordx4 v9, s[16:19], s21 offen offset:1024  nt lds
M v[164:167],a[104:107],a[168:171],v[164:167]
s_nop 0
T a[88:89],v4,49152
T a[90:91],v4,50176
M v[164:167],a[108:111],a[172:175],v[164:167]
s_waitcnt lgkmcnt(4)
M v[160:163],a[100:103],a[172:175],v[160:163]
M v[160:163],a[96:99],a[168:171],v[160:163]
M v[192:195],a[96:99],a[160:163],v[192:195]
R a[168:171],v5,22528
R a[172:175],v6,22528
M v[192:195],a[100:103],a[164:167],v[192:195]
buffer_load_dwordx4 v10, s[16:19], s21 offen offset:2048  nt lds
M v[196:199],a[108:111],a[164:167],v[196:199]
M v[196:199],a[104:107],a[160:163],v[196:199]
s_nop 0
T a[92:93],v4,57344
T a[94:95],v4,58368
M v[200:203],a[112:115],a[160:163],v[200:203]
M v[200:203],a[116:119],a[164:167],v[200:203]
buffer_load_dwordx4 v11, s[16:19], s21 offen offset:3072  nt lds
M v[204:207],a[124:127],a[164:167],v[204:207]
M v[204:207],a[120:123],a[160:163],v[204:207]
M v[208:211],a[128:131],a[160:163],v[208:211]
M v[208:211],a[132:135],a[164:167],v[208:211]
M v[212:215],a[140:143],a[164:167],v[212:215]
SA s21,s21,128
M v[212:215],a[136:139],a[160:163],v[212:215]
M v[216:219],a[144:147],a[160:163],v[216:219]
M v[216:219],a[148:151],a[164:167],v[216:219]
s_waitcnt lgkmcnt(2)
M v[220:223],a[156:159],a[164:167],v[220:223]
s_waitcnt vmcnt(21) lgkmcnt(0)
M v[220:223],a[152:155],a[160:163],v[220:223]
s_barrier
M v[252:255],a[152:155],a[168:171],v[252:255]
R a[160:163],v5,32768
R a[164:167],v6,32768
M v[252:255],a[156:159],a[172:175],v[252:255]
M v[248:251],a[148:151],a[172:175],v[248:251]
M v[248:251],a[144:147],a[168:171],v[248:251]
M v[244:247],a[136:139],a[168:171],v[244:247]
M v[244:247],a[140:143],a[172:175],v[244:247]
M v[240:243],a[132:135],a[172:175],v[240:243]
M v[240:243],a[128:131],a[168:171],v[240:243]
M v[236:239],a[120:123],a[168:171],v[236:239]
M v[236:239],a[124:127],a[172:175],v[236:239]
M v[232:235],a[116:119],a[172:175],v[232:235]
M v[232:235],a[112:115],a[168:171],v[232:235]
M v[228:231],a[104:107],a[168:171],v[228:231]
M v[228:231],a[108:111],a[172:175],v[228:231]
s_waitcnt lgkmcnt(0)
M v[224:227],a[100:103],a[172:175],v[224:227]
M v[224:227],a[96:99],a[168:171],v[224:227]
M a[0:3],a[32:35],a[160:163],a[0:3]
R a[168:171],v5,34816
R a[172:175],v6,34816
M a[0:3],a[36:39],a[164:167],a[0:3]
SA m0,s23,147456
T a[96:97],v1,0
T a[98:99],v1,1024
M a[4:7],a[44:47],a[164:167],a[4:7]
buffer_load_dwordx4 v22, s[56:59], s29 offen offset:0 lds
M a[4:7],a[40:43],a[160:163],a[4:7]
M a[8:11],a[48:51],a[160:163],a[8:11]
M a[8:11],a[52:55],a[164:167],a[8:11]
buffer_load_dwordx4 v23, s[56:59], s29 offen offset:1024 lds
M a[12:15],a[60:63],a[164:167],a[12:15]
s_nop 0
T a[100:101],v1,8192
T a[102:103],v1,9216
M a[12:15],a[56:59],a[160:163],a[12:15]
M a[16:19],a[64:67],a[160:163],a[16:19]
buffer_load_dwordx4 v22, s[56:59], s30 offen offset:2048 lds
M a[16:19],a[68:71],a[164:167],a[16:19]
M a[20:23],a[76:79],a[164:167],a[20:23]
M a[20:23],a[72:75],a[160:163],a[20:23]
s_nop 0
T a[104:105],v2,0
T a[106:107],v2,1024
M a[24:27],a[80:83],a[160:163],a[24:27]
buffer_load_dwordx4 v23, s[56:59], s30 offen offset:3072 lds
M a[24:27],a[84:87],a[164:167],a[24:27]
s_waitcnt lgkmcnt(6)
M a[28:31],a[92:95],a[164:167],a[28:31]
SA s29,s29,128
M a[28:31],a[88:91],a[160:163],a[28:31]
SA s30,s30,128
M v[60:63],a[88:91],a[168:171],v[60:63]
SA m0,s24,16384
R a[160:163],v5,36864
R a[164:167],v6,36864
M v[60:63],a[92:95],a[172:175],v[60:63]
T a[108:109],v2,8192
T a[110:111],v2,9216
M v[56:59],a[84:87],a[172:175],v[56:59]
buffer_load_dwordx4 v12, s[48:51], s22 offen offset:0   lds
M v[56:59],a[80:83],a[168:171],v[56:59]
M v[52:55],a[72:75],a[168:171],v[52:55]
M v[52:55],a[76:79],a[172:175],v[52:55]
s_nop 0
T a[112:113],v3,0
T a[114:115],v3,1024
M v[48:51],a[68:71],a[172:175],v[48:51]
buffer_load_dwordx4 v13, s[48:51], s22 offen offset:1024   lds
M v[48:51],a[64:67],a[168:171],v[48:51]
M v[44:47],a[56:59],a[168:171],v[44:47]
M v[44:47],a[60:63],a[172:175],v[44:47]
buffer_load_dwordx4 v14, s[48:51], s22 offen offset:2048   lds
M v[40:43],a[52:55],a[172:175],v[40:43]
s_nop 0
T a[116:117],v3,8192
T a[118:119],v3,9216
M v[40:43],a[48:51],a[168:171],v[40:43]
M v[36:39],a[40:43],a[168:171],v[36:39]
buffer_load_dwordx4 v15, s[48:51], s22 offen offset:3072   lds
M v[36:39],a[44:47],a[172:175],v[36:39]
s_waitcnt lgkmcnt(6)
M v[32:35],a[36:39],a[172:175],v[32:35]
s_sub_u32 s22, s22, 1048448
M v[32:35],a[32:35],a[168:171],v[32:35]
SA m0,s23,49152
T a[120:121],v4,0
T a[122:123],v4,1024
M v[64:67],a[32:35],a[160:163],v[64:67]
R a[168:171],v5,38912
R a[172:175],v6,38912
M v[64:67],a[36:39],a[164:167],v[64:67]
buffer_load_dwordx4 v8, s[16:19], s21 offen offset:0  nt lds
M v[68:71],a[44:47],a[164:167],v[68:71]
M v[68:71],a[40:43],a[160:163],v[68:71]
M v[72:75],a[48:51],a[160:163],v[72:75]
s_waitcnt vmcnt(17)
s_nop 0
T a[124:125],v4,8192
T a[126:127],v4,9216
M v[72:75],a[52:55],a[164:167],v[72:75]
buffer_load_dwordx4 v9, s[16:19], s21 offen offset:1024  nt lds
M v[76:79],a[60:63],a[164:167],v[76:79]
R a[176:179],v20,0
R a[180:183],v20,2048
M v[76:79],a[56:59],a[160:163],v[76:79]
R a[184:187],v21,0
R a[188:191],v21,2048
M v[80:83],a[64:67],a[160:163],v[80:83]
buffer_load_dwordx4 v10, s[16:19], s21 offen offset:2048  nt lds
M v[80:83],a[68:71],a[164:167],v[80:83]
M v[84:87],a[76:79],a[164:167],v[84:87]
M v[84:87],a[72:75],a[160:163],v[84:87]
buffer_load_dwordx4 v11, s[16:19], s21 offen offset:3072  nt lds
M v[88:91],a[80:83],a[160:163],v[88:91]
SA s21,s21,524160
M v[88:91],a[84:87],a[164:167],v[88:91]
s_waitcnt lgkmcnt(6)
M v[92:95],a[92:95],a[164:167],v[92:95]
s_waitcnt lgkmcnt(0)
M v[92:95],a[88:91],a[160:163],v[92:95]
s_barrier
M v[124:127],a[88:91],a[168:171],v[124:127]
s_lshl_b32 s4, s20, 10
R a[160:163],v5,49152
R a[164:167],v6,49152
M v[124:127],a[92:95],a[172:175],v[124:127]
SA m0,s23,131072
v_bfe_u32 v28, v0, 3, 2
M v[120:123],a[84:87],a[172:175],v[120:123]
s_nop 0
T a[128:129],v1,16384
T a[130:131],v1,17408
M v[120:123],a[80:83],a[168:171],v[120:123]
buffer_load_dwordx4 v22, s[56:59], s29 offen offset:0 lds
M v[116:119],a[72:75],a[168:171],v[116:119]
v_lshrrev_b32 v29, 5, v0
v_lshl_add_u32 v28, v29, 3, v28
M v[116:119],a[76:79],a[172:175],v[116:119]
M v[112:115],a[68:71],a[172:175],v[112:115]
v_lshlrev_b32 v28, 13, v28
M v[112:115],a[64:67],a[168:171],v[112:115]
M v[108:111],a[56:59],a[168:171],v[108:111]
buffer_load_dwordx4 v23, s[56:59], s29 offen offset:1024 lds
M v[108:111],a[60:63],a[172:175],v[108:111]
s_nop 0
T a[132:133],v1,24576
T a[134:135],v1,25600
M v[104:107],a[52:55],a[172:175],v[104:107]
v_lshrrev_b32 v29, 4, v0
v_lshlrev_b32 v29, 1, v29
M v[104:107],a[48:51],a[168:171],v[104:107]
M v[100:103],a[40:43],a[168:171],v[100:103]
v_and_b32 v30, 7, v0
M v[100:103],a[44:47],a[172:175],v[100:103]
s_waitcnt lgkmcnt(4)
M v[96:99],a[36:39],a[172:175],v[96:99]
v_xor_b32 v29, v29, v30
M v[96:99],a[32:35],a[168:171],v[96:99]
buffer_load_dwordx4 v22, s[56:59], s30 offen offset:2048 lds
M v[128:131],a[32:35],a[160:163],v[128:131]
R a[168:171],v5,51200
R a[172:175],v6,51200
M v[128:131],a[36:39],a[164:167],v[128:131]
T a[136:137],v2,16384
T a[138:139],v2,17408
M v[132:135],a[44:47],a[164:167],v[132:135]
v_lshl_add_u32 v28, v29, 4, v28
M v[132:135],a[40:43],a[160:163],v[132:135]
s_and_b32 s64, s20, 1
M v[136:139],a[48:51],a[160:163],v[136:139]
s_lshl_b32 s64, s64, 17
M v[136:139],a[52:55],a[164:167],v[136:139]
s_lshr_b32 s65, s20, 1
M v[140:143],a[60:63],a[164:167],v[140:143]
s_lshl_b32 s65, s65, 15
SA s64,s64,s65
v_add_u32 v8, s64, v28
M v[140:143],a[56:59],a[160:163],v[140:143]
s_nop 0
T a[140:141],v2,24576
T a[142:143],v2,25600
M v[144:147],a[64:67],a[160:163],v[144:147]
buffer_load_dwordx4 v23, s[56:59], s30 offen offset:3072 lds
M v[144:147],a[68:71],a[164:167],v[144:147]
M v[148:151],a[76:79],a[164:167],v[148:151]
SA s29,s29,128
M v[148:151],a[72:75],a[160:163],v[148:151]
SA s30,s30,128
M v[152:155],a[80:83],a[160:163],v[152:155]
SA m0,s24,32768
M v[152:155],a[84:87],a[164:167],v[152:155]
s_waitcnt lgkmcnt(4)
buffer_load_dwordx4 v12, s[48:51], s22 offen offset:0   lds
M v[156:159],a[92:95],a[164:167],v[156:159]
s_nop 0
T a[144:145],v3,16384
T a[146:147],v3,17408
M v[156:159],a[88:91],a[160:163],v[156:159]
M v[188:191],a[88:91],a[168:171],v[188:191]
R a[160:163],v5,53248
R a[164:167],v6,53248
M v[188:191],a[92:95],a[172:175],v[188:191]
M v[184:187],a[84:87],a[172:175],v[184:187]
M v[184:187],a[80:83],a[168:171],v[184:187]
M v[180:183],a[72:75],a[168:171],v[180:183]
buffer_load_dwordx4 v13, s[48:51], s22 offen offset:1024   lds
M v[180:183],a[76:79],a[172:175],v[180:183]
s_nop 0
T a[148:149],v3,24576
T a[150:151],v3,25600
M v[176:179],a[68:71],a[172:175],v[176:179]
M v[176:179],a[64:67],a[168:171],v[176:179]
M v[172:175],a[56:59],a[168:171],v[172:175]
M v[172:175],a[60:63],a[172:175],v[172:175]
M v[168:171],a[52:55],a[172:175],v[168:171]
M v[168:171],a[48:51],a[168:171],v[168:171]
buffer_load_dwordx4 v14, s[48:51], s22 offen offset:2048   lds
M v[164:167],a[40:43],a[168:171],v[164:167]
s_nop 0
T a[152:153],v4,16384
T a[154:155],v4,17408
M v[164:167],a[44:47],a[172:175],v[164:167]
s_waitcnt lgkmcnt(4)
M v[160:163],a[36:39],a[172:175],v[160:163]
M v[160:163],a[32:35],a[168:171],v[160:163]
M v[192:195],a[32:35],a[160:163],v[192:195]
R a[168:171],v5,55296
R a[172:175],v6,55296
M v[192:195],a[36:39],a[164:167],v[192:195]
M v[196:199],a[44:47],a[164:167],v[196:199]
buffer_load_dwordx4 v15, s[48:51], s22 offen offset:3072   lds
M v[196:199],a[40:43],a[160:163],v[196:199]
s_nop 0
T a[156:157],v4,24576
T a[158:159],v4,25600
M v[200:203],a[48:51],a[160:163],v[200:203]
s_waitcnt vmcnt(16)
R a[192:195],v20,16384
R a[196:199],v20,18432
M v[200:203],a[52:55],a[164:167],v[200:203]
R a[200:203],v21,16384
R a[204:207],v21,18432
M v[204:207],a[60:63],a[164:167],v[204:207]
M v[204:207],a[56:59],a[160:163],v[204:207]
M v[208:211],a[64:67],a[160:163],v[208:211]
M v[208:211],a[68:71],a[164:167],v[208:211]
M v[212:215],a[76:79],a[164:167],v[212:215]
SA s22,s22,1048576
M v[212:215],a[72:75],a[160:163],v[212:215]
M v[216:219],a[80:83],a[160:163],v[216:219]
M v[216:219],a[84:87],a[164:167],v[216:219]
s_waitcnt lgkmcnt(6)
M v[220:223],a[92:95],a[164:167],v[220:223]
s_waitcnt lgkmcnt(0)
M v[220:223],a[88:91],a[160:163],v[220:223]
s_barrier
M v[252:255],a[88:91],a[168:171],v[252:255]
R a[160:163],v5,0
R a[164:167],v6,0
M v[252:255],a[92:95],a[172:175],v[252:255]
M v[248:251],a[84:87],a[172:175],v[248:251]
M v[248:251],a[80:83],a[168:171],v[248:251]
M v[244:247],a[72:75],a[168:171],v[244:247]
M v[244:247],a[76:79],a[172:175],v[244:247]
M v[240:243],a[68:71],a[172:175],v[240:243]
M v[240:243],a[64:67],a[168:171],v[240:243]
M v[236:239],a[56:59],a[168:171],v[236:239]
M v[236:239],a[60:63],a[172:175],v[236:239]
M v[232:235],a[52:55],a[172:175],v[232:235]
M v[232:235],a[48:51],a[168:171],v[232:235]
M v[228:231],a[40:43],a[168:171],v[228:231]
M v[228:231],a[44:47],a[172:175],v[228:231]
s_waitcnt lgkmcnt(0)
M v[224:227],a[36:39],a[172:175],v[224:227]
M v[224:227],a[32:35],a[168:171],v[224:227]
M a[0:3],a[96:99],a[160:163],a[0:3]
R a[168:171],v5,2048
R a[172:175],v6,2048
M a[0:3],a[100:103],a[164:167],a[0:3]
SA m0,s23,147456
T a[32:33],v1,32768
T a[34:35],v1,33792
M a[4:7],a[108:111],a[164:167],a[4:7]
buffer_load_dwordx4 v22, s[56:59], s29 offen offset:0 lds
M a[4:7],a[104:107],a[160:163],a[4:7]
M a[8:11],a[112:115],a[160:163],a[8:11]
M a[8:11],a[116:119],a[164:167],a[8:11]
buffer_load_dwordx4 v23, s[56:59], s29 offen offset:1024 lds
M a[12:15],a[124:127],a[164:167],a[12:15]
s_nop 0
T a[36:37],v1,40960
T a[38:39],v1,41984
M a[12:15],a[120:123],a[160:163],a[12:15]
M a[16:19],a[128:131],a[160:163],a[16:19]
buffer_load_dwordx4 v22, s[56:59], s30 offen offset:2048 lds
M a[16:19],a[132:135],a[164:167],a[16:19]
M a[20:23],a[140:143],a[164:167],a[20:23]
M a[20:23],a[136:139],a[160:163],a[20:23]
s_nop 0
T a[40:41],v2,32768
T a[42:43],v2,33792
M a[24:27],a[144:147],a[160:163],a[24:27]
buffer_load_dwordx4 v23, s[56:59], s30 offen offset:3072 lds
M a[24:27],a[148:151],a[164:167],a[24:27]
s_waitcnt lgkmcnt(6)
M a[28:31],a[156:159],a[164:167],a[28:31]
SA s29,s29,128
M a[28:31],a[152:155],a[160:163],a[28:31]
SA s30,s30,128
M v[60:63],a[152:155],a[168:171],v[60:63]
SA m0,s24,49152
R a[160:163],v5,4096
R a[164:167],v6,4096
M v[60:63],a[156:159],a[172:175],v[60:63]
T a[44:45],v2,40960
T a[46:47],v2,41984
M v[56:59],a[148:151],a[172:175],v[56:59]
buffer_load_dwordx4 v12, s[48:51], s22 offen offset:0   lds
M v[56:59],a[144:147],a[168:171],v[56:59]
M v[52:55],a[136:139],a[168:171],v[52:55]
M v[52:55],a[140:143],a[172:175],v[52:55]
s_nop 0
T a[48:49],v3,32768
T a[50:51],v3,33792
M v[48:51],a[132:135],a[172:175],v[48:51]
buffer_load_dwordx4 v13, s[48:51], s22 offen offset:1024   lds
M v[48:51],a[128:131],a[168:171],v[48:51]
M v[44:47],a[120:123],a[168:171],v[44:47]
M v[44:47],a[124:127],a[172:175],v[44:47]
buffer_load_dwordx4 v14, s[48:51], s22 offen offset:2048   lds
M v[40:43],a[116:119],a[172:175],v[40:43]
s_nop 0
T a[52:53],v3,40960
T a[54:55],v3,41984
M v[40:43],a[112:115],a[168:171],v[40:43]
M v[36:39],a[104:107],a[168:171],v[36:39]
buffer_load_dwordx4 v15, s[48:51], s22 offen offset:3072   lds
M v[36:39],a[108:111],a[172:175],v[36:39]
s_waitcnt lgkmcnt(6)
M v[32:35],a[100:103],a[172:175],v[32:35]
s_sub_u32 s22, s22, 1048448
M v[32:35],a[96:99],a[168:171],v[32:35]
s_mov_b32 s25, 0
T a[56:57],v4,32768
T a[58:59],v4,33792
M v[64:67],a[96:99],a[160:163],v[64:67]
SA m0,s4,0
R a[168:171],v5,6144
R a[172:175],v6,6144
M v[64:67],a[100:103],a[164:167],v[64:67]
buffer_load_dwordx4 v8, s[52:55], s25 offen lds
M v[68:71],a[108:111],a[164:167],v[68:71]
s_mov_b32 s25, 262144
M v[68:71],a[104:107],a[160:163],v[68:71]
SA m0,s4,4096
M v[72:75],a[112:115],a[160:163],v[72:75]
s_waitcnt vmcnt(13)
s_nop 0
T a[60:61],v4,40960
T a[62:63],v4,41984
M v[72:75],a[116:119],a[164:167],v[72:75]
buffer_load_dwordx4 v8, s[52:55], s25 offen lds
M v[76:79],a[124:127],a[164:167],v[76:79]
s_mov_b32 s25, 524288
R a[208:211],v20,0
R a[212:215],v20,2048
M v[76:79],a[120:123],a[160:163],v[76:79]
SA m0,s4,8192
R a[216:219],v21,0
R a[220:223],v21,2048
M v[80:83],a[128:131],a[160:163],v[80:83]
buffer_load_dwordx4 v8, s[52:55], s25 offen lds
M v[80:83],a[132:135],a[164:167],v[80:83]
s_mov_b32 s25, 786432
M v[84:87],a[140:143],a[164:167],v[84:87]
SA m0,s4,12288
M v[84:87],a[136:139],a[160:163],v[84:87]
buffer_load_dwordx4 v8, s[52:55], s25 offen lds
M v[88:91],a[144:147],a[160:163],v[88:91]
M v[88:91],a[148:151],a[164:167],v[88:91]
s_waitcnt lgkmcnt(6)
M v[92:95],a[156:159],a[164:167],v[92:95]
s_waitcnt lgkmcnt(0)
M v[92:95],a[152:155],a[160:163],v[92:95]
s_barrier
M v[124:127],a[152:155],a[168:171],v[124:127]
R a[160:163],v5,16384
R a[164:167],v6,16384
M v[124:127],a[156:159],a[172:175],v[124:127]
SA m0,s23,32768
M v[120:123],a[148:151],a[172:175],v[120:123]
s_nop 0
T a[64:65],v1,49152
T a[66:67],v1,50176
M v[120:123],a[144:147],a[168:171],v[120:123]
buffer_load_dwordx4 v22, s[56:59], s29 offen offset:0 lds
M v[116:119],a[136:139],a[168:171],v[116:119]
v_lshrrev_b32 v28, 2, v0
v_lshlrev_b32 v28, 7, v28
M v[116:119],a[140:143],a[172:175],v[116:119]
M v[112:115],a[132:135],a[172:175],v[112:115]
buffer_load_dwordx4 v23, s[56:59], s29 offen offset:1024 lds
M v[112:115],a[128:131],a[168:171],v[112:115]
v_and_b32 v29, 3, v0
M v[108:111],a[120:123],a[168:171],v[108:111]
v_lshl_add_u32 v28, v29, 3, v28
M v[108:111],a[124:127],a[172:175],v[108:111]
s_nop 0
T a[68:69],v1,57344
T a[70:71],v1,58368
M v[104:107],a[116:119],a[172:175],v[104:107]
buffer_load_dwordx4 v22, s[56:59], s30 offen offset:2048 lds
M v[104:107],a[112:115],a[168:171],v[104:107]
v_bfe_u32 v29, v0, 3, 2
M v[100:103],a[104:107],a[168:171],v[100:103]
M v[100:103],a[108:111],a[172:175],v[100:103]
s_waitcnt lgkmcnt(4)
v_lshl_add_u32 v16, v29, 5, v28
M v[96:99],a[100:103],a[172:175],v[96:99]
M v[96:99],a[96:99],a[168:171],v[96:99]
buffer_load_dwordx4 v23, s[56:59], s30 offen offset:3072 lds
M v[128:131],a[96:99],a[160:163],v[128:131]
R a[168:171],v5,18432
R a[172:175],v6,18432
M v[128:131],a[100:103],a[164:167],v[128:131]
SA s29,s29,128
T a[72:73],v2,49152
T a[74:75],v2,50176
M v[132:135],a[108:111],a[164:167],v[132:135]
SA s30,s30,128
v_xor_b32 v17, 32, v16
v_xor_b32 v18, 64, v16
M v[132:135],a[104:107],a[160:163],v[132:135]
SA m0,s23,65536
M v[136:139],a[112:115],a[160:163],v[136:139]
buffer_load_dwordx4 v22, s[56:59], s29 offen offset:0 lds
M v[136:139],a[116:119],a[164:167],v[136:139]
v_xor_b32 v19, 0x60, v16
M v[140:143],a[124:127],a[164:167],v[140:143]
v_add_u32 v12, 0x20000, v16
M v[140:143],a[120:123],a[160:163],v[140:143]
s_nop 0
T a[76:77],v2,57344
T a[78:79],v2,58368
M v[144:147],a[128:131],a[160:163],v[144:147]
buffer_load_dwordx4 v23, s[56:59], s29 offen offset:1024 lds
M v[144:147],a[132:135],a[164:167],v[144:147]
v_add_u32 v13, 0x20000, v17
M v[148:151],a[140:143],a[164:167],v[148:151]
M v[148:151],a[136:139],a[160:163],v[148:151]
v_add_u32 v14, 0x20000, v18
M v[152:155],a[144:147],a[160:163],v[152:155]
M v[152:155],a[148:151],a[164:167],v[152:155]
s_waitcnt lgkmcnt(4)
buffer_load_dwordx4 v22, s[56:59], s30 offen offset:2048 lds
M v[156:159],a[156:159],a[164:167],v[156:159]
s_nop 0
T a[80:81],v3,49152
T a[82:83],v3,50176
M v[156:159],a[152:155],a[160:163],v[156:159]
v_add_u32 v15, 0x20000, v19
M v[188:191],a[152:155],a[168:171],v[188:191]
R a[160:163],v5,20480
R a[164:167],v6,20480
M v[188:191],a[156:159],a[172:175],v[188:191]
M v[184:187],a[148:151],a[172:175],v[184:187]
buffer_load_dwordx4 v23, s[56:59], s30 offen offset:3072 lds
M v[184:187],a[144:147],a[168:171],v[184:187]
SA s29,s29,128
M v[180:183],a[136:139],a[168:171],v[180:183]
SA s30,s30,128
M v[180:183],a[140:143],a[172:175],v[180:183]
s_mov_b32 s25, 1048576
T a[84:85],v3,57344
T a[86:87],v3,58368
M v[176:179],a[132:135],a[172:175],v[176:179]
SA m0,s4,16384
M v[176:179],a[128:131],a[168:171],v[176:179]
buffer_load_dwordx4 v8, s[52:55], s25 offen lds
M v[172:175],a[120:123],a[168:171],v[172:175]
M v[172:175],a[124:127],a[172:175],v[172:175]
s_mov_b32 s25, 1310720
M v[168:171],a[116:119],a[172:175],v[168:171]
SA m0,s4,20480
M v[168:171],a[112:115],a[168:171],v[168:171]
buffer_load_dwordx4 v8, s[52:55], s25 offen lds
M v[164:167],a[104:107],a[168:171],v[164:167]
s_nop 0
T a[88:89],v4,49152
T a[90:91],v4,50176
M v[164:167],a[108:111],a[172:175],v[164:167]
s_waitcnt lgkmcnt(4)
M v[160:163],a[100:103],a[172:175],v[160:163]
s_mov_b32 s25, 1572864
M v[160:163],a[96:99],a[168:171],v[160:163]
SA m0,s4,24576
M v[192:195],a[96:99],a[160:163],v[192:195]
R a[168:171],v5,22528
R a[172:175],v6,22528
M v[192:195],a[100:103],a[164:167],v[192:195]
buffer_load_dwordx4 v8, s[52:55], s25 offen lds
M v[196:199],a[108:111],a[164:167],v[196:199]
M v[196:199],a[104:107],a[160:163],v[196:199]
s_mov_b32 s25, 1835008
T a[92:93],v4,57344
L_w_kv07:
s_cbranch_execz L_wd1
T a[94:95],v4,58368
M v[200:203],a[112:115],a[160:163],v[200:203]
SA m0,s4,28672
M v[200:203],a[116:119],a[164:167],v[200:203]
s_waitcnt vmcnt(19)
buffer_load_dwordx4 v8, s[52:55], s25 offen lds
M v[204:207],a[124:127],a[164:167],v[204:207]
R a[224:227],v20,16384
R a[228:231],v20,18432
M v[204:207],a[120:123],a[160:163],v[204:207]
R a[232:235],v21,16384
R a[236:239],v21,18432
M v[208:211],a[128:131],a[160:163],v[208:211]
v_subrev_u32 v20, 98304, v20
v_subrev_u32 v21, 98304, v21
M v[208:211],a[132:135],a[164:167],v[208:211]
M v[212:215],a[140:143],a[164:167],v[212:215]
M v[212:215],a[136:139],a[160:163],v[212:215]
M v[216:219],a[144:147],a[160:163],v[216:219]
M v[216:219],a[148:151],a[164:167],v[216:219]
s_waitcnt lgkmcnt(6)
M v[220:223],a[156:159],a[164:167],v[220:223]
s_waitcnt lgkmcnt(0)
M v[220:223],a[152:155],a[160:163],v[220:223]
s_barrier
M v[252:255],a[152:155],a[168:171],v[252:255]
R a[160:163],v5,32768
R a[164:167],v6,32768
M v[252:255],a[156:159],a[172:175],v[252:255]
M v[248:251],a[148:151],a[172:175],v[248:251]
M v[248:251],a[144:147],a[168:171],v[248:251]
M v[244:247],a[136:139],a[168:171],v[244:247]
M v[244:247],a[140:143],a[172:175],v[244:247]
M v[240:243],a[132:135],a[172:175],v[240:243]
M v[240:243],a[128:131],a[168:171],v[240:243]
M v[236:239],a[120:123],a[168:171],v[236:239]
M v[236:239],a[124:127],a[172:175],v[236:239]
M v[232:235],a[116:119],a[172:175],v[232:235]
M v[232:235],a[112:115],a[168:171],v[232:235]
M v[228:231],a[104:107],a[168:171],v[228:231]
M v[228:231],a[108:111],a[172:175],v[228:231]
s_waitcnt lgkmcnt(0)
M v[224:227],a[100:103],a[172:175],v[224:227]
M v[224:227],a[96:99],a[168:171],v[224:227]
M a[0:3],a[32:35],a[160:163],a[0:3]
R a[168:171],v5,34816
R a[172:175],v6,34816
M a[0:3],a[36:39],a[164:167],a[0:3]
SA m0,s23,81920
M a[4:7],a[44:47],a[164:167],a[4:7]
buffer_load_dwordx4 v22, s[56:59], s29 offen offset:0 lds
M a[4:7],a[40:43],a[160:163],a[4:7]
M a[8:11],a[48:51],a[160:163],a[8:11]
M a[8:11],a[52:55],a[164:167],a[8:11]
buffer_load_dwordx4 v23, s[56:59], s29 offen offset:1024 lds
M a[12:15],a[60:63],a[164:167],a[12:15]
M a[12:15],a[56:59],a[160:163],a[12:15]
G v24,a0
G v25,a1
M a[16:19],a[64:67],a[160:163],a[16:19]
G v26,a2
G v27,a3
M a[16:19],a[68:71],a[164:167],a[16:19]
buffer_load_dwordx4 v22, s[56:59], s30 offen offset:2048 lds
M a[20:23],a[76:79],a[164:167],a[20:23]
G v28,a4
G v29,a5
M a[20:23],a[72:75],a[160:163],a[20:23]
G v30,a6
G v31,a7
M a[24:27],a[80:83],a[160:163],a[24:27]
C v24,v24,v25
C v25,v26,v27
M a[24:27],a[84:87],a[164:167],a[24:27]
s_waitcnt lgkmcnt(0)
buffer_load_dwordx4 v23, s[56:59], s30 offen offset:3072 lds
M a[28:31],a[92:95],a[164:167],a[28:31]
SA s29,s29,128
C v26,v28,v29
C v27,v30,v31
M a[28:31],a[88:91],a[160:163],a[28:31]
SA s3,s93,0
buffer_store_dwordx4 v[24:27], v7, s[8:11], s3 offen offset:0 sc1
M v[32:35],a[32:35],a[168:171],v[32:35]
SA s30,s30,128
R a[160:163],v5,36864
R a[164:167],v6,36864
M v[32:35],a[36:39],a[172:175],v[32:35]
s_mov_b32 s25, 2097152
G v24,a8
G v25,a9
M v[36:39],a[44:47],a[172:175],v[36:39]
SA m0,s4,131072
G v26,a10
G v27,a11
M v[36:39],a[40:43],a[168:171],v[36:39]
buffer_load_dwordx4 v8, s[52:55], s25 offen lds
M v[40:43],a[48:51],a[168:171],v[40:43]
s_mov_b32 s25, 2359296
G v28,a12
G v29,a13
M v[40:43],a[52:55],a[172:175],v[40:43]
SA m0,s4,135168
G v30,a14
G v31,a15
M v[44:47],a[60:63],a[172:175],v[44:47]
buffer_load_dwordx4 v8, s[52:55], s25 offen lds
M v[44:47],a[56:59],a[168:171],v[44:47]
s_mov_b32 s25, 2621440
C v24,v24,v25
C v25,v26,v27
M v[48:51],a[64:67],a[168:171],v[48:51]
SA m0,s4,139264
C v26,v28,v29
C v27,v30,v31
M v[48:51],a[68:71],a[172:175],v[48:51]
buffer_store_dwordx4 v[24:27], v7, s[8:11], s3 offen offset:1024 sc1
M v[52:55],a[76:79],a[172:175],v[52:55]
s_nop 0
G v24,a16
G v25,a17
M v[52:55],a[72:75],a[168:171],v[52:55]
G v26,a18
G v27,a19
M v[56:59],a[80:83],a[168:171],v[56:59]
buffer_load_dwordx4 v8, s[52:55], s25 offen lds
M v[56:59],a[84:87],a[172:175],v[56:59]
s_waitcnt lgkmcnt(0)
G v28,a20
G v29,a21
M v[60:63],a[92:95],a[172:175],v[60:63]
s_mov_b32 s25, 2883584
G v30,a22
G v31,a23
M v[60:63],a[88:91],a[168:171],v[60:63]
SA m0,s4,143360
C v24,v24,v25
C v25,v26,v27
M v[64:67],a[32:35],a[160:163],v[64:67]
s_waitcnt vmcnt(17)
R a[168:171],v5,38912
R a[172:175],v6,38912
M v[64:67],a[36:39],a[164:167],v[64:67]
buffer_load_dwordx4 v8, s[52:55], s25 offen lds
M v[68:71],a[44:47],a[164:167],v[68:71]
s_mov_b32 s25, 3145728
C v26,v28,v29
C v27,v30,v31
M v[68:71],a[40:43],a[160:163],v[68:71]
SA m0,s4,147456
buffer_store_dwordx4 v[24:27], v7, s[8:11], s3 offen offset:2048 sc1
M v[72:75],a[48:51],a[160:163],v[72:75]
R a[96:99],v20,0
R a[100:103],v20,2048
M v[72:75],a[52:55],a[164:167],v[72:75]
R a[104:107],v21,0
R a[108:111],v21,2048
M v[76:79],a[60:63],a[164:167],v[76:79]
buffer_load_dwordx4 v8, s[52:55], s25 offen lds
M v[76:79],a[56:59],a[160:163],v[76:79]
s_mov_b32 s25, 3407872
G v24,a24
G v25,a25
M v[80:83],a[64:67],a[160:163],v[80:83]
SA m0,s4,151552
G v26,a26
G v27,a27
M v[80:83],a[68:71],a[164:167],v[80:83]
buffer_load_dwordx4 v8, s[52:55], s25 offen lds
M v[84:87],a[76:79],a[164:167],v[84:87]
G v28,a28
G v29,a29
M v[84:87],a[72:75],a[160:163],v[84:87]
G v30,a30
G v31,a31
M v[88:91],a[80:83],a[160:163],v[88:91]
C v24,v24,v25
C v25,v26,v27
M v[88:91],a[84:87],a[164:167],v[88:91]
s_waitcnt lgkmcnt(4)
C v26,v28,v29
C v27,v30,v31
M v[92:95],a[92:95],a[164:167],v[92:95]
s_waitcnt lgkmcnt(0)
buffer_store_dwordx4 v[24:27], v7, s[8:11], s3 offen offset:3072 sc1
M v[92:95],a[88:91],a[160:163],v[92:95]
s_barrier
M v[96:99],a[32:35],a[168:171],v[96:99]
R a[160:163],v5,49152
R a[164:167],v6,49152
M v[96:99],a[36:39],a[172:175],v[96:99]
s_mov_b32 s25, 128
C v64,v64,v65
C v65,v66,v67
M v[100:103],a[44:47],a[172:175],v[100:103]
SA m0,s4,49152
C v66,v68,v69
C v67,v70,v71
M v[100:103],a[40:43],a[168:171],v[100:103]
s_waitcnt vmcnt(18)
buffer_load_dwordx4 v8, s[52:55], s25 offen lds
M v[104:107],a[48:51],a[168:171],v[104:107]
C v72,v72,v73
C v73,v74,v75
M v[104:107],a[52:55],a[172:175],v[104:107]
C v74,v76,v77
C v75,v78,v79
M v[108:111],a[60:63],a[172:175],v[108:111]
C v32,v32,v33
C v33,v34,v35
M v[108:111],a[56:59],a[168:171],v[108:111]
C v34,v36,v37
C v35,v38,v39
M v[112:115],a[64:67],a[168:171],v[112:115]
SA s3,s93,8192
buffer_store_dwordx4 v[32:35], v7, s[8:11], s3 offen offset:0 sc1
M v[112:115],a[68:71],a[172:175],v[112:115]
s_mov_b32 s25, 262272
C v80,v80,v81
C v81,v82,v83
M v[116:119],a[76:79],a[172:175],v[116:119]
SA m0,s4,53248
C v82,v84,v85
C v83,v86,v87
M v[116:119],a[72:75],a[168:171],v[116:119]
R a[112:115],v20,32768
R a[116:119],v20,34816
M v[120:123],a[80:83],a[168:171],v[120:123]
buffer_load_dwordx4 v8, s[52:55], s25 offen lds
M v[120:123],a[84:87],a[172:175],v[120:123]
s_waitcnt lgkmcnt(2)
R a[120:123],v21,32768
R a[124:127],v21,34816
M v[124:127],a[92:95],a[172:175],v[124:127]
C v88,v88,v89
C v89,v90,v91
M v[124:127],a[88:91],a[168:171],v[124:127]
C v90,v92,v93
C v91,v94,v95
M v[128:131],a[32:35],a[160:163],v[128:131]
R a[168:171],v5,51200
R a[172:175],v6,51200
M v[128:131],a[36:39],a[164:167],v[128:131]
C v40,v40,v41
C v41,v42,v43
M v[132:135],a[44:47],a[164:167],v[132:135]
C v42,v44,v45
C v43,v46,v47
M v[132:135],a[40:43],a[160:163],v[132:135]
s_mov_b32 s25, 524416
buffer_store_dwordx4 v[40:43], v7, s[8:11], s3 offen offset:1024 sc1
M v[136:139],a[48:51],a[160:163],v[136:139]
SA m0,s4,57344
C v96,v96,v97
C v97,v98,v99
M v[136:139],a[52:55],a[164:167],v[136:139]
C v98,v100,v101
C v99,v102,v103
M v[140:143],a[60:63],a[164:167],v[140:143]
C v104,v104,v105
C v105,v106,v107
M v[140:143],a[56:59],a[160:163],v[140:143]
buffer_load_dwordx4 v8, s[52:55], s25 offen lds
M v[144:147],a[64:67],a[160:163],v[144:147]
C v106,v108,v109
C v107,v110,v111
M v[144:147],a[68:71],a[164:167],v[144:147]
C v112,v112,v113
C v113,v114,v115
M v[148:151],a[76:79],a[164:167],v[148:151]
C v114,v116,v117
C v115,v118,v119
M v[148:151],a[72:75],a[160:163],v[148:151]
C v48,v48,v49
C v49,v50,v51
M v[152:155],a[80:83],a[160:163],v[152:155]
C v50,v52,v53
C v51,v54,v55
M v[152:155],a[84:87],a[164:167],v[152:155]
s_waitcnt lgkmcnt(0)
buffer_store_dwordx4 v[48:51], v7, s[8:11], s3 offen offset:2048 sc1
M v[156:159],a[92:95],a[164:167],v[156:159]
s_mov_b32 s25, 786560
C v120,v120,v121
C v121,v122,v123
M v[156:159],a[88:91],a[160:163],v[156:159]
SA m0,s4,61440
C v122,v124,v125
C v123,v126,v127
M v[160:163],a[32:35],a[168:171],v[160:163]
R a[160:163],v5,53248
R a[164:167],v6,53248
M v[160:163],a[36:39],a[172:175],v[160:163]
buffer_load_dwordx4 v8, s[52:55], s25 offen lds
M v[164:167],a[44:47],a[172:175],v[164:167]
C v128,v128,v129
C v129,v130,v131
M v[164:167],a[40:43],a[168:171],v[164:167]
C v130,v132,v133
C v131,v134,v135
M v[168:171],a[48:51],a[168:171],v[168:171]
C v56,v56,v57
C v57,v58,v59
M v[168:171],a[52:55],a[172:175],v[168:171]
C v58,v60,v61
C v59,v62,v63
M v[172:175],a[60:63],a[172:175],v[172:175]
buffer_store_dwordx4 v[56:59], v7, s[8:11], s3 offen offset:3072 sc1
M v[172:175],a[56:59],a[168:171],v[172:175]
C v136,v136,v137
C v137,v138,v139
M v[176:179],a[64:67],a[168:171],v[176:179]
C v138,v140,v141
C v139,v142,v143
M v[176:179],a[68:71],a[172:175],v[176:179]
C v144,v144,v145
C v145,v146,v147
M v[180:183],a[76:79],a[172:175],v[180:183]
C v146,v148,v149
C v147,v150,v151
M v[180:183],a[72:75],a[168:171],v[180:183]
C v152,v152,v153
C v153,v154,v155
M v[184:187],a[80:83],a[168:171],v[184:187]
C v154,v156,v157
C v155,v158,v159
M v[184:187],a[84:87],a[172:175],v[184:187]
s_waitcnt lgkmcnt(0)
C v160,v160,v161
C v161,v162,v163
M v[188:191],a[92:95],a[172:175],v[188:191]
C v162,v164,v165
C v163,v166,v167
M v[188:191],a[88:91],a[168:171],v[188:191]
C v168,v168,v169
C v169,v170,v171
M v[192:195],a[32:35],a[160:163],v[192:195]
s_waitcnt vmcnt(18)
R a[168:171],v5,55296
R a[172:175],v6,55296
M v[192:195],a[36:39],a[164:167],v[192:195]
C v170,v172,v173
C v171,v174,v175
M v[196:199],a[44:47],a[164:167],v[196:199]
C v176,v176,v177
C v177,v178,v179
M v[196:199],a[40:43],a[160:163],v[196:199]
C v178,v180,v181
C v179,v182,v183
M v[200:203],a[48:51],a[160:163],v[200:203]
R a[128:131],v20,49152
R a[132:135],v20,51200
M v[200:203],a[52:55],a[164:167],v[200:203]
R a[136:139],v21,49152
R a[140:143],v21,51200
M v[204:207],a[60:63],a[164:167],v[204:207]
C v184,v184,v185
C v185,v186,v187
M v[204:207],a[56:59],a[160:163],v[204:207]
C v186,v188,v189
C v187,v190,v191
M v[208:211],a[64:67],a[160:163],v[208:211]
C v192,v192,v193
C v193,v194,v195
M v[208:211],a[68:71],a[164:167],v[208:211]
C v194,v196,v197
C v195,v198,v199
M v[212:215],a[76:79],a[164:167],v[212:215]
M v[212:215],a[72:75],a[160:163],v[212:215]
C v200,v200,v201
C v201,v202,v203
M v[216:219],a[80:83],a[160:163],v[216:219]
C v202,v204,v205
C v203,v206,v207
M v[216:219],a[84:87],a[164:167],v[216:219]
s_waitcnt lgkmcnt(4)
M v[220:223],a[92:95],a[164:167],v[220:223]
s_waitcnt vmcnt(9) lgkmcnt(0)
M v[220:223],a[88:91],a[160:163],v[220:223]
s_barrier
M v[224:227],a[32:35],a[168:171],v[224:227]
s_nop 0
T v[32:33],v16,0
T v[34:35],v16,2048
M v[224:227],a[36:39],a[172:175],v[224:227]
C v208,v208,v209
C v209,v210,v211
M v[228:231],a[44:47],a[172:175],v[228:231]
T v[36:37],v16,4096
T v[38:39],v16,6144
M v[228:231],a[40:43],a[168:171],v[228:231]
T v[40:41],v16,8192
T v[42:43],v16,10240
M v[232:235],a[48:51],a[168:171],v[232:235]
C v210,v212,v213
C v211,v214,v215
M v[232:235],a[52:55],a[172:175],v[232:235]
T v[44:45],v16,12288
T v[46:47],v16,14336
M v[236:239],a[60:63],a[172:175],v[236:239]
T v[48:49],v16,16384
T v[50:51],v16,18432
M v[236:239],a[56:59],a[168:171],v[236:239]
C v216,v216,v217
C v217,v218,v219
M v[240:243],a[64:67],a[168:171],v[240:243]
T v[52:53],v16,20480
T v[54:55],v16,22528
M v[240:243],a[68:71],a[172:175],v[240:243]
T v[56:57],v16,24576
T v[58:59],v16,26624
M v[244:247],a[76:79],a[172:175],v[244:247]
C v218,v220,v221
C v219,v222,v223
M v[244:247],a[72:75],a[168:171],v[244:247]
C v224,v224,v225
C v225,v226,v227
M v[248:251],a[80:83],a[168:171],v[248:251]
C v226,v228,v229
C v227,v230,v231
M v[248:251],a[84:87],a[172:175],v[248:251]
C v232,v232,v233
C v233,v234,v235
M v[252:255],a[92:95],a[172:175],v[252:255]
C v234,v236,v237
C v235,v238,v239
M v[252:255],a[88:91],a[168:171],v[252:255]
s_waitcnt lgkmcnt(6)
C v240,v240,v241
C v241,v242,v243
M v[68:71],v[32:35],a[176:179],0
s_mul_i32 s72, s41, 4352
T a[144:145],v17,0
T a[146:147],v17,2048
M v[68:71],v[36:39],a[184:187],v[68:71]
s_mov_b32 s25, 1048704
C v242,v244,v245
C v243,v246,v247
M v[68:71],v[40:43],a[192:195],v[68:71]
s_waitcnt lgkmcnt(2)
T a[148:149],v17,4096
T a[150:151],v17,6144
M v[68:71],v[44:47],a[200:203],v[68:71]
SA m0,s4,98304
T a[152:153],v17,8192
T a[154:155],v17,10240
M v[68:71],v[48:51],a[208:211],v[68:71]
SA s46,s72,104923136
buffer_load_dwordx4 v8, s[52:55], s25 offen lds
M v[68:71],v[52:55],a[216:219],v[68:71]
s_lshl_b32 s45, s42, 7
T a[156:157],v17,12288
T a[158:159],v17,14336
M v[68:71],v[56:59],a[224:227],v[68:71]
s_mov_b32 s25, 1310848
T a[160:161],v17,16384
T a[162:163],v17,18432
M v[76:79],v[56:59],a[228:231],0
SA m0,s4,102400
C v248,v248,v249
C v249,v250,v251
M v[76:79],v[52:55],a[220:223],v[76:79]
SA s45,s45,s46
T a[164:165],v17,20480
T a[166:167],v17,22528
M v[76:79],v[48:51],a[212:215],v[76:79]
s_lshl_b32 s72, s20, 2
T a[168:169],v17,24576
T a[170:171],v17,26624
M v[76:79],v[44:47],a[204:207],v[76:79]
SA s72,s72,s45
buffer_load_dwordx4 v8, s[52:55], s25 offen lds
M v[76:79],v[40:43],a[196:199],v[76:79]
C v250,v252,v253
C v251,v254,v255
M v[76:79],v[36:39],a[188:191],v[76:79]
s_mov_b32 s25, 1572992
v_min_u32 v29, 1, v0
v_lshlrev_b32 v29, 29, v29
M v[76:79],v[32:35],a[180:183],v[76:79]
s_waitcnt lgkmcnt(6)
v_mov_b32 v30, 1
M v[84:87],a[144:147],a[176:179],0
SA m0,s4,106496
T v[32:33],v18,0
T v[34:35],v18,2048
M v[84:87],a[148:151],a[184:187],v[84:87]
buffer_load_dwordx4 v8, s[52:55], s25 offen lds
M v[84:87],a[152:155],a[192:195],v[84:87]
s_waitcnt lgkmcnt(2)
s_nop 0
T v[36:37],v18,4096
T v[38:39],v18,6144
M v[84:87],a[156:159],a[200:203],v[84:87]
s_mov_b32 s25, 1835136
T v[40:41],v18,8192
T v[42:43],v18,10240
M v[84:87],a[160:163],a[208:211],v[84:87]
SA m0,s4,110592
M v[84:87],a[164:167],a[216:219],v[84:87]
s_nop 0
T v[44:45],v18,12288
T v[46:47],v18,14336
M v[84:87],a[168:171],a[224:227],v[84:87]
s_waitcnt vmcnt(3)
T v[48:49],v18,16384
T v[50:51],v18,18432
M v[92:95],a[168:171],a[228:231],0
buffer_load_dwordx4 v8, s[52:55], s25 offen lds
M v[92:95],a[164:167],a[220:223],v[92:95]
s_nop 0
T v[52:53],v18,20480
T v[54:55],v18,22528
M v[92:95],a[160:163],a[212:215],v[92:95]
s_mov_b32 s25, 2097280
T v[56:57],v18,24576
T v[58:59],v18,26624
M v[92:95],a[156:159],a[204:207],v[92:95]
SA m0,s4,114688
buffer_store_dword v30, v29, s[8:11], s72 offen offset:4 sc1
M v[92:95],a[152:155],a[196:199],v[92:95]
SA s3,s93,524288
buffer_load_dwordx4 v8, s[52:55], s25 offen lds
M v[92:95],a[148:151],a[188:191],v[92:95]
v_add_u32 v20, 0x10000, v16
v_add_u32 v21, 0x10000, v17
M v[92:95],a[144:147],a[180:183],v[92:95]
s_waitcnt lgkmcnt(6)
buffer_store_dwordx4 v[64:67], v7, s[8:11], s3 offen offset:0 sc1
M v[100:103],v[32:35],a[176:179],0
s_mov_b32 s25, 2359424
L_w_kv08:
s_cbranch_execz L_wd1
T a[144:145],v19,0
T a[146:147],v19,2048
M v[100:103],v[36:39],a[184:187],v[100:103]
SA m0,s4,118784
buffer_store_dwordx4 v[72:75], v7, s[8:11], s3 offen offset:1024 sc1
M v[100:103],v[40:43],a[192:195],v[100:103]
s_waitcnt lgkmcnt(2)
s_nop 0
T a[148:149],v19,4096
T a[150:151],v19,6144
M v[100:103],v[44:47],a[200:203],v[100:103]
T a[152:153],v19,8192
T a[154:155],v19,10240
M v[100:103],v[48:51],a[208:211],v[100:103]
buffer_load_dwordx4 v8, s[52:55], s25 offen lds
M v[100:103],v[52:55],a[216:219],v[100:103]
s_nop 0
T a[156:157],v19,12288
T a[158:159],v19,14336
M v[100:103],v[56:59],a[224:227],v[100:103]
s_mov_b32 s25, 2621568
T a[160:161],v19,16384
T a[162:163],v19,18432
M v[108:111],v[56:59],a[228:231],0
SA m0,s4,122880
buffer_store_dwordx4 v[80:83], v7, s[8:11], s3 offen offset:2048 sc1
M v[108:111],v[52:55],a[220:223],v[108:111]
s_nop 0
T a[164:165],v19,20480
T a[166:167],v19,22528
M v[108:111],v[48:51],a[212:215],v[108:111]
T a[168:169],v19,24576
T a[170:171],v19,26624
M v[108:111],v[44:47],a[204:207],v[108:111]
buffer_load_dwordx4 v8, s[52:55], s25 offen lds
M v[108:111],v[40:43],a[196:199],v[108:111]
v_add_u32 v22, 0x10000, v18
v_add_u32 v23, 0x10000, v19
M v[108:111],v[36:39],a[188:191],v[108:111]
s_mov_b32 s25, 2883712
buffer_store_dwordx4 v[88:91], v7, s[8:11], s3 offen offset:3072 sc1
M v[108:111],v[32:35],a[180:183],v[108:111]
s_waitcnt lgkmcnt(6)
v_or_b32 v1, s20, v0
v_min_u32 v1, 1, v1
M v[116:119],a[144:147],a[176:179],0
SA m0,s4,126976
T v[32:33],v16,28672
T v[34:35],v16,30720
M v[116:119],a[148:151],a[184:187],v[116:119]
buffer_load_dwordx4 v8, s[52:55], s25 offen lds
M v[116:119],a[152:155],a[192:195],v[116:119]
s_waitcnt lgkmcnt(2)
s_nop 0
T v[36:37],v12,0
T v[38:39],v12,2048
M v[116:119],a[156:159],a[200:203],v[116:119]
s_mov_b32 s25, 3145856
T v[40:41],v12,4096
T v[42:43],v12,6144
M v[116:119],a[160:163],a[208:211],v[116:119]
SA m0,s4,32768
v_lshlrev_b32 v1, 29, v1
M v[116:119],a[164:167],a[216:219],v[116:119]
s_nop 0
T v[44:45],v12,8192
T v[46:47],v12,10240
M v[116:119],a[168:171],a[224:227],v[116:119]
T v[48:49],v12,12288
T v[50:51],v12,14336
M v[124:127],a[168:171],a[228:231],0
buffer_load_dwordx4 v8, s[52:55], s25 offen lds
M v[124:127],a[164:167],a[220:223],v[124:127]
s_nop 0
T v[52:53],v12,16384
T v[54:55],v12,18432
M v[124:127],a[160:163],a[212:215],v[124:127]
s_mov_b32 s25, 3408000
T v[56:57],v12,20480
T v[58:59],v12,22528
M v[124:127],a[156:159],a[204:207],v[124:127]
SA m0,s4,36864
v_min_u32 v9, 15, v0
v_lshlrev_b32 v9, 7, v9
M v[124:127],a[152:155],a[196:199],v[124:127]
s_sub_u32 s66, 15, s42
buffer_load_dwordx4 v8, s[52:55], s25 offen lds
M v[124:127],a[148:151],a[188:191],v[124:127]
s_max_u32 s67, s66, s42
M v[124:127],a[144:147],a[180:183],v[124:127]
s_waitcnt lgkmcnt(6)
M v[68:71],v[32:35],a[232:235],v[68:71]
s_mov_b32 s25, 256
T a[144:145],v17,28672
T a[146:147],v17,30720
M v[68:71],v[36:39],a[96:99],v[68:71]
SA m0,s4,65536
M v[68:71],v[40:43],a[104:107],v[68:71]
s_waitcnt lgkmcnt(2)
s_nop 0
T a[148:149],v13,0
T a[150:151],v13,2048
M v[68:71],v[44:47],a[112:115],v[68:71]
s_min_u32 s66, s66, s42
T a[152:153],v13,4096
T a[154:155],v13,6144
M v[68:71],v[48:51],a[120:123],v[68:71]
s_mul_i32 s21, s41, 1048576
buffer_load_dwordx4 v8, s[52:55], s25 offen lds
M v[68:71],v[52:55],a[128:131],v[68:71]
s_lshl_b32 s64, s67, 16
T a[156:157],v13,8192
T a[158:159],v13,10240
M v[68:71],v[56:59],a[136:139],v[68:71]
s_mov_b32 s25, 262400
T a[160:161],v13,12288
T a[162:163],v13,14336
M v[76:79],v[56:59],a[140:143],v[76:79]
SA m0,s4,69632
M v[76:79],v[52:55],a[132:135],v[76:79]
SA s32,s21,s64
T a[164:165],v13,16384
T a[166:167],v13,18432
M v[76:79],v[48:51],a[124:127],v[76:79]
s_lshl_b32 s64, s20, 14
T a[168:169],v13,20480
T a[170:171],v13,22528
M v[76:79],v[44:47],a[116:119],v[76:79]
SA s32,s32,s64
buffer_load_dwordx4 v8, s[52:55], s25 offen lds
M v[76:79],v[40:43],a[108:111],v[76:79]
SA s32,s32,33554432
M v[76:79],v[36:39],a[100:103],v[76:79]
s_mov_b32 s25, 524544
M v[76:79],v[32:35],a[236:239],v[76:79]
s_waitcnt lgkmcnt(6)
M v[84:87],a[144:147],a[232:235],v[84:87]
SA m0,s4,73728
T v[32:33],v18,28672
T v[34:35],v18,30720
M v[84:87],a[148:151],a[96:99],v[84:87]
s_sub_u32 s64, s42, 10
buffer_load_dwordx4 v8, s[52:55], s25 offen lds
M v[84:87],a[152:155],a[104:107],v[84:87]
s_waitcnt lgkmcnt(2)
s_nop 0
T v[36:37],v14,0
T v[38:39],v14,2048
M v[84:87],a[156:159],a[112:115],v[84:87]
s_mov_b32 s25, 786688
T v[40:41],v14,4096
T v[42:43],v14,6144
M v[84:87],a[160:163],a[120:123],v[84:87]
SA m0,s4,77824
M v[84:87],a[164:167],a[128:131],v[84:87]
s_and_b32 s35, s64, 536870912
T v[44:45],v14,8192
T v[46:47],v14,10240
M v[84:87],a[168:171],a[136:139],v[84:87]
T v[48:49],v14,12288
T v[50:51],v14,14336
M v[92:95],a[168:171],a[140:143],v[92:95]
buffer_load_dwordx4 v8, s[52:55], s25 offen lds
M v[92:95],a[164:167],a[132:135],v[92:95]
s_nop 0
T v[52:53],v14,16384
T v[54:55],v14,18432
M v[92:95],a[160:163],a[124:127],v[92:95]
s_mov_b32 s25, 1048832
T v[56:57],v14,20480
T v[58:59],v14,22528
M v[92:95],a[156:159],a[116:119],v[92:95]
SA m0,s4,81920
v_or_b32 v6, s35, v7
MF v68,s5,v68
M v[92:95],a[152:155],a[108:111],v[92:95]
s_lshl_b32 s28, s20, 13
buffer_load_dwordx4 v8, s[52:55], s25 offen lds
M v[92:95],a[148:151],a[100:103],v[92:95]
v_add_u32 v2, 0x10000, v7
v_add_u32 v3, s28, v7
M v[92:95],a[144:147],a[236:239],v[92:95]
s_waitcnt lgkmcnt(6)
v_add_u32 v4, 0x1000, v3
MF v69,s5,v69
M v[100:103],v[32:35],a[232:235],v[100:103]
s_mov_b32 s25, 1310976
T a[144:145],v19,28672
T a[146:147],v19,30720
M v[100:103],v[36:39],a[96:99],v[100:103]
SA m0,s4,86016
MF v70,s5,v70
MF v71,s5,v71
M v[100:103],v[40:43],a[104:107],v[100:103]
s_waitcnt lgkmcnt(2)
T a[148:149],v15,0
T a[150:151],v15,2048
M v[100:103],v[44:47],a[112:115],v[100:103]
s_lshl_b32 s64, s42, 16
T a[152:153],v15,4096
T a[154:155],v15,6144
M v[100:103],v[48:51],a[120:123],v[100:103]
SA s23,s21,s64
buffer_load_dwordx4 v8, s[52:55], s25 offen lds
M v[100:103],v[52:55],a[128:131],v[100:103]
SA s43,s23,16777216
T a[156:157],v15,8192
T a[158:159],v15,10240
M v[100:103],v[56:59],a[136:139],v[100:103]
s_mov_b32 s25, 1573120
T a[160:161],v15,12288
T a[162:163],v15,14336
M v[108:111],v[56:59],a[140:143],v[108:111]
SA m0,s4,90112
MF v84,s5,v84
MF v85,s5,v85
M v[108:111],v[52:55],a[132:135],v[108:111]
SA s26,s21,16777216
T a[164:165],v15,16384
T a[166:167],v15,18432
M v[108:111],v[48:51],a[124:127],v[108:111]
s_mov_b32 s22, 0x7fff
T a[168:169],v15,20480
T a[170:171],v15,22528
M v[108:111],v[44:47],a[116:119],v[108:111]
s_sub_u32 s27, s42, 1
buffer_load_dwordx4 v8, s[52:55], s25 offen lds
M v[108:111],v[40:43],a[108:111],v[108:111]
s_cmp_eq_u32 s42, 0
MF v86,s5,v86
MF v87,s5,v87
M v[108:111],v[36:39],a[100:103],v[108:111]
s_waitcnt vmcnt(7) lgkmcnt(0)
C v68,v68,v69
C v69,v70,v71
M v[108:111],v[32:35],a[236:239],v[108:111]
s_barrier
M v[116:119],a[144:147],a[232:235],v[116:119]
s_mov_b32 s25, 1835264
T v[32:33],v16,49152
T v[34:35],v16,51200
M v[116:119],a[148:151],a[96:99],v[116:119]
s_cselect_b32 s64, 32768, 0
C v70,v84,v85
C v71,v86,v87
M v[116:119],a[152:155],a[104:107],v[116:119]
SA m0,s4,94208
T v[36:37],v16,53248
T v[38:39],v16,55296
M v[116:119],a[156:159],a[112:115],v[116:119]
SA s26,s26,s64
T v[40:41],v16,57344
T v[42:43],v16,59392
M v[116:119],a[160:163],a[120:123],v[116:119]
s_mov_b32 s31, 0x4b800000
buffer_load_dwordx4 v8, s[52:55], s25 offen lds
M v[116:119],a[164:167],a[128:131],v[116:119]
s_mov_b32 s24, 0x33800000
T v[44:45],v16,61440
T v[46:47],v16,63488
M v[116:119],a[168:171],a[136:139],v[116:119]
s_mov_b32 s25, 2097408
T v[48:49],v20,32768
T v[50:51],v20,34816
M v[124:127],a[168:171],a[140:143],v[124:127]
SA m0,s4,155648
W a0,v68
W a1,v69
M v[124:127],a[164:167],a[132:135],v[124:127]
s_lshl_b32 s47, s66, 7
T v[52:53],v20,36864
T v[54:55],v20,38912
M v[124:127],a[160:163],a[124:127],v[124:127]
SA s47,s47,s46
T v[56:57],v20,40960
T v[58:59],v20,43008
M v[124:127],a[156:159],a[116:119],v[124:127]
s_lshl_b32 s64, s20, 5
buffer_load_dwordx4 v8, s[52:55], s25 offen lds
M v[124:127],a[152:155],a[108:111],v[124:127]
SA s47,s47,s64
W a2,v70
W a3,v71
M v[124:127],a[148:151],a[100:103],v[124:127]
SA s47,s47,2048
MF v76,s5,v76
MF v77,s5,v77
M v[124:127],a[144:147],a[236:239],v[124:127]
s_waitcnt lgkmcnt(6)
MF v78,s5,v78
MF v79,s5,v79
M v[132:135],v[32:35],a[176:179],0
s_lshl_b32 s65, s41, 3
T a[144:145],v17,49152
T a[146:147],v17,51200
M v[132:135],v[36:39],a[184:187],v[132:135]
SA s65,s65,s66
MF v92,s5,v92
MF v93,s5,v93
M v[132:135],v[40:43],a[192:195],v[132:135]
s_waitcnt lgkmcnt(2)
T a[148:149],v17,53248
T a[150:151],v17,55296
M v[132:135],v[44:47],a[200:203],v[132:135]
s_mul_i32 s34, s65, 73728
T a[152:153],v17,57344
T a[154:155],v17,59392
M v[132:135],v[48:51],a[208:211],v[132:135]
SA s34,s34,136314880
MF v94,s5,v94
MF v95,s5,v95
M v[132:135],v[52:55],a[216:219],v[132:135]
s_lshl_b32 s65, s42, 4
T a[156:157],v17,61440
T a[158:159],v17,63488
M v[132:135],v[56:59],a[224:227],v[132:135]
SA s65,s65,s41
T a[160:161],v21,32768
T a[162:163],v21,34816
M v[140:143],v[56:59],a[228:231],0
s_mul_i32 s33, s65, 114688
C v76,v76,v77
C v77,v78,v79
M v[140:143],v[52:55],a[220:223],v[140:143]
s_mul_i32 s65, s20, 28672
T a[164:165],v21,36864
T a[166:167],v21,38912
M v[140:143],v[48:51],a[212:215],v[140:143]
SA s33,s33,s65
T a[168:169],v21,40960
T a[170:171],v21,43008
M v[140:143],v[44:47],a[204:207],v[140:143]
SA s33,s33,67108864
C v78,v92,v93
C v79,v94,v95
M v[140:143],v[40:43],a[196:199],v[140:143]
s_mov_b32 s6, 0
W a32,v76
W a33,v77
M v[140:143],v[36:39],a[188:191],v[140:143]
s_mov_b32 s7, 0
W a34,v78
W a35,v79
M v[140:143],v[32:35],a[180:183],v[140:143]
s_waitcnt lgkmcnt(6)
MF v100,s5,v100
MF v101,s5,v101
M v[148:151],a[144:147],a[176:179],0
s_mov_b32 s40, 1
T v[32:33],v18,49152
T v[34:35],v18,51200
M v[148:151],a[148:151],a[184:187],v[148:151]
s_cmp_eq_u32 s20, 0
MF v102,s5,v102
MF v103,s5,v103
M v[148:151],a[152:155],a[192:195],v[148:151]
s_waitcnt lgkmcnt(2)
T v[36:37],v18,53248
T v[38:39],v18,55296
M v[148:151],a[156:159],a[200:203],v[148:151]
s_cselect_b32 s39, 7, 4
T v[40:41],v18,57344
T v[42:43],v18,59392
M v[148:151],a[160:163],a[208:211],v[148:151]
s_lshl_b32 s64, s41, 1
MF v116,s5,v116
MF v117,s5,v117
M v[148:151],a[164:167],a[216:219],v[148:151]
SA s64,s64,s20
T v[44:45],v18,61440
T v[46:47],v18,63488
M v[148:151],a[168:171],a[224:227],v[148:151]
s_cmp_lt_u32 s64, 30
T v[48:49],v22,32768
T v[50:51],v22,34816
M v[156:159],a[168:171],a[228:231],0
s_cselect_b32 s64, 32798, 0
MF v118,s5,v118
MF v119,s5,v119
M v[156:159],a[164:167],a[220:223],v[156:159]
s_cmp_ge_u32 s20, 2
T v[52:53],v22,36864
T v[54:55],v22,38912
M v[156:159],a[160:163],a[212:215],v[156:159]
s_cselect_b32 s64, s64, 0
T v[56:57],v22,40960
T v[58:59],v22,43008
M v[156:159],a[156:159],a[204:207],v[156:159]
s_cmp_eq_u32 s42, 6
C v100,v100,v101
C v101,v102,v103
M v[156:159],a[152:155],a[196:199],v[156:159]
s_cselect_b32 s64, s64, 0
C v102,v116,v117
C v103,v118,v119
M v[156:159],a[148:151],a[188:191],v[156:159]
s_or_b32 s39, s39, s64
W a4,v100
W a5,v101
M v[156:159],a[144:147],a[180:183],v[156:159]
s_waitcnt lgkmcnt(6)
W a6,v102
W a7,v103
M v[164:167],v[32:35],a[176:179],0
s_mov_b64 s[60:61], s[76:77]
T a[144:145],v19,49152
T a[146:147],v19,51200
M v[164:167],v[36:39],a[184:187],v[164:167]
s_mov_b32 s62, s78
MF v108,s5,v108
MF v109,s5,v109
M v[164:167],v[40:43],a[192:195],v[164:167]
s_waitcnt lgkmcnt(2)
T a[148:149],v19,53248
T a[150:151],v19,55296
M v[164:167],v[44:47],a[200:203],v[164:167]
s_mov_b32 s63, 0x20000
T a[152:153],v19,57344
T a[154:155],v19,59392
M v[164:167],v[48:51],a[208:211],v[164:167]
s_mov_b32 s25, 2359552
v_lshrrev_b32 v24, 4, v0
v_lshlrev_b32 v24, 2, v24
M v[164:167],v[52:55],a[216:219],v[164:167]
SA m0,s4,159744
T a[156:157],v19,61440
T a[158:159],v19,63488
M v[164:167],v[56:59],a[224:227],v[164:167]
SA s3,s93,532480
T a[160:161],v23,32768
T a[162:163],v23,34816
M v[172:175],v[56:59],a[228:231],0
buffer_load_dwordx4 v8, s[52:55], s25 offen lds
M v[172:175],v[52:55],a[220:223],v[172:175]
s_nop 0
T a[164:165],v23,36864
T a[166:167],v23,38912
M v[172:175],v[48:51],a[212:215],v[172:175]
s_mov_b32 s25, 2621696
T a[168:169],v23,40960
T a[170:171],v23,43008
M v[172:175],v[44:47],a[204:207],v[172:175]
SA m0,s4,131072
buffer_store_dwordx4 v[96:99], v7, s[8:11], s3 offen offset:0 sc1
M v[172:175],v[40:43],a[196:199],v[172:175]
v_and_b32 v25, 15, v0
v_sub_u32 v24, v24, v25
M v[172:175],v[36:39],a[188:191],v[172:175]
buffer_load_dwordx4 v8, s[52:55], s25 offen lds
M v[172:175],v[32:35],a[180:183],v[172:175]
s_waitcnt lgkmcnt(6)
v_cmp_lt_i32 s[16:17], 0, v24
v_cmp_lt_i32 s[18:19], -1, v24
M v[180:183],a[144:147],a[176:179],0
s_mov_b32 s25, 2883840
T v[32:33],v20,45056
T v[34:35],v20,47104
M v[180:183],a[148:151],a[184:187],v[180:183]
SA m0,s4,135168
buffer_store_dwordx4 v[104:107], v7, s[8:11], s3 offen offset:1024 sc1
M v[180:183],a[152:155],a[192:195],v[180:183]
s_waitcnt lgkmcnt(2)
s_nop 0
T v[36:37],v20,49152
T v[38:39],v20,51200
M v[180:183],a[156:159],a[200:203],v[180:183]
T v[40:41],v20,53248
T v[42:43],v20,55296
M v[180:183],a[160:163],a[208:211],v[180:183]
buffer_load_dwordx4 v8, s[52:55], s25 offen lds
M v[180:183],a[164:167],a[216:219],v[180:183]
s_nop 0
T v[44:45],v20,57344
T v[46:47],v20,59392
M v[180:183],a[168:171],a[224:227],v[180:183]
s_mov_b32 s25, 3145984
T v[48:49],v20,61440
T v[50:51],v20,63488
M v[188:191],a[168:171],a[228:231],0
SA m0,s4,139264
buffer_store_dwordx4 v[112:115], v7, s[8:11], s3 offen offset:2048 sc1
M v[188:191],a[164:167],a[220:223],v[188:191]
s_nop 0
T v[52:53],v16,32768
T v[54:55],v16,34816
M v[188:191],a[160:163],a[212:215],v[188:191]
T v[56:57],v16,36864
T v[58:59],v16,38912
M v[188:191],a[156:159],a[204:207],v[188:191]
buffer_load_dwordx4 v8, s[52:55], s25 offen lds
M v[188:191],a[152:155],a[196:199],v[188:191]
v_cmp_lt_i32 s[48:49], -2, v24
v_cmp_lt_i32 s[50:51], -3, v24
M v[188:191],a[148:151],a[188:191],v[188:191]
s_mov_b32 s25, 3408128
buffer_store_dwordx4 v[120:123], v7, s[8:11], s3 offen offset:3072 sc1
M v[188:191],a[144:147],a[180:183],v[188:191]
s_waitcnt lgkmcnt(6)
v_lshl_add_u32 v25, v0, 7, s95
v_and_b32 v0, 48, v0
M v[132:135],v[32:35],a[232:235],v[132:135]
SA m0,s4,143360
T a[144:145],v21,45056
T a[146:147],v21,47104
M v[132:135],v[36:39],a[96:99],v[132:135]
buffer_load_dwordx4 v8, s[52:55], s25 offen lds
M v[132:135],v[40:43],a[104:107],v[132:135]
s_waitcnt lgkmcnt(2)
s_nop 0
T a[148:149],v21,49152
T a[150:151],v21,51200
M v[132:135],v[44:47],a[112:115],v[132:135]
s_mov_b32 s25, 384
T a[152:153],v21,53248
T a[154:155],v21,55296
M v[132:135],v[48:51],a[120:123],v[132:135]
SA m0,s4,0
v_lshl_add_u32 v0, v0, 24, v25
v_mov_b32 v24, 0x3f80
M v[132:135],v[52:55],a[128:131],v[132:135]
T a[156:157],v21,57344
T a[158:159],v21,59392
M v[132:135],v[56:59],a[136:139],v[132:135]
T a[160:161],v21,61440
T a[162:163],v21,63488
M v[140:143],v[56:59],a[140:143],v[140:143]
buffer_load_dwordx4 v8, s[52:55], s25 offen lds
M v[140:143],v[52:55],a[132:135],v[140:143]
s_nop 0
T a[164:165],v17,32768
T a[166:167],v17,34816
M v[140:143],v[48:51],a[124:127],v[140:143]
s_mov_b32 s25, 262528
T a[168:169],v17,36864
T a[170:171],v17,38912
M v[140:143],v[44:47],a[116:119],v[140:143]
SA m0,s4,4096
MF v110,s5,v110
MF v111,s5,v111
M v[140:143],v[40:43],a[108:111],v[140:143]
buffer_load_dwordx4 v8, s[52:55], s25 offen lds
M v[140:143],v[36:39],a[100:103],v[140:143]
MF v124,s5,v124
MF v125,s5,v125
M v[140:143],v[32:35],a[236:239],v[140:143]
s_waitcnt lgkmcnt(6)
MF v126,s5,v126
MF v127,s5,v127
M v[148:151],a[144:147],a[232:235],v[148:151]
s_mov_b32 s25, 524672
T v[32:33],v22,45056
T v[34:35],v22,47104
M v[148:151],a[148:151],a[96:99],v[148:151]
SA m0,s4,8192
C v108,v108,v109
C v109,v110,v111
M v[148:151],a[152:155],a[104:107],v[148:151]
s_waitcnt lgkmcnt(2)
T v[36:37],v22,49152
T v[38:39],v22,51200
M v[148:151],a[156:159],a[112:115],v[148:151]
T v[40:41],v22,53248
T v[42:43],v22,55296
M v[148:151],a[160:163],a[120:123],v[148:151]
buffer_load_dwordx4 v8, s[52:55], s25 offen lds
M v[148:151],a[164:167],a[128:131],v[148:151]
s_nop 0
T v[44:45],v22,57344
T v[46:47],v22,59392
M v[148:151],a[168:171],a[136:139],v[148:151]
s_mov_b32 s25, 786816
T v[48:49],v22,61440
T v[50:51],v22,63488
M v[156:159],a[168:171],a[140:143],v[156:159]
SA m0,s4,12288
C v110,v124,v125
C v111,v126,v127
M v[156:159],a[164:167],a[132:135],v[156:159]
T v[52:53],v18,32768
T v[54:55],v18,34816
M v[156:159],a[160:163],a[124:127],v[156:159]
T v[56:57],v18,36864
T v[58:59],v18,38912
M v[156:159],a[156:159],a[116:119],v[156:159]
buffer_load_dwordx4 v8, s[52:55], s25 offen lds
M v[156:159],a[152:155],a[108:111],v[156:159]
W a36,v108
W a37,v109
M v[156:159],a[148:151],a[100:103],v[156:159]
s_mov_b32 s25, 1048960
v_lshrrev_b32 v25, 8, v7
v_bfe_u32 v26, v7, 6, 2
v_and_b32 v27, 16, v7
v_lshlrev_b32 v27, v27, v24
v_cmp_eq_u32 vcc, v25, v26
v_and_b32 v28, 32, v7
W a244,0
v_cndmask_b32 v27, 0, v27, vcc
v_cmp_eq_u32 vcc, 0, v28
W a245,0
W a248,0
v_cndmask_b32 v25, 0, v27, vcc
v_sub_u32 v26, v27, v25
W a249,0
W a246,v25
W a247,v26
M v[156:159],a[144:147],a[236:239],v[156:159]
s_waitcnt lgkmcnt(6)
W a38,v110
W a39,v111
M v[164:167],v[32:35],a[232:235],v[164:167]
SA m0,s4,16384
T a[144:145],v23,45056
T a[146:147],v23,47104
M v[164:167],v[36:39],a[96:99],v[164:167]
buffer_load_dwordx4 v8, s[52:55], s25 offen lds
M v[164:167],v[40:43],a[104:107],v[164:167]
s_waitcnt lgkmcnt(2)
s_nop 0
T a[148:149],v23,49152
T a[150:151],v23,51200
M v[164:167],v[44:47],a[112:115],v[164:167]
s_mov_b32 s25, 1311104
T a[152:153],v23,53248
T a[154:155],v23,55296
M v[164:167],v[48:51],a[120:123],v[164:167]
SA m0,s4,20480
MF v132,s5,v132
MF v133,s5,v133
M v[164:167],v[52:55],a[128:131],v[164:167]
T a[156:157],v23,57344
T a[158:159],v23,59392
M v[164:167],v[56:59],a[136:139],v[164:167]
T a[160:161],v23,61440
T a[162:163],v23,63488
M v[172:175],v[56:59],a[140:143],v[172:175]
buffer_load_dwordx4 v8, s[52:55], s25 offen lds
M v[172:175],v[52:55],a[132:135],v[172:175]
s_nop 0
T a[164:165],v19,32768
T a[166:167],v19,34816
M v[172:175],v[48:51],a[124:127],v[172:175]
s_mov_b32 s25, 1573248
T a[168:169],v19,36864
T a[170:171],v19,38912
M v[172:175],v[44:47],a[116:119],v[172:175]
SA m0,s4,24576
MF v134,s5,v134
MF v135,s5,v135
M v[172:175],v[40:43],a[108:111],v[172:175]
buffer_load_dwordx4 v8, s[52:55], s25 offen lds
M v[172:175],v[36:39],a[100:103],v[172:175]
s_waitcnt vmcnt(7) lgkmcnt(0)
MF v148,s5,v148
MF v149,s5,v149
M v[172:175],v[32:35],a[236:239],v[172:175]
s_barrier
M v[180:183],a[144:147],a[232:235],v[180:183]
s_mov_b32 s25, 1835392
T v[32:33],v20,0
T v[34:35],v20,2048
M v[180:183],a[148:151],a[96:99],v[180:183]
SA m0,s4,28672
MF v150,s5,v150
MF v151,s5,v151
M v[180:183],a[152:155],a[104:107],v[180:183]
T v[36:37],v20,4096
T v[38:39],v20,6144
M v[180:183],a[156:159],a[112:115],v[180:183]
T v[40:41],v20,8192
T v[42:43],v20,10240
M v[180:183],a[160:163],a[120:123],v[180:183]
buffer_load_dwordx4 v8, s[52:55], s25 offen lds
M v[180:183],a[164:167],a[128:131],v[180:183]
s_nop 0
T v[44:45],v20,12288
T v[46:47],v20,14336
M v[180:183],a[168:171],a[136:139],v[180:183]
s_mov_b32 s25, 2097536
T v[48:49],v20,16384
T v[50:51],v20,18432
M v[188:191],a[168:171],a[140:143],v[188:191]
SA m0,s4,40960
C v132,v132,v133
C v133,v134,v135
M v[188:191],a[164:167],a[132:135],v[188:191]
T v[52:53],v20,20480
T v[54:55],v20,22528
M v[188:191],a[160:163],a[124:127],v[188:191]
T v[56:57],v20,24576
T v[58:59],v20,26624
M v[188:191],a[156:159],a[116:119],v[188:191]
buffer_load_dwordx4 v8, s[52:55], s25 offen lds
M v[188:191],a[152:155],a[108:111],v[188:191]
C v134,v148,v149
C v135,v150,v151
M v[188:191],a[148:151],a[100:103],v[188:191]
s_mov_b32 s25, 2359680
W a8,v132
W a9,v133
M v[188:191],a[144:147],a[236:239],v[188:191]
s_waitcnt lgkmcnt(6)
W a10,v134
W a11,v135
M v[68:71],v[32:35],a[176:179],0
SA m0,s4,45056
T a[144:145],v21,0
T a[146:147],v21,2048
M v[68:71],v[36:39],a[184:187],v[68:71]
buffer_load_dwordx4 v8, s[52:55], s25 offen lds
M v[68:71],v[40:43],a[192:195],v[68:71]
s_waitcnt lgkmcnt(2)
s_nop 0
T a[148:149],v21,4096
T a[150:151],v21,6144
M v[68:71],v[44:47],a[200:203],v[68:71]
s_mov_b32 s25, 2621824
T a[152:153],v21,8192
T a[154:155],v21,10240
M v[68:71],v[48:51],a[208:211],v[68:71]
SA m0,s4,49152
v_lshrrev_b32 v31, 6, v7
v_bfe_u32 v28, v7, 4, 2
M v[68:71],v[52:55],a[216:219],v[68:71]
T a[156:157],v21,12288
T a[158:159],v21,14336
M v[68:71],v[56:59],a[224:227],v[68:71]
T a[160:161],v21,16384
T a[162:163],v21,18432
M v[76:79],v[56:59],a[228:231],0
buffer_load_dwordx4 v8, s[52:55], s25 offen lds
M v[76:79],v[52:55],a[220:223],v[76:79]
s_nop 0
T a[164:165],v21,20480
T a[166:167],v21,22528
M v[76:79],v[48:51],a[212:215],v[76:79]
s_mov_b32 s25, 2883968
T a[168:169],v21,24576
T a[170:171],v21,26624
M v[76:79],v[44:47],a[204:207],v[76:79]
SA m0,s4,53248
v_lshlrev_b32 v31, 5, v31
v_add_lshl_u32 v31, v31, v28, 2
M v[76:79],v[40:43],a[196:199],v[76:79]
SA s3,s93,262144
buffer_load_dword v5, v31, s[8:11], s46 offen offset:4 sc1
M v[76:79],v[36:39],a[188:191],v[76:79]
buffer_load_dwordx4 v8, s[52:55], s25 offen lds
M v[76:79],v[32:35],a[180:183],v[76:79]
s_waitcnt lgkmcnt(6)
MF v140,s5,v140
MF v141,s5,v141
M v[84:87],a[144:147],a[176:179],0
s_mov_b32 s25, 3146112
T v[32:33],v22,0
T v[34:35],v22,2048
M v[84:87],a[148:151],a[184:187],v[84:87]
SA m0,s4,57344
buffer_store_dwordx4 v[128:131], v7, s[8:11], s3 offen offset:0 sc1
M v[84:87],a[152:155],a[192:195],v[84:87]
s_waitcnt lgkmcnt(2)
s_nop 0
T v[36:37],v22,4096
T v[38:39],v22,6144
M v[84:87],a[156:159],a[200:203],v[84:87]
T v[40:41],v22,8192
T v[42:43],v22,10240
M v[84:87],a[160:163],a[208:211],v[84:87]
buffer_load_dwordx4 v8, s[52:55], s25 offen lds
M v[84:87],a[164:167],a[216:219],v[84:87]
s_nop 0
T v[44:45],v22,12288
T v[46:47],v22,14336
M v[84:87],a[168:171],a[224:227],v[84:87]
s_mov_b32 s25, 3408256
T v[48:49],v22,16384
T v[50:51],v22,18432
M v[92:95],a[168:171],a[228:231],0
SA m0,s4,61440
buffer_store_dwordx4 v[136:139], v7, s[8:11], s3 offen offset:1024 sc1
M v[92:95],a[164:167],a[220:223],v[92:95]
s_nop 0
T v[52:53],v22,20480
T v[54:55],v22,22528
M v[92:95],a[160:163],a[212:215],v[92:95]
T v[56:57],v22,24576
T v[58:59],v22,26624
M v[92:95],a[156:159],a[204:207],v[92:95]
buffer_load_dwordx4 v8, s[52:55], s25 offen lds
M v[92:95],a[152:155],a[196:199],v[92:95]
MF v142,s5,v142
MF v143,s5,v143
M v[92:95],a[148:151],a[188:191],v[92:95]
buffer_store_dwordx4 v[144:147], v7, s[8:11], s3 offen offset:2048 sc1
M v[92:95],a[144:147],a[180:183],v[92:95]
s_waitcnt lgkmcnt(6)
MF v156,s5,v156
MF v157,s5,v157
M v[100:103],v[32:35],a[176:179],0
T a[144:145],v23,0
T a[146:147],v23,2048
M v[100:103],v[36:39],a[184:187],v[100:103]
buffer_store_dwordx4 v[152:155], v7, s[8:11], s3 offen offset:3072 sc1
M v[100:103],v[40:43],a[192:195],v[100:103]
s_waitcnt lgkmcnt(2)
s_nop 0
T a[148:149],v23,4096
T a[150:151],v23,6144
M v[100:103],v[44:47],a[200:203],v[100:103]
T a[152:153],v23,8192
T a[154:155],v23,10240
M v[100:103],v[48:51],a[208:211],v[100:103]
MF v158,s5,v158
MF v159,s5,v159
M v[100:103],v[52:55],a[216:219],v[100:103]
T a[156:157],v23,12288
T a[158:159],v23,14336
M v[100:103],v[56:59],a[224:227],v[100:103]
T a[160:161],v23,16384
T a[162:163],v23,18432
M v[108:111],v[56:59],a[228:231],0
C v140,v140,v141
C v141,v142,v143
M v[108:111],v[52:55],a[220:223],v[108:111]
T a[164:165],v23,20480
T a[166:167],v23,22528
M v[108:111],v[48:51],a[212:215],v[108:111]
T a[168:169],v23,24576
T a[170:171],v23,26624
M v[108:111],v[44:47],a[204:207],v[108:111]
C v142,v156,v157
C v143,v158,v159
M v[108:111],v[40:43],a[196:199],v[108:111]
W a40,v140
W a41,v141
M v[108:111],v[36:39],a[188:191],v[108:111]
W a42,v142
W a43,v143
M v[108:111],v[32:35],a[180:183],v[108:111]
s_waitcnt lgkmcnt(6)
v_mov_b32 v8, 0xff800000
MF v164,s5,v164
M v[116:119],a[144:147],a[176:179],0
T v[32:33],v20,28672
T v[34:35],v20,30720
M v[116:119],a[148:151],a[184:187],v[116:119]
MF v165,s5,v165
MF v166,s5,v166
M v[116:119],a[152:155],a[192:195],v[116:119]
s_waitcnt lgkmcnt(2)
T v[36:37],v12,24576
T v[38:39],v12,26624
M v[116:119],a[156:159],a[200:203],v[116:119]
T v[40:41],v12,28672
T v[42:43],v12,30720
M v[116:119],a[160:163],a[208:211],v[116:119]
MF v167,s5,v167
MF v180,s5,v180
M v[116:119],a[164:167],a[216:219],v[116:119]
T v[44:45],v12,0
T v[46:47],v12,2048
M v[116:119],a[168:171],a[224:227],v[116:119]
T v[48:49],v12,4096
T v[50:51],v12,6144
M v[124:127],a[168:171],a[228:231],0
MF v181,s5,v181
MF v182,s5,v182
M v[124:127],a[164:167],a[220:223],v[124:127]
T v[52:53],v12,8192
T v[54:55],v12,10240
M v[124:127],a[160:163],a[212:215],v[124:127]
T v[56:57],v12,12288
T v[58:59],v12,14336
M v[124:127],a[156:159],a[204:207],v[124:127]
MF v183,s5,v183
C v164,v164,v165
M v[124:127],a[152:155],a[196:199],v[124:127]
C v165,v166,v167
C v166,v180,v181
M v[124:127],a[148:151],a[188:191],v[124:127]
C v167,v182,v183
W a12,v164
M v[124:127],a[144:147],a[180:183],v[124:127]
s_waitcnt lgkmcnt(6)
W a13,v165
W a14,v166
M v[68:71],v[32:35],a[232:235],v[68:71]
T a[144:145],v21,28672
T a[146:147],v21,30720
M v[68:71],v[36:39],a[96:99],v[68:71]
W a15,v167
MF v172,s5,v172
M v[68:71],v[40:43],a[104:107],v[68:71]
s_waitcnt lgkmcnt(2)
T a[148:149],v13,24576
T a[150:151],v13,26624
M v[68:71],v[44:47],a[112:115],v[68:71]
T a[152:153],v13,28672
T a[154:155],v13,30720
M v[68:71],v[48:51],a[120:123],v[68:71]
MF v173,s5,v173
MF v174,s5,v174
M v[68:71],v[52:55],a[128:131],v[68:71]
T a[156:157],v13,0
T a[158:159],v13,2048
M v[68:71],v[56:59],a[136:139],v[68:71]
T a[160:161],v13,4096
T a[162:163],v13,6144
M v[76:79],v[56:59],a[140:143],v[76:79]
MF v175,s5,v175
MF v188,s5,v188
M v[76:79],v[52:55],a[132:135],v[76:79]
T a[164:165],v13,8192
T a[166:167],v13,10240
M v[76:79],v[48:51],a[124:127],v[76:79]
T a[168:169],v13,12288
T a[170:171],v13,14336
M v[76:79],v[44:47],a[116:119],v[76:79]
MF v189,s5,v189
MF v190,s5,v190
M v[76:79],v[40:43],a[108:111],v[76:79]
MF v191,s5,v191
C v172,v172,v173
M v[76:79],v[36:39],a[100:103],v[76:79]
C v173,v174,v175
C v174,v188,v189
M v[76:79],v[32:35],a[236:239],v[76:79]
s_waitcnt lgkmcnt(6)
C v175,v190,v191
W a44,v172
M v[84:87],a[144:147],a[232:235],v[84:87]
T v[32:33],v22,28672
T v[34:35],v22,30720
M v[84:87],a[148:151],a[96:99],v[84:87]
W a45,v173
W a46,v174
M v[84:87],a[152:155],a[104:107],v[84:87]
s_waitcnt lgkmcnt(2)
T v[36:37],v14,24576
T v[38:39],v14,26624
M v[84:87],a[156:159],a[112:115],v[84:87]
T v[40:41],v14,28672
T v[42:43],v14,30720
M v[84:87],a[160:163],a[120:123],v[84:87]
W a47,v175
s_waitcnt vmcnt(7)
v_cmp_ne_u32 vcc, 1, v5
M v[84:87],a[164:167],a[128:131],v[84:87]
s_nop 0
T v[44:45],v14,0
T v[46:47],v14,2048
M v[84:87],a[168:171],a[136:139],v[84:87]
s_cmp_lg_u32 vcc_lo, 0
T v[48:49],v14,4096
T v[50:51],v14,6144
M v[92:95],a[168:171],a[140:143],v[92:95]
s_cbranch_scc1 L_wsq0
L_wrq0:
M v[92:95],a[164:167],a[132:135],v[92:95]
SA m0,s28,98304
T v[52:53],v14,8192
T v[54:55],v14,10240
M v[92:95],a[160:163],a[124:127],v[92:95]
T v[56:57],v14,12288
T v[58:59],v14,14336
M v[92:95],a[156:159],a[116:119],v[92:95]
buffer_load_dwordx4 v3, s[8:11], s21 offen offset:0 sc1 lds
M v[92:95],a[152:155],a[108:111],v[92:95]
MF v68,s5,v68
MF v69,s5,v69
M v[92:95],a[148:151],a[100:103],v[92:95]
buffer_load_dwordx4 v3, s[8:11], s21 offen offset:1024 sc1 lds
M v[92:95],a[144:147],a[236:239],v[92:95]
s_waitcnt lgkmcnt(6)
MF v70,s5,v70
MF v71,s5,v71
M v[100:103],v[32:35],a[232:235],v[100:103]
T a[144:145],v23,28672
T a[146:147],v23,30720
M v[100:103],v[36:39],a[96:99],v[100:103]
buffer_load_dwordx4 v3, s[8:11], s21 offen offset:2048 sc1 lds
M v[100:103],v[40:43],a[104:107],v[100:103]
s_waitcnt lgkmcnt(2)
s_nop 0
T a[148:149],v15,24576
T a[150:151],v15,26624
M v[100:103],v[44:47],a[112:115],v[100:103]
T a[152:153],v15,28672
T a[154:155],v15,30720
M v[100:103],v[48:51],a[120:123],v[100:103]
buffer_load_dwordx4 v3, s[8:11], s21 offen offset:3072 sc1 lds
M v[100:103],v[52:55],a[128:131],v[100:103]
SA m0,s28,102400
T a[156:157],v15,0
T a[158:159],v15,2048
M v[100:103],v[56:59],a[136:139],v[100:103]
T a[160:161],v15,4096
T a[162:163],v15,6144
M v[108:111],v[56:59],a[140:143],v[108:111]
buffer_load_dwordx4 v4, s[8:11], s21 offen offset:0 sc1 lds
M v[108:111],v[52:55],a[132:135],v[108:111]
s_nop 0
T a[164:165],v15,8192
T a[166:167],v15,10240
M v[108:111],v[48:51],a[124:127],v[108:111]
T a[168:169],v15,12288
T a[170:171],v15,14336
M v[108:111],v[44:47],a[116:119],v[108:111]
buffer_load_dwordx4 v4, s[8:11], s21 offen offset:1024 sc1 lds
M v[108:111],v[40:43],a[108:111],v[108:111]
MF v84,s5,v84
MF v85,s5,v85
M v[108:111],v[36:39],a[100:103],v[108:111]
s_waitcnt vmcnt(8) lgkmcnt(0)
buffer_load_dwordx4 v4, s[8:11], s21 offen offset:2048 sc1 lds
M v[108:111],v[32:35],a[236:239],v[108:111]
s_barrier
M v[116:119],a[144:147],a[232:235],v[116:119]
s_nop 0
T v[32:33],v16,0
T v[34:35],v16,2048
M v[116:119],a[148:151],a[96:99],v[116:119]
buffer_load_dwordx4 v4, s[8:11], s21 offen offset:3072 sc1 lds
M v[116:119],a[152:155],a[104:107],v[116:119]
SA s21,s21,32768
T v[36:37],v16,4096
T v[38:39],v16,6144
M v[116:119],a[156:159],a[112:115],v[116:119]
s_sub_u32 s22, s22, 1
T v[40:41],v16,8192
T v[42:43],v16,10240
M v[116:119],a[160:163],a[120:123],v[116:119]
s_cselect_b32 s21, s23, s21
MF v86,s5,v86
MF v87,s5,v87
M v[116:119],a[164:167],a[128:131],v[116:119]
SA m0,s28,65536
T v[44:45],v16,12288
T v[46:47],v16,14336
M v[116:119],a[168:171],a[136:139],v[116:119]
T v[48:49],v16,16384
T v[50:51],v16,18432
M v[124:127],a[168:171],a[140:143],v[124:127]
buffer_load_dwordx4 v3, s[8:11], s21 offen offset:0 sc1 lds
M v[124:127],a[164:167],a[132:135],v[124:127]
s_nop 0
T v[52:53],v16,20480
T v[54:55],v16,22528
M v[124:127],a[160:163],a[124:127],v[124:127]
T v[56:57],v16,24576
T v[58:59],v16,26624
M v[124:127],a[156:159],a[116:119],v[124:127]
buffer_load_dwordx4 v3, s[8:11], s21 offen offset:1024 sc1 lds
M v[124:127],a[152:155],a[108:111],v[124:127]
buffer_load_dword v5, v31, s[8:11], s46 offen offset:4 sc1
M v[124:127],a[148:151],a[100:103],v[124:127]
buffer_load_dwordx4 v3, s[8:11], s21 offen offset:2048 sc1 lds
M v[124:127],a[144:147],a[236:239],v[124:127]
s_waitcnt lgkmcnt(6)
C v68,v68,v69
C v69,v70,v71
M v[132:135],v[32:35],a[176:179],0
T a[144:145],v17,0
T a[146:147],v17,2048
M v[132:135],v[36:39],a[184:187],v[132:135]
buffer_load_dwordx4 v3, s[8:11], s21 offen offset:3072 sc1 lds
M v[132:135],v[40:43],a[192:195],v[132:135]
s_waitcnt lgkmcnt(2)
s_nop 0
T a[148:149],v17,4096
T a[150:151],v17,6144
M v[132:135],v[44:47],a[200:203],v[132:135]
SA m0,s28,69632
T a[152:153],v17,8192
T a[154:155],v17,10240
M v[132:135],v[48:51],a[208:211],v[132:135]
buffer_load_dwordx4 v4, s[8:11], s21 offen offset:0 sc1 lds
M v[132:135],v[52:55],a[216:219],v[132:135]
s_nop 0
T a[156:157],v17,12288
T a[158:159],v17,14336
M v[132:135],v[56:59],a[224:227],v[132:135]
T a[160:161],v17,16384
T a[162:163],v17,18432
M v[140:143],v[56:59],a[228:231],0
buffer_load_dwordx4 v4, s[8:11], s21 offen offset:1024 sc1 lds
M v[140:143],v[52:55],a[220:223],v[140:143]
s_nop 0
T a[164:165],v17,20480
T a[166:167],v17,22528
M v[140:143],v[48:51],a[212:215],v[140:143]
T a[168:169],v17,24576
T a[170:171],v17,26624
M v[140:143],v[44:47],a[204:207],v[140:143]
SA s3,s93,270336
buffer_load_dwordx4 v4, s[8:11], s21 offen offset:2048 sc1 lds
M v[140:143],v[40:43],a[196:199],v[140:143]
C v70,v84,v85
C v71,v86,v87
M v[140:143],v[36:39],a[188:191],v[140:143]
buffer_load_dwordx4 v4, s[8:11], s21 offen offset:3072 sc1 lds
M v[140:143],v[32:35],a[180:183],v[140:143]
s_waitcnt lgkmcnt(6)
W a16,v68
W a17,v69
M v[148:151],a[144:147],a[176:179],0
SA s21,s21,32768
T v[32:33],v18,0
T v[34:35],v18,2048
M v[148:151],a[148:151],a[184:187],v[148:151]
s_sub_u32 s22, s22, 1
buffer_store_dwordx4 v[160:163], v7, s[8:11], s3 offen offset:0 sc1
M v[148:151],a[152:155],a[192:195],v[148:151]
s_waitcnt lgkmcnt(2)
s_nop 0
T v[36:37],v18,4096
T v[38:39],v18,6144
M v[148:151],a[156:159],a[200:203],v[148:151]
s_cselect_b32 s21, s23, s21
T v[40:41],v18,8192
T v[42:43],v18,10240
M v[148:151],a[160:163],a[208:211],v[148:151]
buffer_store_dwordx4 v[168:171], v7, s[8:11], s3 offen offset:1024 sc1
M v[148:151],a[164:167],a[216:219],v[148:151]
s_nop 0
T v[44:45],v18,12288
T v[46:47],v18,14336
M v[148:151],a[168:171],a[224:227],v[148:151]
T v[48:49],v18,16384
T v[50:51],v18,18432
M v[156:159],a[168:171],a[228:231],0
buffer_store_dwordx4 v[176:179], v7, s[8:11], s3 offen offset:2048 sc1
M v[156:159],a[164:167],a[220:223],v[156:159]
s_nop 0
T v[52:53],v18,20480
T v[54:55],v18,22528
M v[156:159],a[160:163],a[212:215],v[156:159]
T v[56:57],v18,24576
T v[58:59],v18,26624
M v[156:159],a[156:159],a[204:207],v[156:159]
buffer_store_dwordx4 v[184:187], v7, s[8:11], s3 offen offset:3072 sc1
M v[156:159],a[152:155],a[196:199],v[156:159]
W a18,v70
W a19,v71
M v[156:159],a[148:151],a[188:191],v[156:159]
MF v76,s5,v76
MF v77,s5,v77
M v[156:159],a[144:147],a[180:183],v[156:159]
s_waitcnt lgkmcnt(6)
MF v78,s5,v78
MF v79,s5,v79
M v[164:167],v[32:35],a[176:179],0
T a[144:145],v19,0
T a[146:147],v19,2048
M v[164:167],v[36:39],a[184:187],v[164:167]
MF v92,s5,v92
MF v93,s5,v93
M v[164:167],v[40:43],a[192:195],v[164:167]
s_waitcnt lgkmcnt(2)
T a[148:149],v19,4096
T a[150:151],v19,6144
M v[164:167],v[44:47],a[200:203],v[164:167]
T a[152:153],v19,8192
T a[154:155],v19,10240
M v[164:167],v[48:51],a[208:211],v[164:167]
MF v94,s5,v94
MF v95,s5,v95
M v[164:167],v[52:55],a[216:219],v[164:167]
T a[156:157],v19,12288
T a[158:159],v19,14336
M v[164:167],v[56:59],a[224:227],v[164:167]
T a[160:161],v19,16384
T a[162:163],v19,18432
M v[172:175],v[56:59],a[228:231],0
C v76,v76,v77
C v77,v78,v79
M v[172:175],v[52:55],a[220:223],v[172:175]
T a[164:165],v19,20480
T a[166:167],v19,22528
M v[172:175],v[48:51],a[212:215],v[172:175]
T a[168:169],v19,24576
T a[170:171],v19,26624
M v[172:175],v[44:47],a[204:207],v[172:175]
C v78,v92,v93
C v79,v94,v95
M v[172:175],v[40:43],a[196:199],v[172:175]
W a48,v76
W a49,v77
M v[172:175],v[36:39],a[188:191],v[172:175]
W a50,v78
W a51,v79
M v[172:175],v[32:35],a[180:183],v[172:175]
s_waitcnt lgkmcnt(6)
v_mov_b32 v30, 2
MF v100,s5,v100
M v[180:183],a[144:147],a[176:179],0
T v[32:33],v16,28672
T v[34:35],v16,30720
M v[180:183],a[148:151],a[184:187],v[180:183]
buffer_store_dword v30, v1, s[8:11], s45 offen sc1
M v[180:183],a[152:155],a[192:195],v[180:183]
s_waitcnt lgkmcnt(2)
s_nop 0
T v[36:37],v16,40960
T v[38:39],v16,43008
M v[180:183],a[156:159],a[200:203],v[180:183]
T v[40:41],v16,45056
T v[42:43],v16,47104
M v[180:183],a[160:163],a[208:211],v[180:183]
MF v101,s5,v101
MF v102,s5,v102
M v[180:183],a[164:167],a[216:219],v[180:183]
T v[44:45],v16,49152
T v[46:47],v16,51200
M v[180:183],a[168:171],a[224:227],v[180:183]
T v[48:49],v16,53248
T v[50:51],v16,55296
M v[188:191],a[168:171],a[228:231],0
MF v103,s5,v103
MF v116,s5,v116
M v[188:191],a[164:167],a[220:223],v[188:191]
T v[52:53],v16,57344
T v[54:55],v16,59392
M v[188:191],a[160:163],a[212:215],v[188:191]
T v[56:57],v16,61440
T v[58:59],v16,63488
M v[188:191],a[156:159],a[204:207],v[188:191]
MF v117,s5,v117
MF v118,s5,v118
M v[188:191],a[152:155],a[196:199],v[188:191]
MF v119,s5,v119
C v100,v100,v101
M v[188:191],a[148:151],a[188:191],v[188:191]
C v101,v102,v103
C v102,v116,v117
M v[188:191],a[144:147],a[180:183],v[188:191]
s_waitcnt lgkmcnt(6)
C v103,v118,v119
W a20,v100
M v[132:135],v[32:35],a[232:235],v[132:135]
T a[144:145],v17,28672
T a[146:147],v17,30720
M v[132:135],v[36:39],a[96:99],v[132:135]
W a21,v101
W a22,v102
M v[132:135],v[40:43],a[104:107],v[132:135]
s_waitcnt lgkmcnt(2)
T a[148:149],v17,40960
T a[150:151],v17,43008
M v[132:135],v[44:47],a[112:115],v[132:135]
T a[152:153],v17,45056
T a[154:155],v17,47104
M v[132:135],v[48:51],a[120:123],v[132:135]
W a23,v103
MF v108,s5,v108
M v[132:135],v[52:55],a[128:131],v[132:135]
T a[156:157],v17,49152
T a[158:159],v17,51200
M v[132:135],v[56:59],a[136:139],v[132:135]
T a[160:161],v17,53248
T a[162:163],v17,55296
M v[140:143],v[56:59],a[140:143],v[140:143]
MF v109,s5,v109
MF v110,s5,v110
M v[140:143],v[52:55],a[132:135],v[140:143]
T a[164:165],v17,57344
T a[166:167],v17,59392
M v[140:143],v[48:51],a[124:127],v[140:143]
T a[168:169],v17,61440
T a[170:171],v17,63488
M v[140:143],v[44:47],a[116:119],v[140:143]
MF v111,s5,v111
MF v124,s5,v124
M v[140:143],v[40:43],a[108:111],v[140:143]
MF v125,s5,v125
MF v126,s5,v126
M v[140:143],v[36:39],a[100:103],v[140:143]
MF v127,s5,v127
C v108,v108,v109
M v[140:143],v[32:35],a[236:239],v[140:143]
s_waitcnt lgkmcnt(6)
C v109,v110,v111
C v110,v124,v125
M v[148:151],a[144:147],a[232:235],v[148:151]
T v[32:33],v18,28672
T v[34:35],v18,30720
M v[148:151],a[148:151],a[96:99],v[148:151]
C v111,v126,v127
W a52,v108
M v[148:151],a[152:155],a[104:107],v[148:151]
s_waitcnt lgkmcnt(2)
T v[36:37],v18,40960
T v[38:39],v18,43008
M v[148:151],a[156:159],a[112:115],v[148:151]
T v[40:41],v18,45056
T v[42:43],v18,47104
M v[148:151],a[160:163],a[120:123],v[148:151]
W a53,v109
W a54,v110
M v[148:151],a[164:167],a[128:131],v[148:151]
T v[44:45],v18,49152
T v[46:47],v18,51200
M v[148:151],a[168:171],a[136:139],v[148:151]
T v[48:49],v18,53248
T v[50:51],v18,55296
M v[156:159],a[168:171],a[140:143],v[156:159]
W a55,v111
s_waitcnt vmcnt(11)
v_cmp_ne_u32 vcc, 1, v5
M v[156:159],a[164:167],a[132:135],v[156:159]
s_nop 0
T v[52:53],v18,57344
T v[54:55],v18,59392
M v[156:159],a[160:163],a[124:127],v[156:159]
s_cmp_lg_u32 vcc_hi, 0
T v[56:57],v18,61440
T v[58:59],v18,63488
M v[156:159],a[156:159],a[116:119],v[156:159]
s_cbranch_scc1 L_wsr0
L_wrr0:
MF v132,s5,v132
MF v133,s5,v133
M v[156:159],a[152:155],a[108:111],v[156:159]
SA m0,s28,131072
MF v134,s5,v134
MF v135,s5,v135
M v[156:159],a[148:151],a[100:103],v[156:159]
buffer_load_dwordx4 v3, s[8:11], s26 offen offset:0 sc1 lds
M v[156:159],a[144:147],a[236:239],v[156:159]
s_waitcnt lgkmcnt(6)
MF v148,s5,v148
MF v149,s5,v149
M v[164:167],v[32:35],a[232:235],v[164:167]
T a[144:145],v19,28672
T a[146:147],v19,30720
M v[164:167],v[36:39],a[96:99],v[164:167]
buffer_load_dwordx4 v3, s[8:11], s26 offen offset:1024 sc1 lds
M v[164:167],v[40:43],a[104:107],v[164:167]
s_waitcnt lgkmcnt(2)
s_nop 0
T a[148:149],v19,40960
T a[150:151],v19,43008
M v[164:167],v[44:47],a[112:115],v[164:167]
T a[152:153],v19,45056
T a[154:155],v19,47104
M v[164:167],v[48:51],a[120:123],v[164:167]
buffer_load_dwordx4 v3, s[8:11], s26 offen offset:2048 sc1 lds
M v[164:167],v[52:55],a[128:131],v[164:167]
s_nop 0
T a[156:157],v19,49152
T a[158:159],v19,51200
M v[164:167],v[56:59],a[136:139],v[164:167]
T a[160:161],v19,53248
T a[162:163],v19,55296
M v[172:175],v[56:59],a[140:143],v[172:175]
buffer_load_dwordx4 v3, s[8:11], s26 offen offset:3072 sc1 lds
M v[172:175],v[52:55],a[132:135],v[172:175]
SA m0,s28,135168
T a[164:165],v19,57344
T a[166:167],v19,59392
M v[172:175],v[48:51],a[124:127],v[172:175]
T a[168:169],v19,61440
T a[170:171],v19,63488
M v[172:175],v[44:47],a[116:119],v[172:175]
buffer_load_dwordx4 v4, s[8:11], s26 offen offset:0 sc1 lds
M v[172:175],v[40:43],a[108:111],v[172:175]
MF v150,s5,v150
MF v151,s5,v151
M v[172:175],v[36:39],a[100:103],v[172:175]
s_waitcnt lgkmcnt(0)
buffer_load_dwordx4 v4, s[8:11], s26 offen offset:1024 sc1 lds
M v[172:175],v[32:35],a[236:239],v[172:175]
s_barrier
M v[180:183],a[144:147],a[232:235],v[180:183]
R a[64:67],v2,32768
R a[68:71],v2,33792
M v[180:183],a[148:151],a[96:99],v[180:183]
buffer_load_dwordx4 v4, s[8:11], s26 offen offset:2048 sc1 lds
M v[180:183],a[152:155],a[104:107],v[180:183]
C v132,v132,v133
C v133,v134,v135
M v[180:183],a[156:159],a[112:115],v[180:183]
R a[72:75],v2,34816
R a[76:79],v2,35840
M v[180:183],a[160:163],a[120:123],v[180:183]
buffer_load_dwordx4 v4, s[8:11], s26 offen offset:3072 sc1 lds
M v[180:183],a[164:167],a[128:131],v[180:183]
SA s26,s26,32768
C v134,v148,v149
C v135,v150,v151
M v[180:183],a[168:171],a[136:139],v[180:183]
R a[80:83],v2,36864
R a[84:87],v2,37888
M v[188:191],a[168:171],a[140:143],v[188:191]
W a24,v132
W a25,v133
M v[188:191],a[164:167],a[132:135],v[188:191]
W a26,v134
W a27,v135
M v[188:191],a[160:163],a[124:127],v[188:191]
R a[88:91],v2,38912
R a[92:95],v2,39936
M v[188:191],a[156:159],a[116:119],v[188:191]
MF v140,s5,v140
MF v141,s5,v141
M v[188:191],a[152:155],a[108:111],v[188:191]
MF v142,s5,v142
MF v143,s5,v143
M v[188:191],a[148:151],a[100:103],v[188:191]
MF v156,s5,v156
MF v157,s5,v157
M v[188:191],a[144:147],a[236:239],v[188:191]
s_waitcnt lgkmcnt(0)
MF v158,s5,v158
MF v159,s5,v159
C v140,v140,v141
C v141,v142,v143
C v142,v156,v157
C v143,v158,v159
W a56,v140
W a57,v141
W a58,v142
W a59,v143
s_cmp_eq_u32 s42, 0
s_cbranch_scc1 L_j0
M v[64:67],a[64:67],a[0:3],0
R a[96:99],v2,40960
R a[100:103],v2,41984
M v[64:67],a[68:71],a[4:7],v[64:67]
MF v164,s5,v164
MF v165,s5,v165
M v[64:67],a[72:75],a[8:11],v[64:67]
MF v166,s5,v166
MF v167,s5,v167
M v[64:67],a[76:79],a[12:15],v[64:67]
R a[104:107],v2,43008
R a[108:111],v2,44032
M v[64:67],a[80:83],a[16:19],v[64:67]
MF v180,s5,v180
MF v181,s5,v181
MF v182,s5,v182
MF v183,s5,v183
C v164,v164,v165
C v165,v166,v167
C v166,v180,v181
C v167,v182,v183
W a28,v164
W a29,v165
W a30,v166
W a31,v167
M v[64:67],a[84:87],a[20:23],v[64:67]
MF v172,s5,v172
MF v173,s5,v173
M v[64:67],a[88:91],a[24:27],v[64:67]
R a[112:115],v2,45056
R a[116:119],v2,46080
M v[64:67],a[92:95],a[28:31],v[64:67]
MF v174,s5,v174
MF v175,s5,v175
M v[68:71],a[64:67],a[32:35],0
MF v188,s5,v188
MF v189,s5,v189
M v[68:71],a[68:71],a[36:39],v[68:71]
R a[120:123],v2,47104
R a[124:127],v2,48128
M v[68:71],a[72:75],a[40:43],v[68:71]
SA m0,s28,32768
MF v190,s5,v190
MF v191,s5,v191
M v[68:71],a[76:79],a[44:47],v[68:71]
SA s3,s93,786432
buffer_load_dwordx4 v3, s[8:11], s26 offen offset:0 sc1 lds
M v[68:71],a[80:83],a[48:51],v[68:71]
C v172,v172,v173
C v173,v174,v175
C v174,v188,v189
C v175,v190,v191
W a60,v172
W a61,v173
W a62,v174
W a63,v175
M v[68:71],a[84:87],a[52:55],v[68:71]
E v18,v64
M v[68:71],a[88:91],a[56:59],v[68:71]
buffer_store_dwordx4 v[192:195], v7, s[8:11], s3 offen offset:0 sc1
M v[68:71],a[92:95],a[60:63],v[68:71]
s_waitcnt lgkmcnt(0)
E v19,v65
M v[72:75],a[96:99],a[0:3],0
R a[64:67],v2,49152
R a[68:71],v2,50176
M v[72:75],a[100:103],a[4:7],v[72:75]
buffer_load_dwordx4 v3, s[8:11], s26 offen offset:1024 sc1 lds
M v[72:75],a[104:107],a[8:11],v[72:75]
E v20,v66
M v[72:75],a[108:111],a[12:15],v[72:75]
R a[72:75],v2,51200
R a[76:79],v2,52224
M v[72:75],a[112:115],a[16:19],v[72:75]
buffer_load_dwordx4 v3, s[8:11], s26 offen offset:2048 sc1 lds
M v[72:75],a[116:119],a[20:23],v[72:75]
E v21,v67
M v[72:75],a[120:123],a[24:27],v[72:75]
R a[80:83],v2,53248
R a[84:87],v2,54272
M v[72:75],a[124:127],a[28:31],v[72:75]
buffer_load_dwordx4 v3, s[8:11], s26 offen offset:3072 sc1 lds
M v[76:79],a[124:127],a[60:63],0
SA m0,s28,36864
E v22,v68
M v[76:79],a[120:123],a[56:59],v[76:79]
R a[88:91],v2,55296
R a[92:95],v2,56320
M v[76:79],a[116:119],a[52:55],v[76:79]
buffer_load_dwordx4 v4, s[8:11], s26 offen offset:0 sc1 lds
M v[76:79],a[112:115],a[48:51],v[76:79]
E v23,v69
M v[76:79],a[108:111],a[44:47],v[76:79]
AF v26,v18,v19
C v40,v18,v19
M v[76:79],a[104:107],a[40:43],v[76:79]
buffer_load_dwordx4 v4, s[8:11], s26 offen offset:1024 sc1 lds
M v[76:79],a[100:103],a[36:39],v[76:79]
v_add_u32 v16, 0x20000, v7
AF v26,v20,v26
M v[76:79],a[96:99],a[32:35],v[76:79]
s_waitcnt lgkmcnt(0)
E v24,v70
M v[80:83],a[64:67],a[0:3],0
R a[96:99],v2,57344
R a[100:103],v2,58368
M v[80:83],a[68:71],a[4:7],v[80:83]
buffer_load_dwordx4 v4, s[8:11], s26 offen offset:2048 sc1 lds
M v[80:83],a[72:75],a[8:11],v[80:83]
E v25,v71
M v[80:83],a[76:79],a[12:15],v[80:83]
R a[104:107],v2,59392
R a[108:111],v2,60416
M v[80:83],a[80:83],a[16:19],v[80:83]
buffer_store_dwordx4 v[200:203], v7, s[8:11], s3 offen offset:1024 sc1
M v[80:83],a[84:87],a[20:23],v[80:83]
E v18,v72
M v[80:83],a[88:91],a[24:27],v[80:83]
R a[112:115],v2,61440
R a[116:119],v2,62464
M v[80:83],a[92:95],a[28:31],v[80:83]
buffer_load_dwordx4 v4, s[8:11], s26 offen offset:3072 sc1 lds
M v[84:87],a[92:95],a[60:63],0
SA s26,s26,32768
E v19,v73
M v[84:87],a[88:91],a[56:59],v[84:87]
R a[120:123],v2,63488
R a[124:127],v2,64512
M v[84:87],a[84:87],a[52:55],v[84:87]
C v41,v20,v21
AF v26,v21,v26
M v[84:87],a[80:83],a[48:51],v[84:87]
buffer_store_dwordx4 v[208:211], v7, s[8:11], s3 offen offset:2048 sc1
M v[84:87],a[76:79],a[44:47],v[84:87]
E v20,v74
M v[84:87],a[72:75],a[40:43],v[84:87]
AF v27,v22,v23
C v44,v22,v23
M v[84:87],a[68:71],a[36:39],v[84:87]
s_waitcnt vmcnt(24) lgkmcnt(0)
E v21,v75
M v[84:87],a[64:67],a[32:35],v[84:87]
s_barrier
M v[88:91],a[96:99],a[0:3],0
R a[64:67],v2,0
R a[68:71],v2,1024
M v[88:91],a[100:103],a[4:7],v[88:91]
E v22,v76
M v[88:91],a[104:107],a[8:11],v[88:91]
AF v27,v24,v27
C v45,v24,v25
M v[88:91],a[108:111],a[12:15],v[88:91]
R a[72:75],v2,2048
R a[76:79],v2,3072
M v[88:91],a[112:115],a[16:19],v[88:91]
E v23,v77
M v[88:91],a[116:119],a[20:23],v[88:91]
AF v27,v25,v27
AF v26,v18,v26
M v[88:91],a[120:123],a[24:27],v[88:91]
R a[80:83],v2,4096
R a[84:87],v2,5120
M v[88:91],a[124:127],a[28:31],v[88:91]
E v24,v78
M v[92:95],a[124:127],a[60:63],0
C v42,v18,v19
AF v26,v19,v26
M v[92:95],a[120:123],a[56:59],v[92:95]
R a[88:91],v2,6144
R a[92:95],v2,7168
M v[92:95],a[116:119],a[52:55],v[92:95]
E v25,v79
M v[92:95],a[112:115],a[48:51],v[92:95]
AF v26,v20,v26
C v43,v20,v21
M v[92:95],a[108:111],a[44:47],v[92:95]
AF v26,v21,v26
AF v27,v22,v27
M v[92:95],a[104:107],a[40:43],v[92:95]
C v46,v22,v23
AF v27,v23,v27
M v[92:95],a[100:103],a[36:39],v[92:95]
s_waitcnt lgkmcnt(0)
AF v27,v24,v27
C v47,v24,v25
M v[92:95],a[96:99],a[32:35],v[92:95]
AF v27,v25,v27
M v[96:99],a[64:67],a[0:3],0
R a[96:99],v2,8192
R a[100:103],v2,9216
M v[96:99],a[68:71],a[4:7],v[96:99]
SA m0,s28,98304
E v18,v80
M v[96:99],a[72:75],a[8:11],v[96:99]
buffer_load_dwordx4 v3, s[8:11], s21 offen offset:0 sc1 lds
M v[96:99],a[76:79],a[12:15],v[96:99]
R a[104:107],v2,10240
R a[108:111],v2,11264
M v[96:99],a[80:83],a[16:19],v[96:99]
v_mov_b32 v30, 0
M v[96:99],a[84:87],a[20:23],v[96:99]
E v19,v81
M v[96:99],a[88:91],a[24:27],v[96:99]
R a[112:115],v2,12288
R a[116:119],v2,13312
M v[96:99],a[92:95],a[28:31],v[96:99]
buffer_load_dwordx4 v3, s[8:11], s21 offen offset:1024 sc1 lds
M v[100:103],a[92:95],a[60:63],0
v_mov_b32 v31, 0
AF v26,v18,v26
M v[100:103],a[88:91],a[56:59],v[100:103]
R a[120:123],v2,14336
R a[124:127],v2,15360
M v[100:103],a[84:87],a[52:55],v[100:103]
SA s3,s93,786432
E v20,v82
M v[100:103],a[80:83],a[48:51],v[100:103]
buffer_load_dwordx4 v3, s[8:11], s21 offen offset:2048 sc1 lds
M v[100:103],a[76:79],a[44:47],v[100:103]
E v21,v83
M v[100:103],a[72:75],a[40:43],v[100:103]
v_mov_b32 v32, 0
C v56,v18,v19
M v[100:103],a[68:71],a[36:39],v[100:103]
buffer_store_dwordx4 v[216:219], v7, s[8:11], s3 offen offset:3072 sc1
M v[100:103],a[64:67],a[32:35],v[100:103]
s_waitcnt lgkmcnt(0)
E v22,v88
M v[108:111],a[96:99],a[32:35],0
R a[64:67],v2,16384
R a[68:71],v2,17408
M v[108:111],a[100:103],a[36:39],v[108:111]
buffer_load_dwordx4 v3, s[8:11], s21 offen offset:3072 sc1 lds
M v[108:111],a[104:107],a[40:43],v[108:111]
SA m0,s28,102400
v_mov_b32 v33, 0
AF v26,v19,v26
M v[108:111],a[108:111],a[44:47],v[108:111]
R a[72:75],v2,18432
R a[76:79],v2,19456
M v[108:111],a[112:115],a[48:51],v[108:111]
buffer_load_dwordx4 v4, s[8:11], s21 offen offset:0 sc1 lds
M v[108:111],a[116:119],a[52:55],v[108:111]
E v23,v89
M v[108:111],a[120:123],a[56:59],v[108:111]
R a[80:83],v2,20480
R a[84:87],v2,21504
M v[108:111],a[124:127],a[60:63],v[108:111]
buffer_load_dwordx4 v4, s[8:11], s21 offen offset:1024 sc1 lds
M v[104:107],a[124:127],a[28:31],0
v_mov_b32 v34, 0
AF v26,v20,v26
M v[104:107],a[120:123],a[24:27],v[104:107]
SA s3,s93,794624
R a[88:91],v2,22528
R a[92:95],v2,23552
M v[104:107],a[116:119],a[20:23],v[104:107]
buffer_load_dwordx4 v4, s[8:11], s21 offen offset:2048 sc1 lds
M v[104:107],a[112:115],a[16:19],v[104:107]
v_mov_b32 v35, 0
C v57,v20,v21
M v[104:107],a[108:111],a[12:15],v[104:107]
E v24,v90
M v[104:107],a[104:107],a[8:11],v[104:107]
E v25,v91
M v[104:107],a[100:103],a[4:7],v[104:107]
buffer_load_dwordx4 v4, s[8:11], s21 offen offset:3072 sc1 lds
M v[104:107],a[96:99],a[0:3],v[104:107]
s_waitcnt lgkmcnt(0)
v_mov_b32 v36, 0
AF v26,v21,v26
M v[112:115],a[64:67],a[0:3],0
SA s21,s21,32768
R a[96:99],v2,24576
R a[100:103],v2,25600
M v[112:115],a[68:71],a[4:7],v[112:115]
s_sub_u32 s22, s22, 1
buffer_store_dwordx4 v[224:227], v7, s[8:11], s3 offen offset:0 sc1
M v[112:115],a[72:75],a[8:11],v[112:115]
s_cselect_b32 s21, s23, s21
E v18,v84
M v[112:115],a[76:79],a[12:15],v[112:115]
R a[104:107],v2,26624
R a[108:111],v2,27648
M v[112:115],a[80:83],a[16:19],v[112:115]
v_mov_b32 v37, 0
AF v26,v22,v26
M v[112:115],a[84:87],a[20:23],v[112:115]
E v19,v85
M v[112:115],a[88:91],a[24:27],v[112:115]
R a[112:115],v2,28672
R a[116:119],v2,29696
M v[112:115],a[92:95],a[28:31],v[112:115]
E v20,v86
M v[116:119],a[92:95],a[60:63],0
v_mov_b32 v38, 0
C v58,v22,v23
M v[116:119],a[88:91],a[56:59],v[116:119]
R a[120:123],v2,30720
R a[124:127],v2,31744
M v[116:119],a[84:87],a[52:55],v[116:119]
E v21,v87
M v[116:119],a[80:83],a[48:51],v[116:119]
buffer_store_dwordx4 v[232:235], v7, s[8:11], s3 offen offset:1024 sc1
M v[116:119],a[76:79],a[44:47],v[116:119]
AF v26,v23,v26
AF v26,v24,v26
M v[116:119],a[72:75],a[40:43],v[116:119]
v_mov_b32 v39, 0
C v59,v24,v25
M v[116:119],a[68:71],a[36:39],v[116:119]
s_waitcnt vmcnt(22) lgkmcnt(0)
E v22,v92
M v[116:119],a[64:67],a[32:35],v[116:119]
s_barrier
M v[124:127],a[96:99],a[32:35],0
R a[64:67],v16,0
R a[68:71],v16,1024
M v[124:127],a[100:103],a[36:39],v[124:127]
E v23,v93
M v[124:127],a[104:107],a[40:43],v[124:127]
AF v26,v25,v26
AF v27,v18,v27
M v[124:127],a[108:111],a[44:47],v[124:127]
R a[72:75],v16,2048
R a[76:79],v16,3072
M v[124:127],a[112:115],a[48:51],v[124:127]
E v24,v94
M v[124:127],a[116:119],a[52:55],v[124:127]
E v25,v95
M v[124:127],a[120:123],a[56:59],v[124:127]
R a[80:83],v16,4096
R a[84:87],v16,5120
M v[124:127],a[124:127],a[60:63],v[124:127]
C v60,v18,v19
AF v27,v19,v27
M v[120:123],a[124:127],a[28:31],0
AF v27,v20,v27
C v61,v20,v21
M v[120:123],a[120:123],a[24:27],v[120:123]
R a[88:91],v16,6144
R a[92:95],v16,7168
M v[120:123],a[116:119],a[20:23],v[120:123]
AF v27,v21,v27
AF v27,v22,v27
M v[120:123],a[112:115],a[16:19],v[120:123]
C v62,v22,v23
AF v27,v23,v27
M v[120:123],a[108:111],a[12:15],v[120:123]
AF v27,v24,v27
C v63,v24,v25
M v[120:123],a[104:107],a[8:11],v[120:123]
AF v27,v25,v27
M v[120:123],a[100:103],a[4:7],v[120:123]
s_waitcnt lgkmcnt(0)
M v[120:123],a[96:99],a[0:3],v[120:123]
v_max_f32 v10, v26, v27
v_min_f32 v11, v26, v27
v_cmp_lt_f32 vcc, s31, v10
v_cmp_gt_f32 s[64:65], s24, v11
s_nop 0
s_or_b64 vcc, vcc, s[64:65]
s_cbranch_vccnz L_stk1
L_rtk1:
M v[128:131],a[64:67],v[40:43],0
R a[96:99],v16,8192
R a[100:103],v16,9216
M v[128:131],a[68:71],v[56:59],v[128:131]
SA m0,s28,65536
E v18,v96
M v[132:135],a[68:71],v[60:63],0
buffer_load_dwordx4 v3, s[8:11], s21 offen offset:0 sc1 lds
M v[132:135],a[64:67],v[44:47],v[132:135]
R a[104:107],v16,10240
R a[108:111],v16,11264
M v[140:143],a[72:75],v[44:47],0
SA s3,s93,794624
E v19,v97
M v[140:143],a[76:79],v[60:63],v[140:143]
AF v30,v26,v30
AF v31,v27,v31
M v[136:139],a[76:79],v[56:59],0
R a[112:115],v16,12288
R a[116:119],v16,13312
M v[136:139],a[72:75],v[40:43],v[136:139]
buffer_load_dwordx4 v3, s[8:11], s21 offen offset:1024 sc1 lds
M v[144:147],a[80:83],v[40:43],0
E v20,v98
M v[144:147],a[84:87],v[56:59],v[144:147]
R a[120:123],v16,14336
R a[124:127],v16,15360
M v[148:151],a[84:87],v[60:63],0
buffer_store_dwordx4 v[240:243], v7, s[8:11], s3 offen offset:2048 sc1
M v[148:151],a[80:83],v[44:47],v[148:151]
E v21,v99
M v[156:159],a[88:91],v[44:47],0
AF v28,v18,v19
C v48,v18,v19
M v[156:159],a[92:95],v[60:63],v[156:159]
buffer_load_dwordx4 v3, s[8:11], s21 offen offset:2048 sc1 lds
M v[152:155],a[92:95],v[56:59],0
AF v28,v20,v28
C v49,v20,v21
M v[152:155],a[88:91],v[40:43],v[152:155]
s_waitcnt lgkmcnt(0)
E v22,v104
M v[160:163],a[96:99],v[40:43],0
R a[64:67],v16,16384
R a[68:71],v16,17408
M v[160:163],a[100:103],v[56:59],v[160:163]
buffer_load_dwordx4 v3, s[8:11], s21 offen offset:3072 sc1 lds
M v[164:167],a[100:103],v[60:63],0
SA m0,s28,69632
E v23,v105
M v[164:167],a[96:99],v[44:47],v[164:167]
R a[72:75],v16,18432
R a[76:79],v16,19456
M v[172:175],a[104:107],v[44:47],0
buffer_load_dwordx4 v4, s[8:11], s21 offen offset:0 sc1 lds
M v[172:175],a[108:111],v[60:63],v[172:175]
AF v28,v21,v28
AF v28,v22,v28
M v[168:171],a[108:111],v[56:59],0
R a[80:83],v16,20480
R a[84:87],v16,21504
M v[168:171],a[104:107],v[40:43],v[168:171]
buffer_store_dwordx4 v[248:251], v7, s[8:11], s3 offen offset:3072 sc1
M v[176:179],a[112:115],v[40:43],0
E v24,v106
M v[176:179],a[116:119],v[56:59],v[176:179]
R a[88:91],v16,22528
R a[92:95],v16,23552
M v[180:183],a[116:119],v[60:63],0
buffer_load_dwordx4 v4, s[8:11], s21 offen offset:1024 sc1 lds
M v[180:183],a[112:115],v[44:47],v[180:183]
E v25,v107
M v[188:191],a[120:123],v[44:47],0
C v50,v22,v23
AF v28,v23,v28
M v[188:191],a[124:127],v[60:63],v[188:191]
buffer_load_dwordx4 v4, s[8:11], s21 offen offset:2048 sc1 lds
M v[184:187],a[124:127],v[56:59],0
E v18,v100
M v[184:187],a[120:123],v[40:43],v[184:187]
s_waitcnt lgkmcnt(0)
AF v28,v24,v28
C v51,v24,v25
M v[192:195],a[64:67],v[40:43],0
R a[96:99],v16,24576
R a[100:103],v16,25600
M v[192:195],a[68:71],v[56:59],v[192:195]
buffer_load_dwordx4 v4, s[8:11], s21 offen offset:3072 sc1 lds
M v[196:199],a[68:71],v[60:63],0
SA s21,s21,32768
E v19,v101
M v[196:199],a[64:67],v[44:47],v[196:199]
s_sub_u32 s22, s22, 1
R a[104:107],v16,26624
R a[108:111],v16,27648
M v[204:207],a[72:75],v[44:47],0
s_cselect_b32 s21, s23, s21
AF v28,v25,v28
AF v29,v18,v19
M v[204:207],a[76:79],v[60:63],v[204:207]
E v20,v102
M v[200:203],a[76:79],v[56:59],0
R a[112:115],v16,28672
R a[116:119],v16,29696
M v[200:203],a[72:75],v[40:43],v[200:203]
C v52,v18,v19
M v[208:211],a[80:83],v[40:43],0
M v[208:211],a[84:87],v[56:59],v[208:211]
R a[120:123],v16,30720
R a[124:127],v16,31744
M v[212:215],a[84:87],v[60:63],0
E v21,v103
M v[212:215],a[80:83],v[44:47],v[212:215]
AF v29,v20,v29
C v53,v20,v21
M v[220:223],a[88:91],v[44:47],0
AF v29,v21,v29
M v[220:223],a[92:95],v[60:63],v[220:223]
E v22,v108
M v[216:219],a[92:95],v[56:59],0
s_waitcnt vmcnt(12) lgkmcnt(0)
M v[216:219],a[88:91],v[40:43],v[216:219]
s_barrier
M v[224:227],a[96:99],v[40:43],0
R a[64:67],v2,32768
R a[68:71],v2,33792
M v[224:227],a[100:103],v[56:59],v[224:227]
E v23,v109
M v[228:231],a[100:103],v[60:63],0
AF v29,v22,v29
C v54,v22,v23
M v[228:231],a[96:99],v[44:47],v[228:231]
R a[72:75],v2,34816
R a[76:79],v2,35840
M v[236:239],a[104:107],v[44:47],0
E v24,v110
M v[236:239],a[108:111],v[60:63],v[236:239]
AF v29,v23,v29
M v[232:235],a[108:111],v[56:59],0
R a[80:83],v2,36864
R a[84:87],v2,37888
M v[232:235],a[104:107],v[40:43],v[232:235]
M v[240:243],a[112:115],v[40:43],0
E v25,v111
M v[240:243],a[116:119],v[56:59],v[240:243]
R a[88:91],v2,38912
R a[92:95],v2,39936
M v[244:247],a[116:119],v[60:63],0
AF v29,v24,v29
C v55,v24,v25
M v[244:247],a[112:115],v[44:47],v[244:247]
AF v29,v25,v29
M v[252:255],a[120:123],v[44:47],0
M v[252:255],a[124:127],v[60:63],v[252:255]
M v[248:251],a[124:127],v[56:59],0
s_waitcnt lgkmcnt(0)
M v[248:251],a[120:123],v[40:43],v[248:251]
s_cmp_lg_u32 s27, 0
s_cbranch_scc1 L_loop_top
s_branch L_d1s
L_j0:
M v[68:71],a[64:67],a[32:35],0
s_cmp_lt_u32 s20, 0
R a[96:99],v2,40960
R a[100:103],v2,41984
M v[68:71],a[68:71],a[36:39],v[68:71]
s_cselect_b64 s[82:83], -1, 0
v_mov_b32 v30, 0
MF v172,s5,v172
M v[68:71],a[72:75],a[40:43],v[68:71]
s_cmp_eq_u32 s20, 0
MF v173,s5,v173
MF v174,s5,v174
M v[68:71],a[76:79],a[44:47],v[68:71]
s_cselect_b64 s[66:67], s[16:17], s[82:83]
R a[104:107],v2,43008
R a[108:111],v2,44032
M v[68:71],a[80:83],a[48:51],v[68:71]
s_cselect_b64 s[68:69], s[18:19], s[82:83]
MF v175,s5,v175
MF v188,s5,v188
M v[68:71],a[84:87],a[52:55],v[68:71]
s_cselect_b64 s[70:71], s[48:49], s[82:83]
MF v189,s5,v189
MF v190,s5,v190
MF v191,s5,v191
C v172,v172,v173
C v173,v174,v175
C v174,v188,v189
C v175,v190,v191
W a60,v172
W a61,v173
W a62,v174
W a63,v175
M v[68:71],a[88:91],a[56:59],v[68:71]
s_cselect_b64 s[72:73], s[50:51], s[82:83]
R a[112:115],v2,45056
R a[116:119],v2,46080
v_cndmask_b32 v64, 0, v8, s[66:67]
v_cndmask_b32 v65, 0, v8, s[68:69]
v_cndmask_b32 v66, 0, v8, s[70:71]
v_cndmask_b32 v67, 0, v8, s[72:73]
M v[68:71],a[92:95],a[60:63],v[68:71]
s_cmp_lt_u32 s20, 1
MF v164,s5,v164
MF v165,s5,v165
M v[64:67],a[64:67],a[0:3],v[64:67]
s_cselect_b64 s[82:83], -1, 0
MF v166,s5,v166
MF v167,s5,v167
M v[64:67],a[68:71],a[4:7],v[64:67]
s_cmp_eq_u32 s20, 1
R a[120:123],v2,47104
R a[124:127],v2,48128
M v[64:67],a[72:75],a[8:11],v[64:67]
s_cselect_b64 s[74:75], s[16:17], s[82:83]
MF v180,s5,v180
MF v181,s5,v181
M v[64:67],a[76:79],a[12:15],v[64:67]
s_cselect_b64 s[76:77], s[18:19], s[82:83]
MF v182,s5,v182
MF v183,s5,v183
M v[64:67],a[80:83],a[16:19],v[64:67]
s_cselect_b64 s[78:79], s[48:49], s[82:83]
C v164,v164,v165
C v165,v166,v167
C v166,v180,v181
C v167,v182,v183
W a28,v164
W a29,v165
W a30,v166
W a31,v167
M v[64:67],a[84:87],a[20:23],v[64:67]
s_cselect_b64 s[80:81], s[50:51], s[82:83]
v_mov_b32 v31, 0
v_cndmask_b32 v72, 0, v8, s[74:75]
M v[64:67],a[88:91],a[24:27],v[64:67]
s_mov_b32 s26, s43
v_mov_b32 v32, 0
M v[64:67],a[92:95],a[28:31],v[64:67]
s_waitcnt lgkmcnt(0)
v_cndmask_b32 v73, 0, v8, s[76:77]
M v[76:79],a[96:99],a[32:35],0
SA m0,s28,0
R a[64:67],v2,49152
R a[68:71],v2,50176
M v[76:79],a[100:103],a[36:39],v[76:79]
SA s3,s93,786432
buffer_load_dwordx4 v3, s[8:11], s26 offen offset:0 sc1 lds
M v[76:79],a[104:107],a[40:43],v[76:79]
v_cndmask_b32 v74, 0, v8, s[78:79]
v_mov_b32 v33, 0
M v[76:79],a[108:111],a[44:47],v[76:79]
R a[72:75],v2,51200
R a[76:79],v2,52224
M v[76:79],a[112:115],a[48:51],v[76:79]
buffer_store_dwordx4 v[192:195], v7, s[8:11], s3 offen offset:0 sc1
M v[76:79],a[116:119],a[52:55],v[76:79]
v_cndmask_b32 v75, 0, v8, s[80:81]
M v[76:79],a[120:123],a[56:59],v[76:79]
s_cmp_lt_u32 s20, 2
R a[80:83],v2,53248
R a[84:87],v2,54272
M v[76:79],a[124:127],a[60:63],v[76:79]
s_cselect_b64 s[82:83], -1, 0
buffer_load_dwordx4 v3, s[8:11], s26 offen offset:1024 sc1 lds
M v[72:75],a[124:127],a[28:31],v[72:75]
s_cmp_eq_u32 s20, 2
E v18,v68
M v[72:75],a[120:123],a[24:27],v[72:75]
s_cselect_b64 s[66:67], s[16:17], s[82:83]
R a[88:91],v2,55296
R a[92:95],v2,56320
M v[72:75],a[116:119],a[20:23],v[72:75]
s_cselect_b64 s[68:69], s[18:19], s[82:83]
buffer_load_dwordx4 v3, s[8:11], s26 offen offset:2048 sc1 lds
M v[72:75],a[112:115],a[16:19],v[72:75]
s_cselect_b64 s[70:71], s[48:49], s[82:83]
v_mov_b32 v34, 0
M v[72:75],a[108:111],a[12:15],v[72:75]
s_cselect_b64 s[72:73], s[50:51], s[82:83]
v_cndmask_b32 v80, 0, v8, s[66:67]
v_cndmask_b32 v81, 0, v8, s[68:69]
M v[72:75],a[104:107],a[8:11],v[72:75]
buffer_store_dwordx4 v[200:203], v7, s[8:11], s3 offen offset:1024 sc1
M v[72:75],a[100:103],a[4:7],v[72:75]
E v19,v69
M v[72:75],a[96:99],a[0:3],v[72:75]
s_waitcnt lgkmcnt(0)
buffer_load_dwordx4 v3, s[8:11], s26 offen offset:3072 sc1 lds
M v[84:87],a[64:67],a[32:35],0
SA m0,s28,4096
R a[96:99],v2,57344
R a[100:103],v2,58368
M v[84:87],a[68:71],a[36:39],v[84:87]
v_cndmask_b32 v82, 0, v8, s[70:71]
v_mov_b32 v35, 0
M v[84:87],a[72:75],a[40:43],v[84:87]
buffer_load_dwordx4 v4, s[8:11], s26 offen offset:0 sc1 lds
M v[84:87],a[76:79],a[44:47],v[84:87]
R a[104:107],v2,59392
R a[108:111],v2,60416
M v[84:87],a[80:83],a[48:51],v[84:87]
buffer_store_dwordx4 v[208:211], v7, s[8:11], s3 offen offset:2048 sc1
M v[84:87],a[84:87],a[52:55],v[84:87]
v_cndmask_b32 v83, 0, v8, s[72:73]
v_mov_b32 v36, 0
M v[84:87],a[88:91],a[56:59],v[84:87]
s_cmp_lt_u32 s20, 3
R a[112:115],v2,61440
R a[116:119],v2,62464
M v[84:87],a[92:95],a[60:63],v[84:87]
s_cselect_b64 s[82:83], -1, 0
buffer_load_dwordx4 v4, s[8:11], s26 offen offset:1024 sc1 lds
M v[80:83],a[92:95],a[28:31],v[80:83]
s_cmp_eq_u32 s20, 3
E v20,v70
M v[80:83],a[88:91],a[24:27],v[80:83]
s_cselect_b64 s[74:75], s[16:17], s[82:83]
R a[120:123],v2,63488
R a[124:127],v2,64512
M v[80:83],a[84:87],a[20:23],v[80:83]
s_cselect_b64 s[76:77], s[18:19], s[82:83]
buffer_load_dwordx4 v4, s[8:11], s26 offen offset:2048 sc1 lds
M v[80:83],a[80:83],a[16:19],v[80:83]
s_cselect_b64 s[78:79], s[48:49], s[82:83]
E v21,v71
M v[80:83],a[76:79],a[12:15],v[80:83]
s_cselect_b64 s[80:81], s[50:51], s[82:83]
buffer_store_dwordx4 v[216:219], v7, s[8:11], s3 offen offset:3072 sc1
M v[80:83],a[72:75],a[8:11],v[80:83]
SA s3,s93,794624
v_cndmask_b32 v88, 0, v8, s[74:75]
v_cndmask_b32 v89, 0, v8, s[76:77]
M v[80:83],a[68:71],a[4:7],v[80:83]
s_waitcnt vmcnt(24) lgkmcnt(0)
buffer_load_dwordx4 v4, s[8:11], s26 offen offset:3072 sc1 lds
M v[80:83],a[64:67],a[0:3],v[80:83]
s_barrier
M v[92:95],a[96:99],a[32:35],0
R a[64:67],v2,0
R a[68:71],v2,1024
M v[92:95],a[100:103],a[36:39],v[92:95]
buffer_store_dwordx4 v[224:227], v7, s[8:11], s3 offen offset:0 sc1
M v[92:95],a[104:107],a[40:43],v[92:95]
v_min_u32 v17, 896, v9
v_cndmask_b32 v90, 0, v8, s[78:79]
M v[92:95],a[108:111],a[44:47],v[92:95]
R a[72:75],v2,2048
R a[76:79],v2,3072
M v[92:95],a[112:115],a[48:51],v[92:95]
buffer_load_dword v5, v17, s[8:11], s46 offen sc1
M v[92:95],a[116:119],a[52:55],v[92:95]
buffer_store_dwordx4 v[232:235], v7, s[8:11], s3 offen offset:1024 sc1
M v[92:95],a[120:123],a[56:59],v[92:95]
R a[80:83],v2,4096
R a[84:87],v2,5120
v_cndmask_b32 v91, 0, v8, s[80:81]
M v[92:95],a[124:127],a[60:63],v[92:95]
v_mov_b32 v37, 0
v_mov_b32 v38, 0
M v[88:91],a[124:127],a[28:31],v[88:91]
buffer_store_dwordx4 v[240:243], v7, s[8:11], s3 offen offset:2048 sc1
M v[88:91],a[120:123],a[24:27],v[88:91]
R a[88:91],v2,6144
R a[92:95],v2,7168
M v[88:91],a[116:119],a[20:23],v[88:91]
v_mov_b32 v39, 0
AF v27,v18,v19
M v[88:91],a[112:115],a[16:19],v[88:91]
buffer_store_dwordx4 v[248:251], v7, s[8:11], s3 offen offset:3072 sc1
M v[88:91],a[108:111],a[12:15],v[88:91]
E v22,v64
M v[88:91],a[104:107],a[8:11],v[88:91]
E v23,v65
M v[88:91],a[100:103],a[4:7],v[88:91]
s_waitcnt lgkmcnt(0)
E v24,v66
M v[88:91],a[96:99],a[0:3],v[88:91]
E v25,v67
C v44,v18,v19
AF v27,v20,v27
C v45,v20,v21
AF v27,v21,v27
AF v26,v22,v23
C v40,v22,v23
E v18,v76
E v19,v77
AF v26,v24,v26
C v41,v24,v25
AF v26,v25,v26
E v20,v78
E v21,v79
AF v27,v18,v27
C v46,v18,v19
AF v27,v19,v27
E v22,v72
E v23,v73
AF v27,v20,v27
C v47,v20,v21
AF v27,v21,v27
E v24,v74
E v25,v75
AF v26,v22,v26
C v42,v22,v23
AF v26,v23,v26
AF v26,v24,v26
C v43,v24,v25
AF v26,v25,v26
v_mov_b32 v56, 0
v_mov_b32 v57, 0
v_mov_b32 v58, 0
v_mov_b32 v59, 0
s_mul_i32 s21, s41, 1048576
SA s21,s21,589824
s_lshl_b32 s84, s42, 1
s_sub_u32 s22, 11, s84
s_mov_b32 s23, 536870912
s_lshl_b32 s86, s20, 14
SA s86,s86,s34
SA s87,s86,4096
SA s88,s86,8192
SA s89,s86,12288
s_lshl_b32 s90, s20, 10
SA s90,s90,s34
SA s90,s90,65536
s_waitcnt vmcnt(3)
v_cmp_gt_u32 vcc, 2, v5
s_nop 0
s_cbranch_vccnz L_lsj0
L_lrj0:
SA m0,s28,98304
v_mov_b32 v10, v26
buffer_load_dwordx4 v3, s[8:11], s21 offen offset:0 sc1 lds
v_mov_b32 v11, v27
buffer_load_dwordx4 v3, s[8:11], s21 offen offset:1024 sc1 lds
v_mov_b32 v12, v10
v_mov_b32 v13, v11
buffer_load_dwordx4 v3, s[8:11], s21 offen offset:2048 sc1 lds
v_permlane16_swap_b32 v12, v10
v_permlane16_swap_b32 v13, v11
buffer_load_dwordx4 v3, s[8:11], s21 offen offset:3072 sc1 lds
v_max_f32 v10, v12, v10
SA m0,s28,102400
v_max_f32 v11, v13, v11
buffer_load_dwordx4 v4, s[8:11], s21 offen offset:0 sc1 lds
v_mov_b32 v12, v10
v_mov_b32 v13, v11
buffer_load_dwordx4 v4, s[8:11], s21 offen offset:1024 sc1 lds
v_permlane32_swap_b32 v12, v10
v_permlane32_swap_b32 v13, v11
buffer_load_dwordx4 v4, s[8:11], s21 offen offset:2048 sc1 lds
v_max_f32 v10, v12, v10
v_max_f32 v11, v13, v11
buffer_load_dwordx4 v4, s[8:11], s21 offen offset:3072 sc1 lds
SA s21,s21,32768
s_sub_u32 s22, s22, 1
s_cselect_b32 s21, s23, s21
v_min_f32 v10, v10, v11
v_cmp_gt_f32 vcc, s24, v10
s_nop 0
s_cbranch_vccnz L_stj0
L_rtj0:
s_cmp_gt_u32 s20, 3
s_cselect_b64 s[82:83], -1, 0
s_cmp_eq_u32 s20, 3
s_cselect_b64 s[66:67], s[16:17], s[82:83]
v_mfma_f32_32x32x16_bf16 v[128:143], v[56:59], v[56:59], 0
s_cselect_b64 s[68:69], s[18:19], s[82:83]
s_cselect_b64 s[70:71], s[48:49], s[82:83]
s_cselect_b64 s[72:73], s[50:51], s[82:83]
v_cndmask_b32 v100, v36, v8, s[66:67]
v_mfma_f32_32x32x16_bf16 v[144:159], v[56:59], v[56:59], 0
v_cndmask_b32 v101, v36, v8, s[68:69]
v_cndmask_b32 v102, v36, v8, s[70:71]
v_cndmask_b32 v103, v36, v8, s[72:73]
s_cmp_gt_u32 s20, 2
v_mfma_f32_32x32x16_bf16 v[160:175], v[56:59], v[56:59], 0
s_cselect_b64 s[82:83], -1, 0
s_cmp_eq_u32 s20, 2
s_cselect_b64 s[74:75], s[16:17], s[82:83]
s_cselect_b64 s[76:77], s[18:19], s[82:83]
v_mfma_f32_32x32x16_bf16 v[176:191], v[56:59], v[56:59], 0
s_cselect_b64 s[78:79], s[48:49], s[82:83]
s_cselect_b64 s[80:81], s[50:51], s[82:83]
v_cndmask_b32 v108, v36, v8, s[74:75]
v_cndmask_b32 v109, v36, v8, s[76:77]
v_mfma_f32_32x32x16_bf16 v[192:207], v[56:59], v[56:59], 0
v_cndmask_b32 v110, v36, v8, s[78:79]
v_cndmask_b32 v111, v36, v8, s[80:81]
s_cmp_gt_u32 s20, 1
s_cselect_b64 s[82:83], -1, 0
v_mfma_f32_32x32x16_bf16 v[208:223], v[56:59], v[56:59], 0
s_cmp_eq_u32 s20, 1
s_cselect_b64 s[66:67], s[16:17], s[82:83]
s_cselect_b64 s[68:69], s[18:19], s[82:83]
s_cselect_b64 s[70:71], s[48:49], s[82:83]
v_mfma_f32_32x32x16_bf16 v[224:239], v[56:59], v[56:59], 0
s_cselect_b64 s[72:73], s[50:51], s[82:83]
v_cndmask_b32 v116, v36, v8, s[66:67]
v_cndmask_b32 v117, v36, v8, s[68:69]
v_cndmask_b32 v118, v36, v8, s[70:71]
v_mfma_f32_32x32x16_bf16 v[240:255], v[56:59], v[56:59], 0
v_cndmask_b32 v119, v36, v8, s[72:73]
s_cmp_gt_u32 s20, 0
s_cselect_b64 s[82:83], -1, 0
s_cmp_eq_u32 s20, 0
s_cselect_b64 s[74:75], s[16:17], s[82:83]
s_cselect_b64 s[76:77], s[18:19], s[82:83]
s_cselect_b64 s[78:79], s[48:49], s[82:83]
s_cselect_b64 s[80:81], s[50:51], s[82:83]
v_cndmask_b32 v124, v36, v8, s[74:75]
v_cndmask_b32 v125, v36, v8, s[76:77]
v_cndmask_b32 v126, v36, v8, s[78:79]
v_cndmask_b32 v127, v36, v8, s[80:81]
s_branch L_d3h
.p2align 12
L_kv1:
s_and_b32 s31, s42, 7
s_lshl_b32 s30, s41, 3
SA s30,s30,s31
s_lshl_b32 s64, s30, 2
SA s64,s64,s20
s_mul_i32 s72, s64, 3584
v_mov_b32 v32, 536870912
v_cmp_gt_u32 vcc, 56, v0
s_lshl_b32 s67, s64, 2
s_nop 0
v_cndmask_b32 v32, v32, v7, vcc
buffer_load_dwordx4 a[176:179], v32, s[56:59], s72 offen offset:0
buffer_load_dwordx4 a[180:183], v32, s[56:59], s72 offen offset:896
buffer_load_dwordx4 a[184:187], v32, s[56:59], s72 offen offset:1792
buffer_load_dwordx4 a[188:191], v32, s[56:59], s72 offen offset:2688
buffer_load_dwordx4 a[192:195], v32, s[60:63], 0 offen
buffer_load_dwordx4 a[196:199], v32, s[68:71], 0 offen
SA m0,s24,16384
s_nop 0
buffer_load_dwordx4 v12, s[48:51], s22 offen offset:0   lds
buffer_load_dwordx4 v13, s[48:51], s22 offen offset:1024   lds
buffer_load_dwordx4 v14, s[48:51], s22 offen offset:2048   lds
buffer_load_dwordx4 v15, s[48:51], s22 offen offset:3072   lds
s_sub_u32 s22, s22, 1048448
SA m0,s23,32768
s_nop 0
buffer_load_dwordx4 v8, s[16:19], s21 offen offset:0  nt lds
buffer_load_dwordx4 v9, s[16:19], s21 offen offset:1024  nt lds
buffer_load_dwordx4 v10, s[16:19], s21 offen offset:2048  nt lds
buffer_load_dwordx4 v11, s[16:19], s21 offen offset:3072  nt lds
SA s21,s21,128
s_mov_b64 exec, 0
s_cmp_eq_u32 s20, 0
s_cbranch_scc1 L_w_kv11
s_cmp_eq_u32 s20, 1
s_cbranch_scc1 L_w_kv12
s_cmp_eq_u32 s20, 2
s_cbranch_scc1 L_w_kv13
s_branch L_w_kv14
L_wd2:
s_mov_b64 exec, -1
s_waitcnt vmcnt(14) lgkmcnt(0)
s_barrier
R a[160:163],v5,0
R a[164:167],v6,0
T a[96:97],v1,0
T a[98:99],v1,1024
T a[100:101],v1,8192
T a[102:103],v1,9216
T a[104:105],v2,0
T a[106:107],v2,1024
T a[108:109],v2,8192
T a[110:111],v2,9216
T a[112:113],v3,0
T a[114:115],v3,1024
T a[116:117],v3,8192
T a[118:119],v3,9216
T a[120:121],v4,0
T a[122:123],v4,1024
T a[124:125],v4,8192
T a[126:127],v4,9216
T a[128:129],v1,16384
T a[130:131],v1,17408
T a[132:133],v1,24576
T a[134:135],v1,25600
T a[136:137],v2,16384
T a[138:139],v2,17408
T a[140:141],v2,24576
T a[142:143],v2,25600
T a[144:145],v3,16384
T a[146:147],v3,17408
T a[148:149],v3,24576
T a[150:151],v3,25600
T a[152:153],v4,16384
T a[154:155],v4,17408
T a[156:157],v4,24576
T a[158:159],v4,25600
s_waitcnt lgkmcnt(15)
M a[0:3],a[160:163],a[96:99],0
SA m0,s23,49152
R a[168:171],v5,2048
R a[172:175],v6,2048
M a[0:3],a[164:167],a[100:103],a[0:3]
buffer_load_dwordx4 v8, s[16:19], s21 offen offset:0  nt lds
M a[4:7],a[164:167],a[108:111],0
M a[4:7],a[160:163],a[104:107],a[4:7]
M a[8:11],a[160:163],a[112:115],0
buffer_load_dwordx4 v9, s[16:19], s21 offen offset:1024  nt lds
M a[8:11],a[164:167],a[116:119],a[8:11]
s_waitcnt lgkmcnt(14)
M a[12:15],a[164:167],a[124:127],0
M a[12:15],a[160:163],a[120:123],a[12:15]
M a[16:19],a[160:163],a[128:131],0
buffer_load_dwordx4 v10, s[16:19], s21 offen offset:2048  nt lds
M a[16:19],a[164:167],a[132:135],a[16:19]
s_waitcnt lgkmcnt(6)
M a[20:23],a[164:167],a[140:143],0
M a[20:23],a[160:163],a[136:139],a[20:23]
buffer_load_dwordx4 v11, s[16:19], s21 offen offset:3072  nt lds
M a[24:27],a[160:163],a[144:147],0
SA s21,s21,524160
M a[24:27],a[164:167],a[148:151],a[24:27]
s_waitcnt lgkmcnt(0)
M a[28:31],a[164:167],a[156:159],0
SA m0,s24,32768
M a[28:31],a[160:163],a[152:155],a[28:31]
buffer_load_dwordx4 v12, s[48:51], s22 offen offset:0   lds
M v[32:35],a[168:171],a[96:99],0
R a[160:163],v5,4096
R a[164:167],v6,4096
M v[32:35],a[172:175],a[100:103],v[32:35]
M v[36:39],a[172:175],a[108:111],0
M v[36:39],a[168:171],a[104:107],v[36:39]
buffer_load_dwordx4 v13, s[48:51], s22 offen offset:1024   lds
M v[40:43],a[168:171],a[112:115],0
M v[40:43],a[172:175],a[116:119],v[40:43]
M v[44:47],a[172:175],a[124:127],0
buffer_load_dwordx4 v14, s[48:51], s22 offen offset:2048   lds
M v[44:47],a[168:171],a[120:123],v[44:47]
M v[48:51],a[168:171],a[128:131],0
M v[48:51],a[172:175],a[132:135],v[48:51]
M v[52:55],a[172:175],a[140:143],0
buffer_load_dwordx4 v15, s[48:51], s22 offen offset:3072   lds
M v[52:55],a[168:171],a[136:139],v[52:55]
SA s22,s22,1048576
M v[56:59],a[168:171],a[144:147],0
M v[56:59],a[172:175],a[148:151],v[56:59]
s_waitcnt lgkmcnt(0)
M v[60:63],a[172:175],a[156:159],0
M v[60:63],a[168:171],a[152:155],v[60:63]
M v[64:67],a[160:163],a[96:99],0
R a[168:171],v5,6144
R a[172:175],v6,6144
M v[64:67],a[164:167],a[100:103],v[64:67]
M v[68:71],a[164:167],a[108:111],0
M v[68:71],a[160:163],a[104:107],v[68:71]
M v[72:75],a[160:163],a[112:115],0
M v[72:75],a[164:167],a[116:119],v[72:75]
M v[76:79],a[164:167],a[124:127],0
M v[76:79],a[160:163],a[120:123],v[76:79]
M v[80:83],a[160:163],a[128:131],0
M v[80:83],a[164:167],a[132:135],v[80:83]
M v[84:87],a[164:167],a[140:143],0
M v[84:87],a[160:163],a[136:139],v[84:87]
M v[88:91],a[160:163],a[144:147],0
M v[88:91],a[164:167],a[148:151],v[88:91]
s_waitcnt lgkmcnt(0)
M v[92:95],a[164:167],a[156:159],0
s_waitcnt vmcnt(12)
M v[92:95],a[160:163],a[152:155],v[92:95]
s_barrier
M v[96:99],a[168:171],a[96:99],0
SA m0,s23,0
R a[160:163],v5,16384
R a[164:167],v6,16384
M v[96:99],a[172:175],a[100:103],v[96:99]
buffer_load_dwordx4 v8, s[16:19], s21 offen offset:0  nt lds
M v[100:103],a[172:175],a[108:111],0
v_lshlrev_b32 v26, 7, v0
v_and_b32 v27, 48, v0
M v[100:103],a[168:171],a[104:107],v[100:103]
v_lshl_add_u32 v26, v27, 24, v26
M v[104:107],a[168:171],a[112:115],0
buffer_load_dwordx4 v9, s[16:19], s21 offen offset:1024  nt lds
M v[104:107],a[172:175],a[116:119],v[104:107]
M v[108:111],a[172:175],a[124:127],0
M v[108:111],a[168:171],a[120:123],v[108:111]
buffer_load_dwordx4 v10, s[16:19], s21 offen offset:2048  nt lds
M v[112:115],a[168:171],a[128:131],0
M v[112:115],a[172:175],a[132:135],v[112:115]
M v[116:119],a[172:175],a[140:143],0
M v[116:119],a[168:171],a[136:139],v[116:119]
buffer_load_dwordx4 v11, s[16:19], s21 offen offset:3072  nt lds
M v[120:123],a[168:171],a[144:147],0
SA s21,s21,128
M v[120:123],a[172:175],a[148:151],v[120:123]
s_waitcnt lgkmcnt(0)
M v[124:127],a[172:175],a[156:159],0
SA m0,s24,49152
M v[124:127],a[168:171],a[152:155],v[124:127]
buffer_load_dwordx4 v12, s[48:51], s22 offen offset:0   lds
M v[128:131],a[160:163],a[96:99],0
R a[168:171],v5,18432
R a[172:175],v6,18432
M v[128:131],a[164:167],a[100:103],v[128:131]
buffer_load_dwordx4 v13, s[48:51], s22 offen offset:1024   lds
M v[132:135],a[164:167],a[108:111],0
M v[132:135],a[160:163],a[104:107],v[132:135]
M v[136:139],a[160:163],a[112:115],0
M v[136:139],a[164:167],a[116:119],v[136:139]
buffer_load_dwordx4 v14, s[48:51], s22 offen offset:2048   lds
M v[140:143],a[164:167],a[124:127],0
M v[140:143],a[160:163],a[120:123],v[140:143]
M v[144:147],a[160:163],a[128:131],0
buffer_load_dwordx4 v15, s[48:51], s22 offen offset:3072   lds
M v[144:147],a[164:167],a[132:135],v[144:147]
s_sub_u32 s22, s22, 1048448
M v[148:151],a[164:167],a[140:143],0
M v[148:151],a[160:163],a[136:139],v[148:151]
M v[152:155],a[160:163],a[144:147],0
M v[152:155],a[164:167],a[148:151],v[152:155]
s_waitcnt lgkmcnt(0)
M v[156:159],a[164:167],a[156:159],0
s_waitcnt vmcnt(12)
M v[156:159],a[160:163],a[152:155],v[156:159]
s_barrier
M v[160:163],a[168:171],a[96:99],0
SA m0,s23,16384
R a[160:163],v5,20480
R a[164:167],v6,20480
M v[160:163],a[172:175],a[100:103],v[160:163]
T a[32:33],v1,32768
T a[34:35],v1,33792
M v[164:167],a[172:175],a[108:111],0
T a[36:37],v1,40960
T a[38:39],v1,41984
M v[164:167],a[168:171],a[104:107],v[164:167]
T a[40:41],v2,32768
T a[42:43],v2,33792
M v[168:171],a[168:171],a[112:115],0
T a[44:45],v2,40960
T a[46:47],v2,41984
M v[168:171],a[172:175],a[116:119],v[168:171]
buffer_load_dwordx4 v8, s[16:19], s21 offen offset:0  nt lds
M v[172:175],a[172:175],a[124:127],0
s_nop 0
T a[48:49],v3,32768
T a[50:51],v3,33792
M v[172:175],a[168:171],a[120:123],v[172:175]
buffer_load_dwordx4 v9, s[16:19], s21 offen offset:1024  nt lds
M v[176:179],a[168:171],a[128:131],0
s_nop 0
T a[52:53],v3,40960
T a[54:55],v3,41984
M v[176:179],a[172:175],a[132:135],v[176:179]
T a[56:57],v4,32768
T a[58:59],v4,33792
M v[180:183],a[172:175],a[140:143],0
buffer_load_dwordx4 v10, s[16:19], s21 offen offset:2048  nt lds
M v[180:183],a[168:171],a[136:139],v[180:183]
s_nop 0
T a[60:61],v4,40960
T a[62:63],v4,41984
M v[184:187],a[168:171],a[144:147],0
buffer_load_dwordx4 v11, s[16:19], s21 offen offset:3072  nt lds
M v[184:187],a[172:175],a[148:151],v[184:187]
s_waitcnt lgkmcnt(15)
s_nop 0
T a[64:65],v1,49152
T a[66:67],v1,50176
M v[188:191],a[172:175],a[156:159],0
SA s21,s21,524160
T a[68:69],v1,57344
T a[70:71],v1,58368
M v[188:191],a[168:171],a[152:155],v[188:191]
SA m0,s24,0
M v[192:195],a[160:163],a[96:99],0
R a[168:171],v5,22528
R a[172:175],v6,22528
M v[192:195],a[164:167],a[100:103],v[192:195]
T a[72:73],v2,49152
T a[74:75],v2,50176
M v[196:199],a[164:167],a[108:111],0
T a[76:77],v2,57344
T a[78:79],v2,58368
M v[196:199],a[160:163],a[104:107],v[196:199]
T a[80:81],v3,49152
T a[82:83],v3,50176
M v[200:203],a[160:163],a[112:115],0
buffer_load_dwordx4 v12, s[48:51], s22 offen offset:0   lds
M v[200:203],a[164:167],a[116:119],v[200:203]
s_nop 0
T a[84:85],v3,57344
T a[86:87],v3,58368
M v[204:207],a[164:167],a[124:127],0
T a[88:89],v4,49152
T a[90:91],v4,50176
M v[204:207],a[160:163],a[120:123],v[204:207]
buffer_load_dwordx4 v13, s[48:51], s22 offen offset:1024   lds
M v[208:211],a[160:163],a[128:131],0
s_nop 0
T a[92:93],v4,57344
T a[94:95],v4,58368
M v[208:211],a[164:167],a[132:135],v[208:211]
buffer_load_dwordx4 v14, s[48:51], s22 offen offset:2048   lds
M v[212:215],a[164:167],a[140:143],0
buffer_load_dwordx4 v15, s[48:51], s22 offen offset:3072   lds
M v[212:215],a[160:163],a[136:139],v[212:215]
SA s22,s22,1048576
M v[216:219],a[160:163],a[144:147],0
M v[216:219],a[164:167],a[148:151],v[216:219]
s_waitcnt lgkmcnt(12)
M v[220:223],a[164:167],a[156:159],0
s_waitcnt vmcnt(12) lgkmcnt(0)
M v[220:223],a[160:163],a[152:155],v[220:223]
s_barrier
M v[224:227],a[168:171],a[96:99],0
SA m0,s23,32768
R a[160:163],v5,32768
R a[164:167],v6,32768
M v[224:227],a[172:175],a[100:103],v[224:227]
buffer_load_dwordx4 v8, s[16:19], s21 offen offset:0  nt lds
M v[228:231],a[172:175],a[108:111],0
M v[228:231],a[168:171],a[104:107],v[228:231]
M v[232:235],a[168:171],a[112:115],0
buffer_load_dwordx4 v9, s[16:19], s21 offen offset:1024  nt lds
M v[232:235],a[172:175],a[116:119],v[232:235]
M v[236:239],a[172:175],a[124:127],0
M v[236:239],a[168:171],a[120:123],v[236:239]
buffer_load_dwordx4 v10, s[16:19], s21 offen offset:2048  nt lds
M v[240:243],a[168:171],a[128:131],0
M v[240:243],a[172:175],a[132:135],v[240:243]
M v[244:247],a[172:175],a[140:143],0
buffer_load_dwordx4 v11, s[16:19], s21 offen offset:3072  nt lds
M v[244:247],a[168:171],a[136:139],v[244:247]
SA s21,s21,128
M v[248:251],a[168:171],a[144:147],0
M v[248:251],a[172:175],a[148:151],v[248:251]
s_waitcnt lgkmcnt(0)
M v[252:255],a[172:175],a[156:159],0
M v[252:255],a[168:171],a[152:155],v[252:255]
M a[0:3],a[160:163],a[32:35],a[0:3]
R a[168:171],v5,34816
R a[172:175],v6,34816
M a[0:3],a[164:167],a[36:39],a[0:3]
T a[96:97],v1,0
T a[98:99],v1,1024
M a[4:7],a[164:167],a[44:47],a[4:7]
SA m0,s24,16384
v_mov_b32 v16, 0
v_mov_b32 v17, 0
M a[4:7],a[160:163],a[40:43],a[4:7]
buffer_load_dwordx4 v12, s[48:51], s22 offen offset:0   lds
M a[8:11],a[160:163],a[48:51],a[8:11]
v_mov_b32 v18, 0
v_mov_b32 v19, 0
M a[8:11],a[164:167],a[52:55],a[8:11]
v_mov_b32 v20, 0
v_mov_b32 v21, 0
M a[12:15],a[164:167],a[60:63],a[12:15]
T a[100:101],v1,8192
T a[102:103],v1,9216
M a[12:15],a[160:163],a[56:59],a[12:15]
v_mov_b32 v22, 0
v_mov_b32 v23, 0
M a[16:19],a[160:163],a[64:67],a[16:19]
buffer_load_dwordx4 v13, s[48:51], s22 offen offset:1024   lds
M a[16:19],a[164:167],a[68:71],a[16:19]
G v28,a192
G v29,a196
M a[20:23],a[164:167],a[76:79],a[20:23]
v_lshlrev_b32 v24, 16, v28
v_lshlrev_b32 v25, 16, v29
M a[20:23],a[160:163],a[72:75],a[20:23]
T a[104:105],v2,0
T a[106:107],v2,1024
M a[24:27],a[160:163],a[80:83],a[24:27]
v_and_b32 v28, 0xffff0000, v28
v_and_b32 v29, 0xffff0000, v29
M a[24:27],a[164:167],a[84:87],a[24:27]
s_waitcnt lgkmcnt(6)
buffer_load_dwordx4 v14, s[48:51], s22 offen offset:2048   lds
M a[28:31],a[164:167],a[92:95],a[28:31]
G v30,a176
v_lshlrev_b32 v31, 16, v30
M a[28:31],a[160:163],a[88:91],a[28:31]
v_and_b32 v30, 0xffff0000, v30
v_fmac_f32 v16, v31, v24
M v[60:63],a[168:171],a[88:91],v[60:63]
R a[160:163],v5,36864
R a[164:167],v6,36864
M v[60:63],a[172:175],a[92:95],v[60:63]
T a[108:109],v2,8192
T a[110:111],v2,9216
M v[56:59],a[172:175],a[84:87],v[56:59]
buffer_load_dwordx4 v15, s[48:51], s22 offen offset:3072   lds
M v[56:59],a[168:171],a[80:83],v[56:59]
s_sub_u32 s22, s22, 1048448
v_fmac_f32 v20, v31, v25
v_fmac_f32 v16, v30, v28
M v[52:55],a[168:171],a[72:75],v[52:55]
v_fmac_f32 v20, v30, v29
G v30,a180
M v[52:55],a[172:175],a[76:79],v[52:55]
T a[112:113],v3,0
T a[114:115],v3,1024
M v[48:51],a[172:175],a[68:71],v[48:51]
SA m0,s23,49152
v_lshlrev_b32 v31, 16, v30
v_and_b32 v30, 0xffff0000, v30
M v[48:51],a[168:171],a[64:67],v[48:51]
buffer_load_dwordx4 v8, s[16:19], s21 offen offset:0  nt lds
M v[44:47],a[168:171],a[56:59],v[44:47]
v_fmac_f32 v17, v31, v24
v_fmac_f32 v21, v31, v25
M v[44:47],a[172:175],a[60:63],v[44:47]
v_fmac_f32 v17, v30, v28
v_fmac_f32 v21, v30, v29
M v[40:43],a[172:175],a[52:55],v[40:43]
T a[116:117],v3,8192
T a[118:119],v3,9216
M v[40:43],a[168:171],a[48:51],v[40:43]
G v30,a184
v_lshlrev_b32 v31, 16, v30
M v[36:39],a[168:171],a[40:43],v[36:39]
buffer_load_dwordx4 v9, s[16:19], s21 offen offset:1024  nt lds
M v[36:39],a[172:175],a[44:47],v[36:39]
s_waitcnt lgkmcnt(6)
v_and_b32 v30, 0xffff0000, v30
v_fmac_f32 v18, v31, v24
M v[32:35],a[172:175],a[36:39],v[32:35]
v_fmac_f32 v22, v31, v25
v_fmac_f32 v18, v30, v28
M v[32:35],a[168:171],a[32:35],v[32:35]
T a[120:121],v4,0
T a[122:123],v4,1024
M v[64:67],a[160:163],a[32:35],v[64:67]
R a[168:171],v5,38912
R a[172:175],v6,38912
M v[64:67],a[164:167],a[36:39],v[64:67]
buffer_load_dwordx4 v10, s[16:19], s21 offen offset:2048  nt lds
M v[68:71],a[164:167],a[44:47],v[68:71]
v_fmac_f32 v22, v30, v29
G v30,a188
M v[68:71],a[160:163],a[40:43],v[68:71]
v_lshlrev_b32 v31, 16, v30
v_and_b32 v30, 0xffff0000, v30
M v[72:75],a[160:163],a[48:51],v[72:75]
T a[124:125],v4,8192
T a[126:127],v4,9216
M v[72:75],a[164:167],a[52:55],v[72:75]
v_fmac_f32 v19, v31, v24
v_fmac_f32 v23, v31, v25
M v[76:79],a[164:167],a[60:63],v[76:79]
buffer_load_dwordx4 v11, s[16:19], s21 offen offset:3072  nt lds
M v[76:79],a[160:163],a[56:59],v[76:79]
SA s21,s21,524160
v_fmac_f32 v19, v30, v28
v_fmac_f32 v23, v30, v29
M v[80:83],a[160:163],a[64:67],v[80:83]
G v28,a193
G v29,a197
M v[80:83],a[164:167],a[68:71],v[80:83]
v_lshlrev_b32 v24, 16, v28
v_lshlrev_b32 v25, 16, v29
M v[84:87],a[164:167],a[76:79],v[84:87]
v_and_b32 v28, 0xffff0000, v28
v_and_b32 v29, 0xffff0000, v29
M v[84:87],a[160:163],a[72:75],v[84:87]
G v30,a177
v_lshlrev_b32 v31, 16, v30
M v[88:91],a[160:163],a[80:83],v[88:91]
v_and_b32 v30, 0xffff0000, v30
v_fmac_f32 v16, v31, v24
M v[88:91],a[164:167],a[84:87],v[88:91]
s_waitcnt lgkmcnt(2)
v_fmac_f32 v20, v31, v25
v_fmac_f32 v16, v30, v28
M v[92:95],a[164:167],a[92:95],v[92:95]
s_waitcnt vmcnt(16) lgkmcnt(0)
v_fmac_f32 v20, v30, v29
G v30,a181
M v[92:95],a[160:163],a[88:91],v[92:95]
s_barrier
M v[124:127],a[168:171],a[88:91],v[124:127]
R a[160:163],v5,49152
R a[164:167],v6,49152
M v[124:127],a[172:175],a[92:95],v[124:127]
v_lshlrev_b32 v31, 16, v30
v_and_b32 v30, 0xffff0000, v30
M v[120:123],a[172:175],a[84:87],v[120:123]
SA m0,s24,32768
T a[128:129],v1,16384
T a[130:131],v1,17408
M v[120:123],a[168:171],a[80:83],v[120:123]
buffer_load_dwordx4 v12, s[48:51], s22 offen offset:0   lds
M v[116:119],a[168:171],a[72:75],v[116:119]
v_fmac_f32 v17, v31, v24
v_fmac_f32 v21, v31, v25
M v[116:119],a[172:175],a[76:79],v[116:119]
v_fmac_f32 v17, v30, v28
v_fmac_f32 v21, v30, v29
M v[112:115],a[172:175],a[68:71],v[112:115]
G v30,a185
v_lshlrev_b32 v31, 16, v30
M v[112:115],a[168:171],a[64:67],v[112:115]
v_and_b32 v30, 0xffff0000, v30
v_fmac_f32 v18, v31, v24
M v[108:111],a[168:171],a[56:59],v[108:111]
v_fmac_f32 v22, v31, v25
v_fmac_f32 v18, v30, v28
M v[108:111],a[172:175],a[60:63],v[108:111]
T a[132:133],v1,24576
T a[134:135],v1,25600
M v[104:107],a[172:175],a[52:55],v[104:107]
buffer_load_dwordx4 v13, s[48:51], s22 offen offset:1024   lds
M v[104:107],a[168:171],a[48:51],v[104:107]
v_fmac_f32 v22, v30, v29
G v30,a189
M v[100:103],a[168:171],a[40:43],v[100:103]
v_lshlrev_b32 v31, 16, v30
v_and_b32 v30, 0xffff0000, v30
M v[100:103],a[172:175],a[44:47],v[100:103]
s_waitcnt lgkmcnt(4)
v_fmac_f32 v19, v31, v24
v_fmac_f32 v23, v31, v25
M v[96:99],a[172:175],a[36:39],v[96:99]
v_fmac_f32 v19, v30, v28
v_fmac_f32 v23, v30, v29
M v[96:99],a[168:171],a[32:35],v[96:99]
G v28,a194
G v29,a198
M v[128:131],a[160:163],a[32:35],v[128:131]
R a[168:171],v5,51200
R a[172:175],v6,51200
M v[128:131],a[164:167],a[36:39],v[128:131]
T a[136:137],v2,16384
T a[138:139],v2,17408
M v[132:135],a[164:167],a[44:47],v[132:135]
buffer_load_dwordx4 v14, s[48:51], s22 offen offset:2048   lds
M v[132:135],a[160:163],a[40:43],v[132:135]
v_lshlrev_b32 v24, 16, v28
v_lshlrev_b32 v25, 16, v29
M v[136:139],a[160:163],a[48:51],v[136:139]
v_and_b32 v28, 0xffff0000, v28
v_and_b32 v29, 0xffff0000, v29
M v[136:139],a[164:167],a[52:55],v[136:139]
G v30,a178
v_lshlrev_b32 v31, 16, v30
M v[140:143],a[164:167],a[60:63],v[140:143]
v_and_b32 v30, 0xffff0000, v30
v_fmac_f32 v16, v31, v24
M v[140:143],a[160:163],a[56:59],v[140:143]
T a[140:141],v2,24576
T a[142:143],v2,25600
M v[144:147],a[160:163],a[64:67],v[144:147]
buffer_load_dwordx4 v15, s[48:51], s22 offen offset:3072   lds
M v[144:147],a[164:167],a[68:71],v[144:147]
SA s22,s22,1048576
v_fmac_f32 v20, v31, v25
v_fmac_f32 v16, v30, v28
M v[148:151],a[164:167],a[76:79],v[148:151]
v_fmac_f32 v20, v30, v29
G v30,a182
M v[148:151],a[160:163],a[72:75],v[148:151]
v_lshlrev_b32 v31, 16, v30
v_and_b32 v30, 0xffff0000, v30
M v[152:155],a[160:163],a[80:83],v[152:155]
v_fmac_f32 v17, v31, v24
v_fmac_f32 v21, v31, v25
M v[152:155],a[164:167],a[84:87],v[152:155]
s_waitcnt lgkmcnt(4)
v_fmac_f32 v17, v30, v28
v_fmac_f32 v21, v30, v29
M v[156:159],a[164:167],a[92:95],v[156:159]
SA m0,s23,0
T a[144:145],v3,16384
T a[146:147],v3,17408
M v[156:159],a[160:163],a[88:91],v[156:159]
buffer_load_dwordx4 v8, s[16:19], s21 offen offset:0  nt lds
M v[188:191],a[168:171],a[88:91],v[188:191]
R a[160:163],v5,53248
R a[164:167],v6,53248
M v[188:191],a[172:175],a[92:95],v[188:191]
G v30,a186
v_lshlrev_b32 v31, 16, v30
M v[184:187],a[172:175],a[84:87],v[184:187]
v_and_b32 v30, 0xffff0000, v30
v_fmac_f32 v18, v31, v24
M v[184:187],a[168:171],a[80:83],v[184:187]
v_fmac_f32 v22, v31, v25
v_fmac_f32 v18, v30, v28
M v[180:183],a[168:171],a[72:75],v[180:183]
v_fmac_f32 v22, v30, v29
G v30,a190
M v[180:183],a[172:175],a[76:79],v[180:183]
L_w_kv11:
s_cbranch_execz L_w_kv15
T a[148:149],v3,24576
T a[150:151],v3,25600
M v[176:179],a[172:175],a[68:71],v[176:179]
buffer_load_dwordx4 v9, s[16:19], s21 offen offset:1024  nt lds
M v[176:179],a[168:171],a[64:67],v[176:179]
v_lshlrev_b32 v31, 16, v30
v_and_b32 v30, 0xffff0000, v30
M v[172:175],a[168:171],a[56:59],v[172:175]
v_fmac_f32 v19, v31, v24
v_fmac_f32 v23, v31, v25
M v[172:175],a[172:175],a[60:63],v[172:175]
v_fmac_f32 v19, v30, v28
v_fmac_f32 v23, v30, v29
M v[168:171],a[172:175],a[52:55],v[168:171]
M v[168:171],a[168:171],a[48:51],v[168:171]
M v[164:167],a[168:171],a[40:43],v[164:167]
s_nop 0
T a[152:153],v4,16384
T a[154:155],v4,17408
M v[164:167],a[172:175],a[44:47],v[164:167]
s_waitcnt lgkmcnt(4)
buffer_load_dwordx4 v10, s[16:19], s21 offen offset:2048  nt lds
M v[160:163],a[172:175],a[36:39],v[160:163]
M v[160:163],a[168:171],a[32:35],v[160:163]
M v[192:195],a[160:163],a[32:35],v[192:195]
R a[168:171],v5,55296
R a[172:175],v6,55296
M v[192:195],a[164:167],a[36:39],v[192:195]
M v[196:199],a[164:167],a[44:47],v[196:199]
M v[196:199],a[160:163],a[40:43],v[196:199]
s_nop 0
T a[156:157],v4,24576
T a[158:159],v4,25600
M v[200:203],a[160:163],a[48:51],v[200:203]
buffer_load_dwordx4 v11, s[16:19], s21 offen offset:3072  nt lds
M v[200:203],a[164:167],a[52:55],v[200:203]
SA s21,s21,128
M v[204:207],a[164:167],a[60:63],v[204:207]
M v[204:207],a[160:163],a[56:59],v[204:207]
M v[208:211],a[160:163],a[64:67],v[208:211]
M v[208:211],a[164:167],a[68:71],v[208:211]
M v[212:215],a[164:167],a[76:79],v[212:215]
M v[212:215],a[160:163],a[72:75],v[212:215]
M v[216:219],a[160:163],a[80:83],v[216:219]
M v[216:219],a[164:167],a[84:87],v[216:219]
s_waitcnt lgkmcnt(2)
M v[220:223],a[164:167],a[92:95],v[220:223]
s_waitcnt vmcnt(16) lgkmcnt(0)
M v[220:223],a[160:163],a[88:91],v[220:223]
s_barrier
M v[252:255],a[168:171],a[88:91],v[252:255]
R a[160:163],v5,0
R a[164:167],v6,0
M v[252:255],a[172:175],a[92:95],v[252:255]
M v[248:251],a[172:175],a[84:87],v[248:251]
M v[248:251],a[168:171],a[80:83],v[248:251]
M v[244:247],a[168:171],a[72:75],v[244:247]
M v[244:247],a[172:175],a[76:79],v[244:247]
M v[240:243],a[172:175],a[68:71],v[240:243]
M v[240:243],a[168:171],a[64:67],v[240:243]
M v[236:239],a[168:171],a[56:59],v[236:239]
M v[236:239],a[172:175],a[60:63],v[236:239]
M v[232:235],a[172:175],a[52:55],v[232:235]
M v[232:235],a[168:171],a[48:51],v[232:235]
M v[228:231],a[168:171],a[40:43],v[228:231]
M v[228:231],a[172:175],a[44:47],v[228:231]
s_waitcnt lgkmcnt(0)
M v[224:227],a[172:175],a[36:39],v[224:227]
M v[224:227],a[168:171],a[32:35],v[224:227]
M a[0:3],a[160:163],a[96:99],a[0:3]
R a[168:171],v5,2048
R a[172:175],v6,2048
M a[0:3],a[164:167],a[100:103],a[0:3]
T a[32:33],v1,32768
T a[34:35],v1,33792
M a[4:7],a[164:167],a[108:111],a[4:7]
SA m0,s24,49152
G v28,a195
G v29,a199
M a[4:7],a[160:163],a[104:107],a[4:7]
buffer_load_dwordx4 v12, s[48:51], s22 offen offset:0   lds
M a[8:11],a[160:163],a[112:115],a[8:11]
v_lshlrev_b32 v24, 16, v28
v_lshlrev_b32 v25, 16, v29
M a[8:11],a[164:167],a[116:119],a[8:11]
v_and_b32 v28, 0xffff0000, v28
v_and_b32 v29, 0xffff0000, v29
M a[12:15],a[164:167],a[124:127],a[12:15]
T a[36:37],v1,40960
T a[38:39],v1,41984
M a[12:15],a[160:163],a[120:123],a[12:15]
G v30,a179
v_lshlrev_b32 v31, 16, v30
M a[16:19],a[160:163],a[128:131],a[16:19]
buffer_load_dwordx4 v13, s[48:51], s22 offen offset:1024   lds
M a[16:19],a[164:167],a[132:135],a[16:19]
v_and_b32 v30, 0xffff0000, v30
v_fmac_f32 v16, v31, v24
M a[20:23],a[164:167],a[140:143],a[20:23]
v_fmac_f32 v20, v31, v25
v_fmac_f32 v16, v30, v28
M a[20:23],a[160:163],a[136:139],a[20:23]
T a[40:41],v2,32768
T a[42:43],v2,33792
M a[24:27],a[160:163],a[144:147],a[24:27]
v_fmac_f32 v20, v30, v29
G v30,a183
M a[24:27],a[164:167],a[148:151],a[24:27]
s_waitcnt lgkmcnt(6)
buffer_load_dwordx4 v14, s[48:51], s22 offen offset:2048   lds
M a[28:31],a[164:167],a[156:159],a[28:31]
v_lshlrev_b32 v31, 16, v30
v_and_b32 v30, 0xffff0000, v30
M a[28:31],a[160:163],a[152:155],a[28:31]
v_fmac_f32 v17, v31, v24
v_fmac_f32 v21, v31, v25
M v[60:63],a[168:171],a[152:155],v[60:63]
R a[160:163],v5,4096
R a[164:167],v6,4096
M v[60:63],a[172:175],a[156:159],v[60:63]
T a[44:45],v2,40960
T a[46:47],v2,41984
M v[56:59],a[172:175],a[148:151],v[56:59]
buffer_load_dwordx4 v15, s[48:51], s22 offen offset:3072   lds
M v[56:59],a[168:171],a[144:147],v[56:59]
s_sub_u32 s22, s22, 1048448
v_fmac_f32 v17, v30, v28
v_fmac_f32 v21, v30, v29
M v[52:55],a[168:171],a[136:139],v[52:55]
G v30,a187
v_lshlrev_b32 v31, 16, v30
M v[52:55],a[172:175],a[140:143],v[52:55]
T a[48:49],v3,32768
T a[50:51],v3,33792
M v[48:51],a[172:175],a[132:135],v[48:51]
SA m0,s23,16384
v_and_b32 v30, 0xffff0000, v30
v_fmac_f32 v18, v31, v24
M v[48:51],a[168:171],a[128:131],v[48:51]
buffer_load_dwordx4 v8, s[16:19], s21 offen offset:0  nt lds
M v[44:47],a[168:171],a[120:123],v[44:47]
v_fmac_f32 v22, v31, v25
v_fmac_f32 v18, v30, v28
M v[44:47],a[172:175],a[124:127],v[44:47]
v_fmac_f32 v22, v30, v29
G v30,a191
M v[40:43],a[172:175],a[116:119],v[40:43]
T a[52:53],v3,40960
T a[54:55],v3,41984
M v[40:43],a[168:171],a[112:115],v[40:43]
v_lshlrev_b32 v31, 16, v30
v_and_b32 v30, 0xffff0000, v30
M v[36:39],a[168:171],a[104:107],v[36:39]
buffer_load_dwordx4 v9, s[16:19], s21 offen offset:1024  nt lds
M v[36:39],a[172:175],a[108:111],v[36:39]
s_waitcnt lgkmcnt(6)
v_fmac_f32 v19, v31, v24
v_fmac_f32 v23, v31, v25
M v[32:35],a[172:175],a[100:103],v[32:35]
v_fmac_f32 v19, v30, v28
v_fmac_f32 v23, v30, v29
M v[32:35],a[168:171],a[96:99],v[32:35]
T a[56:57],v4,32768
T a[58:59],v4,33792
M v[64:67],a[160:163],a[96:99],v[64:67]
R a[168:171],v5,6144
R a[172:175],v6,6144
M v[64:67],a[164:167],a[100:103],v[64:67]
buffer_load_dwordx4 v10, s[16:19], s21 offen offset:2048  nt lds
M v[68:71],a[164:167],a[108:111],v[68:71]
v_permlane32_swap_b32 v16, v18
M v[68:71],a[160:163],a[104:107],v[68:71]
v_permlane32_swap_b32 v17, v19
M v[72:75],a[160:163],a[112:115],v[72:75]
s_nop 0
T a[60:61],v4,40960
T a[62:63],v4,41984
M v[72:75],a[164:167],a[116:119],v[72:75]
v_permlane32_swap_b32 v20, v22
M v[76:79],a[164:167],a[124:127],v[76:79]
buffer_load_dwordx4 v11, s[16:19], s21 offen offset:3072  nt lds
M v[76:79],a[160:163],a[120:123],v[76:79]
SA s21,s21,524160
v_permlane32_swap_b32 v21, v23
M v[80:83],a[160:163],a[128:131],v[80:83]
AF v16,v16,v18
AF v17,v17,v19
M v[80:83],a[164:167],a[132:135],v[80:83]
AF v20,v20,v22
AF v21,v21,v23
M v[84:87],a[164:167],a[140:143],v[84:87]
v_lshrrev_b32 v28, 4, v0
M v[84:87],a[160:163],a[136:139],v[84:87]
v_permlane16_swap_b32 v16, v17
M v[88:91],a[160:163],a[144:147],v[88:91]
v_permlane16_swap_b32 v20, v21
M v[88:91],a[164:167],a[148:151],v[88:91]
s_waitcnt lgkmcnt(2)
AF v16,v16,v17
AF v20,v20,v21
M v[92:95],a[164:167],a[156:159],v[92:95]
s_waitcnt vmcnt(16) lgkmcnt(0)
v_add_u32 v29, s67, v28
v_add_f32 v16, v16, v16 row_ror:8 row_mask:0xf bank_mask:0xf
M v[92:95],a[160:163],a[152:155],v[92:95]
s_barrier
M v[124:127],a[168:171],a[152:155],v[124:127]
R a[160:163],v5,16384
R a[164:167],v6,16384
M v[124:127],a[172:175],a[156:159],v[124:127]
v_add_f32 v20, v20, v20 row_ror:8 row_mask:0xf bank_mask:0xf
v_add_f32 v16, v16, v16 row_ror:4 row_mask:0xf bank_mask:0xf
M v[120:123],a[172:175],a[148:151],v[120:123]
SA m0,s24,0
T a[64:65],v1,49152
T a[66:67],v1,50176
M v[120:123],a[168:171],a[144:147],v[120:123]
buffer_load_dwordx4 v12, s[48:51], s22 offen offset:0   lds
M v[116:119],a[168:171],a[136:139],v[116:119]
v_add_f32 v20, v20, v20 row_ror:4 row_mask:0xf bank_mask:0xf
v_add_f32 v16, v16, v16 row_ror:2 row_mask:0xf bank_mask:0xf
M v[116:119],a[172:175],a[140:143],v[116:119]
v_add_f32 v20, v20, v20 row_ror:2 row_mask:0xf bank_mask:0xf
v_add_f32 v16, v16, v16 row_ror:1 row_mask:0xf bank_mask:0xf
M v[112:115],a[172:175],a[132:135],v[112:115]
v_add_f32 v20, v20, v20 row_ror:1 row_mask:0xf bank_mask:0xf
v_ashrrev_i32 v30, 31, v16
M v[112:115],a[168:171],a[128:131],v[112:115]
v_or_b32 v30, 0x80000000, v30
v_xor_b32 v30, v30, v16
M v[108:111],a[168:171],a[120:123],v[108:111]
v_and_b32 v30, 0xfffff800, v30
v_sub_u32 v29, 2047, v29
M v[108:111],a[172:175],a[124:127],v[108:111]
T a[68:69],v1,57344
T a[70:71],v1,58368
M v[104:107],a[172:175],a[116:119],v[104:107]
buffer_load_dwordx4 v13, s[48:51], s22 offen offset:1024   lds
M v[104:107],a[168:171],a[112:115],v[104:107]
v_or_b32 v30, v30, v29
v_max_u32 v30, 1, v30
M v[100:103],a[168:171],a[104:107],v[100:103]
MF v21,0xbfb8aa3b,v20
M v[100:103],a[172:175],a[108:111],v[100:103]
s_waitcnt lgkmcnt(4)
E v21,v21
M v[96:99],a[172:175],a[100:103],v[96:99]
AF v21,1.0,v21
M v[96:99],a[168:171],a[96:99],v[96:99]
v_rcp_f32 v20, v21
M v[128:131],a[160:163],a[96:99],v[128:131]
s_lshl_b32 s72, s20, 4
R a[168:171],v5,18432
R a[172:175],v6,18432
M v[128:131],a[164:167],a[100:103],v[128:131]
SA s72,s72,163584
T a[72:73],v2,49152
T a[74:75],v2,50176
M v[132:135],a[164:167],a[108:111],v[132:135]
buffer_load_dwordx4 v14, s[48:51], s22 offen offset:2048   lds
M v[132:135],a[160:163],a[104:107],v[132:135]
v_lshl_add_u32 v28, v28, 2, s72
ds_write_b32 v28, v30
M v[136:139],a[160:163],a[112:115],v[136:139]
ds_write_b32 v28, v16 offset:64
ds_write_b32 v28, v20 offset:128
M v[136:139],a[164:167],a[116:119],v[136:139]
M v[140:143],a[164:167],a[124:127],v[140:143]
M v[140:143],a[160:163],a[120:123],v[140:143]
s_nop 0
T a[76:77],v2,57344
T a[78:79],v2,58368
M v[144:147],a[160:163],a[128:131],v[144:147]
buffer_load_dwordx4 v15, s[48:51], s22 offen offset:3072   lds
M v[144:147],a[164:167],a[132:135],v[144:147]
SA s22,s22,1048576
M v[148:151],a[164:167],a[140:143],v[148:151]
M v[148:151],a[160:163],a[136:139],v[148:151]
M v[152:155],a[160:163],a[144:147],v[152:155]
M v[152:155],a[164:167],a[148:151],v[152:155]
s_waitcnt lgkmcnt(7)
M v[156:159],a[164:167],a[156:159],v[156:159]
SA m0,s23,32768
T a[80:81],v3,49152
T a[82:83],v3,50176
M v[156:159],a[160:163],a[152:155],v[156:159]
buffer_load_dwordx4 v8, s[16:19], s21 offen offset:0  nt lds
M v[188:191],a[168:171],a[152:155],v[188:191]
R a[160:163],v5,20480
R a[164:167],v6,20480
M v[188:191],a[172:175],a[156:159],v[188:191]
M v[184:187],a[172:175],a[148:151],v[184:187]
M v[184:187],a[168:171],a[144:147],v[184:187]
M v[180:183],a[168:171],a[136:139],v[180:183]
M v[180:183],a[172:175],a[140:143],v[180:183]
s_nop 0
T a[84:85],v3,57344
T a[86:87],v3,58368
M v[176:179],a[172:175],a[132:135],v[176:179]
buffer_load_dwordx4 v9, s[16:19], s21 offen offset:1024  nt lds
M v[176:179],a[168:171],a[128:131],v[176:179]
M v[172:175],a[168:171],a[120:123],v[172:175]
M v[172:175],a[172:175],a[124:127],v[172:175]
M v[168:171],a[172:175],a[116:119],v[168:171]
M v[168:171],a[168:171],a[112:115],v[168:171]
M v[164:167],a[168:171],a[104:107],v[164:167]
s_nop 0
T a[88:89],v4,49152
T a[90:91],v4,50176
M v[164:167],a[172:175],a[108:111],v[164:167]
s_waitcnt lgkmcnt(4)
buffer_load_dwordx4 v10, s[16:19], s21 offen offset:2048  nt lds
M v[160:163],a[172:175],a[100:103],v[160:163]
M v[160:163],a[168:171],a[96:99],v[160:163]
M v[192:195],a[160:163],a[96:99],v[192:195]
R a[168:171],v5,22528
R a[172:175],v6,22528
M v[192:195],a[164:167],a[100:103],v[192:195]
M v[196:199],a[164:167],a[108:111],v[196:199]
M v[196:199],a[160:163],a[104:107],v[196:199]
s_nop 0
T a[92:93],v4,57344
T a[94:95],v4,58368
M v[200:203],a[160:163],a[112:115],v[200:203]
buffer_load_dwordx4 v11, s[16:19], s21 offen offset:3072  nt lds
M v[200:203],a[164:167],a[116:119],v[200:203]
SA s21,s21,128
M v[204:207],a[164:167],a[124:127],v[204:207]
M v[204:207],a[160:163],a[120:123],v[204:207]
M v[208:211],a[160:163],a[128:131],v[208:211]
M v[208:211],a[164:167],a[132:135],v[208:211]
M v[212:215],a[164:167],a[140:143],v[212:215]
M v[212:215],a[160:163],a[136:139],v[212:215]
M v[216:219],a[160:163],a[144:147],v[216:219]
M v[216:219],a[164:167],a[148:151],v[216:219]
s_waitcnt lgkmcnt(2)
M v[220:223],a[164:167],a[156:159],v[220:223]
s_waitcnt vmcnt(16) lgkmcnt(0)
M v[220:223],a[160:163],a[152:155],v[220:223]
s_barrier
M v[252:255],a[168:171],a[152:155],v[252:255]
R a[160:163],v5,32768
R a[164:167],v6,32768
M v[252:255],a[172:175],a[156:159],v[252:255]
M v[248:251],a[172:175],a[148:151],v[248:251]
M v[248:251],a[168:171],a[144:147],v[248:251]
M v[244:247],a[168:171],a[136:139],v[244:247]
M v[244:247],a[172:175],a[140:143],v[244:247]
M v[240:243],a[172:175],a[132:135],v[240:243]
M v[240:243],a[168:171],a[128:131],v[240:243]
M v[236:239],a[168:171],a[120:123],v[236:239]
M v[236:239],a[172:175],a[124:127],v[236:239]
M v[232:235],a[172:175],a[116:119],v[232:235]
M v[232:235],a[168:171],a[112:115],v[232:235]
M v[228:231],a[168:171],a[104:107],v[228:231]
M v[228:231],a[172:175],a[108:111],v[228:231]
s_waitcnt lgkmcnt(0)
M v[224:227],a[172:175],a[100:103],v[224:227]
M v[224:227],a[168:171],a[96:99],v[224:227]
M a[0:3],a[160:163],a[32:35],a[0:3]
R a[168:171],v5,34816
R a[172:175],v6,34816
M a[0:3],a[164:167],a[36:39],a[0:3]
T a[96:97],v1,0
T a[98:99],v1,1024
M a[4:7],a[164:167],a[44:47],a[4:7]
SA m0,s24,16384
M a[4:7],a[160:163],a[40:43],a[4:7]
buffer_load_dwordx4 v12, s[48:51], s22 offen offset:0   lds
M a[8:11],a[160:163],a[48:51],a[8:11]
v_and_b32 v20, 31, v0
M a[8:11],a[164:167],a[52:55],a[8:11]
v_lshlrev_b32 v20, 2, v20
M a[12:15],a[164:167],a[60:63],a[12:15]
s_nop 0
T a[100:101],v1,8192
T a[102:103],v1,9216
M a[12:15],a[160:163],a[56:59],a[12:15]
v_add_u32 v21, 163584, v20
M a[16:19],a[160:163],a[64:67],a[16:19]
buffer_load_dwordx4 v13, s[48:51], s22 offen offset:1024   lds
M a[16:19],a[164:167],a[68:71],a[16:19]
ds_read_b32 v19, v21
M a[20:23],a[164:167],a[76:79],a[20:23]
ds_read_b32 v21, v21 offset:64
M a[20:23],a[160:163],a[72:75],a[20:23]
s_min_u32 s64, s20, 1
T a[104:105],v2,0
T a[106:107],v2,1024
M a[24:27],a[160:163],a[80:83],a[24:27]
s_lshl_b32 s64, s64, 29
v_and_b32 v22, 32, v0
M a[24:27],a[164:167],a[84:87],a[24:27]
s_waitcnt lgkmcnt(8)
buffer_load_dwordx4 v14, s[48:51], s22 offen offset:2048   lds
M a[28:31],a[164:167],a[92:95],a[28:31]
v_lshl_or_b32 v20, v22, 24, v20
M a[28:31],a[160:163],a[88:91],a[28:31]
v_or_b32 v20, s64, v20
M v[60:63],a[168:171],a[88:91],v[60:63]
R a[160:163],v5,36864
R a[164:167],v6,36864
M v[60:63],a[172:175],a[92:95],v[60:63]
T a[108:109],v2,8192
T a[110:111],v2,9216
M v[56:59],a[172:175],a[84:87],v[56:59]
buffer_load_dwordx4 v15, s[48:51], s22 offen offset:3072   lds
M v[56:59],a[168:171],a[80:83],v[56:59]
s_sub_u32 s22, s22, 1048448
v_and_b32 v22, 16, v0
M v[52:55],a[168:171],a[72:75],v[52:55]
v_lshl_or_b32 v18, v22, 25, v20
s_and_b32 s27, s42, 7
M v[52:55],a[172:175],a[76:79],v[52:55]
s_lshl_b32 s72, s30, 7
T a[112:113],v3,0
T a[114:115],v3,1024
M v[48:51],a[172:175],a[68:71],v[48:51]
SA m0,s23,49152
SA s72,s72,104857600
s_lshl_b32 s64, s41, 3
M v[48:51],a[168:171],a[64:67],v[48:51]
SA s27,s27,s64
buffer_load_dwordx4 v8, s[16:19], s21 offen offset:0  nt lds
M v[44:47],a[168:171],a[56:59],v[44:47]
s_lshl_b32 s27, s27, 2
M v[44:47],a[172:175],a[60:63],v[44:47]
SA s27,s27,s20
M v[40:43],a[172:175],a[52:55],v[40:43]
s_mul_i32 s27, s27, 7168
T a[116:117],v3,8192
T a[118:119],v3,9216
M v[40:43],a[168:171],a[48:51],v[40:43]
s_mov_b32 s60, s90
M v[36:39],a[168:171],a[40:43],v[36:39]
s_and_b32 s61, s91, 0xffff
buffer_load_dwordx4 v9, s[16:19], s21 offen offset:1024  nt lds
M v[36:39],a[172:175],a[44:47],v[36:39]
s_waitcnt lgkmcnt(6)
buffer_store_dword v21, v20, s[8:11], s72 offen sc1
M v[32:35],a[172:175],a[36:39],v[32:35]
s_mov_b32 s62, 3670016
M v[32:35],a[168:171],a[32:35],v[32:35]
s_mov_b32 s63, 0x20000
T a[120:121],v4,0
T a[122:123],v4,1024
M v[64:67],a[160:163],a[32:35],v[64:67]
R a[168:171],v5,38912
R a[172:175],v6,38912
M v[64:67],a[164:167],a[36:39],v[64:67]
buffer_load_dwordx4 v10, s[16:19], s21 offen offset:2048  nt lds
M v[68:71],a[164:167],a[44:47],v[68:71]
M v[68:71],a[160:163],a[40:43],v[68:71]
M v[72:75],a[160:163],a[48:51],v[72:75]
s_nop 0
T a[124:125],v4,8192
T a[126:127],v4,9216
M v[72:75],a[164:167],a[52:55],v[72:75]
M v[76:79],a[164:167],a[60:63],v[76:79]
buffer_load_dwordx4 v11, s[16:19], s21 offen offset:3072  nt lds
M v[76:79],a[160:163],a[56:59],v[76:79]
SA s21,s21,524160
M v[80:83],a[160:163],a[64:67],v[80:83]
M v[80:83],a[164:167],a[68:71],v[80:83]
M v[84:87],a[164:167],a[76:79],v[84:87]
M v[84:87],a[160:163],a[72:75],v[84:87]
M v[88:91],a[160:163],a[80:83],v[88:91]
M v[88:91],a[164:167],a[84:87],v[88:91]
s_waitcnt lgkmcnt(2)
M v[92:95],a[164:167],a[92:95],v[92:95]
s_waitcnt vmcnt(17) lgkmcnt(0)
M v[92:95],a[160:163],a[88:91],v[92:95]
s_barrier
M v[124:127],a[168:171],a[88:91],v[124:127]
R a[160:163],v5,49152
R a[164:167],v6,49152
M v[124:127],a[172:175],a[92:95],v[124:127]
M v[120:123],a[172:175],a[84:87],v[120:123]
SA m0,s24,32768
T a[128:129],v1,16384
T a[130:131],v1,17408
M v[120:123],a[168:171],a[80:83],v[120:123]
buffer_load_dwordx4 v12, s[48:51], s22 offen offset:0   lds
M v[116:119],a[168:171],a[72:75],v[116:119]
v_min_u32 v16, 40, v0
v_lshlrev_b32 v16, 2, v16
M v[116:119],a[172:175],a[76:79],v[116:119]
buffer_load_dword v17, v16, s[12:15], 0 offen sc1
M v[112:115],a[172:175],a[68:71],v[112:115]
M v[112:115],a[168:171],a[64:67],v[112:115]
M v[108:111],a[168:171],a[56:59],v[108:111]
M v[108:111],a[172:175],a[60:63],v[108:111]
s_nop 0
T a[132:133],v1,24576
T a[134:135],v1,25600
M v[104:107],a[172:175],a[52:55],v[104:107]
buffer_load_dwordx4 v13, s[48:51], s22 offen offset:1024   lds
M v[104:107],a[168:171],a[48:51],v[104:107]
M v[100:103],a[168:171],a[40:43],v[100:103]
M v[100:103],a[172:175],a[44:47],v[100:103]
s_waitcnt lgkmcnt(4)
M v[96:99],a[172:175],a[36:39],v[96:99]
M v[96:99],a[168:171],a[32:35],v[96:99]
M v[128:131],a[160:163],a[32:35],v[128:131]
R a[168:171],v5,51200
R a[172:175],v6,51200
M v[128:131],a[164:167],a[36:39],v[128:131]
T a[136:137],v2,16384
T a[138:139],v2,17408
M v[132:135],a[164:167],a[44:47],v[132:135]
buffer_load_dwordx4 v14, s[48:51], s22 offen offset:2048   lds
M v[132:135],a[160:163],a[40:43],v[132:135]
M v[136:139],a[160:163],a[48:51],v[136:139]
M v[136:139],a[164:167],a[52:55],v[136:139]
M v[140:143],a[164:167],a[60:63],v[140:143]
M v[140:143],a[160:163],a[56:59],v[140:143]
s_nop 0
T a[140:141],v2,24576
T a[142:143],v2,25600
M v[144:147],a[160:163],a[64:67],v[144:147]
buffer_load_dwordx4 v15, s[48:51], s22 offen offset:3072   lds
M v[144:147],a[164:167],a[68:71],v[144:147]
SA s22,s22,1048576
M v[148:151],a[164:167],a[76:79],v[148:151]
M v[148:151],a[160:163],a[72:75],v[148:151]
M v[152:155],a[160:163],a[80:83],v[152:155]
M v[152:155],a[164:167],a[84:87],v[152:155]
s_waitcnt lgkmcnt(4)
M v[156:159],a[164:167],a[92:95],v[156:159]
SA m0,s23,0
T a[144:145],v3,16384
T a[146:147],v3,17408
M v[156:159],a[160:163],a[88:91],v[156:159]
buffer_load_dwordx4 v8, s[16:19], s21 offen offset:0  nt lds
M v[188:191],a[168:171],a[88:91],v[188:191]
R a[160:163],v5,53248
R a[164:167],v6,53248
M v[188:191],a[172:175],a[92:95],v[188:191]
buffer_load_dword a240, v26, s[60:63], s27 offen offset:0
M v[184:187],a[172:175],a[84:87],v[184:187]
SA s27,s27,2048
M v[184:187],a[168:171],a[80:83],v[184:187]
M v[180:183],a[168:171],a[72:75],v[180:183]
M v[180:183],a[172:175],a[76:79],v[180:183]
s_nop 0
T a[148:149],v3,24576
T a[150:151],v3,25600
M v[176:179],a[172:175],a[68:71],v[176:179]
buffer_load_dwordx4 v9, s[16:19], s21 offen offset:1024  nt lds
M v[176:179],a[168:171],a[64:67],v[176:179]
M v[172:175],a[168:171],a[56:59],v[172:175]
M v[172:175],a[172:175],a[60:63],v[172:175]
M v[168:171],a[172:175],a[52:55],v[168:171]
M v[168:171],a[168:171],a[48:51],v[168:171]
M v[164:167],a[168:171],a[40:43],v[164:167]
s_nop 0
T a[152:153],v4,16384
T a[154:155],v4,17408
M v[164:167],a[172:175],a[44:47],v[164:167]
s_waitcnt lgkmcnt(4)
buffer_load_dwordx4 v10, s[16:19], s21 offen offset:2048  nt lds
M v[160:163],a[172:175],a[36:39],v[160:163]
M v[160:163],a[168:171],a[32:35],v[160:163]
M v[192:195],a[160:163],a[32:35],v[192:195]
L_w_kv12:
s_cbranch_execz L_w_kv16
R a[168:171],v5,55296
R a[172:175],v6,55296
M v[192:195],a[164:167],a[36:39],v[192:195]
M v[196:199],a[164:167],a[44:47],v[196:199]
M v[196:199],a[160:163],a[40:43],v[196:199]
s_nop 0
T a[156:157],v4,24576
T a[158:159],v4,25600
M v[200:203],a[160:163],a[48:51],v[200:203]
buffer_load_dwordx4 v11, s[16:19], s21 offen offset:3072  nt lds
M v[200:203],a[164:167],a[52:55],v[200:203]
SA s21,s21,128
M v[204:207],a[164:167],a[60:63],v[204:207]
M v[204:207],a[160:163],a[56:59],v[204:207]
M v[208:211],a[160:163],a[64:67],v[208:211]
M v[208:211],a[164:167],a[68:71],v[208:211]
M v[212:215],a[164:167],a[76:79],v[212:215]
M v[212:215],a[160:163],a[72:75],v[212:215]
M v[216:219],a[160:163],a[80:83],v[216:219]
M v[216:219],a[164:167],a[84:87],v[216:219]
s_waitcnt lgkmcnt(2)
M v[220:223],a[164:167],a[92:95],v[220:223]
s_waitcnt vmcnt(19) lgkmcnt(0)
M v[220:223],a[160:163],a[88:91],v[220:223]
s_barrier
M v[252:255],a[168:171],a[88:91],v[252:255]
R a[160:163],v5,0
R a[164:167],v6,0
M v[252:255],a[172:175],a[92:95],v[252:255]
M v[248:251],a[172:175],a[84:87],v[248:251]
M v[248:251],a[168:171],a[80:83],v[248:251]
M v[244:247],a[168:171],a[72:75],v[244:247]
M v[244:247],a[172:175],a[76:79],v[244:247]
M v[240:243],a[172:175],a[68:71],v[240:243]
M v[240:243],a[168:171],a[64:67],v[240:243]
M v[236:239],a[168:171],a[56:59],v[236:239]
M v[236:239],a[172:175],a[60:63],v[236:239]
M v[232:235],a[172:175],a[52:55],v[232:235]
M v[232:235],a[168:171],a[48:51],v[232:235]
M v[228:231],a[168:171],a[40:43],v[228:231]
M v[228:231],a[172:175],a[44:47],v[228:231]
s_waitcnt lgkmcnt(0)
M v[224:227],a[172:175],a[36:39],v[224:227]
M v[224:227],a[168:171],a[32:35],v[224:227]
M a[0:3],a[160:163],a[96:99],a[0:3]
R a[168:171],v5,2048
R a[172:175],v6,2048
M a[0:3],a[164:167],a[100:103],a[0:3]
T a[32:33],v1,32768
T a[34:35],v1,33792
M a[4:7],a[164:167],a[108:111],a[4:7]
SA m0,s24,49152
M a[4:7],a[160:163],a[104:107],a[4:7]
buffer_load_dwordx4 v12, s[48:51], s22 offen offset:0   lds
M a[8:11],a[160:163],a[112:115],a[8:11]
M a[8:11],a[164:167],a[116:119],a[8:11]
M a[12:15],a[164:167],a[124:127],a[12:15]
s_nop 0
T a[36:37],v1,40960
T a[38:39],v1,41984
M a[12:15],a[160:163],a[120:123],a[12:15]
M a[16:19],a[160:163],a[128:131],a[16:19]
buffer_load_dwordx4 v13, s[48:51], s22 offen offset:1024   lds
M a[16:19],a[164:167],a[132:135],a[16:19]
M a[20:23],a[164:167],a[140:143],a[20:23]
M a[20:23],a[160:163],a[136:139],a[20:23]
s_nop 0
T a[40:41],v2,32768
T a[42:43],v2,33792
M a[24:27],a[160:163],a[144:147],a[24:27]
M a[24:27],a[164:167],a[148:151],a[24:27]
s_waitcnt lgkmcnt(6)
buffer_load_dwordx4 v14, s[48:51], s22 offen offset:2048   lds
M a[28:31],a[164:167],a[156:159],a[28:31]
M a[28:31],a[160:163],a[152:155],a[28:31]
M v[60:63],a[168:171],a[152:155],v[60:63]
R a[160:163],v5,4096
R a[164:167],v6,4096
M v[60:63],a[172:175],a[156:159],v[60:63]
T a[44:45],v2,40960
T a[46:47],v2,41984
M v[56:59],a[172:175],a[148:151],v[56:59]
buffer_load_dwordx4 v15, s[48:51], s22 offen offset:3072   lds
M v[56:59],a[168:171],a[144:147],v[56:59]
s_sub_u32 s22, s22, 1048448
M v[52:55],a[168:171],a[136:139],v[52:55]
M v[52:55],a[172:175],a[140:143],v[52:55]
s_nop 0
T a[48:49],v3,32768
T a[50:51],v3,33792
M v[48:51],a[172:175],a[132:135],v[48:51]
SA m0,s23,16384
M v[48:51],a[168:171],a[128:131],v[48:51]
buffer_load_dwordx4 v8, s[16:19], s21 offen offset:0  nt lds
M v[44:47],a[168:171],a[120:123],v[44:47]
M v[44:47],a[172:175],a[124:127],v[44:47]
M v[40:43],a[172:175],a[116:119],v[40:43]
s_nop 0
T a[52:53],v3,40960
T a[54:55],v3,41984
M v[40:43],a[168:171],a[112:115],v[40:43]
M v[36:39],a[168:171],a[104:107],v[36:39]
buffer_load_dwordx4 v9, s[16:19], s21 offen offset:1024  nt lds
M v[36:39],a[172:175],a[108:111],v[36:39]
s_waitcnt lgkmcnt(6)
M v[32:35],a[172:175],a[100:103],v[32:35]
M v[32:35],a[168:171],a[96:99],v[32:35]
s_nop 0
T a[56:57],v4,32768
T a[58:59],v4,33792
M v[64:67],a[160:163],a[96:99],v[64:67]
R a[168:171],v5,6144
R a[172:175],v6,6144
M v[64:67],a[164:167],a[100:103],v[64:67]
buffer_load_dwordx4 v10, s[16:19], s21 offen offset:2048  nt lds
M v[68:71],a[164:167],a[108:111],v[68:71]
M v[68:71],a[160:163],a[104:107],v[68:71]
M v[72:75],a[160:163],a[112:115],v[72:75]
s_nop 0
T a[60:61],v4,40960
T a[62:63],v4,41984
M v[72:75],a[164:167],a[116:119],v[72:75]
M v[76:79],a[164:167],a[124:127],v[76:79]
buffer_load_dwordx4 v11, s[16:19], s21 offen offset:3072  nt lds
M v[76:79],a[160:163],a[120:123],v[76:79]
SA s21,s21,524160
M v[80:83],a[160:163],a[128:131],v[80:83]
M v[80:83],a[164:167],a[132:135],v[80:83]
M v[84:87],a[164:167],a[140:143],v[84:87]
M v[84:87],a[160:163],a[136:139],v[84:87]
M v[88:91],a[160:163],a[144:147],v[88:91]
M v[88:91],a[164:167],a[148:151],v[88:91]
s_waitcnt lgkmcnt(2)
M v[92:95],a[164:167],a[156:159],v[92:95]
s_waitcnt vmcnt(18) lgkmcnt(0)
M v[92:95],a[160:163],a[152:155],v[92:95]
s_barrier
M v[124:127],a[168:171],a[152:155],v[124:127]
R a[160:163],v5,16384
R a[164:167],v6,16384
M v[124:127],a[172:175],a[156:159],v[124:127]
M v[120:123],a[172:175],a[148:151],v[120:123]
SA m0,s24,0
T a[64:65],v1,49152
T a[66:67],v1,50176
M v[120:123],a[168:171],a[144:147],v[120:123]
buffer_load_dwordx4 v12, s[48:51], s22 offen offset:0   lds
M v[116:119],a[168:171],a[136:139],v[116:119]
M v[116:119],a[172:175],a[140:143],v[116:119]
M v[112:115],a[172:175],a[132:135],v[112:115]
M v[112:115],a[168:171],a[128:131],v[112:115]
M v[108:111],a[168:171],a[120:123],v[108:111]
M v[108:111],a[172:175],a[124:127],v[108:111]
s_nop 0
T a[68:69],v1,57344
T a[70:71],v1,58368
M v[104:107],a[172:175],a[116:119],v[104:107]
buffer_load_dwordx4 v13, s[48:51], s22 offen offset:1024   lds
M v[104:107],a[168:171],a[112:115],v[104:107]
M v[100:103],a[168:171],a[104:107],v[100:103]
M v[100:103],a[172:175],a[108:111],v[100:103]
s_waitcnt lgkmcnt(4)
M v[96:99],a[172:175],a[100:103],v[96:99]
M v[96:99],a[168:171],a[96:99],v[96:99]
M v[128:131],a[160:163],a[96:99],v[128:131]
R a[168:171],v5,18432
R a[172:175],v6,18432
M v[128:131],a[164:167],a[100:103],v[128:131]
T a[72:73],v2,49152
T a[74:75],v2,50176
M v[132:135],a[164:167],a[108:111],v[132:135]
buffer_load_dwordx4 v14, s[48:51], s22 offen offset:2048   lds
M v[132:135],a[160:163],a[104:107],v[132:135]
M v[136:139],a[160:163],a[112:115],v[136:139]
M v[136:139],a[164:167],a[116:119],v[136:139]
M v[140:143],a[164:167],a[124:127],v[140:143]
M v[140:143],a[160:163],a[120:123],v[140:143]
s_nop 0
T a[76:77],v2,57344
T a[78:79],v2,58368
M v[144:147],a[160:163],a[128:131],v[144:147]
buffer_load_dwordx4 v15, s[48:51], s22 offen offset:3072   lds
M v[144:147],a[164:167],a[132:135],v[144:147]
SA s22,s22,1048576
M v[148:151],a[164:167],a[140:143],v[148:151]
M v[148:151],a[160:163],a[136:139],v[148:151]
M v[152:155],a[160:163],a[144:147],v[152:155]
M v[152:155],a[164:167],a[148:151],v[152:155]
s_waitcnt lgkmcnt(4)
M v[156:159],a[164:167],a[156:159],v[156:159]
SA m0,s23,32768
T a[80:81],v3,49152
T a[82:83],v3,50176
M v[156:159],a[160:163],a[152:155],v[156:159]
buffer_load_dwordx4 v8, s[16:19], s21 offen offset:0  nt lds
M v[188:191],a[168:171],a[152:155],v[188:191]
R a[160:163],v5,20480
R a[164:167],v6,20480
M v[188:191],a[172:175],a[156:159],v[188:191]
buffer_load_dword a240, v26, s[60:63], s27 offen offset:0
M v[184:187],a[172:175],a[148:151],v[184:187]
SA s27,s27,2048
M v[184:187],a[168:171],a[144:147],v[184:187]
M v[180:183],a[168:171],a[136:139],v[180:183]
M v[180:183],a[172:175],a[140:143],v[180:183]
s_nop 0
T a[84:85],v3,57344
T a[86:87],v3,58368
M v[176:179],a[172:175],a[132:135],v[176:179]
buffer_load_dwordx4 v9, s[16:19], s21 offen offset:1024  nt lds
M v[176:179],a[168:171],a[128:131],v[176:179]
M v[172:175],a[168:171],a[120:123],v[172:175]
M v[172:175],a[172:175],a[124:127],v[172:175]
M v[168:171],a[172:175],a[116:119],v[168:171]
M v[168:171],a[168:171],a[112:115],v[168:171]
M v[164:167],a[168:171],a[104:107],v[164:167]
s_nop 0
T a[88:89],v4,49152
T a[90:91],v4,50176
M v[164:167],a[172:175],a[108:111],v[164:167]
s_waitcnt lgkmcnt(4)
buffer_load_dwordx4 v10, s[16:19], s21 offen offset:2048  nt lds
M v[160:163],a[172:175],a[100:103],v[160:163]
M v[160:163],a[168:171],a[96:99],v[160:163]
M v[192:195],a[160:163],a[96:99],v[192:195]
R a[168:171],v5,22528
R a[172:175],v6,22528
M v[192:195],a[164:167],a[100:103],v[192:195]
M v[196:199],a[164:167],a[108:111],v[196:199]
M v[196:199],a[160:163],a[104:107],v[196:199]
s_nop 0
T a[92:93],v4,57344
T a[94:95],v4,58368
M v[200:203],a[160:163],a[112:115],v[200:203]
buffer_load_dwordx4 v11, s[16:19], s21 offen offset:3072  nt lds
M v[200:203],a[164:167],a[116:119],v[200:203]
SA s21,s21,128
M v[204:207],a[164:167],a[124:127],v[204:207]
M v[204:207],a[160:163],a[120:123],v[204:207]
M v[208:211],a[160:163],a[128:131],v[208:211]
M v[208:211],a[164:167],a[132:135],v[208:211]
M v[212:215],a[164:167],a[140:143],v[212:215]
M v[212:215],a[160:163],a[136:139],v[212:215]
M v[216:219],a[160:163],a[144:147],v[216:219]
M v[216:219],a[164:167],a[148:151],v[216:219]
s_waitcnt lgkmcnt(2)
M v[220:223],a[164:167],a[156:159],v[220:223]
s_waitcnt vmcnt(17) lgkmcnt(0)
M v[220:223],a[160:163],a[152:155],v[220:223]
s_barrier
M v[252:255],a[168:171],a[152:155],v[252:255]
R a[160:163],v5,32768
R a[164:167],v6,32768
M v[252:255],a[172:175],a[156:159],v[252:255]
v_cmp_ne_u32 vcc, 1, v17
M v[248:251],a[172:175],a[148:151],v[248:251]
s_nop 0
M v[248:251],a[168:171],a[144:147],v[248:251]
s_cbranch_vccnz L_zs1
L_zr1:
M v[244:247],a[168:171],a[136:139],v[244:247]
M v[244:247],a[172:175],a[140:143],v[244:247]
s_lshl_b32 s72, s30, 6
M v[240:243],a[172:175],a[132:135],v[240:243]
SA s72,s72,104914944
M v[240:243],a[168:171],a[128:131],v[240:243]
buffer_store_dword v19, v18, s[8:11], s72 offen sc1
M v[236:239],a[168:171],a[120:123],v[236:239]
M v[236:239],a[172:175],a[124:127],v[236:239]
M v[232:235],a[172:175],a[116:119],v[232:235]
M v[232:235],a[168:171],a[112:115],v[232:235]
M v[228:231],a[168:171],a[104:107],v[228:231]
M v[228:231],a[172:175],a[108:111],v[228:231]
s_waitcnt lgkmcnt(0)
M v[224:227],a[172:175],a[100:103],v[224:227]
M v[224:227],a[168:171],a[96:99],v[224:227]
M a[0:3],a[160:163],a[32:35],a[0:3]
R a[168:171],v5,34816
R a[172:175],v6,34816
M a[0:3],a[164:167],a[36:39],a[0:3]
T a[96:97],v1,0
T a[98:99],v1,1024
M a[4:7],a[164:167],a[44:47],a[4:7]
SA m0,s24,16384
M a[4:7],a[160:163],a[40:43],a[4:7]
buffer_load_dwordx4 v12, s[48:51], s22 offen offset:0   lds
M a[8:11],a[160:163],a[48:51],a[8:11]
M a[8:11],a[164:167],a[52:55],a[8:11]
s_mul_i32 s64, s41, 229376
M a[12:15],a[164:167],a[60:63],a[12:15]
SA s72,s90,s64
T a[100:101],v1,8192
T a[102:103],v1,9216
M a[12:15],a[160:163],a[56:59],a[12:15]
s_addc_u32 s73, s91, 0
M a[16:19],a[160:163],a[64:67],a[16:19]
s_sub_u32 s75, 3670016, s64
buffer_load_dwordx4 v13, s[48:51], s22 offen offset:1024   lds
M a[16:19],a[164:167],a[68:71],a[16:19]
s_mov_b32 s12, s72
M a[20:23],a[164:167],a[76:79],a[20:23]
s_and_b32 s13, s73, 0xffff
M a[20:23],a[160:163],a[72:75],a[20:23]
s_mov_b32 s14, s75
T a[104:105],v2,0
T a[106:107],v2,1024
M a[24:27],a[160:163],a[80:83],a[24:27]
s_mov_b32 s15, 0x20000
M a[24:27],a[164:167],a[84:87],a[24:27]
s_waitcnt lgkmcnt(6)
buffer_load_dwordx4 v14, s[48:51], s22 offen offset:2048   lds
M a[28:31],a[164:167],a[92:95],a[28:31]
M a[28:31],a[160:163],a[88:91],a[28:31]
M v[60:63],a[168:171],a[88:91],v[60:63]
R a[160:163],v5,36864
R a[164:167],v6,36864
M v[60:63],a[172:175],a[92:95],v[60:63]
T a[108:109],v2,8192
T a[110:111],v2,9216
M v[56:59],a[172:175],a[84:87],v[56:59]
buffer_load_dwordx4 v15, s[48:51], s22 offen offset:3072   lds
M v[56:59],a[168:171],a[80:83],v[56:59]
s_sub_u32 s22, s22, 1048448
M v[52:55],a[168:171],a[72:75],v[52:55]
M v[52:55],a[172:175],a[76:79],v[52:55]
s_nop 0
T a[112:113],v3,0
T a[114:115],v3,1024
M v[48:51],a[172:175],a[68:71],v[48:51]
SA m0,s23,49152
M v[48:51],a[168:171],a[64:67],v[48:51]
buffer_load_dwordx4 v8, s[16:19], s21 offen offset:0  nt lds
M v[44:47],a[168:171],a[56:59],v[44:47]
M v[44:47],a[172:175],a[60:63],v[44:47]
M v[40:43],a[172:175],a[52:55],v[40:43]
s_nop 0
T a[116:117],v3,8192
T a[118:119],v3,9216
M v[40:43],a[168:171],a[48:51],v[40:43]
M v[36:39],a[168:171],a[40:43],v[36:39]
buffer_load_dwordx4 v9, s[16:19], s21 offen offset:1024  nt lds
M v[36:39],a[172:175],a[44:47],v[36:39]
s_waitcnt lgkmcnt(6)
M v[32:35],a[172:175],a[36:39],v[32:35]
M v[32:35],a[168:171],a[32:35],v[32:35]
s_nop 0
T a[120:121],v4,0
T a[122:123],v4,1024
M v[64:67],a[160:163],a[32:35],v[64:67]
R a[168:171],v5,38912
R a[172:175],v6,38912
M v[64:67],a[164:167],a[36:39],v[64:67]
buffer_load_dwordx4 v10, s[16:19], s21 offen offset:2048  nt lds
M v[68:71],a[164:167],a[44:47],v[68:71]
M v[68:71],a[160:163],a[40:43],v[68:71]
M v[72:75],a[160:163],a[48:51],v[72:75]
s_nop 0
T a[124:125],v4,8192
T a[126:127],v4,9216
M v[72:75],a[164:167],a[52:55],v[72:75]
M v[76:79],a[164:167],a[60:63],v[76:79]
buffer_load_dwordx4 v11, s[16:19], s21 offen offset:3072  nt lds
M v[76:79],a[160:163],a[56:59],v[76:79]
SA s21,s21,524160
M v[80:83],a[160:163],a[64:67],v[80:83]
M v[80:83],a[164:167],a[68:71],v[80:83]
M v[84:87],a[164:167],a[76:79],v[84:87]
M v[84:87],a[160:163],a[72:75],v[84:87]
M v[88:91],a[160:163],a[80:83],v[88:91]
M v[88:91],a[164:167],a[84:87],v[88:91]
s_waitcnt lgkmcnt(2)
M v[92:95],a[164:167],a[92:95],v[92:95]
s_waitcnt vmcnt(18) lgkmcnt(0)
M v[92:95],a[160:163],a[88:91],v[92:95]
s_barrier
M v[124:127],a[168:171],a[88:91],v[124:127]
R a[160:163],v5,49152
R a[164:167],v6,49152
M v[124:127],a[172:175],a[92:95],v[124:127]
M v[120:123],a[172:175],a[84:87],v[120:123]
SA m0,s24,32768
T a[128:129],v1,16384
T a[130:131],v1,17408
M v[120:123],a[168:171],a[80:83],v[120:123]
buffer_load_dwordx4 v12, s[48:51], s22 offen offset:0   lds
M v[116:119],a[168:171],a[72:75],v[116:119]
M v[116:119],a[172:175],a[76:79],v[116:119]
M v[112:115],a[172:175],a[68:71],v[112:115]
M v[112:115],a[168:171],a[64:67],v[112:115]
M v[108:111],a[168:171],a[56:59],v[108:111]
M v[108:111],a[172:175],a[60:63],v[108:111]
s_nop 0
T a[132:133],v1,24576
T a[134:135],v1,25600
M v[104:107],a[172:175],a[52:55],v[104:107]
buffer_load_dwordx4 v13, s[48:51], s22 offen offset:1024   lds
M v[104:107],a[168:171],a[48:51],v[104:107]
M v[100:103],a[168:171],a[40:43],v[100:103]
M v[100:103],a[172:175],a[44:47],v[100:103]
s_waitcnt lgkmcnt(4)
M v[96:99],a[172:175],a[36:39],v[96:99]
M v[96:99],a[168:171],a[32:35],v[96:99]
M v[128:131],a[160:163],a[32:35],v[128:131]
R a[168:171],v5,51200
R a[172:175],v6,51200
M v[128:131],a[164:167],a[36:39],v[128:131]
T a[136:137],v2,16384
T a[138:139],v2,17408
M v[132:135],a[164:167],a[44:47],v[132:135]
buffer_load_dwordx4 v14, s[48:51], s22 offen offset:2048   lds
M v[132:135],a[160:163],a[40:43],v[132:135]
M v[136:139],a[160:163],a[48:51],v[136:139]
M v[136:139],a[164:167],a[52:55],v[136:139]
M v[140:143],a[164:167],a[60:63],v[140:143]
M v[140:143],a[160:163],a[56:59],v[140:143]
s_nop 0
T a[140:141],v2,24576
T a[142:143],v2,25600
M v[144:147],a[160:163],a[64:67],v[144:147]
buffer_load_dwordx4 v15, s[48:51], s22 offen offset:3072   lds
M v[144:147],a[164:167],a[68:71],v[144:147]
SA s22,s22,1048576
M v[148:151],a[164:167],a[76:79],v[148:151]
M v[148:151],a[160:163],a[72:75],v[148:151]
M v[152:155],a[160:163],a[80:83],v[152:155]
M v[152:155],a[164:167],a[84:87],v[152:155]
s_waitcnt lgkmcnt(4)
M v[156:159],a[164:167],a[92:95],v[156:159]
SA m0,s23,0
T a[144:145],v3,16384
T a[146:147],v3,17408
M v[156:159],a[160:163],a[88:91],v[156:159]
buffer_load_dwordx4 v8, s[16:19], s21 offen offset:0  nt lds
M v[188:191],a[168:171],a[88:91],v[188:191]
R a[160:163],v5,53248
R a[164:167],v6,53248
M v[188:191],a[172:175],a[92:95],v[188:191]
buffer_load_dword a240, v26, s[60:63], s27 offen offset:0
M v[184:187],a[172:175],a[84:87],v[184:187]
SA s27,s27,2048
M v[184:187],a[168:171],a[80:83],v[184:187]
M v[180:183],a[168:171],a[72:75],v[180:183]
M v[180:183],a[172:175],a[76:79],v[180:183]
s_nop 0
T a[148:149],v3,24576
T a[150:151],v3,25600
M v[176:179],a[172:175],a[68:71],v[176:179]
buffer_load_dwordx4 v9, s[16:19], s21 offen offset:1024  nt lds
M v[176:179],a[168:171],a[64:67],v[176:179]
M v[172:175],a[168:171],a[56:59],v[172:175]
M v[172:175],a[172:175],a[60:63],v[172:175]
M v[168:171],a[172:175],a[52:55],v[168:171]
M v[168:171],a[168:171],a[48:51],v[168:171]
M v[164:167],a[168:171],a[40:43],v[164:167]
s_nop 0
T a[152:153],v4,16384
T a[154:155],v4,17408
M v[164:167],a[172:175],a[44:47],v[164:167]
s_waitcnt lgkmcnt(4)
buffer_load_dwordx4 v10, s[16:19], s21 offen offset:2048  nt lds
M v[160:163],a[172:175],a[36:39],v[160:163]
M v[160:163],a[168:171],a[32:35],v[160:163]
M v[192:195],a[160:163],a[32:35],v[192:195]
R a[168:171],v5,55296
R a[172:175],v6,55296
M v[192:195],a[164:167],a[36:39],v[192:195]
M v[196:199],a[164:167],a[44:47],v[196:199]
M v[196:199],a[160:163],a[40:43],v[196:199]
s_nop 0
T a[156:157],v4,24576
T a[158:159],v4,25600
M v[200:203],a[160:163],a[48:51],v[200:203]
buffer_load_dwordx4 v11, s[16:19], s21 offen offset:3072  nt lds
M v[200:203],a[164:167],a[52:55],v[200:203]
SA s21,s21,128
M v[204:207],a[164:167],a[60:63],v[204:207]
M v[204:207],a[160:163],a[56:59],v[204:207]
M v[208:211],a[160:163],a[64:67],v[208:211]
M v[208:211],a[164:167],a[68:71],v[208:211]
M v[212:215],a[164:167],a[76:79],v[212:215]
M v[212:215],a[160:163],a[72:75],v[212:215]
M v[216:219],a[160:163],a[80:83],v[216:219]
M v[216:219],a[164:167],a[84:87],v[216:219]
s_waitcnt lgkmcnt(2)
M v[220:223],a[164:167],a[92:95],v[220:223]
s_waitcnt vmcnt(18) lgkmcnt(0)
M v[220:223],a[160:163],a[88:91],v[220:223]
s_barrier
M v[252:255],a[168:171],a[88:91],v[252:255]
R a[160:163],v5,0
R a[164:167],v6,0
M v[252:255],a[172:175],a[92:95],v[252:255]
M v[248:251],a[172:175],a[84:87],v[248:251]
M v[248:251],a[168:171],a[80:83],v[248:251]
M v[244:247],a[168:171],a[72:75],v[244:247]
M v[244:247],a[172:175],a[76:79],v[244:247]
M v[240:243],a[172:175],a[68:71],v[240:243]
M v[240:243],a[168:171],a[64:67],v[240:243]
M v[236:239],a[168:171],a[56:59],v[236:239]
M v[236:239],a[172:175],a[60:63],v[236:239]
M v[232:235],a[172:175],a[52:55],v[232:235]
M v[232:235],a[168:171],a[48:51],v[232:235]
M v[228:231],a[168:171],a[40:43],v[228:231]
M v[228:231],a[172:175],a[44:47],v[228:231]
s_waitcnt lgkmcnt(0)
M v[224:227],a[172:175],a[36:39],v[224:227]
M v[224:227],a[168:171],a[32:35],v[224:227]
M a[0:3],a[160:163],a[96:99],a[0:3]
R a[168:171],v5,2048
R a[172:175],v6,2048
M a[0:3],a[164:167],a[100:103],a[0:3]
T a[32:33],v1,32768
T a[34:35],v1,33792
M a[4:7],a[164:167],a[108:111],a[4:7]
SA m0,s24,49152
M a[4:7],a[160:163],a[104:107],a[4:7]
buffer_load_dwordx4 v12, s[48:51], s22 offen offset:0   lds
M a[8:11],a[160:163],a[112:115],a[8:11]
M a[8:11],a[164:167],a[116:119],a[8:11]
M a[12:15],a[164:167],a[124:127],a[12:15]
s_nop 0
T a[36:37],v1,40960
T a[38:39],v1,41984
M a[12:15],a[160:163],a[120:123],a[12:15]
M a[16:19],a[160:163],a[128:131],a[16:19]
buffer_load_dwordx4 v13, s[48:51], s22 offen offset:1024   lds
M a[16:19],a[164:167],a[132:135],a[16:19]
M a[20:23],a[164:167],a[140:143],a[20:23]
M a[20:23],a[160:163],a[136:139],a[20:23]
s_nop 0
T a[40:41],v2,32768
T a[42:43],v2,33792
M a[24:27],a[160:163],a[144:147],a[24:27]
M a[24:27],a[164:167],a[148:151],a[24:27]
s_waitcnt lgkmcnt(6)
buffer_load_dwordx4 v14, s[48:51], s22 offen offset:2048   lds
M a[28:31],a[164:167],a[156:159],a[28:31]
M a[28:31],a[160:163],a[152:155],a[28:31]
M v[60:63],a[168:171],a[152:155],v[60:63]
R a[160:163],v5,4096
R a[164:167],v6,4096
M v[60:63],a[172:175],a[156:159],v[60:63]
T a[44:45],v2,40960
T a[46:47],v2,41984
L_w_kv13:
s_cbranch_execz L_w_kv17
M v[56:59],a[172:175],a[148:151],v[56:59]
buffer_load_dwordx4 v15, s[48:51], s22 offen offset:3072   lds
M v[56:59],a[168:171],a[144:147],v[56:59]
s_sub_u32 s22, s22, 1048448
M v[52:55],a[168:171],a[136:139],v[52:55]
M v[52:55],a[172:175],a[140:143],v[52:55]
s_nop 0
T a[48:49],v3,32768
T a[50:51],v3,33792
M v[48:51],a[172:175],a[132:135],v[48:51]
SA m0,s23,16384
M v[48:51],a[168:171],a[128:131],v[48:51]
buffer_load_dwordx4 v8, s[16:19], s21 offen offset:0  nt lds
M v[44:47],a[168:171],a[120:123],v[44:47]
M v[44:47],a[172:175],a[124:127],v[44:47]
M v[40:43],a[172:175],a[116:119],v[40:43]
s_nop 0
T a[52:53],v3,40960
T a[54:55],v3,41984
M v[40:43],a[168:171],a[112:115],v[40:43]
M v[36:39],a[168:171],a[104:107],v[36:39]
buffer_load_dwordx4 v9, s[16:19], s21 offen offset:1024  nt lds
M v[36:39],a[172:175],a[108:111],v[36:39]
s_waitcnt lgkmcnt(6)
M v[32:35],a[172:175],a[100:103],v[32:35]
M v[32:35],a[168:171],a[96:99],v[32:35]
s_nop 0
T a[56:57],v4,32768
T a[58:59],v4,33792
M v[64:67],a[160:163],a[96:99],v[64:67]
R a[168:171],v5,6144
R a[172:175],v6,6144
M v[64:67],a[164:167],a[100:103],v[64:67]
buffer_load_dwordx4 v10, s[16:19], s21 offen offset:2048  nt lds
M v[68:71],a[164:167],a[108:111],v[68:71]
M v[68:71],a[160:163],a[104:107],v[68:71]
M v[72:75],a[160:163],a[112:115],v[72:75]
s_nop 0
T a[60:61],v4,40960
T a[62:63],v4,41984
M v[72:75],a[164:167],a[116:119],v[72:75]
M v[76:79],a[164:167],a[124:127],v[76:79]
buffer_load_dwordx4 v11, s[16:19], s21 offen offset:3072  nt lds
M v[76:79],a[160:163],a[120:123],v[76:79]
SA s21,s21,524160
M v[80:83],a[160:163],a[128:131],v[80:83]
M v[80:83],a[164:167],a[132:135],v[80:83]
M v[84:87],a[164:167],a[140:143],v[84:87]
M v[84:87],a[160:163],a[136:139],v[84:87]
M v[88:91],a[160:163],a[144:147],v[88:91]
M v[88:91],a[164:167],a[148:151],v[88:91]
s_waitcnt lgkmcnt(2)
M v[92:95],a[164:167],a[156:159],v[92:95]
s_waitcnt vmcnt(17) lgkmcnt(0)
M v[92:95],a[160:163],a[152:155],v[92:95]
s_barrier
M v[124:127],a[168:171],a[152:155],v[124:127]
R a[160:163],v5,16384
R a[164:167],v6,16384
M v[124:127],a[172:175],a[156:159],v[124:127]
M v[120:123],a[172:175],a[148:151],v[120:123]
SA m0,s24,0
T a[64:65],v1,49152
T a[66:67],v1,50176
M v[120:123],a[168:171],a[144:147],v[120:123]
buffer_load_dwordx4 v12, s[48:51], s22 offen offset:0   lds
M v[116:119],a[168:171],a[136:139],v[116:119]
M v[116:119],a[172:175],a[140:143],v[116:119]
M v[112:115],a[172:175],a[132:135],v[112:115]
M v[112:115],a[168:171],a[128:131],v[112:115]
M v[108:111],a[168:171],a[120:123],v[108:111]
M v[108:111],a[172:175],a[124:127],v[108:111]
s_nop 0
T a[68:69],v1,57344
T a[70:71],v1,58368
M v[104:107],a[172:175],a[116:119],v[104:107]
buffer_load_dwordx4 v13, s[48:51], s22 offen offset:1024   lds
M v[104:107],a[168:171],a[112:115],v[104:107]
M v[100:103],a[168:171],a[104:107],v[100:103]
M v[100:103],a[172:175],a[108:111],v[100:103]
s_waitcnt lgkmcnt(4)
M v[96:99],a[172:175],a[100:103],v[96:99]
M v[96:99],a[168:171],a[96:99],v[96:99]
M v[128:131],a[160:163],a[96:99],v[128:131]
R a[168:171],v5,18432
R a[172:175],v6,18432
M v[128:131],a[164:167],a[100:103],v[128:131]
T a[72:73],v2,49152
T a[74:75],v2,50176
M v[132:135],a[164:167],a[108:111],v[132:135]
buffer_load_dwordx4 v14, s[48:51], s22 offen offset:2048   lds
M v[132:135],a[160:163],a[104:107],v[132:135]
M v[136:139],a[160:163],a[112:115],v[136:139]
M v[136:139],a[164:167],a[116:119],v[136:139]
M v[140:143],a[164:167],a[124:127],v[140:143]
M v[140:143],a[160:163],a[120:123],v[140:143]
s_nop 0
T a[76:77],v2,57344
T a[78:79],v2,58368
M v[144:147],a[160:163],a[128:131],v[144:147]
buffer_load_dwordx4 v15, s[48:51], s22 offen offset:3072   lds
M v[144:147],a[164:167],a[132:135],v[144:147]
SA s22,s22,1048576
M v[148:151],a[164:167],a[140:143],v[148:151]
M v[148:151],a[160:163],a[136:139],v[148:151]
M v[152:155],a[160:163],a[144:147],v[152:155]
M v[152:155],a[164:167],a[148:151],v[152:155]
s_waitcnt lgkmcnt(4)
M v[156:159],a[164:167],a[156:159],v[156:159]
SA m0,s23,32768
T a[80:81],v3,49152
T a[82:83],v3,50176
M v[156:159],a[160:163],a[152:155],v[156:159]
buffer_load_dwordx4 v8, s[16:19], s21 offen offset:0  nt lds
M v[188:191],a[168:171],a[152:155],v[188:191]
R a[160:163],v5,20480
R a[164:167],v6,20480
M v[188:191],a[172:175],a[156:159],v[188:191]
buffer_load_dword a240, v26, s[60:63], s27 offen offset:0
M v[184:187],a[172:175],a[148:151],v[184:187]
SA s27,s27,2048
M v[184:187],a[168:171],a[144:147],v[184:187]
M v[180:183],a[168:171],a[136:139],v[180:183]
M v[180:183],a[172:175],a[140:143],v[180:183]
s_nop 0
T a[84:85],v3,57344
T a[86:87],v3,58368
M v[176:179],a[172:175],a[132:135],v[176:179]
buffer_load_dwordx4 v9, s[16:19], s21 offen offset:1024  nt lds
M v[176:179],a[168:171],a[128:131],v[176:179]
M v[172:175],a[168:171],a[120:123],v[172:175]
M v[172:175],a[172:175],a[124:127],v[172:175]
M v[168:171],a[172:175],a[116:119],v[168:171]
M v[168:171],a[168:171],a[112:115],v[168:171]
M v[164:167],a[168:171],a[104:107],v[164:167]
s_nop 0
T a[88:89],v4,49152
T a[90:91],v4,50176
M v[164:167],a[172:175],a[108:111],v[164:167]
s_waitcnt lgkmcnt(4)
buffer_load_dwordx4 v10, s[16:19], s21 offen offset:2048  nt lds
M v[160:163],a[172:175],a[100:103],v[160:163]
M v[160:163],a[168:171],a[96:99],v[160:163]
M v[192:195],a[160:163],a[96:99],v[192:195]
R a[168:171],v5,22528
R a[172:175],v6,22528
M v[192:195],a[164:167],a[100:103],v[192:195]
M v[196:199],a[164:167],a[108:111],v[196:199]
M v[196:199],a[160:163],a[104:107],v[196:199]
s_nop 0
T a[92:93],v4,57344
T a[94:95],v4,58368
M v[200:203],a[160:163],a[112:115],v[200:203]
buffer_load_dwordx4 v11, s[16:19], s21 offen offset:3072  nt lds
M v[200:203],a[164:167],a[116:119],v[200:203]
SA s21,s21,128
M v[204:207],a[164:167],a[124:127],v[204:207]
M v[204:207],a[160:163],a[120:123],v[204:207]
M v[208:211],a[160:163],a[128:131],v[208:211]
M v[208:211],a[164:167],a[132:135],v[208:211]
M v[212:215],a[164:167],a[140:143],v[212:215]
M v[212:215],a[160:163],a[136:139],v[212:215]
M v[216:219],a[160:163],a[144:147],v[216:219]
M v[216:219],a[164:167],a[148:151],v[216:219]
s_waitcnt lgkmcnt(2)
M v[220:223],a[164:167],a[156:159],v[220:223]
s_waitcnt vmcnt(17) lgkmcnt(0)
M v[220:223],a[160:163],a[152:155],v[220:223]
s_barrier
M v[252:255],a[168:171],a[152:155],v[252:255]
R a[160:163],v5,32768
R a[164:167],v6,32768
M v[252:255],a[172:175],a[156:159],v[252:255]
M v[248:251],a[172:175],a[148:151],v[248:251]
M v[248:251],a[168:171],a[144:147],v[248:251]
M v[244:247],a[168:171],a[136:139],v[244:247]
M v[244:247],a[172:175],a[140:143],v[244:247]
M v[240:243],a[172:175],a[132:135],v[240:243]
M v[240:243],a[168:171],a[128:131],v[240:243]
M v[236:239],a[168:171],a[120:123],v[236:239]
M v[236:239],a[172:175],a[124:127],v[236:239]
M v[232:235],a[172:175],a[116:119],v[232:235]
M v[232:235],a[168:171],a[112:115],v[232:235]
M v[228:231],a[168:171],a[104:107],v[228:231]
M v[228:231],a[172:175],a[108:111],v[228:231]
s_waitcnt lgkmcnt(0)
M v[224:227],a[172:175],a[100:103],v[224:227]
M v[224:227],a[168:171],a[96:99],v[224:227]
M a[0:3],a[160:163],a[32:35],a[0:3]
R a[168:171],v5,34816
R a[172:175],v6,34816
M a[0:3],a[164:167],a[36:39],a[0:3]
T a[96:97],v1,0
T a[98:99],v1,1024
M a[4:7],a[164:167],a[44:47],a[4:7]
SA m0,s24,16384
M a[4:7],a[160:163],a[40:43],a[4:7]
buffer_load_dwordx4 v12, s[48:51], s22 offen offset:0   lds
M a[8:11],a[160:163],a[48:51],a[8:11]
M a[8:11],a[164:167],a[52:55],a[8:11]
M a[12:15],a[164:167],a[60:63],a[12:15]
s_nop 0
T a[100:101],v1,8192
T a[102:103],v1,9216
M a[12:15],a[160:163],a[56:59],a[12:15]
M a[16:19],a[160:163],a[64:67],a[16:19]
buffer_load_dwordx4 v13, s[48:51], s22 offen offset:1024   lds
M a[16:19],a[164:167],a[68:71],a[16:19]
M a[20:23],a[164:167],a[76:79],a[20:23]
M a[20:23],a[160:163],a[72:75],a[20:23]
s_nop 0
T a[104:105],v2,0
T a[106:107],v2,1024
M a[24:27],a[160:163],a[80:83],a[24:27]
M a[24:27],a[164:167],a[84:87],a[24:27]
s_waitcnt lgkmcnt(6)
buffer_load_dwordx4 v14, s[48:51], s22 offen offset:2048   lds
M a[28:31],a[164:167],a[92:95],a[28:31]
M a[28:31],a[160:163],a[88:91],a[28:31]
M v[60:63],a[168:171],a[88:91],v[60:63]
R a[160:163],v5,36864
R a[164:167],v6,36864
M v[60:63],a[172:175],a[92:95],v[60:63]
T a[108:109],v2,8192
T a[110:111],v2,9216
M v[56:59],a[172:175],a[84:87],v[56:59]
buffer_load_dwordx4 v15, s[48:51], s22 offen offset:3072   lds
M v[56:59],a[168:171],a[80:83],v[56:59]
s_sub_u32 s22, s22, 1048448
M v[52:55],a[168:171],a[72:75],v[52:55]
M v[52:55],a[172:175],a[76:79],v[52:55]
s_nop 0
T a[112:113],v3,0
T a[114:115],v3,1024
M v[48:51],a[172:175],a[68:71],v[48:51]
SA m0,s23,49152
M v[48:51],a[168:171],a[64:67],v[48:51]
buffer_load_dwordx4 v8, s[16:19], s21 offen offset:0  nt lds
M v[44:47],a[168:171],a[56:59],v[44:47]
M v[44:47],a[172:175],a[60:63],v[44:47]
M v[40:43],a[172:175],a[52:55],v[40:43]
s_nop 0
T a[116:117],v3,8192
T a[118:119],v3,9216
M v[40:43],a[168:171],a[48:51],v[40:43]
M v[36:39],a[168:171],a[40:43],v[36:39]
buffer_load_dwordx4 v9, s[16:19], s21 offen offset:1024  nt lds
M v[36:39],a[172:175],a[44:47],v[36:39]
s_waitcnt lgkmcnt(6)
M v[32:35],a[172:175],a[36:39],v[32:35]
M v[32:35],a[168:171],a[32:35],v[32:35]
s_nop 0
T a[120:121],v4,0
T a[122:123],v4,1024
M v[64:67],a[160:163],a[32:35],v[64:67]
R a[168:171],v5,38912
R a[172:175],v6,38912
M v[64:67],a[164:167],a[36:39],v[64:67]
buffer_load_dwordx4 v10, s[16:19], s21 offen offset:2048  nt lds
M v[68:71],a[164:167],a[44:47],v[68:71]
M v[68:71],a[160:163],a[40:43],v[68:71]
M v[72:75],a[160:163],a[48:51],v[72:75]
s_nop 0
T a[124:125],v4,8192
T a[126:127],v4,9216
M v[72:75],a[164:167],a[52:55],v[72:75]
M v[76:79],a[164:167],a[60:63],v[76:79]
buffer_load_dwordx4 v11, s[16:19], s21 offen offset:3072  nt lds
M v[76:79],a[160:163],a[56:59],v[76:79]
SA s21,s21,524160
M v[80:83],a[160:163],a[64:67],v[80:83]
M v[80:83],a[164:167],a[68:71],v[80:83]
M v[84:87],a[164:167],a[76:79],v[84:87]
M v[84:87],a[160:163],a[72:75],v[84:87]
M v[88:91],a[160:163],a[80:83],v[88:91]
M v[88:91],a[164:167],a[84:87],v[88:91]
s_waitcnt lgkmcnt(2)
M v[92:95],a[164:167],a[92:95],v[92:95]
s_waitcnt vmcnt(17) lgkmcnt(0)
M v[92:95],a[160:163],a[88:91],v[92:95]
s_barrier
M v[124:127],a[168:171],a[88:91],v[124:127]
R a[160:163],v5,49152
R a[164:167],v6,49152
M v[124:127],a[172:175],a[92:95],v[124:127]
M v[120:123],a[172:175],a[84:87],v[120:123]
SA m0,s24,32768
T a[128:129],v1,16384
T a[130:131],v1,17408
M v[120:123],a[168:171],a[80:83],v[120:123]
buffer_load_dwordx4 v12, s[48:51], s22 offen offset:0   lds
M v[116:119],a[168:171],a[72:75],v[116:119]
M v[116:119],a[172:175],a[76:79],v[116:119]
M v[112:115],a[172:175],a[68:71],v[112:115]
M v[112:115],a[168:171],a[64:67],v[112:115]
M v[108:111],a[168:171],a[56:59],v[108:111]
M v[108:111],a[172:175],a[60:63],v[108:111]
s_nop 0
T a[132:133],v1,24576
T a[134:135],v1,25600
M v[104:107],a[172:175],a[52:55],v[104:107]
buffer_load_dwordx4 v13, s[48:51], s22 offen offset:1024   lds
M v[104:107],a[168:171],a[48:51],v[104:107]
M v[100:103],a[168:171],a[40:43],v[100:103]
s_and_b32 s64, s42, 7
s_lshl_b32 s64, s64, 2
M v[100:103],a[172:175],a[44:47],v[100:103]
s_waitcnt lgkmcnt(4)
SA s64,s64,s20
M v[96:99],a[172:175],a[36:39],v[96:99]
s_mul_i32 s64, s64, 114688
v_bfe_u32 v28, v0, 2, 2
v_and_b32 v29, 3, v0
M v[96:99],a[168:171],a[32:35],v[96:99]
v_lshlrev_b32 v29, 7, v29
v_lshl_add_u32 v28, v28, 13, v29
M v[128:131],a[160:163],a[32:35],v[128:131]
R a[168:171],v5,51200
R a[172:175],v6,51200
M v[128:131],a[164:167],a[36:39],v[128:131]
T a[136:137],v2,16384
T a[138:139],v2,17408
M v[132:135],a[164:167],a[44:47],v[132:135]
buffer_load_dwordx4 v14, s[48:51], s22 offen offset:2048   lds
M v[132:135],a[160:163],a[40:43],v[132:135]
v_add_u32 v23, s64, v28
v_and_b32 v28, 48, v0
M v[136:139],a[160:163],a[48:51],v[136:139]
v_lshl_add_u32 v23, v28, 24, v23
M v[136:139],a[164:167],a[52:55],v[136:139]
M v[140:143],a[164:167],a[60:63],v[140:143]
M v[140:143],a[160:163],a[56:59],v[140:143]
s_nop 0
T a[140:141],v2,24576
T a[142:143],v2,25600
M v[144:147],a[160:163],a[64:67],v[144:147]
buffer_load_dwordx4 v15, s[48:51], s22 offen offset:3072   lds
M v[144:147],a[164:167],a[68:71],v[144:147]
SA s22,s22,1048576
M v[148:151],a[164:167],a[76:79],v[148:151]
M v[148:151],a[160:163],a[72:75],v[148:151]
M v[152:155],a[160:163],a[80:83],v[152:155]
M v[152:155],a[164:167],a[84:87],v[152:155]
s_waitcnt lgkmcnt(4)
M v[156:159],a[164:167],a[92:95],v[156:159]
SA m0,s23,0
T a[144:145],v3,16384
T a[146:147],v3,17408
M v[156:159],a[160:163],a[88:91],v[156:159]
buffer_load_dwordx4 v8, s[16:19], s21 offen offset:0  nt lds
M v[188:191],a[168:171],a[88:91],v[188:191]
R a[160:163],v5,53248
R a[164:167],v6,53248
M v[188:191],a[172:175],a[92:95],v[188:191]
M v[184:187],a[172:175],a[84:87],v[184:187]
M v[184:187],a[168:171],a[80:83],v[184:187]
M v[180:183],a[168:171],a[72:75],v[180:183]
M v[180:183],a[172:175],a[76:79],v[180:183]
s_nop 0
T a[148:149],v3,24576
T a[150:151],v3,25600
M v[176:179],a[172:175],a[68:71],v[176:179]
buffer_load_dwordx4 v9, s[16:19], s21 offen offset:1024  nt lds
M v[176:179],a[168:171],a[64:67],v[176:179]
M v[172:175],a[168:171],a[56:59],v[172:175]
M v[172:175],a[172:175],a[60:63],v[172:175]
M v[168:171],a[172:175],a[52:55],v[168:171]
M v[168:171],a[168:171],a[48:51],v[168:171]
M v[164:167],a[168:171],a[40:43],v[164:167]
s_nop 0
T a[152:153],v4,16384
T a[154:155],v4,17408
M v[164:167],a[172:175],a[44:47],v[164:167]
s_waitcnt lgkmcnt(4)
buffer_load_dwordx4 v10, s[16:19], s21 offen offset:2048  nt lds
M v[160:163],a[172:175],a[36:39],v[160:163]
M v[160:163],a[168:171],a[32:35],v[160:163]
M v[192:195],a[160:163],a[32:35],v[192:195]
R a[168:171],v5,55296
R a[172:175],v6,55296
M v[192:195],a[164:167],a[36:39],v[192:195]
M v[196:199],a[164:167],a[44:47],v[196:199]
M v[196:199],a[160:163],a[40:43],v[196:199]
s_nop 0
T a[156:157],v4,24576
T a[158:159],v4,25600
M v[200:203],a[160:163],a[48:51],v[200:203]
buffer_load_dwordx4 v11, s[16:19], s21 offen offset:3072  nt lds
M v[200:203],a[164:167],a[52:55],v[200:203]
SA s21,s21,128
M v[204:207],a[164:167],a[60:63],v[204:207]
M v[204:207],a[160:163],a[56:59],v[204:207]
M v[208:211],a[160:163],a[64:67],v[208:211]
M v[208:211],a[164:167],a[68:71],v[208:211]
M v[212:215],a[164:167],a[76:79],v[212:215]
M v[212:215],a[160:163],a[72:75],v[212:215]
M v[216:219],a[160:163],a[80:83],v[216:219]
M v[216:219],a[164:167],a[84:87],v[216:219]
s_waitcnt lgkmcnt(2)
M v[220:223],a[164:167],a[92:95],v[220:223]
s_waitcnt vmcnt(16) lgkmcnt(0)
M v[220:223],a[160:163],a[88:91],v[220:223]
s_barrier
M v[252:255],a[168:171],a[88:91],v[252:255]
R a[160:163],v5,0
R a[164:167],v6,0
M v[252:255],a[172:175],a[92:95],v[252:255]
buffer_load_dword a240, v23, s[52:55], 0 offen offset:0
M v[248:251],a[172:175],a[84:87],v[248:251]
v_add_u32 v23, 32768, v23
M v[248:251],a[168:171],a[80:83],v[248:251]
M v[244:247],a[168:171],a[72:75],v[244:247]
M v[244:247],a[172:175],a[76:79],v[244:247]
M v[240:243],a[172:175],a[68:71],v[240:243]
M v[240:243],a[168:171],a[64:67],v[240:243]
M v[236:239],a[168:171],a[56:59],v[236:239]
M v[236:239],a[172:175],a[60:63],v[236:239]
M v[232:235],a[172:175],a[52:55],v[232:235]
M v[232:235],a[168:171],a[48:51],v[232:235]
M v[228:231],a[168:171],a[40:43],v[228:231]
M v[228:231],a[172:175],a[44:47],v[228:231]
s_waitcnt lgkmcnt(0)
M v[224:227],a[172:175],a[36:39],v[224:227]
M v[224:227],a[168:171],a[32:35],v[224:227]
M a[0:3],a[160:163],a[96:99],a[0:3]
R a[168:171],v5,2048
R a[172:175],v6,2048
M a[0:3],a[164:167],a[100:103],a[0:3]
T a[32:33],v1,32768
T a[34:35],v1,33792
M a[4:7],a[164:167],a[108:111],a[4:7]
SA m0,s24,49152
M a[4:7],a[160:163],a[104:107],a[4:7]
buffer_load_dwordx4 v12, s[48:51], s22 offen offset:0   lds
M a[8:11],a[160:163],a[112:115],a[8:11]
M a[8:11],a[164:167],a[116:119],a[8:11]
M a[12:15],a[164:167],a[124:127],a[12:15]
s_nop 0
T a[36:37],v1,40960
T a[38:39],v1,41984
M a[12:15],a[160:163],a[120:123],a[12:15]
M a[16:19],a[160:163],a[128:131],a[16:19]
buffer_load_dwordx4 v13, s[48:51], s22 offen offset:1024   lds
M a[16:19],a[164:167],a[132:135],a[16:19]
M a[20:23],a[164:167],a[140:143],a[20:23]
M a[20:23],a[160:163],a[136:139],a[20:23]
s_nop 0
T a[40:41],v2,32768
T a[42:43],v2,33792
M a[24:27],a[160:163],a[144:147],a[24:27]
M a[24:27],a[164:167],a[148:151],a[24:27]
s_waitcnt lgkmcnt(6)
buffer_load_dwordx4 v14, s[48:51], s22 offen offset:2048   lds
M a[28:31],a[164:167],a[156:159],a[28:31]
M a[28:31],a[160:163],a[152:155],a[28:31]
M v[60:63],a[168:171],a[152:155],v[60:63]
R a[160:163],v5,4096
R a[164:167],v6,4096
M v[60:63],a[172:175],a[156:159],v[60:63]
T a[44:45],v2,40960
T a[46:47],v2,41984
M v[56:59],a[172:175],a[148:151],v[56:59]
buffer_load_dwordx4 v15, s[48:51], s22 offen offset:3072   lds
M v[56:59],a[168:171],a[144:147],v[56:59]
s_sub_u32 s22, s22, 1048448
M v[52:55],a[168:171],a[136:139],v[52:55]
M v[52:55],a[172:175],a[140:143],v[52:55]
s_nop 0
T a[48:49],v3,32768
T a[50:51],v3,33792
M v[48:51],a[172:175],a[132:135],v[48:51]
SA m0,s23,16384
M v[48:51],a[168:171],a[128:131],v[48:51]
buffer_load_dwordx4 v8, s[16:19], s21 offen offset:0  nt lds
M v[44:47],a[168:171],a[120:123],v[44:47]
M v[44:47],a[172:175],a[124:127],v[44:47]
M v[40:43],a[172:175],a[116:119],v[40:43]
s_nop 0
T a[52:53],v3,40960
T a[54:55],v3,41984
M v[40:43],a[168:171],a[112:115],v[40:43]
M v[36:39],a[168:171],a[104:107],v[36:39]
buffer_load_dwordx4 v9, s[16:19], s21 offen offset:1024  nt lds
M v[36:39],a[172:175],a[108:111],v[36:39]
s_waitcnt lgkmcnt(6)
M v[32:35],a[172:175],a[100:103],v[32:35]
M v[32:35],a[168:171],a[96:99],v[32:35]
s_nop 0
T a[56:57],v4,32768
T a[58:59],v4,33792
M v[64:67],a[160:163],a[96:99],v[64:67]
R a[168:171],v5,6144
R a[172:175],v6,6144
M v[64:67],a[164:167],a[100:103],v[64:67]
buffer_load_dwordx4 v10, s[16:19], s21 offen offset:2048  nt lds
M v[68:71],a[164:167],a[108:111],v[68:71]
M v[68:71],a[160:163],a[104:107],v[68:71]
M v[72:75],a[160:163],a[112:115],v[72:75]
s_nop 0
T a[60:61],v4,40960
T a[62:63],v4,41984
M v[72:75],a[164:167],a[116:119],v[72:75]
M v[76:79],a[164:167],a[124:127],v[76:79]
buffer_load_dwordx4 v11, s[16:19], s21 offen offset:3072  nt lds
M v[76:79],a[160:163],a[120:123],v[76:79]
SA s21,s21,524160
M v[80:83],a[160:163],a[128:131],v[80:83]
M v[80:83],a[164:167],a[132:135],v[80:83]
M v[84:87],a[164:167],a[140:143],v[84:87]
M v[84:87],a[160:163],a[136:139],v[84:87]
M v[88:91],a[160:163],a[144:147],v[88:91]
M v[88:91],a[164:167],a[148:151],v[88:91]
s_waitcnt lgkmcnt(2)
M v[92:95],a[164:167],a[156:159],v[92:95]
s_waitcnt vmcnt(17) lgkmcnt(0)
M v[92:95],a[160:163],a[152:155],v[92:95]
s_barrier
M v[124:127],a[168:171],a[152:155],v[124:127]
R a[160:163],v5,16384
R a[164:167],v6,16384
M v[124:127],a[172:175],a[156:159],v[124:127]
M v[120:123],a[172:175],a[148:151],v[120:123]
SA m0,s24,0
T a[64:65],v1,49152
T a[66:67],v1,50176
M v[120:123],a[168:171],a[144:147],v[120:123]
buffer_load_dwordx4 v12, s[48:51], s22 offen offset:0   lds
M v[116:119],a[168:171],a[136:139],v[116:119]
M v[116:119],a[172:175],a[140:143],v[116:119]
M v[112:115],a[172:175],a[132:135],v[112:115]
M v[112:115],a[168:171],a[128:131],v[112:115]
M v[108:111],a[168:171],a[120:123],v[108:111]
M v[108:111],a[172:175],a[124:127],v[108:111]
s_nop 0
T a[68:69],v1,57344
T a[70:71],v1,58368
M v[104:107],a[172:175],a[116:119],v[104:107]
buffer_load_dwordx4 v13, s[48:51], s22 offen offset:1024   lds
M v[104:107],a[168:171],a[112:115],v[104:107]
M v[100:103],a[168:171],a[104:107],v[100:103]
M v[100:103],a[172:175],a[108:111],v[100:103]
s_waitcnt lgkmcnt(4)
M v[96:99],a[172:175],a[100:103],v[96:99]
M v[96:99],a[168:171],a[96:99],v[96:99]
L_w_kv14:
s_cbranch_execz L_w_kv18
M v[128:131],a[160:163],a[96:99],v[128:131]
R a[168:171],v5,18432
R a[172:175],v6,18432
M v[128:131],a[164:167],a[100:103],v[128:131]
T a[72:73],v2,49152
T a[74:75],v2,50176
M v[132:135],a[164:167],a[108:111],v[132:135]
buffer_load_dwordx4 v14, s[48:51], s22 offen offset:2048   lds
M v[132:135],a[160:163],a[104:107],v[132:135]
M v[136:139],a[160:163],a[112:115],v[136:139]
M v[136:139],a[164:167],a[116:119],v[136:139]
M v[140:143],a[164:167],a[124:127],v[140:143]
M v[140:143],a[160:163],a[120:123],v[140:143]
s_nop 0
T a[76:77],v2,57344
T a[78:79],v2,58368
M v[144:147],a[160:163],a[128:131],v[144:147]
buffer_load_dwordx4 v15, s[48:51], s22 offen offset:3072   lds
M v[144:147],a[164:167],a[132:135],v[144:147]
SA s22,s22,1048576
M v[148:151],a[164:167],a[140:143],v[148:151]
M v[148:151],a[160:163],a[136:139],v[148:151]
M v[152:155],a[160:163],a[144:147],v[152:155]
M v[152:155],a[164:167],a[148:151],v[152:155]
s_waitcnt lgkmcnt(4)
M v[156:159],a[164:167],a[156:159],v[156:159]
SA m0,s23,32768
T a[80:81],v3,49152
T a[82:83],v3,50176
M v[156:159],a[160:163],a[152:155],v[156:159]
buffer_load_dwordx4 v8, s[16:19], s21 offen offset:0  nt lds
M v[188:191],a[168:171],a[152:155],v[188:191]
R a[160:163],v5,20480
R a[164:167],v6,20480
M v[188:191],a[172:175],a[156:159],v[188:191]
M v[184:187],a[172:175],a[148:151],v[184:187]
M v[184:187],a[168:171],a[144:147],v[184:187]
M v[180:183],a[168:171],a[136:139],v[180:183]
M v[180:183],a[172:175],a[140:143],v[180:183]
s_nop 0
T a[84:85],v3,57344
T a[86:87],v3,58368
M v[176:179],a[172:175],a[132:135],v[176:179]
buffer_load_dwordx4 v9, s[16:19], s21 offen offset:1024  nt lds
M v[176:179],a[168:171],a[128:131],v[176:179]
M v[172:175],a[168:171],a[120:123],v[172:175]
M v[172:175],a[172:175],a[124:127],v[172:175]
M v[168:171],a[172:175],a[116:119],v[168:171]
M v[168:171],a[168:171],a[112:115],v[168:171]
M v[164:167],a[168:171],a[104:107],v[164:167]
s_nop 0
T a[88:89],v4,49152
T a[90:91],v4,50176
M v[164:167],a[172:175],a[108:111],v[164:167]
s_waitcnt lgkmcnt(4)
buffer_load_dwordx4 v10, s[16:19], s21 offen offset:2048  nt lds
M v[160:163],a[172:175],a[100:103],v[160:163]
M v[160:163],a[168:171],a[96:99],v[160:163]
M v[192:195],a[160:163],a[96:99],v[192:195]
R a[168:171],v5,22528
R a[172:175],v6,22528
M v[192:195],a[164:167],a[100:103],v[192:195]
M v[196:199],a[164:167],a[108:111],v[196:199]
M v[196:199],a[160:163],a[104:107],v[196:199]
s_nop 0
T a[92:93],v4,57344
T a[94:95],v4,58368
M v[200:203],a[160:163],a[112:115],v[200:203]
buffer_load_dwordx4 v11, s[16:19], s21 offen offset:3072  nt lds
M v[200:203],a[164:167],a[116:119],v[200:203]
SA s21,s21,128
M v[204:207],a[164:167],a[124:127],v[204:207]
M v[204:207],a[160:163],a[120:123],v[204:207]
M v[208:211],a[160:163],a[128:131],v[208:211]
M v[208:211],a[164:167],a[132:135],v[208:211]
M v[212:215],a[164:167],a[140:143],v[212:215]
M v[212:215],a[160:163],a[136:139],v[212:215]
M v[216:219],a[160:163],a[144:147],v[216:219]
M v[216:219],a[164:167],a[148:151],v[216:219]
s_waitcnt lgkmcnt(2)
M v[220:223],a[164:167],a[156:159],v[220:223]
s_waitcnt vmcnt(17) lgkmcnt(0)
M v[220:223],a[160:163],a[152:155],v[220:223]
s_barrier
M v[252:255],a[168:171],a[152:155],v[252:255]
R a[160:163],v5,32768
R a[164:167],v6,32768
M v[252:255],a[172:175],a[156:159],v[252:255]
buffer_load_dword a240, v23, s[52:55], 0 offen offset:0
M v[248:251],a[172:175],a[148:151],v[248:251]
v_add_u32 v23, 32768, v23
M v[248:251],a[168:171],a[144:147],v[248:251]
M v[244:247],a[168:171],a[136:139],v[244:247]
M v[244:247],a[172:175],a[140:143],v[244:247]
M v[240:243],a[172:175],a[132:135],v[240:243]
M v[240:243],a[168:171],a[128:131],v[240:243]
M v[236:239],a[168:171],a[120:123],v[236:239]
M v[236:239],a[172:175],a[124:127],v[236:239]
M v[232:235],a[172:175],a[116:119],v[232:235]
M v[232:235],a[168:171],a[112:115],v[232:235]
M v[228:231],a[168:171],a[104:107],v[228:231]
M v[228:231],a[172:175],a[108:111],v[228:231]
s_waitcnt lgkmcnt(0)
M v[224:227],a[172:175],a[100:103],v[224:227]
M v[224:227],a[168:171],a[96:99],v[224:227]
M a[0:3],a[160:163],a[32:35],a[0:3]
R a[168:171],v5,34816
R a[172:175],v6,34816
M a[0:3],a[164:167],a[36:39],a[0:3]
T a[96:97],v1,0
T a[98:99],v1,1024
M a[4:7],a[164:167],a[44:47],a[4:7]
SA m0,s24,16384
M a[4:7],a[160:163],a[40:43],a[4:7]
buffer_load_dwordx4 v12, s[48:51], s22 offen offset:0   lds
M a[8:11],a[160:163],a[48:51],a[8:11]
M a[8:11],a[164:167],a[52:55],a[8:11]
M a[12:15],a[164:167],a[60:63],a[12:15]
s_nop 0
T a[100:101],v1,8192
T a[102:103],v1,9216
M a[12:15],a[160:163],a[56:59],a[12:15]
M a[16:19],a[160:163],a[64:67],a[16:19]
buffer_load_dwordx4 v13, s[48:51], s22 offen offset:1024   lds
M a[16:19],a[164:167],a[68:71],a[16:19]
M a[20:23],a[164:167],a[76:79],a[20:23]
M a[20:23],a[160:163],a[72:75],a[20:23]
s_nop 0
T a[104:105],v2,0
T a[106:107],v2,1024
M a[24:27],a[160:163],a[80:83],a[24:27]
M a[24:27],a[164:167],a[84:87],a[24:27]
s_waitcnt lgkmcnt(6)
buffer_load_dwordx4 v14, s[48:51], s22 offen offset:2048   lds
M a[28:31],a[164:167],a[92:95],a[28:31]
M a[28:31],a[160:163],a[88:91],a[28:31]
M v[60:63],a[168:171],a[88:91],v[60:63]
R a[160:163],v5,36864
R a[164:167],v6,36864
M v[60:63],a[172:175],a[92:95],v[60:63]
T a[108:109],v2,8192
T a[110:111],v2,9216
M v[56:59],a[172:175],a[84:87],v[56:59]
buffer_load_dwordx4 v15, s[48:51], s22 offen offset:3072   lds
M v[56:59],a[168:171],a[80:83],v[56:59]
s_sub_u32 s22, s22, 1048448
M v[52:55],a[168:171],a[72:75],v[52:55]
M v[52:55],a[172:175],a[76:79],v[52:55]
s_nop 0
T a[112:113],v3,0
T a[114:115],v3,1024
M v[48:51],a[172:175],a[68:71],v[48:51]
SA m0,s23,49152
M v[48:51],a[168:171],a[64:67],v[48:51]
buffer_load_dwordx4 v8, s[16:19], s21 offen offset:0  nt lds
M v[44:47],a[168:171],a[56:59],v[44:47]
M v[44:47],a[172:175],a[60:63],v[44:47]
M v[40:43],a[172:175],a[52:55],v[40:43]
s_nop 0
T a[116:117],v3,8192
T a[118:119],v3,9216
M v[40:43],a[168:171],a[48:51],v[40:43]
M v[36:39],a[168:171],a[40:43],v[36:39]
buffer_load_dwordx4 v9, s[16:19], s21 offen offset:1024  nt lds
M v[36:39],a[172:175],a[44:47],v[36:39]
s_waitcnt lgkmcnt(6)
M v[32:35],a[172:175],a[36:39],v[32:35]
M v[32:35],a[168:171],a[32:35],v[32:35]
s_nop 0
T a[120:121],v4,0
T a[122:123],v4,1024
M v[64:67],a[160:163],a[32:35],v[64:67]
R a[168:171],v5,38912
R a[172:175],v6,38912
M v[64:67],a[164:167],a[36:39],v[64:67]
buffer_load_dwordx4 v10, s[16:19], s21 offen offset:2048  nt lds
M v[68:71],a[164:167],a[44:47],v[68:71]
M v[68:71],a[160:163],a[40:43],v[68:71]
M v[72:75],a[160:163],a[48:51],v[72:75]
s_nop 0
T a[124:125],v4,8192
T a[126:127],v4,9216
M v[72:75],a[164:167],a[52:55],v[72:75]
M v[76:79],a[164:167],a[60:63],v[76:79]
buffer_load_dwordx4 v11, s[16:19], s21 offen offset:3072  nt lds
M v[76:79],a[160:163],a[56:59],v[76:79]
SA s21,s21,524160
M v[80:83],a[160:163],a[64:67],v[80:83]
M v[80:83],a[164:167],a[68:71],v[80:83]
M v[84:87],a[164:167],a[76:79],v[84:87]
M v[84:87],a[160:163],a[72:75],v[84:87]
M v[88:91],a[160:163],a[80:83],v[88:91]
M v[88:91],a[164:167],a[84:87],v[88:91]
s_waitcnt lgkmcnt(2)
M v[92:95],a[164:167],a[92:95],v[92:95]
s_waitcnt vmcnt(17) lgkmcnt(0)
M v[92:95],a[160:163],a[88:91],v[92:95]
s_barrier
M v[124:127],a[168:171],a[88:91],v[124:127]
R a[160:163],v5,49152
R a[164:167],v6,49152
M v[124:127],a[172:175],a[92:95],v[124:127]
M v[120:123],a[172:175],a[84:87],v[120:123]
SA m0,s24,32768
T a[128:129],v1,16384
T a[130:131],v1,17408
M v[120:123],a[168:171],a[80:83],v[120:123]
buffer_load_dwordx4 v12, s[48:51], s22 offen offset:0   lds
M v[116:119],a[168:171],a[72:75],v[116:119]
M v[116:119],a[172:175],a[76:79],v[116:119]
M v[112:115],a[172:175],a[68:71],v[112:115]
M v[112:115],a[168:171],a[64:67],v[112:115]
M v[108:111],a[168:171],a[56:59],v[108:111]
M v[108:111],a[172:175],a[60:63],v[108:111]
s_nop 0
T a[132:133],v1,24576
T a[134:135],v1,25600
M v[104:107],a[172:175],a[52:55],v[104:107]
buffer_load_dwordx4 v13, s[48:51], s22 offen offset:1024   lds
M v[104:107],a[168:171],a[48:51],v[104:107]
M v[100:103],a[168:171],a[40:43],v[100:103]
M v[100:103],a[172:175],a[44:47],v[100:103]
s_waitcnt lgkmcnt(4)
M v[96:99],a[172:175],a[36:39],v[96:99]
M v[96:99],a[168:171],a[32:35],v[96:99]
M v[128:131],a[160:163],a[32:35],v[128:131]
R a[168:171],v5,51200
R a[172:175],v6,51200
M v[128:131],a[164:167],a[36:39],v[128:131]
T a[136:137],v2,16384
T a[138:139],v2,17408
M v[132:135],a[164:167],a[44:47],v[132:135]
buffer_load_dwordx4 v14, s[48:51], s22 offen offset:2048   lds
M v[132:135],a[160:163],a[40:43],v[132:135]
M v[136:139],a[160:163],a[48:51],v[136:139]
M v[136:139],a[164:167],a[52:55],v[136:139]
M v[140:143],a[164:167],a[60:63],v[140:143]
M v[140:143],a[160:163],a[56:59],v[140:143]
s_nop 0
T a[140:141],v2,24576
T a[142:143],v2,25600
M v[144:147],a[160:163],a[64:67],v[144:147]
buffer_load_dwordx4 v15, s[48:51], s22 offen offset:3072   lds
M v[144:147],a[164:167],a[68:71],v[144:147]
SA s22,s22,1048576
M v[148:151],a[164:167],a[76:79],v[148:151]
M v[148:151],a[160:163],a[72:75],v[148:151]
M v[152:155],a[160:163],a[80:83],v[152:155]
M v[152:155],a[164:167],a[84:87],v[152:155]
s_waitcnt lgkmcnt(4)
M v[156:159],a[164:167],a[92:95],v[156:159]
SA m0,s23,0
T a[144:145],v3,16384
T a[146:147],v3,17408
M v[156:159],a[160:163],a[88:91],v[156:159]
buffer_load_dwordx4 v8, s[16:19], s21 offen offset:0  nt lds
M v[188:191],a[168:171],a[88:91],v[188:191]
R a[160:163],v5,53248
R a[164:167],v6,53248
M v[188:191],a[172:175],a[92:95],v[188:191]
M v[184:187],a[172:175],a[84:87],v[184:187]
M v[184:187],a[168:171],a[80:83],v[184:187]
M v[180:183],a[168:171],a[72:75],v[180:183]
M v[180:183],a[172:175],a[76:79],v[180:183]
s_nop 0
T a[148:149],v3,24576
T a[150:151],v3,25600
M v[176:179],a[172:175],a[68:71],v[176:179]
buffer_load_dwordx4 v9, s[16:19], s21 offen offset:1024  nt lds
M v[176:179],a[168:171],a[64:67],v[176:179]
M v[172:175],a[168:171],a[56:59],v[172:175]
M v[172:175],a[172:175],a[60:63],v[172:175]
M v[168:171],a[172:175],a[52:55],v[168:171]
M v[168:171],a[168:171],a[48:51],v[168:171]
M v[164:167],a[168:171],a[40:43],v[164:167]
s_nop 0
T a[152:153],v4,16384
T a[154:155],v4,17408
M v[164:167],a[172:175],a[44:47],v[164:167]
s_waitcnt lgkmcnt(4)
buffer_load_dwordx4 v10, s[16:19], s21 offen offset:2048  nt lds
M v[160:163],a[172:175],a[36:39],v[160:163]
M v[160:163],a[168:171],a[32:35],v[160:163]
M v[192:195],a[160:163],a[32:35],v[192:195]
R a[168:171],v5,55296
R a[172:175],v6,55296
M v[192:195],a[164:167],a[36:39],v[192:195]
M v[196:199],a[164:167],a[44:47],v[196:199]
M v[196:199],a[160:163],a[40:43],v[196:199]
s_nop 0
T a[156:157],v4,24576
T a[158:159],v4,25600
M v[200:203],a[160:163],a[48:51],v[200:203]
buffer_load_dwordx4 v11, s[16:19], s21 offen offset:3072  nt lds
M v[200:203],a[164:167],a[52:55],v[200:203]
SA s21,s21,128
M v[204:207],a[164:167],a[60:63],v[204:207]
M v[204:207],a[160:163],a[56:59],v[204:207]
M v[208:211],a[160:163],a[64:67],v[208:211]
M v[208:211],a[164:167],a[68:71],v[208:211]
M v[212:215],a[164:167],a[76:79],v[212:215]
M v[212:215],a[160:163],a[72:75],v[212:215]
M v[216:219],a[160:163],a[80:83],v[216:219]
M v[216:219],a[164:167],a[84:87],v[216:219]
s_waitcnt lgkmcnt(2)
M v[220:223],a[164:167],a[92:95],v[220:223]
s_waitcnt vmcnt(17) lgkmcnt(0)
M v[220:223],a[160:163],a[88:91],v[220:223]
s_barrier
M v[252:255],a[168:171],a[88:91],v[252:255]
R a[160:163],v5,0
R a[164:167],v6,0
M v[252:255],a[172:175],a[92:95],v[252:255]
buffer_load_dword a240, v23, s[52:55], 0 offen offset:0
M v[248:251],a[172:175],a[84:87],v[248:251]
v_add_u32 v23, 16384, v23
M v[248:251],a[168:171],a[80:83],v[248:251]
M v[244:247],a[168:171],a[72:75],v[244:247]
M v[244:247],a[172:175],a[76:79],v[244:247]
M v[240:243],a[172:175],a[68:71],v[240:243]
M v[240:243],a[168:171],a[64:67],v[240:243]
M v[236:239],a[168:171],a[56:59],v[236:239]
M v[236:239],a[172:175],a[60:63],v[236:239]
M v[232:235],a[172:175],a[52:55],v[232:235]
M v[232:235],a[168:171],a[48:51],v[232:235]
M v[228:231],a[168:171],a[40:43],v[228:231]
M v[228:231],a[172:175],a[44:47],v[228:231]
s_waitcnt lgkmcnt(0)
M v[224:227],a[172:175],a[36:39],v[224:227]
M v[224:227],a[168:171],a[32:35],v[224:227]
M a[0:3],a[160:163],a[96:99],a[0:3]
R a[168:171],v5,2048
R a[172:175],v6,2048
M a[0:3],a[164:167],a[100:103],a[0:3]
T a[32:33],v1,32768
T a[34:35],v1,33792
M a[4:7],a[164:167],a[108:111],a[4:7]
SA m0,s24,49152
M a[4:7],a[160:163],a[104:107],a[4:7]
buffer_load_dwordx4 v12, s[48:51], s22 offen offset:0   lds
M a[8:11],a[160:163],a[112:115],a[8:11]
M a[8:11],a[164:167],a[116:119],a[8:11]
M a[12:15],a[164:167],a[124:127],a[12:15]
s_nop 0
T a[36:37],v1,40960
T a[38:39],v1,41984
M a[12:15],a[160:163],a[120:123],a[12:15]
M a[16:19],a[160:163],a[128:131],a[16:19]
buffer_load_dwordx4 v13, s[48:51], s22 offen offset:1024   lds
M a[16:19],a[164:167],a[132:135],a[16:19]
M a[20:23],a[164:167],a[140:143],a[20:23]
M a[20:23],a[160:163],a[136:139],a[20:23]
s_nop 0
T a[40:41],v2,32768
T a[42:43],v2,33792
M a[24:27],a[160:163],a[144:147],a[24:27]
M a[24:27],a[164:167],a[148:151],a[24:27]
s_waitcnt lgkmcnt(6)
buffer_load_dwordx4 v14, s[48:51], s22 offen offset:2048   lds
M a[28:31],a[164:167],a[156:159],a[28:31]
M a[28:31],a[160:163],a[152:155],a[28:31]
M v[60:63],a[168:171],a[152:155],v[60:63]
R a[160:163],v5,4096
R a[164:167],v6,4096
M v[60:63],a[172:175],a[156:159],v[60:63]
T a[44:45],v2,40960
T a[46:47],v2,41984
M v[56:59],a[172:175],a[148:151],v[56:59]
buffer_load_dwordx4 v15, s[48:51], s22 offen offset:3072   lds
M v[56:59],a[168:171],a[144:147],v[56:59]
s_sub_u32 s22, s22, 1048448
M v[52:55],a[168:171],a[136:139],v[52:55]
M v[52:55],a[172:175],a[140:143],v[52:55]
s_nop 0
T a[48:49],v3,32768
T a[50:51],v3,33792
M v[48:51],a[172:175],a[132:135],v[48:51]
SA m0,s23,16384
M v[48:51],a[168:171],a[128:131],v[48:51]
buffer_load_dwordx4 v8, s[16:19], s21 offen offset:0  nt lds
M v[44:47],a[168:171],a[120:123],v[44:47]
M v[44:47],a[172:175],a[124:127],v[44:47]
M v[40:43],a[172:175],a[116:119],v[40:43]
s_nop 0
T a[52:53],v3,40960
T a[54:55],v3,41984
M v[40:43],a[168:171],a[112:115],v[40:43]
M v[36:39],a[168:171],a[104:107],v[36:39]
buffer_load_dwordx4 v9, s[16:19], s21 offen offset:1024  nt lds
M v[36:39],a[172:175],a[108:111],v[36:39]
s_waitcnt lgkmcnt(6)
M v[32:35],a[172:175],a[100:103],v[32:35]
M v[32:35],a[168:171],a[96:99],v[32:35]
s_nop 0
T a[56:57],v4,32768
T a[58:59],v4,33792
M v[64:67],a[160:163],a[96:99],v[64:67]
R a[168:171],v5,6144
R a[172:175],v6,6144
M v[64:67],a[164:167],a[100:103],v[64:67]
buffer_load_dwordx4 v10, s[16:19], s21 offen offset:2048  nt lds
M v[68:71],a[164:167],a[108:111],v[68:71]
M v[68:71],a[160:163],a[104:107],v[68:71]
M v[72:75],a[160:163],a[112:115],v[72:75]
s_nop 0
T a[60:61],v4,40960
T a[62:63],v4,41984
M v[72:75],a[164:167],a[116:119],v[72:75]
M v[76:79],a[164:167],a[124:127],v[76:79]
buffer_load_dwordx4 v11, s[16:19], s21 offen offset:3072  nt lds
M v[76:79],a[160:163],a[120:123],v[76:79]
SA s21,s21,524160
M v[80:83],a[160:163],a[128:131],v[80:83]
M v[80:83],a[164:167],a[132:135],v[80:83]
M v[84:87],a[164:167],a[140:143],v[84:87]
M v[84:87],a[160:163],a[136:139],v[84:87]
M v[88:91],a[160:163],a[144:147],v[88:91]
M v[88:91],a[164:167],a[148:151],v[88:91]
s_waitcnt lgkmcnt(2)
M v[92:95],a[164:167],a[156:159],v[92:95]
s_waitcnt vmcnt(17) lgkmcnt(0)
M v[92:95],a[160:163],a[152:155],v[92:95]
s_barrier
M v[124:127],a[168:171],a[152:155],v[124:127]
R a[160:163],v5,16384
R a[164:167],v6,16384
M v[124:127],a[172:175],a[156:159],v[124:127]
M v[120:123],a[172:175],a[148:151],v[120:123]
SA m0,s24,0
T a[64:65],v1,49152
T a[66:67],v1,50176
M v[120:123],a[168:171],a[144:147],v[120:123]
buffer_load_dwordx4 v12, s[48:51], s22 offen offset:0   lds
M v[116:119],a[168:171],a[136:139],v[116:119]
M v[116:119],a[172:175],a[140:143],v[116:119]
M v[112:115],a[172:175],a[132:135],v[112:115]
M v[112:115],a[168:171],a[128:131],v[112:115]
M v[108:111],a[168:171],a[120:123],v[108:111]
M v[108:111],a[172:175],a[124:127],v[108:111]
s_nop 0
T a[68:69],v1,57344
T a[70:71],v1,58368
M v[104:107],a[172:175],a[116:119],v[104:107]
buffer_load_dwordx4 v13, s[48:51], s22 offen offset:1024   lds
M v[104:107],a[168:171],a[112:115],v[104:107]
M v[100:103],a[168:171],a[104:107],v[100:103]
M v[100:103],a[172:175],a[108:111],v[100:103]
s_waitcnt lgkmcnt(4)
M v[96:99],a[172:175],a[100:103],v[96:99]
M v[96:99],a[168:171],a[96:99],v[96:99]
M v[128:131],a[160:163],a[96:99],v[128:131]
R a[168:171],v5,18432
R a[172:175],v6,18432
M v[128:131],a[164:167],a[100:103],v[128:131]
T a[72:73],v2,49152
T a[74:75],v2,50176
M v[132:135],a[164:167],a[108:111],v[132:135]
buffer_load_dwordx4 v14, s[48:51], s22 offen offset:2048   lds
M v[132:135],a[160:163],a[104:107],v[132:135]
M v[136:139],a[160:163],a[112:115],v[136:139]
M v[136:139],a[164:167],a[116:119],v[136:139]
M v[140:143],a[164:167],a[124:127],v[140:143]
M v[140:143],a[160:163],a[120:123],v[140:143]
s_nop 0
T a[76:77],v2,57344
T a[78:79],v2,58368
M v[144:147],a[160:163],a[128:131],v[144:147]
buffer_load_dwordx4 v15, s[48:51], s22 offen offset:3072   lds
M v[144:147],a[164:167],a[132:135],v[144:147]
SA s22,s22,1048576
M v[148:151],a[164:167],a[140:143],v[148:151]
M v[148:151],a[160:163],a[136:139],v[148:151]
M v[152:155],a[160:163],a[144:147],v[152:155]
M v[152:155],a[164:167],a[148:151],v[152:155]
s_waitcnt lgkmcnt(4)
M v[156:159],a[164:167],a[156:159],v[156:159]
SA m0,s23,32768
T a[80:81],v3,49152
T a[82:83],v3,50176
M v[156:159],a[160:163],a[152:155],v[156:159]
buffer_load_dwordx4 v8, s[16:19], s21 offen offset:0  nt lds
M v[188:191],a[168:171],a[152:155],v[188:191]
R a[160:163],v5,20480
R a[164:167],v6,20480
M v[188:191],a[172:175],a[156:159],v[188:191]
M v[184:187],a[172:175],a[148:151],v[184:187]
M v[184:187],a[168:171],a[144:147],v[184:187]
M v[180:183],a[168:171],a[136:139],v[180:183]
M v[180:183],a[172:175],a[140:143],v[180:183]
s_nop 0
T a[84:85],v3,57344
T a[86:87],v3,58368
M v[176:179],a[172:175],a[132:135],v[176:179]
buffer_load_dwordx4 v9, s[16:19], s21 offen offset:1024  nt lds
M v[176:179],a[168:171],a[128:131],v[176:179]
M v[172:175],a[168:171],a[120:123],v[172:175]
M v[172:175],a[172:175],a[124:127],v[172:175]
M v[168:171],a[172:175],a[116:119],v[168:171]
M v[168:171],a[168:171],a[112:115],v[168:171]
M v[164:167],a[168:171],a[104:107],v[164:167]
s_nop 0
T a[88:89],v4,49152
T a[90:91],v4,50176
M v[164:167],a[172:175],a[108:111],v[164:167]
s_waitcnt lgkmcnt(4)
buffer_load_dwordx4 v10, s[16:19], s21 offen offset:2048  nt lds
M v[160:163],a[172:175],a[100:103],v[160:163]
M v[160:163],a[168:171],a[96:99],v[160:163]
M v[192:195],a[160:163],a[96:99],v[192:195]
R a[168:171],v5,22528
R a[172:175],v6,22528
M v[192:195],a[164:167],a[100:103],v[192:195]
M v[196:199],a[164:167],a[108:111],v[196:199]
M v[196:199],a[160:163],a[104:107],v[196:199]
s_nop 0
T a[92:93],v4,57344
T a[94:95],v4,58368
M v[200:203],a[160:163],a[112:115],v[200:203]
buffer_load_dwordx4 v11, s[16:19], s21 offen offset:3072  nt lds
M v[200:203],a[164:167],a[116:119],v[200:203]
SA s21,s21,128
M v[204:207],a[164:167],a[124:127],v[204:207]
M v[204:207],a[160:163],a[120:123],v[204:207]
M v[208:211],a[160:163],a[128:131],v[208:211]
M v[208:211],a[164:167],a[132:135],v[208:211]
M v[212:215],a[164:167],a[140:143],v[212:215]
M v[212:215],a[160:163],a[136:139],v[212:215]
M v[216:219],a[160:163],a[144:147],v[216:219]
M v[216:219],a[164:167],a[148:151],v[216:219]
s_waitcnt lgkmcnt(2)
M v[220:223],a[164:167],a[156:159],v[220:223]
s_waitcnt vmcnt(17) lgkmcnt(0)
M v[220:223],a[160:163],a[152:155],v[220:223]
s_barrier
M v[252:255],a[168:171],a[152:155],v[252:255]
R a[160:163],v5,32768
R a[164:167],v6,32768
M v[252:255],a[172:175],a[156:159],v[252:255]
buffer_load_dword a240, v23, s[52:55], 0 offen offset:0
M v[248:251],a[172:175],a[148:151],v[248:251]
L_w_kv15:
s_cbranch_execz L_wd2
v_add_u32 v23, 16384, v23
M v[248:251],a[168:171],a[144:147],v[248:251]
M v[244:247],a[168:171],a[136:139],v[244:247]
M v[244:247],a[172:175],a[140:143],v[244:247]
M v[240:243],a[172:175],a[132:135],v[240:243]
M v[240:243],a[168:171],a[128:131],v[240:243]
M v[236:239],a[168:171],a[120:123],v[236:239]
M v[236:239],a[172:175],a[124:127],v[236:239]
M v[232:235],a[172:175],a[116:119],v[232:235]
M v[232:235],a[168:171],a[112:115],v[232:235]
M v[228:231],a[168:171],a[104:107],v[228:231]
M v[228:231],a[172:175],a[108:111],v[228:231]
s_waitcnt lgkmcnt(0)
M v[224:227],a[172:175],a[100:103],v[224:227]
M v[224:227],a[168:171],a[96:99],v[224:227]
M a[0:3],a[160:163],a[32:35],a[0:3]
R a[168:171],v5,34816
R a[172:175],v6,34816
M a[0:3],a[164:167],a[36:39],a[0:3]
T a[96:97],v1,0
T a[98:99],v1,1024
M a[4:7],a[164:167],a[44:47],a[4:7]
SA m0,s24,16384
M a[4:7],a[160:163],a[40:43],a[4:7]
buffer_load_dwordx4 v12, s[48:51], s22 offen offset:0   lds
M a[8:11],a[160:163],a[48:51],a[8:11]
M a[8:11],a[164:167],a[52:55],a[8:11]
M a[12:15],a[164:167],a[60:63],a[12:15]
s_nop 0
T a[100:101],v1,8192
T a[102:103],v1,9216
M a[12:15],a[160:163],a[56:59],a[12:15]
M a[16:19],a[160:163],a[64:67],a[16:19]
buffer_load_dwordx4 v13, s[48:51], s22 offen offset:1024   lds
M a[16:19],a[164:167],a[68:71],a[16:19]
M a[20:23],a[164:167],a[76:79],a[20:23]
M a[20:23],a[160:163],a[72:75],a[20:23]
s_nop 0
T a[104:105],v2,0
T a[106:107],v2,1024
M a[24:27],a[160:163],a[80:83],a[24:27]
M a[24:27],a[164:167],a[84:87],a[24:27]
s_waitcnt lgkmcnt(6)
buffer_load_dwordx4 v14, s[48:51], s22 offen offset:2048   lds
M a[28:31],a[164:167],a[92:95],a[28:31]
M a[28:31],a[160:163],a[88:91],a[28:31]
M v[60:63],a[168:171],a[88:91],v[60:63]
R a[160:163],v5,36864
R a[164:167],v6,36864
M v[60:63],a[172:175],a[92:95],v[60:63]
T a[108:109],v2,8192
T a[110:111],v2,9216
M v[56:59],a[172:175],a[84:87],v[56:59]
buffer_load_dwordx4 v15, s[48:51], s22 offen offset:3072   lds
M v[56:59],a[168:171],a[80:83],v[56:59]
s_sub_u32 s22, s22, 1048448
M v[52:55],a[168:171],a[72:75],v[52:55]
M v[52:55],a[172:175],a[76:79],v[52:55]
s_nop 0
T a[112:113],v3,0
T a[114:115],v3,1024
M v[48:51],a[172:175],a[68:71],v[48:51]
SA m0,s23,49152
M v[48:51],a[168:171],a[64:67],v[48:51]
buffer_load_dwordx4 v8, s[16:19], s21 offen offset:0  nt lds
M v[44:47],a[168:171],a[56:59],v[44:47]
M v[44:47],a[172:175],a[60:63],v[44:47]
M v[40:43],a[172:175],a[52:55],v[40:43]
s_nop 0
T a[116:117],v3,8192
T a[118:119],v3,9216
M v[40:43],a[168:171],a[48:51],v[40:43]
M v[36:39],a[168:171],a[40:43],v[36:39]
buffer_load_dwordx4 v9, s[16:19], s21 offen offset:1024  nt lds
M v[36:39],a[172:175],a[44:47],v[36:39]
s_waitcnt lgkmcnt(6)
M v[32:35],a[172:175],a[36:39],v[32:35]
M v[32:35],a[168:171],a[32:35],v[32:35]
s_nop 0
T a[120:121],v4,0
T a[122:123],v4,1024
M v[64:67],a[160:163],a[32:35],v[64:67]
R a[168:171],v5,38912
R a[172:175],v6,38912
M v[64:67],a[164:167],a[36:39],v[64:67]
buffer_load_dwordx4 v10, s[16:19], s21 offen offset:2048  nt lds
M v[68:71],a[164:167],a[44:47],v[68:71]
M v[68:71],a[160:163],a[40:43],v[68:71]
M v[72:75],a[160:163],a[48:51],v[72:75]
s_nop 0
T a[124:125],v4,8192
T a[126:127],v4,9216
M v[72:75],a[164:167],a[52:55],v[72:75]
M v[76:79],a[164:167],a[60:63],v[76:79]
buffer_load_dwordx4 v11, s[16:19], s21 offen offset:3072  nt lds
M v[76:79],a[160:163],a[56:59],v[76:79]
SA s21,s21,524160
M v[80:83],a[160:163],a[64:67],v[80:83]
M v[80:83],a[164:167],a[68:71],v[80:83]
M v[84:87],a[164:167],a[76:79],v[84:87]
M v[84:87],a[160:163],a[72:75],v[84:87]
M v[88:91],a[160:163],a[80:83],v[88:91]
M v[88:91],a[164:167],a[84:87],v[88:91]
s_waitcnt lgkmcnt(2)
M v[92:95],a[164:167],a[92:95],v[92:95]
s_waitcnt vmcnt(17) lgkmcnt(0)
M v[92:95],a[160:163],a[88:91],v[92:95]
s_barrier
M v[124:127],a[168:171],a[88:91],v[124:127]
R a[160:163],v5,49152
R a[164:167],v6,49152
M v[124:127],a[172:175],a[92:95],v[124:127]
M v[120:123],a[172:175],a[84:87],v[120:123]
SA m0,s24,32768
T a[128:129],v1,16384
T a[130:131],v1,17408
M v[120:123],a[168:171],a[80:83],v[120:123]
buffer_load_dwordx4 v12, s[48:51], s22 offen offset:0   lds
M v[116:119],a[168:171],a[72:75],v[116:119]
M v[116:119],a[172:175],a[76:79],v[116:119]
M v[112:115],a[172:175],a[68:71],v[112:115]
M v[112:115],a[168:171],a[64:67],v[112:115]
M v[108:111],a[168:171],a[56:59],v[108:111]
M v[108:111],a[172:175],a[60:63],v[108:111]
s_nop 0
T a[132:133],v1,24576
T a[134:135],v1,25600
M v[104:107],a[172:175],a[52:55],v[104:107]
buffer_load_dwordx4 v13, s[48:51], s22 offen offset:1024   lds
M v[104:107],a[168:171],a[48:51],v[104:107]
M v[100:103],a[168:171],a[40:43],v[100:103]
M v[100:103],a[172:175],a[44:47],v[100:103]
s_waitcnt lgkmcnt(4)
M v[96:99],a[172:175],a[36:39],v[96:99]
M v[96:99],a[168:171],a[32:35],v[96:99]
M v[128:131],a[160:163],a[32:35],v[128:131]
R a[168:171],v5,51200
R a[172:175],v6,51200
M v[128:131],a[164:167],a[36:39],v[128:131]
T a[136:137],v2,16384
T a[138:139],v2,17408
M v[132:135],a[164:167],a[44:47],v[132:135]
buffer_load_dwordx4 v14, s[48:51], s22 offen offset:2048   lds
M v[132:135],a[160:163],a[40:43],v[132:135]
M v[136:139],a[160:163],a[48:51],v[136:139]
M v[136:139],a[164:167],a[52:55],v[136:139]
M v[140:143],a[164:167],a[60:63],v[140:143]
M v[140:143],a[160:163],a[56:59],v[140:143]
s_nop 0
T a[140:141],v2,24576
T a[142:143],v2,25600
M v[144:147],a[160:163],a[64:67],v[144:147]
buffer_load_dwordx4 v15, s[48:51], s22 offen offset:3072   lds
M v[144:147],a[164:167],a[68:71],v[144:147]
SA s22,s22,1048576
M v[148:151],a[164:167],a[76:79],v[148:151]
M v[148:151],a[160:163],a[72:75],v[148:151]
M v[152:155],a[160:163],a[80:83],v[152:155]
M v[152:155],a[164:167],a[84:87],v[152:155]
s_waitcnt lgkmcnt(4)
M v[156:159],a[164:167],a[92:95],v[156:159]
SA m0,s23,0
T a[144:145],v3,16384
T a[146:147],v3,17408
M v[156:159],a[160:163],a[88:91],v[156:159]
buffer_load_dwordx4 v8, s[16:19], s21 offen offset:0  nt lds
M v[188:191],a[168:171],a[88:91],v[188:191]
R a[160:163],v5,53248
R a[164:167],v6,53248
M v[188:191],a[172:175],a[92:95],v[188:191]
M v[184:187],a[172:175],a[84:87],v[184:187]
M v[184:187],a[168:171],a[80:83],v[184:187]
M v[180:183],a[168:171],a[72:75],v[180:183]
M v[180:183],a[172:175],a[76:79],v[180:183]
s_nop 0
T a[148:149],v3,24576
T a[150:151],v3,25600
M v[176:179],a[172:175],a[68:71],v[176:179]
buffer_load_dwordx4 v9, s[16:19], s21 offen offset:1024  nt lds
M v[176:179],a[168:171],a[64:67],v[176:179]
M v[172:175],a[168:171],a[56:59],v[172:175]
M v[172:175],a[172:175],a[60:63],v[172:175]
M v[168:171],a[172:175],a[52:55],v[168:171]
M v[168:171],a[168:171],a[48:51],v[168:171]
M v[164:167],a[168:171],a[40:43],v[164:167]
s_nop 0
T a[152:153],v4,16384
T a[154:155],v4,17408
M v[164:167],a[172:175],a[44:47],v[164:167]
s_waitcnt lgkmcnt(4)
buffer_load_dwordx4 v10, s[16:19], s21 offen offset:2048  nt lds
M v[160:163],a[172:175],a[36:39],v[160:163]
M v[160:163],a[168:171],a[32:35],v[160:163]
M v[192:195],a[160:163],a[32:35],v[192:195]
R a[168:171],v5,55296
R a[172:175],v6,55296
M v[192:195],a[164:167],a[36:39],v[192:195]
M v[196:199],a[164:167],a[44:47],v[196:199]
M v[196:199],a[160:163],a[40:43],v[196:199]
s_nop 0
T a[156:157],v4,24576
T a[158:159],v4,25600
M v[200:203],a[160:163],a[48:51],v[200:203]
buffer_load_dwordx4 v11, s[16:19], s21 offen offset:3072  nt lds
M v[200:203],a[164:167],a[52:55],v[200:203]
SA s21,s21,128
M v[204:207],a[164:167],a[60:63],v[204:207]
M v[204:207],a[160:163],a[56:59],v[204:207]
M v[208:211],a[160:163],a[64:67],v[208:211]
M v[208:211],a[164:167],a[68:71],v[208:211]
M v[212:215],a[164:167],a[76:79],v[212:215]
M v[212:215],a[160:163],a[72:75],v[212:215]
M v[216:219],a[160:163],a[80:83],v[216:219]
M v[216:219],a[164:167],a[84:87],v[216:219]
s_waitcnt lgkmcnt(2)
M v[220:223],a[164:167],a[92:95],v[220:223]
s_waitcnt vmcnt(17) lgkmcnt(0)
M v[220:223],a[160:163],a[88:91],v[220:223]
s_barrier
M v[252:255],a[168:171],a[88:91],v[252:255]
R a[160:163],v5,0
R a[164:167],v6,0
M v[252:255],a[172:175],a[92:95],v[252:255]
M v[248:251],a[172:175],a[84:87],v[248:251]
M v[248:251],a[168:171],a[80:83],v[248:251]
M v[244:247],a[168:171],a[72:75],v[244:247]
M v[244:247],a[172:175],a[76:79],v[244:247]
M v[240:243],a[172:175],a[68:71],v[240:243]
M v[240:243],a[168:171],a[64:67],v[240:243]
M v[236:239],a[168:171],a[56:59],v[236:239]
M v[236:239],a[172:175],a[60:63],v[236:239]
M v[232:235],a[172:175],a[52:55],v[232:235]
M v[232:235],a[168:171],a[48:51],v[232:235]
M v[228:231],a[168:171],a[40:43],v[228:231]
M v[228:231],a[172:175],a[44:47],v[228:231]
s_waitcnt lgkmcnt(0)
M v[224:227],a[172:175],a[36:39],v[224:227]
M v[224:227],a[168:171],a[32:35],v[224:227]
M a[0:3],a[160:163],a[96:99],a[0:3]
R a[168:171],v5,2048
R a[172:175],v6,2048
M a[0:3],a[164:167],a[100:103],a[0:3]
T a[32:33],v1,32768
T a[34:35],v1,33792
M a[4:7],a[164:167],a[108:111],a[4:7]
SA m0,s24,49152
v_lshrrev_b32 v28, 4, v0
v_and_b32 v29, 7, v0
M a[4:7],a[160:163],a[104:107],a[4:7]
buffer_load_dwordx4 v12, s[48:51], s22 offen offset:0   lds
M a[8:11],a[160:163],a[112:115],a[8:11]
v_xor_b32 v28, v28, v29
v_lshlrev_b32 v28, 4, v28
M a[8:11],a[164:167],a[116:119],a[8:11]
v_lshrrev_b32 v29, 3, v0
v_mul_u32_u24 v29, 896, v29
M a[12:15],a[164:167],a[124:127],a[12:15]
T a[36:37],v1,40960
T a[38:39],v1,41984
M a[12:15],a[160:163],a[120:123],a[12:15]
v_add_u32 v22, v28, v29
v_xor_b32 v28, 64, v28
M a[16:19],a[160:163],a[128:131],a[16:19]
s_mul_i32 s64, s20, 14336
buffer_load_dwordx4 v13, s[48:51], s22 offen offset:1024   lds
M a[16:19],a[164:167],a[132:135],a[16:19]
s_sub_u32 s65, 98304, s64
M a[20:23],a[164:167],a[140:143],a[20:23]
SA s30,s29,s65
M a[20:23],a[160:163],a[136:139],a[20:23]
SA s29,s29,s64
T a[40:41],v2,32768
T a[42:43],v2,33792
M a[24:27],a[160:163],a[144:147],a[24:27]
v_add_u32 v29, 6144, v29
v_add_u32 v23, v28, v29
M a[24:27],a[164:167],a[148:151],a[24:27]
s_waitcnt lgkmcnt(6)
buffer_load_dwordx4 v14, s[48:51], s22 offen offset:2048   lds
M a[28:31],a[164:167],a[156:159],a[28:31]
s_and_b32 s64, s20, 1
M a[28:31],a[160:163],a[152:155],a[28:31]
s_lshl_b32 s64, s64, 12
M v[60:63],a[168:171],a[152:155],v[60:63]
SA s64,s64,65536
R a[160:163],v5,4096
R a[164:167],v6,4096
M v[60:63],a[172:175],a[156:159],v[60:63]
T a[44:45],v2,40960
T a[46:47],v2,41984
M v[56:59],a[172:175],a[148:151],v[56:59]
buffer_load_dwordx4 v15, s[48:51], s22 offen offset:3072   lds
M v[56:59],a[168:171],a[144:147],v[56:59]
s_sub_u32 s22, s22, 1048448
v_add_u32 v20, s64, v5
v_add_u32 v21, s64, v6
M v[52:55],a[168:171],a[136:139],v[52:55]
M v[52:55],a[172:175],a[140:143],v[52:55]
s_nop 0
T a[48:49],v3,32768
T a[50:51],v3,33792
M v[48:51],a[172:175],a[132:135],v[48:51]
SA m0,s23,16384
M v[48:51],a[168:171],a[128:131],v[48:51]
buffer_load_dwordx4 v8, s[16:19], s21 offen offset:0  nt lds
M v[44:47],a[168:171],a[120:123],v[44:47]
M v[44:47],a[172:175],a[124:127],v[44:47]
M v[40:43],a[172:175],a[116:119],v[40:43]
s_nop 0
T a[52:53],v3,40960
T a[54:55],v3,41984
M v[40:43],a[168:171],a[112:115],v[40:43]
M v[36:39],a[168:171],a[104:107],v[36:39]
buffer_load_dwordx4 v9, s[16:19], s21 offen offset:1024  nt lds
M v[36:39],a[172:175],a[108:111],v[36:39]
s_waitcnt lgkmcnt(6)
M v[32:35],a[172:175],a[100:103],v[32:35]
M v[32:35],a[168:171],a[96:99],v[32:35]
s_nop 0
T a[56:57],v4,32768
T a[58:59],v4,33792
M v[64:67],a[160:163],a[96:99],v[64:67]
R a[168:171],v5,6144
R a[172:175],v6,6144
M v[64:67],a[164:167],a[100:103],v[64:67]
buffer_load_dwordx4 v10, s[16:19], s21 offen offset:2048  nt lds
M v[68:71],a[164:167],a[108:111],v[68:71]
M v[68:71],a[160:163],a[104:107],v[68:71]
M v[72:75],a[160:163],a[112:115],v[72:75]
s_nop 0
T a[60:61],v4,40960
T a[62:63],v4,41984
M v[72:75],a[164:167],a[116:119],v[72:75]
M v[76:79],a[164:167],a[124:127],v[76:79]
buffer_load_dwordx4 v11, s[16:19], s21 offen offset:3072  nt lds
M v[76:79],a[160:163],a[120:123],v[76:79]
SA s21,s21,524160
M v[80:83],a[160:163],a[128:131],v[80:83]
M v[80:83],a[164:167],a[132:135],v[80:83]
M v[84:87],a[164:167],a[140:143],v[84:87]
M v[84:87],a[160:163],a[136:139],v[84:87]
M v[88:91],a[160:163],a[144:147],v[88:91]
M v[88:91],a[164:167],a[148:151],v[88:91]
s_waitcnt lgkmcnt(2)
M v[92:95],a[164:167],a[156:159],v[92:95]
s_waitcnt vmcnt(16) lgkmcnt(0)
M v[92:95],a[160:163],a[152:155],v[92:95]
s_barrier
M v[124:127],a[168:171],a[152:155],v[124:127]
R a[160:163],v5,16384
R a[164:167],v6,16384
M v[124:127],a[172:175],a[156:159],v[124:127]
SA m0,s23,131072
M v[120:123],a[172:175],a[148:151],v[120:123]
s_nop 0
T a[64:65],v1,49152
T a[66:67],v1,50176
M v[120:123],a[168:171],a[144:147],v[120:123]
buffer_load_dwordx4 v22, s[56:59], s29 offen offset:0 lds
M v[116:119],a[168:171],a[136:139],v[116:119]
M v[116:119],a[172:175],a[140:143],v[116:119]
M v[112:115],a[172:175],a[132:135],v[112:115]
buffer_load_dwordx4 v23, s[56:59], s29 offen offset:1024 lds
M v[112:115],a[168:171],a[128:131],v[112:115]
M v[108:111],a[168:171],a[120:123],v[108:111]
M v[108:111],a[172:175],a[124:127],v[108:111]
s_nop 0
T a[68:69],v1,57344
T a[70:71],v1,58368
M v[104:107],a[172:175],a[116:119],v[104:107]
buffer_load_dwordx4 v22, s[56:59], s30 offen offset:2048 lds
M v[104:107],a[168:171],a[112:115],v[104:107]
M v[100:103],a[168:171],a[104:107],v[100:103]
M v[100:103],a[172:175],a[108:111],v[100:103]
s_waitcnt lgkmcnt(4)
M v[96:99],a[172:175],a[100:103],v[96:99]
M v[96:99],a[168:171],a[96:99],v[96:99]
buffer_load_dwordx4 v23, s[56:59], s30 offen offset:3072 lds
M v[128:131],a[160:163],a[96:99],v[128:131]
R a[168:171],v5,18432
R a[172:175],v6,18432
M v[128:131],a[164:167],a[100:103],v[128:131]
SA s29,s29,128
T a[72:73],v2,49152
T a[74:75],v2,50176
M v[132:135],a[164:167],a[108:111],v[132:135]
SA s30,s30,128
M v[132:135],a[160:163],a[104:107],v[132:135]
SA m0,s24,0
M v[136:139],a[160:163],a[112:115],v[136:139]
buffer_load_dwordx4 v12, s[48:51], s22 offen offset:0   lds
M v[136:139],a[164:167],a[116:119],v[136:139]
M v[140:143],a[164:167],a[124:127],v[140:143]
M v[140:143],a[160:163],a[120:123],v[140:143]
s_nop 0
T a[76:77],v2,57344
T a[78:79],v2,58368
M v[144:147],a[160:163],a[128:131],v[144:147]
buffer_load_dwordx4 v13, s[48:51], s22 offen offset:1024   lds
M v[144:147],a[164:167],a[132:135],v[144:147]
M v[148:151],a[164:167],a[140:143],v[148:151]
M v[148:151],a[160:163],a[136:139],v[148:151]
M v[152:155],a[160:163],a[144:147],v[152:155]
M v[152:155],a[164:167],a[148:151],v[152:155]
s_waitcnt lgkmcnt(4)
buffer_load_dwordx4 v14, s[48:51], s22 offen offset:2048   lds
M v[156:159],a[164:167],a[156:159],v[156:159]
s_nop 0
T a[80:81],v3,49152
T a[82:83],v3,50176
M v[156:159],a[160:163],a[152:155],v[156:159]
M v[188:191],a[168:171],a[152:155],v[188:191]
R a[160:163],v5,20480
R a[164:167],v6,20480
M v[188:191],a[172:175],a[156:159],v[188:191]
M v[184:187],a[172:175],a[148:151],v[184:187]
buffer_load_dwordx4 v15, s[48:51], s22 offen offset:3072   lds
M v[184:187],a[168:171],a[144:147],v[184:187]
M v[180:183],a[168:171],a[136:139],v[180:183]
M v[180:183],a[172:175],a[140:143],v[180:183]
SA s22,s22,1048576
T a[84:85],v3,57344
T a[86:87],v3,58368
M v[176:179],a[172:175],a[132:135],v[176:179]
SA m0,s23,32768
M v[176:179],a[168:171],a[128:131],v[176:179]
buffer_load_dwordx4 v8, s[16:19], s21 offen offset:0  nt lds
M v[172:175],a[168:171],a[120:123],v[172:175]
M v[172:175],a[172:175],a[124:127],v[172:175]
M v[168:171],a[172:175],a[116:119],v[168:171]
M v[168:171],a[168:171],a[112:115],v[168:171]
buffer_load_dwordx4 v9, s[16:19], s21 offen offset:1024  nt lds
M v[164:167],a[168:171],a[104:107],v[164:167]
s_nop 0
T a[88:89],v4,49152
T a[90:91],v4,50176
M v[164:167],a[172:175],a[108:111],v[164:167]
s_waitcnt lgkmcnt(4)
M v[160:163],a[172:175],a[100:103],v[160:163]
M v[160:163],a[168:171],a[96:99],v[160:163]
M v[192:195],a[160:163],a[96:99],v[192:195]
R a[168:171],v5,22528
R a[172:175],v6,22528
M v[192:195],a[164:167],a[100:103],v[192:195]
buffer_load_dwordx4 v10, s[16:19], s21 offen offset:2048  nt lds
M v[196:199],a[164:167],a[108:111],v[196:199]
M v[196:199],a[160:163],a[104:107],v[196:199]
s_nop 0
T a[92:93],v4,57344
T a[94:95],v4,58368
M v[200:203],a[160:163],a[112:115],v[200:203]
M v[200:203],a[164:167],a[116:119],v[200:203]
buffer_load_dwordx4 v11, s[16:19], s21 offen offset:3072  nt lds
M v[204:207],a[164:167],a[124:127],v[204:207]
M v[204:207],a[160:163],a[120:123],v[204:207]
M v[208:211],a[160:163],a[128:131],v[208:211]
M v[208:211],a[164:167],a[132:135],v[208:211]
M v[212:215],a[164:167],a[140:143],v[212:215]
SA s21,s21,128
M v[212:215],a[160:163],a[136:139],v[212:215]
M v[216:219],a[160:163],a[144:147],v[216:219]
M v[216:219],a[164:167],a[148:151],v[216:219]
s_waitcnt lgkmcnt(2)
M v[220:223],a[164:167],a[156:159],v[220:223]
s_waitcnt vmcnt(20) lgkmcnt(0)
M v[220:223],a[160:163],a[152:155],v[220:223]
s_barrier
M v[252:255],a[168:171],a[152:155],v[252:255]
R a[160:163],v5,32768
R a[164:167],v6,32768
M v[252:255],a[172:175],a[156:159],v[252:255]
M v[248:251],a[172:175],a[148:151],v[248:251]
M v[248:251],a[168:171],a[144:147],v[248:251]
M v[244:247],a[168:171],a[136:139],v[244:247]
M v[244:247],a[172:175],a[140:143],v[244:247]
M v[240:243],a[172:175],a[132:135],v[240:243]
M v[240:243],a[168:171],a[128:131],v[240:243]
M v[236:239],a[168:171],a[120:123],v[236:239]
M v[236:239],a[172:175],a[124:127],v[236:239]
M v[232:235],a[172:175],a[116:119],v[232:235]
M v[232:235],a[168:171],a[112:115],v[232:235]
M v[228:231],a[168:171],a[104:107],v[228:231]
M v[228:231],a[172:175],a[108:111],v[228:231]
s_waitcnt lgkmcnt(0)
M v[224:227],a[172:175],a[100:103],v[224:227]
M v[224:227],a[168:171],a[96:99],v[224:227]
M a[0:3],a[160:163],a[32:35],a[0:3]
R a[168:171],v5,34816
R a[172:175],v6,34816
M a[0:3],a[164:167],a[36:39],a[0:3]
SA m0,s23,147456
T a[96:97],v1,0
T a[98:99],v1,1024
M a[4:7],a[164:167],a[44:47],a[4:7]
buffer_load_dwordx4 v22, s[56:59], s29 offen offset:0 lds
M a[4:7],a[160:163],a[40:43],a[4:7]
M a[8:11],a[160:163],a[48:51],a[8:11]
M a[8:11],a[164:167],a[52:55],a[8:11]
buffer_load_dwordx4 v23, s[56:59], s29 offen offset:1024 lds
M a[12:15],a[164:167],a[60:63],a[12:15]
s_nop 0
T a[100:101],v1,8192
T a[102:103],v1,9216
M a[12:15],a[160:163],a[56:59],a[12:15]
M a[16:19],a[160:163],a[64:67],a[16:19]
buffer_load_dwordx4 v22, s[56:59], s30 offen offset:2048 lds
M a[16:19],a[164:167],a[68:71],a[16:19]
M a[20:23],a[164:167],a[76:79],a[20:23]
M a[20:23],a[160:163],a[72:75],a[20:23]
s_nop 0
T a[104:105],v2,0
T a[106:107],v2,1024
M a[24:27],a[160:163],a[80:83],a[24:27]
buffer_load_dwordx4 v23, s[56:59], s30 offen offset:3072 lds
M a[24:27],a[164:167],a[84:87],a[24:27]
s_waitcnt lgkmcnt(6)
M a[28:31],a[164:167],a[92:95],a[28:31]
SA s29,s29,128
M a[28:31],a[160:163],a[88:91],a[28:31]
SA s30,s30,128
M v[60:63],a[168:171],a[88:91],v[60:63]
SA m0,s24,16384
R a[160:163],v5,36864
R a[164:167],v6,36864
M v[60:63],a[172:175],a[92:95],v[60:63]
T a[108:109],v2,8192
T a[110:111],v2,9216
M v[56:59],a[172:175],a[84:87],v[56:59]
buffer_load_dwordx4 v12, s[48:51], s22 offen offset:0   lds
M v[56:59],a[168:171],a[80:83],v[56:59]
M v[52:55],a[168:171],a[72:75],v[52:55]
M v[52:55],a[172:175],a[76:79],v[52:55]
s_nop 0
T a[112:113],v3,0
T a[114:115],v3,1024
M v[48:51],a[172:175],a[68:71],v[48:51]
buffer_load_dwordx4 v13, s[48:51], s22 offen offset:1024   lds
M v[48:51],a[168:171],a[64:67],v[48:51]
M v[44:47],a[168:171],a[56:59],v[44:47]
M v[44:47],a[172:175],a[60:63],v[44:47]
buffer_load_dwordx4 v14, s[48:51], s22 offen offset:2048   lds
M v[40:43],a[172:175],a[52:55],v[40:43]
s_nop 0
T a[116:117],v3,8192
T a[118:119],v3,9216
L_w_kv16:
s_cbranch_execz L_wd2
M v[40:43],a[168:171],a[48:51],v[40:43]
M v[36:39],a[168:171],a[40:43],v[36:39]
buffer_load_dwordx4 v15, s[48:51], s22 offen offset:3072   lds
M v[36:39],a[172:175],a[44:47],v[36:39]
s_waitcnt lgkmcnt(6)
M v[32:35],a[172:175],a[36:39],v[32:35]
s_sub_u32 s22, s22, 1048448
M v[32:35],a[168:171],a[32:35],v[32:35]
SA m0,s23,49152
T a[120:121],v4,0
T a[122:123],v4,1024
M v[64:67],a[160:163],a[32:35],v[64:67]
R a[168:171],v5,38912
R a[172:175],v6,38912
M v[64:67],a[164:167],a[36:39],v[64:67]
buffer_load_dwordx4 v8, s[16:19], s21 offen offset:0  nt lds
M v[68:71],a[164:167],a[44:47],v[68:71]
M v[68:71],a[160:163],a[40:43],v[68:71]
M v[72:75],a[160:163],a[48:51],v[72:75]
s_waitcnt vmcnt(17)
s_nop 0
T a[124:125],v4,8192
T a[126:127],v4,9216
M v[72:75],a[164:167],a[52:55],v[72:75]
buffer_load_dwordx4 v9, s[16:19], s21 offen offset:1024  nt lds
M v[76:79],a[164:167],a[60:63],v[76:79]
R a[176:179],v20,0
R a[180:183],v20,2048
M v[76:79],a[160:163],a[56:59],v[76:79]
R a[184:187],v21,0
R a[188:191],v21,2048
M v[80:83],a[160:163],a[64:67],v[80:83]
buffer_load_dwordx4 v10, s[16:19], s21 offen offset:2048  nt lds
M v[80:83],a[164:167],a[68:71],v[80:83]
M v[84:87],a[164:167],a[76:79],v[84:87]
M v[84:87],a[160:163],a[72:75],v[84:87]
buffer_load_dwordx4 v11, s[16:19], s21 offen offset:3072  nt lds
M v[88:91],a[160:163],a[80:83],v[88:91]
SA s21,s21,524160
M v[88:91],a[164:167],a[84:87],v[88:91]
s_waitcnt lgkmcnt(6)
M v[92:95],a[164:167],a[92:95],v[92:95]
s_waitcnt lgkmcnt(0)
M v[92:95],a[160:163],a[88:91],v[92:95]
s_barrier
M v[124:127],a[168:171],a[88:91],v[124:127]
s_lshl_b32 s4, s20, 10
R a[160:163],v5,49152
R a[164:167],v6,49152
M v[124:127],a[172:175],a[92:95],v[124:127]
SA m0,s23,131072
v_bfe_u32 v28, v0, 3, 2
M v[120:123],a[172:175],a[84:87],v[120:123]
s_nop 0
T a[128:129],v1,16384
T a[130:131],v1,17408
M v[120:123],a[168:171],a[80:83],v[120:123]
buffer_load_dwordx4 v22, s[56:59], s29 offen offset:0 lds
M v[116:119],a[168:171],a[72:75],v[116:119]
v_lshrrev_b32 v29, 5, v0
v_lshl_add_u32 v28, v29, 3, v28
M v[116:119],a[172:175],a[76:79],v[116:119]
M v[112:115],a[172:175],a[68:71],v[112:115]
v_lshlrev_b32 v28, 13, v28
M v[112:115],a[168:171],a[64:67],v[112:115]
M v[108:111],a[168:171],a[56:59],v[108:111]
buffer_load_dwordx4 v23, s[56:59], s29 offen offset:1024 lds
M v[108:111],a[172:175],a[60:63],v[108:111]
s_nop 0
T a[132:133],v1,24576
T a[134:135],v1,25600
M v[104:107],a[172:175],a[52:55],v[104:107]
v_lshrrev_b32 v29, 4, v0
v_lshlrev_b32 v29, 1, v29
M v[104:107],a[168:171],a[48:51],v[104:107]
M v[100:103],a[168:171],a[40:43],v[100:103]
v_and_b32 v30, 7, v0
M v[100:103],a[172:175],a[44:47],v[100:103]
s_waitcnt lgkmcnt(4)
M v[96:99],a[172:175],a[36:39],v[96:99]
v_xor_b32 v29, v29, v30
M v[96:99],a[168:171],a[32:35],v[96:99]
buffer_load_dwordx4 v22, s[56:59], s30 offen offset:2048 lds
M v[128:131],a[160:163],a[32:35],v[128:131]
R a[168:171],v5,51200
R a[172:175],v6,51200
M v[128:131],a[164:167],a[36:39],v[128:131]
T a[136:137],v2,16384
T a[138:139],v2,17408
M v[132:135],a[164:167],a[44:47],v[132:135]
v_lshl_add_u32 v28, v29, 4, v28
M v[132:135],a[160:163],a[40:43],v[132:135]
s_and_b32 s64, s20, 1
M v[136:139],a[160:163],a[48:51],v[136:139]
s_lshl_b32 s64, s64, 17
M v[136:139],a[164:167],a[52:55],v[136:139]
s_lshr_b32 s65, s20, 1
M v[140:143],a[164:167],a[60:63],v[140:143]
s_lshl_b32 s65, s65, 15
SA s64,s64,s65
v_add_u32 v8, s64, v28
M v[140:143],a[160:163],a[56:59],v[140:143]
s_nop 0
T a[140:141],v2,24576
T a[142:143],v2,25600
M v[144:147],a[160:163],a[64:67],v[144:147]
buffer_load_dwordx4 v23, s[56:59], s30 offen offset:3072 lds
M v[144:147],a[164:167],a[68:71],v[144:147]
M v[148:151],a[164:167],a[76:79],v[148:151]
SA s29,s29,128
M v[148:151],a[160:163],a[72:75],v[148:151]
SA s30,s30,128
M v[152:155],a[160:163],a[80:83],v[152:155]
SA m0,s24,32768
M v[152:155],a[164:167],a[84:87],v[152:155]
s_waitcnt lgkmcnt(4)
buffer_load_dwordx4 v12, s[48:51], s22 offen offset:0   lds
M v[156:159],a[164:167],a[92:95],v[156:159]
s_nop 0
T a[144:145],v3,16384
T a[146:147],v3,17408
M v[156:159],a[160:163],a[88:91],v[156:159]
M v[188:191],a[168:171],a[88:91],v[188:191]
R a[160:163],v5,53248
R a[164:167],v6,53248
M v[188:191],a[172:175],a[92:95],v[188:191]
M v[184:187],a[172:175],a[84:87],v[184:187]
M v[184:187],a[168:171],a[80:83],v[184:187]
M v[180:183],a[168:171],a[72:75],v[180:183]
buffer_load_dwordx4 v13, s[48:51], s22 offen offset:1024   lds
M v[180:183],a[172:175],a[76:79],v[180:183]
s_nop 0
T a[148:149],v3,24576
T a[150:151],v3,25600
M v[176:179],a[172:175],a[68:71],v[176:179]
M v[176:179],a[168:171],a[64:67],v[176:179]
M v[172:175],a[168:171],a[56:59],v[172:175]
M v[172:175],a[172:175],a[60:63],v[172:175]
M v[168:171],a[172:175],a[52:55],v[168:171]
M v[168:171],a[168:171],a[48:51],v[168:171]
buffer_load_dwordx4 v14, s[48:51], s22 offen offset:2048   lds
M v[164:167],a[168:171],a[40:43],v[164:167]
s_nop 0
T a[152:153],v4,16384
T a[154:155],v4,17408
M v[164:167],a[172:175],a[44:47],v[164:167]
s_waitcnt lgkmcnt(4)
M v[160:163],a[172:175],a[36:39],v[160:163]
M v[160:163],a[168:171],a[32:35],v[160:163]
M v[192:195],a[160:163],a[32:35],v[192:195]
R a[168:171],v5,55296
R a[172:175],v6,55296
M v[192:195],a[164:167],a[36:39],v[192:195]
M v[196:199],a[164:167],a[44:47],v[196:199]
buffer_load_dwordx4 v15, s[48:51], s22 offen offset:3072   lds
M v[196:199],a[160:163],a[40:43],v[196:199]
s_nop 0
T a[156:157],v4,24576
T a[158:159],v4,25600
M v[200:203],a[160:163],a[48:51],v[200:203]
s_waitcnt vmcnt(16)
R a[192:195],v20,16384
R a[196:199],v20,18432
M v[200:203],a[164:167],a[52:55],v[200:203]
R a[200:203],v21,16384
R a[204:207],v21,18432
M v[204:207],a[164:167],a[60:63],v[204:207]
M v[204:207],a[160:163],a[56:59],v[204:207]
M v[208:211],a[160:163],a[64:67],v[208:211]
M v[208:211],a[164:167],a[68:71],v[208:211]
M v[212:215],a[164:167],a[76:79],v[212:215]
SA s22,s22,1048576
M v[212:215],a[160:163],a[72:75],v[212:215]
M v[216:219],a[160:163],a[80:83],v[216:219]
M v[216:219],a[164:167],a[84:87],v[216:219]
s_waitcnt lgkmcnt(6)
M v[220:223],a[164:167],a[92:95],v[220:223]
s_waitcnt lgkmcnt(0)
M v[220:223],a[160:163],a[88:91],v[220:223]
s_barrier
M v[252:255],a[168:171],a[88:91],v[252:255]
R a[160:163],v5,0
R a[164:167],v6,0
M v[252:255],a[172:175],a[92:95],v[252:255]
M v[248:251],a[172:175],a[84:87],v[248:251]
M v[248:251],a[168:171],a[80:83],v[248:251]
M v[244:247],a[168:171],a[72:75],v[244:247]
M v[244:247],a[172:175],a[76:79],v[244:247]
M v[240:243],a[172:175],a[68:71],v[240:243]
M v[240:243],a[168:171],a[64:67],v[240:243]
M v[236:239],a[168:171],a[56:59],v[236:239]
M v[236:239],a[172:175],a[60:63],v[236:239]
M v[232:235],a[172:175],a[52:55],v[232:235]
M v[232:235],a[168:171],a[48:51],v[232:235]
M v[228:231],a[168:171],a[40:43],v[228:231]
M v[228:231],a[172:175],a[44:47],v[228:231]
s_waitcnt lgkmcnt(0)
M v[224:227],a[172:175],a[36:39],v[224:227]
M v[224:227],a[168:171],a[32:35],v[224:227]
M a[0:3],a[160:163],a[96:99],a[0:3]
R a[168:171],v5,2048
R a[172:175],v6,2048
M a[0:3],a[164:167],a[100:103],a[0:3]
SA m0,s23,147456
T a[32:33],v1,32768
T a[34:35],v1,33792
M a[4:7],a[164:167],a[108:111],a[4:7]
buffer_load_dwordx4 v22, s[56:59], s29 offen offset:0 lds
M a[4:7],a[160:163],a[104:107],a[4:7]
M a[8:11],a[160:163],a[112:115],a[8:11]
M a[8:11],a[164:167],a[116:119],a[8:11]
buffer_load_dwordx4 v23, s[56:59], s29 offen offset:1024 lds
M a[12:15],a[164:167],a[124:127],a[12:15]
s_nop 0
T a[36:37],v1,40960
T a[38:39],v1,41984
M a[12:15],a[160:163],a[120:123],a[12:15]
M a[16:19],a[160:163],a[128:131],a[16:19]
buffer_load_dwordx4 v22, s[56:59], s30 offen offset:2048 lds
M a[16:19],a[164:167],a[132:135],a[16:19]
M a[20:23],a[164:167],a[140:143],a[20:23]
M a[20:23],a[160:163],a[136:139],a[20:23]
s_nop 0
T a[40:41],v2,32768
T a[42:43],v2,33792
M a[24:27],a[160:163],a[144:147],a[24:27]
buffer_load_dwordx4 v23, s[56:59], s30 offen offset:3072 lds
M a[24:27],a[164:167],a[148:151],a[24:27]
s_waitcnt lgkmcnt(6)
M a[28:31],a[164:167],a[156:159],a[28:31]
SA s29,s29,128
M a[28:31],a[160:163],a[152:155],a[28:31]
SA s30,s30,128
M v[60:63],a[168:171],a[152:155],v[60:63]
SA m0,s24,49152
R a[160:163],v5,4096
R a[164:167],v6,4096
M v[60:63],a[172:175],a[156:159],v[60:63]
T a[44:45],v2,40960
T a[46:47],v2,41984
M v[56:59],a[172:175],a[148:151],v[56:59]
buffer_load_dwordx4 v12, s[48:51], s22 offen offset:0   lds
M v[56:59],a[168:171],a[144:147],v[56:59]
M v[52:55],a[168:171],a[136:139],v[52:55]
M v[52:55],a[172:175],a[140:143],v[52:55]
s_nop 0
T a[48:49],v3,32768
T a[50:51],v3,33792
M v[48:51],a[172:175],a[132:135],v[48:51]
buffer_load_dwordx4 v13, s[48:51], s22 offen offset:1024   lds
M v[48:51],a[168:171],a[128:131],v[48:51]
M v[44:47],a[168:171],a[120:123],v[44:47]
M v[44:47],a[172:175],a[124:127],v[44:47]
buffer_load_dwordx4 v14, s[48:51], s22 offen offset:2048   lds
M v[40:43],a[172:175],a[116:119],v[40:43]
s_nop 0
T a[52:53],v3,40960
T a[54:55],v3,41984
M v[40:43],a[168:171],a[112:115],v[40:43]
M v[36:39],a[168:171],a[104:107],v[36:39]
buffer_load_dwordx4 v15, s[48:51], s22 offen offset:3072   lds
M v[36:39],a[172:175],a[108:111],v[36:39]
s_waitcnt lgkmcnt(6)
M v[32:35],a[172:175],a[100:103],v[32:35]
s_sub_u32 s22, s22, 1048448
M v[32:35],a[168:171],a[96:99],v[32:35]
s_mov_b32 s25, 0
T a[56:57],v4,32768
T a[58:59],v4,33792
M v[64:67],a[160:163],a[96:99],v[64:67]
SA m0,s4,0
R a[168:171],v5,6144
R a[172:175],v6,6144
M v[64:67],a[164:167],a[100:103],v[64:67]
buffer_load_dwordx4 v8, s[52:55], s25 offen lds
M v[68:71],a[164:167],a[108:111],v[68:71]
s_mov_b32 s25, 262144
M v[68:71],a[160:163],a[104:107],v[68:71]
SA m0,s4,4096
M v[72:75],a[160:163],a[112:115],v[72:75]
s_waitcnt vmcnt(13)
s_nop 0
T a[60:61],v4,40960
T a[62:63],v4,41984
M v[72:75],a[164:167],a[116:119],v[72:75]
buffer_load_dwordx4 v8, s[52:55], s25 offen lds
M v[76:79],a[164:167],a[124:127],v[76:79]
s_mov_b32 s25, 524288
R a[208:211],v20,0
R a[212:215],v20,2048
M v[76:79],a[160:163],a[120:123],v[76:79]
SA m0,s4,8192
R a[216:219],v21,0
R a[220:223],v21,2048
M v[80:83],a[160:163],a[128:131],v[80:83]
buffer_load_dwordx4 v8, s[52:55], s25 offen lds
M v[80:83],a[164:167],a[132:135],v[80:83]
s_mov_b32 s25, 786432
M v[84:87],a[164:167],a[140:143],v[84:87]
SA m0,s4,12288
M v[84:87],a[160:163],a[136:139],v[84:87]
buffer_load_dwordx4 v8, s[52:55], s25 offen lds
M v[88:91],a[160:163],a[144:147],v[88:91]
M v[88:91],a[164:167],a[148:151],v[88:91]
s_waitcnt lgkmcnt(6)
M v[92:95],a[164:167],a[156:159],v[92:95]
s_waitcnt lgkmcnt(0)
M v[92:95],a[160:163],a[152:155],v[92:95]
s_barrier
M v[124:127],a[168:171],a[152:155],v[124:127]
R a[160:163],v5,16384
R a[164:167],v6,16384
M v[124:127],a[172:175],a[156:159],v[124:127]
SA m0,s23,32768
M v[120:123],a[172:175],a[148:151],v[120:123]
s_nop 0
T a[64:65],v1,49152
T a[66:67],v1,50176
M v[120:123],a[168:171],a[144:147],v[120:123]
buffer_load_dwordx4 v22, s[56:59], s29 offen offset:0 lds
M v[116:119],a[168:171],a[136:139],v[116:119]
v_lshrrev_b32 v28, 2, v0
v_lshlrev_b32 v28, 7, v28
M v[116:119],a[172:175],a[140:143],v[116:119]
M v[112:115],a[172:175],a[132:135],v[112:115]
buffer_load_dwordx4 v23, s[56:59], s29 offen offset:1024 lds
M v[112:115],a[168:171],a[128:131],v[112:115]
v_and_b32 v29, 3, v0
M v[108:111],a[168:171],a[120:123],v[108:111]
v_lshl_add_u32 v28, v29, 3, v28
M v[108:111],a[172:175],a[124:127],v[108:111]
s_nop 0
T a[68:69],v1,57344
T a[70:71],v1,58368
M v[104:107],a[172:175],a[116:119],v[104:107]
buffer_load_dwordx4 v22, s[56:59], s30 offen offset:2048 lds
M v[104:107],a[168:171],a[112:115],v[104:107]
v_bfe_u32 v29, v0, 3, 2
M v[100:103],a[168:171],a[104:107],v[100:103]
M v[100:103],a[172:175],a[108:111],v[100:103]
s_waitcnt lgkmcnt(4)
v_lshl_add_u32 v16, v29, 5, v28
M v[96:99],a[172:175],a[100:103],v[96:99]
M v[96:99],a[168:171],a[96:99],v[96:99]
buffer_load_dwordx4 v23, s[56:59], s30 offen offset:3072 lds
M v[128:131],a[160:163],a[96:99],v[128:131]
R a[168:171],v5,18432
R a[172:175],v6,18432
M v[128:131],a[164:167],a[100:103],v[128:131]
SA s29,s29,128
T a[72:73],v2,49152
T a[74:75],v2,50176
M v[132:135],a[164:167],a[108:111],v[132:135]
SA s30,s30,128
v_xor_b32 v17, 32, v16
v_xor_b32 v18, 64, v16
M v[132:135],a[160:163],a[104:107],v[132:135]
SA m0,s23,65536
M v[136:139],a[160:163],a[112:115],v[136:139]
buffer_load_dwordx4 v22, s[56:59], s29 offen offset:0 lds
M v[136:139],a[164:167],a[116:119],v[136:139]
v_xor_b32 v19, 0x60, v16
M v[140:143],a[164:167],a[124:127],v[140:143]
v_add_u32 v12, 0x20000, v16
M v[140:143],a[160:163],a[120:123],v[140:143]
s_nop 0
T a[76:77],v2,57344
T a[78:79],v2,58368
M v[144:147],a[160:163],a[128:131],v[144:147]
buffer_load_dwordx4 v23, s[56:59], s29 offen offset:1024 lds
M v[144:147],a[164:167],a[132:135],v[144:147]
v_add_u32 v13, 0x20000, v17
M v[148:151],a[164:167],a[140:143],v[148:151]
M v[148:151],a[160:163],a[136:139],v[148:151]
v_add_u32 v14, 0x20000, v18
M v[152:155],a[160:163],a[144:147],v[152:155]
M v[152:155],a[164:167],a[148:151],v[152:155]
s_waitcnt lgkmcnt(4)
buffer_load_dwordx4 v22, s[56:59], s30 offen offset:2048 lds
M v[156:159],a[164:167],a[156:159],v[156:159]
s_nop 0
T a[80:81],v3,49152
T a[82:83],v3,50176
M v[156:159],a[160:163],a[152:155],v[156:159]
v_add_u32 v15, 0x20000, v19
M v[188:191],a[168:171],a[152:155],v[188:191]
R a[160:163],v5,20480
R a[164:167],v6,20480
M v[188:191],a[172:175],a[156:159],v[188:191]
M v[184:187],a[172:175],a[148:151],v[184:187]
buffer_load_dwordx4 v23, s[56:59], s30 offen offset:3072 lds
M v[184:187],a[168:171],a[144:147],v[184:187]
SA s29,s29,128
M v[180:183],a[168:171],a[136:139],v[180:183]
SA s30,s30,128
M v[180:183],a[172:175],a[140:143],v[180:183]
s_mov_b32 s25, 1048576
T a[84:85],v3,57344
T a[86:87],v3,58368
M v[176:179],a[172:175],a[132:135],v[176:179]
SA m0,s4,16384
M v[176:179],a[168:171],a[128:131],v[176:179]
buffer_load_dwordx4 v8, s[52:55], s25 offen lds
M v[172:175],a[168:171],a[120:123],v[172:175]
M v[172:175],a[172:175],a[124:127],v[172:175]
s_mov_b32 s25, 1310720
M v[168:171],a[172:175],a[116:119],v[168:171]
SA m0,s4,20480
M v[168:171],a[168:171],a[112:115],v[168:171]
buffer_load_dwordx4 v8, s[52:55], s25 offen lds
M v[164:167],a[168:171],a[104:107],v[164:167]
s_nop 0
T a[88:89],v4,49152
T a[90:91],v4,50176
M v[164:167],a[172:175],a[108:111],v[164:167]
s_waitcnt lgkmcnt(4)
M v[160:163],a[172:175],a[100:103],v[160:163]
s_mov_b32 s25, 1572864
M v[160:163],a[168:171],a[96:99],v[160:163]
SA m0,s4,24576
M v[192:195],a[160:163],a[96:99],v[192:195]
R a[168:171],v5,22528
R a[172:175],v6,22528
M v[192:195],a[164:167],a[100:103],v[192:195]
buffer_load_dwordx4 v8, s[52:55], s25 offen lds
M v[196:199],a[164:167],a[108:111],v[196:199]
M v[196:199],a[160:163],a[104:107],v[196:199]
s_mov_b32 s25, 1835008
T a[92:93],v4,57344
T a[94:95],v4,58368
M v[200:203],a[160:163],a[112:115],v[200:203]
SA m0,s4,28672
M v[200:203],a[164:167],a[116:119],v[200:203]
s_waitcnt vmcnt(19)
buffer_load_dwordx4 v8, s[52:55], s25 offen lds
M v[204:207],a[164:167],a[124:127],v[204:207]
R a[224:227],v20,16384
R a[228:231],v20,18432
M v[204:207],a[160:163],a[120:123],v[204:207]
R a[232:235],v21,16384
R a[236:239],v21,18432
M v[208:211],a[160:163],a[128:131],v[208:211]
v_subrev_u32 v20, 98304, v20
v_subrev_u32 v21, 98304, v21
M v[208:211],a[164:167],a[132:135],v[208:211]
M v[212:215],a[164:167],a[140:143],v[212:215]
M v[212:215],a[160:163],a[136:139],v[212:215]
M v[216:219],a[160:163],a[144:147],v[216:219]
M v[216:219],a[164:167],a[148:151],v[216:219]
s_waitcnt lgkmcnt(6)
M v[220:223],a[164:167],a[156:159],v[220:223]
s_waitcnt lgkmcnt(0)
M v[220:223],a[160:163],a[152:155],v[220:223]
s_barrier
M v[252:255],a[168:171],a[152:155],v[252:255]
R a[160:163],v5,32768
R a[164:167],v6,32768
M v[252:255],a[172:175],a[156:159],v[252:255]
M v[248:251],a[172:175],a[148:151],v[248:251]
M v[248:251],a[168:171],a[144:147],v[248:251]
M v[244:247],a[168:171],a[136:139],v[244:247]
M v[244:247],a[172:175],a[140:143],v[244:247]
M v[240:243],a[172:175],a[132:135],v[240:243]
M v[240:243],a[168:171],a[128:131],v[240:243]
M v[236:239],a[168:171],a[120:123],v[236:239]
M v[236:239],a[172:175],a[124:127],v[236:239]
M v[232:235],a[172:175],a[116:119],v[232:235]
M v[232:235],a[168:171],a[112:115],v[232:235]
M v[228:231],a[168:171],a[104:107],v[228:231]
M v[228:231],a[172:175],a[108:111],v[228:231]
s_waitcnt lgkmcnt(0)
M v[224:227],a[172:175],a[100:103],v[224:227]
M v[224:227],a[168:171],a[96:99],v[224:227]
M a[0:3],a[160:163],a[32:35],a[0:3]
R a[168:171],v5,34816
R a[172:175],v6,34816
M a[0:3],a[164:167],a[36:39],a[0:3]
SA m0,s23,81920
M a[4:7],a[164:167],a[44:47],a[4:7]
buffer_load_dwordx4 v22, s[56:59], s29 offen offset:0 lds
M a[4:7],a[160:163],a[40:43],a[4:7]
M a[8:11],a[160:163],a[48:51],a[8:11]
M a[8:11],a[164:167],a[52:55],a[8:11]
buffer_load_dwordx4 v23, s[56:59], s29 offen offset:1024 lds
M a[12:15],a[164:167],a[60:63],a[12:15]
M a[12:15],a[160:163],a[56:59],a[12:15]
M a[16:19],a[160:163],a[64:67],a[16:19]
M a[16:19],a[164:167],a[68:71],a[16:19]
buffer_load_dwordx4 v22, s[56:59], s30 offen offset:2048 lds
M a[20:23],a[164:167],a[76:79],a[20:23]
M a[20:23],a[160:163],a[72:75],a[20:23]
M a[24:27],a[160:163],a[80:83],a[24:27]
M a[24:27],a[164:167],a[84:87],a[24:27]
s_waitcnt lgkmcnt(0)
buffer_load_dwordx4 v23, s[56:59], s30 offen offset:3072 lds
M a[28:31],a[164:167],a[92:95],a[28:31]
SA s29,s29,128
M a[28:31],a[160:163],a[88:91],a[28:31]
SA s30,s30,128
M v[32:35],a[168:171],a[32:35],v[32:35]
s_mov_b32 s25, 2097152
R a[160:163],v5,36864
R a[164:167],v6,36864
M v[32:35],a[172:175],a[36:39],v[32:35]
SA m0,s4,131072
M v[36:39],a[172:175],a[44:47],v[36:39]
buffer_load_dwordx4 v8, s[52:55], s25 offen lds
M v[36:39],a[168:171],a[40:43],v[36:39]
s_mov_b32 s25, 2359296
M v[40:43],a[168:171],a[48:51],v[40:43]
SA m0,s4,135168
M v[40:43],a[172:175],a[52:55],v[40:43]
buffer_load_dwordx4 v8, s[52:55], s25 offen lds
M v[44:47],a[172:175],a[60:63],v[44:47]
G v24,a0
G v25,a1
M v[44:47],a[168:171],a[56:59],v[44:47]
s_mov_b32 s25, 2621440
G v26,a2
G v27,a3
M v[48:51],a[168:171],a[64:67],v[48:51]
SA m0,s4,139264
C v24,v24,v25
C v25,v26,v27
M v[48:51],a[172:175],a[68:71],v[48:51]
buffer_load_dwordx4 v8, s[52:55], s25 offen lds
M v[52:55],a[172:175],a[76:79],v[52:55]
C v26,v32,v33
C v27,v34,v35
M v[52:55],a[168:171],a[72:75],v[52:55]
SA s3,s93,0
M v[56:59],a[168:171],a[80:83],v[56:59]
s_mov_b32 s25, 2883584
buffer_store_dwordx4 v[24:27], v7, s[8:11], s3 offen offset:0 sc1
M v[56:59],a[172:175],a[84:87],v[56:59]
s_waitcnt lgkmcnt(0)
G v28,a4
G v29,a5
M v[60:63],a[172:175],a[92:95],v[60:63]
SA m0,s4,143360
G v30,a6
G v31,a7
M v[60:63],a[168:171],a[88:91],v[60:63]
s_waitcnt vmcnt(16)
buffer_load_dwordx4 v8, s[52:55], s25 offen lds
M v[64:67],a[160:163],a[32:35],v[64:67]
L_w_kv17:
s_cbranch_execz L_wd2
s_mov_b32 s25, 3145728
R a[168:171],v5,38912
R a[172:175],v6,38912
M v[64:67],a[164:167],a[36:39],v[64:67]
SA m0,s4,147456
C v28,v28,v29
C v29,v30,v31
M v[68:71],a[164:167],a[44:47],v[68:71]
buffer_load_dwordx4 v8, s[52:55], s25 offen lds
M v[68:71],a[160:163],a[40:43],v[68:71]
s_mov_b32 s25, 3407872
C v30,v36,v37
C v31,v38,v39
M v[72:75],a[160:163],a[48:51],v[72:75]
SA m0,s4,151552
buffer_store_dwordx4 v[28:31], v7, s[8:11], s3 offen offset:2048 sc1
M v[72:75],a[164:167],a[52:55],v[72:75]
G v24,a8
G v25,a9
M v[76:79],a[164:167],a[60:63],v[76:79]
G v26,a10
G v27,a11
M v[76:79],a[160:163],a[56:59],v[76:79]
buffer_load_dwordx4 v8, s[52:55], s25 offen lds
M v[80:83],a[160:163],a[64:67],v[80:83]
C v24,v24,v25
C v25,v26,v27
M v[80:83],a[164:167],a[68:71],v[80:83]
C v26,v40,v41
C v27,v42,v43
M v[84:87],a[164:167],a[76:79],v[84:87]
SA s3,s93,4096
buffer_store_dwordx4 v[24:27], v7, s[8:11], s3 offen offset:0 sc1
M v[84:87],a[160:163],a[72:75],v[84:87]
R a[96:99],v20,0
R a[100:103],v20,2048
M v[88:91],a[160:163],a[80:83],v[88:91]
R a[104:107],v21,0
R a[108:111],v21,2048
M v[88:91],a[164:167],a[84:87],v[88:91]
s_waitcnt lgkmcnt(4)
G v28,a12
G v29,a13
M v[92:95],a[164:167],a[92:95],v[92:95]
s_waitcnt lgkmcnt(0)
G v30,a14
G v31,a15
M v[92:95],a[160:163],a[88:91],v[92:95]
s_barrier
M v[96:99],a[168:171],a[32:35],v[96:99]
R a[160:163],v5,49152
R a[164:167],v6,49152
M v[96:99],a[172:175],a[36:39],v[96:99]
s_mov_b32 s25, 128
C v28,v28,v29
C v29,v30,v31
M v[100:103],a[172:175],a[44:47],v[100:103]
SA m0,s4,49152
C v30,v44,v45
C v31,v46,v47
M v[100:103],a[168:171],a[40:43],v[100:103]
s_waitcnt vmcnt(17)
buffer_store_dwordx4 v[28:31], v7, s[8:11], s3 offen offset:2048 sc1
M v[104:107],a[168:171],a[48:51],v[104:107]
G v24,a16
G v25,a17
M v[104:107],a[172:175],a[52:55],v[104:107]
G v26,a18
G v27,a19
M v[108:111],a[172:175],a[60:63],v[108:111]
buffer_load_dwordx4 v8, s[52:55], s25 offen lds
M v[108:111],a[168:171],a[56:59],v[108:111]
C v24,v24,v25
C v25,v26,v27
M v[112:115],a[168:171],a[64:67],v[112:115]
C v26,v48,v49
C v27,v50,v51
M v[112:115],a[172:175],a[68:71],v[112:115]
SA s3,s93,8192
buffer_store_dwordx4 v[24:27], v7, s[8:11], s3 offen offset:0 sc1
M v[116:119],a[172:175],a[76:79],v[116:119]
s_mov_b32 s25, 262272
R a[112:115],v20,32768
R a[116:119],v20,34816
M v[116:119],a[168:171],a[72:75],v[116:119]
SA m0,s4,53248
R a[120:123],v21,32768
R a[124:127],v21,34816
M v[120:123],a[168:171],a[80:83],v[120:123]
C v64,v64,v65
C v65,v66,v67
M v[120:123],a[172:175],a[84:87],v[120:123]
s_waitcnt lgkmcnt(4)
buffer_load_dwordx4 v8, s[52:55], s25 offen lds
M v[124:127],a[172:175],a[92:95],v[124:127]
C v66,v96,v97
C v67,v98,v99
M v[124:127],a[168:171],a[88:91],v[124:127]
G v28,a20
G v29,a21
M v[128:131],a[160:163],a[32:35],v[128:131]
R a[168:171],v5,51200
R a[172:175],v6,51200
M v[128:131],a[164:167],a[36:39],v[128:131]
G v30,a22
G v31,a23
M v[132:135],a[164:167],a[44:47],v[132:135]
C v28,v28,v29
C v29,v30,v31
M v[132:135],a[160:163],a[40:43],v[132:135]
s_mov_b32 s25, 524416
C v30,v52,v53
C v31,v54,v55
M v[136:139],a[160:163],a[48:51],v[136:139]
SA m0,s4,57344
buffer_store_dwordx4 v[28:31], v7, s[8:11], s3 offen offset:2048 sc1
M v[136:139],a[164:167],a[52:55],v[136:139]
C v68,v68,v69
C v69,v70,v71
M v[140:143],a[164:167],a[60:63],v[140:143]
C v70,v100,v101
C v71,v102,v103
M v[140:143],a[160:163],a[56:59],v[140:143]
C v72,v72,v73
C v73,v74,v75
M v[144:147],a[160:163],a[64:67],v[144:147]
buffer_load_dwordx4 v8, s[52:55], s25 offen lds
M v[144:147],a[164:167],a[68:71],v[144:147]
C v74,v104,v105
C v75,v106,v107
M v[148:151],a[164:167],a[76:79],v[148:151]
C v76,v76,v77
C v77,v78,v79
M v[148:151],a[160:163],a[72:75],v[148:151]
C v78,v108,v109
C v79,v110,v111
M v[152:155],a[160:163],a[80:83],v[152:155]
C v80,v80,v81
C v81,v82,v83
M v[152:155],a[164:167],a[84:87],v[152:155]
s_waitcnt lgkmcnt(0)
C v82,v112,v113
C v83,v114,v115
M v[156:159],a[164:167],a[92:95],v[156:159]
s_mov_b32 s25, 786560
C v84,v84,v85
C v85,v86,v87
M v[156:159],a[160:163],a[88:91],v[156:159]
SA m0,s4,61440
C v86,v116,v117
C v87,v118,v119
M v[160:163],a[168:171],a[32:35],v[160:163]
R a[160:163],v5,53248
R a[164:167],v6,53248
M v[160:163],a[172:175],a[36:39],v[160:163]
buffer_load_dwordx4 v8, s[52:55], s25 offen lds
M v[164:167],a[172:175],a[44:47],v[164:167]
G v24,a24
G v25,a25
M v[164:167],a[168:171],a[40:43],v[164:167]
G v26,a26
G v27,a27
M v[168:171],a[168:171],a[48:51],v[168:171]
C v24,v24,v25
C v25,v26,v27
M v[168:171],a[172:175],a[52:55],v[168:171]
C v26,v56,v57
C v27,v58,v59
M v[172:175],a[172:175],a[60:63],v[172:175]
SA s3,s93,12288
buffer_store_dwordx4 v[24:27], v7, s[8:11], s3 offen offset:0 sc1
M v[172:175],a[168:171],a[56:59],v[172:175]
C v88,v88,v89
C v89,v90,v91
M v[176:179],a[168:171],a[64:67],v[176:179]
C v90,v120,v121
C v91,v122,v123
M v[176:179],a[172:175],a[68:71],v[176:179]
C v92,v92,v93
C v93,v94,v95
M v[180:183],a[172:175],a[76:79],v[180:183]
C v94,v124,v125
C v95,v126,v127
M v[180:183],a[168:171],a[72:75],v[180:183]
G v28,a28
G v29,a29
M v[184:187],a[168:171],a[80:83],v[184:187]
G v30,a30
G v31,a31
M v[184:187],a[172:175],a[84:87],v[184:187]
s_waitcnt lgkmcnt(0)
C v28,v28,v29
C v29,v30,v31
M v[188:191],a[172:175],a[92:95],v[188:191]
C v30,v60,v61
C v31,v62,v63
M v[188:191],a[168:171],a[88:91],v[188:191]
buffer_store_dwordx4 v[28:31], v7, s[8:11], s3 offen offset:2048 sc1
M v[192:195],a[160:163],a[32:35],v[192:195]
s_waitcnt vmcnt(18)
R a[168:171],v5,55296
R a[172:175],v6,55296
M v[192:195],a[164:167],a[36:39],v[192:195]
C v128,v128,v129
C v129,v130,v131
M v[196:199],a[164:167],a[44:47],v[196:199]
C v130,v160,v161
C v131,v162,v163
M v[196:199],a[160:163],a[40:43],v[196:199]
C v132,v132,v133
C v133,v134,v135
M v[200:203],a[160:163],a[48:51],v[200:203]
C v134,v164,v165
C v135,v166,v167
M v[200:203],a[164:167],a[52:55],v[200:203]
C v136,v136,v137
C v137,v138,v139
M v[204:207],a[164:167],a[60:63],v[204:207]
C v138,v168,v169
C v139,v170,v171
M v[204:207],a[160:163],a[56:59],v[204:207]
C v140,v140,v141
C v141,v142,v143
M v[208:211],a[160:163],a[64:67],v[208:211]
C v142,v172,v173
C v143,v174,v175
M v[208:211],a[164:167],a[68:71],v[208:211]
C v144,v144,v145
C v145,v146,v147
M v[212:215],a[164:167],a[76:79],v[212:215]
R a[128:131],v20,49152
R a[132:135],v20,51200
R a[136:139],v21,49152
R a[140:143],v21,51200
M v[212:215],a[160:163],a[72:75],v[212:215]
C v146,v176,v177
C v147,v178,v179
M v[216:219],a[160:163],a[80:83],v[216:219]
C v148,v148,v149
C v149,v150,v151
M v[216:219],a[164:167],a[84:87],v[216:219]
s_waitcnt lgkmcnt(4)
C v150,v180,v181
C v151,v182,v183
M v[220:223],a[164:167],a[92:95],v[220:223]
s_waitcnt vmcnt(10) lgkmcnt(0)
C v152,v152,v153
C v153,v154,v155
M v[220:223],a[160:163],a[88:91],v[220:223]
s_barrier
M v[224:227],a[168:171],a[32:35],v[224:227]
s_nop 0
T v[32:33],v16,0
T v[34:35],v16,2048
M v[224:227],a[172:175],a[36:39],v[224:227]
C v154,v184,v185
C v155,v186,v187
M v[228:231],a[172:175],a[44:47],v[228:231]
T v[36:37],v16,4096
T v[38:39],v16,6144
M v[228:231],a[168:171],a[40:43],v[228:231]
T v[40:41],v16,8192
T v[42:43],v16,10240
M v[232:235],a[168:171],a[48:51],v[232:235]
C v156,v156,v157
C v157,v158,v159
M v[232:235],a[172:175],a[52:55],v[232:235]
T v[44:45],v16,12288
T v[46:47],v16,14336
M v[236:239],a[172:175],a[60:63],v[236:239]
T v[48:49],v16,16384
T v[50:51],v16,18432
M v[236:239],a[168:171],a[56:59],v[236:239]
C v158,v188,v189
C v159,v190,v191
M v[240:243],a[168:171],a[64:67],v[240:243]
T v[52:53],v16,20480
T v[54:55],v16,22528
M v[240:243],a[172:175],a[68:71],v[240:243]
T v[56:57],v16,24576
T v[58:59],v16,26624
M v[244:247],a[172:175],a[76:79],v[244:247]
C v192,v192,v193
C v193,v194,v195
M v[244:247],a[168:171],a[72:75],v[244:247]
C v194,v224,v225
C v195,v226,v227
M v[248:251],a[168:171],a[80:83],v[248:251]
C v196,v196,v197
C v197,v198,v199
M v[248:251],a[172:175],a[84:87],v[248:251]
C v198,v228,v229
C v199,v230,v231
M v[252:255],a[172:175],a[92:95],v[252:255]
C v200,v200,v201
C v201,v202,v203
M v[252:255],a[168:171],a[88:91],v[252:255]
s_waitcnt lgkmcnt(6)
C v202,v232,v233
C v203,v234,v235
M v[96:99],v[32:35],a[176:179],0
s_mul_i32 s72, s41, 4352
T a[144:145],v17,0
T a[146:147],v17,2048
M v[96:99],v[36:39],a[184:187],v[96:99]
s_mov_b32 s25, 1048704
C v204,v204,v205
C v205,v206,v207
M v[96:99],v[40:43],a[192:195],v[96:99]
s_waitcnt lgkmcnt(2)
T a[148:149],v17,4096
T a[150:151],v17,6144
M v[96:99],v[44:47],a[200:203],v[96:99]
SA m0,s4,98304
T a[152:153],v17,8192
T a[154:155],v17,10240
M v[96:99],v[48:51],a[208:211],v[96:99]
SA s46,s72,104923136
buffer_load_dwordx4 v8, s[52:55], s25 offen lds
M v[96:99],v[52:55],a[216:219],v[96:99]
s_lshl_b32 s45, s42, 7
T a[156:157],v17,12288
T a[158:159],v17,14336
M v[96:99],v[56:59],a[224:227],v[96:99]
s_mov_b32 s25, 1310848
T a[160:161],v17,16384
T a[162:163],v17,18432
M v[100:103],v[56:59],a[228:231],0
SA m0,s4,102400
C v206,v236,v237
C v207,v238,v239
M v[100:103],v[52:55],a[220:223],v[100:103]
SA s45,s45,s46
T a[164:165],v17,20480
T a[166:167],v17,22528
M v[100:103],v[48:51],a[212:215],v[100:103]
s_lshl_b32 s72, s20, 2
T a[168:169],v17,24576
T a[170:171],v17,26624
M v[100:103],v[44:47],a[204:207],v[100:103]
SA s72,s72,s45
buffer_load_dwordx4 v8, s[52:55], s25 offen lds
M v[100:103],v[40:43],a[196:199],v[100:103]
C v208,v208,v209
C v209,v210,v211
M v[100:103],v[36:39],a[188:191],v[100:103]
s_mov_b32 s25, 1572992
C v210,v240,v241
C v211,v242,v243
M v[100:103],v[32:35],a[180:183],v[100:103]
s_waitcnt lgkmcnt(6)
C v212,v212,v213
C v213,v214,v215
M v[104:107],a[144:147],a[176:179],0
SA m0,s4,106496
T v[32:33],v18,0
T v[34:35],v18,2048
M v[104:107],a[148:151],a[184:187],v[104:107]
buffer_load_dwordx4 v8, s[52:55], s25 offen lds
M v[104:107],a[152:155],a[192:195],v[104:107]
s_waitcnt lgkmcnt(2)
s_nop 0
T v[36:37],v18,4096
T v[38:39],v18,6144
M v[104:107],a[156:159],a[200:203],v[104:107]
s_mov_b32 s25, 1835136
T v[40:41],v18,8192
T v[42:43],v18,10240
M v[104:107],a[160:163],a[208:211],v[104:107]
SA m0,s4,110592
C v214,v244,v245
C v215,v246,v247
M v[104:107],a[164:167],a[216:219],v[104:107]
T v[44:45],v18,12288
T v[46:47],v18,14336
M v[104:107],a[168:171],a[224:227],v[104:107]
T v[48:49],v18,16384
T v[50:51],v18,18432
M v[108:111],a[168:171],a[228:231],0
buffer_load_dwordx4 v8, s[52:55], s25 offen lds
M v[108:111],a[164:167],a[220:223],v[108:111]
s_nop 0
T v[52:53],v18,20480
T v[54:55],v18,22528
M v[108:111],a[160:163],a[212:215],v[108:111]
s_mov_b32 s25, 2097280
T v[56:57],v18,24576
T v[58:59],v18,26624
M v[108:111],a[156:159],a[204:207],v[108:111]
SA m0,s4,114688
C v216,v216,v217
C v217,v218,v219
M v[108:111],a[152:155],a[196:199],v[108:111]
SA s3,s93,524288
buffer_load_dwordx4 v8, s[52:55], s25 offen lds
M v[108:111],a[148:151],a[188:191],v[108:111]
C v218,v248,v249
C v219,v250,v251
M v[108:111],a[144:147],a[180:183],v[108:111]
s_waitcnt lgkmcnt(6)
buffer_store_dwordx4 v[64:67], v7, s[8:11], s3 offen offset:0 sc1
M v[112:115],v[32:35],a[176:179],0
s_mov_b32 s25, 2359424
T a[144:145],v19,0
T a[146:147],v19,2048
M v[112:115],v[36:39],a[184:187],v[112:115]
SA m0,s4,118784
buffer_store_dwordx4 v[68:71], v7, s[8:11], s3 offen offset:2048 sc1
M v[112:115],v[40:43],a[192:195],v[112:115]
s_waitcnt lgkmcnt(2)
s_nop 0
T a[148:149],v19,4096
T a[150:151],v19,6144
M v[112:115],v[44:47],a[200:203],v[112:115]
T a[152:153],v19,8192
T a[154:155],v19,10240
M v[112:115],v[48:51],a[208:211],v[112:115]
buffer_load_dwordx4 v8, s[52:55], s25 offen lds
M v[112:115],v[52:55],a[216:219],v[112:115]
s_nop 0
T a[156:157],v19,12288
T a[158:159],v19,14336
M v[112:115],v[56:59],a[224:227],v[112:115]
s_mov_b32 s25, 2621568
T a[160:161],v19,16384
T a[162:163],v19,18432
M v[116:119],v[56:59],a[228:231],0
SA m0,s4,122880
C v220,v220,v221
C v221,v222,v223
M v[116:119],v[52:55],a[220:223],v[116:119]
T a[164:165],v19,20480
T a[166:167],v19,22528
M v[116:119],v[48:51],a[212:215],v[116:119]
T a[168:169],v19,24576
T a[170:171],v19,26624
M v[116:119],v[44:47],a[204:207],v[116:119]
buffer_load_dwordx4 v8, s[52:55], s25 offen lds
M v[116:119],v[40:43],a[196:199],v[116:119]
C v222,v252,v253
C v223,v254,v255
M v[116:119],v[36:39],a[188:191],v[116:119]
s_mov_b32 s25, 2883712
v_min_u32 v29, 1, v0
v_lshlrev_b32 v29, 29, v29
M v[116:119],v[32:35],a[180:183],v[116:119]
s_waitcnt lgkmcnt(6)
v_mov_b32 v30, 1
v_add_u32 v20, 0x10000, v16
M v[120:123],a[144:147],a[176:179],0
SA m0,s4,126976
T v[32:33],v16,28672
T v[34:35],v16,30720
M v[120:123],a[148:151],a[184:187],v[120:123]
s_waitcnt vmcnt(9)
buffer_load_dwordx4 v8, s[52:55], s25 offen lds
M v[120:123],a[152:155],a[192:195],v[120:123]
s_waitcnt lgkmcnt(2)
s_nop 0
T v[36:37],v12,0
T v[38:39],v12,2048
M v[120:123],a[156:159],a[200:203],v[120:123]
s_mov_b32 s25, 3145856
T v[40:41],v12,4096
T v[42:43],v12,6144
M v[120:123],a[160:163],a[208:211],v[120:123]
SA m0,s4,32768
buffer_store_dword v30, v29, s[8:11], s72 offen offset:4 sc1
M v[120:123],a[164:167],a[216:219],v[120:123]
s_nop 0
T v[44:45],v12,8192
T v[46:47],v12,10240
M v[120:123],a[168:171],a[224:227],v[120:123]
T v[48:49],v12,12288
T v[50:51],v12,14336
M v[124:127],a[168:171],a[228:231],0
buffer_load_dwordx4 v8, s[52:55], s25 offen lds
M v[124:127],a[164:167],a[220:223],v[124:127]
s_nop 0
T v[52:53],v12,16384
T v[54:55],v12,18432
M v[124:127],a[160:163],a[212:215],v[124:127]
s_mov_b32 s25, 3408000
T v[56:57],v12,20480
T v[58:59],v12,22528
M v[124:127],a[156:159],a[204:207],v[124:127]
SA m0,s4,36864
v_add_u32 v21, 0x10000, v17
v_add_u32 v22, 0x10000, v18
M v[124:127],a[152:155],a[196:199],v[124:127]
SA s3,s93,528384
buffer_load_dwordx4 v8, s[52:55], s25 offen lds
M v[124:127],a[148:151],a[188:191],v[124:127]
v_add_u32 v23, 0x10000, v19
v_or_b32 v1, s20, v0
M v[124:127],a[144:147],a[180:183],v[124:127]
s_waitcnt lgkmcnt(6)
buffer_store_dwordx4 v[72:75], v7, s[8:11], s3 offen offset:0 sc1
M v[96:99],v[32:35],a[232:235],v[96:99]
s_mov_b32 s25, 256
T a[144:145],v17,28672
T a[146:147],v17,30720
M v[96:99],v[36:39],a[96:99],v[96:99]
SA m0,s4,65536
v_min_u32 v1, 1, v1
v_lshlrev_b32 v1, 29, v1
M v[96:99],v[40:43],a[104:107],v[96:99]
s_waitcnt lgkmcnt(2)
T a[148:149],v13,0
T a[150:151],v13,2048
M v[96:99],v[44:47],a[112:115],v[96:99]
T a[152:153],v13,4096
T a[154:155],v13,6144
M v[96:99],v[48:51],a[120:123],v[96:99]
buffer_load_dwordx4 v8, s[52:55], s25 offen lds
M v[96:99],v[52:55],a[128:131],v[96:99]
s_nop 0
T a[156:157],v13,8192
T a[158:159],v13,10240
M v[96:99],v[56:59],a[136:139],v[96:99]
s_mov_b32 s25, 262400
T a[160:161],v13,12288
T a[162:163],v13,14336
M v[100:103],v[56:59],a[140:143],v[100:103]
SA m0,s4,69632
v_min_u32 v9, 15, v0
v_lshlrev_b32 v9, 7, v9
M v[100:103],v[52:55],a[132:135],v[100:103]
s_sub_u32 s66, 15, s42
T a[164:165],v13,16384
T a[166:167],v13,18432
M v[100:103],v[48:51],a[124:127],v[100:103]
s_max_u32 s67, s66, s42
T a[168:169],v13,20480
L_w_kv18:
s_cbranch_execz L_wd2
T a[170:171],v13,22528
M v[100:103],v[44:47],a[116:119],v[100:103]
s_min_u32 s66, s66, s42
buffer_load_dwordx4 v8, s[52:55], s25 offen lds
M v[100:103],v[40:43],a[108:111],v[100:103]
s_mul_i32 s21, s41, 1048576
M v[100:103],v[36:39],a[100:103],v[100:103]
s_mov_b32 s25, 524544
M v[100:103],v[32:35],a[236:239],v[100:103]
s_waitcnt lgkmcnt(6)
M v[104:107],a[144:147],a[232:235],v[104:107]
SA m0,s4,73728
T v[32:33],v18,28672
T v[34:35],v18,30720
M v[104:107],a[148:151],a[96:99],v[104:107]
s_lshl_b32 s64, s67, 16
buffer_load_dwordx4 v8, s[52:55], s25 offen lds
M v[104:107],a[152:155],a[104:107],v[104:107]
s_waitcnt lgkmcnt(2)
s_nop 0
T v[36:37],v14,0
T v[38:39],v14,2048
M v[104:107],a[156:159],a[112:115],v[104:107]
s_mov_b32 s25, 786688
T v[40:41],v14,4096
T v[42:43],v14,6144
M v[104:107],a[160:163],a[120:123],v[104:107]
SA m0,s4,77824
M v[104:107],a[164:167],a[128:131],v[104:107]
SA s32,s21,s64
T v[44:45],v14,8192
T v[46:47],v14,10240
M v[104:107],a[168:171],a[136:139],v[104:107]
s_lshl_b32 s64, s20, 14
T v[48:49],v14,12288
T v[50:51],v14,14336
M v[108:111],a[168:171],a[140:143],v[108:111]
SA s32,s32,s64
buffer_load_dwordx4 v8, s[52:55], s25 offen lds
M v[108:111],a[164:167],a[132:135],v[108:111]
SA s32,s32,33554432
T v[52:53],v14,16384
T v[54:55],v14,18432
M v[108:111],a[160:163],a[124:127],v[108:111]
s_mov_b32 s25, 1048832
T v[56:57],v14,20480
T v[58:59],v14,22528
M v[108:111],a[156:159],a[116:119],v[108:111]
s_sub_u32 s64, s42, 10
s_and_b32 s35, s64, 536870912
v_or_b32 v6, s35, v7
M v[108:111],a[152:155],a[108:111],v[108:111]
SA m0,s4,81920
MF v96,s5,v96
MF v97,s5,v97
M v[108:111],a[148:151],a[100:103],v[108:111]
s_lshl_b32 s28, s20, 13
buffer_load_dwordx4 v8, s[52:55], s25 offen lds
M v[108:111],a[144:147],a[236:239],v[108:111]
s_waitcnt lgkmcnt(6)
v_add_u32 v2, 0x10000, v7
v_add_u32 v3, s28, v7
M v[112:115],v[32:35],a[232:235],v[112:115]
s_mov_b32 s25, 1310976
T a[144:145],v19,28672
T a[146:147],v19,30720
M v[112:115],v[36:39],a[96:99],v[112:115]
SA m0,s4,86016
v_add_u32 v4, 0x1000, v3
MF v98,s5,v98
M v[112:115],v[40:43],a[104:107],v[112:115]
s_waitcnt lgkmcnt(2)
T a[148:149],v15,0
T a[150:151],v15,2048
M v[112:115],v[44:47],a[112:115],v[112:115]
s_lshl_b32 s64, s42, 16
T a[152:153],v15,4096
T a[154:155],v15,6144
M v[112:115],v[48:51],a[120:123],v[112:115]
SA s23,s21,s64
buffer_load_dwordx4 v8, s[52:55], s25 offen lds
M v[112:115],v[52:55],a[128:131],v[112:115]
SA s43,s23,16777216
T a[156:157],v15,8192
T a[158:159],v15,10240
M v[112:115],v[56:59],a[136:139],v[112:115]
s_mov_b32 s25, 1573120
T a[160:161],v15,12288
T a[162:163],v15,14336
M v[116:119],v[56:59],a[140:143],v[116:119]
SA m0,s4,90112
MF v99,s5,v99
MF v104,s5,v104
M v[116:119],v[52:55],a[132:135],v[116:119]
SA s26,s21,16777216
T a[164:165],v15,16384
T a[166:167],v15,18432
M v[116:119],v[48:51],a[124:127],v[116:119]
s_min_u32 s27, s42, 9
T a[168:169],v15,20480
T a[170:171],v15,22528
M v[116:119],v[44:47],a[116:119],v[116:119]
s_lshl_b32 s22, s27, 1
buffer_load_dwordx4 v8, s[52:55], s25 offen lds
M v[116:119],v[40:43],a[108:111],v[116:119]
s_sub_u32 s22, s22, 1
MF v105,s5,v105
MF v106,s5,v106
M v[116:119],v[36:39],a[100:103],v[116:119]
s_waitcnt vmcnt(8) lgkmcnt(0)
MF v107,s5,v107
C v96,v96,v97
M v[116:119],v[32:35],a[236:239],v[116:119]
s_barrier
M v[120:123],a[144:147],a[232:235],v[120:123]
s_mov_b32 s25, 1835264
T v[32:33],v16,49152
T v[34:35],v16,51200
M v[120:123],a[148:151],a[96:99],v[120:123]
SA m0,s4,94208
C v97,v98,v99
C v98,v104,v105
M v[120:123],a[152:155],a[104:107],v[120:123]
s_sub_u32 s27, s27, 2
T v[36:37],v16,53248
T v[38:39],v16,55296
M v[120:123],a[156:159],a[112:115],v[120:123]
s_mov_b32 s31, 0x4b800000
T v[40:41],v16,57344
T v[42:43],v16,59392
M v[120:123],a[160:163],a[120:123],v[120:123]
s_mov_b32 s24, 0x33800000
buffer_load_dwordx4 v8, s[52:55], s25 offen lds
M v[120:123],a[164:167],a[128:131],v[120:123]
s_lshl_b32 s47, s66, 7
T v[44:45],v16,61440
T v[46:47],v16,63488
M v[120:123],a[168:171],a[136:139],v[120:123]
s_mov_b32 s25, 2097408
T v[48:49],v20,32768
T v[50:51],v20,34816
M v[124:127],a[168:171],a[140:143],v[124:127]
SA m0,s4,155648
C v99,v106,v107
W a0,v96
M v[124:127],a[164:167],a[132:135],v[124:127]
SA s47,s47,s46
T v[52:53],v20,36864
T v[54:55],v20,38912
M v[124:127],a[160:163],a[124:127],v[124:127]
s_lshl_b32 s64, s20, 5
T v[56:57],v20,40960
T v[58:59],v20,43008
M v[124:127],a[156:159],a[116:119],v[124:127]
SA s47,s47,s64
buffer_load_dwordx4 v8, s[52:55], s25 offen lds
M v[124:127],a[152:155],a[108:111],v[124:127]
SA s47,s47,2048
W a1,v97
W a2,v98
M v[124:127],a[148:151],a[100:103],v[124:127]
s_lshl_b32 s65, s41, 3
W a3,v99
MF v100,s5,v100
M v[124:127],a[144:147],a[236:239],v[124:127]
s_waitcnt lgkmcnt(6)
MF v101,s5,v101
MF v102,s5,v102
M v[160:163],v[32:35],a[176:179],0
SA s30,s32,0
T a[144:145],v17,49152
T a[146:147],v17,51200
M v[160:163],v[36:39],a[184:187],v[160:163]
SA s65,s65,s66
buffer_store_dwordx4 a[0:3], v6, s[8:11], s30 offen offset:0 sc1
M v[160:163],v[40:43],a[192:195],v[160:163]
s_waitcnt lgkmcnt(2)
s_nop 0
T a[148:149],v17,53248
T a[150:151],v17,55296
M v[160:163],v[44:47],a[200:203],v[160:163]
s_mul_i32 s34, s65, 73728
T a[152:153],v17,57344
T a[154:155],v17,59392
M v[160:163],v[48:51],a[208:211],v[160:163]
SA s34,s34,136314880
MF v103,s5,v103
MF v108,s5,v108
M v[160:163],v[52:55],a[216:219],v[160:163]
s_lshl_b32 s65, s42, 4
T a[156:157],v17,61440
T a[158:159],v17,63488
M v[160:163],v[56:59],a[224:227],v[160:163]
SA s65,s65,s41
T a[160:161],v21,32768
T a[162:163],v21,34816
M v[164:167],v[56:59],a[228:231],0
s_mul_i32 s33, s65, 114688
MF v109,s5,v109
MF v110,s5,v110
M v[164:167],v[52:55],a[220:223],v[164:167]
s_mul_i32 s65, s20, 28672
T a[164:165],v21,36864
T a[166:167],v21,38912
M v[164:167],v[48:51],a[212:215],v[164:167]
SA s33,s33,s65
T a[168:169],v21,40960
T a[170:171],v21,43008
M v[164:167],v[44:47],a[204:207],v[164:167]
SA s33,s33,67108864
MF v111,s5,v111
C v100,v100,v101
M v[164:167],v[40:43],a[196:199],v[164:167]
s_mov_b32 s6, 0
C v101,v102,v103
C v102,v108,v109
M v[164:167],v[36:39],a[188:191],v[164:167]
s_mov_b32 s7, 1
C v103,v110,v111
W a32,v100
M v[164:167],v[32:35],a[180:183],v[164:167]
s_waitcnt lgkmcnt(6)
W a33,v101
W a34,v102
M v[168:171],a[144:147],a[176:179],0
s_mov_b32 s40, 1
T v[32:33],v18,49152
T v[34:35],v18,51200
M v[168:171],a[148:151],a[184:187],v[168:171]
s_cmp_eq_u32 s20, 0
W a35,v103
MF v112,s5,v112
M v[168:171],a[152:155],a[192:195],v[168:171]
s_waitcnt lgkmcnt(2)
T v[36:37],v18,53248
T v[38:39],v18,55296
M v[168:171],a[156:159],a[200:203],v[168:171]
s_cselect_b32 s39, 6, 4
T v[40:41],v18,57344
T v[42:43],v18,59392
M v[168:171],a[160:163],a[208:211],v[168:171]
s_mov_b64 s[60:61], s[76:77]
MF v113,s5,v113
MF v114,s5,v114
M v[168:171],a[164:167],a[216:219],v[168:171]
s_mov_b32 s62, s78
T v[44:45],v18,61440
T v[46:47],v18,63488
M v[168:171],a[168:171],a[224:227],v[168:171]
s_mov_b32 s63, 0x20000
T v[48:49],v22,32768
T v[50:51],v22,34816
M v[172:175],a[168:171],a[228:231],0
s_mov_b32 s25, 2359552
v_lshrrev_b32 v24, 4, v0
v_lshlrev_b32 v24, 2, v24
M v[172:175],a[164:167],a[220:223],v[172:175]
SA m0,s4,159744
T v[52:53],v22,36864
T v[54:55],v22,38912
M v[172:175],a[160:163],a[212:215],v[172:175]
SA s3,s93,528384
T v[56:57],v22,40960
T v[58:59],v22,43008
M v[172:175],a[156:159],a[204:207],v[172:175]
buffer_load_dwordx4 v8, s[52:55], s25 offen lds
M v[172:175],a[152:155],a[196:199],v[172:175]
SA s30,s32,8192
v_and_b32 v25, 15, v0
v_sub_u32 v24, v24, v25
M v[172:175],a[148:151],a[188:191],v[172:175]
s_mov_b32 s25, 2621696
buffer_store_dwordx4 a[32:35], v6, s[8:11], s30 offen offset:0 sc1
M v[172:175],a[144:147],a[180:183],v[172:175]
s_waitcnt lgkmcnt(6)
v_cmp_lt_i32 s[16:17], 0, v24
v_cmp_lt_i32 s[18:19], -1, v24
M v[176:179],v[32:35],a[176:179],0
SA m0,s4,131072
T a[144:145],v19,49152
T a[146:147],v19,51200
M v[176:179],v[36:39],a[184:187],v[176:179]
buffer_load_dwordx4 v8, s[52:55], s25 offen lds
M v[176:179],v[40:43],a[192:195],v[176:179]
s_waitcnt lgkmcnt(2)
s_nop 0
T a[148:149],v19,53248
T a[150:151],v19,55296
M v[176:179],v[44:47],a[200:203],v[176:179]
s_mov_b32 s25, 2883840
T a[152:153],v19,57344
T a[154:155],v19,59392
M v[176:179],v[48:51],a[208:211],v[176:179]
SA m0,s4,135168
buffer_store_dwordx4 v[76:79], v7, s[8:11], s3 offen offset:2048 sc1
M v[176:179],v[52:55],a[216:219],v[176:179]
s_nop 0
T a[156:157],v19,61440
T a[158:159],v19,63488
M v[176:179],v[56:59],a[224:227],v[176:179]
T a[160:161],v23,32768
T a[162:163],v23,34816
M v[180:183],v[56:59],a[228:231],0
buffer_load_dwordx4 v8, s[52:55], s25 offen lds
M v[180:183],v[52:55],a[220:223],v[180:183]
s_nop 0
T a[164:165],v23,36864
T a[166:167],v23,38912
M v[180:183],v[48:51],a[212:215],v[180:183]
s_mov_b32 s25, 3145984
T a[168:169],v23,40960
T a[170:171],v23,43008
M v[180:183],v[44:47],a[204:207],v[180:183]
SA m0,s4,139264
v_cmp_lt_i32 s[48:49], -2, v24
v_cmp_lt_i32 s[50:51], -3, v24
M v[180:183],v[40:43],a[196:199],v[180:183]
buffer_load_dwordx4 v8, s[52:55], s25 offen lds
M v[180:183],v[36:39],a[188:191],v[180:183]
v_lshl_add_u32 v25, v0, 7, s95
v_and_b32 v0, 48, v0
M v[180:183],v[32:35],a[180:183],v[180:183]
s_waitcnt lgkmcnt(6)
MF v115,s5,v115
MF v120,s5,v120
M v[184:187],a[144:147],a[176:179],0
s_mov_b32 s25, 3408128
T v[32:33],v20,45056
T v[34:35],v20,47104
M v[184:187],a[148:151],a[184:187],v[184:187]
SA m0,s4,143360
MF v121,s5,v121
MF v122,s5,v122
M v[184:187],a[152:155],a[192:195],v[184:187]
s_waitcnt lgkmcnt(2)
T v[36:37],v20,49152
T v[38:39],v20,51200
M v[184:187],a[156:159],a[200:203],v[184:187]
T v[40:41],v20,53248
T v[42:43],v20,55296
M v[184:187],a[160:163],a[208:211],v[184:187]
buffer_load_dwordx4 v8, s[52:55], s25 offen lds
M v[184:187],a[164:167],a[216:219],v[184:187]
s_nop 0
T v[44:45],v20,57344
T v[46:47],v20,59392
M v[184:187],a[168:171],a[224:227],v[184:187]
s_mov_b32 s25, 384
T v[48:49],v20,61440
T v[50:51],v20,63488
M v[188:191],a[168:171],a[228:231],0
SA m0,s4,0
MF v123,s5,v123
C v112,v112,v113
M v[188:191],a[164:167],a[220:223],v[188:191]
T v[52:53],v16,32768
T v[54:55],v16,34816
M v[188:191],a[160:163],a[212:215],v[188:191]
T v[56:57],v16,36864
T v[58:59],v16,38912
M v[188:191],a[156:159],a[204:207],v[188:191]
buffer_load_dwordx4 v8, s[52:55], s25 offen lds
M v[188:191],a[152:155],a[196:199],v[188:191]
C v113,v114,v115
C v114,v120,v121
M v[188:191],a[148:151],a[188:191],v[188:191]
s_mov_b32 s25, 262528
C v115,v122,v123
W a4,v112
M v[188:191],a[144:147],a[180:183],v[188:191]
s_waitcnt lgkmcnt(6)
W a5,v113
W a6,v114
M v[160:163],v[32:35],a[232:235],v[160:163]
SA m0,s4,4096
T a[144:145],v21,45056
T a[146:147],v21,47104
M v[160:163],v[36:39],a[96:99],v[160:163]
SA s3,s93,532480
buffer_load_dwordx4 v8, s[52:55], s25 offen lds
M v[160:163],v[40:43],a[104:107],v[160:163]
s_waitcnt lgkmcnt(2)
s_nop 0
T a[148:149],v21,49152
T a[150:151],v21,51200
M v[160:163],v[44:47],a[112:115],v[160:163]
s_mov_b32 s25, 524672
T a[152:153],v21,53248
T a[154:155],v21,55296
M v[160:163],v[48:51],a[120:123],v[160:163]
SA m0,s4,8192
buffer_store_dwordx4 v[80:83], v7, s[8:11], s3 offen offset:0 sc1
M v[160:163],v[52:55],a[128:131],v[160:163]
s_nop 0
T a[156:157],v21,57344
T a[158:159],v21,59392
M v[160:163],v[56:59],a[136:139],v[160:163]
T a[160:161],v21,61440
T a[162:163],v21,63488
M v[164:167],v[56:59],a[140:143],v[164:167]
buffer_load_dwordx4 v8, s[52:55], s25 offen lds
M v[164:167],v[52:55],a[132:135],v[164:167]
s_nop 0
T a[164:165],v17,32768
T a[166:167],v17,34816
M v[164:167],v[48:51],a[124:127],v[164:167]
s_mov_b32 s25, 786816
T a[168:169],v17,36864
T a[170:171],v17,38912
M v[164:167],v[44:47],a[116:119],v[164:167]
SA m0,s4,12288
buffer_store_dwordx4 v[84:87], v7, s[8:11], s3 offen offset:2048 sc1
M v[164:167],v[40:43],a[108:111],v[164:167]
W a7,v115
v_lshl_add_u32 v0, v0, 24, v25
M v[164:167],v[36:39],a[100:103],v[164:167]
SA s30,s32,0
buffer_store_dwordx4 a[4:7], v6, s[8:11], s30 offen offset:1024 sc1
M v[164:167],v[32:35],a[236:239],v[164:167]
s_waitcnt lgkmcnt(6)
v_mov_b32 v24, 0x3f80
MF v116,s5,v116
M v[168:171],a[144:147],a[232:235],v[168:171]
T v[32:33],v22,45056
T v[34:35],v22,47104
M v[168:171],a[148:151],a[96:99],v[168:171]
buffer_load_dwordx4 v8, s[52:55], s25 offen lds
M v[168:171],a[152:155],a[104:107],v[168:171]
s_waitcnt lgkmcnt(2)
s_nop 0
T v[36:37],v22,49152
T v[38:39],v22,51200
M v[168:171],a[156:159],a[112:115],v[168:171]
s_mov_b32 s25, 1048960
T v[40:41],v22,53248
T v[42:43],v22,55296
M v[168:171],a[160:163],a[120:123],v[168:171]
SA m0,s4,16384
MF v117,s5,v117
MF v118,s5,v118
M v[168:171],a[164:167],a[128:131],v[168:171]
T v[44:45],v22,57344
T v[46:47],v22,59392
M v[168:171],a[168:171],a[136:139],v[168:171]
T v[48:49],v22,61440
T v[50:51],v22,63488
M v[172:175],a[168:171],a[140:143],v[172:175]
buffer_load_dwordx4 v8, s[52:55], s25 offen lds
M v[172:175],a[164:167],a[132:135],v[172:175]
s_nop 0
T v[52:53],v18,32768
T v[54:55],v18,34816
M v[172:175],a[160:163],a[124:127],v[172:175]
s_mov_b32 s25, 1311104
T v[56:57],v18,36864
T v[58:59],v18,38912
M v[172:175],a[156:159],a[116:119],v[172:175]
SA m0,s4,20480
MF v119,s5,v119
MF v124,s5,v124
M v[172:175],a[152:155],a[108:111],v[172:175]
buffer_load_dwordx4 v8, s[52:55], s25 offen lds
M v[172:175],a[148:151],a[100:103],v[172:175]
v_lshrrev_b32 v25, 8, v7
v_bfe_u32 v26, v7, 6, 2
v_and_b32 v27, 16, v7
v_lshlrev_b32 v27, v27, v24
v_cmp_eq_u32 vcc, v25, v26
v_and_b32 v28, 32, v7
W a244,0
v_cndmask_b32 v27, 0, v27, vcc
v_cmp_eq_u32 vcc, 0, v28
W a245,0
W a248,0
v_cndmask_b32 v25, 0, v27, vcc
v_sub_u32 v26, v27, v25
W a249,0
W a246,v25
W a247,v26
M v[172:175],a[144:147],a[236:239],v[172:175]
s_waitcnt lgkmcnt(6)
MF v125,s5,v125
MF v126,s5,v126
M v[176:179],v[32:35],a[232:235],v[176:179]
s_mov_b32 s25, 1573248
T a[144:145],v23,45056
T a[146:147],v23,47104
M v[176:179],v[36:39],a[96:99],v[176:179]
SA m0,s4,24576
MF v127,s5,v127
C v116,v116,v117
M v[176:179],v[40:43],a[104:107],v[176:179]
s_waitcnt lgkmcnt(2)
T a[148:149],v23,49152
T a[150:151],v23,51200
M v[176:179],v[44:47],a[112:115],v[176:179]
T a[152:153],v23,53248
T a[154:155],v23,55296
M v[176:179],v[48:51],a[120:123],v[176:179]
buffer_load_dwordx4 v8, s[52:55], s25 offen lds
M v[176:179],v[52:55],a[128:131],v[176:179]
s_nop 0
T a[156:157],v23,57344
T a[158:159],v23,59392
M v[176:179],v[56:59],a[136:139],v[176:179]
s_mov_b32 s25, 1835392
T a[160:161],v23,61440
T a[162:163],v23,63488
M v[180:183],v[56:59],a[140:143],v[180:183]
SA m0,s4,28672
C v117,v118,v119
C v118,v124,v125
M v[180:183],v[52:55],a[132:135],v[180:183]
T a[164:165],v19,32768
T a[166:167],v19,34816
M v[180:183],v[48:51],a[124:127],v[180:183]
T a[168:169],v19,36864
T a[170:171],v19,38912
M v[180:183],v[44:47],a[116:119],v[180:183]
buffer_load_dwordx4 v8, s[52:55], s25 offen lds
M v[180:183],v[40:43],a[108:111],v[180:183]
C v119,v126,v127
W a36,v116
M v[180:183],v[36:39],a[100:103],v[180:183]
s_waitcnt vmcnt(11) lgkmcnt(0)
W a37,v117
W a38,v118
M v[180:183],v[32:35],a[236:239],v[180:183]
s_barrier
M v[184:187],a[144:147],a[232:235],v[184:187]
s_mov_b32 s25, 2097536
T v[32:33],v20,0
T v[34:35],v20,2048
M v[184:187],a[148:151],a[96:99],v[184:187]
SA m0,s4,40960
W a39,v119
MF v160,s5,v160
M v[184:187],a[152:155],a[104:107],v[184:187]
SA s30,s32,8192
T v[36:37],v20,4096
T v[38:39],v20,6144
M v[184:187],a[156:159],a[112:115],v[184:187]
T v[40:41],v20,8192
T v[42:43],v20,10240
M v[184:187],a[160:163],a[120:123],v[184:187]
buffer_store_dwordx4 a[36:39], v6, s[8:11], s30 offen offset:1024 sc1
M v[184:187],a[164:167],a[128:131],v[184:187]
s_nop 0
T v[44:45],v20,12288
T v[46:47],v20,14336
M v[184:187],a[168:171],a[136:139],v[184:187]
T v[48:49],v20,16384
T v[50:51],v20,18432
M v[188:191],a[168:171],a[140:143],v[188:191]
buffer_load_dwordx4 v8, s[52:55], s25 offen lds
M v[188:191],a[164:167],a[132:135],v[188:191]
s_nop 0
T v[52:53],v20,20480
T v[54:55],v20,22528
M v[188:191],a[160:163],a[124:127],v[188:191]
s_mov_b32 s25, 2359680
T v[56:57],v20,24576
T v[58:59],v20,26624
M v[188:191],a[156:159],a[116:119],v[188:191]
SA m0,s4,45056
MF v161,s5,v161
MF v162,s5,v162
M v[188:191],a[152:155],a[108:111],v[188:191]
buffer_load_dwordx4 v8, s[52:55], s25 offen lds
M v[188:191],a[148:151],a[100:103],v[188:191]
MF v163,s5,v163
MF v168,s5,v168
M v[188:191],a[144:147],a[236:239],v[188:191]
s_waitcnt lgkmcnt(6)
MF v169,s5,v169
MF v170,s5,v170
M v[96:99],v[32:35],a[176:179],0
s_mov_b32 s25, 2621824
T a[144:145],v21,0
T a[146:147],v21,2048
M v[96:99],v[36:39],a[184:187],v[96:99]
SA m0,s4,49152
MF v171,s5,v171
C v160,v160,v161
M v[96:99],v[40:43],a[192:195],v[96:99]
s_waitcnt lgkmcnt(2)
T a[148:149],v21,4096
T a[150:151],v21,6144
M v[96:99],v[44:47],a[200:203],v[96:99]
T a[152:153],v21,8192
T a[154:155],v21,10240
M v[96:99],v[48:51],a[208:211],v[96:99]
buffer_load_dwordx4 v8, s[52:55], s25 offen lds
M v[96:99],v[52:55],a[216:219],v[96:99]
s_nop 0
T a[156:157],v21,12288
T a[158:159],v21,14336
M v[96:99],v[56:59],a[224:227],v[96:99]
s_mov_b32 s25, 2883968
T a[160:161],v21,16384
T a[162:163],v21,18432
M v[100:103],v[56:59],a[228:231],0
SA m0,s4,53248
C v161,v162,v163
C v162,v168,v169
M v[100:103],v[52:55],a[220:223],v[100:103]
T a[164:165],v21,20480
T a[166:167],v21,22528
M v[100:103],v[48:51],a[212:215],v[100:103]
T a[168:169],v21,24576
T a[170:171],v21,26624
M v[100:103],v[44:47],a[204:207],v[100:103]
SA s3,s93,536576
buffer_load_dwordx4 v8, s[52:55], s25 offen lds
M v[100:103],v[40:43],a[196:199],v[100:103]
C v163,v170,v171
W a8,v160
M v[100:103],v[36:39],a[188:191],v[100:103]
s_mov_b32 s25, 3146112
W a9,v161
W a10,v162
M v[100:103],v[32:35],a[180:183],v[100:103]
s_waitcnt lgkmcnt(6)
W a11,v163
v_lshrrev_b32 v31, 6, v7
M v[104:107],a[144:147],a[176:179],0
SA s30,s32,0
T v[32:33],v22,0
T v[34:35],v22,2048
M v[104:107],a[148:151],a[184:187],v[104:107]
SA m0,s4,57344
buffer_store_dwordx4 a[8:11], v6, s[8:11], s30 offen offset:2048 sc1
M v[104:107],a[152:155],a[192:195],v[104:107]
s_waitcnt lgkmcnt(2)
s_nop 0
T v[36:37],v22,4096
T v[38:39],v22,6144
M v[104:107],a[156:159],a[200:203],v[104:107]
T v[40:41],v22,8192
T v[42:43],v22,10240
M v[104:107],a[160:163],a[208:211],v[104:107]
buffer_load_dwordx4 v8, s[52:55], s25 offen lds
M v[104:107],a[164:167],a[216:219],v[104:107]
s_nop 0
T v[44:45],v22,12288
T v[46:47],v22,14336
M v[104:107],a[168:171],a[224:227],v[104:107]
s_mov_b32 s25, 3408256
T v[48:49],v22,16384
T v[50:51],v22,18432
M v[108:111],a[168:171],a[228:231],0
SA m0,s4,61440
buffer_store_dwordx4 v[88:91], v7, s[8:11], s3 offen offset:0 sc1
M v[108:111],a[164:167],a[220:223],v[108:111]
s_nop 0
T v[52:53],v22,20480
T v[54:55],v22,22528
M v[108:111],a[160:163],a[212:215],v[108:111]
T v[56:57],v22,24576
T v[58:59],v22,26624
M v[108:111],a[156:159],a[204:207],v[108:111]
buffer_load_dwordx4 v8, s[52:55], s25 offen lds
M v[108:111],a[152:155],a[196:199],v[108:111]
v_bfe_u32 v28, v7, 4, 2
v_lshlrev_b32 v31, 5, v31
M v[108:111],a[148:151],a[188:191],v[108:111]
buffer_store_dwordx4 v[92:95], v7, s[8:11], s3 offen offset:2048 sc1
M v[108:111],a[144:147],a[180:183],v[108:111]
s_waitcnt lgkmcnt(6)
v_add_lshl_u32 v31, v31, v28, 2
MF v164,s5,v164
M v[112:115],v[32:35],a[176:179],0
T a[144:145],v23,0
T a[146:147],v23,2048
M v[112:115],v[36:39],a[184:187],v[112:115]
buffer_load_dword v5, v31, s[8:11], s46 offen offset:4 sc1
M v[112:115],v[40:43],a[192:195],v[112:115]
s_waitcnt lgkmcnt(2)
s_nop 0
T a[148:149],v23,4096
T a[150:151],v23,6144
M v[112:115],v[44:47],a[200:203],v[112:115]
T a[152:153],v23,8192
T a[154:155],v23,10240
M v[112:115],v[48:51],a[208:211],v[112:115]
MF v165,s5,v165
MF v166,s5,v166
M v[112:115],v[52:55],a[216:219],v[112:115]
T a[156:157],v23,12288
T a[158:159],v23,14336
M v[112:115],v[56:59],a[224:227],v[112:115]
T a[160:161],v23,16384
T a[162:163],v23,18432
M v[116:119],v[56:59],a[228:231],0
MF v167,s5,v167
MF v172,s5,v172
M v[116:119],v[52:55],a[220:223],v[116:119]
T a[164:165],v23,20480
T a[166:167],v23,22528
M v[116:119],v[48:51],a[212:215],v[116:119]
T a[168:169],v23,24576
T a[170:171],v23,26624
M v[116:119],v[44:47],a[204:207],v[116:119]
MF v173,s5,v173
MF v174,s5,v174
M v[116:119],v[40:43],a[196:199],v[116:119]
MF v175,s5,v175
C v164,v164,v165
M v[116:119],v[36:39],a[188:191],v[116:119]
C v165,v166,v167
C v166,v172,v173
M v[116:119],v[32:35],a[180:183],v[116:119]
s_waitcnt lgkmcnt(6)
C v167,v174,v175
W a40,v164
M v[120:123],a[144:147],a[176:179],0
T v[32:33],v20,28672
T v[34:35],v20,30720
M v[120:123],a[148:151],a[184:187],v[120:123]
W a41,v165
W a42,v166
M v[120:123],a[152:155],a[192:195],v[120:123]
s_waitcnt lgkmcnt(2)
T v[36:37],v12,24576
T v[38:39],v12,26624
M v[120:123],a[156:159],a[200:203],v[120:123]
T v[40:41],v12,28672
T v[42:43],v12,30720
M v[120:123],a[160:163],a[208:211],v[120:123]
W a43,v167
v_mov_b32 v8, 0xff800000
M v[120:123],a[164:167],a[216:219],v[120:123]
SA s30,s32,8192
T v[44:45],v12,0
T v[46:47],v12,2048
M v[120:123],a[168:171],a[224:227],v[120:123]
T v[48:49],v12,4096
T v[50:51],v12,6144
M v[124:127],a[168:171],a[228:231],0
buffer_store_dwordx4 a[40:43], v6, s[8:11], s30 offen offset:2048 sc1
M v[124:127],a[164:167],a[220:223],v[124:127]
s_nop 0
T v[52:53],v12,8192
T v[54:55],v12,10240
M v[124:127],a[160:163],a[212:215],v[124:127]
T v[56:57],v12,12288
T v[58:59],v12,14336
M v[124:127],a[156:159],a[204:207],v[124:127]
MF v176,s5,v176
MF v177,s5,v177
M v[124:127],a[152:155],a[196:199],v[124:127]
MF v178,s5,v178
MF v179,s5,v179
M v[124:127],a[148:151],a[188:191],v[124:127]
MF v184,s5,v184
MF v185,s5,v185
M v[124:127],a[144:147],a[180:183],v[124:127]
s_waitcnt lgkmcnt(6)
MF v186,s5,v186
MF v187,s5,v187
M v[96:99],v[32:35],a[232:235],v[96:99]
T a[144:145],v21,28672
T a[146:147],v21,30720
M v[96:99],v[36:39],a[96:99],v[96:99]
C v176,v176,v177
C v177,v178,v179
M v[96:99],v[40:43],a[104:107],v[96:99]
s_waitcnt lgkmcnt(2)
T a[148:149],v13,24576
T a[150:151],v13,26624
M v[96:99],v[44:47],a[112:115],v[96:99]
T a[152:153],v13,28672
T a[154:155],v13,30720
M v[96:99],v[48:51],a[120:123],v[96:99]
C v178,v184,v185
C v179,v186,v187
M v[96:99],v[52:55],a[128:131],v[96:99]
T a[156:157],v13,0
T a[158:159],v13,2048
M v[96:99],v[56:59],a[136:139],v[96:99]
T a[160:161],v13,4096
T a[162:163],v13,6144
M v[100:103],v[56:59],a[140:143],v[100:103]
W a12,v176
W a13,v177
M v[100:103],v[52:55],a[132:135],v[100:103]
T a[164:165],v13,8192
T a[166:167],v13,10240
M v[100:103],v[48:51],a[124:127],v[100:103]
T a[168:169],v13,12288
T a[170:171],v13,14336
M v[100:103],v[44:47],a[116:119],v[100:103]
W a14,v178
W a15,v179
M v[100:103],v[40:43],a[108:111],v[100:103]
MF v180,s5,v180
MF v181,s5,v181
M v[100:103],v[36:39],a[100:103],v[100:103]
MF v182,s5,v182
MF v183,s5,v183
M v[100:103],v[32:35],a[236:239],v[100:103]
s_waitcnt lgkmcnt(6)
MF v188,s5,v188
MF v189,s5,v189
M v[104:107],a[144:147],a[232:235],v[104:107]
T v[32:33],v22,28672
T v[34:35],v22,30720
M v[104:107],a[148:151],a[96:99],v[104:107]
MF v190,s5,v190
MF v191,s5,v191
M v[104:107],a[152:155],a[104:107],v[104:107]
s_waitcnt lgkmcnt(2)
T v[36:37],v14,24576
T v[38:39],v14,26624
M v[104:107],a[156:159],a[112:115],v[104:107]
SA s30,s32,0
T v[40:41],v14,28672
T v[42:43],v14,30720
M v[104:107],a[160:163],a[120:123],v[104:107]
buffer_store_dwordx4 a[12:15], v6, s[8:11], s30 offen offset:3072 sc1
M v[104:107],a[164:167],a[128:131],v[104:107]
s_nop 0
T v[44:45],v14,0
T v[46:47],v14,2048
M v[104:107],a[168:171],a[136:139],v[104:107]
T v[48:49],v14,4096
T v[50:51],v14,6144
M v[108:111],a[168:171],a[140:143],v[108:111]
C v180,v180,v181
C v181,v182,v183
M v[108:111],a[164:167],a[132:135],v[108:111]
T v[52:53],v14,8192
T v[54:55],v14,10240
M v[108:111],a[160:163],a[124:127],v[108:111]
T v[56:57],v14,12288
T v[58:59],v14,14336
M v[108:111],a[156:159],a[116:119],v[108:111]
C v182,v188,v189
C v183,v190,v191
M v[108:111],a[152:155],a[108:111],v[108:111]
W a44,v180
W a45,v181
M v[108:111],a[148:151],a[100:103],v[108:111]
W a46,v182
W a47,v183
M v[108:111],a[144:147],a[236:239],v[108:111]
s_waitcnt lgkmcnt(6)
s_waitcnt vmcnt(2)
v_cmp_ne_u32 vcc, 1, v5
MF v96,s5,v96
M v[112:115],v[32:35],a[232:235],v[112:115]
s_nop 0
T a[144:145],v23,28672
T a[146:147],v23,30720
M v[112:115],v[36:39],a[96:99],v[112:115]
s_cmp_lg_u32 vcc_lo, 0
MF v97,s5,v97
MF v98,s5,v98
M v[112:115],v[40:43],a[104:107],v[112:115]
s_waitcnt lgkmcnt(2)
T a[148:149],v15,24576
T a[150:151],v15,26624
M v[112:115],v[44:47],a[112:115],v[112:115]
s_cbranch_scc1 L_wsq1
L_wrq1:
T a[152:153],v15,28672
T a[154:155],v15,30720
M v[112:115],v[48:51],a[120:123],v[112:115]
SA m0,s28,98304
MF v99,s5,v99
MF v104,s5,v104
M v[112:115],v[52:55],a[128:131],v[112:115]
T a[156:157],v15,0
T a[158:159],v15,2048
M v[112:115],v[56:59],a[136:139],v[112:115]
T a[160:161],v15,4096
T a[162:163],v15,6144
M v[116:119],v[56:59],a[140:143],v[116:119]
buffer_load_dwordx4 v3, s[8:11], s21 offen offset:0 sc1 lds
M v[116:119],v[52:55],a[132:135],v[116:119]
s_nop 0
T a[164:165],v15,8192
T a[166:167],v15,10240
M v[116:119],v[48:51],a[124:127],v[116:119]
T a[168:169],v15,12288
T a[170:171],v15,14336
M v[116:119],v[44:47],a[116:119],v[116:119]
buffer_load_dwordx4 v3, s[8:11], s21 offen offset:1024 sc1 lds
M v[116:119],v[40:43],a[108:111],v[116:119]
MF v105,s5,v105
MF v106,s5,v106
M v[116:119],v[36:39],a[100:103],v[116:119]
s_waitcnt lgkmcnt(0)
buffer_load_dwordx4 v3, s[8:11], s21 offen offset:2048 sc1 lds
M v[116:119],v[32:35],a[236:239],v[116:119]
s_barrier
M v[120:123],a[144:147],a[232:235],v[120:123]
SA s30,s32,8192
T v[32:33],v16,0
T v[34:35],v16,2048
M v[120:123],a[148:151],a[96:99],v[120:123]
buffer_store_dwordx4 a[44:47], v6, s[8:11], s30 offen offset:3072 sc1
M v[120:123],a[152:155],a[104:107],v[120:123]
s_nop 0
T v[36:37],v16,4096
T v[38:39],v16,6144
M v[120:123],a[156:159],a[112:115],v[120:123]
T v[40:41],v16,8192
T v[42:43],v16,10240
M v[120:123],a[160:163],a[120:123],v[120:123]
buffer_load_dwordx4 v3, s[8:11], s21 offen offset:3072 sc1 lds
M v[120:123],a[164:167],a[128:131],v[120:123]
SA m0,s28,102400
T v[44:45],v16,12288
T v[46:47],v16,14336
M v[120:123],a[168:171],a[136:139],v[120:123]
T v[48:49],v16,16384
T v[50:51],v16,18432
M v[124:127],a[168:171],a[140:143],v[124:127]
buffer_load_dwordx4 v4, s[8:11], s21 offen offset:0 sc1 lds
M v[124:127],a[164:167],a[132:135],v[124:127]
s_nop 0
T v[52:53],v16,20480
T v[54:55],v16,22528
M v[124:127],a[160:163],a[124:127],v[124:127]
T v[56:57],v16,24576
T v[58:59],v16,26624
M v[124:127],a[156:159],a[116:119],v[124:127]
buffer_load_dwordx4 v4, s[8:11], s21 offen offset:1024 sc1 lds
M v[124:127],a[152:155],a[108:111],v[124:127]
MF v107,s5,v107
C v96,v96,v97
M v[124:127],a[148:151],a[100:103],v[124:127]
buffer_load_dwordx4 v4, s[8:11], s21 offen offset:2048 sc1 lds
M v[124:127],a[144:147],a[236:239],v[124:127]
s_waitcnt lgkmcnt(6)
C v97,v98,v99
C v98,v104,v105
M v[160:163],v[32:35],a[176:179],0
T a[144:145],v17,0
T a[146:147],v17,2048
M v[160:163],v[36:39],a[184:187],v[160:163]
buffer_load_dwordx4 v4, s[8:11], s21 offen offset:3072 sc1 lds
M v[160:163],v[40:43],a[192:195],v[160:163]
s_waitcnt lgkmcnt(2)
s_nop 0
T a[148:149],v17,4096
T a[150:151],v17,6144
M v[160:163],v[44:47],a[200:203],v[160:163]
SA s21,s21,32768
T a[152:153],v17,8192
T a[154:155],v17,10240
M v[160:163],v[48:51],a[208:211],v[160:163]
s_sub_u32 s22, s22, 1
C v99,v106,v107
W a16,v96
M v[160:163],v[52:55],a[216:219],v[160:163]
s_cselect_b32 s21, s23, s21
T a[156:157],v17,12288
T a[158:159],v17,14336
M v[160:163],v[56:59],a[224:227],v[160:163]
SA m0,s28,65536
T a[160:161],v17,16384
T a[162:163],v17,18432
M v[164:167],v[56:59],a[228:231],0
buffer_load_dwordx4 v3, s[8:11], s21 offen offset:0 sc1 lds
M v[164:167],v[52:55],a[220:223],v[164:167]
s_nop 0
T a[164:165],v17,20480
T a[166:167],v17,22528
M v[164:167],v[48:51],a[212:215],v[164:167]
T a[168:169],v17,24576
T a[170:171],v17,26624
M v[164:167],v[44:47],a[204:207],v[164:167]
buffer_load_dwordx4 v3, s[8:11], s21 offen offset:1024 sc1 lds
M v[164:167],v[40:43],a[196:199],v[164:167]
buffer_load_dword v5, v31, s[8:11], s46 offen offset:4 sc1
M v[164:167],v[36:39],a[188:191],v[164:167]
buffer_load_dwordx4 v3, s[8:11], s21 offen offset:2048 sc1 lds
M v[164:167],v[32:35],a[180:183],v[164:167]
s_waitcnt lgkmcnt(6)
W a17,v97
W a18,v98
M v[168:171],a[144:147],a[176:179],0
T v[32:33],v18,0
T v[34:35],v18,2048
M v[168:171],a[148:151],a[184:187],v[168:171]
buffer_load_dwordx4 v3, s[8:11], s21 offen offset:3072 sc1 lds
M v[168:171],a[152:155],a[192:195],v[168:171]
s_waitcnt lgkmcnt(2)
s_nop 0
T v[36:37],v18,4096
T v[38:39],v18,6144
M v[168:171],a[156:159],a[200:203],v[168:171]
SA m0,s28,69632
T v[40:41],v18,8192
T v[42:43],v18,10240
M v[168:171],a[160:163],a[208:211],v[168:171]
buffer_load_dwordx4 v4, s[8:11], s21 offen offset:0 sc1 lds
M v[168:171],a[164:167],a[216:219],v[168:171]
s_nop 0
T v[44:45],v18,12288
T v[46:47],v18,14336
M v[168:171],a[168:171],a[224:227],v[168:171]
T v[48:49],v18,16384
T v[50:51],v18,18432
M v[172:175],a[168:171],a[228:231],0
buffer_load_dwordx4 v4, s[8:11], s21 offen offset:1024 sc1 lds
M v[172:175],a[164:167],a[220:223],v[172:175]
s_nop 0
T v[52:53],v18,20480
T v[54:55],v18,22528
M v[172:175],a[160:163],a[212:215],v[172:175]
T v[56:57],v18,24576
T v[58:59],v18,26624
M v[172:175],a[156:159],a[204:207],v[172:175]
buffer_load_dwordx4 v4, s[8:11], s21 offen offset:2048 sc1 lds
M v[172:175],a[152:155],a[196:199],v[172:175]
W a19,v99
MF v100,s5,v100
M v[172:175],a[148:151],a[188:191],v[172:175]
SA s30,s32,4096
buffer_store_dwordx4 a[16:19], v6, s[8:11], s30 offen offset:0 sc1
M v[172:175],a[144:147],a[180:183],v[172:175]
s_waitcnt lgkmcnt(6)
MF v101,s5,v101
MF v102,s5,v102
M v[176:179],v[32:35],a[176:179],0
T a[144:145],v19,0
T a[146:147],v19,2048
M v[176:179],v[36:39],a[184:187],v[176:179]
buffer_load_dwordx4 v4, s[8:11], s21 offen offset:3072 sc1 lds
M v[176:179],v[40:43],a[192:195],v[176:179]
s_waitcnt lgkmcnt(2)
s_nop 0
T a[148:149],v19,4096
T a[150:151],v19,6144
M v[176:179],v[44:47],a[200:203],v[176:179]
SA s21,s21,32768
T a[152:153],v19,8192
T a[154:155],v19,10240
M v[176:179],v[48:51],a[208:211],v[176:179]
s_sub_u32 s22, s22, 1
MF v103,s5,v103
MF v108,s5,v108
M v[176:179],v[52:55],a[216:219],v[176:179]
s_cselect_b32 s21, s23, s21
T a[156:157],v19,12288
T a[158:159],v19,14336
M v[176:179],v[56:59],a[224:227],v[176:179]
T a[160:161],v19,16384
T a[162:163],v19,18432
M v[180:183],v[56:59],a[228:231],0
MF v109,s5,v109
MF v110,s5,v110
M v[180:183],v[52:55],a[220:223],v[180:183]
T a[164:165],v19,20480
T a[166:167],v19,22528
M v[180:183],v[48:51],a[212:215],v[180:183]
T a[168:169],v19,24576
T a[170:171],v19,26624
M v[180:183],v[44:47],a[204:207],v[180:183]
MF v111,s5,v111
C v100,v100,v101
M v[180:183],v[40:43],a[196:199],v[180:183]
C v101,v102,v103
C v102,v108,v109
M v[180:183],v[36:39],a[188:191],v[180:183]
C v103,v110,v111
W a48,v100
M v[180:183],v[32:35],a[180:183],v[180:183]
s_waitcnt lgkmcnt(6)
W a49,v101
W a50,v102
M v[184:187],a[144:147],a[176:179],0
T v[32:33],v16,28672
T v[34:35],v16,30720
M v[184:187],a[148:151],a[184:187],v[184:187]
W a51,v103
MF v112,s5,v112
M v[184:187],a[152:155],a[192:195],v[184:187]
s_waitcnt lgkmcnt(2)
T v[36:37],v16,40960
T v[38:39],v16,43008
M v[184:187],a[156:159],a[200:203],v[184:187]
T v[40:41],v16,45056
T v[42:43],v16,47104
M v[184:187],a[160:163],a[208:211],v[184:187]
MF v113,s5,v113
MF v114,s5,v114
M v[184:187],a[164:167],a[216:219],v[184:187]
T v[44:45],v16,49152
T v[46:47],v16,51200
M v[184:187],a[168:171],a[224:227],v[184:187]
T v[48:49],v16,53248
T v[50:51],v16,55296
M v[188:191],a[168:171],a[228:231],0
MF v115,s5,v115
MF v120,s5,v120
M v[188:191],a[164:167],a[220:223],v[188:191]
SA s30,s32,12288
T v[52:53],v16,57344
T v[54:55],v16,59392
M v[188:191],a[160:163],a[212:215],v[188:191]
T v[56:57],v16,61440
T v[58:59],v16,63488
M v[188:191],a[156:159],a[204:207],v[188:191]
buffer_store_dwordx4 a[48:51], v6, s[8:11], s30 offen offset:0 sc1
M v[188:191],a[152:155],a[196:199],v[188:191]
MF v121,s5,v121
MF v122,s5,v122
M v[188:191],a[148:151],a[188:191],v[188:191]
MF v123,s5,v123
C v112,v112,v113
M v[188:191],a[144:147],a[180:183],v[188:191]
s_waitcnt lgkmcnt(6)
C v113,v114,v115
C v114,v120,v121
M v[160:163],v[32:35],a[232:235],v[160:163]
T a[144:145],v17,28672
T a[146:147],v17,30720
M v[160:163],v[36:39],a[96:99],v[160:163]
C v115,v122,v123
W a20,v112
M v[160:163],v[40:43],a[104:107],v[160:163]
s_waitcnt lgkmcnt(2)
T a[148:149],v17,40960
T a[150:151],v17,43008
M v[160:163],v[44:47],a[112:115],v[160:163]
T a[152:153],v17,45056
T a[154:155],v17,47104
M v[160:163],v[48:51],a[120:123],v[160:163]
W a21,v113
W a22,v114
M v[160:163],v[52:55],a[128:131],v[160:163]
T a[156:157],v17,49152
T a[158:159],v17,51200
M v[160:163],v[56:59],a[136:139],v[160:163]
T a[160:161],v17,53248
T a[162:163],v17,55296
M v[164:167],v[56:59],a[140:143],v[164:167]
W a23,v115
MF v116,s5,v116
M v[164:167],v[52:55],a[132:135],v[164:167]
T a[164:165],v17,57344
T a[166:167],v17,59392
M v[164:167],v[48:51],a[124:127],v[164:167]
T a[168:169],v17,61440
T a[170:171],v17,63488
M v[164:167],v[44:47],a[116:119],v[164:167]
MF v117,s5,v117
MF v118,s5,v118
M v[164:167],v[40:43],a[108:111],v[164:167]
MF v119,s5,v119
MF v124,s5,v124
M v[164:167],v[36:39],a[100:103],v[164:167]
MF v125,s5,v125
MF v126,s5,v126
M v[164:167],v[32:35],a[236:239],v[164:167]
s_waitcnt lgkmcnt(6)
MF v127,s5,v127
C v116,v116,v117
M v[168:171],a[144:147],a[232:235],v[168:171]
T v[32:33],v18,28672
T v[34:35],v18,30720
M v[168:171],a[148:151],a[96:99],v[168:171]
C v117,v118,v119
C v118,v124,v125
M v[168:171],a[152:155],a[104:107],v[168:171]
s_waitcnt lgkmcnt(2)
T v[36:37],v18,40960
T v[38:39],v18,43008
M v[168:171],a[156:159],a[112:115],v[168:171]
T v[40:41],v18,45056
T v[42:43],v18,47104
M v[168:171],a[160:163],a[120:123],v[168:171]
C v119,v126,v127
W a52,v116
M v[168:171],a[164:167],a[128:131],v[168:171]
T v[44:45],v18,49152
T v[46:47],v18,51200
M v[168:171],a[168:171],a[136:139],v[168:171]
SA s30,s32,4096
T v[48:49],v18,53248
T v[50:51],v18,55296
M v[172:175],a[168:171],a[140:143],v[172:175]
buffer_store_dwordx4 a[20:23], v6, s[8:11], s30 offen offset:1024 sc1
M v[172:175],a[164:167],a[132:135],v[172:175]
s_nop 0
T v[52:53],v18,57344
T v[54:55],v18,59392
M v[172:175],a[160:163],a[124:127],v[172:175]
T v[56:57],v18,61440
T v[58:59],v18,63488
M v[172:175],a[156:159],a[116:119],v[172:175]
W a53,v117
W a54,v118
M v[172:175],a[152:155],a[108:111],v[172:175]
W a55,v119
s_waitcnt vmcnt(9)
v_cmp_ne_u32 vcc, 1, v5
M v[172:175],a[148:151],a[100:103],v[172:175]
s_nop 0
MF v160,s5,v160
MF v161,s5,v161
M v[172:175],a[144:147],a[236:239],v[172:175]
s_waitcnt lgkmcnt(6)
MF v162,s5,v162
MF v163,s5,v163
M v[176:179],v[32:35],a[232:235],v[176:179]
s_cmp_lg_u32 vcc_hi, 0
T a[144:145],v19,28672
T a[146:147],v19,30720
M v[176:179],v[36:39],a[96:99],v[176:179]
s_cbranch_scc1 L_wsr1
L_wrr1:
MF v168,s5,v168
MF v169,s5,v169
M v[176:179],v[40:43],a[104:107],v[176:179]
s_waitcnt lgkmcnt(2)
T a[148:149],v19,40960
T a[150:151],v19,43008
M v[176:179],v[44:47],a[112:115],v[176:179]
SA m0,s28,131072
T a[152:153],v19,45056
T a[154:155],v19,47104
M v[176:179],v[48:51],a[120:123],v[176:179]
buffer_load_dwordx4 v3, s[8:11], s26 offen offset:0 sc1 lds
M v[176:179],v[52:55],a[128:131],v[176:179]
s_nop 0
T a[156:157],v19,49152
T a[158:159],v19,51200
M v[176:179],v[56:59],a[136:139],v[176:179]
T a[160:161],v19,53248
T a[162:163],v19,55296
M v[180:183],v[56:59],a[140:143],v[180:183]
buffer_load_dwordx4 v3, s[8:11], s26 offen offset:1024 sc1 lds
M v[180:183],v[52:55],a[132:135],v[180:183]
s_nop 0
T a[164:165],v19,57344
T a[166:167],v19,59392
M v[180:183],v[48:51],a[124:127],v[180:183]
T a[168:169],v19,61440
T a[170:171],v19,63488
M v[180:183],v[44:47],a[116:119],v[180:183]
buffer_load_dwordx4 v3, s[8:11], s26 offen offset:2048 sc1 lds
M v[180:183],v[40:43],a[108:111],v[180:183]
MF v170,s5,v170
MF v171,s5,v171
M v[180:183],v[36:39],a[100:103],v[180:183]
s_waitcnt lgkmcnt(0)
buffer_load_dwordx4 v3, s[8:11], s26 offen offset:3072 sc1 lds
M v[180:183],v[32:35],a[236:239],v[180:183]
s_barrier
M v[184:187],a[144:147],a[232:235],v[184:187]
SA m0,s28,135168
R a[64:67],v2,32768
R a[68:71],v2,33792
M v[184:187],a[148:151],a[96:99],v[184:187]
buffer_load_dwordx4 v4, s[8:11], s26 offen offset:0 sc1 lds
M v[184:187],a[152:155],a[104:107],v[184:187]
C v160,v160,v161
C v161,v162,v163
M v[184:187],a[156:159],a[112:115],v[184:187]
SA s30,s32,12288
R a[72:75],v2,34816
R a[76:79],v2,35840
M v[184:187],a[160:163],a[120:123],v[184:187]
buffer_store_dwordx4 a[52:55], v6, s[8:11], s30 offen offset:1024 sc1
M v[184:187],a[164:167],a[128:131],v[184:187]
C v162,v168,v169
C v163,v170,v171
M v[184:187],a[168:171],a[136:139],v[184:187]
R a[80:83],v2,36864
R a[84:87],v2,37888
M v[188:191],a[168:171],a[140:143],v[188:191]
buffer_load_dwordx4 v4, s[8:11], s26 offen offset:1024 sc1 lds
M v[188:191],a[164:167],a[132:135],v[188:191]
W a24,v160
W a25,v161
M v[188:191],a[160:163],a[124:127],v[188:191]
R a[88:91],v2,38912
R a[92:95],v2,39936
M v[188:191],a[156:159],a[116:119],v[188:191]
buffer_load_dwordx4 v4, s[8:11], s26 offen offset:2048 sc1 lds
M v[188:191],a[152:155],a[108:111],v[188:191]
W a26,v162
W a27,v163
M v[188:191],a[148:151],a[100:103],v[188:191]
buffer_load_dwordx4 v4, s[8:11], s26 offen offset:3072 sc1 lds
M v[188:191],a[144:147],a[236:239],v[188:191]
s_waitcnt lgkmcnt(0)
SA s30,s32,4096
buffer_store_dwordx4 a[24:27], v6, s[8:11], s30 offen offset:2048 sc1
SA s26,s26,32768
MF v164,s5,v164
MF v165,s5,v165
MF v166,s5,v166
MF v167,s5,v167
MF v172,s5,v172
MF v173,s5,v173
MF v174,s5,v174
MF v175,s5,v175
C v164,v164,v165
C v165,v166,v167
C v166,v172,v173
C v167,v174,v175
W a56,v164
W a57,v165
W a58,v166
W a59,v167
SA s30,s32,12288
buffer_store_dwordx4 a[56:59], v6, s[8:11], s30 offen offset:2048 sc1
v_mov_b32 v30, 2
buffer_store_dword v30, v1, s[8:11], s45 offen sc1
M v[64:67],a[64:67],a[0:3],0
R a[96:99],v2,40960
R a[100:103],v2,41984
M v[64:67],a[68:71],a[4:7],v[64:67]
MF v176,s5,v176
MF v177,s5,v177
M v[64:67],a[72:75],a[8:11],v[64:67]
MF v178,s5,v178
MF v179,s5,v179
M v[64:67],a[76:79],a[12:15],v[64:67]
R a[104:107],v2,43008
R a[108:111],v2,44032
M v[64:67],a[80:83],a[16:19],v[64:67]
MF v184,s5,v184
MF v185,s5,v185
MF v186,s5,v186
MF v187,s5,v187
C v176,v176,v177
C v177,v178,v179
C v178,v184,v185
C v179,v186,v187
W a28,v176
W a29,v177
W a30,v178
W a31,v179
M v[64:67],a[84:87],a[20:23],v[64:67]
MF v180,s5,v180
MF v181,s5,v181
M v[64:67],a[88:91],a[24:27],v[64:67]
R a[112:115],v2,45056
R a[116:119],v2,46080
M v[64:67],a[92:95],a[28:31],v[64:67]
MF v182,s5,v182
MF v183,s5,v183
M v[68:71],a[64:67],a[32:35],0
MF v188,s5,v188
MF v189,s5,v189
M v[68:71],a[68:71],a[36:39],v[68:71]
R a[120:123],v2,47104
R a[124:127],v2,48128
M v[68:71],a[72:75],a[40:43],v[68:71]
SA m0,s28,32768
MF v190,s5,v190
MF v191,s5,v191
M v[68:71],a[76:79],a[44:47],v[68:71]
buffer_load_dwordx4 v3, s[8:11], s26 offen offset:0 sc1 lds
M v[68:71],a[80:83],a[48:51],v[68:71]
C v180,v180,v181
C v181,v182,v183
C v182,v188,v189
C v183,v190,v191
W a60,v180
W a61,v181
W a62,v182
W a63,v183
M v[68:71],a[84:87],a[52:55],v[68:71]
SA s30,s32,4096
buffer_store_dwordx4 a[28:31], v6, s[8:11], s30 offen offset:3072 sc1
M v[68:71],a[88:91],a[56:59],v[68:71]
SA s30,s32,12288
E v18,v64
M v[68:71],a[92:95],a[60:63],v[68:71]
s_waitcnt lgkmcnt(0)
buffer_store_dwordx4 a[60:63], v6, s[8:11], s30 offen offset:3072 sc1
M v[72:75],a[96:99],a[0:3],0
R a[64:67],v2,49152
R a[68:71],v2,50176
M v[72:75],a[100:103],a[4:7],v[72:75]
E v19,v65
M v[72:75],a[104:107],a[8:11],v[72:75]
buffer_load_dwordx4 v3, s[8:11], s26 offen offset:1024 sc1 lds
M v[72:75],a[108:111],a[12:15],v[72:75]
R a[72:75],v2,51200
R a[76:79],v2,52224
M v[72:75],a[112:115],a[16:19],v[72:75]
E v20,v66
M v[72:75],a[116:119],a[20:23],v[72:75]
buffer_load_dwordx4 v3, s[8:11], s26 offen offset:2048 sc1 lds
M v[72:75],a[120:123],a[24:27],v[72:75]
R a[80:83],v2,53248
R a[84:87],v2,54272
M v[72:75],a[124:127],a[28:31],v[72:75]
E v21,v67
M v[76:79],a[124:127],a[60:63],0
buffer_load_dwordx4 v3, s[8:11], s26 offen offset:3072 sc1 lds
M v[76:79],a[120:123],a[56:59],v[76:79]
SA m0,s28,36864
R a[88:91],v2,55296
R a[92:95],v2,56320
M v[76:79],a[116:119],a[52:55],v[76:79]
E v22,v68
M v[76:79],a[112:115],a[48:51],v[76:79]
buffer_load_dwordx4 v4, s[8:11], s26 offen offset:0 sc1 lds
M v[76:79],a[108:111],a[44:47],v[76:79]
E v23,v69
M v[76:79],a[104:107],a[40:43],v[76:79]
AF v26,v18,v19
C v40,v18,v19
M v[76:79],a[100:103],a[36:39],v[76:79]
buffer_load_dwordx4 v4, s[8:11], s26 offen offset:1024 sc1 lds
M v[76:79],a[96:99],a[32:35],v[76:79]
s_waitcnt lgkmcnt(0)
v_add_u32 v16, 0x20000, v7
AF v26,v20,v26
M v[80:83],a[64:67],a[0:3],0
R a[96:99],v2,57344
R a[100:103],v2,58368
M v[80:83],a[68:71],a[4:7],v[80:83]
buffer_load_dwordx4 v4, s[8:11], s26 offen offset:2048 sc1 lds
M v[80:83],a[72:75],a[8:11],v[80:83]
E v24,v70
M v[80:83],a[76:79],a[12:15],v[80:83]
R a[104:107],v2,59392
R a[108:111],v2,60416
M v[80:83],a[80:83],a[16:19],v[80:83]
buffer_load_dwordx4 v4, s[8:11], s26 offen offset:3072 sc1 lds
M v[80:83],a[84:87],a[20:23],v[80:83]
SA s26,s26,32768
E v25,v71
M v[80:83],a[88:91],a[24:27],v[80:83]
R a[112:115],v2,61440
R a[116:119],v2,62464
M v[80:83],a[92:95],a[28:31],v[80:83]
E v18,v72
M v[84:87],a[92:95],a[60:63],0
E v19,v73
M v[84:87],a[88:91],a[56:59],v[84:87]
R a[120:123],v2,63488
R a[124:127],v2,64512
M v[84:87],a[84:87],a[52:55],v[84:87]
C v41,v20,v21
AF v26,v21,v26
M v[84:87],a[80:83],a[48:51],v[84:87]
E v20,v74
M v[84:87],a[76:79],a[44:47],v[84:87]
AF v27,v22,v23
C v44,v22,v23
M v[84:87],a[72:75],a[40:43],v[84:87]
AF v27,v24,v27
C v45,v24,v25
M v[84:87],a[68:71],a[36:39],v[84:87]
s_waitcnt vmcnt(24) lgkmcnt(0)
E v21,v75
M v[84:87],a[64:67],a[32:35],v[84:87]
s_barrier
M v[88:91],a[96:99],a[0:3],0
R a[64:67],v2,0
R a[68:71],v2,1024
M v[88:91],a[100:103],a[4:7],v[88:91]
E v22,v76
M v[88:91],a[104:107],a[8:11],v[88:91]
AF v27,v25,v27
AF v26,v18,v26
M v[88:91],a[108:111],a[12:15],v[88:91]
R a[72:75],v2,2048
R a[76:79],v2,3072
M v[88:91],a[112:115],a[16:19],v[88:91]
E v23,v77
M v[88:91],a[116:119],a[20:23],v[88:91]
C v42,v18,v19
AF v26,v19,v26
M v[88:91],a[120:123],a[24:27],v[88:91]
R a[80:83],v2,4096
R a[84:87],v2,5120
M v[88:91],a[124:127],a[28:31],v[88:91]
E v24,v78
M v[92:95],a[124:127],a[60:63],0
AF v26,v20,v26
C v43,v20,v21
M v[92:95],a[120:123],a[56:59],v[92:95]
R a[88:91],v2,6144
R a[92:95],v2,7168
M v[92:95],a[116:119],a[52:55],v[92:95]
E v25,v79
M v[92:95],a[112:115],a[48:51],v[92:95]
AF v26,v21,v26
AF v27,v22,v27
M v[92:95],a[108:111],a[44:47],v[92:95]
C v46,v22,v23
AF v27,v23,v27
M v[92:95],a[104:107],a[40:43],v[92:95]
AF v27,v24,v27
C v47,v24,v25
M v[92:95],a[100:103],a[36:39],v[92:95]
s_waitcnt lgkmcnt(0)
AF v27,v25,v27
M v[92:95],a[96:99],a[32:35],v[92:95]
M v[96:99],a[64:67],a[0:3],0
R a[96:99],v2,8192
R a[100:103],v2,9216
M v[96:99],a[68:71],a[4:7],v[96:99]
SA m0,s28,98304
W a128,v128
W a129,v129
M v[96:99],a[72:75],a[8:11],v[96:99]
buffer_load_dwordx4 v3, s[8:11], s21 offen offset:0 sc1 lds
M v[96:99],a[76:79],a[12:15],v[96:99]
R a[104:107],v2,10240
R a[108:111],v2,11264
M v[96:99],a[80:83],a[16:19],v[96:99]
W a130,v130
v_mov_b32 v30, 0
M v[96:99],a[84:87],a[20:23],v[96:99]
W a131,v131
M v[96:99],a[88:91],a[24:27],v[96:99]
R a[112:115],v2,12288
R a[116:119],v2,13312
M v[96:99],a[92:95],a[28:31],v[96:99]
buffer_load_dwordx4 v3, s[8:11], s21 offen offset:1024 sc1 lds
M v[100:103],a[92:95],a[60:63],0
W a132,v132
v_mov_b32 v31, 0
M v[100:103],a[88:91],a[56:59],v[100:103]
R a[120:123],v2,14336
R a[124:127],v2,15360
M v[100:103],a[84:87],a[52:55],v[100:103]
W a133,v133
W a134,v134
M v[100:103],a[80:83],a[48:51],v[100:103]
buffer_load_dwordx4 v3, s[8:11], s21 offen offset:2048 sc1 lds
M v[100:103],a[76:79],a[44:47],v[100:103]
W a135,v135
M v[100:103],a[72:75],a[40:43],v[100:103]
v_mov_b32 v32, 0
M v[100:103],a[68:71],a[36:39],v[100:103]
W a136,v136
M v[100:103],a[64:67],a[32:35],v[100:103]
s_waitcnt lgkmcnt(0)
buffer_load_dwordx4 v3, s[8:11], s21 offen offset:3072 sc1 lds
M v[108:111],a[96:99],a[32:35],0
SA m0,s28,102400
R a[64:67],v2,16384
R a[68:71],v2,17408
M v[108:111],a[100:103],a[36:39],v[108:111]
W a137,v137
v_mov_b32 v33, 0
M v[108:111],a[104:107],a[40:43],v[108:111]
W a138,v138
M v[108:111],a[108:111],a[44:47],v[108:111]
R a[72:75],v2,18432
R a[76:79],v2,19456
M v[108:111],a[112:115],a[48:51],v[108:111]
buffer_load_dwordx4 v4, s[8:11], s21 offen offset:0 sc1 lds
M v[108:111],a[116:119],a[52:55],v[108:111]
W a139,v139
W a140,v140
M v[108:111],a[120:123],a[56:59],v[108:111]
R a[80:83],v2,20480
R a[84:87],v2,21504
M v[108:111],a[124:127],a[60:63],v[108:111]
buffer_load_dwordx4 v4, s[8:11], s21 offen offset:1024 sc1 lds
M v[104:107],a[124:127],a[28:31],0
v_mov_b32 v34, 0
W a141,v141
M v[104:107],a[120:123],a[24:27],v[104:107]
R a[88:91],v2,22528
R a[92:95],v2,23552
M v[104:107],a[116:119],a[20:23],v[104:107]
buffer_load_dwordx4 v4, s[8:11], s21 offen offset:2048 sc1 lds
M v[104:107],a[112:115],a[16:19],v[104:107]
W a142,v142
W a143,v143
M v[104:107],a[108:111],a[12:15],v[104:107]
v_mov_b32 v35, 0
W a144,v144
M v[104:107],a[104:107],a[8:11],v[104:107]
W a145,v145
M v[104:107],a[100:103],a[4:7],v[104:107]
buffer_load_dwordx4 v4, s[8:11], s21 offen offset:3072 sc1 lds
M v[104:107],a[96:99],a[0:3],v[104:107]
s_waitcnt lgkmcnt(0)
v_mov_b32 v36, 0
W a146,v146
M v[112:115],a[64:67],a[0:3],0
SA s21,s21,32768
R a[96:99],v2,24576
R a[100:103],v2,25600
M v[112:115],a[68:71],a[4:7],v[112:115]
s_sub_u32 s22, s22, 1
W a147,v147
M v[112:115],a[72:75],a[8:11],v[112:115]
s_cselect_b32 s21, s23, s21
E v18,v80
M v[112:115],a[76:79],a[12:15],v[112:115]
R a[104:107],v2,26624
R a[108:111],v2,27648
M v[112:115],a[80:83],a[16:19],v[112:115]
W a148,v148
v_mov_b32 v37, 0
M v[112:115],a[84:87],a[20:23],v[112:115]
W a149,v149
M v[112:115],a[88:91],a[24:27],v[112:115]
R a[112:115],v2,28672
R a[116:119],v2,29696
M v[112:115],a[92:95],a[28:31],v[112:115]
W a150,v150
M v[116:119],a[92:95],a[60:63],0
v_mov_b32 v38, 0
W a151,v151
M v[116:119],a[88:91],a[56:59],v[116:119]
R a[120:123],v2,30720
R a[124:127],v2,31744
M v[116:119],a[84:87],a[52:55],v[116:119]
W a152,v152
M v[116:119],a[80:83],a[48:51],v[116:119]
W a153,v153
M v[116:119],a[76:79],a[44:47],v[116:119]
E v19,v81
M v[116:119],a[72:75],a[40:43],v[116:119]
v_mov_b32 v39, 0
W a154,v154
M v[116:119],a[68:71],a[36:39],v[116:119]
s_waitcnt vmcnt(21) lgkmcnt(0)
E v20,v82
M v[116:119],a[64:67],a[32:35],v[116:119]
s_barrier
M v[124:127],a[96:99],a[32:35],0
R a[64:67],v16,0
R a[68:71],v16,1024
M v[124:127],a[100:103],a[36:39],v[124:127]
W a155,v155
W a156,v156
M v[124:127],a[104:107],a[40:43],v[124:127]
W a157,v157
AF v26,v18,v26
M v[124:127],a[108:111],a[44:47],v[124:127]
R a[72:75],v16,2048
R a[76:79],v16,3072
M v[124:127],a[112:115],a[48:51],v[124:127]
W a158,v158
C v56,v18,v19
M v[124:127],a[116:119],a[52:55],v[124:127]
E v21,v83
M v[124:127],a[120:123],a[56:59],v[124:127]
R a[80:83],v16,4096
R a[84:87],v16,5120
M v[124:127],a[124:127],a[60:63],v[124:127]
W a159,v159
AF v26,v19,v26
M v[120:123],a[124:127],a[28:31],0
E v22,v88
M v[120:123],a[120:123],a[24:27],v[120:123]
R a[88:91],v16,6144
R a[92:95],v16,7168
M v[120:123],a[116:119],a[20:23],v[120:123]
E v23,v89
M v[120:123],a[112:115],a[16:19],v[120:123]
E v24,v90
M v[120:123],a[108:111],a[12:15],v[120:123]
E v25,v91
M v[120:123],a[104:107],a[8:11],v[120:123]
E v18,v84
M v[120:123],a[100:103],a[4:7],v[120:123]
s_waitcnt lgkmcnt(0)
E v19,v85
M v[120:123],a[96:99],a[0:3],v[120:123]
AF v26,v20,v26
C v57,v20,v21
AF v26,v21,v26
AF v26,v22,v26
C v58,v22,v23
AF v26,v23,v26
AF v26,v24,v26
C v59,v24,v25
AF v26,v25,v26
E v20,v86
E v21,v87
AF v27,v18,v27
C v60,v18,v19
AF v27,v19,v27
E v22,v92
E v23,v93
AF v27,v20,v27
C v61,v20,v21
AF v27,v21,v27
E v24,v94
E v25,v95
AF v27,v22,v27
C v62,v22,v23
AF v27,v23,v27
AF v27,v24,v27
C v63,v24,v25
AF v27,v25,v27
v_max_f32 v10, v26, v27
v_min_f32 v11, v26, v27
v_cmp_lt_f32 vcc, s31, v10
v_cmp_gt_f32 s[64:65], s24, v11
s_nop 0
s_or_b64 vcc, vcc, s[64:65]
s_cbranch_vccnz L_stv1
L_rtv1:
M v[128:131],a[64:67],v[40:43],0
R a[96:99],v16,8192
R a[100:103],v16,9216
M v[128:131],a[68:71],v[56:59],v[128:131]
SA m0,s28,65536
W a160,v192
W a161,v193
M v[132:135],a[68:71],v[60:63],0
buffer_load_dwordx4 v3, s[8:11], s21 offen offset:0 sc1 lds
M v[132:135],a[64:67],v[44:47],v[132:135]
R a[104:107],v16,10240
R a[108:111],v16,11264
M v[140:143],a[72:75],v[44:47],0
W a162,v194
W a163,v195
M v[140:143],a[76:79],v[60:63],v[140:143]
W a164,v196
W a165,v197
M v[136:139],a[76:79],v[56:59],0
R a[112:115],v16,12288
R a[116:119],v16,13312
M v[136:139],a[72:75],v[40:43],v[136:139]
buffer_load_dwordx4 v3, s[8:11], s21 offen offset:1024 sc1 lds
M v[144:147],a[80:83],v[40:43],0
W a166,v198
W a167,v199
M v[144:147],a[84:87],v[56:59],v[144:147]
R a[120:123],v16,14336
R a[124:127],v16,15360
M v[148:151],a[84:87],v[60:63],0
SA s3,s93,262144
W a168,v200
W a169,v201
M v[148:151],a[80:83],v[44:47],v[148:151]
buffer_load_dwordx4 v3, s[8:11], s21 offen offset:2048 sc1 lds
M v[156:159],a[88:91],v[44:47],0
W a170,v202
W a171,v203
M v[156:159],a[92:95],v[60:63],v[156:159]
W a172,v204
W a173,v205
M v[152:155],a[92:95],v[56:59],0
buffer_store_dwordx4 a[128:131], v7, s[8:11], s3 offen offset:0 sc1
M v[152:155],a[88:91],v[40:43],v[152:155]
s_waitcnt lgkmcnt(0)
W a174,v206
W a175,v207
M v[160:163],a[96:99],v[40:43],0
R a[64:67],v16,16384
R a[68:71],v16,17408
M v[160:163],a[100:103],v[56:59],v[160:163]
buffer_load_dwordx4 v3, s[8:11], s21 offen offset:3072 sc1 lds
M v[164:167],a[100:103],v[60:63],0
SA m0,s28,69632
W a176,v208
W a177,v209
M v[164:167],a[96:99],v[44:47],v[164:167]
R a[72:75],v16,18432
R a[76:79],v16,19456
M v[172:175],a[104:107],v[44:47],0
buffer_load_dwordx4 v4, s[8:11], s21 offen offset:0 sc1 lds
M v[172:175],a[108:111],v[60:63],v[172:175]
W a178,v210
W a179,v211
M v[168:171],a[108:111],v[56:59],0
R a[80:83],v16,20480
R a[84:87],v16,21504
M v[168:171],a[104:107],v[40:43],v[168:171]
buffer_load_dwordx4 v4, s[8:11], s21 offen offset:1024 sc1 lds
M v[176:179],a[112:115],v[40:43],0
W a180,v212
W a181,v213
M v[176:179],a[116:119],v[56:59],v[176:179]
R a[88:91],v16,22528
R a[92:95],v16,23552
M v[180:183],a[116:119],v[60:63],0
buffer_load_dwordx4 v4, s[8:11], s21 offen offset:2048 sc1 lds
M v[180:183],a[112:115],v[44:47],v[180:183]
W a182,v214
W a183,v215
M v[188:191],a[120:123],v[44:47],0
W a184,v216
W a185,v217
W a186,v218
W a187,v219
W a188,v220
W a189,v221
W a190,v222
W a191,v223
M v[188:191],a[124:127],v[60:63],v[188:191]
E v18,v96
M v[184:187],a[124:127],v[56:59],0
buffer_load_dwordx4 v4, s[8:11], s21 offen offset:3072 sc1 lds
M v[184:187],a[120:123],v[40:43],v[184:187]
s_waitcnt lgkmcnt(0)
v_min_u32 v17, 1, v7
v_lshlrev_b32 v17, 29, v17
M v[192:195],a[64:67],v[40:43],0
SA s21,s21,32768
R a[96:99],v16,24576
R a[100:103],v16,25600
M v[192:195],a[68:71],v[56:59],v[192:195]
s_sub_u32 s22, s22, 1
buffer_store_dwordx4 a[132:135], v7, s[8:11], s3 offen offset:2048 sc1
M v[196:199],a[68:71],v[60:63],0
s_cselect_b32 s21, s23, s21
v_mov_b32 v15, 1
AF v30,v26,v30
M v[196:199],a[64:67],v[44:47],v[196:199]
SA s84,s47,16
R a[104:107],v16,26624
R a[108:111],v16,27648
M v[204:207],a[72:75],v[44:47],0
E v19,v97
M v[204:207],a[76:79],v[60:63],v[204:207]
E v20,v98
M v[200:203],a[76:79],v[56:59],0
R a[112:115],v16,28672
R a[116:119],v16,29696
M v[200:203],a[72:75],v[40:43],v[200:203]
E v21,v99
M v[208:211],a[80:83],v[40:43],0
E v22,v104
M v[208:211],a[84:87],v[56:59],v[208:211]
R a[120:123],v16,30720
R a[124:127],v16,31744
M v[212:215],a[84:87],v[60:63],0
SA s3,s93,266240
E v23,v105
M v[212:215],a[80:83],v[44:47],v[212:215]
buffer_store_dwordx4 a[136:139], v7, s[8:11], s3 offen offset:0 sc1
M v[220:223],a[88:91],v[44:47],0
AF v31,v27,v31
AF v28,v18,v19
M v[220:223],a[92:95],v[60:63],v[220:223]
E v24,v106
M v[216:219],a[92:95],v[56:59],0
s_waitcnt vmcnt(11) lgkmcnt(0)
E v25,v107
M v[216:219],a[88:91],v[40:43],v[216:219]
s_barrier
M v[224:227],a[96:99],v[40:43],0
R a[64:67],v2,32768
R a[68:71],v2,33792
M v[224:227],a[100:103],v[56:59],v[224:227]
buffer_store_dword v15, v17, s[8:11], s84 offen sc1
M v[228:231],a[100:103],v[60:63],0
C v48,v18,v19
AF v28,v20,v28
M v[228:231],a[96:99],v[44:47],v[228:231]
R a[72:75],v2,34816
R a[76:79],v2,35840
M v[236:239],a[104:107],v[44:47],0
E v18,v100
M v[236:239],a[108:111],v[60:63],v[236:239]
E v19,v101
M v[232:235],a[108:111],v[56:59],0
R a[80:83],v2,36864
R a[84:87],v2,37888
M v[232:235],a[104:107],v[40:43],v[232:235]
C v49,v20,v21
AF v28,v21,v28
M v[240:243],a[112:115],v[40:43],0
E v20,v102
M v[240:243],a[116:119],v[56:59],v[240:243]
R a[88:91],v2,38912
R a[92:95],v2,39936
M v[244:247],a[116:119],v[60:63],0
E v21,v103
M v[244:247],a[112:115],v[44:47],v[244:247]
AF v28,v22,v28
C v50,v22,v23
M v[252:255],a[120:123],v[44:47],0
AF v28,v23,v28
AF v28,v24,v28
M v[252:255],a[124:127],v[60:63],v[252:255]
E v22,v108
M v[248:251],a[124:127],v[56:59],0
s_waitcnt lgkmcnt(0)
E v23,v109
M v[248:251],a[120:123],v[40:43],v[248:251]
C v51,v24,v25
AF v28,v25,v28
AF v29,v18,v19
C v52,v18,v19
AF v29,v20,v29
C v53,v20,v21
AF v29,v21,v29
E v24,v110
E v25,v111
AF v29,v22,v29
C v54,v22,v23
AF v29,v23,v29
AF v29,v24,v29
C v55,v24,v25
AF v29,v25,v29
M v[64:67],a[64:67],a[0:3],v[32:35]
R a[96:99],v2,40960
R a[100:103],v2,41984
M v[64:67],a[68:71],a[4:7],v[64:67]
SA m0,s28,0
E v18,v112
M v[64:67],a[72:75],a[8:11],v[64:67]
buffer_load_dwordx4 v3, s[8:11], s26 offen offset:0 sc1 lds
M v[64:67],a[76:79],a[12:15],v[64:67]
R a[104:107],v2,43008
R a[108:111],v2,44032
M v[64:67],a[80:83],a[16:19],v[64:67]
E v19,v113
M v[64:67],a[84:87],a[20:23],v[64:67]
AF v28,v18,v28
C v56,v18,v19
M v[64:67],a[88:91],a[24:27],v[64:67]
R a[112:115],v2,45056
R a[116:119],v2,46080
M v[64:67],a[92:95],a[28:31],v[64:67]
buffer_load_dwordx4 v3, s[8:11], s26 offen offset:1024 sc1 lds
M v[68:71],a[92:95],a[60:63],v[36:39]
E v20,v114
M v[68:71],a[88:91],a[56:59],v[68:71]
R a[120:123],v2,47104
R a[124:127],v2,48128
M v[68:71],a[84:87],a[52:55],v[68:71]
SA s3,s93,266240
E v21,v115
M v[68:71],a[80:83],a[48:51],v[68:71]
buffer_load_dwordx4 v3, s[8:11], s26 offen offset:2048 sc1 lds
M v[68:71],a[76:79],a[44:47],v[68:71]
AF v28,v19,v28
AF v28,v20,v28
M v[68:71],a[72:75],a[40:43],v[68:71]
C v57,v20,v21
AF v28,v21,v28
M v[68:71],a[68:71],a[36:39],v[68:71]
buffer_store_dwordx4 a[140:143], v7, s[8:11], s3 offen offset:2048 sc1
M v[68:71],a[64:67],a[32:35],v[68:71]
s_waitcnt lgkmcnt(0)
E v22,v120
M v[76:79],a[96:99],a[32:35],v[36:39]
R a[64:67],v2,49152
R a[68:71],v2,50176
M v[76:79],a[100:103],a[36:39],v[76:79]
buffer_load_dwordx4 v3, s[8:11], s26 offen offset:3072 sc1 lds
M v[76:79],a[104:107],a[40:43],v[76:79]
SA m0,s28,4096
E v23,v121
M v[76:79],a[108:111],a[44:47],v[76:79]
R a[72:75],v2,51200
R a[76:79],v2,52224
M v[76:79],a[112:115],a[48:51],v[76:79]
buffer_load_dwordx4 v4, s[8:11], s26 offen offset:0 sc1 lds
M v[76:79],a[116:119],a[52:55],v[76:79]
E v24,v122
M v[76:79],a[120:123],a[56:59],v[76:79]
R a[80:83],v2,53248
R a[84:87],v2,54272
M v[76:79],a[124:127],a[60:63],v[76:79]
buffer_load_dwordx4 v4, s[8:11], s26 offen offset:1024 sc1 lds
M v[72:75],a[124:127],a[28:31],v[32:35]
E v25,v123
M v[72:75],a[120:123],a[24:27],v[72:75]
SA s3,s93,270336
R a[88:91],v2,55296
R a[92:95],v2,56320
M v[72:75],a[116:119],a[20:23],v[72:75]
buffer_load_dwordx4 v4, s[8:11], s26 offen offset:2048 sc1 lds
M v[72:75],a[112:115],a[16:19],v[72:75]
AF v28,v22,v28
C v58,v22,v23
M v[72:75],a[108:111],a[12:15],v[72:75]
E v18,v116
M v[72:75],a[104:107],a[8:11],v[72:75]
AF v28,v23,v28
AF v28,v24,v28
M v[72:75],a[100:103],a[4:7],v[72:75]
buffer_load_dwordx4 v4, s[8:11], s26 offen offset:3072 sc1 lds
M v[72:75],a[96:99],a[0:3],v[72:75]
s_waitcnt lgkmcnt(0)
E v19,v117
M v[80:83],a[64:67],a[0:3],v[32:35]
SA s26,s26,32768
R a[96:99],v2,57344
R a[100:103],v2,58368
M v[80:83],a[68:71],a[4:7],v[80:83]
buffer_store_dwordx4 a[144:147], v7, s[8:11], s3 offen offset:0 sc1
M v[80:83],a[72:75],a[8:11],v[80:83]
C v59,v24,v25
AF v28,v25,v28
M v[80:83],a[76:79],a[12:15],v[80:83]
R a[104:107],v2,59392
R a[108:111],v2,60416
M v[80:83],a[80:83],a[16:19],v[80:83]
E v20,v118
M v[80:83],a[84:87],a[20:23],v[80:83]
AF v29,v18,v29
C v60,v18,v19
M v[80:83],a[88:91],a[24:27],v[80:83]
R a[112:115],v2,61440
R a[116:119],v2,62464
M v[80:83],a[92:95],a[28:31],v[80:83]
E v21,v119
M v[84:87],a[92:95],a[60:63],v[36:39]
AF v29,v19,v29
AF v29,v20,v29
M v[84:87],a[88:91],a[56:59],v[84:87]
R a[120:123],v2,63488
R a[124:127],v2,64512
M v[84:87],a[84:87],a[52:55],v[84:87]
E v22,v124
M v[84:87],a[80:83],a[48:51],v[84:87]
buffer_store_dwordx4 a[148:151], v7, s[8:11], s3 offen offset:2048 sc1
M v[84:87],a[76:79],a[44:47],v[84:87]
C v61,v20,v21
AF v29,v21,v29
M v[84:87],a[72:75],a[40:43],v[84:87]
E v23,v125
M v[84:87],a[68:71],a[36:39],v[84:87]
s_waitcnt lgkmcnt(0)
AF v29,v22,v29
C v62,v22,v23
M v[84:87],a[64:67],a[32:35],v[84:87]
s_barrier
M v[92:95],a[96:99],a[32:35],v[36:39]
R a[64:67],v7,32768
R a[68:71],v7,33792
M v[92:95],a[100:103],a[36:39],v[92:95]
E v24,v126
M v[92:95],a[104:107],a[40:43],v[92:95]
AF v29,v23,v29
M v[92:95],a[108:111],a[44:47],v[92:95]
R a[72:75],v7,34816
R a[76:79],v7,35840
M v[92:95],a[112:115],a[48:51],v[92:95]
E v25,v127
M v[92:95],a[116:119],a[52:55],v[92:95]
AF v29,v24,v29
C v63,v24,v25
M v[92:95],a[120:123],a[56:59],v[92:95]
R a[80:83],v7,36864
R a[84:87],v7,37888
M v[92:95],a[124:127],a[60:63],v[92:95]
AF v29,v25,v29
M v[88:91],a[124:127],a[28:31],v[32:35]
M v[88:91],a[120:123],a[24:27],v[88:91]
R a[88:91],v7,38912
R a[92:95],v7,39936
M v[88:91],a[116:119],a[20:23],v[88:91]
v_max_f32 v10, v28, v29
M v[88:91],a[112:115],a[16:19],v[88:91]
v_cmp_lt_f32 vcc, s31, v10
M v[88:91],a[108:111],a[12:15],v[88:91]
M v[88:91],a[104:107],a[8:11],v[88:91]
M v[88:91],a[100:103],a[4:7],v[88:91]
s_waitcnt lgkmcnt(0)
M v[88:91],a[96:99],a[0:3],v[88:91]
s_cbranch_vccnz L_stv2
L_rtv2:
M v[128:131],a[64:67],v[48:51],v[128:131]
R a[96:99],v7,40960
R a[100:103],v7,41984
M v[128:131],a[68:71],v[56:59],v[128:131]
SA m0,s28,98304
E v18,v64
M v[132:135],a[68:71],v[60:63],v[132:135]
buffer_load_dwordx4 v3, s[8:11], s21 offen offset:0 sc1 lds
M v[132:135],a[64:67],v[52:55],v[132:135]
R a[104:107],v7,43008
R a[108:111],v7,44032
M v[140:143],a[72:75],v[52:55],v[140:143]
E v19,v65
M v[140:143],a[76:79],v[60:63],v[140:143]
AF v30,v28,v30
AF v31,v29,v31
M v[136:139],a[76:79],v[56:59],v[136:139]
R a[112:115],v7,45056
R a[116:119],v7,46080
M v[136:139],a[72:75],v[48:51],v[136:139]
buffer_load_dwordx4 v3, s[8:11], s21 offen offset:1024 sc1 lds
M v[144:147],a[80:83],v[48:51],v[144:147]
E v20,v66
M v[144:147],a[84:87],v[56:59],v[144:147]
R a[120:123],v7,47104
R a[124:127],v7,48128
M v[148:151],a[84:87],v[60:63],v[148:151]
SA s3,s93,274432
AF v26,v18,v19
C v40,v18,v19
M v[148:151],a[80:83],v[52:55],v[148:151]
buffer_load_dwordx4 v3, s[8:11], s21 offen offset:2048 sc1 lds
M v[156:159],a[88:91],v[52:55],v[156:159]
E v21,v67
M v[156:159],a[92:95],v[60:63],v[156:159]
AF v26,v20,v26
C v41,v20,v21
M v[152:155],a[92:95],v[56:59],v[152:155]
buffer_store_dwordx4 a[152:155], v7, s[8:11], s3 offen offset:0 sc1
M v[152:155],a[88:91],v[48:51],v[152:155]
s_waitcnt lgkmcnt(0)
E v22,v72
M v[160:163],a[96:99],v[48:51],v[160:163]
R a[64:67],v7,49152
R a[68:71],v7,50176
M v[160:163],a[100:103],v[56:59],v[160:163]
buffer_load_dwordx4 v3, s[8:11], s21 offen offset:3072 sc1 lds
M v[164:167],a[100:103],v[60:63],v[164:167]
SA m0,s28,102400
E v23,v73
M v[164:167],a[96:99],v[52:55],v[164:167]
R a[72:75],v7,51200
R a[76:79],v7,52224
M v[172:175],a[104:107],v[52:55],v[172:175]
buffer_load_dwordx4 v4, s[8:11], s21 offen offset:0 sc1 lds
M v[172:175],a[108:111],v[60:63],v[172:175]
AF v26,v21,v26
AF v26,v22,v26
M v[168:171],a[108:111],v[56:59],v[168:171]
R a[80:83],v7,53248
R a[84:87],v7,54272
M v[168:171],a[104:107],v[48:51],v[168:171]
buffer_load_dwordx4 v4, s[8:11], s21 offen offset:1024 sc1 lds
M v[176:179],a[112:115],v[48:51],v[176:179]
E v24,v74
M v[176:179],a[116:119],v[56:59],v[176:179]
R a[88:91],v7,55296
R a[92:95],v7,56320
M v[180:183],a[116:119],v[60:63],v[180:183]
buffer_load_dwordx4 v4, s[8:11], s21 offen offset:2048 sc1 lds
M v[180:183],a[112:115],v[52:55],v[180:183]
E v25,v75
M v[188:191],a[120:123],v[52:55],v[188:191]
C v42,v22,v23
AF v26,v23,v26
M v[188:191],a[124:127],v[60:63],v[188:191]
AF v26,v24,v26
C v43,v24,v25
M v[184:187],a[124:127],v[56:59],v[184:187]
buffer_load_dwordx4 v4, s[8:11], s21 offen offset:3072 sc1 lds
M v[184:187],a[120:123],v[48:51],v[184:187]
s_waitcnt lgkmcnt(0)
E v18,v68
M v[192:195],a[64:67],v[48:51],v[192:195]
SA s21,s21,32768
R a[96:99],v7,57344
R a[100:103],v7,58368
M v[192:195],a[68:71],v[56:59],v[192:195]
s_sub_u32 s22, s22, 1
buffer_store_dwordx4 a[156:159], v7, s[8:11], s3 offen offset:2048 sc1
M v[196:199],a[68:71],v[60:63],v[196:199]
s_cselect_b32 s21, s23, s21
E v19,v69
M v[196:199],a[64:67],v[52:55],v[196:199]
R a[104:107],v7,59392
R a[108:111],v7,60416
M v[204:207],a[72:75],v[52:55],v[204:207]
AF v26,v25,v26
AF v27,v18,v19
M v[204:207],a[76:79],v[60:63],v[204:207]
E v20,v70
M v[200:203],a[76:79],v[56:59],v[200:203]
R a[112:115],v7,61440
R a[116:119],v7,62464
M v[200:203],a[72:75],v[48:51],v[200:203]
C v44,v18,v19
M v[208:211],a[80:83],v[48:51],v[208:211]
M v[208:211],a[84:87],v[56:59],v[208:211]
R a[120:123],v7,63488
R a[124:127],v7,64512
M v[212:215],a[84:87],v[60:63],v[212:215]
SA s3,s93,786432
E v21,v71
M v[212:215],a[80:83],v[52:55],v[212:215]
buffer_store_dwordx4 a[160:163], v7, s[8:11], s3 offen offset:0 sc1
M v[220:223],a[88:91],v[52:55],v[220:223]
AF v27,v20,v27
C v45,v20,v21
M v[220:223],a[92:95],v[60:63],v[220:223]
E v22,v76
M v[216:219],a[92:95],v[56:59],v[216:219]
s_waitcnt vmcnt(25) lgkmcnt(0)
AF v27,v21,v27
M v[216:219],a[88:91],v[48:51],v[216:219]
s_barrier
M v[224:227],a[96:99],v[48:51],v[224:227]
R a[64:67],v2,0
R a[68:71],v2,1024
M v[224:227],a[100:103],v[56:59],v[224:227]
E v23,v77
M v[228:231],a[100:103],v[60:63],v[228:231]
AF v27,v22,v27
C v46,v22,v23
M v[228:231],a[96:99],v[52:55],v[228:231]
R a[72:75],v2,2048
R a[76:79],v2,3072
M v[236:239],a[104:107],v[52:55],v[236:239]
E v24,v78
M v[236:239],a[108:111],v[60:63],v[236:239]
AF v27,v23,v27
M v[232:235],a[108:111],v[56:59],v[232:235]
R a[80:83],v2,4096
R a[84:87],v2,5120
M v[232:235],a[104:107],v[48:51],v[232:235]
M v[240:243],a[112:115],v[48:51],v[240:243]
E v25,v79
M v[240:243],a[116:119],v[56:59],v[240:243]
R a[88:91],v2,6144
R a[92:95],v2,7168
M v[244:247],a[116:119],v[60:63],v[244:247]
AF v27,v24,v27
C v47,v24,v25
M v[244:247],a[112:115],v[52:55],v[244:247]
AF v27,v25,v27
M v[252:255],a[120:123],v[52:55],v[252:255]
M v[252:255],a[124:127],v[60:63],v[252:255]
M v[248:251],a[124:127],v[56:59],v[248:251]
s_waitcnt lgkmcnt(0)
M v[248:251],a[120:123],v[48:51],v[248:251]
M v[96:99],a[64:67],a[0:3],v[32:35]
R a[96:99],v2,8192
R a[100:103],v2,9216
M v[96:99],a[68:71],a[4:7],v[96:99]
SA m0,s28,32768
E v18,v80
M v[96:99],a[72:75],a[8:11],v[96:99]
buffer_load_dwordx4 v3, s[8:11], s26 offen offset:0 sc1 lds
M v[96:99],a[76:79],a[12:15],v[96:99]
R a[104:107],v2,10240
R a[108:111],v2,11264
M v[96:99],a[80:83],a[16:19],v[96:99]
E v19,v81
M v[96:99],a[84:87],a[20:23],v[96:99]
AF v26,v18,v26
C v56,v18,v19
M v[96:99],a[88:91],a[24:27],v[96:99]
R a[112:115],v2,12288
R a[116:119],v2,13312
M v[96:99],a[92:95],a[28:31],v[96:99]
buffer_load_dwordx4 v3, s[8:11], s26 offen offset:1024 sc1 lds
M v[100:103],a[92:95],a[60:63],v[36:39]
E v20,v82
M v[100:103],a[88:91],a[56:59],v[100:103]
R a[120:123],v2,14336
R a[124:127],v2,15360
M v[100:103],a[84:87],a[52:55],v[100:103]
SA s3,s93,786432
E v21,v83
M v[100:103],a[80:83],a[48:51],v[100:103]
buffer_load_dwordx4 v3, s[8:11], s26 offen offset:2048 sc1 lds
M v[100:103],a[76:79],a[44:47],v[100:103]
AF v26,v19,v26
AF v26,v20,v26
M v[100:103],a[72:75],a[40:43],v[100:103]
C v57,v20,v21
AF v26,v21,v26
M v[100:103],a[68:71],a[36:39],v[100:103]
buffer_store_dwordx4 a[164:167], v7, s[8:11], s3 offen offset:2048 sc1
M v[100:103],a[64:67],a[32:35],v[100:103]
s_waitcnt lgkmcnt(0)
E v22,v88
M v[108:111],a[96:99],a[32:35],v[36:39]
R a[64:67],v2,16384
R a[68:71],v2,17408
M v[108:111],a[100:103],a[36:39],v[108:111]
buffer_load_dwordx4 v3, s[8:11], s26 offen offset:3072 sc1 lds
M v[108:111],a[104:107],a[40:43],v[108:111]
SA m0,s28,36864
E v23,v89
M v[108:111],a[108:111],a[44:47],v[108:111]
R a[72:75],v2,18432
R a[76:79],v2,19456
M v[108:111],a[112:115],a[48:51],v[108:111]
buffer_load_dwordx4 v4, s[8:11], s26 offen offset:0 sc1 lds
M v[108:111],a[116:119],a[52:55],v[108:111]
SA s3,s93,790528
E v24,v90
M v[108:111],a[120:123],a[56:59],v[108:111]
R a[80:83],v2,20480
R a[84:87],v2,21504
M v[108:111],a[124:127],a[60:63],v[108:111]
buffer_load_dwordx4 v4, s[8:11], s26 offen offset:1024 sc1 lds
M v[104:107],a[124:127],a[28:31],v[32:35]
E v25,v91
M v[104:107],a[120:123],a[24:27],v[104:107]
R a[88:91],v2,22528
R a[92:95],v2,23552
M v[104:107],a[116:119],a[20:23],v[104:107]
buffer_load_dwordx4 v4, s[8:11], s26 offen offset:2048 sc1 lds
M v[104:107],a[112:115],a[16:19],v[104:107]
AF v26,v22,v26
C v58,v22,v23
M v[104:107],a[108:111],a[12:15],v[104:107]
E v18,v84
M v[104:107],a[104:107],a[8:11],v[104:107]
buffer_store_dwordx4 a[168:171], v7, s[8:11], s3 offen offset:0 sc1
M v[104:107],a[100:103],a[4:7],v[104:107]
AF v26,v23,v26
AF v26,v24,v26
M v[104:107],a[96:99],a[0:3],v[104:107]
s_waitcnt lgkmcnt(0)
E v19,v85
M v[112:115],a[64:67],a[0:3],v[32:35]
R a[96:99],v2,24576
R a[100:103],v2,25600
M v[112:115],a[68:71],a[4:7],v[112:115]
buffer_load_dwordx4 v4, s[8:11], s26 offen offset:3072 sc1 lds
M v[112:115],a[72:75],a[8:11],v[112:115]
SA s26,s26,32768
C v59,v24,v25
AF v26,v25,v26
M v[112:115],a[76:79],a[12:15],v[112:115]
R a[104:107],v2,26624
R a[108:111],v2,27648
M v[112:115],a[80:83],a[16:19],v[112:115]
E v20,v86
M v[112:115],a[84:87],a[20:23],v[112:115]
buffer_store_dwordx4 a[172:175], v7, s[8:11], s3 offen offset:2048 sc1
M v[112:115],a[88:91],a[24:27],v[112:115]
R a[112:115],v2,28672
R a[116:119],v2,29696
M v[112:115],a[92:95],a[28:31],v[112:115]
E v21,v87
M v[116:119],a[92:95],a[60:63],v[36:39]
AF v27,v18,v27
C v60,v18,v19
M v[116:119],a[88:91],a[56:59],v[116:119]
R a[120:123],v2,30720
R a[124:127],v2,31744
M v[116:119],a[84:87],a[52:55],v[116:119]
E v22,v92
M v[116:119],a[80:83],a[48:51],v[116:119]
AF v27,v19,v27
AF v27,v20,v27
M v[116:119],a[76:79],a[44:47],v[116:119]
C v61,v20,v21
AF v27,v21,v27
M v[116:119],a[72:75],a[40:43],v[116:119]
E v23,v93
M v[116:119],a[68:71],a[36:39],v[116:119]
s_waitcnt vmcnt(24) lgkmcnt(0)
AF v27,v22,v27
C v62,v22,v23
M v[116:119],a[64:67],a[32:35],v[116:119]
s_barrier
M v[124:127],a[96:99],a[32:35],v[36:39]
SA s3,s93,794624
R a[64:67],v7,0
R a[68:71],v7,1024
M v[124:127],a[100:103],a[36:39],v[124:127]
buffer_store_dwordx4 a[176:179], v7, s[8:11], s3 offen offset:0 sc1
M v[124:127],a[104:107],a[40:43],v[124:127]
E v24,v94
M v[124:127],a[108:111],a[44:47],v[124:127]
R a[72:75],v7,2048
R a[76:79],v7,3072
M v[124:127],a[112:115],a[48:51],v[124:127]
E v25,v95
M v[124:127],a[116:119],a[52:55],v[124:127]
AF v27,v23,v27
AF v27,v24,v27
M v[124:127],a[120:123],a[56:59],v[124:127]
R a[80:83],v7,4096
R a[84:87],v7,5120
M v[124:127],a[124:127],a[60:63],v[124:127]
C v63,v24,v25
AF v27,v25,v27
M v[120:123],a[124:127],a[28:31],v[32:35]
M v[120:123],a[120:123],a[24:27],v[120:123]
R a[88:91],v7,6144
R a[92:95],v7,7168
M v[120:123],a[116:119],a[20:23],v[120:123]
v_max_f32 v10, v26, v27
M v[120:123],a[112:115],a[16:19],v[120:123]
v_cmp_lt_f32 vcc, s31, v10
M v[120:123],a[108:111],a[12:15],v[120:123]
M v[120:123],a[104:107],a[8:11],v[120:123]
M v[120:123],a[100:103],a[4:7],v[120:123]
s_waitcnt lgkmcnt(0)
M v[120:123],a[96:99],a[0:3],v[120:123]
s_cbranch_vccnz L_stv3
L_rtv3:
M v[128:131],a[64:67],v[40:43],v[128:131]
R a[96:99],v7,8192
R a[100:103],v7,9216
M v[128:131],a[68:71],v[56:59],v[128:131]
SA m0,s28,65536
E v18,v96
M v[132:135],a[68:71],v[60:63],v[132:135]
buffer_load_dwordx4 v3, s[8:11], s21 offen offset:0 sc1 lds
M v[132:135],a[64:67],v[44:47],v[132:135]
R a[104:107],v7,10240
R a[108:111],v7,11264
M v[140:143],a[72:75],v[44:47],v[140:143]
E v19,v97
M v[140:143],a[76:79],v[60:63],v[140:143]
AF v30,v26,v30
AF v31,v27,v31
M v[136:139],a[76:79],v[56:59],v[136:139]
R a[112:115],v7,12288
R a[116:119],v7,13312
M v[136:139],a[72:75],v[40:43],v[136:139]
buffer_load_dwordx4 v3, s[8:11], s21 offen offset:1024 sc1 lds
M v[144:147],a[80:83],v[40:43],v[144:147]
E v20,v98
M v[144:147],a[84:87],v[56:59],v[144:147]
R a[120:123],v7,14336
R a[124:127],v7,15360
M v[148:151],a[84:87],v[60:63],v[148:151]
SA s3,s93,794624
AF v28,v18,v19
C v48,v18,v19
M v[148:151],a[80:83],v[44:47],v[148:151]
buffer_load_dwordx4 v3, s[8:11], s21 offen offset:2048 sc1 lds
M v[156:159],a[88:91],v[44:47],v[156:159]
E v21,v99
M v[156:159],a[92:95],v[60:63],v[156:159]
AF v28,v20,v28
C v49,v20,v21
M v[152:155],a[92:95],v[56:59],v[152:155]
buffer_store_dwordx4 a[180:183], v7, s[8:11], s3 offen offset:2048 sc1
M v[152:155],a[88:91],v[40:43],v[152:155]
s_waitcnt lgkmcnt(0)
E v22,v104
M v[160:163],a[96:99],v[40:43],v[160:163]
R a[64:67],v7,16384
R a[68:71],v7,17408
M v[160:163],a[100:103],v[56:59],v[160:163]
buffer_load_dwordx4 v3, s[8:11], s21 offen offset:3072 sc1 lds
M v[164:167],a[100:103],v[60:63],v[164:167]
SA m0,s28,69632
E v23,v105
M v[164:167],a[96:99],v[44:47],v[164:167]
R a[72:75],v7,18432
R a[76:79],v7,19456
M v[172:175],a[104:107],v[44:47],v[172:175]
buffer_load_dwordx4 v4, s[8:11], s21 offen offset:0 sc1 lds
M v[172:175],a[108:111],v[60:63],v[172:175]
AF v28,v21,v28
AF v28,v22,v28
M v[168:171],a[108:111],v[56:59],v[168:171]
R a[80:83],v7,20480
R a[84:87],v7,21504
M v[168:171],a[104:107],v[40:43],v[168:171]
buffer_load_dwordx4 v4, s[8:11], s21 offen offset:1024 sc1 lds
M v[176:179],a[112:115],v[40:43],v[176:179]
E v24,v106
M v[176:179],a[116:119],v[56:59],v[176:179]
SA s3,s93,798720
R a[88:91],v7,22528
R a[92:95],v7,23552
M v[180:183],a[116:119],v[60:63],v[180:183]
buffer_load_dwordx4 v4, s[8:11], s21 offen offset:2048 sc1 lds
M v[180:183],a[112:115],v[44:47],v[180:183]
E v25,v107
M v[188:191],a[120:123],v[44:47],v[188:191]
C v50,v22,v23
AF v28,v23,v28
M v[188:191],a[124:127],v[60:63],v[188:191]
AF v28,v24,v28
C v51,v24,v25
M v[184:187],a[124:127],v[56:59],v[184:187]
buffer_load_dwordx4 v4, s[8:11], s21 offen offset:3072 sc1 lds
M v[184:187],a[120:123],v[40:43],v[184:187]
s_waitcnt lgkmcnt(0)
E v18,v100
M v[192:195],a[64:67],v[40:43],v[192:195]
SA s21,s21,32768
R a[96:99],v7,24576
R a[100:103],v7,25600
M v[192:195],a[68:71],v[56:59],v[192:195]
s_sub_u32 s22, s22, 1
buffer_store_dwordx4 a[184:187], v7, s[8:11], s3 offen offset:0 sc1
M v[196:199],a[68:71],v[60:63],v[196:199]
s_cselect_b32 s21, s23, s21
E v19,v101
M v[196:199],a[64:67],v[44:47],v[196:199]
R a[104:107],v7,26624
R a[108:111],v7,27648
M v[204:207],a[72:75],v[44:47],v[204:207]
AF v28,v25,v28
AF v29,v18,v19
M v[204:207],a[76:79],v[60:63],v[204:207]
E v20,v102
M v[200:203],a[76:79],v[56:59],v[200:203]
R a[112:115],v7,28672
R a[116:119],v7,29696
M v[200:203],a[72:75],v[40:43],v[200:203]
C v52,v18,v19
M v[208:211],a[80:83],v[40:43],v[208:211]
M v[208:211],a[84:87],v[56:59],v[208:211]
R a[120:123],v7,30720
R a[124:127],v7,31744
M v[212:215],a[84:87],v[60:63],v[212:215]
E v21,v103
M v[212:215],a[80:83],v[44:47],v[212:215]
buffer_store_dwordx4 a[188:191], v7, s[8:11], s3 offen offset:2048 sc1
M v[220:223],a[88:91],v[44:47],v[220:223]
AF v29,v20,v29
C v53,v20,v21
M v[220:223],a[92:95],v[60:63],v[220:223]
E v22,v108
M v[216:219],a[92:95],v[56:59],v[216:219]
s_waitcnt vmcnt(25) lgkmcnt(0)
AF v29,v21,v29
M v[216:219],a[88:91],v[40:43],v[216:219]
s_barrier
M v[224:227],a[96:99],v[40:43],v[224:227]
R a[64:67],v2,32768
R a[68:71],v2,33792
M v[224:227],a[100:103],v[56:59],v[224:227]
E v23,v109
M v[228:231],a[100:103],v[60:63],v[228:231]
AF v29,v22,v29
C v54,v22,v23
M v[228:231],a[96:99],v[44:47],v[228:231]
R a[72:75],v2,34816
R a[76:79],v2,35840
M v[236:239],a[104:107],v[44:47],v[236:239]
E v24,v110
M v[236:239],a[108:111],v[60:63],v[236:239]
AF v29,v23,v29
M v[232:235],a[108:111],v[56:59],v[232:235]
R a[80:83],v2,36864
R a[84:87],v2,37888
M v[232:235],a[104:107],v[40:43],v[232:235]
M v[240:243],a[112:115],v[40:43],v[240:243]
E v25,v111
M v[240:243],a[116:119],v[56:59],v[240:243]
R a[88:91],v2,38912
R a[92:95],v2,39936
M v[244:247],a[116:119],v[60:63],v[244:247]
AF v29,v24,v29
C v55,v24,v25
M v[244:247],a[112:115],v[44:47],v[244:247]
AF v29,v25,v29
M v[252:255],a[120:123],v[44:47],v[252:255]
M v[252:255],a[124:127],v[60:63],v[252:255]
M v[248:251],a[124:127],v[56:59],v[248:251]
s_waitcnt lgkmcnt(0)
M v[248:251],a[120:123],v[40:43],v[248:251]
s_branch L_loop_top
L_st0:
s_call_b64 s[36:37], L_slow0
s_branch L_rt0
L_st1:
s_call_b64 s[36:37], L_slow1
s_branch L_rt1
L_stv1:
s_call_b64 s[36:37], L_slowf
s_branch L_rtv1
L_stk1:
s_call_b64 s[36:37], L_slowf
s_branch L_rtk1
L_sth1:
s_call_b64 s[36:37], L_slowf
s_branch L_rth1
L_stj0:
s_call_b64 s[36:37], L_slowj
s_branch L_rtj0
L_stv2:
s_call_b64 s[36:37], L_slow1
s_branch L_rtv2
L_stv3:
s_call_b64 s[36:37], L_slow0
s_branch L_rtv3
L_std1:
s_call_b64 s[36:37], L_slow1
s_branch L_rtd1
L_std3n:
s_call_b64 s[36:37], L_slow0
s_branch L_rtd3n
L_std3h:
s_call_b64 s[36:37], L_slow0
s_branch L_rtd3h
L_std4n:
s_call_b64 s[36:37], L_slowb
s_branch L_rtd4n
L_std4h:
s_call_b64 s[36:37], L_slowb
s_branch L_rtd4h
L_stfh:
s_call_b64 s[36:37], L_slow1n
s_branch L_rtfh
L_stc:
s_call_b64 s[36:37], L_comb
s_branch L_rtc
L_slow0:
s_nop 7
s_nop 3
v_max3_f32 v10, v64, v65, v66
v_max3_f32 v10, v67, v72, v10
v_max3_f32 v10, v73, v74, v10
v_max3_f32 v10, v75, v80, v10
v_max3_f32 v10, v81, v82, v10
v_max3_f32 v10, v83, v88, v10
v_max3_f32 v10, v89, v90, v10
v_max_f32 v10, v91, v10
v_max3_f32 v11, v68, v69, v70
v_max3_f32 v11, v71, v76, v11
v_max3_f32 v11, v77, v78, v11
v_max3_f32 v11, v79, v84, v11
v_max3_f32 v11, v85, v86, v11
v_max3_f32 v11, v87, v92, v11
v_max3_f32 v11, v93, v94, v11
v_max_f32 v11, v95, v11
v_mov_b32 v12, v10
v_mov_b32 v13, v11
s_nop 0
v_permlane16_swap_b32 v12, v10
v_permlane16_swap_b32 v13, v11
v_max_f32 v10, v12, v10
v_max_f32 v11, v13, v11
v_mov_b32 v12, v10
v_mov_b32 v13, v11
s_nop 0
v_permlane32_swap_b32 v12, v10
v_permlane32_swap_b32 v13, v11
v_max_f32 v10, v12, v10
v_max_f32 v11, v13, v11
v_ceil_f32 v10, v10
v_ceil_f32 v11, v11
v_max_f32 v10, 0, v10
v_max_f32 v11, 0, v11
v_sub_f32 v64, v64, v10
v_sub_f32 v65, v65, v10
v_sub_f32 v66, v66, v10
v_sub_f32 v67, v67, v10
v_sub_f32 v68, v68, v11
v_sub_f32 v69, v69, v11
v_sub_f32 v70, v70, v11
v_sub_f32 v71, v71, v11
v_sub_f32 v72, v72, v10
v_sub_f32 v73, v73, v10
v_sub_f32 v74, v74, v10
v_sub_f32 v75, v75, v10
v_sub_f32 v76, v76, v11
v_sub_f32 v77, v77, v11
v_sub_f32 v78, v78, v11
v_sub_f32 v79, v79, v11
v_sub_f32 v80, v80, v10
v_sub_f32 v81, v81, v10
v_sub_f32 v82, v82, v10
v_sub_f32 v83, v83, v10
v_sub_f32 v84, v84, v11
v_sub_f32 v85, v85, v11
v_sub_f32 v86, v86, v11
v_sub_f32 v87, v87, v11
v_sub_f32 v88, v88, v10
v_sub_f32 v89, v89, v10
v_sub_f32 v90, v90, v10
v_sub_f32 v91, v91, v10
v_sub_f32 v92, v92, v11
v_sub_f32 v93, v93, v11
v_sub_f32 v94, v94, v11
v_sub_f32 v95, v95, v11
v_sub_f32 v96, v96, v10
v_sub_f32 v97, v97, v10
v_sub_f32 v98, v98, v10
v_sub_f32 v99, v99, v10
v_sub_f32 v100, v100, v11
v_sub_f32 v101, v101, v11
v_sub_f32 v102, v102, v11
v_sub_f32 v103, v103, v11
v_sub_f32 v104, v104, v10
v_sub_f32 v105, v105, v10
v_sub_f32 v106, v106, v10
v_sub_f32 v107, v107, v10
v_sub_f32 v108, v108, v11
v_sub_f32 v109, v109, v11
v_sub_f32 v110, v110, v11
v_sub_f32 v111, v111, v11
v_sub_f32 v112, v112, v10
v_sub_f32 v113, v113, v10
v_sub_f32 v114, v114, v10
v_sub_f32 v115, v115, v10
v_sub_f32 v116, v116, v11
v_sub_f32 v117, v117, v11
v_sub_f32 v118, v118, v11
v_sub_f32 v119, v119, v11
v_sub_f32 v120, v120, v10
v_sub_f32 v121, v121, v10
v_sub_f32 v122, v122, v10
v_sub_f32 v123, v123, v10
v_sub_f32 v124, v124, v11
v_sub_f32 v125, v125, v11
v_sub_f32 v126, v126, v11
v_sub_f32 v127, v127, v11
v_sub_f32 v32, v32, v10
v_sub_f32 v33, v33, v10
v_sub_f32 v34, v34, v10
v_sub_f32 v35, v35, v10
v_sub_f32 v36, v36, v11
v_sub_f32 v37, v37, v11
v_sub_f32 v38, v38, v11
v_sub_f32 v39, v39, v11
E v12,-v10
E v13,-v11
MF v30,v12,v30
MF v31,v13,v31
MF v128,v12,v128
MF v129,v12,v129
MF v130,v12,v130
MF v131,v12,v131
MF v132,v13,v132
MF v133,v13,v133
MF v134,v13,v134
MF v135,v13,v135
MF v136,v12,v136
MF v137,v12,v137
MF v138,v12,v138
MF v139,v12,v139
MF v140,v13,v140
MF v141,v13,v141
MF v142,v13,v142
MF v143,v13,v143
MF v144,v12,v144
MF v145,v12,v145
MF v146,v12,v146
MF v147,v12,v147
MF v148,v13,v148
MF v149,v13,v149
MF v150,v13,v150
MF v151,v13,v151
MF v152,v12,v152
MF v153,v12,v153
MF v154,v12,v154
MF v155,v12,v155
MF v156,v13,v156
MF v157,v13,v157
MF v158,v13,v158
MF v159,v13,v159
MF v160,v12,v160
MF v161,v12,v161
MF v162,v12,v162
MF v163,v12,v163
MF v164,v13,v164
MF v165,v13,v165
MF v166,v13,v166
MF v167,v13,v167
MF v168,v12,v168
MF v169,v12,v169
MF v170,v12,v170
MF v171,v12,v171
MF v172,v13,v172
MF v173,v13,v173
MF v174,v13,v174
MF v175,v13,v175
MF v176,v12,v176
MF v177,v12,v177
MF v178,v12,v178
MF v179,v12,v179
MF v180,v13,v180
MF v181,v13,v181
MF v182,v13,v182
MF v183,v13,v183
MF v184,v12,v184
MF v185,v12,v185
MF v186,v12,v186
MF v187,v12,v187
MF v188,v13,v188
MF v189,v13,v189
MF v190,v13,v190
MF v191,v13,v191
MF v192,v12,v192
MF v193,v12,v193
MF v194,v12,v194
MF v195,v12,v195
MF v196,v13,v196
MF v197,v13,v197
MF v198,v13,v198
MF v199,v13,v199
MF v200,v12,v200
MF v201,v12,v201
MF v202,v12,v202
MF v203,v12,v203
MF v204,v13,v204
MF v205,v13,v205
MF v206,v13,v206
MF v207,v13,v207
MF v208,v12,v208
MF v209,v12,v209
MF v210,v12,v210
MF v211,v12,v211
MF v212,v13,v212
MF v213,v13,v213
MF v214,v13,v214
MF v215,v13,v215
MF v216,v12,v216
MF v217,v12,v217
MF v218,v12,v218
MF v219,v12,v219
MF v220,v13,v220
MF v221,v13,v221
MF v222,v13,v222
MF v223,v13,v223
MF v224,v12,v224
MF v225,v12,v225
MF v226,v12,v226
MF v227,v12,v227
MF v228,v13,v228
MF v229,v13,v229
MF v230,v13,v230
MF v231,v13,v231
MF v232,v12,v232
MF v233,v12,v233
MF v234,v12,v234
MF v235,v12,v235
MF v236,v13,v236
MF v237,v13,v237
MF v238,v13,v238
MF v239,v13,v239
MF v240,v12,v240
MF v241,v12,v241
MF v242,v12,v242
MF v243,v12,v243
MF v244,v13,v244
MF v245,v13,v245
MF v246,v13,v246
MF v247,v13,v247
MF v248,v12,v248
MF v249,v12,v249
MF v250,v12,v250
MF v251,v12,v251
MF v252,v13,v252
MF v253,v13,v253
MF v254,v13,v254
MF v255,v13,v255
E v18,v64
E v19,v65
E v20,v66
AF v26,v18,v19
C v40,v18,v19
E v21,v67
E v22,v72
AF v26,v20,v26
C v41,v20,v21
E v23,v73
AF v26,v21,v26
E v24,v74
AF v26,v22,v26
C v42,v22,v23
E v25,v75
AF v26,v23,v26
E v18,v68
AF v26,v24,v26
C v43,v24,v25
E v19,v69
AF v26,v25,v26
E v20,v70
AF v27,v18,v19
C v44,v18,v19
E v21,v71
E v22,v76
AF v27,v20,v27
C v45,v20,v21
E v23,v77
AF v27,v21,v27
E v24,v78
AF v27,v22,v27
C v46,v22,v23
E v25,v79
AF v27,v23,v27
AF v27,v24,v27
C v47,v24,v25
AF v27,v25,v27
E v18,v80
E v19,v81
E v20,v82
AF v26,v18,v26
C v56,v18,v19
E v21,v83
AF v26,v19,v26
E v22,v88
AF v26,v20,v26
C v57,v20,v21
E v23,v89
AF v26,v21,v26
E v24,v90
AF v26,v22,v26
C v58,v22,v23
E v25,v91
AF v26,v23,v26
E v18,v84
AF v26,v24,v26
C v59,v24,v25
E v19,v85
AF v26,v25,v26
E v20,v86
AF v27,v18,v27
C v60,v18,v19
E v21,v87
AF v27,v19,v27
E v22,v92
AF v27,v20,v27
C v61,v20,v21
E v23,v93
AF v27,v21,v27
E v24,v94
AF v27,v22,v27
C v62,v22,v23
E v25,v95
AF v27,v23,v27
AF v27,v24,v27
C v63,v24,v25
AF v27,v25,v27
s_nop 3
s_setpc_b64 s[36:37]
L_slow1:
s_nop 7
s_nop 3
v_max3_f32 v10, v96, v97, v98
v_max3_f32 v10, v99, v104, v10
v_max3_f32 v10, v105, v106, v10
v_max3_f32 v10, v107, v112, v10
v_max3_f32 v10, v113, v114, v10
v_max3_f32 v10, v115, v120, v10
v_max3_f32 v10, v121, v122, v10
v_max_f32 v10, v123, v10
v_max3_f32 v11, v100, v101, v102
v_max3_f32 v11, v103, v108, v11
v_max3_f32 v11, v109, v110, v11
v_max3_f32 v11, v111, v116, v11
v_max3_f32 v11, v117, v118, v11
v_max3_f32 v11, v119, v124, v11
v_max3_f32 v11, v125, v126, v11
v_max_f32 v11, v127, v11
v_mov_b32 v12, v10
v_mov_b32 v13, v11
s_nop 0
v_permlane16_swap_b32 v12, v10
v_permlane16_swap_b32 v13, v11
v_max_f32 v10, v12, v10
v_max_f32 v11, v13, v11
v_mov_b32 v12, v10
v_mov_b32 v13, v11
s_nop 0
v_permlane32_swap_b32 v12, v10
v_permlane32_swap_b32 v13, v11
v_max_f32 v10, v12, v10
v_max_f32 v11, v13, v11
v_ceil_f32 v10, v10
v_ceil_f32 v11, v11
v_max_f32 v10, 0, v10
v_max_f32 v11, 0, v11
v_sub_f32 v96, v96, v10
v_sub_f32 v97, v97, v10
v_sub_f32 v98, v98, v10
v_sub_f32 v99, v99, v10
v_sub_f32 v100, v100, v11
v_sub_f32 v101, v101, v11
v_sub_f32 v102, v102, v11
v_sub_f32 v103, v103, v11
v_sub_f32 v104, v104, v10
v_sub_f32 v105, v105, v10
v_sub_f32 v106, v106, v10
v_sub_f32 v107, v107, v10
v_sub_f32 v108, v108, v11
v_sub_f32 v109, v109, v11
v_sub_f32 v110, v110, v11
v_sub_f32 v111, v111, v11
v_sub_f32 v112, v112, v10
v_sub_f32 v113, v113, v10
v_sub_f32 v114, v114, v10
v_sub_f32 v115, v115, v10
v_sub_f32 v116, v116, v11
v_sub_f32 v117, v117, v11
v_sub_f32 v118, v118, v11
v_sub_f32 v119, v119, v11
v_sub_f32 v120, v120, v10
v_sub_f32 v121, v121, v10
v_sub_f32 v122, v122, v10
v_sub_f32 v123, v123, v10
v_sub_f32 v124, v124, v11
v_sub_f32 v125, v125, v11
v_sub_f32 v126, v126, v11
v_sub_f32 v127, v127, v11
v_sub_f32 v64, v64, v10
v_sub_f32 v65, v65, v10
v_sub_f32 v66, v66, v10
v_sub_f32 v67, v67, v10
v_sub_f32 v68, v68, v11
v_sub_f32 v69, v69, v11
v_sub_f32 v70, v70, v11
v_sub_f32 v71, v71, v11
v_sub_f32 v72, v72, v10
v_sub_f32 v73, v73, v10
v_sub_f32 v74, v74, v10
v_sub_f32 v75, v75, v10
v_sub_f32 v76, v76, v11
v_sub_f32 v77, v77, v11
v_sub_f32 v78, v78, v11
v_sub_f32 v79, v79, v11
v_sub_f32 v80, v80, v10
v_sub_f32 v81, v81, v10
v_sub_f32 v82, v82, v10
v_sub_f32 v83, v83, v10
v_sub_f32 v84, v84, v11
v_sub_f32 v85, v85, v11
v_sub_f32 v86, v86, v11
v_sub_f32 v87, v87, v11
v_sub_f32 v88, v88, v10
v_sub_f32 v89, v89, v10
v_sub_f32 v90, v90, v10
v_sub_f32 v91, v91, v10
v_sub_f32 v92, v92, v11
v_sub_f32 v93, v93, v11
v_sub_f32 v94, v94, v11
v_sub_f32 v95, v95, v11
v_sub_f32 v32, v32, v10
v_sub_f32 v33, v33, v10
v_sub_f32 v34, v34, v10
v_sub_f32 v35, v35, v10
v_sub_f32 v36, v36, v11
v_sub_f32 v37, v37, v11
v_sub_f32 v38, v38, v11
v_sub_f32 v39, v39, v11
E v12,-v10
E v13,-v11
MF v30,v12,v30
MF v31,v13,v31
MF v128,v12,v128
MF v129,v12,v129
MF v130,v12,v130
MF v131,v12,v131
MF v132,v13,v132
MF v133,v13,v133
MF v134,v13,v134
MF v135,v13,v135
MF v136,v12,v136
MF v137,v12,v137
MF v138,v12,v138
MF v139,v12,v139
MF v140,v13,v140
MF v141,v13,v141
MF v142,v13,v142
MF v143,v13,v143
MF v144,v12,v144
MF v145,v12,v145
MF v146,v12,v146
MF v147,v12,v147
MF v148,v13,v148
MF v149,v13,v149
MF v150,v13,v150
MF v151,v13,v151
MF v152,v12,v152
MF v153,v12,v153
MF v154,v12,v154
MF v155,v12,v155
MF v156,v13,v156
MF v157,v13,v157
MF v158,v13,v158
MF v159,v13,v159
MF v160,v12,v160
MF v161,v12,v161
MF v162,v12,v162
MF v163,v12,v163
MF v164,v13,v164
MF v165,v13,v165
MF v166,v13,v166
MF v167,v13,v167
MF v168,v12,v168
MF v169,v12,v169
MF v170,v12,v170
MF v171,v12,v171
MF v172,v13,v172
MF v173,v13,v173
MF v174,v13,v174
MF v175,v13,v175
MF v176,v12,v176
MF v177,v12,v177
MF v178,v12,v178
MF v179,v12,v179
MF v180,v13,v180
MF v181,v13,v181
MF v182,v13,v182
MF v183,v13,v183
MF v184,v12,v184
MF v185,v12,v185
MF v186,v12,v186
MF v187,v12,v187
MF v188,v13,v188
MF v189,v13,v189
MF v190,v13,v190
MF v191,v13,v191
MF v192,v12,v192
MF v193,v12,v193
MF v194,v12,v194
MF v195,v12,v195
MF v196,v13,v196
MF v197,v13,v197
MF v198,v13,v198
MF v199,v13,v199
MF v200,v12,v200
MF v201,v12,v201
MF v202,v12,v202
MF v203,v12,v203
MF v204,v13,v204
MF v205,v13,v205
MF v206,v13,v206
MF v207,v13,v207
MF v208,v12,v208
MF v209,v12,v209
MF v210,v12,v210
MF v211,v12,v211
MF v212,v13,v212
MF v213,v13,v213
MF v214,v13,v214
MF v215,v13,v215
MF v216,v12,v216
MF v217,v12,v217
MF v218,v12,v218
MF v219,v12,v219
MF v220,v13,v220
MF v221,v13,v221
MF v222,v13,v222
MF v223,v13,v223
MF v224,v12,v224
MF v225,v12,v225
MF v226,v12,v226
MF v227,v12,v227
MF v228,v13,v228
MF v229,v13,v229
MF v230,v13,v230
MF v231,v13,v231
MF v232,v12,v232
MF v233,v12,v233
MF v234,v12,v234
MF v235,v12,v235
MF v236,v13,v236
MF v237,v13,v237
MF v238,v13,v238
MF v239,v13,v239
MF v240,v12,v240
MF v241,v12,v241
MF v242,v12,v242
MF v243,v12,v243
MF v244,v13,v244
MF v245,v13,v245
MF v246,v13,v246
MF v247,v13,v247
MF v248,v12,v248
MF v249,v12,v249
MF v250,v12,v250
MF v251,v12,v251
MF v252,v13,v252
MF v253,v13,v253
MF v254,v13,v254
MF v255,v13,v255
E v18,v96
E v19,v97
E v20,v98
AF v28,v18,v19
C v48,v18,v19
E v21,v99
E v22,v104
AF v28,v20,v28
C v49,v20,v21
E v23,v105
AF v28,v21,v28
E v24,v106
AF v28,v22,v28
C v50,v22,v23
E v25,v107
AF v28,v23,v28
E v18,v100
AF v28,v24,v28
C v51,v24,v25
E v19,v101
AF v28,v25,v28
E v20,v102
AF v29,v18,v19
C v52,v18,v19
E v21,v103
E v22,v108
AF v29,v20,v29
C v53,v20,v21
E v23,v109
AF v29,v21,v29
E v24,v110
AF v29,v22,v29
C v54,v22,v23
E v25,v111
AF v29,v23,v29
AF v29,v24,v29
C v55,v24,v25
AF v29,v25,v29
E v18,v112
E v19,v113
E v20,v114
AF v28,v18,v28
C v56,v18,v19
E v21,v115
AF v28,v19,v28
E v22,v120
AF v28,v20,v28
C v57,v20,v21
E v23,v121
AF v28,v21,v28
E v24,v122
AF v28,v22,v28
C v58,v22,v23
E v25,v123
AF v28,v23,v28
E v18,v116
AF v28,v24,v28
C v59,v24,v25
E v19,v117
AF v28,v25,v28
E v20,v118
AF v29,v18,v29
C v60,v18,v19
E v21,v119
AF v29,v19,v29
E v22,v124
AF v29,v20,v29
C v61,v20,v21
E v23,v125
AF v29,v21,v29
E v24,v126
AF v29,v22,v29
C v62,v22,v23
E v25,v127
AF v29,v23,v29
AF v29,v24,v29
C v63,v24,v25
AF v29,v25,v29
s_nop 3
s_setpc_b64 s[36:37]
L_slow1n:
s_nop 7
s_nop 3
v_max3_f32 v10, v96, v97, v98
v_max3_f32 v10, v99, v104, v10
v_max3_f32 v10, v105, v106, v10
v_max3_f32 v10, v107, v112, v10
v_max3_f32 v10, v113, v114, v10
v_max3_f32 v10, v115, v120, v10
v_max3_f32 v10, v121, v122, v10
v_max_f32 v10, v123, v10
v_max3_f32 v11, v100, v101, v102
v_max3_f32 v11, v103, v108, v11
v_max3_f32 v11, v109, v110, v11
v_max3_f32 v11, v111, v116, v11
v_max3_f32 v11, v117, v118, v11
v_max3_f32 v11, v119, v124, v11
v_max3_f32 v11, v125, v126, v11
v_max_f32 v11, v127, v11
v_mov_b32 v12, v10
v_mov_b32 v13, v11
s_nop 0
v_permlane16_swap_b32 v12, v10
v_permlane16_swap_b32 v13, v11
v_max_f32 v10, v12, v10
v_max_f32 v11, v13, v11
v_mov_b32 v12, v10
v_mov_b32 v13, v11
s_nop 0
v_permlane32_swap_b32 v12, v10
v_permlane32_swap_b32 v13, v11
v_max_f32 v10, v12, v10
v_max_f32 v11, v13, v11
v_ceil_f32 v10, v10
v_ceil_f32 v11, v11
v_max_f32 v10, 0, v10
v_max_f32 v11, 0, v11
v_sub_f32 v96, v96, v10
v_sub_f32 v97, v97, v10
v_sub_f32 v98, v98, v10
v_sub_f32 v99, v99, v10
v_sub_f32 v100, v100, v11
v_sub_f32 v101, v101, v11
v_sub_f32 v102, v102, v11
v_sub_f32 v103, v103, v11
v_sub_f32 v104, v104, v10
v_sub_f32 v105, v105, v10
v_sub_f32 v106, v106, v10
v_sub_f32 v107, v107, v10
v_sub_f32 v108, v108, v11
v_sub_f32 v109, v109, v11
v_sub_f32 v110, v110, v11
v_sub_f32 v111, v111, v11
v_sub_f32 v112, v112, v10
v_sub_f32 v113, v113, v10
v_sub_f32 v114, v114, v10
v_sub_f32 v115, v115, v10
v_sub_f32 v116, v116, v11
v_sub_f32 v117, v117, v11
v_sub_f32 v118, v118, v11
v_sub_f32 v119, v119, v11
v_sub_f32 v120, v120, v10
v_sub_f32 v121, v121, v10
v_sub_f32 v122, v122, v10
v_sub_f32 v123, v123, v10
v_sub_f32 v124, v124, v11
v_sub_f32 v125, v125, v11
v_sub_f32 v126, v126, v11
v_sub_f32 v127, v127, v11
v_sub_f32 v32, v32, v10
v_sub_f32 v33, v33, v10
v_sub_f32 v34, v34, v10
v_sub_f32 v35, v35, v10
v_sub_f32 v36, v36, v11
v_sub_f32 v37, v37, v11
v_sub_f32 v38, v38, v11
v_sub_f32 v39, v39, v11
E v12,-v10
E v13,-v11
MF v30,v12,v30
MF v31,v13,v31
MF v128,v12,v128
MF v129,v12,v129
MF v130,v12,v130
MF v131,v12,v131
MF v132,v13,v132
MF v133,v13,v133
MF v134,v13,v134
MF v135,v13,v135
MF v136,v12,v136
MF v137,v12,v137
MF v138,v12,v138
MF v139,v12,v139
MF v140,v13,v140
MF v141,v13,v141
MF v142,v13,v142
MF v143,v13,v143
MF v144,v12,v144
MF v145,v12,v145
MF v146,v12,v146
MF v147,v12,v147
MF v148,v13,v148
MF v149,v13,v149
MF v150,v13,v150
MF v151,v13,v151
MF v152,v12,v152
MF v153,v12,v153
MF v154,v12,v154
MF v155,v12,v155
MF v156,v13,v156
MF v157,v13,v157
MF v158,v13,v158
MF v159,v13,v159
MF v160,v12,v160
MF v161,v12,v161
MF v162,v12,v162
MF v163,v12,v163
MF v164,v13,v164
MF v165,v13,v165
MF v166,v13,v166
MF v167,v13,v167
MF v168,v12,v168
MF v169,v12,v169
MF v170,v12,v170
MF v171,v12,v171
MF v172,v13,v172
MF v173,v13,v173
MF v174,v13,v174
MF v175,v13,v175
MF v176,v12,v176
MF v177,v12,v177
MF v178,v12,v178
MF v179,v12,v179
MF v180,v13,v180
MF v181,v13,v181
MF v182,v13,v182
MF v183,v13,v183
MF v184,v12,v184
MF v185,v12,v185
MF v186,v12,v186
MF v187,v12,v187
MF v188,v13,v188
MF v189,v13,v189
MF v190,v13,v190
MF v191,v13,v191
MF v192,v12,v192
MF v193,v12,v193
MF v194,v12,v194
MF v195,v12,v195
MF v196,v13,v196
MF v197,v13,v197
MF v198,v13,v198
MF v199,v13,v199
MF v200,v12,v200
MF v201,v12,v201
MF v202,v12,v202
MF v203,v12,v203
MF v204,v13,v204
MF v205,v13,v205
MF v206,v13,v206
MF v207,v13,v207
MF v208,v12,v208
MF v209,v12,v209
MF v210,v12,v210
MF v211,v12,v211
MF v212,v13,v212
MF v213,v13,v213
MF v214,v13,v214
MF v215,v13,v215
MF v216,v12,v216
MF v217,v12,v217
MF v218,v12,v218
MF v219,v12,v219
MF v220,v13,v220
MF v221,v13,v221
MF v222,v13,v222
MF v223,v13,v223
MF v224,v12,v224
MF v225,v12,v225
MF v226,v12,v226
MF v227,v12,v227
MF v228,v13,v228
MF v229,v13,v229
MF v230,v13,v230
MF v231,v13,v231
MF v232,v12,v232
MF v233,v12,v233
MF v234,v12,v234
MF v235,v12,v235
MF v236,v13,v236
MF v237,v13,v237
MF v238,v13,v238
MF v239,v13,v239
MF v240,v12,v240
MF v241,v12,v241
MF v242,v12,v242
MF v243,v12,v243
MF v244,v13,v244
MF v245,v13,v245
MF v246,v13,v246
MF v247,v13,v247
MF v248,v12,v248
MF v249,v12,v249
MF v250,v12,v250
MF v251,v12,v251
MF v252,v13,v252
MF v253,v13,v253
MF v254,v13,v254
MF v255,v13,v255
E v18,v96
E v19,v97
E v20,v98
AF v28,v18,v19
C v48,v18,v19
E v21,v99
E v22,v104
AF v28,v20,v28
C v49,v20,v21
E v23,v105
AF v28,v21,v28
E v24,v106
AF v28,v22,v28
C v50,v22,v23
E v25,v107
AF v28,v23,v28
E v18,v100
AF v28,v24,v28
C v51,v24,v25
E v19,v101
AF v28,v25,v28
E v20,v102
AF v29,v18,v19
C v52,v18,v19
E v21,v103
E v22,v108
AF v29,v20,v29
C v53,v20,v21
E v23,v109
AF v29,v21,v29
E v24,v110
AF v29,v22,v29
C v54,v22,v23
E v25,v111
AF v29,v23,v29
AF v29,v24,v29
C v55,v24,v25
AF v29,v25,v29
E v18,v112
E v19,v113
E v20,v114
AF v28,v18,v28
C v56,v18,v19
E v21,v115
AF v28,v19,v28
E v22,v120
AF v28,v20,v28
C v57,v20,v21
E v23,v121
AF v28,v21,v28
E v24,v122
AF v28,v22,v28
C v58,v22,v23
E v25,v123
AF v28,v23,v28
E v18,v116
AF v28,v24,v28
C v59,v24,v25
E v19,v117
AF v28,v25,v28
E v20,v118
AF v29,v18,v29
C v60,v18,v19
E v21,v119
AF v29,v19,v29
E v22,v124
AF v29,v20,v29
C v61,v20,v21
E v23,v125
AF v29,v21,v29
E v24,v126
AF v29,v22,v29
C v62,v22,v23
E v25,v127
AF v29,v23,v29
AF v29,v24,v29
C v63,v24,v25
AF v29,v25,v29
s_nop 3
s_setpc_b64 s[36:37]
L_slowf:
s_nop 7
s_nop 3
v_max3_f32 v10, v64, v65, v66
v_max3_f32 v10, v67, v72, v10
v_max3_f32 v10, v73, v74, v10
v_max3_f32 v10, v75, v80, v10
v_max3_f32 v10, v81, v82, v10
v_max3_f32 v10, v83, v88, v10
v_max3_f32 v10, v89, v90, v10
v_max_f32 v10, v91, v10
v_max3_f32 v11, v68, v69, v70
v_max3_f32 v11, v71, v76, v11
v_max3_f32 v11, v77, v78, v11
v_max3_f32 v11, v79, v84, v11
v_max3_f32 v11, v85, v86, v11
v_max3_f32 v11, v87, v92, v11
v_max3_f32 v11, v93, v94, v11
v_max_f32 v11, v95, v11
v_mov_b32 v12, v10
v_mov_b32 v13, v11
s_nop 0
v_permlane16_swap_b32 v12, v10
v_permlane16_swap_b32 v13, v11
v_max_f32 v10, v12, v10
v_max_f32 v11, v13, v11
v_mov_b32 v12, v10
v_mov_b32 v13, v11
s_nop 0
v_permlane32_swap_b32 v12, v10
v_permlane32_swap_b32 v13, v11
v_max_f32 v10, v12, v10
v_max_f32 v11, v13, v11
v_ceil_f32 v10, v10
v_ceil_f32 v11, v11
v_sub_f32 v64, v64, v10
v_sub_f32 v65, v65, v10
v_sub_f32 v66, v66, v10
v_sub_f32 v67, v67, v10
v_sub_f32 v68, v68, v11
v_sub_f32 v69, v69, v11
v_sub_f32 v70, v70, v11
v_sub_f32 v71, v71, v11
v_sub_f32 v72, v72, v10
v_sub_f32 v73, v73, v10
v_sub_f32 v74, v74, v10
v_sub_f32 v75, v75, v10
v_sub_f32 v76, v76, v11
v_sub_f32 v77, v77, v11
v_sub_f32 v78, v78, v11
v_sub_f32 v79, v79, v11
v_sub_f32 v80, v80, v10
v_sub_f32 v81, v81, v10
v_sub_f32 v82, v82, v10
v_sub_f32 v83, v83, v10
v_sub_f32 v84, v84, v11
v_sub_f32 v85, v85, v11
v_sub_f32 v86, v86, v11
v_sub_f32 v87, v87, v11
v_sub_f32 v88, v88, v10
v_sub_f32 v89, v89, v10
v_sub_f32 v90, v90, v10
v_sub_f32 v91, v91, v10
v_sub_f32 v92, v92, v11
v_sub_f32 v93, v93, v11
v_sub_f32 v94, v94, v11
v_sub_f32 v95, v95, v11
v_sub_f32 v96, v96, v10
v_sub_f32 v97, v97, v10
v_sub_f32 v98, v98, v10
v_sub_f32 v99, v99, v10
v_sub_f32 v100, v100, v11
v_sub_f32 v101, v101, v11
v_sub_f32 v102, v102, v11
v_sub_f32 v103, v103, v11
v_sub_f32 v104, v104, v10
v_sub_f32 v105, v105, v10
v_sub_f32 v106, v106, v10
v_sub_f32 v107, v107, v10
v_sub_f32 v108, v108, v11
v_sub_f32 v109, v109, v11
v_sub_f32 v110, v110, v11
v_sub_f32 v111, v111, v11
v_sub_f32 v112, v112, v10
v_sub_f32 v113, v113, v10
v_sub_f32 v114, v114, v10
v_sub_f32 v115, v115, v10
v_sub_f32 v116, v116, v11
v_sub_f32 v117, v117, v11
v_sub_f32 v118, v118, v11
v_sub_f32 v119, v119, v11
v_sub_f32 v120, v120, v10
v_sub_f32 v121, v121, v10
v_sub_f32 v122, v122, v10
v_sub_f32 v123, v123, v10
v_sub_f32 v124, v124, v11
v_sub_f32 v125, v125, v11
v_sub_f32 v126, v126, v11
v_sub_f32 v127, v127, v11
v_sub_f32 v32, v32, v10
v_sub_f32 v33, v33, v10
v_sub_f32 v34, v34, v10
v_sub_f32 v35, v35, v10
v_sub_f32 v36, v36, v11
v_sub_f32 v37, v37, v11
v_sub_f32 v38, v38, v11
v_sub_f32 v39, v39, v11
E v18,v64
E v19,v65
E v20,v66
AF v26,v18,v19
C v40,v18,v19
E v21,v67
E v22,v72
AF v26,v20,v26
C v41,v20,v21
E v23,v73
AF v26,v21,v26
E v24,v74
AF v26,v22,v26
C v42,v22,v23
E v25,v75
AF v26,v23,v26
E v18,v68
AF v26,v24,v26
C v43,v24,v25
E v19,v69
AF v26,v25,v26
E v20,v70
AF v27,v18,v19
C v44,v18,v19
E v21,v71
E v22,v76
AF v27,v20,v27
C v45,v20,v21
E v23,v77
AF v27,v21,v27
E v24,v78
AF v27,v22,v27
C v46,v22,v23
E v25,v79
AF v27,v23,v27
AF v27,v24,v27
C v47,v24,v25
AF v27,v25,v27
E v18,v80
E v19,v81
E v20,v82
AF v26,v18,v26
C v56,v18,v19
E v21,v83
AF v26,v19,v26
E v22,v88
AF v26,v20,v26
C v57,v20,v21
E v23,v89
AF v26,v21,v26
E v24,v90
AF v26,v22,v26
C v58,v22,v23
E v25,v91
AF v26,v23,v26
E v18,v84
AF v26,v24,v26
C v59,v24,v25
E v19,v85
AF v26,v25,v26
E v20,v86
AF v27,v18,v27
C v60,v18,v19
E v21,v87
AF v27,v19,v27
E v22,v92
AF v27,v20,v27
C v61,v20,v21
E v23,v93
AF v27,v21,v27
E v24,v94
AF v27,v22,v27
C v62,v22,v23
E v25,v95
AF v27,v23,v27
AF v27,v24,v27
C v63,v24,v25
AF v27,v25,v27
s_nop 3
s_setpc_b64 s[36:37]
L_slowj:
s_nop 7
s_nop 3
v_max3_f32 v10, v64, v65, v66
v_max3_f32 v10, v67, v72, v10
v_max3_f32 v10, v73, v74, v10
v_max3_f32 v10, v75, v80, v10
v_max3_f32 v10, v81, v82, v10
v_max3_f32 v10, v83, v88, v10
v_max3_f32 v10, v89, v90, v10
v_max_f32 v10, v91, v10
v_max3_f32 v11, v68, v69, v70
v_max3_f32 v11, v71, v76, v11
v_max3_f32 v11, v77, v78, v11
v_max3_f32 v11, v79, v84, v11
v_max3_f32 v11, v85, v86, v11
v_max3_f32 v11, v87, v92, v11
v_max3_f32 v11, v93, v94, v11
v_max_f32 v11, v95, v11
v_mov_b32 v12, v10
v_mov_b32 v13, v11
s_nop 0
v_permlane16_swap_b32 v12, v10
v_permlane16_swap_b32 v13, v11
v_max_f32 v10, v12, v10
v_max_f32 v11, v13, v11
v_mov_b32 v12, v10
v_mov_b32 v13, v11
s_nop 0
v_permlane32_swap_b32 v12, v10
v_permlane32_swap_b32 v13, v11
v_max_f32 v10, v12, v10
v_max_f32 v11, v13, v11
v_ceil_f32 v10, v10
v_ceil_f32 v11, v11
v_sub_f32 v64, v64, v10
v_sub_f32 v65, v65, v10
v_sub_f32 v66, v66, v10
v_sub_f32 v67, v67, v10
v_sub_f32 v68, v68, v11
v_sub_f32 v69, v69, v11
v_sub_f32 v70, v70, v11
v_sub_f32 v71, v71, v11
v_sub_f32 v72, v72, v10
v_sub_f32 v73, v73, v10
v_sub_f32 v74, v74, v10
v_sub_f32 v75, v75, v10
v_sub_f32 v76, v76, v11
v_sub_f32 v77, v77, v11
v_sub_f32 v78, v78, v11
v_sub_f32 v79, v79, v11
v_sub_f32 v80, v80, v10
v_sub_f32 v81, v81, v10
v_sub_f32 v82, v82, v10
v_sub_f32 v83, v83, v10
v_sub_f32 v84, v84, v11
v_sub_f32 v85, v85, v11
v_sub_f32 v86, v86, v11
v_sub_f32 v87, v87, v11
v_sub_f32 v88, v88, v10
v_sub_f32 v89, v89, v10
v_sub_f32 v90, v90, v10
v_sub_f32 v91, v91, v10
v_sub_f32 v92, v92, v11
v_sub_f32 v93, v93, v11
v_sub_f32 v94, v94, v11
v_sub_f32 v95, v95, v11
v_sub_f32 v32, v32, v10
v_sub_f32 v33, v33, v10
v_sub_f32 v34, v34, v10
v_sub_f32 v35, v35, v10
v_sub_f32 v36, v36, v11
v_sub_f32 v37, v37, v11
v_sub_f32 v38, v38, v11
v_sub_f32 v39, v39, v11
E v18,v64
E v19,v65
E v20,v66
AF v26,v18,v19
C v40,v18,v19
E v21,v67
E v22,v72
AF v26,v20,v26
C v41,v20,v21
E v23,v73
AF v26,v21,v26
E v24,v74
AF v26,v22,v26
C v42,v22,v23
E v25,v75
AF v26,v23,v26
E v18,v68
AF v26,v24,v26
C v43,v24,v25
E v19,v69
AF v26,v25,v26
E v20,v70
AF v27,v18,v19
C v44,v18,v19
E v21,v71
E v22,v76
AF v27,v20,v27
C v45,v20,v21
E v23,v77
AF v27,v21,v27
E v24,v78
AF v27,v22,v27
C v46,v22,v23
E v25,v79
AF v27,v23,v27
AF v27,v24,v27
C v47,v24,v25
AF v27,v25,v27
s_nop 3
s_setpc_b64 s[36:37]
L_slowb:
s_nop 7
s_nop 3
v_max3_f32 v11, v100, v101, v102
v_max3_f32 v11, v103, v108, v11
v_max3_f32 v11, v109, v110, v11
v_max3_f32 v11, v111, v116, v11
v_max3_f32 v11, v117, v118, v11
v_max3_f32 v11, v119, v124, v11
v_max3_f32 v11, v125, v126, v11
v_max_f32 v11, v127, v11
v_mov_b32 v13, v11
s_nop 1
v_permlane16_swap_b32 v13, v11
v_max_f32 v11, v13, v11
v_mov_b32 v13, v11
s_nop 1
v_permlane32_swap_b32 v13, v11
v_max_f32 v11, v13, v11
v_ceil_f32 v11, v11
v_max_f32 v11, 0, v11
v_mov_b32 v10, 0
v_sub_f32 v100, v100, v11
v_sub_f32 v101, v101, v11
v_sub_f32 v102, v102, v11
v_sub_f32 v103, v103, v11
v_sub_f32 v108, v108, v11
v_sub_f32 v109, v109, v11
v_sub_f32 v110, v110, v11
v_sub_f32 v111, v111, v11
v_sub_f32 v116, v116, v11
v_sub_f32 v117, v117, v11
v_sub_f32 v118, v118, v11
v_sub_f32 v119, v119, v11
v_sub_f32 v124, v124, v11
v_sub_f32 v125, v125, v11
v_sub_f32 v126, v126, v11
v_sub_f32 v127, v127, v11
v_sub_f32 v32, v32, v10
v_sub_f32 v33, v33, v10
v_sub_f32 v34, v34, v10
v_sub_f32 v35, v35, v10
v_sub_f32 v36, v36, v11
v_sub_f32 v37, v37, v11
v_sub_f32 v38, v38, v11
v_sub_f32 v39, v39, v11
E v12,-v10
E v13,-v11
MF v30,v12,v30
MF v31,v13,v31
MF v128,v12,v128
MF v129,v12,v129
MF v130,v12,v130
MF v131,v12,v131
MF v132,v13,v132
MF v133,v13,v133
MF v134,v13,v134
MF v135,v13,v135
MF v136,v12,v136
MF v137,v12,v137
MF v138,v12,v138
MF v139,v12,v139
MF v140,v13,v140
MF v141,v13,v141
MF v142,v13,v142
MF v143,v13,v143
MF v144,v12,v144
MF v145,v12,v145
MF v146,v12,v146
MF v147,v12,v147
MF v148,v13,v148
MF v149,v13,v149
MF v150,v13,v150
MF v151,v13,v151
MF v152,v12,v152
MF v153,v12,v153
MF v154,v12,v154
MF v155,v12,v155
MF v156,v13,v156
MF v157,v13,v157
MF v158,v13,v158
MF v159,v13,v159
MF v160,v12,v160
MF v161,v12,v161
MF v162,v12,v162
MF v163,v12,v163
MF v164,v13,v164
MF v165,v13,v165
MF v166,v13,v166
MF v167,v13,v167
MF v168,v12,v168
MF v169,v12,v169
MF v170,v12,v170
MF v171,v12,v171
MF v172,v13,v172
MF v173,v13,v173
MF v174,v13,v174
MF v175,v13,v175
MF v176,v12,v176
MF v177,v12,v177
MF v178,v12,v178
MF v179,v12,v179
MF v180,v13,v180
MF v181,v13,v181
MF v182,v13,v182
MF v183,v13,v183
MF v184,v12,v184
MF v185,v12,v185
MF v186,v12,v186
MF v187,v12,v187
MF v188,v13,v188
MF v189,v13,v189
MF v190,v13,v190
MF v191,v13,v191
MF v192,v12,v192
MF v193,v12,v193
MF v194,v12,v194
MF v195,v12,v195
MF v196,v13,v196
MF v197,v13,v197
MF v198,v13,v198
MF v199,v13,v199
MF v200,v12,v200
MF v201,v12,v201
MF v202,v12,v202
MF v203,v12,v203
MF v204,v13,v204
MF v205,v13,v205
MF v206,v13,v206
MF v207,v13,v207
MF v208,v12,v208
MF v209,v12,v209
MF v210,v12,v210
MF v211,v12,v211
MF v212,v13,v212
MF v213,v13,v213
MF v214,v13,v214
MF v215,v13,v215
MF v216,v12,v216
MF v217,v12,v217
MF v218,v12,v218
MF v219,v12,v219
MF v220,v13,v220
MF v221,v13,v221
MF v222,v13,v222
MF v223,v13,v223
MF v224,v12,v224
MF v225,v12,v225
MF v226,v12,v226
MF v227,v12,v227
MF v228,v13,v228
MF v229,v13,v229
MF v230,v13,v230
MF v231,v13,v231
MF v232,v12,v232
MF v233,v12,v233
MF v234,v12,v234
MF v235,v12,v235
MF v236,v13,v236
MF v237,v13,v237
MF v238,v13,v238
MF v239,v13,v239
MF v240,v12,v240
MF v241,v12,v241
MF v242,v12,v242
MF v243,v12,v243
MF v244,v13,v244
MF v245,v13,v245
MF v246,v13,v246
MF v247,v13,v247
MF v248,v12,v248
MF v249,v12,v249
MF v250,v12,v250
MF v251,v12,v251
MF v252,v13,v252
MF v253,v13,v253
MF v254,v13,v254
MF v255,v13,v255
E v18,v100
E v19,v101
E v20,v102
AF v29,v18,v19
C v52,v18,v19
E v21,v103
E v22,v108
AF v29,v20,v29
C v53,v20,v21
E v23,v109
AF v29,v21,v29
E v24,v110
AF v29,v22,v29
C v54,v22,v23
E v25,v111
AF v29,v23,v29
E v18,v116
AF v29,v24,v29
C v55,v24,v25
E v19,v117
AF v29,v25,v29
E v20,v118
AF v29,v18,v29
C v48,v18,v19
E v21,v119
AF v29,v19,v29
E v22,v124
AF v29,v20,v29
C v49,v20,v21
E v23,v125
AF v29,v21,v29
E v24,v126
AF v29,v22,v29
C v50,v22,v23
E v25,v127
AF v29,v23,v29
AF v29,v24,v29
C v51,v24,v25
AF v29,v25,v29
s_nop 3
s_setpc_b64 s[36:37]
L_comb:
s_waitcnt vmcnt(0)
s_nop 7
v_sub_f32 v10, v32, v14
v_sub_f32 v11, v36, v15
v_max_f32 v10, 0, v10
v_max_f32 v11, 0, v11
v_sub_f32 v100, v100, v11
v_sub_f32 v101, v101, v11
v_sub_f32 v102, v102, v11
v_sub_f32 v103, v103, v11
v_sub_f32 v108, v108, v11
v_sub_f32 v109, v109, v11
v_sub_f32 v110, v110, v11
v_sub_f32 v111, v111, v11
v_sub_f32 v116, v116, v11
v_sub_f32 v117, v117, v11
v_sub_f32 v118, v118, v11
v_sub_f32 v119, v119, v11
v_sub_f32 v124, v124, v11
v_sub_f32 v125, v125, v11
v_sub_f32 v126, v126, v11
v_sub_f32 v127, v127, v11
v_sub_f32 v32, v32, v10
v_sub_f32 v33, v33, v10
v_sub_f32 v34, v34, v10
v_sub_f32 v35, v35, v10
v_sub_f32 v36, v36, v11
v_sub_f32 v37, v37, v11
v_sub_f32 v38, v38, v11
v_sub_f32 v39, v39, v11
E v12,-v10
E v13,-v11
MF v30,v12,v30
MF v31,v13,v31
MF v128,v12,v128
MF v129,v12,v129
MF v130,v12,v130
MF v131,v12,v131
MF v132,v13,v132
MF v133,v13,v133
MF v134,v13,v134
MF v135,v13,v135
MF v136,v12,v136
MF v137,v12,v137
MF v138,v12,v138
MF v139,v12,v139
MF v140,v13,v140
MF v141,v13,v141
MF v142,v13,v142
MF v143,v13,v143
MF v144,v12,v144
MF v145,v12,v145
MF v146,v12,v146
MF v147,v12,v147
MF v148,v13,v148
MF v149,v13,v149
MF v150,v13,v150
MF v151,v13,v151
MF v152,v12,v152
MF v153,v12,v153
MF v154,v12,v154
MF v155,v12,v155
MF v156,v13,v156
MF v157,v13,v157
MF v158,v13,v158
MF v159,v13,v159
MF v160,v12,v160
MF v161,v12,v161
MF v162,v12,v162
MF v163,v12,v163
MF v164,v13,v164
MF v165,v13,v165
MF v166,v13,v166
MF v167,v13,v167
MF v168,v12,v168
MF v169,v12,v169
MF v170,v12,v170
MF v171,v12,v171
MF v172,v13,v172
MF v173,v13,v173
MF v174,v13,v174
MF v175,v13,v175
MF v176,v12,v176
MF v177,v12,v177
MF v178,v12,v178
MF v179,v12,v179
MF v180,v13,v180
MF v181,v13,v181
MF v182,v13,v182
MF v183,v13,v183
MF v184,v12,v184
MF v185,v12,v185
MF v186,v12,v186
MF v187,v12,v187
MF v188,v13,v188
MF v189,v13,v189
MF v190,v13,v190
MF v191,v13,v191
MF v192,v12,v192
MF v193,v12,v193
MF v194,v12,v194
MF v195,v12,v195
MF v196,v13,v196
MF v197,v13,v197
MF v198,v13,v198
MF v199,v13,v199
MF v200,v12,v200
MF v201,v12,v201
MF v202,v12,v202
MF v203,v12,v203
MF v204,v13,v204
MF v205,v13,v205
MF v206,v13,v206
MF v207,v13,v207
MF v208,v12,v208
MF v209,v12,v209
MF v210,v12,v210
MF v211,v12,v211
MF v212,v13,v212
MF v213,v13,v213
MF v214,v13,v214
MF v215,v13,v215
MF v216,v12,v216
MF v217,v12,v217
MF v218,v12,v218
MF v219,v12,v219
MF v220,v13,v220
MF v221,v13,v221
MF v222,v13,v222
MF v223,v13,v223
MF v224,v12,v224
MF v225,v12,v225
MF v226,v12,v226
MF v227,v12,v227
MF v228,v13,v228
MF v229,v13,v229
MF v230,v13,v230
MF v231,v13,v231
MF v232,v12,v232
MF v233,v12,v233
MF v234,v12,v234
MF v235,v12,v235
MF v236,v13,v236
MF v237,v13,v237
MF v238,v13,v238
MF v239,v13,v239
MF v240,v12,v240
MF v241,v12,v241
MF v242,v12,v242
MF v243,v12,v243
MF v244,v13,v244
MF v245,v13,v245
MF v246,v13,v246
MF v247,v13,v247
MF v248,v12,v248
MF v249,v12,v249
MF v250,v12,v250
MF v251,v12,v251
MF v252,v13,v252
MF v253,v13,v253
MF v254,v13,v254
MF v255,v13,v255
E v18,v100
E v19,v101
E v20,v102
AF v29,v18,v19
C v52,v18,v19
E v21,v103
E v22,v108
AF v29,v20,v29
C v53,v20,v21
E v23,v109
AF v29,v21,v29
E v24,v110
AF v29,v22,v29
C v54,v22,v23
E v25,v111
AF v29,v23,v29
E v18,v116
AF v29,v24,v29
C v55,v24,v25
E v19,v117
AF v29,v25,v29
E v20,v118
AF v29,v18,v29
C v48,v18,v19
E v21,v119
AF v29,v19,v29
E v22,v124
AF v29,v20,v29
C v49,v20,v21
E v23,v125
AF v29,v21,v29
E v24,v126
AF v29,v22,v29
C v50,v22,v23
E v25,v127
AF v29,v23,v29
AF v29,v24,v29
C v51,v24,v25
AF v29,v25,v29
v_sub_f32 v10, v32, v14
v_sub_f32 v11, v36, v15
E v10,v10
E v11,v11
s_nop 0
MF v16,v10,v16
MF v17,v11,v17
G v64,a128
v_and_b32 v65, 0xffff0000, v64
v_lshlrev_b32 v64, 16, v64
MF v64,v10,v64
MF v65,v10,v65
C v64,v64,v65
W a128,v64
G v66,a129
v_and_b32 v67, 0xffff0000, v66
v_lshlrev_b32 v66, 16, v66
MF v66,v10,v66
MF v67,v10,v67
C v66,v66,v67
W a129,v66
G v68,a130
v_and_b32 v69, 0xffff0000, v68
v_lshlrev_b32 v68, 16, v68
MF v68,v10,v68
MF v69,v10,v69
C v68,v68,v69
W a130,v68
G v70,a131
v_and_b32 v71, 0xffff0000, v70
v_lshlrev_b32 v70, 16, v70
MF v70,v10,v70
MF v71,v10,v71
C v70,v70,v71
W a131,v70
G v72,a132
v_and_b32 v73, 0xffff0000, v72
v_lshlrev_b32 v72, 16, v72
MF v72,v10,v72
MF v73,v10,v73
C v72,v72,v73
W a132,v72
G v74,a133
v_and_b32 v75, 0xffff0000, v74
v_lshlrev_b32 v74, 16, v74
MF v74,v10,v74
MF v75,v10,v75
C v74,v74,v75
W a133,v74
G v76,a134
v_and_b32 v77, 0xffff0000, v76
v_lshlrev_b32 v76, 16, v76
MF v76,v10,v76
MF v77,v10,v77
C v76,v76,v77
W a134,v76
G v78,a135
v_and_b32 v79, 0xffff0000, v78
v_lshlrev_b32 v78, 16, v78
MF v78,v10,v78
MF v79,v10,v79
C v78,v78,v79
W a135,v78
G v64,a136
v_and_b32 v65, 0xffff0000, v64
v_lshlrev_b32 v64, 16, v64
MF v64,v10,v64
MF v65,v10,v65
C v64,v64,v65
W a136,v64
G v66,a137
v_and_b32 v67, 0xffff0000, v66
v_lshlrev_b32 v66, 16, v66
MF v66,v10,v66
MF v67,v10,v67
C v66,v66,v67
W a137,v66
G v68,a138
v_and_b32 v69, 0xffff0000, v68
v_lshlrev_b32 v68, 16, v68
MF v68,v10,v68
MF v69,v10,v69
C v68,v68,v69
W a138,v68
G v70,a139
v_and_b32 v71, 0xffff0000, v70
v_lshlrev_b32 v70, 16, v70
MF v70,v10,v70
MF v71,v10,v71
C v70,v70,v71
W a139,v70
G v72,a140
v_and_b32 v73, 0xffff0000, v72
v_lshlrev_b32 v72, 16, v72
MF v72,v10,v72
MF v73,v10,v73
C v72,v72,v73
W a140,v72
G v74,a141
v_and_b32 v75, 0xffff0000, v74
v_lshlrev_b32 v74, 16, v74
MF v74,v10,v74
MF v75,v10,v75
C v74,v74,v75
W a141,v74
G v76,a142
v_and_b32 v77, 0xffff0000, v76
v_lshlrev_b32 v76, 16, v76
MF v76,v10,v76
MF v77,v10,v77
C v76,v76,v77
W a142,v76
G v78,a143
v_and_b32 v79, 0xffff0000, v78
v_lshlrev_b32 v78, 16, v78
MF v78,v10,v78
MF v79,v10,v79
C v78,v78,v79
W a143,v78
G v64,a144
v_and_b32 v65, 0xffff0000, v64
v_lshlrev_b32 v64, 16, v64
MF v64,v10,v64
MF v65,v10,v65
C v64,v64,v65
W a144,v64
G v66,a145
v_and_b32 v67, 0xffff0000, v66
v_lshlrev_b32 v66, 16, v66
MF v66,v10,v66
MF v67,v10,v67
C v66,v66,v67
W a145,v66
G v68,a146
v_and_b32 v69, 0xffff0000, v68
v_lshlrev_b32 v68, 16, v68
MF v68,v10,v68
MF v69,v10,v69
C v68,v68,v69
W a146,v68
G v70,a147
v_and_b32 v71, 0xffff0000, v70
v_lshlrev_b32 v70, 16, v70
MF v70,v10,v70
MF v71,v10,v71
C v70,v70,v71
W a147,v70
G v72,a148
v_and_b32 v73, 0xffff0000, v72
v_lshlrev_b32 v72, 16, v72
MF v72,v10,v72
MF v73,v10,v73
C v72,v72,v73
W a148,v72
G v74,a149
v_and_b32 v75, 0xffff0000, v74
v_lshlrev_b32 v74, 16, v74
MF v74,v10,v74
MF v75,v10,v75
C v74,v74,v75
W a149,v74
G v76,a150
v_and_b32 v77, 0xffff0000, v76
v_lshlrev_b32 v76, 16, v76
MF v76,v10,v76
MF v77,v10,v77
C v76,v76,v77
W a150,v76
G v78,a151
v_and_b32 v79, 0xffff0000, v78
v_lshlrev_b32 v78, 16, v78
MF v78,v10,v78
MF v79,v10,v79
C v78,v78,v79
W a151,v78
G v64,a152
v_and_b32 v65, 0xffff0000, v64
v_lshlrev_b32 v64, 16, v64
MF v64,v10,v64
MF v65,v10,v65
C v64,v64,v65
W a152,v64
G v66,a153
v_and_b32 v67, 0xffff0000, v66
v_lshlrev_b32 v66, 16, v66
MF v66,v10,v66
MF v67,v10,v67
C v66,v66,v67
W a153,v66
G v68,a154
v_and_b32 v69, 0xffff0000, v68
v_lshlrev_b32 v68, 16, v68
MF v68,v10,v68
MF v69,v10,v69
C v68,v68,v69
W a154,v68
G v70,a155
v_and_b32 v71, 0xffff0000, v70
v_lshlrev_b32 v70, 16, v70
MF v70,v10,v70
MF v71,v10,v71
C v70,v70,v71
W a155,v70
G v72,a156
v_and_b32 v73, 0xffff0000, v72
v_lshlrev_b32 v72, 16, v72
MF v72,v10,v72
MF v73,v10,v73
C v72,v72,v73
W a156,v72
G v74,a157
v_and_b32 v75, 0xffff0000, v74
v_lshlrev_b32 v74, 16, v74
MF v74,v10,v74
MF v75,v10,v75
C v74,v74,v75
W a157,v74
G v76,a158
v_and_b32 v77, 0xffff0000, v76
v_lshlrev_b32 v76, 16, v76
MF v76,v10,v76
MF v77,v10,v77
C v76,v76,v77
W a158,v76
G v78,a159
v_and_b32 v79, 0xffff0000, v78
v_lshlrev_b32 v78, 16, v78
MF v78,v10,v78
MF v79,v10,v79
C v78,v78,v79
W a159,v78
G v64,a160
v_and_b32 v65, 0xffff0000, v64
v_lshlrev_b32 v64, 16, v64
MF v64,v11,v64
MF v65,v11,v65
C v64,v64,v65
W a160,v64
G v66,a161
v_and_b32 v67, 0xffff0000, v66
v_lshlrev_b32 v66, 16, v66
MF v66,v11,v66
MF v67,v11,v67
C v66,v66,v67
W a161,v66
G v68,a162
v_and_b32 v69, 0xffff0000, v68
v_lshlrev_b32 v68, 16, v68
MF v68,v11,v68
MF v69,v11,v69
C v68,v68,v69
W a162,v68
G v70,a163
v_and_b32 v71, 0xffff0000, v70
v_lshlrev_b32 v70, 16, v70
MF v70,v11,v70
MF v71,v11,v71
C v70,v70,v71
W a163,v70
G v72,a164
v_and_b32 v73, 0xffff0000, v72
v_lshlrev_b32 v72, 16, v72
MF v72,v11,v72
MF v73,v11,v73
C v72,v72,v73
W a164,v72
G v74,a165
v_and_b32 v75, 0xffff0000, v74
v_lshlrev_b32 v74, 16, v74
MF v74,v11,v74
MF v75,v11,v75
C v74,v74,v75
W a165,v74
G v76,a166
v_and_b32 v77, 0xffff0000, v76
v_lshlrev_b32 v76, 16, v76
MF v76,v11,v76
MF v77,v11,v77
C v76,v76,v77
W a166,v76
G v78,a167
v_and_b32 v79, 0xffff0000, v78
v_lshlrev_b32 v78, 16, v78
MF v78,v11,v78
MF v79,v11,v79
C v78,v78,v79
W a167,v78
G v64,a168
v_and_b32 v65, 0xffff0000, v64
v_lshlrev_b32 v64, 16, v64
MF v64,v11,v64
MF v65,v11,v65
C v64,v64,v65
W a168,v64
G v66,a169
v_and_b32 v67, 0xffff0000, v66
v_lshlrev_b32 v66, 16, v66
MF v66,v11,v66
MF v67,v11,v67
C v66,v66,v67
W a169,v66
G v68,a170
v_and_b32 v69, 0xffff0000, v68
v_lshlrev_b32 v68, 16, v68
MF v68,v11,v68
MF v69,v11,v69
C v68,v68,v69
W a170,v68
G v70,a171
v_and_b32 v71, 0xffff0000, v70
v_lshlrev_b32 v70, 16, v70
MF v70,v11,v70
MF v71,v11,v71
C v70,v70,v71
W a171,v70
G v72,a172
v_and_b32 v73, 0xffff0000, v72
v_lshlrev_b32 v72, 16, v72
MF v72,v11,v72
MF v73,v11,v73
C v72,v72,v73
W a172,v72
G v74,a173
v_and_b32 v75, 0xffff0000, v74
v_lshlrev_b32 v74, 16, v74
MF v74,v11,v74
MF v75,v11,v75
C v74,v74,v75
W a173,v74
G v76,a174
v_and_b32 v77, 0xffff0000, v76
v_lshlrev_b32 v76, 16, v76
MF v76,v11,v76
MF v77,v11,v77
C v76,v76,v77
W a174,v76
G v78,a175
v_and_b32 v79, 0xffff0000, v78
v_lshlrev_b32 v78, 16, v78
MF v78,v11,v78
MF v79,v11,v79
C v78,v78,v79
W a175,v78
G v64,a176
v_and_b32 v65, 0xffff0000, v64
v_lshlrev_b32 v64, 16, v64
MF v64,v11,v64
MF v65,v11,v65
C v64,v64,v65
W a176,v64
G v66,a177
v_and_b32 v67, 0xffff0000, v66
v_lshlrev_b32 v66, 16, v66
MF v66,v11,v66
MF v67,v11,v67
C v66,v66,v67
W a177,v66
G v68,a178
v_and_b32 v69, 0xffff0000, v68
v_lshlrev_b32 v68, 16, v68
MF v68,v11,v68
MF v69,v11,v69
C v68,v68,v69
W a178,v68
G v70,a179
v_and_b32 v71, 0xffff0000, v70
v_lshlrev_b32 v70, 16, v70
MF v70,v11,v70
MF v71,v11,v71
C v70,v70,v71
W a179,v70
G v72,a180
v_and_b32 v73, 0xffff0000, v72
v_lshlrev_b32 v72, 16, v72
MF v72,v11,v72
MF v73,v11,v73
C v72,v72,v73
W a180,v72
G v74,a181
v_and_b32 v75, 0xffff0000, v74
v_lshlrev_b32 v74, 16, v74
MF v74,v11,v74
MF v75,v11,v75
C v74,v74,v75
W a181,v74
G v76,a182
v_and_b32 v77, 0xffff0000, v76
v_lshlrev_b32 v76, 16, v76
MF v76,v11,v76
MF v77,v11,v77
C v76,v76,v77
W a182,v76
G v78,a183
v_and_b32 v79, 0xffff0000, v78
v_lshlrev_b32 v78, 16, v78
MF v78,v11,v78
MF v79,v11,v79
C v78,v78,v79
W a183,v78
G v64,a184
v_and_b32 v65, 0xffff0000, v64
v_lshlrev_b32 v64, 16, v64
MF v64,v11,v64
MF v65,v11,v65
C v64,v64,v65
W a184,v64
G v66,a185
v_and_b32 v67, 0xffff0000, v66
v_lshlrev_b32 v66, 16, v66
MF v66,v11,v66
MF v67,v11,v67
C v66,v66,v67
W a185,v66
G v68,a186
v_and_b32 v69, 0xffff0000, v68
v_lshlrev_b32 v68, 16, v68
MF v68,v11,v68
MF v69,v11,v69
C v68,v68,v69
W a186,v68
G v70,a187
v_and_b32 v71, 0xffff0000, v70
v_lshlrev_b32 v70, 16, v70
MF v70,v11,v70
MF v71,v11,v71
C v70,v70,v71
W a187,v70
G v72,a188
v_and_b32 v73, 0xffff0000, v72
v_lshlrev_b32 v72, 16, v72
MF v72,v11,v72
MF v73,v11,v73
C v72,v72,v73
W a188,v72
G v74,a189
v_and_b32 v75, 0xffff0000, v74
v_lshlrev_b32 v74, 16, v74
MF v74,v11,v74
MF v75,v11,v75
C v74,v74,v75
W a189,v74
G v76,a190
v_and_b32 v77, 0xffff0000, v76
v_lshlrev_b32 v76, 16, v76
MF v76,v11,v76
MF v77,v11,v77
C v76,v76,v77
W a190,v76
G v78,a191
v_and_b32 v79, 0xffff0000, v78
v_lshlrev_b32 v78, 16, v78
MF v78,v11,v78
MF v79,v11,v79
C v78,v78,v79
W a191,v78
s_nop 3
s_setpc_b64 s[36:37]
L_zs0:
s_mov_b32 s64, 65536
L_zs0_l:
s_sleep 2
buffer_load_dword v17, v16, s[12:15], 0 offen sc1
s_sub_u32 s64, s64, 1
s_cbranch_scc1 L_zs0_x
s_waitcnt vmcnt(0)
v_cmp_ne_u32 vcc, 1, v17
s_nop 0
s_cbranch_vccnz L_zs0_l
L_zs0_x:
s_waitcnt vmcnt(0)
s_branch L_zr0
L_zs1:
s_mov_b32 s64, 65536
L_zs1_l:
s_sleep 2
buffer_load_dword v17, v16, s[12:15], 0 offen sc1
s_sub_u32 s64, s64, 1
s_cbranch_scc1 L_zs1_x
s_waitcnt vmcnt(0)
v_cmp_ne_u32 vcc, 1, v17
s_nop 0
s_cbranch_vccnz L_zs1_l
L_zs1_x:
s_waitcnt vmcnt(0)
s_branch L_zr1
L_hs:
s_mov_b32 s91, 65536
L_hs_l:
buffer_load_dwordx4 v[16:19], v7, s[8:11], s67 offen offset:0 sc1
buffer_load_dwordx4 v[20:23], v7, s[8:11], s67 offen offset:1024 sc1
s_waitcnt vmcnt(0)
s_sub_u32 s91, s91, 1
s_cbranch_scc1 L_hr
v_min3_u32 v28, v16, v17, v18
v_min3_u32 v28, v28, v19, v20
v_min3_u32 v28, v28, v21, v22
v_min_u32 v28, v28, v23
v_cmp_eq_u32 vcc, 0, v28
s_nop 0
s_cbranch_vccnz L_hs_l
s_branch L_hr
L_lsj0:
s_mov_b32 s91, 65536
L_lsj0_l:
s_sleep 2
buffer_load_dword v5, v17, s[8:11], s46 offen sc1
s_sub_u32 s91, s91, 1
s_cbranch_scc1 L_lsj0_x
s_waitcnt vmcnt(0)
v_cmp_gt_u32 vcc, 2, v5
s_nop 0
s_cbranch_vccnz L_lsj0_l
L_lsj0_x:
s_waitcnt vmcnt(0)
s_branch L_lrj0
L_lsh2:
s_mov_b32 s91, 65536
L_lsh2_l:
s_sleep 2
buffer_load_dword v5, v17, s[8:11], s46 offen sc1
s_sub_u32 s91, s91, 1
s_cbranch_scc1 L_lsh2_x
s_waitcnt vmcnt(0)
v_cmp_gt_u32 vcc, 2, v5
s_nop 0
s_cbranch_vccnz L_lsh2_l
L_lsh2_x:
s_waitcnt vmcnt(0)
s_branch L_lrh2
L_lsh4:
s_mov_b32 s91, 65536
L_lsh4_l:
s_sleep 2
buffer_load_dword v5, v9, s[8:11], s46 offen sc1
s_sub_u32 s91, s91, 1
s_cbranch_scc1 L_lsh4_x
s_waitcnt vmcnt(0)
v_cmp_gt_u32 vcc, s84, v5
s_nop 0
s_cbranch_vccnz L_lsh4_l
L_lsh4_x:
s_waitcnt vmcnt(0)
s_branch L_lrh4
L_wsq0:
s_mov_b32 s91, 65536
L_wsq0_l:
s_sleep 2
buffer_load_dword v5, v31, s[8:11], s46 offen offset:4 sc1
s_sub_u32 s91, s91, 1
s_cbranch_scc1 L_wsq0_x
s_waitcnt vmcnt(0)
v_cmp_ne_u32 vcc, 1, v5
s_nop 0
s_mov_b32 vcc_hi, 0
s_cbranch_vccnz L_wsq0_l
L_wsq0_x:
s_waitcnt vmcnt(0)
s_branch L_wrq0
L_wsr0:
s_mov_b32 s91, 65536
L_wsr0_l:
s_sleep 2
buffer_load_dword v5, v31, s[8:11], s46 offen offset:4 sc1
s_sub_u32 s91, s91, 1
s_cbranch_scc1 L_wsr0_x
s_waitcnt vmcnt(0)
v_cmp_ne_u32 vcc, 1, v5
s_nop 0
s_mov_b32 vcc_lo, 0
s_cbranch_vccnz L_wsr0_l
L_wsr0_x:
s_waitcnt vmcnt(0)
s_branch L_wrr0
L_wsq1:
s_mov_b32 s91, 65536
L_wsq1_l:
s_sleep 2
buffer_load_dword v5, v31, s[8:11], s46 offen offset:4 sc1
s_sub_u32 s91, s91, 1
s_cbranch_scc1 L_wsq1_x
s_waitcnt vmcnt(0)
v_cmp_ne_u32 vcc, 1, v5
s_nop 0
s_mov_b32 vcc_hi, 0
s_cbranch_vccnz L_wsq1_l
L_wsq1_x:
s_waitcnt vmcnt(0)
s_branch L_wrq1
L_wsr1:
s_mov_b32 s91, 65536
L_wsr1_l:
s_sleep 2
buffer_load_dword v5, v31, s[8:11], s46 offen offset:4 sc1
s_sub_u32 s91, s91, 1
s_cbranch_scc1 L_wsr1_x
s_waitcnt vmcnt(0)
v_cmp_ne_u32 vcc, 1, v5
s_nop 0
s_mov_b32 vcc_lo, 0
s_cbranch_vccnz L_wsr1_l
L_wsr1_x:
s_waitcnt vmcnt(0)
s_branch L_wrr1
L_fll:
s_sub_u32 s65, s7, s40
s_mov_b32 s64, -1
s_cmp_eq_u32 s65, 1
s_cbranch_scc1 L_fl2
s_cmp_lg_u32 s20, 0
s_cbranch_scc1 L_fl3
s_lshr_b32 s64, s42, 3
s_cmp_eq_u32 s7, s64
s_cbranch_scc0 L_fl1
v_mov_b32 v15, 4
buffer_store_dword v15, v1, s[8:11], s45 offen sc1
L_fl1:
s_cmp_lg_u32 s65, 0
s_cbranch_scc1 L_fllr
s_movk_i32 s64, 0x380
L_fl2:
v_min_u32 v17, s64, v9
s_mov_b32 s6, 4
buffer_load_dword v5, v17, s[8:11], s46 offen sc1
s_bitcmp1_b32 s39, 15
s_cbranch_scc0 L_fllr
L_fl3:
s_cmp_eq_u32 s7, 1
s_cbranch_scc1 L_y2
s_cmp_eq_u32 s7, 2
s_cbranch_scc1 L_y3
s_cmp_eq_u32 s7, 3
s_cbranch_scc1 L_y4
s_branch L_y5
s_waitcnt vmcnt(0)
L_fps:
s_cmp_lg_u32 s35, 0
s_cbranch_scc1 L_fpr
L_fps2:
s_mov_b32 s91, 65536
L_fps2_l:
s_sleep 2
buffer_load_dword v6, off, s[8:11], s47 sc1
s_sub_u32 s91, s91, 1
s_cbranch_scc1 L_fps2_x
s_waitcnt vmcnt(0)
v_cmp_ne_u32 vcc, 1, v6
s_nop 0
s_cbranch_vccnz L_fps2_l
L_fps2_x:
s_waitcnt vmcnt(0)
s_branch L_fpr
L_fqs:
s_mov_b32 s91, 65536
L_fqs_l:
s_sleep 2
buffer_load_dword v6, off, s[8:11], s47 offset:16 sc1
s_sub_u32 s91, s91, 1
s_cbranch_scc1 L_fqs_x
s_waitcnt vmcnt(0)
v_cmp_ne_u32 vcc, 1, v6
s_nop 0
s_cbranch_vccnz L_fqs_l
L_fqs_x:
s_waitcnt vmcnt(0)
s_branch L_fqr
L_fls0:
s_mov_b32 s91, 65536
L_fls0_l:
s_sleep 2
buffer_load_dword v5, v17, s[8:11], s46 offen sc1
s_sub_u32 s91, s91, 1
s_cbranch_scc1 L_fls0_x
s_waitcnt vmcnt(0)
v_cmp_gt_u32 vcc, s6, v5
s_nop 0
s_cbranch_vccnz L_fls0_l
L_fls0_x:
s_waitcnt vmcnt(0)
s_branch L_flr0
L_y2:
v_lshrrev_b32 v11, 7, v7
v_mul_u32_u24 v11, 4352, v11
v_and_b32 v12, 0x70, v7
v_lshl_add_u32 v11, v12, 3, v11
s_mov_b32 s64, 104923136
s_mov_b32 s65, 104957952
buffer_load_dword a128, v11, s[8:11], s64 offen sc1
buffer_load_dword a129, v11, s[8:11], s65 offen sc1
s_branch L_fllr
s_waitcnt vmcnt(0)
L_y3:
s_mov_b32 s91, 65536
L_y3c:
G v12,a128
G v13,a129
v_min_u32 v12, v12, v13
v_cmp_gt_u32 vcc, 2, v12
s_sub_u32 s91, s91, 1
s_cbranch_scc1 L_y3x
s_cbranch_vccz L_y3x
v_lshrrev_b32 v11, 7, v7
v_mul_u32_u24 v11, 4352, v11
v_and_b32 v12, 0x70, v7
v_lshl_add_u32 v11, v12, 3, v11
s_mov_b32 s64, 104923136
s_mov_b32 s65, 104957952
buffer_load_dword a128, v11, s[8:11], s64 offen sc1
buffer_load_dword a129, v11, s[8:11], s65 offen sc1
s_waitcnt vmcnt(0)
s_branch L_y3c
L_y3x:
s_lshl_b32 s66, s41, 1
SA s66,s66,s20
s_sub_u32 s66, s66, 2
s_cmp_lt_u32 s66, 14
s_cselect_b32 s64, 8, 12
SA s64,s64,104890368
buffer_load_dword a130, off, s[8:11], s64 sc1
v_lshrrev_b32 v11, 7, v7
v_mul_u32_u24 v11, 3584, v11
v_and_b32 v12, 0x70, v7
v_add_u32 v11, v12, v11
s_lshl_b32 s65, s66, 7
SA s65,s65,105906176
buffer_load_dwordx4 a[132:135], v11, s[8:11], s65 offen sc1
SA s65,s65,28672
buffer_load_dwordx4 a[136:139], v11, s[8:11], s65 offen sc1
SA s65,s65,28672
buffer_load_dwordx4 a[140:143], v11, s[8:11], s65 offen sc1
SA s65,s65,28672
buffer_load_dwordx4 a[144:147], v11, s[8:11], s65 offen sc1
SA s65,s65,28672
buffer_load_dwordx4 a[148:151], v11, s[8:11], s65 offen sc1
SA s65,s65,28672
buffer_load_dwordx4 a[152:155], v11, s[8:11], s65 offen sc1
SA s65,s65,28672
buffer_load_dwordx4 a[156:159], v11, s[8:11], s65 offen sc1
SA s65,s65,28672
buffer_load_dwordx4 a[160:163], v11, s[8:11], s65 offen sc1
SA s65,s65,28672
buffer_load_dwordx4 a[164:167], v11, s[8:11], s65 offen sc1
SA s65,s65,28672
buffer_load_dwordx4 a[168:171], v11, s[8:11], s65 offen sc1
SA s65,s65,28672
buffer_load_dwordx4 a[172:175], v11, s[8:11], s65 offen sc1
SA s65,s65,28672
buffer_load_dwordx4 a[176:179], v11, s[8:11], s65 offen sc1
SA s65,s65,28672
buffer_load_dwordx4 a[180:183], v11, s[8:11], s65 offen sc1
SA s65,s65,28672
buffer_load_dwordx4 a[184:187], v11, s[8:11], s65 offen sc1
SA s65,s65,28672
s_branch L_fllr
s_waitcnt vmcnt(0)
L_y4:
G v12,a132
G v13,a133
G v14,a134
G v15,a135
G v16,a136
G v17,a137
AF v12,v16,v12
AF v13,v17,v13
G v16,a138
G v17,a139
AF v14,v16,v14
AF v15,v17,v15
G v16,a140
G v17,a141
AF v12,v16,v12
AF v13,v17,v13
G v16,a142
G v17,a143
AF v14,v16,v14
AF v15,v17,v15
G v16,a144
G v17,a145
AF v12,v16,v12
AF v13,v17,v13
G v16,a146
G v17,a147
AF v14,v16,v14
AF v15,v17,v15
G v16,a148
G v17,a149
AF v12,v16,v12
AF v13,v17,v13
G v16,a150
G v17,a151
AF v14,v16,v14
AF v15,v17,v15
G v16,a152
G v17,a153
AF v12,v16,v12
AF v13,v17,v13
G v16,a154
G v17,a155
AF v14,v16,v14
AF v15,v17,v15
G v16,a156
G v17,a157
AF v12,v16,v12
AF v13,v17,v13
G v16,a158
G v17,a159
AF v14,v16,v14
AF v15,v17,v15
G v16,a160
G v17,a161
AF v12,v16,v12
AF v13,v17,v13
G v16,a162
G v17,a163
AF v14,v16,v14
AF v15,v17,v15
G v16,a164
G v17,a165
AF v12,v16,v12
AF v13,v17,v13
G v16,a166
G v17,a167
AF v14,v16,v14
AF v15,v17,v15
G v16,a168
G v17,a169
AF v12,v16,v12
AF v13,v17,v13
G v16,a170
G v17,a171
AF v14,v16,v14
AF v15,v17,v15
G v16,a172
G v17,a173
AF v12,v16,v12
AF v13,v17,v13
G v16,a174
G v17,a175
AF v14,v16,v14
AF v15,v17,v15
G v16,a176
G v17,a177
AF v12,v16,v12
AF v13,v17,v13
G v16,a178
G v17,a179
AF v14,v16,v14
AF v15,v17,v15
G v16,a180
G v17,a181
AF v12,v16,v12
AF v13,v17,v13
G v16,a182
G v17,a183
AF v14,v16,v14
AF v15,v17,v15
G v16,a184
G v17,a185
AF v12,v16,v12
AF v13,v17,v13
G v16,a186
G v17,a187
AF v14,v16,v14
AF v15,v17,v15
v_add_f32 v12, v12, v12 row_ror:8 row_mask:0xf bank_mask:0xf
v_add_f32 v13, v13, v13 row_ror:8 row_mask:0xf bank_mask:0xf
v_add_f32 v14, v14, v14 row_ror:8 row_mask:0xf bank_mask:0xf
v_add_f32 v15, v15, v15 row_ror:8 row_mask:0xf bank_mask:0xf
v_mov_b32 v11, v12
s_nop 1
v_permlane16_swap_b32 v11, v12
AF v12,v11,v12
v_mov_b32 v11, v13
s_nop 1
v_permlane16_swap_b32 v11, v13
AF v13,v11,v13
v_mov_b32 v11, v14
s_nop 1
v_permlane16_swap_b32 v11, v14
AF v14,v11,v14
v_mov_b32 v11, v15
s_nop 1
v_permlane16_swap_b32 v11, v15
AF v15,v11,v15
v_mov_b32 v11, v12
s_nop 1
v_permlane32_swap_b32 v11, v12
AF v12,v11,v12
v_mov_b32 v11, v13
s_nop 1
v_permlane32_swap_b32 v11, v13
AF v13,v11,v13
v_mov_b32 v11, v14
s_nop 1
v_permlane32_swap_b32 v11, v14
AF v14,v11,v14
v_mov_b32 v11, v15
s_nop 1
v_permlane32_swap_b32 v11, v15
AF v15,v11,v15
G v16,a130
C v11,v12,v13
v_lshlrev_b32 v12, 16, v11
v_and_b32 v13, 0xffff0000, v11
C v11,v14,v15
v_lshlrev_b32 v14, 16, v11
v_and_b32 v15, 0xffff0000, v11
MF v12,v16,v12
MF v13,v16,v13
MF v14,v16,v14
MF v15,v16,v15
C v11,v12,v13
v_lshlrev_b32 v12, 16, v11
v_and_b32 v13, 0xffff0000, v11
C v11,v14,v15
v_lshlrev_b32 v14, 16, v11
v_and_b32 v15, 0xffff0000, v11
s_lshl_b32 s66, s41, 1
SA s66,s66,s20
s_sub_u32 s66, s66, 2
s_lshl_b32 s65, s66, 7
SA s65,s65,104898560
s_mov_b64 exec, 0xff
buffer_store_dwordx4 v[12:15], v7, s[8:11], s65 offen sc1
s_mov_b64 exec, -1
s_nop 1
s_branch L_fllr
L_y5:
s_lshl_b32 s66, s41, 1
SA s66,s66,s20
s_sub_u32 s66, s66, 2
s_lshl_b32 s66, s66, 2
SA s66,s66,105062912
v_mov_b32 v11, 1
s_mov_b64 exec, 1
buffer_store_dword v11, off, s[8:11], s66 sc1
s_mov_b64 exec, -1
s_branch L_fllr
.p2align 12
L_loop_top:
M v[64:67],a[64:67],a[0:3],v[32:35]
SA m0,s28,0
R a[96:99],v2,40960
M v[64:67],a[68:71],a[4:7],v[64:67]
buffer_load_dword a240, v0, s[60:63], 0 offen offset:0
M v[64:67],a[72:75],a[8:11],v[64:67]
R a[100:103],v2,41984
M v[64:67],a[76:79],a[12:15],v[64:67]
s_waitcnt lgkmcnt(2)
buffer_load_dwordx4 v3, s[8:11], s26 offen offset:0 sc1 lds
M v[64:67],a[80:83],a[16:19],v[64:67]
R a[104:107],v2,43008
M v[64:67],a[84:87],a[20:23],v[64:67]
E v18,v112
M v[64:67],a[88:91],a[24:27],v[64:67]
R a[108:111],v2,44032
M v[64:67],a[92:95],a[28:31],v[64:67]
buffer_load_dwordx4 v3, s[8:11], s26 offen offset:1024 sc1 lds
M v[68:71],a[92:95],a[60:63],v[36:39]
R a[112:115],v2,45056
M v[68:71],a[88:91],a[56:59],v[68:71]
E v19,v113
M v[68:71],a[84:87],a[52:55],v[68:71]
R a[116:119],v2,46080
AF v28,v18,v28
M v[68:71],a[80:83],a[48:51],v[68:71]
E v20,v114
M v[68:71],a[76:79],a[44:47],v[68:71]
R a[120:123],v2,47104
C v56,v18,v19
M v[68:71],a[72:75],a[40:43],v[68:71]
buffer_load_dwordx4 v3, s[8:11], s26 offen offset:2048 sc1 lds
M v[68:71],a[68:71],a[36:39],v[68:71]
R a[124:127],v2,48128
AF v28,v19,v28
M v[68:71],a[64:67],a[32:35],v[68:71]
s_waitcnt lgkmcnt(4)
E v21,v115
M v[76:79],a[96:99],a[32:35],v[36:39]
R a[64:67],v2,49152
AF v28,v20,v28
M v[76:79],a[100:103],a[36:39],v[76:79]
buffer_load_dwordx4 v3, s[8:11], s26 offen offset:3072 sc1 lds
M v[76:79],a[104:107],a[40:43],v[76:79]
R a[68:71],v2,50176
C v57,v20,v21
M v[76:79],a[108:111],a[44:47],v[76:79]
s_waitcnt lgkmcnt(2)
E v22,v120
M v[76:79],a[112:115],a[48:51],v[76:79]
R a[72:75],v2,51200
AF v28,v21,v28
M v[76:79],a[116:119],a[52:55],v[76:79]
E v23,v121
M v[76:79],a[120:123],a[56:59],v[76:79]
SA m0,s28,4096
R a[76:79],v2,52224
AF v28,v22,v28
M v[76:79],a[124:127],a[60:63],v[76:79]
buffer_load_dwordx4 v4, s[8:11], s26 offen offset:0 sc1 lds
M v[72:75],a[124:127],a[28:31],v[32:35]
R a[80:83],v2,53248
C v58,v22,v23
M v[72:75],a[120:123],a[24:27],v[72:75]
E v24,v122
M v[72:75],a[116:119],a[20:23],v[72:75]
R a[84:87],v2,54272
AF v28,v23,v28
M v[72:75],a[112:115],a[16:19],v[72:75]
E v25,v123
M v[72:75],a[108:111],a[12:15],v[72:75]
R a[88:91],v2,55296
AF v28,v24,v28
M v[72:75],a[104:107],a[8:11],v[72:75]
buffer_load_dwordx4 v4, s[8:11], s26 offen offset:1024 sc1 lds
M v[72:75],a[100:103],a[4:7],v[72:75]
R a[92:95],v2,56320
C v59,v24,v25
M v[72:75],a[96:99],a[0:3],v[72:75]
s_waitcnt lgkmcnt(4)
E v18,v116
M v[80:83],a[64:67],a[0:3],v[32:35]
R a[96:99],v2,57344
AF v28,v25,v28
M v[80:83],a[68:71],a[4:7],v[80:83]
R a[100:103],v2,58368
M v[80:83],a[72:75],a[8:11],v[80:83]
buffer_load_dwordx4 v4, s[8:11], s26 offen offset:2048 sc1 lds
M v[80:83],a[76:79],a[12:15],v[80:83]
s_waitcnt lgkmcnt(2)
R a[104:107],v2,59392
M v[80:83],a[80:83],a[16:19],v[80:83]
R a[108:111],v2,60416
M v[80:83],a[84:87],a[20:23],v[80:83]
E v19,v117
M v[80:83],a[88:91],a[24:27],v[80:83]
R a[112:115],v2,61440
AF v29,v18,v29
M v[80:83],a[92:95],a[28:31],v[80:83]
R a[116:119],v2,62464
C v60,v18,v19
M v[84:87],a[92:95],a[60:63],v[36:39]
buffer_load_dwordx4 v4, s[8:11], s26 offen offset:3072 sc1 lds
M v[84:87],a[88:91],a[56:59],v[84:87]
SA s26,s26,32768
R a[120:123],v2,63488
AF v29,v19,v29
M v[84:87],a[84:87],a[52:55],v[84:87]
R a[124:127],v2,64512
M v[84:87],a[80:83],a[48:51],v[84:87]
E v20,v118
M v[84:87],a[76:79],a[44:47],v[84:87]
E v21,v119
M v[84:87],a[72:75],a[40:43],v[84:87]
E v22,v124
M v[84:87],a[68:71],a[36:39],v[84:87]
s_waitcnt vmcnt(17) lgkmcnt(0)
E v23,v125
M v[84:87],a[64:67],a[32:35],v[84:87]
s_barrier
M v[92:95],a[96:99],a[32:35],v[36:39]
R a[64:67],v7,32768
AF v29,v20,v29
M v[92:95],a[100:103],a[36:39],v[92:95]
E v24,v126
M v[92:95],a[104:107],a[40:43],v[92:95]
R a[68:71],v7,33792
C v61,v20,v21
M v[92:95],a[108:111],a[44:47],v[92:95]
AF v29,v21,v29
AF v29,v22,v29
M v[92:95],a[112:115],a[48:51],v[92:95]
R a[72:75],v7,34816
C v62,v22,v23
M v[92:95],a[116:119],a[52:55],v[92:95]
E v25,v127
M v[92:95],a[120:123],a[56:59],v[92:95]
R a[76:79],v7,35840
AF v29,v23,v29
M v[92:95],a[124:127],a[60:63],v[92:95]
AF v29,v24,v29
C v63,v24,v25
M v[88:91],a[124:127],a[28:31],v[32:35]
R a[80:83],v7,36864
AF v29,v25,v29
M v[88:91],a[120:123],a[24:27],v[88:91]
M v[88:91],a[116:119],a[20:23],v[88:91]
R a[84:87],v7,37888
v_max_f32 v10, v28, v29
M v[88:91],a[112:115],a[16:19],v[88:91]
v_cmp_lt_f32 vcc, s31, v10
M v[88:91],a[108:111],a[12:15],v[88:91]
R a[88:91],v7,38912
M v[88:91],a[104:107],a[8:11],v[88:91]
M v[88:91],a[100:103],a[4:7],v[88:91]
s_waitcnt lgkmcnt(3)
R a[92:95],v7,39936
M v[88:91],a[96:99],a[0:3],v[88:91]
s_cbranch_vccnz L_st1
L_rt1:
M v[128:131],a[64:67],v[48:51],v[128:131]
SA m0,s28,98304
R a[96:99],v7,40960
AF v30,v28,v30
M v[128:131],a[68:71],v[56:59],v[128:131]
buffer_load_dwordx4 v3, s[8:11], s21 offen offset:0 sc1 lds
M v[132:135],a[68:71],v[60:63],v[132:135]
R a[100:103],v7,41984
AF v31,v29,v31
M v[132:135],a[64:67],v[52:55],v[132:135]
s_waitcnt lgkmcnt(2)
E v18,v64
M v[140:143],a[72:75],v[52:55],v[140:143]
R a[104:107],v7,43008
M v[140:143],a[76:79],v[60:63],v[140:143]
buffer_load_dwordx4 v3, s[8:11], s21 offen offset:1024 sc1 lds
M v[136:139],a[76:79],v[56:59],v[136:139]
R a[108:111],v7,44032
M v[136:139],a[72:75],v[48:51],v[136:139]
E v19,v65
M v[144:147],a[80:83],v[48:51],v[144:147]
R a[112:115],v7,45056
AF v26,v18,v19
M v[144:147],a[84:87],v[56:59],v[144:147]
E v20,v66
M v[148:151],a[84:87],v[60:63],v[148:151]
R a[116:119],v7,46080
C v40,v18,v19
M v[148:151],a[80:83],v[52:55],v[148:151]
buffer_load_dwordx4 v3, s[8:11], s21 offen offset:2048 sc1 lds
M v[156:159],a[88:91],v[52:55],v[156:159]
R a[120:123],v7,47104
M v[156:159],a[92:95],v[60:63],v[156:159]
E v21,v67
M v[152:155],a[92:95],v[56:59],v[152:155]
R a[124:127],v7,48128
AF v26,v20,v26
M v[152:155],a[88:91],v[48:51],v[152:155]
s_waitcnt lgkmcnt(4)
buffer_load_dwordx4 v3, s[8:11], s21 offen offset:3072 sc1 lds
M v[160:163],a[96:99],v[48:51],v[160:163]
R a[64:67],v7,49152
C v41,v20,v21
M v[160:163],a[100:103],v[56:59],v[160:163]
E v22,v72
M v[164:167],a[100:103],v[60:63],v[164:167]
SA m0,s28,102400
R a[68:71],v7,50176
AF v26,v21,v26
M v[164:167],a[96:99],v[52:55],v[164:167]
s_waitcnt lgkmcnt(2)
buffer_load_dwordx4 v4, s[8:11], s21 offen offset:0 sc1 lds
M v[172:175],a[104:107],v[52:55],v[172:175]
R a[72:75],v7,51200
M v[172:175],a[108:111],v[60:63],v[172:175]
E v23,v73
M v[168:171],a[108:111],v[56:59],v[168:171]
R a[76:79],v7,52224
AF v26,v22,v26
M v[168:171],a[104:107],v[48:51],v[168:171]
E v24,v74
M v[176:179],a[112:115],v[48:51],v[176:179]
R a[80:83],v7,53248
C v42,v22,v23
M v[176:179],a[116:119],v[56:59],v[176:179]
buffer_load_dwordx4 v4, s[8:11], s21 offen offset:1024 sc1 lds
M v[180:183],a[116:119],v[60:63],v[180:183]
R a[84:87],v7,54272
AF v26,v23,v26
M v[180:183],a[112:115],v[52:55],v[180:183]
E v25,v75
M v[188:191],a[120:123],v[52:55],v[188:191]
R a[88:91],v7,55296
AF v26,v24,v26
M v[188:191],a[124:127],v[60:63],v[188:191]
buffer_load_dwordx4 v4, s[8:11], s21 offen offset:2048 sc1 lds
M v[184:187],a[124:127],v[56:59],v[184:187]
R a[92:95],v7,56320
C v43,v24,v25
M v[184:187],a[120:123],v[48:51],v[184:187]
s_waitcnt lgkmcnt(4)
E v18,v68
M v[192:195],a[64:67],v[48:51],v[192:195]
R a[96:99],v7,57344
AF v26,v25,v26
M v[192:195],a[68:71],v[56:59],v[192:195]
R a[100:103],v7,58368
M v[196:199],a[68:71],v[60:63],v[196:199]
buffer_load_dwordx4 v4, s[8:11], s21 offen offset:3072 sc1 lds
M v[196:199],a[64:67],v[52:55],v[196:199]
s_waitcnt lgkmcnt(2)
R a[104:107],v7,59392
M v[204:207],a[72:75],v[52:55],v[204:207]
SA s21,s21,32768
R a[108:111],v7,60416
M v[204:207],a[76:79],v[60:63],v[204:207]
s_sub_u32 s22, s22, 1
E v19,v69
M v[200:203],a[76:79],v[56:59],v[200:203]
s_cselect_b32 s21, s23, s21
R a[112:115],v7,61440
AF v27,v18,v19
M v[200:203],a[72:75],v[48:51],v[200:203]
R a[116:119],v7,62464
C v44,v18,v19
M v[208:211],a[80:83],v[48:51],v[208:211]
E v20,v70
M v[208:211],a[84:87],v[56:59],v[208:211]
R a[120:123],v7,63488
M v[212:215],a[84:87],v[60:63],v[212:215]
R a[124:127],v7,64512
M v[212:215],a[80:83],v[52:55],v[212:215]
E v21,v71
M v[220:223],a[88:91],v[52:55],v[220:223]
E v22,v76
M v[220:223],a[92:95],v[60:63],v[220:223]
AF v27,v20,v27
C v45,v20,v21
M v[216:219],a[92:95],v[56:59],v[216:219]
s_waitcnt vmcnt(17) lgkmcnt(0)
AF v27,v21,v27
M v[216:219],a[88:91],v[48:51],v[216:219]
s_barrier
M v[224:227],a[96:99],v[48:51],v[224:227]
R a[64:67],v2,0
M v[224:227],a[100:103],v[56:59],v[224:227]
E v23,v77
M v[228:231],a[100:103],v[60:63],v[228:231]
R a[68:71],v2,1024
AF v27,v22,v27
M v[228:231],a[96:99],v[52:55],v[228:231]
E v24,v78
M v[236:239],a[104:107],v[52:55],v[236:239]
R a[72:75],v2,2048
C v46,v22,v23
M v[236:239],a[108:111],v[60:63],v[236:239]
AF v27,v23,v27
M v[232:235],a[108:111],v[56:59],v[232:235]
R a[76:79],v2,3072
M v[232:235],a[104:107],v[48:51],v[232:235]
E v25,v79
M v[240:243],a[112:115],v[48:51],v[240:243]
R a[80:83],v2,4096
AF v27,v24,v27
M v[240:243],a[116:119],v[56:59],v[240:243]
C v47,v24,v25
AF v27,v25,v27
M v[244:247],a[116:119],v[60:63],v[244:247]
R a[84:87],v2,5120
M v[244:247],a[112:115],v[52:55],v[244:247]
M v[252:255],a[120:123],v[52:55],v[252:255]
R a[88:91],v2,6144
M v[252:255],a[124:127],v[60:63],v[252:255]
M v[248:251],a[124:127],v[56:59],v[248:251]
s_waitcnt lgkmcnt(3)
R a[92:95],v2,7168
M v[248:251],a[120:123],v[48:51],v[248:251]
M v[96:99],a[64:67],a[0:3],v[32:35]
s_bitcmp1_b32 s39, s7
R a[96:99],v2,8192
M v[96:99],a[68:71],a[4:7],v[96:99]
s_cbranch_scc1 L_fll
L_fllr:
E v18,v80
M v[96:99],a[72:75],a[8:11],v[96:99]
SA m0,s28,32768
R a[100:103],v2,9216
M v[96:99],a[76:79],a[12:15],v[96:99]
s_waitcnt lgkmcnt(2)
buffer_load_dwordx4 v3, s[8:11], s26 offen offset:0 sc1 lds
M v[96:99],a[80:83],a[16:19],v[96:99]
R a[104:107],v2,10240
M v[96:99],a[84:87],a[20:23],v[96:99]
E v19,v81
M v[96:99],a[88:91],a[24:27],v[96:99]
R a[108:111],v2,11264
AF v26,v18,v26
M v[96:99],a[92:95],a[28:31],v[96:99]
E v20,v82
M v[100:103],a[92:95],a[60:63],v[36:39]
R a[112:115],v2,12288
C v56,v18,v19
M v[100:103],a[88:91],a[56:59],v[100:103]
buffer_load_dwordx4 v3, s[8:11], s26 offen offset:1024 sc1 lds
M v[100:103],a[84:87],a[52:55],v[100:103]
R a[116:119],v2,13312
AF v26,v19,v26
M v[100:103],a[80:83],a[48:51],v[100:103]
E v21,v83
M v[100:103],a[76:79],a[44:47],v[100:103]
R a[120:123],v2,14336
AF v26,v20,v26
M v[100:103],a[72:75],a[40:43],v[100:103]
buffer_load_dwordx4 v3, s[8:11], s26 offen offset:2048 sc1 lds
M v[100:103],a[68:71],a[36:39],v[100:103]
R a[124:127],v2,15360
C v57,v20,v21
M v[100:103],a[64:67],a[32:35],v[100:103]
s_waitcnt lgkmcnt(4)
E v22,v88
M v[108:111],a[96:99],a[32:35],v[36:39]
R a[64:67],v2,16384
AF v26,v21,v26
M v[108:111],a[100:103],a[36:39],v[108:111]
E v23,v89
M v[108:111],a[104:107],a[40:43],v[108:111]
R a[68:71],v2,17408
AF v26,v22,v26
M v[108:111],a[108:111],a[44:47],v[108:111]
s_waitcnt lgkmcnt(2)
buffer_load_dwordx4 v3, s[8:11], s26 offen offset:3072 sc1 lds
M v[108:111],a[112:115],a[48:51],v[108:111]
R a[72:75],v2,18432
C v58,v22,v23
M v[108:111],a[116:119],a[52:55],v[108:111]
E v24,v90
M v[108:111],a[120:123],a[56:59],v[108:111]
R a[76:79],v2,19456
AF v26,v23,v26
M v[108:111],a[124:127],a[60:63],v[108:111]
SA m0,s28,36864
M v[104:107],a[124:127],a[28:31],v[32:35]
R a[80:83],v2,20480
M v[104:107],a[120:123],a[24:27],v[104:107]
buffer_load_dwordx4 v4, s[8:11], s26 offen offset:0 sc1 lds
M v[104:107],a[116:119],a[20:23],v[104:107]
R a[84:87],v2,21504
M v[104:107],a[112:115],a[16:19],v[104:107]
E v25,v91
M v[104:107],a[108:111],a[12:15],v[104:107]
R a[88:91],v2,22528
AF v26,v24,v26
M v[104:107],a[104:107],a[8:11],v[104:107]
buffer_load_dwordx4 v4, s[8:11], s26 offen offset:1024 sc1 lds
M v[104:107],a[100:103],a[4:7],v[104:107]
R a[92:95],v2,23552
C v59,v24,v25
M v[104:107],a[96:99],a[0:3],v[104:107]
s_waitcnt lgkmcnt(4)
E v18,v84
M v[112:115],a[64:67],a[0:3],v[32:35]
R a[96:99],v2,24576
AF v26,v25,v26
M v[112:115],a[68:71],a[4:7],v[112:115]
R a[100:103],v2,25600
M v[112:115],a[72:75],a[8:11],v[112:115]
buffer_load_dwordx4 v4, s[8:11], s26 offen offset:2048 sc1 lds
M v[112:115],a[76:79],a[12:15],v[112:115]
s_waitcnt lgkmcnt(2)
R a[104:107],v2,26624
M v[112:115],a[80:83],a[16:19],v[112:115]
R a[108:111],v2,27648
M v[112:115],a[84:87],a[20:23],v[112:115]
E v19,v85
M v[112:115],a[88:91],a[24:27],v[112:115]
R a[112:115],v2,28672
AF v27,v18,v27
M v[112:115],a[92:95],a[28:31],v[112:115]
R a[116:119],v2,29696
C v60,v18,v19
M v[116:119],a[92:95],a[60:63],v[36:39]
buffer_load_dwordx4 v4, s[8:11], s26 offen offset:3072 sc1 lds
M v[116:119],a[88:91],a[56:59],v[116:119]
SA s26,s26,32768
R a[120:123],v2,30720
AF v27,v19,v27
M v[116:119],a[84:87],a[52:55],v[116:119]
R a[124:127],v2,31744
M v[116:119],a[80:83],a[48:51],v[116:119]
E v20,v86
M v[116:119],a[76:79],a[44:47],v[116:119]
E v21,v87
M v[116:119],a[72:75],a[40:43],v[116:119]
E v22,v92
M v[116:119],a[68:71],a[36:39],v[116:119]
s_waitcnt vmcnt(16) lgkmcnt(0)
E v23,v93
M v[116:119],a[64:67],a[32:35],v[116:119]
s_barrier
M v[124:127],a[96:99],a[32:35],v[36:39]
R a[64:67],v7,0
AF v27,v20,v27
M v[124:127],a[100:103],a[36:39],v[124:127]
E v24,v94
M v[124:127],a[104:107],a[40:43],v[124:127]
R a[68:71],v7,1024
C v61,v20,v21
M v[124:127],a[108:111],a[44:47],v[124:127]
AF v27,v21,v27
AF v27,v22,v27
M v[124:127],a[112:115],a[48:51],v[124:127]
R a[72:75],v7,2048
C v62,v22,v23
M v[124:127],a[116:119],a[52:55],v[124:127]
E v25,v95
M v[124:127],a[120:123],a[56:59],v[124:127]
R a[76:79],v7,3072
AF v27,v23,v27
M v[124:127],a[124:127],a[60:63],v[124:127]
AF v27,v24,v27
C v63,v24,v25
M v[120:123],a[124:127],a[28:31],v[32:35]
R a[80:83],v7,4096
AF v27,v25,v27
M v[120:123],a[120:123],a[24:27],v[120:123]
M v[120:123],a[116:119],a[20:23],v[120:123]
R a[84:87],v7,5120
v_max_f32 v10, v26, v27
M v[120:123],a[112:115],a[16:19],v[120:123]
v_cmp_lt_f32 vcc, s31, v10
M v[120:123],a[108:111],a[12:15],v[120:123]
R a[88:91],v7,6144
M v[120:123],a[104:107],a[8:11],v[120:123]
M v[120:123],a[100:103],a[4:7],v[120:123]
s_waitcnt lgkmcnt(3)
R a[92:95],v7,7168
M v[120:123],a[96:99],a[0:3],v[120:123]
s_cbranch_vccnz L_st0
L_rt0:
M v[128:131],a[64:67],v[40:43],v[128:131]
SA m0,s28,65536
R a[96:99],v7,8192
AF v30,v26,v30
M v[128:131],a[68:71],v[56:59],v[128:131]
buffer_load_dwordx4 v3, s[8:11], s21 offen offset:0 sc1 lds
M v[132:135],a[68:71],v[60:63],v[132:135]
R a[100:103],v7,9216
AF v31,v27,v31
M v[132:135],a[64:67],v[44:47],v[132:135]
s_waitcnt lgkmcnt(2)
E v18,v96
M v[140:143],a[72:75],v[44:47],v[140:143]
R a[104:107],v7,10240
M v[140:143],a[76:79],v[60:63],v[140:143]
buffer_load_dwordx4 v3, s[8:11], s21 offen offset:1024 sc1 lds
M v[136:139],a[76:79],v[56:59],v[136:139]
R a[108:111],v7,11264
M v[136:139],a[72:75],v[40:43],v[136:139]
E v19,v97
M v[144:147],a[80:83],v[40:43],v[144:147]
R a[112:115],v7,12288
AF v28,v18,v19
M v[144:147],a[84:87],v[56:59],v[144:147]
E v20,v98
M v[148:151],a[84:87],v[60:63],v[148:151]
R a[116:119],v7,13312
C v48,v18,v19
M v[148:151],a[80:83],v[44:47],v[148:151]
buffer_load_dwordx4 v3, s[8:11], s21 offen offset:2048 sc1 lds
M v[156:159],a[88:91],v[44:47],v[156:159]
R a[120:123],v7,14336
M v[156:159],a[92:95],v[60:63],v[156:159]
E v21,v99
M v[152:155],a[92:95],v[56:59],v[152:155]
R a[124:127],v7,15360
AF v28,v20,v28
M v[152:155],a[88:91],v[40:43],v[152:155]
s_waitcnt lgkmcnt(4)
buffer_load_dwordx4 v3, s[8:11], s21 offen offset:3072 sc1 lds
M v[160:163],a[96:99],v[40:43],v[160:163]
R a[64:67],v7,16384
C v49,v20,v21
M v[160:163],a[100:103],v[56:59],v[160:163]
E v22,v104
M v[164:167],a[100:103],v[60:63],v[164:167]
SA m0,s28,69632
R a[68:71],v7,17408
AF v28,v21,v28
M v[164:167],a[96:99],v[44:47],v[164:167]
s_waitcnt lgkmcnt(2)
buffer_load_dwordx4 v4, s[8:11], s21 offen offset:0 sc1 lds
M v[172:175],a[104:107],v[44:47],v[172:175]
R a[72:75],v7,18432
M v[172:175],a[108:111],v[60:63],v[172:175]
E v23,v105
M v[168:171],a[108:111],v[56:59],v[168:171]
R a[76:79],v7,19456
AF v28,v22,v28
M v[168:171],a[104:107],v[40:43],v[168:171]
E v24,v106
M v[176:179],a[112:115],v[40:43],v[176:179]
R a[80:83],v7,20480
C v50,v22,v23
M v[176:179],a[116:119],v[56:59],v[176:179]
buffer_load_dwordx4 v4, s[8:11], s21 offen offset:1024 sc1 lds
M v[180:183],a[116:119],v[60:63],v[180:183]
R a[84:87],v7,21504
AF v28,v23,v28
M v[180:183],a[112:115],v[44:47],v[180:183]
E v25,v107
M v[188:191],a[120:123],v[44:47],v[188:191]
R a[88:91],v7,22528
AF v28,v24,v28
M v[188:191],a[124:127],v[60:63],v[188:191]
buffer_load_dwordx4 v4, s[8:11], s21 offen offset:2048 sc1 lds
M v[184:187],a[124:127],v[56:59],v[184:187]
R a[92:95],v7,23552
C v51,v24,v25
M v[184:187],a[120:123],v[40:43],v[184:187]
s_waitcnt lgkmcnt(4)
E v18,v100
M v[192:195],a[64:67],v[40:43],v[192:195]
R a[96:99],v7,24576
AF v28,v25,v28
M v[192:195],a[68:71],v[56:59],v[192:195]
R a[100:103],v7,25600
M v[196:199],a[68:71],v[60:63],v[196:199]
buffer_load_dwordx4 v4, s[8:11], s21 offen offset:3072 sc1 lds
M v[196:199],a[64:67],v[44:47],v[196:199]
s_waitcnt lgkmcnt(2)
R a[104:107],v7,26624
M v[204:207],a[72:75],v[44:47],v[204:207]
SA s21,s21,32768
R a[108:111],v7,27648
M v[204:207],a[76:79],v[60:63],v[204:207]
s_sub_u32 s22, s22, 1
E v19,v101
M v[200:203],a[76:79],v[56:59],v[200:203]
s_cselect_b32 s21, s23, s21
R a[112:115],v7,28672
AF v29,v18,v19
M v[200:203],a[72:75],v[40:43],v[200:203]
R a[116:119],v7,29696
C v52,v18,v19
M v[208:211],a[80:83],v[40:43],v[208:211]
E v20,v102
M v[208:211],a[84:87],v[56:59],v[208:211]
R a[120:123],v7,30720
M v[212:215],a[84:87],v[60:63],v[212:215]
R a[124:127],v7,31744
M v[212:215],a[80:83],v[44:47],v[212:215]
E v21,v103
M v[220:223],a[88:91],v[44:47],v[220:223]
E v22,v108
M v[220:223],a[92:95],v[60:63],v[220:223]
AF v29,v20,v29
C v53,v20,v21
M v[216:219],a[92:95],v[56:59],v[216:219]
s_waitcnt vmcnt(16) lgkmcnt(0)
AF v29,v21,v29
M v[216:219],a[88:91],v[40:43],v[216:219]
s_barrier
M v[224:227],a[96:99],v[40:43],v[224:227]
R a[64:67],v2,32768
M v[224:227],a[100:103],v[56:59],v[224:227]
E v23,v109
M v[228:231],a[100:103],v[60:63],v[228:231]
R a[68:71],v2,33792
v_cmp_gt_u32 vcc, s6, v5
M v[228:231],a[96:99],v[44:47],v[228:231]
E v24,v110
M v[236:239],a[104:107],v[44:47],v[236:239]
R a[72:75],v2,34816
AF v29,v22,v29
M v[236:239],a[108:111],v[60:63],v[236:239]
s_cbranch_vccnz L_fls0
L_flr0:
C v54,v22,v23
AF v29,v23,v29
M v[232:235],a[108:111],v[56:59],v[232:235]
s_mov_b32 s6, 0
R a[76:79],v2,35840
M v[232:235],a[104:107],v[40:43],v[232:235]
SA s7,s7,1
E v25,v111
M v[240:243],a[112:115],v[40:43],v[240:243]
R a[80:83],v2,36864
AF v29,v24,v29
M v[240:243],a[116:119],v[56:59],v[240:243]
C v55,v24,v25
AF v29,v25,v29
M v[244:247],a[116:119],v[60:63],v[244:247]
R a[84:87],v2,37888
M v[244:247],a[112:115],v[44:47],v[244:247]
M v[252:255],a[120:123],v[44:47],v[252:255]
s_sub_u32 s27, s27, 1
R a[88:91],v2,38912
M v[252:255],a[124:127],v[60:63],v[252:255]
s_cmp_lg_u32 s27, 0
M v[248:251],a[124:127],v[56:59],v[248:251]
s_waitcnt lgkmcnt(3)
R a[92:95],v2,39936
M v[248:251],a[120:123],v[40:43],v[248:251]
s_cbranch_scc1 L_loop_top
s_cmp_eq_u32 s40, 0
s_cbranch_scc1 L_final_h
L_d1s:
M v[68:71],a[64:67],a[32:35],v[36:39]
s_cmp_lt_u32 s20, 0
R a[96:99],v2,40960
R a[100:103],v2,41984
M v[68:71],a[68:71],a[36:39],v[68:71]
s_cselect_b64 s[82:83], -1, 0
E v18,v112
M v[68:71],a[72:75],a[40:43],v[68:71]
s_cmp_eq_u32 s20, 0
M v[68:71],a[76:79],a[44:47],v[68:71]
s_cselect_b64 s[66:67], s[16:17], s[82:83]
R a[104:107],v2,43008
R a[108:111],v2,44032
s_waitcnt lgkmcnt(7)
M v[68:71],a[80:83],a[48:51],v[68:71]
s_cselect_b64 s[68:69], s[18:19], s[82:83]
E v19,v113
s_waitcnt lgkmcnt(6)
M v[68:71],a[84:87],a[52:55],v[68:71]
s_cselect_b64 s[70:71], s[48:49], s[82:83]
AF v28,v18,v28
C v56,v18,v19
s_waitcnt lgkmcnt(5)
M v[68:71],a[88:91],a[56:59],v[68:71]
s_cselect_b64 s[72:73], s[50:51], s[82:83]
R a[112:115],v2,45056
R a[116:119],v2,46080
v_cndmask_b32 v64, v32, v8, s[66:67]
v_cndmask_b32 v65, v32, v8, s[68:69]
v_cndmask_b32 v66, v32, v8, s[70:71]
v_cndmask_b32 v67, v32, v8, s[72:73]
s_waitcnt lgkmcnt(6)
M v[68:71],a[92:95],a[60:63],v[68:71]
s_mov_b32 s26, s43
v_min_u32 v17, 896, v9
AF v28,v19,v28
M v[64:67],a[92:95],a[28:31],v[64:67]
s_cmp_lt_u32 s20, 1
buffer_load_dword v5, v17, s[8:11], s46 offen sc1
M v[64:67],a[88:91],a[24:27],v[64:67]
s_cselect_b64 s[82:83], -1, 0
R a[120:123],v2,47104
R a[124:127],v2,48128
M v[64:67],a[84:87],a[20:23],v[64:67]
SA m0,s28,0
E v20,v114
M v[64:67],a[80:83],a[16:19],v[64:67]
s_cmp_eq_u32 s20, 1
buffer_load_dwordx4 v3, s[8:11], s26 offen offset:0 sc1 lds
M v[64:67],a[76:79],a[12:15],v[64:67]
s_cselect_b64 s[74:75], s[16:17], s[82:83]
E v21,v115
M v[64:67],a[72:75],a[8:11],v[64:67]
s_cselect_b64 s[76:77], s[18:19], s[82:83]
AF v28,v20,v28
C v57,v20,v21
M v[64:67],a[68:71],a[4:7],v[64:67]
s_cselect_b64 s[78:79], s[48:49], s[82:83]
E v22,v120
M v[64:67],a[64:67],a[0:3],v[64:67]
s_waitcnt lgkmcnt(0)
buffer_load_dwordx4 v3, s[8:11], s26 offen offset:1024 sc1 lds
M v[76:79],a[96:99],a[32:35],v[36:39]
s_cselect_b64 s[80:81], s[50:51], s[82:83]
R a[64:67],v2,49152
R a[68:71],v2,50176
M v[76:79],a[100:103],a[36:39],v[76:79]
v_cndmask_b32 v72, v32, v8, s[74:75]
v_cndmask_b32 v73, v32, v8, s[76:77]
M v[76:79],a[104:107],a[40:43],v[76:79]
v_cndmask_b32 v74, v32, v8, s[78:79]
AF v28,v21,v28
M v[76:79],a[108:111],a[44:47],v[76:79]
R a[72:75],v2,51200
R a[76:79],v2,52224
M v[76:79],a[112:115],a[48:51],v[76:79]
buffer_load_dwordx4 v3, s[8:11], s26 offen offset:2048 sc1 lds
M v[76:79],a[116:119],a[52:55],v[76:79]
v_cndmask_b32 v75, v32, v8, s[80:81]
M v[76:79],a[120:123],a[56:59],v[76:79]
s_cmp_lt_u32 s20, 2
R a[80:83],v2,53248
R a[84:87],v2,54272
M v[76:79],a[124:127],a[60:63],v[76:79]
s_cselect_b64 s[82:83], -1, 0
E v23,v121
M v[72:75],a[124:127],a[28:31],v[72:75]
s_cmp_eq_u32 s20, 2
buffer_load_dwordx4 v3, s[8:11], s26 offen offset:3072 sc1 lds
M v[72:75],a[120:123],a[24:27],v[72:75]
s_cselect_b64 s[66:67], s[16:17], s[82:83]
R a[88:91],v2,55296
R a[92:95],v2,56320
M v[72:75],a[116:119],a[20:23],v[72:75]
s_cselect_b64 s[68:69], s[18:19], s[82:83]
E v24,v122
M v[72:75],a[112:115],a[16:19],v[72:75]
s_cselect_b64 s[70:71], s[48:49], s[82:83]
E v25,v123
M v[72:75],a[108:111],a[12:15],v[72:75]
s_cselect_b64 s[72:73], s[50:51], s[82:83]
v_cndmask_b32 v80, v32, v8, s[66:67]
v_cndmask_b32 v81, v32, v8, s[68:69]
M v[72:75],a[104:107],a[8:11],v[72:75]
SA m0,s28,4096
E v18,v116
M v[72:75],a[100:103],a[4:7],v[72:75]
s_lshl_b32 s86, s20, 14
buffer_load_dwordx4 v4, s[8:11], s26 offen offset:0 sc1 lds
M v[72:75],a[96:99],a[0:3],v[72:75]
s_waitcnt lgkmcnt(0)
v_cndmask_b32 v82, v32, v8, s[70:71]
AF v28,v22,v28
M v[84:87],a[64:67],a[32:35],v[36:39]
SA s86,s86,s34
R a[96:99],v2,57344
R a[100:103],v2,58368
M v[84:87],a[68:71],a[36:39],v[84:87]
SA s87,s86,4096
buffer_load_dwordx4 v4, s[8:11], s26 offen offset:1024 sc1 lds
M v[84:87],a[72:75],a[40:43],v[84:87]
SA s88,s86,8192
v_cndmask_b32 v83, v32, v8, s[72:73]
C v58,v22,v23
M v[84:87],a[76:79],a[44:47],v[84:87]
s_cmp_lt_u32 s20, 3
R a[104:107],v2,59392
R a[108:111],v2,60416
M v[84:87],a[80:83],a[48:51],v[84:87]
s_cselect_b64 s[82:83], -1, 0
E v19,v117
M v[84:87],a[84:87],a[52:55],v[84:87]
SA s89,s86,12288
buffer_load_dwordx4 v4, s[8:11], s26 offen offset:2048 sc1 lds
M v[84:87],a[88:91],a[56:59],v[84:87]
s_lshl_b32 s90, s20, 10
R a[112:115],v2,61440
R a[116:119],v2,62464
M v[84:87],a[92:95],a[60:63],v[84:87]
SA s90,s90,s34
E v20,v118
M v[80:83],a[92:95],a[28:31],v[80:83]
SA s90,s90,65536
E v21,v119
M v[80:83],a[88:91],a[24:27],v[80:83]
s_cmp_eq_u32 s20, 3
R a[120:123],v2,63488
R a[124:127],v2,64512
M v[80:83],a[84:87],a[20:23],v[80:83]
s_cselect_b64 s[74:75], s[16:17], s[82:83]
buffer_load_dwordx4 v4, s[8:11], s26 offen offset:3072 sc1 lds
M v[80:83],a[80:83],a[16:19],v[80:83]
s_cselect_b64 s[76:77], s[18:19], s[82:83]
AF v28,v23,v28
AF v28,v24,v28
M v[80:83],a[76:79],a[12:15],v[80:83]
s_cselect_b64 s[78:79], s[48:49], s[82:83]
E v22,v124
M v[80:83],a[72:75],a[8:11],v[80:83]
s_cselect_b64 s[80:81], s[50:51], s[82:83]
v_cndmask_b32 v88, v32, v8, s[74:75]
v_cndmask_b32 v89, v32, v8, s[76:77]
M v[80:83],a[68:71],a[4:7],v[80:83]
s_waitcnt vmcnt(17) lgkmcnt(0)
v_cndmask_b32 v90, v32, v8, s[78:79]
v_cndmask_b32 v91, v32, v8, s[80:81]
M v[80:83],a[64:67],a[0:3],v[80:83]
s_barrier
M v[92:95],a[96:99],a[32:35],v[36:39]
SA s26,s26,32768
R a[64:67],v7,32768
R a[68:71],v7,33792
M v[92:95],a[100:103],a[36:39],v[92:95]
SA m0,s28,131072
E v23,v125
M v[92:95],a[104:107],a[40:43],v[92:95]
buffer_load_dwordx4 v3, s[8:11], s26 offen offset:0 sc1 lds
M v[92:95],a[108:111],a[44:47],v[92:95]
R a[72:75],v7,34816
R a[76:79],v7,35840
M v[92:95],a[112:115],a[48:51],v[92:95]
C v59,v24,v25
AF v28,v25,v28
M v[92:95],a[116:119],a[52:55],v[92:95]
buffer_load_dwordx4 v3, s[8:11], s26 offen offset:1024 sc1 lds
M v[92:95],a[120:123],a[56:59],v[92:95]
R a[80:83],v7,36864
R a[84:87],v7,37888
M v[92:95],a[124:127],a[60:63],v[92:95]
E v24,v126
M v[88:91],a[124:127],a[28:31],v[88:91]
buffer_load_dwordx4 v3, s[8:11], s26 offen offset:2048 sc1 lds
M v[88:91],a[120:123],a[24:27],v[88:91]
R a[88:91],v7,38912
R a[92:95],v7,39936
M v[88:91],a[116:119],a[20:23],v[88:91]
E v25,v127
M v[88:91],a[112:115],a[16:19],v[88:91]
buffer_load_dwordx4 v3, s[8:11], s26 offen offset:3072 sc1 lds
M v[88:91],a[108:111],a[12:15],v[88:91]
AF v29,v18,v29
C v60,v18,v19
M v[88:91],a[104:107],a[8:11],v[88:91]
AF v29,v19,v29
AF v29,v20,v29
M v[88:91],a[100:103],a[4:7],v[88:91]
s_waitcnt lgkmcnt(0)
C v61,v20,v21
AF v29,v21,v29
M v[88:91],a[96:99],a[0:3],v[88:91]
AF v29,v22,v29
C v62,v22,v23
AF v29,v23,v29
AF v29,v24,v29
C v63,v24,v25
AF v29,v25,v29
v_max_f32 v10, v28, v29
v_cmp_lt_f32 vcc, s31, v10
s_nop 0
s_cbranch_vccnz L_std1
L_rtd1:
s_cmp_lt_u32 s42, 6
s_cbranch_scc1 L_d2h
M v[128:131],a[64:67],v[48:51],v[128:131]
R a[96:99],v7,40960
R a[100:103],v7,41984
M v[128:131],a[68:71],v[56:59],v[128:131]
SA m0,s28,135168
E v18,v64
M v[132:135],a[68:71],v[60:63],v[132:135]
buffer_load_dwordx4 v4, s[8:11], s26 offen offset:0 sc1 lds
M v[132:135],a[64:67],v[52:55],v[132:135]
R a[104:107],v7,43008
R a[108:111],v7,44032
M v[140:143],a[72:75],v[52:55],v[140:143]
s_cmp_gt_u32 s20, 3
E v19,v65
M v[140:143],a[76:79],v[60:63],v[140:143]
s_cselect_b64 s[82:83], -1, 0
AF v30,v28,v30
AF v31,v29,v31
M v[136:139],a[76:79],v[56:59],v[136:139]
s_cmp_eq_u32 s20, 3
R a[112:115],v7,45056
R a[116:119],v7,46080
M v[136:139],a[72:75],v[48:51],v[136:139]
s_cselect_b64 s[66:67], s[16:17], s[82:83]
buffer_load_dwordx4 v4, s[8:11], s26 offen offset:1024 sc1 lds
M v[144:147],a[80:83],v[48:51],v[144:147]
s_cselect_b64 s[68:69], s[18:19], s[82:83]
E v20,v66
M v[144:147],a[84:87],v[56:59],v[144:147]
s_cselect_b64 s[70:71], s[48:49], s[82:83]
R a[120:123],v7,47104
R a[124:127],v7,48128
M v[148:151],a[84:87],v[60:63],v[148:151]
s_cselect_b64 s[72:73], s[50:51], s[82:83]
v_cndmask_b32 v100, v36, v8, s[66:67]
v_cndmask_b32 v101, v36, v8, s[68:69]
M v[148:151],a[80:83],v[52:55],v[148:151]
buffer_load_dwordx4 v4, s[8:11], s26 offen offset:2048 sc1 lds
M v[156:159],a[88:91],v[52:55],v[156:159]
v_cndmask_b32 v102, v36, v8, s[70:71]
AF v26,v18,v19
M v[156:159],a[92:95],v[60:63],v[156:159]
E v21,v67
M v[152:155],a[92:95],v[56:59],v[152:155]
v_cndmask_b32 v103, v36, v8, s[72:73]
C v40,v18,v19
M v[152:155],a[88:91],v[48:51],v[152:155]
s_waitcnt lgkmcnt(0)
buffer_load_dwordx4 v4, s[8:11], s26 offen offset:3072 sc1 lds
M v[160:163],a[96:99],v[48:51],v[160:163]
s_cmp_gt_u32 s20, 2
R a[64:67],v7,49152
R a[68:71],v7,50176
M v[160:163],a[100:103],v[56:59],v[160:163]
s_cselect_b64 s[82:83], -1, 0
v_lshrrev_b32 v14, 7, v7
AF v26,v20,v26
M v[164:167],a[100:103],v[60:63],v[164:167]
s_cmp_eq_u32 s20, 2
v_mul_u32_u24 v14, 896, v14
C v41,v20,v21
M v[164:167],a[96:99],v[52:55],v[164:167]
s_cselect_b64 s[74:75], s[16:17], s[82:83]
R a[72:75],v7,51200
R a[76:79],v7,52224
M v[172:175],a[104:107],v[52:55],v[172:175]
s_cselect_b64 s[76:77], s[18:19], s[82:83]
v_lshrrev_b32 v15, 8, v7
AF v26,v21,v26
M v[172:175],a[108:111],v[60:63],v[172:175]
s_cselect_b64 s[78:79], s[48:49], s[82:83]
v_lshlrev_b32 v15, 5, v15
M v[168:171],a[108:111],v[56:59],v[168:171]
s_cselect_b64 s[80:81], s[50:51], s[82:83]
R a[80:83],v7,53248
R a[84:87],v7,54272
M v[168:171],a[104:107],v[48:51],v[168:171]
v_cndmask_b32 v108, v36, v8, s[74:75]
v_cndmask_b32 v109, v36, v8, s[76:77]
M v[176:179],a[112:115],v[48:51],v[176:179]
v_xor_b32 v15, v15, v7
M v[176:179],a[116:119],v[56:59],v[176:179]
R a[88:91],v7,55296
R a[92:95],v7,56320
M v[180:183],a[116:119],v[60:63],v[180:183]
v_and_b32 v15, 0x70, v15
v_cndmask_b32 v110, v36, v8, s[78:79]
M v[180:183],a[112:115],v[52:55],v[180:183]
v_add_u32 v0, v14, v15
M v[188:191],a[120:123],v[52:55],v[188:191]
s_mul_i32 s38, s20, 57344
v_cndmask_b32 v111, v36, v8, s[80:81]
M v[188:191],a[124:127],v[60:63],v[188:191]
s_cmp_gt_u32 s20, 1
E v22,v72
M v[184:187],a[124:127],v[56:59],v[184:187]
s_cselect_b64 s[82:83], -1, 0
E v23,v73
M v[184:187],a[120:123],v[48:51],v[184:187]
s_waitcnt lgkmcnt(0)
E v24,v74
M v[192:195],a[64:67],v[48:51],v[192:195]
SA m0,s28,98304
R a[96:99],v7,57344
R a[100:103],v7,58368
M v[192:195],a[68:71],v[56:59],v[192:195]
s_cmp_eq_u32 s20, 1
E v25,v75
M v[196:199],a[68:71],v[60:63],v[196:199]
s_cselect_b64 s[66:67], s[16:17], s[82:83]
E v18,v68
M v[196:199],a[64:67],v[52:55],v[196:199]
s_cselect_b64 s[68:69], s[18:19], s[82:83]
R a[104:107],v7,59392
R a[108:111],v7,60416
M v[204:207],a[72:75],v[52:55],v[204:207]
s_cselect_b64 s[70:71], s[48:49], s[82:83]
E v19,v69
M v[204:207],a[76:79],v[60:63],v[204:207]
s_cselect_b64 s[72:73], s[50:51], s[82:83]
v_cndmask_b32 v116, v36, v8, s[66:67]
v_cndmask_b32 v117, v36, v8, s[68:69]
M v[200:203],a[76:79],v[56:59],v[200:203]
SA s85,s38,0
R a[112:115],v7,61440
R a[116:119],v7,62464
M v[200:203],a[72:75],v[48:51],v[200:203]
buffer_load_dwordx4 v0, s[12:15], s85 offen offset:0 lds
M v[208:211],a[80:83],v[48:51],v[208:211]
SA s85,s38,6144
v_cndmask_b32 v118, v36, v8, s[70:71]
AF v26,v22,v26
M v[208:211],a[84:87],v[56:59],v[208:211]
R a[120:123],v7,63488
R a[124:127],v7,64512
M v[212:215],a[84:87],v[60:63],v[212:215]
buffer_load_dwordx4 v0, s[12:15], s85 offen offset:1024 lds
M v[212:215],a[80:83],v[52:55],v[212:215]
SA s85,s38,12288
v_cndmask_b32 v119, v36, v8, s[72:73]
C v42,v22,v23
M v[220:223],a[88:91],v[52:55],v[220:223]
s_cmp_gt_u32 s20, 0
E v20,v70
M v[220:223],a[92:95],v[60:63],v[220:223]
s_cselect_b64 s[82:83], -1, 0
buffer_load_dwordx4 v0, s[12:15], s85 offen offset:2048 lds
M v[216:219],a[92:95],v[56:59],v[216:219]
s_waitcnt vmcnt(20) lgkmcnt(0)
E v21,v71
M v[216:219],a[88:91],v[48:51],v[216:219]
s_barrier
M v[224:227],a[96:99],v[48:51],v[224:227]
SA s85,s38,18432
R a[64:67],v2,0
R a[68:71],v2,1024
M v[224:227],a[100:103],v[56:59],v[224:227]
s_cmp_eq_u32 s20, 0
buffer_load_dwordx4 v0, s[12:15], s85 offen offset:3072 lds
M v[228:231],a[100:103],v[60:63],v[228:231]
s_cselect_b64 s[74:75], s[16:17], s[82:83]
AF v26,v23,v26
AF v26,v24,v26
M v[228:231],a[96:99],v[52:55],v[228:231]
s_cselect_b64 s[76:77], s[18:19], s[82:83]
R a[72:75],v2,2048
R a[76:79],v2,3072
M v[236:239],a[104:107],v[52:55],v[236:239]
s_cselect_b64 s[78:79], s[48:49], s[82:83]
E v22,v76
M v[236:239],a[108:111],v[60:63],v[236:239]
s_cselect_b64 s[80:81], s[50:51], s[82:83]
v_cndmask_b32 v124, v36, v8, s[74:75]
v_cndmask_b32 v125, v36, v8, s[76:77]
M v[232:235],a[108:111],v[56:59],v[232:235]
SA m0,s28,102400
R a[80:83],v2,4096
R a[84:87],v2,5120
M v[232:235],a[104:107],v[48:51],v[232:235]
SA s85,s38,28672
buffer_load_dwordx4 v0, s[12:15], s85 offen offset:0 lds
M v[240:243],a[112:115],v[48:51],v[240:243]
SA s85,s38,34816
v_cndmask_b32 v126, v36, v8, s[78:79]
v_cndmask_b32 v127, v36, v8, s[80:81]
M v[240:243],a[116:119],v[56:59],v[240:243]
R a[88:91],v2,6144
R a[92:95],v2,7168
M v[244:247],a[116:119],v[60:63],v[244:247]
buffer_load_dwordx4 v0, s[12:15], s85 offen offset:1024 lds
M v[244:247],a[112:115],v[52:55],v[244:247]
SA s85,s38,40960
E v23,v77
M v[252:255],a[120:123],v[52:55],v[252:255]
buffer_load_dwordx4 v0, s[12:15], s85 offen offset:2048 lds
M v[252:255],a[124:127],v[60:63],v[252:255]
SA s85,s38,47104
C v43,v24,v25
AF v26,v25,v26
M v[248:251],a[124:127],v[56:59],v[248:251]
s_waitcnt lgkmcnt(0)
E v24,v78
M v[248:251],a[120:123],v[48:51],v[248:251]
buffer_load_dwordx4 v0, s[12:15], s85 offen offset:3072 lds
SA s38,s38,128
AF v27,v18,v19
C v44,v18,v19
AF v27,v20,v27
C v45,v20,v21
AF v27,v21,v27
E v25,v79
AF v27,v22,v27
C v46,v22,v23
AF v27,v23,v27
AF v27,v24,v27
C v47,v24,v25
AF v27,v25,v27
M v[100:103],a[64:67],a[32:35],v[100:103]
R a[96:99],v2,8192
R a[100:103],v2,9216
M v[100:103],a[68:71],a[36:39],v[100:103]
R a[104:107],v2,10240
R a[108:111],v2,11264
M v[100:103],a[72:75],a[40:43],v[100:103]
R a[112:115],v2,12288
R a[116:119],v2,13312
M v[100:103],a[76:79],a[44:47],v[100:103]
R a[120:123],v2,14336
R a[124:127],v2,15360
M v[100:103],a[80:83],a[48:51],v[100:103]
v_add_u32 v8, 0x20000, v7
M v[100:103],a[84:87],a[52:55],v[100:103]
SA m0,s28,32768
E v18,v80
M v[100:103],a[88:91],a[56:59],v[100:103]
SA s85,s38,0
buffer_load_dwordx4 v0, s[12:15], s85 offen offset:0 lds
M v[100:103],a[92:95],a[60:63],v[100:103]
s_waitcnt lgkmcnt(0)
E v19,v81
M v[108:111],a[96:99],a[32:35],v[108:111]
SA s85,s38,6144
R a[64:67],v2,16384
R a[68:71],v2,17408
M v[108:111],a[100:103],a[36:39],v[108:111]
R a[72:75],v2,18432
R a[76:79],v2,19456
M v[108:111],a[104:107],a[40:43],v[108:111]
R a[80:83],v2,20480
R a[84:87],v2,21504
M v[108:111],a[108:111],a[44:47],v[108:111]
R a[88:91],v2,22528
R a[92:95],v2,23552
M v[108:111],a[112:115],a[48:51],v[108:111]
buffer_load_dwordx4 v0, s[12:15], s85 offen offset:1024 lds
M v[108:111],a[116:119],a[52:55],v[108:111]
SA s85,s38,12288
E v20,v82
M v[108:111],a[120:123],a[56:59],v[108:111]
buffer_load_dwordx4 v0, s[12:15], s85 offen offset:2048 lds
M v[108:111],a[124:127],a[60:63],v[108:111]
s_waitcnt lgkmcnt(0)
E v21,v83
M v[116:119],a[64:67],a[32:35],v[116:119]
SA s85,s38,18432
R a[96:99],v2,24576
R a[100:103],v2,25600
M v[116:119],a[68:71],a[36:39],v[116:119]
R a[104:107],v2,26624
R a[108:111],v2,27648
M v[116:119],a[72:75],a[40:43],v[116:119]
R a[112:115],v2,28672
R a[116:119],v2,29696
M v[116:119],a[76:79],a[44:47],v[116:119]
R a[120:123],v2,30720
R a[124:127],v2,31744
M v[116:119],a[80:83],a[48:51],v[116:119]
buffer_load_dwordx4 v0, s[12:15], s85 offen offset:3072 lds
M v[116:119],a[84:87],a[52:55],v[116:119]
buffer_load_dword v6, off, s[8:11], s47 sc1
M v[116:119],a[88:91],a[56:59],v[116:119]
s_waitcnt vmcnt(21) lgkmcnt(0)
E v22,v88
M v[116:119],a[92:95],a[60:63],v[116:119]
s_barrier
M v[124:127],a[96:99],a[32:35],v[124:127]
R a[64:67],v7,0
R a[68:71],v7,1024
M v[124:127],a[100:103],a[36:39],v[124:127]
R a[72:75],v7,2048
R a[76:79],v7,3072
M v[124:127],a[104:107],a[40:43],v[124:127]
R a[80:83],v7,4096
R a[84:87],v7,5120
M v[124:127],a[108:111],a[44:47],v[124:127]
R a[88:91],v7,6144
R a[92:95],v7,7168
M v[124:127],a[112:115],a[48:51],v[124:127]
E v23,v89
M v[124:127],a[116:119],a[52:55],v[124:127]
E v24,v90
M v[124:127],a[120:123],a[56:59],v[124:127]
s_waitcnt lgkmcnt(0)
E v25,v91
M v[124:127],a[124:127],a[60:63],v[124:127]
AF v26,v18,v26
C v56,v18,v19
AF v26,v19,v26
AF v26,v20,v26
C v57,v20,v21
AF v26,v21,v26
AF v26,v22,v26
C v58,v22,v23
AF v26,v23,v26
E v18,v84
E v19,v85
AF v26,v24,v26
C v59,v24,v25
AF v26,v25,v26
E v20,v86
E v21,v87
AF v27,v18,v27
C v60,v18,v19
AF v27,v19,v27
E v22,v92
E v23,v93
AF v27,v20,v27
C v61,v20,v21
AF v27,v21,v27
E v24,v94
E v25,v95
AF v27,v22,v27
C v62,v22,v23
AF v27,v23,v27
AF v27,v24,v27
C v63,v24,v25
AF v27,v25,v27
v_max_f32 v10, v26, v27
v_cmp_lt_f32 vcc, s31, v10
s_nop 0
s_cbranch_vccnz L_std3n
L_rtd3n:
M v[128:131],a[64:67],v[40:43],v[128:131]
R a[96:99],v7,8192
R a[100:103],v7,9216
M v[128:131],a[68:71],v[56:59],v[128:131]
v_or_b32 v9, s35, v7
s_waitcnt vmcnt(0)
v_cmp_ne_u32 vcc, 1, v6
M v[132:135],a[68:71],v[60:63],v[132:135]
s_cbranch_vccnz L_fps
L_fpr:
E v18,v100
M v[132:135],a[64:67],v[44:47],v[132:135]
R a[104:107],v7,10240
R a[108:111],v7,11264
M v[140:143],a[72:75],v[44:47],v[140:143]
buffer_load_dwordx4 v[14:17], v9, s[8:11], s90 offen sc1
M v[140:143],a[76:79],v[60:63],v[140:143]
E v19,v101
M v[136:139],a[76:79],v[56:59],v[136:139]
R a[112:115],v7,12288
R a[116:119],v7,13312
M v[136:139],a[72:75],v[40:43],v[136:139]
buffer_load_dwordx4 a[160:163], v9, s[8:11], s88 offen offset:0 sc1
M v[144:147],a[80:83],v[40:43],v[144:147]
E v20,v102
M v[144:147],a[84:87],v[56:59],v[144:147]
R a[120:123],v7,14336
R a[124:127],v7,15360
M v[148:151],a[84:87],v[60:63],v[148:151]
buffer_load_dwordx4 a[128:131], v9, s[8:11], s86 offen offset:0 sc1
M v[148:151],a[80:83],v[44:47],v[148:151]
E v21,v103
M v[156:159],a[88:91],v[44:47],v[156:159]
AF v30,v26,v30
AF v31,v27,v31
M v[156:159],a[92:95],v[60:63],v[156:159]
buffer_load_dwordx4 a[164:167], v9, s[8:11], s88 offen offset:1024 sc1
M v[152:155],a[92:95],v[56:59],v[152:155]
AF v29,v18,v19
C v52,v18,v19
M v[152:155],a[88:91],v[40:43],v[152:155]
s_waitcnt lgkmcnt(0)
E v22,v108
M v[160:163],a[96:99],v[40:43],v[160:163]
R a[64:67],v7,16384
R a[68:71],v7,17408
M v[160:163],a[100:103],v[56:59],v[160:163]
buffer_load_dwordx4 a[132:135], v9, s[8:11], s86 offen offset:1024 sc1
M v[164:167],a[100:103],v[60:63],v[164:167]
E v23,v109
M v[164:167],a[96:99],v[44:47],v[164:167]
R a[72:75],v7,18432
R a[76:79],v7,19456
M v[172:175],a[104:107],v[44:47],v[172:175]
buffer_load_dwordx4 a[168:171], v9, s[8:11], s88 offen offset:2048 sc1
M v[172:175],a[108:111],v[60:63],v[172:175]
AF v29,v20,v29
C v53,v20,v21
M v[168:171],a[108:111],v[56:59],v[168:171]
R a[80:83],v7,20480
R a[84:87],v7,21504
M v[168:171],a[104:107],v[40:43],v[168:171]
buffer_load_dwordx4 a[136:139], v9, s[8:11], s86 offen offset:2048 sc1
M v[176:179],a[112:115],v[40:43],v[176:179]
E v24,v110
M v[176:179],a[116:119],v[56:59],v[176:179]
R a[88:91],v7,22528
R a[92:95],v7,23552
M v[180:183],a[116:119],v[60:63],v[180:183]
buffer_load_dwordx4 a[172:175], v9, s[8:11], s88 offen offset:3072 sc1
M v[180:183],a[112:115],v[44:47],v[180:183]
E v25,v111
M v[188:191],a[120:123],v[44:47],v[188:191]
AF v29,v21,v29
AF v29,v22,v29
M v[188:191],a[124:127],v[60:63],v[188:191]
buffer_load_dwordx4 a[140:143], v9, s[8:11], s86 offen offset:3072 sc1
M v[184:187],a[124:127],v[56:59],v[184:187]
E v18,v116
M v[184:187],a[120:123],v[40:43],v[184:187]
s_waitcnt lgkmcnt(0)
C v54,v22,v23
AF v29,v23,v29
M v[192:195],a[64:67],v[40:43],v[192:195]
R a[96:99],v7,24576
R a[100:103],v7,25600
M v[192:195],a[68:71],v[56:59],v[192:195]
buffer_load_dwordx4 a[176:179], v9, s[8:11], s89 offen offset:0 sc1
M v[196:199],a[68:71],v[60:63],v[196:199]
E v19,v117
M v[196:199],a[64:67],v[44:47],v[196:199]
R a[104:107],v7,26624
R a[108:111],v7,27648
M v[204:207],a[72:75],v[44:47],v[204:207]
buffer_load_dwordx4 a[144:147], v9, s[8:11], s87 offen offset:0 sc1
M v[204:207],a[76:79],v[60:63],v[204:207]
E v20,v118
M v[200:203],a[76:79],v[56:59],v[200:203]
R a[112:115],v7,28672
R a[116:119],v7,29696
M v[200:203],a[72:75],v[40:43],v[200:203]
buffer_load_dwordx4 a[180:183], v9, s[8:11], s89 offen offset:1024 sc1
M v[208:211],a[80:83],v[40:43],v[208:211]
AF v29,v24,v29
C v55,v24,v25
M v[208:211],a[84:87],v[56:59],v[208:211]
R a[120:123],v7,30720
R a[124:127],v7,31744
M v[212:215],a[84:87],v[60:63],v[212:215]
buffer_load_dwordx4 a[148:151], v9, s[8:11], s87 offen offset:1024 sc1
M v[212:215],a[80:83],v[44:47],v[212:215]
E v21,v119
M v[220:223],a[88:91],v[44:47],v[220:223]
AF v29,v25,v29
AF v29,v18,v29
M v[220:223],a[92:95],v[60:63],v[220:223]
buffer_load_dwordx4 a[184:187], v9, s[8:11], s89 offen offset:2048 sc1
M v[216:219],a[92:95],v[56:59],v[216:219]
s_waitcnt lgkmcnt(0)
E v22,v124
M v[216:219],a[88:91],v[40:43],v[216:219]
s_barrier
M v[224:227],a[96:99],v[40:43],v[224:227]
R a[64:67],v8,0
R a[68:71],v8,1024
M v[224:227],a[100:103],v[56:59],v[224:227]
buffer_load_dwordx4 a[152:155], v9, s[8:11], s87 offen offset:2048 sc1
M v[228:231],a[100:103],v[60:63],v[228:231]
E v23,v125
M v[228:231],a[96:99],v[44:47],v[228:231]
R a[72:75],v8,2048
R a[76:79],v8,3072
M v[236:239],a[104:107],v[44:47],v[236:239]
buffer_load_dwordx4 a[188:191], v9, s[8:11], s89 offen offset:3072 sc1
M v[236:239],a[108:111],v[60:63],v[236:239]
E v24,v126
M v[232:235],a[108:111],v[56:59],v[232:235]
R a[80:83],v8,4096
R a[84:87],v8,5120
M v[232:235],a[104:107],v[40:43],v[232:235]
buffer_load_dwordx4 a[156:159], v9, s[8:11], s87 offen offset:3072 sc1
M v[240:243],a[112:115],v[40:43],v[240:243]
E v25,v127
M v[240:243],a[116:119],v[56:59],v[240:243]
R a[88:91],v8,6144
R a[92:95],v8,7168
M v[244:247],a[116:119],v[60:63],v[244:247]
C v48,v18,v19
AF v29,v19,v29
M v[244:247],a[112:115],v[44:47],v[244:247]
AF v29,v20,v29
C v49,v20,v21
M v[252:255],a[120:123],v[44:47],v[252:255]
AF v29,v21,v29
AF v29,v22,v29
M v[252:255],a[124:127],v[60:63],v[252:255]
C v50,v22,v23
AF v29,v23,v29
M v[248:251],a[124:127],v[56:59],v[248:251]
s_waitcnt lgkmcnt(0)
AF v29,v24,v29
C v51,v24,v25
M v[248:251],a[120:123],v[40:43],v[248:251]
AF v29,v25,v29
v_cmp_lt_f32 vcc, s31, v29
s_nop 0
s_cbranch_vccnz L_std4n
L_rtd4n:
s_waitcnt vmcnt(16)
v_cmp_neq_f32 vcc, v32, v14
v_cmp_neq_f32 s[64:65], v36, v15
s_cmp_eq_u32 s35, 0
s_cselect_b64 s[66:67], -1, 0
s_or_b64 vcc, vcc, s[64:65]
s_and_b64 vcc, vcc, s[66:67]
s_cbranch_vccnz L_stc
L_rtc:
M v[132:135],a[64:67],v[52:55],v[132:135]
R a[96:99],v8,8192
R a[100:103],v8,9216
M v[132:135],a[68:71],v[48:51],v[132:135]
s_waitcnt vmcnt(12)
AF v30,v16,v30
AF v31,v17,v31
M v[132:135],a[246:249],a[160:163],v[132:135]
SA m0,s28,36864
AF v31,v29,v31
v_mov_b32 v10, v30
M v[128:131],a[246:249],a[128:131],v[128:131]
SA s85,s38,28672
R a[104:107],v8,10240
R a[108:111],v8,11264
M v[140:143],a[72:75],v[52:55],v[140:143]
buffer_load_dwordx4 v0, s[12:15], s85 offen offset:0 lds
M v[140:143],a[76:79],v[48:51],v[140:143]
SA s85,s38,34816
v_mov_b32 v11, v31
M v[140:143],a[244:247],a[160:163],v[140:143]
R a[112:115],v8,12288
R a[116:119],v8,13312
M v[136:139],a[244:247],a[128:131],v[136:139]
v_permlane16_swap_b32 v10, v30
M v[148:151],a[80:83],v[52:55],v[148:151]
v_permlane16_swap_b32 v11, v31
M v[148:151],a[84:87],v[48:51],v[148:151]
R a[120:123],v8,14336
R a[124:127],v8,15360
M v[148:151],a[246:249],a[164:167],v[148:151]
buffer_load_dwordx4 v0, s[12:15], s85 offen offset:1024 lds
M v[144:147],a[246:249],a[132:135],v[144:147]
SA s85,s38,40960
AF v30,v10,v30
AF v31,v11,v31
M v[156:159],a[88:91],v[52:55],v[156:159]
v_mov_b32 v10, v30
v_mov_b32 v11, v31
M v[156:159],a[92:95],v[48:51],v[156:159]
buffer_load_dwordx4 v0, s[12:15], s85 offen offset:2048 lds
M v[156:159],a[244:247],a[164:167],v[156:159]
s_waitcnt vmcnt(11)
v_permlane32_swap_b32 v10, v30
M v[152:155],a[244:247],a[132:135],v[152:155]
s_waitcnt lgkmcnt(0)
v_permlane32_swap_b32 v11, v31
M v[164:167],a[96:99],v[52:55],v[164:167]
SA s85,s38,47104
R a[64:67],v8,16384
R a[68:71],v8,17408
M v[164:167],a[100:103],v[48:51],v[164:167]
buffer_load_dwordx4 v0, s[12:15], s85 offen offset:3072 lds
M v[164:167],a[246:249],a[168:171],v[164:167]
SA s38,s38,128
C v132,v132,v133
C v133,v134,v135
M v[160:163],a[246:249],a[136:139],v[160:163]
SA m0,s28,65536
R a[72:75],v8,18432
R a[76:79],v8,19456
AF v30,v10,v30
AF v31,v11,v31
v_rcp_f32 v5, v30
v_rcp_f32 v6, v31
M v[172:175],a[104:107],v[52:55],v[172:175]
SA s85,s38,0
buffer_load_dwordx4 v0, s[12:15], s85 offen offset:0 lds
M v[172:175],a[108:111],v[48:51],v[172:175]
SA s85,s38,6144
C v134,v140,v141
C v135,v142,v143
M v[172:175],a[244:247],a[168:171],v[172:175]
R a[80:83],v8,20480
R a[84:87],v8,21504
M v[168:171],a[244:247],a[136:139],v[168:171]
buffer_load_dwordx4 v0, s[12:15], s85 offen offset:1024 lds
M v[180:183],a[112:115],v[52:55],v[180:183]
SA s85,s38,12288
C v128,v128,v129
C v129,v130,v131
M v[180:183],a[116:119],v[48:51],v[180:183]
R a[88:91],v8,22528
R a[92:95],v8,23552
M v[180:183],a[246:249],a[172:175],v[180:183]
buffer_load_dwordx4 v0, s[12:15], s85 offen offset:2048 lds
M v[176:179],a[246:249],a[140:143],v[176:179]
SA s85,s38,18432
C v130,v136,v137
C v131,v138,v139
M v[188:191],a[120:123],v[52:55],v[188:191]
C v148,v148,v149
C v149,v150,v151
M v[188:191],a[124:127],v[48:51],v[188:191]
buffer_load_dwordx4 v0, s[12:15], s85 offen offset:3072 lds
M v[188:191],a[244:247],a[172:175],v[188:191]
s_waitcnt vmcnt(12)
C v150,v156,v157
C v151,v158,v159
M v[184:187],a[244:247],a[140:143],v[184:187]
s_waitcnt lgkmcnt(0)
C v144,v144,v145
C v145,v146,v147
M v[196:199],a[64:67],v[52:55],v[196:199]
SA m0,s28,69632
R a[96:99],v8,24576
R a[100:103],v8,25600
M v[196:199],a[68:71],v[48:51],v[196:199]
SA s85,s38,28672
buffer_load_dwordx4 v0, s[12:15], s85 offen offset:0 lds
M v[196:199],a[246:249],a[176:179],v[196:199]
SA s85,s38,34816
C v146,v152,v153
C v147,v154,v155
M v[192:195],a[246:249],a[144:147],v[192:195]
R a[104:107],v8,26624
R a[108:111],v8,27648
M v[204:207],a[72:75],v[52:55],v[204:207]
buffer_load_dwordx4 v0, s[12:15], s85 offen offset:1024 lds
M v[204:207],a[76:79],v[48:51],v[204:207]
SA s85,s38,40960
v_lshrrev_b32 v16, 4, v7
v_lshrrev_b32 v14, 2, v16
M v[204:207],a[244:247],a[176:179],v[204:207]
R a[112:115],v8,28672
R a[116:119],v8,29696
M v[200:203],a[244:247],a[144:147],v[200:203]
buffer_load_dwordx4 v0, s[12:15], s85 offen offset:2048 lds
M v[212:215],a[80:83],v[52:55],v[212:215]
SA s85,s38,47104
v_lshlrev_b32 v14, 7, v14
v_and_b32 v15, 3, v16
M v[212:215],a[84:87],v[48:51],v[212:215]
R a[120:123],v8,30720
R a[124:127],v8,31744
M v[212:215],a[246:249],a[180:183],v[212:215]
buffer_load_dwordx4 v0, s[12:15], s85 offen offset:3072 lds
M v[208:211],a[246:249],a[148:151],v[208:211]
SA s38,s38,128
v_lshl_add_u32 v14, v15, 3, v14
C v164,v164,v165
M v[220:223],a[88:91],v[52:55],v[220:223]
C v165,v166,v167
C v166,v172,v173
M v[220:223],a[92:95],v[48:51],v[220:223]
s_waitcnt vmcnt(12)
C v167,v174,v175
C v160,v160,v161
M v[220:223],a[244:247],a[180:183],v[220:223]
s_waitcnt lgkmcnt(0)
v_bfe_u32 v15, v16, 3, 2
v_lshl_add_u32 v18, v15, 5, v14
v_xor_b32 v19, 32, v18
v_xor_b32 v20, 64, v18
v_xor_b32 v21, 0x60, v18
v_add_u32 v22, 0x10000, v18
v_add_u32 v23, 0x10000, v19
v_add_u32 v24, 0x10000, v20
v_add_u32 v25, 0x10000, v21
M v[216:219],a[244:247],a[148:151],v[216:219]
s_barrier
M v[228:231],a[96:99],v[52:55],v[228:231]
s_nop 0
T a[64:65],v22,32768
T a[66:67],v22,34816
M v[228:231],a[100:103],v[48:51],v[228:231]
T a[68:69],v22,36864
T a[70:71],v22,38912
M v[228:231],a[246:249],a[184:187],v[228:231]
C v161,v162,v163
C v162,v168,v169
M v[224:227],a[246:249],a[152:155],v[224:227]
T a[72:73],v22,40960
T a[74:75],v22,43008
M v[236:239],a[104:107],v[52:55],v[236:239]
T a[76:77],v22,45056
T a[78:79],v22,47104
M v[236:239],a[108:111],v[48:51],v[236:239]
C v163,v170,v171
C v180,v180,v181
M v[236:239],a[244:247],a[184:187],v[236:239]
T a[80:81],v22,49152
T a[82:83],v22,51200
M v[232:235],a[244:247],a[152:155],v[232:235]
T a[84:85],v22,53248
T a[86:87],v22,55296
M v[244:247],a[112:115],v[52:55],v[244:247]
C v181,v182,v183
C v182,v188,v189
M v[244:247],a[116:119],v[48:51],v[244:247]
T a[88:89],v22,57344
T a[90:91],v22,59392
M v[244:247],a[246:249],a[188:191],v[244:247]
T a[92:93],v22,61440
T a[94:95],v22,63488
M v[240:243],a[246:249],a[156:159],v[240:243]
C v183,v190,v191
C v176,v176,v177
M v[252:255],a[120:123],v[52:55],v[252:255]
C v177,v178,v179
C v178,v184,v185
M v[252:255],a[124:127],v[48:51],v[252:255]
C v179,v186,v187
C v196,v196,v197
M v[252:255],a[244:247],a[188:191],v[252:255]
s_waitcnt lgkmcnt(0)
C v197,v198,v199
C v198,v204,v205
M v[248:251],a[244:247],a[156:159],v[248:251]
C v199,v206,v207
C v192,v192,v193
C v193,v194,v195
C v194,v200,v201
C v195,v202,v203
C v212,v212,v213
C v213,v214,v215
C v214,v220,v221
C v215,v222,v223
C v208,v208,v209
C v209,v210,v211
C v210,v216,v217
C v211,v218,v219
C v228,v228,v229
C v229,v230,v231
C v230,v236,v237
C v231,v238,v239
C v224,v224,v225
C v225,v226,v227
C v226,v232,v233
C v227,v234,v235
C v244,v244,v245
C v245,v246,v247
C v246,v252,v253
C v247,v254,v255
C v240,v240,v241
C v241,v242,v243
C v242,v248,v249
C v243,v250,v251
M v[64:67],a[64:67],v[128:131],0
s_sub_u32 s64, 15, s42
T a[96:97],v23,32768
T a[98:99],v23,34816
M v[64:67],a[68:71],v[144:147],v[64:67]
s_min_u32 s64, s64, s42
T a[100:101],v23,36864
T a[102:103],v23,38912
M v[64:67],a[72:75],v[160:163],v[64:67]
s_mul_i32 s45, s64, 8704
M v[64:67],a[76:79],v[176:179],v[64:67]
s_lshl_b32 s64, s41, 2
T a[104:105],v23,40960
T a[106:107],v23,43008
M v[64:67],a[80:83],v[192:195],v[64:67]
SA s45,s45,s64
T a[108:109],v23,45056
T a[110:111],v23,47104
M v[64:67],a[84:87],v[208:211],v[64:67]
s_lshl_b32 s64, s20, 8
M v[64:67],a[88:91],v[224:227],v[64:67]
SA s45,s45,s64
T a[112:113],v23,49152
T a[114:115],v23,51200
M v[64:67],a[92:95],v[240:243],v[64:67]
SA s45,s45,104992768
T a[116:117],v23,53248
T a[118:119],v23,55296
M v[68:71],a[92:95],v[244:247],0
s_mov_b32 s64, 1024
M v[68:71],a[88:91],v[228:231],v[68:71]
s_mov_b32 s66, 4096
T a[120:121],v23,57344
T a[122:123],v23,59392
M v[68:71],a[84:87],v[212:215],v[68:71]
s_cmp_lt_u32 s42, 8
T a[124:125],v23,61440
T a[126:127],v23,63488
M v[68:71],a[80:83],v[196:199],v[68:71]
s_cselect_b32 s64, 4352, s64
M v[68:71],a[76:79],v[180:183],v[68:71]
s_cselect_b32 s65, 0, 64
M v[68:71],a[72:75],v[164:167],v[68:71]
s_cselect_b32 s66, 536870912, s66
M v[68:71],a[68:71],v[148:151],v[68:71]
SA s3,s45,s64
M v[68:71],a[64:67],v[132:135],v[68:71]
s_waitcnt lgkmcnt(0)
M v[72:75],a[96:99],v[128:131],0
SA s45,s45,s65
T a[64:65],v24,32768
T a[66:67],v24,34816
M v[72:75],a[100:103],v[144:147],v[72:75]
SA m0,s28,0
T a[68:69],v24,36864
T a[70:71],v24,38912
M v[72:75],a[104:107],v[160:163],v[72:75]
SA s85,s38,0
buffer_load_dwordx4 v0, s[12:15], s85 offen offset:0 lds
M v[72:75],a[108:111],v[176:179],v[72:75]
SA s85,s38,6144
T a[72:73],v24,40960
T a[74:75],v24,43008
M v[72:75],a[112:115],v[192:195],v[72:75]
SA s29,s33,0
T a[76:77],v24,45056
T a[78:79],v24,47104
M v[72:75],a[116:119],v[208:211],v[72:75]
SA s30,s33,14336
buffer_load_dwordx4 v0, s[12:15], s85 offen offset:1024 lds
M v[72:75],a[120:123],v[224:227],v[72:75]
SA s85,s38,12288
T a[80:81],v24,49152
T a[82:83],v24,51200
M v[72:75],a[124:127],v[240:243],v[72:75]
T a[84:85],v24,53248
T a[86:87],v24,55296
M v[76:79],a[124:127],v[244:247],0
buffer_load_dwordx4 v0, s[12:15], s85 offen offset:2048 lds
M v[76:79],a[120:123],v[228:231],v[76:79]
SA s85,s38,18432
T a[88:89],v24,57344
T a[90:91],v24,59392
M v[76:79],a[116:119],v[212:215],v[76:79]
T a[92:93],v24,61440
T a[94:95],v24,63488
M v[76:79],a[112:115],v[196:199],v[76:79]
buffer_load_dwordx4 v0, s[12:15], s85 offen offset:3072 lds
M v[76:79],a[108:111],v[180:183],v[76:79]
SA m0,s28,4096
v_lshrrev_b32 v17, 5, v7
v_min_u32 v15, 1, v17
M v[76:79],a[104:107],v[164:167],v[76:79]
SA s85,s38,28672
buffer_load_dwordx4 v0, s[12:15], s85 offen offset:0 lds
M v[76:79],a[100:103],v[148:151],v[76:79]
SA s85,s38,34816
v_lshlrev_b32 v14, 3, v7
v_lshl_or_b32 v16, v15, 29, v14
M v[76:79],a[96:99],v[132:135],v[76:79]
s_waitcnt lgkmcnt(0)
buffer_load_dwordx4 v0, s[12:15], s85 offen offset:1024 lds
M v[80:83],a[64:67],v[128:131],0
SA s85,s38,40960
T a[96:97],v25,32768
T a[98:99],v25,34816
M v[80:83],a[68:71],v[144:147],v[80:83]
T a[100:101],v25,36864
T a[102:103],v25,38912
M v[80:83],a[72:75],v[160:163],v[80:83]
buffer_load_dwordx4 v0, s[12:15], s85 offen offset:2048 lds
M v[80:83],a[76:79],v[176:179],v[80:83]
SA s85,s38,47104
T a[104:105],v25,40960
T a[106:107],v25,43008
M v[80:83],a[80:83],v[192:195],v[80:83]
T a[108:109],v25,45056
T a[110:111],v25,47104
M v[80:83],a[84:87],v[208:211],v[80:83]
buffer_load_dwordx4 v0, s[12:15], s85 offen offset:3072 lds
M v[80:83],a[88:91],v[224:227],v[80:83]
SA s38,s38,128
T a[112:113],v25,49152
T a[114:115],v25,51200
M v[80:83],a[92:95],v[240:243],v[80:83]
SA m0,s28,131072
T a[116:117],v25,53248
T a[118:119],v25,55296
M v[84:87],a[92:95],v[244:247],0
SA s85,s38,0
buffer_load_dwordx4 v0, s[12:15], s85 offen offset:0 lds
M v[84:87],a[88:91],v[228:231],v[84:87]
SA s85,s38,6144
T a[120:121],v25,57344
T a[122:123],v25,59392
M v[84:87],a[84:87],v[212:215],v[84:87]
T a[124:125],v25,61440
T a[126:127],v25,63488
M v[84:87],a[80:83],v[196:199],v[84:87]
buffer_load_dwordx4 v0, s[12:15], s85 offen offset:1024 lds
M v[84:87],a[76:79],v[180:183],v[84:87]
SA s85,s38,12288
v_cmp_eq_u32 vcc, 1, v17
v_add_u32 v14, s66, v14
M v[84:87],a[72:75],v[164:167],v[84:87]
buffer_load_dwordx4 v0, s[12:15], s85 offen offset:2048 lds
M v[84:87],a[68:71],v[148:151],v[84:87]
s_waitcnt vmcnt(19) lgkmcnt(0)
v_mov_b32 v15, 1
v_cndmask_b32 v17, v16, v14, vcc
M v[84:87],a[64:67],v[132:135],v[84:87]
s_barrier
M v[88:91],a[96:99],v[128:131],0
SA s85,s38,18432
T a[64:65],v18,32768
T a[66:67],v18,34816
M v[88:91],a[100:103],v[144:147],v[88:91]
T a[68:69],v18,36864
T a[70:71],v18,38912
M v[88:91],a[104:107],v[160:163],v[88:91]
buffer_load_dwordx4 v0, s[12:15], s85 offen offset:3072 lds
M v[88:91],a[108:111],v[176:179],v[88:91]
SA m0,s28,135168
T a[72:73],v18,40960
T a[74:75],v18,43008
M v[88:91],a[112:115],v[192:195],v[88:91]
SA s85,s38,28672
T a[76:77],v18,45056
T a[78:79],v18,47104
M v[88:91],a[116:119],v[208:211],v[88:91]
buffer_load_dwordx4 v0, s[12:15], s85 offen offset:0 lds
M v[88:91],a[120:123],v[224:227],v[88:91]
SA s85,s38,34816
T a[80:81],v18,49152
T a[82:83],v18,51200
M v[88:91],a[124:127],v[240:243],v[88:91]
T a[84:85],v18,53248
T a[86:87],v18,55296
M v[92:95],a[124:127],v[244:247],0
buffer_load_dwordx4 v0, s[12:15], s85 offen offset:1024 lds
M v[92:95],a[120:123],v[228:231],v[92:95]
SA s85,s38,40960
T a[88:89],v18,57344
T a[90:91],v18,59392
M v[92:95],a[116:119],v[212:215],v[92:95]
T a[92:93],v18,61440
T a[94:95],v18,63488
M v[92:95],a[112:115],v[196:199],v[92:95]
buffer_load_dwordx4 v0, s[12:15], s85 offen offset:2048 lds
M v[92:95],a[108:111],v[180:183],v[92:95]
SA s85,s38,47104
v_add_u32 v40, 0x20000, v18
v_add_u32 v41, 0x20000, v19
M v[92:95],a[104:107],v[164:167],v[92:95]
buffer_load_dwordx4 v0, s[12:15], s85 offen offset:3072 lds
M v[92:95],a[100:103],v[148:151],v[92:95]
s_waitcnt lgkmcnt(0)
v_add_u32 v42, 0x20000, v20
v_add_u32 v43, 0x20000, v21
M v[92:95],a[96:99],v[132:135],v[92:95]
SA s38,s38,128
MF v64,v5,v64
MF v65,v5,v65
MF v66,v5,v66
MF v67,v5,v67
MF v72,v5,v72
MF v73,v5,v73
MF v74,v5,v74
MF v75,v5,v75
C v64,v64,v65
C v65,v66,v67
C v66,v72,v73
C v67,v74,v75
buffer_store_dwordx4 v[64:67], v7, s[8:11], s29 offen offset:0 sc1
MF v68,v6,v68
MF v69,v6,v69
MF v70,v6,v70
MF v71,v6,v71
MF v76,v6,v76
MF v77,v6,v77
MF v78,v6,v78
MF v79,v6,v79
C v68,v68,v69
C v69,v70,v71
C v70,v76,v77
C v71,v78,v79
buffer_store_dwordx4 v[68:71], v7, s[8:11], s30 offen offset:0 sc1
M v[96:99],a[64:67],v[128:131],0
s_nop 0
T a[96:97],v19,32768
T a[98:99],v19,34816
M v[96:99],a[68:71],v[144:147],v[96:99]
SA m0,s28,98304
T a[100:101],v19,36864
T a[102:103],v19,38912
M v[96:99],a[72:75],v[160:163],v[96:99]
SA s85,s38,0
buffer_load_dwordx4 v0, s[12:15], s85 offen offset:0 lds
M v[96:99],a[76:79],v[176:179],v[96:99]
s_nop 0
T a[104:105],v19,40960
T a[106:107],v19,43008
M v[96:99],a[80:83],v[192:195],v[96:99]
T a[108:109],v19,45056
T a[110:111],v19,47104
M v[96:99],a[84:87],v[208:211],v[96:99]
SA s85,s38,6144
MF v80,v5,v80
MF v81,v5,v81
M v[96:99],a[88:91],v[224:227],v[96:99]
T a[112:113],v19,49152
T a[114:115],v19,51200
M v[96:99],a[92:95],v[240:243],v[96:99]
T a[116:117],v19,53248
T a[118:119],v19,55296
M v[100:103],a[92:95],v[244:247],0
buffer_load_dwordx4 v0, s[12:15], s85 offen offset:1024 lds
M v[100:103],a[88:91],v[228:231],v[100:103]
s_nop 0
T a[120:121],v19,57344
T a[122:123],v19,59392
M v[100:103],a[84:87],v[212:215],v[100:103]
T a[124:125],v19,61440
T a[126:127],v19,63488
M v[100:103],a[80:83],v[196:199],v[100:103]
SA s85,s38,12288
MF v82,v5,v82
MF v83,v5,v83
M v[100:103],a[76:79],v[180:183],v[100:103]
buffer_load_dwordx4 v0, s[12:15], s85 offen offset:2048 lds
M v[100:103],a[72:75],v[164:167],v[100:103]
MF v88,v5,v88
MF v89,v5,v89
M v[100:103],a[68:71],v[148:151],v[100:103]
MF v90,v5,v90
MF v91,v5,v91
M v[100:103],a[64:67],v[132:135],v[100:103]
s_waitcnt lgkmcnt(0)
C v80,v80,v81
C v81,v82,v83
M v[104:107],a[96:99],v[128:131],0
SA s85,s38,18432
T a[64:65],v20,32768
T a[66:67],v20,34816
M v[104:107],a[100:103],v[144:147],v[104:107]
T a[68:69],v20,36864
T a[70:71],v20,38912
M v[104:107],a[104:107],v[160:163],v[104:107]
buffer_load_dwordx4 v0, s[12:15], s85 offen offset:3072 lds
M v[104:107],a[108:111],v[176:179],v[104:107]
s_nop 0
T a[72:73],v20,40960
T a[74:75],v20,43008
M v[104:107],a[112:115],v[192:195],v[104:107]
T a[76:77],v20,45056
T a[78:79],v20,47104
M v[104:107],a[116:119],v[208:211],v[104:107]
SA m0,s28,102400
C v82,v88,v89
C v83,v90,v91
M v[104:107],a[120:123],v[224:227],v[104:107]
SA s85,s38,28672
T a[80:81],v20,49152
T a[82:83],v20,51200
M v[104:107],a[124:127],v[240:243],v[104:107]
T a[84:85],v20,53248
T a[86:87],v20,55296
M v[108:111],a[124:127],v[244:247],0
buffer_store_dwordx4 v[80:83], v7, s[8:11], s29 offen offset:1024 sc1
M v[108:111],a[120:123],v[228:231],v[108:111]
s_nop 0
T a[88:89],v20,57344
T a[90:91],v20,59392
M v[108:111],a[116:119],v[212:215],v[108:111]
T a[92:93],v20,61440
T a[94:95],v20,63488
M v[108:111],a[112:115],v[196:199],v[108:111]
buffer_load_dwordx4 v0, s[12:15], s85 offen offset:0 lds
M v[108:111],a[108:111],v[180:183],v[108:111]
SA s85,s38,34816
MF v84,v6,v84
MF v85,v6,v85
M v[108:111],a[104:107],v[164:167],v[108:111]
MF v86,v6,v86
MF v87,v6,v87
M v[108:111],a[100:103],v[148:151],v[108:111]
buffer_load_dwordx4 v0, s[12:15], s85 offen offset:1024 lds
M v[108:111],a[96:99],v[132:135],v[108:111]
s_waitcnt lgkmcnt(0)
MF v92,v6,v92
MF v93,v6,v93
M v[112:115],a[64:67],v[128:131],0
T a[96:97],v21,32768
T a[98:99],v21,34816
M v[112:115],a[68:71],v[144:147],v[112:115]
SA s85,s38,40960
T a[100:101],v21,36864
T a[102:103],v21,38912
M v[112:115],a[72:75],v[160:163],v[112:115]
buffer_load_dwordx4 v0, s[12:15], s85 offen offset:2048 lds
M v[112:115],a[76:79],v[176:179],v[112:115]
s_nop 0
T a[104:105],v21,40960
T a[106:107],v21,43008
M v[112:115],a[80:83],v[192:195],v[112:115]
T a[108:109],v21,45056
T a[110:111],v21,47104
M v[112:115],a[84:87],v[208:211],v[112:115]
MF v94,v6,v94
MF v95,v6,v95
M v[112:115],a[88:91],v[224:227],v[112:115]
SA s85,s38,47104
T a[112:113],v21,49152
T a[114:115],v21,51200
M v[112:115],a[92:95],v[240:243],v[112:115]
T a[116:117],v21,53248
T a[118:119],v21,55296
M v[116:119],a[92:95],v[244:247],0
buffer_load_dwordx4 v0, s[12:15], s85 offen offset:3072 lds
M v[116:119],a[88:91],v[228:231],v[116:119]
s_nop 0
T a[120:121],v21,57344
T a[122:123],v21,59392
M v[116:119],a[84:87],v[212:215],v[116:119]
T a[124:125],v21,61440
T a[126:127],v21,63488
M v[116:119],a[80:83],v[196:199],v[116:119]
C v84,v84,v85
C v85,v86,v87
M v[116:119],a[76:79],v[180:183],v[116:119]
C v86,v92,v93
C v87,v94,v95
M v[116:119],a[72:75],v[164:167],v[116:119]
SA s38,s38,128
buffer_store_dwordx4 v[84:87], v7, s[8:11], s30 offen offset:1024 sc1
M v[116:119],a[68:71],v[148:151],v[116:119]
s_waitcnt vmcnt(28) lgkmcnt(0)
M v[116:119],a[64:67],v[132:135],v[116:119]
s_barrier
M v[120:123],a[96:99],v[128:131],0
SA s29,s33,2048
T a[64:65],v22,0
T a[66:67],v22,2048
M v[120:123],a[100:103],v[144:147],v[120:123]
SA s30,s33,16384
T a[68:69],v22,4096
T a[70:71],v22,6144
M v[120:123],a[104:107],v[160:163],v[120:123]
MF v96,v5,v96
MF v97,v5,v97
M v[120:123],a[108:111],v[176:179],v[120:123]
T a[72:73],v22,8192
T a[74:75],v22,10240
M v[120:123],a[112:115],v[192:195],v[120:123]
T a[76:77],v22,12288
T a[78:79],v22,14336
M v[120:123],a[116:119],v[208:211],v[120:123]
MF v98,v5,v98
MF v99,v5,v99
M v[120:123],a[120:123],v[224:227],v[120:123]
T a[80:81],v22,16384
T a[82:83],v22,18432
M v[120:123],a[124:127],v[240:243],v[120:123]
T a[84:85],v22,20480
T a[86:87],v22,22528
M v[124:127],a[124:127],v[244:247],0
MF v104,v5,v104
MF v105,v5,v105
M v[124:127],a[120:123],v[228:231],v[124:127]
T a[88:89],v22,24576
T a[90:91],v22,26624
M v[124:127],a[116:119],v[212:215],v[124:127]
T a[92:93],v22,28672
T a[94:95],v22,30720
M v[124:127],a[112:115],v[196:199],v[124:127]
MF v106,v5,v106
MF v107,v5,v107
M v[124:127],a[108:111],v[180:183],v[124:127]
C v96,v96,v97
C v97,v98,v99
M v[124:127],a[104:107],v[164:167],v[124:127]
C v98,v104,v105
C v99,v106,v107
M v[124:127],a[100:103],v[148:151],v[124:127]
s_waitcnt lgkmcnt(0)
buffer_store_dwordx4 v[96:99], v7, s[8:11], s29 offen offset:0 sc1
M v[124:127],a[96:99],v[132:135],v[124:127]
MF v100,v6,v100
MF v101,v6,v101
MF v102,v6,v102
MF v103,v6,v103
MF v108,v6,v108
MF v109,v6,v109
MF v110,v6,v110
MF v111,v6,v111
C v100,v100,v101
C v101,v102,v103
C v102,v108,v109
C v103,v110,v111
buffer_store_dwordx4 v[100:103], v7, s[8:11], s30 offen offset:0 sc1
M v[64:67],a[64:67],v[128:131],0
s_nop 0
T a[96:97],v23,0
T a[98:99],v23,2048
M v[64:67],a[68:71],v[144:147],v[64:67]
SA m0,s28,32768
T a[100:101],v23,4096
T a[102:103],v23,6144
M v[64:67],a[72:75],v[160:163],v[64:67]
SA s85,s38,0
buffer_load_dwordx4 v0, s[12:15], s85 offen offset:0 lds
M v[64:67],a[76:79],v[176:179],v[64:67]
s_nop 0
T a[104:105],v23,8192
T a[106:107],v23,10240
M v[64:67],a[80:83],v[192:195],v[64:67]
T a[108:109],v23,12288
T a[110:111],v23,14336
M v[64:67],a[84:87],v[208:211],v[64:67]
SA s85,s38,6144
MF v112,v5,v112
MF v113,v5,v113
M v[64:67],a[88:91],v[224:227],v[64:67]
T a[112:113],v23,16384
T a[114:115],v23,18432
M v[64:67],a[92:95],v[240:243],v[64:67]
T a[116:117],v23,20480
T a[118:119],v23,22528
M v[68:71],a[92:95],v[244:247],0
buffer_load_dwordx4 v0, s[12:15], s85 offen offset:1024 lds
M v[68:71],a[88:91],v[228:231],v[68:71]
s_nop 0
T a[120:121],v23,24576
T a[122:123],v23,26624
M v[68:71],a[84:87],v[212:215],v[68:71]
T a[124:125],v23,28672
T a[126:127],v23,30720
M v[68:71],a[80:83],v[196:199],v[68:71]
SA s85,s38,12288
MF v114,v5,v114
MF v115,v5,v115
M v[68:71],a[76:79],v[180:183],v[68:71]
buffer_load_dwordx4 v0, s[12:15], s85 offen offset:2048 lds
M v[68:71],a[72:75],v[164:167],v[68:71]
MF v120,v5,v120
MF v121,v5,v121
M v[68:71],a[68:71],v[148:151],v[68:71]
MF v122,v5,v122
MF v123,v5,v123
M v[68:71],a[64:67],v[132:135],v[68:71]
s_waitcnt lgkmcnt(0)
C v112,v112,v113
C v113,v114,v115
M v[72:75],a[96:99],v[128:131],0
SA s85,s38,18432
T a[64:65],v24,0
T a[66:67],v24,2048
M v[72:75],a[100:103],v[144:147],v[72:75]
T a[68:69],v24,4096
T a[70:71],v24,6144
M v[72:75],a[104:107],v[160:163],v[72:75]
buffer_load_dwordx4 v0, s[12:15], s85 offen offset:3072 lds
M v[72:75],a[108:111],v[176:179],v[72:75]
s_nop 0
T a[72:73],v24,8192
T a[74:75],v24,10240
M v[72:75],a[112:115],v[192:195],v[72:75]
T a[76:77],v24,12288
T a[78:79],v24,14336
M v[72:75],a[116:119],v[208:211],v[72:75]
SA m0,s28,36864
C v114,v120,v121
C v115,v122,v123
M v[72:75],a[120:123],v[224:227],v[72:75]
SA s85,s38,28672
T a[80:81],v24,16384
T a[82:83],v24,18432
M v[72:75],a[124:127],v[240:243],v[72:75]
T a[84:85],v24,20480
T a[86:87],v24,22528
M v[76:79],a[124:127],v[244:247],0
buffer_store_dwordx4 v[112:115], v7, s[8:11], s29 offen offset:1024 sc1
M v[76:79],a[120:123],v[228:231],v[76:79]
s_nop 0
T a[88:89],v24,24576
T a[90:91],v24,26624
M v[76:79],a[116:119],v[212:215],v[76:79]
T a[92:93],v24,28672
T a[94:95],v24,30720
M v[76:79],a[112:115],v[196:199],v[76:79]
buffer_load_dwordx4 v0, s[12:15], s85 offen offset:0 lds
M v[76:79],a[108:111],v[180:183],v[76:79]
SA s85,s38,34816
MF v116,v6,v116
MF v117,v6,v117
M v[76:79],a[104:107],v[164:167],v[76:79]
MF v118,v6,v118
MF v119,v6,v119
M v[76:79],a[100:103],v[148:151],v[76:79]
buffer_load_dwordx4 v0, s[12:15], s85 offen offset:1024 lds
M v[76:79],a[96:99],v[132:135],v[76:79]
s_waitcnt lgkmcnt(0)
MF v124,v6,v124
MF v125,v6,v125
M v[80:83],a[64:67],v[128:131],0
T a[96:97],v25,0
T a[98:99],v25,2048
M v[80:83],a[68:71],v[144:147],v[80:83]
SA s85,s38,40960
T a[100:101],v25,4096
T a[102:103],v25,6144
M v[80:83],a[72:75],v[160:163],v[80:83]
buffer_load_dwordx4 v0, s[12:15], s85 offen offset:2048 lds
M v[80:83],a[76:79],v[176:179],v[80:83]
s_nop 0
T a[104:105],v25,8192
T a[106:107],v25,10240
M v[80:83],a[80:83],v[192:195],v[80:83]
T a[108:109],v25,12288
T a[110:111],v25,14336
M v[80:83],a[84:87],v[208:211],v[80:83]
MF v126,v6,v126
MF v127,v6,v127
M v[80:83],a[88:91],v[224:227],v[80:83]
SA s85,s38,47104
T a[112:113],v25,16384
T a[114:115],v25,18432
M v[80:83],a[92:95],v[240:243],v[80:83]
T a[116:117],v25,20480
T a[118:119],v25,22528
M v[84:87],a[92:95],v[244:247],0
buffer_load_dwordx4 v0, s[12:15], s85 offen offset:3072 lds
M v[84:87],a[88:91],v[228:231],v[84:87]
s_nop 0
T a[120:121],v25,24576
T a[122:123],v25,26624
M v[84:87],a[84:87],v[212:215],v[84:87]
T a[124:125],v25,28672
T a[126:127],v25,30720
M v[84:87],a[80:83],v[196:199],v[84:87]
C v116,v116,v117
C v117,v118,v119
M v[84:87],a[76:79],v[180:183],v[84:87]
C v118,v124,v125
C v119,v126,v127
M v[84:87],a[72:75],v[164:167],v[84:87]
SA s38,s38,128
buffer_store_dwordx4 v[116:119], v7, s[8:11], s30 offen offset:1024 sc1
M v[84:87],a[68:71],v[148:151],v[84:87]
s_waitcnt vmcnt(32) lgkmcnt(0)
M v[84:87],a[64:67],v[132:135],v[84:87]
s_barrier
M v[88:91],a[96:99],v[128:131],0
SA s29,s33,4096
T a[64:65],v18,0
T a[66:67],v18,2048
M v[88:91],a[100:103],v[144:147],v[88:91]
SA s30,s33,18432
T a[68:69],v18,4096
T a[70:71],v18,6144
M v[88:91],a[104:107],v[160:163],v[88:91]
MF v64,v5,v64
MF v65,v5,v65
M v[88:91],a[108:111],v[176:179],v[88:91]
T a[72:73],v18,8192
T a[74:75],v18,10240
M v[88:91],a[112:115],v[192:195],v[88:91]
T a[76:77],v18,12288
T a[78:79],v18,14336
M v[88:91],a[116:119],v[208:211],v[88:91]
MF v66,v5,v66
MF v67,v5,v67
M v[88:91],a[120:123],v[224:227],v[88:91]
T a[80:81],v18,16384
T a[82:83],v18,18432
M v[88:91],a[124:127],v[240:243],v[88:91]
T a[84:85],v18,20480
T a[86:87],v18,22528
M v[92:95],a[124:127],v[244:247],0
MF v72,v5,v72
MF v73,v5,v73
M v[92:95],a[120:123],v[228:231],v[92:95]
T a[88:89],v18,24576
T a[90:91],v18,26624
M v[92:95],a[116:119],v[212:215],v[92:95]
T a[92:93],v18,28672
T a[94:95],v18,30720
M v[92:95],a[112:115],v[196:199],v[92:95]
MF v74,v5,v74
MF v75,v5,v75
M v[92:95],a[108:111],v[180:183],v[92:95]
C v64,v64,v65
C v65,v66,v67
M v[92:95],a[104:107],v[164:167],v[92:95]
C v66,v72,v73
C v67,v74,v75
M v[92:95],a[100:103],v[148:151],v[92:95]
s_waitcnt lgkmcnt(0)
buffer_store_dwordx4 v[64:67], v7, s[8:11], s29 offen offset:0 sc1
M v[92:95],a[96:99],v[132:135],v[92:95]
MF v68,v6,v68
MF v69,v6,v69
MF v70,v6,v70
MF v71,v6,v71
MF v76,v6,v76
MF v77,v6,v77
MF v78,v6,v78
MF v79,v6,v79
C v68,v68,v69
C v69,v70,v71
C v70,v76,v77
C v71,v78,v79
buffer_store_dwordx4 v[68:71], v7, s[8:11], s30 offen offset:0 sc1
M v[96:99],a[64:67],v[128:131],0
s_nop 0
T a[96:97],v19,0
T a[98:99],v19,2048
M v[96:99],a[68:71],v[144:147],v[96:99]
T a[100:101],v19,4096
T a[102:103],v19,6144
M v[96:99],a[72:75],v[160:163],v[96:99]
MF v80,v5,v80
MF v81,v5,v81
M v[96:99],a[76:79],v[176:179],v[96:99]
T a[104:105],v19,8192
T a[106:107],v19,10240
M v[96:99],a[80:83],v[192:195],v[96:99]
T a[108:109],v19,12288
T a[110:111],v19,14336
M v[96:99],a[84:87],v[208:211],v[96:99]
MF v82,v5,v82
MF v83,v5,v83
M v[96:99],a[88:91],v[224:227],v[96:99]
T a[112:113],v19,16384
T a[114:115],v19,18432
M v[96:99],a[92:95],v[240:243],v[96:99]
T a[116:117],v19,20480
T a[118:119],v19,22528
M v[100:103],a[92:95],v[244:247],0
MF v88,v5,v88
MF v89,v5,v89
M v[100:103],a[88:91],v[228:231],v[100:103]
T a[120:121],v19,24576
T a[122:123],v19,26624
M v[100:103],a[84:87],v[212:215],v[100:103]
T a[124:125],v19,28672
T a[126:127],v19,30720
M v[100:103],a[80:83],v[196:199],v[100:103]
MF v90,v5,v90
MF v91,v5,v91
M v[100:103],a[76:79],v[180:183],v[100:103]
C v80,v80,v81
C v81,v82,v83
M v[100:103],a[72:75],v[164:167],v[100:103]
C v82,v88,v89
C v83,v90,v91
M v[100:103],a[68:71],v[148:151],v[100:103]
buffer_store_dwordx4 v[80:83], v7, s[8:11], s29 offen offset:1024 sc1
M v[100:103],a[64:67],v[132:135],v[100:103]
s_waitcnt lgkmcnt(0)
MF v84,v6,v84
MF v85,v6,v85
M v[104:107],a[96:99],v[128:131],0
T a[64:65],v20,0
T a[66:67],v20,2048
M v[104:107],a[100:103],v[144:147],v[104:107]
T a[68:69],v20,4096
T a[70:71],v20,6144
M v[104:107],a[104:107],v[160:163],v[104:107]
MF v86,v6,v86
MF v87,v6,v87
M v[104:107],a[108:111],v[176:179],v[104:107]
T a[72:73],v20,8192
T a[74:75],v20,10240
M v[104:107],a[112:115],v[192:195],v[104:107]
T a[76:77],v20,12288
T a[78:79],v20,14336
M v[104:107],a[116:119],v[208:211],v[104:107]
MF v92,v6,v92
MF v93,v6,v93
M v[104:107],a[120:123],v[224:227],v[104:107]
T a[80:81],v20,16384
T a[82:83],v20,18432
M v[104:107],a[124:127],v[240:243],v[104:107]
T a[84:85],v20,20480
T a[86:87],v20,22528
M v[108:111],a[124:127],v[244:247],0
MF v94,v6,v94
MF v95,v6,v95
M v[108:111],a[120:123],v[228:231],v[108:111]
T a[88:89],v20,24576
T a[90:91],v20,26624
M v[108:111],a[116:119],v[212:215],v[108:111]
T a[92:93],v20,28672
T a[94:95],v20,30720
M v[108:111],a[112:115],v[196:199],v[108:111]
C v84,v84,v85
C v85,v86,v87
M v[108:111],a[108:111],v[180:183],v[108:111]
C v86,v92,v93
C v87,v94,v95
M v[108:111],a[104:107],v[164:167],v[108:111]
buffer_store_dwordx4 v[84:87], v7, s[8:11], s30 offen offset:1024 sc1
M v[108:111],a[100:103],v[148:151],v[108:111]
SA s29,s33,6144
M v[108:111],a[96:99],v[132:135],v[108:111]
s_waitcnt lgkmcnt(0)
M v[112:115],a[64:67],v[128:131],0
SA s30,s33,20480
T a[96:97],v21,0
T a[98:99],v21,2048
M v[112:115],a[68:71],v[144:147],v[112:115]
T a[100:101],v21,4096
T a[102:103],v21,6144
M v[112:115],a[72:75],v[160:163],v[112:115]
MF v96,v5,v96
MF v97,v5,v97
M v[112:115],a[76:79],v[176:179],v[112:115]
T a[104:105],v21,8192
T a[106:107],v21,10240
M v[112:115],a[80:83],v[192:195],v[112:115]
T a[108:109],v21,12288
T a[110:111],v21,14336
M v[112:115],a[84:87],v[208:211],v[112:115]
MF v98,v5,v98
MF v99,v5,v99
M v[112:115],a[88:91],v[224:227],v[112:115]
T a[112:113],v21,16384
T a[114:115],v21,18432
M v[112:115],a[92:95],v[240:243],v[112:115]
T a[116:117],v21,20480
T a[118:119],v21,22528
M v[116:119],a[92:95],v[244:247],0
MF v104,v5,v104
MF v105,v5,v105
M v[116:119],a[88:91],v[228:231],v[116:119]
T a[120:121],v21,24576
T a[122:123],v21,26624
M v[116:119],a[84:87],v[212:215],v[116:119]
T a[124:125],v21,28672
T a[126:127],v21,30720
M v[116:119],a[80:83],v[196:199],v[116:119]
MF v106,v5,v106
MF v107,v5,v107
M v[116:119],a[76:79],v[180:183],v[116:119]
C v96,v96,v97
C v97,v98,v99
M v[116:119],a[72:75],v[164:167],v[116:119]
C v98,v104,v105
C v99,v106,v107
M v[116:119],a[68:71],v[148:151],v[116:119]
s_waitcnt vmcnt(28) lgkmcnt(0)
buffer_store_dwordx4 v[96:99], v7, s[8:11], s29 offen offset:0 sc1
M v[116:119],a[64:67],v[132:135],v[116:119]
s_barrier
M v[120:123],a[96:99],v[128:131],0
s_nop 0
T a[64:65],v40,0
T a[66:67],v40,2048
M v[120:123],a[100:103],v[144:147],v[120:123]
T a[68:69],v40,4096
T a[70:71],v40,6144
M v[120:123],a[104:107],v[160:163],v[120:123]
MF v100,v6,v100
MF v101,v6,v101
M v[120:123],a[108:111],v[176:179],v[120:123]
T a[72:73],v40,8192
T a[74:75],v40,10240
M v[120:123],a[112:115],v[192:195],v[120:123]
T a[76:77],v40,12288
T a[78:79],v40,14336
M v[120:123],a[116:119],v[208:211],v[120:123]
MF v102,v6,v102
MF v103,v6,v103
M v[120:123],a[120:123],v[224:227],v[120:123]
T a[80:81],v40,16384
T a[82:83],v40,18432
M v[120:123],a[124:127],v[240:243],v[120:123]
T a[84:85],v40,20480
T a[86:87],v40,22528
M v[124:127],a[124:127],v[244:247],0
MF v108,v6,v108
MF v109,v6,v109
M v[124:127],a[120:123],v[228:231],v[124:127]
T a[88:89],v40,24576
T a[90:91],v40,26624
M v[124:127],a[116:119],v[212:215],v[124:127]
T a[92:93],v40,28672
T a[94:95],v40,30720
M v[124:127],a[112:115],v[196:199],v[124:127]
MF v110,v6,v110
MF v111,v6,v111
M v[124:127],a[108:111],v[180:183],v[124:127]
C v100,v100,v101
C v101,v102,v103
M v[124:127],a[104:107],v[164:167],v[124:127]
C v102,v108,v109
C v103,v110,v111
M v[124:127],a[100:103],v[148:151],v[124:127]
s_waitcnt lgkmcnt(0)
buffer_store_dwordx4 v[100:103], v7, s[8:11], s30 offen offset:0 sc1
M v[124:127],a[96:99],v[132:135],v[124:127]
M v[64:67],a[64:67],v[128:131],0
s_nop 0
T a[96:97],v41,0
T a[98:99],v41,2048
M v[64:67],a[68:71],v[144:147],v[64:67]
T a[100:101],v41,4096
T a[102:103],v41,6144
M v[64:67],a[72:75],v[160:163],v[64:67]
v_lshrrev_b32 v32, 4, v7
MF v112,v5,v112
M v[64:67],a[76:79],v[176:179],v[64:67]
s_lshr_b32 s74, s41, 3
T a[104:105],v41,8192
T a[106:107],v41,10240
M v[64:67],a[80:83],v[192:195],v[64:67]
s_sub_u32 s64, 15, s42
T a[108:109],v41,12288
T a[110:111],v41,14336
M v[64:67],a[84:87],v[208:211],v[64:67]
s_mul_i32 s46, s64, 8704
MF v113,v5,v113
MF v114,v5,v114
M v[64:67],a[88:91],v[224:227],v[64:67]
s_and_b32 s72, s41, 7
T a[112:113],v41,16384
T a[114:115],v41,18432
M v[64:67],a[92:95],v[240:243],v[64:67]
s_lshl_b32 s65, s72, 7
T a[116:117],v41,20480
T a[118:119],v41,22528
M v[68:71],a[92:95],v[244:247],0
SA s46,s46,s65
MF v115,v5,v115
MF v120,v5,v120
M v[68:71],a[88:91],v[228:231],v[68:71]
SA s46,s46,104993792
T a[120:121],v41,24576
T a[122:123],v41,26624
M v[68:71],a[84:87],v[212:215],v[68:71]
T a[124:125],v41,28672
T a[126:127],v41,30720
M v[68:71],a[80:83],v[196:199],v[68:71]
v_and_b32 v33, 31, v32
MF v121,v5,v121
M v[68:71],a[76:79],v[180:183],v[68:71]
MF v122,v5,v122
MF v123,v5,v123
M v[68:71],a[72:75],v[164:167],v[68:71]
C v112,v112,v113
C v113,v114,v115
M v[68:71],a[68:71],v[148:151],v[68:71]
C v114,v120,v121
C v115,v122,v123
M v[68:71],a[64:67],v[132:135],v[68:71]
s_waitcnt lgkmcnt(0)
buffer_store_dwordx4 v[112:115], v7, s[8:11], s29 offen offset:1024 sc1
M v[72:75],a[96:99],v[128:131],0
s_nop 0
T a[64:65],v42,0
T a[66:67],v42,2048
M v[72:75],a[100:103],v[144:147],v[72:75]
T a[68:69],v42,4096
T a[70:71],v42,6144
M v[72:75],a[104:107],v[160:163],v[72:75]
MF v116,v6,v116
MF v117,v6,v117
M v[72:75],a[108:111],v[176:179],v[72:75]
T a[72:73],v42,8192
T a[74:75],v42,10240
M v[72:75],a[112:115],v[192:195],v[72:75]
T a[76:77],v42,12288
T a[78:79],v42,14336
M v[72:75],a[116:119],v[208:211],v[72:75]
MF v118,v6,v118
MF v119,v6,v119
M v[72:75],a[120:123],v[224:227],v[72:75]
T a[80:81],v42,16384
T a[82:83],v42,18432
M v[72:75],a[124:127],v[240:243],v[72:75]
T a[84:85],v42,20480
T a[86:87],v42,22528
M v[76:79],a[124:127],v[244:247],0
MF v124,v6,v124
MF v125,v6,v125
M v[76:79],a[120:123],v[228:231],v[76:79]
T a[88:89],v42,24576
T a[90:91],v42,26624
M v[76:79],a[116:119],v[212:215],v[76:79]
T a[92:93],v42,28672
T a[94:95],v42,30720
M v[76:79],a[112:115],v[196:199],v[76:79]
MF v126,v6,v126
MF v127,v6,v127
M v[76:79],a[108:111],v[180:183],v[76:79]
C v116,v116,v117
C v117,v118,v119
M v[76:79],a[104:107],v[164:167],v[76:79]
C v118,v124,v125
C v119,v126,v127
M v[76:79],a[100:103],v[148:151],v[76:79]
buffer_store_dwordx4 v[116:119], v7, s[8:11], s30 offen offset:1024 sc1
M v[76:79],a[96:99],v[132:135],v[76:79]
s_waitcnt lgkmcnt(0)
v_lshlrev_b32 v33, 2, v33
M v[80:83],a[64:67],v[128:131],0
SA s29,s33,8192
T a[96:97],v43,0
T a[98:99],v43,2048
M v[80:83],a[68:71],v[144:147],v[80:83]
SA s30,s33,22528
T a[100:101],v43,4096
T a[102:103],v43,6144
M v[80:83],a[72:75],v[160:163],v[80:83]
s_lshl_b32 s65, s41, 7
MF v64,v5,v64
MF v65,v5,v65
M v[80:83],a[76:79],v[176:179],v[80:83]
SA s65,s65,104890368
T a[104:105],v43,8192
T a[106:107],v43,10240
M v[80:83],a[80:83],v[192:195],v[80:83]
T a[108:109],v43,12288
T a[110:111],v43,14336
M v[80:83],a[84:87],v[208:211],v[80:83]
buffer_load_dword v31, v33, s[8:11], s65 offen sc1
M v[80:83],a[88:91],v[224:227],v[80:83]
s_nop 0
T a[112:113],v43,16384
T a[114:115],v43,18432
M v[80:83],a[92:95],v[240:243],v[80:83]
T a[116:117],v43,20480
T a[118:119],v43,22528
M v[84:87],a[92:95],v[244:247],0
s_cmp_ge_u32 s42, 8
v_bfe_u32 v34, v32, 4, 1
v_lshlrev_b32 v34, 1, v34
M v[84:87],a[88:91],v[228:231],v[84:87]
s_cselect_b32 s84, s45, 536870912
T a[120:121],v43,24576
T a[122:123],v43,26624
M v[84:87],a[84:87],v[212:215],v[84:87]
T a[124:125],v43,28672
T a[126:127],v43,30720
M v[84:87],a[80:83],v[196:199],v[84:87]
v_lshrrev_b32 v35, 5, v32
v_add_u32 v34, v34, v35
M v[84:87],a[76:79],v[180:183],v[84:87]
s_mov_b32 s52, s96
MF v66,v5,v66
MF v67,v5,v67
M v[84:87],a[72:75],v[164:167],v[84:87]
s_and_b32 s53, s97, 0xffff
MF v72,v5,v72
MF v73,v5,v73
M v[84:87],a[68:71],v[148:151],v[84:87]
s_waitcnt vmcnt(22) lgkmcnt(0)
MF v74,v5,v74
MF v75,v5,v75
M v[84:87],a[64:67],v[132:135],v[84:87]
s_barrier
M v[88:91],a[96:99],v[128:131],0
s_mov_b32 s54, 1835008
T a[64:65],v22,32768
T a[66:67],v22,34816
M v[88:91],a[100:103],v[144:147],v[88:91]
s_mov_b32 s55, 0x20000
T a[68:69],v22,36864
T a[70:71],v22,38912
M v[88:91],a[104:107],v[160:163],v[88:91]
s_mul_i32 s77, s42, 1835008
C v64,v64,v65
C v65,v66,v67
M v[88:91],a[108:111],v[176:179],v[88:91]
s_mul_i32 s78, s72, 14336
T a[72:73],v22,40960
T a[74:75],v22,43008
M v[88:91],a[112:115],v[192:195],v[88:91]
SA s77,s77,s78
T a[76:77],v22,45056
T a[78:79],v22,47104
M v[88:91],a[116:119],v[208:211],v[88:91]
SA s77,s77,67108864
C v66,v72,v73
C v67,v74,v75
M v[88:91],a[120:123],v[224:227],v[88:91]
s_lshl_b32 s79, s74, 2
T a[80:81],v22,49152
T a[82:83],v22,51200
M v[88:91],a[124:127],v[240:243],v[88:91]
SA s79,s79,s20
T a[84:85],v22,53248
T a[86:87],v22,55296
M v[92:95],a[124:127],v[244:247],0
SA s79,s79,6
buffer_store_dwordx4 v[64:67], v7, s[8:11], s29 offen offset:0 sc1
M v[92:95],a[120:123],v[228:231],v[92:95]
s_sub_u32 s67, 13, s79
T a[88:89],v22,57344
T a[90:91],v22,59392
M v[92:95],a[116:119],v[212:215],v[92:95]
s_and_b32 s67, s67, 536870912
T a[92:93],v22,61440
T a[94:95],v22,63488
M v[92:95],a[112:115],v[196:199],v[92:95]
s_lshl_b32 s78, s79, 10
MF v68,v6,v68
MF v69,v6,v69
M v[92:95],a[108:111],v[180:183],v[92:95]
SA s78,s78,s77
MF v70,v6,v70
MF v71,v6,v71
M v[92:95],a[104:107],v[164:167],v[92:95]
s_lshl_b32 s79, s79, 6
MF v76,v6,v76
MF v77,v6,v77
M v[92:95],a[100:103],v[148:151],v[92:95]
s_waitcnt lgkmcnt(0)
MF v78,v6,v78
MF v79,v6,v79
M v[92:95],a[96:99],v[132:135],v[92:95]
s_or_b32 s79, s79, s67
v_or_b32 v27, s67, v7
s_lshr_b32 s73, s72, 1
s_sub_u32 s65, 7, s73
s_bitcmp1_b32 s72, 0
s_cselect_b32 s73, s65, s73
s_lshl_b32 s73, s73, 4
s_lshl_b32 s65, s42, 7
SA s73,s73,s65
v_and_b32 v29, 15, v32
v_add_u32 v29, s73, v29
s_mov_b32 s64, 104857664
v_mul_u32_u24 v28, 896, v29
v_lshl_add_u32 v28, v34, 4, v28
C v68,v68,v69
C v69,v70,v71
C v70,v76,v77
C v71,v78,v79
buffer_store_dwordx4 v[68:71], v7, s[8:11], s30 offen offset:0 sc1
v_lshrrev_b32 v35, 4, v29
v_lshlrev_b32 v35, 5, v35
v_and_b32 v36, 15, v29
v_add_lshl_u32 v35, v35, v36, 2
buffer_load_dword v26, v35, s[8:11], s64 offen sc1
s_waitcnt vmcnt(8)
buffer_store_dword v15, v17, s[8:11], s84 offen sc1
buffer_load_dwordx4 v[44:47], v28, s[56:59], s79 offen
M v[96:99],a[64:67],v[128:131],0
s_nop 0
T a[96:97],v23,32768
T a[98:99],v23,34816
M v[96:99],a[68:71],v[144:147],v[96:99]
T a[100:101],v23,36864
T a[102:103],v23,38912
M v[96:99],a[72:75],v[160:163],v[96:99]
MF v80,v5,v80
MF v81,v5,v81
M v[96:99],a[76:79],v[176:179],v[96:99]
T a[104:105],v23,40960
T a[106:107],v23,43008
M v[96:99],a[80:83],v[192:195],v[96:99]
T a[108:109],v23,45056
T a[110:111],v23,47104
M v[96:99],a[84:87],v[208:211],v[96:99]
MF v82,v5,v82
MF v83,v5,v83
M v[96:99],a[88:91],v[224:227],v[96:99]
T a[112:113],v23,49152
T a[114:115],v23,51200
M v[96:99],a[92:95],v[240:243],v[96:99]
T a[116:117],v23,53248
T a[118:119],v23,55296
M v[100:103],a[92:95],v[244:247],0
MF v88,v5,v88
MF v89,v5,v89
M v[100:103],a[88:91],v[228:231],v[100:103]
T a[120:121],v23,57344
T a[122:123],v23,59392
M v[100:103],a[84:87],v[212:215],v[100:103]
T a[124:125],v23,61440
T a[126:127],v23,63488
M v[100:103],a[80:83],v[196:199],v[100:103]
MF v90,v5,v90
MF v91,v5,v91
M v[100:103],a[76:79],v[180:183],v[100:103]
C v80,v80,v81
C v81,v82,v83
M v[100:103],a[72:75],v[164:167],v[100:103]
C v82,v88,v89
C v83,v90,v91
M v[100:103],a[68:71],v[148:151],v[100:103]
buffer_store_dwordx4 v[80:83], v7, s[8:11], s29 offen offset:1024 sc1
M v[100:103],a[64:67],v[132:135],v[100:103]
s_waitcnt lgkmcnt(0)
MF v84,v6,v84
MF v85,v6,v85
M v[104:107],a[96:99],v[128:131],0
T a[64:65],v24,32768
T a[66:67],v24,34816
M v[104:107],a[100:103],v[144:147],v[104:107]
T a[68:69],v24,36864
T a[70:71],v24,38912
M v[104:107],a[104:107],v[160:163],v[104:107]
MF v86,v6,v86
MF v87,v6,v87
M v[104:107],a[108:111],v[176:179],v[104:107]
T a[72:73],v24,40960
T a[74:75],v24,43008
M v[104:107],a[112:115],v[192:195],v[104:107]
T a[76:77],v24,45056
T a[78:79],v24,47104
M v[104:107],a[116:119],v[208:211],v[104:107]
MF v92,v6,v92
MF v93,v6,v93
M v[104:107],a[120:123],v[224:227],v[104:107]
T a[80:81],v24,49152
T a[82:83],v24,51200
M v[104:107],a[124:127],v[240:243],v[104:107]
T a[84:85],v24,53248
T a[86:87],v24,55296
M v[108:111],a[124:127],v[244:247],0
MF v94,v6,v94
MF v95,v6,v95
M v[108:111],a[120:123],v[228:231],v[108:111]
T a[88:89],v24,57344
T a[90:91],v24,59392
M v[108:111],a[116:119],v[212:215],v[108:111]
T a[92:93],v24,61440
T a[94:95],v24,63488
M v[108:111],a[112:115],v[196:199],v[108:111]
C v84,v84,v85
C v85,v86,v87
M v[108:111],a[108:111],v[180:183],v[108:111]
C v86,v92,v93
C v87,v94,v95
M v[108:111],a[104:107],v[164:167],v[108:111]
buffer_store_dwordx4 v[84:87], v7, s[8:11], s30 offen offset:1024 sc1
M v[108:111],a[100:103],v[148:151],v[108:111]
SA s29,s33,10240
M v[108:111],a[96:99],v[132:135],v[108:111]
s_waitcnt lgkmcnt(0)
M v[112:115],a[64:67],v[128:131],0
SA s30,s33,24576
T a[96:97],v25,32768
T a[98:99],v25,34816
M v[112:115],a[68:71],v[144:147],v[112:115]
T a[100:101],v25,36864
T a[102:103],v25,38912
M v[112:115],a[72:75],v[160:163],v[112:115]
MF v96,v5,v96
MF v97,v5,v97
M v[112:115],a[76:79],v[176:179],v[112:115]
T a[104:105],v25,40960
T a[106:107],v25,43008
M v[112:115],a[80:83],v[192:195],v[112:115]
T a[108:109],v25,45056
T a[110:111],v25,47104
M v[112:115],a[84:87],v[208:211],v[112:115]
MF v98,v5,v98
MF v99,v5,v99
M v[112:115],a[88:91],v[224:227],v[112:115]
T a[112:113],v25,49152
T a[114:115],v25,51200
M v[112:115],a[92:95],v[240:243],v[112:115]
T a[116:117],v25,53248
T a[118:119],v25,55296
M v[116:119],a[92:95],v[244:247],0
s_cmp_lt_u32 s42, 8
MF v104,v5,v104
MF v105,v5,v105
M v[116:119],a[88:91],v[228:231],v[116:119]
s_cselect_b32 s84, s45, 536870912
T a[120:121],v25,57344
T a[122:123],v25,59392
M v[116:119],a[84:87],v[212:215],v[116:119]
T a[124:125],v25,61440
T a[126:127],v25,63488
M v[116:119],a[80:83],v[196:199],v[116:119]
MF v106,v5,v106
MF v107,v5,v107
M v[116:119],a[76:79],v[180:183],v[116:119]
C v96,v96,v97
C v97,v98,v99
M v[116:119],a[72:75],v[164:167],v[116:119]
C v98,v104,v105
C v99,v106,v107
M v[116:119],a[68:71],v[148:151],v[116:119]
s_waitcnt lgkmcnt(0)
buffer_store_dwordx4 v[96:99], v7, s[8:11], s29 offen offset:0 sc1
M v[116:119],a[64:67],v[132:135],v[116:119]
s_barrier
M v[120:123],a[96:99],v[128:131],0
s_nop 0
T a[64:65],v18,32768
T a[66:67],v18,34816
M v[120:123],a[100:103],v[144:147],v[120:123]
T a[68:69],v18,36864
T a[70:71],v18,38912
M v[120:123],a[104:107],v[160:163],v[120:123]
MF v100,v6,v100
MF v101,v6,v101
M v[120:123],a[108:111],v[176:179],v[120:123]
T a[72:73],v18,40960
T a[74:75],v18,43008
M v[120:123],a[112:115],v[192:195],v[120:123]
s_waitcnt vmcnt(9)
T a[76:77],v18,45056
T a[78:79],v18,47104
M v[120:123],a[116:119],v[208:211],v[120:123]
buffer_store_dword v15, v17, s[8:11], s84 offen sc1
M v[120:123],a[120:123],v[224:227],v[120:123]
s_nop 0
T a[80:81],v18,49152
T a[82:83],v18,51200
M v[120:123],a[124:127],v[240:243],v[120:123]
T a[84:85],v18,53248
T a[86:87],v18,55296
M v[124:127],a[124:127],v[244:247],0
MF v102,v6,v102
MF v103,v6,v103
M v[124:127],a[120:123],v[228:231],v[124:127]
T a[88:89],v18,57344
T a[90:91],v18,59392
M v[124:127],a[116:119],v[212:215],v[124:127]
T a[92:93],v18,61440
T a[94:95],v18,63488
M v[124:127],a[112:115],v[196:199],v[124:127]
MF v108,v6,v108
MF v109,v6,v109
M v[124:127],a[108:111],v[180:183],v[124:127]
MF v110,v6,v110
MF v111,v6,v111
M v[124:127],a[104:107],v[164:167],v[124:127]
C v100,v100,v101
C v101,v102,v103
M v[124:127],a[100:103],v[148:151],v[124:127]
s_waitcnt lgkmcnt(0)
C v102,v108,v109
C v103,v110,v111
M v[124:127],a[96:99],v[132:135],v[124:127]
buffer_store_dwordx4 v[100:103], v7, s[8:11], s30 offen offset:0 sc1
M v[64:67],a[64:67],v[128:131],0
s_nop 0
T a[96:97],v19,32768
T a[98:99],v19,34816
M v[64:67],a[68:71],v[144:147],v[64:67]
T a[100:101],v19,36864
T a[102:103],v19,38912
M v[64:67],a[72:75],v[160:163],v[64:67]
MF v112,v5,v112
MF v113,v5,v113
M v[64:67],a[76:79],v[176:179],v[64:67]
T a[104:105],v19,40960
T a[106:107],v19,43008
M v[64:67],a[80:83],v[192:195],v[64:67]
T a[108:109],v19,45056
T a[110:111],v19,47104
M v[64:67],a[84:87],v[208:211],v[64:67]
MF v114,v5,v114
MF v115,v5,v115
M v[64:67],a[88:91],v[224:227],v[64:67]
T a[112:113],v19,49152
T a[114:115],v19,51200
M v[64:67],a[92:95],v[240:243],v[64:67]
T a[116:117],v19,53248
T a[118:119],v19,55296
M v[68:71],a[92:95],v[244:247],0
MF v120,v5,v120
MF v121,v5,v121
M v[68:71],a[88:91],v[228:231],v[68:71]
T a[120:121],v19,57344
T a[122:123],v19,59392
M v[68:71],a[84:87],v[212:215],v[68:71]
T a[124:125],v19,61440
T a[126:127],v19,63488
M v[68:71],a[80:83],v[196:199],v[68:71]
MF v122,v5,v122
MF v123,v5,v123
M v[68:71],a[76:79],v[180:183],v[68:71]
C v112,v112,v113
C v113,v114,v115
M v[68:71],a[72:75],v[164:167],v[68:71]
C v114,v120,v121
C v115,v122,v123
M v[68:71],a[68:71],v[148:151],v[68:71]
buffer_store_dwordx4 v[112:115], v7, s[8:11], s29 offen offset:1024 sc1
M v[68:71],a[64:67],v[132:135],v[68:71]
s_waitcnt lgkmcnt(0)
MF v116,v6,v116
MF v117,v6,v117
M v[72:75],a[96:99],v[128:131],0
T a[64:65],v20,32768
T a[66:67],v20,34816
M v[72:75],a[100:103],v[144:147],v[72:75]
T a[68:69],v20,36864
T a[70:71],v20,38912
M v[72:75],a[104:107],v[160:163],v[72:75]
MF v118,v6,v118
MF v119,v6,v119
M v[72:75],a[108:111],v[176:179],v[72:75]
T a[72:73],v20,40960
T a[74:75],v20,43008
M v[72:75],a[112:115],v[192:195],v[72:75]
T a[76:77],v20,45056
T a[78:79],v20,47104
M v[72:75],a[116:119],v[208:211],v[72:75]
MF v124,v6,v124
MF v125,v6,v125
M v[72:75],a[120:123],v[224:227],v[72:75]
T a[80:81],v20,49152
T a[82:83],v20,51200
M v[72:75],a[124:127],v[240:243],v[72:75]
T a[84:85],v20,53248
T a[86:87],v20,55296
M v[76:79],a[124:127],v[244:247],0
MF v126,v6,v126
MF v127,v6,v127
M v[76:79],a[120:123],v[228:231],v[76:79]
T a[88:89],v20,57344
T a[90:91],v20,59392
M v[76:79],a[116:119],v[212:215],v[76:79]
T a[92:93],v20,61440
T a[94:95],v20,63488
M v[76:79],a[112:115],v[196:199],v[76:79]
C v116,v116,v117
C v117,v118,v119
M v[76:79],a[108:111],v[180:183],v[76:79]
C v118,v124,v125
C v119,v126,v127
M v[76:79],a[104:107],v[164:167],v[76:79]
buffer_store_dwordx4 v[116:119], v7, s[8:11], s30 offen offset:1024 sc1
M v[76:79],a[100:103],v[148:151],v[76:79]
SA s29,s33,12288
s_waitcnt vmcnt(12)
v_readlane_b32 s92, v31, 0
v_readlane_b32 s94, v31, 1
M v[76:79],a[96:99],v[132:135],v[76:79]
s_waitcnt lgkmcnt(0)
s_waitcnt vmcnt(9)
v_sub_f32 v30, 1.0, v26
s_waitcnt vmcnt(7)
v_lshlrev_b32 v48, 16, v44
M v[80:83],a[64:67],v[128:131],0
SA s30,s33,26624
T a[96:97],v21,32768
T a[98:99],v21,34816
M v[80:83],a[68:71],v[144:147],v[80:83]
T a[100:101],v21,36864
T a[102:103],v21,38912
M v[80:83],a[72:75],v[160:163],v[80:83]
v_and_b32 v49, 0xffff0000, v44
v_lshlrev_b32 v50, 16, v45
M v[80:83],a[76:79],v[176:179],v[80:83]
T a[104:105],v21,40960
T a[106:107],v21,43008
M v[80:83],a[80:83],v[192:195],v[80:83]
T a[108:109],v21,45056
T a[110:111],v21,47104
M v[80:83],a[84:87],v[208:211],v[80:83]
MF v64,v5,v64
MF v65,v5,v65
M v[80:83],a[88:91],v[224:227],v[80:83]
T a[112:113],v21,49152
T a[114:115],v21,51200
M v[80:83],a[92:95],v[240:243],v[80:83]
T a[116:117],v21,53248
T a[118:119],v21,55296
M v[84:87],a[92:95],v[244:247],0
MF v66,v5,v66
MF v67,v5,v67
M v[84:87],a[88:91],v[228:231],v[84:87]
T a[120:121],v21,57344
T a[122:123],v21,59392
M v[84:87],a[84:87],v[212:215],v[84:87]
T a[124:125],v21,61440
T a[126:127],v21,63488
M v[84:87],a[80:83],v[196:199],v[84:87]
MF v72,v5,v72
MF v73,v5,v73
M v[84:87],a[76:79],v[180:183],v[84:87]
MF v74,v5,v74
MF v75,v5,v75
M v[84:87],a[72:75],v[164:167],v[84:87]
C v64,v64,v65
C v65,v66,v67
M v[84:87],a[68:71],v[148:151],v[84:87]
C v66,v72,v73
C v67,v74,v75
M v[84:87],a[64:67],v[132:135],v[84:87]
s_waitcnt lgkmcnt(0)
buffer_store_dwordx4 v[64:67], v7, s[8:11], s29 offen offset:0 sc1
M v[88:91],a[96:99],v[128:131],0
v_and_b32 v51, 0xffff0000, v45
v_lshlrev_b32 v52, 16, v46
M v[88:91],a[100:103],v[144:147],v[88:91]
MF v68,v6,v68
MF v69,v6,v69
M v[88:91],a[104:107],v[160:163],v[88:91]
MF v70,v6,v70
MF v71,v6,v71
M v[88:91],a[108:111],v[176:179],v[88:91]
MF v76,v6,v76
MF v77,v6,v77
M v[88:91],a[112:115],v[192:195],v[88:91]
MF v78,v6,v78
MF v79,v6,v79
M v[88:91],a[116:119],v[208:211],v[88:91]
C v68,v68,v69
C v69,v70,v71
M v[88:91],a[120:123],v[224:227],v[88:91]
C v70,v76,v77
C v71,v78,v79
M v[88:91],a[124:127],v[240:243],v[88:91]
buffer_store_dwordx4 v[68:71], v7, s[8:11], s30 offen offset:0 sc1
M v[92:95],a[124:127],v[244:247],0
v_and_b32 v53, 0xffff0000, v46
v_lshlrev_b32 v54, 16, v47
M v[92:95],a[120:123],v[228:231],v[92:95]
v_and_b32 v55, 0xffff0000, v47
v_cmp_eq_u32 s[80:81], s92, v29
M v[92:95],a[116:119],v[212:215],v[92:95]
v_cmp_eq_u32 s[82:83], s94, v29
M v[92:95],a[112:115],v[196:199],v[92:95]
MF v80,v5,v80
MF v81,v5,v81
M v[92:95],a[108:111],v[180:183],v[92:95]
MF v82,v5,v82
MF v83,v5,v83
M v[92:95],a[104:107],v[164:167],v[92:95]
MF v88,v5,v88
MF v89,v5,v89
M v[92:95],a[100:103],v[148:151],v[92:95]
MF v90,v5,v90
MF v91,v5,v91
M v[92:95],a[96:99],v[132:135],v[92:95]
C v80,v80,v81
C v81,v82,v83
C v82,v88,v89
C v83,v90,v91
buffer_store_dwordx4 v[80:83], v7, s[8:11], s29 offen offset:1024 sc1
MF v84,v6,v84
MF v85,v6,v85
MF v86,v6,v86
MF v87,v6,v87
MF v92,v6,v92
MF v93,v6,v93
MF v94,v6,v94
MF v95,v6,v95
C v84,v84,v85
C v85,v86,v87
C v86,v92,v93
C v87,v94,v95
buffer_store_dwordx4 v[84:87], v7, s[8:11], s30 offen offset:1024 sc1
buffer_load_dword v9, v33, s[8:11], s46 offen sc1
s_waitcnt vmcnt(1)
buffer_store_dword v15, v16, s[8:11], s3 offen sc1
s_cmp_lt_u32 s42, 8
s_cbranch_scc1 L_red
s_waitcnt vmcnt(1)
v_cmp_eq_u32 vcc, 1, v9
s_mov_b32 s91, 65536
s_lshl_b32 s70, 1, s41
s_mov_b32 s69, 0xffff
s_or_b32 s70, s70, vcc_lo
s_mov_b32 s68, s70
s_barrier
s_cmp_lg_u32 s70, 0
s_cbranch_scc1 L_vk0
s_call_b64 s[36:37], L_rpoll
L_vk0:
s_ff1_i32_b32 s71, s70
s_bitset0_b32 s70, s71
s_mul_i32 s71, s71, 114688
SA s16,s71,s78
buffer_load_dwordx4 v[128:131], v27, s[8:11], s16 offen sc1
s_cmp_lg_u32 s70, 0
s_cbranch_scc1 L_vk1
s_call_b64 s[36:37], L_rpoll
L_vk1:
s_ff1_i32_b32 s71, s70
s_bitset0_b32 s70, s71
s_mul_i32 s71, s71, 114688
SA s17,s71,s78
buffer_load_dwordx4 v[132:135], v27, s[8:11], s17 offen sc1
s_cmp_lg_u32 s70, 0
s_cbranch_scc1 L_vk2
s_call_b64 s[36:37], L_rpoll
L_vk2:
s_ff1_i32_b32 s71, s70
s_bitset0_b32 s70, s71
s_mul_i32 s71, s71, 114688
SA s18,s71,s78
buffer_load_dwordx4 v[136:139], v27, s[8:11], s18 offen sc1
s_cmp_lg_u32 s70, 0
s_cbranch_scc1 L_vk3
s_call_b64 s[36:37], L_rpoll
L_vk3:
s_ff1_i32_b32 s71, s70
s_bitset0_b32 s70, s71
s_mul_i32 s71, s71, 114688
SA s19,s71,s78
buffer_load_dwordx4 v[140:143], v27, s[8:11], s19 offen sc1
s_cmp_lg_u32 s70, 0
s_cbranch_scc1 L_vk4
s_call_b64 s[36:37], L_rpoll
L_vk4:
s_ff1_i32_b32 s71, s70
s_bitset0_b32 s70, s71
s_mul_i32 s71, s71, 114688
SA s48,s71,s78
buffer_load_dwordx4 v[144:147], v27, s[8:11], s48 offen sc1
s_cmp_lg_u32 s70, 0
s_cbranch_scc1 L_vk5
s_call_b64 s[36:37], L_rpoll
L_vk5:
s_ff1_i32_b32 s71, s70
s_bitset0_b32 s70, s71
s_mul_i32 s71, s71, 114688
SA s49,s71,s78
buffer_load_dwordx4 v[148:151], v27, s[8:11], s49 offen sc1
s_cmp_lg_u32 s70, 0
s_cbranch_scc1 L_vk6
s_call_b64 s[36:37], L_rpoll
L_vk6:
s_ff1_i32_b32 s71, s70
s_bitset0_b32 s70, s71
s_mul_i32 s71, s71, 114688
SA s50,s71,s78
buffer_load_dwordx4 v[152:155], v27, s[8:11], s50 offen sc1
s_cmp_lg_u32 s70, 0
s_cbranch_scc1 L_vk7
s_call_b64 s[36:37], L_rpoll
L_vk7:
s_ff1_i32_b32 s71, s70
s_bitset0_b32 s70, s71
s_mul_i32 s71, s71, 114688
SA s51,s71,s78
buffer_load_dwordx4 v[156:159], v27, s[8:11], s51 offen sc1
s_or_b64 vcc, s[80:81], s[82:83]
s_cbranch_vccnz L_moe2
L_moe_ret2:
MF v48,v30,v48
MF v49,v30,v49
MF v50,v30,v50
MF v51,v30,v51
MF v52,v30,v52
MF v53,v30,v53
MF v54,v30,v54
MF v55,v30,v55
s_cmp_lg_u32 s70, 0
s_cbranch_scc1 L_vk8
s_call_b64 s[36:37], L_rpoll
L_vk8:
s_ff1_i32_b32 s71, s70
s_bitset0_b32 s70, s71
s_mul_i32 s71, s71, 114688
SA s21,s71,s78
buffer_load_dwordx4 v[160:163], v27, s[8:11], s21 offen sc1
s_waitcnt vmcnt(8)
M v[56:59],a[246:249],v[128:131],0
M v[60:63],a[244:247],v[128:131],0
s_cmp_lg_u32 s70, 0
s_cbranch_scc1 L_vk9
s_call_b64 s[36:37], L_rpoll
L_vk9:
s_ff1_i32_b32 s71, s70
s_bitset0_b32 s70, s71
s_mul_i32 s71, s71, 114688
SA s22,s71,s78
buffer_load_dwordx4 v[164:167], v27, s[8:11], s22 offen sc1
s_waitcnt vmcnt(8)
M v[56:59],a[246:249],v[132:135],v[56:59]
M v[60:63],a[244:247],v[132:135],v[60:63]
s_cmp_lg_u32 s70, 0
s_cbranch_scc1 L_vk10
s_call_b64 s[36:37], L_rpoll
L_vk10:
s_ff1_i32_b32 s71, s70
s_bitset0_b32 s70, s71
s_mul_i32 s71, s71, 114688
SA s23,s71,s78
buffer_load_dwordx4 v[168:171], v27, s[8:11], s23 offen sc1
s_waitcnt vmcnt(8)
M v[56:59],a[246:249],v[136:139],v[56:59]
M v[60:63],a[244:247],v[136:139],v[60:63]
s_cmp_lg_u32 s70, 0
s_cbranch_scc1 L_vk11
s_call_b64 s[36:37], L_rpoll
L_vk11:
s_ff1_i32_b32 s71, s70
s_bitset0_b32 s70, s71
s_mul_i32 s71, s71, 114688
SA s24,s71,s78
buffer_load_dwordx4 v[172:175], v27, s[8:11], s24 offen sc1
s_waitcnt vmcnt(8)
M v[56:59],a[246:249],v[140:143],v[56:59]
M v[60:63],a[244:247],v[140:143],v[60:63]
s_cmp_lg_u32 s70, 0
s_cbranch_scc1 L_vk12
s_call_b64 s[36:37], L_rpoll
L_vk12:
s_ff1_i32_b32 s71, s70
s_bitset0_b32 s70, s71
s_mul_i32 s71, s71, 114688
SA s25,s71,s78
buffer_load_dwordx4 v[176:179], v27, s[8:11], s25 offen sc1
s_waitcnt vmcnt(8)
M v[56:59],a[246:249],v[144:147],v[56:59]
M v[60:63],a[244:247],v[144:147],v[60:63]
s_cmp_lg_u32 s70, 0
s_cbranch_scc1 L_vk13
s_call_b64 s[36:37], L_rpoll
L_vk13:
s_ff1_i32_b32 s71, s70
s_bitset0_b32 s70, s71
s_mul_i32 s71, s71, 114688
SA s26,s71,s78
buffer_load_dwordx4 v[180:183], v27, s[8:11], s26 offen sc1
s_waitcnt vmcnt(8)
M v[56:59],a[246:249],v[148:151],v[56:59]
M v[60:63],a[244:247],v[148:151],v[60:63]
s_cmp_lg_u32 s70, 0
s_cbranch_scc1 L_vk14
s_call_b64 s[36:37], L_rpoll
L_vk14:
s_ff1_i32_b32 s71, s70
s_bitset0_b32 s70, s71
s_mul_i32 s71, s71, 114688
SA s27,s71,s78
buffer_load_dwordx4 v[184:187], v27, s[8:11], s27 offen sc1
s_waitcnt vmcnt(8)
M v[56:59],a[246:249],v[152:155],v[56:59]
M v[60:63],a[244:247],v[152:155],v[60:63]
s_cmp_lg_u32 s70, 0
s_cbranch_scc1 L_vk15
s_call_b64 s[36:37], L_rpoll
L_vk15:
s_ff1_i32_b32 s71, s70
s_bitset0_b32 s70, s71
s_mul_i32 s71, s71, 114688
SA s28,s71,s78
buffer_load_dwordx4 v[188:191], v27, s[8:11], s28 offen sc1
s_waitcnt vmcnt(8)
M v[56:59],a[246:249],v[156:159],v[56:59]
M v[60:63],a[244:247],v[156:159],v[60:63]
s_waitcnt vmcnt(7)
M v[56:59],a[246:249],v[160:163],v[56:59]
M v[60:63],a[244:247],v[160:163],v[60:63]
s_waitcnt vmcnt(6)
M v[56:59],a[246:249],v[164:167],v[56:59]
M v[60:63],a[244:247],v[164:167],v[60:63]
s_waitcnt vmcnt(5)
M v[56:59],a[246:249],v[168:171],v[56:59]
M v[60:63],a[244:247],v[168:171],v[60:63]
s_waitcnt vmcnt(4)
M v[56:59],a[246:249],v[172:175],v[56:59]
M v[60:63],a[244:247],v[172:175],v[60:63]
s_waitcnt vmcnt(3)
M v[56:59],a[246:249],v[176:179],v[56:59]
M v[60:63],a[244:247],v[176:179],v[60:63]
s_waitcnt vmcnt(2)
M v[56:59],a[246:249],v[180:183],v[56:59]
M v[60:63],a[244:247],v[180:183],v[60:63]
s_waitcnt vmcnt(1)
M v[56:59],a[246:249],v[184:187],v[56:59]
M v[60:63],a[244:247],v[184:187],v[60:63]
s_waitcnt vmcnt(0)
M v[56:59],a[246:249],v[188:191],v[56:59]
M v[60:63],a[244:247],v[188:191],v[60:63]
s_nop 7
v_permlane16_swap_b32 v56, v60
v_permlane16_swap_b32 v57, v61
v_permlane16_swap_b32 v58, v62
v_permlane16_swap_b32 v59, v63
v_fmac_f32 v48, v26, v56
v_fmac_f32 v49, v26, v57
v_fmac_f32 v50, v26, v58
v_fmac_f32 v51, v26, v59
v_fmac_f32 v52, v26, v60
v_fmac_f32 v53, v26, v61
v_fmac_f32 v54, v26, v62
v_fmac_f32 v55, v26, v63
C v44,v48,v49
C v45,v50,v51
C v46,v52,v53
C v47,v54,v55
buffer_store_dwordx4 v[44:47], v28, s[52:55], s79 offen sc1
s_endpgm
L_d2h:
M v[128:131],a[64:67],v[48:51],v[128:131]
R a[96:99],v7,40960
R a[100:103],v7,41984
M v[128:131],a[68:71],v[56:59],v[128:131]
SA m0,s28,135168
E v18,v64
M v[132:135],a[68:71],v[60:63],v[132:135]
buffer_load_dwordx4 v4, s[8:11], s26 offen offset:0 sc1 lds
M v[132:135],a[64:67],v[52:55],v[132:135]
R a[104:107],v7,43008
R a[108:111],v7,44032
M v[140:143],a[72:75],v[52:55],v[140:143]
s_cmp_gt_u32 s20, 3
E v19,v65
M v[140:143],a[76:79],v[60:63],v[140:143]
s_cselect_b64 s[82:83], -1, 0
AF v30,v28,v30
AF v31,v29,v31
M v[136:139],a[76:79],v[56:59],v[136:139]
s_cmp_eq_u32 s20, 3
R a[112:115],v7,45056
R a[116:119],v7,46080
M v[136:139],a[72:75],v[48:51],v[136:139]
s_cselect_b64 s[66:67], s[16:17], s[82:83]
buffer_load_dwordx4 v4, s[8:11], s26 offen offset:1024 sc1 lds
M v[144:147],a[80:83],v[48:51],v[144:147]
s_cselect_b64 s[68:69], s[18:19], s[82:83]
E v20,v66
M v[144:147],a[84:87],v[56:59],v[144:147]
s_cselect_b64 s[70:71], s[48:49], s[82:83]
R a[120:123],v7,47104
R a[124:127],v7,48128
M v[148:151],a[84:87],v[60:63],v[148:151]
s_cselect_b64 s[72:73], s[50:51], s[82:83]
v_cndmask_b32 v100, v36, v8, s[66:67]
v_cndmask_b32 v101, v36, v8, s[68:69]
M v[148:151],a[80:83],v[52:55],v[148:151]
buffer_load_dwordx4 v4, s[8:11], s26 offen offset:2048 sc1 lds
M v[156:159],a[88:91],v[52:55],v[156:159]
v_cndmask_b32 v102, v36, v8, s[70:71]
AF v26,v18,v19
M v[156:159],a[92:95],v[60:63],v[156:159]
E v21,v67
M v[152:155],a[92:95],v[56:59],v[152:155]
v_cndmask_b32 v103, v36, v8, s[72:73]
C v40,v18,v19
M v[152:155],a[88:91],v[48:51],v[152:155]
s_waitcnt lgkmcnt(0)
buffer_load_dwordx4 v4, s[8:11], s26 offen offset:3072 sc1 lds
M v[160:163],a[96:99],v[48:51],v[160:163]
s_cmp_gt_u32 s20, 2
R a[64:67],v7,49152
R a[68:71],v7,50176
M v[160:163],a[100:103],v[56:59],v[160:163]
s_cselect_b64 s[82:83], -1, 0
E v22,v72
M v[164:167],a[100:103],v[60:63],v[164:167]
s_cmp_eq_u32 s20, 2
AF v26,v20,v26
C v41,v20,v21
M v[164:167],a[96:99],v[52:55],v[164:167]
s_mul_i32 s21, s41, 1048576
R a[72:75],v7,51200
R a[76:79],v7,52224
M v[172:175],a[104:107],v[52:55],v[172:175]
s_cselect_b64 s[74:75], s[16:17], s[82:83]
E v23,v73
M v[172:175],a[108:111],v[60:63],v[172:175]
s_cselect_b64 s[76:77], s[18:19], s[82:83]
AF v26,v21,v26
AF v26,v22,v26
M v[168:171],a[108:111],v[56:59],v[168:171]
s_cselect_b64 s[78:79], s[48:49], s[82:83]
R a[80:83],v7,53248
R a[84:87],v7,54272
M v[168:171],a[104:107],v[48:51],v[168:171]
s_cselect_b64 s[80:81], s[50:51], s[82:83]
v_cndmask_b32 v108, v36, v8, s[74:75]
v_cndmask_b32 v109, v36, v8, s[76:77]
M v[176:179],a[112:115],v[48:51],v[176:179]
SA s21,s21,589824
E v24,v74
M v[176:179],a[116:119],v[56:59],v[176:179]
s_lshl_b32 s84, s42, 1
R a[88:91],v7,55296
R a[92:95],v7,56320
M v[180:183],a[116:119],v[60:63],v[180:183]
s_sub_u32 s22, 11, s84
v_cndmask_b32 v110, v36, v8, s[78:79]
C v42,v22,v23
M v[180:183],a[112:115],v[52:55],v[180:183]
s_mov_b32 s23, 536870912
s_waitcnt vmcnt(16)
v_cmp_gt_u32 vcc, 2, v5
AF v26,v23,v26
M v[188:191],a[120:123],v[52:55],v[188:191]
s_cbranch_vccnz L_lsh2
L_lrh2:
v_cndmask_b32 v111, v36, v8, s[80:81]
M v[188:191],a[124:127],v[60:63],v[188:191]
SA m0,s28,98304
E v25,v75
M v[184:187],a[124:127],v[56:59],v[184:187]
s_cmp_gt_u32 s20, 1
buffer_load_dwordx4 v3, s[8:11], s21 offen offset:0 sc1 lds
M v[184:187],a[120:123],v[48:51],v[184:187]
s_waitcnt lgkmcnt(0)
E v18,v68
M v[192:195],a[64:67],v[48:51],v[192:195]
s_cselect_b64 s[82:83], -1, 0
R a[96:99],v7,57344
R a[100:103],v7,58368
M v[192:195],a[68:71],v[56:59],v[192:195]
s_cmp_eq_u32 s20, 1
buffer_load_dwordx4 v3, s[8:11], s21 offen offset:1024 sc1 lds
M v[196:199],a[68:71],v[60:63],v[196:199]
s_cselect_b64 s[66:67], s[16:17], s[82:83]
E v19,v69
M v[196:199],a[64:67],v[52:55],v[196:199]
s_cselect_b64 s[68:69], s[18:19], s[82:83]
R a[104:107],v7,59392
R a[108:111],v7,60416
M v[204:207],a[72:75],v[52:55],v[204:207]
s_cselect_b64 s[70:71], s[48:49], s[82:83]
buffer_load_dwordx4 v3, s[8:11], s21 offen offset:2048 sc1 lds
M v[204:207],a[76:79],v[60:63],v[204:207]
s_cselect_b64 s[72:73], s[50:51], s[82:83]
v_cndmask_b32 v116, v36, v8, s[66:67]
v_cndmask_b32 v117, v36, v8, s[68:69]
M v[200:203],a[76:79],v[56:59],v[200:203]
R a[112:115],v7,61440
R a[116:119],v7,62464
M v[200:203],a[72:75],v[48:51],v[200:203]
v_cndmask_b32 v118, v36, v8, s[70:71]
AF v26,v24,v26
M v[208:211],a[80:83],v[48:51],v[208:211]
buffer_load_dwordx4 v3, s[8:11], s21 offen offset:3072 sc1 lds
M v[208:211],a[84:87],v[56:59],v[208:211]
SA m0,s28,102400
R a[120:123],v7,63488
R a[124:127],v7,64512
M v[212:215],a[84:87],v[60:63],v[212:215]
v_cndmask_b32 v119, v36, v8, s[72:73]
C v43,v24,v25
M v[212:215],a[80:83],v[52:55],v[212:215]
s_cmp_gt_u32 s20, 0
E v20,v70
M v[220:223],a[88:91],v[52:55],v[220:223]
s_cselect_b64 s[82:83], -1, 0
buffer_load_dwordx4 v4, s[8:11], s21 offen offset:0 sc1 lds
M v[220:223],a[92:95],v[60:63],v[220:223]
s_cmp_eq_u32 s20, 0
E v21,v71
M v[216:219],a[92:95],v[56:59],v[216:219]
s_waitcnt lgkmcnt(0)
E v22,v76
M v[216:219],a[88:91],v[48:51],v[216:219]
s_barrier
M v[224:227],a[96:99],v[48:51],v[224:227]
s_cselect_b64 s[74:75], s[16:17], s[82:83]
R a[64:67],v2,0
R a[68:71],v2,1024
M v[224:227],a[100:103],v[56:59],v[224:227]
s_cselect_b64 s[76:77], s[18:19], s[82:83]
buffer_load_dwordx4 v4, s[8:11], s21 offen offset:1024 sc1 lds
M v[228:231],a[100:103],v[60:63],v[228:231]
s_cselect_b64 s[78:79], s[48:49], s[82:83]
E v23,v77
M v[228:231],a[96:99],v[52:55],v[228:231]
s_cselect_b64 s[80:81], s[50:51], s[82:83]
R a[72:75],v2,2048
R a[76:79],v2,3072
M v[236:239],a[104:107],v[52:55],v[236:239]
v_cndmask_b32 v124, v36, v8, s[74:75]
v_cndmask_b32 v125, v36, v8, s[76:77]
M v[236:239],a[108:111],v[60:63],v[236:239]
buffer_load_dwordx4 v4, s[8:11], s21 offen offset:2048 sc1 lds
M v[232:235],a[108:111],v[56:59],v[232:235]
R a[80:83],v2,4096
R a[84:87],v2,5120
M v[232:235],a[104:107],v[48:51],v[232:235]
v_cndmask_b32 v126, v36, v8, s[78:79]
AF v26,v25,v26
M v[240:243],a[112:115],v[48:51],v[240:243]
v_cndmask_b32 v127, v36, v8, s[80:81]
AF v27,v18,v19
M v[240:243],a[116:119],v[56:59],v[240:243]
R a[88:91],v2,6144
R a[92:95],v2,7168
M v[244:247],a[116:119],v[60:63],v[244:247]
buffer_load_dwordx4 v4, s[8:11], s21 offen offset:3072 sc1 lds
M v[244:247],a[112:115],v[52:55],v[244:247]
SA s21,s21,32768
E v24,v78
M v[252:255],a[120:123],v[52:55],v[252:255]
s_sub_u32 s22, s22, 1
E v25,v79
M v[252:255],a[124:127],v[60:63],v[252:255]
s_cselect_b32 s21, s23, s21
C v44,v18,v19
AF v27,v20,v27
M v[248:251],a[124:127],v[56:59],v[248:251]
s_waitcnt lgkmcnt(0)
C v45,v20,v21
AF v27,v21,v27
M v[248:251],a[120:123],v[48:51],v[248:251]
AF v27,v22,v27
C v46,v22,v23
AF v27,v23,v27
AF v27,v24,v27
C v47,v24,v25
AF v27,v25,v27
L_d3h:
M v[100:103],a[64:67],a[32:35],v[100:103]
R a[96:99],v2,8192
R a[100:103],v2,9216
M v[100:103],a[68:71],a[36:39],v[100:103]
R a[104:107],v2,10240
R a[108:111],v2,11264
M v[100:103],a[72:75],a[40:43],v[100:103]
R a[112:115],v2,12288
R a[116:119],v2,13312
M v[100:103],a[76:79],a[44:47],v[100:103]
R a[120:123],v2,14336
R a[124:127],v2,15360
M v[100:103],a[80:83],a[48:51],v[100:103]
v_add_u32 v8, 0x20000, v7
M v[100:103],a[84:87],a[52:55],v[100:103]
buffer_load_dword v5, v9, s[8:11], s46 offen sc1
M v[100:103],a[88:91],a[56:59],v[100:103]
buffer_load_dword v6, off, s[8:11], s47 offset:16 sc1
M v[100:103],a[92:95],a[60:63],v[100:103]
s_waitcnt lgkmcnt(0)
E v18,v80
M v[108:111],a[96:99],a[32:35],v[108:111]
R a[64:67],v2,16384
R a[68:71],v2,17408
M v[108:111],a[100:103],a[36:39],v[108:111]
R a[72:75],v2,18432
R a[76:79],v2,19456
M v[108:111],a[104:107],a[40:43],v[108:111]
R a[80:83],v2,20480
R a[84:87],v2,21504
M v[108:111],a[108:111],a[44:47],v[108:111]
R a[88:91],v2,22528
R a[92:95],v2,23552
M v[108:111],a[112:115],a[48:51],v[108:111]
E v19,v81
M v[108:111],a[116:119],a[52:55],v[108:111]
E v20,v82
M v[108:111],a[120:123],a[56:59],v[108:111]
E v21,v83
M v[108:111],a[124:127],a[60:63],v[108:111]
s_waitcnt lgkmcnt(0)
E v22,v88
M v[116:119],a[64:67],a[32:35],v[116:119]
R a[96:99],v2,24576
R a[100:103],v2,25600
M v[116:119],a[68:71],a[36:39],v[116:119]
R a[104:107],v2,26624
R a[108:111],v2,27648
M v[116:119],a[72:75],a[40:43],v[116:119]
R a[112:115],v2,28672
R a[116:119],v2,29696
M v[116:119],a[76:79],a[44:47],v[116:119]
R a[120:123],v2,30720
R a[124:127],v2,31744
M v[116:119],a[80:83],a[48:51],v[116:119]
E v23,v89
M v[116:119],a[84:87],a[52:55],v[116:119]
E v24,v90
M v[116:119],a[88:91],a[56:59],v[116:119]
s_waitcnt vmcnt(18) lgkmcnt(0)
E v25,v91
M v[116:119],a[92:95],a[60:63],v[116:119]
s_barrier
M v[124:127],a[96:99],a[32:35],v[124:127]
R a[64:67],v7,0
R a[68:71],v7,1024
M v[124:127],a[100:103],a[36:39],v[124:127]
R a[72:75],v7,2048
R a[76:79],v7,3072
M v[124:127],a[104:107],a[40:43],v[124:127]
R a[80:83],v7,4096
R a[84:87],v7,5120
M v[124:127],a[108:111],a[44:47],v[124:127]
R a[88:91],v7,6144
R a[92:95],v7,7168
M v[124:127],a[112:115],a[48:51],v[124:127]
AF v26,v18,v26
C v56,v18,v19
M v[124:127],a[116:119],a[52:55],v[124:127]
AF v26,v19,v26
AF v26,v20,v26
M v[124:127],a[120:123],a[56:59],v[124:127]
s_waitcnt lgkmcnt(0)
E v18,v84
M v[124:127],a[124:127],a[60:63],v[124:127]
E v19,v85
C v57,v20,v21
AF v26,v21,v26
AF v26,v22,v26
C v58,v22,v23
AF v26,v23,v26
AF v26,v24,v26
C v59,v24,v25
AF v26,v25,v26
E v20,v86
E v21,v87
AF v27,v18,v27
C v60,v18,v19
AF v27,v19,v27
E v22,v92
E v23,v93
AF v27,v20,v27
C v61,v20,v21
AF v27,v21,v27
E v24,v94
E v25,v95
AF v27,v22,v27
C v62,v22,v23
AF v27,v23,v27
AF v27,v24,v27
C v63,v24,v25
AF v27,v25,v27
v_max_f32 v10, v26, v27
v_cmp_lt_f32 vcc, s31, v10
s_nop 0
s_cbranch_vccnz L_std3h
L_rtd3h:
M v[128:131],a[64:67],v[40:43],v[128:131]
R a[96:99],v7,8192
R a[100:103],v7,9216
M v[128:131],a[68:71],v[56:59],v[128:131]
s_waitcnt vmcnt(0)
v_cmp_ne_u32 vcc, 1, v6
AF v30,v26,v30
M v[132:135],a[68:71],v[60:63],v[132:135]
s_cbranch_vccnz L_fqs
L_fqr:
E v18,v100
M v[132:135],a[64:67],v[44:47],v[132:135]
SA s73,s32,4096
R a[104:107],v7,10240
R a[108:111],v7,11264
M v[140:143],a[72:75],v[44:47],v[140:143]
SA s74,s32,8192
E v19,v101
M v[140:143],a[76:79],v[60:63],v[140:143]
SA s75,s32,12288
buffer_load_dwordx4 a[0:3], v7, s[8:11], s32 offen offset:0 sc1
M v[136:139],a[76:79],v[56:59],v[136:139]
R a[112:115],v7,12288
R a[116:119],v7,13312
M v[136:139],a[72:75],v[40:43],v[136:139]
E v20,v102
M v[144:147],a[80:83],v[40:43],v[144:147]
buffer_load_dwordx4 a[4:7], v7, s[8:11], s32 offen offset:1024 sc1
M v[144:147],a[84:87],v[56:59],v[144:147]
R a[120:123],v7,14336
R a[124:127],v7,15360
M v[148:151],a[84:87],v[60:63],v[148:151]
AF v31,v27,v31
AF v29,v18,v19
M v[148:151],a[80:83],v[44:47],v[148:151]
buffer_load_dwordx4 a[8:11], v7, s[8:11], s32 offen offset:2048 sc1
M v[156:159],a[88:91],v[44:47],v[156:159]
E v21,v103
M v[156:159],a[92:95],v[60:63],v[156:159]
C v52,v18,v19
AF v29,v20,v29
M v[152:155],a[92:95],v[56:59],v[152:155]
buffer_load_dwordx4 a[12:15], v7, s[8:11], s32 offen offset:3072 sc1
M v[152:155],a[88:91],v[40:43],v[152:155]
s_waitcnt lgkmcnt(0)
E v22,v108
M v[160:163],a[96:99],v[40:43],v[160:163]
R a[64:67],v7,16384
R a[68:71],v7,17408
M v[160:163],a[100:103],v[56:59],v[160:163]
buffer_load_dwordx4 a[16:19], v7, s[8:11], s73 offen offset:0 sc1
M v[164:167],a[100:103],v[60:63],v[164:167]
E v23,v109
M v[164:167],a[96:99],v[44:47],v[164:167]
R a[72:75],v7,18432
R a[76:79],v7,19456
M v[172:175],a[104:107],v[44:47],v[172:175]
buffer_load_dwordx4 a[20:23], v7, s[8:11], s73 offen offset:1024 sc1
M v[172:175],a[108:111],v[60:63],v[172:175]
C v53,v20,v21
AF v29,v21,v29
M v[168:171],a[108:111],v[56:59],v[168:171]
R a[80:83],v7,20480
R a[84:87],v7,21504
M v[168:171],a[104:107],v[40:43],v[168:171]
buffer_load_dwordx4 a[24:27], v7, s[8:11], s73 offen offset:2048 sc1
M v[176:179],a[112:115],v[40:43],v[176:179]
E v24,v110
M v[176:179],a[116:119],v[56:59],v[176:179]
R a[88:91],v7,22528
R a[92:95],v7,23552
M v[180:183],a[116:119],v[60:63],v[180:183]
buffer_load_dwordx4 a[28:31], v7, s[8:11], s73 offen offset:3072 sc1
M v[180:183],a[112:115],v[44:47],v[180:183]
E v25,v111
M v[188:191],a[120:123],v[44:47],v[188:191]
AF v29,v22,v29
C v54,v22,v23
M v[188:191],a[124:127],v[60:63],v[188:191]
buffer_load_dwordx4 a[32:35], v7, s[8:11], s74 offen offset:0 sc1
M v[184:187],a[124:127],v[56:59],v[184:187]
E v18,v116
M v[184:187],a[120:123],v[40:43],v[184:187]
s_waitcnt lgkmcnt(0)
AF v29,v23,v29
AF v29,v24,v29
M v[192:195],a[64:67],v[40:43],v[192:195]
R a[96:99],v7,24576
R a[100:103],v7,25600
M v[192:195],a[68:71],v[56:59],v[192:195]
buffer_load_dwordx4 a[36:39], v7, s[8:11], s74 offen offset:1024 sc1
M v[196:199],a[68:71],v[60:63],v[196:199]
E v19,v117
M v[196:199],a[64:67],v[44:47],v[196:199]
R a[104:107],v7,26624
R a[108:111],v7,27648
M v[204:207],a[72:75],v[44:47],v[204:207]
buffer_load_dwordx4 a[40:43], v7, s[8:11], s74 offen offset:2048 sc1
M v[204:207],a[76:79],v[60:63],v[204:207]
E v20,v118
M v[200:203],a[76:79],v[56:59],v[200:203]
R a[112:115],v7,28672
R a[116:119],v7,29696
M v[200:203],a[72:75],v[40:43],v[200:203]
buffer_load_dwordx4 a[44:47], v7, s[8:11], s74 offen offset:3072 sc1
M v[208:211],a[80:83],v[40:43],v[208:211]
C v55,v24,v25
AF v29,v25,v29
M v[208:211],a[84:87],v[56:59],v[208:211]
R a[120:123],v7,30720
R a[124:127],v7,31744
M v[212:215],a[84:87],v[60:63],v[212:215]
buffer_load_dwordx4 a[48:51], v7, s[8:11], s75 offen offset:0 sc1
M v[212:215],a[80:83],v[44:47],v[212:215]
E v21,v119
M v[220:223],a[88:91],v[44:47],v[220:223]
AF v29,v18,v29
C v48,v18,v19
M v[220:223],a[92:95],v[60:63],v[220:223]
buffer_load_dwordx4 a[52:55], v7, s[8:11], s75 offen offset:1024 sc1
M v[216:219],a[92:95],v[56:59],v[216:219]
s_waitcnt lgkmcnt(0)
E v22,v124
M v[216:219],a[88:91],v[40:43],v[216:219]
s_barrier
M v[224:227],a[96:99],v[40:43],v[224:227]
R a[64:67],v8,0
R a[68:71],v8,1024
M v[224:227],a[100:103],v[56:59],v[224:227]
buffer_load_dwordx4 a[56:59], v7, s[8:11], s75 offen offset:2048 sc1
M v[228:231],a[100:103],v[60:63],v[228:231]
v_mov_b32 v15, 4
AF v29,v19,v29
M v[228:231],a[96:99],v[44:47],v[228:231]
R a[72:75],v8,2048
R a[76:79],v8,3072
M v[236:239],a[104:107],v[44:47],v[236:239]
buffer_store_dword v15, v1, s[8:11], s45 offen sc1
M v[236:239],a[108:111],v[60:63],v[236:239]
buffer_load_dwordx4 a[60:63], v7, s[8:11], s75 offen offset:3072 sc1
M v[232:235],a[108:111],v[56:59],v[232:235]
s_cmp_ge_u32 s42, 2
R a[80:83],v8,4096
R a[84:87],v8,5120
M v[232:235],a[104:107],v[40:43],v[232:235]
s_cselect_b32 s84, 4, 2
v_cmp_gt_u32 vcc, s84, v5
AF v29,v20,v29
M v[240:243],a[112:115],v[40:43],v[240:243]
s_cbranch_vccnz L_lsh4
L_lrh4:
E v23,v125
M v[240:243],a[116:119],v[56:59],v[240:243]
R a[88:91],v8,6144
R a[92:95],v8,7168
M v[244:247],a[116:119],v[60:63],v[244:247]
E v24,v126
M v[244:247],a[112:115],v[44:47],v[244:247]
E v25,v127
M v[252:255],a[120:123],v[44:47],v[252:255]
C v49,v20,v21
AF v29,v21,v29
M v[252:255],a[124:127],v[60:63],v[252:255]
AF v29,v22,v29
C v50,v22,v23
M v[248:251],a[124:127],v[56:59],v[248:251]
s_waitcnt lgkmcnt(0)
AF v29,v23,v29
AF v29,v24,v29
M v[248:251],a[120:123],v[40:43],v[248:251]
C v51,v24,v25
AF v29,v25,v29
v_cmp_lt_f32 vcc, s31, v29
s_nop 0
s_cbranch_vccnz L_std4h
L_rtd4h:
M v[132:135],a[64:67],v[52:55],v[132:135]
R a[96:99],v8,8192
R a[100:103],v8,9216
M v[132:135],a[68:71],v[48:51],v[132:135]
R a[104:107],v8,10240
R a[108:111],v8,11264
M v[140:143],a[72:75],v[52:55],v[140:143]
SA m0,s28,65536
R a[112:115],v8,12288
R a[116:119],v8,13312
M v[140:143],a[76:79],v[48:51],v[140:143]
R a[120:123],v8,14336
R a[124:127],v8,15360
M v[148:151],a[80:83],v[52:55],v[148:151]
buffer_load_dwordx4 v3, s[8:11], s21 offen offset:0 sc1 lds
M v[148:151],a[84:87],v[48:51],v[148:151]
AF v31,v29,v31
v_mov_b32 v10, v30
M v[156:159],a[88:91],v[52:55],v[156:159]
v_mov_b32 v11, v31
C v128,v128,v129
M v[156:159],a[92:95],v[48:51],v[156:159]
s_waitcnt lgkmcnt(0)
v_permlane16_swap_b32 v10, v30
M v[164:167],a[96:99],v[52:55],v[164:167]
R a[64:67],v8,16384
R a[68:71],v8,17408
M v[164:167],a[100:103],v[48:51],v[164:167]
R a[72:75],v8,18432
R a[76:79],v8,19456
M v[172:175],a[104:107],v[52:55],v[172:175]
R a[80:83],v8,20480
R a[84:87],v8,21504
M v[172:175],a[108:111],v[48:51],v[172:175]
R a[88:91],v8,22528
R a[92:95],v8,23552
M v[180:183],a[112:115],v[52:55],v[180:183]
buffer_load_dwordx4 v3, s[8:11], s21 offen offset:1024 sc1 lds
M v[180:183],a[116:119],v[48:51],v[180:183]
v_permlane16_swap_b32 v11, v31
M v[188:191],a[120:123],v[52:55],v[188:191]
AF v30,v10,v30
AF v31,v11,v31
M v[188:191],a[124:127],v[48:51],v[188:191]
s_waitcnt lgkmcnt(0)
buffer_load_dwordx4 v3, s[8:11], s21 offen offset:2048 sc1 lds
M v[196:199],a[64:67],v[52:55],v[196:199]
R a[96:99],v8,24576
R a[100:103],v8,25600
M v[196:199],a[68:71],v[48:51],v[196:199]
R a[104:107],v8,26624
R a[108:111],v8,27648
M v[204:207],a[72:75],v[52:55],v[204:207]
R a[112:115],v8,28672
R a[116:119],v8,29696
M v[204:207],a[76:79],v[48:51],v[204:207]
R a[120:123],v8,30720
R a[124:127],v8,31744
M v[212:215],a[80:83],v[52:55],v[212:215]
buffer_load_dwordx4 v3, s[8:11], s21 offen offset:3072 sc1 lds
M v[212:215],a[84:87],v[48:51],v[212:215]
SA m0,s28,69632
v_mov_b32 v10, v30
v_mov_b32 v11, v31
M v[220:223],a[88:91],v[52:55],v[220:223]
s_waitcnt lgkmcnt(0)
v_permlane32_swap_b32 v10, v30
M v[220:223],a[92:95],v[48:51],v[220:223]
s_barrier
M v[228:231],a[96:99],v[52:55],v[228:231]
R a[64:67],v2,32768
R a[68:71],v2,33792
M v[228:231],a[100:103],v[48:51],v[228:231]
R a[72:75],v2,34816
R a[76:79],v2,35840
M v[236:239],a[104:107],v[52:55],v[236:239]
R a[80:83],v2,36864
R a[84:87],v2,37888
M v[236:239],a[108:111],v[48:51],v[236:239]
R a[88:91],v2,38912
R a[92:95],v2,39936
M v[244:247],a[112:115],v[52:55],v[244:247]
v_permlane32_swap_b32 v11, v31
M v[244:247],a[116:119],v[48:51],v[244:247]
s_waitcnt vmcnt(4)
buffer_load_dwordx4 v4, s[8:11], s21 offen offset:0 sc1 lds
M v[252:255],a[120:123],v[52:55],v[252:255]
s_waitcnt lgkmcnt(0)
AF v30,v10,v30
AF v31,v11,v31
M v[252:255],a[124:127],v[48:51],v[252:255]
v_rcp_f32 v5, v30
M v[64:67],a[64:67],a[0:3],0
R a[96:99],v2,40960
R a[100:103],v2,41984
M v[64:67],a[68:71],a[4:7],v[64:67]
v_rcp_f32 v6, v31
M v[64:67],a[72:75],a[8:11],v[64:67]
buffer_load_dwordx4 v4, s[8:11], s21 offen offset:1024 sc1 lds
M v[64:67],a[76:79],a[12:15],v[64:67]
R a[104:107],v2,43008
R a[108:111],v2,44032
M v[64:67],a[80:83],a[16:19],v[64:67]
W a192,v5
W a193,v6
M v[64:67],a[84:87],a[20:23],v[64:67]
buffer_load_dwordx4 v4, s[8:11], s21 offen offset:2048 sc1 lds
M v[64:67],a[88:91],a[24:27],v[64:67]
R a[112:115],v2,45056
R a[116:119],v2,46080
M v[64:67],a[92:95],a[28:31],v[64:67]
v_mov_b32 v30, 0
v_mov_b32 v31, 0
M v[68:71],a[92:95],a[60:63],0
buffer_load_dwordx4 v4, s[8:11], s21 offen offset:3072 sc1 lds
M v[68:71],a[88:91],a[56:59],v[68:71]
SA s21,s21,32768
R a[120:123],v2,47104
R a[124:127],v2,48128
M v[68:71],a[84:87],a[52:55],v[68:71]
s_sub_u32 s22, s22, 1
v_mov_b32 v32, 0
v_mov_b32 v33, 0
M v[68:71],a[80:83],a[48:51],v[68:71]
s_cselect_b32 s21, s23, s21
v_mov_b32 v34, 0
v_mov_b32 v35, 0
M v[68:71],a[76:79],a[44:47],v[68:71]
s_mul_i32 s26, s41, 1048576
v_mov_b32 v36, 0
v_mov_b32 v37, 0
M v[68:71],a[72:75],a[40:43],v[68:71]
SA s26,s26,17367040
v_mov_b32 v38, 0
v_mov_b32 v39, 0
M v[68:71],a[68:71],a[36:39],v[68:71]
SA m0,s28,0
E v18,v64
M v[68:71],a[64:67],a[32:35],v[68:71]
s_waitcnt lgkmcnt(0)
buffer_load_dwordx4 v3, s[8:11], s26 offen offset:0 sc1 lds
M v[72:75],a[96:99],a[0:3],0
R a[64:67],v2,49152
R a[68:71],v2,50176
M v[72:75],a[100:103],a[4:7],v[72:75]
E v19,v65
M v[72:75],a[104:107],a[8:11],v[72:75]
buffer_load_dwordx4 v3, s[8:11], s26 offen offset:1024 sc1 lds
M v[72:75],a[108:111],a[12:15],v[72:75]
R a[72:75],v2,51200
R a[76:79],v2,52224
M v[72:75],a[112:115],a[16:19],v[72:75]
E v20,v66
M v[72:75],a[116:119],a[20:23],v[72:75]
buffer_load_dwordx4 v3, s[8:11], s26 offen offset:2048 sc1 lds
M v[72:75],a[120:123],a[24:27],v[72:75]
R a[80:83],v2,53248
R a[84:87],v2,54272
M v[72:75],a[124:127],a[28:31],v[72:75]
E v21,v67
M v[76:79],a[124:127],a[60:63],0
buffer_load_dwordx4 v3, s[8:11], s26 offen offset:3072 sc1 lds
M v[76:79],a[120:123],a[56:59],v[76:79]
SA m0,s28,4096
R a[88:91],v2,55296
R a[92:95],v2,56320
M v[76:79],a[116:119],a[52:55],v[76:79]
E v22,v68
M v[76:79],a[112:115],a[48:51],v[76:79]
E v23,v69
M v[76:79],a[108:111],a[44:47],v[76:79]
buffer_load_dwordx4 v4, s[8:11], s26 offen offset:0 sc1 lds
M v[76:79],a[104:107],a[40:43],v[76:79]
AF v26,v18,v19
C v40,v18,v19
M v[76:79],a[100:103],a[36:39],v[76:79]
E v24,v70
M v[76:79],a[96:99],a[32:35],v[76:79]
s_waitcnt lgkmcnt(0)
AF v26,v20,v26
C v41,v20,v21
M v[80:83],a[64:67],a[0:3],0
R a[96:99],v2,57344
R a[100:103],v2,58368
M v[80:83],a[68:71],a[4:7],v[80:83]
buffer_load_dwordx4 v4, s[8:11], s26 offen offset:1024 sc1 lds
M v[80:83],a[72:75],a[8:11],v[80:83]
E v25,v71
M v[80:83],a[76:79],a[12:15],v[80:83]
R a[104:107],v2,59392
R a[108:111],v2,60416
M v[80:83],a[80:83],a[16:19],v[80:83]
AF v26,v21,v26
AF v27,v22,v23
M v[80:83],a[84:87],a[20:23],v[80:83]
buffer_load_dwordx4 v4, s[8:11], s26 offen offset:2048 sc1 lds
M v[80:83],a[88:91],a[24:27],v[80:83]
R a[112:115],v2,61440
R a[116:119],v2,62464
M v[80:83],a[92:95],a[28:31],v[80:83]
E v18,v72
M v[84:87],a[92:95],a[60:63],0
E v19,v73
M v[84:87],a[88:91],a[56:59],v[84:87]
R a[120:123],v2,63488
R a[124:127],v2,64512
M v[84:87],a[84:87],a[52:55],v[84:87]
buffer_load_dwordx4 v4, s[8:11], s26 offen offset:3072 sc1 lds
M v[84:87],a[80:83],a[48:51],v[84:87]
SA s26,s26,32768
E v20,v74
M v[84:87],a[76:79],a[44:47],v[84:87]
SA m0,s28,32768
C v44,v22,v23
AF v27,v24,v27
M v[84:87],a[72:75],a[40:43],v[84:87]
C v45,v24,v25
AF v27,v25,v27
M v[84:87],a[68:71],a[36:39],v[84:87]
s_waitcnt vmcnt(8) lgkmcnt(0)
buffer_load_dwordx4 v3, s[8:11], s26 offen offset:0 sc1 lds
M v[84:87],a[64:67],a[32:35],v[84:87]
s_barrier
M v[88:91],a[96:99],a[0:3],0
R a[64:67],v2,0
R a[68:71],v2,1024
M v[88:91],a[100:103],a[4:7],v[88:91]
E v21,v75
M v[88:91],a[104:107],a[8:11],v[88:91]
buffer_load_dwordx4 v3, s[8:11], s26 offen offset:1024 sc1 lds
M v[88:91],a[108:111],a[12:15],v[88:91]
R a[72:75],v2,2048
R a[76:79],v2,3072
M v[88:91],a[112:115],a[16:19],v[88:91]
E v22,v76
M v[88:91],a[116:119],a[20:23],v[88:91]
E v23,v77
M v[88:91],a[120:123],a[24:27],v[88:91]
R a[80:83],v2,4096
R a[84:87],v2,5120
M v[88:91],a[124:127],a[28:31],v[88:91]
buffer_load_dwordx4 v3, s[8:11], s26 offen offset:2048 sc1 lds
M v[92:95],a[124:127],a[60:63],0
E v24,v78
M v[92:95],a[120:123],a[56:59],v[92:95]
R a[88:91],v2,6144
R a[92:95],v2,7168
M v[92:95],a[116:119],a[52:55],v[92:95]
E v25,v79
M v[92:95],a[112:115],a[48:51],v[92:95]
buffer_load_dwordx4 v3, s[8:11], s26 offen offset:3072 sc1 lds
M v[92:95],a[108:111],a[44:47],v[92:95]
AF v26,v18,v26
C v42,v18,v19
M v[92:95],a[104:107],a[40:43],v[92:95]
AF v26,v19,v26
AF v26,v20,v26
M v[92:95],a[100:103],a[36:39],v[92:95]
s_waitcnt lgkmcnt(0)
C v43,v20,v21
AF v26,v21,v26
M v[92:95],a[96:99],a[32:35],v[92:95]
AF v27,v22,v27
C v46,v22,v23
AF v27,v23,v27
AF v27,v24,v27
C v47,v24,v25
AF v27,v25,v27
M v[96:99],a[64:67],a[0:3],0
R a[96:99],v2,8192
R a[100:103],v2,9216
M v[96:99],a[68:71],a[4:7],v[96:99]
SA m0,s28,98304
E v18,v80
M v[96:99],a[72:75],a[8:11],v[96:99]
buffer_load_dwordx4 v3, s[8:11], s21 offen offset:0 sc1 lds
M v[96:99],a[76:79],a[12:15],v[96:99]
R a[104:107],v2,10240
R a[108:111],v2,11264
M v[96:99],a[80:83],a[16:19],v[96:99]
E v19,v81
M v[96:99],a[84:87],a[20:23],v[96:99]
AF v26,v18,v26
C v56,v18,v19
M v[96:99],a[88:91],a[24:27],v[96:99]
R a[112:115],v2,12288
R a[116:119],v2,13312
M v[96:99],a[92:95],a[28:31],v[96:99]
buffer_load_dwordx4 v3, s[8:11], s21 offen offset:1024 sc1 lds
M v[100:103],a[92:95],a[60:63],0
E v20,v82
M v[100:103],a[88:91],a[56:59],v[100:103]
R a[120:123],v2,14336
R a[124:127],v2,15360
M v[100:103],a[84:87],a[52:55],v[100:103]
E v21,v83
M v[100:103],a[80:83],a[48:51],v[100:103]
buffer_load_dwordx4 v3, s[8:11], s21 offen offset:2048 sc1 lds
M v[100:103],a[76:79],a[44:47],v[100:103]
AF v26,v19,v26
AF v26,v20,v26
M v[100:103],a[72:75],a[40:43],v[100:103]
E v22,v88
M v[100:103],a[68:71],a[36:39],v[100:103]
C v57,v20,v21
AF v26,v21,v26
M v[100:103],a[64:67],a[32:35],v[100:103]
s_waitcnt lgkmcnt(0)
buffer_load_dwordx4 v3, s[8:11], s21 offen offset:3072 sc1 lds
M v[108:111],a[96:99],a[32:35],0
R a[64:67],v2,16384
R a[68:71],v2,17408
M v[108:111],a[100:103],a[36:39],v[108:111]
E v23,v89
M v[108:111],a[104:107],a[40:43],v[108:111]
SA m0,s28,102400
AF v26,v22,v26
C v58,v22,v23
M v[108:111],a[108:111],a[44:47],v[108:111]
R a[72:75],v2,18432
R a[76:79],v2,19456
M v[108:111],a[112:115],a[48:51],v[108:111]
buffer_load_dwordx4 v4, s[8:11], s21 offen offset:0 sc1 lds
M v[108:111],a[116:119],a[52:55],v[108:111]
E v24,v90
M v[108:111],a[120:123],a[56:59],v[108:111]
R a[80:83],v2,20480
R a[84:87],v2,21504
M v[108:111],a[124:127],a[60:63],v[108:111]
E v25,v91
M v[104:107],a[124:127],a[28:31],0
buffer_load_dwordx4 v4, s[8:11], s21 offen offset:1024 sc1 lds
M v[104:107],a[120:123],a[24:27],v[104:107]
R a[88:91],v2,22528
R a[92:95],v2,23552
M v[104:107],a[116:119],a[20:23],v[104:107]
AF v26,v23,v26
AF v26,v24,v26
M v[104:107],a[112:115],a[16:19],v[104:107]
E v18,v84
M v[104:107],a[108:111],a[12:15],v[104:107]
buffer_load_dwordx4 v4, s[8:11], s21 offen offset:2048 sc1 lds
M v[104:107],a[104:107],a[8:11],v[104:107]
C v59,v24,v25
AF v26,v25,v26
M v[104:107],a[100:103],a[4:7],v[104:107]
E v19,v85
M v[104:107],a[96:99],a[0:3],v[104:107]
s_waitcnt lgkmcnt(0)
AF v27,v18,v27
C v60,v18,v19
M v[112:115],a[64:67],a[0:3],0
R a[96:99],v2,24576
R a[100:103],v2,25600
M v[112:115],a[68:71],a[4:7],v[112:115]
buffer_load_dwordx4 v4, s[8:11], s21 offen offset:3072 sc1 lds
M v[112:115],a[72:75],a[8:11],v[112:115]
SA s21,s21,32768
E v20,v86
M v[112:115],a[76:79],a[12:15],v[112:115]
s_sub_u32 s22, s22, 1
R a[104:107],v2,26624
R a[108:111],v2,27648
M v[112:115],a[80:83],a[16:19],v[112:115]
s_cselect_b32 s21, s23, s21
AF v27,v19,v27
C v129,v130,v131
M v[112:115],a[84:87],a[20:23],v[112:115]
SA m0,s28,36864
E v21,v87
M v[112:115],a[88:91],a[24:27],v[112:115]
R a[112:115],v2,28672
R a[116:119],v2,29696
M v[112:115],a[92:95],a[28:31],v[112:115]
buffer_load_dwordx4 v4, s[8:11], s26 offen offset:0 sc1 lds
M v[116:119],a[92:95],a[60:63],0
E v22,v92
M v[116:119],a[88:91],a[56:59],v[116:119]
R a[120:123],v2,30720
R a[124:127],v2,31744
M v[116:119],a[84:87],a[52:55],v[116:119]
AF v27,v20,v27
C v61,v20,v21
M v[116:119],a[80:83],a[48:51],v[116:119]
buffer_load_dwordx4 v4, s[8:11], s26 offen offset:1024 sc1 lds
M v[116:119],a[76:79],a[44:47],v[116:119]
E v23,v93
M v[116:119],a[72:75],a[40:43],v[116:119]
AF v27,v21,v27
AF v27,v22,v27
M v[116:119],a[68:71],a[36:39],v[116:119]
s_waitcnt vmcnt(14) lgkmcnt(0)
C v62,v22,v23
AF v27,v23,v27
M v[116:119],a[64:67],a[32:35],v[116:119]
s_barrier
M v[124:127],a[96:99],a[32:35],0
R a[64:67],v7,0
R a[68:71],v7,1024
M v[124:127],a[100:103],a[36:39],v[124:127]
buffer_load_dwordx4 v4, s[8:11], s26 offen offset:2048 sc1 lds
M v[124:127],a[104:107],a[40:43],v[124:127]
E v24,v94
M v[124:127],a[108:111],a[44:47],v[124:127]
R a[72:75],v7,2048
R a[76:79],v7,3072
M v[124:127],a[112:115],a[48:51],v[124:127]
E v25,v95
M v[124:127],a[116:119],a[52:55],v[124:127]
buffer_load_dwordx4 v4, s[8:11], s26 offen offset:3072 sc1 lds
M v[124:127],a[120:123],a[56:59],v[124:127]
R a[80:83],v7,4096
R a[84:87],v7,5120
M v[124:127],a[124:127],a[60:63],v[124:127]
AF v27,v24,v27
C v63,v24,v25
M v[120:123],a[124:127],a[28:31],0
SA s26,s26,32768
AF v27,v25,v27
C v130,v136,v137
M v[120:123],a[120:123],a[24:27],v[120:123]
R a[88:91],v7,6144
R a[92:95],v7,7168
C v131,v138,v139
W a128,v128
W a129,v129
W a130,v130
W a131,v131
C v144,v144,v145
C v145,v146,v147
C v146,v152,v153
C v147,v154,v155
W a132,v144
W a133,v145
W a134,v146
W a135,v147
C v132,v132,v133
C v133,v134,v135
C v134,v140,v141
C v135,v142,v143
W a160,v132
W a161,v133
W a162,v134
W a163,v135
C v160,v160,v161
C v161,v162,v163
C v162,v168,v169
C v163,v170,v171
W a136,v160
W a137,v161
W a138,v162
W a139,v163
C v148,v148,v149
C v149,v150,v151
C v150,v156,v157
C v151,v158,v159
W a164,v148
W a165,v149
W a166,v150
W a167,v151
C v176,v176,v177
C v177,v178,v179
C v178,v184,v185
C v179,v186,v187
W a140,v176
W a141,v177
W a142,v178
W a143,v179
C v164,v164,v165
C v165,v166,v167
C v166,v172,v173
C v167,v174,v175
W a168,v164
W a169,v165
W a170,v166
W a171,v167
C v192,v192,v193
C v193,v194,v195
C v194,v200,v201
C v195,v202,v203
W a144,v192
W a145,v193
W a146,v194
W a147,v195
C v180,v180,v181
C v181,v182,v183
C v182,v188,v189
C v183,v190,v191
W a172,v180
W a173,v181
W a174,v182
W a175,v183
C v208,v208,v209
C v209,v210,v211
C v210,v216,v217
C v211,v218,v219
W a148,v208
W a149,v209
W a150,v210
W a151,v211
C v196,v196,v197
C v197,v198,v199
C v198,v204,v205
C v199,v206,v207
W a176,v196
W a177,v197
W a178,v198
W a179,v199
C v224,v224,v225
C v225,v226,v227
C v226,v232,v233
C v227,v234,v235
W a152,v224
W a153,v225
W a154,v226
W a155,v227
C v212,v212,v213
C v213,v214,v215
C v214,v220,v221
C v215,v222,v223
W a180,v212
W a181,v213
W a182,v214
W a183,v215
C v240,v240,v241
C v241,v242,v243
C v242,v248,v249
C v243,v250,v251
W a156,v240
W a157,v241
W a158,v242
W a159,v243
C v228,v228,v229
C v229,v230,v231
C v230,v236,v237
C v231,v238,v239
W a184,v228
W a185,v229
W a186,v230
W a187,v231
C v244,v244,v245
C v245,v246,v247
C v246,v252,v253
C v247,v254,v255
W a188,v244
W a189,v245
W a190,v246
W a191,v247
M v[120:123],a[116:119],a[20:23],v[120:123]
M v[120:123],a[112:115],a[16:19],v[120:123]
M v[120:123],a[108:111],a[12:15],v[120:123]
M v[120:123],a[104:107],a[8:11],v[120:123]
M v[120:123],a[100:103],a[4:7],v[120:123]
s_waitcnt lgkmcnt(0)
M v[120:123],a[96:99],a[0:3],v[120:123]
v_max_f32 v10, v26, v27
v_min_f32 v11, v26, v27
v_cmp_lt_f32 vcc, s31, v10
v_cmp_gt_f32 s[64:65], s24, v11
s_nop 0
s_or_b64 vcc, vcc, s[64:65]
s_cbranch_vccnz L_sth1
L_rth1:
M v[128:131],a[64:67],v[40:43],0
R a[96:99],v7,8192
R a[100:103],v7,9216
M v[128:131],a[68:71],v[56:59],v[128:131]
SA m0,s28,65536
E v18,v96
M v[132:135],a[68:71],v[60:63],0
buffer_load_dwordx4 v3, s[8:11], s21 offen offset:0 sc1 lds
M v[132:135],a[64:67],v[44:47],v[132:135]
R a[104:107],v7,10240
R a[108:111],v7,11264
M v[140:143],a[72:75],v[44:47],0
E v19,v97
M v[140:143],a[76:79],v[60:63],v[140:143]
AF v30,v26,v30
AF v31,v27,v31
M v[136:139],a[76:79],v[56:59],0
R a[112:115],v7,12288
R a[116:119],v7,13312
M v[136:139],a[72:75],v[40:43],v[136:139]
buffer_load_dwordx4 v3, s[8:11], s21 offen offset:1024 sc1 lds
M v[144:147],a[80:83],v[40:43],0
E v20,v98
M v[144:147],a[84:87],v[56:59],v[144:147]
R a[120:123],v7,14336
R a[124:127],v7,15360
M v[148:151],a[84:87],v[60:63],0
s_mov_b32 s40, 0
AF v28,v18,v19
C v48,v18,v19
M v[148:151],a[80:83],v[44:47],v[148:151]
s_mov_b32 s7, 0
buffer_load_dwordx4 v3, s[8:11], s21 offen offset:2048 sc1 lds
M v[156:159],a[88:91],v[44:47],0
s_and_b32 s39, s39, 1
E v21,v99
M v[156:159],a[92:95],v[60:63],v[156:159]
s_or_b32 s39, s39, 2
AF v28,v20,v28
C v49,v20,v21
M v[152:155],a[92:95],v[56:59],0
s_sub_u32 s27, 5, s42
AF v28,v21,v28
M v[152:155],a[88:91],v[40:43],v[152:155]
s_waitcnt lgkmcnt(0)
buffer_load_dwordx4 v3, s[8:11], s21 offen offset:3072 sc1 lds
M v[160:163],a[96:99],v[40:43],0
SA m0,s28,69632
R a[64:67],v7,16384
R a[68:71],v7,17408
M v[160:163],a[100:103],v[56:59],v[160:163]
E v22,v104
M v[164:167],a[100:103],v[60:63],0
E v23,v105
M v[164:167],a[96:99],v[44:47],v[164:167]
R a[72:75],v7,18432
R a[76:79],v7,19456
M v[172:175],a[104:107],v[44:47],0
buffer_load_dwordx4 v4, s[8:11], s21 offen offset:0 sc1 lds
M v[172:175],a[108:111],v[60:63],v[172:175]
AF v28,v22,v28
C v50,v22,v23
M v[168:171],a[108:111],v[56:59],0
R a[80:83],v7,20480
R a[84:87],v7,21504
M v[168:171],a[104:107],v[40:43],v[168:171]
buffer_load_dwordx4 v4, s[8:11], s21 offen offset:1024 sc1 lds
M v[176:179],a[112:115],v[40:43],0
E v24,v106
M v[176:179],a[116:119],v[56:59],v[176:179]
R a[88:91],v7,22528
R a[92:95],v7,23552
M v[180:183],a[116:119],v[60:63],0
buffer_load_dwordx4 v4, s[8:11], s21 offen offset:2048 sc1 lds
M v[180:183],a[112:115],v[44:47],v[180:183]
E v25,v107
M v[188:191],a[120:123],v[44:47],0
AF v28,v23,v28
AF v28,v24,v28
M v[188:191],a[124:127],v[60:63],v[188:191]
C v51,v24,v25
AF v28,v25,v28
M v[184:187],a[124:127],v[56:59],0
buffer_load_dwordx4 v4, s[8:11], s21 offen offset:3072 sc1 lds
M v[184:187],a[120:123],v[40:43],v[184:187]
s_waitcnt lgkmcnt(0)
E v18,v100
M v[192:195],a[64:67],v[40:43],0
SA s21,s21,32768
R a[96:99],v7,24576
R a[100:103],v7,25600
M v[192:195],a[68:71],v[56:59],v[192:195]
s_sub_u32 s22, s22, 1
E v19,v101
M v[196:199],a[68:71],v[60:63],0
s_cselect_b32 s21, s23, s21
AF v29,v18,v19
C v52,v18,v19
M v[196:199],a[64:67],v[44:47],v[196:199]
R a[104:107],v7,26624
R a[108:111],v7,27648
M v[204:207],a[72:75],v[44:47],0
M v[204:207],a[76:79],v[60:63],v[204:207]
E v20,v102
M v[200:203],a[76:79],v[56:59],0
R a[112:115],v7,28672
R a[116:119],v7,29696
M v[200:203],a[72:75],v[40:43],v[200:203]
M v[208:211],a[80:83],v[40:43],0
M v[208:211],a[84:87],v[56:59],v[208:211]
R a[120:123],v7,30720
R a[124:127],v7,31744
M v[212:215],a[84:87],v[60:63],0
E v21,v103
M v[212:215],a[80:83],v[44:47],v[212:215]
AF v29,v20,v29
C v53,v20,v21
M v[220:223],a[88:91],v[44:47],0
AF v29,v21,v29
M v[220:223],a[92:95],v[60:63],v[220:223]
E v22,v108
M v[216:219],a[92:95],v[56:59],0
s_waitcnt vmcnt(12) lgkmcnt(0)
M v[216:219],a[88:91],v[40:43],v[216:219]
s_barrier
M v[224:227],a[96:99],v[40:43],0
R a[64:67],v2,32768
R a[68:71],v2,33792
M v[224:227],a[100:103],v[56:59],v[224:227]
E v23,v109
M v[228:231],a[100:103],v[60:63],0
AF v29,v22,v29
C v54,v22,v23
M v[228:231],a[96:99],v[44:47],v[228:231]
R a[72:75],v2,34816
R a[76:79],v2,35840
M v[236:239],a[104:107],v[44:47],0
E v24,v110
M v[236:239],a[108:111],v[60:63],v[236:239]
AF v29,v23,v29
M v[232:235],a[108:111],v[56:59],0
R a[80:83],v2,36864
R a[84:87],v2,37888
M v[232:235],a[104:107],v[40:43],v[232:235]
M v[240:243],a[112:115],v[40:43],0
E v25,v111
M v[240:243],a[116:119],v[56:59],v[240:243]
R a[88:91],v2,38912
R a[92:95],v2,39936
M v[244:247],a[116:119],v[60:63],0
AF v29,v24,v29
C v55,v24,v25
M v[244:247],a[112:115],v[44:47],v[244:247]
AF v29,v25,v29
M v[252:255],a[120:123],v[44:47],0
M v[252:255],a[124:127],v[60:63],v[252:255]
M v[248:251],a[124:127],v[56:59],0
s_waitcnt lgkmcnt(0)
M v[248:251],a[120:123],v[40:43],v[248:251]
s_cmp_lg_u32 s27, 0
s_cbranch_scc1 L_loop_top
L_final_h:
s_waitcnt vmcnt(8) lgkmcnt(0)
s_barrier
R a[64:67],v7,32768
R a[68:71],v7,33792
R a[72:75],v7,34816
R a[76:79],v7,35840
R a[80:83],v7,36864
R a[84:87],v7,37888
R a[88:91],v7,38912
R a[92:95],v7,39936
v_lshrrev_b32 v14, 7, v7
v_mul_u32_u24 v14, 896, v14
v_lshrrev_b32 v15, 8, v7
v_lshlrev_b32 v15, 5, v15
v_xor_b32 v15, v15, v7
v_and_b32 v15, 0x70, v15
v_add_u32 v0, v14, v15
s_mul_i32 s38, s20, 57344
SA m0,s28,98304
SA s85,s38,0
E v18,v112
buffer_load_dwordx4 v0, s[12:15], s85 offen offset:0 lds
E v19,v113
E v20,v114
AF v28,v18,v28
SA s85,s38,6144
C v56,v18,v19
buffer_load_dwordx4 v0, s[12:15], s85 offen offset:1024 lds
E v21,v115
AF v28,v19,v28
E v22,v120
AF v28,v20,v28
SA s85,s38,12288
C v57,v20,v21
buffer_load_dwordx4 v0, s[12:15], s85 offen offset:2048 lds
E v23,v121
AF v28,v21,v28
E v24,v122
AF v28,v22,v28
SA s85,s38,18432
C v58,v22,v23
buffer_load_dwordx4 v0, s[12:15], s85 offen offset:3072 lds
E v25,v123
AF v28,v23,v28
E v18,v116
AF v28,v24,v28
SA m0,s28,102400
SA s85,s38,28672
C v59,v24,v25
buffer_load_dwordx4 v0, s[12:15], s85 offen offset:0 lds
E v19,v117
AF v28,v25,v28
E v20,v118
AF v29,v18,v29
SA s85,s38,34816
C v60,v18,v19
buffer_load_dwordx4 v0, s[12:15], s85 offen offset:1024 lds
E v21,v119
AF v29,v19,v29
E v22,v124
AF v29,v20,v29
SA s85,s38,40960
C v61,v20,v21
buffer_load_dwordx4 v0, s[12:15], s85 offen offset:2048 lds
E v23,v125
AF v29,v21,v29
E v24,v126
AF v29,v22,v29
SA s85,s38,47104
C v62,v22,v23
buffer_load_dwordx4 v0, s[12:15], s85 offen offset:3072 lds
SA s38,s38,128
E v25,v127
AF v29,v23,v29
AF v29,v24,v29
C v63,v24,v25
AF v29,v25,v29
v_max_f32 v10, v28, v29
v_cmp_lt_f32 vcc, s31, v10
s_nop 0
s_cbranch_vccnz L_stfh
L_rtfh:
AF v30,v28,v30
AF v31,v29,v31
v_mov_b32 v10, v32
v_mov_b32 v11, v36
v_mov_b32 v12, v30
v_mov_b32 v13, v31
buffer_store_dwordx4 v[10:13], v7, s[8:11], s90 offen sc1
s_waitcnt lgkmcnt(0)
M v[128:131],a[64:67],v[48:51],v[128:131]
SA m0,s28,65536
R a[96:99],v7,40960
R a[100:103],v7,41984
M v[128:131],a[68:71],v[56:59],v[128:131]
SA s85,s38,0
buffer_load_dwordx4 v0, s[12:15], s85 offen offset:0 lds
M v[132:135],a[68:71],v[60:63],v[132:135]
SA s85,s38,6144
v_lshrrev_b32 v16, 4, v7
v_lshrrev_b32 v14, 2, v16
M v[132:135],a[64:67],v[52:55],v[132:135]
R a[104:107],v7,43008
R a[108:111],v7,44032
M v[136:139],a[72:75],v[48:51],v[136:139]
buffer_load_dwordx4 v0, s[12:15], s85 offen offset:1024 lds
M v[136:139],a[76:79],v[56:59],v[136:139]
SA s85,s38,12288
v_lshlrev_b32 v14, 7, v14
v_and_b32 v15, 3, v16
M v[140:143],a[76:79],v[60:63],v[140:143]
R a[112:115],v7,45056
R a[116:119],v7,46080
M v[140:143],a[72:75],v[52:55],v[140:143]
buffer_load_dwordx4 v0, s[12:15], s85 offen offset:2048 lds
M v[144:147],a[80:83],v[48:51],v[144:147]
SA s85,s38,18432
v_lshl_add_u32 v14, v15, 3, v14
v_bfe_u32 v15, v16, 3, 2
M v[144:147],a[84:87],v[56:59],v[144:147]
R a[120:123],v7,47104
R a[124:127],v7,48128
M v[148:151],a[84:87],v[60:63],v[148:151]
buffer_load_dwordx4 v0, s[12:15], s85 offen offset:3072 lds
M v[148:151],a[80:83],v[52:55],v[148:151]
v_lshl_add_u32 v18, v15, 5, v14
v_xor_b32 v19, 32, v18
M v[152:155],a[88:91],v[48:51],v[152:155]
v_xor_b32 v20, 64, v18
v_xor_b32 v21, 0x60, v18
M v[152:155],a[92:95],v[56:59],v[152:155]
v_add_u32 v22, 0x10000, v18
v_add_u32 v23, 0x10000, v19
M v[156:159],a[92:95],v[60:63],v[156:159]
v_add_u32 v24, 0x10000, v20
v_add_u32 v25, 0x10000, v21
M v[156:159],a[88:91],v[52:55],v[156:159]
s_waitcnt lgkmcnt(0)
C v128,v128,v129
C v129,v130,v131
M v[160:163],a[96:99],v[48:51],v[160:163]
R a[64:67],v7,49152
R a[68:71],v7,50176
M v[160:163],a[100:103],v[56:59],v[160:163]
C v130,v136,v137
C v131,v138,v139
M v[164:167],a[100:103],v[60:63],v[164:167]
buffer_store_dwordx4 v[128:131], v7, s[8:11], s86 offen offset:0 sc1
M v[164:167],a[96:99],v[52:55],v[164:167]
R a[72:75],v7,51200
R a[76:79],v7,52224
M v[168:171],a[104:107],v[48:51],v[168:171]
C v132,v132,v133
C v133,v134,v135
M v[168:171],a[108:111],v[56:59],v[168:171]
C v134,v140,v141
C v135,v142,v143
M v[172:175],a[108:111],v[60:63],v[172:175]
R a[80:83],v7,53248
R a[84:87],v7,54272
M v[172:175],a[104:107],v[52:55],v[172:175]
buffer_store_dwordx4 v[132:135], v7, s[8:11], s88 offen offset:0 sc1
M v[176:179],a[112:115],v[48:51],v[176:179]
C v144,v144,v145
C v145,v146,v147
M v[176:179],a[116:119],v[56:59],v[176:179]
R a[88:91],v7,55296
R a[92:95],v7,56320
M v[180:183],a[116:119],v[60:63],v[180:183]
C v146,v152,v153
C v147,v154,v155
M v[180:183],a[112:115],v[52:55],v[180:183]
buffer_store_dwordx4 v[144:147], v7, s[8:11], s86 offen offset:1024 sc1
M v[184:187],a[120:123],v[48:51],v[184:187]
C v148,v148,v149
C v149,v150,v151
M v[184:187],a[124:127],v[56:59],v[184:187]
C v150,v156,v157
C v151,v158,v159
M v[188:191],a[124:127],v[60:63],v[188:191]
buffer_store_dwordx4 v[148:151], v7, s[8:11], s88 offen offset:1024 sc1
M v[188:191],a[120:123],v[52:55],v[188:191]
s_waitcnt lgkmcnt(0)
C v160,v160,v161
C v161,v162,v163
M v[192:195],a[64:67],v[48:51],v[192:195]
R a[96:99],v7,57344
R a[100:103],v7,58368
M v[192:195],a[68:71],v[56:59],v[192:195]
C v162,v168,v169
C v163,v170,v171
M v[196:199],a[68:71],v[60:63],v[196:199]
buffer_store_dwordx4 v[160:163], v7, s[8:11], s86 offen offset:2048 sc1
M v[196:199],a[64:67],v[52:55],v[196:199]
R a[104:107],v7,59392
R a[108:111],v7,60416
M v[200:203],a[72:75],v[48:51],v[200:203]
C v164,v164,v165
C v165,v166,v167
M v[200:203],a[76:79],v[56:59],v[200:203]
C v166,v172,v173
C v167,v174,v175
M v[204:207],a[76:79],v[60:63],v[204:207]
R a[112:115],v7,61440
R a[116:119],v7,62464
M v[204:207],a[72:75],v[52:55],v[204:207]
buffer_store_dwordx4 v[164:167], v7, s[8:11], s88 offen offset:2048 sc1
M v[208:211],a[80:83],v[48:51],v[208:211]
C v176,v176,v177
C v177,v178,v179
M v[208:211],a[84:87],v[56:59],v[208:211]
R a[120:123],v7,63488
R a[124:127],v7,64512
M v[212:215],a[84:87],v[60:63],v[212:215]
C v178,v184,v185
C v179,v186,v187
M v[212:215],a[80:83],v[52:55],v[212:215]
buffer_store_dwordx4 v[176:179], v7, s[8:11], s86 offen offset:3072 sc1
M v[216:219],a[88:91],v[48:51],v[216:219]
C v180,v180,v181
C v181,v182,v183
M v[216:219],a[92:95],v[56:59],v[216:219]
C v182,v188,v189
C v183,v190,v191
M v[220:223],a[92:95],v[60:63],v[220:223]
s_waitcnt vmcnt(12) lgkmcnt(0)
buffer_store_dwordx4 v[180:183], v7, s[8:11], s88 offen offset:3072 sc1
M v[220:223],a[88:91],v[52:55],v[220:223]
s_barrier
M v[224:227],a[96:99],v[48:51],v[224:227]
s_nop 0
T a[64:65],v22,32768
T a[66:67],v22,34816
M v[224:227],a[100:103],v[56:59],v[224:227]
T a[68:69],v22,36864
T a[70:71],v22,38912
M v[228:231],a[100:103],v[60:63],v[228:231]
C v192,v192,v193
C v193,v194,v195
M v[228:231],a[96:99],v[52:55],v[228:231]
T a[72:73],v22,40960
T a[74:75],v22,43008
M v[232:235],a[104:107],v[48:51],v[232:235]
T a[76:77],v22,45056
T a[78:79],v22,47104
M v[232:235],a[108:111],v[56:59],v[232:235]
C v194,v200,v201
C v195,v202,v203
M v[236:239],a[108:111],v[60:63],v[236:239]
T a[80:81],v22,49152
T a[82:83],v22,51200
M v[236:239],a[104:107],v[52:55],v[236:239]
T a[84:85],v22,53248
T a[86:87],v22,55296
M v[240:243],a[112:115],v[48:51],v[240:243]
buffer_store_dwordx4 v[192:195], v7, s[8:11], s87 offen offset:0 sc1
M v[240:243],a[116:119],v[56:59],v[240:243]
s_nop 0
T a[88:89],v22,57344
T a[90:91],v22,59392
M v[244:247],a[116:119],v[60:63],v[244:247]
T a[92:93],v22,61440
T a[94:95],v22,63488
M v[244:247],a[112:115],v[52:55],v[244:247]
C v196,v196,v197
C v197,v198,v199
M v[248:251],a[120:123],v[48:51],v[248:251]
C v198,v204,v205
C v199,v206,v207
M v[248:251],a[124:127],v[56:59],v[248:251]
buffer_store_dwordx4 v[196:199], v7, s[8:11], s89 offen offset:0 sc1
M v[252:255],a[124:127],v[60:63],v[252:255]
s_waitcnt lgkmcnt(0)
C v208,v208,v209
C v209,v210,v211
M v[252:255],a[120:123],v[52:55],v[252:255]
C v210,v216,v217
C v211,v218,v219
buffer_store_dwordx4 v[208:211], v7, s[8:11], s87 offen offset:1024 sc1
C v212,v212,v213
C v213,v214,v215
C v214,v220,v221
C v215,v222,v223
buffer_store_dwordx4 v[212:215], v7, s[8:11], s89 offen offset:1024 sc1
C v224,v224,v225
C v225,v226,v227
C v226,v232,v233
C v227,v234,v235
buffer_store_dwordx4 v[224:227], v7, s[8:11], s87 offen offset:2048 sc1
C v228,v228,v229
C v229,v230,v231
C v230,v236,v237
C v231,v238,v239
buffer_store_dwordx4 v[228:231], v7, s[8:11], s89 offen offset:2048 sc1
C v240,v240,v241
C v241,v242,v243
C v242,v248,v249
C v243,v250,v251
buffer_store_dwordx4 v[240:243], v7, s[8:11], s87 offen offset:3072 sc1
C v244,v244,v245
C v245,v246,v247
C v246,v252,v253
C v247,v254,v255
buffer_store_dwordx4 v[244:247], v7, s[8:11], s89 offen offset:3072 sc1
M v[64:67],a[64:67],a[128:131],0
s_nop 0
T a[96:97],v23,32768
T a[98:99],v23,34816
M v[64:67],a[68:71],a[132:135],v[64:67]
SA m0,s28,69632
T a[100:101],v23,36864
T a[102:103],v23,38912
M v[64:67],a[72:75],a[136:139],v[64:67]
SA s85,s38,28672
buffer_load_dwordx4 v0, s[12:15], s85 offen offset:0 lds
M v[64:67],a[76:79],a[140:143],v[64:67]
SA s85,s38,34816
T a[104:105],v23,40960
T a[106:107],v23,43008
M v[64:67],a[80:83],a[144:147],v[64:67]
SA s29,s33,0
T a[108:109],v23,45056
T a[110:111],v23,47104
M v[64:67],a[84:87],a[148:151],v[64:67]
SA s30,s33,14336
buffer_load_dwordx4 v0, s[12:15], s85 offen offset:1024 lds
M v[64:67],a[88:91],a[152:155],v[64:67]
SA s85,s38,40960
T a[112:113],v23,49152
T a[114:115],v23,51200
M v[64:67],a[92:95],a[156:159],v[64:67]
T a[116:117],v23,53248
T a[118:119],v23,55296
M v[68:71],a[92:95],a[188:191],0
buffer_load_dwordx4 v0, s[12:15], s85 offen offset:2048 lds
M v[68:71],a[88:91],a[184:187],v[68:71]
SA s85,s38,47104
T a[120:121],v23,57344
T a[122:123],v23,59392
M v[68:71],a[84:87],a[180:183],v[68:71]
T a[124:125],v23,61440
T a[126:127],v23,63488
M v[68:71],a[80:83],a[176:179],v[68:71]
buffer_load_dwordx4 v0, s[12:15], s85 offen offset:3072 lds
M v[68:71],a[76:79],a[172:175],v[68:71]
SA s38,s38,128
G v5,a192
G v6,a193
M v[68:71],a[72:75],a[168:171],v[68:71]
s_sub_u32 s64, 15, s42
M v[68:71],a[68:71],a[164:167],v[68:71]
s_min_u32 s64, s64, s42
M v[68:71],a[64:67],a[160:163],v[68:71]
s_waitcnt lgkmcnt(0)
M v[72:75],a[96:99],a[128:131],0
s_mul_i32 s45, s64, 8704
T a[64:65],v24,32768
T a[66:67],v24,34816
M v[72:75],a[100:103],a[132:135],v[72:75]
s_lshl_b32 s64, s41, 2
T a[68:69],v24,36864
T a[70:71],v24,38912
M v[72:75],a[104:107],a[136:139],v[72:75]
SA s45,s45,s64
M v[72:75],a[108:111],a[140:143],v[72:75]
s_lshl_b32 s64, s20, 8
T a[72:73],v24,40960
T a[74:75],v24,43008
M v[72:75],a[112:115],a[144:147],v[72:75]
SA s45,s45,s64
T a[76:77],v24,45056
T a[78:79],v24,47104
M v[72:75],a[116:119],a[148:151],v[72:75]
SA s45,s45,104992768
M v[72:75],a[120:123],a[152:155],v[72:75]
s_mov_b32 s64, 1024
T a[80:81],v24,49152
T a[82:83],v24,51200
M v[72:75],a[124:127],a[156:159],v[72:75]
s_mov_b32 s66, 4096
T a[84:85],v24,53248
T a[86:87],v24,55296
M v[76:79],a[124:127],a[188:191],0
s_cmp_lt_u32 s42, 8
M v[76:79],a[120:123],a[184:187],v[76:79]
s_cselect_b32 s64, 4352, s64
T a[88:89],v24,57344
T a[90:91],v24,59392
M v[76:79],a[116:119],a[180:183],v[76:79]
s_cselect_b32 s65, 0, 64
T a[92:93],v24,61440
T a[94:95],v24,63488
M v[76:79],a[112:115],a[176:179],v[76:79]
s_cselect_b32 s66, 536870912, s66
MF v64,v5,v64
MF v65,v5,v65
M v[76:79],a[108:111],a[172:175],v[76:79]
SA s3,s45,s64
MF v66,v5,v66
MF v67,v5,v67
M v[76:79],a[104:107],a[168:171],v[76:79]
SA s45,s45,s65
v_lshrrev_b32 v17, 5, v7
v_min_u32 v15, 1, v17
M v[76:79],a[100:103],a[164:167],v[76:79]
SA m0,s28,0
v_lshlrev_b32 v14, 3, v7
v_lshl_or_b32 v16, v15, 29, v14
M v[76:79],a[96:99],a[160:163],v[76:79]
s_waitcnt lgkmcnt(0)
v_cmp_eq_u32 vcc, 1, v17
v_add_u32 v14, s66, v14
M v[80:83],a[64:67],a[128:131],0
SA s85,s38,0
T a[96:97],v25,32768
T a[98:99],v25,34816
M v[80:83],a[68:71],a[132:135],v[80:83]
T a[100:101],v25,36864
T a[102:103],v25,38912
M v[80:83],a[72:75],a[136:139],v[80:83]
buffer_load_dwordx4 v0, s[12:15], s85 offen offset:0 lds
M v[80:83],a[76:79],a[140:143],v[80:83]
SA s85,s38,6144
T a[104:105],v25,40960
T a[106:107],v25,43008
M v[80:83],a[80:83],a[144:147],v[80:83]
T a[108:109],v25,45056
T a[110:111],v25,47104
M v[80:83],a[84:87],a[148:151],v[80:83]
buffer_load_dwordx4 v0, s[12:15], s85 offen offset:1024 lds
M v[80:83],a[88:91],a[152:155],v[80:83]
SA s85,s38,12288
T a[112:113],v25,49152
T a[114:115],v25,51200
M v[80:83],a[92:95],a[156:159],v[80:83]
T a[116:117],v25,53248
T a[118:119],v25,55296
M v[84:87],a[92:95],a[188:191],0
buffer_load_dwordx4 v0, s[12:15], s85 offen offset:2048 lds
M v[84:87],a[88:91],a[184:187],v[84:87]
SA s85,s38,18432
T a[120:121],v25,57344
T a[122:123],v25,59392
M v[84:87],a[84:87],a[180:183],v[84:87]
T a[124:125],v25,61440
T a[126:127],v25,63488
M v[84:87],a[80:83],a[176:179],v[84:87]
buffer_load_dwordx4 v0, s[12:15], s85 offen offset:3072 lds
M v[84:87],a[76:79],a[172:175],v[84:87]
SA m0,s28,4096
v_mov_b32 v15, 1
v_cndmask_b32 v17, v16, v14, vcc
M v[84:87],a[72:75],a[168:171],v[84:87]
SA s85,s38,28672
buffer_load_dwordx4 v0, s[12:15], s85 offen offset:0 lds
M v[84:87],a[68:71],a[164:167],v[84:87]
s_waitcnt vmcnt(5) lgkmcnt(0)
v_min_u32 v10, 1, v7
v_lshlrev_b32 v10, 29, v10
M v[84:87],a[64:67],a[160:163],v[84:87]
s_barrier
M v[88:91],a[96:99],a[128:131],0
SA s85,s38,34816
T a[64:65],v22,0
T a[66:67],v22,2048
M v[88:91],a[100:103],a[132:135],v[88:91]
T a[68:69],v22,4096
T a[70:71],v22,6144
M v[88:91],a[104:107],a[136:139],v[88:91]
buffer_load_dwordx4 v0, s[12:15], s85 offen offset:1024 lds
M v[88:91],a[108:111],a[140:143],v[88:91]
SA s85,s38,40960
T a[72:73],v22,8192
T a[74:75],v22,10240
M v[88:91],a[112:115],a[144:147],v[88:91]
T a[76:77],v22,12288
T a[78:79],v22,14336
M v[88:91],a[116:119],a[148:151],v[88:91]
buffer_load_dwordx4 v0, s[12:15], s85 offen offset:2048 lds
M v[88:91],a[120:123],a[152:155],v[88:91]
SA s85,s38,47104
T a[80:81],v22,16384
T a[82:83],v22,18432
M v[88:91],a[124:127],a[156:159],v[88:91]
T a[84:85],v22,20480
T a[86:87],v22,22528
M v[92:95],a[124:127],a[188:191],0
buffer_store_dword v15, v10, s[8:11], s47 offen sc1
M v[92:95],a[120:123],a[184:187],v[92:95]
s_nop 0
T a[88:89],v22,24576
T a[90:91],v22,26624
M v[92:95],a[116:119],a[180:183],v[92:95]
T a[92:93],v22,28672
T a[94:95],v22,30720
M v[92:95],a[112:115],a[176:179],v[92:95]
buffer_load_dwordx4 v0, s[12:15], s85 offen offset:3072 lds
M v[92:95],a[108:111],a[172:175],v[92:95]
SA s38,s38,128
MF v72,v5,v72
MF v73,v5,v73
M v[92:95],a[104:107],a[168:171],v[92:95]
SA m0,s28,131072
MF v74,v5,v74
MF v75,v5,v75
M v[92:95],a[100:103],a[164:167],v[92:95]
s_waitcnt lgkmcnt(0)
C v64,v64,v65
C v65,v66,v67
M v[92:95],a[96:99],a[160:163],v[92:95]
SA s85,s38,0
C v66,v72,v73
C v67,v74,v75
buffer_store_dwordx4 v[64:67], v7, s[8:11], s29 offen offset:0 sc1
buffer_load_dwordx4 v0, s[12:15], s85 offen offset:0 lds
v_add_u32 v40, 0x20000, v18
v_add_u32 v41, 0x20000, v19
v_add_u32 v42, 0x20000, v20
v_add_u32 v43, 0x20000, v21
SA s85,s38,6144
MF v68,v6,v68
MF v69,v6,v69
MF v70,v6,v70
MF v71,v6,v71
MF v76,v6,v76
MF v77,v6,v77
MF v78,v6,v78
MF v79,v6,v79
C v68,v68,v69
C v69,v70,v71
C v70,v76,v77
C v71,v78,v79
buffer_store_dwordx4 v[68:71], v7, s[8:11], s30 offen offset:0 sc1
buffer_load_dwordx4 v0, s[12:15], s85 offen offset:1024 lds
SA s85,s38,12288
buffer_load_dwordx4 v0, s[12:15], s85 offen offset:2048 lds
SA s85,s38,18432
buffer_load_dwordx4 v0, s[12:15], s85 offen offset:3072 lds
M v[96:99],a[64:67],a[128:131],0
s_nop 0
T a[96:97],v23,0
T a[98:99],v23,2048
M v[96:99],a[68:71],a[132:135],v[96:99]
SA m0,s28,135168
T a[100:101],v23,4096
T a[102:103],v23,6144
M v[96:99],a[72:75],a[136:139],v[96:99]
SA s85,s38,28672
buffer_load_dwordx4 v0, s[12:15], s85 offen offset:0 lds
M v[96:99],a[76:79],a[140:143],v[96:99]
SA s85,s38,34816
T a[104:105],v23,8192
T a[106:107],v23,10240
M v[96:99],a[80:83],a[144:147],v[96:99]
T a[108:109],v23,12288
T a[110:111],v23,14336
M v[96:99],a[84:87],a[148:151],v[96:99]
buffer_load_dwordx4 v0, s[12:15], s85 offen offset:1024 lds
M v[96:99],a[88:91],a[152:155],v[96:99]
SA s85,s38,40960
T a[112:113],v23,16384
T a[114:115],v23,18432
M v[96:99],a[92:95],a[156:159],v[96:99]
T a[116:117],v23,20480
T a[118:119],v23,22528
M v[100:103],a[92:95],a[188:191],0
buffer_load_dwordx4 v0, s[12:15], s85 offen offset:2048 lds
M v[100:103],a[88:91],a[184:187],v[100:103]
SA s85,s38,47104
T a[120:121],v23,24576
T a[122:123],v23,26624
M v[100:103],a[84:87],a[180:183],v[100:103]
T a[124:125],v23,28672
T a[126:127],v23,30720
M v[100:103],a[80:83],a[176:179],v[100:103]
buffer_load_dwordx4 v0, s[12:15], s85 offen offset:3072 lds
M v[100:103],a[76:79],a[172:175],v[100:103]
SA s38,s38,128
MF v80,v5,v80
MF v81,v5,v81
M v[100:103],a[72:75],a[168:171],v[100:103]
SA m0,s28,32768
MF v82,v5,v82
MF v83,v5,v83
M v[100:103],a[68:71],a[164:167],v[100:103]
SA s85,s38,0
buffer_load_dwordx4 v0, s[12:15], s85 offen offset:0 lds
M v[100:103],a[64:67],a[160:163],v[100:103]
s_waitcnt lgkmcnt(0)
MF v88,v5,v88
MF v89,v5,v89
M v[104:107],a[96:99],a[128:131],0
SA s85,s38,6144
T a[64:65],v24,0
T a[66:67],v24,2048
M v[104:107],a[100:103],a[132:135],v[104:107]
T a[68:69],v24,4096
T a[70:71],v24,6144
M v[104:107],a[104:107],a[136:139],v[104:107]
buffer_load_dwordx4 v0, s[12:15], s85 offen offset:1024 lds
M v[104:107],a[108:111],a[140:143],v[104:107]
SA s85,s38,12288
T a[72:73],v24,8192
T a[74:75],v24,10240
M v[104:107],a[112:115],a[144:147],v[104:107]
T a[76:77],v24,12288
T a[78:79],v24,14336
M v[104:107],a[116:119],a[148:151],v[104:107]
buffer_load_dwordx4 v0, s[12:15], s85 offen offset:2048 lds
M v[104:107],a[120:123],a[152:155],v[104:107]
SA s85,s38,18432
T a[80:81],v24,16384
T a[82:83],v24,18432
M v[104:107],a[124:127],a[156:159],v[104:107]
T a[84:85],v24,20480
T a[86:87],v24,22528
M v[108:111],a[124:127],a[188:191],0
buffer_load_dwordx4 v0, s[12:15], s85 offen offset:3072 lds
M v[108:111],a[120:123],a[184:187],v[108:111]
SA m0,s28,36864
T a[88:89],v24,24576
T a[90:91],v24,26624
M v[108:111],a[116:119],a[180:183],v[108:111]
SA s85,s38,28672
T a[92:93],v24,28672
T a[94:95],v24,30720
M v[108:111],a[112:115],a[176:179],v[108:111]
buffer_load_dwordx4 v0, s[12:15], s85 offen offset:0 lds
M v[108:111],a[108:111],a[172:175],v[108:111]
SA s85,s38,34816
MF v90,v5,v90
MF v91,v5,v91
M v[108:111],a[104:107],a[168:171],v[108:111]
C v80,v80,v81
C v81,v82,v83
M v[108:111],a[100:103],a[164:167],v[108:111]
buffer_load_dwordx4 v0, s[12:15], s85 offen offset:1024 lds
M v[108:111],a[96:99],a[160:163],v[108:111]
s_waitcnt lgkmcnt(0)
C v82,v88,v89
C v83,v90,v91
M v[112:115],a[64:67],a[128:131],0
SA s85,s38,40960
T a[96:97],v25,0
T a[98:99],v25,2048
M v[112:115],a[68:71],a[132:135],v[112:115]
T a[100:101],v25,4096
T a[102:103],v25,6144
M v[112:115],a[72:75],a[136:139],v[112:115]
buffer_store_dwordx4 v[80:83], v7, s[8:11], s29 offen offset:1024 sc1
M v[112:115],a[76:79],a[140:143],v[112:115]
s_nop 0
T a[104:105],v25,8192
T a[106:107],v25,10240
M v[112:115],a[80:83],a[144:147],v[112:115]
T a[108:109],v25,12288
T a[110:111],v25,14336
M v[112:115],a[84:87],a[148:151],v[112:115]
buffer_load_dwordx4 v0, s[12:15], s85 offen offset:2048 lds
M v[112:115],a[88:91],a[152:155],v[112:115]
SA s85,s38,47104
T a[112:113],v25,16384
T a[114:115],v25,18432
M v[112:115],a[92:95],a[156:159],v[112:115]
T a[116:117],v25,20480
T a[118:119],v25,22528
M v[116:119],a[92:95],a[188:191],0
buffer_load_dwordx4 v0, s[12:15], s85 offen offset:3072 lds
M v[116:119],a[88:91],a[184:187],v[116:119]
SA s38,s38,128
T a[120:121],v25,24576
T a[122:123],v25,26624
M v[116:119],a[84:87],a[180:183],v[116:119]
SA m0,s28,98304
T a[124:125],v25,28672
T a[126:127],v25,30720
M v[116:119],a[80:83],a[176:179],v[116:119]
SA s85,s38,0
buffer_load_dwordx4 v0, s[12:15], s85 offen offset:0 lds
M v[116:119],a[76:79],a[172:175],v[116:119]
SA s85,s38,6144
MF v84,v6,v84
MF v85,v6,v85
M v[116:119],a[72:75],a[168:171],v[116:119]
buffer_load_dwordx4 v0, s[12:15], s85 offen offset:1024 lds
M v[116:119],a[68:71],a[164:167],v[116:119]
s_waitcnt vmcnt(21) lgkmcnt(0)
MF v86,v6,v86
MF v87,v6,v87
M v[116:119],a[64:67],a[160:163],v[116:119]
s_barrier
M v[120:123],a[96:99],a[128:131],0
SA s85,s38,12288
T a[64:65],v18,0
T a[66:67],v18,2048
M v[120:123],a[100:103],a[132:135],v[120:123]
T a[68:69],v18,4096
T a[70:71],v18,6144
M v[120:123],a[104:107],a[136:139],v[120:123]
buffer_load_dwordx4 v0, s[12:15], s85 offen offset:2048 lds
M v[120:123],a[108:111],a[140:143],v[120:123]
SA s85,s38,18432
T a[72:73],v18,8192
T a[74:75],v18,10240
M v[120:123],a[112:115],a[144:147],v[120:123]
T a[76:77],v18,12288
T a[78:79],v18,14336
M v[120:123],a[116:119],a[148:151],v[120:123]
buffer_load_dwordx4 v0, s[12:15], s85 offen offset:3072 lds
M v[120:123],a[120:123],a[152:155],v[120:123]
s_nop 0
T a[80:81],v18,16384
T a[82:83],v18,18432
M v[120:123],a[124:127],a[156:159],v[120:123]
T a[84:85],v18,20480
T a[86:87],v18,22528
M v[124:127],a[124:127],a[188:191],0
MF v92,v6,v92
MF v93,v6,v93
M v[124:127],a[120:123],a[184:187],v[124:127]
T a[88:89],v18,24576
T a[90:91],v18,26624
M v[124:127],a[116:119],a[180:183],v[124:127]
T a[92:93],v18,28672
T a[94:95],v18,30720
M v[124:127],a[112:115],a[176:179],v[124:127]
MF v94,v6,v94
MF v95,v6,v95
M v[124:127],a[108:111],a[172:175],v[124:127]
C v84,v84,v85
C v85,v86,v87
M v[124:127],a[104:107],a[168:171],v[124:127]
C v86,v92,v93
C v87,v94,v95
M v[124:127],a[100:103],a[164:167],v[124:127]
s_waitcnt lgkmcnt(0)
buffer_store_dwordx4 v[84:87], v7, s[8:11], s30 offen offset:1024 sc1
M v[124:127],a[96:99],a[160:163],v[124:127]
SA s29,s33,2048
SA s30,s33,16384
MF v96,v5,v96
MF v97,v5,v97
MF v98,v5,v98
MF v99,v5,v99
MF v104,v5,v104
MF v105,v5,v105
MF v106,v5,v106
MF v107,v5,v107
C v96,v96,v97
C v97,v98,v99
C v98,v104,v105
C v99,v106,v107
buffer_store_dwordx4 v[96:99], v7, s[8:11], s29 offen offset:0 sc1
MF v100,v6,v100
MF v101,v6,v101
MF v102,v6,v102
MF v103,v6,v103
MF v108,v6,v108
MF v109,v6,v109
MF v110,v6,v110
MF v111,v6,v111
C v100,v100,v101
C v101,v102,v103
C v102,v108,v109
C v103,v110,v111
buffer_store_dwordx4 v[100:103], v7, s[8:11], s30 offen offset:0 sc1
M v[64:67],a[64:67],a[128:131],0
s_nop 0
T a[96:97],v19,0
T a[98:99],v19,2048
M v[64:67],a[68:71],a[132:135],v[64:67]
SA m0,s28,102400
T a[100:101],v19,4096
T a[102:103],v19,6144
M v[64:67],a[72:75],a[136:139],v[64:67]
SA s85,s38,28672
buffer_load_dwordx4 v0, s[12:15], s85 offen offset:0 lds
M v[64:67],a[76:79],a[140:143],v[64:67]
SA s85,s38,34816
T a[104:105],v19,8192
T a[106:107],v19,10240
M v[64:67],a[80:83],a[144:147],v[64:67]
T a[108:109],v19,12288
T a[110:111],v19,14336
M v[64:67],a[84:87],a[148:151],v[64:67]
buffer_load_dwordx4 v0, s[12:15], s85 offen offset:1024 lds
M v[64:67],a[88:91],a[152:155],v[64:67]
s_nop 0
T a[112:113],v19,16384
T a[114:115],v19,18432
M v[64:67],a[92:95],a[156:159],v[64:67]
SA s85,s38,40960
T a[116:117],v19,20480
T a[118:119],v19,22528
M v[68:71],a[92:95],a[188:191],0
buffer_load_dwordx4 v0, s[12:15], s85 offen offset:2048 lds
M v[68:71],a[88:91],a[184:187],v[68:71]
s_nop 0
T a[120:121],v19,24576
T a[122:123],v19,26624
M v[68:71],a[84:87],a[180:183],v[68:71]
T a[124:125],v19,28672
T a[126:127],v19,30720
M v[68:71],a[80:83],a[176:179],v[68:71]
SA s85,s38,47104
MF v112,v5,v112
MF v113,v5,v113
M v[68:71],a[76:79],a[172:175],v[68:71]
buffer_load_dwordx4 v0, s[12:15], s85 offen offset:3072 lds
M v[68:71],a[72:75],a[168:171],v[68:71]
SA s38,s38,128
MF v114,v5,v114
MF v115,v5,v115
M v[68:71],a[68:71],a[164:167],v[68:71]
SA m0,s28,65536
MF v120,v5,v120
MF v121,v5,v121
M v[68:71],a[64:67],a[160:163],v[68:71]
s_waitcnt lgkmcnt(0)
MF v122,v5,v122
MF v123,v5,v123
M v[72:75],a[96:99],a[128:131],0
SA s85,s38,0
T a[64:65],v20,0
T a[66:67],v20,2048
M v[72:75],a[100:103],a[132:135],v[72:75]
T a[68:69],v20,4096
T a[70:71],v20,6144
M v[72:75],a[104:107],a[136:139],v[72:75]
buffer_load_dwordx4 v0, s[12:15], s85 offen offset:0 lds
M v[72:75],a[108:111],a[140:143],v[72:75]
SA s85,s38,6144
T a[72:73],v20,8192
T a[74:75],v20,10240
M v[72:75],a[112:115],a[144:147],v[72:75]
T a[76:77],v20,12288
T a[78:79],v20,14336
M v[72:75],a[116:119],a[148:151],v[72:75]
buffer_load_dwordx4 v0, s[12:15], s85 offen offset:1024 lds
M v[72:75],a[120:123],a[152:155],v[72:75]
SA s85,s38,12288
T a[80:81],v20,16384
T a[82:83],v20,18432
M v[72:75],a[124:127],a[156:159],v[72:75]
T a[84:85],v20,20480
T a[86:87],v20,22528
M v[76:79],a[124:127],a[188:191],0
buffer_load_dwordx4 v0, s[12:15], s85 offen offset:2048 lds
M v[76:79],a[120:123],a[184:187],v[76:79]
SA s85,s38,18432
T a[88:89],v20,24576
T a[90:91],v20,26624
M v[76:79],a[116:119],a[180:183],v[76:79]
T a[92:93],v20,28672
T a[94:95],v20,30720
M v[76:79],a[112:115],a[176:179],v[76:79]
buffer_load_dwordx4 v0, s[12:15], s85 offen offset:3072 lds
M v[76:79],a[108:111],a[172:175],v[76:79]
SA m0,s28,69632
C v112,v112,v113
C v113,v114,v115
M v[76:79],a[104:107],a[168:171],v[76:79]
SA s85,s38,28672
C v114,v120,v121
C v115,v122,v123
M v[76:79],a[100:103],a[164:167],v[76:79]
buffer_store_dwordx4 v[112:115], v7, s[8:11], s29 offen offset:1024 sc1
M v[76:79],a[96:99],a[160:163],v[76:79]
s_waitcnt lgkmcnt(0)
MF v116,v6,v116
MF v117,v6,v117
M v[80:83],a[64:67],a[128:131],0
T a[96:97],v21,0
T a[98:99],v21,2048
M v[80:83],a[68:71],a[132:135],v[80:83]
T a[100:101],v21,4096
T a[102:103],v21,6144
M v[80:83],a[72:75],a[136:139],v[80:83]
buffer_load_dwordx4 v0, s[12:15], s85 offen offset:0 lds
M v[80:83],a[76:79],a[140:143],v[80:83]
SA s85,s38,34816
T a[104:105],v21,8192
T a[106:107],v21,10240
M v[80:83],a[80:83],a[144:147],v[80:83]
T a[108:109],v21,12288
T a[110:111],v21,14336
M v[80:83],a[84:87],a[148:151],v[80:83]
buffer_load_dwordx4 v0, s[12:15], s85 offen offset:1024 lds
M v[80:83],a[88:91],a[152:155],v[80:83]
SA s85,s38,40960
T a[112:113],v21,16384
T a[114:115],v21,18432
M v[80:83],a[92:95],a[156:159],v[80:83]
T a[116:117],v21,20480
T a[118:119],v21,22528
M v[84:87],a[92:95],a[188:191],0
buffer_load_dwordx4 v0, s[12:15], s85 offen offset:2048 lds
M v[84:87],a[88:91],a[184:187],v[84:87]
SA s85,s38,47104
T a[120:121],v21,24576
T a[122:123],v21,26624
M v[84:87],a[84:87],a[180:183],v[84:87]
T a[124:125],v21,28672
T a[126:127],v21,30720
M v[84:87],a[80:83],a[176:179],v[84:87]
buffer_load_dwordx4 v0, s[12:15], s85 offen offset:3072 lds
M v[84:87],a[76:79],a[172:175],v[84:87]
MF v118,v6,v118
MF v119,v6,v119
M v[84:87],a[72:75],a[168:171],v[84:87]
SA s38,s38,128
MF v124,v6,v124
MF v125,v6,v125
M v[84:87],a[68:71],a[164:167],v[84:87]
s_waitcnt vmcnt(29) lgkmcnt(0)
MF v126,v6,v126
MF v127,v6,v127
M v[84:87],a[64:67],a[160:163],v[84:87]
s_barrier
M v[88:91],a[96:99],a[128:131],0
s_nop 0
T a[64:65],v40,0
T a[66:67],v40,2048
M v[88:91],a[100:103],a[132:135],v[88:91]
T a[68:69],v40,4096
T a[70:71],v40,6144
M v[88:91],a[104:107],a[136:139],v[88:91]
C v116,v116,v117
C v117,v118,v119
M v[88:91],a[108:111],a[140:143],v[88:91]
T a[72:73],v40,8192
T a[74:75],v40,10240
M v[88:91],a[112:115],a[144:147],v[88:91]
T a[76:77],v40,12288
T a[78:79],v40,14336
M v[88:91],a[116:119],a[148:151],v[88:91]
C v118,v124,v125
C v119,v126,v127
M v[88:91],a[120:123],a[152:155],v[88:91]
T a[80:81],v40,16384
T a[82:83],v40,18432
M v[88:91],a[124:127],a[156:159],v[88:91]
T a[84:85],v40,20480
T a[86:87],v40,22528
M v[92:95],a[124:127],a[188:191],0
buffer_store_dwordx4 v[116:119], v7, s[8:11], s30 offen offset:1024 sc1
M v[92:95],a[120:123],a[184:187],v[92:95]
SA s29,s33,4096
T a[88:89],v40,24576
T a[90:91],v40,26624
M v[92:95],a[116:119],a[180:183],v[92:95]
SA s30,s33,18432
T a[92:93],v40,28672
T a[94:95],v40,30720
M v[92:95],a[112:115],a[176:179],v[92:95]
MF v64,v5,v64
MF v65,v5,v65
M v[92:95],a[108:111],a[172:175],v[92:95]
MF v66,v5,v66
MF v67,v5,v67
M v[92:95],a[104:107],a[168:171],v[92:95]
MF v72,v5,v72
MF v73,v5,v73
M v[92:95],a[100:103],a[164:167],v[92:95]
s_waitcnt lgkmcnt(0)
MF v74,v5,v74
MF v75,v5,v75
M v[92:95],a[96:99],a[160:163],v[92:95]
C v64,v64,v65
C v65,v66,v67
C v66,v72,v73
C v67,v74,v75
buffer_store_dwordx4 v[64:67], v7, s[8:11], s29 offen offset:0 sc1
MF v68,v6,v68
MF v69,v6,v69
MF v70,v6,v70
MF v71,v6,v71
MF v76,v6,v76
MF v77,v6,v77
MF v78,v6,v78
MF v79,v6,v79
C v68,v68,v69
C v69,v70,v71
C v70,v76,v77
C v71,v78,v79
buffer_store_dwordx4 v[68:71], v7, s[8:11], s30 offen offset:0 sc1
M v[96:99],a[64:67],a[128:131],0
s_nop 0
T a[96:97],v41,0
T a[98:99],v41,2048
M v[96:99],a[68:71],a[132:135],v[96:99]
T a[100:101],v41,4096
T a[102:103],v41,6144
M v[96:99],a[72:75],a[136:139],v[96:99]
MF v80,v5,v80
MF v81,v5,v81
M v[96:99],a[76:79],a[140:143],v[96:99]
T a[104:105],v41,8192
T a[106:107],v41,10240
M v[96:99],a[80:83],a[144:147],v[96:99]
T a[108:109],v41,12288
T a[110:111],v41,14336
M v[96:99],a[84:87],a[148:151],v[96:99]
MF v82,v5,v82
MF v83,v5,v83
M v[96:99],a[88:91],a[152:155],v[96:99]
T a[112:113],v41,16384
T a[114:115],v41,18432
M v[96:99],a[92:95],a[156:159],v[96:99]
T a[116:117],v41,20480
T a[118:119],v41,22528
M v[100:103],a[92:95],a[188:191],0
MF v88,v5,v88
MF v89,v5,v89
M v[100:103],a[88:91],a[184:187],v[100:103]
T a[120:121],v41,24576
T a[122:123],v41,26624
M v[100:103],a[84:87],a[180:183],v[100:103]
T a[124:125],v41,28672
T a[126:127],v41,30720
M v[100:103],a[80:83],a[176:179],v[100:103]
MF v90,v5,v90
MF v91,v5,v91
M v[100:103],a[76:79],a[172:175],v[100:103]
C v80,v80,v81
C v81,v82,v83
M v[100:103],a[72:75],a[168:171],v[100:103]
C v82,v88,v89
C v83,v90,v91
M v[100:103],a[68:71],a[164:167],v[100:103]
buffer_store_dwordx4 v[80:83], v7, s[8:11], s29 offen offset:1024 sc1
M v[100:103],a[64:67],a[160:163],v[100:103]
s_waitcnt lgkmcnt(0)
MF v84,v6,v84
MF v85,v6,v85
M v[104:107],a[96:99],a[128:131],0
T a[64:65],v42,0
T a[66:67],v42,2048
M v[104:107],a[100:103],a[132:135],v[104:107]
T a[68:69],v42,4096
T a[70:71],v42,6144
M v[104:107],a[104:107],a[136:139],v[104:107]
MF v86,v6,v86
MF v87,v6,v87
M v[104:107],a[108:111],a[140:143],v[104:107]
T a[72:73],v42,8192
T a[74:75],v42,10240
M v[104:107],a[112:115],a[144:147],v[104:107]
T a[76:77],v42,12288
T a[78:79],v42,14336
M v[104:107],a[116:119],a[148:151],v[104:107]
MF v92,v6,v92
MF v93,v6,v93
M v[104:107],a[120:123],a[152:155],v[104:107]
T a[80:81],v42,16384
T a[82:83],v42,18432
M v[104:107],a[124:127],a[156:159],v[104:107]
T a[84:85],v42,20480
T a[86:87],v42,22528
M v[108:111],a[124:127],a[188:191],0
MF v94,v6,v94
MF v95,v6,v95
M v[108:111],a[120:123],a[184:187],v[108:111]
T a[88:89],v42,24576
T a[90:91],v42,26624
M v[108:111],a[116:119],a[180:183],v[108:111]
T a[92:93],v42,28672
T a[94:95],v42,30720
M v[108:111],a[112:115],a[176:179],v[108:111]
C v84,v84,v85
C v85,v86,v87
M v[108:111],a[108:111],a[172:175],v[108:111]
C v86,v92,v93
C v87,v94,v95
M v[108:111],a[104:107],a[168:171],v[108:111]
buffer_store_dwordx4 v[84:87], v7, s[8:11], s30 offen offset:1024 sc1
M v[108:111],a[100:103],a[164:167],v[108:111]
SA s29,s33,6144
M v[108:111],a[96:99],a[160:163],v[108:111]
s_waitcnt lgkmcnt(0)
M v[112:115],a[64:67],a[128:131],0
SA s30,s33,20480
T a[96:97],v43,0
T a[98:99],v43,2048
M v[112:115],a[68:71],a[132:135],v[112:115]
T a[100:101],v43,4096
T a[102:103],v43,6144
M v[112:115],a[72:75],a[136:139],v[112:115]
MF v96,v5,v96
MF v97,v5,v97
M v[112:115],a[76:79],a[140:143],v[112:115]
T a[104:105],v43,8192
T a[106:107],v43,10240
M v[112:115],a[80:83],a[144:147],v[112:115]
T a[108:109],v43,12288
T a[110:111],v43,14336
M v[112:115],a[84:87],a[148:151],v[112:115]
MF v98,v5,v98
MF v99,v5,v99
M v[112:115],a[88:91],a[152:155],v[112:115]
T a[112:113],v43,16384
T a[114:115],v43,18432
M v[112:115],a[92:95],a[156:159],v[112:115]
T a[116:117],v43,20480
T a[118:119],v43,22528
M v[116:119],a[92:95],a[188:191],0
MF v104,v5,v104
MF v105,v5,v105
M v[116:119],a[88:91],a[184:187],v[116:119]
T a[120:121],v43,24576
T a[122:123],v43,26624
M v[116:119],a[84:87],a[180:183],v[116:119]
T a[124:125],v43,28672
T a[126:127],v43,30720
M v[116:119],a[80:83],a[176:179],v[116:119]
MF v106,v5,v106
MF v107,v5,v107
M v[116:119],a[76:79],a[172:175],v[116:119]
C v96,v96,v97
C v97,v98,v99
M v[116:119],a[72:75],a[168:171],v[116:119]
C v98,v104,v105
C v99,v106,v107
M v[116:119],a[68:71],a[164:167],v[116:119]
s_waitcnt vmcnt(25) lgkmcnt(0)
buffer_store_dwordx4 v[96:99], v7, s[8:11], s29 offen offset:0 sc1
M v[116:119],a[64:67],a[160:163],v[116:119]
s_barrier
M v[120:123],a[96:99],a[128:131],0
s_nop 0
T a[64:65],v18,32768
T a[66:67],v18,34816
M v[120:123],a[100:103],a[132:135],v[120:123]
T a[68:69],v18,36864
T a[70:71],v18,38912
M v[120:123],a[104:107],a[136:139],v[120:123]
MF v100,v6,v100
MF v101,v6,v101
M v[120:123],a[108:111],a[140:143],v[120:123]
T a[72:73],v18,40960
T a[74:75],v18,43008
M v[120:123],a[112:115],a[144:147],v[120:123]
T a[76:77],v18,45056
T a[78:79],v18,47104
M v[120:123],a[116:119],a[148:151],v[120:123]
MF v102,v6,v102
MF v103,v6,v103
M v[120:123],a[120:123],a[152:155],v[120:123]
T a[80:81],v18,49152
T a[82:83],v18,51200
M v[120:123],a[124:127],a[156:159],v[120:123]
T a[84:85],v18,53248
T a[86:87],v18,55296
M v[124:127],a[124:127],a[188:191],0
MF v108,v6,v108
MF v109,v6,v109
M v[124:127],a[120:123],a[184:187],v[124:127]
T a[88:89],v18,57344
T a[90:91],v18,59392
M v[124:127],a[116:119],a[180:183],v[124:127]
T a[92:93],v18,61440
T a[94:95],v18,63488
M v[124:127],a[112:115],a[176:179],v[124:127]
MF v110,v6,v110
MF v111,v6,v111
M v[124:127],a[108:111],a[172:175],v[124:127]
C v100,v100,v101
C v101,v102,v103
M v[124:127],a[104:107],a[168:171],v[124:127]
C v102,v108,v109
C v103,v110,v111
M v[124:127],a[100:103],a[164:167],v[124:127]
s_waitcnt lgkmcnt(0)
buffer_store_dwordx4 v[100:103], v7, s[8:11], s30 offen offset:0 sc1
M v[124:127],a[96:99],a[160:163],v[124:127]
M v[64:67],a[64:67],a[128:131],0
s_nop 0
T a[96:97],v19,32768
T a[98:99],v19,34816
M v[64:67],a[68:71],a[132:135],v[64:67]
T a[100:101],v19,36864
T a[102:103],v19,38912
M v[64:67],a[72:75],a[136:139],v[64:67]
v_lshrrev_b32 v32, 4, v7
MF v112,v5,v112
M v[64:67],a[76:79],a[140:143],v[64:67]
s_lshr_b32 s74, s41, 3
T a[104:105],v19,40960
T a[106:107],v19,43008
M v[64:67],a[80:83],a[144:147],v[64:67]
s_lshl_b32 s64, s42, 1
T a[108:109],v19,45056
T a[110:111],v19,47104
M v[64:67],a[84:87],a[148:151],v[64:67]
SA s46,s64,s74
MF v113,v5,v113
MF v114,v5,v114
M v[64:67],a[88:91],a[152:155],v[64:67]
s_mul_i32 s46, s46, 4352
T a[112:113],v19,49152
T a[114:115],v19,51200
M v[64:67],a[92:95],a[156:159],v[64:67]
s_and_b32 s72, s41, 7
T a[116:117],v19,53248
T a[118:119],v19,55296
M v[68:71],a[92:95],a[188:191],0
s_lshl_b32 s65, s72, 7
MF v115,v5,v115
MF v120,v5,v120
M v[68:71],a[88:91],a[184:187],v[68:71]
SA s46,s46,s65
T a[120:121],v19,57344
T a[122:123],v19,59392
M v[68:71],a[84:87],a[180:183],v[68:71]
SA s46,s46,104992768
T a[124:125],v19,61440
T a[126:127],v19,63488
M v[68:71],a[80:83],a[176:179],v[68:71]
v_and_b32 v33, 31, v32
MF v121,v5,v121
M v[68:71],a[76:79],a[172:175],v[68:71]
MF v122,v5,v122
MF v123,v5,v123
M v[68:71],a[72:75],a[168:171],v[68:71]
C v112,v112,v113
C v113,v114,v115
M v[68:71],a[68:71],a[164:167],v[68:71]
C v114,v120,v121
C v115,v122,v123
M v[68:71],a[64:67],a[160:163],v[68:71]
s_waitcnt lgkmcnt(0)
buffer_store_dwordx4 v[112:115], v7, s[8:11], s29 offen offset:1024 sc1
M v[72:75],a[96:99],a[128:131],0
s_nop 0
T a[64:65],v20,32768
T a[66:67],v20,34816
M v[72:75],a[100:103],a[132:135],v[72:75]
T a[68:69],v20,36864
T a[70:71],v20,38912
M v[72:75],a[104:107],a[136:139],v[72:75]
MF v116,v6,v116
MF v117,v6,v117
M v[72:75],a[108:111],a[140:143],v[72:75]
T a[72:73],v20,40960
T a[74:75],v20,43008
M v[72:75],a[112:115],a[144:147],v[72:75]
T a[76:77],v20,45056
T a[78:79],v20,47104
M v[72:75],a[116:119],a[148:151],v[72:75]
MF v118,v6,v118
MF v119,v6,v119
M v[72:75],a[120:123],a[152:155],v[72:75]
T a[80:81],v20,49152
T a[82:83],v20,51200
M v[72:75],a[124:127],a[156:159],v[72:75]
T a[84:85],v20,53248
T a[86:87],v20,55296
M v[76:79],a[124:127],a[188:191],0
MF v124,v6,v124
MF v125,v6,v125
M v[76:79],a[120:123],a[184:187],v[76:79]
T a[88:89],v20,57344
T a[90:91],v20,59392
M v[76:79],a[116:119],a[180:183],v[76:79]
T a[92:93],v20,61440
T a[94:95],v20,63488
M v[76:79],a[112:115],a[176:179],v[76:79]
MF v126,v6,v126
MF v127,v6,v127
M v[76:79],a[108:111],a[172:175],v[76:79]
C v116,v116,v117
C v117,v118,v119
M v[76:79],a[104:107],a[168:171],v[76:79]
C v118,v124,v125
C v119,v126,v127
M v[76:79],a[100:103],a[164:167],v[76:79]
buffer_store_dwordx4 v[116:119], v7, s[8:11], s30 offen offset:1024 sc1
M v[76:79],a[96:99],a[160:163],v[76:79]
s_waitcnt lgkmcnt(0)
v_lshlrev_b32 v33, 2, v33
M v[80:83],a[64:67],a[128:131],0
SA s29,s33,8192
T a[96:97],v21,32768
T a[98:99],v21,34816
M v[80:83],a[68:71],a[132:135],v[80:83]
SA s30,s33,22528
T a[100:101],v21,36864
T a[102:103],v21,38912
M v[80:83],a[72:75],a[136:139],v[80:83]
s_lshl_b32 s65, s41, 7
MF v64,v5,v64
MF v65,v5,v65
M v[80:83],a[76:79],a[140:143],v[80:83]
SA s65,s65,104890368
T a[104:105],v21,40960
T a[106:107],v21,43008
M v[80:83],a[80:83],a[144:147],v[80:83]
T a[108:109],v21,45056
T a[110:111],v21,47104
M v[80:83],a[84:87],a[148:151],v[80:83]
buffer_load_dword v31, v33, s[8:11], s65 offen sc1
M v[80:83],a[88:91],a[152:155],v[80:83]
s_nop 0
T a[112:113],v21,49152
T a[114:115],v21,51200
M v[80:83],a[92:95],a[156:159],v[80:83]
T a[116:117],v21,53248
T a[118:119],v21,55296
M v[84:87],a[92:95],a[188:191],0
v_bfe_u32 v34, v32, 4, 1
v_lshlrev_b32 v34, 1, v34
M v[84:87],a[88:91],a[184:187],v[84:87]
T a[120:121],v21,57344
T a[122:123],v21,59392
M v[84:87],a[84:87],a[180:183],v[84:87]
T a[124:125],v21,61440
T a[126:127],v21,63488
M v[84:87],a[80:83],a[176:179],v[84:87]
v_lshrrev_b32 v35, 5, v32
v_add_u32 v34, v34, v35
M v[84:87],a[76:79],a[172:175],v[84:87]
s_mov_b32 s52, s96
MF v66,v5,v66
MF v67,v5,v67
M v[84:87],a[72:75],a[168:171],v[84:87]
s_and_b32 s53, s97, 0xffff
MF v72,v5,v72
MF v73,v5,v73
M v[84:87],a[68:71],a[164:167],v[84:87]
s_waitcnt vmcnt(19) lgkmcnt(0)
MF v74,v5,v74
MF v75,v5,v75
M v[84:87],a[64:67],a[160:163],v[84:87]
s_barrier
M v[88:91],a[96:99],a[128:131],0
s_mov_b32 s54, 1835008
T a[64:65],v22,32768
T a[66:67],v22,34816
M v[88:91],a[100:103],a[132:135],v[88:91]
s_mov_b32 s55, 0x20000
T a[68:69],v22,36864
T a[70:71],v22,38912
M v[88:91],a[104:107],a[136:139],v[88:91]
s_mul_i32 s77, s42, 1835008
C v64,v64,v65
C v65,v66,v67
M v[88:91],a[108:111],a[140:143],v[88:91]
s_mul_i32 s78, s72, 14336
T a[72:73],v22,40960
T a[74:75],v22,43008
M v[88:91],a[112:115],a[144:147],v[88:91]
SA s77,s77,s78
T a[76:77],v22,45056
T a[78:79],v22,47104
M v[88:91],a[116:119],a[148:151],v[88:91]
SA s77,s77,67108864
C v66,v72,v73
C v67,v74,v75
M v[88:91],a[120:123],a[152:155],v[88:91]
s_lshl_b32 s79, s74, 1
T a[80:81],v22,49152
T a[82:83],v22,51200
M v[88:91],a[124:127],a[156:159],v[88:91]
SA s79,s79,s20
T a[84:85],v22,53248
T a[86:87],v22,55296
M v[92:95],a[124:127],a[188:191],0
s_lshl_b32 s71, s74, 1
buffer_store_dwordx4 v[64:67], v7, s[8:11], s29 offen offset:0 sc1
M v[92:95],a[120:123],a[184:187],v[92:95]
SA s71,s71,1
T a[88:89],v22,57344
T a[90:91],v22,59392
M v[92:95],a[116:119],a[180:183],v[92:95]
s_sub_u32 s71, s71, s20
T a[92:93],v22,61440
T a[94:95],v22,63488
M v[92:95],a[112:115],a[176:179],v[92:95]
s_and_b32 s71, s71, 536870912
MF v68,v6,v68
MF v69,v6,v69
M v[92:95],a[108:111],a[172:175],v[92:95]
s_sub_u32 s64, 15, s64
MF v70,v6,v70
MF v71,v6,v71
M v[92:95],a[104:107],a[168:171],v[92:95]
s_sub_u32 s78, s64, 1
MF v76,v6,v76
MF v77,v6,v77
M v[92:95],a[100:103],a[164:167],v[92:95]
s_waitcnt lgkmcnt(0)
MF v78,v6,v78
MF v79,v6,v79
M v[92:95],a[96:99],a[160:163],v[92:95]
s_mul_i32 s78, s78, 1835008
SA s78,s78,s77
s_lshl_b32 s65, s79, 10
SA s78,s78,s65
SA s78,s78,s71
s_lshl_b32 s79, s79, 6
s_or_b32 s79, s79, s71
s_mul_i32 s67, s74, -2
s_lshl_b32 s74, s74, 3
SA s74,s74,s20
s_lshl_b32 s75, s74, 6
SA s76,s75,256
SA s67,s67,3
s_sub_u32 s67, s67, s20
s_and_b32 s67, s67, 536870912
s_or_b32 s76, s76, s67
v_or_b32 v27, s67, v7
v_add_u32 v27, 4096, v27
s_lshl_b32 s65, s74, 10
SA s77,s77,s65
s_lshl_b32 s64, s64, 7
s_lshr_b32 s73, s72, 1
s_sub_u32 s65, 7, s73
s_bitcmp1_b32 s72, 0
s_cselect_b32 s73, s65, s73
s_lshl_b32 s73, s73, 4
s_lshl_b32 s65, s42, 7
SA s73,s73,s65
v_and_b32 v37, 15, v32
v_add_u32 v37, s73, v37
v_add_u32 v29, s64, v37
s_mov_b32 s64, 104857664
v_mul_u32_u24 v38, 896, v37
v_lshl_add_u32 v38, v34, 4, v38
v_lshrrev_b32 v35, 4, v37
v_lshlrev_b32 v35, 5, v35
v_and_b32 v36, 15, v37
v_add_lshl_u32 v35, v35, v36, 2
buffer_load_dword v39, v35, s[8:11], s64 offen sc1
C v68,v68,v69
C v69,v70,v71
C v70,v76,v77
C v71,v78,v79
buffer_store_dwordx4 v[68:71], v7, s[8:11], s30 offen offset:0 sc1
buffer_load_dwordx4 v[48:51], v38, s[56:59], s75 offen
buffer_load_dwordx4 v[52:55], v38, s[56:59], s76 offen
v_mul_u32_u24 v28, 896, v29
v_lshl_add_u32 v28, v34, 4, v28
v_lshrrev_b32 v35, 4, v29
v_lshlrev_b32 v35, 5, v35
v_and_b32 v36, 15, v29
v_add_lshl_u32 v35, v35, v36, 2
buffer_load_dword v26, v35, s[8:11], s64 offen sc1
buffer_load_dwordx4 v[44:47], v28, s[56:59], s79 offen
M v[96:99],a[64:67],a[128:131],0
s_nop 0
T a[96:97],v23,32768
T a[98:99],v23,34816
M v[96:99],a[68:71],a[132:135],v[96:99]
T a[100:101],v23,36864
T a[102:103],v23,38912
M v[96:99],a[72:75],a[136:139],v[96:99]
MF v80,v5,v80
MF v81,v5,v81
M v[96:99],a[76:79],a[140:143],v[96:99]
T a[104:105],v23,40960
T a[106:107],v23,43008
M v[96:99],a[80:83],a[144:147],v[96:99]
T a[108:109],v23,45056
T a[110:111],v23,47104
M v[96:99],a[84:87],a[148:151],v[96:99]
MF v82,v5,v82
MF v83,v5,v83
M v[96:99],a[88:91],a[152:155],v[96:99]
T a[112:113],v23,49152
T a[114:115],v23,51200
M v[96:99],a[92:95],a[156:159],v[96:99]
T a[116:117],v23,53248
T a[118:119],v23,55296
M v[100:103],a[92:95],a[188:191],0
MF v88,v5,v88
MF v89,v5,v89
M v[100:103],a[88:91],a[184:187],v[100:103]
T a[120:121],v23,57344
T a[122:123],v23,59392
M v[100:103],a[84:87],a[180:183],v[100:103]
T a[124:125],v23,61440
T a[126:127],v23,63488
M v[100:103],a[80:83],a[176:179],v[100:103]
MF v90,v5,v90
MF v91,v5,v91
M v[100:103],a[76:79],a[172:175],v[100:103]
C v80,v80,v81
C v81,v82,v83
M v[100:103],a[72:75],a[168:171],v[100:103]
C v82,v88,v89
C v83,v90,v91
M v[100:103],a[68:71],a[164:167],v[100:103]
buffer_store_dwordx4 v[80:83], v7, s[8:11], s29 offen offset:1024 sc1
M v[100:103],a[64:67],a[160:163],v[100:103]
s_waitcnt lgkmcnt(0)
MF v84,v6,v84
MF v85,v6,v85
M v[104:107],a[96:99],a[128:131],0
T a[64:65],v24,32768
T a[66:67],v24,34816
M v[104:107],a[100:103],a[132:135],v[104:107]
T a[68:69],v24,36864
T a[70:71],v24,38912
M v[104:107],a[104:107],a[136:139],v[104:107]
MF v86,v6,v86
MF v87,v6,v87
M v[104:107],a[108:111],a[140:143],v[104:107]
T a[72:73],v24,40960
T a[74:75],v24,43008
M v[104:107],a[112:115],a[144:147],v[104:107]
T a[76:77],v24,45056
T a[78:79],v24,47104
M v[104:107],a[116:119],a[148:151],v[104:107]
MF v92,v6,v92
MF v93,v6,v93
M v[104:107],a[120:123],a[152:155],v[104:107]
T a[80:81],v24,49152
T a[82:83],v24,51200
M v[104:107],a[124:127],a[156:159],v[104:107]
T a[84:85],v24,53248
T a[86:87],v24,55296
M v[108:111],a[124:127],a[188:191],0
MF v94,v6,v94
MF v95,v6,v95
M v[108:111],a[120:123],a[184:187],v[108:111]
T a[88:89],v24,57344
T a[90:91],v24,59392
M v[108:111],a[116:119],a[180:183],v[108:111]
T a[92:93],v24,61440
T a[94:95],v24,63488
M v[108:111],a[112:115],a[176:179],v[108:111]
C v84,v84,v85
C v85,v86,v87
M v[108:111],a[108:111],a[172:175],v[108:111]
C v86,v92,v93
C v87,v94,v95
M v[108:111],a[104:107],a[168:171],v[108:111]
buffer_store_dwordx4 v[84:87], v7, s[8:11], s30 offen offset:1024 sc1
M v[108:111],a[100:103],a[164:167],v[108:111]
SA s29,s33,10240
M v[108:111],a[96:99],a[160:163],v[108:111]
s_waitcnt lgkmcnt(0)
M v[112:115],a[64:67],a[128:131],0
SA s30,s33,24576
T a[96:97],v25,32768
T a[98:99],v25,34816
M v[112:115],a[68:71],a[132:135],v[112:115]
T a[100:101],v25,36864
T a[102:103],v25,38912
M v[112:115],a[72:75],a[136:139],v[112:115]
MF v96,v5,v96
MF v97,v5,v97
M v[112:115],a[76:79],a[140:143],v[112:115]
T a[104:105],v25,40960
T a[106:107],v25,43008
M v[112:115],a[80:83],a[144:147],v[112:115]
T a[108:109],v25,45056
T a[110:111],v25,47104
M v[112:115],a[84:87],a[148:151],v[112:115]
MF v98,v5,v98
MF v99,v5,v99
M v[112:115],a[88:91],a[152:155],v[112:115]
T a[112:113],v25,49152
T a[114:115],v25,51200
M v[112:115],a[92:95],a[156:159],v[112:115]
T a[116:117],v25,53248
T a[118:119],v25,55296
M v[116:119],a[92:95],a[188:191],0
s_mov_b32 s84, s45
MF v104,v5,v104
MF v105,v5,v105
M v[116:119],a[88:91],a[184:187],v[116:119]
T a[120:121],v25,57344
T a[122:123],v25,59392
M v[116:119],a[84:87],a[180:183],v[116:119]
T a[124:125],v25,61440
T a[126:127],v25,63488
M v[116:119],a[80:83],a[176:179],v[116:119]
MF v106,v5,v106
MF v107,v5,v107
M v[116:119],a[76:79],a[172:175],v[116:119]
C v96,v96,v97
C v97,v98,v99
M v[116:119],a[72:75],a[168:171],v[116:119]
C v98,v104,v105
C v99,v106,v107
M v[116:119],a[68:71],a[164:167],v[116:119]
s_waitcnt vmcnt(19) lgkmcnt(0)
buffer_store_dwordx4 v[96:99], v7, s[8:11], s29 offen offset:0 sc1
M v[116:119],a[64:67],a[160:163],v[116:119]
s_barrier
M v[120:123],a[96:99],a[128:131],0
s_nop 0
T a[64:65],v22,0
T a[66:67],v22,2048
M v[120:123],a[100:103],a[132:135],v[120:123]
T a[68:69],v22,4096
T a[70:71],v22,6144
M v[120:123],a[104:107],a[136:139],v[120:123]
MF v100,v6,v100
MF v101,v6,v101
M v[120:123],a[108:111],a[140:143],v[120:123]
T a[72:73],v22,8192
T a[74:75],v22,10240
M v[120:123],a[112:115],a[144:147],v[120:123]
s_waitcnt vmcnt(11)
T a[76:77],v22,12288
T a[78:79],v22,14336
M v[120:123],a[116:119],a[148:151],v[120:123]
buffer_store_dword v15, v17, s[8:11], s84 offen sc1
M v[120:123],a[120:123],a[152:155],v[120:123]
s_nop 0
T a[80:81],v22,16384
T a[82:83],v22,18432
M v[120:123],a[124:127],a[156:159],v[120:123]
T a[84:85],v22,20480
T a[86:87],v22,22528
M v[124:127],a[124:127],a[188:191],0
MF v102,v6,v102
MF v103,v6,v103
M v[124:127],a[120:123],a[184:187],v[124:127]
T a[88:89],v22,24576
T a[90:91],v22,26624
M v[124:127],a[116:119],a[180:183],v[124:127]
T a[92:93],v22,28672
T a[94:95],v22,30720
M v[124:127],a[112:115],a[176:179],v[124:127]
MF v108,v6,v108
MF v109,v6,v109
M v[124:127],a[108:111],a[172:175],v[124:127]
MF v110,v6,v110
MF v111,v6,v111
M v[124:127],a[104:107],a[168:171],v[124:127]
C v100,v100,v101
C v101,v102,v103
M v[124:127],a[100:103],a[164:167],v[124:127]
s_waitcnt lgkmcnt(0)
C v102,v108,v109
C v103,v110,v111
M v[124:127],a[96:99],a[160:163],v[124:127]
buffer_store_dwordx4 v[100:103], v7, s[8:11], s30 offen offset:0 sc1
M v[64:67],a[64:67],a[128:131],0
s_nop 0
T a[96:97],v23,0
T a[98:99],v23,2048
M v[64:67],a[68:71],a[132:135],v[64:67]
T a[100:101],v23,4096
T a[102:103],v23,6144
M v[64:67],a[72:75],a[136:139],v[64:67]
MF v112,v5,v112
MF v113,v5,v113
M v[64:67],a[76:79],a[140:143],v[64:67]
T a[104:105],v23,8192
T a[106:107],v23,10240
M v[64:67],a[80:83],a[144:147],v[64:67]
T a[108:109],v23,12288
T a[110:111],v23,14336
M v[64:67],a[84:87],a[148:151],v[64:67]
MF v114,v5,v114
MF v115,v5,v115
M v[64:67],a[88:91],a[152:155],v[64:67]
T a[112:113],v23,16384
T a[114:115],v23,18432
M v[64:67],a[92:95],a[156:159],v[64:67]
T a[116:117],v23,20480
T a[118:119],v23,22528
M v[68:71],a[92:95],a[188:191],0
MF v120,v5,v120
MF v121,v5,v121
M v[68:71],a[88:91],a[184:187],v[68:71]
T a[120:121],v23,24576
T a[122:123],v23,26624
M v[68:71],a[84:87],a[180:183],v[68:71]
T a[124:125],v23,28672
T a[126:127],v23,30720
M v[68:71],a[80:83],a[176:179],v[68:71]
MF v122,v5,v122
MF v123,v5,v123
M v[68:71],a[76:79],a[172:175],v[68:71]
C v112,v112,v113
C v113,v114,v115
M v[68:71],a[72:75],a[168:171],v[68:71]
C v114,v120,v121
C v115,v122,v123
M v[68:71],a[68:71],a[164:167],v[68:71]
buffer_store_dwordx4 v[112:115], v7, s[8:11], s29 offen offset:1024 sc1
M v[68:71],a[64:67],a[160:163],v[68:71]
s_waitcnt lgkmcnt(0)
MF v116,v6,v116
MF v117,v6,v117
M v[72:75],a[96:99],a[128:131],0
T a[64:65],v24,0
T a[66:67],v24,2048
M v[72:75],a[100:103],a[132:135],v[72:75]
T a[68:69],v24,4096
T a[70:71],v24,6144
M v[72:75],a[104:107],a[136:139],v[72:75]
MF v118,v6,v118
MF v119,v6,v119
M v[72:75],a[108:111],a[140:143],v[72:75]
T a[72:73],v24,8192
T a[74:75],v24,10240
M v[72:75],a[112:115],a[144:147],v[72:75]
T a[76:77],v24,12288
T a[78:79],v24,14336
M v[72:75],a[116:119],a[148:151],v[72:75]
MF v124,v6,v124
MF v125,v6,v125
M v[72:75],a[120:123],a[152:155],v[72:75]
T a[80:81],v24,16384
T a[82:83],v24,18432
M v[72:75],a[124:127],a[156:159],v[72:75]
T a[84:85],v24,20480
T a[86:87],v24,22528
M v[76:79],a[124:127],a[188:191],0
MF v126,v6,v126
MF v127,v6,v127
M v[76:79],a[120:123],a[184:187],v[76:79]
T a[88:89],v24,24576
T a[90:91],v24,26624
M v[76:79],a[116:119],a[180:183],v[76:79]
T a[92:93],v24,28672
T a[94:95],v24,30720
M v[76:79],a[112:115],a[176:179],v[76:79]
C v116,v116,v117
C v117,v118,v119
M v[76:79],a[108:111],a[172:175],v[76:79]
C v118,v124,v125
C v119,v126,v127
M v[76:79],a[104:107],a[168:171],v[76:79]
buffer_store_dwordx4 v[116:119], v7, s[8:11], s30 offen offset:1024 sc1
M v[76:79],a[100:103],a[164:167],v[76:79]
SA s29,s33,12288
M v[76:79],a[96:99],a[160:163],v[76:79]
s_waitcnt lgkmcnt(0)
M v[80:83],a[64:67],a[128:131],0
SA s30,s33,26624
T a[96:97],v25,0
T a[98:99],v25,2048
M v[80:83],a[68:71],a[132:135],v[80:83]
T a[100:101],v25,4096
T a[102:103],v25,6144
M v[80:83],a[72:75],a[136:139],v[80:83]
MF v64,v5,v64
MF v65,v5,v65
M v[80:83],a[76:79],a[140:143],v[80:83]
T a[104:105],v25,8192
T a[106:107],v25,10240
M v[80:83],a[80:83],a[144:147],v[80:83]
T a[108:109],v25,12288
T a[110:111],v25,14336
M v[80:83],a[84:87],a[148:151],v[80:83]
MF v66,v5,v66
MF v67,v5,v67
M v[80:83],a[88:91],a[152:155],v[80:83]
T a[112:113],v25,16384
T a[114:115],v25,18432
M v[80:83],a[92:95],a[156:159],v[80:83]
T a[116:117],v25,20480
T a[118:119],v25,22528
M v[84:87],a[92:95],a[188:191],0
MF v72,v5,v72
MF v73,v5,v73
M v[84:87],a[88:91],a[184:187],v[84:87]
T a[120:121],v25,24576
T a[122:123],v25,26624
M v[84:87],a[84:87],a[180:183],v[84:87]
T a[124:125],v25,28672
T a[126:127],v25,30720
M v[84:87],a[80:83],a[176:179],v[84:87]
MF v74,v5,v74
MF v75,v5,v75
M v[84:87],a[76:79],a[172:175],v[84:87]
C v64,v64,v65
C v65,v66,v67
M v[84:87],a[72:75],a[168:171],v[84:87]
C v66,v72,v73
C v67,v74,v75
M v[84:87],a[68:71],a[164:167],v[84:87]
buffer_store_dwordx4 v[64:67], v7, s[8:11], s29 offen offset:0 sc1
M v[84:87],a[64:67],a[160:163],v[84:87]
s_waitcnt lgkmcnt(0)
MF v68,v6,v68
MF v69,v6,v69
M v[88:91],a[96:99],a[128:131],0
MF v70,v6,v70
MF v71,v6,v71
M v[88:91],a[100:103],a[132:135],v[88:91]
MF v76,v6,v76
MF v77,v6,v77
M v[88:91],a[104:107],a[136:139],v[88:91]
MF v78,v6,v78
MF v79,v6,v79
M v[88:91],a[108:111],a[140:143],v[88:91]
C v68,v68,v69
C v69,v70,v71
M v[88:91],a[112:115],a[144:147],v[88:91]
C v70,v76,v77
C v71,v78,v79
M v[88:91],a[116:119],a[148:151],v[88:91]
buffer_store_dwordx4 v[68:71], v7, s[8:11], s30 offen offset:0 sc1
M v[88:91],a[120:123],a[152:155],v[88:91]
M v[88:91],a[124:127],a[156:159],v[88:91]
M v[92:95],a[124:127],a[188:191],0
M v[92:95],a[120:123],a[184:187],v[92:95]
M v[92:95],a[116:119],a[180:183],v[92:95]
M v[92:95],a[112:115],a[176:179],v[92:95]
MF v80,v5,v80
MF v81,v5,v81
M v[92:95],a[108:111],a[172:175],v[92:95]
MF v82,v5,v82
MF v83,v5,v83
M v[92:95],a[104:107],a[168:171],v[92:95]
MF v88,v5,v88
MF v89,v5,v89
M v[92:95],a[100:103],a[164:167],v[92:95]
MF v90,v5,v90
MF v91,v5,v91
M v[92:95],a[96:99],a[160:163],v[92:95]
C v80,v80,v81
C v81,v82,v83
C v82,v88,v89
C v83,v90,v91
buffer_store_dwordx4 v[80:83], v7, s[8:11], s29 offen offset:1024 sc1
MF v84,v6,v84
MF v85,v6,v85
MF v86,v6,v86
MF v87,v6,v87
MF v92,v6,v92
MF v93,v6,v93
MF v94,v6,v94
MF v95,v6,v95
C v84,v84,v85
C v85,v86,v87
C v86,v92,v93
C v87,v94,v95
buffer_store_dwordx4 v[84:87], v7, s[8:11], s30 offen offset:1024 sc1
buffer_load_dword v9, v33, s[8:11], s46 offen sc1
s_waitcnt vmcnt(1)
buffer_store_dword v15, v16, s[8:11], s3 offen sc1
L_red1:
s_waitcnt vmcnt(0)
v_cmp_eq_u32 vcc, 1, v9
s_mov_b32 s91, 65536
s_mov_b32 s69, 0xffff
s_and_b32 s70, vcc_lo, s69
s_mov_b32 s68, s70
s_cmp_lg_u32 s70, 0
s_cbranch_scc1 L_rk0
s_call_b64 s[36:37], L_rpoll
L_rk0:
s_ff1_i32_b32 s71, s70
s_bitset0_b32 s70, s71
s_mul_i32 s71, s71, 114688
SA s72,s71,s77
buffer_load_dwordx4 v[128:131], v7, s[8:11], s72 offen sc1
buffer_load_dwordx4 v[132:135], v27, s[8:11], s72 offen sc1
s_cmp_lg_u32 s70, 0
s_cbranch_scc1 L_rk1
s_call_b64 s[36:37], L_rpoll
L_rk1:
s_ff1_i32_b32 s71, s70
s_bitset0_b32 s70, s71
s_mul_i32 s71, s71, 114688
SA s72,s71,s77
buffer_load_dwordx4 v[136:139], v7, s[8:11], s72 offen sc1
buffer_load_dwordx4 v[140:143], v27, s[8:11], s72 offen sc1
s_cmp_lg_u32 s70, 0
s_cbranch_scc1 L_rk2
s_call_b64 s[36:37], L_rpoll
L_rk2:
s_ff1_i32_b32 s71, s70
s_bitset0_b32 s70, s71
s_mul_i32 s71, s71, 114688
SA s72,s71,s77
buffer_load_dwordx4 v[144:147], v7, s[8:11], s72 offen sc1
buffer_load_dwordx4 v[148:151], v27, s[8:11], s72 offen sc1
v_readlane_b32 s92, v31, 0
v_readlane_b32 s94, v31, 1
v_lshlrev_b32 v64, 16, v48
v_and_b32 v65, 0xffff0000, v48
v_lshlrev_b32 v66, 16, v49
v_and_b32 v67, 0xffff0000, v49
v_lshlrev_b32 v68, 16, v50
v_and_b32 v69, 0xffff0000, v50
v_lshlrev_b32 v70, 16, v51
v_and_b32 v71, 0xffff0000, v51
v_lshlrev_b32 v72, 16, v52
v_and_b32 v73, 0xffff0000, v52
v_lshlrev_b32 v74, 16, v53
v_and_b32 v75, 0xffff0000, v53
v_lshlrev_b32 v76, 16, v54
v_and_b32 v77, 0xffff0000, v54
v_lshlrev_b32 v78, 16, v55
v_and_b32 v79, 0xffff0000, v55
v_sub_f32 v30, 1.0, v39
v_cmp_eq_u32 s[80:81], s92, v37
v_cmp_eq_u32 s[82:83], s94, v37
s_nop 0
s_or_b64 vcc, s[80:81], s[82:83]
s_cbranch_vccnz L_moe0
L_moe_ret0:
MF v64,v30,v64
MF v65,v30,v65
MF v66,v30,v66
MF v67,v30,v67
MF v68,v30,v68
MF v69,v30,v69
MF v70,v30,v70
MF v71,v30,v71
MF v72,v30,v72
MF v73,v30,v73
MF v74,v30,v74
MF v75,v30,v75
MF v76,v30,v76
MF v77,v30,v77
MF v78,v30,v78
MF v79,v30,v79
s_cmp_lg_u32 s70, 0
s_cbranch_scc1 L_rk3
s_call_b64 s[36:37], L_rpoll
L_rk3:
s_ff1_i32_b32 s71, s70
s_bitset0_b32 s70, s71
s_mul_i32 s71, s71, 114688
SA s72,s71,s77
buffer_load_dwordx4 v[152:155], v7, s[8:11], s72 offen sc1
buffer_load_dwordx4 v[156:159], v27, s[8:11], s72 offen sc1
v_lshlrev_b32 v80, 16, v44
v_and_b32 v81, 0xffff0000, v44
v_lshlrev_b32 v82, 16, v45
v_and_b32 v83, 0xffff0000, v45
v_lshlrev_b32 v84, 16, v46
v_and_b32 v85, 0xffff0000, v46
v_lshlrev_b32 v86, 16, v47
v_and_b32 v87, 0xffff0000, v47
v_sub_f32 v30, 1.0, v26
v_cmp_eq_u32 s[80:81], s92, v29
v_cmp_eq_u32 s[82:83], s94, v29
s_nop 0
s_or_b64 vcc, s[80:81], s[82:83]
s_cbranch_vccnz L_moe1
L_moe_ret1:
MF v80,v30,v80
MF v81,v30,v81
MF v82,v30,v82
MF v83,v30,v83
MF v84,v30,v84
MF v85,v30,v85
MF v86,v30,v86
MF v87,v30,v87
s_waitcnt vmcnt(7)
M v[96:99],a[246:249],v[128:131],0
M v[100:103],a[244:247],v[128:131],0
s_waitcnt vmcnt(6)
M v[104:107],a[246:249],v[132:135],0
M v[108:111],a[244:247],v[132:135],0
s_cmp_lg_u32 s70, 0
s_cbranch_scc1 L_rk4
s_call_b64 s[36:37], L_rpoll
L_rk4:
s_ff1_i32_b32 s71, s70
s_bitset0_b32 s70, s71
s_mul_i32 s71, s71, 114688
SA s72,s71,s77
buffer_load_dwordx4 v[160:163], v7, s[8:11], s72 offen sc1
buffer_load_dwordx4 v[164:167], v27, s[8:11], s72 offen sc1
s_waitcnt vmcnt(7)
M v[96:99],a[246:249],v[136:139],v[96:99]
M v[100:103],a[244:247],v[136:139],v[100:103]
s_waitcnt vmcnt(6)
M v[104:107],a[246:249],v[140:143],v[104:107]
M v[108:111],a[244:247],v[140:143],v[108:111]
s_cmp_lg_u32 s70, 0
s_cbranch_scc1 L_rk5
s_call_b64 s[36:37], L_rpoll
L_rk5:
s_ff1_i32_b32 s71, s70
s_bitset0_b32 s70, s71
s_mul_i32 s71, s71, 114688
SA s72,s71,s77
buffer_load_dwordx4 v[168:171], v7, s[8:11], s72 offen sc1
buffer_load_dwordx4 v[172:175], v27, s[8:11], s72 offen sc1
s_waitcnt vmcnt(7)
M v[96:99],a[246:249],v[144:147],v[96:99]
M v[100:103],a[244:247],v[144:147],v[100:103]
s_waitcnt vmcnt(6)
M v[104:107],a[246:249],v[148:151],v[104:107]
M v[108:111],a[244:247],v[148:151],v[108:111]
s_cmp_lg_u32 s70, 0
s_cbranch_scc1 L_rk6
s_call_b64 s[36:37], L_rpoll
L_rk6:
s_ff1_i32_b32 s71, s70
s_bitset0_b32 s70, s71
s_mul_i32 s71, s71, 114688
SA s72,s71,s77
buffer_load_dwordx4 v[176:179], v7, s[8:11], s72 offen sc1
buffer_load_dwordx4 v[180:183], v27, s[8:11], s72 offen sc1
s_waitcnt vmcnt(7)
M v[96:99],a[246:249],v[152:155],v[96:99]
M v[100:103],a[244:247],v[152:155],v[100:103]
s_waitcnt vmcnt(6)
M v[104:107],a[246:249],v[156:159],v[104:107]
M v[108:111],a[244:247],v[156:159],v[108:111]
s_cmp_lg_u32 s70, 0
s_cbranch_scc1 L_rk7
s_call_b64 s[36:37], L_rpoll
L_rk7:
s_ff1_i32_b32 s71, s70
s_bitset0_b32 s70, s71
s_mul_i32 s71, s71, 114688
SA s72,s71,s77
buffer_load_dwordx4 v[184:187], v7, s[8:11], s72 offen sc1
buffer_load_dwordx4 v[188:191], v27, s[8:11], s72 offen sc1
s_waitcnt vmcnt(7)
M v[96:99],a[246:249],v[160:163],v[96:99]
M v[100:103],a[244:247],v[160:163],v[100:103]
s_waitcnt vmcnt(6)
M v[104:107],a[246:249],v[164:167],v[104:107]
M v[108:111],a[244:247],v[164:167],v[108:111]
s_cmp_lg_u32 s70, 0
s_cbranch_scc1 L_rk8
s_call_b64 s[36:37], L_rpoll
L_rk8:
s_ff1_i32_b32 s71, s70
s_bitset0_b32 s70, s71
s_mul_i32 s71, s71, 114688
SA s72,s71,s77
buffer_load_dwordx4 v[128:131], v7, s[8:11], s72 offen sc1
buffer_load_dwordx4 v[132:135], v27, s[8:11], s72 offen sc1
s_waitcnt vmcnt(7)
M v[96:99],a[246:249],v[168:171],v[96:99]
M v[100:103],a[244:247],v[168:171],v[100:103]
s_waitcnt vmcnt(6)
M v[104:107],a[246:249],v[172:175],v[104:107]
M v[108:111],a[244:247],v[172:175],v[108:111]
s_cmp_lg_u32 s70, 0
s_cbranch_scc1 L_rk9
s_call_b64 s[36:37], L_rpoll
L_rk9:
s_ff1_i32_b32 s71, s70
s_bitset0_b32 s70, s71
s_mul_i32 s71, s71, 114688
SA s72,s71,s77
buffer_load_dwordx4 v[136:139], v7, s[8:11], s72 offen sc1
buffer_load_dwordx4 v[140:143], v27, s[8:11], s72 offen sc1
s_waitcnt vmcnt(7)
M v[96:99],a[246:249],v[176:179],v[96:99]
M v[100:103],a[244:247],v[176:179],v[100:103]
s_waitcnt vmcnt(6)
M v[104:107],a[246:249],v[180:183],v[104:107]
M v[108:111],a[244:247],v[180:183],v[108:111]
s_cmp_lg_u32 s70, 0
s_cbranch_scc1 L_rk10
s_call_b64 s[36:37], L_rpoll
L_rk10:
s_ff1_i32_b32 s71, s70
s_bitset0_b32 s70, s71
s_mul_i32 s71, s71, 114688
SA s72,s71,s77
buffer_load_dwordx4 v[144:147], v7, s[8:11], s72 offen sc1
buffer_load_dwordx4 v[148:151], v27, s[8:11], s72 offen sc1
s_waitcnt vmcnt(7)
M v[96:99],a[246:249],v[184:187],v[96:99]
M v[100:103],a[244:247],v[184:187],v[100:103]
s_waitcnt vmcnt(6)
M v[104:107],a[246:249],v[188:191],v[104:107]
M v[108:111],a[244:247],v[188:191],v[108:111]
s_cmp_lg_u32 s70, 0
s_cbranch_scc1 L_rk11
s_call_b64 s[36:37], L_rpoll
L_rk11:
s_ff1_i32_b32 s71, s70
s_bitset0_b32 s70, s71
s_mul_i32 s71, s71, 114688
SA s72,s71,s77
buffer_load_dwordx4 v[152:155], v7, s[8:11], s72 offen sc1
buffer_load_dwordx4 v[156:159], v27, s[8:11], s72 offen sc1
s_waitcnt vmcnt(7)
M v[96:99],a[246:249],v[128:131],v[96:99]
M v[100:103],a[244:247],v[128:131],v[100:103]
s_waitcnt vmcnt(6)
M v[104:107],a[246:249],v[132:135],v[104:107]
M v[108:111],a[244:247],v[132:135],v[108:111]
s_cmp_lg_u32 s70, 0
s_cbranch_scc1 L_rk12
s_call_b64 s[36:37], L_rpoll
L_rk12:
s_ff1_i32_b32 s71, s70
s_bitset0_b32 s70, s71
s_mul_i32 s71, s71, 114688
SA s72,s71,s77
buffer_load_dwordx4 v[160:163], v7, s[8:11], s72 offen sc1
buffer_load_dwordx4 v[164:167], v27, s[8:11], s72 offen sc1
buffer_load_dword v8, v33, s[8:11], s46 offen sc1
s_waitcnt vmcnt(8)
M v[96:99],a[246:249],v[136:139],v[96:99]
M v[100:103],a[244:247],v[136:139],v[100:103]
s_waitcnt vmcnt(7)
M v[104:107],a[246:249],v[140:143],v[104:107]
M v[108:111],a[244:247],v[140:143],v[108:111]
s_cmp_lg_u32 s70, 0
s_cbranch_scc1 L_rk13
s_call_b64 s[36:37], L_rpoll
L_rk13:
s_ff1_i32_b32 s71, s70
s_bitset0_b32 s70, s71
s_mul_i32 s71, s71, 114688
SA s72,s71,s77
buffer_load_dwordx4 v[168:171], v7, s[8:11], s72 offen sc1
buffer_load_dwordx4 v[172:175], v27, s[8:11], s72 offen sc1
s_waitcnt vmcnt(8)
M v[96:99],a[246:249],v[144:147],v[96:99]
M v[100:103],a[244:247],v[144:147],v[100:103]
s_waitcnt vmcnt(7)
M v[104:107],a[246:249],v[148:151],v[104:107]
M v[108:111],a[244:247],v[148:151],v[108:111]
s_cmp_lg_u32 s70, 0
s_cbranch_scc1 L_rk14
s_call_b64 s[36:37], L_rpoll
L_rk14:
s_ff1_i32_b32 s71, s70
s_bitset0_b32 s70, s71
s_mul_i32 s71, s71, 114688
SA s72,s71,s77
buffer_load_dwordx4 v[176:179], v7, s[8:11], s72 offen sc1
buffer_load_dwordx4 v[180:183], v27, s[8:11], s72 offen sc1
s_waitcnt vmcnt(8)
M v[96:99],a[246:249],v[152:155],v[96:99]
M v[100:103],a[244:247],v[152:155],v[100:103]
s_waitcnt vmcnt(7)
M v[104:107],a[246:249],v[156:159],v[104:107]
M v[108:111],a[244:247],v[156:159],v[108:111]
s_cmp_lg_u32 s70, 0
s_cbranch_scc1 L_rk15
s_call_b64 s[36:37], L_rpoll
L_rk15:
s_ff1_i32_b32 s71, s70
s_bitset0_b32 s70, s71
s_mul_i32 s71, s71, 114688
SA s72,s71,s77
buffer_load_dwordx4 v[184:187], v7, s[8:11], s72 offen sc1
buffer_load_dwordx4 v[188:191], v27, s[8:11], s72 offen sc1
s_waitcnt vmcnt(8)
M v[96:99],a[246:249],v[160:163],v[96:99]
M v[100:103],a[244:247],v[160:163],v[100:103]
s_waitcnt vmcnt(7)
M v[104:107],a[246:249],v[164:167],v[104:107]
M v[108:111],a[244:247],v[164:167],v[108:111]
s_waitcnt vmcnt(6)
v_cmp_eq_u32 vcc, 1, v8
s_mov_b32 s69, 0xffff0000
s_and_b32 s70, vcc_lo, s69
s_mov_b32 s68, s70
s_cmp_lg_u32 s70, 0
s_cbranch_scc1 L_rk16
s_call_b64 s[36:37], L_rpoll
L_rk16:
s_ff1_i32_b32 s71, s70
s_bitset0_b32 s70, s71
s_mul_i32 s71, s71, 114688
SA s72,s71,s78
buffer_load_dwordx4 v[192:195], v7, s[8:11], s72 offen sc1
s_waitcnt vmcnt(6)
M v[96:99],a[246:249],v[168:171],v[96:99]
M v[100:103],a[244:247],v[168:171],v[100:103]
s_waitcnt vmcnt(5)
M v[104:107],a[246:249],v[172:175],v[104:107]
M v[108:111],a[244:247],v[172:175],v[108:111]
s_cmp_lg_u32 s70, 0
s_cbranch_scc1 L_rk17
s_call_b64 s[36:37], L_rpoll
L_rk17:
s_ff1_i32_b32 s71, s70
s_bitset0_b32 s70, s71
s_mul_i32 s71, s71, 114688
SA s72,s71,s78
buffer_load_dwordx4 v[196:199], v7, s[8:11], s72 offen sc1
s_waitcnt vmcnt(5)
M v[96:99],a[246:249],v[176:179],v[96:99]
M v[100:103],a[244:247],v[176:179],v[100:103]
s_waitcnt vmcnt(4)
M v[104:107],a[246:249],v[180:183],v[104:107]
M v[108:111],a[244:247],v[180:183],v[108:111]
s_cmp_lg_u32 s70, 0
s_cbranch_scc1 L_rk18
s_call_b64 s[36:37], L_rpoll
L_rk18:
s_ff1_i32_b32 s71, s70
s_bitset0_b32 s70, s71
s_mul_i32 s71, s71, 114688
SA s72,s71,s78
buffer_load_dwordx4 v[200:203], v7, s[8:11], s72 offen sc1
s_waitcnt vmcnt(4)
M v[96:99],a[246:249],v[184:187],v[96:99]
M v[100:103],a[244:247],v[184:187],v[100:103]
s_waitcnt vmcnt(3)
M v[104:107],a[246:249],v[188:191],v[104:107]
M v[108:111],a[244:247],v[188:191],v[108:111]
s_nop 4
v_permlane16_swap_b32 v96, v100
v_permlane16_swap_b32 v97, v101
v_permlane16_swap_b32 v98, v102
v_permlane16_swap_b32 v99, v103
v_permlane16_swap_b32 v104, v108
v_permlane16_swap_b32 v105, v109
v_permlane16_swap_b32 v106, v110
v_permlane16_swap_b32 v107, v111
v_fmac_f32 v64, v39, v96
v_fmac_f32 v65, v39, v97
v_fmac_f32 v66, v39, v98
v_fmac_f32 v67, v39, v99
v_fmac_f32 v68, v39, v100
v_fmac_f32 v69, v39, v101
v_fmac_f32 v70, v39, v102
v_fmac_f32 v71, v39, v103
C v48,v64,v65
C v49,v66,v67
C v50,v68,v69
C v51,v70,v71
buffer_store_dwordx4 v[48:51], v38, s[52:55], s75 offen sc1
v_fmac_f32 v72, v39, v104
v_fmac_f32 v73, v39, v105
v_fmac_f32 v74, v39, v106
v_fmac_f32 v75, v39, v107
v_fmac_f32 v76, v39, v108
v_fmac_f32 v77, v39, v109
v_fmac_f32 v78, v39, v110
v_fmac_f32 v79, v39, v111
C v52,v72,v73
C v53,v74,v75
C v54,v76,v77
C v55,v78,v79
buffer_store_dwordx4 v[52:55], v38, s[52:55], s76 offen sc1
s_cmp_lg_u32 s70, 0
s_cbranch_scc1 L_rk19
s_call_b64 s[36:37], L_rpoll
L_rk19:
s_ff1_i32_b32 s71, s70
s_bitset0_b32 s70, s71
s_mul_i32 s71, s71, 114688
SA s72,s71,s78
buffer_load_dwordx4 v[204:207], v7, s[8:11], s72 offen sc1
s_cmp_lg_u32 s70, 0
s_cbranch_scc1 L_rk20
s_call_b64 s[36:37], L_rpoll
L_rk20:
s_ff1_i32_b32 s71, s70
s_bitset0_b32 s70, s71
s_mul_i32 s71, s71, 114688
SA s72,s71,s78
buffer_load_dwordx4 v[208:211], v7, s[8:11], s72 offen sc1
s_cmp_lg_u32 s70, 0
s_cbranch_scc1 L_rk21
s_call_b64 s[36:37], L_rpoll
L_rk21:
s_ff1_i32_b32 s71, s70
s_bitset0_b32 s70, s71
s_mul_i32 s71, s71, 114688
SA s72,s71,s78
buffer_load_dwordx4 v[212:215], v7, s[8:11], s72 offen sc1
s_cmp_lg_u32 s70, 0
s_cbranch_scc1 L_rk22
s_call_b64 s[36:37], L_rpoll
L_rk22:
s_ff1_i32_b32 s71, s70
s_bitset0_b32 s70, s71
s_mul_i32 s71, s71, 114688
SA s72,s71,s78
buffer_load_dwordx4 v[216:219], v7, s[8:11], s72 offen sc1
s_cmp_lg_u32 s70, 0
s_cbranch_scc1 L_rk23
s_call_b64 s[36:37], L_rpoll
L_rk23:
s_ff1_i32_b32 s71, s70
s_bitset0_b32 s70, s71
s_mul_i32 s71, s71, 114688
SA s72,s71,s78
buffer_load_dwordx4 v[220:223], v7, s[8:11], s72 offen sc1
s_cmp_lg_u32 s70, 0
s_cbranch_scc1 L_rk24
s_call_b64 s[36:37], L_rpoll
L_rk24:
s_ff1_i32_b32 s71, s70
s_bitset0_b32 s70, s71
s_mul_i32 s71, s71, 114688
SA s72,s71,s78
buffer_load_dwordx4 v[224:227], v7, s[8:11], s72 offen sc1
s_cmp_lg_u32 s70, 0
s_cbranch_scc1 L_rk25
s_call_b64 s[36:37], L_rpoll
L_rk25:
s_ff1_i32_b32 s71, s70
s_bitset0_b32 s70, s71
s_mul_i32 s71, s71, 114688
SA s72,s71,s78
buffer_load_dwordx4 v[228:231], v7, s[8:11], s72 offen sc1
s_cmp_lg_u32 s70, 0
s_cbranch_scc1 L_rk26
s_call_b64 s[36:37], L_rpoll
L_rk26:
s_ff1_i32_b32 s71, s70
s_bitset0_b32 s70, s71
s_mul_i32 s71, s71, 114688
SA s72,s71,s78
buffer_load_dwordx4 v[232:235], v7, s[8:11], s72 offen sc1
s_cmp_lg_u32 s70, 0
s_cbranch_scc1 L_rk27
s_call_b64 s[36:37], L_rpoll
L_rk27:
s_ff1_i32_b32 s71, s70
s_bitset0_b32 s70, s71
s_mul_i32 s71, s71, 114688
SA s72,s71,s78
buffer_load_dwordx4 v[236:239], v7, s[8:11], s72 offen sc1
s_waitcnt vmcnt(13)
M v[112:115],a[246:249],v[192:195],0
M v[116:119],a[244:247],v[192:195],0
s_cmp_lg_u32 s70, 0
s_cbranch_scc1 L_rk28
s_call_b64 s[36:37], L_rpoll
L_rk28:
s_ff1_i32_b32 s71, s70
s_bitset0_b32 s70, s71
s_mul_i32 s71, s71, 114688
SA s72,s71,s78
buffer_load_dwordx4 v[240:243], v7, s[8:11], s72 offen sc1
s_waitcnt vmcnt(13)
M v[112:115],a[246:249],v[196:199],v[112:115]
M v[116:119],a[244:247],v[196:199],v[116:119]
s_cmp_lg_u32 s70, 0
s_cbranch_scc1 L_rk29
s_call_b64 s[36:37], L_rpoll
L_rk29:
s_ff1_i32_b32 s71, s70
s_bitset0_b32 s70, s71
s_mul_i32 s71, s71, 114688
SA s72,s71,s78
buffer_load_dwordx4 v[244:247], v7, s[8:11], s72 offen sc1
s_waitcnt vmcnt(13)
M v[112:115],a[246:249],v[200:203],v[112:115]
M v[116:119],a[244:247],v[200:203],v[116:119]
s_cmp_lg_u32 s70, 0
s_cbranch_scc1 L_rk30
s_call_b64 s[36:37], L_rpoll
L_rk30:
s_ff1_i32_b32 s71, s70
s_bitset0_b32 s70, s71
s_mul_i32 s71, s71, 114688
SA s72,s71,s78
buffer_load_dwordx4 v[248:251], v7, s[8:11], s72 offen sc1
s_waitcnt vmcnt(11)
M v[112:115],a[246:249],v[204:207],v[112:115]
M v[116:119],a[244:247],v[204:207],v[116:119]
s_cmp_lg_u32 s70, 0
s_cbranch_scc1 L_rk31
s_call_b64 s[36:37], L_rpoll
L_rk31:
s_ff1_i32_b32 s71, s70
s_bitset0_b32 s70, s71
s_mul_i32 s71, s71, 114688
SA s72,s71,s78
buffer_load_dwordx4 v[252:255], v7, s[8:11], s72 offen sc1
s_waitcnt vmcnt(11)
M v[112:115],a[246:249],v[208:211],v[112:115]
M v[116:119],a[244:247],v[208:211],v[116:119]
s_waitcnt vmcnt(10)
M v[112:115],a[246:249],v[212:215],v[112:115]
M v[116:119],a[244:247],v[212:215],v[116:119]
s_waitcnt vmcnt(9)
M v[112:115],a[246:249],v[216:219],v[112:115]
M v[116:119],a[244:247],v[216:219],v[116:119]
s_waitcnt vmcnt(8)
M v[112:115],a[246:249],v[220:223],v[112:115]
M v[116:119],a[244:247],v[220:223],v[116:119]
s_waitcnt vmcnt(7)
M v[112:115],a[246:249],v[224:227],v[112:115]
M v[116:119],a[244:247],v[224:227],v[116:119]
s_waitcnt vmcnt(6)
M v[112:115],a[246:249],v[228:231],v[112:115]
M v[116:119],a[244:247],v[228:231],v[116:119]
s_waitcnt vmcnt(5)
M v[112:115],a[246:249],v[232:235],v[112:115]
M v[116:119],a[244:247],v[232:235],v[116:119]
s_waitcnt vmcnt(4)
M v[112:115],a[246:249],v[236:239],v[112:115]
M v[116:119],a[244:247],v[236:239],v[116:119]
s_waitcnt vmcnt(3)
M v[112:115],a[246:249],v[240:243],v[112:115]
M v[116:119],a[244:247],v[240:243],v[116:119]
s_waitcnt vmcnt(2)
M v[112:115],a[246:249],v[244:247],v[112:115]
M v[116:119],a[244:247],v[244:247],v[116:119]
s_waitcnt vmcnt(1)
M v[112:115],a[246:249],v[248:251],v[112:115]
M v[116:119],a[244:247],v[248:251],v[116:119]
s_waitcnt vmcnt(0)
M v[112:115],a[246:249],v[252:255],v[112:115]
M v[116:119],a[244:247],v[252:255],v[116:119]
s_nop 7
v_permlane16_swap_b32 v112, v116
v_permlane16_swap_b32 v113, v117
v_permlane16_swap_b32 v114, v118
v_permlane16_swap_b32 v115, v119
v_fmac_f32 v80, v26, v112
v_fmac_f32 v81, v26, v113
v_fmac_f32 v82, v26, v114
v_fmac_f32 v83, v26, v115
v_fmac_f32 v84, v26, v116
v_fmac_f32 v85, v26, v117
v_fmac_f32 v86, v26, v118
v_fmac_f32 v87, v26, v119
C v44,v80,v81
C v45,v82,v83
C v46,v84,v85
C v47,v86,v87
buffer_store_dwordx4 v[44:47], v28, s[52:55], s79 offen sc1
s_endpgm
L_rpoll0:
s_sleep 1
L_rpoll:
buffer_load_dword v9, v33, s[8:11], s46 offen sc1
s_waitcnt vmcnt(0)
v_cmp_eq_u32 vcc, 1, v9
s_sub_u32 s91, s91, 1
s_cselect_b32 s70, -1, 0
s_or_b32 s70, s70, vcc_lo
s_and_b32 s70, s70, s69
s_andn2_b32 s70, s70, s68
s_cbranch_scc0 L_rpoll0
s_or_b32 s68, s68, s70
s_setpc_b64 s[36:37]
L_moe0:
s_lshl_b32 s88, s75, 1
s_call_b64 s[36:37], L_moe
AF v64,v2,v64
AF v65,v3,v65
AF v66,v4,v66
AF v67,v5,v67
AF v68,v10,v68
AF v69,v11,v69
AF v70,v12,v70
AF v71,v13,v71
AF v72,v14,v72
AF v73,v15,v73
AF v74,v16,v74
AF v75,v17,v75
AF v76,v18,v76
AF v77,v19,v77
AF v78,v20,v78
AF v79,v21,v79
s_mov_b64 exec, -1
s_branch L_moe_ret0
L_moe1:
s_lshl_b32 s88, s79, 1
s_call_b64 s[36:37], L_moe
AF v80,v2,v80
AF v81,v3,v81
AF v82,v4,v82
AF v83,v5,v83
AF v84,v10,v84
AF v85,v11,v85
AF v86,v12,v86
AF v87,v13,v87
s_mov_b64 exec, -1
s_branch L_moe_ret1
L_moe2:
s_lshl_b32 s88, s79, 1
s_call_b64 s[36:37], L_moe
AF v48,v2,v48
AF v49,v3,v49
AF v50,v4,v50
AF v51,v5,v51
AF v52,v10,v52
AF v53,v11,v53
AF v54,v12,v54
AF v55,v13,v55
s_mov_b64 exec, -1
s_branch L_moe_ret2
L_moe:
v_min_u32 v0, 27, v32
v_lshlrev_b32 v0, 2, v0
s_mov_b32 s64, 105062912
s_mov_b32 s65, 65536
s_mov_b32 exec_lo, 0xffffffff
s_mov_b32 exec_hi, 0xffffffff
L_pfy:
buffer_load_dword v1, v0, s[8:11], s64 offen sc1
s_sub_u32 s65, s65, 1
s_cbranch_scc1 L_pfy_x
s_waitcnt vmcnt(0)
v_cmp_ne_u32 vcc, 1, v1
s_nop 0
s_cbranch_vccz L_pfy_x
s_sleep 2
s_branch L_pfy
L_pfy_x:
s_waitcnt vmcnt(0)
s_mov_b64 exec, -1
s_or_b64 exec, s[80:81], s[82:83]
v_mov_b32 v0, 1792
v_cndmask_b32 v0, v0, 0, s[80:81]
v_lshl_add_u32 v0, v34, 5, v0
SA s88,s88,104898560
buffer_load_dwordx4 v[2:5], v0, s[8:11], s88 offen sc1
buffer_load_dwordx4 v[10:13], v0, s[8:11], s88 offen offset:16 sc1
buffer_load_dwordx4 v[14:17], v0, s[8:11], s88 offen offset:512 sc1
buffer_load_dwordx4 v[18:21], v0, s[8:11], s88 offen offset:528 sc1
s_waitcnt vmcnt(0)
s_setpc_b64 s[36:37]
L_red:
v_lshrrev_b32 v32, 4, v7
s_lshr_b32 s74, s41, 3
s_lshl_b32 s64, s42, 1
SA s46,s64,s74
s_mul_i32 s46, s46, 4352
s_and_b32 s72, s41, 7
s_lshl_b32 s65, s72, 7
SA s46,s46,s65
SA s46,s46,104992768
v_and_b32 v33, 31, v32
v_lshlrev_b32 v33, 2, v33
s_lshl_b32 s65, s41, 7
SA s65,s65,104890368
buffer_load_dword v31, v33, s[8:11], s65 offen sc1
v_bfe_u32 v34, v32, 4, 1
v_lshlrev_b32 v34, 1, v34
v_lshrrev_b32 v35, 5, v32
v_add_u32 v34, v34, v35
s_mov_b32 s52, s96
s_and_b32 s53, s97, 0xffff
s_mov_b32 s54, 1835008
s_mov_b32 s55, 0x20000
s_mul_i32 s77, s42, 1835008
s_mul_i32 s78, s72, 14336
SA s77,s77,s78
SA s77,s77,67108864
s_lshl_b32 s79, s74, 1
SA s79,s79,s20
s_lshl_b32 s71, s74, 1
SA s71,s71,1
s_sub_u32 s71, s71, s20
s_and_b32 s71, s71, 536870912
s_sub_u32 s64, 15, s64
s_sub_u32 s78, s64, 1
s_mul_i32 s78, s78, 1835008
SA s78,s78,s77
s_lshl_b32 s65, s79, 10
SA s78,s78,s65
SA s78,s78,s71
s_lshl_b32 s79, s79, 6
s_or_b32 s79, s79, s71
s_mul_i32 s67, s74, -2
s_lshl_b32 s74, s74, 3
SA s74,s74,s20
s_lshl_b32 s75, s74, 6
SA s76,s75,256
SA s67,s67,3
s_sub_u32 s67, s67, s20
s_and_b32 s67, s67, 536870912
s_or_b32 s76, s76, s67
v_or_b32 v27, s67, v7
v_add_u32 v27, 4096, v27
s_lshl_b32 s65, s74, 10
SA s77,s77,s65
s_lshl_b32 s64, s64, 7
s_lshr_b32 s73, s72, 1
s_sub_u32 s65, 7, s73
s_bitcmp1_b32 s72, 0
s_cselect_b32 s73, s65, s73
s_lshl_b32 s73, s73, 4
s_lshl_b32 s65, s42, 7
SA s73,s73,s65
v_and_b32 v37, 15, v32
v_add_u32 v37, s73, v37
v_add_u32 v29, s64, v37
s_mov_b32 s64, 104857664
v_mul_u32_u24 v38, 896, v37
v_lshl_add_u32 v38, v34, 4, v38
v_lshrrev_b32 v35, 4, v37
v_lshlrev_b32 v35, 5, v35
v_and_b32 v36, 15, v37
v_add_lshl_u32 v35, v35, v36, 2
buffer_load_dword v39, v35, s[8:11], s64 offen sc1
buffer_load_dwordx4 v[48:51], v38, s[56:59], s75 offen
buffer_load_dwordx4 v[52:55], v38, s[56:59], s76 offen
v_mul_u32_u24 v28, 896, v29
v_lshl_add_u32 v28, v34, 4, v28
v_lshrrev_b32 v35, 4, v29
v_lshlrev_b32 v35, 5, v35
v_and_b32 v36, 15, v29
v_add_lshl_u32 v35, v35, v36, 2
buffer_load_dword v26, v35, s[8:11], s64 offen sc1
buffer_load_dwordx4 v[44:47], v28, s[56:59], s79 offen
s_waitcnt vmcnt(7)
buffer_load_dword v9, v33, s[8:11], s46 offen sc1
s_branch L_red1
L_code_end:
.section .rodata,"a"
.p2align 6
.amdhsa_kernel gated_mix__compressed_kv_cla__moe_arch_mod__prompt_kernel
  .amdhsa_next_free_vgpr 512
  .amdhsa_next_free_sgpr 102
  .amdhsa_accum_offset 256
  .amdhsa_group_segment_fixed_size 0
  .amdhsa_kernarg_size 120
  .amdhsa_user_sgpr_count 2
  .amdhsa_user_sgpr_kernarg_segment_ptr 1
  .amdhsa_system_sgpr_workgroup_id_x 1
  .amdhsa_float_denorm_mode_32 3
.end_amdhsa_kernel
```

```asm
; @launch grid=(256,1,1) block=(256,1,1) lds=163840
.amdgcn_target "amdgcn-amd-amdhsa--gfx950"
.text
.macro M a, b, c, d
v_mfma_f32_16x16x32_bf16 \a, \b, \c, \d
.endm
.macro R a, b, c
ds_read_b128 \a, \b offset:\c
.endm
.macro T a, b, c
ds_read_b64_tr_b16 \a, \b offset:\c
.endm
.macro C a, b, c
v_cvt_pk_bf16_f32 \a, \b, \c
.endm
.macro E a, b
v_exp_f32 \a, \b
.endm
.macro W a, b
v_accvgpr_write_b32 \a, \b
.endm
.macro G a, b
v_accvgpr_read_b32 \a, \b
.endm
.macro AF a, b, c
v_add_f32 \a, \b, \c
.endm
.macro MF a, b, c
v_mul_f32 \a, \b, \c
.endm
.macro SA a, b, c
s_add_u32 \a, \b, \c
.endm
.globl gated_mix__compressed_kv_cla__moe_arch_mod__prompt_kernel
.p2align 8
.type gated_mix__compressed_kv_cla__moe_arch_mod__prompt_kernel,@function
gated_mix__compressed_kv_cla__moe_arch_mod__prompt_kernel:
s_cmp_lt_u32 s2, 256
s_cbranch_scc1 L_go
s_endpgm
L_go:
s_load_dwordx8 s[80:87], s[0:1], 0
s_load_dwordx4 s[88:91], s[0:1], 32
s_getpc_b64 s[76:77]
L_pc0:
s_lshr_b32 s42, s2, 3
s_mov_b32 s79, 0x20000
s_lshl_b32 s67, s42, 13
s_mov_b32 s78, L_code_end-L_pc0
s_and_b32 s77, s77, 0xffff
v_lshl_add_u32 v31, v0, 5, s67
buffer_load_dword a240, v31, s[76:79], 0 offen offset:0
v_lshrrev_b32 v24, 6, v0
v_and_b32 v0, 63, v0
s_and_b32 s41, s2, 7
v_readfirstlane_b32 s20, v24
s_lshr_b32 s64, s2, 4
v_and_b32 v24, 15, v0
v_lshrrev_b32 v25, 4, v0
s_and_b32 s64, s64, 8
s_or_b32 s41, s41, s64
v_lshlrev_b32 v28, 1, v25
v_xor_b32 v28, v28, v24
v_and_b32 v29, 8, v28
v_and_b32 v28, 7, v28
v_lshlrev_b32 v28, 4, v28
v_lshl_add_u32 v28, v29, 5, v28
v_lshl_add_u32 v28, v25, 13, v28
s_lshl_b32 s64, s20, 17
v_add_u32 v8, s64, v28
v_xor_b32 v28, 0x100, v8
v_add_u32 v9, 31744, v8
v_add_u32 v10, 63488, v28
v_add_u32 v11, 95232, v28
s_mov_b32 s21, 0
s_lshl_b32 s23, s20, 12
s_lshl_b32 s74, s41, 9
s_sub_u32 s18, 8388608, s74
s_mov_b32 s19, s79
s_bitcmp0_b32 s2, 6
s_waitcnt lgkmcnt(0)
s_cselect_b64 s[72:73], s[86:87], s[88:89]
SA s16,s72,s74
s_addc_u32 s73, s73, 0
s_and_b32 s17, s73, 0xffff
SA m0,s23,0
s_nop 0
buffer_load_dwordx4 v8, s[16:19], s21 offen offset:0  nt lds
buffer_load_dwordx4 v9, s[16:19], s21 offen offset:1024  nt lds
buffer_load_dwordx4 v10, s[16:19], s21 offen offset:2048  nt lds
buffer_load_dwordx4 v11, s[16:19], s21 offen offset:3072  nt lds
SA s21,s21,128
s_and_b32 s42, s42, 15
s_lshr_b32 s45, s42, 3
s_and_b32 s65, s20, 1
s_lshr_b32 s66, s20, 1
v_and_b32 v29, 7, v0
v_xor_b32 v28, v25, v29
v_lshlrev_b32 v28, 4, v28
v_lshrrev_b32 v29, 3, v0
v_lshl_add_u32 v30, v29, 11, v28
s_lshl_b32 s64, s66, 19
s_lshl_b32 s67, s65, 21
SA s64,s64,s67
v_add_u32 v12, s64, v30
v_xor_b32 v30, 64, v12
v_add_u32 v14, 30720, v12
v_add_u32 v13, 15360, v30
v_add_u32 v15, 46080, v30
s_mov_b32 s22, 0
SA s24,s23,65536
s_and_b32 s64, s42, 7
s_lshl_b32 s64, s64, 16
s_sub_u32 s50, 4194304, s64
s_mov_b32 s51, s79
SA s48,s82,s64
s_addc_u32 s73, s83, 0
s_and_b32 s49, s73, 0xffff
SA m0,s23,16384
s_nop 0
buffer_load_dwordx4 v8, s[16:19], s21 offen offset:0  nt lds
buffer_load_dwordx4 v9, s[16:19], s21 offen offset:1024  nt lds
buffer_load_dwordx4 v10, s[16:19], s21 offen offset:2048  nt lds
buffer_load_dwordx4 v11, s[16:19], s21 offen offset:3072  nt lds
SA s21,s21,524160
SA m0,s24,0
s_nop 0
buffer_load_dwordx4 v12, s[48:51], s22 offen offset:0   lds
buffer_load_dwordx4 v13, s[48:51], s22 offen offset:1024   lds
buffer_load_dwordx4 v14, s[48:51], s22 offen offset:2048   lds
buffer_load_dwordx4 v15, s[48:51], s22 offen offset:3072   lds
SA s22,s22,1048576
s_load_dwordx2 s[92:93], s[0:1], 56
s_load_dwordx2 s[94:95], s[0:1], 88
s_load_dwordx4 s[4:7], s[0:1], 104
v_lshlrev_b32 v7, 4, v0
v_lshrrev_b32 v26, 2, v24
v_and_b32 v28, 1, v25
v_lshl_or_b32 v28, v28, 2, v26
v_lshl_add_u32 v29, v25, 3, v26
v_lshlrev_b32 v29, 8, v29
v_and_b32 v30, 3, v0
v_lshl_add_u32 v29, v30, 3, v29
s_lshl_b32 s64, s65, 2
SA s64,s64,0
v_xor_b32 v30, s64, v28
v_lshl_add_u32 v1, v30, 5, v29
s_lshl_b32 s64, s65, 2
SA s64,s64,1
v_xor_b32 v30, s64, v28
v_lshl_add_u32 v2, v30, 5, v29
s_lshl_b32 s64, s65, 2
SA s64,s64,2
v_xor_b32 v30, s64, v28
v_lshl_add_u32 v3, v30, 5, v29
s_lshl_b32 s64, s65, 2
SA s64,s64,3
v_xor_b32 v30, s64, v28
v_lshl_add_u32 v4, v30, 5, v29
v_add_u32 v28, 0, v25
v_lshrrev_b32 v29, 1, v24
v_xor_b32 v28, v28, v29
v_lshlrev_b32 v28, 4, v28
v_lshl_add_u32 v28, v24, 7, v28
s_lshl_b32 s64, s66, 13
SA s64,s64,65536
v_add_u32 v5, s64, v28
v_add_u32 v28, 4, v25
v_lshrrev_b32 v29, 1, v24
v_xor_b32 v28, v28, v29
v_lshlrev_b32 v28, 4, v28
v_lshl_add_u32 v28, v24, 7, v28
s_lshl_b32 s64, s66, 13
SA s64,s64,65536
v_add_u32 v6, s64, v28
s_mov_b32 s56, s80
s_and_b32 s57, s81, 0xffff
s_mov_b32 s58, 1835008
s_mov_b32 s59, 0x20000
s_waitcnt lgkmcnt(0)
s_mov_b32 s60, s92
s_and_b32 s61, s93, 0xffff
s_mov_b32 s62, 896
s_mov_b32 s63, 0x20000
s_mov_b32 s68, s94
s_and_b32 s69, s95, 0xffff
s_mov_b32 s70, 896
s_mov_b32 s71, 0x20000
s_lshl_b32 s95, s20, 11
s_lshr_b32 s64, s2, 3
s_lshl_b32 s64, s64, 13
SA s95,s95,s64
s_mov_b32 s8, s6
s_and_b32 s9, s7, 0xffff
s_mov_b32 s10, 268435456
s_mov_b32 s11, 0x20000
s_mov_b32 s12, s4
s_and_b32 s13, s5, 0xffff
s_mov_b32 s14, 256
s_mov_b32 s15, 0x20000
SA s72,s84,s74
s_addc_u32 s73, s85, 0
s_sub_u32 s75, 3670016, s74
s_mov_b32 s52, s72
s_and_b32 s53, s73, 0xffff
s_mov_b32 s54, s75
s_mov_b32 s55, 0x20000
s_mul_i32 s29, s42, 114688
s_mov_b32 s5, 0x3db8aa3b
s_mul_i32 s72, s45, 16777216
s_mul_i32 s73, s41, 1048576
SA s72,s72,s73
s_bfe_u32 s64, s42, 0x20001
s_lshl_b32 s64, s64, 15
SA s72,s72,s64
s_lshl_b32 s64, s66, 17
SA s72,s72,s64
s_and_b32 s67, s42, 1
s_cmp_eq_u32 s45, 0
s_cselect_b32 s64, 12, 14
s_cselect_b32 s75, 14, 10
s_lshl_b32 s67, s67, s75
SA s72,s72,s67
s_lshl_b32 s64, s65, s64
SA s93,s72,s64
s_load_dwordx4 s[80:83], s[0:1], 64
s_load_dwordx2 s[84:85], s[0:1], 80
s_load_dwordx2 s[96:97], s[0:1], 96
s_cmp_eq_u32 s45, 0
s_cbranch_scc0 L_kv1
s_branch L_kv0
.p2align 12
L_kv0:
s_and_b32 s31, s42, 7
s_lshl_b32 s64, s42, 4
SA s64,s64,s41
s_lshl_b32 s64, s64, 2
SA s64,s64,s20
s_cmp_lt_u32 s64, 41
s_cselect_b32 s39, 0, 536870912
s_min_u32 s64, s64, 41
s_lshl_b32 s38, s64, 2
s_max_u32 s67, s64, 8
s_sub_u32 s67, s67, 8
s_mul_i32 s67, s67, 3328
s_lshl_b32 s64, s64, 10
SA s64,s64,s67
SA s73,s64,104914944
v_or_b32 v64, s39, v7
v_mov_b32 v68, 0
v_mov_b32 v69, 0
v_mov_b32 v70, 0
v_mov_b32 v71, 0
buffer_store_dwordx4 v[68:71], v64, s[8:11], s73 offen offset:0 sc1
buffer_store_dwordx4 v[68:71], v64, s[8:11], s73 offen offset:1024 sc1
buffer_store_dwordx4 v[68:71], v64, s[8:11], s73 offen offset:2048 sc1
SA m0,s24,16384
s_nop 0
buffer_load_dwordx4 v12, s[48:51], s22 offen offset:0   lds
buffer_load_dwordx4 v13, s[48:51], s22 offen offset:1024   lds
buffer_load_dwordx4 v14, s[48:51], s22 offen offset:2048   lds
buffer_load_dwordx4 v15, s[48:51], s22 offen offset:3072   lds
s_sub_u32 s22, s22, 1048448
SA m0,s23,32768
s_nop 0
buffer_load_dwordx4 v8, s[16:19], s21 offen offset:0  nt lds
buffer_load_dwordx4 v9, s[16:19], s21 offen offset:1024  nt lds
buffer_load_dwordx4 v10, s[16:19], s21 offen offset:2048  nt lds
buffer_load_dwordx4 v11, s[16:19], s21 offen offset:3072  nt lds
SA s21,s21,128
s_mov_b64 exec, 0
s_cmp_eq_u32 s20, 0
s_cbranch_scc1 L_w_kv01
s_cmp_eq_u32 s20, 1
s_cbranch_scc1 L_w_kv02
s_cmp_eq_u32 s20, 2
s_cbranch_scc1 L_w_kv03
s_branch L_w_kv04
L_wd1:
s_mov_b64 exec, -1
s_waitcnt vmcnt(11) lgkmcnt(0)
s_barrier
R a[160:163],v5,0
R a[164:167],v6,0
T a[96:97],v1,0
T a[98:99],v1,1024
T a[100:101],v1,8192
T a[102:103],v1,9216
T a[104:105],v2,0
T a[106:107],v2,1024
T a[108:109],v2,8192
T a[110:111],v2,9216
T a[112:113],v3,0
T a[114:115],v3,1024
T a[116:117],v3,8192
T a[118:119],v3,9216
T a[120:121],v4,0
T a[122:123],v4,1024
T a[124:125],v4,8192
T a[126:127],v4,9216
T a[128:129],v1,16384
T a[130:131],v1,17408
T a[132:133],v1,24576
T a[134:135],v1,25600
T a[136:137],v2,16384
T a[138:139],v2,17408
T a[140:141],v2,24576
T a[142:143],v2,25600
T a[144:145],v3,16384
T a[146:147],v3,17408
T a[148:149],v3,24576
T a[150:151],v3,25600
T a[152:153],v4,16384
T a[154:155],v4,17408
T a[156:157],v4,24576
T a[158:159],v4,25600
s_waitcnt lgkmcnt(15)
M a[0:3],a[96:99],a[160:163],0
SA m0,s23,49152
R a[168:171],v5,2048
R a[172:175],v6,2048
M a[0:3],a[100:103],a[164:167],a[0:3]
buffer_load_dwordx4 v8, s[16:19], s21 offen offset:0  nt lds
M a[4:7],a[108:111],a[164:167],0
M a[4:7],a[104:107],a[160:163],a[4:7]
M a[8:11],a[112:115],a[160:163],0
buffer_load_dwordx4 v9, s[16:19], s21 offen offset:1024  nt lds
M a[8:11],a[116:119],a[164:167],a[8:11]
s_waitcnt lgkmcnt(14)
M a[12:15],a[124:127],a[164:167],0
M a[12:15],a[120:123],a[160:163],a[12:15]
M a[16:19],a[128:131],a[160:163],0
buffer_load_dwordx4 v10, s[16:19], s21 offen offset:2048  nt lds
M a[16:19],a[132:135],a[164:167],a[16:19]
s_waitcnt lgkmcnt(6)
M a[20:23],a[140:143],a[164:167],0
M a[20:23],a[136:139],a[160:163],a[20:23]
buffer_load_dwordx4 v11, s[16:19], s21 offen offset:3072  nt lds
M a[24:27],a[144:147],a[160:163],0
SA s21,s21,524160
M a[24:27],a[148:151],a[164:167],a[24:27]
s_waitcnt lgkmcnt(0)
M a[28:31],a[156:159],a[164:167],0
SA m0,s24,32768
M a[28:31],a[152:155],a[160:163],a[28:31]
buffer_load_dwordx4 v12, s[48:51], s22 offen offset:0   lds
M v[32:35],a[96:99],a[168:171],0
R a[160:163],v5,4096
R a[164:167],v6,4096
M v[32:35],a[100:103],a[172:175],v[32:35]
M v[36:39],a[108:111],a[172:175],0
M v[36:39],a[104:107],a[168:171],v[36:39]
buffer_load_dwordx4 v13, s[48:51], s22 offen offset:1024   lds
M v[40:43],a[112:115],a[168:171],0
M v[40:43],a[116:119],a[172:175],v[40:43]
M v[44:47],a[124:127],a[172:175],0
buffer_load_dwordx4 v14, s[48:51], s22 offen offset:2048   lds
M v[44:47],a[120:123],a[168:171],v[44:47]
M v[48:51],a[128:131],a[168:171],0
M v[48:51],a[132:135],a[172:175],v[48:51]
M v[52:55],a[140:143],a[172:175],0
buffer_load_dwordx4 v15, s[48:51], s22 offen offset:3072   lds
M v[52:55],a[136:139],a[168:171],v[52:55]
SA s22,s22,1048576
M v[56:59],a[144:147],a[168:171],0
M v[56:59],a[148:151],a[172:175],v[56:59]
s_waitcnt lgkmcnt(0)
M v[60:63],a[156:159],a[172:175],0
M v[60:63],a[152:155],a[168:171],v[60:63]
M v[64:67],a[96:99],a[160:163],0
R a[168:171],v5,6144
R a[172:175],v6,6144
M v[64:67],a[100:103],a[164:167],v[64:67]
M v[68:71],a[108:111],a[164:167],0
M v[68:71],a[104:107],a[160:163],v[68:71]
M v[72:75],a[112:115],a[160:163],0
M v[72:75],a[116:119],a[164:167],v[72:75]
M v[76:79],a[124:127],a[164:167],0
M v[76:79],a[120:123],a[160:163],v[76:79]
M v[80:83],a[128:131],a[160:163],0
M v[80:83],a[132:135],a[164:167],v[80:83]
M v[84:87],a[140:143],a[164:167],0
M v[84:87],a[136:139],a[160:163],v[84:87]
M v[88:91],a[144:147],a[160:163],0
M v[88:91],a[148:151],a[164:167],v[88:91]
s_waitcnt lgkmcnt(0)
M v[92:95],a[156:159],a[164:167],0
s_waitcnt vmcnt(12)
M v[92:95],a[152:155],a[160:163],v[92:95]
s_barrier
M v[96:99],a[96:99],a[168:171],0
SA m0,s23,0
R a[160:163],v5,16384
R a[164:167],v6,16384
M v[96:99],a[100:103],a[172:175],v[96:99]
buffer_load_dwordx4 v8, s[16:19], s21 offen offset:0  nt lds
M v[100:103],a[108:111],a[172:175],0
v_lshlrev_b32 v26, 7, v0
v_and_b32 v27, 48, v0
M v[100:103],a[104:107],a[168:171],v[100:103]
v_lshl_add_u32 v26, v27, 24, v26
M v[104:107],a[112:115],a[168:171],0
buffer_load_dwordx4 v9, s[16:19], s21 offen offset:1024  nt lds
M v[104:107],a[116:119],a[172:175],v[104:107]
M v[108:111],a[124:127],a[172:175],0
M v[108:111],a[120:123],a[168:171],v[108:111]
buffer_load_dwordx4 v10, s[16:19], s21 offen offset:2048  nt lds
M v[112:115],a[128:131],a[168:171],0
M v[112:115],a[132:135],a[172:175],v[112:115]
M v[116:119],a[140:143],a[172:175],0
M v[116:119],a[136:139],a[168:171],v[116:119]
buffer_load_dwordx4 v11, s[16:19], s21 offen offset:3072  nt lds
M v[120:123],a[144:147],a[168:171],0
SA s21,s21,128
M v[120:123],a[148:151],a[172:175],v[120:123]
s_waitcnt lgkmcnt(0)
M v[124:127],a[156:159],a[172:175],0
SA m0,s24,49152
M v[124:127],a[152:155],a[168:171],v[124:127]
buffer_load_dwordx4 v12, s[48:51], s22 offen offset:0   lds
M v[128:131],a[96:99],a[160:163],0
R a[168:171],v5,18432
R a[172:175],v6,18432
M v[128:131],a[100:103],a[164:167],v[128:131]
buffer_load_dwordx4 v13, s[48:51], s22 offen offset:1024   lds
M v[132:135],a[108:111],a[164:167],0
M v[132:135],a[104:107],a[160:163],v[132:135]
M v[136:139],a[112:115],a[160:163],0
M v[136:139],a[116:119],a[164:167],v[136:139]
buffer_load_dwordx4 v14, s[48:51], s22 offen offset:2048   lds
M v[140:143],a[124:127],a[164:167],0
M v[140:143],a[120:123],a[160:163],v[140:143]
M v[144:147],a[128:131],a[160:163],0
buffer_load_dwordx4 v15, s[48:51], s22 offen offset:3072   lds
M v[144:147],a[132:135],a[164:167],v[144:147]
s_sub_u32 s22, s22, 1048448
M v[148:151],a[140:143],a[164:167],0
M v[148:151],a[136:139],a[160:163],v[148:151]
M v[152:155],a[144:147],a[160:163],0
M v[152:155],a[148:151],a[164:167],v[152:155]
s_waitcnt lgkmcnt(0)
M v[156:159],a[156:159],a[164:167],0
s_waitcnt vmcnt(12)
M v[156:159],a[152:155],a[160:163],v[156:159]
s_barrier
M v[160:163],a[96:99],a[168:171],0
SA m0,s23,16384
R a[160:163],v5,20480
R a[164:167],v6,20480
M v[160:163],a[100:103],a[172:175],v[160:163]
T a[32:33],v1,32768
T a[34:35],v1,33792
M v[164:167],a[108:111],a[172:175],0
T a[36:37],v1,40960
T a[38:39],v1,41984
M v[164:167],a[104:107],a[168:171],v[164:167]
T a[40:41],v2,32768
T a[42:43],v2,33792
M v[168:171],a[112:115],a[168:171],0
T a[44:45],v2,40960
T a[46:47],v2,41984
M v[168:171],a[116:119],a[172:175],v[168:171]
buffer_load_dwordx4 v8, s[16:19], s21 offen offset:0  nt lds
M v[172:175],a[124:127],a[172:175],0
s_nop 0
T a[48:49],v3,32768
T a[50:51],v3,33792
M v[172:175],a[120:123],a[168:171],v[172:175]
buffer_load_dwordx4 v9, s[16:19], s21 offen offset:1024  nt lds
M v[176:179],a[128:131],a[168:171],0
s_nop 0
T a[52:53],v3,40960
T a[54:55],v3,41984
M v[176:179],a[132:135],a[172:175],v[176:179]
T a[56:57],v4,32768
T a[58:59],v4,33792
M v[180:183],a[140:143],a[172:175],0
buffer_load_dwordx4 v10, s[16:19], s21 offen offset:2048  nt lds
M v[180:183],a[136:139],a[168:171],v[180:183]
s_nop 0
T a[60:61],v4,40960
T a[62:63],v4,41984
M v[184:187],a[144:147],a[168:171],0
buffer_load_dwordx4 v11, s[16:19], s21 offen offset:3072  nt lds
M v[184:187],a[148:151],a[172:175],v[184:187]
s_waitcnt lgkmcnt(15)
s_nop 0
T a[64:65],v1,49152
T a[66:67],v1,50176
M v[188:191],a[156:159],a[172:175],0
SA s21,s21,524160
T a[68:69],v1,57344
T a[70:71],v1,58368
M v[188:191],a[152:155],a[168:171],v[188:191]
SA m0,s24,0
M v[192:195],a[96:99],a[160:163],0
R a[168:171],v5,22528
R a[172:175],v6,22528
M v[192:195],a[100:103],a[164:167],v[192:195]
T a[72:73],v2,49152
T a[74:75],v2,50176
M v[196:199],a[108:111],a[164:167],0
T a[76:77],v2,57344
T a[78:79],v2,58368
M v[196:199],a[104:107],a[160:163],v[196:199]
T a[80:81],v3,49152
T a[82:83],v3,50176
M v[200:203],a[112:115],a[160:163],0
buffer_load_dwordx4 v12, s[48:51], s22 offen offset:0   lds
M v[200:203],a[116:119],a[164:167],v[200:203]
s_nop 0
T a[84:85],v3,57344
T a[86:87],v3,58368
M v[204:207],a[124:127],a[164:167],0
T a[88:89],v4,49152
T a[90:91],v4,50176
M v[204:207],a[120:123],a[160:163],v[204:207]
buffer_load_dwordx4 v13, s[48:51], s22 offen offset:1024   lds
M v[208:211],a[128:131],a[160:163],0
s_nop 0
T a[92:93],v4,57344
T a[94:95],v4,58368
M v[208:211],a[132:135],a[164:167],v[208:211]
buffer_load_dwordx4 v14, s[48:51], s22 offen offset:2048   lds
M v[212:215],a[140:143],a[164:167],0
buffer_load_dwordx4 v15, s[48:51], s22 offen offset:3072   lds
M v[212:215],a[136:139],a[160:163],v[212:215]
SA s22,s22,1048576
M v[216:219],a[144:147],a[160:163],0
M v[216:219],a[148:151],a[164:167],v[216:219]
s_waitcnt lgkmcnt(12)
M v[220:223],a[156:159],a[164:167],0
s_waitcnt vmcnt(12) lgkmcnt(0)
M v[220:223],a[152:155],a[160:163],v[220:223]
s_barrier
M v[224:227],a[96:99],a[168:171],0
SA m0,s23,32768
R a[160:163],v5,32768
R a[164:167],v6,32768
M v[224:227],a[100:103],a[172:175],v[224:227]
buffer_load_dwordx4 v8, s[16:19], s21 offen offset:0  nt lds
M v[228:231],a[108:111],a[172:175],0
M v[228:231],a[104:107],a[168:171],v[228:231]
M v[232:235],a[112:115],a[168:171],0
buffer_load_dwordx4 v9, s[16:19], s21 offen offset:1024  nt lds
M v[232:235],a[116:119],a[172:175],v[232:235]
M v[236:239],a[124:127],a[172:175],0
M v[236:239],a[120:123],a[168:171],v[236:239]
buffer_load_dwordx4 v10, s[16:19], s21 offen offset:2048  nt lds
M v[240:243],a[128:131],a[168:171],0
M v[240:243],a[132:135],a[172:175],v[240:243]
M v[244:247],a[140:143],a[172:175],0
buffer_load_dwordx4 v11, s[16:19], s21 offen offset:3072  nt lds
M v[244:247],a[136:139],a[168:171],v[244:247]
SA s21,s21,128
M v[248:251],a[144:147],a[168:171],0
M v[248:251],a[148:151],a[172:175],v[248:251]
s_waitcnt lgkmcnt(0)
M v[252:255],a[156:159],a[172:175],0
M v[252:255],a[152:155],a[168:171],v[252:255]
M a[0:3],a[32:35],a[160:163],a[0:3]
R a[168:171],v5,34816
R a[172:175],v6,34816
M a[0:3],a[36:39],a[164:167],a[0:3]
T a[96:97],v1,0
T a[98:99],v1,1024
M a[4:7],a[44:47],a[164:167],a[4:7]
SA m0,s24,16384
M a[4:7],a[40:43],a[160:163],a[4:7]
buffer_load_dwordx4 v12, s[48:51], s22 offen offset:0   lds
M a[8:11],a[48:51],a[160:163],a[8:11]
M a[8:11],a[52:55],a[164:167],a[8:11]
M a[12:15],a[60:63],a[164:167],a[12:15]
s_nop 0
T a[100:101],v1,8192
T a[102:103],v1,9216
M a[12:15],a[56:59],a[160:163],a[12:15]
M a[16:19],a[64:67],a[160:163],a[16:19]
buffer_load_dwordx4 v13, s[48:51], s22 offen offset:1024   lds
M a[16:19],a[68:71],a[164:167],a[16:19]
M a[20:23],a[76:79],a[164:167],a[20:23]
M a[20:23],a[72:75],a[160:163],a[20:23]
s_nop 0
T a[104:105],v2,0
T a[106:107],v2,1024
M a[24:27],a[80:83],a[160:163],a[24:27]
M a[24:27],a[84:87],a[164:167],a[24:27]
s_waitcnt lgkmcnt(6)
buffer_load_dwordx4 v14, s[48:51], s22 offen offset:2048   lds
M a[28:31],a[92:95],a[164:167],a[28:31]
M a[28:31],a[88:91],a[160:163],a[28:31]
M v[60:63],a[88:91],a[168:171],v[60:63]
R a[160:163],v5,36864
R a[164:167],v6,36864
M v[60:63],a[92:95],a[172:175],v[60:63]
T a[108:109],v2,8192
T a[110:111],v2,9216
M v[56:59],a[84:87],a[172:175],v[56:59]
buffer_load_dwordx4 v15, s[48:51], s22 offen offset:3072   lds
M v[56:59],a[80:83],a[168:171],v[56:59]
s_sub_u32 s22, s22, 1048448
M v[52:55],a[72:75],a[168:171],v[52:55]
M v[52:55],a[76:79],a[172:175],v[52:55]
s_nop 0
T a[112:113],v3,0
T a[114:115],v3,1024
M v[48:51],a[68:71],a[172:175],v[48:51]
SA m0,s23,49152
M v[48:51],a[64:67],a[168:171],v[48:51]
buffer_load_dwordx4 v8, s[16:19], s21 offen offset:0  nt lds
M v[44:47],a[56:59],a[168:171],v[44:47]
M v[44:47],a[60:63],a[172:175],v[44:47]
M v[40:43],a[52:55],a[172:175],v[40:43]
s_nop 0
T a[116:117],v3,8192
T a[118:119],v3,9216
M v[40:43],a[48:51],a[168:171],v[40:43]
M v[36:39],a[40:43],a[168:171],v[36:39]
buffer_load_dwordx4 v9, s[16:19], s21 offen offset:1024  nt lds
M v[36:39],a[44:47],a[172:175],v[36:39]
s_waitcnt lgkmcnt(6)
M v[32:35],a[36:39],a[172:175],v[32:35]
M v[32:35],a[32:35],a[168:171],v[32:35]
s_nop 0
T a[120:121],v4,0
T a[122:123],v4,1024
M v[64:67],a[32:35],a[160:163],v[64:67]
R a[168:171],v5,38912
R a[172:175],v6,38912
M v[64:67],a[36:39],a[164:167],v[64:67]
buffer_load_dwordx4 v10, s[16:19], s21 offen offset:2048  nt lds
M v[68:71],a[44:47],a[164:167],v[68:71]
M v[68:71],a[40:43],a[160:163],v[68:71]
M v[72:75],a[48:51],a[160:163],v[72:75]
s_nop 0
T a[124:125],v4,8192
T a[126:127],v4,9216
M v[72:75],a[52:55],a[164:167],v[72:75]
M v[76:79],a[60:63],a[164:167],v[76:79]
buffer_load_dwordx4 v11, s[16:19], s21 offen offset:3072  nt lds
M v[76:79],a[56:59],a[160:163],v[76:79]
SA s21,s21,524160
M v[80:83],a[64:67],a[160:163],v[80:83]
M v[80:83],a[68:71],a[164:167],v[80:83]
M v[84:87],a[76:79],a[164:167],v[84:87]
M v[84:87],a[72:75],a[160:163],v[84:87]
M v[88:91],a[80:83],a[160:163],v[88:91]
M v[88:91],a[84:87],a[164:167],v[88:91]
s_waitcnt lgkmcnt(2)
M v[92:95],a[92:95],a[164:167],v[92:95]
s_waitcnt vmcnt(16) lgkmcnt(0)
M v[92:95],a[88:91],a[160:163],v[92:95]
s_barrier
M v[124:127],a[88:91],a[168:171],v[124:127]
R a[160:163],v5,49152
R a[164:167],v6,49152
M v[124:127],a[92:95],a[172:175],v[124:127]
M v[120:123],a[84:87],a[172:175],v[120:123]
SA m0,s24,32768
T a[128:129],v1,16384
T a[130:131],v1,17408
M v[120:123],a[80:83],a[168:171],v[120:123]
buffer_load_dwordx4 v12, s[48:51], s22 offen offset:0   lds
M v[116:119],a[72:75],a[168:171],v[116:119]
M v[116:119],a[76:79],a[172:175],v[116:119]
M v[112:115],a[68:71],a[172:175],v[112:115]
M v[112:115],a[64:67],a[168:171],v[112:115]
M v[108:111],a[56:59],a[168:171],v[108:111]
M v[108:111],a[60:63],a[172:175],v[108:111]
s_nop 0
T a[132:133],v1,24576
T a[134:135],v1,25600
M v[104:107],a[52:55],a[172:175],v[104:107]
buffer_load_dwordx4 v13, s[48:51], s22 offen offset:1024   lds
M v[104:107],a[48:51],a[168:171],v[104:107]
M v[100:103],a[40:43],a[168:171],v[100:103]
M v[100:103],a[44:47],a[172:175],v[100:103]
s_waitcnt lgkmcnt(4)
M v[96:99],a[36:39],a[172:175],v[96:99]
M v[96:99],a[32:35],a[168:171],v[96:99]
M v[128:131],a[32:35],a[160:163],v[128:131]
R a[168:171],v5,51200
R a[172:175],v6,51200
M v[128:131],a[36:39],a[164:167],v[128:131]
T a[136:137],v2,16384
T a[138:139],v2,17408
M v[132:135],a[44:47],a[164:167],v[132:135]
buffer_load_dwordx4 v14, s[48:51], s22 offen offset:2048   lds
M v[132:135],a[40:43],a[160:163],v[132:135]
M v[136:139],a[48:51],a[160:163],v[136:139]
M v[136:139],a[52:55],a[164:167],v[136:139]
M v[140:143],a[60:63],a[164:167],v[140:143]
M v[140:143],a[56:59],a[160:163],v[140:143]
s_nop 0
T a[140:141],v2,24576
T a[142:143],v2,25600
M v[144:147],a[64:67],a[160:163],v[144:147]
buffer_load_dwordx4 v15, s[48:51], s22 offen offset:3072   lds
M v[144:147],a[68:71],a[164:167],v[144:147]
SA s22,s22,1048576
M v[148:151],a[76:79],a[164:167],v[148:151]
M v[148:151],a[72:75],a[160:163],v[148:151]
M v[152:155],a[80:83],a[160:163],v[152:155]
M v[152:155],a[84:87],a[164:167],v[152:155]
s_waitcnt lgkmcnt(4)
M v[156:159],a[92:95],a[164:167],v[156:159]
SA m0,s23,0
T a[144:145],v3,16384
T a[146:147],v3,17408
M v[156:159],a[88:91],a[160:163],v[156:159]
buffer_load_dwordx4 v8, s[16:19], s21 offen offset:0  nt lds
M v[188:191],a[88:91],a[168:171],v[188:191]
R a[160:163],v5,53248
R a[164:167],v6,53248
M v[188:191],a[92:95],a[172:175],v[188:191]
M v[184:187],a[84:87],a[172:175],v[184:187]
M v[184:187],a[80:83],a[168:171],v[184:187]
M v[180:183],a[72:75],a[168:171],v[180:183]
M v[180:183],a[76:79],a[172:175],v[180:183]
s_nop 0
T a[148:149],v3,24576
T a[150:151],v3,25600
M v[176:179],a[68:71],a[172:175],v[176:179]
buffer_load_dwordx4 v9, s[16:19], s21 offen offset:1024  nt lds
M v[176:179],a[64:67],a[168:171],v[176:179]
M v[172:175],a[56:59],a[168:171],v[172:175]
M v[172:175],a[60:63],a[172:175],v[172:175]
M v[168:171],a[52:55],a[172:175],v[168:171]
M v[168:171],a[48:51],a[168:171],v[168:171]
M v[164:167],a[40:43],a[168:171],v[164:167]
s_nop 0
T a[152:153],v4,16384
T a[154:155],v4,17408
M v[164:167],a[44:47],a[172:175],v[164:167]
s_waitcnt lgkmcnt(4)
buffer_load_dwordx4 v10, s[16:19], s21 offen offset:2048  nt lds
M v[160:163],a[36:39],a[172:175],v[160:163]
M v[160:163],a[32:35],a[168:171],v[160:163]
M v[192:195],a[32:35],a[160:163],v[192:195]
R a[168:171],v5,55296
R a[172:175],v6,55296
M v[192:195],a[36:39],a[164:167],v[192:195]
M v[196:199],a[44:47],a[164:167],v[196:199]
M v[196:199],a[40:43],a[160:163],v[196:199]
s_nop 0
T a[156:157],v4,24576
T a[158:159],v4,25600
M v[200:203],a[48:51],a[160:163],v[200:203]
buffer_load_dwordx4 v11, s[16:19], s21 offen offset:3072  nt lds
M v[200:203],a[52:55],a[164:167],v[200:203]
SA s21,s21,128
M v[204:207],a[60:63],a[164:167],v[204:207]
M v[204:207],a[56:59],a[160:163],v[204:207]
M v[208:211],a[64:67],a[160:163],v[208:211]
M v[208:211],a[68:71],a[164:167],v[208:211]
M v[212:215],a[76:79],a[164:167],v[212:215]
M v[212:215],a[72:75],a[160:163],v[212:215]
M v[216:219],a[80:83],a[160:163],v[216:219]
M v[216:219],a[84:87],a[164:167],v[216:219]
s_waitcnt lgkmcnt(2)
M v[220:223],a[92:95],a[164:167],v[220:223]
s_waitcnt vmcnt(16) lgkmcnt(0)
M v[220:223],a[88:91],a[160:163],v[220:223]
s_barrier
M v[252:255],a[88:91],a[168:171],v[252:255]
R a[160:163],v5,0
R a[164:167],v6,0
M v[252:255],a[92:95],a[172:175],v[252:255]
v_min_u32 v16, 1, v0
v_lshlrev_b32 v16, 29, v16
M v[248:251],a[84:87],a[172:175],v[248:251]
v_or_b32 v16, s39, v16
v_mov_b32 v17, 1
M v[248:251],a[80:83],a[168:171],v[248:251]
buffer_store_dword v17, v16, s[12:15], s38 offen sc1
M v[244:247],a[72:75],a[168:171],v[244:247]
M v[244:247],a[76:79],a[172:175],v[244:247]
M v[240:243],a[68:71],a[172:175],v[240:243]
M v[240:243],a[64:67],a[168:171],v[240:243]
M v[236:239],a[56:59],a[168:171],v[236:239]
M v[236:239],a[60:63],a[172:175],v[236:239]
M v[232:235],a[52:55],a[172:175],v[232:235]
M v[232:235],a[48:51],a[168:171],v[232:235]
M v[228:231],a[40:43],a[168:171],v[228:231]
M v[228:231],a[44:47],a[172:175],v[228:231]
s_waitcnt lgkmcnt(0)
M v[224:227],a[36:39],a[172:175],v[224:227]
M v[224:227],a[32:35],a[168:171],v[224:227]
M a[0:3],a[96:99],a[160:163],a[0:3]
L_w_kv01:
s_cbranch_execz L_w_kv05
R a[168:171],v5,2048
R a[172:175],v6,2048
M a[0:3],a[100:103],a[164:167],a[0:3]
T a[32:33],v1,32768
T a[34:35],v1,33792
M a[4:7],a[108:111],a[164:167],a[4:7]
SA m0,s24,49152
M a[4:7],a[104:107],a[160:163],a[4:7]
buffer_load_dwordx4 v12, s[48:51], s22 offen offset:0   lds
M a[8:11],a[112:115],a[160:163],a[8:11]
M a[8:11],a[116:119],a[164:167],a[8:11]
M a[12:15],a[124:127],a[164:167],a[12:15]
s_nop 0
T a[36:37],v1,40960
T a[38:39],v1,41984
M a[12:15],a[120:123],a[160:163],a[12:15]
M a[16:19],a[128:131],a[160:163],a[16:19]
buffer_load_dwordx4 v13, s[48:51], s22 offen offset:1024   lds
M a[16:19],a[132:135],a[164:167],a[16:19]
M a[20:23],a[140:143],a[164:167],a[20:23]
M a[20:23],a[136:139],a[160:163],a[20:23]
s_nop 0
T a[40:41],v2,32768
T a[42:43],v2,33792
M a[24:27],a[144:147],a[160:163],a[24:27]
M a[24:27],a[148:151],a[164:167],a[24:27]
s_waitcnt lgkmcnt(6)
buffer_load_dwordx4 v14, s[48:51], s22 offen offset:2048   lds
M a[28:31],a[156:159],a[164:167],a[28:31]
M a[28:31],a[152:155],a[160:163],a[28:31]
M v[60:63],a[152:155],a[168:171],v[60:63]
R a[160:163],v5,4096
R a[164:167],v6,4096
M v[60:63],a[156:159],a[172:175],v[60:63]
T a[44:45],v2,40960
T a[46:47],v2,41984
M v[56:59],a[148:151],a[172:175],v[56:59]
buffer_load_dwordx4 v15, s[48:51], s22 offen offset:3072   lds
M v[56:59],a[144:147],a[168:171],v[56:59]
s_sub_u32 s22, s22, 1048448
M v[52:55],a[136:139],a[168:171],v[52:55]
M v[52:55],a[140:143],a[172:175],v[52:55]
s_nop 0
T a[48:49],v3,32768
T a[50:51],v3,33792
M v[48:51],a[132:135],a[172:175],v[48:51]
SA m0,s23,16384
M v[48:51],a[128:131],a[168:171],v[48:51]
buffer_load_dwordx4 v8, s[16:19], s21 offen offset:0  nt lds
M v[44:47],a[120:123],a[168:171],v[44:47]
M v[44:47],a[124:127],a[172:175],v[44:47]
M v[40:43],a[116:119],a[172:175],v[40:43]
s_nop 0
T a[52:53],v3,40960
T a[54:55],v3,41984
M v[40:43],a[112:115],a[168:171],v[40:43]
M v[36:39],a[104:107],a[168:171],v[36:39]
buffer_load_dwordx4 v9, s[16:19], s21 offen offset:1024  nt lds
M v[36:39],a[108:111],a[172:175],v[36:39]
s_waitcnt lgkmcnt(6)
M v[32:35],a[100:103],a[172:175],v[32:35]
M v[32:35],a[96:99],a[168:171],v[32:35]
s_nop 0
T a[56:57],v4,32768
T a[58:59],v4,33792
M v[64:67],a[96:99],a[160:163],v[64:67]
R a[168:171],v5,6144
R a[172:175],v6,6144
M v[64:67],a[100:103],a[164:167],v[64:67]
buffer_load_dwordx4 v10, s[16:19], s21 offen offset:2048  nt lds
M v[68:71],a[108:111],a[164:167],v[68:71]
M v[68:71],a[104:107],a[160:163],v[68:71]
M v[72:75],a[112:115],a[160:163],v[72:75]
s_nop 0
T a[60:61],v4,40960
T a[62:63],v4,41984
M v[72:75],a[116:119],a[164:167],v[72:75]
M v[76:79],a[124:127],a[164:167],v[76:79]
buffer_load_dwordx4 v11, s[16:19], s21 offen offset:3072  nt lds
M v[76:79],a[120:123],a[160:163],v[76:79]
SA s21,s21,524160
M v[80:83],a[128:131],a[160:163],v[80:83]
M v[80:83],a[132:135],a[164:167],v[80:83]
M v[84:87],a[140:143],a[164:167],v[84:87]
M v[84:87],a[136:139],a[160:163],v[84:87]
s_and_b32 s86, s41, 7
M v[88:91],a[144:147],a[160:163],v[88:91]
s_mul_i32 s86, s86, 14
s_lshr_b32 s64, s41, 3
s_mul_i32 s64, s64, 7
M v[88:91],a[148:151],a[164:167],v[88:91]
s_waitcnt lgkmcnt(2)
SA s86,s86,s64
s_min_u32 s64, s31, 6
M v[92:95],a[156:159],a[164:167],v[92:95]
s_waitcnt vmcnt(17) lgkmcnt(0)
SA s86,s86,s64
s_sub_u32 s64, 6, s31
M v[92:95],a[152:155],a[160:163],v[92:95]
s_barrier
M v[124:127],a[152:155],a[168:171],v[124:127]
R a[160:163],v5,16384
R a[164:167],v6,16384
M v[124:127],a[156:159],a[172:175],v[124:127]
s_and_b32 s88, s64, 536870912
s_mul_i32 s87, s20, 7168
M v[120:123],a[148:151],a[172:175],v[120:123]
SA m0,s24,0
T a[64:65],v1,49152
T a[66:67],v1,50176
M v[120:123],a[144:147],a[168:171],v[120:123]
buffer_load_dwordx4 v12, s[48:51], s22 offen offset:0   lds
M v[116:119],a[136:139],a[168:171],v[116:119]
SA s87,s87,131072
M v[116:119],a[140:143],a[172:175],v[116:119]
s_cmp_lt_u32 s20, 2
M v[112:115],a[132:135],a[172:175],v[112:115]
s_cselect_b64 s[72:73], s[80:81], s[82:83]
M v[112:115],a[128:131],a[168:171],v[112:115]
s_mov_b32 s60, s72
M v[108:111],a[120:123],a[168:171],v[108:111]
s_and_b32 s61, s73, 0xffff
M v[108:111],a[124:127],a[172:175],v[108:111]
s_mov_b32 s62, 1605632
T a[68:69],v1,57344
T a[70:71],v1,58368
M v[104:107],a[116:119],a[172:175],v[104:107]
s_mov_b32 s63, 0x20000
buffer_load_dwordx4 v13, s[48:51], s22 offen offset:1024   lds
M v[104:107],a[112:115],a[168:171],v[104:107]
s_mov_b32 s68, s84
M v[100:103],a[104:107],a[168:171],v[100:103]
s_and_b32 s69, s85, 0xffff
s_mov_b32 s70, 1605632
s_mov_b32 s71, 0x20000
M v[100:103],a[108:111],a[172:175],v[100:103]
s_waitcnt lgkmcnt(4)
s_lshl_b32 s89, s86, 5
M v[96:99],a[100:103],a[172:175],v[96:99]
s_and_b32 s64, s20, 1
M v[96:99],a[96:99],a[168:171],v[96:99]
s_mul_i32 s64, s64, 802816
M v[128:131],a[96:99],a[160:163],v[128:131]
SA s89,s89,s64
R a[168:171],v5,18432
R a[172:175],v6,18432
M v[128:131],a[100:103],a[164:167],v[128:131]
T a[72:73],v2,49152
T a[74:75],v2,50176
M v[132:135],a[108:111],a[164:167],v[132:135]
buffer_load_dwordx4 v14, s[48:51], s22 offen offset:2048   lds
M v[132:135],a[104:107],a[160:163],v[132:135]
v_lshrrev_b32 v28, 1, v0
v_mul_u32_u24 v28, 3584, v28
M v[136:139],a[112:115],a[160:163],v[136:139]
v_and_b32 v29, 1, v0
v_lshl_add_u32 v25, v29, 4, v28
M v[136:139],a[116:119],a[164:167],v[136:139]
v_or_b32 v25, s88, v25
M v[140:143],a[124:127],a[164:167],v[140:143]
M v[140:143],a[120:123],a[160:163],v[140:143]
s_nop 0
T a[76:77],v2,57344
T a[78:79],v2,58368
M v[144:147],a[128:131],a[160:163],v[144:147]
buffer_load_dwordx4 v15, s[48:51], s22 offen offset:3072   lds
M v[144:147],a[132:135],a[164:167],v[144:147]
SA s22,s22,1048576
M v[148:151],a[140:143],a[164:167],v[148:151]
M v[148:151],a[136:139],a[160:163],v[148:151]
M v[152:155],a[144:147],a[160:163],v[152:155]
M v[152:155],a[148:151],a[164:167],v[152:155]
s_waitcnt lgkmcnt(4)
M v[156:159],a[156:159],a[164:167],v[156:159]
SA m0,s23,32768
T a[80:81],v3,49152
T a[82:83],v3,50176
M v[156:159],a[152:155],a[160:163],v[156:159]
buffer_load_dwordx4 v8, s[16:19], s21 offen offset:0  nt lds
M v[188:191],a[152:155],a[168:171],v[188:191]
R a[160:163],v5,20480
R a[164:167],v6,20480
M v[188:191],a[156:159],a[172:175],v[188:191]
M v[184:187],a[148:151],a[172:175],v[184:187]
M v[184:187],a[144:147],a[168:171],v[184:187]
M v[180:183],a[136:139],a[168:171],v[180:183]
M v[180:183],a[140:143],a[172:175],v[180:183]
s_nop 0
T a[84:85],v3,57344
T a[86:87],v3,58368
M v[176:179],a[132:135],a[172:175],v[176:179]
buffer_load_dwordx4 v9, s[16:19], s21 offen offset:1024  nt lds
M v[176:179],a[128:131],a[168:171],v[176:179]
M v[172:175],a[120:123],a[168:171],v[172:175]
M v[172:175],a[124:127],a[172:175],v[172:175]
M v[168:171],a[116:119],a[172:175],v[168:171]
M v[168:171],a[112:115],a[168:171],v[168:171]
M v[164:167],a[104:107],a[168:171],v[164:167]
s_nop 0
T a[88:89],v4,49152
T a[90:91],v4,50176
M v[164:167],a[108:111],a[172:175],v[164:167]
s_waitcnt lgkmcnt(4)
buffer_load_dwordx4 v10, s[16:19], s21 offen offset:2048  nt lds
M v[160:163],a[100:103],a[172:175],v[160:163]
M v[160:163],a[96:99],a[168:171],v[160:163]
M v[192:195],a[96:99],a[160:163],v[192:195]
R a[168:171],v5,22528
R a[172:175],v6,22528
M v[192:195],a[100:103],a[164:167],v[192:195]
M v[196:199],a[108:111],a[164:167],v[196:199]
M v[196:199],a[104:107],a[160:163],v[196:199]
s_nop 0
T a[92:93],v4,57344
T a[94:95],v4,58368
M v[200:203],a[112:115],a[160:163],v[200:203]
buffer_load_dwordx4 v11, s[16:19], s21 offen offset:3072  nt lds
M v[200:203],a[116:119],a[164:167],v[200:203]
SA s21,s21,128
M v[204:207],a[124:127],a[164:167],v[204:207]
M v[204:207],a[120:123],a[160:163],v[204:207]
M v[208:211],a[128:131],a[160:163],v[208:211]
M v[208:211],a[132:135],a[164:167],v[208:211]
M v[212:215],a[140:143],a[164:167],v[212:215]
M v[212:215],a[136:139],a[160:163],v[212:215]
M v[216:219],a[144:147],a[160:163],v[216:219]
M v[216:219],a[148:151],a[164:167],v[216:219]
s_waitcnt lgkmcnt(2)
M v[220:223],a[156:159],a[164:167],v[220:223]
s_waitcnt vmcnt(17) lgkmcnt(0)
M v[220:223],a[152:155],a[160:163],v[220:223]
s_barrier
M v[252:255],a[152:155],a[168:171],v[252:255]
R a[160:163],v5,32768
R a[164:167],v6,32768
M v[252:255],a[156:159],a[172:175],v[252:255]
M v[248:251],a[148:151],a[172:175],v[248:251]
M v[248:251],a[144:147],a[168:171],v[248:251]
M v[244:247],a[136:139],a[168:171],v[244:247]
M v[244:247],a[140:143],a[172:175],v[244:247]
M v[240:243],a[132:135],a[172:175],v[240:243]
M v[240:243],a[128:131],a[168:171],v[240:243]
M v[236:239],a[120:123],a[168:171],v[236:239]
M v[236:239],a[124:127],a[172:175],v[236:239]
M v[232:235],a[116:119],a[172:175],v[232:235]
M v[232:235],a[112:115],a[168:171],v[232:235]
M v[228:231],a[104:107],a[168:171],v[228:231]
M v[228:231],a[108:111],a[172:175],v[228:231]
s_waitcnt lgkmcnt(0)
M v[224:227],a[100:103],a[172:175],v[224:227]
M v[224:227],a[96:99],a[168:171],v[224:227]
M a[0:3],a[32:35],a[160:163],a[0:3]
R a[168:171],v5,34816
R a[172:175],v6,34816
M a[0:3],a[36:39],a[164:167],a[0:3]
T a[96:97],v1,0
T a[98:99],v1,1024
M a[4:7],a[44:47],a[164:167],a[4:7]
SA m0,s24,16384
M a[4:7],a[40:43],a[160:163],a[4:7]
buffer_load_dwordx4 v12, s[48:51], s22 offen offset:0   lds
M a[8:11],a[48:51],a[160:163],a[8:11]
M a[8:11],a[52:55],a[164:167],a[8:11]
M a[12:15],a[60:63],a[164:167],a[12:15]
s_nop 0
T a[100:101],v1,8192
T a[102:103],v1,9216
M a[12:15],a[56:59],a[160:163],a[12:15]
M a[16:19],a[64:67],a[160:163],a[16:19]
buffer_load_dwordx4 v13, s[48:51], s22 offen offset:1024   lds
M a[16:19],a[68:71],a[164:167],a[16:19]
M a[20:23],a[76:79],a[164:167],a[20:23]
M a[20:23],a[72:75],a[160:163],a[20:23]
s_nop 0
T a[104:105],v2,0
T a[106:107],v2,1024
M a[24:27],a[80:83],a[160:163],a[24:27]
M a[24:27],a[84:87],a[164:167],a[24:27]
s_waitcnt lgkmcnt(6)
buffer_load_dwordx4 v14, s[48:51], s22 offen offset:2048   lds
M a[28:31],a[92:95],a[164:167],a[28:31]
M a[28:31],a[88:91],a[160:163],a[28:31]
M v[60:63],a[88:91],a[168:171],v[60:63]
R a[160:163],v5,36864
R a[164:167],v6,36864
M v[60:63],a[92:95],a[172:175],v[60:63]
T a[108:109],v2,8192
T a[110:111],v2,9216
M v[56:59],a[84:87],a[172:175],v[56:59]
buffer_load_dwordx4 v15, s[48:51], s22 offen offset:3072   lds
M v[56:59],a[80:83],a[168:171],v[56:59]
s_sub_u32 s22, s22, 1048448
M v[52:55],a[72:75],a[168:171],v[52:55]
M v[52:55],a[76:79],a[172:175],v[52:55]
s_nop 0
T a[112:113],v3,0
T a[114:115],v3,1024
M v[48:51],a[68:71],a[172:175],v[48:51]
SA m0,s23,49152
M v[48:51],a[64:67],a[168:171],v[48:51]
buffer_load_dwordx4 v8, s[16:19], s21 offen offset:0  nt lds
M v[44:47],a[56:59],a[168:171],v[44:47]
M v[44:47],a[60:63],a[172:175],v[44:47]
M v[40:43],a[52:55],a[172:175],v[40:43]
s_nop 0
T a[116:117],v3,8192
T a[118:119],v3,9216
M v[40:43],a[48:51],a[168:171],v[40:43]
M v[36:39],a[40:43],a[168:171],v[36:39]
buffer_load_dwordx4 v9, s[16:19], s21 offen offset:1024  nt lds
M v[36:39],a[44:47],a[172:175],v[36:39]
s_waitcnt lgkmcnt(6)
M v[32:35],a[36:39],a[172:175],v[32:35]
M v[32:35],a[32:35],a[168:171],v[32:35]
s_nop 0
T a[120:121],v4,0
T a[122:123],v4,1024
M v[64:67],a[32:35],a[160:163],v[64:67]
R a[168:171],v5,38912
R a[172:175],v6,38912
M v[64:67],a[36:39],a[164:167],v[64:67]
buffer_load_dwordx4 v10, s[16:19], s21 offen offset:2048  nt lds
M v[68:71],a[44:47],a[164:167],v[68:71]
M v[68:71],a[40:43],a[160:163],v[68:71]
M v[72:75],a[48:51],a[160:163],v[72:75]
s_nop 0
T a[124:125],v4,8192
T a[126:127],v4,9216
M v[72:75],a[52:55],a[164:167],v[72:75]
M v[76:79],a[60:63],a[164:167],v[76:79]
buffer_load_dwordx4 v11, s[16:19], s21 offen offset:3072  nt lds
M v[76:79],a[56:59],a[160:163],v[76:79]
SA s21,s21,524160
M v[80:83],a[64:67],a[160:163],v[80:83]
M v[80:83],a[68:71],a[164:167],v[80:83]
M v[84:87],a[76:79],a[164:167],v[84:87]
M v[84:87],a[72:75],a[160:163],v[84:87]
M v[88:91],a[80:83],a[160:163],v[88:91]
M v[88:91],a[84:87],a[164:167],v[88:91]
s_waitcnt lgkmcnt(2)
M v[92:95],a[92:95],a[164:167],v[92:95]
s_waitcnt vmcnt(16) lgkmcnt(0)
M v[92:95],a[88:91],a[160:163],v[92:95]
s_barrier
M v[124:127],a[88:91],a[168:171],v[124:127]
R a[160:163],v5,49152
R a[164:167],v6,49152
M v[124:127],a[92:95],a[172:175],v[124:127]
M v[120:123],a[84:87],a[172:175],v[120:123]
SA m0,s24,32768
T a[128:129],v1,16384
T a[130:131],v1,17408
M v[120:123],a[80:83],a[168:171],v[120:123]
buffer_load_dwordx4 v12, s[48:51], s22 offen offset:0   lds
M v[116:119],a[72:75],a[168:171],v[116:119]
v_min_u32 v16, 40, v0
v_lshlrev_b32 v16, 2, v16
M v[116:119],a[76:79],a[172:175],v[116:119]
buffer_load_dword v17, v16, s[12:15], 0 offen sc1
M v[112:115],a[68:71],a[172:175],v[112:115]
M v[112:115],a[64:67],a[168:171],v[112:115]
M v[108:111],a[56:59],a[168:171],v[108:111]
buffer_load_dwordx4 v13, s[48:51], s22 offen offset:1024   lds
M v[108:111],a[60:63],a[172:175],v[108:111]
s_nop 0
T a[132:133],v1,24576
T a[134:135],v1,25600
M v[104:107],a[52:55],a[172:175],v[104:107]
M v[104:107],a[48:51],a[168:171],v[104:107]
M v[100:103],a[40:43],a[168:171],v[100:103]
M v[100:103],a[44:47],a[172:175],v[100:103]
s_waitcnt lgkmcnt(4)
M v[96:99],a[36:39],a[172:175],v[96:99]
buffer_load_dwordx4 v14, s[48:51], s22 offen offset:2048   lds
M v[96:99],a[32:35],a[168:171],v[96:99]
M v[128:131],a[32:35],a[160:163],v[128:131]
R a[168:171],v5,51200
R a[172:175],v6,51200
M v[128:131],a[36:39],a[164:167],v[128:131]
T a[136:137],v2,16384
T a[138:139],v2,17408
M v[132:135],a[44:47],a[164:167],v[132:135]
M v[132:135],a[40:43],a[160:163],v[132:135]
M v[136:139],a[48:51],a[160:163],v[136:139]
buffer_load_dwordx4 v15, s[48:51], s22 offen offset:3072   lds
M v[136:139],a[52:55],a[164:167],v[136:139]
SA s22,s22,1048576
M v[140:143],a[60:63],a[164:167],v[140:143]
M v[140:143],a[56:59],a[160:163],v[140:143]
s_nop 0
T a[140:141],v2,24576
T a[142:143],v2,25600
M v[144:147],a[64:67],a[160:163],v[144:147]
SA m0,s23,0
M v[144:147],a[68:71],a[164:167],v[144:147]
buffer_load_dwordx4 v8, s[16:19], s21 offen offset:0  nt lds
M v[148:151],a[76:79],a[164:167],v[148:151]
M v[148:151],a[72:75],a[160:163],v[148:151]
M v[152:155],a[80:83],a[160:163],v[152:155]
M v[152:155],a[84:87],a[164:167],v[152:155]
s_waitcnt lgkmcnt(4)
M v[156:159],a[92:95],a[164:167],v[156:159]
s_nop 0
T a[144:145],v3,16384
T a[146:147],v3,17408
M v[156:159],a[88:91],a[160:163],v[156:159]
buffer_load_dwordx4 v9, s[16:19], s21 offen offset:1024  nt lds
M v[188:191],a[88:91],a[168:171],v[188:191]
R a[160:163],v5,53248
R a[164:167],v6,53248
M v[188:191],a[92:95],a[172:175],v[188:191]
M v[184:187],a[84:87],a[172:175],v[184:187]
M v[184:187],a[80:83],a[168:171],v[184:187]
M v[180:183],a[72:75],a[168:171],v[180:183]
M v[180:183],a[76:79],a[172:175],v[180:183]
s_nop 0
T a[148:149],v3,24576
T a[150:151],v3,25600
M v[176:179],a[68:71],a[172:175],v[176:179]
buffer_load_dwordx4 v10, s[16:19], s21 offen offset:2048  nt lds
M v[176:179],a[64:67],a[168:171],v[176:179]
M v[172:175],a[56:59],a[168:171],v[172:175]
M v[172:175],a[60:63],a[172:175],v[172:175]
M v[168:171],a[52:55],a[172:175],v[168:171]
buffer_load_dwordx4 v11, s[16:19], s21 offen offset:3072  nt lds
M v[168:171],a[48:51],a[168:171],v[168:171]
SA s21,s21,128
M v[164:167],a[40:43],a[168:171],v[164:167]
s_nop 0
T a[152:153],v4,16384
T a[154:155],v4,17408
M v[164:167],a[44:47],a[172:175],v[164:167]
s_waitcnt lgkmcnt(4)
M v[160:163],a[36:39],a[172:175],v[160:163]
M v[160:163],a[32:35],a[168:171],v[160:163]
SA m0,s87,0
M v[192:195],a[32:35],a[160:163],v[192:195]
R a[168:171],v5,55296
R a[172:175],v6,55296
M v[192:195],a[36:39],a[164:167],v[192:195]
buffer_load_dwordx4 v25, s[60:63], s89 offen offset:0 nt lds
M v[196:199],a[44:47],a[164:167],v[196:199]
SA s89,s89,114688
M v[196:199],a[40:43],a[160:163],v[196:199]
s_nop 0
T a[156:157],v4,24576
T a[158:159],v4,25600
M v[200:203],a[48:51],a[160:163],v[200:203]
M v[200:203],a[52:55],a[164:167],v[200:203]
SA m0,s87,1024
M v[204:207],a[60:63],a[164:167],v[204:207]
buffer_load_dwordx4 v25, s[60:63], s89 offen offset:0 nt lds
M v[204:207],a[56:59],a[160:163],v[204:207]
SA s89,s89,114688
M v[208:211],a[64:67],a[160:163],v[208:211]
M v[208:211],a[68:71],a[164:167],v[208:211]
M v[212:215],a[76:79],a[164:167],v[212:215]
M v[212:215],a[72:75],a[160:163],v[212:215]
M v[216:219],a[80:83],a[160:163],v[216:219]
M v[216:219],a[84:87],a[164:167],v[216:219]
s_waitcnt lgkmcnt(2)
M v[220:223],a[92:95],a[164:167],v[220:223]
s_waitcnt vmcnt(19) lgkmcnt(0)
M v[220:223],a[88:91],a[160:163],v[220:223]
s_barrier
M v[252:255],a[88:91],a[168:171],v[252:255]
R a[160:163],v5,0
R a[164:167],v6,0
M v[252:255],a[92:95],a[172:175],v[252:255]
M v[248:251],a[84:87],a[172:175],v[248:251]
M v[248:251],a[80:83],a[168:171],v[248:251]
M v[244:247],a[72:75],a[168:171],v[244:247]
M v[244:247],a[76:79],a[172:175],v[244:247]
M v[240:243],a[68:71],a[172:175],v[240:243]
M v[240:243],a[64:67],a[168:171],v[240:243]
M v[236:239],a[56:59],a[168:171],v[236:239]
M v[236:239],a[60:63],a[172:175],v[236:239]
M v[232:235],a[52:55],a[172:175],v[232:235]
M v[232:235],a[48:51],a[168:171],v[232:235]
M v[228:231],a[40:43],a[168:171],v[228:231]
M v[228:231],a[44:47],a[172:175],v[228:231]
s_waitcnt lgkmcnt(0)
M v[224:227],a[36:39],a[172:175],v[224:227]
M v[224:227],a[32:35],a[168:171],v[224:227]
M a[0:3],a[96:99],a[160:163],a[0:3]
R a[168:171],v5,2048
R a[172:175],v6,2048
M a[0:3],a[100:103],a[164:167],a[0:3]
T a[32:33],v1,32768
T a[34:35],v1,33792
M a[4:7],a[108:111],a[164:167],a[4:7]
SA m0,s24,49152
M a[4:7],a[104:107],a[160:163],a[4:7]
buffer_load_dwordx4 v12, s[48:51], s22 offen offset:0   lds
M a[8:11],a[112:115],a[160:163],a[8:11]
M a[8:11],a[116:119],a[164:167],a[8:11]
M a[12:15],a[124:127],a[164:167],a[12:15]
s_nop 0
T a[36:37],v1,40960
T a[38:39],v1,41984
M a[12:15],a[120:123],a[160:163],a[12:15]
M a[16:19],a[128:131],a[160:163],a[16:19]
buffer_load_dwordx4 v13, s[48:51], s22 offen offset:1024   lds
M a[16:19],a[132:135],a[164:167],a[16:19]
M a[20:23],a[140:143],a[164:167],a[20:23]
M a[20:23],a[136:139],a[160:163],a[20:23]
s_nop 0
T a[40:41],v2,32768
T a[42:43],v2,33792
M a[24:27],a[144:147],a[160:163],a[24:27]
M a[24:27],a[148:151],a[164:167],a[24:27]
s_waitcnt lgkmcnt(6)
buffer_load_dwordx4 v14, s[48:51], s22 offen offset:2048   lds
M a[28:31],a[156:159],a[164:167],a[28:31]
M a[28:31],a[152:155],a[160:163],a[28:31]
M v[60:63],a[152:155],a[168:171],v[60:63]
R a[160:163],v5,4096
R a[164:167],v6,4096
M v[60:63],a[156:159],a[172:175],v[60:63]
T a[44:45],v2,40960
T a[46:47],v2,41984
M v[56:59],a[148:151],a[172:175],v[56:59]
buffer_load_dwordx4 v15, s[48:51], s22 offen offset:3072   lds
M v[56:59],a[144:147],a[168:171],v[56:59]
s_sub_u32 s22, s22, 1048448
M v[52:55],a[136:139],a[168:171],v[52:55]
M v[52:55],a[140:143],a[172:175],v[52:55]
s_nop 0
T a[48:49],v3,32768
T a[50:51],v3,33792
M v[48:51],a[132:135],a[172:175],v[48:51]
SA m0,s23,16384
M v[48:51],a[128:131],a[168:171],v[48:51]
buffer_load_dwordx4 v8, s[16:19], s21 offen offset:0  nt lds
M v[44:47],a[120:123],a[168:171],v[44:47]
M v[44:47],a[124:127],a[172:175],v[44:47]
M v[40:43],a[116:119],a[172:175],v[40:43]
s_nop 0
T a[52:53],v3,40960
T a[54:55],v3,41984
M v[40:43],a[112:115],a[168:171],v[40:43]
M v[36:39],a[104:107],a[168:171],v[36:39]
buffer_load_dwordx4 v9, s[16:19], s21 offen offset:1024  nt lds
M v[36:39],a[108:111],a[172:175],v[36:39]
s_waitcnt lgkmcnt(6)
M v[32:35],a[100:103],a[172:175],v[32:35]
M v[32:35],a[96:99],a[168:171],v[32:35]
s_nop 0
T a[56:57],v4,32768
L_w_kv02:
s_cbranch_execz L_w_kv06
T a[58:59],v4,33792
M v[64:67],a[96:99],a[160:163],v[64:67]
R a[168:171],v5,6144
R a[172:175],v6,6144
M v[64:67],a[100:103],a[164:167],v[64:67]
buffer_load_dwordx4 v10, s[16:19], s21 offen offset:2048  nt lds
M v[68:71],a[108:111],a[164:167],v[68:71]
M v[68:71],a[104:107],a[160:163],v[68:71]
M v[72:75],a[112:115],a[160:163],v[72:75]
s_nop 0
T a[60:61],v4,40960
T a[62:63],v4,41984
M v[72:75],a[116:119],a[164:167],v[72:75]
M v[76:79],a[124:127],a[164:167],v[76:79]
buffer_load_dwordx4 v11, s[16:19], s21 offen offset:3072  nt lds
M v[76:79],a[120:123],a[160:163],v[76:79]
SA s21,s21,524160
M v[80:83],a[128:131],a[160:163],v[80:83]
M v[80:83],a[132:135],a[164:167],v[80:83]
M v[84:87],a[140:143],a[164:167],v[84:87]
M v[84:87],a[136:139],a[160:163],v[84:87]
M v[88:91],a[144:147],a[160:163],v[88:91]
M v[88:91],a[148:151],a[164:167],v[88:91]
s_waitcnt lgkmcnt(2)
M v[92:95],a[156:159],a[164:167],v[92:95]
s_waitcnt vmcnt(19) lgkmcnt(0)
M v[92:95],a[152:155],a[160:163],v[92:95]
s_barrier
M v[124:127],a[152:155],a[168:171],v[124:127]
R a[160:163],v5,16384
R a[164:167],v6,16384
M v[124:127],a[156:159],a[172:175],v[124:127]
M v[120:123],a[148:151],a[172:175],v[120:123]
SA m0,s24,0
T a[64:65],v1,49152
T a[66:67],v1,50176
M v[120:123],a[144:147],a[168:171],v[120:123]
buffer_load_dwordx4 v12, s[48:51], s22 offen offset:0   lds
M v[116:119],a[136:139],a[168:171],v[116:119]
M v[116:119],a[140:143],a[172:175],v[116:119]
M v[112:115],a[132:135],a[172:175],v[112:115]
M v[112:115],a[128:131],a[168:171],v[112:115]
M v[108:111],a[120:123],a[168:171],v[108:111]
buffer_load_dwordx4 v13, s[48:51], s22 offen offset:1024   lds
M v[108:111],a[124:127],a[172:175],v[108:111]
s_nop 0
T a[68:69],v1,57344
T a[70:71],v1,58368
M v[104:107],a[116:119],a[172:175],v[104:107]
M v[104:107],a[112:115],a[168:171],v[104:107]
M v[100:103],a[104:107],a[168:171],v[100:103]
M v[100:103],a[108:111],a[172:175],v[100:103]
s_waitcnt lgkmcnt(4)
M v[96:99],a[100:103],a[172:175],v[96:99]
buffer_load_dwordx4 v14, s[48:51], s22 offen offset:2048   lds
M v[96:99],a[96:99],a[168:171],v[96:99]
M v[128:131],a[96:99],a[160:163],v[128:131]
R a[168:171],v5,18432
R a[172:175],v6,18432
M v[128:131],a[100:103],a[164:167],v[128:131]
T a[72:73],v2,49152
T a[74:75],v2,50176
M v[132:135],a[108:111],a[164:167],v[132:135]
M v[132:135],a[104:107],a[160:163],v[132:135]
M v[136:139],a[112:115],a[160:163],v[136:139]
buffer_load_dwordx4 v15, s[48:51], s22 offen offset:3072   lds
M v[136:139],a[116:119],a[164:167],v[136:139]
SA s22,s22,1048576
M v[140:143],a[124:127],a[164:167],v[140:143]
M v[140:143],a[120:123],a[160:163],v[140:143]
s_nop 0
T a[76:77],v2,57344
T a[78:79],v2,58368
M v[144:147],a[128:131],a[160:163],v[144:147]
SA m0,s23,32768
M v[144:147],a[132:135],a[164:167],v[144:147]
buffer_load_dwordx4 v8, s[16:19], s21 offen offset:0  nt lds
M v[148:151],a[140:143],a[164:167],v[148:151]
M v[148:151],a[136:139],a[160:163],v[148:151]
M v[152:155],a[144:147],a[160:163],v[152:155]
M v[152:155],a[148:151],a[164:167],v[152:155]
s_waitcnt lgkmcnt(4)
M v[156:159],a[156:159],a[164:167],v[156:159]
s_nop 0
T a[80:81],v3,49152
T a[82:83],v3,50176
M v[156:159],a[152:155],a[160:163],v[156:159]
buffer_load_dwordx4 v9, s[16:19], s21 offen offset:1024  nt lds
M v[188:191],a[152:155],a[168:171],v[188:191]
R a[160:163],v5,20480
R a[164:167],v6,20480
M v[188:191],a[156:159],a[172:175],v[188:191]
M v[184:187],a[148:151],a[172:175],v[184:187]
M v[184:187],a[144:147],a[168:171],v[184:187]
M v[180:183],a[136:139],a[168:171],v[180:183]
M v[180:183],a[140:143],a[172:175],v[180:183]
s_nop 0
T a[84:85],v3,57344
T a[86:87],v3,58368
M v[176:179],a[132:135],a[172:175],v[176:179]
buffer_load_dwordx4 v10, s[16:19], s21 offen offset:2048  nt lds
M v[176:179],a[128:131],a[168:171],v[176:179]
M v[172:175],a[120:123],a[168:171],v[172:175]
M v[172:175],a[124:127],a[172:175],v[172:175]
M v[168:171],a[116:119],a[172:175],v[168:171]
buffer_load_dwordx4 v11, s[16:19], s21 offen offset:3072  nt lds
M v[168:171],a[112:115],a[168:171],v[168:171]
SA s21,s21,128
M v[164:167],a[104:107],a[168:171],v[164:167]
s_nop 0
T a[88:89],v4,49152
T a[90:91],v4,50176
M v[164:167],a[108:111],a[172:175],v[164:167]
s_waitcnt lgkmcnt(4)
M v[160:163],a[100:103],a[172:175],v[160:163]
M v[160:163],a[96:99],a[168:171],v[160:163]
SA m0,s87,2048
M v[192:195],a[96:99],a[160:163],v[192:195]
R a[168:171],v5,22528
R a[172:175],v6,22528
M v[192:195],a[100:103],a[164:167],v[192:195]
buffer_load_dwordx4 v25, s[60:63], s89 offen offset:0 nt lds
M v[196:199],a[108:111],a[164:167],v[196:199]
SA s89,s89,114688
M v[196:199],a[104:107],a[160:163],v[196:199]
s_nop 0
T a[92:93],v4,57344
T a[94:95],v4,58368
M v[200:203],a[112:115],a[160:163],v[200:203]
M v[200:203],a[116:119],a[164:167],v[200:203]
SA m0,s87,3072
M v[204:207],a[124:127],a[164:167],v[204:207]
buffer_load_dwordx4 v25, s[60:63], s89 offen offset:0 nt lds
M v[204:207],a[120:123],a[160:163],v[204:207]
SA s89,s89,114688
M v[208:211],a[128:131],a[160:163],v[208:211]
M v[208:211],a[132:135],a[164:167],v[208:211]
M v[212:215],a[140:143],a[164:167],v[212:215]
M v[212:215],a[136:139],a[160:163],v[212:215]
M v[216:219],a[144:147],a[160:163],v[216:219]
M v[216:219],a[148:151],a[164:167],v[216:219]
s_waitcnt lgkmcnt(2)
M v[220:223],a[156:159],a[164:167],v[220:223]
s_waitcnt vmcnt(20) lgkmcnt(0)
M v[220:223],a[152:155],a[160:163],v[220:223]
s_barrier
M v[252:255],a[152:155],a[168:171],v[252:255]
R a[160:163],v5,32768
R a[164:167],v6,32768
M v[252:255],a[156:159],a[172:175],v[252:255]
v_cmp_ne_u32 vcc, 1, v17
M v[248:251],a[148:151],a[172:175],v[248:251]
s_nop 0
M v[248:251],a[144:147],a[168:171],v[248:251]
s_cbranch_vccnz L_zs0
L_zr0:
M v[244:247],a[136:139],a[168:171],v[244:247]
M v[244:247],a[140:143],a[172:175],v[244:247]
M v[240:243],a[132:135],a[172:175],v[240:243]
M v[240:243],a[128:131],a[168:171],v[240:243]
M v[236:239],a[120:123],a[168:171],v[236:239]
M v[236:239],a[124:127],a[172:175],v[236:239]
M v[232:235],a[116:119],a[172:175],v[232:235]
M v[232:235],a[112:115],a[168:171],v[232:235]
M v[228:231],a[104:107],a[168:171],v[228:231]
M v[228:231],a[108:111],a[172:175],v[228:231]
s_waitcnt lgkmcnt(0)
M v[224:227],a[100:103],a[172:175],v[224:227]
M v[224:227],a[96:99],a[168:171],v[224:227]
M a[0:3],a[32:35],a[160:163],a[0:3]
R a[168:171],v5,34816
R a[172:175],v6,34816
M a[0:3],a[36:39],a[164:167],a[0:3]
T a[96:97],v1,0
T a[98:99],v1,1024
M a[4:7],a[44:47],a[164:167],a[4:7]
SA m0,s24,16384
M a[4:7],a[40:43],a[160:163],a[4:7]
buffer_load_dwordx4 v12, s[48:51], s22 offen offset:0   lds
M a[8:11],a[48:51],a[160:163],a[8:11]
M a[8:11],a[52:55],a[164:167],a[8:11]
s_mul_i32 s64, s41, 229376
M a[12:15],a[60:63],a[164:167],a[12:15]
SA s72,s90,s64
T a[100:101],v1,8192
T a[102:103],v1,9216
M a[12:15],a[56:59],a[160:163],a[12:15]
s_addc_u32 s73, s91, 0
M a[16:19],a[64:67],a[160:163],a[16:19]
s_sub_u32 s75, 3670016, s64
buffer_load_dwordx4 v13, s[48:51], s22 offen offset:1024   lds
M a[16:19],a[68:71],a[164:167],a[16:19]
s_mov_b32 s12, s72
M a[20:23],a[76:79],a[164:167],a[20:23]
s_and_b32 s13, s73, 0xffff
M a[20:23],a[72:75],a[160:163],a[20:23]
s_mov_b32 s14, s75
T a[104:105],v2,0
T a[106:107],v2,1024
M a[24:27],a[80:83],a[160:163],a[24:27]
s_mov_b32 s15, 0x20000
M a[24:27],a[84:87],a[164:167],a[24:27]
s_waitcnt lgkmcnt(6)
buffer_load_dwordx4 v14, s[48:51], s22 offen offset:2048   lds
M a[28:31],a[92:95],a[164:167],a[28:31]
M a[28:31],a[88:91],a[160:163],a[28:31]
M v[60:63],a[88:91],a[168:171],v[60:63]
R a[160:163],v5,36864
R a[164:167],v6,36864
M v[60:63],a[92:95],a[172:175],v[60:63]
T a[108:109],v2,8192
T a[110:111],v2,9216
M v[56:59],a[84:87],a[172:175],v[56:59]
buffer_load_dwordx4 v15, s[48:51], s22 offen offset:3072   lds
M v[56:59],a[80:83],a[168:171],v[56:59]
s_sub_u32 s22, s22, 1048448
M v[52:55],a[72:75],a[168:171],v[52:55]
M v[52:55],a[76:79],a[172:175],v[52:55]
s_nop 0
T a[112:113],v3,0
T a[114:115],v3,1024
M v[48:51],a[68:71],a[172:175],v[48:51]
SA m0,s23,49152
M v[48:51],a[64:67],a[168:171],v[48:51]
buffer_load_dwordx4 v8, s[16:19], s21 offen offset:0  nt lds
M v[44:47],a[56:59],a[168:171],v[44:47]
M v[44:47],a[60:63],a[172:175],v[44:47]
M v[40:43],a[52:55],a[172:175],v[40:43]
s_nop 0
T a[116:117],v3,8192
T a[118:119],v3,9216
M v[40:43],a[48:51],a[168:171],v[40:43]
M v[36:39],a[40:43],a[168:171],v[36:39]
buffer_load_dwordx4 v9, s[16:19], s21 offen offset:1024  nt lds
M v[36:39],a[44:47],a[172:175],v[36:39]
s_waitcnt lgkmcnt(6)
M v[32:35],a[36:39],a[172:175],v[32:35]
M v[32:35],a[32:35],a[168:171],v[32:35]
s_nop 0
T a[120:121],v4,0
T a[122:123],v4,1024
M v[64:67],a[32:35],a[160:163],v[64:67]
R a[168:171],v5,38912
R a[172:175],v6,38912
M v[64:67],a[36:39],a[164:167],v[64:67]
buffer_load_dwordx4 v10, s[16:19], s21 offen offset:2048  nt lds
M v[68:71],a[44:47],a[164:167],v[68:71]
M v[68:71],a[40:43],a[160:163],v[68:71]
M v[72:75],a[48:51],a[160:163],v[72:75]
s_nop 0
T a[124:125],v4,8192
T a[126:127],v4,9216
M v[72:75],a[52:55],a[164:167],v[72:75]
M v[76:79],a[60:63],a[164:167],v[76:79]
buffer_load_dwordx4 v11, s[16:19], s21 offen offset:3072  nt lds
M v[76:79],a[56:59],a[160:163],v[76:79]
SA s21,s21,524160
M v[80:83],a[64:67],a[160:163],v[80:83]
M v[80:83],a[68:71],a[164:167],v[80:83]
M v[84:87],a[76:79],a[164:167],v[84:87]
M v[84:87],a[72:75],a[160:163],v[84:87]
M v[88:91],a[80:83],a[160:163],v[88:91]
M v[88:91],a[84:87],a[164:167],v[88:91]
s_waitcnt lgkmcnt(2)
M v[92:95],a[92:95],a[164:167],v[92:95]
s_waitcnt vmcnt(18) lgkmcnt(0)
M v[92:95],a[88:91],a[160:163],v[92:95]
s_barrier
M v[124:127],a[88:91],a[168:171],v[124:127]
R a[160:163],v5,49152
R a[164:167],v6,49152
M v[124:127],a[92:95],a[172:175],v[124:127]
M v[120:123],a[84:87],a[172:175],v[120:123]
SA m0,s24,32768
T a[128:129],v1,16384
T a[130:131],v1,17408
M v[120:123],a[80:83],a[168:171],v[120:123]
buffer_load_dwordx4 v12, s[48:51], s22 offen offset:0   lds
M v[116:119],a[72:75],a[168:171],v[116:119]
M v[116:119],a[76:79],a[172:175],v[116:119]
M v[112:115],a[68:71],a[172:175],v[112:115]
M v[112:115],a[64:67],a[168:171],v[112:115]
M v[108:111],a[56:59],a[168:171],v[108:111]
buffer_load_dwordx4 v13, s[48:51], s22 offen offset:1024   lds
M v[108:111],a[60:63],a[172:175],v[108:111]
s_nop 0
T a[132:133],v1,24576
T a[134:135],v1,25600
M v[104:107],a[52:55],a[172:175],v[104:107]
M v[104:107],a[48:51],a[168:171],v[104:107]
M v[100:103],a[40:43],a[168:171],v[100:103]
M v[100:103],a[44:47],a[172:175],v[100:103]
s_waitcnt lgkmcnt(4)
M v[96:99],a[36:39],a[172:175],v[96:99]
buffer_load_dwordx4 v14, s[48:51], s22 offen offset:2048   lds
M v[96:99],a[32:35],a[168:171],v[96:99]
M v[128:131],a[32:35],a[160:163],v[128:131]
R a[168:171],v5,51200
R a[172:175],v6,51200
M v[128:131],a[36:39],a[164:167],v[128:131]
T a[136:137],v2,16384
T a[138:139],v2,17408
M v[132:135],a[44:47],a[164:167],v[132:135]
M v[132:135],a[40:43],a[160:163],v[132:135]
M v[136:139],a[48:51],a[160:163],v[136:139]
buffer_load_dwordx4 v15, s[48:51], s22 offen offset:3072   lds
M v[136:139],a[52:55],a[164:167],v[136:139]
SA s22,s22,1048576
M v[140:143],a[60:63],a[164:167],v[140:143]
M v[140:143],a[56:59],a[160:163],v[140:143]
s_nop 0
T a[140:141],v2,24576
T a[142:143],v2,25600
M v[144:147],a[64:67],a[160:163],v[144:147]
SA m0,s23,0
M v[144:147],a[68:71],a[164:167],v[144:147]
buffer_load_dwordx4 v8, s[16:19], s21 offen offset:0  nt lds
M v[148:151],a[76:79],a[164:167],v[148:151]
M v[148:151],a[72:75],a[160:163],v[148:151]
M v[152:155],a[80:83],a[160:163],v[152:155]
M v[152:155],a[84:87],a[164:167],v[152:155]
s_waitcnt lgkmcnt(4)
M v[156:159],a[92:95],a[164:167],v[156:159]
s_nop 0
T a[144:145],v3,16384
T a[146:147],v3,17408
M v[156:159],a[88:91],a[160:163],v[156:159]
buffer_load_dwordx4 v9, s[16:19], s21 offen offset:1024  nt lds
M v[188:191],a[88:91],a[168:171],v[188:191]
R a[160:163],v5,53248
R a[164:167],v6,53248
M v[188:191],a[92:95],a[172:175],v[188:191]
M v[184:187],a[84:87],a[172:175],v[184:187]
M v[184:187],a[80:83],a[168:171],v[184:187]
M v[180:183],a[72:75],a[168:171],v[180:183]
M v[180:183],a[76:79],a[172:175],v[180:183]
s_nop 0
T a[148:149],v3,24576
T a[150:151],v3,25600
M v[176:179],a[68:71],a[172:175],v[176:179]
buffer_load_dwordx4 v10, s[16:19], s21 offen offset:2048  nt lds
M v[176:179],a[64:67],a[168:171],v[176:179]
M v[172:175],a[56:59],a[168:171],v[172:175]
M v[172:175],a[60:63],a[172:175],v[172:175]
M v[168:171],a[52:55],a[172:175],v[168:171]
buffer_load_dwordx4 v11, s[16:19], s21 offen offset:3072  nt lds
M v[168:171],a[48:51],a[168:171],v[168:171]
SA s21,s21,128
M v[164:167],a[40:43],a[168:171],v[164:167]
s_nop 0
T a[152:153],v4,16384
T a[154:155],v4,17408
M v[164:167],a[44:47],a[172:175],v[164:167]
s_waitcnt lgkmcnt(4)
M v[160:163],a[36:39],a[172:175],v[160:163]
M v[160:163],a[32:35],a[168:171],v[160:163]
SA m0,s87,4096
M v[192:195],a[32:35],a[160:163],v[192:195]
R a[168:171],v5,55296
R a[172:175],v6,55296
M v[192:195],a[36:39],a[164:167],v[192:195]
buffer_load_dwordx4 v25, s[60:63], s89 offen offset:0 nt lds
M v[196:199],a[44:47],a[164:167],v[196:199]
SA s89,s89,114688
M v[196:199],a[40:43],a[160:163],v[196:199]
s_nop 0
T a[156:157],v4,24576
T a[158:159],v4,25600
M v[200:203],a[48:51],a[160:163],v[200:203]
M v[200:203],a[52:55],a[164:167],v[200:203]
SA m0,s87,5120
M v[204:207],a[60:63],a[164:167],v[204:207]
buffer_load_dwordx4 v25, s[60:63], s89 offen offset:0 nt lds
M v[204:207],a[56:59],a[160:163],v[204:207]
SA s89,s89,114688
M v[208:211],a[64:67],a[160:163],v[208:211]
M v[208:211],a[68:71],a[164:167],v[208:211]
M v[212:215],a[76:79],a[164:167],v[212:215]
M v[212:215],a[72:75],a[160:163],v[212:215]
M v[216:219],a[80:83],a[160:163],v[216:219]
M v[216:219],a[84:87],a[164:167],v[216:219]
s_waitcnt lgkmcnt(2)
M v[220:223],a[92:95],a[164:167],v[220:223]
s_waitcnt vmcnt(20) lgkmcnt(0)
M v[220:223],a[88:91],a[160:163],v[220:223]
s_barrier
M v[252:255],a[88:91],a[168:171],v[252:255]
R a[160:163],v5,0
R a[164:167],v6,0
M v[252:255],a[92:95],a[172:175],v[252:255]
M v[248:251],a[84:87],a[172:175],v[248:251]
M v[248:251],a[80:83],a[168:171],v[248:251]
M v[244:247],a[72:75],a[168:171],v[244:247]
M v[244:247],a[76:79],a[172:175],v[244:247]
M v[240:243],a[68:71],a[172:175],v[240:243]
M v[240:243],a[64:67],a[168:171],v[240:243]
M v[236:239],a[56:59],a[168:171],v[236:239]
M v[236:239],a[60:63],a[172:175],v[236:239]
M v[232:235],a[52:55],a[172:175],v[232:235]
M v[232:235],a[48:51],a[168:171],v[232:235]
M v[228:231],a[40:43],a[168:171],v[228:231]
M v[228:231],a[44:47],a[172:175],v[228:231]
s_waitcnt lgkmcnt(0)
M v[224:227],a[36:39],a[172:175],v[224:227]
M v[224:227],a[32:35],a[168:171],v[224:227]
M a[0:3],a[96:99],a[160:163],a[0:3]
R a[168:171],v5,2048
R a[172:175],v6,2048
M a[0:3],a[100:103],a[164:167],a[0:3]
T a[32:33],v1,32768
T a[34:35],v1,33792
M a[4:7],a[108:111],a[164:167],a[4:7]
SA m0,s24,49152
M a[4:7],a[104:107],a[160:163],a[4:7]
buffer_load_dwordx4 v12, s[48:51], s22 offen offset:0   lds
M a[8:11],a[112:115],a[160:163],a[8:11]
M a[8:11],a[116:119],a[164:167],a[8:11]
M a[12:15],a[124:127],a[164:167],a[12:15]
s_nop 0
T a[36:37],v1,40960
T a[38:39],v1,41984
M a[12:15],a[120:123],a[160:163],a[12:15]
M a[16:19],a[128:131],a[160:163],a[16:19]
buffer_load_dwordx4 v13, s[48:51], s22 offen offset:1024   lds
M a[16:19],a[132:135],a[164:167],a[16:19]
M a[20:23],a[140:143],a[164:167],a[20:23]
M a[20:23],a[136:139],a[160:163],a[20:23]
s_nop 0
T a[40:41],v2,32768
T a[42:43],v2,33792
M a[24:27],a[144:147],a[160:163],a[24:27]
M a[24:27],a[148:151],a[164:167],a[24:27]
s_waitcnt lgkmcnt(6)
buffer_load_dwordx4 v14, s[48:51], s22 offen offset:2048   lds
M a[28:31],a[156:159],a[164:167],a[28:31]
M a[28:31],a[152:155],a[160:163],a[28:31]
M v[60:63],a[152:155],a[168:171],v[60:63]
R a[160:163],v5,4096
R a[164:167],v6,4096
M v[60:63],a[156:159],a[172:175],v[60:63]
T a[44:45],v2,40960
T a[46:47],v2,41984
M v[56:59],a[148:151],a[172:175],v[56:59]
buffer_load_dwordx4 v15, s[48:51], s22 offen offset:3072   lds
M v[56:59],a[144:147],a[168:171],v[56:59]
s_sub_u32 s22, s22, 1048448
M v[52:55],a[136:139],a[168:171],v[52:55]
M v[52:55],a[140:143],a[172:175],v[52:55]
s_nop 0
T a[48:49],v3,32768
T a[50:51],v3,33792
M v[48:51],a[132:135],a[172:175],v[48:51]
SA m0,s23,16384
M v[48:51],a[128:131],a[168:171],v[48:51]
buffer_load_dwordx4 v8, s[16:19], s21 offen offset:0  nt lds
M v[44:47],a[120:123],a[168:171],v[44:47]
M v[44:47],a[124:127],a[172:175],v[44:47]
M v[40:43],a[116:119],a[172:175],v[40:43]
s_nop 0
T a[52:53],v3,40960
T a[54:55],v3,41984
M v[40:43],a[112:115],a[168:171],v[40:43]
M v[36:39],a[104:107],a[168:171],v[36:39]
buffer_load_dwordx4 v9, s[16:19], s21 offen offset:1024  nt lds
M v[36:39],a[108:111],a[172:175],v[36:39]
s_waitcnt lgkmcnt(6)
M v[32:35],a[100:103],a[172:175],v[32:35]
M v[32:35],a[96:99],a[168:171],v[32:35]
s_nop 0
T a[56:57],v4,32768
T a[58:59],v4,33792
M v[64:67],a[96:99],a[160:163],v[64:67]
R a[168:171],v5,6144
R a[172:175],v6,6144
M v[64:67],a[100:103],a[164:167],v[64:67]
buffer_load_dwordx4 v10, s[16:19], s21 offen offset:2048  nt lds
M v[68:71],a[108:111],a[164:167],v[68:71]
M v[68:71],a[104:107],a[160:163],v[68:71]
M v[72:75],a[112:115],a[160:163],v[72:75]
s_nop 0
T a[60:61],v4,40960
T a[62:63],v4,41984
M v[72:75],a[116:119],a[164:167],v[72:75]
M v[76:79],a[124:127],a[164:167],v[76:79]
buffer_load_dwordx4 v11, s[16:19], s21 offen offset:3072  nt lds
M v[76:79],a[120:123],a[160:163],v[76:79]
SA s21,s21,524160
M v[80:83],a[128:131],a[160:163],v[80:83]
M v[80:83],a[132:135],a[164:167],v[80:83]
M v[84:87],a[140:143],a[164:167],v[84:87]
M v[84:87],a[136:139],a[160:163],v[84:87]
M v[88:91],a[144:147],a[160:163],v[88:91]
M v[88:91],a[148:151],a[164:167],v[88:91]
s_waitcnt lgkmcnt(2)
M v[92:95],a[156:159],a[164:167],v[92:95]
s_waitcnt vmcnt(18) lgkmcnt(0)
M v[92:95],a[152:155],a[160:163],v[92:95]
s_barrier
M v[124:127],a[152:155],a[168:171],v[124:127]
R a[160:163],v5,16384
R a[164:167],v6,16384
M v[124:127],a[156:159],a[172:175],v[124:127]
M v[120:123],a[148:151],a[172:175],v[120:123]
SA m0,s24,0
T a[64:65],v1,49152
T a[66:67],v1,50176
M v[120:123],a[144:147],a[168:171],v[120:123]
buffer_load_dwordx4 v12, s[48:51], s22 offen offset:0   lds
M v[116:119],a[136:139],a[168:171],v[116:119]
M v[116:119],a[140:143],a[172:175],v[116:119]
M v[112:115],a[132:135],a[172:175],v[112:115]
M v[112:115],a[128:131],a[168:171],v[112:115]
M v[108:111],a[120:123],a[168:171],v[108:111]
M v[108:111],a[124:127],a[172:175],v[108:111]
s_nop 0
T a[68:69],v1,57344
T a[70:71],v1,58368
M v[104:107],a[116:119],a[172:175],v[104:107]
buffer_load_dwordx4 v13, s[48:51], s22 offen offset:1024   lds
M v[104:107],a[112:115],a[168:171],v[104:107]
M v[100:103],a[104:107],a[168:171],v[100:103]
M v[100:103],a[108:111],a[172:175],v[100:103]
s_waitcnt lgkmcnt(4)
M v[96:99],a[100:103],a[172:175],v[96:99]
M v[96:99],a[96:99],a[168:171],v[96:99]
buffer_load_dwordx4 v14, s[48:51], s22 offen offset:2048   lds
M v[128:131],a[96:99],a[160:163],v[128:131]
R a[168:171],v5,18432
R a[172:175],v6,18432
M v[128:131],a[100:103],a[164:167],v[128:131]
s_lshl_b32 s67, s20, 11
T a[72:73],v2,49152
T a[74:75],v2,50176
M v[132:135],a[108:111],a[164:167],v[132:135]
SA s67,s67,104914944
buffer_load_dwordx4 v[16:19], v7, s[8:11], s67 offen offset:0 sc1
M v[132:135],a[104:107],a[160:163],v[132:135]
M v[136:139],a[112:115],a[160:163],v[136:139]
buffer_load_dwordx4 v[20:23], v7, s[8:11], s67 offen offset:1024 sc1
M v[136:139],a[116:119],a[164:167],v[136:139]
M v[140:143],a[124:127],a[164:167],v[140:143]
buffer_load_dwordx4 v15, s[48:51], s22 offen offset:3072   lds
M v[140:143],a[120:123],a[160:163],v[140:143]
SA s22,s22,1048576
L_w_kv03:
s_cbranch_execz L_w_kv07
T a[76:77],v2,57344
T a[78:79],v2,58368
M v[144:147],a[128:131],a[160:163],v[144:147]
M v[144:147],a[132:135],a[164:167],v[144:147]
M v[148:151],a[140:143],a[164:167],v[148:151]
M v[148:151],a[136:139],a[160:163],v[148:151]
SA m0,s23,32768
M v[152:155],a[144:147],a[160:163],v[152:155]
buffer_load_dwordx4 v8, s[16:19], s21 offen offset:0  nt lds
M v[152:155],a[148:151],a[164:167],v[152:155]
s_waitcnt lgkmcnt(4)
M v[156:159],a[156:159],a[164:167],v[156:159]
s_nop 0
T a[80:81],v3,49152
T a[82:83],v3,50176
M v[156:159],a[152:155],a[160:163],v[156:159]
M v[188:191],a[152:155],a[168:171],v[188:191]
R a[160:163],v5,20480
R a[164:167],v6,20480
M v[188:191],a[156:159],a[172:175],v[188:191]
M v[184:187],a[148:151],a[172:175],v[184:187]
buffer_load_dwordx4 v9, s[16:19], s21 offen offset:1024  nt lds
M v[184:187],a[144:147],a[168:171],v[184:187]
M v[180:183],a[136:139],a[168:171],v[180:183]
M v[180:183],a[140:143],a[172:175],v[180:183]
s_nop 0
T a[84:85],v3,57344
T a[86:87],v3,58368
M v[176:179],a[132:135],a[172:175],v[176:179]
M v[176:179],a[128:131],a[168:171],v[176:179]
M v[172:175],a[120:123],a[168:171],v[172:175]
M v[172:175],a[124:127],a[172:175],v[172:175]
buffer_load_dwordx4 v10, s[16:19], s21 offen offset:2048  nt lds
M v[168:171],a[116:119],a[172:175],v[168:171]
M v[168:171],a[112:115],a[168:171],v[168:171]
M v[164:167],a[104:107],a[168:171],v[164:167]
s_nop 0
T a[88:89],v4,49152
T a[90:91],v4,50176
M v[164:167],a[108:111],a[172:175],v[164:167]
s_waitcnt lgkmcnt(4)
M v[160:163],a[100:103],a[172:175],v[160:163]
M v[160:163],a[96:99],a[168:171],v[160:163]
buffer_load_dwordx4 v11, s[16:19], s21 offen offset:3072  nt lds
M v[192:195],a[96:99],a[160:163],v[192:195]
SA s21,s21,128
R a[168:171],v5,22528
R a[172:175],v6,22528
M v[192:195],a[100:103],a[164:167],v[192:195]
M v[196:199],a[108:111],a[164:167],v[196:199]
M v[196:199],a[104:107],a[160:163],v[196:199]
s_nop 0
T a[92:93],v4,57344
T a[94:95],v4,58368
M v[200:203],a[112:115],a[160:163],v[200:203]
SA m0,s87,6144
M v[200:203],a[116:119],a[164:167],v[200:203]
buffer_load_dwordx4 v25, s[60:63], s89 offen offset:0 nt lds
M v[204:207],a[124:127],a[164:167],v[204:207]
SA s89,s89,114688
M v[204:207],a[120:123],a[160:163],v[204:207]
M v[208:211],a[128:131],a[160:163],v[208:211]
M v[208:211],a[132:135],a[164:167],v[208:211]
M v[212:215],a[140:143],a[164:167],v[212:215]
M v[212:215],a[136:139],a[160:163],v[212:215]
M v[216:219],a[144:147],a[160:163],v[216:219]
M v[216:219],a[148:151],a[164:167],v[216:219]
s_waitcnt lgkmcnt(2)
M v[220:223],a[156:159],a[164:167],v[220:223]
s_waitcnt vmcnt(21) lgkmcnt(0)
M v[220:223],a[152:155],a[160:163],v[220:223]
s_barrier
M v[252:255],a[152:155],a[168:171],v[252:255]
R a[160:163],v5,32768
R a[164:167],v6,32768
M v[252:255],a[156:159],a[172:175],v[252:255]
M v[248:251],a[148:151],a[172:175],v[248:251]
M v[248:251],a[144:147],a[168:171],v[248:251]
M v[244:247],a[136:139],a[168:171],v[244:247]
M v[244:247],a[140:143],a[172:175],v[244:247]
M v[240:243],a[132:135],a[172:175],v[240:243]
M v[240:243],a[128:131],a[168:171],v[240:243]
M v[236:239],a[120:123],a[168:171],v[236:239]
M v[236:239],a[124:127],a[172:175],v[236:239]
M v[232:235],a[116:119],a[172:175],v[232:235]
M v[232:235],a[112:115],a[168:171],v[232:235]
M v[228:231],a[104:107],a[168:171],v[228:231]
M v[228:231],a[108:111],a[172:175],v[228:231]
s_waitcnt lgkmcnt(0)
M v[224:227],a[100:103],a[172:175],v[224:227]
M v[224:227],a[96:99],a[168:171],v[224:227]
M a[0:3],a[32:35],a[160:163],a[0:3]
R a[168:171],v5,34816
R a[172:175],v6,34816
M a[0:3],a[36:39],a[164:167],a[0:3]
T a[96:97],v1,0
T a[98:99],v1,1024
M a[4:7],a[44:47],a[164:167],a[4:7]
SA m0,s24,16384
M a[4:7],a[40:43],a[160:163],a[4:7]
buffer_load_dwordx4 v12, s[48:51], s22 offen offset:0   lds
M a[8:11],a[48:51],a[160:163],a[8:11]
M a[8:11],a[52:55],a[164:167],a[8:11]
M a[12:15],a[60:63],a[164:167],a[12:15]
s_nop 0
T a[100:101],v1,8192
T a[102:103],v1,9216
M a[12:15],a[56:59],a[160:163],a[12:15]
M a[16:19],a[64:67],a[160:163],a[16:19]
buffer_load_dwordx4 v13, s[48:51], s22 offen offset:1024   lds
M a[16:19],a[68:71],a[164:167],a[16:19]
M a[20:23],a[76:79],a[164:167],a[20:23]
s_waitcnt vmcnt(9)
v_min3_u32 v28, v16, v17, v18
M a[20:23],a[72:75],a[160:163],a[20:23]
s_nop 0
T a[104:105],v2,0
T a[106:107],v2,1024
M a[24:27],a[80:83],a[160:163],a[24:27]
s_waitcnt vmcnt(8)
v_min3_u32 v28, v28, v19, v20
M a[24:27],a[84:87],a[164:167],a[24:27]
s_waitcnt lgkmcnt(6)
buffer_load_dwordx4 v14, s[48:51], s22 offen offset:2048   lds
M a[28:31],a[92:95],a[164:167],a[28:31]
v_min3_u32 v28, v28, v21, v22
M a[28:31],a[88:91],a[160:163],a[28:31]
v_min_u32 v28, v28, v23
M v[60:63],a[88:91],a[168:171],v[60:63]
R a[160:163],v5,36864
R a[164:167],v6,36864
M v[60:63],a[92:95],a[172:175],v[60:63]
T a[108:109],v2,8192
T a[110:111],v2,9216
M v[56:59],a[84:87],a[172:175],v[56:59]
buffer_load_dwordx4 v15, s[48:51], s22 offen offset:3072   lds
M v[56:59],a[80:83],a[168:171],v[56:59]
s_sub_u32 s22, s22, 1048448
v_cmp_eq_u32 vcc, 0, v28
M v[52:55],a[72:75],a[168:171],v[52:55]
s_nop 0
M v[52:55],a[76:79],a[172:175],v[52:55]
s_cbranch_vccnz L_hs
L_hr:
T a[112:113],v3,0
T a[114:115],v3,1024
M v[48:51],a[68:71],a[172:175],v[48:51]
SA m0,s23,49152
v_max_u32 v28, v16, v17
M v[48:51],a[64:67],a[168:171],v[48:51]
buffer_load_dwordx4 v8, s[16:19], s21 offen offset:0  nt lds
M v[44:47],a[56:59],a[168:171],v[44:47]
v_min_u32 v29, v16, v17
M v[44:47],a[60:63],a[172:175],v[44:47]
v_med3_u32 v29, v28, v29, v18
M v[40:43],a[52:55],a[172:175],v[40:43]
s_nop 0
T a[116:117],v3,8192
T a[118:119],v3,9216
M v[40:43],a[48:51],a[168:171],v[40:43]
v_max_u32 v28, v28, v18
M v[36:39],a[40:43],a[168:171],v[36:39]
buffer_load_dwordx4 v9, s[16:19], s21 offen offset:1024  nt lds
M v[36:39],a[44:47],a[172:175],v[36:39]
s_waitcnt lgkmcnt(6)
v_med3_u32 v29, v28, v29, v19
M v[32:35],a[36:39],a[172:175],v[32:35]
v_max_u32 v28, v28, v19
M v[32:35],a[32:35],a[168:171],v[32:35]
s_nop 0
T a[120:121],v4,0
T a[122:123],v4,1024
M v[64:67],a[32:35],a[160:163],v[64:67]
R a[168:171],v5,38912
R a[172:175],v6,38912
M v[64:67],a[36:39],a[164:167],v[64:67]
buffer_load_dwordx4 v10, s[16:19], s21 offen offset:2048  nt lds
M v[68:71],a[44:47],a[164:167],v[68:71]
v_med3_u32 v29, v28, v29, v20
M v[68:71],a[40:43],a[160:163],v[68:71]
v_max_u32 v28, v28, v20
M v[72:75],a[48:51],a[160:163],v[72:75]
s_nop 0
T a[124:125],v4,8192
T a[126:127],v4,9216
M v[72:75],a[52:55],a[164:167],v[72:75]
v_med3_u32 v29, v28, v29, v21
M v[76:79],a[60:63],a[164:167],v[76:79]
buffer_load_dwordx4 v11, s[16:19], s21 offen offset:3072  nt lds
M v[76:79],a[56:59],a[160:163],v[76:79]
SA s21,s21,524160
v_max_u32 v28, v28, v21
M v[80:83],a[64:67],a[160:163],v[80:83]
v_med3_u32 v29, v28, v29, v22
M v[80:83],a[68:71],a[164:167],v[80:83]
v_max_u32 v28, v28, v22
M v[84:87],a[76:79],a[164:167],v[84:87]
v_med3_u32 v29, v28, v29, v23
M v[84:87],a[72:75],a[160:163],v[84:87]
v_max_u32 v28, v28, v23
M v[88:91],a[80:83],a[160:163],v[88:91]
s_nop 0
v_mov_b32 v30, v28 row_ror:8 row_mask:0xf bank_mask:0xf
M v[88:91],a[84:87],a[164:167],v[88:91]
s_waitcnt lgkmcnt(2)
v_mov_b32 v31, v29 row_ror:8 row_mask:0xf bank_mask:0xf
M v[92:95],a[92:95],a[164:167],v[92:95]
s_waitcnt lgkmcnt(0)
v_min_u32 v16, v28, v30
M v[92:95],a[88:91],a[160:163],v[92:95]
s_barrier
M v[124:127],a[88:91],a[168:171],v[124:127]
R a[160:163],v5,49152
R a[164:167],v6,49152
M v[124:127],a[92:95],a[172:175],v[124:127]
v_max_u32 v28, v28, v30
M v[120:123],a[84:87],a[172:175],v[120:123]
SA m0,s24,32768
T a[128:129],v1,16384
T a[130:131],v1,17408
M v[120:123],a[80:83],a[168:171],v[120:123]
buffer_load_dwordx4 v12, s[48:51], s22 offen offset:0   lds
M v[116:119],a[72:75],a[168:171],v[116:119]
v_max3_u32 v29, v29, v31, v16
M v[116:119],a[76:79],a[172:175],v[116:119]
v_mov_b32 v30, v28 row_ror:4 row_mask:0xf bank_mask:0xf
M v[112:115],a[68:71],a[172:175],v[112:115]
v_mov_b32 v31, v29 row_ror:4 row_mask:0xf bank_mask:0xf
M v[112:115],a[64:67],a[168:171],v[112:115]
v_min_u32 v16, v28, v30
M v[108:111],a[56:59],a[168:171],v[108:111]
v_max_u32 v28, v28, v30
M v[108:111],a[60:63],a[172:175],v[108:111]
s_nop 0
T a[132:133],v1,24576
T a[134:135],v1,25600
M v[104:107],a[52:55],a[172:175],v[104:107]
buffer_load_dwordx4 v13, s[48:51], s22 offen offset:1024   lds
M v[104:107],a[48:51],a[168:171],v[104:107]
v_max3_u32 v29, v29, v31, v16
M v[100:103],a[40:43],a[168:171],v[100:103]
v_mov_b32 v30, v28 row_ror:2 row_mask:0xf bank_mask:0xf
M v[100:103],a[44:47],a[172:175],v[100:103]
s_waitcnt lgkmcnt(4)
v_mov_b32 v31, v29 row_ror:2 row_mask:0xf bank_mask:0xf
M v[96:99],a[36:39],a[172:175],v[96:99]
v_min_u32 v16, v28, v30
M v[96:99],a[32:35],a[168:171],v[96:99]
v_max_u32 v28, v28, v30
M v[128:131],a[32:35],a[160:163],v[128:131]
R a[168:171],v5,51200
R a[172:175],v6,51200
M v[128:131],a[36:39],a[164:167],v[128:131]
T a[136:137],v2,16384
T a[138:139],v2,17408
M v[132:135],a[44:47],a[164:167],v[132:135]
buffer_load_dwordx4 v14, s[48:51], s22 offen offset:2048   lds
M v[132:135],a[40:43],a[160:163],v[132:135]
v_max3_u32 v29, v29, v31, v16
M v[136:139],a[48:51],a[160:163],v[136:139]
v_mov_b32 v30, v28 row_ror:1 row_mask:0xf bank_mask:0xf
M v[136:139],a[52:55],a[164:167],v[136:139]
v_mov_b32 v31, v29 row_ror:1 row_mask:0xf bank_mask:0xf
M v[140:143],a[60:63],a[164:167],v[140:143]
v_min_u32 v16, v28, v30
M v[140:143],a[56:59],a[160:163],v[140:143]
s_nop 0
T a[140:141],v2,24576
T a[142:143],v2,25600
M v[144:147],a[64:67],a[160:163],v[144:147]
buffer_load_dwordx4 v15, s[48:51], s22 offen offset:3072   lds
M v[144:147],a[68:71],a[164:167],v[144:147]
SA s22,s22,1048576
v_max_u32 v28, v28, v30
M v[148:151],a[76:79],a[164:167],v[148:151]
v_max3_u32 v29, v29, v31, v16
M v[148:151],a[72:75],a[160:163],v[148:151]
v_mov_b32 v30, v28
M v[152:155],a[80:83],a[160:163],v[152:155]
v_mov_b32 v31, v29
M v[152:155],a[84:87],a[164:167],v[152:155]
s_waitcnt lgkmcnt(4)
v_permlane16_swap_b32 v30, v28
M v[156:159],a[92:95],a[164:167],v[156:159]
SA m0,s23,0
T a[144:145],v3,16384
T a[146:147],v3,17408
M v[156:159],a[88:91],a[160:163],v[156:159]
buffer_load_dwordx4 v8, s[16:19], s21 offen offset:0  nt lds
M v[188:191],a[88:91],a[168:171],v[188:191]
R a[160:163],v5,53248
R a[164:167],v6,53248
M v[188:191],a[92:95],a[172:175],v[188:191]
v_permlane16_swap_b32 v31, v29
M v[184:187],a[84:87],a[172:175],v[184:187]
v_min_u32 v16, v28, v30
M v[184:187],a[80:83],a[168:171],v[184:187]
v_max_u32 v28, v28, v30
M v[180:183],a[72:75],a[168:171],v[180:183]
v_max3_u32 v29, v29, v31, v16
M v[180:183],a[76:79],a[172:175],v[180:183]
s_nop 0
T a[148:149],v3,24576
T a[150:151],v3,25600
M v[176:179],a[68:71],a[172:175],v[176:179]
buffer_load_dwordx4 v9, s[16:19], s21 offen offset:1024  nt lds
M v[176:179],a[64:67],a[168:171],v[176:179]
v_mov_b32 v30, v28
M v[172:175],a[56:59],a[168:171],v[172:175]
v_mov_b32 v31, v29
M v[172:175],a[60:63],a[172:175],v[172:175]
v_permlane32_swap_b32 v30, v28
M v[168:171],a[52:55],a[172:175],v[168:171]
v_permlane32_swap_b32 v31, v29
M v[168:171],a[48:51],a[168:171],v[168:171]
v_min_u32 v16, v28, v30
M v[164:167],a[40:43],a[168:171],v[164:167]
s_nop 0
T a[152:153],v4,16384
T a[154:155],v4,17408
M v[164:167],a[44:47],a[172:175],v[164:167]
s_waitcnt lgkmcnt(4)
buffer_load_dwordx4 v10, s[16:19], s21 offen offset:2048  nt lds
M v[160:163],a[36:39],a[172:175],v[160:163]
v_max_u32 v28, v28, v30
M v[160:163],a[32:35],a[168:171],v[160:163]
v_max3_u32 v29, v29, v31, v16
M v[192:195],a[32:35],a[160:163],v[192:195]
s_lshl_b32 s64, s20, 3
R a[168:171],v5,55296
R a[172:175],v6,55296
M v[192:195],a[36:39],a[164:167],v[192:195]
SA s64,s64,159744
v_mov_b32 v16, s64
M v[196:199],a[44:47],a[164:167],v[196:199]
ds_write_b64 v16, v[28:29]
M v[196:199],a[40:43],a[160:163],v[196:199]
s_nop 0
T a[156:157],v4,24576
T a[158:159],v4,25600
M v[200:203],a[48:51],a[160:163],v[200:203]
buffer_load_dwordx4 v11, s[16:19], s21 offen offset:3072  nt lds
M v[200:203],a[52:55],a[164:167],v[200:203]
SA s21,s21,128
M v[204:207],a[60:63],a[164:167],v[204:207]
M v[204:207],a[56:59],a[160:163],v[204:207]
M v[208:211],a[64:67],a[160:163],v[208:211]
M v[208:211],a[68:71],a[164:167],v[208:211]
M v[212:215],a[76:79],a[164:167],v[212:215]
M v[212:215],a[72:75],a[160:163],v[212:215]
M v[216:219],a[80:83],a[160:163],v[216:219]
M v[216:219],a[84:87],a[164:167],v[216:219]
s_waitcnt lgkmcnt(3)
M v[220:223],a[92:95],a[164:167],v[220:223]
s_waitcnt vmcnt(17) lgkmcnt(0)
M v[220:223],a[88:91],a[160:163],v[220:223]
s_barrier
M v[252:255],a[88:91],a[168:171],v[252:255]
R a[160:163],v5,0
R a[164:167],v6,0
M v[252:255],a[92:95],a[172:175],v[252:255]
M v[248:251],a[84:87],a[172:175],v[248:251]
M v[248:251],a[80:83],a[168:171],v[248:251]
M v[244:247],a[72:75],a[168:171],v[244:247]
M v[244:247],a[76:79],a[172:175],v[244:247]
M v[240:243],a[68:71],a[172:175],v[240:243]
M v[240:243],a[64:67],a[168:171],v[240:243]
M v[236:239],a[56:59],a[168:171],v[236:239]
M v[236:239],a[60:63],a[172:175],v[236:239]
M v[232:235],a[52:55],a[172:175],v[232:235]
M v[232:235],a[48:51],a[168:171],v[232:235]
M v[228:231],a[40:43],a[168:171],v[228:231]
M v[228:231],a[44:47],a[172:175],v[228:231]
s_waitcnt lgkmcnt(0)
M v[224:227],a[36:39],a[172:175],v[224:227]
M v[224:227],a[32:35],a[168:171],v[224:227]
M a[0:3],a[96:99],a[160:163],a[0:3]
R a[168:171],v5,2048
R a[172:175],v6,2048
M a[0:3],a[100:103],a[164:167],a[0:3]
T a[32:33],v1,32768
T a[34:35],v1,33792
M a[4:7],a[108:111],a[164:167],a[4:7]
SA m0,s24,49152
M a[4:7],a[104:107],a[160:163],a[4:7]
buffer_load_dwordx4 v12, s[48:51], s22 offen offset:0   lds
M a[8:11],a[112:115],a[160:163],a[8:11]
v_mov_b32 v28, 159744
M a[8:11],a[116:119],a[164:167],a[8:11]
ds_read_b128 v[16:19], v28
M a[12:15],a[124:127],a[164:167],a[12:15]
s_nop 0
T a[36:37],v1,40960
T a[38:39],v1,41984
M a[12:15],a[120:123],a[160:163],a[12:15]
R v[20:23],v28,16
M a[16:19],a[128:131],a[160:163],a[16:19]
buffer_load_dwordx4 v13, s[48:51], s22 offen offset:1024   lds
M a[16:19],a[132:135],a[164:167],a[16:19]
M a[20:23],a[140:143],a[164:167],a[20:23]
M a[20:23],a[136:139],a[160:163],a[20:23]
s_nop 0
T a[40:41],v2,32768
T a[42:43],v2,33792
M a[24:27],a[144:147],a[160:163],a[24:27]
M a[24:27],a[148:151],a[164:167],a[24:27]
s_waitcnt lgkmcnt(8)
buffer_load_dwordx4 v14, s[48:51], s22 offen offset:2048   lds
M a[28:31],a[156:159],a[164:167],a[28:31]
M a[28:31],a[152:155],a[160:163],a[28:31]
M v[60:63],a[152:155],a[168:171],v[60:63]
R a[160:163],v5,4096
R a[164:167],v6,4096
M v[60:63],a[156:159],a[172:175],v[60:63]
T a[44:45],v2,40960
T a[46:47],v2,41984
M v[56:59],a[148:151],a[172:175],v[56:59]
buffer_load_dwordx4 v15, s[48:51], s22 offen offset:3072   lds
M v[56:59],a[144:147],a[168:171],v[56:59]
s_sub_u32 s22, s22, 1048448
s_waitcnt lgkmcnt(9)
v_min_u32 v28, v16, v18
M v[52:55],a[136:139],a[168:171],v[52:55]
v_max_u32 v16, v16, v18
M v[52:55],a[140:143],a[172:175],v[52:55]
s_nop 0
T a[48:49],v3,32768
T a[50:51],v3,33792
M v[48:51],a[132:135],a[172:175],v[48:51]
SA m0,s23,16384
v_max3_u32 v17, v17, v19, v28
M v[48:51],a[128:131],a[168:171],v[48:51]
buffer_load_dwordx4 v8, s[16:19], s21 offen offset:0  nt lds
M v[44:47],a[120:123],a[168:171],v[44:47]
s_waitcnt lgkmcnt(8)
v_min_u32 v29, v20, v22
M v[44:47],a[124:127],a[172:175],v[44:47]
v_max_u32 v20, v20, v22
M v[40:43],a[116:119],a[172:175],v[40:43]
s_nop 0
T a[52:53],v3,40960
T a[54:55],v3,41984
M v[40:43],a[112:115],a[168:171],v[40:43]
v_max3_u32 v21, v21, v23, v29
M v[36:39],a[104:107],a[168:171],v[36:39]
buffer_load_dwordx4 v9, s[16:19], s21 offen offset:1024  nt lds
M v[36:39],a[108:111],a[172:175],v[36:39]
s_waitcnt lgkmcnt(6)
v_min_u32 v28, v16, v20
M v[32:35],a[100:103],a[172:175],v[32:35]
v_max_u32 v16, v16, v20
M v[32:35],a[96:99],a[168:171],v[32:35]
s_nop 0
T a[56:57],v4,32768
T a[58:59],v4,33792
M v[64:67],a[96:99],a[160:163],v[64:67]
R a[168:171],v5,6144
R a[172:175],v6,6144
M v[64:67],a[100:103],a[164:167],v[64:67]
buffer_load_dwordx4 v10, s[16:19], s21 offen offset:2048  nt lds
M v[68:71],a[108:111],a[164:167],v[68:71]
v_max3_u32 v17, v17, v21, v28
M v[68:71],a[104:107],a[160:163],v[68:71]
v_and_b32 v28, 1, v0
M v[72:75],a[112:115],a[160:163],v[72:75]
s_nop 0
T a[60:61],v4,40960
T a[62:63],v4,41984
M v[72:75],a[116:119],a[164:167],v[72:75]
v_cmp_eq_u32 vcc, 0, v28
M v[76:79],a[124:127],a[164:167],v[76:79]
s_and_b32 s64, s20, 1
buffer_load_dwordx4 v11, s[16:19], s21 offen offset:3072  nt lds
M v[76:79],a[120:123],a[160:163],v[76:79]
SA s21,s21,524160
s_mul_i32 s64, s64, 448
v_cndmask_b32 v24, v17, v16, vcc
M v[80:83],a[128:131],a[160:163],v[80:83]
v_and_b32 v24, 0x7ff, v24
M v[80:83],a[132:135],a[164:167],v[80:83]
v_sub_u32 v24, 2047, v24
M v[84:87],a[140:143],a[164:167],v[84:87]
v_mul_u32_u24 v28, 896, v24
M v[84:87],a[136:139],a[160:163],v[84:87]
v_lshrrev_b32 v29, 4, v0
M v[88:91],a[144:147],a[160:163],v[88:91]
v_lshl_add_u32 v28, v29, 4, v28
M v[88:91],a[148:151],a[164:167],v[88:91]
s_waitcnt lgkmcnt(2)
v_bfe_u32 v30, v0, 1, 3
M v[92:95],a[156:159],a[164:167],v[92:95]
s_waitcnt vmcnt(16) lgkmcnt(0)
v_lshl_or_b32 v28, v30, 26, v28
M v[92:95],a[152:155],a[160:163],v[92:95]
s_barrier
M v[124:127],a[152:155],a[168:171],v[124:127]
R a[160:163],v5,16384
R a[164:167],v6,16384
M v[124:127],a[156:159],a[172:175],v[124:127]
buffer_load_dwordx4 a[208:211], v28, s[56:59], s64 offen offset:0
M v[120:123],a[148:151],a[172:175],v[120:123]
SA m0,s24,0
T a[64:65],v1,49152
T a[66:67],v1,50176
M v[120:123],a[144:147],a[168:171],v[120:123]
buffer_load_dwordx4 v12, s[48:51], s22 offen offset:0   lds
M v[116:119],a[136:139],a[168:171],v[116:119]
M v[116:119],a[140:143],a[172:175],v[116:119]
M v[112:115],a[132:135],a[172:175],v[112:115]
buffer_load_dwordx4 a[212:215], v28, s[56:59], s64 offen offset:64
M v[112:115],a[128:131],a[168:171],v[112:115]
M v[108:111],a[120:123],a[168:171],v[108:111]
buffer_load_dwordx4 a[216:219], v28, s[56:59], s64 offen offset:128
M v[108:111],a[124:127],a[172:175],v[108:111]
s_nop 0
T a[68:69],v1,57344
T a[70:71],v1,58368
M v[104:107],a[116:119],a[172:175],v[104:107]
buffer_load_dwordx4 v13, s[48:51], s22 offen offset:1024   lds
M v[104:107],a[112:115],a[168:171],v[104:107]
M v[100:103],a[104:107],a[168:171],v[100:103]
M v[100:103],a[108:111],a[172:175],v[100:103]
s_waitcnt lgkmcnt(4)
M v[96:99],a[100:103],a[172:175],v[96:99]
buffer_load_dwordx4 a[220:223], v28, s[56:59], s64 offen offset:192
M v[96:99],a[96:99],a[168:171],v[96:99]
M v[128:131],a[96:99],a[160:163],v[128:131]
R a[168:171],v5,18432
R a[172:175],v6,18432
M v[128:131],a[100:103],a[164:167],v[128:131]
T a[72:73],v2,49152
T a[74:75],v2,50176
M v[132:135],a[108:111],a[164:167],v[132:135]
buffer_load_dwordx4 v14, s[48:51], s22 offen offset:2048   lds
M v[132:135],a[104:107],a[160:163],v[132:135]
M v[136:139],a[112:115],a[160:163],v[136:139]
buffer_load_dwordx4 a[224:227], v28, s[56:59], s64 offen offset:256
M v[136:139],a[116:119],a[164:167],v[136:139]
M v[140:143],a[124:127],a[164:167],v[140:143]
buffer_load_dwordx4 a[228:231], v28, s[56:59], s64 offen offset:320
M v[140:143],a[120:123],a[160:163],v[140:143]
s_nop 0
T a[76:77],v2,57344
T a[78:79],v2,58368
M v[144:147],a[128:131],a[160:163],v[144:147]
buffer_load_dwordx4 v15, s[48:51], s22 offen offset:3072   lds
M v[144:147],a[132:135],a[164:167],v[144:147]
SA s22,s22,1048576
M v[148:151],a[140:143],a[164:167],v[148:151]
M v[148:151],a[136:139],a[160:163],v[148:151]
buffer_load_dwordx4 a[232:235], v28, s[56:59], s64 offen offset:384
M v[152:155],a[144:147],a[160:163],v[152:155]
v_lshrrev_b32 v28, 4, v24
M v[152:155],a[148:151],a[164:167],v[152:155]
s_waitcnt lgkmcnt(4)
v_lshlrev_b32 v28, 5, v28
M v[156:159],a[156:159],a[164:167],v[156:159]
SA m0,s23,32768
T a[80:81],v3,49152
T a[82:83],v3,50176
M v[156:159],a[152:155],a[160:163],v[156:159]
buffer_load_dwordx4 v8, s[16:19], s21 offen offset:0  nt lds
M v[188:191],a[152:155],a[168:171],v[188:191]
L_w_kv04:
s_cbranch_execz L_w_kv08
R a[160:163],v5,20480
R a[164:167],v6,20480
M v[188:191],a[156:159],a[172:175],v[188:191]
v_and_b32 v30, 15, v24
M v[184:187],a[148:151],a[172:175],v[184:187]
v_add_lshl_u32 v28, v28, v30, 2
M v[184:187],a[144:147],a[168:171],v[184:187]
v_lshrrev_b32 v30, 1, v0
M v[180:183],a[136:139],a[168:171],v[180:183]
v_min_u32 v30, 1, v30
M v[180:183],a[140:143],a[172:175],v[180:183]
s_nop 0
T a[84:85],v3,57344
T a[86:87],v3,58368
M v[176:179],a[132:135],a[172:175],v[176:179]
buffer_load_dwordx4 v9, s[16:19], s21 offen offset:1024  nt lds
M v[176:179],a[128:131],a[168:171],v[176:179]
v_lshl_or_b32 v28, v30, 29, v28
M v[172:175],a[120:123],a[168:171],v[172:175]
s_or_b32 s64, s31, s20
M v[172:175],a[124:127],a[172:175],v[172:175]
s_min_u32 s64, s64, 1
M v[168:171],a[116:119],a[172:175],v[168:171]
s_lshl_b32 s64, s64, 29
M v[168:171],a[112:115],a[168:171],v[168:171]
SA s64,s64,104857600
buffer_load_dword v23, v28, s[8:11], s64 offen sc1
M v[164:167],a[104:107],a[168:171],v[164:167]
s_nop 0
T a[88:89],v4,49152
T a[90:91],v4,50176
M v[164:167],a[108:111],a[172:175],v[164:167]
s_waitcnt lgkmcnt(4)
buffer_load_dwordx4 v10, s[16:19], s21 offen offset:2048  nt lds
M v[160:163],a[100:103],a[172:175],v[160:163]
v_bfe_u32 v28, v0, 2, 2
M v[160:163],a[96:99],a[168:171],v[160:163]
v_lshl_add_u32 v28, v29, 3, v28
M v[192:195],a[96:99],a[160:163],v[192:195]
R a[168:171],v5,22528
R a[172:175],v6,22528
M v[192:195],a[100:103],a[164:167],v[192:195]
v_lshlrev_b32 v28, 5, v28
M v[196:199],a[108:111],a[164:167],v[196:199]
v_and_b32 v30, 3, v0
M v[196:199],a[104:107],a[160:163],v[196:199]
s_nop 0
T a[92:93],v4,57344
T a[94:95],v4,58368
M v[200:203],a[112:115],a[160:163],v[200:203]
buffer_load_dwordx4 v11, s[16:19], s21 offen offset:3072  nt lds
M v[200:203],a[116:119],a[164:167],v[200:203]
SA s21,s21,128
v_lshl_add_u32 v28, v30, 3, v28
M v[204:207],a[124:127],a[164:167],v[204:207]
v_add_u32 v22, s87, v28
M v[204:207],a[120:123],a[160:163],v[204:207]
M v[208:211],a[128:131],a[160:163],v[208:211]
M v[208:211],a[132:135],a[164:167],v[208:211]
M v[212:215],a[140:143],a[164:167],v[212:215]
M v[212:215],a[136:139],a[160:163],v[212:215]
M v[216:219],a[144:147],a[160:163],v[216:219]
M v[216:219],a[148:151],a[164:167],v[216:219]
s_waitcnt lgkmcnt(2)
M v[220:223],a[156:159],a[164:167],v[220:223]
s_waitcnt vmcnt(24) lgkmcnt(0)
M v[220:223],a[152:155],a[160:163],v[220:223]
s_barrier
M v[252:255],a[152:155],a[168:171],v[252:255]
R a[160:163],v5,32768
R a[164:167],v6,32768
M v[252:255],a[156:159],a[172:175],v[252:255]
M v[248:251],a[148:151],a[172:175],v[248:251]
M v[248:251],a[144:147],a[168:171],v[248:251]
M v[244:247],a[136:139],a[168:171],v[244:247]
M v[244:247],a[140:143],a[172:175],v[244:247]
M v[240:243],a[132:135],a[172:175],v[240:243]
M v[240:243],a[128:131],a[168:171],v[240:243]
M v[236:239],a[120:123],a[168:171],v[236:239]
M v[236:239],a[124:127],a[172:175],v[236:239]
M v[232:235],a[116:119],a[172:175],v[232:235]
M v[232:235],a[112:115],a[168:171],v[232:235]
M v[228:231],a[104:107],a[168:171],v[228:231]
M v[228:231],a[108:111],a[172:175],v[228:231]
s_waitcnt lgkmcnt(0)
M v[224:227],a[100:103],a[172:175],v[224:227]
M v[224:227],a[96:99],a[168:171],v[224:227]
M a[0:3],a[32:35],a[160:163],a[0:3]
R a[168:171],v5,34816
R a[172:175],v6,34816
M a[0:3],a[36:39],a[164:167],a[0:3]
T a[96:97],v1,0
T a[98:99],v1,1024
M a[4:7],a[44:47],a[164:167],a[4:7]
SA m0,s24,16384
M a[4:7],a[40:43],a[160:163],a[4:7]
buffer_load_dwordx4 v12, s[48:51], s22 offen offset:0   lds
M a[8:11],a[48:51],a[160:163],a[8:11]
M a[8:11],a[52:55],a[164:167],a[8:11]
M a[12:15],a[60:63],a[164:167],a[12:15]
s_nop 0
T a[100:101],v1,8192
T a[102:103],v1,9216
M a[12:15],a[56:59],a[160:163],a[12:15]
M a[16:19],a[64:67],a[160:163],a[16:19]
buffer_load_dwordx4 v13, s[48:51], s22 offen offset:1024   lds
M a[16:19],a[68:71],a[164:167],a[16:19]
M a[20:23],a[76:79],a[164:167],a[20:23]
M a[20:23],a[72:75],a[160:163],a[20:23]
s_nop 0
T a[104:105],v2,0
T a[106:107],v2,1024
M a[24:27],a[80:83],a[160:163],a[24:27]
M a[24:27],a[84:87],a[164:167],a[24:27]
s_waitcnt lgkmcnt(6)
buffer_load_dwordx4 v14, s[48:51], s22 offen offset:2048   lds
M a[28:31],a[92:95],a[164:167],a[28:31]
M a[28:31],a[88:91],a[160:163],a[28:31]
M v[60:63],a[88:91],a[168:171],v[60:63]
R a[160:163],v5,36864
R a[164:167],v6,36864
M v[60:63],a[92:95],a[172:175],v[60:63]
T a[108:109],v2,8192
T a[110:111],v2,9216
M v[56:59],a[84:87],a[172:175],v[56:59]
buffer_load_dwordx4 v15, s[48:51], s22 offen offset:3072   lds
M v[56:59],a[80:83],a[168:171],v[56:59]
s_sub_u32 s22, s22, 1048448
M v[52:55],a[72:75],a[168:171],v[52:55]
M v[52:55],a[76:79],a[172:175],v[52:55]
s_nop 0
T a[112:113],v3,0
T a[114:115],v3,1024
M v[48:51],a[68:71],a[172:175],v[48:51]
SA m0,s23,49152
M v[48:51],a[64:67],a[168:171],v[48:51]
buffer_load_dwordx4 v8, s[16:19], s21 offen offset:0  nt lds
M v[44:47],a[56:59],a[168:171],v[44:47]
M v[44:47],a[60:63],a[172:175],v[44:47]
M v[40:43],a[52:55],a[172:175],v[40:43]
s_nop 0
T a[116:117],v3,8192
T a[118:119],v3,9216
M v[40:43],a[48:51],a[168:171],v[40:43]
M v[36:39],a[40:43],a[168:171],v[36:39]
buffer_load_dwordx4 v9, s[16:19], s21 offen offset:1024  nt lds
M v[36:39],a[44:47],a[172:175],v[36:39]
s_waitcnt lgkmcnt(6)
M v[32:35],a[36:39],a[172:175],v[32:35]
M v[32:35],a[32:35],a[168:171],v[32:35]
s_nop 0
T a[120:121],v4,0
T a[122:123],v4,1024
M v[64:67],a[32:35],a[160:163],v[64:67]
R a[168:171],v5,38912
R a[172:175],v6,38912
M v[64:67],a[36:39],a[164:167],v[64:67]
buffer_load_dwordx4 v10, s[16:19], s21 offen offset:2048  nt lds
M v[68:71],a[44:47],a[164:167],v[68:71]
M v[68:71],a[40:43],a[160:163],v[68:71]
M v[72:75],a[48:51],a[160:163],v[72:75]
s_nop 0
T a[124:125],v4,8192
T a[126:127],v4,9216
M v[72:75],a[52:55],a[164:167],v[72:75]
M v[76:79],a[60:63],a[164:167],v[76:79]
buffer_load_dwordx4 v11, s[16:19], s21 offen offset:3072  nt lds
M v[76:79],a[56:59],a[160:163],v[76:79]
SA s21,s21,524160
M v[80:83],a[64:67],a[160:163],v[80:83]
M v[80:83],a[68:71],a[164:167],v[80:83]
M v[84:87],a[76:79],a[164:167],v[84:87]
M v[84:87],a[72:75],a[160:163],v[84:87]
M v[88:91],a[80:83],a[160:163],v[88:91]
M v[88:91],a[84:87],a[164:167],v[88:91]
s_waitcnt lgkmcnt(2)
M v[92:95],a[92:95],a[164:167],v[92:95]
s_waitcnt vmcnt(24) lgkmcnt(0)
M v[92:95],a[88:91],a[160:163],v[92:95]
s_barrier
M v[124:127],a[88:91],a[168:171],v[124:127]
R a[160:163],v5,49152
R a[164:167],v6,49152
M v[124:127],a[92:95],a[172:175],v[124:127]
M v[120:123],a[84:87],a[172:175],v[120:123]
SA m0,s24,32768
T a[128:129],v1,16384
T a[130:131],v1,17408
M v[120:123],a[80:83],a[168:171],v[120:123]
buffer_load_dwordx4 v12, s[48:51], s22 offen offset:0   lds
M v[116:119],a[72:75],a[168:171],v[116:119]
s_nop 0
T a[176:177],v22,0
T a[178:179],v22,128
M v[116:119],a[76:79],a[172:175],v[116:119]
T a[180:181],v22,1024
T a[182:183],v22,1152
M v[112:115],a[68:71],a[172:175],v[112:115]
T a[184:185],v22,2048
T a[186:187],v22,2176
M v[112:115],a[64:67],a[168:171],v[112:115]
T a[188:189],v22,3072
T a[190:191],v22,3200
M v[108:111],a[56:59],a[168:171],v[108:111]
M v[108:111],a[60:63],a[172:175],v[108:111]
s_nop 0
T a[132:133],v1,24576
T a[134:135],v1,25600
M v[104:107],a[52:55],a[172:175],v[104:107]
buffer_load_dwordx4 v13, s[48:51], s22 offen offset:1024   lds
M v[104:107],a[48:51],a[168:171],v[104:107]
M v[100:103],a[40:43],a[168:171],v[100:103]
M v[100:103],a[44:47],a[172:175],v[100:103]
s_waitcnt lgkmcnt(12)
M v[96:99],a[36:39],a[172:175],v[96:99]
M v[96:99],a[32:35],a[168:171],v[96:99]
M v[128:131],a[32:35],a[160:163],v[128:131]
R a[168:171],v5,51200
R a[172:175],v6,51200
M v[128:131],a[36:39],a[164:167],v[128:131]
T a[136:137],v2,16384
T a[138:139],v2,17408
M v[132:135],a[44:47],a[164:167],v[132:135]
buffer_load_dwordx4 v14, s[48:51], s22 offen offset:2048   lds
M v[132:135],a[40:43],a[160:163],v[132:135]
M v[136:139],a[48:51],a[160:163],v[136:139]
M v[136:139],a[52:55],a[164:167],v[136:139]
M v[140:143],a[60:63],a[164:167],v[140:143]
M v[140:143],a[56:59],a[160:163],v[140:143]
s_nop 0
T a[140:141],v2,24576
T a[142:143],v2,25600
M v[144:147],a[64:67],a[160:163],v[144:147]
buffer_load_dwordx4 v15, s[48:51], s22 offen offset:3072   lds
M v[144:147],a[68:71],a[164:167],v[144:147]
SA s22,s22,1048576
M v[148:151],a[76:79],a[164:167],v[148:151]
M v[148:151],a[72:75],a[160:163],v[148:151]
M v[152:155],a[80:83],a[160:163],v[152:155]
M v[152:155],a[84:87],a[164:167],v[152:155]
s_waitcnt lgkmcnt(4)
M v[156:159],a[92:95],a[164:167],v[156:159]
SA m0,s23,0
T a[144:145],v3,16384
T a[146:147],v3,17408
M v[156:159],a[88:91],a[160:163],v[156:159]
buffer_load_dwordx4 v8, s[16:19], s21 offen offset:0  nt lds
s_waitcnt vmcnt(28)
M v[16:19],a[176:179],a[208:211],0
s_waitcnt vmcnt(26)
M v[16:19],a[180:183],a[212:215],v[16:19]
s_waitcnt vmcnt(25)
M v[16:19],a[184:187],a[216:219],v[16:19]
s_waitcnt vmcnt(23)
M v[16:19],a[188:191],a[220:223],v[16:19]
M v[188:191],a[88:91],a[168:171],v[188:191]
R a[160:163],v5,53248
R a[164:167],v6,53248
M v[188:191],a[92:95],a[172:175],v[188:191]
T a[176:177],v22,4096
T a[178:179],v22,4224
M v[184:187],a[84:87],a[172:175],v[184:187]
T a[180:181],v22,5120
T a[182:183],v22,5248
M v[184:187],a[80:83],a[168:171],v[184:187]
T a[184:185],v22,6144
T a[186:187],v22,6272
M v[180:183],a[72:75],a[168:171],v[180:183]
M v[180:183],a[76:79],a[172:175],v[180:183]
s_nop 0
T a[148:149],v3,24576
T a[150:151],v3,25600
M v[176:179],a[68:71],a[172:175],v[176:179]
buffer_load_dwordx4 v9, s[16:19], s21 offen offset:1024  nt lds
M v[176:179],a[64:67],a[168:171],v[176:179]
M v[172:175],a[56:59],a[168:171],v[172:175]
M v[172:175],a[60:63],a[172:175],v[172:175]
M v[168:171],a[52:55],a[172:175],v[168:171]
M v[168:171],a[48:51],a[168:171],v[168:171]
M v[164:167],a[40:43],a[168:171],v[164:167]
s_nop 0
T a[152:153],v4,16384
T a[154:155],v4,17408
M v[164:167],a[44:47],a[172:175],v[164:167]
s_waitcnt lgkmcnt(10)
buffer_load_dwordx4 v10, s[16:19], s21 offen offset:2048  nt lds
M v[160:163],a[36:39],a[172:175],v[160:163]
M v[160:163],a[32:35],a[168:171],v[160:163]
M v[192:195],a[32:35],a[160:163],v[192:195]
R a[168:171],v5,55296
R a[172:175],v6,55296
M v[192:195],a[36:39],a[164:167],v[192:195]
M v[196:199],a[44:47],a[164:167],v[196:199]
M v[196:199],a[40:43],a[160:163],v[196:199]
s_nop 0
T a[156:157],v4,24576
T a[158:159],v4,25600
M v[200:203],a[48:51],a[160:163],v[200:203]
buffer_load_dwordx4 v11, s[16:19], s21 offen offset:3072  nt lds
M v[200:203],a[52:55],a[164:167],v[200:203]
SA s21,s21,128
M v[204:207],a[60:63],a[164:167],v[204:207]
M v[204:207],a[56:59],a[160:163],v[204:207]
M v[208:211],a[64:67],a[160:163],v[208:211]
M v[208:211],a[68:71],a[164:167],v[208:211]
M v[212:215],a[76:79],a[164:167],v[212:215]
M v[212:215],a[72:75],a[160:163],v[212:215]
M v[216:219],a[80:83],a[160:163],v[216:219]
M v[216:219],a[84:87],a[164:167],v[216:219]
s_waitcnt lgkmcnt(2)
M v[220:223],a[92:95],a[164:167],v[220:223]
s_waitcnt vmcnt(16) lgkmcnt(0)
M v[220:223],a[88:91],a[160:163],v[220:223]
s_barrier
M v[16:19],a[176:179],a[224:227],v[16:19]
M v[16:19],a[180:183],a[228:231],v[16:19]
M v[16:19],a[184:187],a[232:235],v[16:19]
M v[252:255],a[88:91],a[168:171],v[252:255]
R a[160:163],v5,0
R a[164:167],v6,0
M v[252:255],a[92:95],a[172:175],v[252:255]
M v[248:251],a[84:87],a[172:175],v[248:251]
M v[248:251],a[80:83],a[168:171],v[248:251]
M v[244:247],a[72:75],a[168:171],v[244:247]
M v[244:247],a[76:79],a[172:175],v[244:247]
M v[240:243],a[68:71],a[172:175],v[240:243]
M v[240:243],a[64:67],a[168:171],v[240:243]
M v[236:239],a[56:59],a[168:171],v[236:239]
M v[236:239],a[60:63],a[172:175],v[236:239]
M v[232:235],a[52:55],a[172:175],v[232:235]
M v[232:235],a[48:51],a[168:171],v[232:235]
M v[228:231],a[40:43],a[168:171],v[228:231]
M v[228:231],a[44:47],a[172:175],v[228:231]
s_waitcnt lgkmcnt(0)
M v[224:227],a[36:39],a[172:175],v[224:227]
M v[224:227],a[32:35],a[168:171],v[224:227]
M a[0:3],a[96:99],a[160:163],a[0:3]
R a[168:171],v5,2048
R a[172:175],v6,2048
M a[0:3],a[100:103],a[164:167],a[0:3]
T a[32:33],v1,32768
T a[34:35],v1,33792
M a[4:7],a[108:111],a[164:167],a[4:7]
SA m0,s24,49152
M a[4:7],a[104:107],a[160:163],a[4:7]
buffer_load_dwordx4 v12, s[48:51], s22 offen offset:0   lds
M a[8:11],a[112:115],a[160:163],a[8:11]
M a[8:11],a[116:119],a[164:167],a[8:11]
s_lshl_b32 s64, s20, 10
M a[12:15],a[124:127],a[164:167],a[12:15]
SA s64,s64,159744
T a[36:37],v1,40960
T a[38:39],v1,41984
M a[12:15],a[120:123],a[160:163],a[12:15]
v_add_u32 v21, s64, v7
ds_write_b128 v21, v[16:19]
M a[16:19],a[128:131],a[160:163],a[16:19]
s_mul_i32 s67, s86, 14336
buffer_load_dwordx4 v13, s[48:51], s22 offen offset:1024   lds
M a[16:19],a[132:135],a[164:167],a[16:19]
s_mul_i32 s64, s20, 224
M a[20:23],a[140:143],a[164:167],a[20:23]
SA s67,s67,s64
v_lshrrev_b32 v28, 4, v0
v_mul_u32_u24 v28, 896, v28
M a[20:23],a[136:139],a[160:163],a[20:23]
T a[40:41],v2,32768
T a[42:43],v2,33792
M a[24:27],a[144:147],a[160:163],a[24:27]
v_and_b32 v29, 15, v0
v_lshl_add_u32 v28, v29, 4, v28
M a[24:27],a[148:151],a[164:167],a[24:27]
s_waitcnt lgkmcnt(7)
buffer_load_dwordx4 v14, s[48:51], s22 offen offset:2048   lds
M a[28:31],a[156:159],a[164:167],a[28:31]
v_mov_b32 v30, 536870912
v_cmp_gt_u32 vcc, 14, v29
M a[28:31],a[152:155],a[160:163],a[28:31]
s_nop 0
M v[60:63],a[152:155],a[168:171],v[60:63]
s_nop 0
R a[160:163],v5,4096
R a[164:167],v6,4096
M v[60:63],a[156:159],a[172:175],v[60:63]
T a[44:45],v2,40960
T a[46:47],v2,41984
M v[56:59],a[148:151],a[172:175],v[56:59]
buffer_load_dwordx4 v15, s[48:51], s22 offen offset:3072   lds
M v[56:59],a[144:147],a[168:171],v[56:59]
s_sub_u32 s22, s22, 1048448
v_cndmask_b32 v28, v30, v28, vcc
v_add_u32 v29, 2560, v28
M v[52:55],a[136:139],a[168:171],v[52:55]
v_add_u32 v30, 5120, v28
v_add_u32 v31, 7680, v28
M v[52:55],a[140:143],a[172:175],v[52:55]
T a[48:49],v3,32768
T a[50:51],v3,33792
M v[48:51],a[132:135],a[172:175],v[48:51]
SA m0,s23,16384
M v[48:51],a[128:131],a[168:171],v[48:51]
buffer_load_dwordx4 v8, s[16:19], s21 offen offset:0  nt lds
M v[44:47],a[120:123],a[168:171],v[44:47]
M v[44:47],a[124:127],a[172:175],v[44:47]
M v[40:43],a[116:119],a[172:175],v[40:43]
s_nop 0
T a[52:53],v3,40960
T a[54:55],v3,41984
M v[40:43],a[112:115],a[168:171],v[40:43]
M v[36:39],a[104:107],a[168:171],v[36:39]
buffer_load_dwordx4 v9, s[16:19], s21 offen offset:1024  nt lds
M v[36:39],a[108:111],a[172:175],v[36:39]
s_waitcnt lgkmcnt(6)
M v[32:35],a[100:103],a[172:175],v[32:35]
M v[32:35],a[96:99],a[168:171],v[32:35]
s_nop 0
T a[56:57],v4,32768
T a[58:59],v4,33792
M v[64:67],a[96:99],a[160:163],v[64:67]
R a[168:171],v5,6144
R a[172:175],v6,6144
M v[64:67],a[100:103],a[164:167],v[64:67]
buffer_load_dwordx4 v10, s[16:19], s21 offen offset:2048  nt lds
M v[68:71],a[108:111],a[164:167],v[68:71]
M v[68:71],a[104:107],a[160:163],v[68:71]
M v[72:75],a[112:115],a[160:163],v[72:75]
s_nop 0
T a[60:61],v4,40960
T a[62:63],v4,41984
M v[72:75],a[116:119],a[164:167],v[72:75]
M v[76:79],a[124:127],a[164:167],v[76:79]
buffer_load_dwordx4 v11, s[16:19], s21 offen offset:3072  nt lds
M v[76:79],a[120:123],a[160:163],v[76:79]
SA s21,s21,524160
M v[80:83],a[128:131],a[160:163],v[80:83]
M v[80:83],a[132:135],a[164:167],v[80:83]
M v[84:87],a[140:143],a[164:167],v[84:87]
M v[84:87],a[136:139],a[160:163],v[84:87]
M v[88:91],a[144:147],a[160:163],v[88:91]
M v[88:91],a[148:151],a[164:167],v[88:91]
s_waitcnt lgkmcnt(2)
M v[92:95],a[156:159],a[164:167],v[92:95]
s_waitcnt vmcnt(16) lgkmcnt(0)
M v[92:95],a[152:155],a[160:163],v[92:95]
s_barrier
M v[124:127],a[152:155],a[168:171],v[124:127]
R a[160:163],v5,16384
R a[164:167],v6,16384
M v[124:127],a[156:159],a[172:175],v[124:127]
M v[120:123],a[148:151],a[172:175],v[120:123]
SA m0,s24,0
T a[64:65],v1,49152
T a[66:67],v1,50176
M v[120:123],a[144:147],a[168:171],v[120:123]
buffer_load_dwordx4 v12, s[48:51], s22 offen offset:0   lds
M v[116:119],a[136:139],a[168:171],v[116:119]
M v[116:119],a[140:143],a[172:175],v[116:119]
M v[112:115],a[132:135],a[172:175],v[112:115]
M v[112:115],a[128:131],a[168:171],v[112:115]
buffer_load_dwordx4 v13, s[48:51], s22 offen offset:1024   lds
M v[108:111],a[120:123],a[168:171],v[108:111]
M v[108:111],a[124:127],a[172:175],v[108:111]
s_nop 0
T a[68:69],v1,57344
T a[70:71],v1,58368
M v[104:107],a[116:119],a[172:175],v[104:107]
M v[104:107],a[112:115],a[168:171],v[104:107]
M v[100:103],a[104:107],a[168:171],v[100:103]
buffer_load_dwordx4 v14, s[48:51], s22 offen offset:2048   lds
M v[100:103],a[108:111],a[172:175],v[100:103]
s_waitcnt lgkmcnt(4)
M v[96:99],a[100:103],a[172:175],v[96:99]
M v[96:99],a[96:99],a[168:171],v[96:99]
M v[128:131],a[96:99],a[160:163],v[128:131]
R a[168:171],v5,18432
R a[172:175],v6,18432
M v[128:131],a[100:103],a[164:167],v[128:131]
T a[72:73],v2,49152
T a[74:75],v2,50176
M v[132:135],a[108:111],a[164:167],v[132:135]
buffer_load_dwordx4 v15, s[48:51], s22 offen offset:3072   lds
M v[132:135],a[104:107],a[160:163],v[132:135]
SA s22,s22,1048576
M v[136:139],a[112:115],a[160:163],v[136:139]
M v[136:139],a[116:119],a[164:167],v[136:139]
SA m0,s23,32768
M v[140:143],a[124:127],a[164:167],v[140:143]
buffer_load_dwordx4 v8, s[16:19], s21 offen offset:0  nt lds
M v[140:143],a[120:123],a[160:163],v[140:143]
s_nop 0
T a[76:77],v2,57344
T a[78:79],v2,58368
M v[144:147],a[128:131],a[160:163],v[144:147]
M v[144:147],a[132:135],a[164:167],v[144:147]
M v[148:151],a[140:143],a[164:167],v[148:151]
buffer_load_dwordx4 v9, s[16:19], s21 offen offset:1024  nt lds
M v[148:151],a[136:139],a[160:163],v[148:151]
M v[152:155],a[144:147],a[160:163],v[152:155]
M v[152:155],a[148:151],a[164:167],v[152:155]
s_waitcnt lgkmcnt(4)
M v[156:159],a[156:159],a[164:167],v[156:159]
s_nop 0
T a[80:81],v3,49152
T a[82:83],v3,50176
M v[156:159],a[152:155],a[160:163],v[156:159]
buffer_load_dwordx4 v10, s[16:19], s21 offen offset:2048  nt lds
M v[188:191],a[152:155],a[168:171],v[188:191]
R a[160:163],v5,20480
R a[164:167],v6,20480
M v[188:191],a[156:159],a[172:175],v[188:191]
M v[184:187],a[148:151],a[172:175],v[184:187]
M v[184:187],a[144:147],a[168:171],v[184:187]
M v[180:183],a[136:139],a[168:171],v[180:183]
buffer_load_dwordx4 v11, s[16:19], s21 offen offset:3072  nt lds
M v[180:183],a[140:143],a[172:175],v[180:183]
SA s21,s21,128
T a[84:85],v3,57344
T a[86:87],v3,58368
M v[176:179],a[132:135],a[172:175],v[176:179]
M v[176:179],a[128:131],a[168:171],v[176:179]
M v[172:175],a[120:123],a[168:171],v[172:175]
SA m0,s87,0
M v[172:175],a[124:127],a[172:175],v[172:175]
buffer_load_dwordx4 v28, s[68:71], s67 offen offset:0 nt lds
M v[168:171],a[116:119],a[172:175],v[168:171]
M v[168:171],a[112:115],a[168:171],v[168:171]
M v[164:167],a[104:107],a[168:171],v[164:167]
s_nop 0
T a[88:89],v4,49152
T a[90:91],v4,50176
M v[164:167],a[108:111],a[172:175],v[164:167]
s_waitcnt lgkmcnt(4)
buffer_load_dwordx4 v29, s[68:71], s67 offen offset:1024 nt lds
M v[160:163],a[100:103],a[172:175],v[160:163]
M v[160:163],a[96:99],a[168:171],v[160:163]
M v[192:195],a[96:99],a[160:163],v[192:195]
R a[168:171],v5,22528
R a[172:175],v6,22528
M v[192:195],a[100:103],a[164:167],v[192:195]
M v[196:199],a[108:111],a[164:167],v[196:199]
buffer_load_dwordx4 v30, s[68:71], s67 offen offset:2048 nt lds
M v[196:199],a[104:107],a[160:163],v[196:199]
s_nop 0
T a[92:93],v4,57344
T a[94:95],v4,58368
M v[200:203],a[112:115],a[160:163],v[200:203]
M v[200:203],a[116:119],a[164:167],v[200:203]
M v[204:207],a[124:127],a[164:167],v[204:207]
L_w_kv05:
s_cbranch_execz L_wd1
M v[204:207],a[120:123],a[160:163],v[204:207]
buffer_load_dwordx4 v31, s[68:71], s67 offen offset:3072 nt lds
M v[208:211],a[128:131],a[160:163],v[208:211]
SA s67,s67,0
M v[208:211],a[132:135],a[164:167],v[208:211]
M v[212:215],a[140:143],a[164:167],v[212:215]
M v[212:215],a[136:139],a[160:163],v[212:215]
M v[216:219],a[144:147],a[160:163],v[216:219]
M v[216:219],a[148:151],a[164:167],v[216:219]
s_waitcnt lgkmcnt(2)
M v[220:223],a[156:159],a[164:167],v[220:223]
s_waitcnt vmcnt(20) lgkmcnt(0)
M v[220:223],a[152:155],a[160:163],v[220:223]
s_barrier
M v[252:255],a[152:155],a[168:171],v[252:255]
R a[160:163],v5,32768
R a[164:167],v6,32768
M v[252:255],a[156:159],a[172:175],v[252:255]
M v[248:251],a[148:151],a[172:175],v[248:251]
M v[248:251],a[144:147],a[168:171],v[248:251]
M v[244:247],a[136:139],a[168:171],v[244:247]
M v[244:247],a[140:143],a[172:175],v[244:247]
M v[240:243],a[132:135],a[172:175],v[240:243]
M v[240:243],a[128:131],a[168:171],v[240:243]
M v[236:239],a[120:123],a[168:171],v[236:239]
M v[236:239],a[124:127],a[172:175],v[236:239]
M v[232:235],a[116:119],a[172:175],v[232:235]
M v[232:235],a[112:115],a[168:171],v[232:235]
M v[228:231],a[104:107],a[168:171],v[228:231]
M v[228:231],a[108:111],a[172:175],v[228:231]
s_waitcnt lgkmcnt(0)
M v[224:227],a[100:103],a[172:175],v[224:227]
M v[224:227],a[96:99],a[168:171],v[224:227]
M a[0:3],a[32:35],a[160:163],a[0:3]
R a[168:171],v5,34816
R a[172:175],v6,34816
M a[0:3],a[36:39],a[164:167],a[0:3]
T a[96:97],v1,0
T a[98:99],v1,1024
M a[4:7],a[44:47],a[164:167],a[4:7]
SA m0,s24,16384
C v23,v23,v23
M a[4:7],a[40:43],a[160:163],a[4:7]
buffer_load_dwordx4 v12, s[48:51], s22 offen offset:0   lds
M a[8:11],a[48:51],a[160:163],a[8:11]
v_and_b32 v23, 0xffff0000, v23
M a[8:11],a[52:55],a[164:167],a[8:11]
MF v22,0xbfb8aa3b,v23
M a[12:15],a[60:63],a[164:167],a[12:15]
s_nop 0
T a[100:101],v1,8192
T a[102:103],v1,9216
M a[12:15],a[56:59],a[160:163],a[12:15]
E v22,v22
M a[16:19],a[64:67],a[160:163],a[16:19]
buffer_load_dwordx4 v13, s[48:51], s22 offen offset:1024   lds
M a[16:19],a[68:71],a[164:167],a[16:19]
AF v22,1.0,v22
M a[20:23],a[76:79],a[164:167],a[20:23]
v_rcp_f32 v23, v22
M a[20:23],a[72:75],a[160:163],a[20:23]
s_or_b32 s64, s31, s20
T a[104:105],v2,0
T a[106:107],v2,1024
M a[24:27],a[80:83],a[160:163],a[24:27]
s_min_u32 s64, s64, 1
s_lshl_b32 s64, s64, 29
v_lshrrev_b32 v22, 1, v0
M a[24:27],a[84:87],a[164:167],a[24:27]
s_waitcnt lgkmcnt(6)
buffer_load_dwordx4 v14, s[48:51], s22 offen offset:2048   lds
M a[28:31],a[92:95],a[164:167],a[28:31]
v_min_u32 v22, 1, v22
M a[28:31],a[88:91],a[160:163],a[28:31]
v_lshlrev_b32 v22, 29, v22
M v[60:63],a[88:91],a[168:171],v[60:63]
R a[160:163],v5,36864
R a[164:167],v6,36864
M v[60:63],a[92:95],a[172:175],v[60:63]
T a[108:109],v2,8192
T a[110:111],v2,9216
M v[56:59],a[84:87],a[172:175],v[56:59]
buffer_load_dwordx4 v15, s[48:51], s22 offen offset:3072   lds
M v[56:59],a[80:83],a[168:171],v[56:59]
s_sub_u32 s22, s22, 1048448
v_lshl_or_b32 v22, v0, 2, v22
M v[52:55],a[72:75],a[168:171],v[52:55]
v_or_b32 v22, s64, v22
M v[52:55],a[76:79],a[172:175],v[52:55]
s_nop 0
T a[112:113],v3,0
T a[114:115],v3,1024
M v[48:51],a[68:71],a[172:175],v[48:51]
SA m0,s23,49152
C v23,v23,v23
M v[48:51],a[64:67],a[168:171],v[48:51]
buffer_load_dwordx4 v8, s[16:19], s21 offen offset:0  nt lds
M v[44:47],a[56:59],a[168:171],v[44:47]
v_and_b32 v23, 0xffff0000, v23
M v[44:47],a[60:63],a[172:175],v[44:47]
s_lshl_b32 s64, s41, 7
M v[40:43],a[52:55],a[172:175],v[40:43]
SA s64,s64,104890368
T a[116:117],v3,8192
T a[118:119],v3,9216
M v[40:43],a[48:51],a[168:171],v[40:43]
buffer_store_dword v24, v22, s[8:11], s64 offen sc1
M v[36:39],a[40:43],a[168:171],v[36:39]
buffer_load_dwordx4 v9, s[16:19], s21 offen offset:1024  nt lds
M v[36:39],a[44:47],a[172:175],v[36:39]
s_waitcnt lgkmcnt(6)
buffer_store_dword v23, v22, s[8:11], s64 offen offset:8 sc1
M v[32:35],a[36:39],a[172:175],v[32:35]
v_add_u32 v25, 159744, v7
M v[32:35],a[32:35],a[168:171],v[32:35]
s_nop 0
T a[120:121],v4,0
T a[122:123],v4,1024
M v[64:67],a[32:35],a[160:163],v[64:67]
R a[168:171],v5,38912
R a[172:175],v6,38912
M v[64:67],a[36:39],a[164:167],v[64:67]
buffer_load_dwordx4 v10, s[16:19], s21 offen offset:2048  nt lds
M v[68:71],a[44:47],a[164:167],v[68:71]
ds_read_b128 v[16:19], v25
M v[68:71],a[40:43],a[160:163],v[68:71]
R v[28:31],v25,1024
M v[72:75],a[48:51],a[160:163],v[72:75]
s_nop 0
T a[124:125],v4,8192
T a[126:127],v4,9216
M v[72:75],a[52:55],a[164:167],v[72:75]
R v[20:23],v25,2048
M v[76:79],a[60:63],a[164:167],v[76:79]
buffer_load_dwordx4 v11, s[16:19], s21 offen offset:3072  nt lds
M v[76:79],a[56:59],a[160:163],v[76:79]
SA s21,s21,524160
M v[80:83],a[64:67],a[160:163],v[80:83]
M v[80:83],a[68:71],a[164:167],v[80:83]
M v[84:87],a[76:79],a[164:167],v[84:87]
M v[84:87],a[72:75],a[160:163],v[84:87]
M v[88:91],a[80:83],a[160:163],v[88:91]
M v[88:91],a[84:87],a[164:167],v[88:91]
s_waitcnt lgkmcnt(5)
s_waitcnt lgkmcnt(3)
AF v16,v28,v16
M v[92:95],a[92:95],a[164:167],v[92:95]
s_waitcnt vmcnt(22) lgkmcnt(0)
AF v17,v29,v17
M v[92:95],a[88:91],a[160:163],v[92:95]
s_barrier
M v[124:127],a[88:91],a[168:171],v[124:127]
R a[160:163],v5,49152
R a[164:167],v6,49152
M v[124:127],a[92:95],a[172:175],v[124:127]
AF v18,v30,v18
M v[120:123],a[84:87],a[172:175],v[120:123]
SA m0,s24,32768
T a[128:129],v1,16384
T a[130:131],v1,17408
M v[120:123],a[80:83],a[168:171],v[120:123]
buffer_load_dwordx4 v12, s[48:51], s22 offen offset:0   lds
M v[116:119],a[72:75],a[168:171],v[116:119]
AF v19,v31,v19
M v[116:119],a[76:79],a[172:175],v[116:119]
R v[28:31],v25,3072
M v[112:115],a[68:71],a[172:175],v[112:115]
C v25,v16,v17
M v[112:115],a[64:67],a[168:171],v[112:115]
v_lshlrev_b32 v16, 16, v25
M v[108:111],a[56:59],a[168:171],v[108:111]
v_and_b32 v17, 0xffff0000, v25
M v[108:111],a[60:63],a[172:175],v[108:111]
s_nop 0
T a[132:133],v1,24576
T a[134:135],v1,25600
M v[104:107],a[52:55],a[172:175],v[104:107]
buffer_load_dwordx4 v13, s[48:51], s22 offen offset:1024   lds
M v[104:107],a[48:51],a[168:171],v[104:107]
C v25,v18,v19
M v[100:103],a[40:43],a[168:171],v[100:103]
v_lshlrev_b32 v18, 16, v25
M v[100:103],a[44:47],a[172:175],v[100:103]
s_waitcnt lgkmcnt(5)
v_and_b32 v19, 0xffff0000, v25
M v[96:99],a[36:39],a[172:175],v[96:99]
s_waitcnt lgkmcnt(2)
AF v20,v28,v20
M v[96:99],a[32:35],a[168:171],v[96:99]
AF v21,v29,v21
M v[128:131],a[32:35],a[160:163],v[128:131]
R a[168:171],v5,51200
R a[172:175],v6,51200
M v[128:131],a[36:39],a[164:167],v[128:131]
T a[136:137],v2,16384
T a[138:139],v2,17408
M v[132:135],a[44:47],a[164:167],v[132:135]
buffer_load_dwordx4 v14, s[48:51], s22 offen offset:2048   lds
M v[132:135],a[40:43],a[160:163],v[132:135]
AF v22,v30,v22
M v[136:139],a[48:51],a[160:163],v[136:139]
AF v23,v31,v23
M v[136:139],a[52:55],a[164:167],v[136:139]
MF v28,0xbfb8aa3b,v16
M v[140:143],a[60:63],a[164:167],v[140:143]
MF v29,0xbfb8aa3b,v17
M v[140:143],a[56:59],a[160:163],v[140:143]
s_nop 0
T a[140:141],v2,24576
T a[142:143],v2,25600
M v[144:147],a[64:67],a[160:163],v[144:147]
buffer_load_dwordx4 v15, s[48:51], s22 offen offset:3072   lds
M v[144:147],a[68:71],a[164:167],v[144:147]
SA s22,s22,1048576
MF v30,0xbfb8aa3b,v18
M v[148:151],a[76:79],a[164:167],v[148:151]
MF v31,0xbfb8aa3b,v19
M v[148:151],a[72:75],a[160:163],v[148:151]
E v28,v28
M v[152:155],a[80:83],a[160:163],v[152:155]
E v29,v29
M v[152:155],a[84:87],a[164:167],v[152:155]
s_waitcnt lgkmcnt(4)
E v30,v30
M v[156:159],a[92:95],a[164:167],v[156:159]
SA m0,s23,0
T a[144:145],v3,16384
T a[146:147],v3,17408
M v[156:159],a[88:91],a[160:163],v[156:159]
buffer_load_dwordx4 v8, s[16:19], s21 offen offset:0  nt lds
M v[188:191],a[88:91],a[168:171],v[188:191]
R a[160:163],v5,53248
R a[164:167],v6,53248
M v[188:191],a[92:95],a[172:175],v[188:191]
E v31,v31
M v[184:187],a[84:87],a[172:175],v[184:187]
C v25,v20,v21
M v[184:187],a[80:83],a[168:171],v[184:187]
v_lshlrev_b32 v20, 16, v25
M v[180:183],a[72:75],a[168:171],v[180:183]
v_and_b32 v21, 0xffff0000, v25
M v[180:183],a[76:79],a[172:175],v[180:183]
s_nop 0
T a[148:149],v3,24576
T a[150:151],v3,25600
M v[176:179],a[68:71],a[172:175],v[176:179]
buffer_load_dwordx4 v9, s[16:19], s21 offen offset:1024  nt lds
M v[176:179],a[64:67],a[168:171],v[176:179]
C v25,v22,v23
M v[172:175],a[56:59],a[168:171],v[172:175]
v_lshlrev_b32 v22, 16, v25
M v[172:175],a[60:63],a[172:175],v[172:175]
v_and_b32 v23, 0xffff0000, v25
M v[168:171],a[52:55],a[172:175],v[168:171]
AF v28,1.0,v28
M v[168:171],a[48:51],a[168:171],v[168:171]
AF v29,1.0,v29
M v[164:167],a[40:43],a[168:171],v[164:167]
s_nop 0
T a[152:153],v4,16384
T a[154:155],v4,17408
M v[164:167],a[44:47],a[172:175],v[164:167]
s_waitcnt lgkmcnt(4)
buffer_load_dwordx4 v10, s[16:19], s21 offen offset:2048  nt lds
M v[160:163],a[36:39],a[172:175],v[160:163]
AF v30,1.0,v30
M v[160:163],a[32:35],a[168:171],v[160:163]
AF v31,1.0,v31
M v[192:195],a[32:35],a[160:163],v[192:195]
R a[168:171],v5,55296
R a[172:175],v6,55296
M v[192:195],a[36:39],a[164:167],v[192:195]
v_rcp_f32 v28, v28
M v[196:199],a[44:47],a[164:167],v[196:199]
v_rcp_f32 v29, v29
M v[196:199],a[40:43],a[160:163],v[196:199]
T a[156:157],v4,24576
T a[158:159],v4,25600
M v[200:203],a[48:51],a[160:163],v[200:203]
buffer_load_dwordx4 v11, s[16:19], s21 offen offset:3072  nt lds
M v[200:203],a[52:55],a[164:167],v[200:203]
SA s21,s21,128
v_rcp_f32 v30, v30
M v[204:207],a[60:63],a[164:167],v[204:207]
v_rcp_f32 v31, v31
M v[204:207],a[56:59],a[160:163],v[204:207]
MF v16,v28,v16
M v[208:211],a[64:67],a[160:163],v[208:211]
MF v17,v29,v17
M v[208:211],a[68:71],a[164:167],v[208:211]
MF v18,v30,v18
M v[212:215],a[76:79],a[164:167],v[212:215]
MF v19,v31,v19
M v[212:215],a[72:75],a[160:163],v[212:215]
C v25,v16,v17
M v[216:219],a[80:83],a[160:163],v[216:219]
v_lshlrev_b32 v16, 16, v25
M v[216:219],a[84:87],a[164:167],v[216:219]
s_waitcnt lgkmcnt(2)
v_and_b32 v17, 0xffff0000, v25
M v[220:223],a[92:95],a[164:167],v[220:223]
s_waitcnt vmcnt(22) lgkmcnt(0)
C v25,v18,v19
M v[220:223],a[88:91],a[160:163],v[220:223]
s_barrier
M v[252:255],a[88:91],a[168:171],v[252:255]
R a[160:163],v5,0
R a[164:167],v6,0
M v[252:255],a[92:95],a[172:175],v[252:255]
v_lshlrev_b32 v18, 16, v25
M v[248:251],a[84:87],a[172:175],v[248:251]
v_and_b32 v19, 0xffff0000, v25
M v[248:251],a[80:83],a[168:171],v[248:251]
MF v16,v20,v16
M v[244:247],a[72:75],a[168:171],v[244:247]
MF v17,v21,v17
M v[244:247],a[76:79],a[172:175],v[244:247]
MF v18,v22,v18
M v[240:243],a[68:71],a[172:175],v[240:243]
MF v19,v23,v19
M v[240:243],a[64:67],a[168:171],v[240:243]
C v16,v16,v17
M v[236:239],a[56:59],a[168:171],v[236:239]
C v17,v18,v19
M v[236:239],a[60:63],a[172:175],v[236:239]
M v[232:235],a[52:55],a[172:175],v[232:235]
M v[232:235],a[48:51],a[168:171],v[232:235]
M v[228:231],a[40:43],a[168:171],v[228:231]
M v[228:231],a[44:47],a[172:175],v[228:231]
s_waitcnt lgkmcnt(0)
M v[224:227],a[36:39],a[172:175],v[224:227]
M v[224:227],a[32:35],a[168:171],v[224:227]
M a[0:3],a[96:99],a[160:163],a[0:3]
R a[168:171],v5,2048
R a[172:175],v6,2048
M a[0:3],a[100:103],a[164:167],a[0:3]
T a[32:33],v1,32768
T a[34:35],v1,33792
M a[4:7],a[108:111],a[164:167],a[4:7]
SA m0,s24,49152
v_lshrrev_b32 v28, 4, v0
v_and_b32 v29, 7, v0
M a[4:7],a[104:107],a[160:163],a[4:7]
buffer_load_dwordx4 v12, s[48:51], s22 offen offset:0   lds
M a[8:11],a[112:115],a[160:163],a[8:11]
v_xor_b32 v28, v28, v29
v_lshlrev_b32 v28, 4, v28
M a[8:11],a[116:119],a[164:167],a[8:11]
v_lshrrev_b32 v29, 3, v0
v_mul_u32_u24 v29, 896, v29
M a[12:15],a[124:127],a[164:167],a[12:15]
T a[36:37],v1,40960
T a[38:39],v1,41984
M a[12:15],a[120:123],a[160:163],a[12:15]
v_add_u32 v22, v28, v29
v_xor_b32 v28, 64, v28
M a[16:19],a[128:131],a[160:163],a[16:19]
s_mul_i32 s64, s20, 14336
buffer_load_dwordx4 v13, s[48:51], s22 offen offset:1024   lds
M a[16:19],a[132:135],a[164:167],a[16:19]
s_sub_u32 s65, 98304, s64
M a[20:23],a[140:143],a[164:167],a[20:23]
SA s30,s29,s65
M a[20:23],a[136:139],a[160:163],a[20:23]
SA s29,s29,s64
T a[40:41],v2,32768
T a[42:43],v2,33792
M a[24:27],a[144:147],a[160:163],a[24:27]
v_add_u32 v29, 6144, v29
v_add_u32 v23, v28, v29
M a[24:27],a[148:151],a[164:167],a[24:27]
s_waitcnt lgkmcnt(6)
buffer_load_dwordx4 v14, s[48:51], s22 offen offset:2048   lds
M a[28:31],a[156:159],a[164:167],a[28:31]
s_and_b32 s64, s20, 1
M a[28:31],a[152:155],a[160:163],a[28:31]
s_lshl_b32 s64, s64, 12
M v[60:63],a[152:155],a[168:171],v[60:63]
SA s64,s64,65536
R a[160:163],v5,4096
R a[164:167],v6,4096
M v[60:63],a[156:159],a[172:175],v[60:63]
T a[44:45],v2,40960
T a[46:47],v2,41984
M v[56:59],a[148:151],a[172:175],v[56:59]
buffer_load_dwordx4 v15, s[48:51], s22 offen offset:3072   lds
M v[56:59],a[144:147],a[168:171],v[56:59]
s_sub_u32 s22, s22, 1048448
v_add_u32 v20, s64, v5
v_add_u32 v21, s64, v6
M v[52:55],a[136:139],a[168:171],v[52:55]
v_lshrrev_b32 v28, 2, v0
v_lshlrev_b32 v28, 8, v28
M v[52:55],a[140:143],a[172:175],v[52:55]
T a[48:49],v3,32768
T a[50:51],v3,33792
M v[48:51],a[132:135],a[172:175],v[48:51]
SA m0,s23,16384
v_and_b32 v29, 3, v0
v_lshl_add_u32 v28, v29, 3, v28
M v[48:51],a[128:131],a[168:171],v[48:51]
buffer_load_dwordx4 v8, s[16:19], s21 offen offset:0  nt lds
M v[44:47],a[120:123],a[168:171],v[44:47]
v_add_u32 v28, s87, v28
M v[44:47],a[124:127],a[172:175],v[44:47]
s_waitcnt vmcnt(23)
s_nop 0
T a[176:177],v28,0
T a[178:179],v28,32
M v[40:43],a[116:119],a[172:175],v[40:43]
T a[52:53],v3,40960
T a[54:55],v3,41984
M v[40:43],a[112:115],a[168:171],v[40:43]
T a[180:181],v28,64
T a[182:183],v28,96
M v[36:39],a[104:107],a[168:171],v[36:39]
buffer_load_dwordx4 v9, s[16:19], s21 offen offset:1024  nt lds
M v[36:39],a[108:111],a[172:175],v[36:39]
s_waitcnt lgkmcnt(10)
s_nop 0
T a[184:185],v28,128
T a[186:187],v28,160
M v[32:35],a[100:103],a[172:175],v[32:35]
T a[188:189],v28,192
M v[32:35],a[96:99],a[168:171],v[32:35]
s_nop 0
T a[56:57],v4,32768
T a[58:59],v4,33792
M v[64:67],a[96:99],a[160:163],v[64:67]
R a[168:171],v5,6144
R a[172:175],v6,6144
M v[64:67],a[100:103],a[164:167],v[64:67]
buffer_load_dwordx4 v10, s[16:19], s21 offen offset:2048  nt lds
s_waitcnt lgkmcnt(12)
v_mfma_f32_16x16x16_bf16 a[192:195], a[176:177], v[16:17], 0
M v[68:71],a[108:111],a[164:167],v[68:71]
v_mov_b32 v18, v16 row_shr:2 row_mask:0xf bank_mask:0xf bound_ctrl:0
v_mov_b32 v19, v17 row_shr:2 row_mask:0xf bank_mask:0xf bound_ctrl:0
M v[68:71],a[104:107],a[160:163],v[68:71]
M v[72:75],a[112:115],a[160:163],v[72:75]
s_nop 0
T a[60:61],v4,40960
T a[62:63],v4,41984
M v[72:75],a[116:119],a[164:167],v[72:75]
s_waitcnt lgkmcnt(13)
v_mfma_f32_16x16x16_bf16 a[192:195], a[178:179], v[18:19], a[192:195]
M v[76:79],a[124:127],a[164:167],v[76:79]
buffer_load_dwordx4 v11, s[16:19], s21 offen offset:3072  nt lds
M v[76:79],a[120:123],a[160:163],v[76:79]
SA s21,s21,524160
v_mov_b32 v16, v18 row_shr:2 row_mask:0xf bank_mask:0xf bound_ctrl:0
v_mov_b32 v17, v19 row_shr:2 row_mask:0xf bank_mask:0xf bound_ctrl:0
M v[80:83],a[128:131],a[160:163],v[80:83]
M v[80:83],a[132:135],a[164:167],v[80:83]
s_waitcnt lgkmcnt(10)
v_mfma_f32_16x16x16_bf16 a[192:195], a[180:181], v[16:17], a[192:195]
M v[84:87],a[140:143],a[164:167],v[84:87]
v_mov_b32 v18, v16 row_shr:2 row_mask:0xf bank_mask:0xf bound_ctrl:0
v_mov_b32 v19, v17 row_shr:2 row_mask:0xf bank_mask:0xf bound_ctrl:0
M v[84:87],a[136:139],a[160:163],v[84:87]
M v[88:91],a[144:147],a[160:163],v[88:91]
M v[88:91],a[148:151],a[164:167],v[88:91]
s_waitcnt lgkmcnt(2)
v_mfma_f32_16x16x16_bf16 a[192:195], a[182:183], v[18:19], a[192:195]
M v[92:95],a[156:159],a[164:167],v[92:95]
s_waitcnt vmcnt(16) lgkmcnt(0)
v_mov_b32 v16, v18 row_shr:2 row_mask:0xf bank_mask:0xf bound_ctrl:0
v_mov_b32 v17, v19 row_shr:2 row_mask:0xf bank_mask:0xf bound_ctrl:0
M v[92:95],a[152:155],a[160:163],v[92:95]
s_barrier
M v[124:127],a[152:155],a[168:171],v[124:127]
R a[160:163],v5,16384
R a[164:167],v6,16384
M v[124:127],a[156:159],a[172:175],v[124:127]
SA m0,s23,131072
v_mfma_f32_16x16x16_bf16 a[192:195], a[184:185], v[16:17], a[192:195]
M v[120:123],a[148:151],a[172:175],v[120:123]
s_nop 0
T a[64:65],v1,49152
T a[66:67],v1,50176
M v[120:123],a[144:147],a[168:171],v[120:123]
v_mov_b32 v18, v16 row_shr:2 row_mask:0xf bank_mask:0xf bound_ctrl:0
v_mov_b32 v19, v17 row_shr:2 row_mask:0xf bank_mask:0xf bound_ctrl:0
M v[116:119],a[136:139],a[168:171],v[116:119]
buffer_load_dwordx4 v22, s[56:59], s29 offen offset:0 lds
M v[116:119],a[140:143],a[172:175],v[116:119]
v_mfma_f32_16x16x16_bf16 a[192:195], a[186:187], v[18:19], a[192:195]
M v[112:115],a[132:135],a[172:175],v[112:115]
v_mov_b32 v16, v18 row_shr:2 row_mask:0xf bank_mask:0xf bound_ctrl:0
v_mov_b32 v17, v19 row_shr:2 row_mask:0xf bank_mask:0xf bound_ctrl:0
M v[112:115],a[128:131],a[168:171],v[112:115]
buffer_load_dwordx4 v23, s[56:59], s29 offen offset:1024 lds
M v[108:111],a[120:123],a[168:171],v[108:111]
M v[108:111],a[124:127],a[172:175],v[108:111]
s_nop 0
T a[68:69],v1,57344
T a[70:71],v1,58368
v_mfma_f32_16x16x16_bf16 a[192:195], a[188:189], v[16:17], a[192:195]
M v[104:107],a[116:119],a[172:175],v[104:107]
buffer_load_dwordx4 v22, s[56:59], s30 offen offset:2048 lds
M v[104:107],a[112:115],a[168:171],v[104:107]
v_and_b32 v29, 1, v0
v_mul_u32_u24 v30, 1792, v29
M v[100:103],a[104:107],a[168:171],v[100:103]
v_lshrrev_b32 v31, 4, v0
v_lshl_add_u32 v30, v31, 4, v30
M v[100:103],a[108:111],a[172:175],v[100:103]
s_waitcnt lgkmcnt(4)
v_bfe_u32 v29, v0, 1, 3
v_lshl_add_u32 v30, v29, 6, v30
M v[96:99],a[100:103],a[172:175],v[96:99]
v_add_u32 v29, 1, v29
v_lshrrev_b32 v29, 3, v29
M v[96:99],a[96:99],a[168:171],v[96:99]
v_lshl_or_b32 v30, v29, 29, v30
v_or_b32 v30, s88, v30
M v[128:131],a[96:99],a[160:163],v[128:131]
s_mul_i32 s89, s86, 3584
R a[168:171],v5,18432
R a[172:175],v6,18432
M v[128:131],a[100:103],a[164:167],v[128:131]
s_mul_i32 s64, s20, 448
T a[72:73],v2,49152
T a[74:75],v2,50176
M v[132:135],a[108:111],a[164:167],v[132:135]
SA s89,s89,s64
M v[132:135],a[104:107],a[160:163],v[132:135]
SA s89,s89,105906176
buffer_store_dwordx4 a[192:195], v30, s[8:11], s89 offen sc1
M v[136:139],a[112:115],a[160:163],v[136:139]
M v[136:139],a[116:119],a[164:167],v[136:139]
M v[140:143],a[124:127],a[164:167],v[140:143]
buffer_load_dwordx4 v23, s[56:59], s30 offen offset:3072 lds
M v[140:143],a[120:123],a[160:163],v[140:143]
SA s29,s29,128
T a[76:77],v2,57344
T a[78:79],v2,58368
M v[144:147],a[128:131],a[160:163],v[144:147]
SA s30,s30,128
M v[144:147],a[132:135],a[164:167],v[144:147]
SA m0,s24,0
M v[148:151],a[140:143],a[164:167],v[148:151]
buffer_load_dwordx4 v12, s[48:51], s22 offen offset:0   lds
M v[148:151],a[136:139],a[160:163],v[148:151]
M v[152:155],a[144:147],a[160:163],v[152:155]
M v[152:155],a[148:151],a[164:167],v[152:155]
s_waitcnt lgkmcnt(4)
buffer_load_dwordx4 v13, s[48:51], s22 offen offset:1024   lds
M v[156:159],a[156:159],a[164:167],v[156:159]
s_nop 0
T a[80:81],v3,49152
T a[82:83],v3,50176
M v[156:159],a[152:155],a[160:163],v[156:159]
M v[188:191],a[152:155],a[168:171],v[188:191]
R a[160:163],v5,20480
R a[164:167],v6,20480
M v[188:191],a[156:159],a[172:175],v[188:191]
buffer_load_dwordx4 v14, s[48:51], s22 offen offset:2048   lds
M v[184:187],a[148:151],a[172:175],v[184:187]
M v[184:187],a[144:147],a[168:171],v[184:187]
M v[180:183],a[136:139],a[168:171],v[180:183]
buffer_load_dwordx4 v15, s[48:51], s22 offen offset:3072   lds
M v[180:183],a[140:143],a[172:175],v[180:183]
SA s22,s22,1048576
T a[84:85],v3,57344
T a[86:87],v3,58368
M v[176:179],a[132:135],a[172:175],v[176:179]
SA m0,s23,32768
M v[176:179],a[128:131],a[168:171],v[176:179]
buffer_load_dwordx4 v8, s[16:19], s21 offen offset:0  nt lds
L_w_kv06:
s_cbranch_execz L_wd1
M v[172:175],a[120:123],a[168:171],v[172:175]
M v[172:175],a[124:127],a[172:175],v[172:175]
M v[168:171],a[116:119],a[172:175],v[168:171]
M v[168:171],a[112:115],a[168:171],v[168:171]
buffer_load_dwordx4 v9, s[16:19], s21 offen offset:1024  nt lds
M v[164:167],a[104:107],a[168:171],v[164:167]
s_nop 0
T a[88:89],v4,49152
T a[90:91],v4,50176
M v[164:167],a[108:111],a[172:175],v[164:167]
s_waitcnt lgkmcnt(4)
M v[160:163],a[100:103],a[172:175],v[160:163]
M v[160:163],a[96:99],a[168:171],v[160:163]
M v[192:195],a[96:99],a[160:163],v[192:195]
R a[168:171],v5,22528
R a[172:175],v6,22528
M v[192:195],a[100:103],a[164:167],v[192:195]
buffer_load_dwordx4 v10, s[16:19], s21 offen offset:2048  nt lds
M v[196:199],a[108:111],a[164:167],v[196:199]
M v[196:199],a[104:107],a[160:163],v[196:199]
s_nop 0
T a[92:93],v4,57344
T a[94:95],v4,58368
M v[200:203],a[112:115],a[160:163],v[200:203]
M v[200:203],a[116:119],a[164:167],v[200:203]
buffer_load_dwordx4 v11, s[16:19], s21 offen offset:3072  nt lds
M v[204:207],a[124:127],a[164:167],v[204:207]
M v[204:207],a[120:123],a[160:163],v[204:207]
M v[208:211],a[128:131],a[160:163],v[208:211]
M v[208:211],a[132:135],a[164:167],v[208:211]
M v[212:215],a[140:143],a[164:167],v[212:215]
SA s21,s21,128
M v[212:215],a[136:139],a[160:163],v[212:215]
M v[216:219],a[144:147],a[160:163],v[216:219]
M v[216:219],a[148:151],a[164:167],v[216:219]
s_waitcnt lgkmcnt(2)
M v[220:223],a[156:159],a[164:167],v[220:223]
s_waitcnt vmcnt(21) lgkmcnt(0)
M v[220:223],a[152:155],a[160:163],v[220:223]
s_barrier
M v[252:255],a[152:155],a[168:171],v[252:255]
R a[160:163],v5,32768
R a[164:167],v6,32768
M v[252:255],a[156:159],a[172:175],v[252:255]
M v[248:251],a[148:151],a[172:175],v[248:251]
M v[248:251],a[144:147],a[168:171],v[248:251]
M v[244:247],a[136:139],a[168:171],v[244:247]
M v[244:247],a[140:143],a[172:175],v[244:247]
M v[240:243],a[132:135],a[172:175],v[240:243]
M v[240:243],a[128:131],a[168:171],v[240:243]
M v[236:239],a[120:123],a[168:171],v[236:239]
M v[236:239],a[124:127],a[172:175],v[236:239]
M v[232:235],a[116:119],a[172:175],v[232:235]
M v[232:235],a[112:115],a[168:171],v[232:235]
M v[228:231],a[104:107],a[168:171],v[228:231]
M v[228:231],a[108:111],a[172:175],v[228:231]
s_waitcnt lgkmcnt(0)
M v[224:227],a[100:103],a[172:175],v[224:227]
M v[224:227],a[96:99],a[168:171],v[224:227]
M a[0:3],a[32:35],a[160:163],a[0:3]
R a[168:171],v5,34816
R a[172:175],v6,34816
M a[0:3],a[36:39],a[164:167],a[0:3]
SA m0,s23,147456
T a[96:97],v1,0
T a[98:99],v1,1024
M a[4:7],a[44:47],a[164:167],a[4:7]
buffer_load_dwordx4 v22, s[56:59], s29 offen offset:0 lds
M a[4:7],a[40:43],a[160:163],a[4:7]
M a[8:11],a[48:51],a[160:163],a[8:11]
M a[8:11],a[52:55],a[164:167],a[8:11]
buffer_load_dwordx4 v23, s[56:59], s29 offen offset:1024 lds
M a[12:15],a[60:63],a[164:167],a[12:15]
s_nop 0
T a[100:101],v1,8192
T a[102:103],v1,9216
M a[12:15],a[56:59],a[160:163],a[12:15]
M a[16:19],a[64:67],a[160:163],a[16:19]
buffer_load_dwordx4 v22, s[56:59], s30 offen offset:2048 lds
M a[16:19],a[68:71],a[164:167],a[16:19]
M a[20:23],a[76:79],a[164:167],a[20:23]
M a[20:23],a[72:75],a[160:163],a[20:23]
s_nop 0
T a[104:105],v2,0
T a[106:107],v2,1024
M a[24:27],a[80:83],a[160:163],a[24:27]
buffer_load_dwordx4 v23, s[56:59], s30 offen offset:3072 lds
M a[24:27],a[84:87],a[164:167],a[24:27]
s_waitcnt lgkmcnt(6)
M a[28:31],a[92:95],a[164:167],a[28:31]
SA s29,s29,128
M a[28:31],a[88:91],a[160:163],a[28:31]
SA s30,s30,128
M v[60:63],a[88:91],a[168:171],v[60:63]
SA m0,s24,16384
R a[160:163],v5,36864
R a[164:167],v6,36864
M v[60:63],a[92:95],a[172:175],v[60:63]
T a[108:109],v2,8192
T a[110:111],v2,9216
M v[56:59],a[84:87],a[172:175],v[56:59]
buffer_load_dwordx4 v12, s[48:51], s22 offen offset:0   lds
M v[56:59],a[80:83],a[168:171],v[56:59]
M v[52:55],a[72:75],a[168:171],v[52:55]
M v[52:55],a[76:79],a[172:175],v[52:55]
s_nop 0
T a[112:113],v3,0
T a[114:115],v3,1024
M v[48:51],a[68:71],a[172:175],v[48:51]
buffer_load_dwordx4 v13, s[48:51], s22 offen offset:1024   lds
M v[48:51],a[64:67],a[168:171],v[48:51]
M v[44:47],a[56:59],a[168:171],v[44:47]
M v[44:47],a[60:63],a[172:175],v[44:47]
buffer_load_dwordx4 v14, s[48:51], s22 offen offset:2048   lds
M v[40:43],a[52:55],a[172:175],v[40:43]
s_nop 0
T a[116:117],v3,8192
T a[118:119],v3,9216
M v[40:43],a[48:51],a[168:171],v[40:43]
M v[36:39],a[40:43],a[168:171],v[36:39]
buffer_load_dwordx4 v15, s[48:51], s22 offen offset:3072   lds
M v[36:39],a[44:47],a[172:175],v[36:39]
s_waitcnt lgkmcnt(6)
M v[32:35],a[36:39],a[172:175],v[32:35]
s_sub_u32 s22, s22, 1048448
M v[32:35],a[32:35],a[168:171],v[32:35]
SA m0,s23,49152
T a[120:121],v4,0
T a[122:123],v4,1024
M v[64:67],a[32:35],a[160:163],v[64:67]
R a[168:171],v5,38912
R a[172:175],v6,38912
M v[64:67],a[36:39],a[164:167],v[64:67]
buffer_load_dwordx4 v8, s[16:19], s21 offen offset:0  nt lds
M v[68:71],a[44:47],a[164:167],v[68:71]
M v[68:71],a[40:43],a[160:163],v[68:71]
M v[72:75],a[48:51],a[160:163],v[72:75]
s_waitcnt vmcnt(17)
s_nop 0
T a[124:125],v4,8192
T a[126:127],v4,9216
M v[72:75],a[52:55],a[164:167],v[72:75]
buffer_load_dwordx4 v9, s[16:19], s21 offen offset:1024  nt lds
M v[76:79],a[60:63],a[164:167],v[76:79]
R a[176:179],v20,0
R a[180:183],v20,2048
M v[76:79],a[56:59],a[160:163],v[76:79]
R a[184:187],v21,0
R a[188:191],v21,2048
M v[80:83],a[64:67],a[160:163],v[80:83]
buffer_load_dwordx4 v10, s[16:19], s21 offen offset:2048  nt lds
M v[80:83],a[68:71],a[164:167],v[80:83]
M v[84:87],a[76:79],a[164:167],v[84:87]
M v[84:87],a[72:75],a[160:163],v[84:87]
buffer_load_dwordx4 v11, s[16:19], s21 offen offset:3072  nt lds
M v[88:91],a[80:83],a[160:163],v[88:91]
SA s21,s21,524160
M v[88:91],a[84:87],a[164:167],v[88:91]
s_waitcnt lgkmcnt(6)
M v[92:95],a[92:95],a[164:167],v[92:95]
s_waitcnt lgkmcnt(0)
M v[92:95],a[88:91],a[160:163],v[92:95]
s_barrier
M v[124:127],a[88:91],a[168:171],v[124:127]
s_lshl_b32 s4, s20, 10
R a[160:163],v5,49152
R a[164:167],v6,49152
M v[124:127],a[92:95],a[172:175],v[124:127]
SA m0,s23,131072
v_bfe_u32 v28, v0, 3, 2
M v[120:123],a[84:87],a[172:175],v[120:123]
s_nop 0
T a[128:129],v1,16384
T a[130:131],v1,17408
M v[120:123],a[80:83],a[168:171],v[120:123]
buffer_load_dwordx4 v22, s[56:59], s29 offen offset:0 lds
M v[116:119],a[72:75],a[168:171],v[116:119]
v_lshrrev_b32 v29, 5, v0
v_lshl_add_u32 v28, v29, 3, v28
M v[116:119],a[76:79],a[172:175],v[116:119]
M v[112:115],a[68:71],a[172:175],v[112:115]
v_lshlrev_b32 v28, 13, v28
M v[112:115],a[64:67],a[168:171],v[112:115]
M v[108:111],a[56:59],a[168:171],v[108:111]
buffer_load_dwordx4 v23, s[56:59], s29 offen offset:1024 lds
M v[108:111],a[60:63],a[172:175],v[108:111]
s_nop 0
T a[132:133],v1,24576
T a[134:135],v1,25600
M v[104:107],a[52:55],a[172:175],v[104:107]
v_lshrrev_b32 v29, 4, v0
v_lshlrev_b32 v29, 1, v29
M v[104:107],a[48:51],a[168:171],v[104:107]
M v[100:103],a[40:43],a[168:171],v[100:103]
v_and_b32 v30, 7, v0
M v[100:103],a[44:47],a[172:175],v[100:103]
s_waitcnt lgkmcnt(4)
M v[96:99],a[36:39],a[172:175],v[96:99]
v_xor_b32 v29, v29, v30
M v[96:99],a[32:35],a[168:171],v[96:99]
buffer_load_dwordx4 v22, s[56:59], s30 offen offset:2048 lds
M v[128:131],a[32:35],a[160:163],v[128:131]
R a[168:171],v5,51200
R a[172:175],v6,51200
M v[128:131],a[36:39],a[164:167],v[128:131]
T a[136:137],v2,16384
T a[138:139],v2,17408
M v[132:135],a[44:47],a[164:167],v[132:135]
v_lshl_add_u32 v28, v29, 4, v28
M v[132:135],a[40:43],a[160:163],v[132:135]
s_and_b32 s64, s20, 1
M v[136:139],a[48:51],a[160:163],v[136:139]
s_lshl_b32 s64, s64, 17
M v[136:139],a[52:55],a[164:167],v[136:139]
s_lshr_b32 s65, s20, 1
M v[140:143],a[60:63],a[164:167],v[140:143]
s_lshl_b32 s65, s65, 15
SA s64,s64,s65
v_add_u32 v8, s64, v28
M v[140:143],a[56:59],a[160:163],v[140:143]
s_nop 0
T a[140:141],v2,24576
T a[142:143],v2,25600
M v[144:147],a[64:67],a[160:163],v[144:147]
buffer_load_dwordx4 v23, s[56:59], s30 offen offset:3072 lds
M v[144:147],a[68:71],a[164:167],v[144:147]
M v[148:151],a[76:79],a[164:167],v[148:151]
SA s29,s29,128
M v[148:151],a[72:75],a[160:163],v[148:151]
SA s30,s30,128
M v[152:155],a[80:83],a[160:163],v[152:155]
SA m0,s24,32768
M v[152:155],a[84:87],a[164:167],v[152:155]
s_waitcnt lgkmcnt(4)
buffer_load_dwordx4 v12, s[48:51], s22 offen offset:0   lds
M v[156:159],a[92:95],a[164:167],v[156:159]
s_nop 0
T a[144:145],v3,16384
T a[146:147],v3,17408
M v[156:159],a[88:91],a[160:163],v[156:159]
M v[188:191],a[88:91],a[168:171],v[188:191]
R a[160:163],v5,53248
R a[164:167],v6,53248
M v[188:191],a[92:95],a[172:175],v[188:191]
M v[184:187],a[84:87],a[172:175],v[184:187]
M v[184:187],a[80:83],a[168:171],v[184:187]
M v[180:183],a[72:75],a[168:171],v[180:183]
buffer_load_dwordx4 v13, s[48:51], s22 offen offset:1024   lds
M v[180:183],a[76:79],a[172:175],v[180:183]
s_nop 0
T a[148:149],v3,24576
T a[150:151],v3,25600
M v[176:179],a[68:71],a[172:175],v[176:179]
M v[176:179],a[64:67],a[168:171],v[176:179]
M v[172:175],a[56:59],a[168:171],v[172:175]
M v[172:175],a[60:63],a[172:175],v[172:175]
M v[168:171],a[52:55],a[172:175],v[168:171]
M v[168:171],a[48:51],a[168:171],v[168:171]
buffer_load_dwordx4 v14, s[48:51], s22 offen offset:2048   lds
M v[164:167],a[40:43],a[168:171],v[164:167]
s_nop 0
T a[152:153],v4,16384
T a[154:155],v4,17408
M v[164:167],a[44:47],a[172:175],v[164:167]
s_waitcnt lgkmcnt(4)
M v[160:163],a[36:39],a[172:175],v[160:163]
M v[160:163],a[32:35],a[168:171],v[160:163]
M v[192:195],a[32:35],a[160:163],v[192:195]
R a[168:171],v5,55296
R a[172:175],v6,55296
M v[192:195],a[36:39],a[164:167],v[192:195]
M v[196:199],a[44:47],a[164:167],v[196:199]
buffer_load_dwordx4 v15, s[48:51], s22 offen offset:3072   lds
M v[196:199],a[40:43],a[160:163],v[196:199]
s_nop 0
T a[156:157],v4,24576
T a[158:159],v4,25600
M v[200:203],a[48:51],a[160:163],v[200:203]
s_waitcnt vmcnt(16)
R a[192:195],v20,16384
R a[196:199],v20,18432
M v[200:203],a[52:55],a[164:167],v[200:203]
R a[200:203],v21,16384
R a[204:207],v21,18432
M v[204:207],a[60:63],a[164:167],v[204:207]
M v[204:207],a[56:59],a[160:163],v[204:207]
M v[208:211],a[64:67],a[160:163],v[208:211]
M v[208:211],a[68:71],a[164:167],v[208:211]
M v[212:215],a[76:79],a[164:167],v[212:215]
SA s22,s22,1048576
M v[212:215],a[72:75],a[160:163],v[212:215]
M v[216:219],a[80:83],a[160:163],v[216:219]
M v[216:219],a[84:87],a[164:167],v[216:219]
s_waitcnt lgkmcnt(6)
M v[220:223],a[92:95],a[164:167],v[220:223]
s_waitcnt lgkmcnt(0)
M v[220:223],a[88:91],a[160:163],v[220:223]
s_barrier
M v[252:255],a[88:91],a[168:171],v[252:255]
R a[160:163],v5,0
R a[164:167],v6,0
M v[252:255],a[92:95],a[172:175],v[252:255]
M v[248:251],a[84:87],a[172:175],v[248:251]
M v[248:251],a[80:83],a[168:171],v[248:251]
M v[244:247],a[72:75],a[168:171],v[244:247]
M v[244:247],a[76:79],a[172:175],v[244:247]
M v[240:243],a[68:71],a[172:175],v[240:243]
M v[240:243],a[64:67],a[168:171],v[240:243]
M v[236:239],a[56:59],a[168:171],v[236:239]
M v[236:239],a[60:63],a[172:175],v[236:239]
M v[232:235],a[52:55],a[172:175],v[232:235]
M v[232:235],a[48:51],a[168:171],v[232:235]
M v[228:231],a[40:43],a[168:171],v[228:231]
M v[228:231],a[44:47],a[172:175],v[228:231]
s_waitcnt lgkmcnt(0)
M v[224:227],a[36:39],a[172:175],v[224:227]
M v[224:227],a[32:35],a[168:171],v[224:227]
M a[0:3],a[96:99],a[160:163],a[0:3]
R a[168:171],v5,2048
R a[172:175],v6,2048
M a[0:3],a[100:103],a[164:167],a[0:3]
SA m0,s23,147456
T a[32:33],v1,32768
T a[34:35],v1,33792
M a[4:7],a[108:111],a[164:167],a[4:7]
buffer_load_dwordx4 v22, s[56:59], s29 offen offset:0 lds
M a[4:7],a[104:107],a[160:163],a[4:7]
M a[8:11],a[112:115],a[160:163],a[8:11]
M a[8:11],a[116:119],a[164:167],a[8:11]
buffer_load_dwordx4 v23, s[56:59], s29 offen offset:1024 lds
M a[12:15],a[124:127],a[164:167],a[12:15]
s_nop 0
T a[36:37],v1,40960
T a[38:39],v1,41984
M a[12:15],a[120:123],a[160:163],a[12:15]
M a[16:19],a[128:131],a[160:163],a[16:19]
buffer_load_dwordx4 v22, s[56:59], s30 offen offset:2048 lds
M a[16:19],a[132:135],a[164:167],a[16:19]
M a[20:23],a[140:143],a[164:167],a[20:23]
M a[20:23],a[136:139],a[160:163],a[20:23]
s_nop 0
T a[40:41],v2,32768
T a[42:43],v2,33792
M a[24:27],a[144:147],a[160:163],a[24:27]
buffer_load_dwordx4 v23, s[56:59], s30 offen offset:3072 lds
M a[24:27],a[148:151],a[164:167],a[24:27]
s_waitcnt lgkmcnt(6)
M a[28:31],a[156:159],a[164:167],a[28:31]
SA s29,s29,128
M a[28:31],a[152:155],a[160:163],a[28:31]
SA s30,s30,128
M v[60:63],a[152:155],a[168:171],v[60:63]
SA m0,s24,49152
R a[160:163],v5,4096
R a[164:167],v6,4096
M v[60:63],a[156:159],a[172:175],v[60:63]
T a[44:45],v2,40960
T a[46:47],v2,41984
M v[56:59],a[148:151],a[172:175],v[56:59]
buffer_load_dwordx4 v12, s[48:51], s22 offen offset:0   lds
M v[56:59],a[144:147],a[168:171],v[56:59]
M v[52:55],a[136:139],a[168:171],v[52:55]
M v[52:55],a[140:143],a[172:175],v[52:55]
s_nop 0
T a[48:49],v3,32768
T a[50:51],v3,33792
M v[48:51],a[132:135],a[172:175],v[48:51]
buffer_load_dwordx4 v13, s[48:51], s22 offen offset:1024   lds
M v[48:51],a[128:131],a[168:171],v[48:51]
M v[44:47],a[120:123],a[168:171],v[44:47]
M v[44:47],a[124:127],a[172:175],v[44:47]
buffer_load_dwordx4 v14, s[48:51], s22 offen offset:2048   lds
M v[40:43],a[116:119],a[172:175],v[40:43]
s_nop 0
T a[52:53],v3,40960
T a[54:55],v3,41984
M v[40:43],a[112:115],a[168:171],v[40:43]
M v[36:39],a[104:107],a[168:171],v[36:39]
buffer_load_dwordx4 v15, s[48:51], s22 offen offset:3072   lds
M v[36:39],a[108:111],a[172:175],v[36:39]
s_waitcnt lgkmcnt(6)
M v[32:35],a[100:103],a[172:175],v[32:35]
s_sub_u32 s22, s22, 1048448
M v[32:35],a[96:99],a[168:171],v[32:35]
s_mov_b32 s25, 0
T a[56:57],v4,32768
T a[58:59],v4,33792
M v[64:67],a[96:99],a[160:163],v[64:67]
SA m0,s4,0
R a[168:171],v5,6144
R a[172:175],v6,6144
M v[64:67],a[100:103],a[164:167],v[64:67]
buffer_load_dwordx4 v8, s[52:55], s25 offen lds
M v[68:71],a[108:111],a[164:167],v[68:71]
s_mov_b32 s25, 262144
M v[68:71],a[104:107],a[160:163],v[68:71]
SA m0,s4,4096
M v[72:75],a[112:115],a[160:163],v[72:75]
s_waitcnt vmcnt(13)
s_nop 0
T a[60:61],v4,40960
T a[62:63],v4,41984
M v[72:75],a[116:119],a[164:167],v[72:75]
buffer_load_dwordx4 v8, s[52:55], s25 offen lds
M v[76:79],a[124:127],a[164:167],v[76:79]
s_mov_b32 s25, 524288
R a[208:211],v20,0
R a[212:215],v20,2048
M v[76:79],a[120:123],a[160:163],v[76:79]
SA m0,s4,8192
R a[216:219],v21,0
R a[220:223],v21,2048
M v[80:83],a[128:131],a[160:163],v[80:83]
buffer_load_dwordx4 v8, s[52:55], s25 offen lds
M v[80:83],a[132:135],a[164:167],v[80:83]
s_mov_b32 s25, 786432
M v[84:87],a[140:143],a[164:167],v[84:87]
SA m0,s4,12288
M v[84:87],a[136:139],a[160:163],v[84:87]
buffer_load_dwordx4 v8, s[52:55], s25 offen lds
M v[88:91],a[144:147],a[160:163],v[88:91]
M v[88:91],a[148:151],a[164:167],v[88:91]
s_waitcnt lgkmcnt(6)
M v[92:95],a[156:159],a[164:167],v[92:95]
s_waitcnt lgkmcnt(0)
M v[92:95],a[152:155],a[160:163],v[92:95]
s_barrier
M v[124:127],a[152:155],a[168:171],v[124:127]
R a[160:163],v5,16384
R a[164:167],v6,16384
M v[124:127],a[156:159],a[172:175],v[124:127]
SA m0,s23,32768
M v[120:123],a[148:151],a[172:175],v[120:123]
s_nop 0
T a[64:65],v1,49152
T a[66:67],v1,50176
M v[120:123],a[144:147],a[168:171],v[120:123]
buffer_load_dwordx4 v22, s[56:59], s29 offen offset:0 lds
M v[116:119],a[136:139],a[168:171],v[116:119]
v_lshrrev_b32 v28, 2, v0
v_lshlrev_b32 v28, 7, v28
M v[116:119],a[140:143],a[172:175],v[116:119]
M v[112:115],a[132:135],a[172:175],v[112:115]
buffer_load_dwordx4 v23, s[56:59], s29 offen offset:1024 lds
M v[112:115],a[128:131],a[168:171],v[112:115]
v_and_b32 v29, 3, v0
M v[108:111],a[120:123],a[168:171],v[108:111]
v_lshl_add_u32 v28, v29, 3, v28
M v[108:111],a[124:127],a[172:175],v[108:111]
s_nop 0
T a[68:69],v1,57344
T a[70:71],v1,58368
M v[104:107],a[116:119],a[172:175],v[104:107]
buffer_load_dwordx4 v22, s[56:59], s30 offen offset:2048 lds
M v[104:107],a[112:115],a[168:171],v[104:107]
v_bfe_u32 v29, v0, 3, 2
M v[100:103],a[104:107],a[168:171],v[100:103]
M v[100:103],a[108:111],a[172:175],v[100:103]
s_waitcnt lgkmcnt(4)
v_lshl_add_u32 v16, v29, 5, v28
M v[96:99],a[100:103],a[172:175],v[96:99]
M v[96:99],a[96:99],a[168:171],v[96:99]
buffer_load_dwordx4 v23, s[56:59], s30 offen offset:3072 lds
M v[128:131],a[96:99],a[160:163],v[128:131]
R a[168:171],v5,18432
R a[172:175],v6,18432
M v[128:131],a[100:103],a[164:167],v[128:131]
SA s29,s29,128
T a[72:73],v2,49152
T a[74:75],v2,50176
M v[132:135],a[108:111],a[164:167],v[132:135]
SA s30,s30,128
v_xor_b32 v17, 32, v16
v_xor_b32 v18, 64, v16
M v[132:135],a[104:107],a[160:163],v[132:135]
SA m0,s23,65536
M v[136:139],a[112:115],a[160:163],v[136:139]
buffer_load_dwordx4 v22, s[56:59], s29 offen offset:0 lds
M v[136:139],a[116:119],a[164:167],v[136:139]
v_xor_b32 v19, 0x60, v16
M v[140:143],a[124:127],a[164:167],v[140:143]
v_add_u32 v12, 0x20000, v16
M v[140:143],a[120:123],a[160:163],v[140:143]
s_nop 0
T a[76:77],v2,57344
T a[78:79],v2,58368
M v[144:147],a[128:131],a[160:163],v[144:147]
buffer_load_dwordx4 v23, s[56:59], s29 offen offset:1024 lds
M v[144:147],a[132:135],a[164:167],v[144:147]
v_add_u32 v13, 0x20000, v17
M v[148:151],a[140:143],a[164:167],v[148:151]
M v[148:151],a[136:139],a[160:163],v[148:151]
v_add_u32 v14, 0x20000, v18
M v[152:155],a[144:147],a[160:163],v[152:155]
M v[152:155],a[148:151],a[164:167],v[152:155]
s_waitcnt lgkmcnt(4)
buffer_load_dwordx4 v22, s[56:59], s30 offen offset:2048 lds
M v[156:159],a[156:159],a[164:167],v[156:159]
s_nop 0
T a[80:81],v3,49152
T a[82:83],v3,50176
M v[156:159],a[152:155],a[160:163],v[156:159]
v_add_u32 v15, 0x20000, v19
M v[188:191],a[152:155],a[168:171],v[188:191]
R a[160:163],v5,20480
R a[164:167],v6,20480
M v[188:191],a[156:159],a[172:175],v[188:191]
M v[184:187],a[148:151],a[172:175],v[184:187]
buffer_load_dwordx4 v23, s[56:59], s30 offen offset:3072 lds
M v[184:187],a[144:147],a[168:171],v[184:187]
SA s29,s29,128
M v[180:183],a[136:139],a[168:171],v[180:183]
SA s30,s30,128
M v[180:183],a[140:143],a[172:175],v[180:183]
s_mov_b32 s25, 1048576
T a[84:85],v3,57344
T a[86:87],v3,58368
M v[176:179],a[132:135],a[172:175],v[176:179]
SA m0,s4,16384
M v[176:179],a[128:131],a[168:171],v[176:179]
buffer_load_dwordx4 v8, s[52:55], s25 offen lds
M v[172:175],a[120:123],a[168:171],v[172:175]
M v[172:175],a[124:127],a[172:175],v[172:175]
s_mov_b32 s25, 1310720
M v[168:171],a[116:119],a[172:175],v[168:171]
SA m0,s4,20480
M v[168:171],a[112:115],a[168:171],v[168:171]
buffer_load_dwordx4 v8, s[52:55], s25 offen lds
M v[164:167],a[104:107],a[168:171],v[164:167]
s_nop 0
T a[88:89],v4,49152
T a[90:91],v4,50176
M v[164:167],a[108:111],a[172:175],v[164:167]
s_waitcnt lgkmcnt(4)
M v[160:163],a[100:103],a[172:175],v[160:163]
s_mov_b32 s25, 1572864
M v[160:163],a[96:99],a[168:171],v[160:163]
SA m0,s4,24576
M v[192:195],a[96:99],a[160:163],v[192:195]
R a[168:171],v5,22528
R a[172:175],v6,22528
M v[192:195],a[100:103],a[164:167],v[192:195]
buffer_load_dwordx4 v8, s[52:55], s25 offen lds
M v[196:199],a[108:111],a[164:167],v[196:199]
M v[196:199],a[104:107],a[160:163],v[196:199]
s_mov_b32 s25, 1835008
T a[92:93],v4,57344
L_w_kv07:
s_cbranch_execz L_wd1
T a[94:95],v4,58368
M v[200:203],a[112:115],a[160:163],v[200:203]
SA m0,s4,28672
M v[200:203],a[116:119],a[164:167],v[200:203]
s_waitcnt vmcnt(19)
buffer_load_dwordx4 v8, s[52:55], s25 offen lds
M v[204:207],a[124:127],a[164:167],v[204:207]
R a[224:227],v20,16384
R a[228:231],v20,18432
M v[204:207],a[120:123],a[160:163],v[204:207]
R a[232:235],v21,16384
R a[236:239],v21,18432
M v[208:211],a[128:131],a[160:163],v[208:211]
v_subrev_u32 v20, 98304, v20
v_subrev_u32 v21, 98304, v21
M v[208:211],a[132:135],a[164:167],v[208:211]
M v[212:215],a[140:143],a[164:167],v[212:215]
M v[212:215],a[136:139],a[160:163],v[212:215]
M v[216:219],a[144:147],a[160:163],v[216:219]
M v[216:219],a[148:151],a[164:167],v[216:219]
s_waitcnt lgkmcnt(6)
M v[220:223],a[156:159],a[164:167],v[220:223]
s_waitcnt lgkmcnt(0)
M v[220:223],a[152:155],a[160:163],v[220:223]
s_barrier
M v[252:255],a[152:155],a[168:171],v[252:255]
R a[160:163],v5,32768
R a[164:167],v6,32768
M v[252:255],a[156:159],a[172:175],v[252:255]
M v[248:251],a[148:151],a[172:175],v[248:251]
M v[248:251],a[144:147],a[168:171],v[248:251]
M v[244:247],a[136:139],a[168:171],v[244:247]
M v[244:247],a[140:143],a[172:175],v[244:247]
M v[240:243],a[132:135],a[172:175],v[240:243]
M v[240:243],a[128:131],a[168:171],v[240:243]
M v[236:239],a[120:123],a[168:171],v[236:239]
M v[236:239],a[124:127],a[172:175],v[236:239]
M v[232:235],a[116:119],a[172:175],v[232:235]
M v[232:235],a[112:115],a[168:171],v[232:235]
M v[228:231],a[104:107],a[168:171],v[228:231]
M v[228:231],a[108:111],a[172:175],v[228:231]
s_waitcnt lgkmcnt(0)
M v[224:227],a[100:103],a[172:175],v[224:227]
M v[224:227],a[96:99],a[168:171],v[224:227]
M a[0:3],a[32:35],a[160:163],a[0:3]
R a[168:171],v5,34816
R a[172:175],v6,34816
M a[0:3],a[36:39],a[164:167],a[0:3]
SA m0,s23,81920
M a[4:7],a[44:47],a[164:167],a[4:7]
buffer_load_dwordx4 v22, s[56:59], s29 offen offset:0 lds
M a[4:7],a[40:43],a[160:163],a[4:7]
M a[8:11],a[48:51],a[160:163],a[8:11]
M a[8:11],a[52:55],a[164:167],a[8:11]
buffer_load_dwordx4 v23, s[56:59], s29 offen offset:1024 lds
M a[12:15],a[60:63],a[164:167],a[12:15]
M a[12:15],a[56:59],a[160:163],a[12:15]
G v24,a0
G v25,a1
M a[16:19],a[64:67],a[160:163],a[16:19]
G v26,a2
G v27,a3
M a[16:19],a[68:71],a[164:167],a[16:19]
buffer_load_dwordx4 v22, s[56:59], s30 offen offset:2048 lds
M a[20:23],a[76:79],a[164:167],a[20:23]
G v28,a4
G v29,a5
M a[20:23],a[72:75],a[160:163],a[20:23]
G v30,a6
G v31,a7
M a[24:27],a[80:83],a[160:163],a[24:27]
C v24,v24,v25
C v25,v26,v27
M a[24:27],a[84:87],a[164:167],a[24:27]
s_waitcnt lgkmcnt(0)
buffer_load_dwordx4 v23, s[56:59], s30 offen offset:3072 lds
M a[28:31],a[92:95],a[164:167],a[28:31]
SA s29,s29,128
C v26,v28,v29
C v27,v30,v31
M a[28:31],a[88:91],a[160:163],a[28:31]
SA s3,s93,0
buffer_store_dwordx4 v[24:27], v7, s[8:11], s3 offen offset:0 sc1
M v[32:35],a[32:35],a[168:171],v[32:35]
SA s30,s30,128
R a[160:163],v5,36864
R a[164:167],v6,36864
M v[32:35],a[36:39],a[172:175],v[32:35]
s_mov_b32 s25, 2097152
G v24,a8
G v25,a9
M v[36:39],a[44:47],a[172:175],v[36:39]
SA m0,s4,131072
G v26,a10
G v27,a11
M v[36:39],a[40:43],a[168:171],v[36:39]
buffer_load_dwordx4 v8, s[52:55], s25 offen lds
M v[40:43],a[48:51],a[168:171],v[40:43]
s_mov_b32 s25, 2359296
G v28,a12
G v29,a13
M v[40:43],a[52:55],a[172:175],v[40:43]
SA m0,s4,135168
G v30,a14
G v31,a15
M v[44:47],a[60:63],a[172:175],v[44:47]
buffer_load_dwordx4 v8, s[52:55], s25 offen lds
M v[44:47],a[56:59],a[168:171],v[44:47]
s_mov_b32 s25, 2621440
C v24,v24,v25
C v25,v26,v27
M v[48:51],a[64:67],a[168:171],v[48:51]
SA m0,s4,139264
C v26,v28,v29
C v27,v30,v31
M v[48:51],a[68:71],a[172:175],v[48:51]
buffer_store_dwordx4 v[24:27], v7, s[8:11], s3 offen offset:1024 sc1
M v[52:55],a[76:79],a[172:175],v[52:55]
s_nop 0
G v24,a16
G v25,a17
M v[52:55],a[72:75],a[168:171],v[52:55]
G v26,a18
G v27,a19
M v[56:59],a[80:83],a[168:171],v[56:59]
buffer_load_dwordx4 v8, s[52:55], s25 offen lds
M v[56:59],a[84:87],a[172:175],v[56:59]
s_waitcnt lgkmcnt(0)
G v28,a20
G v29,a21
M v[60:63],a[92:95],a[172:175],v[60:63]
s_mov_b32 s25, 2883584
G v30,a22
G v31,a23
M v[60:63],a[88:91],a[168:171],v[60:63]
SA m0,s4,143360
C v24,v24,v25
C v25,v26,v27
M v[64:67],a[32:35],a[160:163],v[64:67]
s_waitcnt vmcnt(17)
R a[168:171],v5,38912
R a[172:175],v6,38912
M v[64:67],a[36:39],a[164:167],v[64:67]
buffer_load_dwordx4 v8, s[52:55], s25 offen lds
M v[68:71],a[44:47],a[164:167],v[68:71]
s_mov_b32 s25, 3145728
C v26,v28,v29
C v27,v30,v31
M v[68:71],a[40:43],a[160:163],v[68:71]
SA m0,s4,147456
buffer_store_dwordx4 v[24:27], v7, s[8:11], s3 offen offset:2048 sc1
M v[72:75],a[48:51],a[160:163],v[72:75]
R a[96:99],v20,0
R a[100:103],v20,2048
M v[72:75],a[52:55],a[164:167],v[72:75]
R a[104:107],v21,0
R a[108:111],v21,2048
M v[76:79],a[60:63],a[164:167],v[76:79]
buffer_load_dwordx4 v8, s[52:55], s25 offen lds
M v[76:79],a[56:59],a[160:163],v[76:79]
s_mov_b32 s25, 3407872
G v24,a24
G v25,a25
M v[80:83],a[64:67],a[160:163],v[80:83]
SA m0,s4,151552
G v26,a26
G v27,a27
M v[80:83],a[68:71],a[164:167],v[80:83]
buffer_load_dwordx4 v8, s[52:55], s25 offen lds
M v[84:87],a[76:79],a[164:167],v[84:87]
G v28,a28
G v29,a29
M v[84:87],a[72:75],a[160:163],v[84:87]
G v30,a30
G v31,a31
M v[88:91],a[80:83],a[160:163],v[88:91]
C v24,v24,v25
C v25,v26,v27
M v[88:91],a[84:87],a[164:167],v[88:91]
s_waitcnt lgkmcnt(4)
C v26,v28,v29
C v27,v30,v31
M v[92:95],a[92:95],a[164:167],v[92:95]
s_waitcnt lgkmcnt(0)
buffer_store_dwordx4 v[24:27], v7, s[8:11], s3 offen offset:3072 sc1
M v[92:95],a[88:91],a[160:163],v[92:95]
s_barrier
M v[96:99],a[32:35],a[168:171],v[96:99]
R a[160:163],v5,49152
R a[164:167],v6,49152
M v[96:99],a[36:39],a[172:175],v[96:99]
s_mov_b32 s25, 128
C v64,v64,v65
C v65,v66,v67
M v[100:103],a[44:47],a[172:175],v[100:103]
SA m0,s4,49152
C v66,v68,v69
C v67,v70,v71
M v[100:103],a[40:43],a[168:171],v[100:103]
s_waitcnt vmcnt(18)
buffer_load_dwordx4 v8, s[52:55], s25 offen lds
M v[104:107],a[48:51],a[168:171],v[104:107]
C v72,v72,v73
C v73,v74,v75
M v[104:107],a[52:55],a[172:175],v[104:107]
C v74,v76,v77
C v75,v78,v79
M v[108:111],a[60:63],a[172:175],v[108:111]
C v32,v32,v33
C v33,v34,v35
M v[108:111],a[56:59],a[168:171],v[108:111]
C v34,v36,v37
C v35,v38,v39
M v[112:115],a[64:67],a[168:171],v[112:115]
SA s3,s93,8192
buffer_store_dwordx4 v[32:35], v7, s[8:11], s3 offen offset:0 sc1
M v[112:115],a[68:71],a[172:175],v[112:115]
s_mov_b32 s25, 262272
C v80,v80,v81
C v81,v82,v83
M v[116:119],a[76:79],a[172:175],v[116:119]
SA m0,s4,53248
C v82,v84,v85
C v83,v86,v87
M v[116:119],a[72:75],a[168:171],v[116:119]
R a[112:115],v20,32768
R a[116:119],v20,34816
M v[120:123],a[80:83],a[168:171],v[120:123]
buffer_load_dwordx4 v8, s[52:55], s25 offen lds
M v[120:123],a[84:87],a[172:175],v[120:123]
s_waitcnt lgkmcnt(2)
R a[120:123],v21,32768
R a[124:127],v21,34816
M v[124:127],a[92:95],a[172:175],v[124:127]
C v88,v88,v89
C v89,v90,v91
M v[124:127],a[88:91],a[168:171],v[124:127]
C v90,v92,v93
C v91,v94,v95
M v[128:131],a[32:35],a[160:163],v[128:131]
R a[168:171],v5,51200
R a[172:175],v6,51200
M v[128:131],a[36:39],a[164:167],v[128:131]
C v40,v40,v41
C v41,v42,v43
M v[132:135],a[44:47],a[164:167],v[132:135]
C v42,v44,v45
C v43,v46,v47
M v[132:135],a[40:43],a[160:163],v[132:135]
s_mov_b32 s25, 524416
buffer_store_dwordx4 v[40:43], v7, s[8:11], s3 offen offset:1024 sc1
M v[136:139],a[48:51],a[160:163],v[136:139]
SA m0,s4,57344
C v96,v96,v97
C v97,v98,v99
M v[136:139],a[52:55],a[164:167],v[136:139]
C v98,v100,v101
C v99,v102,v103
M v[140:143],a[60:63],a[164:167],v[140:143]
C v104,v104,v105
C v105,v106,v107
M v[140:143],a[56:59],a[160:163],v[140:143]
buffer_load_dwordx4 v8, s[52:55], s25 offen lds
M v[144:147],a[64:67],a[160:163],v[144:147]
C v106,v108,v109
C v107,v110,v111
M v[144:147],a[68:71],a[164:167],v[144:147]
C v112,v112,v113
C v113,v114,v115
M v[148:151],a[76:79],a[164:167],v[148:151]
C v114,v116,v117
C v115,v118,v119
M v[148:151],a[72:75],a[160:163],v[148:151]
C v48,v48,v49
C v49,v50,v51
M v[152:155],a[80:83],a[160:163],v[152:155]
C v50,v52,v53
C v51,v54,v55
M v[152:155],a[84:87],a[164:167],v[152:155]
s_waitcnt lgkmcnt(0)
buffer_store_dwordx4 v[48:51], v7, s[8:11], s3 offen offset:2048 sc1
M v[156:159],a[92:95],a[164:167],v[156:159]
s_mov_b32 s25, 786560
C v120,v120,v121
C v121,v122,v123
M v[156:159],a[88:91],a[160:163],v[156:159]
SA m0,s4,61440
C v122,v124,v125
C v123,v126,v127
M v[160:163],a[32:35],a[168:171],v[160:163]
R a[160:163],v5,53248
R a[164:167],v6,53248
M v[160:163],a[36:39],a[172:175],v[160:163]
buffer_load_dwordx4 v8, s[52:55], s25 offen lds
M v[164:167],a[44:47],a[172:175],v[164:167]
C v128,v128,v129
C v129,v130,v131
M v[164:167],a[40:43],a[168:171],v[164:167]
C v130,v132,v133
C v131,v134,v135
M v[168:171],a[48:51],a[168:171],v[168:171]
C v56,v56,v57
C v57,v58,v59
M v[168:171],a[52:55],a[172:175],v[168:171]
C v58,v60,v61
C v59,v62,v63
M v[172:175],a[60:63],a[172:175],v[172:175]
buffer_store_dwordx4 v[56:59], v7, s[8:11], s3 offen offset:3072 sc1
M v[172:175],a[56:59],a[168:171],v[172:175]
C v136,v136,v137
C v137,v138,v139
M v[176:179],a[64:67],a[168:171],v[176:179]
C v138,v140,v141
C v139,v142,v143
M v[176:179],a[68:71],a[172:175],v[176:179]
C v144,v144,v145
C v145,v146,v147
M v[180:183],a[76:79],a[172:175],v[180:183]
C v146,v148,v149
C v147,v150,v151
M v[180:183],a[72:75],a[168:171],v[180:183]
C v152,v152,v153
C v153,v154,v155
M v[184:187],a[80:83],a[168:171],v[184:187]
C v154,v156,v157
C v155,v158,v159
M v[184:187],a[84:87],a[172:175],v[184:187]
s_waitcnt lgkmcnt(0)
C v160,v160,v161
C v161,v162,v163
M v[188:191],a[92:95],a[172:175],v[188:191]
C v162,v164,v165
C v163,v166,v167
M v[188:191],a[88:91],a[168:171],v[188:191]
C v168,v168,v169
C v169,v170,v171
M v[192:195],a[32:35],a[160:163],v[192:195]
s_waitcnt vmcnt(18)
R a[168:171],v5,55296
R a[172:175],v6,55296
M v[192:195],a[36:39],a[164:167],v[192:195]
C v170,v172,v173
C v171,v174,v175
M v[196:199],a[44:47],a[164:167],v[196:199]
C v176,v176,v177
C v177,v178,v179
M v[196:199],a[40:43],a[160:163],v[196:199]
C v178,v180,v181
C v179,v182,v183
M v[200:203],a[48:51],a[160:163],v[200:203]
R a[128:131],v20,49152
R a[132:135],v20,51200
M v[200:203],a[52:55],a[164:167],v[200:203]
R a[136:139],v21,49152
R a[140:143],v21,51200
M v[204:207],a[60:63],a[164:167],v[204:207]
C v184,v184,v185
C v185,v186,v187
M v[204:207],a[56:59],a[160:163],v[204:207]
C v186,v188,v189
C v187,v190,v191
M v[208:211],a[64:67],a[160:163],v[208:211]
C v192,v192,v193
C v193,v194,v195
M v[208:211],a[68:71],a[164:167],v[208:211]
C v194,v196,v197
C v195,v198,v199
M v[212:215],a[76:79],a[164:167],v[212:215]
M v[212:215],a[72:75],a[160:163],v[212:215]
C v200,v200,v201
C v201,v202,v203
M v[216:219],a[80:83],a[160:163],v[216:219]
C v202,v204,v205
C v203,v206,v207
M v[216:219],a[84:87],a[164:167],v[216:219]
s_waitcnt lgkmcnt(4)
M v[220:223],a[92:95],a[164:167],v[220:223]
s_waitcnt vmcnt(9) lgkmcnt(0)
M v[220:223],a[88:91],a[160:163],v[220:223]
s_barrier
M v[224:227],a[32:35],a[168:171],v[224:227]
s_nop 0
T v[32:33],v16,0
T v[34:35],v16,2048
M v[224:227],a[36:39],a[172:175],v[224:227]
C v208,v208,v209
C v209,v210,v211
M v[228:231],a[44:47],a[172:175],v[228:231]
T v[36:37],v16,4096
T v[38:39],v16,6144
M v[228:231],a[40:43],a[168:171],v[228:231]
T v[40:41],v16,8192
T v[42:43],v16,10240
M v[232:235],a[48:51],a[168:171],v[232:235]
C v210,v212,v213
C v211,v214,v215
M v[232:235],a[52:55],a[172:175],v[232:235]
T v[44:45],v16,12288
T v[46:47],v16,14336
M v[236:239],a[60:63],a[172:175],v[236:239]
T v[48:49],v16,16384
T v[50:51],v16,18432
M v[236:239],a[56:59],a[168:171],v[236:239]
C v216,v216,v217
C v217,v218,v219
M v[240:243],a[64:67],a[168:171],v[240:243]
T v[52:53],v16,20480
T v[54:55],v16,22528
M v[240:243],a[68:71],a[172:175],v[240:243]
T v[56:57],v16,24576
T v[58:59],v16,26624
M v[244:247],a[76:79],a[172:175],v[244:247]
C v218,v220,v221
C v219,v222,v223
M v[244:247],a[72:75],a[168:171],v[244:247]
C v224,v224,v225
C v225,v226,v227
M v[248:251],a[80:83],a[168:171],v[248:251]
C v226,v228,v229
C v227,v230,v231
M v[248:251],a[84:87],a[172:175],v[248:251]
C v232,v232,v233
C v233,v234,v235
M v[252:255],a[92:95],a[172:175],v[252:255]
C v234,v236,v237
C v235,v238,v239
M v[252:255],a[88:91],a[168:171],v[252:255]
s_waitcnt lgkmcnt(6)
C v240,v240,v241
C v241,v242,v243
M v[68:71],v[32:35],a[176:179],0
s_mul_i32 s72, s41, 4352
T a[144:145],v17,0
T a[146:147],v17,2048
M v[68:71],v[36:39],a[184:187],v[68:71]
s_mov_b32 s25, 1048704
C v242,v244,v245
C v243,v246,v247
M v[68:71],v[40:43],a[192:195],v[68:71]
s_waitcnt lgkmcnt(2)
T a[148:149],v17,4096
T a[150:151],v17,6144
M v[68:71],v[44:47],a[200:203],v[68:71]
SA m0,s4,98304
T a[152:153],v17,8192
T a[154:155],v17,10240
M v[68:71],v[48:51],a[208:211],v[68:71]
SA s46,s72,104923136
buffer_load_dwordx4 v8, s[52:55], s25 offen lds
M v[68:71],v[52:55],a[216:219],v[68:71]
s_lshl_b32 s45, s42, 7
T a[156:157],v17,12288
T a[158:159],v17,14336
M v[68:71],v[56:59],a[224:227],v[68:71]
s_mov_b32 s25, 1310848
T a[160:161],v17,16384
T a[162:163],v17,18432
M v[76:79],v[56:59],a[228:231],0
SA m0,s4,102400
C v248,v248,v249
C v249,v250,v251
M v[76:79],v[52:55],a[220:223],v[76:79]
SA s45,s45,s46
T a[164:165],v17,20480
T a[166:167],v17,22528
M v[76:79],v[48:51],a[212:215],v[76:79]
s_lshl_b32 s72, s20, 2
T a[168:169],v17,24576
T a[170:171],v17,26624
M v[76:79],v[44:47],a[204:207],v[76:79]
SA s72,s72,s45
buffer_load_dwordx4 v8, s[52:55], s25 offen lds
M v[76:79],v[40:43],a[196:199],v[76:79]
C v250,v252,v253
C v251,v254,v255
M v[76:79],v[36:39],a[188:191],v[76:79]
s_mov_b32 s25, 1572992
v_min_u32 v29, 1, v0
v_lshlrev_b32 v29, 29, v29
M v[76:79],v[32:35],a[180:183],v[76:79]
s_waitcnt lgkmcnt(6)
v_mov_b32 v30, 1
M v[84:87],a[144:147],a[176:179],0
SA m0,s4,106496
T v[32:33],v18,0
T v[34:35],v18,2048
M v[84:87],a[148:151],a[184:187],v[84:87]
buffer_load_dwordx4 v8, s[52:55], s25 offen lds
M v[84:87],a[152:155],a[192:195],v[84:87]
s_waitcnt lgkmcnt(2)
s_nop 0
T v[36:37],v18,4096
T v[38:39],v18,6144
M v[84:87],a[156:159],a[200:203],v[84:87]
s_mov_b32 s25, 1835136
T v[40:41],v18,8192
T v[42:43],v18,10240
M v[84:87],a[160:163],a[208:211],v[84:87]
SA m0,s4,110592
M v[84:87],a[164:167],a[216:219],v[84:87]
s_nop 0
T v[44:45],v18,12288
T v[46:47],v18,14336
M v[84:87],a[168:171],a[224:227],v[84:87]
s_waitcnt vmcnt(3)
T v[48:49],v18,16384
T v[50:51],v18,18432
M v[92:95],a[168:171],a[228:231],0
buffer_load_dwordx4 v8, s[52:55], s25 offen lds
M v[92:95],a[164:167],a[220:223],v[92:95]
s_nop 0
T v[52:53],v18,20480
T v[54:55],v18,22528
M v[92:95],a[160:163],a[212:215],v[92:95]
s_mov_b32 s25, 2097280
T v[56:57],v18,24576
T v[58:59],v18,26624
M v[92:95],a[156:159],a[204:207],v[92:95]
SA m0,s4,114688
buffer_store_dword v30, v29, s[8:11], s72 offen offset:4 sc1
M v[92:95],a[152:155],a[196:199],v[92:95]
SA s3,s93,524288
buffer_load_dwordx4 v8, s[52:55], s25 offen lds
M v[92:95],a[148:151],a[188:191],v[92:95]
v_add_u32 v20, 0x10000, v16
v_add_u32 v21, 0x10000, v17
M v[92:95],a[144:147],a[180:183],v[92:95]
s_waitcnt lgkmcnt(6)
buffer_store_dwordx4 v[64:67], v7, s[8:11], s3 offen offset:0 sc1
M v[100:103],v[32:35],a[176:179],0
s_mov_b32 s25, 2359424
L_w_kv08:
s_cbranch_execz L_wd1
T a[144:145],v19,0
T a[146:147],v19,2048
M v[100:103],v[36:39],a[184:187],v[100:103]
SA m0,s4,118784
buffer_store_dwordx4 v[72:75], v7, s[8:11], s3 offen offset:1024 sc1
M v[100:103],v[40:43],a[192:195],v[100:103]
s_waitcnt lgkmcnt(2)
s_nop 0
T a[148:149],v19,4096
T a[150:151],v19,6144
M v[100:103],v[44:47],a[200:203],v[100:103]
T a[152:153],v19,8192
T a[154:155],v19,10240
M v[100:103],v[48:51],a[208:211],v[100:103]
buffer_load_dwordx4 v8, s[52:55], s25 offen lds
M v[100:103],v[52:55],a[216:219],v[100:103]
s_nop 0
T a[156:157],v19,12288
T a[158:159],v19,14336
M v[100:103],v[56:59],a[224:227],v[100:103]
s_mov_b32 s25, 2621568
T a[160:161],v19,16384
T a[162:163],v19,18432
M v[108:111],v[56:59],a[228:231],0
SA m0,s4,122880
buffer_store_dwordx4 v[80:83], v7, s[8:11], s3 offen offset:2048 sc1
M v[108:111],v[52:55],a[220:223],v[108:111]
s_nop 0
T a[164:165],v19,20480
T a[166:167],v19,22528
M v[108:111],v[48:51],a[212:215],v[108:111]
T a[168:169],v19,24576
T a[170:171],v19,26624
M v[108:111],v[44:47],a[204:207],v[108:111]
buffer_load_dwordx4 v8, s[52:55], s25 offen lds
M v[108:111],v[40:43],a[196:199],v[108:111]
v_add_u32 v22, 0x10000, v18
v_add_u32 v23, 0x10000, v19
M v[108:111],v[36:39],a[188:191],v[108:111]
s_mov_b32 s25, 2883712
buffer_store_dwordx4 v[88:91], v7, s[8:11], s3 offen offset:3072 sc1
M v[108:111],v[32:35],a[180:183],v[108:111]
s_waitcnt lgkmcnt(6)
v_or_b32 v1, s20, v0
v_min_u32 v1, 1, v1
M v[116:119],a[144:147],a[176:179],0
SA m0,s4,126976
T v[32:33],v16,28672
T v[34:35],v16,30720
M v[116:119],a[148:151],a[184:187],v[116:119]
buffer_load_dwordx4 v8, s[52:55], s25 offen lds
M v[116:119],a[152:155],a[192:195],v[116:119]
s_waitcnt lgkmcnt(2)
s_nop 0
T v[36:37],v12,0
T v[38:39],v12,2048
M v[116:119],a[156:159],a[200:203],v[116:119]
s_mov_b32 s25, 3145856
T v[40:41],v12,4096
T v[42:43],v12,6144
M v[116:119],a[160:163],a[208:211],v[116:119]
SA m0,s4,32768
v_lshlrev_b32 v1, 29, v1
M v[116:119],a[164:167],a[216:219],v[116:119]
s_nop 0
T v[44:45],v12,8192
T v[46:47],v12,10240
M v[116:119],a[168:171],a[224:227],v[116:119]
T v[48:49],v12,12288
T v[50:51],v12,14336
M v[124:127],a[168:171],a[228:231],0
buffer_load_dwordx4 v8, s[52:55], s25 offen lds
M v[124:127],a[164:167],a[220:223],v[124:127]
s_nop 0
T v[52:53],v12,16384
T v[54:55],v12,18432
M v[124:127],a[160:163],a[212:215],v[124:127]
s_mov_b32 s25, 3408000
T v[56:57],v12,20480
T v[58:59],v12,22528
M v[124:127],a[156:159],a[204:207],v[124:127]
SA m0,s4,36864
v_min_u32 v9, 15, v0
v_lshlrev_b32 v9, 7, v9
M v[124:127],a[152:155],a[196:199],v[124:127]
s_sub_u32 s66, 15, s42
buffer_load_dwordx4 v8, s[52:55], s25 offen lds
M v[124:127],a[148:151],a[188:191],v[124:127]
s_max_u32 s67, s66, s42
M v[124:127],a[144:147],a[180:183],v[124:127]
s_waitcnt lgkmcnt(6)
M v[68:71],v[32:35],a[232:235],v[68:71]
s_mov_b32 s25, 256
T a[144:145],v17,28672
T a[146:147],v17,30720
M v[68:71],v[36:39],a[96:99],v[68:71]
SA m0,s4,65536
M v[68:71],v[40:43],a[104:107],v[68:71]
s_waitcnt lgkmcnt(2)
s_nop 0
T a[148:149],v13,0
T a[150:151],v13,2048
M v[68:71],v[44:47],a[112:115],v[68:71]
s_min_u32 s66, s66, s42
T a[152:153],v13,4096
T a[154:155],v13,6144
M v[68:71],v[48:51],a[120:123],v[68:71]
s_mul_i32 s21, s41, 1048576
buffer_load_dwordx4 v8, s[52:55], s25 offen lds
M v[68:71],v[52:55],a[128:131],v[68:71]
s_lshl_b32 s64, s67, 16
T a[156:157],v13,8192
T a[158:159],v13,10240
M v[68:71],v[56:59],a[136:139],v[68:71]
s_mov_b32 s25, 262400
T a[160:161],v13,12288
T a[162:163],v13,14336
M v[76:79],v[56:59],a[140:143],v[76:79]
SA m0,s4,69632
M v[76:79],v[52:55],a[132:135],v[76:79]
SA s32,s21,s64
T a[164:165],v13,16384
T a[166:167],v13,18432
M v[76:79],v[48:51],a[124:127],v[76:79]
s_lshl_b32 s64, s20, 14
T a[168:169],v13,20480
T a[170:171],v13,22528
M v[76:79],v[44:47],a[116:119],v[76:79]
SA s32,s32,s64
buffer_load_dwordx4 v8, s[52:55], s25 offen lds
M v[76:79],v[40:43],a[108:111],v[76:79]
SA s32,s32,33554432
M v[76:79],v[36:39],a[100:103],v[76:79]
s_mov_b32 s25, 524544
M v[76:79],v[32:35],a[236:239],v[76:79]
s_waitcnt lgkmcnt(6)
M v[84:87],a[144:147],a[232:235],v[84:87]
SA m0,s4,73728
T v[32:33],v18,28672
T v[34:35],v18,30720
M v[84:87],a[148:151],a[96:99],v[84:87]
s_sub_u32 s64, s42, 10
buffer_load_dwordx4 v8, s[52:55], s25 offen lds
M v[84:87],a[152:155],a[104:107],v[84:87]
s_waitcnt lgkmcnt(2)
s_nop 0
T v[36:37],v14,0
T v[38:39],v14,2048
M v[84:87],a[156:159],a[112:115],v[84:87]
s_mov_b32 s25, 786688
T v[40:41],v14,4096
T v[42:43],v14,6144
M v[84:87],a[160:163],a[120:123],v[84:87]
SA m0,s4,77824
M v[84:87],a[164:167],a[128:131],v[84:87]
s_and_b32 s35, s64, 536870912
T v[44:45],v14,8192
T v[46:47],v14,10240
M v[84:87],a[168:171],a[136:139],v[84:87]
T v[48:49],v14,12288
T v[50:51],v14,14336
M v[92:95],a[168:171],a[140:143],v[92:95]
buffer_load_dwordx4 v8, s[52:55], s25 offen lds
M v[92:95],a[164:167],a[132:135],v[92:95]
s_nop 0
T v[52:53],v14,16384
T v[54:55],v14,18432
M v[92:95],a[160:163],a[124:127],v[92:95]
s_mov_b32 s25, 1048832
T v[56:57],v14,20480
T v[58:59],v14,22528
M v[92:95],a[156:159],a[116:119],v[92:95]
SA m0,s4,81920
v_or_b32 v6, s35, v7
MF v68,s5,v68
M v[92:95],a[152:155],a[108:111],v[92:95]
s_lshl_b32 s28, s20, 13
buffer_load_dwordx4 v8, s[52:55], s25 offen lds
M v[92:95],a[148:151],a[100:103],v[92:95]
v_add_u32 v2, 0x10000, v7
v_add_u32 v3, s28, v7
M v[92:95],a[144:147],a[236:239],v[92:95]
s_waitcnt lgkmcnt(6)
v_add_u32 v4, 0x1000, v3
MF v69,s5,v69
M v[100:103],v[32:35],a[232:235],v[100:103]
s_mov_b32 s25, 1310976
T a[144:145],v19,28672
T a[146:147],v19,30720
M v[100:103],v[36:39],a[96:99],v[100:103]
SA m0,s4,86016
MF v70,s5,v70
MF v71,s5,v71
M v[100:103],v[40:43],a[104:107],v[100:103]
s_waitcnt lgkmcnt(2)
T a[148:149],v15,0
T a[150:151],v15,2048
M v[100:103],v[44:47],a[112:115],v[100:103]
s_lshl_b32 s64, s42, 16
T a[152:153],v15,4096
T a[154:155],v15,6144
M v[100:103],v[48:51],a[120:123],v[100:103]
SA s23,s21,s64
buffer_load_dwordx4 v8, s[52:55], s25 offen lds
M v[100:103],v[52:55],a[128:131],v[100:103]
SA s43,s23,16777216
T a[156:157],v15,8192
T a[158:159],v15,10240
M v[100:103],v[56:59],a[136:139],v[100:103]
s_mov_b32 s25, 1573120
T a[160:161],v15,12288
T a[162:163],v15,14336
M v[108:111],v[56:59],a[140:143],v[108:111]
SA m0,s4,90112
MF v84,s5,v84
MF v85,s5,v85
M v[108:111],v[52:55],a[132:135],v[108:111]
SA s26,s21,16777216
T a[164:165],v15,16384
T a[166:167],v15,18432
M v[108:111],v[48:51],a[124:127],v[108:111]
s_mov_b32 s22, 0x7fff
T a[168:169],v15,20480
T a[170:171],v15,22528
M v[108:111],v[44:47],a[116:119],v[108:111]
s_sub_u32 s27, s42, 1
buffer_load_dwordx4 v8, s[52:55], s25 offen lds
M v[108:111],v[40:43],a[108:111],v[108:111]
s_cmp_eq_u32 s42, 0
MF v86,s5,v86
MF v87,s5,v87
M v[108:111],v[36:39],a[100:103],v[108:111]
s_waitcnt vmcnt(7) lgkmcnt(0)
C v68,v68,v69
C v69,v70,v71
M v[108:111],v[32:35],a[236:239],v[108:111]
s_barrier
M v[116:119],a[144:147],a[232:235],v[116:119]
s_mov_b32 s25, 1835264
T v[32:33],v16,49152
T v[34:35],v16,51200
M v[116:119],a[148:151],a[96:99],v[116:119]
s_cselect_b32 s64, 32768, 0
C v70,v84,v85
C v71,v86,v87
M v[116:119],a[152:155],a[104:107],v[116:119]
SA m0,s4,94208
T v[36:37],v16,53248
T v[38:39],v16,55296
M v[116:119],a[156:159],a[112:115],v[116:119]
SA s26,s26,s64
T v[40:41],v16,57344
T v[42:43],v16,59392
M v[116:119],a[160:163],a[120:123],v[116:119]
s_mov_b32 s31, 0x4b800000
buffer_load_dwordx4 v8, s[52:55], s25 offen lds
M v[116:119],a[164:167],a[128:131],v[116:119]
s_mov_b32 s24, 0x33800000
T v[44:45],v16,61440
T v[46:47],v16,63488
M v[116:119],a[168:171],a[136:139],v[116:119]
s_mov_b32 s25, 2097408
T v[48:49],v20,32768
T v[50:51],v20,34816
M v[124:127],a[168:171],a[140:143],v[124:127]
SA m0,s4,155648
W a0,v68
W a1,v69
M v[124:127],a[164:167],a[132:135],v[124:127]
s_lshl_b32 s47, s66, 7
T v[52:53],v20,36864
T v[54:55],v20,38912
M v[124:127],a[160:163],a[124:127],v[124:127]
SA s47,s47,s46
T v[56:57],v20,40960
T v[58:59],v20,43008
M v[124:127],a[156:159],a[116:119],v[124:127]
s_lshl_b32 s64, s20, 5
buffer_load_dwordx4 v8, s[52:55], s25 offen lds
M v[124:127],a[152:155],a[108:111],v[124:127]
SA s47,s47,s64
W a2,v70
W a3,v71
M v[124:127],a[148:151],a[100:103],v[124:127]
SA s47,s47,2048
MF v76,s5,v76
MF v77,s5,v77
M v[124:127],a[144:147],a[236:239],v[124:127]
s_waitcnt lgkmcnt(6)
MF v78,s5,v78
MF v79,s5,v79
M v[132:135],v[32:35],a[176:179],0
s_lshl_b32 s65, s41, 3
T a[144:145],v17,49152
T a[146:147],v17,51200
M v[132:135],v[36:39],a[184:187],v[132:135]
SA s65,s65,s66
MF v92,s5,v92
MF v93,s5,v93
M v[132:135],v[40:43],a[192:195],v[132:135]
s_waitcnt lgkmcnt(2)
T a[148:149],v17,53248
T a[150:151],v17,55296
M v[132:135],v[44:47],a[200:203],v[132:135]
s_mul_i32 s34, s65, 73728
T a[152:153],v17,57344
T a[154:155],v17,59392
M v[132:135],v[48:51],a[208:211],v[132:135]
SA s34,s34,136314880
MF v94,s5,v94
MF v95,s5,v95
M v[132:135],v[52:55],a[216:219],v[132:135]
s_lshl_b32 s65, s42, 4
T a[156:157],v17,61440
T a[158:159],v17,63488
M v[132:135],v[56:59],a[224:227],v[132:135]
SA s65,s65,s41
T a[160:161],v21,32768
T a[162:163],v21,34816
M v[140:143],v[56:59],a[228:231],0
s_mul_i32 s33, s65, 114688
C v76,v76,v77
C v77,v78,v79
M v[140:143],v[52:55],a[220:223],v[140:143]
s_mul_i32 s65, s20, 28672
T a[164:165],v21,36864
T a[166:167],v21,38912
M v[140:143],v[48:51],a[212:215],v[140:143]
SA s33,s33,s65
T a[168:169],v21,40960
T a[170:171],v21,43008
M v[140:143],v[44:47],a[204:207],v[140:143]
SA s33,s33,67108864
C v78,v92,v93
C v79,v94,v95
M v[140:143],v[40:43],a[196:199],v[140:143]
s_mov_b32 s6, 0
W a32,v76
W a33,v77
M v[140:143],v[36:39],a[188:191],v[140:143]
s_mov_b32 s7, 0
W a34,v78
W a35,v79
M v[140:143],v[32:35],a[180:183],v[140:143]
s_waitcnt lgkmcnt(6)
MF v100,s5,v100
MF v101,s5,v101
M v[148:151],a[144:147],a[176:179],0
s_mov_b32 s40, 1
T v[32:33],v18,49152
T v[34:35],v18,51200
M v[148:151],a[148:151],a[184:187],v[148:151]
s_cmp_eq_u32 s20, 0
MF v102,s5,v102
MF v103,s5,v103
M v[148:151],a[152:155],a[192:195],v[148:151]
s_waitcnt lgkmcnt(2)
T v[36:37],v18,53248
T v[38:39],v18,55296
M v[148:151],a[156:159],a[200:203],v[148:151]
s_cselect_b32 s39, 7, 4
T v[40:41],v18,57344
T v[42:43],v18,59392
M v[148:151],a[160:163],a[208:211],v[148:151]
s_lshl_b32 s64, s41, 1
MF v116,s5,v116
MF v117,s5,v117
M v[148:151],a[164:167],a[216:219],v[148:151]
SA s64,s64,s20
T v[44:45],v18,61440
T v[46:47],v18,63488
M v[148:151],a[168:171],a[224:227],v[148:151]
s_cmp_lt_u32 s64, 30
T v[48:49],v22,32768
T v[50:51],v22,34816
M v[156:159],a[168:171],a[228:231],0
s_cselect_b32 s64, 32798, 0
MF v118,s5,v118
MF v119,s5,v119
M v[156:159],a[164:167],a[220:223],v[156:159]
s_cmp_ge_u32 s20, 2
T v[52:53],v22,36864
T v[54:55],v22,38912
M v[156:159],a[160:163],a[212:215],v[156:159]
s_cselect_b32 s64, s64, 0
T v[56:57],v22,40960
T v[58:59],v22,43008
M v[156:159],a[156:159],a[204:207],v[156:159]
s_cmp_eq_u32 s42, 6
C v100,v100,v101
C v101,v102,v103
M v[156:159],a[152:155],a[196:199],v[156:159]
s_cselect_b32 s64, s64, 0
C v102,v116,v117
C v103,v118,v119
M v[156:159],a[148:151],a[188:191],v[156:159]
s_or_b32 s39, s39, s64
W a4,v100
W a5,v101
M v[156:159],a[144:147],a[180:183],v[156:159]
s_waitcnt lgkmcnt(6)
W a6,v102
W a7,v103
M v[164:167],v[32:35],a[176:179],0
s_mov_b64 s[60:61], s[76:77]
T a[144:145],v19,49152
T a[146:147],v19,51200
M v[164:167],v[36:39],a[184:187],v[164:167]
s_mov_b32 s62, s78
MF v108,s5,v108
MF v109,s5,v109
M v[164:167],v[40:43],a[192:195],v[164:167]
s_waitcnt lgkmcnt(2)
T a[148:149],v19,53248
T a[150:151],v19,55296
M v[164:167],v[44:47],a[200:203],v[164:167]
s_mov_b32 s63, 0x20000
T a[152:153],v19,57344
T a[154:155],v19,59392
M v[164:167],v[48:51],a[208:211],v[164:167]
s_mov_b32 s25, 2359552
v_lshrrev_b32 v24, 4, v0
v_lshlrev_b32 v24, 2, v24
M v[164:167],v[52:55],a[216:219],v[164:167]
SA m0,s4,159744
T a[156:157],v19,61440
T a[158:159],v19,63488
M v[164:167],v[56:59],a[224:227],v[164:167]
SA s3,s93,532480
T a[160:161],v23,32768
T a[162:163],v23,34816
M v[172:175],v[56:59],a[228:231],0
buffer_load_dwordx4 v8, s[52:55], s25 offen lds
M v[172:175],v[52:55],a[220:223],v[172:175]
s_nop 0
T a[164:165],v23,36864
T a[166:167],v23,38912
M v[172:175],v[48:51],a[212:215],v[172:175]
s_mov_b32 s25, 2621696
T a[168:169],v23,40960
T a[170:171],v23,43008
M v[172:175],v[44:47],a[204:207],v[172:175]
SA m0,s4,131072
buffer_store_dwordx4 v[96:99], v7, s[8:11], s3 offen offset:0 sc1
M v[172:175],v[40:43],a[196:199],v[172:175]
v_and_b32 v25, 15, v0
v_sub_u32 v24, v24, v25
M v[172:175],v[36:39],a[188:191],v[172:175]
buffer_load_dwordx4 v8, s[52:55], s25 offen lds
M v[172:175],v[32:35],a[180:183],v[172:175]
s_waitcnt lgkmcnt(6)
v_cmp_lt_i32 s[16:17], 0, v24
v_cmp_lt_i32 s[18:19], -1, v24
M v[180:183],a[144:147],a[176:179],0
s_mov_b32 s25, 2883840
T v[32:33],v20,45056
T v[34:35],v20,47104
M v[180:183],a[148:151],a[184:187],v[180:183]
SA m0,s4,135168
buffer_store_dwordx4 v[104:107], v7, s[8:11], s3 offen offset:1024 sc1
M v[180:183],a[152:155],a[192:195],v[180:183]
s_waitcnt lgkmcnt(2)
s_nop 0
T v[36:37],v20,49152
T v[38:39],v20,51200
M v[180:183],a[156:159],a[200:203],v[180:183]
T v[40:41],v20,53248
T v[42:43],v20,55296
M v[180:183],a[160:163],a[208:211],v[180:183]
buffer_load_dwordx4 v8, s[52:55], s25 offen lds
M v[180:183],a[164:167],a[216:219],v[180:183]
s_nop 0
T v[44:45],v20,57344
T v[46:47],v20,59392
M v[180:183],a[168:171],a[224:227],v[180:183]
s_mov_b32 s25, 3145984
T v[48:49],v20,61440
T v[50:51],v20,63488
M v[188:191],a[168:171],a[228:231],0
SA m0,s4,139264
buffer_store_dwordx4 v[112:115], v7, s[8:11], s3 offen offset:2048 sc1
M v[188:191],a[164:167],a[220:223],v[188:191]
s_nop 0
T v[52:53],v16,32768
T v[54:55],v16,34816
M v[188:191],a[160:163],a[212:215],v[188:191]
T v[56:57],v16,36864
T v[58:59],v16,38912
M v[188:191],a[156:159],a[204:207],v[188:191]
buffer_load_dwordx4 v8, s[52:55], s25 offen lds
M v[188:191],a[152:155],a[196:199],v[188:191]
v_cmp_lt_i32 s[48:49], -2, v24
v_cmp_lt_i32 s[50:51], -3, v24
M v[188:191],a[148:151],a[188:191],v[188:191]
s_mov_b32 s25, 3408128
buffer_store_dwordx4 v[120:123], v7, s[8:11], s3 offen offset:3072 sc1
M v[188:191],a[144:147],a[180:183],v[188:191]
s_waitcnt lgkmcnt(6)
v_lshl_add_u32 v25, v0, 7, s95
v_and_b32 v0, 48, v0
M v[132:135],v[32:35],a[232:235],v[132:135]
SA m0,s4,143360
T a[144:145],v21,45056
T a[146:147],v21,47104
M v[132:135],v[36:39],a[96:99],v[132:135]
buffer_load_dwordx4 v8, s[52:55], s25 offen lds
M v[132:135],v[40:43],a[104:107],v[132:135]
s_waitcnt lgkmcnt(2)
s_nop 0
T a[148:149],v21,49152
T a[150:151],v21,51200
M v[132:135],v[44:47],a[112:115],v[132:135]
s_mov_b32 s25, 384
T a[152:153],v21,53248
T a[154:155],v21,55296
M v[132:135],v[48:51],a[120:123],v[132:135]
SA m0,s4,0
v_lshl_add_u32 v0, v0, 24, v25
v_mov_b32 v24, 0x3f80
M v[132:135],v[52:55],a[128:131],v[132:135]
T a[156:157],v21,57344
T a[158:159],v21,59392
M v[132:135],v[56:59],a[136:139],v[132:135]
T a[160:161],v21,61440
T a[162:163],v21,63488
M v[140:143],v[56:59],a[140:143],v[140:143]
buffer_load_dwordx4 v8, s[52:55], s25 offen lds
M v[140:143],v[52:55],a[132:135],v[140:143]
s_nop 0
T a[164:165],v17,32768
T a[166:167],v17,34816
M v[140:143],v[48:51],a[124:127],v[140:143]
s_mov_b32 s25, 262528
T a[168:169],v17,36864
T a[170:171],v17,38912
M v[140:143],v[44:47],a[116:119],v[140:143]
SA m0,s4,4096
MF v110,s5,v110
MF v111,s5,v111
M v[140:143],v[40:43],a[108:111],v[140:143]
buffer_load_dwordx4 v8, s[52:55], s25 offen lds
M v[140:143],v[36:39],a[100:103],v[140:143]
MF v124,s5,v124
MF v125,s5,v125
M v[140:143],v[32:35],a[236:239],v[140:143]
s_waitcnt lgkmcnt(6)
MF v126,s5,v126
MF v127,s5,v127
M v[148:151],a[144:147],a[232:235],v[148:151]
s_mov_b32 s25, 524672
T v[32:33],v22,45056
T v[34:35],v22,47104
M v[148:151],a[148:151],a[96:99],v[148:151]
SA m0,s4,8192
C v108,v108,v109
C v109,v110,v111
M v[148:151],a[152:155],a[104:107],v[148:151]
s_waitcnt lgkmcnt(2)
T v[36:37],v22,49152
T v[38:39],v22,51200
M v[148:151],a[156:159],a[112:115],v[148:151]
T v[40:41],v22,53248
T v[42:43],v22,55296
M v[148:151],a[160:163],a[120:123],v[148:151]
buffer_load_dwordx4 v8, s[52:55], s25 offen lds
M v[148:151],a[164:167],a[128:131],v[148:151]
s_nop 0
T v[44:45],v22,57344
T v[46:47],v22,59392
M v[148:151],a[168:171],a[136:139],v[148:151]
s_mov_b32 s25, 786816
T v[48:49],v22,61440
T v[50:51],v22,63488
M v[156:159],a[168:171],a[140:143],v[156:159]
SA m0,s4,12288
C v110,v124,v125
C v111,v126,v127
M v[156:159],a[164:167],a[132:135],v[156:159]
T v[52:53],v18,32768
T v[54:55],v18,34816
M v[156:159],a[160:163],a[124:127],v[156:159]
T v[56:57],v18,36864
T v[58:59],v18,38912
M v[156:159],a[156:159],a[116:119],v[156:159]
buffer_load_dwordx4 v8, s[52:55], s25 offen lds
M v[156:159],a[152:155],a[108:111],v[156:159]
W a36,v108
W a37,v109
M v[156:159],a[148:151],a[100:103],v[156:159]
s_mov_b32 s25, 1048960
v_lshrrev_b32 v25, 8, v7
v_bfe_u32 v26, v7, 6, 2
v_and_b32 v27, 16, v7
v_lshlrev_b32 v27, v27, v24
v_cmp_eq_u32 vcc, v25, v26
v_and_b32 v28, 32, v7
W a244,0
v_cndmask_b32 v27, 0, v27, vcc
v_cmp_eq_u32 vcc, 0, v28
W a245,0
W a248,0
v_cndmask_b32 v25, 0, v27, vcc
v_sub_u32 v26, v27, v25
W a249,0
W a246,v25
W a247,v26
M v[156:159],a[144:147],a[236:239],v[156:159]
s_waitcnt lgkmcnt(6)
W a38,v110
W a39,v111
M v[164:167],v[32:35],a[232:235],v[164:167]
SA m0,s4,16384
T a[144:145],v23,45056
T a[146:147],v23,47104
M v[164:167],v[36:39],a[96:99],v[164:167]
buffer_load_dwordx4 v8, s[52:55], s25 offen lds
M v[164:167],v[40:43],a[104:107],v[164:167]
s_waitcnt lgkmcnt(2)
s_nop 0
T a[148:149],v23,49152
T a[150:151],v23,51200
M v[164:167],v[44:47],a[112:115],v[164:167]
s_mov_b32 s25, 1311104
T a[152:153],v23,53248
T a[154:155],v23,55296
M v[164:167],v[48:51],a[120:123],v[164:167]
SA m0,s4,20480
MF v132,s5,v132
MF v133,s5,v133
M v[164:167],v[52:55],a[128:131],v[164:167]
T a[156:157],v23,57344
T a[158:159],v23,59392
M v[164:167],v[56:59],a[136:139],v[164:167]
T a[160:161],v23,61440
T a[162:163],v23,63488
M v[172:175],v[56:59],a[140:143],v[172:175]
buffer_load_dwordx4 v8, s[52:55], s25 offen lds
M v[172:175],v[52:55],a[132:135],v[172:175]
s_nop 0
T a[164:165],v19,32768
T a[166:167],v19,34816
M v[172:175],v[48:51],a[124:127],v[172:175]
s_mov_b32 s25, 1573248
T a[168:169],v19,36864
T a[170:171],v19,38912
M v[172:175],v[44:47],a[116:119],v[172:175]
SA m0,s4,24576
MF v134,s5,v134
MF v135,s5,v135
M v[172:175],v[40:43],a[108:111],v[172:175]
buffer_load_dwordx4 v8, s[52:55], s25 offen lds
M v[172:175],v[36:39],a[100:103],v[172:175]
s_waitcnt vmcnt(7) lgkmcnt(0)
MF v148,s5,v148
MF v149,s5,v149
M v[172:175],v[32:35],a[236:239],v[172:175]
s_barrier
M v[180:183],a[144:147],a[232:235],v[180:183]
s_mov_b32 s25, 1835392
T v[32:33],v20,0
T v[34:35],v20,2048
M v[180:183],a[148:151],a[96:99],v[180:183]
SA m0,s4,28672
MF v150,s5,v150
MF v151,s5,v151
M v[180:183],a[152:155],a[104:107],v[180:183]
T v[36:37],v20,4096
T v[38:39],v20,6144
M v[180:183],a[156:159],a[112:115],v[180:183]
T v[40:41],v20,8192
T v[42:43],v20,10240
M v[180:183],a[160:163],a[120:123],v[180:183]
buffer_load_dwordx4 v8, s[52:55], s25 offen lds
M v[180:183],a[164:167],a[128:131],v[180:183]
s_nop 0
T v[44:45],v20,12288
T v[46:47],v20,14336
M v[180:183],a[168:171],a[136:139],v[180:183]
s_mov_b32 s25, 2097536
T v[48:49],v20,16384
T v[50:51],v20,18432
M v[188:191],a[168:171],a[140:143],v[188:191]
SA m0,s4,40960
C v132,v132,v133
C v133,v134,v135
M v[188:191],a[164:167],a[132:135],v[188:191]
T v[52:53],v20,20480
T v[54:55],v20,22528
M v[188:191],a[160:163],a[124:127],v[188:191]
T v[56:57],v20,24576
T v[58:59],v20,26624
M v[188:191],a[156:159],a[116:119],v[188:191]
buffer_load_dwordx4 v8, s[52:55], s25 offen lds
M v[188:191],a[152:155],a[108:111],v[188:191]
C v134,v148,v149
C v135,v150,v151
M v[188:191],a[148:151],a[100:103],v[188:191]
s_mov_b32 s25, 2359680
W a8,v132
W a9,v133
M v[188:191],a[144:147],a[236:239],v[188:191]
s_waitcnt lgkmcnt(6)
W a10,v134
W a11,v135
M v[68:71],v[32:35],a[176:179],0
SA m0,s4,45056
T a[144:145],v21,0
T a[146:147],v21,2048
M v[68:71],v[36:39],a[184:187],v[68:71]
buffer_load_dwordx4 v8, s[52:55], s25 offen lds
M v[68:71],v[40:43],a[192:195],v[68:71]
s_waitcnt lgkmcnt(2)
s_nop 0
T a[148:149],v21,4096
T a[150:151],v21,6144
M v[68:71],v[44:47],a[200:203],v[68:71]
s_mov_b32 s25, 2621824
T a[152:153],v21,8192
T a[154:155],v21,10240
M v[68:71],v[48:51],a[208:211],v[68:71]
SA m0,s4,49152
v_lshrrev_b32 v31, 6, v7
v_bfe_u32 v28, v7, 4, 2
M v[68:71],v[52:55],a[216:219],v[68:71]
T a[156:157],v21,12288
T a[158:159],v21,14336
M v[68:71],v[56:59],a[224:227],v[68:71]
T a[160:161],v21,16384
T a[162:163],v21,18432
M v[76:79],v[56:59],a[228:231],0
buffer_load_dwordx4 v8, s[52:55], s25 offen lds
M v[76:79],v[52:55],a[220:223],v[76:79]
s_nop 0
T a[164:165],v21,20480
T a[166:167],v21,22528
M v[76:79],v[48:51],a[212:215],v[76:79]
s_mov_b32 s25, 2883968
T a[168:169],v21,24576
T a[170:171],v21,26624
M v[76:79],v[44:47],a[204:207],v[76:79]
SA m0,s4,53248
v_lshlrev_b32 v31, 5, v31
v_add_lshl_u32 v31, v31, v28, 2
M v[76:79],v[40:43],a[196:199],v[76:79]
SA s3,s93,262144
buffer_load_dword v5, v31, s[8:11], s46 offen offset:4 sc1
M v[76:79],v[36:39],a[188:191],v[76:79]
buffer_load_dwordx4 v8, s[52:55], s25 offen lds
M v[76:79],v[32:35],a[180:183],v[76:79]
s_waitcnt lgkmcnt(6)
MF v140,s5,v140
MF v141,s5,v141
M v[84:87],a[144:147],a[176:179],0
s_mov_b32 s25, 3146112
T v[32:33],v22,0
T v[34:35],v22,2048
M v[84:87],a[148:151],a[184:187],v[84:87]
SA m0,s4,57344
buffer_store_dwordx4 v[128:131], v7, s[8:11], s3 offen offset:0 sc1
M v[84:87],a[152:155],a[192:195],v[84:87]
s_waitcnt lgkmcnt(2)
s_nop 0
T v[36:37],v22,4096
T v[38:39],v22,6144
M v[84:87],a[156:159],a[200:203],v[84:87]
T v[40:41],v22,8192
T v[42:43],v22,10240
M v[84:87],a[160:163],a[208:211],v[84:87]
buffer_load_dwordx4 v8, s[52:55], s25 offen lds
M v[84:87],a[164:167],a[216:219],v[84:87]
s_nop 0
T v[44:45],v22,12288
T v[46:47],v22,14336
M v[84:87],a[168:171],a[224:227],v[84:87]
s_mov_b32 s25, 3408256
T v[48:49],v22,16384
T v[50:51],v22,18432
M v[92:95],a[168:171],a[228:231],0
SA m0,s4,61440
buffer_store_dwordx4 v[136:139], v7, s[8:11], s3 offen offset:1024 sc1
M v[92:95],a[164:167],a[220:223],v[92:95]
s_nop 0
T v[52:53],v22,20480
T v[54:55],v22,22528
M v[92:95],a[160:163],a[212:215],v[92:95]
T v[56:57],v22,24576
T v[58:59],v22,26624
M v[92:95],a[156:159],a[204:207],v[92:95]
buffer_load_dwordx4 v8, s[52:55], s25 offen lds
M v[92:95],a[152:155],a[196:199],v[92:95]
MF v142,s5,v142
MF v143,s5,v143
M v[92:95],a[148:151],a[188:191],v[92:95]
buffer_store_dwordx4 v[144:147], v7, s[8:11], s3 offen offset:2048 sc1
M v[92:95],a[144:147],a[180:183],v[92:95]
s_waitcnt lgkmcnt(6)
MF v156,s5,v156
MF v157,s5,v157
M v[100:103],v[32:35],a[176:179],0
T a[144:145],v23,0
T a[146:147],v23,2048
M v[100:103],v[36:39],a[184:187],v[100:103]
buffer_store_dwordx4 v[152:155], v7, s[8:11], s3 offen offset:3072 sc1
M v[100:103],v[40:43],a[192:195],v[100:103]
s_waitcnt lgkmcnt(2)
s_nop 0
T a[148:149],v23,4096
T a[150:151],v23,6144
M v[100:103],v[44:47],a[200:203],v[100:103]
T a[152:153],v23,8192
T a[154:155],v23,10240
M v[100:103],v[48:51],a[208:211],v[100:103]
MF v158,s5,v158
MF v159,s5,v159
M v[100:103],v[52:55],a[216:219],v[100:103]
T a[156:157],v23,12288
T a[158:159],v23,14336
M v[100:103],v[56:59],a[224:227],v[100:103]
T a[160:161],v23,16384
T a[162:163],v23,18432
M v[108:111],v[56:59],a[228:231],0
C v140,v140,v141
C v141,v142,v143
M v[108:111],v[52:55],a[220:223],v[108:111]
T a[164:165],v23,20480
T a[166:167],v23,22528
M v[108:111],v[48:51],a[212:215],v[108:111]
T a[168:169],v23,24576
T a[170:171],v23,26624
M v[108:111],v[44:47],a[204:207],v[108:111]
C v142,v156,v157
C v143,v158,v159
M v[108:111],v[40:43],a[196:199],v[108:111]
W a40,v140
W a41,v141
M v[108:111],v[36:39],a[188:191],v[108:111]
W a42,v142
W a43,v143
M v[108:111],v[32:35],a[180:183],v[108:111]
s_waitcnt lgkmcnt(6)
v_mov_b32 v8, 0xff800000
MF v164,s5,v164
M v[116:119],a[144:147],a[176:179],0
T v[32:33],v20,28672
T v[34:35],v20,30720
M v[116:119],a[148:151],a[184:187],v[116:119]
MF v165,s5,v165
MF v166,s5,v166
M v[116:119],a[152:155],a[192:195],v[116:119]
s_waitcnt lgkmcnt(2)
T v[36:37],v12,24576
T v[38:39],v12,26624
M v[116:119],a[156:159],a[200:203],v[116:119]
T v[40:41],v12,28672
T v[42:43],v12,30720
M v[116:119],a[160:163],a[208:211],v[116:119]
MF v167,s5,v167
MF v180,s5,v180
M v[116:119],a[164:167],a[216:219],v[116:119]
T v[44:45],v12,0
T v[46:47],v12,2048
M v[116:119],a[168:171],a[224:227],v[116:119]
T v[48:49],v12,4096
T v[50:51],v12,6144
M v[124:127],a[168:171],a[228:231],0
MF v181,s5,v181
MF v182,s5,v182
M v[124:127],a[164:167],a[220:223],v[124:127]
T v[52:53],v12,8192
T v[54:55],v12,10240
M v[124:127],a[160:163],a[212:215],v[124:127]
T v[56:57],v12,12288
T v[58:59],v12,14336
M v[124:127],a[156:159],a[204:207],v[124:127]
MF v183,s5,v183
C v164,v164,v165
M v[124:127],a[152:155],a[196:199],v[124:127]
C v165,v166,v167
C v166,v180,v181
M v[124:127],a[148:151],a[188:191],v[124:127]
C v167,v182,v183
W a12,v164
M v[124:127],a[144:147],a[180:183],v[124:127]
s_waitcnt lgkmcnt(6)
W a13,v165
W a14,v166
M v[68:71],v[32:35],a[232:235],v[68:71]
T a[144:145],v21,28672
T a[146:147],v21,30720
M v[68:71],v[36:39],a[96:99],v[68:71]
W a15,v167
MF v172,s5,v172
M v[68:71],v[40:43],a[104:107],v[68:71]
s_waitcnt lgkmcnt(2)
T a[148:149],v13,24576
T a[150:151],v13,26624
M v[68:71],v[44:47],a[112:115],v[68:71]
T a[152:153],v13,28672
T a[154:155],v13,30720
M v[68:71],v[48:51],a[120:123],v[68:71]
MF v173,s5,v173
MF v174,s5,v174
M v[68:71],v[52:55],a[128:131],v[68:71]
T a[156:157],v13,0
T a[158:159],v13,2048
M v[68:71],v[56:59],a[136:139],v[68:71]
T a[160:161],v13,4096
T a[162:163],v13,6144
M v[76:79],v[56:59],a[140:143],v[76:79]
MF v175,s5,v175
MF v188,s5,v188
M v[76:79],v[52:55],a[132:135],v[76:79]
T a[164:165],v13,8192
T a[166:167],v13,10240
M v[76:79],v[48:51],a[124:127],v[76:79]
T a[168:169],v13,12288
T a[170:171],v13,14336
M v[76:79],v[44:47],a[116:119],v[76:79]
MF v189,s5,v189
MF v190,s5,v190
M v[76:79],v[40:43],a[108:111],v[76:79]
MF v191,s5,v191
C v172,v172,v173
M v[76:79],v[36:39],a[100:103],v[76:79]
C v173,v174,v175
C v174,v188,v189
M v[76:79],v[32:35],a[236:239],v[76:79]
s_waitcnt lgkmcnt(6)
C v175,v190,v191
W a44,v172
M v[84:87],a[144:147],a[232:235],v[84:87]
T v[32:33],v22,28672
T v[34:35],v22,30720
M v[84:87],a[148:151],a[96:99],v[84:87]
W a45,v173
W a46,v174
M v[84:87],a[152:155],a[104:107],v[84:87]
s_waitcnt lgkmcnt(2)
T v[36:37],v14,24576
T v[38:39],v14,26624
M v[84:87],a[156:159],a[112:115],v[84:87]
T v[40:41],v14,28672
T v[42:43],v14,30720
M v[84:87],a[160:163],a[120:123],v[84:87]
W a47,v175
s_waitcnt vmcnt(7)
v_cmp_ne_u32 vcc, 1, v5
M v[84:87],a[164:167],a[128:131],v[84:87]
s_nop 0
T v[44:45],v14,0
T v[46:47],v14,2048
M v[84:87],a[168:171],a[136:139],v[84:87]
s_cmp_lg_u32 vcc_lo, 0
T v[48:49],v14,4096
T v[50:51],v14,6144
M v[92:95],a[168:171],a[140:143],v[92:95]
s_cbranch_scc1 L_wsq0
L_wrq0:
M v[92:95],a[164:167],a[132:135],v[92:95]
SA m0,s28,98304
T v[52:53],v14,8192
T v[54:55],v14,10240
M v[92:95],a[160:163],a[124:127],v[92:95]
T v[56:57],v14,12288
T v[58:59],v14,14336
M v[92:95],a[156:159],a[116:119],v[92:95]
buffer_load_dwordx4 v3, s[8:11], s21 offen offset:0 sc1 lds
M v[92:95],a[152:155],a[108:111],v[92:95]
MF v68,s5,v68
MF v69,s5,v69
M v[92:95],a[148:151],a[100:103],v[92:95]
buffer_load_dwordx4 v3, s[8:11], s21 offen offset:1024 sc1 lds
M v[92:95],a[144:147],a[236:239],v[92:95]
s_waitcnt lgkmcnt(6)
MF v70,s5,v70
MF v71,s5,v71
M v[100:103],v[32:35],a[232:235],v[100:103]
T a[144:145],v23,28672
T a[146:147],v23,30720
M v[100:103],v[36:39],a[96:99],v[100:103]
buffer_load_dwordx4 v3, s[8:11], s21 offen offset:2048 sc1 lds
M v[100:103],v[40:43],a[104:107],v[100:103]
s_waitcnt lgkmcnt(2)
s_nop 0
T a[148:149],v15,24576
T a[150:151],v15,26624
M v[100:103],v[44:47],a[112:115],v[100:103]
T a[152:153],v15,28672
T a[154:155],v15,30720
M v[100:103],v[48:51],a[120:123],v[100:103]
buffer_load_dwordx4 v3, s[8:11], s21 offen offset:3072 sc1 lds
M v[100:103],v[52:55],a[128:131],v[100:103]
SA m0,s28,102400
T a[156:157],v15,0
T a[158:159],v15,2048
M v[100:103],v[56:59],a[136:139],v[100:103]
T a[160:161],v15,4096
T a[162:163],v15,6144
M v[108:111],v[56:59],a[140:143],v[108:111]
buffer_load_dwordx4 v4, s[8:11], s21 offen offset:0 sc1 lds
M v[108:111],v[52:55],a[132:135],v[108:111]
s_nop 0
T a[164:165],v15,8192
T a[166:167],v15,10240
M v[108:111],v[48:51],a[124:127],v[108:111]
T a[168:169],v15,12288
T a[170:171],v15,14336
M v[108:111],v[44:47],a[116:119],v[108:111]
buffer_load_dwordx4 v4, s[8:11], s21 offen offset:1024 sc1 lds
M v[108:111],v[40:43],a[108:111],v[108:111]
MF v84,s5,v84
MF v85,s5,v85
M v[108:111],v[36:39],a[100:103],v[108:111]
s_waitcnt vmcnt(8) lgkmcnt(0)
buffer_load_dwordx4 v4, s[8:11], s21 offen offset:2048 sc1 lds
M v[108:111],v[32:35],a[236:239],v[108:111]
s_barrier
M v[116:119],a[144:147],a[232:235],v[116:119]
s_nop 0
T v[32:33],v16,0
T v[34:35],v16,2048
M v[116:119],a[148:151],a[96:99],v[116:119]
buffer_load_dwordx4 v4, s[8:11], s21 offen offset:3072 sc1 lds
M v[116:119],a[152:155],a[104:107],v[116:119]
SA s21,s21,32768
T v[36:37],v16,4096
T v[38:39],v16,6144
M v[116:119],a[156:159],a[112:115],v[116:119]
s_sub_u32 s22, s22, 1
T v[40:41],v16,8192
T v[42:43],v16,10240
M v[116:119],a[160:163],a[120:123],v[116:119]
s_cselect_b32 s21, s23, s21
MF v86,s5,v86
MF v87,s5,v87
M v[116:119],a[164:167],a[128:131],v[116:119]
SA m0,s28,65536
T v[44:45],v16,12288
T v[46:47],v16,14336
M v[116:119],a[168:171],a[136:139],v[116:119]
T v[48:49],v16,16384
T v[50:51],v16,18432
M v[124:127],a[168:171],a[140:143],v[124:127]
buffer_load_dwordx4 v3, s[8:11], s21 offen offset:0 sc1 lds
M v[124:127],a[164:167],a[132:135],v[124:127]
s_nop 0
T v[52:53],v16,20480
T v[54:55],v16,22528
M v[124:127],a[160:163],a[124:127],v[124:127]
T v[56:57],v16,24576
T v[58:59],v16,26624
M v[124:127],a[156:159],a[116:119],v[124:127]
buffer_load_dwordx4 v3, s[8:11], s21 offen offset:1024 sc1 lds
M v[124:127],a[152:155],a[108:111],v[124:127]
buffer_load_dword v5, v31, s[8:11], s46 offen offset:4 sc1
M v[124:127],a[148:151],a[100:103],v[124:127]
buffer_load_dwordx4 v3, s[8:11], s21 offen offset:2048 sc1 lds
M v[124:127],a[144:147],a[236:239],v[124:127]
s_waitcnt lgkmcnt(6)
C v68,v68,v69
C v69,v70,v71
M v[132:135],v[32:35],a[176:179],0
T a[144:145],v17,0
T a[146:147],v17,2048
M v[132:135],v[36:39],a[184:187],v[132:135]
buffer_load_dwordx4 v3, s[8:11], s21 offen offset:3072 sc1 lds
M v[132:135],v[40:43],a[192:195],v[132:135]
s_waitcnt lgkmcnt(2)
s_nop 0
T a[148:149],v17,4096
T a[150:151],v17,6144
M v[132:135],v[44:47],a[200:203],v[132:135]
SA m0,s28,69632
T a[152:153],v17,8192
T a[154:155],v17,10240
M v[132:135],v[48:51],a[208:211],v[132:135]
buffer_load_dwordx4 v4, s[8:11], s21 offen offset:0 sc1 lds
M v[132:135],v[52:55],a[216:219],v[132:135]
s_nop 0
T a[156:157],v17,12288
T a[158:159],v17,14336
M v[132:135],v[56:59],a[224:227],v[132:135]
T a[160:161],v17,16384
T a[162:163],v17,18432
M v[140:143],v[56:59],a[228:231],0
buffer_load_dwordx4 v4, s[8:11], s21 offen offset:1024 sc1 lds
M v[140:143],v[52:55],a[220:223],v[140:143]
s_nop 0
T a[164:165],v17,20480
T a[166:167],v17,22528
M v[140:143],v[48:51],a[212:215],v[140:143]
T a[168:169],v17,24576
T a[170:171],v17,26624
M v[140:143],v[44:47],a[204:207],v[140:143]
SA s3,s93,270336
buffer_load_dwordx4 v4, s[8:11], s21 offen offset:2048 sc1 lds
M v[140:143],v[40:43],a[196:199],v[140:143]
C v70,v84,v85
C v71,v86,v87
M v[140:143],v[36:39],a[188:191],v[140:143]
buffer_load_dwordx4 v4, s[8:11], s21 offen offset:3072 sc1 lds
M v[140:143],v[32:35],a[180:183],v[140:143]
s_waitcnt lgkmcnt(6)
W a16,v68
W a17,v69
M v[148:151],a[144:147],a[176:179],0
SA s21,s21,32768
T v[32:33],v18,0
T v[34:35],v18,2048
M v[148:151],a[148:151],a[184:187],v[148:151]
s_sub_u32 s22, s22, 1
buffer_store_dwordx4 v[160:163], v7, s[8:11], s3 offen offset:0 sc1
M v[148:151],a[152:155],a[192:195],v[148:151]
s_waitcnt lgkmcnt(2)
s_nop 0
T v[36:37],v18,4096
T v[38:39],v18,6144
M v[148:151],a[156:159],a[200:203],v[148:151]
s_cselect_b32 s21, s23, s21
T v[40:41],v18,8192
T v[42:43],v18,10240
M v[148:151],a[160:163],a[208:211],v[148:151]
buffer_store_dwordx4 v[168:171], v7, s[8:11], s3 offen offset:1024 sc1
M v[148:151],a[164:167],a[216:219],v[148:151]
s_nop 0
T v[44:45],v18,12288
T v[46:47],v18,14336
M v[148:151],a[168:171],a[224:227],v[148:151]
T v[48:49],v18,16384
T v[50:51],v18,18432
M v[156:159],a[168:171],a[228:231],0
buffer_store_dwordx4 v[176:179], v7, s[8:11], s3 offen offset:2048 sc1
M v[156:159],a[164:167],a[220:223],v[156:159]
s_nop 0
T v[52:53],v18,20480
T v[54:55],v18,22528
M v[156:159],a[160:163],a[212:215],v[156:159]
T v[56:57],v18,24576
T v[58:59],v18,26624
M v[156:159],a[156:159],a[204:207],v[156:159]
buffer_store_dwordx4 v[184:187], v7, s[8:11], s3 offen offset:3072 sc1
M v[156:159],a[152:155],a[196:199],v[156:159]
W a18,v70
W a19,v71
M v[156:159],a[148:151],a[188:191],v[156:159]
MF v76,s5,v76
MF v77,s5,v77
M v[156:159],a[144:147],a[180:183],v[156:159]
s_waitcnt lgkmcnt(6)
MF v78,s5,v78
MF v79,s5,v79
M v[164:167],v[32:35],a[176:179],0
T a[144:145],v19,0
T a[146:147],v19,2048
M v[164:167],v[36:39],a[184:187],v[164:167]
MF v92,s5,v92
MF v93,s5,v93
M v[164:167],v[40:43],a[192:195],v[164:167]
s_waitcnt lgkmcnt(2)
T a[148:149],v19,4096
T a[150:151],v19,6144
M v[164:167],v[44:47],a[200:203],v[164:167]
T a[152:153],v19,8192
T a[154:155],v19,10240
M v[164:167],v[48:51],a[208:211],v[164:167]
MF v94,s5,v94
MF v95,s5,v95
M v[164:167],v[52:55],a[216:219],v[164:167]
T a[156:157],v19,12288
T a[158:159],v19,14336
M v[164:167],v[56:59],a[224:227],v[164:167]
T a[160:161],v19,16384
T a[162:163],v19,18432
M v[172:175],v[56:59],a[228:231],0
C v76,v76,v77
C v77,v78,v79
M v[172:175],v[52:55],a[220:223],v[172:175]
T a[164:165],v19,20480
T a[166:167],v19,22528
M v[172:175],v[48:51],a[212:215],v[172:175]
T a[168:169],v19,24576
T a[170:171],v19,26624
M v[172:175],v[44:47],a[204:207],v[172:175]
C v78,v92,v93
C v79,v94,v95
M v[172:175],v[40:43],a[196:199],v[172:175]
W a48,v76
W a49,v77
M v[172:175],v[36:39],a[188:191],v[172:175]
W a50,v78
W a51,v79
M v[172:175],v[32:35],a[180:183],v[172:175]
s_waitcnt lgkmcnt(6)
v_mov_b32 v30, 2
MF v100,s5,v100
M v[180:183],a[144:147],a[176:179],0
T v[32:33],v16,28672
T v[34:35],v16,30720
M v[180:183],a[148:151],a[184:187],v[180:183]
buffer_store_dword v30, v1, s[8:11], s45 offen sc1
M v[180:183],a[152:155],a[192:195],v[180:183]
s_waitcnt lgkmcnt(2)
s_nop 0
T v[36:37],v16,40960
T v[38:39],v16,43008
M v[180:183],a[156:159],a[200:203],v[180:183]
T v[40:41],v16,45056
T v[42:43],v16,47104
M v[180:183],a[160:163],a[208:211],v[180:183]
MF v101,s5,v101
MF v102,s5,v102
M v[180:183],a[164:167],a[216:219],v[180:183]
T v[44:45],v16,49152
T v[46:47],v16,51200
M v[180:183],a[168:171],a[224:227],v[180:183]
T v[48:49],v16,53248
T v[50:51],v16,55296
M v[188:191],a[168:171],a[228:231],0
MF v103,s5,v103
MF v116,s5,v116
M v[188:191],a[164:167],a[220:223],v[188:191]
T v[52:53],v16,57344
T v[54:55],v16,59392
M v[188:191],a[160:163],a[212:215],v[188:191]
T v[56:57],v16,61440
T v[58:59],v16,63488
M v[188:191],a[156:159],a[204:207],v[188:191]
MF v117,s5,v117
MF v118,s5,v118
M v[188:191],a[152:155],a[196:199],v[188:191]
MF v119,s5,v119
C v100,v100,v101
M v[188:191],a[148:151],a[188:191],v[188:191]
C v101,v102,v103
C v102,v116,v117
M v[188:191],a[144:147],a[180:183],v[188:191]
s_waitcnt lgkmcnt(6)
C v103,v118,v119
W a20,v100
M v[132:135],v[32:35],a[232:235],v[132:135]
T a[144:145],v17,28672
T a[146:147],v17,30720
M v[132:135],v[36:39],a[96:99],v[132:135]
W a21,v101
W a22,v102
M v[132:135],v[40:43],a[104:107],v[132:135]
s_waitcnt lgkmcnt(2)
T a[148:149],v17,40960
T a[150:151],v17,43008
M v[132:135],v[44:47],a[112:115],v[132:135]
T a[152:153],v17,45056
T a[154:155],v17,47104
M v[132:135],v[48:51],a[120:123],v[132:135]
W a23,v103
MF v108,s5,v108
M v[132:135],v[52:55],a[128:131],v[132:135]
T a[156:157],v17,49152
T a[158:159],v17,51200
M v[132:135],v[56:59],a[136:139],v[132:135]
T a[160:161],v17,53248
T a[162:163],v17,55296
M v[140:143],v[56:59],a[140:143],v[140:143]
MF v109,s5,v109
MF v110,s5,v110
M v[140:143],v[52:55],a[132:135],v[140:143]
T a[164:165],v17,57344
T a[166:167],v17,59392
M v[140:143],v[48:51],a[124:127],v[140:143]
T a[168:169],v17,61440
T a[170:171],v17,63488
M v[140:143],v[44:47],a[116:119],v[140:143]
MF v111,s5,v111
MF v124,s5,v124
M v[140:143],v[40:43],a[108:111],v[140:143]
MF v125,s5,v125
MF v126,s5,v126
M v[140:143],v[36:39],a[100:103],v[140:143]
MF v127,s5,v127
C v108,v108,v109
M v[140:143],v[32:35],a[236:239],v[140:143]
s_waitcnt lgkmcnt(6)
C v109,v110,v111
C v110,v124,v125
M v[148:151],a[144:147],a[232:235],v[148:151]
T v[32:33],v18,28672
T v[34:35],v18,30720
M v[148:151],a[148:151],a[96:99],v[148:151]
C v111,v126,v127
W a52,v108
M v[148:151],a[152:155],a[104:107],v[148:151]
s_waitcnt lgkmcnt(2)
T v[36:37],v18,40960
T v[38:39],v18,43008
M v[148:151],a[156:159],a[112:115],v[148:151]
T v[40:41],v18,45056
T v[42:43],v18,47104
M v[148:151],a[160:163],a[120:123],v[148:151]
W a53,v109
W a54,v110
M v[148:151],a[164:167],a[128:131],v[148:151]
T v[44:45],v18,49152
T v[46:47],v18,51200
M v[148:151],a[168:171],a[136:139],v[148:151]
T v[48:49],v18,53248
T v[50:51],v18,55296
M v[156:159],a[168:171],a[140:143],v[156:159]
W a55,v111
s_waitcnt vmcnt(11)
v_cmp_ne_u32 vcc, 1, v5
M v[156:159],a[164:167],a[132:135],v[156:159]
s_nop 0
T v[52:53],v18,57344
T v[54:55],v18,59392
M v[156:159],a[160:163],a[124:127],v[156:159]
s_cmp_lg_u32 vcc_hi, 0
T v[56:57],v18,61440
T v[58:59],v18,63488
M v[156:159],a[156:159],a[116:119],v[156:159]
s_cbranch_scc1 L_wsr0
L_wrr0:
MF v132,s5,v132
MF v133,s5,v133
M v[156:159],a[152:155],a[108:111],v[156:159]
SA m0,s28,131072
MF v134,s5,v134
MF v135,s5,v135
M v[156:159],a[148:151],a[100:103],v[156:159]
buffer_load_dwordx4 v3, s[8:11], s26 offen offset:0 sc1 lds
M v[156:159],a[144:147],a[236:239],v[156:159]
s_waitcnt lgkmcnt(6)
MF v148,s5,v148
MF v149,s5,v149
M v[164:167],v[32:35],a[232:235],v[164:167]
T a[144:145],v19,28672
T a[146:147],v19,30720
M v[164:167],v[36:39],a[96:99],v[164:167]
buffer_load_dwordx4 v3, s[8:11], s26 offen offset:1024 sc1 lds
M v[164:167],v[40:43],a[104:107],v[164:167]
s_waitcnt lgkmcnt(2)
s_nop 0
T a[148:149],v19,40960
T a[150:151],v19,43008
M v[164:167],v[44:47],a[112:115],v[164:167]
T a[152:153],v19,45056
T a[154:155],v19,47104
M v[164:167],v[48:51],a[120:123],v[164:167]
buffer_load_dwordx4 v3, s[8:11], s26 offen offset:2048 sc1 lds
M v[164:167],v[52:55],a[128:131],v[164:167]
s_nop 0
T a[156:157],v19,49152
T a[158:159],v19,51200
M v[164:167],v[56:59],a[136:139],v[164:167]
T a[160:161],v19,53248
T a[162:163],v19,55296
M v[172:175],v[56:59],a[140:143],v[172:175]
buffer_load_dwordx4 v3, s[8:11], s26 offen offset:3072 sc1 lds
M v[172:175],v[52:55],a[132:135],v[172:175]
SA m0,s28,135168
T a[164:165],v19,57344
T a[166:167],v19,59392
M v[172:175],v[48:51],a[124:127],v[172:175]
T a[168:169],v19,61440
T a[170:171],v19,63488
M v[172:175],v[44:47],a[116:119],v[172:175]
buffer_load_dwordx4 v4, s[8:11], s26 offen offset:0 sc1 lds
M v[172:175],v[40:43],a[108:111],v[172:175]
MF v150,s5,v150
MF v151,s5,v151
M v[172:175],v[36:39],a[100:103],v[172:175]
s_waitcnt lgkmcnt(0)
buffer_load_dwordx4 v4, s[8:11], s26 offen offset:1024 sc1 lds
M v[172:175],v[32:35],a[236:239],v[172:175]
s_barrier
M v[180:183],a[144:147],a[232:235],v[180:183]
R a[64:67],v2,32768
R a[68:71],v2,33792
M v[180:183],a[148:151],a[96:99],v[180:183]
buffer_load_dwordx4 v4, s[8:11], s26 offen offset:2048 sc1 lds
M v[180:183],a[152:155],a[104:107],v[180:183]
C v132,v132,v133
C v133,v134,v135
M v[180:183],a[156:159],a[112:115],v[180:183]
R a[72:75],v2,34816
R a[76:79],v2,35840
M v[180:183],a[160:163],a[120:123],v[180:183]
buffer_load_dwordx4 v4, s[8:11], s26 offen offset:3072 sc1 lds
M v[180:183],a[164:167],a[128:131],v[180:183]
SA s26,s26,32768
C v134,v148,v149
C v135,v150,v151
M v[180:183],a[168:171],a[136:139],v[180:183]
R a[80:83],v2,36864
R a[84:87],v2,37888
M v[188:191],a[168:171],a[140:143],v[188:191]
W a24,v132
W a25,v133
M v[188:191],a[164:167],a[132:135],v[188:191]
W a26,v134
W a27,v135
M v[188:191],a[160:163],a[124:127],v[188:191]
R a[88:91],v2,38912
R a[92:95],v2,39936
M v[188:191],a[156:159],a[116:119],v[188:191]
MF v140,s5,v140
MF v141,s5,v141
M v[188:191],a[152:155],a[108:111],v[188:191]
MF v142,s5,v142
MF v143,s5,v143
M v[188:191],a[148:151],a[100:103],v[188:191]
MF v156,s5,v156
MF v157,s5,v157
M v[188:191],a[144:147],a[236:239],v[188:191]
s_waitcnt lgkmcnt(0)
MF v158,s5,v158
MF v159,s5,v159
C v140,v140,v141
C v141,v142,v143
C v142,v156,v157
C v143,v158,v159
W a56,v140
W a57,v141
W a58,v142
W a59,v143
s_cmp_eq_u32 s42, 0
s_cbranch_scc1 L_j0
M v[64:67],a[64:67],a[0:3],0
R a[96:99],v2,40960
R a[100:103],v2,41984
M v[64:67],a[68:71],a[4:7],v[64:67]
MF v164,s5,v164
MF v165,s5,v165
M v[64:67],a[72:75],a[8:11],v[64:67]
MF v166,s5,v166
MF v167,s5,v167
M v[64:67],a[76:79],a[12:15],v[64:67]
R a[104:107],v2,43008
R a[108:111],v2,44032
M v[64:67],a[80:83],a[16:19],v[64:67]
MF v180,s5,v180
MF v181,s5,v181
MF v182,s5,v182
MF v183,s5,v183
C v164,v164,v165
C v165,v166,v167
C v166,v180,v181
C v167,v182,v183
W a28,v164
W a29,v165
W a30,v166
W a31,v167
M v[64:67],a[84:87],a[20:23],v[64:67]
MF v172,s5,v172
MF v173,s5,v173
M v[64:67],a[88:91],a[24:27],v[64:67]
R a[112:115],v2,45056
R a[116:119],v2,46080
M v[64:67],a[92:95],a[28:31],v[64:67]
MF v174,s5,v174
MF v175,s5,v175
M v[68:71],a[64:67],a[32:35],0
MF v188,s5,v188
MF v189,s5,v189
M v[68:71],a[68:71],a[36:39],v[68:71]
R a[120:123],v2,47104
R a[124:127],v2,48128
M v[68:71],a[72:75],a[40:43],v[68:71]
SA m0,s28,32768
MF v190,s5,v190
MF v191,s5,v191
M v[68:71],a[76:79],a[44:47],v[68:71]
SA s3,s93,786432
buffer_load_dwordx4 v3, s[8:11], s26 offen offset:0 sc1 lds
M v[68:71],a[80:83],a[48:51],v[68:71]
C v172,v172,v173
C v173,v174,v175
C v174,v188,v189
C v175,v190,v191
W a60,v172
W a61,v173
W a62,v174
W a63,v175
M v[68:71],a[84:87],a[52:55],v[68:71]
E v18,v64
M v[68:71],a[88:91],a[56:59],v[68:71]
buffer_store_dwordx4 v[192:195], v7, s[8:11], s3 offen offset:0 sc1
M v[68:71],a[92:95],a[60:63],v[68:71]
s_waitcnt lgkmcnt(0)
E v19,v65
M v[72:75],a[96:99],a[0:3],0
R a[64:67],v2,49152
R a[68:71],v2,50176
M v[72:75],a[100:103],a[4:7],v[72:75]
buffer_load_dwordx4 v3, s[8:11], s26 offen offset:1024 sc1 lds
M v[72:75],a[104:107],a[8:11],v[72:75]
E v20,v66
M v[72:75],a[108:111],a[12:15],v[72:75]
R a[72:75],v2,51200
R a[76:79],v2,52224
M v[72:75],a[112:115],a[16:19],v[72:75]
buffer_load_dwordx4 v3, s[8:11], s26 offen offset:2048 sc1 lds
M v[72:75],a[116:119],a[20:23],v[72:75]
E v21,v67
M v[72:75],a[120:123],a[24:27],v[72:75]
R a[80:83],v2,53248
R a[84:87],v2,54272
M v[72:75],a[124:127],a[28:31],v[72:75]
buffer_load_dwordx4 v3, s[8:11], s26 offen offset:3072 sc1 lds
M v[76:79],a[124:127],a[60:63],0
SA m0,s28,36864
E v22,v68
M v[76:79],a[120:123],a[56:59],v[76:79]
R a[88:91],v2,55296
R a[92:95],v2,56320
M v[76:79],a[116:119],a[52:55],v[76:79]
buffer_load_dwordx4 v4, s[8:11], s26 offen offset:0 sc1 lds
M v[76:79],a[112:115],a[48:51],v[76:79]
E v23,v69
M v[76:79],a[108:111],a[44:47],v[76:79]
AF v26,v18,v19
C v40,v18,v19
M v[76:79],a[104:107],a[40:43],v[76:79]
buffer_load_dwordx4 v4, s[8:11], s26 offen offset:1024 sc1 lds
M v[76:79],a[100:103],a[36:39],v[76:79]
v_add_u32 v16, 0x20000, v7
AF v26,v20,v26
M v[76:79],a[96:99],a[32:35],v[76:79]
s_waitcnt lgkmcnt(0)
E v24,v70
M v[80:83],a[64:67],a[0:3],0
R a[96:99],v2,57344
R a[100:103],v2,58368
M v[80:83],a[68:71],a[4:7],v[80:83]
buffer_load_dwordx4 v4, s[8:11], s26 offen offset:2048 sc1 lds
M v[80:83],a[72:75],a[8:11],v[80:83]
E v25,v71
M v[80:83],a[76:79],a[12:15],v[80:83]
R a[104:107],v2,59392
R a[108:111],v2,60416
M v[80:83],a[80:83],a[16:19],v[80:83]
buffer_store_dwordx4 v[200:203], v7, s[8:11], s3 offen offset:1024 sc1
M v[80:83],a[84:87],a[20:23],v[80:83]
E v18,v72
M v[80:83],a[88:91],a[24:27],v[80:83]
R a[112:115],v2,61440
R a[116:119],v2,62464
M v[80:83],a[92:95],a[28:31],v[80:83]
buffer_load_dwordx4 v4, s[8:11], s26 offen offset:3072 sc1 lds
M v[84:87],a[92:95],a[60:63],0
SA s26,s26,32768
E v19,v73
M v[84:87],a[88:91],a[56:59],v[84:87]
R a[120:123],v2,63488
R a[124:127],v2,64512
M v[84:87],a[84:87],a[52:55],v[84:87]
C v41,v20,v21
AF v26,v21,v26
M v[84:87],a[80:83],a[48:51],v[84:87]
buffer_store_dwordx4 v[208:211], v7, s[8:11], s3 offen offset:2048 sc1
M v[84:87],a[76:79],a[44:47],v[84:87]
E v20,v74
M v[84:87],a[72:75],a[40:43],v[84:87]
AF v27,v22,v23
C v44,v22,v23
M v[84:87],a[68:71],a[36:39],v[84:87]
s_waitcnt vmcnt(24) lgkmcnt(0)
E v21,v75
M v[84:87],a[64:67],a[32:35],v[84:87]
s_barrier
M v[88:91],a[96:99],a[0:3],0
R a[64:67],v2,0
R a[68:71],v2,1024
M v[88:91],a[100:103],a[4:7],v[88:91]
E v22,v76
M v[88:91],a[104:107],a[8:11],v[88:91]
AF v27,v24,v27
C v45,v24,v25
M v[88:91],a[108:111],a[12:15],v[88:91]
R a[72:75],v2,2048
R a[76:79],v2,3072
M v[88:91],a[112:115],a[16:19],v[88:91]
E v23,v77
M v[88:91],a[116:119],a[20:23],v[88:91]
AF v27,v25,v27
AF v26,v18,v26
M v[88:91],a[120:123],a[24:27],v[88:91]
R a[80:83],v2,4096
R a[84:87],v2,5120
M v[88:91],a[124:127],a[28:31],v[88:91]
E v24,v78
M v[92:95],a[124:127],a[60:63],0
C v42,v18,v19
AF v26,v19,v26
M v[92:95],a[120:123],a[56:59],v[92:95]
R a[88:91],v2,6144
R a[92:95],v2,7168
M v[92:95],a[116:119],a[52:55],v[92:95]
E v25,v79
M v[92:95],a[112:115],a[48:51],v[92:95]
AF v26,v20,v26
C v43,v20,v21
M v[92:95],a[108:111],a[44:47],v[92:95]
AF v26,v21,v26
AF v27,v22,v27
M v[92:95],a[104:107],a[40:43],v[92:95]
C v46,v22,v23
AF v27,v23,v27
M v[92:95],a[100:103],a[36:39],v[92:95]
s_waitcnt lgkmcnt(0)
AF v27,v24,v27
C v47,v24,v25
M v[92:95],a[96:99],a[32:35],v[92:95]
AF v27,v25,v27
M v[96:99],a[64:67],a[0:3],0
R a[96:99],v2,8192
R a[100:103],v2,9216
M v[96:99],a[68:71],a[4:7],v[96:99]
SA m0,s28,98304
E v18,v80
M v[96:99],a[72:75],a[8:11],v[96:99]
buffer_load_dwordx4 v3, s[8:11], s21 offen offset:0 sc1 lds
M v[96:99],a[76:79],a[12:15],v[96:99]
R a[104:107],v2,10240
R a[108:111],v2,11264
M v[96:99],a[80:83],a[16:19],v[96:99]
v_mov_b32 v30, 0
M v[96:99],a[84:87],a[20:23],v[96:99]
E v19,v81
M v[96:99],a[88:91],a[24:27],v[96:99]
R a[112:115],v2,12288
R a[116:119],v2,13312
M v[96:99],a[92:95],a[28:31],v[96:99]
buffer_load_dwordx4 v3, s[8:11], s21 offen offset:1024 sc1 lds
M v[100:103],a[92:95],a[60:63],0
v_mov_b32 v31, 0
AF v26,v18,v26
M v[100:103],a[88:91],a[56:59],v[100:103]
R a[120:123],v2,14336
R a[124:127],v2,15360
M v[100:103],a[84:87],a[52:55],v[100:103]
SA s3,s93,786432
E v20,v82
M v[100:103],a[80:83],a[48:51],v[100:103]
buffer_load_dwordx4 v3, s[8:11], s21 offen offset:2048 sc1 lds
M v[100:103],a[76:79],a[44:47],v[100:103]
E v21,v83
M v[100:103],a[72:75],a[40:43],v[100:103]
v_mov_b32 v32, 0
C v56,v18,v19
M v[100:103],a[68:71],a[36:39],v[100:103]
buffer_store_dwordx4 v[216:219], v7, s[8:11], s3 offen offset:3072 sc1
M v[100:103],a[64:67],a[32:35],v[100:103]
s_waitcnt lgkmcnt(0)
E v22,v88
M v[108:111],a[96:99],a[32:35],0
R a[64:67],v2,16384
R a[68:71],v2,17408
M v[108:111],a[100:103],a[36:39],v[108:111]
buffer_load_dwordx4 v3, s[8:11], s21 offen offset:3072 sc1 lds
M v[108:111],a[104:107],a[40:43],v[108:111]
SA m0,s28,102400
v_mov_b32 v33, 0
AF v26,v19,v26
M v[108:111],a[108:111],a[44:47],v[108:111]
R a[72:75],v2,18432
R a[76:79],v2,19456
M v[108:111],a[112:115],a[48:51],v[108:111]
buffer_load_dwordx4 v4, s[8:11], s21 offen offset:0 sc1 lds
M v[108:111],a[116:119],a[52:55],v[108:111]
E v23,v89
M v[108:111],a[120:123],a[56:59],v[108:111]
R a[80:83],v2,20480
R a[84:87],v2,21504
M v[108:111],a[124:127],a[60:63],v[108:111]
buffer_load_dwordx4 v4, s[8:11], s21 offen offset:1024 sc1 lds
M v[104:107],a[124:127],a[28:31],0
v_mov_b32 v34, 0
AF v26,v20,v26
M v[104:107],a[120:123],a[24:27],v[104:107]
SA s3,s93,794624
R a[88:91],v2,22528
R a[92:95],v2,23552
M v[104:107],a[116:119],a[20:23],v[104:107]
buffer_load_dwordx4 v4, s[8:11], s21 offen offset:2048 sc1 lds
M v[104:107],a[112:115],a[16:19],v[104:107]
v_mov_b32 v35, 0
C v57,v20,v21
M v[104:107],a[108:111],a[12:15],v[104:107]
E v24,v90
M v[104:107],a[104:107],a[8:11],v[104:107]
E v25,v91
M v[104:107],a[100:103],a[4:7],v[104:107]
buffer_load_dwordx4 v4, s[8:11], s21 offen offset:3072 sc1 lds
M v[104:107],a[96:99],a[0:3],v[104:107]
s_waitcnt lgkmcnt(0)
v_mov_b32 v36, 0
AF v26,v21,v26
M v[112:115],a[64:67],a[0:3],0
SA s21,s21,32768
R a[96:99],v2,24576
R a[100:103],v2,25600
M v[112:115],a[68:71],a[4:7],v[112:115]
s_sub_u32 s22, s22, 1
buffer_store_dwordx4 v[224:227], v7, s[8:11], s3 offen offset:0 sc1
M v[112:115],a[72:75],a[8:11],v[112:115]
s_cselect_b32 s21, s23, s21
E v18,v84
M v[112:115],a[76:79],a[12:15],v[112:115]
R a[104:107],v2,26624
R a[108:111],v2,27648
M v[112:115],a[80:83],a[16:19],v[112:115]
v_mov_b32 v37, 0
AF v26,v22,v26
M v[112:115],a[84:87],a[20:23],v[112:115]
E v19,v85
M v[112:115],a[88:91],a[24:27],v[112:115]
R a[112:115],v2,28672
R a[116:119],v2,29696
M v[112:115],a[92:95],a[28:31],v[112:115]
E v20,v86
M v[116:119],a[92:95],a[60:63],0
v_mov_b32 v38, 0
C v58,v22,v23
M v[116:119],a[88:91],a[56:59],v[116:119]
R a[120:123],v2,30720
R a[124:127],v2,31744
M v[116:119],a[84:87],a[52:55],v[116:119]
E v21,v87
M v[116:119],a[80:83],a[48:51],v[116:119]
buffer_store_dwordx4 v[232:235], v7, s[8:11], s3 offen offset:1024 sc1
M v[116:119],a[76:79],a[44:47],v[116:119]
AF v26,v23,v26
AF v26,v24,v26
M v[116:119],a[72:75],a[40:43],v[116:119]
v_mov_b32 v39, 0
C v59,v24,v25
M v[116:119],a[68:71],a[36:39],v[116:119]
s_waitcnt vmcnt(22) lgkmcnt(0)
E v22,v92
M v[116:119],a[64:67],a[32:35],v[116:119]
s_barrier
M v[124:127],a[96:99],a[32:35],0
R a[64:67],v16,0
R a[68:71],v16,1024
M v[124:127],a[100:103],a[36:39],v[124:127]
E v23,v93
M v[124:127],a[104:107],a[40:43],v[124:127]
AF v26,v25,v26
AF v27,v18,v27
M v[124:127],a[108:111],a[44:47],v[124:127]
R a[72:75],v16,2048
R a[76:79],v16,3072
M v[124:127],a[112:115],a[48:51],v[124:127]
E v24,v94
M v[124:127],a[116:119],a[52:55],v[124:127]
E v25,v95
M v[124:127],a[120:123],a[56:59],v[124:127]
R a[80:83],v16,4096
R a[84:87],v16,5120
M v[124:127],a[124:127],a[60:63],v[124:127]
C v60,v18,v19
AF v27,v19,v27
M v[120:123],a[124:127],a[28:31],0
AF v27,v20,v27
C v61,v20,v21
M v[120:123],a[120:123],a[24:27],v[120:123]
R a[88:91],v16,6144
R a[92:95],v16,7168
M v[120:123],a[116:119],a[20:23],v[120:123]
AF v27,v21,v27
AF v27,v22,v27
M v[120:123],a[112:115],a[16:19],v[120:123]
C v62,v22,v23
AF v27,v23,v27
M v[120:123],a[108:111],a[12:15],v[120:123]
AF v27,v24,v27
C v63,v24,v25
M v[120:123],a[104:107],a[8:11],v[120:123]
AF v27,v25,v27
M v[120:123],a[100:103],a[4:7],v[120:123]
s_waitcnt lgkmcnt(0)
M v[120:123],a[96:99],a[0:3],v[120:123]
v_max_f32 v10, v26, v27
v_min_f32 v11, v26, v27
v_cmp_lt_f32 vcc, s31, v10
v_cmp_gt_f32 s[64:65], s24, v11
s_nop 0
s_or_b64 vcc, vcc, s[64:65]
s_cbranch_vccnz L_stk1
L_rtk1:
M v[128:131],a[64:67],v[40:43],0
R a[96:99],v16,8192
R a[100:103],v16,9216
M v[128:131],a[68:71],v[56:59],v[128:131]
SA m0,s28,65536
E v18,v96
M v[132:135],a[68:71],v[60:63],0
buffer_load_dwordx4 v3, s[8:11], s21 offen offset:0 sc1 lds
M v[132:135],a[64:67],v[44:47],v[132:135]
R a[104:107],v16,10240
R a[108:111],v16,11264
M v[140:143],a[72:75],v[44:47],0
SA s3,s93,794624
E v19,v97
M v[140:143],a[76:79],v[60:63],v[140:143]
AF v30,v26,v30
AF v31,v27,v31
M v[136:139],a[76:79],v[56:59],0
R a[112:115],v16,12288
R a[116:119],v16,13312
M v[136:139],a[72:75],v[40:43],v[136:139]
buffer_load_dwordx4 v3, s[8:11], s21 offen offset:1024 sc1 lds
M v[144:147],a[80:83],v[40:43],0
E v20,v98
M v[144:147],a[84:87],v[56:59],v[144:147]
R a[120:123],v16,14336
R a[124:127],v16,15360
M v[148:151],a[84:87],v[60:63],0
buffer_store_dwordx4 v[240:243], v7, s[8:11], s3 offen offset:2048 sc1
M v[148:151],a[80:83],v[44:47],v[148:151]
E v21,v99
M v[156:159],a[88:91],v[44:47],0
AF v28,v18,v19
C v48,v18,v19
M v[156:159],a[92:95],v[60:63],v[156:159]
buffer_load_dwordx4 v3, s[8:11], s21 offen offset:2048 sc1 lds
M v[152:155],a[92:95],v[56:59],0
AF v28,v20,v28
C v49,v20,v21
M v[152:155],a[88:91],v[40:43],v[152:155]
s_waitcnt lgkmcnt(0)
E v22,v104
M v[160:163],a[96:99],v[40:43],0
R a[64:67],v16,16384
R a[68:71],v16,17408
M v[160:163],a[100:103],v[56:59],v[160:163]
buffer_load_dwordx4 v3, s[8:11], s21 offen offset:3072 sc1 lds
M v[164:167],a[100:103],v[60:63],0
SA m0,s28,69632
E v23,v105
M v[164:167],a[96:99],v[44:47],v[164:167]
R a[72:75],v16,18432
R a[76:79],v16,19456
M v[172:175],a[104:107],v[44:47],0
buffer_load_dwordx4 v4, s[8:11], s21 offen offset:0 sc1 lds
M v[172:175],a[108:111],v[60:63],v[172:175]
AF v28,v21,v28
AF v28,v22,v28
M v[168:171],a[108:111],v[56:59],0
R a[80:83],v16,20480
R a[84:87],v16,21504
M v[168:171],a[104:107],v[40:43],v[168:171]
buffer_store_dwordx4 v[248:251], v7, s[8:11], s3 offen offset:3072 sc1
M v[176:179],a[112:115],v[40:43],0
E v24,v106
M v[176:179],a[116:119],v[56:59],v[176:179]
R a[88:91],v16,22528
R a[92:95],v16,23552
M v[180:183],a[116:119],v[60:63],0
buffer_load_dwordx4 v4, s[8:11], s21 offen offset:1024 sc1 lds
M v[180:183],a[112:115],v[44:47],v[180:183]
E v25,v107
M v[188:191],a[120:123],v[44:47],0
C v50,v22,v23
AF v28,v23,v28
M v[188:191],a[124:127],v[60:63],v[188:191]
buffer_load_dwordx4 v4, s[8:11], s21 offen offset:2048 sc1 lds
M v[184:187],a[124:127],v[56:59],0
E v18,v100
M v[184:187],a[120:123],v[40:43],v[184:187]
s_waitcnt lgkmcnt(0)
AF v28,v24,v28
C v51,v24,v25
M v[192:195],a[64:67],v[40:43],0
R a[96:99],v16,24576
R a[100:103],v16,25600
M v[192:195],a[68:71],v[56:59],v[192:195]
buffer_load_dwordx4 v4, s[8:11], s21 offen offset:3072 sc1 lds
M v[196:199],a[68:71],v[60:63],0
SA s21,s21,32768
E v19,v101
M v[196:199],a[64:67],v[44:47],v[196:199]
s_sub_u32 s22, s22, 1
R a[104:107],v16,26624
R a[108:111],v16,27648
M v[204:207],a[72:75],v[44:47],0
s_cselect_b32 s21, s23, s21
AF v28,v25,v28
AF v29,v18,v19
M v[204:207],a[76:79],v[60:63],v[204:207]
E v20,v102
M v[200:203],a[76:79],v[56:59],0
R a[112:115],v16,28672
R a[116:119],v16,29696
M v[200:203],a[72:75],v[40:43],v[200:203]
C v52,v18,v19
M v[208:211],a[80:83],v[40:43],0
M v[208:211],a[84:87],v[56:59],v[208:211]
R a[120:123],v16,30720
R a[124:127],v16,31744
M v[212:215],a[84:87],v[60:63],0
E v21,v103
M v[212:215],a[80:83],v[44:47],v[212:215]
AF v29,v20,v29
C v53,v20,v21
M v[220:223],a[88:91],v[44:47],0
AF v29,v21,v29
M v[220:223],a[92:95],v[60:63],v[220:223]
E v22,v108
M v[216:219],a[92:95],v[56:59],0
s_waitcnt vmcnt(12) lgkmcnt(0)
M v[216:219],a[88:91],v[40:43],v[216:219]
s_barrier
M v[224:227],a[96:99],v[40:43],0
R a[64:67],v2,32768
R a[68:71],v2,33792
M v[224:227],a[100:103],v[56:59],v[224:227]
E v23,v109
M v[228:231],a[100:103],v[60:63],0
AF v29,v22,v29
C v54,v22,v23
M v[228:231],a[96:99],v[44:47],v[228:231]
R a[72:75],v2,34816
R a[76:79],v2,35840
M v[236:239],a[104:107],v[44:47],0
E v24,v110
M v[236:239],a[108:111],v[60:63],v[236:239]
AF v29,v23,v29
M v[232:235],a[108:111],v[56:59],0
R a[80:83],v2,36864
R a[84:87],v2,37888
M v[232:235],a[104:107],v[40:43],v[232:235]
M v[240:243],a[112:115],v[40:43],0
E v25,v111
M v[240:243],a[116:119],v[56:59],v[240:243]
R a[88:91],v2,38912
R a[92:95],v2,39936
M v[244:247],a[116:119],v[60:63],0
AF v29,v24,v29
C v55,v24,v25
M v[244:247],a[112:115],v[44:47],v[244:247]
AF v29,v25,v29
M v[252:255],a[120:123],v[44:47],0
M v[252:255],a[124:127],v[60:63],v[252:255]
M v[248:251],a[124:127],v[56:59],0
s_waitcnt lgkmcnt(0)
M v[248:251],a[120:123],v[40:43],v[248:251]
s_cmp_lg_u32 s27, 0
s_cbranch_scc1 L_loop_top
s_branch L_d1s
L_j0:
M v[68:71],a[64:67],a[32:35],0
s_cmp_lt_u32 s20, 0
R a[96:99],v2,40960
R a[100:103],v2,41984
M v[68:71],a[68:71],a[36:39],v[68:71]
s_cselect_b64 s[82:83], -1, 0
v_mov_b32 v30, 0
MF v172,s5,v172
M v[68:71],a[72:75],a[40:43],v[68:71]
s_cmp_eq_u32 s20, 0
MF v173,s5,v173
MF v174,s5,v174
M v[68:71],a[76:79],a[44:47],v[68:71]
s_cselect_b64 s[66:67], s[16:17], s[82:83]
R a[104:107],v2,43008
R a[108:111],v2,44032
M v[68:71],a[80:83],a[48:51],v[68:71]
s_cselect_b64 s[68:69], s[18:19], s[82:83]
MF v175,s5,v175
MF v188,s5,v188
M v[68:71],a[84:87],a[52:55],v[68:71]
s_cselect_b64 s[70:71], s[48:49], s[82:83]
MF v189,s5,v189
MF v190,s5,v190
MF v191,s5,v191
C v172,v172,v173
C v173,v174,v175
C v174,v188,v189
C v175,v190,v191
W a60,v172
W a61,v173
W a62,v174
W a63,v175
M v[68:71],a[88:91],a[56:59],v[68:71]
s_cselect_b64 s[72:73], s[50:51], s[82:83]
R a[112:115],v2,45056
R a[116:119],v2,46080
v_cndmask_b32 v64, 0, v8, s[66:67]
v_cndmask_b32 v65, 0, v8, s[68:69]
v_cndmask_b32 v66, 0, v8, s[70:71]
v_cndmask_b32 v67, 0, v8, s[72:73]
M v[68:71],a[92:95],a[60:63],v[68:71]
s_cmp_lt_u32 s20, 1
MF v164,s5,v164
MF v165,s5,v165
M v[64:67],a[64:67],a[0:3],v[64:67]
s_cselect_b64 s[82:83], -1, 0
MF v166,s5,v166
MF v167,s5,v167
M v[64:67],a[68:71],a[4:7],v[64:67]
s_cmp_eq_u32 s20, 1
R a[120:123],v2,47104
R a[124:127],v2,48128
M v[64:67],a[72:75],a[8:11],v[64:67]
s_cselect_b64 s[74:75], s[16:17], s[82:83]
MF v180,s5,v180
MF v181,s5,v181
M v[64:67],a[76:79],a[12:15],v[64:67]
s_cselect_b64 s[76:77], s[18:19], s[82:83]
MF v182,s5,v182
MF v183,s5,v183
M v[64:67],a[80:83],a[16:19],v[64:67]
s_cselect_b64 s[78:79], s[48:49], s[82:83]
C v164,v164,v165
C v165,v166,v167
C v166,v180,v181
C v167,v182,v183
W a28,v164
W a29,v165
W a30,v166
W a31,v167
M v[64:67],a[84:87],a[20:23],v[64:67]
s_cselect_b64 s[80:81], s[50:51], s[82:83]
v_mov_b32 v31, 0
v_cndmask_b32 v72, 0, v8, s[74:75]
M v[64:67],a[88:91],a[24:27],v[64:67]
s_mov_b32 s26, s43
v_mov_b32 v32, 0
M v[64:67],a[92:95],a[28:31],v[64:67]
s_waitcnt lgkmcnt(0)
v_cndmask_b32 v73, 0, v8, s[76:77]
M v[76:79],a[96:99],a[32:35],0
SA m0,s28,0
R a[64:67],v2,49152
R a[68:71],v2,50176
M v[76:79],a[100:103],a[36:39],v[76:79]
SA s3,s93,786432
buffer_load_dwordx4 v3, s[8:11], s26 offen offset:0 sc1 lds
M v[76:79],a[104:107],a[40:43],v[76:79]
v_cndmask_b32 v74, 0, v8, s[78:79]
v_mov_b32 v33, 0
M v[76:79],a[108:111],a[44:47],v[76:79]
R a[72:75],v2,51200
R a[76:79],v2,52224
M v[76:79],a[112:115],a[48:51],v[76:79]
buffer_store_dwordx4 v[192:195], v7, s[8:11], s3 offen offset:0 sc1
M v[76:79],a[116:119],a[52:55],v[76:79]
v_cndmask_b32 v75, 0, v8, s[80:81]
M v[76:79],a[120:123],a[56:59],v[76:79]
s_cmp_lt_u32 s20, 2
R a[80:83],v2,53248
R a[84:87],v2,54272
M v[76:79],a[124:127],a[60:63],v[76:79]
s_cselect_b64 s[82:83], -1, 0
buffer_load_dwordx4 v3, s[8:11], s26 offen offset:1024 sc1 lds
M v[72:75],a[124:127],a[28:31],v[72:75]
s_cmp_eq_u32 s20, 2
E v18,v68
M v[72:75],a[120:123],a[24:27],v[72:75]
s_cselect_b64 s[66:67], s[16:17], s[82:83]
R a[88:91],v2,55296
R a[92:95],v2,56320
M v[72:75],a[116:119],a[20:23],v[72:75]
s_cselect_b64 s[68:69], s[18:19], s[82:83]
buffer_load_dwordx4 v3, s[8:11], s26 offen offset:2048 sc1 lds
M v[72:75],a[112:115],a[16:19],v[72:75]
s_cselect_b64 s[70:71], s[48:49], s[82:83]
v_mov_b32 v34, 0
M v[72:75],a[108:111],a[12:15],v[72:75]
s_cselect_b64 s[72:73], s[50:51], s[82:83]
v_cndmask_b32 v80, 0, v8, s[66:67]
v_cndmask_b32 v81, 0, v8, s[68:69]
M v[72:75],a[104:107],a[8:11],v[72:75]
buffer_store_dwordx4 v[200:203], v7, s[8:11], s3 offen offset:1024 sc1
M v[72:75],a[100:103],a[4:7],v[72:75]
E v19,v69
M v[72:75],a[96:99],a[0:3],v[72:75]
s_waitcnt lgkmcnt(0)
buffer_load_dwordx4 v3, s[8:11], s26 offen offset:3072 sc1 lds
M v[84:87],a[64:67],a[32:35],0
SA m0,s28,4096
R a[96:99],v2,57344
R a[100:103],v2,58368
M v[84:87],a[68:71],a[36:39],v[84:87]
v_cndmask_b32 v82, 0, v8, s[70:71]
v_mov_b32 v35, 0
M v[84:87],a[72:75],a[40:43],v[84:87]
buffer_load_dwordx4 v4, s[8:11], s26 offen offset:0 sc1 lds
M v[84:87],a[76:79],a[44:47],v[84:87]
R a[104:107],v2,59392
R a[108:111],v2,60416
M v[84:87],a[80:83],a[48:51],v[84:87]
buffer_store_dwordx4 v[208:211], v7, s[8:11], s3 offen offset:2048 sc1
M v[84:87],a[84:87],a[52:55],v[84:87]
v_cndmask_b32 v83, 0, v8, s[72:73]
v_mov_b32 v36, 0
M v[84:87],a[88:91],a[56:59],v[84:87]
s_cmp_lt_u32 s20, 3
R a[112:115],v2,61440
R a[116:119],v2,62464
M v[84:87],a[92:95],a[60:63],v[84:87]
s_cselect_b64 s[82:83], -1, 0
buffer_load_dwordx4 v4, s[8:11], s26 offen offset:1024 sc1 lds
M v[80:83],a[92:95],a[28:31],v[80:83]
s_cmp_eq_u32 s20, 3
E v20,v70
M v[80:83],a[88:91],a[24:27],v[80:83]
s_cselect_b64 s[74:75], s[16:17], s[82:83]
R a[120:123],v2,63488
R a[124:127],v2,64512
M v[80:83],a[84:87],a[20:23],v[80:83]
s_cselect_b64 s[76:77], s[18:19], s[82:83]
buffer_load_dwordx4 v4, s[8:11], s26 offen offset:2048 sc1 lds
M v[80:83],a[80:83],a[16:19],v[80:83]
s_cselect_b64 s[78:79], s[48:49], s[82:83]
E v21,v71
M v[80:83],a[76:79],a[12:15],v[80:83]
s_cselect_b64 s[80:81], s[50:51], s[82:83]
buffer_store_dwordx4 v[216:219], v7, s[8:11], s3 offen offset:3072 sc1
M v[80:83],a[72:75],a[8:11],v[80:83]
SA s3,s93,794624
v_cndmask_b32 v88, 0, v8, s[74:75]
v_cndmask_b32 v89, 0, v8, s[76:77]
M v[80:83],a[68:71],a[4:7],v[80:83]
s_waitcnt vmcnt(24) lgkmcnt(0)
buffer_load_dwordx4 v4, s[8:11], s26 offen offset:3072 sc1 lds
M v[80:83],a[64:67],a[0:3],v[80:83]
s_barrier
M v[92:95],a[96:99],a[32:35],0
R a[64:67],v2,0
R a[68:71],v2,1024
M v[92:95],a[100:103],a[36:39],v[92:95]
buffer_store_dwordx4 v[224:227], v7, s[8:11], s3 offen offset:0 sc1
M v[92:95],a[104:107],a[40:43],v[92:95]
v_min_u32 v17, 896, v9
v_cndmask_b32 v90, 0, v8, s[78:79]
M v[92:95],a[108:111],a[44:47],v[92:95]
R a[72:75],v2,2048
R a[76:79],v2,3072
M v[92:95],a[112:115],a[48:51],v[92:95]
buffer_load_dword v5, v17, s[8:11], s46 offen sc1
M v[92:95],a[116:119],a[52:55],v[92:95]
buffer_store_dwordx4 v[232:235], v7, s[8:11], s3 offen offset:1024 sc1
M v[92:95],a[120:123],a[56:59],v[92:95]
R a[80:83],v2,4096
R a[84:87],v2,5120
v_cndmask_b32 v91, 0, v8, s[80:81]
M v[92:95],a[124:127],a[60:63],v[92:95]
v_mov_b32 v37, 0
v_mov_b32 v38, 0
M v[88:91],a[124:127],a[28:31],v[88:91]
buffer_store_dwordx4 v[240:243], v7, s[8:11], s3 offen offset:2048 sc1
M v[88:91],a[120:123],a[24:27],v[88:91]
R a[88:91],v2,6144
R a[92:95],v2,7168
M v[88:91],a[116:119],a[20:23],v[88:91]
v_mov_b32 v39, 0
AF v27,v18,v19
M v[88:91],a[112:115],a[16:19],v[88:91]
buffer_store_dwordx4 v[248:251], v7, s[8:11], s3 offen offset:3072 sc1
M v[88:91],a[108:111],a[12:15],v[88:91]
E v22,v64
M v[88:91],a[104:107],a[8:11],v[88:91]
E v23,v65
M v[88:91],a[100:103],a[4:7],v[88:91]
s_waitcnt lgkmcnt(0)
E v24,v66
M v[88:91],a[96:99],a[0:3],v[88:91]
E v25,v67
C v44,v18,v19
AF v27,v20,v27
C v45,v20,v21
AF v27,v21,v27
AF v26,v22,v23
C v40,v22,v23
E v18,v76
E v19,v77
AF v26,v24,v26
C v41,v24,v25
AF v26,v25,v26
E v20,v78
E v21,v79
AF v27,v18,v27
C v46,v18,v19
AF v27,v19,v27
E v22,v72
E v23,v73
AF v27,v20,v27
C v47,v20,v21
AF v27,v21,v27
E v24,v74
E v25,v75
AF v26,v22,v26
C v42,v22,v23
AF v26,v23,v26
AF v26,v24,v26
C v43,v24,v25
AF v26,v25,v26
v_mov_b32 v56, 0
v_mov_b32 v57, 0
v_mov_b32 v58, 0
v_mov_b32 v59, 0
s_mul_i32 s21, s41, 1048576
SA s21,s21,589824
s_lshl_b32 s84, s42, 1
s_sub_u32 s22, 11, s84
s_mov_b32 s23, 536870912
s_lshl_b32 s86, s20, 14
SA s86,s86,s34
SA s87,s86,4096
SA s88,s86,8192
SA s89,s86,12288
s_lshl_b32 s90, s20, 10
SA s90,s90,s34
SA s90,s90,65536
s_waitcnt vmcnt(3)
v_cmp_gt_u32 vcc, 2, v5
s_nop 0
s_cbranch_vccnz L_lsj0
L_lrj0:
SA m0,s28,98304
v_mov_b32 v10, v26
buffer_load_dwordx4 v3, s[8:11], s21 offen offset:0 sc1 lds
v_mov_b32 v11, v27
buffer_load_dwordx4 v3, s[8:11], s21 offen offset:1024 sc1 lds
v_mov_b32 v12, v10
v_mov_b32 v13, v11
buffer_load_dwordx4 v3, s[8:11], s21 offen offset:2048 sc1 lds
v_permlane16_swap_b32 v12, v10
v_permlane16_swap_b32 v13, v11
buffer_load_dwordx4 v3, s[8:11], s21 offen offset:3072 sc1 lds
v_max_f32 v10, v12, v10
SA m0,s28,102400
v_max_f32 v11, v13, v11
buffer_load_dwordx4 v4, s[8:11], s21 offen offset:0 sc1 lds
v_mov_b32 v12, v10
v_mov_b32 v13, v11
buffer_load_dwordx4 v4, s[8:11], s21 offen offset:1024 sc1 lds
v_permlane32_swap_b32 v12, v10
v_permlane32_swap_b32 v13, v11
buffer_load_dwordx4 v4, s[8:11], s21 offen offset:2048 sc1 lds
v_max_f32 v10, v12, v10
v_max_f32 v11, v13, v11
buffer_load_dwordx4 v4, s[8:11], s21 offen offset:3072 sc1 lds
SA s21,s21,32768
s_sub_u32 s22, s22, 1
s_cselect_b32 s21, s23, s21
v_min_f32 v10, v10, v11
v_cmp_gt_f32 vcc, s24, v10
s_nop 0
s_cbranch_vccnz L_stj0
L_rtj0:
s_cmp_gt_u32 s20, 3
s_cselect_b64 s[82:83], -1, 0
s_cmp_eq_u32 s20, 3
s_cselect_b64 s[66:67], s[16:17], s[82:83]
v_mfma_f32_32x32x16_bf16 v[128:143], v[56:59], v[56:59], 0
s_cselect_b64 s[68:69], s[18:19], s[82:83]
s_cselect_b64 s[70:71], s[48:49], s[82:83]
s_cselect_b64 s[72:73], s[50:51], s[82:83]
v_cndmask_b32 v100, v36, v8, s[66:67]
v_mfma_f32_32x32x16_bf16 v[144:159], v[56:59], v[56:59], 0
v_cndmask_b32 v101, v36, v8, s[68:69]
v_cndmask_b32 v102, v36, v8, s[70:71]
v_cndmask_b32 v103, v36, v8, s[72:73]
s_cmp_gt_u32 s20, 2
v_mfma_f32_32x32x16_bf16 v[160:175], v[56:59], v[56:59], 0
s_cselect_b64 s[82:83], -1, 0
s_cmp_eq_u32 s20, 2
s_cselect_b64 s[74:75], s[16:17], s[82:83]
s_cselect_b64 s[76:77], s[18:19], s[82:83]
v_mfma_f32_32x32x16_bf16 v[176:191], v[56:59], v[56:59], 0
s_cselect_b64 s[78:79], s[48:49], s[82:83]
s_cselect_b64 s[80:81], s[50:51], s[82:83]
v_cndmask_b32 v108, v36, v8, s[74:75]
v_cndmask_b32 v109, v36, v8, s[76:77]
v_mfma_f32_32x32x16_bf16 v[192:207], v[56:59], v[56:59], 0
v_cndmask_b32 v110, v36, v8, s[78:79]
v_cndmask_b32 v111, v36, v8, s[80:81]
s_cmp_gt_u32 s20, 1
s_cselect_b64 s[82:83], -1, 0
v_mfma_f32_32x32x16_bf16 v[208:223], v[56:59], v[56:59], 0
s_cmp_eq_u32 s20, 1
s_cselect_b64 s[66:67], s[16:17], s[82:83]
s_cselect_b64 s[68:69], s[18:19], s[82:83]
s_cselect_b64 s[70:71], s[48:49], s[82:83]
v_mfma_f32_32x32x16_bf16 v[224:239], v[56:59], v[56:59], 0
s_cselect_b64 s[72:73], s[50:51], s[82:83]
v_cndmask_b32 v116, v36, v8, s[66:67]
v_cndmask_b32 v117, v36, v8, s[68:69]
v_cndmask_b32 v118, v36, v8, s[70:71]
v_mfma_f32_32x32x16_bf16 v[240:255], v[56:59], v[56:59], 0
v_cndmask_b32 v119, v36, v8, s[72:73]
s_cmp_gt_u32 s20, 0
s_cselect_b64 s[82:83], -1, 0
s_cmp_eq_u32 s20, 0
s_cselect_b64 s[74:75], s[16:17], s[82:83]
s_cselect_b64 s[76:77], s[18:19], s[82:83]
s_cselect_b64 s[78:79], s[48:49], s[82:83]
s_cselect_b64 s[80:81], s[50:51], s[82:83]
v_cndmask_b32 v124, v36, v8, s[74:75]
v_cndmask_b32 v125, v36, v8, s[76:77]
v_cndmask_b32 v126, v36, v8, s[78:79]
v_cndmask_b32 v127, v36, v8, s[80:81]
s_branch L_d3h
.p2align 12
L_kv1:
s_and_b32 s31, s42, 7
s_lshl_b32 s30, s41, 3
SA s30,s30,s31
s_lshl_b32 s64, s30, 2
SA s64,s64,s20
s_mul_i32 s72, s64, 3584
v_mov_b32 v32, 536870912
v_cmp_gt_u32 vcc, 56, v0
s_lshl_b32 s67, s64, 2
s_nop 0
v_cndmask_b32 v32, v32, v7, vcc
buffer_load_dwordx4 a[176:179], v32, s[56:59], s72 offen offset:0
buffer_load_dwordx4 a[180:183], v32, s[56:59], s72 offen offset:896
buffer_load_dwordx4 a[184:187], v32, s[56:59], s72 offen offset:1792
buffer_load_dwordx4 a[188:191], v32, s[56:59], s72 offen offset:2688
buffer_load_dwordx4 a[192:195], v32, s[60:63], 0 offen
buffer_load_dwordx4 a[196:199], v32, s[68:71], 0 offen
SA m0,s24,16384
s_nop 0
buffer_load_dwordx4 v12, s[48:51], s22 offen offset:0   lds
buffer_load_dwordx4 v13, s[48:51], s22 offen offset:1024   lds
buffer_load_dwordx4 v14, s[48:51], s22 offen offset:2048   lds
buffer_load_dwordx4 v15, s[48:51], s22 offen offset:3072   lds
s_sub_u32 s22, s22, 1048448
SA m0,s23,32768
s_nop 0
buffer_load_dwordx4 v8, s[16:19], s21 offen offset:0  nt lds
buffer_load_dwordx4 v9, s[16:19], s21 offen offset:1024  nt lds
buffer_load_dwordx4 v10, s[16:19], s21 offen offset:2048  nt lds
buffer_load_dwordx4 v11, s[16:19], s21 offen offset:3072  nt lds
SA s21,s21,128
s_mov_b64 exec, 0
s_cmp_eq_u32 s20, 0
s_cbranch_scc1 L_w_kv11
s_cmp_eq_u32 s20, 1
s_cbranch_scc1 L_w_kv12
s_cmp_eq_u32 s20, 2
s_cbranch_scc1 L_w_kv13
s_branch L_w_kv14
L_wd2:
s_mov_b64 exec, -1
s_waitcnt vmcnt(14) lgkmcnt(0)
s_barrier
R a[160:163],v5,0
R a[164:167],v6,0
T a[96:97],v1,0
T a[98:99],v1,1024
T a[100:101],v1,8192
T a[102:103],v1,9216
T a[104:105],v2,0
T a[106:107],v2,1024
T a[108:109],v2,8192
T a[110:111],v2,9216
T a[112:113],v3,0
T a[114:115],v3,1024
T a[116:117],v3,8192
T a[118:119],v3,9216
T a[120:121],v4,0
T a[122:123],v4,1024
T a[124:125],v4,8192
T a[126:127],v4,9216
T a[128:129],v1,16384
T a[130:131],v1,17408
T a[132:133],v1,24576
T a[134:135],v1,25600
T a[136:137],v2,16384
T a[138:139],v2,17408
T a[140:141],v2,24576
T a[142:143],v2,25600
T a[144:145],v3,16384
T a[146:147],v3,17408
T a[148:149],v3,24576
T a[150:151],v3,25600
T a[152:153],v4,16384
T a[154:155],v4,17408
T a[156:157],v4,24576
T a[158:159],v4,25600
s_waitcnt lgkmcnt(15)
M a[0:3],a[160:163],a[96:99],0
SA m0,s23,49152
R a[168:171],v5,2048
R a[172:175],v6,2048
M a[0:3],a[164:167],a[100:103],a[0:3]
buffer_load_dwordx4 v8, s[16:19], s21 offen offset:0  nt lds
M a[4:7],a[164:167],a[108:111],0
M a[4:7],a[160:163],a[104:107],a[4:7]
M a[8:11],a[160:163],a[112:115],0
buffer_load_dwordx4 v9, s[16:19], s21 offen offset:1024  nt lds
M a[8:11],a[164:167],a[116:119],a[8:11]
s_waitcnt lgkmcnt(14)
M a[12:15],a[164:167],a[124:127],0
M a[12:15],a[160:163],a[120:123],a[12:15]
M a[16:19],a[160:163],a[128:131],0
buffer_load_dwordx4 v10, s[16:19], s21 offen offset:2048  nt lds
M a[16:19],a[164:167],a[132:135],a[16:19]
s_waitcnt lgkmcnt(6)
M a[20:23],a[164:167],a[140:143],0
M a[20:23],a[160:163],a[136:139],a[20:23]
buffer_load_dwordx4 v11, s[16:19], s21 offen offset:3072  nt lds
M a[24:27],a[160:163],a[144:147],0
SA s21,s21,524160
M a[24:27],a[164:167],a[148:151],a[24:27]
s_waitcnt lgkmcnt(0)
M a[28:31],a[164:167],a[156:159],0
SA m0,s24,32768
M a[28:31],a[160:163],a[152:155],a[28:31]
buffer_load_dwordx4 v12, s[48:51], s22 offen offset:0   lds
M v[32:35],a[168:171],a[96:99],0
R a[160:163],v5,4096
R a[164:167],v6,4096
M v[32:35],a[172:175],a[100:103],v[32:35]
M v[36:39],a[172:175],a[108:111],0
M v[36:39],a[168:171],a[104:107],v[36:39]
buffer_load_dwordx4 v13, s[48:51], s22 offen offset:1024   lds
M v[40:43],a[168:171],a[112:115],0
M v[40:43],a[172:175],a[116:119],v[40:43]
M v[44:47],a[172:175],a[124:127],0
buffer_load_dwordx4 v14, s[48:51], s22 offen offset:2048   lds
M v[44:47],a[168:171],a[120:123],v[44:47]
M v[48:51],a[168:171],a[128:131],0
M v[48:51],a[172:175],a[132:135],v[48:51]
M v[52:55],a[172:175],a[140:143],0
buffer_load_dwordx4 v15, s[48:51], s22 offen offset:3072   lds
M v[52:55],a[168:171],a[136:139],v[52:55]
SA s22,s22,1048576
M v[56:59],a[168:171],a[144:147],0
M v[56:59],a[172:175],a[148:151],v[56:59]
s_waitcnt lgkmcnt(0)
M v[60:63],a[172:175],a[156:159],0
M v[60:63],a[168:171],a[152:155],v[60:63]
M v[64:67],a[160:163],a[96:99],0
R a[168:171],v5,6144
R a[172:175],v6,6144
M v[64:67],a[164:167],a[100:103],v[64:67]
M v[68:71],a[164:167],a[108:111],0
M v[68:71],a[160:163],a[104:107],v[68:71]
M v[72:75],a[160:163],a[112:115],0
M v[72:75],a[164:167],a[116:119],v[72:75]
M v[76:79],a[164:167],a[124:127],0
M v[76:79],a[160:163],a[120:123],v[76:79]
M v[80:83],a[160:163],a[128:131],0
M v[80:83],a[164:167],a[132:135],v[80:83]
M v[84:87],a[164:167],a[140:143],0
M v[84:87],a[160:163],a[136:139],v[84:87]
M v[88:91],a[160:163],a[144:147],0
M v[88:91],a[164:167],a[148:151],v[88:91]
s_waitcnt lgkmcnt(0)
M v[92:95],a[164:167],a[156:159],0
s_waitcnt vmcnt(12)
M v[92:95],a[160:163],a[152:155],v[92:95]
s_barrier
M v[96:99],a[168:171],a[96:99],0
SA m0,s23,0
R a[160:163],v5,16384
R a[164:167],v6,16384
M v[96:99],a[172:175],a[100:103],v[96:99]
buffer_load_dwordx4 v8, s[16:19], s21 offen offset:0  nt lds
M v[100:103],a[172:175],a[108:111],0
v_lshlrev_b32 v26, 7, v0
v_and_b32 v27, 48, v0
M v[100:103],a[168:171],a[104:107],v[100:103]
v_lshl_add_u32 v26, v27, 24, v26
M v[104:107],a[168:171],a[112:115],0
buffer_load_dwordx4 v9, s[16:19], s21 offen offset:1024  nt lds
M v[104:107],a[172:175],a[116:119],v[104:107]
M v[108:111],a[172:175],a[124:127],0
M v[108:111],a[168:171],a[120:123],v[108:111]
buffer_load_dwordx4 v10, s[16:19], s21 offen offset:2048  nt lds
M v[112:115],a[168:171],a[128:131],0
M v[112:115],a[172:175],a[132:135],v[112:115]
M v[116:119],a[172:175],a[140:143],0
M v[116:119],a[168:171],a[136:139],v[116:119]
buffer_load_dwordx4 v11, s[16:19], s21 offen offset:3072  nt lds
M v[120:123],a[168:171],a[144:147],0
SA s21,s21,128
M v[120:123],a[172:175],a[148:151],v[120:123]
s_waitcnt lgkmcnt(0)
M v[124:127],a[172:175],a[156:159],0
SA m0,s24,49152
M v[124:127],a[168:171],a[152:155],v[124:127]
buffer_load_dwordx4 v12, s[48:51], s22 offen offset:0   lds
M v[128:131],a[160:163],a[96:99],0
R a[168:171],v5,18432
R a[172:175],v6,18432
M v[128:131],a[164:167],a[100:103],v[128:131]
buffer_load_dwordx4 v13, s[48:51], s22 offen offset:1024   lds
M v[132:135],a[164:167],a[108:111],0
M v[132:135],a[160:163],a[104:107],v[132:135]
M v[136:139],a[160:163],a[112:115],0
M v[136:139],a[164:167],a[116:119],v[136:139]
buffer_load_dwordx4 v14, s[48:51], s22 offen offset:2048   lds
M v[140:143],a[164:167],a[124:127],0
M v[140:143],a[160:163],a[120:123],v[140:143]
M v[144:147],a[160:163],a[128:131],0
buffer_load_dwordx4 v15, s[48:51], s22 offen offset:3072   lds
M v[144:147],a[164:167],a[132:135],v[144:147]
s_sub_u32 s22, s22, 1048448
M v[148:151],a[164:167],a[140:143],0
M v[148:151],a[160:163],a[136:139],v[148:151]
M v[152:155],a[160:163],a[144:147],0
M v[152:155],a[164:167],a[148:151],v[152:155]
s_waitcnt lgkmcnt(0)
M v[156:159],a[164:167],a[156:159],0
s_waitcnt vmcnt(12)
M v[156:159],a[160:163],a[152:155],v[156:159]
s_barrier
M v[160:163],a[168:171],a[96:99],0
SA m0,s23,16384
R a[160:163],v5,20480
R a[164:167],v6,20480
M v[160:163],a[172:175],a[100:103],v[160:163]
T a[32:33],v1,32768
T a[34:35],v1,33792
M v[164:167],a[172:175],a[108:111],0
T a[36:37],v1,40960
T a[38:39],v1,41984
M v[164:167],a[168:171],a[104:107],v[164:167]
T a[40:41],v2,32768
T a[42:43],v2,33792
M v[168:171],a[168:171],a[112:115],0
T a[44:45],v2,40960
T a[46:47],v2,41984
M v[168:171],a[172:175],a[116:119],v[168:171]
buffer_load_dwordx4 v8, s[16:19], s21 offen offset:0  nt lds
M v[172:175],a[172:175],a[124:127],0
s_nop 0
T a[48:49],v3,32768
T a[50:51],v3,33792
M v[172:175],a[168:171],a[120:123],v[172:175]
buffer_load_dwordx4 v9, s[16:19], s21 offen offset:1024  nt lds
M v[176:179],a[168:171],a[128:131],0
s_nop 0
T a[52:53],v3,40960
T a[54:55],v3,41984
M v[176:179],a[172:175],a[132:135],v[176:179]
T a[56:57],v4,32768
T a[58:59],v4,33792
M v[180:183],a[172:175],a[140:143],0
buffer_load_dwordx4 v10, s[16:19], s21 offen offset:2048  nt lds
M v[180:183],a[168:171],a[136:139],v[180:183]
s_nop 0
T a[60:61],v4,40960
T a[62:63],v4,41984
M v[184:187],a[168:171],a[144:147],0
buffer_load_dwordx4 v11, s[16:19], s21 offen offset:3072  nt lds
M v[184:187],a[172:175],a[148:151],v[184:187]
s_waitcnt lgkmcnt(15)
s_nop 0
T a[64:65],v1,49152
T a[66:67],v1,50176
M v[188:191],a[172:175],a[156:159],0
SA s21,s21,524160
T a[68:69],v1,57344
T a[70:71],v1,58368
M v[188:191],a[168:171],a[152:155],v[188:191]
SA m0,s24,0
M v[192:195],a[160:163],a[96:99],0
R a[168:171],v5,22528
R a[172:175],v6,22528
M v[192:195],a[164:167],a[100:103],v[192:195]
T a[72:73],v2,49152
T a[74:75],v2,50176
M v[196:199],a[164:167],a[108:111],0
T a[76:77],v2,57344
T a[78:79],v2,58368
M v[196:199],a[160:163],a[104:107],v[196:199]
T a[80:81],v3,49152
T a[82:83],v3,50176
M v[200:203],a[160:163],a[112:115],0
buffer_load_dwordx4 v12, s[48:51], s22 offen offset:0   lds
M v[200:203],a[164:167],a[116:119],v[200:203]
s_nop 0
T a[84:85],v3,57344
T a[86:87],v3,58368
M v[204:207],a[164:167],a[124:127],0
T a[88:89],v4,49152
T a[90:91],v4,50176
M v[204:207],a[160:163],a[120:123],v[204:207]
buffer_load_dwordx4 v13, s[48:51], s22 offen offset:1024   lds
M v[208:211],a[160:163],a[128:131],0
s_nop 0
T a[92:93],v4,57344
T a[94:95],v4,58368
M v[208:211],a[164:167],a[132:135],v[208:211]
buffer_load_dwordx4 v14, s[48:51], s22 offen offset:2048   lds
M v[212:215],a[164:167],a[140:143],0
buffer_load_dwordx4 v15, s[48:51], s22 offen offset:3072   lds
M v[212:215],a[160:163],a[136:139],v[212:215]
SA s22,s22,1048576
M v[216:219],a[160:163],a[144:147],0
M v[216:219],a[164:167],a[148:151],v[216:219]
s_waitcnt lgkmcnt(12)
M v[220:223],a[164:167],a[156:159],0
s_waitcnt vmcnt(12) lgkmcnt(0)
M v[220:223],a[160:163],a[152:155],v[220:223]
s_barrier
M v[224:227],a[168:171],a[96:99],0
SA m0,s23,32768
R a[160:163],v5,32768
R a[164:167],v6,32768
M v[224:227],a[172:175],a[100:103],v[224:227]
buffer_load_dwordx4 v8, s[16:19], s21 offen offset:0  nt lds
M v[228:231],a[172:175],a[108:111],0
M v[228:231],a[168:171],a[104:107],v[228:231]
M v[232:235],a[168:171],a[112:115],0
buffer_load_dwordx4 v9, s[16:19], s21 offen offset:1024  nt lds
M v[232:235],a[172:175],a[116:119],v[232:235]
M v[236:239],a[172:175],a[124:127],0
M v[236:239],a[168:171],a[120:123],v[236:239]
buffer_load_dwordx4 v10, s[16:19], s21 offen offset:2048  nt lds
M v[240:243],a[168:171],a[128:131],0
M v[240:243],a[172:175],a[132:135],v[240:243]
M v[244:247],a[172:175],a[140:143],0
buffer_load_dwordx4 v11, s[16:19], s21 offen offset:3072  nt lds
M v[244:247],a[168:171],a[136:139],v[244:247]
SA s21,s21,128
M v[248:251],a[168:171],a[144:147],0
M v[248:251],a[172:175],a[148:151],v[248:251]
s_waitcnt lgkmcnt(0)
M v[252:255],a[172:175],a[156:159],0
M v[252:255],a[168:171],a[152:155],v[252:255]
M a[0:3],a[160:163],a[32:35],a[0:3]
R a[168:171],v5,34816
R a[172:175],v6,34816
M a[0:3],a[164:167],a[36:39],a[0:3]
T a[96:97],v1,0
T a[98:99],v1,1024
M a[4:7],a[164:167],a[44:47],a[4:7]
SA m0,s24,16384
v_mov_b32 v16, 0
v_mov_b32 v17, 0
M a[4:7],a[160:163],a[40:43],a[4:7]
buffer_load_dwordx4 v12, s[48:51], s22 offen offset:0   lds
M a[8:11],a[160:163],a[48:51],a[8:11]
v_mov_b32 v18, 0
v_mov_b32 v19, 0
M a[8:11],a[164:167],a[52:55],a[8:11]
v_mov_b32 v20, 0
v_mov_b32 v21, 0
M a[12:15],a[164:167],a[60:63],a[12:15]
T a[100:101],v1,8192
T a[102:103],v1,9216
M a[12:15],a[160:163],a[56:59],a[12:15]
v_mov_b32 v22, 0
v_mov_b32 v23, 0
M a[16:19],a[160:163],a[64:67],a[16:19]
buffer_load_dwordx4 v13, s[48:51], s22 offen offset:1024   lds
M a[16:19],a[164:167],a[68:71],a[16:19]
G v28,a192
G v29,a196
M a[20:23],a[164:167],a[76:79],a[20:23]
v_lshlrev_b32 v24, 16, v28
v_lshlrev_b32 v25, 16, v29
M a[20:23],a[160:163],a[72:75],a[20:23]
T a[104:105],v2,0
T a[106:107],v2,1024
M a[24:27],a[160:163],a[80:83],a[24:27]
v_and_b32 v28, 0xffff0000, v28
v_and_b32 v29, 0xffff0000, v29
M a[24:27],a[164:167],a[84:87],a[24:27]
s_waitcnt lgkmcnt(6)
buffer_load_dwordx4 v14, s[48:51], s22 offen offset:2048   lds
M a[28:31],a[164:167],a[92:95],a[28:31]
G v30,a176
v_lshlrev_b32 v31, 16, v30
M a[28:31],a[160:163],a[88:91],a[28:31]
v_and_b32 v30, 0xffff0000, v30
v_fmac_f32 v16, v31, v24
M v[60:63],a[168:171],a[88:91],v[60:63]
R a[160:163],v5,36864
R a[164:167],v6,36864
M v[60:63],a[172:175],a[92:95],v[60:63]
T a[108:109],v2,8192
T a[110:111],v2,9216
M v[56:59],a[172:175],a[84:87],v[56:59]
buffer_load_dwordx4 v15, s[48:51], s22 offen offset:3072   lds
M v[56:59],a[168:171],a[80:83],v[56:59]
s_sub_u32 s22, s22, 1048448
v_fmac_f32 v20, v31, v25
v_fmac_f32 v16, v30, v28
M v[52:55],a[168:171],a[72:75],v[52:55]
v_fmac_f32 v20, v30, v29
G v30,a180
M v[52:55],a[172:175],a[76:79],v[52:55]
T a[112:113],v3,0
T a[114:115],v3,1024
M v[48:51],a[172:175],a[68:71],v[48:51]
SA m0,s23,49152
v_lshlrev_b32 v31, 16, v30
v_and_b32 v30, 0xffff0000, v30
M v[48:51],a[168:171],a[64:67],v[48:51]
buffer_load_dwordx4 v8, s[16:19], s21 offen offset:0  nt lds
M v[44:47],a[168:171],a[56:59],v[44:47]
v_fmac_f32 v17, v31, v24
v_fmac_f32 v21, v31, v25
M v[44:47],a[172:175],a[60:63],v[44:47]
v_fmac_f32 v17, v30, v28
v_fmac_f32 v21, v30, v29
M v[40:43],a[172:175],a[52:55],v[40:43]
T a[116:117],v3,8192
T a[118:119],v3,9216
M v[40:43],a[168:171],a[48:51],v[40:43]
G v30,a184
v_lshlrev_b32 v31, 16, v30
M v[36:39],a[168:171],a[40:43],v[36:39]
buffer_load_dwordx4 v9, s[16:19], s21 offen offset:1024  nt lds
M v[36:39],a[172:175],a[44:47],v[36:39]
s_waitcnt lgkmcnt(6)
v_and_b32 v30, 0xffff0000, v30
v_fmac_f32 v18, v31, v24
M v[32:35],a[172:175],a[36:39],v[32:35]
v_fmac_f32 v22, v31, v25
v_fmac_f32 v18, v30, v28
M v[32:35],a[168:171],a[32:35],v[32:35]
T a[120:121],v4,0
T a[122:123],v4,1024
M v[64:67],a[160:163],a[32:35],v[64:67]
R a[168:171],v5,38912
R a[172:175],v6,38912
M v[64:67],a[164:167],a[36:39],v[64:67]
buffer_load_dwordx4 v10, s[16:19], s21 offen offset:2048  nt lds
M v[68:71],a[164:167],a[44:47],v[68:71]
v_fmac_f32 v22, v30, v29
G v30,a188
M v[68:71],a[160:163],a[40:43],v[68:71]
v_lshlrev_b32 v31, 16, v30
v_and_b32 v30, 0xffff0000, v30
M v[72:75],a[160:163],a[48:51],v[72:75]
T a[124:125],v4,8192
T a[126:127],v4,9216
M v[72:75],a[164:167],a[52:55],v[72:75]
v_fmac_f32 v19, v31, v24
v_fmac_f32 v23, v31, v25
M v[76:79],a[164:167],a[60:63],v[76:79]
buffer_load_dwordx4 v11, s[16:19], s21 offen offset:3072  nt lds
M v[76:79],a[160:163],a[56:59],v[76:79]
SA s21,s21,524160
v_fmac_f32 v19, v30, v28
v_fmac_f32 v23, v30, v29
M v[80:83],a[160:163],a[64:67],v[80:83]
G v28,a193
G v29,a197
M v[80:83],a[164:167],a[68:71],v[80:83]
v_lshlrev_b32 v24, 16, v28
v_lshlrev_b32 v25, 16, v29
M v[84:87],a[164:167],a[76:79],v[84:87]
v_and_b32 v28, 0xffff0000, v28
v_and_b32 v29, 0xffff0000, v29
M v[84:87],a[160:163],a[72:75],v[84:87]
G v30,a177
v_lshlrev_b32 v31, 16, v30
M v[88:91],a[160:163],a[80:83],v[88:91]
v_and_b32 v30, 0xffff0000, v30
v_fmac_f32 v16, v31, v24
M v[88:91],a[164:167],a[84:87],v[88:91]
s_waitcnt lgkmcnt(2)
v_fmac_f32 v20, v31, v25
v_fmac_f32 v16, v30, v28
M v[92:95],a[164:167],a[92:95],v[92:95]
s_waitcnt vmcnt(16) lgkmcnt(0)
v_fmac_f32 v20, v30, v29
G v30,a181
M v[92:95],a[160:163],a[88:91],v[92:95]
s_barrier
M v[124:127],a[168:171],a[88:91],v[124:127]
R a[160:163],v5,49152
R a[164:167],v6,49152
M v[124:127],a[172:175],a[92:95],v[124:127]
v_lshlrev_b32 v31, 16, v30
v_and_b32 v30, 0xffff0000, v30
M v[120:123],a[172:175],a[84:87],v[120:123]
SA m0,s24,32768
T a[128:129],v1,16384
T a[130:131],v1,17408
M v[120:123],a[168:171],a[80:83],v[120:123]
buffer_load_dwordx4 v12, s[48:51], s22 offen offset:0   lds
M v[116:119],a[168:171],a[72:75],v[116:119]
v_fmac_f32 v17, v31, v24
v_fmac_f32 v21, v31, v25
M v[116:119],a[172:175],a[76:79],v[116:119]
v_fmac_f32 v17, v30, v28
v_fmac_f32 v21, v30, v29
M v[112:115],a[172:175],a[68:71],v[112:115]
G v30,a185
v_lshlrev_b32 v31, 16, v30
M v[112:115],a[168:171],a[64:67],v[112:115]
v_and_b32 v30, 0xffff0000, v30
v_fmac_f32 v18, v31, v24
M v[108:111],a[168:171],a[56:59],v[108:111]
v_fmac_f32 v22, v31, v25
v_fmac_f32 v18, v30, v28
M v[108:111],a[172:175],a[60:63],v[108:111]
T a[132:133],v1,24576
T a[134:135],v1,25600
M v[104:107],a[172:175],a[52:55],v[104:107]
buffer_load_dwordx4 v13, s[48:51], s22 offen offset:1024   lds
M v[104:107],a[168:171],a[48:51],v[104:107]
v_fmac_f32 v22, v30, v29
G v30,a189
M v[100:103],a[168:171],a[40:43],v[100:103]
v_lshlrev_b32 v31, 16, v30
v_and_b32 v30, 0xffff0000, v30
M v[100:103],a[172:175],a[44:47],v[100:103]
s_waitcnt lgkmcnt(4)
v_fmac_f32 v19, v31, v24
v_fmac_f32 v23, v31, v25
M v[96:99],a[172:175],a[36:39],v[96:99]
v_fmac_f32 v19, v30, v28
v_fmac_f32 v23, v30, v29
M v[96:99],a[168:171],a[32:35],v[96:99]
G v28,a194
G v29,a198
M v[128:131],a[160:163],a[32:35],v[128:131]
R a[168:171],v5,51200
R a[172:175],v6,51200
M v[128:131],a[164:167],a[36:39],v[128:131]
T a[136:137],v2,16384
T a[138:139],v2,17408
M v[132:135],a[164:167],a[44:47],v[132:135]
buffer_load_dwordx4 v14, s[48:51], s22 offen offset:2048   lds
M v[132:135],a[160:163],a[40:43],v[132:135]
v_lshlrev_b32 v24, 16, v28
v_lshlrev_b32 v25, 16, v29
M v[136:139],a[160:163],a[48:51],v[136:139]
v_and_b32 v28, 0xffff0000, v28
v_and_b32 v29, 0xffff0000, v29
M v[136:139],a[164:167],a[52:55],v[136:139]
G v30,a178
v_lshlrev_b32 v31, 16, v30
M v[140:143],a[164:167],a[60:63],v[140:143]
v_and_b32 v30, 0xffff0000, v30
v_fmac_f32 v16, v31, v24
M v[140:143],a[160:163],a[56:59],v[140:143]
T a[140:141],v2,24576
T a[142:143],v2,25600
M v[144:147],a[160:163],a[64:67],v[144:147]
buffer_load_dwordx4 v15, s[48:51], s22 offen offset:3072   lds
M v[144:147],a[164:167],a[68:71],v[144:147]
SA s22,s22,1048576
v_fmac_f32 v20, v31, v25
v_fmac_f32 v16, v30, v28
M v[148:151],a[164:167],a[76:79],v[148:151]
v_fmac_f32 v20, v30, v29
G v30,a182
M v[148:151],a[160:163],a[72:75],v[148:151]
v_lshlrev_b32 v31, 16, v30
v_and_b32 v30, 0xffff0000, v30
M v[152:155],a[160:163],a[80:83],v[152:155]
v_fmac_f32 v17, v31, v24
v_fmac_f32 v21, v31, v25
M v[152:155],a[164:167],a[84:87],v[152:155]
s_waitcnt lgkmcnt(4)
v_fmac_f32 v17, v30, v28
v_fmac_f32 v21, v30, v29
M v[156:159],a[164:167],a[92:95],v[156:159]
SA m0,s23,0
T a[144:145],v3,16384
T a[146:147],v3,17408
M v[156:159],a[160:163],a[88:91],v[156:159]
buffer_load_dwordx4 v8, s[16:19], s21 offen offset:0  nt lds
M v[188:191],a[168:171],a[88:91],v[188:191]
R a[160:163],v5,53248
R a[164:167],v6,53248
M v[188:191],a[172:175],a[92:95],v[188:191]
G v30,a186
v_lshlrev_b32 v31, 16, v30
M v[184:187],a[172:175],a[84:87],v[184:187]
v_and_b32 v30, 0xffff0000, v30
v_fmac_f32 v18, v31, v24
M v[184:187],a[168:171],a[80:83],v[184:187]
v_fmac_f32 v22, v31, v25
v_fmac_f32 v18, v30, v28
M v[180:183],a[168:171],a[72:75],v[180:183]
v_fmac_f32 v22, v30, v29
G v30,a190
M v[180:183],a[172:175],a[76:79],v[180:183]
L_w_kv11:
s_cbranch_execz L_w_kv15
T a[148:149],v3,24576
T a[150:151],v3,25600
M v[176:179],a[172:175],a[68:71],v[176:179]
buffer_load_dwordx4 v9, s[16:19], s21 offen offset:1024  nt lds
M v[176:179],a[168:171],a[64:67],v[176:179]
v_lshlrev_b32 v31, 16, v30
v_and_b32 v30, 0xffff0000, v30
M v[172:175],a[168:171],a[56:59],v[172:175]
v_fmac_f32 v19, v31, v24
v_fmac_f32 v23, v31, v25
M v[172:175],a[172:175],a[60:63],v[172:175]
v_fmac_f32 v19, v30, v28
v_fmac_f32 v23, v30, v29
M v[168:171],a[172:175],a[52:55],v[168:171]
M v[168:171],a[168:171],a[48:51],v[168:171]
M v[164:167],a[168:171],a[40:43],v[164:167]
s_nop 0
T a[152:153],v4,16384
T a[154:155],v4,17408
M v[164:167],a[172:175],a[44:47],v[164:167]
s_waitcnt lgkmcnt(4)
buffer_load_dwordx4 v10, s[16:19], s21 offen offset:2048  nt lds
M v[160:163],a[172:175],a[36:39],v[160:163]
M v[160:163],a[168:171],a[32:35],v[160:163]
M v[192:195],a[160:163],a[32:35],v[192:195]
R a[168:171],v5,55296
R a[172:175],v6,55296
M v[192:195],a[164:167],a[36:39],v[192:195]
M v[196:199],a[164:167],a[44:47],v[196:199]
M v[196:199],a[160:163],a[40:43],v[196:199]
s_nop 0
T a[156:157],v4,24576
T a[158:159],v4,25600
M v[200:203],a[160:163],a[48:51],v[200:203]
buffer_load_dwordx4 v11, s[16:19], s21 offen offset:3072  nt lds
M v[200:203],a[164:167],a[52:55],v[200:203]
SA s21,s21,128
M v[204:207],a[164:167],a[60:63],v[204:207]
M v[204:207],a[160:163],a[56:59],v[204:207]
M v[208:211],a[160:163],a[64:67],v[208:211]
M v[208:211],a[164:167],a[68:71],v[208:211]
M v[212:215],a[164:167],a[76:79],v[212:215]
M v[212:215],a[160:163],a[72:75],v[212:215]
M v[216:219],a[160:163],a[80:83],v[216:219]
M v[216:219],a[164:167],a[84:87],v[216:219]
s_waitcnt lgkmcnt(2)
M v[220:223],a[164:167],a[92:95],v[220:223]
s_waitcnt vmcnt(16) lgkmcnt(0)
M v[220:223],a[160:163],a[88:91],v[220:223]
s_barrier
M v[252:255],a[168:171],a[88:91],v[252:255]
R a[160:163],v5,0
R a[164:167],v6,0
M v[252:255],a[172:175],a[92:95],v[252:255]
M v[248:251],a[172:175],a[84:87],v[248:251]
M v[248:251],a[168:171],a[80:83],v[248:251]
M v[244:247],a[168:171],a[72:75],v[244:247]
M v[244:247],a[172:175],a[76:79],v[244:247]
M v[240:243],a[172:175],a[68:71],v[240:243]
M v[240:243],a[168:171],a[64:67],v[240:243]
M v[236:239],a[168:171],a[56:59],v[236:239]
M v[236:239],a[172:175],a[60:63],v[236:239]
M v[232:235],a[172:175],a[52:55],v[232:235]
M v[232:235],a[168:171],a[48:51],v[232:235]
M v[228:231],a[168:171],a[40:43],v[228:231]
M v[228:231],a[172:175],a[44:47],v[228:231]
s_waitcnt lgkmcnt(0)
M v[224:227],a[172:175],a[36:39],v[224:227]
M v[224:227],a[168:171],a[32:35],v[224:227]
M a[0:3],a[160:163],a[96:99],a[0:3]
R a[168:171],v5,2048
R a[172:175],v6,2048
M a[0:3],a[164:167],a[100:103],a[0:3]
T a[32:33],v1,32768
T a[34:35],v1,33792
M a[4:7],a[164:167],a[108:111],a[4:7]
SA m0,s24,49152
G v28,a195
G v29,a199
M a[4:7],a[160:163],a[104:107],a[4:7]
buffer_load_dwordx4 v12, s[48:51], s22 offen offset:0   lds
M a[8:11],a[160:163],a[112:115],a[8:11]
v_lshlrev_b32 v24, 16, v28
v_lshlrev_b32 v25, 16, v29
M a[8:11],a[164:167],a[116:119],a[8:11]
v_and_b32 v28, 0xffff0000, v28
v_and_b32 v29, 0xffff0000, v29
M a[12:15],a[164:167],a[124:127],a[12:15]
T a[36:37],v1,40960
T a[38:39],v1,41984
M a[12:15],a[160:163],a[120:123],a[12:15]
G v30,a179
v_lshlrev_b32 v31, 16, v30
M a[16:19],a[160:163],a[128:131],a[16:19]
buffer_load_dwordx4 v13, s[48:51], s22 offen offset:1024   lds
M a[16:19],a[164:167],a[132:135],a[16:19]
v_and_b32 v30, 0xffff0000, v30
v_fmac_f32 v16, v31, v24
M a[20:23],a[164:167],a[140:143],a[20:23]
v_fmac_f32 v20, v31, v25
v_fmac_f32 v16, v30, v28
M a[20:23],a[160:163],a[136:139],a[20:23]
T a[40:41],v2,32768
T a[42:43],v2,33792
M a[24:27],a[160:163],a[144:147],a[24:27]
v_fmac_f32 v20, v30, v29
G v30,a183
M a[24:27],a[164:167],a[148:151],a[24:27]
s_waitcnt lgkmcnt(6)
buffer_load_dwordx4 v14, s[48:51], s22 offen offset:2048   lds
M a[28:31],a[164:167],a[156:159],a[28:31]
v_lshlrev_b32 v31, 16, v30
v_and_b32 v30, 0xffff0000, v30
M a[28:31],a[160:163],a[152:155],a[28:31]
v_fmac_f32 v17, v31, v24
v_fmac_f32 v21, v31, v25
M v[60:63],a[168:171],a[152:155],v[60:63]
R a[160:163],v5,4096
R a[164:167],v6,4096
M v[60:63],a[172:175],a[156:159],v[60:63]
T a[44:45],v2,40960
T a[46:47],v2,41984
M v[56:59],a[172:175],a[148:151],v[56:59]
buffer_load_dwordx4 v15, s[48:51], s22 offen offset:3072   lds
M v[56:59],a[168:171],a[144:147],v[56:59]
s_sub_u32 s22, s22, 1048448
v_fmac_f32 v17, v30, v28
v_fmac_f32 v21, v30, v29
M v[52:55],a[168:171],a[136:139],v[52:55]
G v30,a187
v_lshlrev_b32 v31, 16, v30
M v[52:55],a[172:175],a[140:143],v[52:55]
T a[48:49],v3,32768
T a[50:51],v3,33792
M v[48:51],a[172:175],a[132:135],v[48:51]
SA m0,s23,16384
v_and_b32 v30, 0xffff0000, v30
v_fmac_f32 v18, v31, v24
M v[48:51],a[168:171],a[128:131],v[48:51]
buffer_load_dwordx4 v8, s[16:19], s21 offen offset:0  nt lds
M v[44:47],a[168:171],a[120:123],v[44:47]
v_fmac_f32 v22, v31, v25
v_fmac_f32 v18, v30, v28
M v[44:47],a[172:175],a[124:127],v[44:47]
v_fmac_f32 v22, v30, v29
G v30,a191
M v[40:43],a[172:175],a[116:119],v[40:43]
T a[52:53],v3,40960
T a[54:55],v3,41984
M v[40:43],a[168:171],a[112:115],v[40:43]
v_lshlrev_b32 v31, 16, v30
v_and_b32 v30, 0xffff0000, v30
M v[36:39],a[168:171],a[104:107],v[36:39]
buffer_load_dwordx4 v9, s[16:19], s21 offen offset:1024  nt lds
M v[36:39],a[172:175],a[108:111],v[36:39]
s_waitcnt lgkmcnt(6)
v_fmac_f32 v19, v31, v24
v_fmac_f32 v23, v31, v25
M v[32:35],a[172:175],a[100:103],v[32:35]
v_fmac_f32 v19, v30, v28
v_fmac_f32 v23, v30, v29
M v[32:35],a[168:171],a[96:99],v[32:35]
T a[56:57],v4,32768
T a[58:59],v4,33792
M v[64:67],a[160:163],a[96:99],v[64:67]
R a[168:171],v5,6144
R a[172:175],v6,6144
M v[64:67],a[164:167],a[100:103],v[64:67]
buffer_load_dwordx4 v10, s[16:19], s21 offen offset:2048  nt lds
M v[68:71],a[164:167],a[108:111],v[68:71]
v_permlane32_swap_b32 v16, v18
M v[68:71],a[160:163],a[104:107],v[68:71]
v_permlane32_swap_b32 v17, v19
M v[72:75],a[160:163],a[112:115],v[72:75]
s_nop 0
T a[60:61],v4,40960
T a[62:63],v4,41984
M v[72:75],a[164:167],a[116:119],v[72:75]
v_permlane32_swap_b32 v20, v22
M v[76:79],a[164:167],a[124:127],v[76:79]
buffer_load_dwordx4 v11, s[16:19], s21 offen offset:3072  nt lds
M v[76:79],a[160:163],a[120:123],v[76:79]
SA s21,s21,524160
v_permlane32_swap_b32 v21, v23
M v[80:83],a[160:163],a[128:131],v[80:83]
AF v16,v16,v18
AF v17,v17,v19
M v[80:83],a[164:167],a[132:135],v[80:83]
AF v20,v20,v22
AF v21,v21,v23
M v[84:87],a[164:167],a[140:143],v[84:87]
v_lshrrev_b32 v28, 4, v0
M v[84:87],a[160:163],a[136:139],v[84:87]
v_permlane16_swap_b32 v16, v17
M v[88:91],a[160:163],a[144:147],v[88:91]
v_permlane16_swap_b32 v20, v21
M v[88:91],a[164:167],a[148:151],v[88:91]
s_waitcnt lgkmcnt(2)
AF v16,v16,v17
AF v20,v20,v21
M v[92:95],a[164:167],a[156:159],v[92:95]
s_waitcnt vmcnt(16) lgkmcnt(0)
v_add_u32 v29, s67, v28
v_add_f32 v16, v16, v16 row_ror:8 row_mask:0xf bank_mask:0xf
M v[92:95],a[160:163],a[152:155],v[92:95]
s_barrier
M v[124:127],a[168:171],a[152:155],v[124:127]
R a[160:163],v5,16384
R a[164:167],v6,16384
M v[124:127],a[172:175],a[156:159],v[124:127]
v_add_f32 v20, v20, v20 row_ror:8 row_mask:0xf bank_mask:0xf
v_add_f32 v16, v16, v16 row_ror:4 row_mask:0xf bank_mask:0xf
M v[120:123],a[172:175],a[148:151],v[120:123]
SA m0,s24,0
T a[64:65],v1,49152
T a[66:67],v1,50176
M v[120:123],a[168:171],a[144:147],v[120:123]
buffer_load_dwordx4 v12, s[48:51], s22 offen offset:0   lds
M v[116:119],a[168:171],a[136:139],v[116:119]
v_add_f32 v20, v20, v20 row_ror:4 row_mask:0xf bank_mask:0xf
v_add_f32 v16, v16, v16 row_ror:2 row_mask:0xf bank_mask:0xf
M v[116:119],a[172:175],a[140:143],v[116:119]
v_add_f32 v20, v20, v20 row_ror:2 row_mask:0xf bank_mask:0xf
v_add_f32 v16, v16, v16 row_ror:1 row_mask:0xf bank_mask:0xf
M v[112:115],a[172:175],a[132:135],v[112:115]
v_add_f32 v20, v20, v20 row_ror:1 row_mask:0xf bank_mask:0xf
v_ashrrev_i32 v30, 31, v16
M v[112:115],a[168:171],a[128:131],v[112:115]
v_or_b32 v30, 0x80000000, v30
v_xor_b32 v30, v30, v16
M v[108:111],a[168:171],a[120:123],v[108:111]
v_and_b32 v30, 0xfffff800, v30
v_sub_u32 v29, 2047, v29
M v[108:111],a[172:175],a[124:127],v[108:111]
T a[68:69],v1,57344
T a[70:71],v1,58368
M v[104:107],a[172:175],a[116:119],v[104:107]
buffer_load_dwordx4 v13, s[48:51], s22 offen offset:1024   lds
M v[104:107],a[168:171],a[112:115],v[104:107]
v_or_b32 v30, v30, v29
v_max_u32 v30, 1, v30
M v[100:103],a[168:171],a[104:107],v[100:103]
MF v21,0xbfb8aa3b,v20
M v[100:103],a[172:175],a[108:111],v[100:103]
s_waitcnt lgkmcnt(4)
E v21,v21
M v[96:99],a[172:175],a[100:103],v[96:99]
AF v21,1.0,v21
M v[96:99],a[168:171],a[96:99],v[96:99]
v_rcp_f32 v20, v21
M v[128:131],a[160:163],a[96:99],v[128:131]
s_lshl_b32 s72, s20, 4
R a[168:171],v5,18432
R a[172:175],v6,18432
M v[128:131],a[164:167],a[100:103],v[128:131]
SA s72,s72,163584
T a[72:73],v2,49152
T a[74:75],v2,50176
M v[132:135],a[164:167],a[108:111],v[132:135]
buffer_load_dwordx4 v14, s[48:51], s22 offen offset:2048   lds
M v[132:135],a[160:163],a[104:107],v[132:135]
v_lshl_add_u32 v28, v28, 2, s72
ds_write_b32 v28, v30
M v[136:139],a[160:163],a[112:115],v[136:139]
ds_write_b32 v28, v16 offset:64
ds_write_b32 v28, v20 offset:128
M v[136:139],a[164:167],a[116:119],v[136:139]
M v[140:143],a[164:167],a[124:127],v[140:143]
M v[140:143],a[160:163],a[120:123],v[140:143]
s_nop 0
T a[76:77],v2,57344
T a[78:79],v2,58368
M v[144:147],a[160:163],a[128:131],v[144:147]
buffer_load_dwordx4 v15, s[48:51], s22 offen offset:3072   lds
M v[144:147],a[164:167],a[132:135],v[144:147]
SA s22,s22,1048576
M v[148:151],a[164:167],a[140:143],v[148:151]
M v[148:151],a[160:163],a[136:139],v[148:151]
M v[152:155],a[160:163],a[144:147],v[152:155]
M v[152:155],a[164:167],a[148:151],v[152:155]
s_waitcnt lgkmcnt(7)
M v[156:159],a[164:167],a[156:159],v[156:159]
SA m0,s23,32768
T a[80:81],v3,49152
T a[82:83],v3,50176
M v[156:159],a[160:163],a[152:155],v[156:159]
buffer_load_dwordx4 v8, s[16:19], s21 offen offset:0  nt lds
M v[188:191],a[168:171],a[152:155],v[188:191]
R a[160:163],v5,20480
R a[164:167],v6,20480
M v[188:191],a[172:175],a[156:159],v[188:191]
M v[184:187],a[172:175],a[148:151],v[184:187]
M v[184:187],a[168:171],a[144:147],v[184:187]
M v[180:183],a[168:171],a[136:139],v[180:183]
M v[180:183],a[172:175],a[140:143],v[180:183]
s_nop 0
T a[84:85],v3,57344
T a[86:87],v3,58368
M v[176:179],a[172:175],a[132:135],v[176:179]
buffer_load_dwordx4 v9, s[16:19], s21 offen offset:1024  nt lds
M v[176:179],a[168:171],a[128:131],v[176:179]
M v[172:175],a[168:171],a[120:123],v[172:175]
M v[172:175],a[172:175],a[124:127],v[172:175]
M v[168:171],a[172:175],a[116:119],v[168:171]
M v[168:171],a[168:171],a[112:115],v[168:171]
M v[164:167],a[168:171],a[104:107],v[164:167]
s_nop 0
T a[88:89],v4,49152
T a[90:91],v4,50176
M v[164:167],a[172:175],a[108:111],v[164:167]
s_waitcnt lgkmcnt(4)
buffer_load_dwordx4 v10, s[16:19], s21 offen offset:2048  nt lds
M v[160:163],a[172:175],a[100:103],v[160:163]
M v[160:163],a[168:171],a[96:99],v[160:163]
M v[192:195],a[160:163],a[96:99],v[192:195]
R a[168:171],v5,22528
R a[172:175],v6,22528
M v[192:195],a[164:167],a[100:103],v[192:195]
M v[196:199],a[164:167],a[108:111],v[196:199]
M v[196:199],a[160:163],a[104:107],v[196:199]
s_nop 0
T a[92:93],v4,57344
T a[94:95],v4,58368
M v[200:203],a[160:163],a[112:115],v[200:203]
buffer_load_dwordx4 v11, s[16:19], s21 offen offset:3072  nt lds
M v[200:203],a[164:167],a[116:119],v[200:203]
SA s21,s21,128
M v[204:207],a[164:167],a[124:127],v[204:207]
M v[204:207],a[160:163],a[120:123],v[204:207]
M v[208:211],a[160:163],a[128:131],v[208:211]
M v[208:211],a[164:167],a[132:135],v[208:211]
M v[212:215],a[164:167],a[140:143],v[212:215]
M v[212:215],a[160:163],a[136:139],v[212:215]
M v[216:219],a[160:163],a[144:147],v[216:219]
M v[216:219],a[164:167],a[148:151],v[216:219]
s_waitcnt lgkmcnt(2)
M v[220:223],a[164:167],a[156:159],v[220:223]
s_waitcnt vmcnt(16) lgkmcnt(0)
M v[220:223],a[160:163],a[152:155],v[220:223]
s_barrier
M v[252:255],a[168:171],a[152:155],v[252:255]
R a[160:163],v5,32768
R a[164:167],v6,32768
M v[252:255],a[172:175],a[156:159],v[252:255]
M v[248:251],a[172:175],a[148:151],v[248:251]
M v[248:251],a[168:171],a[144:147],v[248:251]
M v[244:247],a[168:171],a[136:139],v[244:247]
M v[244:247],a[172:175],a[140:143],v[244:247]
M v[240:243],a[172:175],a[132:135],v[240:243]
M v[240:243],a[168:171],a[128:131],v[240:243]
M v[236:239],a[168:171],a[120:123],v[236:239]
M v[236:239],a[172:175],a[124:127],v[236:239]
M v[232:235],a[172:175],a[116:119],v[232:235]
M v[232:235],a[168:171],a[112:115],v[232:235]
M v[228:231],a[168:171],a[104:107],v[228:231]
M v[228:231],a[172:175],a[108:111],v[228:231]
s_waitcnt lgkmcnt(0)
M v[224:227],a[172:175],a[100:103],v[224:227]
M v[224:227],a[168:171],a[96:99],v[224:227]
M a[0:3],a[160:163],a[32:35],a[0:3]
R a[168:171],v5,34816
R a[172:175],v6,34816
M a[0:3],a[164:167],a[36:39],a[0:3]
T a[96:97],v1,0
T a[98:99],v1,1024
M a[4:7],a[164:167],a[44:47],a[4:7]
SA m0,s24,16384
M a[4:7],a[160:163],a[40:43],a[4:7]
buffer_load_dwordx4 v12, s[48:51], s22 offen offset:0   lds
M a[8:11],a[160:163],a[48:51],a[8:11]
v_and_b32 v20, 31, v0
M a[8:11],a[164:167],a[52:55],a[8:11]
v_lshlrev_b32 v20, 2, v20
M a[12:15],a[164:167],a[60:63],a[12:15]
s_nop 0
T a[100:101],v1,8192
T a[102:103],v1,9216
M a[12:15],a[160:163],a[56:59],a[12:15]
v_add_u32 v21, 163584, v20
M a[16:19],a[160:163],a[64:67],a[16:19]
buffer_load_dwordx4 v13, s[48:51], s22 offen offset:1024   lds
M a[16:19],a[164:167],a[68:71],a[16:19]
ds_read_b32 v19, v21
M a[20:23],a[164:167],a[76:79],a[20:23]
ds_read_b32 v21, v21 offset:64
M a[20:23],a[160:163],a[72:75],a[20:23]
s_min_u32 s64, s20, 1
T a[104:105],v2,0
T a[106:107],v2,1024
M a[24:27],a[160:163],a[80:83],a[24:27]
s_lshl_b32 s64, s64, 29
v_and_b32 v22, 32, v0
M a[24:27],a[164:167],a[84:87],a[24:27]
s_waitcnt lgkmcnt(8)
buffer_load_dwordx4 v14, s[48:51], s22 offen offset:2048   lds
M a[28:31],a[164:167],a[92:95],a[28:31]
v_lshl_or_b32 v20, v22, 24, v20
M a[28:31],a[160:163],a[88:91],a[28:31]
v_or_b32 v20, s64, v20
M v[60:63],a[168:171],a[88:91],v[60:63]
R a[160:163],v5,36864
R a[164:167],v6,36864
M v[60:63],a[172:175],a[92:95],v[60:63]
T a[108:109],v2,8192
T a[110:111],v2,9216
M v[56:59],a[172:175],a[84:87],v[56:59]
buffer_load_dwordx4 v15, s[48:51], s22 offen offset:3072   lds
M v[56:59],a[168:171],a[80:83],v[56:59]
s_sub_u32 s22, s22, 1048448
v_and_b32 v22, 16, v0
M v[52:55],a[168:171],a[72:75],v[52:55]
v_lshl_or_b32 v18, v22, 25, v20
s_and_b32 s27, s42, 7
M v[52:55],a[172:175],a[76:79],v[52:55]
s_lshl_b32 s72, s30, 7
T a[112:113],v3,0
T a[114:115],v3,1024
M v[48:51],a[172:175],a[68:71],v[48:51]
SA m0,s23,49152
SA s72,s72,104857600
s_lshl_b32 s64, s41, 3
M v[48:51],a[168:171],a[64:67],v[48:51]
SA s27,s27,s64
buffer_load_dwordx4 v8, s[16:19], s21 offen offset:0  nt lds
M v[44:47],a[168:171],a[56:59],v[44:47]
s_lshl_b32 s27, s27, 2
M v[44:47],a[172:175],a[60:63],v[44:47]
SA s27,s27,s20
M v[40:43],a[172:175],a[52:55],v[40:43]
s_mul_i32 s27, s27, 7168
T a[116:117],v3,8192
T a[118:119],v3,9216
M v[40:43],a[168:171],a[48:51],v[40:43]
s_mov_b32 s60, s90
M v[36:39],a[168:171],a[40:43],v[36:39]
s_and_b32 s61, s91, 0xffff
buffer_load_dwordx4 v9, s[16:19], s21 offen offset:1024  nt lds
M v[36:39],a[172:175],a[44:47],v[36:39]
s_waitcnt lgkmcnt(6)
buffer_store_dword v21, v20, s[8:11], s72 offen sc1
M v[32:35],a[172:175],a[36:39],v[32:35]
s_mov_b32 s62, 3670016
M v[32:35],a[168:171],a[32:35],v[32:35]
s_mov_b32 s63, 0x20000
T a[120:121],v4,0
T a[122:123],v4,1024
M v[64:67],a[160:163],a[32:35],v[64:67]
R a[168:171],v5,38912
R a[172:175],v6,38912
M v[64:67],a[164:167],a[36:39],v[64:67]
buffer_load_dwordx4 v10, s[16:19], s21 offen offset:2048  nt lds
M v[68:71],a[164:167],a[44:47],v[68:71]
M v[68:71],a[160:163],a[40:43],v[68:71]
M v[72:75],a[160:163],a[48:51],v[72:75]
s_nop 0
T a[124:125],v4,8192
T a[126:127],v4,9216
M v[72:75],a[164:167],a[52:55],v[72:75]
M v[76:79],a[164:167],a[60:63],v[76:79]
buffer_load_dwordx4 v11, s[16:19], s21 offen offset:3072  nt lds
M v[76:79],a[160:163],a[56:59],v[76:79]
SA s21,s21,524160
M v[80:83],a[160:163],a[64:67],v[80:83]
M v[80:83],a[164:167],a[68:71],v[80:83]
M v[84:87],a[164:167],a[76:79],v[84:87]
M v[84:87],a[160:163],a[72:75],v[84:87]
M v[88:91],a[160:163],a[80:83],v[88:91]
M v[88:91],a[164:167],a[84:87],v[88:91]
s_waitcnt lgkmcnt(2)
M v[92:95],a[164:167],a[92:95],v[92:95]
s_waitcnt vmcnt(17) lgkmcnt(0)
M v[92:95],a[160:163],a[88:91],v[92:95]
s_barrier
M v[124:127],a[168:171],a[88:91],v[124:127]
R a[160:163],v5,49152
R a[164:167],v6,49152
M v[124:127],a[172:175],a[92:95],v[124:127]
M v[120:123],a[172:175],a[84:87],v[120:123]
SA m0,s24,32768
T a[128:129],v1,16384
T a[130:131],v1,17408
M v[120:123],a[168:171],a[80:83],v[120:123]
buffer_load_dwordx4 v12, s[48:51], s22 offen offset:0   lds
M v[116:119],a[168:171],a[72:75],v[116:119]
v_min_u32 v16, 40, v0
v_lshlrev_b32 v16, 2, v16
M v[116:119],a[172:175],a[76:79],v[116:119]
buffer_load_dword v17, v16, s[12:15], 0 offen sc1
M v[112:115],a[172:175],a[68:71],v[112:115]
M v[112:115],a[168:171],a[64:67],v[112:115]
M v[108:111],a[168:171],a[56:59],v[108:111]
M v[108:111],a[172:175],a[60:63],v[108:111]
s_nop 0
T a[132:133],v1,24576
T a[134:135],v1,25600
M v[104:107],a[172:175],a[52:55],v[104:107]
buffer_load_dwordx4 v13, s[48:51], s22 offen offset:1024   lds
M v[104:107],a[168:171],a[48:51],v[104:107]
M v[100:103],a[168:171],a[40:43],v[100:103]
M v[100:103],a[172:175],a[44:47],v[100:103]
s_waitcnt lgkmcnt(4)
M v[96:99],a[172:175],a[36:39],v[96:99]
M v[96:99],a[168:171],a[32:35],v[96:99]
M v[128:131],a[160:163],a[32:35],v[128:131]
R a[168:171],v5,51200
R a[172:175],v6,51200
M v[128:131],a[164:167],a[36:39],v[128:131]
T a[136:137],v2,16384
T a[138:139],v2,17408
M v[132:135],a[164:167],a[44:47],v[132:135]
buffer_load_dwordx4 v14, s[48:51], s22 offen offset:2048   lds
M v[132:135],a[160:163],a[40:43],v[132:135]
M v[136:139],a[160:163],a[48:51],v[136:139]
M v[136:139],a[164:167],a[52:55],v[136:139]
M v[140:143],a[164:167],a[60:63],v[140:143]
M v[140:143],a[160:163],a[56:59],v[140:143]
s_nop 0
T a[140:141],v2,24576
T a[142:143],v2,25600
M v[144:147],a[160:163],a[64:67],v[144:147]
buffer_load_dwordx4 v15, s[48:51], s22 offen offset:3072   lds
M v[144:147],a[164:167],a[68:71],v[144:147]
SA s22,s22,1048576
M v[148:151],a[164:167],a[76:79],v[148:151]
M v[148:151],a[160:163],a[72:75],v[148:151]
M v[152:155],a[160:163],a[80:83],v[152:155]
M v[152:155],a[164:167],a[84:87],v[152:155]
s_waitcnt lgkmcnt(4)
M v[156:159],a[164:167],a[92:95],v[156:159]
SA m0,s23,0
T a[144:145],v3,16384
T a[146:147],v3,17408
M v[156:159],a[160:163],a[88:91],v[156:159]
buffer_load_dwordx4 v8, s[16:19], s21 offen offset:0  nt lds
M v[188:191],a[168:171],a[88:91],v[188:191]
R a[160:163],v5,53248
R a[164:167],v6,53248
M v[188:191],a[172:175],a[92:95],v[188:191]
buffer_load_dword a240, v26, s[60:63], s27 offen offset:0
M v[184:187],a[172:175],a[84:87],v[184:187]
SA s27,s27,2048
M v[184:187],a[168:171],a[80:83],v[184:187]
M v[180:183],a[168:171],a[72:75],v[180:183]
M v[180:183],a[172:175],a[76:79],v[180:183]
s_nop 0
T a[148:149],v3,24576
T a[150:151],v3,25600
M v[176:179],a[172:175],a[68:71],v[176:179]
buffer_load_dwordx4 v9, s[16:19], s21 offen offset:1024  nt lds
M v[176:179],a[168:171],a[64:67],v[176:179]
M v[172:175],a[168:171],a[56:59],v[172:175]
M v[172:175],a[172:175],a[60:63],v[172:175]
M v[168:171],a[172:175],a[52:55],v[168:171]
M v[168:171],a[168:171],a[48:51],v[168:171]
M v[164:167],a[168:171],a[40:43],v[164:167]
s_nop 0
T a[152:153],v4,16384
T a[154:155],v4,17408
M v[164:167],a[172:175],a[44:47],v[164:167]
s_waitcnt lgkmcnt(4)
buffer_load_dwordx4 v10, s[16:19], s21 offen offset:2048  nt lds
M v[160:163],a[172:175],a[36:39],v[160:163]
M v[160:163],a[168:171],a[32:35],v[160:163]
M v[192:195],a[160:163],a[32:35],v[192:195]
L_w_kv12:
s_cbranch_execz L_w_kv16
R a[168:171],v5,55296
R a[172:175],v6,55296
M v[192:195],a[164:167],a[36:39],v[192:195]
M v[196:199],a[164:167],a[44:47],v[196:199]
M v[196:199],a[160:163],a[40:43],v[196:199]
s_nop 0
T a[156:157],v4,24576
T a[158:159],v4,25600
M v[200:203],a[160:163],a[48:51],v[200:203]
buffer_load_dwordx4 v11, s[16:19], s21 offen offset:3072  nt lds
M v[200:203],a[164:167],a[52:55],v[200:203]
SA s21,s21,128
M v[204:207],a[164:167],a[60:63],v[204:207]
M v[204:207],a[160:163],a[56:59],v[204:207]
M v[208:211],a[160:163],a[64:67],v[208:211]
M v[208:211],a[164:167],a[68:71],v[208:211]
M v[212:215],a[164:167],a[76:79],v[212:215]
M v[212:215],a[160:163],a[72:75],v[212:215]
M v[216:219],a[160:163],a[80:83],v[216:219]
M v[216:219],a[164:167],a[84:87],v[216:219]
s_waitcnt lgkmcnt(2)
M v[220:223],a[164:167],a[92:95],v[220:223]
s_waitcnt vmcnt(19) lgkmcnt(0)
M v[220:223],a[160:163],a[88:91],v[220:223]
s_barrier
M v[252:255],a[168:171],a[88:91],v[252:255]
R a[160:163],v5,0
R a[164:167],v6,0
M v[252:255],a[172:175],a[92:95],v[252:255]
M v[248:251],a[172:175],a[84:87],v[248:251]
M v[248:251],a[168:171],a[80:83],v[248:251]
M v[244:247],a[168:171],a[72:75],v[244:247]
M v[244:247],a[172:175],a[76:79],v[244:247]
M v[240:243],a[172:175],a[68:71],v[240:243]
M v[240:243],a[168:171],a[64:67],v[240:243]
M v[236:239],a[168:171],a[56:59],v[236:239]
M v[236:239],a[172:175],a[60:63],v[236:239]
M v[232:235],a[172:175],a[52:55],v[232:235]
M v[232:235],a[168:171],a[48:51],v[232:235]
M v[228:231],a[168:171],a[40:43],v[228:231]
M v[228:231],a[172:175],a[44:47],v[228:231]
s_waitcnt lgkmcnt(0)
M v[224:227],a[172:175],a[36:39],v[224:227]
M v[224:227],a[168:171],a[32:35],v[224:227]
M a[0:3],a[160:163],a[96:99],a[0:3]
R a[168:171],v5,2048
R a[172:175],v6,2048
M a[0:3],a[164:167],a[100:103],a[0:3]
T a[32:33],v1,32768
T a[34:35],v1,33792
M a[4:7],a[164:167],a[108:111],a[4:7]
SA m0,s24,49152
M a[4:7],a[160:163],a[104:107],a[4:7]
buffer_load_dwordx4 v12, s[48:51], s22 offen offset:0   lds
M a[8:11],a[160:163],a[112:115],a[8:11]
M a[8:11],a[164:167],a[116:119],a[8:11]
M a[12:15],a[164:167],a[124:127],a[12:15]
s_nop 0
T a[36:37],v1,40960
T a[38:39],v1,41984
M a[12:15],a[160:163],a[120:123],a[12:15]
M a[16:19],a[160:163],a[128:131],a[16:19]
buffer_load_dwordx4 v13, s[48:51], s22 offen offset:1024   lds
M a[16:19],a[164:167],a[132:135],a[16:19]
M a[20:23],a[164:167],a[140:143],a[20:23]
M a[20:23],a[160:163],a[136:139],a[20:23]
s_nop 0
T a[40:41],v2,32768
T a[42:43],v2,33792
M a[24:27],a[160:163],a[144:147],a[24:27]
M a[24:27],a[164:167],a[148:151],a[24:27]
s_waitcnt lgkmcnt(6)
buffer_load_dwordx4 v14, s[48:51], s22 offen offset:2048   lds
M a[28:31],a[164:167],a[156:159],a[28:31]
M a[28:31],a[160:163],a[152:155],a[28:31]
M v[60:63],a[168:171],a[152:155],v[60:63]
R a[160:163],v5,4096
R a[164:167],v6,4096
M v[60:63],a[172:175],a[156:159],v[60:63]
T a[44:45],v2,40960
T a[46:47],v2,41984
M v[56:59],a[172:175],a[148:151],v[56:59]
buffer_load_dwordx4 v15, s[48:51], s22 offen offset:3072   lds
M v[56:59],a[168:171],a[144:147],v[56:59]
s_sub_u32 s22, s22, 1048448
M v[52:55],a[168:171],a[136:139],v[52:55]
M v[52:55],a[172:175],a[140:143],v[52:55]
s_nop 0
T a[48:49],v3,32768
T a[50:51],v3,33792
M v[48:51],a[172:175],a[132:135],v[48:51]
SA m0,s23,16384
M v[48:51],a[168:171],a[128:131],v[48:51]
buffer_load_dwordx4 v8, s[16:19], s21 offen offset:0  nt lds
M v[44:47],a[168:171],a[120:123],v[44:47]
M v[44:47],a[172:175],a[124:127],v[44:47]
M v[40:43],a[172:175],a[116:119],v[40:43]
s_nop 0
T a[52:53],v3,40960
T a[54:55],v3,41984
M v[40:43],a[168:171],a[112:115],v[40:43]
M v[36:39],a[168:171],a[104:107],v[36:39]
buffer_load_dwordx4 v9, s[16:19], s21 offen offset:1024  nt lds
M v[36:39],a[172:175],a[108:111],v[36:39]
s_waitcnt lgkmcnt(6)
M v[32:35],a[172:175],a[100:103],v[32:35]
M v[32:35],a[168:171],a[96:99],v[32:35]
s_nop 0
T a[56:57],v4,32768
T a[58:59],v4,33792
M v[64:67],a[160:163],a[96:99],v[64:67]
R a[168:171],v5,6144
R a[172:175],v6,6144
M v[64:67],a[164:167],a[100:103],v[64:67]
buffer_load_dwordx4 v10, s[16:19], s21 offen offset:2048  nt lds
M v[68:71],a[164:167],a[108:111],v[68:71]
M v[68:71],a[160:163],a[104:107],v[68:71]
M v[72:75],a[160:163],a[112:115],v[72:75]
s_nop 0
T a[60:61],v4,40960
T a[62:63],v4,41984
M v[72:75],a[164:167],a[116:119],v[72:75]
M v[76:79],a[164:167],a[124:127],v[76:79]
buffer_load_dwordx4 v11, s[16:19], s21 offen offset:3072  nt lds
M v[76:79],a[160:163],a[120:123],v[76:79]
SA s21,s21,524160
M v[80:83],a[160:163],a[128:131],v[80:83]
M v[80:83],a[164:167],a[132:135],v[80:83]
M v[84:87],a[164:167],a[140:143],v[84:87]
M v[84:87],a[160:163],a[136:139],v[84:87]
M v[88:91],a[160:163],a[144:147],v[88:91]
M v[88:91],a[164:167],a[148:151],v[88:91]
s_waitcnt lgkmcnt(2)
M v[92:95],a[164:167],a[156:159],v[92:95]
s_waitcnt vmcnt(18) lgkmcnt(0)
M v[92:95],a[160:163],a[152:155],v[92:95]
s_barrier
M v[124:127],a[168:171],a[152:155],v[124:127]
R a[160:163],v5,16384
R a[164:167],v6,16384
M v[124:127],a[172:175],a[156:159],v[124:127]
M v[120:123],a[172:175],a[148:151],v[120:123]
SA m0,s24,0
T a[64:65],v1,49152
T a[66:67],v1,50176
M v[120:123],a[168:171],a[144:147],v[120:123]
buffer_load_dwordx4 v12, s[48:51], s22 offen offset:0   lds
M v[116:119],a[168:171],a[136:139],v[116:119]
M v[116:119],a[172:175],a[140:143],v[116:119]
M v[112:115],a[172:175],a[132:135],v[112:115]
M v[112:115],a[168:171],a[128:131],v[112:115]
M v[108:111],a[168:171],a[120:123],v[108:111]
M v[108:111],a[172:175],a[124:127],v[108:111]
s_nop 0
T a[68:69],v1,57344
T a[70:71],v1,58368
M v[104:107],a[172:175],a[116:119],v[104:107]
buffer_load_dwordx4 v13, s[48:51], s22 offen offset:1024   lds
M v[104:107],a[168:171],a[112:115],v[104:107]
M v[100:103],a[168:171],a[104:107],v[100:103]
M v[100:103],a[172:175],a[108:111],v[100:103]
s_waitcnt lgkmcnt(4)
M v[96:99],a[172:175],a[100:103],v[96:99]
M v[96:99],a[168:171],a[96:99],v[96:99]
M v[128:131],a[160:163],a[96:99],v[128:131]
R a[168:171],v5,18432
R a[172:175],v6,18432
M v[128:131],a[164:167],a[100:103],v[128:131]
T a[72:73],v2,49152
T a[74:75],v2,50176
M v[132:135],a[164:167],a[108:111],v[132:135]
buffer_load_dwordx4 v14, s[48:51], s22 offen offset:2048   lds
M v[132:135],a[160:163],a[104:107],v[132:135]
M v[136:139],a[160:163],a[112:115],v[136:139]
M v[136:139],a[164:167],a[116:119],v[136:139]
M v[140:143],a[164:167],a[124:127],v[140:143]
M v[140:143],a[160:163],a[120:123],v[140:143]
s_nop 0
T a[76:77],v2,57344
T a[78:79],v2,58368
M v[144:147],a[160:163],a[128:131],v[144:147]
buffer_load_dwordx4 v15, s[48:51], s22 offen offset:3072   lds
M v[144:147],a[164:167],a[132:135],v[144:147]
SA s22,s22,1048576
M v[148:151],a[164:167],a[140:143],v[148:151]
M v[148:151],a[160:163],a[136:139],v[148:151]
M v[152:155],a[160:163],a[144:147],v[152:155]
M v[152:155],a[164:167],a[148:151],v[152:155]
s_waitcnt lgkmcnt(4)
M v[156:159],a[164:167],a[156:159],v[156:159]
SA m0,s23,32768
T a[80:81],v3,49152
T a[82:83],v3,50176
M v[156:159],a[160:163],a[152:155],v[156:159]
buffer_load_dwordx4 v8, s[16:19], s21 offen offset:0  nt lds
M v[188:191],a[168:171],a[152:155],v[188:191]
R a[160:163],v5,20480
R a[164:167],v6,20480
M v[188:191],a[172:175],a[156:159],v[188:191]
buffer_load_dword a240, v26, s[60:63], s27 offen offset:0
M v[184:187],a[172:175],a[148:151],v[184:187]
SA s27,s27,2048
M v[184:187],a[168:171],a[144:147],v[184:187]
M v[180:183],a[168:171],a[136:139],v[180:183]
M v[180:183],a[172:175],a[140:143],v[180:183]
s_nop 0
T a[84:85],v3,57344
T a[86:87],v3,58368
M v[176:179],a[172:175],a[132:135],v[176:179]
buffer_load_dwordx4 v9, s[16:19], s21 offen offset:1024  nt lds
M v[176:179],a[168:171],a[128:131],v[176:179]
M v[172:175],a[168:171],a[120:123],v[172:175]
M v[172:175],a[172:175],a[124:127],v[172:175]
M v[168:171],a[172:175],a[116:119],v[168:171]
M v[168:171],a[168:171],a[112:115],v[168:171]
M v[164:167],a[168:171],a[104:107],v[164:167]
s_nop 0
T a[88:89],v4,49152
T a[90:91],v4,50176
M v[164:167],a[172:175],a[108:111],v[164:167]
s_waitcnt lgkmcnt(4)
buffer_load_dwordx4 v10, s[16:19], s21 offen offset:2048  nt lds
M v[160:163],a[172:175],a[100:103],v[160:163]
M v[160:163],a[168:171],a[96:99],v[160:163]
M v[192:195],a[160:163],a[96:99],v[192:195]
R a[168:171],v5,22528
R a[172:175],v6,22528
M v[192:195],a[164:167],a[100:103],v[192:195]
M v[196:199],a[164:167],a[108:111],v[196:199]
M v[196:199],a[160:163],a[104:107],v[196:199]
s_nop 0
T a[92:93],v4,57344
T a[94:95],v4,58368
M v[200:203],a[160:163],a[112:115],v[200:203]
buffer_load_dwordx4 v11, s[16:19], s21 offen offset:3072  nt lds
M v[200:203],a[164:167],a[116:119],v[200:203]
SA s21,s21,128
M v[204:207],a[164:167],a[124:127],v[204:207]
M v[204:207],a[160:163],a[120:123],v[204:207]
M v[208:211],a[160:163],a[128:131],v[208:211]
M v[208:211],a[164:167],a[132:135],v[208:211]
M v[212:215],a[164:167],a[140:143],v[212:215]
M v[212:215],a[160:163],a[136:139],v[212:215]
M v[216:219],a[160:163],a[144:147],v[216:219]
M v[216:219],a[164:167],a[148:151],v[216:219]
s_waitcnt lgkmcnt(2)
M v[220:223],a[164:167],a[156:159],v[220:223]
s_waitcnt vmcnt(17) lgkmcnt(0)
M v[220:223],a[160:163],a[152:155],v[220:223]
s_barrier
M v[252:255],a[168:171],a[152:155],v[252:255]
R a[160:163],v5,32768
R a[164:167],v6,32768
M v[252:255],a[172:175],a[156:159],v[252:255]
v_cmp_ne_u32 vcc, 1, v17
M v[248:251],a[172:175],a[148:151],v[248:251]
s_nop 0
M v[248:251],a[168:171],a[144:147],v[248:251]
s_cbranch_vccnz L_zs1
L_zr1:
M v[244:247],a[168:171],a[136:139],v[244:247]
M v[244:247],a[172:175],a[140:143],v[244:247]
s_lshl_b32 s72, s30, 6
M v[240:243],a[172:175],a[132:135],v[240:243]
SA s72,s72,104914944
M v[240:243],a[168:171],a[128:131],v[240:243]
buffer_store_dword v19, v18, s[8:11], s72 offen sc1
M v[236:239],a[168:171],a[120:123],v[236:239]
M v[236:239],a[172:175],a[124:127],v[236:239]
M v[232:235],a[172:175],a[116:119],v[232:235]
M v[232:235],a[168:171],a[112:115],v[232:235]
M v[228:231],a[168:171],a[104:107],v[228:231]
M v[228:231],a[172:175],a[108:111],v[228:231]
s_waitcnt lgkmcnt(0)
M v[224:227],a[172:175],a[100:103],v[224:227]
M v[224:227],a[168:171],a[96:99],v[224:227]
M a[0:3],a[160:163],a[32:35],a[0:3]
R a[168:171],v5,34816
R a[172:175],v6,34816
M a[0:3],a[164:167],a[36:39],a[0:3]
T a[96:97],v1,0
T a[98:99],v1,1024
M a[4:7],a[164:167],a[44:47],a[4:7]
SA m0,s24,16384
M a[4:7],a[160:163],a[40:43],a[4:7]
buffer_load_dwordx4 v12, s[48:51], s22 offen offset:0   lds
M a[8:11],a[160:163],a[48:51],a[8:11]
M a[8:11],a[164:167],a[52:55],a[8:11]
s_mul_i32 s64, s41, 229376
M a[12:15],a[164:167],a[60:63],a[12:15]
SA s72,s90,s64
T a[100:101],v1,8192
T a[102:103],v1,9216
M a[12:15],a[160:163],a[56:59],a[12:15]
s_addc_u32 s73, s91, 0
M a[16:19],a[160:163],a[64:67],a[16:19]
s_sub_u32 s75, 3670016, s64
buffer_load_dwordx4 v13, s[48:51], s22 offen offset:1024   lds
M a[16:19],a[164:167],a[68:71],a[16:19]
s_mov_b32 s12, s72
M a[20:23],a[164:167],a[76:79],a[20:23]
s_and_b32 s13, s73, 0xffff
M a[20:23],a[160:163],a[72:75],a[20:23]
s_mov_b32 s14, s75
T a[104:105],v2,0
T a[106:107],v2,1024
M a[24:27],a[160:163],a[80:83],a[24:27]
s_mov_b32 s15, 0x20000
M a[24:27],a[164:167],a[84:87],a[24:27]
s_waitcnt lgkmcnt(6)
buffer_load_dwordx4 v14, s[48:51], s22 offen offset:2048   lds
M a[28:31],a[164:167],a[92:95],a[28:31]
M a[28:31],a[160:163],a[88:91],a[28:31]
M v[60:63],a[168:171],a[88:91],v[60:63]
R a[160:163],v5,36864
R a[164:167],v6,36864
M v[60:63],a[172:175],a[92:95],v[60:63]
T a[108:109],v2,8192
T a[110:111],v2,9216
M v[56:59],a[172:175],a[84:87],v[56:59]
buffer_load_dwordx4 v15, s[48:51], s22 offen offset:3072   lds
M v[56:59],a[168:171],a[80:83],v[56:59]
s_sub_u32 s22, s22, 1048448
M v[52:55],a[168:171],a[72:75],v[52:55]
M v[52:55],a[172:175],a[76:79],v[52:55]
s_nop 0
T a[112:113],v3,0
T a[114:115],v3,1024
M v[48:51],a[172:175],a[68:71],v[48:51]
SA m0,s23,49152
M v[48:51],a[168:171],a[64:67],v[48:51]
buffer_load_dwordx4 v8, s[16:19], s21 offen offset:0  nt lds
M v[44:47],a[168:171],a[56:59],v[44:47]
M v[44:47],a[172:175],a[60:63],v[44:47]
M v[40:43],a[172:175],a[52:55],v[40:43]
s_nop 0
T a[116:117],v3,8192
T a[118:119],v3,9216
M v[40:43],a[168:171],a[48:51],v[40:43]
M v[36:39],a[168:171],a[40:43],v[36:39]
buffer_load_dwordx4 v9, s[16:19], s21 offen offset:1024  nt lds
M v[36:39],a[172:175],a[44:47],v[36:39]
s_waitcnt lgkmcnt(6)
M v[32:35],a[172:175],a[36:39],v[32:35]
M v[32:35],a[168:171],a[32:35],v[32:35]
s_nop 0
T a[120:121],v4,0
T a[122:123],v4,1024
M v[64:67],a[160:163],a[32:35],v[64:67]
R a[168:171],v5,38912
R a[172:175],v6,38912
M v[64:67],a[164:167],a[36:39],v[64:67]
buffer_load_dwordx4 v10, s[16:19], s21 offen offset:2048  nt lds
M v[68:71],a[164:167],a[44:47],v[68:71]
M v[68:71],a[160:163],a[40:43],v[68:71]
M v[72:75],a[160:163],a[48:51],v[72:75]
s_nop 0
T a[124:125],v4,8192
T a[126:127],v4,9216
M v[72:75],a[164:167],a[52:55],v[72:75]
M v[76:79],a[164:167],a[60:63],v[76:79]
buffer_load_dwordx4 v11, s[16:19], s21 offen offset:3072  nt lds
M v[76:79],a[160:163],a[56:59],v[76:79]
SA s21,s21,524160
M v[80:83],a[160:163],a[64:67],v[80:83]
M v[80:83],a[164:167],a[68:71],v[80:83]
M v[84:87],a[164:167],a[76:79],v[84:87]
M v[84:87],a[160:163],a[72:75],v[84:87]
M v[88:91],a[160:163],a[80:83],v[88:91]
M v[88:91],a[164:167],a[84:87],v[88:91]
s_waitcnt lgkmcnt(2)
M v[92:95],a[164:167],a[92:95],v[92:95]
s_waitcnt vmcnt(18) lgkmcnt(0)
M v[92:95],a[160:163],a[88:91],v[92:95]
s_barrier
M v[124:127],a[168:171],a[88:91],v[124:127]
R a[160:163],v5,49152
R a[164:167],v6,49152
M v[124:127],a[172:175],a[92:95],v[124:127]
M v[120:123],a[172:175],a[84:87],v[120:123]
SA m0,s24,32768
T a[128:129],v1,16384
T a[130:131],v1,17408
M v[120:123],a[168:171],a[80:83],v[120:123]
buffer_load_dwordx4 v12, s[48:51], s22 offen offset:0   lds
M v[116:119],a[168:171],a[72:75],v[116:119]
M v[116:119],a[172:175],a[76:79],v[116:119]
M v[112:115],a[172:175],a[68:71],v[112:115]
M v[112:115],a[168:171],a[64:67],v[112:115]
M v[108:111],a[168:171],a[56:59],v[108:111]
M v[108:111],a[172:175],a[60:63],v[108:111]
s_nop 0
T a[132:133],v1,24576
T a[134:135],v1,25600
M v[104:107],a[172:175],a[52:55],v[104:107]
buffer_load_dwordx4 v13, s[48:51], s22 offen offset:1024   lds
M v[104:107],a[168:171],a[48:51],v[104:107]
M v[100:103],a[168:171],a[40:43],v[100:103]
M v[100:103],a[172:175],a[44:47],v[100:103]
s_waitcnt lgkmcnt(4)
M v[96:99],a[172:175],a[36:39],v[96:99]
M v[96:99],a[168:171],a[32:35],v[96:99]
M v[128:131],a[160:163],a[32:35],v[128:131]
R a[168:171],v5,51200
R a[172:175],v6,51200
M v[128:131],a[164:167],a[36:39],v[128:131]
T a[136:137],v2,16384
T a[138:139],v2,17408
M v[132:135],a[164:167],a[44:47],v[132:135]
buffer_load_dwordx4 v14, s[48:51], s22 offen offset:2048   lds
M v[132:135],a[160:163],a[40:43],v[132:135]
M v[136:139],a[160:163],a[48:51],v[136:139]
M v[136:139],a[164:167],a[52:55],v[136:139]
M v[140:143],a[164:167],a[60:63],v[140:143]
M v[140:143],a[160:163],a[56:59],v[140:143]
s_nop 0
T a[140:141],v2,24576
T a[142:143],v2,25600
M v[144:147],a[160:163],a[64:67],v[144:147]
buffer_load_dwordx4 v15, s[48:51], s22 offen offset:3072   lds
M v[144:147],a[164:167],a[68:71],v[144:147]
SA s22,s22,1048576
M v[148:151],a[164:167],a[76:79],v[148:151]
M v[148:151],a[160:163],a[72:75],v[148:151]
M v[152:155],a[160:163],a[80:83],v[152:155]
M v[152:155],a[164:167],a[84:87],v[152:155]
s_waitcnt lgkmcnt(4)
M v[156:159],a[164:167],a[92:95],v[156:159]
SA m0,s23,0
T a[144:145],v3,16384
T a[146:147],v3,17408
M v[156:159],a[160:163],a[88:91],v[156:159]
buffer_load_dwordx4 v8, s[16:19], s21 offen offset:0  nt lds
M v[188:191],a[168:171],a[88:91],v[188:191]
R a[160:163],v5,53248
R a[164:167],v6,53248
M v[188:191],a[172:175],a[92:95],v[188:191]
buffer_load_dword a240, v26, s[60:63], s27 offen offset:0
M v[184:187],a[172:175],a[84:87],v[184:187]
SA s27,s27,2048
M v[184:187],a[168:171],a[80:83],v[184:187]
M v[180:183],a[168:171],a[72:75],v[180:183]
M v[180:183],a[172:175],a[76:79],v[180:183]
s_nop 0
T a[148:149],v3,24576
T a[150:151],v3,25600
M v[176:179],a[172:175],a[68:71],v[176:179]
buffer_load_dwordx4 v9, s[16:19], s21 offen offset:1024  nt lds
M v[176:179],a[168:171],a[64:67],v[176:179]
M v[172:175],a[168:171],a[56:59],v[172:175]
M v[172:175],a[172:175],a[60:63],v[172:175]
M v[168:171],a[172:175],a[52:55],v[168:171]
M v[168:171],a[168:171],a[48:51],v[168:171]
M v[164:167],a[168:171],a[40:43],v[164:167]
s_nop 0
T a[152:153],v4,16384
T a[154:155],v4,17408
M v[164:167],a[172:175],a[44:47],v[164:167]
s_waitcnt lgkmcnt(4)
buffer_load_dwordx4 v10, s[16:19], s21 offen offset:2048  nt lds
M v[160:163],a[172:175],a[36:39],v[160:163]
M v[160:163],a[168:171],a[32:35],v[160:163]
M v[192:195],a[160:163],a[32:35],v[192:195]
R a[168:171],v5,55296
R a[172:175],v6,55296
M v[192:195],a[164:167],a[36:39],v[192:195]
M v[196:199],a[164:167],a[44:47],v[196:199]
M v[196:199],a[160:163],a[40:43],v[196:199]
s_nop 0
T a[156:157],v4,24576
T a[158:159],v4,25600
M v[200:203],a[160:163],a[48:51],v[200:203]
buffer_load_dwordx4 v11, s[16:19], s21 offen offset:3072  nt lds
M v[200:203],a[164:167],a[52:55],v[200:203]
SA s21,s21,128
M v[204:207],a[164:167],a[60:63],v[204:207]
M v[204:207],a[160:163],a[56:59],v[204:207]
M v[208:211],a[160:163],a[64:67],v[208:211]
M v[208:211],a[164:167],a[68:71],v[208:211]
M v[212:215],a[164:167],a[76:79],v[212:215]
M v[212:215],a[160:163],a[72:75],v[212:215]
M v[216:219],a[160:163],a[80:83],v[216:219]
M v[216:219],a[164:167],a[84:87],v[216:219]
s_waitcnt lgkmcnt(2)
M v[220:223],a[164:167],a[92:95],v[220:223]
s_waitcnt vmcnt(18) lgkmcnt(0)
M v[220:223],a[160:163],a[88:91],v[220:223]
s_barrier
M v[252:255],a[168:171],a[88:91],v[252:255]
R a[160:163],v5,0
R a[164:167],v6,0
M v[252:255],a[172:175],a[92:95],v[252:255]
M v[248:251],a[172:175],a[84:87],v[248:251]
M v[248:251],a[168:171],a[80:83],v[248:251]
M v[244:247],a[168:171],a[72:75],v[244:247]
M v[244:247],a[172:175],a[76:79],v[244:247]
M v[240:243],a[172:175],a[68:71],v[240:243]
M v[240:243],a[168:171],a[64:67],v[240:243]
M v[236:239],a[168:171],a[56:59],v[236:239]
M v[236:239],a[172:175],a[60:63],v[236:239]
M v[232:235],a[172:175],a[52:55],v[232:235]
M v[232:235],a[168:171],a[48:51],v[232:235]
M v[228:231],a[168:171],a[40:43],v[228:231]
M v[228:231],a[172:175],a[44:47],v[228:231]
s_waitcnt lgkmcnt(0)
M v[224:227],a[172:175],a[36:39],v[224:227]
M v[224:227],a[168:171],a[32:35],v[224:227]
M a[0:3],a[160:163],a[96:99],a[0:3]
R a[168:171],v5,2048
R a[172:175],v6,2048
M a[0:3],a[164:167],a[100:103],a[0:3]
T a[32:33],v1,32768
T a[34:35],v1,33792
M a[4:7],a[164:167],a[108:111],a[4:7]
SA m0,s24,49152
M a[4:7],a[160:163],a[104:107],a[4:7]
buffer_load_dwordx4 v12, s[48:51], s22 offen offset:0   lds
M a[8:11],a[160:163],a[112:115],a[8:11]
M a[8:11],a[164:167],a[116:119],a[8:11]
M a[12:15],a[164:167],a[124:127],a[12:15]
s_nop 0
T a[36:37],v1,40960
T a[38:39],v1,41984
M a[12:15],a[160:163],a[120:123],a[12:15]
M a[16:19],a[160:163],a[128:131],a[16:19]
buffer_load_dwordx4 v13, s[48:51], s22 offen offset:1024   lds
M a[16:19],a[164:167],a[132:135],a[16:19]
M a[20:23],a[164:167],a[140:143],a[20:23]
M a[20:23],a[160:163],a[136:139],a[20:23]
s_nop 0
T a[40:41],v2,32768
T a[42:43],v2,33792
M a[24:27],a[160:163],a[144:147],a[24:27]
M a[24:27],a[164:167],a[148:151],a[24:27]
s_waitcnt lgkmcnt(6)
buffer_load_dwordx4 v14, s[48:51], s22 offen offset:2048   lds
M a[28:31],a[164:167],a[156:159],a[28:31]
M a[28:31],a[160:163],a[152:155],a[28:31]
M v[60:63],a[168:171],a[152:155],v[60:63]
R a[160:163],v5,4096
R a[164:167],v6,4096
M v[60:63],a[172:175],a[156:159],v[60:63]
T a[44:45],v2,40960
T a[46:47],v2,41984
L_w_kv13:
s_cbranch_execz L_w_kv17
M v[56:59],a[172:175],a[148:151],v[56:59]
buffer_load_dwordx4 v15, s[48:51], s22 offen offset:3072   lds
M v[56:59],a[168:171],a[144:147],v[56:59]
s_sub_u32 s22, s22, 1048448
M v[52:55],a[168:171],a[136:139],v[52:55]
M v[52:55],a[172:175],a[140:143],v[52:55]
s_nop 0
T a[48:49],v3,32768
T a[50:51],v3,33792
M v[48:51],a[172:175],a[132:135],v[48:51]
SA m0,s23,16384
M v[48:51],a[168:171],a[128:131],v[48:51]
buffer_load_dwordx4 v8, s[16:19], s21 offen offset:0  nt lds
M v[44:47],a[168:171],a[120:123],v[44:47]
M v[44:47],a[172:175],a[124:127],v[44:47]
M v[40:43],a[172:175],a[116:119],v[40:43]
s_nop 0
T a[52:53],v3,40960
T a[54:55],v3,41984
M v[40:43],a[168:171],a[112:115],v[40:43]
M v[36:39],a[168:171],a[104:107],v[36:39]
buffer_load_dwordx4 v9, s[16:19], s21 offen offset:1024  nt lds
M v[36:39],a[172:175],a[108:111],v[36:39]
s_waitcnt lgkmcnt(6)
M v[32:35],a[172:175],a[100:103],v[32:35]
M v[32:35],a[168:171],a[96:99],v[32:35]
s_nop 0
T a[56:57],v4,32768
T a[58:59],v4,33792
M v[64:67],a[160:163],a[96:99],v[64:67]
R a[168:171],v5,6144
R a[172:175],v6,6144
M v[64:67],a[164:167],a[100:103],v[64:67]
buffer_load_dwordx4 v10, s[16:19], s21 offen offset:2048  nt lds
M v[68:71],a[164:167],a[108:111],v[68:71]
M v[68:71],a[160:163],a[104:107],v[68:71]
M v[72:75],a[160:163],a[112:115],v[72:75]
s_nop 0
T a[60:61],v4,40960
T a[62:63],v4,41984
M v[72:75],a[164:167],a[116:119],v[72:75]
M v[76:79],a[164:167],a[124:127],v[76:79]
buffer_load_dwordx4 v11, s[16:19], s21 offen offset:3072  nt lds
M v[76:79],a[160:163],a[120:123],v[76:79]
SA s21,s21,524160
M v[80:83],a[160:163],a[128:131],v[80:83]
M v[80:83],a[164:167],a[132:135],v[80:83]
M v[84:87],a[164:167],a[140:143],v[84:87]
M v[84:87],a[160:163],a[136:139],v[84:87]
M v[88:91],a[160:163],a[144:147],v[88:91]
M v[88:91],a[164:167],a[148:151],v[88:91]
s_waitcnt lgkmcnt(2)
M v[92:95],a[164:167],a[156:159],v[92:95]
s_waitcnt vmcnt(17) lgkmcnt(0)
M v[92:95],a[160:163],a[152:155],v[92:95]
s_barrier
M v[124:127],a[168:171],a[152:155],v[124:127]
R a[160:163],v5,16384
R a[164:167],v6,16384
M v[124:127],a[172:175],a[156:159],v[124:127]
M v[120:123],a[172:175],a[148:151],v[120:123]
SA m0,s24,0
T a[64:65],v1,49152
T a[66:67],v1,50176
M v[120:123],a[168:171],a[144:147],v[120:123]
buffer_load_dwordx4 v12, s[48:51], s22 offen offset:0   lds
M v[116:119],a[168:171],a[136:139],v[116:119]
M v[116:119],a[172:175],a[140:143],v[116:119]
M v[112:115],a[172:175],a[132:135],v[112:115]
M v[112:115],a[168:171],a[128:131],v[112:115]
M v[108:111],a[168:171],a[120:123],v[108:111]
M v[108:111],a[172:175],a[124:127],v[108:111]
s_nop 0
T a[68:69],v1,57344
T a[70:71],v1,58368
M v[104:107],a[172:175],a[116:119],v[104:107]
buffer_load_dwordx4 v13, s[48:51], s22 offen offset:1024   lds
M v[104:107],a[168:171],a[112:115],v[104:107]
M v[100:103],a[168:171],a[104:107],v[100:103]
M v[100:103],a[172:175],a[108:111],v[100:103]
s_waitcnt lgkmcnt(4)
M v[96:99],a[172:175],a[100:103],v[96:99]
M v[96:99],a[168:171],a[96:99],v[96:99]
M v[128:131],a[160:163],a[96:99],v[128:131]
R a[168:171],v5,18432
R a[172:175],v6,18432
M v[128:131],a[164:167],a[100:103],v[128:131]
T a[72:73],v2,49152
T a[74:75],v2,50176
M v[132:135],a[164:167],a[108:111],v[132:135]
buffer_load_dwordx4 v14, s[48:51], s22 offen offset:2048   lds
M v[132:135],a[160:163],a[104:107],v[132:135]
M v[136:139],a[160:163],a[112:115],v[136:139]
M v[136:139],a[164:167],a[116:119],v[136:139]
M v[140:143],a[164:167],a[124:127],v[140:143]
M v[140:143],a[160:163],a[120:123],v[140:143]
s_nop 0
T a[76:77],v2,57344
T a[78:79],v2,58368
M v[144:147],a[160:163],a[128:131],v[144:147]
buffer_load_dwordx4 v15, s[48:51], s22 offen offset:3072   lds
M v[144:147],a[164:167],a[132:135],v[144:147]
SA s22,s22,1048576
M v[148:151],a[164:167],a[140:143],v[148:151]
M v[148:151],a[160:163],a[136:139],v[148:151]
M v[152:155],a[160:163],a[144:147],v[152:155]
M v[152:155],a[164:167],a[148:151],v[152:155]
s_waitcnt lgkmcnt(4)
M v[156:159],a[164:167],a[156:159],v[156:159]
SA m0,s23,32768
T a[80:81],v3,49152
T a[82:83],v3,50176
M v[156:159],a[160:163],a[152:155],v[156:159]
buffer_load_dwordx4 v8, s[16:19], s21 offen offset:0  nt lds
M v[188:191],a[168:171],a[152:155],v[188:191]
R a[160:163],v5,20480
R a[164:167],v6,20480
M v[188:191],a[172:175],a[156:159],v[188:191]
buffer_load_dword a240, v26, s[60:63], s27 offen offset:0
M v[184:187],a[172:175],a[148:151],v[184:187]
SA s27,s27,2048
M v[184:187],a[168:171],a[144:147],v[184:187]
M v[180:183],a[168:171],a[136:139],v[180:183]
M v[180:183],a[172:175],a[140:143],v[180:183]
s_nop 0
T a[84:85],v3,57344
T a[86:87],v3,58368
M v[176:179],a[172:175],a[132:135],v[176:179]
buffer_load_dwordx4 v9, s[16:19], s21 offen offset:1024  nt lds
M v[176:179],a[168:171],a[128:131],v[176:179]
M v[172:175],a[168:171],a[120:123],v[172:175]
M v[172:175],a[172:175],a[124:127],v[172:175]
M v[168:171],a[172:175],a[116:119],v[168:171]
M v[168:171],a[168:171],a[112:115],v[168:171]
M v[164:167],a[168:171],a[104:107],v[164:167]
s_nop 0
T a[88:89],v4,49152
T a[90:91],v4,50176
M v[164:167],a[172:175],a[108:111],v[164:167]
s_waitcnt lgkmcnt(4)
buffer_load_dwordx4 v10, s[16:19], s21 offen offset:2048  nt lds
M v[160:163],a[172:175],a[100:103],v[160:163]
M v[160:163],a[168:171],a[96:99],v[160:163]
M v[192:195],a[160:163],a[96:99],v[192:195]
R a[168:171],v5,22528
R a[172:175],v6,22528
M v[192:195],a[164:167],a[100:103],v[192:195]
M v[196:199],a[164:167],a[108:111],v[196:199]
M v[196:199],a[160:163],a[104:107],v[196:199]
s_nop 0
T a[92:93],v4,57344
T a[94:95],v4,58368
M v[200:203],a[160:163],a[112:115],v[200:203]
buffer_load_dwordx4 v11, s[16:19], s21 offen offset:3072  nt lds
M v[200:203],a[164:167],a[116:119],v[200:203]
SA s21,s21,128
M v[204:207],a[164:167],a[124:127],v[204:207]
M v[204:207],a[160:163],a[120:123],v[204:207]
M v[208:211],a[160:163],a[128:131],v[208:211]
M v[208:211],a[164:167],a[132:135],v[208:211]
M v[212:215],a[164:167],a[140:143],v[212:215]
M v[212:215],a[160:163],a[136:139],v[212:215]
M v[216:219],a[160:163],a[144:147],v[216:219]
M v[216:219],a[164:167],a[148:151],v[216:219]
s_waitcnt lgkmcnt(2)
M v[220:223],a[164:167],a[156:159],v[220:223]
s_waitcnt vmcnt(17) lgkmcnt(0)
M v[220:223],a[160:163],a[152:155],v[220:223]
s_barrier
M v[252:255],a[168:171],a[152:155],v[252:255]
R a[160:163],v5,32768
R a[164:167],v6,32768
M v[252:255],a[172:175],a[156:159],v[252:255]
M v[248:251],a[172:175],a[148:151],v[248:251]
M v[248:251],a[168:171],a[144:147],v[248:251]
M v[244:247],a[168:171],a[136:139],v[244:247]
M v[244:247],a[172:175],a[140:143],v[244:247]
M v[240:243],a[172:175],a[132:135],v[240:243]
M v[240:243],a[168:171],a[128:131],v[240:243]
M v[236:239],a[168:171],a[120:123],v[236:239]
M v[236:239],a[172:175],a[124:127],v[236:239]
M v[232:235],a[172:175],a[116:119],v[232:235]
M v[232:235],a[168:171],a[112:115],v[232:235]
M v[228:231],a[168:171],a[104:107],v[228:231]
M v[228:231],a[172:175],a[108:111],v[228:231]
s_waitcnt lgkmcnt(0)
M v[224:227],a[172:175],a[100:103],v[224:227]
M v[224:227],a[168:171],a[96:99],v[224:227]
M a[0:3],a[160:163],a[32:35],a[0:3]
R a[168:171],v5,34816
R a[172:175],v6,34816
M a[0:3],a[164:167],a[36:39],a[0:3]
T a[96:97],v1,0
T a[98:99],v1,1024
M a[4:7],a[164:167],a[44:47],a[4:7]
SA m0,s24,16384
M a[4:7],a[160:163],a[40:43],a[4:7]
buffer_load_dwordx4 v12, s[48:51], s22 offen offset:0   lds
M a[8:11],a[160:163],a[48:51],a[8:11]
M a[8:11],a[164:167],a[52:55],a[8:11]
M a[12:15],a[164:167],a[60:63],a[12:15]
s_nop 0
T a[100:101],v1,8192
T a[102:103],v1,9216
M a[12:15],a[160:163],a[56:59],a[12:15]
M a[16:19],a[160:163],a[64:67],a[16:19]
buffer_load_dwordx4 v13, s[48:51], s22 offen offset:1024   lds
M a[16:19],a[164:167],a[68:71],a[16:19]
M a[20:23],a[164:167],a[76:79],a[20:23]
M a[20:23],a[160:163],a[72:75],a[20:23]
s_nop 0
T a[104:105],v2,0
T a[106:107],v2,1024
M a[24:27],a[160:163],a[80:83],a[24:27]
M a[24:27],a[164:167],a[84:87],a[24:27]
s_waitcnt lgkmcnt(6)
buffer_load_dwordx4 v14, s[48:51], s22 offen offset:2048   lds
M a[28:31],a[164:167],a[92:95],a[28:31]
M a[28:31],a[160:163],a[88:91],a[28:31]
M v[60:63],a[168:171],a[88:91],v[60:63]
R a[160:163],v5,36864
R a[164:167],v6,36864
M v[60:63],a[172:175],a[92:95],v[60:63]
T a[108:109],v2,8192
T a[110:111],v2,9216
M v[56:59],a[172:175],a[84:87],v[56:59]
buffer_load_dwordx4 v15, s[48:51], s22 offen offset:3072   lds
M v[56:59],a[168:171],a[80:83],v[56:59]
s_sub_u32 s22, s22, 1048448
M v[52:55],a[168:171],a[72:75],v[52:55]
M v[52:55],a[172:175],a[76:79],v[52:55]
s_nop 0
T a[112:113],v3,0
T a[114:115],v3,1024
M v[48:51],a[172:175],a[68:71],v[48:51]
SA m0,s23,49152
M v[48:51],a[168:171],a[64:67],v[48:51]
buffer_load_dwordx4 v8, s[16:19], s21 offen offset:0  nt lds
M v[44:47],a[168:171],a[56:59],v[44:47]
M v[44:47],a[172:175],a[60:63],v[44:47]
M v[40:43],a[172:175],a[52:55],v[40:43]
s_nop 0
T a[116:117],v3,8192
T a[118:119],v3,9216
M v[40:43],a[168:171],a[48:51],v[40:43]
M v[36:39],a[168:171],a[40:43],v[36:39]
buffer_load_dwordx4 v9, s[16:19], s21 offen offset:1024  nt lds
M v[36:39],a[172:175],a[44:47],v[36:39]
s_waitcnt lgkmcnt(6)
M v[32:35],a[172:175],a[36:39],v[32:35]
M v[32:35],a[168:171],a[32:35],v[32:35]
s_nop 0
T a[120:121],v4,0
T a[122:123],v4,1024
M v[64:67],a[160:163],a[32:35],v[64:67]
R a[168:171],v5,38912
R a[172:175],v6,38912
M v[64:67],a[164:167],a[36:39],v[64:67]
buffer_load_dwordx4 v10, s[16:19], s21 offen offset:2048  nt lds
M v[68:71],a[164:167],a[44:47],v[68:71]
M v[68:71],a[160:163],a[40:43],v[68:71]
M v[72:75],a[160:163],a[48:51],v[72:75]
s_nop 0
T a[124:125],v4,8192
T a[126:127],v4,9216
M v[72:75],a[164:167],a[52:55],v[72:75]
M v[76:79],a[164:167],a[60:63],v[76:79]
buffer_load_dwordx4 v11, s[16:19], s21 offen offset:3072  nt lds
M v[76:79],a[160:163],a[56:59],v[76:79]
SA s21,s21,524160
M v[80:83],a[160:163],a[64:67],v[80:83]
M v[80:83],a[164:167],a[68:71],v[80:83]
M v[84:87],a[164:167],a[76:79],v[84:87]
M v[84:87],a[160:163],a[72:75],v[84:87]
M v[88:91],a[160:163],a[80:83],v[88:91]
M v[88:91],a[164:167],a[84:87],v[88:91]
s_waitcnt lgkmcnt(2)
M v[92:95],a[164:167],a[92:95],v[92:95]
s_waitcnt vmcnt(17) lgkmcnt(0)
M v[92:95],a[160:163],a[88:91],v[92:95]
s_barrier
M v[124:127],a[168:171],a[88:91],v[124:127]
R a[160:163],v5,49152
R a[164:167],v6,49152
M v[124:127],a[172:175],a[92:95],v[124:127]
M v[120:123],a[172:175],a[84:87],v[120:123]
SA m0,s24,32768
T a[128:129],v1,16384
T a[130:131],v1,17408
M v[120:123],a[168:171],a[80:83],v[120:123]
buffer_load_dwordx4 v12, s[48:51], s22 offen offset:0   lds
M v[116:119],a[168:171],a[72:75],v[116:119]
M v[116:119],a[172:175],a[76:79],v[116:119]
M v[112:115],a[172:175],a[68:71],v[112:115]
M v[112:115],a[168:171],a[64:67],v[112:115]
M v[108:111],a[168:171],a[56:59],v[108:111]
M v[108:111],a[172:175],a[60:63],v[108:111]
s_nop 0
T a[132:133],v1,24576
T a[134:135],v1,25600
M v[104:107],a[172:175],a[52:55],v[104:107]
buffer_load_dwordx4 v13, s[48:51], s22 offen offset:1024   lds
M v[104:107],a[168:171],a[48:51],v[104:107]
M v[100:103],a[168:171],a[40:43],v[100:103]
s_and_b32 s64, s42, 7
s_lshl_b32 s64, s64, 2
M v[100:103],a[172:175],a[44:47],v[100:103]
s_waitcnt lgkmcnt(4)
SA s64,s64,s20
M v[96:99],a[172:175],a[36:39],v[96:99]
s_mul_i32 s64, s64, 114688
v_bfe_u32 v28, v0, 2, 2
v_and_b32 v29, 3, v0
M v[96:99],a[168:171],a[32:35],v[96:99]
v_lshlrev_b32 v29, 7, v29
v_lshl_add_u32 v28, v28, 13, v29
M v[128:131],a[160:163],a[32:35],v[128:131]
R a[168:171],v5,51200
R a[172:175],v6,51200
M v[128:131],a[164:167],a[36:39],v[128:131]
T a[136:137],v2,16384
T a[138:139],v2,17408
M v[132:135],a[164:167],a[44:47],v[132:135]
buffer_load_dwordx4 v14, s[48:51], s22 offen offset:2048   lds
M v[132:135],a[160:163],a[40:43],v[132:135]
v_add_u32 v23, s64, v28
v_and_b32 v28, 48, v0
M v[136:139],a[160:163],a[48:51],v[136:139]
v_lshl_add_u32 v23, v28, 24, v23
M v[136:139],a[164:167],a[52:55],v[136:139]
M v[140:143],a[164:167],a[60:63],v[140:143]
M v[140:143],a[160:163],a[56:59],v[140:143]
s_nop 0
T a[140:141],v2,24576
T a[142:143],v2,25600
M v[144:147],a[160:163],a[64:67],v[144:147]
buffer_load_dwordx4 v15, s[48:51], s22 offen offset:3072   lds
M v[144:147],a[164:167],a[68:71],v[144:147]
SA s22,s22,1048576
M v[148:151],a[164:167],a[76:79],v[148:151]
M v[148:151],a[160:163],a[72:75],v[148:151]
M v[152:155],a[160:163],a[80:83],v[152:155]
M v[152:155],a[164:167],a[84:87],v[152:155]
s_waitcnt lgkmcnt(4)
M v[156:159],a[164:167],a[92:95],v[156:159]
SA m0,s23,0
T a[144:145],v3,16384
T a[146:147],v3,17408
M v[156:159],a[160:163],a[88:91],v[156:159]
buffer_load_dwordx4 v8, s[16:19], s21 offen offset:0  nt lds
M v[188:191],a[168:171],a[88:91],v[188:191]
R a[160:163],v5,53248
R a[164:167],v6,53248
M v[188:191],a[172:175],a[92:95],v[188:191]
M v[184:187],a[172:175],a[84:87],v[184:187]
M v[184:187],a[168:171],a[80:83],v[184:187]
M v[180:183],a[168:171],a[72:75],v[180:183]
M v[180:183],a[172:175],a[76:79],v[180:183]
s_nop 0
T a[148:149],v3,24576
T a[150:151],v3,25600
M v[176:179],a[172:175],a[68:71],v[176:179]
buffer_load_dwordx4 v9, s[16:19], s21 offen offset:1024  nt lds
M v[176:179],a[168:171],a[64:67],v[176:179]
M v[172:175],a[168:171],a[56:59],v[172:175]
M v[172:175],a[172:175],a[60:63],v[172:175]
M v[168:171],a[172:175],a[52:55],v[168:171]
M v[168:171],a[168:171],a[48:51],v[168:171]
M v[164:167],a[168:171],a[40:43],v[164:167]
s_nop 0
T a[152:153],v4,16384
T a[154:155],v4,17408
M v[164:167],a[172:175],a[44:47],v[164:167]
s_waitcnt lgkmcnt(4)
buffer_load_dwordx4 v10, s[16:19], s21 offen offset:2048  nt lds
M v[160:163],a[172:175],a[36:39],v[160:163]
M v[160:163],a[168:171],a[32:35],v[160:163]
M v[192:195],a[160:163],a[32:35],v[192:195]
R a[168:171],v5,55296
R a[172:175],v6,55296
M v[192:195],a[164:167],a[36:39],v[192:195]
M v[196:199],a[164:167],a[44:47],v[196:199]
M v[196:199],a[160:163],a[40:43],v[196:199]
s_nop 0
T a[156:157],v4,24576
T a[158:159],v4,25600
M v[200:203],a[160:163],a[48:51],v[200:203]
buffer_load_dwordx4 v11, s[16:19], s21 offen offset:3072  nt lds
M v[200:203],a[164:167],a[52:55],v[200:203]
SA s21,s21,128
M v[204:207],a[164:167],a[60:63],v[204:207]
M v[204:207],a[160:163],a[56:59],v[204:207]
M v[208:211],a[160:163],a[64:67],v[208:211]
M v[208:211],a[164:167],a[68:71],v[208:211]
M v[212:215],a[164:167],a[76:79],v[212:215]
M v[212:215],a[160:163],a[72:75],v[212:215]
M v[216:219],a[160:163],a[80:83],v[216:219]
M v[216:219],a[164:167],a[84:87],v[216:219]
s_waitcnt lgkmcnt(2)
M v[220:223],a[164:167],a[92:95],v[220:223]
s_waitcnt vmcnt(16) lgkmcnt(0)
M v[220:223],a[160:163],a[88:91],v[220:223]
s_barrier
M v[252:255],a[168:171],a[88:91],v[252:255]
R a[160:163],v5,0
R a[164:167],v6,0
M v[252:255],a[172:175],a[92:95],v[252:255]
buffer_load_dword a240, v23, s[52:55], 0 offen offset:0
M v[248:251],a[172:175],a[84:87],v[248:251]
v_add_u32 v23, 32768, v23
M v[248:251],a[168:171],a[80:83],v[248:251]
M v[244:247],a[168:171],a[72:75],v[244:247]
M v[244:247],a[172:175],a[76:79],v[244:247]
M v[240:243],a[172:175],a[68:71],v[240:243]
M v[240:243],a[168:171],a[64:67],v[240:243]
M v[236:239],a[168:171],a[56:59],v[236:239]
M v[236:239],a[172:175],a[60:63],v[236:239]
M v[232:235],a[172:175],a[52:55],v[232:235]
M v[232:235],a[168:171],a[48:51],v[232:235]
M v[228:231],a[168:171],a[40:43],v[228:231]
M v[228:231],a[172:175],a[44:47],v[228:231]
s_waitcnt lgkmcnt(0)
M v[224:227],a[172:175],a[36:39],v[224:227]
M v[224:227],a[168:171],a[32:35],v[224:227]
M a[0:3],a[160:163],a[96:99],a[0:3]
R a[168:171],v5,2048
R a[172:175],v6,2048
M a[0:3],a[164:167],a[100:103],a[0:3]
T a[32:33],v1,32768
T a[34:35],v1,33792
M a[4:7],a[164:167],a[108:111],a[4:7]
SA m0,s24,49152
M a[4:7],a[160:163],a[104:107],a[4:7]
buffer_load_dwordx4 v12, s[48:51], s22 offen offset:0   lds
M a[8:11],a[160:163],a[112:115],a[8:11]
M a[8:11],a[164:167],a[116:119],a[8:11]
M a[12:15],a[164:167],a[124:127],a[12:15]
s_nop 0
T a[36:37],v1,40960
T a[38:39],v1,41984
M a[12:15],a[160:163],a[120:123],a[12:15]
M a[16:19],a[160:163],a[128:131],a[16:19]
buffer_load_dwordx4 v13, s[48:51], s22 offen offset:1024   lds
M a[16:19],a[164:167],a[132:135],a[16:19]
M a[20:23],a[164:167],a[140:143],a[20:23]
M a[20:23],a[160:163],a[136:139],a[20:23]
s_nop 0
T a[40:41],v2,32768
T a[42:43],v2,33792
M a[24:27],a[160:163],a[144:147],a[24:27]
M a[24:27],a[164:167],a[148:151],a[24:27]
s_waitcnt lgkmcnt(6)
buffer_load_dwordx4 v14, s[48:51], s22 offen offset:2048   lds
M a[28:31],a[164:167],a[156:159],a[28:31]
M a[28:31],a[160:163],a[152:155],a[28:31]
M v[60:63],a[168:171],a[152:155],v[60:63]
R a[160:163],v5,4096
R a[164:167],v6,4096
M v[60:63],a[172:175],a[156:159],v[60:63]
T a[44:45],v2,40960
T a[46:47],v2,41984
M v[56:59],a[172:175],a[148:151],v[56:59]
buffer_load_dwordx4 v15, s[48:51], s22 offen offset:3072   lds
M v[56:59],a[168:171],a[144:147],v[56:59]
s_sub_u32 s22, s22, 1048448
M v[52:55],a[168:171],a[136:139],v[52:55]
M v[52:55],a[172:175],a[140:143],v[52:55]
s_nop 0
T a[48:49],v3,32768
T a[50:51],v3,33792
M v[48:51],a[172:175],a[132:135],v[48:51]
SA m0,s23,16384
M v[48:51],a[168:171],a[128:131],v[48:51]
buffer_load_dwordx4 v8, s[16:19], s21 offen offset:0  nt lds
M v[44:47],a[168:171],a[120:123],v[44:47]
M v[44:47],a[172:175],a[124:127],v[44:47]
M v[40:43],a[172:175],a[116:119],v[40:43]
s_nop 0
T a[52:53],v3,40960
T a[54:55],v3,41984
M v[40:43],a[168:171],a[112:115],v[40:43]
M v[36:39],a[168:171],a[104:107],v[36:39]
buffer_load_dwordx4 v9, s[16:19], s21 offen offset:1024  nt lds
M v[36:39],a[172:175],a[108:111],v[36:39]
s_waitcnt lgkmcnt(6)
M v[32:35],a[172:175],a[100:103],v[32:35]
M v[32:35],a[168:171],a[96:99],v[32:35]
s_nop 0
T a[56:57],v4,32768
T a[58:59],v4,33792
M v[64:67],a[160:163],a[96:99],v[64:67]
R a[168:171],v5,6144
R a[172:175],v6,6144
M v[64:67],a[164:167],a[100:103],v[64:67]
buffer_load_dwordx4 v10, s[16:19], s21 offen offset:2048  nt lds
M v[68:71],a[164:167],a[108:111],v[68:71]
M v[68:71],a[160:163],a[104:107],v[68:71]
M v[72:75],a[160:163],a[112:115],v[72:75]
s_nop 0
T a[60:61],v4,40960
T a[62:63],v4,41984
M v[72:75],a[164:167],a[116:119],v[72:75]
M v[76:79],a[164:167],a[124:127],v[76:79]
buffer_load_dwordx4 v11, s[16:19], s21 offen offset:3072  nt lds
M v[76:79],a[160:163],a[120:123],v[76:79]
SA s21,s21,524160
M v[80:83],a[160:163],a[128:131],v[80:83]
M v[80:83],a[164:167],a[132:135],v[80:83]
M v[84:87],a[164:167],a[140:143],v[84:87]
M v[84:87],a[160:163],a[136:139],v[84:87]
M v[88:91],a[160:163],a[144:147],v[88:91]
M v[88:91],a[164:167],a[148:151],v[88:91]
s_waitcnt lgkmcnt(2)
M v[92:95],a[164:167],a[156:159],v[92:95]
s_waitcnt vmcnt(17) lgkmcnt(0)
M v[92:95],a[160:163],a[152:155],v[92:95]
s_barrier
M v[124:127],a[168:171],a[152:155],v[124:127]
R a[160:163],v5,16384
R a[164:167],v6,16384
M v[124:127],a[172:175],a[156:159],v[124:127]
M v[120:123],a[172:175],a[148:151],v[120:123]
SA m0,s24,0
T a[64:65],v1,49152
T a[66:67],v1,50176
M v[120:123],a[168:171],a[144:147],v[120:123]
buffer_load_dwordx4 v12, s[48:51], s22 offen offset:0   lds
M v[116:119],a[168:171],a[136:139],v[116:119]
M v[116:119],a[172:175],a[140:143],v[116:119]
M v[112:115],a[172:175],a[132:135],v[112:115]
M v[112:115],a[168:171],a[128:131],v[112:115]
M v[108:111],a[168:171],a[120:123],v[108:111]
M v[108:111],a[172:175],a[124:127],v[108:111]
s_nop 0
T a[68:69],v1,57344
T a[70:71],v1,58368
M v[104:107],a[172:175],a[116:119],v[104:107]
buffer_load_dwordx4 v13, s[48:51], s22 offen offset:1024   lds
M v[104:107],a[168:171],a[112:115],v[104:107]
M v[100:103],a[168:171],a[104:107],v[100:103]
M v[100:103],a[172:175],a[108:111],v[100:103]
s_waitcnt lgkmcnt(4)
M v[96:99],a[172:175],a[100:103],v[96:99]
M v[96:99],a[168:171],a[96:99],v[96:99]
L_w_kv14:
s_cbranch_execz L_w_kv18
M v[128:131],a[160:163],a[96:99],v[128:131]
R a[168:171],v5,18432
R a[172:175],v6,18432
M v[128:131],a[164:167],a[100:103],v[128:131]
T a[72:73],v2,49152
T a[74:75],v2,50176
M v[132:135],a[164:167],a[108:111],v[132:135]
buffer_load_dwordx4 v14, s[48:51], s22 offen offset:2048   lds
M v[132:135],a[160:163],a[104:107],v[132:135]
M v[136:139],a[160:163],a[112:115],v[136:139]
M v[136:139],a[164:167],a[116:119],v[136:139]
M v[140:143],a[164:167],a[124:127],v[140:143]
M v[140:143],a[160:163],a[120:123],v[140:143]
s_nop 0
T a[76:77],v2,57344
T a[78:79],v2,58368
M v[144:147],a[160:163],a[128:131],v[144:147]
buffer_load_dwordx4 v15, s[48:51], s22 offen offset:3072   lds
M v[144:147],a[164:167],a[132:135],v[144:147]
SA s22,s22,1048576
M v[148:151],a[164:167],a[140:143],v[148:151]
M v[148:151],a[160:163],a[136:139],v[148:151]
M v[152:155],a[160:163],a[144:147],v[152:155]
M v[152:155],a[164:167],a[148:151],v[152:155]
s_waitcnt lgkmcnt(4)
M v[156:159],a[164:167],a[156:159],v[156:159]
SA m0,s23,32768
T a[80:81],v3,49152
T a[82:83],v3,50176
M v[156:159],a[160:163],a[152:155],v[156:159]
buffer_load_dwordx4 v8, s[16:19], s21 offen offset:0  nt lds
M v[188:191],a[168:171],a[152:155],v[188:191]
R a[160:163],v5,20480
R a[164:167],v6,20480
M v[188:191],a[172:175],a[156:159],v[188:191]
M v[184:187],a[172:175],a[148:151],v[184:187]
M v[184:187],a[168:171],a[144:147],v[184:187]
M v[180:183],a[168:171],a[136:139],v[180:183]
M v[180:183],a[172:175],a[140:143],v[180:183]
s_nop 0
T a[84:85],v3,57344
T a[86:87],v3,58368
M v[176:179],a[172:175],a[132:135],v[176:179]
buffer_load_dwordx4 v9, s[16:19], s21 offen offset:1024  nt lds
M v[176:179],a[168:171],a[128:131],v[176:179]
M v[172:175],a[168:171],a[120:123],v[172:175]
M v[172:175],a[172:175],a[124:127],v[172:175]
M v[168:171],a[172:175],a[116:119],v[168:171]
M v[168:171],a[168:171],a[112:115],v[168:171]
M v[164:167],a[168:171],a[104:107],v[164:167]
s_nop 0
T a[88:89],v4,49152
T a[90:91],v4,50176
M v[164:167],a[172:175],a[108:111],v[164:167]
s_waitcnt lgkmcnt(4)
buffer_load_dwordx4 v10, s[16:19], s21 offen offset:2048  nt lds
M v[160:163],a[172:175],a[100:103],v[160:163]
M v[160:163],a[168:171],a[96:99],v[160:163]
M v[192:195],a[160:163],a[96:99],v[192:195]
R a[168:171],v5,22528
R a[172:175],v6,22528
M v[192:195],a[164:167],a[100:103],v[192:195]
M v[196:199],a[164:167],a[108:111],v[196:199]
M v[196:199],a[160:163],a[104:107],v[196:199]
s_nop 0
T a[92:93],v4,57344
T a[94:95],v4,58368
M v[200:203],a[160:163],a[112:115],v[200:203]
buffer_load_dwordx4 v11, s[16:19], s21 offen offset:3072  nt lds
M v[200:203],a[164:167],a[116:119],v[200:203]
SA s21,s21,128
M v[204:207],a[164:167],a[124:127],v[204:207]
M v[204:207],a[160:163],a[120:123],v[204:207]
M v[208:211],a[160:163],a[128:131],v[208:211]
M v[208:211],a[164:167],a[132:135],v[208:211]
M v[212:215],a[164:167],a[140:143],v[212:215]
M v[212:215],a[160:163],a[136:139],v[212:215]
M v[216:219],a[160:163],a[144:147],v[216:219]
M v[216:219],a[164:167],a[148:151],v[216:219]
s_waitcnt lgkmcnt(2)
M v[220:223],a[164:167],a[156:159],v[220:223]
s_waitcnt vmcnt(17) lgkmcnt(0)
M v[220:223],a[160:163],a[152:155],v[220:223]
s_barrier
M v[252:255],a[168:171],a[152:155],v[252:255]
R a[160:163],v5,32768
R a[164:167],v6,32768
M v[252:255],a[172:175],a[156:159],v[252:255]
buffer_load_dword a240, v23, s[52:55], 0 offen offset:0
M v[248:251],a[172:175],a[148:151],v[248:251]
v_add_u32 v23, 32768, v23
M v[248:251],a[168:171],a[144:147],v[248:251]
M v[244:247],a[168:171],a[136:139],v[244:247]
M v[244:247],a[172:175],a[140:143],v[244:247]
M v[240:243],a[172:175],a[132:135],v[240:243]
M v[240:243],a[168:171],a[128:131],v[240:243]
M v[236:239],a[168:171],a[120:123],v[236:239]
M v[236:239],a[172:175],a[124:127],v[236:239]
M v[232:235],a[172:175],a[116:119],v[232:235]
M v[232:235],a[168:171],a[112:115],v[232:235]
M v[228:231],a[168:171],a[104:107],v[228:231]
M v[228:231],a[172:175],a[108:111],v[228:231]
s_waitcnt lgkmcnt(0)
M v[224:227],a[172:175],a[100:103],v[224:227]
M v[224:227],a[168:171],a[96:99],v[224:227]
M a[0:3],a[160:163],a[32:35],a[0:3]
R a[168:171],v5,34816
R a[172:175],v6,34816
M a[0:3],a[164:167],a[36:39],a[0:3]
T a[96:97],v1,0
T a[98:99],v1,1024
M a[4:7],a[164:167],a[44:47],a[4:7]
SA m0,s24,16384
M a[4:7],a[160:163],a[40:43],a[4:7]
buffer_load_dwordx4 v12, s[48:51], s22 offen offset:0   lds
M a[8:11],a[160:163],a[48:51],a[8:11]
M a[8:11],a[164:167],a[52:55],a[8:11]
M a[12:15],a[164:167],a[60:63],a[12:15]
s_nop 0
T a[100:101],v1,8192
T a[102:103],v1,9216
M a[12:15],a[160:163],a[56:59],a[12:15]
M a[16:19],a[160:163],a[64:67],a[16:19]
buffer_load_dwordx4 v13, s[48:51], s22 offen offset:1024   lds
M a[16:19],a[164:167],a[68:71],a[16:19]
M a[20:23],a[164:167],a[76:79],a[20:23]
M a[20:23],a[160:163],a[72:75],a[20:23]
s_nop 0
T a[104:105],v2,0
T a[106:107],v2,1024
M a[24:27],a[160:163],a[80:83],a[24:27]
M a[24:27],a[164:167],a[84:87],a[24:27]
s_waitcnt lgkmcnt(6)
buffer_load_dwordx4 v14, s[48:51], s22 offen offset:2048   lds
M a[28:31],a[164:167],a[92:95],a[28:31]
M a[28:31],a[160:163],a[88:91],a[28:31]
M v[60:63],a[168:171],a[88:91],v[60:63]
R a[160:163],v5,36864
R a[164:167],v6,36864
M v[60:63],a[172:175],a[92:95],v[60:63]
T a[108:109],v2,8192
T a[110:111],v2,9216
M v[56:59],a[172:175],a[84:87],v[56:59]
buffer_load_dwordx4 v15, s[48:51], s22 offen offset:3072   lds
M v[56:59],a[168:171],a[80:83],v[56:59]
s_sub_u32 s22, s22, 1048448
M v[52:55],a[168:171],a[72:75],v[52:55]
M v[52:55],a[172:175],a[76:79],v[52:55]
s_nop 0
T a[112:113],v3,0
T a[114:115],v3,1024
M v[48:51],a[172:175],a[68:71],v[48:51]
SA m0,s23,49152
M v[48:51],a[168:171],a[64:67],v[48:51]
buffer_load_dwordx4 v8, s[16:19], s21 offen offset:0  nt lds
M v[44:47],a[168:171],a[56:59],v[44:47]
M v[44:47],a[172:175],a[60:63],v[44:47]
M v[40:43],a[172:175],a[52:55],v[40:43]
s_nop 0
T a[116:117],v3,8192
T a[118:119],v3,9216
M v[40:43],a[168:171],a[48:51],v[40:43]
M v[36:39],a[168:171],a[40:43],v[36:39]
buffer_load_dwordx4 v9, s[16:19], s21 offen offset:1024  nt lds
M v[36:39],a[172:175],a[44:47],v[36:39]
s_waitcnt lgkmcnt(6)
M v[32:35],a[172:175],a[36:39],v[32:35]
M v[32:35],a[168:171],a[32:35],v[32:35]
s_nop 0
T a[120:121],v4,0
T a[122:123],v4,1024
M v[64:67],a[160:163],a[32:35],v[64:67]
R a[168:171],v5,38912
R a[172:175],v6,38912
M v[64:67],a[164:167],a[36:39],v[64:67]
buffer_load_dwordx4 v10, s[16:19], s21 offen offset:2048  nt lds
M v[68:71],a[164:167],a[44:47],v[68:71]
M v[68:71],a[160:163],a[40:43],v[68:71]
M v[72:75],a[160:163],a[48:51],v[72:75]
s_nop 0
T a[124:125],v4,8192
T a[126:127],v4,9216
M v[72:75],a[164:167],a[52:55],v[72:75]
M v[76:79],a[164:167],a[60:63],v[76:79]
buffer_load_dwordx4 v11, s[16:19], s21 offen offset:3072  nt lds
M v[76:79],a[160:163],a[56:59],v[76:79]
SA s21,s21,524160
M v[80:83],a[160:163],a[64:67],v[80:83]
M v[80:83],a[164:167],a[68:71],v[80:83]
M v[84:87],a[164:167],a[76:79],v[84:87]
M v[84:87],a[160:163],a[72:75],v[84:87]
M v[88:91],a[160:163],a[80:83],v[88:91]
M v[88:91],a[164:167],a[84:87],v[88:91]
s_waitcnt lgkmcnt(2)
M v[92:95],a[164:167],a[92:95],v[92:95]
s_waitcnt vmcnt(17) lgkmcnt(0)
M v[92:95],a[160:163],a[88:91],v[92:95]
s_barrier
M v[124:127],a[168:171],a[88:91],v[124:127]
R a[160:163],v5,49152
R a[164:167],v6,49152
M v[124:127],a[172:175],a[92:95],v[124:127]
M v[120:123],a[172:175],a[84:87],v[120:123]
SA m0,s24,32768
T a[128:129],v1,16384
T a[130:131],v1,17408
M v[120:123],a[168:171],a[80:83],v[120:123]
buffer_load_dwordx4 v12, s[48:51], s22 offen offset:0   lds
M v[116:119],a[168:171],a[72:75],v[116:119]
M v[116:119],a[172:175],a[76:79],v[116:119]
M v[112:115],a[172:175],a[68:71],v[112:115]
M v[112:115],a[168:171],a[64:67],v[112:115]
M v[108:111],a[168:171],a[56:59],v[108:111]
M v[108:111],a[172:175],a[60:63],v[108:111]
s_nop 0
T a[132:133],v1,24576
T a[134:135],v1,25600
M v[104:107],a[172:175],a[52:55],v[104:107]
buffer_load_dwordx4 v13, s[48:51], s22 offen offset:1024   lds
M v[104:107],a[168:171],a[48:51],v[104:107]
M v[100:103],a[168:171],a[40:43],v[100:103]
M v[100:103],a[172:175],a[44:47],v[100:103]
s_waitcnt lgkmcnt(4)
M v[96:99],a[172:175],a[36:39],v[96:99]
M v[96:99],a[168:171],a[32:35],v[96:99]
M v[128:131],a[160:163],a[32:35],v[128:131]
R a[168:171],v5,51200
R a[172:175],v6,51200
M v[128:131],a[164:167],a[36:39],v[128:131]
T a[136:137],v2,16384
T a[138:139],v2,17408
M v[132:135],a[164:167],a[44:47],v[132:135]
buffer_load_dwordx4 v14, s[48:51], s22 offen offset:2048   lds
M v[132:135],a[160:163],a[40:43],v[132:135]
M v[136:139],a[160:163],a[48:51],v[136:139]
M v[136:139],a[164:167],a[52:55],v[136:139]
M v[140:143],a[164:167],a[60:63],v[140:143]
M v[140:143],a[160:163],a[56:59],v[140:143]
s_nop 0
T a[140:141],v2,24576
T a[142:143],v2,25600
M v[144:147],a[160:163],a[64:67],v[144:147]
buffer_load_dwordx4 v15, s[48:51], s22 offen offset:3072   lds
M v[144:147],a[164:167],a[68:71],v[144:147]
SA s22,s22,1048576
M v[148:151],a[164:167],a[76:79],v[148:151]
M v[148:151],a[160:163],a[72:75],v[148:151]
M v[152:155],a[160:163],a[80:83],v[152:155]
M v[152:155],a[164:167],a[84:87],v[152:155]
s_waitcnt lgkmcnt(4)
M v[156:159],a[164:167],a[92:95],v[156:159]
SA m0,s23,0
T a[144:145],v3,16384
T a[146:147],v3,17408
M v[156:159],a[160:163],a[88:91],v[156:159]
buffer_load_dwordx4 v8, s[16:19], s21 offen offset:0  nt lds
M v[188:191],a[168:171],a[88:91],v[188:191]
R a[160:163],v5,53248
R a[164:167],v6,53248
M v[188:191],a[172:175],a[92:95],v[188:191]
M v[184:187],a[172:175],a[84:87],v[184:187]
M v[184:187],a[168:171],a[80:83],v[184:187]
M v[180:183],a[168:171],a[72:75],v[180:183]
M v[180:183],a[172:175],a[76:79],v[180:183]
s_nop 0
T a[148:149],v3,24576
T a[150:151],v3,25600
M v[176:179],a[172:175],a[68:71],v[176:179]
buffer_load_dwordx4 v9, s[16:19], s21 offen offset:1024  nt lds
M v[176:179],a[168:171],a[64:67],v[176:179]
M v[172:175],a[168:171],a[56:59],v[172:175]
M v[172:175],a[172:175],a[60:63],v[172:175]
M v[168:171],a[172:175],a[52:55],v[168:171]
M v[168:171],a[168:171],a[48:51],v[168:171]
M v[164:167],a[168:171],a[40:43],v[164:167]
s_nop 0
T a[152:153],v4,16384
T a[154:155],v4,17408
M v[164:167],a[172:175],a[44:47],v[164:167]
s_waitcnt lgkmcnt(4)
buffer_load_dwordx4 v10, s[16:19], s21 offen offset:2048  nt lds
M v[160:163],a[172:175],a[36:39],v[160:163]
M v[160:163],a[168:171],a[32:35],v[160:163]
M v[192:195],a[160:163],a[32:35],v[192:195]
R a[168:171],v5,55296
R a[172:175],v6,55296
M v[192:195],a[164:167],a[36:39],v[192:195]
M v[196:199],a[164:167],a[44:47],v[196:199]
M v[196:199],a[160:163],a[40:43],v[196:199]
s_nop 0
T a[156:157],v4,24576
T a[158:159],v4,25600
M v[200:203],a[160:163],a[48:51],v[200:203]
buffer_load_dwordx4 v11, s[16:19], s21 offen offset:3072  nt lds
M v[200:203],a[164:167],a[52:55],v[200:203]
SA s21,s21,128
M v[204:207],a[164:167],a[60:63],v[204:207]
M v[204:207],a[160:163],a[56:59],v[204:207]
M v[208:211],a[160:163],a[64:67],v[208:211]
M v[208:211],a[164:167],a[68:71],v[208:211]
M v[212:215],a[164:167],a[76:79],v[212:215]
M v[212:215],a[160:163],a[72:75],v[212:215]
M v[216:219],a[160:163],a[80:83],v[216:219]
M v[216:219],a[164:167],a[84:87],v[216:219]
s_waitcnt lgkmcnt(2)
M v[220:223],a[164:167],a[92:95],v[220:223]
s_waitcnt vmcnt(17) lgkmcnt(0)
M v[220:223],a[160:163],a[88:91],v[220:223]
s_barrier
M v[252:255],a[168:171],a[88:91],v[252:255]
R a[160:163],v5,0
R a[164:167],v6,0
M v[252:255],a[172:175],a[92:95],v[252:255]
buffer_load_dword a240, v23, s[52:55], 0 offen offset:0
M v[248:251],a[172:175],a[84:87],v[248:251]
v_add_u32 v23, 16384, v23
M v[248:251],a[168:171],a[80:83],v[248:251]
M v[244:247],a[168:171],a[72:75],v[244:247]
M v[244:247],a[172:175],a[76:79],v[244:247]
M v[240:243],a[172:175],a[68:71],v[240:243]
M v[240:243],a[168:171],a[64:67],v[240:243]
M v[236:239],a[168:171],a[56:59],v[236:239]
M v[236:239],a[172:175],a[60:63],v[236:239]
M v[232:235],a[172:175],a[52:55],v[232:235]
M v[232:235],a[168:171],a[48:51],v[232:235]
M v[228:231],a[168:171],a[40:43],v[228:231]
M v[228:231],a[172:175],a[44:47],v[228:231]
s_waitcnt lgkmcnt(0)
M v[224:227],a[172:175],a[36:39],v[224:227]
M v[224:227],a[168:171],a[32:35],v[224:227]
M a[0:3],a[160:163],a[96:99],a[0:3]
R a[168:171],v5,2048
R a[172:175],v6,2048
M a[0:3],a[164:167],a[100:103],a[0:3]
T a[32:33],v1,32768
T a[34:35],v1,33792
M a[4:7],a[164:167],a[108:111],a[4:7]
SA m0,s24,49152
M a[4:7],a[160:163],a[104:107],a[4:7]
buffer_load_dwordx4 v12, s[48:51], s22 offen offset:0   lds
M a[8:11],a[160:163],a[112:115],a[8:11]
M a[8:11],a[164:167],a[116:119],a[8:11]
M a[12:15],a[164:167],a[124:127],a[12:15]
s_nop 0
T a[36:37],v1,40960
T a[38:39],v1,41984
M a[12:15],a[160:163],a[120:123],a[12:15]
M a[16:19],a[160:163],a[128:131],a[16:19]
buffer_load_dwordx4 v13, s[48:51], s22 offen offset:1024   lds
M a[16:19],a[164:167],a[132:135],a[16:19]
M a[20:23],a[164:167],a[140:143],a[20:23]
M a[20:23],a[160:163],a[136:139],a[20:23]
s_nop 0
T a[40:41],v2,32768
T a[42:43],v2,33792
M a[24:27],a[160:163],a[144:147],a[24:27]
M a[24:27],a[164:167],a[148:151],a[24:27]
s_waitcnt lgkmcnt(6)
buffer_load_dwordx4 v14, s[48:51], s22 offen offset:2048   lds
M a[28:31],a[164:167],a[156:159],a[28:31]
M a[28:31],a[160:163],a[152:155],a[28:31]
M v[60:63],a[168:171],a[152:155],v[60:63]
R a[160:163],v5,4096
R a[164:167],v6,4096
M v[60:63],a[172:175],a[156:159],v[60:63]
T a[44:45],v2,40960
T a[46:47],v2,41984
M v[56:59],a[172:175],a[148:151],v[56:59]
buffer_load_dwordx4 v15, s[48:51], s22 offen offset:3072   lds
M v[56:59],a[168:171],a[144:147],v[56:59]
s_sub_u32 s22, s22, 1048448
M v[52:55],a[168:171],a[136:139],v[52:55]
M v[52:55],a[172:175],a[140:143],v[52:55]
s_nop 0
T a[48:49],v3,32768
T a[50:51],v3,33792
M v[48:51],a[172:175],a[132:135],v[48:51]
SA m0,s23,16384
M v[48:51],a[168:171],a[128:131],v[48:51]
buffer_load_dwordx4 v8, s[16:19], s21 offen offset:0  nt lds
M v[44:47],a[168:171],a[120:123],v[44:47]
M v[44:47],a[172:175],a[124:127],v[44:47]
M v[40:43],a[172:175],a[116:119],v[40:43]
s_nop 0
T a[52:53],v3,40960
T a[54:55],v3,41984
M v[40:43],a[168:171],a[112:115],v[40:43]
M v[36:39],a[168:171],a[104:107],v[36:39]
buffer_load_dwordx4 v9, s[16:19], s21 offen offset:1024  nt lds
M v[36:39],a[172:175],a[108:111],v[36:39]
s_waitcnt lgkmcnt(6)
M v[32:35],a[172:175],a[100:103],v[32:35]
M v[32:35],a[168:171],a[96:99],v[32:35]
s_nop 0
T a[56:57],v4,32768
T a[58:59],v4,33792
M v[64:67],a[160:163],a[96:99],v[64:67]
R a[168:171],v5,6144
R a[172:175],v6,6144
M v[64:67],a[164:167],a[100:103],v[64:67]
buffer_load_dwordx4 v10, s[16:19], s21 offen offset:2048  nt lds
M v[68:71],a[164:167],a[108:111],v[68:71]
M v[68:71],a[160:163],a[104:107],v[68:71]
M v[72:75],a[160:163],a[112:115],v[72:75]
s_nop 0
T a[60:61],v4,40960
T a[62:63],v4,41984
M v[72:75],a[164:167],a[116:119],v[72:75]
M v[76:79],a[164:167],a[124:127],v[76:79]
buffer_load_dwordx4 v11, s[16:19], s21 offen offset:3072  nt lds
M v[76:79],a[160:163],a[120:123],v[76:79]
SA s21,s21,524160
M v[80:83],a[160:163],a[128:131],v[80:83]
M v[80:83],a[164:167],a[132:135],v[80:83]
M v[84:87],a[164:167],a[140:143],v[84:87]
M v[84:87],a[160:163],a[136:139],v[84:87]
M v[88:91],a[160:163],a[144:147],v[88:91]
M v[88:91],a[164:167],a[148:151],v[88:91]
s_waitcnt lgkmcnt(2)
M v[92:95],a[164:167],a[156:159],v[92:95]
s_waitcnt vmcnt(17) lgkmcnt(0)
M v[92:95],a[160:163],a[152:155],v[92:95]
s_barrier
M v[124:127],a[168:171],a[152:155],v[124:127]
R a[160:163],v5,16384
R a[164:167],v6,16384
M v[124:127],a[172:175],a[156:159],v[124:127]
M v[120:123],a[172:175],a[148:151],v[120:123]
SA m0,s24,0
T a[64:65],v1,49152
T a[66:67],v1,50176
M v[120:123],a[168:171],a[144:147],v[120:123]
buffer_load_dwordx4 v12, s[48:51], s22 offen offset:0   lds
M v[116:119],a[168:171],a[136:139],v[116:119]
M v[116:119],a[172:175],a[140:143],v[116:119]
M v[112:115],a[172:175],a[132:135],v[112:115]
M v[112:115],a[168:171],a[128:131],v[112:115]
M v[108:111],a[168:171],a[120:123],v[108:111]
M v[108:111],a[172:175],a[124:127],v[108:111]
s_nop 0
T a[68:69],v1,57344
T a[70:71],v1,58368
M v[104:107],a[172:175],a[116:119],v[104:107]
buffer_load_dwordx4 v13, s[48:51], s22 offen offset:1024   lds
M v[104:107],a[168:171],a[112:115],v[104:107]
M v[100:103],a[168:171],a[104:107],v[100:103]
M v[100:103],a[172:175],a[108:111],v[100:103]
s_waitcnt lgkmcnt(4)
M v[96:99],a[172:175],a[100:103],v[96:99]
M v[96:99],a[168:171],a[96:99],v[96:99]
M v[128:131],a[160:163],a[96:99],v[128:131]
R a[168:171],v5,18432
R a[172:175],v6,18432
M v[128:131],a[164:167],a[100:103],v[128:131]
T a[72:73],v2,49152
T a[74:75],v2,50176
M v[132:135],a[164:167],a[108:111],v[132:135]
buffer_load_dwordx4 v14, s[48:51], s22 offen offset:2048   lds
M v[132:135],a[160:163],a[104:107],v[132:135]
M v[136:139],a[160:163],a[112:115],v[136:139]
M v[136:139],a[164:167],a[116:119],v[136:139]
M v[140:143],a[164:167],a[124:127],v[140:143]
M v[140:143],a[160:163],a[120:123],v[140:143]
s_nop 0
T a[76:77],v2,57344
T a[78:79],v2,58368
M v[144:147],a[160:163],a[128:131],v[144:147]
buffer_load_dwordx4 v15, s[48:51], s22 offen offset:3072   lds
M v[144:147],a[164:167],a[132:135],v[144:147]
SA s22,s22,1048576
M v[148:151],a[164:167],a[140:143],v[148:151]
M v[148:151],a[160:163],a[136:139],v[148:151]
M v[152:155],a[160:163],a[144:147],v[152:155]
M v[152:155],a[164:167],a[148:151],v[152:155]
s_waitcnt lgkmcnt(4)
M v[156:159],a[164:167],a[156:159],v[156:159]
SA m0,s23,32768
T a[80:81],v3,49152
T a[82:83],v3,50176
M v[156:159],a[160:163],a[152:155],v[156:159]
buffer_load_dwordx4 v8, s[16:19], s21 offen offset:0  nt lds
M v[188:191],a[168:171],a[152:155],v[188:191]
R a[160:163],v5,20480
R a[164:167],v6,20480
M v[188:191],a[172:175],a[156:159],v[188:191]
M v[184:187],a[172:175],a[148:151],v[184:187]
M v[184:187],a[168:171],a[144:147],v[184:187]
M v[180:183],a[168:171],a[136:139],v[180:183]
M v[180:183],a[172:175],a[140:143],v[180:183]
s_nop 0
T a[84:85],v3,57344
T a[86:87],v3,58368
M v[176:179],a[172:175],a[132:135],v[176:179]
buffer_load_dwordx4 v9, s[16:19], s21 offen offset:1024  nt lds
M v[176:179],a[168:171],a[128:131],v[176:179]
M v[172:175],a[168:171],a[120:123],v[172:175]
M v[172:175],a[172:175],a[124:127],v[172:175]
M v[168:171],a[172:175],a[116:119],v[168:171]
M v[168:171],a[168:171],a[112:115],v[168:171]
M v[164:167],a[168:171],a[104:107],v[164:167]
s_nop 0
T a[88:89],v4,49152
T a[90:91],v4,50176
M v[164:167],a[172:175],a[108:111],v[164:167]
s_waitcnt lgkmcnt(4)
buffer_load_dwordx4 v10, s[16:19], s21 offen offset:2048  nt lds
M v[160:163],a[172:175],a[100:103],v[160:163]
M v[160:163],a[168:171],a[96:99],v[160:163]
M v[192:195],a[160:163],a[96:99],v[192:195]
R a[168:171],v5,22528
R a[172:175],v6,22528
M v[192:195],a[164:167],a[100:103],v[192:195]
M v[196:199],a[164:167],a[108:111],v[196:199]
M v[196:199],a[160:163],a[104:107],v[196:199]
s_nop 0
T a[92:93],v4,57344
T a[94:95],v4,58368
M v[200:203],a[160:163],a[112:115],v[200:203]
buffer_load_dwordx4 v11, s[16:19], s21 offen offset:3072  nt lds
M v[200:203],a[164:167],a[116:119],v[200:203]
SA s21,s21,128
M v[204:207],a[164:167],a[124:127],v[204:207]
M v[204:207],a[160:163],a[120:123],v[204:207]
M v[208:211],a[160:163],a[128:131],v[208:211]
M v[208:211],a[164:167],a[132:135],v[208:211]
M v[212:215],a[164:167],a[140:143],v[212:215]
M v[212:215],a[160:163],a[136:139],v[212:215]
M v[216:219],a[160:163],a[144:147],v[216:219]
M v[216:219],a[164:167],a[148:151],v[216:219]
s_waitcnt lgkmcnt(2)
M v[220:223],a[164:167],a[156:159],v[220:223]
s_waitcnt vmcnt(17) lgkmcnt(0)
M v[220:223],a[160:163],a[152:155],v[220:223]
s_barrier
M v[252:255],a[168:171],a[152:155],v[252:255]
R a[160:163],v5,32768
R a[164:167],v6,32768
M v[252:255],a[172:175],a[156:159],v[252:255]
buffer_load_dword a240, v23, s[52:55], 0 offen offset:0
M v[248:251],a[172:175],a[148:151],v[248:251]
L_w_kv15:
s_cbranch_execz L_wd2
v_add_u32 v23, 16384, v23
M v[248:251],a[168:171],a[144:147],v[248:251]
M v[244:247],a[168:171],a[136:139],v[244:247]
M v[244:247],a[172:175],a[140:143],v[244:247]
M v[240:243],a[172:175],a[132:135],v[240:243]
M v[240:243],a[168:171],a[128:131],v[240:243]
M v[236:239],a[168:171],a[120:123],v[236:239]
M v[236:239],a[172:175],a[124:127],v[236:239]
M v[232:235],a[172:175],a[116:119],v[232:235]
M v[232:235],a[168:171],a[112:115],v[232:235]
M v[228:231],a[168:171],a[104:107],v[228:231]
M v[228:231],a[172:175],a[108:111],v[228:231]
s_waitcnt lgkmcnt(0)
M v[224:227],a[172:175],a[100:103],v[224:227]
M v[224:227],a[168:171],a[96:99],v[224:227]
M a[0:3],a[160:163],a[32:35],a[0:3]
R a[168:171],v5,34816
R a[172:175],v6,34816
M a[0:3],a[164:167],a[36:39],a[0:3]
T a[96:97],v1,0
T a[98:99],v1,1024
M a[4:7],a[164:167],a[44:47],a[4:7]
SA m0,s24,16384
M a[4:7],a[160:163],a[40:43],a[4:7]
buffer_load_dwordx4 v12, s[48:51], s22 offen offset:0   lds
M a[8:11],a[160:163],a[48:51],a[8:11]
M a[8:11],a[164:167],a[52:55],a[8:11]
M a[12:15],a[164:167],a[60:63],a[12:15]
s_nop 0
T a[100:101],v1,8192
T a[102:103],v1,9216
M a[12:15],a[160:163],a[56:59],a[12:15]
M a[16:19],a[160:163],a[64:67],a[16:19]
buffer_load_dwordx4 v13, s[48:51], s22 offen offset:1024   lds
M a[16:19],a[164:167],a[68:71],a[16:19]
M a[20:23],a[164:167],a[76:79],a[20:23]
M a[20:23],a[160:163],a[72:75],a[20:23]
s_nop 0
T a[104:105],v2,0
T a[106:107],v2,1024
M a[24:27],a[160:163],a[80:83],a[24:27]
M a[24:27],a[164:167],a[84:87],a[24:27]
s_waitcnt lgkmcnt(6)
buffer_load_dwordx4 v14, s[48:51], s22 offen offset:2048   lds
M a[28:31],a[164:167],a[92:95],a[28:31]
M a[28:31],a[160:163],a[88:91],a[28:31]
M v[60:63],a[168:171],a[88:91],v[60:63]
R a[160:163],v5,36864
R a[164:167],v6,36864
M v[60:63],a[172:175],a[92:95],v[60:63]
T a[108:109],v2,8192
T a[110:111],v2,9216
M v[56:59],a[172:175],a[84:87],v[56:59]
buffer_load_dwordx4 v15, s[48:51], s22 offen offset:3072   lds
M v[56:59],a[168:171],a[80:83],v[56:59]
s_sub_u32 s22, s22, 1048448
M v[52:55],a[168:171],a[72:75],v[52:55]
M v[52:55],a[172:175],a[76:79],v[52:55]
s_nop 0
T a[112:113],v3,0
T a[114:115],v3,1024
M v[48:51],a[172:175],a[68:71],v[48:51]
SA m0,s23,49152
M v[48:51],a[168:171],a[64:67],v[48:51]
buffer_load_dwordx4 v8, s[16:19], s21 offen offset:0  nt lds
M v[44:47],a[168:171],a[56:59],v[44:47]
M v[44:47],a[172:175],a[60:63],v[44:47]
M v[40:43],a[172:175],a[52:55],v[40:43]
s_nop 0
T a[116:117],v3,8192
T a[118:119],v3,9216
M v[40:43],a[168:171],a[48:51],v[40:43]
M v[36:39],a[168:171],a[40:43],v[36:39]
buffer_load_dwordx4 v9, s[16:19], s21 offen offset:1024  nt lds
M v[36:39],a[172:175],a[44:47],v[36:39]
s_waitcnt lgkmcnt(6)
M v[32:35],a[172:175],a[36:39],v[32:35]
M v[32:35],a[168:171],a[32:35],v[32:35]
s_nop 0
T a[120:121],v4,0
T a[122:123],v4,1024
M v[64:67],a[160:163],a[32:35],v[64:67]
R a[168:171],v5,38912
R a[172:175],v6,38912
M v[64:67],a[164:167],a[36:39],v[64:67]
buffer_load_dwordx4 v10, s[16:19], s21 offen offset:2048  nt lds
M v[68:71],a[164:167],a[44:47],v[68:71]
M v[68:71],a[160:163],a[40:43],v[68:71]
M v[72:75],a[160:163],a[48:51],v[72:75]
s_nop 0
T a[124:125],v4,8192
T a[126:127],v4,9216
M v[72:75],a[164:167],a[52:55],v[72:75]
M v[76:79],a[164:167],a[60:63],v[76:79]
buffer_load_dwordx4 v11, s[16:19], s21 offen offset:3072  nt lds
M v[76:79],a[160:163],a[56:59],v[76:79]
SA s21,s21,524160
M v[80:83],a[160:163],a[64:67],v[80:83]
M v[80:83],a[164:167],a[68:71],v[80:83]
M v[84:87],a[164:167],a[76:79],v[84:87]
M v[84:87],a[160:163],a[72:75],v[84:87]
M v[88:91],a[160:163],a[80:83],v[88:91]
M v[88:91],a[164:167],a[84:87],v[88:91]
s_waitcnt lgkmcnt(2)
M v[92:95],a[164:167],a[92:95],v[92:95]
s_waitcnt vmcnt(17) lgkmcnt(0)
M v[92:95],a[160:163],a[88:91],v[92:95]
s_barrier
M v[124:127],a[168:171],a[88:91],v[124:127]
R a[160:163],v5,49152
R a[164:167],v6,49152
M v[124:127],a[172:175],a[92:95],v[124:127]
M v[120:123],a[172:175],a[84:87],v[120:123]
SA m0,s24,32768
T a[128:129],v1,16384
T a[130:131],v1,17408
M v[120:123],a[168:171],a[80:83],v[120:123]
buffer_load_dwordx4 v12, s[48:51], s22 offen offset:0   lds
M v[116:119],a[168:171],a[72:75],v[116:119]
M v[116:119],a[172:175],a[76:79],v[116:119]
M v[112:115],a[172:175],a[68:71],v[112:115]
M v[112:115],a[168:171],a[64:67],v[112:115]
M v[108:111],a[168:171],a[56:59],v[108:111]
M v[108:111],a[172:175],a[60:63],v[108:111]
s_nop 0
T a[132:133],v1,24576
T a[134:135],v1,25600
M v[104:107],a[172:175],a[52:55],v[104:107]
buffer_load_dwordx4 v13, s[48:51], s22 offen offset:1024   lds
M v[104:107],a[168:171],a[48:51],v[104:107]
M v[100:103],a[168:171],a[40:43],v[100:103]
M v[100:103],a[172:175],a[44:47],v[100:103]
s_waitcnt lgkmcnt(4)
M v[96:99],a[172:175],a[36:39],v[96:99]
M v[96:99],a[168:171],a[32:35],v[96:99]
M v[128:131],a[160:163],a[32:35],v[128:131]
R a[168:171],v5,51200
R a[172:175],v6,51200
M v[128:131],a[164:167],a[36:39],v[128:131]
T a[136:137],v2,16384
T a[138:139],v2,17408
M v[132:135],a[164:167],a[44:47],v[132:135]
buffer_load_dwordx4 v14, s[48:51], s22 offen offset:2048   lds
M v[132:135],a[160:163],a[40:43],v[132:135]
M v[136:139],a[160:163],a[48:51],v[136:139]
M v[136:139],a[164:167],a[52:55],v[136:139]
M v[140:143],a[164:167],a[60:63],v[140:143]
M v[140:143],a[160:163],a[56:59],v[140:143]
s_nop 0
T a[140:141],v2,24576
T a[142:143],v2,25600
M v[144:147],a[160:163],a[64:67],v[144:147]
buffer_load_dwordx4 v15, s[48:51], s22 offen offset:3072   lds
M v[144:147],a[164:167],a[68:71],v[144:147]
SA s22,s22,1048576
M v[148:151],a[164:167],a[76:79],v[148:151]
M v[148:151],a[160:163],a[72:75],v[148:151]
M v[152:155],a[160:163],a[80:83],v[152:155]
M v[152:155],a[164:167],a[84:87],v[152:155]
s_waitcnt lgkmcnt(4)
M v[156:159],a[164:167],a[92:95],v[156:159]
SA m0,s23,0
T a[144:145],v3,16384
T a[146:147],v3,17408
M v[156:159],a[160:163],a[88:91],v[156:159]
buffer_load_dwordx4 v8, s[16:19], s21 offen offset:0  nt lds
M v[188:191],a[168:171],a[88:91],v[188:191]
R a[160:163],v5,53248
R a[164:167],v6,53248
M v[188:191],a[172:175],a[92:95],v[188:191]
M v[184:187],a[172:175],a[84:87],v[184:187]
M v[184:187],a[168:171],a[80:83],v[184:187]
M v[180:183],a[168:171],a[72:75],v[180:183]
M v[180:183],a[172:175],a[76:79],v[180:183]
s_nop 0
T a[148:149],v3,24576
T a[150:151],v3,25600
M v[176:179],a[172:175],a[68:71],v[176:179]
buffer_load_dwordx4 v9, s[16:19], s21 offen offset:1024  nt lds
M v[176:179],a[168:171],a[64:67],v[176:179]
M v[172:175],a[168:171],a[56:59],v[172:175]
M v[172:175],a[172:175],a[60:63],v[172:175]
M v[168:171],a[172:175],a[52:55],v[168:171]
M v[168:171],a[168:171],a[48:51],v[168:171]
M v[164:167],a[168:171],a[40:43],v[164:167]
s_nop 0
T a[152:153],v4,16384
T a[154:155],v4,17408
M v[164:167],a[172:175],a[44:47],v[164:167]
s_waitcnt lgkmcnt(4)
buffer_load_dwordx4 v10, s[16:19], s21 offen offset:2048  nt lds
M v[160:163],a[172:175],a[36:39],v[160:163]
M v[160:163],a[168:171],a[32:35],v[160:163]
M v[192:195],a[160:163],a[32:35],v[192:195]
R a[168:171],v5,55296
R a[172:175],v6,55296
M v[192:195],a[164:167],a[36:39],v[192:195]
M v[196:199],a[164:167],a[44:47],v[196:199]
M v[196:199],a[160:163],a[40:43],v[196:199]
s_nop 0
T a[156:157],v4,24576
T a[158:159],v4,25600
M v[200:203],a[160:163],a[48:51],v[200:203]
buffer_load_dwordx4 v11, s[16:19], s21 offen offset:3072  nt lds
M v[200:203],a[164:167],a[52:55],v[200:203]
SA s21,s21,128
M v[204:207],a[164:167],a[60:63],v[204:207]
M v[204:207],a[160:163],a[56:59],v[204:207]
M v[208:211],a[160:163],a[64:67],v[208:211]
M v[208:211],a[164:167],a[68:71],v[208:211]
M v[212:215],a[164:167],a[76:79],v[212:215]
M v[212:215],a[160:163],a[72:75],v[212:215]
M v[216:219],a[160:163],a[80:83],v[216:219]
M v[216:219],a[164:167],a[84:87],v[216:219]
s_waitcnt lgkmcnt(2)
M v[220:223],a[164:167],a[92:95],v[220:223]
s_waitcnt vmcnt(17) lgkmcnt(0)
M v[220:223],a[160:163],a[88:91],v[220:223]
s_barrier
M v[252:255],a[168:171],a[88:91],v[252:255]
R a[160:163],v5,0
R a[164:167],v6,0
M v[252:255],a[172:175],a[92:95],v[252:255]
M v[248:251],a[172:175],a[84:87],v[248:251]
M v[248:251],a[168:171],a[80:83],v[248:251]
M v[244:247],a[168:171],a[72:75],v[244:247]
M v[244:247],a[172:175],a[76:79],v[244:247]
M v[240:243],a[172:175],a[68:71],v[240:243]
M v[240:243],a[168:171],a[64:67],v[240:243]
M v[236:239],a[168:171],a[56:59],v[236:239]
M v[236:239],a[172:175],a[60:63],v[236:239]
M v[232:235],a[172:175],a[52:55],v[232:235]
M v[232:235],a[168:171],a[48:51],v[232:235]
M v[228:231],a[168:171],a[40:43],v[228:231]
M v[228:231],a[172:175],a[44:47],v[228:231]
s_waitcnt lgkmcnt(0)
M v[224:227],a[172:175],a[36:39],v[224:227]
M v[224:227],a[168:171],a[32:35],v[224:227]
M a[0:3],a[160:163],a[96:99],a[0:3]
R a[168:171],v5,2048
R a[172:175],v6,2048
M a[0:3],a[164:167],a[100:103],a[0:3]
T a[32:33],v1,32768
T a[34:35],v1,33792
M a[4:7],a[164:167],a[108:111],a[4:7]
SA m0,s24,49152
v_lshrrev_b32 v28, 4, v0
v_and_b32 v29, 7, v0
M a[4:7],a[160:163],a[104:107],a[4:7]
buffer_load_dwordx4 v12, s[48:51], s22 offen offset:0   lds
M a[8:11],a[160:163],a[112:115],a[8:11]
v_xor_b32 v28, v28, v29
v_lshlrev_b32 v28, 4, v28
M a[8:11],a[164:167],a[116:119],a[8:11]
v_lshrrev_b32 v29, 3, v0
v_mul_u32_u24 v29, 896, v29
M a[12:15],a[164:167],a[124:127],a[12:15]
T a[36:37],v1,40960
T a[38:39],v1,41984
M a[12:15],a[160:163],a[120:123],a[12:15]
v_add_u32 v22, v28, v29
v_xor_b32 v28, 64, v28
M a[16:19],a[160:163],a[128:131],a[16:19]
s_mul_i32 s64, s20, 14336
buffer_load_dwordx4 v13, s[48:51], s22 offen offset:1024   lds
M a[16:19],a[164:167],a[132:135],a[16:19]
s_sub_u32 s65, 98304, s64
M a[20:23],a[164:167],a[140:143],a[20:23]
SA s30,s29,s65
M a[20:23],a[160:163],a[136:139],a[20:23]
SA s29,s29,s64
T a[40:41],v2,32768
T a[42:43],v2,33792
M a[24:27],a[160:163],a[144:147],a[24:27]
v_add_u32 v29, 6144, v29
v_add_u32 v23, v28, v29
M a[24:27],a[164:167],a[148:151],a[24:27]
s_waitcnt lgkmcnt(6)
buffer_load_dwordx4 v14, s[48:51], s22 offen offset:2048   lds
M a[28:31],a[164:167],a[156:159],a[28:31]
s_and_b32 s64, s20, 1
M a[28:31],a[160:163],a[152:155],a[28:31]
s_lshl_b32 s64, s64, 12
M v[60:63],a[168:171],a[152:155],v[60:63]
SA s64,s64,65536
R a[160:163],v5,4096
R a[164:167],v6,4096
M v[60:63],a[172:175],a[156:159],v[60:63]
T a[44:45],v2,40960
T a[46:47],v2,41984
M v[56:59],a[172:175],a[148:151],v[56:59]
buffer_load_dwordx4 v15, s[48:51], s22 offen offset:3072   lds
M v[56:59],a[168:171],a[144:147],v[56:59]
s_sub_u32 s22, s22, 1048448
v_add_u32 v20, s64, v5
v_add_u32 v21, s64, v6
M v[52:55],a[168:171],a[136:139],v[52:55]
M v[52:55],a[172:175],a[140:143],v[52:55]
s_nop 0
T a[48:49],v3,32768
T a[50:51],v3,33792
M v[48:51],a[172:175],a[132:135],v[48:51]
SA m0,s23,16384
M v[48:51],a[168:171],a[128:131],v[48:51]
buffer_load_dwordx4 v8, s[16:19], s21 offen offset:0  nt lds
M v[44:47],a[168:171],a[120:123],v[44:47]
M v[44:47],a[172:175],a[124:127],v[44:47]
M v[40:43],a[172:175],a[116:119],v[40:43]
s_nop 0
T a[52:53],v3,40960
T a[54:55],v3,41984
M v[40:43],a[168:171],a[112:115],v[40:43]
M v[36:39],a[168:171],a[104:107],v[36:39]
buffer_load_dwordx4 v9, s[16:19], s21 offen offset:1024  nt lds
M v[36:39],a[172:175],a[108:111],v[36:39]
s_waitcnt lgkmcnt(6)
M v[32:35],a[172:175],a[100:103],v[32:35]
M v[32:35],a[168:171],a[96:99],v[32:35]
s_nop 0
T a[56:57],v4,32768
T a[58:59],v4,33792
M v[64:67],a[160:163],a[96:99],v[64:67]
R a[168:171],v5,6144
R a[172:175],v6,6144
M v[64:67],a[164:167],a[100:103],v[64:67]
buffer_load_dwordx4 v10, s[16:19], s21 offen offset:2048  nt lds
M v[68:71],a[164:167],a[108:111],v[68:71]
M v[68:71],a[160:163],a[104:107],v[68:71]
M v[72:75],a[160:163],a[112:115],v[72:75]
s_nop 0
T a[60:61],v4,40960
T a[62:63],v4,41984
M v[72:75],a[164:167],a[116:119],v[72:75]
M v[76:79],a[164:167],a[124:127],v[76:79]
buffer_load_dwordx4 v11, s[16:19], s21 offen offset:3072  nt lds
M v[76:79],a[160:163],a[120:123],v[76:79]
SA s21,s21,524160
M v[80:83],a[160:163],a[128:131],v[80:83]
M v[80:83],a[164:167],a[132:135],v[80:83]
M v[84:87],a[164:167],a[140:143],v[84:87]
M v[84:87],a[160:163],a[136:139],v[84:87]
M v[88:91],a[160:163],a[144:147],v[88:91]
M v[88:91],a[164:167],a[148:151],v[88:91]
s_waitcnt lgkmcnt(2)
M v[92:95],a[164:167],a[156:159],v[92:95]
s_waitcnt vmcnt(16) lgkmcnt(0)
M v[92:95],a[160:163],a[152:155],v[92:95]
s_barrier
M v[124:127],a[168:171],a[152:155],v[124:127]
R a[160:163],v5,16384
R a[164:167],v6,16384
M v[124:127],a[172:175],a[156:159],v[124:127]
SA m0,s23,131072
M v[120:123],a[172:175],a[148:151],v[120:123]
s_nop 0
T a[64:65],v1,49152
T a[66:67],v1,50176
M v[120:123],a[168:171],a[144:147],v[120:123]
buffer_load_dwordx4 v22, s[56:59], s29 offen offset:0 lds
M v[116:119],a[168:171],a[136:139],v[116:119]
M v[116:119],a[172:175],a[140:143],v[116:119]
M v[112:115],a[172:175],a[132:135],v[112:115]
buffer_load_dwordx4 v23, s[56:59], s29 offen offset:1024 lds
M v[112:115],a[168:171],a[128:131],v[112:115]
M v[108:111],a[168:171],a[120:123],v[108:111]
M v[108:111],a[172:175],a[124:127],v[108:111]
s_nop 0
T a[68:69],v1,57344
T a[70:71],v1,58368
M v[104:107],a[172:175],a[116:119],v[104:107]
buffer_load_dwordx4 v22, s[56:59], s30 offen offset:2048 lds
M v[104:107],a[168:171],a[112:115],v[104:107]
M v[100:103],a[168:171],a[104:107],v[100:103]
M v[100:103],a[172:175],a[108:111],v[100:103]
s_waitcnt lgkmcnt(4)
M v[96:99],a[172:175],a[100:103],v[96:99]
M v[96:99],a[168:171],a[96:99],v[96:99]
buffer_load_dwordx4 v23, s[56:59], s30 offen offset:3072 lds
M v[128:131],a[160:163],a[96:99],v[128:131]
R a[168:171],v5,18432
R a[172:175],v6,18432
M v[128:131],a[164:167],a[100:103],v[128:131]
SA s29,s29,128
T a[72:73],v2,49152
T a[74:75],v2,50176
M v[132:135],a[164:167],a[108:111],v[132:135]
SA s30,s30,128
M v[132:135],a[160:163],a[104:107],v[132:135]
SA m0,s24,0
M v[136:139],a[160:163],a[112:115],v[136:139]
buffer_load_dwordx4 v12, s[48:51], s22 offen offset:0   lds
M v[136:139],a[164:167],a[116:119],v[136:139]
M v[140:143],a[164:167],a[124:127],v[140:143]
M v[140:143],a[160:163],a[120:123],v[140:143]
s_nop 0
T a[76:77],v2,57344
T a[78:79],v2,58368
M v[144:147],a[160:163],a[128:131],v[144:147]
buffer_load_dwordx4 v13, s[48:51], s22 offen offset:1024   lds
M v[144:147],a[164:167],a[132:135],v[144:147]
M v[148:151],a[164:167],a[140:143],v[148:151]
M v[148:151],a[160:163],a[136:139],v[148:151]
M v[152:155],a[160:163],a[144:147],v[152:155]
M v[152:155],a[164:167],a[148:151],v[152:155]
s_waitcnt lgkmcnt(4)
buffer_load_dwordx4 v14, s[48:51], s22 offen offset:2048   lds
M v[156:159],a[164:167],a[156:159],v[156:159]
s_nop 0
T a[80:81],v3,49152
T a[82:83],v3,50176
M v[156:159],a[160:163],a[152:155],v[156:159]
M v[188:191],a[168:171],a[152:155],v[188:191]
R a[160:163],v5,20480
R a[164:167],v6,20480
M v[188:191],a[172:175],a[156:159],v[188:191]
M v[184:187],a[172:175],a[148:151],v[184:187]
buffer_load_dwordx4 v15, s[48:51], s22 offen offset:3072   lds
M v[184:187],a[168:171],a[144:147],v[184:187]
M v[180:183],a[168:171],a[136:139],v[180:183]
M v[180:183],a[172:175],a[140:143],v[180:183]
SA s22,s22,1048576
T a[84:85],v3,57344
T a[86:87],v3,58368
M v[176:179],a[172:175],a[132:135],v[176:179]
SA m0,s23,32768
M v[176:179],a[168:171],a[128:131],v[176:179]
buffer_load_dwordx4 v8, s[16:19], s21 offen offset:0  nt lds
M v[172:175],a[168:171],a[120:123],v[172:175]
M v[172:175],a[172:175],a[124:127],v[172:175]
M v[168:171],a[172:175],a[116:119],v[168:171]
M v[168:171],a[168:171],a[112:115],v[168:171]
buffer_load_dwordx4 v9, s[16:19], s21 offen offset:1024  nt lds
M v[164:167],a[168:171],a[104:107],v[164:167]
s_nop 0
T a[88:89],v4,49152
T a[90:91],v4,50176
M v[164:167],a[172:175],a[108:111],v[164:167]
s_waitcnt lgkmcnt(4)
M v[160:163],a[172:175],a[100:103],v[160:163]
M v[160:163],a[168:171],a[96:99],v[160:163]
M v[192:195],a[160:163],a[96:99],v[192:195]
R a[168:171],v5,22528
R a[172:175],v6,22528
M v[192:195],a[164:167],a[100:103],v[192:195]
buffer_load_dwordx4 v10, s[16:19], s21 offen offset:2048  nt lds
M v[196:199],a[164:167],a[108:111],v[196:199]
M v[196:199],a[160:163],a[104:107],v[196:199]
s_nop 0
T a[92:93],v4,57344
T a[94:95],v4,58368
M v[200:203],a[160:163],a[112:115],v[200:203]
M v[200:203],a[164:167],a[116:119],v[200:203]
buffer_load_dwordx4 v11, s[16:19], s21 offen offset:3072  nt lds
M v[204:207],a[164:167],a[124:127],v[204:207]
M v[204:207],a[160:163],a[120:123],v[204:207]
M v[208:211],a[160:163],a[128:131],v[208:211]
M v[208:211],a[164:167],a[132:135],v[208:211]
M v[212:215],a[164:167],a[140:143],v[212:215]
SA s21,s21,128
M v[212:215],a[160:163],a[136:139],v[212:215]
M v[216:219],a[160:163],a[144:147],v[216:219]
M v[216:219],a[164:167],a[148:151],v[216:219]
s_waitcnt lgkmcnt(2)
M v[220:223],a[164:167],a[156:159],v[220:223]
s_waitcnt vmcnt(20) lgkmcnt(0)
M v[220:223],a[160:163],a[152:155],v[220:223]
s_barrier
M v[252:255],a[168:171],a[152:155],v[252:255]
R a[160:163],v5,32768
R a[164:167],v6,32768
M v[252:255],a[172:175],a[156:159],v[252:255]
M v[248:251],a[172:175],a[148:151],v[248:251]
M v[248:251],a[168:171],a[144:147],v[248:251]
M v[244:247],a[168:171],a[136:139],v[244:247]
M v[244:247],a[172:175],a[140:143],v[244:247]
M v[240:243],a[172:175],a[132:135],v[240:243]
M v[240:243],a[168:171],a[128:131],v[240:243]
M v[236:239],a[168:171],a[120:123],v[236:239]
M v[236:239],a[172:175],a[124:127],v[236:239]
M v[232:235],a[172:175],a[116:119],v[232:235]
M v[232:235],a[168:171],a[112:115],v[232:235]
M v[228:231],a[168:171],a[104:107],v[228:231]
M v[228:231],a[172:175],a[108:111],v[228:231]
s_waitcnt lgkmcnt(0)
M v[224:227],a[172:175],a[100:103],v[224:227]
M v[224:227],a[168:171],a[96:99],v[224:227]
M a[0:3],a[160:163],a[32:35],a[0:3]
R a[168:171],v5,34816
R a[172:175],v6,34816
M a[0:3],a[164:167],a[36:39],a[0:3]
SA m0,s23,147456
T a[96:97],v1,0
T a[98:99],v1,1024
M a[4:7],a[164:167],a[44:47],a[4:7]
buffer_load_dwordx4 v22, s[56:59], s29 offen offset:0 lds
M a[4:7],a[160:163],a[40:43],a[4:7]
M a[8:11],a[160:163],a[48:51],a[8:11]
M a[8:11],a[164:167],a[52:55],a[8:11]
buffer_load_dwordx4 v23, s[56:59], s29 offen offset:1024 lds
M a[12:15],a[164:167],a[60:63],a[12:15]
s_nop 0
T a[100:101],v1,8192
T a[102:103],v1,9216
M a[12:15],a[160:163],a[56:59],a[12:15]
M a[16:19],a[160:163],a[64:67],a[16:19]
buffer_load_dwordx4 v22, s[56:59], s30 offen offset:2048 lds
M a[16:19],a[164:167],a[68:71],a[16:19]
M a[20:23],a[164:167],a[76:79],a[20:23]
M a[20:23],a[160:163],a[72:75],a[20:23]
s_nop 0
T a[104:105],v2,0
T a[106:107],v2,1024
M a[24:27],a[160:163],a[80:83],a[24:27]
buffer_load_dwordx4 v23, s[56:59], s30 offen offset:3072 lds
M a[24:27],a[164:167],a[84:87],a[24:27]
s_waitcnt lgkmcnt(6)
M a[28:31],a[164:167],a[92:95],a[28:31]
SA s29,s29,128
M a[28:31],a[160:163],a[88:91],a[28:31]
SA s30,s30,128
M v[60:63],a[168:171],a[88:91],v[60:63]
SA m0,s24,16384
R a[160:163],v5,36864
R a[164:167],v6,36864
M v[60:63],a[172:175],a[92:95],v[60:63]
T a[108:109],v2,8192
T a[110:111],v2,9216
M v[56:59],a[172:175],a[84:87],v[56:59]
buffer_load_dwordx4 v12, s[48:51], s22 offen offset:0   lds
M v[56:59],a[168:171],a[80:83],v[56:59]
M v[52:55],a[168:171],a[72:75],v[52:55]
M v[52:55],a[172:175],a[76:79],v[52:55]
s_nop 0
T a[112:113],v3,0
T a[114:115],v3,1024
M v[48:51],a[172:175],a[68:71],v[48:51]
buffer_load_dwordx4 v13, s[48:51], s22 offen offset:1024   lds
M v[48:51],a[168:171],a[64:67],v[48:51]
M v[44:47],a[168:171],a[56:59],v[44:47]
M v[44:47],a[172:175],a[60:63],v[44:47]
buffer_load_dwordx4 v14, s[48:51], s22 offen offset:2048   lds
M v[40:43],a[172:175],a[52:55],v[40:43]
s_nop 0
T a[116:117],v3,8192
T a[118:119],v3,9216
L_w_kv16:
s_cbranch_execz L_wd2
M v[40:43],a[168:171],a[48:51],v[40:43]
M v[36:39],a[168:171],a[40:43],v[36:39]
buffer_load_dwordx4 v15, s[48:51], s22 offen offset:3072   lds
M v[36:39],a[172:175],a[44:47],v[36:39]
s_waitcnt lgkmcnt(6)
M v[32:35],a[172:175],a[36:39],v[32:35]
s_sub_u32 s22, s22, 1048448
M v[32:35],a[168:171],a[32:35],v[32:35]
SA m0,s23,49152
T a[120:121],v4,0
T a[122:123],v4,1024
M v[64:67],a[160:163],a[32:35],v[64:67]
R a[168:171],v5,38912
R a[172:175],v6,38912
M v[64:67],a[164:167],a[36:39],v[64:67]
buffer_load_dwordx4 v8, s[16:19], s21 offen offset:0  nt lds
M v[68:71],a[164:167],a[44:47],v[68:71]
M v[68:71],a[160:163],a[40:43],v[68:71]
M v[72:75],a[160:163],a[48:51],v[72:75]
s_waitcnt vmcnt(17)
s_nop 0
T a[124:125],v4,8192
T a[126:127],v4,9216
M v[72:75],a[164:167],a[52:55],v[72:75]
buffer_load_dwordx4 v9, s[16:19], s21 offen offset:1024  nt lds
M v[76:79],a[164:167],a[60:63],v[76:79]
R a[176:179],v20,0
R a[180:183],v20,2048
M v[76:79],a[160:163],a[56:59],v[76:79]
R a[184:187],v21,0
R a[188:191],v21,2048
M v[80:83],a[160:163],a[64:67],v[80:83]
buffer_load_dwordx4 v10, s[16:19], s21 offen offset:2048  nt lds
M v[80:83],a[164:167],a[68:71],v[80:83]
M v[84:87],a[164:167],a[76:79],v[84:87]
M v[84:87],a[160:163],a[72:75],v[84:87]
buffer_load_dwordx4 v11, s[16:19], s21 offen offset:3072  nt lds
M v[88:91],a[160:163],a[80:83],v[88:91]
SA s21,s21,524160
M v[88:91],a[164:167],a[84:87],v[88:91]
s_waitcnt lgkmcnt(6)
M v[92:95],a[164:167],a[92:95],v[92:95]
s_waitcnt lgkmcnt(0)
M v[92:95],a[160:163],a[88:91],v[92:95]
s_barrier
M v[124:127],a[168:171],a[88:91],v[124:127]
s_lshl_b32 s4, s20, 10
R a[160:163],v5,49152
R a[164:167],v6,49152
M v[124:127],a[172:175],a[92:95],v[124:127]
SA m0,s23,131072
v_bfe_u32 v28, v0, 3, 2
M v[120:123],a[172:175],a[84:87],v[120:123]
s_nop 0
T a[128:129],v1,16384
T a[130:131],v1,17408
M v[120:123],a[168:171],a[80:83],v[120:123]
buffer_load_dwordx4 v22, s[56:59], s29 offen offset:0 lds
M v[116:119],a[168:171],a[72:75],v[116:119]
v_lshrrev_b32 v29, 5, v0
v_lshl_add_u32 v28, v29, 3, v28
M v[116:119],a[172:175],a[76:79],v[116:119]
M v[112:115],a[172:175],a[68:71],v[112:115]
v_lshlrev_b32 v28, 13, v28
M v[112:115],a[168:171],a[64:67],v[112:115]
M v[108:111],a[168:171],a[56:59],v[108:111]
buffer_load_dwordx4 v23, s[56:59], s29 offen offset:1024 lds
M v[108:111],a[172:175],a[60:63],v[108:111]
s_nop 0
T a[132:133],v1,24576
T a[134:135],v1,25600
M v[104:107],a[172:175],a[52:55],v[104:107]
v_lshrrev_b32 v29, 4, v0
v_lshlrev_b32 v29, 1, v29
M v[104:107],a[168:171],a[48:51],v[104:107]
M v[100:103],a[168:171],a[40:43],v[100:103]
v_and_b32 v30, 7, v0
M v[100:103],a[172:175],a[44:47],v[100:103]
s_waitcnt lgkmcnt(4)
M v[96:99],a[172:175],a[36:39],v[96:99]
v_xor_b32 v29, v29, v30
M v[96:99],a[168:171],a[32:35],v[96:99]
buffer_load_dwordx4 v22, s[56:59], s30 offen offset:2048 lds
M v[128:131],a[160:163],a[32:35],v[128:131]
R a[168:171],v5,51200
R a[172:175],v6,51200
M v[128:131],a[164:167],a[36:39],v[128:131]
T a[136:137],v2,16384
T a[138:139],v2,17408
M v[132:135],a[164:167],a[44:47],v[132:135]
v_lshl_add_u32 v28, v29, 4, v28
M v[132:135],a[160:163],a[40:43],v[132:135]
s_and_b32 s64, s20, 1
M v[136:139],a[160:163],a[48:51],v[136:139]
s_lshl_b32 s64, s64, 17
M v[136:139],a[164:167],a[52:55],v[136:139]
s_lshr_b32 s65, s20, 1
M v[140:143],a[164:167],a[60:63],v[140:143]
s_lshl_b32 s65, s65, 15
SA s64,s64,s65
v_add_u32 v8, s64, v28
M v[140:143],a[160:163],a[56:59],v[140:143]
s_nop 0
T a[140:141],v2,24576
T a[142:143],v2,25600
M v[144:147],a[160:163],a[64:67],v[144:147]
buffer_load_dwordx4 v23, s[56:59], s30 offen offset:3072 lds
M v[144:147],a[164:167],a[68:71],v[144:147]
M v[148:151],a[164:167],a[76:79],v[148:151]
SA s29,s29,128
M v[148:151],a[160:163],a[72:75],v[148:151]
SA s30,s30,128
M v[152:155],a[160:163],a[80:83],v[152:155]
SA m0,s24,32768
M v[152:155],a[164:167],a[84:87],v[152:155]
s_waitcnt lgkmcnt(4)
buffer_load_dwordx4 v12, s[48:51], s22 offen offset:0   lds
M v[156:159],a[164:167],a[92:95],v[156:159]
s_nop 0
T a[144:145],v3,16384
T a[146:147],v3,17408
M v[156:159],a[160:163],a[88:91],v[156:159]
M v[188:191],a[168:171],a[88:91],v[188:191]
R a[160:163],v5,53248
R a[164:167],v6,53248
M v[188:191],a[172:175],a[92:95],v[188:191]
M v[184:187],a[172:175],a[84:87],v[184:187]
M v[184:187],a[168:171],a[80:83],v[184:187]
M v[180:183],a[168:171],a[72:75],v[180:183]
buffer_load_dwordx4 v13, s[48:51], s22 offen offset:1024   lds
M v[180:183],a[172:175],a[76:79],v[180:183]
s_nop 0
T a[148:149],v3,24576
T a[150:151],v3,25600
M v[176:179],a[172:175],a[68:71],v[176:179]
M v[176:179],a[168:171],a[64:67],v[176:179]
M v[172:175],a[168:171],a[56:59],v[172:175]
M v[172:175],a[172:175],a[60:63],v[172:175]
M v[168:171],a[172:175],a[52:55],v[168:171]
M v[168:171],a[168:171],a[48:51],v[168:171]
buffer_load_dwordx4 v14, s[48:51], s22 offen offset:2048   lds
M v[164:167],a[168:171],a[40:43],v[164:167]
s_nop 0
T a[152:153],v4,16384
T a[154:155],v4,17408
M v[164:167],a[172:175],a[44:47],v[164:167]
s_waitcnt lgkmcnt(4)
M v[160:163],a[172:175],a[36:39],v[160:163]
M v[160:163],a[168:171],a[32:35],v[160:163]
M v[192:195],a[160:163],a[32:35],v[192:195]
R a[168:171],v5,55296
R a[172:175],v6,55296
M v[192:195],a[164:167],a[36:39],v[192:195]
M v[196:199],a[164:167],a[44:47],v[196:199]
buffer_load_dwordx4 v15, s[48:51], s22 offen offset:3072   lds
M v[196:199],a[160:163],a[40:43],v[196:199]
s_nop 0
T a[156:157],v4,24576
T a[158:159],v4,25600
M v[200:203],a[160:163],a[48:51],v[200:203]
s_waitcnt vmcnt(16)
R a[192:195],v20,16384
R a[196:199],v20,18432
M v[200:203],a[164:167],a[52:55],v[200:203]
R a[200:203],v21,16384
R a[204:207],v21,18432
M v[204:207],a[164:167],a[60:63],v[204:207]
M v[204:207],a[160:163],a[56:59],v[204:207]
M v[208:211],a[160:163],a[64:67],v[208:211]
M v[208:211],a[164:167],a[68:71],v[208:211]
M v[212:215],a[164:167],a[76:79],v[212:215]
SA s22,s22,1048576
M v[212:215],a[160:163],a[72:75],v[212:215]
M v[216:219],a[160:163],a[80:83],v[216:219]
M v[216:219],a[164:167],a[84:87],v[216:219]
s_waitcnt lgkmcnt(6)
M v[220:223],a[164:167],a[92:95],v[220:223]
s_waitcnt lgkmcnt(0)
M v[220:223],a[160:163],a[88:91],v[220:223]
s_barrier
M v[252:255],a[168:171],a[88:91],v[252:255]
R a[160:163],v5,0
R a[164:167],v6,0
M v[252:255],a[172:175],a[92:95],v[252:255]
M v[248:251],a[172:175],a[84:87],v[248:251]
M v[248:251],a[168:171],a[80:83],v[248:251]
M v[244:247],a[168:171],a[72:75],v[244:247]
M v[244:247],a[172:175],a[76:79],v[244:247]
M v[240:243],a[172:175],a[68:71],v[240:243]
M v[240:243],a[168:171],a[64:67],v[240:243]
M v[236:239],a[168:171],a[56:59],v[236:239]
M v[236:239],a[172:175],a[60:63],v[236:239]
M v[232:235],a[172:175],a[52:55],v[232:235]
M v[232:235],a[168:171],a[48:51],v[232:235]
M v[228:231],a[168:171],a[40:43],v[228:231]
M v[228:231],a[172:175],a[44:47],v[228:231]
s_waitcnt lgkmcnt(0)
M v[224:227],a[172:175],a[36:39],v[224:227]
M v[224:227],a[168:171],a[32:35],v[224:227]
M a[0:3],a[160:163],a[96:99],a[0:3]
R a[168:171],v5,2048
R a[172:175],v6,2048
M a[0:3],a[164:167],a[100:103],a[0:3]
SA m0,s23,147456
T a[32:33],v1,32768
T a[34:35],v1,33792
M a[4:7],a[164:167],a[108:111],a[4:7]
buffer_load_dwordx4 v22, s[56:59], s29 offen offset:0 lds
M a[4:7],a[160:163],a[104:107],a[4:7]
M a[8:11],a[160:163],a[112:115],a[8:11]
M a[8:11],a[164:167],a[116:119],a[8:11]
buffer_load_dwordx4 v23, s[56:59], s29 offen offset:1024 lds
M a[12:15],a[164:167],a[124:127],a[12:15]
s_nop 0
T a[36:37],v1,40960
T a[38:39],v1,41984
M a[12:15],a[160:163],a[120:123],a[12:15]
M a[16:19],a[160:163],a[128:131],a[16:19]
buffer_load_dwordx4 v22, s[56:59], s30 offen offset:2048 lds
M a[16:19],a[164:167],a[132:135],a[16:19]
M a[20:23],a[164:167],a[140:143],a[20:23]
M a[20:23],a[160:163],a[136:139],a[20:23]
s_nop 0
T a[40:41],v2,32768
T a[42:43],v2,33792
M a[24:27],a[160:163],a[144:147],a[24:27]
buffer_load_dwordx4 v23, s[56:59], s30 offen offset:3072 lds
M a[24:27],a[164:167],a[148:151],a[24:27]
s_waitcnt lgkmcnt(6)
M a[28:31],a[164:167],a[156:159],a[28:31]
SA s29,s29,128
M a[28:31],a[160:163],a[152:155],a[28:31]
SA s30,s30,128
M v[60:63],a[168:171],a[152:155],v[60:63]
SA m0,s24,49152
R a[160:163],v5,4096
R a[164:167],v6,4096
M v[60:63],a[172:175],a[156:159],v[60:63]
T a[44:45],v2,40960
T a[46:47],v2,41984
M v[56:59],a[172:175],a[148:151],v[56:59]
buffer_load_dwordx4 v12, s[48:51], s22 offen offset:0   lds
M v[56:59],a[168:171],a[144:147],v[56:59]
M v[52:55],a[168:171],a[136:139],v[52:55]
M v[52:55],a[172:175],a[140:143],v[52:55]
s_nop 0
T a[48:49],v3,32768
T a[50:51],v3,33792
M v[48:51],a[172:175],a[132:135],v[48:51]
buffer_load_dwordx4 v13, s[48:51], s22 offen offset:1024   lds
M v[48:51],a[168:171],a[128:131],v[48:51]
M v[44:47],a[168:171],a[120:123],v[44:47]
M v[44:47],a[172:175],a[124:127],v[44:47]
buffer_load_dwordx4 v14, s[48:51], s22 offen offset:2048   lds
M v[40:43],a[172:175],a[116:119],v[40:43]
s_nop 0
T a[52:53],v3,40960
T a[54:55],v3,41984
M v[40:43],a[168:171],a[112:115],v[40:43]
M v[36:39],a[168:171],a[104:107],v[36:39]
buffer_load_dwordx4 v15, s[48:51], s22 offen offset:3072   lds
M v[36:39],a[172:175],a[108:111],v[36:39]
s_waitcnt lgkmcnt(6)
M v[32:35],a[172:175],a[100:103],v[32:35]
s_sub_u32 s22, s22, 1048448
M v[32:35],a[168:171],a[96:99],v[32:35]
s_mov_b32 s25, 0
T a[56:57],v4,32768
T a[58:59],v4,33792
M v[64:67],a[160:163],a[96:99],v[64:67]
SA m0,s4,0
R a[168:171],v5,6144
R a[172:175],v6,6144
M v[64:67],a[164:167],a[100:103],v[64:67]
buffer_load_dwordx4 v8, s[52:55], s25 offen lds
M v[68:71],a[164:167],a[108:111],v[68:71]
s_mov_b32 s25, 262144
M v[68:71],a[160:163],a[104:107],v[68:71]
SA m0,s4,4096
M v[72:75],a[160:163],a[112:115],v[72:75]
s_waitcnt vmcnt(13)
s_nop 0
T a[60:61],v4,40960
T a[62:63],v4,41984
M v[72:75],a[164:167],a[116:119],v[72:75]
buffer_load_dwordx4 v8, s[52:55], s25 offen lds
M v[76:79],a[164:167],a[124:127],v[76:79]
s_mov_b32 s25, 524288
R a[208:211],v20,0
R a[212:215],v20,2048
M v[76:79],a[160:163],a[120:123],v[76:79]
SA m0,s4,8192
R a[216:219],v21,0
R a[220:223],v21,2048
M v[80:83],a[160:163],a[128:131],v[80:83]
buffer_load_dwordx4 v8, s[52:55], s25 offen lds
M v[80:83],a[164:167],a[132:135],v[80:83]
s_mov_b32 s25, 786432
M v[84:87],a[164:167],a[140:143],v[84:87]
SA m0,s4,12288
M v[84:87],a[160:163],a[136:139],v[84:87]
buffer_load_dwordx4 v8, s[52:55], s25 offen lds
M v[88:91],a[160:163],a[144:147],v[88:91]
M v[88:91],a[164:167],a[148:151],v[88:91]
s_waitcnt lgkmcnt(6)
M v[92:95],a[164:167],a[156:159],v[92:95]
s_waitcnt lgkmcnt(0)
M v[92:95],a[160:163],a[152:155],v[92:95]
s_barrier
M v[124:127],a[168:171],a[152:155],v[124:127]
R a[160:163],v5,16384
R a[164:167],v6,16384
M v[124:127],a[172:175],a[156:159],v[124:127]
SA m0,s23,32768
M v[120:123],a[172:175],a[148:151],v[120:123]
s_nop 0
T a[64:65],v1,49152
T a[66:67],v1,50176
M v[120:123],a[168:171],a[144:147],v[120:123]
buffer_load_dwordx4 v22, s[56:59], s29 offen offset:0 lds
M v[116:119],a[168:171],a[136:139],v[116:119]
v_lshrrev_b32 v28, 2, v0
v_lshlrev_b32 v28, 7, v28
M v[116:119],a[172:175],a[140:143],v[116:119]
M v[112:115],a[172:175],a[132:135],v[112:115]
buffer_load_dwordx4 v23, s[56:59], s29 offen offset:1024 lds
M v[112:115],a[168:171],a[128:131],v[112:115]
v_and_b32 v29, 3, v0
M v[108:111],a[168:171],a[120:123],v[108:111]
v_lshl_add_u32 v28, v29, 3, v28
M v[108:111],a[172:175],a[124:127],v[108:111]
s_nop 0
T a[68:69],v1,57344
T a[70:71],v1,58368
M v[104:107],a[172:175],a[116:119],v[104:107]
buffer_load_dwordx4 v22, s[56:59], s30 offen offset:2048 lds
M v[104:107],a[168:171],a[112:115],v[104:107]
v_bfe_u32 v29, v0, 3, 2
M v[100:103],a[168:171],a[104:107],v[100:103]
M v[100:103],a[172:175],a[108:111],v[100:103]
s_waitcnt lgkmcnt(4)
v_lshl_add_u32 v16, v29, 5, v28
M v[96:99],a[172:175],a[100:103],v[96:99]
M v[96:99],a[168:171],a[96:99],v[96:99]
buffer_load_dwordx4 v23, s[56:59], s30 offen offset:3072 lds
M v[128:131],a[160:163],a[96:99],v[128:131]
R a[168:171],v5,18432
R a[172:175],v6,18432
M v[128:131],a[164:167],a[100:103],v[128:131]
SA s29,s29,128
T a[72:73],v2,49152
T a[74:75],v2,50176
M v[132:135],a[164:167],a[108:111],v[132:135]
SA s30,s30,128
v_xor_b32 v17, 32, v16
v_xor_b32 v18, 64, v16
M v[132:135],a[160:163],a[104:107],v[132:135]
SA m0,s23,65536
M v[136:139],a[160:163],a[112:115],v[136:139]
buffer_load_dwordx4 v22, s[56:59], s29 offen offset:0 lds
M v[136:139],a[164:167],a[116:119],v[136:139]
v_xor_b32 v19, 0x60, v16
M v[140:143],a[164:167],a[124:127],v[140:143]
v_add_u32 v12, 0x20000, v16
M v[140:143],a[160:163],a[120:123],v[140:143]
s_nop 0
T a[76:77],v2,57344
T a[78:79],v2,58368
M v[144:147],a[160:163],a[128:131],v[144:147]
buffer_load_dwordx4 v23, s[56:59], s29 offen offset:1024 lds
M v[144:147],a[164:167],a[132:135],v[144:147]
v_add_u32 v13, 0x20000, v17
M v[148:151],a[164:167],a[140:143],v[148:151]
M v[148:151],a[160:163],a[136:139],v[148:151]
v_add_u32 v14, 0x20000, v18
M v[152:155],a[160:163],a[144:147],v[152:155]
M v[152:155],a[164:167],a[148:151],v[152:155]
s_waitcnt lgkmcnt(4)
buffer_load_dwordx4 v22, s[56:59], s30 offen offset:2048 lds
M v[156:159],a[164:167],a[156:159],v[156:159]
s_nop 0
T a[80:81],v3,49152
T a[82:83],v3,50176
M v[156:159],a[160:163],a[152:155],v[156:159]
v_add_u32 v15, 0x20000, v19
M v[188:191],a[168:171],a[152:155],v[188:191]
R a[160:163],v5,20480
R a[164:167],v6,20480
M v[188:191],a[172:175],a[156:159],v[188:191]
M v[184:187],a[172:175],a[148:151],v[184:187]
buffer_load_dwordx4 v23, s[56:59], s30 offen offset:3072 lds
M v[184:187],a[168:171],a[144:147],v[184:187]
SA s29,s29,128
M v[180:183],a[168:171],a[136:139],v[180:183]
SA s30,s30,128
M v[180:183],a[172:175],a[140:143],v[180:183]
s_mov_b32 s25, 1048576
T a[84:85],v3,57344
T a[86:87],v3,58368
M v[176:179],a[172:175],a[132:135],v[176:179]
SA m0,s4,16384
M v[176:179],a[168:171],a[128:131],v[176:179]
buffer_load_dwordx4 v8, s[52:55], s25 offen lds
M v[172:175],a[168:171],a[120:123],v[172:175]
M v[172:175],a[172:175],a[124:127],v[172:175]
s_mov_b32 s25, 1310720
M v[168:171],a[172:175],a[116:119],v[168:171]
SA m0,s4,20480
M v[168:171],a[168:171],a[112:115],v[168:171]
buffer_load_dwordx4 v8, s[52:55], s25 offen lds
M v[164:167],a[168:171],a[104:107],v[164:167]
s_nop 0
T a[88:89],v4,49152
T a[90:91],v4,50176
M v[164:167],a[172:175],a[108:111],v[164:167]
s_waitcnt lgkmcnt(4)
M v[160:163],a[172:175],a[100:103],v[160:163]
s_mov_b32 s25, 1572864
M v[160:163],a[168:171],a[96:99],v[160:163]
SA m0,s4,24576
M v[192:195],a[160:163],a[96:99],v[192:195]
R a[168:171],v5,22528
R a[172:175],v6,22528
M v[192:195],a[164:167],a[100:103],v[192:195]
buffer_load_dwordx4 v8, s[52:55], s25 offen lds
M v[196:199],a[164:167],a[108:111],v[196:199]
M v[196:199],a[160:163],a[104:107],v[196:199]
s_mov_b32 s25, 1835008
T a[92:93],v4,57344
T a[94:95],v4,58368
M v[200:203],a[160:163],a[112:115],v[200:203]
SA m0,s4,28672
M v[200:203],a[164:167],a[116:119],v[200:203]
s_waitcnt vmcnt(19)
buffer_load_dwordx4 v8, s[52:55], s25 offen lds
M v[204:207],a[164:167],a[124:127],v[204:207]
R a[224:227],v20,16384
R a[228:231],v20,18432
M v[204:207],a[160:163],a[120:123],v[204:207]
R a[232:235],v21,16384
R a[236:239],v21,18432
M v[208:211],a[160:163],a[128:131],v[208:211]
v_subrev_u32 v20, 98304, v20
v_subrev_u32 v21, 98304, v21
M v[208:211],a[164:167],a[132:135],v[208:211]
M v[212:215],a[164:167],a[140:143],v[212:215]
M v[212:215],a[160:163],a[136:139],v[212:215]
M v[216:219],a[160:163],a[144:147],v[216:219]
M v[216:219],a[164:167],a[148:151],v[216:219]
s_waitcnt lgkmcnt(6)
M v[220:223],a[164:167],a[156:159],v[220:223]
s_waitcnt lgkmcnt(0)
M v[220:223],a[160:163],a[152:155],v[220:223]
s_barrier
M v[252:255],a[168:171],a[152:155],v[252:255]
R a[160:163],v5,32768
R a[164:167],v6,32768
M v[252:255],a[172:175],a[156:159],v[252:255]
M v[248:251],a[172:175],a[148:151],v[248:251]
M v[248:251],a[168:171],a[144:147],v[248:251]
M v[244:247],a[168:171],a[136:139],v[244:247]
M v[244:247],a[172:175],a[140:143],v[244:247]
M v[240:243],a[172:175],a[132:135],v[240:243]
M v[240:243],a[168:171],a[128:131],v[240:243]
M v[236:239],a[168:171],a[120:123],v[236:239]
M v[236:239],a[172:175],a[124:127],v[236:239]
M v[232:235],a[172:175],a[116:119],v[232:235]
M v[232:235],a[168:171],a[112:115],v[232:235]
M v[228:231],a[168:171],a[104:107],v[228:231]
M v[228:231],a[172:175],a[108:111],v[228:231]
s_waitcnt lgkmcnt(0)
M v[224:227],a[172:175],a[100:103],v[224:227]
M v[224:227],a[168:171],a[96:99],v[224:227]
M a[0:3],a[160:163],a[32:35],a[0:3]
R a[168:171],v5,34816
R a[172:175],v6,34816
M a[0:3],a[164:167],a[36:39],a[0:3]
SA m0,s23,81920
M a[4:7],a[164:167],a[44:47],a[4:7]
buffer_load_dwordx4 v22, s[56:59], s29 offen offset:0 lds
M a[4:7],a[160:163],a[40:43],a[4:7]
M a[8:11],a[160:163],a[48:51],a[8:11]
M a[8:11],a[164:167],a[52:55],a[8:11]
buffer_load_dwordx4 v23, s[56:59], s29 offen offset:1024 lds
M a[12:15],a[164:167],a[60:63],a[12:15]
M a[12:15],a[160:163],a[56:59],a[12:15]
M a[16:19],a[160:163],a[64:67],a[16:19]
M a[16:19],a[164:167],a[68:71],a[16:19]
buffer_load_dwordx4 v22, s[56:59], s30 offen offset:2048 lds
M a[20:23],a[164:167],a[76:79],a[20:23]
M a[20:23],a[160:163],a[72:75],a[20:23]
M a[24:27],a[160:163],a[80:83],a[24:27]
M a[24:27],a[164:167],a[84:87],a[24:27]
s_waitcnt lgkmcnt(0)
buffer_load_dwordx4 v23, s[56:59], s30 offen offset:3072 lds
M a[28:31],a[164:167],a[92:95],a[28:31]
SA s29,s29,128
M a[28:31],a[160:163],a[88:91],a[28:31]
SA s30,s30,128
M v[32:35],a[168:171],a[32:35],v[32:35]
s_mov_b32 s25, 2097152
R a[160:163],v5,36864
R a[164:167],v6,36864
M v[32:35],a[172:175],a[36:39],v[32:35]
SA m0,s4,131072
M v[36:39],a[172:175],a[44:47],v[36:39]
buffer_load_dwordx4 v8, s[52:55], s25 offen lds
M v[36:39],a[168:171],a[40:43],v[36:39]
s_mov_b32 s25, 2359296
M v[40:43],a[168:171],a[48:51],v[40:43]
SA m0,s4,135168
M v[40:43],a[172:175],a[52:55],v[40:43]
buffer_load_dwordx4 v8, s[52:55], s25 offen lds
M v[44:47],a[172:175],a[60:63],v[44:47]
G v24,a0
G v25,a1
M v[44:47],a[168:171],a[56:59],v[44:47]
s_mov_b32 s25, 2621440
G v26,a2
G v27,a3
M v[48:51],a[168:171],a[64:67],v[48:51]
SA m0,s4,139264
C v24,v24,v25
C v25,v26,v27
M v[48:51],a[172:175],a[68:71],v[48:51]
buffer_load_dwordx4 v8, s[52:55], s25 offen lds
M v[52:55],a[172:175],a[76:79],v[52:55]
C v26,v32,v33
C v27,v34,v35
M v[52:55],a[168:171],a[72:75],v[52:55]
SA s3,s93,0
M v[56:59],a[168:171],a[80:83],v[56:59]
s_mov_b32 s25, 2883584
buffer_store_dwordx4 v[24:27], v7, s[8:11], s3 offen offset:0 sc1
M v[56:59],a[172:175],a[84:87],v[56:59]
s_waitcnt lgkmcnt(0)
G v28,a4
G v29,a5
M v[60:63],a[172:175],a[92:95],v[60:63]
SA m0,s4,143360
G v30,a6
G v31,a7
M v[60:63],a[168:171],a[88:91],v[60:63]
s_waitcnt vmcnt(16)
buffer_load_dwordx4 v8, s[52:55], s25 offen lds
M v[64:67],a[160:163],a[32:35],v[64:67]
L_w_kv17:
s_cbranch_execz L_wd2
s_mov_b32 s25, 3145728
R a[168:171],v5,38912
R a[172:175],v6,38912
M v[64:67],a[164:167],a[36:39],v[64:67]
SA m0,s4,147456
C v28,v28,v29
C v29,v30,v31
M v[68:71],a[164:167],a[44:47],v[68:71]
buffer_load_dwordx4 v8, s[52:55], s25 offen lds
M v[68:71],a[160:163],a[40:43],v[68:71]
s_mov_b32 s25, 3407872
C v30,v36,v37
C v31,v38,v39
M v[72:75],a[160:163],a[48:51],v[72:75]
SA m0,s4,151552
buffer_store_dwordx4 v[28:31], v7, s[8:11], s3 offen offset:2048 sc1
M v[72:75],a[164:167],a[52:55],v[72:75]
G v24,a8
G v25,a9
M v[76:79],a[164:167],a[60:63],v[76:79]
G v26,a10
G v27,a11
M v[76:79],a[160:163],a[56:59],v[76:79]
buffer_load_dwordx4 v8, s[52:55], s25 offen lds
M v[80:83],a[160:163],a[64:67],v[80:83]
C v24,v24,v25
C v25,v26,v27
M v[80:83],a[164:167],a[68:71],v[80:83]
C v26,v40,v41
C v27,v42,v43
M v[84:87],a[164:167],a[76:79],v[84:87]
SA s3,s93,4096
buffer_store_dwordx4 v[24:27], v7, s[8:11], s3 offen offset:0 sc1
M v[84:87],a[160:163],a[72:75],v[84:87]
R a[96:99],v20,0
R a[100:103],v20,2048
M v[88:91],a[160:163],a[80:83],v[88:91]
R a[104:107],v21,0
R a[108:111],v21,2048
M v[88:91],a[164:167],a[84:87],v[88:91]
s_waitcnt lgkmcnt(4)
G v28,a12
G v29,a13
M v[92:95],a[164:167],a[92:95],v[92:95]
s_waitcnt lgkmcnt(0)
G v30,a14
G v31,a15
M v[92:95],a[160:163],a[88:91],v[92:95]
s_barrier
M v[96:99],a[168:171],a[32:35],v[96:99]
R a[160:163],v5,49152
R a[164:167],v6,49152
M v[96:99],a[172:175],a[36:39],v[96:99]
s_mov_b32 s25, 128
C v28,v28,v29
C v29,v30,v31
M v[100:103],a[172:175],a[44:47],v[100:103]
SA m0,s4,49152
C v30,v44,v45
C v31,v46,v47
M v[100:103],a[168:171],a[40:43],v[100:103]
s_waitcnt vmcnt(17)
buffer_store_dwordx4 v[28:31], v7, s[8:11], s3 offen offset:2048 sc1
M v[104:107],a[168:171],a[48:51],v[104:107]
G v24,a16
G v25,a17
M v[104:107],a[172:175],a[52:55],v[104:107]
G v26,a18
G v27,a19
M v[108:111],a[172:175],a[60:63],v[108:111]
buffer_load_dwordx4 v8, s[52:55], s25 offen lds
M v[108:111],a[168:171],a[56:59],v[108:111]
C v24,v24,v25
C v25,v26,v27
M v[112:115],a[168:171],a[64:67],v[112:115]
C v26,v48,v49
C v27,v50,v51
M v[112:115],a[172:175],a[68:71],v[112:115]
SA s3,s93,8192
buffer_store_dwordx4 v[24:27], v7, s[8:11], s3 offen offset:0 sc1
M v[116:119],a[172:175],a[76:79],v[116:119]
s_mov_b32 s25, 262272
R a[112:115],v20,32768
R a[116:119],v20,34816
M v[116:119],a[168:171],a[72:75],v[116:119]
SA m0,s4,53248
R a[120:123],v21,32768
R a[124:127],v21,34816
M v[120:123],a[168:171],a[80:83],v[120:123]
C v64,v64,v65
C v65,v66,v67
M v[120:123],a[172:175],a[84:87],v[120:123]
s_waitcnt lgkmcnt(4)
buffer_load_dwordx4 v8, s[52:55], s25 offen lds
M v[124:127],a[172:175],a[92:95],v[124:127]
C v66,v96,v97
C v67,v98,v99
M v[124:127],a[168:171],a[88:91],v[124:127]
G v28,a20
G v29,a21
M v[128:131],a[160:163],a[32:35],v[128:131]
R a[168:171],v5,51200
R a[172:175],v6,51200
M v[128:131],a[164:167],a[36:39],v[128:131]
G v30,a22
G v31,a23
M v[132:135],a[164:167],a[44:47],v[132:135]
C v28,v28,v29
C v29,v30,v31
M v[132:135],a[160:163],a[40:43],v[132:135]
s_mov_b32 s25, 524416
C v30,v52,v53
C v31,v54,v55
M v[136:139],a[160:163],a[48:51],v[136:139]
SA m0,s4,57344
buffer_store_dwordx4 v[28:31], v7, s[8:11], s3 offen offset:2048 sc1
M v[136:139],a[164:167],a[52:55],v[136:139]
C v68,v68,v69
C v69,v70,v71
M v[140:143],a[164:167],a[60:63],v[140:143]
C v70,v100,v101
C v71,v102,v103
M v[140:143],a[160:163],a[56:59],v[140:143]
C v72,v72,v73
C v73,v74,v75
M v[144:147],a[160:163],a[64:67],v[144:147]
buffer_load_dwordx4 v8, s[52:55], s25 offen lds
M v[144:147],a[164:167],a[68:71],v[144:147]
C v74,v104,v105
C v75,v106,v107
M v[148:151],a[164:167],a[76:79],v[148:151]
C v76,v76,v77
C v77,v78,v79
M v[148:151],a[160:163],a[72:75],v[148:151]
C v78,v108,v109
C v79,v110,v111
M v[152:155],a[160:163],a[80:83],v[152:155]
C v80,v80,v81
C v81,v82,v83
M v[152:155],a[164:167],a[84:87],v[152:155]
s_waitcnt lgkmcnt(0)
C v82,v112,v113
C v83,v114,v115
M v[156:159],a[164:167],a[92:95],v[156:159]
s_mov_b32 s25, 786560
C v84,v84,v85
C v85,v86,v87
M v[156:159],a[160:163],a[88:91],v[156:159]
SA m0,s4,61440
C v86,v116,v117
C v87,v118,v119
M v[160:163],a[168:171],a[32:35],v[160:163]
R a[160:163],v5,53248
R a[164:167],v6,53248
M v[160:163],a[172:175],a[36:39],v[160:163]
buffer_load_dwordx4 v8, s[52:55], s25 offen lds
M v[164:167],a[172:175],a[44:47],v[164:167]
G v24,a24
G v25,a25
M v[164:167],a[168:171],a[40:43],v[164:167]
G v26,a26
G v27,a27
M v[168:171],a[168:171],a[48:51],v[168:171]
C v24,v24,v25
C v25,v26,v27
M v[168:171],a[172:175],a[52:55],v[168:171]
C v26,v56,v57
C v27,v58,v59
M v[172:175],a[172:175],a[60:63],v[172:175]
SA s3,s93,12288
buffer_store_dwordx4 v[24:27], v7, s[8:11], s3 offen offset:0 sc1
M v[172:175],a[168:171],a[56:59],v[172:175]
C v88,v88,v89
C v89,v90,v91
M v[176:179],a[168:171],a[64:67],v[176:179]
C v90,v120,v121
C v91,v122,v123
M v[176:179],a[172:175],a[68:71],v[176:179]
C v92,v92,v93
C v93,v94,v95
M v[180:183],a[172:175],a[76:79],v[180:183]
C v94,v124,v125
C v95,v126,v127
M v[180:183],a[168:171],a[72:75],v[180:183]
G v28,a28
G v29,a29
M v[184:187],a[168:171],a[80:83],v[184:187]
G v30,a30
G v31,a31
M v[184:187],a[172:175],a[84:87],v[184:187]
s_waitcnt lgkmcnt(0)
C v28,v28,v29
C v29,v30,v31
M v[188:191],a[172:175],a[92:95],v[188:191]
C v30,v60,v61
C v31,v62,v63
M v[188:191],a[168:171],a[88:91],v[188:191]
buffer_store_dwordx4 v[28:31], v7, s[8:11], s3 offen offset:2048 sc1
M v[192:195],a[160:163],a[32:35],v[192:195]
s_waitcnt vmcnt(18)
R a[168:171],v5,55296
R a[172:175],v6,55296
M v[192:195],a[164:167],a[36:39],v[192:195]
C v128,v128,v129
C v129,v130,v131
M v[196:199],a[164:167],a[44:47],v[196:199]
C v130,v160,v161
C v131,v162,v163
M v[196:199],a[160:163],a[40:43],v[196:199]
C v132,v132,v133
C v133,v134,v135
M v[200:203],a[160:163],a[48:51],v[200:203]
C v134,v164,v165
C v135,v166,v167
M v[200:203],a[164:167],a[52:55],v[200:203]
C v136,v136,v137
C v137,v138,v139
M v[204:207],a[164:167],a[60:63],v[204:207]
C v138,v168,v169
C v139,v170,v171
M v[204:207],a[160:163],a[56:59],v[204:207]
C v140,v140,v141
C v141,v142,v143
M v[208:211],a[160:163],a[64:67],v[208:211]
C v142,v172,v173
C v143,v174,v175
M v[208:211],a[164:167],a[68:71],v[208:211]
C v144,v144,v145
C v145,v146,v147
M v[212:215],a[164:167],a[76:79],v[212:215]
R a[128:131],v20,49152
R a[132:135],v20,51200
R a[136:139],v21,49152
R a[140:143],v21,51200
M v[212:215],a[160:163],a[72:75],v[212:215]
C v146,v176,v177
C v147,v178,v179
M v[216:219],a[160:163],a[80:83],v[216:219]
C v148,v148,v149
C v149,v150,v151
M v[216:219],a[164:167],a[84:87],v[216:219]
s_waitcnt lgkmcnt(4)
C v150,v180,v181
C v151,v182,v183
M v[220:223],a[164:167],a[92:95],v[220:223]
s_waitcnt vmcnt(10) lgkmcnt(0)
C v152,v152,v153
C v153,v154,v155
M v[220:223],a[160:163],a[88:91],v[220:223]
s_barrier
M v[224:227],a[168:171],a[32:35],v[224:227]
s_nop 0
T v[32:33],v16,0
T v[34:35],v16,2048
M v[224:227],a[172:175],a[36:39],v[224:227]
C v154,v184,v185
C v155,v186,v187
M v[228:231],a[172:175],a[44:47],v[228:231]
T v[36:37],v16,4096
T v[38:39],v16,6144
M v[228:231],a[168:171],a[40:43],v[228:231]
T v[40:41],v16,8192
T v[42:43],v16,10240
M v[232:235],a[168:171],a[48:51],v[232:235]
C v156,v156,v157
C v157,v158,v159
M v[232:235],a[172:175],a[52:55],v[232:235]
T v[44:45],v16,12288
T v[46:47],v16,14336
M v[236:239],a[172:175],a[60:63],v[236:239]
T v[48:49],v16,16384
T v[50:51],v16,18432
M v[236:239],a[168:171],a[56:59],v[236:239]
C v158,v188,v189
C v159,v190,v191
M v[240:243],a[168:171],a[64:67],v[240:243]
T v[52:53],v16,20480
T v[54:55],v16,22528
M v[240:243],a[172:175],a[68:71],v[240:243]
T v[56:57],v16,24576
T v[58:59],v16,26624
M v[244:247],a[172:175],a[76:79],v[244:247]
C v192,v192,v193
C v193,v194,v195
M v[244:247],a[168:171],a[72:75],v[244:247]
C v194,v224,v225
C v195,v226,v227
M v[248:251],a[168:171],a[80:83],v[248:251]
C v196,v196,v197
C v197,v198,v199
M v[248:251],a[172:175],a[84:87],v[248:251]
C v198,v228,v229
C v199,v230,v231
M v[252:255],a[172:175],a[92:95],v[252:255]
C v200,v200,v201
C v201,v202,v203
M v[252:255],a[168:171],a[88:91],v[252:255]
s_waitcnt lgkmcnt(6)
C v202,v232,v233
C v203,v234,v235
M v[96:99],v[32:35],a[176:179],0
s_mul_i32 s72, s41, 4352
T a[144:145],v17,0
T a[146:147],v17,2048
M v[96:99],v[36:39],a[184:187],v[96:99]
s_mov_b32 s25, 1048704
C v204,v204,v205
C v205,v206,v207
M v[96:99],v[40:43],a[192:195],v[96:99]
s_waitcnt lgkmcnt(2)
T a[148:149],v17,4096
T a[150:151],v17,6144
M v[96:99],v[44:47],a[200:203],v[96:99]
SA m0,s4,98304
T a[152:153],v17,8192
T a[154:155],v17,10240
M v[96:99],v[48:51],a[208:211],v[96:99]
SA s46,s72,104923136
buffer_load_dwordx4 v8, s[52:55], s25 offen lds
M v[96:99],v[52:55],a[216:219],v[96:99]
s_lshl_b32 s45, s42, 7
T a[156:157],v17,12288
T a[158:159],v17,14336
M v[96:99],v[56:59],a[224:227],v[96:99]
s_mov_b32 s25, 1310848
T a[160:161],v17,16384
T a[162:163],v17,18432
M v[100:103],v[56:59],a[228:231],0
SA m0,s4,102400
C v206,v236,v237
C v207,v238,v239
M v[100:103],v[52:55],a[220:223],v[100:103]
SA s45,s45,s46
T a[164:165],v17,20480
T a[166:167],v17,22528
M v[100:103],v[48:51],a[212:215],v[100:103]
s_lshl_b32 s72, s20, 2
T a[168:169],v17,24576
T a[170:171],v17,26624
M v[100:103],v[44:47],a[204:207],v[100:103]
SA s72,s72,s45
buffer_load_dwordx4 v8, s[52:55], s25 offen lds
M v[100:103],v[40:43],a[196:199],v[100:103]
C v208,v208,v209
C v209,v210,v211
M v[100:103],v[36:39],a[188:191],v[100:103]
s_mov_b32 s25, 1572992
C v210,v240,v241
C v211,v242,v243
M v[100:103],v[32:35],a[180:183],v[100:103]
s_waitcnt lgkmcnt(6)
C v212,v212,v213
C v213,v214,v215
M v[104:107],a[144:147],a[176:179],0
SA m0,s4,106496
T v[32:33],v18,0
T v[34:35],v18,2048
M v[104:107],a[148:151],a[184:187],v[104:107]
buffer_load_dwordx4 v8, s[52:55], s25 offen lds
M v[104:107],a[152:155],a[192:195],v[104:107]
s_waitcnt lgkmcnt(2)
s_nop 0
T v[36:37],v18,4096
T v[38:39],v18,6144
M v[104:107],a[156:159],a[200:203],v[104:107]
s_mov_b32 s25, 1835136
T v[40:41],v18,8192
T v[42:43],v18,10240
M v[104:107],a[160:163],a[208:211],v[104:107]
SA m0,s4,110592
C v214,v244,v245
C v215,v246,v247
M v[104:107],a[164:167],a[216:219],v[104:107]
T v[44:45],v18,12288
T v[46:47],v18,14336
M v[104:107],a[168:171],a[224:227],v[104:107]
T v[48:49],v18,16384
T v[50:51],v18,18432
M v[108:111],a[168:171],a[228:231],0
buffer_load_dwordx4 v8, s[52:55], s25 offen lds
M v[108:111],a[164:167],a[220:223],v[108:111]
s_nop 0
T v[52:53],v18,20480
T v[54:55],v18,22528
M v[108:111],a[160:163],a[212:215],v[108:111]
s_mov_b32 s25, 2097280
T v[56:57],v18,24576
T v[58:59],v18,26624
M v[108:111],a[156:159],a[204:207],v[108:111]
SA m0,s4,114688
C v216,v216,v217
C v217,v218,v219
M v[108:111],a[152:155],a[196:199],v[108:111]
SA s3,s93,524288
buffer_load_dwordx4 v8, s[52:55], s25 offen lds
M v[108:111],a[148:151],a[188:191],v[108:111]
C v218,v248,v249
C v219,v250,v251
M v[108:111],a[144:147],a[180:183],v[108:111]
s_waitcnt lgkmcnt(6)
buffer_store_dwordx4 v[64:67], v7, s[8:11], s3 offen offset:0 sc1
M v[112:115],v[32:35],a[176:179],0
s_mov_b32 s25, 2359424
T a[144:145],v19,0
T a[146:147],v19,2048
M v[112:115],v[36:39],a[184:187],v[112:115]
SA m0,s4,118784
buffer_store_dwordx4 v[68:71], v7, s[8:11], s3 offen offset:2048 sc1
M v[112:115],v[40:43],a[192:195],v[112:115]
s_waitcnt lgkmcnt(2)
s_nop 0
T a[148:149],v19,4096
T a[150:151],v19,6144
M v[112:115],v[44:47],a[200:203],v[112:115]
T a[152:153],v19,8192
T a[154:155],v19,10240
M v[112:115],v[48:51],a[208:211],v[112:115]
buffer_load_dwordx4 v8, s[52:55], s25 offen lds
M v[112:115],v[52:55],a[216:219],v[112:115]
s_nop 0
T a[156:157],v19,12288
T a[158:159],v19,14336
M v[112:115],v[56:59],a[224:227],v[112:115]
s_mov_b32 s25, 2621568
T a[160:161],v19,16384
T a[162:163],v19,18432
M v[116:119],v[56:59],a[228:231],0
SA m0,s4,122880
C v220,v220,v221
C v221,v222,v223
M v[116:119],v[52:55],a[220:223],v[116:119]
T a[164:165],v19,20480
T a[166:167],v19,22528
M v[116:119],v[48:51],a[212:215],v[116:119]
T a[168:169],v19,24576
T a[170:171],v19,26624
M v[116:119],v[44:47],a[204:207],v[116:119]
buffer_load_dwordx4 v8, s[52:55], s25 offen lds
M v[116:119],v[40:43],a[196:199],v[116:119]
C v222,v252,v253
C v223,v254,v255
M v[116:119],v[36:39],a[188:191],v[116:119]
s_mov_b32 s25, 2883712
v_min_u32 v29, 1, v0
v_lshlrev_b32 v29, 29, v29
M v[116:119],v[32:35],a[180:183],v[116:119]
s_waitcnt lgkmcnt(6)
v_mov_b32 v30, 1
v_add_u32 v20, 0x10000, v16
M v[120:123],a[144:147],a[176:179],0
SA m0,s4,126976
T v[32:33],v16,28672
T v[34:35],v16,30720
M v[120:123],a[148:151],a[184:187],v[120:123]
s_waitcnt vmcnt(9)
buffer_load_dwordx4 v8, s[52:55], s25 offen lds
M v[120:123],a[152:155],a[192:195],v[120:123]
s_waitcnt lgkmcnt(2)
s_nop 0
T v[36:37],v12,0
T v[38:39],v12,2048
M v[120:123],a[156:159],a[200:203],v[120:123]
s_mov_b32 s25, 3145856
T v[40:41],v12,4096
T v[42:43],v12,6144
M v[120:123],a[160:163],a[208:211],v[120:123]
SA m0,s4,32768
buffer_store_dword v30, v29, s[8:11], s72 offen offset:4 sc1
M v[120:123],a[164:167],a[216:219],v[120:123]
s_nop 0
T v[44:45],v12,8192
T v[46:47],v12,10240
M v[120:123],a[168:171],a[224:227],v[120:123]
T v[48:49],v12,12288
T v[50:51],v12,14336
M v[124:127],a[168:171],a[228:231],0
buffer_load_dwordx4 v8, s[52:55], s25 offen lds
M v[124:127],a[164:167],a[220:223],v[124:127]
s_nop 0
T v[52:53],v12,16384
T v[54:55],v12,18432
M v[124:127],a[160:163],a[212:215],v[124:127]
s_mov_b32 s25, 3408000
T v[56:57],v12,20480
T v[58:59],v12,22528
M v[124:127],a[156:159],a[204:207],v[124:127]
SA m0,s4,36864
v_add_u32 v21, 0x10000, v17
v_add_u32 v22, 0x10000, v18
M v[124:127],a[152:155],a[196:199],v[124:127]
SA s3,s93,528384
buffer_load_dwordx4 v8, s[52:55], s25 offen lds
M v[124:127],a[148:151],a[188:191],v[124:127]
v_add_u32 v23, 0x10000, v19
v_or_b32 v1, s20, v0
M v[124:127],a[144:147],a[180:183],v[124:127]
s_waitcnt lgkmcnt(6)
buffer_store_dwordx4 v[72:75], v7, s[8:11], s3 offen offset:0 sc1
M v[96:99],v[32:35],a[232:235],v[96:99]
s_mov_b32 s25, 256
T a[144:145],v17,28672
T a[146:147],v17,30720
M v[96:99],v[36:39],a[96:99],v[96:99]
SA m0,s4,65536
v_min_u32 v1, 1, v1
v_lshlrev_b32 v1, 29, v1
M v[96:99],v[40:43],a[104:107],v[96:99]
s_waitcnt lgkmcnt(2)
T a[148:149],v13,0
T a[150:151],v13,2048
M v[96:99],v[44:47],a[112:115],v[96:99]
T a[152:153],v13,4096
T a[154:155],v13,6144
M v[96:99],v[48:51],a[120:123],v[96:99]
buffer_load_dwordx4 v8, s[52:55], s25 offen lds
M v[96:99],v[52:55],a[128:131],v[96:99]
s_nop 0
T a[156:157],v13,8192
T a[158:159],v13,10240
M v[96:99],v[56:59],a[136:139],v[96:99]
s_mov_b32 s25, 262400
T a[160:161],v13,12288
T a[162:163],v13,14336
M v[100:103],v[56:59],a[140:143],v[100:103]
SA m0,s4,69632
v_min_u32 v9, 15, v0
v_lshlrev_b32 v9, 7, v9
M v[100:103],v[52:55],a[132:135],v[100:103]
s_sub_u32 s66, 15, s42
T a[164:165],v13,16384
T a[166:167],v13,18432
M v[100:103],v[48:51],a[124:127],v[100:103]
s_max_u32 s67, s66, s42
T a[168:169],v13,20480
L_w_kv18:
s_cbranch_execz L_wd2
T a[170:171],v13,22528
M v[100:103],v[44:47],a[116:119],v[100:103]
s_min_u32 s66, s66, s42
buffer_load_dwordx4 v8, s[52:55], s25 offen lds
M v[100:103],v[40:43],a[108:111],v[100:103]
s_mul_i32 s21, s41, 1048576
M v[100:103],v[36:39],a[100:103],v[100:103]
s_mov_b32 s25, 524544
M v[100:103],v[32:35],a[236:239],v[100:103]
s_waitcnt lgkmcnt(6)
M v[104:107],a[144:147],a[232:235],v[104:107]
SA m0,s4,73728
T v[32:33],v18,28672
T v[34:35],v18,30720
M v[104:107],a[148:151],a[96:99],v[104:107]
s_lshl_b32 s64, s67, 16
buffer_load_dwordx4 v8, s[52:55], s25 offen lds
M v[104:107],a[152:155],a[104:107],v[104:107]
s_waitcnt lgkmcnt(2)
s_nop 0
T v[36:37],v14,0
T v[38:39],v14,2048
M v[104:107],a[156:159],a[112:115],v[104:107]
s_mov_b32 s25, 786688
T v[40:41],v14,4096
T v[42:43],v14,6144
M v[104:107],a[160:163],a[120:123],v[104:107]
SA m0,s4,77824
M v[104:107],a[164:167],a[128:131],v[104:107]
SA s32,s21,s64
T v[44:45],v14,8192
T v[46:47],v14,10240
M v[104:107],a[168:171],a[136:139],v[104:107]
s_lshl_b32 s64, s20, 14
T v[48:49],v14,12288
T v[50:51],v14,14336
M v[108:111],a[168:171],a[140:143],v[108:111]
SA s32,s32,s64
buffer_load_dwordx4 v8, s[52:55], s25 offen lds
M v[108:111],a[164:167],a[132:135],v[108:111]
SA s32,s32,33554432
T v[52:53],v14,16384
T v[54:55],v14,18432
M v[108:111],a[160:163],a[124:127],v[108:111]
s_mov_b32 s25, 1048832
T v[56:57],v14,20480
T v[58:59],v14,22528
M v[108:111],a[156:159],a[116:119],v[108:111]
s_sub_u32 s64, s42, 10
s_and_b32 s35, s64, 536870912
v_or_b32 v6, s35, v7
M v[108:111],a[152:155],a[108:111],v[108:111]
SA m0,s4,81920
MF v96,s5,v96
MF v97,s5,v97
M v[108:111],a[148:151],a[100:103],v[108:111]
s_lshl_b32 s28, s20, 13
buffer_load_dwordx4 v8, s[52:55], s25 offen lds
M v[108:111],a[144:147],a[236:239],v[108:111]
s_waitcnt lgkmcnt(6)
v_add_u32 v2, 0x10000, v7
v_add_u32 v3, s28, v7
M v[112:115],v[32:35],a[232:235],v[112:115]
s_mov_b32 s25, 1310976
T a[144:145],v19,28672
T a[146:147],v19,30720
M v[112:115],v[36:39],a[96:99],v[112:115]
SA m0,s4,86016
v_add_u32 v4, 0x1000, v3
MF v98,s5,v98
M v[112:115],v[40:43],a[104:107],v[112:115]
s_waitcnt lgkmcnt(2)
T a[148:149],v15,0
T a[150:151],v15,2048
M v[112:115],v[44:47],a[112:115],v[112:115]
s_lshl_b32 s64, s42, 16
T a[152:153],v15,4096
T a[154:155],v15,6144
M v[112:115],v[48:51],a[120:123],v[112:115]
SA s23,s21,s64
buffer_load_dwordx4 v8, s[52:55], s25 offen lds
M v[112:115],v[52:55],a[128:131],v[112:115]
SA s43,s23,16777216
T a[156:157],v15,8192
T a[158:159],v15,10240
M v[112:115],v[56:59],a[136:139],v[112:115]
s_mov_b32 s25, 1573120
T a[160:161],v15,12288
T a[162:163],v15,14336
M v[116:119],v[56:59],a[140:143],v[116:119]
SA m0,s4,90112
MF v99,s5,v99
MF v104,s5,v104
M v[116:119],v[52:55],a[132:135],v[116:119]
SA s26,s21,16777216
T a[164:165],v15,16384
T a[166:167],v15,18432
M v[116:119],v[48:51],a[124:127],v[116:119]
s_min_u32 s27, s42, 9
T a[168:169],v15,20480
T a[170:171],v15,22528
M v[116:119],v[44:47],a[116:119],v[116:119]
s_lshl_b32 s22, s27, 1
buffer_load_dwordx4 v8, s[52:55], s25 offen lds
M v[116:119],v[40:43],a[108:111],v[116:119]
s_sub_u32 s22, s22, 1
MF v105,s5,v105
MF v106,s5,v106
M v[116:119],v[36:39],a[100:103],v[116:119]
s_waitcnt vmcnt(8) lgkmcnt(0)
MF v107,s5,v107
C v96,v96,v97
M v[116:119],v[32:35],a[236:239],v[116:119]
s_barrier
M v[120:123],a[144:147],a[232:235],v[120:123]
s_mov_b32 s25, 1835264
T v[32:33],v16,49152
T v[34:35],v16,51200
M v[120:123],a[148:151],a[96:99],v[120:123]
SA m0,s4,94208
C v97,v98,v99
C v98,v104,v105
M v[120:123],a[152:155],a[104:107],v[120:123]
s_sub_u32 s27, s27, 2
T v[36:37],v16,53248
T v[38:39],v16,55296
M v[120:123],a[156:159],a[112:115],v[120:123]
s_mov_b32 s31, 0x4b800000
T v[40:41],v16,57344
T v[42:43],v16,59392
M v[120:123],a[160:163],a[120:123],v[120:123]
s_mov_b32 s24, 0x33800000
buffer_load_dwordx4 v8, s[52:55], s25 offen lds
M v[120:123],a[164:167],a[128:131],v[120:123]
s_lshl_b32 s47, s66, 7
T v[44:45],v16,61440
T v[46:47],v16,63488
M v[120:123],a[168:171],a[136:139],v[120:123]
s_mov_b32 s25, 2097408
T v[48:49],v20,32768
T v[50:51],v20,34816
M v[124:127],a[168:171],a[140:143],v[124:127]
SA m0,s4,155648
C v99,v106,v107
W a0,v96
M v[124:127],a[164:167],a[132:135],v[124:127]
SA s47,s47,s46
T v[52:53],v20,36864
T v[54:55],v20,38912
M v[124:127],a[160:163],a[124:127],v[124:127]
s_lshl_b32 s64, s20, 5
T v[56:57],v20,40960
T v[58:59],v20,43008
M v[124:127],a[156:159],a[116:119],v[124:127]
SA s47,s47,s64
buffer_load_dwordx4 v8, s[52:55], s25 offen lds
M v[124:127],a[152:155],a[108:111],v[124:127]
SA s47,s47,2048
W a1,v97
W a2,v98
M v[124:127],a[148:151],a[100:103],v[124:127]
s_lshl_b32 s65, s41, 3
W a3,v99
MF v100,s5,v100
M v[124:127],a[144:147],a[236:239],v[124:127]
s_waitcnt lgkmcnt(6)
MF v101,s5,v101
MF v102,s5,v102
M v[160:163],v[32:35],a[176:179],0
SA s65,s65,s66
T a[144:145],v17,49152
T a[146:147],v17,51200
M v[160:163],v[36:39],a[184:187],v[160:163]
s_mul_i32 s34, s65, 73728
MF v103,s5,v103
MF v108,s5,v108
M v[160:163],v[40:43],a[192:195],v[160:163]
s_waitcnt lgkmcnt(2)
T a[148:149],v17,53248
T a[150:151],v17,55296
M v[160:163],v[44:47],a[200:203],v[160:163]
SA s34,s34,136314880
T a[152:153],v17,57344
T a[154:155],v17,59392
M v[160:163],v[48:51],a[208:211],v[160:163]
s_lshl_b32 s65, s42, 4
MF v109,s5,v109
MF v110,s5,v110
M v[160:163],v[52:55],a[216:219],v[160:163]
SA s65,s65,s41
T a[156:157],v17,61440
T a[158:159],v17,63488
M v[160:163],v[56:59],a[224:227],v[160:163]
s_mul_i32 s33, s65, 114688
T a[160:161],v21,32768
T a[162:163],v21,34816
M v[164:167],v[56:59],a[228:231],0
s_mul_i32 s65, s20, 28672
MF v111,s5,v111
C v100,v100,v101
M v[164:167],v[52:55],a[220:223],v[164:167]
SA s33,s33,s65
T a[164:165],v21,36864
T a[166:167],v21,38912
M v[164:167],v[48:51],a[212:215],v[164:167]
SA s33,s33,67108864
T a[168:169],v21,40960
T a[170:171],v21,43008
M v[164:167],v[44:47],a[204:207],v[164:167]
s_mov_b32 s6, 0
C v101,v102,v103
C v102,v108,v109
M v[164:167],v[40:43],a[196:199],v[164:167]
s_mov_b32 s7, 1
C v103,v110,v111
W a32,v100
M v[164:167],v[36:39],a[188:191],v[164:167]
s_mov_b32 s40, 1
W a33,v101
W a34,v102
M v[164:167],v[32:35],a[180:183],v[164:167]
s_waitcnt lgkmcnt(6)
W a35,v103
MF v112,s5,v112
M v[168:171],a[144:147],a[176:179],0
s_cmp_eq_u32 s20, 0
T v[32:33],v18,49152
T v[34:35],v18,51200
M v[168:171],a[148:151],a[184:187],v[168:171]
s_cselect_b32 s39, 6, 4
MF v113,s5,v113
MF v114,s5,v114
M v[168:171],a[152:155],a[192:195],v[168:171]
s_waitcnt lgkmcnt(2)
T v[36:37],v18,53248
T v[38:39],v18,55296
M v[168:171],a[156:159],a[200:203],v[168:171]
s_mov_b64 s[60:61], s[76:77]
T v[40:41],v18,57344
T v[42:43],v18,59392
M v[168:171],a[160:163],a[208:211],v[168:171]
s_mov_b32 s62, s78
MF v115,s5,v115
MF v120,s5,v120
M v[168:171],a[164:167],a[216:219],v[168:171]
s_mov_b32 s63, 0x20000
T v[44:45],v18,61440
T v[46:47],v18,63488
M v[168:171],a[168:171],a[224:227],v[168:171]
SA s30,s32,0
T v[48:49],v22,32768
T v[50:51],v22,34816
M v[172:175],a[168:171],a[228:231],0
s_mov_b32 s25, 2359552
buffer_store_dwordx4 a[0:3], v6, s[8:11], s30 offen offset:0 sc1
M v[172:175],a[164:167],a[220:223],v[172:175]
SA m0,s4,159744
T v[52:53],v22,36864
T v[54:55],v22,38912
M v[172:175],a[160:163],a[212:215],v[172:175]
SA s3,s93,528384
T v[56:57],v22,40960
T v[58:59],v22,43008
M v[172:175],a[156:159],a[204:207],v[172:175]
buffer_load_dwordx4 v8, s[52:55], s25 offen lds
M v[172:175],a[152:155],a[196:199],v[172:175]
v_lshrrev_b32 v24, 4, v0
v_lshlrev_b32 v24, 2, v24
M v[172:175],a[148:151],a[188:191],v[172:175]
s_mov_b32 s25, 2621696
buffer_store_dwordx4 v[76:79], v7, s[8:11], s3 offen offset:2048 sc1
M v[172:175],a[144:147],a[180:183],v[172:175]
s_waitcnt lgkmcnt(6)
v_and_b32 v25, 15, v0
v_sub_u32 v24, v24, v25
M v[176:179],v[32:35],a[176:179],0
SA m0,s4,131072
T a[144:145],v19,49152
T a[146:147],v19,51200
M v[176:179],v[36:39],a[184:187],v[176:179]
buffer_load_dwordx4 v8, s[52:55], s25 offen lds
M v[176:179],v[40:43],a[192:195],v[176:179]
s_waitcnt lgkmcnt(2)
s_nop 0
T a[148:149],v19,53248
T a[150:151],v19,55296
M v[176:179],v[44:47],a[200:203],v[176:179]
s_mov_b32 s25, 2883840
T a[152:153],v19,57344
T a[154:155],v19,59392
M v[176:179],v[48:51],a[208:211],v[176:179]
SA m0,s4,135168
v_cmp_lt_i32 s[16:17], 0, v24
v_cmp_lt_i32 s[18:19], -1, v24
M v[176:179],v[52:55],a[216:219],v[176:179]
T a[156:157],v19,61440
T a[158:159],v19,63488
M v[176:179],v[56:59],a[224:227],v[176:179]
T a[160:161],v23,32768
T a[162:163],v23,34816
M v[180:183],v[56:59],a[228:231],0
buffer_load_dwordx4 v8, s[52:55], s25 offen lds
M v[180:183],v[52:55],a[220:223],v[180:183]
s_nop 0
T a[164:165],v23,36864
T a[166:167],v23,38912
M v[180:183],v[48:51],a[212:215],v[180:183]
s_mov_b32 s25, 3145984
T a[168:169],v23,40960
T a[170:171],v23,43008
M v[180:183],v[44:47],a[204:207],v[180:183]
SA m0,s4,139264
v_cmp_lt_i32 s[48:49], -2, v24
v_cmp_lt_i32 s[50:51], -3, v24
M v[180:183],v[40:43],a[196:199],v[180:183]
buffer_load_dwordx4 v8, s[52:55], s25 offen lds
M v[180:183],v[36:39],a[188:191],v[180:183]
v_lshl_add_u32 v25, v0, 7, s95
v_and_b32 v0, 48, v0
M v[180:183],v[32:35],a[180:183],v[180:183]
s_waitcnt lgkmcnt(6)
MF v121,s5,v121
MF v122,s5,v122
M v[184:187],a[144:147],a[176:179],0
s_mov_b32 s25, 3408128
T v[32:33],v20,45056
T v[34:35],v20,47104
M v[184:187],a[148:151],a[184:187],v[184:187]
SA m0,s4,143360
MF v123,s5,v123
C v112,v112,v113
M v[184:187],a[152:155],a[192:195],v[184:187]
s_waitcnt lgkmcnt(2)
T v[36:37],v20,49152
T v[38:39],v20,51200
M v[184:187],a[156:159],a[200:203],v[184:187]
SA s30,s32,8192
T v[40:41],v20,53248
T v[42:43],v20,55296
M v[184:187],a[160:163],a[208:211],v[184:187]
buffer_store_dwordx4 a[32:35], v6, s[8:11], s30 offen offset:0 sc1
M v[184:187],a[164:167],a[216:219],v[184:187]
s_nop 0
T v[44:45],v20,57344
T v[46:47],v20,59392
M v[184:187],a[168:171],a[224:227],v[184:187]
T v[48:49],v20,61440
T v[50:51],v20,63488
M v[188:191],a[168:171],a[228:231],0
buffer_load_dwordx4 v8, s[52:55], s25 offen lds
M v[188:191],a[164:167],a[220:223],v[188:191]
SA s3,s93,532480
T v[52:53],v16,32768
T v[54:55],v16,34816
M v[188:191],a[160:163],a[212:215],v[188:191]
s_mov_b32 s25, 384
T v[56:57],v16,36864
T v[58:59],v16,38912
M v[188:191],a[156:159],a[204:207],v[188:191]
SA m0,s4,0
buffer_store_dwordx4 v[80:83], v7, s[8:11], s3 offen offset:0 sc1
M v[188:191],a[152:155],a[196:199],v[188:191]
C v113,v114,v115
C v114,v120,v121
M v[188:191],a[148:151],a[188:191],v[188:191]
buffer_load_dwordx4 v8, s[52:55], s25 offen lds
M v[188:191],a[144:147],a[180:183],v[188:191]
s_waitcnt lgkmcnt(6)
C v115,v122,v123
W a4,v112
M v[160:163],v[32:35],a[232:235],v[160:163]
s_mov_b32 s25, 262528
T a[144:145],v21,45056
T a[146:147],v21,47104
M v[160:163],v[36:39],a[96:99],v[160:163]
SA m0,s4,4096
buffer_store_dwordx4 v[84:87], v7, s[8:11], s3 offen offset:2048 sc1
M v[160:163],v[40:43],a[104:107],v[160:163]
s_waitcnt lgkmcnt(2)
s_nop 0
T a[148:149],v21,49152
T a[150:151],v21,51200
M v[160:163],v[44:47],a[112:115],v[160:163]
T a[152:153],v21,53248
T a[154:155],v21,55296
M v[160:163],v[48:51],a[120:123],v[160:163]
buffer_load_dwordx4 v8, s[52:55], s25 offen lds
M v[160:163],v[52:55],a[128:131],v[160:163]
s_nop 0
T a[156:157],v21,57344
T a[158:159],v21,59392
M v[160:163],v[56:59],a[136:139],v[160:163]
s_mov_b32 s25, 524672
T a[160:161],v21,61440
T a[162:163],v21,63488
M v[164:167],v[56:59],a[140:143],v[164:167]
SA m0,s4,8192
W a5,v113
W a6,v114
M v[164:167],v[52:55],a[132:135],v[164:167]
T a[164:165],v17,32768
T a[166:167],v17,34816
M v[164:167],v[48:51],a[124:127],v[164:167]
T a[168:169],v17,36864
T a[170:171],v17,38912
M v[164:167],v[44:47],a[116:119],v[164:167]
buffer_load_dwordx4 v8, s[52:55], s25 offen lds
M v[164:167],v[40:43],a[108:111],v[164:167]
W a7,v115
v_lshl_add_u32 v0, v0, 24, v25
M v[164:167],v[36:39],a[100:103],v[164:167]
s_mov_b32 s25, 786816
v_mov_b32 v24, 0x3f80
MF v116,s5,v116
M v[164:167],v[32:35],a[236:239],v[164:167]
s_waitcnt lgkmcnt(6)
MF v117,s5,v117
MF v118,s5,v118
M v[168:171],a[144:147],a[232:235],v[168:171]
SA s30,s32,0
T v[32:33],v22,45056
T v[34:35],v22,47104
M v[168:171],a[148:151],a[96:99],v[168:171]
SA m0,s4,12288
buffer_store_dwordx4 a[4:7], v6, s[8:11], s30 offen offset:1024 sc1
M v[168:171],a[152:155],a[104:107],v[168:171]
s_waitcnt lgkmcnt(2)
s_nop 0
T v[36:37],v22,49152
T v[38:39],v22,51200
M v[168:171],a[156:159],a[112:115],v[168:171]
T v[40:41],v22,53248
T v[42:43],v22,55296
M v[168:171],a[160:163],a[120:123],v[168:171]
buffer_load_dwordx4 v8, s[52:55], s25 offen lds
M v[168:171],a[164:167],a[128:131],v[168:171]
s_nop 0
T v[44:45],v22,57344
T v[46:47],v22,59392
M v[168:171],a[168:171],a[136:139],v[168:171]
s_mov_b32 s25, 1048960
T v[48:49],v22,61440
T v[50:51],v22,63488
M v[172:175],a[168:171],a[140:143],v[172:175]
SA m0,s4,16384
MF v119,s5,v119
MF v124,s5,v124
M v[172:175],a[164:167],a[132:135],v[172:175]
T v[52:53],v18,32768
T v[54:55],v18,34816
M v[172:175],a[160:163],a[124:127],v[172:175]
T v[56:57],v18,36864
T v[58:59],v18,38912
M v[172:175],a[156:159],a[116:119],v[172:175]
buffer_load_dwordx4 v8, s[52:55], s25 offen lds
M v[172:175],a[152:155],a[108:111],v[172:175]
MF v125,s5,v125
MF v126,s5,v126
M v[172:175],a[148:151],a[100:103],v[172:175]
s_mov_b32 s25, 1311104
v_lshrrev_b32 v25, 8, v7
v_bfe_u32 v26, v7, 6, 2
v_and_b32 v27, 16, v7
v_lshlrev_b32 v27, v27, v24
v_cmp_eq_u32 vcc, v25, v26
v_and_b32 v28, 32, v7
W a244,0
v_cndmask_b32 v27, 0, v27, vcc
v_cmp_eq_u32 vcc, 0, v28
W a245,0
W a248,0
v_cndmask_b32 v25, 0, v27, vcc
v_sub_u32 v26, v27, v25
W a249,0
W a246,v25
W a247,v26
M v[172:175],a[144:147],a[236:239],v[172:175]
s_waitcnt lgkmcnt(6)
MF v127,s5,v127
C v116,v116,v117
M v[176:179],v[32:35],a[232:235],v[176:179]
SA m0,s4,20480
T a[144:145],v23,45056
T a[146:147],v23,47104
M v[176:179],v[36:39],a[96:99],v[176:179]
buffer_load_dwordx4 v8, s[52:55], s25 offen lds
M v[176:179],v[40:43],a[104:107],v[176:179]
s_waitcnt lgkmcnt(2)
s_nop 0
T a[148:149],v23,49152
T a[150:151],v23,51200
M v[176:179],v[44:47],a[112:115],v[176:179]
s_mov_b32 s25, 1573248
T a[152:153],v23,53248
T a[154:155],v23,55296
M v[176:179],v[48:51],a[120:123],v[176:179]
SA m0,s4,24576
C v117,v118,v119
C v118,v124,v125
M v[176:179],v[52:55],a[128:131],v[176:179]
T a[156:157],v23,57344
T a[158:159],v23,59392
M v[176:179],v[56:59],a[136:139],v[176:179]
T a[160:161],v23,61440
T a[162:163],v23,63488
M v[180:183],v[56:59],a[140:143],v[180:183]
buffer_load_dwordx4 v8, s[52:55], s25 offen lds
M v[180:183],v[52:55],a[132:135],v[180:183]
s_nop 0
T a[164:165],v19,32768
T a[166:167],v19,34816
M v[180:183],v[48:51],a[124:127],v[180:183]
s_mov_b32 s25, 1835392
T a[168:169],v19,36864
T a[170:171],v19,38912
M v[180:183],v[44:47],a[116:119],v[180:183]
SA m0,s4,28672
C v119,v126,v127
W a36,v116
M v[180:183],v[40:43],a[108:111],v[180:183]
buffer_load_dwordx4 v8, s[52:55], s25 offen lds
M v[180:183],v[36:39],a[100:103],v[180:183]
s_waitcnt vmcnt(11) lgkmcnt(0)
W a37,v117
W a38,v118
M v[180:183],v[32:35],a[236:239],v[180:183]
s_barrier
M v[184:187],a[144:147],a[232:235],v[184:187]
s_mov_b32 s25, 2097536
T v[32:33],v20,0
T v[34:35],v20,2048
M v[184:187],a[148:151],a[96:99],v[184:187]
SA m0,s4,40960
W a39,v119
MF v160,s5,v160
M v[184:187],a[152:155],a[104:107],v[184:187]
SA s30,s32,8192
T v[36:37],v20,4096
T v[38:39],v20,6144
M v[184:187],a[156:159],a[112:115],v[184:187]
T v[40:41],v20,8192
T v[42:43],v20,10240
M v[184:187],a[160:163],a[120:123],v[184:187]
buffer_store_dwordx4 a[36:39], v6, s[8:11], s30 offen offset:1024 sc1
M v[184:187],a[164:167],a[128:131],v[184:187]
s_nop 0
T v[44:45],v20,12288
T v[46:47],v20,14336
M v[184:187],a[168:171],a[136:139],v[184:187]
T v[48:49],v20,16384
T v[50:51],v20,18432
M v[188:191],a[168:171],a[140:143],v[188:191]
buffer_load_dwordx4 v8, s[52:55], s25 offen lds
M v[188:191],a[164:167],a[132:135],v[188:191]
s_nop 0
T v[52:53],v20,20480
T v[54:55],v20,22528
M v[188:191],a[160:163],a[124:127],v[188:191]
s_mov_b32 s25, 2359680
T v[56:57],v20,24576
T v[58:59],v20,26624
M v[188:191],a[156:159],a[116:119],v[188:191]
SA m0,s4,45056
MF v161,s5,v161
MF v162,s5,v162
M v[188:191],a[152:155],a[108:111],v[188:191]
buffer_load_dwordx4 v8, s[52:55], s25 offen lds
M v[188:191],a[148:151],a[100:103],v[188:191]
MF v163,s5,v163
MF v168,s5,v168
M v[188:191],a[144:147],a[236:239],v[188:191]
s_waitcnt lgkmcnt(6)
MF v169,s5,v169
MF v170,s5,v170
M v[96:99],v[32:35],a[176:179],0
s_mov_b32 s25, 2621824
T a[144:145],v21,0
T a[146:147],v21,2048
M v[96:99],v[36:39],a[184:187],v[96:99]
SA m0,s4,49152
MF v171,s5,v171
C v160,v160,v161
M v[96:99],v[40:43],a[192:195],v[96:99]
s_waitcnt lgkmcnt(2)
T a[148:149],v21,4096
T a[150:151],v21,6144
M v[96:99],v[44:47],a[200:203],v[96:99]
T a[152:153],v21,8192
T a[154:155],v21,10240
M v[96:99],v[48:51],a[208:211],v[96:99]
buffer_load_dwordx4 v8, s[52:55], s25 offen lds
M v[96:99],v[52:55],a[216:219],v[96:99]
s_nop 0
T a[156:157],v21,12288
T a[158:159],v21,14336
M v[96:99],v[56:59],a[224:227],v[96:99]
s_mov_b32 s25, 2883968
T a[160:161],v21,16384
T a[162:163],v21,18432
M v[100:103],v[56:59],a[228:231],0
SA m0,s4,53248
C v161,v162,v163
C v162,v168,v169
M v[100:103],v[52:55],a[220:223],v[100:103]
T a[164:165],v21,20480
T a[166:167],v21,22528
M v[100:103],v[48:51],a[212:215],v[100:103]
T a[168:169],v21,24576
T a[170:171],v21,26624
M v[100:103],v[44:47],a[204:207],v[100:103]
SA s3,s93,536576
buffer_load_dwordx4 v8, s[52:55], s25 offen lds
M v[100:103],v[40:43],a[196:199],v[100:103]
C v163,v170,v171
W a8,v160
M v[100:103],v[36:39],a[188:191],v[100:103]
s_mov_b32 s25, 3146112
W a9,v161
W a10,v162
M v[100:103],v[32:35],a[180:183],v[100:103]
s_waitcnt lgkmcnt(6)
W a11,v163
v_lshrrev_b32 v31, 6, v7
M v[104:107],a[144:147],a[176:179],0
SA s30,s32,0
T v[32:33],v22,0
T v[34:35],v22,2048
M v[104:107],a[148:151],a[184:187],v[104:107]
SA m0,s4,57344
buffer_store_dwordx4 a[8:11], v6, s[8:11], s30 offen offset:2048 sc1
M v[104:107],a[152:155],a[192:195],v[104:107]
s_waitcnt lgkmcnt(2)
s_nop 0
T v[36:37],v22,4096
T v[38:39],v22,6144
M v[104:107],a[156:159],a[200:203],v[104:107]
T v[40:41],v22,8192
T v[42:43],v22,10240
M v[104:107],a[160:163],a[208:211],v[104:107]
buffer_load_dwordx4 v8, s[52:55], s25 offen lds
M v[104:107],a[164:167],a[216:219],v[104:107]
s_nop 0
T v[44:45],v22,12288
T v[46:47],v22,14336
M v[104:107],a[168:171],a[224:227],v[104:107]
s_mov_b32 s25, 3408256
T v[48:49],v22,16384
T v[50:51],v22,18432
M v[108:111],a[168:171],a[228:231],0
SA m0,s4,61440
buffer_store_dwordx4 v[88:91], v7, s[8:11], s3 offen offset:0 sc1
M v[108:111],a[164:167],a[220:223],v[108:111]
s_nop 0
T v[52:53],v22,20480
T v[54:55],v22,22528
M v[108:111],a[160:163],a[212:215],v[108:111]
T v[56:57],v22,24576
T v[58:59],v22,26624
M v[108:111],a[156:159],a[204:207],v[108:111]
buffer_load_dwordx4 v8, s[52:55], s25 offen lds
M v[108:111],a[152:155],a[196:199],v[108:111]
v_bfe_u32 v28, v7, 4, 2
v_lshlrev_b32 v31, 5, v31
M v[108:111],a[148:151],a[188:191],v[108:111]
buffer_store_dwordx4 v[92:95], v7, s[8:11], s3 offen offset:2048 sc1
M v[108:111],a[144:147],a[180:183],v[108:111]
s_waitcnt lgkmcnt(6)
v_add_lshl_u32 v31, v31, v28, 2
MF v164,s5,v164
M v[112:115],v[32:35],a[176:179],0
T a[144:145],v23,0
T a[146:147],v23,2048
M v[112:115],v[36:39],a[184:187],v[112:115]
buffer_load_dword v5, v31, s[8:11], s46 offen offset:4 sc1
M v[112:115],v[40:43],a[192:195],v[112:115]
s_waitcnt lgkmcnt(2)
s_nop 0
T a[148:149],v23,4096
T a[150:151],v23,6144
M v[112:115],v[44:47],a[200:203],v[112:115]
T a[152:153],v23,8192
T a[154:155],v23,10240
M v[112:115],v[48:51],a[208:211],v[112:115]
MF v165,s5,v165
MF v166,s5,v166
M v[112:115],v[52:55],a[216:219],v[112:115]
T a[156:157],v23,12288
T a[158:159],v23,14336
M v[112:115],v[56:59],a[224:227],v[112:115]
T a[160:161],v23,16384
T a[162:163],v23,18432
M v[116:119],v[56:59],a[228:231],0
MF v167,s5,v167
MF v172,s5,v172
M v[116:119],v[52:55],a[220:223],v[116:119]
T a[164:165],v23,20480
T a[166:167],v23,22528
M v[116:119],v[48:51],a[212:215],v[116:119]
T a[168:169],v23,24576
T a[170:171],v23,26624
M v[116:119],v[44:47],a[204:207],v[116:119]
MF v173,s5,v173
MF v174,s5,v174
M v[116:119],v[40:43],a[196:199],v[116:119]
MF v175,s5,v175
C v164,v164,v165
M v[116:119],v[36:39],a[188:191],v[116:119]
C v165,v166,v167
C v166,v172,v173
M v[116:119],v[32:35],a[180:183],v[116:119]
s_waitcnt lgkmcnt(6)
C v167,v174,v175
W a40,v164
M v[120:123],a[144:147],a[176:179],0
T v[32:33],v20,28672
T v[34:35],v20,30720
M v[120:123],a[148:151],a[184:187],v[120:123]
W a41,v165
W a42,v166
M v[120:123],a[152:155],a[192:195],v[120:123]
s_waitcnt lgkmcnt(2)
T v[36:37],v12,24576
T v[38:39],v12,26624
M v[120:123],a[156:159],a[200:203],v[120:123]
T v[40:41],v12,28672
T v[42:43],v12,30720
M v[120:123],a[160:163],a[208:211],v[120:123]
W a43,v167
v_mov_b32 v8, 0xff800000
M v[120:123],a[164:167],a[216:219],v[120:123]
SA s30,s32,8192
T v[44:45],v12,0
T v[46:47],v12,2048
M v[120:123],a[168:171],a[224:227],v[120:123]
T v[48:49],v12,4096
T v[50:51],v12,6144
M v[124:127],a[168:171],a[228:231],0
buffer_store_dwordx4 a[40:43], v6, s[8:11], s30 offen offset:2048 sc1
M v[124:127],a[164:167],a[220:223],v[124:127]
s_nop 0
T v[52:53],v12,8192
T v[54:55],v12,10240
M v[124:127],a[160:163],a[212:215],v[124:127]
T v[56:57],v12,12288
T v[58:59],v12,14336
M v[124:127],a[156:159],a[204:207],v[124:127]
MF v176,s5,v176
MF v177,s5,v177
M v[124:127],a[152:155],a[196:199],v[124:127]
MF v178,s5,v178
MF v179,s5,v179
M v[124:127],a[148:151],a[188:191],v[124:127]
MF v184,s5,v184
MF v185,s5,v185
M v[124:127],a[144:147],a[180:183],v[124:127]
s_waitcnt lgkmcnt(6)
MF v186,s5,v186
MF v187,s5,v187
M v[96:99],v[32:35],a[232:235],v[96:99]
T a[144:145],v21,28672
T a[146:147],v21,30720
M v[96:99],v[36:39],a[96:99],v[96:99]
C v176,v176,v177
C v177,v178,v179
M v[96:99],v[40:43],a[104:107],v[96:99]
s_waitcnt lgkmcnt(2)
T a[148:149],v13,24576
T a[150:151],v13,26624
M v[96:99],v[44:47],a[112:115],v[96:99]
T a[152:153],v13,28672
T a[154:155],v13,30720
M v[96:99],v[48:51],a[120:123],v[96:99]
C v178,v184,v185
C v179,v186,v187
M v[96:99],v[52:55],a[128:131],v[96:99]
T a[156:157],v13,0
T a[158:159],v13,2048
M v[96:99],v[56:59],a[136:139],v[96:99]
T a[160:161],v13,4096
T a[162:163],v13,6144
M v[100:103],v[56:59],a[140:143],v[100:103]
W a12,v176
W a13,v177
M v[100:103],v[52:55],a[132:135],v[100:103]
T a[164:165],v13,8192
T a[166:167],v13,10240
M v[100:103],v[48:51],a[124:127],v[100:103]
T a[168:169],v13,12288
T a[170:171],v13,14336
M v[100:103],v[44:47],a[116:119],v[100:103]
W a14,v178
W a15,v179
M v[100:103],v[40:43],a[108:111],v[100:103]
MF v180,s5,v180
MF v181,s5,v181
M v[100:103],v[36:39],a[100:103],v[100:103]
MF v182,s5,v182
MF v183,s5,v183
M v[100:103],v[32:35],a[236:239],v[100:103]
s_waitcnt lgkmcnt(6)
MF v188,s5,v188
MF v189,s5,v189
M v[104:107],a[144:147],a[232:235],v[104:107]
T v[32:33],v22,28672
T v[34:35],v22,30720
M v[104:107],a[148:151],a[96:99],v[104:107]
MF v190,s5,v190
MF v191,s5,v191
M v[104:107],a[152:155],a[104:107],v[104:107]
s_waitcnt lgkmcnt(2)
T v[36:37],v14,24576
T v[38:39],v14,26624
M v[104:107],a[156:159],a[112:115],v[104:107]
SA s30,s32,0
T v[40:41],v14,28672
T v[42:43],v14,30720
M v[104:107],a[160:163],a[120:123],v[104:107]
buffer_store_dwordx4 a[12:15], v6, s[8:11], s30 offen offset:3072 sc1
M v[104:107],a[164:167],a[128:131],v[104:107]
s_nop 0
T v[44:45],v14,0
T v[46:47],v14,2048
M v[104:107],a[168:171],a[136:139],v[104:107]
T v[48:49],v14,4096
T v[50:51],v14,6144
M v[108:111],a[168:171],a[140:143],v[108:111]
C v180,v180,v181
C v181,v182,v183
M v[108:111],a[164:167],a[132:135],v[108:111]
T v[52:53],v14,8192
T v[54:55],v14,10240
M v[108:111],a[160:163],a[124:127],v[108:111]
T v[56:57],v14,12288
T v[58:59],v14,14336
M v[108:111],a[156:159],a[116:119],v[108:111]
C v182,v188,v189
C v183,v190,v191
M v[108:111],a[152:155],a[108:111],v[108:111]
W a44,v180
W a45,v181
M v[108:111],a[148:151],a[100:103],v[108:111]
W a46,v182
W a47,v183
M v[108:111],a[144:147],a[236:239],v[108:111]
s_waitcnt lgkmcnt(6)
s_waitcnt vmcnt(2)
v_cmp_ne_u32 vcc, 1, v5
MF v96,s5,v96
M v[112:115],v[32:35],a[232:235],v[112:115]
s_nop 0
T a[144:145],v23,28672
T a[146:147],v23,30720
M v[112:115],v[36:39],a[96:99],v[112:115]
s_cmp_lg_u32 vcc_lo, 0
MF v97,s5,v97
MF v98,s5,v98
M v[112:115],v[40:43],a[104:107],v[112:115]
s_waitcnt lgkmcnt(2)
T a[148:149],v15,24576
T a[150:151],v15,26624
M v[112:115],v[44:47],a[112:115],v[112:115]
s_cbranch_scc1 L_wsq1
L_wrq1:
T a[152:153],v15,28672
T a[154:155],v15,30720
M v[112:115],v[48:51],a[120:123],v[112:115]
SA m0,s28,98304
MF v99,s5,v99
MF v104,s5,v104
M v[112:115],v[52:55],a[128:131],v[112:115]
T a[156:157],v15,0
T a[158:159],v15,2048
M v[112:115],v[56:59],a[136:139],v[112:115]
T a[160:161],v15,4096
T a[162:163],v15,6144
M v[116:119],v[56:59],a[140:143],v[116:119]
buffer_load_dwordx4 v3, s[8:11], s21 offen offset:0 sc1 lds
M v[116:119],v[52:55],a[132:135],v[116:119]
s_nop 0
T a[164:165],v15,8192
T a[166:167],v15,10240
M v[116:119],v[48:51],a[124:127],v[116:119]
T a[168:169],v15,12288
T a[170:171],v15,14336
M v[116:119],v[44:47],a[116:119],v[116:119]
buffer_load_dwordx4 v3, s[8:11], s21 offen offset:1024 sc1 lds
M v[116:119],v[40:43],a[108:111],v[116:119]
MF v105,s5,v105
MF v106,s5,v106
M v[116:119],v[36:39],a[100:103],v[116:119]
s_waitcnt lgkmcnt(0)
buffer_load_dwordx4 v3, s[8:11], s21 offen offset:2048 sc1 lds
M v[116:119],v[32:35],a[236:239],v[116:119]
s_barrier
M v[120:123],a[144:147],a[232:235],v[120:123]
SA s30,s32,8192
T v[32:33],v16,0
T v[34:35],v16,2048
M v[120:123],a[148:151],a[96:99],v[120:123]
buffer_store_dwordx4 a[44:47], v6, s[8:11], s30 offen offset:3072 sc1
M v[120:123],a[152:155],a[104:107],v[120:123]
s_nop 0
T v[36:37],v16,4096
T v[38:39],v16,6144
M v[120:123],a[156:159],a[112:115],v[120:123]
T v[40:41],v16,8192
T v[42:43],v16,10240
M v[120:123],a[160:163],a[120:123],v[120:123]
buffer_load_dwordx4 v3, s[8:11], s21 offen offset:3072 sc1 lds
M v[120:123],a[164:167],a[128:131],v[120:123]
SA m0,s28,102400
T v[44:45],v16,12288
T v[46:47],v16,14336
M v[120:123],a[168:171],a[136:139],v[120:123]
T v[48:49],v16,16384
T v[50:51],v16,18432
M v[124:127],a[168:171],a[140:143],v[124:127]
buffer_load_dwordx4 v4, s[8:11], s21 offen offset:0 sc1 lds
M v[124:127],a[164:167],a[132:135],v[124:127]
s_nop 0
T v[52:53],v16,20480
T v[54:55],v16,22528
M v[124:127],a[160:163],a[124:127],v[124:127]
T v[56:57],v16,24576
T v[58:59],v16,26624
M v[124:127],a[156:159],a[116:119],v[124:127]
buffer_load_dwordx4 v4, s[8:11], s21 offen offset:1024 sc1 lds
M v[124:127],a[152:155],a[108:111],v[124:127]
MF v107,s5,v107
C v96,v96,v97
M v[124:127],a[148:151],a[100:103],v[124:127]
buffer_load_dwordx4 v4, s[8:11], s21 offen offset:2048 sc1 lds
M v[124:127],a[144:147],a[236:239],v[124:127]
s_waitcnt lgkmcnt(6)
C v97,v98,v99
C v98,v104,v105
M v[160:163],v[32:35],a[176:179],0
T a[144:145],v17,0
T a[146:147],v17,2048
M v[160:163],v[36:39],a[184:187],v[160:163]
buffer_load_dwordx4 v4, s[8:11], s21 offen offset:3072 sc1 lds
M v[160:163],v[40:43],a[192:195],v[160:163]
s_waitcnt lgkmcnt(2)
s_nop 0
T a[148:149],v17,4096
T a[150:151],v17,6144
M v[160:163],v[44:47],a[200:203],v[160:163]
SA s21,s21,32768
T a[152:153],v17,8192
T a[154:155],v17,10240
M v[160:163],v[48:51],a[208:211],v[160:163]
s_sub_u32 s22, s22, 1
C v99,v106,v107
W a16,v96
M v[160:163],v[52:55],a[216:219],v[160:163]
s_cselect_b32 s21, s23, s21
T a[156:157],v17,12288
T a[158:159],v17,14336
M v[160:163],v[56:59],a[224:227],v[160:163]
SA m0,s28,65536
T a[160:161],v17,16384
T a[162:163],v17,18432
M v[164:167],v[56:59],a[228:231],0
buffer_load_dwordx4 v3, s[8:11], s21 offen offset:0 sc1 lds
M v[164:167],v[52:55],a[220:223],v[164:167]
s_nop 0
T a[164:165],v17,20480
T a[166:167],v17,22528
M v[164:167],v[48:51],a[212:215],v[164:167]
T a[168:169],v17,24576
T a[170:171],v17,26624
M v[164:167],v[44:47],a[204:207],v[164:167]
buffer_load_dwordx4 v3, s[8:11], s21 offen offset:1024 sc1 lds
M v[164:167],v[40:43],a[196:199],v[164:167]
buffer_load_dword v5, v31, s[8:11], s46 offen offset:4 sc1
M v[164:167],v[36:39],a[188:191],v[164:167]
buffer_load_dwordx4 v3, s[8:11], s21 offen offset:2048 sc1 lds
M v[164:167],v[32:35],a[180:183],v[164:167]
s_waitcnt lgkmcnt(6)
W a17,v97
W a18,v98
M v[168:171],a[144:147],a[176:179],0
T v[32:33],v18,0
T v[34:35],v18,2048
M v[168:171],a[148:151],a[184:187],v[168:171]
buffer_load_dwordx4 v3, s[8:11], s21 offen offset:3072 sc1 lds
M v[168:171],a[152:155],a[192:195],v[168:171]
s_waitcnt lgkmcnt(2)
s_nop 0
T v[36:37],v18,4096
T v[38:39],v18,6144
M v[168:171],a[156:159],a[200:203],v[168:171]
SA m0,s28,69632
T v[40:41],v18,8192
T v[42:43],v18,10240
M v[168:171],a[160:163],a[208:211],v[168:171]
buffer_load_dwordx4 v4, s[8:11], s21 offen offset:0 sc1 lds
M v[168:171],a[164:167],a[216:219],v[168:171]
s_nop 0
T v[44:45],v18,12288
T v[46:47],v18,14336
M v[168:171],a[168:171],a[224:227],v[168:171]
T v[48:49],v18,16384
T v[50:51],v18,18432
M v[172:175],a[168:171],a[228:231],0
buffer_load_dwordx4 v4, s[8:11], s21 offen offset:1024 sc1 lds
M v[172:175],a[164:167],a[220:223],v[172:175]
s_nop 0
T v[52:53],v18,20480
T v[54:55],v18,22528
M v[172:175],a[160:163],a[212:215],v[172:175]
T v[56:57],v18,24576
T v[58:59],v18,26624
M v[172:175],a[156:159],a[204:207],v[172:175]
buffer_load_dwordx4 v4, s[8:11], s21 offen offset:2048 sc1 lds
M v[172:175],a[152:155],a[196:199],v[172:175]
W a19,v99
MF v100,s5,v100
M v[172:175],a[148:151],a[188:191],v[172:175]
SA s30,s32,4096
buffer_store_dwordx4 a[16:19], v6, s[8:11], s30 offen offset:0 sc1
M v[172:175],a[144:147],a[180:183],v[172:175]
s_waitcnt lgkmcnt(6)
MF v101,s5,v101
MF v102,s5,v102
M v[176:179],v[32:35],a[176:179],0
T a[144:145],v19,0
T a[146:147],v19,2048
M v[176:179],v[36:39],a[184:187],v[176:179]
buffer_load_dwordx4 v4, s[8:11], s21 offen offset:3072 sc1 lds
M v[176:179],v[40:43],a[192:195],v[176:179]
s_waitcnt lgkmcnt(2)
s_nop 0
T a[148:149],v19,4096
T a[150:151],v19,6144
M v[176:179],v[44:47],a[200:203],v[176:179]
SA s21,s21,32768
T a[152:153],v19,8192
T a[154:155],v19,10240
M v[176:179],v[48:51],a[208:211],v[176:179]
s_sub_u32 s22, s22, 1
MF v103,s5,v103
MF v108,s5,v108
M v[176:179],v[52:55],a[216:219],v[176:179]
s_cselect_b32 s21, s23, s21
T a[156:157],v19,12288
T a[158:159],v19,14336
M v[176:179],v[56:59],a[224:227],v[176:179]
T a[160:161],v19,16384
T a[162:163],v19,18432
M v[180:183],v[56:59],a[228:231],0
MF v109,s5,v109
MF v110,s5,v110
M v[180:183],v[52:55],a[220:223],v[180:183]
T a[164:165],v19,20480
T a[166:167],v19,22528
M v[180:183],v[48:51],a[212:215],v[180:183]
T a[168:169],v19,24576
T a[170:171],v19,26624
M v[180:183],v[44:47],a[204:207],v[180:183]
MF v111,s5,v111
C v100,v100,v101
M v[180:183],v[40:43],a[196:199],v[180:183]
C v101,v102,v103
C v102,v108,v109
M v[180:183],v[36:39],a[188:191],v[180:183]
C v103,v110,v111
W a48,v100
M v[180:183],v[32:35],a[180:183],v[180:183]
s_waitcnt lgkmcnt(6)
W a49,v101
W a50,v102
M v[184:187],a[144:147],a[176:179],0
T v[32:33],v16,28672
T v[34:35],v16,30720
M v[184:187],a[148:151],a[184:187],v[184:187]
W a51,v103
MF v112,s5,v112
M v[184:187],a[152:155],a[192:195],v[184:187]
s_waitcnt lgkmcnt(2)
T v[36:37],v16,40960
T v[38:39],v16,43008
M v[184:187],a[156:159],a[200:203],v[184:187]
T v[40:41],v16,45056
T v[42:43],v16,47104
M v[184:187],a[160:163],a[208:211],v[184:187]
MF v113,s5,v113
MF v114,s5,v114
M v[184:187],a[164:167],a[216:219],v[184:187]
T v[44:45],v16,49152
T v[46:47],v16,51200
M v[184:187],a[168:171],a[224:227],v[184:187]
T v[48:49],v16,53248
T v[50:51],v16,55296
M v[188:191],a[168:171],a[228:231],0
MF v115,s5,v115
MF v120,s5,v120
M v[188:191],a[164:167],a[220:223],v[188:191]
SA s30,s32,12288
T v[52:53],v16,57344
T v[54:55],v16,59392
M v[188:191],a[160:163],a[212:215],v[188:191]
T v[56:57],v16,61440
T v[58:59],v16,63488
M v[188:191],a[156:159],a[204:207],v[188:191]
buffer_store_dwordx4 a[48:51], v6, s[8:11], s30 offen offset:0 sc1
M v[188:191],a[152:155],a[196:199],v[188:191]
MF v121,s5,v121
MF v122,s5,v122
M v[188:191],a[148:151],a[188:191],v[188:191]
MF v123,s5,v123
C v112,v112,v113
M v[188:191],a[144:147],a[180:183],v[188:191]
s_waitcnt lgkmcnt(6)
C v113,v114,v115
C v114,v120,v121
M v[160:163],v[32:35],a[232:235],v[160:163]
T a[144:145],v17,28672
T a[146:147],v17,30720
M v[160:163],v[36:39],a[96:99],v[160:163]
C v115,v122,v123
W a20,v112
M v[160:163],v[40:43],a[104:107],v[160:163]
s_waitcnt lgkmcnt(2)
T a[148:149],v17,40960
T a[150:151],v17,43008
M v[160:163],v[44:47],a[112:115],v[160:163]
T a[152:153],v17,45056
T a[154:155],v17,47104
M v[160:163],v[48:51],a[120:123],v[160:163]
W a21,v113
W a22,v114
M v[160:163],v[52:55],a[128:131],v[160:163]
T a[156:157],v17,49152
T a[158:159],v17,51200
M v[160:163],v[56:59],a[136:139],v[160:163]
T a[160:161],v17,53248
T a[162:163],v17,55296
M v[164:167],v[56:59],a[140:143],v[164:167]
W a23,v115
MF v116,s5,v116
M v[164:167],v[52:55],a[132:135],v[164:167]
T a[164:165],v17,57344
T a[166:167],v17,59392
M v[164:167],v[48:51],a[124:127],v[164:167]
T a[168:169],v17,61440
T a[170:171],v17,63488
M v[164:167],v[44:47],a[116:119],v[164:167]
MF v117,s5,v117
MF v118,s5,v118
M v[164:167],v[40:43],a[108:111],v[164:167]
MF v119,s5,v119
MF v124,s5,v124
M v[164:167],v[36:39],a[100:103],v[164:167]
MF v125,s5,v125
MF v126,s5,v126
M v[164:167],v[32:35],a[236:239],v[164:167]
s_waitcnt lgkmcnt(6)
MF v127,s5,v127
C v116,v116,v117
M v[168:171],a[144:147],a[232:235],v[168:171]
T v[32:33],v18,28672
T v[34:35],v18,30720
M v[168:171],a[148:151],a[96:99],v[168:171]
C v117,v118,v119
C v118,v124,v125
M v[168:171],a[152:155],a[104:107],v[168:171]
s_waitcnt lgkmcnt(2)
T v[36:37],v18,40960
T v[38:39],v18,43008
M v[168:171],a[156:159],a[112:115],v[168:171]
T v[40:41],v18,45056
T v[42:43],v18,47104
M v[168:171],a[160:163],a[120:123],v[168:171]
C v119,v126,v127
W a52,v116
M v[168:171],a[164:167],a[128:131],v[168:171]
T v[44:45],v18,49152
T v[46:47],v18,51200
M v[168:171],a[168:171],a[136:139],v[168:171]
SA s30,s32,4096
T v[48:49],v18,53248
T v[50:51],v18,55296
M v[172:175],a[168:171],a[140:143],v[172:175]
buffer_store_dwordx4 a[20:23], v6, s[8:11], s30 offen offset:1024 sc1
M v[172:175],a[164:167],a[132:135],v[172:175]
s_nop 0
T v[52:53],v18,57344
T v[54:55],v18,59392
M v[172:175],a[160:163],a[124:127],v[172:175]
T v[56:57],v18,61440
T v[58:59],v18,63488
M v[172:175],a[156:159],a[116:119],v[172:175]
W a53,v117
W a54,v118
M v[172:175],a[152:155],a[108:111],v[172:175]
W a55,v119
s_waitcnt vmcnt(9)
v_cmp_ne_u32 vcc, 1, v5
M v[172:175],a[148:151],a[100:103],v[172:175]
s_nop 0
MF v160,s5,v160
MF v161,s5,v161
M v[172:175],a[144:147],a[236:239],v[172:175]
s_waitcnt lgkmcnt(6)
MF v162,s5,v162
MF v163,s5,v163
M v[176:179],v[32:35],a[232:235],v[176:179]
s_cmp_lg_u32 vcc_hi, 0
T a[144:145],v19,28672
T a[146:147],v19,30720
M v[176:179],v[36:39],a[96:99],v[176:179]
s_cbranch_scc1 L_wsr1
L_wrr1:
MF v168,s5,v168
MF v169,s5,v169
M v[176:179],v[40:43],a[104:107],v[176:179]
s_waitcnt lgkmcnt(2)
T a[148:149],v19,40960
T a[150:151],v19,43008
M v[176:179],v[44:47],a[112:115],v[176:179]
SA m0,s28,131072
T a[152:153],v19,45056
T a[154:155],v19,47104
M v[176:179],v[48:51],a[120:123],v[176:179]
buffer_load_dwordx4 v3, s[8:11], s26 offen offset:0 sc1 lds
M v[176:179],v[52:55],a[128:131],v[176:179]
s_nop 0
T a[156:157],v19,49152
T a[158:159],v19,51200
M v[176:179],v[56:59],a[136:139],v[176:179]
T a[160:161],v19,53248
T a[162:163],v19,55296
M v[180:183],v[56:59],a[140:143],v[180:183]
buffer_load_dwordx4 v3, s[8:11], s26 offen offset:1024 sc1 lds
M v[180:183],v[52:55],a[132:135],v[180:183]
s_nop 0
T a[164:165],v19,57344
T a[166:167],v19,59392
M v[180:183],v[48:51],a[124:127],v[180:183]
T a[168:169],v19,61440
T a[170:171],v19,63488
M v[180:183],v[44:47],a[116:119],v[180:183]
buffer_load_dwordx4 v3, s[8:11], s26 offen offset:2048 sc1 lds
M v[180:183],v[40:43],a[108:111],v[180:183]
MF v170,s5,v170
MF v171,s5,v171
M v[180:183],v[36:39],a[100:103],v[180:183]
s_waitcnt lgkmcnt(0)
buffer_load_dwordx4 v3, s[8:11], s26 offen offset:3072 sc1 lds
M v[180:183],v[32:35],a[236:239],v[180:183]
s_barrier
M v[184:187],a[144:147],a[232:235],v[184:187]
SA m0,s28,135168
R a[64:67],v2,32768
R a[68:71],v2,33792
M v[184:187],a[148:151],a[96:99],v[184:187]
buffer_load_dwordx4 v4, s[8:11], s26 offen offset:0 sc1 lds
M v[184:187],a[152:155],a[104:107],v[184:187]
C v160,v160,v161
C v161,v162,v163
M v[184:187],a[156:159],a[112:115],v[184:187]
SA s30,s32,12288
R a[72:75],v2,34816
R a[76:79],v2,35840
M v[184:187],a[160:163],a[120:123],v[184:187]
buffer_store_dwordx4 a[52:55], v6, s[8:11], s30 offen offset:1024 sc1
M v[184:187],a[164:167],a[128:131],v[184:187]
C v162,v168,v169
C v163,v170,v171
M v[184:187],a[168:171],a[136:139],v[184:187]
R a[80:83],v2,36864
R a[84:87],v2,37888
M v[188:191],a[168:171],a[140:143],v[188:191]
buffer_load_dwordx4 v4, s[8:11], s26 offen offset:1024 sc1 lds
M v[188:191],a[164:167],a[132:135],v[188:191]
W a24,v160
W a25,v161
M v[188:191],a[160:163],a[124:127],v[188:191]
R a[88:91],v2,38912
R a[92:95],v2,39936
M v[188:191],a[156:159],a[116:119],v[188:191]
buffer_load_dwordx4 v4, s[8:11], s26 offen offset:2048 sc1 lds
M v[188:191],a[152:155],a[108:111],v[188:191]
W a26,v162
W a27,v163
M v[188:191],a[148:151],a[100:103],v[188:191]
buffer_load_dwordx4 v4, s[8:11], s26 offen offset:3072 sc1 lds
M v[188:191],a[144:147],a[236:239],v[188:191]
s_waitcnt lgkmcnt(0)
SA s30,s32,4096
buffer_store_dwordx4 a[24:27], v6, s[8:11], s30 offen offset:2048 sc1
SA s26,s26,32768
MF v164,s5,v164
MF v165,s5,v165
MF v166,s5,v166
MF v167,s5,v167
MF v172,s5,v172
MF v173,s5,v173
MF v174,s5,v174
MF v175,s5,v175
C v164,v164,v165
C v165,v166,v167
C v166,v172,v173
C v167,v174,v175
W a56,v164
W a57,v165
W a58,v166
W a59,v167
SA s30,s32,12288
buffer_store_dwordx4 a[56:59], v6, s[8:11], s30 offen offset:2048 sc1
v_mov_b32 v30, 2
buffer_store_dword v30, v1, s[8:11], s45 offen sc1
M v[64:67],a[64:67],a[0:3],0
R a[96:99],v2,40960
R a[100:103],v2,41984
M v[64:67],a[68:71],a[4:7],v[64:67]
MF v176,s5,v176
MF v177,s5,v177
M v[64:67],a[72:75],a[8:11],v[64:67]
MF v178,s5,v178
MF v179,s5,v179
M v[64:67],a[76:79],a[12:15],v[64:67]
R a[104:107],v2,43008
R a[108:111],v2,44032
M v[64:67],a[80:83],a[16:19],v[64:67]
MF v184,s5,v184
MF v185,s5,v185
MF v186,s5,v186
MF v187,s5,v187
C v176,v176,v177
C v177,v178,v179
C v178,v184,v185
C v179,v186,v187
W a28,v176
W a29,v177
W a30,v178
W a31,v179
M v[64:67],a[84:87],a[20:23],v[64:67]
MF v180,s5,v180
MF v181,s5,v181
M v[64:67],a[88:91],a[24:27],v[64:67]
R a[112:115],v2,45056
R a[116:119],v2,46080
M v[64:67],a[92:95],a[28:31],v[64:67]
MF v182,s5,v182
MF v183,s5,v183
M v[68:71],a[64:67],a[32:35],0
MF v188,s5,v188
MF v189,s5,v189
M v[68:71],a[68:71],a[36:39],v[68:71]
R a[120:123],v2,47104
R a[124:127],v2,48128
M v[68:71],a[72:75],a[40:43],v[68:71]
SA m0,s28,32768
MF v190,s5,v190
MF v191,s5,v191
M v[68:71],a[76:79],a[44:47],v[68:71]
buffer_load_dwordx4 v3, s[8:11], s26 offen offset:0 sc1 lds
M v[68:71],a[80:83],a[48:51],v[68:71]
C v180,v180,v181
C v181,v182,v183
C v182,v188,v189
C v183,v190,v191
W a60,v180
W a61,v181
W a62,v182
W a63,v183
M v[68:71],a[84:87],a[52:55],v[68:71]
SA s30,s32,4096
buffer_store_dwordx4 a[28:31], v6, s[8:11], s30 offen offset:3072 sc1
M v[68:71],a[88:91],a[56:59],v[68:71]
SA s30,s32,12288
E v18,v64
M v[68:71],a[92:95],a[60:63],v[68:71]
s_waitcnt lgkmcnt(0)
buffer_store_dwordx4 a[60:63], v6, s[8:11], s30 offen offset:3072 sc1
M v[72:75],a[96:99],a[0:3],0
R a[64:67],v2,49152
R a[68:71],v2,50176
M v[72:75],a[100:103],a[4:7],v[72:75]
E v19,v65
M v[72:75],a[104:107],a[8:11],v[72:75]
buffer_load_dwordx4 v3, s[8:11], s26 offen offset:1024 sc1 lds
M v[72:75],a[108:111],a[12:15],v[72:75]
R a[72:75],v2,51200
R a[76:79],v2,52224
M v[72:75],a[112:115],a[16:19],v[72:75]
E v20,v66
M v[72:75],a[116:119],a[20:23],v[72:75]
buffer_load_dwordx4 v3, s[8:11], s26 offen offset:2048 sc1 lds
M v[72:75],a[120:123],a[24:27],v[72:75]
R a[80:83],v2,53248
R a[84:87],v2,54272
M v[72:75],a[124:127],a[28:31],v[72:75]
E v21,v67
M v[76:79],a[124:127],a[60:63],0
buffer_load_dwordx4 v3, s[8:11], s26 offen offset:3072 sc1 lds
M v[76:79],a[120:123],a[56:59],v[76:79]
SA m0,s28,36864
R a[88:91],v2,55296
R a[92:95],v2,56320
M v[76:79],a[116:119],a[52:55],v[76:79]
E v22,v68
M v[76:79],a[112:115],a[48:51],v[76:79]
buffer_load_dwordx4 v4, s[8:11], s26 offen offset:0 sc1 lds
M v[76:79],a[108:111],a[44:47],v[76:79]
E v23,v69
M v[76:79],a[104:107],a[40:43],v[76:79]
AF v26,v18,v19
C v40,v18,v19
M v[76:79],a[100:103],a[36:39],v[76:79]
buffer_load_dwordx4 v4, s[8:11], s26 offen offset:1024 sc1 lds
M v[76:79],a[96:99],a[32:35],v[76:79]
s_waitcnt lgkmcnt(0)
v_add_u32 v16, 0x20000, v7
AF v26,v20,v26
M v[80:83],a[64:67],a[0:3],0
R a[96:99],v2,57344
R a[100:103],v2,58368
M v[80:83],a[68:71],a[4:7],v[80:83]
buffer_load_dwordx4 v4, s[8:11], s26 offen offset:2048 sc1 lds
M v[80:83],a[72:75],a[8:11],v[80:83]
E v24,v70
M v[80:83],a[76:79],a[12:15],v[80:83]
R a[104:107],v2,59392
R a[108:111],v2,60416
M v[80:83],a[80:83],a[16:19],v[80:83]
buffer_load_dwordx4 v4, s[8:11], s26 offen offset:3072 sc1 lds
M v[80:83],a[84:87],a[20:23],v[80:83]
SA s26,s26,32768
E v25,v71
M v[80:83],a[88:91],a[24:27],v[80:83]
R a[112:115],v2,61440
R a[116:119],v2,62464
M v[80:83],a[92:95],a[28:31],v[80:83]
E v18,v72
M v[84:87],a[92:95],a[60:63],0
E v19,v73
M v[84:87],a[88:91],a[56:59],v[84:87]
R a[120:123],v2,63488
R a[124:127],v2,64512
M v[84:87],a[84:87],a[52:55],v[84:87]
C v41,v20,v21
AF v26,v21,v26
M v[84:87],a[80:83],a[48:51],v[84:87]
E v20,v74
M v[84:87],a[76:79],a[44:47],v[84:87]
AF v27,v22,v23
C v44,v22,v23
M v[84:87],a[72:75],a[40:43],v[84:87]
AF v27,v24,v27
C v45,v24,v25
M v[84:87],a[68:71],a[36:39],v[84:87]
s_waitcnt vmcnt(24) lgkmcnt(0)
E v21,v75
M v[84:87],a[64:67],a[32:35],v[84:87]
s_barrier
M v[88:91],a[96:99],a[0:3],0
R a[64:67],v2,0
R a[68:71],v2,1024
M v[88:91],a[100:103],a[4:7],v[88:91]
E v22,v76
M v[88:91],a[104:107],a[8:11],v[88:91]
AF v27,v25,v27
AF v26,v18,v26
M v[88:91],a[108:111],a[12:15],v[88:91]
R a[72:75],v2,2048
R a[76:79],v2,3072
M v[88:91],a[112:115],a[16:19],v[88:91]
E v23,v77
M v[88:91],a[116:119],a[20:23],v[88:91]
C v42,v18,v19
AF v26,v19,v26
M v[88:91],a[120:123],a[24:27],v[88:91]
R a[80:83],v2,4096
R a[84:87],v2,5120
M v[88:91],a[124:127],a[28:31],v[88:91]
E v24,v78
M v[92:95],a[124:127],a[60:63],0
AF v26,v20,v26
C v43,v20,v21
M v[92:95],a[120:123],a[56:59],v[92:95]
R a[88:91],v2,6144
R a[92:95],v2,7168
M v[92:95],a[116:119],a[52:55],v[92:95]
E v25,v79
M v[92:95],a[112:115],a[48:51],v[92:95]
AF v26,v21,v26
AF v27,v22,v27
M v[92:95],a[108:111],a[44:47],v[92:95]
C v46,v22,v23
AF v27,v23,v27
M v[92:95],a[104:107],a[40:43],v[92:95]
AF v27,v24,v27
C v47,v24,v25
M v[92:95],a[100:103],a[36:39],v[92:95]
s_waitcnt lgkmcnt(0)
AF v27,v25,v27
M v[92:95],a[96:99],a[32:35],v[92:95]
M v[96:99],a[64:67],a[0:3],0
R a[96:99],v2,8192
R a[100:103],v2,9216
M v[96:99],a[68:71],a[4:7],v[96:99]
SA m0,s28,98304
W a128,v128
W a129,v129
M v[96:99],a[72:75],a[8:11],v[96:99]
buffer_load_dwordx4 v3, s[8:11], s21 offen offset:0 sc1 lds
M v[96:99],a[76:79],a[12:15],v[96:99]
R a[104:107],v2,10240
R a[108:111],v2,11264
M v[96:99],a[80:83],a[16:19],v[96:99]
W a130,v130
v_mov_b32 v30, 0
M v[96:99],a[84:87],a[20:23],v[96:99]
W a131,v131
M v[96:99],a[88:91],a[24:27],v[96:99]
R a[112:115],v2,12288
R a[116:119],v2,13312
M v[96:99],a[92:95],a[28:31],v[96:99]
buffer_load_dwordx4 v3, s[8:11], s21 offen offset:1024 sc1 lds
M v[100:103],a[92:95],a[60:63],0
W a132,v132
v_mov_b32 v31, 0
M v[100:103],a[88:91],a[56:59],v[100:103]
R a[120:123],v2,14336
R a[124:127],v2,15360
M v[100:103],a[84:87],a[52:55],v[100:103]
W a133,v133
W a134,v134
M v[100:103],a[80:83],a[48:51],v[100:103]
buffer_load_dwordx4 v3, s[8:11], s21 offen offset:2048 sc1 lds
M v[100:103],a[76:79],a[44:47],v[100:103]
W a135,v135
M v[100:103],a[72:75],a[40:43],v[100:103]
v_mov_b32 v32, 0
M v[100:103],a[68:71],a[36:39],v[100:103]
W a136,v136
M v[100:103],a[64:67],a[32:35],v[100:103]
s_waitcnt lgkmcnt(0)
buffer_load_dwordx4 v3, s[8:11], s21 offen offset:3072 sc1 lds
M v[108:111],a[96:99],a[32:35],0
SA m0,s28,102400
R a[64:67],v2,16384
R a[68:71],v2,17408
M v[108:111],a[100:103],a[36:39],v[108:111]
W a137,v137
v_mov_b32 v33, 0
M v[108:111],a[104:107],a[40:43],v[108:111]
W a138,v138
M v[108:111],a[108:111],a[44:47],v[108:111]
R a[72:75],v2,18432
R a[76:79],v2,19456
M v[108:111],a[112:115],a[48:51],v[108:111]
buffer_load_dwordx4 v4, s[8:11], s21 offen offset:0 sc1 lds
M v[108:111],a[116:119],a[52:55],v[108:111]
W a139,v139
W a140,v140
M v[108:111],a[120:123],a[56:59],v[108:111]
R a[80:83],v2,20480
R a[84:87],v2,21504
M v[108:111],a[124:127],a[60:63],v[108:111]
buffer_load_dwordx4 v4, s[8:11], s21 offen offset:1024 sc1 lds
M v[104:107],a[124:127],a[28:31],0
v_mov_b32 v34, 0
W a141,v141
M v[104:107],a[120:123],a[24:27],v[104:107]
R a[88:91],v2,22528
R a[92:95],v2,23552
M v[104:107],a[116:119],a[20:23],v[104:107]
buffer_load_dwordx4 v4, s[8:11], s21 offen offset:2048 sc1 lds
M v[104:107],a[112:115],a[16:19],v[104:107]
W a142,v142
W a143,v143
M v[104:107],a[108:111],a[12:15],v[104:107]
v_mov_b32 v35, 0
W a144,v144
M v[104:107],a[104:107],a[8:11],v[104:107]
W a145,v145
M v[104:107],a[100:103],a[4:7],v[104:107]
buffer_load_dwordx4 v4, s[8:11], s21 offen offset:3072 sc1 lds
M v[104:107],a[96:99],a[0:3],v[104:107]
s_waitcnt lgkmcnt(0)
v_mov_b32 v36, 0
W a146,v146
M v[112:115],a[64:67],a[0:3],0
SA s21,s21,32768
R a[96:99],v2,24576
R a[100:103],v2,25600
M v[112:115],a[68:71],a[4:7],v[112:115]
s_sub_u32 s22, s22, 1
W a147,v147
M v[112:115],a[72:75],a[8:11],v[112:115]
s_cselect_b32 s21, s23, s21
E v18,v80
M v[112:115],a[76:79],a[12:15],v[112:115]
R a[104:107],v2,26624
R a[108:111],v2,27648
M v[112:115],a[80:83],a[16:19],v[112:115]
W a148,v148
v_mov_b32 v37, 0
M v[112:115],a[84:87],a[20:23],v[112:115]
W a149,v149
M v[112:115],a[88:91],a[24:27],v[112:115]
R a[112:115],v2,28672
R a[116:119],v2,29696
M v[112:115],a[92:95],a[28:31],v[112:115]
W a150,v150
M v[116:119],a[92:95],a[60:63],0
v_mov_b32 v38, 0
W a151,v151
M v[116:119],a[88:91],a[56:59],v[116:119]
R a[120:123],v2,30720
R a[124:127],v2,31744
M v[116:119],a[84:87],a[52:55],v[116:119]
W a152,v152
M v[116:119],a[80:83],a[48:51],v[116:119]
W a153,v153
M v[116:119],a[76:79],a[44:47],v[116:119]
E v19,v81
M v[116:119],a[72:75],a[40:43],v[116:119]
v_mov_b32 v39, 0
W a154,v154
M v[116:119],a[68:71],a[36:39],v[116:119]
s_waitcnt vmcnt(21) lgkmcnt(0)
E v20,v82
M v[116:119],a[64:67],a[32:35],v[116:119]
s_barrier
M v[124:127],a[96:99],a[32:35],0
R a[64:67],v16,0
R a[68:71],v16,1024
M v[124:127],a[100:103],a[36:39],v[124:127]
W a155,v155
W a156,v156
M v[124:127],a[104:107],a[40:43],v[124:127]
W a157,v157
AF v26,v18,v26
M v[124:127],a[108:111],a[44:47],v[124:127]
R a[72:75],v16,2048
R a[76:79],v16,3072
M v[124:127],a[112:115],a[48:51],v[124:127]
W a158,v158
C v56,v18,v19
M v[124:127],a[116:119],a[52:55],v[124:127]
E v21,v83
M v[124:127],a[120:123],a[56:59],v[124:127]
R a[80:83],v16,4096
R a[84:87],v16,5120
M v[124:127],a[124:127],a[60:63],v[124:127]
W a159,v159
AF v26,v19,v26
M v[120:123],a[124:127],a[28:31],0
E v22,v88
M v[120:123],a[120:123],a[24:27],v[120:123]
R a[88:91],v16,6144
R a[92:95],v16,7168
M v[120:123],a[116:119],a[20:23],v[120:123]
E v23,v89
M v[120:123],a[112:115],a[16:19],v[120:123]
E v24,v90
M v[120:123],a[108:111],a[12:15],v[120:123]
E v25,v91
M v[120:123],a[104:107],a[8:11],v[120:123]
E v18,v84
M v[120:123],a[100:103],a[4:7],v[120:123]
s_waitcnt lgkmcnt(0)
E v19,v85
M v[120:123],a[96:99],a[0:3],v[120:123]
AF v26,v20,v26
C v57,v20,v21
AF v26,v21,v26
AF v26,v22,v26
C v58,v22,v23
AF v26,v23,v26
AF v26,v24,v26
C v59,v24,v25
AF v26,v25,v26
E v20,v86
E v21,v87
AF v27,v18,v27
C v60,v18,v19
AF v27,v19,v27
E v22,v92
E v23,v93
AF v27,v20,v27
C v61,v20,v21
AF v27,v21,v27
E v24,v94
E v25,v95
AF v27,v22,v27
C v62,v22,v23
AF v27,v23,v27
AF v27,v24,v27
C v63,v24,v25
AF v27,v25,v27
v_max_f32 v10, v26, v27
v_min_f32 v11, v26, v27
v_cmp_lt_f32 vcc, s31, v10
v_cmp_gt_f32 s[64:65], s24, v11
s_nop 0
s_or_b64 vcc, vcc, s[64:65]
s_cbranch_vccnz L_stv1
L_rtv1:
M v[128:131],a[64:67],v[40:43],0
R a[96:99],v16,8192
R a[100:103],v16,9216
M v[128:131],a[68:71],v[56:59],v[128:131]
SA m0,s28,65536
W a160,v192
W a161,v193
M v[132:135],a[68:71],v[60:63],0
buffer_load_dwordx4 v3, s[8:11], s21 offen offset:0 sc1 lds
M v[132:135],a[64:67],v[44:47],v[132:135]
R a[104:107],v16,10240
R a[108:111],v16,11264
M v[140:143],a[72:75],v[44:47],0
W a162,v194
W a163,v195
M v[140:143],a[76:79],v[60:63],v[140:143]
W a164,v196
W a165,v197
M v[136:139],a[76:79],v[56:59],0
R a[112:115],v16,12288
R a[116:119],v16,13312
M v[136:139],a[72:75],v[40:43],v[136:139]
buffer_load_dwordx4 v3, s[8:11], s21 offen offset:1024 sc1 lds
M v[144:147],a[80:83],v[40:43],0
W a166,v198
W a167,v199
M v[144:147],a[84:87],v[56:59],v[144:147]
R a[120:123],v16,14336
R a[124:127],v16,15360
M v[148:151],a[84:87],v[60:63],0
SA s3,s93,262144
W a168,v200
W a169,v201
M v[148:151],a[80:83],v[44:47],v[148:151]
buffer_load_dwordx4 v3, s[8:11], s21 offen offset:2048 sc1 lds
M v[156:159],a[88:91],v[44:47],0
W a170,v202
W a171,v203
M v[156:159],a[92:95],v[60:63],v[156:159]
W a172,v204
W a173,v205
M v[152:155],a[92:95],v[56:59],0
buffer_store_dwordx4 a[128:131], v7, s[8:11], s3 offen offset:0 sc1
M v[152:155],a[88:91],v[40:43],v[152:155]
s_waitcnt lgkmcnt(0)
W a174,v206
W a175,v207
M v[160:163],a[96:99],v[40:43],0
R a[64:67],v16,16384
R a[68:71],v16,17408
M v[160:163],a[100:103],v[56:59],v[160:163]
buffer_load_dwordx4 v3, s[8:11], s21 offen offset:3072 sc1 lds
M v[164:167],a[100:103],v[60:63],0
SA m0,s28,69632
W a176,v208
W a177,v209
M v[164:167],a[96:99],v[44:47],v[164:167]
R a[72:75],v16,18432
R a[76:79],v16,19456
M v[172:175],a[104:107],v[44:47],0
buffer_load_dwordx4 v4, s[8:11], s21 offen offset:0 sc1 lds
M v[172:175],a[108:111],v[60:63],v[172:175]
W a178,v210
W a179,v211
M v[168:171],a[108:111],v[56:59],0
R a[80:83],v16,20480
R a[84:87],v16,21504
M v[168:171],a[104:107],v[40:43],v[168:171]
buffer_load_dwordx4 v4, s[8:11], s21 offen offset:1024 sc1 lds
M v[176:179],a[112:115],v[40:43],0
W a180,v212
W a181,v213
M v[176:179],a[116:119],v[56:59],v[176:179]
R a[88:91],v16,22528
R a[92:95],v16,23552
M v[180:183],a[116:119],v[60:63],0
buffer_load_dwordx4 v4, s[8:11], s21 offen offset:2048 sc1 lds
M v[180:183],a[112:115],v[44:47],v[180:183]
W a182,v214
W a183,v215
M v[188:191],a[120:123],v[44:47],0
W a184,v216
W a185,v217
W a186,v218
W a187,v219
W a188,v220
W a189,v221
W a190,v222
W a191,v223
M v[188:191],a[124:127],v[60:63],v[188:191]
E v18,v96
M v[184:187],a[124:127],v[56:59],0
buffer_load_dwordx4 v4, s[8:11], s21 offen offset:3072 sc1 lds
M v[184:187],a[120:123],v[40:43],v[184:187]
s_waitcnt lgkmcnt(0)
v_min_u32 v17, 1, v7
v_lshlrev_b32 v17, 29, v17
M v[192:195],a[64:67],v[40:43],0
SA s21,s21,32768
R a[96:99],v16,24576
R a[100:103],v16,25600
M v[192:195],a[68:71],v[56:59],v[192:195]
s_sub_u32 s22, s22, 1
buffer_store_dwordx4 a[132:135], v7, s[8:11], s3 offen offset:2048 sc1
M v[196:199],a[68:71],v[60:63],0
s_cselect_b32 s21, s23, s21
v_mov_b32 v15, 1
AF v30,v26,v30
M v[196:199],a[64:67],v[44:47],v[196:199]
SA s84,s47,16
R a[104:107],v16,26624
R a[108:111],v16,27648
M v[204:207],a[72:75],v[44:47],0
E v19,v97
M v[204:207],a[76:79],v[60:63],v[204:207]
E v20,v98
M v[200:203],a[76:79],v[56:59],0
R a[112:115],v16,28672
R a[116:119],v16,29696
M v[200:203],a[72:75],v[40:43],v[200:203]
E v21,v99
M v[208:211],a[80:83],v[40:43],0
E v22,v104
M v[208:211],a[84:87],v[56:59],v[208:211]
R a[120:123],v16,30720
R a[124:127],v16,31744
M v[212:215],a[84:87],v[60:63],0
SA s3,s93,266240
E v23,v105
M v[212:215],a[80:83],v[44:47],v[212:215]
buffer_store_dwordx4 a[136:139], v7, s[8:11], s3 offen offset:0 sc1
M v[220:223],a[88:91],v[44:47],0
AF v31,v27,v31
AF v28,v18,v19
M v[220:223],a[92:95],v[60:63],v[220:223]
E v24,v106
M v[216:219],a[92:95],v[56:59],0
s_waitcnt vmcnt(11) lgkmcnt(0)
E v25,v107
M v[216:219],a[88:91],v[40:43],v[216:219]
s_barrier
M v[224:227],a[96:99],v[40:43],0
R a[64:67],v2,32768
R a[68:71],v2,33792
M v[224:227],a[100:103],v[56:59],v[224:227]
buffer_store_dword v15, v17, s[8:11], s84 offen sc1
M v[228:231],a[100:103],v[60:63],0
C v48,v18,v19
AF v28,v20,v28
M v[228:231],a[96:99],v[44:47],v[228:231]
R a[72:75],v2,34816
R a[76:79],v2,35840
M v[236:239],a[104:107],v[44:47],0
E v18,v100
M v[236:239],a[108:111],v[60:63],v[236:239]
E v19,v101
M v[232:235],a[108:111],v[56:59],0
R a[80:83],v2,36864
R a[84:87],v2,37888
M v[232:235],a[104:107],v[40:43],v[232:235]
C v49,v20,v21
AF v28,v21,v28
M v[240:243],a[112:115],v[40:43],0
E v20,v102
M v[240:243],a[116:119],v[56:59],v[240:243]
R a[88:91],v2,38912
R a[92:95],v2,39936
M v[244:247],a[116:119],v[60:63],0
E v21,v103
M v[244:247],a[112:115],v[44:47],v[244:247]
AF v28,v22,v28
C v50,v22,v23
M v[252:255],a[120:123],v[44:47],0
AF v28,v23,v28
AF v28,v24,v28
M v[252:255],a[124:127],v[60:63],v[252:255]
E v22,v108
M v[248:251],a[124:127],v[56:59],0
s_waitcnt lgkmcnt(0)
E v23,v109
M v[248:251],a[120:123],v[40:43],v[248:251]
C v51,v24,v25
AF v28,v25,v28
AF v29,v18,v19
C v52,v18,v19
AF v29,v20,v29
C v53,v20,v21
AF v29,v21,v29
E v24,v110
E v25,v111
AF v29,v22,v29
C v54,v22,v23
AF v29,v23,v29
AF v29,v24,v29
C v55,v24,v25
AF v29,v25,v29
M v[64:67],a[64:67],a[0:3],v[32:35]
R a[96:99],v2,40960
R a[100:103],v2,41984
M v[64:67],a[68:71],a[4:7],v[64:67]
SA m0,s28,0
E v18,v112
M v[64:67],a[72:75],a[8:11],v[64:67]
buffer_load_dwordx4 v3, s[8:11], s26 offen offset:0 sc1 lds
M v[64:67],a[76:79],a[12:15],v[64:67]
R a[104:107],v2,43008
R a[108:111],v2,44032
M v[64:67],a[80:83],a[16:19],v[64:67]
E v19,v113
M v[64:67],a[84:87],a[20:23],v[64:67]
AF v28,v18,v28
C v56,v18,v19
M v[64:67],a[88:91],a[24:27],v[64:67]
R a[112:115],v2,45056
R a[116:119],v2,46080
M v[64:67],a[92:95],a[28:31],v[64:67]
buffer_load_dwordx4 v3, s[8:11], s26 offen offset:1024 sc1 lds
M v[68:71],a[92:95],a[60:63],v[36:39]
E v20,v114
M v[68:71],a[88:91],a[56:59],v[68:71]
R a[120:123],v2,47104
R a[124:127],v2,48128
M v[68:71],a[84:87],a[52:55],v[68:71]
SA s3,s93,266240
E v21,v115
M v[68:71],a[80:83],a[48:51],v[68:71]
buffer_load_dwordx4 v3, s[8:11], s26 offen offset:2048 sc1 lds
M v[68:71],a[76:79],a[44:47],v[68:71]
AF v28,v19,v28
AF v28,v20,v28
M v[68:71],a[72:75],a[40:43],v[68:71]
C v57,v20,v21
AF v28,v21,v28
M v[68:71],a[68:71],a[36:39],v[68:71]
buffer_store_dwordx4 a[140:143], v7, s[8:11], s3 offen offset:2048 sc1
M v[68:71],a[64:67],a[32:35],v[68:71]
s_waitcnt lgkmcnt(0)
E v22,v120
M v[76:79],a[96:99],a[32:35],v[36:39]
R a[64:67],v2,49152
R a[68:71],v2,50176
M v[76:79],a[100:103],a[36:39],v[76:79]
buffer_load_dwordx4 v3, s[8:11], s26 offen offset:3072 sc1 lds
M v[76:79],a[104:107],a[40:43],v[76:79]
SA m0,s28,4096
E v23,v121
M v[76:79],a[108:111],a[44:47],v[76:79]
R a[72:75],v2,51200
R a[76:79],v2,52224
M v[76:79],a[112:115],a[48:51],v[76:79]
buffer_load_dwordx4 v4, s[8:11], s26 offen offset:0 sc1 lds
M v[76:79],a[116:119],a[52:55],v[76:79]
E v24,v122
M v[76:79],a[120:123],a[56:59],v[76:79]
R a[80:83],v2,53248
R a[84:87],v2,54272
M v[76:79],a[124:127],a[60:63],v[76:79]
buffer_load_dwordx4 v4, s[8:11], s26 offen offset:1024 sc1 lds
M v[72:75],a[124:127],a[28:31],v[32:35]
E v25,v123
M v[72:75],a[120:123],a[24:27],v[72:75]
SA s3,s93,270336
R a[88:91],v2,55296
R a[92:95],v2,56320
M v[72:75],a[116:119],a[20:23],v[72:75]
buffer_load_dwordx4 v4, s[8:11], s26 offen offset:2048 sc1 lds
M v[72:75],a[112:115],a[16:19],v[72:75]
AF v28,v22,v28
C v58,v22,v23
M v[72:75],a[108:111],a[12:15],v[72:75]
E v18,v116
M v[72:75],a[104:107],a[8:11],v[72:75]
AF v28,v23,v28
AF v28,v24,v28
M v[72:75],a[100:103],a[4:7],v[72:75]
buffer_load_dwordx4 v4, s[8:11], s26 offen offset:3072 sc1 lds
M v[72:75],a[96:99],a[0:3],v[72:75]
s_waitcnt lgkmcnt(0)
E v19,v117
M v[80:83],a[64:67],a[0:3],v[32:35]
SA s26,s26,32768
R a[96:99],v2,57344
R a[100:103],v2,58368
M v[80:83],a[68:71],a[4:7],v[80:83]
buffer_store_dwordx4 a[144:147], v7, s[8:11], s3 offen offset:0 sc1
M v[80:83],a[72:75],a[8:11],v[80:83]
C v59,v24,v25
AF v28,v25,v28
M v[80:83],a[76:79],a[12:15],v[80:83]
R a[104:107],v2,59392
R a[108:111],v2,60416
M v[80:83],a[80:83],a[16:19],v[80:83]
E v20,v118
M v[80:83],a[84:87],a[20:23],v[80:83]
AF v29,v18,v29
C v60,v18,v19
M v[80:83],a[88:91],a[24:27],v[80:83]
R a[112:115],v2,61440
R a[116:119],v2,62464
M v[80:83],a[92:95],a[28:31],v[80:83]
E v21,v119
M v[84:87],a[92:95],a[60:63],v[36:39]
AF v29,v19,v29
AF v29,v20,v29
M v[84:87],a[88:91],a[56:59],v[84:87]
R a[120:123],v2,63488
R a[124:127],v2,64512
M v[84:87],a[84:87],a[52:55],v[84:87]
E v22,v124
M v[84:87],a[80:83],a[48:51],v[84:87]
buffer_store_dwordx4 a[148:151], v7, s[8:11], s3 offen offset:2048 sc1
M v[84:87],a[76:79],a[44:47],v[84:87]
C v61,v20,v21
AF v29,v21,v29
M v[84:87],a[72:75],a[40:43],v[84:87]
E v23,v125
M v[84:87],a[68:71],a[36:39],v[84:87]
s_waitcnt lgkmcnt(0)
AF v29,v22,v29
C v62,v22,v23
M v[84:87],a[64:67],a[32:35],v[84:87]
s_barrier
M v[92:95],a[96:99],a[32:35],v[36:39]
R a[64:67],v7,32768
R a[68:71],v7,33792
M v[92:95],a[100:103],a[36:39],v[92:95]
E v24,v126
M v[92:95],a[104:107],a[40:43],v[92:95]
AF v29,v23,v29
M v[92:95],a[108:111],a[44:47],v[92:95]
R a[72:75],v7,34816
R a[76:79],v7,35840
M v[92:95],a[112:115],a[48:51],v[92:95]
E v25,v127
M v[92:95],a[116:119],a[52:55],v[92:95]
AF v29,v24,v29
C v63,v24,v25
M v[92:95],a[120:123],a[56:59],v[92:95]
R a[80:83],v7,36864
R a[84:87],v7,37888
M v[92:95],a[124:127],a[60:63],v[92:95]
AF v29,v25,v29
M v[88:91],a[124:127],a[28:31],v[32:35]
M v[88:91],a[120:123],a[24:27],v[88:91]
R a[88:91],v7,38912
R a[92:95],v7,39936
M v[88:91],a[116:119],a[20:23],v[88:91]
v_max_f32 v10, v28, v29
M v[88:91],a[112:115],a[16:19],v[88:91]
v_cmp_lt_f32 vcc, s31, v10
M v[88:91],a[108:111],a[12:15],v[88:91]
M v[88:91],a[104:107],a[8:11],v[88:91]
M v[88:91],a[100:103],a[4:7],v[88:91]
s_waitcnt lgkmcnt(0)
M v[88:91],a[96:99],a[0:3],v[88:91]
s_cbranch_vccnz L_stv2
L_rtv2:
M v[128:131],a[64:67],v[48:51],v[128:131]
R a[96:99],v7,40960
R a[100:103],v7,41984
M v[128:131],a[68:71],v[56:59],v[128:131]
SA m0,s28,98304
E v18,v64
M v[132:135],a[68:71],v[60:63],v[132:135]
buffer_load_dwordx4 v3, s[8:11], s21 offen offset:0 sc1 lds
M v[132:135],a[64:67],v[52:55],v[132:135]
R a[104:107],v7,43008
R a[108:111],v7,44032
M v[140:143],a[72:75],v[52:55],v[140:143]
E v19,v65
M v[140:143],a[76:79],v[60:63],v[140:143]
AF v30,v28,v30
AF v31,v29,v31
M v[136:139],a[76:79],v[56:59],v[136:139]
R a[112:115],v7,45056
R a[116:119],v7,46080
M v[136:139],a[72:75],v[48:51],v[136:139]
buffer_load_dwordx4 v3, s[8:11], s21 offen offset:1024 sc1 lds
M v[144:147],a[80:83],v[48:51],v[144:147]
E v20,v66
M v[144:147],a[84:87],v[56:59],v[144:147]
R a[120:123],v7,47104
R a[124:127],v7,48128
M v[148:151],a[84:87],v[60:63],v[148:151]
SA s3,s93,274432
AF v26,v18,v19
C v40,v18,v19
M v[148:151],a[80:83],v[52:55],v[148:151]
buffer_load_dwordx4 v3, s[8:11], s21 offen offset:2048 sc1 lds
M v[156:159],a[88:91],v[52:55],v[156:159]
E v21,v67
M v[156:159],a[92:95],v[60:63],v[156:159]
AF v26,v20,v26
C v41,v20,v21
M v[152:155],a[92:95],v[56:59],v[152:155]
buffer_store_dwordx4 a[152:155], v7, s[8:11], s3 offen offset:0 sc1
M v[152:155],a[88:91],v[48:51],v[152:155]
s_waitcnt lgkmcnt(0)
E v22,v72
M v[160:163],a[96:99],v[48:51],v[160:163]
R a[64:67],v7,49152
R a[68:71],v7,50176
M v[160:163],a[100:103],v[56:59],v[160:163]
buffer_load_dwordx4 v3, s[8:11], s21 offen offset:3072 sc1 lds
M v[164:167],a[100:103],v[60:63],v[164:167]
SA m0,s28,102400
E v23,v73
M v[164:167],a[96:99],v[52:55],v[164:167]
R a[72:75],v7,51200
R a[76:79],v7,52224
M v[172:175],a[104:107],v[52:55],v[172:175]
buffer_load_dwordx4 v4, s[8:11], s21 offen offset:0 sc1 lds
M v[172:175],a[108:111],v[60:63],v[172:175]
AF v26,v21,v26
AF v26,v22,v26
M v[168:171],a[108:111],v[56:59],v[168:171]
R a[80:83],v7,53248
R a[84:87],v7,54272
M v[168:171],a[104:107],v[48:51],v[168:171]
buffer_load_dwordx4 v4, s[8:11], s21 offen offset:1024 sc1 lds
M v[176:179],a[112:115],v[48:51],v[176:179]
E v24,v74
M v[176:179],a[116:119],v[56:59],v[176:179]
R a[88:91],v7,55296
R a[92:95],v7,56320
M v[180:183],a[116:119],v[60:63],v[180:183]
buffer_load_dwordx4 v4, s[8:11], s21 offen offset:2048 sc1 lds
M v[180:183],a[112:115],v[52:55],v[180:183]
E v25,v75
M v[188:191],a[120:123],v[52:55],v[188:191]
C v42,v22,v23
AF v26,v23,v26
M v[188:191],a[124:127],v[60:63],v[188:191]
AF v26,v24,v26
C v43,v24,v25
M v[184:187],a[124:127],v[56:59],v[184:187]
buffer_load_dwordx4 v4, s[8:11], s21 offen offset:3072 sc1 lds
M v[184:187],a[120:123],v[48:51],v[184:187]
s_waitcnt lgkmcnt(0)
E v18,v68
M v[192:195],a[64:67],v[48:51],v[192:195]
SA s21,s21,32768
R a[96:99],v7,57344
R a[100:103],v7,58368
M v[192:195],a[68:71],v[56:59],v[192:195]
s_sub_u32 s22, s22, 1
buffer_store_dwordx4 a[156:159], v7, s[8:11], s3 offen offset:2048 sc1
M v[196:199],a[68:71],v[60:63],v[196:199]
s_cselect_b32 s21, s23, s21
E v19,v69
M v[196:199],a[64:67],v[52:55],v[196:199]
R a[104:107],v7,59392
R a[108:111],v7,60416
M v[204:207],a[72:75],v[52:55],v[204:207]
AF v26,v25,v26
AF v27,v18,v19
M v[204:207],a[76:79],v[60:63],v[204:207]
E v20,v70
M v[200:203],a[76:79],v[56:59],v[200:203]
R a[112:115],v7,61440
R a[116:119],v7,62464
M v[200:203],a[72:75],v[48:51],v[200:203]
C v44,v18,v19
M v[208:211],a[80:83],v[48:51],v[208:211]
M v[208:211],a[84:87],v[56:59],v[208:211]
R a[120:123],v7,63488
R a[124:127],v7,64512
M v[212:215],a[84:87],v[60:63],v[212:215]
SA s3,s93,786432
E v21,v71
M v[212:215],a[80:83],v[52:55],v[212:215]
buffer_store_dwordx4 a[160:163], v7, s[8:11], s3 offen offset:0 sc1
M v[220:223],a[88:91],v[52:55],v[220:223]
AF v27,v20,v27
C v45,v20,v21
M v[220:223],a[92:95],v[60:63],v[220:223]
E v22,v76
M v[216:219],a[92:95],v[56:59],v[216:219]
s_waitcnt vmcnt(25) lgkmcnt(0)
AF v27,v21,v27
M v[216:219],a[88:91],v[48:51],v[216:219]
s_barrier
M v[224:227],a[96:99],v[48:51],v[224:227]
R a[64:67],v2,0
R a[68:71],v2,1024
M v[224:227],a[100:103],v[56:59],v[224:227]
E v23,v77
M v[228:231],a[100:103],v[60:63],v[228:231]
AF v27,v22,v27
C v46,v22,v23
M v[228:231],a[96:99],v[52:55],v[228:231]
R a[72:75],v2,2048
R a[76:79],v2,3072
M v[236:239],a[104:107],v[52:55],v[236:239]
E v24,v78
M v[236:239],a[108:111],v[60:63],v[236:239]
AF v27,v23,v27
M v[232:235],a[108:111],v[56:59],v[232:235]
R a[80:83],v2,4096
R a[84:87],v2,5120
M v[232:235],a[104:107],v[48:51],v[232:235]
M v[240:243],a[112:115],v[48:51],v[240:243]
E v25,v79
M v[240:243],a[116:119],v[56:59],v[240:243]
R a[88:91],v2,6144
R a[92:95],v2,7168
M v[244:247],a[116:119],v[60:63],v[244:247]
AF v27,v24,v27
C v47,v24,v25
M v[244:247],a[112:115],v[52:55],v[244:247]
AF v27,v25,v27
M v[252:255],a[120:123],v[52:55],v[252:255]
M v[252:255],a[124:127],v[60:63],v[252:255]
M v[248:251],a[124:127],v[56:59],v[248:251]
s_waitcnt lgkmcnt(0)
M v[248:251],a[120:123],v[48:51],v[248:251]
M v[96:99],a[64:67],a[0:3],v[32:35]
R a[96:99],v2,8192
R a[100:103],v2,9216
M v[96:99],a[68:71],a[4:7],v[96:99]
SA m0,s28,32768
E v18,v80
M v[96:99],a[72:75],a[8:11],v[96:99]
buffer_load_dwordx4 v3, s[8:11], s26 offen offset:0 sc1 lds
M v[96:99],a[76:79],a[12:15],v[96:99]
R a[104:107],v2,10240
R a[108:111],v2,11264
M v[96:99],a[80:83],a[16:19],v[96:99]
E v19,v81
M v[96:99],a[84:87],a[20:23],v[96:99]
AF v26,v18,v26
C v56,v18,v19
M v[96:99],a[88:91],a[24:27],v[96:99]
R a[112:115],v2,12288
R a[116:119],v2,13312
M v[96:99],a[92:95],a[28:31],v[96:99]
buffer_load_dwordx4 v3, s[8:11], s26 offen offset:1024 sc1 lds
M v[100:103],a[92:95],a[60:63],v[36:39]
E v20,v82
M v[100:103],a[88:91],a[56:59],v[100:103]
R a[120:123],v2,14336
R a[124:127],v2,15360
M v[100:103],a[84:87],a[52:55],v[100:103]
SA s3,s93,786432
E v21,v83
M v[100:103],a[80:83],a[48:51],v[100:103]
buffer_load_dwordx4 v3, s[8:11], s26 offen offset:2048 sc1 lds
M v[100:103],a[76:79],a[44:47],v[100:103]
AF v26,v19,v26
AF v26,v20,v26
M v[100:103],a[72:75],a[40:43],v[100:103]
C v57,v20,v21
AF v26,v21,v26
M v[100:103],a[68:71],a[36:39],v[100:103]
buffer_store_dwordx4 a[164:167], v7, s[8:11], s3 offen offset:2048 sc1
M v[100:103],a[64:67],a[32:35],v[100:103]
s_waitcnt lgkmcnt(0)
E v22,v88
M v[108:111],a[96:99],a[32:35],v[36:39]
R a[64:67],v2,16384
R a[68:71],v2,17408
M v[108:111],a[100:103],a[36:39],v[108:111]
buffer_load_dwordx4 v3, s[8:11], s26 offen offset:3072 sc1 lds
M v[108:111],a[104:107],a[40:43],v[108:111]
SA m0,s28,36864
E v23,v89
M v[108:111],a[108:111],a[44:47],v[108:111]
R a[72:75],v2,18432
R a[76:79],v2,19456
M v[108:111],a[112:115],a[48:51],v[108:111]
buffer_load_dwordx4 v4, s[8:11], s26 offen offset:0 sc1 lds
M v[108:111],a[116:119],a[52:55],v[108:111]
SA s3,s93,790528
E v24,v90
M v[108:111],a[120:123],a[56:59],v[108:111]
R a[80:83],v2,20480
R a[84:87],v2,21504
M v[108:111],a[124:127],a[60:63],v[108:111]
buffer_load_dwordx4 v4, s[8:11], s26 offen offset:1024 sc1 lds
M v[104:107],a[124:127],a[28:31],v[32:35]
E v25,v91
M v[104:107],a[120:123],a[24:27],v[104:107]
R a[88:91],v2,22528
R a[92:95],v2,23552
M v[104:107],a[116:119],a[20:23],v[104:107]
buffer_load_dwordx4 v4, s[8:11], s26 offen offset:2048 sc1 lds
M v[104:107],a[112:115],a[16:19],v[104:107]
AF v26,v22,v26
C v58,v22,v23
M v[104:107],a[108:111],a[12:15],v[104:107]
E v18,v84
M v[104:107],a[104:107],a[8:11],v[104:107]
buffer_store_dwordx4 a[168:171], v7, s[8:11], s3 offen offset:0 sc1
M v[104:107],a[100:103],a[4:7],v[104:107]
AF v26,v23,v26
AF v26,v24,v26
M v[104:107],a[96:99],a[0:3],v[104:107]
s_waitcnt lgkmcnt(0)
E v19,v85
M v[112:115],a[64:67],a[0:3],v[32:35]
R a[96:99],v2,24576
R a[100:103],v2,25600
M v[112:115],a[68:71],a[4:7],v[112:115]
buffer_load_dwordx4 v4, s[8:11], s26 offen offset:3072 sc1 lds
M v[112:115],a[72:75],a[8:11],v[112:115]
SA s26,s26,32768
C v59,v24,v25
AF v26,v25,v26
M v[112:115],a[76:79],a[12:15],v[112:115]
R a[104:107],v2,26624
R a[108:111],v2,27648
M v[112:115],a[80:83],a[16:19],v[112:115]
E v20,v86
M v[112:115],a[84:87],a[20:23],v[112:115]
buffer_store_dwordx4 a[172:175], v7, s[8:11], s3 offen offset:2048 sc1
M v[112:115],a[88:91],a[24:27],v[112:115]
R a[112:115],v2,28672
R a[116:119],v2,29696
M v[112:115],a[92:95],a[28:31],v[112:115]
E v21,v87
M v[116:119],a[92:95],a[60:63],v[36:39]
AF v27,v18,v27
C v60,v18,v19
M v[116:119],a[88:91],a[56:59],v[116:119]
R a[120:123],v2,30720
R a[124:127],v2,31744
M v[116:119],a[84:87],a[52:55],v[116:119]
E v22,v92
M v[116:119],a[80:83],a[48:51],v[116:119]
AF v27,v19,v27
AF v27,v20,v27
M v[116:119],a[76:79],a[44:47],v[116:119]
C v61,v20,v21
AF v27,v21,v27
M v[116:119],a[72:75],a[40:43],v[116:119]
E v23,v93
M v[116:119],a[68:71],a[36:39],v[116:119]
s_waitcnt vmcnt(24) lgkmcnt(0)
AF v27,v22,v27
C v62,v22,v23
M v[116:119],a[64:67],a[32:35],v[116:119]
s_barrier
M v[124:127],a[96:99],a[32:35],v[36:39]
SA s3,s93,794624
R a[64:67],v7,0
R a[68:71],v7,1024
M v[124:127],a[100:103],a[36:39],v[124:127]
buffer_store_dwordx4 a[176:179], v7, s[8:11], s3 offen offset:0 sc1
M v[124:127],a[104:107],a[40:43],v[124:127]
E v24,v94
M v[124:127],a[108:111],a[44:47],v[124:127]
R a[72:75],v7,2048
R a[76:79],v7,3072
M v[124:127],a[112:115],a[48:51],v[124:127]
E v25,v95
M v[124:127],a[116:119],a[52:55],v[124:127]
AF v27,v23,v27
AF v27,v24,v27
M v[124:127],a[120:123],a[56:59],v[124:127]
R a[80:83],v7,4096
R a[84:87],v7,5120
M v[124:127],a[124:127],a[60:63],v[124:127]
C v63,v24,v25
AF v27,v25,v27
M v[120:123],a[124:127],a[28:31],v[32:35]
M v[120:123],a[120:123],a[24:27],v[120:123]
R a[88:91],v7,6144
R a[92:95],v7,7168
M v[120:123],a[116:119],a[20:23],v[120:123]
v_max_f32 v10, v26, v27
M v[120:123],a[112:115],a[16:19],v[120:123]
v_cmp_lt_f32 vcc, s31, v10
M v[120:123],a[108:111],a[12:15],v[120:123]
M v[120:123],a[104:107],a[8:11],v[120:123]
M v[120:123],a[100:103],a[4:7],v[120:123]
s_waitcnt lgkmcnt(0)
M v[120:123],a[96:99],a[0:3],v[120:123]
s_cbranch_vccnz L_stv3
L_rtv3:
M v[128:131],a[64:67],v[40:43],v[128:131]
R a[96:99],v7,8192
R a[100:103],v7,9216
M v[128:131],a[68:71],v[56:59],v[128:131]
SA m0,s28,65536
E v18,v96
M v[132:135],a[68:71],v[60:63],v[132:135]
buffer_load_dwordx4 v3, s[8:11], s21 offen offset:0 sc1 lds
M v[132:135],a[64:67],v[44:47],v[132:135]
R a[104:107],v7,10240
R a[108:111],v7,11264
M v[140:143],a[72:75],v[44:47],v[140:143]
E v19,v97
M v[140:143],a[76:79],v[60:63],v[140:143]
AF v30,v26,v30
AF v31,v27,v31
M v[136:139],a[76:79],v[56:59],v[136:139]
R a[112:115],v7,12288
R a[116:119],v7,13312
M v[136:139],a[72:75],v[40:43],v[136:139]
buffer_load_dwordx4 v3, s[8:11], s21 offen offset:1024 sc1 lds
M v[144:147],a[80:83],v[40:43],v[144:147]
E v20,v98
M v[144:147],a[84:87],v[56:59],v[144:147]
R a[120:123],v7,14336
R a[124:127],v7,15360
M v[148:151],a[84:87],v[60:63],v[148:151]
SA s3,s93,794624
AF v28,v18,v19
C v48,v18,v19
M v[148:151],a[80:83],v[44:47],v[148:151]
buffer_load_dwordx4 v3, s[8:11], s21 offen offset:2048 sc1 lds
M v[156:159],a[88:91],v[44:47],v[156:159]
E v21,v99
M v[156:159],a[92:95],v[60:63],v[156:159]
AF v28,v20,v28
C v49,v20,v21
M v[152:155],a[92:95],v[56:59],v[152:155]
buffer_store_dwordx4 a[180:183], v7, s[8:11], s3 offen offset:2048 sc1
M v[152:155],a[88:91],v[40:43],v[152:155]
s_waitcnt lgkmcnt(0)
E v22,v104
M v[160:163],a[96:99],v[40:43],v[160:163]
R a[64:67],v7,16384
R a[68:71],v7,17408
M v[160:163],a[100:103],v[56:59],v[160:163]
buffer_load_dwordx4 v3, s[8:11], s21 offen offset:3072 sc1 lds
M v[164:167],a[100:103],v[60:63],v[164:167]
SA m0,s28,69632
E v23,v105
M v[164:167],a[96:99],v[44:47],v[164:167]
R a[72:75],v7,18432
R a[76:79],v7,19456
M v[172:175],a[104:107],v[44:47],v[172:175]
buffer_load_dwordx4 v4, s[8:11], s21 offen offset:0 sc1 lds
M v[172:175],a[108:111],v[60:63],v[172:175]
AF v28,v21,v28
AF v28,v22,v28
M v[168:171],a[108:111],v[56:59],v[168:171]
R a[80:83],v7,20480
R a[84:87],v7,21504
M v[168:171],a[104:107],v[40:43],v[168:171]
buffer_load_dwordx4 v4, s[8:11], s21 offen offset:1024 sc1 lds
M v[176:179],a[112:115],v[40:43],v[176:179]
E v24,v106
M v[176:179],a[116:119],v[56:59],v[176:179]
SA s3,s93,798720
R a[88:91],v7,22528
R a[92:95],v7,23552
M v[180:183],a[116:119],v[60:63],v[180:183]
buffer_load_dwordx4 v4, s[8:11], s21 offen offset:2048 sc1 lds
M v[180:183],a[112:115],v[44:47],v[180:183]
E v25,v107
M v[188:191],a[120:123],v[44:47],v[188:191]
C v50,v22,v23
AF v28,v23,v28
M v[188:191],a[124:127],v[60:63],v[188:191]
AF v28,v24,v28
C v51,v24,v25
M v[184:187],a[124:127],v[56:59],v[184:187]
buffer_load_dwordx4 v4, s[8:11], s21 offen offset:3072 sc1 lds
M v[184:187],a[120:123],v[40:43],v[184:187]
s_waitcnt lgkmcnt(0)
E v18,v100
M v[192:195],a[64:67],v[40:43],v[192:195]
SA s21,s21,32768
R a[96:99],v7,24576
R a[100:103],v7,25600
M v[192:195],a[68:71],v[56:59],v[192:195]
s_sub_u32 s22, s22, 1
buffer_store_dwordx4 a[184:187], v7, s[8:11], s3 offen offset:0 sc1
M v[196:199],a[68:71],v[60:63],v[196:199]
s_cselect_b32 s21, s23, s21
E v19,v101
M v[196:199],a[64:67],v[44:47],v[196:199]
R a[104:107],v7,26624
R a[108:111],v7,27648
M v[204:207],a[72:75],v[44:47],v[204:207]
AF v28,v25,v28
AF v29,v18,v19
M v[204:207],a[76:79],v[60:63],v[204:207]
E v20,v102
M v[200:203],a[76:79],v[56:59],v[200:203]
R a[112:115],v7,28672
R a[116:119],v7,29696
M v[200:203],a[72:75],v[40:43],v[200:203]
C v52,v18,v19
M v[208:211],a[80:83],v[40:43],v[208:211]
M v[208:211],a[84:87],v[56:59],v[208:211]
R a[120:123],v7,30720
R a[124:127],v7,31744
M v[212:215],a[84:87],v[60:63],v[212:215]
E v21,v103
M v[212:215],a[80:83],v[44:47],v[212:215]
buffer_store_dwordx4 a[188:191], v7, s[8:11], s3 offen offset:2048 sc1
M v[220:223],a[88:91],v[44:47],v[220:223]
AF v29,v20,v29
C v53,v20,v21
M v[220:223],a[92:95],v[60:63],v[220:223]
E v22,v108
M v[216:219],a[92:95],v[56:59],v[216:219]
s_waitcnt vmcnt(25) lgkmcnt(0)
AF v29,v21,v29
M v[216:219],a[88:91],v[40:43],v[216:219]
s_barrier
M v[224:227],a[96:99],v[40:43],v[224:227]
R a[64:67],v2,32768
R a[68:71],v2,33792
M v[224:227],a[100:103],v[56:59],v[224:227]
E v23,v109
M v[228:231],a[100:103],v[60:63],v[228:231]
AF v29,v22,v29
C v54,v22,v23
M v[228:231],a[96:99],v[44:47],v[228:231]
R a[72:75],v2,34816
R a[76:79],v2,35840
M v[236:239],a[104:107],v[44:47],v[236:239]
E v24,v110
M v[236:239],a[108:111],v[60:63],v[236:239]
AF v29,v23,v29
M v[232:235],a[108:111],v[56:59],v[232:235]
R a[80:83],v2,36864
R a[84:87],v2,37888
M v[232:235],a[104:107],v[40:43],v[232:235]
M v[240:243],a[112:115],v[40:43],v[240:243]
E v25,v111
M v[240:243],a[116:119],v[56:59],v[240:243]
R a[88:91],v2,38912
R a[92:95],v2,39936
M v[244:247],a[116:119],v[60:63],v[244:247]
AF v29,v24,v29
C v55,v24,v25
M v[244:247],a[112:115],v[44:47],v[244:247]
AF v29,v25,v29
M v[252:255],a[120:123],v[44:47],v[252:255]
M v[252:255],a[124:127],v[60:63],v[252:255]
M v[248:251],a[124:127],v[56:59],v[248:251]
s_waitcnt lgkmcnt(0)
M v[248:251],a[120:123],v[40:43],v[248:251]
s_branch L_loop_top
L_st0:
s_call_b64 s[36:37], L_slow0
s_branch L_rt0
L_st1:
s_call_b64 s[36:37], L_slow1
s_branch L_rt1
L_stv1:
s_call_b64 s[36:37], L_slowf
s_branch L_rtv1
L_stk1:
s_call_b64 s[36:37], L_slowf
s_branch L_rtk1
L_sth1:
s_call_b64 s[36:37], L_slowf
s_branch L_rth1
L_stj0:
s_call_b64 s[36:37], L_slowj
s_branch L_rtj0
L_stv2:
s_call_b64 s[36:37], L_slow1
s_branch L_rtv2
L_stv3:
s_call_b64 s[36:37], L_slow0
s_branch L_rtv3
L_std1:
s_call_b64 s[36:37], L_slow1
s_branch L_rtd1
L_std3n:
s_call_b64 s[36:37], L_slow0
s_branch L_rtd3n
L_std3h:
s_call_b64 s[36:37], L_slow0
s_branch L_rtd3h
L_std4n:
s_call_b64 s[36:37], L_slowb
s_branch L_rtd4n
L_std4h:
s_call_b64 s[36:37], L_slowb
s_branch L_rtd4h
L_stfh:
s_call_b64 s[36:37], L_slow1n
s_branch L_rtfh
L_stc:
s_call_b64 s[36:37], L_comb
s_branch L_rtc
L_slow0:
s_nop 7
s_nop 3
v_max3_f32 v10, v64, v65, v66
v_max3_f32 v10, v67, v72, v10
v_max3_f32 v10, v73, v74, v10
v_max3_f32 v10, v75, v80, v10
v_max3_f32 v10, v81, v82, v10
v_max3_f32 v10, v83, v88, v10
v_max3_f32 v10, v89, v90, v10
v_max_f32 v10, v91, v10
v_max3_f32 v11, v68, v69, v70
v_max3_f32 v11, v71, v76, v11
v_max3_f32 v11, v77, v78, v11
v_max3_f32 v11, v79, v84, v11
v_max3_f32 v11, v85, v86, v11
v_max3_f32 v11, v87, v92, v11
v_max3_f32 v11, v93, v94, v11
v_max_f32 v11, v95, v11
v_mov_b32 v12, v10
v_mov_b32 v13, v11
s_nop 0
v_permlane16_swap_b32 v12, v10
v_permlane16_swap_b32 v13, v11
v_max_f32 v10, v12, v10
v_max_f32 v11, v13, v11
v_mov_b32 v12, v10
v_mov_b32 v13, v11
s_nop 0
v_permlane32_swap_b32 v12, v10
v_permlane32_swap_b32 v13, v11
v_max_f32 v10, v12, v10
v_max_f32 v11, v13, v11
v_ceil_f32 v10, v10
v_ceil_f32 v11, v11
v_max_f32 v10, 0, v10
v_max_f32 v11, 0, v11
v_sub_f32 v64, v64, v10
v_sub_f32 v65, v65, v10
v_sub_f32 v66, v66, v10
v_sub_f32 v67, v67, v10
v_sub_f32 v68, v68, v11
v_sub_f32 v69, v69, v11
v_sub_f32 v70, v70, v11
v_sub_f32 v71, v71, v11
v_sub_f32 v72, v72, v10
v_sub_f32 v73, v73, v10
v_sub_f32 v74, v74, v10
v_sub_f32 v75, v75, v10
v_sub_f32 v76, v76, v11
v_sub_f32 v77, v77, v11
v_sub_f32 v78, v78, v11
v_sub_f32 v79, v79, v11
v_sub_f32 v80, v80, v10
v_sub_f32 v81, v81, v10
v_sub_f32 v82, v82, v10
v_sub_f32 v83, v83, v10
v_sub_f32 v84, v84, v11
v_sub_f32 v85, v85, v11
v_sub_f32 v86, v86, v11
v_sub_f32 v87, v87, v11
v_sub_f32 v88, v88, v10
v_sub_f32 v89, v89, v10
v_sub_f32 v90, v90, v10
v_sub_f32 v91, v91, v10
v_sub_f32 v92, v92, v11
v_sub_f32 v93, v93, v11
v_sub_f32 v94, v94, v11
v_sub_f32 v95, v95, v11
v_sub_f32 v96, v96, v10
v_sub_f32 v97, v97, v10
v_sub_f32 v98, v98, v10
v_sub_f32 v99, v99, v10
v_sub_f32 v100, v100, v11
v_sub_f32 v101, v101, v11
v_sub_f32 v102, v102, v11
v_sub_f32 v103, v103, v11
v_sub_f32 v104, v104, v10
v_sub_f32 v105, v105, v10
v_sub_f32 v106, v106, v10
v_sub_f32 v107, v107, v10
v_sub_f32 v108, v108, v11
v_sub_f32 v109, v109, v11
v_sub_f32 v110, v110, v11
v_sub_f32 v111, v111, v11
v_sub_f32 v112, v112, v10
v_sub_f32 v113, v113, v10
v_sub_f32 v114, v114, v10
v_sub_f32 v115, v115, v10
v_sub_f32 v116, v116, v11
v_sub_f32 v117, v117, v11
v_sub_f32 v118, v118, v11
v_sub_f32 v119, v119, v11
v_sub_f32 v120, v120, v10
v_sub_f32 v121, v121, v10
v_sub_f32 v122, v122, v10
v_sub_f32 v123, v123, v10
v_sub_f32 v124, v124, v11
v_sub_f32 v125, v125, v11
v_sub_f32 v126, v126, v11
v_sub_f32 v127, v127, v11
v_sub_f32 v32, v32, v10
v_sub_f32 v33, v33, v10
v_sub_f32 v34, v34, v10
v_sub_f32 v35, v35, v10
v_sub_f32 v36, v36, v11
v_sub_f32 v37, v37, v11
v_sub_f32 v38, v38, v11
v_sub_f32 v39, v39, v11
E v12,-v10
E v13,-v11
MF v30,v12,v30
MF v31,v13,v31
MF v128,v12,v128
MF v129,v12,v129
MF v130,v12,v130
MF v131,v12,v131
MF v132,v13,v132
MF v133,v13,v133
MF v134,v13,v134
MF v135,v13,v135
MF v136,v12,v136
MF v137,v12,v137
MF v138,v12,v138
MF v139,v12,v139
MF v140,v13,v140
MF v141,v13,v141
MF v142,v13,v142
MF v143,v13,v143
MF v144,v12,v144
MF v145,v12,v145
MF v146,v12,v146
MF v147,v12,v147
MF v148,v13,v148
MF v149,v13,v149
MF v150,v13,v150
MF v151,v13,v151
MF v152,v12,v152
MF v153,v12,v153
MF v154,v12,v154
MF v155,v12,v155
MF v156,v13,v156
MF v157,v13,v157
MF v158,v13,v158
MF v159,v13,v159
MF v160,v12,v160
MF v161,v12,v161
MF v162,v12,v162
MF v163,v12,v163
MF v164,v13,v164
MF v165,v13,v165
MF v166,v13,v166
MF v167,v13,v167
MF v168,v12,v168
MF v169,v12,v169
MF v170,v12,v170
MF v171,v12,v171
MF v172,v13,v172
MF v173,v13,v173
MF v174,v13,v174
MF v175,v13,v175
MF v176,v12,v176
MF v177,v12,v177
MF v178,v12,v178
MF v179,v12,v179
MF v180,v13,v180
MF v181,v13,v181
MF v182,v13,v182
MF v183,v13,v183
MF v184,v12,v184
MF v185,v12,v185
MF v186,v12,v186
MF v187,v12,v187
MF v188,v13,v188
MF v189,v13,v189
MF v190,v13,v190
MF v191,v13,v191
MF v192,v12,v192
MF v193,v12,v193
MF v194,v12,v194
MF v195,v12,v195
MF v196,v13,v196
MF v197,v13,v197
MF v198,v13,v198
MF v199,v13,v199
MF v200,v12,v200
MF v201,v12,v201
MF v202,v12,v202
MF v203,v12,v203
MF v204,v13,v204
MF v205,v13,v205
MF v206,v13,v206
MF v207,v13,v207
MF v208,v12,v208
MF v209,v12,v209
MF v210,v12,v210
MF v211,v12,v211
MF v212,v13,v212
MF v213,v13,v213
MF v214,v13,v214
MF v215,v13,v215
MF v216,v12,v216
MF v217,v12,v217
MF v218,v12,v218
MF v219,v12,v219
MF v220,v13,v220
MF v221,v13,v221
MF v222,v13,v222
MF v223,v13,v223
MF v224,v12,v224
MF v225,v12,v225
MF v226,v12,v226
MF v227,v12,v227
MF v228,v13,v228
MF v229,v13,v229
MF v230,v13,v230
MF v231,v13,v231
MF v232,v12,v232
MF v233,v12,v233
MF v234,v12,v234
MF v235,v12,v235
MF v236,v13,v236
MF v237,v13,v237
MF v238,v13,v238
MF v239,v13,v239
MF v240,v12,v240
MF v241,v12,v241
MF v242,v12,v242
MF v243,v12,v243
MF v244,v13,v244
MF v245,v13,v245
MF v246,v13,v246
MF v247,v13,v247
MF v248,v12,v248
MF v249,v12,v249
MF v250,v12,v250
MF v251,v12,v251
MF v252,v13,v252
MF v253,v13,v253
MF v254,v13,v254
MF v255,v13,v255
E v18,v64
E v19,v65
E v20,v66
AF v26,v18,v19
C v40,v18,v19
E v21,v67
E v22,v72
AF v26,v20,v26
C v41,v20,v21
E v23,v73
AF v26,v21,v26
E v24,v74
AF v26,v22,v26
C v42,v22,v23
E v25,v75
AF v26,v23,v26
E v18,v68
AF v26,v24,v26
C v43,v24,v25
E v19,v69
AF v26,v25,v26
E v20,v70
AF v27,v18,v19
C v44,v18,v19
E v21,v71
E v22,v76
AF v27,v20,v27
C v45,v20,v21
E v23,v77
AF v27,v21,v27
E v24,v78
AF v27,v22,v27
C v46,v22,v23
E v25,v79
AF v27,v23,v27
AF v27,v24,v27
C v47,v24,v25
AF v27,v25,v27
E v18,v80
E v19,v81
E v20,v82
AF v26,v18,v26
C v56,v18,v19
E v21,v83
AF v26,v19,v26
E v22,v88
AF v26,v20,v26
C v57,v20,v21
E v23,v89
AF v26,v21,v26
E v24,v90
AF v26,v22,v26
C v58,v22,v23
E v25,v91
AF v26,v23,v26
E v18,v84
AF v26,v24,v26
C v59,v24,v25
E v19,v85
AF v26,v25,v26
E v20,v86
AF v27,v18,v27
C v60,v18,v19
E v21,v87
AF v27,v19,v27
E v22,v92
AF v27,v20,v27
C v61,v20,v21
E v23,v93
AF v27,v21,v27
E v24,v94
AF v27,v22,v27
C v62,v22,v23
E v25,v95
AF v27,v23,v27
AF v27,v24,v27
C v63,v24,v25
AF v27,v25,v27
s_nop 3
s_setpc_b64 s[36:37]
L_slow1:
s_nop 7
s_nop 3
v_max3_f32 v10, v96, v97, v98
v_max3_f32 v10, v99, v104, v10
v_max3_f32 v10, v105, v106, v10
v_max3_f32 v10, v107, v112, v10
v_max3_f32 v10, v113, v114, v10
v_max3_f32 v10, v115, v120, v10
v_max3_f32 v10, v121, v122, v10
v_max_f32 v10, v123, v10
v_max3_f32 v11, v100, v101, v102
v_max3_f32 v11, v103, v108, v11
v_max3_f32 v11, v109, v110, v11
v_max3_f32 v11, v111, v116, v11
v_max3_f32 v11, v117, v118, v11
v_max3_f32 v11, v119, v124, v11
v_max3_f32 v11, v125, v126, v11
v_max_f32 v11, v127, v11
v_mov_b32 v12, v10
v_mov_b32 v13, v11
s_nop 0
v_permlane16_swap_b32 v12, v10
v_permlane16_swap_b32 v13, v11
v_max_f32 v10, v12, v10
v_max_f32 v11, v13, v11
v_mov_b32 v12, v10
v_mov_b32 v13, v11
s_nop 0
v_permlane32_swap_b32 v12, v10
v_permlane32_swap_b32 v13, v11
v_max_f32 v10, v12, v10
v_max_f32 v11, v13, v11
v_ceil_f32 v10, v10
v_ceil_f32 v11, v11
v_max_f32 v10, 0, v10
v_max_f32 v11, 0, v11
v_sub_f32 v96, v96, v10
v_sub_f32 v97, v97, v10
v_sub_f32 v98, v98, v10
v_sub_f32 v99, v99, v10
v_sub_f32 v100, v100, v11
v_sub_f32 v101, v101, v11
v_sub_f32 v102, v102, v11
v_sub_f32 v103, v103, v11
v_sub_f32 v104, v104, v10
v_sub_f32 v105, v105, v10
v_sub_f32 v106, v106, v10
v_sub_f32 v107, v107, v10
v_sub_f32 v108, v108, v11
v_sub_f32 v109, v109, v11
v_sub_f32 v110, v110, v11
v_sub_f32 v111, v111, v11
v_sub_f32 v112, v112, v10
v_sub_f32 v113, v113, v10
v_sub_f32 v114, v114, v10
v_sub_f32 v115, v115, v10
v_sub_f32 v116, v116, v11
v_sub_f32 v117, v117, v11
v_sub_f32 v118, v118, v11
v_sub_f32 v119, v119, v11
v_sub_f32 v120, v120, v10
v_sub_f32 v121, v121, v10
v_sub_f32 v122, v122, v10
v_sub_f32 v123, v123, v10
v_sub_f32 v124, v124, v11
v_sub_f32 v125, v125, v11
v_sub_f32 v126, v126, v11
v_sub_f32 v127, v127, v11
v_sub_f32 v64, v64, v10
v_sub_f32 v65, v65, v10
v_sub_f32 v66, v66, v10
v_sub_f32 v67, v67, v10
v_sub_f32 v68, v68, v11
v_sub_f32 v69, v69, v11
v_sub_f32 v70, v70, v11
v_sub_f32 v71, v71, v11
v_sub_f32 v72, v72, v10
v_sub_f32 v73, v73, v10
v_sub_f32 v74, v74, v10
v_sub_f32 v75, v75, v10
v_sub_f32 v76, v76, v11
v_sub_f32 v77, v77, v11
v_sub_f32 v78, v78, v11
v_sub_f32 v79, v79, v11
v_sub_f32 v80, v80, v10
v_sub_f32 v81, v81, v10
v_sub_f32 v82, v82, v10
v_sub_f32 v83, v83, v10
v_sub_f32 v84, v84, v11
v_sub_f32 v85, v85, v11
v_sub_f32 v86, v86, v11
v_sub_f32 v87, v87, v11
v_sub_f32 v88, v88, v10
v_sub_f32 v89, v89, v10
v_sub_f32 v90, v90, v10
v_sub_f32 v91, v91, v10
v_sub_f32 v92, v92, v11
v_sub_f32 v93, v93, v11
v_sub_f32 v94, v94, v11
v_sub_f32 v95, v95, v11
v_sub_f32 v32, v32, v10
v_sub_f32 v33, v33, v10
v_sub_f32 v34, v34, v10
v_sub_f32 v35, v35, v10
v_sub_f32 v36, v36, v11
v_sub_f32 v37, v37, v11
v_sub_f32 v38, v38, v11
v_sub_f32 v39, v39, v11
E v12,-v10
E v13,-v11
MF v30,v12,v30
MF v31,v13,v31
MF v128,v12,v128
MF v129,v12,v129
MF v130,v12,v130
MF v131,v12,v131
MF v132,v13,v132
MF v133,v13,v133
MF v134,v13,v134
MF v135,v13,v135
MF v136,v12,v136
MF v137,v12,v137
MF v138,v12,v138
MF v139,v12,v139
MF v140,v13,v140
MF v141,v13,v141
MF v142,v13,v142
MF v143,v13,v143
MF v144,v12,v144
MF v145,v12,v145
MF v146,v12,v146
MF v147,v12,v147
MF v148,v13,v148
MF v149,v13,v149
MF v150,v13,v150
MF v151,v13,v151
MF v152,v12,v152
MF v153,v12,v153
MF v154,v12,v154
MF v155,v12,v155
MF v156,v13,v156
MF v157,v13,v157
MF v158,v13,v158
MF v159,v13,v159
MF v160,v12,v160
MF v161,v12,v161
MF v162,v12,v162
MF v163,v12,v163
MF v164,v13,v164
MF v165,v13,v165
MF v166,v13,v166
MF v167,v13,v167
MF v168,v12,v168
MF v169,v12,v169
MF v170,v12,v170
MF v171,v12,v171
MF v172,v13,v172
MF v173,v13,v173
MF v174,v13,v174
MF v175,v13,v175
MF v176,v12,v176
MF v177,v12,v177
MF v178,v12,v178
MF v179,v12,v179
MF v180,v13,v180
MF v181,v13,v181
MF v182,v13,v182
MF v183,v13,v183
MF v184,v12,v184
MF v185,v12,v185
MF v186,v12,v186
MF v187,v12,v187
MF v188,v13,v188
MF v189,v13,v189
MF v190,v13,v190
MF v191,v13,v191
MF v192,v12,v192
MF v193,v12,v193
MF v194,v12,v194
MF v195,v12,v195
MF v196,v13,v196
MF v197,v13,v197
MF v198,v13,v198
MF v199,v13,v199
MF v200,v12,v200
MF v201,v12,v201
MF v202,v12,v202
MF v203,v12,v203
MF v204,v13,v204
MF v205,v13,v205
MF v206,v13,v206
MF v207,v13,v207
MF v208,v12,v208
MF v209,v12,v209
MF v210,v12,v210
MF v211,v12,v211
MF v212,v13,v212
MF v213,v13,v213
MF v214,v13,v214
MF v215,v13,v215
MF v216,v12,v216
MF v217,v12,v217
MF v218,v12,v218
MF v219,v12,v219
MF v220,v13,v220
MF v221,v13,v221
MF v222,v13,v222
MF v223,v13,v223
MF v224,v12,v224
MF v225,v12,v225
MF v226,v12,v226
MF v227,v12,v227
MF v228,v13,v228
MF v229,v13,v229
MF v230,v13,v230
MF v231,v13,v231
MF v232,v12,v232
MF v233,v12,v233
MF v234,v12,v234
MF v235,v12,v235
MF v236,v13,v236
MF v237,v13,v237
MF v238,v13,v238
MF v239,v13,v239
MF v240,v12,v240
MF v241,v12,v241
MF v242,v12,v242
MF v243,v12,v243
MF v244,v13,v244
MF v245,v13,v245
MF v246,v13,v246
MF v247,v13,v247
MF v248,v12,v248
MF v249,v12,v249
MF v250,v12,v250
MF v251,v12,v251
MF v252,v13,v252
MF v253,v13,v253
MF v254,v13,v254
MF v255,v13,v255
E v18,v96
E v19,v97
E v20,v98
AF v28,v18,v19
C v48,v18,v19
E v21,v99
E v22,v104
AF v28,v20,v28
C v49,v20,v21
E v23,v105
AF v28,v21,v28
E v24,v106
AF v28,v22,v28
C v50,v22,v23
E v25,v107
AF v28,v23,v28
E v18,v100
AF v28,v24,v28
C v51,v24,v25
E v19,v101
AF v28,v25,v28
E v20,v102
AF v29,v18,v19
C v52,v18,v19
E v21,v103
E v22,v108
AF v29,v20,v29
C v53,v20,v21
E v23,v109
AF v29,v21,v29
E v24,v110
AF v29,v22,v29
C v54,v22,v23
E v25,v111
AF v29,v23,v29
AF v29,v24,v29
C v55,v24,v25
AF v29,v25,v29
E v18,v112
E v19,v113
E v20,v114
AF v28,v18,v28
C v56,v18,v19
E v21,v115
AF v28,v19,v28
E v22,v120
AF v28,v20,v28
C v57,v20,v21
E v23,v121
AF v28,v21,v28
E v24,v122
AF v28,v22,v28
C v58,v22,v23
E v25,v123
AF v28,v23,v28
E v18,v116
AF v28,v24,v28
C v59,v24,v25
E v19,v117
AF v28,v25,v28
E v20,v118
AF v29,v18,v29
C v60,v18,v19
E v21,v119
AF v29,v19,v29
E v22,v124
AF v29,v20,v29
C v61,v20,v21
E v23,v125
AF v29,v21,v29
E v24,v126
AF v29,v22,v29
C v62,v22,v23
E v25,v127
AF v29,v23,v29
AF v29,v24,v29
C v63,v24,v25
AF v29,v25,v29
s_nop 3
s_setpc_b64 s[36:37]
L_slow1n:
s_nop 7
s_nop 3
v_max3_f32 v10, v96, v97, v98
v_max3_f32 v10, v99, v104, v10
v_max3_f32 v10, v105, v106, v10
v_max3_f32 v10, v107, v112, v10
v_max3_f32 v10, v113, v114, v10
v_max3_f32 v10, v115, v120, v10
v_max3_f32 v10, v121, v122, v10
v_max_f32 v10, v123, v10
v_max3_f32 v11, v100, v101, v102
v_max3_f32 v11, v103, v108, v11
v_max3_f32 v11, v109, v110, v11
v_max3_f32 v11, v111, v116, v11
v_max3_f32 v11, v117, v118, v11
v_max3_f32 v11, v119, v124, v11
v_max3_f32 v11, v125, v126, v11
v_max_f32 v11, v127, v11
v_mov_b32 v12, v10
v_mov_b32 v13, v11
s_nop 0
v_permlane16_swap_b32 v12, v10
v_permlane16_swap_b32 v13, v11
v_max_f32 v10, v12, v10
v_max_f32 v11, v13, v11
v_mov_b32 v12, v10
v_mov_b32 v13, v11
s_nop 0
v_permlane32_swap_b32 v12, v10
v_permlane32_swap_b32 v13, v11
v_max_f32 v10, v12, v10
v_max_f32 v11, v13, v11
v_ceil_f32 v10, v10
v_ceil_f32 v11, v11
v_max_f32 v10, 0, v10
v_max_f32 v11, 0, v11
v_sub_f32 v96, v96, v10
v_sub_f32 v97, v97, v10
v_sub_f32 v98, v98, v10
v_sub_f32 v99, v99, v10
v_sub_f32 v100, v100, v11
v_sub_f32 v101, v101, v11
v_sub_f32 v102, v102, v11
v_sub_f32 v103, v103, v11
v_sub_f32 v104, v104, v10
v_sub_f32 v105, v105, v10
v_sub_f32 v106, v106, v10
v_sub_f32 v107, v107, v10
v_sub_f32 v108, v108, v11
v_sub_f32 v109, v109, v11
v_sub_f32 v110, v110, v11
v_sub_f32 v111, v111, v11
v_sub_f32 v112, v112, v10
v_sub_f32 v113, v113, v10
v_sub_f32 v114, v114, v10
v_sub_f32 v115, v115, v10
v_sub_f32 v116, v116, v11
v_sub_f32 v117, v117, v11
v_sub_f32 v118, v118, v11
v_sub_f32 v119, v119, v11
v_sub_f32 v120, v120, v10
v_sub_f32 v121, v121, v10
v_sub_f32 v122, v122, v10
v_sub_f32 v123, v123, v10
v_sub_f32 v124, v124, v11
v_sub_f32 v125, v125, v11
v_sub_f32 v126, v126, v11
v_sub_f32 v127, v127, v11
v_sub_f32 v32, v32, v10
v_sub_f32 v33, v33, v10
v_sub_f32 v34, v34, v10
v_sub_f32 v35, v35, v10
v_sub_f32 v36, v36, v11
v_sub_f32 v37, v37, v11
v_sub_f32 v38, v38, v11
v_sub_f32 v39, v39, v11
E v12,-v10
E v13,-v11
MF v30,v12,v30
MF v31,v13,v31
MF v128,v12,v128
MF v129,v12,v129
MF v130,v12,v130
MF v131,v12,v131
MF v132,v13,v132
MF v133,v13,v133
MF v134,v13,v134
MF v135,v13,v135
MF v136,v12,v136
MF v137,v12,v137
MF v138,v12,v138
MF v139,v12,v139
MF v140,v13,v140
MF v141,v13,v141
MF v142,v13,v142
MF v143,v13,v143
MF v144,v12,v144
MF v145,v12,v145
MF v146,v12,v146
MF v147,v12,v147
MF v148,v13,v148
MF v149,v13,v149
MF v150,v13,v150
MF v151,v13,v151
MF v152,v12,v152
MF v153,v12,v153
MF v154,v12,v154
MF v155,v12,v155
MF v156,v13,v156
MF v157,v13,v157
MF v158,v13,v158
MF v159,v13,v159
MF v160,v12,v160
MF v161,v12,v161
MF v162,v12,v162
MF v163,v12,v163
MF v164,v13,v164
MF v165,v13,v165
MF v166,v13,v166
MF v167,v13,v167
MF v168,v12,v168
MF v169,v12,v169
MF v170,v12,v170
MF v171,v12,v171
MF v172,v13,v172
MF v173,v13,v173
MF v174,v13,v174
MF v175,v13,v175
MF v176,v12,v176
MF v177,v12,v177
MF v178,v12,v178
MF v179,v12,v179
MF v180,v13,v180
MF v181,v13,v181
MF v182,v13,v182
MF v183,v13,v183
MF v184,v12,v184
MF v185,v12,v185
MF v186,v12,v186
MF v187,v12,v187
MF v188,v13,v188
MF v189,v13,v189
MF v190,v13,v190
MF v191,v13,v191
MF v192,v12,v192
MF v193,v12,v193
MF v194,v12,v194
MF v195,v12,v195
MF v196,v13,v196
MF v197,v13,v197
MF v198,v13,v198
MF v199,v13,v199
MF v200,v12,v200
MF v201,v12,v201
MF v202,v12,v202
MF v203,v12,v203
MF v204,v13,v204
MF v205,v13,v205
MF v206,v13,v206
MF v207,v13,v207
MF v208,v12,v208
MF v209,v12,v209
MF v210,v12,v210
MF v211,v12,v211
MF v212,v13,v212
MF v213,v13,v213
MF v214,v13,v214
MF v215,v13,v215
MF v216,v12,v216
MF v217,v12,v217
MF v218,v12,v218
MF v219,v12,v219
MF v220,v13,v220
MF v221,v13,v221
MF v222,v13,v222
MF v223,v13,v223
MF v224,v12,v224
MF v225,v12,v225
MF v226,v12,v226
MF v227,v12,v227
MF v228,v13,v228
MF v229,v13,v229
MF v230,v13,v230
MF v231,v13,v231
MF v232,v12,v232
MF v233,v12,v233
MF v234,v12,v234
MF v235,v12,v235
MF v236,v13,v236
MF v237,v13,v237
MF v238,v13,v238
MF v239,v13,v239
MF v240,v12,v240
MF v241,v12,v241
MF v242,v12,v242
MF v243,v12,v243
MF v244,v13,v244
MF v245,v13,v245
MF v246,v13,v246
MF v247,v13,v247
MF v248,v12,v248
MF v249,v12,v249
MF v250,v12,v250
MF v251,v12,v251
MF v252,v13,v252
MF v253,v13,v253
MF v254,v13,v254
MF v255,v13,v255
E v18,v96
E v19,v97
E v20,v98
AF v28,v18,v19
C v48,v18,v19
E v21,v99
E v22,v104
AF v28,v20,v28
C v49,v20,v21
E v23,v105
AF v28,v21,v28
E v24,v106
AF v28,v22,v28
C v50,v22,v23
E v25,v107
AF v28,v23,v28
E v18,v100
AF v28,v24,v28
C v51,v24,v25
E v19,v101
AF v28,v25,v28
E v20,v102
AF v29,v18,v19
C v52,v18,v19
E v21,v103
E v22,v108
AF v29,v20,v29
C v53,v20,v21
E v23,v109
AF v29,v21,v29
E v24,v110
AF v29,v22,v29
C v54,v22,v23
E v25,v111
AF v29,v23,v29
AF v29,v24,v29
C v55,v24,v25
AF v29,v25,v29
E v18,v112
E v19,v113
E v20,v114
AF v28,v18,v28
C v56,v18,v19
E v21,v115
AF v28,v19,v28
E v22,v120
AF v28,v20,v28
C v57,v20,v21
E v23,v121
AF v28,v21,v28
E v24,v122
AF v28,v22,v28
C v58,v22,v23
E v25,v123
AF v28,v23,v28
E v18,v116
AF v28,v24,v28
C v59,v24,v25
E v19,v117
AF v28,v25,v28
E v20,v118
AF v29,v18,v29
C v60,v18,v19
E v21,v119
AF v29,v19,v29
E v22,v124
AF v29,v20,v29
C v61,v20,v21
E v23,v125
AF v29,v21,v29
E v24,v126
AF v29,v22,v29
C v62,v22,v23
E v25,v127
AF v29,v23,v29
AF v29,v24,v29
C v63,v24,v25
AF v29,v25,v29
s_nop 3
s_setpc_b64 s[36:37]
L_slowf:
s_nop 7
s_nop 3
v_max3_f32 v10, v64, v65, v66
v_max3_f32 v10, v67, v72, v10
v_max3_f32 v10, v73, v74, v10
v_max3_f32 v10, v75, v80, v10
v_max3_f32 v10, v81, v82, v10
v_max3_f32 v10, v83, v88, v10
v_max3_f32 v10, v89, v90, v10
v_max_f32 v10, v91, v10
v_max3_f32 v11, v68, v69, v70
v_max3_f32 v11, v71, v76, v11
v_max3_f32 v11, v77, v78, v11
v_max3_f32 v11, v79, v84, v11
v_max3_f32 v11, v85, v86, v11
v_max3_f32 v11, v87, v92, v11
v_max3_f32 v11, v93, v94, v11
v_max_f32 v11, v95, v11
v_mov_b32 v12, v10
v_mov_b32 v13, v11
s_nop 0
v_permlane16_swap_b32 v12, v10
v_permlane16_swap_b32 v13, v11
v_max_f32 v10, v12, v10
v_max_f32 v11, v13, v11
v_mov_b32 v12, v10
v_mov_b32 v13, v11
s_nop 0
v_permlane32_swap_b32 v12, v10
v_permlane32_swap_b32 v13, v11
v_max_f32 v10, v12, v10
v_max_f32 v11, v13, v11
v_ceil_f32 v10, v10
v_ceil_f32 v11, v11
v_sub_f32 v64, v64, v10
v_sub_f32 v65, v65, v10
v_sub_f32 v66, v66, v10
v_sub_f32 v67, v67, v10
v_sub_f32 v68, v68, v11
v_sub_f32 v69, v69, v11
v_sub_f32 v70, v70, v11
v_sub_f32 v71, v71, v11
v_sub_f32 v72, v72, v10
v_sub_f32 v73, v73, v10
v_sub_f32 v74, v74, v10
v_sub_f32 v75, v75, v10
v_sub_f32 v76, v76, v11
v_sub_f32 v77, v77, v11
v_sub_f32 v78, v78, v11
v_sub_f32 v79, v79, v11
v_sub_f32 v80, v80, v10
v_sub_f32 v81, v81, v10
v_sub_f32 v82, v82, v10
v_sub_f32 v83, v83, v10
v_sub_f32 v84, v84, v11
v_sub_f32 v85, v85, v11
v_sub_f32 v86, v86, v11
v_sub_f32 v87, v87, v11
v_sub_f32 v88, v88, v10
v_sub_f32 v89, v89, v10
v_sub_f32 v90, v90, v10
v_sub_f32 v91, v91, v10
v_sub_f32 v92, v92, v11
v_sub_f32 v93, v93, v11
v_sub_f32 v94, v94, v11
v_sub_f32 v95, v95, v11
v_sub_f32 v96, v96, v10
v_sub_f32 v97, v97, v10
v_sub_f32 v98, v98, v10
v_sub_f32 v99, v99, v10
v_sub_f32 v100, v100, v11
v_sub_f32 v101, v101, v11
v_sub_f32 v102, v102, v11
v_sub_f32 v103, v103, v11
v_sub_f32 v104, v104, v10
v_sub_f32 v105, v105, v10
v_sub_f32 v106, v106, v10
v_sub_f32 v107, v107, v10
v_sub_f32 v108, v108, v11
v_sub_f32 v109, v109, v11
v_sub_f32 v110, v110, v11
v_sub_f32 v111, v111, v11
v_sub_f32 v112, v112, v10
v_sub_f32 v113, v113, v10
v_sub_f32 v114, v114, v10
v_sub_f32 v115, v115, v10
v_sub_f32 v116, v116, v11
v_sub_f32 v117, v117, v11
v_sub_f32 v118, v118, v11
v_sub_f32 v119, v119, v11
v_sub_f32 v120, v120, v10
v_sub_f32 v121, v121, v10
v_sub_f32 v122, v122, v10
v_sub_f32 v123, v123, v10
v_sub_f32 v124, v124, v11
v_sub_f32 v125, v125, v11
v_sub_f32 v126, v126, v11
v_sub_f32 v127, v127, v11
v_sub_f32 v32, v32, v10
v_sub_f32 v33, v33, v10
v_sub_f32 v34, v34, v10
v_sub_f32 v35, v35, v10
v_sub_f32 v36, v36, v11
v_sub_f32 v37, v37, v11
v_sub_f32 v38, v38, v11
v_sub_f32 v39, v39, v11
E v18,v64
E v19,v65
E v20,v66
AF v26,v18,v19
C v40,v18,v19
E v21,v67
E v22,v72
AF v26,v20,v26
C v41,v20,v21
E v23,v73
AF v26,v21,v26
E v24,v74
AF v26,v22,v26
C v42,v22,v23
E v25,v75
AF v26,v23,v26
E v18,v68
AF v26,v24,v26
C v43,v24,v25
E v19,v69
AF v26,v25,v26
E v20,v70
AF v27,v18,v19
C v44,v18,v19
E v21,v71
E v22,v76
AF v27,v20,v27
C v45,v20,v21
E v23,v77
AF v27,v21,v27
E v24,v78
AF v27,v22,v27
C v46,v22,v23
E v25,v79
AF v27,v23,v27
AF v27,v24,v27
C v47,v24,v25
AF v27,v25,v27
E v18,v80
E v19,v81
E v20,v82
AF v26,v18,v26
C v56,v18,v19
E v21,v83
AF v26,v19,v26
E v22,v88
AF v26,v20,v26
C v57,v20,v21
E v23,v89
AF v26,v21,v26
E v24,v90
AF v26,v22,v26
C v58,v22,v23
E v25,v91
AF v26,v23,v26
E v18,v84
AF v26,v24,v26
C v59,v24,v25
E v19,v85
AF v26,v25,v26
E v20,v86
AF v27,v18,v27
C v60,v18,v19
E v21,v87
AF v27,v19,v27
E v22,v92
AF v27,v20,v27
C v61,v20,v21
E v23,v93
AF v27,v21,v27
E v24,v94
AF v27,v22,v27
C v62,v22,v23
E v25,v95
AF v27,v23,v27
AF v27,v24,v27
C v63,v24,v25
AF v27,v25,v27
s_nop 3
s_setpc_b64 s[36:37]
L_slowj:
s_nop 7
s_nop 3
v_max3_f32 v10, v64, v65, v66
v_max3_f32 v10, v67, v72, v10
v_max3_f32 v10, v73, v74, v10
v_max3_f32 v10, v75, v80, v10
v_max3_f32 v10, v81, v82, v10
v_max3_f32 v10, v83, v88, v10
v_max3_f32 v10, v89, v90, v10
v_max_f32 v10, v91, v10
v_max3_f32 v11, v68, v69, v70
v_max3_f32 v11, v71, v76, v11
v_max3_f32 v11, v77, v78, v11
v_max3_f32 v11, v79, v84, v11
v_max3_f32 v11, v85, v86, v11
v_max3_f32 v11, v87, v92, v11
v_max3_f32 v11, v93, v94, v11
v_max_f32 v11, v95, v11
v_mov_b32 v12, v10
v_mov_b32 v13, v11
s_nop 0
v_permlane16_swap_b32 v12, v10
v_permlane16_swap_b32 v13, v11
v_max_f32 v10, v12, v10
v_max_f32 v11, v13, v11
v_mov_b32 v12, v10
v_mov_b32 v13, v11
s_nop 0
v_permlane32_swap_b32 v12, v10
v_permlane32_swap_b32 v13, v11
v_max_f32 v10, v12, v10
v_max_f32 v11, v13, v11
v_ceil_f32 v10, v10
v_ceil_f32 v11, v11
v_sub_f32 v64, v64, v10
v_sub_f32 v65, v65, v10
v_sub_f32 v66, v66, v10
v_sub_f32 v67, v67, v10
v_sub_f32 v68, v68, v11
v_sub_f32 v69, v69, v11
v_sub_f32 v70, v70, v11
v_sub_f32 v71, v71, v11
v_sub_f32 v72, v72, v10
v_sub_f32 v73, v73, v10
v_sub_f32 v74, v74, v10
v_sub_f32 v75, v75, v10
v_sub_f32 v76, v76, v11
v_sub_f32 v77, v77, v11
v_sub_f32 v78, v78, v11
v_sub_f32 v79, v79, v11
v_sub_f32 v80, v80, v10
v_sub_f32 v81, v81, v10
v_sub_f32 v82, v82, v10
v_sub_f32 v83, v83, v10
v_sub_f32 v84, v84, v11
v_sub_f32 v85, v85, v11
v_sub_f32 v86, v86, v11
v_sub_f32 v87, v87, v11
v_sub_f32 v88, v88, v10
v_sub_f32 v89, v89, v10
v_sub_f32 v90, v90, v10
v_sub_f32 v91, v91, v10
v_sub_f32 v92, v92, v11
v_sub_f32 v93, v93, v11
v_sub_f32 v94, v94, v11
v_sub_f32 v95, v95, v11
v_sub_f32 v32, v32, v10
v_sub_f32 v33, v33, v10
v_sub_f32 v34, v34, v10
v_sub_f32 v35, v35, v10
v_sub_f32 v36, v36, v11
v_sub_f32 v37, v37, v11
v_sub_f32 v38, v38, v11
v_sub_f32 v39, v39, v11
E v18,v64
E v19,v65
E v20,v66
AF v26,v18,v19
C v40,v18,v19
E v21,v67
E v22,v72
AF v26,v20,v26
C v41,v20,v21
E v23,v73
AF v26,v21,v26
E v24,v74
AF v26,v22,v26
C v42,v22,v23
E v25,v75
AF v26,v23,v26
E v18,v68
AF v26,v24,v26
C v43,v24,v25
E v19,v69
AF v26,v25,v26
E v20,v70
AF v27,v18,v19
C v44,v18,v19
E v21,v71
E v22,v76
AF v27,v20,v27
C v45,v20,v21
E v23,v77
AF v27,v21,v27
E v24,v78
AF v27,v22,v27
C v46,v22,v23
E v25,v79
AF v27,v23,v27
AF v27,v24,v27
C v47,v24,v25
AF v27,v25,v27
s_nop 3
s_setpc_b64 s[36:37]
L_slowb:
s_nop 7
s_nop 3
v_max3_f32 v11, v100, v101, v102
v_max3_f32 v11, v103, v108, v11
v_max3_f32 v11, v109, v110, v11
v_max3_f32 v11, v111, v116, v11
v_max3_f32 v11, v117, v118, v11
v_max3_f32 v11, v119, v124, v11
v_max3_f32 v11, v125, v126, v11
v_max_f32 v11, v127, v11
v_mov_b32 v13, v11
s_nop 1
v_permlane16_swap_b32 v13, v11
v_max_f32 v11, v13, v11
v_mov_b32 v13, v11
s_nop 1
v_permlane32_swap_b32 v13, v11
v_max_f32 v11, v13, v11
v_ceil_f32 v11, v11
v_max_f32 v11, 0, v11
v_mov_b32 v10, 0
v_sub_f32 v100, v100, v11
v_sub_f32 v101, v101, v11
v_sub_f32 v102, v102, v11
v_sub_f32 v103, v103, v11
v_sub_f32 v108, v108, v11
v_sub_f32 v109, v109, v11
v_sub_f32 v110, v110, v11
v_sub_f32 v111, v111, v11
v_sub_f32 v116, v116, v11
v_sub_f32 v117, v117, v11
v_sub_f32 v118, v118, v11
v_sub_f32 v119, v119, v11
v_sub_f32 v124, v124, v11
v_sub_f32 v125, v125, v11
v_sub_f32 v126, v126, v11
v_sub_f32 v127, v127, v11
v_sub_f32 v32, v32, v10
v_sub_f32 v33, v33, v10
v_sub_f32 v34, v34, v10
v_sub_f32 v35, v35, v10
v_sub_f32 v36, v36, v11
v_sub_f32 v37, v37, v11
v_sub_f32 v38, v38, v11
v_sub_f32 v39, v39, v11
E v12,-v10
E v13,-v11
MF v30,v12,v30
MF v31,v13,v31
MF v128,v12,v128
MF v129,v12,v129
MF v130,v12,v130
MF v131,v12,v131
MF v132,v13,v132
MF v133,v13,v133
MF v134,v13,v134
MF v135,v13,v135
MF v136,v12,v136
MF v137,v12,v137
MF v138,v12,v138
MF v139,v12,v139
MF v140,v13,v140
MF v141,v13,v141
MF v142,v13,v142
MF v143,v13,v143
MF v144,v12,v144
MF v145,v12,v145
MF v146,v12,v146
MF v147,v12,v147
MF v148,v13,v148
MF v149,v13,v149
MF v150,v13,v150
MF v151,v13,v151
MF v152,v12,v152
MF v153,v12,v153
MF v154,v12,v154
MF v155,v12,v155
MF v156,v13,v156
MF v157,v13,v157
MF v158,v13,v158
MF v159,v13,v159
MF v160,v12,v160
MF v161,v12,v161
MF v162,v12,v162
MF v163,v12,v163
MF v164,v13,v164
MF v165,v13,v165
MF v166,v13,v166
MF v167,v13,v167
MF v168,v12,v168
MF v169,v12,v169
MF v170,v12,v170
MF v171,v12,v171
MF v172,v13,v172
MF v173,v13,v173
MF v174,v13,v174
MF v175,v13,v175
MF v176,v12,v176
MF v177,v12,v177
MF v178,v12,v178
MF v179,v12,v179
MF v180,v13,v180
MF v181,v13,v181
MF v182,v13,v182
MF v183,v13,v183
MF v184,v12,v184
MF v185,v12,v185
MF v186,v12,v186
MF v187,v12,v187
MF v188,v13,v188
MF v189,v13,v189
MF v190,v13,v190
MF v191,v13,v191
MF v192,v12,v192
MF v193,v12,v193
MF v194,v12,v194
MF v195,v12,v195
MF v196,v13,v196
MF v197,v13,v197
MF v198,v13,v198
MF v199,v13,v199
MF v200,v12,v200
MF v201,v12,v201
MF v202,v12,v202
MF v203,v12,v203
MF v204,v13,v204
MF v205,v13,v205
MF v206,v13,v206
MF v207,v13,v207
MF v208,v12,v208
MF v209,v12,v209
MF v210,v12,v210
MF v211,v12,v211
MF v212,v13,v212
MF v213,v13,v213
MF v214,v13,v214
MF v215,v13,v215
MF v216,v12,v216
MF v217,v12,v217
MF v218,v12,v218
MF v219,v12,v219
MF v220,v13,v220
MF v221,v13,v221
MF v222,v13,v222
MF v223,v13,v223
MF v224,v12,v224
MF v225,v12,v225
MF v226,v12,v226
MF v227,v12,v227
MF v228,v13,v228
MF v229,v13,v229
MF v230,v13,v230
MF v231,v13,v231
MF v232,v12,v232
MF v233,v12,v233
MF v234,v12,v234
MF v235,v12,v235
MF v236,v13,v236
MF v237,v13,v237
MF v238,v13,v238
MF v239,v13,v239
MF v240,v12,v240
MF v241,v12,v241
MF v242,v12,v242
MF v243,v12,v243
MF v244,v13,v244
MF v245,v13,v245
MF v246,v13,v246
MF v247,v13,v247
MF v248,v12,v248
MF v249,v12,v249
MF v250,v12,v250
MF v251,v12,v251
MF v252,v13,v252
MF v253,v13,v253
MF v254,v13,v254
MF v255,v13,v255
E v18,v100
E v19,v101
E v20,v102
AF v29,v18,v19
C v52,v18,v19
E v21,v103
E v22,v108
AF v29,v20,v29
C v53,v20,v21
E v23,v109
AF v29,v21,v29
E v24,v110
AF v29,v22,v29
C v54,v22,v23
E v25,v111
AF v29,v23,v29
E v18,v116
AF v29,v24,v29
C v55,v24,v25
E v19,v117
AF v29,v25,v29
E v20,v118
AF v29,v18,v29
C v48,v18,v19
E v21,v119
AF v29,v19,v29
E v22,v124
AF v29,v20,v29
C v49,v20,v21
E v23,v125
AF v29,v21,v29
E v24,v126
AF v29,v22,v29
C v50,v22,v23
E v25,v127
AF v29,v23,v29
AF v29,v24,v29
C v51,v24,v25
AF v29,v25,v29
s_nop 3
s_setpc_b64 s[36:37]
L_comb:
s_waitcnt vmcnt(0)
s_nop 7
v_sub_f32 v10, v32, v14
v_sub_f32 v11, v36, v15
v_max_f32 v10, 0, v10
v_max_f32 v11, 0, v11
v_sub_f32 v100, v100, v11
v_sub_f32 v101, v101, v11
v_sub_f32 v102, v102, v11
v_sub_f32 v103, v103, v11
v_sub_f32 v108, v108, v11
v_sub_f32 v109, v109, v11
v_sub_f32 v110, v110, v11
v_sub_f32 v111, v111, v11
v_sub_f32 v116, v116, v11
v_sub_f32 v117, v117, v11
v_sub_f32 v118, v118, v11
v_sub_f32 v119, v119, v11
v_sub_f32 v124, v124, v11
v_sub_f32 v125, v125, v11
v_sub_f32 v126, v126, v11
v_sub_f32 v127, v127, v11
v_sub_f32 v32, v32, v10
v_sub_f32 v33, v33, v10
v_sub_f32 v34, v34, v10
v_sub_f32 v35, v35, v10
v_sub_f32 v36, v36, v11
v_sub_f32 v37, v37, v11
v_sub_f32 v38, v38, v11
v_sub_f32 v39, v39, v11
E v12,-v10
E v13,-v11
MF v30,v12,v30
MF v31,v13,v31
MF v128,v12,v128
MF v129,v12,v129
MF v130,v12,v130
MF v131,v12,v131
MF v132,v13,v132
MF v133,v13,v133
MF v134,v13,v134
MF v135,v13,v135
MF v136,v12,v136
MF v137,v12,v137
MF v138,v12,v138
MF v139,v12,v139
MF v140,v13,v140
MF v141,v13,v141
MF v142,v13,v142
MF v143,v13,v143
MF v144,v12,v144
MF v145,v12,v145
MF v146,v12,v146
MF v147,v12,v147
MF v148,v13,v148
MF v149,v13,v149
MF v150,v13,v150
MF v151,v13,v151
MF v152,v12,v152
MF v153,v12,v153
MF v154,v12,v154
MF v155,v12,v155
MF v156,v13,v156
MF v157,v13,v157
MF v158,v13,v158
MF v159,v13,v159
MF v160,v12,v160
MF v161,v12,v161
MF v162,v12,v162
MF v163,v12,v163
MF v164,v13,v164
MF v165,v13,v165
MF v166,v13,v166
MF v167,v13,v167
MF v168,v12,v168
MF v169,v12,v169
MF v170,v12,v170
MF v171,v12,v171
MF v172,v13,v172
MF v173,v13,v173
MF v174,v13,v174
MF v175,v13,v175
MF v176,v12,v176
MF v177,v12,v177
MF v178,v12,v178
MF v179,v12,v179
MF v180,v13,v180
MF v181,v13,v181
MF v182,v13,v182
MF v183,v13,v183
MF v184,v12,v184
MF v185,v12,v185
MF v186,v12,v186
MF v187,v12,v187
MF v188,v13,v188
MF v189,v13,v189
MF v190,v13,v190
MF v191,v13,v191
MF v192,v12,v192
MF v193,v12,v193
MF v194,v12,v194
MF v195,v12,v195
MF v196,v13,v196
MF v197,v13,v197
MF v198,v13,v198
MF v199,v13,v199
MF v200,v12,v200
MF v201,v12,v201
MF v202,v12,v202
MF v203,v12,v203
MF v204,v13,v204
MF v205,v13,v205
MF v206,v13,v206
MF v207,v13,v207
MF v208,v12,v208
MF v209,v12,v209
MF v210,v12,v210
MF v211,v12,v211
MF v212,v13,v212
MF v213,v13,v213
MF v214,v13,v214
MF v215,v13,v215
MF v216,v12,v216
MF v217,v12,v217
MF v218,v12,v218
MF v219,v12,v219
MF v220,v13,v220
MF v221,v13,v221
MF v222,v13,v222
MF v223,v13,v223
MF v224,v12,v224
MF v225,v12,v225
MF v226,v12,v226
MF v227,v12,v227
MF v228,v13,v228
MF v229,v13,v229
MF v230,v13,v230
MF v231,v13,v231
MF v232,v12,v232
MF v233,v12,v233
MF v234,v12,v234
MF v235,v12,v235
MF v236,v13,v236
MF v237,v13,v237
MF v238,v13,v238
MF v239,v13,v239
MF v240,v12,v240
MF v241,v12,v241
MF v242,v12,v242
MF v243,v12,v243
MF v244,v13,v244
MF v245,v13,v245
MF v246,v13,v246
MF v247,v13,v247
MF v248,v12,v248
MF v249,v12,v249
MF v250,v12,v250
MF v251,v12,v251
MF v252,v13,v252
MF v253,v13,v253
MF v254,v13,v254
MF v255,v13,v255
E v18,v100
E v19,v101
E v20,v102
AF v29,v18,v19
C v52,v18,v19
E v21,v103
E v22,v108
AF v29,v20,v29
C v53,v20,v21
E v23,v109
AF v29,v21,v29
E v24,v110
AF v29,v22,v29
C v54,v22,v23
E v25,v111
AF v29,v23,v29
E v18,v116
AF v29,v24,v29
C v55,v24,v25
E v19,v117
AF v29,v25,v29
E v20,v118
AF v29,v18,v29
C v48,v18,v19
E v21,v119
AF v29,v19,v29
E v22,v124
AF v29,v20,v29
C v49,v20,v21
E v23,v125
AF v29,v21,v29
E v24,v126
AF v29,v22,v29
C v50,v22,v23
E v25,v127
AF v29,v23,v29
AF v29,v24,v29
C v51,v24,v25
AF v29,v25,v29
v_sub_f32 v10, v32, v14
v_sub_f32 v11, v36, v15
E v10,v10
E v11,v11
s_nop 0
MF v16,v10,v16
MF v17,v11,v17
G v64,a128
v_and_b32 v65, 0xffff0000, v64
v_lshlrev_b32 v64, 16, v64
MF v64,v10,v64
MF v65,v10,v65
C v64,v64,v65
W a128,v64
G v66,a129
v_and_b32 v67, 0xffff0000, v66
v_lshlrev_b32 v66, 16, v66
MF v66,v10,v66
MF v67,v10,v67
C v66,v66,v67
W a129,v66
G v68,a130
v_and_b32 v69, 0xffff0000, v68
v_lshlrev_b32 v68, 16, v68
MF v68,v10,v68
MF v69,v10,v69
C v68,v68,v69
W a130,v68
G v70,a131
v_and_b32 v71, 0xffff0000, v70
v_lshlrev_b32 v70, 16, v70
MF v70,v10,v70
MF v71,v10,v71
C v70,v70,v71
W a131,v70
G v72,a132
v_and_b32 v73, 0xffff0000, v72
v_lshlrev_b32 v72, 16, v72
MF v72,v10,v72
MF v73,v10,v73
C v72,v72,v73
W a132,v72
G v74,a133
v_and_b32 v75, 0xffff0000, v74
v_lshlrev_b32 v74, 16, v74
MF v74,v10,v74
MF v75,v10,v75
C v74,v74,v75
W a133,v74
G v76,a134
v_and_b32 v77, 0xffff0000, v76
v_lshlrev_b32 v76, 16, v76
MF v76,v10,v76
MF v77,v10,v77
C v76,v76,v77
W a134,v76
G v78,a135
v_and_b32 v79, 0xffff0000, v78
v_lshlrev_b32 v78, 16, v78
MF v78,v10,v78
MF v79,v10,v79
C v78,v78,v79
W a135,v78
G v64,a136
v_and_b32 v65, 0xffff0000, v64
v_lshlrev_b32 v64, 16, v64
MF v64,v10,v64
MF v65,v10,v65
C v64,v64,v65
W a136,v64
G v66,a137
v_and_b32 v67, 0xffff0000, v66
v_lshlrev_b32 v66, 16, v66
MF v66,v10,v66
MF v67,v10,v67
C v66,v66,v67
W a137,v66
G v68,a138
v_and_b32 v69, 0xffff0000, v68
v_lshlrev_b32 v68, 16, v68
MF v68,v10,v68
MF v69,v10,v69
C v68,v68,v69
W a138,v68
G v70,a139
v_and_b32 v71, 0xffff0000, v70
v_lshlrev_b32 v70, 16, v70
MF v70,v10,v70
MF v71,v10,v71
C v70,v70,v71
W a139,v70
G v72,a140
v_and_b32 v73, 0xffff0000, v72
v_lshlrev_b32 v72, 16, v72
MF v72,v10,v72
MF v73,v10,v73
C v72,v72,v73
W a140,v72
G v74,a141
v_and_b32 v75, 0xffff0000, v74
v_lshlrev_b32 v74, 16, v74
MF v74,v10,v74
MF v75,v10,v75
C v74,v74,v75
W a141,v74
G v76,a142
v_and_b32 v77, 0xffff0000, v76
v_lshlrev_b32 v76, 16, v76
MF v76,v10,v76
MF v77,v10,v77
C v76,v76,v77
W a142,v76
G v78,a143
v_and_b32 v79, 0xffff0000, v78
v_lshlrev_b32 v78, 16, v78
MF v78,v10,v78
MF v79,v10,v79
C v78,v78,v79
W a143,v78
G v64,a144
v_and_b32 v65, 0xffff0000, v64
v_lshlrev_b32 v64, 16, v64
MF v64,v10,v64
MF v65,v10,v65
C v64,v64,v65
W a144,v64
G v66,a145
v_and_b32 v67, 0xffff0000, v66
v_lshlrev_b32 v66, 16, v66
MF v66,v10,v66
MF v67,v10,v67
C v66,v66,v67
W a145,v66
G v68,a146
v_and_b32 v69, 0xffff0000, v68
v_lshlrev_b32 v68, 16, v68
MF v68,v10,v68
MF v69,v10,v69
C v68,v68,v69
W a146,v68
G v70,a147
v_and_b32 v71, 0xffff0000, v70
v_lshlrev_b32 v70, 16, v70
MF v70,v10,v70
MF v71,v10,v71
C v70,v70,v71
W a147,v70
G v72,a148
v_and_b32 v73, 0xffff0000, v72
v_lshlrev_b32 v72, 16, v72
MF v72,v10,v72
MF v73,v10,v73
C v72,v72,v73
W a148,v72
G v74,a149
v_and_b32 v75, 0xffff0000, v74
v_lshlrev_b32 v74, 16, v74
MF v74,v10,v74
MF v75,v10,v75
C v74,v74,v75
W a149,v74
G v76,a150
v_and_b32 v77, 0xffff0000, v76
v_lshlrev_b32 v76, 16, v76
MF v76,v10,v76
MF v77,v10,v77
C v76,v76,v77
W a150,v76
G v78,a151
v_and_b32 v79, 0xffff0000, v78
v_lshlrev_b32 v78, 16, v78
MF v78,v10,v78
MF v79,v10,v79
C v78,v78,v79
W a151,v78
G v64,a152
v_and_b32 v65, 0xffff0000, v64
v_lshlrev_b32 v64, 16, v64
MF v64,v10,v64
MF v65,v10,v65
C v64,v64,v65
W a152,v64
G v66,a153
v_and_b32 v67, 0xffff0000, v66
v_lshlrev_b32 v66, 16, v66
MF v66,v10,v66
MF v67,v10,v67
C v66,v66,v67
W a153,v66
G v68,a154
v_and_b32 v69, 0xffff0000, v68
v_lshlrev_b32 v68, 16, v68
MF v68,v10,v68
MF v69,v10,v69
C v68,v68,v69
W a154,v68
G v70,a155
v_and_b32 v71, 0xffff0000, v70
v_lshlrev_b32 v70, 16, v70
MF v70,v10,v70
MF v71,v10,v71
C v70,v70,v71
W a155,v70
G v72,a156
v_and_b32 v73, 0xffff0000, v72
v_lshlrev_b32 v72, 16, v72
MF v72,v10,v72
MF v73,v10,v73
C v72,v72,v73
W a156,v72
G v74,a157
v_and_b32 v75, 0xffff0000, v74
v_lshlrev_b32 v74, 16, v74
MF v74,v10,v74
MF v75,v10,v75
C v74,v74,v75
W a157,v74
G v76,a158
v_and_b32 v77, 0xffff0000, v76
v_lshlrev_b32 v76, 16, v76
MF v76,v10,v76
MF v77,v10,v77
C v76,v76,v77
W a158,v76
G v78,a159
v_and_b32 v79, 0xffff0000, v78
v_lshlrev_b32 v78, 16, v78
MF v78,v10,v78
MF v79,v10,v79
C v78,v78,v79
W a159,v78
G v64,a160
v_and_b32 v65, 0xffff0000, v64
v_lshlrev_b32 v64, 16, v64
MF v64,v11,v64
MF v65,v11,v65
C v64,v64,v65
W a160,v64
G v66,a161
v_and_b32 v67, 0xffff0000, v66
v_lshlrev_b32 v66, 16, v66
MF v66,v11,v66
MF v67,v11,v67
C v66,v66,v67
W a161,v66
G v68,a162
v_and_b32 v69, 0xffff0000, v68
v_lshlrev_b32 v68, 16, v68
MF v68,v11,v68
MF v69,v11,v69
C v68,v68,v69
W a162,v68
G v70,a163
v_and_b32 v71, 0xffff0000, v70
v_lshlrev_b32 v70, 16, v70
MF v70,v11,v70
MF v71,v11,v71
C v70,v70,v71
W a163,v70
G v72,a164
v_and_b32 v73, 0xffff0000, v72
v_lshlrev_b32 v72, 16, v72
MF v72,v11,v72
MF v73,v11,v73
C v72,v72,v73
W a164,v72
G v74,a165
v_and_b32 v75, 0xffff0000, v74
v_lshlrev_b32 v74, 16, v74
MF v74,v11,v74
MF v75,v11,v75
C v74,v74,v75
W a165,v74
G v76,a166
v_and_b32 v77, 0xffff0000, v76
v_lshlrev_b32 v76, 16, v76
MF v76,v11,v76
MF v77,v11,v77
C v76,v76,v77
W a166,v76
G v78,a167
v_and_b32 v79, 0xffff0000, v78
v_lshlrev_b32 v78, 16, v78
MF v78,v11,v78
MF v79,v11,v79
C v78,v78,v79
W a167,v78
G v64,a168
v_and_b32 v65, 0xffff0000, v64
v_lshlrev_b32 v64, 16, v64
MF v64,v11,v64
MF v65,v11,v65
C v64,v64,v65
W a168,v64
G v66,a169
v_and_b32 v67, 0xffff0000, v66
v_lshlrev_b32 v66, 16, v66
MF v66,v11,v66
MF v67,v11,v67
C v66,v66,v67
W a169,v66
G v68,a170
v_and_b32 v69, 0xffff0000, v68
v_lshlrev_b32 v68, 16, v68
MF v68,v11,v68
MF v69,v11,v69
C v68,v68,v69
W a170,v68
G v70,a171
v_and_b32 v71, 0xffff0000, v70
v_lshlrev_b32 v70, 16, v70
MF v70,v11,v70
MF v71,v11,v71
C v70,v70,v71
W a171,v70
G v72,a172
v_and_b32 v73, 0xffff0000, v72
v_lshlrev_b32 v72, 16, v72
MF v72,v11,v72
MF v73,v11,v73
C v72,v72,v73
W a172,v72
G v74,a173
v_and_b32 v75, 0xffff0000, v74
v_lshlrev_b32 v74, 16, v74
MF v74,v11,v74
MF v75,v11,v75
C v74,v74,v75
W a173,v74
G v76,a174
v_and_b32 v77, 0xffff0000, v76
v_lshlrev_b32 v76, 16, v76
MF v76,v11,v76
MF v77,v11,v77
C v76,v76,v77
W a174,v76
G v78,a175
v_and_b32 v79, 0xffff0000, v78
v_lshlrev_b32 v78, 16, v78
MF v78,v11,v78
MF v79,v11,v79
C v78,v78,v79
W a175,v78
G v64,a176
v_and_b32 v65, 0xffff0000, v64
v_lshlrev_b32 v64, 16, v64
MF v64,v11,v64
MF v65,v11,v65
C v64,v64,v65
W a176,v64
G v66,a177
v_and_b32 v67, 0xffff0000, v66
v_lshlrev_b32 v66, 16, v66
MF v66,v11,v66
MF v67,v11,v67
C v66,v66,v67
W a177,v66
G v68,a178
v_and_b32 v69, 0xffff0000, v68
v_lshlrev_b32 v68, 16, v68
MF v68,v11,v68
MF v69,v11,v69
C v68,v68,v69
W a178,v68
G v70,a179
v_and_b32 v71, 0xffff0000, v70
v_lshlrev_b32 v70, 16, v70
MF v70,v11,v70
MF v71,v11,v71
C v70,v70,v71
W a179,v70
G v72,a180
v_and_b32 v73, 0xffff0000, v72
v_lshlrev_b32 v72, 16, v72
MF v72,v11,v72
MF v73,v11,v73
C v72,v72,v73
W a180,v72
G v74,a181
v_and_b32 v75, 0xffff0000, v74
v_lshlrev_b32 v74, 16, v74
MF v74,v11,v74
MF v75,v11,v75
C v74,v74,v75
W a181,v74
G v76,a182
v_and_b32 v77, 0xffff0000, v76
v_lshlrev_b32 v76, 16, v76
MF v76,v11,v76
MF v77,v11,v77
C v76,v76,v77
W a182,v76
G v78,a183
v_and_b32 v79, 0xffff0000, v78
v_lshlrev_b32 v78, 16, v78
MF v78,v11,v78
MF v79,v11,v79
C v78,v78,v79
W a183,v78
G v64,a184
v_and_b32 v65, 0xffff0000, v64
v_lshlrev_b32 v64, 16, v64
MF v64,v11,v64
MF v65,v11,v65
C v64,v64,v65
W a184,v64
G v66,a185
v_and_b32 v67, 0xffff0000, v66
v_lshlrev_b32 v66, 16, v66
MF v66,v11,v66
MF v67,v11,v67
C v66,v66,v67
W a185,v66
G v68,a186
v_and_b32 v69, 0xffff0000, v68
v_lshlrev_b32 v68, 16, v68
MF v68,v11,v68
MF v69,v11,v69
C v68,v68,v69
W a186,v68
G v70,a187
v_and_b32 v71, 0xffff0000, v70
v_lshlrev_b32 v70, 16, v70
MF v70,v11,v70
MF v71,v11,v71
C v70,v70,v71
W a187,v70
G v72,a188
v_and_b32 v73, 0xffff0000, v72
v_lshlrev_b32 v72, 16, v72
MF v72,v11,v72
MF v73,v11,v73
C v72,v72,v73
W a188,v72
G v74,a189
v_and_b32 v75, 0xffff0000, v74
v_lshlrev_b32 v74, 16, v74
MF v74,v11,v74
MF v75,v11,v75
C v74,v74,v75
W a189,v74
G v76,a190
v_and_b32 v77, 0xffff0000, v76
v_lshlrev_b32 v76, 16, v76
MF v76,v11,v76
MF v77,v11,v77
C v76,v76,v77
W a190,v76
G v78,a191
v_and_b32 v79, 0xffff0000, v78
v_lshlrev_b32 v78, 16, v78
MF v78,v11,v78
MF v79,v11,v79
C v78,v78,v79
W a191,v78
s_nop 3
s_setpc_b64 s[36:37]
L_zs0:
s_mov_b32 s64, 65536
L_zs0_l:
s_sleep 2
buffer_load_dword v17, v16, s[12:15], 0 offen sc1
s_sub_u32 s64, s64, 1
s_cbranch_scc1 L_zs0_x
s_waitcnt vmcnt(0)
v_cmp_ne_u32 vcc, 1, v17
s_nop 0
s_cbranch_vccnz L_zs0_l
L_zs0_x:
s_waitcnt vmcnt(0)
s_branch L_zr0
L_zs1:
s_mov_b32 s64, 65536
L_zs1_l:
s_sleep 2
buffer_load_dword v17, v16, s[12:15], 0 offen sc1
s_sub_u32 s64, s64, 1
s_cbranch_scc1 L_zs1_x
s_waitcnt vmcnt(0)
v_cmp_ne_u32 vcc, 1, v17
s_nop 0
s_cbranch_vccnz L_zs1_l
L_zs1_x:
s_waitcnt vmcnt(0)
s_branch L_zr1
L_hs:
s_mov_b32 s91, 65536
L_hs_l:
buffer_load_dwordx4 v[16:19], v7, s[8:11], s67 offen offset:0 sc1
buffer_load_dwordx4 v[20:23], v7, s[8:11], s67 offen offset:1024 sc1
s_waitcnt vmcnt(0)
s_sub_u32 s91, s91, 1
s_cbranch_scc1 L_hr
v_min3_u32 v28, v16, v17, v18
v_min3_u32 v28, v28, v19, v20
v_min3_u32 v28, v28, v21, v22
v_min_u32 v28, v28, v23
v_cmp_eq_u32 vcc, 0, v28
s_nop 0
s_cbranch_vccnz L_hs_l
s_branch L_hr
L_lsj0:
s_mov_b32 s91, 65536
L_lsj0_l:
s_sleep 2
buffer_load_dword v5, v17, s[8:11], s46 offen sc1
s_sub_u32 s91, s91, 1
s_cbranch_scc1 L_lsj0_x
s_waitcnt vmcnt(0)
v_cmp_gt_u32 vcc, 2, v5
s_nop 0
s_cbranch_vccnz L_lsj0_l
L_lsj0_x:
s_waitcnt vmcnt(0)
s_branch L_lrj0
L_lsh2:
s_mov_b32 s91, 65536
L_lsh2_l:
s_sleep 2
buffer_load_dword v5, v17, s[8:11], s46 offen sc1
s_sub_u32 s91, s91, 1
s_cbranch_scc1 L_lsh2_x
s_waitcnt vmcnt(0)
v_cmp_gt_u32 vcc, 2, v5
s_nop 0
s_cbranch_vccnz L_lsh2_l
L_lsh2_x:
s_waitcnt vmcnt(0)
s_branch L_lrh2
L_lsh4:
s_mov_b32 s91, 65536
L_lsh4_l:
s_sleep 2
buffer_load_dword v5, v9, s[8:11], s46 offen sc1
s_sub_u32 s91, s91, 1
s_cbranch_scc1 L_lsh4_x
s_waitcnt vmcnt(0)
v_cmp_gt_u32 vcc, s84, v5
s_nop 0
s_cbranch_vccnz L_lsh4_l
L_lsh4_x:
s_waitcnt vmcnt(0)
s_branch L_lrh4
L_wsq0:
s_mov_b32 s91, 65536
L_wsq0_l:
s_sleep 2
buffer_load_dword v5, v31, s[8:11], s46 offen offset:4 sc1
s_sub_u32 s91, s91, 1
s_cbranch_scc1 L_wsq0_x
s_waitcnt vmcnt(0)
v_cmp_ne_u32 vcc, 1, v5
s_nop 0
s_mov_b32 vcc_hi, 0
s_cbranch_vccnz L_wsq0_l
L_wsq0_x:
s_waitcnt vmcnt(0)
s_branch L_wrq0
L_wsr0:
s_mov_b32 s91, 65536
L_wsr0_l:
s_sleep 2
buffer_load_dword v5, v31, s[8:11], s46 offen offset:4 sc1
s_sub_u32 s91, s91, 1
s_cbranch_scc1 L_wsr0_x
s_waitcnt vmcnt(0)
v_cmp_ne_u32 vcc, 1, v5
s_nop 0
s_mov_b32 vcc_lo, 0
s_cbranch_vccnz L_wsr0_l
L_wsr0_x:
s_waitcnt vmcnt(0)
s_branch L_wrr0
L_wsq1:
s_mov_b32 s91, 65536
L_wsq1_l:
s_sleep 2
buffer_load_dword v5, v31, s[8:11], s46 offen offset:4 sc1
s_sub_u32 s91, s91, 1
s_cbranch_scc1 L_wsq1_x
s_waitcnt vmcnt(0)
v_cmp_ne_u32 vcc, 1, v5
s_nop 0
s_mov_b32 vcc_hi, 0
s_cbranch_vccnz L_wsq1_l
L_wsq1_x:
s_waitcnt vmcnt(0)
s_branch L_wrq1
L_wsr1:
s_mov_b32 s91, 65536
L_wsr1_l:
s_sleep 2
buffer_load_dword v5, v31, s[8:11], s46 offen offset:4 sc1
s_sub_u32 s91, s91, 1
s_cbranch_scc1 L_wsr1_x
s_waitcnt vmcnt(0)
v_cmp_ne_u32 vcc, 1, v5
s_nop 0
s_mov_b32 vcc_lo, 0
s_cbranch_vccnz L_wsr1_l
L_wsr1_x:
s_waitcnt vmcnt(0)
s_branch L_wrr1
L_fll:
s_sub_u32 s65, s7, s40
s_mov_b32 s64, -1
s_cmp_eq_u32 s65, 1
s_cbranch_scc1 L_fl2
s_cmp_lg_u32 s20, 0
s_cbranch_scc1 L_fl3
s_lshr_b32 s64, s42, 3
s_cmp_eq_u32 s7, s64
s_cbranch_scc0 L_fl1
v_mov_b32 v15, 4
buffer_store_dword v15, v1, s[8:11], s45 offen sc1
L_fl1:
s_cmp_lg_u32 s65, 0
s_cbranch_scc1 L_fllr
s_movk_i32 s64, 0x380
L_fl2:
v_min_u32 v17, s64, v9
s_mov_b32 s6, 4
buffer_load_dword v5, v17, s[8:11], s46 offen sc1
s_bitcmp1_b32 s39, 15
s_cbranch_scc0 L_fllr
L_fl3:
s_cmp_eq_u32 s7, 1
s_cbranch_scc1 L_y2
s_cmp_eq_u32 s7, 2
s_cbranch_scc1 L_y3
s_cmp_eq_u32 s7, 3
s_cbranch_scc1 L_y4
s_branch L_y5
s_waitcnt vmcnt(0)
L_fps:
s_cmp_lg_u32 s35, 0
s_cbranch_scc1 L_fpr
L_fps2:
s_mov_b32 s91, 65536
L_fps2_l:
s_sleep 2
buffer_load_dword v6, off, s[8:11], s47 sc1
s_sub_u32 s91, s91, 1
s_cbranch_scc1 L_fps2_x
s_waitcnt vmcnt(0)
v_cmp_ne_u32 vcc, 1, v6
s_nop 0
s_cbranch_vccnz L_fps2_l
L_fps2_x:
s_waitcnt vmcnt(0)
s_branch L_fpr
L_fqs:
s_mov_b32 s91, 65536
L_fqs_l:
s_sleep 2
buffer_load_dword v6, off, s[8:11], s47 offset:16 sc1
s_sub_u32 s91, s91, 1
s_cbranch_scc1 L_fqs_x
s_waitcnt vmcnt(0)
v_cmp_ne_u32 vcc, 1, v6
s_nop 0
s_cbranch_vccnz L_fqs_l
L_fqs_x:
s_waitcnt vmcnt(0)
s_branch L_fqr
L_fls0:
s_mov_b32 s91, 65536
L_fls0_l:
s_sleep 2
buffer_load_dword v5, v17, s[8:11], s46 offen sc1
s_sub_u32 s91, s91, 1
s_cbranch_scc1 L_fls0_x
s_waitcnt vmcnt(0)
v_cmp_gt_u32 vcc, s6, v5
s_nop 0
s_cbranch_vccnz L_fls0_l
L_fls0_x:
s_waitcnt vmcnt(0)
s_branch L_flr0
L_y2:
v_lshrrev_b32 v11, 7, v7
v_mul_u32_u24 v11, 4352, v11
v_and_b32 v12, 0x70, v7
v_lshl_add_u32 v11, v12, 3, v11
s_mov_b32 s64, 104923136
s_mov_b32 s65, 104957952
buffer_load_dword a128, v11, s[8:11], s64 offen sc1
buffer_load_dword a129, v11, s[8:11], s65 offen sc1
s_branch L_fllr
s_waitcnt vmcnt(0)
L_y3:
s_mov_b32 s91, 65536
L_y3c:
G v12,a128
G v13,a129
v_min_u32 v12, v12, v13
v_cmp_gt_u32 vcc, 2, v12
s_sub_u32 s91, s91, 1
s_cbranch_scc1 L_y3x
s_cbranch_vccz L_y3x
v_lshrrev_b32 v11, 7, v7
v_mul_u32_u24 v11, 4352, v11
v_and_b32 v12, 0x70, v7
v_lshl_add_u32 v11, v12, 3, v11
s_mov_b32 s64, 104923136
s_mov_b32 s65, 104957952
buffer_load_dword a128, v11, s[8:11], s64 offen sc1
buffer_load_dword a129, v11, s[8:11], s65 offen sc1
s_waitcnt vmcnt(0)
s_branch L_y3c
L_y3x:
s_lshl_b32 s66, s41, 1
SA s66,s66,s20
s_sub_u32 s66, s66, 2
s_cmp_lt_u32 s66, 14
s_cselect_b32 s64, 8, 12
SA s64,s64,104890368
buffer_load_dword a130, off, s[8:11], s64 sc1
v_lshrrev_b32 v11, 7, v7
v_mul_u32_u24 v11, 3584, v11
v_and_b32 v12, 0x70, v7
v_add_u32 v11, v12, v11
s_lshl_b32 s65, s66, 7
SA s65,s65,105906176
buffer_load_dwordx4 a[132:135], v11, s[8:11], s65 offen sc1
SA s65,s65,28672
buffer_load_dwordx4 a[136:139], v11, s[8:11], s65 offen sc1
SA s65,s65,28672
buffer_load_dwordx4 a[140:143], v11, s[8:11], s65 offen sc1
SA s65,s65,28672
buffer_load_dwordx4 a[144:147], v11, s[8:11], s65 offen sc1
SA s65,s65,28672
buffer_load_dwordx4 a[148:151], v11, s[8:11], s65 offen sc1
SA s65,s65,28672
buffer_load_dwordx4 a[152:155], v11, s[8:11], s65 offen sc1
SA s65,s65,28672
buffer_load_dwordx4 a[156:159], v11, s[8:11], s65 offen sc1
SA s65,s65,28672
buffer_load_dwordx4 a[160:163], v11, s[8:11], s65 offen sc1
SA s65,s65,28672
buffer_load_dwordx4 a[164:167], v11, s[8:11], s65 offen sc1
SA s65,s65,28672
buffer_load_dwordx4 a[168:171], v11, s[8:11], s65 offen sc1
SA s65,s65,28672
buffer_load_dwordx4 a[172:175], v11, s[8:11], s65 offen sc1
SA s65,s65,28672
buffer_load_dwordx4 a[176:179], v11, s[8:11], s65 offen sc1
SA s65,s65,28672
buffer_load_dwordx4 a[180:183], v11, s[8:11], s65 offen sc1
SA s65,s65,28672
buffer_load_dwordx4 a[184:187], v11, s[8:11], s65 offen sc1
SA s65,s65,28672
s_branch L_fllr
s_waitcnt vmcnt(0)
L_y4:
G v12,a132
G v13,a133
G v14,a134
G v15,a135
G v16,a136
G v17,a137
AF v12,v16,v12
AF v13,v17,v13
G v16,a138
G v17,a139
AF v14,v16,v14
AF v15,v17,v15
G v16,a140
G v17,a141
AF v12,v16,v12
AF v13,v17,v13
G v16,a142
G v17,a143
AF v14,v16,v14
AF v15,v17,v15
G v16,a144
G v17,a145
AF v12,v16,v12
AF v13,v17,v13
G v16,a146
G v17,a147
AF v14,v16,v14
AF v15,v17,v15
G v16,a148
G v17,a149
AF v12,v16,v12
AF v13,v17,v13
G v16,a150
G v17,a151
AF v14,v16,v14
AF v15,v17,v15
G v16,a152
G v17,a153
AF v12,v16,v12
AF v13,v17,v13
G v16,a154
G v17,a155
AF v14,v16,v14
AF v15,v17,v15
G v16,a156
G v17,a157
AF v12,v16,v12
AF v13,v17,v13
G v16,a158
G v17,a159
AF v14,v16,v14
AF v15,v17,v15
G v16,a160
G v17,a161
AF v12,v16,v12
AF v13,v17,v13
G v16,a162
G v17,a163
AF v14,v16,v14
AF v15,v17,v15
G v16,a164
G v17,a165
AF v12,v16,v12
AF v13,v17,v13
G v16,a166
G v17,a167
AF v14,v16,v14
AF v15,v17,v15
G v16,a168
G v17,a169
AF v12,v16,v12
AF v13,v17,v13
G v16,a170
G v17,a171
AF v14,v16,v14
AF v15,v17,v15
G v16,a172
G v17,a173
AF v12,v16,v12
AF v13,v17,v13
G v16,a174
G v17,a175
AF v14,v16,v14
AF v15,v17,v15
G v16,a176
G v17,a177
AF v12,v16,v12
AF v13,v17,v13
G v16,a178
G v17,a179
AF v14,v16,v14
AF v15,v17,v15
G v16,a180
G v17,a181
AF v12,v16,v12
AF v13,v17,v13
G v16,a182
G v17,a183
AF v14,v16,v14
AF v15,v17,v15
G v16,a184
G v17,a185
AF v12,v16,v12
AF v13,v17,v13
G v16,a186
G v17,a187
AF v14,v16,v14
AF v15,v17,v15
v_add_f32 v12, v12, v12 row_ror:8 row_mask:0xf bank_mask:0xf
v_add_f32 v13, v13, v13 row_ror:8 row_mask:0xf bank_mask:0xf
v_add_f32 v14, v14, v14 row_ror:8 row_mask:0xf bank_mask:0xf
v_add_f32 v15, v15, v15 row_ror:8 row_mask:0xf bank_mask:0xf
v_mov_b32 v11, v12
s_nop 1
v_permlane16_swap_b32 v11, v12
AF v12,v11,v12
v_mov_b32 v11, v13
s_nop 1
v_permlane16_swap_b32 v11, v13
AF v13,v11,v13
v_mov_b32 v11, v14
s_nop 1
v_permlane16_swap_b32 v11, v14
AF v14,v11,v14
v_mov_b32 v11, v15
s_nop 1
v_permlane16_swap_b32 v11, v15
AF v15,v11,v15
v_mov_b32 v11, v12
s_nop 1
v_permlane32_swap_b32 v11, v12
AF v12,v11,v12
v_mov_b32 v11, v13
s_nop 1
v_permlane32_swap_b32 v11, v13
AF v13,v11,v13
v_mov_b32 v11, v14
s_nop 1
v_permlane32_swap_b32 v11, v14
AF v14,v11,v14
v_mov_b32 v11, v15
s_nop 1
v_permlane32_swap_b32 v11, v15
AF v15,v11,v15
G v16,a130
C v11,v12,v13
v_lshlrev_b32 v12, 16, v11
v_and_b32 v13, 0xffff0000, v11
C v11,v14,v15
v_lshlrev_b32 v14, 16, v11
v_and_b32 v15, 0xffff0000, v11
MF v12,v16,v12
MF v13,v16,v13
MF v14,v16,v14
MF v15,v16,v15
C v11,v12,v13
v_lshlrev_b32 v12, 16, v11
v_and_b32 v13, 0xffff0000, v11
C v11,v14,v15
v_lshlrev_b32 v14, 16, v11
v_and_b32 v15, 0xffff0000, v11
s_lshl_b32 s66, s41, 1
SA s66,s66,s20
s_sub_u32 s66, s66, 2
s_lshl_b32 s65, s66, 7
SA s65,s65,104898560
s_mov_b64 exec, 0xff
buffer_store_dwordx4 v[12:15], v7, s[8:11], s65 offen sc1
s_mov_b64 exec, -1
s_nop 1
s_branch L_fllr
L_y5:
s_lshl_b32 s66, s41, 1
SA s66,s66,s20
s_sub_u32 s66, s66, 2
s_lshl_b32 s66, s66, 2
SA s66,s66,105062912
v_mov_b32 v11, 1
s_mov_b64 exec, 1
buffer_store_dword v11, off, s[8:11], s66 sc1
s_mov_b64 exec, -1
s_branch L_fllr
.p2align 12
L_loop_top:
M v[64:67],a[64:67],a[0:3],v[32:35]
SA m0,s28,0
R a[96:99],v2,40960
M v[64:67],a[68:71],a[4:7],v[64:67]
buffer_load_dword a240, v0, s[60:63], 0 offen offset:0
M v[64:67],a[72:75],a[8:11],v[64:67]
R a[100:103],v2,41984
M v[64:67],a[76:79],a[12:15],v[64:67]
s_waitcnt lgkmcnt(2)
buffer_load_dwordx4 v3, s[8:11], s26 offen offset:0 sc1 lds
M v[64:67],a[80:83],a[16:19],v[64:67]
R a[104:107],v2,43008
M v[64:67],a[84:87],a[20:23],v[64:67]
E v18,v112
M v[64:67],a[88:91],a[24:27],v[64:67]
R a[108:111],v2,44032
M v[64:67],a[92:95],a[28:31],v[64:67]
buffer_load_dwordx4 v3, s[8:11], s26 offen offset:1024 sc1 lds
M v[68:71],a[92:95],a[60:63],v[36:39]
R a[112:115],v2,45056
M v[68:71],a[88:91],a[56:59],v[68:71]
E v19,v113
M v[68:71],a[84:87],a[52:55],v[68:71]
R a[116:119],v2,46080
AF v28,v18,v28
M v[68:71],a[80:83],a[48:51],v[68:71]
E v20,v114
M v[68:71],a[76:79],a[44:47],v[68:71]
R a[120:123],v2,47104
C v56,v18,v19
M v[68:71],a[72:75],a[40:43],v[68:71]
buffer_load_dwordx4 v3, s[8:11], s26 offen offset:2048 sc1 lds
M v[68:71],a[68:71],a[36:39],v[68:71]
R a[124:127],v2,48128
AF v28,v19,v28
M v[68:71],a[64:67],a[32:35],v[68:71]
s_waitcnt lgkmcnt(4)
E v21,v115
M v[76:79],a[96:99],a[32:35],v[36:39]
R a[64:67],v2,49152
AF v28,v20,v28
M v[76:79],a[100:103],a[36:39],v[76:79]
buffer_load_dwordx4 v3, s[8:11], s26 offen offset:3072 sc1 lds
M v[76:79],a[104:107],a[40:43],v[76:79]
R a[68:71],v2,50176
C v57,v20,v21
M v[76:79],a[108:111],a[44:47],v[76:79]
s_waitcnt lgkmcnt(2)
E v22,v120
M v[76:79],a[112:115],a[48:51],v[76:79]
R a[72:75],v2,51200
AF v28,v21,v28
M v[76:79],a[116:119],a[52:55],v[76:79]
E v23,v121
M v[76:79],a[120:123],a[56:59],v[76:79]
SA m0,s28,4096
R a[76:79],v2,52224
AF v28,v22,v28
M v[76:79],a[124:127],a[60:63],v[76:79]
buffer_load_dwordx4 v4, s[8:11], s26 offen offset:0 sc1 lds
M v[72:75],a[124:127],a[28:31],v[32:35]
R a[80:83],v2,53248
C v58,v22,v23
M v[72:75],a[120:123],a[24:27],v[72:75]
E v24,v122
M v[72:75],a[116:119],a[20:23],v[72:75]
R a[84:87],v2,54272
AF v28,v23,v28
M v[72:75],a[112:115],a[16:19],v[72:75]
E v25,v123
M v[72:75],a[108:111],a[12:15],v[72:75]
R a[88:91],v2,55296
AF v28,v24,v28
M v[72:75],a[104:107],a[8:11],v[72:75]
buffer_load_dwordx4 v4, s[8:11], s26 offen offset:1024 sc1 lds
M v[72:75],a[100:103],a[4:7],v[72:75]
R a[92:95],v2,56320
C v59,v24,v25
M v[72:75],a[96:99],a[0:3],v[72:75]
s_waitcnt lgkmcnt(4)
E v18,v116
M v[80:83],a[64:67],a[0:3],v[32:35]
R a[96:99],v2,57344
AF v28,v25,v28
M v[80:83],a[68:71],a[4:7],v[80:83]
R a[100:103],v2,58368
M v[80:83],a[72:75],a[8:11],v[80:83]
buffer_load_dwordx4 v4, s[8:11], s26 offen offset:2048 sc1 lds
M v[80:83],a[76:79],a[12:15],v[80:83]
s_waitcnt lgkmcnt(2)
R a[104:107],v2,59392
M v[80:83],a[80:83],a[16:19],v[80:83]
R a[108:111],v2,60416
M v[80:83],a[84:87],a[20:23],v[80:83]
E v19,v117
M v[80:83],a[88:91],a[24:27],v[80:83]
R a[112:115],v2,61440
AF v29,v18,v29
M v[80:83],a[92:95],a[28:31],v[80:83]
R a[116:119],v2,62464
C v60,v18,v19
M v[84:87],a[92:95],a[60:63],v[36:39]
buffer_load_dwordx4 v4, s[8:11], s26 offen offset:3072 sc1 lds
M v[84:87],a[88:91],a[56:59],v[84:87]
SA s26,s26,32768
R a[120:123],v2,63488
AF v29,v19,v29
M v[84:87],a[84:87],a[52:55],v[84:87]
R a[124:127],v2,64512
M v[84:87],a[80:83],a[48:51],v[84:87]
E v20,v118
M v[84:87],a[76:79],a[44:47],v[84:87]
E v21,v119
M v[84:87],a[72:75],a[40:43],v[84:87]
E v22,v124
M v[84:87],a[68:71],a[36:39],v[84:87]
s_waitcnt vmcnt(17) lgkmcnt(0)
E v23,v125
M v[84:87],a[64:67],a[32:35],v[84:87]
s_barrier
M v[92:95],a[96:99],a[32:35],v[36:39]
R a[64:67],v7,32768
AF v29,v20,v29
M v[92:95],a[100:103],a[36:39],v[92:95]
E v24,v126
M v[92:95],a[104:107],a[40:43],v[92:95]
R a[68:71],v7,33792
C v61,v20,v21
M v[92:95],a[108:111],a[44:47],v[92:95]
AF v29,v21,v29
AF v29,v22,v29
M v[92:95],a[112:115],a[48:51],v[92:95]
R a[72:75],v7,34816
C v62,v22,v23
M v[92:95],a[116:119],a[52:55],v[92:95]
E v25,v127
M v[92:95],a[120:123],a[56:59],v[92:95]
R a[76:79],v7,35840
AF v29,v23,v29
M v[92:95],a[124:127],a[60:63],v[92:95]
AF v29,v24,v29
C v63,v24,v25
M v[88:91],a[124:127],a[28:31],v[32:35]
R a[80:83],v7,36864
AF v29,v25,v29
M v[88:91],a[120:123],a[24:27],v[88:91]
M v[88:91],a[116:119],a[20:23],v[88:91]
R a[84:87],v7,37888
v_max_f32 v10, v28, v29
M v[88:91],a[112:115],a[16:19],v[88:91]
v_cmp_lt_f32 vcc, s31, v10
M v[88:91],a[108:111],a[12:15],v[88:91]
R a[88:91],v7,38912
M v[88:91],a[104:107],a[8:11],v[88:91]
M v[88:91],a[100:103],a[4:7],v[88:91]
s_waitcnt lgkmcnt(3)
R a[92:95],v7,39936
M v[88:91],a[96:99],a[0:3],v[88:91]
s_cbranch_vccnz L_st1
L_rt1:
M v[128:131],a[64:67],v[48:51],v[128:131]
SA m0,s28,98304
R a[96:99],v7,40960
AF v30,v28,v30
M v[128:131],a[68:71],v[56:59],v[128:131]
buffer_load_dwordx4 v3, s[8:11], s21 offen offset:0 sc1 lds
M v[132:135],a[68:71],v[60:63],v[132:135]
R a[100:103],v7,41984
AF v31,v29,v31
M v[132:135],a[64:67],v[52:55],v[132:135]
s_waitcnt lgkmcnt(2)
E v18,v64
M v[140:143],a[72:75],v[52:55],v[140:143]
R a[104:107],v7,43008
M v[140:143],a[76:79],v[60:63],v[140:143]
buffer_load_dwordx4 v3, s[8:11], s21 offen offset:1024 sc1 lds
M v[136:139],a[76:79],v[56:59],v[136:139]
R a[108:111],v7,44032
M v[136:139],a[72:75],v[48:51],v[136:139]
E v19,v65
M v[144:147],a[80:83],v[48:51],v[144:147]
R a[112:115],v7,45056
AF v26,v18,v19
M v[144:147],a[84:87],v[56:59],v[144:147]
E v20,v66
M v[148:151],a[84:87],v[60:63],v[148:151]
R a[116:119],v7,46080
C v40,v18,v19
M v[148:151],a[80:83],v[52:55],v[148:151]
buffer_load_dwordx4 v3, s[8:11], s21 offen offset:2048 sc1 lds
M v[156:159],a[88:91],v[52:55],v[156:159]
R a[120:123],v7,47104
M v[156:159],a[92:95],v[60:63],v[156:159]
E v21,v67
M v[152:155],a[92:95],v[56:59],v[152:155]
R a[124:127],v7,48128
AF v26,v20,v26
M v[152:155],a[88:91],v[48:51],v[152:155]
s_waitcnt lgkmcnt(4)
buffer_load_dwordx4 v3, s[8:11], s21 offen offset:3072 sc1 lds
M v[160:163],a[96:99],v[48:51],v[160:163]
R a[64:67],v7,49152
C v41,v20,v21
M v[160:163],a[100:103],v[56:59],v[160:163]
E v22,v72
M v[164:167],a[100:103],v[60:63],v[164:167]
SA m0,s28,102400
R a[68:71],v7,50176
AF v26,v21,v26
M v[164:167],a[96:99],v[52:55],v[164:167]
s_waitcnt lgkmcnt(2)
buffer_load_dwordx4 v4, s[8:11], s21 offen offset:0 sc1 lds
M v[172:175],a[104:107],v[52:55],v[172:175]
R a[72:75],v7,51200
M v[172:175],a[108:111],v[60:63],v[172:175]
E v23,v73
M v[168:171],a[108:111],v[56:59],v[168:171]
R a[76:79],v7,52224
AF v26,v22,v26
M v[168:171],a[104:107],v[48:51],v[168:171]
E v24,v74
M v[176:179],a[112:115],v[48:51],v[176:179]
R a[80:83],v7,53248
C v42,v22,v23
M v[176:179],a[116:119],v[56:59],v[176:179]
buffer_load_dwordx4 v4, s[8:11], s21 offen offset:1024 sc1 lds
M v[180:183],a[116:119],v[60:63],v[180:183]
R a[84:87],v7,54272
AF v26,v23,v26
M v[180:183],a[112:115],v[52:55],v[180:183]
E v25,v75
M v[188:191],a[120:123],v[52:55],v[188:191]
R a[88:91],v7,55296
AF v26,v24,v26
M v[188:191],a[124:127],v[60:63],v[188:191]
buffer_load_dwordx4 v4, s[8:11], s21 offen offset:2048 sc1 lds
M v[184:187],a[124:127],v[56:59],v[184:187]
R a[92:95],v7,56320
C v43,v24,v25
M v[184:187],a[120:123],v[48:51],v[184:187]
s_waitcnt lgkmcnt(4)
E v18,v68
M v[192:195],a[64:67],v[48:51],v[192:195]
R a[96:99],v7,57344
AF v26,v25,v26
M v[192:195],a[68:71],v[56:59],v[192:195]
R a[100:103],v7,58368
M v[196:199],a[68:71],v[60:63],v[196:199]
buffer_load_dwordx4 v4, s[8:11], s21 offen offset:3072 sc1 lds
M v[196:199],a[64:67],v[52:55],v[196:199]
s_waitcnt lgkmcnt(2)
R a[104:107],v7,59392
M v[204:207],a[72:75],v[52:55],v[204:207]
SA s21,s21,32768
R a[108:111],v7,60416
M v[204:207],a[76:79],v[60:63],v[204:207]
s_sub_u32 s22, s22, 1
E v19,v69
M v[200:203],a[76:79],v[56:59],v[200:203]
s_cselect_b32 s21, s23, s21
R a[112:115],v7,61440
AF v27,v18,v19
M v[200:203],a[72:75],v[48:51],v[200:203]
R a[116:119],v7,62464
C v44,v18,v19
M v[208:211],a[80:83],v[48:51],v[208:211]
E v20,v70
M v[208:211],a[84:87],v[56:59],v[208:211]
R a[120:123],v7,63488
M v[212:215],a[84:87],v[60:63],v[212:215]
R a[124:127],v7,64512
M v[212:215],a[80:83],v[52:55],v[212:215]
E v21,v71
M v[220:223],a[88:91],v[52:55],v[220:223]
E v22,v76
M v[220:223],a[92:95],v[60:63],v[220:223]
AF v27,v20,v27
C v45,v20,v21
M v[216:219],a[92:95],v[56:59],v[216:219]
s_waitcnt vmcnt(17) lgkmcnt(0)
AF v27,v21,v27
M v[216:219],a[88:91],v[48:51],v[216:219]
s_barrier
M v[224:227],a[96:99],v[48:51],v[224:227]
R a[64:67],v2,0
M v[224:227],a[100:103],v[56:59],v[224:227]
E v23,v77
M v[228:231],a[100:103],v[60:63],v[228:231]
R a[68:71],v2,1024
AF v27,v22,v27
M v[228:231],a[96:99],v[52:55],v[228:231]
E v24,v78
M v[236:239],a[104:107],v[52:55],v[236:239]
R a[72:75],v2,2048
C v46,v22,v23
M v[236:239],a[108:111],v[60:63],v[236:239]
AF v27,v23,v27
M v[232:235],a[108:111],v[56:59],v[232:235]
R a[76:79],v2,3072
M v[232:235],a[104:107],v[48:51],v[232:235]
E v25,v79
M v[240:243],a[112:115],v[48:51],v[240:243]
R a[80:83],v2,4096
AF v27,v24,v27
M v[240:243],a[116:119],v[56:59],v[240:243]
C v47,v24,v25
AF v27,v25,v27
M v[244:247],a[116:119],v[60:63],v[244:247]
R a[84:87],v2,5120
M v[244:247],a[112:115],v[52:55],v[244:247]
M v[252:255],a[120:123],v[52:55],v[252:255]
R a[88:91],v2,6144
M v[252:255],a[124:127],v[60:63],v[252:255]
M v[248:251],a[124:127],v[56:59],v[248:251]
s_waitcnt lgkmcnt(3)
R a[92:95],v2,7168
M v[248:251],a[120:123],v[48:51],v[248:251]
M v[96:99],a[64:67],a[0:3],v[32:35]
s_bitcmp1_b32 s39, s7
R a[96:99],v2,8192
M v[96:99],a[68:71],a[4:7],v[96:99]
s_cbranch_scc1 L_fll
L_fllr:
E v18,v80
M v[96:99],a[72:75],a[8:11],v[96:99]
SA m0,s28,32768
R a[100:103],v2,9216
M v[96:99],a[76:79],a[12:15],v[96:99]
s_waitcnt lgkmcnt(2)
buffer_load_dwordx4 v3, s[8:11], s26 offen offset:0 sc1 lds
M v[96:99],a[80:83],a[16:19],v[96:99]
R a[104:107],v2,10240
M v[96:99],a[84:87],a[20:23],v[96:99]
E v19,v81
M v[96:99],a[88:91],a[24:27],v[96:99]
R a[108:111],v2,11264
AF v26,v18,v26
M v[96:99],a[92:95],a[28:31],v[96:99]
E v20,v82
M v[100:103],a[92:95],a[60:63],v[36:39]
R a[112:115],v2,12288
C v56,v18,v19
M v[100:103],a[88:91],a[56:59],v[100:103]
buffer_load_dwordx4 v3, s[8:11], s26 offen offset:1024 sc1 lds
M v[100:103],a[84:87],a[52:55],v[100:103]
R a[116:119],v2,13312
AF v26,v19,v26
M v[100:103],a[80:83],a[48:51],v[100:103]
E v21,v83
M v[100:103],a[76:79],a[44:47],v[100:103]
R a[120:123],v2,14336
AF v26,v20,v26
M v[100:103],a[72:75],a[40:43],v[100:103]
buffer_load_dwordx4 v3, s[8:11], s26 offen offset:2048 sc1 lds
M v[100:103],a[68:71],a[36:39],v[100:103]
R a[124:127],v2,15360
C v57,v20,v21
M v[100:103],a[64:67],a[32:35],v[100:103]
s_waitcnt lgkmcnt(4)
E v22,v88
M v[108:111],a[96:99],a[32:35],v[36:39]
R a[64:67],v2,16384
AF v26,v21,v26
M v[108:111],a[100:103],a[36:39],v[108:111]
E v23,v89
M v[108:111],a[104:107],a[40:43],v[108:111]
R a[68:71],v2,17408
AF v26,v22,v26
M v[108:111],a[108:111],a[44:47],v[108:111]
s_waitcnt lgkmcnt(2)
buffer_load_dwordx4 v3, s[8:11], s26 offen offset:3072 sc1 lds
M v[108:111],a[112:115],a[48:51],v[108:111]
R a[72:75],v2,18432
C v58,v22,v23
M v[108:111],a[116:119],a[52:55],v[108:111]
E v24,v90
M v[108:111],a[120:123],a[56:59],v[108:111]
R a[76:79],v2,19456
AF v26,v23,v26
M v[108:111],a[124:127],a[60:63],v[108:111]
SA m0,s28,36864
M v[104:107],a[124:127],a[28:31],v[32:35]
R a[80:83],v2,20480
M v[104:107],a[120:123],a[24:27],v[104:107]
buffer_load_dwordx4 v4, s[8:11], s26 offen offset:0 sc1 lds
M v[104:107],a[116:119],a[20:23],v[104:107]
R a[84:87],v2,21504
M v[104:107],a[112:115],a[16:19],v[104:107]
E v25,v91
M v[104:107],a[108:111],a[12:15],v[104:107]
R a[88:91],v2,22528
AF v26,v24,v26
M v[104:107],a[104:107],a[8:11],v[104:107]
buffer_load_dwordx4 v4, s[8:11], s26 offen offset:1024 sc1 lds
M v[104:107],a[100:103],a[4:7],v[104:107]
R a[92:95],v2,23552
C v59,v24,v25
M v[104:107],a[96:99],a[0:3],v[104:107]
s_waitcnt lgkmcnt(4)
E v18,v84
M v[112:115],a[64:67],a[0:3],v[32:35]
R a[96:99],v2,24576
AF v26,v25,v26
M v[112:115],a[68:71],a[4:7],v[112:115]
R a[100:103],v2,25600
M v[112:115],a[72:75],a[8:11],v[112:115]
buffer_load_dwordx4 v4, s[8:11], s26 offen offset:2048 sc1 lds
M v[112:115],a[76:79],a[12:15],v[112:115]
s_waitcnt lgkmcnt(2)
R a[104:107],v2,26624
M v[112:115],a[80:83],a[16:19],v[112:115]
R a[108:111],v2,27648
M v[112:115],a[84:87],a[20:23],v[112:115]
E v19,v85
M v[112:115],a[88:91],a[24:27],v[112:115]
R a[112:115],v2,28672
AF v27,v18,v27
M v[112:115],a[92:95],a[28:31],v[112:115]
R a[116:119],v2,29696
C v60,v18,v19
M v[116:119],a[92:95],a[60:63],v[36:39]
buffer_load_dwordx4 v4, s[8:11], s26 offen offset:3072 sc1 lds
M v[116:119],a[88:91],a[56:59],v[116:119]
SA s26,s26,32768
R a[120:123],v2,30720
AF v27,v19,v27
M v[116:119],a[84:87],a[52:55],v[116:119]
R a[124:127],v2,31744
M v[116:119],a[80:83],a[48:51],v[116:119]
E v20,v86
M v[116:119],a[76:79],a[44:47],v[116:119]
E v21,v87
M v[116:119],a[72:75],a[40:43],v[116:119]
E v22,v92
M v[116:119],a[68:71],a[36:39],v[116:119]
s_waitcnt vmcnt(16) lgkmcnt(0)
E v23,v93
M v[116:119],a[64:67],a[32:35],v[116:119]
s_barrier
M v[124:127],a[96:99],a[32:35],v[36:39]
R a[64:67],v7,0
AF v27,v20,v27
M v[124:127],a[100:103],a[36:39],v[124:127]
E v24,v94
M v[124:127],a[104:107],a[40:43],v[124:127]
R a[68:71],v7,1024
C v61,v20,v21
M v[124:127],a[108:111],a[44:47],v[124:127]
AF v27,v21,v27
AF v27,v22,v27
M v[124:127],a[112:115],a[48:51],v[124:127]
R a[72:75],v7,2048
C v62,v22,v23
M v[124:127],a[116:119],a[52:55],v[124:127]
E v25,v95
M v[124:127],a[120:123],a[56:59],v[124:127]
R a[76:79],v7,3072
AF v27,v23,v27
M v[124:127],a[124:127],a[60:63],v[124:127]
AF v27,v24,v27
C v63,v24,v25
M v[120:123],a[124:127],a[28:31],v[32:35]
R a[80:83],v7,4096
AF v27,v25,v27
M v[120:123],a[120:123],a[24:27],v[120:123]
M v[120:123],a[116:119],a[20:23],v[120:123]
R a[84:87],v7,5120
v_max_f32 v10, v26, v27
M v[120:123],a[112:115],a[16:19],v[120:123]
v_cmp_lt_f32 vcc, s31, v10
M v[120:123],a[108:111],a[12:15],v[120:123]
R a[88:91],v7,6144
M v[120:123],a[104:107],a[8:11],v[120:123]
M v[120:123],a[100:103],a[4:7],v[120:123]
s_waitcnt lgkmcnt(3)
R a[92:95],v7,7168
M v[120:123],a[96:99],a[0:3],v[120:123]
s_cbranch_vccnz L_st0
L_rt0:
M v[128:131],a[64:67],v[40:43],v[128:131]
SA m0,s28,65536
R a[96:99],v7,8192
AF v30,v26,v30
M v[128:131],a[68:71],v[56:59],v[128:131]
buffer_load_dwordx4 v3, s[8:11], s21 offen offset:0 sc1 lds
M v[132:135],a[68:71],v[60:63],v[132:135]
R a[100:103],v7,9216
AF v31,v27,v31
M v[132:135],a[64:67],v[44:47],v[132:135]
s_waitcnt lgkmcnt(2)
E v18,v96
M v[140:143],a[72:75],v[44:47],v[140:143]
R a[104:107],v7,10240
M v[140:143],a[76:79],v[60:63],v[140:143]
buffer_load_dwordx4 v3, s[8:11], s21 offen offset:1024 sc1 lds
M v[136:139],a[76:79],v[56:59],v[136:139]
R a[108:111],v7,11264
M v[136:139],a[72:75],v[40:43],v[136:139]
E v19,v97
M v[144:147],a[80:83],v[40:43],v[144:147]
R a[112:115],v7,12288
AF v28,v18,v19
M v[144:147],a[84:87],v[56:59],v[144:147]
E v20,v98
M v[148:151],a[84:87],v[60:63],v[148:151]
R a[116:119],v7,13312
C v48,v18,v19
M v[148:151],a[80:83],v[44:47],v[148:151]
buffer_load_dwordx4 v3, s[8:11], s21 offen offset:2048 sc1 lds
M v[156:159],a[88:91],v[44:47],v[156:159]
R a[120:123],v7,14336
M v[156:159],a[92:95],v[60:63],v[156:159]
E v21,v99
M v[152:155],a[92:95],v[56:59],v[152:155]
R a[124:127],v7,15360
AF v28,v20,v28
M v[152:155],a[88:91],v[40:43],v[152:155]
s_waitcnt lgkmcnt(4)
buffer_load_dwordx4 v3, s[8:11], s21 offen offset:3072 sc1 lds
M v[160:163],a[96:99],v[40:43],v[160:163]
R a[64:67],v7,16384
C v49,v20,v21
M v[160:163],a[100:103],v[56:59],v[160:163]
E v22,v104
M v[164:167],a[100:103],v[60:63],v[164:167]
SA m0,s28,69632
R a[68:71],v7,17408
AF v28,v21,v28
M v[164:167],a[96:99],v[44:47],v[164:167]
s_waitcnt lgkmcnt(2)
buffer_load_dwordx4 v4, s[8:11], s21 offen offset:0 sc1 lds
M v[172:175],a[104:107],v[44:47],v[172:175]
R a[72:75],v7,18432
M v[172:175],a[108:111],v[60:63],v[172:175]
E v23,v105
M v[168:171],a[108:111],v[56:59],v[168:171]
R a[76:79],v7,19456
AF v28,v22,v28
M v[168:171],a[104:107],v[40:43],v[168:171]
E v24,v106
M v[176:179],a[112:115],v[40:43],v[176:179]
R a[80:83],v7,20480
C v50,v22,v23
M v[176:179],a[116:119],v[56:59],v[176:179]
buffer_load_dwordx4 v4, s[8:11], s21 offen offset:1024 sc1 lds
M v[180:183],a[116:119],v[60:63],v[180:183]
R a[84:87],v7,21504
AF v28,v23,v28
M v[180:183],a[112:115],v[44:47],v[180:183]
E v25,v107
M v[188:191],a[120:123],v[44:47],v[188:191]
R a[88:91],v7,22528
AF v28,v24,v28
M v[188:191],a[124:127],v[60:63],v[188:191]
buffer_load_dwordx4 v4, s[8:11], s21 offen offset:2048 sc1 lds
M v[184:187],a[124:127],v[56:59],v[184:187]
R a[92:95],v7,23552
C v51,v24,v25
M v[184:187],a[120:123],v[40:43],v[184:187]
s_waitcnt lgkmcnt(4)
E v18,v100
M v[192:195],a[64:67],v[40:43],v[192:195]
R a[96:99],v7,24576
AF v28,v25,v28
M v[192:195],a[68:71],v[56:59],v[192:195]
R a[100:103],v7,25600
M v[196:199],a[68:71],v[60:63],v[196:199]
buffer_load_dwordx4 v4, s[8:11], s21 offen offset:3072 sc1 lds
M v[196:199],a[64:67],v[44:47],v[196:199]
s_waitcnt lgkmcnt(2)
R a[104:107],v7,26624
M v[204:207],a[72:75],v[44:47],v[204:207]
SA s21,s21,32768
R a[108:111],v7,27648
M v[204:207],a[76:79],v[60:63],v[204:207]
s_sub_u32 s22, s22, 1
E v19,v101
M v[200:203],a[76:79],v[56:59],v[200:203]
s_cselect_b32 s21, s23, s21
R a[112:115],v7,28672
AF v29,v18,v19
M v[200:203],a[72:75],v[40:43],v[200:203]
R a[116:119],v7,29696
C v52,v18,v19
M v[208:211],a[80:83],v[40:43],v[208:211]
E v20,v102
M v[208:211],a[84:87],v[56:59],v[208:211]
R a[120:123],v7,30720
M v[212:215],a[84:87],v[60:63],v[212:215]
R a[124:127],v7,31744
M v[212:215],a[80:83],v[44:47],v[212:215]
E v21,v103
M v[220:223],a[88:91],v[44:47],v[220:223]
E v22,v108
M v[220:223],a[92:95],v[60:63],v[220:223]
AF v29,v20,v29
C v53,v20,v21
M v[216:219],a[92:95],v[56:59],v[216:219]
s_waitcnt vmcnt(16) lgkmcnt(0)
AF v29,v21,v29
M v[216:219],a[88:91],v[40:43],v[216:219]
s_barrier
M v[224:227],a[96:99],v[40:43],v[224:227]
R a[64:67],v2,32768
M v[224:227],a[100:103],v[56:59],v[224:227]
E v23,v109
M v[228:231],a[100:103],v[60:63],v[228:231]
R a[68:71],v2,33792
v_cmp_gt_u32 vcc, s6, v5
M v[228:231],a[96:99],v[44:47],v[228:231]
E v24,v110
M v[236:239],a[104:107],v[44:47],v[236:239]
R a[72:75],v2,34816
AF v29,v22,v29
M v[236:239],a[108:111],v[60:63],v[236:239]
s_cbranch_vccnz L_fls0
L_flr0:
C v54,v22,v23
AF v29,v23,v29
M v[232:235],a[108:111],v[56:59],v[232:235]
s_mov_b32 s6, 0
R a[76:79],v2,35840
M v[232:235],a[104:107],v[40:43],v[232:235]
SA s7,s7,1
E v25,v111
M v[240:243],a[112:115],v[40:43],v[240:243]
R a[80:83],v2,36864
AF v29,v24,v29
M v[240:243],a[116:119],v[56:59],v[240:243]
C v55,v24,v25
AF v29,v25,v29
M v[244:247],a[116:119],v[60:63],v[244:247]
R a[84:87],v2,37888
M v[244:247],a[112:115],v[44:47],v[244:247]
M v[252:255],a[120:123],v[44:47],v[252:255]
s_sub_u32 s27, s27, 1
R a[88:91],v2,38912
M v[252:255],a[124:127],v[60:63],v[252:255]
s_cmp_lg_u32 s27, 0
M v[248:251],a[124:127],v[56:59],v[248:251]
s_waitcnt lgkmcnt(3)
R a[92:95],v2,39936
M v[248:251],a[120:123],v[40:43],v[248:251]
s_cbranch_scc1 L_loop_top
s_cmp_eq_u32 s40, 0
s_cbranch_scc1 L_final_h
L_d1s:
M v[68:71],a[64:67],a[32:35],v[36:39]
s_cmp_lt_u32 s20, 0
R a[96:99],v2,40960
R a[100:103],v2,41984
M v[68:71],a[68:71],a[36:39],v[68:71]
s_cselect_b64 s[82:83], -1, 0
E v18,v112
M v[68:71],a[72:75],a[40:43],v[68:71]
s_cmp_eq_u32 s20, 0
M v[68:71],a[76:79],a[44:47],v[68:71]
s_cselect_b64 s[66:67], s[16:17], s[82:83]
R a[104:107],v2,43008
R a[108:111],v2,44032
s_waitcnt lgkmcnt(7)
M v[68:71],a[80:83],a[48:51],v[68:71]
s_cselect_b64 s[68:69], s[18:19], s[82:83]
E v19,v113
s_waitcnt lgkmcnt(6)
M v[68:71],a[84:87],a[52:55],v[68:71]
s_cselect_b64 s[70:71], s[48:49], s[82:83]
AF v28,v18,v28
C v56,v18,v19
s_waitcnt lgkmcnt(5)
M v[68:71],a[88:91],a[56:59],v[68:71]
s_cselect_b64 s[72:73], s[50:51], s[82:83]
R a[112:115],v2,45056
R a[116:119],v2,46080
v_cndmask_b32 v64, v32, v8, s[66:67]
v_cndmask_b32 v65, v32, v8, s[68:69]
v_cndmask_b32 v66, v32, v8, s[70:71]
v_cndmask_b32 v67, v32, v8, s[72:73]
s_waitcnt lgkmcnt(6)
M v[68:71],a[92:95],a[60:63],v[68:71]
s_mov_b32 s26, s43
v_min_u32 v17, 896, v9
AF v28,v19,v28
M v[64:67],a[92:95],a[28:31],v[64:67]
s_cmp_lt_u32 s20, 1
buffer_load_dword v5, v17, s[8:11], s46 offen sc1
M v[64:67],a[88:91],a[24:27],v[64:67]
s_cselect_b64 s[82:83], -1, 0
R a[120:123],v2,47104
R a[124:127],v2,48128
M v[64:67],a[84:87],a[20:23],v[64:67]
SA m0,s28,0
E v20,v114
M v[64:67],a[80:83],a[16:19],v[64:67]
s_cmp_eq_u32 s20, 1
buffer_load_dwordx4 v3, s[8:11], s26 offen offset:0 sc1 lds
M v[64:67],a[76:79],a[12:15],v[64:67]
s_cselect_b64 s[74:75], s[16:17], s[82:83]
E v21,v115
M v[64:67],a[72:75],a[8:11],v[64:67]
s_cselect_b64 s[76:77], s[18:19], s[82:83]
AF v28,v20,v28
C v57,v20,v21
M v[64:67],a[68:71],a[4:7],v[64:67]
s_cselect_b64 s[78:79], s[48:49], s[82:83]
E v22,v120
M v[64:67],a[64:67],a[0:3],v[64:67]
s_waitcnt lgkmcnt(0)
buffer_load_dwordx4 v3, s[8:11], s26 offen offset:1024 sc1 lds
M v[76:79],a[96:99],a[32:35],v[36:39]
s_cselect_b64 s[80:81], s[50:51], s[82:83]
R a[64:67],v2,49152
R a[68:71],v2,50176
M v[76:79],a[100:103],a[36:39],v[76:79]
v_cndmask_b32 v72, v32, v8, s[74:75]
v_cndmask_b32 v73, v32, v8, s[76:77]
M v[76:79],a[104:107],a[40:43],v[76:79]
v_cndmask_b32 v74, v32, v8, s[78:79]
AF v28,v21,v28
M v[76:79],a[108:111],a[44:47],v[76:79]
R a[72:75],v2,51200
R a[76:79],v2,52224
M v[76:79],a[112:115],a[48:51],v[76:79]
buffer_load_dwordx4 v3, s[8:11], s26 offen offset:2048 sc1 lds
M v[76:79],a[116:119],a[52:55],v[76:79]
v_cndmask_b32 v75, v32, v8, s[80:81]
M v[76:79],a[120:123],a[56:59],v[76:79]
s_cmp_lt_u32 s20, 2
R a[80:83],v2,53248
R a[84:87],v2,54272
M v[76:79],a[124:127],a[60:63],v[76:79]
s_cselect_b64 s[82:83], -1, 0
E v23,v121
M v[72:75],a[124:127],a[28:31],v[72:75]
s_cmp_eq_u32 s20, 2
buffer_load_dwordx4 v3, s[8:11], s26 offen offset:3072 sc1 lds
M v[72:75],a[120:123],a[24:27],v[72:75]
s_cselect_b64 s[66:67], s[16:17], s[82:83]
R a[88:91],v2,55296
R a[92:95],v2,56320
M v[72:75],a[116:119],a[20:23],v[72:75]
s_cselect_b64 s[68:69], s[18:19], s[82:83]
E v24,v122
M v[72:75],a[112:115],a[16:19],v[72:75]
s_cselect_b64 s[70:71], s[48:49], s[82:83]
E v25,v123
M v[72:75],a[108:111],a[12:15],v[72:75]
s_cselect_b64 s[72:73], s[50:51], s[82:83]
v_cndmask_b32 v80, v32, v8, s[66:67]
v_cndmask_b32 v81, v32, v8, s[68:69]
M v[72:75],a[104:107],a[8:11],v[72:75]
SA m0,s28,4096
E v18,v116
M v[72:75],a[100:103],a[4:7],v[72:75]
s_lshl_b32 s86, s20, 14
buffer_load_dwordx4 v4, s[8:11], s26 offen offset:0 sc1 lds
M v[72:75],a[96:99],a[0:3],v[72:75]
s_waitcnt lgkmcnt(0)
v_cndmask_b32 v82, v32, v8, s[70:71]
AF v28,v22,v28
M v[84:87],a[64:67],a[32:35],v[36:39]
SA s86,s86,s34
R a[96:99],v2,57344
R a[100:103],v2,58368
M v[84:87],a[68:71],a[36:39],v[84:87]
SA s87,s86,4096
buffer_load_dwordx4 v4, s[8:11], s26 offen offset:1024 sc1 lds
M v[84:87],a[72:75],a[40:43],v[84:87]
SA s88,s86,8192
v_cndmask_b32 v83, v32, v8, s[72:73]
C v58,v22,v23
M v[84:87],a[76:79],a[44:47],v[84:87]
s_cmp_lt_u32 s20, 3
R a[104:107],v2,59392
R a[108:111],v2,60416
M v[84:87],a[80:83],a[48:51],v[84:87]
s_cselect_b64 s[82:83], -1, 0
E v19,v117
M v[84:87],a[84:87],a[52:55],v[84:87]
SA s89,s86,12288
buffer_load_dwordx4 v4, s[8:11], s26 offen offset:2048 sc1 lds
M v[84:87],a[88:91],a[56:59],v[84:87]
s_lshl_b32 s90, s20, 10
R a[112:115],v2,61440
R a[116:119],v2,62464
M v[84:87],a[92:95],a[60:63],v[84:87]
SA s90,s90,s34
E v20,v118
M v[80:83],a[92:95],a[28:31],v[80:83]
SA s90,s90,65536
E v21,v119
M v[80:83],a[88:91],a[24:27],v[80:83]
s_cmp_eq_u32 s20, 3
R a[120:123],v2,63488
R a[124:127],v2,64512
M v[80:83],a[84:87],a[20:23],v[80:83]
s_cselect_b64 s[74:75], s[16:17], s[82:83]
buffer_load_dwordx4 v4, s[8:11], s26 offen offset:3072 sc1 lds
M v[80:83],a[80:83],a[16:19],v[80:83]
s_cselect_b64 s[76:77], s[18:19], s[82:83]
AF v28,v23,v28
AF v28,v24,v28
M v[80:83],a[76:79],a[12:15],v[80:83]
s_cselect_b64 s[78:79], s[48:49], s[82:83]
E v22,v124
M v[80:83],a[72:75],a[8:11],v[80:83]
s_cselect_b64 s[80:81], s[50:51], s[82:83]
v_cndmask_b32 v88, v32, v8, s[74:75]
v_cndmask_b32 v89, v32, v8, s[76:77]
M v[80:83],a[68:71],a[4:7],v[80:83]
s_waitcnt vmcnt(17) lgkmcnt(0)
v_cndmask_b32 v90, v32, v8, s[78:79]
v_cndmask_b32 v91, v32, v8, s[80:81]
M v[80:83],a[64:67],a[0:3],v[80:83]
s_barrier
M v[92:95],a[96:99],a[32:35],v[36:39]
SA s26,s26,32768
R a[64:67],v7,32768
R a[68:71],v7,33792
M v[92:95],a[100:103],a[36:39],v[92:95]
SA m0,s28,131072
E v23,v125
M v[92:95],a[104:107],a[40:43],v[92:95]
buffer_load_dwordx4 v3, s[8:11], s26 offen offset:0 sc1 lds
M v[92:95],a[108:111],a[44:47],v[92:95]
R a[72:75],v7,34816
R a[76:79],v7,35840
M v[92:95],a[112:115],a[48:51],v[92:95]
C v59,v24,v25
AF v28,v25,v28
M v[92:95],a[116:119],a[52:55],v[92:95]
buffer_load_dwordx4 v3, s[8:11], s26 offen offset:1024 sc1 lds
M v[92:95],a[120:123],a[56:59],v[92:95]
R a[80:83],v7,36864
R a[84:87],v7,37888
M v[92:95],a[124:127],a[60:63],v[92:95]
E v24,v126
M v[88:91],a[124:127],a[28:31],v[88:91]
buffer_load_dwordx4 v3, s[8:11], s26 offen offset:2048 sc1 lds
M v[88:91],a[120:123],a[24:27],v[88:91]
R a[88:91],v7,38912
R a[92:95],v7,39936
M v[88:91],a[116:119],a[20:23],v[88:91]
E v25,v127
M v[88:91],a[112:115],a[16:19],v[88:91]
buffer_load_dwordx4 v3, s[8:11], s26 offen offset:3072 sc1 lds
M v[88:91],a[108:111],a[12:15],v[88:91]
AF v29,v18,v29
C v60,v18,v19
M v[88:91],a[104:107],a[8:11],v[88:91]
AF v29,v19,v29
AF v29,v20,v29
M v[88:91],a[100:103],a[4:7],v[88:91]
s_waitcnt lgkmcnt(0)
C v61,v20,v21
AF v29,v21,v29
M v[88:91],a[96:99],a[0:3],v[88:91]
AF v29,v22,v29
C v62,v22,v23
AF v29,v23,v29
AF v29,v24,v29
C v63,v24,v25
AF v29,v25,v29
v_max_f32 v10, v28, v29
v_cmp_lt_f32 vcc, s31, v10
s_nop 0
s_cbranch_vccnz L_std1
L_rtd1:
s_cmp_lt_u32 s42, 6
s_cbranch_scc1 L_d2h
M v[128:131],a[64:67],v[48:51],v[128:131]
R a[96:99],v7,40960
R a[100:103],v7,41984
M v[128:131],a[68:71],v[56:59],v[128:131]
SA m0,s28,135168
E v18,v64
M v[132:135],a[68:71],v[60:63],v[132:135]
buffer_load_dwordx4 v4, s[8:11], s26 offen offset:0 sc1 lds
M v[132:135],a[64:67],v[52:55],v[132:135]
R a[104:107],v7,43008
R a[108:111],v7,44032
M v[140:143],a[72:75],v[52:55],v[140:143]
s_cmp_gt_u32 s20, 3
E v19,v65
M v[140:143],a[76:79],v[60:63],v[140:143]
s_cselect_b64 s[82:83], -1, 0
AF v30,v28,v30
AF v31,v29,v31
M v[136:139],a[76:79],v[56:59],v[136:139]
s_cmp_eq_u32 s20, 3
R a[112:115],v7,45056
R a[116:119],v7,46080
M v[136:139],a[72:75],v[48:51],v[136:139]
s_cselect_b64 s[66:67], s[16:17], s[82:83]
buffer_load_dwordx4 v4, s[8:11], s26 offen offset:1024 sc1 lds
M v[144:147],a[80:83],v[48:51],v[144:147]
s_cselect_b64 s[68:69], s[18:19], s[82:83]
E v20,v66
M v[144:147],a[84:87],v[56:59],v[144:147]
s_cselect_b64 s[70:71], s[48:49], s[82:83]
R a[120:123],v7,47104
R a[124:127],v7,48128
M v[148:151],a[84:87],v[60:63],v[148:151]
s_cselect_b64 s[72:73], s[50:51], s[82:83]
v_cndmask_b32 v100, v36, v8, s[66:67]
v_cndmask_b32 v101, v36, v8, s[68:69]
M v[148:151],a[80:83],v[52:55],v[148:151]
buffer_load_dwordx4 v4, s[8:11], s26 offen offset:2048 sc1 lds
M v[156:159],a[88:91],v[52:55],v[156:159]
v_cndmask_b32 v102, v36, v8, s[70:71]
AF v26,v18,v19
M v[156:159],a[92:95],v[60:63],v[156:159]
E v21,v67
M v[152:155],a[92:95],v[56:59],v[152:155]
v_cndmask_b32 v103, v36, v8, s[72:73]
C v40,v18,v19
M v[152:155],a[88:91],v[48:51],v[152:155]
s_waitcnt lgkmcnt(0)
buffer_load_dwordx4 v4, s[8:11], s26 offen offset:3072 sc1 lds
M v[160:163],a[96:99],v[48:51],v[160:163]
s_cmp_gt_u32 s20, 2
R a[64:67],v7,49152
R a[68:71],v7,50176
M v[160:163],a[100:103],v[56:59],v[160:163]
s_cselect_b64 s[82:83], -1, 0
v_lshrrev_b32 v14, 7, v7
AF v26,v20,v26
M v[164:167],a[100:103],v[60:63],v[164:167]
s_cmp_eq_u32 s20, 2
v_mul_u32_u24 v14, 896, v14
C v41,v20,v21
M v[164:167],a[96:99],v[52:55],v[164:167]
s_cselect_b64 s[74:75], s[16:17], s[82:83]
R a[72:75],v7,51200
R a[76:79],v7,52224
M v[172:175],a[104:107],v[52:55],v[172:175]
s_cselect_b64 s[76:77], s[18:19], s[82:83]
v_lshrrev_b32 v15, 8, v7
AF v26,v21,v26
M v[172:175],a[108:111],v[60:63],v[172:175]
s_cselect_b64 s[78:79], s[48:49], s[82:83]
v_lshlrev_b32 v15, 5, v15
M v[168:171],a[108:111],v[56:59],v[168:171]
s_cselect_b64 s[80:81], s[50:51], s[82:83]
R a[80:83],v7,53248
R a[84:87],v7,54272
M v[168:171],a[104:107],v[48:51],v[168:171]
v_cndmask_b32 v108, v36, v8, s[74:75]
v_cndmask_b32 v109, v36, v8, s[76:77]
M v[176:179],a[112:115],v[48:51],v[176:179]
v_xor_b32 v15, v15, v7
M v[176:179],a[116:119],v[56:59],v[176:179]
R a[88:91],v7,55296
R a[92:95],v7,56320
M v[180:183],a[116:119],v[60:63],v[180:183]
v_and_b32 v15, 0x70, v15
v_cndmask_b32 v110, v36, v8, s[78:79]
M v[180:183],a[112:115],v[52:55],v[180:183]
v_add_u32 v0, v14, v15
M v[188:191],a[120:123],v[52:55],v[188:191]
s_mul_i32 s38, s20, 57344
v_cndmask_b32 v111, v36, v8, s[80:81]
M v[188:191],a[124:127],v[60:63],v[188:191]
s_cmp_gt_u32 s20, 1
E v22,v72
M v[184:187],a[124:127],v[56:59],v[184:187]
s_cselect_b64 s[82:83], -1, 0
E v23,v73
M v[184:187],a[120:123],v[48:51],v[184:187]
s_waitcnt lgkmcnt(0)
E v24,v74
M v[192:195],a[64:67],v[48:51],v[192:195]
SA m0,s28,98304
R a[96:99],v7,57344
R a[100:103],v7,58368
M v[192:195],a[68:71],v[56:59],v[192:195]
s_cmp_eq_u32 s20, 1
E v25,v75
M v[196:199],a[68:71],v[60:63],v[196:199]
s_cselect_b64 s[66:67], s[16:17], s[82:83]
E v18,v68
M v[196:199],a[64:67],v[52:55],v[196:199]
s_cselect_b64 s[68:69], s[18:19], s[82:83]
R a[104:107],v7,59392
R a[108:111],v7,60416
M v[204:207],a[72:75],v[52:55],v[204:207]
s_cselect_b64 s[70:71], s[48:49], s[82:83]
E v19,v69
M v[204:207],a[76:79],v[60:63],v[204:207]
s_cselect_b64 s[72:73], s[50:51], s[82:83]
v_cndmask_b32 v116, v36, v8, s[66:67]
v_cndmask_b32 v117, v36, v8, s[68:69]
M v[200:203],a[76:79],v[56:59],v[200:203]
SA s85,s38,0
R a[112:115],v7,61440
R a[116:119],v7,62464
M v[200:203],a[72:75],v[48:51],v[200:203]
buffer_load_dwordx4 v0, s[12:15], s85 offen offset:0 lds
M v[208:211],a[80:83],v[48:51],v[208:211]
SA s85,s38,6144
v_cndmask_b32 v118, v36, v8, s[70:71]
AF v26,v22,v26
M v[208:211],a[84:87],v[56:59],v[208:211]
R a[120:123],v7,63488
R a[124:127],v7,64512
M v[212:215],a[84:87],v[60:63],v[212:215]
buffer_load_dwordx4 v0, s[12:15], s85 offen offset:1024 lds
M v[212:215],a[80:83],v[52:55],v[212:215]
SA s85,s38,12288
v_cndmask_b32 v119, v36, v8, s[72:73]
C v42,v22,v23
M v[220:223],a[88:91],v[52:55],v[220:223]
s_cmp_gt_u32 s20, 0
E v20,v70
M v[220:223],a[92:95],v[60:63],v[220:223]
s_cselect_b64 s[82:83], -1, 0
buffer_load_dwordx4 v0, s[12:15], s85 offen offset:2048 lds
M v[216:219],a[92:95],v[56:59],v[216:219]
s_waitcnt vmcnt(20) lgkmcnt(0)
E v21,v71
M v[216:219],a[88:91],v[48:51],v[216:219]
s_barrier
M v[224:227],a[96:99],v[48:51],v[224:227]
SA s85,s38,18432
R a[64:67],v2,0
R a[68:71],v2,1024
M v[224:227],a[100:103],v[56:59],v[224:227]
s_cmp_eq_u32 s20, 0
buffer_load_dwordx4 v0, s[12:15], s85 offen offset:3072 lds
M v[228:231],a[100:103],v[60:63],v[228:231]
s_cselect_b64 s[74:75], s[16:17], s[82:83]
AF v26,v23,v26
AF v26,v24,v26
M v[228:231],a[96:99],v[52:55],v[228:231]
s_cselect_b64 s[76:77], s[18:19], s[82:83]
R a[72:75],v2,2048
R a[76:79],v2,3072
M v[236:239],a[104:107],v[52:55],v[236:239]
s_cselect_b64 s[78:79], s[48:49], s[82:83]
E v22,v76
M v[236:239],a[108:111],v[60:63],v[236:239]
s_cselect_b64 s[80:81], s[50:51], s[82:83]
v_cndmask_b32 v124, v36, v8, s[74:75]
v_cndmask_b32 v125, v36, v8, s[76:77]
M v[232:235],a[108:111],v[56:59],v[232:235]
SA m0,s28,102400
R a[80:83],v2,4096
R a[84:87],v2,5120
M v[232:235],a[104:107],v[48:51],v[232:235]
SA s85,s38,28672
buffer_load_dwordx4 v0, s[12:15], s85 offen offset:0 lds
M v[240:243],a[112:115],v[48:51],v[240:243]
SA s85,s38,34816
v_cndmask_b32 v126, v36, v8, s[78:79]
v_cndmask_b32 v127, v36, v8, s[80:81]
M v[240:243],a[116:119],v[56:59],v[240:243]
R a[88:91],v2,6144
R a[92:95],v2,7168
M v[244:247],a[116:119],v[60:63],v[244:247]
buffer_load_dwordx4 v0, s[12:15], s85 offen offset:1024 lds
M v[244:247],a[112:115],v[52:55],v[244:247]
SA s85,s38,40960
E v23,v77
M v[252:255],a[120:123],v[52:55],v[252:255]
buffer_load_dwordx4 v0, s[12:15], s85 offen offset:2048 lds
M v[252:255],a[124:127],v[60:63],v[252:255]
SA s85,s38,47104
C v43,v24,v25
AF v26,v25,v26
M v[248:251],a[124:127],v[56:59],v[248:251]
s_waitcnt lgkmcnt(0)
E v24,v78
M v[248:251],a[120:123],v[48:51],v[248:251]
buffer_load_dwordx4 v0, s[12:15], s85 offen offset:3072 lds
SA s38,s38,128
AF v27,v18,v19
C v44,v18,v19
AF v27,v20,v27
C v45,v20,v21
AF v27,v21,v27
E v25,v79
AF v27,v22,v27
C v46,v22,v23
AF v27,v23,v27
AF v27,v24,v27
C v47,v24,v25
AF v27,v25,v27
M v[100:103],a[64:67],a[32:35],v[100:103]
R a[96:99],v2,8192
R a[100:103],v2,9216
M v[100:103],a[68:71],a[36:39],v[100:103]
R a[104:107],v2,10240
R a[108:111],v2,11264
M v[100:103],a[72:75],a[40:43],v[100:103]
R a[112:115],v2,12288
R a[116:119],v2,13312
M v[100:103],a[76:79],a[44:47],v[100:103]
R a[120:123],v2,14336
R a[124:127],v2,15360
M v[100:103],a[80:83],a[48:51],v[100:103]
v_add_u32 v8, 0x20000, v7
M v[100:103],a[84:87],a[52:55],v[100:103]
SA m0,s28,32768
E v18,v80
M v[100:103],a[88:91],a[56:59],v[100:103]
SA s85,s38,0
buffer_load_dwordx4 v0, s[12:15], s85 offen offset:0 lds
M v[100:103],a[92:95],a[60:63],v[100:103]
s_waitcnt lgkmcnt(0)
E v19,v81
M v[108:111],a[96:99],a[32:35],v[108:111]
SA s85,s38,6144
R a[64:67],v2,16384
R a[68:71],v2,17408
M v[108:111],a[100:103],a[36:39],v[108:111]
R a[72:75],v2,18432
R a[76:79],v2,19456
M v[108:111],a[104:107],a[40:43],v[108:111]
R a[80:83],v2,20480
R a[84:87],v2,21504
M v[108:111],a[108:111],a[44:47],v[108:111]
R a[88:91],v2,22528
R a[92:95],v2,23552
M v[108:111],a[112:115],a[48:51],v[108:111]
buffer_load_dwordx4 v0, s[12:15], s85 offen offset:1024 lds
M v[108:111],a[116:119],a[52:55],v[108:111]
SA s85,s38,12288
E v20,v82
M v[108:111],a[120:123],a[56:59],v[108:111]
buffer_load_dwordx4 v0, s[12:15], s85 offen offset:2048 lds
M v[108:111],a[124:127],a[60:63],v[108:111]
s_waitcnt lgkmcnt(0)
E v21,v83
M v[116:119],a[64:67],a[32:35],v[116:119]
SA s85,s38,18432
R a[96:99],v2,24576
R a[100:103],v2,25600
M v[116:119],a[68:71],a[36:39],v[116:119]
R a[104:107],v2,26624
R a[108:111],v2,27648
M v[116:119],a[72:75],a[40:43],v[116:119]
R a[112:115],v2,28672
R a[116:119],v2,29696
M v[116:119],a[76:79],a[44:47],v[116:119]
R a[120:123],v2,30720
R a[124:127],v2,31744
M v[116:119],a[80:83],a[48:51],v[116:119]
buffer_load_dwordx4 v0, s[12:15], s85 offen offset:3072 lds
M v[116:119],a[84:87],a[52:55],v[116:119]
buffer_load_dword v6, off, s[8:11], s47 sc1
M v[116:119],a[88:91],a[56:59],v[116:119]
s_waitcnt vmcnt(21) lgkmcnt(0)
E v22,v88
M v[116:119],a[92:95],a[60:63],v[116:119]
s_barrier
M v[124:127],a[96:99],a[32:35],v[124:127]
R a[64:67],v7,0
R a[68:71],v7,1024
M v[124:127],a[100:103],a[36:39],v[124:127]
R a[72:75],v7,2048
R a[76:79],v7,3072
M v[124:127],a[104:107],a[40:43],v[124:127]
R a[80:83],v7,4096
R a[84:87],v7,5120
M v[124:127],a[108:111],a[44:47],v[124:127]
R a[88:91],v7,6144
R a[92:95],v7,7168
M v[124:127],a[112:115],a[48:51],v[124:127]
E v23,v89
M v[124:127],a[116:119],a[52:55],v[124:127]
E v24,v90
M v[124:127],a[120:123],a[56:59],v[124:127]
s_waitcnt lgkmcnt(0)
E v25,v91
M v[124:127],a[124:127],a[60:63],v[124:127]
AF v26,v18,v26
C v56,v18,v19
AF v26,v19,v26
AF v26,v20,v26
C v57,v20,v21
AF v26,v21,v26
AF v26,v22,v26
C v58,v22,v23
AF v26,v23,v26
E v18,v84
E v19,v85
AF v26,v24,v26
C v59,v24,v25
AF v26,v25,v26
E v20,v86
E v21,v87
AF v27,v18,v27
C v60,v18,v19
AF v27,v19,v27
E v22,v92
E v23,v93
AF v27,v20,v27
C v61,v20,v21
AF v27,v21,v27
E v24,v94
E v25,v95
AF v27,v22,v27
C v62,v22,v23
AF v27,v23,v27
AF v27,v24,v27
C v63,v24,v25
AF v27,v25,v27
v_max_f32 v10, v26, v27
v_cmp_lt_f32 vcc, s31, v10
s_nop 0
s_cbranch_vccnz L_std3n
L_rtd3n:
M v[128:131],a[64:67],v[40:43],v[128:131]
R a[96:99],v7,8192
R a[100:103],v7,9216
M v[128:131],a[68:71],v[56:59],v[128:131]
v_or_b32 v9, s35, v7
s_waitcnt vmcnt(0)
v_cmp_ne_u32 vcc, 1, v6
M v[132:135],a[68:71],v[60:63],v[132:135]
s_cbranch_vccnz L_fps
L_fpr:
E v18,v100
M v[132:135],a[64:67],v[44:47],v[132:135]
R a[104:107],v7,10240
R a[108:111],v7,11264
M v[140:143],a[72:75],v[44:47],v[140:143]
buffer_load_dwordx4 v[14:17], v9, s[8:11], s90 offen sc1
M v[140:143],a[76:79],v[60:63],v[140:143]
E v19,v101
M v[136:139],a[76:79],v[56:59],v[136:139]
R a[112:115],v7,12288
R a[116:119],v7,13312
M v[136:139],a[72:75],v[40:43],v[136:139]
buffer_load_dwordx4 a[160:163], v9, s[8:11], s88 offen offset:0 sc1
M v[144:147],a[80:83],v[40:43],v[144:147]
E v20,v102
M v[144:147],a[84:87],v[56:59],v[144:147]
R a[120:123],v7,14336
R a[124:127],v7,15360
M v[148:151],a[84:87],v[60:63],v[148:151]
buffer_load_dwordx4 a[128:131], v9, s[8:11], s86 offen offset:0 sc1
M v[148:151],a[80:83],v[44:47],v[148:151]
E v21,v103
M v[156:159],a[88:91],v[44:47],v[156:159]
AF v30,v26,v30
AF v31,v27,v31
M v[156:159],a[92:95],v[60:63],v[156:159]
buffer_load_dwordx4 a[164:167], v9, s[8:11], s88 offen offset:1024 sc1
M v[152:155],a[92:95],v[56:59],v[152:155]
AF v29,v18,v19
C v52,v18,v19
M v[152:155],a[88:91],v[40:43],v[152:155]
s_waitcnt lgkmcnt(0)
E v22,v108
M v[160:163],a[96:99],v[40:43],v[160:163]
R a[64:67],v7,16384
R a[68:71],v7,17408
M v[160:163],a[100:103],v[56:59],v[160:163]
buffer_load_dwordx4 a[132:135], v9, s[8:11], s86 offen offset:1024 sc1
M v[164:167],a[100:103],v[60:63],v[164:167]
E v23,v109
M v[164:167],a[96:99],v[44:47],v[164:167]
R a[72:75],v7,18432
R a[76:79],v7,19456
M v[172:175],a[104:107],v[44:47],v[172:175]
buffer_load_dwordx4 a[168:171], v9, s[8:11], s88 offen offset:2048 sc1
M v[172:175],a[108:111],v[60:63],v[172:175]
AF v29,v20,v29
C v53,v20,v21
M v[168:171],a[108:111],v[56:59],v[168:171]
R a[80:83],v7,20480
R a[84:87],v7,21504
M v[168:171],a[104:107],v[40:43],v[168:171]
buffer_load_dwordx4 a[136:139], v9, s[8:11], s86 offen offset:2048 sc1
M v[176:179],a[112:115],v[40:43],v[176:179]
E v24,v110
M v[176:179],a[116:119],v[56:59],v[176:179]
R a[88:91],v7,22528
R a[92:95],v7,23552
M v[180:183],a[116:119],v[60:63],v[180:183]
buffer_load_dwordx4 a[172:175], v9, s[8:11], s88 offen offset:3072 sc1
M v[180:183],a[112:115],v[44:47],v[180:183]
E v25,v111
M v[188:191],a[120:123],v[44:47],v[188:191]
AF v29,v21,v29
AF v29,v22,v29
M v[188:191],a[124:127],v[60:63],v[188:191]
buffer_load_dwordx4 a[140:143], v9, s[8:11], s86 offen offset:3072 sc1
M v[184:187],a[124:127],v[56:59],v[184:187]
E v18,v116
M v[184:187],a[120:123],v[40:43],v[184:187]
s_waitcnt lgkmcnt(0)
C v54,v22,v23
AF v29,v23,v29
M v[192:195],a[64:67],v[40:43],v[192:195]
R a[96:99],v7,24576
R a[100:103],v7,25600
M v[192:195],a[68:71],v[56:59],v[192:195]
buffer_load_dwordx4 a[176:179], v9, s[8:11], s89 offen offset:0 sc1
M v[196:199],a[68:71],v[60:63],v[196:199]
E v19,v117
M v[196:199],a[64:67],v[44:47],v[196:199]
R a[104:107],v7,26624
R a[108:111],v7,27648
M v[204:207],a[72:75],v[44:47],v[204:207]
buffer_load_dwordx4 a[144:147], v9, s[8:11], s87 offen offset:0 sc1
M v[204:207],a[76:79],v[60:63],v[204:207]
E v20,v118
M v[200:203],a[76:79],v[56:59],v[200:203]
R a[112:115],v7,28672
R a[116:119],v7,29696
M v[200:203],a[72:75],v[40:43],v[200:203]
buffer_load_dwordx4 a[180:183], v9, s[8:11], s89 offen offset:1024 sc1
M v[208:211],a[80:83],v[40:43],v[208:211]
AF v29,v24,v29
C v55,v24,v25
M v[208:211],a[84:87],v[56:59],v[208:211]
R a[120:123],v7,30720
R a[124:127],v7,31744
M v[212:215],a[84:87],v[60:63],v[212:215]
buffer_load_dwordx4 a[148:151], v9, s[8:11], s87 offen offset:1024 sc1
M v[212:215],a[80:83],v[44:47],v[212:215]
E v21,v119
M v[220:223],a[88:91],v[44:47],v[220:223]
AF v29,v25,v29
AF v29,v18,v29
M v[220:223],a[92:95],v[60:63],v[220:223]
buffer_load_dwordx4 a[184:187], v9, s[8:11], s89 offen offset:2048 sc1
M v[216:219],a[92:95],v[56:59],v[216:219]
s_waitcnt lgkmcnt(0)
E v22,v124
M v[216:219],a[88:91],v[40:43],v[216:219]
s_barrier
M v[224:227],a[96:99],v[40:43],v[224:227]
R a[64:67],v8,0
R a[68:71],v8,1024
M v[224:227],a[100:103],v[56:59],v[224:227]
buffer_load_dwordx4 a[152:155], v9, s[8:11], s87 offen offset:2048 sc1
M v[228:231],a[100:103],v[60:63],v[228:231]
E v23,v125
M v[228:231],a[96:99],v[44:47],v[228:231]
R a[72:75],v8,2048
R a[76:79],v8,3072
M v[236:239],a[104:107],v[44:47],v[236:239]
buffer_load_dwordx4 a[188:191], v9, s[8:11], s89 offen offset:3072 sc1
M v[236:239],a[108:111],v[60:63],v[236:239]
E v24,v126
M v[232:235],a[108:111],v[56:59],v[232:235]
R a[80:83],v8,4096
R a[84:87],v8,5120
M v[232:235],a[104:107],v[40:43],v[232:235]
buffer_load_dwordx4 a[156:159], v9, s[8:11], s87 offen offset:3072 sc1
M v[240:243],a[112:115],v[40:43],v[240:243]
E v25,v127
M v[240:243],a[116:119],v[56:59],v[240:243]
R a[88:91],v8,6144
R a[92:95],v8,7168
M v[244:247],a[116:119],v[60:63],v[244:247]
C v48,v18,v19
AF v29,v19,v29
M v[244:247],a[112:115],v[44:47],v[244:247]
AF v29,v20,v29
C v49,v20,v21
M v[252:255],a[120:123],v[44:47],v[252:255]
AF v29,v21,v29
AF v29,v22,v29
M v[252:255],a[124:127],v[60:63],v[252:255]
C v50,v22,v23
AF v29,v23,v29
M v[248:251],a[124:127],v[56:59],v[248:251]
s_waitcnt lgkmcnt(0)
AF v29,v24,v29
C v51,v24,v25
M v[248:251],a[120:123],v[40:43],v[248:251]
AF v29,v25,v29
v_cmp_lt_f32 vcc, s31, v29
s_nop 0
s_cbranch_vccnz L_std4n
L_rtd4n:
s_waitcnt vmcnt(16)
v_cmp_neq_f32 vcc, v32, v14
v_cmp_neq_f32 s[64:65], v36, v15
s_cmp_eq_u32 s35, 0
s_cselect_b64 s[66:67], -1, 0
s_or_b64 vcc, vcc, s[64:65]
s_and_b64 vcc, vcc, s[66:67]
s_cbranch_vccnz L_stc
L_rtc:
M v[132:135],a[64:67],v[52:55],v[132:135]
R a[96:99],v8,8192
R a[100:103],v8,9216
M v[132:135],a[68:71],v[48:51],v[132:135]
s_waitcnt vmcnt(12)
AF v30,v16,v30
AF v31,v17,v31
M v[132:135],a[246:249],a[160:163],v[132:135]
SA m0,s28,36864
AF v31,v29,v31
v_mov_b32 v10, v30
M v[128:131],a[246:249],a[128:131],v[128:131]
SA s85,s38,28672
R a[104:107],v8,10240
R a[108:111],v8,11264
M v[140:143],a[72:75],v[52:55],v[140:143]
buffer_load_dwordx4 v0, s[12:15], s85 offen offset:0 lds
M v[140:143],a[76:79],v[48:51],v[140:143]
SA s85,s38,34816
v_mov_b32 v11, v31
M v[140:143],a[244:247],a[160:163],v[140:143]
R a[112:115],v8,12288
R a[116:119],v8,13312
M v[136:139],a[244:247],a[128:131],v[136:139]
v_permlane16_swap_b32 v10, v30
M v[148:151],a[80:83],v[52:55],v[148:151]
v_permlane16_swap_b32 v11, v31
M v[148:151],a[84:87],v[48:51],v[148:151]
R a[120:123],v8,14336
R a[124:127],v8,15360
M v[148:151],a[246:249],a[164:167],v[148:151]
buffer_load_dwordx4 v0, s[12:15], s85 offen offset:1024 lds
M v[144:147],a[246:249],a[132:135],v[144:147]
SA s85,s38,40960
AF v30,v10,v30
AF v31,v11,v31
M v[156:159],a[88:91],v[52:55],v[156:159]
v_mov_b32 v10, v30
v_mov_b32 v11, v31
M v[156:159],a[92:95],v[48:51],v[156:159]
buffer_load_dwordx4 v0, s[12:15], s85 offen offset:2048 lds
M v[156:159],a[244:247],a[164:167],v[156:159]
s_waitcnt vmcnt(11)
v_permlane32_swap_b32 v10, v30
M v[152:155],a[244:247],a[132:135],v[152:155]
s_waitcnt lgkmcnt(0)
v_permlane32_swap_b32 v11, v31
M v[164:167],a[96:99],v[52:55],v[164:167]
SA s85,s38,47104
R a[64:67],v8,16384
R a[68:71],v8,17408
M v[164:167],a[100:103],v[48:51],v[164:167]
buffer_load_dwordx4 v0, s[12:15], s85 offen offset:3072 lds
M v[164:167],a[246:249],a[168:171],v[164:167]
SA s38,s38,128
C v132,v132,v133
C v133,v134,v135
M v[160:163],a[246:249],a[136:139],v[160:163]
SA m0,s28,65536
R a[72:75],v8,18432
R a[76:79],v8,19456
AF v30,v10,v30
AF v31,v11,v31
v_rcp_f32 v5, v30
v_rcp_f32 v6, v31
M v[172:175],a[104:107],v[52:55],v[172:175]
SA s85,s38,0
buffer_load_dwordx4 v0, s[12:15], s85 offen offset:0 lds
M v[172:175],a[108:111],v[48:51],v[172:175]
SA s85,s38,6144
C v134,v140,v141
C v135,v142,v143
M v[172:175],a[244:247],a[168:171],v[172:175]
R a[80:83],v8,20480
R a[84:87],v8,21504
M v[168:171],a[244:247],a[136:139],v[168:171]
buffer_load_dwordx4 v0, s[12:15], s85 offen offset:1024 lds
M v[180:183],a[112:115],v[52:55],v[180:183]
SA s85,s38,12288
C v128,v128,v129
C v129,v130,v131
M v[180:183],a[116:119],v[48:51],v[180:183]
R a[88:91],v8,22528
R a[92:95],v8,23552
M v[180:183],a[246:249],a[172:175],v[180:183]
buffer_load_dwordx4 v0, s[12:15], s85 offen offset:2048 lds
M v[176:179],a[246:249],a[140:143],v[176:179]
SA s85,s38,18432
C v130,v136,v137
C v131,v138,v139
M v[188:191],a[120:123],v[52:55],v[188:191]
C v148,v148,v149
C v149,v150,v151
M v[188:191],a[124:127],v[48:51],v[188:191]
buffer_load_dwordx4 v0, s[12:15], s85 offen offset:3072 lds
M v[188:191],a[244:247],a[172:175],v[188:191]
s_waitcnt vmcnt(12)
C v150,v156,v157
C v151,v158,v159
M v[184:187],a[244:247],a[140:143],v[184:187]
s_waitcnt lgkmcnt(0)
C v144,v144,v145
C v145,v146,v147
M v[196:199],a[64:67],v[52:55],v[196:199]
SA m0,s28,69632
R a[96:99],v8,24576
R a[100:103],v8,25600
M v[196:199],a[68:71],v[48:51],v[196:199]
SA s85,s38,28672
buffer_load_dwordx4 v0, s[12:15], s85 offen offset:0 lds
M v[196:199],a[246:249],a[176:179],v[196:199]
SA s85,s38,34816
C v146,v152,v153
C v147,v154,v155
M v[192:195],a[246:249],a[144:147],v[192:195]
R a[104:107],v8,26624
R a[108:111],v8,27648
M v[204:207],a[72:75],v[52:55],v[204:207]
buffer_load_dwordx4 v0, s[12:15], s85 offen offset:1024 lds
M v[204:207],a[76:79],v[48:51],v[204:207]
SA s85,s38,40960
v_lshrrev_b32 v16, 4, v7
v_lshrrev_b32 v14, 2, v16
M v[204:207],a[244:247],a[176:179],v[204:207]
R a[112:115],v8,28672
R a[116:119],v8,29696
M v[200:203],a[244:247],a[144:147],v[200:203]
buffer_load_dwordx4 v0, s[12:15], s85 offen offset:2048 lds
M v[212:215],a[80:83],v[52:55],v[212:215]
SA s85,s38,47104
v_lshlrev_b32 v14, 7, v14
v_and_b32 v15, 3, v16
M v[212:215],a[84:87],v[48:51],v[212:215]
R a[120:123],v8,30720
R a[124:127],v8,31744
M v[212:215],a[246:249],a[180:183],v[212:215]
buffer_load_dwordx4 v0, s[12:15], s85 offen offset:3072 lds
M v[208:211],a[246:249],a[148:151],v[208:211]
SA s38,s38,128
v_lshl_add_u32 v14, v15, 3, v14
C v164,v164,v165
M v[220:223],a[88:91],v[52:55],v[220:223]
C v165,v166,v167
C v166,v172,v173
M v[220:223],a[92:95],v[48:51],v[220:223]
s_waitcnt vmcnt(12)
C v167,v174,v175
C v160,v160,v161
M v[220:223],a[244:247],a[180:183],v[220:223]
s_waitcnt lgkmcnt(0)
v_bfe_u32 v15, v16, 3, 2
v_lshl_add_u32 v18, v15, 5, v14
v_xor_b32 v19, 32, v18
v_xor_b32 v20, 64, v18
v_xor_b32 v21, 0x60, v18
v_add_u32 v22, 0x10000, v18
v_add_u32 v23, 0x10000, v19
v_add_u32 v24, 0x10000, v20
v_add_u32 v25, 0x10000, v21
M v[216:219],a[244:247],a[148:151],v[216:219]
s_barrier
M v[228:231],a[96:99],v[52:55],v[228:231]
s_nop 0
T a[64:65],v22,32768
T a[66:67],v22,34816
M v[228:231],a[100:103],v[48:51],v[228:231]
T a[68:69],v22,36864
T a[70:71],v22,38912
M v[228:231],a[246:249],a[184:187],v[228:231]
C v161,v162,v163
C v162,v168,v169
M v[224:227],a[246:249],a[152:155],v[224:227]
T a[72:73],v22,40960
T a[74:75],v22,43008
M v[236:239],a[104:107],v[52:55],v[236:239]
T a[76:77],v22,45056
T a[78:79],v22,47104
M v[236:239],a[108:111],v[48:51],v[236:239]
C v163,v170,v171
C v180,v180,v181
M v[236:239],a[244:247],a[184:187],v[236:239]
T a[80:81],v22,49152
T a[82:83],v22,51200
M v[232:235],a[244:247],a[152:155],v[232:235]
T a[84:85],v22,53248
T a[86:87],v22,55296
M v[244:247],a[112:115],v[52:55],v[244:247]
C v181,v182,v183
C v182,v188,v189
M v[244:247],a[116:119],v[48:51],v[244:247]
T a[88:89],v22,57344
T a[90:91],v22,59392
M v[244:247],a[246:249],a[188:191],v[244:247]
T a[92:93],v22,61440
T a[94:95],v22,63488
M v[240:243],a[246:249],a[156:159],v[240:243]
C v183,v190,v191
C v176,v176,v177
M v[252:255],a[120:123],v[52:55],v[252:255]
C v177,v178,v179
C v178,v184,v185
M v[252:255],a[124:127],v[48:51],v[252:255]
C v179,v186,v187
C v196,v196,v197
M v[252:255],a[244:247],a[188:191],v[252:255]
s_waitcnt lgkmcnt(0)
C v197,v198,v199
C v198,v204,v205
M v[248:251],a[244:247],a[156:159],v[248:251]
C v199,v206,v207
C v192,v192,v193
C v193,v194,v195
C v194,v200,v201
C v195,v202,v203
C v212,v212,v213
C v213,v214,v215
C v214,v220,v221
C v215,v222,v223
C v208,v208,v209
C v209,v210,v211
C v210,v216,v217
C v211,v218,v219
C v228,v228,v229
C v229,v230,v231
C v230,v236,v237
C v231,v238,v239
C v224,v224,v225
C v225,v226,v227
C v226,v232,v233
C v227,v234,v235
C v244,v244,v245
C v245,v246,v247
C v246,v252,v253
C v247,v254,v255
C v240,v240,v241
C v241,v242,v243
C v242,v248,v249
C v243,v250,v251
M v[64:67],a[64:67],v[128:131],0
s_sub_u32 s64, 15, s42
T a[96:97],v23,32768
T a[98:99],v23,34816
M v[64:67],a[68:71],v[144:147],v[64:67]
s_min_u32 s64, s64, s42
T a[100:101],v23,36864
T a[102:103],v23,38912
M v[64:67],a[72:75],v[160:163],v[64:67]
s_mul_i32 s45, s64, 8704
M v[64:67],a[76:79],v[176:179],v[64:67]
s_lshl_b32 s64, s41, 2
T a[104:105],v23,40960
T a[106:107],v23,43008
M v[64:67],a[80:83],v[192:195],v[64:67]
SA s45,s45,s64
T a[108:109],v23,45056
T a[110:111],v23,47104
M v[64:67],a[84:87],v[208:211],v[64:67]
s_lshl_b32 s64, s20, 8
M v[64:67],a[88:91],v[224:227],v[64:67]
SA s45,s45,s64
T a[112:113],v23,49152
T a[114:115],v23,51200
M v[64:67],a[92:95],v[240:243],v[64:67]
SA s45,s45,104992768
T a[116:117],v23,53248
T a[118:119],v23,55296
M v[68:71],a[92:95],v[244:247],0
s_mov_b32 s64, 1024
M v[68:71],a[88:91],v[228:231],v[68:71]
s_mov_b32 s66, 4096
T a[120:121],v23,57344
T a[122:123],v23,59392
M v[68:71],a[84:87],v[212:215],v[68:71]
s_cmp_lt_u32 s42, 8
T a[124:125],v23,61440
T a[126:127],v23,63488
M v[68:71],a[80:83],v[196:199],v[68:71]
s_cselect_b32 s64, 4352, s64
M v[68:71],a[76:79],v[180:183],v[68:71]
s_cselect_b32 s65, 0, 64
M v[68:71],a[72:75],v[164:167],v[68:71]
s_cselect_b32 s66, 536870912, s66
M v[68:71],a[68:71],v[148:151],v[68:71]
SA s3,s45,s64
M v[68:71],a[64:67],v[132:135],v[68:71]
s_waitcnt lgkmcnt(0)
M v[72:75],a[96:99],v[128:131],0
SA s45,s45,s65
T a[64:65],v24,32768
T a[66:67],v24,34816
M v[72:75],a[100:103],v[144:147],v[72:75]
SA m0,s28,0
T a[68:69],v24,36864
T a[70:71],v24,38912
M v[72:75],a[104:107],v[160:163],v[72:75]
SA s85,s38,0
buffer_load_dwordx4 v0, s[12:15], s85 offen offset:0 lds
M v[72:75],a[108:111],v[176:179],v[72:75]
SA s85,s38,6144
T a[72:73],v24,40960
T a[74:75],v24,43008
M v[72:75],a[112:115],v[192:195],v[72:75]
SA s29,s33,0
T a[76:77],v24,45056
T a[78:79],v24,47104
M v[72:75],a[116:119],v[208:211],v[72:75]
SA s30,s33,14336
buffer_load_dwordx4 v0, s[12:15], s85 offen offset:1024 lds
M v[72:75],a[120:123],v[224:227],v[72:75]
SA s85,s38,12288
T a[80:81],v24,49152
T a[82:83],v24,51200
M v[72:75],a[124:127],v[240:243],v[72:75]
T a[84:85],v24,53248
T a[86:87],v24,55296
M v[76:79],a[124:127],v[244:247],0
buffer_load_dwordx4 v0, s[12:15], s85 offen offset:2048 lds
M v[76:79],a[120:123],v[228:231],v[76:79]
SA s85,s38,18432
T a[88:89],v24,57344
T a[90:91],v24,59392
M v[76:79],a[116:119],v[212:215],v[76:79]
T a[92:93],v24,61440
T a[94:95],v24,63488
M v[76:79],a[112:115],v[196:199],v[76:79]
buffer_load_dwordx4 v0, s[12:15], s85 offen offset:3072 lds
M v[76:79],a[108:111],v[180:183],v[76:79]
SA m0,s28,4096
v_lshrrev_b32 v17, 5, v7
v_min_u32 v15, 1, v17
M v[76:79],a[104:107],v[164:167],v[76:79]
SA s85,s38,28672
buffer_load_dwordx4 v0, s[12:15], s85 offen offset:0 lds
M v[76:79],a[100:103],v[148:151],v[76:79]
SA s85,s38,34816
v_lshlrev_b32 v14, 3, v7
v_lshl_or_b32 v16, v15, 29, v14
M v[76:79],a[96:99],v[132:135],v[76:79]
s_waitcnt lgkmcnt(0)
buffer_load_dwordx4 v0, s[12:15], s85 offen offset:1024 lds
M v[80:83],a[64:67],v[128:131],0
SA s85,s38,40960
T a[96:97],v25,32768
T a[98:99],v25,34816
M v[80:83],a[68:71],v[144:147],v[80:83]
T a[100:101],v25,36864
T a[102:103],v25,38912
M v[80:83],a[72:75],v[160:163],v[80:83]
buffer_load_dwordx4 v0, s[12:15], s85 offen offset:2048 lds
M v[80:83],a[76:79],v[176:179],v[80:83]
SA s85,s38,47104
T a[104:105],v25,40960
T a[106:107],v25,43008
M v[80:83],a[80:83],v[192:195],v[80:83]
T a[108:109],v25,45056
T a[110:111],v25,47104
M v[80:83],a[84:87],v[208:211],v[80:83]
buffer_load_dwordx4 v0, s[12:15], s85 offen offset:3072 lds
M v[80:83],a[88:91],v[224:227],v[80:83]
SA s38,s38,128
T a[112:113],v25,49152
T a[114:115],v25,51200
M v[80:83],a[92:95],v[240:243],v[80:83]
SA m0,s28,131072
T a[116:117],v25,53248
T a[118:119],v25,55296
M v[84:87],a[92:95],v[244:247],0
SA s85,s38,0
buffer_load_dwordx4 v0, s[12:15], s85 offen offset:0 lds
M v[84:87],a[88:91],v[228:231],v[84:87]
SA s85,s38,6144
T a[120:121],v25,57344
T a[122:123],v25,59392
M v[84:87],a[84:87],v[212:215],v[84:87]
T a[124:125],v25,61440
T a[126:127],v25,63488
M v[84:87],a[80:83],v[196:199],v[84:87]
buffer_load_dwordx4 v0, s[12:15], s85 offen offset:1024 lds
M v[84:87],a[76:79],v[180:183],v[84:87]
SA s85,s38,12288
v_cmp_eq_u32 vcc, 1, v17
v_add_u32 v14, s66, v14
M v[84:87],a[72:75],v[164:167],v[84:87]
buffer_load_dwordx4 v0, s[12:15], s85 offen offset:2048 lds
M v[84:87],a[68:71],v[148:151],v[84:87]
s_waitcnt vmcnt(19) lgkmcnt(0)
v_mov_b32 v15, 1
v_cndmask_b32 v17, v16, v14, vcc
M v[84:87],a[64:67],v[132:135],v[84:87]
s_barrier
M v[88:91],a[96:99],v[128:131],0
SA s85,s38,18432
T a[64:65],v18,32768
T a[66:67],v18,34816
M v[88:91],a[100:103],v[144:147],v[88:91]
T a[68:69],v18,36864
T a[70:71],v18,38912
M v[88:91],a[104:107],v[160:163],v[88:91]
buffer_load_dwordx4 v0, s[12:15], s85 offen offset:3072 lds
M v[88:91],a[108:111],v[176:179],v[88:91]
SA m0,s28,135168
T a[72:73],v18,40960
T a[74:75],v18,43008
M v[88:91],a[112:115],v[192:195],v[88:91]
SA s85,s38,28672
T a[76:77],v18,45056
T a[78:79],v18,47104
M v[88:91],a[116:119],v[208:211],v[88:91]
buffer_load_dwordx4 v0, s[12:15], s85 offen offset:0 lds
M v[88:91],a[120:123],v[224:227],v[88:91]
SA s85,s38,34816
T a[80:81],v18,49152
T a[82:83],v18,51200
M v[88:91],a[124:127],v[240:243],v[88:91]
T a[84:85],v18,53248
T a[86:87],v18,55296
M v[92:95],a[124:127],v[244:247],0
buffer_load_dwordx4 v0, s[12:15], s85 offen offset:1024 lds
M v[92:95],a[120:123],v[228:231],v[92:95]
SA s85,s38,40960
T a[88:89],v18,57344
T a[90:91],v18,59392
M v[92:95],a[116:119],v[212:215],v[92:95]
T a[92:93],v18,61440
T a[94:95],v18,63488
M v[92:95],a[112:115],v[196:199],v[92:95]
buffer_load_dwordx4 v0, s[12:15], s85 offen offset:2048 lds
M v[92:95],a[108:111],v[180:183],v[92:95]
SA s85,s38,47104
v_add_u32 v40, 0x20000, v18
v_add_u32 v41, 0x20000, v19
M v[92:95],a[104:107],v[164:167],v[92:95]
buffer_load_dwordx4 v0, s[12:15], s85 offen offset:3072 lds
M v[92:95],a[100:103],v[148:151],v[92:95]
s_waitcnt lgkmcnt(0)
v_add_u32 v42, 0x20000, v20
v_add_u32 v43, 0x20000, v21
M v[92:95],a[96:99],v[132:135],v[92:95]
SA s38,s38,128
MF v64,v5,v64
MF v65,v5,v65
MF v66,v5,v66
MF v67,v5,v67
MF v72,v5,v72
MF v73,v5,v73
MF v74,v5,v74
MF v75,v5,v75
C v64,v64,v65
C v65,v66,v67
C v66,v72,v73
C v67,v74,v75
buffer_store_dwordx4 v[64:67], v7, s[8:11], s29 offen offset:0 sc1
MF v68,v6,v68
MF v69,v6,v69
MF v70,v6,v70
MF v71,v6,v71
MF v76,v6,v76
MF v77,v6,v77
MF v78,v6,v78
MF v79,v6,v79
C v68,v68,v69
C v69,v70,v71
C v70,v76,v77
C v71,v78,v79
buffer_store_dwordx4 v[68:71], v7, s[8:11], s30 offen offset:0 sc1
M v[96:99],a[64:67],v[128:131],0
s_nop 0
T a[96:97],v19,32768
T a[98:99],v19,34816
M v[96:99],a[68:71],v[144:147],v[96:99]
SA m0,s28,98304
T a[100:101],v19,36864
T a[102:103],v19,38912
M v[96:99],a[72:75],v[160:163],v[96:99]
SA s85,s38,0
buffer_load_dwordx4 v0, s[12:15], s85 offen offset:0 lds
M v[96:99],a[76:79],v[176:179],v[96:99]
s_nop 0
T a[104:105],v19,40960
T a[106:107],v19,43008
M v[96:99],a[80:83],v[192:195],v[96:99]
T a[108:109],v19,45056
T a[110:111],v19,47104
M v[96:99],a[84:87],v[208:211],v[96:99]
SA s85,s38,6144
MF v80,v5,v80
MF v81,v5,v81
M v[96:99],a[88:91],v[224:227],v[96:99]
T a[112:113],v19,49152
T a[114:115],v19,51200
M v[96:99],a[92:95],v[240:243],v[96:99]
T a[116:117],v19,53248
T a[118:119],v19,55296
M v[100:103],a[92:95],v[244:247],0
buffer_load_dwordx4 v0, s[12:15], s85 offen offset:1024 lds
M v[100:103],a[88:91],v[228:231],v[100:103]
s_nop 0
T a[120:121],v19,57344
T a[122:123],v19,59392
M v[100:103],a[84:87],v[212:215],v[100:103]
T a[124:125],v19,61440
T a[126:127],v19,63488
M v[100:103],a[80:83],v[196:199],v[100:103]
SA s85,s38,12288
MF v82,v5,v82
MF v83,v5,v83
M v[100:103],a[76:79],v[180:183],v[100:103]
buffer_load_dwordx4 v0, s[12:15], s85 offen offset:2048 lds
M v[100:103],a[72:75],v[164:167],v[100:103]
MF v88,v5,v88
MF v89,v5,v89
M v[100:103],a[68:71],v[148:151],v[100:103]
MF v90,v5,v90
MF v91,v5,v91
M v[100:103],a[64:67],v[132:135],v[100:103]
s_waitcnt lgkmcnt(0)
C v80,v80,v81
C v81,v82,v83
M v[104:107],a[96:99],v[128:131],0
SA s85,s38,18432
T a[64:65],v20,32768
T a[66:67],v20,34816
M v[104:107],a[100:103],v[144:147],v[104:107]
T a[68:69],v20,36864
T a[70:71],v20,38912
M v[104:107],a[104:107],v[160:163],v[104:107]
buffer_load_dwordx4 v0, s[12:15], s85 offen offset:3072 lds
M v[104:107],a[108:111],v[176:179],v[104:107]
s_nop 0
T a[72:73],v20,40960
T a[74:75],v20,43008
M v[104:107],a[112:115],v[192:195],v[104:107]
T a[76:77],v20,45056
T a[78:79],v20,47104
M v[104:107],a[116:119],v[208:211],v[104:107]
SA m0,s28,102400
C v82,v88,v89
C v83,v90,v91
M v[104:107],a[120:123],v[224:227],v[104:107]
SA s85,s38,28672
T a[80:81],v20,49152
T a[82:83],v20,51200
M v[104:107],a[124:127],v[240:243],v[104:107]
T a[84:85],v20,53248
T a[86:87],v20,55296
M v[108:111],a[124:127],v[244:247],0
buffer_store_dwordx4 v[80:83], v7, s[8:11], s29 offen offset:1024 sc1
M v[108:111],a[120:123],v[228:231],v[108:111]
s_nop 0
T a[88:89],v20,57344
T a[90:91],v20,59392
M v[108:111],a[116:119],v[212:215],v[108:111]
T a[92:93],v20,61440
T a[94:95],v20,63488
M v[108:111],a[112:115],v[196:199],v[108:111]
buffer_load_dwordx4 v0, s[12:15], s85 offen offset:0 lds
M v[108:111],a[108:111],v[180:183],v[108:111]
SA s85,s38,34816
MF v84,v6,v84
MF v85,v6,v85
M v[108:111],a[104:107],v[164:167],v[108:111]
MF v86,v6,v86
MF v87,v6,v87
M v[108:111],a[100:103],v[148:151],v[108:111]
buffer_load_dwordx4 v0, s[12:15], s85 offen offset:1024 lds
M v[108:111],a[96:99],v[132:135],v[108:111]
s_waitcnt lgkmcnt(0)
MF v92,v6,v92
MF v93,v6,v93
M v[112:115],a[64:67],v[128:131],0
T a[96:97],v21,32768
T a[98:99],v21,34816
M v[112:115],a[68:71],v[144:147],v[112:115]
SA s85,s38,40960
T a[100:101],v21,36864
T a[102:103],v21,38912
M v[112:115],a[72:75],v[160:163],v[112:115]
buffer_load_dwordx4 v0, s[12:15], s85 offen offset:2048 lds
M v[112:115],a[76:79],v[176:179],v[112:115]
s_nop 0
T a[104:105],v21,40960
T a[106:107],v21,43008
M v[112:115],a[80:83],v[192:195],v[112:115]
T a[108:109],v21,45056
T a[110:111],v21,47104
M v[112:115],a[84:87],v[208:211],v[112:115]
MF v94,v6,v94
MF v95,v6,v95
M v[112:115],a[88:91],v[224:227],v[112:115]
SA s85,s38,47104
T a[112:113],v21,49152
T a[114:115],v21,51200
M v[112:115],a[92:95],v[240:243],v[112:115]
T a[116:117],v21,53248
T a[118:119],v21,55296
M v[116:119],a[92:95],v[244:247],0
buffer_load_dwordx4 v0, s[12:15], s85 offen offset:3072 lds
M v[116:119],a[88:91],v[228:231],v[116:119]
s_nop 0
T a[120:121],v21,57344
T a[122:123],v21,59392
M v[116:119],a[84:87],v[212:215],v[116:119]
T a[124:125],v21,61440
T a[126:127],v21,63488
M v[116:119],a[80:83],v[196:199],v[116:119]
C v84,v84,v85
C v85,v86,v87
M v[116:119],a[76:79],v[180:183],v[116:119]
C v86,v92,v93
C v87,v94,v95
M v[116:119],a[72:75],v[164:167],v[116:119]
SA s38,s38,128
buffer_store_dwordx4 v[84:87], v7, s[8:11], s30 offen offset:1024 sc1
M v[116:119],a[68:71],v[148:151],v[116:119]
s_waitcnt vmcnt(28) lgkmcnt(0)
M v[116:119],a[64:67],v[132:135],v[116:119]
s_barrier
M v[120:123],a[96:99],v[128:131],0
SA s29,s33,2048
T a[64:65],v22,0
T a[66:67],v22,2048
M v[120:123],a[100:103],v[144:147],v[120:123]
SA s30,s33,16384
T a[68:69],v22,4096
T a[70:71],v22,6144
M v[120:123],a[104:107],v[160:163],v[120:123]
MF v96,v5,v96
MF v97,v5,v97
M v[120:123],a[108:111],v[176:179],v[120:123]
T a[72:73],v22,8192
T a[74:75],v22,10240
M v[120:123],a[112:115],v[192:195],v[120:123]
T a[76:77],v22,12288
T a[78:79],v22,14336
M v[120:123],a[116:119],v[208:211],v[120:123]
MF v98,v5,v98
MF v99,v5,v99
M v[120:123],a[120:123],v[224:227],v[120:123]
T a[80:81],v22,16384
T a[82:83],v22,18432
M v[120:123],a[124:127],v[240:243],v[120:123]
T a[84:85],v22,20480
T a[86:87],v22,22528
M v[124:127],a[124:127],v[244:247],0
MF v104,v5,v104
MF v105,v5,v105
M v[124:127],a[120:123],v[228:231],v[124:127]
T a[88:89],v22,24576
T a[90:91],v22,26624
M v[124:127],a[116:119],v[212:215],v[124:127]
T a[92:93],v22,28672
T a[94:95],v22,30720
M v[124:127],a[112:115],v[196:199],v[124:127]
MF v106,v5,v106
MF v107,v5,v107
M v[124:127],a[108:111],v[180:183],v[124:127]
C v96,v96,v97
C v97,v98,v99
M v[124:127],a[104:107],v[164:167],v[124:127]
C v98,v104,v105
C v99,v106,v107
M v[124:127],a[100:103],v[148:151],v[124:127]
s_waitcnt lgkmcnt(0)
buffer_store_dwordx4 v[96:99], v7, s[8:11], s29 offen offset:0 sc1
M v[124:127],a[96:99],v[132:135],v[124:127]
MF v100,v6,v100
MF v101,v6,v101
MF v102,v6,v102
MF v103,v6,v103
MF v108,v6,v108
MF v109,v6,v109
MF v110,v6,v110
MF v111,v6,v111
C v100,v100,v101
C v101,v102,v103
C v102,v108,v109
C v103,v110,v111
buffer_store_dwordx4 v[100:103], v7, s[8:11], s30 offen offset:0 sc1
M v[64:67],a[64:67],v[128:131],0
s_nop 0
T a[96:97],v23,0
T a[98:99],v23,2048
M v[64:67],a[68:71],v[144:147],v[64:67]
SA m0,s28,32768
T a[100:101],v23,4096
T a[102:103],v23,6144
M v[64:67],a[72:75],v[160:163],v[64:67]
SA s85,s38,0
buffer_load_dwordx4 v0, s[12:15], s85 offen offset:0 lds
M v[64:67],a[76:79],v[176:179],v[64:67]
s_nop 0
T a[104:105],v23,8192
T a[106:107],v23,10240
M v[64:67],a[80:83],v[192:195],v[64:67]
T a[108:109],v23,12288
T a[110:111],v23,14336
M v[64:67],a[84:87],v[208:211],v[64:67]
SA s85,s38,6144
MF v112,v5,v112
MF v113,v5,v113
M v[64:67],a[88:91],v[224:227],v[64:67]
T a[112:113],v23,16384
T a[114:115],v23,18432
M v[64:67],a[92:95],v[240:243],v[64:67]
T a[116:117],v23,20480
T a[118:119],v23,22528
M v[68:71],a[92:95],v[244:247],0
buffer_load_dwordx4 v0, s[12:15], s85 offen offset:1024 lds
M v[68:71],a[88:91],v[228:231],v[68:71]
s_nop 0
T a[120:121],v23,24576
T a[122:123],v23,26624
M v[68:71],a[84:87],v[212:215],v[68:71]
T a[124:125],v23,28672
T a[126:127],v23,30720
M v[68:71],a[80:83],v[196:199],v[68:71]
SA s85,s38,12288
MF v114,v5,v114
MF v115,v5,v115
M v[68:71],a[76:79],v[180:183],v[68:71]
buffer_load_dwordx4 v0, s[12:15], s85 offen offset:2048 lds
M v[68:71],a[72:75],v[164:167],v[68:71]
MF v120,v5,v120
MF v121,v5,v121
M v[68:71],a[68:71],v[148:151],v[68:71]
MF v122,v5,v122
MF v123,v5,v123
M v[68:71],a[64:67],v[132:135],v[68:71]
s_waitcnt lgkmcnt(0)
C v112,v112,v113
C v113,v114,v115
M v[72:75],a[96:99],v[128:131],0
SA s85,s38,18432
T a[64:65],v24,0
T a[66:67],v24,2048
M v[72:75],a[100:103],v[144:147],v[72:75]
T a[68:69],v24,4096
T a[70:71],v24,6144
M v[72:75],a[104:107],v[160:163],v[72:75]
buffer_load_dwordx4 v0, s[12:15], s85 offen offset:3072 lds
M v[72:75],a[108:111],v[176:179],v[72:75]
s_nop 0
T a[72:73],v24,8192
T a[74:75],v24,10240
M v[72:75],a[112:115],v[192:195],v[72:75]
T a[76:77],v24,12288
T a[78:79],v24,14336
M v[72:75],a[116:119],v[208:211],v[72:75]
SA m0,s28,36864
C v114,v120,v121
C v115,v122,v123
M v[72:75],a[120:123],v[224:227],v[72:75]
SA s85,s38,28672
T a[80:81],v24,16384
T a[82:83],v24,18432
M v[72:75],a[124:127],v[240:243],v[72:75]
T a[84:85],v24,20480
T a[86:87],v24,22528
M v[76:79],a[124:127],v[244:247],0
buffer_store_dwordx4 v[112:115], v7, s[8:11], s29 offen offset:1024 sc1
M v[76:79],a[120:123],v[228:231],v[76:79]
s_nop 0
T a[88:89],v24,24576
T a[90:91],v24,26624
M v[76:79],a[116:119],v[212:215],v[76:79]
T a[92:93],v24,28672
T a[94:95],v24,30720
M v[76:79],a[112:115],v[196:199],v[76:79]
buffer_load_dwordx4 v0, s[12:15], s85 offen offset:0 lds
M v[76:79],a[108:111],v[180:183],v[76:79]
SA s85,s38,34816
MF v116,v6,v116
MF v117,v6,v117
M v[76:79],a[104:107],v[164:167],v[76:79]
MF v118,v6,v118
MF v119,v6,v119
M v[76:79],a[100:103],v[148:151],v[76:79]
buffer_load_dwordx4 v0, s[12:15], s85 offen offset:1024 lds
M v[76:79],a[96:99],v[132:135],v[76:79]
s_waitcnt lgkmcnt(0)
MF v124,v6,v124
MF v125,v6,v125
M v[80:83],a[64:67],v[128:131],0
T a[96:97],v25,0
T a[98:99],v25,2048
M v[80:83],a[68:71],v[144:147],v[80:83]
SA s85,s38,40960
T a[100:101],v25,4096
T a[102:103],v25,6144
M v[80:83],a[72:75],v[160:163],v[80:83]
buffer_load_dwordx4 v0, s[12:15], s85 offen offset:2048 lds
M v[80:83],a[76:79],v[176:179],v[80:83]
s_nop 0
T a[104:105],v25,8192
T a[106:107],v25,10240
M v[80:83],a[80:83],v[192:195],v[80:83]
T a[108:109],v25,12288
T a[110:111],v25,14336
M v[80:83],a[84:87],v[208:211],v[80:83]
MF v126,v6,v126
MF v127,v6,v127
M v[80:83],a[88:91],v[224:227],v[80:83]
SA s85,s38,47104
T a[112:113],v25,16384
T a[114:115],v25,18432
M v[80:83],a[92:95],v[240:243],v[80:83]
T a[116:117],v25,20480
T a[118:119],v25,22528
M v[84:87],a[92:95],v[244:247],0
buffer_load_dwordx4 v0, s[12:15], s85 offen offset:3072 lds
M v[84:87],a[88:91],v[228:231],v[84:87]
s_nop 0
T a[120:121],v25,24576
T a[122:123],v25,26624
M v[84:87],a[84:87],v[212:215],v[84:87]
T a[124:125],v25,28672
T a[126:127],v25,30720
M v[84:87],a[80:83],v[196:199],v[84:87]
C v116,v116,v117
C v117,v118,v119
M v[84:87],a[76:79],v[180:183],v[84:87]
C v118,v124,v125
C v119,v126,v127
M v[84:87],a[72:75],v[164:167],v[84:87]
SA s38,s38,128
buffer_store_dwordx4 v[116:119], v7, s[8:11], s30 offen offset:1024 sc1
M v[84:87],a[68:71],v[148:151],v[84:87]
s_waitcnt vmcnt(32) lgkmcnt(0)
M v[84:87],a[64:67],v[132:135],v[84:87]
s_barrier
M v[88:91],a[96:99],v[128:131],0
SA s29,s33,4096
T a[64:65],v18,0
T a[66:67],v18,2048
M v[88:91],a[100:103],v[144:147],v[88:91]
SA s30,s33,18432
T a[68:69],v18,4096
T a[70:71],v18,6144
M v[88:91],a[104:107],v[160:163],v[88:91]
MF v64,v5,v64
MF v65,v5,v65
M v[88:91],a[108:111],v[176:179],v[88:91]
T a[72:73],v18,8192
T a[74:75],v18,10240
M v[88:91],a[112:115],v[192:195],v[88:91]
T a[76:77],v18,12288
T a[78:79],v18,14336
M v[88:91],a[116:119],v[208:211],v[88:91]
MF v66,v5,v66
MF v67,v5,v67
M v[88:91],a[120:123],v[224:227],v[88:91]
T a[80:81],v18,16384
T a[82:83],v18,18432
M v[88:91],a[124:127],v[240:243],v[88:91]
T a[84:85],v18,20480
T a[86:87],v18,22528
M v[92:95],a[124:127],v[244:247],0
MF v72,v5,v72
MF v73,v5,v73
M v[92:95],a[120:123],v[228:231],v[92:95]
T a[88:89],v18,24576
T a[90:91],v18,26624
M v[92:95],a[116:119],v[212:215],v[92:95]
T a[92:93],v18,28672
T a[94:95],v18,30720
M v[92:95],a[112:115],v[196:199],v[92:95]
MF v74,v5,v74
MF v75,v5,v75
M v[92:95],a[108:111],v[180:183],v[92:95]
C v64,v64,v65
C v65,v66,v67
M v[92:95],a[104:107],v[164:167],v[92:95]
C v66,v72,v73
C v67,v74,v75
M v[92:95],a[100:103],v[148:151],v[92:95]
s_waitcnt lgkmcnt(0)
buffer_store_dwordx4 v[64:67], v7, s[8:11], s29 offen offset:0 sc1
M v[92:95],a[96:99],v[132:135],v[92:95]
MF v68,v6,v68
MF v69,v6,v69
MF v70,v6,v70
MF v71,v6,v71
MF v76,v6,v76
MF v77,v6,v77
MF v78,v6,v78
MF v79,v6,v79
C v68,v68,v69
C v69,v70,v71
C v70,v76,v77
C v71,v78,v79
buffer_store_dwordx4 v[68:71], v7, s[8:11], s30 offen offset:0 sc1
M v[96:99],a[64:67],v[128:131],0
s_nop 0
T a[96:97],v19,0
T a[98:99],v19,2048
M v[96:99],a[68:71],v[144:147],v[96:99]
T a[100:101],v19,4096
T a[102:103],v19,6144
M v[96:99],a[72:75],v[160:163],v[96:99]
MF v80,v5,v80
MF v81,v5,v81
M v[96:99],a[76:79],v[176:179],v[96:99]
T a[104:105],v19,8192
T a[106:107],v19,10240
M v[96:99],a[80:83],v[192:195],v[96:99]
T a[108:109],v19,12288
T a[110:111],v19,14336
M v[96:99],a[84:87],v[208:211],v[96:99]
MF v82,v5,v82
MF v83,v5,v83
M v[96:99],a[88:91],v[224:227],v[96:99]
T a[112:113],v19,16384
T a[114:115],v19,18432
M v[96:99],a[92:95],v[240:243],v[96:99]
T a[116:117],v19,20480
T a[118:119],v19,22528
M v[100:103],a[92:95],v[244:247],0
MF v88,v5,v88
MF v89,v5,v89
M v[100:103],a[88:91],v[228:231],v[100:103]
T a[120:121],v19,24576
T a[122:123],v19,26624
M v[100:103],a[84:87],v[212:215],v[100:103]
T a[124:125],v19,28672
T a[126:127],v19,30720
M v[100:103],a[80:83],v[196:199],v[100:103]
MF v90,v5,v90
MF v91,v5,v91
M v[100:103],a[76:79],v[180:183],v[100:103]
C v80,v80,v81
C v81,v82,v83
M v[100:103],a[72:75],v[164:167],v[100:103]
C v82,v88,v89
C v83,v90,v91
M v[100:103],a[68:71],v[148:151],v[100:103]
buffer_store_dwordx4 v[80:83], v7, s[8:11], s29 offen offset:1024 sc1
M v[100:103],a[64:67],v[132:135],v[100:103]
s_waitcnt lgkmcnt(0)
MF v84,v6,v84
MF v85,v6,v85
M v[104:107],a[96:99],v[128:131],0
T a[64:65],v20,0
T a[66:67],v20,2048
M v[104:107],a[100:103],v[144:147],v[104:107]
T a[68:69],v20,4096
T a[70:71],v20,6144
M v[104:107],a[104:107],v[160:163],v[104:107]
MF v86,v6,v86
MF v87,v6,v87
M v[104:107],a[108:111],v[176:179],v[104:107]
T a[72:73],v20,8192
T a[74:75],v20,10240
M v[104:107],a[112:115],v[192:195],v[104:107]
T a[76:77],v20,12288
T a[78:79],v20,14336
M v[104:107],a[116:119],v[208:211],v[104:107]
MF v92,v6,v92
MF v93,v6,v93
M v[104:107],a[120:123],v[224:227],v[104:107]
T a[80:81],v20,16384
T a[82:83],v20,18432
M v[104:107],a[124:127],v[240:243],v[104:107]
T a[84:85],v20,20480
T a[86:87],v20,22528
M v[108:111],a[124:127],v[244:247],0
MF v94,v6,v94
MF v95,v6,v95
M v[108:111],a[120:123],v[228:231],v[108:111]
T a[88:89],v20,24576
T a[90:91],v20,26624
M v[108:111],a[116:119],v[212:215],v[108:111]
T a[92:93],v20,28672
T a[94:95],v20,30720
M v[108:111],a[112:115],v[196:199],v[108:111]
C v84,v84,v85
C v85,v86,v87
M v[108:111],a[108:111],v[180:183],v[108:111]
C v86,v92,v93
C v87,v94,v95
M v[108:111],a[104:107],v[164:167],v[108:111]
buffer_store_dwordx4 v[84:87], v7, s[8:11], s30 offen offset:1024 sc1
M v[108:111],a[100:103],v[148:151],v[108:111]
SA s29,s33,6144
M v[108:111],a[96:99],v[132:135],v[108:111]
s_waitcnt lgkmcnt(0)
M v[112:115],a[64:67],v[128:131],0
SA s30,s33,20480
T a[96:97],v21,0
T a[98:99],v21,2048
M v[112:115],a[68:71],v[144:147],v[112:115]
T a[100:101],v21,4096
T a[102:103],v21,6144
M v[112:115],a[72:75],v[160:163],v[112:115]
MF v96,v5,v96
MF v97,v5,v97
M v[112:115],a[76:79],v[176:179],v[112:115]
T a[104:105],v21,8192
T a[106:107],v21,10240
M v[112:115],a[80:83],v[192:195],v[112:115]
T a[108:109],v21,12288
T a[110:111],v21,14336
M v[112:115],a[84:87],v[208:211],v[112:115]
MF v98,v5,v98
MF v99,v5,v99
M v[112:115],a[88:91],v[224:227],v[112:115]
T a[112:113],v21,16384
T a[114:115],v21,18432
M v[112:115],a[92:95],v[240:243],v[112:115]
T a[116:117],v21,20480
T a[118:119],v21,22528
M v[116:119],a[92:95],v[244:247],0
MF v104,v5,v104
MF v105,v5,v105
M v[116:119],a[88:91],v[228:231],v[116:119]
T a[120:121],v21,24576
T a[122:123],v21,26624
M v[116:119],a[84:87],v[212:215],v[116:119]
T a[124:125],v21,28672
T a[126:127],v21,30720
M v[116:119],a[80:83],v[196:199],v[116:119]
MF v106,v5,v106
MF v107,v5,v107
M v[116:119],a[76:79],v[180:183],v[116:119]
C v96,v96,v97
C v97,v98,v99
M v[116:119],a[72:75],v[164:167],v[116:119]
C v98,v104,v105
C v99,v106,v107
M v[116:119],a[68:71],v[148:151],v[116:119]
s_waitcnt vmcnt(28) lgkmcnt(0)
buffer_store_dwordx4 v[96:99], v7, s[8:11], s29 offen offset:0 sc1
M v[116:119],a[64:67],v[132:135],v[116:119]
s_barrier
M v[120:123],a[96:99],v[128:131],0
s_nop 0
T a[64:65],v40,0
T a[66:67],v40,2048
M v[120:123],a[100:103],v[144:147],v[120:123]
T a[68:69],v40,4096
T a[70:71],v40,6144
M v[120:123],a[104:107],v[160:163],v[120:123]
MF v100,v6,v100
MF v101,v6,v101
M v[120:123],a[108:111],v[176:179],v[120:123]
T a[72:73],v40,8192
T a[74:75],v40,10240
M v[120:123],a[112:115],v[192:195],v[120:123]
T a[76:77],v40,12288
T a[78:79],v40,14336
M v[120:123],a[116:119],v[208:211],v[120:123]
MF v102,v6,v102
MF v103,v6,v103
M v[120:123],a[120:123],v[224:227],v[120:123]
T a[80:81],v40,16384
T a[82:83],v40,18432
M v[120:123],a[124:127],v[240:243],v[120:123]
T a[84:85],v40,20480
T a[86:87],v40,22528
M v[124:127],a[124:127],v[244:247],0
MF v108,v6,v108
MF v109,v6,v109
M v[124:127],a[120:123],v[228:231],v[124:127]
T a[88:89],v40,24576
T a[90:91],v40,26624
M v[124:127],a[116:119],v[212:215],v[124:127]
T a[92:93],v40,28672
T a[94:95],v40,30720
M v[124:127],a[112:115],v[196:199],v[124:127]
MF v110,v6,v110
MF v111,v6,v111
M v[124:127],a[108:111],v[180:183],v[124:127]
C v100,v100,v101
C v101,v102,v103
M v[124:127],a[104:107],v[164:167],v[124:127]
C v102,v108,v109
C v103,v110,v111
M v[124:127],a[100:103],v[148:151],v[124:127]
s_waitcnt lgkmcnt(0)
buffer_store_dwordx4 v[100:103], v7, s[8:11], s30 offen offset:0 sc1
M v[124:127],a[96:99],v[132:135],v[124:127]
M v[64:67],a[64:67],v[128:131],0
s_nop 0
T a[96:97],v41,0
T a[98:99],v41,2048
M v[64:67],a[68:71],v[144:147],v[64:67]
T a[100:101],v41,4096
T a[102:103],v41,6144
M v[64:67],a[72:75],v[160:163],v[64:67]
v_lshrrev_b32 v32, 4, v7
MF v112,v5,v112
M v[64:67],a[76:79],v[176:179],v[64:67]
s_lshr_b32 s74, s41, 3
T a[104:105],v41,8192
T a[106:107],v41,10240
M v[64:67],a[80:83],v[192:195],v[64:67]
s_sub_u32 s64, 15, s42
T a[108:109],v41,12288
T a[110:111],v41,14336
M v[64:67],a[84:87],v[208:211],v[64:67]
s_mul_i32 s46, s64, 8704
MF v113,v5,v113
MF v114,v5,v114
M v[64:67],a[88:91],v[224:227],v[64:67]
s_and_b32 s72, s41, 7
T a[112:113],v41,16384
T a[114:115],v41,18432
M v[64:67],a[92:95],v[240:243],v[64:67]
s_lshl_b32 s65, s72, 7
T a[116:117],v41,20480
T a[118:119],v41,22528
M v[68:71],a[92:95],v[244:247],0
SA s46,s46,s65
MF v115,v5,v115
MF v120,v5,v120
M v[68:71],a[88:91],v[228:231],v[68:71]
SA s46,s46,104993792
T a[120:121],v41,24576
T a[122:123],v41,26624
M v[68:71],a[84:87],v[212:215],v[68:71]
T a[124:125],v41,28672
T a[126:127],v41,30720
M v[68:71],a[80:83],v[196:199],v[68:71]
v_and_b32 v33, 31, v32
MF v121,v5,v121
M v[68:71],a[76:79],v[180:183],v[68:71]
MF v122,v5,v122
MF v123,v5,v123
M v[68:71],a[72:75],v[164:167],v[68:71]
C v112,v112,v113
C v113,v114,v115
M v[68:71],a[68:71],v[148:151],v[68:71]
C v114,v120,v121
C v115,v122,v123
M v[68:71],a[64:67],v[132:135],v[68:71]
s_waitcnt lgkmcnt(0)
buffer_store_dwordx4 v[112:115], v7, s[8:11], s29 offen offset:1024 sc1
M v[72:75],a[96:99],v[128:131],0
s_nop 0
T a[64:65],v42,0
T a[66:67],v42,2048
M v[72:75],a[100:103],v[144:147],v[72:75]
T a[68:69],v42,4096
T a[70:71],v42,6144
M v[72:75],a[104:107],v[160:163],v[72:75]
MF v116,v6,v116
MF v117,v6,v117
M v[72:75],a[108:111],v[176:179],v[72:75]
T a[72:73],v42,8192
T a[74:75],v42,10240
M v[72:75],a[112:115],v[192:195],v[72:75]
T a[76:77],v42,12288
T a[78:79],v42,14336
M v[72:75],a[116:119],v[208:211],v[72:75]
MF v118,v6,v118
MF v119,v6,v119
M v[72:75],a[120:123],v[224:227],v[72:75]
T a[80:81],v42,16384
T a[82:83],v42,18432
M v[72:75],a[124:127],v[240:243],v[72:75]
T a[84:85],v42,20480
T a[86:87],v42,22528
M v[76:79],a[124:127],v[244:247],0
MF v124,v6,v124
MF v125,v6,v125
M v[76:79],a[120:123],v[228:231],v[76:79]
T a[88:89],v42,24576
T a[90:91],v42,26624
M v[76:79],a[116:119],v[212:215],v[76:79]
T a[92:93],v42,28672
T a[94:95],v42,30720
M v[76:79],a[112:115],v[196:199],v[76:79]
MF v126,v6,v126
MF v127,v6,v127
M v[76:79],a[108:111],v[180:183],v[76:79]
C v116,v116,v117
C v117,v118,v119
M v[76:79],a[104:107],v[164:167],v[76:79]
C v118,v124,v125
C v119,v126,v127
M v[76:79],a[100:103],v[148:151],v[76:79]
buffer_store_dwordx4 v[116:119], v7, s[8:11], s30 offen offset:1024 sc1
M v[76:79],a[96:99],v[132:135],v[76:79]
s_waitcnt lgkmcnt(0)
v_lshlrev_b32 v33, 2, v33
M v[80:83],a[64:67],v[128:131],0
SA s29,s33,8192
T a[96:97],v43,0
T a[98:99],v43,2048
M v[80:83],a[68:71],v[144:147],v[80:83]
SA s30,s33,22528
T a[100:101],v43,4096
T a[102:103],v43,6144
M v[80:83],a[72:75],v[160:163],v[80:83]
s_lshl_b32 s65, s41, 7
MF v64,v5,v64
MF v65,v5,v65
M v[80:83],a[76:79],v[176:179],v[80:83]
SA s65,s65,104890368
T a[104:105],v43,8192
T a[106:107],v43,10240
M v[80:83],a[80:83],v[192:195],v[80:83]
T a[108:109],v43,12288
T a[110:111],v43,14336
M v[80:83],a[84:87],v[208:211],v[80:83]
buffer_load_dword v31, v33, s[8:11], s65 offen sc1
M v[80:83],a[88:91],v[224:227],v[80:83]
s_nop 0
T a[112:113],v43,16384
T a[114:115],v43,18432
M v[80:83],a[92:95],v[240:243],v[80:83]
T a[116:117],v43,20480
T a[118:119],v43,22528
M v[84:87],a[92:95],v[244:247],0
s_cmp_ge_u32 s42, 8
v_bfe_u32 v34, v32, 4, 1
v_lshlrev_b32 v34, 1, v34
M v[84:87],a[88:91],v[228:231],v[84:87]
s_cselect_b32 s84, s45, 536870912
T a[120:121],v43,24576
T a[122:123],v43,26624
M v[84:87],a[84:87],v[212:215],v[84:87]
T a[124:125],v43,28672
T a[126:127],v43,30720
M v[84:87],a[80:83],v[196:199],v[84:87]
v_lshrrev_b32 v35, 5, v32
v_add_u32 v34, v34, v35
M v[84:87],a[76:79],v[180:183],v[84:87]
s_mov_b32 s52, s96
MF v66,v5,v66
MF v67,v5,v67
M v[84:87],a[72:75],v[164:167],v[84:87]
s_and_b32 s53, s97, 0xffff
MF v72,v5,v72
MF v73,v5,v73
M v[84:87],a[68:71],v[148:151],v[84:87]
s_waitcnt vmcnt(22) lgkmcnt(0)
MF v74,v5,v74
MF v75,v5,v75
M v[84:87],a[64:67],v[132:135],v[84:87]
s_barrier
M v[88:91],a[96:99],v[128:131],0
s_mov_b32 s54, 1835008
T a[64:65],v22,32768
T a[66:67],v22,34816
M v[88:91],a[100:103],v[144:147],v[88:91]
s_mov_b32 s55, 0x20000
T a[68:69],v22,36864
T a[70:71],v22,38912
M v[88:91],a[104:107],v[160:163],v[88:91]
s_mul_i32 s77, s42, 1835008
C v64,v64,v65
C v65,v66,v67
M v[88:91],a[108:111],v[176:179],v[88:91]
s_mul_i32 s78, s72, 14336
T a[72:73],v22,40960
T a[74:75],v22,43008
M v[88:91],a[112:115],v[192:195],v[88:91]
SA s77,s77,s78
T a[76:77],v22,45056
T a[78:79],v22,47104
M v[88:91],a[116:119],v[208:211],v[88:91]
SA s77,s77,67108864
C v66,v72,v73
C v67,v74,v75
M v[88:91],a[120:123],v[224:227],v[88:91]
s_lshl_b32 s79, s74, 2
T a[80:81],v22,49152
T a[82:83],v22,51200
M v[88:91],a[124:127],v[240:243],v[88:91]
SA s79,s79,s20
T a[84:85],v22,53248
T a[86:87],v22,55296
M v[92:95],a[124:127],v[244:247],0
SA s79,s79,6
buffer_store_dwordx4 v[64:67], v7, s[8:11], s29 offen offset:0 sc1
M v[92:95],a[120:123],v[228:231],v[92:95]
s_sub_u32 s67, 13, s79
T a[88:89],v22,57344
T a[90:91],v22,59392
M v[92:95],a[116:119],v[212:215],v[92:95]
s_and_b32 s67, s67, 536870912
T a[92:93],v22,61440
T a[94:95],v22,63488
M v[92:95],a[112:115],v[196:199],v[92:95]
s_lshl_b32 s78, s79, 10
MF v68,v6,v68
MF v69,v6,v69
M v[92:95],a[108:111],v[180:183],v[92:95]
SA s78,s78,s77
MF v70,v6,v70
MF v71,v6,v71
M v[92:95],a[104:107],v[164:167],v[92:95]
s_lshl_b32 s79, s79, 6
MF v76,v6,v76
MF v77,v6,v77
M v[92:95],a[100:103],v[148:151],v[92:95]
s_waitcnt lgkmcnt(0)
MF v78,v6,v78
MF v79,v6,v79
M v[92:95],a[96:99],v[132:135],v[92:95]
s_or_b32 s79, s79, s67
v_or_b32 v27, s67, v7
s_lshr_b32 s73, s72, 1
s_sub_u32 s65, 7, s73
s_bitcmp1_b32 s72, 0
s_cselect_b32 s73, s65, s73
s_lshl_b32 s73, s73, 4
s_lshl_b32 s65, s42, 7
SA s73,s73,s65
v_and_b32 v29, 15, v32
v_add_u32 v29, s73, v29
s_mov_b32 s64, 104857664
v_mul_u32_u24 v28, 896, v29
v_lshl_add_u32 v28, v34, 4, v28
C v68,v68,v69
C v69,v70,v71
C v70,v76,v77
C v71,v78,v79
buffer_store_dwordx4 v[68:71], v7, s[8:11], s30 offen offset:0 sc1
v_lshrrev_b32 v35, 4, v29
v_lshlrev_b32 v35, 5, v35
v_and_b32 v36, 15, v29
v_add_lshl_u32 v35, v35, v36, 2
buffer_load_dword v26, v35, s[8:11], s64 offen sc1
s_waitcnt vmcnt(8)
buffer_store_dword v15, v17, s[8:11], s84 offen sc1
buffer_load_dwordx4 v[44:47], v28, s[56:59], s79 offen
M v[96:99],a[64:67],v[128:131],0
s_nop 0
T a[96:97],v23,32768
T a[98:99],v23,34816
M v[96:99],a[68:71],v[144:147],v[96:99]
T a[100:101],v23,36864
T a[102:103],v23,38912
M v[96:99],a[72:75],v[160:163],v[96:99]
MF v80,v5,v80
MF v81,v5,v81
M v[96:99],a[76:79],v[176:179],v[96:99]
T a[104:105],v23,40960
T a[106:107],v23,43008
M v[96:99],a[80:83],v[192:195],v[96:99]
T a[108:109],v23,45056
T a[110:111],v23,47104
M v[96:99],a[84:87],v[208:211],v[96:99]
MF v82,v5,v82
MF v83,v5,v83
M v[96:99],a[88:91],v[224:227],v[96:99]
T a[112:113],v23,49152
T a[114:115],v23,51200
M v[96:99],a[92:95],v[240:243],v[96:99]
T a[116:117],v23,53248
T a[118:119],v23,55296
M v[100:103],a[92:95],v[244:247],0
MF v88,v5,v88
MF v89,v5,v89
M v[100:103],a[88:91],v[228:231],v[100:103]
T a[120:121],v23,57344
T a[122:123],v23,59392
M v[100:103],a[84:87],v[212:215],v[100:103]
T a[124:125],v23,61440
T a[126:127],v23,63488
M v[100:103],a[80:83],v[196:199],v[100:103]
MF v90,v5,v90
MF v91,v5,v91
M v[100:103],a[76:79],v[180:183],v[100:103]
C v80,v80,v81
C v81,v82,v83
M v[100:103],a[72:75],v[164:167],v[100:103]
C v82,v88,v89
C v83,v90,v91
M v[100:103],a[68:71],v[148:151],v[100:103]
buffer_store_dwordx4 v[80:83], v7, s[8:11], s29 offen offset:1024 sc1
M v[100:103],a[64:67],v[132:135],v[100:103]
s_waitcnt lgkmcnt(0)
MF v84,v6,v84
MF v85,v6,v85
M v[104:107],a[96:99],v[128:131],0
T a[64:65],v24,32768
T a[66:67],v24,34816
M v[104:107],a[100:103],v[144:147],v[104:107]
T a[68:69],v24,36864
T a[70:71],v24,38912
M v[104:107],a[104:107],v[160:163],v[104:107]
MF v86,v6,v86
MF v87,v6,v87
M v[104:107],a[108:111],v[176:179],v[104:107]
T a[72:73],v24,40960
T a[74:75],v24,43008
M v[104:107],a[112:115],v[192:195],v[104:107]
T a[76:77],v24,45056
T a[78:79],v24,47104
M v[104:107],a[116:119],v[208:211],v[104:107]
MF v92,v6,v92
MF v93,v6,v93
M v[104:107],a[120:123],v[224:227],v[104:107]
T a[80:81],v24,49152
T a[82:83],v24,51200
M v[104:107],a[124:127],v[240:243],v[104:107]
T a[84:85],v24,53248
T a[86:87],v24,55296
M v[108:111],a[124:127],v[244:247],0
MF v94,v6,v94
MF v95,v6,v95
M v[108:111],a[120:123],v[228:231],v[108:111]
T a[88:89],v24,57344
T a[90:91],v24,59392
M v[108:111],a[116:119],v[212:215],v[108:111]
T a[92:93],v24,61440
T a[94:95],v24,63488
M v[108:111],a[112:115],v[196:199],v[108:111]
C v84,v84,v85
C v85,v86,v87
M v[108:111],a[108:111],v[180:183],v[108:111]
C v86,v92,v93
C v87,v94,v95
M v[108:111],a[104:107],v[164:167],v[108:111]
buffer_store_dwordx4 v[84:87], v7, s[8:11], s30 offen offset:1024 sc1
M v[108:111],a[100:103],v[148:151],v[108:111]
SA s29,s33,10240
M v[108:111],a[96:99],v[132:135],v[108:111]
s_waitcnt lgkmcnt(0)
M v[112:115],a[64:67],v[128:131],0
SA s30,s33,24576
T a[96:97],v25,32768
T a[98:99],v25,34816
M v[112:115],a[68:71],v[144:147],v[112:115]
T a[100:101],v25,36864
T a[102:103],v25,38912
M v[112:115],a[72:75],v[160:163],v[112:115]
MF v96,v5,v96
MF v97,v5,v97
M v[112:115],a[76:79],v[176:179],v[112:115]
T a[104:105],v25,40960
T a[106:107],v25,43008
M v[112:115],a[80:83],v[192:195],v[112:115]
T a[108:109],v25,45056
T a[110:111],v25,47104
M v[112:115],a[84:87],v[208:211],v[112:115]
MF v98,v5,v98
MF v99,v5,v99
M v[112:115],a[88:91],v[224:227],v[112:115]
T a[112:113],v25,49152
T a[114:115],v25,51200
M v[112:115],a[92:95],v[240:243],v[112:115]
T a[116:117],v25,53248
T a[118:119],v25,55296
M v[116:119],a[92:95],v[244:247],0
s_cmp_lt_u32 s42, 8
MF v104,v5,v104
MF v105,v5,v105
M v[116:119],a[88:91],v[228:231],v[116:119]
s_cselect_b32 s84, s45, 536870912
T a[120:121],v25,57344
T a[122:123],v25,59392
M v[116:119],a[84:87],v[212:215],v[116:119]
T a[124:125],v25,61440
T a[126:127],v25,63488
M v[116:119],a[80:83],v[196:199],v[116:119]
MF v106,v5,v106
MF v107,v5,v107
M v[116:119],a[76:79],v[180:183],v[116:119]
C v96,v96,v97
C v97,v98,v99
M v[116:119],a[72:75],v[164:167],v[116:119]
C v98,v104,v105
C v99,v106,v107
M v[116:119],a[68:71],v[148:151],v[116:119]
s_waitcnt lgkmcnt(0)
buffer_store_dwordx4 v[96:99], v7, s[8:11], s29 offen offset:0 sc1
M v[116:119],a[64:67],v[132:135],v[116:119]
s_barrier
M v[120:123],a[96:99],v[128:131],0
s_nop 0
T a[64:65],v18,32768
T a[66:67],v18,34816
M v[120:123],a[100:103],v[144:147],v[120:123]
T a[68:69],v18,36864
T a[70:71],v18,38912
M v[120:123],a[104:107],v[160:163],v[120:123]
MF v100,v6,v100
MF v101,v6,v101
M v[120:123],a[108:111],v[176:179],v[120:123]
T a[72:73],v18,40960
T a[74:75],v18,43008
M v[120:123],a[112:115],v[192:195],v[120:123]
s_waitcnt vmcnt(9)
T a[76:77],v18,45056
T a[78:79],v18,47104
M v[120:123],a[116:119],v[208:211],v[120:123]
buffer_store_dword v15, v17, s[8:11], s84 offen sc1
M v[120:123],a[120:123],v[224:227],v[120:123]
s_nop 0
T a[80:81],v18,49152
T a[82:83],v18,51200
M v[120:123],a[124:127],v[240:243],v[120:123]
T a[84:85],v18,53248
T a[86:87],v18,55296
M v[124:127],a[124:127],v[244:247],0
MF v102,v6,v102
MF v103,v6,v103
M v[124:127],a[120:123],v[228:231],v[124:127]
T a[88:89],v18,57344
T a[90:91],v18,59392
M v[124:127],a[116:119],v[212:215],v[124:127]
T a[92:93],v18,61440
T a[94:95],v18,63488
M v[124:127],a[112:115],v[196:199],v[124:127]
MF v108,v6,v108
MF v109,v6,v109
M v[124:127],a[108:111],v[180:183],v[124:127]
MF v110,v6,v110
MF v111,v6,v111
M v[124:127],a[104:107],v[164:167],v[124:127]
C v100,v100,v101
C v101,v102,v103
M v[124:127],a[100:103],v[148:151],v[124:127]
s_waitcnt lgkmcnt(0)
C v102,v108,v109
C v103,v110,v111
M v[124:127],a[96:99],v[132:135],v[124:127]
buffer_store_dwordx4 v[100:103], v7, s[8:11], s30 offen offset:0 sc1
M v[64:67],a[64:67],v[128:131],0
s_nop 0
T a[96:97],v19,32768
T a[98:99],v19,34816
M v[64:67],a[68:71],v[144:147],v[64:67]
T a[100:101],v19,36864
T a[102:103],v19,38912
M v[64:67],a[72:75],v[160:163],v[64:67]
MF v112,v5,v112
MF v113,v5,v113
M v[64:67],a[76:79],v[176:179],v[64:67]
T a[104:105],v19,40960
T a[106:107],v19,43008
M v[64:67],a[80:83],v[192:195],v[64:67]
T a[108:109],v19,45056
T a[110:111],v19,47104
M v[64:67],a[84:87],v[208:211],v[64:67]
MF v114,v5,v114
MF v115,v5,v115
M v[64:67],a[88:91],v[224:227],v[64:67]
T a[112:113],v19,49152
T a[114:115],v19,51200
M v[64:67],a[92:95],v[240:243],v[64:67]
T a[116:117],v19,53248
T a[118:119],v19,55296
M v[68:71],a[92:95],v[244:247],0
MF v120,v5,v120
MF v121,v5,v121
M v[68:71],a[88:91],v[228:231],v[68:71]
T a[120:121],v19,57344
T a[122:123],v19,59392
M v[68:71],a[84:87],v[212:215],v[68:71]
T a[124:125],v19,61440
T a[126:127],v19,63488
M v[68:71],a[80:83],v[196:199],v[68:71]
MF v122,v5,v122
MF v123,v5,v123
M v[68:71],a[76:79],v[180:183],v[68:71]
C v112,v112,v113
C v113,v114,v115
M v[68:71],a[72:75],v[164:167],v[68:71]
C v114,v120,v121
C v115,v122,v123
M v[68:71],a[68:71],v[148:151],v[68:71]
buffer_store_dwordx4 v[112:115], v7, s[8:11], s29 offen offset:1024 sc1
M v[68:71],a[64:67],v[132:135],v[68:71]
s_waitcnt lgkmcnt(0)
MF v116,v6,v116
MF v117,v6,v117
M v[72:75],a[96:99],v[128:131],0
T a[64:65],v20,32768
T a[66:67],v20,34816
M v[72:75],a[100:103],v[144:147],v[72:75]
T a[68:69],v20,36864
T a[70:71],v20,38912
M v[72:75],a[104:107],v[160:163],v[72:75]
MF v118,v6,v118
MF v119,v6,v119
M v[72:75],a[108:111],v[176:179],v[72:75]
T a[72:73],v20,40960
T a[74:75],v20,43008
M v[72:75],a[112:115],v[192:195],v[72:75]
T a[76:77],v20,45056
T a[78:79],v20,47104
M v[72:75],a[116:119],v[208:211],v[72:75]
MF v124,v6,v124
MF v125,v6,v125
M v[72:75],a[120:123],v[224:227],v[72:75]
T a[80:81],v20,49152
T a[82:83],v20,51200
M v[72:75],a[124:127],v[240:243],v[72:75]
T a[84:85],v20,53248
T a[86:87],v20,55296
M v[76:79],a[124:127],v[244:247],0
MF v126,v6,v126
MF v127,v6,v127
M v[76:79],a[120:123],v[228:231],v[76:79]
T a[88:89],v20,57344
T a[90:91],v20,59392
M v[76:79],a[116:119],v[212:215],v[76:79]
T a[92:93],v20,61440
T a[94:95],v20,63488
M v[76:79],a[112:115],v[196:199],v[76:79]
C v116,v116,v117
C v117,v118,v119
M v[76:79],a[108:111],v[180:183],v[76:79]
C v118,v124,v125
C v119,v126,v127
M v[76:79],a[104:107],v[164:167],v[76:79]
buffer_store_dwordx4 v[116:119], v7, s[8:11], s30 offen offset:1024 sc1
M v[76:79],a[100:103],v[148:151],v[76:79]
SA s29,s33,12288
s_waitcnt vmcnt(12)
v_readlane_b32 s92, v31, 0
v_readlane_b32 s94, v31, 1
M v[76:79],a[96:99],v[132:135],v[76:79]
s_waitcnt lgkmcnt(0)
s_waitcnt vmcnt(9)
v_sub_f32 v30, 1.0, v26
s_waitcnt vmcnt(7)
v_lshlrev_b32 v48, 16, v44
M v[80:83],a[64:67],v[128:131],0
SA s30,s33,26624
T a[96:97],v21,32768
T a[98:99],v21,34816
M v[80:83],a[68:71],v[144:147],v[80:83]
T a[100:101],v21,36864
T a[102:103],v21,38912
M v[80:83],a[72:75],v[160:163],v[80:83]
v_and_b32 v49, 0xffff0000, v44
v_lshlrev_b32 v50, 16, v45
M v[80:83],a[76:79],v[176:179],v[80:83]
T a[104:105],v21,40960
T a[106:107],v21,43008
M v[80:83],a[80:83],v[192:195],v[80:83]
T a[108:109],v21,45056
T a[110:111],v21,47104
M v[80:83],a[84:87],v[208:211],v[80:83]
MF v64,v5,v64
MF v65,v5,v65
M v[80:83],a[88:91],v[224:227],v[80:83]
T a[112:113],v21,49152
T a[114:115],v21,51200
M v[80:83],a[92:95],v[240:243],v[80:83]
T a[116:117],v21,53248
T a[118:119],v21,55296
M v[84:87],a[92:95],v[244:247],0
MF v66,v5,v66
MF v67,v5,v67
M v[84:87],a[88:91],v[228:231],v[84:87]
T a[120:121],v21,57344
T a[122:123],v21,59392
M v[84:87],a[84:87],v[212:215],v[84:87]
T a[124:125],v21,61440
T a[126:127],v21,63488
M v[84:87],a[80:83],v[196:199],v[84:87]
MF v72,v5,v72
MF v73,v5,v73
M v[84:87],a[76:79],v[180:183],v[84:87]
MF v74,v5,v74
MF v75,v5,v75
M v[84:87],a[72:75],v[164:167],v[84:87]
C v64,v64,v65
C v65,v66,v67
M v[84:87],a[68:71],v[148:151],v[84:87]
C v66,v72,v73
C v67,v74,v75
M v[84:87],a[64:67],v[132:135],v[84:87]
s_waitcnt lgkmcnt(0)
buffer_store_dwordx4 v[64:67], v7, s[8:11], s29 offen offset:0 sc1
M v[88:91],a[96:99],v[128:131],0
v_and_b32 v51, 0xffff0000, v45
v_lshlrev_b32 v52, 16, v46
M v[88:91],a[100:103],v[144:147],v[88:91]
MF v68,v6,v68
MF v69,v6,v69
M v[88:91],a[104:107],v[160:163],v[88:91]
MF v70,v6,v70
MF v71,v6,v71
M v[88:91],a[108:111],v[176:179],v[88:91]
MF v76,v6,v76
MF v77,v6,v77
M v[88:91],a[112:115],v[192:195],v[88:91]
MF v78,v6,v78
MF v79,v6,v79
M v[88:91],a[116:119],v[208:211],v[88:91]
C v68,v68,v69
C v69,v70,v71
M v[88:91],a[120:123],v[224:227],v[88:91]
C v70,v76,v77
C v71,v78,v79
M v[88:91],a[124:127],v[240:243],v[88:91]
buffer_store_dwordx4 v[68:71], v7, s[8:11], s30 offen offset:0 sc1
M v[92:95],a[124:127],v[244:247],0
v_and_b32 v53, 0xffff0000, v46
v_lshlrev_b32 v54, 16, v47
M v[92:95],a[120:123],v[228:231],v[92:95]
v_and_b32 v55, 0xffff0000, v47
v_cmp_eq_u32 s[80:81], s92, v29
M v[92:95],a[116:119],v[212:215],v[92:95]
v_cmp_eq_u32 s[82:83], s94, v29
M v[92:95],a[112:115],v[196:199],v[92:95]
MF v80,v5,v80
MF v81,v5,v81
M v[92:95],a[108:111],v[180:183],v[92:95]
MF v82,v5,v82
MF v83,v5,v83
M v[92:95],a[104:107],v[164:167],v[92:95]
MF v88,v5,v88
MF v89,v5,v89
M v[92:95],a[100:103],v[148:151],v[92:95]
MF v90,v5,v90
MF v91,v5,v91
M v[92:95],a[96:99],v[132:135],v[92:95]
C v80,v80,v81
C v81,v82,v83
C v82,v88,v89
C v83,v90,v91
buffer_store_dwordx4 v[80:83], v7, s[8:11], s29 offen offset:1024 sc1
MF v84,v6,v84
MF v85,v6,v85
MF v86,v6,v86
MF v87,v6,v87
MF v92,v6,v92
MF v93,v6,v93
MF v94,v6,v94
MF v95,v6,v95
C v84,v84,v85
C v85,v86,v87
C v86,v92,v93
C v87,v94,v95
buffer_store_dwordx4 v[84:87], v7, s[8:11], s30 offen offset:1024 sc1
buffer_load_dword v9, v33, s[8:11], s46 offen sc1
s_waitcnt vmcnt(1)
buffer_store_dword v15, v16, s[8:11], s3 offen sc1
s_cmp_lt_u32 s42, 8
s_cbranch_scc1 L_red
s_waitcnt vmcnt(1)
v_cmp_eq_u32 vcc, 1, v9
s_mov_b32 s91, 65536
s_lshl_b32 s70, 1, s41
s_mov_b32 s69, 0xffff
s_or_b32 s70, s70, vcc_lo
s_mov_b32 s68, s70
s_barrier
s_cmp_lg_u32 s70, 0
s_cbranch_scc1 L_vk0
s_call_b64 s[36:37], L_rpoll
L_vk0:
s_ff1_i32_b32 s71, s70
s_bitset0_b32 s70, s71
s_mul_i32 s71, s71, 114688
SA s16,s71,s78
buffer_load_dwordx4 v[128:131], v27, s[8:11], s16 offen sc1
s_cmp_lg_u32 s70, 0
s_cbranch_scc1 L_vk1
s_call_b64 s[36:37], L_rpoll
L_vk1:
s_ff1_i32_b32 s71, s70
s_bitset0_b32 s70, s71
s_mul_i32 s71, s71, 114688
SA s17,s71,s78
buffer_load_dwordx4 v[132:135], v27, s[8:11], s17 offen sc1
s_cmp_lg_u32 s70, 0
s_cbranch_scc1 L_vk2
s_call_b64 s[36:37], L_rpoll
L_vk2:
s_ff1_i32_b32 s71, s70
s_bitset0_b32 s70, s71
s_mul_i32 s71, s71, 114688
SA s18,s71,s78
buffer_load_dwordx4 v[136:139], v27, s[8:11], s18 offen sc1
s_cmp_lg_u32 s70, 0
s_cbranch_scc1 L_vk3
s_call_b64 s[36:37], L_rpoll
L_vk3:
s_ff1_i32_b32 s71, s70
s_bitset0_b32 s70, s71
s_mul_i32 s71, s71, 114688
SA s19,s71,s78
buffer_load_dwordx4 v[140:143], v27, s[8:11], s19 offen sc1
s_cmp_lg_u32 s70, 0
s_cbranch_scc1 L_vk4
s_call_b64 s[36:37], L_rpoll
L_vk4:
s_ff1_i32_b32 s71, s70
s_bitset0_b32 s70, s71
s_mul_i32 s71, s71, 114688
SA s48,s71,s78
buffer_load_dwordx4 v[144:147], v27, s[8:11], s48 offen sc1
s_cmp_lg_u32 s70, 0
s_cbranch_scc1 L_vk5
s_call_b64 s[36:37], L_rpoll
L_vk5:
s_ff1_i32_b32 s71, s70
s_bitset0_b32 s70, s71
s_mul_i32 s71, s71, 114688
SA s49,s71,s78
buffer_load_dwordx4 v[148:151], v27, s[8:11], s49 offen sc1
s_cmp_lg_u32 s70, 0
s_cbranch_scc1 L_vk6
s_call_b64 s[36:37], L_rpoll
L_vk6:
s_ff1_i32_b32 s71, s70
s_bitset0_b32 s70, s71
s_mul_i32 s71, s71, 114688
SA s50,s71,s78
buffer_load_dwordx4 v[152:155], v27, s[8:11], s50 offen sc1
s_cmp_lg_u32 s70, 0
s_cbranch_scc1 L_vk7
s_call_b64 s[36:37], L_rpoll
L_vk7:
s_ff1_i32_b32 s71, s70
s_bitset0_b32 s70, s71
s_mul_i32 s71, s71, 114688
SA s51,s71,s78
buffer_load_dwordx4 v[156:159], v27, s[8:11], s51 offen sc1
s_or_b64 vcc, s[80:81], s[82:83]
s_cbranch_vccnz L_moe2
L_moe_ret2:
MF v48,v30,v48
MF v49,v30,v49
MF v50,v30,v50
MF v51,v30,v51
MF v52,v30,v52
MF v53,v30,v53
MF v54,v30,v54
MF v55,v30,v55
s_cmp_lg_u32 s70, 0
s_cbranch_scc1 L_vk8
s_call_b64 s[36:37], L_rpoll
L_vk8:
s_ff1_i32_b32 s71, s70
s_bitset0_b32 s70, s71
s_mul_i32 s71, s71, 114688
SA s21,s71,s78
buffer_load_dwordx4 v[160:163], v27, s[8:11], s21 offen sc1
s_waitcnt vmcnt(8)
M v[56:59],a[246:249],v[128:131],0
M v[60:63],a[244:247],v[128:131],0
s_cmp_lg_u32 s70, 0
s_cbranch_scc1 L_vk9
s_call_b64 s[36:37], L_rpoll
L_vk9:
s_ff1_i32_b32 s71, s70
s_bitset0_b32 s70, s71
s_mul_i32 s71, s71, 114688
SA s22,s71,s78
buffer_load_dwordx4 v[164:167], v27, s[8:11], s22 offen sc1
s_waitcnt vmcnt(8)
M v[56:59],a[246:249],v[132:135],v[56:59]
M v[60:63],a[244:247],v[132:135],v[60:63]
s_cmp_lg_u32 s70, 0
s_cbranch_scc1 L_vk10
s_call_b64 s[36:37], L_rpoll
L_vk10:
s_ff1_i32_b32 s71, s70
s_bitset0_b32 s70, s71
s_mul_i32 s71, s71, 114688
SA s23,s71,s78
buffer_load_dwordx4 v[168:171], v27, s[8:11], s23 offen sc1
s_waitcnt vmcnt(8)
M v[56:59],a[246:249],v[136:139],v[56:59]
M v[60:63],a[244:247],v[136:139],v[60:63]
s_cmp_lg_u32 s70, 0
s_cbranch_scc1 L_vk11
s_call_b64 s[36:37], L_rpoll
L_vk11:
s_ff1_i32_b32 s71, s70
s_bitset0_b32 s70, s71
s_mul_i32 s71, s71, 114688
SA s24,s71,s78
buffer_load_dwordx4 v[172:175], v27, s[8:11], s24 offen sc1
s_waitcnt vmcnt(8)
M v[56:59],a[246:249],v[140:143],v[56:59]
M v[60:63],a[244:247],v[140:143],v[60:63]
s_cmp_lg_u32 s70, 0
s_cbranch_scc1 L_vk12
s_call_b64 s[36:37], L_rpoll
L_vk12:
s_ff1_i32_b32 s71, s70
s_bitset0_b32 s70, s71
s_mul_i32 s71, s71, 114688
SA s25,s71,s78
buffer_load_dwordx4 v[176:179], v27, s[8:11], s25 offen sc1
s_waitcnt vmcnt(8)
M v[56:59],a[246:249],v[144:147],v[56:59]
M v[60:63],a[244:247],v[144:147],v[60:63]
s_cmp_lg_u32 s70, 0
s_cbranch_scc1 L_vk13
s_call_b64 s[36:37], L_rpoll
L_vk13:
s_ff1_i32_b32 s71, s70
s_bitset0_b32 s70, s71
s_mul_i32 s71, s71, 114688
SA s26,s71,s78
buffer_load_dwordx4 v[180:183], v27, s[8:11], s26 offen sc1
s_waitcnt vmcnt(8)
M v[56:59],a[246:249],v[148:151],v[56:59]
M v[60:63],a[244:247],v[148:151],v[60:63]
s_cmp_lg_u32 s70, 0
s_cbranch_scc1 L_vk14
s_call_b64 s[36:37], L_rpoll
L_vk14:
s_ff1_i32_b32 s71, s70
s_bitset0_b32 s70, s71
s_mul_i32 s71, s71, 114688
SA s27,s71,s78
buffer_load_dwordx4 v[184:187], v27, s[8:11], s27 offen sc1
s_waitcnt vmcnt(8)
M v[56:59],a[246:249],v[152:155],v[56:59]
M v[60:63],a[244:247],v[152:155],v[60:63]
s_cmp_lg_u32 s70, 0
s_cbranch_scc1 L_vk15
s_call_b64 s[36:37], L_rpoll
L_vk15:
s_ff1_i32_b32 s71, s70
s_bitset0_b32 s70, s71
s_mul_i32 s71, s71, 114688
SA s28,s71,s78
buffer_load_dwordx4 v[188:191], v27, s[8:11], s28 offen sc1
s_waitcnt vmcnt(8)
M v[56:59],a[246:249],v[156:159],v[56:59]
M v[60:63],a[244:247],v[156:159],v[60:63]
s_waitcnt vmcnt(7)
M v[56:59],a[246:249],v[160:163],v[56:59]
M v[60:63],a[244:247],v[160:163],v[60:63]
s_waitcnt vmcnt(6)
M v[56:59],a[246:249],v[164:167],v[56:59]
M v[60:63],a[244:247],v[164:167],v[60:63]
s_waitcnt vmcnt(5)
M v[56:59],a[246:249],v[168:171],v[56:59]
M v[60:63],a[244:247],v[168:171],v[60:63]
s_waitcnt vmcnt(4)
M v[56:59],a[246:249],v[172:175],v[56:59]
M v[60:63],a[244:247],v[172:175],v[60:63]
s_waitcnt vmcnt(3)
M v[56:59],a[246:249],v[176:179],v[56:59]
M v[60:63],a[244:247],v[176:179],v[60:63]
s_waitcnt vmcnt(2)
M v[56:59],a[246:249],v[180:183],v[56:59]
M v[60:63],a[244:247],v[180:183],v[60:63]
s_waitcnt vmcnt(1)
M v[56:59],a[246:249],v[184:187],v[56:59]
M v[60:63],a[244:247],v[184:187],v[60:63]
s_waitcnt vmcnt(0)
M v[56:59],a[246:249],v[188:191],v[56:59]
M v[60:63],a[244:247],v[188:191],v[60:63]
s_nop 7
v_permlane16_swap_b32 v56, v60
v_permlane16_swap_b32 v57, v61
v_permlane16_swap_b32 v58, v62
v_permlane16_swap_b32 v59, v63
v_fmac_f32 v48, v26, v56
v_fmac_f32 v49, v26, v57
v_fmac_f32 v50, v26, v58
v_fmac_f32 v51, v26, v59
v_fmac_f32 v52, v26, v60
v_fmac_f32 v53, v26, v61
v_fmac_f32 v54, v26, v62
v_fmac_f32 v55, v26, v63
C v44,v48,v49
C v45,v50,v51
C v46,v52,v53
C v47,v54,v55
buffer_store_dwordx4 v[44:47], v28, s[52:55], s79 offen sc1
s_endpgm
L_d2h:
M v[128:131],a[64:67],v[48:51],v[128:131]
R a[96:99],v7,40960
R a[100:103],v7,41984
M v[128:131],a[68:71],v[56:59],v[128:131]
SA m0,s28,135168
E v18,v64
M v[132:135],a[68:71],v[60:63],v[132:135]
buffer_load_dwordx4 v4, s[8:11], s26 offen offset:0 sc1 lds
M v[132:135],a[64:67],v[52:55],v[132:135]
R a[104:107],v7,43008
R a[108:111],v7,44032
M v[140:143],a[72:75],v[52:55],v[140:143]
s_cmp_gt_u32 s20, 3
E v19,v65
M v[140:143],a[76:79],v[60:63],v[140:143]
s_cselect_b64 s[82:83], -1, 0
AF v30,v28,v30
AF v31,v29,v31
M v[136:139],a[76:79],v[56:59],v[136:139]
s_cmp_eq_u32 s20, 3
R a[112:115],v7,45056
R a[116:119],v7,46080
M v[136:139],a[72:75],v[48:51],v[136:139]
s_cselect_b64 s[66:67], s[16:17], s[82:83]
buffer_load_dwordx4 v4, s[8:11], s26 offen offset:1024 sc1 lds
M v[144:147],a[80:83],v[48:51],v[144:147]
s_cselect_b64 s[68:69], s[18:19], s[82:83]
E v20,v66
M v[144:147],a[84:87],v[56:59],v[144:147]
s_cselect_b64 s[70:71], s[48:49], s[82:83]
R a[120:123],v7,47104
R a[124:127],v7,48128
M v[148:151],a[84:87],v[60:63],v[148:151]
s_cselect_b64 s[72:73], s[50:51], s[82:83]
v_cndmask_b32 v100, v36, v8, s[66:67]
v_cndmask_b32 v101, v36, v8, s[68:69]
M v[148:151],a[80:83],v[52:55],v[148:151]
buffer_load_dwordx4 v4, s[8:11], s26 offen offset:2048 sc1 lds
M v[156:159],a[88:91],v[52:55],v[156:159]
v_cndmask_b32 v102, v36, v8, s[70:71]
AF v26,v18,v19
M v[156:159],a[92:95],v[60:63],v[156:159]
E v21,v67
M v[152:155],a[92:95],v[56:59],v[152:155]
v_cndmask_b32 v103, v36, v8, s[72:73]
C v40,v18,v19
M v[152:155],a[88:91],v[48:51],v[152:155]
s_waitcnt lgkmcnt(0)
buffer_load_dwordx4 v4, s[8:11], s26 offen offset:3072 sc1 lds
M v[160:163],a[96:99],v[48:51],v[160:163]
s_cmp_gt_u32 s20, 2
R a[64:67],v7,49152
R a[68:71],v7,50176
M v[160:163],a[100:103],v[56:59],v[160:163]
s_cselect_b64 s[82:83], -1, 0
E v22,v72
M v[164:167],a[100:103],v[60:63],v[164:167]
s_cmp_eq_u32 s20, 2
AF v26,v20,v26
C v41,v20,v21
M v[164:167],a[96:99],v[52:55],v[164:167]
s_mul_i32 s21, s41, 1048576
R a[72:75],v7,51200
R a[76:79],v7,52224
M v[172:175],a[104:107],v[52:55],v[172:175]
s_cselect_b64 s[74:75], s[16:17], s[82:83]
E v23,v73
M v[172:175],a[108:111],v[60:63],v[172:175]
s_cselect_b64 s[76:77], s[18:19], s[82:83]
AF v26,v21,v26
AF v26,v22,v26
M v[168:171],a[108:111],v[56:59],v[168:171]
s_cselect_b64 s[78:79], s[48:49], s[82:83]
R a[80:83],v7,53248
R a[84:87],v7,54272
M v[168:171],a[104:107],v[48:51],v[168:171]
s_cselect_b64 s[80:81], s[50:51], s[82:83]
v_cndmask_b32 v108, v36, v8, s[74:75]
v_cndmask_b32 v109, v36, v8, s[76:77]
M v[176:179],a[112:115],v[48:51],v[176:179]
SA s21,s21,589824
E v24,v74
M v[176:179],a[116:119],v[56:59],v[176:179]
s_lshl_b32 s84, s42, 1
R a[88:91],v7,55296
R a[92:95],v7,56320
M v[180:183],a[116:119],v[60:63],v[180:183]
s_sub_u32 s22, 11, s84
v_cndmask_b32 v110, v36, v8, s[78:79]
C v42,v22,v23
M v[180:183],a[112:115],v[52:55],v[180:183]
s_mov_b32 s23, 536870912
s_waitcnt vmcnt(16)
v_cmp_gt_u32 vcc, 2, v5
AF v26,v23,v26
M v[188:191],a[120:123],v[52:55],v[188:191]
s_cbranch_vccnz L_lsh2
L_lrh2:
v_cndmask_b32 v111, v36, v8, s[80:81]
M v[188:191],a[124:127],v[60:63],v[188:191]
SA m0,s28,98304
E v25,v75
M v[184:187],a[124:127],v[56:59],v[184:187]
s_cmp_gt_u32 s20, 1
buffer_load_dwordx4 v3, s[8:11], s21 offen offset:0 sc1 lds
M v[184:187],a[120:123],v[48:51],v[184:187]
s_waitcnt lgkmcnt(0)
E v18,v68
M v[192:195],a[64:67],v[48:51],v[192:195]
s_cselect_b64 s[82:83], -1, 0
R a[96:99],v7,57344
R a[100:103],v7,58368
M v[192:195],a[68:71],v[56:59],v[192:195]
s_cmp_eq_u32 s20, 1
buffer_load_dwordx4 v3, s[8:11], s21 offen offset:1024 sc1 lds
M v[196:199],a[68:71],v[60:63],v[196:199]
s_cselect_b64 s[66:67], s[16:17], s[82:83]
E v19,v69
M v[196:199],a[64:67],v[52:55],v[196:199]
s_cselect_b64 s[68:69], s[18:19], s[82:83]
R a[104:107],v7,59392
R a[108:111],v7,60416
M v[204:207],a[72:75],v[52:55],v[204:207]
s_cselect_b64 s[70:71], s[48:49], s[82:83]
buffer_load_dwordx4 v3, s[8:11], s21 offen offset:2048 sc1 lds
M v[204:207],a[76:79],v[60:63],v[204:207]
s_cselect_b64 s[72:73], s[50:51], s[82:83]
v_cndmask_b32 v116, v36, v8, s[66:67]
v_cndmask_b32 v117, v36, v8, s[68:69]
M v[200:203],a[76:79],v[56:59],v[200:203]
R a[112:115],v7,61440
R a[116:119],v7,62464
M v[200:203],a[72:75],v[48:51],v[200:203]
v_cndmask_b32 v118, v36, v8, s[70:71]
AF v26,v24,v26
M v[208:211],a[80:83],v[48:51],v[208:211]
buffer_load_dwordx4 v3, s[8:11], s21 offen offset:3072 sc1 lds
M v[208:211],a[84:87],v[56:59],v[208:211]
SA m0,s28,102400
R a[120:123],v7,63488
R a[124:127],v7,64512
M v[212:215],a[84:87],v[60:63],v[212:215]
v_cndmask_b32 v119, v36, v8, s[72:73]
C v43,v24,v25
M v[212:215],a[80:83],v[52:55],v[212:215]
s_cmp_gt_u32 s20, 0
E v20,v70
M v[220:223],a[88:91],v[52:55],v[220:223]
s_cselect_b64 s[82:83], -1, 0
buffer_load_dwordx4 v4, s[8:11], s21 offen offset:0 sc1 lds
M v[220:223],a[92:95],v[60:63],v[220:223]
s_cmp_eq_u32 s20, 0
E v21,v71
M v[216:219],a[92:95],v[56:59],v[216:219]
s_waitcnt lgkmcnt(0)
E v22,v76
M v[216:219],a[88:91],v[48:51],v[216:219]
s_barrier
M v[224:227],a[96:99],v[48:51],v[224:227]
s_cselect_b64 s[74:75], s[16:17], s[82:83]
R a[64:67],v2,0
R a[68:71],v2,1024
M v[224:227],a[100:103],v[56:59],v[224:227]
s_cselect_b64 s[76:77], s[18:19], s[82:83]
buffer_load_dwordx4 v4, s[8:11], s21 offen offset:1024 sc1 lds
M v[228:231],a[100:103],v[60:63],v[228:231]
s_cselect_b64 s[78:79], s[48:49], s[82:83]
E v23,v77
M v[228:231],a[96:99],v[52:55],v[228:231]
s_cselect_b64 s[80:81], s[50:51], s[82:83]
R a[72:75],v2,2048
R a[76:79],v2,3072
M v[236:239],a[104:107],v[52:55],v[236:239]
v_cndmask_b32 v124, v36, v8, s[74:75]
v_cndmask_b32 v125, v36, v8, s[76:77]
M v[236:239],a[108:111],v[60:63],v[236:239]
buffer_load_dwordx4 v4, s[8:11], s21 offen offset:2048 sc1 lds
M v[232:235],a[108:111],v[56:59],v[232:235]
R a[80:83],v2,4096
R a[84:87],v2,5120
M v[232:235],a[104:107],v[48:51],v[232:235]
v_cndmask_b32 v126, v36, v8, s[78:79]
AF v26,v25,v26
M v[240:243],a[112:115],v[48:51],v[240:243]
v_cndmask_b32 v127, v36, v8, s[80:81]
AF v27,v18,v19
M v[240:243],a[116:119],v[56:59],v[240:243]
R a[88:91],v2,6144
R a[92:95],v2,7168
M v[244:247],a[116:119],v[60:63],v[244:247]
buffer_load_dwordx4 v4, s[8:11], s21 offen offset:3072 sc1 lds
M v[244:247],a[112:115],v[52:55],v[244:247]
SA s21,s21,32768
E v24,v78
M v[252:255],a[120:123],v[52:55],v[252:255]
s_sub_u32 s22, s22, 1
E v25,v79
M v[252:255],a[124:127],v[60:63],v[252:255]
s_cselect_b32 s21, s23, s21
C v44,v18,v19
AF v27,v20,v27
M v[248:251],a[124:127],v[56:59],v[248:251]
s_waitcnt lgkmcnt(0)
C v45,v20,v21
AF v27,v21,v27
M v[248:251],a[120:123],v[48:51],v[248:251]
AF v27,v22,v27
C v46,v22,v23
AF v27,v23,v27
AF v27,v24,v27
C v47,v24,v25
AF v27,v25,v27
L_d3h:
M v[100:103],a[64:67],a[32:35],v[100:103]
R a[96:99],v2,8192
R a[100:103],v2,9216
M v[100:103],a[68:71],a[36:39],v[100:103]
R a[104:107],v2,10240
R a[108:111],v2,11264
M v[100:103],a[72:75],a[40:43],v[100:103]
R a[112:115],v2,12288
R a[116:119],v2,13312
M v[100:103],a[76:79],a[44:47],v[100:103]
R a[120:123],v2,14336
R a[124:127],v2,15360
M v[100:103],a[80:83],a[48:51],v[100:103]
v_add_u32 v8, 0x20000, v7
M v[100:103],a[84:87],a[52:55],v[100:103]
buffer_load_dword v5, v9, s[8:11], s46 offen sc1
M v[100:103],a[88:91],a[56:59],v[100:103]
buffer_load_dword v6, off, s[8:11], s47 offset:16 sc1
M v[100:103],a[92:95],a[60:63],v[100:103]
s_waitcnt lgkmcnt(0)
E v18,v80
M v[108:111],a[96:99],a[32:35],v[108:111]
R a[64:67],v2,16384
R a[68:71],v2,17408
M v[108:111],a[100:103],a[36:39],v[108:111]
R a[72:75],v2,18432
R a[76:79],v2,19456
M v[108:111],a[104:107],a[40:43],v[108:111]
R a[80:83],v2,20480
R a[84:87],v2,21504
M v[108:111],a[108:111],a[44:47],v[108:111]
R a[88:91],v2,22528
R a[92:95],v2,23552
M v[108:111],a[112:115],a[48:51],v[108:111]
E v19,v81
M v[108:111],a[116:119],a[52:55],v[108:111]
E v20,v82
M v[108:111],a[120:123],a[56:59],v[108:111]
E v21,v83
M v[108:111],a[124:127],a[60:63],v[108:111]
s_waitcnt lgkmcnt(0)
E v22,v88
M v[116:119],a[64:67],a[32:35],v[116:119]
R a[96:99],v2,24576
R a[100:103],v2,25600
M v[116:119],a[68:71],a[36:39],v[116:119]
R a[104:107],v2,26624
R a[108:111],v2,27648
M v[116:119],a[72:75],a[40:43],v[116:119]
R a[112:115],v2,28672
R a[116:119],v2,29696
M v[116:119],a[76:79],a[44:47],v[116:119]
R a[120:123],v2,30720
R a[124:127],v2,31744
M v[116:119],a[80:83],a[48:51],v[116:119]
E v23,v89
M v[116:119],a[84:87],a[52:55],v[116:119]
E v24,v90
M v[116:119],a[88:91],a[56:59],v[116:119]
s_waitcnt vmcnt(18) lgkmcnt(0)
E v25,v91
M v[116:119],a[92:95],a[60:63],v[116:119]
s_barrier
M v[124:127],a[96:99],a[32:35],v[124:127]
R a[64:67],v7,0
R a[68:71],v7,1024
M v[124:127],a[100:103],a[36:39],v[124:127]
R a[72:75],v7,2048
R a[76:79],v7,3072
M v[124:127],a[104:107],a[40:43],v[124:127]
R a[80:83],v7,4096
R a[84:87],v7,5120
M v[124:127],a[108:111],a[44:47],v[124:127]
R a[88:91],v7,6144
R a[92:95],v7,7168
M v[124:127],a[112:115],a[48:51],v[124:127]
AF v26,v18,v26
C v56,v18,v19
M v[124:127],a[116:119],a[52:55],v[124:127]
AF v26,v19,v26
AF v26,v20,v26
M v[124:127],a[120:123],a[56:59],v[124:127]
s_waitcnt lgkmcnt(0)
E v18,v84
M v[124:127],a[124:127],a[60:63],v[124:127]
E v19,v85
C v57,v20,v21
AF v26,v21,v26
AF v26,v22,v26
C v58,v22,v23
AF v26,v23,v26
AF v26,v24,v26
C v59,v24,v25
AF v26,v25,v26
E v20,v86
E v21,v87
AF v27,v18,v27
C v60,v18,v19
AF v27,v19,v27
E v22,v92
E v23,v93
AF v27,v20,v27
C v61,v20,v21
AF v27,v21,v27
E v24,v94
E v25,v95
AF v27,v22,v27
C v62,v22,v23
AF v27,v23,v27
AF v27,v24,v27
C v63,v24,v25
AF v27,v25,v27
v_max_f32 v10, v26, v27
v_cmp_lt_f32 vcc, s31, v10
s_nop 0
s_cbranch_vccnz L_std3h
L_rtd3h:
M v[128:131],a[64:67],v[40:43],v[128:131]
R a[96:99],v7,8192
R a[100:103],v7,9216
M v[128:131],a[68:71],v[56:59],v[128:131]
s_waitcnt vmcnt(0)
v_cmp_ne_u32 vcc, 1, v6
AF v30,v26,v30
M v[132:135],a[68:71],v[60:63],v[132:135]
s_cbranch_vccnz L_fqs
L_fqr:
E v18,v100
M v[132:135],a[64:67],v[44:47],v[132:135]
SA s73,s32,4096
R a[104:107],v7,10240
R a[108:111],v7,11264
M v[140:143],a[72:75],v[44:47],v[140:143]
SA s74,s32,8192
E v19,v101
M v[140:143],a[76:79],v[60:63],v[140:143]
SA s75,s32,12288
buffer_load_dwordx4 a[0:3], v7, s[8:11], s32 offen offset:0 sc1
M v[136:139],a[76:79],v[56:59],v[136:139]
R a[112:115],v7,12288
R a[116:119],v7,13312
M v[136:139],a[72:75],v[40:43],v[136:139]
E v20,v102
M v[144:147],a[80:83],v[40:43],v[144:147]
buffer_load_dwordx4 a[4:7], v7, s[8:11], s32 offen offset:1024 sc1
M v[144:147],a[84:87],v[56:59],v[144:147]
R a[120:123],v7,14336
R a[124:127],v7,15360
M v[148:151],a[84:87],v[60:63],v[148:151]
AF v31,v27,v31
AF v29,v18,v19
M v[148:151],a[80:83],v[44:47],v[148:151]
buffer_load_dwordx4 a[8:11], v7, s[8:11], s32 offen offset:2048 sc1
M v[156:159],a[88:91],v[44:47],v[156:159]
E v21,v103
M v[156:159],a[92:95],v[60:63],v[156:159]
C v52,v18,v19
AF v29,v20,v29
M v[152:155],a[92:95],v[56:59],v[152:155]
buffer_load_dwordx4 a[12:15], v7, s[8:11], s32 offen offset:3072 sc1
M v[152:155],a[88:91],v[40:43],v[152:155]
s_waitcnt lgkmcnt(0)
E v22,v108
M v[160:163],a[96:99],v[40:43],v[160:163]
R a[64:67],v7,16384
R a[68:71],v7,17408
M v[160:163],a[100:103],v[56:59],v[160:163]
buffer_load_dwordx4 a[16:19], v7, s[8:11], s73 offen offset:0 sc1
M v[164:167],a[100:103],v[60:63],v[164:167]
E v23,v109
M v[164:167],a[96:99],v[44:47],v[164:167]
R a[72:75],v7,18432
R a[76:79],v7,19456
M v[172:175],a[104:107],v[44:47],v[172:175]
buffer_load_dwordx4 a[20:23], v7, s[8:11], s73 offen offset:1024 sc1
M v[172:175],a[108:111],v[60:63],v[172:175]
C v53,v20,v21
AF v29,v21,v29
M v[168:171],a[108:111],v[56:59],v[168:171]
R a[80:83],v7,20480
R a[84:87],v7,21504
M v[168:171],a[104:107],v[40:43],v[168:171]
buffer_load_dwordx4 a[24:27], v7, s[8:11], s73 offen offset:2048 sc1
M v[176:179],a[112:115],v[40:43],v[176:179]
E v24,v110
M v[176:179],a[116:119],v[56:59],v[176:179]
R a[88:91],v7,22528
R a[92:95],v7,23552
M v[180:183],a[116:119],v[60:63],v[180:183]
buffer_load_dwordx4 a[28:31], v7, s[8:11], s73 offen offset:3072 sc1
M v[180:183],a[112:115],v[44:47],v[180:183]
E v25,v111
M v[188:191],a[120:123],v[44:47],v[188:191]
AF v29,v22,v29
C v54,v22,v23
M v[188:191],a[124:127],v[60:63],v[188:191]
buffer_load_dwordx4 a[32:35], v7, s[8:11], s74 offen offset:0 sc1
M v[184:187],a[124:127],v[56:59],v[184:187]
E v18,v116
M v[184:187],a[120:123],v[40:43],v[184:187]
s_waitcnt lgkmcnt(0)
AF v29,v23,v29
AF v29,v24,v29
M v[192:195],a[64:67],v[40:43],v[192:195]
R a[96:99],v7,24576
R a[100:103],v7,25600
M v[192:195],a[68:71],v[56:59],v[192:195]
buffer_load_dwordx4 a[36:39], v7, s[8:11], s74 offen offset:1024 sc1
M v[196:199],a[68:71],v[60:63],v[196:199]
E v19,v117
M v[196:199],a[64:67],v[44:47],v[196:199]
R a[104:107],v7,26624
R a[108:111],v7,27648
M v[204:207],a[72:75],v[44:47],v[204:207]
buffer_load_dwordx4 a[40:43], v7, s[8:11], s74 offen offset:2048 sc1
M v[204:207],a[76:79],v[60:63],v[204:207]
E v20,v118
M v[200:203],a[76:79],v[56:59],v[200:203]
R a[112:115],v7,28672
R a[116:119],v7,29696
M v[200:203],a[72:75],v[40:43],v[200:203]
buffer_load_dwordx4 a[44:47], v7, s[8:11], s74 offen offset:3072 sc1
M v[208:211],a[80:83],v[40:43],v[208:211]
C v55,v24,v25
AF v29,v25,v29
M v[208:211],a[84:87],v[56:59],v[208:211]
R a[120:123],v7,30720
R a[124:127],v7,31744
M v[212:215],a[84:87],v[60:63],v[212:215]
buffer_load_dwordx4 a[48:51], v7, s[8:11], s75 offen offset:0 sc1
M v[212:215],a[80:83],v[44:47],v[212:215]
E v21,v119
M v[220:223],a[88:91],v[44:47],v[220:223]
AF v29,v18,v29
C v48,v18,v19
M v[220:223],a[92:95],v[60:63],v[220:223]
buffer_load_dwordx4 a[52:55], v7, s[8:11], s75 offen offset:1024 sc1
M v[216:219],a[92:95],v[56:59],v[216:219]
s_waitcnt lgkmcnt(0)
E v22,v124
M v[216:219],a[88:91],v[40:43],v[216:219]
s_barrier
M v[224:227],a[96:99],v[40:43],v[224:227]
R a[64:67],v8,0
R a[68:71],v8,1024
M v[224:227],a[100:103],v[56:59],v[224:227]
buffer_load_dwordx4 a[56:59], v7, s[8:11], s75 offen offset:2048 sc1
M v[228:231],a[100:103],v[60:63],v[228:231]
v_mov_b32 v15, 4
AF v29,v19,v29
M v[228:231],a[96:99],v[44:47],v[228:231]
R a[72:75],v8,2048
R a[76:79],v8,3072
M v[236:239],a[104:107],v[44:47],v[236:239]
buffer_store_dword v15, v1, s[8:11], s45 offen sc1
M v[236:239],a[108:111],v[60:63],v[236:239]
buffer_load_dwordx4 a[60:63], v7, s[8:11], s75 offen offset:3072 sc1
M v[232:235],a[108:111],v[56:59],v[232:235]
s_cmp_ge_u32 s42, 2
R a[80:83],v8,4096
R a[84:87],v8,5120
M v[232:235],a[104:107],v[40:43],v[232:235]
s_cselect_b32 s84, 4, 2
v_cmp_gt_u32 vcc, s84, v5
AF v29,v20,v29
M v[240:243],a[112:115],v[40:43],v[240:243]
s_cbranch_vccnz L_lsh4
L_lrh4:
E v23,v125
M v[240:243],a[116:119],v[56:59],v[240:243]
R a[88:91],v8,6144
R a[92:95],v8,7168
M v[244:247],a[116:119],v[60:63],v[244:247]
E v24,v126
M v[244:247],a[112:115],v[44:47],v[244:247]
E v25,v127
M v[252:255],a[120:123],v[44:47],v[252:255]
C v49,v20,v21
AF v29,v21,v29
M v[252:255],a[124:127],v[60:63],v[252:255]
AF v29,v22,v29
C v50,v22,v23
M v[248:251],a[124:127],v[56:59],v[248:251]
s_waitcnt lgkmcnt(0)
AF v29,v23,v29
AF v29,v24,v29
M v[248:251],a[120:123],v[40:43],v[248:251]
C v51,v24,v25
AF v29,v25,v29
v_cmp_lt_f32 vcc, s31, v29
s_nop 0
s_cbranch_vccnz L_std4h
L_rtd4h:
M v[132:135],a[64:67],v[52:55],v[132:135]
R a[96:99],v8,8192
R a[100:103],v8,9216
M v[132:135],a[68:71],v[48:51],v[132:135]
R a[104:107],v8,10240
R a[108:111],v8,11264
M v[140:143],a[72:75],v[52:55],v[140:143]
SA m0,s28,65536
R a[112:115],v8,12288
R a[116:119],v8,13312
M v[140:143],a[76:79],v[48:51],v[140:143]
R a[120:123],v8,14336
R a[124:127],v8,15360
M v[148:151],a[80:83],v[52:55],v[148:151]
buffer_load_dwordx4 v3, s[8:11], s21 offen offset:0 sc1 lds
M v[148:151],a[84:87],v[48:51],v[148:151]
AF v31,v29,v31
v_mov_b32 v10, v30
M v[156:159],a[88:91],v[52:55],v[156:159]
v_mov_b32 v11, v31
C v128,v128,v129
M v[156:159],a[92:95],v[48:51],v[156:159]
s_waitcnt lgkmcnt(0)
v_permlane16_swap_b32 v10, v30
M v[164:167],a[96:99],v[52:55],v[164:167]
R a[64:67],v8,16384
R a[68:71],v8,17408
M v[164:167],a[100:103],v[48:51],v[164:167]
R a[72:75],v8,18432
R a[76:79],v8,19456
M v[172:175],a[104:107],v[52:55],v[172:175]
R a[80:83],v8,20480
R a[84:87],v8,21504
M v[172:175],a[108:111],v[48:51],v[172:175]
R a[88:91],v8,22528
R a[92:95],v8,23552
M v[180:183],a[112:115],v[52:55],v[180:183]
buffer_load_dwordx4 v3, s[8:11], s21 offen offset:1024 sc1 lds
M v[180:183],a[116:119],v[48:51],v[180:183]
v_permlane16_swap_b32 v11, v31
M v[188:191],a[120:123],v[52:55],v[188:191]
AF v30,v10,v30
AF v31,v11,v31
M v[188:191],a[124:127],v[48:51],v[188:191]
s_waitcnt lgkmcnt(0)
buffer_load_dwordx4 v3, s[8:11], s21 offen offset:2048 sc1 lds
M v[196:199],a[64:67],v[52:55],v[196:199]
R a[96:99],v8,24576
R a[100:103],v8,25600
M v[196:199],a[68:71],v[48:51],v[196:199]
R a[104:107],v8,26624
R a[108:111],v8,27648
M v[204:207],a[72:75],v[52:55],v[204:207]
R a[112:115],v8,28672
R a[116:119],v8,29696
M v[204:207],a[76:79],v[48:51],v[204:207]
R a[120:123],v8,30720
R a[124:127],v8,31744
M v[212:215],a[80:83],v[52:55],v[212:215]
buffer_load_dwordx4 v3, s[8:11], s21 offen offset:3072 sc1 lds
M v[212:215],a[84:87],v[48:51],v[212:215]
SA m0,s28,69632
v_mov_b32 v10, v30
v_mov_b32 v11, v31
M v[220:223],a[88:91],v[52:55],v[220:223]
s_waitcnt lgkmcnt(0)
v_permlane32_swap_b32 v10, v30
M v[220:223],a[92:95],v[48:51],v[220:223]
s_barrier
M v[228:231],a[96:99],v[52:55],v[228:231]
R a[64:67],v2,32768
R a[68:71],v2,33792
M v[228:231],a[100:103],v[48:51],v[228:231]
R a[72:75],v2,34816
R a[76:79],v2,35840
M v[236:239],a[104:107],v[52:55],v[236:239]
R a[80:83],v2,36864
R a[84:87],v2,37888
M v[236:239],a[108:111],v[48:51],v[236:239]
R a[88:91],v2,38912
R a[92:95],v2,39936
M v[244:247],a[112:115],v[52:55],v[244:247]
v_permlane32_swap_b32 v11, v31
M v[244:247],a[116:119],v[48:51],v[244:247]
s_waitcnt vmcnt(4)
buffer_load_dwordx4 v4, s[8:11], s21 offen offset:0 sc1 lds
M v[252:255],a[120:123],v[52:55],v[252:255]
s_waitcnt lgkmcnt(0)
AF v30,v10,v30
AF v31,v11,v31
M v[252:255],a[124:127],v[48:51],v[252:255]
v_rcp_f32 v5, v30
M v[64:67],a[64:67],a[0:3],0
R a[96:99],v2,40960
R a[100:103],v2,41984
M v[64:67],a[68:71],a[4:7],v[64:67]
v_rcp_f32 v6, v31
M v[64:67],a[72:75],a[8:11],v[64:67]
buffer_load_dwordx4 v4, s[8:11], s21 offen offset:1024 sc1 lds
M v[64:67],a[76:79],a[12:15],v[64:67]
R a[104:107],v2,43008
R a[108:111],v2,44032
M v[64:67],a[80:83],a[16:19],v[64:67]
W a192,v5
W a193,v6
M v[64:67],a[84:87],a[20:23],v[64:67]
buffer_load_dwordx4 v4, s[8:11], s21 offen offset:2048 sc1 lds
M v[64:67],a[88:91],a[24:27],v[64:67]
R a[112:115],v2,45056
R a[116:119],v2,46080
M v[64:67],a[92:95],a[28:31],v[64:67]
v_mov_b32 v30, 0
v_mov_b32 v31, 0
M v[68:71],a[92:95],a[60:63],0
buffer_load_dwordx4 v4, s[8:11], s21 offen offset:3072 sc1 lds
M v[68:71],a[88:91],a[56:59],v[68:71]
SA s21,s21,32768
R a[120:123],v2,47104
R a[124:127],v2,48128
M v[68:71],a[84:87],a[52:55],v[68:71]
s_sub_u32 s22, s22, 1
v_mov_b32 v32, 0
v_mov_b32 v33, 0
M v[68:71],a[80:83],a[48:51],v[68:71]
s_cselect_b32 s21, s23, s21
v_mov_b32 v34, 0
v_mov_b32 v35, 0
M v[68:71],a[76:79],a[44:47],v[68:71]
s_mul_i32 s26, s41, 1048576
v_mov_b32 v36, 0
v_mov_b32 v37, 0
M v[68:71],a[72:75],a[40:43],v[68:71]
SA s26,s26,17367040
v_mov_b32 v38, 0
v_mov_b32 v39, 0
M v[68:71],a[68:71],a[36:39],v[68:71]
SA m0,s28,0
E v18,v64
M v[68:71],a[64:67],a[32:35],v[68:71]
s_waitcnt lgkmcnt(0)
buffer_load_dwordx4 v3, s[8:11], s26 offen offset:0 sc1 lds
M v[72:75],a[96:99],a[0:3],0
R a[64:67],v2,49152
R a[68:71],v2,50176
M v[72:75],a[100:103],a[4:7],v[72:75]
E v19,v65
M v[72:75],a[104:107],a[8:11],v[72:75]
buffer_load_dwordx4 v3, s[8:11], s26 offen offset:1024 sc1 lds
M v[72:75],a[108:111],a[12:15],v[72:75]
R a[72:75],v2,51200
R a[76:79],v2,52224
M v[72:75],a[112:115],a[16:19],v[72:75]
E v20,v66
M v[72:75],a[116:119],a[20:23],v[72:75]
buffer_load_dwordx4 v3, s[8:11], s26 offen offset:2048 sc1 lds
M v[72:75],a[120:123],a[24:27],v[72:75]
R a[80:83],v2,53248
R a[84:87],v2,54272
M v[72:75],a[124:127],a[28:31],v[72:75]
E v21,v67
M v[76:79],a[124:127],a[60:63],0
buffer_load_dwordx4 v3, s[8:11], s26 offen offset:3072 sc1 lds
M v[76:79],a[120:123],a[56:59],v[76:79]
SA m0,s28,4096
R a[88:91],v2,55296
R a[92:95],v2,56320
M v[76:79],a[116:119],a[52:55],v[76:79]
E v22,v68
M v[76:79],a[112:115],a[48:51],v[76:79]
E v23,v69
M v[76:79],a[108:111],a[44:47],v[76:79]
buffer_load_dwordx4 v4, s[8:11], s26 offen offset:0 sc1 lds
M v[76:79],a[104:107],a[40:43],v[76:79]
AF v26,v18,v19
C v40,v18,v19
M v[76:79],a[100:103],a[36:39],v[76:79]
E v24,v70
M v[76:79],a[96:99],a[32:35],v[76:79]
s_waitcnt lgkmcnt(0)
AF v26,v20,v26
C v41,v20,v21
M v[80:83],a[64:67],a[0:3],0
R a[96:99],v2,57344
R a[100:103],v2,58368
M v[80:83],a[68:71],a[4:7],v[80:83]
buffer_load_dwordx4 v4, s[8:11], s26 offen offset:1024 sc1 lds
M v[80:83],a[72:75],a[8:11],v[80:83]
E v25,v71
M v[80:83],a[76:79],a[12:15],v[80:83]
R a[104:107],v2,59392
R a[108:111],v2,60416
M v[80:83],a[80:83],a[16:19],v[80:83]
AF v26,v21,v26
AF v27,v22,v23
M v[80:83],a[84:87],a[20:23],v[80:83]
buffer_load_dwordx4 v4, s[8:11], s26 offen offset:2048 sc1 lds
M v[80:83],a[88:91],a[24:27],v[80:83]
R a[112:115],v2,61440
R a[116:119],v2,62464
M v[80:83],a[92:95],a[28:31],v[80:83]
E v18,v72
M v[84:87],a[92:95],a[60:63],0
E v19,v73
M v[84:87],a[88:91],a[56:59],v[84:87]
R a[120:123],v2,63488
R a[124:127],v2,64512
M v[84:87],a[84:87],a[52:55],v[84:87]
buffer_load_dwordx4 v4, s[8:11], s26 offen offset:3072 sc1 lds
M v[84:87],a[80:83],a[48:51],v[84:87]
SA s26,s26,32768
E v20,v74
M v[84:87],a[76:79],a[44:47],v[84:87]
SA m0,s28,32768
C v44,v22,v23
AF v27,v24,v27
M v[84:87],a[72:75],a[40:43],v[84:87]
C v45,v24,v25
AF v27,v25,v27
M v[84:87],a[68:71],a[36:39],v[84:87]
s_waitcnt vmcnt(8) lgkmcnt(0)
buffer_load_dwordx4 v3, s[8:11], s26 offen offset:0 sc1 lds
M v[84:87],a[64:67],a[32:35],v[84:87]
s_barrier
M v[88:91],a[96:99],a[0:3],0
R a[64:67],v2,0
R a[68:71],v2,1024
M v[88:91],a[100:103],a[4:7],v[88:91]
E v21,v75
M v[88:91],a[104:107],a[8:11],v[88:91]
buffer_load_dwordx4 v3, s[8:11], s26 offen offset:1024 sc1 lds
M v[88:91],a[108:111],a[12:15],v[88:91]
R a[72:75],v2,2048
R a[76:79],v2,3072
M v[88:91],a[112:115],a[16:19],v[88:91]
E v22,v76
M v[88:91],a[116:119],a[20:23],v[88:91]
E v23,v77
M v[88:91],a[120:123],a[24:27],v[88:91]
R a[80:83],v2,4096
R a[84:87],v2,5120
M v[88:91],a[124:127],a[28:31],v[88:91]
buffer_load_dwordx4 v3, s[8:11], s26 offen offset:2048 sc1 lds
M v[92:95],a[124:127],a[60:63],0
E v24,v78
M v[92:95],a[120:123],a[56:59],v[92:95]
R a[88:91],v2,6144
R a[92:95],v2,7168
M v[92:95],a[116:119],a[52:55],v[92:95]
E v25,v79
M v[92:95],a[112:115],a[48:51],v[92:95]
buffer_load_dwordx4 v3, s[8:11], s26 offen offset:3072 sc1 lds
M v[92:95],a[108:111],a[44:47],v[92:95]
AF v26,v18,v26
C v42,v18,v19
M v[92:95],a[104:107],a[40:43],v[92:95]
AF v26,v19,v26
AF v26,v20,v26
M v[92:95],a[100:103],a[36:39],v[92:95]
s_waitcnt lgkmcnt(0)
C v43,v20,v21
AF v26,v21,v26
M v[92:95],a[96:99],a[32:35],v[92:95]
AF v27,v22,v27
C v46,v22,v23
AF v27,v23,v27
AF v27,v24,v27
C v47,v24,v25
AF v27,v25,v27
M v[96:99],a[64:67],a[0:3],0
R a[96:99],v2,8192
R a[100:103],v2,9216
M v[96:99],a[68:71],a[4:7],v[96:99]
SA m0,s28,98304
E v18,v80
M v[96:99],a[72:75],a[8:11],v[96:99]
buffer_load_dwordx4 v3, s[8:11], s21 offen offset:0 sc1 lds
M v[96:99],a[76:79],a[12:15],v[96:99]
R a[104:107],v2,10240
R a[108:111],v2,11264
M v[96:99],a[80:83],a[16:19],v[96:99]
E v19,v81
M v[96:99],a[84:87],a[20:23],v[96:99]
AF v26,v18,v26
C v56,v18,v19
M v[96:99],a[88:91],a[24:27],v[96:99]
R a[112:115],v2,12288
R a[116:119],v2,13312
M v[96:99],a[92:95],a[28:31],v[96:99]
buffer_load_dwordx4 v3, s[8:11], s21 offen offset:1024 sc1 lds
M v[100:103],a[92:95],a[60:63],0
E v20,v82
M v[100:103],a[88:91],a[56:59],v[100:103]
R a[120:123],v2,14336
R a[124:127],v2,15360
M v[100:103],a[84:87],a[52:55],v[100:103]
E v21,v83
M v[100:103],a[80:83],a[48:51],v[100:103]
buffer_load_dwordx4 v3, s[8:11], s21 offen offset:2048 sc1 lds
M v[100:103],a[76:79],a[44:47],v[100:103]
AF v26,v19,v26
AF v26,v20,v26
M v[100:103],a[72:75],a[40:43],v[100:103]
E v22,v88
M v[100:103],a[68:71],a[36:39],v[100:103]
C v57,v20,v21
AF v26,v21,v26
M v[100:103],a[64:67],a[32:35],v[100:103]
s_waitcnt lgkmcnt(0)
buffer_load_dwordx4 v3, s[8:11], s21 offen offset:3072 sc1 lds
M v[108:111],a[96:99],a[32:35],0
R a[64:67],v2,16384
R a[68:71],v2,17408
M v[108:111],a[100:103],a[36:39],v[108:111]
E v23,v89
M v[108:111],a[104:107],a[40:43],v[108:111]
SA m0,s28,102400
AF v26,v22,v26
C v58,v22,v23
M v[108:111],a[108:111],a[44:47],v[108:111]
R a[72:75],v2,18432
R a[76:79],v2,19456
M v[108:111],a[112:115],a[48:51],v[108:111]
buffer_load_dwordx4 v4, s[8:11], s21 offen offset:0 sc1 lds
M v[108:111],a[116:119],a[52:55],v[108:111]
E v24,v90
M v[108:111],a[120:123],a[56:59],v[108:111]
R a[80:83],v2,20480
R a[84:87],v2,21504
M v[108:111],a[124:127],a[60:63],v[108:111]
E v25,v91
M v[104:107],a[124:127],a[28:31],0
buffer_load_dwordx4 v4, s[8:11], s21 offen offset:1024 sc1 lds
M v[104:107],a[120:123],a[24:27],v[104:107]
R a[88:91],v2,22528
R a[92:95],v2,23552
M v[104:107],a[116:119],a[20:23],v[104:107]
AF v26,v23,v26
AF v26,v24,v26
M v[104:107],a[112:115],a[16:19],v[104:107]
E v18,v84
M v[104:107],a[108:111],a[12:15],v[104:107]
buffer_load_dwordx4 v4, s[8:11], s21 offen offset:2048 sc1 lds
M v[104:107],a[104:107],a[8:11],v[104:107]
C v59,v24,v25
AF v26,v25,v26
M v[104:107],a[100:103],a[4:7],v[104:107]
E v19,v85
M v[104:107],a[96:99],a[0:3],v[104:107]
s_waitcnt lgkmcnt(0)
AF v27,v18,v27
C v60,v18,v19
M v[112:115],a[64:67],a[0:3],0
R a[96:99],v2,24576
R a[100:103],v2,25600
M v[112:115],a[68:71],a[4:7],v[112:115]
buffer_load_dwordx4 v4, s[8:11], s21 offen offset:3072 sc1 lds
M v[112:115],a[72:75],a[8:11],v[112:115]
SA s21,s21,32768
E v20,v86
M v[112:115],a[76:79],a[12:15],v[112:115]
s_sub_u32 s22, s22, 1
R a[104:107],v2,26624
R a[108:111],v2,27648
M v[112:115],a[80:83],a[16:19],v[112:115]
s_cselect_b32 s21, s23, s21
AF v27,v19,v27
C v129,v130,v131
M v[112:115],a[84:87],a[20:23],v[112:115]
SA m0,s28,36864
E v21,v87
M v[112:115],a[88:91],a[24:27],v[112:115]
R a[112:115],v2,28672
R a[116:119],v2,29696
M v[112:115],a[92:95],a[28:31],v[112:115]
buffer_load_dwordx4 v4, s[8:11], s26 offen offset:0 sc1 lds
M v[116:119],a[92:95],a[60:63],0
E v22,v92
M v[116:119],a[88:91],a[56:59],v[116:119]
R a[120:123],v2,30720
R a[124:127],v2,31744
M v[116:119],a[84:87],a[52:55],v[116:119]
AF v27,v20,v27
C v61,v20,v21
M v[116:119],a[80:83],a[48:51],v[116:119]
buffer_load_dwordx4 v4, s[8:11], s26 offen offset:1024 sc1 lds
M v[116:119],a[76:79],a[44:47],v[116:119]
E v23,v93
M v[116:119],a[72:75],a[40:43],v[116:119]
AF v27,v21,v27
AF v27,v22,v27
M v[116:119],a[68:71],a[36:39],v[116:119]
s_waitcnt vmcnt(14) lgkmcnt(0)
C v62,v22,v23
AF v27,v23,v27
M v[116:119],a[64:67],a[32:35],v[116:119]
s_barrier
M v[124:127],a[96:99],a[32:35],0
R a[64:67],v7,0
R a[68:71],v7,1024
M v[124:127],a[100:103],a[36:39],v[124:127]
buffer_load_dwordx4 v4, s[8:11], s26 offen offset:2048 sc1 lds
M v[124:127],a[104:107],a[40:43],v[124:127]
E v24,v94
M v[124:127],a[108:111],a[44:47],v[124:127]
R a[72:75],v7,2048
R a[76:79],v7,3072
M v[124:127],a[112:115],a[48:51],v[124:127]
E v25,v95
M v[124:127],a[116:119],a[52:55],v[124:127]
buffer_load_dwordx4 v4, s[8:11], s26 offen offset:3072 sc1 lds
M v[124:127],a[120:123],a[56:59],v[124:127]
R a[80:83],v7,4096
R a[84:87],v7,5120
M v[124:127],a[124:127],a[60:63],v[124:127]
AF v27,v24,v27
C v63,v24,v25
M v[120:123],a[124:127],a[28:31],0
SA s26,s26,32768
AF v27,v25,v27
C v130,v136,v137
M v[120:123],a[120:123],a[24:27],v[120:123]
R a[88:91],v7,6144
R a[92:95],v7,7168
C v131,v138,v139
W a128,v128
W a129,v129
W a130,v130
W a131,v131
C v144,v144,v145
C v145,v146,v147
C v146,v152,v153
C v147,v154,v155
W a132,v144
W a133,v145
W a134,v146
W a135,v147
C v132,v132,v133
C v133,v134,v135
C v134,v140,v141
C v135,v142,v143
W a160,v132
W a161,v133
W a162,v134
W a163,v135
C v160,v160,v161
C v161,v162,v163
C v162,v168,v169
C v163,v170,v171
W a136,v160
W a137,v161
W a138,v162
W a139,v163
C v148,v148,v149
C v149,v150,v151
C v150,v156,v157
C v151,v158,v159
W a164,v148
W a165,v149
W a166,v150
W a167,v151
C v176,v176,v177
C v177,v178,v179
C v178,v184,v185
C v179,v186,v187
W a140,v176
W a141,v177
W a142,v178
W a143,v179
C v164,v164,v165
C v165,v166,v167
C v166,v172,v173
C v167,v174,v175
W a168,v164
W a169,v165
W a170,v166
W a171,v167
C v192,v192,v193
C v193,v194,v195
C v194,v200,v201
C v195,v202,v203
W a144,v192
W a145,v193
W a146,v194
W a147,v195
C v180,v180,v181
C v181,v182,v183
C v182,v188,v189
C v183,v190,v191
W a172,v180
W a173,v181
W a174,v182
W a175,v183
C v208,v208,v209
C v209,v210,v211
C v210,v216,v217
C v211,v218,v219
W a148,v208
W a149,v209
W a150,v210
W a151,v211
C v196,v196,v197
C v197,v198,v199
C v198,v204,v205
C v199,v206,v207
W a176,v196
W a177,v197
W a178,v198
W a179,v199
C v224,v224,v225
C v225,v226,v227
C v226,v232,v233
C v227,v234,v235
W a152,v224
W a153,v225
W a154,v226
W a155,v227
C v212,v212,v213
C v213,v214,v215
C v214,v220,v221
C v215,v222,v223
W a180,v212
W a181,v213
W a182,v214
W a183,v215
C v240,v240,v241
C v241,v242,v243
C v242,v248,v249
C v243,v250,v251
W a156,v240
W a157,v241
W a158,v242
W a159,v243
C v228,v228,v229
C v229,v230,v231
C v230,v236,v237
C v231,v238,v239
W a184,v228
W a185,v229
W a186,v230
W a187,v231
C v244,v244,v245
C v245,v246,v247
C v246,v252,v253
C v247,v254,v255
W a188,v244
W a189,v245
W a190,v246
W a191,v247
M v[120:123],a[116:119],a[20:23],v[120:123]
M v[120:123],a[112:115],a[16:19],v[120:123]
M v[120:123],a[108:111],a[12:15],v[120:123]
M v[120:123],a[104:107],a[8:11],v[120:123]
M v[120:123],a[100:103],a[4:7],v[120:123]
s_waitcnt lgkmcnt(0)
M v[120:123],a[96:99],a[0:3],v[120:123]
v_max_f32 v10, v26, v27
v_min_f32 v11, v26, v27
v_cmp_lt_f32 vcc, s31, v10
v_cmp_gt_f32 s[64:65], s24, v11
s_nop 0
s_or_b64 vcc, vcc, s[64:65]
s_cbranch_vccnz L_sth1
L_rth1:
M v[128:131],a[64:67],v[40:43],0
R a[96:99],v7,8192
R a[100:103],v7,9216
M v[128:131],a[68:71],v[56:59],v[128:131]
SA m0,s28,65536
E v18,v96
M v[132:135],a[68:71],v[60:63],0
buffer_load_dwordx4 v3, s[8:11], s21 offen offset:0 sc1 lds
M v[132:135],a[64:67],v[44:47],v[132:135]
R a[104:107],v7,10240
R a[108:111],v7,11264
M v[140:143],a[72:75],v[44:47],0
E v19,v97
M v[140:143],a[76:79],v[60:63],v[140:143]
AF v30,v26,v30
AF v31,v27,v31
M v[136:139],a[76:79],v[56:59],0
R a[112:115],v7,12288
R a[116:119],v7,13312
M v[136:139],a[72:75],v[40:43],v[136:139]
buffer_load_dwordx4 v3, s[8:11], s21 offen offset:1024 sc1 lds
M v[144:147],a[80:83],v[40:43],0
E v20,v98
M v[144:147],a[84:87],v[56:59],v[144:147]
R a[120:123],v7,14336
R a[124:127],v7,15360
M v[148:151],a[84:87],v[60:63],0
s_mov_b32 s40, 0
AF v28,v18,v19
C v48,v18,v19
M v[148:151],a[80:83],v[44:47],v[148:151]
s_mov_b32 s7, 0
buffer_load_dwordx4 v3, s[8:11], s21 offen offset:2048 sc1 lds
M v[156:159],a[88:91],v[44:47],0
s_and_b32 s39, s39, 1
E v21,v99
M v[156:159],a[92:95],v[60:63],v[156:159]
s_or_b32 s39, s39, 2
AF v28,v20,v28
C v49,v20,v21
M v[152:155],a[92:95],v[56:59],0
s_sub_u32 s27, 5, s42
AF v28,v21,v28
M v[152:155],a[88:91],v[40:43],v[152:155]
s_waitcnt lgkmcnt(0)
buffer_load_dwordx4 v3, s[8:11], s21 offen offset:3072 sc1 lds
M v[160:163],a[96:99],v[40:43],0
SA m0,s28,69632
R a[64:67],v7,16384
R a[68:71],v7,17408
M v[160:163],a[100:103],v[56:59],v[160:163]
E v22,v104
M v[164:167],a[100:103],v[60:63],0
E v23,v105
M v[164:167],a[96:99],v[44:47],v[164:167]
R a[72:75],v7,18432
R a[76:79],v7,19456
M v[172:175],a[104:107],v[44:47],0
buffer_load_dwordx4 v4, s[8:11], s21 offen offset:0 sc1 lds
M v[172:175],a[108:111],v[60:63],v[172:175]
AF v28,v22,v28
C v50,v22,v23
M v[168:171],a[108:111],v[56:59],0
R a[80:83],v7,20480
R a[84:87],v7,21504
M v[168:171],a[104:107],v[40:43],v[168:171]
buffer_load_dwordx4 v4, s[8:11], s21 offen offset:1024 sc1 lds
M v[176:179],a[112:115],v[40:43],0
E v24,v106
M v[176:179],a[116:119],v[56:59],v[176:179]
R a[88:91],v7,22528
R a[92:95],v7,23552
M v[180:183],a[116:119],v[60:63],0
buffer_load_dwordx4 v4, s[8:11], s21 offen offset:2048 sc1 lds
M v[180:183],a[112:115],v[44:47],v[180:183]
E v25,v107
M v[188:191],a[120:123],v[44:47],0
AF v28,v23,v28
AF v28,v24,v28
M v[188:191],a[124:127],v[60:63],v[188:191]
C v51,v24,v25
AF v28,v25,v28
M v[184:187],a[124:127],v[56:59],0
buffer_load_dwordx4 v4, s[8:11], s21 offen offset:3072 sc1 lds
M v[184:187],a[120:123],v[40:43],v[184:187]
s_waitcnt lgkmcnt(0)
E v18,v100
M v[192:195],a[64:67],v[40:43],0
SA s21,s21,32768
R a[96:99],v7,24576
R a[100:103],v7,25600
M v[192:195],a[68:71],v[56:59],v[192:195]
s_sub_u32 s22, s22, 1
E v19,v101
M v[196:199],a[68:71],v[60:63],0
s_cselect_b32 s21, s23, s21
AF v29,v18,v19
C v52,v18,v19
M v[196:199],a[64:67],v[44:47],v[196:199]
R a[104:107],v7,26624
R a[108:111],v7,27648
M v[204:207],a[72:75],v[44:47],0
M v[204:207],a[76:79],v[60:63],v[204:207]
E v20,v102
M v[200:203],a[76:79],v[56:59],0
R a[112:115],v7,28672
R a[116:119],v7,29696
M v[200:203],a[72:75],v[40:43],v[200:203]
M v[208:211],a[80:83],v[40:43],0
M v[208:211],a[84:87],v[56:59],v[208:211]
R a[120:123],v7,30720
R a[124:127],v7,31744
M v[212:215],a[84:87],v[60:63],0
E v21,v103
M v[212:215],a[80:83],v[44:47],v[212:215]
AF v29,v20,v29
C v53,v20,v21
M v[220:223],a[88:91],v[44:47],0
AF v29,v21,v29
M v[220:223],a[92:95],v[60:63],v[220:223]
E v22,v108
M v[216:219],a[92:95],v[56:59],0
s_waitcnt vmcnt(12) lgkmcnt(0)
M v[216:219],a[88:91],v[40:43],v[216:219]
s_barrier
M v[224:227],a[96:99],v[40:43],0
R a[64:67],v2,32768
R a[68:71],v2,33792
M v[224:227],a[100:103],v[56:59],v[224:227]
E v23,v109
M v[228:231],a[100:103],v[60:63],0
AF v29,v22,v29
C v54,v22,v23
M v[228:231],a[96:99],v[44:47],v[228:231]
R a[72:75],v2,34816
R a[76:79],v2,35840
M v[236:239],a[104:107],v[44:47],0
E v24,v110
M v[236:239],a[108:111],v[60:63],v[236:239]
AF v29,v23,v29
M v[232:235],a[108:111],v[56:59],0
R a[80:83],v2,36864
R a[84:87],v2,37888
M v[232:235],a[104:107],v[40:43],v[232:235]
M v[240:243],a[112:115],v[40:43],0
E v25,v111
M v[240:243],a[116:119],v[56:59],v[240:243]
R a[88:91],v2,38912
R a[92:95],v2,39936
M v[244:247],a[116:119],v[60:63],0
AF v29,v24,v29
C v55,v24,v25
M v[244:247],a[112:115],v[44:47],v[244:247]
AF v29,v25,v29
M v[252:255],a[120:123],v[44:47],0
M v[252:255],a[124:127],v[60:63],v[252:255]
M v[248:251],a[124:127],v[56:59],0
s_waitcnt lgkmcnt(0)
M v[248:251],a[120:123],v[40:43],v[248:251]
s_cmp_lg_u32 s27, 0
s_cbranch_scc1 L_loop_top
L_final_h:
s_waitcnt vmcnt(8) lgkmcnt(0)
s_barrier
R a[64:67],v7,32768
R a[68:71],v7,33792
R a[72:75],v7,34816
R a[76:79],v7,35840
R a[80:83],v7,36864
R a[84:87],v7,37888
R a[88:91],v7,38912
R a[92:95],v7,39936
v_lshrrev_b32 v14, 7, v7
v_mul_u32_u24 v14, 896, v14
v_lshrrev_b32 v15, 8, v7
v_lshlrev_b32 v15, 5, v15
v_xor_b32 v15, v15, v7
v_and_b32 v15, 0x70, v15
v_add_u32 v0, v14, v15
s_mul_i32 s38, s20, 57344
SA m0,s28,98304
SA s85,s38,0
E v18,v112
buffer_load_dwordx4 v0, s[12:15], s85 offen offset:0 lds
E v19,v113
E v20,v114
AF v28,v18,v28
SA s85,s38,6144
C v56,v18,v19
buffer_load_dwordx4 v0, s[12:15], s85 offen offset:1024 lds
E v21,v115
AF v28,v19,v28
E v22,v120
AF v28,v20,v28
SA s85,s38,12288
C v57,v20,v21
buffer_load_dwordx4 v0, s[12:15], s85 offen offset:2048 lds
E v23,v121
AF v28,v21,v28
E v24,v122
AF v28,v22,v28
SA s85,s38,18432
C v58,v22,v23
buffer_load_dwordx4 v0, s[12:15], s85 offen offset:3072 lds
E v25,v123
AF v28,v23,v28
E v18,v116
AF v28,v24,v28
SA m0,s28,102400
SA s85,s38,28672
C v59,v24,v25
buffer_load_dwordx4 v0, s[12:15], s85 offen offset:0 lds
E v19,v117
AF v28,v25,v28
E v20,v118
AF v29,v18,v29
SA s85,s38,34816
C v60,v18,v19
buffer_load_dwordx4 v0, s[12:15], s85 offen offset:1024 lds
E v21,v119
AF v29,v19,v29
E v22,v124
AF v29,v20,v29
SA s85,s38,40960
C v61,v20,v21
buffer_load_dwordx4 v0, s[12:15], s85 offen offset:2048 lds
E v23,v125
AF v29,v21,v29
E v24,v126
AF v29,v22,v29
SA s85,s38,47104
C v62,v22,v23
buffer_load_dwordx4 v0, s[12:15], s85 offen offset:3072 lds
SA s38,s38,128
E v25,v127
AF v29,v23,v29
AF v29,v24,v29
C v63,v24,v25
AF v29,v25,v29
v_max_f32 v10, v28, v29
v_cmp_lt_f32 vcc, s31, v10
s_nop 0
s_cbranch_vccnz L_stfh
L_rtfh:
AF v30,v28,v30
AF v31,v29,v31
v_mov_b32 v10, v32
v_mov_b32 v11, v36
v_mov_b32 v12, v30
v_mov_b32 v13, v31
buffer_store_dwordx4 v[10:13], v7, s[8:11], s90 offen sc1
s_waitcnt lgkmcnt(0)
M v[128:131],a[64:67],v[48:51],v[128:131]
SA m0,s28,65536
R a[96:99],v7,40960
R a[100:103],v7,41984
M v[128:131],a[68:71],v[56:59],v[128:131]
SA s85,s38,0
buffer_load_dwordx4 v0, s[12:15], s85 offen offset:0 lds
M v[132:135],a[68:71],v[60:63],v[132:135]
SA s85,s38,6144
v_lshrrev_b32 v16, 4, v7
v_lshrrev_b32 v14, 2, v16
M v[132:135],a[64:67],v[52:55],v[132:135]
R a[104:107],v7,43008
R a[108:111],v7,44032
M v[136:139],a[72:75],v[48:51],v[136:139]
buffer_load_dwordx4 v0, s[12:15], s85 offen offset:1024 lds
M v[136:139],a[76:79],v[56:59],v[136:139]
SA s85,s38,12288
v_lshlrev_b32 v14, 7, v14
v_and_b32 v15, 3, v16
M v[140:143],a[76:79],v[60:63],v[140:143]
R a[112:115],v7,45056
R a[116:119],v7,46080
M v[140:143],a[72:75],v[52:55],v[140:143]
buffer_load_dwordx4 v0, s[12:15], s85 offen offset:2048 lds
M v[144:147],a[80:83],v[48:51],v[144:147]
SA s85,s38,18432
v_lshl_add_u32 v14, v15, 3, v14
v_bfe_u32 v15, v16, 3, 2
M v[144:147],a[84:87],v[56:59],v[144:147]
R a[120:123],v7,47104
R a[124:127],v7,48128
M v[148:151],a[84:87],v[60:63],v[148:151]
buffer_load_dwordx4 v0, s[12:15], s85 offen offset:3072 lds
M v[148:151],a[80:83],v[52:55],v[148:151]
v_lshl_add_u32 v18, v15, 5, v14
v_xor_b32 v19, 32, v18
M v[152:155],a[88:91],v[48:51],v[152:155]
v_xor_b32 v20, 64, v18
v_xor_b32 v21, 0x60, v18
M v[152:155],a[92:95],v[56:59],v[152:155]
v_add_u32 v22, 0x10000, v18
v_add_u32 v23, 0x10000, v19
M v[156:159],a[92:95],v[60:63],v[156:159]
v_add_u32 v24, 0x10000, v20
v_add_u32 v25, 0x10000, v21
M v[156:159],a[88:91],v[52:55],v[156:159]
s_waitcnt lgkmcnt(0)
C v128,v128,v129
C v129,v130,v131
M v[160:163],a[96:99],v[48:51],v[160:163]
R a[64:67],v7,49152
R a[68:71],v7,50176
M v[160:163],a[100:103],v[56:59],v[160:163]
C v130,v136,v137
C v131,v138,v139
M v[164:167],a[100:103],v[60:63],v[164:167]
buffer_store_dwordx4 v[128:131], v7, s[8:11], s86 offen offset:0 sc1
M v[164:167],a[96:99],v[52:55],v[164:167]
R a[72:75],v7,51200
R a[76:79],v7,52224
M v[168:171],a[104:107],v[48:51],v[168:171]
C v132,v132,v133
C v133,v134,v135
M v[168:171],a[108:111],v[56:59],v[168:171]
C v134,v140,v141
C v135,v142,v143
M v[172:175],a[108:111],v[60:63],v[172:175]
R a[80:83],v7,53248
R a[84:87],v7,54272
M v[172:175],a[104:107],v[52:55],v[172:175]
buffer_store_dwordx4 v[132:135], v7, s[8:11], s88 offen offset:0 sc1
M v[176:179],a[112:115],v[48:51],v[176:179]
C v144,v144,v145
C v145,v146,v147
M v[176:179],a[116:119],v[56:59],v[176:179]
R a[88:91],v7,55296
R a[92:95],v7,56320
M v[180:183],a[116:119],v[60:63],v[180:183]
C v146,v152,v153
C v147,v154,v155
M v[180:183],a[112:115],v[52:55],v[180:183]
buffer_store_dwordx4 v[144:147], v7, s[8:11], s86 offen offset:1024 sc1
M v[184:187],a[120:123],v[48:51],v[184:187]
C v148,v148,v149
C v149,v150,v151
M v[184:187],a[124:127],v[56:59],v[184:187]
C v150,v156,v157
C v151,v158,v159
M v[188:191],a[124:127],v[60:63],v[188:191]
buffer_store_dwordx4 v[148:151], v7, s[8:11], s88 offen offset:1024 sc1
M v[188:191],a[120:123],v[52:55],v[188:191]
s_waitcnt lgkmcnt(0)
C v160,v160,v161
C v161,v162,v163
M v[192:195],a[64:67],v[48:51],v[192:195]
R a[96:99],v7,57344
R a[100:103],v7,58368
M v[192:195],a[68:71],v[56:59],v[192:195]
C v162,v168,v169
C v163,v170,v171
M v[196:199],a[68:71],v[60:63],v[196:199]
buffer_store_dwordx4 v[160:163], v7, s[8:11], s86 offen offset:2048 sc1
M v[196:199],a[64:67],v[52:55],v[196:199]
R a[104:107],v7,59392
R a[108:111],v7,60416
M v[200:203],a[72:75],v[48:51],v[200:203]
C v164,v164,v165
C v165,v166,v167
M v[200:203],a[76:79],v[56:59],v[200:203]
C v166,v172,v173
C v167,v174,v175
M v[204:207],a[76:79],v[60:63],v[204:207]
R a[112:115],v7,61440
R a[116:119],v7,62464
M v[204:207],a[72:75],v[52:55],v[204:207]
buffer_store_dwordx4 v[164:167], v7, s[8:11], s88 offen offset:2048 sc1
M v[208:211],a[80:83],v[48:51],v[208:211]
C v176,v176,v177
C v177,v178,v179
M v[208:211],a[84:87],v[56:59],v[208:211]
R a[120:123],v7,63488
R a[124:127],v7,64512
M v[212:215],a[84:87],v[60:63],v[212:215]
C v178,v184,v185
C v179,v186,v187
M v[212:215],a[80:83],v[52:55],v[212:215]
buffer_store_dwordx4 v[176:179], v7, s[8:11], s86 offen offset:3072 sc1
M v[216:219],a[88:91],v[48:51],v[216:219]
C v180,v180,v181
C v181,v182,v183
M v[216:219],a[92:95],v[56:59],v[216:219]
C v182,v188,v189
C v183,v190,v191
M v[220:223],a[92:95],v[60:63],v[220:223]
s_waitcnt vmcnt(12) lgkmcnt(0)
buffer_store_dwordx4 v[180:183], v7, s[8:11], s88 offen offset:3072 sc1
M v[220:223],a[88:91],v[52:55],v[220:223]
s_barrier
M v[224:227],a[96:99],v[48:51],v[224:227]
s_nop 0
T a[64:65],v22,32768
T a[66:67],v22,34816
M v[224:227],a[100:103],v[56:59],v[224:227]
T a[68:69],v22,36864
T a[70:71],v22,38912
M v[228:231],a[100:103],v[60:63],v[228:231]
C v192,v192,v193
C v193,v194,v195
M v[228:231],a[96:99],v[52:55],v[228:231]
T a[72:73],v22,40960
T a[74:75],v22,43008
M v[232:235],a[104:107],v[48:51],v[232:235]
T a[76:77],v22,45056
T a[78:79],v22,47104
M v[232:235],a[108:111],v[56:59],v[232:235]
C v194,v200,v201
C v195,v202,v203
M v[236:239],a[108:111],v[60:63],v[236:239]
T a[80:81],v22,49152
T a[82:83],v22,51200
M v[236:239],a[104:107],v[52:55],v[236:239]
T a[84:85],v22,53248
T a[86:87],v22,55296
M v[240:243],a[112:115],v[48:51],v[240:243]
buffer_store_dwordx4 v[192:195], v7, s[8:11], s87 offen offset:0 sc1
M v[240:243],a[116:119],v[56:59],v[240:243]
s_nop 0
T a[88:89],v22,57344
T a[90:91],v22,59392
M v[244:247],a[116:119],v[60:63],v[244:247]
T a[92:93],v22,61440
T a[94:95],v22,63488
M v[244:247],a[112:115],v[52:55],v[244:247]
C v196,v196,v197
C v197,v198,v199
M v[248:251],a[120:123],v[48:51],v[248:251]
C v198,v204,v205
C v199,v206,v207
M v[248:251],a[124:127],v[56:59],v[248:251]
buffer_store_dwordx4 v[196:199], v7, s[8:11], s89 offen offset:0 sc1
M v[252:255],a[124:127],v[60:63],v[252:255]
s_waitcnt lgkmcnt(0)
C v208,v208,v209
C v209,v210,v211
M v[252:255],a[120:123],v[52:55],v[252:255]
C v210,v216,v217
C v211,v218,v219
buffer_store_dwordx4 v[208:211], v7, s[8:11], s87 offen offset:1024 sc1
C v212,v212,v213
C v213,v214,v215
C v214,v220,v221
C v215,v222,v223
buffer_store_dwordx4 v[212:215], v7, s[8:11], s89 offen offset:1024 sc1
C v224,v224,v225
C v225,v226,v227
C v226,v232,v233
C v227,v234,v235
buffer_store_dwordx4 v[224:227], v7, s[8:11], s87 offen offset:2048 sc1
C v228,v228,v229
C v229,v230,v231
C v230,v236,v237
C v231,v238,v239
buffer_store_dwordx4 v[228:231], v7, s[8:11], s89 offen offset:2048 sc1
C v240,v240,v241
C v241,v242,v243
C v242,v248,v249
C v243,v250,v251
buffer_store_dwordx4 v[240:243], v7, s[8:11], s87 offen offset:3072 sc1
C v244,v244,v245
C v245,v246,v247
C v246,v252,v253
C v247,v254,v255
buffer_store_dwordx4 v[244:247], v7, s[8:11], s89 offen offset:3072 sc1
M v[64:67],a[64:67],a[128:131],0
s_nop 0
T a[96:97],v23,32768
T a[98:99],v23,34816
M v[64:67],a[68:71],a[132:135],v[64:67]
SA m0,s28,69632
T a[100:101],v23,36864
T a[102:103],v23,38912
M v[64:67],a[72:75],a[136:139],v[64:67]
SA s85,s38,28672
buffer_load_dwordx4 v0, s[12:15], s85 offen offset:0 lds
M v[64:67],a[76:79],a[140:143],v[64:67]
SA s85,s38,34816
T a[104:105],v23,40960
T a[106:107],v23,43008
M v[64:67],a[80:83],a[144:147],v[64:67]
SA s29,s33,0
T a[108:109],v23,45056
T a[110:111],v23,47104
M v[64:67],a[84:87],a[148:151],v[64:67]
SA s30,s33,14336
buffer_load_dwordx4 v0, s[12:15], s85 offen offset:1024 lds
M v[64:67],a[88:91],a[152:155],v[64:67]
SA s85,s38,40960
T a[112:113],v23,49152
T a[114:115],v23,51200
M v[64:67],a[92:95],a[156:159],v[64:67]
T a[116:117],v23,53248
T a[118:119],v23,55296
M v[68:71],a[92:95],a[188:191],0
buffer_load_dwordx4 v0, s[12:15], s85 offen offset:2048 lds
M v[68:71],a[88:91],a[184:187],v[68:71]
SA s85,s38,47104
T a[120:121],v23,57344
T a[122:123],v23,59392
M v[68:71],a[84:87],a[180:183],v[68:71]
T a[124:125],v23,61440
T a[126:127],v23,63488
M v[68:71],a[80:83],a[176:179],v[68:71]
buffer_load_dwordx4 v0, s[12:15], s85 offen offset:3072 lds
M v[68:71],a[76:79],a[172:175],v[68:71]
SA s38,s38,128
G v5,a192
G v6,a193
M v[68:71],a[72:75],a[168:171],v[68:71]
s_sub_u32 s64, 15, s42
M v[68:71],a[68:71],a[164:167],v[68:71]
s_min_u32 s64, s64, s42
M v[68:71],a[64:67],a[160:163],v[68:71]
s_waitcnt lgkmcnt(0)
M v[72:75],a[96:99],a[128:131],0
s_mul_i32 s45, s64, 8704
T a[64:65],v24,32768
T a[66:67],v24,34816
M v[72:75],a[100:103],a[132:135],v[72:75]
s_lshl_b32 s64, s41, 2
T a[68:69],v24,36864
T a[70:71],v24,38912
M v[72:75],a[104:107],a[136:139],v[72:75]
SA s45,s45,s64
M v[72:75],a[108:111],a[140:143],v[72:75]
s_lshl_b32 s64, s20, 8
T a[72:73],v24,40960
T a[74:75],v24,43008
M v[72:75],a[112:115],a[144:147],v[72:75]
SA s45,s45,s64
T a[76:77],v24,45056
T a[78:79],v24,47104
M v[72:75],a[116:119],a[148:151],v[72:75]
SA s45,s45,104992768
M v[72:75],a[120:123],a[152:155],v[72:75]
s_mov_b32 s64, 1024
T a[80:81],v24,49152
T a[82:83],v24,51200
M v[72:75],a[124:127],a[156:159],v[72:75]
s_mov_b32 s66, 4096
T a[84:85],v24,53248
T a[86:87],v24,55296
M v[76:79],a[124:127],a[188:191],0
s_cmp_lt_u32 s42, 8
M v[76:79],a[120:123],a[184:187],v[76:79]
s_cselect_b32 s64, 4352, s64
T a[88:89],v24,57344
T a[90:91],v24,59392
M v[76:79],a[116:119],a[180:183],v[76:79]
s_cselect_b32 s65, 0, 64
T a[92:93],v24,61440
T a[94:95],v24,63488
M v[76:79],a[112:115],a[176:179],v[76:79]
s_cselect_b32 s66, 536870912, s66
MF v64,v5,v64
MF v65,v5,v65
M v[76:79],a[108:111],a[172:175],v[76:79]
SA s3,s45,s64
MF v66,v5,v66
MF v67,v5,v67
M v[76:79],a[104:107],a[168:171],v[76:79]
SA s45,s45,s65
v_lshrrev_b32 v17, 5, v7
v_min_u32 v15, 1, v17
M v[76:79],a[100:103],a[164:167],v[76:79]
SA m0,s28,0
v_lshlrev_b32 v14, 3, v7
v_lshl_or_b32 v16, v15, 29, v14
M v[76:79],a[96:99],a[160:163],v[76:79]
s_waitcnt lgkmcnt(0)
v_cmp_eq_u32 vcc, 1, v17
v_add_u32 v14, s66, v14
M v[80:83],a[64:67],a[128:131],0
SA s85,s38,0
T a[96:97],v25,32768
T a[98:99],v25,34816
M v[80:83],a[68:71],a[132:135],v[80:83]
T a[100:101],v25,36864
T a[102:103],v25,38912
M v[80:83],a[72:75],a[136:139],v[80:83]
buffer_load_dwordx4 v0, s[12:15], s85 offen offset:0 lds
M v[80:83],a[76:79],a[140:143],v[80:83]
SA s85,s38,6144
T a[104:105],v25,40960
T a[106:107],v25,43008
M v[80:83],a[80:83],a[144:147],v[80:83]
T a[108:109],v25,45056
T a[110:111],v25,47104
M v[80:83],a[84:87],a[148:151],v[80:83]
buffer_load_dwordx4 v0, s[12:15], s85 offen offset:1024 lds
M v[80:83],a[88:91],a[152:155],v[80:83]
SA s85,s38,12288
T a[112:113],v25,49152
T a[114:115],v25,51200
M v[80:83],a[92:95],a[156:159],v[80:83]
T a[116:117],v25,53248
T a[118:119],v25,55296
M v[84:87],a[92:95],a[188:191],0
buffer_load_dwordx4 v0, s[12:15], s85 offen offset:2048 lds
M v[84:87],a[88:91],a[184:187],v[84:87]
SA s85,s38,18432
T a[120:121],v25,57344
T a[122:123],v25,59392
M v[84:87],a[84:87],a[180:183],v[84:87]
T a[124:125],v25,61440
T a[126:127],v25,63488
M v[84:87],a[80:83],a[176:179],v[84:87]
buffer_load_dwordx4 v0, s[12:15], s85 offen offset:3072 lds
M v[84:87],a[76:79],a[172:175],v[84:87]
SA m0,s28,4096
v_mov_b32 v15, 1
v_cndmask_b32 v17, v16, v14, vcc
M v[84:87],a[72:75],a[168:171],v[84:87]
SA s85,s38,28672
buffer_load_dwordx4 v0, s[12:15], s85 offen offset:0 lds
M v[84:87],a[68:71],a[164:167],v[84:87]
s_waitcnt vmcnt(5) lgkmcnt(0)
v_min_u32 v10, 1, v7
v_lshlrev_b32 v10, 29, v10
M v[84:87],a[64:67],a[160:163],v[84:87]
s_barrier
M v[88:91],a[96:99],a[128:131],0
SA s85,s38,34816
T a[64:65],v22,0
T a[66:67],v22,2048
M v[88:91],a[100:103],a[132:135],v[88:91]
T a[68:69],v22,4096
T a[70:71],v22,6144
M v[88:91],a[104:107],a[136:139],v[88:91]
buffer_load_dwordx4 v0, s[12:15], s85 offen offset:1024 lds
M v[88:91],a[108:111],a[140:143],v[88:91]
SA s85,s38,40960
T a[72:73],v22,8192
T a[74:75],v22,10240
M v[88:91],a[112:115],a[144:147],v[88:91]
T a[76:77],v22,12288
T a[78:79],v22,14336
M v[88:91],a[116:119],a[148:151],v[88:91]
buffer_load_dwordx4 v0, s[12:15], s85 offen offset:2048 lds
M v[88:91],a[120:123],a[152:155],v[88:91]
SA s85,s38,47104
T a[80:81],v22,16384
T a[82:83],v22,18432
M v[88:91],a[124:127],a[156:159],v[88:91]
T a[84:85],v22,20480
T a[86:87],v22,22528
M v[92:95],a[124:127],a[188:191],0
buffer_store_dword v15, v10, s[8:11], s47 offen sc1
M v[92:95],a[120:123],a[184:187],v[92:95]
s_nop 0
T a[88:89],v22,24576
T a[90:91],v22,26624
M v[92:95],a[116:119],a[180:183],v[92:95]
T a[92:93],v22,28672
T a[94:95],v22,30720
M v[92:95],a[112:115],a[176:179],v[92:95]
buffer_load_dwordx4 v0, s[12:15], s85 offen offset:3072 lds
M v[92:95],a[108:111],a[172:175],v[92:95]
SA s38,s38,128
MF v72,v5,v72
MF v73,v5,v73
M v[92:95],a[104:107],a[168:171],v[92:95]
SA m0,s28,131072
MF v74,v5,v74
MF v75,v5,v75
M v[92:95],a[100:103],a[164:167],v[92:95]
s_waitcnt lgkmcnt(0)
C v64,v64,v65
C v65,v66,v67
M v[92:95],a[96:99],a[160:163],v[92:95]
SA s85,s38,0
C v66,v72,v73
C v67,v74,v75
buffer_store_dwordx4 v[64:67], v7, s[8:11], s29 offen offset:0 sc1
buffer_load_dwordx4 v0, s[12:15], s85 offen offset:0 lds
v_add_u32 v40, 0x20000, v18
v_add_u32 v41, 0x20000, v19
v_add_u32 v42, 0x20000, v20
v_add_u32 v43, 0x20000, v21
SA s85,s38,6144
MF v68,v6,v68
MF v69,v6,v69
MF v70,v6,v70
MF v71,v6,v71
MF v76,v6,v76
MF v77,v6,v77
MF v78,v6,v78
MF v79,v6,v79
C v68,v68,v69
C v69,v70,v71
C v70,v76,v77
C v71,v78,v79
buffer_store_dwordx4 v[68:71], v7, s[8:11], s30 offen offset:0 sc1
buffer_load_dwordx4 v0, s[12:15], s85 offen offset:1024 lds
SA s85,s38,12288
buffer_load_dwordx4 v0, s[12:15], s85 offen offset:2048 lds
SA s85,s38,18432
buffer_load_dwordx4 v0, s[12:15], s85 offen offset:3072 lds
M v[96:99],a[64:67],a[128:131],0
s_nop 0
T a[96:97],v23,0
T a[98:99],v23,2048
M v[96:99],a[68:71],a[132:135],v[96:99]
SA m0,s28,135168
T a[100:101],v23,4096
T a[102:103],v23,6144
M v[96:99],a[72:75],a[136:139],v[96:99]
SA s85,s38,28672
buffer_load_dwordx4 v0, s[12:15], s85 offen offset:0 lds
M v[96:99],a[76:79],a[140:143],v[96:99]
SA s85,s38,34816
T a[104:105],v23,8192
T a[106:107],v23,10240
M v[96:99],a[80:83],a[144:147],v[96:99]
T a[108:109],v23,12288
T a[110:111],v23,14336
M v[96:99],a[84:87],a[148:151],v[96:99]
buffer_load_dwordx4 v0, s[12:15], s85 offen offset:1024 lds
M v[96:99],a[88:91],a[152:155],v[96:99]
SA s85,s38,40960
T a[112:113],v23,16384
T a[114:115],v23,18432
M v[96:99],a[92:95],a[156:159],v[96:99]
T a[116:117],v23,20480
T a[118:119],v23,22528
M v[100:103],a[92:95],a[188:191],0
buffer_load_dwordx4 v0, s[12:15], s85 offen offset:2048 lds
M v[100:103],a[88:91],a[184:187],v[100:103]
SA s85,s38,47104
T a[120:121],v23,24576
T a[122:123],v23,26624
M v[100:103],a[84:87],a[180:183],v[100:103]
T a[124:125],v23,28672
T a[126:127],v23,30720
M v[100:103],a[80:83],a[176:179],v[100:103]
buffer_load_dwordx4 v0, s[12:15], s85 offen offset:3072 lds
M v[100:103],a[76:79],a[172:175],v[100:103]
SA s38,s38,128
MF v80,v5,v80
MF v81,v5,v81
M v[100:103],a[72:75],a[168:171],v[100:103]
SA m0,s28,32768
MF v82,v5,v82
MF v83,v5,v83
M v[100:103],a[68:71],a[164:167],v[100:103]
SA s85,s38,0
buffer_load_dwordx4 v0, s[12:15], s85 offen offset:0 lds
M v[100:103],a[64:67],a[160:163],v[100:103]
s_waitcnt lgkmcnt(0)
MF v88,v5,v88
MF v89,v5,v89
M v[104:107],a[96:99],a[128:131],0
SA s85,s38,6144
T a[64:65],v24,0
T a[66:67],v24,2048
M v[104:107],a[100:103],a[132:135],v[104:107]
T a[68:69],v24,4096
T a[70:71],v24,6144
M v[104:107],a[104:107],a[136:139],v[104:107]
buffer_load_dwordx4 v0, s[12:15], s85 offen offset:1024 lds
M v[104:107],a[108:111],a[140:143],v[104:107]
SA s85,s38,12288
T a[72:73],v24,8192
T a[74:75],v24,10240
M v[104:107],a[112:115],a[144:147],v[104:107]
T a[76:77],v24,12288
T a[78:79],v24,14336
M v[104:107],a[116:119],a[148:151],v[104:107]
buffer_load_dwordx4 v0, s[12:15], s85 offen offset:2048 lds
M v[104:107],a[120:123],a[152:155],v[104:107]
SA s85,s38,18432
T a[80:81],v24,16384
T a[82:83],v24,18432
M v[104:107],a[124:127],a[156:159],v[104:107]
T a[84:85],v24,20480
T a[86:87],v24,22528
M v[108:111],a[124:127],a[188:191],0
buffer_load_dwordx4 v0, s[12:15], s85 offen offset:3072 lds
M v[108:111],a[120:123],a[184:187],v[108:111]
SA m0,s28,36864
T a[88:89],v24,24576
T a[90:91],v24,26624
M v[108:111],a[116:119],a[180:183],v[108:111]
SA s85,s38,28672
T a[92:93],v24,28672
T a[94:95],v24,30720
M v[108:111],a[112:115],a[176:179],v[108:111]
buffer_load_dwordx4 v0, s[12:15], s85 offen offset:0 lds
M v[108:111],a[108:111],a[172:175],v[108:111]
SA s85,s38,34816
MF v90,v5,v90
MF v91,v5,v91
M v[108:111],a[104:107],a[168:171],v[108:111]
C v80,v80,v81
C v81,v82,v83
M v[108:111],a[100:103],a[164:167],v[108:111]
buffer_load_dwordx4 v0, s[12:15], s85 offen offset:1024 lds
M v[108:111],a[96:99],a[160:163],v[108:111]
s_waitcnt lgkmcnt(0)
C v82,v88,v89
C v83,v90,v91
M v[112:115],a[64:67],a[128:131],0
SA s85,s38,40960
T a[96:97],v25,0
T a[98:99],v25,2048
M v[112:115],a[68:71],a[132:135],v[112:115]
T a[100:101],v25,4096
T a[102:103],v25,6144
M v[112:115],a[72:75],a[136:139],v[112:115]
buffer_store_dwordx4 v[80:83], v7, s[8:11], s29 offen offset:1024 sc1
M v[112:115],a[76:79],a[140:143],v[112:115]
s_nop 0
T a[104:105],v25,8192
T a[106:107],v25,10240
M v[112:115],a[80:83],a[144:147],v[112:115]
T a[108:109],v25,12288
T a[110:111],v25,14336
M v[112:115],a[84:87],a[148:151],v[112:115]
buffer_load_dwordx4 v0, s[12:15], s85 offen offset:2048 lds
M v[112:115],a[88:91],a[152:155],v[112:115]
SA s85,s38,47104
T a[112:113],v25,16384
T a[114:115],v25,18432
M v[112:115],a[92:95],a[156:159],v[112:115]
T a[116:117],v25,20480
T a[118:119],v25,22528
M v[116:119],a[92:95],a[188:191],0
buffer_load_dwordx4 v0, s[12:15], s85 offen offset:3072 lds
M v[116:119],a[88:91],a[184:187],v[116:119]
SA s38,s38,128
T a[120:121],v25,24576
T a[122:123],v25,26624
M v[116:119],a[84:87],a[180:183],v[116:119]
SA m0,s28,98304
T a[124:125],v25,28672
T a[126:127],v25,30720
M v[116:119],a[80:83],a[176:179],v[116:119]
SA s85,s38,0
buffer_load_dwordx4 v0, s[12:15], s85 offen offset:0 lds
M v[116:119],a[76:79],a[172:175],v[116:119]
SA s85,s38,6144
MF v84,v6,v84
MF v85,v6,v85
M v[116:119],a[72:75],a[168:171],v[116:119]
buffer_load_dwordx4 v0, s[12:15], s85 offen offset:1024 lds
M v[116:119],a[68:71],a[164:167],v[116:119]
s_waitcnt vmcnt(21) lgkmcnt(0)
MF v86,v6,v86
MF v87,v6,v87
M v[116:119],a[64:67],a[160:163],v[116:119]
s_barrier
M v[120:123],a[96:99],a[128:131],0
SA s85,s38,12288
T a[64:65],v18,0
T a[66:67],v18,2048
M v[120:123],a[100:103],a[132:135],v[120:123]
T a[68:69],v18,4096
T a[70:71],v18,6144
M v[120:123],a[104:107],a[136:139],v[120:123]
buffer_load_dwordx4 v0, s[12:15], s85 offen offset:2048 lds
M v[120:123],a[108:111],a[140:143],v[120:123]
SA s85,s38,18432
T a[72:73],v18,8192
T a[74:75],v18,10240
M v[120:123],a[112:115],a[144:147],v[120:123]
T a[76:77],v18,12288
T a[78:79],v18,14336
M v[120:123],a[116:119],a[148:151],v[120:123]
buffer_load_dwordx4 v0, s[12:15], s85 offen offset:3072 lds
M v[120:123],a[120:123],a[152:155],v[120:123]
s_nop 0
T a[80:81],v18,16384
T a[82:83],v18,18432
M v[120:123],a[124:127],a[156:159],v[120:123]
T a[84:85],v18,20480
T a[86:87],v18,22528
M v[124:127],a[124:127],a[188:191],0
MF v92,v6,v92
MF v93,v6,v93
M v[124:127],a[120:123],a[184:187],v[124:127]
T a[88:89],v18,24576
T a[90:91],v18,26624
M v[124:127],a[116:119],a[180:183],v[124:127]
T a[92:93],v18,28672
T a[94:95],v18,30720
M v[124:127],a[112:115],a[176:179],v[124:127]
MF v94,v6,v94
MF v95,v6,v95
M v[124:127],a[108:111],a[172:175],v[124:127]
C v84,v84,v85
C v85,v86,v87
M v[124:127],a[104:107],a[168:171],v[124:127]
C v86,v92,v93
C v87,v94,v95
M v[124:127],a[100:103],a[164:167],v[124:127]
s_waitcnt lgkmcnt(0)
buffer_store_dwordx4 v[84:87], v7, s[8:11], s30 offen offset:1024 sc1
M v[124:127],a[96:99],a[160:163],v[124:127]
SA s29,s33,2048
SA s30,s33,16384
MF v96,v5,v96
MF v97,v5,v97
MF v98,v5,v98
MF v99,v5,v99
MF v104,v5,v104
MF v105,v5,v105
MF v106,v5,v106
MF v107,v5,v107
C v96,v96,v97
C v97,v98,v99
C v98,v104,v105
C v99,v106,v107
buffer_store_dwordx4 v[96:99], v7, s[8:11], s29 offen offset:0 sc1
MF v100,v6,v100
MF v101,v6,v101
MF v102,v6,v102
MF v103,v6,v103
MF v108,v6,v108
MF v109,v6,v109
MF v110,v6,v110
MF v111,v6,v111
C v100,v100,v101
C v101,v102,v103
C v102,v108,v109
C v103,v110,v111
buffer_store_dwordx4 v[100:103], v7, s[8:11], s30 offen offset:0 sc1
M v[64:67],a[64:67],a[128:131],0
s_nop 0
T a[96:97],v19,0
T a[98:99],v19,2048
M v[64:67],a[68:71],a[132:135],v[64:67]
SA m0,s28,102400
T a[100:101],v19,4096
T a[102:103],v19,6144
M v[64:67],a[72:75],a[136:139],v[64:67]
SA s85,s38,28672
buffer_load_dwordx4 v0, s[12:15], s85 offen offset:0 lds
M v[64:67],a[76:79],a[140:143],v[64:67]
SA s85,s38,34816
T a[104:105],v19,8192
T a[106:107],v19,10240
M v[64:67],a[80:83],a[144:147],v[64:67]
T a[108:109],v19,12288
T a[110:111],v19,14336
M v[64:67],a[84:87],a[148:151],v[64:67]
buffer_load_dwordx4 v0, s[12:15], s85 offen offset:1024 lds
M v[64:67],a[88:91],a[152:155],v[64:67]
s_nop 0
T a[112:113],v19,16384
T a[114:115],v19,18432
M v[64:67],a[92:95],a[156:159],v[64:67]
SA s85,s38,40960
T a[116:117],v19,20480
T a[118:119],v19,22528
M v[68:71],a[92:95],a[188:191],0
buffer_load_dwordx4 v0, s[12:15], s85 offen offset:2048 lds
M v[68:71],a[88:91],a[184:187],v[68:71]
s_nop 0
T a[120:121],v19,24576
T a[122:123],v19,26624
M v[68:71],a[84:87],a[180:183],v[68:71]
T a[124:125],v19,28672
T a[126:127],v19,30720
M v[68:71],a[80:83],a[176:179],v[68:71]
SA s85,s38,47104
MF v112,v5,v112
MF v113,v5,v113
M v[68:71],a[76:79],a[172:175],v[68:71]
buffer_load_dwordx4 v0, s[12:15], s85 offen offset:3072 lds
M v[68:71],a[72:75],a[168:171],v[68:71]
SA s38,s38,128
MF v114,v5,v114
MF v115,v5,v115
M v[68:71],a[68:71],a[164:167],v[68:71]
SA m0,s28,65536
MF v120,v5,v120
MF v121,v5,v121
M v[68:71],a[64:67],a[160:163],v[68:71]
s_waitcnt lgkmcnt(0)
MF v122,v5,v122
MF v123,v5,v123
M v[72:75],a[96:99],a[128:131],0
SA s85,s38,0
T a[64:65],v20,0
T a[66:67],v20,2048
M v[72:75],a[100:103],a[132:135],v[72:75]
T a[68:69],v20,4096
T a[70:71],v20,6144
M v[72:75],a[104:107],a[136:139],v[72:75]
buffer_load_dwordx4 v0, s[12:15], s85 offen offset:0 lds
M v[72:75],a[108:111],a[140:143],v[72:75]
SA s85,s38,6144
T a[72:73],v20,8192
T a[74:75],v20,10240
M v[72:75],a[112:115],a[144:147],v[72:75]
T a[76:77],v20,12288
T a[78:79],v20,14336
M v[72:75],a[116:119],a[148:151],v[72:75]
buffer_load_dwordx4 v0, s[12:15], s85 offen offset:1024 lds
M v[72:75],a[120:123],a[152:155],v[72:75]
SA s85,s38,12288
T a[80:81],v20,16384
T a[82:83],v20,18432
M v[72:75],a[124:127],a[156:159],v[72:75]
T a[84:85],v20,20480
T a[86:87],v20,22528
M v[76:79],a[124:127],a[188:191],0
buffer_load_dwordx4 v0, s[12:15], s85 offen offset:2048 lds
M v[76:79],a[120:123],a[184:187],v[76:79]
SA s85,s38,18432
T a[88:89],v20,24576
T a[90:91],v20,26624
M v[76:79],a[116:119],a[180:183],v[76:79]
T a[92:93],v20,28672
T a[94:95],v20,30720
M v[76:79],a[112:115],a[176:179],v[76:79]
buffer_load_dwordx4 v0, s[12:15], s85 offen offset:3072 lds
M v[76:79],a[108:111],a[172:175],v[76:79]
SA m0,s28,69632
C v112,v112,v113
C v113,v114,v115
M v[76:79],a[104:107],a[168:171],v[76:79]
SA s85,s38,28672
C v114,v120,v121
C v115,v122,v123
M v[76:79],a[100:103],a[164:167],v[76:79]
buffer_store_dwordx4 v[112:115], v7, s[8:11], s29 offen offset:1024 sc1
M v[76:79],a[96:99],a[160:163],v[76:79]
s_waitcnt lgkmcnt(0)
MF v116,v6,v116
MF v117,v6,v117
M v[80:83],a[64:67],a[128:131],0
T a[96:97],v21,0
T a[98:99],v21,2048
M v[80:83],a[68:71],a[132:135],v[80:83]
T a[100:101],v21,4096
T a[102:103],v21,6144
M v[80:83],a[72:75],a[136:139],v[80:83]
buffer_load_dwordx4 v0, s[12:15], s85 offen offset:0 lds
M v[80:83],a[76:79],a[140:143],v[80:83]
SA s85,s38,34816
T a[104:105],v21,8192
T a[106:107],v21,10240
M v[80:83],a[80:83],a[144:147],v[80:83]
T a[108:109],v21,12288
T a[110:111],v21,14336
M v[80:83],a[84:87],a[148:151],v[80:83]
buffer_load_dwordx4 v0, s[12:15], s85 offen offset:1024 lds
M v[80:83],a[88:91],a[152:155],v[80:83]
SA s85,s38,40960
T a[112:113],v21,16384
T a[114:115],v21,18432
M v[80:83],a[92:95],a[156:159],v[80:83]
T a[116:117],v21,20480
T a[118:119],v21,22528
M v[84:87],a[92:95],a[188:191],0
buffer_load_dwordx4 v0, s[12:15], s85 offen offset:2048 lds
M v[84:87],a[88:91],a[184:187],v[84:87]
SA s85,s38,47104
T a[120:121],v21,24576
T a[122:123],v21,26624
M v[84:87],a[84:87],a[180:183],v[84:87]
T a[124:125],v21,28672
T a[126:127],v21,30720
M v[84:87],a[80:83],a[176:179],v[84:87]
buffer_load_dwordx4 v0, s[12:15], s85 offen offset:3072 lds
M v[84:87],a[76:79],a[172:175],v[84:87]
MF v118,v6,v118
MF v119,v6,v119
M v[84:87],a[72:75],a[168:171],v[84:87]
SA s38,s38,128
MF v124,v6,v124
MF v125,v6,v125
M v[84:87],a[68:71],a[164:167],v[84:87]
s_waitcnt vmcnt(29) lgkmcnt(0)
MF v126,v6,v126
MF v127,v6,v127
M v[84:87],a[64:67],a[160:163],v[84:87]
s_barrier
M v[88:91],a[96:99],a[128:131],0
s_nop 0
T a[64:65],v40,0
T a[66:67],v40,2048
M v[88:91],a[100:103],a[132:135],v[88:91]
T a[68:69],v40,4096
T a[70:71],v40,6144
M v[88:91],a[104:107],a[136:139],v[88:91]
C v116,v116,v117
C v117,v118,v119
M v[88:91],a[108:111],a[140:143],v[88:91]
T a[72:73],v40,8192
T a[74:75],v40,10240
M v[88:91],a[112:115],a[144:147],v[88:91]
T a[76:77],v40,12288
T a[78:79],v40,14336
M v[88:91],a[116:119],a[148:151],v[88:91]
C v118,v124,v125
C v119,v126,v127
M v[88:91],a[120:123],a[152:155],v[88:91]
T a[80:81],v40,16384
T a[82:83],v40,18432
M v[88:91],a[124:127],a[156:159],v[88:91]
T a[84:85],v40,20480
T a[86:87],v40,22528
M v[92:95],a[124:127],a[188:191],0
buffer_store_dwordx4 v[116:119], v7, s[8:11], s30 offen offset:1024 sc1
M v[92:95],a[120:123],a[184:187],v[92:95]
SA s29,s33,4096
T a[88:89],v40,24576
T a[90:91],v40,26624
M v[92:95],a[116:119],a[180:183],v[92:95]
SA s30,s33,18432
T a[92:93],v40,28672
T a[94:95],v40,30720
M v[92:95],a[112:115],a[176:179],v[92:95]
MF v64,v5,v64
MF v65,v5,v65
M v[92:95],a[108:111],a[172:175],v[92:95]
MF v66,v5,v66
MF v67,v5,v67
M v[92:95],a[104:107],a[168:171],v[92:95]
MF v72,v5,v72
MF v73,v5,v73
M v[92:95],a[100:103],a[164:167],v[92:95]
s_waitcnt lgkmcnt(0)
MF v74,v5,v74
MF v75,v5,v75
M v[92:95],a[96:99],a[160:163],v[92:95]
C v64,v64,v65
C v65,v66,v67
C v66,v72,v73
C v67,v74,v75
buffer_store_dwordx4 v[64:67], v7, s[8:11], s29 offen offset:0 sc1
MF v68,v6,v68
MF v69,v6,v69
MF v70,v6,v70
MF v71,v6,v71
MF v76,v6,v76
MF v77,v6,v77
MF v78,v6,v78
MF v79,v6,v79
C v68,v68,v69
C v69,v70,v71
C v70,v76,v77
C v71,v78,v79
buffer_store_dwordx4 v[68:71], v7, s[8:11], s30 offen offset:0 sc1
M v[96:99],a[64:67],a[128:131],0
s_nop 0
T a[96:97],v41,0
T a[98:99],v41,2048
M v[96:99],a[68:71],a[132:135],v[96:99]
T a[100:101],v41,4096
T a[102:103],v41,6144
M v[96:99],a[72:75],a[136:139],v[96:99]
MF v80,v5,v80
MF v81,v5,v81
M v[96:99],a[76:79],a[140:143],v[96:99]
T a[104:105],v41,8192
T a[106:107],v41,10240
M v[96:99],a[80:83],a[144:147],v[96:99]
T a[108:109],v41,12288
T a[110:111],v41,14336
M v[96:99],a[84:87],a[148:151],v[96:99]
MF v82,v5,v82
MF v83,v5,v83
M v[96:99],a[88:91],a[152:155],v[96:99]
T a[112:113],v41,16384
T a[114:115],v41,18432
M v[96:99],a[92:95],a[156:159],v[96:99]
T a[116:117],v41,20480
T a[118:119],v41,22528
M v[100:103],a[92:95],a[188:191],0
MF v88,v5,v88
MF v89,v5,v89
M v[100:103],a[88:91],a[184:187],v[100:103]
T a[120:121],v41,24576
T a[122:123],v41,26624
M v[100:103],a[84:87],a[180:183],v[100:103]
T a[124:125],v41,28672
T a[126:127],v41,30720
M v[100:103],a[80:83],a[176:179],v[100:103]
MF v90,v5,v90
MF v91,v5,v91
M v[100:103],a[76:79],a[172:175],v[100:103]
C v80,v80,v81
C v81,v82,v83
M v[100:103],a[72:75],a[168:171],v[100:103]
C v82,v88,v89
C v83,v90,v91
M v[100:103],a[68:71],a[164:167],v[100:103]
buffer_store_dwordx4 v[80:83], v7, s[8:11], s29 offen offset:1024 sc1
M v[100:103],a[64:67],a[160:163],v[100:103]
s_waitcnt lgkmcnt(0)
MF v84,v6,v84
MF v85,v6,v85
M v[104:107],a[96:99],a[128:131],0
T a[64:65],v42,0
T a[66:67],v42,2048
M v[104:107],a[100:103],a[132:135],v[104:107]
T a[68:69],v42,4096
T a[70:71],v42,6144
M v[104:107],a[104:107],a[136:139],v[104:107]
MF v86,v6,v86
MF v87,v6,v87
M v[104:107],a[108:111],a[140:143],v[104:107]
T a[72:73],v42,8192
T a[74:75],v42,10240
M v[104:107],a[112:115],a[144:147],v[104:107]
T a[76:77],v42,12288
T a[78:79],v42,14336
M v[104:107],a[116:119],a[148:151],v[104:107]
MF v92,v6,v92
MF v93,v6,v93
M v[104:107],a[120:123],a[152:155],v[104:107]
T a[80:81],v42,16384
T a[82:83],v42,18432
M v[104:107],a[124:127],a[156:159],v[104:107]
T a[84:85],v42,20480
T a[86:87],v42,22528
M v[108:111],a[124:127],a[188:191],0
MF v94,v6,v94
MF v95,v6,v95
M v[108:111],a[120:123],a[184:187],v[108:111]
T a[88:89],v42,24576
T a[90:91],v42,26624
M v[108:111],a[116:119],a[180:183],v[108:111]
T a[92:93],v42,28672
T a[94:95],v42,30720
M v[108:111],a[112:115],a[176:179],v[108:111]
C v84,v84,v85
C v85,v86,v87
M v[108:111],a[108:111],a[172:175],v[108:111]
C v86,v92,v93
C v87,v94,v95
M v[108:111],a[104:107],a[168:171],v[108:111]
buffer_store_dwordx4 v[84:87], v7, s[8:11], s30 offen offset:1024 sc1
M v[108:111],a[100:103],a[164:167],v[108:111]
SA s29,s33,6144
M v[108:111],a[96:99],a[160:163],v[108:111]
s_waitcnt lgkmcnt(0)
M v[112:115],a[64:67],a[128:131],0
SA s30,s33,20480
T a[96:97],v43,0
T a[98:99],v43,2048
M v[112:115],a[68:71],a[132:135],v[112:115]
T a[100:101],v43,4096
T a[102:103],v43,6144
M v[112:115],a[72:75],a[136:139],v[112:115]
MF v96,v5,v96
MF v97,v5,v97
M v[112:115],a[76:79],a[140:143],v[112:115]
T a[104:105],v43,8192
T a[106:107],v43,10240
M v[112:115],a[80:83],a[144:147],v[112:115]
T a[108:109],v43,12288
T a[110:111],v43,14336
M v[112:115],a[84:87],a[148:151],v[112:115]
MF v98,v5,v98
MF v99,v5,v99
M v[112:115],a[88:91],a[152:155],v[112:115]
T a[112:113],v43,16384
T a[114:115],v43,18432
M v[112:115],a[92:95],a[156:159],v[112:115]
T a[116:117],v43,20480
T a[118:119],v43,22528
M v[116:119],a[92:95],a[188:191],0
MF v104,v5,v104
MF v105,v5,v105
M v[116:119],a[88:91],a[184:187],v[116:119]
T a[120:121],v43,24576
T a[122:123],v43,26624
M v[116:119],a[84:87],a[180:183],v[116:119]
T a[124:125],v43,28672
T a[126:127],v43,30720
M v[116:119],a[80:83],a[176:179],v[116:119]
MF v106,v5,v106
MF v107,v5,v107
M v[116:119],a[76:79],a[172:175],v[116:119]
C v96,v96,v97
C v97,v98,v99
M v[116:119],a[72:75],a[168:171],v[116:119]
C v98,v104,v105
C v99,v106,v107
M v[116:119],a[68:71],a[164:167],v[116:119]
s_waitcnt vmcnt(25) lgkmcnt(0)
buffer_store_dwordx4 v[96:99], v7, s[8:11], s29 offen offset:0 sc1
M v[116:119],a[64:67],a[160:163],v[116:119]
s_barrier
M v[120:123],a[96:99],a[128:131],0
s_nop 0
T a[64:65],v18,32768
T a[66:67],v18,34816
M v[120:123],a[100:103],a[132:135],v[120:123]
T a[68:69],v18,36864
T a[70:71],v18,38912
M v[120:123],a[104:107],a[136:139],v[120:123]
MF v100,v6,v100
MF v101,v6,v101
M v[120:123],a[108:111],a[140:143],v[120:123]
T a[72:73],v18,40960
T a[74:75],v18,43008
M v[120:123],a[112:115],a[144:147],v[120:123]
T a[76:77],v18,45056
T a[78:79],v18,47104
M v[120:123],a[116:119],a[148:151],v[120:123]
MF v102,v6,v102
MF v103,v6,v103
M v[120:123],a[120:123],a[152:155],v[120:123]
T a[80:81],v18,49152
T a[82:83],v18,51200
M v[120:123],a[124:127],a[156:159],v[120:123]
T a[84:85],v18,53248
T a[86:87],v18,55296
M v[124:127],a[124:127],a[188:191],0
MF v108,v6,v108
MF v109,v6,v109
M v[124:127],a[120:123],a[184:187],v[124:127]
T a[88:89],v18,57344
T a[90:91],v18,59392
M v[124:127],a[116:119],a[180:183],v[124:127]
T a[92:93],v18,61440
T a[94:95],v18,63488
M v[124:127],a[112:115],a[176:179],v[124:127]
MF v110,v6,v110
MF v111,v6,v111
M v[124:127],a[108:111],a[172:175],v[124:127]
C v100,v100,v101
C v101,v102,v103
M v[124:127],a[104:107],a[168:171],v[124:127]
C v102,v108,v109
C v103,v110,v111
M v[124:127],a[100:103],a[164:167],v[124:127]
s_waitcnt lgkmcnt(0)
buffer_store_dwordx4 v[100:103], v7, s[8:11], s30 offen offset:0 sc1
M v[124:127],a[96:99],a[160:163],v[124:127]
M v[64:67],a[64:67],a[128:131],0
s_nop 0
T a[96:97],v19,32768
T a[98:99],v19,34816
M v[64:67],a[68:71],a[132:135],v[64:67]
T a[100:101],v19,36864
T a[102:103],v19,38912
M v[64:67],a[72:75],a[136:139],v[64:67]
v_lshrrev_b32 v32, 4, v7
MF v112,v5,v112
M v[64:67],a[76:79],a[140:143],v[64:67]
s_lshr_b32 s74, s41, 3
T a[104:105],v19,40960
T a[106:107],v19,43008
M v[64:67],a[80:83],a[144:147],v[64:67]
s_lshl_b32 s64, s42, 1
T a[108:109],v19,45056
T a[110:111],v19,47104
M v[64:67],a[84:87],a[148:151],v[64:67]
SA s46,s64,s74
MF v113,v5,v113
MF v114,v5,v114
M v[64:67],a[88:91],a[152:155],v[64:67]
s_mul_i32 s46, s46, 4352
T a[112:113],v19,49152
T a[114:115],v19,51200
M v[64:67],a[92:95],a[156:159],v[64:67]
s_and_b32 s72, s41, 7
T a[116:117],v19,53248
T a[118:119],v19,55296
M v[68:71],a[92:95],a[188:191],0
s_lshl_b32 s65, s72, 7
MF v115,v5,v115
MF v120,v5,v120
M v[68:71],a[88:91],a[184:187],v[68:71]
SA s46,s46,s65
T a[120:121],v19,57344
T a[122:123],v19,59392
M v[68:71],a[84:87],a[180:183],v[68:71]
SA s46,s46,104992768
T a[124:125],v19,61440
T a[126:127],v19,63488
M v[68:71],a[80:83],a[176:179],v[68:71]
v_and_b32 v33, 31, v32
MF v121,v5,v121
M v[68:71],a[76:79],a[172:175],v[68:71]
MF v122,v5,v122
MF v123,v5,v123
M v[68:71],a[72:75],a[168:171],v[68:71]
C v112,v112,v113
C v113,v114,v115
M v[68:71],a[68:71],a[164:167],v[68:71]
C v114,v120,v121
C v115,v122,v123
M v[68:71],a[64:67],a[160:163],v[68:71]
s_waitcnt lgkmcnt(0)
buffer_store_dwordx4 v[112:115], v7, s[8:11], s29 offen offset:1024 sc1
M v[72:75],a[96:99],a[128:131],0
s_nop 0
T a[64:65],v20,32768
T a[66:67],v20,34816
M v[72:75],a[100:103],a[132:135],v[72:75]
T a[68:69],v20,36864
T a[70:71],v20,38912
M v[72:75],a[104:107],a[136:139],v[72:75]
MF v116,v6,v116
MF v117,v6,v117
M v[72:75],a[108:111],a[140:143],v[72:75]
T a[72:73],v20,40960
T a[74:75],v20,43008
M v[72:75],a[112:115],a[144:147],v[72:75]
T a[76:77],v20,45056
T a[78:79],v20,47104
M v[72:75],a[116:119],a[148:151],v[72:75]
MF v118,v6,v118
MF v119,v6,v119
M v[72:75],a[120:123],a[152:155],v[72:75]
T a[80:81],v20,49152
T a[82:83],v20,51200
M v[72:75],a[124:127],a[156:159],v[72:75]
T a[84:85],v20,53248
T a[86:87],v20,55296
M v[76:79],a[124:127],a[188:191],0
MF v124,v6,v124
MF v125,v6,v125
M v[76:79],a[120:123],a[184:187],v[76:79]
T a[88:89],v20,57344
T a[90:91],v20,59392
M v[76:79],a[116:119],a[180:183],v[76:79]
T a[92:93],v20,61440
T a[94:95],v20,63488
M v[76:79],a[112:115],a[176:179],v[76:79]
MF v126,v6,v126
MF v127,v6,v127
M v[76:79],a[108:111],a[172:175],v[76:79]
C v116,v116,v117
C v117,v118,v119
M v[76:79],a[104:107],a[168:171],v[76:79]
C v118,v124,v125
C v119,v126,v127
M v[76:79],a[100:103],a[164:167],v[76:79]
buffer_store_dwordx4 v[116:119], v7, s[8:11], s30 offen offset:1024 sc1
M v[76:79],a[96:99],a[160:163],v[76:79]
s_waitcnt lgkmcnt(0)
v_lshlrev_b32 v33, 2, v33
M v[80:83],a[64:67],a[128:131],0
SA s29,s33,8192
T a[96:97],v21,32768
T a[98:99],v21,34816
M v[80:83],a[68:71],a[132:135],v[80:83]
SA s30,s33,22528
T a[100:101],v21,36864
T a[102:103],v21,38912
M v[80:83],a[72:75],a[136:139],v[80:83]
s_lshl_b32 s65, s41, 7
MF v64,v5,v64
MF v65,v5,v65
M v[80:83],a[76:79],a[140:143],v[80:83]
SA s65,s65,104890368
T a[104:105],v21,40960
T a[106:107],v21,43008
M v[80:83],a[80:83],a[144:147],v[80:83]
T a[108:109],v21,45056
T a[110:111],v21,47104
M v[80:83],a[84:87],a[148:151],v[80:83]
buffer_load_dword v31, v33, s[8:11], s65 offen sc1
M v[80:83],a[88:91],a[152:155],v[80:83]
s_nop 0
T a[112:113],v21,49152
T a[114:115],v21,51200
M v[80:83],a[92:95],a[156:159],v[80:83]
T a[116:117],v21,53248
T a[118:119],v21,55296
M v[84:87],a[92:95],a[188:191],0
v_bfe_u32 v34, v32, 4, 1
v_lshlrev_b32 v34, 1, v34
M v[84:87],a[88:91],a[184:187],v[84:87]
T a[120:121],v21,57344
T a[122:123],v21,59392
M v[84:87],a[84:87],a[180:183],v[84:87]
T a[124:125],v21,61440
T a[126:127],v21,63488
M v[84:87],a[80:83],a[176:179],v[84:87]
v_lshrrev_b32 v35, 5, v32
v_add_u32 v34, v34, v35
M v[84:87],a[76:79],a[172:175],v[84:87]
s_mov_b32 s52, s96
MF v66,v5,v66
MF v67,v5,v67
M v[84:87],a[72:75],a[168:171],v[84:87]
s_and_b32 s53, s97, 0xffff
MF v72,v5,v72
MF v73,v5,v73
M v[84:87],a[68:71],a[164:167],v[84:87]
s_waitcnt vmcnt(19) lgkmcnt(0)
MF v74,v5,v74
MF v75,v5,v75
M v[84:87],a[64:67],a[160:163],v[84:87]
s_barrier
M v[88:91],a[96:99],a[128:131],0
s_mov_b32 s54, 1835008
T a[64:65],v22,32768
T a[66:67],v22,34816
M v[88:91],a[100:103],a[132:135],v[88:91]
s_mov_b32 s55, 0x20000
T a[68:69],v22,36864
T a[70:71],v22,38912
M v[88:91],a[104:107],a[136:139],v[88:91]
s_mul_i32 s77, s42, 1835008
C v64,v64,v65
C v65,v66,v67
M v[88:91],a[108:111],a[140:143],v[88:91]
s_mul_i32 s78, s72, 14336
T a[72:73],v22,40960
T a[74:75],v22,43008
M v[88:91],a[112:115],a[144:147],v[88:91]
SA s77,s77,s78
T a[76:77],v22,45056
T a[78:79],v22,47104
M v[88:91],a[116:119],a[148:151],v[88:91]
SA s77,s77,67108864
C v66,v72,v73
C v67,v74,v75
M v[88:91],a[120:123],a[152:155],v[88:91]
s_lshl_b32 s79, s74, 1
T a[80:81],v22,49152
T a[82:83],v22,51200
M v[88:91],a[124:127],a[156:159],v[88:91]
SA s79,s79,s20
T a[84:85],v22,53248
T a[86:87],v22,55296
M v[92:95],a[124:127],a[188:191],0
s_lshl_b32 s71, s74, 1
buffer_store_dwordx4 v[64:67], v7, s[8:11], s29 offen offset:0 sc1
M v[92:95],a[120:123],a[184:187],v[92:95]
SA s71,s71,1
T a[88:89],v22,57344
T a[90:91],v22,59392
M v[92:95],a[116:119],a[180:183],v[92:95]
s_sub_u32 s71, s71, s20
T a[92:93],v22,61440
T a[94:95],v22,63488
M v[92:95],a[112:115],a[176:179],v[92:95]
s_and_b32 s71, s71, 536870912
MF v68,v6,v68
MF v69,v6,v69
M v[92:95],a[108:111],a[172:175],v[92:95]
s_sub_u32 s64, 15, s64
MF v70,v6,v70
MF v71,v6,v71
M v[92:95],a[104:107],a[168:171],v[92:95]
s_sub_u32 s78, s64, 1
MF v76,v6,v76
MF v77,v6,v77
M v[92:95],a[100:103],a[164:167],v[92:95]
s_waitcnt lgkmcnt(0)
MF v78,v6,v78
MF v79,v6,v79
M v[92:95],a[96:99],a[160:163],v[92:95]
s_mul_i32 s78, s78, 1835008
SA s78,s78,s77
s_lshl_b32 s65, s79, 10
SA s78,s78,s65
SA s78,s78,s71
s_lshl_b32 s79, s79, 6
s_or_b32 s79, s79, s71
s_mul_i32 s67, s74, -2
s_lshl_b32 s74, s74, 3
SA s74,s74,s20
s_lshl_b32 s75, s74, 6
SA s76,s75,256
SA s67,s67,3
s_sub_u32 s67, s67, s20
s_and_b32 s67, s67, 536870912
s_or_b32 s76, s76, s67
v_or_b32 v27, s67, v7
v_add_u32 v27, 4096, v27
s_lshl_b32 s65, s74, 10
SA s77,s77,s65
s_lshl_b32 s64, s64, 7
s_lshr_b32 s73, s72, 1
s_sub_u32 s65, 7, s73
s_bitcmp1_b32 s72, 0
s_cselect_b32 s73, s65, s73
s_lshl_b32 s73, s73, 4
s_lshl_b32 s65, s42, 7
SA s73,s73,s65
v_and_b32 v37, 15, v32
v_add_u32 v37, s73, v37
v_add_u32 v29, s64, v37
s_mov_b32 s64, 104857664
v_mul_u32_u24 v38, 896, v37
v_lshl_add_u32 v38, v34, 4, v38
v_lshrrev_b32 v35, 4, v37
v_lshlrev_b32 v35, 5, v35
v_and_b32 v36, 15, v37
v_add_lshl_u32 v35, v35, v36, 2
buffer_load_dword v39, v35, s[8:11], s64 offen sc1
C v68,v68,v69
C v69,v70,v71
C v70,v76,v77
C v71,v78,v79
buffer_store_dwordx4 v[68:71], v7, s[8:11], s30 offen offset:0 sc1
buffer_load_dwordx4 v[48:51], v38, s[56:59], s75 offen
buffer_load_dwordx4 v[52:55], v38, s[56:59], s76 offen
v_mul_u32_u24 v28, 896, v29
v_lshl_add_u32 v28, v34, 4, v28
v_lshrrev_b32 v35, 4, v29
v_lshlrev_b32 v35, 5, v35
v_and_b32 v36, 15, v29
v_add_lshl_u32 v35, v35, v36, 2
buffer_load_dword v26, v35, s[8:11], s64 offen sc1
buffer_load_dwordx4 v[44:47], v28, s[56:59], s79 offen
M v[96:99],a[64:67],a[128:131],0
s_nop 0
T a[96:97],v23,32768
T a[98:99],v23,34816
M v[96:99],a[68:71],a[132:135],v[96:99]
T a[100:101],v23,36864
T a[102:103],v23,38912
M v[96:99],a[72:75],a[136:139],v[96:99]
MF v80,v5,v80
MF v81,v5,v81
M v[96:99],a[76:79],a[140:143],v[96:99]
T a[104:105],v23,40960
T a[106:107],v23,43008
M v[96:99],a[80:83],a[144:147],v[96:99]
T a[108:109],v23,45056
T a[110:111],v23,47104
M v[96:99],a[84:87],a[148:151],v[96:99]
MF v82,v5,v82
MF v83,v5,v83
M v[96:99],a[88:91],a[152:155],v[96:99]
T a[112:113],v23,49152
T a[114:115],v23,51200
M v[96:99],a[92:95],a[156:159],v[96:99]
T a[116:117],v23,53248
T a[118:119],v23,55296
M v[100:103],a[92:95],a[188:191],0
MF v88,v5,v88
MF v89,v5,v89
M v[100:103],a[88:91],a[184:187],v[100:103]
T a[120:121],v23,57344
T a[122:123],v23,59392
M v[100:103],a[84:87],a[180:183],v[100:103]
T a[124:125],v23,61440
T a[126:127],v23,63488
M v[100:103],a[80:83],a[176:179],v[100:103]
MF v90,v5,v90
MF v91,v5,v91
M v[100:103],a[76:79],a[172:175],v[100:103]
C v80,v80,v81
C v81,v82,v83
M v[100:103],a[72:75],a[168:171],v[100:103]
C v82,v88,v89
C v83,v90,v91
M v[100:103],a[68:71],a[164:167],v[100:103]
buffer_store_dwordx4 v[80:83], v7, s[8:11], s29 offen offset:1024 sc1
M v[100:103],a[64:67],a[160:163],v[100:103]
s_waitcnt lgkmcnt(0)
MF v84,v6,v84
MF v85,v6,v85
M v[104:107],a[96:99],a[128:131],0
T a[64:65],v24,32768
T a[66:67],v24,34816
M v[104:107],a[100:103],a[132:135],v[104:107]
T a[68:69],v24,36864
T a[70:71],v24,38912
M v[104:107],a[104:107],a[136:139],v[104:107]
MF v86,v6,v86
MF v87,v6,v87
M v[104:107],a[108:111],a[140:143],v[104:107]
T a[72:73],v24,40960
T a[74:75],v24,43008
M v[104:107],a[112:115],a[144:147],v[104:107]
T a[76:77],v24,45056
T a[78:79],v24,47104
M v[104:107],a[116:119],a[148:151],v[104:107]
MF v92,v6,v92
MF v93,v6,v93
M v[104:107],a[120:123],a[152:155],v[104:107]
T a[80:81],v24,49152
T a[82:83],v24,51200
M v[104:107],a[124:127],a[156:159],v[104:107]
T a[84:85],v24,53248
T a[86:87],v24,55296
M v[108:111],a[124:127],a[188:191],0
MF v94,v6,v94
MF v95,v6,v95
M v[108:111],a[120:123],a[184:187],v[108:111]
T a[88:89],v24,57344
T a[90:91],v24,59392
M v[108:111],a[116:119],a[180:183],v[108:111]
T a[92:93],v24,61440
T a[94:95],v24,63488
M v[108:111],a[112:115],a[176:179],v[108:111]
C v84,v84,v85
C v85,v86,v87
M v[108:111],a[108:111],a[172:175],v[108:111]
C v86,v92,v93
C v87,v94,v95
M v[108:111],a[104:107],a[168:171],v[108:111]
buffer_store_dwordx4 v[84:87], v7, s[8:11], s30 offen offset:1024 sc1
M v[108:111],a[100:103],a[164:167],v[108:111]
SA s29,s33,10240
M v[108:111],a[96:99],a[160:163],v[108:111]
s_waitcnt lgkmcnt(0)
M v[112:115],a[64:67],a[128:131],0
SA s30,s33,24576
T a[96:97],v25,32768
T a[98:99],v25,34816
M v[112:115],a[68:71],a[132:135],v[112:115]
T a[100:101],v25,36864
T a[102:103],v25,38912
M v[112:115],a[72:75],a[136:139],v[112:115]
MF v96,v5,v96
MF v97,v5,v97
M v[112:115],a[76:79],a[140:143],v[112:115]
T a[104:105],v25,40960
T a[106:107],v25,43008
M v[112:115],a[80:83],a[144:147],v[112:115]
T a[108:109],v25,45056
T a[110:111],v25,47104
M v[112:115],a[84:87],a[148:151],v[112:115]
MF v98,v5,v98
MF v99,v5,v99
M v[112:115],a[88:91],a[152:155],v[112:115]
T a[112:113],v25,49152
T a[114:115],v25,51200
M v[112:115],a[92:95],a[156:159],v[112:115]
T a[116:117],v25,53248
T a[118:119],v25,55296
M v[116:119],a[92:95],a[188:191],0
s_mov_b32 s84, s45
MF v104,v5,v104
MF v105,v5,v105
M v[116:119],a[88:91],a[184:187],v[116:119]
T a[120:121],v25,57344
T a[122:123],v25,59392
M v[116:119],a[84:87],a[180:183],v[116:119]
T a[124:125],v25,61440
T a[126:127],v25,63488
M v[116:119],a[80:83],a[176:179],v[116:119]
MF v106,v5,v106
MF v107,v5,v107
M v[116:119],a[76:79],a[172:175],v[116:119]
C v96,v96,v97
C v97,v98,v99
M v[116:119],a[72:75],a[168:171],v[116:119]
C v98,v104,v105
C v99,v106,v107
M v[116:119],a[68:71],a[164:167],v[116:119]
s_waitcnt vmcnt(19) lgkmcnt(0)
buffer_store_dwordx4 v[96:99], v7, s[8:11], s29 offen offset:0 sc1
M v[116:119],a[64:67],a[160:163],v[116:119]
s_barrier
M v[120:123],a[96:99],a[128:131],0
s_nop 0
T a[64:65],v22,0
T a[66:67],v22,2048
M v[120:123],a[100:103],a[132:135],v[120:123]
T a[68:69],v22,4096
T a[70:71],v22,6144
M v[120:123],a[104:107],a[136:139],v[120:123]
MF v100,v6,v100
MF v101,v6,v101
M v[120:123],a[108:111],a[140:143],v[120:123]
T a[72:73],v22,8192
T a[74:75],v22,10240
M v[120:123],a[112:115],a[144:147],v[120:123]
s_waitcnt vmcnt(11)
T a[76:77],v22,12288
T a[78:79],v22,14336
M v[120:123],a[116:119],a[148:151],v[120:123]
buffer_store_dword v15, v17, s[8:11], s84 offen sc1
M v[120:123],a[120:123],a[152:155],v[120:123]
s_nop 0
T a[80:81],v22,16384
T a[82:83],v22,18432
M v[120:123],a[124:127],a[156:159],v[120:123]
T a[84:85],v22,20480
T a[86:87],v22,22528
M v[124:127],a[124:127],a[188:191],0
MF v102,v6,v102
MF v103,v6,v103
M v[124:127],a[120:123],a[184:187],v[124:127]
T a[88:89],v22,24576
T a[90:91],v22,26624
M v[124:127],a[116:119],a[180:183],v[124:127]
T a[92:93],v22,28672
T a[94:95],v22,30720
M v[124:127],a[112:115],a[176:179],v[124:127]
MF v108,v6,v108
MF v109,v6,v109
M v[124:127],a[108:111],a[172:175],v[124:127]
MF v110,v6,v110
MF v111,v6,v111
M v[124:127],a[104:107],a[168:171],v[124:127]
C v100,v100,v101
C v101,v102,v103
M v[124:127],a[100:103],a[164:167],v[124:127]
s_waitcnt lgkmcnt(0)
C v102,v108,v109
C v103,v110,v111
M v[124:127],a[96:99],a[160:163],v[124:127]
buffer_store_dwordx4 v[100:103], v7, s[8:11], s30 offen offset:0 sc1
M v[64:67],a[64:67],a[128:131],0
s_nop 0
T a[96:97],v23,0
T a[98:99],v23,2048
M v[64:67],a[68:71],a[132:135],v[64:67]
T a[100:101],v23,4096
T a[102:103],v23,6144
M v[64:67],a[72:75],a[136:139],v[64:67]
MF v112,v5,v112
MF v113,v5,v113
M v[64:67],a[76:79],a[140:143],v[64:67]
T a[104:105],v23,8192
T a[106:107],v23,10240
M v[64:67],a[80:83],a[144:147],v[64:67]
T a[108:109],v23,12288
T a[110:111],v23,14336
M v[64:67],a[84:87],a[148:151],v[64:67]
MF v114,v5,v114
MF v115,v5,v115
M v[64:67],a[88:91],a[152:155],v[64:67]
T a[112:113],v23,16384
T a[114:115],v23,18432
M v[64:67],a[92:95],a[156:159],v[64:67]
T a[116:117],v23,20480
T a[118:119],v23,22528
M v[68:71],a[92:95],a[188:191],0
MF v120,v5,v120
MF v121,v5,v121
M v[68:71],a[88:91],a[184:187],v[68:71]
T a[120:121],v23,24576
T a[122:123],v23,26624
M v[68:71],a[84:87],a[180:183],v[68:71]
T a[124:125],v23,28672
T a[126:127],v23,30720
M v[68:71],a[80:83],a[176:179],v[68:71]
MF v122,v5,v122
MF v123,v5,v123
M v[68:71],a[76:79],a[172:175],v[68:71]
C v112,v112,v113
C v113,v114,v115
M v[68:71],a[72:75],a[168:171],v[68:71]
C v114,v120,v121
C v115,v122,v123
M v[68:71],a[68:71],a[164:167],v[68:71]
buffer_store_dwordx4 v[112:115], v7, s[8:11], s29 offen offset:1024 sc1
M v[68:71],a[64:67],a[160:163],v[68:71]
s_waitcnt lgkmcnt(0)
MF v116,v6,v116
MF v117,v6,v117
M v[72:75],a[96:99],a[128:131],0
T a[64:65],v24,0
T a[66:67],v24,2048
M v[72:75],a[100:103],a[132:135],v[72:75]
T a[68:69],v24,4096
T a[70:71],v24,6144
M v[72:75],a[104:107],a[136:139],v[72:75]
MF v118,v6,v118
MF v119,v6,v119
M v[72:75],a[108:111],a[140:143],v[72:75]
T a[72:73],v24,8192
T a[74:75],v24,10240
M v[72:75],a[112:115],a[144:147],v[72:75]
T a[76:77],v24,12288
T a[78:79],v24,14336
M v[72:75],a[116:119],a[148:151],v[72:75]
MF v124,v6,v124
MF v125,v6,v125
M v[72:75],a[120:123],a[152:155],v[72:75]
T a[80:81],v24,16384
T a[82:83],v24,18432
M v[72:75],a[124:127],a[156:159],v[72:75]
T a[84:85],v24,20480
T a[86:87],v24,22528
M v[76:79],a[124:127],a[188:191],0
MF v126,v6,v126
MF v127,v6,v127
M v[76:79],a[120:123],a[184:187],v[76:79]
T a[88:89],v24,24576
T a[90:91],v24,26624
M v[76:79],a[116:119],a[180:183],v[76:79]
T a[92:93],v24,28672
T a[94:95],v24,30720
M v[76:79],a[112:115],a[176:179],v[76:79]
C v116,v116,v117
C v117,v118,v119
M v[76:79],a[108:111],a[172:175],v[76:79]
C v118,v124,v125
C v119,v126,v127
M v[76:79],a[104:107],a[168:171],v[76:79]
buffer_store_dwordx4 v[116:119], v7, s[8:11], s30 offen offset:1024 sc1
M v[76:79],a[100:103],a[164:167],v[76:79]
SA s29,s33,12288
M v[76:79],a[96:99],a[160:163],v[76:79]
s_waitcnt lgkmcnt(0)
M v[80:83],a[64:67],a[128:131],0
SA s30,s33,26624
T a[96:97],v25,0
T a[98:99],v25,2048
M v[80:83],a[68:71],a[132:135],v[80:83]
T a[100:101],v25,4096
T a[102:103],v25,6144
M v[80:83],a[72:75],a[136:139],v[80:83]
MF v64,v5,v64
MF v65,v5,v65
M v[80:83],a[76:79],a[140:143],v[80:83]
T a[104:105],v25,8192
T a[106:107],v25,10240
M v[80:83],a[80:83],a[144:147],v[80:83]
T a[108:109],v25,12288
T a[110:111],v25,14336
M v[80:83],a[84:87],a[148:151],v[80:83]
MF v66,v5,v66
MF v67,v5,v67
M v[80:83],a[88:91],a[152:155],v[80:83]
T a[112:113],v25,16384
T a[114:115],v25,18432
M v[80:83],a[92:95],a[156:159],v[80:83]
T a[116:117],v25,20480
T a[118:119],v25,22528
M v[84:87],a[92:95],a[188:191],0
MF v72,v5,v72
MF v73,v5,v73
M v[84:87],a[88:91],a[184:187],v[84:87]
T a[120:121],v25,24576
T a[122:123],v25,26624
M v[84:87],a[84:87],a[180:183],v[84:87]
T a[124:125],v25,28672
T a[126:127],v25,30720
M v[84:87],a[80:83],a[176:179],v[84:87]
MF v74,v5,v74
MF v75,v5,v75
M v[84:87],a[76:79],a[172:175],v[84:87]
C v64,v64,v65
C v65,v66,v67
M v[84:87],a[72:75],a[168:171],v[84:87]
C v66,v72,v73
C v67,v74,v75
M v[84:87],a[68:71],a[164:167],v[84:87]
buffer_store_dwordx4 v[64:67], v7, s[8:11], s29 offen offset:0 sc1
M v[84:87],a[64:67],a[160:163],v[84:87]
s_waitcnt lgkmcnt(0)
MF v68,v6,v68
MF v69,v6,v69
M v[88:91],a[96:99],a[128:131],0
MF v70,v6,v70
MF v71,v6,v71
M v[88:91],a[100:103],a[132:135],v[88:91]
MF v76,v6,v76
MF v77,v6,v77
M v[88:91],a[104:107],a[136:139],v[88:91]
MF v78,v6,v78
MF v79,v6,v79
M v[88:91],a[108:111],a[140:143],v[88:91]
C v68,v68,v69
C v69,v70,v71
M v[88:91],a[112:115],a[144:147],v[88:91]
C v70,v76,v77
C v71,v78,v79
M v[88:91],a[116:119],a[148:151],v[88:91]
buffer_store_dwordx4 v[68:71], v7, s[8:11], s30 offen offset:0 sc1
M v[88:91],a[120:123],a[152:155],v[88:91]
M v[88:91],a[124:127],a[156:159],v[88:91]
M v[92:95],a[124:127],a[188:191],0
M v[92:95],a[120:123],a[184:187],v[92:95]
M v[92:95],a[116:119],a[180:183],v[92:95]
M v[92:95],a[112:115],a[176:179],v[92:95]
MF v80,v5,v80
MF v81,v5,v81
M v[92:95],a[108:111],a[172:175],v[92:95]
MF v82,v5,v82
MF v83,v5,v83
M v[92:95],a[104:107],a[168:171],v[92:95]
MF v88,v5,v88
MF v89,v5,v89
M v[92:95],a[100:103],a[164:167],v[92:95]
MF v90,v5,v90
MF v91,v5,v91
M v[92:95],a[96:99],a[160:163],v[92:95]
C v80,v80,v81
C v81,v82,v83
C v82,v88,v89
C v83,v90,v91
buffer_store_dwordx4 v[80:83], v7, s[8:11], s29 offen offset:1024 sc1
MF v84,v6,v84
MF v85,v6,v85
MF v86,v6,v86
MF v87,v6,v87
MF v92,v6,v92
MF v93,v6,v93
MF v94,v6,v94
MF v95,v6,v95
C v84,v84,v85
C v85,v86,v87
C v86,v92,v93
C v87,v94,v95
buffer_store_dwordx4 v[84:87], v7, s[8:11], s30 offen offset:1024 sc1
buffer_load_dword v9, v33, s[8:11], s46 offen sc1
s_waitcnt vmcnt(1)
buffer_store_dword v15, v16, s[8:11], s3 offen sc1
L_red1:
s_waitcnt vmcnt(0)
v_cmp_eq_u32 vcc, 1, v9
s_mov_b32 s91, 65536
s_mov_b32 s69, 0xffff
s_and_b32 s70, vcc_lo, s69
s_mov_b32 s68, s70
s_cmp_lg_u32 s70, 0
s_cbranch_scc1 L_rk0
s_call_b64 s[36:37], L_rpoll
L_rk0:
s_ff1_i32_b32 s71, s70
s_bitset0_b32 s70, s71
s_mul_i32 s71, s71, 114688
SA s72,s71,s77
buffer_load_dwordx4 v[128:131], v7, s[8:11], s72 offen sc1
buffer_load_dwordx4 v[132:135], v27, s[8:11], s72 offen sc1
s_cmp_lg_u32 s70, 0
s_cbranch_scc1 L_rk1
s_call_b64 s[36:37], L_rpoll
L_rk1:
s_ff1_i32_b32 s71, s70
s_bitset0_b32 s70, s71
s_mul_i32 s71, s71, 114688
SA s72,s71,s77
buffer_load_dwordx4 v[136:139], v7, s[8:11], s72 offen sc1
buffer_load_dwordx4 v[140:143], v27, s[8:11], s72 offen sc1
s_cmp_lg_u32 s70, 0
s_cbranch_scc1 L_rk2
s_call_b64 s[36:37], L_rpoll
L_rk2:
s_ff1_i32_b32 s71, s70
s_bitset0_b32 s70, s71
s_mul_i32 s71, s71, 114688
SA s72,s71,s77
buffer_load_dwordx4 v[144:147], v7, s[8:11], s72 offen sc1
buffer_load_dwordx4 v[148:151], v27, s[8:11], s72 offen sc1
v_readlane_b32 s92, v31, 0
v_readlane_b32 s94, v31, 1
v_lshlrev_b32 v64, 16, v48
v_and_b32 v65, 0xffff0000, v48
v_lshlrev_b32 v66, 16, v49
v_and_b32 v67, 0xffff0000, v49
v_lshlrev_b32 v68, 16, v50
v_and_b32 v69, 0xffff0000, v50
v_lshlrev_b32 v70, 16, v51
v_and_b32 v71, 0xffff0000, v51
v_lshlrev_b32 v72, 16, v52
v_and_b32 v73, 0xffff0000, v52
v_lshlrev_b32 v74, 16, v53
v_and_b32 v75, 0xffff0000, v53
v_lshlrev_b32 v76, 16, v54
v_and_b32 v77, 0xffff0000, v54
v_lshlrev_b32 v78, 16, v55
v_and_b32 v79, 0xffff0000, v55
v_sub_f32 v30, 1.0, v39
v_cmp_eq_u32 s[80:81], s92, v37
v_cmp_eq_u32 s[82:83], s94, v37
s_nop 0
s_or_b64 vcc, s[80:81], s[82:83]
s_cbranch_vccnz L_moe0
L_moe_ret0:
MF v64,v30,v64
MF v65,v30,v65
MF v66,v30,v66
MF v67,v30,v67
MF v68,v30,v68
MF v69,v30,v69
MF v70,v30,v70
MF v71,v30,v71
MF v72,v30,v72
MF v73,v30,v73
MF v74,v30,v74
MF v75,v30,v75
MF v76,v30,v76
MF v77,v30,v77
MF v78,v30,v78
MF v79,v30,v79
s_cmp_lg_u32 s70, 0
s_cbranch_scc1 L_rk3
s_call_b64 s[36:37], L_rpoll
L_rk3:
s_ff1_i32_b32 s71, s70
s_bitset0_b32 s70, s71
s_mul_i32 s71, s71, 114688
SA s72,s71,s77
buffer_load_dwordx4 v[152:155], v7, s[8:11], s72 offen sc1
buffer_load_dwordx4 v[156:159], v27, s[8:11], s72 offen sc1
v_lshlrev_b32 v80, 16, v44
v_and_b32 v81, 0xffff0000, v44
v_lshlrev_b32 v82, 16, v45
v_and_b32 v83, 0xffff0000, v45
v_lshlrev_b32 v84, 16, v46
v_and_b32 v85, 0xffff0000, v46
v_lshlrev_b32 v86, 16, v47
v_and_b32 v87, 0xffff0000, v47
v_sub_f32 v30, 1.0, v26
v_cmp_eq_u32 s[80:81], s92, v29
v_cmp_eq_u32 s[82:83], s94, v29
s_nop 0
s_or_b64 vcc, s[80:81], s[82:83]
s_cbranch_vccnz L_moe1
L_moe_ret1:
MF v80,v30,v80
MF v81,v30,v81
MF v82,v30,v82
MF v83,v30,v83
MF v84,v30,v84
MF v85,v30,v85
MF v86,v30,v86
MF v87,v30,v87
s_waitcnt vmcnt(7)
M v[96:99],a[246:249],v[128:131],0
M v[100:103],a[244:247],v[128:131],0
s_waitcnt vmcnt(6)
M v[104:107],a[246:249],v[132:135],0
M v[108:111],a[244:247],v[132:135],0
s_cmp_lg_u32 s70, 0
s_cbranch_scc1 L_rk4
s_call_b64 s[36:37], L_rpoll
L_rk4:
s_ff1_i32_b32 s71, s70
s_bitset0_b32 s70, s71
s_mul_i32 s71, s71, 114688
SA s72,s71,s77
buffer_load_dwordx4 v[160:163], v7, s[8:11], s72 offen sc1
buffer_load_dwordx4 v[164:167], v27, s[8:11], s72 offen sc1
s_waitcnt vmcnt(7)
M v[96:99],a[246:249],v[136:139],v[96:99]
M v[100:103],a[244:247],v[136:139],v[100:103]
s_waitcnt vmcnt(6)
M v[104:107],a[246:249],v[140:143],v[104:107]
M v[108:111],a[244:247],v[140:143],v[108:111]
s_cmp_lg_u32 s70, 0
s_cbranch_scc1 L_rk5
s_call_b64 s[36:37], L_rpoll
L_rk5:
s_ff1_i32_b32 s71, s70
s_bitset0_b32 s70, s71
s_mul_i32 s71, s71, 114688
SA s72,s71,s77
buffer_load_dwordx4 v[168:171], v7, s[8:11], s72 offen sc1
buffer_load_dwordx4 v[172:175], v27, s[8:11], s72 offen sc1
s_waitcnt vmcnt(7)
M v[96:99],a[246:249],v[144:147],v[96:99]
M v[100:103],a[244:247],v[144:147],v[100:103]
s_waitcnt vmcnt(6)
M v[104:107],a[246:249],v[148:151],v[104:107]
M v[108:111],a[244:247],v[148:151],v[108:111]
s_cmp_lg_u32 s70, 0
s_cbranch_scc1 L_rk6
s_call_b64 s[36:37], L_rpoll
L_rk6:
s_ff1_i32_b32 s71, s70
s_bitset0_b32 s70, s71
s_mul_i32 s71, s71, 114688
SA s72,s71,s77
buffer_load_dwordx4 v[176:179], v7, s[8:11], s72 offen sc1
buffer_load_dwordx4 v[180:183], v27, s[8:11], s72 offen sc1
s_waitcnt vmcnt(7)
M v[96:99],a[246:249],v[152:155],v[96:99]
M v[100:103],a[244:247],v[152:155],v[100:103]
s_waitcnt vmcnt(6)
M v[104:107],a[246:249],v[156:159],v[104:107]
M v[108:111],a[244:247],v[156:159],v[108:111]
s_cmp_lg_u32 s70, 0
s_cbranch_scc1 L_rk7
s_call_b64 s[36:37], L_rpoll
L_rk7:
s_ff1_i32_b32 s71, s70
s_bitset0_b32 s70, s71
s_mul_i32 s71, s71, 114688
SA s72,s71,s77
buffer_load_dwordx4 v[184:187], v7, s[8:11], s72 offen sc1
buffer_load_dwordx4 v[188:191], v27, s[8:11], s72 offen sc1
s_waitcnt vmcnt(7)
M v[96:99],a[246:249],v[160:163],v[96:99]
M v[100:103],a[244:247],v[160:163],v[100:103]
s_waitcnt vmcnt(6)
M v[104:107],a[246:249],v[164:167],v[104:107]
M v[108:111],a[244:247],v[164:167],v[108:111]
s_cmp_lg_u32 s70, 0
s_cbranch_scc1 L_rk8
s_call_b64 s[36:37], L_rpoll
L_rk8:
s_ff1_i32_b32 s71, s70
s_bitset0_b32 s70, s71
s_mul_i32 s71, s71, 114688
SA s72,s71,s77
buffer_load_dwordx4 v[128:131], v7, s[8:11], s72 offen sc1
buffer_load_dwordx4 v[132:135], v27, s[8:11], s72 offen sc1
s_waitcnt vmcnt(7)
M v[96:99],a[246:249],v[168:171],v[96:99]
M v[100:103],a[244:247],v[168:171],v[100:103]
s_waitcnt vmcnt(6)
M v[104:107],a[246:249],v[172:175],v[104:107]
M v[108:111],a[244:247],v[172:175],v[108:111]
s_cmp_lg_u32 s70, 0
s_cbranch_scc1 L_rk9
s_call_b64 s[36:37], L_rpoll
L_rk9:
s_ff1_i32_b32 s71, s70
s_bitset0_b32 s70, s71
s_mul_i32 s71, s71, 114688
SA s72,s71,s77
buffer_load_dwordx4 v[136:139], v7, s[8:11], s72 offen sc1
buffer_load_dwordx4 v[140:143], v27, s[8:11], s72 offen sc1
s_waitcnt vmcnt(7)
M v[96:99],a[246:249],v[176:179],v[96:99]
M v[100:103],a[244:247],v[176:179],v[100:103]
s_waitcnt vmcnt(6)
M v[104:107],a[246:249],v[180:183],v[104:107]
M v[108:111],a[244:247],v[180:183],v[108:111]
s_cmp_lg_u32 s70, 0
s_cbranch_scc1 L_rk10
s_call_b64 s[36:37], L_rpoll
L_rk10:
s_ff1_i32_b32 s71, s70
s_bitset0_b32 s70, s71
s_mul_i32 s71, s71, 114688
SA s72,s71,s77
buffer_load_dwordx4 v[144:147], v7, s[8:11], s72 offen sc1
buffer_load_dwordx4 v[148:151], v27, s[8:11], s72 offen sc1
s_waitcnt vmcnt(7)
M v[96:99],a[246:249],v[184:187],v[96:99]
M v[100:103],a[244:247],v[184:187],v[100:103]
s_waitcnt vmcnt(6)
M v[104:107],a[246:249],v[188:191],v[104:107]
M v[108:111],a[244:247],v[188:191],v[108:111]
s_cmp_lg_u32 s70, 0
s_cbranch_scc1 L_rk11
s_call_b64 s[36:37], L_rpoll
L_rk11:
s_ff1_i32_b32 s71, s70
s_bitset0_b32 s70, s71
s_mul_i32 s71, s71, 114688
SA s72,s71,s77
buffer_load_dwordx4 v[152:155], v7, s[8:11], s72 offen sc1
buffer_load_dwordx4 v[156:159], v27, s[8:11], s72 offen sc1
s_waitcnt vmcnt(7)
M v[96:99],a[246:249],v[128:131],v[96:99]
M v[100:103],a[244:247],v[128:131],v[100:103]
s_waitcnt vmcnt(6)
M v[104:107],a[246:249],v[132:135],v[104:107]
M v[108:111],a[244:247],v[132:135],v[108:111]
s_cmp_lg_u32 s70, 0
s_cbranch_scc1 L_rk12
s_call_b64 s[36:37], L_rpoll
L_rk12:
s_ff1_i32_b32 s71, s70
s_bitset0_b32 s70, s71
s_mul_i32 s71, s71, 114688
SA s72,s71,s77
buffer_load_dwordx4 v[160:163], v7, s[8:11], s72 offen sc1
buffer_load_dwordx4 v[164:167], v27, s[8:11], s72 offen sc1
buffer_load_dword v8, v33, s[8:11], s46 offen sc1
s_waitcnt vmcnt(8)
M v[96:99],a[246:249],v[136:139],v[96:99]
M v[100:103],a[244:247],v[136:139],v[100:103]
s_waitcnt vmcnt(7)
M v[104:107],a[246:249],v[140:143],v[104:107]
M v[108:111],a[244:247],v[140:143],v[108:111]
s_cmp_lg_u32 s70, 0
s_cbranch_scc1 L_rk13
s_call_b64 s[36:37], L_rpoll
L_rk13:
s_ff1_i32_b32 s71, s70
s_bitset0_b32 s70, s71
s_mul_i32 s71, s71, 114688
SA s72,s71,s77
buffer_load_dwordx4 v[168:171], v7, s[8:11], s72 offen sc1
buffer_load_dwordx4 v[172:175], v27, s[8:11], s72 offen sc1
s_waitcnt vmcnt(8)
M v[96:99],a[246:249],v[144:147],v[96:99]
M v[100:103],a[244:247],v[144:147],v[100:103]
s_waitcnt vmcnt(7)
M v[104:107],a[246:249],v[148:151],v[104:107]
M v[108:111],a[244:247],v[148:151],v[108:111]
s_cmp_lg_u32 s70, 0
s_cbranch_scc1 L_rk14
s_call_b64 s[36:37], L_rpoll
L_rk14:
s_ff1_i32_b32 s71, s70
s_bitset0_b32 s70, s71
s_mul_i32 s71, s71, 114688
SA s72,s71,s77
buffer_load_dwordx4 v[176:179], v7, s[8:11], s72 offen sc1
buffer_load_dwordx4 v[180:183], v27, s[8:11], s72 offen sc1
s_waitcnt vmcnt(8)
M v[96:99],a[246:249],v[152:155],v[96:99]
M v[100:103],a[244:247],v[152:155],v[100:103]
s_waitcnt vmcnt(7)
M v[104:107],a[246:249],v[156:159],v[104:107]
M v[108:111],a[244:247],v[156:159],v[108:111]
s_cmp_lg_u32 s70, 0
s_cbranch_scc1 L_rk15
s_call_b64 s[36:37], L_rpoll
L_rk15:
s_ff1_i32_b32 s71, s70
s_bitset0_b32 s70, s71
s_mul_i32 s71, s71, 114688
SA s72,s71,s77
buffer_load_dwordx4 v[184:187], v7, s[8:11], s72 offen sc1
buffer_load_dwordx4 v[188:191], v27, s[8:11], s72 offen sc1
s_waitcnt vmcnt(8)
M v[96:99],a[246:249],v[160:163],v[96:99]
M v[100:103],a[244:247],v[160:163],v[100:103]
s_waitcnt vmcnt(7)
M v[104:107],a[246:249],v[164:167],v[104:107]
M v[108:111],a[244:247],v[164:167],v[108:111]
s_waitcnt vmcnt(6)
v_cmp_eq_u32 vcc, 1, v8
s_mov_b32 s69, 0xffff0000
s_and_b32 s70, vcc_lo, s69
s_mov_b32 s68, s70
s_cmp_lg_u32 s70, 0
s_cbranch_scc1 L_rk16
s_call_b64 s[36:37], L_rpoll
L_rk16:
s_ff1_i32_b32 s71, s70
s_bitset0_b32 s70, s71
s_mul_i32 s71, s71, 114688
SA s72,s71,s78
buffer_load_dwordx4 v[192:195], v7, s[8:11], s72 offen sc1
s_waitcnt vmcnt(6)
M v[96:99],a[246:249],v[168:171],v[96:99]
M v[100:103],a[244:247],v[168:171],v[100:103]
s_waitcnt vmcnt(5)
M v[104:107],a[246:249],v[172:175],v[104:107]
M v[108:111],a[244:247],v[172:175],v[108:111]
s_cmp_lg_u32 s70, 0
s_cbranch_scc1 L_rk17
s_call_b64 s[36:37], L_rpoll
L_rk17:
s_ff1_i32_b32 s71, s70
s_bitset0_b32 s70, s71
s_mul_i32 s71, s71, 114688
SA s72,s71,s78
buffer_load_dwordx4 v[196:199], v7, s[8:11], s72 offen sc1
s_waitcnt vmcnt(5)
M v[96:99],a[246:249],v[176:179],v[96:99]
M v[100:103],a[244:247],v[176:179],v[100:103]
s_waitcnt vmcnt(4)
M v[104:107],a[246:249],v[180:183],v[104:107]
M v[108:111],a[244:247],v[180:183],v[108:111]
s_cmp_lg_u32 s70, 0
s_cbranch_scc1 L_rk18
s_call_b64 s[36:37], L_rpoll
L_rk18:
s_ff1_i32_b32 s71, s70
s_bitset0_b32 s70, s71
s_mul_i32 s71, s71, 114688
SA s72,s71,s78
buffer_load_dwordx4 v[200:203], v7, s[8:11], s72 offen sc1
s_waitcnt vmcnt(4)
M v[96:99],a[246:249],v[184:187],v[96:99]
M v[100:103],a[244:247],v[184:187],v[100:103]
s_waitcnt vmcnt(3)
M v[104:107],a[246:249],v[188:191],v[104:107]
M v[108:111],a[244:247],v[188:191],v[108:111]
s_nop 4
v_permlane16_swap_b32 v96, v100
v_permlane16_swap_b32 v97, v101
v_permlane16_swap_b32 v98, v102
v_permlane16_swap_b32 v99, v103
v_permlane16_swap_b32 v104, v108
v_permlane16_swap_b32 v105, v109
v_permlane16_swap_b32 v106, v110
v_permlane16_swap_b32 v107, v111
v_fmac_f32 v64, v39, v96
v_fmac_f32 v65, v39, v97
v_fmac_f32 v66, v39, v98
v_fmac_f32 v67, v39, v99
v_fmac_f32 v68, v39, v100
v_fmac_f32 v69, v39, v101
v_fmac_f32 v70, v39, v102
v_fmac_f32 v71, v39, v103
C v48,v64,v65
C v49,v66,v67
C v50,v68,v69
C v51,v70,v71
buffer_store_dwordx4 v[48:51], v38, s[52:55], s75 offen sc1
v_fmac_f32 v72, v39, v104
v_fmac_f32 v73, v39, v105
v_fmac_f32 v74, v39, v106
v_fmac_f32 v75, v39, v107
v_fmac_f32 v76, v39, v108
v_fmac_f32 v77, v39, v109
v_fmac_f32 v78, v39, v110
v_fmac_f32 v79, v39, v111
C v52,v72,v73
C v53,v74,v75
C v54,v76,v77
C v55,v78,v79
buffer_store_dwordx4 v[52:55], v38, s[52:55], s76 offen sc1
s_cmp_lg_u32 s70, 0
s_cbranch_scc1 L_rk19
s_call_b64 s[36:37], L_rpoll
L_rk19:
s_ff1_i32_b32 s71, s70
s_bitset0_b32 s70, s71
s_mul_i32 s71, s71, 114688
SA s72,s71,s78
buffer_load_dwordx4 v[204:207], v7, s[8:11], s72 offen sc1
s_cmp_lg_u32 s70, 0
s_cbranch_scc1 L_rk20
s_call_b64 s[36:37], L_rpoll
L_rk20:
s_ff1_i32_b32 s71, s70
s_bitset0_b32 s70, s71
s_mul_i32 s71, s71, 114688
SA s72,s71,s78
buffer_load_dwordx4 v[208:211], v7, s[8:11], s72 offen sc1
s_cmp_lg_u32 s70, 0
s_cbranch_scc1 L_rk21
s_call_b64 s[36:37], L_rpoll
L_rk21:
s_ff1_i32_b32 s71, s70
s_bitset0_b32 s70, s71
s_mul_i32 s71, s71, 114688
SA s72,s71,s78
buffer_load_dwordx4 v[212:215], v7, s[8:11], s72 offen sc1
s_cmp_lg_u32 s70, 0
s_cbranch_scc1 L_rk22
s_call_b64 s[36:37], L_rpoll
L_rk22:
s_ff1_i32_b32 s71, s70
s_bitset0_b32 s70, s71
s_mul_i32 s71, s71, 114688
SA s72,s71,s78
buffer_load_dwordx4 v[216:219], v7, s[8:11], s72 offen sc1
s_cmp_lg_u32 s70, 0
s_cbranch_scc1 L_rk23
s_call_b64 s[36:37], L_rpoll
L_rk23:
s_ff1_i32_b32 s71, s70
s_bitset0_b32 s70, s71
s_mul_i32 s71, s71, 114688
SA s72,s71,s78
buffer_load_dwordx4 v[220:223], v7, s[8:11], s72 offen sc1
s_cmp_lg_u32 s70, 0
s_cbranch_scc1 L_rk24
s_call_b64 s[36:37], L_rpoll
L_rk24:
s_ff1_i32_b32 s71, s70
s_bitset0_b32 s70, s71
s_mul_i32 s71, s71, 114688
SA s72,s71,s78
buffer_load_dwordx4 v[224:227], v7, s[8:11], s72 offen sc1
s_cmp_lg_u32 s70, 0
s_cbranch_scc1 L_rk25
s_call_b64 s[36:37], L_rpoll
L_rk25:
s_ff1_i32_b32 s71, s70
s_bitset0_b32 s70, s71
s_mul_i32 s71, s71, 114688
SA s72,s71,s78
buffer_load_dwordx4 v[228:231], v7, s[8:11], s72 offen sc1
s_cmp_lg_u32 s70, 0
s_cbranch_scc1 L_rk26
s_call_b64 s[36:37], L_rpoll
L_rk26:
s_ff1_i32_b32 s71, s70
s_bitset0_b32 s70, s71
s_mul_i32 s71, s71, 114688
SA s72,s71,s78
buffer_load_dwordx4 v[232:235], v7, s[8:11], s72 offen sc1
s_cmp_lg_u32 s70, 0
s_cbranch_scc1 L_rk27
s_call_b64 s[36:37], L_rpoll
L_rk27:
s_ff1_i32_b32 s71, s70
s_bitset0_b32 s70, s71
s_mul_i32 s71, s71, 114688
SA s72,s71,s78
buffer_load_dwordx4 v[236:239], v7, s[8:11], s72 offen sc1
s_waitcnt vmcnt(13)
M v[112:115],a[246:249],v[192:195],0
M v[116:119],a[244:247],v[192:195],0
s_cmp_lg_u32 s70, 0
s_cbranch_scc1 L_rk28
s_call_b64 s[36:37], L_rpoll
L_rk28:
s_ff1_i32_b32 s71, s70
s_bitset0_b32 s70, s71
s_mul_i32 s71, s71, 114688
SA s72,s71,s78
buffer_load_dwordx4 v[240:243], v7, s[8:11], s72 offen sc1
s_waitcnt vmcnt(13)
M v[112:115],a[246:249],v[196:199],v[112:115]
M v[116:119],a[244:247],v[196:199],v[116:119]
s_cmp_lg_u32 s70, 0
s_cbranch_scc1 L_rk29
s_call_b64 s[36:37], L_rpoll
L_rk29:
s_ff1_i32_b32 s71, s70
s_bitset0_b32 s70, s71
s_mul_i32 s71, s71, 114688
SA s72,s71,s78
buffer_load_dwordx4 v[244:247], v7, s[8:11], s72 offen sc1
s_waitcnt vmcnt(13)
M v[112:115],a[246:249],v[200:203],v[112:115]
M v[116:119],a[244:247],v[200:203],v[116:119]
s_cmp_lg_u32 s70, 0
s_cbranch_scc1 L_rk30
s_call_b64 s[36:37], L_rpoll
L_rk30:
s_ff1_i32_b32 s71, s70
s_bitset0_b32 s70, s71
s_mul_i32 s71, s71, 114688
SA s72,s71,s78
buffer_load_dwordx4 v[248:251], v7, s[8:11], s72 offen sc1
s_waitcnt vmcnt(11)
M v[112:115],a[246:249],v[204:207],v[112:115]
M v[116:119],a[244:247],v[204:207],v[116:119]
s_cmp_lg_u32 s70, 0
s_cbranch_scc1 L_rk31
s_call_b64 s[36:37], L_rpoll
L_rk31:
s_ff1_i32_b32 s71, s70
s_bitset0_b32 s70, s71
s_mul_i32 s71, s71, 114688
SA s72,s71,s78
buffer_load_dwordx4 v[252:255], v7, s[8:11], s72 offen sc1
s_waitcnt vmcnt(11)
M v[112:115],a[246:249],v[208:211],v[112:115]
M v[116:119],a[244:247],v[208:211],v[116:119]
s_waitcnt vmcnt(10)
M v[112:115],a[246:249],v[212:215],v[112:115]
M v[116:119],a[244:247],v[212:215],v[116:119]
s_waitcnt vmcnt(9)
M v[112:115],a[246:249],v[216:219],v[112:115]
M v[116:119],a[244:247],v[216:219],v[116:119]
s_waitcnt vmcnt(8)
M v[112:115],a[246:249],v[220:223],v[112:115]
M v[116:119],a[244:247],v[220:223],v[116:119]
s_waitcnt vmcnt(7)
M v[112:115],a[246:249],v[224:227],v[112:115]
M v[116:119],a[244:247],v[224:227],v[116:119]
s_waitcnt vmcnt(6)
M v[112:115],a[246:249],v[228:231],v[112:115]
M v[116:119],a[244:247],v[228:231],v[116:119]
s_waitcnt vmcnt(5)
M v[112:115],a[246:249],v[232:235],v[112:115]
M v[116:119],a[244:247],v[232:235],v[116:119]
s_waitcnt vmcnt(4)
M v[112:115],a[246:249],v[236:239],v[112:115]
M v[116:119],a[244:247],v[236:239],v[116:119]
s_waitcnt vmcnt(3)
M v[112:115],a[246:249],v[240:243],v[112:115]
M v[116:119],a[244:247],v[240:243],v[116:119]
s_waitcnt vmcnt(2)
M v[112:115],a[246:249],v[244:247],v[112:115]
M v[116:119],a[244:247],v[244:247],v[116:119]
s_waitcnt vmcnt(1)
M v[112:115],a[246:249],v[248:251],v[112:115]
M v[116:119],a[244:247],v[248:251],v[116:119]
s_waitcnt vmcnt(0)
M v[112:115],a[246:249],v[252:255],v[112:115]
M v[116:119],a[244:247],v[252:255],v[116:119]
s_nop 7
v_permlane16_swap_b32 v112, v116
v_permlane16_swap_b32 v113, v117
v_permlane16_swap_b32 v114, v118
v_permlane16_swap_b32 v115, v119
v_fmac_f32 v80, v26, v112
v_fmac_f32 v81, v26, v113
v_fmac_f32 v82, v26, v114
v_fmac_f32 v83, v26, v115
v_fmac_f32 v84, v26, v116
v_fmac_f32 v85, v26, v117
v_fmac_f32 v86, v26, v118
v_fmac_f32 v87, v26, v119
C v44,v80,v81
C v45,v82,v83
C v46,v84,v85
C v47,v86,v87
buffer_store_dwordx4 v[44:47], v28, s[52:55], s79 offen sc1
s_endpgm
L_rpoll0:
s_sleep 1
L_rpoll:
buffer_load_dword v9, v33, s[8:11], s46 offen sc1
s_waitcnt vmcnt(0)
v_cmp_eq_u32 vcc, 1, v9
s_sub_u32 s91, s91, 1
s_cselect_b32 s70, -1, 0
s_or_b32 s70, s70, vcc_lo
s_and_b32 s70, s70, s69
s_andn2_b32 s70, s70, s68
s_cbranch_scc0 L_rpoll0
s_or_b32 s68, s68, s70
s_setpc_b64 s[36:37]
L_moe0:
s_lshl_b32 s88, s75, 1
s_call_b64 s[36:37], L_moe
AF v64,v2,v64
AF v65,v3,v65
AF v66,v4,v66
AF v67,v5,v67
AF v68,v10,v68
AF v69,v11,v69
AF v70,v12,v70
AF v71,v13,v71
AF v72,v14,v72
AF v73,v15,v73
AF v74,v16,v74
AF v75,v17,v75
AF v76,v18,v76
AF v77,v19,v77
AF v78,v20,v78
AF v79,v21,v79
s_mov_b64 exec, -1
s_branch L_moe_ret0
L_moe1:
s_lshl_b32 s88, s79, 1
s_call_b64 s[36:37], L_moe
AF v80,v2,v80
AF v81,v3,v81
AF v82,v4,v82
AF v83,v5,v83
AF v84,v10,v84
AF v85,v11,v85
AF v86,v12,v86
AF v87,v13,v87
s_mov_b64 exec, -1
s_branch L_moe_ret1
L_moe2:
s_lshl_b32 s88, s79, 1
s_call_b64 s[36:37], L_moe
AF v48,v2,v48
AF v49,v3,v49
AF v50,v4,v50
AF v51,v5,v51
AF v52,v10,v52
AF v53,v11,v53
AF v54,v12,v54
AF v55,v13,v55
s_mov_b64 exec, -1
s_branch L_moe_ret2
L_moe:
v_min_u32 v0, 27, v32
v_lshlrev_b32 v0, 2, v0
s_mov_b32 s64, 105062912
s_mov_b32 s65, 65536
s_mov_b32 exec_lo, 0xffffffff
s_mov_b32 exec_hi, 0xffffffff
L_pfy:
buffer_load_dword v1, v0, s[8:11], s64 offen sc1
s_sub_u32 s65, s65, 1
s_cbranch_scc1 L_pfy_x
s_waitcnt vmcnt(0)
v_cmp_ne_u32 vcc, 1, v1
s_nop 0
s_cbranch_vccz L_pfy_x
s_sleep 2
s_branch L_pfy
L_pfy_x:
s_waitcnt vmcnt(0)
s_mov_b64 exec, -1
s_or_b64 exec, s[80:81], s[82:83]
v_mov_b32 v0, 1792
v_cndmask_b32 v0, v0, 0, s[80:81]
v_lshl_add_u32 v0, v34, 5, v0
SA s88,s88,104898560
buffer_load_dwordx4 v[2:5], v0, s[8:11], s88 offen sc1
buffer_load_dwordx4 v[10:13], v0, s[8:11], s88 offen offset:16 sc1
buffer_load_dwordx4 v[14:17], v0, s[8:11], s88 offen offset:512 sc1
buffer_load_dwordx4 v[18:21], v0, s[8:11], s88 offen offset:528 sc1
s_waitcnt vmcnt(0)
s_setpc_b64 s[36:37]
L_red:
v_lshrrev_b32 v32, 4, v7
s_lshr_b32 s74, s41, 3
s_lshl_b32 s64, s42, 1
SA s46,s64,s74
s_mul_i32 s46, s46, 4352
s_and_b32 s72, s41, 7
s_lshl_b32 s65, s72, 7
SA s46,s46,s65
SA s46,s46,104992768
v_and_b32 v33, 31, v32
v_lshlrev_b32 v33, 2, v33
s_lshl_b32 s65, s41, 7
SA s65,s65,104890368
buffer_load_dword v31, v33, s[8:11], s65 offen sc1
v_bfe_u32 v34, v32, 4, 1
v_lshlrev_b32 v34, 1, v34
v_lshrrev_b32 v35, 5, v32
v_add_u32 v34, v34, v35
s_mov_b32 s52, s96
s_and_b32 s53, s97, 0xffff
s_mov_b32 s54, 1835008
s_mov_b32 s55, 0x20000
s_mul_i32 s77, s42, 1835008
s_mul_i32 s78, s72, 14336
SA s77,s77,s78
SA s77,s77,67108864
s_lshl_b32 s79, s74, 1
SA s79,s79,s20
s_lshl_b32 s71, s74, 1
SA s71,s71,1
s_sub_u32 s71, s71, s20
s_and_b32 s71, s71, 536870912
s_sub_u32 s64, 15, s64
s_sub_u32 s78, s64, 1
s_mul_i32 s78, s78, 1835008
SA s78,s78,s77
s_lshl_b32 s65, s79, 10
SA s78,s78,s65
SA s78,s78,s71
s_lshl_b32 s79, s79, 6
s_or_b32 s79, s79, s71
s_mul_i32 s67, s74, -2
s_lshl_b32 s74, s74, 3
SA s74,s74,s20
s_lshl_b32 s75, s74, 6
SA s76,s75,256
SA s67,s67,3
s_sub_u32 s67, s67, s20
s_and_b32 s67, s67, 536870912
s_or_b32 s76, s76, s67
v_or_b32 v27, s67, v7
v_add_u32 v27, 4096, v27
s_lshl_b32 s65, s74, 10
SA s77,s77,s65
s_lshl_b32 s64, s64, 7
s_lshr_b32 s73, s72, 1
s_sub_u32 s65, 7, s73
s_bitcmp1_b32 s72, 0
s_cselect_b32 s73, s65, s73
s_lshl_b32 s73, s73, 4
s_lshl_b32 s65, s42, 7
SA s73,s73,s65
v_and_b32 v37, 15, v32
v_add_u32 v37, s73, v37
v_add_u32 v29, s64, v37
s_mov_b32 s64, 104857664
v_mul_u32_u24 v38, 896, v37
v_lshl_add_u32 v38, v34, 4, v38
v_lshrrev_b32 v35, 4, v37
v_lshlrev_b32 v35, 5, v35
v_and_b32 v36, 15, v37
v_add_lshl_u32 v35, v35, v36, 2
buffer_load_dword v39, v35, s[8:11], s64 offen sc1
buffer_load_dwordx4 v[48:51], v38, s[56:59], s75 offen
buffer_load_dwordx4 v[52:55], v38, s[56:59], s76 offen
v_mul_u32_u24 v28, 896, v29
v_lshl_add_u32 v28, v34, 4, v28
v_lshrrev_b32 v35, 4, v29
v_lshlrev_b32 v35, 5, v35
v_and_b32 v36, 15, v29
v_add_lshl_u32 v35, v35, v36, 2
buffer_load_dword v26, v35, s[8:11], s64 offen sc1
buffer_load_dwordx4 v[44:47], v28, s[56:59], s79 offen
s_waitcnt vmcnt(7)
buffer_load_dword v9, v33, s[8:11], s46 offen sc1
s_branch L_red1
L_code_end:
.section .rodata,"a"
.p2align 6
.amdhsa_kernel gated_mix__compressed_kv_cla__moe_arch_mod__prompt_kernel
  .amdhsa_next_free_vgpr 512
  .amdhsa_next_free_sgpr 102
  .amdhsa_accum_offset 256
  .amdhsa_group_segment_fixed_size 0
  .amdhsa_kernarg_size 120
  .amdhsa_user_sgpr_count 2
  .amdhsa_user_sgpr_kernarg_segment_ptr 1
  .amdhsa_system_sgpr_workgroup_id_x 1
  .amdhsa_float_denorm_mode_32 3
.end_amdhsa_kernel
```

```asm
; @launch grid=(256,1,1) block=(256,1,1) lds=163840
.amdgcn_target "amdgcn-amd-amdhsa--gfx950"
.text
.macro M a, b, c, d
v_mfma_f32_16x16x32_bf16 \a, \b, \c, \d
.endm
.macro R a, b, c
ds_read_b128 \a, \b offset:\c
.endm
.macro T a, b, c
ds_read_b64_tr_b16 \a, \b offset:\c
.endm
.macro C a, b, c
v_cvt_pk_bf16_f32 \a, \b, \c
.endm
.macro E a, b
v_exp_f32 \a, \b
.endm
.macro W a, b
v_accvgpr_write_b32 \a, \b
.endm
.macro G a, b
v_accvgpr_read_b32 \a, \b
.endm
.macro AF a, b, c
v_add_f32 \a, \b, \c
.endm
.macro MF a, b, c
v_mul_f32 \a, \b, \c
.endm
.macro SA a, b, c
s_add_u32 \a, \b, \c
.endm
.globl gated_mix__compressed_kv_cla__moe_arch_mod__prompt_kernel
.p2align 8
.type gated_mix__compressed_kv_cla__moe_arch_mod__prompt_kernel,@function
gated_mix__compressed_kv_cla__moe_arch_mod__prompt_kernel:
s_cmp_lt_u32 s2, 256
s_cbranch_scc1 L_go
s_endpgm
L_go:
s_load_dwordx8 s[80:87], s[0:1], 0
s_load_dwordx4 s[88:91], s[0:1], 32
s_getpc_b64 s[76:77]
L_pc0:
s_lshr_b32 s42, s2, 3
s_mov_b32 s79, 0x20000
s_lshl_b32 s67, s42, 13
s_mov_b32 s78, L_code_end-L_pc0
s_and_b32 s77, s77, 0xffff
v_lshl_add_u32 v31, v0, 5, s67
buffer_load_dword a240, v31, s[76:79], 0 offen offset:0
v_lshrrev_b32 v24, 6, v0
v_and_b32 v0, 63, v0
s_and_b32 s41, s2, 7
v_readfirstlane_b32 s20, v24
s_lshr_b32 s64, s2, 4
v_and_b32 v24, 15, v0
v_lshrrev_b32 v25, 4, v0
s_and_b32 s64, s64, 8
s_or_b32 s41, s41, s64
v_lshlrev_b32 v28, 1, v25
v_xor_b32 v28, v28, v24
v_and_b32 v29, 8, v28
v_and_b32 v28, 7, v28
v_lshlrev_b32 v28, 4, v28
v_lshl_add_u32 v28, v29, 5, v28
v_lshl_add_u32 v28, v25, 13, v28
s_lshl_b32 s64, s20, 17
v_add_u32 v8, s64, v28
v_xor_b32 v28, 0x100, v8
v_add_u32 v9, 31744, v8
v_add_u32 v10, 63488, v28
v_add_u32 v11, 95232, v28
s_mov_b32 s21, 0
s_lshl_b32 s23, s20, 12
s_lshl_b32 s74, s41, 9
s_sub_u32 s18, 8388608, s74
s_mov_b32 s19, s79
s_bitcmp0_b32 s2, 6
s_waitcnt lgkmcnt(0)
s_cselect_b64 s[72:73], s[86:87], s[88:89]
SA s16,s72,s74
s_addc_u32 s73, s73, 0
s_and_b32 s17, s73, 0xffff
SA m0,s23,0
s_nop 0
buffer_load_dwordx4 v8, s[16:19], s21 offen offset:0  nt lds
buffer_load_dwordx4 v9, s[16:19], s21 offen offset:1024  nt lds
buffer_load_dwordx4 v10, s[16:19], s21 offen offset:2048  nt lds
buffer_load_dwordx4 v11, s[16:19], s21 offen offset:3072  nt lds
SA s21,s21,128
s_and_b32 s42, s42, 15
s_lshr_b32 s45, s42, 3
s_and_b32 s65, s20, 1
s_lshr_b32 s66, s20, 1
v_and_b32 v29, 7, v0
v_xor_b32 v28, v25, v29
v_lshlrev_b32 v28, 4, v28
v_lshrrev_b32 v29, 3, v0
v_lshl_add_u32 v30, v29, 11, v28
s_lshl_b32 s64, s66, 19
s_lshl_b32 s67, s65, 21
SA s64,s64,s67
v_add_u32 v12, s64, v30
v_xor_b32 v30, 64, v12
v_add_u32 v14, 30720, v12
v_add_u32 v13, 15360, v30
v_add_u32 v15, 46080, v30
s_mov_b32 s22, 0
SA s24,s23,65536
s_and_b32 s64, s42, 7
s_lshl_b32 s64, s64, 16
s_sub_u32 s50, 4194304, s64
s_mov_b32 s51, s79
SA s48,s82,s64
s_addc_u32 s73, s83, 0
s_and_b32 s49, s73, 0xffff
SA m0,s23,16384
s_nop 0
buffer_load_dwordx4 v8, s[16:19], s21 offen offset:0  nt lds
buffer_load_dwordx4 v9, s[16:19], s21 offen offset:1024  nt lds
buffer_load_dwordx4 v10, s[16:19], s21 offen offset:2048  nt lds
buffer_load_dwordx4 v11, s[16:19], s21 offen offset:3072  nt lds
SA s21,s21,524160
SA m0,s24,0
s_nop 0
buffer_load_dwordx4 v12, s[48:51], s22 offen offset:0   lds
buffer_load_dwordx4 v13, s[48:51], s22 offen offset:1024   lds
buffer_load_dwordx4 v14, s[48:51], s22 offen offset:2048   lds
buffer_load_dwordx4 v15, s[48:51], s22 offen offset:3072   lds
SA s22,s22,1048576
s_load_dwordx2 s[92:93], s[0:1], 56
s_load_dwordx2 s[94:95], s[0:1], 88
s_load_dwordx4 s[4:7], s[0:1], 104
v_lshlrev_b32 v7, 4, v0
v_lshrrev_b32 v26, 2, v24
v_and_b32 v28, 1, v25
v_lshl_or_b32 v28, v28, 2, v26
v_lshl_add_u32 v29, v25, 3, v26
v_lshlrev_b32 v29, 8, v29
v_and_b32 v30, 3, v0
v_lshl_add_u32 v29, v30, 3, v29
s_lshl_b32 s64, s65, 2
SA s64,s64,0
v_xor_b32 v30, s64, v28
v_lshl_add_u32 v1, v30, 5, v29
s_lshl_b32 s64, s65, 2
SA s64,s64,1
v_xor_b32 v30, s64, v28
v_lshl_add_u32 v2, v30, 5, v29
s_lshl_b32 s64, s65, 2
SA s64,s64,2
v_xor_b32 v30, s64, v28
v_lshl_add_u32 v3, v30, 5, v29
s_lshl_b32 s64, s65, 2
SA s64,s64,3
v_xor_b32 v30, s64, v28
v_lshl_add_u32 v4, v30, 5, v29
v_add_u32 v28, 0, v25
v_lshrrev_b32 v29, 1, v24
v_xor_b32 v28, v28, v29
v_lshlrev_b32 v28, 4, v28
v_lshl_add_u32 v28, v24, 7, v28
s_lshl_b32 s64, s66, 13
SA s64,s64,65536
v_add_u32 v5, s64, v28
v_add_u32 v28, 4, v25
v_lshrrev_b32 v29, 1, v24
v_xor_b32 v28, v28, v29
v_lshlrev_b32 v28, 4, v28
v_lshl_add_u32 v28, v24, 7, v28
s_lshl_b32 s64, s66, 13
SA s64,s64,65536
v_add_u32 v6, s64, v28
s_mov_b32 s56, s80
s_and_b32 s57, s81, 0xffff
s_mov_b32 s58, 1835008
s_mov_b32 s59, 0x20000
s_waitcnt lgkmcnt(0)
s_mov_b32 s60, s92
s_and_b32 s61, s93, 0xffff
s_mov_b32 s62, 896
s_mov_b32 s63, 0x20000
s_mov_b32 s68, s94
s_and_b32 s69, s95, 0xffff
s_mov_b32 s70, 896
s_mov_b32 s71, 0x20000
s_lshl_b32 s95, s20, 11
s_lshr_b32 s64, s2, 3
s_lshl_b32 s64, s64, 13
SA s95,s95,s64
s_mov_b32 s8, s6
s_and_b32 s9, s7, 0xffff
s_mov_b32 s10, 268435456
s_mov_b32 s11, 0x20000
s_mov_b32 s12, s4
s_and_b32 s13, s5, 0xffff
s_mov_b32 s14, 256
s_mov_b32 s15, 0x20000
SA s72,s84,s74
s_addc_u32 s73, s85, 0
s_sub_u32 s75, 3670016, s74
s_mov_b32 s52, s72
s_and_b32 s53, s73, 0xffff
s_mov_b32 s54, s75
s_mov_b32 s55, 0x20000
s_mul_i32 s29, s42, 114688
s_mov_b32 s5, 0x3db8aa3b
s_mul_i32 s72, s45, 16777216
s_mul_i32 s73, s41, 1048576
SA s72,s72,s73
s_bfe_u32 s64, s42, 0x20001
s_lshl_b32 s64, s64, 15
SA s72,s72,s64
s_lshl_b32 s64, s66, 17
SA s72,s72,s64
s_and_b32 s67, s42, 1
s_cmp_eq_u32 s45, 0
s_cselect_b32 s64, 12, 14
s_cselect_b32 s75, 14, 10
s_lshl_b32 s67, s67, s75
SA s72,s72,s67
s_lshl_b32 s64, s65, s64
SA s93,s72,s64
s_load_dwordx4 s[80:83], s[0:1], 64
s_load_dwordx2 s[84:85], s[0:1], 80
s_load_dwordx2 s[96:97], s[0:1], 96
s_cmp_eq_u32 s45, 0
s_cbranch_scc0 L_kv1
s_branch L_kv0
.p2align 12
L_kv0:
s_and_b32 s31, s42, 7
s_lshl_b32 s64, s42, 4
SA s64,s64,s41
s_lshl_b32 s64, s64, 2
SA s64,s64,s20
s_cmp_lt_u32 s64, 41
s_cselect_b32 s39, 0, 536870912
s_min_u32 s64, s64, 41
s_lshl_b32 s38, s64, 2
s_max_u32 s67, s64, 8
s_sub_u32 s67, s67, 8
s_mul_i32 s67, s67, 3328
s_lshl_b32 s64, s64, 10
SA s64,s64,s67
SA s73,s64,104914944
v_or_b32 v64, s39, v7
v_mov_b32 v68, 0
v_mov_b32 v69, 0
v_mov_b32 v70, 0
v_mov_b32 v71, 0
buffer_store_dwordx4 v[68:71], v64, s[8:11], s73 offen offset:0 sc1
buffer_store_dwordx4 v[68:71], v64, s[8:11], s73 offen offset:1024 sc1
buffer_store_dwordx4 v[68:71], v64, s[8:11], s73 offen offset:2048 sc1
SA m0,s24,16384
s_nop 0
buffer_load_dwordx4 v12, s[48:51], s22 offen offset:0   lds
buffer_load_dwordx4 v13, s[48:51], s22 offen offset:1024   lds
buffer_load_dwordx4 v14, s[48:51], s22 offen offset:2048   lds
buffer_load_dwordx4 v15, s[48:51], s22 offen offset:3072   lds
s_sub_u32 s22, s22, 1048448
SA m0,s23,32768
s_nop 0
buffer_load_dwordx4 v8, s[16:19], s21 offen offset:0  nt lds
buffer_load_dwordx4 v9, s[16:19], s21 offen offset:1024  nt lds
buffer_load_dwordx4 v10, s[16:19], s21 offen offset:2048  nt lds
buffer_load_dwordx4 v11, s[16:19], s21 offen offset:3072  nt lds
SA s21,s21,128
s_mov_b64 exec, 0
s_cmp_eq_u32 s20, 0
s_cbranch_scc1 L_w_kv01
s_cmp_eq_u32 s20, 1
s_cbranch_scc1 L_w_kv02
s_cmp_eq_u32 s20, 2
s_cbranch_scc1 L_w_kv03
s_branch L_w_kv04
L_wd1:
s_mov_b64 exec, -1
s_waitcnt vmcnt(11) lgkmcnt(0)
s_barrier
R a[160:163],v5,0
R a[164:167],v6,0
T a[96:97],v1,0
T a[98:99],v1,1024
T a[100:101],v1,8192
T a[102:103],v1,9216
T a[104:105],v2,0
T a[106:107],v2,1024
T a[108:109],v2,8192
T a[110:111],v2,9216
T a[112:113],v3,0
T a[114:115],v3,1024
T a[116:117],v3,8192
T a[118:119],v3,9216
T a[120:121],v4,0
T a[122:123],v4,1024
T a[124:125],v4,8192
T a[126:127],v4,9216
T a[128:129],v1,16384
T a[130:131],v1,17408
T a[132:133],v1,24576
T a[134:135],v1,25600
T a[136:137],v2,16384
T a[138:139],v2,17408
T a[140:141],v2,24576
T a[142:143],v2,25600
T a[144:145],v3,16384
T a[146:147],v3,17408
T a[148:149],v3,24576
T a[150:151],v3,25600
T a[152:153],v4,16384
T a[154:155],v4,17408
T a[156:157],v4,24576
T a[158:159],v4,25600
s_waitcnt lgkmcnt(15)
M a[0:3],a[96:99],a[160:163],0
SA m0,s23,49152
R a[168:171],v5,2048
R a[172:175],v6,2048
M a[0:3],a[100:103],a[164:167],a[0:3]
buffer_load_dwordx4 v8, s[16:19], s21 offen offset:0  nt lds
M a[4:7],a[108:111],a[164:167],0
M a[4:7],a[104:107],a[160:163],a[4:7]
M a[8:11],a[112:115],a[160:163],0
buffer_load_dwordx4 v9, s[16:19], s21 offen offset:1024  nt lds
M a[8:11],a[116:119],a[164:167],a[8:11]
s_waitcnt lgkmcnt(14)
M a[12:15],a[124:127],a[164:167],0
M a[12:15],a[120:123],a[160:163],a[12:15]
M a[16:19],a[128:131],a[160:163],0
buffer_load_dwordx4 v10, s[16:19], s21 offen offset:2048  nt lds
M a[16:19],a[132:135],a[164:167],a[16:19]
s_waitcnt lgkmcnt(6)
M a[20:23],a[140:143],a[164:167],0
M a[20:23],a[136:139],a[160:163],a[20:23]
buffer_load_dwordx4 v11, s[16:19], s21 offen offset:3072  nt lds
M a[24:27],a[144:147],a[160:163],0
SA s21,s21,524160
M a[24:27],a[148:151],a[164:167],a[24:27]
s_waitcnt lgkmcnt(0)
M a[28:31],a[156:159],a[164:167],0
SA m0,s24,32768
M a[28:31],a[152:155],a[160:163],a[28:31]
buffer_load_dwordx4 v12, s[48:51], s22 offen offset:0   lds
M v[32:35],a[96:99],a[168:171],0
R a[160:163],v5,4096
R a[164:167],v6,4096
M v[32:35],a[100:103],a[172:175],v[32:35]
M v[36:39],a[108:111],a[172:175],0
M v[36:39],a[104:107],a[168:171],v[36:39]
buffer_load_dwordx4 v13, s[48:51], s22 offen offset:1024   lds
M v[40:43],a[112:115],a[168:171],0
M v[40:43],a[116:119],a[172:175],v[40:43]
M v[44:47],a[124:127],a[172:175],0
buffer_load_dwordx4 v14, s[48:51], s22 offen offset:2048   lds
M v[44:47],a[120:123],a[168:171],v[44:47]
M v[48:51],a[128:131],a[168:171],0
M v[48:51],a[132:135],a[172:175],v[48:51]
M v[52:55],a[140:143],a[172:175],0
buffer_load_dwordx4 v15, s[48:51], s22 offen offset:3072   lds
M v[52:55],a[136:139],a[168:171],v[52:55]
SA s22,s22,1048576
M v[56:59],a[144:147],a[168:171],0
M v[56:59],a[148:151],a[172:175],v[56:59]
s_waitcnt lgkmcnt(0)
M v[60:63],a[156:159],a[172:175],0
M v[60:63],a[152:155],a[168:171],v[60:63]
M v[64:67],a[96:99],a[160:163],0
R a[168:171],v5,6144
R a[172:175],v6,6144
M v[64:67],a[100:103],a[164:167],v[64:67]
M v[68:71],a[108:111],a[164:167],0
M v[68:71],a[104:107],a[160:163],v[68:71]
M v[72:75],a[112:115],a[160:163],0
M v[72:75],a[116:119],a[164:167],v[72:75]
M v[76:79],a[124:127],a[164:167],0
M v[76:79],a[120:123],a[160:163],v[76:79]
M v[80:83],a[128:131],a[160:163],0
M v[80:83],a[132:135],a[164:167],v[80:83]
M v[84:87],a[140:143],a[164:167],0
M v[84:87],a[136:139],a[160:163],v[84:87]
M v[88:91],a[144:147],a[160:163],0
M v[88:91],a[148:151],a[164:167],v[88:91]
s_waitcnt lgkmcnt(0)
M v[92:95],a[156:159],a[164:167],0
s_waitcnt vmcnt(12)
M v[92:95],a[152:155],a[160:163],v[92:95]
s_barrier
M v[96:99],a[96:99],a[168:171],0
SA m0,s23,0
R a[160:163],v5,16384
R a[164:167],v6,16384
M v[96:99],a[100:103],a[172:175],v[96:99]
buffer_load_dwordx4 v8, s[16:19], s21 offen offset:0  nt lds
M v[100:103],a[108:111],a[172:175],0
v_lshlrev_b32 v26, 7, v0
v_and_b32 v27, 48, v0
M v[100:103],a[104:107],a[168:171],v[100:103]
v_lshl_add_u32 v26, v27, 24, v26
M v[104:107],a[112:115],a[168:171],0
buffer_load_dwordx4 v9, s[16:19], s21 offen offset:1024  nt lds
M v[104:107],a[116:119],a[172:175],v[104:107]
M v[108:111],a[124:127],a[172:175],0
M v[108:111],a[120:123],a[168:171],v[108:111]
buffer_load_dwordx4 v10, s[16:19], s21 offen offset:2048  nt lds
M v[112:115],a[128:131],a[168:171],0
M v[112:115],a[132:135],a[172:175],v[112:115]
M v[116:119],a[140:143],a[172:175],0
M v[116:119],a[136:139],a[168:171],v[116:119]
buffer_load_dwordx4 v11, s[16:19], s21 offen offset:3072  nt lds
M v[120:123],a[144:147],a[168:171],0
SA s21,s21,128
M v[120:123],a[148:151],a[172:175],v[120:123]
s_waitcnt lgkmcnt(0)
M v[124:127],a[156:159],a[172:175],0
SA m0,s24,49152
M v[124:127],a[152:155],a[168:171],v[124:127]
buffer_load_dwordx4 v12, s[48:51], s22 offen offset:0   lds
M v[128:131],a[96:99],a[160:163],0
R a[168:171],v5,18432
R a[172:175],v6,18432
M v[128:131],a[100:103],a[164:167],v[128:131]
buffer_load_dwordx4 v13, s[48:51], s22 offen offset:1024   lds
M v[132:135],a[108:111],a[164:167],0
M v[132:135],a[104:107],a[160:163],v[132:135]
M v[136:139],a[112:115],a[160:163],0
M v[136:139],a[116:119],a[164:167],v[136:139]
buffer_load_dwordx4 v14, s[48:51], s22 offen offset:2048   lds
M v[140:143],a[124:127],a[164:167],0
M v[140:143],a[120:123],a[160:163],v[140:143]
M v[144:147],a[128:131],a[160:163],0
buffer_load_dwordx4 v15, s[48:51], s22 offen offset:3072   lds
M v[144:147],a[132:135],a[164:167],v[144:147]
s_sub_u32 s22, s22, 1048448
M v[148:151],a[140:143],a[164:167],0
M v[148:151],a[136:139],a[160:163],v[148:151]
M v[152:155],a[144:147],a[160:163],0
M v[152:155],a[148:151],a[164:167],v[152:155]
s_waitcnt lgkmcnt(0)
M v[156:159],a[156:159],a[164:167],0
s_waitcnt vmcnt(12)
M v[156:159],a[152:155],a[160:163],v[156:159]
s_barrier
M v[160:163],a[96:99],a[168:171],0
SA m0,s23,16384
R a[160:163],v5,20480
R a[164:167],v6,20480
M v[160:163],a[100:103],a[172:175],v[160:163]
T a[32:33],v1,32768
T a[34:35],v1,33792
M v[164:167],a[108:111],a[172:175],0
T a[36:37],v1,40960
T a[38:39],v1,41984
M v[164:167],a[104:107],a[168:171],v[164:167]
T a[40:41],v2,32768
T a[42:43],v2,33792
M v[168:171],a[112:115],a[168:171],0
T a[44:45],v2,40960
T a[46:47],v2,41984
M v[168:171],a[116:119],a[172:175],v[168:171]
buffer_load_dwordx4 v8, s[16:19], s21 offen offset:0  nt lds
M v[172:175],a[124:127],a[172:175],0
s_nop 0
T a[48:49],v3,32768
T a[50:51],v3,33792
M v[172:175],a[120:123],a[168:171],v[172:175]
buffer_load_dwordx4 v9, s[16:19], s21 offen offset:1024  nt lds
M v[176:179],a[128:131],a[168:171],0
s_nop 0
T a[52:53],v3,40960
T a[54:55],v3,41984
M v[176:179],a[132:135],a[172:175],v[176:179]
T a[56:57],v4,32768
T a[58:59],v4,33792
M v[180:183],a[140:143],a[172:175],0
buffer_load_dwordx4 v10, s[16:19], s21 offen offset:2048  nt lds
M v[180:183],a[136:139],a[168:171],v[180:183]
s_nop 0
T a[60:61],v4,40960
T a[62:63],v4,41984
M v[184:187],a[144:147],a[168:171],0
buffer_load_dwordx4 v11, s[16:19], s21 offen offset:3072  nt lds
M v[184:187],a[148:151],a[172:175],v[184:187]
s_waitcnt lgkmcnt(15)
s_nop 0
T a[64:65],v1,49152
T a[66:67],v1,50176
M v[188:191],a[156:159],a[172:175],0
SA s21,s21,524160
T a[68:69],v1,57344
T a[70:71],v1,58368
M v[188:191],a[152:155],a[168:171],v[188:191]
SA m0,s24,0
M v[192:195],a[96:99],a[160:163],0
R a[168:171],v5,22528
R a[172:175],v6,22528
M v[192:195],a[100:103],a[164:167],v[192:195]
T a[72:73],v2,49152
T a[74:75],v2,50176
M v[196:199],a[108:111],a[164:167],0
T a[76:77],v2,57344
T a[78:79],v2,58368
M v[196:199],a[104:107],a[160:163],v[196:199]
T a[80:81],v3,49152
T a[82:83],v3,50176
M v[200:203],a[112:115],a[160:163],0
buffer_load_dwordx4 v12, s[48:51], s22 offen offset:0   lds
M v[200:203],a[116:119],a[164:167],v[200:203]
s_nop 0
T a[84:85],v3,57344
T a[86:87],v3,58368
M v[204:207],a[124:127],a[164:167],0
T a[88:89],v4,49152
T a[90:91],v4,50176
M v[204:207],a[120:123],a[160:163],v[204:207]
buffer_load_dwordx4 v13, s[48:51], s22 offen offset:1024   lds
M v[208:211],a[128:131],a[160:163],0
s_nop 0
T a[92:93],v4,57344
T a[94:95],v4,58368
M v[208:211],a[132:135],a[164:167],v[208:211]
buffer_load_dwordx4 v14, s[48:51], s22 offen offset:2048   lds
M v[212:215],a[140:143],a[164:167],0
buffer_load_dwordx4 v15, s[48:51], s22 offen offset:3072   lds
M v[212:215],a[136:139],a[160:163],v[212:215]
SA s22,s22,1048576
M v[216:219],a[144:147],a[160:163],0
M v[216:219],a[148:151],a[164:167],v[216:219]
s_waitcnt lgkmcnt(12)
M v[220:223],a[156:159],a[164:167],0
s_waitcnt vmcnt(12) lgkmcnt(0)
M v[220:223],a[152:155],a[160:163],v[220:223]
s_barrier
M v[224:227],a[96:99],a[168:171],0
SA m0,s23,32768
R a[160:163],v5,32768
R a[164:167],v6,32768
M v[224:227],a[100:103],a[172:175],v[224:227]
buffer_load_dwordx4 v8, s[16:19], s21 offen offset:0  nt lds
M v[228:231],a[108:111],a[172:175],0
M v[228:231],a[104:107],a[168:171],v[228:231]
M v[232:235],a[112:115],a[168:171],0
buffer_load_dwordx4 v9, s[16:19], s21 offen offset:1024  nt lds
M v[232:235],a[116:119],a[172:175],v[232:235]
M v[236:239],a[124:127],a[172:175],0
M v[236:239],a[120:123],a[168:171],v[236:239]
buffer_load_dwordx4 v10, s[16:19], s21 offen offset:2048  nt lds
M v[240:243],a[128:131],a[168:171],0
M v[240:243],a[132:135],a[172:175],v[240:243]
M v[244:247],a[140:143],a[172:175],0
buffer_load_dwordx4 v11, s[16:19], s21 offen offset:3072  nt lds
M v[244:247],a[136:139],a[168:171],v[244:247]
SA s21,s21,128
M v[248:251],a[144:147],a[168:171],0
M v[248:251],a[148:151],a[172:175],v[248:251]
s_waitcnt lgkmcnt(0)
M v[252:255],a[156:159],a[172:175],0
M v[252:255],a[152:155],a[168:171],v[252:255]
M a[0:3],a[32:35],a[160:163],a[0:3]
R a[168:171],v5,34816
R a[172:175],v6,34816
M a[0:3],a[36:39],a[164:167],a[0:3]
T a[96:97],v1,0
T a[98:99],v1,1024
M a[4:7],a[44:47],a[164:167],a[4:7]
SA m0,s24,16384
M a[4:7],a[40:43],a[160:163],a[4:7]
buffer_load_dwordx4 v12, s[48:51], s22 offen offset:0   lds
M a[8:11],a[48:51],a[160:163],a[8:11]
M a[8:11],a[52:55],a[164:167],a[8:11]
M a[12:15],a[60:63],a[164:167],a[12:15]
s_nop 0
T a[100:101],v1,8192
T a[102:103],v1,9216
M a[12:15],a[56:59],a[160:163],a[12:15]
M a[16:19],a[64:67],a[160:163],a[16:19]
buffer_load_dwordx4 v13, s[48:51], s22 offen offset:1024   lds
M a[16:19],a[68:71],a[164:167],a[16:19]
M a[20:23],a[76:79],a[164:167],a[20:23]
M a[20:23],a[72:75],a[160:163],a[20:23]
s_nop 0
T a[104:105],v2,0
T a[106:107],v2,1024
M a[24:27],a[80:83],a[160:163],a[24:27]
M a[24:27],a[84:87],a[164:167],a[24:27]
s_waitcnt lgkmcnt(6)
buffer_load_dwordx4 v14, s[48:51], s22 offen offset:2048   lds
M a[28:31],a[92:95],a[164:167],a[28:31]
M a[28:31],a[88:91],a[160:163],a[28:31]
M v[60:63],a[88:91],a[168:171],v[60:63]
R a[160:163],v5,36864
R a[164:167],v6,36864
M v[60:63],a[92:95],a[172:175],v[60:63]
T a[108:109],v2,8192
T a[110:111],v2,9216
M v[56:59],a[84:87],a[172:175],v[56:59]
buffer_load_dwordx4 v15, s[48:51], s22 offen offset:3072   lds
M v[56:59],a[80:83],a[168:171],v[56:59]
s_sub_u32 s22, s22, 1048448
M v[52:55],a[72:75],a[168:171],v[52:55]
M v[52:55],a[76:79],a[172:175],v[52:55]
s_nop 0
T a[112:113],v3,0
T a[114:115],v3,1024
M v[48:51],a[68:71],a[172:175],v[48:51]
SA m0,s23,49152
M v[48:51],a[64:67],a[168:171],v[48:51]
buffer_load_dwordx4 v8, s[16:19], s21 offen offset:0  nt lds
M v[44:47],a[56:59],a[168:171],v[44:47]
M v[44:47],a[60:63],a[172:175],v[44:47]
M v[40:43],a[52:55],a[172:175],v[40:43]
s_nop 0
T a[116:117],v3,8192
T a[118:119],v3,9216
M v[40:43],a[48:51],a[168:171],v[40:43]
M v[36:39],a[40:43],a[168:171],v[36:39]
buffer_load_dwordx4 v9, s[16:19], s21 offen offset:1024  nt lds
M v[36:39],a[44:47],a[172:175],v[36:39]
s_waitcnt lgkmcnt(6)
M v[32:35],a[36:39],a[172:175],v[32:35]
M v[32:35],a[32:35],a[168:171],v[32:35]
s_nop 0
T a[120:121],v4,0
T a[122:123],v4,1024
M v[64:67],a[32:35],a[160:163],v[64:67]
R a[168:171],v5,38912
R a[172:175],v6,38912
M v[64:67],a[36:39],a[164:167],v[64:67]
buffer_load_dwordx4 v10, s[16:19], s21 offen offset:2048  nt lds
M v[68:71],a[44:47],a[164:167],v[68:71]
M v[68:71],a[40:43],a[160:163],v[68:71]
M v[72:75],a[48:51],a[160:163],v[72:75]
s_nop 0
T a[124:125],v4,8192
T a[126:127],v4,9216
M v[72:75],a[52:55],a[164:167],v[72:75]
M v[76:79],a[60:63],a[164:167],v[76:79]
buffer_load_dwordx4 v11, s[16:19], s21 offen offset:3072  nt lds
M v[76:79],a[56:59],a[160:163],v[76:79]
SA s21,s21,524160
M v[80:83],a[64:67],a[160:163],v[80:83]
M v[80:83],a[68:71],a[164:167],v[80:83]
M v[84:87],a[76:79],a[164:167],v[84:87]
M v[84:87],a[72:75],a[160:163],v[84:87]
M v[88:91],a[80:83],a[160:163],v[88:91]
M v[88:91],a[84:87],a[164:167],v[88:91]
s_waitcnt lgkmcnt(2)
M v[92:95],a[92:95],a[164:167],v[92:95]
s_waitcnt vmcnt(16) lgkmcnt(0)
M v[92:95],a[88:91],a[160:163],v[92:95]
s_barrier
M v[124:127],a[88:91],a[168:171],v[124:127]
R a[160:163],v5,49152
R a[164:167],v6,49152
M v[124:127],a[92:95],a[172:175],v[124:127]
M v[120:123],a[84:87],a[172:175],v[120:123]
SA m0,s24,32768
T a[128:129],v1,16384
T a[130:131],v1,17408
M v[120:123],a[80:83],a[168:171],v[120:123]
buffer_load_dwordx4 v12, s[48:51], s22 offen offset:0   lds
M v[116:119],a[72:75],a[168:171],v[116:119]
M v[116:119],a[76:79],a[172:175],v[116:119]
M v[112:115],a[68:71],a[172:175],v[112:115]
M v[112:115],a[64:67],a[168:171],v[112:115]
M v[108:111],a[56:59],a[168:171],v[108:111]
M v[108:111],a[60:63],a[172:175],v[108:111]
s_nop 0
T a[132:133],v1,24576
T a[134:135],v1,25600
M v[104:107],a[52:55],a[172:175],v[104:107]
buffer_load_dwordx4 v13, s[48:51], s22 offen offset:1024   lds
M v[104:107],a[48:51],a[168:171],v[104:107]
M v[100:103],a[40:43],a[168:171],v[100:103]
M v[100:103],a[44:47],a[172:175],v[100:103]
s_waitcnt lgkmcnt(4)
M v[96:99],a[36:39],a[172:175],v[96:99]
M v[96:99],a[32:35],a[168:171],v[96:99]
M v[128:131],a[32:35],a[160:163],v[128:131]
R a[168:171],v5,51200
R a[172:175],v6,51200
M v[128:131],a[36:39],a[164:167],v[128:131]
T a[136:137],v2,16384
T a[138:139],v2,17408
M v[132:135],a[44:47],a[164:167],v[132:135]
buffer_load_dwordx4 v14, s[48:51], s22 offen offset:2048   lds
M v[132:135],a[40:43],a[160:163],v[132:135]
M v[136:139],a[48:51],a[160:163],v[136:139]
M v[136:139],a[52:55],a[164:167],v[136:139]
M v[140:143],a[60:63],a[164:167],v[140:143]
M v[140:143],a[56:59],a[160:163],v[140:143]
s_nop 0
T a[140:141],v2,24576
T a[142:143],v2,25600
M v[144:147],a[64:67],a[160:163],v[144:147]
buffer_load_dwordx4 v15, s[48:51], s22 offen offset:3072   lds
M v[144:147],a[68:71],a[164:167],v[144:147]
SA s22,s22,1048576
M v[148:151],a[76:79],a[164:167],v[148:151]
M v[148:151],a[72:75],a[160:163],v[148:151]
M v[152:155],a[80:83],a[160:163],v[152:155]
M v[152:155],a[84:87],a[164:167],v[152:155]
s_waitcnt lgkmcnt(4)
M v[156:159],a[92:95],a[164:167],v[156:159]
SA m0,s23,0
T a[144:145],v3,16384
T a[146:147],v3,17408
M v[156:159],a[88:91],a[160:163],v[156:159]
buffer_load_dwordx4 v8, s[16:19], s21 offen offset:0  nt lds
M v[188:191],a[88:91],a[168:171],v[188:191]
R a[160:163],v5,53248
R a[164:167],v6,53248
M v[188:191],a[92:95],a[172:175],v[188:191]
M v[184:187],a[84:87],a[172:175],v[184:187]
M v[184:187],a[80:83],a[168:171],v[184:187]
M v[180:183],a[72:75],a[168:171],v[180:183]
M v[180:183],a[76:79],a[172:175],v[180:183]
s_nop 0
T a[148:149],v3,24576
T a[150:151],v3,25600
M v[176:179],a[68:71],a[172:175],v[176:179]
buffer_load_dwordx4 v9, s[16:19], s21 offen offset:1024  nt lds
M v[176:179],a[64:67],a[168:171],v[176:179]
M v[172:175],a[56:59],a[168:171],v[172:175]
M v[172:175],a[60:63],a[172:175],v[172:175]
M v[168:171],a[52:55],a[172:175],v[168:171]
M v[168:171],a[48:51],a[168:171],v[168:171]
M v[164:167],a[40:43],a[168:171],v[164:167]
s_nop 0
T a[152:153],v4,16384
T a[154:155],v4,17408
M v[164:167],a[44:47],a[172:175],v[164:167]
s_waitcnt lgkmcnt(4)
buffer_load_dwordx4 v10, s[16:19], s21 offen offset:2048  nt lds
M v[160:163],a[36:39],a[172:175],v[160:163]
M v[160:163],a[32:35],a[168:171],v[160:163]
M v[192:195],a[32:35],a[160:163],v[192:195]
R a[168:171],v5,55296
R a[172:175],v6,55296
M v[192:195],a[36:39],a[164:167],v[192:195]
M v[196:199],a[44:47],a[164:167],v[196:199]
M v[196:199],a[40:43],a[160:163],v[196:199]
s_nop 0
T a[156:157],v4,24576
T a[158:159],v4,25600
M v[200:203],a[48:51],a[160:163],v[200:203]
buffer_load_dwordx4 v11, s[16:19], s21 offen offset:3072  nt lds
M v[200:203],a[52:55],a[164:167],v[200:203]
SA s21,s21,128
M v[204:207],a[60:63],a[164:167],v[204:207]
M v[204:207],a[56:59],a[160:163],v[204:207]
M v[208:211],a[64:67],a[160:163],v[208:211]
M v[208:211],a[68:71],a[164:167],v[208:211]
M v[212:215],a[76:79],a[164:167],v[212:215]
M v[212:215],a[72:75],a[160:163],v[212:215]
M v[216:219],a[80:83],a[160:163],v[216:219]
M v[216:219],a[84:87],a[164:167],v[216:219]
s_waitcnt lgkmcnt(2)
M v[220:223],a[92:95],a[164:167],v[220:223]
s_waitcnt vmcnt(16) lgkmcnt(0)
M v[220:223],a[88:91],a[160:163],v[220:223]
s_barrier
M v[252:255],a[88:91],a[168:171],v[252:255]
R a[160:163],v5,0
R a[164:167],v6,0
M v[252:255],a[92:95],a[172:175],v[252:255]
v_min_u32 v16, 1, v0
v_lshlrev_b32 v16, 29, v16
M v[248:251],a[84:87],a[172:175],v[248:251]
v_or_b32 v16, s39, v16
v_mov_b32 v17, 1
M v[248:251],a[80:83],a[168:171],v[248:251]
buffer_store_dword v17, v16, s[12:15], s38 offen sc1
M v[244:247],a[72:75],a[168:171],v[244:247]
M v[244:247],a[76:79],a[172:175],v[244:247]
M v[240:243],a[68:71],a[172:175],v[240:243]
M v[240:243],a[64:67],a[168:171],v[240:243]
M v[236:239],a[56:59],a[168:171],v[236:239]
M v[236:239],a[60:63],a[172:175],v[236:239]
M v[232:235],a[52:55],a[172:175],v[232:235]
M v[232:235],a[48:51],a[168:171],v[232:235]
M v[228:231],a[40:43],a[168:171],v[228:231]
M v[228:231],a[44:47],a[172:175],v[228:231]
s_waitcnt lgkmcnt(0)
M v[224:227],a[36:39],a[172:175],v[224:227]
M v[224:227],a[32:35],a[168:171],v[224:227]
M a[0:3],a[96:99],a[160:163],a[0:3]
L_w_kv01:
s_cbranch_execz L_w_kv05
R a[168:171],v5,2048
R a[172:175],v6,2048
M a[0:3],a[100:103],a[164:167],a[0:3]
T a[32:33],v1,32768
T a[34:35],v1,33792
M a[4:7],a[108:111],a[164:167],a[4:7]
SA m0,s24,49152
M a[4:7],a[104:107],a[160:163],a[4:7]
buffer_load_dwordx4 v12, s[48:51], s22 offen offset:0   lds
M a[8:11],a[112:115],a[160:163],a[8:11]
M a[8:11],a[116:119],a[164:167],a[8:11]
M a[12:15],a[124:127],a[164:167],a[12:15]
s_nop 0
T a[36:37],v1,40960
T a[38:39],v1,41984
M a[12:15],a[120:123],a[160:163],a[12:15]
M a[16:19],a[128:131],a[160:163],a[16:19]
buffer_load_dwordx4 v13, s[48:51], s22 offen offset:1024   lds
M a[16:19],a[132:135],a[164:167],a[16:19]
M a[20:23],a[140:143],a[164:167],a[20:23]
M a[20:23],a[136:139],a[160:163],a[20:23]
s_nop 0
T a[40:41],v2,32768
T a[42:43],v2,33792
M a[24:27],a[144:147],a[160:163],a[24:27]
M a[24:27],a[148:151],a[164:167],a[24:27]
s_waitcnt lgkmcnt(6)
buffer_load_dwordx4 v14, s[48:51], s22 offen offset:2048   lds
M a[28:31],a[156:159],a[164:167],a[28:31]
M a[28:31],a[152:155],a[160:163],a[28:31]
M v[60:63],a[152:155],a[168:171],v[60:63]
R a[160:163],v5,4096
R a[164:167],v6,4096
M v[60:63],a[156:159],a[172:175],v[60:63]
T a[44:45],v2,40960
T a[46:47],v2,41984
M v[56:59],a[148:151],a[172:175],v[56:59]
buffer_load_dwordx4 v15, s[48:51], s22 offen offset:3072   lds
M v[56:59],a[144:147],a[168:171],v[56:59]
s_sub_u32 s22, s22, 1048448
M v[52:55],a[136:139],a[168:171],v[52:55]
M v[52:55],a[140:143],a[172:175],v[52:55]
s_nop 0
T a[48:49],v3,32768
T a[50:51],v3,33792
M v[48:51],a[132:135],a[172:175],v[48:51]
SA m0,s23,16384
M v[48:51],a[128:131],a[168:171],v[48:51]
buffer_load_dwordx4 v8, s[16:19], s21 offen offset:0  nt lds
M v[44:47],a[120:123],a[168:171],v[44:47]
M v[44:47],a[124:127],a[172:175],v[44:47]
M v[40:43],a[116:119],a[172:175],v[40:43]
s_nop 0
T a[52:53],v3,40960
T a[54:55],v3,41984
M v[40:43],a[112:115],a[168:171],v[40:43]
M v[36:39],a[104:107],a[168:171],v[36:39]
buffer_load_dwordx4 v9, s[16:19], s21 offen offset:1024  nt lds
M v[36:39],a[108:111],a[172:175],v[36:39]
s_waitcnt lgkmcnt(6)
M v[32:35],a[100:103],a[172:175],v[32:35]
M v[32:35],a[96:99],a[168:171],v[32:35]
s_nop 0
T a[56:57],v4,32768
T a[58:59],v4,33792
M v[64:67],a[96:99],a[160:163],v[64:67]
R a[168:171],v5,6144
R a[172:175],v6,6144
M v[64:67],a[100:103],a[164:167],v[64:67]
buffer_load_dwordx4 v10, s[16:19], s21 offen offset:2048  nt lds
M v[68:71],a[108:111],a[164:167],v[68:71]
M v[68:71],a[104:107],a[160:163],v[68:71]
M v[72:75],a[112:115],a[160:163],v[72:75]
s_nop 0
T a[60:61],v4,40960
T a[62:63],v4,41984
M v[72:75],a[116:119],a[164:167],v[72:75]
M v[76:79],a[124:127],a[164:167],v[76:79]
buffer_load_dwordx4 v11, s[16:19], s21 offen offset:3072  nt lds
M v[76:79],a[120:123],a[160:163],v[76:79]
SA s21,s21,524160
M v[80:83],a[128:131],a[160:163],v[80:83]
M v[80:83],a[132:135],a[164:167],v[80:83]
M v[84:87],a[140:143],a[164:167],v[84:87]
M v[84:87],a[136:139],a[160:163],v[84:87]
s_and_b32 s86, s41, 7
M v[88:91],a[144:147],a[160:163],v[88:91]
s_mul_i32 s86, s86, 14
s_lshr_b32 s64, s41, 3
s_mul_i32 s64, s64, 7
M v[88:91],a[148:151],a[164:167],v[88:91]
s_waitcnt lgkmcnt(2)
SA s86,s86,s64
s_min_u32 s64, s31, 6
M v[92:95],a[156:159],a[164:167],v[92:95]
s_waitcnt vmcnt(17) lgkmcnt(0)
SA s86,s86,s64
s_sub_u32 s64, 6, s31
M v[92:95],a[152:155],a[160:163],v[92:95]
s_barrier
M v[124:127],a[152:155],a[168:171],v[124:127]
R a[160:163],v5,16384
R a[164:167],v6,16384
M v[124:127],a[156:159],a[172:175],v[124:127]
s_and_b32 s88, s64, 536870912
s_mul_i32 s87, s20, 7168
M v[120:123],a[148:151],a[172:175],v[120:123]
SA m0,s24,0
T a[64:65],v1,49152
T a[66:67],v1,50176
M v[120:123],a[144:147],a[168:171],v[120:123]
buffer_load_dwordx4 v12, s[48:51], s22 offen offset:0   lds
M v[116:119],a[136:139],a[168:171],v[116:119]
SA s87,s87,131072
M v[116:119],a[140:143],a[172:175],v[116:119]
s_cmp_lt_u32 s20, 2
M v[112:115],a[132:135],a[172:175],v[112:115]
s_cselect_b64 s[72:73], s[80:81], s[82:83]
M v[112:115],a[128:131],a[168:171],v[112:115]
s_mov_b32 s60, s72
M v[108:111],a[120:123],a[168:171],v[108:111]
s_and_b32 s61, s73, 0xffff
M v[108:111],a[124:127],a[172:175],v[108:111]
s_mov_b32 s62, 1605632
T a[68:69],v1,57344
T a[70:71],v1,58368
M v[104:107],a[116:119],a[172:175],v[104:107]
s_mov_b32 s63, 0x20000
buffer_load_dwordx4 v13, s[48:51], s22 offen offset:1024   lds
M v[104:107],a[112:115],a[168:171],v[104:107]
s_mov_b32 s68, s84
M v[100:103],a[104:107],a[168:171],v[100:103]
s_and_b32 s69, s85, 0xffff
s_mov_b32 s70, 1605632
s_mov_b32 s71, 0x20000
M v[100:103],a[108:111],a[172:175],v[100:103]
s_waitcnt lgkmcnt(4)
s_lshl_b32 s89, s86, 5
M v[96:99],a[100:103],a[172:175],v[96:99]
s_and_b32 s64, s20, 1
M v[96:99],a[96:99],a[168:171],v[96:99]
s_mul_i32 s64, s64, 802816
M v[128:131],a[96:99],a[160:163],v[128:131]
SA s89,s89,s64
R a[168:171],v5,18432
R a[172:175],v6,18432
M v[128:131],a[100:103],a[164:167],v[128:131]
T a[72:73],v2,49152
T a[74:75],v2,50176
M v[132:135],a[108:111],a[164:167],v[132:135]
buffer_load_dwordx4 v14, s[48:51], s22 offen offset:2048   lds
M v[132:135],a[104:107],a[160:163],v[132:135]
v_lshrrev_b32 v28, 1, v0
v_mul_u32_u24 v28, 3584, v28
M v[136:139],a[112:115],a[160:163],v[136:139]
v_and_b32 v29, 1, v0
v_lshl_add_u32 v25, v29, 4, v28
M v[136:139],a[116:119],a[164:167],v[136:139]
v_or_b32 v25, s88, v25
M v[140:143],a[124:127],a[164:167],v[140:143]
M v[140:143],a[120:123],a[160:163],v[140:143]
s_nop 0
T a[76:77],v2,57344
T a[78:79],v2,58368
M v[144:147],a[128:131],a[160:163],v[144:147]
buffer_load_dwordx4 v15, s[48:51], s22 offen offset:3072   lds
M v[144:147],a[132:135],a[164:167],v[144:147]
SA s22,s22,1048576
M v[148:151],a[140:143],a[164:167],v[148:151]
M v[148:151],a[136:139],a[160:163],v[148:151]
M v[152:155],a[144:147],a[160:163],v[152:155]
M v[152:155],a[148:151],a[164:167],v[152:155]
s_waitcnt lgkmcnt(4)
M v[156:159],a[156:159],a[164:167],v[156:159]
SA m0,s23,32768
T a[80:81],v3,49152
T a[82:83],v3,50176
M v[156:159],a[152:155],a[160:163],v[156:159]
buffer_load_dwordx4 v8, s[16:19], s21 offen offset:0  nt lds
M v[188:191],a[152:155],a[168:171],v[188:191]
R a[160:163],v5,20480
R a[164:167],v6,20480
M v[188:191],a[156:159],a[172:175],v[188:191]
M v[184:187],a[148:151],a[172:175],v[184:187]
M v[184:187],a[144:147],a[168:171],v[184:187]
M v[180:183],a[136:139],a[168:171],v[180:183]
M v[180:183],a[140:143],a[172:175],v[180:183]
s_nop 0
T a[84:85],v3,57344
T a[86:87],v3,58368
M v[176:179],a[132:135],a[172:175],v[176:179]
buffer_load_dwordx4 v9, s[16:19], s21 offen offset:1024  nt lds
M v[176:179],a[128:131],a[168:171],v[176:179]
M v[172:175],a[120:123],a[168:171],v[172:175]
M v[172:175],a[124:127],a[172:175],v[172:175]
M v[168:171],a[116:119],a[172:175],v[168:171]
M v[168:171],a[112:115],a[168:171],v[168:171]
M v[164:167],a[104:107],a[168:171],v[164:167]
s_nop 0
T a[88:89],v4,49152
T a[90:91],v4,50176
M v[164:167],a[108:111],a[172:175],v[164:167]
s_waitcnt lgkmcnt(4)
buffer_load_dwordx4 v10, s[16:19], s21 offen offset:2048  nt lds
M v[160:163],a[100:103],a[172:175],v[160:163]
M v[160:163],a[96:99],a[168:171],v[160:163]
M v[192:195],a[96:99],a[160:163],v[192:195]
R a[168:171],v5,22528
R a[172:175],v6,22528
M v[192:195],a[100:103],a[164:167],v[192:195]
M v[196:199],a[108:111],a[164:167],v[196:199]
M v[196:199],a[104:107],a[160:163],v[196:199]
s_nop 0
T a[92:93],v4,57344
T a[94:95],v4,58368
M v[200:203],a[112:115],a[160:163],v[200:203]
buffer_load_dwordx4 v11, s[16:19], s21 offen offset:3072  nt lds
M v[200:203],a[116:119],a[164:167],v[200:203]
SA s21,s21,128
M v[204:207],a[124:127],a[164:167],v[204:207]
M v[204:207],a[120:123],a[160:163],v[204:207]
M v[208:211],a[128:131],a[160:163],v[208:211]
M v[208:211],a[132:135],a[164:167],v[208:211]
M v[212:215],a[140:143],a[164:167],v[212:215]
M v[212:215],a[136:139],a[160:163],v[212:215]
M v[216:219],a[144:147],a[160:163],v[216:219]
M v[216:219],a[148:151],a[164:167],v[216:219]
s_waitcnt lgkmcnt(2)
M v[220:223],a[156:159],a[164:167],v[220:223]
s_waitcnt vmcnt(17) lgkmcnt(0)
M v[220:223],a[152:155],a[160:163],v[220:223]
s_barrier
M v[252:255],a[152:155],a[168:171],v[252:255]
R a[160:163],v5,32768
R a[164:167],v6,32768
M v[252:255],a[156:159],a[172:175],v[252:255]
M v[248:251],a[148:151],a[172:175],v[248:251]
M v[248:251],a[144:147],a[168:171],v[248:251]
M v[244:247],a[136:139],a[168:171],v[244:247]
M v[244:247],a[140:143],a[172:175],v[244:247]
M v[240:243],a[132:135],a[172:175],v[240:243]
M v[240:243],a[128:131],a[168:171],v[240:243]
M v[236:239],a[120:123],a[168:171],v[236:239]
M v[236:239],a[124:127],a[172:175],v[236:239]
M v[232:235],a[116:119],a[172:175],v[232:235]
M v[232:235],a[112:115],a[168:171],v[232:235]
M v[228:231],a[104:107],a[168:171],v[228:231]
M v[228:231],a[108:111],a[172:175],v[228:231]
s_waitcnt lgkmcnt(0)
M v[224:227],a[100:103],a[172:175],v[224:227]
M v[224:227],a[96:99],a[168:171],v[224:227]
M a[0:3],a[32:35],a[160:163],a[0:3]
R a[168:171],v5,34816
R a[172:175],v6,34816
M a[0:3],a[36:39],a[164:167],a[0:3]
T a[96:97],v1,0
T a[98:99],v1,1024
M a[4:7],a[44:47],a[164:167],a[4:7]
SA m0,s24,16384
M a[4:7],a[40:43],a[160:163],a[4:7]
buffer_load_dwordx4 v12, s[48:51], s22 offen offset:0   lds
M a[8:11],a[48:51],a[160:163],a[8:11]
M a[8:11],a[52:55],a[164:167],a[8:11]
M a[12:15],a[60:63],a[164:167],a[12:15]
s_nop 0
T a[100:101],v1,8192
T a[102:103],v1,9216
M a[12:15],a[56:59],a[160:163],a[12:15]
buffer_load_dwordx4 v13, s[48:51], s22 offen offset:1024   lds
M a[16:19],a[64:67],a[160:163],a[16:19]
M a[16:19],a[68:71],a[164:167],a[16:19]
M a[20:23],a[76:79],a[164:167],a[20:23]
M a[20:23],a[72:75],a[160:163],a[20:23]
s_nop 0
T a[104:105],v2,0
T a[106:107],v2,1024
M a[24:27],a[80:83],a[160:163],a[24:27]
buffer_load_dwordx4 v14, s[48:51], s22 offen offset:2048   lds
M a[24:27],a[84:87],a[164:167],a[24:27]
s_waitcnt lgkmcnt(6)
M a[28:31],a[92:95],a[164:167],a[28:31]
M a[28:31],a[88:91],a[160:163],a[28:31]
M v[60:63],a[88:91],a[168:171],v[60:63]
R a[160:163],v5,36864
R a[164:167],v6,36864
M v[60:63],a[92:95],a[172:175],v[60:63]
T a[108:109],v2,8192
T a[110:111],v2,9216
M v[56:59],a[84:87],a[172:175],v[56:59]
buffer_load_dwordx4 v15, s[48:51], s22 offen offset:3072   lds
M v[56:59],a[80:83],a[168:171],v[56:59]
s_sub_u32 s22, s22, 1048448
M v[52:55],a[72:75],a[168:171],v[52:55]
SA m0,s23,49152
M v[52:55],a[76:79],a[172:175],v[52:55]
s_nop 0
T a[112:113],v3,0
T a[114:115],v3,1024
M v[48:51],a[68:71],a[172:175],v[48:51]
buffer_load_dwordx4 v8, s[16:19], s21 offen offset:0  nt lds
M v[48:51],a[64:67],a[168:171],v[48:51]
M v[44:47],a[56:59],a[168:171],v[44:47]
M v[44:47],a[60:63],a[172:175],v[44:47]
buffer_load_dwordx4 v9, s[16:19], s21 offen offset:1024  nt lds
M v[40:43],a[52:55],a[172:175],v[40:43]
s_nop 0
T a[116:117],v3,8192
T a[118:119],v3,9216
M v[40:43],a[48:51],a[168:171],v[40:43]
M v[36:39],a[40:43],a[168:171],v[36:39]
M v[36:39],a[44:47],a[172:175],v[36:39]
s_waitcnt lgkmcnt(6)
M v[32:35],a[36:39],a[172:175],v[32:35]
buffer_load_dwordx4 v10, s[16:19], s21 offen offset:2048  nt lds
M v[32:35],a[32:35],a[168:171],v[32:35]
s_nop 0
T a[120:121],v4,0
T a[122:123],v4,1024
M v[64:67],a[32:35],a[160:163],v[64:67]
R a[168:171],v5,38912
R a[172:175],v6,38912
M v[64:67],a[36:39],a[164:167],v[64:67]
M v[68:71],a[44:47],a[164:167],v[68:71]
buffer_load_dwordx4 v11, s[16:19], s21 offen offset:3072  nt lds
M v[68:71],a[40:43],a[160:163],v[68:71]
SA s21,s21,524160
M v[72:75],a[48:51],a[160:163],v[72:75]
s_nop 0
T a[124:125],v4,8192
T a[126:127],v4,9216
M v[72:75],a[52:55],a[164:167],v[72:75]
M v[76:79],a[60:63],a[164:167],v[76:79]
SA m0,s87,0
M v[76:79],a[56:59],a[160:163],v[76:79]
buffer_load_dwordx4 v25, s[60:63], s89 offen offset:0 nt lds
M v[80:83],a[64:67],a[160:163],v[80:83]
SA s89,s89,114688
M v[80:83],a[68:71],a[164:167],v[80:83]
M v[84:87],a[76:79],a[164:167],v[84:87]
M v[84:87],a[72:75],a[160:163],v[84:87]
M v[88:91],a[80:83],a[160:163],v[88:91]
M v[88:91],a[84:87],a[164:167],v[88:91]
s_waitcnt lgkmcnt(2)
M v[92:95],a[92:95],a[164:167],v[92:95]
s_waitcnt vmcnt(17) lgkmcnt(0)
M v[92:95],a[88:91],a[160:163],v[92:95]
s_barrier
M v[124:127],a[88:91],a[168:171],v[124:127]
R a[160:163],v5,49152
R a[164:167],v6,49152
M v[124:127],a[92:95],a[172:175],v[124:127]
M v[120:123],a[84:87],a[172:175],v[120:123]
SA m0,s24,32768
T a[128:129],v1,16384
T a[130:131],v1,17408
M v[120:123],a[80:83],a[168:171],v[120:123]
buffer_load_dwordx4 v12, s[48:51], s22 offen offset:0   lds
M v[116:119],a[72:75],a[168:171],v[116:119]
v_min_u32 v16, 40, v0
v_lshlrev_b32 v16, 2, v16
M v[116:119],a[76:79],a[172:175],v[116:119]
buffer_load_dword v17, v16, s[12:15], 0 offen sc1
M v[112:115],a[68:71],a[172:175],v[112:115]
M v[112:115],a[64:67],a[168:171],v[112:115]
M v[108:111],a[56:59],a[168:171],v[108:111]
M v[108:111],a[60:63],a[172:175],v[108:111]
s_nop 0
T a[132:133],v1,24576
T a[134:135],v1,25600
M v[104:107],a[52:55],a[172:175],v[104:107]
buffer_load_dwordx4 v13, s[48:51], s22 offen offset:1024   lds
M v[104:107],a[48:51],a[168:171],v[104:107]
M v[100:103],a[40:43],a[168:171],v[100:103]
M v[100:103],a[44:47],a[172:175],v[100:103]
s_waitcnt lgkmcnt(4)
M v[96:99],a[36:39],a[172:175],v[96:99]
M v[96:99],a[32:35],a[168:171],v[96:99]
M v[128:131],a[32:35],a[160:163],v[128:131]
R a[168:171],v5,51200
R a[172:175],v6,51200
M v[128:131],a[36:39],a[164:167],v[128:131]
T a[136:137],v2,16384
T a[138:139],v2,17408
M v[132:135],a[44:47],a[164:167],v[132:135]
buffer_load_dwordx4 v14, s[48:51], s22 offen offset:2048   lds
M v[132:135],a[40:43],a[160:163],v[132:135]
M v[136:139],a[48:51],a[160:163],v[136:139]
M v[136:139],a[52:55],a[164:167],v[136:139]
M v[140:143],a[60:63],a[164:167],v[140:143]
M v[140:143],a[56:59],a[160:163],v[140:143]
s_nop 0
T a[140:141],v2,24576
T a[142:143],v2,25600
M v[144:147],a[64:67],a[160:163],v[144:147]
buffer_load_dwordx4 v15, s[48:51], s22 offen offset:3072   lds
M v[144:147],a[68:71],a[164:167],v[144:147]
SA s22,s22,1048576
M v[148:151],a[76:79],a[164:167],v[148:151]
M v[148:151],a[72:75],a[160:163],v[148:151]
M v[152:155],a[80:83],a[160:163],v[152:155]
M v[152:155],a[84:87],a[164:167],v[152:155]
s_waitcnt lgkmcnt(4)
M v[156:159],a[92:95],a[164:167],v[156:159]
SA m0,s23,0
T a[144:145],v3,16384
T a[146:147],v3,17408
M v[156:159],a[88:91],a[160:163],v[156:159]
buffer_load_dwordx4 v8, s[16:19], s21 offen offset:0  nt lds
M v[188:191],a[88:91],a[168:171],v[188:191]
R a[160:163],v5,53248
R a[164:167],v6,53248
M v[188:191],a[92:95],a[172:175],v[188:191]
M v[184:187],a[84:87],a[172:175],v[184:187]
M v[184:187],a[80:83],a[168:171],v[184:187]
M v[180:183],a[72:75],a[168:171],v[180:183]
M v[180:183],a[76:79],a[172:175],v[180:183]
s_nop 0
T a[148:149],v3,24576
T a[150:151],v3,25600
M v[176:179],a[68:71],a[172:175],v[176:179]
buffer_load_dwordx4 v9, s[16:19], s21 offen offset:1024  nt lds
M v[176:179],a[64:67],a[168:171],v[176:179]
M v[172:175],a[56:59],a[168:171],v[172:175]
M v[172:175],a[60:63],a[172:175],v[172:175]
M v[168:171],a[52:55],a[172:175],v[168:171]
M v[168:171],a[48:51],a[168:171],v[168:171]
M v[164:167],a[40:43],a[168:171],v[164:167]
s_nop 0
T a[152:153],v4,16384
T a[154:155],v4,17408
M v[164:167],a[44:47],a[172:175],v[164:167]
s_waitcnt lgkmcnt(4)
buffer_load_dwordx4 v10, s[16:19], s21 offen offset:2048  nt lds
M v[160:163],a[36:39],a[172:175],v[160:163]
M v[160:163],a[32:35],a[168:171],v[160:163]
M v[192:195],a[32:35],a[160:163],v[192:195]
R a[168:171],v5,55296
R a[172:175],v6,55296
M v[192:195],a[36:39],a[164:167],v[192:195]
M v[196:199],a[44:47],a[164:167],v[196:199]
M v[196:199],a[40:43],a[160:163],v[196:199]
s_nop 0
T a[156:157],v4,24576
T a[158:159],v4,25600
M v[200:203],a[48:51],a[160:163],v[200:203]
buffer_load_dwordx4 v11, s[16:19], s21 offen offset:3072  nt lds
M v[200:203],a[52:55],a[164:167],v[200:203]
SA s21,s21,128
M v[204:207],a[60:63],a[164:167],v[204:207]
M v[204:207],a[56:59],a[160:163],v[204:207]
M v[208:211],a[64:67],a[160:163],v[208:211]
M v[208:211],a[68:71],a[164:167],v[208:211]
M v[212:215],a[76:79],a[164:167],v[212:215]
M v[212:215],a[72:75],a[160:163],v[212:215]
M v[216:219],a[80:83],a[160:163],v[216:219]
M v[216:219],a[84:87],a[164:167],v[216:219]
s_waitcnt lgkmcnt(2)
M v[220:223],a[92:95],a[164:167],v[220:223]
s_waitcnt vmcnt(18) lgkmcnt(0)
M v[220:223],a[88:91],a[160:163],v[220:223]
s_barrier
M v[252:255],a[88:91],a[168:171],v[252:255]
R a[160:163],v5,0
R a[164:167],v6,0
M v[252:255],a[92:95],a[172:175],v[252:255]
M v[248:251],a[84:87],a[172:175],v[248:251]
M v[248:251],a[80:83],a[168:171],v[248:251]
M v[244:247],a[72:75],a[168:171],v[244:247]
M v[244:247],a[76:79],a[172:175],v[244:247]
M v[240:243],a[68:71],a[172:175],v[240:243]
M v[240:243],a[64:67],a[168:171],v[240:243]
M v[236:239],a[56:59],a[168:171],v[236:239]
M v[236:239],a[60:63],a[172:175],v[236:239]
M v[232:235],a[52:55],a[172:175],v[232:235]
M v[232:235],a[48:51],a[168:171],v[232:235]
M v[228:231],a[40:43],a[168:171],v[228:231]
M v[228:231],a[44:47],a[172:175],v[228:231]
s_waitcnt lgkmcnt(0)
M v[224:227],a[36:39],a[172:175],v[224:227]
M v[224:227],a[32:35],a[168:171],v[224:227]
M a[0:3],a[96:99],a[160:163],a[0:3]
R a[168:171],v5,2048
R a[172:175],v6,2048
M a[0:3],a[100:103],a[164:167],a[0:3]
T a[32:33],v1,32768
T a[34:35],v1,33792
M a[4:7],a[108:111],a[164:167],a[4:7]
SA m0,s24,49152
M a[4:7],a[104:107],a[160:163],a[4:7]
buffer_load_dwordx4 v12, s[48:51], s22 offen offset:0   lds
M a[8:11],a[112:115],a[160:163],a[8:11]
M a[8:11],a[116:119],a[164:167],a[8:11]
M a[12:15],a[124:127],a[164:167],a[12:15]
s_nop 0
T a[36:37],v1,40960
T a[38:39],v1,41984
M a[12:15],a[120:123],a[160:163],a[12:15]
buffer_load_dwordx4 v13, s[48:51], s22 offen offset:1024   lds
M a[16:19],a[128:131],a[160:163],a[16:19]
M a[16:19],a[132:135],a[164:167],a[16:19]
M a[20:23],a[140:143],a[164:167],a[20:23]
M a[20:23],a[136:139],a[160:163],a[20:23]
s_nop 0
T a[40:41],v2,32768
T a[42:43],v2,33792
M a[24:27],a[144:147],a[160:163],a[24:27]
buffer_load_dwordx4 v14, s[48:51], s22 offen offset:2048   lds
M a[24:27],a[148:151],a[164:167],a[24:27]
s_waitcnt lgkmcnt(6)
M a[28:31],a[156:159],a[164:167],a[28:31]
M a[28:31],a[152:155],a[160:163],a[28:31]
M v[60:63],a[152:155],a[168:171],v[60:63]
R a[160:163],v5,4096
R a[164:167],v6,4096
M v[60:63],a[156:159],a[172:175],v[60:63]
T a[44:45],v2,40960
T a[46:47],v2,41984
M v[56:59],a[148:151],a[172:175],v[56:59]
buffer_load_dwordx4 v15, s[48:51], s22 offen offset:3072   lds
M v[56:59],a[144:147],a[168:171],v[56:59]
s_sub_u32 s22, s22, 1048448
M v[52:55],a[136:139],a[168:171],v[52:55]
SA m0,s23,16384
M v[52:55],a[140:143],a[172:175],v[52:55]
s_nop 0
T a[48:49],v3,32768
T a[50:51],v3,33792
M v[48:51],a[132:135],a[172:175],v[48:51]
buffer_load_dwordx4 v8, s[16:19], s21 offen offset:0  nt lds
M v[48:51],a[128:131],a[168:171],v[48:51]
M v[44:47],a[120:123],a[168:171],v[44:47]
M v[44:47],a[124:127],a[172:175],v[44:47]
buffer_load_dwordx4 v9, s[16:19], s21 offen offset:1024  nt lds
M v[40:43],a[116:119],a[172:175],v[40:43]
s_nop 0
T a[52:53],v3,40960
T a[54:55],v3,41984
M v[40:43],a[112:115],a[168:171],v[40:43]
M v[36:39],a[104:107],a[168:171],v[36:39]
M v[36:39],a[108:111],a[172:175],v[36:39]
s_waitcnt lgkmcnt(6)
M v[32:35],a[100:103],a[172:175],v[32:35]
buffer_load_dwordx4 v10, s[16:19], s21 offen offset:2048  nt lds
M v[32:35],a[96:99],a[168:171],v[32:35]
s_nop 0
T a[56:57],v4,32768
T a[58:59],v4,33792
M v[64:67],a[96:99],a[160:163],v[64:67]
R a[168:171],v5,6144
L_w_kv02:
s_cbranch_execz L_w_kv06
R a[172:175],v6,6144
M v[64:67],a[100:103],a[164:167],v[64:67]
M v[68:71],a[108:111],a[164:167],v[68:71]
buffer_load_dwordx4 v11, s[16:19], s21 offen offset:3072  nt lds
M v[68:71],a[104:107],a[160:163],v[68:71]
SA s21,s21,524160
M v[72:75],a[112:115],a[160:163],v[72:75]
s_nop 0
T a[60:61],v4,40960
T a[62:63],v4,41984
M v[72:75],a[116:119],a[164:167],v[72:75]
M v[76:79],a[124:127],a[164:167],v[76:79]
SA m0,s87,1024
M v[76:79],a[120:123],a[160:163],v[76:79]
buffer_load_dwordx4 v25, s[60:63], s89 offen offset:0 nt lds
M v[80:83],a[128:131],a[160:163],v[80:83]
SA s89,s89,114688
M v[80:83],a[132:135],a[164:167],v[80:83]
M v[84:87],a[140:143],a[164:167],v[84:87]
M v[84:87],a[136:139],a[160:163],v[84:87]
M v[88:91],a[144:147],a[160:163],v[88:91]
M v[88:91],a[148:151],a[164:167],v[88:91]
s_waitcnt lgkmcnt(2)
M v[92:95],a[156:159],a[164:167],v[92:95]
s_waitcnt vmcnt(19) lgkmcnt(0)
M v[92:95],a[152:155],a[160:163],v[92:95]
s_barrier
M v[124:127],a[152:155],a[168:171],v[124:127]
R a[160:163],v5,16384
R a[164:167],v6,16384
M v[124:127],a[156:159],a[172:175],v[124:127]
M v[120:123],a[148:151],a[172:175],v[120:123]
SA m0,s24,0
T a[64:65],v1,49152
T a[66:67],v1,50176
M v[120:123],a[144:147],a[168:171],v[120:123]
buffer_load_dwordx4 v12, s[48:51], s22 offen offset:0   lds
M v[116:119],a[136:139],a[168:171],v[116:119]
M v[116:119],a[140:143],a[172:175],v[116:119]
M v[112:115],a[132:135],a[172:175],v[112:115]
M v[112:115],a[128:131],a[168:171],v[112:115]
M v[108:111],a[120:123],a[168:171],v[108:111]
M v[108:111],a[124:127],a[172:175],v[108:111]
s_nop 0
T a[68:69],v1,57344
T a[70:71],v1,58368
M v[104:107],a[116:119],a[172:175],v[104:107]
buffer_load_dwordx4 v13, s[48:51], s22 offen offset:1024   lds
M v[104:107],a[112:115],a[168:171],v[104:107]
M v[100:103],a[104:107],a[168:171],v[100:103]
M v[100:103],a[108:111],a[172:175],v[100:103]
s_waitcnt lgkmcnt(4)
M v[96:99],a[100:103],a[172:175],v[96:99]
M v[96:99],a[96:99],a[168:171],v[96:99]
M v[128:131],a[96:99],a[160:163],v[128:131]
R a[168:171],v5,18432
R a[172:175],v6,18432
M v[128:131],a[100:103],a[164:167],v[128:131]
T a[72:73],v2,49152
T a[74:75],v2,50176
M v[132:135],a[108:111],a[164:167],v[132:135]
buffer_load_dwordx4 v14, s[48:51], s22 offen offset:2048   lds
M v[132:135],a[104:107],a[160:163],v[132:135]
M v[136:139],a[112:115],a[160:163],v[136:139]
M v[136:139],a[116:119],a[164:167],v[136:139]
M v[140:143],a[124:127],a[164:167],v[140:143]
M v[140:143],a[120:123],a[160:163],v[140:143]
s_nop 0
T a[76:77],v2,57344
T a[78:79],v2,58368
M v[144:147],a[128:131],a[160:163],v[144:147]
buffer_load_dwordx4 v15, s[48:51], s22 offen offset:3072   lds
M v[144:147],a[132:135],a[164:167],v[144:147]
SA s22,s22,1048576
M v[148:151],a[140:143],a[164:167],v[148:151]
M v[148:151],a[136:139],a[160:163],v[148:151]
M v[152:155],a[144:147],a[160:163],v[152:155]
M v[152:155],a[148:151],a[164:167],v[152:155]
s_waitcnt lgkmcnt(4)
M v[156:159],a[156:159],a[164:167],v[156:159]
SA m0,s23,32768
T a[80:81],v3,49152
T a[82:83],v3,50176
M v[156:159],a[152:155],a[160:163],v[156:159]
buffer_load_dwordx4 v8, s[16:19], s21 offen offset:0  nt lds
M v[188:191],a[152:155],a[168:171],v[188:191]
R a[160:163],v5,20480
R a[164:167],v6,20480
M v[188:191],a[156:159],a[172:175],v[188:191]
M v[184:187],a[148:151],a[172:175],v[184:187]
M v[184:187],a[144:147],a[168:171],v[184:187]
M v[180:183],a[136:139],a[168:171],v[180:183]
M v[180:183],a[140:143],a[172:175],v[180:183]
s_nop 0
T a[84:85],v3,57344
T a[86:87],v3,58368
M v[176:179],a[132:135],a[172:175],v[176:179]
buffer_load_dwordx4 v9, s[16:19], s21 offen offset:1024  nt lds
M v[176:179],a[128:131],a[168:171],v[176:179]
M v[172:175],a[120:123],a[168:171],v[172:175]
M v[172:175],a[124:127],a[172:175],v[172:175]
M v[168:171],a[116:119],a[172:175],v[168:171]
M v[168:171],a[112:115],a[168:171],v[168:171]
M v[164:167],a[104:107],a[168:171],v[164:167]
s_nop 0
T a[88:89],v4,49152
T a[90:91],v4,50176
M v[164:167],a[108:111],a[172:175],v[164:167]
s_waitcnt lgkmcnt(4)
buffer_load_dwordx4 v10, s[16:19], s21 offen offset:2048  nt lds
M v[160:163],a[100:103],a[172:175],v[160:163]
M v[160:163],a[96:99],a[168:171],v[160:163]
M v[192:195],a[96:99],a[160:163],v[192:195]
R a[168:171],v5,22528
R a[172:175],v6,22528
M v[192:195],a[100:103],a[164:167],v[192:195]
M v[196:199],a[108:111],a[164:167],v[196:199]
M v[196:199],a[104:107],a[160:163],v[196:199]
s_nop 0
T a[92:93],v4,57344
T a[94:95],v4,58368
M v[200:203],a[112:115],a[160:163],v[200:203]
buffer_load_dwordx4 v11, s[16:19], s21 offen offset:3072  nt lds
M v[200:203],a[116:119],a[164:167],v[200:203]
SA s21,s21,128
M v[204:207],a[124:127],a[164:167],v[204:207]
M v[204:207],a[120:123],a[160:163],v[204:207]
M v[208:211],a[128:131],a[160:163],v[208:211]
M v[208:211],a[132:135],a[164:167],v[208:211]
M v[212:215],a[140:143],a[164:167],v[212:215]
M v[212:215],a[136:139],a[160:163],v[212:215]
M v[216:219],a[144:147],a[160:163],v[216:219]
M v[216:219],a[148:151],a[164:167],v[216:219]
s_waitcnt lgkmcnt(2)
M v[220:223],a[156:159],a[164:167],v[220:223]
s_waitcnt vmcnt(17) lgkmcnt(0)
M v[220:223],a[152:155],a[160:163],v[220:223]
s_barrier
M v[252:255],a[152:155],a[168:171],v[252:255]
R a[160:163],v5,32768
R a[164:167],v6,32768
M v[252:255],a[156:159],a[172:175],v[252:255]
v_cmp_ne_u32 vcc, 1, v17
M v[248:251],a[148:151],a[172:175],v[248:251]
s_nop 0
M v[248:251],a[144:147],a[168:171],v[248:251]
s_cbranch_vccnz L_zs0
L_zr0:
M v[244:247],a[136:139],a[168:171],v[244:247]
M v[244:247],a[140:143],a[172:175],v[244:247]
M v[240:243],a[132:135],a[172:175],v[240:243]
M v[240:243],a[128:131],a[168:171],v[240:243]
M v[236:239],a[120:123],a[168:171],v[236:239]
M v[236:239],a[124:127],a[172:175],v[236:239]
M v[232:235],a[116:119],a[172:175],v[232:235]
M v[232:235],a[112:115],a[168:171],v[232:235]
M v[228:231],a[104:107],a[168:171],v[228:231]
M v[228:231],a[108:111],a[172:175],v[228:231]
s_waitcnt lgkmcnt(0)
M v[224:227],a[100:103],a[172:175],v[224:227]
M v[224:227],a[96:99],a[168:171],v[224:227]
M a[0:3],a[32:35],a[160:163],a[0:3]
R a[168:171],v5,34816
R a[172:175],v6,34816
M a[0:3],a[36:39],a[164:167],a[0:3]
T a[96:97],v1,0
T a[98:99],v1,1024
M a[4:7],a[44:47],a[164:167],a[4:7]
SA m0,s24,16384
M a[4:7],a[40:43],a[160:163],a[4:7]
buffer_load_dwordx4 v12, s[48:51], s22 offen offset:0   lds
M a[8:11],a[48:51],a[160:163],a[8:11]
M a[8:11],a[52:55],a[164:167],a[8:11]
s_mul_i32 s64, s41, 229376
M a[12:15],a[60:63],a[164:167],a[12:15]
SA s72,s90,s64
T a[100:101],v1,8192
T a[102:103],v1,9216
M a[12:15],a[56:59],a[160:163],a[12:15]
s_addc_u32 s73, s91, 0
buffer_load_dwordx4 v13, s[48:51], s22 offen offset:1024   lds
M a[16:19],a[64:67],a[160:163],a[16:19]
s_sub_u32 s75, 3670016, s64
M a[16:19],a[68:71],a[164:167],a[16:19]
s_mov_b32 s12, s72
M a[20:23],a[76:79],a[164:167],a[20:23]
s_and_b32 s13, s73, 0xffff
M a[20:23],a[72:75],a[160:163],a[20:23]
s_mov_b32 s14, s75
T a[104:105],v2,0
T a[106:107],v2,1024
M a[24:27],a[80:83],a[160:163],a[24:27]
s_mov_b32 s15, 0x20000
buffer_load_dwordx4 v14, s[48:51], s22 offen offset:2048   lds
M a[24:27],a[84:87],a[164:167],a[24:27]
s_waitcnt lgkmcnt(6)
M a[28:31],a[92:95],a[164:167],a[28:31]
M a[28:31],a[88:91],a[160:163],a[28:31]
M v[60:63],a[88:91],a[168:171],v[60:63]
R a[160:163],v5,36864
R a[164:167],v6,36864
M v[60:63],a[92:95],a[172:175],v[60:63]
T a[108:109],v2,8192
T a[110:111],v2,9216
M v[56:59],a[84:87],a[172:175],v[56:59]
buffer_load_dwordx4 v15, s[48:51], s22 offen offset:3072   lds
M v[56:59],a[80:83],a[168:171],v[56:59]
s_sub_u32 s22, s22, 1048448
M v[52:55],a[72:75],a[168:171],v[52:55]
SA m0,s23,49152
M v[52:55],a[76:79],a[172:175],v[52:55]
s_nop 0
T a[112:113],v3,0
T a[114:115],v3,1024
M v[48:51],a[68:71],a[172:175],v[48:51]
buffer_load_dwordx4 v8, s[16:19], s21 offen offset:0  nt lds
M v[48:51],a[64:67],a[168:171],v[48:51]
M v[44:47],a[56:59],a[168:171],v[44:47]
M v[44:47],a[60:63],a[172:175],v[44:47]
buffer_load_dwordx4 v9, s[16:19], s21 offen offset:1024  nt lds
M v[40:43],a[52:55],a[172:175],v[40:43]
s_nop 0
T a[116:117],v3,8192
T a[118:119],v3,9216
M v[40:43],a[48:51],a[168:171],v[40:43]
M v[36:39],a[40:43],a[168:171],v[36:39]
M v[36:39],a[44:47],a[172:175],v[36:39]
s_waitcnt lgkmcnt(6)
M v[32:35],a[36:39],a[172:175],v[32:35]
buffer_load_dwordx4 v10, s[16:19], s21 offen offset:2048  nt lds
M v[32:35],a[32:35],a[168:171],v[32:35]
s_nop 0
T a[120:121],v4,0
T a[122:123],v4,1024
M v[64:67],a[32:35],a[160:163],v[64:67]
R a[168:171],v5,38912
R a[172:175],v6,38912
M v[64:67],a[36:39],a[164:167],v[64:67]
M v[68:71],a[44:47],a[164:167],v[68:71]
buffer_load_dwordx4 v11, s[16:19], s21 offen offset:3072  nt lds
M v[68:71],a[40:43],a[160:163],v[68:71]
SA s21,s21,524160
M v[72:75],a[48:51],a[160:163],v[72:75]
s_nop 0
T a[124:125],v4,8192
T a[126:127],v4,9216
M v[72:75],a[52:55],a[164:167],v[72:75]
M v[76:79],a[60:63],a[164:167],v[76:79]
SA m0,s87,2048
M v[76:79],a[56:59],a[160:163],v[76:79]
buffer_load_dwordx4 v25, s[60:63], s89 offen offset:0 nt lds
M v[80:83],a[64:67],a[160:163],v[80:83]
SA s89,s89,114688
M v[80:83],a[68:71],a[164:167],v[80:83]
M v[84:87],a[76:79],a[164:167],v[84:87]
M v[84:87],a[72:75],a[160:163],v[84:87]
M v[88:91],a[80:83],a[160:163],v[88:91]
M v[88:91],a[84:87],a[164:167],v[88:91]
s_waitcnt lgkmcnt(2)
M v[92:95],a[92:95],a[164:167],v[92:95]
s_waitcnt vmcnt(18) lgkmcnt(0)
M v[92:95],a[88:91],a[160:163],v[92:95]
s_barrier
M v[124:127],a[88:91],a[168:171],v[124:127]
R a[160:163],v5,49152
R a[164:167],v6,49152
M v[124:127],a[92:95],a[172:175],v[124:127]
M v[120:123],a[84:87],a[172:175],v[120:123]
SA m0,s24,32768
T a[128:129],v1,16384
T a[130:131],v1,17408
M v[120:123],a[80:83],a[168:171],v[120:123]
buffer_load_dwordx4 v12, s[48:51], s22 offen offset:0   lds
M v[116:119],a[72:75],a[168:171],v[116:119]
M v[116:119],a[76:79],a[172:175],v[116:119]
M v[112:115],a[68:71],a[172:175],v[112:115]
M v[112:115],a[64:67],a[168:171],v[112:115]
M v[108:111],a[56:59],a[168:171],v[108:111]
M v[108:111],a[60:63],a[172:175],v[108:111]
s_nop 0
T a[132:133],v1,24576
T a[134:135],v1,25600
M v[104:107],a[52:55],a[172:175],v[104:107]
buffer_load_dwordx4 v13, s[48:51], s22 offen offset:1024   lds
M v[104:107],a[48:51],a[168:171],v[104:107]
M v[100:103],a[40:43],a[168:171],v[100:103]
M v[100:103],a[44:47],a[172:175],v[100:103]
s_waitcnt lgkmcnt(4)
M v[96:99],a[36:39],a[172:175],v[96:99]
M v[96:99],a[32:35],a[168:171],v[96:99]
M v[128:131],a[32:35],a[160:163],v[128:131]
R a[168:171],v5,51200
R a[172:175],v6,51200
M v[128:131],a[36:39],a[164:167],v[128:131]
T a[136:137],v2,16384
T a[138:139],v2,17408
M v[132:135],a[44:47],a[164:167],v[132:135]
buffer_load_dwordx4 v14, s[48:51], s22 offen offset:2048   lds
M v[132:135],a[40:43],a[160:163],v[132:135]
M v[136:139],a[48:51],a[160:163],v[136:139]
M v[136:139],a[52:55],a[164:167],v[136:139]
M v[140:143],a[60:63],a[164:167],v[140:143]
M v[140:143],a[56:59],a[160:163],v[140:143]
s_nop 0
T a[140:141],v2,24576
T a[142:143],v2,25600
M v[144:147],a[64:67],a[160:163],v[144:147]
buffer_load_dwordx4 v15, s[48:51], s22 offen offset:3072   lds
M v[144:147],a[68:71],a[164:167],v[144:147]
SA s22,s22,1048576
M v[148:151],a[76:79],a[164:167],v[148:151]
M v[148:151],a[72:75],a[160:163],v[148:151]
M v[152:155],a[80:83],a[160:163],v[152:155]
M v[152:155],a[84:87],a[164:167],v[152:155]
s_waitcnt lgkmcnt(4)
M v[156:159],a[92:95],a[164:167],v[156:159]
SA m0,s23,0
T a[144:145],v3,16384
T a[146:147],v3,17408
M v[156:159],a[88:91],a[160:163],v[156:159]
buffer_load_dwordx4 v8, s[16:19], s21 offen offset:0  nt lds
M v[188:191],a[88:91],a[168:171],v[188:191]
R a[160:163],v5,53248
R a[164:167],v6,53248
M v[188:191],a[92:95],a[172:175],v[188:191]
M v[184:187],a[84:87],a[172:175],v[184:187]
M v[184:187],a[80:83],a[168:171],v[184:187]
M v[180:183],a[72:75],a[168:171],v[180:183]
M v[180:183],a[76:79],a[172:175],v[180:183]
s_nop 0
T a[148:149],v3,24576
T a[150:151],v3,25600
M v[176:179],a[68:71],a[172:175],v[176:179]
buffer_load_dwordx4 v9, s[16:19], s21 offen offset:1024  nt lds
M v[176:179],a[64:67],a[168:171],v[176:179]
M v[172:175],a[56:59],a[168:171],v[172:175]
M v[172:175],a[60:63],a[172:175],v[172:175]
M v[168:171],a[52:55],a[172:175],v[168:171]
M v[168:171],a[48:51],a[168:171],v[168:171]
M v[164:167],a[40:43],a[168:171],v[164:167]
s_nop 0
T a[152:153],v4,16384
T a[154:155],v4,17408
M v[164:167],a[44:47],a[172:175],v[164:167]
s_waitcnt lgkmcnt(4)
buffer_load_dwordx4 v10, s[16:19], s21 offen offset:2048  nt lds
M v[160:163],a[36:39],a[172:175],v[160:163]
M v[160:163],a[32:35],a[168:171],v[160:163]
M v[192:195],a[32:35],a[160:163],v[192:195]
R a[168:171],v5,55296
R a[172:175],v6,55296
M v[192:195],a[36:39],a[164:167],v[192:195]
M v[196:199],a[44:47],a[164:167],v[196:199]
M v[196:199],a[40:43],a[160:163],v[196:199]
s_nop 0
T a[156:157],v4,24576
T a[158:159],v4,25600
M v[200:203],a[48:51],a[160:163],v[200:203]
buffer_load_dwordx4 v11, s[16:19], s21 offen offset:3072  nt lds
M v[200:203],a[52:55],a[164:167],v[200:203]
SA s21,s21,128
M v[204:207],a[60:63],a[164:167],v[204:207]
M v[204:207],a[56:59],a[160:163],v[204:207]
M v[208:211],a[64:67],a[160:163],v[208:211]
M v[208:211],a[68:71],a[164:167],v[208:211]
M v[212:215],a[76:79],a[164:167],v[212:215]
M v[212:215],a[72:75],a[160:163],v[212:215]
M v[216:219],a[80:83],a[160:163],v[216:219]
M v[216:219],a[84:87],a[164:167],v[216:219]
s_waitcnt lgkmcnt(2)
M v[220:223],a[92:95],a[164:167],v[220:223]
s_waitcnt vmcnt(17) lgkmcnt(0)
M v[220:223],a[88:91],a[160:163],v[220:223]
s_barrier
M v[252:255],a[88:91],a[168:171],v[252:255]
R a[160:163],v5,0
R a[164:167],v6,0
M v[252:255],a[92:95],a[172:175],v[252:255]
M v[248:251],a[84:87],a[172:175],v[248:251]
M v[248:251],a[80:83],a[168:171],v[248:251]
M v[244:247],a[72:75],a[168:171],v[244:247]
M v[244:247],a[76:79],a[172:175],v[244:247]
M v[240:243],a[68:71],a[172:175],v[240:243]
M v[240:243],a[64:67],a[168:171],v[240:243]
M v[236:239],a[56:59],a[168:171],v[236:239]
M v[236:239],a[60:63],a[172:175],v[236:239]
M v[232:235],a[52:55],a[172:175],v[232:235]
M v[232:235],a[48:51],a[168:171],v[232:235]
M v[228:231],a[40:43],a[168:171],v[228:231]
M v[228:231],a[44:47],a[172:175],v[228:231]
s_waitcnt lgkmcnt(0)
M v[224:227],a[36:39],a[172:175],v[224:227]
M v[224:227],a[32:35],a[168:171],v[224:227]
M a[0:3],a[96:99],a[160:163],a[0:3]
R a[168:171],v5,2048
R a[172:175],v6,2048
M a[0:3],a[100:103],a[164:167],a[0:3]
T a[32:33],v1,32768
T a[34:35],v1,33792
M a[4:7],a[108:111],a[164:167],a[4:7]
SA m0,s24,49152
M a[4:7],a[104:107],a[160:163],a[4:7]
buffer_load_dwordx4 v12, s[48:51], s22 offen offset:0   lds
M a[8:11],a[112:115],a[160:163],a[8:11]
M a[8:11],a[116:119],a[164:167],a[8:11]
M a[12:15],a[124:127],a[164:167],a[12:15]
s_nop 0
T a[36:37],v1,40960
T a[38:39],v1,41984
M a[12:15],a[120:123],a[160:163],a[12:15]
buffer_load_dwordx4 v13, s[48:51], s22 offen offset:1024   lds
M a[16:19],a[128:131],a[160:163],a[16:19]
M a[16:19],a[132:135],a[164:167],a[16:19]
M a[20:23],a[140:143],a[164:167],a[20:23]
M a[20:23],a[136:139],a[160:163],a[20:23]
s_nop 0
T a[40:41],v2,32768
T a[42:43],v2,33792
M a[24:27],a[144:147],a[160:163],a[24:27]
buffer_load_dwordx4 v14, s[48:51], s22 offen offset:2048   lds
M a[24:27],a[148:151],a[164:167],a[24:27]
s_waitcnt lgkmcnt(6)
M a[28:31],a[156:159],a[164:167],a[28:31]
M a[28:31],a[152:155],a[160:163],a[28:31]
M v[60:63],a[152:155],a[168:171],v[60:63]
R a[160:163],v5,4096
R a[164:167],v6,4096
M v[60:63],a[156:159],a[172:175],v[60:63]
T a[44:45],v2,40960
T a[46:47],v2,41984
M v[56:59],a[148:151],a[172:175],v[56:59]
buffer_load_dwordx4 v15, s[48:51], s22 offen offset:3072   lds
M v[56:59],a[144:147],a[168:171],v[56:59]
s_sub_u32 s22, s22, 1048448
M v[52:55],a[136:139],a[168:171],v[52:55]
SA m0,s23,16384
M v[52:55],a[140:143],a[172:175],v[52:55]
s_nop 0
T a[48:49],v3,32768
T a[50:51],v3,33792
M v[48:51],a[132:135],a[172:175],v[48:51]
buffer_load_dwordx4 v8, s[16:19], s21 offen offset:0  nt lds
M v[48:51],a[128:131],a[168:171],v[48:51]
M v[44:47],a[120:123],a[168:171],v[44:47]
M v[44:47],a[124:127],a[172:175],v[44:47]
buffer_load_dwordx4 v9, s[16:19], s21 offen offset:1024  nt lds
M v[40:43],a[116:119],a[172:175],v[40:43]
s_nop 0
T a[52:53],v3,40960
T a[54:55],v3,41984
M v[40:43],a[112:115],a[168:171],v[40:43]
M v[36:39],a[104:107],a[168:171],v[36:39]
M v[36:39],a[108:111],a[172:175],v[36:39]
s_waitcnt lgkmcnt(6)
M v[32:35],a[100:103],a[172:175],v[32:35]
buffer_load_dwordx4 v10, s[16:19], s21 offen offset:2048  nt lds
M v[32:35],a[96:99],a[168:171],v[32:35]
s_nop 0
T a[56:57],v4,32768
T a[58:59],v4,33792
M v[64:67],a[96:99],a[160:163],v[64:67]
R a[168:171],v5,6144
R a[172:175],v6,6144
M v[64:67],a[100:103],a[164:167],v[64:67]
M v[68:71],a[108:111],a[164:167],v[68:71]
buffer_load_dwordx4 v11, s[16:19], s21 offen offset:3072  nt lds
M v[68:71],a[104:107],a[160:163],v[68:71]
SA s21,s21,524160
M v[72:75],a[112:115],a[160:163],v[72:75]
s_nop 0
T a[60:61],v4,40960
T a[62:63],v4,41984
M v[72:75],a[116:119],a[164:167],v[72:75]
M v[76:79],a[124:127],a[164:167],v[76:79]
SA m0,s87,3072
M v[76:79],a[120:123],a[160:163],v[76:79]
buffer_load_dwordx4 v25, s[60:63], s89 offen offset:0 nt lds
M v[80:83],a[128:131],a[160:163],v[80:83]
SA s89,s89,114688
M v[80:83],a[132:135],a[164:167],v[80:83]
M v[84:87],a[140:143],a[164:167],v[84:87]
M v[84:87],a[136:139],a[160:163],v[84:87]
M v[88:91],a[144:147],a[160:163],v[88:91]
M v[88:91],a[148:151],a[164:167],v[88:91]
s_waitcnt lgkmcnt(2)
M v[92:95],a[156:159],a[164:167],v[92:95]
s_waitcnt vmcnt(18) lgkmcnt(0)
M v[92:95],a[152:155],a[160:163],v[92:95]
s_barrier
M v[124:127],a[152:155],a[168:171],v[124:127]
R a[160:163],v5,16384
R a[164:167],v6,16384
M v[124:127],a[156:159],a[172:175],v[124:127]
M v[120:123],a[148:151],a[172:175],v[120:123]
SA m0,s24,0
T a[64:65],v1,49152
T a[66:67],v1,50176
M v[120:123],a[144:147],a[168:171],v[120:123]
buffer_load_dwordx4 v12, s[48:51], s22 offen offset:0   lds
M v[116:119],a[136:139],a[168:171],v[116:119]
M v[116:119],a[140:143],a[172:175],v[116:119]
M v[112:115],a[132:135],a[172:175],v[112:115]
M v[112:115],a[128:131],a[168:171],v[112:115]
M v[108:111],a[120:123],a[168:171],v[108:111]
M v[108:111],a[124:127],a[172:175],v[108:111]
s_nop 0
T a[68:69],v1,57344
T a[70:71],v1,58368
M v[104:107],a[116:119],a[172:175],v[104:107]
buffer_load_dwordx4 v13, s[48:51], s22 offen offset:1024   lds
M v[104:107],a[112:115],a[168:171],v[104:107]
M v[100:103],a[104:107],a[168:171],v[100:103]
M v[100:103],a[108:111],a[172:175],v[100:103]
s_waitcnt lgkmcnt(4)
M v[96:99],a[100:103],a[172:175],v[96:99]
M v[96:99],a[96:99],a[168:171],v[96:99]
M v[128:131],a[96:99],a[160:163],v[128:131]
R a[168:171],v5,18432
R a[172:175],v6,18432
M v[128:131],a[100:103],a[164:167],v[128:131]
s_lshl_b32 s67, s20, 11
T a[72:73],v2,49152
T a[74:75],v2,50176
M v[132:135],a[108:111],a[164:167],v[132:135]
SA s67,s67,104914944
buffer_load_dwordx4 v14, s[48:51], s22 offen offset:2048   lds
M v[132:135],a[104:107],a[160:163],v[132:135]
M v[136:139],a[112:115],a[160:163],v[136:139]
M v[136:139],a[116:119],a[164:167],v[136:139]
buffer_load_dwordx4 v[16:19], v7, s[8:11], s67 offen offset:0 sc1
M v[140:143],a[124:127],a[164:167],v[140:143]
M v[140:143],a[120:123],a[160:163],v[140:143]
s_nop 0
T a[76:77],v2,57344
T a[78:79],v2,58368
M v[144:147],a[128:131],a[160:163],v[144:147]
buffer_load_dwordx4 v15, s[48:51], s22 offen offset:3072   lds
M v[144:147],a[132:135],a[164:167],v[144:147]
SA s22,s22,1048576
M v[148:151],a[140:143],a[164:167],v[148:151]
buffer_load_dwordx4 v[20:23], v7, s[8:11], s67 offen offset:1024 sc1
M v[148:151],a[136:139],a[160:163],v[148:151]
M v[152:155],a[144:147],a[160:163],v[152:155]
L_w_kv03:
s_cbranch_execz L_w_kv07
M v[152:155],a[148:151],a[164:167],v[152:155]
s_waitcnt lgkmcnt(4)
M v[156:159],a[156:159],a[164:167],v[156:159]
SA m0,s23,32768
T a[80:81],v3,49152
T a[82:83],v3,50176
M v[156:159],a[152:155],a[160:163],v[156:159]
buffer_load_dwordx4 v8, s[16:19], s21 offen offset:0  nt lds
M v[188:191],a[152:155],a[168:171],v[188:191]
R a[160:163],v5,20480
R a[164:167],v6,20480
M v[188:191],a[156:159],a[172:175],v[188:191]
M v[184:187],a[148:151],a[172:175],v[184:187]
M v[184:187],a[144:147],a[168:171],v[184:187]
M v[180:183],a[136:139],a[168:171],v[180:183]
M v[180:183],a[140:143],a[172:175],v[180:183]
s_nop 0
T a[84:85],v3,57344
T a[86:87],v3,58368
M v[176:179],a[132:135],a[172:175],v[176:179]
buffer_load_dwordx4 v9, s[16:19], s21 offen offset:1024  nt lds
M v[176:179],a[128:131],a[168:171],v[176:179]
M v[172:175],a[120:123],a[168:171],v[172:175]
M v[172:175],a[124:127],a[172:175],v[172:175]
M v[168:171],a[116:119],a[172:175],v[168:171]
M v[168:171],a[112:115],a[168:171],v[168:171]
M v[164:167],a[104:107],a[168:171],v[164:167]
s_nop 0
T a[88:89],v4,49152
T a[90:91],v4,50176
M v[164:167],a[108:111],a[172:175],v[164:167]
s_waitcnt lgkmcnt(4)
buffer_load_dwordx4 v10, s[16:19], s21 offen offset:2048  nt lds
M v[160:163],a[100:103],a[172:175],v[160:163]
M v[160:163],a[96:99],a[168:171],v[160:163]
M v[192:195],a[96:99],a[160:163],v[192:195]
R a[168:171],v5,22528
R a[172:175],v6,22528
M v[192:195],a[100:103],a[164:167],v[192:195]
M v[196:199],a[108:111],a[164:167],v[196:199]
M v[196:199],a[104:107],a[160:163],v[196:199]
s_nop 0
T a[92:93],v4,57344
T a[94:95],v4,58368
M v[200:203],a[112:115],a[160:163],v[200:203]
buffer_load_dwordx4 v11, s[16:19], s21 offen offset:3072  nt lds
M v[200:203],a[116:119],a[164:167],v[200:203]
SA s21,s21,128
M v[204:207],a[124:127],a[164:167],v[204:207]
M v[204:207],a[120:123],a[160:163],v[204:207]
M v[208:211],a[128:131],a[160:163],v[208:211]
M v[208:211],a[132:135],a[164:167],v[208:211]
M v[212:215],a[140:143],a[164:167],v[212:215]
M v[212:215],a[136:139],a[160:163],v[212:215]
M v[216:219],a[144:147],a[160:163],v[216:219]
M v[216:219],a[148:151],a[164:167],v[216:219]
s_waitcnt lgkmcnt(2)
M v[220:223],a[156:159],a[164:167],v[220:223]
s_waitcnt vmcnt(19) lgkmcnt(0)
M v[220:223],a[152:155],a[160:163],v[220:223]
s_barrier
M v[252:255],a[152:155],a[168:171],v[252:255]
R a[160:163],v5,32768
R a[164:167],v6,32768
M v[252:255],a[156:159],a[172:175],v[252:255]
M v[248:251],a[148:151],a[172:175],v[248:251]
M v[248:251],a[144:147],a[168:171],v[248:251]
M v[244:247],a[136:139],a[168:171],v[244:247]
M v[244:247],a[140:143],a[172:175],v[244:247]
M v[240:243],a[132:135],a[172:175],v[240:243]
M v[240:243],a[128:131],a[168:171],v[240:243]
M v[236:239],a[120:123],a[168:171],v[236:239]
M v[236:239],a[124:127],a[172:175],v[236:239]
M v[232:235],a[116:119],a[172:175],v[232:235]
M v[232:235],a[112:115],a[168:171],v[232:235]
M v[228:231],a[104:107],a[168:171],v[228:231]
M v[228:231],a[108:111],a[172:175],v[228:231]
s_waitcnt lgkmcnt(0)
M v[224:227],a[100:103],a[172:175],v[224:227]
M v[224:227],a[96:99],a[168:171],v[224:227]
M a[0:3],a[32:35],a[160:163],a[0:3]
R a[168:171],v5,34816
R a[172:175],v6,34816
M a[0:3],a[36:39],a[164:167],a[0:3]
T a[96:97],v1,0
T a[98:99],v1,1024
M a[4:7],a[44:47],a[164:167],a[4:7]
SA m0,s24,16384
M a[4:7],a[40:43],a[160:163],a[4:7]
buffer_load_dwordx4 v12, s[48:51], s22 offen offset:0   lds
M a[8:11],a[48:51],a[160:163],a[8:11]
M a[8:11],a[52:55],a[164:167],a[8:11]
M a[12:15],a[60:63],a[164:167],a[12:15]
s_nop 0
T a[100:101],v1,8192
T a[102:103],v1,9216
M a[12:15],a[56:59],a[160:163],a[12:15]
buffer_load_dwordx4 v13, s[48:51], s22 offen offset:1024   lds
M a[16:19],a[64:67],a[160:163],a[16:19]
M a[16:19],a[68:71],a[164:167],a[16:19]
M a[20:23],a[76:79],a[164:167],a[20:23]
s_waitcnt vmcnt(8)
v_min3_u32 v28, v16, v17, v18
M a[20:23],a[72:75],a[160:163],a[20:23]
s_nop 0
T a[104:105],v2,0
T a[106:107],v2,1024
M a[24:27],a[80:83],a[160:163],a[24:27]
buffer_load_dwordx4 v14, s[48:51], s22 offen offset:2048   lds
M a[24:27],a[84:87],a[164:167],a[24:27]
s_waitcnt lgkmcnt(6)
s_waitcnt vmcnt(7)
v_min3_u32 v28, v28, v19, v20
M a[28:31],a[92:95],a[164:167],a[28:31]
v_min3_u32 v28, v28, v21, v22
M a[28:31],a[88:91],a[160:163],a[28:31]
v_min_u32 v28, v28, v23
M v[60:63],a[88:91],a[168:171],v[60:63]
R a[160:163],v5,36864
R a[164:167],v6,36864
M v[60:63],a[92:95],a[172:175],v[60:63]
T a[108:109],v2,8192
T a[110:111],v2,9216
M v[56:59],a[84:87],a[172:175],v[56:59]
buffer_load_dwordx4 v15, s[48:51], s22 offen offset:3072   lds
M v[56:59],a[80:83],a[168:171],v[56:59]
s_sub_u32 s22, s22, 1048448
v_cmp_eq_u32 vcc, 0, v28
M v[52:55],a[72:75],a[168:171],v[52:55]
SA m0,s23,49152
s_nop 0
M v[52:55],a[76:79],a[172:175],v[52:55]
s_cbranch_vccnz L_hs
L_hr:
T a[112:113],v3,0
T a[114:115],v3,1024
M v[48:51],a[68:71],a[172:175],v[48:51]
buffer_load_dwordx4 v8, s[16:19], s21 offen offset:0  nt lds
M v[48:51],a[64:67],a[168:171],v[48:51]
v_max_u32 v28, v16, v17
M v[44:47],a[56:59],a[168:171],v[44:47]
v_min_u32 v29, v16, v17
M v[44:47],a[60:63],a[172:175],v[44:47]
buffer_load_dwordx4 v9, s[16:19], s21 offen offset:1024  nt lds
M v[40:43],a[52:55],a[172:175],v[40:43]
s_nop 0
T a[116:117],v3,8192
T a[118:119],v3,9216
M v[40:43],a[48:51],a[168:171],v[40:43]
v_med3_u32 v29, v28, v29, v18
M v[36:39],a[40:43],a[168:171],v[36:39]
v_max_u32 v28, v28, v18
M v[36:39],a[44:47],a[172:175],v[36:39]
s_waitcnt lgkmcnt(6)
v_med3_u32 v29, v28, v29, v19
M v[32:35],a[36:39],a[172:175],v[32:35]
buffer_load_dwordx4 v10, s[16:19], s21 offen offset:2048  nt lds
M v[32:35],a[32:35],a[168:171],v[32:35]
s_nop 0
T a[120:121],v4,0
T a[122:123],v4,1024
M v[64:67],a[32:35],a[160:163],v[64:67]
R a[168:171],v5,38912
R a[172:175],v6,38912
M v[64:67],a[36:39],a[164:167],v[64:67]
v_max_u32 v28, v28, v19
M v[68:71],a[44:47],a[164:167],v[68:71]
buffer_load_dwordx4 v11, s[16:19], s21 offen offset:3072  nt lds
M v[68:71],a[40:43],a[160:163],v[68:71]
SA s21,s21,524160
v_med3_u32 v29, v28, v29, v20
M v[72:75],a[48:51],a[160:163],v[72:75]
s_nop 0
T a[124:125],v4,8192
T a[126:127],v4,9216
M v[72:75],a[52:55],a[164:167],v[72:75]
v_max_u32 v28, v28, v20
M v[76:79],a[60:63],a[164:167],v[76:79]
SA m0,s87,4096
v_med3_u32 v29, v28, v29, v21
M v[76:79],a[56:59],a[160:163],v[76:79]
buffer_load_dwordx4 v25, s[60:63], s89 offen offset:0 nt lds
M v[80:83],a[64:67],a[160:163],v[80:83]
SA s89,s89,114688
v_max_u32 v28, v28, v21
M v[80:83],a[68:71],a[164:167],v[80:83]
v_med3_u32 v29, v28, v29, v22
M v[84:87],a[76:79],a[164:167],v[84:87]
v_max_u32 v28, v28, v22
M v[84:87],a[72:75],a[160:163],v[84:87]
v_med3_u32 v29, v28, v29, v23
M v[88:91],a[80:83],a[160:163],v[88:91]
v_max_u32 v28, v28, v23
M v[88:91],a[84:87],a[164:167],v[88:91]
s_waitcnt lgkmcnt(2)
v_mov_b32 v30, v28 row_ror:8 row_mask:0xf bank_mask:0xf
M v[92:95],a[92:95],a[164:167],v[92:95]
s_waitcnt lgkmcnt(0)
v_mov_b32 v31, v29 row_ror:8 row_mask:0xf bank_mask:0xf
M v[92:95],a[88:91],a[160:163],v[92:95]
s_barrier
M v[124:127],a[88:91],a[168:171],v[124:127]
R a[160:163],v5,49152
R a[164:167],v6,49152
M v[124:127],a[92:95],a[172:175],v[124:127]
v_min_u32 v16, v28, v30
M v[120:123],a[84:87],a[172:175],v[120:123]
SA m0,s24,32768
T a[128:129],v1,16384
T a[130:131],v1,17408
M v[120:123],a[80:83],a[168:171],v[120:123]
buffer_load_dwordx4 v12, s[48:51], s22 offen offset:0   lds
M v[116:119],a[72:75],a[168:171],v[116:119]
v_max_u32 v28, v28, v30
M v[116:119],a[76:79],a[172:175],v[116:119]
v_max3_u32 v29, v29, v31, v16
M v[112:115],a[68:71],a[172:175],v[112:115]
v_mov_b32 v30, v28 row_ror:4 row_mask:0xf bank_mask:0xf
M v[112:115],a[64:67],a[168:171],v[112:115]
v_mov_b32 v31, v29 row_ror:4 row_mask:0xf bank_mask:0xf
M v[108:111],a[56:59],a[168:171],v[108:111]
v_min_u32 v16, v28, v30
M v[108:111],a[60:63],a[172:175],v[108:111]
s_nop 0
T a[132:133],v1,24576
T a[134:135],v1,25600
M v[104:107],a[52:55],a[172:175],v[104:107]
buffer_load_dwordx4 v13, s[48:51], s22 offen offset:1024   lds
M v[104:107],a[48:51],a[168:171],v[104:107]
v_max_u32 v28, v28, v30
M v[100:103],a[40:43],a[168:171],v[100:103]
v_max3_u32 v29, v29, v31, v16
M v[100:103],a[44:47],a[172:175],v[100:103]
s_waitcnt lgkmcnt(4)
v_mov_b32 v30, v28 row_ror:2 row_mask:0xf bank_mask:0xf
M v[96:99],a[36:39],a[172:175],v[96:99]
v_mov_b32 v31, v29 row_ror:2 row_mask:0xf bank_mask:0xf
M v[96:99],a[32:35],a[168:171],v[96:99]
v_min_u32 v16, v28, v30
M v[128:131],a[32:35],a[160:163],v[128:131]
R a[168:171],v5,51200
R a[172:175],v6,51200
M v[128:131],a[36:39],a[164:167],v[128:131]
T a[136:137],v2,16384
T a[138:139],v2,17408
M v[132:135],a[44:47],a[164:167],v[132:135]
buffer_load_dwordx4 v14, s[48:51], s22 offen offset:2048   lds
M v[132:135],a[40:43],a[160:163],v[132:135]
v_max_u32 v28, v28, v30
M v[136:139],a[48:51],a[160:163],v[136:139]
v_max3_u32 v29, v29, v31, v16
M v[136:139],a[52:55],a[164:167],v[136:139]
v_mov_b32 v30, v28 row_ror:1 row_mask:0xf bank_mask:0xf
M v[140:143],a[60:63],a[164:167],v[140:143]
v_mov_b32 v31, v29 row_ror:1 row_mask:0xf bank_mask:0xf
M v[140:143],a[56:59],a[160:163],v[140:143]
s_nop 0
T a[140:141],v2,24576
T a[142:143],v2,25600
M v[144:147],a[64:67],a[160:163],v[144:147]
buffer_load_dwordx4 v15, s[48:51], s22 offen offset:3072   lds
M v[144:147],a[68:71],a[164:167],v[144:147]
SA s22,s22,1048576
v_min_u32 v16, v28, v30
M v[148:151],a[76:79],a[164:167],v[148:151]
v_max_u32 v28, v28, v30
M v[148:151],a[72:75],a[160:163],v[148:151]
v_max3_u32 v29, v29, v31, v16
M v[152:155],a[80:83],a[160:163],v[152:155]
v_mov_b32 v30, v28
M v[152:155],a[84:87],a[164:167],v[152:155]
s_waitcnt lgkmcnt(4)
v_mov_b32 v31, v29
M v[156:159],a[92:95],a[164:167],v[156:159]
SA m0,s23,0
T a[144:145],v3,16384
T a[146:147],v3,17408
M v[156:159],a[88:91],a[160:163],v[156:159]
buffer_load_dwordx4 v8, s[16:19], s21 offen offset:0  nt lds
M v[188:191],a[88:91],a[168:171],v[188:191]
R a[160:163],v5,53248
R a[164:167],v6,53248
M v[188:191],a[92:95],a[172:175],v[188:191]
v_permlane16_swap_b32 v30, v28
M v[184:187],a[84:87],a[172:175],v[184:187]
v_permlane16_swap_b32 v31, v29
M v[184:187],a[80:83],a[168:171],v[184:187]
v_min_u32 v16, v28, v30
M v[180:183],a[72:75],a[168:171],v[180:183]
v_max_u32 v28, v28, v30
M v[180:183],a[76:79],a[172:175],v[180:183]
s_nop 0
T a[148:149],v3,24576
T a[150:151],v3,25600
M v[176:179],a[68:71],a[172:175],v[176:179]
buffer_load_dwordx4 v9, s[16:19], s21 offen offset:1024  nt lds
M v[176:179],a[64:67],a[168:171],v[176:179]
v_max3_u32 v29, v29, v31, v16
M v[172:175],a[56:59],a[168:171],v[172:175]
v_mov_b32 v30, v28
M v[172:175],a[60:63],a[172:175],v[172:175]
v_mov_b32 v31, v29
M v[168:171],a[52:55],a[172:175],v[168:171]
v_permlane32_swap_b32 v30, v28
M v[168:171],a[48:51],a[168:171],v[168:171]
v_permlane32_swap_b32 v31, v29
M v[164:167],a[40:43],a[168:171],v[164:167]
s_nop 0
T a[152:153],v4,16384
T a[154:155],v4,17408
M v[164:167],a[44:47],a[172:175],v[164:167]
s_waitcnt lgkmcnt(4)
buffer_load_dwordx4 v10, s[16:19], s21 offen offset:2048  nt lds
M v[160:163],a[36:39],a[172:175],v[160:163]
v_min_u32 v16, v28, v30
M v[160:163],a[32:35],a[168:171],v[160:163]
v_max_u32 v28, v28, v30
M v[192:195],a[32:35],a[160:163],v[192:195]
R a[168:171],v5,55296
R a[172:175],v6,55296
M v[192:195],a[36:39],a[164:167],v[192:195]
v_max3_u32 v29, v29, v31, v16
M v[196:199],a[44:47],a[164:167],v[196:199]
s_lshl_b32 s64, s20, 3
M v[196:199],a[40:43],a[160:163],v[196:199]
SA s64,s64,159744
T a[156:157],v4,24576
T a[158:159],v4,25600
M v[200:203],a[48:51],a[160:163],v[200:203]
buffer_load_dwordx4 v11, s[16:19], s21 offen offset:3072  nt lds
M v[200:203],a[52:55],a[164:167],v[200:203]
SA s21,s21,128
v_mov_b32 v16, s64
M v[204:207],a[60:63],a[164:167],v[204:207]
ds_write_b64 v16, v[28:29]
M v[204:207],a[56:59],a[160:163],v[204:207]
M v[208:211],a[64:67],a[160:163],v[208:211]
M v[208:211],a[68:71],a[164:167],v[208:211]
M v[212:215],a[76:79],a[164:167],v[212:215]
M v[212:215],a[72:75],a[160:163],v[212:215]
M v[216:219],a[80:83],a[160:163],v[216:219]
M v[216:219],a[84:87],a[164:167],v[216:219]
s_waitcnt lgkmcnt(3)
M v[220:223],a[92:95],a[164:167],v[220:223]
s_waitcnt vmcnt(17) lgkmcnt(0)
M v[220:223],a[88:91],a[160:163],v[220:223]
s_barrier
M v[252:255],a[88:91],a[168:171],v[252:255]
R a[160:163],v5,0
R a[164:167],v6,0
M v[252:255],a[92:95],a[172:175],v[252:255]
M v[248:251],a[84:87],a[172:175],v[248:251]
M v[248:251],a[80:83],a[168:171],v[248:251]
M v[244:247],a[72:75],a[168:171],v[244:247]
M v[244:247],a[76:79],a[172:175],v[244:247]
M v[240:243],a[68:71],a[172:175],v[240:243]
M v[240:243],a[64:67],a[168:171],v[240:243]
M v[236:239],a[56:59],a[168:171],v[236:239]
M v[236:239],a[60:63],a[172:175],v[236:239]
M v[232:235],a[52:55],a[172:175],v[232:235]
M v[232:235],a[48:51],a[168:171],v[232:235]
M v[228:231],a[40:43],a[168:171],v[228:231]
M v[228:231],a[44:47],a[172:175],v[228:231]
s_waitcnt lgkmcnt(0)
M v[224:227],a[36:39],a[172:175],v[224:227]
M v[224:227],a[32:35],a[168:171],v[224:227]
M a[0:3],a[96:99],a[160:163],a[0:3]
R a[168:171],v5,2048
R a[172:175],v6,2048
M a[0:3],a[100:103],a[164:167],a[0:3]
T a[32:33],v1,32768
T a[34:35],v1,33792
M a[4:7],a[108:111],a[164:167],a[4:7]
SA m0,s24,49152
M a[4:7],a[104:107],a[160:163],a[4:7]
buffer_load_dwordx4 v12, s[48:51], s22 offen offset:0   lds
M a[8:11],a[112:115],a[160:163],a[8:11]
v_mov_b32 v28, 159744
M a[8:11],a[116:119],a[164:167],a[8:11]
ds_read_b128 v[16:19], v28
M a[12:15],a[124:127],a[164:167],a[12:15]
s_nop 0
T a[36:37],v1,40960
T a[38:39],v1,41984
M a[12:15],a[120:123],a[160:163],a[12:15]
buffer_load_dwordx4 v13, s[48:51], s22 offen offset:1024   lds
M a[16:19],a[128:131],a[160:163],a[16:19]
R v[20:23],v28,16
M a[16:19],a[132:135],a[164:167],a[16:19]
M a[20:23],a[140:143],a[164:167],a[20:23]
M a[20:23],a[136:139],a[160:163],a[20:23]
s_nop 0
T a[40:41],v2,32768
T a[42:43],v2,33792
M a[24:27],a[144:147],a[160:163],a[24:27]
buffer_load_dwordx4 v14, s[48:51], s22 offen offset:2048   lds
M a[24:27],a[148:151],a[164:167],a[24:27]
s_waitcnt lgkmcnt(8)
M a[28:31],a[156:159],a[164:167],a[28:31]
M a[28:31],a[152:155],a[160:163],a[28:31]
M v[60:63],a[152:155],a[168:171],v[60:63]
R a[160:163],v5,4096
R a[164:167],v6,4096
M v[60:63],a[156:159],a[172:175],v[60:63]
T a[44:45],v2,40960
T a[46:47],v2,41984
M v[56:59],a[148:151],a[172:175],v[56:59]
buffer_load_dwordx4 v15, s[48:51], s22 offen offset:3072   lds
M v[56:59],a[144:147],a[168:171],v[56:59]
s_sub_u32 s22, s22, 1048448
s_waitcnt lgkmcnt(9)
v_min_u32 v28, v16, v18
M v[52:55],a[136:139],a[168:171],v[52:55]
SA m0,s23,16384
v_max_u32 v16, v16, v18
M v[52:55],a[140:143],a[172:175],v[52:55]
s_nop 0
T a[48:49],v3,32768
T a[50:51],v3,33792
M v[48:51],a[132:135],a[172:175],v[48:51]
buffer_load_dwordx4 v8, s[16:19], s21 offen offset:0  nt lds
M v[48:51],a[128:131],a[168:171],v[48:51]
v_max3_u32 v17, v17, v19, v28
M v[44:47],a[120:123],a[168:171],v[44:47]
s_waitcnt lgkmcnt(8)
v_min_u32 v29, v20, v22
M v[44:47],a[124:127],a[172:175],v[44:47]
buffer_load_dwordx4 v9, s[16:19], s21 offen offset:1024  nt lds
M v[40:43],a[116:119],a[172:175],v[40:43]
s_nop 0
T a[52:53],v3,40960
T a[54:55],v3,41984
M v[40:43],a[112:115],a[168:171],v[40:43]
v_max_u32 v20, v20, v22
M v[36:39],a[104:107],a[168:171],v[36:39]
v_max3_u32 v21, v21, v23, v29
M v[36:39],a[108:111],a[172:175],v[36:39]
s_waitcnt lgkmcnt(6)
v_min_u32 v28, v16, v20
M v[32:35],a[100:103],a[172:175],v[32:35]
buffer_load_dwordx4 v10, s[16:19], s21 offen offset:2048  nt lds
M v[32:35],a[96:99],a[168:171],v[32:35]
s_nop 0
T a[56:57],v4,32768
T a[58:59],v4,33792
M v[64:67],a[96:99],a[160:163],v[64:67]
R a[168:171],v5,6144
R a[172:175],v6,6144
M v[64:67],a[100:103],a[164:167],v[64:67]
v_max_u32 v16, v16, v20
M v[68:71],a[108:111],a[164:167],v[68:71]
buffer_load_dwordx4 v11, s[16:19], s21 offen offset:3072  nt lds
M v[68:71],a[104:107],a[160:163],v[68:71]
SA s21,s21,524160
v_max3_u32 v17, v17, v21, v28
M v[72:75],a[112:115],a[160:163],v[72:75]
s_nop 0
T a[60:61],v4,40960
T a[62:63],v4,41984
M v[72:75],a[116:119],a[164:167],v[72:75]
v_and_b32 v28, 1, v0
M v[76:79],a[124:127],a[164:167],v[76:79]
SA m0,s87,5120
v_cmp_eq_u32 vcc, 0, v28
M v[76:79],a[120:123],a[160:163],v[76:79]
s_and_b32 s64, s20, 1
buffer_load_dwordx4 v25, s[60:63], s89 offen offset:0 nt lds
M v[80:83],a[128:131],a[160:163],v[80:83]
SA s89,s89,114688
s_mul_i32 s64, s64, 448
v_cndmask_b32 v24, v17, v16, vcc
M v[80:83],a[132:135],a[164:167],v[80:83]
v_and_b32 v24, 0x7ff, v24
M v[84:87],a[140:143],a[164:167],v[84:87]
v_sub_u32 v24, 2047, v24
M v[84:87],a[136:139],a[160:163],v[84:87]
v_mul_u32_u24 v28, 896, v24
M v[88:91],a[144:147],a[160:163],v[88:91]
v_lshrrev_b32 v29, 4, v0
M v[88:91],a[148:151],a[164:167],v[88:91]
s_waitcnt lgkmcnt(2)
v_lshl_add_u32 v28, v29, 4, v28
M v[92:95],a[156:159],a[164:167],v[92:95]
s_waitcnt vmcnt(18) lgkmcnt(0)
v_bfe_u32 v30, v0, 1, 3
M v[92:95],a[152:155],a[160:163],v[92:95]
s_barrier
M v[124:127],a[152:155],a[168:171],v[124:127]
R a[160:163],v5,16384
R a[164:167],v6,16384
M v[124:127],a[156:159],a[172:175],v[124:127]
v_lshl_or_b32 v28, v30, 26, v28
M v[120:123],a[148:151],a[172:175],v[120:123]
SA m0,s24,0
T a[64:65],v1,49152
T a[66:67],v1,50176
M v[120:123],a[144:147],a[168:171],v[120:123]
buffer_load_dwordx4 v12, s[48:51], s22 offen offset:0   lds
M v[116:119],a[136:139],a[168:171],v[116:119]
M v[116:119],a[140:143],a[172:175],v[116:119]
M v[112:115],a[132:135],a[172:175],v[112:115]
buffer_load_dwordx4 a[208:211], v28, s[56:59], s64 offen offset:0
M v[112:115],a[128:131],a[168:171],v[112:115]
M v[108:111],a[120:123],a[168:171],v[108:111]
buffer_load_dwordx4 a[212:215], v28, s[56:59], s64 offen offset:64
M v[108:111],a[124:127],a[172:175],v[108:111]
s_nop 0
T a[68:69],v1,57344
T a[70:71],v1,58368
M v[104:107],a[116:119],a[172:175],v[104:107]
buffer_load_dwordx4 v13, s[48:51], s22 offen offset:1024   lds
M v[104:107],a[112:115],a[168:171],v[104:107]
M v[100:103],a[104:107],a[168:171],v[100:103]
buffer_load_dwordx4 a[216:219], v28, s[56:59], s64 offen offset:128
M v[100:103],a[108:111],a[172:175],v[100:103]
s_waitcnt lgkmcnt(4)
M v[96:99],a[100:103],a[172:175],v[96:99]
M v[96:99],a[96:99],a[168:171],v[96:99]
buffer_load_dwordx4 v14, s[48:51], s22 offen offset:2048   lds
M v[128:131],a[96:99],a[160:163],v[128:131]
R a[168:171],v5,18432
R a[172:175],v6,18432
M v[128:131],a[100:103],a[164:167],v[128:131]
T a[72:73],v2,49152
T a[74:75],v2,50176
M v[132:135],a[108:111],a[164:167],v[132:135]
buffer_load_dwordx4 a[220:223], v28, s[56:59], s64 offen offset:192
M v[132:135],a[104:107],a[160:163],v[132:135]
M v[136:139],a[112:115],a[160:163],v[136:139]
buffer_load_dwordx4 a[224:227], v28, s[56:59], s64 offen offset:256
M v[136:139],a[116:119],a[164:167],v[136:139]
M v[140:143],a[124:127],a[164:167],v[140:143]
buffer_load_dwordx4 v15, s[48:51], s22 offen offset:3072   lds
M v[140:143],a[120:123],a[160:163],v[140:143]
SA s22,s22,1048576
T a[76:77],v2,57344
T a[78:79],v2,58368
M v[144:147],a[128:131],a[160:163],v[144:147]
M v[144:147],a[132:135],a[164:167],v[144:147]
buffer_load_dwordx4 a[228:231], v28, s[56:59], s64 offen offset:320
M v[148:151],a[140:143],a[164:167],v[148:151]
M v[148:151],a[136:139],a[160:163],v[148:151]
SA m0,s23,32768
M v[152:155],a[144:147],a[160:163],v[152:155]
buffer_load_dwordx4 v8, s[16:19], s21 offen offset:0  nt lds
M v[152:155],a[148:151],a[164:167],v[152:155]
s_waitcnt lgkmcnt(4)
M v[156:159],a[156:159],a[164:167],v[156:159]
s_nop 0
T a[80:81],v3,49152
T a[82:83],v3,50176
M v[156:159],a[152:155],a[160:163],v[156:159]
buffer_load_dwordx4 a[232:235], v28, s[56:59], s64 offen offset:384
M v[188:191],a[152:155],a[168:171],v[188:191]
R a[160:163],v5,20480
R a[164:167],v6,20480
M v[188:191],a[156:159],a[172:175],v[188:191]
v_lshrrev_b32 v28, 4, v24
M v[184:187],a[148:151],a[172:175],v[184:187]
buffer_load_dwordx4 v9, s[16:19], s21 offen offset:1024  nt lds
M v[184:187],a[144:147],a[168:171],v[184:187]
L_w_kv04:
s_cbranch_execz L_w_kv08
v_lshlrev_b32 v28, 5, v28
M v[180:183],a[136:139],a[168:171],v[180:183]
v_and_b32 v30, 15, v24
M v[180:183],a[140:143],a[172:175],v[180:183]
s_nop 0
T a[84:85],v3,57344
T a[86:87],v3,58368
M v[176:179],a[132:135],a[172:175],v[176:179]
v_add_lshl_u32 v28, v28, v30, 2
M v[176:179],a[128:131],a[168:171],v[176:179]
v_lshrrev_b32 v30, 1, v0
M v[172:175],a[120:123],a[168:171],v[172:175]
v_min_u32 v30, 1, v30
M v[172:175],a[124:127],a[172:175],v[172:175]
buffer_load_dwordx4 v10, s[16:19], s21 offen offset:2048  nt lds
M v[168:171],a[116:119],a[172:175],v[168:171]
v_lshl_or_b32 v28, v30, 29, v28
M v[168:171],a[112:115],a[168:171],v[168:171]
s_or_b32 s64, s31, s20
M v[164:167],a[104:107],a[168:171],v[164:167]
s_min_u32 s64, s64, 1
T a[88:89],v4,49152
T a[90:91],v4,50176
M v[164:167],a[108:111],a[172:175],v[164:167]
s_waitcnt lgkmcnt(4)
s_lshl_b32 s64, s64, 29
M v[160:163],a[100:103],a[172:175],v[160:163]
SA s64,s64,104857600
buffer_load_dword v23, v28, s[8:11], s64 offen sc1
M v[160:163],a[96:99],a[168:171],v[160:163]
buffer_load_dwordx4 v11, s[16:19], s21 offen offset:3072  nt lds
M v[192:195],a[96:99],a[160:163],v[192:195]
SA s21,s21,128
R a[168:171],v5,22528
R a[172:175],v6,22528
M v[192:195],a[100:103],a[164:167],v[192:195]
v_bfe_u32 v28, v0, 2, 2
M v[196:199],a[108:111],a[164:167],v[196:199]
v_lshl_add_u32 v28, v29, 3, v28
M v[196:199],a[104:107],a[160:163],v[196:199]
s_nop 0
T a[92:93],v4,57344
T a[94:95],v4,58368
M v[200:203],a[112:115],a[160:163],v[200:203]
SA m0,s87,6144
v_lshlrev_b32 v28, 5, v28
M v[200:203],a[116:119],a[164:167],v[200:203]
buffer_load_dwordx4 v25, s[60:63], s89 offen offset:0 nt lds
M v[204:207],a[124:127],a[164:167],v[204:207]
SA s89,s89,114688
v_and_b32 v30, 3, v0
M v[204:207],a[120:123],a[160:163],v[204:207]
v_lshl_add_u32 v28, v30, 3, v28
M v[208:211],a[128:131],a[160:163],v[208:211]
v_add_u32 v22, s87, v28
M v[208:211],a[132:135],a[164:167],v[208:211]
M v[212:215],a[140:143],a[164:167],v[212:215]
M v[212:215],a[136:139],a[160:163],v[212:215]
M v[216:219],a[144:147],a[160:163],v[216:219]
M v[216:219],a[148:151],a[164:167],v[216:219]
s_waitcnt lgkmcnt(2)
M v[220:223],a[156:159],a[164:167],v[220:223]
s_waitcnt vmcnt(26) lgkmcnt(0)
M v[220:223],a[152:155],a[160:163],v[220:223]
s_barrier
M v[252:255],a[152:155],a[168:171],v[252:255]
R a[160:163],v5,32768
R a[164:167],v6,32768
M v[252:255],a[156:159],a[172:175],v[252:255]
M v[248:251],a[148:151],a[172:175],v[248:251]
M v[248:251],a[144:147],a[168:171],v[248:251]
M v[244:247],a[136:139],a[168:171],v[244:247]
M v[244:247],a[140:143],a[172:175],v[244:247]
M v[240:243],a[132:135],a[172:175],v[240:243]
M v[240:243],a[128:131],a[168:171],v[240:243]
M v[236:239],a[120:123],a[168:171],v[236:239]
M v[236:239],a[124:127],a[172:175],v[236:239]
M v[232:235],a[116:119],a[172:175],v[232:235]
M v[232:235],a[112:115],a[168:171],v[232:235]
M v[228:231],a[104:107],a[168:171],v[228:231]
M v[228:231],a[108:111],a[172:175],v[228:231]
s_waitcnt lgkmcnt(0)
M v[224:227],a[100:103],a[172:175],v[224:227]
M v[224:227],a[96:99],a[168:171],v[224:227]
M a[0:3],a[32:35],a[160:163],a[0:3]
R a[168:171],v5,34816
R a[172:175],v6,34816
M a[0:3],a[36:39],a[164:167],a[0:3]
T a[96:97],v1,0
T a[98:99],v1,1024
M a[4:7],a[44:47],a[164:167],a[4:7]
SA m0,s24,16384
M a[4:7],a[40:43],a[160:163],a[4:7]
buffer_load_dwordx4 v12, s[48:51], s22 offen offset:0   lds
M a[8:11],a[48:51],a[160:163],a[8:11]
M a[8:11],a[52:55],a[164:167],a[8:11]
M a[12:15],a[60:63],a[164:167],a[12:15]
s_nop 0
T a[100:101],v1,8192
T a[102:103],v1,9216
M a[12:15],a[56:59],a[160:163],a[12:15]
M a[16:19],a[64:67],a[160:163],a[16:19]
buffer_load_dwordx4 v13, s[48:51], s22 offen offset:1024   lds
M a[16:19],a[68:71],a[164:167],a[16:19]
M a[20:23],a[76:79],a[164:167],a[20:23]
M a[20:23],a[72:75],a[160:163],a[20:23]
s_nop 0
T a[104:105],v2,0
T a[106:107],v2,1024
M a[24:27],a[80:83],a[160:163],a[24:27]
M a[24:27],a[84:87],a[164:167],a[24:27]
s_waitcnt lgkmcnt(6)
buffer_load_dwordx4 v14, s[48:51], s22 offen offset:2048   lds
M a[28:31],a[92:95],a[164:167],a[28:31]
M a[28:31],a[88:91],a[160:163],a[28:31]
M v[60:63],a[88:91],a[168:171],v[60:63]
R a[160:163],v5,36864
R a[164:167],v6,36864
M v[60:63],a[92:95],a[172:175],v[60:63]
T a[108:109],v2,8192
T a[110:111],v2,9216
M v[56:59],a[84:87],a[172:175],v[56:59]
buffer_load_dwordx4 v15, s[48:51], s22 offen offset:3072   lds
M v[56:59],a[80:83],a[168:171],v[56:59]
s_sub_u32 s22, s22, 1048448
M v[52:55],a[72:75],a[168:171],v[52:55]
M v[52:55],a[76:79],a[172:175],v[52:55]
s_nop 0
T a[112:113],v3,0
T a[114:115],v3,1024
M v[48:51],a[68:71],a[172:175],v[48:51]
SA m0,s23,49152
M v[48:51],a[64:67],a[168:171],v[48:51]
buffer_load_dwordx4 v8, s[16:19], s21 offen offset:0  nt lds
M v[44:47],a[56:59],a[168:171],v[44:47]
M v[44:47],a[60:63],a[172:175],v[44:47]
M v[40:43],a[52:55],a[172:175],v[40:43]
s_nop 0
T a[116:117],v3,8192
T a[118:119],v3,9216
M v[40:43],a[48:51],a[168:171],v[40:43]
M v[36:39],a[40:43],a[168:171],v[36:39]
buffer_load_dwordx4 v9, s[16:19], s21 offen offset:1024  nt lds
M v[36:39],a[44:47],a[172:175],v[36:39]
s_waitcnt lgkmcnt(6)
M v[32:35],a[36:39],a[172:175],v[32:35]
M v[32:35],a[32:35],a[168:171],v[32:35]
s_nop 0
T a[120:121],v4,0
T a[122:123],v4,1024
M v[64:67],a[32:35],a[160:163],v[64:67]
R a[168:171],v5,38912
R a[172:175],v6,38912
M v[64:67],a[36:39],a[164:167],v[64:67]
buffer_load_dwordx4 v10, s[16:19], s21 offen offset:2048  nt lds
M v[68:71],a[44:47],a[164:167],v[68:71]
M v[68:71],a[40:43],a[160:163],v[68:71]
M v[72:75],a[48:51],a[160:163],v[72:75]
s_nop 0
T a[124:125],v4,8192
T a[126:127],v4,9216
M v[72:75],a[52:55],a[164:167],v[72:75]
M v[76:79],a[60:63],a[164:167],v[76:79]
buffer_load_dwordx4 v11, s[16:19], s21 offen offset:3072  nt lds
M v[76:79],a[56:59],a[160:163],v[76:79]
SA s21,s21,524160
M v[80:83],a[64:67],a[160:163],v[80:83]
M v[80:83],a[68:71],a[164:167],v[80:83]
M v[84:87],a[76:79],a[164:167],v[84:87]
M v[84:87],a[72:75],a[160:163],v[84:87]
M v[88:91],a[80:83],a[160:163],v[88:91]
M v[88:91],a[84:87],a[164:167],v[88:91]
s_waitcnt lgkmcnt(2)
M v[92:95],a[92:95],a[164:167],v[92:95]
s_waitcnt vmcnt(26) lgkmcnt(0)
M v[92:95],a[88:91],a[160:163],v[92:95]
s_barrier
M v[124:127],a[88:91],a[168:171],v[124:127]
R a[160:163],v5,49152
R a[164:167],v6,49152
M v[124:127],a[92:95],a[172:175],v[124:127]
M v[120:123],a[84:87],a[172:175],v[120:123]
SA m0,s24,32768
T a[128:129],v1,16384
T a[130:131],v1,17408
M v[120:123],a[80:83],a[168:171],v[120:123]
s_waitcnt vmcnt(8)
buffer_load_dwordx4 v12, s[48:51], s22 offen offset:0   lds
M v[116:119],a[72:75],a[168:171],v[116:119]
s_nop 0
T a[176:177],v22,0
T a[178:179],v22,128
M v[116:119],a[76:79],a[172:175],v[116:119]
T a[180:181],v22,1024
T a[182:183],v22,1152
M v[112:115],a[68:71],a[172:175],v[112:115]
T a[184:185],v22,2048
T a[186:187],v22,2176
M v[112:115],a[64:67],a[168:171],v[112:115]
T a[188:189],v22,3072
T a[190:191],v22,3200
M v[108:111],a[56:59],a[168:171],v[108:111]
M v[108:111],a[60:63],a[172:175],v[108:111]
s_nop 0
T a[132:133],v1,24576
T a[134:135],v1,25600
M v[104:107],a[52:55],a[172:175],v[104:107]
buffer_load_dwordx4 v13, s[48:51], s22 offen offset:1024   lds
M v[104:107],a[48:51],a[168:171],v[104:107]
M v[100:103],a[40:43],a[168:171],v[100:103]
M v[100:103],a[44:47],a[172:175],v[100:103]
s_waitcnt lgkmcnt(12)
M v[96:99],a[36:39],a[172:175],v[96:99]
M v[96:99],a[32:35],a[168:171],v[96:99]
M v[128:131],a[32:35],a[160:163],v[128:131]
R a[168:171],v5,51200
R a[172:175],v6,51200
M v[128:131],a[36:39],a[164:167],v[128:131]
T a[136:137],v2,16384
T a[138:139],v2,17408
M v[132:135],a[44:47],a[164:167],v[132:135]
buffer_load_dwordx4 v14, s[48:51], s22 offen offset:2048   lds
M v[132:135],a[40:43],a[160:163],v[132:135]
M v[136:139],a[48:51],a[160:163],v[136:139]
M v[136:139],a[52:55],a[164:167],v[136:139]
M v[140:143],a[60:63],a[164:167],v[140:143]
M v[140:143],a[56:59],a[160:163],v[140:143]
s_nop 0
T a[140:141],v2,24576
T a[142:143],v2,25600
M v[144:147],a[64:67],a[160:163],v[144:147]
buffer_load_dwordx4 v15, s[48:51], s22 offen offset:3072   lds
M v[144:147],a[68:71],a[164:167],v[144:147]
SA s22,s22,1048576
M v[148:151],a[76:79],a[164:167],v[148:151]
M v[148:151],a[72:75],a[160:163],v[148:151]
M v[152:155],a[80:83],a[160:163],v[152:155]
M v[152:155],a[84:87],a[164:167],v[152:155]
s_waitcnt lgkmcnt(4)
M v[156:159],a[92:95],a[164:167],v[156:159]
SA m0,s23,0
T a[144:145],v3,16384
T a[146:147],v3,17408
M v[156:159],a[88:91],a[160:163],v[156:159]
buffer_load_dwordx4 v8, s[16:19], s21 offen offset:0  nt lds
M v[16:19],a[176:179],a[208:211],0
M v[16:19],a[180:183],a[212:215],v[16:19]
M v[16:19],a[184:187],a[216:219],v[16:19]
M v[16:19],a[188:191],a[220:223],v[16:19]
M v[188:191],a[88:91],a[168:171],v[188:191]
R a[160:163],v5,53248
R a[164:167],v6,53248
M v[188:191],a[92:95],a[172:175],v[188:191]
T a[176:177],v22,4096
T a[178:179],v22,4224
M v[184:187],a[84:87],a[172:175],v[184:187]
T a[180:181],v22,5120
T a[182:183],v22,5248
M v[184:187],a[80:83],a[168:171],v[184:187]
T a[184:185],v22,6144
T a[186:187],v22,6272
M v[180:183],a[72:75],a[168:171],v[180:183]
M v[180:183],a[76:79],a[172:175],v[180:183]
s_nop 0
T a[148:149],v3,24576
T a[150:151],v3,25600
M v[176:179],a[68:71],a[172:175],v[176:179]
buffer_load_dwordx4 v9, s[16:19], s21 offen offset:1024  nt lds
M v[176:179],a[64:67],a[168:171],v[176:179]
M v[172:175],a[56:59],a[168:171],v[172:175]
M v[172:175],a[60:63],a[172:175],v[172:175]
M v[168:171],a[52:55],a[172:175],v[168:171]
M v[168:171],a[48:51],a[168:171],v[168:171]
M v[164:167],a[40:43],a[168:171],v[164:167]
s_nop 0
T a[152:153],v4,16384
T a[154:155],v4,17408
M v[164:167],a[44:47],a[172:175],v[164:167]
s_waitcnt lgkmcnt(10)
buffer_load_dwordx4 v10, s[16:19], s21 offen offset:2048  nt lds
M v[160:163],a[36:39],a[172:175],v[160:163]
M v[160:163],a[32:35],a[168:171],v[160:163]
M v[192:195],a[32:35],a[160:163],v[192:195]
R a[168:171],v5,55296
R a[172:175],v6,55296
M v[192:195],a[36:39],a[164:167],v[192:195]
M v[196:199],a[44:47],a[164:167],v[196:199]
M v[196:199],a[40:43],a[160:163],v[196:199]
s_nop 0
T a[156:157],v4,24576
T a[158:159],v4,25600
M v[200:203],a[48:51],a[160:163],v[200:203]
buffer_load_dwordx4 v11, s[16:19], s21 offen offset:3072  nt lds
M v[200:203],a[52:55],a[164:167],v[200:203]
SA s21,s21,128
M v[204:207],a[60:63],a[164:167],v[204:207]
M v[204:207],a[56:59],a[160:163],v[204:207]
M v[208:211],a[64:67],a[160:163],v[208:211]
M v[208:211],a[68:71],a[164:167],v[208:211]
M v[212:215],a[76:79],a[164:167],v[212:215]
M v[212:215],a[72:75],a[160:163],v[212:215]
M v[216:219],a[80:83],a[160:163],v[216:219]
M v[216:219],a[84:87],a[164:167],v[216:219]
s_waitcnt lgkmcnt(2)
M v[220:223],a[92:95],a[164:167],v[220:223]
s_waitcnt lgkmcnt(0)
M v[220:223],a[88:91],a[160:163],v[220:223]
s_barrier
M v[16:19],a[176:179],a[224:227],v[16:19]
M v[16:19],a[180:183],a[228:231],v[16:19]
M v[16:19],a[184:187],a[232:235],v[16:19]
M v[252:255],a[88:91],a[168:171],v[252:255]
R a[160:163],v5,0
R a[164:167],v6,0
M v[252:255],a[92:95],a[172:175],v[252:255]
M v[248:251],a[84:87],a[172:175],v[248:251]
M v[248:251],a[80:83],a[168:171],v[248:251]
M v[244:247],a[72:75],a[168:171],v[244:247]
M v[244:247],a[76:79],a[172:175],v[244:247]
M v[240:243],a[68:71],a[172:175],v[240:243]
M v[240:243],a[64:67],a[168:171],v[240:243]
M v[236:239],a[56:59],a[168:171],v[236:239]
M v[236:239],a[60:63],a[172:175],v[236:239]
M v[232:235],a[52:55],a[172:175],v[232:235]
M v[232:235],a[48:51],a[168:171],v[232:235]
M v[228:231],a[40:43],a[168:171],v[228:231]
M v[228:231],a[44:47],a[172:175],v[228:231]
s_waitcnt lgkmcnt(0)
M v[224:227],a[36:39],a[172:175],v[224:227]
M v[224:227],a[32:35],a[168:171],v[224:227]
M a[0:3],a[96:99],a[160:163],a[0:3]
R a[168:171],v5,2048
R a[172:175],v6,2048
M a[0:3],a[100:103],a[164:167],a[0:3]
T a[32:33],v1,32768
T a[34:35],v1,33792
M a[4:7],a[108:111],a[164:167],a[4:7]
SA m0,s24,49152
M a[4:7],a[104:107],a[160:163],a[4:7]
buffer_load_dwordx4 v12, s[48:51], s22 offen offset:0   lds
M a[8:11],a[112:115],a[160:163],a[8:11]
M a[8:11],a[116:119],a[164:167],a[8:11]
s_lshl_b32 s64, s20, 10
M a[12:15],a[124:127],a[164:167],a[12:15]
SA s64,s64,159744
T a[36:37],v1,40960
T a[38:39],v1,41984
M a[12:15],a[120:123],a[160:163],a[12:15]
v_add_u32 v21, s64, v7
ds_write_b128 v21, v[16:19]
M a[16:19],a[128:131],a[160:163],a[16:19]
s_mul_i32 s67, s86, 14336
buffer_load_dwordx4 v13, s[48:51], s22 offen offset:1024   lds
M a[16:19],a[132:135],a[164:167],a[16:19]
s_mul_i32 s64, s20, 224
M a[20:23],a[140:143],a[164:167],a[20:23]
SA s67,s67,s64
v_lshrrev_b32 v28, 4, v0
v_mul_u32_u24 v28, 896, v28
M a[20:23],a[136:139],a[160:163],a[20:23]
T a[40:41],v2,32768
T a[42:43],v2,33792
M a[24:27],a[144:147],a[160:163],a[24:27]
v_and_b32 v29, 15, v0
v_lshl_add_u32 v28, v29, 4, v28
M a[24:27],a[148:151],a[164:167],a[24:27]
s_waitcnt lgkmcnt(7)
buffer_load_dwordx4 v14, s[48:51], s22 offen offset:2048   lds
M a[28:31],a[156:159],a[164:167],a[28:31]
v_mov_b32 v30, 536870912
v_cmp_gt_u32 vcc, 14, v29
M a[28:31],a[152:155],a[160:163],a[28:31]
s_nop 0
M v[60:63],a[152:155],a[168:171],v[60:63]
s_nop 0
R a[160:163],v5,4096
R a[164:167],v6,4096
M v[60:63],a[156:159],a[172:175],v[60:63]
T a[44:45],v2,40960
T a[46:47],v2,41984
M v[56:59],a[148:151],a[172:175],v[56:59]
buffer_load_dwordx4 v15, s[48:51], s22 offen offset:3072   lds
M v[56:59],a[144:147],a[168:171],v[56:59]
s_sub_u32 s22, s22, 1048448
v_cndmask_b32 v28, v30, v28, vcc
v_add_u32 v29, 2560, v28
M v[52:55],a[136:139],a[168:171],v[52:55]
v_add_u32 v30, 5120, v28
v_add_u32 v31, 7680, v28
M v[52:55],a[140:143],a[172:175],v[52:55]
T a[48:49],v3,32768
T a[50:51],v3,33792
M v[48:51],a[132:135],a[172:175],v[48:51]
SA m0,s23,16384
M v[48:51],a[128:131],a[168:171],v[48:51]
buffer_load_dwordx4 v8, s[16:19], s21 offen offset:0  nt lds
M v[44:47],a[120:123],a[168:171],v[44:47]
M v[44:47],a[124:127],a[172:175],v[44:47]
M v[40:43],a[116:119],a[172:175],v[40:43]
s_nop 0
T a[52:53],v3,40960
T a[54:55],v3,41984
M v[40:43],a[112:115],a[168:171],v[40:43]
M v[36:39],a[104:107],a[168:171],v[36:39]
buffer_load_dwordx4 v9, s[16:19], s21 offen offset:1024  nt lds
M v[36:39],a[108:111],a[172:175],v[36:39]
s_waitcnt lgkmcnt(6)
M v[32:35],a[100:103],a[172:175],v[32:35]
M v[32:35],a[96:99],a[168:171],v[32:35]
s_nop 0
T a[56:57],v4,32768
T a[58:59],v4,33792
M v[64:67],a[96:99],a[160:163],v[64:67]
R a[168:171],v5,6144
R a[172:175],v6,6144
M v[64:67],a[100:103],a[164:167],v[64:67]
buffer_load_dwordx4 v10, s[16:19], s21 offen offset:2048  nt lds
M v[68:71],a[108:111],a[164:167],v[68:71]
M v[68:71],a[104:107],a[160:163],v[68:71]
M v[72:75],a[112:115],a[160:163],v[72:75]
s_nop 0
T a[60:61],v4,40960
T a[62:63],v4,41984
M v[72:75],a[116:119],a[164:167],v[72:75]
M v[76:79],a[124:127],a[164:167],v[76:79]
buffer_load_dwordx4 v11, s[16:19], s21 offen offset:3072  nt lds
M v[76:79],a[120:123],a[160:163],v[76:79]
SA s21,s21,524160
M v[80:83],a[128:131],a[160:163],v[80:83]
M v[80:83],a[132:135],a[164:167],v[80:83]
M v[84:87],a[140:143],a[164:167],v[84:87]
M v[84:87],a[136:139],a[160:163],v[84:87]
M v[88:91],a[144:147],a[160:163],v[88:91]
M v[88:91],a[148:151],a[164:167],v[88:91]
s_waitcnt lgkmcnt(2)
M v[92:95],a[156:159],a[164:167],v[92:95]
s_waitcnt vmcnt(16) lgkmcnt(0)
M v[92:95],a[152:155],a[160:163],v[92:95]
s_barrier
M v[124:127],a[152:155],a[168:171],v[124:127]
R a[160:163],v5,16384
R a[164:167],v6,16384
M v[124:127],a[156:159],a[172:175],v[124:127]
M v[120:123],a[148:151],a[172:175],v[120:123]
SA m0,s24,0
T a[64:65],v1,49152
T a[66:67],v1,50176
M v[120:123],a[144:147],a[168:171],v[120:123]
buffer_load_dwordx4 v12, s[48:51], s22 offen offset:0   lds
M v[116:119],a[136:139],a[168:171],v[116:119]
M v[116:119],a[140:143],a[172:175],v[116:119]
M v[112:115],a[132:135],a[172:175],v[112:115]
M v[112:115],a[128:131],a[168:171],v[112:115]
buffer_load_dwordx4 v13, s[48:51], s22 offen offset:1024   lds
M v[108:111],a[120:123],a[168:171],v[108:111]
M v[108:111],a[124:127],a[172:175],v[108:111]
s_nop 0
T a[68:69],v1,57344
T a[70:71],v1,58368
M v[104:107],a[116:119],a[172:175],v[104:107]
M v[104:107],a[112:115],a[168:171],v[104:107]
M v[100:103],a[104:107],a[168:171],v[100:103]
buffer_load_dwordx4 v14, s[48:51], s22 offen offset:2048   lds
M v[100:103],a[108:111],a[172:175],v[100:103]
s_waitcnt lgkmcnt(4)
M v[96:99],a[100:103],a[172:175],v[96:99]
M v[96:99],a[96:99],a[168:171],v[96:99]
M v[128:131],a[96:99],a[160:163],v[128:131]
R a[168:171],v5,18432
R a[172:175],v6,18432
M v[128:131],a[100:103],a[164:167],v[128:131]
T a[72:73],v2,49152
T a[74:75],v2,50176
M v[132:135],a[108:111],a[164:167],v[132:135]
buffer_load_dwordx4 v15, s[48:51], s22 offen offset:3072   lds
M v[132:135],a[104:107],a[160:163],v[132:135]
SA s22,s22,1048576
M v[136:139],a[112:115],a[160:163],v[136:139]
M v[136:139],a[116:119],a[164:167],v[136:139]
SA m0,s23,32768
M v[140:143],a[124:127],a[164:167],v[140:143]
buffer_load_dwordx4 v8, s[16:19], s21 offen offset:0  nt lds
M v[140:143],a[120:123],a[160:163],v[140:143]
s_nop 0
T a[76:77],v2,57344
T a[78:79],v2,58368
M v[144:147],a[128:131],a[160:163],v[144:147]
M v[144:147],a[132:135],a[164:167],v[144:147]
M v[148:151],a[140:143],a[164:167],v[148:151]
buffer_load_dwordx4 v9, s[16:19], s21 offen offset:1024  nt lds
M v[148:151],a[136:139],a[160:163],v[148:151]
M v[152:155],a[144:147],a[160:163],v[152:155]
M v[152:155],a[148:151],a[164:167],v[152:155]
s_waitcnt lgkmcnt(4)
M v[156:159],a[156:159],a[164:167],v[156:159]
s_nop 0
T a[80:81],v3,49152
T a[82:83],v3,50176
M v[156:159],a[152:155],a[160:163],v[156:159]
buffer_load_dwordx4 v10, s[16:19], s21 offen offset:2048  nt lds
M v[188:191],a[152:155],a[168:171],v[188:191]
R a[160:163],v5,20480
R a[164:167],v6,20480
M v[188:191],a[156:159],a[172:175],v[188:191]
M v[184:187],a[148:151],a[172:175],v[184:187]
M v[184:187],a[144:147],a[168:171],v[184:187]
M v[180:183],a[136:139],a[168:171],v[180:183]
buffer_load_dwordx4 v11, s[16:19], s21 offen offset:3072  nt lds
M v[180:183],a[140:143],a[172:175],v[180:183]
SA s21,s21,128
T a[84:85],v3,57344
T a[86:87],v3,58368
M v[176:179],a[132:135],a[172:175],v[176:179]
M v[176:179],a[128:131],a[168:171],v[176:179]
M v[172:175],a[120:123],a[168:171],v[172:175]
SA m0,s87,0
M v[172:175],a[124:127],a[172:175],v[172:175]
buffer_load_dwordx4 v28, s[68:71], s67 offen offset:0 nt lds
M v[168:171],a[116:119],a[172:175],v[168:171]
M v[168:171],a[112:115],a[168:171],v[168:171]
M v[164:167],a[104:107],a[168:171],v[164:167]
s_nop 0
T a[88:89],v4,49152
T a[90:91],v4,50176
M v[164:167],a[108:111],a[172:175],v[164:167]
s_waitcnt lgkmcnt(4)
buffer_load_dwordx4 v29, s[68:71], s67 offen offset:1024 nt lds
M v[160:163],a[100:103],a[172:175],v[160:163]
M v[160:163],a[96:99],a[168:171],v[160:163]
M v[192:195],a[96:99],a[160:163],v[192:195]
R a[168:171],v5,22528
R a[172:175],v6,22528
M v[192:195],a[100:103],a[164:167],v[192:195]
M v[196:199],a[108:111],a[164:167],v[196:199]
buffer_load_dwordx4 v30, s[68:71], s67 offen offset:2048 nt lds
M v[196:199],a[104:107],a[160:163],v[196:199]
s_nop 0
T a[92:93],v4,57344
T a[94:95],v4,58368
M v[200:203],a[112:115],a[160:163],v[200:203]
M v[200:203],a[116:119],a[164:167],v[200:203]
M v[204:207],a[124:127],a[164:167],v[204:207]
M v[204:207],a[120:123],a[160:163],v[204:207]
buffer_load_dwordx4 v31, s[68:71], s67 offen offset:3072 nt lds
M v[208:211],a[128:131],a[160:163],v[208:211]
SA s67,s67,0
M v[208:211],a[132:135],a[164:167],v[208:211]
L_w_kv05:
s_cbranch_execz L_wd1
M v[212:215],a[140:143],a[164:167],v[212:215]
M v[212:215],a[136:139],a[160:163],v[212:215]
M v[216:219],a[144:147],a[160:163],v[216:219]
M v[216:219],a[148:151],a[164:167],v[216:219]
s_waitcnt lgkmcnt(2)
M v[220:223],a[156:159],a[164:167],v[220:223]
s_waitcnt vmcnt(20) lgkmcnt(0)
M v[220:223],a[152:155],a[160:163],v[220:223]
s_barrier
M v[252:255],a[152:155],a[168:171],v[252:255]
R a[160:163],v5,32768
R a[164:167],v6,32768
M v[252:255],a[156:159],a[172:175],v[252:255]
M v[248:251],a[148:151],a[172:175],v[248:251]
M v[248:251],a[144:147],a[168:171],v[248:251]
M v[244:247],a[136:139],a[168:171],v[244:247]
M v[244:247],a[140:143],a[172:175],v[244:247]
M v[240:243],a[132:135],a[172:175],v[240:243]
M v[240:243],a[128:131],a[168:171],v[240:243]
M v[236:239],a[120:123],a[168:171],v[236:239]
M v[236:239],a[124:127],a[172:175],v[236:239]
M v[232:235],a[116:119],a[172:175],v[232:235]
M v[232:235],a[112:115],a[168:171],v[232:235]
M v[228:231],a[104:107],a[168:171],v[228:231]
M v[228:231],a[108:111],a[172:175],v[228:231]
s_waitcnt lgkmcnt(0)
M v[224:227],a[100:103],a[172:175],v[224:227]
M v[224:227],a[96:99],a[168:171],v[224:227]
M a[0:3],a[32:35],a[160:163],a[0:3]
R a[168:171],v5,34816
R a[172:175],v6,34816
M a[0:3],a[36:39],a[164:167],a[0:3]
T a[96:97],v1,0
T a[98:99],v1,1024
M a[4:7],a[44:47],a[164:167],a[4:7]
SA m0,s24,16384
C v23,v23,v23
M a[4:7],a[40:43],a[160:163],a[4:7]
buffer_load_dwordx4 v12, s[48:51], s22 offen offset:0   lds
M a[8:11],a[48:51],a[160:163],a[8:11]
v_and_b32 v23, 0xffff0000, v23
M a[8:11],a[52:55],a[164:167],a[8:11]
MF v22,0xbfb8aa3b,v23
M a[12:15],a[60:63],a[164:167],a[12:15]
s_nop 0
T a[100:101],v1,8192
T a[102:103],v1,9216
M a[12:15],a[56:59],a[160:163],a[12:15]
E v22,v22
M a[16:19],a[64:67],a[160:163],a[16:19]
buffer_load_dwordx4 v13, s[48:51], s22 offen offset:1024   lds
M a[16:19],a[68:71],a[164:167],a[16:19]
AF v22,1.0,v22
M a[20:23],a[76:79],a[164:167],a[20:23]
v_rcp_f32 v23, v22
M a[20:23],a[72:75],a[160:163],a[20:23]
s_or_b32 s64, s31, s20
T a[104:105],v2,0
T a[106:107],v2,1024
M a[24:27],a[80:83],a[160:163],a[24:27]
s_min_u32 s64, s64, 1
s_lshl_b32 s64, s64, 29
v_lshrrev_b32 v22, 1, v0
M a[24:27],a[84:87],a[164:167],a[24:27]
s_waitcnt lgkmcnt(6)
buffer_load_dwordx4 v14, s[48:51], s22 offen offset:2048   lds
M a[28:31],a[92:95],a[164:167],a[28:31]
v_min_u32 v22, 1, v22
M a[28:31],a[88:91],a[160:163],a[28:31]
v_lshlrev_b32 v22, 29, v22
M v[60:63],a[88:91],a[168:171],v[60:63]
R a[160:163],v5,36864
R a[164:167],v6,36864
M v[60:63],a[92:95],a[172:175],v[60:63]
T a[108:109],v2,8192
T a[110:111],v2,9216
M v[56:59],a[84:87],a[172:175],v[56:59]
buffer_load_dwordx4 v15, s[48:51], s22 offen offset:3072   lds
M v[56:59],a[80:83],a[168:171],v[56:59]
s_sub_u32 s22, s22, 1048448
v_lshl_or_b32 v22, v0, 2, v22
M v[52:55],a[72:75],a[168:171],v[52:55]
v_or_b32 v22, s64, v22
M v[52:55],a[76:79],a[172:175],v[52:55]
s_nop 0
T a[112:113],v3,0
T a[114:115],v3,1024
M v[48:51],a[68:71],a[172:175],v[48:51]
SA m0,s23,49152
C v23,v23,v23
M v[48:51],a[64:67],a[168:171],v[48:51]
buffer_load_dwordx4 v8, s[16:19], s21 offen offset:0  nt lds
M v[44:47],a[56:59],a[168:171],v[44:47]
v_and_b32 v23, 0xffff0000, v23
M v[44:47],a[60:63],a[172:175],v[44:47]
s_lshl_b32 s64, s41, 7
M v[40:43],a[52:55],a[172:175],v[40:43]
SA s64,s64,104890368
T a[116:117],v3,8192
T a[118:119],v3,9216
M v[40:43],a[48:51],a[168:171],v[40:43]
buffer_store_dword v24, v22, s[8:11], s64 offen sc1
M v[36:39],a[40:43],a[168:171],v[36:39]
buffer_load_dwordx4 v9, s[16:19], s21 offen offset:1024  nt lds
M v[36:39],a[44:47],a[172:175],v[36:39]
s_waitcnt lgkmcnt(6)
buffer_store_dword v23, v22, s[8:11], s64 offen offset:8 sc1
M v[32:35],a[36:39],a[172:175],v[32:35]
v_add_u32 v25, 159744, v7
M v[32:35],a[32:35],a[168:171],v[32:35]
s_nop 0
T a[120:121],v4,0
T a[122:123],v4,1024
M v[64:67],a[32:35],a[160:163],v[64:67]
R a[168:171],v5,38912
R a[172:175],v6,38912
M v[64:67],a[36:39],a[164:167],v[64:67]
buffer_load_dwordx4 v10, s[16:19], s21 offen offset:2048  nt lds
M v[68:71],a[44:47],a[164:167],v[68:71]
ds_read_b128 v[16:19], v25
M v[68:71],a[40:43],a[160:163],v[68:71]
R v[28:31],v25,1024
M v[72:75],a[48:51],a[160:163],v[72:75]
s_nop 0
T a[124:125],v4,8192
T a[126:127],v4,9216
M v[72:75],a[52:55],a[164:167],v[72:75]
R v[20:23],v25,2048
M v[76:79],a[60:63],a[164:167],v[76:79]
buffer_load_dwordx4 v11, s[16:19], s21 offen offset:3072  nt lds
M v[76:79],a[56:59],a[160:163],v[76:79]
SA s21,s21,524160
M v[80:83],a[64:67],a[160:163],v[80:83]
M v[80:83],a[68:71],a[164:167],v[80:83]
M v[84:87],a[76:79],a[164:167],v[84:87]
M v[84:87],a[72:75],a[160:163],v[84:87]
M v[88:91],a[80:83],a[160:163],v[88:91]
M v[88:91],a[84:87],a[164:167],v[88:91]
s_waitcnt lgkmcnt(5)
s_waitcnt lgkmcnt(3)
AF v16,v28,v16
M v[92:95],a[92:95],a[164:167],v[92:95]
s_waitcnt vmcnt(22) lgkmcnt(0)
AF v17,v29,v17
M v[92:95],a[88:91],a[160:163],v[92:95]
s_barrier
M v[124:127],a[88:91],a[168:171],v[124:127]
R a[160:163],v5,49152
R a[164:167],v6,49152
M v[124:127],a[92:95],a[172:175],v[124:127]
AF v18,v30,v18
M v[120:123],a[84:87],a[172:175],v[120:123]
SA m0,s24,32768
T a[128:129],v1,16384
T a[130:131],v1,17408
M v[120:123],a[80:83],a[168:171],v[120:123]
buffer_load_dwordx4 v12, s[48:51], s22 offen offset:0   lds
M v[116:119],a[72:75],a[168:171],v[116:119]
AF v19,v31,v19
M v[116:119],a[76:79],a[172:175],v[116:119]
R v[28:31],v25,3072
M v[112:115],a[68:71],a[172:175],v[112:115]
C v25,v16,v17
M v[112:115],a[64:67],a[168:171],v[112:115]
v_lshlrev_b32 v16, 16, v25
M v[108:111],a[56:59],a[168:171],v[108:111]
v_and_b32 v17, 0xffff0000, v25
M v[108:111],a[60:63],a[172:175],v[108:111]
s_nop 0
T a[132:133],v1,24576
T a[134:135],v1,25600
M v[104:107],a[52:55],a[172:175],v[104:107]
buffer_load_dwordx4 v13, s[48:51], s22 offen offset:1024   lds
M v[104:107],a[48:51],a[168:171],v[104:107]
C v25,v18,v19
M v[100:103],a[40:43],a[168:171],v[100:103]
v_lshlrev_b32 v18, 16, v25
M v[100:103],a[44:47],a[172:175],v[100:103]
s_waitcnt lgkmcnt(5)
v_and_b32 v19, 0xffff0000, v25
M v[96:99],a[36:39],a[172:175],v[96:99]
s_waitcnt lgkmcnt(2)
AF v20,v28,v20
M v[96:99],a[32:35],a[168:171],v[96:99]
AF v21,v29,v21
M v[128:131],a[32:35],a[160:163],v[128:131]
R a[168:171],v5,51200
R a[172:175],v6,51200
M v[128:131],a[36:39],a[164:167],v[128:131]
T a[136:137],v2,16384
T a[138:139],v2,17408
M v[132:135],a[44:47],a[164:167],v[132:135]
buffer_load_dwordx4 v14, s[48:51], s22 offen offset:2048   lds
M v[132:135],a[40:43],a[160:163],v[132:135]
AF v22,v30,v22
M v[136:139],a[48:51],a[160:163],v[136:139]
AF v23,v31,v23
M v[136:139],a[52:55],a[164:167],v[136:139]
MF v28,0xbfb8aa3b,v16
M v[140:143],a[60:63],a[164:167],v[140:143]
MF v29,0xbfb8aa3b,v17
M v[140:143],a[56:59],a[160:163],v[140:143]
s_nop 0
T a[140:141],v2,24576
T a[142:143],v2,25600
M v[144:147],a[64:67],a[160:163],v[144:147]
buffer_load_dwordx4 v15, s[48:51], s22 offen offset:3072   lds
M v[144:147],a[68:71],a[164:167],v[144:147]
SA s22,s22,1048576
MF v30,0xbfb8aa3b,v18
M v[148:151],a[76:79],a[164:167],v[148:151]
MF v31,0xbfb8aa3b,v19
M v[148:151],a[72:75],a[160:163],v[148:151]
E v28,v28
M v[152:155],a[80:83],a[160:163],v[152:155]
E v29,v29
M v[152:155],a[84:87],a[164:167],v[152:155]
s_waitcnt lgkmcnt(4)
E v30,v30
M v[156:159],a[92:95],a[164:167],v[156:159]
SA m0,s23,0
T a[144:145],v3,16384
T a[146:147],v3,17408
M v[156:159],a[88:91],a[160:163],v[156:159]
buffer_load_dwordx4 v8, s[16:19], s21 offen offset:0  nt lds
M v[188:191],a[88:91],a[168:171],v[188:191]
R a[160:163],v5,53248
R a[164:167],v6,53248
M v[188:191],a[92:95],a[172:175],v[188:191]
E v31,v31
M v[184:187],a[84:87],a[172:175],v[184:187]
C v25,v20,v21
M v[184:187],a[80:83],a[168:171],v[184:187]
v_lshlrev_b32 v20, 16, v25
M v[180:183],a[72:75],a[168:171],v[180:183]
v_and_b32 v21, 0xffff0000, v25
M v[180:183],a[76:79],a[172:175],v[180:183]
s_nop 0
T a[148:149],v3,24576
T a[150:151],v3,25600
M v[176:179],a[68:71],a[172:175],v[176:179]
buffer_load_dwordx4 v9, s[16:19], s21 offen offset:1024  nt lds
M v[176:179],a[64:67],a[168:171],v[176:179]
C v25,v22,v23
M v[172:175],a[56:59],a[168:171],v[172:175]
v_lshlrev_b32 v22, 16, v25
M v[172:175],a[60:63],a[172:175],v[172:175]
v_and_b32 v23, 0xffff0000, v25
M v[168:171],a[52:55],a[172:175],v[168:171]
AF v28,1.0,v28
M v[168:171],a[48:51],a[168:171],v[168:171]
AF v29,1.0,v29
M v[164:167],a[40:43],a[168:171],v[164:167]
s_nop 0
T a[152:153],v4,16384
T a[154:155],v4,17408
M v[164:167],a[44:47],a[172:175],v[164:167]
s_waitcnt lgkmcnt(4)
buffer_load_dwordx4 v10, s[16:19], s21 offen offset:2048  nt lds
M v[160:163],a[36:39],a[172:175],v[160:163]
AF v30,1.0,v30
M v[160:163],a[32:35],a[168:171],v[160:163]
AF v31,1.0,v31
M v[192:195],a[32:35],a[160:163],v[192:195]
R a[168:171],v5,55296
R a[172:175],v6,55296
M v[192:195],a[36:39],a[164:167],v[192:195]
v_rcp_f32 v28, v28
M v[196:199],a[44:47],a[164:167],v[196:199]
v_rcp_f32 v29, v29
M v[196:199],a[40:43],a[160:163],v[196:199]
T a[156:157],v4,24576
T a[158:159],v4,25600
M v[200:203],a[48:51],a[160:163],v[200:203]
buffer_load_dwordx4 v11, s[16:19], s21 offen offset:3072  nt lds
M v[200:203],a[52:55],a[164:167],v[200:203]
SA s21,s21,128
v_rcp_f32 v30, v30
M v[204:207],a[60:63],a[164:167],v[204:207]
v_rcp_f32 v31, v31
M v[204:207],a[56:59],a[160:163],v[204:207]
MF v16,v28,v16
M v[208:211],a[64:67],a[160:163],v[208:211]
MF v17,v29,v17
M v[208:211],a[68:71],a[164:167],v[208:211]
MF v18,v30,v18
M v[212:215],a[76:79],a[164:167],v[212:215]
MF v19,v31,v19
M v[212:215],a[72:75],a[160:163],v[212:215]
C v25,v16,v17
M v[216:219],a[80:83],a[160:163],v[216:219]
v_lshlrev_b32 v16, 16, v25
M v[216:219],a[84:87],a[164:167],v[216:219]
s_waitcnt lgkmcnt(2)
v_and_b32 v17, 0xffff0000, v25
M v[220:223],a[92:95],a[164:167],v[220:223]
s_waitcnt vmcnt(22) lgkmcnt(0)
C v25,v18,v19
M v[220:223],a[88:91],a[160:163],v[220:223]
s_barrier
M v[252:255],a[88:91],a[168:171],v[252:255]
R a[160:163],v5,0
R a[164:167],v6,0
M v[252:255],a[92:95],a[172:175],v[252:255]
v_lshlrev_b32 v18, 16, v25
M v[248:251],a[84:87],a[172:175],v[248:251]
v_and_b32 v19, 0xffff0000, v25
M v[248:251],a[80:83],a[168:171],v[248:251]
MF v16,v20,v16
M v[244:247],a[72:75],a[168:171],v[244:247]
MF v17,v21,v17
M v[244:247],a[76:79],a[172:175],v[244:247]
MF v18,v22,v18
M v[240:243],a[68:71],a[172:175],v[240:243]
MF v19,v23,v19
M v[240:243],a[64:67],a[168:171],v[240:243]
C v16,v16,v17
M v[236:239],a[56:59],a[168:171],v[236:239]
C v17,v18,v19
M v[236:239],a[60:63],a[172:175],v[236:239]
M v[232:235],a[52:55],a[172:175],v[232:235]
M v[232:235],a[48:51],a[168:171],v[232:235]
M v[228:231],a[40:43],a[168:171],v[228:231]
M v[228:231],a[44:47],a[172:175],v[228:231]
s_waitcnt lgkmcnt(0)
M v[224:227],a[36:39],a[172:175],v[224:227]
M v[224:227],a[32:35],a[168:171],v[224:227]
M a[0:3],a[96:99],a[160:163],a[0:3]
R a[168:171],v5,2048
R a[172:175],v6,2048
M a[0:3],a[100:103],a[164:167],a[0:3]
T a[32:33],v1,32768
T a[34:35],v1,33792
M a[4:7],a[108:111],a[164:167],a[4:7]
SA m0,s24,49152
v_lshrrev_b32 v28, 4, v0
v_and_b32 v29, 7, v0
M a[4:7],a[104:107],a[160:163],a[4:7]
buffer_load_dwordx4 v12, s[48:51], s22 offen offset:0   lds
M a[8:11],a[112:115],a[160:163],a[8:11]
v_xor_b32 v28, v28, v29
v_lshlrev_b32 v28, 4, v28
M a[8:11],a[116:119],a[164:167],a[8:11]
v_lshrrev_b32 v29, 3, v0
v_mul_u32_u24 v29, 896, v29
M a[12:15],a[124:127],a[164:167],a[12:15]
T a[36:37],v1,40960
T a[38:39],v1,41984
M a[12:15],a[120:123],a[160:163],a[12:15]
v_add_u32 v22, v28, v29
v_xor_b32 v28, 64, v28
M a[16:19],a[128:131],a[160:163],a[16:19]
s_mul_i32 s64, s20, 14336
buffer_load_dwordx4 v13, s[48:51], s22 offen offset:1024   lds
M a[16:19],a[132:135],a[164:167],a[16:19]
s_sub_u32 s65, 98304, s64
M a[20:23],a[140:143],a[164:167],a[20:23]
SA s30,s29,s65
M a[20:23],a[136:139],a[160:163],a[20:23]
SA s29,s29,s64
T a[40:41],v2,32768
T a[42:43],v2,33792
M a[24:27],a[144:147],a[160:163],a[24:27]
v_add_u32 v29, 6144, v29
v_add_u32 v23, v28, v29
M a[24:27],a[148:151],a[164:167],a[24:27]
s_waitcnt lgkmcnt(6)
buffer_load_dwordx4 v14, s[48:51], s22 offen offset:2048   lds
M a[28:31],a[156:159],a[164:167],a[28:31]
s_and_b32 s64, s20, 1
M a[28:31],a[152:155],a[160:163],a[28:31]
s_lshl_b32 s64, s64, 12
M v[60:63],a[152:155],a[168:171],v[60:63]
SA s64,s64,65536
R a[160:163],v5,4096
R a[164:167],v6,4096
M v[60:63],a[156:159],a[172:175],v[60:63]
T a[44:45],v2,40960
T a[46:47],v2,41984
M v[56:59],a[148:151],a[172:175],v[56:59]
buffer_load_dwordx4 v15, s[48:51], s22 offen offset:3072   lds
M v[56:59],a[144:147],a[168:171],v[56:59]
s_sub_u32 s22, s22, 1048448
v_add_u32 v20, s64, v5
v_add_u32 v21, s64, v6
M v[52:55],a[136:139],a[168:171],v[52:55]
v_lshrrev_b32 v28, 2, v0
v_lshlrev_b32 v28, 8, v28
M v[52:55],a[140:143],a[172:175],v[52:55]
T a[48:49],v3,32768
T a[50:51],v3,33792
M v[48:51],a[132:135],a[172:175],v[48:51]
SA m0,s23,16384
v_and_b32 v29, 3, v0
v_lshl_add_u32 v28, v29, 3, v28
M v[48:51],a[128:131],a[168:171],v[48:51]
buffer_load_dwordx4 v8, s[16:19], s21 offen offset:0  nt lds
M v[44:47],a[120:123],a[168:171],v[44:47]
v_add_u32 v28, s87, v28
M v[44:47],a[124:127],a[172:175],v[44:47]
s_waitcnt vmcnt(23)
s_nop 0
T a[176:177],v28,0
T a[178:179],v28,32
M v[40:43],a[116:119],a[172:175],v[40:43]
T a[52:53],v3,40960
T a[54:55],v3,41984
M v[40:43],a[112:115],a[168:171],v[40:43]
T a[180:181],v28,64
T a[182:183],v28,96
M v[36:39],a[104:107],a[168:171],v[36:39]
buffer_load_dwordx4 v9, s[16:19], s21 offen offset:1024  nt lds
M v[36:39],a[108:111],a[172:175],v[36:39]
s_waitcnt lgkmcnt(10)
s_nop 0
T a[184:185],v28,128
T a[186:187],v28,160
M v[32:35],a[100:103],a[172:175],v[32:35]
T a[188:189],v28,192
M v[32:35],a[96:99],a[168:171],v[32:35]
s_nop 0
T a[56:57],v4,32768
T a[58:59],v4,33792
M v[64:67],a[96:99],a[160:163],v[64:67]
R a[168:171],v5,6144
R a[172:175],v6,6144
M v[64:67],a[100:103],a[164:167],v[64:67]
buffer_load_dwordx4 v10, s[16:19], s21 offen offset:2048  nt lds
s_waitcnt lgkmcnt(12)
v_mfma_f32_16x16x16_bf16 a[192:195], a[176:177], v[16:17], 0
M v[68:71],a[108:111],a[164:167],v[68:71]
v_mov_b32 v18, v16 row_shr:2 row_mask:0xf bank_mask:0xf bound_ctrl:0
v_mov_b32 v19, v17 row_shr:2 row_mask:0xf bank_mask:0xf bound_ctrl:0
M v[68:71],a[104:107],a[160:163],v[68:71]
M v[72:75],a[112:115],a[160:163],v[72:75]
s_nop 0
T a[60:61],v4,40960
T a[62:63],v4,41984
M v[72:75],a[116:119],a[164:167],v[72:75]
s_waitcnt lgkmcnt(13)
v_mfma_f32_16x16x16_bf16 a[192:195], a[178:179], v[18:19], a[192:195]
M v[76:79],a[124:127],a[164:167],v[76:79]
buffer_load_dwordx4 v11, s[16:19], s21 offen offset:3072  nt lds
M v[76:79],a[120:123],a[160:163],v[76:79]
SA s21,s21,524160
v_mov_b32 v16, v18 row_shr:2 row_mask:0xf bank_mask:0xf bound_ctrl:0
v_mov_b32 v17, v19 row_shr:2 row_mask:0xf bank_mask:0xf bound_ctrl:0
M v[80:83],a[128:131],a[160:163],v[80:83]
M v[80:83],a[132:135],a[164:167],v[80:83]
s_waitcnt lgkmcnt(10)
v_mfma_f32_16x16x16_bf16 a[192:195], a[180:181], v[16:17], a[192:195]
M v[84:87],a[140:143],a[164:167],v[84:87]
v_mov_b32 v18, v16 row_shr:2 row_mask:0xf bank_mask:0xf bound_ctrl:0
v_mov_b32 v19, v17 row_shr:2 row_mask:0xf bank_mask:0xf bound_ctrl:0
M v[84:87],a[136:139],a[160:163],v[84:87]
M v[88:91],a[144:147],a[160:163],v[88:91]
M v[88:91],a[148:151],a[164:167],v[88:91]
s_waitcnt lgkmcnt(2)
v_mfma_f32_16x16x16_bf16 a[192:195], a[182:183], v[18:19], a[192:195]
M v[92:95],a[156:159],a[164:167],v[92:95]
s_waitcnt vmcnt(16) lgkmcnt(0)
v_mov_b32 v16, v18 row_shr:2 row_mask:0xf bank_mask:0xf bound_ctrl:0
v_mov_b32 v17, v19 row_shr:2 row_mask:0xf bank_mask:0xf bound_ctrl:0
M v[92:95],a[152:155],a[160:163],v[92:95]
s_barrier
M v[124:127],a[152:155],a[168:171],v[124:127]
R a[160:163],v5,16384
R a[164:167],v6,16384
M v[124:127],a[156:159],a[172:175],v[124:127]
SA m0,s23,131072
v_mfma_f32_16x16x16_bf16 a[192:195], a[184:185], v[16:17], a[192:195]
M v[120:123],a[148:151],a[172:175],v[120:123]
s_nop 0
T a[64:65],v1,49152
T a[66:67],v1,50176
M v[120:123],a[144:147],a[168:171],v[120:123]
v_mov_b32 v18, v16 row_shr:2 row_mask:0xf bank_mask:0xf bound_ctrl:0
v_mov_b32 v19, v17 row_shr:2 row_mask:0xf bank_mask:0xf bound_ctrl:0
M v[116:119],a[136:139],a[168:171],v[116:119]
buffer_load_dwordx4 v22, s[56:59], s29 offen offset:0 lds
M v[116:119],a[140:143],a[172:175],v[116:119]
v_mfma_f32_16x16x16_bf16 a[192:195], a[186:187], v[18:19], a[192:195]
M v[112:115],a[132:135],a[172:175],v[112:115]
v_mov_b32 v16, v18 row_shr:2 row_mask:0xf bank_mask:0xf bound_ctrl:0
v_mov_b32 v17, v19 row_shr:2 row_mask:0xf bank_mask:0xf bound_ctrl:0
M v[112:115],a[128:131],a[168:171],v[112:115]
buffer_load_dwordx4 v23, s[56:59], s29 offen offset:1024 lds
M v[108:111],a[120:123],a[168:171],v[108:111]
M v[108:111],a[124:127],a[172:175],v[108:111]
s_nop 0
T a[68:69],v1,57344
T a[70:71],v1,58368
v_mfma_f32_16x16x16_bf16 a[192:195], a[188:189], v[16:17], a[192:195]
M v[104:107],a[116:119],a[172:175],v[104:107]
buffer_load_dwordx4 v22, s[56:59], s30 offen offset:2048 lds
M v[104:107],a[112:115],a[168:171],v[104:107]
v_and_b32 v29, 1, v0
v_mul_u32_u24 v30, 1792, v29
M v[100:103],a[104:107],a[168:171],v[100:103]
v_lshrrev_b32 v31, 4, v0
v_lshl_add_u32 v30, v31, 4, v30
M v[100:103],a[108:111],a[172:175],v[100:103]
s_waitcnt lgkmcnt(4)
v_bfe_u32 v29, v0, 1, 3
v_lshl_add_u32 v30, v29, 6, v30
M v[96:99],a[100:103],a[172:175],v[96:99]
v_add_u32 v29, 1, v29
v_lshrrev_b32 v29, 3, v29
M v[96:99],a[96:99],a[168:171],v[96:99]
v_lshl_or_b32 v30, v29, 29, v30
v_or_b32 v30, s88, v30
M v[128:131],a[96:99],a[160:163],v[128:131]
s_mul_i32 s89, s86, 3584
R a[168:171],v5,18432
R a[172:175],v6,18432
M v[128:131],a[100:103],a[164:167],v[128:131]
s_mul_i32 s64, s20, 448
T a[72:73],v2,49152
T a[74:75],v2,50176
M v[132:135],a[108:111],a[164:167],v[132:135]
SA s89,s89,s64
M v[132:135],a[104:107],a[160:163],v[132:135]
SA s89,s89,105906176
buffer_store_dwordx4 a[192:195], v30, s[8:11], s89 offen sc1
M v[136:139],a[112:115],a[160:163],v[136:139]
M v[136:139],a[116:119],a[164:167],v[136:139]
M v[140:143],a[124:127],a[164:167],v[140:143]
buffer_load_dwordx4 v23, s[56:59], s30 offen offset:3072 lds
M v[140:143],a[120:123],a[160:163],v[140:143]
SA s29,s29,128
T a[76:77],v2,57344
T a[78:79],v2,58368
M v[144:147],a[128:131],a[160:163],v[144:147]
SA s30,s30,128
M v[144:147],a[132:135],a[164:167],v[144:147]
SA m0,s24,0
M v[148:151],a[140:143],a[164:167],v[148:151]
buffer_load_dwordx4 v12, s[48:51], s22 offen offset:0   lds
M v[148:151],a[136:139],a[160:163],v[148:151]
M v[152:155],a[144:147],a[160:163],v[152:155]
M v[152:155],a[148:151],a[164:167],v[152:155]
s_waitcnt lgkmcnt(4)
buffer_load_dwordx4 v13, s[48:51], s22 offen offset:1024   lds
M v[156:159],a[156:159],a[164:167],v[156:159]
s_nop 0
T a[80:81],v3,49152
T a[82:83],v3,50176
M v[156:159],a[152:155],a[160:163],v[156:159]
M v[188:191],a[152:155],a[168:171],v[188:191]
R a[160:163],v5,20480
R a[164:167],v6,20480
M v[188:191],a[156:159],a[172:175],v[188:191]
buffer_load_dwordx4 v14, s[48:51], s22 offen offset:2048   lds
M v[184:187],a[148:151],a[172:175],v[184:187]
M v[184:187],a[144:147],a[168:171],v[184:187]
M v[180:183],a[136:139],a[168:171],v[180:183]
buffer_load_dwordx4 v15, s[48:51], s22 offen offset:3072   lds
M v[180:183],a[140:143],a[172:175],v[180:183]
SA s22,s22,1048576
T a[84:85],v3,57344
T a[86:87],v3,58368
M v[176:179],a[132:135],a[172:175],v[176:179]
SA m0,s23,32768
M v[176:179],a[128:131],a[168:171],v[176:179]
buffer_load_dwordx4 v8, s[16:19], s21 offen offset:0  nt lds
M v[172:175],a[120:123],a[168:171],v[172:175]
M v[172:175],a[124:127],a[172:175],v[172:175]
M v[168:171],a[116:119],a[172:175],v[168:171]
M v[168:171],a[112:115],a[168:171],v[168:171]
L_w_kv06:
s_cbranch_execz L_wd1
buffer_load_dwordx4 v9, s[16:19], s21 offen offset:1024  nt lds
M v[164:167],a[104:107],a[168:171],v[164:167]
s_nop 0
T a[88:89],v4,49152
T a[90:91],v4,50176
M v[164:167],a[108:111],a[172:175],v[164:167]
s_waitcnt lgkmcnt(4)
M v[160:163],a[100:103],a[172:175],v[160:163]
M v[160:163],a[96:99],a[168:171],v[160:163]
M v[192:195],a[96:99],a[160:163],v[192:195]
R a[168:171],v5,22528
R a[172:175],v6,22528
M v[192:195],a[100:103],a[164:167],v[192:195]
buffer_load_dwordx4 v10, s[16:19], s21 offen offset:2048  nt lds
M v[196:199],a[108:111],a[164:167],v[196:199]
M v[196:199],a[104:107],a[160:163],v[196:199]
s_nop 0
T a[92:93],v4,57344
T a[94:95],v4,58368
M v[200:203],a[112:115],a[160:163],v[200:203]
M v[200:203],a[116:119],a[164:167],v[200:203]
buffer_load_dwordx4 v11, s[16:19], s21 offen offset:3072  nt lds
M v[204:207],a[124:127],a[164:167],v[204:207]
M v[204:207],a[120:123],a[160:163],v[204:207]
M v[208:211],a[128:131],a[160:163],v[208:211]
M v[208:211],a[132:135],a[164:167],v[208:211]
M v[212:215],a[140:143],a[164:167],v[212:215]
SA s21,s21,128
M v[212:215],a[136:139],a[160:163],v[212:215]
M v[216:219],a[144:147],a[160:163],v[216:219]
M v[216:219],a[148:151],a[164:167],v[216:219]
s_waitcnt lgkmcnt(2)
M v[220:223],a[156:159],a[164:167],v[220:223]
s_waitcnt vmcnt(21) lgkmcnt(0)
M v[220:223],a[152:155],a[160:163],v[220:223]
s_barrier
M v[252:255],a[152:155],a[168:171],v[252:255]
R a[160:163],v5,32768
R a[164:167],v6,32768
M v[252:255],a[156:159],a[172:175],v[252:255]
M v[248:251],a[148:151],a[172:175],v[248:251]
M v[248:251],a[144:147],a[168:171],v[248:251]
M v[244:247],a[136:139],a[168:171],v[244:247]
M v[244:247],a[140:143],a[172:175],v[244:247]
M v[240:243],a[132:135],a[172:175],v[240:243]
M v[240:243],a[128:131],a[168:171],v[240:243]
M v[236:239],a[120:123],a[168:171],v[236:239]
M v[236:239],a[124:127],a[172:175],v[236:239]
M v[232:235],a[116:119],a[172:175],v[232:235]
M v[232:235],a[112:115],a[168:171],v[232:235]
M v[228:231],a[104:107],a[168:171],v[228:231]
M v[228:231],a[108:111],a[172:175],v[228:231]
s_waitcnt lgkmcnt(0)
M v[224:227],a[100:103],a[172:175],v[224:227]
M v[224:227],a[96:99],a[168:171],v[224:227]
M a[0:3],a[32:35],a[160:163],a[0:3]
R a[168:171],v5,34816
R a[172:175],v6,34816
M a[0:3],a[36:39],a[164:167],a[0:3]
SA m0,s23,147456
T a[96:97],v1,0
T a[98:99],v1,1024
M a[4:7],a[44:47],a[164:167],a[4:7]
buffer_load_dwordx4 v22, s[56:59], s29 offen offset:0 lds
M a[4:7],a[40:43],a[160:163],a[4:7]
M a[8:11],a[48:51],a[160:163],a[8:11]
M a[8:11],a[52:55],a[164:167],a[8:11]
buffer_load_dwordx4 v23, s[56:59], s29 offen offset:1024 lds
M a[12:15],a[60:63],a[164:167],a[12:15]
s_nop 0
T a[100:101],v1,8192
T a[102:103],v1,9216
M a[12:15],a[56:59],a[160:163],a[12:15]
M a[16:19],a[64:67],a[160:163],a[16:19]
buffer_load_dwordx4 v22, s[56:59], s30 offen offset:2048 lds
M a[16:19],a[68:71],a[164:167],a[16:19]
M a[20:23],a[76:79],a[164:167],a[20:23]
M a[20:23],a[72:75],a[160:163],a[20:23]
s_nop 0
T a[104:105],v2,0
T a[106:107],v2,1024
M a[24:27],a[80:83],a[160:163],a[24:27]
buffer_load_dwordx4 v23, s[56:59], s30 offen offset:3072 lds
M a[24:27],a[84:87],a[164:167],a[24:27]
s_waitcnt lgkmcnt(6)
M a[28:31],a[92:95],a[164:167],a[28:31]
SA s29,s29,128
M a[28:31],a[88:91],a[160:163],a[28:31]
SA s30,s30,128
M v[60:63],a[88:91],a[168:171],v[60:63]
SA m0,s24,16384
R a[160:163],v5,36864
R a[164:167],v6,36864
M v[60:63],a[92:95],a[172:175],v[60:63]
T a[108:109],v2,8192
T a[110:111],v2,9216
M v[56:59],a[84:87],a[172:175],v[56:59]
buffer_load_dwordx4 v12, s[48:51], s22 offen offset:0   lds
M v[56:59],a[80:83],a[168:171],v[56:59]
M v[52:55],a[72:75],a[168:171],v[52:55]
M v[52:55],a[76:79],a[172:175],v[52:55]
s_nop 0
T a[112:113],v3,0
T a[114:115],v3,1024
M v[48:51],a[68:71],a[172:175],v[48:51]
buffer_load_dwordx4 v13, s[48:51], s22 offen offset:1024   lds
M v[48:51],a[64:67],a[168:171],v[48:51]
M v[44:47],a[56:59],a[168:171],v[44:47]
M v[44:47],a[60:63],a[172:175],v[44:47]
buffer_load_dwordx4 v14, s[48:51], s22 offen offset:2048   lds
M v[40:43],a[52:55],a[172:175],v[40:43]
s_nop 0
T a[116:117],v3,8192
T a[118:119],v3,9216
M v[40:43],a[48:51],a[168:171],v[40:43]
M v[36:39],a[40:43],a[168:171],v[36:39]
buffer_load_dwordx4 v15, s[48:51], s22 offen offset:3072   lds
M v[36:39],a[44:47],a[172:175],v[36:39]
s_waitcnt lgkmcnt(6)
M v[32:35],a[36:39],a[172:175],v[32:35]
s_sub_u32 s22, s22, 1048448
M v[32:35],a[32:35],a[168:171],v[32:35]
SA m0,s23,49152
T a[120:121],v4,0
T a[122:123],v4,1024
M v[64:67],a[32:35],a[160:163],v[64:67]
R a[168:171],v5,38912
R a[172:175],v6,38912
M v[64:67],a[36:39],a[164:167],v[64:67]
buffer_load_dwordx4 v8, s[16:19], s21 offen offset:0  nt lds
M v[68:71],a[44:47],a[164:167],v[68:71]
M v[68:71],a[40:43],a[160:163],v[68:71]
M v[72:75],a[48:51],a[160:163],v[72:75]
s_waitcnt vmcnt(17)
s_nop 0
T a[124:125],v4,8192
T a[126:127],v4,9216
M v[72:75],a[52:55],a[164:167],v[72:75]
buffer_load_dwordx4 v9, s[16:19], s21 offen offset:1024  nt lds
M v[76:79],a[60:63],a[164:167],v[76:79]
R a[176:179],v20,0
R a[180:183],v20,2048
M v[76:79],a[56:59],a[160:163],v[76:79]
R a[184:187],v21,0
R a[188:191],v21,2048
M v[80:83],a[64:67],a[160:163],v[80:83]
buffer_load_dwordx4 v10, s[16:19], s21 offen offset:2048  nt lds
M v[80:83],a[68:71],a[164:167],v[80:83]
M v[84:87],a[76:79],a[164:167],v[84:87]
M v[84:87],a[72:75],a[160:163],v[84:87]
buffer_load_dwordx4 v11, s[16:19], s21 offen offset:3072  nt lds
M v[88:91],a[80:83],a[160:163],v[88:91]
SA s21,s21,524160
M v[88:91],a[84:87],a[164:167],v[88:91]
s_waitcnt lgkmcnt(6)
M v[92:95],a[92:95],a[164:167],v[92:95]
s_waitcnt lgkmcnt(0)
M v[92:95],a[88:91],a[160:163],v[92:95]
s_barrier
M v[124:127],a[88:91],a[168:171],v[124:127]
s_lshl_b32 s4, s20, 10
R a[160:163],v5,49152
R a[164:167],v6,49152
M v[124:127],a[92:95],a[172:175],v[124:127]
SA m0,s23,131072
v_bfe_u32 v28, v0, 3, 2
M v[120:123],a[84:87],a[172:175],v[120:123]
s_nop 0
T a[128:129],v1,16384
T a[130:131],v1,17408
M v[120:123],a[80:83],a[168:171],v[120:123]
buffer_load_dwordx4 v22, s[56:59], s29 offen offset:0 lds
M v[116:119],a[72:75],a[168:171],v[116:119]
v_lshrrev_b32 v29, 5, v0
v_lshl_add_u32 v28, v29, 3, v28
M v[116:119],a[76:79],a[172:175],v[116:119]
M v[112:115],a[68:71],a[172:175],v[112:115]
v_lshlrev_b32 v28, 13, v28
M v[112:115],a[64:67],a[168:171],v[112:115]
M v[108:111],a[56:59],a[168:171],v[108:111]
buffer_load_dwordx4 v23, s[56:59], s29 offen offset:1024 lds
M v[108:111],a[60:63],a[172:175],v[108:111]
s_nop 0
T a[132:133],v1,24576
T a[134:135],v1,25600
M v[104:107],a[52:55],a[172:175],v[104:107]
v_lshrrev_b32 v29, 4, v0
v_lshlrev_b32 v29, 1, v29
M v[104:107],a[48:51],a[168:171],v[104:107]
M v[100:103],a[40:43],a[168:171],v[100:103]
v_and_b32 v30, 7, v0
M v[100:103],a[44:47],a[172:175],v[100:103]
s_waitcnt lgkmcnt(4)
M v[96:99],a[36:39],a[172:175],v[96:99]
v_xor_b32 v29, v29, v30
M v[96:99],a[32:35],a[168:171],v[96:99]
buffer_load_dwordx4 v22, s[56:59], s30 offen offset:2048 lds
M v[128:131],a[32:35],a[160:163],v[128:131]
R a[168:171],v5,51200
R a[172:175],v6,51200
M v[128:131],a[36:39],a[164:167],v[128:131]
T a[136:137],v2,16384
T a[138:139],v2,17408
M v[132:135],a[44:47],a[164:167],v[132:135]
v_lshl_add_u32 v28, v29, 4, v28
M v[132:135],a[40:43],a[160:163],v[132:135]
s_and_b32 s64, s20, 1
M v[136:139],a[48:51],a[160:163],v[136:139]
s_lshl_b32 s64, s64, 17
M v[136:139],a[52:55],a[164:167],v[136:139]
s_lshr_b32 s65, s20, 1
M v[140:143],a[60:63],a[164:167],v[140:143]
s_lshl_b32 s65, s65, 15
SA s64,s64,s65
v_add_u32 v8, s64, v28
M v[140:143],a[56:59],a[160:163],v[140:143]
s_nop 0
T a[140:141],v2,24576
T a[142:143],v2,25600
M v[144:147],a[64:67],a[160:163],v[144:147]
buffer_load_dwordx4 v23, s[56:59], s30 offen offset:3072 lds
M v[144:147],a[68:71],a[164:167],v[144:147]
M v[148:151],a[76:79],a[164:167],v[148:151]
SA s29,s29,128
M v[148:151],a[72:75],a[160:163],v[148:151]
SA s30,s30,128
M v[152:155],a[80:83],a[160:163],v[152:155]
SA m0,s24,32768
M v[152:155],a[84:87],a[164:167],v[152:155]
s_waitcnt lgkmcnt(4)
buffer_load_dwordx4 v12, s[48:51], s22 offen offset:0   lds
M v[156:159],a[92:95],a[164:167],v[156:159]
s_nop 0
T a[144:145],v3,16384
T a[146:147],v3,17408
M v[156:159],a[88:91],a[160:163],v[156:159]
M v[188:191],a[88:91],a[168:171],v[188:191]
R a[160:163],v5,53248
R a[164:167],v6,53248
M v[188:191],a[92:95],a[172:175],v[188:191]
M v[184:187],a[84:87],a[172:175],v[184:187]
M v[184:187],a[80:83],a[168:171],v[184:187]
M v[180:183],a[72:75],a[168:171],v[180:183]
buffer_load_dwordx4 v13, s[48:51], s22 offen offset:1024   lds
M v[180:183],a[76:79],a[172:175],v[180:183]
s_nop 0
T a[148:149],v3,24576
T a[150:151],v3,25600
M v[176:179],a[68:71],a[172:175],v[176:179]
M v[176:179],a[64:67],a[168:171],v[176:179]
M v[172:175],a[56:59],a[168:171],v[172:175]
M v[172:175],a[60:63],a[172:175],v[172:175]
M v[168:171],a[52:55],a[172:175],v[168:171]
M v[168:171],a[48:51],a[168:171],v[168:171]
buffer_load_dwordx4 v14, s[48:51], s22 offen offset:2048   lds
M v[164:167],a[40:43],a[168:171],v[164:167]
s_nop 0
T a[152:153],v4,16384
T a[154:155],v4,17408
M v[164:167],a[44:47],a[172:175],v[164:167]
s_waitcnt lgkmcnt(4)
M v[160:163],a[36:39],a[172:175],v[160:163]
M v[160:163],a[32:35],a[168:171],v[160:163]
M v[192:195],a[32:35],a[160:163],v[192:195]
R a[168:171],v5,55296
R a[172:175],v6,55296
M v[192:195],a[36:39],a[164:167],v[192:195]
M v[196:199],a[44:47],a[164:167],v[196:199]
buffer_load_dwordx4 v15, s[48:51], s22 offen offset:3072   lds
M v[196:199],a[40:43],a[160:163],v[196:199]
s_nop 0
T a[156:157],v4,24576
T a[158:159],v4,25600
M v[200:203],a[48:51],a[160:163],v[200:203]
s_waitcnt vmcnt(16)
R a[192:195],v20,16384
R a[196:199],v20,18432
M v[200:203],a[52:55],a[164:167],v[200:203]
R a[200:203],v21,16384
R a[204:207],v21,18432
M v[204:207],a[60:63],a[164:167],v[204:207]
M v[204:207],a[56:59],a[160:163],v[204:207]
M v[208:211],a[64:67],a[160:163],v[208:211]
M v[208:211],a[68:71],a[164:167],v[208:211]
M v[212:215],a[76:79],a[164:167],v[212:215]
SA s22,s22,1048576
M v[212:215],a[72:75],a[160:163],v[212:215]
M v[216:219],a[80:83],a[160:163],v[216:219]
M v[216:219],a[84:87],a[164:167],v[216:219]
s_waitcnt lgkmcnt(6)
M v[220:223],a[92:95],a[164:167],v[220:223]
s_waitcnt lgkmcnt(0)
M v[220:223],a[88:91],a[160:163],v[220:223]
s_barrier
M v[252:255],a[88:91],a[168:171],v[252:255]
R a[160:163],v5,0
R a[164:167],v6,0
M v[252:255],a[92:95],a[172:175],v[252:255]
M v[248:251],a[84:87],a[172:175],v[248:251]
M v[248:251],a[80:83],a[168:171],v[248:251]
M v[244:247],a[72:75],a[168:171],v[244:247]
M v[244:247],a[76:79],a[172:175],v[244:247]
M v[240:243],a[68:71],a[172:175],v[240:243]
M v[240:243],a[64:67],a[168:171],v[240:243]
M v[236:239],a[56:59],a[168:171],v[236:239]
M v[236:239],a[60:63],a[172:175],v[236:239]
M v[232:235],a[52:55],a[172:175],v[232:235]
M v[232:235],a[48:51],a[168:171],v[232:235]
M v[228:231],a[40:43],a[168:171],v[228:231]
M v[228:231],a[44:47],a[172:175],v[228:231]
s_waitcnt lgkmcnt(0)
M v[224:227],a[36:39],a[172:175],v[224:227]
M v[224:227],a[32:35],a[168:171],v[224:227]
M a[0:3],a[96:99],a[160:163],a[0:3]
R a[168:171],v5,2048
R a[172:175],v6,2048
M a[0:3],a[100:103],a[164:167],a[0:3]
SA m0,s23,147456
T a[32:33],v1,32768
T a[34:35],v1,33792
M a[4:7],a[108:111],a[164:167],a[4:7]
buffer_load_dwordx4 v22, s[56:59], s29 offen offset:0 lds
M a[4:7],a[104:107],a[160:163],a[4:7]
M a[8:11],a[112:115],a[160:163],a[8:11]
M a[8:11],a[116:119],a[164:167],a[8:11]
buffer_load_dwordx4 v23, s[56:59], s29 offen offset:1024 lds
M a[12:15],a[124:127],a[164:167],a[12:15]
s_nop 0
T a[36:37],v1,40960
T a[38:39],v1,41984
M a[12:15],a[120:123],a[160:163],a[12:15]
M a[16:19],a[128:131],a[160:163],a[16:19]
buffer_load_dwordx4 v22, s[56:59], s30 offen offset:2048 lds
M a[16:19],a[132:135],a[164:167],a[16:19]
M a[20:23],a[140:143],a[164:167],a[20:23]
M a[20:23],a[136:139],a[160:163],a[20:23]
s_nop 0
T a[40:41],v2,32768
T a[42:43],v2,33792
M a[24:27],a[144:147],a[160:163],a[24:27]
buffer_load_dwordx4 v23, s[56:59], s30 offen offset:3072 lds
M a[24:27],a[148:151],a[164:167],a[24:27]
s_waitcnt lgkmcnt(6)
M a[28:31],a[156:159],a[164:167],a[28:31]
SA s29,s29,128
M a[28:31],a[152:155],a[160:163],a[28:31]
SA s30,s30,128
M v[60:63],a[152:155],a[168:171],v[60:63]
SA m0,s24,49152
R a[160:163],v5,4096
R a[164:167],v6,4096
M v[60:63],a[156:159],a[172:175],v[60:63]
T a[44:45],v2,40960
T a[46:47],v2,41984
M v[56:59],a[148:151],a[172:175],v[56:59]
buffer_load_dwordx4 v12, s[48:51], s22 offen offset:0   lds
M v[56:59],a[144:147],a[168:171],v[56:59]
M v[52:55],a[136:139],a[168:171],v[52:55]
M v[52:55],a[140:143],a[172:175],v[52:55]
s_nop 0
T a[48:49],v3,32768
T a[50:51],v3,33792
M v[48:51],a[132:135],a[172:175],v[48:51]
buffer_load_dwordx4 v13, s[48:51], s22 offen offset:1024   lds
M v[48:51],a[128:131],a[168:171],v[48:51]
M v[44:47],a[120:123],a[168:171],v[44:47]
M v[44:47],a[124:127],a[172:175],v[44:47]
buffer_load_dwordx4 v14, s[48:51], s22 offen offset:2048   lds
M v[40:43],a[116:119],a[172:175],v[40:43]
s_nop 0
T a[52:53],v3,40960
T a[54:55],v3,41984
M v[40:43],a[112:115],a[168:171],v[40:43]
M v[36:39],a[104:107],a[168:171],v[36:39]
buffer_load_dwordx4 v15, s[48:51], s22 offen offset:3072   lds
M v[36:39],a[108:111],a[172:175],v[36:39]
s_waitcnt lgkmcnt(6)
M v[32:35],a[100:103],a[172:175],v[32:35]
s_sub_u32 s22, s22, 1048448
M v[32:35],a[96:99],a[168:171],v[32:35]
s_mov_b32 s25, 0
T a[56:57],v4,32768
T a[58:59],v4,33792
M v[64:67],a[96:99],a[160:163],v[64:67]
SA m0,s4,0
R a[168:171],v5,6144
R a[172:175],v6,6144
M v[64:67],a[100:103],a[164:167],v[64:67]
buffer_load_dwordx4 v8, s[52:55], s25 offen lds
M v[68:71],a[108:111],a[164:167],v[68:71]
s_mov_b32 s25, 262144
M v[68:71],a[104:107],a[160:163],v[68:71]
SA m0,s4,4096
M v[72:75],a[112:115],a[160:163],v[72:75]
s_waitcnt vmcnt(13)
s_nop 0
T a[60:61],v4,40960
T a[62:63],v4,41984
M v[72:75],a[116:119],a[164:167],v[72:75]
buffer_load_dwordx4 v8, s[52:55], s25 offen lds
M v[76:79],a[124:127],a[164:167],v[76:79]
s_mov_b32 s25, 524288
R a[208:211],v20,0
R a[212:215],v20,2048
M v[76:79],a[120:123],a[160:163],v[76:79]
SA m0,s4,8192
R a[216:219],v21,0
R a[220:223],v21,2048
M v[80:83],a[128:131],a[160:163],v[80:83]
buffer_load_dwordx4 v8, s[52:55], s25 offen lds
M v[80:83],a[132:135],a[164:167],v[80:83]
s_mov_b32 s25, 786432
M v[84:87],a[140:143],a[164:167],v[84:87]
SA m0,s4,12288
M v[84:87],a[136:139],a[160:163],v[84:87]
buffer_load_dwordx4 v8, s[52:55], s25 offen lds
M v[88:91],a[144:147],a[160:163],v[88:91]
M v[88:91],a[148:151],a[164:167],v[88:91]
s_waitcnt lgkmcnt(6)
M v[92:95],a[156:159],a[164:167],v[92:95]
s_waitcnt lgkmcnt(0)
M v[92:95],a[152:155],a[160:163],v[92:95]
s_barrier
M v[124:127],a[152:155],a[168:171],v[124:127]
R a[160:163],v5,16384
R a[164:167],v6,16384
M v[124:127],a[156:159],a[172:175],v[124:127]
SA m0,s23,32768
M v[120:123],a[148:151],a[172:175],v[120:123]
s_nop 0
T a[64:65],v1,49152
T a[66:67],v1,50176
M v[120:123],a[144:147],a[168:171],v[120:123]
buffer_load_dwordx4 v22, s[56:59], s29 offen offset:0 lds
M v[116:119],a[136:139],a[168:171],v[116:119]
v_lshrrev_b32 v28, 2, v0
v_lshlrev_b32 v28, 7, v28
M v[116:119],a[140:143],a[172:175],v[116:119]
M v[112:115],a[132:135],a[172:175],v[112:115]
buffer_load_dwordx4 v23, s[56:59], s29 offen offset:1024 lds
M v[112:115],a[128:131],a[168:171],v[112:115]
v_and_b32 v29, 3, v0
M v[108:111],a[120:123],a[168:171],v[108:111]
v_lshl_add_u32 v28, v29, 3, v28
M v[108:111],a[124:127],a[172:175],v[108:111]
s_nop 0
T a[68:69],v1,57344
T a[70:71],v1,58368
M v[104:107],a[116:119],a[172:175],v[104:107]
buffer_load_dwordx4 v22, s[56:59], s30 offen offset:2048 lds
M v[104:107],a[112:115],a[168:171],v[104:107]
v_bfe_u32 v29, v0, 3, 2
M v[100:103],a[104:107],a[168:171],v[100:103]
M v[100:103],a[108:111],a[172:175],v[100:103]
s_waitcnt lgkmcnt(4)
v_lshl_add_u32 v16, v29, 5, v28
M v[96:99],a[100:103],a[172:175],v[96:99]
M v[96:99],a[96:99],a[168:171],v[96:99]
buffer_load_dwordx4 v23, s[56:59], s30 offen offset:3072 lds
M v[128:131],a[96:99],a[160:163],v[128:131]
R a[168:171],v5,18432
R a[172:175],v6,18432
M v[128:131],a[100:103],a[164:167],v[128:131]
SA s29,s29,128
T a[72:73],v2,49152
T a[74:75],v2,50176
M v[132:135],a[108:111],a[164:167],v[132:135]
SA s30,s30,128
v_xor_b32 v17, 32, v16
v_xor_b32 v18, 64, v16
M v[132:135],a[104:107],a[160:163],v[132:135]
SA m0,s23,65536
M v[136:139],a[112:115],a[160:163],v[136:139]
buffer_load_dwordx4 v22, s[56:59], s29 offen offset:0 lds
M v[136:139],a[116:119],a[164:167],v[136:139]
v_xor_b32 v19, 0x60, v16
M v[140:143],a[124:127],a[164:167],v[140:143]
v_add_u32 v12, 0x20000, v16
M v[140:143],a[120:123],a[160:163],v[140:143]
s_nop 0
T a[76:77],v2,57344
T a[78:79],v2,58368
M v[144:147],a[128:131],a[160:163],v[144:147]
buffer_load_dwordx4 v23, s[56:59], s29 offen offset:1024 lds
M v[144:147],a[132:135],a[164:167],v[144:147]
v_add_u32 v13, 0x20000, v17
M v[148:151],a[140:143],a[164:167],v[148:151]
M v[148:151],a[136:139],a[160:163],v[148:151]
v_add_u32 v14, 0x20000, v18
M v[152:155],a[144:147],a[160:163],v[152:155]
M v[152:155],a[148:151],a[164:167],v[152:155]
s_waitcnt lgkmcnt(4)
buffer_load_dwordx4 v22, s[56:59], s30 offen offset:2048 lds
M v[156:159],a[156:159],a[164:167],v[156:159]
s_nop 0
T a[80:81],v3,49152
T a[82:83],v3,50176
M v[156:159],a[152:155],a[160:163],v[156:159]
v_add_u32 v15, 0x20000, v19
M v[188:191],a[152:155],a[168:171],v[188:191]
R a[160:163],v5,20480
R a[164:167],v6,20480
M v[188:191],a[156:159],a[172:175],v[188:191]
M v[184:187],a[148:151],a[172:175],v[184:187]
buffer_load_dwordx4 v23, s[56:59], s30 offen offset:3072 lds
M v[184:187],a[144:147],a[168:171],v[184:187]
SA s29,s29,128
M v[180:183],a[136:139],a[168:171],v[180:183]
SA s30,s30,128
M v[180:183],a[140:143],a[172:175],v[180:183]
s_mov_b32 s25, 1048576
T a[84:85],v3,57344
T a[86:87],v3,58368
M v[176:179],a[132:135],a[172:175],v[176:179]
SA m0,s4,16384
M v[176:179],a[128:131],a[168:171],v[176:179]
buffer_load_dwordx4 v8, s[52:55], s25 offen lds
M v[172:175],a[120:123],a[168:171],v[172:175]
M v[172:175],a[124:127],a[172:175],v[172:175]
s_mov_b32 s25, 1310720
M v[168:171],a[116:119],a[172:175],v[168:171]
SA m0,s4,20480
M v[168:171],a[112:115],a[168:171],v[168:171]
buffer_load_dwordx4 v8, s[52:55], s25 offen lds
M v[164:167],a[104:107],a[168:171],v[164:167]
s_nop 0
T a[88:89],v4,49152
T a[90:91],v4,50176
M v[164:167],a[108:111],a[172:175],v[164:167]
s_waitcnt lgkmcnt(4)
M v[160:163],a[100:103],a[172:175],v[160:163]
s_mov_b32 s25, 1572864
M v[160:163],a[96:99],a[168:171],v[160:163]
SA m0,s4,24576
M v[192:195],a[96:99],a[160:163],v[192:195]
R a[168:171],v5,22528
R a[172:175],v6,22528
M v[192:195],a[100:103],a[164:167],v[192:195]
buffer_load_dwordx4 v8, s[52:55], s25 offen lds
M v[196:199],a[108:111],a[164:167],v[196:199]
M v[196:199],a[104:107],a[160:163],v[196:199]
s_mov_b32 s25, 1835008
T a[92:93],v4,57344
T a[94:95],v4,58368
M v[200:203],a[112:115],a[160:163],v[200:203]
SA m0,s4,28672
M v[200:203],a[116:119],a[164:167],v[200:203]
s_waitcnt vmcnt(19)
L_w_kv07:
s_cbranch_execz L_wd1
buffer_load_dwordx4 v8, s[52:55], s25 offen lds
M v[204:207],a[124:127],a[164:167],v[204:207]
R a[224:227],v20,16384
R a[228:231],v20,18432
M v[204:207],a[120:123],a[160:163],v[204:207]
R a[232:235],v21,16384
R a[236:239],v21,18432
M v[208:211],a[128:131],a[160:163],v[208:211]
v_subrev_u32 v20, 98304, v20
v_subrev_u32 v21, 98304, v21
M v[208:211],a[132:135],a[164:167],v[208:211]
M v[212:215],a[140:143],a[164:167],v[212:215]
M v[212:215],a[136:139],a[160:163],v[212:215]
M v[216:219],a[144:147],a[160:163],v[216:219]
M v[216:219],a[148:151],a[164:167],v[216:219]
s_waitcnt lgkmcnt(6)
M v[220:223],a[156:159],a[164:167],v[220:223]
s_waitcnt lgkmcnt(0)
M v[220:223],a[152:155],a[160:163],v[220:223]
s_barrier
M v[252:255],a[152:155],a[168:171],v[252:255]
R a[160:163],v5,32768
R a[164:167],v6,32768
M v[252:255],a[156:159],a[172:175],v[252:255]
M v[248:251],a[148:151],a[172:175],v[248:251]
M v[248:251],a[144:147],a[168:171],v[248:251]
M v[244:247],a[136:139],a[168:171],v[244:247]
M v[244:247],a[140:143],a[172:175],v[244:247]
M v[240:243],a[132:135],a[172:175],v[240:243]
M v[240:243],a[128:131],a[168:171],v[240:243]
M v[236:239],a[120:123],a[168:171],v[236:239]
M v[236:239],a[124:127],a[172:175],v[236:239]
M v[232:235],a[116:119],a[172:175],v[232:235]
M v[232:235],a[112:115],a[168:171],v[232:235]
M v[228:231],a[104:107],a[168:171],v[228:231]
M v[228:231],a[108:111],a[172:175],v[228:231]
s_waitcnt lgkmcnt(0)
M v[224:227],a[100:103],a[172:175],v[224:227]
M v[224:227],a[96:99],a[168:171],v[224:227]
M a[0:3],a[32:35],a[160:163],a[0:3]
R a[168:171],v5,34816
R a[172:175],v6,34816
M a[0:3],a[36:39],a[164:167],a[0:3]
SA m0,s23,81920
M a[4:7],a[44:47],a[164:167],a[4:7]
buffer_load_dwordx4 v22, s[56:59], s29 offen offset:0 lds
M a[4:7],a[40:43],a[160:163],a[4:7]
M a[8:11],a[48:51],a[160:163],a[8:11]
M a[8:11],a[52:55],a[164:167],a[8:11]
buffer_load_dwordx4 v23, s[56:59], s29 offen offset:1024 lds
M a[12:15],a[60:63],a[164:167],a[12:15]
M a[12:15],a[56:59],a[160:163],a[12:15]
G v24,a0
G v25,a1
M a[16:19],a[64:67],a[160:163],a[16:19]
G v26,a2
G v27,a3
M a[16:19],a[68:71],a[164:167],a[16:19]
buffer_load_dwordx4 v22, s[56:59], s30 offen offset:2048 lds
M a[20:23],a[76:79],a[164:167],a[20:23]
G v28,a4
G v29,a5
M a[20:23],a[72:75],a[160:163],a[20:23]
G v30,a6
G v31,a7
M a[24:27],a[80:83],a[160:163],a[24:27]
C v24,v24,v25
C v25,v26,v27
M a[24:27],a[84:87],a[164:167],a[24:27]
s_waitcnt lgkmcnt(0)
buffer_load_dwordx4 v23, s[56:59], s30 offen offset:3072 lds
M a[28:31],a[92:95],a[164:167],a[28:31]
SA s29,s29,128
C v26,v28,v29
C v27,v30,v31
M a[28:31],a[88:91],a[160:163],a[28:31]
SA s3,s93,0
buffer_store_dwordx4 v[24:27], v7, s[8:11], s3 offen offset:0 sc1
M v[32:35],a[32:35],a[168:171],v[32:35]
SA s30,s30,128
R a[160:163],v5,36864
R a[164:167],v6,36864
M v[32:35],a[36:39],a[172:175],v[32:35]
s_mov_b32 s25, 2097152
G v24,a8
G v25,a9
M v[36:39],a[44:47],a[172:175],v[36:39]
SA m0,s4,131072
G v26,a10
G v27,a11
M v[36:39],a[40:43],a[168:171],v[36:39]
buffer_load_dwordx4 v8, s[52:55], s25 offen lds
M v[40:43],a[48:51],a[168:171],v[40:43]
s_mov_b32 s25, 2359296
G v28,a12
G v29,a13
M v[40:43],a[52:55],a[172:175],v[40:43]
SA m0,s4,135168
G v30,a14
G v31,a15
M v[44:47],a[60:63],a[172:175],v[44:47]
buffer_load_dwordx4 v8, s[52:55], s25 offen lds
M v[44:47],a[56:59],a[168:171],v[44:47]
s_mov_b32 s25, 2621440
C v24,v24,v25
C v25,v26,v27
M v[48:51],a[64:67],a[168:171],v[48:51]
SA m0,s4,139264
C v26,v28,v29
C v27,v30,v31
M v[48:51],a[68:71],a[172:175],v[48:51]
buffer_store_dwordx4 v[24:27], v7, s[8:11], s3 offen offset:1024 sc1
M v[52:55],a[76:79],a[172:175],v[52:55]
s_nop 0
G v24,a16
G v25,a17
M v[52:55],a[72:75],a[168:171],v[52:55]
G v26,a18
G v27,a19
M v[56:59],a[80:83],a[168:171],v[56:59]
buffer_load_dwordx4 v8, s[52:55], s25 offen lds
M v[56:59],a[84:87],a[172:175],v[56:59]
s_waitcnt lgkmcnt(0)
G v28,a20
G v29,a21
M v[60:63],a[92:95],a[172:175],v[60:63]
s_mov_b32 s25, 2883584
G v30,a22
G v31,a23
M v[60:63],a[88:91],a[168:171],v[60:63]
SA m0,s4,143360
C v24,v24,v25
C v25,v26,v27
M v[64:67],a[32:35],a[160:163],v[64:67]
s_waitcnt vmcnt(17)
R a[168:171],v5,38912
R a[172:175],v6,38912
M v[64:67],a[36:39],a[164:167],v[64:67]
buffer_load_dwordx4 v8, s[52:55], s25 offen lds
M v[68:71],a[44:47],a[164:167],v[68:71]
s_mov_b32 s25, 3145728
C v26,v28,v29
C v27,v30,v31
M v[68:71],a[40:43],a[160:163],v[68:71]
SA m0,s4,147456
buffer_store_dwordx4 v[24:27], v7, s[8:11], s3 offen offset:2048 sc1
M v[72:75],a[48:51],a[160:163],v[72:75]
R a[96:99],v20,0
R a[100:103],v20,2048
M v[72:75],a[52:55],a[164:167],v[72:75]
R a[104:107],v21,0
R a[108:111],v21,2048
M v[76:79],a[60:63],a[164:167],v[76:79]
buffer_load_dwordx4 v8, s[52:55], s25 offen lds
M v[76:79],a[56:59],a[160:163],v[76:79]
s_mov_b32 s25, 3407872
G v24,a24
G v25,a25
M v[80:83],a[64:67],a[160:163],v[80:83]
SA m0,s4,151552
G v26,a26
G v27,a27
M v[80:83],a[68:71],a[164:167],v[80:83]
buffer_load_dwordx4 v8, s[52:55], s25 offen lds
M v[84:87],a[76:79],a[164:167],v[84:87]
G v28,a28
G v29,a29
M v[84:87],a[72:75],a[160:163],v[84:87]
G v30,a30
G v31,a31
M v[88:91],a[80:83],a[160:163],v[88:91]
C v24,v24,v25
C v25,v26,v27
M v[88:91],a[84:87],a[164:167],v[88:91]
s_waitcnt lgkmcnt(4)
C v26,v28,v29
C v27,v30,v31
M v[92:95],a[92:95],a[164:167],v[92:95]
s_waitcnt lgkmcnt(0)
buffer_store_dwordx4 v[24:27], v7, s[8:11], s3 offen offset:3072 sc1
M v[92:95],a[88:91],a[160:163],v[92:95]
s_barrier
M v[96:99],a[32:35],a[168:171],v[96:99]
R a[160:163],v5,49152
R a[164:167],v6,49152
M v[96:99],a[36:39],a[172:175],v[96:99]
s_mov_b32 s25, 128
C v64,v64,v65
C v65,v66,v67
M v[100:103],a[44:47],a[172:175],v[100:103]
SA m0,s4,49152
C v66,v68,v69
C v67,v70,v71
M v[100:103],a[40:43],a[168:171],v[100:103]
s_waitcnt vmcnt(18)
buffer_load_dwordx4 v8, s[52:55], s25 offen lds
M v[104:107],a[48:51],a[168:171],v[104:107]
C v72,v72,v73
C v73,v74,v75
M v[104:107],a[52:55],a[172:175],v[104:107]
C v74,v76,v77
C v75,v78,v79
M v[108:111],a[60:63],a[172:175],v[108:111]
C v32,v32,v33
C v33,v34,v35
M v[108:111],a[56:59],a[168:171],v[108:111]
C v34,v36,v37
C v35,v38,v39
M v[112:115],a[64:67],a[168:171],v[112:115]
SA s3,s93,8192
buffer_store_dwordx4 v[32:35], v7, s[8:11], s3 offen offset:0 sc1
M v[112:115],a[68:71],a[172:175],v[112:115]
s_mov_b32 s25, 262272
C v80,v80,v81
C v81,v82,v83
M v[116:119],a[76:79],a[172:175],v[116:119]
SA m0,s4,53248
C v82,v84,v85
C v83,v86,v87
M v[116:119],a[72:75],a[168:171],v[116:119]
R a[112:115],v20,32768
R a[116:119],v20,34816
M v[120:123],a[80:83],a[168:171],v[120:123]
buffer_load_dwordx4 v8, s[52:55], s25 offen lds
M v[120:123],a[84:87],a[172:175],v[120:123]
s_waitcnt lgkmcnt(2)
R a[120:123],v21,32768
R a[124:127],v21,34816
M v[124:127],a[92:95],a[172:175],v[124:127]
C v88,v88,v89
C v89,v90,v91
M v[124:127],a[88:91],a[168:171],v[124:127]
C v90,v92,v93
C v91,v94,v95
M v[128:131],a[32:35],a[160:163],v[128:131]
R a[168:171],v5,51200
R a[172:175],v6,51200
M v[128:131],a[36:39],a[164:167],v[128:131]
C v40,v40,v41
C v41,v42,v43
M v[132:135],a[44:47],a[164:167],v[132:135]
C v42,v44,v45
C v43,v46,v47
M v[132:135],a[40:43],a[160:163],v[132:135]
s_mov_b32 s25, 524416
buffer_store_dwordx4 v[40:43], v7, s[8:11], s3 offen offset:1024 sc1
M v[136:139],a[48:51],a[160:163],v[136:139]
SA m0,s4,57344
C v96,v96,v97
C v97,v98,v99
M v[136:139],a[52:55],a[164:167],v[136:139]
C v98,v100,v101
C v99,v102,v103
M v[140:143],a[60:63],a[164:167],v[140:143]
C v104,v104,v105
C v105,v106,v107
M v[140:143],a[56:59],a[160:163],v[140:143]
buffer_load_dwordx4 v8, s[52:55], s25 offen lds
M v[144:147],a[64:67],a[160:163],v[144:147]
C v106,v108,v109
C v107,v110,v111
M v[144:147],a[68:71],a[164:167],v[144:147]
C v112,v112,v113
C v113,v114,v115
M v[148:151],a[76:79],a[164:167],v[148:151]
C v114,v116,v117
C v115,v118,v119
M v[148:151],a[72:75],a[160:163],v[148:151]
C v48,v48,v49
C v49,v50,v51
M v[152:155],a[80:83],a[160:163],v[152:155]
C v50,v52,v53
C v51,v54,v55
M v[152:155],a[84:87],a[164:167],v[152:155]
s_waitcnt lgkmcnt(0)
buffer_store_dwordx4 v[48:51], v7, s[8:11], s3 offen offset:2048 sc1
M v[156:159],a[92:95],a[164:167],v[156:159]
s_mov_b32 s25, 786560
C v120,v120,v121
C v121,v122,v123
M v[156:159],a[88:91],a[160:163],v[156:159]
SA m0,s4,61440
C v122,v124,v125
C v123,v126,v127
M v[160:163],a[32:35],a[168:171],v[160:163]
R a[160:163],v5,53248
R a[164:167],v6,53248
M v[160:163],a[36:39],a[172:175],v[160:163]
buffer_load_dwordx4 v8, s[52:55], s25 offen lds
M v[164:167],a[44:47],a[172:175],v[164:167]
C v128,v128,v129
C v129,v130,v131
M v[164:167],a[40:43],a[168:171],v[164:167]
C v130,v132,v133
C v131,v134,v135
M v[168:171],a[48:51],a[168:171],v[168:171]
C v56,v56,v57
C v57,v58,v59
M v[168:171],a[52:55],a[172:175],v[168:171]
C v58,v60,v61
C v59,v62,v63
M v[172:175],a[60:63],a[172:175],v[172:175]
buffer_store_dwordx4 v[56:59], v7, s[8:11], s3 offen offset:3072 sc1
M v[172:175],a[56:59],a[168:171],v[172:175]
C v136,v136,v137
C v137,v138,v139
M v[176:179],a[64:67],a[168:171],v[176:179]
C v138,v140,v141
C v139,v142,v143
M v[176:179],a[68:71],a[172:175],v[176:179]
C v144,v144,v145
C v145,v146,v147
M v[180:183],a[76:79],a[172:175],v[180:183]
C v146,v148,v149
C v147,v150,v151
M v[180:183],a[72:75],a[168:171],v[180:183]
C v152,v152,v153
C v153,v154,v155
M v[184:187],a[80:83],a[168:171],v[184:187]
C v154,v156,v157
C v155,v158,v159
M v[184:187],a[84:87],a[172:175],v[184:187]
s_waitcnt lgkmcnt(0)
C v160,v160,v161
C v161,v162,v163
M v[188:191],a[92:95],a[172:175],v[188:191]
C v162,v164,v165
C v163,v166,v167
M v[188:191],a[88:91],a[168:171],v[188:191]
C v168,v168,v169
C v169,v170,v171
M v[192:195],a[32:35],a[160:163],v[192:195]
s_waitcnt vmcnt(18)
R a[168:171],v5,55296
R a[172:175],v6,55296
M v[192:195],a[36:39],a[164:167],v[192:195]
C v170,v172,v173
C v171,v174,v175
M v[196:199],a[44:47],a[164:167],v[196:199]
C v176,v176,v177
C v177,v178,v179
M v[196:199],a[40:43],a[160:163],v[196:199]
C v178,v180,v181
C v179,v182,v183
M v[200:203],a[48:51],a[160:163],v[200:203]
R a[128:131],v20,49152
R a[132:135],v20,51200
M v[200:203],a[52:55],a[164:167],v[200:203]
R a[136:139],v21,49152
R a[140:143],v21,51200
M v[204:207],a[60:63],a[164:167],v[204:207]
C v184,v184,v185
C v185,v186,v187
M v[204:207],a[56:59],a[160:163],v[204:207]
C v186,v188,v189
C v187,v190,v191
M v[208:211],a[64:67],a[160:163],v[208:211]
C v192,v192,v193
C v193,v194,v195
M v[208:211],a[68:71],a[164:167],v[208:211]
C v194,v196,v197
C v195,v198,v199
M v[212:215],a[76:79],a[164:167],v[212:215]
M v[212:215],a[72:75],a[160:163],v[212:215]
C v200,v200,v201
C v201,v202,v203
M v[216:219],a[80:83],a[160:163],v[216:219]
C v202,v204,v205
C v203,v206,v207
M v[216:219],a[84:87],a[164:167],v[216:219]
s_waitcnt lgkmcnt(4)
M v[220:223],a[92:95],a[164:167],v[220:223]
s_waitcnt vmcnt(9) lgkmcnt(0)
M v[220:223],a[88:91],a[160:163],v[220:223]
s_barrier
M v[224:227],a[32:35],a[168:171],v[224:227]
s_nop 0
T v[32:33],v16,0
T v[34:35],v16,2048
M v[224:227],a[36:39],a[172:175],v[224:227]
C v208,v208,v209
C v209,v210,v211
M v[228:231],a[44:47],a[172:175],v[228:231]
T v[36:37],v16,4096
T v[38:39],v16,6144
M v[228:231],a[40:43],a[168:171],v[228:231]
T v[40:41],v16,8192
T v[42:43],v16,10240
M v[232:235],a[48:51],a[168:171],v[232:235]
C v210,v212,v213
C v211,v214,v215
M v[232:235],a[52:55],a[172:175],v[232:235]
T v[44:45],v16,12288
T v[46:47],v16,14336
M v[236:239],a[60:63],a[172:175],v[236:239]
T v[48:49],v16,16384
T v[50:51],v16,18432
M v[236:239],a[56:59],a[168:171],v[236:239]
C v216,v216,v217
C v217,v218,v219
M v[240:243],a[64:67],a[168:171],v[240:243]
T v[52:53],v16,20480
T v[54:55],v16,22528
M v[240:243],a[68:71],a[172:175],v[240:243]
T v[56:57],v16,24576
T v[58:59],v16,26624
M v[244:247],a[76:79],a[172:175],v[244:247]
C v218,v220,v221
C v219,v222,v223
M v[244:247],a[72:75],a[168:171],v[244:247]
C v224,v224,v225
C v225,v226,v227
M v[248:251],a[80:83],a[168:171],v[248:251]
C v226,v228,v229
C v227,v230,v231
M v[248:251],a[84:87],a[172:175],v[248:251]
C v232,v232,v233
C v233,v234,v235
M v[252:255],a[92:95],a[172:175],v[252:255]
C v234,v236,v237
C v235,v238,v239
M v[252:255],a[88:91],a[168:171],v[252:255]
s_waitcnt lgkmcnt(6)
C v240,v240,v241
C v241,v242,v243
M v[68:71],v[32:35],a[176:179],0
s_mul_i32 s72, s41, 4352
T a[144:145],v17,0
T a[146:147],v17,2048
M v[68:71],v[36:39],a[184:187],v[68:71]
s_mov_b32 s25, 1048704
C v242,v244,v245
C v243,v246,v247
M v[68:71],v[40:43],a[192:195],v[68:71]
s_waitcnt lgkmcnt(2)
T a[148:149],v17,4096
T a[150:151],v17,6144
M v[68:71],v[44:47],a[200:203],v[68:71]
SA m0,s4,98304
T a[152:153],v17,8192
T a[154:155],v17,10240
M v[68:71],v[48:51],a[208:211],v[68:71]
SA s46,s72,104923136
buffer_load_dwordx4 v8, s[52:55], s25 offen lds
M v[68:71],v[52:55],a[216:219],v[68:71]
s_lshl_b32 s45, s42, 7
T a[156:157],v17,12288
T a[158:159],v17,14336
M v[68:71],v[56:59],a[224:227],v[68:71]
s_mov_b32 s25, 1310848
T a[160:161],v17,16384
T a[162:163],v17,18432
M v[76:79],v[56:59],a[228:231],0
SA m0,s4,102400
C v248,v248,v249
C v249,v250,v251
M v[76:79],v[52:55],a[220:223],v[76:79]
SA s45,s45,s46
T a[164:165],v17,20480
T a[166:167],v17,22528
M v[76:79],v[48:51],a[212:215],v[76:79]
s_lshl_b32 s72, s20, 2
T a[168:169],v17,24576
T a[170:171],v17,26624
M v[76:79],v[44:47],a[204:207],v[76:79]
SA s72,s72,s45
buffer_load_dwordx4 v8, s[52:55], s25 offen lds
M v[76:79],v[40:43],a[196:199],v[76:79]
C v250,v252,v253
C v251,v254,v255
M v[76:79],v[36:39],a[188:191],v[76:79]
s_mov_b32 s25, 1572992
v_min_u32 v29, 1, v0
v_lshlrev_b32 v29, 29, v29
M v[76:79],v[32:35],a[180:183],v[76:79]
s_waitcnt lgkmcnt(6)
v_mov_b32 v30, 1
M v[84:87],a[144:147],a[176:179],0
SA m0,s4,106496
T v[32:33],v18,0
T v[34:35],v18,2048
M v[84:87],a[148:151],a[184:187],v[84:87]
buffer_load_dwordx4 v8, s[52:55], s25 offen lds
M v[84:87],a[152:155],a[192:195],v[84:87]
s_waitcnt lgkmcnt(2)
s_nop 0
T v[36:37],v18,4096
T v[38:39],v18,6144
M v[84:87],a[156:159],a[200:203],v[84:87]
s_mov_b32 s25, 1835136
T v[40:41],v18,8192
T v[42:43],v18,10240
M v[84:87],a[160:163],a[208:211],v[84:87]
SA m0,s4,110592
M v[84:87],a[164:167],a[216:219],v[84:87]
s_nop 0
T v[44:45],v18,12288
T v[46:47],v18,14336
M v[84:87],a[168:171],a[224:227],v[84:87]
s_waitcnt vmcnt(3)
T v[48:49],v18,16384
T v[50:51],v18,18432
M v[92:95],a[168:171],a[228:231],0
buffer_load_dwordx4 v8, s[52:55], s25 offen lds
M v[92:95],a[164:167],a[220:223],v[92:95]
s_nop 0
T v[52:53],v18,20480
T v[54:55],v18,22528
M v[92:95],a[160:163],a[212:215],v[92:95]
s_mov_b32 s25, 2097280
T v[56:57],v18,24576
T v[58:59],v18,26624
M v[92:95],a[156:159],a[204:207],v[92:95]
SA m0,s4,114688
buffer_store_dword v30, v29, s[8:11], s72 offen offset:4 sc1
M v[92:95],a[152:155],a[196:199],v[92:95]
SA s3,s93,524288
buffer_load_dwordx4 v8, s[52:55], s25 offen lds
M v[92:95],a[148:151],a[188:191],v[92:95]
v_add_u32 v20, 0x10000, v16
v_add_u32 v21, 0x10000, v17
M v[92:95],a[144:147],a[180:183],v[92:95]
s_waitcnt lgkmcnt(6)
buffer_store_dwordx4 v[64:67], v7, s[8:11], s3 offen offset:0 sc1
M v[100:103],v[32:35],a[176:179],0
s_mov_b32 s25, 2359424
T a[144:145],v19,0
T a[146:147],v19,2048
M v[100:103],v[36:39],a[184:187],v[100:103]
SA m0,s4,118784
L_w_kv08:
s_cbranch_execz L_wd1
buffer_store_dwordx4 v[72:75], v7, s[8:11], s3 offen offset:1024 sc1
M v[100:103],v[40:43],a[192:195],v[100:103]
s_waitcnt lgkmcnt(2)
s_nop 0
T a[148:149],v19,4096
T a[150:151],v19,6144
M v[100:103],v[44:47],a[200:203],v[100:103]
T a[152:153],v19,8192
T a[154:155],v19,10240
M v[100:103],v[48:51],a[208:211],v[100:103]
buffer_load_dwordx4 v8, s[52:55], s25 offen lds
M v[100:103],v[52:55],a[216:219],v[100:103]
s_nop 0
T a[156:157],v19,12288
T a[158:159],v19,14336
M v[100:103],v[56:59],a[224:227],v[100:103]
s_mov_b32 s25, 2621568
T a[160:161],v19,16384
T a[162:163],v19,18432
M v[108:111],v[56:59],a[228:231],0
SA m0,s4,122880
buffer_store_dwordx4 v[80:83], v7, s[8:11], s3 offen offset:2048 sc1
M v[108:111],v[52:55],a[220:223],v[108:111]
s_nop 0
T a[164:165],v19,20480
T a[166:167],v19,22528
M v[108:111],v[48:51],a[212:215],v[108:111]
T a[168:169],v19,24576
T a[170:171],v19,26624
M v[108:111],v[44:47],a[204:207],v[108:111]
buffer_load_dwordx4 v8, s[52:55], s25 offen lds
M v[108:111],v[40:43],a[196:199],v[108:111]
v_add_u32 v22, 0x10000, v18
v_add_u32 v23, 0x10000, v19
M v[108:111],v[36:39],a[188:191],v[108:111]
s_mov_b32 s25, 2883712
buffer_store_dwordx4 v[88:91], v7, s[8:11], s3 offen offset:3072 sc1
M v[108:111],v[32:35],a[180:183],v[108:111]
s_waitcnt lgkmcnt(6)
v_or_b32 v1, s20, v0
v_min_u32 v1, 1, v1
M v[116:119],a[144:147],a[176:179],0
SA m0,s4,126976
T v[32:33],v16,28672
T v[34:35],v16,30720
M v[116:119],a[148:151],a[184:187],v[116:119]
buffer_load_dwordx4 v8, s[52:55], s25 offen lds
M v[116:119],a[152:155],a[192:195],v[116:119]
s_waitcnt lgkmcnt(2)
s_nop 0
T v[36:37],v12,0
T v[38:39],v12,2048
M v[116:119],a[156:159],a[200:203],v[116:119]
s_mov_b32 s25, 3145856
T v[40:41],v12,4096
T v[42:43],v12,6144
M v[116:119],a[160:163],a[208:211],v[116:119]
SA m0,s4,32768
v_lshlrev_b32 v1, 29, v1
M v[116:119],a[164:167],a[216:219],v[116:119]
s_nop 0
T v[44:45],v12,8192
T v[46:47],v12,10240
M v[116:119],a[168:171],a[224:227],v[116:119]
T v[48:49],v12,12288
T v[50:51],v12,14336
M v[124:127],a[168:171],a[228:231],0
buffer_load_dwordx4 v8, s[52:55], s25 offen lds
M v[124:127],a[164:167],a[220:223],v[124:127]
s_nop 0
T v[52:53],v12,16384
T v[54:55],v12,18432
M v[124:127],a[160:163],a[212:215],v[124:127]
s_mov_b32 s25, 3408000
T v[56:57],v12,20480
T v[58:59],v12,22528
M v[124:127],a[156:159],a[204:207],v[124:127]
SA m0,s4,36864
v_min_u32 v9, 15, v0
v_lshlrev_b32 v9, 7, v9
M v[124:127],a[152:155],a[196:199],v[124:127]
s_sub_u32 s66, 15, s42
buffer_load_dwordx4 v8, s[52:55], s25 offen lds
M v[124:127],a[148:151],a[188:191],v[124:127]
s_max_u32 s67, s66, s42
M v[124:127],a[144:147],a[180:183],v[124:127]
s_waitcnt lgkmcnt(6)
M v[68:71],v[32:35],a[232:235],v[68:71]
s_mov_b32 s25, 256
T a[144:145],v17,28672
T a[146:147],v17,30720
M v[68:71],v[36:39],a[96:99],v[68:71]
SA m0,s4,65536
M v[68:71],v[40:43],a[104:107],v[68:71]
s_waitcnt lgkmcnt(2)
s_nop 0
T a[148:149],v13,0
T a[150:151],v13,2048
M v[68:71],v[44:47],a[112:115],v[68:71]
s_min_u32 s66, s66, s42
T a[152:153],v13,4096
T a[154:155],v13,6144
M v[68:71],v[48:51],a[120:123],v[68:71]
s_mul_i32 s21, s41, 1048576
buffer_load_dwordx4 v8, s[52:55], s25 offen lds
M v[68:71],v[52:55],a[128:131],v[68:71]
s_lshl_b32 s64, s67, 16
T a[156:157],v13,8192
T a[158:159],v13,10240
M v[68:71],v[56:59],a[136:139],v[68:71]
s_mov_b32 s25, 262400
T a[160:161],v13,12288
T a[162:163],v13,14336
M v[76:79],v[56:59],a[140:143],v[76:79]
SA m0,s4,69632
M v[76:79],v[52:55],a[132:135],v[76:79]
SA s32,s21,s64
T a[164:165],v13,16384
T a[166:167],v13,18432
M v[76:79],v[48:51],a[124:127],v[76:79]
s_lshl_b32 s64, s20, 14
T a[168:169],v13,20480
T a[170:171],v13,22528
M v[76:79],v[44:47],a[116:119],v[76:79]
SA s32,s32,s64
buffer_load_dwordx4 v8, s[52:55], s25 offen lds
M v[76:79],v[40:43],a[108:111],v[76:79]
SA s32,s32,33554432
M v[76:79],v[36:39],a[100:103],v[76:79]
s_mov_b32 s25, 524544
M v[76:79],v[32:35],a[236:239],v[76:79]
s_waitcnt lgkmcnt(6)
M v[84:87],a[144:147],a[232:235],v[84:87]
SA m0,s4,73728
T v[32:33],v18,28672
T v[34:35],v18,30720
M v[84:87],a[148:151],a[96:99],v[84:87]
s_sub_u32 s64, s42, 10
buffer_load_dwordx4 v8, s[52:55], s25 offen lds
M v[84:87],a[152:155],a[104:107],v[84:87]
s_waitcnt lgkmcnt(2)
s_nop 0
T v[36:37],v14,0
T v[38:39],v14,2048
M v[84:87],a[156:159],a[112:115],v[84:87]
s_mov_b32 s25, 786688
T v[40:41],v14,4096
T v[42:43],v14,6144
M v[84:87],a[160:163],a[120:123],v[84:87]
SA m0,s4,77824
M v[84:87],a[164:167],a[128:131],v[84:87]
s_and_b32 s35, s64, 536870912
T v[44:45],v14,8192
T v[46:47],v14,10240
M v[84:87],a[168:171],a[136:139],v[84:87]
T v[48:49],v14,12288
T v[50:51],v14,14336
M v[92:95],a[168:171],a[140:143],v[92:95]
buffer_load_dwordx4 v8, s[52:55], s25 offen lds
M v[92:95],a[164:167],a[132:135],v[92:95]
s_nop 0
T v[52:53],v14,16384
T v[54:55],v14,18432
M v[92:95],a[160:163],a[124:127],v[92:95]
s_mov_b32 s25, 1048832
T v[56:57],v14,20480
T v[58:59],v14,22528
M v[92:95],a[156:159],a[116:119],v[92:95]
SA m0,s4,81920
v_or_b32 v6, s35, v7
MF v68,s5,v68
M v[92:95],a[152:155],a[108:111],v[92:95]
s_lshl_b32 s28, s20, 13
buffer_load_dwordx4 v8, s[52:55], s25 offen lds
M v[92:95],a[148:151],a[100:103],v[92:95]
v_add_u32 v2, 0x10000, v7
v_add_u32 v3, s28, v7
M v[92:95],a[144:147],a[236:239],v[92:95]
s_waitcnt lgkmcnt(6)
v_add_u32 v4, 0x1000, v3
MF v69,s5,v69
M v[100:103],v[32:35],a[232:235],v[100:103]
s_mov_b32 s25, 1310976
T a[144:145],v19,28672
T a[146:147],v19,30720
M v[100:103],v[36:39],a[96:99],v[100:103]
SA m0,s4,86016
MF v70,s5,v70
MF v71,s5,v71
M v[100:103],v[40:43],a[104:107],v[100:103]
s_waitcnt lgkmcnt(2)
T a[148:149],v15,0
T a[150:151],v15,2048
M v[100:103],v[44:47],a[112:115],v[100:103]
s_lshl_b32 s64, s42, 16
T a[152:153],v15,4096
T a[154:155],v15,6144
M v[100:103],v[48:51],a[120:123],v[100:103]
SA s23,s21,s64
buffer_load_dwordx4 v8, s[52:55], s25 offen lds
M v[100:103],v[52:55],a[128:131],v[100:103]
SA s43,s23,16777216
T a[156:157],v15,8192
T a[158:159],v15,10240
M v[100:103],v[56:59],a[136:139],v[100:103]
s_mov_b32 s25, 1573120
T a[160:161],v15,12288
T a[162:163],v15,14336
M v[108:111],v[56:59],a[140:143],v[108:111]
SA m0,s4,90112
MF v84,s5,v84
MF v85,s5,v85
M v[108:111],v[52:55],a[132:135],v[108:111]
SA s26,s21,16777216
T a[164:165],v15,16384
T a[166:167],v15,18432
M v[108:111],v[48:51],a[124:127],v[108:111]
s_mov_b32 s22, 0x7fff
T a[168:169],v15,20480
T a[170:171],v15,22528
M v[108:111],v[44:47],a[116:119],v[108:111]
s_sub_u32 s27, s42, 1
buffer_load_dwordx4 v8, s[52:55], s25 offen lds
M v[108:111],v[40:43],a[108:111],v[108:111]
s_cmp_eq_u32 s42, 0
MF v86,s5,v86
MF v87,s5,v87
M v[108:111],v[36:39],a[100:103],v[108:111]
s_waitcnt vmcnt(7) lgkmcnt(0)
C v68,v68,v69
C v69,v70,v71
M v[108:111],v[32:35],a[236:239],v[108:111]
s_barrier
M v[116:119],a[144:147],a[232:235],v[116:119]
s_mov_b32 s25, 1835264
T v[32:33],v16,49152
T v[34:35],v16,51200
M v[116:119],a[148:151],a[96:99],v[116:119]
s_cselect_b32 s64, 32768, 0
C v70,v84,v85
C v71,v86,v87
M v[116:119],a[152:155],a[104:107],v[116:119]
SA m0,s4,94208
T v[36:37],v16,53248
T v[38:39],v16,55296
M v[116:119],a[156:159],a[112:115],v[116:119]
SA s26,s26,s64
T v[40:41],v16,57344
T v[42:43],v16,59392
M v[116:119],a[160:163],a[120:123],v[116:119]
s_mov_b32 s31, 0x4b800000
buffer_load_dwordx4 v8, s[52:55], s25 offen lds
M v[116:119],a[164:167],a[128:131],v[116:119]
s_mov_b32 s24, 0x33800000
T v[44:45],v16,61440
T v[46:47],v16,63488
M v[116:119],a[168:171],a[136:139],v[116:119]
s_mov_b32 s25, 2097408
T v[48:49],v20,32768
T v[50:51],v20,34816
M v[124:127],a[168:171],a[140:143],v[124:127]
SA m0,s4,155648
W a0,v68
W a1,v69
M v[124:127],a[164:167],a[132:135],v[124:127]
s_lshl_b32 s47, s66, 7
T v[52:53],v20,36864
T v[54:55],v20,38912
M v[124:127],a[160:163],a[124:127],v[124:127]
SA s47,s47,s46
T v[56:57],v20,40960
T v[58:59],v20,43008
M v[124:127],a[156:159],a[116:119],v[124:127]
s_lshl_b32 s64, s20, 5
buffer_load_dwordx4 v8, s[52:55], s25 offen lds
M v[124:127],a[152:155],a[108:111],v[124:127]
SA s47,s47,s64
W a2,v70
W a3,v71
M v[124:127],a[148:151],a[100:103],v[124:127]
SA s47,s47,2048
MF v76,s5,v76
MF v77,s5,v77
M v[124:127],a[144:147],a[236:239],v[124:127]
s_waitcnt lgkmcnt(6)
MF v78,s5,v78
MF v79,s5,v79
M v[132:135],v[32:35],a[176:179],0
s_lshl_b32 s65, s41, 3
T a[144:145],v17,49152
T a[146:147],v17,51200
M v[132:135],v[36:39],a[184:187],v[132:135]
SA s65,s65,s66
MF v92,s5,v92
MF v93,s5,v93
M v[132:135],v[40:43],a[192:195],v[132:135]
s_waitcnt lgkmcnt(2)
T a[148:149],v17,53248
T a[150:151],v17,55296
M v[132:135],v[44:47],a[200:203],v[132:135]
s_mul_i32 s34, s65, 73728
T a[152:153],v17,57344
T a[154:155],v17,59392
M v[132:135],v[48:51],a[208:211],v[132:135]
SA s34,s34,136314880
MF v94,s5,v94
MF v95,s5,v95
M v[132:135],v[52:55],a[216:219],v[132:135]
s_lshl_b32 s65, s42, 4
T a[156:157],v17,61440
T a[158:159],v17,63488
M v[132:135],v[56:59],a[224:227],v[132:135]
SA s65,s65,s41
T a[160:161],v21,32768
T a[162:163],v21,34816
M v[140:143],v[56:59],a[228:231],0
s_mul_i32 s33, s65, 114688
C v76,v76,v77
C v77,v78,v79
M v[140:143],v[52:55],a[220:223],v[140:143]
s_mul_i32 s65, s20, 28672
T a[164:165],v21,36864
T a[166:167],v21,38912
M v[140:143],v[48:51],a[212:215],v[140:143]
SA s33,s33,s65
T a[168:169],v21,40960
T a[170:171],v21,43008
M v[140:143],v[44:47],a[204:207],v[140:143]
SA s33,s33,67108864
C v78,v92,v93
C v79,v94,v95
M v[140:143],v[40:43],a[196:199],v[140:143]
s_mov_b32 s6, 0
W a32,v76
W a33,v77
M v[140:143],v[36:39],a[188:191],v[140:143]
s_mov_b32 s7, 0
W a34,v78
W a35,v79
M v[140:143],v[32:35],a[180:183],v[140:143]
s_waitcnt lgkmcnt(6)
MF v100,s5,v100
MF v101,s5,v101
M v[148:151],a[144:147],a[176:179],0
s_mov_b32 s40, 1
T v[32:33],v18,49152
T v[34:35],v18,51200
M v[148:151],a[148:151],a[184:187],v[148:151]
s_cmp_eq_u32 s20, 0
MF v102,s5,v102
MF v103,s5,v103
M v[148:151],a[152:155],a[192:195],v[148:151]
s_waitcnt lgkmcnt(2)
T v[36:37],v18,53248
T v[38:39],v18,55296
M v[148:151],a[156:159],a[200:203],v[148:151]
s_cselect_b32 s39, 7, 4
T v[40:41],v18,57344
T v[42:43],v18,59392
M v[148:151],a[160:163],a[208:211],v[148:151]
s_lshl_b32 s64, s41, 1
MF v116,s5,v116
MF v117,s5,v117
M v[148:151],a[164:167],a[216:219],v[148:151]
SA s64,s64,s20
T v[44:45],v18,61440
T v[46:47],v18,63488
M v[148:151],a[168:171],a[224:227],v[148:151]
s_cmp_lt_u32 s64, 30
T v[48:49],v22,32768
T v[50:51],v22,34816
M v[156:159],a[168:171],a[228:231],0
s_cselect_b32 s64, 32798, 0
MF v118,s5,v118
MF v119,s5,v119
M v[156:159],a[164:167],a[220:223],v[156:159]
s_cmp_ge_u32 s20, 2
T v[52:53],v22,36864
T v[54:55],v22,38912
M v[156:159],a[160:163],a[212:215],v[156:159]
s_cselect_b32 s64, s64, 0
T v[56:57],v22,40960
T v[58:59],v22,43008
M v[156:159],a[156:159],a[204:207],v[156:159]
s_cmp_eq_u32 s42, 6
C v100,v100,v101
C v101,v102,v103
M v[156:159],a[152:155],a[196:199],v[156:159]
s_cselect_b32 s64, s64, 0
C v102,v116,v117
C v103,v118,v119
M v[156:159],a[148:151],a[188:191],v[156:159]
s_or_b32 s39, s39, s64
W a4,v100
W a5,v101
M v[156:159],a[144:147],a[180:183],v[156:159]
s_waitcnt lgkmcnt(6)
W a6,v102
W a7,v103
M v[164:167],v[32:35],a[176:179],0
s_mov_b64 s[60:61], s[76:77]
T a[144:145],v19,49152
T a[146:147],v19,51200
M v[164:167],v[36:39],a[184:187],v[164:167]
s_mov_b32 s62, s78
MF v108,s5,v108
MF v109,s5,v109
M v[164:167],v[40:43],a[192:195],v[164:167]
s_waitcnt lgkmcnt(2)
T a[148:149],v19,53248
T a[150:151],v19,55296
M v[164:167],v[44:47],a[200:203],v[164:167]
s_mov_b32 s63, 0x20000
T a[152:153],v19,57344
T a[154:155],v19,59392
M v[164:167],v[48:51],a[208:211],v[164:167]
s_mov_b32 s25, 2359552
v_lshrrev_b32 v24, 4, v0
v_lshlrev_b32 v24, 2, v24
M v[164:167],v[52:55],a[216:219],v[164:167]
SA m0,s4,159744
T a[156:157],v19,61440
T a[158:159],v19,63488
M v[164:167],v[56:59],a[224:227],v[164:167]
SA s3,s93,532480
T a[160:161],v23,32768
T a[162:163],v23,34816
M v[172:175],v[56:59],a[228:231],0
buffer_load_dwordx4 v8, s[52:55], s25 offen lds
M v[172:175],v[52:55],a[220:223],v[172:175]
s_nop 0
T a[164:165],v23,36864
T a[166:167],v23,38912
M v[172:175],v[48:51],a[212:215],v[172:175]
s_mov_b32 s25, 2621696
T a[168:169],v23,40960
T a[170:171],v23,43008
M v[172:175],v[44:47],a[204:207],v[172:175]
SA m0,s4,131072
buffer_store_dwordx4 v[96:99], v7, s[8:11], s3 offen offset:0 sc1
M v[172:175],v[40:43],a[196:199],v[172:175]
v_and_b32 v25, 15, v0
v_sub_u32 v24, v24, v25
M v[172:175],v[36:39],a[188:191],v[172:175]
buffer_load_dwordx4 v8, s[52:55], s25 offen lds
M v[172:175],v[32:35],a[180:183],v[172:175]
s_waitcnt lgkmcnt(6)
v_cmp_lt_i32 s[16:17], 0, v24
v_cmp_lt_i32 s[18:19], -1, v24
M v[180:183],a[144:147],a[176:179],0
s_mov_b32 s25, 2883840
T v[32:33],v20,45056
T v[34:35],v20,47104
M v[180:183],a[148:151],a[184:187],v[180:183]
SA m0,s4,135168
buffer_store_dwordx4 v[104:107], v7, s[8:11], s3 offen offset:1024 sc1
M v[180:183],a[152:155],a[192:195],v[180:183]
s_waitcnt lgkmcnt(2)
s_nop 0
T v[36:37],v20,49152
T v[38:39],v20,51200
M v[180:183],a[156:159],a[200:203],v[180:183]
T v[40:41],v20,53248
T v[42:43],v20,55296
M v[180:183],a[160:163],a[208:211],v[180:183]
buffer_load_dwordx4 v8, s[52:55], s25 offen lds
M v[180:183],a[164:167],a[216:219],v[180:183]
s_nop 0
T v[44:45],v20,57344
T v[46:47],v20,59392
M v[180:183],a[168:171],a[224:227],v[180:183]
s_mov_b32 s25, 3145984
T v[48:49],v20,61440
T v[50:51],v20,63488
M v[188:191],a[168:171],a[228:231],0
SA m0,s4,139264
buffer_store_dwordx4 v[112:115], v7, s[8:11], s3 offen offset:2048 sc1
M v[188:191],a[164:167],a[220:223],v[188:191]
s_nop 0
T v[52:53],v16,32768
T v[54:55],v16,34816
M v[188:191],a[160:163],a[212:215],v[188:191]
T v[56:57],v16,36864
T v[58:59],v16,38912
M v[188:191],a[156:159],a[204:207],v[188:191]
buffer_load_dwordx4 v8, s[52:55], s25 offen lds
M v[188:191],a[152:155],a[196:199],v[188:191]
v_cmp_lt_i32 s[48:49], -2, v24
v_cmp_lt_i32 s[50:51], -3, v24
M v[188:191],a[148:151],a[188:191],v[188:191]
s_mov_b32 s25, 3408128
buffer_store_dwordx4 v[120:123], v7, s[8:11], s3 offen offset:3072 sc1
M v[188:191],a[144:147],a[180:183],v[188:191]
s_waitcnt lgkmcnt(6)
v_lshl_add_u32 v25, v0, 7, s95
v_and_b32 v0, 48, v0
M v[132:135],v[32:35],a[232:235],v[132:135]
SA m0,s4,143360
T a[144:145],v21,45056
T a[146:147],v21,47104
M v[132:135],v[36:39],a[96:99],v[132:135]
buffer_load_dwordx4 v8, s[52:55], s25 offen lds
M v[132:135],v[40:43],a[104:107],v[132:135]
s_waitcnt lgkmcnt(2)
s_nop 0
T a[148:149],v21,49152
T a[150:151],v21,51200
M v[132:135],v[44:47],a[112:115],v[132:135]
s_mov_b32 s25, 384
T a[152:153],v21,53248
T a[154:155],v21,55296
M v[132:135],v[48:51],a[120:123],v[132:135]
SA m0,s4,0
v_lshl_add_u32 v0, v0, 24, v25
v_mov_b32 v24, 0x3f80
M v[132:135],v[52:55],a[128:131],v[132:135]
T a[156:157],v21,57344
T a[158:159],v21,59392
M v[132:135],v[56:59],a[136:139],v[132:135]
T a[160:161],v21,61440
T a[162:163],v21,63488
M v[140:143],v[56:59],a[140:143],v[140:143]
buffer_load_dwordx4 v8, s[52:55], s25 offen lds
M v[140:143],v[52:55],a[132:135],v[140:143]
s_nop 0
T a[164:165],v17,32768
T a[166:167],v17,34816
M v[140:143],v[48:51],a[124:127],v[140:143]
s_mov_b32 s25, 262528
T a[168:169],v17,36864
T a[170:171],v17,38912
M v[140:143],v[44:47],a[116:119],v[140:143]
SA m0,s4,4096
MF v110,s5,v110
MF v111,s5,v111
M v[140:143],v[40:43],a[108:111],v[140:143]
buffer_load_dwordx4 v8, s[52:55], s25 offen lds
M v[140:143],v[36:39],a[100:103],v[140:143]
MF v124,s5,v124
MF v125,s5,v125
M v[140:143],v[32:35],a[236:239],v[140:143]
s_waitcnt lgkmcnt(6)
MF v126,s5,v126
MF v127,s5,v127
M v[148:151],a[144:147],a[232:235],v[148:151]
s_mov_b32 s25, 524672
T v[32:33],v22,45056
T v[34:35],v22,47104
M v[148:151],a[148:151],a[96:99],v[148:151]
SA m0,s4,8192
C v108,v108,v109
C v109,v110,v111
M v[148:151],a[152:155],a[104:107],v[148:151]
s_waitcnt lgkmcnt(2)
T v[36:37],v22,49152
T v[38:39],v22,51200
M v[148:151],a[156:159],a[112:115],v[148:151]
T v[40:41],v22,53248
T v[42:43],v22,55296
M v[148:151],a[160:163],a[120:123],v[148:151]
buffer_load_dwordx4 v8, s[52:55], s25 offen lds
M v[148:151],a[164:167],a[128:131],v[148:151]
s_nop 0
T v[44:45],v22,57344
T v[46:47],v22,59392
M v[148:151],a[168:171],a[136:139],v[148:151]
s_mov_b32 s25, 786816
T v[48:49],v22,61440
T v[50:51],v22,63488
M v[156:159],a[168:171],a[140:143],v[156:159]
SA m0,s4,12288
C v110,v124,v125
C v111,v126,v127
M v[156:159],a[164:167],a[132:135],v[156:159]
T v[52:53],v18,32768
T v[54:55],v18,34816
M v[156:159],a[160:163],a[124:127],v[156:159]
T v[56:57],v18,36864
T v[58:59],v18,38912
M v[156:159],a[156:159],a[116:119],v[156:159]
buffer_load_dwordx4 v8, s[52:55], s25 offen lds
M v[156:159],a[152:155],a[108:111],v[156:159]
W a36,v108
W a37,v109
M v[156:159],a[148:151],a[100:103],v[156:159]
s_mov_b32 s25, 1048960
v_lshrrev_b32 v25, 8, v7
v_bfe_u32 v26, v7, 6, 2
v_and_b32 v27, 16, v7
v_lshlrev_b32 v27, v27, v24
v_cmp_eq_u32 vcc, v25, v26
v_and_b32 v28, 32, v7
W a244,0
v_cndmask_b32 v27, 0, v27, vcc
v_cmp_eq_u32 vcc, 0, v28
W a245,0
W a248,0
v_cndmask_b32 v25, 0, v27, vcc
v_sub_u32 v26, v27, v25
W a249,0
W a246,v25
W a247,v26
M v[156:159],a[144:147],a[236:239],v[156:159]
s_waitcnt lgkmcnt(6)
W a38,v110
W a39,v111
M v[164:167],v[32:35],a[232:235],v[164:167]
SA m0,s4,16384
T a[144:145],v23,45056
T a[146:147],v23,47104
M v[164:167],v[36:39],a[96:99],v[164:167]
buffer_load_dwordx4 v8, s[52:55], s25 offen lds
M v[164:167],v[40:43],a[104:107],v[164:167]
s_waitcnt lgkmcnt(2)
s_nop 0
T a[148:149],v23,49152
T a[150:151],v23,51200
M v[164:167],v[44:47],a[112:115],v[164:167]
s_mov_b32 s25, 1311104
T a[152:153],v23,53248
T a[154:155],v23,55296
M v[164:167],v[48:51],a[120:123],v[164:167]
SA m0,s4,20480
MF v132,s5,v132
MF v133,s5,v133
M v[164:167],v[52:55],a[128:131],v[164:167]
T a[156:157],v23,57344
T a[158:159],v23,59392
M v[164:167],v[56:59],a[136:139],v[164:167]
T a[160:161],v23,61440
T a[162:163],v23,63488
M v[172:175],v[56:59],a[140:143],v[172:175]
buffer_load_dwordx4 v8, s[52:55], s25 offen lds
M v[172:175],v[52:55],a[132:135],v[172:175]
s_nop 0
T a[164:165],v19,32768
T a[166:167],v19,34816
M v[172:175],v[48:51],a[124:127],v[172:175]
s_mov_b32 s25, 1573248
T a[168:169],v19,36864
T a[170:171],v19,38912
M v[172:175],v[44:47],a[116:119],v[172:175]
SA m0,s4,24576
MF v134,s5,v134
MF v135,s5,v135
M v[172:175],v[40:43],a[108:111],v[172:175]
buffer_load_dwordx4 v8, s[52:55], s25 offen lds
M v[172:175],v[36:39],a[100:103],v[172:175]
s_waitcnt vmcnt(7) lgkmcnt(0)
MF v148,s5,v148
MF v149,s5,v149
M v[172:175],v[32:35],a[236:239],v[172:175]
s_barrier
M v[180:183],a[144:147],a[232:235],v[180:183]
s_mov_b32 s25, 1835392
T v[32:33],v20,0
T v[34:35],v20,2048
M v[180:183],a[148:151],a[96:99],v[180:183]
SA m0,s4,28672
MF v150,s5,v150
MF v151,s5,v151
M v[180:183],a[152:155],a[104:107],v[180:183]
T v[36:37],v20,4096
T v[38:39],v20,6144
M v[180:183],a[156:159],a[112:115],v[180:183]
T v[40:41],v20,8192
T v[42:43],v20,10240
M v[180:183],a[160:163],a[120:123],v[180:183]
buffer_load_dwordx4 v8, s[52:55], s25 offen lds
M v[180:183],a[164:167],a[128:131],v[180:183]
s_nop 0
T v[44:45],v20,12288
T v[46:47],v20,14336
M v[180:183],a[168:171],a[136:139],v[180:183]
s_mov_b32 s25, 2097536
T v[48:49],v20,16384
T v[50:51],v20,18432
M v[188:191],a[168:171],a[140:143],v[188:191]
SA m0,s4,40960
C v132,v132,v133
C v133,v134,v135
M v[188:191],a[164:167],a[132:135],v[188:191]
T v[52:53],v20,20480
T v[54:55],v20,22528
M v[188:191],a[160:163],a[124:127],v[188:191]
T v[56:57],v20,24576
T v[58:59],v20,26624
M v[188:191],a[156:159],a[116:119],v[188:191]
buffer_load_dwordx4 v8, s[52:55], s25 offen lds
M v[188:191],a[152:155],a[108:111],v[188:191]
C v134,v148,v149
C v135,v150,v151
M v[188:191],a[148:151],a[100:103],v[188:191]
s_mov_b32 s25, 2359680
W a8,v132
W a9,v133
M v[188:191],a[144:147],a[236:239],v[188:191]
s_waitcnt lgkmcnt(6)
W a10,v134
W a11,v135
M v[68:71],v[32:35],a[176:179],0
SA m0,s4,45056
T a[144:145],v21,0
T a[146:147],v21,2048
M v[68:71],v[36:39],a[184:187],v[68:71]
buffer_load_dwordx4 v8, s[52:55], s25 offen lds
M v[68:71],v[40:43],a[192:195],v[68:71]
s_waitcnt lgkmcnt(2)
s_nop 0
T a[148:149],v21,4096
T a[150:151],v21,6144
M v[68:71],v[44:47],a[200:203],v[68:71]
s_mov_b32 s25, 2621824
T a[152:153],v21,8192
T a[154:155],v21,10240
M v[68:71],v[48:51],a[208:211],v[68:71]
SA m0,s4,49152
v_lshrrev_b32 v31, 6, v7
v_bfe_u32 v28, v7, 4, 2
M v[68:71],v[52:55],a[216:219],v[68:71]
T a[156:157],v21,12288
T a[158:159],v21,14336
M v[68:71],v[56:59],a[224:227],v[68:71]
T a[160:161],v21,16384
T a[162:163],v21,18432
M v[76:79],v[56:59],a[228:231],0
buffer_load_dwordx4 v8, s[52:55], s25 offen lds
M v[76:79],v[52:55],a[220:223],v[76:79]
s_nop 0
T a[164:165],v21,20480
T a[166:167],v21,22528
M v[76:79],v[48:51],a[212:215],v[76:79]
s_mov_b32 s25, 2883968
T a[168:169],v21,24576
T a[170:171],v21,26624
M v[76:79],v[44:47],a[204:207],v[76:79]
SA m0,s4,53248
v_lshlrev_b32 v31, 5, v31
v_add_lshl_u32 v31, v31, v28, 2
M v[76:79],v[40:43],a[196:199],v[76:79]
SA s3,s93,262144
buffer_load_dword v5, v31, s[8:11], s46 offen offset:4 sc1
M v[76:79],v[36:39],a[188:191],v[76:79]
buffer_load_dwordx4 v8, s[52:55], s25 offen lds
M v[76:79],v[32:35],a[180:183],v[76:79]
s_waitcnt lgkmcnt(6)
MF v140,s5,v140
MF v141,s5,v141
M v[84:87],a[144:147],a[176:179],0
s_mov_b32 s25, 3146112
T v[32:33],v22,0
T v[34:35],v22,2048
M v[84:87],a[148:151],a[184:187],v[84:87]
SA m0,s4,57344
buffer_store_dwordx4 v[128:131], v7, s[8:11], s3 offen offset:0 sc1
M v[84:87],a[152:155],a[192:195],v[84:87]
s_waitcnt lgkmcnt(2)
s_nop 0
T v[36:37],v22,4096
T v[38:39],v22,6144
M v[84:87],a[156:159],a[200:203],v[84:87]
T v[40:41],v22,8192
T v[42:43],v22,10240
M v[84:87],a[160:163],a[208:211],v[84:87]
buffer_load_dwordx4 v8, s[52:55], s25 offen lds
M v[84:87],a[164:167],a[216:219],v[84:87]
s_nop 0
T v[44:45],v22,12288
T v[46:47],v22,14336
M v[84:87],a[168:171],a[224:227],v[84:87]
s_mov_b32 s25, 3408256
T v[48:49],v22,16384
T v[50:51],v22,18432
M v[92:95],a[168:171],a[228:231],0
SA m0,s4,61440
buffer_store_dwordx4 v[136:139], v7, s[8:11], s3 offen offset:1024 sc1
M v[92:95],a[164:167],a[220:223],v[92:95]
s_nop 0
T v[52:53],v22,20480
T v[54:55],v22,22528
M v[92:95],a[160:163],a[212:215],v[92:95]
T v[56:57],v22,24576
T v[58:59],v22,26624
M v[92:95],a[156:159],a[204:207],v[92:95]
buffer_load_dwordx4 v8, s[52:55], s25 offen lds
M v[92:95],a[152:155],a[196:199],v[92:95]
MF v142,s5,v142
MF v143,s5,v143
M v[92:95],a[148:151],a[188:191],v[92:95]
buffer_store_dwordx4 v[144:147], v7, s[8:11], s3 offen offset:2048 sc1
M v[92:95],a[144:147],a[180:183],v[92:95]
s_waitcnt lgkmcnt(6)
MF v156,s5,v156
MF v157,s5,v157
M v[100:103],v[32:35],a[176:179],0
T a[144:145],v23,0
T a[146:147],v23,2048
M v[100:103],v[36:39],a[184:187],v[100:103]
buffer_store_dwordx4 v[152:155], v7, s[8:11], s3 offen offset:3072 sc1
M v[100:103],v[40:43],a[192:195],v[100:103]
s_waitcnt lgkmcnt(2)
s_nop 0
T a[148:149],v23,4096
T a[150:151],v23,6144
M v[100:103],v[44:47],a[200:203],v[100:103]
T a[152:153],v23,8192
T a[154:155],v23,10240
M v[100:103],v[48:51],a[208:211],v[100:103]
MF v158,s5,v158
MF v159,s5,v159
M v[100:103],v[52:55],a[216:219],v[100:103]
T a[156:157],v23,12288
T a[158:159],v23,14336
M v[100:103],v[56:59],a[224:227],v[100:103]
T a[160:161],v23,16384
T a[162:163],v23,18432
M v[108:111],v[56:59],a[228:231],0
C v140,v140,v141
C v141,v142,v143
M v[108:111],v[52:55],a[220:223],v[108:111]
T a[164:165],v23,20480
T a[166:167],v23,22528
M v[108:111],v[48:51],a[212:215],v[108:111]
T a[168:169],v23,24576
T a[170:171],v23,26624
M v[108:111],v[44:47],a[204:207],v[108:111]
C v142,v156,v157
C v143,v158,v159
M v[108:111],v[40:43],a[196:199],v[108:111]
W a40,v140
W a41,v141
M v[108:111],v[36:39],a[188:191],v[108:111]
W a42,v142
W a43,v143
M v[108:111],v[32:35],a[180:183],v[108:111]
s_waitcnt lgkmcnt(6)
v_mov_b32 v8, 0xff800000
MF v164,s5,v164
M v[116:119],a[144:147],a[176:179],0
T v[32:33],v20,28672
T v[34:35],v20,30720
M v[116:119],a[148:151],a[184:187],v[116:119]
MF v165,s5,v165
MF v166,s5,v166
M v[116:119],a[152:155],a[192:195],v[116:119]
s_waitcnt lgkmcnt(2)
T v[36:37],v12,24576
T v[38:39],v12,26624
M v[116:119],a[156:159],a[200:203],v[116:119]
T v[40:41],v12,28672
T v[42:43],v12,30720
M v[116:119],a[160:163],a[208:211],v[116:119]
MF v167,s5,v167
MF v180,s5,v180
M v[116:119],a[164:167],a[216:219],v[116:119]
T v[44:45],v12,0
T v[46:47],v12,2048
M v[116:119],a[168:171],a[224:227],v[116:119]
T v[48:49],v12,4096
T v[50:51],v12,6144
M v[124:127],a[168:171],a[228:231],0
MF v181,s5,v181
MF v182,s5,v182
M v[124:127],a[164:167],a[220:223],v[124:127]
T v[52:53],v12,8192
T v[54:55],v12,10240
M v[124:127],a[160:163],a[212:215],v[124:127]
T v[56:57],v12,12288
T v[58:59],v12,14336
M v[124:127],a[156:159],a[204:207],v[124:127]
MF v183,s5,v183
C v164,v164,v165
M v[124:127],a[152:155],a[196:199],v[124:127]
C v165,v166,v167
C v166,v180,v181
M v[124:127],a[148:151],a[188:191],v[124:127]
C v167,v182,v183
W a12,v164
M v[124:127],a[144:147],a[180:183],v[124:127]
s_waitcnt lgkmcnt(6)
W a13,v165
W a14,v166
M v[68:71],v[32:35],a[232:235],v[68:71]
T a[144:145],v21,28672
T a[146:147],v21,30720
M v[68:71],v[36:39],a[96:99],v[68:71]
W a15,v167
MF v172,s5,v172
M v[68:71],v[40:43],a[104:107],v[68:71]
s_waitcnt lgkmcnt(2)
T a[148:149],v13,24576
T a[150:151],v13,26624
M v[68:71],v[44:47],a[112:115],v[68:71]
T a[152:153],v13,28672
T a[154:155],v13,30720
M v[68:71],v[48:51],a[120:123],v[68:71]
MF v173,s5,v173
MF v174,s5,v174
M v[68:71],v[52:55],a[128:131],v[68:71]
T a[156:157],v13,0
T a[158:159],v13,2048
M v[68:71],v[56:59],a[136:139],v[68:71]
T a[160:161],v13,4096
T a[162:163],v13,6144
M v[76:79],v[56:59],a[140:143],v[76:79]
MF v175,s5,v175
MF v188,s5,v188
M v[76:79],v[52:55],a[132:135],v[76:79]
T a[164:165],v13,8192
T a[166:167],v13,10240
M v[76:79],v[48:51],a[124:127],v[76:79]
T a[168:169],v13,12288
T a[170:171],v13,14336
M v[76:79],v[44:47],a[116:119],v[76:79]
MF v189,s5,v189
MF v190,s5,v190
M v[76:79],v[40:43],a[108:111],v[76:79]
MF v191,s5,v191
C v172,v172,v173
M v[76:79],v[36:39],a[100:103],v[76:79]
C v173,v174,v175
C v174,v188,v189
M v[76:79],v[32:35],a[236:239],v[76:79]
s_waitcnt lgkmcnt(6)
C v175,v190,v191
W a44,v172
M v[84:87],a[144:147],a[232:235],v[84:87]
T v[32:33],v22,28672
T v[34:35],v22,30720
M v[84:87],a[148:151],a[96:99],v[84:87]
W a45,v173
W a46,v174
M v[84:87],a[152:155],a[104:107],v[84:87]
s_waitcnt lgkmcnt(2)
T v[36:37],v14,24576
T v[38:39],v14,26624
M v[84:87],a[156:159],a[112:115],v[84:87]
T v[40:41],v14,28672
T v[42:43],v14,30720
M v[84:87],a[160:163],a[120:123],v[84:87]
W a47,v175
s_waitcnt vmcnt(7)
v_cmp_ne_u32 vcc, 1, v5
M v[84:87],a[164:167],a[128:131],v[84:87]
s_nop 0
T v[44:45],v14,0
T v[46:47],v14,2048
M v[84:87],a[168:171],a[136:139],v[84:87]
s_cmp_lg_u32 vcc_lo, 0
T v[48:49],v14,4096
T v[50:51],v14,6144
M v[92:95],a[168:171],a[140:143],v[92:95]
s_cbranch_scc1 L_wsq0
L_wrq0:
M v[92:95],a[164:167],a[132:135],v[92:95]
SA m0,s28,98304
T v[52:53],v14,8192
T v[54:55],v14,10240
M v[92:95],a[160:163],a[124:127],v[92:95]
T v[56:57],v14,12288
T v[58:59],v14,14336
M v[92:95],a[156:159],a[116:119],v[92:95]
buffer_load_dwordx4 v3, s[8:11], s21 offen offset:0 sc1 lds
M v[92:95],a[152:155],a[108:111],v[92:95]
MF v68,s5,v68
MF v69,s5,v69
M v[92:95],a[148:151],a[100:103],v[92:95]
buffer_load_dwordx4 v3, s[8:11], s21 offen offset:1024 sc1 lds
M v[92:95],a[144:147],a[236:239],v[92:95]
s_waitcnt lgkmcnt(6)
MF v70,s5,v70
MF v71,s5,v71
M v[100:103],v[32:35],a[232:235],v[100:103]
T a[144:145],v23,28672
T a[146:147],v23,30720
M v[100:103],v[36:39],a[96:99],v[100:103]
buffer_load_dwordx4 v3, s[8:11], s21 offen offset:2048 sc1 lds
M v[100:103],v[40:43],a[104:107],v[100:103]
s_waitcnt lgkmcnt(2)
s_nop 0
T a[148:149],v15,24576
T a[150:151],v15,26624
M v[100:103],v[44:47],a[112:115],v[100:103]
T a[152:153],v15,28672
T a[154:155],v15,30720
M v[100:103],v[48:51],a[120:123],v[100:103]
buffer_load_dwordx4 v3, s[8:11], s21 offen offset:3072 sc1 lds
M v[100:103],v[52:55],a[128:131],v[100:103]
SA m0,s28,102400
T a[156:157],v15,0
T a[158:159],v15,2048
M v[100:103],v[56:59],a[136:139],v[100:103]
T a[160:161],v15,4096
T a[162:163],v15,6144
M v[108:111],v[56:59],a[140:143],v[108:111]
buffer_load_dwordx4 v4, s[8:11], s21 offen offset:0 sc1 lds
M v[108:111],v[52:55],a[132:135],v[108:111]
s_nop 0
T a[164:165],v15,8192
T a[166:167],v15,10240
M v[108:111],v[48:51],a[124:127],v[108:111]
T a[168:169],v15,12288
T a[170:171],v15,14336
M v[108:111],v[44:47],a[116:119],v[108:111]
buffer_load_dwordx4 v4, s[8:11], s21 offen offset:1024 sc1 lds
M v[108:111],v[40:43],a[108:111],v[108:111]
MF v84,s5,v84
MF v85,s5,v85
M v[108:111],v[36:39],a[100:103],v[108:111]
s_waitcnt vmcnt(8) lgkmcnt(0)
buffer_load_dwordx4 v4, s[8:11], s21 offen offset:2048 sc1 lds
M v[108:111],v[32:35],a[236:239],v[108:111]
s_barrier
M v[116:119],a[144:147],a[232:235],v[116:119]
s_nop 0
T v[32:33],v16,0
T v[34:35],v16,2048
M v[116:119],a[148:151],a[96:99],v[116:119]
buffer_load_dwordx4 v4, s[8:11], s21 offen offset:3072 sc1 lds
M v[116:119],a[152:155],a[104:107],v[116:119]
SA s21,s21,32768
T v[36:37],v16,4096
T v[38:39],v16,6144
M v[116:119],a[156:159],a[112:115],v[116:119]
s_sub_u32 s22, s22, 1
T v[40:41],v16,8192
T v[42:43],v16,10240
M v[116:119],a[160:163],a[120:123],v[116:119]
s_cselect_b32 s21, s23, s21
MF v86,s5,v86
MF v87,s5,v87
M v[116:119],a[164:167],a[128:131],v[116:119]
SA m0,s28,65536
T v[44:45],v16,12288
T v[46:47],v16,14336
M v[116:119],a[168:171],a[136:139],v[116:119]
T v[48:49],v16,16384
T v[50:51],v16,18432
M v[124:127],a[168:171],a[140:143],v[124:127]
buffer_load_dwordx4 v3, s[8:11], s21 offen offset:0 sc1 lds
M v[124:127],a[164:167],a[132:135],v[124:127]
s_nop 0
T v[52:53],v16,20480
T v[54:55],v16,22528
M v[124:127],a[160:163],a[124:127],v[124:127]
T v[56:57],v16,24576
T v[58:59],v16,26624
M v[124:127],a[156:159],a[116:119],v[124:127]
buffer_load_dwordx4 v3, s[8:11], s21 offen offset:1024 sc1 lds
M v[124:127],a[152:155],a[108:111],v[124:127]
buffer_load_dword v5, v31, s[8:11], s46 offen offset:4 sc1
M v[124:127],a[148:151],a[100:103],v[124:127]
buffer_load_dwordx4 v3, s[8:11], s21 offen offset:2048 sc1 lds
M v[124:127],a[144:147],a[236:239],v[124:127]
s_waitcnt lgkmcnt(6)
C v68,v68,v69
C v69,v70,v71
M v[132:135],v[32:35],a[176:179],0
T a[144:145],v17,0
T a[146:147],v17,2048
M v[132:135],v[36:39],a[184:187],v[132:135]
buffer_load_dwordx4 v3, s[8:11], s21 offen offset:3072 sc1 lds
M v[132:135],v[40:43],a[192:195],v[132:135]
s_waitcnt lgkmcnt(2)
s_nop 0
T a[148:149],v17,4096
T a[150:151],v17,6144
M v[132:135],v[44:47],a[200:203],v[132:135]
SA m0,s28,69632
T a[152:153],v17,8192
T a[154:155],v17,10240
M v[132:135],v[48:51],a[208:211],v[132:135]
buffer_load_dwordx4 v4, s[8:11], s21 offen offset:0 sc1 lds
M v[132:135],v[52:55],a[216:219],v[132:135]
s_nop 0
T a[156:157],v17,12288
T a[158:159],v17,14336
M v[132:135],v[56:59],a[224:227],v[132:135]
T a[160:161],v17,16384
T a[162:163],v17,18432
M v[140:143],v[56:59],a[228:231],0
buffer_load_dwordx4 v4, s[8:11], s21 offen offset:1024 sc1 lds
M v[140:143],v[52:55],a[220:223],v[140:143]
s_nop 0
T a[164:165],v17,20480
T a[166:167],v17,22528
M v[140:143],v[48:51],a[212:215],v[140:143]
T a[168:169],v17,24576
T a[170:171],v17,26624
M v[140:143],v[44:47],a[204:207],v[140:143]
SA s3,s93,270336
buffer_load_dwordx4 v4, s[8:11], s21 offen offset:2048 sc1 lds
M v[140:143],v[40:43],a[196:199],v[140:143]
C v70,v84,v85
C v71,v86,v87
M v[140:143],v[36:39],a[188:191],v[140:143]
buffer_load_dwordx4 v4, s[8:11], s21 offen offset:3072 sc1 lds
M v[140:143],v[32:35],a[180:183],v[140:143]
s_waitcnt lgkmcnt(6)
W a16,v68
W a17,v69
M v[148:151],a[144:147],a[176:179],0
SA s21,s21,32768
T v[32:33],v18,0
T v[34:35],v18,2048
M v[148:151],a[148:151],a[184:187],v[148:151]
s_sub_u32 s22, s22, 1
buffer_store_dwordx4 v[160:163], v7, s[8:11], s3 offen offset:0 sc1
M v[148:151],a[152:155],a[192:195],v[148:151]
s_waitcnt lgkmcnt(2)
s_nop 0
T v[36:37],v18,4096
T v[38:39],v18,6144
M v[148:151],a[156:159],a[200:203],v[148:151]
s_cselect_b32 s21, s23, s21
T v[40:41],v18,8192
T v[42:43],v18,10240
M v[148:151],a[160:163],a[208:211],v[148:151]
buffer_store_dwordx4 v[168:171], v7, s[8:11], s3 offen offset:1024 sc1
M v[148:151],a[164:167],a[216:219],v[148:151]
s_nop 0
T v[44:45],v18,12288
T v[46:47],v18,14336
M v[148:151],a[168:171],a[224:227],v[148:151]
T v[48:49],v18,16384
T v[50:51],v18,18432
M v[156:159],a[168:171],a[228:231],0
buffer_store_dwordx4 v[176:179], v7, s[8:11], s3 offen offset:2048 sc1
M v[156:159],a[164:167],a[220:223],v[156:159]
s_nop 0
T v[52:53],v18,20480
T v[54:55],v18,22528
M v[156:159],a[160:163],a[212:215],v[156:159]
T v[56:57],v18,24576
T v[58:59],v18,26624
M v[156:159],a[156:159],a[204:207],v[156:159]
buffer_store_dwordx4 v[184:187], v7, s[8:11], s3 offen offset:3072 sc1
M v[156:159],a[152:155],a[196:199],v[156:159]
W a18,v70
W a19,v71
M v[156:159],a[148:151],a[188:191],v[156:159]
MF v76,s5,v76
MF v77,s5,v77
M v[156:159],a[144:147],a[180:183],v[156:159]
s_waitcnt lgkmcnt(6)
MF v78,s5,v78
MF v79,s5,v79
M v[164:167],v[32:35],a[176:179],0
T a[144:145],v19,0
T a[146:147],v19,2048
M v[164:167],v[36:39],a[184:187],v[164:167]
MF v92,s5,v92
MF v93,s5,v93
M v[164:167],v[40:43],a[192:195],v[164:167]
s_waitcnt lgkmcnt(2)
T a[148:149],v19,4096
T a[150:151],v19,6144
M v[164:167],v[44:47],a[200:203],v[164:167]
T a[152:153],v19,8192
T a[154:155],v19,10240
M v[164:167],v[48:51],a[208:211],v[164:167]
MF v94,s5,v94
MF v95,s5,v95
M v[164:167],v[52:55],a[216:219],v[164:167]
T a[156:157],v19,12288
T a[158:159],v19,14336
M v[164:167],v[56:59],a[224:227],v[164:167]
T a[160:161],v19,16384
T a[162:163],v19,18432
M v[172:175],v[56:59],a[228:231],0
C v76,v76,v77
C v77,v78,v79
M v[172:175],v[52:55],a[220:223],v[172:175]
T a[164:165],v19,20480
T a[166:167],v19,22528
M v[172:175],v[48:51],a[212:215],v[172:175]
T a[168:169],v19,24576
T a[170:171],v19,26624
M v[172:175],v[44:47],a[204:207],v[172:175]
C v78,v92,v93
C v79,v94,v95
M v[172:175],v[40:43],a[196:199],v[172:175]
W a48,v76
W a49,v77
M v[172:175],v[36:39],a[188:191],v[172:175]
W a50,v78
W a51,v79
M v[172:175],v[32:35],a[180:183],v[172:175]
s_waitcnt lgkmcnt(6)
v_mov_b32 v30, 2
MF v100,s5,v100
M v[180:183],a[144:147],a[176:179],0
T v[32:33],v16,28672
T v[34:35],v16,30720
M v[180:183],a[148:151],a[184:187],v[180:183]
buffer_store_dword v30, v1, s[8:11], s45 offen sc1
M v[180:183],a[152:155],a[192:195],v[180:183]
s_waitcnt lgkmcnt(2)
s_nop 0
T v[36:37],v16,40960
T v[38:39],v16,43008
M v[180:183],a[156:159],a[200:203],v[180:183]
T v[40:41],v16,45056
T v[42:43],v16,47104
M v[180:183],a[160:163],a[208:211],v[180:183]
MF v101,s5,v101
MF v102,s5,v102
M v[180:183],a[164:167],a[216:219],v[180:183]
T v[44:45],v16,49152
T v[46:47],v16,51200
M v[180:183],a[168:171],a[224:227],v[180:183]
T v[48:49],v16,53248
T v[50:51],v16,55296
M v[188:191],a[168:171],a[228:231],0
MF v103,s5,v103
MF v116,s5,v116
M v[188:191],a[164:167],a[220:223],v[188:191]
T v[52:53],v16,57344
T v[54:55],v16,59392
M v[188:191],a[160:163],a[212:215],v[188:191]
T v[56:57],v16,61440
T v[58:59],v16,63488
M v[188:191],a[156:159],a[204:207],v[188:191]
MF v117,s5,v117
MF v118,s5,v118
M v[188:191],a[152:155],a[196:199],v[188:191]
MF v119,s5,v119
C v100,v100,v101
M v[188:191],a[148:151],a[188:191],v[188:191]
C v101,v102,v103
C v102,v116,v117
M v[188:191],a[144:147],a[180:183],v[188:191]
s_waitcnt lgkmcnt(6)
C v103,v118,v119
W a20,v100
M v[132:135],v[32:35],a[232:235],v[132:135]
T a[144:145],v17,28672
T a[146:147],v17,30720
M v[132:135],v[36:39],a[96:99],v[132:135]
W a21,v101
W a22,v102
M v[132:135],v[40:43],a[104:107],v[132:135]
s_waitcnt lgkmcnt(2)
T a[148:149],v17,40960
T a[150:151],v17,43008
M v[132:135],v[44:47],a[112:115],v[132:135]
T a[152:153],v17,45056
T a[154:155],v17,47104
M v[132:135],v[48:51],a[120:123],v[132:135]
W a23,v103
MF v108,s5,v108
M v[132:135],v[52:55],a[128:131],v[132:135]
T a[156:157],v17,49152
T a[158:159],v17,51200
M v[132:135],v[56:59],a[136:139],v[132:135]
T a[160:161],v17,53248
T a[162:163],v17,55296
M v[140:143],v[56:59],a[140:143],v[140:143]
MF v109,s5,v109
MF v110,s5,v110
M v[140:143],v[52:55],a[132:135],v[140:143]
T a[164:165],v17,57344
T a[166:167],v17,59392
M v[140:143],v[48:51],a[124:127],v[140:143]
T a[168:169],v17,61440
T a[170:171],v17,63488
M v[140:143],v[44:47],a[116:119],v[140:143]
MF v111,s5,v111
MF v124,s5,v124
M v[140:143],v[40:43],a[108:111],v[140:143]
MF v125,s5,v125
MF v126,s5,v126
M v[140:143],v[36:39],a[100:103],v[140:143]
MF v127,s5,v127
C v108,v108,v109
M v[140:143],v[32:35],a[236:239],v[140:143]
s_waitcnt lgkmcnt(6)
C v109,v110,v111
C v110,v124,v125
M v[148:151],a[144:147],a[232:235],v[148:151]
T v[32:33],v18,28672
T v[34:35],v18,30720
M v[148:151],a[148:151],a[96:99],v[148:151]
C v111,v126,v127
W a52,v108
M v[148:151],a[152:155],a[104:107],v[148:151]
s_waitcnt lgkmcnt(2)
T v[36:37],v18,40960
T v[38:39],v18,43008
M v[148:151],a[156:159],a[112:115],v[148:151]
T v[40:41],v18,45056
T v[42:43],v18,47104
M v[148:151],a[160:163],a[120:123],v[148:151]
W a53,v109
W a54,v110
M v[148:151],a[164:167],a[128:131],v[148:151]
T v[44:45],v18,49152
T v[46:47],v18,51200
M v[148:151],a[168:171],a[136:139],v[148:151]
T v[48:49],v18,53248
T v[50:51],v18,55296
M v[156:159],a[168:171],a[140:143],v[156:159]
W a55,v111
s_waitcnt vmcnt(11)
v_cmp_ne_u32 vcc, 1, v5
M v[156:159],a[164:167],a[132:135],v[156:159]
s_nop 0
T v[52:53],v18,57344
T v[54:55],v18,59392
M v[156:159],a[160:163],a[124:127],v[156:159]
s_cmp_lg_u32 vcc_hi, 0
T v[56:57],v18,61440
T v[58:59],v18,63488
M v[156:159],a[156:159],a[116:119],v[156:159]
s_cbranch_scc1 L_wsr0
L_wrr0:
MF v132,s5,v132
MF v133,s5,v133
M v[156:159],a[152:155],a[108:111],v[156:159]
SA m0,s28,131072
MF v134,s5,v134
MF v135,s5,v135
M v[156:159],a[148:151],a[100:103],v[156:159]
buffer_load_dwordx4 v3, s[8:11], s26 offen offset:0 sc1 lds
M v[156:159],a[144:147],a[236:239],v[156:159]
s_waitcnt lgkmcnt(6)
MF v148,s5,v148
MF v149,s5,v149
M v[164:167],v[32:35],a[232:235],v[164:167]
T a[144:145],v19,28672
T a[146:147],v19,30720
M v[164:167],v[36:39],a[96:99],v[164:167]
buffer_load_dwordx4 v3, s[8:11], s26 offen offset:1024 sc1 lds
M v[164:167],v[40:43],a[104:107],v[164:167]
s_waitcnt lgkmcnt(2)
s_nop 0
T a[148:149],v19,40960
T a[150:151],v19,43008
M v[164:167],v[44:47],a[112:115],v[164:167]
T a[152:153],v19,45056
T a[154:155],v19,47104
M v[164:167],v[48:51],a[120:123],v[164:167]
buffer_load_dwordx4 v3, s[8:11], s26 offen offset:2048 sc1 lds
M v[164:167],v[52:55],a[128:131],v[164:167]
s_nop 0
T a[156:157],v19,49152
T a[158:159],v19,51200
M v[164:167],v[56:59],a[136:139],v[164:167]
T a[160:161],v19,53248
T a[162:163],v19,55296
M v[172:175],v[56:59],a[140:143],v[172:175]
buffer_load_dwordx4 v3, s[8:11], s26 offen offset:3072 sc1 lds
M v[172:175],v[52:55],a[132:135],v[172:175]
SA m0,s28,135168
T a[164:165],v19,57344
T a[166:167],v19,59392
M v[172:175],v[48:51],a[124:127],v[172:175]
T a[168:169],v19,61440
T a[170:171],v19,63488
M v[172:175],v[44:47],a[116:119],v[172:175]
buffer_load_dwordx4 v4, s[8:11], s26 offen offset:0 sc1 lds
M v[172:175],v[40:43],a[108:111],v[172:175]
MF v150,s5,v150
MF v151,s5,v151
M v[172:175],v[36:39],a[100:103],v[172:175]
s_waitcnt lgkmcnt(0)
buffer_load_dwordx4 v4, s[8:11], s26 offen offset:1024 sc1 lds
M v[172:175],v[32:35],a[236:239],v[172:175]
s_barrier
M v[180:183],a[144:147],a[232:235],v[180:183]
R a[64:67],v2,32768
R a[68:71],v2,33792
M v[180:183],a[148:151],a[96:99],v[180:183]
buffer_load_dwordx4 v4, s[8:11], s26 offen offset:2048 sc1 lds
M v[180:183],a[152:155],a[104:107],v[180:183]
C v132,v132,v133
C v133,v134,v135
M v[180:183],a[156:159],a[112:115],v[180:183]
R a[72:75],v2,34816
R a[76:79],v2,35840
M v[180:183],a[160:163],a[120:123],v[180:183]
buffer_load_dwordx4 v4, s[8:11], s26 offen offset:3072 sc1 lds
M v[180:183],a[164:167],a[128:131],v[180:183]
SA s26,s26,32768
C v134,v148,v149
C v135,v150,v151
M v[180:183],a[168:171],a[136:139],v[180:183]
R a[80:83],v2,36864
R a[84:87],v2,37888
M v[188:191],a[168:171],a[140:143],v[188:191]
W a24,v132
W a25,v133
M v[188:191],a[164:167],a[132:135],v[188:191]
W a26,v134
W a27,v135
M v[188:191],a[160:163],a[124:127],v[188:191]
R a[88:91],v2,38912
R a[92:95],v2,39936
M v[188:191],a[156:159],a[116:119],v[188:191]
MF v140,s5,v140
MF v141,s5,v141
M v[188:191],a[152:155],a[108:111],v[188:191]
MF v142,s5,v142
MF v143,s5,v143
M v[188:191],a[148:151],a[100:103],v[188:191]
MF v156,s5,v156
MF v157,s5,v157
M v[188:191],a[144:147],a[236:239],v[188:191]
s_waitcnt lgkmcnt(0)
MF v158,s5,v158
MF v159,s5,v159
C v140,v140,v141
C v141,v142,v143
C v142,v156,v157
C v143,v158,v159
W a56,v140
W a57,v141
W a58,v142
W a59,v143
s_cmp_eq_u32 s42, 0
s_cbranch_scc1 L_j0
M v[64:67],a[64:67],a[0:3],0
R a[96:99],v2,40960
R a[100:103],v2,41984
M v[64:67],a[68:71],a[4:7],v[64:67]
MF v164,s5,v164
MF v165,s5,v165
M v[64:67],a[72:75],a[8:11],v[64:67]
MF v166,s5,v166
MF v167,s5,v167
M v[64:67],a[76:79],a[12:15],v[64:67]
R a[104:107],v2,43008
R a[108:111],v2,44032
M v[64:67],a[80:83],a[16:19],v[64:67]
MF v180,s5,v180
MF v181,s5,v181
MF v182,s5,v182
MF v183,s5,v183
C v164,v164,v165
C v165,v166,v167
C v166,v180,v181
C v167,v182,v183
W a28,v164
W a29,v165
W a30,v166
W a31,v167
M v[64:67],a[84:87],a[20:23],v[64:67]
MF v172,s5,v172
MF v173,s5,v173
M v[64:67],a[88:91],a[24:27],v[64:67]
R a[112:115],v2,45056
R a[116:119],v2,46080
M v[64:67],a[92:95],a[28:31],v[64:67]
MF v174,s5,v174
MF v175,s5,v175
M v[68:71],a[64:67],a[32:35],0
MF v188,s5,v188
MF v189,s5,v189
M v[68:71],a[68:71],a[36:39],v[68:71]
R a[120:123],v2,47104
R a[124:127],v2,48128
M v[68:71],a[72:75],a[40:43],v[68:71]
SA m0,s28,32768
MF v190,s5,v190
MF v191,s5,v191
M v[68:71],a[76:79],a[44:47],v[68:71]
SA s3,s93,786432
buffer_load_dwordx4 v3, s[8:11], s26 offen offset:0 sc1 lds
M v[68:71],a[80:83],a[48:51],v[68:71]
C v172,v172,v173
C v173,v174,v175
C v174,v188,v189
C v175,v190,v191
W a60,v172
W a61,v173
W a62,v174
W a63,v175
M v[68:71],a[84:87],a[52:55],v[68:71]
E v18,v64
M v[68:71],a[88:91],a[56:59],v[68:71]
buffer_store_dwordx4 v[192:195], v7, s[8:11], s3 offen offset:0 sc1
M v[68:71],a[92:95],a[60:63],v[68:71]
s_waitcnt lgkmcnt(0)
E v19,v65
M v[72:75],a[96:99],a[0:3],0
R a[64:67],v2,49152
R a[68:71],v2,50176
M v[72:75],a[100:103],a[4:7],v[72:75]
buffer_load_dwordx4 v3, s[8:11], s26 offen offset:1024 sc1 lds
M v[72:75],a[104:107],a[8:11],v[72:75]
E v20,v66
M v[72:75],a[108:111],a[12:15],v[72:75]
R a[72:75],v2,51200
R a[76:79],v2,52224
M v[72:75],a[112:115],a[16:19],v[72:75]
buffer_load_dwordx4 v3, s[8:11], s26 offen offset:2048 sc1 lds
M v[72:75],a[116:119],a[20:23],v[72:75]
E v21,v67
M v[72:75],a[120:123],a[24:27],v[72:75]
R a[80:83],v2,53248
R a[84:87],v2,54272
M v[72:75],a[124:127],a[28:31],v[72:75]
buffer_load_dwordx4 v3, s[8:11], s26 offen offset:3072 sc1 lds
M v[76:79],a[124:127],a[60:63],0
SA m0,s28,36864
E v22,v68
M v[76:79],a[120:123],a[56:59],v[76:79]
R a[88:91],v2,55296
R a[92:95],v2,56320
M v[76:79],a[116:119],a[52:55],v[76:79]
buffer_load_dwordx4 v4, s[8:11], s26 offen offset:0 sc1 lds
M v[76:79],a[112:115],a[48:51],v[76:79]
E v23,v69
M v[76:79],a[108:111],a[44:47],v[76:79]
AF v26,v18,v19
C v40,v18,v19
M v[76:79],a[104:107],a[40:43],v[76:79]
buffer_load_dwordx4 v4, s[8:11], s26 offen offset:1024 sc1 lds
M v[76:79],a[100:103],a[36:39],v[76:79]
v_add_u32 v16, 0x20000, v7
AF v26,v20,v26
M v[76:79],a[96:99],a[32:35],v[76:79]
s_waitcnt lgkmcnt(0)
E v24,v70
M v[80:83],a[64:67],a[0:3],0
R a[96:99],v2,57344
R a[100:103],v2,58368
M v[80:83],a[68:71],a[4:7],v[80:83]
buffer_load_dwordx4 v4, s[8:11], s26 offen offset:2048 sc1 lds
M v[80:83],a[72:75],a[8:11],v[80:83]
E v25,v71
M v[80:83],a[76:79],a[12:15],v[80:83]
R a[104:107],v2,59392
R a[108:111],v2,60416
M v[80:83],a[80:83],a[16:19],v[80:83]
buffer_store_dwordx4 v[200:203], v7, s[8:11], s3 offen offset:1024 sc1
M v[80:83],a[84:87],a[20:23],v[80:83]
E v18,v72
M v[80:83],a[88:91],a[24:27],v[80:83]
R a[112:115],v2,61440
R a[116:119],v2,62464
M v[80:83],a[92:95],a[28:31],v[80:83]
buffer_load_dwordx4 v4, s[8:11], s26 offen offset:3072 sc1 lds
M v[84:87],a[92:95],a[60:63],0
SA s26,s26,32768
E v19,v73
M v[84:87],a[88:91],a[56:59],v[84:87]
R a[120:123],v2,63488
R a[124:127],v2,64512
M v[84:87],a[84:87],a[52:55],v[84:87]
C v41,v20,v21
AF v26,v21,v26
M v[84:87],a[80:83],a[48:51],v[84:87]
buffer_store_dwordx4 v[208:211], v7, s[8:11], s3 offen offset:2048 sc1
M v[84:87],a[76:79],a[44:47],v[84:87]
E v20,v74
M v[84:87],a[72:75],a[40:43],v[84:87]
AF v27,v22,v23
C v44,v22,v23
M v[84:87],a[68:71],a[36:39],v[84:87]
s_waitcnt vmcnt(24) lgkmcnt(0)
E v21,v75
M v[84:87],a[64:67],a[32:35],v[84:87]
s_barrier
M v[88:91],a[96:99],a[0:3],0
R a[64:67],v2,0
R a[68:71],v2,1024
M v[88:91],a[100:103],a[4:7],v[88:91]
E v22,v76
M v[88:91],a[104:107],a[8:11],v[88:91]
AF v27,v24,v27
C v45,v24,v25
M v[88:91],a[108:111],a[12:15],v[88:91]
R a[72:75],v2,2048
R a[76:79],v2,3072
M v[88:91],a[112:115],a[16:19],v[88:91]
E v23,v77
M v[88:91],a[116:119],a[20:23],v[88:91]
AF v27,v25,v27
AF v26,v18,v26
M v[88:91],a[120:123],a[24:27],v[88:91]
R a[80:83],v2,4096
R a[84:87],v2,5120
M v[88:91],a[124:127],a[28:31],v[88:91]
E v24,v78
M v[92:95],a[124:127],a[60:63],0
C v42,v18,v19
AF v26,v19,v26
M v[92:95],a[120:123],a[56:59],v[92:95]
R a[88:91],v2,6144
R a[92:95],v2,7168
M v[92:95],a[116:119],a[52:55],v[92:95]
E v25,v79
M v[92:95],a[112:115],a[48:51],v[92:95]
AF v26,v20,v26
C v43,v20,v21
M v[92:95],a[108:111],a[44:47],v[92:95]
AF v26,v21,v26
AF v27,v22,v27
M v[92:95],a[104:107],a[40:43],v[92:95]
C v46,v22,v23
AF v27,v23,v27
M v[92:95],a[100:103],a[36:39],v[92:95]
s_waitcnt lgkmcnt(0)
AF v27,v24,v27
C v47,v24,v25
M v[92:95],a[96:99],a[32:35],v[92:95]
AF v27,v25,v27
M v[96:99],a[64:67],a[0:3],0
R a[96:99],v2,8192
R a[100:103],v2,9216
M v[96:99],a[68:71],a[4:7],v[96:99]
SA m0,s28,98304
E v18,v80
M v[96:99],a[72:75],a[8:11],v[96:99]
buffer_load_dwordx4 v3, s[8:11], s21 offen offset:0 sc1 lds
M v[96:99],a[76:79],a[12:15],v[96:99]
R a[104:107],v2,10240
R a[108:111],v2,11264
M v[96:99],a[80:83],a[16:19],v[96:99]
v_mov_b32 v30, 0
M v[96:99],a[84:87],a[20:23],v[96:99]
E v19,v81
M v[96:99],a[88:91],a[24:27],v[96:99]
R a[112:115],v2,12288
R a[116:119],v2,13312
M v[96:99],a[92:95],a[28:31],v[96:99]
buffer_load_dwordx4 v3, s[8:11], s21 offen offset:1024 sc1 lds
M v[100:103],a[92:95],a[60:63],0
v_mov_b32 v31, 0
AF v26,v18,v26
M v[100:103],a[88:91],a[56:59],v[100:103]
R a[120:123],v2,14336
R a[124:127],v2,15360
M v[100:103],a[84:87],a[52:55],v[100:103]
SA s3,s93,786432
E v20,v82
M v[100:103],a[80:83],a[48:51],v[100:103]
buffer_load_dwordx4 v3, s[8:11], s21 offen offset:2048 sc1 lds
M v[100:103],a[76:79],a[44:47],v[100:103]
E v21,v83
M v[100:103],a[72:75],a[40:43],v[100:103]
v_mov_b32 v32, 0
C v56,v18,v19
M v[100:103],a[68:71],a[36:39],v[100:103]
buffer_store_dwordx4 v[216:219], v7, s[8:11], s3 offen offset:3072 sc1
M v[100:103],a[64:67],a[32:35],v[100:103]
s_waitcnt lgkmcnt(0)
E v22,v88
M v[108:111],a[96:99],a[32:35],0
R a[64:67],v2,16384
R a[68:71],v2,17408
M v[108:111],a[100:103],a[36:39],v[108:111]
buffer_load_dwordx4 v3, s[8:11], s21 offen offset:3072 sc1 lds
M v[108:111],a[104:107],a[40:43],v[108:111]
SA m0,s28,102400
v_mov_b32 v33, 0
AF v26,v19,v26
M v[108:111],a[108:111],a[44:47],v[108:111]
R a[72:75],v2,18432
R a[76:79],v2,19456
M v[108:111],a[112:115],a[48:51],v[108:111]
buffer_load_dwordx4 v4, s[8:11], s21 offen offset:0 sc1 lds
M v[108:111],a[116:119],a[52:55],v[108:111]
E v23,v89
M v[108:111],a[120:123],a[56:59],v[108:111]
R a[80:83],v2,20480
R a[84:87],v2,21504
M v[108:111],a[124:127],a[60:63],v[108:111]
buffer_load_dwordx4 v4, s[8:11], s21 offen offset:1024 sc1 lds
M v[104:107],a[124:127],a[28:31],0
v_mov_b32 v34, 0
AF v26,v20,v26
M v[104:107],a[120:123],a[24:27],v[104:107]
SA s3,s93,794624
R a[88:91],v2,22528
R a[92:95],v2,23552
M v[104:107],a[116:119],a[20:23],v[104:107]
buffer_load_dwordx4 v4, s[8:11], s21 offen offset:2048 sc1 lds
M v[104:107],a[112:115],a[16:19],v[104:107]
v_mov_b32 v35, 0
C v57,v20,v21
M v[104:107],a[108:111],a[12:15],v[104:107]
E v24,v90
M v[104:107],a[104:107],a[8:11],v[104:107]
E v25,v91
M v[104:107],a[100:103],a[4:7],v[104:107]
buffer_load_dwordx4 v4, s[8:11], s21 offen offset:3072 sc1 lds
M v[104:107],a[96:99],a[0:3],v[104:107]
s_waitcnt lgkmcnt(0)
v_mov_b32 v36, 0
AF v26,v21,v26
M v[112:115],a[64:67],a[0:3],0
SA s21,s21,32768
R a[96:99],v2,24576
R a[100:103],v2,25600
M v[112:115],a[68:71],a[4:7],v[112:115]
s_sub_u32 s22, s22, 1
buffer_store_dwordx4 v[224:227], v7, s[8:11], s3 offen offset:0 sc1
M v[112:115],a[72:75],a[8:11],v[112:115]
s_cselect_b32 s21, s23, s21
E v18,v84
M v[112:115],a[76:79],a[12:15],v[112:115]
R a[104:107],v2,26624
R a[108:111],v2,27648
M v[112:115],a[80:83],a[16:19],v[112:115]
v_mov_b32 v37, 0
AF v26,v22,v26
M v[112:115],a[84:87],a[20:23],v[112:115]
E v19,v85
M v[112:115],a[88:91],a[24:27],v[112:115]
R a[112:115],v2,28672
R a[116:119],v2,29696
M v[112:115],a[92:95],a[28:31],v[112:115]
E v20,v86
M v[116:119],a[92:95],a[60:63],0
v_mov_b32 v38, 0
C v58,v22,v23
M v[116:119],a[88:91],a[56:59],v[116:119]
R a[120:123],v2,30720
R a[124:127],v2,31744
M v[116:119],a[84:87],a[52:55],v[116:119]
E v21,v87
M v[116:119],a[80:83],a[48:51],v[116:119]
buffer_store_dwordx4 v[232:235], v7, s[8:11], s3 offen offset:1024 sc1
M v[116:119],a[76:79],a[44:47],v[116:119]
AF v26,v23,v26
AF v26,v24,v26
M v[116:119],a[72:75],a[40:43],v[116:119]
v_mov_b32 v39, 0
C v59,v24,v25
M v[116:119],a[68:71],a[36:39],v[116:119]
s_waitcnt vmcnt(22) lgkmcnt(0)
E v22,v92
M v[116:119],a[64:67],a[32:35],v[116:119]
s_barrier
M v[124:127],a[96:99],a[32:35],0
R a[64:67],v16,0
R a[68:71],v16,1024
M v[124:127],a[100:103],a[36:39],v[124:127]
E v23,v93
M v[124:127],a[104:107],a[40:43],v[124:127]
AF v26,v25,v26
AF v27,v18,v27
M v[124:127],a[108:111],a[44:47],v[124:127]
R a[72:75],v16,2048
R a[76:79],v16,3072
M v[124:127],a[112:115],a[48:51],v[124:127]
E v24,v94
M v[124:127],a[116:119],a[52:55],v[124:127]
E v25,v95
M v[124:127],a[120:123],a[56:59],v[124:127]
R a[80:83],v16,4096
R a[84:87],v16,5120
M v[124:127],a[124:127],a[60:63],v[124:127]
C v60,v18,v19
AF v27,v19,v27
M v[120:123],a[124:127],a[28:31],0
AF v27,v20,v27
C v61,v20,v21
M v[120:123],a[120:123],a[24:27],v[120:123]
R a[88:91],v16,6144
R a[92:95],v16,7168
M v[120:123],a[116:119],a[20:23],v[120:123]
AF v27,v21,v27
AF v27,v22,v27
M v[120:123],a[112:115],a[16:19],v[120:123]
C v62,v22,v23
AF v27,v23,v27
M v[120:123],a[108:111],a[12:15],v[120:123]
AF v27,v24,v27
C v63,v24,v25
M v[120:123],a[104:107],a[8:11],v[120:123]
AF v27,v25,v27
M v[120:123],a[100:103],a[4:7],v[120:123]
s_waitcnt lgkmcnt(0)
M v[120:123],a[96:99],a[0:3],v[120:123]
v_max_f32 v10, v26, v27
v_min_f32 v11, v26, v27
v_cmp_lt_f32 vcc, s31, v10
v_cmp_gt_f32 s[64:65], s24, v11
s_nop 0
s_or_b64 vcc, vcc, s[64:65]
s_cbranch_vccnz L_stk1
L_rtk1:
M v[128:131],a[64:67],v[40:43],0
R a[96:99],v16,8192
R a[100:103],v16,9216
M v[128:131],a[68:71],v[56:59],v[128:131]
SA m0,s28,65536
E v18,v96
M v[132:135],a[68:71],v[60:63],0
buffer_load_dwordx4 v3, s[8:11], s21 offen offset:0 sc1 lds
M v[132:135],a[64:67],v[44:47],v[132:135]
R a[104:107],v16,10240
R a[108:111],v16,11264
M v[140:143],a[72:75],v[44:47],0
SA s3,s93,794624
E v19,v97
M v[140:143],a[76:79],v[60:63],v[140:143]
AF v30,v26,v30
AF v31,v27,v31
M v[136:139],a[76:79],v[56:59],0
R a[112:115],v16,12288
R a[116:119],v16,13312
M v[136:139],a[72:75],v[40:43],v[136:139]
buffer_load_dwordx4 v3, s[8:11], s21 offen offset:1024 sc1 lds
M v[144:147],a[80:83],v[40:43],0
E v20,v98
M v[144:147],a[84:87],v[56:59],v[144:147]
R a[120:123],v16,14336
R a[124:127],v16,15360
M v[148:151],a[84:87],v[60:63],0
buffer_store_dwordx4 v[240:243], v7, s[8:11], s3 offen offset:2048 sc1
M v[148:151],a[80:83],v[44:47],v[148:151]
E v21,v99
M v[156:159],a[88:91],v[44:47],0
AF v28,v18,v19
C v48,v18,v19
M v[156:159],a[92:95],v[60:63],v[156:159]
buffer_load_dwordx4 v3, s[8:11], s21 offen offset:2048 sc1 lds
M v[152:155],a[92:95],v[56:59],0
AF v28,v20,v28
C v49,v20,v21
M v[152:155],a[88:91],v[40:43],v[152:155]
s_waitcnt lgkmcnt(0)
E v22,v104
M v[160:163],a[96:99],v[40:43],0
R a[64:67],v16,16384
R a[68:71],v16,17408
M v[160:163],a[100:103],v[56:59],v[160:163]
buffer_load_dwordx4 v3, s[8:11], s21 offen offset:3072 sc1 lds
M v[164:167],a[100:103],v[60:63],0
SA m0,s28,69632
E v23,v105
M v[164:167],a[96:99],v[44:47],v[164:167]
R a[72:75],v16,18432
R a[76:79],v16,19456
M v[172:175],a[104:107],v[44:47],0
buffer_load_dwordx4 v4, s[8:11], s21 offen offset:0 sc1 lds
M v[172:175],a[108:111],v[60:63],v[172:175]
AF v28,v21,v28
AF v28,v22,v28
M v[168:171],a[108:111],v[56:59],0
R a[80:83],v16,20480
R a[84:87],v16,21504
M v[168:171],a[104:107],v[40:43],v[168:171]
buffer_store_dwordx4 v[248:251], v7, s[8:11], s3 offen offset:3072 sc1
M v[176:179],a[112:115],v[40:43],0
E v24,v106
M v[176:179],a[116:119],v[56:59],v[176:179]
R a[88:91],v16,22528
R a[92:95],v16,23552
M v[180:183],a[116:119],v[60:63],0
buffer_load_dwordx4 v4, s[8:11], s21 offen offset:1024 sc1 lds
M v[180:183],a[112:115],v[44:47],v[180:183]
E v25,v107
M v[188:191],a[120:123],v[44:47],0
C v50,v22,v23
AF v28,v23,v28
M v[188:191],a[124:127],v[60:63],v[188:191]
buffer_load_dwordx4 v4, s[8:11], s21 offen offset:2048 sc1 lds
M v[184:187],a[124:127],v[56:59],0
E v18,v100
M v[184:187],a[120:123],v[40:43],v[184:187]
s_waitcnt lgkmcnt(0)
AF v28,v24,v28
C v51,v24,v25
M v[192:195],a[64:67],v[40:43],0
R a[96:99],v16,24576
R a[100:103],v16,25600
M v[192:195],a[68:71],v[56:59],v[192:195]
buffer_load_dwordx4 v4, s[8:11], s21 offen offset:3072 sc1 lds
M v[196:199],a[68:71],v[60:63],0
SA s21,s21,32768
E v19,v101
M v[196:199],a[64:67],v[44:47],v[196:199]
s_sub_u32 s22, s22, 1
R a[104:107],v16,26624
R a[108:111],v16,27648
M v[204:207],a[72:75],v[44:47],0
s_cselect_b32 s21, s23, s21
AF v28,v25,v28
AF v29,v18,v19
M v[204:207],a[76:79],v[60:63],v[204:207]
E v20,v102
M v[200:203],a[76:79],v[56:59],0
R a[112:115],v16,28672
R a[116:119],v16,29696
M v[200:203],a[72:75],v[40:43],v[200:203]
C v52,v18,v19
M v[208:211],a[80:83],v[40:43],0
M v[208:211],a[84:87],v[56:59],v[208:211]
R a[120:123],v16,30720
R a[124:127],v16,31744
M v[212:215],a[84:87],v[60:63],0
E v21,v103
M v[212:215],a[80:83],v[44:47],v[212:215]
AF v29,v20,v29
C v53,v20,v21
M v[220:223],a[88:91],v[44:47],0
AF v29,v21,v29
M v[220:223],a[92:95],v[60:63],v[220:223]
E v22,v108
M v[216:219],a[92:95],v[56:59],0
s_waitcnt vmcnt(12) lgkmcnt(0)
M v[216:219],a[88:91],v[40:43],v[216:219]
s_barrier
M v[224:227],a[96:99],v[40:43],0
R a[64:67],v2,32768
R a[68:71],v2,33792
M v[224:227],a[100:103],v[56:59],v[224:227]
E v23,v109
M v[228:231],a[100:103],v[60:63],0
AF v29,v22,v29
C v54,v22,v23
M v[228:231],a[96:99],v[44:47],v[228:231]
R a[72:75],v2,34816
R a[76:79],v2,35840
M v[236:239],a[104:107],v[44:47],0
E v24,v110
M v[236:239],a[108:111],v[60:63],v[236:239]
AF v29,v23,v29
M v[232:235],a[108:111],v[56:59],0
R a[80:83],v2,36864
R a[84:87],v2,37888
M v[232:235],a[104:107],v[40:43],v[232:235]
M v[240:243],a[112:115],v[40:43],0
E v25,v111
M v[240:243],a[116:119],v[56:59],v[240:243]
R a[88:91],v2,38912
R a[92:95],v2,39936
M v[244:247],a[116:119],v[60:63],0
AF v29,v24,v29
C v55,v24,v25
M v[244:247],a[112:115],v[44:47],v[244:247]
AF v29,v25,v29
M v[252:255],a[120:123],v[44:47],0
M v[252:255],a[124:127],v[60:63],v[252:255]
M v[248:251],a[124:127],v[56:59],0
s_waitcnt lgkmcnt(0)
M v[248:251],a[120:123],v[40:43],v[248:251]
s_cmp_lg_u32 s27, 0
s_cbranch_scc1 L_loop_top
s_branch L_d1s
L_j0:
M v[68:71],a[64:67],a[32:35],0
s_cmp_lt_u32 s20, 0
R a[96:99],v2,40960
R a[100:103],v2,41984
M v[68:71],a[68:71],a[36:39],v[68:71]
s_cselect_b64 s[82:83], -1, 0
v_mov_b32 v30, 0
MF v172,s5,v172
M v[68:71],a[72:75],a[40:43],v[68:71]
s_cmp_eq_u32 s20, 0
MF v173,s5,v173
MF v174,s5,v174
M v[68:71],a[76:79],a[44:47],v[68:71]
s_cselect_b64 s[66:67], s[16:17], s[82:83]
R a[104:107],v2,43008
R a[108:111],v2,44032
M v[68:71],a[80:83],a[48:51],v[68:71]
s_cselect_b64 s[68:69], s[18:19], s[82:83]
MF v175,s5,v175
MF v188,s5,v188
M v[68:71],a[84:87],a[52:55],v[68:71]
s_cselect_b64 s[70:71], s[48:49], s[82:83]
MF v189,s5,v189
MF v190,s5,v190
MF v191,s5,v191
C v172,v172,v173
C v173,v174,v175
C v174,v188,v189
C v175,v190,v191
W a60,v172
W a61,v173
W a62,v174
W a63,v175
M v[68:71],a[88:91],a[56:59],v[68:71]
s_cselect_b64 s[72:73], s[50:51], s[82:83]
R a[112:115],v2,45056
R a[116:119],v2,46080
v_cndmask_b32 v64, 0, v8, s[66:67]
v_cndmask_b32 v65, 0, v8, s[68:69]
v_cndmask_b32 v66, 0, v8, s[70:71]
v_cndmask_b32 v67, 0, v8, s[72:73]
M v[68:71],a[92:95],a[60:63],v[68:71]
s_cmp_lt_u32 s20, 1
MF v164,s5,v164
MF v165,s5,v165
M v[64:67],a[64:67],a[0:3],v[64:67]
s_cselect_b64 s[82:83], -1, 0
MF v166,s5,v166
MF v167,s5,v167
M v[64:67],a[68:71],a[4:7],v[64:67]
s_cmp_eq_u32 s20, 1
R a[120:123],v2,47104
R a[124:127],v2,48128
M v[64:67],a[72:75],a[8:11],v[64:67]
s_cselect_b64 s[74:75], s[16:17], s[82:83]
MF v180,s5,v180
MF v181,s5,v181
M v[64:67],a[76:79],a[12:15],v[64:67]
s_cselect_b64 s[76:77], s[18:19], s[82:83]
MF v182,s5,v182
MF v183,s5,v183
M v[64:67],a[80:83],a[16:19],v[64:67]
s_cselect_b64 s[78:79], s[48:49], s[82:83]
C v164,v164,v165
C v165,v166,v167
C v166,v180,v181
C v167,v182,v183
W a28,v164
W a29,v165
W a30,v166
W a31,v167
M v[64:67],a[84:87],a[20:23],v[64:67]
s_cselect_b64 s[80:81], s[50:51], s[82:83]
v_mov_b32 v31, 0
v_cndmask_b32 v72, 0, v8, s[74:75]
M v[64:67],a[88:91],a[24:27],v[64:67]
s_mov_b32 s26, s43
v_mov_b32 v32, 0
M v[64:67],a[92:95],a[28:31],v[64:67]
s_waitcnt lgkmcnt(0)
v_cndmask_b32 v73, 0, v8, s[76:77]
M v[76:79],a[96:99],a[32:35],0
SA m0,s28,0
R a[64:67],v2,49152
R a[68:71],v2,50176
M v[76:79],a[100:103],a[36:39],v[76:79]
SA s3,s93,786432
buffer_load_dwordx4 v3, s[8:11], s26 offen offset:0 sc1 lds
M v[76:79],a[104:107],a[40:43],v[76:79]
v_cndmask_b32 v74, 0, v8, s[78:79]
v_mov_b32 v33, 0
M v[76:79],a[108:111],a[44:47],v[76:79]
R a[72:75],v2,51200
R a[76:79],v2,52224
M v[76:79],a[112:115],a[48:51],v[76:79]
buffer_store_dwordx4 v[192:195], v7, s[8:11], s3 offen offset:0 sc1
M v[76:79],a[116:119],a[52:55],v[76:79]
v_cndmask_b32 v75, 0, v8, s[80:81]
M v[76:79],a[120:123],a[56:59],v[76:79]
s_cmp_lt_u32 s20, 2
R a[80:83],v2,53248
R a[84:87],v2,54272
M v[76:79],a[124:127],a[60:63],v[76:79]
s_cselect_b64 s[82:83], -1, 0
buffer_load_dwordx4 v3, s[8:11], s26 offen offset:1024 sc1 lds
M v[72:75],a[124:127],a[28:31],v[72:75]
s_cmp_eq_u32 s20, 2
E v18,v68
M v[72:75],a[120:123],a[24:27],v[72:75]
s_cselect_b64 s[66:67], s[16:17], s[82:83]
R a[88:91],v2,55296
R a[92:95],v2,56320
M v[72:75],a[116:119],a[20:23],v[72:75]
s_cselect_b64 s[68:69], s[18:19], s[82:83]
buffer_load_dwordx4 v3, s[8:11], s26 offen offset:2048 sc1 lds
M v[72:75],a[112:115],a[16:19],v[72:75]
s_cselect_b64 s[70:71], s[48:49], s[82:83]
v_mov_b32 v34, 0
M v[72:75],a[108:111],a[12:15],v[72:75]
s_cselect_b64 s[72:73], s[50:51], s[82:83]
v_cndmask_b32 v80, 0, v8, s[66:67]
v_cndmask_b32 v81, 0, v8, s[68:69]
M v[72:75],a[104:107],a[8:11],v[72:75]
buffer_store_dwordx4 v[200:203], v7, s[8:11], s3 offen offset:1024 sc1
M v[72:75],a[100:103],a[4:7],v[72:75]
E v19,v69
M v[72:75],a[96:99],a[0:3],v[72:75]
s_waitcnt lgkmcnt(0)
buffer_load_dwordx4 v3, s[8:11], s26 offen offset:3072 sc1 lds
M v[84:87],a[64:67],a[32:35],0
SA m0,s28,4096
R a[96:99],v2,57344
R a[100:103],v2,58368
M v[84:87],a[68:71],a[36:39],v[84:87]
v_cndmask_b32 v82, 0, v8, s[70:71]
v_mov_b32 v35, 0
M v[84:87],a[72:75],a[40:43],v[84:87]
buffer_load_dwordx4 v4, s[8:11], s26 offen offset:0 sc1 lds
M v[84:87],a[76:79],a[44:47],v[84:87]
R a[104:107],v2,59392
R a[108:111],v2,60416
M v[84:87],a[80:83],a[48:51],v[84:87]
buffer_store_dwordx4 v[208:211], v7, s[8:11], s3 offen offset:2048 sc1
M v[84:87],a[84:87],a[52:55],v[84:87]
v_cndmask_b32 v83, 0, v8, s[72:73]
v_mov_b32 v36, 0
M v[84:87],a[88:91],a[56:59],v[84:87]
s_cmp_lt_u32 s20, 3
R a[112:115],v2,61440
R a[116:119],v2,62464
M v[84:87],a[92:95],a[60:63],v[84:87]
s_cselect_b64 s[82:83], -1, 0
buffer_load_dwordx4 v4, s[8:11], s26 offen offset:1024 sc1 lds
M v[80:83],a[92:95],a[28:31],v[80:83]
s_cmp_eq_u32 s20, 3
E v20,v70
M v[80:83],a[88:91],a[24:27],v[80:83]
s_cselect_b64 s[74:75], s[16:17], s[82:83]
R a[120:123],v2,63488
R a[124:127],v2,64512
M v[80:83],a[84:87],a[20:23],v[80:83]
s_cselect_b64 s[76:77], s[18:19], s[82:83]
buffer_load_dwordx4 v4, s[8:11], s26 offen offset:2048 sc1 lds
M v[80:83],a[80:83],a[16:19],v[80:83]
s_cselect_b64 s[78:79], s[48:49], s[82:83]
E v21,v71
M v[80:83],a[76:79],a[12:15],v[80:83]
s_cselect_b64 s[80:81], s[50:51], s[82:83]
buffer_store_dwordx4 v[216:219], v7, s[8:11], s3 offen offset:3072 sc1
M v[80:83],a[72:75],a[8:11],v[80:83]
SA s3,s93,794624
v_cndmask_b32 v88, 0, v8, s[74:75]
v_cndmask_b32 v89, 0, v8, s[76:77]
M v[80:83],a[68:71],a[4:7],v[80:83]
s_waitcnt vmcnt(24) lgkmcnt(0)
buffer_load_dwordx4 v4, s[8:11], s26 offen offset:3072 sc1 lds
M v[80:83],a[64:67],a[0:3],v[80:83]
s_barrier
M v[92:95],a[96:99],a[32:35],0
R a[64:67],v2,0
R a[68:71],v2,1024
M v[92:95],a[100:103],a[36:39],v[92:95]
buffer_store_dwordx4 v[224:227], v7, s[8:11], s3 offen offset:0 sc1
M v[92:95],a[104:107],a[40:43],v[92:95]
v_min_u32 v17, 896, v9
v_cndmask_b32 v90, 0, v8, s[78:79]
M v[92:95],a[108:111],a[44:47],v[92:95]
R a[72:75],v2,2048
R a[76:79],v2,3072
M v[92:95],a[112:115],a[48:51],v[92:95]
buffer_load_dword v5, v17, s[8:11], s46 offen sc1
M v[92:95],a[116:119],a[52:55],v[92:95]
buffer_store_dwordx4 v[232:235], v7, s[8:11], s3 offen offset:1024 sc1
M v[92:95],a[120:123],a[56:59],v[92:95]
R a[80:83],v2,4096
R a[84:87],v2,5120
v_cndmask_b32 v91, 0, v8, s[80:81]
M v[92:95],a[124:127],a[60:63],v[92:95]
v_mov_b32 v37, 0
v_mov_b32 v38, 0
M v[88:91],a[124:127],a[28:31],v[88:91]
buffer_store_dwordx4 v[240:243], v7, s[8:11], s3 offen offset:2048 sc1
M v[88:91],a[120:123],a[24:27],v[88:91]
R a[88:91],v2,6144
R a[92:95],v2,7168
M v[88:91],a[116:119],a[20:23],v[88:91]
v_mov_b32 v39, 0
AF v27,v18,v19
M v[88:91],a[112:115],a[16:19],v[88:91]
buffer_store_dwordx4 v[248:251], v7, s[8:11], s3 offen offset:3072 sc1
M v[88:91],a[108:111],a[12:15],v[88:91]
E v22,v64
M v[88:91],a[104:107],a[8:11],v[88:91]
E v23,v65
M v[88:91],a[100:103],a[4:7],v[88:91]
s_waitcnt lgkmcnt(0)
E v24,v66
M v[88:91],a[96:99],a[0:3],v[88:91]
E v25,v67
C v44,v18,v19
AF v27,v20,v27
C v45,v20,v21
AF v27,v21,v27
AF v26,v22,v23
C v40,v22,v23
E v18,v76
E v19,v77
AF v26,v24,v26
C v41,v24,v25
AF v26,v25,v26
E v20,v78
E v21,v79
AF v27,v18,v27
C v46,v18,v19
AF v27,v19,v27
E v22,v72
E v23,v73
AF v27,v20,v27
C v47,v20,v21
AF v27,v21,v27
E v24,v74
E v25,v75
AF v26,v22,v26
C v42,v22,v23
AF v26,v23,v26
AF v26,v24,v26
C v43,v24,v25
AF v26,v25,v26
v_mov_b32 v56, 0
v_mov_b32 v57, 0
v_mov_b32 v58, 0
v_mov_b32 v59, 0
s_mul_i32 s21, s41, 1048576
SA s21,s21,589824
s_lshl_b32 s84, s42, 1
s_sub_u32 s22, 11, s84
s_mov_b32 s23, 536870912
s_lshl_b32 s86, s20, 14
SA s86,s86,s34
SA s87,s86,4096
SA s88,s86,8192
SA s89,s86,12288
s_lshl_b32 s90, s20, 10
SA s90,s90,s34
SA s90,s90,65536
s_waitcnt vmcnt(3)
v_cmp_gt_u32 vcc, 2, v5
s_nop 0
s_cbranch_vccnz L_lsj0
L_lrj0:
SA m0,s28,98304
v_mov_b32 v10, v26
buffer_load_dwordx4 v3, s[8:11], s21 offen offset:0 sc1 lds
v_mov_b32 v11, v27
buffer_load_dwordx4 v3, s[8:11], s21 offen offset:1024 sc1 lds
v_mov_b32 v12, v10
v_mov_b32 v13, v11
buffer_load_dwordx4 v3, s[8:11], s21 offen offset:2048 sc1 lds
v_permlane16_swap_b32 v12, v10
v_permlane16_swap_b32 v13, v11
buffer_load_dwordx4 v3, s[8:11], s21 offen offset:3072 sc1 lds
v_max_f32 v10, v12, v10
SA m0,s28,102400
v_max_f32 v11, v13, v11
buffer_load_dwordx4 v4, s[8:11], s21 offen offset:0 sc1 lds
v_mov_b32 v12, v10
v_mov_b32 v13, v11
buffer_load_dwordx4 v4, s[8:11], s21 offen offset:1024 sc1 lds
v_permlane32_swap_b32 v12, v10
v_permlane32_swap_b32 v13, v11
buffer_load_dwordx4 v4, s[8:11], s21 offen offset:2048 sc1 lds
v_max_f32 v10, v12, v10
v_max_f32 v11, v13, v11
buffer_load_dwordx4 v4, s[8:11], s21 offen offset:3072 sc1 lds
SA s21,s21,32768
s_sub_u32 s22, s22, 1
s_cselect_b32 s21, s23, s21
v_min_f32 v10, v10, v11
v_cmp_gt_f32 vcc, s24, v10
s_nop 0
s_cbranch_vccnz L_stj0
L_rtj0:
s_cmp_gt_u32 s20, 3
s_cselect_b64 s[82:83], -1, 0
s_cmp_eq_u32 s20, 3
s_cselect_b64 s[66:67], s[16:17], s[82:83]
v_mfma_f32_32x32x16_bf16 v[128:143], v[56:59], v[56:59], 0
s_cselect_b64 s[68:69], s[18:19], s[82:83]
s_cselect_b64 s[70:71], s[48:49], s[82:83]
s_cselect_b64 s[72:73], s[50:51], s[82:83]
v_cndmask_b32 v100, v36, v8, s[66:67]
v_mfma_f32_32x32x16_bf16 v[144:159], v[56:59], v[56:59], 0
v_cndmask_b32 v101, v36, v8, s[68:69]
v_cndmask_b32 v102, v36, v8, s[70:71]
v_cndmask_b32 v103, v36, v8, s[72:73]
s_cmp_gt_u32 s20, 2
v_mfma_f32_32x32x16_bf16 v[160:175], v[56:59], v[56:59], 0
s_cselect_b64 s[82:83], -1, 0
s_cmp_eq_u32 s20, 2
s_cselect_b64 s[74:75], s[16:17], s[82:83]
s_cselect_b64 s[76:77], s[18:19], s[82:83]
v_mfma_f32_32x32x16_bf16 v[176:191], v[56:59], v[56:59], 0
s_cselect_b64 s[78:79], s[48:49], s[82:83]
s_cselect_b64 s[80:81], s[50:51], s[82:83]
v_cndmask_b32 v108, v36, v8, s[74:75]
v_cndmask_b32 v109, v36, v8, s[76:77]
v_mfma_f32_32x32x16_bf16 v[192:207], v[56:59], v[56:59], 0
v_cndmask_b32 v110, v36, v8, s[78:79]
v_cndmask_b32 v111, v36, v8, s[80:81]
s_cmp_gt_u32 s20, 1
s_cselect_b64 s[82:83], -1, 0
v_mfma_f32_32x32x16_bf16 v[208:223], v[56:59], v[56:59], 0
s_cmp_eq_u32 s20, 1
s_cselect_b64 s[66:67], s[16:17], s[82:83]
s_cselect_b64 s[68:69], s[18:19], s[82:83]
s_cselect_b64 s[70:71], s[48:49], s[82:83]
v_mfma_f32_32x32x16_bf16 v[224:239], v[56:59], v[56:59], 0
s_cselect_b64 s[72:73], s[50:51], s[82:83]
v_cndmask_b32 v116, v36, v8, s[66:67]
v_cndmask_b32 v117, v36, v8, s[68:69]
v_cndmask_b32 v118, v36, v8, s[70:71]
v_mfma_f32_32x32x16_bf16 v[240:255], v[56:59], v[56:59], 0
v_cndmask_b32 v119, v36, v8, s[72:73]
s_cmp_gt_u32 s20, 0
s_cselect_b64 s[82:83], -1, 0
s_cmp_eq_u32 s20, 0
s_cselect_b64 s[74:75], s[16:17], s[82:83]
s_cselect_b64 s[76:77], s[18:19], s[82:83]
s_cselect_b64 s[78:79], s[48:49], s[82:83]
s_cselect_b64 s[80:81], s[50:51], s[82:83]
v_cndmask_b32 v124, v36, v8, s[74:75]
v_cndmask_b32 v125, v36, v8, s[76:77]
v_cndmask_b32 v126, v36, v8, s[78:79]
v_cndmask_b32 v127, v36, v8, s[80:81]
s_branch L_d3h
.p2align 12
L_kv1:
s_and_b32 s31, s42, 7
s_lshl_b32 s30, s41, 3
SA s30,s30,s31
s_lshl_b32 s64, s30, 2
SA s64,s64,s20
s_mul_i32 s72, s64, 3584
v_mov_b32 v32, 536870912
v_cmp_gt_u32 vcc, 56, v0
s_lshl_b32 s67, s64, 2
s_nop 0
v_cndmask_b32 v32, v32, v7, vcc
buffer_load_dwordx4 a[176:179], v32, s[56:59], s72 offen offset:0
buffer_load_dwordx4 a[180:183], v32, s[56:59], s72 offen offset:896
buffer_load_dwordx4 a[184:187], v32, s[56:59], s72 offen offset:1792
buffer_load_dwordx4 a[188:191], v32, s[56:59], s72 offen offset:2688
buffer_load_dwordx4 a[192:195], v32, s[60:63], 0 offen
buffer_load_dwordx4 a[196:199], v32, s[68:71], 0 offen
SA m0,s24,16384
s_nop 0
buffer_load_dwordx4 v12, s[48:51], s22 offen offset:0   lds
buffer_load_dwordx4 v13, s[48:51], s22 offen offset:1024   lds
buffer_load_dwordx4 v14, s[48:51], s22 offen offset:2048   lds
buffer_load_dwordx4 v15, s[48:51], s22 offen offset:3072   lds
s_sub_u32 s22, s22, 1048448
SA m0,s23,32768
s_nop 0
buffer_load_dwordx4 v8, s[16:19], s21 offen offset:0  nt lds
buffer_load_dwordx4 v9, s[16:19], s21 offen offset:1024  nt lds
buffer_load_dwordx4 v10, s[16:19], s21 offen offset:2048  nt lds
buffer_load_dwordx4 v11, s[16:19], s21 offen offset:3072  nt lds
SA s21,s21,128
s_mov_b64 exec, 0
s_cmp_eq_u32 s20, 0
s_cbranch_scc1 L_w_kv11
s_cmp_eq_u32 s20, 1
s_cbranch_scc1 L_w_kv12
s_cmp_eq_u32 s20, 2
s_cbranch_scc1 L_w_kv13
s_branch L_w_kv14
L_wd2:
s_mov_b64 exec, -1
s_waitcnt vmcnt(14) lgkmcnt(0)
s_barrier
R a[160:163],v5,0
R a[164:167],v6,0
T a[96:97],v1,0
T a[98:99],v1,1024
T a[100:101],v1,8192
T a[102:103],v1,9216
T a[104:105],v2,0
T a[106:107],v2,1024
T a[108:109],v2,8192
T a[110:111],v2,9216
T a[112:113],v3,0
T a[114:115],v3,1024
T a[116:117],v3,8192
T a[118:119],v3,9216
T a[120:121],v4,0
T a[122:123],v4,1024
T a[124:125],v4,8192
T a[126:127],v4,9216
T a[128:129],v1,16384
T a[130:131],v1,17408
T a[132:133],v1,24576
T a[134:135],v1,25600
T a[136:137],v2,16384
T a[138:139],v2,17408
T a[140:141],v2,24576
T a[142:143],v2,25600
T a[144:145],v3,16384
T a[146:147],v3,17408
T a[148:149],v3,24576
T a[150:151],v3,25600
T a[152:153],v4,16384
T a[154:155],v4,17408
T a[156:157],v4,24576
T a[158:159],v4,25600
s_waitcnt lgkmcnt(15)
M a[0:3],a[160:163],a[96:99],0
SA m0,s23,49152
R a[168:171],v5,2048
R a[172:175],v6,2048
M a[0:3],a[164:167],a[100:103],a[0:3]
buffer_load_dwordx4 v8, s[16:19], s21 offen offset:0  nt lds
M a[4:7],a[164:167],a[108:111],0
M a[4:7],a[160:163],a[104:107],a[4:7]
M a[8:11],a[160:163],a[112:115],0
buffer_load_dwordx4 v9, s[16:19], s21 offen offset:1024  nt lds
M a[8:11],a[164:167],a[116:119],a[8:11]
s_waitcnt lgkmcnt(14)
M a[12:15],a[164:167],a[124:127],0
M a[12:15],a[160:163],a[120:123],a[12:15]
M a[16:19],a[160:163],a[128:131],0
buffer_load_dwordx4 v10, s[16:19], s21 offen offset:2048  nt lds
M a[16:19],a[164:167],a[132:135],a[16:19]
s_waitcnt lgkmcnt(6)
M a[20:23],a[164:167],a[140:143],0
M a[20:23],a[160:163],a[136:139],a[20:23]
buffer_load_dwordx4 v11, s[16:19], s21 offen offset:3072  nt lds
M a[24:27],a[160:163],a[144:147],0
SA s21,s21,524160
M a[24:27],a[164:167],a[148:151],a[24:27]
s_waitcnt lgkmcnt(0)
M a[28:31],a[164:167],a[156:159],0
SA m0,s24,32768
M a[28:31],a[160:163],a[152:155],a[28:31]
buffer_load_dwordx4 v12, s[48:51], s22 offen offset:0   lds
M v[32:35],a[168:171],a[96:99],0
R a[160:163],v5,4096
R a[164:167],v6,4096
M v[32:35],a[172:175],a[100:103],v[32:35]
M v[36:39],a[172:175],a[108:111],0
M v[36:39],a[168:171],a[104:107],v[36:39]
buffer_load_dwordx4 v13, s[48:51], s22 offen offset:1024   lds
M v[40:43],a[168:171],a[112:115],0
M v[40:43],a[172:175],a[116:119],v[40:43]
M v[44:47],a[172:175],a[124:127],0
buffer_load_dwordx4 v14, s[48:51], s22 offen offset:2048   lds
M v[44:47],a[168:171],a[120:123],v[44:47]
M v[48:51],a[168:171],a[128:131],0
M v[48:51],a[172:175],a[132:135],v[48:51]
M v[52:55],a[172:175],a[140:143],0
buffer_load_dwordx4 v15, s[48:51], s22 offen offset:3072   lds
M v[52:55],a[168:171],a[136:139],v[52:55]
SA s22,s22,1048576
M v[56:59],a[168:171],a[144:147],0
M v[56:59],a[172:175],a[148:151],v[56:59]
s_waitcnt lgkmcnt(0)
M v[60:63],a[172:175],a[156:159],0
M v[60:63],a[168:171],a[152:155],v[60:63]
M v[64:67],a[160:163],a[96:99],0
R a[168:171],v5,6144
R a[172:175],v6,6144
M v[64:67],a[164:167],a[100:103],v[64:67]
M v[68:71],a[164:167],a[108:111],0
M v[68:71],a[160:163],a[104:107],v[68:71]
M v[72:75],a[160:163],a[112:115],0
M v[72:75],a[164:167],a[116:119],v[72:75]
M v[76:79],a[164:167],a[124:127],0
M v[76:79],a[160:163],a[120:123],v[76:79]
M v[80:83],a[160:163],a[128:131],0
M v[80:83],a[164:167],a[132:135],v[80:83]
M v[84:87],a[164:167],a[140:143],0
M v[84:87],a[160:163],a[136:139],v[84:87]
M v[88:91],a[160:163],a[144:147],0
M v[88:91],a[164:167],a[148:151],v[88:91]
s_waitcnt lgkmcnt(0)
M v[92:95],a[164:167],a[156:159],0
s_waitcnt vmcnt(12)
M v[92:95],a[160:163],a[152:155],v[92:95]
s_barrier
M v[96:99],a[168:171],a[96:99],0
SA m0,s23,0
R a[160:163],v5,16384
R a[164:167],v6,16384
M v[96:99],a[172:175],a[100:103],v[96:99]
buffer_load_dwordx4 v8, s[16:19], s21 offen offset:0  nt lds
M v[100:103],a[172:175],a[108:111],0
v_lshlrev_b32 v26, 7, v0
v_and_b32 v27, 48, v0
M v[100:103],a[168:171],a[104:107],v[100:103]
v_lshl_add_u32 v26, v27, 24, v26
M v[104:107],a[168:171],a[112:115],0
buffer_load_dwordx4 v9, s[16:19], s21 offen offset:1024  nt lds
M v[104:107],a[172:175],a[116:119],v[104:107]
M v[108:111],a[172:175],a[124:127],0
M v[108:111],a[168:171],a[120:123],v[108:111]
buffer_load_dwordx4 v10, s[16:19], s21 offen offset:2048  nt lds
M v[112:115],a[168:171],a[128:131],0
M v[112:115],a[172:175],a[132:135],v[112:115]
M v[116:119],a[172:175],a[140:143],0
M v[116:119],a[168:171],a[136:139],v[116:119]
buffer_load_dwordx4 v11, s[16:19], s21 offen offset:3072  nt lds
M v[120:123],a[168:171],a[144:147],0
SA s21,s21,128
M v[120:123],a[172:175],a[148:151],v[120:123]
s_waitcnt lgkmcnt(0)
M v[124:127],a[172:175],a[156:159],0
SA m0,s24,49152
M v[124:127],a[168:171],a[152:155],v[124:127]
buffer_load_dwordx4 v12, s[48:51], s22 offen offset:0   lds
M v[128:131],a[160:163],a[96:99],0
R a[168:171],v5,18432
R a[172:175],v6,18432
M v[128:131],a[164:167],a[100:103],v[128:131]
buffer_load_dwordx4 v13, s[48:51], s22 offen offset:1024   lds
M v[132:135],a[164:167],a[108:111],0
M v[132:135],a[160:163],a[104:107],v[132:135]
M v[136:139],a[160:163],a[112:115],0
M v[136:139],a[164:167],a[116:119],v[136:139]
buffer_load_dwordx4 v14, s[48:51], s22 offen offset:2048   lds
M v[140:143],a[164:167],a[124:127],0
M v[140:143],a[160:163],a[120:123],v[140:143]
M v[144:147],a[160:163],a[128:131],0
buffer_load_dwordx4 v15, s[48:51], s22 offen offset:3072   lds
M v[144:147],a[164:167],a[132:135],v[144:147]
s_sub_u32 s22, s22, 1048448
M v[148:151],a[164:167],a[140:143],0
M v[148:151],a[160:163],a[136:139],v[148:151]
M v[152:155],a[160:163],a[144:147],0
M v[152:155],a[164:167],a[148:151],v[152:155]
s_waitcnt lgkmcnt(0)
M v[156:159],a[164:167],a[156:159],0
s_waitcnt vmcnt(12)
M v[156:159],a[160:163],a[152:155],v[156:159]
s_barrier
M v[160:163],a[168:171],a[96:99],0
SA m0,s23,16384
R a[160:163],v5,20480
R a[164:167],v6,20480
M v[160:163],a[172:175],a[100:103],v[160:163]
T a[32:33],v1,32768
T a[34:35],v1,33792
M v[164:167],a[172:175],a[108:111],0
T a[36:37],v1,40960
T a[38:39],v1,41984
M v[164:167],a[168:171],a[104:107],v[164:167]
T a[40:41],v2,32768
T a[42:43],v2,33792
M v[168:171],a[168:171],a[112:115],0
T a[44:45],v2,40960
T a[46:47],v2,41984
M v[168:171],a[172:175],a[116:119],v[168:171]
buffer_load_dwordx4 v8, s[16:19], s21 offen offset:0  nt lds
M v[172:175],a[172:175],a[124:127],0
s_nop 0
T a[48:49],v3,32768
T a[50:51],v3,33792
M v[172:175],a[168:171],a[120:123],v[172:175]
buffer_load_dwordx4 v9, s[16:19], s21 offen offset:1024  nt lds
M v[176:179],a[168:171],a[128:131],0
s_nop 0
T a[52:53],v3,40960
T a[54:55],v3,41984
M v[176:179],a[172:175],a[132:135],v[176:179]
T a[56:57],v4,32768
T a[58:59],v4,33792
M v[180:183],a[172:175],a[140:143],0
buffer_load_dwordx4 v10, s[16:19], s21 offen offset:2048  nt lds
M v[180:183],a[168:171],a[136:139],v[180:183]
s_nop 0
T a[60:61],v4,40960
T a[62:63],v4,41984
M v[184:187],a[168:171],a[144:147],0
buffer_load_dwordx4 v11, s[16:19], s21 offen offset:3072  nt lds
M v[184:187],a[172:175],a[148:151],v[184:187]
s_waitcnt lgkmcnt(15)
s_nop 0
T a[64:65],v1,49152
T a[66:67],v1,50176
M v[188:191],a[172:175],a[156:159],0
SA s21,s21,524160
T a[68:69],v1,57344
T a[70:71],v1,58368
M v[188:191],a[168:171],a[152:155],v[188:191]
SA m0,s24,0
M v[192:195],a[160:163],a[96:99],0
R a[168:171],v5,22528
R a[172:175],v6,22528
M v[192:195],a[164:167],a[100:103],v[192:195]
T a[72:73],v2,49152
T a[74:75],v2,50176
M v[196:199],a[164:167],a[108:111],0
T a[76:77],v2,57344
T a[78:79],v2,58368
M v[196:199],a[160:163],a[104:107],v[196:199]
T a[80:81],v3,49152
T a[82:83],v3,50176
M v[200:203],a[160:163],a[112:115],0
buffer_load_dwordx4 v12, s[48:51], s22 offen offset:0   lds
M v[200:203],a[164:167],a[116:119],v[200:203]
s_nop 0
T a[84:85],v3,57344
T a[86:87],v3,58368
M v[204:207],a[164:167],a[124:127],0
T a[88:89],v4,49152
T a[90:91],v4,50176
M v[204:207],a[160:163],a[120:123],v[204:207]
buffer_load_dwordx4 v13, s[48:51], s22 offen offset:1024   lds
M v[208:211],a[160:163],a[128:131],0
s_nop 0
T a[92:93],v4,57344
T a[94:95],v4,58368
M v[208:211],a[164:167],a[132:135],v[208:211]
buffer_load_dwordx4 v14, s[48:51], s22 offen offset:2048   lds
M v[212:215],a[164:167],a[140:143],0
buffer_load_dwordx4 v15, s[48:51], s22 offen offset:3072   lds
M v[212:215],a[160:163],a[136:139],v[212:215]
SA s22,s22,1048576
M v[216:219],a[160:163],a[144:147],0
M v[216:219],a[164:167],a[148:151],v[216:219]
s_waitcnt lgkmcnt(12)
M v[220:223],a[164:167],a[156:159],0
s_waitcnt vmcnt(12) lgkmcnt(0)
M v[220:223],a[160:163],a[152:155],v[220:223]
s_barrier
M v[224:227],a[168:171],a[96:99],0
SA m0,s23,32768
R a[160:163],v5,32768
R a[164:167],v6,32768
M v[224:227],a[172:175],a[100:103],v[224:227]
buffer_load_dwordx4 v8, s[16:19], s21 offen offset:0  nt lds
M v[228:231],a[172:175],a[108:111],0
M v[228:231],a[168:171],a[104:107],v[228:231]
M v[232:235],a[168:171],a[112:115],0
buffer_load_dwordx4 v9, s[16:19], s21 offen offset:1024  nt lds
M v[232:235],a[172:175],a[116:119],v[232:235]
M v[236:239],a[172:175],a[124:127],0
M v[236:239],a[168:171],a[120:123],v[236:239]
buffer_load_dwordx4 v10, s[16:19], s21 offen offset:2048  nt lds
M v[240:243],a[168:171],a[128:131],0
M v[240:243],a[172:175],a[132:135],v[240:243]
M v[244:247],a[172:175],a[140:143],0
buffer_load_dwordx4 v11, s[16:19], s21 offen offset:3072  nt lds
M v[244:247],a[168:171],a[136:139],v[244:247]
SA s21,s21,128
M v[248:251],a[168:171],a[144:147],0
M v[248:251],a[172:175],a[148:151],v[248:251]
s_waitcnt lgkmcnt(0)
M v[252:255],a[172:175],a[156:159],0
M v[252:255],a[168:171],a[152:155],v[252:255]
M a[0:3],a[160:163],a[32:35],a[0:3]
R a[168:171],v5,34816
R a[172:175],v6,34816
M a[0:3],a[164:167],a[36:39],a[0:3]
T a[96:97],v1,0
T a[98:99],v1,1024
M a[4:7],a[164:167],a[44:47],a[4:7]
SA m0,s24,16384
v_mov_b32 v16, 0
v_mov_b32 v17, 0
M a[4:7],a[160:163],a[40:43],a[4:7]
buffer_load_dwordx4 v12, s[48:51], s22 offen offset:0   lds
M a[8:11],a[160:163],a[48:51],a[8:11]
v_mov_b32 v18, 0
v_mov_b32 v19, 0
M a[8:11],a[164:167],a[52:55],a[8:11]
v_mov_b32 v20, 0
v_mov_b32 v21, 0
M a[12:15],a[164:167],a[60:63],a[12:15]
T a[100:101],v1,8192
T a[102:103],v1,9216
M a[12:15],a[160:163],a[56:59],a[12:15]
v_mov_b32 v22, 0
v_mov_b32 v23, 0
M a[16:19],a[160:163],a[64:67],a[16:19]
buffer_load_dwordx4 v13, s[48:51], s22 offen offset:1024   lds
M a[16:19],a[164:167],a[68:71],a[16:19]
G v28,a192
G v29,a196
M a[20:23],a[164:167],a[76:79],a[20:23]
v_lshlrev_b32 v24, 16, v28
v_lshlrev_b32 v25, 16, v29
M a[20:23],a[160:163],a[72:75],a[20:23]
T a[104:105],v2,0
T a[106:107],v2,1024
M a[24:27],a[160:163],a[80:83],a[24:27]
v_and_b32 v28, 0xffff0000, v28
v_and_b32 v29, 0xffff0000, v29
M a[24:27],a[164:167],a[84:87],a[24:27]
s_waitcnt lgkmcnt(6)
buffer_load_dwordx4 v14, s[48:51], s22 offen offset:2048   lds
M a[28:31],a[164:167],a[92:95],a[28:31]
G v30,a176
v_lshlrev_b32 v31, 16, v30
M a[28:31],a[160:163],a[88:91],a[28:31]
v_and_b32 v30, 0xffff0000, v30
v_fmac_f32 v16, v31, v24
M v[60:63],a[168:171],a[88:91],v[60:63]
R a[160:163],v5,36864
R a[164:167],v6,36864
M v[60:63],a[172:175],a[92:95],v[60:63]
T a[108:109],v2,8192
T a[110:111],v2,9216
M v[56:59],a[172:175],a[84:87],v[56:59]
buffer_load_dwordx4 v15, s[48:51], s22 offen offset:3072   lds
M v[56:59],a[168:171],a[80:83],v[56:59]
s_sub_u32 s22, s22, 1048448
v_fmac_f32 v20, v31, v25
v_fmac_f32 v16, v30, v28
M v[52:55],a[168:171],a[72:75],v[52:55]
v_fmac_f32 v20, v30, v29
G v30,a180
M v[52:55],a[172:175],a[76:79],v[52:55]
T a[112:113],v3,0
T a[114:115],v3,1024
M v[48:51],a[172:175],a[68:71],v[48:51]
SA m0,s23,49152
v_lshlrev_b32 v31, 16, v30
v_and_b32 v30, 0xffff0000, v30
M v[48:51],a[168:171],a[64:67],v[48:51]
buffer_load_dwordx4 v8, s[16:19], s21 offen offset:0  nt lds
M v[44:47],a[168:171],a[56:59],v[44:47]
v_fmac_f32 v17, v31, v24
v_fmac_f32 v21, v31, v25
M v[44:47],a[172:175],a[60:63],v[44:47]
v_fmac_f32 v17, v30, v28
v_fmac_f32 v21, v30, v29
M v[40:43],a[172:175],a[52:55],v[40:43]
T a[116:117],v3,8192
T a[118:119],v3,9216
M v[40:43],a[168:171],a[48:51],v[40:43]
G v30,a184
v_lshlrev_b32 v31, 16, v30
M v[36:39],a[168:171],a[40:43],v[36:39]
buffer_load_dwordx4 v9, s[16:19], s21 offen offset:1024  nt lds
M v[36:39],a[172:175],a[44:47],v[36:39]
s_waitcnt lgkmcnt(6)
v_and_b32 v30, 0xffff0000, v30
v_fmac_f32 v18, v31, v24
M v[32:35],a[172:175],a[36:39],v[32:35]
v_fmac_f32 v22, v31, v25
v_fmac_f32 v18, v30, v28
M v[32:35],a[168:171],a[32:35],v[32:35]
T a[120:121],v4,0
T a[122:123],v4,1024
M v[64:67],a[160:163],a[32:35],v[64:67]
R a[168:171],v5,38912
R a[172:175],v6,38912
M v[64:67],a[164:167],a[36:39],v[64:67]
buffer_load_dwordx4 v10, s[16:19], s21 offen offset:2048  nt lds
M v[68:71],a[164:167],a[44:47],v[68:71]
v_fmac_f32 v22, v30, v29
G v30,a188
M v[68:71],a[160:163],a[40:43],v[68:71]
v_lshlrev_b32 v31, 16, v30
v_and_b32 v30, 0xffff0000, v30
M v[72:75],a[160:163],a[48:51],v[72:75]
T a[124:125],v4,8192
T a[126:127],v4,9216
M v[72:75],a[164:167],a[52:55],v[72:75]
v_fmac_f32 v19, v31, v24
v_fmac_f32 v23, v31, v25
M v[76:79],a[164:167],a[60:63],v[76:79]
buffer_load_dwordx4 v11, s[16:19], s21 offen offset:3072  nt lds
M v[76:79],a[160:163],a[56:59],v[76:79]
SA s21,s21,524160
v_fmac_f32 v19, v30, v28
v_fmac_f32 v23, v30, v29
M v[80:83],a[160:163],a[64:67],v[80:83]
G v28,a193
G v29,a197
M v[80:83],a[164:167],a[68:71],v[80:83]
v_lshlrev_b32 v24, 16, v28
v_lshlrev_b32 v25, 16, v29
M v[84:87],a[164:167],a[76:79],v[84:87]
v_and_b32 v28, 0xffff0000, v28
v_and_b32 v29, 0xffff0000, v29
M v[84:87],a[160:163],a[72:75],v[84:87]
G v30,a177
v_lshlrev_b32 v31, 16, v30
M v[88:91],a[160:163],a[80:83],v[88:91]
v_and_b32 v30, 0xffff0000, v30
v_fmac_f32 v16, v31, v24
M v[88:91],a[164:167],a[84:87],v[88:91]
s_waitcnt lgkmcnt(2)
v_fmac_f32 v20, v31, v25
v_fmac_f32 v16, v30, v28
M v[92:95],a[164:167],a[92:95],v[92:95]
s_waitcnt vmcnt(16) lgkmcnt(0)
v_fmac_f32 v20, v30, v29
G v30,a181
M v[92:95],a[160:163],a[88:91],v[92:95]
s_barrier
M v[124:127],a[168:171],a[88:91],v[124:127]
R a[160:163],v5,49152
R a[164:167],v6,49152
M v[124:127],a[172:175],a[92:95],v[124:127]
v_lshlrev_b32 v31, 16, v30
v_and_b32 v30, 0xffff0000, v30
M v[120:123],a[172:175],a[84:87],v[120:123]
SA m0,s24,32768
T a[128:129],v1,16384
T a[130:131],v1,17408
M v[120:123],a[168:171],a[80:83],v[120:123]
buffer_load_dwordx4 v12, s[48:51], s22 offen offset:0   lds
M v[116:119],a[168:171],a[72:75],v[116:119]
v_fmac_f32 v17, v31, v24
v_fmac_f32 v21, v31, v25
M v[116:119],a[172:175],a[76:79],v[116:119]
v_fmac_f32 v17, v30, v28
v_fmac_f32 v21, v30, v29
M v[112:115],a[172:175],a[68:71],v[112:115]
G v30,a185
v_lshlrev_b32 v31, 16, v30
M v[112:115],a[168:171],a[64:67],v[112:115]
v_and_b32 v30, 0xffff0000, v30
v_fmac_f32 v18, v31, v24
M v[108:111],a[168:171],a[56:59],v[108:111]
v_fmac_f32 v22, v31, v25
v_fmac_f32 v18, v30, v28
M v[108:111],a[172:175],a[60:63],v[108:111]
T a[132:133],v1,24576
T a[134:135],v1,25600
M v[104:107],a[172:175],a[52:55],v[104:107]
buffer_load_dwordx4 v13, s[48:51], s22 offen offset:1024   lds
M v[104:107],a[168:171],a[48:51],v[104:107]
v_fmac_f32 v22, v30, v29
G v30,a189
M v[100:103],a[168:171],a[40:43],v[100:103]
v_lshlrev_b32 v31, 16, v30
v_and_b32 v30, 0xffff0000, v30
M v[100:103],a[172:175],a[44:47],v[100:103]
s_waitcnt lgkmcnt(4)
v_fmac_f32 v19, v31, v24
v_fmac_f32 v23, v31, v25
M v[96:99],a[172:175],a[36:39],v[96:99]
v_fmac_f32 v19, v30, v28
v_fmac_f32 v23, v30, v29
M v[96:99],a[168:171],a[32:35],v[96:99]
G v28,a194
G v29,a198
M v[128:131],a[160:163],a[32:35],v[128:131]
R a[168:171],v5,51200
R a[172:175],v6,51200
M v[128:131],a[164:167],a[36:39],v[128:131]
T a[136:137],v2,16384
T a[138:139],v2,17408
M v[132:135],a[164:167],a[44:47],v[132:135]
buffer_load_dwordx4 v14, s[48:51], s22 offen offset:2048   lds
M v[132:135],a[160:163],a[40:43],v[132:135]
v_lshlrev_b32 v24, 16, v28
v_lshlrev_b32 v25, 16, v29
M v[136:139],a[160:163],a[48:51],v[136:139]
v_and_b32 v28, 0xffff0000, v28
v_and_b32 v29, 0xffff0000, v29
M v[136:139],a[164:167],a[52:55],v[136:139]
G v30,a178
v_lshlrev_b32 v31, 16, v30
M v[140:143],a[164:167],a[60:63],v[140:143]
v_and_b32 v30, 0xffff0000, v30
v_fmac_f32 v16, v31, v24
M v[140:143],a[160:163],a[56:59],v[140:143]
T a[140:141],v2,24576
T a[142:143],v2,25600
M v[144:147],a[160:163],a[64:67],v[144:147]
buffer_load_dwordx4 v15, s[48:51], s22 offen offset:3072   lds
M v[144:147],a[164:167],a[68:71],v[144:147]
SA s22,s22,1048576
v_fmac_f32 v20, v31, v25
v_fmac_f32 v16, v30, v28
M v[148:151],a[164:167],a[76:79],v[148:151]
v_fmac_f32 v20, v30, v29
G v30,a182
M v[148:151],a[160:163],a[72:75],v[148:151]
v_lshlrev_b32 v31, 16, v30
v_and_b32 v30, 0xffff0000, v30
M v[152:155],a[160:163],a[80:83],v[152:155]
v_fmac_f32 v17, v31, v24
v_fmac_f32 v21, v31, v25
M v[152:155],a[164:167],a[84:87],v[152:155]
s_waitcnt lgkmcnt(4)
v_fmac_f32 v17, v30, v28
v_fmac_f32 v21, v30, v29
M v[156:159],a[164:167],a[92:95],v[156:159]
SA m0,s23,0
T a[144:145],v3,16384
T a[146:147],v3,17408
M v[156:159],a[160:163],a[88:91],v[156:159]
buffer_load_dwordx4 v8, s[16:19], s21 offen offset:0  nt lds
M v[188:191],a[168:171],a[88:91],v[188:191]
R a[160:163],v5,53248
R a[164:167],v6,53248
M v[188:191],a[172:175],a[92:95],v[188:191]
G v30,a186
v_lshlrev_b32 v31, 16, v30
M v[184:187],a[172:175],a[84:87],v[184:187]
v_and_b32 v30, 0xffff0000, v30
v_fmac_f32 v18, v31, v24
M v[184:187],a[168:171],a[80:83],v[184:187]
v_fmac_f32 v22, v31, v25
v_fmac_f32 v18, v30, v28
M v[180:183],a[168:171],a[72:75],v[180:183]
v_fmac_f32 v22, v30, v29
G v30,a190
M v[180:183],a[172:175],a[76:79],v[180:183]
L_w_kv11:
s_cbranch_execz L_w_kv15
T a[148:149],v3,24576
T a[150:151],v3,25600
M v[176:179],a[172:175],a[68:71],v[176:179]
buffer_load_dwordx4 v9, s[16:19], s21 offen offset:1024  nt lds
M v[176:179],a[168:171],a[64:67],v[176:179]
v_lshlrev_b32 v31, 16, v30
v_and_b32 v30, 0xffff0000, v30
M v[172:175],a[168:171],a[56:59],v[172:175]
v_fmac_f32 v19, v31, v24
v_fmac_f32 v23, v31, v25
M v[172:175],a[172:175],a[60:63],v[172:175]
v_fmac_f32 v19, v30, v28
v_fmac_f32 v23, v30, v29
M v[168:171],a[172:175],a[52:55],v[168:171]
M v[168:171],a[168:171],a[48:51],v[168:171]
M v[164:167],a[168:171],a[40:43],v[164:167]
s_nop 0
T a[152:153],v4,16384
T a[154:155],v4,17408
M v[164:167],a[172:175],a[44:47],v[164:167]
s_waitcnt lgkmcnt(4)
buffer_load_dwordx4 v10, s[16:19], s21 offen offset:2048  nt lds
M v[160:163],a[172:175],a[36:39],v[160:163]
M v[160:163],a[168:171],a[32:35],v[160:163]
M v[192:195],a[160:163],a[32:35],v[192:195]
R a[168:171],v5,55296
R a[172:175],v6,55296
M v[192:195],a[164:167],a[36:39],v[192:195]
M v[196:199],a[164:167],a[44:47],v[196:199]
M v[196:199],a[160:163],a[40:43],v[196:199]
s_nop 0
T a[156:157],v4,24576
T a[158:159],v4,25600
M v[200:203],a[160:163],a[48:51],v[200:203]
buffer_load_dwordx4 v11, s[16:19], s21 offen offset:3072  nt lds
M v[200:203],a[164:167],a[52:55],v[200:203]
SA s21,s21,128
M v[204:207],a[164:167],a[60:63],v[204:207]
M v[204:207],a[160:163],a[56:59],v[204:207]
M v[208:211],a[160:163],a[64:67],v[208:211]
M v[208:211],a[164:167],a[68:71],v[208:211]
M v[212:215],a[164:167],a[76:79],v[212:215]
M v[212:215],a[160:163],a[72:75],v[212:215]
M v[216:219],a[160:163],a[80:83],v[216:219]
M v[216:219],a[164:167],a[84:87],v[216:219]
s_waitcnt lgkmcnt(2)
M v[220:223],a[164:167],a[92:95],v[220:223]
s_waitcnt vmcnt(16) lgkmcnt(0)
M v[220:223],a[160:163],a[88:91],v[220:223]
s_barrier
M v[252:255],a[168:171],a[88:91],v[252:255]
R a[160:163],v5,0
R a[164:167],v6,0
M v[252:255],a[172:175],a[92:95],v[252:255]
M v[248:251],a[172:175],a[84:87],v[248:251]
M v[248:251],a[168:171],a[80:83],v[248:251]
M v[244:247],a[168:171],a[72:75],v[244:247]
M v[244:247],a[172:175],a[76:79],v[244:247]
M v[240:243],a[172:175],a[68:71],v[240:243]
M v[240:243],a[168:171],a[64:67],v[240:243]
M v[236:239],a[168:171],a[56:59],v[236:239]
M v[236:239],a[172:175],a[60:63],v[236:239]
M v[232:235],a[172:175],a[52:55],v[232:235]
M v[232:235],a[168:171],a[48:51],v[232:235]
M v[228:231],a[168:171],a[40:43],v[228:231]
M v[228:231],a[172:175],a[44:47],v[228:231]
s_waitcnt lgkmcnt(0)
M v[224:227],a[172:175],a[36:39],v[224:227]
M v[224:227],a[168:171],a[32:35],v[224:227]
M a[0:3],a[160:163],a[96:99],a[0:3]
R a[168:171],v5,2048
R a[172:175],v6,2048
M a[0:3],a[164:167],a[100:103],a[0:3]
T a[32:33],v1,32768
T a[34:35],v1,33792
M a[4:7],a[164:167],a[108:111],a[4:7]
SA m0,s24,49152
G v28,a195
G v29,a199
M a[4:7],a[160:163],a[104:107],a[4:7]
buffer_load_dwordx4 v12, s[48:51], s22 offen offset:0   lds
M a[8:11],a[160:163],a[112:115],a[8:11]
v_lshlrev_b32 v24, 16, v28
v_lshlrev_b32 v25, 16, v29
M a[8:11],a[164:167],a[116:119],a[8:11]
v_and_b32 v28, 0xffff0000, v28
v_and_b32 v29, 0xffff0000, v29
M a[12:15],a[164:167],a[124:127],a[12:15]
T a[36:37],v1,40960
T a[38:39],v1,41984
M a[12:15],a[160:163],a[120:123],a[12:15]
G v30,a179
v_lshlrev_b32 v31, 16, v30
M a[16:19],a[160:163],a[128:131],a[16:19]
buffer_load_dwordx4 v13, s[48:51], s22 offen offset:1024   lds
M a[16:19],a[164:167],a[132:135],a[16:19]
v_and_b32 v30, 0xffff0000, v30
v_fmac_f32 v16, v31, v24
M a[20:23],a[164:167],a[140:143],a[20:23]
v_fmac_f32 v20, v31, v25
v_fmac_f32 v16, v30, v28
M a[20:23],a[160:163],a[136:139],a[20:23]
T a[40:41],v2,32768
T a[42:43],v2,33792
M a[24:27],a[160:163],a[144:147],a[24:27]
v_fmac_f32 v20, v30, v29
G v30,a183
M a[24:27],a[164:167],a[148:151],a[24:27]
s_waitcnt lgkmcnt(6)
buffer_load_dwordx4 v14, s[48:51], s22 offen offset:2048   lds
M a[28:31],a[164:167],a[156:159],a[28:31]
v_lshlrev_b32 v31, 16, v30
v_and_b32 v30, 0xffff0000, v30
M a[28:31],a[160:163],a[152:155],a[28:31]
v_fmac_f32 v17, v31, v24
v_fmac_f32 v21, v31, v25
M v[60:63],a[168:171],a[152:155],v[60:63]
R a[160:163],v5,4096
R a[164:167],v6,4096
M v[60:63],a[172:175],a[156:159],v[60:63]
T a[44:45],v2,40960
T a[46:47],v2,41984
M v[56:59],a[172:175],a[148:151],v[56:59]
buffer_load_dwordx4 v15, s[48:51], s22 offen offset:3072   lds
M v[56:59],a[168:171],a[144:147],v[56:59]
s_sub_u32 s22, s22, 1048448
v_fmac_f32 v17, v30, v28
v_fmac_f32 v21, v30, v29
M v[52:55],a[168:171],a[136:139],v[52:55]
G v30,a187
v_lshlrev_b32 v31, 16, v30
M v[52:55],a[172:175],a[140:143],v[52:55]
T a[48:49],v3,32768
T a[50:51],v3,33792
M v[48:51],a[172:175],a[132:135],v[48:51]
SA m0,s23,16384
v_and_b32 v30, 0xffff0000, v30
v_fmac_f32 v18, v31, v24
M v[48:51],a[168:171],a[128:131],v[48:51]
buffer_load_dwordx4 v8, s[16:19], s21 offen offset:0  nt lds
M v[44:47],a[168:171],a[120:123],v[44:47]
v_fmac_f32 v22, v31, v25
v_fmac_f32 v18, v30, v28
M v[44:47],a[172:175],a[124:127],v[44:47]
v_fmac_f32 v22, v30, v29
G v30,a191
M v[40:43],a[172:175],a[116:119],v[40:43]
T a[52:53],v3,40960
T a[54:55],v3,41984
M v[40:43],a[168:171],a[112:115],v[40:43]
v_lshlrev_b32 v31, 16, v30
v_and_b32 v30, 0xffff0000, v30
M v[36:39],a[168:171],a[104:107],v[36:39]
buffer_load_dwordx4 v9, s[16:19], s21 offen offset:1024  nt lds
M v[36:39],a[172:175],a[108:111],v[36:39]
s_waitcnt lgkmcnt(6)
v_fmac_f32 v19, v31, v24
v_fmac_f32 v23, v31, v25
M v[32:35],a[172:175],a[100:103],v[32:35]
v_fmac_f32 v19, v30, v28
v_fmac_f32 v23, v30, v29
M v[32:35],a[168:171],a[96:99],v[32:35]
T a[56:57],v4,32768
T a[58:59],v4,33792
M v[64:67],a[160:163],a[96:99],v[64:67]
R a[168:171],v5,6144
R a[172:175],v6,6144
M v[64:67],a[164:167],a[100:103],v[64:67]
buffer_load_dwordx4 v10, s[16:19], s21 offen offset:2048  nt lds
M v[68:71],a[164:167],a[108:111],v[68:71]
v_permlane32_swap_b32 v16, v18
M v[68:71],a[160:163],a[104:107],v[68:71]
v_permlane32_swap_b32 v17, v19
M v[72:75],a[160:163],a[112:115],v[72:75]
s_nop 0
T a[60:61],v4,40960
T a[62:63],v4,41984
M v[72:75],a[164:167],a[116:119],v[72:75]
v_permlane32_swap_b32 v20, v22
M v[76:79],a[164:167],a[124:127],v[76:79]
buffer_load_dwordx4 v11, s[16:19], s21 offen offset:3072  nt lds
M v[76:79],a[160:163],a[120:123],v[76:79]
SA s21,s21,524160
v_permlane32_swap_b32 v21, v23
M v[80:83],a[160:163],a[128:131],v[80:83]
AF v16,v16,v18
AF v17,v17,v19
M v[80:83],a[164:167],a[132:135],v[80:83]
AF v20,v20,v22
AF v21,v21,v23
M v[84:87],a[164:167],a[140:143],v[84:87]
v_lshrrev_b32 v28, 4, v0
M v[84:87],a[160:163],a[136:139],v[84:87]
v_permlane16_swap_b32 v16, v17
M v[88:91],a[160:163],a[144:147],v[88:91]
v_permlane16_swap_b32 v20, v21
M v[88:91],a[164:167],a[148:151],v[88:91]
s_waitcnt lgkmcnt(2)
AF v16,v16,v17
AF v20,v20,v21
M v[92:95],a[164:167],a[156:159],v[92:95]
s_waitcnt vmcnt(16) lgkmcnt(0)
v_add_u32 v29, s67, v28
v_add_f32 v16, v16, v16 row_ror:8 row_mask:0xf bank_mask:0xf
M v[92:95],a[160:163],a[152:155],v[92:95]
s_barrier
M v[124:127],a[168:171],a[152:155],v[124:127]
R a[160:163],v5,16384
R a[164:167],v6,16384
M v[124:127],a[172:175],a[156:159],v[124:127]
v_add_f32 v20, v20, v20 row_ror:8 row_mask:0xf bank_mask:0xf
v_add_f32 v16, v16, v16 row_ror:4 row_mask:0xf bank_mask:0xf
M v[120:123],a[172:175],a[148:151],v[120:123]
SA m0,s24,0
T a[64:65],v1,49152
T a[66:67],v1,50176
M v[120:123],a[168:171],a[144:147],v[120:123]
buffer_load_dwordx4 v12, s[48:51], s22 offen offset:0   lds
M v[116:119],a[168:171],a[136:139],v[116:119]
v_add_f32 v20, v20, v20 row_ror:4 row_mask:0xf bank_mask:0xf
v_add_f32 v16, v16, v16 row_ror:2 row_mask:0xf bank_mask:0xf
M v[116:119],a[172:175],a[140:143],v[116:119]
v_add_f32 v20, v20, v20 row_ror:2 row_mask:0xf bank_mask:0xf
v_add_f32 v16, v16, v16 row_ror:1 row_mask:0xf bank_mask:0xf
M v[112:115],a[172:175],a[132:135],v[112:115]
v_add_f32 v20, v20, v20 row_ror:1 row_mask:0xf bank_mask:0xf
v_ashrrev_i32 v30, 31, v16
M v[112:115],a[168:171],a[128:131],v[112:115]
v_or_b32 v30, 0x80000000, v30
v_xor_b32 v30, v30, v16
M v[108:111],a[168:171],a[120:123],v[108:111]
v_and_b32 v30, 0xfffff800, v30
v_sub_u32 v29, 2047, v29
M v[108:111],a[172:175],a[124:127],v[108:111]
T a[68:69],v1,57344
T a[70:71],v1,58368
M v[104:107],a[172:175],a[116:119],v[104:107]
buffer_load_dwordx4 v13, s[48:51], s22 offen offset:1024   lds
M v[104:107],a[168:171],a[112:115],v[104:107]
v_or_b32 v30, v30, v29
v_max_u32 v30, 1, v30
M v[100:103],a[168:171],a[104:107],v[100:103]
MF v21,0xbfb8aa3b,v20
M v[100:103],a[172:175],a[108:111],v[100:103]
s_waitcnt lgkmcnt(4)
E v21,v21
M v[96:99],a[172:175],a[100:103],v[96:99]
AF v21,1.0,v21
M v[96:99],a[168:171],a[96:99],v[96:99]
v_rcp_f32 v20, v21
M v[128:131],a[160:163],a[96:99],v[128:131]
s_lshl_b32 s72, s20, 4
R a[168:171],v5,18432
R a[172:175],v6,18432
M v[128:131],a[164:167],a[100:103],v[128:131]
SA s72,s72,163584
T a[72:73],v2,49152
T a[74:75],v2,50176
M v[132:135],a[164:167],a[108:111],v[132:135]
buffer_load_dwordx4 v14, s[48:51], s22 offen offset:2048   lds
M v[132:135],a[160:163],a[104:107],v[132:135]
v_lshl_add_u32 v28, v28, 2, s72
ds_write_b32 v28, v30
M v[136:139],a[160:163],a[112:115],v[136:139]
ds_write_b32 v28, v16 offset:64
ds_write_b32 v28, v20 offset:128
M v[136:139],a[164:167],a[116:119],v[136:139]
M v[140:143],a[164:167],a[124:127],v[140:143]
M v[140:143],a[160:163],a[120:123],v[140:143]
s_nop 0
T a[76:77],v2,57344
T a[78:79],v2,58368
M v[144:147],a[160:163],a[128:131],v[144:147]
buffer_load_dwordx4 v15, s[48:51], s22 offen offset:3072   lds
M v[144:147],a[164:167],a[132:135],v[144:147]
SA s22,s22,1048576
M v[148:151],a[164:167],a[140:143],v[148:151]
M v[148:151],a[160:163],a[136:139],v[148:151]
M v[152:155],a[160:163],a[144:147],v[152:155]
M v[152:155],a[164:167],a[148:151],v[152:155]
s_waitcnt lgkmcnt(7)
M v[156:159],a[164:167],a[156:159],v[156:159]
SA m0,s23,32768
T a[80:81],v3,49152
T a[82:83],v3,50176
M v[156:159],a[160:163],a[152:155],v[156:159]
buffer_load_dwordx4 v8, s[16:19], s21 offen offset:0  nt lds
M v[188:191],a[168:171],a[152:155],v[188:191]
R a[160:163],v5,20480
R a[164:167],v6,20480
M v[188:191],a[172:175],a[156:159],v[188:191]
M v[184:187],a[172:175],a[148:151],v[184:187]
M v[184:187],a[168:171],a[144:147],v[184:187]
M v[180:183],a[168:171],a[136:139],v[180:183]
M v[180:183],a[172:175],a[140:143],v[180:183]
s_nop 0
T a[84:85],v3,57344
T a[86:87],v3,58368
M v[176:179],a[172:175],a[132:135],v[176:179]
buffer_load_dwordx4 v9, s[16:19], s21 offen offset:1024  nt lds
M v[176:179],a[168:171],a[128:131],v[176:179]
M v[172:175],a[168:171],a[120:123],v[172:175]
M v[172:175],a[172:175],a[124:127],v[172:175]
M v[168:171],a[172:175],a[116:119],v[168:171]
M v[168:171],a[168:171],a[112:115],v[168:171]
M v[164:167],a[168:171],a[104:107],v[164:167]
s_nop 0
T a[88:89],v4,49152
T a[90:91],v4,50176
M v[164:167],a[172:175],a[108:111],v[164:167]
s_waitcnt lgkmcnt(4)
buffer_load_dwordx4 v10, s[16:19], s21 offen offset:2048  nt lds
M v[160:163],a[172:175],a[100:103],v[160:163]
M v[160:163],a[168:171],a[96:99],v[160:163]
M v[192:195],a[160:163],a[96:99],v[192:195]
R a[168:171],v5,22528
R a[172:175],v6,22528
M v[192:195],a[164:167],a[100:103],v[192:195]
M v[196:199],a[164:167],a[108:111],v[196:199]
M v[196:199],a[160:163],a[104:107],v[196:199]
s_nop 0
T a[92:93],v4,57344
T a[94:95],v4,58368
M v[200:203],a[160:163],a[112:115],v[200:203]
buffer_load_dwordx4 v11, s[16:19], s21 offen offset:3072  nt lds
M v[200:203],a[164:167],a[116:119],v[200:203]
SA s21,s21,128
M v[204:207],a[164:167],a[124:127],v[204:207]
M v[204:207],a[160:163],a[120:123],v[204:207]
M v[208:211],a[160:163],a[128:131],v[208:211]
M v[208:211],a[164:167],a[132:135],v[208:211]
M v[212:215],a[164:167],a[140:143],v[212:215]
M v[212:215],a[160:163],a[136:139],v[212:215]
M v[216:219],a[160:163],a[144:147],v[216:219]
M v[216:219],a[164:167],a[148:151],v[216:219]
s_waitcnt lgkmcnt(2)
M v[220:223],a[164:167],a[156:159],v[220:223]
s_waitcnt vmcnt(16) lgkmcnt(0)
M v[220:223],a[160:163],a[152:155],v[220:223]
s_barrier
M v[252:255],a[168:171],a[152:155],v[252:255]
R a[160:163],v5,32768
R a[164:167],v6,32768
M v[252:255],a[172:175],a[156:159],v[252:255]
M v[248:251],a[172:175],a[148:151],v[248:251]
M v[248:251],a[168:171],a[144:147],v[248:251]
M v[244:247],a[168:171],a[136:139],v[244:247]
M v[244:247],a[172:175],a[140:143],v[244:247]
M v[240:243],a[172:175],a[132:135],v[240:243]
M v[240:243],a[168:171],a[128:131],v[240:243]
M v[236:239],a[168:171],a[120:123],v[236:239]
M v[236:239],a[172:175],a[124:127],v[236:239]
M v[232:235],a[172:175],a[116:119],v[232:235]
M v[232:235],a[168:171],a[112:115],v[232:235]
M v[228:231],a[168:171],a[104:107],v[228:231]
M v[228:231],a[172:175],a[108:111],v[228:231]
s_waitcnt lgkmcnt(0)
M v[224:227],a[172:175],a[100:103],v[224:227]
M v[224:227],a[168:171],a[96:99],v[224:227]
M a[0:3],a[160:163],a[32:35],a[0:3]
R a[168:171],v5,34816
R a[172:175],v6,34816
M a[0:3],a[164:167],a[36:39],a[0:3]
T a[96:97],v1,0
T a[98:99],v1,1024
M a[4:7],a[164:167],a[44:47],a[4:7]
SA m0,s24,16384
M a[4:7],a[160:163],a[40:43],a[4:7]
buffer_load_dwordx4 v12, s[48:51], s22 offen offset:0   lds
M a[8:11],a[160:163],a[48:51],a[8:11]
v_and_b32 v20, 31, v0
M a[8:11],a[164:167],a[52:55],a[8:11]
v_lshlrev_b32 v20, 2, v20
M a[12:15],a[164:167],a[60:63],a[12:15]
s_nop 0
T a[100:101],v1,8192
T a[102:103],v1,9216
M a[12:15],a[160:163],a[56:59],a[12:15]
v_add_u32 v21, 163584, v20
M a[16:19],a[160:163],a[64:67],a[16:19]
buffer_load_dwordx4 v13, s[48:51], s22 offen offset:1024   lds
M a[16:19],a[164:167],a[68:71],a[16:19]
ds_read_b32 v19, v21
M a[20:23],a[164:167],a[76:79],a[20:23]
ds_read_b32 v21, v21 offset:64
M a[20:23],a[160:163],a[72:75],a[20:23]
s_min_u32 s64, s20, 1
T a[104:105],v2,0
T a[106:107],v2,1024
M a[24:27],a[160:163],a[80:83],a[24:27]
s_lshl_b32 s64, s64, 29
v_and_b32 v22, 32, v0
M a[24:27],a[164:167],a[84:87],a[24:27]
s_waitcnt lgkmcnt(8)
buffer_load_dwordx4 v14, s[48:51], s22 offen offset:2048   lds
M a[28:31],a[164:167],a[92:95],a[28:31]
v_lshl_or_b32 v20, v22, 24, v20
M a[28:31],a[160:163],a[88:91],a[28:31]
v_or_b32 v20, s64, v20
M v[60:63],a[168:171],a[88:91],v[60:63]
R a[160:163],v5,36864
R a[164:167],v6,36864
M v[60:63],a[172:175],a[92:95],v[60:63]
T a[108:109],v2,8192
T a[110:111],v2,9216
M v[56:59],a[172:175],a[84:87],v[56:59]
buffer_load_dwordx4 v15, s[48:51], s22 offen offset:3072   lds
M v[56:59],a[168:171],a[80:83],v[56:59]
s_sub_u32 s22, s22, 1048448
v_and_b32 v22, 16, v0
M v[52:55],a[168:171],a[72:75],v[52:55]
v_lshl_or_b32 v18, v22, 25, v20
s_and_b32 s27, s42, 7
M v[52:55],a[172:175],a[76:79],v[52:55]
s_lshl_b32 s72, s30, 7
T a[112:113],v3,0
T a[114:115],v3,1024
M v[48:51],a[172:175],a[68:71],v[48:51]
SA m0,s23,49152
SA s72,s72,104857600
s_lshl_b32 s64, s41, 3
M v[48:51],a[168:171],a[64:67],v[48:51]
SA s27,s27,s64
buffer_load_dwordx4 v8, s[16:19], s21 offen offset:0  nt lds
M v[44:47],a[168:171],a[56:59],v[44:47]
s_lshl_b32 s27, s27, 2
M v[44:47],a[172:175],a[60:63],v[44:47]
SA s27,s27,s20
M v[40:43],a[172:175],a[52:55],v[40:43]
s_mul_i32 s27, s27, 7168
T a[116:117],v3,8192
T a[118:119],v3,9216
M v[40:43],a[168:171],a[48:51],v[40:43]
s_mov_b32 s60, s90
M v[36:39],a[168:171],a[40:43],v[36:39]
s_and_b32 s61, s91, 0xffff
buffer_load_dwordx4 v9, s[16:19], s21 offen offset:1024  nt lds
M v[36:39],a[172:175],a[44:47],v[36:39]
s_waitcnt lgkmcnt(6)
buffer_store_dword v21, v20, s[8:11], s72 offen sc1
M v[32:35],a[172:175],a[36:39],v[32:35]
s_mov_b32 s62, 3670016
M v[32:35],a[168:171],a[32:35],v[32:35]
s_mov_b32 s63, 0x20000
T a[120:121],v4,0
T a[122:123],v4,1024
M v[64:67],a[160:163],a[32:35],v[64:67]
R a[168:171],v5,38912
R a[172:175],v6,38912
M v[64:67],a[164:167],a[36:39],v[64:67]
buffer_load_dwordx4 v10, s[16:19], s21 offen offset:2048  nt lds
M v[68:71],a[164:167],a[44:47],v[68:71]
M v[68:71],a[160:163],a[40:43],v[68:71]
M v[72:75],a[160:163],a[48:51],v[72:75]
s_nop 0
T a[124:125],v4,8192
T a[126:127],v4,9216
M v[72:75],a[164:167],a[52:55],v[72:75]
M v[76:79],a[164:167],a[60:63],v[76:79]
buffer_load_dwordx4 v11, s[16:19], s21 offen offset:3072  nt lds
M v[76:79],a[160:163],a[56:59],v[76:79]
SA s21,s21,524160
M v[80:83],a[160:163],a[64:67],v[80:83]
M v[80:83],a[164:167],a[68:71],v[80:83]
M v[84:87],a[164:167],a[76:79],v[84:87]
M v[84:87],a[160:163],a[72:75],v[84:87]
M v[88:91],a[160:163],a[80:83],v[88:91]
M v[88:91],a[164:167],a[84:87],v[88:91]
s_waitcnt lgkmcnt(2)
M v[92:95],a[164:167],a[92:95],v[92:95]
s_waitcnt vmcnt(17) lgkmcnt(0)
M v[92:95],a[160:163],a[88:91],v[92:95]
s_barrier
M v[124:127],a[168:171],a[88:91],v[124:127]
R a[160:163],v5,49152
R a[164:167],v6,49152
M v[124:127],a[172:175],a[92:95],v[124:127]
M v[120:123],a[172:175],a[84:87],v[120:123]
SA m0,s24,32768
T a[128:129],v1,16384
T a[130:131],v1,17408
M v[120:123],a[168:171],a[80:83],v[120:123]
buffer_load_dwordx4 v12, s[48:51], s22 offen offset:0   lds
M v[116:119],a[168:171],a[72:75],v[116:119]
v_min_u32 v16, 40, v0
v_lshlrev_b32 v16, 2, v16
M v[116:119],a[172:175],a[76:79],v[116:119]
buffer_load_dword v17, v16, s[12:15], 0 offen sc1
M v[112:115],a[172:175],a[68:71],v[112:115]
M v[112:115],a[168:171],a[64:67],v[112:115]
M v[108:111],a[168:171],a[56:59],v[108:111]
M v[108:111],a[172:175],a[60:63],v[108:111]
s_nop 0
T a[132:133],v1,24576
T a[134:135],v1,25600
M v[104:107],a[172:175],a[52:55],v[104:107]
buffer_load_dwordx4 v13, s[48:51], s22 offen offset:1024   lds
M v[104:107],a[168:171],a[48:51],v[104:107]
M v[100:103],a[168:171],a[40:43],v[100:103]
M v[100:103],a[172:175],a[44:47],v[100:103]
s_waitcnt lgkmcnt(4)
M v[96:99],a[172:175],a[36:39],v[96:99]
M v[96:99],a[168:171],a[32:35],v[96:99]
M v[128:131],a[160:163],a[32:35],v[128:131]
R a[168:171],v5,51200
R a[172:175],v6,51200
M v[128:131],a[164:167],a[36:39],v[128:131]
T a[136:137],v2,16384
T a[138:139],v2,17408
M v[132:135],a[164:167],a[44:47],v[132:135]
buffer_load_dwordx4 v14, s[48:51], s22 offen offset:2048   lds
M v[132:135],a[160:163],a[40:43],v[132:135]
M v[136:139],a[160:163],a[48:51],v[136:139]
M v[136:139],a[164:167],a[52:55],v[136:139]
M v[140:143],a[164:167],a[60:63],v[140:143]
M v[140:143],a[160:163],a[56:59],v[140:143]
s_nop 0
T a[140:141],v2,24576
T a[142:143],v2,25600
M v[144:147],a[160:163],a[64:67],v[144:147]
buffer_load_dwordx4 v15, s[48:51], s22 offen offset:3072   lds
M v[144:147],a[164:167],a[68:71],v[144:147]
SA s22,s22,1048576
M v[148:151],a[164:167],a[76:79],v[148:151]
M v[148:151],a[160:163],a[72:75],v[148:151]
M v[152:155],a[160:163],a[80:83],v[152:155]
M v[152:155],a[164:167],a[84:87],v[152:155]
s_waitcnt lgkmcnt(4)
M v[156:159],a[164:167],a[92:95],v[156:159]
SA m0,s23,0
T a[144:145],v3,16384
T a[146:147],v3,17408
M v[156:159],a[160:163],a[88:91],v[156:159]
buffer_load_dwordx4 v8, s[16:19], s21 offen offset:0  nt lds
M v[188:191],a[168:171],a[88:91],v[188:191]
R a[160:163],v5,53248
R a[164:167],v6,53248
M v[188:191],a[172:175],a[92:95],v[188:191]
buffer_load_dword a240, v26, s[60:63], s27 offen offset:0
M v[184:187],a[172:175],a[84:87],v[184:187]
SA s27,s27,2048
M v[184:187],a[168:171],a[80:83],v[184:187]
M v[180:183],a[168:171],a[72:75],v[180:183]
M v[180:183],a[172:175],a[76:79],v[180:183]
s_nop 0
T a[148:149],v3,24576
T a[150:151],v3,25600
M v[176:179],a[172:175],a[68:71],v[176:179]
buffer_load_dwordx4 v9, s[16:19], s21 offen offset:1024  nt lds
M v[176:179],a[168:171],a[64:67],v[176:179]
M v[172:175],a[168:171],a[56:59],v[172:175]
M v[172:175],a[172:175],a[60:63],v[172:175]
M v[168:171],a[172:175],a[52:55],v[168:171]
M v[168:171],a[168:171],a[48:51],v[168:171]
M v[164:167],a[168:171],a[40:43],v[164:167]
s_nop 0
T a[152:153],v4,16384
T a[154:155],v4,17408
M v[164:167],a[172:175],a[44:47],v[164:167]
s_waitcnt lgkmcnt(4)
buffer_load_dwordx4 v10, s[16:19], s21 offen offset:2048  nt lds
M v[160:163],a[172:175],a[36:39],v[160:163]
M v[160:163],a[168:171],a[32:35],v[160:163]
M v[192:195],a[160:163],a[32:35],v[192:195]
L_w_kv12:
s_cbranch_execz L_w_kv16
R a[168:171],v5,55296
R a[172:175],v6,55296
M v[192:195],a[164:167],a[36:39],v[192:195]
M v[196:199],a[164:167],a[44:47],v[196:199]
M v[196:199],a[160:163],a[40:43],v[196:199]
s_nop 0
T a[156:157],v4,24576
T a[158:159],v4,25600
M v[200:203],a[160:163],a[48:51],v[200:203]
buffer_load_dwordx4 v11, s[16:19], s21 offen offset:3072  nt lds
M v[200:203],a[164:167],a[52:55],v[200:203]
SA s21,s21,128
M v[204:207],a[164:167],a[60:63],v[204:207]
M v[204:207],a[160:163],a[56:59],v[204:207]
M v[208:211],a[160:163],a[64:67],v[208:211]
M v[208:211],a[164:167],a[68:71],v[208:211]
M v[212:215],a[164:167],a[76:79],v[212:215]
M v[212:215],a[160:163],a[72:75],v[212:215]
M v[216:219],a[160:163],a[80:83],v[216:219]
M v[216:219],a[164:167],a[84:87],v[216:219]
s_waitcnt lgkmcnt(2)
M v[220:223],a[164:167],a[92:95],v[220:223]
s_waitcnt vmcnt(19) lgkmcnt(0)
M v[220:223],a[160:163],a[88:91],v[220:223]
s_barrier
M v[252:255],a[168:171],a[88:91],v[252:255]
R a[160:163],v5,0
R a[164:167],v6,0
M v[252:255],a[172:175],a[92:95],v[252:255]
M v[248:251],a[172:175],a[84:87],v[248:251]
M v[248:251],a[168:171],a[80:83],v[248:251]
M v[244:247],a[168:171],a[72:75],v[244:247]
M v[244:247],a[172:175],a[76:79],v[244:247]
M v[240:243],a[172:175],a[68:71],v[240:243]
M v[240:243],a[168:171],a[64:67],v[240:243]
M v[236:239],a[168:171],a[56:59],v[236:239]
M v[236:239],a[172:175],a[60:63],v[236:239]
M v[232:235],a[172:175],a[52:55],v[232:235]
M v[232:235],a[168:171],a[48:51],v[232:235]
M v[228:231],a[168:171],a[40:43],v[228:231]
M v[228:231],a[172:175],a[44:47],v[228:231]
s_waitcnt lgkmcnt(0)
M v[224:227],a[172:175],a[36:39],v[224:227]
M v[224:227],a[168:171],a[32:35],v[224:227]
M a[0:3],a[160:163],a[96:99],a[0:3]
R a[168:171],v5,2048
R a[172:175],v6,2048
M a[0:3],a[164:167],a[100:103],a[0:3]
T a[32:33],v1,32768
T a[34:35],v1,33792
M a[4:7],a[164:167],a[108:111],a[4:7]
SA m0,s24,49152
M a[4:7],a[160:163],a[104:107],a[4:7]
buffer_load_dwordx4 v12, s[48:51], s22 offen offset:0   lds
M a[8:11],a[160:163],a[112:115],a[8:11]
M a[8:11],a[164:167],a[116:119],a[8:11]
M a[12:15],a[164:167],a[124:127],a[12:15]
s_nop 0
T a[36:37],v1,40960
T a[38:39],v1,41984
M a[12:15],a[160:163],a[120:123],a[12:15]
M a[16:19],a[160:163],a[128:131],a[16:19]
buffer_load_dwordx4 v13, s[48:51], s22 offen offset:1024   lds
M a[16:19],a[164:167],a[132:135],a[16:19]
M a[20:23],a[164:167],a[140:143],a[20:23]
M a[20:23],a[160:163],a[136:139],a[20:23]
s_nop 0
T a[40:41],v2,32768
T a[42:43],v2,33792
M a[24:27],a[160:163],a[144:147],a[24:27]
M a[24:27],a[164:167],a[148:151],a[24:27]
s_waitcnt lgkmcnt(6)
buffer_load_dwordx4 v14, s[48:51], s22 offen offset:2048   lds
M a[28:31],a[164:167],a[156:159],a[28:31]
M a[28:31],a[160:163],a[152:155],a[28:31]
M v[60:63],a[168:171],a[152:155],v[60:63]
R a[160:163],v5,4096
R a[164:167],v6,4096
M v[60:63],a[172:175],a[156:159],v[60:63]
T a[44:45],v2,40960
T a[46:47],v2,41984
M v[56:59],a[172:175],a[148:151],v[56:59]
buffer_load_dwordx4 v15, s[48:51], s22 offen offset:3072   lds
M v[56:59],a[168:171],a[144:147],v[56:59]
s_sub_u32 s22, s22, 1048448
M v[52:55],a[168:171],a[136:139],v[52:55]
M v[52:55],a[172:175],a[140:143],v[52:55]
s_nop 0
T a[48:49],v3,32768
T a[50:51],v3,33792
M v[48:51],a[172:175],a[132:135],v[48:51]
SA m0,s23,16384
M v[48:51],a[168:171],a[128:131],v[48:51]
buffer_load_dwordx4 v8, s[16:19], s21 offen offset:0  nt lds
M v[44:47],a[168:171],a[120:123],v[44:47]
M v[44:47],a[172:175],a[124:127],v[44:47]
M v[40:43],a[172:175],a[116:119],v[40:43]
s_nop 0
T a[52:53],v3,40960
T a[54:55],v3,41984
M v[40:43],a[168:171],a[112:115],v[40:43]
M v[36:39],a[168:171],a[104:107],v[36:39]
buffer_load_dwordx4 v9, s[16:19], s21 offen offset:1024  nt lds
M v[36:39],a[172:175],a[108:111],v[36:39]
s_waitcnt lgkmcnt(6)
M v[32:35],a[172:175],a[100:103],v[32:35]
M v[32:35],a[168:171],a[96:99],v[32:35]
s_nop 0
T a[56:57],v4,32768
T a[58:59],v4,33792
M v[64:67],a[160:163],a[96:99],v[64:67]
R a[168:171],v5,6144
R a[172:175],v6,6144
M v[64:67],a[164:167],a[100:103],v[64:67]
buffer_load_dwordx4 v10, s[16:19], s21 offen offset:2048  nt lds
M v[68:71],a[164:167],a[108:111],v[68:71]
M v[68:71],a[160:163],a[104:107],v[68:71]
M v[72:75],a[160:163],a[112:115],v[72:75]
s_nop 0
T a[60:61],v4,40960
T a[62:63],v4,41984
M v[72:75],a[164:167],a[116:119],v[72:75]
M v[76:79],a[164:167],a[124:127],v[76:79]
buffer_load_dwordx4 v11, s[16:19], s21 offen offset:3072  nt lds
M v[76:79],a[160:163],a[120:123],v[76:79]
SA s21,s21,524160
M v[80:83],a[160:163],a[128:131],v[80:83]
M v[80:83],a[164:167],a[132:135],v[80:83]
M v[84:87],a[164:167],a[140:143],v[84:87]
M v[84:87],a[160:163],a[136:139],v[84:87]
M v[88:91],a[160:163],a[144:147],v[88:91]
M v[88:91],a[164:167],a[148:151],v[88:91]
s_waitcnt lgkmcnt(2)
M v[92:95],a[164:167],a[156:159],v[92:95]
s_waitcnt vmcnt(18) lgkmcnt(0)
M v[92:95],a[160:163],a[152:155],v[92:95]
s_barrier
M v[124:127],a[168:171],a[152:155],v[124:127]
R a[160:163],v5,16384
R a[164:167],v6,16384
M v[124:127],a[172:175],a[156:159],v[124:127]
M v[120:123],a[172:175],a[148:151],v[120:123]
SA m0,s24,0
T a[64:65],v1,49152
T a[66:67],v1,50176
M v[120:123],a[168:171],a[144:147],v[120:123]
buffer_load_dwordx4 v12, s[48:51], s22 offen offset:0   lds
M v[116:119],a[168:171],a[136:139],v[116:119]
M v[116:119],a[172:175],a[140:143],v[116:119]
M v[112:115],a[172:175],a[132:135],v[112:115]
M v[112:115],a[168:171],a[128:131],v[112:115]
M v[108:111],a[168:171],a[120:123],v[108:111]
M v[108:111],a[172:175],a[124:127],v[108:111]
s_nop 0
T a[68:69],v1,57344
T a[70:71],v1,58368
M v[104:107],a[172:175],a[116:119],v[104:107]
buffer_load_dwordx4 v13, s[48:51], s22 offen offset:1024   lds
M v[104:107],a[168:171],a[112:115],v[104:107]
M v[100:103],a[168:171],a[104:107],v[100:103]
M v[100:103],a[172:175],a[108:111],v[100:103]
s_waitcnt lgkmcnt(4)
M v[96:99],a[172:175],a[100:103],v[96:99]
M v[96:99],a[168:171],a[96:99],v[96:99]
M v[128:131],a[160:163],a[96:99],v[128:131]
R a[168:171],v5,18432
R a[172:175],v6,18432
M v[128:131],a[164:167],a[100:103],v[128:131]
T a[72:73],v2,49152
T a[74:75],v2,50176
M v[132:135],a[164:167],a[108:111],v[132:135]
buffer_load_dwordx4 v14, s[48:51], s22 offen offset:2048   lds
M v[132:135],a[160:163],a[104:107],v[132:135]
M v[136:139],a[160:163],a[112:115],v[136:139]
M v[136:139],a[164:167],a[116:119],v[136:139]
M v[140:143],a[164:167],a[124:127],v[140:143]
M v[140:143],a[160:163],a[120:123],v[140:143]
s_nop 0
T a[76:77],v2,57344
T a[78:79],v2,58368
M v[144:147],a[160:163],a[128:131],v[144:147]
buffer_load_dwordx4 v15, s[48:51], s22 offen offset:3072   lds
M v[144:147],a[164:167],a[132:135],v[144:147]
SA s22,s22,1048576
M v[148:151],a[164:167],a[140:143],v[148:151]
M v[148:151],a[160:163],a[136:139],v[148:151]
M v[152:155],a[160:163],a[144:147],v[152:155]
M v[152:155],a[164:167],a[148:151],v[152:155]
s_waitcnt lgkmcnt(4)
M v[156:159],a[164:167],a[156:159],v[156:159]
SA m0,s23,32768
T a[80:81],v3,49152
T a[82:83],v3,50176
M v[156:159],a[160:163],a[152:155],v[156:159]
buffer_load_dwordx4 v8, s[16:19], s21 offen offset:0  nt lds
M v[188:191],a[168:171],a[152:155],v[188:191]
R a[160:163],v5,20480
R a[164:167],v6,20480
M v[188:191],a[172:175],a[156:159],v[188:191]
buffer_load_dword a240, v26, s[60:63], s27 offen offset:0
M v[184:187],a[172:175],a[148:151],v[184:187]
SA s27,s27,2048
M v[184:187],a[168:171],a[144:147],v[184:187]
M v[180:183],a[168:171],a[136:139],v[180:183]
M v[180:183],a[172:175],a[140:143],v[180:183]
s_nop 0
T a[84:85],v3,57344
T a[86:87],v3,58368
M v[176:179],a[172:175],a[132:135],v[176:179]
buffer_load_dwordx4 v9, s[16:19], s21 offen offset:1024  nt lds
M v[176:179],a[168:171],a[128:131],v[176:179]
M v[172:175],a[168:171],a[120:123],v[172:175]
M v[172:175],a[172:175],a[124:127],v[172:175]
M v[168:171],a[172:175],a[116:119],v[168:171]
M v[168:171],a[168:171],a[112:115],v[168:171]
M v[164:167],a[168:171],a[104:107],v[164:167]
s_nop 0
T a[88:89],v4,49152
T a[90:91],v4,50176
M v[164:167],a[172:175],a[108:111],v[164:167]
s_waitcnt lgkmcnt(4)
buffer_load_dwordx4 v10, s[16:19], s21 offen offset:2048  nt lds
M v[160:163],a[172:175],a[100:103],v[160:163]
M v[160:163],a[168:171],a[96:99],v[160:163]
M v[192:195],a[160:163],a[96:99],v[192:195]
R a[168:171],v5,22528
R a[172:175],v6,22528
M v[192:195],a[164:167],a[100:103],v[192:195]
M v[196:199],a[164:167],a[108:111],v[196:199]
M v[196:199],a[160:163],a[104:107],v[196:199]
s_nop 0
T a[92:93],v4,57344
T a[94:95],v4,58368
M v[200:203],a[160:163],a[112:115],v[200:203]
buffer_load_dwordx4 v11, s[16:19], s21 offen offset:3072  nt lds
M v[200:203],a[164:167],a[116:119],v[200:203]
SA s21,s21,128
M v[204:207],a[164:167],a[124:127],v[204:207]
M v[204:207],a[160:163],a[120:123],v[204:207]
M v[208:211],a[160:163],a[128:131],v[208:211]
M v[208:211],a[164:167],a[132:135],v[208:211]
M v[212:215],a[164:167],a[140:143],v[212:215]
M v[212:215],a[160:163],a[136:139],v[212:215]
M v[216:219],a[160:163],a[144:147],v[216:219]
M v[216:219],a[164:167],a[148:151],v[216:219]
s_waitcnt lgkmcnt(2)
M v[220:223],a[164:167],a[156:159],v[220:223]
s_waitcnt vmcnt(17) lgkmcnt(0)
M v[220:223],a[160:163],a[152:155],v[220:223]
s_barrier
M v[252:255],a[168:171],a[152:155],v[252:255]
R a[160:163],v5,32768
R a[164:167],v6,32768
M v[252:255],a[172:175],a[156:159],v[252:255]
v_cmp_ne_u32 vcc, 1, v17
M v[248:251],a[172:175],a[148:151],v[248:251]
s_nop 0
M v[248:251],a[168:171],a[144:147],v[248:251]
s_cbranch_vccnz L_zs1
L_zr1:
M v[244:247],a[168:171],a[136:139],v[244:247]
M v[244:247],a[172:175],a[140:143],v[244:247]
s_lshl_b32 s72, s30, 6
M v[240:243],a[172:175],a[132:135],v[240:243]
SA s72,s72,104914944
M v[240:243],a[168:171],a[128:131],v[240:243]
buffer_store_dword v19, v18, s[8:11], s72 offen sc1
M v[236:239],a[168:171],a[120:123],v[236:239]
M v[236:239],a[172:175],a[124:127],v[236:239]
M v[232:235],a[172:175],a[116:119],v[232:235]
M v[232:235],a[168:171],a[112:115],v[232:235]
M v[228:231],a[168:171],a[104:107],v[228:231]
M v[228:231],a[172:175],a[108:111],v[228:231]
s_waitcnt lgkmcnt(0)
M v[224:227],a[172:175],a[100:103],v[224:227]
M v[224:227],a[168:171],a[96:99],v[224:227]
M a[0:3],a[160:163],a[32:35],a[0:3]
R a[168:171],v5,34816
R a[172:175],v6,34816
M a[0:3],a[164:167],a[36:39],a[0:3]
T a[96:97],v1,0
T a[98:99],v1,1024
M a[4:7],a[164:167],a[44:47],a[4:7]
SA m0,s24,16384
M a[4:7],a[160:163],a[40:43],a[4:7]
buffer_load_dwordx4 v12, s[48:51], s22 offen offset:0   lds
M a[8:11],a[160:163],a[48:51],a[8:11]
M a[8:11],a[164:167],a[52:55],a[8:11]
s_mul_i32 s64, s41, 229376
M a[12:15],a[164:167],a[60:63],a[12:15]
SA s72,s90,s64
T a[100:101],v1,8192
T a[102:103],v1,9216
M a[12:15],a[160:163],a[56:59],a[12:15]
s_addc_u32 s73, s91, 0
M a[16:19],a[160:163],a[64:67],a[16:19]
s_sub_u32 s75, 3670016, s64
buffer_load_dwordx4 v13, s[48:51], s22 offen offset:1024   lds
M a[16:19],a[164:167],a[68:71],a[16:19]
s_mov_b32 s12, s72
M a[20:23],a[164:167],a[76:79],a[20:23]
s_and_b32 s13, s73, 0xffff
M a[20:23],a[160:163],a[72:75],a[20:23]
s_mov_b32 s14, s75
T a[104:105],v2,0
T a[106:107],v2,1024
M a[24:27],a[160:163],a[80:83],a[24:27]
s_mov_b32 s15, 0x20000
M a[24:27],a[164:167],a[84:87],a[24:27]
s_waitcnt lgkmcnt(6)
buffer_load_dwordx4 v14, s[48:51], s22 offen offset:2048   lds
M a[28:31],a[164:167],a[92:95],a[28:31]
M a[28:31],a[160:163],a[88:91],a[28:31]
M v[60:63],a[168:171],a[88:91],v[60:63]
R a[160:163],v5,36864
R a[164:167],v6,36864
M v[60:63],a[172:175],a[92:95],v[60:63]
T a[108:109],v2,8192
T a[110:111],v2,9216
M v[56:59],a[172:175],a[84:87],v[56:59]
buffer_load_dwordx4 v15, s[48:51], s22 offen offset:3072   lds
M v[56:59],a[168:171],a[80:83],v[56:59]
s_sub_u32 s22, s22, 1048448
M v[52:55],a[168:171],a[72:75],v[52:55]
M v[52:55],a[172:175],a[76:79],v[52:55]
s_nop 0
T a[112:113],v3,0
T a[114:115],v3,1024
M v[48:51],a[172:175],a[68:71],v[48:51]
SA m0,s23,49152
M v[48:51],a[168:171],a[64:67],v[48:51]
buffer_load_dwordx4 v8, s[16:19], s21 offen offset:0  nt lds
M v[44:47],a[168:171],a[56:59],v[44:47]
M v[44:47],a[172:175],a[60:63],v[44:47]
M v[40:43],a[172:175],a[52:55],v[40:43]
s_nop 0
T a[116:117],v3,8192
T a[118:119],v3,9216
M v[40:43],a[168:171],a[48:51],v[40:43]
M v[36:39],a[168:171],a[40:43],v[36:39]
buffer_load_dwordx4 v9, s[16:19], s21 offen offset:1024  nt lds
M v[36:39],a[172:175],a[44:47],v[36:39]
s_waitcnt lgkmcnt(6)
M v[32:35],a[172:175],a[36:39],v[32:35]
M v[32:35],a[168:171],a[32:35],v[32:35]
s_nop 0
T a[120:121],v4,0
T a[122:123],v4,1024
M v[64:67],a[160:163],a[32:35],v[64:67]
R a[168:171],v5,38912
R a[172:175],v6,38912
M v[64:67],a[164:167],a[36:39],v[64:67]
buffer_load_dwordx4 v10, s[16:19], s21 offen offset:2048  nt lds
M v[68:71],a[164:167],a[44:47],v[68:71]
M v[68:71],a[160:163],a[40:43],v[68:71]
M v[72:75],a[160:163],a[48:51],v[72:75]
s_nop 0
T a[124:125],v4,8192
T a[126:127],v4,9216
M v[72:75],a[164:167],a[52:55],v[72:75]
M v[76:79],a[164:167],a[60:63],v[76:79]
buffer_load_dwordx4 v11, s[16:19], s21 offen offset:3072  nt lds
M v[76:79],a[160:163],a[56:59],v[76:79]
SA s21,s21,524160
M v[80:83],a[160:163],a[64:67],v[80:83]
M v[80:83],a[164:167],a[68:71],v[80:83]
M v[84:87],a[164:167],a[76:79],v[84:87]
M v[84:87],a[160:163],a[72:75],v[84:87]
M v[88:91],a[160:163],a[80:83],v[88:91]
M v[88:91],a[164:167],a[84:87],v[88:91]
s_waitcnt lgkmcnt(2)
M v[92:95],a[164:167],a[92:95],v[92:95]
s_waitcnt vmcnt(18) lgkmcnt(0)
M v[92:95],a[160:163],a[88:91],v[92:95]
s_barrier
M v[124:127],a[168:171],a[88:91],v[124:127]
R a[160:163],v5,49152
R a[164:167],v6,49152
M v[124:127],a[172:175],a[92:95],v[124:127]
M v[120:123],a[172:175],a[84:87],v[120:123]
SA m0,s24,32768
T a[128:129],v1,16384
T a[130:131],v1,17408
M v[120:123],a[168:171],a[80:83],v[120:123]
buffer_load_dwordx4 v12, s[48:51], s22 offen offset:0   lds
M v[116:119],a[168:171],a[72:75],v[116:119]
M v[116:119],a[172:175],a[76:79],v[116:119]
M v[112:115],a[172:175],a[68:71],v[112:115]
M v[112:115],a[168:171],a[64:67],v[112:115]
M v[108:111],a[168:171],a[56:59],v[108:111]
M v[108:111],a[172:175],a[60:63],v[108:111]
s_nop 0
T a[132:133],v1,24576
T a[134:135],v1,25600
M v[104:107],a[172:175],a[52:55],v[104:107]
buffer_load_dwordx4 v13, s[48:51], s22 offen offset:1024   lds
M v[104:107],a[168:171],a[48:51],v[104:107]
M v[100:103],a[168:171],a[40:43],v[100:103]
M v[100:103],a[172:175],a[44:47],v[100:103]
s_waitcnt lgkmcnt(4)
M v[96:99],a[172:175],a[36:39],v[96:99]
M v[96:99],a[168:171],a[32:35],v[96:99]
M v[128:131],a[160:163],a[32:35],v[128:131]
R a[168:171],v5,51200
R a[172:175],v6,51200
M v[128:131],a[164:167],a[36:39],v[128:131]
T a[136:137],v2,16384
T a[138:139],v2,17408
M v[132:135],a[164:167],a[44:47],v[132:135]
buffer_load_dwordx4 v14, s[48:51], s22 offen offset:2048   lds
M v[132:135],a[160:163],a[40:43],v[132:135]
M v[136:139],a[160:163],a[48:51],v[136:139]
M v[136:139],a[164:167],a[52:55],v[136:139]
M v[140:143],a[164:167],a[60:63],v[140:143]
M v[140:143],a[160:163],a[56:59],v[140:143]
s_nop 0
T a[140:141],v2,24576
T a[142:143],v2,25600
M v[144:147],a[160:163],a[64:67],v[144:147]
buffer_load_dwordx4 v15, s[48:51], s22 offen offset:3072   lds
M v[144:147],a[164:167],a[68:71],v[144:147]
SA s22,s22,1048576
M v[148:151],a[164:167],a[76:79],v[148:151]
M v[148:151],a[160:163],a[72:75],v[148:151]
M v[152:155],a[160:163],a[80:83],v[152:155]
M v[152:155],a[164:167],a[84:87],v[152:155]
s_waitcnt lgkmcnt(4)
M v[156:159],a[164:167],a[92:95],v[156:159]
SA m0,s23,0
T a[144:145],v3,16384
T a[146:147],v3,17408
M v[156:159],a[160:163],a[88:91],v[156:159]
buffer_load_dwordx4 v8, s[16:19], s21 offen offset:0  nt lds
M v[188:191],a[168:171],a[88:91],v[188:191]
R a[160:163],v5,53248
R a[164:167],v6,53248
M v[188:191],a[172:175],a[92:95],v[188:191]
buffer_load_dword a240, v26, s[60:63], s27 offen offset:0
M v[184:187],a[172:175],a[84:87],v[184:187]
SA s27,s27,2048
M v[184:187],a[168:171],a[80:83],v[184:187]
M v[180:183],a[168:171],a[72:75],v[180:183]
M v[180:183],a[172:175],a[76:79],v[180:183]
s_nop 0
T a[148:149],v3,24576
T a[150:151],v3,25600
M v[176:179],a[172:175],a[68:71],v[176:179]
buffer_load_dwordx4 v9, s[16:19], s21 offen offset:1024  nt lds
M v[176:179],a[168:171],a[64:67],v[176:179]
M v[172:175],a[168:171],a[56:59],v[172:175]
M v[172:175],a[172:175],a[60:63],v[172:175]
M v[168:171],a[172:175],a[52:55],v[168:171]
M v[168:171],a[168:171],a[48:51],v[168:171]
M v[164:167],a[168:171],a[40:43],v[164:167]
s_nop 0
T a[152:153],v4,16384
T a[154:155],v4,17408
M v[164:167],a[172:175],a[44:47],v[164:167]
s_waitcnt lgkmcnt(4)
buffer_load_dwordx4 v10, s[16:19], s21 offen offset:2048  nt lds
M v[160:163],a[172:175],a[36:39],v[160:163]
M v[160:163],a[168:171],a[32:35],v[160:163]
M v[192:195],a[160:163],a[32:35],v[192:195]
R a[168:171],v5,55296
R a[172:175],v6,55296
M v[192:195],a[164:167],a[36:39],v[192:195]
M v[196:199],a[164:167],a[44:47],v[196:199]
M v[196:199],a[160:163],a[40:43],v[196:199]
s_nop 0
T a[156:157],v4,24576
T a[158:159],v4,25600
M v[200:203],a[160:163],a[48:51],v[200:203]
buffer_load_dwordx4 v11, s[16:19], s21 offen offset:3072  nt lds
M v[200:203],a[164:167],a[52:55],v[200:203]
SA s21,s21,128
M v[204:207],a[164:167],a[60:63],v[204:207]
M v[204:207],a[160:163],a[56:59],v[204:207]
M v[208:211],a[160:163],a[64:67],v[208:211]
M v[208:211],a[164:167],a[68:71],v[208:211]
M v[212:215],a[164:167],a[76:79],v[212:215]
M v[212:215],a[160:163],a[72:75],v[212:215]
M v[216:219],a[160:163],a[80:83],v[216:219]
M v[216:219],a[164:167],a[84:87],v[216:219]
s_waitcnt lgkmcnt(2)
M v[220:223],a[164:167],a[92:95],v[220:223]
s_waitcnt vmcnt(18) lgkmcnt(0)
M v[220:223],a[160:163],a[88:91],v[220:223]
s_barrier
M v[252:255],a[168:171],a[88:91],v[252:255]
R a[160:163],v5,0
R a[164:167],v6,0
M v[252:255],a[172:175],a[92:95],v[252:255]
M v[248:251],a[172:175],a[84:87],v[248:251]
M v[248:251],a[168:171],a[80:83],v[248:251]
M v[244:247],a[168:171],a[72:75],v[244:247]
M v[244:247],a[172:175],a[76:79],v[244:247]
M v[240:243],a[172:175],a[68:71],v[240:243]
M v[240:243],a[168:171],a[64:67],v[240:243]
M v[236:239],a[168:171],a[56:59],v[236:239]
M v[236:239],a[172:175],a[60:63],v[236:239]
M v[232:235],a[172:175],a[52:55],v[232:235]
M v[232:235],a[168:171],a[48:51],v[232:235]
M v[228:231],a[168:171],a[40:43],v[228:231]
M v[228:231],a[172:175],a[44:47],v[228:231]
s_waitcnt lgkmcnt(0)
M v[224:227],a[172:175],a[36:39],v[224:227]
M v[224:227],a[168:171],a[32:35],v[224:227]
M a[0:3],a[160:163],a[96:99],a[0:3]
R a[168:171],v5,2048
R a[172:175],v6,2048
M a[0:3],a[164:167],a[100:103],a[0:3]
T a[32:33],v1,32768
T a[34:35],v1,33792
M a[4:7],a[164:167],a[108:111],a[4:7]
SA m0,s24,49152
M a[4:7],a[160:163],a[104:107],a[4:7]
buffer_load_dwordx4 v12, s[48:51], s22 offen offset:0   lds
M a[8:11],a[160:163],a[112:115],a[8:11]
M a[8:11],a[164:167],a[116:119],a[8:11]
M a[12:15],a[164:167],a[124:127],a[12:15]
s_nop 0
T a[36:37],v1,40960
T a[38:39],v1,41984
M a[12:15],a[160:163],a[120:123],a[12:15]
M a[16:19],a[160:163],a[128:131],a[16:19]
buffer_load_dwordx4 v13, s[48:51], s22 offen offset:1024   lds
M a[16:19],a[164:167],a[132:135],a[16:19]
M a[20:23],a[164:167],a[140:143],a[20:23]
M a[20:23],a[160:163],a[136:139],a[20:23]
s_nop 0
T a[40:41],v2,32768
T a[42:43],v2,33792
M a[24:27],a[160:163],a[144:147],a[24:27]
M a[24:27],a[164:167],a[148:151],a[24:27]
s_waitcnt lgkmcnt(6)
buffer_load_dwordx4 v14, s[48:51], s22 offen offset:2048   lds
M a[28:31],a[164:167],a[156:159],a[28:31]
M a[28:31],a[160:163],a[152:155],a[28:31]
M v[60:63],a[168:171],a[152:155],v[60:63]
R a[160:163],v5,4096
R a[164:167],v6,4096
M v[60:63],a[172:175],a[156:159],v[60:63]
T a[44:45],v2,40960
T a[46:47],v2,41984
L_w_kv13:
s_cbranch_execz L_w_kv17
M v[56:59],a[172:175],a[148:151],v[56:59]
buffer_load_dwordx4 v15, s[48:51], s22 offen offset:3072   lds
M v[56:59],a[168:171],a[144:147],v[56:59]
s_sub_u32 s22, s22, 1048448
M v[52:55],a[168:171],a[136:139],v[52:55]
M v[52:55],a[172:175],a[140:143],v[52:55]
s_nop 0
T a[48:49],v3,32768
T a[50:51],v3,33792
M v[48:51],a[172:175],a[132:135],v[48:51]
SA m0,s23,16384
M v[48:51],a[168:171],a[128:131],v[48:51]
buffer_load_dwordx4 v8, s[16:19], s21 offen offset:0  nt lds
M v[44:47],a[168:171],a[120:123],v[44:47]
M v[44:47],a[172:175],a[124:127],v[44:47]
M v[40:43],a[172:175],a[116:119],v[40:43]
s_nop 0
T a[52:53],v3,40960
T a[54:55],v3,41984
M v[40:43],a[168:171],a[112:115],v[40:43]
M v[36:39],a[168:171],a[104:107],v[36:39]
buffer_load_dwordx4 v9, s[16:19], s21 offen offset:1024  nt lds
M v[36:39],a[172:175],a[108:111],v[36:39]
s_waitcnt lgkmcnt(6)
M v[32:35],a[172:175],a[100:103],v[32:35]
M v[32:35],a[168:171],a[96:99],v[32:35]
s_nop 0
T a[56:57],v4,32768
T a[58:59],v4,33792
M v[64:67],a[160:163],a[96:99],v[64:67]
R a[168:171],v5,6144
R a[172:175],v6,6144
M v[64:67],a[164:167],a[100:103],v[64:67]
buffer_load_dwordx4 v10, s[16:19], s21 offen offset:2048  nt lds
M v[68:71],a[164:167],a[108:111],v[68:71]
M v[68:71],a[160:163],a[104:107],v[68:71]
M v[72:75],a[160:163],a[112:115],v[72:75]
s_nop 0
T a[60:61],v4,40960
T a[62:63],v4,41984
M v[72:75],a[164:167],a[116:119],v[72:75]
M v[76:79],a[164:167],a[124:127],v[76:79]
buffer_load_dwordx4 v11, s[16:19], s21 offen offset:3072  nt lds
M v[76:79],a[160:163],a[120:123],v[76:79]
SA s21,s21,524160
M v[80:83],a[160:163],a[128:131],v[80:83]
M v[80:83],a[164:167],a[132:135],v[80:83]
M v[84:87],a[164:167],a[140:143],v[84:87]
M v[84:87],a[160:163],a[136:139],v[84:87]
M v[88:91],a[160:163],a[144:147],v[88:91]
M v[88:91],a[164:167],a[148:151],v[88:91]
s_waitcnt lgkmcnt(2)
M v[92:95],a[164:167],a[156:159],v[92:95]
s_waitcnt vmcnt(17) lgkmcnt(0)
M v[92:95],a[160:163],a[152:155],v[92:95]
s_barrier
M v[124:127],a[168:171],a[152:155],v[124:127]
R a[160:163],v5,16384
R a[164:167],v6,16384
M v[124:127],a[172:175],a[156:159],v[124:127]
M v[120:123],a[172:175],a[148:151],v[120:123]
SA m0,s24,0
T a[64:65],v1,49152
T a[66:67],v1,50176
M v[120:123],a[168:171],a[144:147],v[120:123]
buffer_load_dwordx4 v12, s[48:51], s22 offen offset:0   lds
M v[116:119],a[168:171],a[136:139],v[116:119]
M v[116:119],a[172:175],a[140:143],v[116:119]
M v[112:115],a[172:175],a[132:135],v[112:115]
M v[112:115],a[168:171],a[128:131],v[112:115]
M v[108:111],a[168:171],a[120:123],v[108:111]
M v[108:111],a[172:175],a[124:127],v[108:111]
s_nop 0
T a[68:69],v1,57344
T a[70:71],v1,58368
M v[104:107],a[172:175],a[116:119],v[104:107]
buffer_load_dwordx4 v13, s[48:51], s22 offen offset:1024   lds
M v[104:107],a[168:171],a[112:115],v[104:107]
M v[100:103],a[168:171],a[104:107],v[100:103]
M v[100:103],a[172:175],a[108:111],v[100:103]
s_waitcnt lgkmcnt(4)
M v[96:99],a[172:175],a[100:103],v[96:99]
M v[96:99],a[168:171],a[96:99],v[96:99]
M v[128:131],a[160:163],a[96:99],v[128:131]
R a[168:171],v5,18432
R a[172:175],v6,18432
M v[128:131],a[164:167],a[100:103],v[128:131]
T a[72:73],v2,49152
T a[74:75],v2,50176
M v[132:135],a[164:167],a[108:111],v[132:135]
buffer_load_dwordx4 v14, s[48:51], s22 offen offset:2048   lds
M v[132:135],a[160:163],a[104:107],v[132:135]
M v[136:139],a[160:163],a[112:115],v[136:139]
M v[136:139],a[164:167],a[116:119],v[136:139]
M v[140:143],a[164:167],a[124:127],v[140:143]
M v[140:143],a[160:163],a[120:123],v[140:143]
s_nop 0
T a[76:77],v2,57344
T a[78:79],v2,58368
M v[144:147],a[160:163],a[128:131],v[144:147]
buffer_load_dwordx4 v15, s[48:51], s22 offen offset:3072   lds
M v[144:147],a[164:167],a[132:135],v[144:147]
SA s22,s22,1048576
M v[148:151],a[164:167],a[140:143],v[148:151]
M v[148:151],a[160:163],a[136:139],v[148:151]
M v[152:155],a[160:163],a[144:147],v[152:155]
M v[152:155],a[164:167],a[148:151],v[152:155]
s_waitcnt lgkmcnt(4)
M v[156:159],a[164:167],a[156:159],v[156:159]
SA m0,s23,32768
T a[80:81],v3,49152
T a[82:83],v3,50176
M v[156:159],a[160:163],a[152:155],v[156:159]
buffer_load_dwordx4 v8, s[16:19], s21 offen offset:0  nt lds
M v[188:191],a[168:171],a[152:155],v[188:191]
R a[160:163],v5,20480
R a[164:167],v6,20480
M v[188:191],a[172:175],a[156:159],v[188:191]
buffer_load_dword a240, v26, s[60:63], s27 offen offset:0
M v[184:187],a[172:175],a[148:151],v[184:187]
SA s27,s27,2048
M v[184:187],a[168:171],a[144:147],v[184:187]
M v[180:183],a[168:171],a[136:139],v[180:183]
M v[180:183],a[172:175],a[140:143],v[180:183]
s_nop 0
T a[84:85],v3,57344
T a[86:87],v3,58368
M v[176:179],a[172:175],a[132:135],v[176:179]
buffer_load_dwordx4 v9, s[16:19], s21 offen offset:1024  nt lds
M v[176:179],a[168:171],a[128:131],v[176:179]
M v[172:175],a[168:171],a[120:123],v[172:175]
M v[172:175],a[172:175],a[124:127],v[172:175]
M v[168:171],a[172:175],a[116:119],v[168:171]
M v[168:171],a[168:171],a[112:115],v[168:171]
M v[164:167],a[168:171],a[104:107],v[164:167]
s_nop 0
T a[88:89],v4,49152
T a[90:91],v4,50176
M v[164:167],a[172:175],a[108:111],v[164:167]
s_waitcnt lgkmcnt(4)
buffer_load_dwordx4 v10, s[16:19], s21 offen offset:2048  nt lds
M v[160:163],a[172:175],a[100:103],v[160:163]
M v[160:163],a[168:171],a[96:99],v[160:163]
M v[192:195],a[160:163],a[96:99],v[192:195]
R a[168:171],v5,22528
R a[172:175],v6,22528
M v[192:195],a[164:167],a[100:103],v[192:195]
M v[196:199],a[164:167],a[108:111],v[196:199]
M v[196:199],a[160:163],a[104:107],v[196:199]
s_nop 0
T a[92:93],v4,57344
T a[94:95],v4,58368
M v[200:203],a[160:163],a[112:115],v[200:203]
buffer_load_dwordx4 v11, s[16:19], s21 offen offset:3072  nt lds
M v[200:203],a[164:167],a[116:119],v[200:203]
SA s21,s21,128
M v[204:207],a[164:167],a[124:127],v[204:207]
M v[204:207],a[160:163],a[120:123],v[204:207]
M v[208:211],a[160:163],a[128:131],v[208:211]
M v[208:211],a[164:167],a[132:135],v[208:211]
M v[212:215],a[164:167],a[140:143],v[212:215]
M v[212:215],a[160:163],a[136:139],v[212:215]
M v[216:219],a[160:163],a[144:147],v[216:219]
M v[216:219],a[164:167],a[148:151],v[216:219]
s_waitcnt lgkmcnt(2)
M v[220:223],a[164:167],a[156:159],v[220:223]
s_waitcnt vmcnt(17) lgkmcnt(0)
M v[220:223],a[160:163],a[152:155],v[220:223]
s_barrier
M v[252:255],a[168:171],a[152:155],v[252:255]
R a[160:163],v5,32768
R a[164:167],v6,32768
M v[252:255],a[172:175],a[156:159],v[252:255]
M v[248:251],a[172:175],a[148:151],v[248:251]
M v[248:251],a[168:171],a[144:147],v[248:251]
M v[244:247],a[168:171],a[136:139],v[244:247]
M v[244:247],a[172:175],a[140:143],v[244:247]
M v[240:243],a[172:175],a[132:135],v[240:243]
M v[240:243],a[168:171],a[128:131],v[240:243]
M v[236:239],a[168:171],a[120:123],v[236:239]
M v[236:239],a[172:175],a[124:127],v[236:239]
M v[232:235],a[172:175],a[116:119],v[232:235]
M v[232:235],a[168:171],a[112:115],v[232:235]
M v[228:231],a[168:171],a[104:107],v[228:231]
M v[228:231],a[172:175],a[108:111],v[228:231]
s_waitcnt lgkmcnt(0)
M v[224:227],a[172:175],a[100:103],v[224:227]
M v[224:227],a[168:171],a[96:99],v[224:227]
M a[0:3],a[160:163],a[32:35],a[0:3]
R a[168:171],v5,34816
R a[172:175],v6,34816
M a[0:3],a[164:167],a[36:39],a[0:3]
T a[96:97],v1,0
T a[98:99],v1,1024
M a[4:7],a[164:167],a[44:47],a[4:7]
SA m0,s24,16384
M a[4:7],a[160:163],a[40:43],a[4:7]
buffer_load_dwordx4 v12, s[48:51], s22 offen offset:0   lds
M a[8:11],a[160:163],a[48:51],a[8:11]
M a[8:11],a[164:167],a[52:55],a[8:11]
M a[12:15],a[164:167],a[60:63],a[12:15]
s_nop 0
T a[100:101],v1,8192
T a[102:103],v1,9216
M a[12:15],a[160:163],a[56:59],a[12:15]
M a[16:19],a[160:163],a[64:67],a[16:19]
buffer_load_dwordx4 v13, s[48:51], s22 offen offset:1024   lds
M a[16:19],a[164:167],a[68:71],a[16:19]
M a[20:23],a[164:167],a[76:79],a[20:23]
M a[20:23],a[160:163],a[72:75],a[20:23]
s_nop 0
T a[104:105],v2,0
T a[106:107],v2,1024
M a[24:27],a[160:163],a[80:83],a[24:27]
M a[24:27],a[164:167],a[84:87],a[24:27]
s_waitcnt lgkmcnt(6)
buffer_load_dwordx4 v14, s[48:51], s22 offen offset:2048   lds
M a[28:31],a[164:167],a[92:95],a[28:31]
M a[28:31],a[160:163],a[88:91],a[28:31]
M v[60:63],a[168:171],a[88:91],v[60:63]
R a[160:163],v5,36864
R a[164:167],v6,36864
M v[60:63],a[172:175],a[92:95],v[60:63]
T a[108:109],v2,8192
T a[110:111],v2,9216
M v[56:59],a[172:175],a[84:87],v[56:59]
buffer_load_dwordx4 v15, s[48:51], s22 offen offset:3072   lds
M v[56:59],a[168:171],a[80:83],v[56:59]
s_sub_u32 s22, s22, 1048448
M v[52:55],a[168:171],a[72:75],v[52:55]
M v[52:55],a[172:175],a[76:79],v[52:55]
s_nop 0
T a[112:113],v3,0
T a[114:115],v3,1024
M v[48:51],a[172:175],a[68:71],v[48:51]
SA m0,s23,49152
M v[48:51],a[168:171],a[64:67],v[48:51]
buffer_load_dwordx4 v8, s[16:19], s21 offen offset:0  nt lds
M v[44:47],a[168:171],a[56:59],v[44:47]
M v[44:47],a[172:175],a[60:63],v[44:47]
M v[40:43],a[172:175],a[52:55],v[40:43]
s_nop 0
T a[116:117],v3,8192
T a[118:119],v3,9216
M v[40:43],a[168:171],a[48:51],v[40:43]
M v[36:39],a[168:171],a[40:43],v[36:39]
buffer_load_dwordx4 v9, s[16:19], s21 offen offset:1024  nt lds
M v[36:39],a[172:175],a[44:47],v[36:39]
s_waitcnt lgkmcnt(6)
M v[32:35],a[172:175],a[36:39],v[32:35]
M v[32:35],a[168:171],a[32:35],v[32:35]
s_nop 0
T a[120:121],v4,0
T a[122:123],v4,1024
M v[64:67],a[160:163],a[32:35],v[64:67]
R a[168:171],v5,38912
R a[172:175],v6,38912
M v[64:67],a[164:167],a[36:39],v[64:67]
buffer_load_dwordx4 v10, s[16:19], s21 offen offset:2048  nt lds
M v[68:71],a[164:167],a[44:47],v[68:71]
M v[68:71],a[160:163],a[40:43],v[68:71]
M v[72:75],a[160:163],a[48:51],v[72:75]
s_nop 0
T a[124:125],v4,8192
T a[126:127],v4,9216
M v[72:75],a[164:167],a[52:55],v[72:75]
M v[76:79],a[164:167],a[60:63],v[76:79]
buffer_load_dwordx4 v11, s[16:19], s21 offen offset:3072  nt lds
M v[76:79],a[160:163],a[56:59],v[76:79]
SA s21,s21,524160
M v[80:83],a[160:163],a[64:67],v[80:83]
M v[80:83],a[164:167],a[68:71],v[80:83]
M v[84:87],a[164:167],a[76:79],v[84:87]
M v[84:87],a[160:163],a[72:75],v[84:87]
M v[88:91],a[160:163],a[80:83],v[88:91]
M v[88:91],a[164:167],a[84:87],v[88:91]
s_waitcnt lgkmcnt(2)
M v[92:95],a[164:167],a[92:95],v[92:95]
s_waitcnt vmcnt(17) lgkmcnt(0)
M v[92:95],a[160:163],a[88:91],v[92:95]
s_barrier
M v[124:127],a[168:171],a[88:91],v[124:127]
R a[160:163],v5,49152
R a[164:167],v6,49152
M v[124:127],a[172:175],a[92:95],v[124:127]
M v[120:123],a[172:175],a[84:87],v[120:123]
SA m0,s24,32768
T a[128:129],v1,16384
T a[130:131],v1,17408
M v[120:123],a[168:171],a[80:83],v[120:123]
buffer_load_dwordx4 v12, s[48:51], s22 offen offset:0   lds
M v[116:119],a[168:171],a[72:75],v[116:119]
M v[116:119],a[172:175],a[76:79],v[116:119]
M v[112:115],a[172:175],a[68:71],v[112:115]
M v[112:115],a[168:171],a[64:67],v[112:115]
M v[108:111],a[168:171],a[56:59],v[108:111]
M v[108:111],a[172:175],a[60:63],v[108:111]
s_nop 0
T a[132:133],v1,24576
T a[134:135],v1,25600
M v[104:107],a[172:175],a[52:55],v[104:107]
buffer_load_dwordx4 v13, s[48:51], s22 offen offset:1024   lds
M v[104:107],a[168:171],a[48:51],v[104:107]
M v[100:103],a[168:171],a[40:43],v[100:103]
s_and_b32 s64, s42, 7
s_lshl_b32 s64, s64, 2
M v[100:103],a[172:175],a[44:47],v[100:103]
s_waitcnt lgkmcnt(4)
SA s64,s64,s20
M v[96:99],a[172:175],a[36:39],v[96:99]
s_mul_i32 s64, s64, 114688
v_bfe_u32 v28, v0, 2, 2
v_and_b32 v29, 3, v0
M v[96:99],a[168:171],a[32:35],v[96:99]
v_lshlrev_b32 v29, 7, v29
v_lshl_add_u32 v28, v28, 13, v29
M v[128:131],a[160:163],a[32:35],v[128:131]
R a[168:171],v5,51200
R a[172:175],v6,51200
M v[128:131],a[164:167],a[36:39],v[128:131]
T a[136:137],v2,16384
T a[138:139],v2,17408
M v[132:135],a[164:167],a[44:47],v[132:135]
buffer_load_dwordx4 v14, s[48:51], s22 offen offset:2048   lds
M v[132:135],a[160:163],a[40:43],v[132:135]
v_add_u32 v23, s64, v28
v_and_b32 v28, 48, v0
M v[136:139],a[160:163],a[48:51],v[136:139]
v_lshl_add_u32 v23, v28, 24, v23
M v[136:139],a[164:167],a[52:55],v[136:139]
M v[140:143],a[164:167],a[60:63],v[140:143]
M v[140:143],a[160:163],a[56:59],v[140:143]
s_nop 0
T a[140:141],v2,24576
T a[142:143],v2,25600
M v[144:147],a[160:163],a[64:67],v[144:147]
buffer_load_dwordx4 v15, s[48:51], s22 offen offset:3072   lds
M v[144:147],a[164:167],a[68:71],v[144:147]
SA s22,s22,1048576
M v[148:151],a[164:167],a[76:79],v[148:151]
M v[148:151],a[160:163],a[72:75],v[148:151]
M v[152:155],a[160:163],a[80:83],v[152:155]
M v[152:155],a[164:167],a[84:87],v[152:155]
s_waitcnt lgkmcnt(4)
M v[156:159],a[164:167],a[92:95],v[156:159]
SA m0,s23,0
T a[144:145],v3,16384
T a[146:147],v3,17408
M v[156:159],a[160:163],a[88:91],v[156:159]
buffer_load_dwordx4 v8, s[16:19], s21 offen offset:0  nt lds
M v[188:191],a[168:171],a[88:91],v[188:191]
R a[160:163],v5,53248
R a[164:167],v6,53248
M v[188:191],a[172:175],a[92:95],v[188:191]
M v[184:187],a[172:175],a[84:87],v[184:187]
M v[184:187],a[168:171],a[80:83],v[184:187]
M v[180:183],a[168:171],a[72:75],v[180:183]
M v[180:183],a[172:175],a[76:79],v[180:183]
s_nop 0
T a[148:149],v3,24576
T a[150:151],v3,25600
M v[176:179],a[172:175],a[68:71],v[176:179]
buffer_load_dwordx4 v9, s[16:19], s21 offen offset:1024  nt lds
M v[176:179],a[168:171],a[64:67],v[176:179]
M v[172:175],a[168:171],a[56:59],v[172:175]
M v[172:175],a[172:175],a[60:63],v[172:175]
M v[168:171],a[172:175],a[52:55],v[168:171]
M v[168:171],a[168:171],a[48:51],v[168:171]
M v[164:167],a[168:171],a[40:43],v[164:167]
s_nop 0
T a[152:153],v4,16384
T a[154:155],v4,17408
M v[164:167],a[172:175],a[44:47],v[164:167]
s_waitcnt lgkmcnt(4)
buffer_load_dwordx4 v10, s[16:19], s21 offen offset:2048  nt lds
M v[160:163],a[172:175],a[36:39],v[160:163]
M v[160:163],a[168:171],a[32:35],v[160:163]
M v[192:195],a[160:163],a[32:35],v[192:195]
R a[168:171],v5,55296
R a[172:175],v6,55296
M v[192:195],a[164:167],a[36:39],v[192:195]
M v[196:199],a[164:167],a[44:47],v[196:199]
M v[196:199],a[160:163],a[40:43],v[196:199]
s_nop 0
T a[156:157],v4,24576
T a[158:159],v4,25600
M v[200:203],a[160:163],a[48:51],v[200:203]
buffer_load_dwordx4 v11, s[16:19], s21 offen offset:3072  nt lds
M v[200:203],a[164:167],a[52:55],v[200:203]
SA s21,s21,128
M v[204:207],a[164:167],a[60:63],v[204:207]
M v[204:207],a[160:163],a[56:59],v[204:207]
M v[208:211],a[160:163],a[64:67],v[208:211]
M v[208:211],a[164:167],a[68:71],v[208:211]
M v[212:215],a[164:167],a[76:79],v[212:215]
M v[212:215],a[160:163],a[72:75],v[212:215]
M v[216:219],a[160:163],a[80:83],v[216:219]
M v[216:219],a[164:167],a[84:87],v[216:219]
s_waitcnt lgkmcnt(2)
M v[220:223],a[164:167],a[92:95],v[220:223]
s_waitcnt vmcnt(16) lgkmcnt(0)
M v[220:223],a[160:163],a[88:91],v[220:223]
s_barrier
M v[252:255],a[168:171],a[88:91],v[252:255]
R a[160:163],v5,0
R a[164:167],v6,0
M v[252:255],a[172:175],a[92:95],v[252:255]
buffer_load_dword a240, v23, s[52:55], 0 offen offset:0
M v[248:251],a[172:175],a[84:87],v[248:251]
v_add_u32 v23, 32768, v23
M v[248:251],a[168:171],a[80:83],v[248:251]
M v[244:247],a[168:171],a[72:75],v[244:247]
M v[244:247],a[172:175],a[76:79],v[244:247]
M v[240:243],a[172:175],a[68:71],v[240:243]
M v[240:243],a[168:171],a[64:67],v[240:243]
M v[236:239],a[168:171],a[56:59],v[236:239]
M v[236:239],a[172:175],a[60:63],v[236:239]
M v[232:235],a[172:175],a[52:55],v[232:235]
M v[232:235],a[168:171],a[48:51],v[232:235]
M v[228:231],a[168:171],a[40:43],v[228:231]
M v[228:231],a[172:175],a[44:47],v[228:231]
s_waitcnt lgkmcnt(0)
M v[224:227],a[172:175],a[36:39],v[224:227]
M v[224:227],a[168:171],a[32:35],v[224:227]
M a[0:3],a[160:163],a[96:99],a[0:3]
R a[168:171],v5,2048
R a[172:175],v6,2048
M a[0:3],a[164:167],a[100:103],a[0:3]
T a[32:33],v1,32768
T a[34:35],v1,33792
M a[4:7],a[164:167],a[108:111],a[4:7]
SA m0,s24,49152
M a[4:7],a[160:163],a[104:107],a[4:7]
buffer_load_dwordx4 v12, s[48:51], s22 offen offset:0   lds
M a[8:11],a[160:163],a[112:115],a[8:11]
M a[8:11],a[164:167],a[116:119],a[8:11]
M a[12:15],a[164:167],a[124:127],a[12:15]
s_nop 0
T a[36:37],v1,40960
T a[38:39],v1,41984
M a[12:15],a[160:163],a[120:123],a[12:15]
M a[16:19],a[160:163],a[128:131],a[16:19]
buffer_load_dwordx4 v13, s[48:51], s22 offen offset:1024   lds
M a[16:19],a[164:167],a[132:135],a[16:19]
M a[20:23],a[164:167],a[140:143],a[20:23]
M a[20:23],a[160:163],a[136:139],a[20:23]
s_nop 0
T a[40:41],v2,32768
T a[42:43],v2,33792
M a[24:27],a[160:163],a[144:147],a[24:27]
M a[24:27],a[164:167],a[148:151],a[24:27]
s_waitcnt lgkmcnt(6)
buffer_load_dwordx4 v14, s[48:51], s22 offen offset:2048   lds
M a[28:31],a[164:167],a[156:159],a[28:31]
M a[28:31],a[160:163],a[152:155],a[28:31]
M v[60:63],a[168:171],a[152:155],v[60:63]
R a[160:163],v5,4096
R a[164:167],v6,4096
M v[60:63],a[172:175],a[156:159],v[60:63]
T a[44:45],v2,40960
T a[46:47],v2,41984
M v[56:59],a[172:175],a[148:151],v[56:59]
buffer_load_dwordx4 v15, s[48:51], s22 offen offset:3072   lds
M v[56:59],a[168:171],a[144:147],v[56:59]
s_sub_u32 s22, s22, 1048448
M v[52:55],a[168:171],a[136:139],v[52:55]
M v[52:55],a[172:175],a[140:143],v[52:55]
s_nop 0
T a[48:49],v3,32768
T a[50:51],v3,33792
M v[48:51],a[172:175],a[132:135],v[48:51]
SA m0,s23,16384
M v[48:51],a[168:171],a[128:131],v[48:51]
buffer_load_dwordx4 v8, s[16:19], s21 offen offset:0  nt lds
M v[44:47],a[168:171],a[120:123],v[44:47]
M v[44:47],a[172:175],a[124:127],v[44:47]
M v[40:43],a[172:175],a[116:119],v[40:43]
s_nop 0
T a[52:53],v3,40960
T a[54:55],v3,41984
M v[40:43],a[168:171],a[112:115],v[40:43]
M v[36:39],a[168:171],a[104:107],v[36:39]
buffer_load_dwordx4 v9, s[16:19], s21 offen offset:1024  nt lds
M v[36:39],a[172:175],a[108:111],v[36:39]
s_waitcnt lgkmcnt(6)
M v[32:35],a[172:175],a[100:103],v[32:35]
M v[32:35],a[168:171],a[96:99],v[32:35]
s_nop 0
T a[56:57],v4,32768
T a[58:59],v4,33792
M v[64:67],a[160:163],a[96:99],v[64:67]
R a[168:171],v5,6144
R a[172:175],v6,6144
M v[64:67],a[164:167],a[100:103],v[64:67]
buffer_load_dwordx4 v10, s[16:19], s21 offen offset:2048  nt lds
M v[68:71],a[164:167],a[108:111],v[68:71]
M v[68:71],a[160:163],a[104:107],v[68:71]
M v[72:75],a[160:163],a[112:115],v[72:75]
s_nop 0
T a[60:61],v4,40960
T a[62:63],v4,41984
M v[72:75],a[164:167],a[116:119],v[72:75]
M v[76:79],a[164:167],a[124:127],v[76:79]
buffer_load_dwordx4 v11, s[16:19], s21 offen offset:3072  nt lds
M v[76:79],a[160:163],a[120:123],v[76:79]
SA s21,s21,524160
M v[80:83],a[160:163],a[128:131],v[80:83]
M v[80:83],a[164:167],a[132:135],v[80:83]
M v[84:87],a[164:167],a[140:143],v[84:87]
M v[84:87],a[160:163],a[136:139],v[84:87]
M v[88:91],a[160:163],a[144:147],v[88:91]
M v[88:91],a[164:167],a[148:151],v[88:91]
s_waitcnt lgkmcnt(2)
M v[92:95],a[164:167],a[156:159],v[92:95]
s_waitcnt vmcnt(17) lgkmcnt(0)
M v[92:95],a[160:163],a[152:155],v[92:95]
s_barrier
M v[124:127],a[168:171],a[152:155],v[124:127]
R a[160:163],v5,16384
R a[164:167],v6,16384
M v[124:127],a[172:175],a[156:159],v[124:127]
M v[120:123],a[172:175],a[148:151],v[120:123]
SA m0,s24,0
T a[64:65],v1,49152
T a[66:67],v1,50176
M v[120:123],a[168:171],a[144:147],v[120:123]
buffer_load_dwordx4 v12, s[48:51], s22 offen offset:0   lds
M v[116:119],a[168:171],a[136:139],v[116:119]
M v[116:119],a[172:175],a[140:143],v[116:119]
M v[112:115],a[172:175],a[132:135],v[112:115]
M v[112:115],a[168:171],a[128:131],v[112:115]
M v[108:111],a[168:171],a[120:123],v[108:111]
M v[108:111],a[172:175],a[124:127],v[108:111]
s_nop 0
T a[68:69],v1,57344
T a[70:71],v1,58368
M v[104:107],a[172:175],a[116:119],v[104:107]
buffer_load_dwordx4 v13, s[48:51], s22 offen offset:1024   lds
M v[104:107],a[168:171],a[112:115],v[104:107]
M v[100:103],a[168:171],a[104:107],v[100:103]
M v[100:103],a[172:175],a[108:111],v[100:103]
s_waitcnt lgkmcnt(4)
M v[96:99],a[172:175],a[100:103],v[96:99]
M v[96:99],a[168:171],a[96:99],v[96:99]
L_w_kv14:
s_cbranch_execz L_w_kv18
M v[128:131],a[160:163],a[96:99],v[128:131]
R a[168:171],v5,18432
R a[172:175],v6,18432
M v[128:131],a[164:167],a[100:103],v[128:131]
T a[72:73],v2,49152
T a[74:75],v2,50176
M v[132:135],a[164:167],a[108:111],v[132:135]
buffer_load_dwordx4 v14, s[48:51], s22 offen offset:2048   lds
M v[132:135],a[160:163],a[104:107],v[132:135]
M v[136:139],a[160:163],a[112:115],v[136:139]
M v[136:139],a[164:167],a[116:119],v[136:139]
M v[140:143],a[164:167],a[124:127],v[140:143]
M v[140:143],a[160:163],a[120:123],v[140:143]
s_nop 0
T a[76:77],v2,57344
T a[78:79],v2,58368
M v[144:147],a[160:163],a[128:131],v[144:147]
buffer_load_dwordx4 v15, s[48:51], s22 offen offset:3072   lds
M v[144:147],a[164:167],a[132:135],v[144:147]
SA s22,s22,1048576
M v[148:151],a[164:167],a[140:143],v[148:151]
M v[148:151],a[160:163],a[136:139],v[148:151]
M v[152:155],a[160:163],a[144:147],v[152:155]
M v[152:155],a[164:167],a[148:151],v[152:155]
s_waitcnt lgkmcnt(4)
M v[156:159],a[164:167],a[156:159],v[156:159]
SA m0,s23,32768
T a[80:81],v3,49152
T a[82:83],v3,50176
M v[156:159],a[160:163],a[152:155],v[156:159]
buffer_load_dwordx4 v8, s[16:19], s21 offen offset:0  nt lds
M v[188:191],a[168:171],a[152:155],v[188:191]
R a[160:163],v5,20480
R a[164:167],v6,20480
M v[188:191],a[172:175],a[156:159],v[188:191]
M v[184:187],a[172:175],a[148:151],v[184:187]
M v[184:187],a[168:171],a[144:147],v[184:187]
M v[180:183],a[168:171],a[136:139],v[180:183]
M v[180:183],a[172:175],a[140:143],v[180:183]
s_nop 0
T a[84:85],v3,57344
T a[86:87],v3,58368
M v[176:179],a[172:175],a[132:135],v[176:179]
buffer_load_dwordx4 v9, s[16:19], s21 offen offset:1024  nt lds
M v[176:179],a[168:171],a[128:131],v[176:179]
M v[172:175],a[168:171],a[120:123],v[172:175]
M v[172:175],a[172:175],a[124:127],v[172:175]
M v[168:171],a[172:175],a[116:119],v[168:171]
M v[168:171],a[168:171],a[112:115],v[168:171]
M v[164:167],a[168:171],a[104:107],v[164:167]
s_nop 0
T a[88:89],v4,49152
T a[90:91],v4,50176
M v[164:167],a[172:175],a[108:111],v[164:167]
s_waitcnt lgkmcnt(4)
buffer_load_dwordx4 v10, s[16:19], s21 offen offset:2048  nt lds
M v[160:163],a[172:175],a[100:103],v[160:163]
M v[160:163],a[168:171],a[96:99],v[160:163]
M v[192:195],a[160:163],a[96:99],v[192:195]
R a[168:171],v5,22528
R a[172:175],v6,22528
M v[192:195],a[164:167],a[100:103],v[192:195]
M v[196:199],a[164:167],a[108:111],v[196:199]
M v[196:199],a[160:163],a[104:107],v[196:199]
s_nop 0
T a[92:93],v4,57344
T a[94:95],v4,58368
M v[200:203],a[160:163],a[112:115],v[200:203]
buffer_load_dwordx4 v11, s[16:19], s21 offen offset:3072  nt lds
M v[200:203],a[164:167],a[116:119],v[200:203]
SA s21,s21,128
M v[204:207],a[164:167],a[124:127],v[204:207]
M v[204:207],a[160:163],a[120:123],v[204:207]
M v[208:211],a[160:163],a[128:131],v[208:211]
M v[208:211],a[164:167],a[132:135],v[208:211]
M v[212:215],a[164:167],a[140:143],v[212:215]
M v[212:215],a[160:163],a[136:139],v[212:215]
M v[216:219],a[160:163],a[144:147],v[216:219]
M v[216:219],a[164:167],a[148:151],v[216:219]
s_waitcnt lgkmcnt(2)
M v[220:223],a[164:167],a[156:159],v[220:223]
s_waitcnt vmcnt(17) lgkmcnt(0)
M v[220:223],a[160:163],a[152:155],v[220:223]
s_barrier
M v[252:255],a[168:171],a[152:155],v[252:255]
R a[160:163],v5,32768
R a[164:167],v6,32768
M v[252:255],a[172:175],a[156:159],v[252:255]
buffer_load_dword a240, v23, s[52:55], 0 offen offset:0
M v[248:251],a[172:175],a[148:151],v[248:251]
v_add_u32 v23, 32768, v23
M v[248:251],a[168:171],a[144:147],v[248:251]
M v[244:247],a[168:171],a[136:139],v[244:247]
M v[244:247],a[172:175],a[140:143],v[244:247]
M v[240:243],a[172:175],a[132:135],v[240:243]
M v[240:243],a[168:171],a[128:131],v[240:243]
M v[236:239],a[168:171],a[120:123],v[236:239]
M v[236:239],a[172:175],a[124:127],v[236:239]
M v[232:235],a[172:175],a[116:119],v[232:235]
M v[232:235],a[168:171],a[112:115],v[232:235]
M v[228:231],a[168:171],a[104:107],v[228:231]
M v[228:231],a[172:175],a[108:111],v[228:231]
s_waitcnt lgkmcnt(0)
M v[224:227],a[172:175],a[100:103],v[224:227]
M v[224:227],a[168:171],a[96:99],v[224:227]
M a[0:3],a[160:163],a[32:35],a[0:3]
R a[168:171],v5,34816
R a[172:175],v6,34816
M a[0:3],a[164:167],a[36:39],a[0:3]
T a[96:97],v1,0
T a[98:99],v1,1024
M a[4:7],a[164:167],a[44:47],a[4:7]
SA m0,s24,16384
M a[4:7],a[160:163],a[40:43],a[4:7]
buffer_load_dwordx4 v12, s[48:51], s22 offen offset:0   lds
M a[8:11],a[160:163],a[48:51],a[8:11]
M a[8:11],a[164:167],a[52:55],a[8:11]
M a[12:15],a[164:167],a[60:63],a[12:15]
s_nop 0
T a[100:101],v1,8192
T a[102:103],v1,9216
M a[12:15],a[160:163],a[56:59],a[12:15]
M a[16:19],a[160:163],a[64:67],a[16:19]
buffer_load_dwordx4 v13, s[48:51], s22 offen offset:1024   lds
M a[16:19],a[164:167],a[68:71],a[16:19]
M a[20:23],a[164:167],a[76:79],a[20:23]
M a[20:23],a[160:163],a[72:75],a[20:23]
s_nop 0
T a[104:105],v2,0
T a[106:107],v2,1024
M a[24:27],a[160:163],a[80:83],a[24:27]
M a[24:27],a[164:167],a[84:87],a[24:27]
s_waitcnt lgkmcnt(6)
buffer_load_dwordx4 v14, s[48:51], s22 offen offset:2048   lds
M a[28:31],a[164:167],a[92:95],a[28:31]
M a[28:31],a[160:163],a[88:91],a[28:31]
M v[60:63],a[168:171],a[88:91],v[60:63]
R a[160:163],v5,36864
R a[164:167],v6,36864
M v[60:63],a[172:175],a[92:95],v[60:63]
T a[108:109],v2,8192
T a[110:111],v2,9216
M v[56:59],a[172:175],a[84:87],v[56:59]
buffer_load_dwordx4 v15, s[48:51], s22 offen offset:3072   lds
M v[56:59],a[168:171],a[80:83],v[56:59]
s_sub_u32 s22, s22, 1048448
M v[52:55],a[168:171],a[72:75],v[52:55]
M v[52:55],a[172:175],a[76:79],v[52:55]
s_nop 0
T a[112:113],v3,0
T a[114:115],v3,1024
M v[48:51],a[172:175],a[68:71],v[48:51]
SA m0,s23,49152
M v[48:51],a[168:171],a[64:67],v[48:51]
buffer_load_dwordx4 v8, s[16:19], s21 offen offset:0  nt lds
M v[44:47],a[168:171],a[56:59],v[44:47]
M v[44:47],a[172:175],a[60:63],v[44:47]
M v[40:43],a[172:175],a[52:55],v[40:43]
s_nop 0
T a[116:117],v3,8192
T a[118:119],v3,9216
M v[40:43],a[168:171],a[48:51],v[40:43]
M v[36:39],a[168:171],a[40:43],v[36:39]
buffer_load_dwordx4 v9, s[16:19], s21 offen offset:1024  nt lds
M v[36:39],a[172:175],a[44:47],v[36:39]
s_waitcnt lgkmcnt(6)
M v[32:35],a[172:175],a[36:39],v[32:35]
M v[32:35],a[168:171],a[32:35],v[32:35]
s_nop 0
T a[120:121],v4,0
T a[122:123],v4,1024
M v[64:67],a[160:163],a[32:35],v[64:67]
R a[168:171],v5,38912
R a[172:175],v6,38912
M v[64:67],a[164:167],a[36:39],v[64:67]
buffer_load_dwordx4 v10, s[16:19], s21 offen offset:2048  nt lds
M v[68:71],a[164:167],a[44:47],v[68:71]
M v[68:71],a[160:163],a[40:43],v[68:71]
M v[72:75],a[160:163],a[48:51],v[72:75]
s_nop 0
T a[124:125],v4,8192
T a[126:127],v4,9216
M v[72:75],a[164:167],a[52:55],v[72:75]
M v[76:79],a[164:167],a[60:63],v[76:79]
buffer_load_dwordx4 v11, s[16:19], s21 offen offset:3072  nt lds
M v[76:79],a[160:163],a[56:59],v[76:79]
SA s21,s21,524160
M v[80:83],a[160:163],a[64:67],v[80:83]
M v[80:83],a[164:167],a[68:71],v[80:83]
M v[84:87],a[164:167],a[76:79],v[84:87]
M v[84:87],a[160:163],a[72:75],v[84:87]
M v[88:91],a[160:163],a[80:83],v[88:91]
M v[88:91],a[164:167],a[84:87],v[88:91]
s_waitcnt lgkmcnt(2)
M v[92:95],a[164:167],a[92:95],v[92:95]
s_waitcnt vmcnt(17) lgkmcnt(0)
M v[92:95],a[160:163],a[88:91],v[92:95]
s_barrier
M v[124:127],a[168:171],a[88:91],v[124:127]
R a[160:163],v5,49152
R a[164:167],v6,49152
M v[124:127],a[172:175],a[92:95],v[124:127]
M v[120:123],a[172:175],a[84:87],v[120:123]
SA m0,s24,32768
T a[128:129],v1,16384
T a[130:131],v1,17408
M v[120:123],a[168:171],a[80:83],v[120:123]
buffer_load_dwordx4 v12, s[48:51], s22 offen offset:0   lds
M v[116:119],a[168:171],a[72:75],v[116:119]
M v[116:119],a[172:175],a[76:79],v[116:119]
M v[112:115],a[172:175],a[68:71],v[112:115]
M v[112:115],a[168:171],a[64:67],v[112:115]
M v[108:111],a[168:171],a[56:59],v[108:111]
M v[108:111],a[172:175],a[60:63],v[108:111]
s_nop 0
T a[132:133],v1,24576
T a[134:135],v1,25600
M v[104:107],a[172:175],a[52:55],v[104:107]
buffer_load_dwordx4 v13, s[48:51], s22 offen offset:1024   lds
M v[104:107],a[168:171],a[48:51],v[104:107]
M v[100:103],a[168:171],a[40:43],v[100:103]
M v[100:103],a[172:175],a[44:47],v[100:103]
s_waitcnt lgkmcnt(4)
M v[96:99],a[172:175],a[36:39],v[96:99]
M v[96:99],a[168:171],a[32:35],v[96:99]
M v[128:131],a[160:163],a[32:35],v[128:131]
R a[168:171],v5,51200
R a[172:175],v6,51200
M v[128:131],a[164:167],a[36:39],v[128:131]
T a[136:137],v2,16384
T a[138:139],v2,17408
M v[132:135],a[164:167],a[44:47],v[132:135]
buffer_load_dwordx4 v14, s[48:51], s22 offen offset:2048   lds
M v[132:135],a[160:163],a[40:43],v[132:135]
M v[136:139],a[160:163],a[48:51],v[136:139]
M v[136:139],a[164:167],a[52:55],v[136:139]
M v[140:143],a[164:167],a[60:63],v[140:143]
M v[140:143],a[160:163],a[56:59],v[140:143]
s_nop 0
T a[140:141],v2,24576
T a[142:143],v2,25600
M v[144:147],a[160:163],a[64:67],v[144:147]
buffer_load_dwordx4 v15, s[48:51], s22 offen offset:3072   lds
M v[144:147],a[164:167],a[68:71],v[144:147]
SA s22,s22,1048576
M v[148:151],a[164:167],a[76:79],v[148:151]
M v[148:151],a[160:163],a[72:75],v[148:151]
M v[152:155],a[160:163],a[80:83],v[152:155]
M v[152:155],a[164:167],a[84:87],v[152:155]
s_waitcnt lgkmcnt(4)
M v[156:159],a[164:167],a[92:95],v[156:159]
SA m0,s23,0
T a[144:145],v3,16384
T a[146:147],v3,17408
M v[156:159],a[160:163],a[88:91],v[156:159]
buffer_load_dwordx4 v8, s[16:19], s21 offen offset:0  nt lds
M v[188:191],a[168:171],a[88:91],v[188:191]
R a[160:163],v5,53248
R a[164:167],v6,53248
M v[188:191],a[172:175],a[92:95],v[188:191]
M v[184:187],a[172:175],a[84:87],v[184:187]
M v[184:187],a[168:171],a[80:83],v[184:187]
M v[180:183],a[168:171],a[72:75],v[180:183]
M v[180:183],a[172:175],a[76:79],v[180:183]
s_nop 0
T a[148:149],v3,24576
T a[150:151],v3,25600
M v[176:179],a[172:175],a[68:71],v[176:179]
buffer_load_dwordx4 v9, s[16:19], s21 offen offset:1024  nt lds
M v[176:179],a[168:171],a[64:67],v[176:179]
M v[172:175],a[168:171],a[56:59],v[172:175]
M v[172:175],a[172:175],a[60:63],v[172:175]
M v[168:171],a[172:175],a[52:55],v[168:171]
M v[168:171],a[168:171],a[48:51],v[168:171]
M v[164:167],a[168:171],a[40:43],v[164:167]
s_nop 0
T a[152:153],v4,16384
T a[154:155],v4,17408
M v[164:167],a[172:175],a[44:47],v[164:167]
s_waitcnt lgkmcnt(4)
buffer_load_dwordx4 v10, s[16:19], s21 offen offset:2048  nt lds
M v[160:163],a[172:175],a[36:39],v[160:163]
M v[160:163],a[168:171],a[32:35],v[160:163]
M v[192:195],a[160:163],a[32:35],v[192:195]
R a[168:171],v5,55296
R a[172:175],v6,55296
M v[192:195],a[164:167],a[36:39],v[192:195]
M v[196:199],a[164:167],a[44:47],v[196:199]
M v[196:199],a[160:163],a[40:43],v[196:199]
s_nop 0
T a[156:157],v4,24576
T a[158:159],v4,25600
M v[200:203],a[160:163],a[48:51],v[200:203]
buffer_load_dwordx4 v11, s[16:19], s21 offen offset:3072  nt lds
M v[200:203],a[164:167],a[52:55],v[200:203]
SA s21,s21,128
M v[204:207],a[164:167],a[60:63],v[204:207]
M v[204:207],a[160:163],a[56:59],v[204:207]
M v[208:211],a[160:163],a[64:67],v[208:211]
M v[208:211],a[164:167],a[68:71],v[208:211]
M v[212:215],a[164:167],a[76:79],v[212:215]
M v[212:215],a[160:163],a[72:75],v[212:215]
M v[216:219],a[160:163],a[80:83],v[216:219]
M v[216:219],a[164:167],a[84:87],v[216:219]
s_waitcnt lgkmcnt(2)
M v[220:223],a[164:167],a[92:95],v[220:223]
s_waitcnt vmcnt(17) lgkmcnt(0)
M v[220:223],a[160:163],a[88:91],v[220:223]
s_barrier
M v[252:255],a[168:171],a[88:91],v[252:255]
R a[160:163],v5,0
R a[164:167],v6,0
M v[252:255],a[172:175],a[92:95],v[252:255]
buffer_load_dword a240, v23, s[52:55], 0 offen offset:0
M v[248:251],a[172:175],a[84:87],v[248:251]
v_add_u32 v23, 16384, v23
M v[248:251],a[168:171],a[80:83],v[248:251]
M v[244:247],a[168:171],a[72:75],v[244:247]
M v[244:247],a[172:175],a[76:79],v[244:247]
M v[240:243],a[172:175],a[68:71],v[240:243]
M v[240:243],a[168:171],a[64:67],v[240:243]
M v[236:239],a[168:171],a[56:59],v[236:239]
M v[236:239],a[172:175],a[60:63],v[236:239]
M v[232:235],a[172:175],a[52:55],v[232:235]
M v[232:235],a[168:171],a[48:51],v[232:235]
M v[228:231],a[168:171],a[40:43],v[228:231]
M v[228:231],a[172:175],a[44:47],v[228:231]
s_waitcnt lgkmcnt(0)
M v[224:227],a[172:175],a[36:39],v[224:227]
M v[224:227],a[168:171],a[32:35],v[224:227]
M a[0:3],a[160:163],a[96:99],a[0:3]
R a[168:171],v5,2048
R a[172:175],v6,2048
M a[0:3],a[164:167],a[100:103],a[0:3]
T a[32:33],v1,32768
T a[34:35],v1,33792
M a[4:7],a[164:167],a[108:111],a[4:7]
SA m0,s24,49152
M a[4:7],a[160:163],a[104:107],a[4:7]
buffer_load_dwordx4 v12, s[48:51], s22 offen offset:0   lds
M a[8:11],a[160:163],a[112:115],a[8:11]
M a[8:11],a[164:167],a[116:119],a[8:11]
M a[12:15],a[164:167],a[124:127],a[12:15]
s_nop 0
T a[36:37],v1,40960
T a[38:39],v1,41984
M a[12:15],a[160:163],a[120:123],a[12:15]
M a[16:19],a[160:163],a[128:131],a[16:19]
buffer_load_dwordx4 v13, s[48:51], s22 offen offset:1024   lds
M a[16:19],a[164:167],a[132:135],a[16:19]
M a[20:23],a[164:167],a[140:143],a[20:23]
M a[20:23],a[160:163],a[136:139],a[20:23]
s_nop 0
T a[40:41],v2,32768
T a[42:43],v2,33792
M a[24:27],a[160:163],a[144:147],a[24:27]
M a[24:27],a[164:167],a[148:151],a[24:27]
s_waitcnt lgkmcnt(6)
buffer_load_dwordx4 v14, s[48:51], s22 offen offset:2048   lds
M a[28:31],a[164:167],a[156:159],a[28:31]
M a[28:31],a[160:163],a[152:155],a[28:31]
M v[60:63],a[168:171],a[152:155],v[60:63]
R a[160:163],v5,4096
R a[164:167],v6,4096
M v[60:63],a[172:175],a[156:159],v[60:63]
T a[44:45],v2,40960
T a[46:47],v2,41984
M v[56:59],a[172:175],a[148:151],v[56:59]
buffer_load_dwordx4 v15, s[48:51], s22 offen offset:3072   lds
M v[56:59],a[168:171],a[144:147],v[56:59]
s_sub_u32 s22, s22, 1048448
M v[52:55],a[168:171],a[136:139],v[52:55]
M v[52:55],a[172:175],a[140:143],v[52:55]
s_nop 0
T a[48:49],v3,32768
T a[50:51],v3,33792
M v[48:51],a[172:175],a[132:135],v[48:51]
SA m0,s23,16384
M v[48:51],a[168:171],a[128:131],v[48:51]
buffer_load_dwordx4 v8, s[16:19], s21 offen offset:0  nt lds
M v[44:47],a[168:171],a[120:123],v[44:47]
M v[44:47],a[172:175],a[124:127],v[44:47]
M v[40:43],a[172:175],a[116:119],v[40:43]
s_nop 0
T a[52:53],v3,40960
T a[54:55],v3,41984
M v[40:43],a[168:171],a[112:115],v[40:43]
M v[36:39],a[168:171],a[104:107],v[36:39]
buffer_load_dwordx4 v9, s[16:19], s21 offen offset:1024  nt lds
M v[36:39],a[172:175],a[108:111],v[36:39]
s_waitcnt lgkmcnt(6)
M v[32:35],a[172:175],a[100:103],v[32:35]
M v[32:35],a[168:171],a[96:99],v[32:35]
s_nop 0
T a[56:57],v4,32768
T a[58:59],v4,33792
M v[64:67],a[160:163],a[96:99],v[64:67]
R a[168:171],v5,6144
R a[172:175],v6,6144
M v[64:67],a[164:167],a[100:103],v[64:67]
buffer_load_dwordx4 v10, s[16:19], s21 offen offset:2048  nt lds
M v[68:71],a[164:167],a[108:111],v[68:71]
M v[68:71],a[160:163],a[104:107],v[68:71]
M v[72:75],a[160:163],a[112:115],v[72:75]
s_nop 0
T a[60:61],v4,40960
T a[62:63],v4,41984
M v[72:75],a[164:167],a[116:119],v[72:75]
M v[76:79],a[164:167],a[124:127],v[76:79]
buffer_load_dwordx4 v11, s[16:19], s21 offen offset:3072  nt lds
M v[76:79],a[160:163],a[120:123],v[76:79]
SA s21,s21,524160
M v[80:83],a[160:163],a[128:131],v[80:83]
M v[80:83],a[164:167],a[132:135],v[80:83]
M v[84:87],a[164:167],a[140:143],v[84:87]
M v[84:87],a[160:163],a[136:139],v[84:87]
M v[88:91],a[160:163],a[144:147],v[88:91]
M v[88:91],a[164:167],a[148:151],v[88:91]
s_waitcnt lgkmcnt(2)
M v[92:95],a[164:167],a[156:159],v[92:95]
s_waitcnt vmcnt(17) lgkmcnt(0)
M v[92:95],a[160:163],a[152:155],v[92:95]
s_barrier
M v[124:127],a[168:171],a[152:155],v[124:127]
R a[160:163],v5,16384
R a[164:167],v6,16384
M v[124:127],a[172:175],a[156:159],v[124:127]
M v[120:123],a[172:175],a[148:151],v[120:123]
SA m0,s24,0
T a[64:65],v1,49152
T a[66:67],v1,50176
M v[120:123],a[168:171],a[144:147],v[120:123]
buffer_load_dwordx4 v12, s[48:51], s22 offen offset:0   lds
M v[116:119],a[168:171],a[136:139],v[116:119]
M v[116:119],a[172:175],a[140:143],v[116:119]
M v[112:115],a[172:175],a[132:135],v[112:115]
M v[112:115],a[168:171],a[128:131],v[112:115]
M v[108:111],a[168:171],a[120:123],v[108:111]
M v[108:111],a[172:175],a[124:127],v[108:111]
s_nop 0
T a[68:69],v1,57344
T a[70:71],v1,58368
M v[104:107],a[172:175],a[116:119],v[104:107]
buffer_load_dwordx4 v13, s[48:51], s22 offen offset:1024   lds
M v[104:107],a[168:171],a[112:115],v[104:107]
M v[100:103],a[168:171],a[104:107],v[100:103]
M v[100:103],a[172:175],a[108:111],v[100:103]
s_waitcnt lgkmcnt(4)
M v[96:99],a[172:175],a[100:103],v[96:99]
M v[96:99],a[168:171],a[96:99],v[96:99]
M v[128:131],a[160:163],a[96:99],v[128:131]
R a[168:171],v5,18432
R a[172:175],v6,18432
M v[128:131],a[164:167],a[100:103],v[128:131]
T a[72:73],v2,49152
T a[74:75],v2,50176
M v[132:135],a[164:167],a[108:111],v[132:135]
buffer_load_dwordx4 v14, s[48:51], s22 offen offset:2048   lds
M v[132:135],a[160:163],a[104:107],v[132:135]
M v[136:139],a[160:163],a[112:115],v[136:139]
M v[136:139],a[164:167],a[116:119],v[136:139]
M v[140:143],a[164:167],a[124:127],v[140:143]
M v[140:143],a[160:163],a[120:123],v[140:143]
s_nop 0
T a[76:77],v2,57344
T a[78:79],v2,58368
M v[144:147],a[160:163],a[128:131],v[144:147]
buffer_load_dwordx4 v15, s[48:51], s22 offen offset:3072   lds
M v[144:147],a[164:167],a[132:135],v[144:147]
SA s22,s22,1048576
M v[148:151],a[164:167],a[140:143],v[148:151]
M v[148:151],a[160:163],a[136:139],v[148:151]
M v[152:155],a[160:163],a[144:147],v[152:155]
M v[152:155],a[164:167],a[148:151],v[152:155]
s_waitcnt lgkmcnt(4)
M v[156:159],a[164:167],a[156:159],v[156:159]
SA m0,s23,32768
T a[80:81],v3,49152
T a[82:83],v3,50176
M v[156:159],a[160:163],a[152:155],v[156:159]
buffer_load_dwordx4 v8, s[16:19], s21 offen offset:0  nt lds
M v[188:191],a[168:171],a[152:155],v[188:191]
R a[160:163],v5,20480
R a[164:167],v6,20480
M v[188:191],a[172:175],a[156:159],v[188:191]
M v[184:187],a[172:175],a[148:151],v[184:187]
M v[184:187],a[168:171],a[144:147],v[184:187]
M v[180:183],a[168:171],a[136:139],v[180:183]
M v[180:183],a[172:175],a[140:143],v[180:183]
s_nop 0
T a[84:85],v3,57344
T a[86:87],v3,58368
M v[176:179],a[172:175],a[132:135],v[176:179]
buffer_load_dwordx4 v9, s[16:19], s21 offen offset:1024  nt lds
M v[176:179],a[168:171],a[128:131],v[176:179]
M v[172:175],a[168:171],a[120:123],v[172:175]
M v[172:175],a[172:175],a[124:127],v[172:175]
M v[168:171],a[172:175],a[116:119],v[168:171]
M v[168:171],a[168:171],a[112:115],v[168:171]
M v[164:167],a[168:171],a[104:107],v[164:167]
s_nop 0
T a[88:89],v4,49152
T a[90:91],v4,50176
M v[164:167],a[172:175],a[108:111],v[164:167]
s_waitcnt lgkmcnt(4)
buffer_load_dwordx4 v10, s[16:19], s21 offen offset:2048  nt lds
M v[160:163],a[172:175],a[100:103],v[160:163]
M v[160:163],a[168:171],a[96:99],v[160:163]
M v[192:195],a[160:163],a[96:99],v[192:195]
R a[168:171],v5,22528
R a[172:175],v6,22528
M v[192:195],a[164:167],a[100:103],v[192:195]
M v[196:199],a[164:167],a[108:111],v[196:199]
M v[196:199],a[160:163],a[104:107],v[196:199]
s_nop 0
T a[92:93],v4,57344
T a[94:95],v4,58368
M v[200:203],a[160:163],a[112:115],v[200:203]
buffer_load_dwordx4 v11, s[16:19], s21 offen offset:3072  nt lds
M v[200:203],a[164:167],a[116:119],v[200:203]
SA s21,s21,128
M v[204:207],a[164:167],a[124:127],v[204:207]
M v[204:207],a[160:163],a[120:123],v[204:207]
M v[208:211],a[160:163],a[128:131],v[208:211]
M v[208:211],a[164:167],a[132:135],v[208:211]
M v[212:215],a[164:167],a[140:143],v[212:215]
M v[212:215],a[160:163],a[136:139],v[212:215]
M v[216:219],a[160:163],a[144:147],v[216:219]
M v[216:219],a[164:167],a[148:151],v[216:219]
s_waitcnt lgkmcnt(2)
M v[220:223],a[164:167],a[156:159],v[220:223]
s_waitcnt vmcnt(17) lgkmcnt(0)
M v[220:223],a[160:163],a[152:155],v[220:223]
s_barrier
M v[252:255],a[168:171],a[152:155],v[252:255]
R a[160:163],v5,32768
R a[164:167],v6,32768
M v[252:255],a[172:175],a[156:159],v[252:255]
buffer_load_dword a240, v23, s[52:55], 0 offen offset:0
M v[248:251],a[172:175],a[148:151],v[248:251]
L_w_kv15:
s_cbranch_execz L_wd2
v_add_u32 v23, 16384, v23
M v[248:251],a[168:171],a[144:147],v[248:251]
M v[244:247],a[168:171],a[136:139],v[244:247]
M v[244:247],a[172:175],a[140:143],v[244:247]
M v[240:243],a[172:175],a[132:135],v[240:243]
M v[240:243],a[168:171],a[128:131],v[240:243]
M v[236:239],a[168:171],a[120:123],v[236:239]
M v[236:239],a[172:175],a[124:127],v[236:239]
M v[232:235],a[172:175],a[116:119],v[232:235]
M v[232:235],a[168:171],a[112:115],v[232:235]
M v[228:231],a[168:171],a[104:107],v[228:231]
M v[228:231],a[172:175],a[108:111],v[228:231]
s_waitcnt lgkmcnt(0)
M v[224:227],a[172:175],a[100:103],v[224:227]
M v[224:227],a[168:171],a[96:99],v[224:227]
M a[0:3],a[160:163],a[32:35],a[0:3]
R a[168:171],v5,34816
R a[172:175],v6,34816
M a[0:3],a[164:167],a[36:39],a[0:3]
T a[96:97],v1,0
T a[98:99],v1,1024
M a[4:7],a[164:167],a[44:47],a[4:7]
SA m0,s24,16384
M a[4:7],a[160:163],a[40:43],a[4:7]
buffer_load_dwordx4 v12, s[48:51], s22 offen offset:0   lds
M a[8:11],a[160:163],a[48:51],a[8:11]
M a[8:11],a[164:167],a[52:55],a[8:11]
M a[12:15],a[164:167],a[60:63],a[12:15]
s_nop 0
T a[100:101],v1,8192
T a[102:103],v1,9216
M a[12:15],a[160:163],a[56:59],a[12:15]
M a[16:19],a[160:163],a[64:67],a[16:19]
buffer_load_dwordx4 v13, s[48:51], s22 offen offset:1024   lds
M a[16:19],a[164:167],a[68:71],a[16:19]
M a[20:23],a[164:167],a[76:79],a[20:23]
M a[20:23],a[160:163],a[72:75],a[20:23]
s_nop 0
T a[104:105],v2,0
T a[106:107],v2,1024
M a[24:27],a[160:163],a[80:83],a[24:27]
M a[24:27],a[164:167],a[84:87],a[24:27]
s_waitcnt lgkmcnt(6)
buffer_load_dwordx4 v14, s[48:51], s22 offen offset:2048   lds
M a[28:31],a[164:167],a[92:95],a[28:31]
M a[28:31],a[160:163],a[88:91],a[28:31]
M v[60:63],a[168:171],a[88:91],v[60:63]
R a[160:163],v5,36864
R a[164:167],v6,36864
M v[60:63],a[172:175],a[92:95],v[60:63]
T a[108:109],v2,8192
T a[110:111],v2,9216
M v[56:59],a[172:175],a[84:87],v[56:59]
buffer_load_dwordx4 v15, s[48:51], s22 offen offset:3072   lds
M v[56:59],a[168:171],a[80:83],v[56:59]
s_sub_u32 s22, s22, 1048448
M v[52:55],a[168:171],a[72:75],v[52:55]
M v[52:55],a[172:175],a[76:79],v[52:55]
s_nop 0
T a[112:113],v3,0
T a[114:115],v3,1024
M v[48:51],a[172:175],a[68:71],v[48:51]
SA m0,s23,49152
M v[48:51],a[168:171],a[64:67],v[48:51]
buffer_load_dwordx4 v8, s[16:19], s21 offen offset:0  nt lds
M v[44:47],a[168:171],a[56:59],v[44:47]
M v[44:47],a[172:175],a[60:63],v[44:47]
M v[40:43],a[172:175],a[52:55],v[40:43]
s_nop 0
T a[116:117],v3,8192
T a[118:119],v3,9216
M v[40:43],a[168:171],a[48:51],v[40:43]
M v[36:39],a[168:171],a[40:43],v[36:39]
buffer_load_dwordx4 v9, s[16:19], s21 offen offset:1024  nt lds
M v[36:39],a[172:175],a[44:47],v[36:39]
s_waitcnt lgkmcnt(6)
M v[32:35],a[172:175],a[36:39],v[32:35]
M v[32:35],a[168:171],a[32:35],v[32:35]
s_nop 0
T a[120:121],v4,0
T a[122:123],v4,1024
M v[64:67],a[160:163],a[32:35],v[64:67]
R a[168:171],v5,38912
R a[172:175],v6,38912
M v[64:67],a[164:167],a[36:39],v[64:67]
buffer_load_dwordx4 v10, s[16:19], s21 offen offset:2048  nt lds
M v[68:71],a[164:167],a[44:47],v[68:71]
M v[68:71],a[160:163],a[40:43],v[68:71]
M v[72:75],a[160:163],a[48:51],v[72:75]
s_nop 0
T a[124:125],v4,8192
T a[126:127],v4,9216
M v[72:75],a[164:167],a[52:55],v[72:75]
M v[76:79],a[164:167],a[60:63],v[76:79]
buffer_load_dwordx4 v11, s[16:19], s21 offen offset:3072  nt lds
M v[76:79],a[160:163],a[56:59],v[76:79]
SA s21,s21,524160
M v[80:83],a[160:163],a[64:67],v[80:83]
M v[80:83],a[164:167],a[68:71],v[80:83]
M v[84:87],a[164:167],a[76:79],v[84:87]
M v[84:87],a[160:163],a[72:75],v[84:87]
M v[88:91],a[160:163],a[80:83],v[88:91]
M v[88:91],a[164:167],a[84:87],v[88:91]
s_waitcnt lgkmcnt(2)
M v[92:95],a[164:167],a[92:95],v[92:95]
s_waitcnt vmcnt(17) lgkmcnt(0)
M v[92:95],a[160:163],a[88:91],v[92:95]
s_barrier
M v[124:127],a[168:171],a[88:91],v[124:127]
R a[160:163],v5,49152
R a[164:167],v6,49152
M v[124:127],a[172:175],a[92:95],v[124:127]
M v[120:123],a[172:175],a[84:87],v[120:123]
SA m0,s24,32768
T a[128:129],v1,16384
T a[130:131],v1,17408
M v[120:123],a[168:171],a[80:83],v[120:123]
buffer_load_dwordx4 v12, s[48:51], s22 offen offset:0   lds
M v[116:119],a[168:171],a[72:75],v[116:119]
M v[116:119],a[172:175],a[76:79],v[116:119]
M v[112:115],a[172:175],a[68:71],v[112:115]
M v[112:115],a[168:171],a[64:67],v[112:115]
M v[108:111],a[168:171],a[56:59],v[108:111]
M v[108:111],a[172:175],a[60:63],v[108:111]
s_nop 0
T a[132:133],v1,24576
T a[134:135],v1,25600
M v[104:107],a[172:175],a[52:55],v[104:107]
buffer_load_dwordx4 v13, s[48:51], s22 offen offset:1024   lds
M v[104:107],a[168:171],a[48:51],v[104:107]
M v[100:103],a[168:171],a[40:43],v[100:103]
M v[100:103],a[172:175],a[44:47],v[100:103]
s_waitcnt lgkmcnt(4)
M v[96:99],a[172:175],a[36:39],v[96:99]
M v[96:99],a[168:171],a[32:35],v[96:99]
M v[128:131],a[160:163],a[32:35],v[128:131]
R a[168:171],v5,51200
R a[172:175],v6,51200
M v[128:131],a[164:167],a[36:39],v[128:131]
T a[136:137],v2,16384
T a[138:139],v2,17408
M v[132:135],a[164:167],a[44:47],v[132:135]
buffer_load_dwordx4 v14, s[48:51], s22 offen offset:2048   lds
M v[132:135],a[160:163],a[40:43],v[132:135]
M v[136:139],a[160:163],a[48:51],v[136:139]
M v[136:139],a[164:167],a[52:55],v[136:139]
M v[140:143],a[164:167],a[60:63],v[140:143]
M v[140:143],a[160:163],a[56:59],v[140:143]
s_nop 0
T a[140:141],v2,24576
T a[142:143],v2,25600
M v[144:147],a[160:163],a[64:67],v[144:147]
buffer_load_dwordx4 v15, s[48:51], s22 offen offset:3072   lds
M v[144:147],a[164:167],a[68:71],v[144:147]
SA s22,s22,1048576
M v[148:151],a[164:167],a[76:79],v[148:151]
M v[148:151],a[160:163],a[72:75],v[148:151]
M v[152:155],a[160:163],a[80:83],v[152:155]
M v[152:155],a[164:167],a[84:87],v[152:155]
s_waitcnt lgkmcnt(4)
M v[156:159],a[164:167],a[92:95],v[156:159]
SA m0,s23,0
T a[144:145],v3,16384
T a[146:147],v3,17408
M v[156:159],a[160:163],a[88:91],v[156:159]
buffer_load_dwordx4 v8, s[16:19], s21 offen offset:0  nt lds
M v[188:191],a[168:171],a[88:91],v[188:191]
R a[160:163],v5,53248
R a[164:167],v6,53248
M v[188:191],a[172:175],a[92:95],v[188:191]
M v[184:187],a[172:175],a[84:87],v[184:187]
M v[184:187],a[168:171],a[80:83],v[184:187]
M v[180:183],a[168:171],a[72:75],v[180:183]
M v[180:183],a[172:175],a[76:79],v[180:183]
s_nop 0
T a[148:149],v3,24576
T a[150:151],v3,25600
M v[176:179],a[172:175],a[68:71],v[176:179]
buffer_load_dwordx4 v9, s[16:19], s21 offen offset:1024  nt lds
M v[176:179],a[168:171],a[64:67],v[176:179]
M v[172:175],a[168:171],a[56:59],v[172:175]
M v[172:175],a[172:175],a[60:63],v[172:175]
M v[168:171],a[172:175],a[52:55],v[168:171]
M v[168:171],a[168:171],a[48:51],v[168:171]
M v[164:167],a[168:171],a[40:43],v[164:167]
s_nop 0
T a[152:153],v4,16384
T a[154:155],v4,17408
M v[164:167],a[172:175],a[44:47],v[164:167]
s_waitcnt lgkmcnt(4)
buffer_load_dwordx4 v10, s[16:19], s21 offen offset:2048  nt lds
M v[160:163],a[172:175],a[36:39],v[160:163]
M v[160:163],a[168:171],a[32:35],v[160:163]
M v[192:195],a[160:163],a[32:35],v[192:195]
R a[168:171],v5,55296
R a[172:175],v6,55296
M v[192:195],a[164:167],a[36:39],v[192:195]
M v[196:199],a[164:167],a[44:47],v[196:199]
M v[196:199],a[160:163],a[40:43],v[196:199]
s_nop 0
T a[156:157],v4,24576
T a[158:159],v4,25600
M v[200:203],a[160:163],a[48:51],v[200:203]
buffer_load_dwordx4 v11, s[16:19], s21 offen offset:3072  nt lds
M v[200:203],a[164:167],a[52:55],v[200:203]
SA s21,s21,128
M v[204:207],a[164:167],a[60:63],v[204:207]
M v[204:207],a[160:163],a[56:59],v[204:207]
M v[208:211],a[160:163],a[64:67],v[208:211]
M v[208:211],a[164:167],a[68:71],v[208:211]
M v[212:215],a[164:167],a[76:79],v[212:215]
M v[212:215],a[160:163],a[72:75],v[212:215]
M v[216:219],a[160:163],a[80:83],v[216:219]
M v[216:219],a[164:167],a[84:87],v[216:219]
s_waitcnt lgkmcnt(2)
M v[220:223],a[164:167],a[92:95],v[220:223]
s_waitcnt vmcnt(17) lgkmcnt(0)
M v[220:223],a[160:163],a[88:91],v[220:223]
s_barrier
M v[252:255],a[168:171],a[88:91],v[252:255]
R a[160:163],v5,0
R a[164:167],v6,0
M v[252:255],a[172:175],a[92:95],v[252:255]
M v[248:251],a[172:175],a[84:87],v[248:251]
M v[248:251],a[168:171],a[80:83],v[248:251]
M v[244:247],a[168:171],a[72:75],v[244:247]
M v[244:247],a[172:175],a[76:79],v[244:247]
M v[240:243],a[172:175],a[68:71],v[240:243]
M v[240:243],a[168:171],a[64:67],v[240:243]
M v[236:239],a[168:171],a[56:59],v[236:239]
M v[236:239],a[172:175],a[60:63],v[236:239]
M v[232:235],a[172:175],a[52:55],v[232:235]
M v[232:235],a[168:171],a[48:51],v[232:235]
M v[228:231],a[168:171],a[40:43],v[228:231]
M v[228:231],a[172:175],a[44:47],v[228:231]
s_waitcnt lgkmcnt(0)
M v[224:227],a[172:175],a[36:39],v[224:227]
M v[224:227],a[168:171],a[32:35],v[224:227]
M a[0:3],a[160:163],a[96:99],a[0:3]
R a[168:171],v5,2048
R a[172:175],v6,2048
M a[0:3],a[164:167],a[100:103],a[0:3]
T a[32:33],v1,32768
T a[34:35],v1,33792
M a[4:7],a[164:167],a[108:111],a[4:7]
SA m0,s24,49152
v_lshrrev_b32 v28, 4, v0
v_and_b32 v29, 7, v0
M a[4:7],a[160:163],a[104:107],a[4:7]
buffer_load_dwordx4 v12, s[48:51], s22 offen offset:0   lds
M a[8:11],a[160:163],a[112:115],a[8:11]
v_xor_b32 v28, v28, v29
v_lshlrev_b32 v28, 4, v28
M a[8:11],a[164:167],a[116:119],a[8:11]
v_lshrrev_b32 v29, 3, v0
v_mul_u32_u24 v29, 896, v29
M a[12:15],a[164:167],a[124:127],a[12:15]
T a[36:37],v1,40960
T a[38:39],v1,41984
M a[12:15],a[160:163],a[120:123],a[12:15]
v_add_u32 v22, v28, v29
v_xor_b32 v28, 64, v28
M a[16:19],a[160:163],a[128:131],a[16:19]
s_mul_i32 s64, s20, 14336
buffer_load_dwordx4 v13, s[48:51], s22 offen offset:1024   lds
M a[16:19],a[164:167],a[132:135],a[16:19]
s_sub_u32 s65, 98304, s64
M a[20:23],a[164:167],a[140:143],a[20:23]
SA s30,s29,s65
M a[20:23],a[160:163],a[136:139],a[20:23]
SA s29,s29,s64
T a[40:41],v2,32768
T a[42:43],v2,33792
M a[24:27],a[160:163],a[144:147],a[24:27]
v_add_u32 v29, 6144, v29
v_add_u32 v23, v28, v29
M a[24:27],a[164:167],a[148:151],a[24:27]
s_waitcnt lgkmcnt(6)
buffer_load_dwordx4 v14, s[48:51], s22 offen offset:2048   lds
M a[28:31],a[164:167],a[156:159],a[28:31]
s_and_b32 s64, s20, 1
M a[28:31],a[160:163],a[152:155],a[28:31]
s_lshl_b32 s64, s64, 12
M v[60:63],a[168:171],a[152:155],v[60:63]
SA s64,s64,65536
R a[160:163],v5,4096
R a[164:167],v6,4096
M v[60:63],a[172:175],a[156:159],v[60:63]
T a[44:45],v2,40960
T a[46:47],v2,41984
M v[56:59],a[172:175],a[148:151],v[56:59]
buffer_load_dwordx4 v15, s[48:51], s22 offen offset:3072   lds
M v[56:59],a[168:171],a[144:147],v[56:59]
s_sub_u32 s22, s22, 1048448
v_add_u32 v20, s64, v5
v_add_u32 v21, s64, v6
M v[52:55],a[168:171],a[136:139],v[52:55]
M v[52:55],a[172:175],a[140:143],v[52:55]
s_nop 0
T a[48:49],v3,32768
T a[50:51],v3,33792
M v[48:51],a[172:175],a[132:135],v[48:51]
SA m0,s23,16384
M v[48:51],a[168:171],a[128:131],v[48:51]
buffer_load_dwordx4 v8, s[16:19], s21 offen offset:0  nt lds
M v[44:47],a[168:171],a[120:123],v[44:47]
M v[44:47],a[172:175],a[124:127],v[44:47]
M v[40:43],a[172:175],a[116:119],v[40:43]
s_nop 0
T a[52:53],v3,40960
T a[54:55],v3,41984
M v[40:43],a[168:171],a[112:115],v[40:43]
M v[36:39],a[168:171],a[104:107],v[36:39]
buffer_load_dwordx4 v9, s[16:19], s21 offen offset:1024  nt lds
M v[36:39],a[172:175],a[108:111],v[36:39]
s_waitcnt lgkmcnt(6)
M v[32:35],a[172:175],a[100:103],v[32:35]
M v[32:35],a[168:171],a[96:99],v[32:35]
s_nop 0
T a[56:57],v4,32768
T a[58:59],v4,33792
M v[64:67],a[160:163],a[96:99],v[64:67]
R a[168:171],v5,6144
R a[172:175],v6,6144
M v[64:67],a[164:167],a[100:103],v[64:67]
buffer_load_dwordx4 v10, s[16:19], s21 offen offset:2048  nt lds
M v[68:71],a[164:167],a[108:111],v[68:71]
M v[68:71],a[160:163],a[104:107],v[68:71]
M v[72:75],a[160:163],a[112:115],v[72:75]
s_nop 0
T a[60:61],v4,40960
T a[62:63],v4,41984
M v[72:75],a[164:167],a[116:119],v[72:75]
M v[76:79],a[164:167],a[124:127],v[76:79]
buffer_load_dwordx4 v11, s[16:19], s21 offen offset:3072  nt lds
M v[76:79],a[160:163],a[120:123],v[76:79]
SA s21,s21,524160
M v[80:83],a[160:163],a[128:131],v[80:83]
M v[80:83],a[164:167],a[132:135],v[80:83]
M v[84:87],a[164:167],a[140:143],v[84:87]
M v[84:87],a[160:163],a[136:139],v[84:87]
M v[88:91],a[160:163],a[144:147],v[88:91]
M v[88:91],a[164:167],a[148:151],v[88:91]
s_waitcnt lgkmcnt(2)
M v[92:95],a[164:167],a[156:159],v[92:95]
s_waitcnt vmcnt(16) lgkmcnt(0)
M v[92:95],a[160:163],a[152:155],v[92:95]
s_barrier
M v[124:127],a[168:171],a[152:155],v[124:127]
R a[160:163],v5,16384
R a[164:167],v6,16384
M v[124:127],a[172:175],a[156:159],v[124:127]
SA m0,s23,131072
M v[120:123],a[172:175],a[148:151],v[120:123]
s_nop 0
T a[64:65],v1,49152
T a[66:67],v1,50176
M v[120:123],a[168:171],a[144:147],v[120:123]
buffer_load_dwordx4 v22, s[56:59], s29 offen offset:0 lds
M v[116:119],a[168:171],a[136:139],v[116:119]
M v[116:119],a[172:175],a[140:143],v[116:119]
M v[112:115],a[172:175],a[132:135],v[112:115]
buffer_load_dwordx4 v23, s[56:59], s29 offen offset:1024 lds
M v[112:115],a[168:171],a[128:131],v[112:115]
M v[108:111],a[168:171],a[120:123],v[108:111]
M v[108:111],a[172:175],a[124:127],v[108:111]
s_nop 0
T a[68:69],v1,57344
T a[70:71],v1,58368
M v[104:107],a[172:175],a[116:119],v[104:107]
buffer_load_dwordx4 v22, s[56:59], s30 offen offset:2048 lds
M v[104:107],a[168:171],a[112:115],v[104:107]
M v[100:103],a[168:171],a[104:107],v[100:103]
M v[100:103],a[172:175],a[108:111],v[100:103]
s_waitcnt lgkmcnt(4)
M v[96:99],a[172:175],a[100:103],v[96:99]
M v[96:99],a[168:171],a[96:99],v[96:99]
buffer_load_dwordx4 v23, s[56:59], s30 offen offset:3072 lds
M v[128:131],a[160:163],a[96:99],v[128:131]
R a[168:171],v5,18432
R a[172:175],v6,18432
M v[128:131],a[164:167],a[100:103],v[128:131]
SA s29,s29,128
T a[72:73],v2,49152
T a[74:75],v2,50176
M v[132:135],a[164:167],a[108:111],v[132:135]
SA s30,s30,128
M v[132:135],a[160:163],a[104:107],v[132:135]
SA m0,s24,0
M v[136:139],a[160:163],a[112:115],v[136:139]
buffer_load_dwordx4 v12, s[48:51], s22 offen offset:0   lds
M v[136:139],a[164:167],a[116:119],v[136:139]
M v[140:143],a[164:167],a[124:127],v[140:143]
M v[140:143],a[160:163],a[120:123],v[140:143]
s_nop 0
T a[76:77],v2,57344
T a[78:79],v2,58368
M v[144:147],a[160:163],a[128:131],v[144:147]
buffer_load_dwordx4 v13, s[48:51], s22 offen offset:1024   lds
M v[144:147],a[164:167],a[132:135],v[144:147]
M v[148:151],a[164:167],a[140:143],v[148:151]
M v[148:151],a[160:163],a[136:139],v[148:151]
M v[152:155],a[160:163],a[144:147],v[152:155]
M v[152:155],a[164:167],a[148:151],v[152:155]
s_waitcnt lgkmcnt(4)
buffer_load_dwordx4 v14, s[48:51], s22 offen offset:2048   lds
M v[156:159],a[164:167],a[156:159],v[156:159]
s_nop 0
T a[80:81],v3,49152
T a[82:83],v3,50176
M v[156:159],a[160:163],a[152:155],v[156:159]
M v[188:191],a[168:171],a[152:155],v[188:191]
R a[160:163],v5,20480
R a[164:167],v6,20480
M v[188:191],a[172:175],a[156:159],v[188:191]
M v[184:187],a[172:175],a[148:151],v[184:187]
buffer_load_dwordx4 v15, s[48:51], s22 offen offset:3072   lds
M v[184:187],a[168:171],a[144:147],v[184:187]
M v[180:183],a[168:171],a[136:139],v[180:183]
M v[180:183],a[172:175],a[140:143],v[180:183]
SA s22,s22,1048576
T a[84:85],v3,57344
T a[86:87],v3,58368
M v[176:179],a[172:175],a[132:135],v[176:179]
SA m0,s23,32768
M v[176:179],a[168:171],a[128:131],v[176:179]
buffer_load_dwordx4 v8, s[16:19], s21 offen offset:0  nt lds
M v[172:175],a[168:171],a[120:123],v[172:175]
M v[172:175],a[172:175],a[124:127],v[172:175]
M v[168:171],a[172:175],a[116:119],v[168:171]
M v[168:171],a[168:171],a[112:115],v[168:171]
buffer_load_dwordx4 v9, s[16:19], s21 offen offset:1024  nt lds
M v[164:167],a[168:171],a[104:107],v[164:167]
s_nop 0
T a[88:89],v4,49152
T a[90:91],v4,50176
M v[164:167],a[172:175],a[108:111],v[164:167]
s_waitcnt lgkmcnt(4)
M v[160:163],a[172:175],a[100:103],v[160:163]
M v[160:163],a[168:171],a[96:99],v[160:163]
M v[192:195],a[160:163],a[96:99],v[192:195]
R a[168:171],v5,22528
R a[172:175],v6,22528
M v[192:195],a[164:167],a[100:103],v[192:195]
buffer_load_dwordx4 v10, s[16:19], s21 offen offset:2048  nt lds
M v[196:199],a[164:167],a[108:111],v[196:199]
M v[196:199],a[160:163],a[104:107],v[196:199]
s_nop 0
T a[92:93],v4,57344
T a[94:95],v4,58368
M v[200:203],a[160:163],a[112:115],v[200:203]
M v[200:203],a[164:167],a[116:119],v[200:203]
buffer_load_dwordx4 v11, s[16:19], s21 offen offset:3072  nt lds
M v[204:207],a[164:167],a[124:127],v[204:207]
M v[204:207],a[160:163],a[120:123],v[204:207]
M v[208:211],a[160:163],a[128:131],v[208:211]
M v[208:211],a[164:167],a[132:135],v[208:211]
M v[212:215],a[164:167],a[140:143],v[212:215]
SA s21,s21,128
M v[212:215],a[160:163],a[136:139],v[212:215]
M v[216:219],a[160:163],a[144:147],v[216:219]
M v[216:219],a[164:167],a[148:151],v[216:219]
s_waitcnt lgkmcnt(2)
M v[220:223],a[164:167],a[156:159],v[220:223]
s_waitcnt vmcnt(20) lgkmcnt(0)
M v[220:223],a[160:163],a[152:155],v[220:223]
s_barrier
M v[252:255],a[168:171],a[152:155],v[252:255]
R a[160:163],v5,32768
R a[164:167],v6,32768
M v[252:255],a[172:175],a[156:159],v[252:255]
M v[248:251],a[172:175],a[148:151],v[248:251]
M v[248:251],a[168:171],a[144:147],v[248:251]
M v[244:247],a[168:171],a[136:139],v[244:247]
M v[244:247],a[172:175],a[140:143],v[244:247]
M v[240:243],a[172:175],a[132:135],v[240:243]
M v[240:243],a[168:171],a[128:131],v[240:243]
M v[236:239],a[168:171],a[120:123],v[236:239]
M v[236:239],a[172:175],a[124:127],v[236:239]
M v[232:235],a[172:175],a[116:119],v[232:235]
M v[232:235],a[168:171],a[112:115],v[232:235]
M v[228:231],a[168:171],a[104:107],v[228:231]
M v[228:231],a[172:175],a[108:111],v[228:231]
s_waitcnt lgkmcnt(0)
M v[224:227],a[172:175],a[100:103],v[224:227]
M v[224:227],a[168:171],a[96:99],v[224:227]
M a[0:3],a[160:163],a[32:35],a[0:3]
R a[168:171],v5,34816
R a[172:175],v6,34816
M a[0:3],a[164:167],a[36:39],a[0:3]
SA m0,s23,147456
T a[96:97],v1,0
T a[98:99],v1,1024
M a[4:7],a[164:167],a[44:47],a[4:7]
buffer_load_dwordx4 v22, s[56:59], s29 offen offset:0 lds
M a[4:7],a[160:163],a[40:43],a[4:7]
M a[8:11],a[160:163],a[48:51],a[8:11]
M a[8:11],a[164:167],a[52:55],a[8:11]
buffer_load_dwordx4 v23, s[56:59], s29 offen offset:1024 lds
M a[12:15],a[164:167],a[60:63],a[12:15]
s_nop 0
T a[100:101],v1,8192
T a[102:103],v1,9216
M a[12:15],a[160:163],a[56:59],a[12:15]
M a[16:19],a[160:163],a[64:67],a[16:19]
buffer_load_dwordx4 v22, s[56:59], s30 offen offset:2048 lds
M a[16:19],a[164:167],a[68:71],a[16:19]
M a[20:23],a[164:167],a[76:79],a[20:23]
M a[20:23],a[160:163],a[72:75],a[20:23]
s_nop 0
T a[104:105],v2,0
T a[106:107],v2,1024
M a[24:27],a[160:163],a[80:83],a[24:27]
buffer_load_dwordx4 v23, s[56:59], s30 offen offset:3072 lds
M a[24:27],a[164:167],a[84:87],a[24:27]
s_waitcnt lgkmcnt(6)
M a[28:31],a[164:167],a[92:95],a[28:31]
SA s29,s29,128
M a[28:31],a[160:163],a[88:91],a[28:31]
SA s30,s30,128
M v[60:63],a[168:171],a[88:91],v[60:63]
SA m0,s24,16384
R a[160:163],v5,36864
R a[164:167],v6,36864
M v[60:63],a[172:175],a[92:95],v[60:63]
T a[108:109],v2,8192
T a[110:111],v2,9216
M v[56:59],a[172:175],a[84:87],v[56:59]
buffer_load_dwordx4 v12, s[48:51], s22 offen offset:0   lds
M v[56:59],a[168:171],a[80:83],v[56:59]
M v[52:55],a[168:171],a[72:75],v[52:55]
M v[52:55],a[172:175],a[76:79],v[52:55]
s_nop 0
T a[112:113],v3,0
T a[114:115],v3,1024
M v[48:51],a[172:175],a[68:71],v[48:51]
buffer_load_dwordx4 v13, s[48:51], s22 offen offset:1024   lds
M v[48:51],a[168:171],a[64:67],v[48:51]
M v[44:47],a[168:171],a[56:59],v[44:47]
M v[44:47],a[172:175],a[60:63],v[44:47]
buffer_load_dwordx4 v14, s[48:51], s22 offen offset:2048   lds
M v[40:43],a[172:175],a[52:55],v[40:43]
s_nop 0
T a[116:117],v3,8192
T a[118:119],v3,9216
L_w_kv16:
s_cbranch_execz L_wd2
M v[40:43],a[168:171],a[48:51],v[40:43]
M v[36:39],a[168:171],a[40:43],v[36:39]
buffer_load_dwordx4 v15, s[48:51], s22 offen offset:3072   lds
M v[36:39],a[172:175],a[44:47],v[36:39]
s_waitcnt lgkmcnt(6)
M v[32:35],a[172:175],a[36:39],v[32:35]
s_sub_u32 s22, s22, 1048448
M v[32:35],a[168:171],a[32:35],v[32:35]
SA m0,s23,49152
T a[120:121],v4,0
T a[122:123],v4,1024
M v[64:67],a[160:163],a[32:35],v[64:67]
R a[168:171],v5,38912
R a[172:175],v6,38912
M v[64:67],a[164:167],a[36:39],v[64:67]
buffer_load_dwordx4 v8, s[16:19], s21 offen offset:0  nt lds
M v[68:71],a[164:167],a[44:47],v[68:71]
M v[68:71],a[160:163],a[40:43],v[68:71]
M v[72:75],a[160:163],a[48:51],v[72:75]
s_waitcnt vmcnt(17)
s_nop 0
T a[124:125],v4,8192
T a[126:127],v4,9216
M v[72:75],a[164:167],a[52:55],v[72:75]
buffer_load_dwordx4 v9, s[16:19], s21 offen offset:1024  nt lds
M v[76:79],a[164:167],a[60:63],v[76:79]
R a[176:179],v20,0
R a[180:183],v20,2048
M v[76:79],a[160:163],a[56:59],v[76:79]
R a[184:187],v21,0
R a[188:191],v21,2048
M v[80:83],a[160:163],a[64:67],v[80:83]
buffer_load_dwordx4 v10, s[16:19], s21 offen offset:2048  nt lds
M v[80:83],a[164:167],a[68:71],v[80:83]
M v[84:87],a[164:167],a[76:79],v[84:87]
M v[84:87],a[160:163],a[72:75],v[84:87]
buffer_load_dwordx4 v11, s[16:19], s21 offen offset:3072  nt lds
M v[88:91],a[160:163],a[80:83],v[88:91]
SA s21,s21,524160
M v[88:91],a[164:167],a[84:87],v[88:91]
s_waitcnt lgkmcnt(6)
M v[92:95],a[164:167],a[92:95],v[92:95]
s_waitcnt lgkmcnt(0)
M v[92:95],a[160:163],a[88:91],v[92:95]
s_barrier
M v[124:127],a[168:171],a[88:91],v[124:127]
s_lshl_b32 s4, s20, 10
R a[160:163],v5,49152
R a[164:167],v6,49152
M v[124:127],a[172:175],a[92:95],v[124:127]
SA m0,s23,131072
v_bfe_u32 v28, v0, 3, 2
M v[120:123],a[172:175],a[84:87],v[120:123]
s_nop 0
T a[128:129],v1,16384
T a[130:131],v1,17408
M v[120:123],a[168:171],a[80:83],v[120:123]
buffer_load_dwordx4 v22, s[56:59], s29 offen offset:0 lds
M v[116:119],a[168:171],a[72:75],v[116:119]
v_lshrrev_b32 v29, 5, v0
v_lshl_add_u32 v28, v29, 3, v28
M v[116:119],a[172:175],a[76:79],v[116:119]
M v[112:115],a[172:175],a[68:71],v[112:115]
v_lshlrev_b32 v28, 13, v28
M v[112:115],a[168:171],a[64:67],v[112:115]
M v[108:111],a[168:171],a[56:59],v[108:111]
buffer_load_dwordx4 v23, s[56:59], s29 offen offset:1024 lds
M v[108:111],a[172:175],a[60:63],v[108:111]
s_nop 0
T a[132:133],v1,24576
T a[134:135],v1,25600
M v[104:107],a[172:175],a[52:55],v[104:107]
v_lshrrev_b32 v29, 4, v0
v_lshlrev_b32 v29, 1, v29
M v[104:107],a[168:171],a[48:51],v[104:107]
M v[100:103],a[168:171],a[40:43],v[100:103]
v_and_b32 v30, 7, v0
M v[100:103],a[172:175],a[44:47],v[100:103]
s_waitcnt lgkmcnt(4)
M v[96:99],a[172:175],a[36:39],v[96:99]
v_xor_b32 v29, v29, v30
M v[96:99],a[168:171],a[32:35],v[96:99]
buffer_load_dwordx4 v22, s[56:59], s30 offen offset:2048 lds
M v[128:131],a[160:163],a[32:35],v[128:131]
R a[168:171],v5,51200
R a[172:175],v6,51200
M v[128:131],a[164:167],a[36:39],v[128:131]
T a[136:137],v2,16384
T a[138:139],v2,17408
M v[132:135],a[164:167],a[44:47],v[132:135]
v_lshl_add_u32 v28, v29, 4, v28
M v[132:135],a[160:163],a[40:43],v[132:135]
s_and_b32 s64, s20, 1
M v[136:139],a[160:163],a[48:51],v[136:139]
s_lshl_b32 s64, s64, 17
M v[136:139],a[164:167],a[52:55],v[136:139]
s_lshr_b32 s65, s20, 1
M v[140:143],a[164:167],a[60:63],v[140:143]
s_lshl_b32 s65, s65, 15
SA s64,s64,s65
v_add_u32 v8, s64, v28
M v[140:143],a[160:163],a[56:59],v[140:143]
s_nop 0
T a[140:141],v2,24576
T a[142:143],v2,25600
M v[144:147],a[160:163],a[64:67],v[144:147]
buffer_load_dwordx4 v23, s[56:59], s30 offen offset:3072 lds
M v[144:147],a[164:167],a[68:71],v[144:147]
M v[148:151],a[164:167],a[76:79],v[148:151]
SA s29,s29,128
M v[148:151],a[160:163],a[72:75],v[148:151]
SA s30,s30,128
M v[152:155],a[160:163],a[80:83],v[152:155]
SA m0,s24,32768
M v[152:155],a[164:167],a[84:87],v[152:155]
s_waitcnt lgkmcnt(4)
buffer_load_dwordx4 v12, s[48:51], s22 offen offset:0   lds
M v[156:159],a[164:167],a[92:95],v[156:159]
s_nop 0
T a[144:145],v3,16384
T a[146:147],v3,17408
M v[156:159],a[160:163],a[88:91],v[156:159]
M v[188:191],a[168:171],a[88:91],v[188:191]
R a[160:163],v5,53248
R a[164:167],v6,53248
M v[188:191],a[172:175],a[92:95],v[188:191]
M v[184:187],a[172:175],a[84:87],v[184:187]
M v[184:187],a[168:171],a[80:83],v[184:187]
M v[180:183],a[168:171],a[72:75],v[180:183]
buffer_load_dwordx4 v13, s[48:51], s22 offen offset:1024   lds
M v[180:183],a[172:175],a[76:79],v[180:183]
s_nop 0
T a[148:149],v3,24576
T a[150:151],v3,25600
M v[176:179],a[172:175],a[68:71],v[176:179]
M v[176:179],a[168:171],a[64:67],v[176:179]
M v[172:175],a[168:171],a[56:59],v[172:175]
M v[172:175],a[172:175],a[60:63],v[172:175]
M v[168:171],a[172:175],a[52:55],v[168:171]
M v[168:171],a[168:171],a[48:51],v[168:171]
buffer_load_dwordx4 v14, s[48:51], s22 offen offset:2048   lds
M v[164:167],a[168:171],a[40:43],v[164:167]
s_nop 0
T a[152:153],v4,16384
T a[154:155],v4,17408
M v[164:167],a[172:175],a[44:47],v[164:167]
s_waitcnt lgkmcnt(4)
M v[160:163],a[172:175],a[36:39],v[160:163]
M v[160:163],a[168:171],a[32:35],v[160:163]
M v[192:195],a[160:163],a[32:35],v[192:195]
R a[168:171],v5,55296
R a[172:175],v6,55296
M v[192:195],a[164:167],a[36:39],v[192:195]
M v[196:199],a[164:167],a[44:47],v[196:199]
buffer_load_dwordx4 v15, s[48:51], s22 offen offset:3072   lds
M v[196:199],a[160:163],a[40:43],v[196:199]
s_nop 0
T a[156:157],v4,24576
T a[158:159],v4,25600
M v[200:203],a[160:163],a[48:51],v[200:203]
s_waitcnt vmcnt(16)
R a[192:195],v20,16384
R a[196:199],v20,18432
M v[200:203],a[164:167],a[52:55],v[200:203]
R a[200:203],v21,16384
R a[204:207],v21,18432
M v[204:207],a[164:167],a[60:63],v[204:207]
M v[204:207],a[160:163],a[56:59],v[204:207]
M v[208:211],a[160:163],a[64:67],v[208:211]
M v[208:211],a[164:167],a[68:71],v[208:211]
M v[212:215],a[164:167],a[76:79],v[212:215]
SA s22,s22,1048576
M v[212:215],a[160:163],a[72:75],v[212:215]
M v[216:219],a[160:163],a[80:83],v[216:219]
M v[216:219],a[164:167],a[84:87],v[216:219]
s_waitcnt lgkmcnt(6)
M v[220:223],a[164:167],a[92:95],v[220:223]
s_waitcnt lgkmcnt(0)
M v[220:223],a[160:163],a[88:91],v[220:223]
s_barrier
M v[252:255],a[168:171],a[88:91],v[252:255]
R a[160:163],v5,0
R a[164:167],v6,0
M v[252:255],a[172:175],a[92:95],v[252:255]
M v[248:251],a[172:175],a[84:87],v[248:251]
M v[248:251],a[168:171],a[80:83],v[248:251]
M v[244:247],a[168:171],a[72:75],v[244:247]
M v[244:247],a[172:175],a[76:79],v[244:247]
M v[240:243],a[172:175],a[68:71],v[240:243]
M v[240:243],a[168:171],a[64:67],v[240:243]
M v[236:239],a[168:171],a[56:59],v[236:239]
M v[236:239],a[172:175],a[60:63],v[236:239]
M v[232:235],a[172:175],a[52:55],v[232:235]
M v[232:235],a[168:171],a[48:51],v[232:235]
M v[228:231],a[168:171],a[40:43],v[228:231]
M v[228:231],a[172:175],a[44:47],v[228:231]
s_waitcnt lgkmcnt(0)
M v[224:227],a[172:175],a[36:39],v[224:227]
M v[224:227],a[168:171],a[32:35],v[224:227]
M a[0:3],a[160:163],a[96:99],a[0:3]
R a[168:171],v5,2048
R a[172:175],v6,2048
M a[0:3],a[164:167],a[100:103],a[0:3]
SA m0,s23,147456
T a[32:33],v1,32768
T a[34:35],v1,33792
M a[4:7],a[164:167],a[108:111],a[4:7]
buffer_load_dwordx4 v22, s[56:59], s29 offen offset:0 lds
M a[4:7],a[160:163],a[104:107],a[4:7]
M a[8:11],a[160:163],a[112:115],a[8:11]
M a[8:11],a[164:167],a[116:119],a[8:11]
buffer_load_dwordx4 v23, s[56:59], s29 offen offset:1024 lds
M a[12:15],a[164:167],a[124:127],a[12:15]
s_nop 0
T a[36:37],v1,40960
T a[38:39],v1,41984
M a[12:15],a[160:163],a[120:123],a[12:15]
M a[16:19],a[160:163],a[128:131],a[16:19]
buffer_load_dwordx4 v22, s[56:59], s30 offen offset:2048 lds
M a[16:19],a[164:167],a[132:135],a[16:19]
M a[20:23],a[164:167],a[140:143],a[20:23]
M a[20:23],a[160:163],a[136:139],a[20:23]
s_nop 0
T a[40:41],v2,32768
T a[42:43],v2,33792
M a[24:27],a[160:163],a[144:147],a[24:27]
buffer_load_dwordx4 v23, s[56:59], s30 offen offset:3072 lds
M a[24:27],a[164:167],a[148:151],a[24:27]
s_waitcnt lgkmcnt(6)
M a[28:31],a[164:167],a[156:159],a[28:31]
SA s29,s29,128
M a[28:31],a[160:163],a[152:155],a[28:31]
SA s30,s30,128
M v[60:63],a[168:171],a[152:155],v[60:63]
SA m0,s24,49152
R a[160:163],v5,4096
R a[164:167],v6,4096
M v[60:63],a[172:175],a[156:159],v[60:63]
T a[44:45],v2,40960
T a[46:47],v2,41984
M v[56:59],a[172:175],a[148:151],v[56:59]
buffer_load_dwordx4 v12, s[48:51], s22 offen offset:0   lds
M v[56:59],a[168:171],a[144:147],v[56:59]
M v[52:55],a[168:171],a[136:139],v[52:55]
M v[52:55],a[172:175],a[140:143],v[52:55]
s_nop 0
T a[48:49],v3,32768
T a[50:51],v3,33792
M v[48:51],a[172:175],a[132:135],v[48:51]
buffer_load_dwordx4 v13, s[48:51], s22 offen offset:1024   lds
M v[48:51],a[168:171],a[128:131],v[48:51]
M v[44:47],a[168:171],a[120:123],v[44:47]
M v[44:47],a[172:175],a[124:127],v[44:47]
buffer_load_dwordx4 v14, s[48:51], s22 offen offset:2048   lds
M v[40:43],a[172:175],a[116:119],v[40:43]
s_nop 0
T a[52:53],v3,40960
T a[54:55],v3,41984
M v[40:43],a[168:171],a[112:115],v[40:43]
M v[36:39],a[168:171],a[104:107],v[36:39]
buffer_load_dwordx4 v15, s[48:51], s22 offen offset:3072   lds
M v[36:39],a[172:175],a[108:111],v[36:39]
s_waitcnt lgkmcnt(6)
M v[32:35],a[172:175],a[100:103],v[32:35]
s_sub_u32 s22, s22, 1048448
M v[32:35],a[168:171],a[96:99],v[32:35]
s_mov_b32 s25, 0
T a[56:57],v4,32768
T a[58:59],v4,33792
M v[64:67],a[160:163],a[96:99],v[64:67]
SA m0,s4,0
R a[168:171],v5,6144
R a[172:175],v6,6144
M v[64:67],a[164:167],a[100:103],v[64:67]
buffer_load_dwordx4 v8, s[52:55], s25 offen lds
M v[68:71],a[164:167],a[108:111],v[68:71]
s_mov_b32 s25, 262144
M v[68:71],a[160:163],a[104:107],v[68:71]
SA m0,s4,4096
M v[72:75],a[160:163],a[112:115],v[72:75]
s_waitcnt vmcnt(13)
s_nop 0
T a[60:61],v4,40960
T a[62:63],v4,41984
M v[72:75],a[164:167],a[116:119],v[72:75]
buffer_load_dwordx4 v8, s[52:55], s25 offen lds
M v[76:79],a[164:167],a[124:127],v[76:79]
s_mov_b32 s25, 524288
R a[208:211],v20,0
R a[212:215],v20,2048
M v[76:79],a[160:163],a[120:123],v[76:79]
SA m0,s4,8192
R a[216:219],v21,0
R a[220:223],v21,2048
M v[80:83],a[160:163],a[128:131],v[80:83]
buffer_load_dwordx4 v8, s[52:55], s25 offen lds
M v[80:83],a[164:167],a[132:135],v[80:83]
s_mov_b32 s25, 786432
M v[84:87],a[164:167],a[140:143],v[84:87]
SA m0,s4,12288
M v[84:87],a[160:163],a[136:139],v[84:87]
buffer_load_dwordx4 v8, s[52:55], s25 offen lds
M v[88:91],a[160:163],a[144:147],v[88:91]
M v[88:91],a[164:167],a[148:151],v[88:91]
s_waitcnt lgkmcnt(6)
M v[92:95],a[164:167],a[156:159],v[92:95]
s_waitcnt lgkmcnt(0)
M v[92:95],a[160:163],a[152:155],v[92:95]
s_barrier
M v[124:127],a[168:171],a[152:155],v[124:127]
R a[160:163],v5,16384
R a[164:167],v6,16384
M v[124:127],a[172:175],a[156:159],v[124:127]
SA m0,s23,32768
M v[120:123],a[172:175],a[148:151],v[120:123]
s_nop 0
T a[64:65],v1,49152
T a[66:67],v1,50176
M v[120:123],a[168:171],a[144:147],v[120:123]
buffer_load_dwordx4 v22, s[56:59], s29 offen offset:0 lds
M v[116:119],a[168:171],a[136:139],v[116:119]
v_lshrrev_b32 v28, 2, v0
v_lshlrev_b32 v28, 7, v28
M v[116:119],a[172:175],a[140:143],v[116:119]
M v[112:115],a[172:175],a[132:135],v[112:115]
buffer_load_dwordx4 v23, s[56:59], s29 offen offset:1024 lds
M v[112:115],a[168:171],a[128:131],v[112:115]
v_and_b32 v29, 3, v0
M v[108:111],a[168:171],a[120:123],v[108:111]
v_lshl_add_u32 v28, v29, 3, v28
M v[108:111],a[172:175],a[124:127],v[108:111]
s_nop 0
T a[68:69],v1,57344
T a[70:71],v1,58368
M v[104:107],a[172:175],a[116:119],v[104:107]
buffer_load_dwordx4 v22, s[56:59], s30 offen offset:2048 lds
M v[104:107],a[168:171],a[112:115],v[104:107]
v_bfe_u32 v29, v0, 3, 2
M v[100:103],a[168:171],a[104:107],v[100:103]
M v[100:103],a[172:175],a[108:111],v[100:103]
s_waitcnt lgkmcnt(4)
v_lshl_add_u32 v16, v29, 5, v28
M v[96:99],a[172:175],a[100:103],v[96:99]
M v[96:99],a[168:171],a[96:99],v[96:99]
buffer_load_dwordx4 v23, s[56:59], s30 offen offset:3072 lds
M v[128:131],a[160:163],a[96:99],v[128:131]
R a[168:171],v5,18432
R a[172:175],v6,18432
M v[128:131],a[164:167],a[100:103],v[128:131]
SA s29,s29,128
T a[72:73],v2,49152
T a[74:75],v2,50176
M v[132:135],a[164:167],a[108:111],v[132:135]
SA s30,s30,128
v_xor_b32 v17, 32, v16
v_xor_b32 v18, 64, v16
M v[132:135],a[160:163],a[104:107],v[132:135]
SA m0,s23,65536
M v[136:139],a[160:163],a[112:115],v[136:139]
buffer_load_dwordx4 v22, s[56:59], s29 offen offset:0 lds
M v[136:139],a[164:167],a[116:119],v[136:139]
v_xor_b32 v19, 0x60, v16
M v[140:143],a[164:167],a[124:127],v[140:143]
v_add_u32 v12, 0x20000, v16
M v[140:143],a[160:163],a[120:123],v[140:143]
s_nop 0
T a[76:77],v2,57344
T a[78:79],v2,58368
M v[144:147],a[160:163],a[128:131],v[144:147]
buffer_load_dwordx4 v23, s[56:59], s29 offen offset:1024 lds
M v[144:147],a[164:167],a[132:135],v[144:147]
v_add_u32 v13, 0x20000, v17
M v[148:151],a[164:167],a[140:143],v[148:151]
M v[148:151],a[160:163],a[136:139],v[148:151]
v_add_u32 v14, 0x20000, v18
M v[152:155],a[160:163],a[144:147],v[152:155]
M v[152:155],a[164:167],a[148:151],v[152:155]
s_waitcnt lgkmcnt(4)
buffer_load_dwordx4 v22, s[56:59], s30 offen offset:2048 lds
M v[156:159],a[164:167],a[156:159],v[156:159]
s_nop 0
T a[80:81],v3,49152
T a[82:83],v3,50176
M v[156:159],a[160:163],a[152:155],v[156:159]
v_add_u32 v15, 0x20000, v19
M v[188:191],a[168:171],a[152:155],v[188:191]
R a[160:163],v5,20480
R a[164:167],v6,20480
M v[188:191],a[172:175],a[156:159],v[188:191]
M v[184:187],a[172:175],a[148:151],v[184:187]
buffer_load_dwordx4 v23, s[56:59], s30 offen offset:3072 lds
M v[184:187],a[168:171],a[144:147],v[184:187]
SA s29,s29,128
M v[180:183],a[168:171],a[136:139],v[180:183]
SA s30,s30,128
M v[180:183],a[172:175],a[140:143],v[180:183]
s_mov_b32 s25, 1048576
T a[84:85],v3,57344
T a[86:87],v3,58368
M v[176:179],a[172:175],a[132:135],v[176:179]
SA m0,s4,16384
M v[176:179],a[168:171],a[128:131],v[176:179]
buffer_load_dwordx4 v8, s[52:55], s25 offen lds
M v[172:175],a[168:171],a[120:123],v[172:175]
M v[172:175],a[172:175],a[124:127],v[172:175]
s_mov_b32 s25, 1310720
M v[168:171],a[172:175],a[116:119],v[168:171]
SA m0,s4,20480
M v[168:171],a[168:171],a[112:115],v[168:171]
buffer_load_dwordx4 v8, s[52:55], s25 offen lds
M v[164:167],a[168:171],a[104:107],v[164:167]
s_nop 0
T a[88:89],v4,49152
T a[90:91],v4,50176
M v[164:167],a[172:175],a[108:111],v[164:167]
s_waitcnt lgkmcnt(4)
M v[160:163],a[172:175],a[100:103],v[160:163]
s_mov_b32 s25, 1572864
M v[160:163],a[168:171],a[96:99],v[160:163]
SA m0,s4,24576
M v[192:195],a[160:163],a[96:99],v[192:195]
R a[168:171],v5,22528
R a[172:175],v6,22528
M v[192:195],a[164:167],a[100:103],v[192:195]
buffer_load_dwordx4 v8, s[52:55], s25 offen lds
M v[196:199],a[164:167],a[108:111],v[196:199]
M v[196:199],a[160:163],a[104:107],v[196:199]
s_mov_b32 s25, 1835008
T a[92:93],v4,57344
T a[94:95],v4,58368
M v[200:203],a[160:163],a[112:115],v[200:203]
SA m0,s4,28672
M v[200:203],a[164:167],a[116:119],v[200:203]
s_waitcnt vmcnt(19)
buffer_load_dwordx4 v8, s[52:55], s25 offen lds
M v[204:207],a[164:167],a[124:127],v[204:207]
R a[224:227],v20,16384
R a[228:231],v20,18432
M v[204:207],a[160:163],a[120:123],v[204:207]
R a[232:235],v21,16384
R a[236:239],v21,18432
M v[208:211],a[160:163],a[128:131],v[208:211]
v_subrev_u32 v20, 98304, v20
v_subrev_u32 v21, 98304, v21
M v[208:211],a[164:167],a[132:135],v[208:211]
M v[212:215],a[164:167],a[140:143],v[212:215]
M v[212:215],a[160:163],a[136:139],v[212:215]
M v[216:219],a[160:163],a[144:147],v[216:219]
M v[216:219],a[164:167],a[148:151],v[216:219]
s_waitcnt lgkmcnt(6)
M v[220:223],a[164:167],a[156:159],v[220:223]
s_waitcnt lgkmcnt(0)
M v[220:223],a[160:163],a[152:155],v[220:223]
s_barrier
M v[252:255],a[168:171],a[152:155],v[252:255]
R a[160:163],v5,32768
R a[164:167],v6,32768
M v[252:255],a[172:175],a[156:159],v[252:255]
M v[248:251],a[172:175],a[148:151],v[248:251]
M v[248:251],a[168:171],a[144:147],v[248:251]
M v[244:247],a[168:171],a[136:139],v[244:247]
M v[244:247],a[172:175],a[140:143],v[244:247]
M v[240:243],a[172:175],a[132:135],v[240:243]
M v[240:243],a[168:171],a[128:131],v[240:243]
M v[236:239],a[168:171],a[120:123],v[236:239]
M v[236:239],a[172:175],a[124:127],v[236:239]
M v[232:235],a[172:175],a[116:119],v[232:235]
M v[232:235],a[168:171],a[112:115],v[232:235]
M v[228:231],a[168:171],a[104:107],v[228:231]
M v[228:231],a[172:175],a[108:111],v[228:231]
s_waitcnt lgkmcnt(0)
M v[224:227],a[172:175],a[100:103],v[224:227]
M v[224:227],a[168:171],a[96:99],v[224:227]
M a[0:3],a[160:163],a[32:35],a[0:3]
R a[168:171],v5,34816
R a[172:175],v6,34816
M a[0:3],a[164:167],a[36:39],a[0:3]
SA m0,s23,81920
M a[4:7],a[164:167],a[44:47],a[4:7]
buffer_load_dwordx4 v22, s[56:59], s29 offen offset:0 lds
M a[4:7],a[160:163],a[40:43],a[4:7]
M a[8:11],a[160:163],a[48:51],a[8:11]
M a[8:11],a[164:167],a[52:55],a[8:11]
buffer_load_dwordx4 v23, s[56:59], s29 offen offset:1024 lds
M a[12:15],a[164:167],a[60:63],a[12:15]
M a[12:15],a[160:163],a[56:59],a[12:15]
M a[16:19],a[160:163],a[64:67],a[16:19]
M a[16:19],a[164:167],a[68:71],a[16:19]
buffer_load_dwordx4 v22, s[56:59], s30 offen offset:2048 lds
M a[20:23],a[164:167],a[76:79],a[20:23]
M a[20:23],a[160:163],a[72:75],a[20:23]
M a[24:27],a[160:163],a[80:83],a[24:27]
M a[24:27],a[164:167],a[84:87],a[24:27]
s_waitcnt lgkmcnt(0)
buffer_load_dwordx4 v23, s[56:59], s30 offen offset:3072 lds
M a[28:31],a[164:167],a[92:95],a[28:31]
SA s29,s29,128
M a[28:31],a[160:163],a[88:91],a[28:31]
SA s30,s30,128
M v[32:35],a[168:171],a[32:35],v[32:35]
s_mov_b32 s25, 2097152
R a[160:163],v5,36864
R a[164:167],v6,36864
M v[32:35],a[172:175],a[36:39],v[32:35]
SA m0,s4,131072
M v[36:39],a[172:175],a[44:47],v[36:39]
buffer_load_dwordx4 v8, s[52:55], s25 offen lds
M v[36:39],a[168:171],a[40:43],v[36:39]
s_mov_b32 s25, 2359296
M v[40:43],a[168:171],a[48:51],v[40:43]
SA m0,s4,135168
M v[40:43],a[172:175],a[52:55],v[40:43]
buffer_load_dwordx4 v8, s[52:55], s25 offen lds
M v[44:47],a[172:175],a[60:63],v[44:47]
G v24,a0
G v25,a1
M v[44:47],a[168:171],a[56:59],v[44:47]
s_mov_b32 s25, 2621440
G v26,a2
G v27,a3
M v[48:51],a[168:171],a[64:67],v[48:51]
SA m0,s4,139264
C v24,v24,v25
C v25,v26,v27
M v[48:51],a[172:175],a[68:71],v[48:51]
buffer_load_dwordx4 v8, s[52:55], s25 offen lds
M v[52:55],a[172:175],a[76:79],v[52:55]
C v26,v32,v33
C v27,v34,v35
M v[52:55],a[168:171],a[72:75],v[52:55]
SA s3,s93,0
M v[56:59],a[168:171],a[80:83],v[56:59]
s_mov_b32 s25, 2883584
buffer_store_dwordx4 v[24:27], v7, s[8:11], s3 offen offset:0 sc1
M v[56:59],a[172:175],a[84:87],v[56:59]
s_waitcnt lgkmcnt(0)
G v28,a4
G v29,a5
M v[60:63],a[172:175],a[92:95],v[60:63]
SA m0,s4,143360
G v30,a6
G v31,a7
M v[60:63],a[168:171],a[88:91],v[60:63]
s_waitcnt vmcnt(16)
buffer_load_dwordx4 v8, s[52:55], s25 offen lds
M v[64:67],a[160:163],a[32:35],v[64:67]
L_w_kv17:
s_cbranch_execz L_wd2
s_mov_b32 s25, 3145728
R a[168:171],v5,38912
R a[172:175],v6,38912
M v[64:67],a[164:167],a[36:39],v[64:67]
SA m0,s4,147456
C v28,v28,v29
C v29,v30,v31
M v[68:71],a[164:167],a[44:47],v[68:71]
buffer_load_dwordx4 v8, s[52:55], s25 offen lds
M v[68:71],a[160:163],a[40:43],v[68:71]
s_mov_b32 s25, 3407872
C v30,v36,v37
C v31,v38,v39
M v[72:75],a[160:163],a[48:51],v[72:75]
SA m0,s4,151552
buffer_store_dwordx4 v[28:31], v7, s[8:11], s3 offen offset:2048 sc1
M v[72:75],a[164:167],a[52:55],v[72:75]
G v24,a8
G v25,a9
M v[76:79],a[164:167],a[60:63],v[76:79]
G v26,a10
G v27,a11
M v[76:79],a[160:163],a[56:59],v[76:79]
buffer_load_dwordx4 v8, s[52:55], s25 offen lds
M v[80:83],a[160:163],a[64:67],v[80:83]
C v24,v24,v25
C v25,v26,v27
M v[80:83],a[164:167],a[68:71],v[80:83]
C v26,v40,v41
C v27,v42,v43
M v[84:87],a[164:167],a[76:79],v[84:87]
SA s3,s93,4096
buffer_store_dwordx4 v[24:27], v7, s[8:11], s3 offen offset:0 sc1
M v[84:87],a[160:163],a[72:75],v[84:87]
R a[96:99],v20,0
R a[100:103],v20,2048
M v[88:91],a[160:163],a[80:83],v[88:91]
R a[104:107],v21,0
R a[108:111],v21,2048
M v[88:91],a[164:167],a[84:87],v[88:91]
s_waitcnt lgkmcnt(4)
G v28,a12
G v29,a13
M v[92:95],a[164:167],a[92:95],v[92:95]
s_waitcnt lgkmcnt(0)
G v30,a14
G v31,a15
M v[92:95],a[160:163],a[88:91],v[92:95]
s_barrier
M v[96:99],a[168:171],a[32:35],v[96:99]
R a[160:163],v5,49152
R a[164:167],v6,49152
M v[96:99],a[172:175],a[36:39],v[96:99]
s_mov_b32 s25, 128
C v28,v28,v29
C v29,v30,v31
M v[100:103],a[172:175],a[44:47],v[100:103]
SA m0,s4,49152
C v30,v44,v45
C v31,v46,v47
M v[100:103],a[168:171],a[40:43],v[100:103]
s_waitcnt vmcnt(17)
buffer_store_dwordx4 v[28:31], v7, s[8:11], s3 offen offset:2048 sc1
M v[104:107],a[168:171],a[48:51],v[104:107]
G v24,a16
G v25,a17
M v[104:107],a[172:175],a[52:55],v[104:107]
G v26,a18
G v27,a19
M v[108:111],a[172:175],a[60:63],v[108:111]
buffer_load_dwordx4 v8, s[52:55], s25 offen lds
M v[108:111],a[168:171],a[56:59],v[108:111]
C v24,v24,v25
C v25,v26,v27
M v[112:115],a[168:171],a[64:67],v[112:115]
C v26,v48,v49
C v27,v50,v51
M v[112:115],a[172:175],a[68:71],v[112:115]
SA s3,s93,8192
buffer_store_dwordx4 v[24:27], v7, s[8:11], s3 offen offset:0 sc1
M v[116:119],a[172:175],a[76:79],v[116:119]
s_mov_b32 s25, 262272
R a[112:115],v20,32768
R a[116:119],v20,34816
M v[116:119],a[168:171],a[72:75],v[116:119]
SA m0,s4,53248
R a[120:123],v21,32768
R a[124:127],v21,34816
M v[120:123],a[168:171],a[80:83],v[120:123]
C v64,v64,v65
C v65,v66,v67
M v[120:123],a[172:175],a[84:87],v[120:123]
s_waitcnt lgkmcnt(4)
buffer_load_dwordx4 v8, s[52:55], s25 offen lds
M v[124:127],a[172:175],a[92:95],v[124:127]
C v66,v96,v97
C v67,v98,v99
M v[124:127],a[168:171],a[88:91],v[124:127]
G v28,a20
G v29,a21
M v[128:131],a[160:163],a[32:35],v[128:131]
R a[168:171],v5,51200
R a[172:175],v6,51200
M v[128:131],a[164:167],a[36:39],v[128:131]
G v30,a22
G v31,a23
M v[132:135],a[164:167],a[44:47],v[132:135]
C v28,v28,v29
C v29,v30,v31
M v[132:135],a[160:163],a[40:43],v[132:135]
s_mov_b32 s25, 524416
C v30,v52,v53
C v31,v54,v55
M v[136:139],a[160:163],a[48:51],v[136:139]
SA m0,s4,57344
buffer_store_dwordx4 v[28:31], v7, s[8:11], s3 offen offset:2048 sc1
M v[136:139],a[164:167],a[52:55],v[136:139]
C v68,v68,v69
C v69,v70,v71
M v[140:143],a[164:167],a[60:63],v[140:143]
C v70,v100,v101
C v71,v102,v103
M v[140:143],a[160:163],a[56:59],v[140:143]
C v72,v72,v73
C v73,v74,v75
M v[144:147],a[160:163],a[64:67],v[144:147]
buffer_load_dwordx4 v8, s[52:55], s25 offen lds
M v[144:147],a[164:167],a[68:71],v[144:147]
C v74,v104,v105
C v75,v106,v107
M v[148:151],a[164:167],a[76:79],v[148:151]
C v76,v76,v77
C v77,v78,v79
M v[148:151],a[160:163],a[72:75],v[148:151]
C v78,v108,v109
C v79,v110,v111
M v[152:155],a[160:163],a[80:83],v[152:155]
C v80,v80,v81
C v81,v82,v83
M v[152:155],a[164:167],a[84:87],v[152:155]
s_waitcnt lgkmcnt(0)
C v82,v112,v113
C v83,v114,v115
M v[156:159],a[164:167],a[92:95],v[156:159]
s_mov_b32 s25, 786560
C v84,v84,v85
C v85,v86,v87
M v[156:159],a[160:163],a[88:91],v[156:159]
SA m0,s4,61440
C v86,v116,v117
C v87,v118,v119
M v[160:163],a[168:171],a[32:35],v[160:163]
R a[160:163],v5,53248
R a[164:167],v6,53248
M v[160:163],a[172:175],a[36:39],v[160:163]
buffer_load_dwordx4 v8, s[52:55], s25 offen lds
M v[164:167],a[172:175],a[44:47],v[164:167]
G v24,a24
G v25,a25
M v[164:167],a[168:171],a[40:43],v[164:167]
G v26,a26
G v27,a27
M v[168:171],a[168:171],a[48:51],v[168:171]
C v24,v24,v25
C v25,v26,v27
M v[168:171],a[172:175],a[52:55],v[168:171]
C v26,v56,v57
C v27,v58,v59
M v[172:175],a[172:175],a[60:63],v[172:175]
SA s3,s93,12288
buffer_store_dwordx4 v[24:27], v7, s[8:11], s3 offen offset:0 sc1
M v[172:175],a[168:171],a[56:59],v[172:175]
C v88,v88,v89
C v89,v90,v91
M v[176:179],a[168:171],a[64:67],v[176:179]
C v90,v120,v121
C v91,v122,v123
M v[176:179],a[172:175],a[68:71],v[176:179]
C v92,v92,v93
C v93,v94,v95
M v[180:183],a[172:175],a[76:79],v[180:183]
C v94,v124,v125
C v95,v126,v127
M v[180:183],a[168:171],a[72:75],v[180:183]
G v28,a28
G v29,a29
M v[184:187],a[168:171],a[80:83],v[184:187]
G v30,a30
G v31,a31
M v[184:187],a[172:175],a[84:87],v[184:187]
s_waitcnt lgkmcnt(0)
C v28,v28,v29
C v29,v30,v31
M v[188:191],a[172:175],a[92:95],v[188:191]
C v30,v60,v61
C v31,v62,v63
M v[188:191],a[168:171],a[88:91],v[188:191]
buffer_store_dwordx4 v[28:31], v7, s[8:11], s3 offen offset:2048 sc1
M v[192:195],a[160:163],a[32:35],v[192:195]
s_waitcnt vmcnt(18)
R a[168:171],v5,55296
R a[172:175],v6,55296
M v[192:195],a[164:167],a[36:39],v[192:195]
C v128,v128,v129
C v129,v130,v131
M v[196:199],a[164:167],a[44:47],v[196:199]
C v130,v160,v161
C v131,v162,v163
M v[196:199],a[160:163],a[40:43],v[196:199]
C v132,v132,v133
C v133,v134,v135
M v[200:203],a[160:163],a[48:51],v[200:203]
C v134,v164,v165
C v135,v166,v167
M v[200:203],a[164:167],a[52:55],v[200:203]
C v136,v136,v137
C v137,v138,v139
M v[204:207],a[164:167],a[60:63],v[204:207]
C v138,v168,v169
C v139,v170,v171
M v[204:207],a[160:163],a[56:59],v[204:207]
C v140,v140,v141
C v141,v142,v143
M v[208:211],a[160:163],a[64:67],v[208:211]
C v142,v172,v173
C v143,v174,v175
M v[208:211],a[164:167],a[68:71],v[208:211]
C v144,v144,v145
C v145,v146,v147
M v[212:215],a[164:167],a[76:79],v[212:215]
R a[128:131],v20,49152
R a[132:135],v20,51200
R a[136:139],v21,49152
R a[140:143],v21,51200
M v[212:215],a[160:163],a[72:75],v[212:215]
C v146,v176,v177
C v147,v178,v179
M v[216:219],a[160:163],a[80:83],v[216:219]
C v148,v148,v149
C v149,v150,v151
M v[216:219],a[164:167],a[84:87],v[216:219]
s_waitcnt lgkmcnt(4)
C v150,v180,v181
C v151,v182,v183
M v[220:223],a[164:167],a[92:95],v[220:223]
s_waitcnt vmcnt(10) lgkmcnt(0)
C v152,v152,v153
C v153,v154,v155
M v[220:223],a[160:163],a[88:91],v[220:223]
s_barrier
M v[224:227],a[168:171],a[32:35],v[224:227]
s_nop 0
T v[32:33],v16,0
T v[34:35],v16,2048
M v[224:227],a[172:175],a[36:39],v[224:227]
C v154,v184,v185
C v155,v186,v187
M v[228:231],a[172:175],a[44:47],v[228:231]
T v[36:37],v16,4096
T v[38:39],v16,6144
M v[228:231],a[168:171],a[40:43],v[228:231]
T v[40:41],v16,8192
T v[42:43],v16,10240
M v[232:235],a[168:171],a[48:51],v[232:235]
C v156,v156,v157
C v157,v158,v159
M v[232:235],a[172:175],a[52:55],v[232:235]
T v[44:45],v16,12288
T v[46:47],v16,14336
M v[236:239],a[172:175],a[60:63],v[236:239]
T v[48:49],v16,16384
T v[50:51],v16,18432
M v[236:239],a[168:171],a[56:59],v[236:239]
C v158,v188,v189
C v159,v190,v191
M v[240:243],a[168:171],a[64:67],v[240:243]
T v[52:53],v16,20480
T v[54:55],v16,22528
M v[240:243],a[172:175],a[68:71],v[240:243]
T v[56:57],v16,24576
T v[58:59],v16,26624
M v[244:247],a[172:175],a[76:79],v[244:247]
C v192,v192,v193
C v193,v194,v195
M v[244:247],a[168:171],a[72:75],v[244:247]
C v194,v224,v225
C v195,v226,v227
M v[248:251],a[168:171],a[80:83],v[248:251]
C v196,v196,v197
C v197,v198,v199
M v[248:251],a[172:175],a[84:87],v[248:251]
C v198,v228,v229
C v199,v230,v231
M v[252:255],a[172:175],a[92:95],v[252:255]
C v200,v200,v201
C v201,v202,v203
M v[252:255],a[168:171],a[88:91],v[252:255]
s_waitcnt lgkmcnt(6)
C v202,v232,v233
C v203,v234,v235
M v[96:99],v[32:35],a[176:179],0
s_mul_i32 s72, s41, 4352
T a[144:145],v17,0
T a[146:147],v17,2048
M v[96:99],v[36:39],a[184:187],v[96:99]
s_mov_b32 s25, 1048704
C v204,v204,v205
C v205,v206,v207
M v[96:99],v[40:43],a[192:195],v[96:99]
s_waitcnt lgkmcnt(2)
T a[148:149],v17,4096
T a[150:151],v17,6144
M v[96:99],v[44:47],a[200:203],v[96:99]
SA m0,s4,98304
T a[152:153],v17,8192
T a[154:155],v17,10240
M v[96:99],v[48:51],a[208:211],v[96:99]
SA s46,s72,104923136
buffer_load_dwordx4 v8, s[52:55], s25 offen lds
M v[96:99],v[52:55],a[216:219],v[96:99]
s_lshl_b32 s45, s42, 7
T a[156:157],v17,12288
T a[158:159],v17,14336
M v[96:99],v[56:59],a[224:227],v[96:99]
s_mov_b32 s25, 1310848
T a[160:161],v17,16384
T a[162:163],v17,18432
M v[100:103],v[56:59],a[228:231],0
SA m0,s4,102400
C v206,v236,v237
C v207,v238,v239
M v[100:103],v[52:55],a[220:223],v[100:103]
SA s45,s45,s46
T a[164:165],v17,20480
T a[166:167],v17,22528
M v[100:103],v[48:51],a[212:215],v[100:103]
s_lshl_b32 s72, s20, 2
T a[168:169],v17,24576
T a[170:171],v17,26624
M v[100:103],v[44:47],a[204:207],v[100:103]
SA s72,s72,s45
buffer_load_dwordx4 v8, s[52:55], s25 offen lds
M v[100:103],v[40:43],a[196:199],v[100:103]
C v208,v208,v209
C v209,v210,v211
M v[100:103],v[36:39],a[188:191],v[100:103]
s_mov_b32 s25, 1572992
C v210,v240,v241
C v211,v242,v243
M v[100:103],v[32:35],a[180:183],v[100:103]
s_waitcnt lgkmcnt(6)
C v212,v212,v213
C v213,v214,v215
M v[104:107],a[144:147],a[176:179],0
SA m0,s4,106496
T v[32:33],v18,0
T v[34:35],v18,2048
M v[104:107],a[148:151],a[184:187],v[104:107]
buffer_load_dwordx4 v8, s[52:55], s25 offen lds
M v[104:107],a[152:155],a[192:195],v[104:107]
s_waitcnt lgkmcnt(2)
s_nop 0
T v[36:37],v18,4096
T v[38:39],v18,6144
M v[104:107],a[156:159],a[200:203],v[104:107]
s_mov_b32 s25, 1835136
T v[40:41],v18,8192
T v[42:43],v18,10240
M v[104:107],a[160:163],a[208:211],v[104:107]
SA m0,s4,110592
C v214,v244,v245
C v215,v246,v247
M v[104:107],a[164:167],a[216:219],v[104:107]
T v[44:45],v18,12288
T v[46:47],v18,14336
M v[104:107],a[168:171],a[224:227],v[104:107]
T v[48:49],v18,16384
T v[50:51],v18,18432
M v[108:111],a[168:171],a[228:231],0
buffer_load_dwordx4 v8, s[52:55], s25 offen lds
M v[108:111],a[164:167],a[220:223],v[108:111]
s_nop 0
T v[52:53],v18,20480
T v[54:55],v18,22528
M v[108:111],a[160:163],a[212:215],v[108:111]
s_mov_b32 s25, 2097280
T v[56:57],v18,24576
T v[58:59],v18,26624
M v[108:111],a[156:159],a[204:207],v[108:111]
SA m0,s4,114688
C v216,v216,v217
C v217,v218,v219
M v[108:111],a[152:155],a[196:199],v[108:111]
SA s3,s93,524288
buffer_load_dwordx4 v8, s[52:55], s25 offen lds
M v[108:111],a[148:151],a[188:191],v[108:111]
C v218,v248,v249
C v219,v250,v251
M v[108:111],a[144:147],a[180:183],v[108:111]
s_waitcnt lgkmcnt(6)
buffer_store_dwordx4 v[64:67], v7, s[8:11], s3 offen offset:0 sc1
M v[112:115],v[32:35],a[176:179],0
s_mov_b32 s25, 2359424
T a[144:145],v19,0
T a[146:147],v19,2048
M v[112:115],v[36:39],a[184:187],v[112:115]
SA m0,s4,118784
buffer_store_dwordx4 v[68:71], v7, s[8:11], s3 offen offset:2048 sc1
M v[112:115],v[40:43],a[192:195],v[112:115]
s_waitcnt lgkmcnt(2)
s_nop 0
T a[148:149],v19,4096
T a[150:151],v19,6144
M v[112:115],v[44:47],a[200:203],v[112:115]
T a[152:153],v19,8192
T a[154:155],v19,10240
M v[112:115],v[48:51],a[208:211],v[112:115]
buffer_load_dwordx4 v8, s[52:55], s25 offen lds
M v[112:115],v[52:55],a[216:219],v[112:115]
s_nop 0
T a[156:157],v19,12288
T a[158:159],v19,14336
M v[112:115],v[56:59],a[224:227],v[112:115]
s_mov_b32 s25, 2621568
T a[160:161],v19,16384
T a[162:163],v19,18432
M v[116:119],v[56:59],a[228:231],0
SA m0,s4,122880
C v220,v220,v221
C v221,v222,v223
M v[116:119],v[52:55],a[220:223],v[116:119]
T a[164:165],v19,20480
T a[166:167],v19,22528
M v[116:119],v[48:51],a[212:215],v[116:119]
T a[168:169],v19,24576
T a[170:171],v19,26624
M v[116:119],v[44:47],a[204:207],v[116:119]
buffer_load_dwordx4 v8, s[52:55], s25 offen lds
M v[116:119],v[40:43],a[196:199],v[116:119]
C v222,v252,v253
C v223,v254,v255
M v[116:119],v[36:39],a[188:191],v[116:119]
s_mov_b32 s25, 2883712
v_min_u32 v29, 1, v0
v_lshlrev_b32 v29, 29, v29
M v[116:119],v[32:35],a[180:183],v[116:119]
s_waitcnt lgkmcnt(6)
v_mov_b32 v30, 1
v_add_u32 v20, 0x10000, v16
M v[120:123],a[144:147],a[176:179],0
SA m0,s4,126976
T v[32:33],v16,28672
T v[34:35],v16,30720
M v[120:123],a[148:151],a[184:187],v[120:123]
s_waitcnt vmcnt(9)
buffer_load_dwordx4 v8, s[52:55], s25 offen lds
M v[120:123],a[152:155],a[192:195],v[120:123]
s_waitcnt lgkmcnt(2)
s_nop 0
T v[36:37],v12,0
T v[38:39],v12,2048
M v[120:123],a[156:159],a[200:203],v[120:123]
s_mov_b32 s25, 3145856
T v[40:41],v12,4096
T v[42:43],v12,6144
M v[120:123],a[160:163],a[208:211],v[120:123]
SA m0,s4,32768
buffer_store_dword v30, v29, s[8:11], s72 offen offset:4 sc1
M v[120:123],a[164:167],a[216:219],v[120:123]
s_nop 0
T v[44:45],v12,8192
T v[46:47],v12,10240
M v[120:123],a[168:171],a[224:227],v[120:123]
T v[48:49],v12,12288
T v[50:51],v12,14336
M v[124:127],a[168:171],a[228:231],0
buffer_load_dwordx4 v8, s[52:55], s25 offen lds
M v[124:127],a[164:167],a[220:223],v[124:127]
s_nop 0
T v[52:53],v12,16384
T v[54:55],v12,18432
M v[124:127],a[160:163],a[212:215],v[124:127]
s_mov_b32 s25, 3408000
T v[56:57],v12,20480
T v[58:59],v12,22528
M v[124:127],a[156:159],a[204:207],v[124:127]
SA m0,s4,36864
v_add_u32 v21, 0x10000, v17
v_add_u32 v22, 0x10000, v18
M v[124:127],a[152:155],a[196:199],v[124:127]
SA s3,s93,528384
buffer_load_dwordx4 v8, s[52:55], s25 offen lds
M v[124:127],a[148:151],a[188:191],v[124:127]
v_add_u32 v23, 0x10000, v19
v_or_b32 v1, s20, v0
M v[124:127],a[144:147],a[180:183],v[124:127]
s_waitcnt lgkmcnt(6)
buffer_store_dwordx4 v[72:75], v7, s[8:11], s3 offen offset:0 sc1
M v[96:99],v[32:35],a[232:235],v[96:99]
s_mov_b32 s25, 256
T a[144:145],v17,28672
T a[146:147],v17,30720
M v[96:99],v[36:39],a[96:99],v[96:99]
SA m0,s4,65536
v_min_u32 v1, 1, v1
v_lshlrev_b32 v1, 29, v1
M v[96:99],v[40:43],a[104:107],v[96:99]
s_waitcnt lgkmcnt(2)
T a[148:149],v13,0
T a[150:151],v13,2048
M v[96:99],v[44:47],a[112:115],v[96:99]
T a[152:153],v13,4096
T a[154:155],v13,6144
M v[96:99],v[48:51],a[120:123],v[96:99]
buffer_load_dwordx4 v8, s[52:55], s25 offen lds
M v[96:99],v[52:55],a[128:131],v[96:99]
s_nop 0
T a[156:157],v13,8192
T a[158:159],v13,10240
M v[96:99],v[56:59],a[136:139],v[96:99]
s_mov_b32 s25, 262400
T a[160:161],v13,12288
T a[162:163],v13,14336
M v[100:103],v[56:59],a[140:143],v[100:103]
SA m0,s4,69632
v_min_u32 v9, 15, v0
v_lshlrev_b32 v9, 7, v9
M v[100:103],v[52:55],a[132:135],v[100:103]
s_sub_u32 s66, 15, s42
T a[164:165],v13,16384
T a[166:167],v13,18432
M v[100:103],v[48:51],a[124:127],v[100:103]
s_max_u32 s67, s66, s42
T a[168:169],v13,20480
L_w_kv18:
s_cbranch_execz L_wd2
T a[170:171],v13,22528
M v[100:103],v[44:47],a[116:119],v[100:103]
s_min_u32 s66, s66, s42
buffer_load_dwordx4 v8, s[52:55], s25 offen lds
M v[100:103],v[40:43],a[108:111],v[100:103]
s_mul_i32 s21, s41, 1048576
M v[100:103],v[36:39],a[100:103],v[100:103]
s_mov_b32 s25, 524544
M v[100:103],v[32:35],a[236:239],v[100:103]
s_waitcnt lgkmcnt(6)
M v[104:107],a[144:147],a[232:235],v[104:107]
SA m0,s4,73728
T v[32:33],v18,28672
T v[34:35],v18,30720
M v[104:107],a[148:151],a[96:99],v[104:107]
s_lshl_b32 s64, s67, 16
buffer_load_dwordx4 v8, s[52:55], s25 offen lds
M v[104:107],a[152:155],a[104:107],v[104:107]
s_waitcnt lgkmcnt(2)
s_nop 0
T v[36:37],v14,0
T v[38:39],v14,2048
M v[104:107],a[156:159],a[112:115],v[104:107]
s_mov_b32 s25, 786688
T v[40:41],v14,4096
T v[42:43],v14,6144
M v[104:107],a[160:163],a[120:123],v[104:107]
SA m0,s4,77824
M v[104:107],a[164:167],a[128:131],v[104:107]
SA s32,s21,s64
T v[44:45],v14,8192
T v[46:47],v14,10240
M v[104:107],a[168:171],a[136:139],v[104:107]
s_lshl_b32 s64, s20, 14
T v[48:49],v14,12288
T v[50:51],v14,14336
M v[108:111],a[168:171],a[140:143],v[108:111]
SA s32,s32,s64
buffer_load_dwordx4 v8, s[52:55], s25 offen lds
M v[108:111],a[164:167],a[132:135],v[108:111]
SA s32,s32,33554432
T v[52:53],v14,16384
T v[54:55],v14,18432
M v[108:111],a[160:163],a[124:127],v[108:111]
s_mov_b32 s25, 1048832
T v[56:57],v14,20480
T v[58:59],v14,22528
M v[108:111],a[156:159],a[116:119],v[108:111]
s_sub_u32 s64, s42, 10
s_and_b32 s35, s64, 536870912
v_or_b32 v6, s35, v7
M v[108:111],a[152:155],a[108:111],v[108:111]
SA m0,s4,81920
MF v96,s5,v96
MF v97,s5,v97
M v[108:111],a[148:151],a[100:103],v[108:111]
s_lshl_b32 s28, s20, 13
buffer_load_dwordx4 v8, s[52:55], s25 offen lds
M v[108:111],a[144:147],a[236:239],v[108:111]
s_waitcnt lgkmcnt(6)
v_add_u32 v2, 0x10000, v7
v_add_u32 v3, s28, v7
M v[112:115],v[32:35],a[232:235],v[112:115]
s_mov_b32 s25, 1310976
T a[144:145],v19,28672
T a[146:147],v19,30720
M v[112:115],v[36:39],a[96:99],v[112:115]
SA m0,s4,86016
v_add_u32 v4, 0x1000, v3
MF v98,s5,v98
M v[112:115],v[40:43],a[104:107],v[112:115]
s_waitcnt lgkmcnt(2)
T a[148:149],v15,0
T a[150:151],v15,2048
M v[112:115],v[44:47],a[112:115],v[112:115]
s_lshl_b32 s64, s42, 16
T a[152:153],v15,4096
T a[154:155],v15,6144
M v[112:115],v[48:51],a[120:123],v[112:115]
SA s23,s21,s64
buffer_load_dwordx4 v8, s[52:55], s25 offen lds
M v[112:115],v[52:55],a[128:131],v[112:115]
SA s43,s23,16777216
T a[156:157],v15,8192
T a[158:159],v15,10240
M v[112:115],v[56:59],a[136:139],v[112:115]
s_mov_b32 s25, 1573120
T a[160:161],v15,12288
T a[162:163],v15,14336
M v[116:119],v[56:59],a[140:143],v[116:119]
SA m0,s4,90112
MF v99,s5,v99
MF v104,s5,v104
M v[116:119],v[52:55],a[132:135],v[116:119]
SA s26,s21,16777216
T a[164:165],v15,16384
T a[166:167],v15,18432
M v[116:119],v[48:51],a[124:127],v[116:119]
s_min_u32 s27, s42, 9
T a[168:169],v15,20480
T a[170:171],v15,22528
M v[116:119],v[44:47],a[116:119],v[116:119]
s_lshl_b32 s22, s27, 1
buffer_load_dwordx4 v8, s[52:55], s25 offen lds
M v[116:119],v[40:43],a[108:111],v[116:119]
s_sub_u32 s22, s22, 1
MF v105,s5,v105
MF v106,s5,v106
M v[116:119],v[36:39],a[100:103],v[116:119]
s_waitcnt vmcnt(8) lgkmcnt(0)
MF v107,s5,v107
C v96,v96,v97
M v[116:119],v[32:35],a[236:239],v[116:119]
s_barrier
M v[120:123],a[144:147],a[232:235],v[120:123]
s_mov_b32 s25, 1835264
T v[32:33],v16,49152
T v[34:35],v16,51200
M v[120:123],a[148:151],a[96:99],v[120:123]
SA m0,s4,94208
C v97,v98,v99
C v98,v104,v105
M v[120:123],a[152:155],a[104:107],v[120:123]
s_sub_u32 s27, s27, 2
T v[36:37],v16,53248
T v[38:39],v16,55296
M v[120:123],a[156:159],a[112:115],v[120:123]
s_mov_b32 s31, 0x4b800000
T v[40:41],v16,57344
T v[42:43],v16,59392
M v[120:123],a[160:163],a[120:123],v[120:123]
s_mov_b32 s24, 0x33800000
buffer_load_dwordx4 v8, s[52:55], s25 offen lds
M v[120:123],a[164:167],a[128:131],v[120:123]
s_lshl_b32 s47, s66, 7
T v[44:45],v16,61440
T v[46:47],v16,63488
M v[120:123],a[168:171],a[136:139],v[120:123]
s_mov_b32 s25, 2097408
T v[48:49],v20,32768
T v[50:51],v20,34816
M v[124:127],a[168:171],a[140:143],v[124:127]
SA m0,s4,155648
C v99,v106,v107
W a0,v96
M v[124:127],a[164:167],a[132:135],v[124:127]
SA s47,s47,s46
T v[52:53],v20,36864
T v[54:55],v20,38912
M v[124:127],a[160:163],a[124:127],v[124:127]
s_lshl_b32 s64, s20, 5
T v[56:57],v20,40960
T v[58:59],v20,43008
M v[124:127],a[156:159],a[116:119],v[124:127]
SA s47,s47,s64
buffer_load_dwordx4 v8, s[52:55], s25 offen lds
M v[124:127],a[152:155],a[108:111],v[124:127]
SA s47,s47,2048
W a1,v97
W a2,v98
M v[124:127],a[148:151],a[100:103],v[124:127]
s_lshl_b32 s65, s41, 3
W a3,v99
MF v100,s5,v100
M v[124:127],a[144:147],a[236:239],v[124:127]
s_waitcnt lgkmcnt(6)
MF v101,s5,v101
MF v102,s5,v102
M v[160:163],v[32:35],a[176:179],0
SA s65,s65,s66
T a[144:145],v17,49152
T a[146:147],v17,51200
M v[160:163],v[36:39],a[184:187],v[160:163]
s_mul_i32 s34, s65, 73728
MF v103,s5,v103
MF v108,s5,v108
M v[160:163],v[40:43],a[192:195],v[160:163]
s_waitcnt lgkmcnt(2)
T a[148:149],v17,53248
T a[150:151],v17,55296
M v[160:163],v[44:47],a[200:203],v[160:163]
SA s34,s34,136314880
T a[152:153],v17,57344
T a[154:155],v17,59392
M v[160:163],v[48:51],a[208:211],v[160:163]
s_lshl_b32 s65, s42, 4
MF v109,s5,v109
MF v110,s5,v110
M v[160:163],v[52:55],a[216:219],v[160:163]
SA s65,s65,s41
T a[156:157],v17,61440
T a[158:159],v17,63488
M v[160:163],v[56:59],a[224:227],v[160:163]
s_mul_i32 s33, s65, 114688
T a[160:161],v21,32768
T a[162:163],v21,34816
M v[164:167],v[56:59],a[228:231],0
s_mul_i32 s65, s20, 28672
MF v111,s5,v111
C v100,v100,v101
M v[164:167],v[52:55],a[220:223],v[164:167]
SA s33,s33,s65
T a[164:165],v21,36864
T a[166:167],v21,38912
M v[164:167],v[48:51],a[212:215],v[164:167]
SA s33,s33,67108864
T a[168:169],v21,40960
T a[170:171],v21,43008
M v[164:167],v[44:47],a[204:207],v[164:167]
s_mov_b32 s6, 0
C v101,v102,v103
C v102,v108,v109
M v[164:167],v[40:43],a[196:199],v[164:167]
s_mov_b32 s7, 1
C v103,v110,v111
W a32,v100
M v[164:167],v[36:39],a[188:191],v[164:167]
s_mov_b32 s40, 1
W a33,v101
W a34,v102
M v[164:167],v[32:35],a[180:183],v[164:167]
s_waitcnt lgkmcnt(6)
W a35,v103
MF v112,s5,v112
M v[168:171],a[144:147],a[176:179],0
s_cmp_eq_u32 s20, 0
T v[32:33],v18,49152
T v[34:35],v18,51200
M v[168:171],a[148:151],a[184:187],v[168:171]
s_cselect_b32 s39, 6, 4
MF v113,s5,v113
MF v114,s5,v114
M v[168:171],a[152:155],a[192:195],v[168:171]
s_waitcnt lgkmcnt(2)
T v[36:37],v18,53248
T v[38:39],v18,55296
M v[168:171],a[156:159],a[200:203],v[168:171]
s_mov_b64 s[60:61], s[76:77]
T v[40:41],v18,57344
T v[42:43],v18,59392
M v[168:171],a[160:163],a[208:211],v[168:171]
s_mov_b32 s62, s78
MF v115,s5,v115
MF v120,s5,v120
M v[168:171],a[164:167],a[216:219],v[168:171]
s_mov_b32 s63, 0x20000
T v[44:45],v18,61440
T v[46:47],v18,63488
M v[168:171],a[168:171],a[224:227],v[168:171]
SA s30,s32,0
T v[48:49],v22,32768
T v[50:51],v22,34816
M v[172:175],a[168:171],a[228:231],0
s_mov_b32 s25, 2359552
buffer_store_dwordx4 a[0:3], v6, s[8:11], s30 offen offset:0 sc1
M v[172:175],a[164:167],a[220:223],v[172:175]
SA m0,s4,159744
T v[52:53],v22,36864
T v[54:55],v22,38912
M v[172:175],a[160:163],a[212:215],v[172:175]
SA s3,s93,528384
T v[56:57],v22,40960
T v[58:59],v22,43008
M v[172:175],a[156:159],a[204:207],v[172:175]
buffer_load_dwordx4 v8, s[52:55], s25 offen lds
M v[172:175],a[152:155],a[196:199],v[172:175]
v_lshrrev_b32 v24, 4, v0
v_lshlrev_b32 v24, 2, v24
M v[172:175],a[148:151],a[188:191],v[172:175]
s_mov_b32 s25, 2621696
buffer_store_dwordx4 v[76:79], v7, s[8:11], s3 offen offset:2048 sc1
M v[172:175],a[144:147],a[180:183],v[172:175]
s_waitcnt lgkmcnt(6)
v_and_b32 v25, 15, v0
v_sub_u32 v24, v24, v25
M v[176:179],v[32:35],a[176:179],0
SA m0,s4,131072
T a[144:145],v19,49152
T a[146:147],v19,51200
M v[176:179],v[36:39],a[184:187],v[176:179]
buffer_load_dwordx4 v8, s[52:55], s25 offen lds
M v[176:179],v[40:43],a[192:195],v[176:179]
s_waitcnt lgkmcnt(2)
s_nop 0
T a[148:149],v19,53248
T a[150:151],v19,55296
M v[176:179],v[44:47],a[200:203],v[176:179]
s_mov_b32 s25, 2883840
T a[152:153],v19,57344
T a[154:155],v19,59392
M v[176:179],v[48:51],a[208:211],v[176:179]
SA m0,s4,135168
v_cmp_lt_i32 s[16:17], 0, v24
v_cmp_lt_i32 s[18:19], -1, v24
M v[176:179],v[52:55],a[216:219],v[176:179]
T a[156:157],v19,61440
T a[158:159],v19,63488
M v[176:179],v[56:59],a[224:227],v[176:179]
T a[160:161],v23,32768
T a[162:163],v23,34816
M v[180:183],v[56:59],a[228:231],0
buffer_load_dwordx4 v8, s[52:55], s25 offen lds
M v[180:183],v[52:55],a[220:223],v[180:183]
s_nop 0
T a[164:165],v23,36864
T a[166:167],v23,38912
M v[180:183],v[48:51],a[212:215],v[180:183]
s_mov_b32 s25, 3145984
T a[168:169],v23,40960
T a[170:171],v23,43008
M v[180:183],v[44:47],a[204:207],v[180:183]
SA m0,s4,139264
v_cmp_lt_i32 s[48:49], -2, v24
v_cmp_lt_i32 s[50:51], -3, v24
M v[180:183],v[40:43],a[196:199],v[180:183]
buffer_load_dwordx4 v8, s[52:55], s25 offen lds
M v[180:183],v[36:39],a[188:191],v[180:183]
v_lshl_add_u32 v25, v0, 7, s95
v_and_b32 v0, 48, v0
M v[180:183],v[32:35],a[180:183],v[180:183]
s_waitcnt lgkmcnt(6)
MF v121,s5,v121
MF v122,s5,v122
M v[184:187],a[144:147],a[176:179],0
s_mov_b32 s25, 3408128
T v[32:33],v20,45056
T v[34:35],v20,47104
M v[184:187],a[148:151],a[184:187],v[184:187]
SA m0,s4,143360
MF v123,s5,v123
C v112,v112,v113
M v[184:187],a[152:155],a[192:195],v[184:187]
s_waitcnt lgkmcnt(2)
T v[36:37],v20,49152
T v[38:39],v20,51200
M v[184:187],a[156:159],a[200:203],v[184:187]
SA s30,s32,8192
T v[40:41],v20,53248
T v[42:43],v20,55296
M v[184:187],a[160:163],a[208:211],v[184:187]
buffer_store_dwordx4 a[32:35], v6, s[8:11], s30 offen offset:0 sc1
M v[184:187],a[164:167],a[216:219],v[184:187]
s_nop 0
T v[44:45],v20,57344
T v[46:47],v20,59392
M v[184:187],a[168:171],a[224:227],v[184:187]
T v[48:49],v20,61440
T v[50:51],v20,63488
M v[188:191],a[168:171],a[228:231],0
buffer_load_dwordx4 v8, s[52:55], s25 offen lds
M v[188:191],a[164:167],a[220:223],v[188:191]
SA s3,s93,532480
T v[52:53],v16,32768
T v[54:55],v16,34816
M v[188:191],a[160:163],a[212:215],v[188:191]
s_mov_b32 s25, 384
T v[56:57],v16,36864
T v[58:59],v16,38912
M v[188:191],a[156:159],a[204:207],v[188:191]
SA m0,s4,0
buffer_store_dwordx4 v[80:83], v7, s[8:11], s3 offen offset:0 sc1
M v[188:191],a[152:155],a[196:199],v[188:191]
C v113,v114,v115
C v114,v120,v121
M v[188:191],a[148:151],a[188:191],v[188:191]
buffer_load_dwordx4 v8, s[52:55], s25 offen lds
M v[188:191],a[144:147],a[180:183],v[188:191]
s_waitcnt lgkmcnt(6)
C v115,v122,v123
W a4,v112
M v[160:163],v[32:35],a[232:235],v[160:163]
s_mov_b32 s25, 262528
T a[144:145],v21,45056
T a[146:147],v21,47104
M v[160:163],v[36:39],a[96:99],v[160:163]
SA m0,s4,4096
buffer_store_dwordx4 v[84:87], v7, s[8:11], s3 offen offset:2048 sc1
M v[160:163],v[40:43],a[104:107],v[160:163]
s_waitcnt lgkmcnt(2)
s_nop 0
T a[148:149],v21,49152
T a[150:151],v21,51200
M v[160:163],v[44:47],a[112:115],v[160:163]
T a[152:153],v21,53248
T a[154:155],v21,55296
M v[160:163],v[48:51],a[120:123],v[160:163]
buffer_load_dwordx4 v8, s[52:55], s25 offen lds
M v[160:163],v[52:55],a[128:131],v[160:163]
s_nop 0
T a[156:157],v21,57344
T a[158:159],v21,59392
M v[160:163],v[56:59],a[136:139],v[160:163]
s_mov_b32 s25, 524672
T a[160:161],v21,61440
T a[162:163],v21,63488
M v[164:167],v[56:59],a[140:143],v[164:167]
SA m0,s4,8192
W a5,v113
W a6,v114
M v[164:167],v[52:55],a[132:135],v[164:167]
T a[164:165],v17,32768
T a[166:167],v17,34816
M v[164:167],v[48:51],a[124:127],v[164:167]
T a[168:169],v17,36864
T a[170:171],v17,38912
M v[164:167],v[44:47],a[116:119],v[164:167]
buffer_load_dwordx4 v8, s[52:55], s25 offen lds
M v[164:167],v[40:43],a[108:111],v[164:167]
W a7,v115
v_lshl_add_u32 v0, v0, 24, v25
M v[164:167],v[36:39],a[100:103],v[164:167]
s_mov_b32 s25, 786816
v_mov_b32 v24, 0x3f80
MF v116,s5,v116
M v[164:167],v[32:35],a[236:239],v[164:167]
s_waitcnt lgkmcnt(6)
MF v117,s5,v117
MF v118,s5,v118
M v[168:171],a[144:147],a[232:235],v[168:171]
SA s30,s32,0
T v[32:33],v22,45056
T v[34:35],v22,47104
M v[168:171],a[148:151],a[96:99],v[168:171]
SA m0,s4,12288
buffer_store_dwordx4 a[4:7], v6, s[8:11], s30 offen offset:1024 sc1
M v[168:171],a[152:155],a[104:107],v[168:171]
s_waitcnt lgkmcnt(2)
s_nop 0
T v[36:37],v22,49152
T v[38:39],v22,51200
M v[168:171],a[156:159],a[112:115],v[168:171]
T v[40:41],v22,53248
T v[42:43],v22,55296
M v[168:171],a[160:163],a[120:123],v[168:171]
buffer_load_dwordx4 v8, s[52:55], s25 offen lds
M v[168:171],a[164:167],a[128:131],v[168:171]
s_nop 0
T v[44:45],v22,57344
T v[46:47],v22,59392
M v[168:171],a[168:171],a[136:139],v[168:171]
s_mov_b32 s25, 1048960
T v[48:49],v22,61440
T v[50:51],v22,63488
M v[172:175],a[168:171],a[140:143],v[172:175]
SA m0,s4,16384
MF v119,s5,v119
MF v124,s5,v124
M v[172:175],a[164:167],a[132:135],v[172:175]
T v[52:53],v18,32768
T v[54:55],v18,34816
M v[172:175],a[160:163],a[124:127],v[172:175]
T v[56:57],v18,36864
T v[58:59],v18,38912
M v[172:175],a[156:159],a[116:119],v[172:175]
buffer_load_dwordx4 v8, s[52:55], s25 offen lds
M v[172:175],a[152:155],a[108:111],v[172:175]
MF v125,s5,v125
MF v126,s5,v126
M v[172:175],a[148:151],a[100:103],v[172:175]
s_mov_b32 s25, 1311104
v_lshrrev_b32 v25, 8, v7
v_bfe_u32 v26, v7, 6, 2
v_and_b32 v27, 16, v7
v_lshlrev_b32 v27, v27, v24
v_cmp_eq_u32 vcc, v25, v26
v_and_b32 v28, 32, v7
W a244,0
v_cndmask_b32 v27, 0, v27, vcc
v_cmp_eq_u32 vcc, 0, v28
W a245,0
W a248,0
v_cndmask_b32 v25, 0, v27, vcc
v_sub_u32 v26, v27, v25
W a249,0
W a246,v25
W a247,v26
M v[172:175],a[144:147],a[236:239],v[172:175]
s_waitcnt lgkmcnt(6)
MF v127,s5,v127
C v116,v116,v117
M v[176:179],v[32:35],a[232:235],v[176:179]
SA m0,s4,20480
T a[144:145],v23,45056
T a[146:147],v23,47104
M v[176:179],v[36:39],a[96:99],v[176:179]
buffer_load_dwordx4 v8, s[52:55], s25 offen lds
M v[176:179],v[40:43],a[104:107],v[176:179]
s_waitcnt lgkmcnt(2)
s_nop 0
T a[148:149],v23,49152
T a[150:151],v23,51200
M v[176:179],v[44:47],a[112:115],v[176:179]
s_mov_b32 s25, 1573248
T a[152:153],v23,53248
T a[154:155],v23,55296
M v[176:179],v[48:51],a[120:123],v[176:179]
SA m0,s4,24576
C v117,v118,v119
C v118,v124,v125
M v[176:179],v[52:55],a[128:131],v[176:179]
T a[156:157],v23,57344
T a[158:159],v23,59392
M v[176:179],v[56:59],a[136:139],v[176:179]
T a[160:161],v23,61440
T a[162:163],v23,63488
M v[180:183],v[56:59],a[140:143],v[180:183]
buffer_load_dwordx4 v8, s[52:55], s25 offen lds
M v[180:183],v[52:55],a[132:135],v[180:183]
s_nop 0
T a[164:165],v19,32768
T a[166:167],v19,34816
M v[180:183],v[48:51],a[124:127],v[180:183]
s_mov_b32 s25, 1835392
T a[168:169],v19,36864
T a[170:171],v19,38912
M v[180:183],v[44:47],a[116:119],v[180:183]
SA m0,s4,28672
C v119,v126,v127
W a36,v116
M v[180:183],v[40:43],a[108:111],v[180:183]
buffer_load_dwordx4 v8, s[52:55], s25 offen lds
M v[180:183],v[36:39],a[100:103],v[180:183]
s_waitcnt vmcnt(11) lgkmcnt(0)
W a37,v117
W a38,v118
M v[180:183],v[32:35],a[236:239],v[180:183]
s_barrier
M v[184:187],a[144:147],a[232:235],v[184:187]
s_mov_b32 s25, 2097536
T v[32:33],v20,0
T v[34:35],v20,2048
M v[184:187],a[148:151],a[96:99],v[184:187]
SA m0,s4,40960
W a39,v119
MF v160,s5,v160
M v[184:187],a[152:155],a[104:107],v[184:187]
SA s30,s32,8192
T v[36:37],v20,4096
T v[38:39],v20,6144
M v[184:187],a[156:159],a[112:115],v[184:187]
T v[40:41],v20,8192
T v[42:43],v20,10240
M v[184:187],a[160:163],a[120:123],v[184:187]
buffer_store_dwordx4 a[36:39], v6, s[8:11], s30 offen offset:1024 sc1
M v[184:187],a[164:167],a[128:131],v[184:187]
s_nop 0
T v[44:45],v20,12288
T v[46:47],v20,14336
M v[184:187],a[168:171],a[136:139],v[184:187]
T v[48:49],v20,16384
T v[50:51],v20,18432
M v[188:191],a[168:171],a[140:143],v[188:191]
buffer_load_dwordx4 v8, s[52:55], s25 offen lds
M v[188:191],a[164:167],a[132:135],v[188:191]
s_nop 0
T v[52:53],v20,20480
T v[54:55],v20,22528
M v[188:191],a[160:163],a[124:127],v[188:191]
s_mov_b32 s25, 2359680
T v[56:57],v20,24576
T v[58:59],v20,26624
M v[188:191],a[156:159],a[116:119],v[188:191]
SA m0,s4,45056
MF v161,s5,v161
MF v162,s5,v162
M v[188:191],a[152:155],a[108:111],v[188:191]
buffer_load_dwordx4 v8, s[52:55], s25 offen lds
M v[188:191],a[148:151],a[100:103],v[188:191]
MF v163,s5,v163
MF v168,s5,v168
M v[188:191],a[144:147],a[236:239],v[188:191]
s_waitcnt lgkmcnt(6)
MF v169,s5,v169
MF v170,s5,v170
M v[96:99],v[32:35],a[176:179],0
s_mov_b32 s25, 2621824
T a[144:145],v21,0
T a[146:147],v21,2048
M v[96:99],v[36:39],a[184:187],v[96:99]
SA m0,s4,49152
MF v171,s5,v171
C v160,v160,v161
M v[96:99],v[40:43],a[192:195],v[96:99]
s_waitcnt lgkmcnt(2)
T a[148:149],v21,4096
T a[150:151],v21,6144
M v[96:99],v[44:47],a[200:203],v[96:99]
T a[152:153],v21,8192
T a[154:155],v21,10240
M v[96:99],v[48:51],a[208:211],v[96:99]
buffer_load_dwordx4 v8, s[52:55], s25 offen lds
M v[96:99],v[52:55],a[216:219],v[96:99]
s_nop 0
T a[156:157],v21,12288
T a[158:159],v21,14336
M v[96:99],v[56:59],a[224:227],v[96:99]
s_mov_b32 s25, 2883968
T a[160:161],v21,16384
T a[162:163],v21,18432
M v[100:103],v[56:59],a[228:231],0
SA m0,s4,53248
C v161,v162,v163
C v162,v168,v169
M v[100:103],v[52:55],a[220:223],v[100:103]
T a[164:165],v21,20480
T a[166:167],v21,22528
M v[100:103],v[48:51],a[212:215],v[100:103]
T a[168:169],v21,24576
T a[170:171],v21,26624
M v[100:103],v[44:47],a[204:207],v[100:103]
SA s3,s93,536576
buffer_load_dwordx4 v8, s[52:55], s25 offen lds
M v[100:103],v[40:43],a[196:199],v[100:103]
C v163,v170,v171
W a8,v160
M v[100:103],v[36:39],a[188:191],v[100:103]
s_mov_b32 s25, 3146112
W a9,v161
W a10,v162
M v[100:103],v[32:35],a[180:183],v[100:103]
s_waitcnt lgkmcnt(6)
W a11,v163
v_lshrrev_b32 v31, 6, v7
M v[104:107],a[144:147],a[176:179],0
SA s30,s32,0
T v[32:33],v22,0
T v[34:35],v22,2048
M v[104:107],a[148:151],a[184:187],v[104:107]
SA m0,s4,57344
buffer_store_dwordx4 a[8:11], v6, s[8:11], s30 offen offset:2048 sc1
M v[104:107],a[152:155],a[192:195],v[104:107]
s_waitcnt lgkmcnt(2)
s_nop 0
T v[36:37],v22,4096
T v[38:39],v22,6144
M v[104:107],a[156:159],a[200:203],v[104:107]
T v[40:41],v22,8192
T v[42:43],v22,10240
M v[104:107],a[160:163],a[208:211],v[104:107]
buffer_load_dwordx4 v8, s[52:55], s25 offen lds
M v[104:107],a[164:167],a[216:219],v[104:107]
s_nop 0
T v[44:45],v22,12288
T v[46:47],v22,14336
M v[104:107],a[168:171],a[224:227],v[104:107]
s_mov_b32 s25, 3408256
T v[48:49],v22,16384
T v[50:51],v22,18432
M v[108:111],a[168:171],a[228:231],0
SA m0,s4,61440
buffer_store_dwordx4 v[88:91], v7, s[8:11], s3 offen offset:0 sc1
M v[108:111],a[164:167],a[220:223],v[108:111]
s_nop 0
T v[52:53],v22,20480
T v[54:55],v22,22528
M v[108:111],a[160:163],a[212:215],v[108:111]
T v[56:57],v22,24576
T v[58:59],v22,26624
M v[108:111],a[156:159],a[204:207],v[108:111]
buffer_load_dwordx4 v8, s[52:55], s25 offen lds
M v[108:111],a[152:155],a[196:199],v[108:111]
v_bfe_u32 v28, v7, 4, 2
v_lshlrev_b32 v31, 5, v31
M v[108:111],a[148:151],a[188:191],v[108:111]
buffer_store_dwordx4 v[92:95], v7, s[8:11], s3 offen offset:2048 sc1
M v[108:111],a[144:147],a[180:183],v[108:111]
s_waitcnt lgkmcnt(6)
v_add_lshl_u32 v31, v31, v28, 2
MF v164,s5,v164
M v[112:115],v[32:35],a[176:179],0
T a[144:145],v23,0
T a[146:147],v23,2048
M v[112:115],v[36:39],a[184:187],v[112:115]
buffer_load_dword v5, v31, s[8:11], s46 offen offset:4 sc1
M v[112:115],v[40:43],a[192:195],v[112:115]
s_waitcnt lgkmcnt(2)
s_nop 0
T a[148:149],v23,4096
T a[150:151],v23,6144
M v[112:115],v[44:47],a[200:203],v[112:115]
T a[152:153],v23,8192
T a[154:155],v23,10240
M v[112:115],v[48:51],a[208:211],v[112:115]
MF v165,s5,v165
MF v166,s5,v166
M v[112:115],v[52:55],a[216:219],v[112:115]
T a[156:157],v23,12288
T a[158:159],v23,14336
M v[112:115],v[56:59],a[224:227],v[112:115]
T a[160:161],v23,16384
T a[162:163],v23,18432
M v[116:119],v[56:59],a[228:231],0
MF v167,s5,v167
MF v172,s5,v172
M v[116:119],v[52:55],a[220:223],v[116:119]
T a[164:165],v23,20480
T a[166:167],v23,22528
M v[116:119],v[48:51],a[212:215],v[116:119]
T a[168:169],v23,24576
T a[170:171],v23,26624
M v[116:119],v[44:47],a[204:207],v[116:119]
MF v173,s5,v173
MF v174,s5,v174
M v[116:119],v[40:43],a[196:199],v[116:119]
MF v175,s5,v175
C v164,v164,v165
M v[116:119],v[36:39],a[188:191],v[116:119]
C v165,v166,v167
C v166,v172,v173
M v[116:119],v[32:35],a[180:183],v[116:119]
s_waitcnt lgkmcnt(6)
C v167,v174,v175
W a40,v164
M v[120:123],a[144:147],a[176:179],0
T v[32:33],v20,28672
T v[34:35],v20,30720
M v[120:123],a[148:151],a[184:187],v[120:123]
W a41,v165
W a42,v166
M v[120:123],a[152:155],a[192:195],v[120:123]
s_waitcnt lgkmcnt(2)
T v[36:37],v12,24576
T v[38:39],v12,26624
M v[120:123],a[156:159],a[200:203],v[120:123]
T v[40:41],v12,28672
T v[42:43],v12,30720
M v[120:123],a[160:163],a[208:211],v[120:123]
W a43,v167
v_mov_b32 v8, 0xff800000
M v[120:123],a[164:167],a[216:219],v[120:123]
SA s30,s32,8192
T v[44:45],v12,0
T v[46:47],v12,2048
M v[120:123],a[168:171],a[224:227],v[120:123]
T v[48:49],v12,4096
T v[50:51],v12,6144
M v[124:127],a[168:171],a[228:231],0
buffer_store_dwordx4 a[40:43], v6, s[8:11], s30 offen offset:2048 sc1
M v[124:127],a[164:167],a[220:223],v[124:127]
s_nop 0
T v[52:53],v12,8192
T v[54:55],v12,10240
M v[124:127],a[160:163],a[212:215],v[124:127]
T v[56:57],v12,12288
T v[58:59],v12,14336
M v[124:127],a[156:159],a[204:207],v[124:127]
MF v176,s5,v176
MF v177,s5,v177
M v[124:127],a[152:155],a[196:199],v[124:127]
MF v178,s5,v178
MF v179,s5,v179
M v[124:127],a[148:151],a[188:191],v[124:127]
MF v184,s5,v184
MF v185,s5,v185
M v[124:127],a[144:147],a[180:183],v[124:127]
s_waitcnt lgkmcnt(6)
MF v186,s5,v186
MF v187,s5,v187
M v[96:99],v[32:35],a[232:235],v[96:99]
T a[144:145],v21,28672
T a[146:147],v21,30720
M v[96:99],v[36:39],a[96:99],v[96:99]
C v176,v176,v177
C v177,v178,v179
M v[96:99],v[40:43],a[104:107],v[96:99]
s_waitcnt lgkmcnt(2)
T a[148:149],v13,24576
T a[150:151],v13,26624
M v[96:99],v[44:47],a[112:115],v[96:99]
T a[152:153],v13,28672
T a[154:155],v13,30720
M v[96:99],v[48:51],a[120:123],v[96:99]
C v178,v184,v185
C v179,v186,v187
M v[96:99],v[52:55],a[128:131],v[96:99]
T a[156:157],v13,0
T a[158:159],v13,2048
M v[96:99],v[56:59],a[136:139],v[96:99]
T a[160:161],v13,4096
T a[162:163],v13,6144
M v[100:103],v[56:59],a[140:143],v[100:103]
W a12,v176
W a13,v177
M v[100:103],v[52:55],a[132:135],v[100:103]
T a[164:165],v13,8192
T a[166:167],v13,10240
M v[100:103],v[48:51],a[124:127],v[100:103]
T a[168:169],v13,12288
T a[170:171],v13,14336
M v[100:103],v[44:47],a[116:119],v[100:103]
W a14,v178
W a15,v179
M v[100:103],v[40:43],a[108:111],v[100:103]
MF v180,s5,v180
MF v181,s5,v181
M v[100:103],v[36:39],a[100:103],v[100:103]
MF v182,s5,v182
MF v183,s5,v183
M v[100:103],v[32:35],a[236:239],v[100:103]
s_waitcnt lgkmcnt(6)
MF v188,s5,v188
MF v189,s5,v189
M v[104:107],a[144:147],a[232:235],v[104:107]
T v[32:33],v22,28672
T v[34:35],v22,30720
M v[104:107],a[148:151],a[96:99],v[104:107]
MF v190,s5,v190
MF v191,s5,v191
M v[104:107],a[152:155],a[104:107],v[104:107]
s_waitcnt lgkmcnt(2)
T v[36:37],v14,24576
T v[38:39],v14,26624
M v[104:107],a[156:159],a[112:115],v[104:107]
SA s30,s32,0
T v[40:41],v14,28672
T v[42:43],v14,30720
M v[104:107],a[160:163],a[120:123],v[104:107]
buffer_store_dwordx4 a[12:15], v6, s[8:11], s30 offen offset:3072 sc1
M v[104:107],a[164:167],a[128:131],v[104:107]
s_nop 0
T v[44:45],v14,0
T v[46:47],v14,2048
M v[104:107],a[168:171],a[136:139],v[104:107]
T v[48:49],v14,4096
T v[50:51],v14,6144
M v[108:111],a[168:171],a[140:143],v[108:111]
C v180,v180,v181
C v181,v182,v183
M v[108:111],a[164:167],a[132:135],v[108:111]
T v[52:53],v14,8192
T v[54:55],v14,10240
M v[108:111],a[160:163],a[124:127],v[108:111]
T v[56:57],v14,12288
T v[58:59],v14,14336
M v[108:111],a[156:159],a[116:119],v[108:111]
C v182,v188,v189
C v183,v190,v191
M v[108:111],a[152:155],a[108:111],v[108:111]
W a44,v180
W a45,v181
M v[108:111],a[148:151],a[100:103],v[108:111]
W a46,v182
W a47,v183
M v[108:111],a[144:147],a[236:239],v[108:111]
s_waitcnt lgkmcnt(6)
s_waitcnt vmcnt(2)
v_cmp_ne_u32 vcc, 1, v5
MF v96,s5,v96
M v[112:115],v[32:35],a[232:235],v[112:115]
s_nop 0
T a[144:145],v23,28672
T a[146:147],v23,30720
M v[112:115],v[36:39],a[96:99],v[112:115]
s_cmp_lg_u32 vcc_lo, 0
MF v97,s5,v97
MF v98,s5,v98
M v[112:115],v[40:43],a[104:107],v[112:115]
s_waitcnt lgkmcnt(2)
T a[148:149],v15,24576
T a[150:151],v15,26624
M v[112:115],v[44:47],a[112:115],v[112:115]
s_cbranch_scc1 L_wsq1
L_wrq1:
T a[152:153],v15,28672
T a[154:155],v15,30720
M v[112:115],v[48:51],a[120:123],v[112:115]
SA m0,s28,98304
MF v99,s5,v99
MF v104,s5,v104
M v[112:115],v[52:55],a[128:131],v[112:115]
T a[156:157],v15,0
T a[158:159],v15,2048
M v[112:115],v[56:59],a[136:139],v[112:115]
T a[160:161],v15,4096
T a[162:163],v15,6144
M v[116:119],v[56:59],a[140:143],v[116:119]
buffer_load_dwordx4 v3, s[8:11], s21 offen offset:0 sc1 lds
M v[116:119],v[52:55],a[132:135],v[116:119]
s_nop 0
T a[164:165],v15,8192
T a[166:167],v15,10240
M v[116:119],v[48:51],a[124:127],v[116:119]
T a[168:169],v15,12288
T a[170:171],v15,14336
M v[116:119],v[44:47],a[116:119],v[116:119]
buffer_load_dwordx4 v3, s[8:11], s21 offen offset:1024 sc1 lds
M v[116:119],v[40:43],a[108:111],v[116:119]
MF v105,s5,v105
MF v106,s5,v106
M v[116:119],v[36:39],a[100:103],v[116:119]
s_waitcnt lgkmcnt(0)
buffer_load_dwordx4 v3, s[8:11], s21 offen offset:2048 sc1 lds
M v[116:119],v[32:35],a[236:239],v[116:119]
s_barrier
M v[120:123],a[144:147],a[232:235],v[120:123]
SA s30,s32,8192
T v[32:33],v16,0
T v[34:35],v16,2048
M v[120:123],a[148:151],a[96:99],v[120:123]
buffer_store_dwordx4 a[44:47], v6, s[8:11], s30 offen offset:3072 sc1
M v[120:123],a[152:155],a[104:107],v[120:123]
s_nop 0
T v[36:37],v16,4096
T v[38:39],v16,6144
M v[120:123],a[156:159],a[112:115],v[120:123]
T v[40:41],v16,8192
T v[42:43],v16,10240
M v[120:123],a[160:163],a[120:123],v[120:123]
buffer_load_dwordx4 v3, s[8:11], s21 offen offset:3072 sc1 lds
M v[120:123],a[164:167],a[128:131],v[120:123]
SA m0,s28,102400
T v[44:45],v16,12288
T v[46:47],v16,14336
M v[120:123],a[168:171],a[136:139],v[120:123]
T v[48:49],v16,16384
T v[50:51],v16,18432
M v[124:127],a[168:171],a[140:143],v[124:127]
buffer_load_dwordx4 v4, s[8:11], s21 offen offset:0 sc1 lds
M v[124:127],a[164:167],a[132:135],v[124:127]
s_nop 0
T v[52:53],v16,20480
T v[54:55],v16,22528
M v[124:127],a[160:163],a[124:127],v[124:127]
T v[56:57],v16,24576
T v[58:59],v16,26624
M v[124:127],a[156:159],a[116:119],v[124:127]
buffer_load_dwordx4 v4, s[8:11], s21 offen offset:1024 sc1 lds
M v[124:127],a[152:155],a[108:111],v[124:127]
MF v107,s5,v107
C v96,v96,v97
M v[124:127],a[148:151],a[100:103],v[124:127]
buffer_load_dwordx4 v4, s[8:11], s21 offen offset:2048 sc1 lds
M v[124:127],a[144:147],a[236:239],v[124:127]
s_waitcnt lgkmcnt(6)
C v97,v98,v99
C v98,v104,v105
M v[160:163],v[32:35],a[176:179],0
T a[144:145],v17,0
T a[146:147],v17,2048
M v[160:163],v[36:39],a[184:187],v[160:163]
buffer_load_dwordx4 v4, s[8:11], s21 offen offset:3072 sc1 lds
M v[160:163],v[40:43],a[192:195],v[160:163]
s_waitcnt lgkmcnt(2)
s_nop 0
T a[148:149],v17,4096
T a[150:151],v17,6144
M v[160:163],v[44:47],a[200:203],v[160:163]
SA s21,s21,32768
T a[152:153],v17,8192
T a[154:155],v17,10240
M v[160:163],v[48:51],a[208:211],v[160:163]
s_sub_u32 s22, s22, 1
C v99,v106,v107
W a16,v96
M v[160:163],v[52:55],a[216:219],v[160:163]
s_cselect_b32 s21, s23, s21
T a[156:157],v17,12288
T a[158:159],v17,14336
M v[160:163],v[56:59],a[224:227],v[160:163]
SA m0,s28,65536
T a[160:161],v17,16384
T a[162:163],v17,18432
M v[164:167],v[56:59],a[228:231],0
buffer_load_dwordx4 v3, s[8:11], s21 offen offset:0 sc1 lds
M v[164:167],v[52:55],a[220:223],v[164:167]
s_nop 0
T a[164:165],v17,20480
T a[166:167],v17,22528
M v[164:167],v[48:51],a[212:215],v[164:167]
T a[168:169],v17,24576
T a[170:171],v17,26624
M v[164:167],v[44:47],a[204:207],v[164:167]
buffer_load_dwordx4 v3, s[8:11], s21 offen offset:1024 sc1 lds
M v[164:167],v[40:43],a[196:199],v[164:167]
buffer_load_dword v5, v31, s[8:11], s46 offen offset:4 sc1
M v[164:167],v[36:39],a[188:191],v[164:167]
buffer_load_dwordx4 v3, s[8:11], s21 offen offset:2048 sc1 lds
M v[164:167],v[32:35],a[180:183],v[164:167]
s_waitcnt lgkmcnt(6)
W a17,v97
W a18,v98
M v[168:171],a[144:147],a[176:179],0
T v[32:33],v18,0
T v[34:35],v18,2048
M v[168:171],a[148:151],a[184:187],v[168:171]
buffer_load_dwordx4 v3, s[8:11], s21 offen offset:3072 sc1 lds
M v[168:171],a[152:155],a[192:195],v[168:171]
s_waitcnt lgkmcnt(2)
s_nop 0
T v[36:37],v18,4096
T v[38:39],v18,6144
M v[168:171],a[156:159],a[200:203],v[168:171]
SA m0,s28,69632
T v[40:41],v18,8192
T v[42:43],v18,10240
M v[168:171],a[160:163],a[208:211],v[168:171]
buffer_load_dwordx4 v4, s[8:11], s21 offen offset:0 sc1 lds
M v[168:171],a[164:167],a[216:219],v[168:171]
s_nop 0
T v[44:45],v18,12288
T v[46:47],v18,14336
M v[168:171],a[168:171],a[224:227],v[168:171]
T v[48:49],v18,16384
T v[50:51],v18,18432
M v[172:175],a[168:171],a[228:231],0
buffer_load_dwordx4 v4, s[8:11], s21 offen offset:1024 sc1 lds
M v[172:175],a[164:167],a[220:223],v[172:175]
s_nop 0
T v[52:53],v18,20480
T v[54:55],v18,22528
M v[172:175],a[160:163],a[212:215],v[172:175]
T v[56:57],v18,24576
T v[58:59],v18,26624
M v[172:175],a[156:159],a[204:207],v[172:175]
buffer_load_dwordx4 v4, s[8:11], s21 offen offset:2048 sc1 lds
M v[172:175],a[152:155],a[196:199],v[172:175]
W a19,v99
MF v100,s5,v100
M v[172:175],a[148:151],a[188:191],v[172:175]
SA s30,s32,4096
buffer_store_dwordx4 a[16:19], v6, s[8:11], s30 offen offset:0 sc1
M v[172:175],a[144:147],a[180:183],v[172:175]
s_waitcnt lgkmcnt(6)
MF v101,s5,v101
MF v102,s5,v102
M v[176:179],v[32:35],a[176:179],0
T a[144:145],v19,0
T a[146:147],v19,2048
M v[176:179],v[36:39],a[184:187],v[176:179]
buffer_load_dwordx4 v4, s[8:11], s21 offen offset:3072 sc1 lds
M v[176:179],v[40:43],a[192:195],v[176:179]
s_waitcnt lgkmcnt(2)
s_nop 0
T a[148:149],v19,4096
T a[150:151],v19,6144
M v[176:179],v[44:47],a[200:203],v[176:179]
SA s21,s21,32768
T a[152:153],v19,8192
T a[154:155],v19,10240
M v[176:179],v[48:51],a[208:211],v[176:179]
s_sub_u32 s22, s22, 1
MF v103,s5,v103
MF v108,s5,v108
M v[176:179],v[52:55],a[216:219],v[176:179]
s_cselect_b32 s21, s23, s21
T a[156:157],v19,12288
T a[158:159],v19,14336
M v[176:179],v[56:59],a[224:227],v[176:179]
T a[160:161],v19,16384
T a[162:163],v19,18432
M v[180:183],v[56:59],a[228:231],0
MF v109,s5,v109
MF v110,s5,v110
M v[180:183],v[52:55],a[220:223],v[180:183]
T a[164:165],v19,20480
T a[166:167],v19,22528
M v[180:183],v[48:51],a[212:215],v[180:183]
T a[168:169],v19,24576
T a[170:171],v19,26624
M v[180:183],v[44:47],a[204:207],v[180:183]
MF v111,s5,v111
C v100,v100,v101
M v[180:183],v[40:43],a[196:199],v[180:183]
C v101,v102,v103
C v102,v108,v109
M v[180:183],v[36:39],a[188:191],v[180:183]
C v103,v110,v111
W a48,v100
M v[180:183],v[32:35],a[180:183],v[180:183]
s_waitcnt lgkmcnt(6)
W a49,v101
W a50,v102
M v[184:187],a[144:147],a[176:179],0
T v[32:33],v16,28672
T v[34:35],v16,30720
M v[184:187],a[148:151],a[184:187],v[184:187]
W a51,v103
MF v112,s5,v112
M v[184:187],a[152:155],a[192:195],v[184:187]
s_waitcnt lgkmcnt(2)
T v[36:37],v16,40960
T v[38:39],v16,43008
M v[184:187],a[156:159],a[200:203],v[184:187]
T v[40:41],v16,45056
T v[42:43],v16,47104
M v[184:187],a[160:163],a[208:211],v[184:187]
MF v113,s5,v113
MF v114,s5,v114
M v[184:187],a[164:167],a[216:219],v[184:187]
T v[44:45],v16,49152
T v[46:47],v16,51200
M v[184:187],a[168:171],a[224:227],v[184:187]
T v[48:49],v16,53248
T v[50:51],v16,55296
M v[188:191],a[168:171],a[228:231],0
MF v115,s5,v115
MF v120,s5,v120
M v[188:191],a[164:167],a[220:223],v[188:191]
SA s30,s32,12288
T v[52:53],v16,57344
T v[54:55],v16,59392
M v[188:191],a[160:163],a[212:215],v[188:191]
T v[56:57],v16,61440
T v[58:59],v16,63488
M v[188:191],a[156:159],a[204:207],v[188:191]
buffer_store_dwordx4 a[48:51], v6, s[8:11], s30 offen offset:0 sc1
M v[188:191],a[152:155],a[196:199],v[188:191]
MF v121,s5,v121
MF v122,s5,v122
M v[188:191],a[148:151],a[188:191],v[188:191]
MF v123,s5,v123
C v112,v112,v113
M v[188:191],a[144:147],a[180:183],v[188:191]
s_waitcnt lgkmcnt(6)
C v113,v114,v115
C v114,v120,v121
M v[160:163],v[32:35],a[232:235],v[160:163]
T a[144:145],v17,28672
T a[146:147],v17,30720
M v[160:163],v[36:39],a[96:99],v[160:163]
C v115,v122,v123
W a20,v112
M v[160:163],v[40:43],a[104:107],v[160:163]
s_waitcnt lgkmcnt(2)
T a[148:149],v17,40960
T a[150:151],v17,43008
M v[160:163],v[44:47],a[112:115],v[160:163]
T a[152:153],v17,45056
T a[154:155],v17,47104
M v[160:163],v[48:51],a[120:123],v[160:163]
W a21,v113
W a22,v114
M v[160:163],v[52:55],a[128:131],v[160:163]
T a[156:157],v17,49152
T a[158:159],v17,51200
M v[160:163],v[56:59],a[136:139],v[160:163]
T a[160:161],v17,53248
T a[162:163],v17,55296
M v[164:167],v[56:59],a[140:143],v[164:167]
W a23,v115
MF v116,s5,v116
M v[164:167],v[52:55],a[132:135],v[164:167]
T a[164:165],v17,57344
T a[166:167],v17,59392
M v[164:167],v[48:51],a[124:127],v[164:167]
T a[168:169],v17,61440
T a[170:171],v17,63488
M v[164:167],v[44:47],a[116:119],v[164:167]
MF v117,s5,v117
MF v118,s5,v118
M v[164:167],v[40:43],a[108:111],v[164:167]
MF v119,s5,v119
MF v124,s5,v124
M v[164:167],v[36:39],a[100:103],v[164:167]
MF v125,s5,v125
MF v126,s5,v126
M v[164:167],v[32:35],a[236:239],v[164:167]
s_waitcnt lgkmcnt(6)
MF v127,s5,v127
C v116,v116,v117
M v[168:171],a[144:147],a[232:235],v[168:171]
T v[32:33],v18,28672
T v[34:35],v18,30720
M v[168:171],a[148:151],a[96:99],v[168:171]
C v117,v118,v119
C v118,v124,v125
M v[168:171],a[152:155],a[104:107],v[168:171]
s_waitcnt lgkmcnt(2)
T v[36:37],v18,40960
T v[38:39],v18,43008
M v[168:171],a[156:159],a[112:115],v[168:171]
T v[40:41],v18,45056
T v[42:43],v18,47104
M v[168:171],a[160:163],a[120:123],v[168:171]
C v119,v126,v127
W a52,v116
M v[168:171],a[164:167],a[128:131],v[168:171]
T v[44:45],v18,49152
T v[46:47],v18,51200
M v[168:171],a[168:171],a[136:139],v[168:171]
SA s30,s32,4096
T v[48:49],v18,53248
T v[50:51],v18,55296
M v[172:175],a[168:171],a[140:143],v[172:175]
buffer_store_dwordx4 a[20:23], v6, s[8:11], s30 offen offset:1024 sc1
M v[172:175],a[164:167],a[132:135],v[172:175]
s_nop 0
T v[52:53],v18,57344
T v[54:55],v18,59392
M v[172:175],a[160:163],a[124:127],v[172:175]
T v[56:57],v18,61440
T v[58:59],v18,63488
M v[172:175],a[156:159],a[116:119],v[172:175]
W a53,v117
W a54,v118
M v[172:175],a[152:155],a[108:111],v[172:175]
W a55,v119
s_waitcnt vmcnt(9)
v_cmp_ne_u32 vcc, 1, v5
M v[172:175],a[148:151],a[100:103],v[172:175]
s_nop 0
MF v160,s5,v160
MF v161,s5,v161
M v[172:175],a[144:147],a[236:239],v[172:175]
s_waitcnt lgkmcnt(6)
MF v162,s5,v162
MF v163,s5,v163
M v[176:179],v[32:35],a[232:235],v[176:179]
s_cmp_lg_u32 vcc_hi, 0
T a[144:145],v19,28672
T a[146:147],v19,30720
M v[176:179],v[36:39],a[96:99],v[176:179]
s_cbranch_scc1 L_wsr1
L_wrr1:
MF v168,s5,v168
MF v169,s5,v169
M v[176:179],v[40:43],a[104:107],v[176:179]
s_waitcnt lgkmcnt(2)
T a[148:149],v19,40960
T a[150:151],v19,43008
M v[176:179],v[44:47],a[112:115],v[176:179]
SA m0,s28,131072
T a[152:153],v19,45056
T a[154:155],v19,47104
M v[176:179],v[48:51],a[120:123],v[176:179]
buffer_load_dwordx4 v3, s[8:11], s26 offen offset:0 sc1 lds
M v[176:179],v[52:55],a[128:131],v[176:179]
s_nop 0
T a[156:157],v19,49152
T a[158:159],v19,51200
M v[176:179],v[56:59],a[136:139],v[176:179]
T a[160:161],v19,53248
T a[162:163],v19,55296
M v[180:183],v[56:59],a[140:143],v[180:183]
buffer_load_dwordx4 v3, s[8:11], s26 offen offset:1024 sc1 lds
M v[180:183],v[52:55],a[132:135],v[180:183]
s_nop 0
T a[164:165],v19,57344
T a[166:167],v19,59392
M v[180:183],v[48:51],a[124:127],v[180:183]
T a[168:169],v19,61440
T a[170:171],v19,63488
M v[180:183],v[44:47],a[116:119],v[180:183]
buffer_load_dwordx4 v3, s[8:11], s26 offen offset:2048 sc1 lds
M v[180:183],v[40:43],a[108:111],v[180:183]
MF v170,s5,v170
MF v171,s5,v171
M v[180:183],v[36:39],a[100:103],v[180:183]
s_waitcnt lgkmcnt(0)
buffer_load_dwordx4 v3, s[8:11], s26 offen offset:3072 sc1 lds
M v[180:183],v[32:35],a[236:239],v[180:183]
s_barrier
M v[184:187],a[144:147],a[232:235],v[184:187]
SA m0,s28,135168
R a[64:67],v2,32768
R a[68:71],v2,33792
M v[184:187],a[148:151],a[96:99],v[184:187]
buffer_load_dwordx4 v4, s[8:11], s26 offen offset:0 sc1 lds
M v[184:187],a[152:155],a[104:107],v[184:187]
C v160,v160,v161
C v161,v162,v163
M v[184:187],a[156:159],a[112:115],v[184:187]
SA s30,s32,12288
R a[72:75],v2,34816
R a[76:79],v2,35840
M v[184:187],a[160:163],a[120:123],v[184:187]
buffer_store_dwordx4 a[52:55], v6, s[8:11], s30 offen offset:1024 sc1
M v[184:187],a[164:167],a[128:131],v[184:187]
C v162,v168,v169
C v163,v170,v171
M v[184:187],a[168:171],a[136:139],v[184:187]
R a[80:83],v2,36864
R a[84:87],v2,37888
M v[188:191],a[168:171],a[140:143],v[188:191]
buffer_load_dwordx4 v4, s[8:11], s26 offen offset:1024 sc1 lds
M v[188:191],a[164:167],a[132:135],v[188:191]
W a24,v160
W a25,v161
M v[188:191],a[160:163],a[124:127],v[188:191]
R a[88:91],v2,38912
R a[92:95],v2,39936
M v[188:191],a[156:159],a[116:119],v[188:191]
buffer_load_dwordx4 v4, s[8:11], s26 offen offset:2048 sc1 lds
M v[188:191],a[152:155],a[108:111],v[188:191]
W a26,v162
W a27,v163
M v[188:191],a[148:151],a[100:103],v[188:191]
buffer_load_dwordx4 v4, s[8:11], s26 offen offset:3072 sc1 lds
M v[188:191],a[144:147],a[236:239],v[188:191]
s_waitcnt lgkmcnt(0)
SA s30,s32,4096
buffer_store_dwordx4 a[24:27], v6, s[8:11], s30 offen offset:2048 sc1
SA s26,s26,32768
MF v164,s5,v164
MF v165,s5,v165
MF v166,s5,v166
MF v167,s5,v167
MF v172,s5,v172
MF v173,s5,v173
MF v174,s5,v174
MF v175,s5,v175
C v164,v164,v165
C v165,v166,v167
C v166,v172,v173
C v167,v174,v175
W a56,v164
W a57,v165
W a58,v166
W a59,v167
SA s30,s32,12288
buffer_store_dwordx4 a[56:59], v6, s[8:11], s30 offen offset:2048 sc1
v_mov_b32 v30, 2
buffer_store_dword v30, v1, s[8:11], s45 offen sc1
M v[64:67],a[64:67],a[0:3],0
R a[96:99],v2,40960
R a[100:103],v2,41984
M v[64:67],a[68:71],a[4:7],v[64:67]
MF v176,s5,v176
MF v177,s5,v177
M v[64:67],a[72:75],a[8:11],v[64:67]
MF v178,s5,v178
MF v179,s5,v179
M v[64:67],a[76:79],a[12:15],v[64:67]
R a[104:107],v2,43008
R a[108:111],v2,44032
M v[64:67],a[80:83],a[16:19],v[64:67]
MF v184,s5,v184
MF v185,s5,v185
MF v186,s5,v186
MF v187,s5,v187
C v176,v176,v177
C v177,v178,v179
C v178,v184,v185
C v179,v186,v187
W a28,v176
W a29,v177
W a30,v178
W a31,v179
M v[64:67],a[84:87],a[20:23],v[64:67]
MF v180,s5,v180
MF v181,s5,v181
M v[64:67],a[88:91],a[24:27],v[64:67]
R a[112:115],v2,45056
R a[116:119],v2,46080
M v[64:67],a[92:95],a[28:31],v[64:67]
MF v182,s5,v182
MF v183,s5,v183
M v[68:71],a[64:67],a[32:35],0
MF v188,s5,v188
MF v189,s5,v189
M v[68:71],a[68:71],a[36:39],v[68:71]
R a[120:123],v2,47104
R a[124:127],v2,48128
M v[68:71],a[72:75],a[40:43],v[68:71]
SA m0,s28,32768
MF v190,s5,v190
MF v191,s5,v191
M v[68:71],a[76:79],a[44:47],v[68:71]
buffer_load_dwordx4 v3, s[8:11], s26 offen offset:0 sc1 lds
M v[68:71],a[80:83],a[48:51],v[68:71]
C v180,v180,v181
C v181,v182,v183
C v182,v188,v189
C v183,v190,v191
W a60,v180
W a61,v181
W a62,v182
W a63,v183
M v[68:71],a[84:87],a[52:55],v[68:71]
SA s30,s32,4096
buffer_store_dwordx4 a[28:31], v6, s[8:11], s30 offen offset:3072 sc1
M v[68:71],a[88:91],a[56:59],v[68:71]
SA s30,s32,12288
E v18,v64
M v[68:71],a[92:95],a[60:63],v[68:71]
s_waitcnt lgkmcnt(0)
buffer_store_dwordx4 a[60:63], v6, s[8:11], s30 offen offset:3072 sc1
M v[72:75],a[96:99],a[0:3],0
R a[64:67],v2,49152
R a[68:71],v2,50176
M v[72:75],a[100:103],a[4:7],v[72:75]
E v19,v65
M v[72:75],a[104:107],a[8:11],v[72:75]
buffer_load_dwordx4 v3, s[8:11], s26 offen offset:1024 sc1 lds
M v[72:75],a[108:111],a[12:15],v[72:75]
R a[72:75],v2,51200
R a[76:79],v2,52224
M v[72:75],a[112:115],a[16:19],v[72:75]
E v20,v66
M v[72:75],a[116:119],a[20:23],v[72:75]
buffer_load_dwordx4 v3, s[8:11], s26 offen offset:2048 sc1 lds
M v[72:75],a[120:123],a[24:27],v[72:75]
R a[80:83],v2,53248
R a[84:87],v2,54272
M v[72:75],a[124:127],a[28:31],v[72:75]
E v21,v67
M v[76:79],a[124:127],a[60:63],0
buffer_load_dwordx4 v3, s[8:11], s26 offen offset:3072 sc1 lds
M v[76:79],a[120:123],a[56:59],v[76:79]
SA m0,s28,36864
R a[88:91],v2,55296
R a[92:95],v2,56320
M v[76:79],a[116:119],a[52:55],v[76:79]
E v22,v68
M v[76:79],a[112:115],a[48:51],v[76:79]
buffer_load_dwordx4 v4, s[8:11], s26 offen offset:0 sc1 lds
M v[76:79],a[108:111],a[44:47],v[76:79]
E v23,v69
M v[76:79],a[104:107],a[40:43],v[76:79]
AF v26,v18,v19
C v40,v18,v19
M v[76:79],a[100:103],a[36:39],v[76:79]
buffer_load_dwordx4 v4, s[8:11], s26 offen offset:1024 sc1 lds
M v[76:79],a[96:99],a[32:35],v[76:79]
s_waitcnt lgkmcnt(0)
v_add_u32 v16, 0x20000, v7
AF v26,v20,v26
M v[80:83],a[64:67],a[0:3],0
R a[96:99],v2,57344
R a[100:103],v2,58368
M v[80:83],a[68:71],a[4:7],v[80:83]
buffer_load_dwordx4 v4, s[8:11], s26 offen offset:2048 sc1 lds
M v[80:83],a[72:75],a[8:11],v[80:83]
E v24,v70
M v[80:83],a[76:79],a[12:15],v[80:83]
R a[104:107],v2,59392
R a[108:111],v2,60416
M v[80:83],a[80:83],a[16:19],v[80:83]
buffer_load_dwordx4 v4, s[8:11], s26 offen offset:3072 sc1 lds
M v[80:83],a[84:87],a[20:23],v[80:83]
SA s26,s26,32768
E v25,v71
M v[80:83],a[88:91],a[24:27],v[80:83]
R a[112:115],v2,61440
R a[116:119],v2,62464
M v[80:83],a[92:95],a[28:31],v[80:83]
E v18,v72
M v[84:87],a[92:95],a[60:63],0
E v19,v73
M v[84:87],a[88:91],a[56:59],v[84:87]
R a[120:123],v2,63488
R a[124:127],v2,64512
M v[84:87],a[84:87],a[52:55],v[84:87]
C v41,v20,v21
AF v26,v21,v26
M v[84:87],a[80:83],a[48:51],v[84:87]
E v20,v74
M v[84:87],a[76:79],a[44:47],v[84:87]
AF v27,v22,v23
C v44,v22,v23
M v[84:87],a[72:75],a[40:43],v[84:87]
AF v27,v24,v27
C v45,v24,v25
M v[84:87],a[68:71],a[36:39],v[84:87]
s_waitcnt vmcnt(24) lgkmcnt(0)
E v21,v75
M v[84:87],a[64:67],a[32:35],v[84:87]
s_barrier
M v[88:91],a[96:99],a[0:3],0
R a[64:67],v2,0
R a[68:71],v2,1024
M v[88:91],a[100:103],a[4:7],v[88:91]
E v22,v76
M v[88:91],a[104:107],a[8:11],v[88:91]
AF v27,v25,v27
AF v26,v18,v26
M v[88:91],a[108:111],a[12:15],v[88:91]
R a[72:75],v2,2048
R a[76:79],v2,3072
M v[88:91],a[112:115],a[16:19],v[88:91]
E v23,v77
M v[88:91],a[116:119],a[20:23],v[88:91]
C v42,v18,v19
AF v26,v19,v26
M v[88:91],a[120:123],a[24:27],v[88:91]
R a[80:83],v2,4096
R a[84:87],v2,5120
M v[88:91],a[124:127],a[28:31],v[88:91]
E v24,v78
M v[92:95],a[124:127],a[60:63],0
AF v26,v20,v26
C v43,v20,v21
M v[92:95],a[120:123],a[56:59],v[92:95]
R a[88:91],v2,6144
R a[92:95],v2,7168
M v[92:95],a[116:119],a[52:55],v[92:95]
E v25,v79
M v[92:95],a[112:115],a[48:51],v[92:95]
AF v26,v21,v26
AF v27,v22,v27
M v[92:95],a[108:111],a[44:47],v[92:95]
C v46,v22,v23
AF v27,v23,v27
M v[92:95],a[104:107],a[40:43],v[92:95]
AF v27,v24,v27
C v47,v24,v25
M v[92:95],a[100:103],a[36:39],v[92:95]
s_waitcnt lgkmcnt(0)
AF v27,v25,v27
M v[92:95],a[96:99],a[32:35],v[92:95]
M v[96:99],a[64:67],a[0:3],0
R a[96:99],v2,8192
R a[100:103],v2,9216
M v[96:99],a[68:71],a[4:7],v[96:99]
SA m0,s28,98304
W a128,v128
W a129,v129
M v[96:99],a[72:75],a[8:11],v[96:99]
buffer_load_dwordx4 v3, s[8:11], s21 offen offset:0 sc1 lds
M v[96:99],a[76:79],a[12:15],v[96:99]
R a[104:107],v2,10240
R a[108:111],v2,11264
M v[96:99],a[80:83],a[16:19],v[96:99]
W a130,v130
v_mov_b32 v30, 0
M v[96:99],a[84:87],a[20:23],v[96:99]
W a131,v131
M v[96:99],a[88:91],a[24:27],v[96:99]
R a[112:115],v2,12288
R a[116:119],v2,13312
M v[96:99],a[92:95],a[28:31],v[96:99]
buffer_load_dwordx4 v3, s[8:11], s21 offen offset:1024 sc1 lds
M v[100:103],a[92:95],a[60:63],0
W a132,v132
v_mov_b32 v31, 0
M v[100:103],a[88:91],a[56:59],v[100:103]
R a[120:123],v2,14336
R a[124:127],v2,15360
M v[100:103],a[84:87],a[52:55],v[100:103]
W a133,v133
W a134,v134
M v[100:103],a[80:83],a[48:51],v[100:103]
buffer_load_dwordx4 v3, s[8:11], s21 offen offset:2048 sc1 lds
M v[100:103],a[76:79],a[44:47],v[100:103]
W a135,v135
M v[100:103],a[72:75],a[40:43],v[100:103]
v_mov_b32 v32, 0
M v[100:103],a[68:71],a[36:39],v[100:103]
W a136,v136
M v[100:103],a[64:67],a[32:35],v[100:103]
s_waitcnt lgkmcnt(0)
buffer_load_dwordx4 v3, s[8:11], s21 offen offset:3072 sc1 lds
M v[108:111],a[96:99],a[32:35],0
SA m0,s28,102400
R a[64:67],v2,16384
R a[68:71],v2,17408
M v[108:111],a[100:103],a[36:39],v[108:111]
W a137,v137
v_mov_b32 v33, 0
M v[108:111],a[104:107],a[40:43],v[108:111]
W a138,v138
M v[108:111],a[108:111],a[44:47],v[108:111]
R a[72:75],v2,18432
R a[76:79],v2,19456
M v[108:111],a[112:115],a[48:51],v[108:111]
buffer_load_dwordx4 v4, s[8:11], s21 offen offset:0 sc1 lds
M v[108:111],a[116:119],a[52:55],v[108:111]
W a139,v139
W a140,v140
M v[108:111],a[120:123],a[56:59],v[108:111]
R a[80:83],v2,20480
R a[84:87],v2,21504
M v[108:111],a[124:127],a[60:63],v[108:111]
buffer_load_dwordx4 v4, s[8:11], s21 offen offset:1024 sc1 lds
M v[104:107],a[124:127],a[28:31],0
v_mov_b32 v34, 0
W a141,v141
M v[104:107],a[120:123],a[24:27],v[104:107]
R a[88:91],v2,22528
R a[92:95],v2,23552
M v[104:107],a[116:119],a[20:23],v[104:107]
buffer_load_dwordx4 v4, s[8:11], s21 offen offset:2048 sc1 lds
M v[104:107],a[112:115],a[16:19],v[104:107]
W a142,v142
W a143,v143
M v[104:107],a[108:111],a[12:15],v[104:107]
v_mov_b32 v35, 0
W a144,v144
M v[104:107],a[104:107],a[8:11],v[104:107]
W a145,v145
M v[104:107],a[100:103],a[4:7],v[104:107]
buffer_load_dwordx4 v4, s[8:11], s21 offen offset:3072 sc1 lds
M v[104:107],a[96:99],a[0:3],v[104:107]
s_waitcnt lgkmcnt(0)
v_mov_b32 v36, 0
W a146,v146
M v[112:115],a[64:67],a[0:3],0
SA s21,s21,32768
R a[96:99],v2,24576
R a[100:103],v2,25600
M v[112:115],a[68:71],a[4:7],v[112:115]
s_sub_u32 s22, s22, 1
W a147,v147
M v[112:115],a[72:75],a[8:11],v[112:115]
s_cselect_b32 s21, s23, s21
E v18,v80
M v[112:115],a[76:79],a[12:15],v[112:115]
R a[104:107],v2,26624
R a[108:111],v2,27648
M v[112:115],a[80:83],a[16:19],v[112:115]
W a148,v148
v_mov_b32 v37, 0
M v[112:115],a[84:87],a[20:23],v[112:115]
W a149,v149
M v[112:115],a[88:91],a[24:27],v[112:115]
R a[112:115],v2,28672
R a[116:119],v2,29696
M v[112:115],a[92:95],a[28:31],v[112:115]
W a150,v150
M v[116:119],a[92:95],a[60:63],0
v_mov_b32 v38, 0
W a151,v151
M v[116:119],a[88:91],a[56:59],v[116:119]
R a[120:123],v2,30720
R a[124:127],v2,31744
M v[116:119],a[84:87],a[52:55],v[116:119]
W a152,v152
M v[116:119],a[80:83],a[48:51],v[116:119]
W a153,v153
M v[116:119],a[76:79],a[44:47],v[116:119]
E v19,v81
M v[116:119],a[72:75],a[40:43],v[116:119]
v_mov_b32 v39, 0
W a154,v154
M v[116:119],a[68:71],a[36:39],v[116:119]
s_waitcnt vmcnt(21) lgkmcnt(0)
E v20,v82
M v[116:119],a[64:67],a[32:35],v[116:119]
s_barrier
M v[124:127],a[96:99],a[32:35],0
R a[64:67],v16,0
R a[68:71],v16,1024
M v[124:127],a[100:103],a[36:39],v[124:127]
W a155,v155
W a156,v156
M v[124:127],a[104:107],a[40:43],v[124:127]
W a157,v157
AF v26,v18,v26
M v[124:127],a[108:111],a[44:47],v[124:127]
R a[72:75],v16,2048
R a[76:79],v16,3072
M v[124:127],a[112:115],a[48:51],v[124:127]
W a158,v158
C v56,v18,v19
M v[124:127],a[116:119],a[52:55],v[124:127]
E v21,v83
M v[124:127],a[120:123],a[56:59],v[124:127]
R a[80:83],v16,4096
R a[84:87],v16,5120
M v[124:127],a[124:127],a[60:63],v[124:127]
W a159,v159
AF v26,v19,v26
M v[120:123],a[124:127],a[28:31],0
E v22,v88
M v[120:123],a[120:123],a[24:27],v[120:123]
R a[88:91],v16,6144
R a[92:95],v16,7168
M v[120:123],a[116:119],a[20:23],v[120:123]
E v23,v89
M v[120:123],a[112:115],a[16:19],v[120:123]
E v24,v90
M v[120:123],a[108:111],a[12:15],v[120:123]
E v25,v91
M v[120:123],a[104:107],a[8:11],v[120:123]
E v18,v84
M v[120:123],a[100:103],a[4:7],v[120:123]
s_waitcnt lgkmcnt(0)
E v19,v85
M v[120:123],a[96:99],a[0:3],v[120:123]
AF v26,v20,v26
C v57,v20,v21
AF v26,v21,v26
AF v26,v22,v26
C v58,v22,v23
AF v26,v23,v26
AF v26,v24,v26
C v59,v24,v25
AF v26,v25,v26
E v20,v86
E v21,v87
AF v27,v18,v27
C v60,v18,v19
AF v27,v19,v27
E v22,v92
E v23,v93
AF v27,v20,v27
C v61,v20,v21
AF v27,v21,v27
E v24,v94
E v25,v95
AF v27,v22,v27
C v62,v22,v23
AF v27,v23,v27
AF v27,v24,v27
C v63,v24,v25
AF v27,v25,v27
v_max_f32 v10, v26, v27
v_min_f32 v11, v26, v27
v_cmp_lt_f32 vcc, s31, v10
v_cmp_gt_f32 s[64:65], s24, v11
s_nop 0
s_or_b64 vcc, vcc, s[64:65]
s_cbranch_vccnz L_stv1
L_rtv1:
M v[128:131],a[64:67],v[40:43],0
R a[96:99],v16,8192
R a[100:103],v16,9216
M v[128:131],a[68:71],v[56:59],v[128:131]
SA m0,s28,65536
W a160,v192
W a161,v193
M v[132:135],a[68:71],v[60:63],0
buffer_load_dwordx4 v3, s[8:11], s21 offen offset:0 sc1 lds
M v[132:135],a[64:67],v[44:47],v[132:135]
R a[104:107],v16,10240
R a[108:111],v16,11264
M v[140:143],a[72:75],v[44:47],0
W a162,v194
W a163,v195
M v[140:143],a[76:79],v[60:63],v[140:143]
W a164,v196
W a165,v197
M v[136:139],a[76:79],v[56:59],0
R a[112:115],v16,12288
R a[116:119],v16,13312
M v[136:139],a[72:75],v[40:43],v[136:139]
buffer_load_dwordx4 v3, s[8:11], s21 offen offset:1024 sc1 lds
M v[144:147],a[80:83],v[40:43],0
W a166,v198
W a167,v199
M v[144:147],a[84:87],v[56:59],v[144:147]
R a[120:123],v16,14336
R a[124:127],v16,15360
M v[148:151],a[84:87],v[60:63],0
SA s3,s93,262144
W a168,v200
W a169,v201
M v[148:151],a[80:83],v[44:47],v[148:151]
buffer_load_dwordx4 v3, s[8:11], s21 offen offset:2048 sc1 lds
M v[156:159],a[88:91],v[44:47],0
W a170,v202
W a171,v203
M v[156:159],a[92:95],v[60:63],v[156:159]
W a172,v204
W a173,v205
M v[152:155],a[92:95],v[56:59],0
buffer_store_dwordx4 a[128:131], v7, s[8:11], s3 offen offset:0 sc1
M v[152:155],a[88:91],v[40:43],v[152:155]
s_waitcnt lgkmcnt(0)
W a174,v206
W a175,v207
M v[160:163],a[96:99],v[40:43],0
R a[64:67],v16,16384
R a[68:71],v16,17408
M v[160:163],a[100:103],v[56:59],v[160:163]
buffer_load_dwordx4 v3, s[8:11], s21 offen offset:3072 sc1 lds
M v[164:167],a[100:103],v[60:63],0
SA m0,s28,69632
W a176,v208
W a177,v209
M v[164:167],a[96:99],v[44:47],v[164:167]
R a[72:75],v16,18432
R a[76:79],v16,19456
M v[172:175],a[104:107],v[44:47],0
buffer_load_dwordx4 v4, s[8:11], s21 offen offset:0 sc1 lds
M v[172:175],a[108:111],v[60:63],v[172:175]
W a178,v210
W a179,v211
M v[168:171],a[108:111],v[56:59],0
R a[80:83],v16,20480
R a[84:87],v16,21504
M v[168:171],a[104:107],v[40:43],v[168:171]
buffer_load_dwordx4 v4, s[8:11], s21 offen offset:1024 sc1 lds
M v[176:179],a[112:115],v[40:43],0
W a180,v212
W a181,v213
M v[176:179],a[116:119],v[56:59],v[176:179]
R a[88:91],v16,22528
R a[92:95],v16,23552
M v[180:183],a[116:119],v[60:63],0
buffer_load_dwordx4 v4, s[8:11], s21 offen offset:2048 sc1 lds
M v[180:183],a[112:115],v[44:47],v[180:183]
W a182,v214
W a183,v215
M v[188:191],a[120:123],v[44:47],0
W a184,v216
W a185,v217
W a186,v218
W a187,v219
W a188,v220
W a189,v221
W a190,v222
W a191,v223
M v[188:191],a[124:127],v[60:63],v[188:191]
E v18,v96
M v[184:187],a[124:127],v[56:59],0
buffer_load_dwordx4 v4, s[8:11], s21 offen offset:3072 sc1 lds
M v[184:187],a[120:123],v[40:43],v[184:187]
s_waitcnt lgkmcnt(0)
v_min_u32 v17, 1, v7
v_lshlrev_b32 v17, 29, v17
M v[192:195],a[64:67],v[40:43],0
SA s21,s21,32768
R a[96:99],v16,24576
R a[100:103],v16,25600
M v[192:195],a[68:71],v[56:59],v[192:195]
s_sub_u32 s22, s22, 1
buffer_store_dwordx4 a[132:135], v7, s[8:11], s3 offen offset:2048 sc1
M v[196:199],a[68:71],v[60:63],0
s_cselect_b32 s21, s23, s21
v_mov_b32 v15, 1
AF v30,v26,v30
M v[196:199],a[64:67],v[44:47],v[196:199]
SA s84,s47,16
R a[104:107],v16,26624
R a[108:111],v16,27648
M v[204:207],a[72:75],v[44:47],0
E v19,v97
M v[204:207],a[76:79],v[60:63],v[204:207]
E v20,v98
M v[200:203],a[76:79],v[56:59],0
R a[112:115],v16,28672
R a[116:119],v16,29696
M v[200:203],a[72:75],v[40:43],v[200:203]
E v21,v99
M v[208:211],a[80:83],v[40:43],0
E v22,v104
M v[208:211],a[84:87],v[56:59],v[208:211]
R a[120:123],v16,30720
R a[124:127],v16,31744
M v[212:215],a[84:87],v[60:63],0
SA s3,s93,266240
E v23,v105
M v[212:215],a[80:83],v[44:47],v[212:215]
buffer_store_dwordx4 a[136:139], v7, s[8:11], s3 offen offset:0 sc1
M v[220:223],a[88:91],v[44:47],0
AF v31,v27,v31
AF v28,v18,v19
M v[220:223],a[92:95],v[60:63],v[220:223]
E v24,v106
M v[216:219],a[92:95],v[56:59],0
s_waitcnt vmcnt(11) lgkmcnt(0)
E v25,v107
M v[216:219],a[88:91],v[40:43],v[216:219]
s_barrier
M v[224:227],a[96:99],v[40:43],0
R a[64:67],v2,32768
R a[68:71],v2,33792
M v[224:227],a[100:103],v[56:59],v[224:227]
buffer_store_dword v15, v17, s[8:11], s84 offen sc1
M v[228:231],a[100:103],v[60:63],0
C v48,v18,v19
AF v28,v20,v28
M v[228:231],a[96:99],v[44:47],v[228:231]
R a[72:75],v2,34816
R a[76:79],v2,35840
M v[236:239],a[104:107],v[44:47],0
E v18,v100
M v[236:239],a[108:111],v[60:63],v[236:239]
E v19,v101
M v[232:235],a[108:111],v[56:59],0
R a[80:83],v2,36864
R a[84:87],v2,37888
M v[232:235],a[104:107],v[40:43],v[232:235]
C v49,v20,v21
AF v28,v21,v28
M v[240:243],a[112:115],v[40:43],0
E v20,v102
M v[240:243],a[116:119],v[56:59],v[240:243]
R a[88:91],v2,38912
R a[92:95],v2,39936
M v[244:247],a[116:119],v[60:63],0
E v21,v103
M v[244:247],a[112:115],v[44:47],v[244:247]
AF v28,v22,v28
C v50,v22,v23
M v[252:255],a[120:123],v[44:47],0
AF v28,v23,v28
AF v28,v24,v28
M v[252:255],a[124:127],v[60:63],v[252:255]
E v22,v108
M v[248:251],a[124:127],v[56:59],0
s_waitcnt lgkmcnt(0)
E v23,v109
M v[248:251],a[120:123],v[40:43],v[248:251]
C v51,v24,v25
AF v28,v25,v28
AF v29,v18,v19
C v52,v18,v19
AF v29,v20,v29
C v53,v20,v21
AF v29,v21,v29
E v24,v110
E v25,v111
AF v29,v22,v29
C v54,v22,v23
AF v29,v23,v29
AF v29,v24,v29
C v55,v24,v25
AF v29,v25,v29
M v[64:67],a[64:67],a[0:3],v[32:35]
R a[96:99],v2,40960
R a[100:103],v2,41984
M v[64:67],a[68:71],a[4:7],v[64:67]
SA m0,s28,0
E v18,v112
M v[64:67],a[72:75],a[8:11],v[64:67]
buffer_load_dwordx4 v3, s[8:11], s26 offen offset:0 sc1 lds
M v[64:67],a[76:79],a[12:15],v[64:67]
R a[104:107],v2,43008
R a[108:111],v2,44032
M v[64:67],a[80:83],a[16:19],v[64:67]
E v19,v113
M v[64:67],a[84:87],a[20:23],v[64:67]
AF v28,v18,v28
C v56,v18,v19
M v[64:67],a[88:91],a[24:27],v[64:67]
R a[112:115],v2,45056
R a[116:119],v2,46080
M v[64:67],a[92:95],a[28:31],v[64:67]
buffer_load_dwordx4 v3, s[8:11], s26 offen offset:1024 sc1 lds
M v[68:71],a[92:95],a[60:63],v[36:39]
E v20,v114
M v[68:71],a[88:91],a[56:59],v[68:71]
R a[120:123],v2,47104
R a[124:127],v2,48128
M v[68:71],a[84:87],a[52:55],v[68:71]
SA s3,s93,266240
E v21,v115
M v[68:71],a[80:83],a[48:51],v[68:71]
buffer_load_dwordx4 v3, s[8:11], s26 offen offset:2048 sc1 lds
M v[68:71],a[76:79],a[44:47],v[68:71]
AF v28,v19,v28
AF v28,v20,v28
M v[68:71],a[72:75],a[40:43],v[68:71]
C v57,v20,v21
AF v28,v21,v28
M v[68:71],a[68:71],a[36:39],v[68:71]
buffer_store_dwordx4 a[140:143], v7, s[8:11], s3 offen offset:2048 sc1
M v[68:71],a[64:67],a[32:35],v[68:71]
s_waitcnt lgkmcnt(0)
E v22,v120
M v[76:79],a[96:99],a[32:35],v[36:39]
R a[64:67],v2,49152
R a[68:71],v2,50176
M v[76:79],a[100:103],a[36:39],v[76:79]
buffer_load_dwordx4 v3, s[8:11], s26 offen offset:3072 sc1 lds
M v[76:79],a[104:107],a[40:43],v[76:79]
SA m0,s28,4096
E v23,v121
M v[76:79],a[108:111],a[44:47],v[76:79]
R a[72:75],v2,51200
R a[76:79],v2,52224
M v[76:79],a[112:115],a[48:51],v[76:79]
buffer_load_dwordx4 v4, s[8:11], s26 offen offset:0 sc1 lds
M v[76:79],a[116:119],a[52:55],v[76:79]
E v24,v122
M v[76:79],a[120:123],a[56:59],v[76:79]
R a[80:83],v2,53248
R a[84:87],v2,54272
M v[76:79],a[124:127],a[60:63],v[76:79]
buffer_load_dwordx4 v4, s[8:11], s26 offen offset:1024 sc1 lds
M v[72:75],a[124:127],a[28:31],v[32:35]
E v25,v123
M v[72:75],a[120:123],a[24:27],v[72:75]
SA s3,s93,270336
R a[88:91],v2,55296
R a[92:95],v2,56320
M v[72:75],a[116:119],a[20:23],v[72:75]
buffer_load_dwordx4 v4, s[8:11], s26 offen offset:2048 sc1 lds
M v[72:75],a[112:115],a[16:19],v[72:75]
AF v28,v22,v28
C v58,v22,v23
M v[72:75],a[108:111],a[12:15],v[72:75]
E v18,v116
M v[72:75],a[104:107],a[8:11],v[72:75]
AF v28,v23,v28
AF v28,v24,v28
M v[72:75],a[100:103],a[4:7],v[72:75]
buffer_load_dwordx4 v4, s[8:11], s26 offen offset:3072 sc1 lds
M v[72:75],a[96:99],a[0:3],v[72:75]
s_waitcnt lgkmcnt(0)
E v19,v117
M v[80:83],a[64:67],a[0:3],v[32:35]
SA s26,s26,32768
R a[96:99],v2,57344
R a[100:103],v2,58368
M v[80:83],a[68:71],a[4:7],v[80:83]
buffer_store_dwordx4 a[144:147], v7, s[8:11], s3 offen offset:0 sc1
M v[80:83],a[72:75],a[8:11],v[80:83]
C v59,v24,v25
AF v28,v25,v28
M v[80:83],a[76:79],a[12:15],v[80:83]
R a[104:107],v2,59392
R a[108:111],v2,60416
M v[80:83],a[80:83],a[16:19],v[80:83]
E v20,v118
M v[80:83],a[84:87],a[20:23],v[80:83]
AF v29,v18,v29
C v60,v18,v19
M v[80:83],a[88:91],a[24:27],v[80:83]
R a[112:115],v2,61440
R a[116:119],v2,62464
M v[80:83],a[92:95],a[28:31],v[80:83]
E v21,v119
M v[84:87],a[92:95],a[60:63],v[36:39]
AF v29,v19,v29
AF v29,v20,v29
M v[84:87],a[88:91],a[56:59],v[84:87]
R a[120:123],v2,63488
R a[124:127],v2,64512
M v[84:87],a[84:87],a[52:55],v[84:87]
E v22,v124
M v[84:87],a[80:83],a[48:51],v[84:87]
buffer_store_dwordx4 a[148:151], v7, s[8:11], s3 offen offset:2048 sc1
M v[84:87],a[76:79],a[44:47],v[84:87]
C v61,v20,v21
AF v29,v21,v29
M v[84:87],a[72:75],a[40:43],v[84:87]
E v23,v125
M v[84:87],a[68:71],a[36:39],v[84:87]
s_waitcnt lgkmcnt(0)
AF v29,v22,v29
C v62,v22,v23
M v[84:87],a[64:67],a[32:35],v[84:87]
s_barrier
M v[92:95],a[96:99],a[32:35],v[36:39]
R a[64:67],v7,32768
R a[68:71],v7,33792
M v[92:95],a[100:103],a[36:39],v[92:95]
E v24,v126
M v[92:95],a[104:107],a[40:43],v[92:95]
AF v29,v23,v29
M v[92:95],a[108:111],a[44:47],v[92:95]
R a[72:75],v7,34816
R a[76:79],v7,35840
M v[92:95],a[112:115],a[48:51],v[92:95]
E v25,v127
M v[92:95],a[116:119],a[52:55],v[92:95]
AF v29,v24,v29
C v63,v24,v25
M v[92:95],a[120:123],a[56:59],v[92:95]
R a[80:83],v7,36864
R a[84:87],v7,37888
M v[92:95],a[124:127],a[60:63],v[92:95]
AF v29,v25,v29
M v[88:91],a[124:127],a[28:31],v[32:35]
M v[88:91],a[120:123],a[24:27],v[88:91]
R a[88:91],v7,38912
R a[92:95],v7,39936
M v[88:91],a[116:119],a[20:23],v[88:91]
v_max_f32 v10, v28, v29
M v[88:91],a[112:115],a[16:19],v[88:91]
v_cmp_lt_f32 vcc, s31, v10
M v[88:91],a[108:111],a[12:15],v[88:91]
M v[88:91],a[104:107],a[8:11],v[88:91]
M v[88:91],a[100:103],a[4:7],v[88:91]
s_waitcnt lgkmcnt(0)
M v[88:91],a[96:99],a[0:3],v[88:91]
s_cbranch_vccnz L_stv2
L_rtv2:
M v[128:131],a[64:67],v[48:51],v[128:131]
R a[96:99],v7,40960
R a[100:103],v7,41984
M v[128:131],a[68:71],v[56:59],v[128:131]
SA m0,s28,98304
E v18,v64
M v[132:135],a[68:71],v[60:63],v[132:135]
buffer_load_dwordx4 v3, s[8:11], s21 offen offset:0 sc1 lds
M v[132:135],a[64:67],v[52:55],v[132:135]
R a[104:107],v7,43008
R a[108:111],v7,44032
M v[140:143],a[72:75],v[52:55],v[140:143]
E v19,v65
M v[140:143],a[76:79],v[60:63],v[140:143]
AF v30,v28,v30
AF v31,v29,v31
M v[136:139],a[76:79],v[56:59],v[136:139]
R a[112:115],v7,45056
R a[116:119],v7,46080
M v[136:139],a[72:75],v[48:51],v[136:139]
buffer_load_dwordx4 v3, s[8:11], s21 offen offset:1024 sc1 lds
M v[144:147],a[80:83],v[48:51],v[144:147]
E v20,v66
M v[144:147],a[84:87],v[56:59],v[144:147]
R a[120:123],v7,47104
R a[124:127],v7,48128
M v[148:151],a[84:87],v[60:63],v[148:151]
SA s3,s93,274432
AF v26,v18,v19
C v40,v18,v19
M v[148:151],a[80:83],v[52:55],v[148:151]
buffer_load_dwordx4 v3, s[8:11], s21 offen offset:2048 sc1 lds
M v[156:159],a[88:91],v[52:55],v[156:159]
E v21,v67
M v[156:159],a[92:95],v[60:63],v[156:159]
AF v26,v20,v26
C v41,v20,v21
M v[152:155],a[92:95],v[56:59],v[152:155]
buffer_store_dwordx4 a[152:155], v7, s[8:11], s3 offen offset:0 sc1
M v[152:155],a[88:91],v[48:51],v[152:155]
s_waitcnt lgkmcnt(0)
E v22,v72
M v[160:163],a[96:99],v[48:51],v[160:163]
R a[64:67],v7,49152
R a[68:71],v7,50176
M v[160:163],a[100:103],v[56:59],v[160:163]
buffer_load_dwordx4 v3, s[8:11], s21 offen offset:3072 sc1 lds
M v[164:167],a[100:103],v[60:63],v[164:167]
SA m0,s28,102400
E v23,v73
M v[164:167],a[96:99],v[52:55],v[164:167]
R a[72:75],v7,51200
R a[76:79],v7,52224
M v[172:175],a[104:107],v[52:55],v[172:175]
buffer_load_dwordx4 v4, s[8:11], s21 offen offset:0 sc1 lds
M v[172:175],a[108:111],v[60:63],v[172:175]
AF v26,v21,v26
AF v26,v22,v26
M v[168:171],a[108:111],v[56:59],v[168:171]
R a[80:83],v7,53248
R a[84:87],v7,54272
M v[168:171],a[104:107],v[48:51],v[168:171]
buffer_load_dwordx4 v4, s[8:11], s21 offen offset:1024 sc1 lds
M v[176:179],a[112:115],v[48:51],v[176:179]
E v24,v74
M v[176:179],a[116:119],v[56:59],v[176:179]
R a[88:91],v7,55296
R a[92:95],v7,56320
M v[180:183],a[116:119],v[60:63],v[180:183]
buffer_load_dwordx4 v4, s[8:11], s21 offen offset:2048 sc1 lds
M v[180:183],a[112:115],v[52:55],v[180:183]
E v25,v75
M v[188:191],a[120:123],v[52:55],v[188:191]
C v42,v22,v23
AF v26,v23,v26
M v[188:191],a[124:127],v[60:63],v[188:191]
AF v26,v24,v26
C v43,v24,v25
M v[184:187],a[124:127],v[56:59],v[184:187]
buffer_load_dwordx4 v4, s[8:11], s21 offen offset:3072 sc1 lds
M v[184:187],a[120:123],v[48:51],v[184:187]
s_waitcnt lgkmcnt(0)
E v18,v68
M v[192:195],a[64:67],v[48:51],v[192:195]
SA s21,s21,32768
R a[96:99],v7,57344
R a[100:103],v7,58368
M v[192:195],a[68:71],v[56:59],v[192:195]
s_sub_u32 s22, s22, 1
buffer_store_dwordx4 a[156:159], v7, s[8:11], s3 offen offset:2048 sc1
M v[196:199],a[68:71],v[60:63],v[196:199]
s_cselect_b32 s21, s23, s21
E v19,v69
M v[196:199],a[64:67],v[52:55],v[196:199]
R a[104:107],v7,59392
R a[108:111],v7,60416
M v[204:207],a[72:75],v[52:55],v[204:207]
AF v26,v25,v26
AF v27,v18,v19
M v[204:207],a[76:79],v[60:63],v[204:207]
E v20,v70
M v[200:203],a[76:79],v[56:59],v[200:203]
R a[112:115],v7,61440
R a[116:119],v7,62464
M v[200:203],a[72:75],v[48:51],v[200:203]
C v44,v18,v19
M v[208:211],a[80:83],v[48:51],v[208:211]
M v[208:211],a[84:87],v[56:59],v[208:211]
R a[120:123],v7,63488
R a[124:127],v7,64512
M v[212:215],a[84:87],v[60:63],v[212:215]
SA s3,s93,786432
E v21,v71
M v[212:215],a[80:83],v[52:55],v[212:215]
buffer_store_dwordx4 a[160:163], v7, s[8:11], s3 offen offset:0 sc1
M v[220:223],a[88:91],v[52:55],v[220:223]
AF v27,v20,v27
C v45,v20,v21
M v[220:223],a[92:95],v[60:63],v[220:223]
E v22,v76
M v[216:219],a[92:95],v[56:59],v[216:219]
s_waitcnt vmcnt(25) lgkmcnt(0)
AF v27,v21,v27
M v[216:219],a[88:91],v[48:51],v[216:219]
s_barrier
M v[224:227],a[96:99],v[48:51],v[224:227]
R a[64:67],v2,0
R a[68:71],v2,1024
M v[224:227],a[100:103],v[56:59],v[224:227]
E v23,v77
M v[228:231],a[100:103],v[60:63],v[228:231]
AF v27,v22,v27
C v46,v22,v23
M v[228:231],a[96:99],v[52:55],v[228:231]
R a[72:75],v2,2048
R a[76:79],v2,3072
M v[236:239],a[104:107],v[52:55],v[236:239]
E v24,v78
M v[236:239],a[108:111],v[60:63],v[236:239]
AF v27,v23,v27
M v[232:235],a[108:111],v[56:59],v[232:235]
R a[80:83],v2,4096
R a[84:87],v2,5120
M v[232:235],a[104:107],v[48:51],v[232:235]
M v[240:243],a[112:115],v[48:51],v[240:243]
E v25,v79
M v[240:243],a[116:119],v[56:59],v[240:243]
R a[88:91],v2,6144
R a[92:95],v2,7168
M v[244:247],a[116:119],v[60:63],v[244:247]
AF v27,v24,v27
C v47,v24,v25
M v[244:247],a[112:115],v[52:55],v[244:247]
AF v27,v25,v27
M v[252:255],a[120:123],v[52:55],v[252:255]
M v[252:255],a[124:127],v[60:63],v[252:255]
M v[248:251],a[124:127],v[56:59],v[248:251]
s_waitcnt lgkmcnt(0)
M v[248:251],a[120:123],v[48:51],v[248:251]
M v[96:99],a[64:67],a[0:3],v[32:35]
R a[96:99],v2,8192
R a[100:103],v2,9216
M v[96:99],a[68:71],a[4:7],v[96:99]
SA m0,s28,32768
E v18,v80
M v[96:99],a[72:75],a[8:11],v[96:99]
buffer_load_dwordx4 v3, s[8:11], s26 offen offset:0 sc1 lds
M v[96:99],a[76:79],a[12:15],v[96:99]
R a[104:107],v2,10240
R a[108:111],v2,11264
M v[96:99],a[80:83],a[16:19],v[96:99]
E v19,v81
M v[96:99],a[84:87],a[20:23],v[96:99]
AF v26,v18,v26
C v56,v18,v19
M v[96:99],a[88:91],a[24:27],v[96:99]
R a[112:115],v2,12288
R a[116:119],v2,13312
M v[96:99],a[92:95],a[28:31],v[96:99]
buffer_load_dwordx4 v3, s[8:11], s26 offen offset:1024 sc1 lds
M v[100:103],a[92:95],a[60:63],v[36:39]
E v20,v82
M v[100:103],a[88:91],a[56:59],v[100:103]
R a[120:123],v2,14336
R a[124:127],v2,15360
M v[100:103],a[84:87],a[52:55],v[100:103]
SA s3,s93,786432
E v21,v83
M v[100:103],a[80:83],a[48:51],v[100:103]
buffer_load_dwordx4 v3, s[8:11], s26 offen offset:2048 sc1 lds
M v[100:103],a[76:79],a[44:47],v[100:103]
AF v26,v19,v26
AF v26,v20,v26
M v[100:103],a[72:75],a[40:43],v[100:103]
C v57,v20,v21
AF v26,v21,v26
M v[100:103],a[68:71],a[36:39],v[100:103]
buffer_store_dwordx4 a[164:167], v7, s[8:11], s3 offen offset:2048 sc1
M v[100:103],a[64:67],a[32:35],v[100:103]
s_waitcnt lgkmcnt(0)
E v22,v88
M v[108:111],a[96:99],a[32:35],v[36:39]
R a[64:67],v2,16384
R a[68:71],v2,17408
M v[108:111],a[100:103],a[36:39],v[108:111]
buffer_load_dwordx4 v3, s[8:11], s26 offen offset:3072 sc1 lds
M v[108:111],a[104:107],a[40:43],v[108:111]
SA m0,s28,36864
E v23,v89
M v[108:111],a[108:111],a[44:47],v[108:111]
R a[72:75],v2,18432
R a[76:79],v2,19456
M v[108:111],a[112:115],a[48:51],v[108:111]
buffer_load_dwordx4 v4, s[8:11], s26 offen offset:0 sc1 lds
M v[108:111],a[116:119],a[52:55],v[108:111]
SA s3,s93,790528
E v24,v90
M v[108:111],a[120:123],a[56:59],v[108:111]
R a[80:83],v2,20480
R a[84:87],v2,21504
M v[108:111],a[124:127],a[60:63],v[108:111]
buffer_load_dwordx4 v4, s[8:11], s26 offen offset:1024 sc1 lds
M v[104:107],a[124:127],a[28:31],v[32:35]
E v25,v91
M v[104:107],a[120:123],a[24:27],v[104:107]
R a[88:91],v2,22528
R a[92:95],v2,23552
M v[104:107],a[116:119],a[20:23],v[104:107]
buffer_load_dwordx4 v4, s[8:11], s26 offen offset:2048 sc1 lds
M v[104:107],a[112:115],a[16:19],v[104:107]
AF v26,v22,v26
C v58,v22,v23
M v[104:107],a[108:111],a[12:15],v[104:107]
E v18,v84
M v[104:107],a[104:107],a[8:11],v[104:107]
buffer_store_dwordx4 a[168:171], v7, s[8:11], s3 offen offset:0 sc1
M v[104:107],a[100:103],a[4:7],v[104:107]
AF v26,v23,v26
AF v26,v24,v26
M v[104:107],a[96:99],a[0:3],v[104:107]
s_waitcnt lgkmcnt(0)
E v19,v85
M v[112:115],a[64:67],a[0:3],v[32:35]
R a[96:99],v2,24576
R a[100:103],v2,25600
M v[112:115],a[68:71],a[4:7],v[112:115]
buffer_load_dwordx4 v4, s[8:11], s26 offen offset:3072 sc1 lds
M v[112:115],a[72:75],a[8:11],v[112:115]
SA s26,s26,32768
C v59,v24,v25
AF v26,v25,v26
M v[112:115],a[76:79],a[12:15],v[112:115]
R a[104:107],v2,26624
R a[108:111],v2,27648
M v[112:115],a[80:83],a[16:19],v[112:115]
E v20,v86
M v[112:115],a[84:87],a[20:23],v[112:115]
buffer_store_dwordx4 a[172:175], v7, s[8:11], s3 offen offset:2048 sc1
M v[112:115],a[88:91],a[24:27],v[112:115]
R a[112:115],v2,28672
R a[116:119],v2,29696
M v[112:115],a[92:95],a[28:31],v[112:115]
E v21,v87
M v[116:119],a[92:95],a[60:63],v[36:39]
AF v27,v18,v27
C v60,v18,v19
M v[116:119],a[88:91],a[56:59],v[116:119]
R a[120:123],v2,30720
R a[124:127],v2,31744
M v[116:119],a[84:87],a[52:55],v[116:119]
E v22,v92
M v[116:119],a[80:83],a[48:51],v[116:119]
AF v27,v19,v27
AF v27,v20,v27
M v[116:119],a[76:79],a[44:47],v[116:119]
C v61,v20,v21
AF v27,v21,v27
M v[116:119],a[72:75],a[40:43],v[116:119]
E v23,v93
M v[116:119],a[68:71],a[36:39],v[116:119]
s_waitcnt vmcnt(24) lgkmcnt(0)
AF v27,v22,v27
C v62,v22,v23
M v[116:119],a[64:67],a[32:35],v[116:119]
s_barrier
M v[124:127],a[96:99],a[32:35],v[36:39]
SA s3,s93,794624
R a[64:67],v7,0
R a[68:71],v7,1024
M v[124:127],a[100:103],a[36:39],v[124:127]
buffer_store_dwordx4 a[176:179], v7, s[8:11], s3 offen offset:0 sc1
M v[124:127],a[104:107],a[40:43],v[124:127]
E v24,v94
M v[124:127],a[108:111],a[44:47],v[124:127]
R a[72:75],v7,2048
R a[76:79],v7,3072
M v[124:127],a[112:115],a[48:51],v[124:127]
E v25,v95
M v[124:127],a[116:119],a[52:55],v[124:127]
AF v27,v23,v27
AF v27,v24,v27
M v[124:127],a[120:123],a[56:59],v[124:127]
R a[80:83],v7,4096
R a[84:87],v7,5120
M v[124:127],a[124:127],a[60:63],v[124:127]
C v63,v24,v25
AF v27,v25,v27
M v[120:123],a[124:127],a[28:31],v[32:35]
M v[120:123],a[120:123],a[24:27],v[120:123]
R a[88:91],v7,6144
R a[92:95],v7,7168
M v[120:123],a[116:119],a[20:23],v[120:123]
v_max_f32 v10, v26, v27
M v[120:123],a[112:115],a[16:19],v[120:123]
v_cmp_lt_f32 vcc, s31, v10
M v[120:123],a[108:111],a[12:15],v[120:123]
M v[120:123],a[104:107],a[8:11],v[120:123]
M v[120:123],a[100:103],a[4:7],v[120:123]
s_waitcnt lgkmcnt(0)
M v[120:123],a[96:99],a[0:3],v[120:123]
s_cbranch_vccnz L_stv3
L_rtv3:
M v[128:131],a[64:67],v[40:43],v[128:131]
R a[96:99],v7,8192
R a[100:103],v7,9216
M v[128:131],a[68:71],v[56:59],v[128:131]
SA m0,s28,65536
E v18,v96
M v[132:135],a[68:71],v[60:63],v[132:135]
buffer_load_dwordx4 v3, s[8:11], s21 offen offset:0 sc1 lds
M v[132:135],a[64:67],v[44:47],v[132:135]
R a[104:107],v7,10240
R a[108:111],v7,11264
M v[140:143],a[72:75],v[44:47],v[140:143]
E v19,v97
M v[140:143],a[76:79],v[60:63],v[140:143]
AF v30,v26,v30
AF v31,v27,v31
M v[136:139],a[76:79],v[56:59],v[136:139]
R a[112:115],v7,12288
R a[116:119],v7,13312
M v[136:139],a[72:75],v[40:43],v[136:139]
buffer_load_dwordx4 v3, s[8:11], s21 offen offset:1024 sc1 lds
M v[144:147],a[80:83],v[40:43],v[144:147]
E v20,v98
M v[144:147],a[84:87],v[56:59],v[144:147]
R a[120:123],v7,14336
R a[124:127],v7,15360
M v[148:151],a[84:87],v[60:63],v[148:151]
SA s3,s93,794624
AF v28,v18,v19
C v48,v18,v19
M v[148:151],a[80:83],v[44:47],v[148:151]
buffer_load_dwordx4 v3, s[8:11], s21 offen offset:2048 sc1 lds
M v[156:159],a[88:91],v[44:47],v[156:159]
E v21,v99
M v[156:159],a[92:95],v[60:63],v[156:159]
AF v28,v20,v28
C v49,v20,v21
M v[152:155],a[92:95],v[56:59],v[152:155]
buffer_store_dwordx4 a[180:183], v7, s[8:11], s3 offen offset:2048 sc1
M v[152:155],a[88:91],v[40:43],v[152:155]
s_waitcnt lgkmcnt(0)
E v22,v104
M v[160:163],a[96:99],v[40:43],v[160:163]
R a[64:67],v7,16384
R a[68:71],v7,17408
M v[160:163],a[100:103],v[56:59],v[160:163]
buffer_load_dwordx4 v3, s[8:11], s21 offen offset:3072 sc1 lds
M v[164:167],a[100:103],v[60:63],v[164:167]
SA m0,s28,69632
E v23,v105
M v[164:167],a[96:99],v[44:47],v[164:167]
R a[72:75],v7,18432
R a[76:79],v7,19456
M v[172:175],a[104:107],v[44:47],v[172:175]
buffer_load_dwordx4 v4, s[8:11], s21 offen offset:0 sc1 lds
M v[172:175],a[108:111],v[60:63],v[172:175]
AF v28,v21,v28
AF v28,v22,v28
M v[168:171],a[108:111],v[56:59],v[168:171]
R a[80:83],v7,20480
R a[84:87],v7,21504
M v[168:171],a[104:107],v[40:43],v[168:171]
buffer_load_dwordx4 v4, s[8:11], s21 offen offset:1024 sc1 lds
M v[176:179],a[112:115],v[40:43],v[176:179]
E v24,v106
M v[176:179],a[116:119],v[56:59],v[176:179]
SA s3,s93,798720
R a[88:91],v7,22528
R a[92:95],v7,23552
M v[180:183],a[116:119],v[60:63],v[180:183]
buffer_load_dwordx4 v4, s[8:11], s21 offen offset:2048 sc1 lds
M v[180:183],a[112:115],v[44:47],v[180:183]
E v25,v107
M v[188:191],a[120:123],v[44:47],v[188:191]
C v50,v22,v23
AF v28,v23,v28
M v[188:191],a[124:127],v[60:63],v[188:191]
AF v28,v24,v28
C v51,v24,v25
M v[184:187],a[124:127],v[56:59],v[184:187]
buffer_load_dwordx4 v4, s[8:11], s21 offen offset:3072 sc1 lds
M v[184:187],a[120:123],v[40:43],v[184:187]
s_waitcnt lgkmcnt(0)
E v18,v100
M v[192:195],a[64:67],v[40:43],v[192:195]
SA s21,s21,32768
R a[96:99],v7,24576
R a[100:103],v7,25600
M v[192:195],a[68:71],v[56:59],v[192:195]
s_sub_u32 s22, s22, 1
buffer_store_dwordx4 a[184:187], v7, s[8:11], s3 offen offset:0 sc1
M v[196:199],a[68:71],v[60:63],v[196:199]
s_cselect_b32 s21, s23, s21
E v19,v101
M v[196:199],a[64:67],v[44:47],v[196:199]
R a[104:107],v7,26624
R a[108:111],v7,27648
M v[204:207],a[72:75],v[44:47],v[204:207]
AF v28,v25,v28
AF v29,v18,v19
M v[204:207],a[76:79],v[60:63],v[204:207]
E v20,v102
M v[200:203],a[76:79],v[56:59],v[200:203]
R a[112:115],v7,28672
R a[116:119],v7,29696
M v[200:203],a[72:75],v[40:43],v[200:203]
C v52,v18,v19
M v[208:211],a[80:83],v[40:43],v[208:211]
M v[208:211],a[84:87],v[56:59],v[208:211]
R a[120:123],v7,30720
R a[124:127],v7,31744
M v[212:215],a[84:87],v[60:63],v[212:215]
E v21,v103
M v[212:215],a[80:83],v[44:47],v[212:215]
buffer_store_dwordx4 a[188:191], v7, s[8:11], s3 offen offset:2048 sc1
M v[220:223],a[88:91],v[44:47],v[220:223]
AF v29,v20,v29
C v53,v20,v21
M v[220:223],a[92:95],v[60:63],v[220:223]
E v22,v108
M v[216:219],a[92:95],v[56:59],v[216:219]
s_waitcnt vmcnt(25) lgkmcnt(0)
AF v29,v21,v29
M v[216:219],a[88:91],v[40:43],v[216:219]
s_barrier
M v[224:227],a[96:99],v[40:43],v[224:227]
R a[64:67],v2,32768
R a[68:71],v2,33792
M v[224:227],a[100:103],v[56:59],v[224:227]
E v23,v109
M v[228:231],a[100:103],v[60:63],v[228:231]
AF v29,v22,v29
C v54,v22,v23
M v[228:231],a[96:99],v[44:47],v[228:231]
R a[72:75],v2,34816
R a[76:79],v2,35840
M v[236:239],a[104:107],v[44:47],v[236:239]
E v24,v110
M v[236:239],a[108:111],v[60:63],v[236:239]
AF v29,v23,v29
M v[232:235],a[108:111],v[56:59],v[232:235]
R a[80:83],v2,36864
R a[84:87],v2,37888
M v[232:235],a[104:107],v[40:43],v[232:235]
M v[240:243],a[112:115],v[40:43],v[240:243]
E v25,v111
M v[240:243],a[116:119],v[56:59],v[240:243]
R a[88:91],v2,38912
R a[92:95],v2,39936
M v[244:247],a[116:119],v[60:63],v[244:247]
AF v29,v24,v29
C v55,v24,v25
M v[244:247],a[112:115],v[44:47],v[244:247]
AF v29,v25,v29
M v[252:255],a[120:123],v[44:47],v[252:255]
M v[252:255],a[124:127],v[60:63],v[252:255]
M v[248:251],a[124:127],v[56:59],v[248:251]
s_waitcnt lgkmcnt(0)
M v[248:251],a[120:123],v[40:43],v[248:251]
s_branch L_loop_top
L_st0:
s_call_b64 s[36:37], L_slow0
s_branch L_rt0
L_st1:
s_call_b64 s[36:37], L_slow1
s_branch L_rt1
L_stv1:
s_call_b64 s[36:37], L_slowf
s_branch L_rtv1
L_stk1:
s_call_b64 s[36:37], L_slowf
s_branch L_rtk1
L_sth1:
s_call_b64 s[36:37], L_slowf
s_branch L_rth1
L_stj0:
s_call_b64 s[36:37], L_slowj
s_branch L_rtj0
L_stv2:
s_call_b64 s[36:37], L_slow1
s_branch L_rtv2
L_stv3:
s_call_b64 s[36:37], L_slow0
s_branch L_rtv3
L_std1:
s_call_b64 s[36:37], L_slow1
s_branch L_rtd1
L_std3n:
s_call_b64 s[36:37], L_slow0
s_branch L_rtd3n
L_std3h:
s_call_b64 s[36:37], L_slow0
s_branch L_rtd3h
L_std4n:
s_call_b64 s[36:37], L_slowb
s_branch L_rtd4n
L_std4h:
s_call_b64 s[36:37], L_slowb
s_branch L_rtd4h
L_stfh:
s_call_b64 s[36:37], L_slow1n
s_branch L_rtfh
L_stc:
s_call_b64 s[36:37], L_comb
s_branch L_rtc
L_slow0:
s_nop 7
s_nop 3
v_max3_f32 v10, v64, v65, v66
v_max3_f32 v10, v67, v72, v10
v_max3_f32 v10, v73, v74, v10
v_max3_f32 v10, v75, v80, v10
v_max3_f32 v10, v81, v82, v10
v_max3_f32 v10, v83, v88, v10
v_max3_f32 v10, v89, v90, v10
v_max_f32 v10, v91, v10
v_max3_f32 v11, v68, v69, v70
v_max3_f32 v11, v71, v76, v11
v_max3_f32 v11, v77, v78, v11
v_max3_f32 v11, v79, v84, v11
v_max3_f32 v11, v85, v86, v11
v_max3_f32 v11, v87, v92, v11
v_max3_f32 v11, v93, v94, v11
v_max_f32 v11, v95, v11
v_mov_b32 v12, v10
v_mov_b32 v13, v11
s_nop 0
v_permlane16_swap_b32 v12, v10
v_permlane16_swap_b32 v13, v11
v_max_f32 v10, v12, v10
v_max_f32 v11, v13, v11
v_mov_b32 v12, v10
v_mov_b32 v13, v11
s_nop 0
v_permlane32_swap_b32 v12, v10
v_permlane32_swap_b32 v13, v11
v_max_f32 v10, v12, v10
v_max_f32 v11, v13, v11
v_ceil_f32 v10, v10
v_ceil_f32 v11, v11
v_max_f32 v10, 0, v10
v_max_f32 v11, 0, v11
v_sub_f32 v64, v64, v10
v_sub_f32 v65, v65, v10
v_sub_f32 v66, v66, v10
v_sub_f32 v67, v67, v10
v_sub_f32 v68, v68, v11
v_sub_f32 v69, v69, v11
v_sub_f32 v70, v70, v11
v_sub_f32 v71, v71, v11
v_sub_f32 v72, v72, v10
v_sub_f32 v73, v73, v10
v_sub_f32 v74, v74, v10
v_sub_f32 v75, v75, v10
v_sub_f32 v76, v76, v11
v_sub_f32 v77, v77, v11
v_sub_f32 v78, v78, v11
v_sub_f32 v79, v79, v11
v_sub_f32 v80, v80, v10
v_sub_f32 v81, v81, v10
v_sub_f32 v82, v82, v10
v_sub_f32 v83, v83, v10
v_sub_f32 v84, v84, v11
v_sub_f32 v85, v85, v11
v_sub_f32 v86, v86, v11
v_sub_f32 v87, v87, v11
v_sub_f32 v88, v88, v10
v_sub_f32 v89, v89, v10
v_sub_f32 v90, v90, v10
v_sub_f32 v91, v91, v10
v_sub_f32 v92, v92, v11
v_sub_f32 v93, v93, v11
v_sub_f32 v94, v94, v11
v_sub_f32 v95, v95, v11
v_sub_f32 v96, v96, v10
v_sub_f32 v97, v97, v10
v_sub_f32 v98, v98, v10
v_sub_f32 v99, v99, v10
v_sub_f32 v100, v100, v11
v_sub_f32 v101, v101, v11
v_sub_f32 v102, v102, v11
v_sub_f32 v103, v103, v11
v_sub_f32 v104, v104, v10
v_sub_f32 v105, v105, v10
v_sub_f32 v106, v106, v10
v_sub_f32 v107, v107, v10
v_sub_f32 v108, v108, v11
v_sub_f32 v109, v109, v11
v_sub_f32 v110, v110, v11
v_sub_f32 v111, v111, v11
v_sub_f32 v112, v112, v10
v_sub_f32 v113, v113, v10
v_sub_f32 v114, v114, v10
v_sub_f32 v115, v115, v10
v_sub_f32 v116, v116, v11
v_sub_f32 v117, v117, v11
v_sub_f32 v118, v118, v11
v_sub_f32 v119, v119, v11
v_sub_f32 v120, v120, v10
v_sub_f32 v121, v121, v10
v_sub_f32 v122, v122, v10
v_sub_f32 v123, v123, v10
v_sub_f32 v124, v124, v11
v_sub_f32 v125, v125, v11
v_sub_f32 v126, v126, v11
v_sub_f32 v127, v127, v11
v_sub_f32 v32, v32, v10
v_sub_f32 v33, v33, v10
v_sub_f32 v34, v34, v10
v_sub_f32 v35, v35, v10
v_sub_f32 v36, v36, v11
v_sub_f32 v37, v37, v11
v_sub_f32 v38, v38, v11
v_sub_f32 v39, v39, v11
E v12,-v10
E v13,-v11
MF v30,v12,v30
MF v31,v13,v31
MF v128,v12,v128
MF v129,v12,v129
MF v130,v12,v130
MF v131,v12,v131
MF v132,v13,v132
MF v133,v13,v133
MF v134,v13,v134
MF v135,v13,v135
MF v136,v12,v136
MF v137,v12,v137
MF v138,v12,v138
MF v139,v12,v139
MF v140,v13,v140
MF v141,v13,v141
MF v142,v13,v142
MF v143,v13,v143
MF v144,v12,v144
MF v145,v12,v145
MF v146,v12,v146
MF v147,v12,v147
MF v148,v13,v148
MF v149,v13,v149
MF v150,v13,v150
MF v151,v13,v151
MF v152,v12,v152
MF v153,v12,v153
MF v154,v12,v154
MF v155,v12,v155
MF v156,v13,v156
MF v157,v13,v157
MF v158,v13,v158
MF v159,v13,v159
MF v160,v12,v160
MF v161,v12,v161
MF v162,v12,v162
MF v163,v12,v163
MF v164,v13,v164
MF v165,v13,v165
MF v166,v13,v166
MF v167,v13,v167
MF v168,v12,v168
MF v169,v12,v169
MF v170,v12,v170
MF v171,v12,v171
MF v172,v13,v172
MF v173,v13,v173
MF v174,v13,v174
MF v175,v13,v175
MF v176,v12,v176
MF v177,v12,v177
MF v178,v12,v178
MF v179,v12,v179
MF v180,v13,v180
MF v181,v13,v181
MF v182,v13,v182
MF v183,v13,v183
MF v184,v12,v184
MF v185,v12,v185
MF v186,v12,v186
MF v187,v12,v187
MF v188,v13,v188
MF v189,v13,v189
MF v190,v13,v190
MF v191,v13,v191
MF v192,v12,v192
MF v193,v12,v193
MF v194,v12,v194
MF v195,v12,v195
MF v196,v13,v196
MF v197,v13,v197
MF v198,v13,v198
MF v199,v13,v199
MF v200,v12,v200
MF v201,v12,v201
MF v202,v12,v202
MF v203,v12,v203
MF v204,v13,v204
MF v205,v13,v205
MF v206,v13,v206
MF v207,v13,v207
MF v208,v12,v208
MF v209,v12,v209
MF v210,v12,v210
MF v211,v12,v211
MF v212,v13,v212
MF v213,v13,v213
MF v214,v13,v214
MF v215,v13,v215
MF v216,v12,v216
MF v217,v12,v217
MF v218,v12,v218
MF v219,v12,v219
MF v220,v13,v220
MF v221,v13,v221
MF v222,v13,v222
MF v223,v13,v223
MF v224,v12,v224
MF v225,v12,v225
MF v226,v12,v226
MF v227,v12,v227
MF v228,v13,v228
MF v229,v13,v229
MF v230,v13,v230
MF v231,v13,v231
MF v232,v12,v232
MF v233,v12,v233
MF v234,v12,v234
MF v235,v12,v235
MF v236,v13,v236
MF v237,v13,v237
MF v238,v13,v238
MF v239,v13,v239
MF v240,v12,v240
MF v241,v12,v241
MF v242,v12,v242
MF v243,v12,v243
MF v244,v13,v244
MF v245,v13,v245
MF v246,v13,v246
MF v247,v13,v247
MF v248,v12,v248
MF v249,v12,v249
MF v250,v12,v250
MF v251,v12,v251
MF v252,v13,v252
MF v253,v13,v253
MF v254,v13,v254
MF v255,v13,v255
E v18,v64
E v19,v65
E v20,v66
AF v26,v18,v19
C v40,v18,v19
E v21,v67
E v22,v72
AF v26,v20,v26
C v41,v20,v21
E v23,v73
AF v26,v21,v26
E v24,v74
AF v26,v22,v26
C v42,v22,v23
E v25,v75
AF v26,v23,v26
E v18,v68
AF v26,v24,v26
C v43,v24,v25
E v19,v69
AF v26,v25,v26
E v20,v70
AF v27,v18,v19
C v44,v18,v19
E v21,v71
E v22,v76
AF v27,v20,v27
C v45,v20,v21
E v23,v77
AF v27,v21,v27
E v24,v78
AF v27,v22,v27
C v46,v22,v23
E v25,v79
AF v27,v23,v27
AF v27,v24,v27
C v47,v24,v25
AF v27,v25,v27
E v18,v80
E v19,v81
E v20,v82
AF v26,v18,v26
C v56,v18,v19
E v21,v83
AF v26,v19,v26
E v22,v88
AF v26,v20,v26
C v57,v20,v21
E v23,v89
AF v26,v21,v26
E v24,v90
AF v26,v22,v26
C v58,v22,v23
E v25,v91
AF v26,v23,v26
E v18,v84
AF v26,v24,v26
C v59,v24,v25
E v19,v85
AF v26,v25,v26
E v20,v86
AF v27,v18,v27
C v60,v18,v19
E v21,v87
AF v27,v19,v27
E v22,v92
AF v27,v20,v27
C v61,v20,v21
E v23,v93
AF v27,v21,v27
E v24,v94
AF v27,v22,v27
C v62,v22,v23
E v25,v95
AF v27,v23,v27
AF v27,v24,v27
C v63,v24,v25
AF v27,v25,v27
s_nop 3
s_setpc_b64 s[36:37]
L_slow1:
s_nop 7
s_nop 3
v_max3_f32 v10, v96, v97, v98
v_max3_f32 v10, v99, v104, v10
v_max3_f32 v10, v105, v106, v10
v_max3_f32 v10, v107, v112, v10
v_max3_f32 v10, v113, v114, v10
v_max3_f32 v10, v115, v120, v10
v_max3_f32 v10, v121, v122, v10
v_max_f32 v10, v123, v10
v_max3_f32 v11, v100, v101, v102
v_max3_f32 v11, v103, v108, v11
v_max3_f32 v11, v109, v110, v11
v_max3_f32 v11, v111, v116, v11
v_max3_f32 v11, v117, v118, v11
v_max3_f32 v11, v119, v124, v11
v_max3_f32 v11, v125, v126, v11
v_max_f32 v11, v127, v11
v_mov_b32 v12, v10
v_mov_b32 v13, v11
s_nop 0
v_permlane16_swap_b32 v12, v10
v_permlane16_swap_b32 v13, v11
v_max_f32 v10, v12, v10
v_max_f32 v11, v13, v11
v_mov_b32 v12, v10
v_mov_b32 v13, v11
s_nop 0
v_permlane32_swap_b32 v12, v10
v_permlane32_swap_b32 v13, v11
v_max_f32 v10, v12, v10
v_max_f32 v11, v13, v11
v_ceil_f32 v10, v10
v_ceil_f32 v11, v11
v_max_f32 v10, 0, v10
v_max_f32 v11, 0, v11
v_sub_f32 v96, v96, v10
v_sub_f32 v97, v97, v10
v_sub_f32 v98, v98, v10
v_sub_f32 v99, v99, v10
v_sub_f32 v100, v100, v11
v_sub_f32 v101, v101, v11
v_sub_f32 v102, v102, v11
v_sub_f32 v103, v103, v11
v_sub_f32 v104, v104, v10
v_sub_f32 v105, v105, v10
v_sub_f32 v106, v106, v10
v_sub_f32 v107, v107, v10
v_sub_f32 v108, v108, v11
v_sub_f32 v109, v109, v11
v_sub_f32 v110, v110, v11
v_sub_f32 v111, v111, v11
v_sub_f32 v112, v112, v10
v_sub_f32 v113, v113, v10
v_sub_f32 v114, v114, v10
v_sub_f32 v115, v115, v10
v_sub_f32 v116, v116, v11
v_sub_f32 v117, v117, v11
v_sub_f32 v118, v118, v11
v_sub_f32 v119, v119, v11
v_sub_f32 v120, v120, v10
v_sub_f32 v121, v121, v10
v_sub_f32 v122, v122, v10
v_sub_f32 v123, v123, v10
v_sub_f32 v124, v124, v11
v_sub_f32 v125, v125, v11
v_sub_f32 v126, v126, v11
v_sub_f32 v127, v127, v11
v_sub_f32 v64, v64, v10
v_sub_f32 v65, v65, v10
v_sub_f32 v66, v66, v10
v_sub_f32 v67, v67, v10
v_sub_f32 v68, v68, v11
v_sub_f32 v69, v69, v11
v_sub_f32 v70, v70, v11
v_sub_f32 v71, v71, v11
v_sub_f32 v72, v72, v10
v_sub_f32 v73, v73, v10
v_sub_f32 v74, v74, v10
v_sub_f32 v75, v75, v10
v_sub_f32 v76, v76, v11
v_sub_f32 v77, v77, v11
v_sub_f32 v78, v78, v11
v_sub_f32 v79, v79, v11
v_sub_f32 v80, v80, v10
v_sub_f32 v81, v81, v10
v_sub_f32 v82, v82, v10
v_sub_f32 v83, v83, v10
v_sub_f32 v84, v84, v11
v_sub_f32 v85, v85, v11
v_sub_f32 v86, v86, v11
v_sub_f32 v87, v87, v11
v_sub_f32 v88, v88, v10
v_sub_f32 v89, v89, v10
v_sub_f32 v90, v90, v10
v_sub_f32 v91, v91, v10
v_sub_f32 v92, v92, v11
v_sub_f32 v93, v93, v11
v_sub_f32 v94, v94, v11
v_sub_f32 v95, v95, v11
v_sub_f32 v32, v32, v10
v_sub_f32 v33, v33, v10
v_sub_f32 v34, v34, v10
v_sub_f32 v35, v35, v10
v_sub_f32 v36, v36, v11
v_sub_f32 v37, v37, v11
v_sub_f32 v38, v38, v11
v_sub_f32 v39, v39, v11
E v12,-v10
E v13,-v11
MF v30,v12,v30
MF v31,v13,v31
MF v128,v12,v128
MF v129,v12,v129
MF v130,v12,v130
MF v131,v12,v131
MF v132,v13,v132
MF v133,v13,v133
MF v134,v13,v134
MF v135,v13,v135
MF v136,v12,v136
MF v137,v12,v137
MF v138,v12,v138
MF v139,v12,v139
MF v140,v13,v140
MF v141,v13,v141
MF v142,v13,v142
MF v143,v13,v143
MF v144,v12,v144
MF v145,v12,v145
MF v146,v12,v146
MF v147,v12,v147
MF v148,v13,v148
MF v149,v13,v149
MF v150,v13,v150
MF v151,v13,v151
MF v152,v12,v152
MF v153,v12,v153
MF v154,v12,v154
MF v155,v12,v155
MF v156,v13,v156
MF v157,v13,v157
MF v158,v13,v158
MF v159,v13,v159
MF v160,v12,v160
MF v161,v12,v161
MF v162,v12,v162
MF v163,v12,v163
MF v164,v13,v164
MF v165,v13,v165
MF v166,v13,v166
MF v167,v13,v167
MF v168,v12,v168
MF v169,v12,v169
MF v170,v12,v170
MF v171,v12,v171
MF v172,v13,v172
MF v173,v13,v173
MF v174,v13,v174
MF v175,v13,v175
MF v176,v12,v176
MF v177,v12,v177
MF v178,v12,v178
MF v179,v12,v179
MF v180,v13,v180
MF v181,v13,v181
MF v182,v13,v182
MF v183,v13,v183
MF v184,v12,v184
MF v185,v12,v185
MF v186,v12,v186
MF v187,v12,v187
MF v188,v13,v188
MF v189,v13,v189
MF v190,v13,v190
MF v191,v13,v191
MF v192,v12,v192
MF v193,v12,v193
MF v194,v12,v194
MF v195,v12,v195
MF v196,v13,v196
MF v197,v13,v197
MF v198,v13,v198
MF v199,v13,v199
MF v200,v12,v200
MF v201,v12,v201
MF v202,v12,v202
MF v203,v12,v203
MF v204,v13,v204
MF v205,v13,v205
MF v206,v13,v206
MF v207,v13,v207
MF v208,v12,v208
MF v209,v12,v209
MF v210,v12,v210
MF v211,v12,v211
MF v212,v13,v212
MF v213,v13,v213
MF v214,v13,v214
MF v215,v13,v215
MF v216,v12,v216
MF v217,v12,v217
MF v218,v12,v218
MF v219,v12,v219
MF v220,v13,v220
MF v221,v13,v221
MF v222,v13,v222
MF v223,v13,v223
MF v224,v12,v224
MF v225,v12,v225
MF v226,v12,v226
MF v227,v12,v227
MF v228,v13,v228
MF v229,v13,v229
MF v230,v13,v230
MF v231,v13,v231
MF v232,v12,v232
MF v233,v12,v233
MF v234,v12,v234
MF v235,v12,v235
MF v236,v13,v236
MF v237,v13,v237
MF v238,v13,v238
MF v239,v13,v239
MF v240,v12,v240
MF v241,v12,v241
MF v242,v12,v242
MF v243,v12,v243
MF v244,v13,v244
MF v245,v13,v245
MF v246,v13,v246
MF v247,v13,v247
MF v248,v12,v248
MF v249,v12,v249
MF v250,v12,v250
MF v251,v12,v251
MF v252,v13,v252
MF v253,v13,v253
MF v254,v13,v254
MF v255,v13,v255
E v18,v96
E v19,v97
E v20,v98
AF v28,v18,v19
C v48,v18,v19
E v21,v99
E v22,v104
AF v28,v20,v28
C v49,v20,v21
E v23,v105
AF v28,v21,v28
E v24,v106
AF v28,v22,v28
C v50,v22,v23
E v25,v107
AF v28,v23,v28
E v18,v100
AF v28,v24,v28
C v51,v24,v25
E v19,v101
AF v28,v25,v28
E v20,v102
AF v29,v18,v19
C v52,v18,v19
E v21,v103
E v22,v108
AF v29,v20,v29
C v53,v20,v21
E v23,v109
AF v29,v21,v29
E v24,v110
AF v29,v22,v29
C v54,v22,v23
E v25,v111
AF v29,v23,v29
AF v29,v24,v29
C v55,v24,v25
AF v29,v25,v29
E v18,v112
E v19,v113
E v20,v114
AF v28,v18,v28
C v56,v18,v19
E v21,v115
AF v28,v19,v28
E v22,v120
AF v28,v20,v28
C v57,v20,v21
E v23,v121
AF v28,v21,v28
E v24,v122
AF v28,v22,v28
C v58,v22,v23
E v25,v123
AF v28,v23,v28
E v18,v116
AF v28,v24,v28
C v59,v24,v25
E v19,v117
AF v28,v25,v28
E v20,v118
AF v29,v18,v29
C v60,v18,v19
E v21,v119
AF v29,v19,v29
E v22,v124
AF v29,v20,v29
C v61,v20,v21
E v23,v125
AF v29,v21,v29
E v24,v126
AF v29,v22,v29
C v62,v22,v23
E v25,v127
AF v29,v23,v29
AF v29,v24,v29
C v63,v24,v25
AF v29,v25,v29
s_nop 3
s_setpc_b64 s[36:37]
L_slow1n:
s_nop 7
s_nop 3
v_max3_f32 v10, v96, v97, v98
v_max3_f32 v10, v99, v104, v10
v_max3_f32 v10, v105, v106, v10
v_max3_f32 v10, v107, v112, v10
v_max3_f32 v10, v113, v114, v10
v_max3_f32 v10, v115, v120, v10
v_max3_f32 v10, v121, v122, v10
v_max_f32 v10, v123, v10
v_max3_f32 v11, v100, v101, v102
v_max3_f32 v11, v103, v108, v11
v_max3_f32 v11, v109, v110, v11
v_max3_f32 v11, v111, v116, v11
v_max3_f32 v11, v117, v118, v11
v_max3_f32 v11, v119, v124, v11
v_max3_f32 v11, v125, v126, v11
v_max_f32 v11, v127, v11
v_mov_b32 v12, v10
v_mov_b32 v13, v11
s_nop 0
v_permlane16_swap_b32 v12, v10
v_permlane16_swap_b32 v13, v11
v_max_f32 v10, v12, v10
v_max_f32 v11, v13, v11
v_mov_b32 v12, v10
v_mov_b32 v13, v11
s_nop 0
v_permlane32_swap_b32 v12, v10
v_permlane32_swap_b32 v13, v11
v_max_f32 v10, v12, v10
v_max_f32 v11, v13, v11
v_ceil_f32 v10, v10
v_ceil_f32 v11, v11
v_max_f32 v10, 0, v10
v_max_f32 v11, 0, v11
v_sub_f32 v96, v96, v10
v_sub_f32 v97, v97, v10
v_sub_f32 v98, v98, v10
v_sub_f32 v99, v99, v10
v_sub_f32 v100, v100, v11
v_sub_f32 v101, v101, v11
v_sub_f32 v102, v102, v11
v_sub_f32 v103, v103, v11
v_sub_f32 v104, v104, v10
v_sub_f32 v105, v105, v10
v_sub_f32 v106, v106, v10
v_sub_f32 v107, v107, v10
v_sub_f32 v108, v108, v11
v_sub_f32 v109, v109, v11
v_sub_f32 v110, v110, v11
v_sub_f32 v111, v111, v11
v_sub_f32 v112, v112, v10
v_sub_f32 v113, v113, v10
v_sub_f32 v114, v114, v10
v_sub_f32 v115, v115, v10
v_sub_f32 v116, v116, v11
v_sub_f32 v117, v117, v11
v_sub_f32 v118, v118, v11
v_sub_f32 v119, v119, v11
v_sub_f32 v120, v120, v10
v_sub_f32 v121, v121, v10
v_sub_f32 v122, v122, v10
v_sub_f32 v123, v123, v10
v_sub_f32 v124, v124, v11
v_sub_f32 v125, v125, v11
v_sub_f32 v126, v126, v11
v_sub_f32 v127, v127, v11
v_sub_f32 v32, v32, v10
v_sub_f32 v33, v33, v10
v_sub_f32 v34, v34, v10
v_sub_f32 v35, v35, v10
v_sub_f32 v36, v36, v11
v_sub_f32 v37, v37, v11
v_sub_f32 v38, v38, v11
v_sub_f32 v39, v39, v11
E v12,-v10
E v13,-v11
MF v30,v12,v30
MF v31,v13,v31
MF v128,v12,v128
MF v129,v12,v129
MF v130,v12,v130
MF v131,v12,v131
MF v132,v13,v132
MF v133,v13,v133
MF v134,v13,v134
MF v135,v13,v135
MF v136,v12,v136
MF v137,v12,v137
MF v138,v12,v138
MF v139,v12,v139
MF v140,v13,v140
MF v141,v13,v141
MF v142,v13,v142
MF v143,v13,v143
MF v144,v12,v144
MF v145,v12,v145
MF v146,v12,v146
MF v147,v12,v147
MF v148,v13,v148
MF v149,v13,v149
MF v150,v13,v150
MF v151,v13,v151
MF v152,v12,v152
MF v153,v12,v153
MF v154,v12,v154
MF v155,v12,v155
MF v156,v13,v156
MF v157,v13,v157
MF v158,v13,v158
MF v159,v13,v159
MF v160,v12,v160
MF v161,v12,v161
MF v162,v12,v162
MF v163,v12,v163
MF v164,v13,v164
MF v165,v13,v165
MF v166,v13,v166
MF v167,v13,v167
MF v168,v12,v168
MF v169,v12,v169
MF v170,v12,v170
MF v171,v12,v171
MF v172,v13,v172
MF v173,v13,v173
MF v174,v13,v174
MF v175,v13,v175
MF v176,v12,v176
MF v177,v12,v177
MF v178,v12,v178
MF v179,v12,v179
MF v180,v13,v180
MF v181,v13,v181
MF v182,v13,v182
MF v183,v13,v183
MF v184,v12,v184
MF v185,v12,v185
MF v186,v12,v186
MF v187,v12,v187
MF v188,v13,v188
MF v189,v13,v189
MF v190,v13,v190
MF v191,v13,v191
MF v192,v12,v192
MF v193,v12,v193
MF v194,v12,v194
MF v195,v12,v195
MF v196,v13,v196
MF v197,v13,v197
MF v198,v13,v198
MF v199,v13,v199
MF v200,v12,v200
MF v201,v12,v201
MF v202,v12,v202
MF v203,v12,v203
MF v204,v13,v204
MF v205,v13,v205
MF v206,v13,v206
MF v207,v13,v207
MF v208,v12,v208
MF v209,v12,v209
MF v210,v12,v210
MF v211,v12,v211
MF v212,v13,v212
MF v213,v13,v213
MF v214,v13,v214
MF v215,v13,v215
MF v216,v12,v216
MF v217,v12,v217
MF v218,v12,v218
MF v219,v12,v219
MF v220,v13,v220
MF v221,v13,v221
MF v222,v13,v222
MF v223,v13,v223
MF v224,v12,v224
MF v225,v12,v225
MF v226,v12,v226
MF v227,v12,v227
MF v228,v13,v228
MF v229,v13,v229
MF v230,v13,v230
MF v231,v13,v231
MF v232,v12,v232
MF v233,v12,v233
MF v234,v12,v234
MF v235,v12,v235
MF v236,v13,v236
MF v237,v13,v237
MF v238,v13,v238
MF v239,v13,v239
MF v240,v12,v240
MF v241,v12,v241
MF v242,v12,v242
MF v243,v12,v243
MF v244,v13,v244
MF v245,v13,v245
MF v246,v13,v246
MF v247,v13,v247
MF v248,v12,v248
MF v249,v12,v249
MF v250,v12,v250
MF v251,v12,v251
MF v252,v13,v252
MF v253,v13,v253
MF v254,v13,v254
MF v255,v13,v255
E v18,v96
E v19,v97
E v20,v98
AF v28,v18,v19
C v48,v18,v19
E v21,v99
E v22,v104
AF v28,v20,v28
C v49,v20,v21
E v23,v105
AF v28,v21,v28
E v24,v106
AF v28,v22,v28
C v50,v22,v23
E v25,v107
AF v28,v23,v28
E v18,v100
AF v28,v24,v28
C v51,v24,v25
E v19,v101
AF v28,v25,v28
E v20,v102
AF v29,v18,v19
C v52,v18,v19
E v21,v103
E v22,v108
AF v29,v20,v29
C v53,v20,v21
E v23,v109
AF v29,v21,v29
E v24,v110
AF v29,v22,v29
C v54,v22,v23
E v25,v111
AF v29,v23,v29
AF v29,v24,v29
C v55,v24,v25
AF v29,v25,v29
E v18,v112
E v19,v113
E v20,v114
AF v28,v18,v28
C v56,v18,v19
E v21,v115
AF v28,v19,v28
E v22,v120
AF v28,v20,v28
C v57,v20,v21
E v23,v121
AF v28,v21,v28
E v24,v122
AF v28,v22,v28
C v58,v22,v23
E v25,v123
AF v28,v23,v28
E v18,v116
AF v28,v24,v28
C v59,v24,v25
E v19,v117
AF v28,v25,v28
E v20,v118
AF v29,v18,v29
C v60,v18,v19
E v21,v119
AF v29,v19,v29
E v22,v124
AF v29,v20,v29
C v61,v20,v21
E v23,v125
AF v29,v21,v29
E v24,v126
AF v29,v22,v29
C v62,v22,v23
E v25,v127
AF v29,v23,v29
AF v29,v24,v29
C v63,v24,v25
AF v29,v25,v29
s_nop 3
s_setpc_b64 s[36:37]
L_slowf:
s_nop 7
s_nop 3
v_max3_f32 v10, v64, v65, v66
v_max3_f32 v10, v67, v72, v10
v_max3_f32 v10, v73, v74, v10
v_max3_f32 v10, v75, v80, v10
v_max3_f32 v10, v81, v82, v10
v_max3_f32 v10, v83, v88, v10
v_max3_f32 v10, v89, v90, v10
v_max_f32 v10, v91, v10
v_max3_f32 v11, v68, v69, v70
v_max3_f32 v11, v71, v76, v11
v_max3_f32 v11, v77, v78, v11
v_max3_f32 v11, v79, v84, v11
v_max3_f32 v11, v85, v86, v11
v_max3_f32 v11, v87, v92, v11
v_max3_f32 v11, v93, v94, v11
v_max_f32 v11, v95, v11
v_mov_b32 v12, v10
v_mov_b32 v13, v11
s_nop 0
v_permlane16_swap_b32 v12, v10
v_permlane16_swap_b32 v13, v11
v_max_f32 v10, v12, v10
v_max_f32 v11, v13, v11
v_mov_b32 v12, v10
v_mov_b32 v13, v11
s_nop 0
v_permlane32_swap_b32 v12, v10
v_permlane32_swap_b32 v13, v11
v_max_f32 v10, v12, v10
v_max_f32 v11, v13, v11
v_ceil_f32 v10, v10
v_ceil_f32 v11, v11
v_sub_f32 v64, v64, v10
v_sub_f32 v65, v65, v10
v_sub_f32 v66, v66, v10
v_sub_f32 v67, v67, v10
v_sub_f32 v68, v68, v11
v_sub_f32 v69, v69, v11
v_sub_f32 v70, v70, v11
v_sub_f32 v71, v71, v11
v_sub_f32 v72, v72, v10
v_sub_f32 v73, v73, v10
v_sub_f32 v74, v74, v10
v_sub_f32 v75, v75, v10
v_sub_f32 v76, v76, v11
v_sub_f32 v77, v77, v11
v_sub_f32 v78, v78, v11
v_sub_f32 v79, v79, v11
v_sub_f32 v80, v80, v10
v_sub_f32 v81, v81, v10
v_sub_f32 v82, v82, v10
v_sub_f32 v83, v83, v10
v_sub_f32 v84, v84, v11
v_sub_f32 v85, v85, v11
v_sub_f32 v86, v86, v11
v_sub_f32 v87, v87, v11
v_sub_f32 v88, v88, v10
v_sub_f32 v89, v89, v10
v_sub_f32 v90, v90, v10
v_sub_f32 v91, v91, v10
v_sub_f32 v92, v92, v11
v_sub_f32 v93, v93, v11
v_sub_f32 v94, v94, v11
v_sub_f32 v95, v95, v11
v_sub_f32 v96, v96, v10
v_sub_f32 v97, v97, v10
v_sub_f32 v98, v98, v10
v_sub_f32 v99, v99, v10
v_sub_f32 v100, v100, v11
v_sub_f32 v101, v101, v11
v_sub_f32 v102, v102, v11
v_sub_f32 v103, v103, v11
v_sub_f32 v104, v104, v10
v_sub_f32 v105, v105, v10
v_sub_f32 v106, v106, v10
v_sub_f32 v107, v107, v10
v_sub_f32 v108, v108, v11
v_sub_f32 v109, v109, v11
v_sub_f32 v110, v110, v11
v_sub_f32 v111, v111, v11
v_sub_f32 v112, v112, v10
v_sub_f32 v113, v113, v10
v_sub_f32 v114, v114, v10
v_sub_f32 v115, v115, v10
v_sub_f32 v116, v116, v11
v_sub_f32 v117, v117, v11
v_sub_f32 v118, v118, v11
v_sub_f32 v119, v119, v11
v_sub_f32 v120, v120, v10
v_sub_f32 v121, v121, v10
v_sub_f32 v122, v122, v10
v_sub_f32 v123, v123, v10
v_sub_f32 v124, v124, v11
v_sub_f32 v125, v125, v11
v_sub_f32 v126, v126, v11
v_sub_f32 v127, v127, v11
v_sub_f32 v32, v32, v10
v_sub_f32 v33, v33, v10
v_sub_f32 v34, v34, v10
v_sub_f32 v35, v35, v10
v_sub_f32 v36, v36, v11
v_sub_f32 v37, v37, v11
v_sub_f32 v38, v38, v11
v_sub_f32 v39, v39, v11
E v18,v64
E v19,v65
E v20,v66
AF v26,v18,v19
C v40,v18,v19
E v21,v67
E v22,v72
AF v26,v20,v26
C v41,v20,v21
E v23,v73
AF v26,v21,v26
E v24,v74
AF v26,v22,v26
C v42,v22,v23
E v25,v75
AF v26,v23,v26
E v18,v68
AF v26,v24,v26
C v43,v24,v25
E v19,v69
AF v26,v25,v26
E v20,v70
AF v27,v18,v19
C v44,v18,v19
E v21,v71
E v22,v76
AF v27,v20,v27
C v45,v20,v21
E v23,v77
AF v27,v21,v27
E v24,v78
AF v27,v22,v27
C v46,v22,v23
E v25,v79
AF v27,v23,v27
AF v27,v24,v27
C v47,v24,v25
AF v27,v25,v27
E v18,v80
E v19,v81
E v20,v82
AF v26,v18,v26
C v56,v18,v19
E v21,v83
AF v26,v19,v26
E v22,v88
AF v26,v20,v26
C v57,v20,v21
E v23,v89
AF v26,v21,v26
E v24,v90
AF v26,v22,v26
C v58,v22,v23
E v25,v91
AF v26,v23,v26
E v18,v84
AF v26,v24,v26
C v59,v24,v25
E v19,v85
AF v26,v25,v26
E v20,v86
AF v27,v18,v27
C v60,v18,v19
E v21,v87
AF v27,v19,v27
E v22,v92
AF v27,v20,v27
C v61,v20,v21
E v23,v93
AF v27,v21,v27
E v24,v94
AF v27,v22,v27
C v62,v22,v23
E v25,v95
AF v27,v23,v27
AF v27,v24,v27
C v63,v24,v25
AF v27,v25,v27
s_nop 3
s_setpc_b64 s[36:37]
L_slowj:
s_nop 7
s_nop 3
v_max3_f32 v10, v64, v65, v66
v_max3_f32 v10, v67, v72, v10
v_max3_f32 v10, v73, v74, v10
v_max3_f32 v10, v75, v80, v10
v_max3_f32 v10, v81, v82, v10
v_max3_f32 v10, v83, v88, v10
v_max3_f32 v10, v89, v90, v10
v_max_f32 v10, v91, v10
v_max3_f32 v11, v68, v69, v70
v_max3_f32 v11, v71, v76, v11
v_max3_f32 v11, v77, v78, v11
v_max3_f32 v11, v79, v84, v11
v_max3_f32 v11, v85, v86, v11
v_max3_f32 v11, v87, v92, v11
v_max3_f32 v11, v93, v94, v11
v_max_f32 v11, v95, v11
v_mov_b32 v12, v10
v_mov_b32 v13, v11
s_nop 0
v_permlane16_swap_b32 v12, v10
v_permlane16_swap_b32 v13, v11
v_max_f32 v10, v12, v10
v_max_f32 v11, v13, v11
v_mov_b32 v12, v10
v_mov_b32 v13, v11
s_nop 0
v_permlane32_swap_b32 v12, v10
v_permlane32_swap_b32 v13, v11
v_max_f32 v10, v12, v10
v_max_f32 v11, v13, v11
v_ceil_f32 v10, v10
v_ceil_f32 v11, v11
v_sub_f32 v64, v64, v10
v_sub_f32 v65, v65, v10
v_sub_f32 v66, v66, v10
v_sub_f32 v67, v67, v10
v_sub_f32 v68, v68, v11
v_sub_f32 v69, v69, v11
v_sub_f32 v70, v70, v11
v_sub_f32 v71, v71, v11
v_sub_f32 v72, v72, v10
v_sub_f32 v73, v73, v10
v_sub_f32 v74, v74, v10
v_sub_f32 v75, v75, v10
v_sub_f32 v76, v76, v11
v_sub_f32 v77, v77, v11
v_sub_f32 v78, v78, v11
v_sub_f32 v79, v79, v11
v_sub_f32 v80, v80, v10
v_sub_f32 v81, v81, v10
v_sub_f32 v82, v82, v10
v_sub_f32 v83, v83, v10
v_sub_f32 v84, v84, v11
v_sub_f32 v85, v85, v11
v_sub_f32 v86, v86, v11
v_sub_f32 v87, v87, v11
v_sub_f32 v88, v88, v10
v_sub_f32 v89, v89, v10
v_sub_f32 v90, v90, v10
v_sub_f32 v91, v91, v10
v_sub_f32 v92, v92, v11
v_sub_f32 v93, v93, v11
v_sub_f32 v94, v94, v11
v_sub_f32 v95, v95, v11
v_sub_f32 v32, v32, v10
v_sub_f32 v33, v33, v10
v_sub_f32 v34, v34, v10
v_sub_f32 v35, v35, v10
v_sub_f32 v36, v36, v11
v_sub_f32 v37, v37, v11
v_sub_f32 v38, v38, v11
v_sub_f32 v39, v39, v11
E v18,v64
E v19,v65
E v20,v66
AF v26,v18,v19
C v40,v18,v19
E v21,v67
E v22,v72
AF v26,v20,v26
C v41,v20,v21
E v23,v73
AF v26,v21,v26
E v24,v74
AF v26,v22,v26
C v42,v22,v23
E v25,v75
AF v26,v23,v26
E v18,v68
AF v26,v24,v26
C v43,v24,v25
E v19,v69
AF v26,v25,v26
E v20,v70
AF v27,v18,v19
C v44,v18,v19
E v21,v71
E v22,v76
AF v27,v20,v27
C v45,v20,v21
E v23,v77
AF v27,v21,v27
E v24,v78
AF v27,v22,v27
C v46,v22,v23
E v25,v79
AF v27,v23,v27
AF v27,v24,v27
C v47,v24,v25
AF v27,v25,v27
s_nop 3
s_setpc_b64 s[36:37]
L_slowb:
s_nop 7
s_nop 3
v_max3_f32 v11, v100, v101, v102
v_max3_f32 v11, v103, v108, v11
v_max3_f32 v11, v109, v110, v11
v_max3_f32 v11, v111, v116, v11
v_max3_f32 v11, v117, v118, v11
v_max3_f32 v11, v119, v124, v11
v_max3_f32 v11, v125, v126, v11
v_max_f32 v11, v127, v11
v_mov_b32 v13, v11
s_nop 1
v_permlane16_swap_b32 v13, v11
v_max_f32 v11, v13, v11
v_mov_b32 v13, v11
s_nop 1
v_permlane32_swap_b32 v13, v11
v_max_f32 v11, v13, v11
v_ceil_f32 v11, v11
v_max_f32 v11, 0, v11
v_mov_b32 v10, 0
v_sub_f32 v100, v100, v11
v_sub_f32 v101, v101, v11
v_sub_f32 v102, v102, v11
v_sub_f32 v103, v103, v11
v_sub_f32 v108, v108, v11
v_sub_f32 v109, v109, v11
v_sub_f32 v110, v110, v11
v_sub_f32 v111, v111, v11
v_sub_f32 v116, v116, v11
v_sub_f32 v117, v117, v11
v_sub_f32 v118, v118, v11
v_sub_f32 v119, v119, v11
v_sub_f32 v124, v124, v11
v_sub_f32 v125, v125, v11
v_sub_f32 v126, v126, v11
v_sub_f32 v127, v127, v11
v_sub_f32 v32, v32, v10
v_sub_f32 v33, v33, v10
v_sub_f32 v34, v34, v10
v_sub_f32 v35, v35, v10
v_sub_f32 v36, v36, v11
v_sub_f32 v37, v37, v11
v_sub_f32 v38, v38, v11
v_sub_f32 v39, v39, v11
E v12,-v10
E v13,-v11
MF v30,v12,v30
MF v31,v13,v31
MF v128,v12,v128
MF v129,v12,v129
MF v130,v12,v130
MF v131,v12,v131
MF v132,v13,v132
MF v133,v13,v133
MF v134,v13,v134
MF v135,v13,v135
MF v136,v12,v136
MF v137,v12,v137
MF v138,v12,v138
MF v139,v12,v139
MF v140,v13,v140
MF v141,v13,v141
MF v142,v13,v142
MF v143,v13,v143
MF v144,v12,v144
MF v145,v12,v145
MF v146,v12,v146
MF v147,v12,v147
MF v148,v13,v148
MF v149,v13,v149
MF v150,v13,v150
MF v151,v13,v151
MF v152,v12,v152
MF v153,v12,v153
MF v154,v12,v154
MF v155,v12,v155
MF v156,v13,v156
MF v157,v13,v157
MF v158,v13,v158
MF v159,v13,v159
MF v160,v12,v160
MF v161,v12,v161
MF v162,v12,v162
MF v163,v12,v163
MF v164,v13,v164
MF v165,v13,v165
MF v166,v13,v166
MF v167,v13,v167
MF v168,v12,v168
MF v169,v12,v169
MF v170,v12,v170
MF v171,v12,v171
MF v172,v13,v172
MF v173,v13,v173
MF v174,v13,v174
MF v175,v13,v175
MF v176,v12,v176
MF v177,v12,v177
MF v178,v12,v178
MF v179,v12,v179
MF v180,v13,v180
MF v181,v13,v181
MF v182,v13,v182
MF v183,v13,v183
MF v184,v12,v184
MF v185,v12,v185
MF v186,v12,v186
MF v187,v12,v187
MF v188,v13,v188
MF v189,v13,v189
MF v190,v13,v190
MF v191,v13,v191
MF v192,v12,v192
MF v193,v12,v193
MF v194,v12,v194
MF v195,v12,v195
MF v196,v13,v196
MF v197,v13,v197
MF v198,v13,v198
MF v199,v13,v199
MF v200,v12,v200
MF v201,v12,v201
MF v202,v12,v202
MF v203,v12,v203
MF v204,v13,v204
MF v205,v13,v205
MF v206,v13,v206
MF v207,v13,v207
MF v208,v12,v208
MF v209,v12,v209
MF v210,v12,v210
MF v211,v12,v211
MF v212,v13,v212
MF v213,v13,v213
MF v214,v13,v214
MF v215,v13,v215
MF v216,v12,v216
MF v217,v12,v217
MF v218,v12,v218
MF v219,v12,v219
MF v220,v13,v220
MF v221,v13,v221
MF v222,v13,v222
MF v223,v13,v223
MF v224,v12,v224
MF v225,v12,v225
MF v226,v12,v226
MF v227,v12,v227
MF v228,v13,v228
MF v229,v13,v229
MF v230,v13,v230
MF v231,v13,v231
MF v232,v12,v232
MF v233,v12,v233
MF v234,v12,v234
MF v235,v12,v235
MF v236,v13,v236
MF v237,v13,v237
MF v238,v13,v238
MF v239,v13,v239
MF v240,v12,v240
MF v241,v12,v241
MF v242,v12,v242
MF v243,v12,v243
MF v244,v13,v244
MF v245,v13,v245
MF v246,v13,v246
MF v247,v13,v247
MF v248,v12,v248
MF v249,v12,v249
MF v250,v12,v250
MF v251,v12,v251
MF v252,v13,v252
MF v253,v13,v253
MF v254,v13,v254
MF v255,v13,v255
E v18,v100
E v19,v101
E v20,v102
AF v29,v18,v19
C v52,v18,v19
E v21,v103
E v22,v108
AF v29,v20,v29
C v53,v20,v21
E v23,v109
AF v29,v21,v29
E v24,v110
AF v29,v22,v29
C v54,v22,v23
E v25,v111
AF v29,v23,v29
E v18,v116
AF v29,v24,v29
C v55,v24,v25
E v19,v117
AF v29,v25,v29
E v20,v118
AF v29,v18,v29
C v48,v18,v19
E v21,v119
AF v29,v19,v29
E v22,v124
AF v29,v20,v29
C v49,v20,v21
E v23,v125
AF v29,v21,v29
E v24,v126
AF v29,v22,v29
C v50,v22,v23
E v25,v127
AF v29,v23,v29
AF v29,v24,v29
C v51,v24,v25
AF v29,v25,v29
s_nop 3
s_setpc_b64 s[36:37]
L_comb:
s_waitcnt vmcnt(0)
s_nop 7
v_sub_f32 v10, v32, v14
v_sub_f32 v11, v36, v15
v_max_f32 v10, 0, v10
v_max_f32 v11, 0, v11
v_sub_f32 v100, v100, v11
v_sub_f32 v101, v101, v11
v_sub_f32 v102, v102, v11
v_sub_f32 v103, v103, v11
v_sub_f32 v108, v108, v11
v_sub_f32 v109, v109, v11
v_sub_f32 v110, v110, v11
v_sub_f32 v111, v111, v11
v_sub_f32 v116, v116, v11
v_sub_f32 v117, v117, v11
v_sub_f32 v118, v118, v11
v_sub_f32 v119, v119, v11
v_sub_f32 v124, v124, v11
v_sub_f32 v125, v125, v11
v_sub_f32 v126, v126, v11
v_sub_f32 v127, v127, v11
v_sub_f32 v32, v32, v10
v_sub_f32 v33, v33, v10
v_sub_f32 v34, v34, v10
v_sub_f32 v35, v35, v10
v_sub_f32 v36, v36, v11
v_sub_f32 v37, v37, v11
v_sub_f32 v38, v38, v11
v_sub_f32 v39, v39, v11
E v12,-v10
E v13,-v11
MF v30,v12,v30
MF v31,v13,v31
MF v128,v12,v128
MF v129,v12,v129
MF v130,v12,v130
MF v131,v12,v131
MF v132,v13,v132
MF v133,v13,v133
MF v134,v13,v134
MF v135,v13,v135
MF v136,v12,v136
MF v137,v12,v137
MF v138,v12,v138
MF v139,v12,v139
MF v140,v13,v140
MF v141,v13,v141
MF v142,v13,v142
MF v143,v13,v143
MF v144,v12,v144
MF v145,v12,v145
MF v146,v12,v146
MF v147,v12,v147
MF v148,v13,v148
MF v149,v13,v149
MF v150,v13,v150
MF v151,v13,v151
MF v152,v12,v152
MF v153,v12,v153
MF v154,v12,v154
MF v155,v12,v155
MF v156,v13,v156
MF v157,v13,v157
MF v158,v13,v158
MF v159,v13,v159
MF v160,v12,v160
MF v161,v12,v161
MF v162,v12,v162
MF v163,v12,v163
MF v164,v13,v164
MF v165,v13,v165
MF v166,v13,v166
MF v167,v13,v167
MF v168,v12,v168
MF v169,v12,v169
MF v170,v12,v170
MF v171,v12,v171
MF v172,v13,v172
MF v173,v13,v173
MF v174,v13,v174
MF v175,v13,v175
MF v176,v12,v176
MF v177,v12,v177
MF v178,v12,v178
MF v179,v12,v179
MF v180,v13,v180
MF v181,v13,v181
MF v182,v13,v182
MF v183,v13,v183
MF v184,v12,v184
MF v185,v12,v185
MF v186,v12,v186
MF v187,v12,v187
MF v188,v13,v188
MF v189,v13,v189
MF v190,v13,v190
MF v191,v13,v191
MF v192,v12,v192
MF v193,v12,v193
MF v194,v12,v194
MF v195,v12,v195
MF v196,v13,v196
MF v197,v13,v197
MF v198,v13,v198
MF v199,v13,v199
MF v200,v12,v200
MF v201,v12,v201
MF v202,v12,v202
MF v203,v12,v203
MF v204,v13,v204
MF v205,v13,v205
MF v206,v13,v206
MF v207,v13,v207
MF v208,v12,v208
MF v209,v12,v209
MF v210,v12,v210
MF v211,v12,v211
MF v212,v13,v212
MF v213,v13,v213
MF v214,v13,v214
MF v215,v13,v215
MF v216,v12,v216
MF v217,v12,v217
MF v218,v12,v218
MF v219,v12,v219
MF v220,v13,v220
MF v221,v13,v221
MF v222,v13,v222
MF v223,v13,v223
MF v224,v12,v224
MF v225,v12,v225
MF v226,v12,v226
MF v227,v12,v227
MF v228,v13,v228
MF v229,v13,v229
MF v230,v13,v230
MF v231,v13,v231
MF v232,v12,v232
MF v233,v12,v233
MF v234,v12,v234
MF v235,v12,v235
MF v236,v13,v236
MF v237,v13,v237
MF v238,v13,v238
MF v239,v13,v239
MF v240,v12,v240
MF v241,v12,v241
MF v242,v12,v242
MF v243,v12,v243
MF v244,v13,v244
MF v245,v13,v245
MF v246,v13,v246
MF v247,v13,v247
MF v248,v12,v248
MF v249,v12,v249
MF v250,v12,v250
MF v251,v12,v251
MF v252,v13,v252
MF v253,v13,v253
MF v254,v13,v254
MF v255,v13,v255
E v18,v100
E v19,v101
E v20,v102
AF v29,v18,v19
C v52,v18,v19
E v21,v103
E v22,v108
AF v29,v20,v29
C v53,v20,v21
E v23,v109
AF v29,v21,v29
E v24,v110
AF v29,v22,v29
C v54,v22,v23
E v25,v111
AF v29,v23,v29
E v18,v116
AF v29,v24,v29
C v55,v24,v25
E v19,v117
AF v29,v25,v29
E v20,v118
AF v29,v18,v29
C v48,v18,v19
E v21,v119
AF v29,v19,v29
E v22,v124
AF v29,v20,v29
C v49,v20,v21
E v23,v125
AF v29,v21,v29
E v24,v126
AF v29,v22,v29
C v50,v22,v23
E v25,v127
AF v29,v23,v29
AF v29,v24,v29
C v51,v24,v25
AF v29,v25,v29
v_sub_f32 v10, v32, v14
v_sub_f32 v11, v36, v15
E v10,v10
E v11,v11
s_nop 0
MF v16,v10,v16
MF v17,v11,v17
G v64,a128
v_and_b32 v65, 0xffff0000, v64
v_lshlrev_b32 v64, 16, v64
MF v64,v10,v64
MF v65,v10,v65
C v64,v64,v65
W a128,v64
G v66,a129
v_and_b32 v67, 0xffff0000, v66
v_lshlrev_b32 v66, 16, v66
MF v66,v10,v66
MF v67,v10,v67
C v66,v66,v67
W a129,v66
G v68,a130
v_and_b32 v69, 0xffff0000, v68
v_lshlrev_b32 v68, 16, v68
MF v68,v10,v68
MF v69,v10,v69
C v68,v68,v69
W a130,v68
G v70,a131
v_and_b32 v71, 0xffff0000, v70
v_lshlrev_b32 v70, 16, v70
MF v70,v10,v70
MF v71,v10,v71
C v70,v70,v71
W a131,v70
G v72,a132
v_and_b32 v73, 0xffff0000, v72
v_lshlrev_b32 v72, 16, v72
MF v72,v10,v72
MF v73,v10,v73
C v72,v72,v73
W a132,v72
G v74,a133
v_and_b32 v75, 0xffff0000, v74
v_lshlrev_b32 v74, 16, v74
MF v74,v10,v74
MF v75,v10,v75
C v74,v74,v75
W a133,v74
G v76,a134
v_and_b32 v77, 0xffff0000, v76
v_lshlrev_b32 v76, 16, v76
MF v76,v10,v76
MF v77,v10,v77
C v76,v76,v77
W a134,v76
G v78,a135
v_and_b32 v79, 0xffff0000, v78
v_lshlrev_b32 v78, 16, v78
MF v78,v10,v78
MF v79,v10,v79
C v78,v78,v79
W a135,v78
G v64,a136
v_and_b32 v65, 0xffff0000, v64
v_lshlrev_b32 v64, 16, v64
MF v64,v10,v64
MF v65,v10,v65
C v64,v64,v65
W a136,v64
G v66,a137
v_and_b32 v67, 0xffff0000, v66
v_lshlrev_b32 v66, 16, v66
MF v66,v10,v66
MF v67,v10,v67
C v66,v66,v67
W a137,v66
G v68,a138
v_and_b32 v69, 0xffff0000, v68
v_lshlrev_b32 v68, 16, v68
MF v68,v10,v68
MF v69,v10,v69
C v68,v68,v69
W a138,v68
G v70,a139
v_and_b32 v71, 0xffff0000, v70
v_lshlrev_b32 v70, 16, v70
MF v70,v10,v70
MF v71,v10,v71
C v70,v70,v71
W a139,v70
G v72,a140
v_and_b32 v73, 0xffff0000, v72
v_lshlrev_b32 v72, 16, v72
MF v72,v10,v72
MF v73,v10,v73
C v72,v72,v73
W a140,v72
G v74,a141
v_and_b32 v75, 0xffff0000, v74
v_lshlrev_b32 v74, 16, v74
MF v74,v10,v74
MF v75,v10,v75
C v74,v74,v75
W a141,v74
G v76,a142
v_and_b32 v77, 0xffff0000, v76
v_lshlrev_b32 v76, 16, v76
MF v76,v10,v76
MF v77,v10,v77
C v76,v76,v77
W a142,v76
G v78,a143
v_and_b32 v79, 0xffff0000, v78
v_lshlrev_b32 v78, 16, v78
MF v78,v10,v78
MF v79,v10,v79
C v78,v78,v79
W a143,v78
G v64,a144
v_and_b32 v65, 0xffff0000, v64
v_lshlrev_b32 v64, 16, v64
MF v64,v10,v64
MF v65,v10,v65
C v64,v64,v65
W a144,v64
G v66,a145
v_and_b32 v67, 0xffff0000, v66
v_lshlrev_b32 v66, 16, v66
MF v66,v10,v66
MF v67,v10,v67
C v66,v66,v67
W a145,v66
G v68,a146
v_and_b32 v69, 0xffff0000, v68
v_lshlrev_b32 v68, 16, v68
MF v68,v10,v68
MF v69,v10,v69
C v68,v68,v69
W a146,v68
G v70,a147
v_and_b32 v71, 0xffff0000, v70
v_lshlrev_b32 v70, 16, v70
MF v70,v10,v70
MF v71,v10,v71
C v70,v70,v71
W a147,v70
G v72,a148
v_and_b32 v73, 0xffff0000, v72
v_lshlrev_b32 v72, 16, v72
MF v72,v10,v72
MF v73,v10,v73
C v72,v72,v73
W a148,v72
G v74,a149
v_and_b32 v75, 0xffff0000, v74
v_lshlrev_b32 v74, 16, v74
MF v74,v10,v74
MF v75,v10,v75
C v74,v74,v75
W a149,v74
G v76,a150
v_and_b32 v77, 0xffff0000, v76
v_lshlrev_b32 v76, 16, v76
MF v76,v10,v76
MF v77,v10,v77
C v76,v76,v77
W a150,v76
G v78,a151
v_and_b32 v79, 0xffff0000, v78
v_lshlrev_b32 v78, 16, v78
MF v78,v10,v78
MF v79,v10,v79
C v78,v78,v79
W a151,v78
G v64,a152
v_and_b32 v65, 0xffff0000, v64
v_lshlrev_b32 v64, 16, v64
MF v64,v10,v64
MF v65,v10,v65
C v64,v64,v65
W a152,v64
G v66,a153
v_and_b32 v67, 0xffff0000, v66
v_lshlrev_b32 v66, 16, v66
MF v66,v10,v66
MF v67,v10,v67
C v66,v66,v67
W a153,v66
G v68,a154
v_and_b32 v69, 0xffff0000, v68
v_lshlrev_b32 v68, 16, v68
MF v68,v10,v68
MF v69,v10,v69
C v68,v68,v69
W a154,v68
G v70,a155
v_and_b32 v71, 0xffff0000, v70
v_lshlrev_b32 v70, 16, v70
MF v70,v10,v70
MF v71,v10,v71
C v70,v70,v71
W a155,v70
G v72,a156
v_and_b32 v73, 0xffff0000, v72
v_lshlrev_b32 v72, 16, v72
MF v72,v10,v72
MF v73,v10,v73
C v72,v72,v73
W a156,v72
G v74,a157
v_and_b32 v75, 0xffff0000, v74
v_lshlrev_b32 v74, 16, v74
MF v74,v10,v74
MF v75,v10,v75
C v74,v74,v75
W a157,v74
G v76,a158
v_and_b32 v77, 0xffff0000, v76
v_lshlrev_b32 v76, 16, v76
MF v76,v10,v76
MF v77,v10,v77
C v76,v76,v77
W a158,v76
G v78,a159
v_and_b32 v79, 0xffff0000, v78
v_lshlrev_b32 v78, 16, v78
MF v78,v10,v78
MF v79,v10,v79
C v78,v78,v79
W a159,v78
G v64,a160
v_and_b32 v65, 0xffff0000, v64
v_lshlrev_b32 v64, 16, v64
MF v64,v11,v64
MF v65,v11,v65
C v64,v64,v65
W a160,v64
G v66,a161
v_and_b32 v67, 0xffff0000, v66
v_lshlrev_b32 v66, 16, v66
MF v66,v11,v66
MF v67,v11,v67
C v66,v66,v67
W a161,v66
G v68,a162
v_and_b32 v69, 0xffff0000, v68
v_lshlrev_b32 v68, 16, v68
MF v68,v11,v68
MF v69,v11,v69
C v68,v68,v69
W a162,v68
G v70,a163
v_and_b32 v71, 0xffff0000, v70
v_lshlrev_b32 v70, 16, v70
MF v70,v11,v70
MF v71,v11,v71
C v70,v70,v71
W a163,v70
G v72,a164
v_and_b32 v73, 0xffff0000, v72
v_lshlrev_b32 v72, 16, v72
MF v72,v11,v72
MF v73,v11,v73
C v72,v72,v73
W a164,v72
G v74,a165
v_and_b32 v75, 0xffff0000, v74
v_lshlrev_b32 v74, 16, v74
MF v74,v11,v74
MF v75,v11,v75
C v74,v74,v75
W a165,v74
G v76,a166
v_and_b32 v77, 0xffff0000, v76
v_lshlrev_b32 v76, 16, v76
MF v76,v11,v76
MF v77,v11,v77
C v76,v76,v77
W a166,v76
G v78,a167
v_and_b32 v79, 0xffff0000, v78
v_lshlrev_b32 v78, 16, v78
MF v78,v11,v78
MF v79,v11,v79
C v78,v78,v79
W a167,v78
G v64,a168
v_and_b32 v65, 0xffff0000, v64
v_lshlrev_b32 v64, 16, v64
MF v64,v11,v64
MF v65,v11,v65
C v64,v64,v65
W a168,v64
G v66,a169
v_and_b32 v67, 0xffff0000, v66
v_lshlrev_b32 v66, 16, v66
MF v66,v11,v66
MF v67,v11,v67
C v66,v66,v67
W a169,v66
G v68,a170
v_and_b32 v69, 0xffff0000, v68
v_lshlrev_b32 v68, 16, v68
MF v68,v11,v68
MF v69,v11,v69
C v68,v68,v69
W a170,v68
G v70,a171
v_and_b32 v71, 0xffff0000, v70
v_lshlrev_b32 v70, 16, v70
MF v70,v11,v70
MF v71,v11,v71
C v70,v70,v71
W a171,v70
G v72,a172
v_and_b32 v73, 0xffff0000, v72
v_lshlrev_b32 v72, 16, v72
MF v72,v11,v72
MF v73,v11,v73
C v72,v72,v73
W a172,v72
G v74,a173
v_and_b32 v75, 0xffff0000, v74
v_lshlrev_b32 v74, 16, v74
MF v74,v11,v74
MF v75,v11,v75
C v74,v74,v75
W a173,v74
G v76,a174
v_and_b32 v77, 0xffff0000, v76
v_lshlrev_b32 v76, 16, v76
MF v76,v11,v76
MF v77,v11,v77
C v76,v76,v77
W a174,v76
G v78,a175
v_and_b32 v79, 0xffff0000, v78
v_lshlrev_b32 v78, 16, v78
MF v78,v11,v78
MF v79,v11,v79
C v78,v78,v79
W a175,v78
G v64,a176
v_and_b32 v65, 0xffff0000, v64
v_lshlrev_b32 v64, 16, v64
MF v64,v11,v64
MF v65,v11,v65
C v64,v64,v65
W a176,v64
G v66,a177
v_and_b32 v67, 0xffff0000, v66
v_lshlrev_b32 v66, 16, v66
MF v66,v11,v66
MF v67,v11,v67
C v66,v66,v67
W a177,v66
G v68,a178
v_and_b32 v69, 0xffff0000, v68
v_lshlrev_b32 v68, 16, v68
MF v68,v11,v68
MF v69,v11,v69
C v68,v68,v69
W a178,v68
G v70,a179
v_and_b32 v71, 0xffff0000, v70
v_lshlrev_b32 v70, 16, v70
MF v70,v11,v70
MF v71,v11,v71
C v70,v70,v71
W a179,v70
G v72,a180
v_and_b32 v73, 0xffff0000, v72
v_lshlrev_b32 v72, 16, v72
MF v72,v11,v72
MF v73,v11,v73
C v72,v72,v73
W a180,v72
G v74,a181
v_and_b32 v75, 0xffff0000, v74
v_lshlrev_b32 v74, 16, v74
MF v74,v11,v74
MF v75,v11,v75
C v74,v74,v75
W a181,v74
G v76,a182
v_and_b32 v77, 0xffff0000, v76
v_lshlrev_b32 v76, 16, v76
MF v76,v11,v76
MF v77,v11,v77
C v76,v76,v77
W a182,v76
G v78,a183
v_and_b32 v79, 0xffff0000, v78
v_lshlrev_b32 v78, 16, v78
MF v78,v11,v78
MF v79,v11,v79
C v78,v78,v79
W a183,v78
G v64,a184
v_and_b32 v65, 0xffff0000, v64
v_lshlrev_b32 v64, 16, v64
MF v64,v11,v64
MF v65,v11,v65
C v64,v64,v65
W a184,v64
G v66,a185
v_and_b32 v67, 0xffff0000, v66
v_lshlrev_b32 v66, 16, v66
MF v66,v11,v66
MF v67,v11,v67
C v66,v66,v67
W a185,v66
G v68,a186
v_and_b32 v69, 0xffff0000, v68
v_lshlrev_b32 v68, 16, v68
MF v68,v11,v68
MF v69,v11,v69
C v68,v68,v69
W a186,v68
G v70,a187
v_and_b32 v71, 0xffff0000, v70
v_lshlrev_b32 v70, 16, v70
MF v70,v11,v70
MF v71,v11,v71
C v70,v70,v71
W a187,v70
G v72,a188
v_and_b32 v73, 0xffff0000, v72
v_lshlrev_b32 v72, 16, v72
MF v72,v11,v72
MF v73,v11,v73
C v72,v72,v73
W a188,v72
G v74,a189
v_and_b32 v75, 0xffff0000, v74
v_lshlrev_b32 v74, 16, v74
MF v74,v11,v74
MF v75,v11,v75
C v74,v74,v75
W a189,v74
G v76,a190
v_and_b32 v77, 0xffff0000, v76
v_lshlrev_b32 v76, 16, v76
MF v76,v11,v76
MF v77,v11,v77
C v76,v76,v77
W a190,v76
G v78,a191
v_and_b32 v79, 0xffff0000, v78
v_lshlrev_b32 v78, 16, v78
MF v78,v11,v78
MF v79,v11,v79
C v78,v78,v79
W a191,v78
s_nop 3
s_setpc_b64 s[36:37]
L_zs0:
s_mov_b32 s64, 65536
L_zs0_l:
s_sleep 2
buffer_load_dword v17, v16, s[12:15], 0 offen sc1
s_sub_u32 s64, s64, 1
s_cbranch_scc1 L_zs0_x
s_waitcnt vmcnt(0)
v_cmp_ne_u32 vcc, 1, v17
s_nop 0
s_cbranch_vccnz L_zs0_l
L_zs0_x:
s_waitcnt vmcnt(0)
s_branch L_zr0
L_zs1:
s_mov_b32 s64, 65536
L_zs1_l:
s_sleep 2
buffer_load_dword v17, v16, s[12:15], 0 offen sc1
s_sub_u32 s64, s64, 1
s_cbranch_scc1 L_zs1_x
s_waitcnt vmcnt(0)
v_cmp_ne_u32 vcc, 1, v17
s_nop 0
s_cbranch_vccnz L_zs1_l
L_zs1_x:
s_waitcnt vmcnt(0)
s_branch L_zr1
L_hs:
s_mov_b32 s91, 65536
L_hs_l:
buffer_load_dwordx4 v[16:19], v7, s[8:11], s67 offen offset:0 sc1
buffer_load_dwordx4 v[20:23], v7, s[8:11], s67 offen offset:1024 sc1
s_waitcnt vmcnt(0)
s_sub_u32 s91, s91, 1
s_cbranch_scc1 L_hr
v_min3_u32 v28, v16, v17, v18
v_min3_u32 v28, v28, v19, v20
v_min3_u32 v28, v28, v21, v22
v_min_u32 v28, v28, v23
v_cmp_eq_u32 vcc, 0, v28
s_nop 0
s_cbranch_vccnz L_hs_l
s_branch L_hr
L_lsj0:
s_mov_b32 s91, 65536
L_lsj0_l:
s_sleep 2
buffer_load_dword v5, v17, s[8:11], s46 offen sc1
s_sub_u32 s91, s91, 1
s_cbranch_scc1 L_lsj0_x
s_waitcnt vmcnt(0)
v_cmp_gt_u32 vcc, 2, v5
s_nop 0
s_cbranch_vccnz L_lsj0_l
L_lsj0_x:
s_waitcnt vmcnt(0)
s_branch L_lrj0
L_lsh2:
s_mov_b32 s91, 65536
L_lsh2_l:
s_sleep 2
buffer_load_dword v5, v17, s[8:11], s46 offen sc1
s_sub_u32 s91, s91, 1
s_cbranch_scc1 L_lsh2_x
s_waitcnt vmcnt(0)
v_cmp_gt_u32 vcc, 2, v5
s_nop 0
s_cbranch_vccnz L_lsh2_l
L_lsh2_x:
s_waitcnt vmcnt(0)
s_branch L_lrh2
L_lsh4:
s_mov_b32 s91, 65536
L_lsh4_l:
s_sleep 2
buffer_load_dword v5, v9, s[8:11], s46 offen sc1
s_sub_u32 s91, s91, 1
s_cbranch_scc1 L_lsh4_x
s_waitcnt vmcnt(0)
v_cmp_gt_u32 vcc, s84, v5
s_nop 0
s_cbranch_vccnz L_lsh4_l
L_lsh4_x:
s_waitcnt vmcnt(0)
s_branch L_lrh4
L_wsq0:
s_mov_b32 s91, 65536
L_wsq0_l:
s_sleep 2
buffer_load_dword v5, v31, s[8:11], s46 offen offset:4 sc1
s_sub_u32 s91, s91, 1
s_cbranch_scc1 L_wsq0_x
s_waitcnt vmcnt(0)
v_cmp_ne_u32 vcc, 1, v5
s_nop 0
s_mov_b32 vcc_hi, 0
s_cbranch_vccnz L_wsq0_l
L_wsq0_x:
s_waitcnt vmcnt(0)
s_branch L_wrq0
L_wsr0:
s_mov_b32 s91, 65536
L_wsr0_l:
s_sleep 2
buffer_load_dword v5, v31, s[8:11], s46 offen offset:4 sc1
s_sub_u32 s91, s91, 1
s_cbranch_scc1 L_wsr0_x
s_waitcnt vmcnt(0)
v_cmp_ne_u32 vcc, 1, v5
s_nop 0
s_mov_b32 vcc_lo, 0
s_cbranch_vccnz L_wsr0_l
L_wsr0_x:
s_waitcnt vmcnt(0)
s_branch L_wrr0
L_wsq1:
s_mov_b32 s91, 65536
L_wsq1_l:
s_sleep 2
buffer_load_dword v5, v31, s[8:11], s46 offen offset:4 sc1
s_sub_u32 s91, s91, 1
s_cbranch_scc1 L_wsq1_x
s_waitcnt vmcnt(0)
v_cmp_ne_u32 vcc, 1, v5
s_nop 0
s_mov_b32 vcc_hi, 0
s_cbranch_vccnz L_wsq1_l
L_wsq1_x:
s_waitcnt vmcnt(0)
s_branch L_wrq1
L_wsr1:
s_mov_b32 s91, 65536
L_wsr1_l:
s_sleep 2
buffer_load_dword v5, v31, s[8:11], s46 offen offset:4 sc1
s_sub_u32 s91, s91, 1
s_cbranch_scc1 L_wsr1_x
s_waitcnt vmcnt(0)
v_cmp_ne_u32 vcc, 1, v5
s_nop 0
s_mov_b32 vcc_lo, 0
s_cbranch_vccnz L_wsr1_l
L_wsr1_x:
s_waitcnt vmcnt(0)
s_branch L_wrr1
L_fll:
s_sub_u32 s65, s7, s40
s_mov_b32 s64, -1
s_cmp_eq_u32 s65, 1
s_cbranch_scc1 L_fl2
s_cmp_lg_u32 s20, 0
s_cbranch_scc1 L_fl3
s_lshr_b32 s64, s42, 3
s_cmp_eq_u32 s7, s64
s_cbranch_scc0 L_fl1
v_mov_b32 v15, 4
buffer_store_dword v15, v1, s[8:11], s45 offen sc1
L_fl1:
s_cmp_lg_u32 s65, 0
s_cbranch_scc1 L_fllr
s_movk_i32 s64, 0x380
L_fl2:
v_min_u32 v17, s64, v9
s_mov_b32 s6, 4
buffer_load_dword v5, v17, s[8:11], s46 offen sc1
s_bitcmp1_b32 s39, 15
s_cbranch_scc0 L_fllr
L_fl3:
s_cmp_eq_u32 s7, 1
s_cbranch_scc1 L_y2
s_cmp_eq_u32 s7, 2
s_cbranch_scc1 L_y3
s_cmp_eq_u32 s7, 3
s_cbranch_scc1 L_y4
s_branch L_y5
s_waitcnt vmcnt(0)
L_fps:
s_cmp_lg_u32 s35, 0
s_cbranch_scc1 L_fpr
L_fps2:
s_mov_b32 s91, 65536
L_fps2_l:
s_sleep 2
buffer_load_dword v6, off, s[8:11], s47 sc1
s_sub_u32 s91, s91, 1
s_cbranch_scc1 L_fps2_x
s_waitcnt vmcnt(0)
v_cmp_ne_u32 vcc, 1, v6
s_nop 0
s_cbranch_vccnz L_fps2_l
L_fps2_x:
s_waitcnt vmcnt(0)
s_branch L_fpr
L_fqs:
s_mov_b32 s91, 65536
L_fqs_l:
s_sleep 2
buffer_load_dword v6, off, s[8:11], s47 offset:16 sc1
s_sub_u32 s91, s91, 1
s_cbranch_scc1 L_fqs_x
s_waitcnt vmcnt(0)
v_cmp_ne_u32 vcc, 1, v6
s_nop 0
s_cbranch_vccnz L_fqs_l
L_fqs_x:
s_waitcnt vmcnt(0)
s_branch L_fqr
L_fls0:
s_mov_b32 s91, 65536
L_fls0_l:
s_sleep 2
buffer_load_dword v5, v17, s[8:11], s46 offen sc1
s_sub_u32 s91, s91, 1
s_cbranch_scc1 L_fls0_x
s_waitcnt vmcnt(0)
v_cmp_gt_u32 vcc, s6, v5
s_nop 0
s_cbranch_vccnz L_fls0_l
L_fls0_x:
s_waitcnt vmcnt(0)
s_branch L_flr0
L_y2:
v_lshrrev_b32 v11, 7, v7
v_mul_u32_u24 v11, 4352, v11
v_and_b32 v12, 0x70, v7
v_lshl_add_u32 v11, v12, 3, v11
s_mov_b32 s64, 104923136
s_mov_b32 s65, 104957952
buffer_load_dword a128, v11, s[8:11], s64 offen sc1
buffer_load_dword a129, v11, s[8:11], s65 offen sc1
s_branch L_fllr
s_waitcnt vmcnt(0)
L_y3:
s_mov_b32 s91, 65536
L_y3c:
G v12,a128
G v13,a129
v_min_u32 v12, v12, v13
v_cmp_gt_u32 vcc, 2, v12
s_sub_u32 s91, s91, 1
s_cbranch_scc1 L_y3x
s_cbranch_vccz L_y3x
v_lshrrev_b32 v11, 7, v7
v_mul_u32_u24 v11, 4352, v11
v_and_b32 v12, 0x70, v7
v_lshl_add_u32 v11, v12, 3, v11
s_mov_b32 s64, 104923136
s_mov_b32 s65, 104957952
buffer_load_dword a128, v11, s[8:11], s64 offen sc1
buffer_load_dword a129, v11, s[8:11], s65 offen sc1
s_waitcnt vmcnt(0)
s_branch L_y3c
L_y3x:
s_lshl_b32 s66, s41, 1
SA s66,s66,s20
s_sub_u32 s66, s66, 2
s_cmp_lt_u32 s66, 14
s_cselect_b32 s64, 8, 12
SA s64,s64,104890368
buffer_load_dword a130, off, s[8:11], s64 sc1
v_lshrrev_b32 v11, 7, v7
v_mul_u32_u24 v11, 3584, v11
v_and_b32 v12, 0x70, v7
v_add_u32 v11, v12, v11
s_lshl_b32 s65, s66, 7
SA s65,s65,105906176
buffer_load_dwordx4 a[132:135], v11, s[8:11], s65 offen sc1
SA s65,s65,28672
buffer_load_dwordx4 a[136:139], v11, s[8:11], s65 offen sc1
SA s65,s65,28672
buffer_load_dwordx4 a[140:143], v11, s[8:11], s65 offen sc1
SA s65,s65,28672
buffer_load_dwordx4 a[144:147], v11, s[8:11], s65 offen sc1
SA s65,s65,28672
buffer_load_dwordx4 a[148:151], v11, s[8:11], s65 offen sc1
SA s65,s65,28672
buffer_load_dwordx4 a[152:155], v11, s[8:11], s65 offen sc1
SA s65,s65,28672
buffer_load_dwordx4 a[156:159], v11, s[8:11], s65 offen sc1
SA s65,s65,28672
buffer_load_dwordx4 a[160:163], v11, s[8:11], s65 offen sc1
SA s65,s65,28672
buffer_load_dwordx4 a[164:167], v11, s[8:11], s65 offen sc1
SA s65,s65,28672
buffer_load_dwordx4 a[168:171], v11, s[8:11], s65 offen sc1
SA s65,s65,28672
buffer_load_dwordx4 a[172:175], v11, s[8:11], s65 offen sc1
SA s65,s65,28672
buffer_load_dwordx4 a[176:179], v11, s[8:11], s65 offen sc1
SA s65,s65,28672
buffer_load_dwordx4 a[180:183], v11, s[8:11], s65 offen sc1
SA s65,s65,28672
buffer_load_dwordx4 a[184:187], v11, s[8:11], s65 offen sc1
SA s65,s65,28672
s_branch L_fllr
s_waitcnt vmcnt(0)
L_y4:
G v12,a132
G v13,a133
G v14,a134
G v15,a135
G v16,a136
G v17,a137
AF v12,v16,v12
AF v13,v17,v13
G v16,a138
G v17,a139
AF v14,v16,v14
AF v15,v17,v15
G v16,a140
G v17,a141
AF v12,v16,v12
AF v13,v17,v13
G v16,a142
G v17,a143
AF v14,v16,v14
AF v15,v17,v15
G v16,a144
G v17,a145
AF v12,v16,v12
AF v13,v17,v13
G v16,a146
G v17,a147
AF v14,v16,v14
AF v15,v17,v15
G v16,a148
G v17,a149
AF v12,v16,v12
AF v13,v17,v13
G v16,a150
G v17,a151
AF v14,v16,v14
AF v15,v17,v15
G v16,a152
G v17,a153
AF v12,v16,v12
AF v13,v17,v13
G v16,a154
G v17,a155
AF v14,v16,v14
AF v15,v17,v15
G v16,a156
G v17,a157
AF v12,v16,v12
AF v13,v17,v13
G v16,a158
G v17,a159
AF v14,v16,v14
AF v15,v17,v15
G v16,a160
G v17,a161
AF v12,v16,v12
AF v13,v17,v13
G v16,a162
G v17,a163
AF v14,v16,v14
AF v15,v17,v15
G v16,a164
G v17,a165
AF v12,v16,v12
AF v13,v17,v13
G v16,a166
G v17,a167
AF v14,v16,v14
AF v15,v17,v15
G v16,a168
G v17,a169
AF v12,v16,v12
AF v13,v17,v13
G v16,a170
G v17,a171
AF v14,v16,v14
AF v15,v17,v15
G v16,a172
G v17,a173
AF v12,v16,v12
AF v13,v17,v13
G v16,a174
G v17,a175
AF v14,v16,v14
AF v15,v17,v15
G v16,a176
G v17,a177
AF v12,v16,v12
AF v13,v17,v13
G v16,a178
G v17,a179
AF v14,v16,v14
AF v15,v17,v15
G v16,a180
G v17,a181
AF v12,v16,v12
AF v13,v17,v13
G v16,a182
G v17,a183
AF v14,v16,v14
AF v15,v17,v15
G v16,a184
G v17,a185
AF v12,v16,v12
AF v13,v17,v13
G v16,a186
G v17,a187
AF v14,v16,v14
AF v15,v17,v15
v_add_f32 v12, v12, v12 row_ror:8 row_mask:0xf bank_mask:0xf
v_add_f32 v13, v13, v13 row_ror:8 row_mask:0xf bank_mask:0xf
v_add_f32 v14, v14, v14 row_ror:8 row_mask:0xf bank_mask:0xf
v_add_f32 v15, v15, v15 row_ror:8 row_mask:0xf bank_mask:0xf
v_mov_b32 v11, v12
s_nop 1
v_permlane16_swap_b32 v11, v12
AF v12,v11,v12
v_mov_b32 v11, v13
s_nop 1
v_permlane16_swap_b32 v11, v13
AF v13,v11,v13
v_mov_b32 v11, v14
s_nop 1
v_permlane16_swap_b32 v11, v14
AF v14,v11,v14
v_mov_b32 v11, v15
s_nop 1
v_permlane16_swap_b32 v11, v15
AF v15,v11,v15
v_mov_b32 v11, v12
s_nop 1
v_permlane32_swap_b32 v11, v12
AF v12,v11,v12
v_mov_b32 v11, v13
s_nop 1
v_permlane32_swap_b32 v11, v13
AF v13,v11,v13
v_mov_b32 v11, v14
s_nop 1
v_permlane32_swap_b32 v11, v14
AF v14,v11,v14
v_mov_b32 v11, v15
s_nop 1
v_permlane32_swap_b32 v11, v15
AF v15,v11,v15
G v16,a130
C v11,v12,v13
v_lshlrev_b32 v12, 16, v11
v_and_b32 v13, 0xffff0000, v11
C v11,v14,v15
v_lshlrev_b32 v14, 16, v11
v_and_b32 v15, 0xffff0000, v11
MF v12,v16,v12
MF v13,v16,v13
MF v14,v16,v14
MF v15,v16,v15
C v11,v12,v13
v_lshlrev_b32 v12, 16, v11
v_and_b32 v13, 0xffff0000, v11
C v11,v14,v15
v_lshlrev_b32 v14, 16, v11
v_and_b32 v15, 0xffff0000, v11
s_lshl_b32 s66, s41, 1
SA s66,s66,s20
s_sub_u32 s66, s66, 2
s_lshl_b32 s65, s66, 7
SA s65,s65,104898560
s_mov_b64 exec, 0xff
buffer_store_dwordx4 v[12:15], v7, s[8:11], s65 offen sc1
s_mov_b64 exec, -1
s_nop 1
s_branch L_fllr
L_y5:
s_lshl_b32 s66, s41, 1
SA s66,s66,s20
s_sub_u32 s66, s66, 2
s_lshl_b32 s66, s66, 2
SA s66,s66,105062912
v_mov_b32 v11, 1
s_mov_b64 exec, 1
buffer_store_dword v11, off, s[8:11], s66 sc1
s_mov_b64 exec, -1
s_branch L_fllr
.p2align 12
L_loop_top:
M v[64:67],a[64:67],a[0:3],v[32:35]
SA m0,s28,0
R a[96:99],v2,40960
M v[64:67],a[68:71],a[4:7],v[64:67]
buffer_load_dword a240, v0, s[60:63], 0 offen offset:0
M v[64:67],a[72:75],a[8:11],v[64:67]
R a[100:103],v2,41984
M v[64:67],a[76:79],a[12:15],v[64:67]
s_waitcnt lgkmcnt(2)
buffer_load_dwordx4 v3, s[8:11], s26 offen offset:0 sc1 lds
M v[64:67],a[80:83],a[16:19],v[64:67]
R a[104:107],v2,43008
M v[64:67],a[84:87],a[20:23],v[64:67]
E v18,v112
M v[64:67],a[88:91],a[24:27],v[64:67]
R a[108:111],v2,44032
M v[64:67],a[92:95],a[28:31],v[64:67]
buffer_load_dwordx4 v3, s[8:11], s26 offen offset:1024 sc1 lds
M v[68:71],a[92:95],a[60:63],v[36:39]
R a[112:115],v2,45056
M v[68:71],a[88:91],a[56:59],v[68:71]
E v19,v113
M v[68:71],a[84:87],a[52:55],v[68:71]
R a[116:119],v2,46080
AF v28,v18,v28
M v[68:71],a[80:83],a[48:51],v[68:71]
E v20,v114
M v[68:71],a[76:79],a[44:47],v[68:71]
R a[120:123],v2,47104
C v56,v18,v19
M v[68:71],a[72:75],a[40:43],v[68:71]
buffer_load_dwordx4 v3, s[8:11], s26 offen offset:2048 sc1 lds
M v[68:71],a[68:71],a[36:39],v[68:71]
R a[124:127],v2,48128
AF v28,v19,v28
M v[68:71],a[64:67],a[32:35],v[68:71]
s_waitcnt lgkmcnt(4)
E v21,v115
M v[76:79],a[96:99],a[32:35],v[36:39]
R a[64:67],v2,49152
AF v28,v20,v28
M v[76:79],a[100:103],a[36:39],v[76:79]
buffer_load_dwordx4 v3, s[8:11], s26 offen offset:3072 sc1 lds
M v[76:79],a[104:107],a[40:43],v[76:79]
R a[68:71],v2,50176
C v57,v20,v21
M v[76:79],a[108:111],a[44:47],v[76:79]
s_waitcnt lgkmcnt(2)
E v22,v120
M v[76:79],a[112:115],a[48:51],v[76:79]
R a[72:75],v2,51200
AF v28,v21,v28
M v[76:79],a[116:119],a[52:55],v[76:79]
E v23,v121
M v[76:79],a[120:123],a[56:59],v[76:79]
SA m0,s28,4096
R a[76:79],v2,52224
AF v28,v22,v28
M v[76:79],a[124:127],a[60:63],v[76:79]
buffer_load_dwordx4 v4, s[8:11], s26 offen offset:0 sc1 lds
M v[72:75],a[124:127],a[28:31],v[32:35]
R a[80:83],v2,53248
C v58,v22,v23
M v[72:75],a[120:123],a[24:27],v[72:75]
E v24,v122
M v[72:75],a[116:119],a[20:23],v[72:75]
R a[84:87],v2,54272
AF v28,v23,v28
M v[72:75],a[112:115],a[16:19],v[72:75]
E v25,v123
M v[72:75],a[108:111],a[12:15],v[72:75]
R a[88:91],v2,55296
AF v28,v24,v28
M v[72:75],a[104:107],a[8:11],v[72:75]
buffer_load_dwordx4 v4, s[8:11], s26 offen offset:1024 sc1 lds
M v[72:75],a[100:103],a[4:7],v[72:75]
R a[92:95],v2,56320
C v59,v24,v25
M v[72:75],a[96:99],a[0:3],v[72:75]
s_waitcnt lgkmcnt(4)
E v18,v116
M v[80:83],a[64:67],a[0:3],v[32:35]
R a[96:99],v2,57344
AF v28,v25,v28
M v[80:83],a[68:71],a[4:7],v[80:83]
R a[100:103],v2,58368
M v[80:83],a[72:75],a[8:11],v[80:83]
buffer_load_dwordx4 v4, s[8:11], s26 offen offset:2048 sc1 lds
M v[80:83],a[76:79],a[12:15],v[80:83]
s_waitcnt lgkmcnt(2)
R a[104:107],v2,59392
M v[80:83],a[80:83],a[16:19],v[80:83]
R a[108:111],v2,60416
M v[80:83],a[84:87],a[20:23],v[80:83]
E v19,v117
M v[80:83],a[88:91],a[24:27],v[80:83]
R a[112:115],v2,61440
AF v29,v18,v29
M v[80:83],a[92:95],a[28:31],v[80:83]
R a[116:119],v2,62464
C v60,v18,v19
M v[84:87],a[92:95],a[60:63],v[36:39]
buffer_load_dwordx4 v4, s[8:11], s26 offen offset:3072 sc1 lds
M v[84:87],a[88:91],a[56:59],v[84:87]
SA s26,s26,32768
R a[120:123],v2,63488
AF v29,v19,v29
M v[84:87],a[84:87],a[52:55],v[84:87]
R a[124:127],v2,64512
M v[84:87],a[80:83],a[48:51],v[84:87]
E v20,v118
M v[84:87],a[76:79],a[44:47],v[84:87]
E v21,v119
M v[84:87],a[72:75],a[40:43],v[84:87]
E v22,v124
M v[84:87],a[68:71],a[36:39],v[84:87]
s_waitcnt vmcnt(17) lgkmcnt(0)
E v23,v125
M v[84:87],a[64:67],a[32:35],v[84:87]
s_barrier
M v[92:95],a[96:99],a[32:35],v[36:39]
R a[64:67],v7,32768
AF v29,v20,v29
M v[92:95],a[100:103],a[36:39],v[92:95]
E v24,v126
M v[92:95],a[104:107],a[40:43],v[92:95]
R a[68:71],v7,33792
C v61,v20,v21
M v[92:95],a[108:111],a[44:47],v[92:95]
AF v29,v21,v29
AF v29,v22,v29
M v[92:95],a[112:115],a[48:51],v[92:95]
R a[72:75],v7,34816
C v62,v22,v23
M v[92:95],a[116:119],a[52:55],v[92:95]
E v25,v127
M v[92:95],a[120:123],a[56:59],v[92:95]
R a[76:79],v7,35840
AF v29,v23,v29
M v[92:95],a[124:127],a[60:63],v[92:95]
AF v29,v24,v29
C v63,v24,v25
M v[88:91],a[124:127],a[28:31],v[32:35]
R a[80:83],v7,36864
AF v29,v25,v29
M v[88:91],a[120:123],a[24:27],v[88:91]
M v[88:91],a[116:119],a[20:23],v[88:91]
R a[84:87],v7,37888
v_max_f32 v10, v28, v29
M v[88:91],a[112:115],a[16:19],v[88:91]
v_cmp_lt_f32 vcc, s31, v10
M v[88:91],a[108:111],a[12:15],v[88:91]
R a[88:91],v7,38912
M v[88:91],a[104:107],a[8:11],v[88:91]
M v[88:91],a[100:103],a[4:7],v[88:91]
s_waitcnt lgkmcnt(3)
R a[92:95],v7,39936
M v[88:91],a[96:99],a[0:3],v[88:91]
s_cbranch_vccnz L_st1
L_rt1:
M v[128:131],a[64:67],v[48:51],v[128:131]
SA m0,s28,98304
R a[96:99],v7,40960
AF v30,v28,v30
M v[128:131],a[68:71],v[56:59],v[128:131]
buffer_load_dwordx4 v3, s[8:11], s21 offen offset:0 sc1 lds
M v[132:135],a[68:71],v[60:63],v[132:135]
R a[100:103],v7,41984
AF v31,v29,v31
M v[132:135],a[64:67],v[52:55],v[132:135]
s_waitcnt lgkmcnt(2)
E v18,v64
M v[140:143],a[72:75],v[52:55],v[140:143]
R a[104:107],v7,43008
M v[140:143],a[76:79],v[60:63],v[140:143]
buffer_load_dwordx4 v3, s[8:11], s21 offen offset:1024 sc1 lds
M v[136:139],a[76:79],v[56:59],v[136:139]
R a[108:111],v7,44032
M v[136:139],a[72:75],v[48:51],v[136:139]
E v19,v65
M v[144:147],a[80:83],v[48:51],v[144:147]
R a[112:115],v7,45056
AF v26,v18,v19
M v[144:147],a[84:87],v[56:59],v[144:147]
E v20,v66
M v[148:151],a[84:87],v[60:63],v[148:151]
R a[116:119],v7,46080
C v40,v18,v19
M v[148:151],a[80:83],v[52:55],v[148:151]
buffer_load_dwordx4 v3, s[8:11], s21 offen offset:2048 sc1 lds
M v[156:159],a[88:91],v[52:55],v[156:159]
R a[120:123],v7,47104
M v[156:159],a[92:95],v[60:63],v[156:159]
E v21,v67
M v[152:155],a[92:95],v[56:59],v[152:155]
R a[124:127],v7,48128
AF v26,v20,v26
M v[152:155],a[88:91],v[48:51],v[152:155]
s_waitcnt lgkmcnt(4)
buffer_load_dwordx4 v3, s[8:11], s21 offen offset:3072 sc1 lds
M v[160:163],a[96:99],v[48:51],v[160:163]
R a[64:67],v7,49152
C v41,v20,v21
M v[160:163],a[100:103],v[56:59],v[160:163]
E v22,v72
M v[164:167],a[100:103],v[60:63],v[164:167]
SA m0,s28,102400
R a[68:71],v7,50176
AF v26,v21,v26
M v[164:167],a[96:99],v[52:55],v[164:167]
s_waitcnt lgkmcnt(2)
buffer_load_dwordx4 v4, s[8:11], s21 offen offset:0 sc1 lds
M v[172:175],a[104:107],v[52:55],v[172:175]
R a[72:75],v7,51200
M v[172:175],a[108:111],v[60:63],v[172:175]
E v23,v73
M v[168:171],a[108:111],v[56:59],v[168:171]
R a[76:79],v7,52224
AF v26,v22,v26
M v[168:171],a[104:107],v[48:51],v[168:171]
E v24,v74
M v[176:179],a[112:115],v[48:51],v[176:179]
R a[80:83],v7,53248
C v42,v22,v23
M v[176:179],a[116:119],v[56:59],v[176:179]
buffer_load_dwordx4 v4, s[8:11], s21 offen offset:1024 sc1 lds
M v[180:183],a[116:119],v[60:63],v[180:183]
R a[84:87],v7,54272
AF v26,v23,v26
M v[180:183],a[112:115],v[52:55],v[180:183]
E v25,v75
M v[188:191],a[120:123],v[52:55],v[188:191]
R a[88:91],v7,55296
AF v26,v24,v26
M v[188:191],a[124:127],v[60:63],v[188:191]
buffer_load_dwordx4 v4, s[8:11], s21 offen offset:2048 sc1 lds
M v[184:187],a[124:127],v[56:59],v[184:187]
R a[92:95],v7,56320
C v43,v24,v25
M v[184:187],a[120:123],v[48:51],v[184:187]
s_waitcnt lgkmcnt(4)
E v18,v68
M v[192:195],a[64:67],v[48:51],v[192:195]
R a[96:99],v7,57344
AF v26,v25,v26
M v[192:195],a[68:71],v[56:59],v[192:195]
R a[100:103],v7,58368
M v[196:199],a[68:71],v[60:63],v[196:199]
buffer_load_dwordx4 v4, s[8:11], s21 offen offset:3072 sc1 lds
M v[196:199],a[64:67],v[52:55],v[196:199]
s_waitcnt lgkmcnt(2)
R a[104:107],v7,59392
M v[204:207],a[72:75],v[52:55],v[204:207]
SA s21,s21,32768
R a[108:111],v7,60416
M v[204:207],a[76:79],v[60:63],v[204:207]
s_sub_u32 s22, s22, 1
E v19,v69
M v[200:203],a[76:79],v[56:59],v[200:203]
s_cselect_b32 s21, s23, s21
R a[112:115],v7,61440
AF v27,v18,v19
M v[200:203],a[72:75],v[48:51],v[200:203]
R a[116:119],v7,62464
C v44,v18,v19
M v[208:211],a[80:83],v[48:51],v[208:211]
E v20,v70
M v[208:211],a[84:87],v[56:59],v[208:211]
R a[120:123],v7,63488
M v[212:215],a[84:87],v[60:63],v[212:215]
R a[124:127],v7,64512
M v[212:215],a[80:83],v[52:55],v[212:215]
E v21,v71
M v[220:223],a[88:91],v[52:55],v[220:223]
E v22,v76
M v[220:223],a[92:95],v[60:63],v[220:223]
AF v27,v20,v27
C v45,v20,v21
M v[216:219],a[92:95],v[56:59],v[216:219]
s_waitcnt vmcnt(17) lgkmcnt(0)
AF v27,v21,v27
M v[216:219],a[88:91],v[48:51],v[216:219]
s_barrier
M v[224:227],a[96:99],v[48:51],v[224:227]
R a[64:67],v2,0
M v[224:227],a[100:103],v[56:59],v[224:227]
E v23,v77
M v[228:231],a[100:103],v[60:63],v[228:231]
R a[68:71],v2,1024
AF v27,v22,v27
M v[228:231],a[96:99],v[52:55],v[228:231]
E v24,v78
M v[236:239],a[104:107],v[52:55],v[236:239]
R a[72:75],v2,2048
C v46,v22,v23
M v[236:239],a[108:111],v[60:63],v[236:239]
AF v27,v23,v27
M v[232:235],a[108:111],v[56:59],v[232:235]
R a[76:79],v2,3072
M v[232:235],a[104:107],v[48:51],v[232:235]
E v25,v79
M v[240:243],a[112:115],v[48:51],v[240:243]
R a[80:83],v2,4096
AF v27,v24,v27
M v[240:243],a[116:119],v[56:59],v[240:243]
C v47,v24,v25
AF v27,v25,v27
M v[244:247],a[116:119],v[60:63],v[244:247]
R a[84:87],v2,5120
M v[244:247],a[112:115],v[52:55],v[244:247]
M v[252:255],a[120:123],v[52:55],v[252:255]
R a[88:91],v2,6144
M v[252:255],a[124:127],v[60:63],v[252:255]
M v[248:251],a[124:127],v[56:59],v[248:251]
s_waitcnt lgkmcnt(3)
R a[92:95],v2,7168
M v[248:251],a[120:123],v[48:51],v[248:251]
M v[96:99],a[64:67],a[0:3],v[32:35]
s_bitcmp1_b32 s39, s7
R a[96:99],v2,8192
M v[96:99],a[68:71],a[4:7],v[96:99]
s_cbranch_scc1 L_fll
L_fllr:
E v18,v80
M v[96:99],a[72:75],a[8:11],v[96:99]
SA m0,s28,32768
R a[100:103],v2,9216
M v[96:99],a[76:79],a[12:15],v[96:99]
s_waitcnt lgkmcnt(2)
buffer_load_dwordx4 v3, s[8:11], s26 offen offset:0 sc1 lds
M v[96:99],a[80:83],a[16:19],v[96:99]
R a[104:107],v2,10240
M v[96:99],a[84:87],a[20:23],v[96:99]
E v19,v81
M v[96:99],a[88:91],a[24:27],v[96:99]
R a[108:111],v2,11264
AF v26,v18,v26
M v[96:99],a[92:95],a[28:31],v[96:99]
E v20,v82
M v[100:103],a[92:95],a[60:63],v[36:39]
R a[112:115],v2,12288
C v56,v18,v19
M v[100:103],a[88:91],a[56:59],v[100:103]
buffer_load_dwordx4 v3, s[8:11], s26 offen offset:1024 sc1 lds
M v[100:103],a[84:87],a[52:55],v[100:103]
R a[116:119],v2,13312
AF v26,v19,v26
M v[100:103],a[80:83],a[48:51],v[100:103]
E v21,v83
M v[100:103],a[76:79],a[44:47],v[100:103]
R a[120:123],v2,14336
AF v26,v20,v26
M v[100:103],a[72:75],a[40:43],v[100:103]
buffer_load_dwordx4 v3, s[8:11], s26 offen offset:2048 sc1 lds
M v[100:103],a[68:71],a[36:39],v[100:103]
R a[124:127],v2,15360
C v57,v20,v21
M v[100:103],a[64:67],a[32:35],v[100:103]
s_waitcnt lgkmcnt(4)
E v22,v88
M v[108:111],a[96:99],a[32:35],v[36:39]
R a[64:67],v2,16384
AF v26,v21,v26
M v[108:111],a[100:103],a[36:39],v[108:111]
E v23,v89
M v[108:111],a[104:107],a[40:43],v[108:111]
R a[68:71],v2,17408
AF v26,v22,v26
M v[108:111],a[108:111],a[44:47],v[108:111]
s_waitcnt lgkmcnt(2)
buffer_load_dwordx4 v3, s[8:11], s26 offen offset:3072 sc1 lds
M v[108:111],a[112:115],a[48:51],v[108:111]
R a[72:75],v2,18432
C v58,v22,v23
M v[108:111],a[116:119],a[52:55],v[108:111]
E v24,v90
M v[108:111],a[120:123],a[56:59],v[108:111]
R a[76:79],v2,19456
AF v26,v23,v26
M v[108:111],a[124:127],a[60:63],v[108:111]
SA m0,s28,36864
M v[104:107],a[124:127],a[28:31],v[32:35]
R a[80:83],v2,20480
M v[104:107],a[120:123],a[24:27],v[104:107]
buffer_load_dwordx4 v4, s[8:11], s26 offen offset:0 sc1 lds
M v[104:107],a[116:119],a[20:23],v[104:107]
R a[84:87],v2,21504
M v[104:107],a[112:115],a[16:19],v[104:107]
E v25,v91
M v[104:107],a[108:111],a[12:15],v[104:107]
R a[88:91],v2,22528
AF v26,v24,v26
M v[104:107],a[104:107],a[8:11],v[104:107]
buffer_load_dwordx4 v4, s[8:11], s26 offen offset:1024 sc1 lds
M v[104:107],a[100:103],a[4:7],v[104:107]
R a[92:95],v2,23552
C v59,v24,v25
M v[104:107],a[96:99],a[0:3],v[104:107]
s_waitcnt lgkmcnt(4)
E v18,v84
M v[112:115],a[64:67],a[0:3],v[32:35]
R a[96:99],v2,24576
AF v26,v25,v26
M v[112:115],a[68:71],a[4:7],v[112:115]
R a[100:103],v2,25600
M v[112:115],a[72:75],a[8:11],v[112:115]
buffer_load_dwordx4 v4, s[8:11], s26 offen offset:2048 sc1 lds
M v[112:115],a[76:79],a[12:15],v[112:115]
s_waitcnt lgkmcnt(2)
R a[104:107],v2,26624
M v[112:115],a[80:83],a[16:19],v[112:115]
R a[108:111],v2,27648
M v[112:115],a[84:87],a[20:23],v[112:115]
E v19,v85
M v[112:115],a[88:91],a[24:27],v[112:115]
R a[112:115],v2,28672
AF v27,v18,v27
M v[112:115],a[92:95],a[28:31],v[112:115]
R a[116:119],v2,29696
C v60,v18,v19
M v[116:119],a[92:95],a[60:63],v[36:39]
buffer_load_dwordx4 v4, s[8:11], s26 offen offset:3072 sc1 lds
M v[116:119],a[88:91],a[56:59],v[116:119]
SA s26,s26,32768
R a[120:123],v2,30720
AF v27,v19,v27
M v[116:119],a[84:87],a[52:55],v[116:119]
R a[124:127],v2,31744
M v[116:119],a[80:83],a[48:51],v[116:119]
E v20,v86
M v[116:119],a[76:79],a[44:47],v[116:119]
E v21,v87
M v[116:119],a[72:75],a[40:43],v[116:119]
E v22,v92
M v[116:119],a[68:71],a[36:39],v[116:119]
s_waitcnt vmcnt(16) lgkmcnt(0)
E v23,v93
M v[116:119],a[64:67],a[32:35],v[116:119]
s_barrier
M v[124:127],a[96:99],a[32:35],v[36:39]
R a[64:67],v7,0
AF v27,v20,v27
M v[124:127],a[100:103],a[36:39],v[124:127]
E v24,v94
M v[124:127],a[104:107],a[40:43],v[124:127]
R a[68:71],v7,1024
C v61,v20,v21
M v[124:127],a[108:111],a[44:47],v[124:127]
AF v27,v21,v27
AF v27,v22,v27
M v[124:127],a[112:115],a[48:51],v[124:127]
R a[72:75],v7,2048
C v62,v22,v23
M v[124:127],a[116:119],a[52:55],v[124:127]
E v25,v95
M v[124:127],a[120:123],a[56:59],v[124:127]
R a[76:79],v7,3072
AF v27,v23,v27
M v[124:127],a[124:127],a[60:63],v[124:127]
AF v27,v24,v27
C v63,v24,v25
M v[120:123],a[124:127],a[28:31],v[32:35]
R a[80:83],v7,4096
AF v27,v25,v27
M v[120:123],a[120:123],a[24:27],v[120:123]
M v[120:123],a[116:119],a[20:23],v[120:123]
R a[84:87],v7,5120
v_max_f32 v10, v26, v27
M v[120:123],a[112:115],a[16:19],v[120:123]
v_cmp_lt_f32 vcc, s31, v10
M v[120:123],a[108:111],a[12:15],v[120:123]
R a[88:91],v7,6144
M v[120:123],a[104:107],a[8:11],v[120:123]
M v[120:123],a[100:103],a[4:7],v[120:123]
s_waitcnt lgkmcnt(3)
R a[92:95],v7,7168
M v[120:123],a[96:99],a[0:3],v[120:123]
s_cbranch_vccnz L_st0
L_rt0:
M v[128:131],a[64:67],v[40:43],v[128:131]
SA m0,s28,65536
R a[96:99],v7,8192
AF v30,v26,v30
M v[128:131],a[68:71],v[56:59],v[128:131]
buffer_load_dwordx4 v3, s[8:11], s21 offen offset:0 sc1 lds
M v[132:135],a[68:71],v[60:63],v[132:135]
R a[100:103],v7,9216
AF v31,v27,v31
M v[132:135],a[64:67],v[44:47],v[132:135]
s_waitcnt lgkmcnt(2)
E v18,v96
M v[140:143],a[72:75],v[44:47],v[140:143]
R a[104:107],v7,10240
M v[140:143],a[76:79],v[60:63],v[140:143]
buffer_load_dwordx4 v3, s[8:11], s21 offen offset:1024 sc1 lds
M v[136:139],a[76:79],v[56:59],v[136:139]
R a[108:111],v7,11264
M v[136:139],a[72:75],v[40:43],v[136:139]
E v19,v97
M v[144:147],a[80:83],v[40:43],v[144:147]
R a[112:115],v7,12288
AF v28,v18,v19
M v[144:147],a[84:87],v[56:59],v[144:147]
E v20,v98
M v[148:151],a[84:87],v[60:63],v[148:151]
R a[116:119],v7,13312
C v48,v18,v19
M v[148:151],a[80:83],v[44:47],v[148:151]
buffer_load_dwordx4 v3, s[8:11], s21 offen offset:2048 sc1 lds
M v[156:159],a[88:91],v[44:47],v[156:159]
R a[120:123],v7,14336
M v[156:159],a[92:95],v[60:63],v[156:159]
E v21,v99
M v[152:155],a[92:95],v[56:59],v[152:155]
R a[124:127],v7,15360
AF v28,v20,v28
M v[152:155],a[88:91],v[40:43],v[152:155]
s_waitcnt lgkmcnt(4)
buffer_load_dwordx4 v3, s[8:11], s21 offen offset:3072 sc1 lds
M v[160:163],a[96:99],v[40:43],v[160:163]
R a[64:67],v7,16384
C v49,v20,v21
M v[160:163],a[100:103],v[56:59],v[160:163]
E v22,v104
M v[164:167],a[100:103],v[60:63],v[164:167]
SA m0,s28,69632
R a[68:71],v7,17408
AF v28,v21,v28
M v[164:167],a[96:99],v[44:47],v[164:167]
s_waitcnt lgkmcnt(2)
buffer_load_dwordx4 v4, s[8:11], s21 offen offset:0 sc1 lds
M v[172:175],a[104:107],v[44:47],v[172:175]
R a[72:75],v7,18432
M v[172:175],a[108:111],v[60:63],v[172:175]
E v23,v105
M v[168:171],a[108:111],v[56:59],v[168:171]
R a[76:79],v7,19456
AF v28,v22,v28
M v[168:171],a[104:107],v[40:43],v[168:171]
E v24,v106
M v[176:179],a[112:115],v[40:43],v[176:179]
R a[80:83],v7,20480
C v50,v22,v23
M v[176:179],a[116:119],v[56:59],v[176:179]
buffer_load_dwordx4 v4, s[8:11], s21 offen offset:1024 sc1 lds
M v[180:183],a[116:119],v[60:63],v[180:183]
R a[84:87],v7,21504
AF v28,v23,v28
M v[180:183],a[112:115],v[44:47],v[180:183]
E v25,v107
M v[188:191],a[120:123],v[44:47],v[188:191]
R a[88:91],v7,22528
AF v28,v24,v28
M v[188:191],a[124:127],v[60:63],v[188:191]
buffer_load_dwordx4 v4, s[8:11], s21 offen offset:2048 sc1 lds
M v[184:187],a[124:127],v[56:59],v[184:187]
R a[92:95],v7,23552
C v51,v24,v25
M v[184:187],a[120:123],v[40:43],v[184:187]
s_waitcnt lgkmcnt(4)
E v18,v100
M v[192:195],a[64:67],v[40:43],v[192:195]
R a[96:99],v7,24576
AF v28,v25,v28
M v[192:195],a[68:71],v[56:59],v[192:195]
R a[100:103],v7,25600
M v[196:199],a[68:71],v[60:63],v[196:199]
buffer_load_dwordx4 v4, s[8:11], s21 offen offset:3072 sc1 lds
M v[196:199],a[64:67],v[44:47],v[196:199]
s_waitcnt lgkmcnt(2)
R a[104:107],v7,26624
M v[204:207],a[72:75],v[44:47],v[204:207]
SA s21,s21,32768
R a[108:111],v7,27648
M v[204:207],a[76:79],v[60:63],v[204:207]
s_sub_u32 s22, s22, 1
E v19,v101
M v[200:203],a[76:79],v[56:59],v[200:203]
s_cselect_b32 s21, s23, s21
R a[112:115],v7,28672
AF v29,v18,v19
M v[200:203],a[72:75],v[40:43],v[200:203]
R a[116:119],v7,29696
C v52,v18,v19
M v[208:211],a[80:83],v[40:43],v[208:211]
E v20,v102
M v[208:211],a[84:87],v[56:59],v[208:211]
R a[120:123],v7,30720
M v[212:215],a[84:87],v[60:63],v[212:215]
R a[124:127],v7,31744
M v[212:215],a[80:83],v[44:47],v[212:215]
E v21,v103
M v[220:223],a[88:91],v[44:47],v[220:223]
E v22,v108
M v[220:223],a[92:95],v[60:63],v[220:223]
AF v29,v20,v29
C v53,v20,v21
M v[216:219],a[92:95],v[56:59],v[216:219]
s_waitcnt vmcnt(16) lgkmcnt(0)
AF v29,v21,v29
M v[216:219],a[88:91],v[40:43],v[216:219]
s_barrier
M v[224:227],a[96:99],v[40:43],v[224:227]
R a[64:67],v2,32768
M v[224:227],a[100:103],v[56:59],v[224:227]
E v23,v109
M v[228:231],a[100:103],v[60:63],v[228:231]
R a[68:71],v2,33792
v_cmp_gt_u32 vcc, s6, v5
M v[228:231],a[96:99],v[44:47],v[228:231]
E v24,v110
M v[236:239],a[104:107],v[44:47],v[236:239]
R a[72:75],v2,34816
AF v29,v22,v29
M v[236:239],a[108:111],v[60:63],v[236:239]
s_cbranch_vccnz L_fls0
L_flr0:
C v54,v22,v23
AF v29,v23,v29
M v[232:235],a[108:111],v[56:59],v[232:235]
s_mov_b32 s6, 0
R a[76:79],v2,35840
M v[232:235],a[104:107],v[40:43],v[232:235]
SA s7,s7,1
E v25,v111
M v[240:243],a[112:115],v[40:43],v[240:243]
R a[80:83],v2,36864
AF v29,v24,v29
M v[240:243],a[116:119],v[56:59],v[240:243]
C v55,v24,v25
AF v29,v25,v29
M v[244:247],a[116:119],v[60:63],v[244:247]
R a[84:87],v2,37888
M v[244:247],a[112:115],v[44:47],v[244:247]
M v[252:255],a[120:123],v[44:47],v[252:255]
s_sub_u32 s27, s27, 1
R a[88:91],v2,38912
M v[252:255],a[124:127],v[60:63],v[252:255]
s_cmp_lg_u32 s27, 0
M v[248:251],a[124:127],v[56:59],v[248:251]
s_waitcnt lgkmcnt(3)
R a[92:95],v2,39936
M v[248:251],a[120:123],v[40:43],v[248:251]
s_cbranch_scc1 L_loop_top
s_cmp_eq_u32 s40, 0
s_cbranch_scc1 L_final_h
L_d1s:
M v[68:71],a[64:67],a[32:35],v[36:39]
s_cmp_lt_u32 s20, 0
R a[96:99],v2,40960
R a[100:103],v2,41984
M v[68:71],a[68:71],a[36:39],v[68:71]
s_cselect_b64 s[82:83], -1, 0
E v18,v112
M v[68:71],a[72:75],a[40:43],v[68:71]
s_cmp_eq_u32 s20, 0
M v[68:71],a[76:79],a[44:47],v[68:71]
s_cselect_b64 s[66:67], s[16:17], s[82:83]
R a[104:107],v2,43008
R a[108:111],v2,44032
s_waitcnt lgkmcnt(7)
M v[68:71],a[80:83],a[48:51],v[68:71]
s_cselect_b64 s[68:69], s[18:19], s[82:83]
E v19,v113
s_waitcnt lgkmcnt(6)
M v[68:71],a[84:87],a[52:55],v[68:71]
s_cselect_b64 s[70:71], s[48:49], s[82:83]
AF v28,v18,v28
C v56,v18,v19
s_waitcnt lgkmcnt(5)
M v[68:71],a[88:91],a[56:59],v[68:71]
s_cselect_b64 s[72:73], s[50:51], s[82:83]
R a[112:115],v2,45056
R a[116:119],v2,46080
v_cndmask_b32 v64, v32, v8, s[66:67]
v_cndmask_b32 v65, v32, v8, s[68:69]
v_cndmask_b32 v66, v32, v8, s[70:71]
v_cndmask_b32 v67, v32, v8, s[72:73]
s_waitcnt lgkmcnt(6)
M v[68:71],a[92:95],a[60:63],v[68:71]
s_mov_b32 s26, s43
v_min_u32 v17, 896, v9
AF v28,v19,v28
M v[64:67],a[92:95],a[28:31],v[64:67]
s_cmp_lt_u32 s20, 1
buffer_load_dword v5, v17, s[8:11], s46 offen sc1
M v[64:67],a[88:91],a[24:27],v[64:67]
s_cselect_b64 s[82:83], -1, 0
R a[120:123],v2,47104
R a[124:127],v2,48128
M v[64:67],a[84:87],a[20:23],v[64:67]
SA m0,s28,0
E v20,v114
M v[64:67],a[80:83],a[16:19],v[64:67]
s_cmp_eq_u32 s20, 1
buffer_load_dwordx4 v3, s[8:11], s26 offen offset:0 sc1 lds
M v[64:67],a[76:79],a[12:15],v[64:67]
s_cselect_b64 s[74:75], s[16:17], s[82:83]
E v21,v115
M v[64:67],a[72:75],a[8:11],v[64:67]
s_cselect_b64 s[76:77], s[18:19], s[82:83]
AF v28,v20,v28
C v57,v20,v21
M v[64:67],a[68:71],a[4:7],v[64:67]
s_cselect_b64 s[78:79], s[48:49], s[82:83]
E v22,v120
M v[64:67],a[64:67],a[0:3],v[64:67]
s_waitcnt lgkmcnt(0)
buffer_load_dwordx4 v3, s[8:11], s26 offen offset:1024 sc1 lds
M v[76:79],a[96:99],a[32:35],v[36:39]
s_cselect_b64 s[80:81], s[50:51], s[82:83]
R a[64:67],v2,49152
R a[68:71],v2,50176
M v[76:79],a[100:103],a[36:39],v[76:79]
v_cndmask_b32 v72, v32, v8, s[74:75]
v_cndmask_b32 v73, v32, v8, s[76:77]
M v[76:79],a[104:107],a[40:43],v[76:79]
v_cndmask_b32 v74, v32, v8, s[78:79]
AF v28,v21,v28
M v[76:79],a[108:111],a[44:47],v[76:79]
R a[72:75],v2,51200
R a[76:79],v2,52224
M v[76:79],a[112:115],a[48:51],v[76:79]
buffer_load_dwordx4 v3, s[8:11], s26 offen offset:2048 sc1 lds
M v[76:79],a[116:119],a[52:55],v[76:79]
v_cndmask_b32 v75, v32, v8, s[80:81]
M v[76:79],a[120:123],a[56:59],v[76:79]
s_cmp_lt_u32 s20, 2
R a[80:83],v2,53248
R a[84:87],v2,54272
M v[76:79],a[124:127],a[60:63],v[76:79]
s_cselect_b64 s[82:83], -1, 0
E v23,v121
M v[72:75],a[124:127],a[28:31],v[72:75]
s_cmp_eq_u32 s20, 2
buffer_load_dwordx4 v3, s[8:11], s26 offen offset:3072 sc1 lds
M v[72:75],a[120:123],a[24:27],v[72:75]
s_cselect_b64 s[66:67], s[16:17], s[82:83]
R a[88:91],v2,55296
R a[92:95],v2,56320
M v[72:75],a[116:119],a[20:23],v[72:75]
s_cselect_b64 s[68:69], s[18:19], s[82:83]
E v24,v122
M v[72:75],a[112:115],a[16:19],v[72:75]
s_cselect_b64 s[70:71], s[48:49], s[82:83]
E v25,v123
M v[72:75],a[108:111],a[12:15],v[72:75]
s_cselect_b64 s[72:73], s[50:51], s[82:83]
v_cndmask_b32 v80, v32, v8, s[66:67]
v_cndmask_b32 v81, v32, v8, s[68:69]
M v[72:75],a[104:107],a[8:11],v[72:75]
SA m0,s28,4096
E v18,v116
M v[72:75],a[100:103],a[4:7],v[72:75]
s_lshl_b32 s86, s20, 14
buffer_load_dwordx4 v4, s[8:11], s26 offen offset:0 sc1 lds
M v[72:75],a[96:99],a[0:3],v[72:75]
s_waitcnt lgkmcnt(0)
v_cndmask_b32 v82, v32, v8, s[70:71]
AF v28,v22,v28
M v[84:87],a[64:67],a[32:35],v[36:39]
SA s86,s86,s34
R a[96:99],v2,57344
R a[100:103],v2,58368
M v[84:87],a[68:71],a[36:39],v[84:87]
SA s87,s86,4096
buffer_load_dwordx4 v4, s[8:11], s26 offen offset:1024 sc1 lds
M v[84:87],a[72:75],a[40:43],v[84:87]
SA s88,s86,8192
v_cndmask_b32 v83, v32, v8, s[72:73]
C v58,v22,v23
M v[84:87],a[76:79],a[44:47],v[84:87]
s_cmp_lt_u32 s20, 3
R a[104:107],v2,59392
R a[108:111],v2,60416
M v[84:87],a[80:83],a[48:51],v[84:87]
s_cselect_b64 s[82:83], -1, 0
E v19,v117
M v[84:87],a[84:87],a[52:55],v[84:87]
SA s89,s86,12288
buffer_load_dwordx4 v4, s[8:11], s26 offen offset:2048 sc1 lds
M v[84:87],a[88:91],a[56:59],v[84:87]
s_lshl_b32 s90, s20, 10
R a[112:115],v2,61440
R a[116:119],v2,62464
M v[84:87],a[92:95],a[60:63],v[84:87]
SA s90,s90,s34
E v20,v118
M v[80:83],a[92:95],a[28:31],v[80:83]
SA s90,s90,65536
E v21,v119
M v[80:83],a[88:91],a[24:27],v[80:83]
s_cmp_eq_u32 s20, 3
R a[120:123],v2,63488
R a[124:127],v2,64512
M v[80:83],a[84:87],a[20:23],v[80:83]
s_cselect_b64 s[74:75], s[16:17], s[82:83]
buffer_load_dwordx4 v4, s[8:11], s26 offen offset:3072 sc1 lds
M v[80:83],a[80:83],a[16:19],v[80:83]
s_cselect_b64 s[76:77], s[18:19], s[82:83]
AF v28,v23,v28
AF v28,v24,v28
M v[80:83],a[76:79],a[12:15],v[80:83]
s_cselect_b64 s[78:79], s[48:49], s[82:83]
E v22,v124
M v[80:83],a[72:75],a[8:11],v[80:83]
s_cselect_b64 s[80:81], s[50:51], s[82:83]
v_cndmask_b32 v88, v32, v8, s[74:75]
v_cndmask_b32 v89, v32, v8, s[76:77]
M v[80:83],a[68:71],a[4:7],v[80:83]
s_waitcnt vmcnt(17) lgkmcnt(0)
v_cndmask_b32 v90, v32, v8, s[78:79]
v_cndmask_b32 v91, v32, v8, s[80:81]
M v[80:83],a[64:67],a[0:3],v[80:83]
s_barrier
M v[92:95],a[96:99],a[32:35],v[36:39]
SA s26,s26,32768
R a[64:67],v7,32768
R a[68:71],v7,33792
M v[92:95],a[100:103],a[36:39],v[92:95]
SA m0,s28,131072
E v23,v125
M v[92:95],a[104:107],a[40:43],v[92:95]
buffer_load_dwordx4 v3, s[8:11], s26 offen offset:0 sc1 lds
M v[92:95],a[108:111],a[44:47],v[92:95]
R a[72:75],v7,34816
R a[76:79],v7,35840
M v[92:95],a[112:115],a[48:51],v[92:95]
C v59,v24,v25
AF v28,v25,v28
M v[92:95],a[116:119],a[52:55],v[92:95]
buffer_load_dwordx4 v3, s[8:11], s26 offen offset:1024 sc1 lds
M v[92:95],a[120:123],a[56:59],v[92:95]
R a[80:83],v7,36864
R a[84:87],v7,37888
M v[92:95],a[124:127],a[60:63],v[92:95]
E v24,v126
M v[88:91],a[124:127],a[28:31],v[88:91]
buffer_load_dwordx4 v3, s[8:11], s26 offen offset:2048 sc1 lds
M v[88:91],a[120:123],a[24:27],v[88:91]
R a[88:91],v7,38912
R a[92:95],v7,39936
M v[88:91],a[116:119],a[20:23],v[88:91]
E v25,v127
M v[88:91],a[112:115],a[16:19],v[88:91]
buffer_load_dwordx4 v3, s[8:11], s26 offen offset:3072 sc1 lds
M v[88:91],a[108:111],a[12:15],v[88:91]
AF v29,v18,v29
C v60,v18,v19
M v[88:91],a[104:107],a[8:11],v[88:91]
AF v29,v19,v29
AF v29,v20,v29
M v[88:91],a[100:103],a[4:7],v[88:91]
s_waitcnt lgkmcnt(0)
C v61,v20,v21
AF v29,v21,v29
M v[88:91],a[96:99],a[0:3],v[88:91]
AF v29,v22,v29
C v62,v22,v23
AF v29,v23,v29
AF v29,v24,v29
C v63,v24,v25
AF v29,v25,v29
v_max_f32 v10, v28, v29
v_cmp_lt_f32 vcc, s31, v10
s_nop 0
s_cbranch_vccnz L_std1
L_rtd1:
s_cmp_lt_u32 s42, 6
s_cbranch_scc1 L_d2h
M v[128:131],a[64:67],v[48:51],v[128:131]
R a[96:99],v7,40960
R a[100:103],v7,41984
M v[128:131],a[68:71],v[56:59],v[128:131]
SA m0,s28,135168
E v18,v64
M v[132:135],a[68:71],v[60:63],v[132:135]
buffer_load_dwordx4 v4, s[8:11], s26 offen offset:0 sc1 lds
M v[132:135],a[64:67],v[52:55],v[132:135]
R a[104:107],v7,43008
R a[108:111],v7,44032
M v[140:143],a[72:75],v[52:55],v[140:143]
s_cmp_gt_u32 s20, 3
E v19,v65
M v[140:143],a[76:79],v[60:63],v[140:143]
s_cselect_b64 s[82:83], -1, 0
AF v30,v28,v30
AF v31,v29,v31
M v[136:139],a[76:79],v[56:59],v[136:139]
s_cmp_eq_u32 s20, 3
R a[112:115],v7,45056
R a[116:119],v7,46080
M v[136:139],a[72:75],v[48:51],v[136:139]
s_cselect_b64 s[66:67], s[16:17], s[82:83]
buffer_load_dwordx4 v4, s[8:11], s26 offen offset:1024 sc1 lds
M v[144:147],a[80:83],v[48:51],v[144:147]
s_cselect_b64 s[68:69], s[18:19], s[82:83]
E v20,v66
M v[144:147],a[84:87],v[56:59],v[144:147]
s_cselect_b64 s[70:71], s[48:49], s[82:83]
R a[120:123],v7,47104
R a[124:127],v7,48128
M v[148:151],a[84:87],v[60:63],v[148:151]
s_cselect_b64 s[72:73], s[50:51], s[82:83]
v_cndmask_b32 v100, v36, v8, s[66:67]
v_cndmask_b32 v101, v36, v8, s[68:69]
M v[148:151],a[80:83],v[52:55],v[148:151]
buffer_load_dwordx4 v4, s[8:11], s26 offen offset:2048 sc1 lds
M v[156:159],a[88:91],v[52:55],v[156:159]
v_cndmask_b32 v102, v36, v8, s[70:71]
AF v26,v18,v19
M v[156:159],a[92:95],v[60:63],v[156:159]
E v21,v67
M v[152:155],a[92:95],v[56:59],v[152:155]
v_cndmask_b32 v103, v36, v8, s[72:73]
C v40,v18,v19
M v[152:155],a[88:91],v[48:51],v[152:155]
s_waitcnt lgkmcnt(0)
buffer_load_dwordx4 v4, s[8:11], s26 offen offset:3072 sc1 lds
M v[160:163],a[96:99],v[48:51],v[160:163]
s_cmp_gt_u32 s20, 2
R a[64:67],v7,49152
R a[68:71],v7,50176
M v[160:163],a[100:103],v[56:59],v[160:163]
s_cselect_b64 s[82:83], -1, 0
v_lshrrev_b32 v14, 7, v7
AF v26,v20,v26
M v[164:167],a[100:103],v[60:63],v[164:167]
s_cmp_eq_u32 s20, 2
v_mul_u32_u24 v14, 896, v14
C v41,v20,v21
M v[164:167],a[96:99],v[52:55],v[164:167]
s_cselect_b64 s[74:75], s[16:17], s[82:83]
R a[72:75],v7,51200
R a[76:79],v7,52224
M v[172:175],a[104:107],v[52:55],v[172:175]
s_cselect_b64 s[76:77], s[18:19], s[82:83]
v_lshrrev_b32 v15, 8, v7
AF v26,v21,v26
M v[172:175],a[108:111],v[60:63],v[172:175]
s_cselect_b64 s[78:79], s[48:49], s[82:83]
v_lshlrev_b32 v15, 5, v15
M v[168:171],a[108:111],v[56:59],v[168:171]
s_cselect_b64 s[80:81], s[50:51], s[82:83]
R a[80:83],v7,53248
R a[84:87],v7,54272
M v[168:171],a[104:107],v[48:51],v[168:171]
v_cndmask_b32 v108, v36, v8, s[74:75]
v_cndmask_b32 v109, v36, v8, s[76:77]
M v[176:179],a[112:115],v[48:51],v[176:179]
v_xor_b32 v15, v15, v7
M v[176:179],a[116:119],v[56:59],v[176:179]
R a[88:91],v7,55296
R a[92:95],v7,56320
M v[180:183],a[116:119],v[60:63],v[180:183]
v_and_b32 v15, 0x70, v15
v_cndmask_b32 v110, v36, v8, s[78:79]
M v[180:183],a[112:115],v[52:55],v[180:183]
v_add_u32 v0, v14, v15
M v[188:191],a[120:123],v[52:55],v[188:191]
s_mul_i32 s38, s20, 57344
v_cndmask_b32 v111, v36, v8, s[80:81]
M v[188:191],a[124:127],v[60:63],v[188:191]
s_cmp_gt_u32 s20, 1
E v22,v72
M v[184:187],a[124:127],v[56:59],v[184:187]
s_cselect_b64 s[82:83], -1, 0
E v23,v73
M v[184:187],a[120:123],v[48:51],v[184:187]
s_waitcnt lgkmcnt(0)
E v24,v74
M v[192:195],a[64:67],v[48:51],v[192:195]
SA m0,s28,98304
R a[96:99],v7,57344
R a[100:103],v7,58368
M v[192:195],a[68:71],v[56:59],v[192:195]
s_cmp_eq_u32 s20, 1
E v25,v75
M v[196:199],a[68:71],v[60:63],v[196:199]
s_cselect_b64 s[66:67], s[16:17], s[82:83]
E v18,v68
M v[196:199],a[64:67],v[52:55],v[196:199]
s_cselect_b64 s[68:69], s[18:19], s[82:83]
R a[104:107],v7,59392
R a[108:111],v7,60416
M v[204:207],a[72:75],v[52:55],v[204:207]
s_cselect_b64 s[70:71], s[48:49], s[82:83]
E v19,v69
M v[204:207],a[76:79],v[60:63],v[204:207]
s_cselect_b64 s[72:73], s[50:51], s[82:83]
v_cndmask_b32 v116, v36, v8, s[66:67]
v_cndmask_b32 v117, v36, v8, s[68:69]
M v[200:203],a[76:79],v[56:59],v[200:203]
SA s85,s38,0
R a[112:115],v7,61440
R a[116:119],v7,62464
M v[200:203],a[72:75],v[48:51],v[200:203]
buffer_load_dwordx4 v0, s[12:15], s85 offen offset:0 lds
M v[208:211],a[80:83],v[48:51],v[208:211]
SA s85,s38,6144
v_cndmask_b32 v118, v36, v8, s[70:71]
AF v26,v22,v26
M v[208:211],a[84:87],v[56:59],v[208:211]
R a[120:123],v7,63488
R a[124:127],v7,64512
M v[212:215],a[84:87],v[60:63],v[212:215]
buffer_load_dwordx4 v0, s[12:15], s85 offen offset:1024 lds
M v[212:215],a[80:83],v[52:55],v[212:215]
SA s85,s38,12288
v_cndmask_b32 v119, v36, v8, s[72:73]
C v42,v22,v23
M v[220:223],a[88:91],v[52:55],v[220:223]
s_cmp_gt_u32 s20, 0
E v20,v70
M v[220:223],a[92:95],v[60:63],v[220:223]
s_cselect_b64 s[82:83], -1, 0
buffer_load_dwordx4 v0, s[12:15], s85 offen offset:2048 lds
M v[216:219],a[92:95],v[56:59],v[216:219]
s_waitcnt vmcnt(20) lgkmcnt(0)
E v21,v71
M v[216:219],a[88:91],v[48:51],v[216:219]
s_barrier
M v[224:227],a[96:99],v[48:51],v[224:227]
SA s85,s38,18432
R a[64:67],v2,0
R a[68:71],v2,1024
M v[224:227],a[100:103],v[56:59],v[224:227]
s_cmp_eq_u32 s20, 0
buffer_load_dwordx4 v0, s[12:15], s85 offen offset:3072 lds
M v[228:231],a[100:103],v[60:63],v[228:231]
s_cselect_b64 s[74:75], s[16:17], s[82:83]
AF v26,v23,v26
AF v26,v24,v26
M v[228:231],a[96:99],v[52:55],v[228:231]
s_cselect_b64 s[76:77], s[18:19], s[82:83]
R a[72:75],v2,2048
R a[76:79],v2,3072
M v[236:239],a[104:107],v[52:55],v[236:239]
s_cselect_b64 s[78:79], s[48:49], s[82:83]
E v22,v76
M v[236:239],a[108:111],v[60:63],v[236:239]
s_cselect_b64 s[80:81], s[50:51], s[82:83]
v_cndmask_b32 v124, v36, v8, s[74:75]
v_cndmask_b32 v125, v36, v8, s[76:77]
M v[232:235],a[108:111],v[56:59],v[232:235]
SA m0,s28,102400
R a[80:83],v2,4096
R a[84:87],v2,5120
M v[232:235],a[104:107],v[48:51],v[232:235]
SA s85,s38,28672
buffer_load_dwordx4 v0, s[12:15], s85 offen offset:0 lds
M v[240:243],a[112:115],v[48:51],v[240:243]
SA s85,s38,34816
v_cndmask_b32 v126, v36, v8, s[78:79]
v_cndmask_b32 v127, v36, v8, s[80:81]
M v[240:243],a[116:119],v[56:59],v[240:243]
R a[88:91],v2,6144
R a[92:95],v2,7168
M v[244:247],a[116:119],v[60:63],v[244:247]
buffer_load_dwordx4 v0, s[12:15], s85 offen offset:1024 lds
M v[244:247],a[112:115],v[52:55],v[244:247]
SA s85,s38,40960
E v23,v77
M v[252:255],a[120:123],v[52:55],v[252:255]
buffer_load_dwordx4 v0, s[12:15], s85 offen offset:2048 lds
M v[252:255],a[124:127],v[60:63],v[252:255]
SA s85,s38,47104
C v43,v24,v25
AF v26,v25,v26
M v[248:251],a[124:127],v[56:59],v[248:251]
s_waitcnt lgkmcnt(0)
E v24,v78
M v[248:251],a[120:123],v[48:51],v[248:251]
buffer_load_dwordx4 v0, s[12:15], s85 offen offset:3072 lds
SA s38,s38,128
AF v27,v18,v19
C v44,v18,v19
AF v27,v20,v27
C v45,v20,v21
AF v27,v21,v27
E v25,v79
AF v27,v22,v27
C v46,v22,v23
AF v27,v23,v27
AF v27,v24,v27
C v47,v24,v25
AF v27,v25,v27
M v[100:103],a[64:67],a[32:35],v[100:103]
R a[96:99],v2,8192
R a[100:103],v2,9216
M v[100:103],a[68:71],a[36:39],v[100:103]
R a[104:107],v2,10240
R a[108:111],v2,11264
M v[100:103],a[72:75],a[40:43],v[100:103]
R a[112:115],v2,12288
R a[116:119],v2,13312
M v[100:103],a[76:79],a[44:47],v[100:103]
R a[120:123],v2,14336
R a[124:127],v2,15360
M v[100:103],a[80:83],a[48:51],v[100:103]
v_add_u32 v8, 0x20000, v7
M v[100:103],a[84:87],a[52:55],v[100:103]
SA m0,s28,32768
E v18,v80
M v[100:103],a[88:91],a[56:59],v[100:103]
SA s85,s38,0
buffer_load_dwordx4 v0, s[12:15], s85 offen offset:0 lds
M v[100:103],a[92:95],a[60:63],v[100:103]
s_waitcnt lgkmcnt(0)
E v19,v81
M v[108:111],a[96:99],a[32:35],v[108:111]
SA s85,s38,6144
R a[64:67],v2,16384
R a[68:71],v2,17408
M v[108:111],a[100:103],a[36:39],v[108:111]
R a[72:75],v2,18432
R a[76:79],v2,19456
M v[108:111],a[104:107],a[40:43],v[108:111]
R a[80:83],v2,20480
R a[84:87],v2,21504
M v[108:111],a[108:111],a[44:47],v[108:111]
R a[88:91],v2,22528
R a[92:95],v2,23552
M v[108:111],a[112:115],a[48:51],v[108:111]
buffer_load_dwordx4 v0, s[12:15], s85 offen offset:1024 lds
M v[108:111],a[116:119],a[52:55],v[108:111]
SA s85,s38,12288
E v20,v82
M v[108:111],a[120:123],a[56:59],v[108:111]
buffer_load_dwordx4 v0, s[12:15], s85 offen offset:2048 lds
M v[108:111],a[124:127],a[60:63],v[108:111]
s_waitcnt lgkmcnt(0)
E v21,v83
M v[116:119],a[64:67],a[32:35],v[116:119]
SA s85,s38,18432
R a[96:99],v2,24576
R a[100:103],v2,25600
M v[116:119],a[68:71],a[36:39],v[116:119]
R a[104:107],v2,26624
R a[108:111],v2,27648
M v[116:119],a[72:75],a[40:43],v[116:119]
R a[112:115],v2,28672
R a[116:119],v2,29696
M v[116:119],a[76:79],a[44:47],v[116:119]
R a[120:123],v2,30720
R a[124:127],v2,31744
M v[116:119],a[80:83],a[48:51],v[116:119]
buffer_load_dwordx4 v0, s[12:15], s85 offen offset:3072 lds
M v[116:119],a[84:87],a[52:55],v[116:119]
buffer_load_dword v6, off, s[8:11], s47 sc1
M v[116:119],a[88:91],a[56:59],v[116:119]
s_waitcnt vmcnt(21) lgkmcnt(0)
E v22,v88
M v[116:119],a[92:95],a[60:63],v[116:119]
s_barrier
M v[124:127],a[96:99],a[32:35],v[124:127]
R a[64:67],v7,0
R a[68:71],v7,1024
M v[124:127],a[100:103],a[36:39],v[124:127]
R a[72:75],v7,2048
R a[76:79],v7,3072
M v[124:127],a[104:107],a[40:43],v[124:127]
R a[80:83],v7,4096
R a[84:87],v7,5120
M v[124:127],a[108:111],a[44:47],v[124:127]
R a[88:91],v7,6144
R a[92:95],v7,7168
M v[124:127],a[112:115],a[48:51],v[124:127]
E v23,v89
M v[124:127],a[116:119],a[52:55],v[124:127]
E v24,v90
M v[124:127],a[120:123],a[56:59],v[124:127]
s_waitcnt lgkmcnt(0)
E v25,v91
M v[124:127],a[124:127],a[60:63],v[124:127]
AF v26,v18,v26
C v56,v18,v19
AF v26,v19,v26
AF v26,v20,v26
C v57,v20,v21
AF v26,v21,v26
AF v26,v22,v26
C v58,v22,v23
AF v26,v23,v26
E v18,v84
E v19,v85
AF v26,v24,v26
C v59,v24,v25
AF v26,v25,v26
E v20,v86
E v21,v87
AF v27,v18,v27
C v60,v18,v19
AF v27,v19,v27
E v22,v92
E v23,v93
AF v27,v20,v27
C v61,v20,v21
AF v27,v21,v27
E v24,v94
E v25,v95
AF v27,v22,v27
C v62,v22,v23
AF v27,v23,v27
AF v27,v24,v27
C v63,v24,v25
AF v27,v25,v27
v_max_f32 v10, v26, v27
v_cmp_lt_f32 vcc, s31, v10
s_nop 0
s_cbranch_vccnz L_std3n
L_rtd3n:
M v[128:131],a[64:67],v[40:43],v[128:131]
R a[96:99],v7,8192
R a[100:103],v7,9216
M v[128:131],a[68:71],v[56:59],v[128:131]
v_or_b32 v9, s35, v7
s_waitcnt vmcnt(0)
v_cmp_ne_u32 vcc, 1, v6
M v[132:135],a[68:71],v[60:63],v[132:135]
s_cbranch_vccnz L_fps
L_fpr:
E v18,v100
M v[132:135],a[64:67],v[44:47],v[132:135]
R a[104:107],v7,10240
R a[108:111],v7,11264
M v[140:143],a[72:75],v[44:47],v[140:143]
buffer_load_dwordx4 v[14:17], v9, s[8:11], s90 offen sc1
M v[140:143],a[76:79],v[60:63],v[140:143]
E v19,v101
M v[136:139],a[76:79],v[56:59],v[136:139]
R a[112:115],v7,12288
R a[116:119],v7,13312
M v[136:139],a[72:75],v[40:43],v[136:139]
buffer_load_dwordx4 a[160:163], v9, s[8:11], s88 offen offset:0 sc1
M v[144:147],a[80:83],v[40:43],v[144:147]
E v20,v102
M v[144:147],a[84:87],v[56:59],v[144:147]
R a[120:123],v7,14336
R a[124:127],v7,15360
M v[148:151],a[84:87],v[60:63],v[148:151]
buffer_load_dwordx4 a[128:131], v9, s[8:11], s86 offen offset:0 sc1
M v[148:151],a[80:83],v[44:47],v[148:151]
E v21,v103
M v[156:159],a[88:91],v[44:47],v[156:159]
AF v30,v26,v30
AF v31,v27,v31
M v[156:159],a[92:95],v[60:63],v[156:159]
buffer_load_dwordx4 a[164:167], v9, s[8:11], s88 offen offset:1024 sc1
M v[152:155],a[92:95],v[56:59],v[152:155]
AF v29,v18,v19
C v52,v18,v19
M v[152:155],a[88:91],v[40:43],v[152:155]
s_waitcnt lgkmcnt(0)
E v22,v108
M v[160:163],a[96:99],v[40:43],v[160:163]
R a[64:67],v7,16384
R a[68:71],v7,17408
M v[160:163],a[100:103],v[56:59],v[160:163]
buffer_load_dwordx4 a[132:135], v9, s[8:11], s86 offen offset:1024 sc1
M v[164:167],a[100:103],v[60:63],v[164:167]
E v23,v109
M v[164:167],a[96:99],v[44:47],v[164:167]
R a[72:75],v7,18432
R a[76:79],v7,19456
M v[172:175],a[104:107],v[44:47],v[172:175]
buffer_load_dwordx4 a[168:171], v9, s[8:11], s88 offen offset:2048 sc1
M v[172:175],a[108:111],v[60:63],v[172:175]
AF v29,v20,v29
C v53,v20,v21
M v[168:171],a[108:111],v[56:59],v[168:171]
R a[80:83],v7,20480
R a[84:87],v7,21504
M v[168:171],a[104:107],v[40:43],v[168:171]
buffer_load_dwordx4 a[136:139], v9, s[8:11], s86 offen offset:2048 sc1
M v[176:179],a[112:115],v[40:43],v[176:179]
E v24,v110
M v[176:179],a[116:119],v[56:59],v[176:179]
R a[88:91],v7,22528
R a[92:95],v7,23552
M v[180:183],a[116:119],v[60:63],v[180:183]
buffer_load_dwordx4 a[172:175], v9, s[8:11], s88 offen offset:3072 sc1
M v[180:183],a[112:115],v[44:47],v[180:183]
E v25,v111
M v[188:191],a[120:123],v[44:47],v[188:191]
AF v29,v21,v29
AF v29,v22,v29
M v[188:191],a[124:127],v[60:63],v[188:191]
buffer_load_dwordx4 a[140:143], v9, s[8:11], s86 offen offset:3072 sc1
M v[184:187],a[124:127],v[56:59],v[184:187]
E v18,v116
M v[184:187],a[120:123],v[40:43],v[184:187]
s_waitcnt lgkmcnt(0)
C v54,v22,v23
AF v29,v23,v29
M v[192:195],a[64:67],v[40:43],v[192:195]
R a[96:99],v7,24576
R a[100:103],v7,25600
M v[192:195],a[68:71],v[56:59],v[192:195]
buffer_load_dwordx4 a[176:179], v9, s[8:11], s89 offen offset:0 sc1
M v[196:199],a[68:71],v[60:63],v[196:199]
E v19,v117
M v[196:199],a[64:67],v[44:47],v[196:199]
R a[104:107],v7,26624
R a[108:111],v7,27648
M v[204:207],a[72:75],v[44:47],v[204:207]
buffer_load_dwordx4 a[144:147], v9, s[8:11], s87 offen offset:0 sc1
M v[204:207],a[76:79],v[60:63],v[204:207]
E v20,v118
M v[200:203],a[76:79],v[56:59],v[200:203]
R a[112:115],v7,28672
R a[116:119],v7,29696
M v[200:203],a[72:75],v[40:43],v[200:203]
buffer_load_dwordx4 a[180:183], v9, s[8:11], s89 offen offset:1024 sc1
M v[208:211],a[80:83],v[40:43],v[208:211]
AF v29,v24,v29
C v55,v24,v25
M v[208:211],a[84:87],v[56:59],v[208:211]
R a[120:123],v7,30720
R a[124:127],v7,31744
M v[212:215],a[84:87],v[60:63],v[212:215]
buffer_load_dwordx4 a[148:151], v9, s[8:11], s87 offen offset:1024 sc1
M v[212:215],a[80:83],v[44:47],v[212:215]
E v21,v119
M v[220:223],a[88:91],v[44:47],v[220:223]
AF v29,v25,v29
AF v29,v18,v29
M v[220:223],a[92:95],v[60:63],v[220:223]
buffer_load_dwordx4 a[184:187], v9, s[8:11], s89 offen offset:2048 sc1
M v[216:219],a[92:95],v[56:59],v[216:219]
s_waitcnt lgkmcnt(0)
E v22,v124
M v[216:219],a[88:91],v[40:43],v[216:219]
s_barrier
M v[224:227],a[96:99],v[40:43],v[224:227]
R a[64:67],v8,0
R a[68:71],v8,1024
M v[224:227],a[100:103],v[56:59],v[224:227]
buffer_load_dwordx4 a[152:155], v9, s[8:11], s87 offen offset:2048 sc1
M v[228:231],a[100:103],v[60:63],v[228:231]
E v23,v125
M v[228:231],a[96:99],v[44:47],v[228:231]
R a[72:75],v8,2048
R a[76:79],v8,3072
M v[236:239],a[104:107],v[44:47],v[236:239]
buffer_load_dwordx4 a[188:191], v9, s[8:11], s89 offen offset:3072 sc1
M v[236:239],a[108:111],v[60:63],v[236:239]
E v24,v126
M v[232:235],a[108:111],v[56:59],v[232:235]
R a[80:83],v8,4096
R a[84:87],v8,5120
M v[232:235],a[104:107],v[40:43],v[232:235]
buffer_load_dwordx4 a[156:159], v9, s[8:11], s87 offen offset:3072 sc1
M v[240:243],a[112:115],v[40:43],v[240:243]
E v25,v127
M v[240:243],a[116:119],v[56:59],v[240:243]
R a[88:91],v8,6144
R a[92:95],v8,7168
M v[244:247],a[116:119],v[60:63],v[244:247]
C v48,v18,v19
AF v29,v19,v29
M v[244:247],a[112:115],v[44:47],v[244:247]
AF v29,v20,v29
C v49,v20,v21
M v[252:255],a[120:123],v[44:47],v[252:255]
AF v29,v21,v29
AF v29,v22,v29
M v[252:255],a[124:127],v[60:63],v[252:255]
C v50,v22,v23
AF v29,v23,v29
M v[248:251],a[124:127],v[56:59],v[248:251]
s_waitcnt lgkmcnt(0)
AF v29,v24,v29
C v51,v24,v25
M v[248:251],a[120:123],v[40:43],v[248:251]
AF v29,v25,v29
v_cmp_lt_f32 vcc, s31, v29
s_nop 0
s_cbranch_vccnz L_std4n
L_rtd4n:
s_waitcnt vmcnt(16)
v_cmp_neq_f32 vcc, v32, v14
v_cmp_neq_f32 s[64:65], v36, v15
s_cmp_eq_u32 s35, 0
s_cselect_b64 s[66:67], -1, 0
s_or_b64 vcc, vcc, s[64:65]
s_and_b64 vcc, vcc, s[66:67]
s_cbranch_vccnz L_stc
L_rtc:
M v[132:135],a[64:67],v[52:55],v[132:135]
R a[96:99],v8,8192
R a[100:103],v8,9216
M v[132:135],a[68:71],v[48:51],v[132:135]
s_waitcnt vmcnt(12)
AF v30,v16,v30
AF v31,v17,v31
M v[132:135],a[246:249],a[160:163],v[132:135]
SA m0,s28,36864
AF v31,v29,v31
v_mov_b32 v10, v30
M v[128:131],a[246:249],a[128:131],v[128:131]
SA s85,s38,28672
R a[104:107],v8,10240
R a[108:111],v8,11264
M v[140:143],a[72:75],v[52:55],v[140:143]
buffer_load_dwordx4 v0, s[12:15], s85 offen offset:0 lds
M v[140:143],a[76:79],v[48:51],v[140:143]
SA s85,s38,34816
v_mov_b32 v11, v31
M v[140:143],a[244:247],a[160:163],v[140:143]
R a[112:115],v8,12288
R a[116:119],v8,13312
M v[136:139],a[244:247],a[128:131],v[136:139]
v_permlane16_swap_b32 v10, v30
M v[148:151],a[80:83],v[52:55],v[148:151]
v_permlane16_swap_b32 v11, v31
M v[148:151],a[84:87],v[48:51],v[148:151]
R a[120:123],v8,14336
R a[124:127],v8,15360
M v[148:151],a[246:249],a[164:167],v[148:151]
buffer_load_dwordx4 v0, s[12:15], s85 offen offset:1024 lds
M v[144:147],a[246:249],a[132:135],v[144:147]
SA s85,s38,40960
AF v30,v10,v30
AF v31,v11,v31
M v[156:159],a[88:91],v[52:55],v[156:159]
v_mov_b32 v10, v30
v_mov_b32 v11, v31
M v[156:159],a[92:95],v[48:51],v[156:159]
buffer_load_dwordx4 v0, s[12:15], s85 offen offset:2048 lds
M v[156:159],a[244:247],a[164:167],v[156:159]
s_waitcnt vmcnt(11)
v_permlane32_swap_b32 v10, v30
M v[152:155],a[244:247],a[132:135],v[152:155]
s_waitcnt lgkmcnt(0)
v_permlane32_swap_b32 v11, v31
M v[164:167],a[96:99],v[52:55],v[164:167]
SA s85,s38,47104
R a[64:67],v8,16384
R a[68:71],v8,17408
M v[164:167],a[100:103],v[48:51],v[164:167]
buffer_load_dwordx4 v0, s[12:15], s85 offen offset:3072 lds
M v[164:167],a[246:249],a[168:171],v[164:167]
SA s38,s38,128
C v132,v132,v133
C v133,v134,v135
M v[160:163],a[246:249],a[136:139],v[160:163]
SA m0,s28,65536
R a[72:75],v8,18432
R a[76:79],v8,19456
AF v30,v10,v30
AF v31,v11,v31
v_rcp_f32 v5, v30
v_rcp_f32 v6, v31
M v[172:175],a[104:107],v[52:55],v[172:175]
SA s85,s38,0
buffer_load_dwordx4 v0, s[12:15], s85 offen offset:0 lds
M v[172:175],a[108:111],v[48:51],v[172:175]
SA s85,s38,6144
C v134,v140,v141
C v135,v142,v143
M v[172:175],a[244:247],a[168:171],v[172:175]
R a[80:83],v8,20480
R a[84:87],v8,21504
M v[168:171],a[244:247],a[136:139],v[168:171]
buffer_load_dwordx4 v0, s[12:15], s85 offen offset:1024 lds
M v[180:183],a[112:115],v[52:55],v[180:183]
SA s85,s38,12288
C v128,v128,v129
C v129,v130,v131
M v[180:183],a[116:119],v[48:51],v[180:183]
R a[88:91],v8,22528
R a[92:95],v8,23552
M v[180:183],a[246:249],a[172:175],v[180:183]
buffer_load_dwordx4 v0, s[12:15], s85 offen offset:2048 lds
M v[176:179],a[246:249],a[140:143],v[176:179]
SA s85,s38,18432
C v130,v136,v137
C v131,v138,v139
M v[188:191],a[120:123],v[52:55],v[188:191]
C v148,v148,v149
C v149,v150,v151
M v[188:191],a[124:127],v[48:51],v[188:191]
buffer_load_dwordx4 v0, s[12:15], s85 offen offset:3072 lds
M v[188:191],a[244:247],a[172:175],v[188:191]
s_waitcnt vmcnt(12)
C v150,v156,v157
C v151,v158,v159
M v[184:187],a[244:247],a[140:143],v[184:187]
s_waitcnt lgkmcnt(0)
C v144,v144,v145
C v145,v146,v147
M v[196:199],a[64:67],v[52:55],v[196:199]
SA m0,s28,69632
R a[96:99],v8,24576
R a[100:103],v8,25600
M v[196:199],a[68:71],v[48:51],v[196:199]
SA s85,s38,28672
buffer_load_dwordx4 v0, s[12:15], s85 offen offset:0 lds
M v[196:199],a[246:249],a[176:179],v[196:199]
SA s85,s38,34816
C v146,v152,v153
C v147,v154,v155
M v[192:195],a[246:249],a[144:147],v[192:195]
R a[104:107],v8,26624
R a[108:111],v8,27648
M v[204:207],a[72:75],v[52:55],v[204:207]
buffer_load_dwordx4 v0, s[12:15], s85 offen offset:1024 lds
M v[204:207],a[76:79],v[48:51],v[204:207]
SA s85,s38,40960
v_lshrrev_b32 v16, 4, v7
v_lshrrev_b32 v14, 2, v16
M v[204:207],a[244:247],a[176:179],v[204:207]
R a[112:115],v8,28672
R a[116:119],v8,29696
M v[200:203],a[244:247],a[144:147],v[200:203]
buffer_load_dwordx4 v0, s[12:15], s85 offen offset:2048 lds
M v[212:215],a[80:83],v[52:55],v[212:215]
SA s85,s38,47104
v_lshlrev_b32 v14, 7, v14
v_and_b32 v15, 3, v16
M v[212:215],a[84:87],v[48:51],v[212:215]
R a[120:123],v8,30720
R a[124:127],v8,31744
M v[212:215],a[246:249],a[180:183],v[212:215]
buffer_load_dwordx4 v0, s[12:15], s85 offen offset:3072 lds
M v[208:211],a[246:249],a[148:151],v[208:211]
SA s38,s38,128
v_lshl_add_u32 v14, v15, 3, v14
C v164,v164,v165
M v[220:223],a[88:91],v[52:55],v[220:223]
C v165,v166,v167
C v166,v172,v173
M v[220:223],a[92:95],v[48:51],v[220:223]
s_waitcnt vmcnt(12)
C v167,v174,v175
C v160,v160,v161
M v[220:223],a[244:247],a[180:183],v[220:223]
s_waitcnt lgkmcnt(0)
v_bfe_u32 v15, v16, 3, 2
v_lshl_add_u32 v18, v15, 5, v14
v_xor_b32 v19, 32, v18
v_xor_b32 v20, 64, v18
v_xor_b32 v21, 0x60, v18
v_add_u32 v22, 0x10000, v18
v_add_u32 v23, 0x10000, v19
v_add_u32 v24, 0x10000, v20
v_add_u32 v25, 0x10000, v21
M v[216:219],a[244:247],a[148:151],v[216:219]
s_barrier
M v[228:231],a[96:99],v[52:55],v[228:231]
s_nop 0
T a[64:65],v22,32768
T a[66:67],v22,34816
M v[228:231],a[100:103],v[48:51],v[228:231]
T a[68:69],v22,36864
T a[70:71],v22,38912
M v[228:231],a[246:249],a[184:187],v[228:231]
C v161,v162,v163
C v162,v168,v169
M v[224:227],a[246:249],a[152:155],v[224:227]
T a[72:73],v22,40960
T a[74:75],v22,43008
M v[236:239],a[104:107],v[52:55],v[236:239]
T a[76:77],v22,45056
T a[78:79],v22,47104
M v[236:239],a[108:111],v[48:51],v[236:239]
C v163,v170,v171
C v180,v180,v181
M v[236:239],a[244:247],a[184:187],v[236:239]
T a[80:81],v22,49152
T a[82:83],v22,51200
M v[232:235],a[244:247],a[152:155],v[232:235]
T a[84:85],v22,53248
T a[86:87],v22,55296
M v[244:247],a[112:115],v[52:55],v[244:247]
C v181,v182,v183
C v182,v188,v189
M v[244:247],a[116:119],v[48:51],v[244:247]
T a[88:89],v22,57344
T a[90:91],v22,59392
M v[244:247],a[246:249],a[188:191],v[244:247]
T a[92:93],v22,61440
T a[94:95],v22,63488
M v[240:243],a[246:249],a[156:159],v[240:243]
C v183,v190,v191
C v176,v176,v177
M v[252:255],a[120:123],v[52:55],v[252:255]
C v177,v178,v179
C v178,v184,v185
M v[252:255],a[124:127],v[48:51],v[252:255]
C v179,v186,v187
C v196,v196,v197
M v[252:255],a[244:247],a[188:191],v[252:255]
s_waitcnt lgkmcnt(0)
C v197,v198,v199
C v198,v204,v205
M v[248:251],a[244:247],a[156:159],v[248:251]
C v199,v206,v207
C v192,v192,v193
C v193,v194,v195
C v194,v200,v201
C v195,v202,v203
C v212,v212,v213
C v213,v214,v215
C v214,v220,v221
C v215,v222,v223
C v208,v208,v209
C v209,v210,v211
C v210,v216,v217
C v211,v218,v219
C v228,v228,v229
C v229,v230,v231
C v230,v236,v237
C v231,v238,v239
C v224,v224,v225
C v225,v226,v227
C v226,v232,v233
C v227,v234,v235
C v244,v244,v245
C v245,v246,v247
C v246,v252,v253
C v247,v254,v255
C v240,v240,v241
C v241,v242,v243
C v242,v248,v249
C v243,v250,v251
M v[64:67],a[64:67],v[128:131],0
s_sub_u32 s64, 15, s42
T a[96:97],v23,32768
T a[98:99],v23,34816
M v[64:67],a[68:71],v[144:147],v[64:67]
s_min_u32 s64, s64, s42
T a[100:101],v23,36864
T a[102:103],v23,38912
M v[64:67],a[72:75],v[160:163],v[64:67]
s_mul_i32 s45, s64, 8704
M v[64:67],a[76:79],v[176:179],v[64:67]
s_lshl_b32 s64, s41, 2
T a[104:105],v23,40960
T a[106:107],v23,43008
M v[64:67],a[80:83],v[192:195],v[64:67]
SA s45,s45,s64
T a[108:109],v23,45056
T a[110:111],v23,47104
M v[64:67],a[84:87],v[208:211],v[64:67]
s_lshl_b32 s64, s20, 8
M v[64:67],a[88:91],v[224:227],v[64:67]
SA s45,s45,s64
T a[112:113],v23,49152
T a[114:115],v23,51200
M v[64:67],a[92:95],v[240:243],v[64:67]
SA s45,s45,104992768
T a[116:117],v23,53248
T a[118:119],v23,55296
M v[68:71],a[92:95],v[244:247],0
s_mov_b32 s64, 1024
M v[68:71],a[88:91],v[228:231],v[68:71]
s_mov_b32 s66, 4096
T a[120:121],v23,57344
T a[122:123],v23,59392
M v[68:71],a[84:87],v[212:215],v[68:71]
s_cmp_lt_u32 s42, 8
T a[124:125],v23,61440
T a[126:127],v23,63488
M v[68:71],a[80:83],v[196:199],v[68:71]
s_cselect_b32 s64, 4352, s64
M v[68:71],a[76:79],v[180:183],v[68:71]
s_cselect_b32 s65, 0, 64
M v[68:71],a[72:75],v[164:167],v[68:71]
s_cselect_b32 s66, 536870912, s66
M v[68:71],a[68:71],v[148:151],v[68:71]
SA s3,s45,s64
M v[68:71],a[64:67],v[132:135],v[68:71]
s_waitcnt lgkmcnt(0)
M v[72:75],a[96:99],v[128:131],0
SA s45,s45,s65
T a[64:65],v24,32768
T a[66:67],v24,34816
M v[72:75],a[100:103],v[144:147],v[72:75]
SA m0,s28,0
T a[68:69],v24,36864
T a[70:71],v24,38912
M v[72:75],a[104:107],v[160:163],v[72:75]
SA s85,s38,0
buffer_load_dwordx4 v0, s[12:15], s85 offen offset:0 lds
M v[72:75],a[108:111],v[176:179],v[72:75]
SA s85,s38,6144
T a[72:73],v24,40960
T a[74:75],v24,43008
M v[72:75],a[112:115],v[192:195],v[72:75]
SA s29,s33,0
T a[76:77],v24,45056
T a[78:79],v24,47104
M v[72:75],a[116:119],v[208:211],v[72:75]
SA s30,s33,14336
buffer_load_dwordx4 v0, s[12:15], s85 offen offset:1024 lds
M v[72:75],a[120:123],v[224:227],v[72:75]
SA s85,s38,12288
T a[80:81],v24,49152
T a[82:83],v24,51200
M v[72:75],a[124:127],v[240:243],v[72:75]
T a[84:85],v24,53248
T a[86:87],v24,55296
M v[76:79],a[124:127],v[244:247],0
buffer_load_dwordx4 v0, s[12:15], s85 offen offset:2048 lds
M v[76:79],a[120:123],v[228:231],v[76:79]
SA s85,s38,18432
T a[88:89],v24,57344
T a[90:91],v24,59392
M v[76:79],a[116:119],v[212:215],v[76:79]
T a[92:93],v24,61440
T a[94:95],v24,63488
M v[76:79],a[112:115],v[196:199],v[76:79]
buffer_load_dwordx4 v0, s[12:15], s85 offen offset:3072 lds
M v[76:79],a[108:111],v[180:183],v[76:79]
SA m0,s28,4096
v_lshrrev_b32 v17, 5, v7
v_min_u32 v15, 1, v17
M v[76:79],a[104:107],v[164:167],v[76:79]
SA s85,s38,28672
buffer_load_dwordx4 v0, s[12:15], s85 offen offset:0 lds
M v[76:79],a[100:103],v[148:151],v[76:79]
SA s85,s38,34816
v_lshlrev_b32 v14, 3, v7
v_lshl_or_b32 v16, v15, 29, v14
M v[76:79],a[96:99],v[132:135],v[76:79]
s_waitcnt lgkmcnt(0)
buffer_load_dwordx4 v0, s[12:15], s85 offen offset:1024 lds
M v[80:83],a[64:67],v[128:131],0
SA s85,s38,40960
T a[96:97],v25,32768
T a[98:99],v25,34816
M v[80:83],a[68:71],v[144:147],v[80:83]
T a[100:101],v25,36864
T a[102:103],v25,38912
M v[80:83],a[72:75],v[160:163],v[80:83]
buffer_load_dwordx4 v0, s[12:15], s85 offen offset:2048 lds
M v[80:83],a[76:79],v[176:179],v[80:83]
SA s85,s38,47104
T a[104:105],v25,40960
T a[106:107],v25,43008
M v[80:83],a[80:83],v[192:195],v[80:83]
T a[108:109],v25,45056
T a[110:111],v25,47104
M v[80:83],a[84:87],v[208:211],v[80:83]
buffer_load_dwordx4 v0, s[12:15], s85 offen offset:3072 lds
M v[80:83],a[88:91],v[224:227],v[80:83]
SA s38,s38,128
T a[112:113],v25,49152
T a[114:115],v25,51200
M v[80:83],a[92:95],v[240:243],v[80:83]
SA m0,s28,131072
T a[116:117],v25,53248
T a[118:119],v25,55296
M v[84:87],a[92:95],v[244:247],0
SA s85,s38,0
buffer_load_dwordx4 v0, s[12:15], s85 offen offset:0 lds
M v[84:87],a[88:91],v[228:231],v[84:87]
SA s85,s38,6144
T a[120:121],v25,57344
T a[122:123],v25,59392
M v[84:87],a[84:87],v[212:215],v[84:87]
T a[124:125],v25,61440
T a[126:127],v25,63488
M v[84:87],a[80:83],v[196:199],v[84:87]
buffer_load_dwordx4 v0, s[12:15], s85 offen offset:1024 lds
M v[84:87],a[76:79],v[180:183],v[84:87]
SA s85,s38,12288
v_cmp_eq_u32 vcc, 1, v17
v_add_u32 v14, s66, v14
M v[84:87],a[72:75],v[164:167],v[84:87]
buffer_load_dwordx4 v0, s[12:15], s85 offen offset:2048 lds
M v[84:87],a[68:71],v[148:151],v[84:87]
s_waitcnt vmcnt(19) lgkmcnt(0)
v_mov_b32 v15, 1
v_cndmask_b32 v17, v16, v14, vcc
M v[84:87],a[64:67],v[132:135],v[84:87]
s_barrier
M v[88:91],a[96:99],v[128:131],0
SA s85,s38,18432
T a[64:65],v18,32768
T a[66:67],v18,34816
M v[88:91],a[100:103],v[144:147],v[88:91]
T a[68:69],v18,36864
T a[70:71],v18,38912
M v[88:91],a[104:107],v[160:163],v[88:91]
buffer_load_dwordx4 v0, s[12:15], s85 offen offset:3072 lds
M v[88:91],a[108:111],v[176:179],v[88:91]
SA m0,s28,135168
T a[72:73],v18,40960
T a[74:75],v18,43008
M v[88:91],a[112:115],v[192:195],v[88:91]
SA s85,s38,28672
T a[76:77],v18,45056
T a[78:79],v18,47104
M v[88:91],a[116:119],v[208:211],v[88:91]
buffer_load_dwordx4 v0, s[12:15], s85 offen offset:0 lds
M v[88:91],a[120:123],v[224:227],v[88:91]
SA s85,s38,34816
T a[80:81],v18,49152
T a[82:83],v18,51200
M v[88:91],a[124:127],v[240:243],v[88:91]
T a[84:85],v18,53248
T a[86:87],v18,55296
M v[92:95],a[124:127],v[244:247],0
buffer_load_dwordx4 v0, s[12:15], s85 offen offset:1024 lds
M v[92:95],a[120:123],v[228:231],v[92:95]
SA s85,s38,40960
T a[88:89],v18,57344
T a[90:91],v18,59392
M v[92:95],a[116:119],v[212:215],v[92:95]
T a[92:93],v18,61440
T a[94:95],v18,63488
M v[92:95],a[112:115],v[196:199],v[92:95]
buffer_load_dwordx4 v0, s[12:15], s85 offen offset:2048 lds
M v[92:95],a[108:111],v[180:183],v[92:95]
SA s85,s38,47104
v_add_u32 v40, 0x20000, v18
v_add_u32 v41, 0x20000, v19
M v[92:95],a[104:107],v[164:167],v[92:95]
buffer_load_dwordx4 v0, s[12:15], s85 offen offset:3072 lds
M v[92:95],a[100:103],v[148:151],v[92:95]
s_waitcnt lgkmcnt(0)
v_add_u32 v42, 0x20000, v20
v_add_u32 v43, 0x20000, v21
M v[92:95],a[96:99],v[132:135],v[92:95]
SA s38,s38,128
MF v64,v5,v64
MF v65,v5,v65
MF v66,v5,v66
MF v67,v5,v67
MF v72,v5,v72
MF v73,v5,v73
MF v74,v5,v74
MF v75,v5,v75
C v64,v64,v65
C v65,v66,v67
C v66,v72,v73
C v67,v74,v75
buffer_store_dwordx4 v[64:67], v7, s[8:11], s29 offen offset:0 sc1
MF v68,v6,v68
MF v69,v6,v69
MF v70,v6,v70
MF v71,v6,v71
MF v76,v6,v76
MF v77,v6,v77
MF v78,v6,v78
MF v79,v6,v79
C v68,v68,v69
C v69,v70,v71
C v70,v76,v77
C v71,v78,v79
buffer_store_dwordx4 v[68:71], v7, s[8:11], s30 offen offset:0 sc1
M v[96:99],a[64:67],v[128:131],0
s_nop 0
T a[96:97],v19,32768
T a[98:99],v19,34816
M v[96:99],a[68:71],v[144:147],v[96:99]
SA m0,s28,98304
T a[100:101],v19,36864
T a[102:103],v19,38912
M v[96:99],a[72:75],v[160:163],v[96:99]
SA s85,s38,0
buffer_load_dwordx4 v0, s[12:15], s85 offen offset:0 lds
M v[96:99],a[76:79],v[176:179],v[96:99]
s_nop 0
T a[104:105],v19,40960
T a[106:107],v19,43008
M v[96:99],a[80:83],v[192:195],v[96:99]
T a[108:109],v19,45056
T a[110:111],v19,47104
M v[96:99],a[84:87],v[208:211],v[96:99]
SA s85,s38,6144
MF v80,v5,v80
MF v81,v5,v81
M v[96:99],a[88:91],v[224:227],v[96:99]
T a[112:113],v19,49152
T a[114:115],v19,51200
M v[96:99],a[92:95],v[240:243],v[96:99]
T a[116:117],v19,53248
T a[118:119],v19,55296
M v[100:103],a[92:95],v[244:247],0
buffer_load_dwordx4 v0, s[12:15], s85 offen offset:1024 lds
M v[100:103],a[88:91],v[228:231],v[100:103]
s_nop 0
T a[120:121],v19,57344
T a[122:123],v19,59392
M v[100:103],a[84:87],v[212:215],v[100:103]
T a[124:125],v19,61440
T a[126:127],v19,63488
M v[100:103],a[80:83],v[196:199],v[100:103]
SA s85,s38,12288
MF v82,v5,v82
MF v83,v5,v83
M v[100:103],a[76:79],v[180:183],v[100:103]
buffer_load_dwordx4 v0, s[12:15], s85 offen offset:2048 lds
M v[100:103],a[72:75],v[164:167],v[100:103]
MF v88,v5,v88
MF v89,v5,v89
M v[100:103],a[68:71],v[148:151],v[100:103]
MF v90,v5,v90
MF v91,v5,v91
M v[100:103],a[64:67],v[132:135],v[100:103]
s_waitcnt lgkmcnt(0)
C v80,v80,v81
C v81,v82,v83
M v[104:107],a[96:99],v[128:131],0
SA s85,s38,18432
T a[64:65],v20,32768
T a[66:67],v20,34816
M v[104:107],a[100:103],v[144:147],v[104:107]
T a[68:69],v20,36864
T a[70:71],v20,38912
M v[104:107],a[104:107],v[160:163],v[104:107]
buffer_load_dwordx4 v0, s[12:15], s85 offen offset:3072 lds
M v[104:107],a[108:111],v[176:179],v[104:107]
s_nop 0
T a[72:73],v20,40960
T a[74:75],v20,43008
M v[104:107],a[112:115],v[192:195],v[104:107]
T a[76:77],v20,45056
T a[78:79],v20,47104
M v[104:107],a[116:119],v[208:211],v[104:107]
SA m0,s28,102400
C v82,v88,v89
C v83,v90,v91
M v[104:107],a[120:123],v[224:227],v[104:107]
SA s85,s38,28672
T a[80:81],v20,49152
T a[82:83],v20,51200
M v[104:107],a[124:127],v[240:243],v[104:107]
T a[84:85],v20,53248
T a[86:87],v20,55296
M v[108:111],a[124:127],v[244:247],0
buffer_store_dwordx4 v[80:83], v7, s[8:11], s29 offen offset:1024 sc1
M v[108:111],a[120:123],v[228:231],v[108:111]
s_nop 0
T a[88:89],v20,57344
T a[90:91],v20,59392
M v[108:111],a[116:119],v[212:215],v[108:111]
T a[92:93],v20,61440
T a[94:95],v20,63488
M v[108:111],a[112:115],v[196:199],v[108:111]
buffer_load_dwordx4 v0, s[12:15], s85 offen offset:0 lds
M v[108:111],a[108:111],v[180:183],v[108:111]
SA s85,s38,34816
MF v84,v6,v84
MF v85,v6,v85
M v[108:111],a[104:107],v[164:167],v[108:111]
MF v86,v6,v86
MF v87,v6,v87
M v[108:111],a[100:103],v[148:151],v[108:111]
buffer_load_dwordx4 v0, s[12:15], s85 offen offset:1024 lds
M v[108:111],a[96:99],v[132:135],v[108:111]
s_waitcnt lgkmcnt(0)
MF v92,v6,v92
MF v93,v6,v93
M v[112:115],a[64:67],v[128:131],0
T a[96:97],v21,32768
T a[98:99],v21,34816
M v[112:115],a[68:71],v[144:147],v[112:115]
SA s85,s38,40960
T a[100:101],v21,36864
T a[102:103],v21,38912
M v[112:115],a[72:75],v[160:163],v[112:115]
buffer_load_dwordx4 v0, s[12:15], s85 offen offset:2048 lds
M v[112:115],a[76:79],v[176:179],v[112:115]
s_nop 0
T a[104:105],v21,40960
T a[106:107],v21,43008
M v[112:115],a[80:83],v[192:195],v[112:115]
T a[108:109],v21,45056
T a[110:111],v21,47104
M v[112:115],a[84:87],v[208:211],v[112:115]
MF v94,v6,v94
MF v95,v6,v95
M v[112:115],a[88:91],v[224:227],v[112:115]
SA s85,s38,47104
T a[112:113],v21,49152
T a[114:115],v21,51200
M v[112:115],a[92:95],v[240:243],v[112:115]
T a[116:117],v21,53248
T a[118:119],v21,55296
M v[116:119],a[92:95],v[244:247],0
buffer_load_dwordx4 v0, s[12:15], s85 offen offset:3072 lds
M v[116:119],a[88:91],v[228:231],v[116:119]
s_nop 0
T a[120:121],v21,57344
T a[122:123],v21,59392
M v[116:119],a[84:87],v[212:215],v[116:119]
T a[124:125],v21,61440
T a[126:127],v21,63488
M v[116:119],a[80:83],v[196:199],v[116:119]
C v84,v84,v85
C v85,v86,v87
M v[116:119],a[76:79],v[180:183],v[116:119]
C v86,v92,v93
C v87,v94,v95
M v[116:119],a[72:75],v[164:167],v[116:119]
SA s38,s38,128
buffer_store_dwordx4 v[84:87], v7, s[8:11], s30 offen offset:1024 sc1
M v[116:119],a[68:71],v[148:151],v[116:119]
s_waitcnt vmcnt(28) lgkmcnt(0)
M v[116:119],a[64:67],v[132:135],v[116:119]
s_barrier
M v[120:123],a[96:99],v[128:131],0
SA s29,s33,2048
T a[64:65],v22,0
T a[66:67],v22,2048
M v[120:123],a[100:103],v[144:147],v[120:123]
SA s30,s33,16384
T a[68:69],v22,4096
T a[70:71],v22,6144
M v[120:123],a[104:107],v[160:163],v[120:123]
MF v96,v5,v96
MF v97,v5,v97
M v[120:123],a[108:111],v[176:179],v[120:123]
T a[72:73],v22,8192
T a[74:75],v22,10240
M v[120:123],a[112:115],v[192:195],v[120:123]
T a[76:77],v22,12288
T a[78:79],v22,14336
M v[120:123],a[116:119],v[208:211],v[120:123]
MF v98,v5,v98
MF v99,v5,v99
M v[120:123],a[120:123],v[224:227],v[120:123]
T a[80:81],v22,16384
T a[82:83],v22,18432
M v[120:123],a[124:127],v[240:243],v[120:123]
T a[84:85],v22,20480
T a[86:87],v22,22528
M v[124:127],a[124:127],v[244:247],0
MF v104,v5,v104
MF v105,v5,v105
M v[124:127],a[120:123],v[228:231],v[124:127]
T a[88:89],v22,24576
T a[90:91],v22,26624
M v[124:127],a[116:119],v[212:215],v[124:127]
T a[92:93],v22,28672
T a[94:95],v22,30720
M v[124:127],a[112:115],v[196:199],v[124:127]
MF v106,v5,v106
MF v107,v5,v107
M v[124:127],a[108:111],v[180:183],v[124:127]
C v96,v96,v97
C v97,v98,v99
M v[124:127],a[104:107],v[164:167],v[124:127]
C v98,v104,v105
C v99,v106,v107
M v[124:127],a[100:103],v[148:151],v[124:127]
s_waitcnt lgkmcnt(0)
buffer_store_dwordx4 v[96:99], v7, s[8:11], s29 offen offset:0 sc1
M v[124:127],a[96:99],v[132:135],v[124:127]
MF v100,v6,v100
MF v101,v6,v101
MF v102,v6,v102
MF v103,v6,v103
MF v108,v6,v108
MF v109,v6,v109
MF v110,v6,v110
MF v111,v6,v111
C v100,v100,v101
C v101,v102,v103
C v102,v108,v109
C v103,v110,v111
buffer_store_dwordx4 v[100:103], v7, s[8:11], s30 offen offset:0 sc1
M v[64:67],a[64:67],v[128:131],0
s_nop 0
T a[96:97],v23,0
T a[98:99],v23,2048
M v[64:67],a[68:71],v[144:147],v[64:67]
SA m0,s28,32768
T a[100:101],v23,4096
T a[102:103],v23,6144
M v[64:67],a[72:75],v[160:163],v[64:67]
SA s85,s38,0
buffer_load_dwordx4 v0, s[12:15], s85 offen offset:0 lds
M v[64:67],a[76:79],v[176:179],v[64:67]
s_nop 0
T a[104:105],v23,8192
T a[106:107],v23,10240
M v[64:67],a[80:83],v[192:195],v[64:67]
T a[108:109],v23,12288
T a[110:111],v23,14336
M v[64:67],a[84:87],v[208:211],v[64:67]
SA s85,s38,6144
MF v112,v5,v112
MF v113,v5,v113
M v[64:67],a[88:91],v[224:227],v[64:67]
T a[112:113],v23,16384
T a[114:115],v23,18432
M v[64:67],a[92:95],v[240:243],v[64:67]
T a[116:117],v23,20480
T a[118:119],v23,22528
M v[68:71],a[92:95],v[244:247],0
buffer_load_dwordx4 v0, s[12:15], s85 offen offset:1024 lds
M v[68:71],a[88:91],v[228:231],v[68:71]
s_nop 0
T a[120:121],v23,24576
T a[122:123],v23,26624
M v[68:71],a[84:87],v[212:215],v[68:71]
T a[124:125],v23,28672
T a[126:127],v23,30720
M v[68:71],a[80:83],v[196:199],v[68:71]
SA s85,s38,12288
MF v114,v5,v114
MF v115,v5,v115
M v[68:71],a[76:79],v[180:183],v[68:71]
buffer_load_dwordx4 v0, s[12:15], s85 offen offset:2048 lds
M v[68:71],a[72:75],v[164:167],v[68:71]
MF v120,v5,v120
MF v121,v5,v121
M v[68:71],a[68:71],v[148:151],v[68:71]
MF v122,v5,v122
MF v123,v5,v123
M v[68:71],a[64:67],v[132:135],v[68:71]
s_waitcnt lgkmcnt(0)
C v112,v112,v113
C v113,v114,v115
M v[72:75],a[96:99],v[128:131],0
SA s85,s38,18432
T a[64:65],v24,0
T a[66:67],v24,2048
M v[72:75],a[100:103],v[144:147],v[72:75]
T a[68:69],v24,4096
T a[70:71],v24,6144
M v[72:75],a[104:107],v[160:163],v[72:75]
buffer_load_dwordx4 v0, s[12:15], s85 offen offset:3072 lds
M v[72:75],a[108:111],v[176:179],v[72:75]
s_nop 0
T a[72:73],v24,8192
T a[74:75],v24,10240
M v[72:75],a[112:115],v[192:195],v[72:75]
T a[76:77],v24,12288
T a[78:79],v24,14336
M v[72:75],a[116:119],v[208:211],v[72:75]
SA m0,s28,36864
C v114,v120,v121
C v115,v122,v123
M v[72:75],a[120:123],v[224:227],v[72:75]
SA s85,s38,28672
T a[80:81],v24,16384
T a[82:83],v24,18432
M v[72:75],a[124:127],v[240:243],v[72:75]
T a[84:85],v24,20480
T a[86:87],v24,22528
M v[76:79],a[124:127],v[244:247],0
buffer_store_dwordx4 v[112:115], v7, s[8:11], s29 offen offset:1024 sc1
M v[76:79],a[120:123],v[228:231],v[76:79]
s_nop 0
T a[88:89],v24,24576
T a[90:91],v24,26624
M v[76:79],a[116:119],v[212:215],v[76:79]
T a[92:93],v24,28672
T a[94:95],v24,30720
M v[76:79],a[112:115],v[196:199],v[76:79]
buffer_load_dwordx4 v0, s[12:15], s85 offen offset:0 lds
M v[76:79],a[108:111],v[180:183],v[76:79]
SA s85,s38,34816
MF v116,v6,v116
MF v117,v6,v117
M v[76:79],a[104:107],v[164:167],v[76:79]
MF v118,v6,v118
MF v119,v6,v119
M v[76:79],a[100:103],v[148:151],v[76:79]
buffer_load_dwordx4 v0, s[12:15], s85 offen offset:1024 lds
M v[76:79],a[96:99],v[132:135],v[76:79]
s_waitcnt lgkmcnt(0)
MF v124,v6,v124
MF v125,v6,v125
M v[80:83],a[64:67],v[128:131],0
T a[96:97],v25,0
T a[98:99],v25,2048
M v[80:83],a[68:71],v[144:147],v[80:83]
SA s85,s38,40960
T a[100:101],v25,4096
T a[102:103],v25,6144
M v[80:83],a[72:75],v[160:163],v[80:83]
buffer_load_dwordx4 v0, s[12:15], s85 offen offset:2048 lds
M v[80:83],a[76:79],v[176:179],v[80:83]
s_nop 0
T a[104:105],v25,8192
T a[106:107],v25,10240
M v[80:83],a[80:83],v[192:195],v[80:83]
T a[108:109],v25,12288
T a[110:111],v25,14336
M v[80:83],a[84:87],v[208:211],v[80:83]
MF v126,v6,v126
MF v127,v6,v127
M v[80:83],a[88:91],v[224:227],v[80:83]
SA s85,s38,47104
T a[112:113],v25,16384
T a[114:115],v25,18432
M v[80:83],a[92:95],v[240:243],v[80:83]
T a[116:117],v25,20480
T a[118:119],v25,22528
M v[84:87],a[92:95],v[244:247],0
buffer_load_dwordx4 v0, s[12:15], s85 offen offset:3072 lds
M v[84:87],a[88:91],v[228:231],v[84:87]
s_nop 0
T a[120:121],v25,24576
T a[122:123],v25,26624
M v[84:87],a[84:87],v[212:215],v[84:87]
T a[124:125],v25,28672
T a[126:127],v25,30720
M v[84:87],a[80:83],v[196:199],v[84:87]
C v116,v116,v117
C v117,v118,v119
M v[84:87],a[76:79],v[180:183],v[84:87]
C v118,v124,v125
C v119,v126,v127
M v[84:87],a[72:75],v[164:167],v[84:87]
SA s38,s38,128
buffer_store_dwordx4 v[116:119], v7, s[8:11], s30 offen offset:1024 sc1
M v[84:87],a[68:71],v[148:151],v[84:87]
s_waitcnt vmcnt(32) lgkmcnt(0)
M v[84:87],a[64:67],v[132:135],v[84:87]
s_barrier
M v[88:91],a[96:99],v[128:131],0
SA s29,s33,4096
T a[64:65],v18,0
T a[66:67],v18,2048
M v[88:91],a[100:103],v[144:147],v[88:91]
SA s30,s33,18432
T a[68:69],v18,4096
T a[70:71],v18,6144
M v[88:91],a[104:107],v[160:163],v[88:91]
MF v64,v5,v64
MF v65,v5,v65
M v[88:91],a[108:111],v[176:179],v[88:91]
T a[72:73],v18,8192
T a[74:75],v18,10240
M v[88:91],a[112:115],v[192:195],v[88:91]
T a[76:77],v18,12288
T a[78:79],v18,14336
M v[88:91],a[116:119],v[208:211],v[88:91]
MF v66,v5,v66
MF v67,v5,v67
M v[88:91],a[120:123],v[224:227],v[88:91]
T a[80:81],v18,16384
T a[82:83],v18,18432
M v[88:91],a[124:127],v[240:243],v[88:91]
T a[84:85],v18,20480
T a[86:87],v18,22528
M v[92:95],a[124:127],v[244:247],0
MF v72,v5,v72
MF v73,v5,v73
M v[92:95],a[120:123],v[228:231],v[92:95]
T a[88:89],v18,24576
T a[90:91],v18,26624
M v[92:95],a[116:119],v[212:215],v[92:95]
T a[92:93],v18,28672
T a[94:95],v18,30720
M v[92:95],a[112:115],v[196:199],v[92:95]
MF v74,v5,v74
MF v75,v5,v75
M v[92:95],a[108:111],v[180:183],v[92:95]
C v64,v64,v65
C v65,v66,v67
M v[92:95],a[104:107],v[164:167],v[92:95]
C v66,v72,v73
C v67,v74,v75
M v[92:95],a[100:103],v[148:151],v[92:95]
s_waitcnt lgkmcnt(0)
buffer_store_dwordx4 v[64:67], v7, s[8:11], s29 offen offset:0 sc1
M v[92:95],a[96:99],v[132:135],v[92:95]
MF v68,v6,v68
MF v69,v6,v69
MF v70,v6,v70
MF v71,v6,v71
MF v76,v6,v76
MF v77,v6,v77
MF v78,v6,v78
MF v79,v6,v79
C v68,v68,v69
C v69,v70,v71
C v70,v76,v77
C v71,v78,v79
buffer_store_dwordx4 v[68:71], v7, s[8:11], s30 offen offset:0 sc1
M v[96:99],a[64:67],v[128:131],0
s_nop 0
T a[96:97],v19,0
T a[98:99],v19,2048
M v[96:99],a[68:71],v[144:147],v[96:99]
T a[100:101],v19,4096
T a[102:103],v19,6144
M v[96:99],a[72:75],v[160:163],v[96:99]
MF v80,v5,v80
MF v81,v5,v81
M v[96:99],a[76:79],v[176:179],v[96:99]
T a[104:105],v19,8192
T a[106:107],v19,10240
M v[96:99],a[80:83],v[192:195],v[96:99]
T a[108:109],v19,12288
T a[110:111],v19,14336
M v[96:99],a[84:87],v[208:211],v[96:99]
MF v82,v5,v82
MF v83,v5,v83
M v[96:99],a[88:91],v[224:227],v[96:99]
T a[112:113],v19,16384
T a[114:115],v19,18432
M v[96:99],a[92:95],v[240:243],v[96:99]
T a[116:117],v19,20480
T a[118:119],v19,22528
M v[100:103],a[92:95],v[244:247],0
MF v88,v5,v88
MF v89,v5,v89
M v[100:103],a[88:91],v[228:231],v[100:103]
T a[120:121],v19,24576
T a[122:123],v19,26624
M v[100:103],a[84:87],v[212:215],v[100:103]
T a[124:125],v19,28672
T a[126:127],v19,30720
M v[100:103],a[80:83],v[196:199],v[100:103]
MF v90,v5,v90
MF v91,v5,v91
M v[100:103],a[76:79],v[180:183],v[100:103]
C v80,v80,v81
C v81,v82,v83
M v[100:103],a[72:75],v[164:167],v[100:103]
C v82,v88,v89
C v83,v90,v91
M v[100:103],a[68:71],v[148:151],v[100:103]
buffer_store_dwordx4 v[80:83], v7, s[8:11], s29 offen offset:1024 sc1
M v[100:103],a[64:67],v[132:135],v[100:103]
s_waitcnt lgkmcnt(0)
MF v84,v6,v84
MF v85,v6,v85
M v[104:107],a[96:99],v[128:131],0
T a[64:65],v20,0
T a[66:67],v20,2048
M v[104:107],a[100:103],v[144:147],v[104:107]
T a[68:69],v20,4096
T a[70:71],v20,6144
M v[104:107],a[104:107],v[160:163],v[104:107]
MF v86,v6,v86
MF v87,v6,v87
M v[104:107],a[108:111],v[176:179],v[104:107]
T a[72:73],v20,8192
T a[74:75],v20,10240
M v[104:107],a[112:115],v[192:195],v[104:107]
T a[76:77],v20,12288
T a[78:79],v20,14336
M v[104:107],a[116:119],v[208:211],v[104:107]
MF v92,v6,v92
MF v93,v6,v93
M v[104:107],a[120:123],v[224:227],v[104:107]
T a[80:81],v20,16384
T a[82:83],v20,18432
M v[104:107],a[124:127],v[240:243],v[104:107]
T a[84:85],v20,20480
T a[86:87],v20,22528
M v[108:111],a[124:127],v[244:247],0
MF v94,v6,v94
MF v95,v6,v95
M v[108:111],a[120:123],v[228:231],v[108:111]
T a[88:89],v20,24576
T a[90:91],v20,26624
M v[108:111],a[116:119],v[212:215],v[108:111]
T a[92:93],v20,28672
T a[94:95],v20,30720
M v[108:111],a[112:115],v[196:199],v[108:111]
C v84,v84,v85
C v85,v86,v87
M v[108:111],a[108:111],v[180:183],v[108:111]
C v86,v92,v93
C v87,v94,v95
M v[108:111],a[104:107],v[164:167],v[108:111]
buffer_store_dwordx4 v[84:87], v7, s[8:11], s30 offen offset:1024 sc1
M v[108:111],a[100:103],v[148:151],v[108:111]
SA s29,s33,6144
M v[108:111],a[96:99],v[132:135],v[108:111]
s_waitcnt lgkmcnt(0)
M v[112:115],a[64:67],v[128:131],0
SA s30,s33,20480
T a[96:97],v21,0
T a[98:99],v21,2048
M v[112:115],a[68:71],v[144:147],v[112:115]
T a[100:101],v21,4096
T a[102:103],v21,6144
M v[112:115],a[72:75],v[160:163],v[112:115]
MF v96,v5,v96
MF v97,v5,v97
M v[112:115],a[76:79],v[176:179],v[112:115]
T a[104:105],v21,8192
T a[106:107],v21,10240
M v[112:115],a[80:83],v[192:195],v[112:115]
T a[108:109],v21,12288
T a[110:111],v21,14336
M v[112:115],a[84:87],v[208:211],v[112:115]
MF v98,v5,v98
MF v99,v5,v99
M v[112:115],a[88:91],v[224:227],v[112:115]
T a[112:113],v21,16384
T a[114:115],v21,18432
M v[112:115],a[92:95],v[240:243],v[112:115]
T a[116:117],v21,20480
T a[118:119],v21,22528
M v[116:119],a[92:95],v[244:247],0
MF v104,v5,v104
MF v105,v5,v105
M v[116:119],a[88:91],v[228:231],v[116:119]
T a[120:121],v21,24576
T a[122:123],v21,26624
M v[116:119],a[84:87],v[212:215],v[116:119]
T a[124:125],v21,28672
T a[126:127],v21,30720
M v[116:119],a[80:83],v[196:199],v[116:119]
MF v106,v5,v106
MF v107,v5,v107
M v[116:119],a[76:79],v[180:183],v[116:119]
C v96,v96,v97
C v97,v98,v99
M v[116:119],a[72:75],v[164:167],v[116:119]
C v98,v104,v105
C v99,v106,v107
M v[116:119],a[68:71],v[148:151],v[116:119]
s_waitcnt vmcnt(28) lgkmcnt(0)
buffer_store_dwordx4 v[96:99], v7, s[8:11], s29 offen offset:0 sc1
M v[116:119],a[64:67],v[132:135],v[116:119]
s_barrier
M v[120:123],a[96:99],v[128:131],0
s_nop 0
T a[64:65],v40,0
T a[66:67],v40,2048
M v[120:123],a[100:103],v[144:147],v[120:123]
T a[68:69],v40,4096
T a[70:71],v40,6144
M v[120:123],a[104:107],v[160:163],v[120:123]
MF v100,v6,v100
MF v101,v6,v101
M v[120:123],a[108:111],v[176:179],v[120:123]
T a[72:73],v40,8192
T a[74:75],v40,10240
M v[120:123],a[112:115],v[192:195],v[120:123]
T a[76:77],v40,12288
T a[78:79],v40,14336
M v[120:123],a[116:119],v[208:211],v[120:123]
MF v102,v6,v102
MF v103,v6,v103
M v[120:123],a[120:123],v[224:227],v[120:123]
T a[80:81],v40,16384
T a[82:83],v40,18432
M v[120:123],a[124:127],v[240:243],v[120:123]
T a[84:85],v40,20480
T a[86:87],v40,22528
M v[124:127],a[124:127],v[244:247],0
MF v108,v6,v108
MF v109,v6,v109
M v[124:127],a[120:123],v[228:231],v[124:127]
T a[88:89],v40,24576
T a[90:91],v40,26624
M v[124:127],a[116:119],v[212:215],v[124:127]
T a[92:93],v40,28672
T a[94:95],v40,30720
M v[124:127],a[112:115],v[196:199],v[124:127]
MF v110,v6,v110
MF v111,v6,v111
M v[124:127],a[108:111],v[180:183],v[124:127]
C v100,v100,v101
C v101,v102,v103
M v[124:127],a[104:107],v[164:167],v[124:127]
C v102,v108,v109
C v103,v110,v111
M v[124:127],a[100:103],v[148:151],v[124:127]
s_waitcnt lgkmcnt(0)
buffer_store_dwordx4 v[100:103], v7, s[8:11], s30 offen offset:0 sc1
M v[124:127],a[96:99],v[132:135],v[124:127]
M v[64:67],a[64:67],v[128:131],0
s_nop 0
T a[96:97],v41,0
T a[98:99],v41,2048
M v[64:67],a[68:71],v[144:147],v[64:67]
T a[100:101],v41,4096
T a[102:103],v41,6144
M v[64:67],a[72:75],v[160:163],v[64:67]
v_lshrrev_b32 v32, 4, v7
MF v112,v5,v112
M v[64:67],a[76:79],v[176:179],v[64:67]
s_lshr_b32 s74, s41, 3
T a[104:105],v41,8192
T a[106:107],v41,10240
M v[64:67],a[80:83],v[192:195],v[64:67]
s_sub_u32 s64, 15, s42
T a[108:109],v41,12288
T a[110:111],v41,14336
M v[64:67],a[84:87],v[208:211],v[64:67]
s_mul_i32 s46, s64, 8704
MF v113,v5,v113
MF v114,v5,v114
M v[64:67],a[88:91],v[224:227],v[64:67]
s_and_b32 s72, s41, 7
T a[112:113],v41,16384
T a[114:115],v41,18432
M v[64:67],a[92:95],v[240:243],v[64:67]
s_lshl_b32 s65, s72, 7
T a[116:117],v41,20480
T a[118:119],v41,22528
M v[68:71],a[92:95],v[244:247],0
SA s46,s46,s65
MF v115,v5,v115
MF v120,v5,v120
M v[68:71],a[88:91],v[228:231],v[68:71]
SA s46,s46,104993792
T a[120:121],v41,24576
T a[122:123],v41,26624
M v[68:71],a[84:87],v[212:215],v[68:71]
T a[124:125],v41,28672
T a[126:127],v41,30720
M v[68:71],a[80:83],v[196:199],v[68:71]
v_and_b32 v33, 31, v32
MF v121,v5,v121
M v[68:71],a[76:79],v[180:183],v[68:71]
MF v122,v5,v122
MF v123,v5,v123
M v[68:71],a[72:75],v[164:167],v[68:71]
C v112,v112,v113
C v113,v114,v115
M v[68:71],a[68:71],v[148:151],v[68:71]
C v114,v120,v121
C v115,v122,v123
M v[68:71],a[64:67],v[132:135],v[68:71]
s_waitcnt lgkmcnt(0)
buffer_store_dwordx4 v[112:115], v7, s[8:11], s29 offen offset:1024 sc1
M v[72:75],a[96:99],v[128:131],0
s_nop 0
T a[64:65],v42,0
T a[66:67],v42,2048
M v[72:75],a[100:103],v[144:147],v[72:75]
T a[68:69],v42,4096
T a[70:71],v42,6144
M v[72:75],a[104:107],v[160:163],v[72:75]
MF v116,v6,v116
MF v117,v6,v117
M v[72:75],a[108:111],v[176:179],v[72:75]
T a[72:73],v42,8192
T a[74:75],v42,10240
M v[72:75],a[112:115],v[192:195],v[72:75]
T a[76:77],v42,12288
T a[78:79],v42,14336
M v[72:75],a[116:119],v[208:211],v[72:75]
MF v118,v6,v118
MF v119,v6,v119
M v[72:75],a[120:123],v[224:227],v[72:75]
T a[80:81],v42,16384
T a[82:83],v42,18432
M v[72:75],a[124:127],v[240:243],v[72:75]
T a[84:85],v42,20480
T a[86:87],v42,22528
M v[76:79],a[124:127],v[244:247],0
MF v124,v6,v124
MF v125,v6,v125
M v[76:79],a[120:123],v[228:231],v[76:79]
T a[88:89],v42,24576
T a[90:91],v42,26624
M v[76:79],a[116:119],v[212:215],v[76:79]
T a[92:93],v42,28672
T a[94:95],v42,30720
M v[76:79],a[112:115],v[196:199],v[76:79]
MF v126,v6,v126
MF v127,v6,v127
M v[76:79],a[108:111],v[180:183],v[76:79]
C v116,v116,v117
C v117,v118,v119
M v[76:79],a[104:107],v[164:167],v[76:79]
C v118,v124,v125
C v119,v126,v127
M v[76:79],a[100:103],v[148:151],v[76:79]
buffer_store_dwordx4 v[116:119], v7, s[8:11], s30 offen offset:1024 sc1
M v[76:79],a[96:99],v[132:135],v[76:79]
s_waitcnt lgkmcnt(0)
v_lshlrev_b32 v33, 2, v33
M v[80:83],a[64:67],v[128:131],0
SA s29,s33,8192
T a[96:97],v43,0
T a[98:99],v43,2048
M v[80:83],a[68:71],v[144:147],v[80:83]
SA s30,s33,22528
T a[100:101],v43,4096
T a[102:103],v43,6144
M v[80:83],a[72:75],v[160:163],v[80:83]
s_lshl_b32 s65, s41, 7
MF v64,v5,v64
MF v65,v5,v65
M v[80:83],a[76:79],v[176:179],v[80:83]
SA s65,s65,104890368
T a[104:105],v43,8192
T a[106:107],v43,10240
M v[80:83],a[80:83],v[192:195],v[80:83]
T a[108:109],v43,12288
T a[110:111],v43,14336
M v[80:83],a[84:87],v[208:211],v[80:83]
buffer_load_dword v31, v33, s[8:11], s65 offen sc1
M v[80:83],a[88:91],v[224:227],v[80:83]
s_nop 0
T a[112:113],v43,16384
T a[114:115],v43,18432
M v[80:83],a[92:95],v[240:243],v[80:83]
T a[116:117],v43,20480
T a[118:119],v43,22528
M v[84:87],a[92:95],v[244:247],0
s_cmp_ge_u32 s42, 8
v_bfe_u32 v34, v32, 4, 1
v_lshlrev_b32 v34, 1, v34
M v[84:87],a[88:91],v[228:231],v[84:87]
s_cselect_b32 s84, s45, 536870912
T a[120:121],v43,24576
T a[122:123],v43,26624
M v[84:87],a[84:87],v[212:215],v[84:87]
T a[124:125],v43,28672
T a[126:127],v43,30720
M v[84:87],a[80:83],v[196:199],v[84:87]
v_lshrrev_b32 v35, 5, v32
v_add_u32 v34, v34, v35
M v[84:87],a[76:79],v[180:183],v[84:87]
s_mov_b32 s52, s96
MF v66,v5,v66
MF v67,v5,v67
M v[84:87],a[72:75],v[164:167],v[84:87]
s_and_b32 s53, s97, 0xffff
MF v72,v5,v72
MF v73,v5,v73
M v[84:87],a[68:71],v[148:151],v[84:87]
s_waitcnt vmcnt(22) lgkmcnt(0)
MF v74,v5,v74
MF v75,v5,v75
M v[84:87],a[64:67],v[132:135],v[84:87]
s_barrier
M v[88:91],a[96:99],v[128:131],0
s_mov_b32 s54, 1835008
T a[64:65],v22,32768
T a[66:67],v22,34816
M v[88:91],a[100:103],v[144:147],v[88:91]
s_mov_b32 s55, 0x20000
T a[68:69],v22,36864
T a[70:71],v22,38912
M v[88:91],a[104:107],v[160:163],v[88:91]
s_mul_i32 s77, s42, 1835008
C v64,v64,v65
C v65,v66,v67
M v[88:91],a[108:111],v[176:179],v[88:91]
s_mul_i32 s78, s72, 14336
T a[72:73],v22,40960
T a[74:75],v22,43008
M v[88:91],a[112:115],v[192:195],v[88:91]
SA s77,s77,s78
T a[76:77],v22,45056
T a[78:79],v22,47104
M v[88:91],a[116:119],v[208:211],v[88:91]
SA s77,s77,67108864
C v66,v72,v73
C v67,v74,v75
M v[88:91],a[120:123],v[224:227],v[88:91]
s_lshl_b32 s79, s74, 2
T a[80:81],v22,49152
T a[82:83],v22,51200
M v[88:91],a[124:127],v[240:243],v[88:91]
SA s79,s79,s20
T a[84:85],v22,53248
T a[86:87],v22,55296
M v[92:95],a[124:127],v[244:247],0
SA s79,s79,6
buffer_store_dwordx4 v[64:67], v7, s[8:11], s29 offen offset:0 sc1
M v[92:95],a[120:123],v[228:231],v[92:95]
s_sub_u32 s67, 13, s79
T a[88:89],v22,57344
T a[90:91],v22,59392
M v[92:95],a[116:119],v[212:215],v[92:95]
s_and_b32 s67, s67, 536870912
T a[92:93],v22,61440
T a[94:95],v22,63488
M v[92:95],a[112:115],v[196:199],v[92:95]
s_lshl_b32 s78, s79, 10
MF v68,v6,v68
MF v69,v6,v69
M v[92:95],a[108:111],v[180:183],v[92:95]
SA s78,s78,s77
MF v70,v6,v70
MF v71,v6,v71
M v[92:95],a[104:107],v[164:167],v[92:95]
s_lshl_b32 s79, s79, 6
MF v76,v6,v76
MF v77,v6,v77
M v[92:95],a[100:103],v[148:151],v[92:95]
s_waitcnt lgkmcnt(0)
MF v78,v6,v78
MF v79,v6,v79
M v[92:95],a[96:99],v[132:135],v[92:95]
s_or_b32 s79, s79, s67
v_or_b32 v27, s67, v7
s_lshr_b32 s73, s72, 1
s_sub_u32 s65, 7, s73
s_bitcmp1_b32 s72, 0
s_cselect_b32 s73, s65, s73
s_lshl_b32 s73, s73, 4
s_lshl_b32 s65, s42, 7
SA s73,s73,s65
v_and_b32 v29, 15, v32
v_add_u32 v29, s73, v29
s_mov_b32 s64, 104857664
v_mul_u32_u24 v28, 896, v29
v_lshl_add_u32 v28, v34, 4, v28
C v68,v68,v69
C v69,v70,v71
C v70,v76,v77
C v71,v78,v79
buffer_store_dwordx4 v[68:71], v7, s[8:11], s30 offen offset:0 sc1
v_lshrrev_b32 v35, 4, v29
v_lshlrev_b32 v35, 5, v35
v_and_b32 v36, 15, v29
v_add_lshl_u32 v35, v35, v36, 2
buffer_load_dword v26, v35, s[8:11], s64 offen sc1
s_waitcnt vmcnt(8)
buffer_store_dword v15, v17, s[8:11], s84 offen sc1
buffer_load_dwordx4 v[44:47], v28, s[56:59], s79 offen
M v[96:99],a[64:67],v[128:131],0
s_nop 0
T a[96:97],v23,32768
T a[98:99],v23,34816
M v[96:99],a[68:71],v[144:147],v[96:99]
T a[100:101],v23,36864
T a[102:103],v23,38912
M v[96:99],a[72:75],v[160:163],v[96:99]
MF v80,v5,v80
MF v81,v5,v81
M v[96:99],a[76:79],v[176:179],v[96:99]
T a[104:105],v23,40960
T a[106:107],v23,43008
M v[96:99],a[80:83],v[192:195],v[96:99]
T a[108:109],v23,45056
T a[110:111],v23,47104
M v[96:99],a[84:87],v[208:211],v[96:99]
MF v82,v5,v82
MF v83,v5,v83
M v[96:99],a[88:91],v[224:227],v[96:99]
T a[112:113],v23,49152
T a[114:115],v23,51200
M v[96:99],a[92:95],v[240:243],v[96:99]
T a[116:117],v23,53248
T a[118:119],v23,55296
M v[100:103],a[92:95],v[244:247],0
MF v88,v5,v88
MF v89,v5,v89
M v[100:103],a[88:91],v[228:231],v[100:103]
T a[120:121],v23,57344
T a[122:123],v23,59392
M v[100:103],a[84:87],v[212:215],v[100:103]
T a[124:125],v23,61440
T a[126:127],v23,63488
M v[100:103],a[80:83],v[196:199],v[100:103]
MF v90,v5,v90
MF v91,v5,v91
M v[100:103],a[76:79],v[180:183],v[100:103]
C v80,v80,v81
C v81,v82,v83
M v[100:103],a[72:75],v[164:167],v[100:103]
C v82,v88,v89
C v83,v90,v91
M v[100:103],a[68:71],v[148:151],v[100:103]
buffer_store_dwordx4 v[80:83], v7, s[8:11], s29 offen offset:1024 sc1
M v[100:103],a[64:67],v[132:135],v[100:103]
s_waitcnt lgkmcnt(0)
MF v84,v6,v84
MF v85,v6,v85
M v[104:107],a[96:99],v[128:131],0
T a[64:65],v24,32768
T a[66:67],v24,34816
M v[104:107],a[100:103],v[144:147],v[104:107]
T a[68:69],v24,36864
T a[70:71],v24,38912
M v[104:107],a[104:107],v[160:163],v[104:107]
MF v86,v6,v86
MF v87,v6,v87
M v[104:107],a[108:111],v[176:179],v[104:107]
T a[72:73],v24,40960
T a[74:75],v24,43008
M v[104:107],a[112:115],v[192:195],v[104:107]
T a[76:77],v24,45056
T a[78:79],v24,47104
M v[104:107],a[116:119],v[208:211],v[104:107]
MF v92,v6,v92
MF v93,v6,v93
M v[104:107],a[120:123],v[224:227],v[104:107]
T a[80:81],v24,49152
T a[82:83],v24,51200
M v[104:107],a[124:127],v[240:243],v[104:107]
T a[84:85],v24,53248
T a[86:87],v24,55296
M v[108:111],a[124:127],v[244:247],0
MF v94,v6,v94
MF v95,v6,v95
M v[108:111],a[120:123],v[228:231],v[108:111]
T a[88:89],v24,57344
T a[90:91],v24,59392
M v[108:111],a[116:119],v[212:215],v[108:111]
T a[92:93],v24,61440
T a[94:95],v24,63488
M v[108:111],a[112:115],v[196:199],v[108:111]
C v84,v84,v85
C v85,v86,v87
M v[108:111],a[108:111],v[180:183],v[108:111]
C v86,v92,v93
C v87,v94,v95
M v[108:111],a[104:107],v[164:167],v[108:111]
buffer_store_dwordx4 v[84:87], v7, s[8:11], s30 offen offset:1024 sc1
M v[108:111],a[100:103],v[148:151],v[108:111]
SA s29,s33,10240
M v[108:111],a[96:99],v[132:135],v[108:111]
s_waitcnt lgkmcnt(0)
M v[112:115],a[64:67],v[128:131],0
SA s30,s33,24576
T a[96:97],v25,32768
T a[98:99],v25,34816
M v[112:115],a[68:71],v[144:147],v[112:115]
T a[100:101],v25,36864
T a[102:103],v25,38912
M v[112:115],a[72:75],v[160:163],v[112:115]
MF v96,v5,v96
MF v97,v5,v97
M v[112:115],a[76:79],v[176:179],v[112:115]
T a[104:105],v25,40960
T a[106:107],v25,43008
M v[112:115],a[80:83],v[192:195],v[112:115]
T a[108:109],v25,45056
T a[110:111],v25,47104
M v[112:115],a[84:87],v[208:211],v[112:115]
MF v98,v5,v98
MF v99,v5,v99
M v[112:115],a[88:91],v[224:227],v[112:115]
T a[112:113],v25,49152
T a[114:115],v25,51200
M v[112:115],a[92:95],v[240:243],v[112:115]
T a[116:117],v25,53248
T a[118:119],v25,55296
M v[116:119],a[92:95],v[244:247],0
s_cmp_lt_u32 s42, 8
MF v104,v5,v104
MF v105,v5,v105
M v[116:119],a[88:91],v[228:231],v[116:119]
s_cselect_b32 s84, s45, 536870912
T a[120:121],v25,57344
T a[122:123],v25,59392
M v[116:119],a[84:87],v[212:215],v[116:119]
T a[124:125],v25,61440
T a[126:127],v25,63488
M v[116:119],a[80:83],v[196:199],v[116:119]
MF v106,v5,v106
MF v107,v5,v107
M v[116:119],a[76:79],v[180:183],v[116:119]
C v96,v96,v97
C v97,v98,v99
M v[116:119],a[72:75],v[164:167],v[116:119]
C v98,v104,v105
C v99,v106,v107
M v[116:119],a[68:71],v[148:151],v[116:119]
s_waitcnt lgkmcnt(0)
buffer_store_dwordx4 v[96:99], v7, s[8:11], s29 offen offset:0 sc1
M v[116:119],a[64:67],v[132:135],v[116:119]
s_barrier
M v[120:123],a[96:99],v[128:131],0
s_nop 0
T a[64:65],v18,32768
T a[66:67],v18,34816
M v[120:123],a[100:103],v[144:147],v[120:123]
T a[68:69],v18,36864
T a[70:71],v18,38912
M v[120:123],a[104:107],v[160:163],v[120:123]
MF v100,v6,v100
MF v101,v6,v101
M v[120:123],a[108:111],v[176:179],v[120:123]
T a[72:73],v18,40960
T a[74:75],v18,43008
M v[120:123],a[112:115],v[192:195],v[120:123]
s_waitcnt vmcnt(9)
T a[76:77],v18,45056
T a[78:79],v18,47104
M v[120:123],a[116:119],v[208:211],v[120:123]
buffer_store_dword v15, v17, s[8:11], s84 offen sc1
M v[120:123],a[120:123],v[224:227],v[120:123]
s_nop 0
T a[80:81],v18,49152
T a[82:83],v18,51200
M v[120:123],a[124:127],v[240:243],v[120:123]
T a[84:85],v18,53248
T a[86:87],v18,55296
M v[124:127],a[124:127],v[244:247],0
MF v102,v6,v102
MF v103,v6,v103
M v[124:127],a[120:123],v[228:231],v[124:127]
T a[88:89],v18,57344
T a[90:91],v18,59392
M v[124:127],a[116:119],v[212:215],v[124:127]
T a[92:93],v18,61440
T a[94:95],v18,63488
M v[124:127],a[112:115],v[196:199],v[124:127]
MF v108,v6,v108
MF v109,v6,v109
M v[124:127],a[108:111],v[180:183],v[124:127]
MF v110,v6,v110
MF v111,v6,v111
M v[124:127],a[104:107],v[164:167],v[124:127]
C v100,v100,v101
C v101,v102,v103
M v[124:127],a[100:103],v[148:151],v[124:127]
s_waitcnt lgkmcnt(0)
C v102,v108,v109
C v103,v110,v111
M v[124:127],a[96:99],v[132:135],v[124:127]
buffer_store_dwordx4 v[100:103], v7, s[8:11], s30 offen offset:0 sc1
M v[64:67],a[64:67],v[128:131],0
s_nop 0
T a[96:97],v19,32768
T a[98:99],v19,34816
M v[64:67],a[68:71],v[144:147],v[64:67]
T a[100:101],v19,36864
T a[102:103],v19,38912
M v[64:67],a[72:75],v[160:163],v[64:67]
MF v112,v5,v112
MF v113,v5,v113
M v[64:67],a[76:79],v[176:179],v[64:67]
T a[104:105],v19,40960
T a[106:107],v19,43008
M v[64:67],a[80:83],v[192:195],v[64:67]
T a[108:109],v19,45056
T a[110:111],v19,47104
M v[64:67],a[84:87],v[208:211],v[64:67]
MF v114,v5,v114
MF v115,v5,v115
M v[64:67],a[88:91],v[224:227],v[64:67]
T a[112:113],v19,49152
T a[114:115],v19,51200
M v[64:67],a[92:95],v[240:243],v[64:67]
T a[116:117],v19,53248
T a[118:119],v19,55296
M v[68:71],a[92:95],v[244:247],0
MF v120,v5,v120
MF v121,v5,v121
M v[68:71],a[88:91],v[228:231],v[68:71]
T a[120:121],v19,57344
T a[122:123],v19,59392
M v[68:71],a[84:87],v[212:215],v[68:71]
T a[124:125],v19,61440
T a[126:127],v19,63488
M v[68:71],a[80:83],v[196:199],v[68:71]
MF v122,v5,v122
MF v123,v5,v123
M v[68:71],a[76:79],v[180:183],v[68:71]
C v112,v112,v113
C v113,v114,v115
M v[68:71],a[72:75],v[164:167],v[68:71]
C v114,v120,v121
C v115,v122,v123
M v[68:71],a[68:71],v[148:151],v[68:71]
buffer_store_dwordx4 v[112:115], v7, s[8:11], s29 offen offset:1024 sc1
M v[68:71],a[64:67],v[132:135],v[68:71]
s_waitcnt lgkmcnt(0)
MF v116,v6,v116
MF v117,v6,v117
M v[72:75],a[96:99],v[128:131],0
T a[64:65],v20,32768
T a[66:67],v20,34816
M v[72:75],a[100:103],v[144:147],v[72:75]
T a[68:69],v20,36864
T a[70:71],v20,38912
M v[72:75],a[104:107],v[160:163],v[72:75]
MF v118,v6,v118
MF v119,v6,v119
M v[72:75],a[108:111],v[176:179],v[72:75]
T a[72:73],v20,40960
T a[74:75],v20,43008
M v[72:75],a[112:115],v[192:195],v[72:75]
T a[76:77],v20,45056
T a[78:79],v20,47104
M v[72:75],a[116:119],v[208:211],v[72:75]
MF v124,v6,v124
MF v125,v6,v125
M v[72:75],a[120:123],v[224:227],v[72:75]
T a[80:81],v20,49152
T a[82:83],v20,51200
M v[72:75],a[124:127],v[240:243],v[72:75]
T a[84:85],v20,53248
T a[86:87],v20,55296
M v[76:79],a[124:127],v[244:247],0
MF v126,v6,v126
MF v127,v6,v127
M v[76:79],a[120:123],v[228:231],v[76:79]
T a[88:89],v20,57344
T a[90:91],v20,59392
M v[76:79],a[116:119],v[212:215],v[76:79]
T a[92:93],v20,61440
T a[94:95],v20,63488
M v[76:79],a[112:115],v[196:199],v[76:79]
C v116,v116,v117
C v117,v118,v119
M v[76:79],a[108:111],v[180:183],v[76:79]
C v118,v124,v125
C v119,v126,v127
M v[76:79],a[104:107],v[164:167],v[76:79]
buffer_store_dwordx4 v[116:119], v7, s[8:11], s30 offen offset:1024 sc1
M v[76:79],a[100:103],v[148:151],v[76:79]
SA s29,s33,12288
s_waitcnt vmcnt(12)
v_readlane_b32 s92, v31, 0
v_readlane_b32 s94, v31, 1
M v[76:79],a[96:99],v[132:135],v[76:79]
s_waitcnt lgkmcnt(0)
s_waitcnt vmcnt(9)
v_sub_f32 v30, 1.0, v26
s_waitcnt vmcnt(7)
v_lshlrev_b32 v48, 16, v44
M v[80:83],a[64:67],v[128:131],0
SA s30,s33,26624
T a[96:97],v21,32768
T a[98:99],v21,34816
M v[80:83],a[68:71],v[144:147],v[80:83]
T a[100:101],v21,36864
T a[102:103],v21,38912
M v[80:83],a[72:75],v[160:163],v[80:83]
v_and_b32 v49, 0xffff0000, v44
v_lshlrev_b32 v50, 16, v45
M v[80:83],a[76:79],v[176:179],v[80:83]
T a[104:105],v21,40960
T a[106:107],v21,43008
M v[80:83],a[80:83],v[192:195],v[80:83]
T a[108:109],v21,45056
T a[110:111],v21,47104
M v[80:83],a[84:87],v[208:211],v[80:83]
MF v64,v5,v64
MF v65,v5,v65
M v[80:83],a[88:91],v[224:227],v[80:83]
T a[112:113],v21,49152
T a[114:115],v21,51200
M v[80:83],a[92:95],v[240:243],v[80:83]
T a[116:117],v21,53248
T a[118:119],v21,55296
M v[84:87],a[92:95],v[244:247],0
MF v66,v5,v66
MF v67,v5,v67
M v[84:87],a[88:91],v[228:231],v[84:87]
T a[120:121],v21,57344
T a[122:123],v21,59392
M v[84:87],a[84:87],v[212:215],v[84:87]
T a[124:125],v21,61440
T a[126:127],v21,63488
M v[84:87],a[80:83],v[196:199],v[84:87]
MF v72,v5,v72
MF v73,v5,v73
M v[84:87],a[76:79],v[180:183],v[84:87]
MF v74,v5,v74
MF v75,v5,v75
M v[84:87],a[72:75],v[164:167],v[84:87]
C v64,v64,v65
C v65,v66,v67
M v[84:87],a[68:71],v[148:151],v[84:87]
C v66,v72,v73
C v67,v74,v75
M v[84:87],a[64:67],v[132:135],v[84:87]
s_waitcnt lgkmcnt(0)
buffer_store_dwordx4 v[64:67], v7, s[8:11], s29 offen offset:0 sc1
M v[88:91],a[96:99],v[128:131],0
v_and_b32 v51, 0xffff0000, v45
v_lshlrev_b32 v52, 16, v46
M v[88:91],a[100:103],v[144:147],v[88:91]
MF v68,v6,v68
MF v69,v6,v69
M v[88:91],a[104:107],v[160:163],v[88:91]
MF v70,v6,v70
MF v71,v6,v71
M v[88:91],a[108:111],v[176:179],v[88:91]
MF v76,v6,v76
MF v77,v6,v77
M v[88:91],a[112:115],v[192:195],v[88:91]
MF v78,v6,v78
MF v79,v6,v79
M v[88:91],a[116:119],v[208:211],v[88:91]
C v68,v68,v69
C v69,v70,v71
M v[88:91],a[120:123],v[224:227],v[88:91]
C v70,v76,v77
C v71,v78,v79
M v[88:91],a[124:127],v[240:243],v[88:91]
buffer_store_dwordx4 v[68:71], v7, s[8:11], s30 offen offset:0 sc1
M v[92:95],a[124:127],v[244:247],0
v_and_b32 v53, 0xffff0000, v46
v_lshlrev_b32 v54, 16, v47
M v[92:95],a[120:123],v[228:231],v[92:95]
v_and_b32 v55, 0xffff0000, v47
v_cmp_eq_u32 s[80:81], s92, v29
M v[92:95],a[116:119],v[212:215],v[92:95]
v_cmp_eq_u32 s[82:83], s94, v29
M v[92:95],a[112:115],v[196:199],v[92:95]
MF v80,v5,v80
MF v81,v5,v81
M v[92:95],a[108:111],v[180:183],v[92:95]
MF v82,v5,v82
MF v83,v5,v83
M v[92:95],a[104:107],v[164:167],v[92:95]
MF v88,v5,v88
MF v89,v5,v89
M v[92:95],a[100:103],v[148:151],v[92:95]
MF v90,v5,v90
MF v91,v5,v91
M v[92:95],a[96:99],v[132:135],v[92:95]
C v80,v80,v81
C v81,v82,v83
C v82,v88,v89
C v83,v90,v91
buffer_store_dwordx4 v[80:83], v7, s[8:11], s29 offen offset:1024 sc1
MF v84,v6,v84
MF v85,v6,v85
MF v86,v6,v86
MF v87,v6,v87
MF v92,v6,v92
MF v93,v6,v93
MF v94,v6,v94
MF v95,v6,v95
C v84,v84,v85
C v85,v86,v87
C v86,v92,v93
C v87,v94,v95
buffer_store_dwordx4 v[84:87], v7, s[8:11], s30 offen offset:1024 sc1
buffer_load_dword v9, v33, s[8:11], s46 offen sc1
s_waitcnt vmcnt(1)
buffer_store_dword v15, v16, s[8:11], s3 offen sc1
s_cmp_lt_u32 s42, 8
s_cbranch_scc1 L_red
s_waitcnt vmcnt(1)
v_cmp_eq_u32 vcc, 1, v9
s_mov_b32 s91, 65536
s_lshl_b32 s70, 1, s41
s_mov_b32 s69, 0xffff
s_or_b32 s70, s70, vcc_lo
s_mov_b32 s68, s70
s_barrier
s_cmp_lg_u32 s70, 0
s_cbranch_scc1 L_vk0
s_call_b64 s[36:37], L_rpoll
L_vk0:
s_ff1_i32_b32 s71, s70
s_bitset0_b32 s70, s71
s_mul_i32 s71, s71, 114688
SA s16,s71,s78
buffer_load_dwordx4 v[128:131], v27, s[8:11], s16 offen sc1
s_cmp_lg_u32 s70, 0
s_cbranch_scc1 L_vk1
s_call_b64 s[36:37], L_rpoll
L_vk1:
s_ff1_i32_b32 s71, s70
s_bitset0_b32 s70, s71
s_mul_i32 s71, s71, 114688
SA s17,s71,s78
buffer_load_dwordx4 v[132:135], v27, s[8:11], s17 offen sc1
s_cmp_lg_u32 s70, 0
s_cbranch_scc1 L_vk2
s_call_b64 s[36:37], L_rpoll
L_vk2:
s_ff1_i32_b32 s71, s70
s_bitset0_b32 s70, s71
s_mul_i32 s71, s71, 114688
SA s18,s71,s78
buffer_load_dwordx4 v[136:139], v27, s[8:11], s18 offen sc1
s_cmp_lg_u32 s70, 0
s_cbranch_scc1 L_vk3
s_call_b64 s[36:37], L_rpoll
L_vk3:
s_ff1_i32_b32 s71, s70
s_bitset0_b32 s70, s71
s_mul_i32 s71, s71, 114688
SA s19,s71,s78
buffer_load_dwordx4 v[140:143], v27, s[8:11], s19 offen sc1
s_cmp_lg_u32 s70, 0
s_cbranch_scc1 L_vk4
s_call_b64 s[36:37], L_rpoll
L_vk4:
s_ff1_i32_b32 s71, s70
s_bitset0_b32 s70, s71
s_mul_i32 s71, s71, 114688
SA s48,s71,s78
buffer_load_dwordx4 v[144:147], v27, s[8:11], s48 offen sc1
s_cmp_lg_u32 s70, 0
s_cbranch_scc1 L_vk5
s_call_b64 s[36:37], L_rpoll
L_vk5:
s_ff1_i32_b32 s71, s70
s_bitset0_b32 s70, s71
s_mul_i32 s71, s71, 114688
SA s49,s71,s78
buffer_load_dwordx4 v[148:151], v27, s[8:11], s49 offen sc1
s_cmp_lg_u32 s70, 0
s_cbranch_scc1 L_vk6
s_call_b64 s[36:37], L_rpoll
L_vk6:
s_ff1_i32_b32 s71, s70
s_bitset0_b32 s70, s71
s_mul_i32 s71, s71, 114688
SA s50,s71,s78
buffer_load_dwordx4 v[152:155], v27, s[8:11], s50 offen sc1
s_cmp_lg_u32 s70, 0
s_cbranch_scc1 L_vk7
s_call_b64 s[36:37], L_rpoll
L_vk7:
s_ff1_i32_b32 s71, s70
s_bitset0_b32 s70, s71
s_mul_i32 s71, s71, 114688
SA s51,s71,s78
buffer_load_dwordx4 v[156:159], v27, s[8:11], s51 offen sc1
s_or_b64 vcc, s[80:81], s[82:83]
s_cbranch_vccnz L_moe2
L_moe_ret2:
MF v48,v30,v48
MF v49,v30,v49
MF v50,v30,v50
MF v51,v30,v51
MF v52,v30,v52
MF v53,v30,v53
MF v54,v30,v54
MF v55,v30,v55
s_cmp_lg_u32 s70, 0
s_cbranch_scc1 L_vk8
s_call_b64 s[36:37], L_rpoll
L_vk8:
s_ff1_i32_b32 s71, s70
s_bitset0_b32 s70, s71
s_mul_i32 s71, s71, 114688
SA s21,s71,s78
buffer_load_dwordx4 v[160:163], v27, s[8:11], s21 offen sc1
s_waitcnt vmcnt(8)
M v[56:59],a[246:249],v[128:131],0
M v[60:63],a[244:247],v[128:131],0
s_cmp_lg_u32 s70, 0
s_cbranch_scc1 L_vk9
s_call_b64 s[36:37], L_rpoll
L_vk9:
s_ff1_i32_b32 s71, s70
s_bitset0_b32 s70, s71
s_mul_i32 s71, s71, 114688
SA s22,s71,s78
buffer_load_dwordx4 v[164:167], v27, s[8:11], s22 offen sc1
s_waitcnt vmcnt(8)
M v[56:59],a[246:249],v[132:135],v[56:59]
M v[60:63],a[244:247],v[132:135],v[60:63]
s_cmp_lg_u32 s70, 0
s_cbranch_scc1 L_vk10
s_call_b64 s[36:37], L_rpoll
L_vk10:
s_ff1_i32_b32 s71, s70
s_bitset0_b32 s70, s71
s_mul_i32 s71, s71, 114688
SA s23,s71,s78
buffer_load_dwordx4 v[168:171], v27, s[8:11], s23 offen sc1
s_waitcnt vmcnt(8)
M v[56:59],a[246:249],v[136:139],v[56:59]
M v[60:63],a[244:247],v[136:139],v[60:63]
s_cmp_lg_u32 s70, 0
s_cbranch_scc1 L_vk11
s_call_b64 s[36:37], L_rpoll
L_vk11:
s_ff1_i32_b32 s71, s70
s_bitset0_b32 s70, s71
s_mul_i32 s71, s71, 114688
SA s24,s71,s78
buffer_load_dwordx4 v[172:175], v27, s[8:11], s24 offen sc1
s_waitcnt vmcnt(8)
M v[56:59],a[246:249],v[140:143],v[56:59]
M v[60:63],a[244:247],v[140:143],v[60:63]
s_cmp_lg_u32 s70, 0
s_cbranch_scc1 L_vk12
s_call_b64 s[36:37], L_rpoll
L_vk12:
s_ff1_i32_b32 s71, s70
s_bitset0_b32 s70, s71
s_mul_i32 s71, s71, 114688
SA s25,s71,s78
buffer_load_dwordx4 v[176:179], v27, s[8:11], s25 offen sc1
s_waitcnt vmcnt(8)
M v[56:59],a[246:249],v[144:147],v[56:59]
M v[60:63],a[244:247],v[144:147],v[60:63]
s_cmp_lg_u32 s70, 0
s_cbranch_scc1 L_vk13
s_call_b64 s[36:37], L_rpoll
L_vk13:
s_ff1_i32_b32 s71, s70
s_bitset0_b32 s70, s71
s_mul_i32 s71, s71, 114688
SA s26,s71,s78
buffer_load_dwordx4 v[180:183], v27, s[8:11], s26 offen sc1
s_waitcnt vmcnt(8)
M v[56:59],a[246:249],v[148:151],v[56:59]
M v[60:63],a[244:247],v[148:151],v[60:63]
s_cmp_lg_u32 s70, 0
s_cbranch_scc1 L_vk14
s_call_b64 s[36:37], L_rpoll
L_vk14:
s_ff1_i32_b32 s71, s70
s_bitset0_b32 s70, s71
s_mul_i32 s71, s71, 114688
SA s27,s71,s78
buffer_load_dwordx4 v[184:187], v27, s[8:11], s27 offen sc1
s_waitcnt vmcnt(8)
M v[56:59],a[246:249],v[152:155],v[56:59]
M v[60:63],a[244:247],v[152:155],v[60:63]
s_cmp_lg_u32 s70, 0
s_cbranch_scc1 L_vk15
s_call_b64 s[36:37], L_rpoll
L_vk15:
s_ff1_i32_b32 s71, s70
s_bitset0_b32 s70, s71
s_mul_i32 s71, s71, 114688
SA s28,s71,s78
buffer_load_dwordx4 v[188:191], v27, s[8:11], s28 offen sc1
s_waitcnt vmcnt(8)
M v[56:59],a[246:249],v[156:159],v[56:59]
M v[60:63],a[244:247],v[156:159],v[60:63]
s_waitcnt vmcnt(7)
M v[56:59],a[246:249],v[160:163],v[56:59]
M v[60:63],a[244:247],v[160:163],v[60:63]
s_waitcnt vmcnt(6)
M v[56:59],a[246:249],v[164:167],v[56:59]
M v[60:63],a[244:247],v[164:167],v[60:63]
s_waitcnt vmcnt(5)
M v[56:59],a[246:249],v[168:171],v[56:59]
M v[60:63],a[244:247],v[168:171],v[60:63]
s_waitcnt vmcnt(4)
M v[56:59],a[246:249],v[172:175],v[56:59]
M v[60:63],a[244:247],v[172:175],v[60:63]
s_waitcnt vmcnt(3)
M v[56:59],a[246:249],v[176:179],v[56:59]
M v[60:63],a[244:247],v[176:179],v[60:63]
s_waitcnt vmcnt(2)
M v[56:59],a[246:249],v[180:183],v[56:59]
M v[60:63],a[244:247],v[180:183],v[60:63]
s_waitcnt vmcnt(1)
M v[56:59],a[246:249],v[184:187],v[56:59]
M v[60:63],a[244:247],v[184:187],v[60:63]
s_waitcnt vmcnt(0)
M v[56:59],a[246:249],v[188:191],v[56:59]
M v[60:63],a[244:247],v[188:191],v[60:63]
s_nop 7
v_permlane16_swap_b32 v56, v60
v_permlane16_swap_b32 v57, v61
v_permlane16_swap_b32 v58, v62
v_permlane16_swap_b32 v59, v63
v_fmac_f32 v48, v26, v56
v_fmac_f32 v49, v26, v57
v_fmac_f32 v50, v26, v58
v_fmac_f32 v51, v26, v59
v_fmac_f32 v52, v26, v60
v_fmac_f32 v53, v26, v61
v_fmac_f32 v54, v26, v62
v_fmac_f32 v55, v26, v63
C v44,v48,v49
C v45,v50,v51
C v46,v52,v53
C v47,v54,v55
buffer_store_dwordx4 v[44:47], v28, s[52:55], s79 offen sc1
s_endpgm
L_d2h:
M v[128:131],a[64:67],v[48:51],v[128:131]
R a[96:99],v7,40960
R a[100:103],v7,41984
M v[128:131],a[68:71],v[56:59],v[128:131]
SA m0,s28,135168
E v18,v64
M v[132:135],a[68:71],v[60:63],v[132:135]
buffer_load_dwordx4 v4, s[8:11], s26 offen offset:0 sc1 lds
M v[132:135],a[64:67],v[52:55],v[132:135]
R a[104:107],v7,43008
R a[108:111],v7,44032
M v[140:143],a[72:75],v[52:55],v[140:143]
s_cmp_gt_u32 s20, 3
E v19,v65
M v[140:143],a[76:79],v[60:63],v[140:143]
s_cselect_b64 s[82:83], -1, 0
AF v30,v28,v30
AF v31,v29,v31
M v[136:139],a[76:79],v[56:59],v[136:139]
s_cmp_eq_u32 s20, 3
R a[112:115],v7,45056
R a[116:119],v7,46080
M v[136:139],a[72:75],v[48:51],v[136:139]
s_cselect_b64 s[66:67], s[16:17], s[82:83]
buffer_load_dwordx4 v4, s[8:11], s26 offen offset:1024 sc1 lds
M v[144:147],a[80:83],v[48:51],v[144:147]
s_cselect_b64 s[68:69], s[18:19], s[82:83]
E v20,v66
M v[144:147],a[84:87],v[56:59],v[144:147]
s_cselect_b64 s[70:71], s[48:49], s[82:83]
R a[120:123],v7,47104
R a[124:127],v7,48128
M v[148:151],a[84:87],v[60:63],v[148:151]
s_cselect_b64 s[72:73], s[50:51], s[82:83]
v_cndmask_b32 v100, v36, v8, s[66:67]
v_cndmask_b32 v101, v36, v8, s[68:69]
M v[148:151],a[80:83],v[52:55],v[148:151]
buffer_load_dwordx4 v4, s[8:11], s26 offen offset:2048 sc1 lds
M v[156:159],a[88:91],v[52:55],v[156:159]
v_cndmask_b32 v102, v36, v8, s[70:71]
AF v26,v18,v19
M v[156:159],a[92:95],v[60:63],v[156:159]
E v21,v67
M v[152:155],a[92:95],v[56:59],v[152:155]
v_cndmask_b32 v103, v36, v8, s[72:73]
C v40,v18,v19
M v[152:155],a[88:91],v[48:51],v[152:155]
s_waitcnt lgkmcnt(0)
buffer_load_dwordx4 v4, s[8:11], s26 offen offset:3072 sc1 lds
M v[160:163],a[96:99],v[48:51],v[160:163]
s_cmp_gt_u32 s20, 2
R a[64:67],v7,49152
R a[68:71],v7,50176
M v[160:163],a[100:103],v[56:59],v[160:163]
s_cselect_b64 s[82:83], -1, 0
E v22,v72
M v[164:167],a[100:103],v[60:63],v[164:167]
s_cmp_eq_u32 s20, 2
AF v26,v20,v26
C v41,v20,v21
M v[164:167],a[96:99],v[52:55],v[164:167]
s_mul_i32 s21, s41, 1048576
R a[72:75],v7,51200
R a[76:79],v7,52224
M v[172:175],a[104:107],v[52:55],v[172:175]
s_cselect_b64 s[74:75], s[16:17], s[82:83]
E v23,v73
M v[172:175],a[108:111],v[60:63],v[172:175]
s_cselect_b64 s[76:77], s[18:19], s[82:83]
AF v26,v21,v26
AF v26,v22,v26
M v[168:171],a[108:111],v[56:59],v[168:171]
s_cselect_b64 s[78:79], s[48:49], s[82:83]
R a[80:83],v7,53248
R a[84:87],v7,54272
M v[168:171],a[104:107],v[48:51],v[168:171]
s_cselect_b64 s[80:81], s[50:51], s[82:83]
v_cndmask_b32 v108, v36, v8, s[74:75]
v_cndmask_b32 v109, v36, v8, s[76:77]
M v[176:179],a[112:115],v[48:51],v[176:179]
SA s21,s21,589824
E v24,v74
M v[176:179],a[116:119],v[56:59],v[176:179]
s_lshl_b32 s84, s42, 1
R a[88:91],v7,55296
R a[92:95],v7,56320
M v[180:183],a[116:119],v[60:63],v[180:183]
s_sub_u32 s22, 11, s84
v_cndmask_b32 v110, v36, v8, s[78:79]
C v42,v22,v23
M v[180:183],a[112:115],v[52:55],v[180:183]
s_mov_b32 s23, 536870912
s_waitcnt vmcnt(16)
v_cmp_gt_u32 vcc, 2, v5
AF v26,v23,v26
M v[188:191],a[120:123],v[52:55],v[188:191]
s_cbranch_vccnz L_lsh2
L_lrh2:
v_cndmask_b32 v111, v36, v8, s[80:81]
M v[188:191],a[124:127],v[60:63],v[188:191]
SA m0,s28,98304
E v25,v75
M v[184:187],a[124:127],v[56:59],v[184:187]
s_cmp_gt_u32 s20, 1
buffer_load_dwordx4 v3, s[8:11], s21 offen offset:0 sc1 lds
M v[184:187],a[120:123],v[48:51],v[184:187]
s_waitcnt lgkmcnt(0)
E v18,v68
M v[192:195],a[64:67],v[48:51],v[192:195]
s_cselect_b64 s[82:83], -1, 0
R a[96:99],v7,57344
R a[100:103],v7,58368
M v[192:195],a[68:71],v[56:59],v[192:195]
s_cmp_eq_u32 s20, 1
buffer_load_dwordx4 v3, s[8:11], s21 offen offset:1024 sc1 lds
M v[196:199],a[68:71],v[60:63],v[196:199]
s_cselect_b64 s[66:67], s[16:17], s[82:83]
E v19,v69
M v[196:199],a[64:67],v[52:55],v[196:199]
s_cselect_b64 s[68:69], s[18:19], s[82:83]
R a[104:107],v7,59392
R a[108:111],v7,60416
M v[204:207],a[72:75],v[52:55],v[204:207]
s_cselect_b64 s[70:71], s[48:49], s[82:83]
buffer_load_dwordx4 v3, s[8:11], s21 offen offset:2048 sc1 lds
M v[204:207],a[76:79],v[60:63],v[204:207]
s_cselect_b64 s[72:73], s[50:51], s[82:83]
v_cndmask_b32 v116, v36, v8, s[66:67]
v_cndmask_b32 v117, v36, v8, s[68:69]
M v[200:203],a[76:79],v[56:59],v[200:203]
R a[112:115],v7,61440
R a[116:119],v7,62464
M v[200:203],a[72:75],v[48:51],v[200:203]
v_cndmask_b32 v118, v36, v8, s[70:71]
AF v26,v24,v26
M v[208:211],a[80:83],v[48:51],v[208:211]
buffer_load_dwordx4 v3, s[8:11], s21 offen offset:3072 sc1 lds
M v[208:211],a[84:87],v[56:59],v[208:211]
SA m0,s28,102400
R a[120:123],v7,63488
R a[124:127],v7,64512
M v[212:215],a[84:87],v[60:63],v[212:215]
v_cndmask_b32 v119, v36, v8, s[72:73]
C v43,v24,v25
M v[212:215],a[80:83],v[52:55],v[212:215]
s_cmp_gt_u32 s20, 0
E v20,v70
M v[220:223],a[88:91],v[52:55],v[220:223]
s_cselect_b64 s[82:83], -1, 0
buffer_load_dwordx4 v4, s[8:11], s21 offen offset:0 sc1 lds
M v[220:223],a[92:95],v[60:63],v[220:223]
s_cmp_eq_u32 s20, 0
E v21,v71
M v[216:219],a[92:95],v[56:59],v[216:219]
s_waitcnt lgkmcnt(0)
E v22,v76
M v[216:219],a[88:91],v[48:51],v[216:219]
s_barrier
M v[224:227],a[96:99],v[48:51],v[224:227]
s_cselect_b64 s[74:75], s[16:17], s[82:83]
R a[64:67],v2,0
R a[68:71],v2,1024
M v[224:227],a[100:103],v[56:59],v[224:227]
s_cselect_b64 s[76:77], s[18:19], s[82:83]
buffer_load_dwordx4 v4, s[8:11], s21 offen offset:1024 sc1 lds
M v[228:231],a[100:103],v[60:63],v[228:231]
s_cselect_b64 s[78:79], s[48:49], s[82:83]
E v23,v77
M v[228:231],a[96:99],v[52:55],v[228:231]
s_cselect_b64 s[80:81], s[50:51], s[82:83]
R a[72:75],v2,2048
R a[76:79],v2,3072
M v[236:239],a[104:107],v[52:55],v[236:239]
v_cndmask_b32 v124, v36, v8, s[74:75]
v_cndmask_b32 v125, v36, v8, s[76:77]
M v[236:239],a[108:111],v[60:63],v[236:239]
buffer_load_dwordx4 v4, s[8:11], s21 offen offset:2048 sc1 lds
M v[232:235],a[108:111],v[56:59],v[232:235]
R a[80:83],v2,4096
R a[84:87],v2,5120
M v[232:235],a[104:107],v[48:51],v[232:235]
v_cndmask_b32 v126, v36, v8, s[78:79]
AF v26,v25,v26
M v[240:243],a[112:115],v[48:51],v[240:243]
v_cndmask_b32 v127, v36, v8, s[80:81]
AF v27,v18,v19
M v[240:243],a[116:119],v[56:59],v[240:243]
R a[88:91],v2,6144
R a[92:95],v2,7168
M v[244:247],a[116:119],v[60:63],v[244:247]
buffer_load_dwordx4 v4, s[8:11], s21 offen offset:3072 sc1 lds
M v[244:247],a[112:115],v[52:55],v[244:247]
SA s21,s21,32768
E v24,v78
M v[252:255],a[120:123],v[52:55],v[252:255]
s_sub_u32 s22, s22, 1
E v25,v79
M v[252:255],a[124:127],v[60:63],v[252:255]
s_cselect_b32 s21, s23, s21
C v44,v18,v19
AF v27,v20,v27
M v[248:251],a[124:127],v[56:59],v[248:251]
s_waitcnt lgkmcnt(0)
C v45,v20,v21
AF v27,v21,v27
M v[248:251],a[120:123],v[48:51],v[248:251]
AF v27,v22,v27
C v46,v22,v23
AF v27,v23,v27
AF v27,v24,v27
C v47,v24,v25
AF v27,v25,v27
L_d3h:
M v[100:103],a[64:67],a[32:35],v[100:103]
R a[96:99],v2,8192
R a[100:103],v2,9216
M v[100:103],a[68:71],a[36:39],v[100:103]
R a[104:107],v2,10240
R a[108:111],v2,11264
M v[100:103],a[72:75],a[40:43],v[100:103]
R a[112:115],v2,12288
R a[116:119],v2,13312
M v[100:103],a[76:79],a[44:47],v[100:103]
R a[120:123],v2,14336
R a[124:127],v2,15360
M v[100:103],a[80:83],a[48:51],v[100:103]
v_add_u32 v8, 0x20000, v7
M v[100:103],a[84:87],a[52:55],v[100:103]
buffer_load_dword v5, v9, s[8:11], s46 offen sc1
M v[100:103],a[88:91],a[56:59],v[100:103]
buffer_load_dword v6, off, s[8:11], s47 offset:16 sc1
M v[100:103],a[92:95],a[60:63],v[100:103]
s_waitcnt lgkmcnt(0)
E v18,v80
M v[108:111],a[96:99],a[32:35],v[108:111]
R a[64:67],v2,16384
R a[68:71],v2,17408
M v[108:111],a[100:103],a[36:39],v[108:111]
R a[72:75],v2,18432
R a[76:79],v2,19456
M v[108:111],a[104:107],a[40:43],v[108:111]
R a[80:83],v2,20480
R a[84:87],v2,21504
M v[108:111],a[108:111],a[44:47],v[108:111]
R a[88:91],v2,22528
R a[92:95],v2,23552
M v[108:111],a[112:115],a[48:51],v[108:111]
E v19,v81
M v[108:111],a[116:119],a[52:55],v[108:111]
E v20,v82
M v[108:111],a[120:123],a[56:59],v[108:111]
E v21,v83
M v[108:111],a[124:127],a[60:63],v[108:111]
s_waitcnt lgkmcnt(0)
E v22,v88
M v[116:119],a[64:67],a[32:35],v[116:119]
R a[96:99],v2,24576
R a[100:103],v2,25600
M v[116:119],a[68:71],a[36:39],v[116:119]
R a[104:107],v2,26624
R a[108:111],v2,27648
M v[116:119],a[72:75],a[40:43],v[116:119]
R a[112:115],v2,28672
R a[116:119],v2,29696
M v[116:119],a[76:79],a[44:47],v[116:119]
R a[120:123],v2,30720
R a[124:127],v2,31744
M v[116:119],a[80:83],a[48:51],v[116:119]
E v23,v89
M v[116:119],a[84:87],a[52:55],v[116:119]
E v24,v90
M v[116:119],a[88:91],a[56:59],v[116:119]
s_waitcnt vmcnt(18) lgkmcnt(0)
E v25,v91
M v[116:119],a[92:95],a[60:63],v[116:119]
s_barrier
M v[124:127],a[96:99],a[32:35],v[124:127]
R a[64:67],v7,0
R a[68:71],v7,1024
M v[124:127],a[100:103],a[36:39],v[124:127]
R a[72:75],v7,2048
R a[76:79],v7,3072
M v[124:127],a[104:107],a[40:43],v[124:127]
R a[80:83],v7,4096
R a[84:87],v7,5120
M v[124:127],a[108:111],a[44:47],v[124:127]
R a[88:91],v7,6144
R a[92:95],v7,7168
M v[124:127],a[112:115],a[48:51],v[124:127]
AF v26,v18,v26
C v56,v18,v19
M v[124:127],a[116:119],a[52:55],v[124:127]
AF v26,v19,v26
AF v26,v20,v26
M v[124:127],a[120:123],a[56:59],v[124:127]
s_waitcnt lgkmcnt(0)
E v18,v84
M v[124:127],a[124:127],a[60:63],v[124:127]
E v19,v85
C v57,v20,v21
AF v26,v21,v26
AF v26,v22,v26
C v58,v22,v23
AF v26,v23,v26
AF v26,v24,v26
C v59,v24,v25
AF v26,v25,v26
E v20,v86
E v21,v87
AF v27,v18,v27
C v60,v18,v19
AF v27,v19,v27
E v22,v92
E v23,v93
AF v27,v20,v27
C v61,v20,v21
AF v27,v21,v27
E v24,v94
E v25,v95
AF v27,v22,v27
C v62,v22,v23
AF v27,v23,v27
AF v27,v24,v27
C v63,v24,v25
AF v27,v25,v27
v_max_f32 v10, v26, v27
v_cmp_lt_f32 vcc, s31, v10
s_nop 0
s_cbranch_vccnz L_std3h
L_rtd3h:
M v[128:131],a[64:67],v[40:43],v[128:131]
R a[96:99],v7,8192
R a[100:103],v7,9216
M v[128:131],a[68:71],v[56:59],v[128:131]
s_waitcnt vmcnt(0)
v_cmp_ne_u32 vcc, 1, v6
AF v30,v26,v30
M v[132:135],a[68:71],v[60:63],v[132:135]
s_cbranch_vccnz L_fqs
L_fqr:
E v18,v100
M v[132:135],a[64:67],v[44:47],v[132:135]
SA s73,s32,4096
R a[104:107],v7,10240
R a[108:111],v7,11264
M v[140:143],a[72:75],v[44:47],v[140:143]
SA s74,s32,8192
E v19,v101
M v[140:143],a[76:79],v[60:63],v[140:143]
SA s75,s32,12288
buffer_load_dwordx4 a[0:3], v7, s[8:11], s32 offen offset:0 sc1
M v[136:139],a[76:79],v[56:59],v[136:139]
R a[112:115],v7,12288
R a[116:119],v7,13312
M v[136:139],a[72:75],v[40:43],v[136:139]
E v20,v102
M v[144:147],a[80:83],v[40:43],v[144:147]
buffer_load_dwordx4 a[4:7], v7, s[8:11], s32 offen offset:1024 sc1
M v[144:147],a[84:87],v[56:59],v[144:147]
R a[120:123],v7,14336
R a[124:127],v7,15360
M v[148:151],a[84:87],v[60:63],v[148:151]
AF v31,v27,v31
AF v29,v18,v19
M v[148:151],a[80:83],v[44:47],v[148:151]
buffer_load_dwordx4 a[8:11], v7, s[8:11], s32 offen offset:2048 sc1
M v[156:159],a[88:91],v[44:47],v[156:159]
E v21,v103
M v[156:159],a[92:95],v[60:63],v[156:159]
C v52,v18,v19
AF v29,v20,v29
M v[152:155],a[92:95],v[56:59],v[152:155]
buffer_load_dwordx4 a[12:15], v7, s[8:11], s32 offen offset:3072 sc1
M v[152:155],a[88:91],v[40:43],v[152:155]
s_waitcnt lgkmcnt(0)
E v22,v108
M v[160:163],a[96:99],v[40:43],v[160:163]
R a[64:67],v7,16384
R a[68:71],v7,17408
M v[160:163],a[100:103],v[56:59],v[160:163]
buffer_load_dwordx4 a[16:19], v7, s[8:11], s73 offen offset:0 sc1
M v[164:167],a[100:103],v[60:63],v[164:167]
E v23,v109
M v[164:167],a[96:99],v[44:47],v[164:167]
R a[72:75],v7,18432
R a[76:79],v7,19456
M v[172:175],a[104:107],v[44:47],v[172:175]
buffer_load_dwordx4 a[20:23], v7, s[8:11], s73 offen offset:1024 sc1
M v[172:175],a[108:111],v[60:63],v[172:175]
C v53,v20,v21
AF v29,v21,v29
M v[168:171],a[108:111],v[56:59],v[168:171]
R a[80:83],v7,20480
R a[84:87],v7,21504
M v[168:171],a[104:107],v[40:43],v[168:171]
buffer_load_dwordx4 a[24:27], v7, s[8:11], s73 offen offset:2048 sc1
M v[176:179],a[112:115],v[40:43],v[176:179]
E v24,v110
M v[176:179],a[116:119],v[56:59],v[176:179]
R a[88:91],v7,22528
R a[92:95],v7,23552
M v[180:183],a[116:119],v[60:63],v[180:183]
buffer_load_dwordx4 a[28:31], v7, s[8:11], s73 offen offset:3072 sc1
M v[180:183],a[112:115],v[44:47],v[180:183]
E v25,v111
M v[188:191],a[120:123],v[44:47],v[188:191]
AF v29,v22,v29
C v54,v22,v23
M v[188:191],a[124:127],v[60:63],v[188:191]
buffer_load_dwordx4 a[32:35], v7, s[8:11], s74 offen offset:0 sc1
M v[184:187],a[124:127],v[56:59],v[184:187]
E v18,v116
M v[184:187],a[120:123],v[40:43],v[184:187]
s_waitcnt lgkmcnt(0)
AF v29,v23,v29
AF v29,v24,v29
M v[192:195],a[64:67],v[40:43],v[192:195]
R a[96:99],v7,24576
R a[100:103],v7,25600
M v[192:195],a[68:71],v[56:59],v[192:195]
buffer_load_dwordx4 a[36:39], v7, s[8:11], s74 offen offset:1024 sc1
M v[196:199],a[68:71],v[60:63],v[196:199]
E v19,v117
M v[196:199],a[64:67],v[44:47],v[196:199]
R a[104:107],v7,26624
R a[108:111],v7,27648
M v[204:207],a[72:75],v[44:47],v[204:207]
buffer_load_dwordx4 a[40:43], v7, s[8:11], s74 offen offset:2048 sc1
M v[204:207],a[76:79],v[60:63],v[204:207]
E v20,v118
M v[200:203],a[76:79],v[56:59],v[200:203]
R a[112:115],v7,28672
R a[116:119],v7,29696
M v[200:203],a[72:75],v[40:43],v[200:203]
buffer_load_dwordx4 a[44:47], v7, s[8:11], s74 offen offset:3072 sc1
M v[208:211],a[80:83],v[40:43],v[208:211]
C v55,v24,v25
AF v29,v25,v29
M v[208:211],a[84:87],v[56:59],v[208:211]
R a[120:123],v7,30720
R a[124:127],v7,31744
M v[212:215],a[84:87],v[60:63],v[212:215]
buffer_load_dwordx4 a[48:51], v7, s[8:11], s75 offen offset:0 sc1
M v[212:215],a[80:83],v[44:47],v[212:215]
E v21,v119
M v[220:223],a[88:91],v[44:47],v[220:223]
AF v29,v18,v29
C v48,v18,v19
M v[220:223],a[92:95],v[60:63],v[220:223]
buffer_load_dwordx4 a[52:55], v7, s[8:11], s75 offen offset:1024 sc1
M v[216:219],a[92:95],v[56:59],v[216:219]
s_waitcnt lgkmcnt(0)
E v22,v124
M v[216:219],a[88:91],v[40:43],v[216:219]
s_barrier
M v[224:227],a[96:99],v[40:43],v[224:227]
R a[64:67],v8,0
R a[68:71],v8,1024
M v[224:227],a[100:103],v[56:59],v[224:227]
buffer_load_dwordx4 a[56:59], v7, s[8:11], s75 offen offset:2048 sc1
M v[228:231],a[100:103],v[60:63],v[228:231]
v_mov_b32 v15, 4
AF v29,v19,v29
M v[228:231],a[96:99],v[44:47],v[228:231]
R a[72:75],v8,2048
R a[76:79],v8,3072
M v[236:239],a[104:107],v[44:47],v[236:239]
buffer_store_dword v15, v1, s[8:11], s45 offen sc1
M v[236:239],a[108:111],v[60:63],v[236:239]
buffer_load_dwordx4 a[60:63], v7, s[8:11], s75 offen offset:3072 sc1
M v[232:235],a[108:111],v[56:59],v[232:235]
s_cmp_ge_u32 s42, 2
R a[80:83],v8,4096
R a[84:87],v8,5120
M v[232:235],a[104:107],v[40:43],v[232:235]
s_cselect_b32 s84, 4, 2
v_cmp_gt_u32 vcc, s84, v5
AF v29,v20,v29
M v[240:243],a[112:115],v[40:43],v[240:243]
s_cbranch_vccnz L_lsh4
L_lrh4:
E v23,v125
M v[240:243],a[116:119],v[56:59],v[240:243]
R a[88:91],v8,6144
R a[92:95],v8,7168
M v[244:247],a[116:119],v[60:63],v[244:247]
E v24,v126
M v[244:247],a[112:115],v[44:47],v[244:247]
E v25,v127
M v[252:255],a[120:123],v[44:47],v[252:255]
C v49,v20,v21
AF v29,v21,v29
M v[252:255],a[124:127],v[60:63],v[252:255]
AF v29,v22,v29
C v50,v22,v23
M v[248:251],a[124:127],v[56:59],v[248:251]
s_waitcnt lgkmcnt(0)
AF v29,v23,v29
AF v29,v24,v29
M v[248:251],a[120:123],v[40:43],v[248:251]
C v51,v24,v25
AF v29,v25,v29
v_cmp_lt_f32 vcc, s31, v29
s_nop 0
s_cbranch_vccnz L_std4h
L_rtd4h:
M v[132:135],a[64:67],v[52:55],v[132:135]
R a[96:99],v8,8192
R a[100:103],v8,9216
M v[132:135],a[68:71],v[48:51],v[132:135]
R a[104:107],v8,10240
R a[108:111],v8,11264
M v[140:143],a[72:75],v[52:55],v[140:143]
SA m0,s28,65536
R a[112:115],v8,12288
R a[116:119],v8,13312
M v[140:143],a[76:79],v[48:51],v[140:143]
R a[120:123],v8,14336
R a[124:127],v8,15360
M v[148:151],a[80:83],v[52:55],v[148:151]
buffer_load_dwordx4 v3, s[8:11], s21 offen offset:0 sc1 lds
M v[148:151],a[84:87],v[48:51],v[148:151]
AF v31,v29,v31
v_mov_b32 v10, v30
M v[156:159],a[88:91],v[52:55],v[156:159]
v_mov_b32 v11, v31
C v128,v128,v129
M v[156:159],a[92:95],v[48:51],v[156:159]
s_waitcnt lgkmcnt(0)
v_permlane16_swap_b32 v10, v30
M v[164:167],a[96:99],v[52:55],v[164:167]
R a[64:67],v8,16384
R a[68:71],v8,17408
M v[164:167],a[100:103],v[48:51],v[164:167]
R a[72:75],v8,18432
R a[76:79],v8,19456
M v[172:175],a[104:107],v[52:55],v[172:175]
R a[80:83],v8,20480
R a[84:87],v8,21504
M v[172:175],a[108:111],v[48:51],v[172:175]
R a[88:91],v8,22528
R a[92:95],v8,23552
M v[180:183],a[112:115],v[52:55],v[180:183]
buffer_load_dwordx4 v3, s[8:11], s21 offen offset:1024 sc1 lds
M v[180:183],a[116:119],v[48:51],v[180:183]
v_permlane16_swap_b32 v11, v31
M v[188:191],a[120:123],v[52:55],v[188:191]
AF v30,v10,v30
AF v31,v11,v31
M v[188:191],a[124:127],v[48:51],v[188:191]
s_waitcnt lgkmcnt(0)
buffer_load_dwordx4 v3, s[8:11], s21 offen offset:2048 sc1 lds
M v[196:199],a[64:67],v[52:55],v[196:199]
R a[96:99],v8,24576
R a[100:103],v8,25600
M v[196:199],a[68:71],v[48:51],v[196:199]
R a[104:107],v8,26624
R a[108:111],v8,27648
M v[204:207],a[72:75],v[52:55],v[204:207]
R a[112:115],v8,28672
R a[116:119],v8,29696
M v[204:207],a[76:79],v[48:51],v[204:207]
R a[120:123],v8,30720
R a[124:127],v8,31744
M v[212:215],a[80:83],v[52:55],v[212:215]
buffer_load_dwordx4 v3, s[8:11], s21 offen offset:3072 sc1 lds
M v[212:215],a[84:87],v[48:51],v[212:215]
SA m0,s28,69632
v_mov_b32 v10, v30
v_mov_b32 v11, v31
M v[220:223],a[88:91],v[52:55],v[220:223]
s_waitcnt lgkmcnt(0)
v_permlane32_swap_b32 v10, v30
M v[220:223],a[92:95],v[48:51],v[220:223]
s_barrier
M v[228:231],a[96:99],v[52:55],v[228:231]
R a[64:67],v2,32768
R a[68:71],v2,33792
M v[228:231],a[100:103],v[48:51],v[228:231]
R a[72:75],v2,34816
R a[76:79],v2,35840
M v[236:239],a[104:107],v[52:55],v[236:239]
R a[80:83],v2,36864
R a[84:87],v2,37888
M v[236:239],a[108:111],v[48:51],v[236:239]
R a[88:91],v2,38912
R a[92:95],v2,39936
M v[244:247],a[112:115],v[52:55],v[244:247]
v_permlane32_swap_b32 v11, v31
M v[244:247],a[116:119],v[48:51],v[244:247]
s_waitcnt vmcnt(4)
buffer_load_dwordx4 v4, s[8:11], s21 offen offset:0 sc1 lds
M v[252:255],a[120:123],v[52:55],v[252:255]
s_waitcnt lgkmcnt(0)
AF v30,v10,v30
AF v31,v11,v31
M v[252:255],a[124:127],v[48:51],v[252:255]
v_rcp_f32 v5, v30
M v[64:67],a[64:67],a[0:3],0
R a[96:99],v2,40960
R a[100:103],v2,41984
M v[64:67],a[68:71],a[4:7],v[64:67]
v_rcp_f32 v6, v31
M v[64:67],a[72:75],a[8:11],v[64:67]
buffer_load_dwordx4 v4, s[8:11], s21 offen offset:1024 sc1 lds
M v[64:67],a[76:79],a[12:15],v[64:67]
R a[104:107],v2,43008
R a[108:111],v2,44032
M v[64:67],a[80:83],a[16:19],v[64:67]
W a192,v5
W a193,v6
M v[64:67],a[84:87],a[20:23],v[64:67]
buffer_load_dwordx4 v4, s[8:11], s21 offen offset:2048 sc1 lds
M v[64:67],a[88:91],a[24:27],v[64:67]
R a[112:115],v2,45056
R a[116:119],v2,46080
M v[64:67],a[92:95],a[28:31],v[64:67]
v_mov_b32 v30, 0
v_mov_b32 v31, 0
M v[68:71],a[92:95],a[60:63],0
buffer_load_dwordx4 v4, s[8:11], s21 offen offset:3072 sc1 lds
M v[68:71],a[88:91],a[56:59],v[68:71]
SA s21,s21,32768
R a[120:123],v2,47104
R a[124:127],v2,48128
M v[68:71],a[84:87],a[52:55],v[68:71]
s_sub_u32 s22, s22, 1
v_mov_b32 v32, 0
v_mov_b32 v33, 0
M v[68:71],a[80:83],a[48:51],v[68:71]
s_cselect_b32 s21, s23, s21
v_mov_b32 v34, 0
v_mov_b32 v35, 0
M v[68:71],a[76:79],a[44:47],v[68:71]
s_mul_i32 s26, s41, 1048576
v_mov_b32 v36, 0
v_mov_b32 v37, 0
M v[68:71],a[72:75],a[40:43],v[68:71]
SA s26,s26,17367040
v_mov_b32 v38, 0
v_mov_b32 v39, 0
M v[68:71],a[68:71],a[36:39],v[68:71]
SA m0,s28,0
E v18,v64
M v[68:71],a[64:67],a[32:35],v[68:71]
s_waitcnt lgkmcnt(0)
buffer_load_dwordx4 v3, s[8:11], s26 offen offset:0 sc1 lds
M v[72:75],a[96:99],a[0:3],0
R a[64:67],v2,49152
R a[68:71],v2,50176
M v[72:75],a[100:103],a[4:7],v[72:75]
E v19,v65
M v[72:75],a[104:107],a[8:11],v[72:75]
buffer_load_dwordx4 v3, s[8:11], s26 offen offset:1024 sc1 lds
M v[72:75],a[108:111],a[12:15],v[72:75]
R a[72:75],v2,51200
R a[76:79],v2,52224
M v[72:75],a[112:115],a[16:19],v[72:75]
E v20,v66
M v[72:75],a[116:119],a[20:23],v[72:75]
buffer_load_dwordx4 v3, s[8:11], s26 offen offset:2048 sc1 lds
M v[72:75],a[120:123],a[24:27],v[72:75]
R a[80:83],v2,53248
R a[84:87],v2,54272
M v[72:75],a[124:127],a[28:31],v[72:75]
E v21,v67
M v[76:79],a[124:127],a[60:63],0
buffer_load_dwordx4 v3, s[8:11], s26 offen offset:3072 sc1 lds
M v[76:79],a[120:123],a[56:59],v[76:79]
SA m0,s28,4096
R a[88:91],v2,55296
R a[92:95],v2,56320
M v[76:79],a[116:119],a[52:55],v[76:79]
E v22,v68
M v[76:79],a[112:115],a[48:51],v[76:79]
E v23,v69
M v[76:79],a[108:111],a[44:47],v[76:79]
buffer_load_dwordx4 v4, s[8:11], s26 offen offset:0 sc1 lds
M v[76:79],a[104:107],a[40:43],v[76:79]
AF v26,v18,v19
C v40,v18,v19
M v[76:79],a[100:103],a[36:39],v[76:79]
E v24,v70
M v[76:79],a[96:99],a[32:35],v[76:79]
s_waitcnt lgkmcnt(0)
AF v26,v20,v26
C v41,v20,v21
M v[80:83],a[64:67],a[0:3],0
R a[96:99],v2,57344
R a[100:103],v2,58368
M v[80:83],a[68:71],a[4:7],v[80:83]
buffer_load_dwordx4 v4, s[8:11], s26 offen offset:1024 sc1 lds
M v[80:83],a[72:75],a[8:11],v[80:83]
E v25,v71
M v[80:83],a[76:79],a[12:15],v[80:83]
R a[104:107],v2,59392
R a[108:111],v2,60416
M v[80:83],a[80:83],a[16:19],v[80:83]
AF v26,v21,v26
AF v27,v22,v23
M v[80:83],a[84:87],a[20:23],v[80:83]
buffer_load_dwordx4 v4, s[8:11], s26 offen offset:2048 sc1 lds
M v[80:83],a[88:91],a[24:27],v[80:83]
R a[112:115],v2,61440
R a[116:119],v2,62464
M v[80:83],a[92:95],a[28:31],v[80:83]
E v18,v72
M v[84:87],a[92:95],a[60:63],0
E v19,v73
M v[84:87],a[88:91],a[56:59],v[84:87]
R a[120:123],v2,63488
R a[124:127],v2,64512
M v[84:87],a[84:87],a[52:55],v[84:87]
buffer_load_dwordx4 v4, s[8:11], s26 offen offset:3072 sc1 lds
M v[84:87],a[80:83],a[48:51],v[84:87]
SA s26,s26,32768
E v20,v74
M v[84:87],a[76:79],a[44:47],v[84:87]
SA m0,s28,32768
C v44,v22,v23
AF v27,v24,v27
M v[84:87],a[72:75],a[40:43],v[84:87]
C v45,v24,v25
AF v27,v25,v27
M v[84:87],a[68:71],a[36:39],v[84:87]
s_waitcnt vmcnt(8) lgkmcnt(0)
buffer_load_dwordx4 v3, s[8:11], s26 offen offset:0 sc1 lds
M v[84:87],a[64:67],a[32:35],v[84:87]
s_barrier
M v[88:91],a[96:99],a[0:3],0
R a[64:67],v2,0
R a[68:71],v2,1024
M v[88:91],a[100:103],a[4:7],v[88:91]
E v21,v75
M v[88:91],a[104:107],a[8:11],v[88:91]
buffer_load_dwordx4 v3, s[8:11], s26 offen offset:1024 sc1 lds
M v[88:91],a[108:111],a[12:15],v[88:91]
R a[72:75],v2,2048
R a[76:79],v2,3072
M v[88:91],a[112:115],a[16:19],v[88:91]
E v22,v76
M v[88:91],a[116:119],a[20:23],v[88:91]
E v23,v77
M v[88:91],a[120:123],a[24:27],v[88:91]
R a[80:83],v2,4096
R a[84:87],v2,5120
M v[88:91],a[124:127],a[28:31],v[88:91]
buffer_load_dwordx4 v3, s[8:11], s26 offen offset:2048 sc1 lds
M v[92:95],a[124:127],a[60:63],0
E v24,v78
M v[92:95],a[120:123],a[56:59],v[92:95]
R a[88:91],v2,6144
R a[92:95],v2,7168
M v[92:95],a[116:119],a[52:55],v[92:95]
E v25,v79
M v[92:95],a[112:115],a[48:51],v[92:95]
buffer_load_dwordx4 v3, s[8:11], s26 offen offset:3072 sc1 lds
M v[92:95],a[108:111],a[44:47],v[92:95]
AF v26,v18,v26
C v42,v18,v19
M v[92:95],a[104:107],a[40:43],v[92:95]
AF v26,v19,v26
AF v26,v20,v26
M v[92:95],a[100:103],a[36:39],v[92:95]
s_waitcnt lgkmcnt(0)
C v43,v20,v21
AF v26,v21,v26
M v[92:95],a[96:99],a[32:35],v[92:95]
AF v27,v22,v27
C v46,v22,v23
AF v27,v23,v27
AF v27,v24,v27
C v47,v24,v25
AF v27,v25,v27
M v[96:99],a[64:67],a[0:3],0
R a[96:99],v2,8192
R a[100:103],v2,9216
M v[96:99],a[68:71],a[4:7],v[96:99]
SA m0,s28,98304
E v18,v80
M v[96:99],a[72:75],a[8:11],v[96:99]
buffer_load_dwordx4 v3, s[8:11], s21 offen offset:0 sc1 lds
M v[96:99],a[76:79],a[12:15],v[96:99]
R a[104:107],v2,10240
R a[108:111],v2,11264
M v[96:99],a[80:83],a[16:19],v[96:99]
E v19,v81
M v[96:99],a[84:87],a[20:23],v[96:99]
AF v26,v18,v26
C v56,v18,v19
M v[96:99],a[88:91],a[24:27],v[96:99]
R a[112:115],v2,12288
R a[116:119],v2,13312
M v[96:99],a[92:95],a[28:31],v[96:99]
buffer_load_dwordx4 v3, s[8:11], s21 offen offset:1024 sc1 lds
M v[100:103],a[92:95],a[60:63],0
E v20,v82
M v[100:103],a[88:91],a[56:59],v[100:103]
R a[120:123],v2,14336
R a[124:127],v2,15360
M v[100:103],a[84:87],a[52:55],v[100:103]
E v21,v83
M v[100:103],a[80:83],a[48:51],v[100:103]
buffer_load_dwordx4 v3, s[8:11], s21 offen offset:2048 sc1 lds
M v[100:103],a[76:79],a[44:47],v[100:103]
AF v26,v19,v26
AF v26,v20,v26
M v[100:103],a[72:75],a[40:43],v[100:103]
E v22,v88
M v[100:103],a[68:71],a[36:39],v[100:103]
C v57,v20,v21
AF v26,v21,v26
M v[100:103],a[64:67],a[32:35],v[100:103]
s_waitcnt lgkmcnt(0)
buffer_load_dwordx4 v3, s[8:11], s21 offen offset:3072 sc1 lds
M v[108:111],a[96:99],a[32:35],0
R a[64:67],v2,16384
R a[68:71],v2,17408
M v[108:111],a[100:103],a[36:39],v[108:111]
E v23,v89
M v[108:111],a[104:107],a[40:43],v[108:111]
SA m0,s28,102400
AF v26,v22,v26
C v58,v22,v23
M v[108:111],a[108:111],a[44:47],v[108:111]
R a[72:75],v2,18432
R a[76:79],v2,19456
M v[108:111],a[112:115],a[48:51],v[108:111]
buffer_load_dwordx4 v4, s[8:11], s21 offen offset:0 sc1 lds
M v[108:111],a[116:119],a[52:55],v[108:111]
E v24,v90
M v[108:111],a[120:123],a[56:59],v[108:111]
R a[80:83],v2,20480
R a[84:87],v2,21504
M v[108:111],a[124:127],a[60:63],v[108:111]
E v25,v91
M v[104:107],a[124:127],a[28:31],0
buffer_load_dwordx4 v4, s[8:11], s21 offen offset:1024 sc1 lds
M v[104:107],a[120:123],a[24:27],v[104:107]
R a[88:91],v2,22528
R a[92:95],v2,23552
M v[104:107],a[116:119],a[20:23],v[104:107]
AF v26,v23,v26
AF v26,v24,v26
M v[104:107],a[112:115],a[16:19],v[104:107]
E v18,v84
M v[104:107],a[108:111],a[12:15],v[104:107]
buffer_load_dwordx4 v4, s[8:11], s21 offen offset:2048 sc1 lds
M v[104:107],a[104:107],a[8:11],v[104:107]
C v59,v24,v25
AF v26,v25,v26
M v[104:107],a[100:103],a[4:7],v[104:107]
E v19,v85
M v[104:107],a[96:99],a[0:3],v[104:107]
s_waitcnt lgkmcnt(0)
AF v27,v18,v27
C v60,v18,v19
M v[112:115],a[64:67],a[0:3],0
R a[96:99],v2,24576
R a[100:103],v2,25600
M v[112:115],a[68:71],a[4:7],v[112:115]
buffer_load_dwordx4 v4, s[8:11], s21 offen offset:3072 sc1 lds
M v[112:115],a[72:75],a[8:11],v[112:115]
SA s21,s21,32768
E v20,v86
M v[112:115],a[76:79],a[12:15],v[112:115]
s_sub_u32 s22, s22, 1
R a[104:107],v2,26624
R a[108:111],v2,27648
M v[112:115],a[80:83],a[16:19],v[112:115]
s_cselect_b32 s21, s23, s21
AF v27,v19,v27
C v129,v130,v131
M v[112:115],a[84:87],a[20:23],v[112:115]
SA m0,s28,36864
E v21,v87
M v[112:115],a[88:91],a[24:27],v[112:115]
R a[112:115],v2,28672
R a[116:119],v2,29696
M v[112:115],a[92:95],a[28:31],v[112:115]
buffer_load_dwordx4 v4, s[8:11], s26 offen offset:0 sc1 lds
M v[116:119],a[92:95],a[60:63],0
E v22,v92
M v[116:119],a[88:91],a[56:59],v[116:119]
R a[120:123],v2,30720
R a[124:127],v2,31744
M v[116:119],a[84:87],a[52:55],v[116:119]
AF v27,v20,v27
C v61,v20,v21
M v[116:119],a[80:83],a[48:51],v[116:119]
buffer_load_dwordx4 v4, s[8:11], s26 offen offset:1024 sc1 lds
M v[116:119],a[76:79],a[44:47],v[116:119]
E v23,v93
M v[116:119],a[72:75],a[40:43],v[116:119]
AF v27,v21,v27
AF v27,v22,v27
M v[116:119],a[68:71],a[36:39],v[116:119]
s_waitcnt vmcnt(14) lgkmcnt(0)
C v62,v22,v23
AF v27,v23,v27
M v[116:119],a[64:67],a[32:35],v[116:119]
s_barrier
M v[124:127],a[96:99],a[32:35],0
R a[64:67],v7,0
R a[68:71],v7,1024
M v[124:127],a[100:103],a[36:39],v[124:127]
buffer_load_dwordx4 v4, s[8:11], s26 offen offset:2048 sc1 lds
M v[124:127],a[104:107],a[40:43],v[124:127]
E v24,v94
M v[124:127],a[108:111],a[44:47],v[124:127]
R a[72:75],v7,2048
R a[76:79],v7,3072
M v[124:127],a[112:115],a[48:51],v[124:127]
E v25,v95
M v[124:127],a[116:119],a[52:55],v[124:127]
buffer_load_dwordx4 v4, s[8:11], s26 offen offset:3072 sc1 lds
M v[124:127],a[120:123],a[56:59],v[124:127]
R a[80:83],v7,4096
R a[84:87],v7,5120
M v[124:127],a[124:127],a[60:63],v[124:127]
AF v27,v24,v27
C v63,v24,v25
M v[120:123],a[124:127],a[28:31],0
SA s26,s26,32768
AF v27,v25,v27
C v130,v136,v137
M v[120:123],a[120:123],a[24:27],v[120:123]
R a[88:91],v7,6144
R a[92:95],v7,7168
C v131,v138,v139
W a128,v128
W a129,v129
W a130,v130
W a131,v131
C v144,v144,v145
C v145,v146,v147
C v146,v152,v153
C v147,v154,v155
W a132,v144
W a133,v145
W a134,v146
W a135,v147
C v132,v132,v133
C v133,v134,v135
C v134,v140,v141
C v135,v142,v143
W a160,v132
W a161,v133
W a162,v134
W a163,v135
C v160,v160,v161
C v161,v162,v163
C v162,v168,v169
C v163,v170,v171
W a136,v160
W a137,v161
W a138,v162
W a139,v163
C v148,v148,v149
C v149,v150,v151
C v150,v156,v157
C v151,v158,v159
W a164,v148
W a165,v149
W a166,v150
W a167,v151
C v176,v176,v177
C v177,v178,v179
C v178,v184,v185
C v179,v186,v187
W a140,v176
W a141,v177
W a142,v178
W a143,v179
C v164,v164,v165
C v165,v166,v167
C v166,v172,v173
C v167,v174,v175
W a168,v164
W a169,v165
W a170,v166
W a171,v167
C v192,v192,v193
C v193,v194,v195
C v194,v200,v201
C v195,v202,v203
W a144,v192
W a145,v193
W a146,v194
W a147,v195
C v180,v180,v181
C v181,v182,v183
C v182,v188,v189
C v183,v190,v191
W a172,v180
W a173,v181
W a174,v182
W a175,v183
C v208,v208,v209
C v209,v210,v211
C v210,v216,v217
C v211,v218,v219
W a148,v208
W a149,v209
W a150,v210
W a151,v211
C v196,v196,v197
C v197,v198,v199
C v198,v204,v205
C v199,v206,v207
W a176,v196
W a177,v197
W a178,v198
W a179,v199
C v224,v224,v225
C v225,v226,v227
C v226,v232,v233
C v227,v234,v235
W a152,v224
W a153,v225
W a154,v226
W a155,v227
C v212,v212,v213
C v213,v214,v215
C v214,v220,v221
C v215,v222,v223
W a180,v212
W a181,v213
W a182,v214
W a183,v215
C v240,v240,v241
C v241,v242,v243
C v242,v248,v249
C v243,v250,v251
W a156,v240
W a157,v241
W a158,v242
W a159,v243
C v228,v228,v229
C v229,v230,v231
C v230,v236,v237
C v231,v238,v239
W a184,v228
W a185,v229
W a186,v230
W a187,v231
C v244,v244,v245
C v245,v246,v247
C v246,v252,v253
C v247,v254,v255
W a188,v244
W a189,v245
W a190,v246
W a191,v247
M v[120:123],a[116:119],a[20:23],v[120:123]
M v[120:123],a[112:115],a[16:19],v[120:123]
M v[120:123],a[108:111],a[12:15],v[120:123]
M v[120:123],a[104:107],a[8:11],v[120:123]
M v[120:123],a[100:103],a[4:7],v[120:123]
s_waitcnt lgkmcnt(0)
M v[120:123],a[96:99],a[0:3],v[120:123]
v_max_f32 v10, v26, v27
v_min_f32 v11, v26, v27
v_cmp_lt_f32 vcc, s31, v10
v_cmp_gt_f32 s[64:65], s24, v11
s_nop 0
s_or_b64 vcc, vcc, s[64:65]
s_cbranch_vccnz L_sth1
L_rth1:
M v[128:131],a[64:67],v[40:43],0
R a[96:99],v7,8192
R a[100:103],v7,9216
M v[128:131],a[68:71],v[56:59],v[128:131]
SA m0,s28,65536
E v18,v96
M v[132:135],a[68:71],v[60:63],0
buffer_load_dwordx4 v3, s[8:11], s21 offen offset:0 sc1 lds
M v[132:135],a[64:67],v[44:47],v[132:135]
R a[104:107],v7,10240
R a[108:111],v7,11264
M v[140:143],a[72:75],v[44:47],0
E v19,v97
M v[140:143],a[76:79],v[60:63],v[140:143]
AF v30,v26,v30
AF v31,v27,v31
M v[136:139],a[76:79],v[56:59],0
R a[112:115],v7,12288
R a[116:119],v7,13312
M v[136:139],a[72:75],v[40:43],v[136:139]
buffer_load_dwordx4 v3, s[8:11], s21 offen offset:1024 sc1 lds
M v[144:147],a[80:83],v[40:43],0
E v20,v98
M v[144:147],a[84:87],v[56:59],v[144:147]
R a[120:123],v7,14336
R a[124:127],v7,15360
M v[148:151],a[84:87],v[60:63],0
s_mov_b32 s40, 0
AF v28,v18,v19
C v48,v18,v19
M v[148:151],a[80:83],v[44:47],v[148:151]
s_mov_b32 s7, 0
buffer_load_dwordx4 v3, s[8:11], s21 offen offset:2048 sc1 lds
M v[156:159],a[88:91],v[44:47],0
s_and_b32 s39, s39, 1
E v21,v99
M v[156:159],a[92:95],v[60:63],v[156:159]
s_or_b32 s39, s39, 2
AF v28,v20,v28
C v49,v20,v21
M v[152:155],a[92:95],v[56:59],0
s_sub_u32 s27, 5, s42
AF v28,v21,v28
M v[152:155],a[88:91],v[40:43],v[152:155]
s_waitcnt lgkmcnt(0)
buffer_load_dwordx4 v3, s[8:11], s21 offen offset:3072 sc1 lds
M v[160:163],a[96:99],v[40:43],0
SA m0,s28,69632
R a[64:67],v7,16384
R a[68:71],v7,17408
M v[160:163],a[100:103],v[56:59],v[160:163]
E v22,v104
M v[164:167],a[100:103],v[60:63],0
E v23,v105
M v[164:167],a[96:99],v[44:47],v[164:167]
R a[72:75],v7,18432
R a[76:79],v7,19456
M v[172:175],a[104:107],v[44:47],0
buffer_load_dwordx4 v4, s[8:11], s21 offen offset:0 sc1 lds
M v[172:175],a[108:111],v[60:63],v[172:175]
AF v28,v22,v28
C v50,v22,v23
M v[168:171],a[108:111],v[56:59],0
R a[80:83],v7,20480
R a[84:87],v7,21504
M v[168:171],a[104:107],v[40:43],v[168:171]
buffer_load_dwordx4 v4, s[8:11], s21 offen offset:1024 sc1 lds
M v[176:179],a[112:115],v[40:43],0
E v24,v106
M v[176:179],a[116:119],v[56:59],v[176:179]
R a[88:91],v7,22528
R a[92:95],v7,23552
M v[180:183],a[116:119],v[60:63],0
buffer_load_dwordx4 v4, s[8:11], s21 offen offset:2048 sc1 lds
M v[180:183],a[112:115],v[44:47],v[180:183]
E v25,v107
M v[188:191],a[120:123],v[44:47],0
AF v28,v23,v28
AF v28,v24,v28
M v[188:191],a[124:127],v[60:63],v[188:191]
C v51,v24,v25
AF v28,v25,v28
M v[184:187],a[124:127],v[56:59],0
buffer_load_dwordx4 v4, s[8:11], s21 offen offset:3072 sc1 lds
M v[184:187],a[120:123],v[40:43],v[184:187]
s_waitcnt lgkmcnt(0)
E v18,v100
M v[192:195],a[64:67],v[40:43],0
SA s21,s21,32768
R a[96:99],v7,24576
R a[100:103],v7,25600
M v[192:195],a[68:71],v[56:59],v[192:195]
s_sub_u32 s22, s22, 1
E v19,v101
M v[196:199],a[68:71],v[60:63],0
s_cselect_b32 s21, s23, s21
AF v29,v18,v19
C v52,v18,v19
M v[196:199],a[64:67],v[44:47],v[196:199]
R a[104:107],v7,26624
R a[108:111],v7,27648
M v[204:207],a[72:75],v[44:47],0
M v[204:207],a[76:79],v[60:63],v[204:207]
E v20,v102
M v[200:203],a[76:79],v[56:59],0
R a[112:115],v7,28672
R a[116:119],v7,29696
M v[200:203],a[72:75],v[40:43],v[200:203]
M v[208:211],a[80:83],v[40:43],0
M v[208:211],a[84:87],v[56:59],v[208:211]
R a[120:123],v7,30720
R a[124:127],v7,31744
M v[212:215],a[84:87],v[60:63],0
E v21,v103
M v[212:215],a[80:83],v[44:47],v[212:215]
AF v29,v20,v29
C v53,v20,v21
M v[220:223],a[88:91],v[44:47],0
AF v29,v21,v29
M v[220:223],a[92:95],v[60:63],v[220:223]
E v22,v108
M v[216:219],a[92:95],v[56:59],0
s_waitcnt vmcnt(12) lgkmcnt(0)
M v[216:219],a[88:91],v[40:43],v[216:219]
s_barrier
M v[224:227],a[96:99],v[40:43],0
R a[64:67],v2,32768
R a[68:71],v2,33792
M v[224:227],a[100:103],v[56:59],v[224:227]
E v23,v109
M v[228:231],a[100:103],v[60:63],0
AF v29,v22,v29
C v54,v22,v23
M v[228:231],a[96:99],v[44:47],v[228:231]
R a[72:75],v2,34816
R a[76:79],v2,35840
M v[236:239],a[104:107],v[44:47],0
E v24,v110
M v[236:239],a[108:111],v[60:63],v[236:239]
AF v29,v23,v29
M v[232:235],a[108:111],v[56:59],0
R a[80:83],v2,36864
R a[84:87],v2,37888
M v[232:235],a[104:107],v[40:43],v[232:235]
M v[240:243],a[112:115],v[40:43],0
E v25,v111
M v[240:243],a[116:119],v[56:59],v[240:243]
R a[88:91],v2,38912
R a[92:95],v2,39936
M v[244:247],a[116:119],v[60:63],0
AF v29,v24,v29
C v55,v24,v25
M v[244:247],a[112:115],v[44:47],v[244:247]
AF v29,v25,v29
M v[252:255],a[120:123],v[44:47],0
M v[252:255],a[124:127],v[60:63],v[252:255]
M v[248:251],a[124:127],v[56:59],0
s_waitcnt lgkmcnt(0)
M v[248:251],a[120:123],v[40:43],v[248:251]
s_cmp_lg_u32 s27, 0
s_cbranch_scc1 L_loop_top
L_final_h:
s_waitcnt vmcnt(8) lgkmcnt(0)
s_barrier
R a[64:67],v7,32768
R a[68:71],v7,33792
R a[72:75],v7,34816
R a[76:79],v7,35840
R a[80:83],v7,36864
R a[84:87],v7,37888
R a[88:91],v7,38912
R a[92:95],v7,39936
v_lshrrev_b32 v14, 7, v7
v_mul_u32_u24 v14, 896, v14
v_lshrrev_b32 v15, 8, v7
v_lshlrev_b32 v15, 5, v15
v_xor_b32 v15, v15, v7
v_and_b32 v15, 0x70, v15
v_add_u32 v0, v14, v15
s_mul_i32 s38, s20, 57344
SA m0,s28,98304
SA s85,s38,0
E v18,v112
buffer_load_dwordx4 v0, s[12:15], s85 offen offset:0 lds
E v19,v113
E v20,v114
AF v28,v18,v28
SA s85,s38,6144
C v56,v18,v19
buffer_load_dwordx4 v0, s[12:15], s85 offen offset:1024 lds
E v21,v115
AF v28,v19,v28
E v22,v120
AF v28,v20,v28
SA s85,s38,12288
C v57,v20,v21
buffer_load_dwordx4 v0, s[12:15], s85 offen offset:2048 lds
E v23,v121
AF v28,v21,v28
E v24,v122
AF v28,v22,v28
SA s85,s38,18432
C v58,v22,v23
buffer_load_dwordx4 v0, s[12:15], s85 offen offset:3072 lds
E v25,v123
AF v28,v23,v28
E v18,v116
AF v28,v24,v28
SA m0,s28,102400
SA s85,s38,28672
C v59,v24,v25
buffer_load_dwordx4 v0, s[12:15], s85 offen offset:0 lds
E v19,v117
AF v28,v25,v28
E v20,v118
AF v29,v18,v29
SA s85,s38,34816
C v60,v18,v19
buffer_load_dwordx4 v0, s[12:15], s85 offen offset:1024 lds
E v21,v119
AF v29,v19,v29
E v22,v124
AF v29,v20,v29
SA s85,s38,40960
C v61,v20,v21
buffer_load_dwordx4 v0, s[12:15], s85 offen offset:2048 lds
E v23,v125
AF v29,v21,v29
E v24,v126
AF v29,v22,v29
SA s85,s38,47104
C v62,v22,v23
buffer_load_dwordx4 v0, s[12:15], s85 offen offset:3072 lds
SA s38,s38,128
E v25,v127
AF v29,v23,v29
AF v29,v24,v29
C v63,v24,v25
AF v29,v25,v29
v_max_f32 v10, v28, v29
v_cmp_lt_f32 vcc, s31, v10
s_nop 0
s_cbranch_vccnz L_stfh
L_rtfh:
AF v30,v28,v30
AF v31,v29,v31
v_mov_b32 v10, v32
v_mov_b32 v11, v36
v_mov_b32 v12, v30
v_mov_b32 v13, v31
buffer_store_dwordx4 v[10:13], v7, s[8:11], s90 offen sc1
s_waitcnt lgkmcnt(0)
M v[128:131],a[64:67],v[48:51],v[128:131]
SA m0,s28,65536
R a[96:99],v7,40960
R a[100:103],v7,41984
M v[128:131],a[68:71],v[56:59],v[128:131]
SA s85,s38,0
buffer_load_dwordx4 v0, s[12:15], s85 offen offset:0 lds
M v[132:135],a[68:71],v[60:63],v[132:135]
SA s85,s38,6144
v_lshrrev_b32 v16, 4, v7
v_lshrrev_b32 v14, 2, v16
M v[132:135],a[64:67],v[52:55],v[132:135]
R a[104:107],v7,43008
R a[108:111],v7,44032
M v[136:139],a[72:75],v[48:51],v[136:139]
buffer_load_dwordx4 v0, s[12:15], s85 offen offset:1024 lds
M v[136:139],a[76:79],v[56:59],v[136:139]
SA s85,s38,12288
v_lshlrev_b32 v14, 7, v14
v_and_b32 v15, 3, v16
M v[140:143],a[76:79],v[60:63],v[140:143]
R a[112:115],v7,45056
R a[116:119],v7,46080
M v[140:143],a[72:75],v[52:55],v[140:143]
buffer_load_dwordx4 v0, s[12:15], s85 offen offset:2048 lds
M v[144:147],a[80:83],v[48:51],v[144:147]
SA s85,s38,18432
v_lshl_add_u32 v14, v15, 3, v14
v_bfe_u32 v15, v16, 3, 2
M v[144:147],a[84:87],v[56:59],v[144:147]
R a[120:123],v7,47104
R a[124:127],v7,48128
M v[148:151],a[84:87],v[60:63],v[148:151]
buffer_load_dwordx4 v0, s[12:15], s85 offen offset:3072 lds
M v[148:151],a[80:83],v[52:55],v[148:151]
v_lshl_add_u32 v18, v15, 5, v14
v_xor_b32 v19, 32, v18
M v[152:155],a[88:91],v[48:51],v[152:155]
v_xor_b32 v20, 64, v18
v_xor_b32 v21, 0x60, v18
M v[152:155],a[92:95],v[56:59],v[152:155]
v_add_u32 v22, 0x10000, v18
v_add_u32 v23, 0x10000, v19
M v[156:159],a[92:95],v[60:63],v[156:159]
v_add_u32 v24, 0x10000, v20
v_add_u32 v25, 0x10000, v21
M v[156:159],a[88:91],v[52:55],v[156:159]
s_waitcnt lgkmcnt(0)
C v128,v128,v129
C v129,v130,v131
M v[160:163],a[96:99],v[48:51],v[160:163]
R a[64:67],v7,49152
R a[68:71],v7,50176
M v[160:163],a[100:103],v[56:59],v[160:163]
C v130,v136,v137
C v131,v138,v139
M v[164:167],a[100:103],v[60:63],v[164:167]
buffer_store_dwordx4 v[128:131], v7, s[8:11], s86 offen offset:0 sc1
M v[164:167],a[96:99],v[52:55],v[164:167]
R a[72:75],v7,51200
R a[76:79],v7,52224
M v[168:171],a[104:107],v[48:51],v[168:171]
C v132,v132,v133
C v133,v134,v135
M v[168:171],a[108:111],v[56:59],v[168:171]
C v134,v140,v141
C v135,v142,v143
M v[172:175],a[108:111],v[60:63],v[172:175]
R a[80:83],v7,53248
R a[84:87],v7,54272
M v[172:175],a[104:107],v[52:55],v[172:175]
buffer_store_dwordx4 v[132:135], v7, s[8:11], s88 offen offset:0 sc1
M v[176:179],a[112:115],v[48:51],v[176:179]
C v144,v144,v145
C v145,v146,v147
M v[176:179],a[116:119],v[56:59],v[176:179]
R a[88:91],v7,55296
R a[92:95],v7,56320
M v[180:183],a[116:119],v[60:63],v[180:183]
C v146,v152,v153
C v147,v154,v155
M v[180:183],a[112:115],v[52:55],v[180:183]
buffer_store_dwordx4 v[144:147], v7, s[8:11], s86 offen offset:1024 sc1
M v[184:187],a[120:123],v[48:51],v[184:187]
C v148,v148,v149
C v149,v150,v151
M v[184:187],a[124:127],v[56:59],v[184:187]
C v150,v156,v157
C v151,v158,v159
M v[188:191],a[124:127],v[60:63],v[188:191]
buffer_store_dwordx4 v[148:151], v7, s[8:11], s88 offen offset:1024 sc1
M v[188:191],a[120:123],v[52:55],v[188:191]
s_waitcnt lgkmcnt(0)
C v160,v160,v161
C v161,v162,v163
M v[192:195],a[64:67],v[48:51],v[192:195]
R a[96:99],v7,57344
R a[100:103],v7,58368
M v[192:195],a[68:71],v[56:59],v[192:195]
C v162,v168,v169
C v163,v170,v171
M v[196:199],a[68:71],v[60:63],v[196:199]
buffer_store_dwordx4 v[160:163], v7, s[8:11], s86 offen offset:2048 sc1
M v[196:199],a[64:67],v[52:55],v[196:199]
R a[104:107],v7,59392
R a[108:111],v7,60416
M v[200:203],a[72:75],v[48:51],v[200:203]
C v164,v164,v165
C v165,v166,v167
M v[200:203],a[76:79],v[56:59],v[200:203]
C v166,v172,v173
C v167,v174,v175
M v[204:207],a[76:79],v[60:63],v[204:207]
R a[112:115],v7,61440
R a[116:119],v7,62464
M v[204:207],a[72:75],v[52:55],v[204:207]
buffer_store_dwordx4 v[164:167], v7, s[8:11], s88 offen offset:2048 sc1
M v[208:211],a[80:83],v[48:51],v[208:211]
C v176,v176,v177
C v177,v178,v179
M v[208:211],a[84:87],v[56:59],v[208:211]
R a[120:123],v7,63488
R a[124:127],v7,64512
M v[212:215],a[84:87],v[60:63],v[212:215]
C v178,v184,v185
C v179,v186,v187
M v[212:215],a[80:83],v[52:55],v[212:215]
buffer_store_dwordx4 v[176:179], v7, s[8:11], s86 offen offset:3072 sc1
M v[216:219],a[88:91],v[48:51],v[216:219]
C v180,v180,v181
C v181,v182,v183
M v[216:219],a[92:95],v[56:59],v[216:219]
C v182,v188,v189
C v183,v190,v191
M v[220:223],a[92:95],v[60:63],v[220:223]
s_waitcnt vmcnt(12) lgkmcnt(0)
buffer_store_dwordx4 v[180:183], v7, s[8:11], s88 offen offset:3072 sc1
M v[220:223],a[88:91],v[52:55],v[220:223]
s_barrier
M v[224:227],a[96:99],v[48:51],v[224:227]
s_nop 0
T a[64:65],v22,32768
T a[66:67],v22,34816
M v[224:227],a[100:103],v[56:59],v[224:227]
T a[68:69],v22,36864
T a[70:71],v22,38912
M v[228:231],a[100:103],v[60:63],v[228:231]
C v192,v192,v193
C v193,v194,v195
M v[228:231],a[96:99],v[52:55],v[228:231]
T a[72:73],v22,40960
T a[74:75],v22,43008
M v[232:235],a[104:107],v[48:51],v[232:235]
T a[76:77],v22,45056
T a[78:79],v22,47104
M v[232:235],a[108:111],v[56:59],v[232:235]
C v194,v200,v201
C v195,v202,v203
M v[236:239],a[108:111],v[60:63],v[236:239]
T a[80:81],v22,49152
T a[82:83],v22,51200
M v[236:239],a[104:107],v[52:55],v[236:239]
T a[84:85],v22,53248
T a[86:87],v22,55296
M v[240:243],a[112:115],v[48:51],v[240:243]
buffer_store_dwordx4 v[192:195], v7, s[8:11], s87 offen offset:0 sc1
M v[240:243],a[116:119],v[56:59],v[240:243]
s_nop 0
T a[88:89],v22,57344
T a[90:91],v22,59392
M v[244:247],a[116:119],v[60:63],v[244:247]
T a[92:93],v22,61440
T a[94:95],v22,63488
M v[244:247],a[112:115],v[52:55],v[244:247]
C v196,v196,v197
C v197,v198,v199
M v[248:251],a[120:123],v[48:51],v[248:251]
C v198,v204,v205
C v199,v206,v207
M v[248:251],a[124:127],v[56:59],v[248:251]
buffer_store_dwordx4 v[196:199], v7, s[8:11], s89 offen offset:0 sc1
M v[252:255],a[124:127],v[60:63],v[252:255]
s_waitcnt lgkmcnt(0)
C v208,v208,v209
C v209,v210,v211
M v[252:255],a[120:123],v[52:55],v[252:255]
C v210,v216,v217
C v211,v218,v219
buffer_store_dwordx4 v[208:211], v7, s[8:11], s87 offen offset:1024 sc1
C v212,v212,v213
C v213,v214,v215
C v214,v220,v221
C v215,v222,v223
buffer_store_dwordx4 v[212:215], v7, s[8:11], s89 offen offset:1024 sc1
C v224,v224,v225
C v225,v226,v227
C v226,v232,v233
C v227,v234,v235
buffer_store_dwordx4 v[224:227], v7, s[8:11], s87 offen offset:2048 sc1
C v228,v228,v229
C v229,v230,v231
C v230,v236,v237
C v231,v238,v239
buffer_store_dwordx4 v[228:231], v7, s[8:11], s89 offen offset:2048 sc1
C v240,v240,v241
C v241,v242,v243
C v242,v248,v249
C v243,v250,v251
buffer_store_dwordx4 v[240:243], v7, s[8:11], s87 offen offset:3072 sc1
C v244,v244,v245
C v245,v246,v247
C v246,v252,v253
C v247,v254,v255
buffer_store_dwordx4 v[244:247], v7, s[8:11], s89 offen offset:3072 sc1
M v[64:67],a[64:67],a[128:131],0
s_nop 0
T a[96:97],v23,32768
T a[98:99],v23,34816
M v[64:67],a[68:71],a[132:135],v[64:67]
SA m0,s28,69632
T a[100:101],v23,36864
T a[102:103],v23,38912
M v[64:67],a[72:75],a[136:139],v[64:67]
SA s85,s38,28672
buffer_load_dwordx4 v0, s[12:15], s85 offen offset:0 lds
M v[64:67],a[76:79],a[140:143],v[64:67]
SA s85,s38,34816
T a[104:105],v23,40960
T a[106:107],v23,43008
M v[64:67],a[80:83],a[144:147],v[64:67]
SA s29,s33,0
T a[108:109],v23,45056
T a[110:111],v23,47104
M v[64:67],a[84:87],a[148:151],v[64:67]
SA s30,s33,14336
buffer_load_dwordx4 v0, s[12:15], s85 offen offset:1024 lds
M v[64:67],a[88:91],a[152:155],v[64:67]
SA s85,s38,40960
T a[112:113],v23,49152
T a[114:115],v23,51200
M v[64:67],a[92:95],a[156:159],v[64:67]
T a[116:117],v23,53248
T a[118:119],v23,55296
M v[68:71],a[92:95],a[188:191],0
buffer_load_dwordx4 v0, s[12:15], s85 offen offset:2048 lds
M v[68:71],a[88:91],a[184:187],v[68:71]
SA s85,s38,47104
T a[120:121],v23,57344
T a[122:123],v23,59392
M v[68:71],a[84:87],a[180:183],v[68:71]
T a[124:125],v23,61440
T a[126:127],v23,63488
M v[68:71],a[80:83],a[176:179],v[68:71]
buffer_load_dwordx4 v0, s[12:15], s85 offen offset:3072 lds
M v[68:71],a[76:79],a[172:175],v[68:71]
SA s38,s38,128
G v5,a192
G v6,a193
M v[68:71],a[72:75],a[168:171],v[68:71]
s_sub_u32 s64, 15, s42
M v[68:71],a[68:71],a[164:167],v[68:71]
s_min_u32 s64, s64, s42
M v[68:71],a[64:67],a[160:163],v[68:71]
s_waitcnt lgkmcnt(0)
M v[72:75],a[96:99],a[128:131],0
s_mul_i32 s45, s64, 8704
T a[64:65],v24,32768
T a[66:67],v24,34816
M v[72:75],a[100:103],a[132:135],v[72:75]
s_lshl_b32 s64, s41, 2
T a[68:69],v24,36864
T a[70:71],v24,38912
M v[72:75],a[104:107],a[136:139],v[72:75]
SA s45,s45,s64
M v[72:75],a[108:111],a[140:143],v[72:75]
s_lshl_b32 s64, s20, 8
T a[72:73],v24,40960
T a[74:75],v24,43008
M v[72:75],a[112:115],a[144:147],v[72:75]
SA s45,s45,s64
T a[76:77],v24,45056
T a[78:79],v24,47104
M v[72:75],a[116:119],a[148:151],v[72:75]
SA s45,s45,104992768
M v[72:75],a[120:123],a[152:155],v[72:75]
s_mov_b32 s64, 1024
T a[80:81],v24,49152
T a[82:83],v24,51200
M v[72:75],a[124:127],a[156:159],v[72:75]
s_mov_b32 s66, 4096
T a[84:85],v24,53248
T a[86:87],v24,55296
M v[76:79],a[124:127],a[188:191],0
s_cmp_lt_u32 s42, 8
M v[76:79],a[120:123],a[184:187],v[76:79]
s_cselect_b32 s64, 4352, s64
T a[88:89],v24,57344
T a[90:91],v24,59392
M v[76:79],a[116:119],a[180:183],v[76:79]
s_cselect_b32 s65, 0, 64
T a[92:93],v24,61440
T a[94:95],v24,63488
M v[76:79],a[112:115],a[176:179],v[76:79]
s_cselect_b32 s66, 536870912, s66
MF v64,v5,v64
MF v65,v5,v65
M v[76:79],a[108:111],a[172:175],v[76:79]
SA s3,s45,s64
MF v66,v5,v66
MF v67,v5,v67
M v[76:79],a[104:107],a[168:171],v[76:79]
SA s45,s45,s65
v_lshrrev_b32 v17, 5, v7
v_min_u32 v15, 1, v17
M v[76:79],a[100:103],a[164:167],v[76:79]
SA m0,s28,0
v_lshlrev_b32 v14, 3, v7
v_lshl_or_b32 v16, v15, 29, v14
M v[76:79],a[96:99],a[160:163],v[76:79]
s_waitcnt lgkmcnt(0)
v_cmp_eq_u32 vcc, 1, v17
v_add_u32 v14, s66, v14
M v[80:83],a[64:67],a[128:131],0
SA s85,s38,0
T a[96:97],v25,32768
T a[98:99],v25,34816
M v[80:83],a[68:71],a[132:135],v[80:83]
T a[100:101],v25,36864
T a[102:103],v25,38912
M v[80:83],a[72:75],a[136:139],v[80:83]
buffer_load_dwordx4 v0, s[12:15], s85 offen offset:0 lds
M v[80:83],a[76:79],a[140:143],v[80:83]
SA s85,s38,6144
T a[104:105],v25,40960
T a[106:107],v25,43008
M v[80:83],a[80:83],a[144:147],v[80:83]
T a[108:109],v25,45056
T a[110:111],v25,47104
M v[80:83],a[84:87],a[148:151],v[80:83]
buffer_load_dwordx4 v0, s[12:15], s85 offen offset:1024 lds
M v[80:83],a[88:91],a[152:155],v[80:83]
SA s85,s38,12288
T a[112:113],v25,49152
T a[114:115],v25,51200
M v[80:83],a[92:95],a[156:159],v[80:83]
T a[116:117],v25,53248
T a[118:119],v25,55296
M v[84:87],a[92:95],a[188:191],0
buffer_load_dwordx4 v0, s[12:15], s85 offen offset:2048 lds
M v[84:87],a[88:91],a[184:187],v[84:87]
SA s85,s38,18432
T a[120:121],v25,57344
T a[122:123],v25,59392
M v[84:87],a[84:87],a[180:183],v[84:87]
T a[124:125],v25,61440
T a[126:127],v25,63488
M v[84:87],a[80:83],a[176:179],v[84:87]
buffer_load_dwordx4 v0, s[12:15], s85 offen offset:3072 lds
M v[84:87],a[76:79],a[172:175],v[84:87]
SA m0,s28,4096
v_mov_b32 v15, 1
v_cndmask_b32 v17, v16, v14, vcc
M v[84:87],a[72:75],a[168:171],v[84:87]
SA s85,s38,28672
buffer_load_dwordx4 v0, s[12:15], s85 offen offset:0 lds
M v[84:87],a[68:71],a[164:167],v[84:87]
s_waitcnt vmcnt(5) lgkmcnt(0)
v_min_u32 v10, 1, v7
v_lshlrev_b32 v10, 29, v10
M v[84:87],a[64:67],a[160:163],v[84:87]
s_barrier
M v[88:91],a[96:99],a[128:131],0
SA s85,s38,34816
T a[64:65],v22,0
T a[66:67],v22,2048
M v[88:91],a[100:103],a[132:135],v[88:91]
T a[68:69],v22,4096
T a[70:71],v22,6144
M v[88:91],a[104:107],a[136:139],v[88:91]
buffer_load_dwordx4 v0, s[12:15], s85 offen offset:1024 lds
M v[88:91],a[108:111],a[140:143],v[88:91]
SA s85,s38,40960
T a[72:73],v22,8192
T a[74:75],v22,10240
M v[88:91],a[112:115],a[144:147],v[88:91]
T a[76:77],v22,12288
T a[78:79],v22,14336
M v[88:91],a[116:119],a[148:151],v[88:91]
buffer_load_dwordx4 v0, s[12:15], s85 offen offset:2048 lds
M v[88:91],a[120:123],a[152:155],v[88:91]
SA s85,s38,47104
T a[80:81],v22,16384
T a[82:83],v22,18432
M v[88:91],a[124:127],a[156:159],v[88:91]
T a[84:85],v22,20480
T a[86:87],v22,22528
M v[92:95],a[124:127],a[188:191],0
buffer_store_dword v15, v10, s[8:11], s47 offen sc1
M v[92:95],a[120:123],a[184:187],v[92:95]
s_nop 0
T a[88:89],v22,24576
T a[90:91],v22,26624
M v[92:95],a[116:119],a[180:183],v[92:95]
T a[92:93],v22,28672
T a[94:95],v22,30720
M v[92:95],a[112:115],a[176:179],v[92:95]
buffer_load_dwordx4 v0, s[12:15], s85 offen offset:3072 lds
M v[92:95],a[108:111],a[172:175],v[92:95]
SA s38,s38,128
MF v72,v5,v72
MF v73,v5,v73
M v[92:95],a[104:107],a[168:171],v[92:95]
SA m0,s28,131072
MF v74,v5,v74
MF v75,v5,v75
M v[92:95],a[100:103],a[164:167],v[92:95]
s_waitcnt lgkmcnt(0)
C v64,v64,v65
C v65,v66,v67
M v[92:95],a[96:99],a[160:163],v[92:95]
SA s85,s38,0
C v66,v72,v73
C v67,v74,v75
buffer_store_dwordx4 v[64:67], v7, s[8:11], s29 offen offset:0 sc1
buffer_load_dwordx4 v0, s[12:15], s85 offen offset:0 lds
v_add_u32 v40, 0x20000, v18
v_add_u32 v41, 0x20000, v19
v_add_u32 v42, 0x20000, v20
v_add_u32 v43, 0x20000, v21
SA s85,s38,6144
MF v68,v6,v68
MF v69,v6,v69
MF v70,v6,v70
MF v71,v6,v71
MF v76,v6,v76
MF v77,v6,v77
MF v78,v6,v78
MF v79,v6,v79
C v68,v68,v69
C v69,v70,v71
C v70,v76,v77
C v71,v78,v79
buffer_store_dwordx4 v[68:71], v7, s[8:11], s30 offen offset:0 sc1
buffer_load_dwordx4 v0, s[12:15], s85 offen offset:1024 lds
SA s85,s38,12288
buffer_load_dwordx4 v0, s[12:15], s85 offen offset:2048 lds
SA s85,s38,18432
buffer_load_dwordx4 v0, s[12:15], s85 offen offset:3072 lds
M v[96:99],a[64:67],a[128:131],0
s_nop 0
T a[96:97],v23,0
T a[98:99],v23,2048
M v[96:99],a[68:71],a[132:135],v[96:99]
SA m0,s28,135168
T a[100:101],v23,4096
T a[102:103],v23,6144
M v[96:99],a[72:75],a[136:139],v[96:99]
SA s85,s38,28672
buffer_load_dwordx4 v0, s[12:15], s85 offen offset:0 lds
M v[96:99],a[76:79],a[140:143],v[96:99]
SA s85,s38,34816
T a[104:105],v23,8192
T a[106:107],v23,10240
M v[96:99],a[80:83],a[144:147],v[96:99]
T a[108:109],v23,12288
T a[110:111],v23,14336
M v[96:99],a[84:87],a[148:151],v[96:99]
buffer_load_dwordx4 v0, s[12:15], s85 offen offset:1024 lds
M v[96:99],a[88:91],a[152:155],v[96:99]
SA s85,s38,40960
T a[112:113],v23,16384
T a[114:115],v23,18432
M v[96:99],a[92:95],a[156:159],v[96:99]
T a[116:117],v23,20480
T a[118:119],v23,22528
M v[100:103],a[92:95],a[188:191],0
buffer_load_dwordx4 v0, s[12:15], s85 offen offset:2048 lds
M v[100:103],a[88:91],a[184:187],v[100:103]
SA s85,s38,47104
T a[120:121],v23,24576
T a[122:123],v23,26624
M v[100:103],a[84:87],a[180:183],v[100:103]
T a[124:125],v23,28672
T a[126:127],v23,30720
M v[100:103],a[80:83],a[176:179],v[100:103]
buffer_load_dwordx4 v0, s[12:15], s85 offen offset:3072 lds
M v[100:103],a[76:79],a[172:175],v[100:103]
SA s38,s38,128
MF v80,v5,v80
MF v81,v5,v81
M v[100:103],a[72:75],a[168:171],v[100:103]
SA m0,s28,32768
MF v82,v5,v82
MF v83,v5,v83
M v[100:103],a[68:71],a[164:167],v[100:103]
SA s85,s38,0
buffer_load_dwordx4 v0, s[12:15], s85 offen offset:0 lds
M v[100:103],a[64:67],a[160:163],v[100:103]
s_waitcnt lgkmcnt(0)
MF v88,v5,v88
MF v89,v5,v89
M v[104:107],a[96:99],a[128:131],0
SA s85,s38,6144
T a[64:65],v24,0
T a[66:67],v24,2048
M v[104:107],a[100:103],a[132:135],v[104:107]
T a[68:69],v24,4096
T a[70:71],v24,6144
M v[104:107],a[104:107],a[136:139],v[104:107]
buffer_load_dwordx4 v0, s[12:15], s85 offen offset:1024 lds
M v[104:107],a[108:111],a[140:143],v[104:107]
SA s85,s38,12288
T a[72:73],v24,8192
T a[74:75],v24,10240
M v[104:107],a[112:115],a[144:147],v[104:107]
T a[76:77],v24,12288
T a[78:79],v24,14336
M v[104:107],a[116:119],a[148:151],v[104:107]
buffer_load_dwordx4 v0, s[12:15], s85 offen offset:2048 lds
M v[104:107],a[120:123],a[152:155],v[104:107]
SA s85,s38,18432
T a[80:81],v24,16384
T a[82:83],v24,18432
M v[104:107],a[124:127],a[156:159],v[104:107]
T a[84:85],v24,20480
T a[86:87],v24,22528
M v[108:111],a[124:127],a[188:191],0
buffer_load_dwordx4 v0, s[12:15], s85 offen offset:3072 lds
M v[108:111],a[120:123],a[184:187],v[108:111]
SA m0,s28,36864
T a[88:89],v24,24576
T a[90:91],v24,26624
M v[108:111],a[116:119],a[180:183],v[108:111]
SA s85,s38,28672
T a[92:93],v24,28672
T a[94:95],v24,30720
M v[108:111],a[112:115],a[176:179],v[108:111]
buffer_load_dwordx4 v0, s[12:15], s85 offen offset:0 lds
M v[108:111],a[108:111],a[172:175],v[108:111]
SA s85,s38,34816
MF v90,v5,v90
MF v91,v5,v91
M v[108:111],a[104:107],a[168:171],v[108:111]
C v80,v80,v81
C v81,v82,v83
M v[108:111],a[100:103],a[164:167],v[108:111]
buffer_load_dwordx4 v0, s[12:15], s85 offen offset:1024 lds
M v[108:111],a[96:99],a[160:163],v[108:111]
s_waitcnt lgkmcnt(0)
C v82,v88,v89
C v83,v90,v91
M v[112:115],a[64:67],a[128:131],0
SA s85,s38,40960
T a[96:97],v25,0
T a[98:99],v25,2048
M v[112:115],a[68:71],a[132:135],v[112:115]
T a[100:101],v25,4096
T a[102:103],v25,6144
M v[112:115],a[72:75],a[136:139],v[112:115]
buffer_store_dwordx4 v[80:83], v7, s[8:11], s29 offen offset:1024 sc1
M v[112:115],a[76:79],a[140:143],v[112:115]
s_nop 0
T a[104:105],v25,8192
T a[106:107],v25,10240
M v[112:115],a[80:83],a[144:147],v[112:115]
T a[108:109],v25,12288
T a[110:111],v25,14336
M v[112:115],a[84:87],a[148:151],v[112:115]
buffer_load_dwordx4 v0, s[12:15], s85 offen offset:2048 lds
M v[112:115],a[88:91],a[152:155],v[112:115]
SA s85,s38,47104
T a[112:113],v25,16384
T a[114:115],v25,18432
M v[112:115],a[92:95],a[156:159],v[112:115]
T a[116:117],v25,20480
T a[118:119],v25,22528
M v[116:119],a[92:95],a[188:191],0
buffer_load_dwordx4 v0, s[12:15], s85 offen offset:3072 lds
M v[116:119],a[88:91],a[184:187],v[116:119]
SA s38,s38,128
T a[120:121],v25,24576
T a[122:123],v25,26624
M v[116:119],a[84:87],a[180:183],v[116:119]
SA m0,s28,98304
T a[124:125],v25,28672
T a[126:127],v25,30720
M v[116:119],a[80:83],a[176:179],v[116:119]
SA s85,s38,0
buffer_load_dwordx4 v0, s[12:15], s85 offen offset:0 lds
M v[116:119],a[76:79],a[172:175],v[116:119]
SA s85,s38,6144
MF v84,v6,v84
MF v85,v6,v85
M v[116:119],a[72:75],a[168:171],v[116:119]
buffer_load_dwordx4 v0, s[12:15], s85 offen offset:1024 lds
M v[116:119],a[68:71],a[164:167],v[116:119]
s_waitcnt vmcnt(21) lgkmcnt(0)
MF v86,v6,v86
MF v87,v6,v87
M v[116:119],a[64:67],a[160:163],v[116:119]
s_barrier
M v[120:123],a[96:99],a[128:131],0
SA s85,s38,12288
T a[64:65],v18,0
T a[66:67],v18,2048
M v[120:123],a[100:103],a[132:135],v[120:123]
T a[68:69],v18,4096
T a[70:71],v18,6144
M v[120:123],a[104:107],a[136:139],v[120:123]
buffer_load_dwordx4 v0, s[12:15], s85 offen offset:2048 lds
M v[120:123],a[108:111],a[140:143],v[120:123]
SA s85,s38,18432
T a[72:73],v18,8192
T a[74:75],v18,10240
M v[120:123],a[112:115],a[144:147],v[120:123]
T a[76:77],v18,12288
T a[78:79],v18,14336
M v[120:123],a[116:119],a[148:151],v[120:123]
buffer_load_dwordx4 v0, s[12:15], s85 offen offset:3072 lds
M v[120:123],a[120:123],a[152:155],v[120:123]
s_nop 0
T a[80:81],v18,16384
T a[82:83],v18,18432
M v[120:123],a[124:127],a[156:159],v[120:123]
T a[84:85],v18,20480
T a[86:87],v18,22528
M v[124:127],a[124:127],a[188:191],0
MF v92,v6,v92
MF v93,v6,v93
M v[124:127],a[120:123],a[184:187],v[124:127]
T a[88:89],v18,24576
T a[90:91],v18,26624
M v[124:127],a[116:119],a[180:183],v[124:127]
T a[92:93],v18,28672
T a[94:95],v18,30720
M v[124:127],a[112:115],a[176:179],v[124:127]
MF v94,v6,v94
MF v95,v6,v95
M v[124:127],a[108:111],a[172:175],v[124:127]
C v84,v84,v85
C v85,v86,v87
M v[124:127],a[104:107],a[168:171],v[124:127]
C v86,v92,v93
C v87,v94,v95
M v[124:127],a[100:103],a[164:167],v[124:127]
s_waitcnt lgkmcnt(0)
buffer_store_dwordx4 v[84:87], v7, s[8:11], s30 offen offset:1024 sc1
M v[124:127],a[96:99],a[160:163],v[124:127]
SA s29,s33,2048
SA s30,s33,16384
MF v96,v5,v96
MF v97,v5,v97
MF v98,v5,v98
MF v99,v5,v99
MF v104,v5,v104
MF v105,v5,v105
MF v106,v5,v106
MF v107,v5,v107
C v96,v96,v97
C v97,v98,v99
C v98,v104,v105
C v99,v106,v107
buffer_store_dwordx4 v[96:99], v7, s[8:11], s29 offen offset:0 sc1
MF v100,v6,v100
MF v101,v6,v101
MF v102,v6,v102
MF v103,v6,v103
MF v108,v6,v108
MF v109,v6,v109
MF v110,v6,v110
MF v111,v6,v111
C v100,v100,v101
C v101,v102,v103
C v102,v108,v109
C v103,v110,v111
buffer_store_dwordx4 v[100:103], v7, s[8:11], s30 offen offset:0 sc1
M v[64:67],a[64:67],a[128:131],0
s_nop 0
T a[96:97],v19,0
T a[98:99],v19,2048
M v[64:67],a[68:71],a[132:135],v[64:67]
SA m0,s28,102400
T a[100:101],v19,4096
T a[102:103],v19,6144
M v[64:67],a[72:75],a[136:139],v[64:67]
SA s85,s38,28672
buffer_load_dwordx4 v0, s[12:15], s85 offen offset:0 lds
M v[64:67],a[76:79],a[140:143],v[64:67]
SA s85,s38,34816
T a[104:105],v19,8192
T a[106:107],v19,10240
M v[64:67],a[80:83],a[144:147],v[64:67]
T a[108:109],v19,12288
T a[110:111],v19,14336
M v[64:67],a[84:87],a[148:151],v[64:67]
buffer_load_dwordx4 v0, s[12:15], s85 offen offset:1024 lds
M v[64:67],a[88:91],a[152:155],v[64:67]
s_nop 0
T a[112:113],v19,16384
T a[114:115],v19,18432
M v[64:67],a[92:95],a[156:159],v[64:67]
SA s85,s38,40960
T a[116:117],v19,20480
T a[118:119],v19,22528
M v[68:71],a[92:95],a[188:191],0
buffer_load_dwordx4 v0, s[12:15], s85 offen offset:2048 lds
M v[68:71],a[88:91],a[184:187],v[68:71]
s_nop 0
T a[120:121],v19,24576
T a[122:123],v19,26624
M v[68:71],a[84:87],a[180:183],v[68:71]
T a[124:125],v19,28672
T a[126:127],v19,30720
M v[68:71],a[80:83],a[176:179],v[68:71]
SA s85,s38,47104
MF v112,v5,v112
MF v113,v5,v113
M v[68:71],a[76:79],a[172:175],v[68:71]
buffer_load_dwordx4 v0, s[12:15], s85 offen offset:3072 lds
M v[68:71],a[72:75],a[168:171],v[68:71]
SA s38,s38,128
MF v114,v5,v114
MF v115,v5,v115
M v[68:71],a[68:71],a[164:167],v[68:71]
SA m0,s28,65536
MF v120,v5,v120
MF v121,v5,v121
M v[68:71],a[64:67],a[160:163],v[68:71]
s_waitcnt lgkmcnt(0)
MF v122,v5,v122
MF v123,v5,v123
M v[72:75],a[96:99],a[128:131],0
SA s85,s38,0
T a[64:65],v20,0
T a[66:67],v20,2048
M v[72:75],a[100:103],a[132:135],v[72:75]
T a[68:69],v20,4096
T a[70:71],v20,6144
M v[72:75],a[104:107],a[136:139],v[72:75]
buffer_load_dwordx4 v0, s[12:15], s85 offen offset:0 lds
M v[72:75],a[108:111],a[140:143],v[72:75]
SA s85,s38,6144
T a[72:73],v20,8192
T a[74:75],v20,10240
M v[72:75],a[112:115],a[144:147],v[72:75]
T a[76:77],v20,12288
T a[78:79],v20,14336
M v[72:75],a[116:119],a[148:151],v[72:75]
buffer_load_dwordx4 v0, s[12:15], s85 offen offset:1024 lds
M v[72:75],a[120:123],a[152:155],v[72:75]
SA s85,s38,12288
T a[80:81],v20,16384
T a[82:83],v20,18432
M v[72:75],a[124:127],a[156:159],v[72:75]
T a[84:85],v20,20480
T a[86:87],v20,22528
M v[76:79],a[124:127],a[188:191],0
buffer_load_dwordx4 v0, s[12:15], s85 offen offset:2048 lds
M v[76:79],a[120:123],a[184:187],v[76:79]
SA s85,s38,18432
T a[88:89],v20,24576
T a[90:91],v20,26624
M v[76:79],a[116:119],a[180:183],v[76:79]
T a[92:93],v20,28672
T a[94:95],v20,30720
M v[76:79],a[112:115],a[176:179],v[76:79]
buffer_load_dwordx4 v0, s[12:15], s85 offen offset:3072 lds
M v[76:79],a[108:111],a[172:175],v[76:79]
SA m0,s28,69632
C v112,v112,v113
C v113,v114,v115
M v[76:79],a[104:107],a[168:171],v[76:79]
SA s85,s38,28672
C v114,v120,v121
C v115,v122,v123
M v[76:79],a[100:103],a[164:167],v[76:79]
buffer_store_dwordx4 v[112:115], v7, s[8:11], s29 offen offset:1024 sc1
M v[76:79],a[96:99],a[160:163],v[76:79]
s_waitcnt lgkmcnt(0)
MF v116,v6,v116
MF v117,v6,v117
M v[80:83],a[64:67],a[128:131],0
T a[96:97],v21,0
T a[98:99],v21,2048
M v[80:83],a[68:71],a[132:135],v[80:83]
T a[100:101],v21,4096
T a[102:103],v21,6144
M v[80:83],a[72:75],a[136:139],v[80:83]
buffer_load_dwordx4 v0, s[12:15], s85 offen offset:0 lds
M v[80:83],a[76:79],a[140:143],v[80:83]
SA s85,s38,34816
T a[104:105],v21,8192
T a[106:107],v21,10240
M v[80:83],a[80:83],a[144:147],v[80:83]
T a[108:109],v21,12288
T a[110:111],v21,14336
M v[80:83],a[84:87],a[148:151],v[80:83]
buffer_load_dwordx4 v0, s[12:15], s85 offen offset:1024 lds
M v[80:83],a[88:91],a[152:155],v[80:83]
SA s85,s38,40960
T a[112:113],v21,16384
T a[114:115],v21,18432
M v[80:83],a[92:95],a[156:159],v[80:83]
T a[116:117],v21,20480
T a[118:119],v21,22528
M v[84:87],a[92:95],a[188:191],0
buffer_load_dwordx4 v0, s[12:15], s85 offen offset:2048 lds
M v[84:87],a[88:91],a[184:187],v[84:87]
SA s85,s38,47104
T a[120:121],v21,24576
T a[122:123],v21,26624
M v[84:87],a[84:87],a[180:183],v[84:87]
T a[124:125],v21,28672
T a[126:127],v21,30720
M v[84:87],a[80:83],a[176:179],v[84:87]
buffer_load_dwordx4 v0, s[12:15], s85 offen offset:3072 lds
M v[84:87],a[76:79],a[172:175],v[84:87]
MF v118,v6,v118
MF v119,v6,v119
M v[84:87],a[72:75],a[168:171],v[84:87]
SA s38,s38,128
MF v124,v6,v124
MF v125,v6,v125
M v[84:87],a[68:71],a[164:167],v[84:87]
s_waitcnt vmcnt(29) lgkmcnt(0)
MF v126,v6,v126
MF v127,v6,v127
M v[84:87],a[64:67],a[160:163],v[84:87]
s_barrier
M v[88:91],a[96:99],a[128:131],0
s_nop 0
T a[64:65],v40,0
T a[66:67],v40,2048
M v[88:91],a[100:103],a[132:135],v[88:91]
T a[68:69],v40,4096
T a[70:71],v40,6144
M v[88:91],a[104:107],a[136:139],v[88:91]
C v116,v116,v117
C v117,v118,v119
M v[88:91],a[108:111],a[140:143],v[88:91]
T a[72:73],v40,8192
T a[74:75],v40,10240
M v[88:91],a[112:115],a[144:147],v[88:91]
T a[76:77],v40,12288
T a[78:79],v40,14336
M v[88:91],a[116:119],a[148:151],v[88:91]
C v118,v124,v125
C v119,v126,v127
M v[88:91],a[120:123],a[152:155],v[88:91]
T a[80:81],v40,16384
T a[82:83],v40,18432
M v[88:91],a[124:127],a[156:159],v[88:91]
T a[84:85],v40,20480
T a[86:87],v40,22528
M v[92:95],a[124:127],a[188:191],0
buffer_store_dwordx4 v[116:119], v7, s[8:11], s30 offen offset:1024 sc1
M v[92:95],a[120:123],a[184:187],v[92:95]
SA s29,s33,4096
T a[88:89],v40,24576
T a[90:91],v40,26624
M v[92:95],a[116:119],a[180:183],v[92:95]
SA s30,s33,18432
T a[92:93],v40,28672
T a[94:95],v40,30720
M v[92:95],a[112:115],a[176:179],v[92:95]
MF v64,v5,v64
MF v65,v5,v65
M v[92:95],a[108:111],a[172:175],v[92:95]
MF v66,v5,v66
MF v67,v5,v67
M v[92:95],a[104:107],a[168:171],v[92:95]
MF v72,v5,v72
MF v73,v5,v73
M v[92:95],a[100:103],a[164:167],v[92:95]
s_waitcnt lgkmcnt(0)
MF v74,v5,v74
MF v75,v5,v75
M v[92:95],a[96:99],a[160:163],v[92:95]
C v64,v64,v65
C v65,v66,v67
C v66,v72,v73
C v67,v74,v75
buffer_store_dwordx4 v[64:67], v7, s[8:11], s29 offen offset:0 sc1
MF v68,v6,v68
MF v69,v6,v69
MF v70,v6,v70
MF v71,v6,v71
MF v76,v6,v76
MF v77,v6,v77
MF v78,v6,v78
MF v79,v6,v79
C v68,v68,v69
C v69,v70,v71
C v70,v76,v77
C v71,v78,v79
buffer_store_dwordx4 v[68:71], v7, s[8:11], s30 offen offset:0 sc1
M v[96:99],a[64:67],a[128:131],0
s_nop 0
T a[96:97],v41,0
T a[98:99],v41,2048
M v[96:99],a[68:71],a[132:135],v[96:99]
T a[100:101],v41,4096
T a[102:103],v41,6144
M v[96:99],a[72:75],a[136:139],v[96:99]
MF v80,v5,v80
MF v81,v5,v81
M v[96:99],a[76:79],a[140:143],v[96:99]
T a[104:105],v41,8192
T a[106:107],v41,10240
M v[96:99],a[80:83],a[144:147],v[96:99]
T a[108:109],v41,12288
T a[110:111],v41,14336
M v[96:99],a[84:87],a[148:151],v[96:99]
MF v82,v5,v82
MF v83,v5,v83
M v[96:99],a[88:91],a[152:155],v[96:99]
T a[112:113],v41,16384
T a[114:115],v41,18432
M v[96:99],a[92:95],a[156:159],v[96:99]
T a[116:117],v41,20480
T a[118:119],v41,22528
M v[100:103],a[92:95],a[188:191],0
MF v88,v5,v88
MF v89,v5,v89
M v[100:103],a[88:91],a[184:187],v[100:103]
T a[120:121],v41,24576
T a[122:123],v41,26624
M v[100:103],a[84:87],a[180:183],v[100:103]
T a[124:125],v41,28672
T a[126:127],v41,30720
M v[100:103],a[80:83],a[176:179],v[100:103]
MF v90,v5,v90
MF v91,v5,v91
M v[100:103],a[76:79],a[172:175],v[100:103]
C v80,v80,v81
C v81,v82,v83
M v[100:103],a[72:75],a[168:171],v[100:103]
C v82,v88,v89
C v83,v90,v91
M v[100:103],a[68:71],a[164:167],v[100:103]
buffer_store_dwordx4 v[80:83], v7, s[8:11], s29 offen offset:1024 sc1
M v[100:103],a[64:67],a[160:163],v[100:103]
s_waitcnt lgkmcnt(0)
MF v84,v6,v84
MF v85,v6,v85
M v[104:107],a[96:99],a[128:131],0
T a[64:65],v42,0
T a[66:67],v42,2048
M v[104:107],a[100:103],a[132:135],v[104:107]
T a[68:69],v42,4096
T a[70:71],v42,6144
M v[104:107],a[104:107],a[136:139],v[104:107]
MF v86,v6,v86
MF v87,v6,v87
M v[104:107],a[108:111],a[140:143],v[104:107]
T a[72:73],v42,8192
T a[74:75],v42,10240
M v[104:107],a[112:115],a[144:147],v[104:107]
T a[76:77],v42,12288
T a[78:79],v42,14336
M v[104:107],a[116:119],a[148:151],v[104:107]
MF v92,v6,v92
MF v93,v6,v93
M v[104:107],a[120:123],a[152:155],v[104:107]
T a[80:81],v42,16384
T a[82:83],v42,18432
M v[104:107],a[124:127],a[156:159],v[104:107]
T a[84:85],v42,20480
T a[86:87],v42,22528
M v[108:111],a[124:127],a[188:191],0
MF v94,v6,v94
MF v95,v6,v95
M v[108:111],a[120:123],a[184:187],v[108:111]
T a[88:89],v42,24576
T a[90:91],v42,26624
M v[108:111],a[116:119],a[180:183],v[108:111]
T a[92:93],v42,28672
T a[94:95],v42,30720
M v[108:111],a[112:115],a[176:179],v[108:111]
C v84,v84,v85
C v85,v86,v87
M v[108:111],a[108:111],a[172:175],v[108:111]
C v86,v92,v93
C v87,v94,v95
M v[108:111],a[104:107],a[168:171],v[108:111]
buffer_store_dwordx4 v[84:87], v7, s[8:11], s30 offen offset:1024 sc1
M v[108:111],a[100:103],a[164:167],v[108:111]
SA s29,s33,6144
M v[108:111],a[96:99],a[160:163],v[108:111]
s_waitcnt lgkmcnt(0)
M v[112:115],a[64:67],a[128:131],0
SA s30,s33,20480
T a[96:97],v43,0
T a[98:99],v43,2048
M v[112:115],a[68:71],a[132:135],v[112:115]
T a[100:101],v43,4096
T a[102:103],v43,6144
M v[112:115],a[72:75],a[136:139],v[112:115]
MF v96,v5,v96
MF v97,v5,v97
M v[112:115],a[76:79],a[140:143],v[112:115]
T a[104:105],v43,8192
T a[106:107],v43,10240
M v[112:115],a[80:83],a[144:147],v[112:115]
T a[108:109],v43,12288
T a[110:111],v43,14336
M v[112:115],a[84:87],a[148:151],v[112:115]
MF v98,v5,v98
MF v99,v5,v99
M v[112:115],a[88:91],a[152:155],v[112:115]
T a[112:113],v43,16384
T a[114:115],v43,18432
M v[112:115],a[92:95],a[156:159],v[112:115]
T a[116:117],v43,20480
T a[118:119],v43,22528
M v[116:119],a[92:95],a[188:191],0
MF v104,v5,v104
MF v105,v5,v105
M v[116:119],a[88:91],a[184:187],v[116:119]
T a[120:121],v43,24576
T a[122:123],v43,26624
M v[116:119],a[84:87],a[180:183],v[116:119]
T a[124:125],v43,28672
T a[126:127],v43,30720
M v[116:119],a[80:83],a[176:179],v[116:119]
MF v106,v5,v106
MF v107,v5,v107
M v[116:119],a[76:79],a[172:175],v[116:119]
C v96,v96,v97
C v97,v98,v99
M v[116:119],a[72:75],a[168:171],v[116:119]
C v98,v104,v105
C v99,v106,v107
M v[116:119],a[68:71],a[164:167],v[116:119]
s_waitcnt vmcnt(25) lgkmcnt(0)
buffer_store_dwordx4 v[96:99], v7, s[8:11], s29 offen offset:0 sc1
M v[116:119],a[64:67],a[160:163],v[116:119]
s_barrier
M v[120:123],a[96:99],a[128:131],0
s_nop 0
T a[64:65],v18,32768
T a[66:67],v18,34816
M v[120:123],a[100:103],a[132:135],v[120:123]
T a[68:69],v18,36864
T a[70:71],v18,38912
M v[120:123],a[104:107],a[136:139],v[120:123]
MF v100,v6,v100
MF v101,v6,v101
M v[120:123],a[108:111],a[140:143],v[120:123]
T a[72:73],v18,40960
T a[74:75],v18,43008
M v[120:123],a[112:115],a[144:147],v[120:123]
T a[76:77],v18,45056
T a[78:79],v18,47104
M v[120:123],a[116:119],a[148:151],v[120:123]
MF v102,v6,v102
MF v103,v6,v103
M v[120:123],a[120:123],a[152:155],v[120:123]
T a[80:81],v18,49152
T a[82:83],v18,51200
M v[120:123],a[124:127],a[156:159],v[120:123]
T a[84:85],v18,53248
T a[86:87],v18,55296
M v[124:127],a[124:127],a[188:191],0
MF v108,v6,v108
MF v109,v6,v109
M v[124:127],a[120:123],a[184:187],v[124:127]
T a[88:89],v18,57344
T a[90:91],v18,59392
M v[124:127],a[116:119],a[180:183],v[124:127]
T a[92:93],v18,61440
T a[94:95],v18,63488
M v[124:127],a[112:115],a[176:179],v[124:127]
MF v110,v6,v110
MF v111,v6,v111
M v[124:127],a[108:111],a[172:175],v[124:127]
C v100,v100,v101
C v101,v102,v103
M v[124:127],a[104:107],a[168:171],v[124:127]
C v102,v108,v109
C v103,v110,v111
M v[124:127],a[100:103],a[164:167],v[124:127]
s_waitcnt lgkmcnt(0)
buffer_store_dwordx4 v[100:103], v7, s[8:11], s30 offen offset:0 sc1
M v[124:127],a[96:99],a[160:163],v[124:127]
M v[64:67],a[64:67],a[128:131],0
s_nop 0
T a[96:97],v19,32768
T a[98:99],v19,34816
M v[64:67],a[68:71],a[132:135],v[64:67]
T a[100:101],v19,36864
T a[102:103],v19,38912
M v[64:67],a[72:75],a[136:139],v[64:67]
v_lshrrev_b32 v32, 4, v7
MF v112,v5,v112
M v[64:67],a[76:79],a[140:143],v[64:67]
s_lshr_b32 s74, s41, 3
T a[104:105],v19,40960
T a[106:107],v19,43008
M v[64:67],a[80:83],a[144:147],v[64:67]
s_lshl_b32 s64, s42, 1
T a[108:109],v19,45056
T a[110:111],v19,47104
M v[64:67],a[84:87],a[148:151],v[64:67]
SA s46,s64,s74
MF v113,v5,v113
MF v114,v5,v114
M v[64:67],a[88:91],a[152:155],v[64:67]
s_mul_i32 s46, s46, 4352
T a[112:113],v19,49152
T a[114:115],v19,51200
M v[64:67],a[92:95],a[156:159],v[64:67]
s_and_b32 s72, s41, 7
T a[116:117],v19,53248
T a[118:119],v19,55296
M v[68:71],a[92:95],a[188:191],0
s_lshl_b32 s65, s72, 7
MF v115,v5,v115
MF v120,v5,v120
M v[68:71],a[88:91],a[184:187],v[68:71]
SA s46,s46,s65
T a[120:121],v19,57344
T a[122:123],v19,59392
M v[68:71],a[84:87],a[180:183],v[68:71]
SA s46,s46,104992768
T a[124:125],v19,61440
T a[126:127],v19,63488
M v[68:71],a[80:83],a[176:179],v[68:71]
v_and_b32 v33, 31, v32
MF v121,v5,v121
M v[68:71],a[76:79],a[172:175],v[68:71]
MF v122,v5,v122
MF v123,v5,v123
M v[68:71],a[72:75],a[168:171],v[68:71]
C v112,v112,v113
C v113,v114,v115
M v[68:71],a[68:71],a[164:167],v[68:71]
C v114,v120,v121
C v115,v122,v123
M v[68:71],a[64:67],a[160:163],v[68:71]
s_waitcnt lgkmcnt(0)
buffer_store_dwordx4 v[112:115], v7, s[8:11], s29 offen offset:1024 sc1
M v[72:75],a[96:99],a[128:131],0
s_nop 0
T a[64:65],v20,32768
T a[66:67],v20,34816
M v[72:75],a[100:103],a[132:135],v[72:75]
T a[68:69],v20,36864
T a[70:71],v20,38912
M v[72:75],a[104:107],a[136:139],v[72:75]
MF v116,v6,v116
MF v117,v6,v117
M v[72:75],a[108:111],a[140:143],v[72:75]
T a[72:73],v20,40960
T a[74:75],v20,43008
M v[72:75],a[112:115],a[144:147],v[72:75]
T a[76:77],v20,45056
T a[78:79],v20,47104
M v[72:75],a[116:119],a[148:151],v[72:75]
MF v118,v6,v118
MF v119,v6,v119
M v[72:75],a[120:123],a[152:155],v[72:75]
T a[80:81],v20,49152
T a[82:83],v20,51200
M v[72:75],a[124:127],a[156:159],v[72:75]
T a[84:85],v20,53248
T a[86:87],v20,55296
M v[76:79],a[124:127],a[188:191],0
MF v124,v6,v124
MF v125,v6,v125
M v[76:79],a[120:123],a[184:187],v[76:79]
T a[88:89],v20,57344
T a[90:91],v20,59392
M v[76:79],a[116:119],a[180:183],v[76:79]
T a[92:93],v20,61440
T a[94:95],v20,63488
M v[76:79],a[112:115],a[176:179],v[76:79]
MF v126,v6,v126
MF v127,v6,v127
M v[76:79],a[108:111],a[172:175],v[76:79]
C v116,v116,v117
C v117,v118,v119
M v[76:79],a[104:107],a[168:171],v[76:79]
C v118,v124,v125
C v119,v126,v127
M v[76:79],a[100:103],a[164:167],v[76:79]
buffer_store_dwordx4 v[116:119], v7, s[8:11], s30 offen offset:1024 sc1
M v[76:79],a[96:99],a[160:163],v[76:79]
s_waitcnt lgkmcnt(0)
v_lshlrev_b32 v33, 2, v33
M v[80:83],a[64:67],a[128:131],0
SA s29,s33,8192
T a[96:97],v21,32768
T a[98:99],v21,34816
M v[80:83],a[68:71],a[132:135],v[80:83]
SA s30,s33,22528
T a[100:101],v21,36864
T a[102:103],v21,38912
M v[80:83],a[72:75],a[136:139],v[80:83]
s_lshl_b32 s65, s41, 7
MF v64,v5,v64
MF v65,v5,v65
M v[80:83],a[76:79],a[140:143],v[80:83]
SA s65,s65,104890368
T a[104:105],v21,40960
T a[106:107],v21,43008
M v[80:83],a[80:83],a[144:147],v[80:83]
T a[108:109],v21,45056
T a[110:111],v21,47104
M v[80:83],a[84:87],a[148:151],v[80:83]
buffer_load_dword v31, v33, s[8:11], s65 offen sc1
M v[80:83],a[88:91],a[152:155],v[80:83]
s_nop 0
T a[112:113],v21,49152
T a[114:115],v21,51200
M v[80:83],a[92:95],a[156:159],v[80:83]
T a[116:117],v21,53248
T a[118:119],v21,55296
M v[84:87],a[92:95],a[188:191],0
v_bfe_u32 v34, v32, 4, 1
v_lshlrev_b32 v34, 1, v34
M v[84:87],a[88:91],a[184:187],v[84:87]
T a[120:121],v21,57344
T a[122:123],v21,59392
M v[84:87],a[84:87],a[180:183],v[84:87]
T a[124:125],v21,61440
T a[126:127],v21,63488
M v[84:87],a[80:83],a[176:179],v[84:87]
v_lshrrev_b32 v35, 5, v32
v_add_u32 v34, v34, v35
M v[84:87],a[76:79],a[172:175],v[84:87]
s_mov_b32 s52, s96
MF v66,v5,v66
MF v67,v5,v67
M v[84:87],a[72:75],a[168:171],v[84:87]
s_and_b32 s53, s97, 0xffff
MF v72,v5,v72
MF v73,v5,v73
M v[84:87],a[68:71],a[164:167],v[84:87]
s_waitcnt vmcnt(19) lgkmcnt(0)
MF v74,v5,v74
MF v75,v5,v75
M v[84:87],a[64:67],a[160:163],v[84:87]
s_barrier
M v[88:91],a[96:99],a[128:131],0
s_mov_b32 s54, 1835008
T a[64:65],v22,32768
T a[66:67],v22,34816
M v[88:91],a[100:103],a[132:135],v[88:91]
s_mov_b32 s55, 0x20000
T a[68:69],v22,36864
T a[70:71],v22,38912
M v[88:91],a[104:107],a[136:139],v[88:91]
s_mul_i32 s77, s42, 1835008
C v64,v64,v65
C v65,v66,v67
M v[88:91],a[108:111],a[140:143],v[88:91]
s_mul_i32 s78, s72, 14336
T a[72:73],v22,40960
T a[74:75],v22,43008
M v[88:91],a[112:115],a[144:147],v[88:91]
SA s77,s77,s78
T a[76:77],v22,45056
T a[78:79],v22,47104
M v[88:91],a[116:119],a[148:151],v[88:91]
SA s77,s77,67108864
C v66,v72,v73
C v67,v74,v75
M v[88:91],a[120:123],a[152:155],v[88:91]
s_lshl_b32 s79, s74, 1
T a[80:81],v22,49152
T a[82:83],v22,51200
M v[88:91],a[124:127],a[156:159],v[88:91]
SA s79,s79,s20
T a[84:85],v22,53248
T a[86:87],v22,55296
M v[92:95],a[124:127],a[188:191],0
s_lshl_b32 s71, s74, 1
buffer_store_dwordx4 v[64:67], v7, s[8:11], s29 offen offset:0 sc1
M v[92:95],a[120:123],a[184:187],v[92:95]
SA s71,s71,1
T a[88:89],v22,57344
T a[90:91],v22,59392
M v[92:95],a[116:119],a[180:183],v[92:95]
s_sub_u32 s71, s71, s20
T a[92:93],v22,61440
T a[94:95],v22,63488
M v[92:95],a[112:115],a[176:179],v[92:95]
s_and_b32 s71, s71, 536870912
MF v68,v6,v68
MF v69,v6,v69
M v[92:95],a[108:111],a[172:175],v[92:95]
s_sub_u32 s64, 15, s64
MF v70,v6,v70
MF v71,v6,v71
M v[92:95],a[104:107],a[168:171],v[92:95]
s_sub_u32 s78, s64, 1
MF v76,v6,v76
MF v77,v6,v77
M v[92:95],a[100:103],a[164:167],v[92:95]
s_waitcnt lgkmcnt(0)
MF v78,v6,v78
MF v79,v6,v79
M v[92:95],a[96:99],a[160:163],v[92:95]
s_mul_i32 s78, s78, 1835008
SA s78,s78,s77
s_lshl_b32 s65, s79, 10
SA s78,s78,s65
SA s78,s78,s71
s_lshl_b32 s79, s79, 6
s_or_b32 s79, s79, s71
s_mul_i32 s67, s74, -2
s_lshl_b32 s74, s74, 3
SA s74,s74,s20
s_lshl_b32 s75, s74, 6
SA s76,s75,256
SA s67,s67,3
s_sub_u32 s67, s67, s20
s_and_b32 s67, s67, 536870912
s_or_b32 s76, s76, s67
v_or_b32 v27, s67, v7
v_add_u32 v27, 4096, v27
s_lshl_b32 s65, s74, 10
SA s77,s77,s65
s_lshl_b32 s64, s64, 7
s_lshr_b32 s73, s72, 1
s_sub_u32 s65, 7, s73
s_bitcmp1_b32 s72, 0
s_cselect_b32 s73, s65, s73
s_lshl_b32 s73, s73, 4
s_lshl_b32 s65, s42, 7
SA s73,s73,s65
v_and_b32 v37, 15, v32
v_add_u32 v37, s73, v37
v_add_u32 v29, s64, v37
s_mov_b32 s64, 104857664
v_mul_u32_u24 v38, 896, v37
v_lshl_add_u32 v38, v34, 4, v38
v_lshrrev_b32 v35, 4, v37
v_lshlrev_b32 v35, 5, v35
v_and_b32 v36, 15, v37
v_add_lshl_u32 v35, v35, v36, 2
buffer_load_dword v39, v35, s[8:11], s64 offen sc1
C v68,v68,v69
C v69,v70,v71
C v70,v76,v77
C v71,v78,v79
buffer_store_dwordx4 v[68:71], v7, s[8:11], s30 offen offset:0 sc1
buffer_load_dwordx4 v[48:51], v38, s[56:59], s75 offen
buffer_load_dwordx4 v[52:55], v38, s[56:59], s76 offen
v_mul_u32_u24 v28, 896, v29
v_lshl_add_u32 v28, v34, 4, v28
v_lshrrev_b32 v35, 4, v29
v_lshlrev_b32 v35, 5, v35
v_and_b32 v36, 15, v29
v_add_lshl_u32 v35, v35, v36, 2
buffer_load_dword v26, v35, s[8:11], s64 offen sc1
buffer_load_dwordx4 v[44:47], v28, s[56:59], s79 offen
M v[96:99],a[64:67],a[128:131],0
s_nop 0
T a[96:97],v23,32768
T a[98:99],v23,34816
M v[96:99],a[68:71],a[132:135],v[96:99]
T a[100:101],v23,36864
T a[102:103],v23,38912
M v[96:99],a[72:75],a[136:139],v[96:99]
MF v80,v5,v80
MF v81,v5,v81
M v[96:99],a[76:79],a[140:143],v[96:99]
T a[104:105],v23,40960
T a[106:107],v23,43008
M v[96:99],a[80:83],a[144:147],v[96:99]
T a[108:109],v23,45056
T a[110:111],v23,47104
M v[96:99],a[84:87],a[148:151],v[96:99]
MF v82,v5,v82
MF v83,v5,v83
M v[96:99],a[88:91],a[152:155],v[96:99]
T a[112:113],v23,49152
T a[114:115],v23,51200
M v[96:99],a[92:95],a[156:159],v[96:99]
T a[116:117],v23,53248
T a[118:119],v23,55296
M v[100:103],a[92:95],a[188:191],0
MF v88,v5,v88
MF v89,v5,v89
M v[100:103],a[88:91],a[184:187],v[100:103]
T a[120:121],v23,57344
T a[122:123],v23,59392
M v[100:103],a[84:87],a[180:183],v[100:103]
T a[124:125],v23,61440
T a[126:127],v23,63488
M v[100:103],a[80:83],a[176:179],v[100:103]
MF v90,v5,v90
MF v91,v5,v91
M v[100:103],a[76:79],a[172:175],v[100:103]
C v80,v80,v81
C v81,v82,v83
M v[100:103],a[72:75],a[168:171],v[100:103]
C v82,v88,v89
C v83,v90,v91
M v[100:103],a[68:71],a[164:167],v[100:103]
buffer_store_dwordx4 v[80:83], v7, s[8:11], s29 offen offset:1024 sc1
M v[100:103],a[64:67],a[160:163],v[100:103]
s_waitcnt lgkmcnt(0)
MF v84,v6,v84
MF v85,v6,v85
M v[104:107],a[96:99],a[128:131],0
T a[64:65],v24,32768
T a[66:67],v24,34816
M v[104:107],a[100:103],a[132:135],v[104:107]
T a[68:69],v24,36864
T a[70:71],v24,38912
M v[104:107],a[104:107],a[136:139],v[104:107]
MF v86,v6,v86
MF v87,v6,v87
M v[104:107],a[108:111],a[140:143],v[104:107]
T a[72:73],v24,40960
T a[74:75],v24,43008
M v[104:107],a[112:115],a[144:147],v[104:107]
T a[76:77],v24,45056
T a[78:79],v24,47104
M v[104:107],a[116:119],a[148:151],v[104:107]
MF v92,v6,v92
MF v93,v6,v93
M v[104:107],a[120:123],a[152:155],v[104:107]
T a[80:81],v24,49152
T a[82:83],v24,51200
M v[104:107],a[124:127],a[156:159],v[104:107]
T a[84:85],v24,53248
T a[86:87],v24,55296
M v[108:111],a[124:127],a[188:191],0
MF v94,v6,v94
MF v95,v6,v95
M v[108:111],a[120:123],a[184:187],v[108:111]
T a[88:89],v24,57344
T a[90:91],v24,59392
M v[108:111],a[116:119],a[180:183],v[108:111]
T a[92:93],v24,61440
T a[94:95],v24,63488
M v[108:111],a[112:115],a[176:179],v[108:111]
C v84,v84,v85
C v85,v86,v87
M v[108:111],a[108:111],a[172:175],v[108:111]
C v86,v92,v93
C v87,v94,v95
M v[108:111],a[104:107],a[168:171],v[108:111]
buffer_store_dwordx4 v[84:87], v7, s[8:11], s30 offen offset:1024 sc1
M v[108:111],a[100:103],a[164:167],v[108:111]
SA s29,s33,10240
M v[108:111],a[96:99],a[160:163],v[108:111]
s_waitcnt lgkmcnt(0)
M v[112:115],a[64:67],a[128:131],0
SA s30,s33,24576
T a[96:97],v25,32768
T a[98:99],v25,34816
M v[112:115],a[68:71],a[132:135],v[112:115]
T a[100:101],v25,36864
T a[102:103],v25,38912
M v[112:115],a[72:75],a[136:139],v[112:115]
MF v96,v5,v96
MF v97,v5,v97
M v[112:115],a[76:79],a[140:143],v[112:115]
T a[104:105],v25,40960
T a[106:107],v25,43008
M v[112:115],a[80:83],a[144:147],v[112:115]
T a[108:109],v25,45056
T a[110:111],v25,47104
M v[112:115],a[84:87],a[148:151],v[112:115]
MF v98,v5,v98
MF v99,v5,v99
M v[112:115],a[88:91],a[152:155],v[112:115]
T a[112:113],v25,49152
T a[114:115],v25,51200
M v[112:115],a[92:95],a[156:159],v[112:115]
T a[116:117],v25,53248
T a[118:119],v25,55296
M v[116:119],a[92:95],a[188:191],0
s_mov_b32 s84, s45
MF v104,v5,v104
MF v105,v5,v105
M v[116:119],a[88:91],a[184:187],v[116:119]
T a[120:121],v25,57344
T a[122:123],v25,59392
M v[116:119],a[84:87],a[180:183],v[116:119]
T a[124:125],v25,61440
T a[126:127],v25,63488
M v[116:119],a[80:83],a[176:179],v[116:119]
MF v106,v5,v106
MF v107,v5,v107
M v[116:119],a[76:79],a[172:175],v[116:119]
C v96,v96,v97
C v97,v98,v99
M v[116:119],a[72:75],a[168:171],v[116:119]
C v98,v104,v105
C v99,v106,v107
M v[116:119],a[68:71],a[164:167],v[116:119]
s_waitcnt vmcnt(19) lgkmcnt(0)
buffer_store_dwordx4 v[96:99], v7, s[8:11], s29 offen offset:0 sc1
M v[116:119],a[64:67],a[160:163],v[116:119]
s_barrier
M v[120:123],a[96:99],a[128:131],0
s_nop 0
T a[64:65],v22,0
T a[66:67],v22,2048
M v[120:123],a[100:103],a[132:135],v[120:123]
T a[68:69],v22,4096
T a[70:71],v22,6144
M v[120:123],a[104:107],a[136:139],v[120:123]
MF v100,v6,v100
MF v101,v6,v101
M v[120:123],a[108:111],a[140:143],v[120:123]
T a[72:73],v22,8192
T a[74:75],v22,10240
M v[120:123],a[112:115],a[144:147],v[120:123]
s_waitcnt vmcnt(11)
T a[76:77],v22,12288
T a[78:79],v22,14336
M v[120:123],a[116:119],a[148:151],v[120:123]
buffer_store_dword v15, v17, s[8:11], s84 offen sc1
M v[120:123],a[120:123],a[152:155],v[120:123]
s_nop 0
T a[80:81],v22,16384
T a[82:83],v22,18432
M v[120:123],a[124:127],a[156:159],v[120:123]
T a[84:85],v22,20480
T a[86:87],v22,22528
M v[124:127],a[124:127],a[188:191],0
MF v102,v6,v102
MF v103,v6,v103
M v[124:127],a[120:123],a[184:187],v[124:127]
T a[88:89],v22,24576
T a[90:91],v22,26624
M v[124:127],a[116:119],a[180:183],v[124:127]
T a[92:93],v22,28672
T a[94:95],v22,30720
M v[124:127],a[112:115],a[176:179],v[124:127]
MF v108,v6,v108
MF v109,v6,v109
M v[124:127],a[108:111],a[172:175],v[124:127]
MF v110,v6,v110
MF v111,v6,v111
M v[124:127],a[104:107],a[168:171],v[124:127]
C v100,v100,v101
C v101,v102,v103
M v[124:127],a[100:103],a[164:167],v[124:127]
s_waitcnt lgkmcnt(0)
C v102,v108,v109
C v103,v110,v111
M v[124:127],a[96:99],a[160:163],v[124:127]
buffer_store_dwordx4 v[100:103], v7, s[8:11], s30 offen offset:0 sc1
M v[64:67],a[64:67],a[128:131],0
s_nop 0
T a[96:97],v23,0
T a[98:99],v23,2048
M v[64:67],a[68:71],a[132:135],v[64:67]
T a[100:101],v23,4096
T a[102:103],v23,6144
M v[64:67],a[72:75],a[136:139],v[64:67]
MF v112,v5,v112
MF v113,v5,v113
M v[64:67],a[76:79],a[140:143],v[64:67]
T a[104:105],v23,8192
T a[106:107],v23,10240
M v[64:67],a[80:83],a[144:147],v[64:67]
T a[108:109],v23,12288
T a[110:111],v23,14336
M v[64:67],a[84:87],a[148:151],v[64:67]
MF v114,v5,v114
MF v115,v5,v115
M v[64:67],a[88:91],a[152:155],v[64:67]
T a[112:113],v23,16384
T a[114:115],v23,18432
M v[64:67],a[92:95],a[156:159],v[64:67]
T a[116:117],v23,20480
T a[118:119],v23,22528
M v[68:71],a[92:95],a[188:191],0
MF v120,v5,v120
MF v121,v5,v121
M v[68:71],a[88:91],a[184:187],v[68:71]
T a[120:121],v23,24576
T a[122:123],v23,26624
M v[68:71],a[84:87],a[180:183],v[68:71]
T a[124:125],v23,28672
T a[126:127],v23,30720
M v[68:71],a[80:83],a[176:179],v[68:71]
MF v122,v5,v122
MF v123,v5,v123
M v[68:71],a[76:79],a[172:175],v[68:71]
C v112,v112,v113
C v113,v114,v115
M v[68:71],a[72:75],a[168:171],v[68:71]
C v114,v120,v121
C v115,v122,v123
M v[68:71],a[68:71],a[164:167],v[68:71]
buffer_store_dwordx4 v[112:115], v7, s[8:11], s29 offen offset:1024 sc1
M v[68:71],a[64:67],a[160:163],v[68:71]
s_waitcnt lgkmcnt(0)
MF v116,v6,v116
MF v117,v6,v117
M v[72:75],a[96:99],a[128:131],0
T a[64:65],v24,0
T a[66:67],v24,2048
M v[72:75],a[100:103],a[132:135],v[72:75]
T a[68:69],v24,4096
T a[70:71],v24,6144
M v[72:75],a[104:107],a[136:139],v[72:75]
MF v118,v6,v118
MF v119,v6,v119
M v[72:75],a[108:111],a[140:143],v[72:75]
T a[72:73],v24,8192
T a[74:75],v24,10240
M v[72:75],a[112:115],a[144:147],v[72:75]
T a[76:77],v24,12288
T a[78:79],v24,14336
M v[72:75],a[116:119],a[148:151],v[72:75]
MF v124,v6,v124
MF v125,v6,v125
M v[72:75],a[120:123],a[152:155],v[72:75]
T a[80:81],v24,16384
T a[82:83],v24,18432
M v[72:75],a[124:127],a[156:159],v[72:75]
T a[84:85],v24,20480
T a[86:87],v24,22528
M v[76:79],a[124:127],a[188:191],0
MF v126,v6,v126
MF v127,v6,v127
M v[76:79],a[120:123],a[184:187],v[76:79]
T a[88:89],v24,24576
T a[90:91],v24,26624
M v[76:79],a[116:119],a[180:183],v[76:79]
T a[92:93],v24,28672
T a[94:95],v24,30720
M v[76:79],a[112:115],a[176:179],v[76:79]
C v116,v116,v117
C v117,v118,v119
M v[76:79],a[108:111],a[172:175],v[76:79]
C v118,v124,v125
C v119,v126,v127
M v[76:79],a[104:107],a[168:171],v[76:79]
buffer_store_dwordx4 v[116:119], v7, s[8:11], s30 offen offset:1024 sc1
M v[76:79],a[100:103],a[164:167],v[76:79]
SA s29,s33,12288
M v[76:79],a[96:99],a[160:163],v[76:79]
s_waitcnt lgkmcnt(0)
M v[80:83],a[64:67],a[128:131],0
SA s30,s33,26624
T a[96:97],v25,0
T a[98:99],v25,2048
M v[80:83],a[68:71],a[132:135],v[80:83]
T a[100:101],v25,4096
T a[102:103],v25,6144
M v[80:83],a[72:75],a[136:139],v[80:83]
MF v64,v5,v64
MF v65,v5,v65
M v[80:83],a[76:79],a[140:143],v[80:83]
T a[104:105],v25,8192
T a[106:107],v25,10240
M v[80:83],a[80:83],a[144:147],v[80:83]
T a[108:109],v25,12288
T a[110:111],v25,14336
M v[80:83],a[84:87],a[148:151],v[80:83]
MF v66,v5,v66
MF v67,v5,v67
M v[80:83],a[88:91],a[152:155],v[80:83]
T a[112:113],v25,16384
T a[114:115],v25,18432
M v[80:83],a[92:95],a[156:159],v[80:83]
T a[116:117],v25,20480
T a[118:119],v25,22528
M v[84:87],a[92:95],a[188:191],0
MF v72,v5,v72
MF v73,v5,v73
M v[84:87],a[88:91],a[184:187],v[84:87]
T a[120:121],v25,24576
T a[122:123],v25,26624
M v[84:87],a[84:87],a[180:183],v[84:87]
T a[124:125],v25,28672
T a[126:127],v25,30720
M v[84:87],a[80:83],a[176:179],v[84:87]
MF v74,v5,v74
MF v75,v5,v75
M v[84:87],a[76:79],a[172:175],v[84:87]
C v64,v64,v65
C v65,v66,v67
M v[84:87],a[72:75],a[168:171],v[84:87]
C v66,v72,v73
C v67,v74,v75
M v[84:87],a[68:71],a[164:167],v[84:87]
buffer_store_dwordx4 v[64:67], v7, s[8:11], s29 offen offset:0 sc1
M v[84:87],a[64:67],a[160:163],v[84:87]
s_waitcnt lgkmcnt(0)
MF v68,v6,v68
MF v69,v6,v69
M v[88:91],a[96:99],a[128:131],0
MF v70,v6,v70
MF v71,v6,v71
M v[88:91],a[100:103],a[132:135],v[88:91]
MF v76,v6,v76
MF v77,v6,v77
M v[88:91],a[104:107],a[136:139],v[88:91]
MF v78,v6,v78
MF v79,v6,v79
M v[88:91],a[108:111],a[140:143],v[88:91]
C v68,v68,v69
C v69,v70,v71
M v[88:91],a[112:115],a[144:147],v[88:91]
C v70,v76,v77
C v71,v78,v79
M v[88:91],a[116:119],a[148:151],v[88:91]
buffer_store_dwordx4 v[68:71], v7, s[8:11], s30 offen offset:0 sc1
M v[88:91],a[120:123],a[152:155],v[88:91]
M v[88:91],a[124:127],a[156:159],v[88:91]
M v[92:95],a[124:127],a[188:191],0
M v[92:95],a[120:123],a[184:187],v[92:95]
M v[92:95],a[116:119],a[180:183],v[92:95]
M v[92:95],a[112:115],a[176:179],v[92:95]
MF v80,v5,v80
MF v81,v5,v81
M v[92:95],a[108:111],a[172:175],v[92:95]
MF v82,v5,v82
MF v83,v5,v83
M v[92:95],a[104:107],a[168:171],v[92:95]
MF v88,v5,v88
MF v89,v5,v89
M v[92:95],a[100:103],a[164:167],v[92:95]
MF v90,v5,v90
MF v91,v5,v91
M v[92:95],a[96:99],a[160:163],v[92:95]
C v80,v80,v81
C v81,v82,v83
C v82,v88,v89
C v83,v90,v91
buffer_store_dwordx4 v[80:83], v7, s[8:11], s29 offen offset:1024 sc1
MF v84,v6,v84
MF v85,v6,v85
MF v86,v6,v86
MF v87,v6,v87
MF v92,v6,v92
MF v93,v6,v93
MF v94,v6,v94
MF v95,v6,v95
C v84,v84,v85
C v85,v86,v87
C v86,v92,v93
C v87,v94,v95
buffer_store_dwordx4 v[84:87], v7, s[8:11], s30 offen offset:1024 sc1
buffer_load_dword v9, v33, s[8:11], s46 offen sc1
s_waitcnt vmcnt(1)
buffer_store_dword v15, v16, s[8:11], s3 offen sc1
L_red1:
s_waitcnt vmcnt(0)
v_cmp_eq_u32 vcc, 1, v9
s_mov_b32 s91, 65536
s_mov_b32 s69, 0xffff
s_and_b32 s70, vcc_lo, s69
s_mov_b32 s68, s70
s_cmp_lg_u32 s70, 0
s_cbranch_scc1 L_rk0
s_call_b64 s[36:37], L_rpoll
L_rk0:
s_ff1_i32_b32 s71, s70
s_bitset0_b32 s70, s71
s_mul_i32 s71, s71, 114688
SA s72,s71,s77
buffer_load_dwordx4 v[128:131], v7, s[8:11], s72 offen sc1
buffer_load_dwordx4 v[132:135], v27, s[8:11], s72 offen sc1
s_cmp_lg_u32 s70, 0
s_cbranch_scc1 L_rk1
s_call_b64 s[36:37], L_rpoll
L_rk1:
s_ff1_i32_b32 s71, s70
s_bitset0_b32 s70, s71
s_mul_i32 s71, s71, 114688
SA s72,s71,s77
buffer_load_dwordx4 v[136:139], v7, s[8:11], s72 offen sc1
buffer_load_dwordx4 v[140:143], v27, s[8:11], s72 offen sc1
s_cmp_lg_u32 s70, 0
s_cbranch_scc1 L_rk2
s_call_b64 s[36:37], L_rpoll
L_rk2:
s_ff1_i32_b32 s71, s70
s_bitset0_b32 s70, s71
s_mul_i32 s71, s71, 114688
SA s72,s71,s77
buffer_load_dwordx4 v[144:147], v7, s[8:11], s72 offen sc1
buffer_load_dwordx4 v[148:151], v27, s[8:11], s72 offen sc1
v_readlane_b32 s92, v31, 0
v_readlane_b32 s94, v31, 1
v_lshlrev_b32 v64, 16, v48
v_and_b32 v65, 0xffff0000, v48
v_lshlrev_b32 v66, 16, v49
v_and_b32 v67, 0xffff0000, v49
v_lshlrev_b32 v68, 16, v50
v_and_b32 v69, 0xffff0000, v50
v_lshlrev_b32 v70, 16, v51
v_and_b32 v71, 0xffff0000, v51
v_lshlrev_b32 v72, 16, v52
v_and_b32 v73, 0xffff0000, v52
v_lshlrev_b32 v74, 16, v53
v_and_b32 v75, 0xffff0000, v53
v_lshlrev_b32 v76, 16, v54
v_and_b32 v77, 0xffff0000, v54
v_lshlrev_b32 v78, 16, v55
v_and_b32 v79, 0xffff0000, v55
v_sub_f32 v30, 1.0, v39
v_cmp_eq_u32 s[80:81], s92, v37
v_cmp_eq_u32 s[82:83], s94, v37
s_nop 0
s_or_b64 vcc, s[80:81], s[82:83]
s_cbranch_vccnz L_moe0
L_moe_ret0:
MF v64,v30,v64
MF v65,v30,v65
MF v66,v30,v66
MF v67,v30,v67
MF v68,v30,v68
MF v69,v30,v69
MF v70,v30,v70
MF v71,v30,v71
MF v72,v30,v72
MF v73,v30,v73
MF v74,v30,v74
MF v75,v30,v75
MF v76,v30,v76
MF v77,v30,v77
MF v78,v30,v78
MF v79,v30,v79
s_cmp_lg_u32 s70, 0
s_cbranch_scc1 L_rk3
s_call_b64 s[36:37], L_rpoll
L_rk3:
s_ff1_i32_b32 s71, s70
s_bitset0_b32 s70, s71
s_mul_i32 s71, s71, 114688
SA s72,s71,s77
buffer_load_dwordx4 v[152:155], v7, s[8:11], s72 offen sc1
buffer_load_dwordx4 v[156:159], v27, s[8:11], s72 offen sc1
v_lshlrev_b32 v80, 16, v44
v_and_b32 v81, 0xffff0000, v44
v_lshlrev_b32 v82, 16, v45
v_and_b32 v83, 0xffff0000, v45
v_lshlrev_b32 v84, 16, v46
v_and_b32 v85, 0xffff0000, v46
v_lshlrev_b32 v86, 16, v47
v_and_b32 v87, 0xffff0000, v47
v_sub_f32 v30, 1.0, v26
v_cmp_eq_u32 s[80:81], s92, v29
v_cmp_eq_u32 s[82:83], s94, v29
s_nop 0
s_or_b64 vcc, s[80:81], s[82:83]
s_cbranch_vccnz L_moe1
L_moe_ret1:
MF v80,v30,v80
MF v81,v30,v81
MF v82,v30,v82
MF v83,v30,v83
MF v84,v30,v84
MF v85,v30,v85
MF v86,v30,v86
MF v87,v30,v87
s_waitcnt vmcnt(7)
M v[96:99],a[246:249],v[128:131],0
M v[100:103],a[244:247],v[128:131],0
s_waitcnt vmcnt(6)
M v[104:107],a[246:249],v[132:135],0
M v[108:111],a[244:247],v[132:135],0
s_cmp_lg_u32 s70, 0
s_cbranch_scc1 L_rk4
s_call_b64 s[36:37], L_rpoll
L_rk4:
s_ff1_i32_b32 s71, s70
s_bitset0_b32 s70, s71
s_mul_i32 s71, s71, 114688
SA s72,s71,s77
buffer_load_dwordx4 v[160:163], v7, s[8:11], s72 offen sc1
buffer_load_dwordx4 v[164:167], v27, s[8:11], s72 offen sc1
s_waitcnt vmcnt(7)
M v[96:99],a[246:249],v[136:139],v[96:99]
M v[100:103],a[244:247],v[136:139],v[100:103]
s_waitcnt vmcnt(6)
M v[104:107],a[246:249],v[140:143],v[104:107]
M v[108:111],a[244:247],v[140:143],v[108:111]
s_cmp_lg_u32 s70, 0
s_cbranch_scc1 L_rk5
s_call_b64 s[36:37], L_rpoll
L_rk5:
s_ff1_i32_b32 s71, s70
s_bitset0_b32 s70, s71
s_mul_i32 s71, s71, 114688
SA s72,s71,s77
buffer_load_dwordx4 v[168:171], v7, s[8:11], s72 offen sc1
buffer_load_dwordx4 v[172:175], v27, s[8:11], s72 offen sc1
s_waitcnt vmcnt(7)
M v[96:99],a[246:249],v[144:147],v[96:99]
M v[100:103],a[244:247],v[144:147],v[100:103]
s_waitcnt vmcnt(6)
M v[104:107],a[246:249],v[148:151],v[104:107]
M v[108:111],a[244:247],v[148:151],v[108:111]
s_cmp_lg_u32 s70, 0
s_cbranch_scc1 L_rk6
s_call_b64 s[36:37], L_rpoll
L_rk6:
s_ff1_i32_b32 s71, s70
s_bitset0_b32 s70, s71
s_mul_i32 s71, s71, 114688
SA s72,s71,s77
buffer_load_dwordx4 v[176:179], v7, s[8:11], s72 offen sc1
buffer_load_dwordx4 v[180:183], v27, s[8:11], s72 offen sc1
s_waitcnt vmcnt(7)
M v[96:99],a[246:249],v[152:155],v[96:99]
M v[100:103],a[244:247],v[152:155],v[100:103]
s_waitcnt vmcnt(6)
M v[104:107],a[246:249],v[156:159],v[104:107]
M v[108:111],a[244:247],v[156:159],v[108:111]
s_cmp_lg_u32 s70, 0
s_cbranch_scc1 L_rk7
s_call_b64 s[36:37], L_rpoll
L_rk7:
s_ff1_i32_b32 s71, s70
s_bitset0_b32 s70, s71
s_mul_i32 s71, s71, 114688
SA s72,s71,s77
buffer_load_dwordx4 v[184:187], v7, s[8:11], s72 offen sc1
buffer_load_dwordx4 v[188:191], v27, s[8:11], s72 offen sc1
s_waitcnt vmcnt(7)
M v[96:99],a[246:249],v[160:163],v[96:99]
M v[100:103],a[244:247],v[160:163],v[100:103]
s_waitcnt vmcnt(6)
M v[104:107],a[246:249],v[164:167],v[104:107]
M v[108:111],a[244:247],v[164:167],v[108:111]
s_cmp_lg_u32 s70, 0
s_cbranch_scc1 L_rk8
s_call_b64 s[36:37], L_rpoll
L_rk8:
s_ff1_i32_b32 s71, s70
s_bitset0_b32 s70, s71
s_mul_i32 s71, s71, 114688
SA s72,s71,s77
buffer_load_dwordx4 v[128:131], v7, s[8:11], s72 offen sc1
buffer_load_dwordx4 v[132:135], v27, s[8:11], s72 offen sc1
s_waitcnt vmcnt(7)
M v[96:99],a[246:249],v[168:171],v[96:99]
M v[100:103],a[244:247],v[168:171],v[100:103]
s_waitcnt vmcnt(6)
M v[104:107],a[246:249],v[172:175],v[104:107]
M v[108:111],a[244:247],v[172:175],v[108:111]
s_cmp_lg_u32 s70, 0
s_cbranch_scc1 L_rk9
s_call_b64 s[36:37], L_rpoll
L_rk9:
s_ff1_i32_b32 s71, s70
s_bitset0_b32 s70, s71
s_mul_i32 s71, s71, 114688
SA s72,s71,s77
buffer_load_dwordx4 v[136:139], v7, s[8:11], s72 offen sc1
buffer_load_dwordx4 v[140:143], v27, s[8:11], s72 offen sc1
s_waitcnt vmcnt(7)
M v[96:99],a[246:249],v[176:179],v[96:99]
M v[100:103],a[244:247],v[176:179],v[100:103]
s_waitcnt vmcnt(6)
M v[104:107],a[246:249],v[180:183],v[104:107]
M v[108:111],a[244:247],v[180:183],v[108:111]
s_cmp_lg_u32 s70, 0
s_cbranch_scc1 L_rk10
s_call_b64 s[36:37], L_rpoll
L_rk10:
s_ff1_i32_b32 s71, s70
s_bitset0_b32 s70, s71
s_mul_i32 s71, s71, 114688
SA s72,s71,s77
buffer_load_dwordx4 v[144:147], v7, s[8:11], s72 offen sc1
buffer_load_dwordx4 v[148:151], v27, s[8:11], s72 offen sc1
s_waitcnt vmcnt(7)
M v[96:99],a[246:249],v[184:187],v[96:99]
M v[100:103],a[244:247],v[184:187],v[100:103]
s_waitcnt vmcnt(6)
M v[104:107],a[246:249],v[188:191],v[104:107]
M v[108:111],a[244:247],v[188:191],v[108:111]
s_cmp_lg_u32 s70, 0
s_cbranch_scc1 L_rk11
s_call_b64 s[36:37], L_rpoll
L_rk11:
s_ff1_i32_b32 s71, s70
s_bitset0_b32 s70, s71
s_mul_i32 s71, s71, 114688
SA s72,s71,s77
buffer_load_dwordx4 v[152:155], v7, s[8:11], s72 offen sc1
buffer_load_dwordx4 v[156:159], v27, s[8:11], s72 offen sc1
s_waitcnt vmcnt(7)
M v[96:99],a[246:249],v[128:131],v[96:99]
M v[100:103],a[244:247],v[128:131],v[100:103]
s_waitcnt vmcnt(6)
M v[104:107],a[246:249],v[132:135],v[104:107]
M v[108:111],a[244:247],v[132:135],v[108:111]
s_cmp_lg_u32 s70, 0
s_cbranch_scc1 L_rk12
s_call_b64 s[36:37], L_rpoll
L_rk12:
s_ff1_i32_b32 s71, s70
s_bitset0_b32 s70, s71
s_mul_i32 s71, s71, 114688
SA s72,s71,s77
buffer_load_dwordx4 v[160:163], v7, s[8:11], s72 offen sc1
buffer_load_dwordx4 v[164:167], v27, s[8:11], s72 offen sc1
buffer_load_dword v8, v33, s[8:11], s46 offen sc1
s_waitcnt vmcnt(8)
M v[96:99],a[246:249],v[136:139],v[96:99]
M v[100:103],a[244:247],v[136:139],v[100:103]
s_waitcnt vmcnt(7)
M v[104:107],a[246:249],v[140:143],v[104:107]
M v[108:111],a[244:247],v[140:143],v[108:111]
s_cmp_lg_u32 s70, 0
s_cbranch_scc1 L_rk13
s_call_b64 s[36:37], L_rpoll
L_rk13:
s_ff1_i32_b32 s71, s70
s_bitset0_b32 s70, s71
s_mul_i32 s71, s71, 114688
SA s72,s71,s77
buffer_load_dwordx4 v[168:171], v7, s[8:11], s72 offen sc1
buffer_load_dwordx4 v[172:175], v27, s[8:11], s72 offen sc1
s_waitcnt vmcnt(8)
M v[96:99],a[246:249],v[144:147],v[96:99]
M v[100:103],a[244:247],v[144:147],v[100:103]
s_waitcnt vmcnt(7)
M v[104:107],a[246:249],v[148:151],v[104:107]
M v[108:111],a[244:247],v[148:151],v[108:111]
s_cmp_lg_u32 s70, 0
s_cbranch_scc1 L_rk14
s_call_b64 s[36:37], L_rpoll
L_rk14:
s_ff1_i32_b32 s71, s70
s_bitset0_b32 s70, s71
s_mul_i32 s71, s71, 114688
SA s72,s71,s77
buffer_load_dwordx4 v[176:179], v7, s[8:11], s72 offen sc1
buffer_load_dwordx4 v[180:183], v27, s[8:11], s72 offen sc1
s_waitcnt vmcnt(8)
M v[96:99],a[246:249],v[152:155],v[96:99]
M v[100:103],a[244:247],v[152:155],v[100:103]
s_waitcnt vmcnt(7)
M v[104:107],a[246:249],v[156:159],v[104:107]
M v[108:111],a[244:247],v[156:159],v[108:111]
s_cmp_lg_u32 s70, 0
s_cbranch_scc1 L_rk15
s_call_b64 s[36:37], L_rpoll
L_rk15:
s_ff1_i32_b32 s71, s70
s_bitset0_b32 s70, s71
s_mul_i32 s71, s71, 114688
SA s72,s71,s77
buffer_load_dwordx4 v[184:187], v7, s[8:11], s72 offen sc1
buffer_load_dwordx4 v[188:191], v27, s[8:11], s72 offen sc1
s_waitcnt vmcnt(8)
M v[96:99],a[246:249],v[160:163],v[96:99]
M v[100:103],a[244:247],v[160:163],v[100:103]
s_waitcnt vmcnt(7)
M v[104:107],a[246:249],v[164:167],v[104:107]
M v[108:111],a[244:247],v[164:167],v[108:111]
s_waitcnt vmcnt(6)
v_cmp_eq_u32 vcc, 1, v8
s_mov_b32 s69, 0xffff0000
s_and_b32 s70, vcc_lo, s69
s_mov_b32 s68, s70
s_cmp_lg_u32 s70, 0
s_cbranch_scc1 L_rk16
s_call_b64 s[36:37], L_rpoll
L_rk16:
s_ff1_i32_b32 s71, s70
s_bitset0_b32 s70, s71
s_mul_i32 s71, s71, 114688
SA s72,s71,s78
buffer_load_dwordx4 v[192:195], v7, s[8:11], s72 offen sc1
s_waitcnt vmcnt(6)
M v[96:99],a[246:249],v[168:171],v[96:99]
M v[100:103],a[244:247],v[168:171],v[100:103]
s_waitcnt vmcnt(5)
M v[104:107],a[246:249],v[172:175],v[104:107]
M v[108:111],a[244:247],v[172:175],v[108:111]
s_cmp_lg_u32 s70, 0
s_cbranch_scc1 L_rk17
s_call_b64 s[36:37], L_rpoll
L_rk17:
s_ff1_i32_b32 s71, s70
s_bitset0_b32 s70, s71
s_mul_i32 s71, s71, 114688
SA s72,s71,s78
buffer_load_dwordx4 v[196:199], v7, s[8:11], s72 offen sc1
s_waitcnt vmcnt(5)
M v[96:99],a[246:249],v[176:179],v[96:99]
M v[100:103],a[244:247],v[176:179],v[100:103]
s_waitcnt vmcnt(4)
M v[104:107],a[246:249],v[180:183],v[104:107]
M v[108:111],a[244:247],v[180:183],v[108:111]
s_cmp_lg_u32 s70, 0
s_cbranch_scc1 L_rk18
s_call_b64 s[36:37], L_rpoll
L_rk18:
s_ff1_i32_b32 s71, s70
s_bitset0_b32 s70, s71
s_mul_i32 s71, s71, 114688
SA s72,s71,s78
buffer_load_dwordx4 v[200:203], v7, s[8:11], s72 offen sc1
s_waitcnt vmcnt(4)
M v[96:99],a[246:249],v[184:187],v[96:99]
M v[100:103],a[244:247],v[184:187],v[100:103]
s_waitcnt vmcnt(3)
M v[104:107],a[246:249],v[188:191],v[104:107]
M v[108:111],a[244:247],v[188:191],v[108:111]
s_nop 4
v_permlane16_swap_b32 v96, v100
v_permlane16_swap_b32 v97, v101
v_permlane16_swap_b32 v98, v102
v_permlane16_swap_b32 v99, v103
v_permlane16_swap_b32 v104, v108
v_permlane16_swap_b32 v105, v109
v_permlane16_swap_b32 v106, v110
v_permlane16_swap_b32 v107, v111
v_fmac_f32 v64, v39, v96
v_fmac_f32 v65, v39, v97
v_fmac_f32 v66, v39, v98
v_fmac_f32 v67, v39, v99
v_fmac_f32 v68, v39, v100
v_fmac_f32 v69, v39, v101
v_fmac_f32 v70, v39, v102
v_fmac_f32 v71, v39, v103
C v48,v64,v65
C v49,v66,v67
C v50,v68,v69
C v51,v70,v71
buffer_store_dwordx4 v[48:51], v38, s[52:55], s75 offen sc1
v_fmac_f32 v72, v39, v104
v_fmac_f32 v73, v39, v105
v_fmac_f32 v74, v39, v106
v_fmac_f32 v75, v39, v107
v_fmac_f32 v76, v39, v108
v_fmac_f32 v77, v39, v109
v_fmac_f32 v78, v39, v110
v_fmac_f32 v79, v39, v111
C v52,v72,v73
C v53,v74,v75
C v54,v76,v77
C v55,v78,v79
buffer_store_dwordx4 v[52:55], v38, s[52:55], s76 offen sc1
s_cmp_lg_u32 s70, 0
s_cbranch_scc1 L_rk19
s_call_b64 s[36:37], L_rpoll
L_rk19:
s_ff1_i32_b32 s71, s70
s_bitset0_b32 s70, s71
s_mul_i32 s71, s71, 114688
SA s72,s71,s78
buffer_load_dwordx4 v[204:207], v7, s[8:11], s72 offen sc1
s_cmp_lg_u32 s70, 0
s_cbranch_scc1 L_rk20
s_call_b64 s[36:37], L_rpoll
L_rk20:
s_ff1_i32_b32 s71, s70
s_bitset0_b32 s70, s71
s_mul_i32 s71, s71, 114688
SA s72,s71,s78
buffer_load_dwordx4 v[208:211], v7, s[8:11], s72 offen sc1
s_cmp_lg_u32 s70, 0
s_cbranch_scc1 L_rk21
s_call_b64 s[36:37], L_rpoll
L_rk21:
s_ff1_i32_b32 s71, s70
s_bitset0_b32 s70, s71
s_mul_i32 s71, s71, 114688
SA s72,s71,s78
buffer_load_dwordx4 v[212:215], v7, s[8:11], s72 offen sc1
s_cmp_lg_u32 s70, 0
s_cbranch_scc1 L_rk22
s_call_b64 s[36:37], L_rpoll
L_rk22:
s_ff1_i32_b32 s71, s70
s_bitset0_b32 s70, s71
s_mul_i32 s71, s71, 114688
SA s72,s71,s78
buffer_load_dwordx4 v[216:219], v7, s[8:11], s72 offen sc1
s_cmp_lg_u32 s70, 0
s_cbranch_scc1 L_rk23
s_call_b64 s[36:37], L_rpoll
L_rk23:
s_ff1_i32_b32 s71, s70
s_bitset0_b32 s70, s71
s_mul_i32 s71, s71, 114688
SA s72,s71,s78
buffer_load_dwordx4 v[220:223], v7, s[8:11], s72 offen sc1
s_cmp_lg_u32 s70, 0
s_cbranch_scc1 L_rk24
s_call_b64 s[36:37], L_rpoll
L_rk24:
s_ff1_i32_b32 s71, s70
s_bitset0_b32 s70, s71
s_mul_i32 s71, s71, 114688
SA s72,s71,s78
buffer_load_dwordx4 v[224:227], v7, s[8:11], s72 offen sc1
s_cmp_lg_u32 s70, 0
s_cbranch_scc1 L_rk25
s_call_b64 s[36:37], L_rpoll
L_rk25:
s_ff1_i32_b32 s71, s70
s_bitset0_b32 s70, s71
s_mul_i32 s71, s71, 114688
SA s72,s71,s78
buffer_load_dwordx4 v[228:231], v7, s[8:11], s72 offen sc1
s_cmp_lg_u32 s70, 0
s_cbranch_scc1 L_rk26
s_call_b64 s[36:37], L_rpoll
L_rk26:
s_ff1_i32_b32 s71, s70
s_bitset0_b32 s70, s71
s_mul_i32 s71, s71, 114688
SA s72,s71,s78
buffer_load_dwordx4 v[232:235], v7, s[8:11], s72 offen sc1
s_cmp_lg_u32 s70, 0
s_cbranch_scc1 L_rk27
s_call_b64 s[36:37], L_rpoll
L_rk27:
s_ff1_i32_b32 s71, s70
s_bitset0_b32 s70, s71
s_mul_i32 s71, s71, 114688
SA s72,s71,s78
buffer_load_dwordx4 v[236:239], v7, s[8:11], s72 offen sc1
s_waitcnt vmcnt(13)
M v[112:115],a[246:249],v[192:195],0
M v[116:119],a[244:247],v[192:195],0
s_cmp_lg_u32 s70, 0
s_cbranch_scc1 L_rk28
s_call_b64 s[36:37], L_rpoll
L_rk28:
s_ff1_i32_b32 s71, s70
s_bitset0_b32 s70, s71
s_mul_i32 s71, s71, 114688
SA s72,s71,s78
buffer_load_dwordx4 v[240:243], v7, s[8:11], s72 offen sc1
s_waitcnt vmcnt(13)
M v[112:115],a[246:249],v[196:199],v[112:115]
M v[116:119],a[244:247],v[196:199],v[116:119]
s_cmp_lg_u32 s70, 0
s_cbranch_scc1 L_rk29
s_call_b64 s[36:37], L_rpoll
L_rk29:
s_ff1_i32_b32 s71, s70
s_bitset0_b32 s70, s71
s_mul_i32 s71, s71, 114688
SA s72,s71,s78
buffer_load_dwordx4 v[244:247], v7, s[8:11], s72 offen sc1
s_waitcnt vmcnt(13)
M v[112:115],a[246:249],v[200:203],v[112:115]
M v[116:119],a[244:247],v[200:203],v[116:119]
s_cmp_lg_u32 s70, 0
s_cbranch_scc1 L_rk30
s_call_b64 s[36:37], L_rpoll
L_rk30:
s_ff1_i32_b32 s71, s70
s_bitset0_b32 s70, s71
s_mul_i32 s71, s71, 114688
SA s72,s71,s78
buffer_load_dwordx4 v[248:251], v7, s[8:11], s72 offen sc1
s_waitcnt vmcnt(11)
M v[112:115],a[246:249],v[204:207],v[112:115]
M v[116:119],a[244:247],v[204:207],v[116:119]
s_cmp_lg_u32 s70, 0
s_cbranch_scc1 L_rk31
s_call_b64 s[36:37], L_rpoll
L_rk31:
s_ff1_i32_b32 s71, s70
s_bitset0_b32 s70, s71
s_mul_i32 s71, s71, 114688
SA s72,s71,s78
buffer_load_dwordx4 v[252:255], v7, s[8:11], s72 offen sc1
s_waitcnt vmcnt(11)
M v[112:115],a[246:249],v[208:211],v[112:115]
M v[116:119],a[244:247],v[208:211],v[116:119]
s_waitcnt vmcnt(10)
M v[112:115],a[246:249],v[212:215],v[112:115]
M v[116:119],a[244:247],v[212:215],v[116:119]
s_waitcnt vmcnt(9)
M v[112:115],a[246:249],v[216:219],v[112:115]
M v[116:119],a[244:247],v[216:219],v[116:119]
s_waitcnt vmcnt(8)
M v[112:115],a[246:249],v[220:223],v[112:115]
M v[116:119],a[244:247],v[220:223],v[116:119]
s_waitcnt vmcnt(7)
M v[112:115],a[246:249],v[224:227],v[112:115]
M v[116:119],a[244:247],v[224:227],v[116:119]
s_waitcnt vmcnt(6)
M v[112:115],a[246:249],v[228:231],v[112:115]
M v[116:119],a[244:247],v[228:231],v[116:119]
s_waitcnt vmcnt(5)
M v[112:115],a[246:249],v[232:235],v[112:115]
M v[116:119],a[244:247],v[232:235],v[116:119]
s_waitcnt vmcnt(4)
M v[112:115],a[246:249],v[236:239],v[112:115]
M v[116:119],a[244:247],v[236:239],v[116:119]
s_waitcnt vmcnt(3)
M v[112:115],a[246:249],v[240:243],v[112:115]
M v[116:119],a[244:247],v[240:243],v[116:119]
s_waitcnt vmcnt(2)
M v[112:115],a[246:249],v[244:247],v[112:115]
M v[116:119],a[244:247],v[244:247],v[116:119]
s_waitcnt vmcnt(1)
M v[112:115],a[246:249],v[248:251],v[112:115]
M v[116:119],a[244:247],v[248:251],v[116:119]
s_waitcnt vmcnt(0)
M v[112:115],a[246:249],v[252:255],v[112:115]
M v[116:119],a[244:247],v[252:255],v[116:119]
s_nop 7
v_permlane16_swap_b32 v112, v116
v_permlane16_swap_b32 v113, v117
v_permlane16_swap_b32 v114, v118
v_permlane16_swap_b32 v115, v119
v_fmac_f32 v80, v26, v112
v_fmac_f32 v81, v26, v113
v_fmac_f32 v82, v26, v114
v_fmac_f32 v83, v26, v115
v_fmac_f32 v84, v26, v116
v_fmac_f32 v85, v26, v117
v_fmac_f32 v86, v26, v118
v_fmac_f32 v87, v26, v119
C v44,v80,v81
C v45,v82,v83
C v46,v84,v85
C v47,v86,v87
buffer_store_dwordx4 v[44:47], v28, s[52:55], s79 offen sc1
s_endpgm
L_rpoll0:
s_sleep 1
L_rpoll:
buffer_load_dword v9, v33, s[8:11], s46 offen sc1
s_waitcnt vmcnt(0)
v_cmp_eq_u32 vcc, 1, v9
s_sub_u32 s91, s91, 1
s_cselect_b32 s70, -1, 0
s_or_b32 s70, s70, vcc_lo
s_and_b32 s70, s70, s69
s_andn2_b32 s70, s70, s68
s_cbranch_scc0 L_rpoll0
s_or_b32 s68, s68, s70
s_setpc_b64 s[36:37]
L_moe0:
s_lshl_b32 s88, s75, 1
s_call_b64 s[36:37], L_moe
AF v64,v2,v64
AF v65,v3,v65
AF v66,v4,v66
AF v67,v5,v67
AF v68,v10,v68
AF v69,v11,v69
AF v70,v12,v70
AF v71,v13,v71
AF v72,v14,v72
AF v73,v15,v73
AF v74,v16,v74
AF v75,v17,v75
AF v76,v18,v76
AF v77,v19,v77
AF v78,v20,v78
AF v79,v21,v79
s_mov_b64 exec, -1
s_branch L_moe_ret0
L_moe1:
s_lshl_b32 s88, s79, 1
s_call_b64 s[36:37], L_moe
AF v80,v2,v80
AF v81,v3,v81
AF v82,v4,v82
AF v83,v5,v83
AF v84,v10,v84
AF v85,v11,v85
AF v86,v12,v86
AF v87,v13,v87
s_mov_b64 exec, -1
s_branch L_moe_ret1
L_moe2:
s_lshl_b32 s88, s79, 1
s_call_b64 s[36:37], L_moe
AF v48,v2,v48
AF v49,v3,v49
AF v50,v4,v50
AF v51,v5,v51
AF v52,v10,v52
AF v53,v11,v53
AF v54,v12,v54
AF v55,v13,v55
s_mov_b64 exec, -1
s_branch L_moe_ret2
L_moe:
v_min_u32 v0, 27, v32
v_lshlrev_b32 v0, 2, v0
s_mov_b32 s64, 105062912
s_mov_b32 s65, 65536
s_mov_b32 exec_lo, 0xffffffff
s_mov_b32 exec_hi, 0xffffffff
L_pfy:
buffer_load_dword v1, v0, s[8:11], s64 offen sc1
s_sub_u32 s65, s65, 1
s_cbranch_scc1 L_pfy_x
s_waitcnt vmcnt(0)
v_cmp_ne_u32 vcc, 1, v1
s_nop 0
s_cbranch_vccz L_pfy_x
s_sleep 2
s_branch L_pfy
L_pfy_x:
s_waitcnt vmcnt(0)
s_mov_b64 exec, -1
s_or_b64 exec, s[80:81], s[82:83]
v_mov_b32 v0, 1792
v_cndmask_b32 v0, v0, 0, s[80:81]
v_lshl_add_u32 v0, v34, 5, v0
SA s88,s88,104898560
buffer_load_dwordx4 v[2:5], v0, s[8:11], s88 offen sc1
buffer_load_dwordx4 v[10:13], v0, s[8:11], s88 offen offset:16 sc1
buffer_load_dwordx4 v[14:17], v0, s[8:11], s88 offen offset:512 sc1
buffer_load_dwordx4 v[18:21], v0, s[8:11], s88 offen offset:528 sc1
s_waitcnt vmcnt(0)
s_setpc_b64 s[36:37]
L_red:
v_lshrrev_b32 v32, 4, v7
s_lshr_b32 s74, s41, 3
s_lshl_b32 s64, s42, 1
SA s46,s64,s74
s_mul_i32 s46, s46, 4352
s_and_b32 s72, s41, 7
s_lshl_b32 s65, s72, 7
SA s46,s46,s65
SA s46,s46,104992768
v_and_b32 v33, 31, v32
v_lshlrev_b32 v33, 2, v33
s_lshl_b32 s65, s41, 7
SA s65,s65,104890368
buffer_load_dword v31, v33, s[8:11], s65 offen sc1
v_bfe_u32 v34, v32, 4, 1
v_lshlrev_b32 v34, 1, v34
v_lshrrev_b32 v35, 5, v32
v_add_u32 v34, v34, v35
s_mov_b32 s52, s96
s_and_b32 s53, s97, 0xffff
s_mov_b32 s54, 1835008
s_mov_b32 s55, 0x20000
s_mul_i32 s77, s42, 1835008
s_mul_i32 s78, s72, 14336
SA s77,s77,s78
SA s77,s77,67108864
s_lshl_b32 s79, s74, 1
SA s79,s79,s20
s_lshl_b32 s71, s74, 1
SA s71,s71,1
s_sub_u32 s71, s71, s20
s_and_b32 s71, s71, 536870912
s_sub_u32 s64, 15, s64
s_sub_u32 s78, s64, 1
s_mul_i32 s78, s78, 1835008
SA s78,s78,s77
s_lshl_b32 s65, s79, 10
SA s78,s78,s65
SA s78,s78,s71
s_lshl_b32 s79, s79, 6
s_or_b32 s79, s79, s71
s_mul_i32 s67, s74, -2
s_lshl_b32 s74, s74, 3
SA s74,s74,s20
s_lshl_b32 s75, s74, 6
SA s76,s75,256
SA s67,s67,3
s_sub_u32 s67, s67, s20
s_and_b32 s67, s67, 536870912
s_or_b32 s76, s76, s67
v_or_b32 v27, s67, v7
v_add_u32 v27, 4096, v27
s_lshl_b32 s65, s74, 10
SA s77,s77,s65
s_lshl_b32 s64, s64, 7
s_lshr_b32 s73, s72, 1
s_sub_u32 s65, 7, s73
s_bitcmp1_b32 s72, 0
s_cselect_b32 s73, s65, s73
s_lshl_b32 s73, s73, 4
s_lshl_b32 s65, s42, 7
SA s73,s73,s65
v_and_b32 v37, 15, v32
v_add_u32 v37, s73, v37
v_add_u32 v29, s64, v37
s_mov_b32 s64, 104857664
v_mul_u32_u24 v38, 896, v37
v_lshl_add_u32 v38, v34, 4, v38
v_lshrrev_b32 v35, 4, v37
v_lshlrev_b32 v35, 5, v35
v_and_b32 v36, 15, v37
v_add_lshl_u32 v35, v35, v36, 2
buffer_load_dword v39, v35, s[8:11], s64 offen sc1
buffer_load_dwordx4 v[48:51], v38, s[56:59], s75 offen
buffer_load_dwordx4 v[52:55], v38, s[56:59], s76 offen
v_mul_u32_u24 v28, 896, v29
v_lshl_add_u32 v28, v34, 4, v28
v_lshrrev_b32 v35, 4, v29
v_lshlrev_b32 v35, 5, v35
v_and_b32 v36, 15, v29
v_add_lshl_u32 v35, v35, v36, 2
buffer_load_dword v26, v35, s[8:11], s64 offen sc1
buffer_load_dwordx4 v[44:47], v28, s[56:59], s79 offen
s_waitcnt vmcnt(7)
buffer_load_dword v9, v33, s[8:11], s46 offen sc1
s_branch L_red1
L_code_end:
.section .rodata,"a"
.p2align 6
.amdhsa_kernel gated_mix__compressed_kv_cla__moe_arch_mod__prompt_kernel
  .amdhsa_next_free_vgpr 512
  .amdhsa_next_free_sgpr 102
  .amdhsa_accum_offset 256
  .amdhsa_group_segment_fixed_size 0
  .amdhsa_kernarg_size 120
  .amdhsa_user_sgpr_count 2
  .amdhsa_user_sgpr_kernarg_segment_ptr 1
  .amdhsa_system_sgpr_workgroup_id_x 1
  .amdhsa_float_denorm_mode_32 3
.end_amdhsa_kernel
```

```asm
; @launch grid=(256,1,1) block=(256,1,1) lds=163840
.amdgcn_target "amdgcn-amd-amdhsa--gfx950"
.text
.macro M a, b, c, d
v_mfma_f32_16x16x32_bf16 \a, \b, \c, \d
.endm
.macro R a, b, c
ds_read_b128 \a, \b offset:\c
.endm
.macro T a, b, c
ds_read_b64_tr_b16 \a, \b offset:\c
.endm
.macro C a, b, c
v_cvt_pk_bf16_f32 \a, \b, \c
.endm
.macro E a, b
v_exp_f32 \a, \b
.endm
.macro W a, b
v_accvgpr_write_b32 \a, \b
.endm
.macro G a, b
v_accvgpr_read_b32 \a, \b
.endm
.macro AF a, b, c
v_add_f32 \a, \b, \c
.endm
.macro MF a, b, c
v_mul_f32 \a, \b, \c
.endm
.macro SA a, b, c
s_add_u32 \a, \b, \c
.endm
.globl gated_mix__compressed_kv_cla__moe_arch_mod__prompt_kernel
.p2align 8
.type gated_mix__compressed_kv_cla__moe_arch_mod__prompt_kernel,@function
gated_mix__compressed_kv_cla__moe_arch_mod__prompt_kernel:
s_cmp_lt_u32 s2, 256
s_cbranch_scc1 L_go
s_endpgm
L_go:
s_load_dwordx8 s[80:87], s[0:1], 0
s_load_dwordx4 s[88:91], s[0:1], 32
s_getpc_b64 s[76:77]
L_pc0:
s_lshr_b32 s42, s2, 3
s_mov_b32 s79, 0x20000
s_lshl_b32 s67, s42, 13
s_mov_b32 s78, L_code_end-L_pc0
s_and_b32 s77, s77, 0xffff
v_lshl_add_u32 v31, v0, 5, s67
buffer_load_dword a240, v31, s[76:79], 0 offen offset:0
v_lshrrev_b32 v24, 6, v0
v_and_b32 v0, 63, v0
s_and_b32 s41, s2, 7
v_readfirstlane_b32 s20, v24
s_lshr_b32 s64, s2, 4
v_and_b32 v24, 15, v0
v_lshrrev_b32 v25, 4, v0
s_and_b32 s64, s64, 8
s_or_b32 s41, s41, s64
v_lshlrev_b32 v28, 1, v25
v_xor_b32 v28, v28, v24
v_and_b32 v29, 8, v28
v_and_b32 v28, 7, v28
v_lshlrev_b32 v28, 4, v28
v_lshl_add_u32 v28, v29, 5, v28
v_lshl_add_u32 v28, v25, 13, v28
s_lshl_b32 s64, s20, 17
v_add_u32 v8, s64, v28
v_xor_b32 v28, 0x100, v8
v_add_u32 v9, 31744, v8
v_add_u32 v10, 63488, v28
v_add_u32 v11, 95232, v28
s_mov_b32 s21, 0
s_lshl_b32 s23, s20, 12
s_lshl_b32 s74, s41, 9
s_sub_u32 s18, 8388608, s74
s_mov_b32 s19, s79
s_bitcmp0_b32 s2, 6
s_waitcnt lgkmcnt(0)
s_cselect_b64 s[72:73], s[86:87], s[88:89]
SA s16,s72,s74
s_addc_u32 s73, s73, 0
s_and_b32 s17, s73, 0xffff
SA m0,s23,0
s_nop 0
buffer_load_dwordx4 v8, s[16:19], s21 offen offset:0   lds
buffer_load_dwordx4 v9, s[16:19], s21 offen offset:1024   lds
buffer_load_dwordx4 v10, s[16:19], s21 offen offset:2048   lds
buffer_load_dwordx4 v11, s[16:19], s21 offen offset:3072   lds
SA s21,s21,128
s_and_b32 s42, s42, 15
s_lshr_b32 s45, s42, 3
s_and_b32 s65, s20, 1
s_lshr_b32 s66, s20, 1
v_and_b32 v29, 7, v0
v_xor_b32 v28, v25, v29
v_lshlrev_b32 v28, 4, v28
v_lshrrev_b32 v29, 3, v0
v_lshl_add_u32 v30, v29, 11, v28
s_lshl_b32 s64, s66, 19
s_lshl_b32 s67, s65, 21
SA s64,s64,s67
v_add_u32 v12, s64, v30
v_xor_b32 v30, 64, v12
v_add_u32 v14, 30720, v12
v_add_u32 v13, 15360, v30
v_add_u32 v15, 46080, v30
s_mov_b32 s22, 0
SA s24,s23,65536
s_and_b32 s64, s42, 7
s_lshl_b32 s64, s64, 16
s_sub_u32 s50, 4194304, s64
s_mov_b32 s51, s79
SA s48,s82,s64
s_addc_u32 s73, s83, 0
s_and_b32 s49, s73, 0xffff
SA m0,s23,16384
s_nop 0
buffer_load_dwordx4 v8, s[16:19], s21 offen offset:0   lds
buffer_load_dwordx4 v9, s[16:19], s21 offen offset:1024   lds
buffer_load_dwordx4 v10, s[16:19], s21 offen offset:2048   lds
buffer_load_dwordx4 v11, s[16:19], s21 offen offset:3072   lds
SA s21,s21,524160
SA m0,s24,0
s_nop 0
buffer_load_dwordx4 v12, s[48:51], s22 offen offset:0   lds
buffer_load_dwordx4 v13, s[48:51], s22 offen offset:1024   lds
buffer_load_dwordx4 v14, s[48:51], s22 offen offset:2048   lds
buffer_load_dwordx4 v15, s[48:51], s22 offen offset:3072   lds
SA s22,s22,1048576
s_load_dwordx2 s[92:93], s[0:1], 56
s_load_dwordx2 s[94:95], s[0:1], 88
s_load_dwordx4 s[4:7], s[0:1], 104
v_lshlrev_b32 v7, 4, v0
v_lshrrev_b32 v26, 2, v24
v_and_b32 v28, 1, v25
v_lshl_or_b32 v28, v28, 2, v26
v_lshl_add_u32 v29, v25, 3, v26
v_lshlrev_b32 v29, 8, v29
v_and_b32 v30, 3, v0
v_lshl_add_u32 v29, v30, 3, v29
s_lshl_b32 s64, s65, 2
SA s64,s64,0
v_xor_b32 v30, s64, v28
v_lshl_add_u32 v1, v30, 5, v29
s_lshl_b32 s64, s65, 2
SA s64,s64,1
v_xor_b32 v30, s64, v28
v_lshl_add_u32 v2, v30, 5, v29
s_lshl_b32 s64, s65, 2
SA s64,s64,2
v_xor_b32 v30, s64, v28
v_lshl_add_u32 v3, v30, 5, v29
s_lshl_b32 s64, s65, 2
SA s64,s64,3
v_xor_b32 v30, s64, v28
v_lshl_add_u32 v4, v30, 5, v29
v_add_u32 v28, 0, v25
v_lshrrev_b32 v29, 1, v24
v_xor_b32 v28, v28, v29
v_lshlrev_b32 v28, 4, v28
v_lshl_add_u32 v28, v24, 7, v28
s_lshl_b32 s64, s66, 13
SA s64,s64,65536
v_add_u32 v5, s64, v28
v_add_u32 v28, 4, v25
v_lshrrev_b32 v29, 1, v24
v_xor_b32 v28, v28, v29
v_lshlrev_b32 v28, 4, v28
v_lshl_add_u32 v28, v24, 7, v28
s_lshl_b32 s64, s66, 13
SA s64,s64,65536
v_add_u32 v6, s64, v28
s_mov_b32 s56, s80
s_and_b32 s57, s81, 0xffff
s_mov_b32 s58, 1835008
s_mov_b32 s59, 0x20000
s_waitcnt lgkmcnt(0)
s_mov_b32 s60, s92
s_and_b32 s61, s93, 0xffff
s_mov_b32 s62, 896
s_mov_b32 s63, 0x20000
s_mov_b32 s68, s94
s_and_b32 s69, s95, 0xffff
s_mov_b32 s70, 896
s_mov_b32 s71, 0x20000
s_lshl_b32 s95, s20, 11
s_lshr_b32 s64, s2, 3
s_lshl_b32 s64, s64, 13
SA s95,s95,s64
s_mov_b32 s8, s6
s_and_b32 s9, s7, 0xffff
s_mov_b32 s10, 268435456
s_mov_b32 s11, 0x20000
s_mov_b32 s12, s4
s_and_b32 s13, s5, 0xffff
s_mov_b32 s14, 256
s_mov_b32 s15, 0x20000
SA s72,s84,s74
s_addc_u32 s73, s85, 0
s_sub_u32 s75, 3670016, s74
s_mov_b32 s52, s72
s_and_b32 s53, s73, 0xffff
s_mov_b32 s54, s75
s_mov_b32 s55, 0x20000
s_mul_i32 s29, s42, 114688
s_mov_b32 s5, 0x3db8aa3b
s_mul_i32 s72, s45, 16777216
s_mul_i32 s73, s41, 1048576
SA s72,s72,s73
s_bfe_u32 s64, s42, 0x20001
s_lshl_b32 s64, s64, 15
SA s72,s72,s64
s_lshl_b32 s64, s66, 17
SA s72,s72,s64
s_and_b32 s67, s42, 1
s_cmp_eq_u32 s45, 0
s_cselect_b32 s64, 12, 14
s_cselect_b32 s75, 14, 10
s_lshl_b32 s67, s67, s75
SA s72,s72,s67
s_lshl_b32 s64, s65, s64
SA s93,s72,s64
s_load_dwordx4 s[80:83], s[0:1], 64
s_load_dwordx2 s[84:85], s[0:1], 80
s_load_dwordx2 s[96:97], s[0:1], 96
s_cmp_eq_u32 s45, 0
s_cbranch_scc0 L_kv1
s_branch L_kv0
.p2align 12
L_kv0:
s_and_b32 s31, s42, 7
s_lshl_b32 s64, s42, 4
SA s64,s64,s41
s_lshl_b32 s64, s64, 2
SA s64,s64,s20
s_cmp_lt_u32 s64, 41
s_cselect_b32 s39, 0, 536870912
s_min_u32 s64, s64, 41
s_lshl_b32 s38, s64, 2
s_max_u32 s67, s64, 8
s_sub_u32 s67, s67, 8
s_mul_i32 s67, s67, 3328
s_lshl_b32 s64, s64, 10
SA s64,s64,s67
SA s73,s64,104914944
v_or_b32 v64, s39, v7
v_mov_b32 v68, 0
v_mov_b32 v69, 0
v_mov_b32 v70, 0
v_mov_b32 v71, 0
buffer_store_dwordx4 v[68:71], v64, s[8:11], s73 offen offset:0 sc1
buffer_store_dwordx4 v[68:71], v64, s[8:11], s73 offen offset:1024 sc1
buffer_store_dwordx4 v[68:71], v64, s[8:11], s73 offen offset:2048 sc1
SA m0,s24,16384
s_nop 0
buffer_load_dwordx4 v12, s[48:51], s22 offen offset:0   lds
buffer_load_dwordx4 v13, s[48:51], s22 offen offset:1024   lds
buffer_load_dwordx4 v14, s[48:51], s22 offen offset:2048   lds
buffer_load_dwordx4 v15, s[48:51], s22 offen offset:3072   lds
s_sub_u32 s22, s22, 1048448
SA m0,s23,32768
s_nop 0
buffer_load_dwordx4 v8, s[16:19], s21 offen offset:0   lds
buffer_load_dwordx4 v9, s[16:19], s21 offen offset:1024   lds
buffer_load_dwordx4 v10, s[16:19], s21 offen offset:2048   lds
buffer_load_dwordx4 v11, s[16:19], s21 offen offset:3072   lds
SA s21,s21,128
s_mov_b64 exec, 0
s_cmp_eq_u32 s20, 0
s_cbranch_scc1 L_w_kv01
s_cmp_eq_u32 s20, 1
s_cbranch_scc1 L_w_kv02
s_cmp_eq_u32 s20, 2
s_cbranch_scc1 L_w_kv03
s_branch L_w_kv04
L_wd1:
s_mov_b64 exec, -1
s_waitcnt vmcnt(11) lgkmcnt(0)
s_barrier
R a[160:163],v5,0
R a[164:167],v6,0
T a[96:97],v1,0
T a[98:99],v1,1024
T a[100:101],v1,8192
T a[102:103],v1,9216
T a[104:105],v2,0
T a[106:107],v2,1024
T a[108:109],v2,8192
T a[110:111],v2,9216
T a[112:113],v3,0
T a[114:115],v3,1024
T a[116:117],v3,8192
T a[118:119],v3,9216
T a[120:121],v4,0
T a[122:123],v4,1024
T a[124:125],v4,8192
T a[126:127],v4,9216
T a[128:129],v1,16384
T a[130:131],v1,17408
T a[132:133],v1,24576
T a[134:135],v1,25600
T a[136:137],v2,16384
T a[138:139],v2,17408
T a[140:141],v2,24576
T a[142:143],v2,25600
T a[144:145],v3,16384
T a[146:147],v3,17408
T a[148:149],v3,24576
T a[150:151],v3,25600
T a[152:153],v4,16384
T a[154:155],v4,17408
T a[156:157],v4,24576
T a[158:159],v4,25600
s_waitcnt lgkmcnt(15)
M a[0:3],a[96:99],a[160:163],0
SA m0,s23,49152
R a[168:171],v5,2048
R a[172:175],v6,2048
M a[0:3],a[100:103],a[164:167],a[0:3]
buffer_load_dwordx4 v8, s[16:19], s21 offen offset:0   lds
M a[4:7],a[108:111],a[164:167],0
M a[4:7],a[104:107],a[160:163],a[4:7]
M a[8:11],a[112:115],a[160:163],0
buffer_load_dwordx4 v9, s[16:19], s21 offen offset:1024   lds
M a[8:11],a[116:119],a[164:167],a[8:11]
s_waitcnt lgkmcnt(14)
M a[12:15],a[124:127],a[164:167],0
M a[12:15],a[120:123],a[160:163],a[12:15]
M a[16:19],a[128:131],a[160:163],0
buffer_load_dwordx4 v10, s[16:19], s21 offen offset:2048   lds
M a[16:19],a[132:135],a[164:167],a[16:19]
s_waitcnt lgkmcnt(6)
M a[20:23],a[140:143],a[164:167],0
M a[20:23],a[136:139],a[160:163],a[20:23]
buffer_load_dwordx4 v11, s[16:19], s21 offen offset:3072   lds
M a[24:27],a[144:147],a[160:163],0
SA s21,s21,524160
M a[24:27],a[148:151],a[164:167],a[24:27]
s_waitcnt lgkmcnt(0)
M a[28:31],a[156:159],a[164:167],0
SA m0,s24,32768
M a[28:31],a[152:155],a[160:163],a[28:31]
buffer_load_dwordx4 v12, s[48:51], s22 offen offset:0   lds
M v[32:35],a[96:99],a[168:171],0
R a[160:163],v5,4096
R a[164:167],v6,4096
M v[32:35],a[100:103],a[172:175],v[32:35]
M v[36:39],a[108:111],a[172:175],0
M v[36:39],a[104:107],a[168:171],v[36:39]
buffer_load_dwordx4 v13, s[48:51], s22 offen offset:1024   lds
M v[40:43],a[112:115],a[168:171],0
M v[40:43],a[116:119],a[172:175],v[40:43]
M v[44:47],a[124:127],a[172:175],0
buffer_load_dwordx4 v14, s[48:51], s22 offen offset:2048   lds
M v[44:47],a[120:123],a[168:171],v[44:47]
M v[48:51],a[128:131],a[168:171],0
M v[48:51],a[132:135],a[172:175],v[48:51]
M v[52:55],a[140:143],a[172:175],0
buffer_load_dwordx4 v15, s[48:51], s22 offen offset:3072   lds
M v[52:55],a[136:139],a[168:171],v[52:55]
SA s22,s22,1048576
M v[56:59],a[144:147],a[168:171],0
M v[56:59],a[148:151],a[172:175],v[56:59]
s_waitcnt lgkmcnt(0)
M v[60:63],a[156:159],a[172:175],0
M v[60:63],a[152:155],a[168:171],v[60:63]
M v[64:67],a[96:99],a[160:163],0
R a[168:171],v5,6144
R a[172:175],v6,6144
M v[64:67],a[100:103],a[164:167],v[64:67]
M v[68:71],a[108:111],a[164:167],0
M v[68:71],a[104:107],a[160:163],v[68:71]
M v[72:75],a[112:115],a[160:163],0
M v[72:75],a[116:119],a[164:167],v[72:75]
M v[76:79],a[124:127],a[164:167],0
M v[76:79],a[120:123],a[160:163],v[76:79]
M v[80:83],a[128:131],a[160:163],0
M v[80:83],a[132:135],a[164:167],v[80:83]
M v[84:87],a[140:143],a[164:167],0
M v[84:87],a[136:139],a[160:163],v[84:87]
M v[88:91],a[144:147],a[160:163],0
M v[88:91],a[148:151],a[164:167],v[88:91]
s_waitcnt lgkmcnt(0)
M v[92:95],a[156:159],a[164:167],0
s_waitcnt vmcnt(12)
M v[92:95],a[152:155],a[160:163],v[92:95]
s_barrier
M v[96:99],a[96:99],a[168:171],0
SA m0,s23,0
R a[160:163],v5,16384
R a[164:167],v6,16384
M v[96:99],a[100:103],a[172:175],v[96:99]
buffer_load_dwordx4 v8, s[16:19], s21 offen offset:0   lds
M v[100:103],a[108:111],a[172:175],0
v_lshlrev_b32 v26, 7, v0
v_and_b32 v27, 48, v0
M v[100:103],a[104:107],a[168:171],v[100:103]
v_lshl_add_u32 v26, v27, 24, v26
M v[104:107],a[112:115],a[168:171],0
buffer_load_dwordx4 v9, s[16:19], s21 offen offset:1024   lds
M v[104:107],a[116:119],a[172:175],v[104:107]
M v[108:111],a[124:127],a[172:175],0
M v[108:111],a[120:123],a[168:171],v[108:111]
buffer_load_dwordx4 v10, s[16:19], s21 offen offset:2048   lds
M v[112:115],a[128:131],a[168:171],0
M v[112:115],a[132:135],a[172:175],v[112:115]
M v[116:119],a[140:143],a[172:175],0
M v[116:119],a[136:139],a[168:171],v[116:119]
buffer_load_dwordx4 v11, s[16:19], s21 offen offset:3072   lds
M v[120:123],a[144:147],a[168:171],0
SA s21,s21,128
M v[120:123],a[148:151],a[172:175],v[120:123]
s_waitcnt lgkmcnt(0)
M v[124:127],a[156:159],a[172:175],0
SA m0,s24,49152
M v[124:127],a[152:155],a[168:171],v[124:127]
buffer_load_dwordx4 v12, s[48:51], s22 offen offset:0   lds
M v[128:131],a[96:99],a[160:163],0
R a[168:171],v5,18432
R a[172:175],v6,18432
M v[128:131],a[100:103],a[164:167],v[128:131]
buffer_load_dwordx4 v13, s[48:51], s22 offen offset:1024   lds
M v[132:135],a[108:111],a[164:167],0
M v[132:135],a[104:107],a[160:163],v[132:135]
M v[136:139],a[112:115],a[160:163],0
M v[136:139],a[116:119],a[164:167],v[136:139]
buffer_load_dwordx4 v14, s[48:51], s22 offen offset:2048   lds
M v[140:143],a[124:127],a[164:167],0
M v[140:143],a[120:123],a[160:163],v[140:143]
M v[144:147],a[128:131],a[160:163],0
buffer_load_dwordx4 v15, s[48:51], s22 offen offset:3072   lds
M v[144:147],a[132:135],a[164:167],v[144:147]
s_sub_u32 s22, s22, 1048448
M v[148:151],a[140:143],a[164:167],0
M v[148:151],a[136:139],a[160:163],v[148:151]
M v[152:155],a[144:147],a[160:163],0
M v[152:155],a[148:151],a[164:167],v[152:155]
s_waitcnt lgkmcnt(0)
M v[156:159],a[156:159],a[164:167],0
s_waitcnt vmcnt(12)
M v[156:159],a[152:155],a[160:163],v[156:159]
s_barrier
M v[160:163],a[96:99],a[168:171],0
SA m0,s23,16384
R a[160:163],v5,20480
R a[164:167],v6,20480
M v[160:163],a[100:103],a[172:175],v[160:163]
T a[32:33],v1,32768
T a[34:35],v1,33792
M v[164:167],a[108:111],a[172:175],0
T a[36:37],v1,40960
T a[38:39],v1,41984
M v[164:167],a[104:107],a[168:171],v[164:167]
T a[40:41],v2,32768
T a[42:43],v2,33792
M v[168:171],a[112:115],a[168:171],0
T a[44:45],v2,40960
T a[46:47],v2,41984
M v[168:171],a[116:119],a[172:175],v[168:171]
buffer_load_dwordx4 v8, s[16:19], s21 offen offset:0   lds
M v[172:175],a[124:127],a[172:175],0
s_nop 0
T a[48:49],v3,32768
T a[50:51],v3,33792
M v[172:175],a[120:123],a[168:171],v[172:175]
buffer_load_dwordx4 v9, s[16:19], s21 offen offset:1024   lds
M v[176:179],a[128:131],a[168:171],0
s_nop 0
T a[52:53],v3,40960
T a[54:55],v3,41984
M v[176:179],a[132:135],a[172:175],v[176:179]
T a[56:57],v4,32768
T a[58:59],v4,33792
M v[180:183],a[140:143],a[172:175],0
buffer_load_dwordx4 v10, s[16:19], s21 offen offset:2048   lds
M v[180:183],a[136:139],a[168:171],v[180:183]
s_nop 0
T a[60:61],v4,40960
T a[62:63],v4,41984
M v[184:187],a[144:147],a[168:171],0
buffer_load_dwordx4 v11, s[16:19], s21 offen offset:3072   lds
M v[184:187],a[148:151],a[172:175],v[184:187]
s_waitcnt lgkmcnt(15)
s_nop 0
T a[64:65],v1,49152
T a[66:67],v1,50176
M v[188:191],a[156:159],a[172:175],0
SA s21,s21,524160
T a[68:69],v1,57344
T a[70:71],v1,58368
M v[188:191],a[152:155],a[168:171],v[188:191]
SA m0,s24,0
M v[192:195],a[96:99],a[160:163],0
R a[168:171],v5,22528
R a[172:175],v6,22528
M v[192:195],a[100:103],a[164:167],v[192:195]
T a[72:73],v2,49152
T a[74:75],v2,50176
M v[196:199],a[108:111],a[164:167],0
T a[76:77],v2,57344
T a[78:79],v2,58368
M v[196:199],a[104:107],a[160:163],v[196:199]
T a[80:81],v3,49152
T a[82:83],v3,50176
M v[200:203],a[112:115],a[160:163],0
buffer_load_dwordx4 v12, s[48:51], s22 offen offset:0   lds
M v[200:203],a[116:119],a[164:167],v[200:203]
s_nop 0
T a[84:85],v3,57344
T a[86:87],v3,58368
M v[204:207],a[124:127],a[164:167],0
T a[88:89],v4,49152
T a[90:91],v4,50176
M v[204:207],a[120:123],a[160:163],v[204:207]
buffer_load_dwordx4 v13, s[48:51], s22 offen offset:1024   lds
M v[208:211],a[128:131],a[160:163],0
s_nop 0
T a[92:93],v4,57344
T a[94:95],v4,58368
M v[208:211],a[132:135],a[164:167],v[208:211]
buffer_load_dwordx4 v14, s[48:51], s22 offen offset:2048   lds
M v[212:215],a[140:143],a[164:167],0
buffer_load_dwordx4 v15, s[48:51], s22 offen offset:3072   lds
M v[212:215],a[136:139],a[160:163],v[212:215]
SA s22,s22,1048576
M v[216:219],a[144:147],a[160:163],0
M v[216:219],a[148:151],a[164:167],v[216:219]
s_waitcnt lgkmcnt(12)
M v[220:223],a[156:159],a[164:167],0
s_waitcnt vmcnt(12) lgkmcnt(0)
M v[220:223],a[152:155],a[160:163],v[220:223]
s_barrier
M v[224:227],a[96:99],a[168:171],0
SA m0,s23,32768
R a[160:163],v5,32768
R a[164:167],v6,32768
M v[224:227],a[100:103],a[172:175],v[224:227]
buffer_load_dwordx4 v8, s[16:19], s21 offen offset:0   lds
M v[228:231],a[108:111],a[172:175],0
M v[228:231],a[104:107],a[168:171],v[228:231]
M v[232:235],a[112:115],a[168:171],0
buffer_load_dwordx4 v9, s[16:19], s21 offen offset:1024   lds
M v[232:235],a[116:119],a[172:175],v[232:235]
M v[236:239],a[124:127],a[172:175],0
M v[236:239],a[120:123],a[168:171],v[236:239]
buffer_load_dwordx4 v10, s[16:19], s21 offen offset:2048   lds
M v[240:243],a[128:131],a[168:171],0
M v[240:243],a[132:135],a[172:175],v[240:243]
M v[244:247],a[140:143],a[172:175],0
buffer_load_dwordx4 v11, s[16:19], s21 offen offset:3072   lds
M v[244:247],a[136:139],a[168:171],v[244:247]
SA s21,s21,128
M v[248:251],a[144:147],a[168:171],0
M v[248:251],a[148:151],a[172:175],v[248:251]
s_waitcnt lgkmcnt(0)
M v[252:255],a[156:159],a[172:175],0
M v[252:255],a[152:155],a[168:171],v[252:255]
M a[0:3],a[32:35],a[160:163],a[0:3]
R a[168:171],v5,34816
R a[172:175],v6,34816
M a[0:3],a[36:39],a[164:167],a[0:3]
T a[96:97],v1,0
T a[98:99],v1,1024
M a[4:7],a[44:47],a[164:167],a[4:7]
SA m0,s24,16384
M a[4:7],a[40:43],a[160:163],a[4:7]
buffer_load_dwordx4 v12, s[48:51], s22 offen offset:0   lds
M a[8:11],a[48:51],a[160:163],a[8:11]
M a[8:11],a[52:55],a[164:167],a[8:11]
M a[12:15],a[60:63],a[164:167],a[12:15]
s_nop 0
T a[100:101],v1,8192
T a[102:103],v1,9216
M a[12:15],a[56:59],a[160:163],a[12:15]
M a[16:19],a[64:67],a[160:163],a[16:19]
buffer_load_dwordx4 v13, s[48:51], s22 offen offset:1024   lds
M a[16:19],a[68:71],a[164:167],a[16:19]
M a[20:23],a[76:79],a[164:167],a[20:23]
M a[20:23],a[72:75],a[160:163],a[20:23]
s_nop 0
T a[104:105],v2,0
T a[106:107],v2,1024
M a[24:27],a[80:83],a[160:163],a[24:27]
M a[24:27],a[84:87],a[164:167],a[24:27]
s_waitcnt lgkmcnt(6)
buffer_load_dwordx4 v14, s[48:51], s22 offen offset:2048   lds
M a[28:31],a[92:95],a[164:167],a[28:31]
M a[28:31],a[88:91],a[160:163],a[28:31]
M v[60:63],a[88:91],a[168:171],v[60:63]
R a[160:163],v5,36864
R a[164:167],v6,36864
M v[60:63],a[92:95],a[172:175],v[60:63]
T a[108:109],v2,8192
T a[110:111],v2,9216
M v[56:59],a[84:87],a[172:175],v[56:59]
buffer_load_dwordx4 v15, s[48:51], s22 offen offset:3072   lds
M v[56:59],a[80:83],a[168:171],v[56:59]
s_sub_u32 s22, s22, 1048448
M v[52:55],a[72:75],a[168:171],v[52:55]
M v[52:55],a[76:79],a[172:175],v[52:55]
s_nop 0
T a[112:113],v3,0
T a[114:115],v3,1024
M v[48:51],a[68:71],a[172:175],v[48:51]
SA m0,s23,49152
M v[48:51],a[64:67],a[168:171],v[48:51]
buffer_load_dwordx4 v8, s[16:19], s21 offen offset:0   lds
M v[44:47],a[56:59],a[168:171],v[44:47]
M v[44:47],a[60:63],a[172:175],v[44:47]
M v[40:43],a[52:55],a[172:175],v[40:43]
s_nop 0
T a[116:117],v3,8192
T a[118:119],v3,9216
M v[40:43],a[48:51],a[168:171],v[40:43]
M v[36:39],a[40:43],a[168:171],v[36:39]
buffer_load_dwordx4 v9, s[16:19], s21 offen offset:1024   lds
M v[36:39],a[44:47],a[172:175],v[36:39]
s_waitcnt lgkmcnt(6)
M v[32:35],a[36:39],a[172:175],v[32:35]
M v[32:35],a[32:35],a[168:171],v[32:35]
s_nop 0
T a[120:121],v4,0
T a[122:123],v4,1024
M v[64:67],a[32:35],a[160:163],v[64:67]
R a[168:171],v5,38912
R a[172:175],v6,38912
M v[64:67],a[36:39],a[164:167],v[64:67]
buffer_load_dwordx4 v10, s[16:19], s21 offen offset:2048   lds
M v[68:71],a[44:47],a[164:167],v[68:71]
M v[68:71],a[40:43],a[160:163],v[68:71]
M v[72:75],a[48:51],a[160:163],v[72:75]
s_nop 0
T a[124:125],v4,8192
T a[126:127],v4,9216
M v[72:75],a[52:55],a[164:167],v[72:75]
M v[76:79],a[60:63],a[164:167],v[76:79]
buffer_load_dwordx4 v11, s[16:19], s21 offen offset:3072   lds
M v[76:79],a[56:59],a[160:163],v[76:79]
SA s21,s21,524160
M v[80:83],a[64:67],a[160:163],v[80:83]
M v[80:83],a[68:71],a[164:167],v[80:83]
M v[84:87],a[76:79],a[164:167],v[84:87]
M v[84:87],a[72:75],a[160:163],v[84:87]
M v[88:91],a[80:83],a[160:163],v[88:91]
M v[88:91],a[84:87],a[164:167],v[88:91]
s_waitcnt lgkmcnt(2)
M v[92:95],a[92:95],a[164:167],v[92:95]
s_waitcnt vmcnt(16) lgkmcnt(0)
M v[92:95],a[88:91],a[160:163],v[92:95]
s_barrier
M v[124:127],a[88:91],a[168:171],v[124:127]
R a[160:163],v5,49152
R a[164:167],v6,49152
M v[124:127],a[92:95],a[172:175],v[124:127]
M v[120:123],a[84:87],a[172:175],v[120:123]
SA m0,s24,32768
T a[128:129],v1,16384
T a[130:131],v1,17408
M v[120:123],a[80:83],a[168:171],v[120:123]
buffer_load_dwordx4 v12, s[48:51], s22 offen offset:0   lds
M v[116:119],a[72:75],a[168:171],v[116:119]
M v[116:119],a[76:79],a[172:175],v[116:119]
M v[112:115],a[68:71],a[172:175],v[112:115]
M v[112:115],a[64:67],a[168:171],v[112:115]
M v[108:111],a[56:59],a[168:171],v[108:111]
M v[108:111],a[60:63],a[172:175],v[108:111]
s_nop 0
T a[132:133],v1,24576
T a[134:135],v1,25600
M v[104:107],a[52:55],a[172:175],v[104:107]
buffer_load_dwordx4 v13, s[48:51], s22 offen offset:1024   lds
M v[104:107],a[48:51],a[168:171],v[104:107]
M v[100:103],a[40:43],a[168:171],v[100:103]
M v[100:103],a[44:47],a[172:175],v[100:103]
s_waitcnt lgkmcnt(4)
M v[96:99],a[36:39],a[172:175],v[96:99]
M v[96:99],a[32:35],a[168:171],v[96:99]
M v[128:131],a[32:35],a[160:163],v[128:131]
R a[168:171],v5,51200
R a[172:175],v6,51200
M v[128:131],a[36:39],a[164:167],v[128:131]
T a[136:137],v2,16384
T a[138:139],v2,17408
M v[132:135],a[44:47],a[164:167],v[132:135]
buffer_load_dwordx4 v14, s[48:51], s22 offen offset:2048   lds
M v[132:135],a[40:43],a[160:163],v[132:135]
M v[136:139],a[48:51],a[160:163],v[136:139]
M v[136:139],a[52:55],a[164:167],v[136:139]
M v[140:143],a[60:63],a[164:167],v[140:143]
M v[140:143],a[56:59],a[160:163],v[140:143]
s_nop 0
T a[140:141],v2,24576
T a[142:143],v2,25600
M v[144:147],a[64:67],a[160:163],v[144:147]
buffer_load_dwordx4 v15, s[48:51], s22 offen offset:3072   lds
M v[144:147],a[68:71],a[164:167],v[144:147]
SA s22,s22,1048576
M v[148:151],a[76:79],a[164:167],v[148:151]
M v[148:151],a[72:75],a[160:163],v[148:151]
M v[152:155],a[80:83],a[160:163],v[152:155]
M v[152:155],a[84:87],a[164:167],v[152:155]
s_waitcnt lgkmcnt(4)
M v[156:159],a[92:95],a[164:167],v[156:159]
SA m0,s23,0
T a[144:145],v3,16384
T a[146:147],v3,17408
M v[156:159],a[88:91],a[160:163],v[156:159]
buffer_load_dwordx4 v8, s[16:19], s21 offen offset:0   lds
M v[188:191],a[88:91],a[168:171],v[188:191]
R a[160:163],v5,53248
R a[164:167],v6,53248
M v[188:191],a[92:95],a[172:175],v[188:191]
M v[184:187],a[84:87],a[172:175],v[184:187]
M v[184:187],a[80:83],a[168:171],v[184:187]
M v[180:183],a[72:75],a[168:171],v[180:183]
M v[180:183],a[76:79],a[172:175],v[180:183]
s_nop 0
T a[148:149],v3,24576
T a[150:151],v3,25600
M v[176:179],a[68:71],a[172:175],v[176:179]
buffer_load_dwordx4 v9, s[16:19], s21 offen offset:1024   lds
M v[176:179],a[64:67],a[168:171],v[176:179]
M v[172:175],a[56:59],a[168:171],v[172:175]
M v[172:175],a[60:63],a[172:175],v[172:175]
M v[168:171],a[52:55],a[172:175],v[168:171]
M v[168:171],a[48:51],a[168:171],v[168:171]
M v[164:167],a[40:43],a[168:171],v[164:167]
s_nop 0
T a[152:153],v4,16384
T a[154:155],v4,17408
M v[164:167],a[44:47],a[172:175],v[164:167]
s_waitcnt lgkmcnt(4)
buffer_load_dwordx4 v10, s[16:19], s21 offen offset:2048   lds
M v[160:163],a[36:39],a[172:175],v[160:163]
M v[160:163],a[32:35],a[168:171],v[160:163]
M v[192:195],a[32:35],a[160:163],v[192:195]
R a[168:171],v5,55296
R a[172:175],v6,55296
M v[192:195],a[36:39],a[164:167],v[192:195]
M v[196:199],a[44:47],a[164:167],v[196:199]
M v[196:199],a[40:43],a[160:163],v[196:199]
s_nop 0
T a[156:157],v4,24576
T a[158:159],v4,25600
M v[200:203],a[48:51],a[160:163],v[200:203]
buffer_load_dwordx4 v11, s[16:19], s21 offen offset:3072   lds
M v[200:203],a[52:55],a[164:167],v[200:203]
SA s21,s21,128
M v[204:207],a[60:63],a[164:167],v[204:207]
M v[204:207],a[56:59],a[160:163],v[204:207]
M v[208:211],a[64:67],a[160:163],v[208:211]
M v[208:211],a[68:71],a[164:167],v[208:211]
M v[212:215],a[76:79],a[164:167],v[212:215]
M v[212:215],a[72:75],a[160:163],v[212:215]
M v[216:219],a[80:83],a[160:163],v[216:219]
M v[216:219],a[84:87],a[164:167],v[216:219]
s_waitcnt lgkmcnt(2)
M v[220:223],a[92:95],a[164:167],v[220:223]
s_waitcnt vmcnt(16) lgkmcnt(0)
M v[220:223],a[88:91],a[160:163],v[220:223]
s_barrier
M v[252:255],a[88:91],a[168:171],v[252:255]
R a[160:163],v5,0
R a[164:167],v6,0
M v[252:255],a[92:95],a[172:175],v[252:255]
v_min_u32 v16, 1, v0
v_lshlrev_b32 v16, 29, v16
M v[248:251],a[84:87],a[172:175],v[248:251]
v_or_b32 v16, s39, v16
v_mov_b32 v17, 1
M v[248:251],a[80:83],a[168:171],v[248:251]
buffer_store_dword v17, v16, s[12:15], s38 offen sc1
M v[244:247],a[72:75],a[168:171],v[244:247]
M v[244:247],a[76:79],a[172:175],v[244:247]
M v[240:243],a[68:71],a[172:175],v[240:243]
M v[240:243],a[64:67],a[168:171],v[240:243]
M v[236:239],a[56:59],a[168:171],v[236:239]
M v[236:239],a[60:63],a[172:175],v[236:239]
M v[232:235],a[52:55],a[172:175],v[232:235]
M v[232:235],a[48:51],a[168:171],v[232:235]
M v[228:231],a[40:43],a[168:171],v[228:231]
M v[228:231],a[44:47],a[172:175],v[228:231]
s_waitcnt lgkmcnt(0)
M v[224:227],a[36:39],a[172:175],v[224:227]
M v[224:227],a[32:35],a[168:171],v[224:227]
M a[0:3],a[96:99],a[160:163],a[0:3]
L_w_kv01:
s_cbranch_execz L_w_kv05
R a[168:171],v5,2048
R a[172:175],v6,2048
M a[0:3],a[100:103],a[164:167],a[0:3]
T a[32:33],v1,32768
T a[34:35],v1,33792
M a[4:7],a[108:111],a[164:167],a[4:7]
SA m0,s24,49152
M a[4:7],a[104:107],a[160:163],a[4:7]
buffer_load_dwordx4 v12, s[48:51], s22 offen offset:0   lds
M a[8:11],a[112:115],a[160:163],a[8:11]
M a[8:11],a[116:119],a[164:167],a[8:11]
M a[12:15],a[124:127],a[164:167],a[12:15]
s_nop 0
T a[36:37],v1,40960
T a[38:39],v1,41984
M a[12:15],a[120:123],a[160:163],a[12:15]
M a[16:19],a[128:131],a[160:163],a[16:19]
buffer_load_dwordx4 v13, s[48:51], s22 offen offset:1024   lds
M a[16:19],a[132:135],a[164:167],a[16:19]
M a[20:23],a[140:143],a[164:167],a[20:23]
M a[20:23],a[136:139],a[160:163],a[20:23]
s_nop 0
T a[40:41],v2,32768
T a[42:43],v2,33792
M a[24:27],a[144:147],a[160:163],a[24:27]
M a[24:27],a[148:151],a[164:167],a[24:27]
s_waitcnt lgkmcnt(6)
buffer_load_dwordx4 v14, s[48:51], s22 offen offset:2048   lds
M a[28:31],a[156:159],a[164:167],a[28:31]
M a[28:31],a[152:155],a[160:163],a[28:31]
M v[60:63],a[152:155],a[168:171],v[60:63]
R a[160:163],v5,4096
R a[164:167],v6,4096
M v[60:63],a[156:159],a[172:175],v[60:63]
T a[44:45],v2,40960
T a[46:47],v2,41984
M v[56:59],a[148:151],a[172:175],v[56:59]
buffer_load_dwordx4 v15, s[48:51], s22 offen offset:3072   lds
M v[56:59],a[144:147],a[168:171],v[56:59]
s_sub_u32 s22, s22, 1048448
M v[52:55],a[136:139],a[168:171],v[52:55]
M v[52:55],a[140:143],a[172:175],v[52:55]
s_nop 0
T a[48:49],v3,32768
T a[50:51],v3,33792
M v[48:51],a[132:135],a[172:175],v[48:51]
SA m0,s23,16384
M v[48:51],a[128:131],a[168:171],v[48:51]
buffer_load_dwordx4 v8, s[16:19], s21 offen offset:0   lds
M v[44:47],a[120:123],a[168:171],v[44:47]
M v[44:47],a[124:127],a[172:175],v[44:47]
M v[40:43],a[116:119],a[172:175],v[40:43]
s_nop 0
T a[52:53],v3,40960
T a[54:55],v3,41984
M v[40:43],a[112:115],a[168:171],v[40:43]
M v[36:39],a[104:107],a[168:171],v[36:39]
buffer_load_dwordx4 v9, s[16:19], s21 offen offset:1024   lds
M v[36:39],a[108:111],a[172:175],v[36:39]
s_waitcnt lgkmcnt(6)
M v[32:35],a[100:103],a[172:175],v[32:35]
M v[32:35],a[96:99],a[168:171],v[32:35]
s_nop 0
T a[56:57],v4,32768
T a[58:59],v4,33792
M v[64:67],a[96:99],a[160:163],v[64:67]
R a[168:171],v5,6144
R a[172:175],v6,6144
M v[64:67],a[100:103],a[164:167],v[64:67]
buffer_load_dwordx4 v10, s[16:19], s21 offen offset:2048   lds
M v[68:71],a[108:111],a[164:167],v[68:71]
M v[68:71],a[104:107],a[160:163],v[68:71]
M v[72:75],a[112:115],a[160:163],v[72:75]
s_nop 0
T a[60:61],v4,40960
T a[62:63],v4,41984
M v[72:75],a[116:119],a[164:167],v[72:75]
M v[76:79],a[124:127],a[164:167],v[76:79]
buffer_load_dwordx4 v11, s[16:19], s21 offen offset:3072   lds
M v[76:79],a[120:123],a[160:163],v[76:79]
SA s21,s21,524160
M v[80:83],a[128:131],a[160:163],v[80:83]
M v[80:83],a[132:135],a[164:167],v[80:83]
M v[84:87],a[140:143],a[164:167],v[84:87]
M v[84:87],a[136:139],a[160:163],v[84:87]
s_and_b32 s86, s41, 7
M v[88:91],a[144:147],a[160:163],v[88:91]
s_mul_i32 s86, s86, 14
s_lshr_b32 s64, s41, 3
s_mul_i32 s64, s64, 7
M v[88:91],a[148:151],a[164:167],v[88:91]
s_waitcnt lgkmcnt(2)
SA s86,s86,s64
s_min_u32 s64, s31, 6
M v[92:95],a[156:159],a[164:167],v[92:95]
s_waitcnt vmcnt(17) lgkmcnt(0)
SA s86,s86,s64
s_sub_u32 s64, 6, s31
M v[92:95],a[152:155],a[160:163],v[92:95]
s_barrier
M v[124:127],a[152:155],a[168:171],v[124:127]
R a[160:163],v5,16384
R a[164:167],v6,16384
M v[124:127],a[156:159],a[172:175],v[124:127]
s_and_b32 s88, s64, 536870912
s_mul_i32 s87, s20, 7168
M v[120:123],a[148:151],a[172:175],v[120:123]
SA m0,s24,0
T a[64:65],v1,49152
T a[66:67],v1,50176
M v[120:123],a[144:147],a[168:171],v[120:123]
buffer_load_dwordx4 v12, s[48:51], s22 offen offset:0   lds
M v[116:119],a[136:139],a[168:171],v[116:119]
SA s87,s87,131072
M v[116:119],a[140:143],a[172:175],v[116:119]
s_cmp_lt_u32 s20, 2
M v[112:115],a[132:135],a[172:175],v[112:115]
s_cselect_b64 s[72:73], s[80:81], s[82:83]
M v[112:115],a[128:131],a[168:171],v[112:115]
s_mov_b32 s60, s72
M v[108:111],a[120:123],a[168:171],v[108:111]
s_and_b32 s61, s73, 0xffff
M v[108:111],a[124:127],a[172:175],v[108:111]
s_mov_b32 s62, 1605632
T a[68:69],v1,57344
T a[70:71],v1,58368
M v[104:107],a[116:119],a[172:175],v[104:107]
s_mov_b32 s63, 0x20000
buffer_load_dwordx4 v13, s[48:51], s22 offen offset:1024   lds
M v[104:107],a[112:115],a[168:171],v[104:107]
s_mov_b32 s68, s84
M v[100:103],a[104:107],a[168:171],v[100:103]
s_and_b32 s69, s85, 0xffff
s_mov_b32 s70, 1605632
s_mov_b32 s71, 0x20000
M v[100:103],a[108:111],a[172:175],v[100:103]
s_waitcnt lgkmcnt(4)
s_lshl_b32 s89, s86, 5
M v[96:99],a[100:103],a[172:175],v[96:99]
s_and_b32 s64, s20, 1
M v[96:99],a[96:99],a[168:171],v[96:99]
s_mul_i32 s64, s64, 802816
M v[128:131],a[96:99],a[160:163],v[128:131]
SA s89,s89,s64
R a[168:171],v5,18432
R a[172:175],v6,18432
M v[128:131],a[100:103],a[164:167],v[128:131]
T a[72:73],v2,49152
T a[74:75],v2,50176
M v[132:135],a[108:111],a[164:167],v[132:135]
buffer_load_dwordx4 v14, s[48:51], s22 offen offset:2048   lds
M v[132:135],a[104:107],a[160:163],v[132:135]
v_lshrrev_b32 v28, 1, v0
v_mul_u32_u24 v28, 3584, v28
M v[136:139],a[112:115],a[160:163],v[136:139]
v_and_b32 v29, 1, v0
v_lshl_add_u32 v25, v29, 4, v28
M v[136:139],a[116:119],a[164:167],v[136:139]
v_or_b32 v25, s88, v25
M v[140:143],a[124:127],a[164:167],v[140:143]
M v[140:143],a[120:123],a[160:163],v[140:143]
s_nop 0
T a[76:77],v2,57344
T a[78:79],v2,58368
M v[144:147],a[128:131],a[160:163],v[144:147]
buffer_load_dwordx4 v15, s[48:51], s22 offen offset:3072   lds
M v[144:147],a[132:135],a[164:167],v[144:147]
SA s22,s22,1048576
M v[148:151],a[140:143],a[164:167],v[148:151]
M v[148:151],a[136:139],a[160:163],v[148:151]
M v[152:155],a[144:147],a[160:163],v[152:155]
M v[152:155],a[148:151],a[164:167],v[152:155]
s_waitcnt lgkmcnt(4)
M v[156:159],a[156:159],a[164:167],v[156:159]
SA m0,s23,32768
T a[80:81],v3,49152
T a[82:83],v3,50176
M v[156:159],a[152:155],a[160:163],v[156:159]
buffer_load_dwordx4 v8, s[16:19], s21 offen offset:0   lds
M v[188:191],a[152:155],a[168:171],v[188:191]
R a[160:163],v5,20480
R a[164:167],v6,20480
M v[188:191],a[156:159],a[172:175],v[188:191]
M v[184:187],a[148:151],a[172:175],v[184:187]
M v[184:187],a[144:147],a[168:171],v[184:187]
M v[180:183],a[136:139],a[168:171],v[180:183]
M v[180:183],a[140:143],a[172:175],v[180:183]
s_nop 0
T a[84:85],v3,57344
T a[86:87],v3,58368
M v[176:179],a[132:135],a[172:175],v[176:179]
buffer_load_dwordx4 v9, s[16:19], s21 offen offset:1024   lds
M v[176:179],a[128:131],a[168:171],v[176:179]
M v[172:175],a[120:123],a[168:171],v[172:175]
M v[172:175],a[124:127],a[172:175],v[172:175]
M v[168:171],a[116:119],a[172:175],v[168:171]
M v[168:171],a[112:115],a[168:171],v[168:171]
M v[164:167],a[104:107],a[168:171],v[164:167]
s_nop 0
T a[88:89],v4,49152
T a[90:91],v4,50176
M v[164:167],a[108:111],a[172:175],v[164:167]
s_waitcnt lgkmcnt(4)
buffer_load_dwordx4 v10, s[16:19], s21 offen offset:2048   lds
M v[160:163],a[100:103],a[172:175],v[160:163]
M v[160:163],a[96:99],a[168:171],v[160:163]
M v[192:195],a[96:99],a[160:163],v[192:195]
R a[168:171],v5,22528
R a[172:175],v6,22528
M v[192:195],a[100:103],a[164:167],v[192:195]
M v[196:199],a[108:111],a[164:167],v[196:199]
M v[196:199],a[104:107],a[160:163],v[196:199]
s_nop 0
T a[92:93],v4,57344
T a[94:95],v4,58368
M v[200:203],a[112:115],a[160:163],v[200:203]
buffer_load_dwordx4 v11, s[16:19], s21 offen offset:3072   lds
M v[200:203],a[116:119],a[164:167],v[200:203]
SA s21,s21,128
M v[204:207],a[124:127],a[164:167],v[204:207]
M v[204:207],a[120:123],a[160:163],v[204:207]
M v[208:211],a[128:131],a[160:163],v[208:211]
M v[208:211],a[132:135],a[164:167],v[208:211]
M v[212:215],a[140:143],a[164:167],v[212:215]
M v[212:215],a[136:139],a[160:163],v[212:215]
M v[216:219],a[144:147],a[160:163],v[216:219]
M v[216:219],a[148:151],a[164:167],v[216:219]
s_waitcnt lgkmcnt(2)
M v[220:223],a[156:159],a[164:167],v[220:223]
s_waitcnt vmcnt(17) lgkmcnt(0)
M v[220:223],a[152:155],a[160:163],v[220:223]
s_barrier
M v[252:255],a[152:155],a[168:171],v[252:255]
R a[160:163],v5,32768
R a[164:167],v6,32768
M v[252:255],a[156:159],a[172:175],v[252:255]
M v[248:251],a[148:151],a[172:175],v[248:251]
M v[248:251],a[144:147],a[168:171],v[248:251]
M v[244:247],a[136:139],a[168:171],v[244:247]
M v[244:247],a[140:143],a[172:175],v[244:247]
M v[240:243],a[132:135],a[172:175],v[240:243]
M v[240:243],a[128:131],a[168:171],v[240:243]
M v[236:239],a[120:123],a[168:171],v[236:239]
M v[236:239],a[124:127],a[172:175],v[236:239]
M v[232:235],a[116:119],a[172:175],v[232:235]
M v[232:235],a[112:115],a[168:171],v[232:235]
M v[228:231],a[104:107],a[168:171],v[228:231]
M v[228:231],a[108:111],a[172:175],v[228:231]
s_waitcnt lgkmcnt(0)
M v[224:227],a[100:103],a[172:175],v[224:227]
M v[224:227],a[96:99],a[168:171],v[224:227]
M a[0:3],a[32:35],a[160:163],a[0:3]
R a[168:171],v5,34816
R a[172:175],v6,34816
M a[0:3],a[36:39],a[164:167],a[0:3]
T a[96:97],v1,0
T a[98:99],v1,1024
M a[4:7],a[44:47],a[164:167],a[4:7]
SA m0,s24,16384
M a[4:7],a[40:43],a[160:163],a[4:7]
buffer_load_dwordx4 v12, s[48:51], s22 offen offset:0   lds
M a[8:11],a[48:51],a[160:163],a[8:11]
M a[8:11],a[52:55],a[164:167],a[8:11]
M a[12:15],a[60:63],a[164:167],a[12:15]
s_nop 0
T a[100:101],v1,8192
T a[102:103],v1,9216
M a[12:15],a[56:59],a[160:163],a[12:15]
buffer_load_dwordx4 v13, s[48:51], s22 offen offset:1024   lds
M a[16:19],a[64:67],a[160:163],a[16:19]
M a[16:19],a[68:71],a[164:167],a[16:19]
M a[20:23],a[76:79],a[164:167],a[20:23]
M a[20:23],a[72:75],a[160:163],a[20:23]
s_nop 0
T a[104:105],v2,0
T a[106:107],v2,1024
M a[24:27],a[80:83],a[160:163],a[24:27]
buffer_load_dwordx4 v14, s[48:51], s22 offen offset:2048   lds
M a[24:27],a[84:87],a[164:167],a[24:27]
s_waitcnt lgkmcnt(6)
M a[28:31],a[92:95],a[164:167],a[28:31]
M a[28:31],a[88:91],a[160:163],a[28:31]
M v[60:63],a[88:91],a[168:171],v[60:63]
R a[160:163],v5,36864
R a[164:167],v6,36864
M v[60:63],a[92:95],a[172:175],v[60:63]
T a[108:109],v2,8192
T a[110:111],v2,9216
M v[56:59],a[84:87],a[172:175],v[56:59]
buffer_load_dwordx4 v15, s[48:51], s22 offen offset:3072   lds
M v[56:59],a[80:83],a[168:171],v[56:59]
s_sub_u32 s22, s22, 1048448
M v[52:55],a[72:75],a[168:171],v[52:55]
SA m0,s23,49152
M v[52:55],a[76:79],a[172:175],v[52:55]
s_nop 0
T a[112:113],v3,0
T a[114:115],v3,1024
M v[48:51],a[68:71],a[172:175],v[48:51]
buffer_load_dwordx4 v8, s[16:19], s21 offen offset:0   lds
M v[48:51],a[64:67],a[168:171],v[48:51]
M v[44:47],a[56:59],a[168:171],v[44:47]
M v[44:47],a[60:63],a[172:175],v[44:47]
buffer_load_dwordx4 v9, s[16:19], s21 offen offset:1024   lds
M v[40:43],a[52:55],a[172:175],v[40:43]
s_nop 0
T a[116:117],v3,8192
T a[118:119],v3,9216
M v[40:43],a[48:51],a[168:171],v[40:43]
M v[36:39],a[40:43],a[168:171],v[36:39]
M v[36:39],a[44:47],a[172:175],v[36:39]
s_waitcnt lgkmcnt(6)
M v[32:35],a[36:39],a[172:175],v[32:35]
buffer_load_dwordx4 v10, s[16:19], s21 offen offset:2048   lds
M v[32:35],a[32:35],a[168:171],v[32:35]
s_nop 0
T a[120:121],v4,0
T a[122:123],v4,1024
M v[64:67],a[32:35],a[160:163],v[64:67]
R a[168:171],v5,38912
R a[172:175],v6,38912
M v[64:67],a[36:39],a[164:167],v[64:67]
M v[68:71],a[44:47],a[164:167],v[68:71]
buffer_load_dwordx4 v11, s[16:19], s21 offen offset:3072   lds
M v[68:71],a[40:43],a[160:163],v[68:71]
SA s21,s21,524160
M v[72:75],a[48:51],a[160:163],v[72:75]
s_nop 0
T a[124:125],v4,8192
T a[126:127],v4,9216
M v[72:75],a[52:55],a[164:167],v[72:75]
M v[76:79],a[60:63],a[164:167],v[76:79]
SA m0,s87,0
M v[76:79],a[56:59],a[160:163],v[76:79]
buffer_load_dwordx4 v25, s[60:63], s89 offen offset:0  lds
M v[80:83],a[64:67],a[160:163],v[80:83]
SA s89,s89,114688
M v[80:83],a[68:71],a[164:167],v[80:83]
M v[84:87],a[76:79],a[164:167],v[84:87]
M v[84:87],a[72:75],a[160:163],v[84:87]
M v[88:91],a[80:83],a[160:163],v[88:91]
M v[88:91],a[84:87],a[164:167],v[88:91]
s_waitcnt lgkmcnt(2)
M v[92:95],a[92:95],a[164:167],v[92:95]
s_waitcnt vmcnt(17) lgkmcnt(0)
M v[92:95],a[88:91],a[160:163],v[92:95]
s_barrier
M v[124:127],a[88:91],a[168:171],v[124:127]
R a[160:163],v5,49152
R a[164:167],v6,49152
M v[124:127],a[92:95],a[172:175],v[124:127]
M v[120:123],a[84:87],a[172:175],v[120:123]
SA m0,s24,32768
T a[128:129],v1,16384
T a[130:131],v1,17408
M v[120:123],a[80:83],a[168:171],v[120:123]
buffer_load_dwordx4 v12, s[48:51], s22 offen offset:0   lds
M v[116:119],a[72:75],a[168:171],v[116:119]
v_min_u32 v16, 40, v0
v_lshlrev_b32 v16, 2, v16
M v[116:119],a[76:79],a[172:175],v[116:119]
buffer_load_dword v17, v16, s[12:15], 0 offen sc1
M v[112:115],a[68:71],a[172:175],v[112:115]
M v[112:115],a[64:67],a[168:171],v[112:115]
M v[108:111],a[56:59],a[168:171],v[108:111]
M v[108:111],a[60:63],a[172:175],v[108:111]
s_nop 0
T a[132:133],v1,24576
T a[134:135],v1,25600
M v[104:107],a[52:55],a[172:175],v[104:107]
buffer_load_dwordx4 v13, s[48:51], s22 offen offset:1024   lds
M v[104:107],a[48:51],a[168:171],v[104:107]
M v[100:103],a[40:43],a[168:171],v[100:103]
M v[100:103],a[44:47],a[172:175],v[100:103]
s_waitcnt lgkmcnt(4)
M v[96:99],a[36:39],a[172:175],v[96:99]
M v[96:99],a[32:35],a[168:171],v[96:99]
M v[128:131],a[32:35],a[160:163],v[128:131]
R a[168:171],v5,51200
R a[172:175],v6,51200
M v[128:131],a[36:39],a[164:167],v[128:131]
T a[136:137],v2,16384
T a[138:139],v2,17408
M v[132:135],a[44:47],a[164:167],v[132:135]
buffer_load_dwordx4 v14, s[48:51], s22 offen offset:2048   lds
M v[132:135],a[40:43],a[160:163],v[132:135]
M v[136:139],a[48:51],a[160:163],v[136:139]
M v[136:139],a[52:55],a[164:167],v[136:139]
M v[140:143],a[60:63],a[164:167],v[140:143]
M v[140:143],a[56:59],a[160:163],v[140:143]
s_nop 0
T a[140:141],v2,24576
T a[142:143],v2,25600
M v[144:147],a[64:67],a[160:163],v[144:147]
buffer_load_dwordx4 v15, s[48:51], s22 offen offset:3072   lds
M v[144:147],a[68:71],a[164:167],v[144:147]
SA s22,s22,1048576
M v[148:151],a[76:79],a[164:167],v[148:151]
M v[148:151],a[72:75],a[160:163],v[148:151]
M v[152:155],a[80:83],a[160:163],v[152:155]
M v[152:155],a[84:87],a[164:167],v[152:155]
s_waitcnt lgkmcnt(4)
M v[156:159],a[92:95],a[164:167],v[156:159]
SA m0,s23,0
T a[144:145],v3,16384
T a[146:147],v3,17408
M v[156:159],a[88:91],a[160:163],v[156:159]
buffer_load_dwordx4 v8, s[16:19], s21 offen offset:0   lds
M v[188:191],a[88:91],a[168:171],v[188:191]
R a[160:163],v5,53248
R a[164:167],v6,53248
M v[188:191],a[92:95],a[172:175],v[188:191]
M v[184:187],a[84:87],a[172:175],v[184:187]
M v[184:187],a[80:83],a[168:171],v[184:187]
M v[180:183],a[72:75],a[168:171],v[180:183]
M v[180:183],a[76:79],a[172:175],v[180:183]
s_nop 0
T a[148:149],v3,24576
T a[150:151],v3,25600
M v[176:179],a[68:71],a[172:175],v[176:179]
buffer_load_dwordx4 v9, s[16:19], s21 offen offset:1024   lds
M v[176:179],a[64:67],a[168:171],v[176:179]
M v[172:175],a[56:59],a[168:171],v[172:175]
M v[172:175],a[60:63],a[172:175],v[172:175]
M v[168:171],a[52:55],a[172:175],v[168:171]
M v[168:171],a[48:51],a[168:171],v[168:171]
M v[164:167],a[40:43],a[168:171],v[164:167]
s_nop 0
T a[152:153],v4,16384
T a[154:155],v4,17408
M v[164:167],a[44:47],a[172:175],v[164:167]
s_waitcnt lgkmcnt(4)
buffer_load_dwordx4 v10, s[16:19], s21 offen offset:2048   lds
M v[160:163],a[36:39],a[172:175],v[160:163]
M v[160:163],a[32:35],a[168:171],v[160:163]
M v[192:195],a[32:35],a[160:163],v[192:195]
R a[168:171],v5,55296
R a[172:175],v6,55296
M v[192:195],a[36:39],a[164:167],v[192:195]
M v[196:199],a[44:47],a[164:167],v[196:199]
M v[196:199],a[40:43],a[160:163],v[196:199]
s_nop 0
T a[156:157],v4,24576
T a[158:159],v4,25600
M v[200:203],a[48:51],a[160:163],v[200:203]
buffer_load_dwordx4 v11, s[16:19], s21 offen offset:3072   lds
M v[200:203],a[52:55],a[164:167],v[200:203]
SA s21,s21,128
M v[204:207],a[60:63],a[164:167],v[204:207]
M v[204:207],a[56:59],a[160:163],v[204:207]
M v[208:211],a[64:67],a[160:163],v[208:211]
M v[208:211],a[68:71],a[164:167],v[208:211]
M v[212:215],a[76:79],a[164:167],v[212:215]
M v[212:215],a[72:75],a[160:163],v[212:215]
M v[216:219],a[80:83],a[160:163],v[216:219]
M v[216:219],a[84:87],a[164:167],v[216:219]
s_waitcnt lgkmcnt(2)
M v[220:223],a[92:95],a[164:167],v[220:223]
s_waitcnt vmcnt(18) lgkmcnt(0)
M v[220:223],a[88:91],a[160:163],v[220:223]
s_barrier
M v[252:255],a[88:91],a[168:171],v[252:255]
R a[160:163],v5,0
R a[164:167],v6,0
M v[252:255],a[92:95],a[172:175],v[252:255]
M v[248:251],a[84:87],a[172:175],v[248:251]
M v[248:251],a[80:83],a[168:171],v[248:251]
M v[244:247],a[72:75],a[168:171],v[244:247]
M v[244:247],a[76:79],a[172:175],v[244:247]
M v[240:243],a[68:71],a[172:175],v[240:243]
M v[240:243],a[64:67],a[168:171],v[240:243]
M v[236:239],a[56:59],a[168:171],v[236:239]
M v[236:239],a[60:63],a[172:175],v[236:239]
M v[232:235],a[52:55],a[172:175],v[232:235]
M v[232:235],a[48:51],a[168:171],v[232:235]
M v[228:231],a[40:43],a[168:171],v[228:231]
M v[228:231],a[44:47],a[172:175],v[228:231]
s_waitcnt lgkmcnt(0)
M v[224:227],a[36:39],a[172:175],v[224:227]
M v[224:227],a[32:35],a[168:171],v[224:227]
M a[0:3],a[96:99],a[160:163],a[0:3]
R a[168:171],v5,2048
R a[172:175],v6,2048
M a[0:3],a[100:103],a[164:167],a[0:3]
T a[32:33],v1,32768
T a[34:35],v1,33792
M a[4:7],a[108:111],a[164:167],a[4:7]
SA m0,s24,49152
M a[4:7],a[104:107],a[160:163],a[4:7]
buffer_load_dwordx4 v12, s[48:51], s22 offen offset:0   lds
M a[8:11],a[112:115],a[160:163],a[8:11]
M a[8:11],a[116:119],a[164:167],a[8:11]
M a[12:15],a[124:127],a[164:167],a[12:15]
s_nop 0
T a[36:37],v1,40960
T a[38:39],v1,41984
M a[12:15],a[120:123],a[160:163],a[12:15]
buffer_load_dwordx4 v13, s[48:51], s22 offen offset:1024   lds
M a[16:19],a[128:131],a[160:163],a[16:19]
M a[16:19],a[132:135],a[164:167],a[16:19]
M a[20:23],a[140:143],a[164:167],a[20:23]
M a[20:23],a[136:139],a[160:163],a[20:23]
s_nop 0
T a[40:41],v2,32768
T a[42:43],v2,33792
M a[24:27],a[144:147],a[160:163],a[24:27]
buffer_load_dwordx4 v14, s[48:51], s22 offen offset:2048   lds
M a[24:27],a[148:151],a[164:167],a[24:27]
s_waitcnt lgkmcnt(6)
M a[28:31],a[156:159],a[164:167],a[28:31]
M a[28:31],a[152:155],a[160:163],a[28:31]
M v[60:63],a[152:155],a[168:171],v[60:63]
R a[160:163],v5,4096
R a[164:167],v6,4096
M v[60:63],a[156:159],a[172:175],v[60:63]
T a[44:45],v2,40960
T a[46:47],v2,41984
M v[56:59],a[148:151],a[172:175],v[56:59]
buffer_load_dwordx4 v15, s[48:51], s22 offen offset:3072   lds
M v[56:59],a[144:147],a[168:171],v[56:59]
s_sub_u32 s22, s22, 1048448
M v[52:55],a[136:139],a[168:171],v[52:55]
SA m0,s23,16384
M v[52:55],a[140:143],a[172:175],v[52:55]
s_nop 0
T a[48:49],v3,32768
T a[50:51],v3,33792
M v[48:51],a[132:135],a[172:175],v[48:51]
buffer_load_dwordx4 v8, s[16:19], s21 offen offset:0   lds
M v[48:51],a[128:131],a[168:171],v[48:51]
M v[44:47],a[120:123],a[168:171],v[44:47]
M v[44:47],a[124:127],a[172:175],v[44:47]
buffer_load_dwordx4 v9, s[16:19], s21 offen offset:1024   lds
M v[40:43],a[116:119],a[172:175],v[40:43]
s_nop 0
T a[52:53],v3,40960
T a[54:55],v3,41984
M v[40:43],a[112:115],a[168:171],v[40:43]
M v[36:39],a[104:107],a[168:171],v[36:39]
M v[36:39],a[108:111],a[172:175],v[36:39]
s_waitcnt lgkmcnt(6)
M v[32:35],a[100:103],a[172:175],v[32:35]
buffer_load_dwordx4 v10, s[16:19], s21 offen offset:2048   lds
M v[32:35],a[96:99],a[168:171],v[32:35]
s_nop 0
T a[56:57],v4,32768
T a[58:59],v4,33792
M v[64:67],a[96:99],a[160:163],v[64:67]
R a[168:171],v5,6144
L_w_kv02:
s_cbranch_execz L_w_kv06
R a[172:175],v6,6144
M v[64:67],a[100:103],a[164:167],v[64:67]
M v[68:71],a[108:111],a[164:167],v[68:71]
buffer_load_dwordx4 v11, s[16:19], s21 offen offset:3072   lds
M v[68:71],a[104:107],a[160:163],v[68:71]
SA s21,s21,524160
M v[72:75],a[112:115],a[160:163],v[72:75]
s_nop 0
T a[60:61],v4,40960
T a[62:63],v4,41984
M v[72:75],a[116:119],a[164:167],v[72:75]
M v[76:79],a[124:127],a[164:167],v[76:79]
SA m0,s87,1024
M v[76:79],a[120:123],a[160:163],v[76:79]
buffer_load_dwordx4 v25, s[60:63], s89 offen offset:0  lds
M v[80:83],a[128:131],a[160:163],v[80:83]
SA s89,s89,114688
M v[80:83],a[132:135],a[164:167],v[80:83]
M v[84:87],a[140:143],a[164:167],v[84:87]
M v[84:87],a[136:139],a[160:163],v[84:87]
M v[88:91],a[144:147],a[160:163],v[88:91]
M v[88:91],a[148:151],a[164:167],v[88:91]
s_waitcnt lgkmcnt(2)
M v[92:95],a[156:159],a[164:167],v[92:95]
s_waitcnt vmcnt(19) lgkmcnt(0)
M v[92:95],a[152:155],a[160:163],v[92:95]
s_barrier
M v[124:127],a[152:155],a[168:171],v[124:127]
R a[160:163],v5,16384
R a[164:167],v6,16384
M v[124:127],a[156:159],a[172:175],v[124:127]
M v[120:123],a[148:151],a[172:175],v[120:123]
SA m0,s24,0
T a[64:65],v1,49152
T a[66:67],v1,50176
M v[120:123],a[144:147],a[168:171],v[120:123]
buffer_load_dwordx4 v12, s[48:51], s22 offen offset:0   lds
M v[116:119],a[136:139],a[168:171],v[116:119]
M v[116:119],a[140:143],a[172:175],v[116:119]
M v[112:115],a[132:135],a[172:175],v[112:115]
M v[112:115],a[128:131],a[168:171],v[112:115]
M v[108:111],a[120:123],a[168:171],v[108:111]
M v[108:111],a[124:127],a[172:175],v[108:111]
s_nop 0
T a[68:69],v1,57344
T a[70:71],v1,58368
M v[104:107],a[116:119],a[172:175],v[104:107]
buffer_load_dwordx4 v13, s[48:51], s22 offen offset:1024   lds
M v[104:107],a[112:115],a[168:171],v[104:107]
M v[100:103],a[104:107],a[168:171],v[100:103]
M v[100:103],a[108:111],a[172:175],v[100:103]
s_waitcnt lgkmcnt(4)
M v[96:99],a[100:103],a[172:175],v[96:99]
M v[96:99],a[96:99],a[168:171],v[96:99]
M v[128:131],a[96:99],a[160:163],v[128:131]
R a[168:171],v5,18432
R a[172:175],v6,18432
M v[128:131],a[100:103],a[164:167],v[128:131]
T a[72:73],v2,49152
T a[74:75],v2,50176
M v[132:135],a[108:111],a[164:167],v[132:135]
buffer_load_dwordx4 v14, s[48:51], s22 offen offset:2048   lds
M v[132:135],a[104:107],a[160:163],v[132:135]
M v[136:139],a[112:115],a[160:163],v[136:139]
M v[136:139],a[116:119],a[164:167],v[136:139]
M v[140:143],a[124:127],a[164:167],v[140:143]
M v[140:143],a[120:123],a[160:163],v[140:143]
s_nop 0
T a[76:77],v2,57344
T a[78:79],v2,58368
M v[144:147],a[128:131],a[160:163],v[144:147]
buffer_load_dwordx4 v15, s[48:51], s22 offen offset:3072   lds
M v[144:147],a[132:135],a[164:167],v[144:147]
SA s22,s22,1048576
M v[148:151],a[140:143],a[164:167],v[148:151]
M v[148:151],a[136:139],a[160:163],v[148:151]
M v[152:155],a[144:147],a[160:163],v[152:155]
M v[152:155],a[148:151],a[164:167],v[152:155]
s_waitcnt lgkmcnt(4)
M v[156:159],a[156:159],a[164:167],v[156:159]
SA m0,s23,32768
T a[80:81],v3,49152
T a[82:83],v3,50176
M v[156:159],a[152:155],a[160:163],v[156:159]
buffer_load_dwordx4 v8, s[16:19], s21 offen offset:0   lds
M v[188:191],a[152:155],a[168:171],v[188:191]
R a[160:163],v5,20480
R a[164:167],v6,20480
M v[188:191],a[156:159],a[172:175],v[188:191]
M v[184:187],a[148:151],a[172:175],v[184:187]
M v[184:187],a[144:147],a[168:171],v[184:187]
M v[180:183],a[136:139],a[168:171],v[180:183]
M v[180:183],a[140:143],a[172:175],v[180:183]
s_nop 0
T a[84:85],v3,57344
T a[86:87],v3,58368
M v[176:179],a[132:135],a[172:175],v[176:179]
buffer_load_dwordx4 v9, s[16:19], s21 offen offset:1024   lds
M v[176:179],a[128:131],a[168:171],v[176:179]
M v[172:175],a[120:123],a[168:171],v[172:175]
M v[172:175],a[124:127],a[172:175],v[172:175]
M v[168:171],a[116:119],a[172:175],v[168:171]
M v[168:171],a[112:115],a[168:171],v[168:171]
M v[164:167],a[104:107],a[168:171],v[164:167]
s_nop 0
T a[88:89],v4,49152
T a[90:91],v4,50176
M v[164:167],a[108:111],a[172:175],v[164:167]
s_waitcnt lgkmcnt(4)
buffer_load_dwordx4 v10, s[16:19], s21 offen offset:2048   lds
M v[160:163],a[100:103],a[172:175],v[160:163]
M v[160:163],a[96:99],a[168:171],v[160:163]
M v[192:195],a[96:99],a[160:163],v[192:195]
R a[168:171],v5,22528
R a[172:175],v6,22528
M v[192:195],a[100:103],a[164:167],v[192:195]
M v[196:199],a[108:111],a[164:167],v[196:199]
M v[196:199],a[104:107],a[160:163],v[196:199]
s_nop 0
T a[92:93],v4,57344
T a[94:95],v4,58368
M v[200:203],a[112:115],a[160:163],v[200:203]
buffer_load_dwordx4 v11, s[16:19], s21 offen offset:3072   lds
M v[200:203],a[116:119],a[164:167],v[200:203]
SA s21,s21,128
M v[204:207],a[124:127],a[164:167],v[204:207]
M v[204:207],a[120:123],a[160:163],v[204:207]
M v[208:211],a[128:131],a[160:163],v[208:211]
M v[208:211],a[132:135],a[164:167],v[208:211]
M v[212:215],a[140:143],a[164:167],v[212:215]
M v[212:215],a[136:139],a[160:163],v[212:215]
M v[216:219],a[144:147],a[160:163],v[216:219]
M v[216:219],a[148:151],a[164:167],v[216:219]
s_waitcnt lgkmcnt(2)
M v[220:223],a[156:159],a[164:167],v[220:223]
s_waitcnt vmcnt(17) lgkmcnt(0)
M v[220:223],a[152:155],a[160:163],v[220:223]
s_barrier
M v[252:255],a[152:155],a[168:171],v[252:255]
R a[160:163],v5,32768
R a[164:167],v6,32768
M v[252:255],a[156:159],a[172:175],v[252:255]
v_cmp_ne_u32 vcc, 1, v17
M v[248:251],a[148:151],a[172:175],v[248:251]
s_nop 0
M v[248:251],a[144:147],a[168:171],v[248:251]
s_cbranch_vccnz L_zs0
L_zr0:
M v[244:247],a[136:139],a[168:171],v[244:247]
M v[244:247],a[140:143],a[172:175],v[244:247]
M v[240:243],a[132:135],a[172:175],v[240:243]
M v[240:243],a[128:131],a[168:171],v[240:243]
M v[236:239],a[120:123],a[168:171],v[236:239]
M v[236:239],a[124:127],a[172:175],v[236:239]
M v[232:235],a[116:119],a[172:175],v[232:235]
M v[232:235],a[112:115],a[168:171],v[232:235]
M v[228:231],a[104:107],a[168:171],v[228:231]
M v[228:231],a[108:111],a[172:175],v[228:231]
s_waitcnt lgkmcnt(0)
M v[224:227],a[100:103],a[172:175],v[224:227]
M v[224:227],a[96:99],a[168:171],v[224:227]
M a[0:3],a[32:35],a[160:163],a[0:3]
R a[168:171],v5,34816
R a[172:175],v6,34816
M a[0:3],a[36:39],a[164:167],a[0:3]
T a[96:97],v1,0
T a[98:99],v1,1024
M a[4:7],a[44:47],a[164:167],a[4:7]
SA m0,s24,16384
M a[4:7],a[40:43],a[160:163],a[4:7]
buffer_load_dwordx4 v12, s[48:51], s22 offen offset:0   lds
M a[8:11],a[48:51],a[160:163],a[8:11]
M a[8:11],a[52:55],a[164:167],a[8:11]
s_mul_i32 s64, s41, 229376
M a[12:15],a[60:63],a[164:167],a[12:15]
SA s72,s90,s64
T a[100:101],v1,8192
T a[102:103],v1,9216
M a[12:15],a[56:59],a[160:163],a[12:15]
s_addc_u32 s73, s91, 0
buffer_load_dwordx4 v13, s[48:51], s22 offen offset:1024   lds
M a[16:19],a[64:67],a[160:163],a[16:19]
s_sub_u32 s75, 3670016, s64
M a[16:19],a[68:71],a[164:167],a[16:19]
s_mov_b32 s12, s72
M a[20:23],a[76:79],a[164:167],a[20:23]
s_and_b32 s13, s73, 0xffff
M a[20:23],a[72:75],a[160:163],a[20:23]
s_mov_b32 s14, s75
T a[104:105],v2,0
T a[106:107],v2,1024
M a[24:27],a[80:83],a[160:163],a[24:27]
s_mov_b32 s15, 0x20000
buffer_load_dwordx4 v14, s[48:51], s22 offen offset:2048   lds
M a[24:27],a[84:87],a[164:167],a[24:27]
s_waitcnt lgkmcnt(6)
M a[28:31],a[92:95],a[164:167],a[28:31]
M a[28:31],a[88:91],a[160:163],a[28:31]
M v[60:63],a[88:91],a[168:171],v[60:63]
R a[160:163],v5,36864
R a[164:167],v6,36864
M v[60:63],a[92:95],a[172:175],v[60:63]
T a[108:109],v2,8192
T a[110:111],v2,9216
M v[56:59],a[84:87],a[172:175],v[56:59]
buffer_load_dwordx4 v15, s[48:51], s22 offen offset:3072   lds
M v[56:59],a[80:83],a[168:171],v[56:59]
s_sub_u32 s22, s22, 1048448
M v[52:55],a[72:75],a[168:171],v[52:55]
SA m0,s23,49152
M v[52:55],a[76:79],a[172:175],v[52:55]
s_nop 0
T a[112:113],v3,0
T a[114:115],v3,1024
M v[48:51],a[68:71],a[172:175],v[48:51]
buffer_load_dwordx4 v8, s[16:19], s21 offen offset:0   lds
M v[48:51],a[64:67],a[168:171],v[48:51]
M v[44:47],a[56:59],a[168:171],v[44:47]
M v[44:47],a[60:63],a[172:175],v[44:47]
buffer_load_dwordx4 v9, s[16:19], s21 offen offset:1024   lds
M v[40:43],a[52:55],a[172:175],v[40:43]
s_nop 0
T a[116:117],v3,8192
T a[118:119],v3,9216
M v[40:43],a[48:51],a[168:171],v[40:43]
M v[36:39],a[40:43],a[168:171],v[36:39]
M v[36:39],a[44:47],a[172:175],v[36:39]
s_waitcnt lgkmcnt(6)
M v[32:35],a[36:39],a[172:175],v[32:35]
buffer_load_dwordx4 v10, s[16:19], s21 offen offset:2048   lds
M v[32:35],a[32:35],a[168:171],v[32:35]
s_nop 0
T a[120:121],v4,0
T a[122:123],v4,1024
M v[64:67],a[32:35],a[160:163],v[64:67]
R a[168:171],v5,38912
R a[172:175],v6,38912
M v[64:67],a[36:39],a[164:167],v[64:67]
M v[68:71],a[44:47],a[164:167],v[68:71]
buffer_load_dwordx4 v11, s[16:19], s21 offen offset:3072   lds
M v[68:71],a[40:43],a[160:163],v[68:71]
SA s21,s21,524160
M v[72:75],a[48:51],a[160:163],v[72:75]
s_nop 0
T a[124:125],v4,8192
T a[126:127],v4,9216
M v[72:75],a[52:55],a[164:167],v[72:75]
M v[76:79],a[60:63],a[164:167],v[76:79]
SA m0,s87,2048
M v[76:79],a[56:59],a[160:163],v[76:79]
buffer_load_dwordx4 v25, s[60:63], s89 offen offset:0  lds
M v[80:83],a[64:67],a[160:163],v[80:83]
SA s89,s89,114688
M v[80:83],a[68:71],a[164:167],v[80:83]
M v[84:87],a[76:79],a[164:167],v[84:87]
M v[84:87],a[72:75],a[160:163],v[84:87]
M v[88:91],a[80:83],a[160:163],v[88:91]
M v[88:91],a[84:87],a[164:167],v[88:91]
s_waitcnt lgkmcnt(2)
M v[92:95],a[92:95],a[164:167],v[92:95]
s_waitcnt vmcnt(18) lgkmcnt(0)
M v[92:95],a[88:91],a[160:163],v[92:95]
s_barrier
M v[124:127],a[88:91],a[168:171],v[124:127]
R a[160:163],v5,49152
R a[164:167],v6,49152
M v[124:127],a[92:95],a[172:175],v[124:127]
M v[120:123],a[84:87],a[172:175],v[120:123]
SA m0,s24,32768
T a[128:129],v1,16384
T a[130:131],v1,17408
M v[120:123],a[80:83],a[168:171],v[120:123]
buffer_load_dwordx4 v12, s[48:51], s22 offen offset:0   lds
M v[116:119],a[72:75],a[168:171],v[116:119]
M v[116:119],a[76:79],a[172:175],v[116:119]
M v[112:115],a[68:71],a[172:175],v[112:115]
M v[112:115],a[64:67],a[168:171],v[112:115]
M v[108:111],a[56:59],a[168:171],v[108:111]
M v[108:111],a[60:63],a[172:175],v[108:111]
s_nop 0
T a[132:133],v1,24576
T a[134:135],v1,25600
M v[104:107],a[52:55],a[172:175],v[104:107]
buffer_load_dwordx4 v13, s[48:51], s22 offen offset:1024   lds
M v[104:107],a[48:51],a[168:171],v[104:107]
M v[100:103],a[40:43],a[168:171],v[100:103]
M v[100:103],a[44:47],a[172:175],v[100:103]
s_waitcnt lgkmcnt(4)
M v[96:99],a[36:39],a[172:175],v[96:99]
M v[96:99],a[32:35],a[168:171],v[96:99]
M v[128:131],a[32:35],a[160:163],v[128:131]
R a[168:171],v5,51200
R a[172:175],v6,51200
M v[128:131],a[36:39],a[164:167],v[128:131]
T a[136:137],v2,16384
T a[138:139],v2,17408
M v[132:135],a[44:47],a[164:167],v[132:135]
buffer_load_dwordx4 v14, s[48:51], s22 offen offset:2048   lds
M v[132:135],a[40:43],a[160:163],v[132:135]
M v[136:139],a[48:51],a[160:163],v[136:139]
M v[136:139],a[52:55],a[164:167],v[136:139]
M v[140:143],a[60:63],a[164:167],v[140:143]
M v[140:143],a[56:59],a[160:163],v[140:143]
s_nop 0
T a[140:141],v2,24576
T a[142:143],v2,25600
M v[144:147],a[64:67],a[160:163],v[144:147]
buffer_load_dwordx4 v15, s[48:51], s22 offen offset:3072   lds
M v[144:147],a[68:71],a[164:167],v[144:147]
SA s22,s22,1048576
M v[148:151],a[76:79],a[164:167],v[148:151]
M v[148:151],a[72:75],a[160:163],v[148:151]
M v[152:155],a[80:83],a[160:163],v[152:155]
M v[152:155],a[84:87],a[164:167],v[152:155]
s_waitcnt lgkmcnt(4)
M v[156:159],a[92:95],a[164:167],v[156:159]
SA m0,s23,0
T a[144:145],v3,16384
T a[146:147],v3,17408
M v[156:159],a[88:91],a[160:163],v[156:159]
buffer_load_dwordx4 v8, s[16:19], s21 offen offset:0   lds
M v[188:191],a[88:91],a[168:171],v[188:191]
R a[160:163],v5,53248
R a[164:167],v6,53248
M v[188:191],a[92:95],a[172:175],v[188:191]
M v[184:187],a[84:87],a[172:175],v[184:187]
M v[184:187],a[80:83],a[168:171],v[184:187]
M v[180:183],a[72:75],a[168:171],v[180:183]
M v[180:183],a[76:79],a[172:175],v[180:183]
s_nop 0
T a[148:149],v3,24576
T a[150:151],v3,25600
M v[176:179],a[68:71],a[172:175],v[176:179]
buffer_load_dwordx4 v9, s[16:19], s21 offen offset:1024   lds
M v[176:179],a[64:67],a[168:171],v[176:179]
M v[172:175],a[56:59],a[168:171],v[172:175]
M v[172:175],a[60:63],a[172:175],v[172:175]
M v[168:171],a[52:55],a[172:175],v[168:171]
M v[168:171],a[48:51],a[168:171],v[168:171]
M v[164:167],a[40:43],a[168:171],v[164:167]
s_nop 0
T a[152:153],v4,16384
T a[154:155],v4,17408
M v[164:167],a[44:47],a[172:175],v[164:167]
s_waitcnt lgkmcnt(4)
buffer_load_dwordx4 v10, s[16:19], s21 offen offset:2048   lds
M v[160:163],a[36:39],a[172:175],v[160:163]
M v[160:163],a[32:35],a[168:171],v[160:163]
M v[192:195],a[32:35],a[160:163],v[192:195]
R a[168:171],v5,55296
R a[172:175],v6,55296
M v[192:195],a[36:39],a[164:167],v[192:195]
M v[196:199],a[44:47],a[164:167],v[196:199]
M v[196:199],a[40:43],a[160:163],v[196:199]
s_nop 0
T a[156:157],v4,24576
T a[158:159],v4,25600
M v[200:203],a[48:51],a[160:163],v[200:203]
buffer_load_dwordx4 v11, s[16:19], s21 offen offset:3072   lds
M v[200:203],a[52:55],a[164:167],v[200:203]
SA s21,s21,128
M v[204:207],a[60:63],a[164:167],v[204:207]
M v[204:207],a[56:59],a[160:163],v[204:207]
M v[208:211],a[64:67],a[160:163],v[208:211]
M v[208:211],a[68:71],a[164:167],v[208:211]
M v[212:215],a[76:79],a[164:167],v[212:215]
M v[212:215],a[72:75],a[160:163],v[212:215]
M v[216:219],a[80:83],a[160:163],v[216:219]
M v[216:219],a[84:87],a[164:167],v[216:219]
s_waitcnt lgkmcnt(2)
M v[220:223],a[92:95],a[164:167],v[220:223]
s_waitcnt vmcnt(17) lgkmcnt(0)
M v[220:223],a[88:91],a[160:163],v[220:223]
s_barrier
M v[252:255],a[88:91],a[168:171],v[252:255]
R a[160:163],v5,0
R a[164:167],v6,0
M v[252:255],a[92:95],a[172:175],v[252:255]
M v[248:251],a[84:87],a[172:175],v[248:251]
M v[248:251],a[80:83],a[168:171],v[248:251]
M v[244:247],a[72:75],a[168:171],v[244:247]
M v[244:247],a[76:79],a[172:175],v[244:247]
M v[240:243],a[68:71],a[172:175],v[240:243]
M v[240:243],a[64:67],a[168:171],v[240:243]
M v[236:239],a[56:59],a[168:171],v[236:239]
M v[236:239],a[60:63],a[172:175],v[236:239]
M v[232:235],a[52:55],a[172:175],v[232:235]
M v[232:235],a[48:51],a[168:171],v[232:235]
M v[228:231],a[40:43],a[168:171],v[228:231]
M v[228:231],a[44:47],a[172:175],v[228:231]
s_waitcnt lgkmcnt(0)
M v[224:227],a[36:39],a[172:175],v[224:227]
M v[224:227],a[32:35],a[168:171],v[224:227]
M a[0:3],a[96:99],a[160:163],a[0:3]
R a[168:171],v5,2048
R a[172:175],v6,2048
M a[0:3],a[100:103],a[164:167],a[0:3]
T a[32:33],v1,32768
T a[34:35],v1,33792
M a[4:7],a[108:111],a[164:167],a[4:7]
SA m0,s24,49152
M a[4:7],a[104:107],a[160:163],a[4:7]
buffer_load_dwordx4 v12, s[48:51], s22 offen offset:0   lds
M a[8:11],a[112:115],a[160:163],a[8:11]
M a[8:11],a[116:119],a[164:167],a[8:11]
M a[12:15],a[124:127],a[164:167],a[12:15]
s_nop 0
T a[36:37],v1,40960
T a[38:39],v1,41984
M a[12:15],a[120:123],a[160:163],a[12:15]
buffer_load_dwordx4 v13, s[48:51], s22 offen offset:1024   lds
M a[16:19],a[128:131],a[160:163],a[16:19]
M a[16:19],a[132:135],a[164:167],a[16:19]
M a[20:23],a[140:143],a[164:167],a[20:23]
M a[20:23],a[136:139],a[160:163],a[20:23]
s_nop 0
T a[40:41],v2,32768
T a[42:43],v2,33792
M a[24:27],a[144:147],a[160:163],a[24:27]
buffer_load_dwordx4 v14, s[48:51], s22 offen offset:2048   lds
M a[24:27],a[148:151],a[164:167],a[24:27]
s_waitcnt lgkmcnt(6)
M a[28:31],a[156:159],a[164:167],a[28:31]
M a[28:31],a[152:155],a[160:163],a[28:31]
M v[60:63],a[152:155],a[168:171],v[60:63]
R a[160:163],v5,4096
R a[164:167],v6,4096
M v[60:63],a[156:159],a[172:175],v[60:63]
T a[44:45],v2,40960
T a[46:47],v2,41984
M v[56:59],a[148:151],a[172:175],v[56:59]
buffer_load_dwordx4 v15, s[48:51], s22 offen offset:3072   lds
M v[56:59],a[144:147],a[168:171],v[56:59]
s_sub_u32 s22, s22, 1048448
M v[52:55],a[136:139],a[168:171],v[52:55]
SA m0,s23,16384
M v[52:55],a[140:143],a[172:175],v[52:55]
s_nop 0
T a[48:49],v3,32768
T a[50:51],v3,33792
M v[48:51],a[132:135],a[172:175],v[48:51]
buffer_load_dwordx4 v8, s[16:19], s21 offen offset:0   lds
M v[48:51],a[128:131],a[168:171],v[48:51]
M v[44:47],a[120:123],a[168:171],v[44:47]
M v[44:47],a[124:127],a[172:175],v[44:47]
buffer_load_dwordx4 v9, s[16:19], s21 offen offset:1024   lds
M v[40:43],a[116:119],a[172:175],v[40:43]
s_nop 0
T a[52:53],v3,40960
T a[54:55],v3,41984
M v[40:43],a[112:115],a[168:171],v[40:43]
M v[36:39],a[104:107],a[168:171],v[36:39]
M v[36:39],a[108:111],a[172:175],v[36:39]
s_waitcnt lgkmcnt(6)
M v[32:35],a[100:103],a[172:175],v[32:35]
buffer_load_dwordx4 v10, s[16:19], s21 offen offset:2048   lds
M v[32:35],a[96:99],a[168:171],v[32:35]
s_nop 0
T a[56:57],v4,32768
T a[58:59],v4,33792
M v[64:67],a[96:99],a[160:163],v[64:67]
R a[168:171],v5,6144
R a[172:175],v6,6144
M v[64:67],a[100:103],a[164:167],v[64:67]
M v[68:71],a[108:111],a[164:167],v[68:71]
buffer_load_dwordx4 v11, s[16:19], s21 offen offset:3072   lds
M v[68:71],a[104:107],a[160:163],v[68:71]
SA s21,s21,524160
M v[72:75],a[112:115],a[160:163],v[72:75]
s_nop 0
T a[60:61],v4,40960
T a[62:63],v4,41984
M v[72:75],a[116:119],a[164:167],v[72:75]
M v[76:79],a[124:127],a[164:167],v[76:79]
SA m0,s87,3072
M v[76:79],a[120:123],a[160:163],v[76:79]
buffer_load_dwordx4 v25, s[60:63], s89 offen offset:0  lds
M v[80:83],a[128:131],a[160:163],v[80:83]
SA s89,s89,114688
M v[80:83],a[132:135],a[164:167],v[80:83]
M v[84:87],a[140:143],a[164:167],v[84:87]
M v[84:87],a[136:139],a[160:163],v[84:87]
M v[88:91],a[144:147],a[160:163],v[88:91]
M v[88:91],a[148:151],a[164:167],v[88:91]
s_waitcnt lgkmcnt(2)
M v[92:95],a[156:159],a[164:167],v[92:95]
s_waitcnt vmcnt(18) lgkmcnt(0)
M v[92:95],a[152:155],a[160:163],v[92:95]
s_barrier
M v[124:127],a[152:155],a[168:171],v[124:127]
R a[160:163],v5,16384
R a[164:167],v6,16384
M v[124:127],a[156:159],a[172:175],v[124:127]
M v[120:123],a[148:151],a[172:175],v[120:123]
SA m0,s24,0
T a[64:65],v1,49152
T a[66:67],v1,50176
M v[120:123],a[144:147],a[168:171],v[120:123]
buffer_load_dwordx4 v12, s[48:51], s22 offen offset:0   lds
M v[116:119],a[136:139],a[168:171],v[116:119]
M v[116:119],a[140:143],a[172:175],v[116:119]
M v[112:115],a[132:135],a[172:175],v[112:115]
M v[112:115],a[128:131],a[168:171],v[112:115]
M v[108:111],a[120:123],a[168:171],v[108:111]
M v[108:111],a[124:127],a[172:175],v[108:111]
s_nop 0
T a[68:69],v1,57344
T a[70:71],v1,58368
M v[104:107],a[116:119],a[172:175],v[104:107]
buffer_load_dwordx4 v13, s[48:51], s22 offen offset:1024   lds
M v[104:107],a[112:115],a[168:171],v[104:107]
M v[100:103],a[104:107],a[168:171],v[100:103]
M v[100:103],a[108:111],a[172:175],v[100:103]
s_waitcnt lgkmcnt(4)
M v[96:99],a[100:103],a[172:175],v[96:99]
M v[96:99],a[96:99],a[168:171],v[96:99]
M v[128:131],a[96:99],a[160:163],v[128:131]
R a[168:171],v5,18432
R a[172:175],v6,18432
M v[128:131],a[100:103],a[164:167],v[128:131]
s_lshl_b32 s67, s20, 11
T a[72:73],v2,49152
T a[74:75],v2,50176
M v[132:135],a[108:111],a[164:167],v[132:135]
SA s67,s67,104914944
buffer_load_dwordx4 v14, s[48:51], s22 offen offset:2048   lds
M v[132:135],a[104:107],a[160:163],v[132:135]
M v[136:139],a[112:115],a[160:163],v[136:139]
M v[136:139],a[116:119],a[164:167],v[136:139]
buffer_load_dwordx4 v[16:19], v7, s[8:11], s67 offen offset:0 sc1
M v[140:143],a[124:127],a[164:167],v[140:143]
M v[140:143],a[120:123],a[160:163],v[140:143]
s_nop 0
T a[76:77],v2,57344
T a[78:79],v2,58368
M v[144:147],a[128:131],a[160:163],v[144:147]
buffer_load_dwordx4 v15, s[48:51], s22 offen offset:3072   lds
M v[144:147],a[132:135],a[164:167],v[144:147]
SA s22,s22,1048576
M v[148:151],a[140:143],a[164:167],v[148:151]
buffer_load_dwordx4 v[20:23], v7, s[8:11], s67 offen offset:1024 sc1
M v[148:151],a[136:139],a[160:163],v[148:151]
M v[152:155],a[144:147],a[160:163],v[152:155]
L_w_kv03:
s_cbranch_execz L_w_kv07
M v[152:155],a[148:151],a[164:167],v[152:155]
s_waitcnt lgkmcnt(4)
M v[156:159],a[156:159],a[164:167],v[156:159]
SA m0,s23,32768
T a[80:81],v3,49152
T a[82:83],v3,50176
M v[156:159],a[152:155],a[160:163],v[156:159]
buffer_load_dwordx4 v8, s[16:19], s21 offen offset:0   lds
M v[188:191],a[152:155],a[168:171],v[188:191]
R a[160:163],v5,20480
R a[164:167],v6,20480
M v[188:191],a[156:159],a[172:175],v[188:191]
M v[184:187],a[148:151],a[172:175],v[184:187]
M v[184:187],a[144:147],a[168:171],v[184:187]
M v[180:183],a[136:139],a[168:171],v[180:183]
M v[180:183],a[140:143],a[172:175],v[180:183]
s_nop 0
T a[84:85],v3,57344
T a[86:87],v3,58368
M v[176:179],a[132:135],a[172:175],v[176:179]
buffer_load_dwordx4 v9, s[16:19], s21 offen offset:1024   lds
M v[176:179],a[128:131],a[168:171],v[176:179]
M v[172:175],a[120:123],a[168:171],v[172:175]
M v[172:175],a[124:127],a[172:175],v[172:175]
M v[168:171],a[116:119],a[172:175],v[168:171]
M v[168:171],a[112:115],a[168:171],v[168:171]
M v[164:167],a[104:107],a[168:171],v[164:167]
s_nop 0
T a[88:89],v4,49152
T a[90:91],v4,50176
M v[164:167],a[108:111],a[172:175],v[164:167]
s_waitcnt lgkmcnt(4)
buffer_load_dwordx4 v10, s[16:19], s21 offen offset:2048   lds
M v[160:163],a[100:103],a[172:175],v[160:163]
M v[160:163],a[96:99],a[168:171],v[160:163]
M v[192:195],a[96:99],a[160:163],v[192:195]
R a[168:171],v5,22528
R a[172:175],v6,22528
M v[192:195],a[100:103],a[164:167],v[192:195]
M v[196:199],a[108:111],a[164:167],v[196:199]
M v[196:199],a[104:107],a[160:163],v[196:199]
s_nop 0
T a[92:93],v4,57344
T a[94:95],v4,58368
M v[200:203],a[112:115],a[160:163],v[200:203]
buffer_load_dwordx4 v11, s[16:19], s21 offen offset:3072   lds
M v[200:203],a[116:119],a[164:167],v[200:203]
SA s21,s21,128
M v[204:207],a[124:127],a[164:167],v[204:207]
M v[204:207],a[120:123],a[160:163],v[204:207]
M v[208:211],a[128:131],a[160:163],v[208:211]
M v[208:211],a[132:135],a[164:167],v[208:211]
M v[212:215],a[140:143],a[164:167],v[212:215]
M v[212:215],a[136:139],a[160:163],v[212:215]
M v[216:219],a[144:147],a[160:163],v[216:219]
M v[216:219],a[148:151],a[164:167],v[216:219]
s_waitcnt lgkmcnt(2)
M v[220:223],a[156:159],a[164:167],v[220:223]
s_waitcnt vmcnt(19) lgkmcnt(0)
M v[220:223],a[152:155],a[160:163],v[220:223]
s_barrier
M v[252:255],a[152:155],a[168:171],v[252:255]
R a[160:163],v5,32768
R a[164:167],v6,32768
M v[252:255],a[156:159],a[172:175],v[252:255]
M v[248:251],a[148:151],a[172:175],v[248:251]
M v[248:251],a[144:147],a[168:171],v[248:251]
M v[244:247],a[136:139],a[168:171],v[244:247]
M v[244:247],a[140:143],a[172:175],v[244:247]
M v[240:243],a[132:135],a[172:175],v[240:243]
M v[240:243],a[128:131],a[168:171],v[240:243]
M v[236:239],a[120:123],a[168:171],v[236:239]
M v[236:239],a[124:127],a[172:175],v[236:239]
M v[232:235],a[116:119],a[172:175],v[232:235]
M v[232:235],a[112:115],a[168:171],v[232:235]
M v[228:231],a[104:107],a[168:171],v[228:231]
M v[228:231],a[108:111],a[172:175],v[228:231]
s_waitcnt lgkmcnt(0)
M v[224:227],a[100:103],a[172:175],v[224:227]
M v[224:227],a[96:99],a[168:171],v[224:227]
M a[0:3],a[32:35],a[160:163],a[0:3]
R a[168:171],v5,34816
R a[172:175],v6,34816
M a[0:3],a[36:39],a[164:167],a[0:3]
T a[96:97],v1,0
T a[98:99],v1,1024
M a[4:7],a[44:47],a[164:167],a[4:7]
SA m0,s24,16384
M a[4:7],a[40:43],a[160:163],a[4:7]
buffer_load_dwordx4 v12, s[48:51], s22 offen offset:0   lds
M a[8:11],a[48:51],a[160:163],a[8:11]
M a[8:11],a[52:55],a[164:167],a[8:11]
M a[12:15],a[60:63],a[164:167],a[12:15]
s_nop 0
T a[100:101],v1,8192
T a[102:103],v1,9216
M a[12:15],a[56:59],a[160:163],a[12:15]
buffer_load_dwordx4 v13, s[48:51], s22 offen offset:1024   lds
M a[16:19],a[64:67],a[160:163],a[16:19]
M a[16:19],a[68:71],a[164:167],a[16:19]
M a[20:23],a[76:79],a[164:167],a[20:23]
s_waitcnt vmcnt(8)
v_min3_u32 v28, v16, v17, v18
M a[20:23],a[72:75],a[160:163],a[20:23]
s_nop 0
T a[104:105],v2,0
T a[106:107],v2,1024
M a[24:27],a[80:83],a[160:163],a[24:27]
buffer_load_dwordx4 v14, s[48:51], s22 offen offset:2048   lds
M a[24:27],a[84:87],a[164:167],a[24:27]
s_waitcnt lgkmcnt(6)
s_waitcnt vmcnt(7)
v_min3_u32 v28, v28, v19, v20
M a[28:31],a[92:95],a[164:167],a[28:31]
v_min3_u32 v28, v28, v21, v22
M a[28:31],a[88:91],a[160:163],a[28:31]
v_min_u32 v28, v28, v23
M v[60:63],a[88:91],a[168:171],v[60:63]
R a[160:163],v5,36864
R a[164:167],v6,36864
M v[60:63],a[92:95],a[172:175],v[60:63]
T a[108:109],v2,8192
T a[110:111],v2,9216
M v[56:59],a[84:87],a[172:175],v[56:59]
buffer_load_dwordx4 v15, s[48:51], s22 offen offset:3072   lds
M v[56:59],a[80:83],a[168:171],v[56:59]
s_sub_u32 s22, s22, 1048448
v_cmp_eq_u32 vcc, 0, v28
M v[52:55],a[72:75],a[168:171],v[52:55]
SA m0,s23,49152
s_nop 0
M v[52:55],a[76:79],a[172:175],v[52:55]
s_cbranch_vccnz L_hs
L_hr:
T a[112:113],v3,0
T a[114:115],v3,1024
M v[48:51],a[68:71],a[172:175],v[48:51]
buffer_load_dwordx4 v8, s[16:19], s21 offen offset:0   lds
M v[48:51],a[64:67],a[168:171],v[48:51]
v_max_u32 v28, v16, v17
M v[44:47],a[56:59],a[168:171],v[44:47]
v_min_u32 v29, v16, v17
M v[44:47],a[60:63],a[172:175],v[44:47]
buffer_load_dwordx4 v9, s[16:19], s21 offen offset:1024   lds
M v[40:43],a[52:55],a[172:175],v[40:43]
s_nop 0
T a[116:117],v3,8192
T a[118:119],v3,9216
M v[40:43],a[48:51],a[168:171],v[40:43]
v_med3_u32 v29, v28, v29, v18
M v[36:39],a[40:43],a[168:171],v[36:39]
v_max_u32 v28, v28, v18
M v[36:39],a[44:47],a[172:175],v[36:39]
s_waitcnt lgkmcnt(6)
v_med3_u32 v29, v28, v29, v19
M v[32:35],a[36:39],a[172:175],v[32:35]
buffer_load_dwordx4 v10, s[16:19], s21 offen offset:2048   lds
M v[32:35],a[32:35],a[168:171],v[32:35]
s_nop 0
T a[120:121],v4,0
T a[122:123],v4,1024
M v[64:67],a[32:35],a[160:163],v[64:67]
R a[168:171],v5,38912
R a[172:175],v6,38912
M v[64:67],a[36:39],a[164:167],v[64:67]
v_max_u32 v28, v28, v19
M v[68:71],a[44:47],a[164:167],v[68:71]
buffer_load_dwordx4 v11, s[16:19], s21 offen offset:3072   lds
M v[68:71],a[40:43],a[160:163],v[68:71]
SA s21,s21,524160
v_med3_u32 v29, v28, v29, v20
M v[72:75],a[48:51],a[160:163],v[72:75]
s_nop 0
T a[124:125],v4,8192
T a[126:127],v4,9216
M v[72:75],a[52:55],a[164:167],v[72:75]
v_max_u32 v28, v28, v20
M v[76:79],a[60:63],a[164:167],v[76:79]
SA m0,s87,4096
v_med3_u32 v29, v28, v29, v21
M v[76:79],a[56:59],a[160:163],v[76:79]
buffer_load_dwordx4 v25, s[60:63], s89 offen offset:0  lds
M v[80:83],a[64:67],a[160:163],v[80:83]
SA s89,s89,114688
v_max_u32 v28, v28, v21
M v[80:83],a[68:71],a[164:167],v[80:83]
v_med3_u32 v29, v28, v29, v22
M v[84:87],a[76:79],a[164:167],v[84:87]
v_max_u32 v28, v28, v22
M v[84:87],a[72:75],a[160:163],v[84:87]
v_med3_u32 v29, v28, v29, v23
M v[88:91],a[80:83],a[160:163],v[88:91]
v_max_u32 v28, v28, v23
M v[88:91],a[84:87],a[164:167],v[88:91]
s_waitcnt lgkmcnt(2)
v_mov_b32 v30, v28 row_ror:8 row_mask:0xf bank_mask:0xf
M v[92:95],a[92:95],a[164:167],v[92:95]
s_waitcnt lgkmcnt(0)
v_mov_b32 v31, v29 row_ror:8 row_mask:0xf bank_mask:0xf
M v[92:95],a[88:91],a[160:163],v[92:95]
s_barrier
M v[124:127],a[88:91],a[168:171],v[124:127]
R a[160:163],v5,49152
R a[164:167],v6,49152
M v[124:127],a[92:95],a[172:175],v[124:127]
v_min_u32 v16, v28, v30
M v[120:123],a[84:87],a[172:175],v[120:123]
SA m0,s24,32768
T a[128:129],v1,16384
T a[130:131],v1,17408
M v[120:123],a[80:83],a[168:171],v[120:123]
buffer_load_dwordx4 v12, s[48:51], s22 offen offset:0   lds
M v[116:119],a[72:75],a[168:171],v[116:119]
v_max_u32 v28, v28, v30
M v[116:119],a[76:79],a[172:175],v[116:119]
v_max3_u32 v29, v29, v31, v16
M v[112:115],a[68:71],a[172:175],v[112:115]
v_mov_b32 v30, v28 row_ror:4 row_mask:0xf bank_mask:0xf
M v[112:115],a[64:67],a[168:171],v[112:115]
v_mov_b32 v31, v29 row_ror:4 row_mask:0xf bank_mask:0xf
M v[108:111],a[56:59],a[168:171],v[108:111]
v_min_u32 v16, v28, v30
M v[108:111],a[60:63],a[172:175],v[108:111]
s_nop 0
T a[132:133],v1,24576
T a[134:135],v1,25600
M v[104:107],a[52:55],a[172:175],v[104:107]
buffer_load_dwordx4 v13, s[48:51], s22 offen offset:1024   lds
M v[104:107],a[48:51],a[168:171],v[104:107]
v_max_u32 v28, v28, v30
M v[100:103],a[40:43],a[168:171],v[100:103]
v_max3_u32 v29, v29, v31, v16
M v[100:103],a[44:47],a[172:175],v[100:103]
s_waitcnt lgkmcnt(4)
v_mov_b32 v30, v28 row_ror:2 row_mask:0xf bank_mask:0xf
M v[96:99],a[36:39],a[172:175],v[96:99]
v_mov_b32 v31, v29 row_ror:2 row_mask:0xf bank_mask:0xf
M v[96:99],a[32:35],a[168:171],v[96:99]
v_min_u32 v16, v28, v30
M v[128:131],a[32:35],a[160:163],v[128:131]
R a[168:171],v5,51200
R a[172:175],v6,51200
M v[128:131],a[36:39],a[164:167],v[128:131]
T a[136:137],v2,16384
T a[138:139],v2,17408
M v[132:135],a[44:47],a[164:167],v[132:135]
buffer_load_dwordx4 v14, s[48:51], s22 offen offset:2048   lds
M v[132:135],a[40:43],a[160:163],v[132:135]
v_max_u32 v28, v28, v30
M v[136:139],a[48:51],a[160:163],v[136:139]
v_max3_u32 v29, v29, v31, v16
M v[136:139],a[52:55],a[164:167],v[136:139]
v_mov_b32 v30, v28 row_ror:1 row_mask:0xf bank_mask:0xf
M v[140:143],a[60:63],a[164:167],v[140:143]
v_mov_b32 v31, v29 row_ror:1 row_mask:0xf bank_mask:0xf
M v[140:143],a[56:59],a[160:163],v[140:143]
s_nop 0
T a[140:141],v2,24576
T a[142:143],v2,25600
M v[144:147],a[64:67],a[160:163],v[144:147]
buffer_load_dwordx4 v15, s[48:51], s22 offen offset:3072   lds
M v[144:147],a[68:71],a[164:167],v[144:147]
SA s22,s22,1048576
v_min_u32 v16, v28, v30
M v[148:151],a[76:79],a[164:167],v[148:151]
v_max_u32 v28, v28, v30
M v[148:151],a[72:75],a[160:163],v[148:151]
v_max3_u32 v29, v29, v31, v16
M v[152:155],a[80:83],a[160:163],v[152:155]
v_mov_b32 v30, v28
M v[152:155],a[84:87],a[164:167],v[152:155]
s_waitcnt lgkmcnt(4)
v_mov_b32 v31, v29
M v[156:159],a[92:95],a[164:167],v[156:159]
SA m0,s23,0
T a[144:145],v3,16384
T a[146:147],v3,17408
M v[156:159],a[88:91],a[160:163],v[156:159]
buffer_load_dwordx4 v8, s[16:19], s21 offen offset:0   lds
M v[188:191],a[88:91],a[168:171],v[188:191]
R a[160:163],v5,53248
R a[164:167],v6,53248
M v[188:191],a[92:95],a[172:175],v[188:191]
v_permlane16_swap_b32 v30, v28
M v[184:187],a[84:87],a[172:175],v[184:187]
v_permlane16_swap_b32 v31, v29
M v[184:187],a[80:83],a[168:171],v[184:187]
v_min_u32 v16, v28, v30
M v[180:183],a[72:75],a[168:171],v[180:183]
v_max_u32 v28, v28, v30
M v[180:183],a[76:79],a[172:175],v[180:183]
s_nop 0
T a[148:149],v3,24576
T a[150:151],v3,25600
M v[176:179],a[68:71],a[172:175],v[176:179]
buffer_load_dwordx4 v9, s[16:19], s21 offen offset:1024   lds
M v[176:179],a[64:67],a[168:171],v[176:179]
v_max3_u32 v29, v29, v31, v16
M v[172:175],a[56:59],a[168:171],v[172:175]
v_mov_b32 v30, v28
M v[172:175],a[60:63],a[172:175],v[172:175]
v_mov_b32 v31, v29
M v[168:171],a[52:55],a[172:175],v[168:171]
v_permlane32_swap_b32 v30, v28
M v[168:171],a[48:51],a[168:171],v[168:171]
v_permlane32_swap_b32 v31, v29
M v[164:167],a[40:43],a[168:171],v[164:167]
s_nop 0
T a[152:153],v4,16384
T a[154:155],v4,17408
M v[164:167],a[44:47],a[172:175],v[164:167]
s_waitcnt lgkmcnt(4)
buffer_load_dwordx4 v10, s[16:19], s21 offen offset:2048   lds
M v[160:163],a[36:39],a[172:175],v[160:163]
v_min_u32 v16, v28, v30
M v[160:163],a[32:35],a[168:171],v[160:163]
v_max_u32 v28, v28, v30
M v[192:195],a[32:35],a[160:163],v[192:195]
R a[168:171],v5,55296
R a[172:175],v6,55296
M v[192:195],a[36:39],a[164:167],v[192:195]
v_max3_u32 v29, v29, v31, v16
M v[196:199],a[44:47],a[164:167],v[196:199]
s_lshl_b32 s64, s20, 3
M v[196:199],a[40:43],a[160:163],v[196:199]
SA s64,s64,159744
T a[156:157],v4,24576
T a[158:159],v4,25600
M v[200:203],a[48:51],a[160:163],v[200:203]
buffer_load_dwordx4 v11, s[16:19], s21 offen offset:3072   lds
M v[200:203],a[52:55],a[164:167],v[200:203]
SA s21,s21,128
v_mov_b32 v16, s64
M v[204:207],a[60:63],a[164:167],v[204:207]
ds_write_b64 v16, v[28:29]
M v[204:207],a[56:59],a[160:163],v[204:207]
M v[208:211],a[64:67],a[160:163],v[208:211]
M v[208:211],a[68:71],a[164:167],v[208:211]
M v[212:215],a[76:79],a[164:167],v[212:215]
M v[212:215],a[72:75],a[160:163],v[212:215]
M v[216:219],a[80:83],a[160:163],v[216:219]
M v[216:219],a[84:87],a[164:167],v[216:219]
s_waitcnt lgkmcnt(3)
M v[220:223],a[92:95],a[164:167],v[220:223]
s_waitcnt vmcnt(17) lgkmcnt(0)
M v[220:223],a[88:91],a[160:163],v[220:223]
s_barrier
M v[252:255],a[88:91],a[168:171],v[252:255]
R a[160:163],v5,0
R a[164:167],v6,0
M v[252:255],a[92:95],a[172:175],v[252:255]
M v[248:251],a[84:87],a[172:175],v[248:251]
M v[248:251],a[80:83],a[168:171],v[248:251]
M v[244:247],a[72:75],a[168:171],v[244:247]
M v[244:247],a[76:79],a[172:175],v[244:247]
M v[240:243],a[68:71],a[172:175],v[240:243]
M v[240:243],a[64:67],a[168:171],v[240:243]
M v[236:239],a[56:59],a[168:171],v[236:239]
M v[236:239],a[60:63],a[172:175],v[236:239]
M v[232:235],a[52:55],a[172:175],v[232:235]
M v[232:235],a[48:51],a[168:171],v[232:235]
M v[228:231],a[40:43],a[168:171],v[228:231]
M v[228:231],a[44:47],a[172:175],v[228:231]
s_waitcnt lgkmcnt(0)
M v[224:227],a[36:39],a[172:175],v[224:227]
M v[224:227],a[32:35],a[168:171],v[224:227]
M a[0:3],a[96:99],a[160:163],a[0:3]
R a[168:171],v5,2048
R a[172:175],v6,2048
M a[0:3],a[100:103],a[164:167],a[0:3]
T a[32:33],v1,32768
T a[34:35],v1,33792
M a[4:7],a[108:111],a[164:167],a[4:7]
SA m0,s24,49152
M a[4:7],a[104:107],a[160:163],a[4:7]
buffer_load_dwordx4 v12, s[48:51], s22 offen offset:0   lds
M a[8:11],a[112:115],a[160:163],a[8:11]
v_mov_b32 v28, 159744
M a[8:11],a[116:119],a[164:167],a[8:11]
ds_read_b128 v[16:19], v28
M a[12:15],a[124:127],a[164:167],a[12:15]
s_nop 0
T a[36:37],v1,40960
T a[38:39],v1,41984
M a[12:15],a[120:123],a[160:163],a[12:15]
buffer_load_dwordx4 v13, s[48:51], s22 offen offset:1024   lds
M a[16:19],a[128:131],a[160:163],a[16:19]
R v[20:23],v28,16
M a[16:19],a[132:135],a[164:167],a[16:19]
M a[20:23],a[140:143],a[164:167],a[20:23]
M a[20:23],a[136:139],a[160:163],a[20:23]
s_nop 0
T a[40:41],v2,32768
T a[42:43],v2,33792
M a[24:27],a[144:147],a[160:163],a[24:27]
buffer_load_dwordx4 v14, s[48:51], s22 offen offset:2048   lds
M a[24:27],a[148:151],a[164:167],a[24:27]
s_waitcnt lgkmcnt(8)
M a[28:31],a[156:159],a[164:167],a[28:31]
M a[28:31],a[152:155],a[160:163],a[28:31]
M v[60:63],a[152:155],a[168:171],v[60:63]
R a[160:163],v5,4096
R a[164:167],v6,4096
M v[60:63],a[156:159],a[172:175],v[60:63]
T a[44:45],v2,40960
T a[46:47],v2,41984
M v[56:59],a[148:151],a[172:175],v[56:59]
buffer_load_dwordx4 v15, s[48:51], s22 offen offset:3072   lds
M v[56:59],a[144:147],a[168:171],v[56:59]
s_sub_u32 s22, s22, 1048448
s_waitcnt lgkmcnt(9)
v_min_u32 v28, v16, v18
M v[52:55],a[136:139],a[168:171],v[52:55]
SA m0,s23,16384
v_max_u32 v16, v16, v18
M v[52:55],a[140:143],a[172:175],v[52:55]
s_nop 0
T a[48:49],v3,32768
T a[50:51],v3,33792
M v[48:51],a[132:135],a[172:175],v[48:51]
buffer_load_dwordx4 v8, s[16:19], s21 offen offset:0   lds
M v[48:51],a[128:131],a[168:171],v[48:51]
v_max3_u32 v17, v17, v19, v28
M v[44:47],a[120:123],a[168:171],v[44:47]
s_waitcnt lgkmcnt(8)
v_min_u32 v29, v20, v22
M v[44:47],a[124:127],a[172:175],v[44:47]
buffer_load_dwordx4 v9, s[16:19], s21 offen offset:1024   lds
M v[40:43],a[116:119],a[172:175],v[40:43]
s_nop 0
T a[52:53],v3,40960
T a[54:55],v3,41984
M v[40:43],a[112:115],a[168:171],v[40:43]
v_max_u32 v20, v20, v22
M v[36:39],a[104:107],a[168:171],v[36:39]
v_max3_u32 v21, v21, v23, v29
M v[36:39],a[108:111],a[172:175],v[36:39]
s_waitcnt lgkmcnt(6)
v_min_u32 v28, v16, v20
M v[32:35],a[100:103],a[172:175],v[32:35]
buffer_load_dwordx4 v10, s[16:19], s21 offen offset:2048   lds
M v[32:35],a[96:99],a[168:171],v[32:35]
s_nop 0
T a[56:57],v4,32768
T a[58:59],v4,33792
M v[64:67],a[96:99],a[160:163],v[64:67]
R a[168:171],v5,6144
R a[172:175],v6,6144
M v[64:67],a[100:103],a[164:167],v[64:67]
v_max_u32 v16, v16, v20
M v[68:71],a[108:111],a[164:167],v[68:71]
buffer_load_dwordx4 v11, s[16:19], s21 offen offset:3072   lds
M v[68:71],a[104:107],a[160:163],v[68:71]
SA s21,s21,524160
v_max3_u32 v17, v17, v21, v28
M v[72:75],a[112:115],a[160:163],v[72:75]
s_nop 0
T a[60:61],v4,40960
T a[62:63],v4,41984
M v[72:75],a[116:119],a[164:167],v[72:75]
v_and_b32 v28, 1, v0
M v[76:79],a[124:127],a[164:167],v[76:79]
SA m0,s87,5120
v_cmp_eq_u32 vcc, 0, v28
M v[76:79],a[120:123],a[160:163],v[76:79]
s_and_b32 s64, s20, 1
buffer_load_dwordx4 v25, s[60:63], s89 offen offset:0  lds
M v[80:83],a[128:131],a[160:163],v[80:83]
SA s89,s89,114688
s_mul_i32 s64, s64, 448
v_cndmask_b32 v24, v17, v16, vcc
M v[80:83],a[132:135],a[164:167],v[80:83]
v_and_b32 v24, 0x7ff, v24
M v[84:87],a[140:143],a[164:167],v[84:87]
v_sub_u32 v24, 2047, v24
M v[84:87],a[136:139],a[160:163],v[84:87]
v_mul_u32_u24 v28, 896, v24
M v[88:91],a[144:147],a[160:163],v[88:91]
v_lshrrev_b32 v29, 4, v0
M v[88:91],a[148:151],a[164:167],v[88:91]
s_waitcnt lgkmcnt(2)
v_lshl_add_u32 v28, v29, 4, v28
M v[92:95],a[156:159],a[164:167],v[92:95]
s_waitcnt vmcnt(18) lgkmcnt(0)
v_bfe_u32 v30, v0, 1, 3
M v[92:95],a[152:155],a[160:163],v[92:95]
s_barrier
M v[124:127],a[152:155],a[168:171],v[124:127]
R a[160:163],v5,16384
R a[164:167],v6,16384
M v[124:127],a[156:159],a[172:175],v[124:127]
v_lshl_or_b32 v28, v30, 26, v28
M v[120:123],a[148:151],a[172:175],v[120:123]
SA m0,s24,0
T a[64:65],v1,49152
T a[66:67],v1,50176
M v[120:123],a[144:147],a[168:171],v[120:123]
buffer_load_dwordx4 v12, s[48:51], s22 offen offset:0   lds
M v[116:119],a[136:139],a[168:171],v[116:119]
M v[116:119],a[140:143],a[172:175],v[116:119]
M v[112:115],a[132:135],a[172:175],v[112:115]
buffer_load_dwordx4 a[208:211], v28, s[56:59], s64 offen offset:0
M v[112:115],a[128:131],a[168:171],v[112:115]
M v[108:111],a[120:123],a[168:171],v[108:111]
buffer_load_dwordx4 a[212:215], v28, s[56:59], s64 offen offset:64
M v[108:111],a[124:127],a[172:175],v[108:111]
s_nop 0
T a[68:69],v1,57344
T a[70:71],v1,58368
M v[104:107],a[116:119],a[172:175],v[104:107]
buffer_load_dwordx4 v13, s[48:51], s22 offen offset:1024   lds
M v[104:107],a[112:115],a[168:171],v[104:107]
M v[100:103],a[104:107],a[168:171],v[100:103]
buffer_load_dwordx4 a[216:219], v28, s[56:59], s64 offen offset:128
M v[100:103],a[108:111],a[172:175],v[100:103]
s_waitcnt lgkmcnt(4)
M v[96:99],a[100:103],a[172:175],v[96:99]
M v[96:99],a[96:99],a[168:171],v[96:99]
buffer_load_dwordx4 v14, s[48:51], s22 offen offset:2048   lds
M v[128:131],a[96:99],a[160:163],v[128:131]
R a[168:171],v5,18432
R a[172:175],v6,18432
M v[128:131],a[100:103],a[164:167],v[128:131]
T a[72:73],v2,49152
T a[74:75],v2,50176
M v[132:135],a[108:111],a[164:167],v[132:135]
buffer_load_dwordx4 a[220:223], v28, s[56:59], s64 offen offset:192
M v[132:135],a[104:107],a[160:163],v[132:135]
M v[136:139],a[112:115],a[160:163],v[136:139]
buffer_load_dwordx4 a[224:227], v28, s[56:59], s64 offen offset:256
M v[136:139],a[116:119],a[164:167],v[136:139]
M v[140:143],a[124:127],a[164:167],v[140:143]
buffer_load_dwordx4 v15, s[48:51], s22 offen offset:3072   lds
M v[140:143],a[120:123],a[160:163],v[140:143]
SA s22,s22,1048576
T a[76:77],v2,57344
T a[78:79],v2,58368
M v[144:147],a[128:131],a[160:163],v[144:147]
M v[144:147],a[132:135],a[164:167],v[144:147]
buffer_load_dwordx4 a[228:231], v28, s[56:59], s64 offen offset:320
M v[148:151],a[140:143],a[164:167],v[148:151]
M v[148:151],a[136:139],a[160:163],v[148:151]
SA m0,s23,32768
M v[152:155],a[144:147],a[160:163],v[152:155]
buffer_load_dwordx4 v8, s[16:19], s21 offen offset:0   lds
M v[152:155],a[148:151],a[164:167],v[152:155]
s_waitcnt lgkmcnt(4)
M v[156:159],a[156:159],a[164:167],v[156:159]
s_nop 0
T a[80:81],v3,49152
T a[82:83],v3,50176
M v[156:159],a[152:155],a[160:163],v[156:159]
buffer_load_dwordx4 a[232:235], v28, s[56:59], s64 offen offset:384
M v[188:191],a[152:155],a[168:171],v[188:191]
R a[160:163],v5,20480
R a[164:167],v6,20480
M v[188:191],a[156:159],a[172:175],v[188:191]
v_lshrrev_b32 v28, 4, v24
M v[184:187],a[148:151],a[172:175],v[184:187]
buffer_load_dwordx4 v9, s[16:19], s21 offen offset:1024   lds
M v[184:187],a[144:147],a[168:171],v[184:187]
L_w_kv04:
s_cbranch_execz L_w_kv08
v_lshlrev_b32 v28, 5, v28
M v[180:183],a[136:139],a[168:171],v[180:183]
v_and_b32 v30, 15, v24
M v[180:183],a[140:143],a[172:175],v[180:183]
s_nop 0
T a[84:85],v3,57344
T a[86:87],v3,58368
M v[176:179],a[132:135],a[172:175],v[176:179]
v_add_lshl_u32 v28, v28, v30, 2
M v[176:179],a[128:131],a[168:171],v[176:179]
v_lshrrev_b32 v30, 1, v0
M v[172:175],a[120:123],a[168:171],v[172:175]
v_min_u32 v30, 1, v30
M v[172:175],a[124:127],a[172:175],v[172:175]
buffer_load_dwordx4 v10, s[16:19], s21 offen offset:2048   lds
M v[168:171],a[116:119],a[172:175],v[168:171]
v_lshl_or_b32 v28, v30, 29, v28
M v[168:171],a[112:115],a[168:171],v[168:171]
s_or_b32 s64, s31, s20
M v[164:167],a[104:107],a[168:171],v[164:167]
s_min_u32 s64, s64, 1
T a[88:89],v4,49152
T a[90:91],v4,50176
M v[164:167],a[108:111],a[172:175],v[164:167]
s_waitcnt lgkmcnt(4)
s_lshl_b32 s64, s64, 29
M v[160:163],a[100:103],a[172:175],v[160:163]
SA s64,s64,104857600
buffer_load_dword v23, v28, s[8:11], s64 offen sc1
M v[160:163],a[96:99],a[168:171],v[160:163]
buffer_load_dwordx4 v11, s[16:19], s21 offen offset:3072   lds
M v[192:195],a[96:99],a[160:163],v[192:195]
SA s21,s21,128
R a[168:171],v5,22528
R a[172:175],v6,22528
M v[192:195],a[100:103],a[164:167],v[192:195]
v_bfe_u32 v28, v0, 2, 2
M v[196:199],a[108:111],a[164:167],v[196:199]
v_lshl_add_u32 v28, v29, 3, v28
M v[196:199],a[104:107],a[160:163],v[196:199]
s_nop 0
T a[92:93],v4,57344
T a[94:95],v4,58368
M v[200:203],a[112:115],a[160:163],v[200:203]
SA m0,s87,6144
v_lshlrev_b32 v28, 5, v28
M v[200:203],a[116:119],a[164:167],v[200:203]
buffer_load_dwordx4 v25, s[60:63], s89 offen offset:0  lds
M v[204:207],a[124:127],a[164:167],v[204:207]
SA s89,s89,114688
v_and_b32 v30, 3, v0
M v[204:207],a[120:123],a[160:163],v[204:207]
v_lshl_add_u32 v28, v30, 3, v28
M v[208:211],a[128:131],a[160:163],v[208:211]
v_add_u32 v22, s87, v28
M v[208:211],a[132:135],a[164:167],v[208:211]
M v[212:215],a[140:143],a[164:167],v[212:215]
M v[212:215],a[136:139],a[160:163],v[212:215]
M v[216:219],a[144:147],a[160:163],v[216:219]
M v[216:219],a[148:151],a[164:167],v[216:219]
s_waitcnt lgkmcnt(2)
M v[220:223],a[156:159],a[164:167],v[220:223]
s_waitcnt vmcnt(26) lgkmcnt(0)
M v[220:223],a[152:155],a[160:163],v[220:223]
s_barrier
M v[252:255],a[152:155],a[168:171],v[252:255]
R a[160:163],v5,32768
R a[164:167],v6,32768
M v[252:255],a[156:159],a[172:175],v[252:255]
M v[248:251],a[148:151],a[172:175],v[248:251]
M v[248:251],a[144:147],a[168:171],v[248:251]
M v[244:247],a[136:139],a[168:171],v[244:247]
M v[244:247],a[140:143],a[172:175],v[244:247]
M v[240:243],a[132:135],a[172:175],v[240:243]
M v[240:243],a[128:131],a[168:171],v[240:243]
M v[236:239],a[120:123],a[168:171],v[236:239]
M v[236:239],a[124:127],a[172:175],v[236:239]
M v[232:235],a[116:119],a[172:175],v[232:235]
M v[232:235],a[112:115],a[168:171],v[232:235]
M v[228:231],a[104:107],a[168:171],v[228:231]
M v[228:231],a[108:111],a[172:175],v[228:231]
s_waitcnt lgkmcnt(0)
M v[224:227],a[100:103],a[172:175],v[224:227]
M v[224:227],a[96:99],a[168:171],v[224:227]
M a[0:3],a[32:35],a[160:163],a[0:3]
R a[168:171],v5,34816
R a[172:175],v6,34816
M a[0:3],a[36:39],a[164:167],a[0:3]
T a[96:97],v1,0
T a[98:99],v1,1024
M a[4:7],a[44:47],a[164:167],a[4:7]
SA m0,s24,16384
M a[4:7],a[40:43],a[160:163],a[4:7]
buffer_load_dwordx4 v12, s[48:51], s22 offen offset:0   lds
M a[8:11],a[48:51],a[160:163],a[8:11]
M a[8:11],a[52:55],a[164:167],a[8:11]
M a[12:15],a[60:63],a[164:167],a[12:15]
s_nop 0
T a[100:101],v1,8192
T a[102:103],v1,9216
M a[12:15],a[56:59],a[160:163],a[12:15]
M a[16:19],a[64:67],a[160:163],a[16:19]
buffer_load_dwordx4 v13, s[48:51], s22 offen offset:1024   lds
M a[16:19],a[68:71],a[164:167],a[16:19]
M a[20:23],a[76:79],a[164:167],a[20:23]
M a[20:23],a[72:75],a[160:163],a[20:23]
s_nop 0
T a[104:105],v2,0
T a[106:107],v2,1024
M a[24:27],a[80:83],a[160:163],a[24:27]
M a[24:27],a[84:87],a[164:167],a[24:27]
s_waitcnt lgkmcnt(6)
buffer_load_dwordx4 v14, s[48:51], s22 offen offset:2048   lds
M a[28:31],a[92:95],a[164:167],a[28:31]
M a[28:31],a[88:91],a[160:163],a[28:31]
M v[60:63],a[88:91],a[168:171],v[60:63]
R a[160:163],v5,36864
R a[164:167],v6,36864
M v[60:63],a[92:95],a[172:175],v[60:63]
T a[108:109],v2,8192
T a[110:111],v2,9216
M v[56:59],a[84:87],a[172:175],v[56:59]
buffer_load_dwordx4 v15, s[48:51], s22 offen offset:3072   lds
M v[56:59],a[80:83],a[168:171],v[56:59]
s_sub_u32 s22, s22, 1048448
M v[52:55],a[72:75],a[168:171],v[52:55]
M v[52:55],a[76:79],a[172:175],v[52:55]
s_nop 0
T a[112:113],v3,0
T a[114:115],v3,1024
M v[48:51],a[68:71],a[172:175],v[48:51]
SA m0,s23,49152
M v[48:51],a[64:67],a[168:171],v[48:51]
buffer_load_dwordx4 v8, s[16:19], s21 offen offset:0   lds
M v[44:47],a[56:59],a[168:171],v[44:47]
M v[44:47],a[60:63],a[172:175],v[44:47]
M v[40:43],a[52:55],a[172:175],v[40:43]
s_nop 0
T a[116:117],v3,8192
T a[118:119],v3,9216
M v[40:43],a[48:51],a[168:171],v[40:43]
M v[36:39],a[40:43],a[168:171],v[36:39]
buffer_load_dwordx4 v9, s[16:19], s21 offen offset:1024   lds
M v[36:39],a[44:47],a[172:175],v[36:39]
s_waitcnt lgkmcnt(6)
M v[32:35],a[36:39],a[172:175],v[32:35]
M v[32:35],a[32:35],a[168:171],v[32:35]
s_nop 0
T a[120:121],v4,0
T a[122:123],v4,1024
M v[64:67],a[32:35],a[160:163],v[64:67]
R a[168:171],v5,38912
R a[172:175],v6,38912
M v[64:67],a[36:39],a[164:167],v[64:67]
buffer_load_dwordx4 v10, s[16:19], s21 offen offset:2048   lds
M v[68:71],a[44:47],a[164:167],v[68:71]
M v[68:71],a[40:43],a[160:163],v[68:71]
M v[72:75],a[48:51],a[160:163],v[72:75]
s_nop 0
T a[124:125],v4,8192
T a[126:127],v4,9216
M v[72:75],a[52:55],a[164:167],v[72:75]
M v[76:79],a[60:63],a[164:167],v[76:79]
buffer_load_dwordx4 v11, s[16:19], s21 offen offset:3072   lds
M v[76:79],a[56:59],a[160:163],v[76:79]
SA s21,s21,524160
M v[80:83],a[64:67],a[160:163],v[80:83]
M v[80:83],a[68:71],a[164:167],v[80:83]
M v[84:87],a[76:79],a[164:167],v[84:87]
M v[84:87],a[72:75],a[160:163],v[84:87]
M v[88:91],a[80:83],a[160:163],v[88:91]
M v[88:91],a[84:87],a[164:167],v[88:91]
s_waitcnt lgkmcnt(2)
M v[92:95],a[92:95],a[164:167],v[92:95]
s_waitcnt vmcnt(26) lgkmcnt(0)
M v[92:95],a[88:91],a[160:163],v[92:95]
s_barrier
M v[124:127],a[88:91],a[168:171],v[124:127]
R a[160:163],v5,49152
R a[164:167],v6,49152
M v[124:127],a[92:95],a[172:175],v[124:127]
M v[120:123],a[84:87],a[172:175],v[120:123]
SA m0,s24,32768
T a[128:129],v1,16384
T a[130:131],v1,17408
M v[120:123],a[80:83],a[168:171],v[120:123]
s_waitcnt vmcnt(8)
buffer_load_dwordx4 v12, s[48:51], s22 offen offset:0   lds
M v[116:119],a[72:75],a[168:171],v[116:119]
s_nop 0
T a[176:177],v22,0
T a[178:179],v22,128
M v[116:119],a[76:79],a[172:175],v[116:119]
T a[180:181],v22,1024
T a[182:183],v22,1152
M v[112:115],a[68:71],a[172:175],v[112:115]
T a[184:185],v22,2048
T a[186:187],v22,2176
M v[112:115],a[64:67],a[168:171],v[112:115]
T a[188:189],v22,3072
T a[190:191],v22,3200
M v[108:111],a[56:59],a[168:171],v[108:111]
M v[108:111],a[60:63],a[172:175],v[108:111]
s_nop 0
T a[132:133],v1,24576
T a[134:135],v1,25600
M v[104:107],a[52:55],a[172:175],v[104:107]
buffer_load_dwordx4 v13, s[48:51], s22 offen offset:1024   lds
M v[104:107],a[48:51],a[168:171],v[104:107]
M v[100:103],a[40:43],a[168:171],v[100:103]
M v[100:103],a[44:47],a[172:175],v[100:103]
s_waitcnt lgkmcnt(12)
M v[96:99],a[36:39],a[172:175],v[96:99]
M v[96:99],a[32:35],a[168:171],v[96:99]
M v[128:131],a[32:35],a[160:163],v[128:131]
R a[168:171],v5,51200
R a[172:175],v6,51200
M v[128:131],a[36:39],a[164:167],v[128:131]
T a[136:137],v2,16384
T a[138:139],v2,17408
M v[132:135],a[44:47],a[164:167],v[132:135]
buffer_load_dwordx4 v14, s[48:51], s22 offen offset:2048   lds
M v[132:135],a[40:43],a[160:163],v[132:135]
M v[136:139],a[48:51],a[160:163],v[136:139]
M v[136:139],a[52:55],a[164:167],v[136:139]
M v[140:143],a[60:63],a[164:167],v[140:143]
M v[140:143],a[56:59],a[160:163],v[140:143]
s_nop 0
T a[140:141],v2,24576
T a[142:143],v2,25600
M v[144:147],a[64:67],a[160:163],v[144:147]
buffer_load_dwordx4 v15, s[48:51], s22 offen offset:3072   lds
M v[144:147],a[68:71],a[164:167],v[144:147]
SA s22,s22,1048576
M v[148:151],a[76:79],a[164:167],v[148:151]
M v[148:151],a[72:75],a[160:163],v[148:151]
M v[152:155],a[80:83],a[160:163],v[152:155]
M v[152:155],a[84:87],a[164:167],v[152:155]
s_waitcnt lgkmcnt(4)
M v[156:159],a[92:95],a[164:167],v[156:159]
SA m0,s23,0
T a[144:145],v3,16384
T a[146:147],v3,17408
M v[156:159],a[88:91],a[160:163],v[156:159]
buffer_load_dwordx4 v8, s[16:19], s21 offen offset:0   lds
M v[16:19],a[176:179],a[208:211],0
M v[16:19],a[180:183],a[212:215],v[16:19]
M v[16:19],a[184:187],a[216:219],v[16:19]
M v[16:19],a[188:191],a[220:223],v[16:19]
M v[188:191],a[88:91],a[168:171],v[188:191]
R a[160:163],v5,53248
R a[164:167],v6,53248
M v[188:191],a[92:95],a[172:175],v[188:191]
T a[176:177],v22,4096
T a[178:179],v22,4224
M v[184:187],a[84:87],a[172:175],v[184:187]
T a[180:181],v22,5120
T a[182:183],v22,5248
M v[184:187],a[80:83],a[168:171],v[184:187]
T a[184:185],v22,6144
T a[186:187],v22,6272
M v[180:183],a[72:75],a[168:171],v[180:183]
M v[180:183],a[76:79],a[172:175],v[180:183]
s_nop 0
T a[148:149],v3,24576
T a[150:151],v3,25600
M v[176:179],a[68:71],a[172:175],v[176:179]
buffer_load_dwordx4 v9, s[16:19], s21 offen offset:1024   lds
M v[176:179],a[64:67],a[168:171],v[176:179]
M v[172:175],a[56:59],a[168:171],v[172:175]
M v[172:175],a[60:63],a[172:175],v[172:175]
M v[168:171],a[52:55],a[172:175],v[168:171]
M v[168:171],a[48:51],a[168:171],v[168:171]
M v[164:167],a[40:43],a[168:171],v[164:167]
s_nop 0
T a[152:153],v4,16384
T a[154:155],v4,17408
M v[164:167],a[44:47],a[172:175],v[164:167]
s_waitcnt lgkmcnt(10)
buffer_load_dwordx4 v10, s[16:19], s21 offen offset:2048   lds
M v[160:163],a[36:39],a[172:175],v[160:163]
M v[160:163],a[32:35],a[168:171],v[160:163]
M v[192:195],a[32:35],a[160:163],v[192:195]
R a[168:171],v5,55296
R a[172:175],v6,55296
M v[192:195],a[36:39],a[164:167],v[192:195]
M v[196:199],a[44:47],a[164:167],v[196:199]
M v[196:199],a[40:43],a[160:163],v[196:199]
s_nop 0
T a[156:157],v4,24576
T a[158:159],v4,25600
M v[200:203],a[48:51],a[160:163],v[200:203]
buffer_load_dwordx4 v11, s[16:19], s21 offen offset:3072   lds
M v[200:203],a[52:55],a[164:167],v[200:203]
SA s21,s21,128
M v[204:207],a[60:63],a[164:167],v[204:207]
M v[204:207],a[56:59],a[160:163],v[204:207]
M v[208:211],a[64:67],a[160:163],v[208:211]
M v[208:211],a[68:71],a[164:167],v[208:211]
M v[212:215],a[76:79],a[164:167],v[212:215]
M v[212:215],a[72:75],a[160:163],v[212:215]
M v[216:219],a[80:83],a[160:163],v[216:219]
M v[216:219],a[84:87],a[164:167],v[216:219]
s_waitcnt lgkmcnt(2)
M v[220:223],a[92:95],a[164:167],v[220:223]
s_waitcnt lgkmcnt(0)
M v[220:223],a[88:91],a[160:163],v[220:223]
s_barrier
M v[16:19],a[176:179],a[224:227],v[16:19]
M v[16:19],a[180:183],a[228:231],v[16:19]
M v[16:19],a[184:187],a[232:235],v[16:19]
M v[252:255],a[88:91],a[168:171],v[252:255]
R a[160:163],v5,0
R a[164:167],v6,0
M v[252:255],a[92:95],a[172:175],v[252:255]
M v[248:251],a[84:87],a[172:175],v[248:251]
M v[248:251],a[80:83],a[168:171],v[248:251]
M v[244:247],a[72:75],a[168:171],v[244:247]
M v[244:247],a[76:79],a[172:175],v[244:247]
M v[240:243],a[68:71],a[172:175],v[240:243]
M v[240:243],a[64:67],a[168:171],v[240:243]
M v[236:239],a[56:59],a[168:171],v[236:239]
M v[236:239],a[60:63],a[172:175],v[236:239]
M v[232:235],a[52:55],a[172:175],v[232:235]
M v[232:235],a[48:51],a[168:171],v[232:235]
M v[228:231],a[40:43],a[168:171],v[228:231]
M v[228:231],a[44:47],a[172:175],v[228:231]
s_waitcnt lgkmcnt(0)
M v[224:227],a[36:39],a[172:175],v[224:227]
M v[224:227],a[32:35],a[168:171],v[224:227]
M a[0:3],a[96:99],a[160:163],a[0:3]
R a[168:171],v5,2048
R a[172:175],v6,2048
M a[0:3],a[100:103],a[164:167],a[0:3]
T a[32:33],v1,32768
T a[34:35],v1,33792
M a[4:7],a[108:111],a[164:167],a[4:7]
SA m0,s24,49152
M a[4:7],a[104:107],a[160:163],a[4:7]
buffer_load_dwordx4 v12, s[48:51], s22 offen offset:0   lds
M a[8:11],a[112:115],a[160:163],a[8:11]
M a[8:11],a[116:119],a[164:167],a[8:11]
s_lshl_b32 s64, s20, 10
M a[12:15],a[124:127],a[164:167],a[12:15]
SA s64,s64,159744
T a[36:37],v1,40960
T a[38:39],v1,41984
M a[12:15],a[120:123],a[160:163],a[12:15]
v_add_u32 v21, s64, v7
ds_write_b128 v21, v[16:19]
M a[16:19],a[128:131],a[160:163],a[16:19]
s_mul_i32 s67, s86, 14336
buffer_load_dwordx4 v13, s[48:51], s22 offen offset:1024   lds
M a[16:19],a[132:135],a[164:167],a[16:19]
s_mul_i32 s64, s20, 224
M a[20:23],a[140:143],a[164:167],a[20:23]
SA s67,s67,s64
v_lshrrev_b32 v28, 4, v0
v_mul_u32_u24 v28, 896, v28
M a[20:23],a[136:139],a[160:163],a[20:23]
T a[40:41],v2,32768
T a[42:43],v2,33792
M a[24:27],a[144:147],a[160:163],a[24:27]
v_and_b32 v29, 15, v0
v_lshl_add_u32 v28, v29, 4, v28
M a[24:27],a[148:151],a[164:167],a[24:27]
s_waitcnt lgkmcnt(7)
buffer_load_dwordx4 v14, s[48:51], s22 offen offset:2048   lds
M a[28:31],a[156:159],a[164:167],a[28:31]
v_mov_b32 v30, 536870912
v_cmp_gt_u32 vcc, 14, v29
M a[28:31],a[152:155],a[160:163],a[28:31]
s_nop 0
M v[60:63],a[152:155],a[168:171],v[60:63]
s_nop 0
R a[160:163],v5,4096
R a[164:167],v6,4096
M v[60:63],a[156:159],a[172:175],v[60:63]
T a[44:45],v2,40960
T a[46:47],v2,41984
M v[56:59],a[148:151],a[172:175],v[56:59]
buffer_load_dwordx4 v15, s[48:51], s22 offen offset:3072   lds
M v[56:59],a[144:147],a[168:171],v[56:59]
s_sub_u32 s22, s22, 1048448
v_cndmask_b32 v28, v30, v28, vcc
v_add_u32 v29, 2560, v28
M v[52:55],a[136:139],a[168:171],v[52:55]
v_add_u32 v30, 5120, v28
v_add_u32 v31, 7680, v28
M v[52:55],a[140:143],a[172:175],v[52:55]
T a[48:49],v3,32768
T a[50:51],v3,33792
M v[48:51],a[132:135],a[172:175],v[48:51]
SA m0,s23,16384
M v[48:51],a[128:131],a[168:171],v[48:51]
buffer_load_dwordx4 v8, s[16:19], s21 offen offset:0   lds
M v[44:47],a[120:123],a[168:171],v[44:47]
M v[44:47],a[124:127],a[172:175],v[44:47]
M v[40:43],a[116:119],a[172:175],v[40:43]
s_nop 0
T a[52:53],v3,40960
T a[54:55],v3,41984
M v[40:43],a[112:115],a[168:171],v[40:43]
M v[36:39],a[104:107],a[168:171],v[36:39]
buffer_load_dwordx4 v9, s[16:19], s21 offen offset:1024   lds
M v[36:39],a[108:111],a[172:175],v[36:39]
s_waitcnt lgkmcnt(6)
M v[32:35],a[100:103],a[172:175],v[32:35]
M v[32:35],a[96:99],a[168:171],v[32:35]
s_nop 0
T a[56:57],v4,32768
T a[58:59],v4,33792
M v[64:67],a[96:99],a[160:163],v[64:67]
R a[168:171],v5,6144
R a[172:175],v6,6144
M v[64:67],a[100:103],a[164:167],v[64:67]
buffer_load_dwordx4 v10, s[16:19], s21 offen offset:2048   lds
M v[68:71],a[108:111],a[164:167],v[68:71]
M v[68:71],a[104:107],a[160:163],v[68:71]
M v[72:75],a[112:115],a[160:163],v[72:75]
s_nop 0
T a[60:61],v4,40960
T a[62:63],v4,41984
M v[72:75],a[116:119],a[164:167],v[72:75]
M v[76:79],a[124:127],a[164:167],v[76:79]
buffer_load_dwordx4 v11, s[16:19], s21 offen offset:3072   lds
M v[76:79],a[120:123],a[160:163],v[76:79]
SA s21,s21,524160
M v[80:83],a[128:131],a[160:163],v[80:83]
M v[80:83],a[132:135],a[164:167],v[80:83]
M v[84:87],a[140:143],a[164:167],v[84:87]
M v[84:87],a[136:139],a[160:163],v[84:87]
M v[88:91],a[144:147],a[160:163],v[88:91]
M v[88:91],a[148:151],a[164:167],v[88:91]
s_waitcnt lgkmcnt(2)
M v[92:95],a[156:159],a[164:167],v[92:95]
s_waitcnt vmcnt(16) lgkmcnt(0)
M v[92:95],a[152:155],a[160:163],v[92:95]
s_barrier
M v[124:127],a[152:155],a[168:171],v[124:127]
R a[160:163],v5,16384
R a[164:167],v6,16384
M v[124:127],a[156:159],a[172:175],v[124:127]
M v[120:123],a[148:151],a[172:175],v[120:123]
SA m0,s24,0
T a[64:65],v1,49152
T a[66:67],v1,50176
M v[120:123],a[144:147],a[168:171],v[120:123]
buffer_load_dwordx4 v12, s[48:51], s22 offen offset:0   lds
M v[116:119],a[136:139],a[168:171],v[116:119]
M v[116:119],a[140:143],a[172:175],v[116:119]
M v[112:115],a[132:135],a[172:175],v[112:115]
M v[112:115],a[128:131],a[168:171],v[112:115]
buffer_load_dwordx4 v13, s[48:51], s22 offen offset:1024   lds
M v[108:111],a[120:123],a[168:171],v[108:111]
M v[108:111],a[124:127],a[172:175],v[108:111]
s_nop 0
T a[68:69],v1,57344
T a[70:71],v1,58368
M v[104:107],a[116:119],a[172:175],v[104:107]
M v[104:107],a[112:115],a[168:171],v[104:107]
M v[100:103],a[104:107],a[168:171],v[100:103]
buffer_load_dwordx4 v14, s[48:51], s22 offen offset:2048   lds
M v[100:103],a[108:111],a[172:175],v[100:103]
s_waitcnt lgkmcnt(4)
M v[96:99],a[100:103],a[172:175],v[96:99]
M v[96:99],a[96:99],a[168:171],v[96:99]
M v[128:131],a[96:99],a[160:163],v[128:131]
R a[168:171],v5,18432
R a[172:175],v6,18432
M v[128:131],a[100:103],a[164:167],v[128:131]
T a[72:73],v2,49152
T a[74:75],v2,50176
M v[132:135],a[108:111],a[164:167],v[132:135]
buffer_load_dwordx4 v15, s[48:51], s22 offen offset:3072   lds
M v[132:135],a[104:107],a[160:163],v[132:135]
SA s22,s22,1048576
M v[136:139],a[112:115],a[160:163],v[136:139]
M v[136:139],a[116:119],a[164:167],v[136:139]
SA m0,s23,32768
M v[140:143],a[124:127],a[164:167],v[140:143]
buffer_load_dwordx4 v8, s[16:19], s21 offen offset:0   lds
M v[140:143],a[120:123],a[160:163],v[140:143]
s_nop 0
T a[76:77],v2,57344
T a[78:79],v2,58368
M v[144:147],a[128:131],a[160:163],v[144:147]
M v[144:147],a[132:135],a[164:167],v[144:147]
M v[148:151],a[140:143],a[164:167],v[148:151]
buffer_load_dwordx4 v9, s[16:19], s21 offen offset:1024   lds
M v[148:151],a[136:139],a[160:163],v[148:151]
M v[152:155],a[144:147],a[160:163],v[152:155]
M v[152:155],a[148:151],a[164:167],v[152:155]
s_waitcnt lgkmcnt(4)
M v[156:159],a[156:159],a[164:167],v[156:159]
s_nop 0
T a[80:81],v3,49152
T a[82:83],v3,50176
M v[156:159],a[152:155],a[160:163],v[156:159]
buffer_load_dwordx4 v10, s[16:19], s21 offen offset:2048   lds
M v[188:191],a[152:155],a[168:171],v[188:191]
R a[160:163],v5,20480
R a[164:167],v6,20480
M v[188:191],a[156:159],a[172:175],v[188:191]
M v[184:187],a[148:151],a[172:175],v[184:187]
M v[184:187],a[144:147],a[168:171],v[184:187]
M v[180:183],a[136:139],a[168:171],v[180:183]
buffer_load_dwordx4 v11, s[16:19], s21 offen offset:3072   lds
M v[180:183],a[140:143],a[172:175],v[180:183]
SA s21,s21,128
T a[84:85],v3,57344
T a[86:87],v3,58368
M v[176:179],a[132:135],a[172:175],v[176:179]
M v[176:179],a[128:131],a[168:171],v[176:179]
M v[172:175],a[120:123],a[168:171],v[172:175]
SA m0,s87,0
M v[172:175],a[124:127],a[172:175],v[172:175]
buffer_load_dwordx4 v28, s[68:71], s67 offen offset:0 nt lds
M v[168:171],a[116:119],a[172:175],v[168:171]
M v[168:171],a[112:115],a[168:171],v[168:171]
M v[164:167],a[104:107],a[168:171],v[164:167]
s_nop 0
T a[88:89],v4,49152
T a[90:91],v4,50176
M v[164:167],a[108:111],a[172:175],v[164:167]
s_waitcnt lgkmcnt(4)
buffer_load_dwordx4 v29, s[68:71], s67 offen offset:1024 nt lds
M v[160:163],a[100:103],a[172:175],v[160:163]
M v[160:163],a[96:99],a[168:171],v[160:163]
M v[192:195],a[96:99],a[160:163],v[192:195]
R a[168:171],v5,22528
R a[172:175],v6,22528
M v[192:195],a[100:103],a[164:167],v[192:195]
M v[196:199],a[108:111],a[164:167],v[196:199]
buffer_load_dwordx4 v30, s[68:71], s67 offen offset:2048 nt lds
M v[196:199],a[104:107],a[160:163],v[196:199]
s_nop 0
T a[92:93],v4,57344
T a[94:95],v4,58368
M v[200:203],a[112:115],a[160:163],v[200:203]
M v[200:203],a[116:119],a[164:167],v[200:203]
M v[204:207],a[124:127],a[164:167],v[204:207]
M v[204:207],a[120:123],a[160:163],v[204:207]
buffer_load_dwordx4 v31, s[68:71], s67 offen offset:3072 nt lds
M v[208:211],a[128:131],a[160:163],v[208:211]
SA s67,s67,0
M v[208:211],a[132:135],a[164:167],v[208:211]
L_w_kv05:
s_cbranch_execz L_wd1
M v[212:215],a[140:143],a[164:167],v[212:215]
M v[212:215],a[136:139],a[160:163],v[212:215]
M v[216:219],a[144:147],a[160:163],v[216:219]
M v[216:219],a[148:151],a[164:167],v[216:219]
s_waitcnt lgkmcnt(2)
M v[220:223],a[156:159],a[164:167],v[220:223]
s_waitcnt vmcnt(20) lgkmcnt(0)
M v[220:223],a[152:155],a[160:163],v[220:223]
s_barrier
M v[252:255],a[152:155],a[168:171],v[252:255]
R a[160:163],v5,32768
R a[164:167],v6,32768
M v[252:255],a[156:159],a[172:175],v[252:255]
M v[248:251],a[148:151],a[172:175],v[248:251]
M v[248:251],a[144:147],a[168:171],v[248:251]
M v[244:247],a[136:139],a[168:171],v[244:247]
M v[244:247],a[140:143],a[172:175],v[244:247]
M v[240:243],a[132:135],a[172:175],v[240:243]
M v[240:243],a[128:131],a[168:171],v[240:243]
M v[236:239],a[120:123],a[168:171],v[236:239]
M v[236:239],a[124:127],a[172:175],v[236:239]
M v[232:235],a[116:119],a[172:175],v[232:235]
M v[232:235],a[112:115],a[168:171],v[232:235]
M v[228:231],a[104:107],a[168:171],v[228:231]
M v[228:231],a[108:111],a[172:175],v[228:231]
s_waitcnt lgkmcnt(0)
M v[224:227],a[100:103],a[172:175],v[224:227]
M v[224:227],a[96:99],a[168:171],v[224:227]
M a[0:3],a[32:35],a[160:163],a[0:3]
R a[168:171],v5,34816
R a[172:175],v6,34816
M a[0:3],a[36:39],a[164:167],a[0:3]
T a[96:97],v1,0
T a[98:99],v1,1024
M a[4:7],a[44:47],a[164:167],a[4:7]
SA m0,s24,16384
C v23,v23,v23
M a[4:7],a[40:43],a[160:163],a[4:7]
buffer_load_dwordx4 v12, s[48:51], s22 offen offset:0   lds
M a[8:11],a[48:51],a[160:163],a[8:11]
v_and_b32 v23, 0xffff0000, v23
M a[8:11],a[52:55],a[164:167],a[8:11]
MF v22,0xbfb8aa3b,v23
M a[12:15],a[60:63],a[164:167],a[12:15]
s_nop 0
T a[100:101],v1,8192
T a[102:103],v1,9216
M a[12:15],a[56:59],a[160:163],a[12:15]
E v22,v22
M a[16:19],a[64:67],a[160:163],a[16:19]
buffer_load_dwordx4 v13, s[48:51], s22 offen offset:1024   lds
M a[16:19],a[68:71],a[164:167],a[16:19]
AF v22,1.0,v22
M a[20:23],a[76:79],a[164:167],a[20:23]
v_rcp_f32 v23, v22
M a[20:23],a[72:75],a[160:163],a[20:23]
s_or_b32 s64, s31, s20
T a[104:105],v2,0
T a[106:107],v2,1024
M a[24:27],a[80:83],a[160:163],a[24:27]
s_min_u32 s64, s64, 1
s_lshl_b32 s64, s64, 29
v_lshrrev_b32 v22, 1, v0
M a[24:27],a[84:87],a[164:167],a[24:27]
s_waitcnt lgkmcnt(6)
buffer_load_dwordx4 v14, s[48:51], s22 offen offset:2048   lds
M a[28:31],a[92:95],a[164:167],a[28:31]
v_min_u32 v22, 1, v22
M a[28:31],a[88:91],a[160:163],a[28:31]
v_lshlrev_b32 v22, 29, v22
M v[60:63],a[88:91],a[168:171],v[60:63]
R a[160:163],v5,36864
R a[164:167],v6,36864
M v[60:63],a[92:95],a[172:175],v[60:63]
T a[108:109],v2,8192
T a[110:111],v2,9216
M v[56:59],a[84:87],a[172:175],v[56:59]
buffer_load_dwordx4 v15, s[48:51], s22 offen offset:3072   lds
M v[56:59],a[80:83],a[168:171],v[56:59]
s_sub_u32 s22, s22, 1048448
v_lshl_or_b32 v22, v0, 2, v22
M v[52:55],a[72:75],a[168:171],v[52:55]
v_or_b32 v22, s64, v22
M v[52:55],a[76:79],a[172:175],v[52:55]
s_nop 0
T a[112:113],v3,0
T a[114:115],v3,1024
M v[48:51],a[68:71],a[172:175],v[48:51]
SA m0,s23,49152
C v23,v23,v23
M v[48:51],a[64:67],a[168:171],v[48:51]
buffer_load_dwordx4 v8, s[16:19], s21 offen offset:0   lds
M v[44:47],a[56:59],a[168:171],v[44:47]
v_and_b32 v23, 0xffff0000, v23
M v[44:47],a[60:63],a[172:175],v[44:47]
s_lshl_b32 s64, s41, 7
M v[40:43],a[52:55],a[172:175],v[40:43]
SA s64,s64,104890368
T a[116:117],v3,8192
T a[118:119],v3,9216
M v[40:43],a[48:51],a[168:171],v[40:43]
buffer_store_dword v24, v22, s[8:11], s64 offen sc1
M v[36:39],a[40:43],a[168:171],v[36:39]
buffer_load_dwordx4 v9, s[16:19], s21 offen offset:1024   lds
M v[36:39],a[44:47],a[172:175],v[36:39]
s_waitcnt lgkmcnt(6)
buffer_store_dword v23, v22, s[8:11], s64 offen offset:8 sc1
M v[32:35],a[36:39],a[172:175],v[32:35]
v_add_u32 v25, 159744, v7
M v[32:35],a[32:35],a[168:171],v[32:35]
s_nop 0
T a[120:121],v4,0
T a[122:123],v4,1024
M v[64:67],a[32:35],a[160:163],v[64:67]
R a[168:171],v5,38912
R a[172:175],v6,38912
M v[64:67],a[36:39],a[164:167],v[64:67]
buffer_load_dwordx4 v10, s[16:19], s21 offen offset:2048   lds
M v[68:71],a[44:47],a[164:167],v[68:71]
ds_read_b128 v[16:19], v25
M v[68:71],a[40:43],a[160:163],v[68:71]
R v[28:31],v25,1024
M v[72:75],a[48:51],a[160:163],v[72:75]
s_nop 0
T a[124:125],v4,8192
T a[126:127],v4,9216
M v[72:75],a[52:55],a[164:167],v[72:75]
R v[20:23],v25,2048
M v[76:79],a[60:63],a[164:167],v[76:79]
buffer_load_dwordx4 v11, s[16:19], s21 offen offset:3072   lds
M v[76:79],a[56:59],a[160:163],v[76:79]
SA s21,s21,524160
M v[80:83],a[64:67],a[160:163],v[80:83]
M v[80:83],a[68:71],a[164:167],v[80:83]
M v[84:87],a[76:79],a[164:167],v[84:87]
M v[84:87],a[72:75],a[160:163],v[84:87]
M v[88:91],a[80:83],a[160:163],v[88:91]
M v[88:91],a[84:87],a[164:167],v[88:91]
s_waitcnt lgkmcnt(5)
s_waitcnt lgkmcnt(3)
AF v16,v28,v16
M v[92:95],a[92:95],a[164:167],v[92:95]
s_waitcnt vmcnt(22) lgkmcnt(0)
AF v17,v29,v17
M v[92:95],a[88:91],a[160:163],v[92:95]
s_barrier
M v[124:127],a[88:91],a[168:171],v[124:127]
R a[160:163],v5,49152
R a[164:167],v6,49152
M v[124:127],a[92:95],a[172:175],v[124:127]
AF v18,v30,v18
M v[120:123],a[84:87],a[172:175],v[120:123]
SA m0,s24,32768
T a[128:129],v1,16384
T a[130:131],v1,17408
M v[120:123],a[80:83],a[168:171],v[120:123]
buffer_load_dwordx4 v12, s[48:51], s22 offen offset:0   lds
M v[116:119],a[72:75],a[168:171],v[116:119]
AF v19,v31,v19
M v[116:119],a[76:79],a[172:175],v[116:119]
R v[28:31],v25,3072
M v[112:115],a[68:71],a[172:175],v[112:115]
C v25,v16,v17
M v[112:115],a[64:67],a[168:171],v[112:115]
v_lshlrev_b32 v16, 16, v25
M v[108:111],a[56:59],a[168:171],v[108:111]
v_and_b32 v17, 0xffff0000, v25
M v[108:111],a[60:63],a[172:175],v[108:111]
s_nop 0
T a[132:133],v1,24576
T a[134:135],v1,25600
M v[104:107],a[52:55],a[172:175],v[104:107]
buffer_load_dwordx4 v13, s[48:51], s22 offen offset:1024   lds
M v[104:107],a[48:51],a[168:171],v[104:107]
C v25,v18,v19
M v[100:103],a[40:43],a[168:171],v[100:103]
v_lshlrev_b32 v18, 16, v25
M v[100:103],a[44:47],a[172:175],v[100:103]
s_waitcnt lgkmcnt(5)
v_and_b32 v19, 0xffff0000, v25
M v[96:99],a[36:39],a[172:175],v[96:99]
s_waitcnt lgkmcnt(2)
AF v20,v28,v20
M v[96:99],a[32:35],a[168:171],v[96:99]
AF v21,v29,v21
M v[128:131],a[32:35],a[160:163],v[128:131]
R a[168:171],v5,51200
R a[172:175],v6,51200
M v[128:131],a[36:39],a[164:167],v[128:131]
T a[136:137],v2,16384
T a[138:139],v2,17408
M v[132:135],a[44:47],a[164:167],v[132:135]
buffer_load_dwordx4 v14, s[48:51], s22 offen offset:2048   lds
M v[132:135],a[40:43],a[160:163],v[132:135]
AF v22,v30,v22
M v[136:139],a[48:51],a[160:163],v[136:139]
AF v23,v31,v23
M v[136:139],a[52:55],a[164:167],v[136:139]
MF v28,0xbfb8aa3b,v16
M v[140:143],a[60:63],a[164:167],v[140:143]
MF v29,0xbfb8aa3b,v17
M v[140:143],a[56:59],a[160:163],v[140:143]
s_nop 0
T a[140:141],v2,24576
T a[142:143],v2,25600
M v[144:147],a[64:67],a[160:163],v[144:147]
buffer_load_dwordx4 v15, s[48:51], s22 offen offset:3072   lds
M v[144:147],a[68:71],a[164:167],v[144:147]
SA s22,s22,1048576
MF v30,0xbfb8aa3b,v18
M v[148:151],a[76:79],a[164:167],v[148:151]
MF v31,0xbfb8aa3b,v19
M v[148:151],a[72:75],a[160:163],v[148:151]
E v28,v28
M v[152:155],a[80:83],a[160:163],v[152:155]
E v29,v29
M v[152:155],a[84:87],a[164:167],v[152:155]
s_waitcnt lgkmcnt(4)
E v30,v30
M v[156:159],a[92:95],a[164:167],v[156:159]
SA m0,s23,0
T a[144:145],v3,16384
T a[146:147],v3,17408
M v[156:159],a[88:91],a[160:163],v[156:159]
buffer_load_dwordx4 v8, s[16:19], s21 offen offset:0   lds
M v[188:191],a[88:91],a[168:171],v[188:191]
R a[160:163],v5,53248
R a[164:167],v6,53248
M v[188:191],a[92:95],a[172:175],v[188:191]
E v31,v31
M v[184:187],a[84:87],a[172:175],v[184:187]
C v25,v20,v21
M v[184:187],a[80:83],a[168:171],v[184:187]
v_lshlrev_b32 v20, 16, v25
M v[180:183],a[72:75],a[168:171],v[180:183]
v_and_b32 v21, 0xffff0000, v25
M v[180:183],a[76:79],a[172:175],v[180:183]
s_nop 0
T a[148:149],v3,24576
T a[150:151],v3,25600
M v[176:179],a[68:71],a[172:175],v[176:179]
buffer_load_dwordx4 v9, s[16:19], s21 offen offset:1024   lds
M v[176:179],a[64:67],a[168:171],v[176:179]
C v25,v22,v23
M v[172:175],a[56:59],a[168:171],v[172:175]
v_lshlrev_b32 v22, 16, v25
M v[172:175],a[60:63],a[172:175],v[172:175]
v_and_b32 v23, 0xffff0000, v25
M v[168:171],a[52:55],a[172:175],v[168:171]
AF v28,1.0,v28
M v[168:171],a[48:51],a[168:171],v[168:171]
AF v29,1.0,v29
M v[164:167],a[40:43],a[168:171],v[164:167]
s_nop 0
T a[152:153],v4,16384
T a[154:155],v4,17408
M v[164:167],a[44:47],a[172:175],v[164:167]
s_waitcnt lgkmcnt(4)
buffer_load_dwordx4 v10, s[16:19], s21 offen offset:2048   lds
M v[160:163],a[36:39],a[172:175],v[160:163]
AF v30,1.0,v30
M v[160:163],a[32:35],a[168:171],v[160:163]
AF v31,1.0,v31
M v[192:195],a[32:35],a[160:163],v[192:195]
R a[168:171],v5,55296
R a[172:175],v6,55296
M v[192:195],a[36:39],a[164:167],v[192:195]
v_rcp_f32 v28, v28
M v[196:199],a[44:47],a[164:167],v[196:199]
v_rcp_f32 v29, v29
M v[196:199],a[40:43],a[160:163],v[196:199]
T a[156:157],v4,24576
T a[158:159],v4,25600
M v[200:203],a[48:51],a[160:163],v[200:203]
buffer_load_dwordx4 v11, s[16:19], s21 offen offset:3072   lds
M v[200:203],a[52:55],a[164:167],v[200:203]
SA s21,s21,128
v_rcp_f32 v30, v30
M v[204:207],a[60:63],a[164:167],v[204:207]
v_rcp_f32 v31, v31
M v[204:207],a[56:59],a[160:163],v[204:207]
MF v16,v28,v16
M v[208:211],a[64:67],a[160:163],v[208:211]
MF v17,v29,v17
M v[208:211],a[68:71],a[164:167],v[208:211]
MF v18,v30,v18
M v[212:215],a[76:79],a[164:167],v[212:215]
MF v19,v31,v19
M v[212:215],a[72:75],a[160:163],v[212:215]
C v25,v16,v17
M v[216:219],a[80:83],a[160:163],v[216:219]
v_lshlrev_b32 v16, 16, v25
M v[216:219],a[84:87],a[164:167],v[216:219]
s_waitcnt lgkmcnt(2)
v_and_b32 v17, 0xffff0000, v25
M v[220:223],a[92:95],a[164:167],v[220:223]
s_waitcnt vmcnt(22) lgkmcnt(0)
C v25,v18,v19
M v[220:223],a[88:91],a[160:163],v[220:223]
s_barrier
M v[252:255],a[88:91],a[168:171],v[252:255]
R a[160:163],v5,0
R a[164:167],v6,0
M v[252:255],a[92:95],a[172:175],v[252:255]
v_lshlrev_b32 v18, 16, v25
M v[248:251],a[84:87],a[172:175],v[248:251]
v_and_b32 v19, 0xffff0000, v25
M v[248:251],a[80:83],a[168:171],v[248:251]
MF v16,v20,v16
M v[244:247],a[72:75],a[168:171],v[244:247]
MF v17,v21,v17
M v[244:247],a[76:79],a[172:175],v[244:247]
MF v18,v22,v18
M v[240:243],a[68:71],a[172:175],v[240:243]
MF v19,v23,v19
M v[240:243],a[64:67],a[168:171],v[240:243]
C v16,v16,v17
M v[236:239],a[56:59],a[168:171],v[236:239]
C v17,v18,v19
M v[236:239],a[60:63],a[172:175],v[236:239]
M v[232:235],a[52:55],a[172:175],v[232:235]
M v[232:235],a[48:51],a[168:171],v[232:235]
M v[228:231],a[40:43],a[168:171],v[228:231]
M v[228:231],a[44:47],a[172:175],v[228:231]
s_waitcnt lgkmcnt(0)
M v[224:227],a[36:39],a[172:175],v[224:227]
M v[224:227],a[32:35],a[168:171],v[224:227]
M a[0:3],a[96:99],a[160:163],a[0:3]
R a[168:171],v5,2048
R a[172:175],v6,2048
M a[0:3],a[100:103],a[164:167],a[0:3]
T a[32:33],v1,32768
T a[34:35],v1,33792
M a[4:7],a[108:111],a[164:167],a[4:7]
SA m0,s24,49152
v_lshrrev_b32 v28, 4, v0
v_and_b32 v29, 7, v0
M a[4:7],a[104:107],a[160:163],a[4:7]
buffer_load_dwordx4 v12, s[48:51], s22 offen offset:0   lds
M a[8:11],a[112:115],a[160:163],a[8:11]
v_xor_b32 v28, v28, v29
v_lshlrev_b32 v28, 4, v28
M a[8:11],a[116:119],a[164:167],a[8:11]
v_lshrrev_b32 v29, 3, v0
v_mul_u32_u24 v29, 896, v29
M a[12:15],a[124:127],a[164:167],a[12:15]
T a[36:37],v1,40960
T a[38:39],v1,41984
M a[12:15],a[120:123],a[160:163],a[12:15]
v_add_u32 v22, v28, v29
v_xor_b32 v28, 64, v28
M a[16:19],a[128:131],a[160:163],a[16:19]
s_mul_i32 s64, s20, 14336
buffer_load_dwordx4 v13, s[48:51], s22 offen offset:1024   lds
M a[16:19],a[132:135],a[164:167],a[16:19]
s_sub_u32 s65, 98304, s64
M a[20:23],a[140:143],a[164:167],a[20:23]
SA s30,s29,s65
M a[20:23],a[136:139],a[160:163],a[20:23]
SA s29,s29,s64
T a[40:41],v2,32768
T a[42:43],v2,33792
M a[24:27],a[144:147],a[160:163],a[24:27]
v_add_u32 v29, 6144, v29
v_add_u32 v23, v28, v29
M a[24:27],a[148:151],a[164:167],a[24:27]
s_waitcnt lgkmcnt(6)
buffer_load_dwordx4 v14, s[48:51], s22 offen offset:2048   lds
M a[28:31],a[156:159],a[164:167],a[28:31]
s_and_b32 s64, s20, 1
M a[28:31],a[152:155],a[160:163],a[28:31]
s_lshl_b32 s64, s64, 12
M v[60:63],a[152:155],a[168:171],v[60:63]
SA s64,s64,65536
R a[160:163],v5,4096
R a[164:167],v6,4096
M v[60:63],a[156:159],a[172:175],v[60:63]
T a[44:45],v2,40960
T a[46:47],v2,41984
M v[56:59],a[148:151],a[172:175],v[56:59]
buffer_load_dwordx4 v15, s[48:51], s22 offen offset:3072   lds
M v[56:59],a[144:147],a[168:171],v[56:59]
s_sub_u32 s22, s22, 1048448
v_add_u32 v20, s64, v5
v_add_u32 v21, s64, v6
M v[52:55],a[136:139],a[168:171],v[52:55]
v_lshrrev_b32 v28, 2, v0
v_lshlrev_b32 v28, 8, v28
M v[52:55],a[140:143],a[172:175],v[52:55]
T a[48:49],v3,32768
T a[50:51],v3,33792
M v[48:51],a[132:135],a[172:175],v[48:51]
SA m0,s23,16384
v_and_b32 v29, 3, v0
v_lshl_add_u32 v28, v29, 3, v28
M v[48:51],a[128:131],a[168:171],v[48:51]
buffer_load_dwordx4 v8, s[16:19], s21 offen offset:0   lds
M v[44:47],a[120:123],a[168:171],v[44:47]
v_add_u32 v28, s87, v28
M v[44:47],a[124:127],a[172:175],v[44:47]
s_waitcnt vmcnt(23)
s_nop 0
T a[176:177],v28,0
T a[178:179],v28,32
M v[40:43],a[116:119],a[172:175],v[40:43]
T a[52:53],v3,40960
T a[54:55],v3,41984
M v[40:43],a[112:115],a[168:171],v[40:43]
T a[180:181],v28,64
T a[182:183],v28,96
M v[36:39],a[104:107],a[168:171],v[36:39]
buffer_load_dwordx4 v9, s[16:19], s21 offen offset:1024   lds
M v[36:39],a[108:111],a[172:175],v[36:39]
s_waitcnt lgkmcnt(10)
s_nop 0
T a[184:185],v28,128
T a[186:187],v28,160
M v[32:35],a[100:103],a[172:175],v[32:35]
T a[188:189],v28,192
M v[32:35],a[96:99],a[168:171],v[32:35]
s_nop 0
T a[56:57],v4,32768
T a[58:59],v4,33792
M v[64:67],a[96:99],a[160:163],v[64:67]
R a[168:171],v5,6144
R a[172:175],v6,6144
M v[64:67],a[100:103],a[164:167],v[64:67]
buffer_load_dwordx4 v10, s[16:19], s21 offen offset:2048   lds
s_waitcnt lgkmcnt(12)
v_mfma_f32_16x16x16_bf16 a[192:195], a[176:177], v[16:17], 0
M v[68:71],a[108:111],a[164:167],v[68:71]
v_mov_b32 v18, v16 row_shr:2 row_mask:0xf bank_mask:0xf bound_ctrl:0
v_mov_b32 v19, v17 row_shr:2 row_mask:0xf bank_mask:0xf bound_ctrl:0
M v[68:71],a[104:107],a[160:163],v[68:71]
M v[72:75],a[112:115],a[160:163],v[72:75]
s_nop 0
T a[60:61],v4,40960
T a[62:63],v4,41984
M v[72:75],a[116:119],a[164:167],v[72:75]
s_waitcnt lgkmcnt(13)
v_mfma_f32_16x16x16_bf16 a[192:195], a[178:179], v[18:19], a[192:195]
M v[76:79],a[124:127],a[164:167],v[76:79]
buffer_load_dwordx4 v11, s[16:19], s21 offen offset:3072   lds
M v[76:79],a[120:123],a[160:163],v[76:79]
SA s21,s21,524160
v_mov_b32 v16, v18 row_shr:2 row_mask:0xf bank_mask:0xf bound_ctrl:0
v_mov_b32 v17, v19 row_shr:2 row_mask:0xf bank_mask:0xf bound_ctrl:0
M v[80:83],a[128:131],a[160:163],v[80:83]
M v[80:83],a[132:135],a[164:167],v[80:83]
s_waitcnt lgkmcnt(10)
v_mfma_f32_16x16x16_bf16 a[192:195], a[180:181], v[16:17], a[192:195]
M v[84:87],a[140:143],a[164:167],v[84:87]
v_mov_b32 v18, v16 row_shr:2 row_mask:0xf bank_mask:0xf bound_ctrl:0
v_mov_b32 v19, v17 row_shr:2 row_mask:0xf bank_mask:0xf bound_ctrl:0
M v[84:87],a[136:139],a[160:163],v[84:87]
M v[88:91],a[144:147],a[160:163],v[88:91]
M v[88:91],a[148:151],a[164:167],v[88:91]
s_waitcnt lgkmcnt(2)
v_mfma_f32_16x16x16_bf16 a[192:195], a[182:183], v[18:19], a[192:195]
M v[92:95],a[156:159],a[164:167],v[92:95]
s_waitcnt vmcnt(16) lgkmcnt(0)
v_mov_b32 v16, v18 row_shr:2 row_mask:0xf bank_mask:0xf bound_ctrl:0
v_mov_b32 v17, v19 row_shr:2 row_mask:0xf bank_mask:0xf bound_ctrl:0
M v[92:95],a[152:155],a[160:163],v[92:95]
s_barrier
M v[124:127],a[152:155],a[168:171],v[124:127]
R a[160:163],v5,16384
R a[164:167],v6,16384
M v[124:127],a[156:159],a[172:175],v[124:127]
SA m0,s23,131072
v_mfma_f32_16x16x16_bf16 a[192:195], a[184:185], v[16:17], a[192:195]
M v[120:123],a[148:151],a[172:175],v[120:123]
s_nop 0
T a[64:65],v1,49152
T a[66:67],v1,50176
M v[120:123],a[144:147],a[168:171],v[120:123]
v_mov_b32 v18, v16 row_shr:2 row_mask:0xf bank_mask:0xf bound_ctrl:0
v_mov_b32 v19, v17 row_shr:2 row_mask:0xf bank_mask:0xf bound_ctrl:0
M v[116:119],a[136:139],a[168:171],v[116:119]
buffer_load_dwordx4 v22, s[56:59], s29 offen offset:0 lds
M v[116:119],a[140:143],a[172:175],v[116:119]
v_mfma_f32_16x16x16_bf16 a[192:195], a[186:187], v[18:19], a[192:195]
M v[112:115],a[132:135],a[172:175],v[112:115]
v_mov_b32 v16, v18 row_shr:2 row_mask:0xf bank_mask:0xf bound_ctrl:0
v_mov_b32 v17, v19 row_shr:2 row_mask:0xf bank_mask:0xf bound_ctrl:0
M v[112:115],a[128:131],a[168:171],v[112:115]
buffer_load_dwordx4 v23, s[56:59], s29 offen offset:1024 lds
M v[108:111],a[120:123],a[168:171],v[108:111]
M v[108:111],a[124:127],a[172:175],v[108:111]
s_nop 0
T a[68:69],v1,57344
T a[70:71],v1,58368
v_mfma_f32_16x16x16_bf16 a[192:195], a[188:189], v[16:17], a[192:195]
M v[104:107],a[116:119],a[172:175],v[104:107]
buffer_load_dwordx4 v22, s[56:59], s30 offen offset:2048 lds
M v[104:107],a[112:115],a[168:171],v[104:107]
v_and_b32 v29, 1, v0
v_mul_u32_u24 v30, 1792, v29
M v[100:103],a[104:107],a[168:171],v[100:103]
v_lshrrev_b32 v31, 4, v0
v_lshl_add_u32 v30, v31, 4, v30
M v[100:103],a[108:111],a[172:175],v[100:103]
s_waitcnt lgkmcnt(4)
v_bfe_u32 v29, v0, 1, 3
v_lshl_add_u32 v30, v29, 6, v30
M v[96:99],a[100:103],a[172:175],v[96:99]
v_add_u32 v29, 1, v29
v_lshrrev_b32 v29, 3, v29
M v[96:99],a[96:99],a[168:171],v[96:99]
v_lshl_or_b32 v30, v29, 29, v30
v_or_b32 v30, s88, v30
M v[128:131],a[96:99],a[160:163],v[128:131]
s_mul_i32 s89, s86, 3584
R a[168:171],v5,18432
R a[172:175],v6,18432
M v[128:131],a[100:103],a[164:167],v[128:131]
s_mul_i32 s64, s20, 448
T a[72:73],v2,49152
T a[74:75],v2,50176
M v[132:135],a[108:111],a[164:167],v[132:135]
SA s89,s89,s64
M v[132:135],a[104:107],a[160:163],v[132:135]
SA s89,s89,105906176
buffer_store_dwordx4 a[192:195], v30, s[8:11], s89 offen sc1
M v[136:139],a[112:115],a[160:163],v[136:139]
M v[136:139],a[116:119],a[164:167],v[136:139]
M v[140:143],a[124:127],a[164:167],v[140:143]
buffer_load_dwordx4 v23, s[56:59], s30 offen offset:3072 lds
M v[140:143],a[120:123],a[160:163],v[140:143]
SA s29,s29,128
T a[76:77],v2,57344
T a[78:79],v2,58368
M v[144:147],a[128:131],a[160:163],v[144:147]
SA s30,s30,128
M v[144:147],a[132:135],a[164:167],v[144:147]
SA m0,s24,0
M v[148:151],a[140:143],a[164:167],v[148:151]
buffer_load_dwordx4 v12, s[48:51], s22 offen offset:0   lds
M v[148:151],a[136:139],a[160:163],v[148:151]
M v[152:155],a[144:147],a[160:163],v[152:155]
M v[152:155],a[148:151],a[164:167],v[152:155]
s_waitcnt lgkmcnt(4)
buffer_load_dwordx4 v13, s[48:51], s22 offen offset:1024   lds
M v[156:159],a[156:159],a[164:167],v[156:159]
s_nop 0
T a[80:81],v3,49152
T a[82:83],v3,50176
M v[156:159],a[152:155],a[160:163],v[156:159]
M v[188:191],a[152:155],a[168:171],v[188:191]
R a[160:163],v5,20480
R a[164:167],v6,20480
M v[188:191],a[156:159],a[172:175],v[188:191]
buffer_load_dwordx4 v14, s[48:51], s22 offen offset:2048   lds
M v[184:187],a[148:151],a[172:175],v[184:187]
M v[184:187],a[144:147],a[168:171],v[184:187]
M v[180:183],a[136:139],a[168:171],v[180:183]
buffer_load_dwordx4 v15, s[48:51], s22 offen offset:3072   lds
M v[180:183],a[140:143],a[172:175],v[180:183]
SA s22,s22,1048576
T a[84:85],v3,57344
T a[86:87],v3,58368
M v[176:179],a[132:135],a[172:175],v[176:179]
SA m0,s23,32768
M v[176:179],a[128:131],a[168:171],v[176:179]
buffer_load_dwordx4 v8, s[16:19], s21 offen offset:0   lds
M v[172:175],a[120:123],a[168:171],v[172:175]
M v[172:175],a[124:127],a[172:175],v[172:175]
M v[168:171],a[116:119],a[172:175],v[168:171]
M v[168:171],a[112:115],a[168:171],v[168:171]
L_w_kv06:
s_cbranch_execz L_wd1
buffer_load_dwordx4 v9, s[16:19], s21 offen offset:1024   lds
M v[164:167],a[104:107],a[168:171],v[164:167]
s_nop 0
T a[88:89],v4,49152
T a[90:91],v4,50176
M v[164:167],a[108:111],a[172:175],v[164:167]
s_waitcnt lgkmcnt(4)
M v[160:163],a[100:103],a[172:175],v[160:163]
M v[160:163],a[96:99],a[168:171],v[160:163]
M v[192:195],a[96:99],a[160:163],v[192:195]
R a[168:171],v5,22528
R a[172:175],v6,22528
M v[192:195],a[100:103],a[164:167],v[192:195]
buffer_load_dwordx4 v10, s[16:19], s21 offen offset:2048   lds
M v[196:199],a[108:111],a[164:167],v[196:199]
M v[196:199],a[104:107],a[160:163],v[196:199]
s_nop 0
T a[92:93],v4,57344
T a[94:95],v4,58368
M v[200:203],a[112:115],a[160:163],v[200:203]
M v[200:203],a[116:119],a[164:167],v[200:203]
buffer_load_dwordx4 v11, s[16:19], s21 offen offset:3072   lds
M v[204:207],a[124:127],a[164:167],v[204:207]
M v[204:207],a[120:123],a[160:163],v[204:207]
M v[208:211],a[128:131],a[160:163],v[208:211]
M v[208:211],a[132:135],a[164:167],v[208:211]
M v[212:215],a[140:143],a[164:167],v[212:215]
SA s21,s21,128
M v[212:215],a[136:139],a[160:163],v[212:215]
M v[216:219],a[144:147],a[160:163],v[216:219]
M v[216:219],a[148:151],a[164:167],v[216:219]
s_waitcnt lgkmcnt(2)
M v[220:223],a[156:159],a[164:167],v[220:223]
s_waitcnt vmcnt(21) lgkmcnt(0)
M v[220:223],a[152:155],a[160:163],v[220:223]
s_barrier
M v[252:255],a[152:155],a[168:171],v[252:255]
R a[160:163],v5,32768
R a[164:167],v6,32768
M v[252:255],a[156:159],a[172:175],v[252:255]
M v[248:251],a[148:151],a[172:175],v[248:251]
M v[248:251],a[144:147],a[168:171],v[248:251]
M v[244:247],a[136:139],a[168:171],v[244:247]
M v[244:247],a[140:143],a[172:175],v[244:247]
M v[240:243],a[132:135],a[172:175],v[240:243]
M v[240:243],a[128:131],a[168:171],v[240:243]
M v[236:239],a[120:123],a[168:171],v[236:239]
M v[236:239],a[124:127],a[172:175],v[236:239]
M v[232:235],a[116:119],a[172:175],v[232:235]
M v[232:235],a[112:115],a[168:171],v[232:235]
M v[228:231],a[104:107],a[168:171],v[228:231]
M v[228:231],a[108:111],a[172:175],v[228:231]
s_waitcnt lgkmcnt(0)
M v[224:227],a[100:103],a[172:175],v[224:227]
M v[224:227],a[96:99],a[168:171],v[224:227]
M a[0:3],a[32:35],a[160:163],a[0:3]
R a[168:171],v5,34816
R a[172:175],v6,34816
M a[0:3],a[36:39],a[164:167],a[0:3]
SA m0,s23,147456
T a[96:97],v1,0
T a[98:99],v1,1024
M a[4:7],a[44:47],a[164:167],a[4:7]
buffer_load_dwordx4 v22, s[56:59], s29 offen offset:0 lds
M a[4:7],a[40:43],a[160:163],a[4:7]
M a[8:11],a[48:51],a[160:163],a[8:11]
M a[8:11],a[52:55],a[164:167],a[8:11]
buffer_load_dwordx4 v23, s[56:59], s29 offen offset:1024 lds
M a[12:15],a[60:63],a[164:167],a[12:15]
s_nop 0
T a[100:101],v1,8192
T a[102:103],v1,9216
M a[12:15],a[56:59],a[160:163],a[12:15]
M a[16:19],a[64:67],a[160:163],a[16:19]
buffer_load_dwordx4 v22, s[56:59], s30 offen offset:2048 lds
M a[16:19],a[68:71],a[164:167],a[16:19]
M a[20:23],a[76:79],a[164:167],a[20:23]
M a[20:23],a[72:75],a[160:163],a[20:23]
s_nop 0
T a[104:105],v2,0
T a[106:107],v2,1024
M a[24:27],a[80:83],a[160:163],a[24:27]
buffer_load_dwordx4 v23, s[56:59], s30 offen offset:3072 lds
M a[24:27],a[84:87],a[164:167],a[24:27]
s_waitcnt lgkmcnt(6)
M a[28:31],a[92:95],a[164:167],a[28:31]
SA s29,s29,128
M a[28:31],a[88:91],a[160:163],a[28:31]
SA s30,s30,128
M v[60:63],a[88:91],a[168:171],v[60:63]
SA m0,s24,16384
R a[160:163],v5,36864
R a[164:167],v6,36864
M v[60:63],a[92:95],a[172:175],v[60:63]
T a[108:109],v2,8192
T a[110:111],v2,9216
M v[56:59],a[84:87],a[172:175],v[56:59]
buffer_load_dwordx4 v12, s[48:51], s22 offen offset:0   lds
M v[56:59],a[80:83],a[168:171],v[56:59]
M v[52:55],a[72:75],a[168:171],v[52:55]
M v[52:55],a[76:79],a[172:175],v[52:55]
s_nop 0
T a[112:113],v3,0
T a[114:115],v3,1024
M v[48:51],a[68:71],a[172:175],v[48:51]
buffer_load_dwordx4 v13, s[48:51], s22 offen offset:1024   lds
M v[48:51],a[64:67],a[168:171],v[48:51]
M v[44:47],a[56:59],a[168:171],v[44:47]
M v[44:47],a[60:63],a[172:175],v[44:47]
buffer_load_dwordx4 v14, s[48:51], s22 offen offset:2048   lds
M v[40:43],a[52:55],a[172:175],v[40:43]
s_nop 0
T a[116:117],v3,8192
T a[118:119],v3,9216
M v[40:43],a[48:51],a[168:171],v[40:43]
M v[36:39],a[40:43],a[168:171],v[36:39]
buffer_load_dwordx4 v15, s[48:51], s22 offen offset:3072   lds
M v[36:39],a[44:47],a[172:175],v[36:39]
s_waitcnt lgkmcnt(6)
M v[32:35],a[36:39],a[172:175],v[32:35]
s_sub_u32 s22, s22, 1048448
M v[32:35],a[32:35],a[168:171],v[32:35]
SA m0,s23,49152
T a[120:121],v4,0
T a[122:123],v4,1024
M v[64:67],a[32:35],a[160:163],v[64:67]
R a[168:171],v5,38912
R a[172:175],v6,38912
M v[64:67],a[36:39],a[164:167],v[64:67]
buffer_load_dwordx4 v8, s[16:19], s21 offen offset:0   lds
M v[68:71],a[44:47],a[164:167],v[68:71]
M v[68:71],a[40:43],a[160:163],v[68:71]
M v[72:75],a[48:51],a[160:163],v[72:75]
s_waitcnt vmcnt(17)
s_nop 0
T a[124:125],v4,8192
T a[126:127],v4,9216
M v[72:75],a[52:55],a[164:167],v[72:75]
buffer_load_dwordx4 v9, s[16:19], s21 offen offset:1024   lds
M v[76:79],a[60:63],a[164:167],v[76:79]
R a[176:179],v20,0
R a[180:183],v20,2048
M v[76:79],a[56:59],a[160:163],v[76:79]
R a[184:187],v21,0
R a[188:191],v21,2048
M v[80:83],a[64:67],a[160:163],v[80:83]
buffer_load_dwordx4 v10, s[16:19], s21 offen offset:2048   lds
M v[80:83],a[68:71],a[164:167],v[80:83]
M v[84:87],a[76:79],a[164:167],v[84:87]
M v[84:87],a[72:75],a[160:163],v[84:87]
buffer_load_dwordx4 v11, s[16:19], s21 offen offset:3072   lds
M v[88:91],a[80:83],a[160:163],v[88:91]
SA s21,s21,524160
M v[88:91],a[84:87],a[164:167],v[88:91]
s_waitcnt lgkmcnt(6)
M v[92:95],a[92:95],a[164:167],v[92:95]
s_waitcnt lgkmcnt(0)
M v[92:95],a[88:91],a[160:163],v[92:95]
s_barrier
M v[124:127],a[88:91],a[168:171],v[124:127]
s_lshl_b32 s4, s20, 10
R a[160:163],v5,49152
R a[164:167],v6,49152
M v[124:127],a[92:95],a[172:175],v[124:127]
SA m0,s23,131072
v_bfe_u32 v28, v0, 3, 2
M v[120:123],a[84:87],a[172:175],v[120:123]
s_nop 0
T a[128:129],v1,16384
T a[130:131],v1,17408
M v[120:123],a[80:83],a[168:171],v[120:123]
buffer_load_dwordx4 v22, s[56:59], s29 offen offset:0 lds
M v[116:119],a[72:75],a[168:171],v[116:119]
v_lshrrev_b32 v29, 5, v0
v_lshl_add_u32 v28, v29, 3, v28
M v[116:119],a[76:79],a[172:175],v[116:119]
M v[112:115],a[68:71],a[172:175],v[112:115]
v_lshlrev_b32 v28, 13, v28
M v[112:115],a[64:67],a[168:171],v[112:115]
M v[108:111],a[56:59],a[168:171],v[108:111]
buffer_load_dwordx4 v23, s[56:59], s29 offen offset:1024 lds
M v[108:111],a[60:63],a[172:175],v[108:111]
s_nop 0
T a[132:133],v1,24576
T a[134:135],v1,25600
M v[104:107],a[52:55],a[172:175],v[104:107]
v_lshrrev_b32 v29, 4, v0
v_lshlrev_b32 v29, 1, v29
M v[104:107],a[48:51],a[168:171],v[104:107]
M v[100:103],a[40:43],a[168:171],v[100:103]
v_and_b32 v30, 7, v0
M v[100:103],a[44:47],a[172:175],v[100:103]
s_waitcnt lgkmcnt(4)
M v[96:99],a[36:39],a[172:175],v[96:99]
v_xor_b32 v29, v29, v30
M v[96:99],a[32:35],a[168:171],v[96:99]
buffer_load_dwordx4 v22, s[56:59], s30 offen offset:2048 lds
M v[128:131],a[32:35],a[160:163],v[128:131]
R a[168:171],v5,51200
R a[172:175],v6,51200
M v[128:131],a[36:39],a[164:167],v[128:131]
T a[136:137],v2,16384
T a[138:139],v2,17408
M v[132:135],a[44:47],a[164:167],v[132:135]
v_lshl_add_u32 v28, v29, 4, v28
M v[132:135],a[40:43],a[160:163],v[132:135]
s_and_b32 s64, s20, 1
M v[136:139],a[48:51],a[160:163],v[136:139]
s_lshl_b32 s64, s64, 17
M v[136:139],a[52:55],a[164:167],v[136:139]
s_lshr_b32 s65, s20, 1
M v[140:143],a[60:63],a[164:167],v[140:143]
s_lshl_b32 s65, s65, 15
SA s64,s64,s65
v_add_u32 v8, s64, v28
M v[140:143],a[56:59],a[160:163],v[140:143]
s_nop 0
T a[140:141],v2,24576
T a[142:143],v2,25600
M v[144:147],a[64:67],a[160:163],v[144:147]
buffer_load_dwordx4 v23, s[56:59], s30 offen offset:3072 lds
M v[144:147],a[68:71],a[164:167],v[144:147]
M v[148:151],a[76:79],a[164:167],v[148:151]
SA s29,s29,128
M v[148:151],a[72:75],a[160:163],v[148:151]
SA s30,s30,128
M v[152:155],a[80:83],a[160:163],v[152:155]
SA m0,s24,32768
M v[152:155],a[84:87],a[164:167],v[152:155]
s_waitcnt lgkmcnt(4)
buffer_load_dwordx4 v12, s[48:51], s22 offen offset:0   lds
M v[156:159],a[92:95],a[164:167],v[156:159]
s_nop 0
T a[144:145],v3,16384
T a[146:147],v3,17408
M v[156:159],a[88:91],a[160:163],v[156:159]
M v[188:191],a[88:91],a[168:171],v[188:191]
R a[160:163],v5,53248
R a[164:167],v6,53248
M v[188:191],a[92:95],a[172:175],v[188:191]
M v[184:187],a[84:87],a[172:175],v[184:187]
M v[184:187],a[80:83],a[168:171],v[184:187]
M v[180:183],a[72:75],a[168:171],v[180:183]
buffer_load_dwordx4 v13, s[48:51], s22 offen offset:1024   lds
M v[180:183],a[76:79],a[172:175],v[180:183]
s_nop 0
T a[148:149],v3,24576
T a[150:151],v3,25600
M v[176:179],a[68:71],a[172:175],v[176:179]
M v[176:179],a[64:67],a[168:171],v[176:179]
M v[172:175],a[56:59],a[168:171],v[172:175]
M v[172:175],a[60:63],a[172:175],v[172:175]
M v[168:171],a[52:55],a[172:175],v[168:171]
M v[168:171],a[48:51],a[168:171],v[168:171]
buffer_load_dwordx4 v14, s[48:51], s22 offen offset:2048   lds
M v[164:167],a[40:43],a[168:171],v[164:167]
s_nop 0
T a[152:153],v4,16384
T a[154:155],v4,17408
M v[164:167],a[44:47],a[172:175],v[164:167]
s_waitcnt lgkmcnt(4)
M v[160:163],a[36:39],a[172:175],v[160:163]
M v[160:163],a[32:35],a[168:171],v[160:163]
M v[192:195],a[32:35],a[160:163],v[192:195]
R a[168:171],v5,55296
R a[172:175],v6,55296
M v[192:195],a[36:39],a[164:167],v[192:195]
M v[196:199],a[44:47],a[164:167],v[196:199]
buffer_load_dwordx4 v15, s[48:51], s22 offen offset:3072   lds
M v[196:199],a[40:43],a[160:163],v[196:199]
s_nop 0
T a[156:157],v4,24576
T a[158:159],v4,25600
M v[200:203],a[48:51],a[160:163],v[200:203]
s_waitcnt vmcnt(16)
R a[192:195],v20,16384
R a[196:199],v20,18432
M v[200:203],a[52:55],a[164:167],v[200:203]
R a[200:203],v21,16384
R a[204:207],v21,18432
M v[204:207],a[60:63],a[164:167],v[204:207]
M v[204:207],a[56:59],a[160:163],v[204:207]
M v[208:211],a[64:67],a[160:163],v[208:211]
M v[208:211],a[68:71],a[164:167],v[208:211]
M v[212:215],a[76:79],a[164:167],v[212:215]
SA s22,s22,1048576
M v[212:215],a[72:75],a[160:163],v[212:215]
M v[216:219],a[80:83],a[160:163],v[216:219]
M v[216:219],a[84:87],a[164:167],v[216:219]
s_waitcnt lgkmcnt(6)
M v[220:223],a[92:95],a[164:167],v[220:223]
s_waitcnt lgkmcnt(0)
M v[220:223],a[88:91],a[160:163],v[220:223]
s_barrier
M v[252:255],a[88:91],a[168:171],v[252:255]
R a[160:163],v5,0
R a[164:167],v6,0
M v[252:255],a[92:95],a[172:175],v[252:255]
M v[248:251],a[84:87],a[172:175],v[248:251]
M v[248:251],a[80:83],a[168:171],v[248:251]
M v[244:247],a[72:75],a[168:171],v[244:247]
M v[244:247],a[76:79],a[172:175],v[244:247]
M v[240:243],a[68:71],a[172:175],v[240:243]
M v[240:243],a[64:67],a[168:171],v[240:243]
M v[236:239],a[56:59],a[168:171],v[236:239]
M v[236:239],a[60:63],a[172:175],v[236:239]
M v[232:235],a[52:55],a[172:175],v[232:235]
M v[232:235],a[48:51],a[168:171],v[232:235]
M v[228:231],a[40:43],a[168:171],v[228:231]
M v[228:231],a[44:47],a[172:175],v[228:231]
s_waitcnt lgkmcnt(0)
M v[224:227],a[36:39],a[172:175],v[224:227]
M v[224:227],a[32:35],a[168:171],v[224:227]
M a[0:3],a[96:99],a[160:163],a[0:3]
R a[168:171],v5,2048
R a[172:175],v6,2048
M a[0:3],a[100:103],a[164:167],a[0:3]
SA m0,s23,147456
T a[32:33],v1,32768
T a[34:35],v1,33792
M a[4:7],a[108:111],a[164:167],a[4:7]
buffer_load_dwordx4 v22, s[56:59], s29 offen offset:0 lds
M a[4:7],a[104:107],a[160:163],a[4:7]
M a[8:11],a[112:115],a[160:163],a[8:11]
M a[8:11],a[116:119],a[164:167],a[8:11]
buffer_load_dwordx4 v23, s[56:59], s29 offen offset:1024 lds
M a[12:15],a[124:127],a[164:167],a[12:15]
s_nop 0
T a[36:37],v1,40960
T a[38:39],v1,41984
M a[12:15],a[120:123],a[160:163],a[12:15]
M a[16:19],a[128:131],a[160:163],a[16:19]
buffer_load_dwordx4 v22, s[56:59], s30 offen offset:2048 lds
M a[16:19],a[132:135],a[164:167],a[16:19]
M a[20:23],a[140:143],a[164:167],a[20:23]
M a[20:23],a[136:139],a[160:163],a[20:23]
s_nop 0
T a[40:41],v2,32768
T a[42:43],v2,33792
M a[24:27],a[144:147],a[160:163],a[24:27]
buffer_load_dwordx4 v23, s[56:59], s30 offen offset:3072 lds
M a[24:27],a[148:151],a[164:167],a[24:27]
s_waitcnt lgkmcnt(6)
M a[28:31],a[156:159],a[164:167],a[28:31]
SA s29,s29,128
M a[28:31],a[152:155],a[160:163],a[28:31]
SA s30,s30,128
M v[60:63],a[152:155],a[168:171],v[60:63]
SA m0,s24,49152
R a[160:163],v5,4096
R a[164:167],v6,4096
M v[60:63],a[156:159],a[172:175],v[60:63]
T a[44:45],v2,40960
T a[46:47],v2,41984
M v[56:59],a[148:151],a[172:175],v[56:59]
buffer_load_dwordx4 v12, s[48:51], s22 offen offset:0   lds
M v[56:59],a[144:147],a[168:171],v[56:59]
M v[52:55],a[136:139],a[168:171],v[52:55]
M v[52:55],a[140:143],a[172:175],v[52:55]
s_nop 0
T a[48:49],v3,32768
T a[50:51],v3,33792
M v[48:51],a[132:135],a[172:175],v[48:51]
buffer_load_dwordx4 v13, s[48:51], s22 offen offset:1024   lds
M v[48:51],a[128:131],a[168:171],v[48:51]
M v[44:47],a[120:123],a[168:171],v[44:47]
M v[44:47],a[124:127],a[172:175],v[44:47]
buffer_load_dwordx4 v14, s[48:51], s22 offen offset:2048   lds
M v[40:43],a[116:119],a[172:175],v[40:43]
s_nop 0
T a[52:53],v3,40960
T a[54:55],v3,41984
M v[40:43],a[112:115],a[168:171],v[40:43]
M v[36:39],a[104:107],a[168:171],v[36:39]
buffer_load_dwordx4 v15, s[48:51], s22 offen offset:3072   lds
M v[36:39],a[108:111],a[172:175],v[36:39]
s_waitcnt lgkmcnt(6)
M v[32:35],a[100:103],a[172:175],v[32:35]
s_sub_u32 s22, s22, 1048448
M v[32:35],a[96:99],a[168:171],v[32:35]
s_mov_b32 s25, 0
T a[56:57],v4,32768
T a[58:59],v4,33792
M v[64:67],a[96:99],a[160:163],v[64:67]
SA m0,s4,0
R a[168:171],v5,6144
R a[172:175],v6,6144
M v[64:67],a[100:103],a[164:167],v[64:67]
buffer_load_dwordx4 v8, s[52:55], s25 offen lds
M v[68:71],a[108:111],a[164:167],v[68:71]
s_mov_b32 s25, 262144
M v[68:71],a[104:107],a[160:163],v[68:71]
SA m0,s4,4096
M v[72:75],a[112:115],a[160:163],v[72:75]
s_waitcnt vmcnt(13)
s_nop 0
T a[60:61],v4,40960
T a[62:63],v4,41984
M v[72:75],a[116:119],a[164:167],v[72:75]
buffer_load_dwordx4 v8, s[52:55], s25 offen lds
M v[76:79],a[124:127],a[164:167],v[76:79]
s_mov_b32 s25, 524288
R a[208:211],v20,0
R a[212:215],v20,2048
M v[76:79],a[120:123],a[160:163],v[76:79]
SA m0,s4,8192
R a[216:219],v21,0
R a[220:223],v21,2048
M v[80:83],a[128:131],a[160:163],v[80:83]
buffer_load_dwordx4 v8, s[52:55], s25 offen lds
M v[80:83],a[132:135],a[164:167],v[80:83]
s_mov_b32 s25, 786432
M v[84:87],a[140:143],a[164:167],v[84:87]
SA m0,s4,12288
M v[84:87],a[136:139],a[160:163],v[84:87]
buffer_load_dwordx4 v8, s[52:55], s25 offen lds
M v[88:91],a[144:147],a[160:163],v[88:91]
M v[88:91],a[148:151],a[164:167],v[88:91]
s_waitcnt lgkmcnt(6)
M v[92:95],a[156:159],a[164:167],v[92:95]
s_waitcnt lgkmcnt(0)
M v[92:95],a[152:155],a[160:163],v[92:95]
s_barrier
M v[124:127],a[152:155],a[168:171],v[124:127]
R a[160:163],v5,16384
R a[164:167],v6,16384
M v[124:127],a[156:159],a[172:175],v[124:127]
SA m0,s23,32768
M v[120:123],a[148:151],a[172:175],v[120:123]
s_nop 0
T a[64:65],v1,49152
T a[66:67],v1,50176
M v[120:123],a[144:147],a[168:171],v[120:123]
buffer_load_dwordx4 v22, s[56:59], s29 offen offset:0 lds
M v[116:119],a[136:139],a[168:171],v[116:119]
v_lshrrev_b32 v28, 2, v0
v_lshlrev_b32 v28, 7, v28
M v[116:119],a[140:143],a[172:175],v[116:119]
M v[112:115],a[132:135],a[172:175],v[112:115]
buffer_load_dwordx4 v23, s[56:59], s29 offen offset:1024 lds
M v[112:115],a[128:131],a[168:171],v[112:115]
v_and_b32 v29, 3, v0
M v[108:111],a[120:123],a[168:171],v[108:111]
v_lshl_add_u32 v28, v29, 3, v28
M v[108:111],a[124:127],a[172:175],v[108:111]
s_nop 0
T a[68:69],v1,57344
T a[70:71],v1,58368
M v[104:107],a[116:119],a[172:175],v[104:107]
buffer_load_dwordx4 v22, s[56:59], s30 offen offset:2048 lds
M v[104:107],a[112:115],a[168:171],v[104:107]
v_bfe_u32 v29, v0, 3, 2
M v[100:103],a[104:107],a[168:171],v[100:103]
M v[100:103],a[108:111],a[172:175],v[100:103]
s_waitcnt lgkmcnt(4)
v_lshl_add_u32 v16, v29, 5, v28
M v[96:99],a[100:103],a[172:175],v[96:99]
M v[96:99],a[96:99],a[168:171],v[96:99]
buffer_load_dwordx4 v23, s[56:59], s30 offen offset:3072 lds
M v[128:131],a[96:99],a[160:163],v[128:131]
R a[168:171],v5,18432
R a[172:175],v6,18432
M v[128:131],a[100:103],a[164:167],v[128:131]
SA s29,s29,128
T a[72:73],v2,49152
T a[74:75],v2,50176
M v[132:135],a[108:111],a[164:167],v[132:135]
SA s30,s30,128
v_xor_b32 v17, 32, v16
v_xor_b32 v18, 64, v16
M v[132:135],a[104:107],a[160:163],v[132:135]
SA m0,s23,65536
M v[136:139],a[112:115],a[160:163],v[136:139]
buffer_load_dwordx4 v22, s[56:59], s29 offen offset:0 lds
M v[136:139],a[116:119],a[164:167],v[136:139]
v_xor_b32 v19, 0x60, v16
M v[140:143],a[124:127],a[164:167],v[140:143]
v_add_u32 v12, 0x20000, v16
M v[140:143],a[120:123],a[160:163],v[140:143]
s_nop 0
T a[76:77],v2,57344
T a[78:79],v2,58368
M v[144:147],a[128:131],a[160:163],v[144:147]
buffer_load_dwordx4 v23, s[56:59], s29 offen offset:1024 lds
M v[144:147],a[132:135],a[164:167],v[144:147]
v_add_u32 v13, 0x20000, v17
M v[148:151],a[140:143],a[164:167],v[148:151]
M v[148:151],a[136:139],a[160:163],v[148:151]
v_add_u32 v14, 0x20000, v18
M v[152:155],a[144:147],a[160:163],v[152:155]
M v[152:155],a[148:151],a[164:167],v[152:155]
s_waitcnt lgkmcnt(4)
buffer_load_dwordx4 v22, s[56:59], s30 offen offset:2048 lds
M v[156:159],a[156:159],a[164:167],v[156:159]
s_nop 0
T a[80:81],v3,49152
T a[82:83],v3,50176
M v[156:159],a[152:155],a[160:163],v[156:159]
v_add_u32 v15, 0x20000, v19
M v[188:191],a[152:155],a[168:171],v[188:191]
R a[160:163],v5,20480
R a[164:167],v6,20480
M v[188:191],a[156:159],a[172:175],v[188:191]
M v[184:187],a[148:151],a[172:175],v[184:187]
buffer_load_dwordx4 v23, s[56:59], s30 offen offset:3072 lds
M v[184:187],a[144:147],a[168:171],v[184:187]
SA s29,s29,128
M v[180:183],a[136:139],a[168:171],v[180:183]
SA s30,s30,128
M v[180:183],a[140:143],a[172:175],v[180:183]
s_mov_b32 s25, 1048576
T a[84:85],v3,57344
T a[86:87],v3,58368
M v[176:179],a[132:135],a[172:175],v[176:179]
SA m0,s4,16384
M v[176:179],a[128:131],a[168:171],v[176:179]
buffer_load_dwordx4 v8, s[52:55], s25 offen lds
M v[172:175],a[120:123],a[168:171],v[172:175]
M v[172:175],a[124:127],a[172:175],v[172:175]
s_mov_b32 s25, 1310720
M v[168:171],a[116:119],a[172:175],v[168:171]
SA m0,s4,20480
M v[168:171],a[112:115],a[168:171],v[168:171]
buffer_load_dwordx4 v8, s[52:55], s25 offen lds
M v[164:167],a[104:107],a[168:171],v[164:167]
s_nop 0
T a[88:89],v4,49152
T a[90:91],v4,50176
M v[164:167],a[108:111],a[172:175],v[164:167]
s_waitcnt lgkmcnt(4)
M v[160:163],a[100:103],a[172:175],v[160:163]
s_mov_b32 s25, 1572864
M v[160:163],a[96:99],a[168:171],v[160:163]
SA m0,s4,24576
M v[192:195],a[96:99],a[160:163],v[192:195]
R a[168:171],v5,22528
R a[172:175],v6,22528
M v[192:195],a[100:103],a[164:167],v[192:195]
buffer_load_dwordx4 v8, s[52:55], s25 offen lds
M v[196:199],a[108:111],a[164:167],v[196:199]
M v[196:199],a[104:107],a[160:163],v[196:199]
s_mov_b32 s25, 1835008
T a[92:93],v4,57344
T a[94:95],v4,58368
M v[200:203],a[112:115],a[160:163],v[200:203]
SA m0,s4,28672
M v[200:203],a[116:119],a[164:167],v[200:203]
s_waitcnt vmcnt(19)
L_w_kv07:
s_cbranch_execz L_wd1
buffer_load_dwordx4 v8, s[52:55], s25 offen lds
M v[204:207],a[124:127],a[164:167],v[204:207]
R a[224:227],v20,16384
R a[228:231],v20,18432
M v[204:207],a[120:123],a[160:163],v[204:207]
R a[232:235],v21,16384
R a[236:239],v21,18432
M v[208:211],a[128:131],a[160:163],v[208:211]
v_subrev_u32 v20, 98304, v20
v_subrev_u32 v21, 98304, v21
M v[208:211],a[132:135],a[164:167],v[208:211]
M v[212:215],a[140:143],a[164:167],v[212:215]
M v[212:215],a[136:139],a[160:163],v[212:215]
M v[216:219],a[144:147],a[160:163],v[216:219]
M v[216:219],a[148:151],a[164:167],v[216:219]
s_waitcnt lgkmcnt(6)
M v[220:223],a[156:159],a[164:167],v[220:223]
s_waitcnt lgkmcnt(0)
M v[220:223],a[152:155],a[160:163],v[220:223]
s_barrier
M v[252:255],a[152:155],a[168:171],v[252:255]
R a[160:163],v5,32768
R a[164:167],v6,32768
M v[252:255],a[156:159],a[172:175],v[252:255]
M v[248:251],a[148:151],a[172:175],v[248:251]
M v[248:251],a[144:147],a[168:171],v[248:251]
M v[244:247],a[136:139],a[168:171],v[244:247]
M v[244:247],a[140:143],a[172:175],v[244:247]
M v[240:243],a[132:135],a[172:175],v[240:243]
M v[240:243],a[128:131],a[168:171],v[240:243]
M v[236:239],a[120:123],a[168:171],v[236:239]
M v[236:239],a[124:127],a[172:175],v[236:239]
M v[232:235],a[116:119],a[172:175],v[232:235]
M v[232:235],a[112:115],a[168:171],v[232:235]
M v[228:231],a[104:107],a[168:171],v[228:231]
M v[228:231],a[108:111],a[172:175],v[228:231]
s_waitcnt lgkmcnt(0)
M v[224:227],a[100:103],a[172:175],v[224:227]
M v[224:227],a[96:99],a[168:171],v[224:227]
M a[0:3],a[32:35],a[160:163],a[0:3]
R a[168:171],v5,34816
R a[172:175],v6,34816
M a[0:3],a[36:39],a[164:167],a[0:3]
SA m0,s23,81920
M a[4:7],a[44:47],a[164:167],a[4:7]
buffer_load_dwordx4 v22, s[56:59], s29 offen offset:0 lds
M a[4:7],a[40:43],a[160:163],a[4:7]
M a[8:11],a[48:51],a[160:163],a[8:11]
M a[8:11],a[52:55],a[164:167],a[8:11]
buffer_load_dwordx4 v23, s[56:59], s29 offen offset:1024 lds
M a[12:15],a[60:63],a[164:167],a[12:15]
M a[12:15],a[56:59],a[160:163],a[12:15]
G v24,a0
G v25,a1
M a[16:19],a[64:67],a[160:163],a[16:19]
G v26,a2
G v27,a3
M a[16:19],a[68:71],a[164:167],a[16:19]
buffer_load_dwordx4 v22, s[56:59], s30 offen offset:2048 lds
M a[20:23],a[76:79],a[164:167],a[20:23]
G v28,a4
G v29,a5
M a[20:23],a[72:75],a[160:163],a[20:23]
G v30,a6
G v31,a7
M a[24:27],a[80:83],a[160:163],a[24:27]
C v24,v24,v25
C v25,v26,v27
M a[24:27],a[84:87],a[164:167],a[24:27]
s_waitcnt lgkmcnt(0)
buffer_load_dwordx4 v23, s[56:59], s30 offen offset:3072 lds
M a[28:31],a[92:95],a[164:167],a[28:31]
SA s29,s29,128
C v26,v28,v29
C v27,v30,v31
M a[28:31],a[88:91],a[160:163],a[28:31]
SA s3,s93,0
buffer_store_dwordx4 v[24:27], v7, s[8:11], s3 offen offset:0 sc1
M v[32:35],a[32:35],a[168:171],v[32:35]
SA s30,s30,128
R a[160:163],v5,36864
R a[164:167],v6,36864
M v[32:35],a[36:39],a[172:175],v[32:35]
s_mov_b32 s25, 2097152
G v24,a8
G v25,a9
M v[36:39],a[44:47],a[172:175],v[36:39]
SA m0,s4,131072
G v26,a10
G v27,a11
M v[36:39],a[40:43],a[168:171],v[36:39]
buffer_load_dwordx4 v8, s[52:55], s25 offen lds
M v[40:43],a[48:51],a[168:171],v[40:43]
s_mov_b32 s25, 2359296
G v28,a12
G v29,a13
M v[40:43],a[52:55],a[172:175],v[40:43]
SA m0,s4,135168
G v30,a14
G v31,a15
M v[44:47],a[60:63],a[172:175],v[44:47]
buffer_load_dwordx4 v8, s[52:55], s25 offen lds
M v[44:47],a[56:59],a[168:171],v[44:47]
s_mov_b32 s25, 2621440
C v24,v24,v25
C v25,v26,v27
M v[48:51],a[64:67],a[168:171],v[48:51]
SA m0,s4,139264
C v26,v28,v29
C v27,v30,v31
M v[48:51],a[68:71],a[172:175],v[48:51]
buffer_store_dwordx4 v[24:27], v7, s[8:11], s3 offen offset:1024 sc1
M v[52:55],a[76:79],a[172:175],v[52:55]
s_nop 0
G v24,a16
G v25,a17
M v[52:55],a[72:75],a[168:171],v[52:55]
G v26,a18
G v27,a19
M v[56:59],a[80:83],a[168:171],v[56:59]
buffer_load_dwordx4 v8, s[52:55], s25 offen lds
M v[56:59],a[84:87],a[172:175],v[56:59]
s_waitcnt lgkmcnt(0)
G v28,a20
G v29,a21
M v[60:63],a[92:95],a[172:175],v[60:63]
s_mov_b32 s25, 2883584
G v30,a22
G v31,a23
M v[60:63],a[88:91],a[168:171],v[60:63]
SA m0,s4,143360
C v24,v24,v25
C v25,v26,v27
M v[64:67],a[32:35],a[160:163],v[64:67]
s_waitcnt vmcnt(17)
R a[168:171],v5,38912
R a[172:175],v6,38912
M v[64:67],a[36:39],a[164:167],v[64:67]
buffer_load_dwordx4 v8, s[52:55], s25 offen lds
M v[68:71],a[44:47],a[164:167],v[68:71]
s_mov_b32 s25, 3145728
C v26,v28,v29
C v27,v30,v31
M v[68:71],a[40:43],a[160:163],v[68:71]
SA m0,s4,147456
buffer_store_dwordx4 v[24:27], v7, s[8:11], s3 offen offset:2048 sc1
M v[72:75],a[48:51],a[160:163],v[72:75]
R a[96:99],v20,0
R a[100:103],v20,2048
M v[72:75],a[52:55],a[164:167],v[72:75]
R a[104:107],v21,0
R a[108:111],v21,2048
M v[76:79],a[60:63],a[164:167],v[76:79]
buffer_load_dwordx4 v8, s[52:55], s25 offen lds
M v[76:79],a[56:59],a[160:163],v[76:79]
s_mov_b32 s25, 3407872
G v24,a24
G v25,a25
M v[80:83],a[64:67],a[160:163],v[80:83]
SA m0,s4,151552
G v26,a26
G v27,a27
M v[80:83],a[68:71],a[164:167],v[80:83]
buffer_load_dwordx4 v8, s[52:55], s25 offen lds
M v[84:87],a[76:79],a[164:167],v[84:87]
G v28,a28
G v29,a29
M v[84:87],a[72:75],a[160:163],v[84:87]
G v30,a30
G v31,a31
M v[88:91],a[80:83],a[160:163],v[88:91]
C v24,v24,v25
C v25,v26,v27
M v[88:91],a[84:87],a[164:167],v[88:91]
s_waitcnt lgkmcnt(4)
C v26,v28,v29
C v27,v30,v31
M v[92:95],a[92:95],a[164:167],v[92:95]
s_waitcnt lgkmcnt(0)
buffer_store_dwordx4 v[24:27], v7, s[8:11], s3 offen offset:3072 sc1
M v[92:95],a[88:91],a[160:163],v[92:95]
s_barrier
M v[96:99],a[32:35],a[168:171],v[96:99]
R a[160:163],v5,49152
R a[164:167],v6,49152
M v[96:99],a[36:39],a[172:175],v[96:99]
s_mov_b32 s25, 128
C v64,v64,v65
C v65,v66,v67
M v[100:103],a[44:47],a[172:175],v[100:103]
SA m0,s4,49152
C v66,v68,v69
C v67,v70,v71
M v[100:103],a[40:43],a[168:171],v[100:103]
s_waitcnt vmcnt(18)
buffer_load_dwordx4 v8, s[52:55], s25 offen lds
M v[104:107],a[48:51],a[168:171],v[104:107]
C v72,v72,v73
C v73,v74,v75
M v[104:107],a[52:55],a[172:175],v[104:107]
C v74,v76,v77
C v75,v78,v79
M v[108:111],a[60:63],a[172:175],v[108:111]
C v32,v32,v33
C v33,v34,v35
M v[108:111],a[56:59],a[168:171],v[108:111]
C v34,v36,v37
C v35,v38,v39
M v[112:115],a[64:67],a[168:171],v[112:115]
SA s3,s93,8192
buffer_store_dwordx4 v[32:35], v7, s[8:11], s3 offen offset:0 sc1
M v[112:115],a[68:71],a[172:175],v[112:115]
s_mov_b32 s25, 262272
C v80,v80,v81
C v81,v82,v83
M v[116:119],a[76:79],a[172:175],v[116:119]
SA m0,s4,53248
C v82,v84,v85
C v83,v86,v87
M v[116:119],a[72:75],a[168:171],v[116:119]
R a[112:115],v20,32768
R a[116:119],v20,34816
M v[120:123],a[80:83],a[168:171],v[120:123]
buffer_load_dwordx4 v8, s[52:55], s25 offen lds
M v[120:123],a[84:87],a[172:175],v[120:123]
s_waitcnt lgkmcnt(2)
R a[120:123],v21,32768
R a[124:127],v21,34816
M v[124:127],a[92:95],a[172:175],v[124:127]
C v88,v88,v89
C v89,v90,v91
M v[124:127],a[88:91],a[168:171],v[124:127]
C v90,v92,v93
C v91,v94,v95
M v[128:131],a[32:35],a[160:163],v[128:131]
R a[168:171],v5,51200
R a[172:175],v6,51200
M v[128:131],a[36:39],a[164:167],v[128:131]
C v40,v40,v41
C v41,v42,v43
M v[132:135],a[44:47],a[164:167],v[132:135]
C v42,v44,v45
C v43,v46,v47
M v[132:135],a[40:43],a[160:163],v[132:135]
s_mov_b32 s25, 524416
buffer_store_dwordx4 v[40:43], v7, s[8:11], s3 offen offset:1024 sc1
M v[136:139],a[48:51],a[160:163],v[136:139]
SA m0,s4,57344
C v96,v96,v97
C v97,v98,v99
M v[136:139],a[52:55],a[164:167],v[136:139]
C v98,v100,v101
C v99,v102,v103
M v[140:143],a[60:63],a[164:167],v[140:143]
C v104,v104,v105
C v105,v106,v107
M v[140:143],a[56:59],a[160:163],v[140:143]
buffer_load_dwordx4 v8, s[52:55], s25 offen lds
M v[144:147],a[64:67],a[160:163],v[144:147]
C v106,v108,v109
C v107,v110,v111
M v[144:147],a[68:71],a[164:167],v[144:147]
C v112,v112,v113
C v113,v114,v115
M v[148:151],a[76:79],a[164:167],v[148:151]
C v114,v116,v117
C v115,v118,v119
M v[148:151],a[72:75],a[160:163],v[148:151]
C v48,v48,v49
C v49,v50,v51
M v[152:155],a[80:83],a[160:163],v[152:155]
C v50,v52,v53
C v51,v54,v55
M v[152:155],a[84:87],a[164:167],v[152:155]
s_waitcnt lgkmcnt(0)
buffer_store_dwordx4 v[48:51], v7, s[8:11], s3 offen offset:2048 sc1
M v[156:159],a[92:95],a[164:167],v[156:159]
s_mov_b32 s25, 786560
C v120,v120,v121
C v121,v122,v123
M v[156:159],a[88:91],a[160:163],v[156:159]
SA m0,s4,61440
C v122,v124,v125
C v123,v126,v127
M v[160:163],a[32:35],a[168:171],v[160:163]
R a[160:163],v5,53248
R a[164:167],v6,53248
M v[160:163],a[36:39],a[172:175],v[160:163]
buffer_load_dwordx4 v8, s[52:55], s25 offen lds
M v[164:167],a[44:47],a[172:175],v[164:167]
C v128,v128,v129
C v129,v130,v131
M v[164:167],a[40:43],a[168:171],v[164:167]
C v130,v132,v133
C v131,v134,v135
M v[168:171],a[48:51],a[168:171],v[168:171]
C v56,v56,v57
C v57,v58,v59
M v[168:171],a[52:55],a[172:175],v[168:171]
C v58,v60,v61
C v59,v62,v63
M v[172:175],a[60:63],a[172:175],v[172:175]
buffer_store_dwordx4 v[56:59], v7, s[8:11], s3 offen offset:3072 sc1
M v[172:175],a[56:59],a[168:171],v[172:175]
C v136,v136,v137
C v137,v138,v139
M v[176:179],a[64:67],a[168:171],v[176:179]
C v138,v140,v141
C v139,v142,v143
M v[176:179],a[68:71],a[172:175],v[176:179]
C v144,v144,v145
C v145,v146,v147
M v[180:183],a[76:79],a[172:175],v[180:183]
C v146,v148,v149
C v147,v150,v151
M v[180:183],a[72:75],a[168:171],v[180:183]
C v152,v152,v153
C v153,v154,v155
M v[184:187],a[80:83],a[168:171],v[184:187]
C v154,v156,v157
C v155,v158,v159
M v[184:187],a[84:87],a[172:175],v[184:187]
s_waitcnt lgkmcnt(0)
C v160,v160,v161
C v161,v162,v163
M v[188:191],a[92:95],a[172:175],v[188:191]
C v162,v164,v165
C v163,v166,v167
M v[188:191],a[88:91],a[168:171],v[188:191]
C v168,v168,v169
C v169,v170,v171
M v[192:195],a[32:35],a[160:163],v[192:195]
s_waitcnt vmcnt(18)
R a[168:171],v5,55296
R a[172:175],v6,55296
M v[192:195],a[36:39],a[164:167],v[192:195]
C v170,v172,v173
C v171,v174,v175
M v[196:199],a[44:47],a[164:167],v[196:199]
C v176,v176,v177
C v177,v178,v179
M v[196:199],a[40:43],a[160:163],v[196:199]
C v178,v180,v181
C v179,v182,v183
M v[200:203],a[48:51],a[160:163],v[200:203]
R a[128:131],v20,49152
R a[132:135],v20,51200
M v[200:203],a[52:55],a[164:167],v[200:203]
R a[136:139],v21,49152
R a[140:143],v21,51200
M v[204:207],a[60:63],a[164:167],v[204:207]
C v184,v184,v185
C v185,v186,v187
M v[204:207],a[56:59],a[160:163],v[204:207]
C v186,v188,v189
C v187,v190,v191
M v[208:211],a[64:67],a[160:163],v[208:211]
C v192,v192,v193
C v193,v194,v195
M v[208:211],a[68:71],a[164:167],v[208:211]
C v194,v196,v197
C v195,v198,v199
M v[212:215],a[76:79],a[164:167],v[212:215]
M v[212:215],a[72:75],a[160:163],v[212:215]
C v200,v200,v201
C v201,v202,v203
M v[216:219],a[80:83],a[160:163],v[216:219]
C v202,v204,v205
C v203,v206,v207
M v[216:219],a[84:87],a[164:167],v[216:219]
s_waitcnt lgkmcnt(4)
M v[220:223],a[92:95],a[164:167],v[220:223]
s_waitcnt vmcnt(9) lgkmcnt(0)
M v[220:223],a[88:91],a[160:163],v[220:223]
s_barrier
M v[224:227],a[32:35],a[168:171],v[224:227]
s_nop 0
T v[32:33],v16,0
T v[34:35],v16,2048
M v[224:227],a[36:39],a[172:175],v[224:227]
C v208,v208,v209
C v209,v210,v211
M v[228:231],a[44:47],a[172:175],v[228:231]
T v[36:37],v16,4096
T v[38:39],v16,6144
M v[228:231],a[40:43],a[168:171],v[228:231]
T v[40:41],v16,8192
T v[42:43],v16,10240
M v[232:235],a[48:51],a[168:171],v[232:235]
C v210,v212,v213
C v211,v214,v215
M v[232:235],a[52:55],a[172:175],v[232:235]
T v[44:45],v16,12288
T v[46:47],v16,14336
M v[236:239],a[60:63],a[172:175],v[236:239]
T v[48:49],v16,16384
T v[50:51],v16,18432
M v[236:239],a[56:59],a[168:171],v[236:239]
C v216,v216,v217
C v217,v218,v219
M v[240:243],a[64:67],a[168:171],v[240:243]
T v[52:53],v16,20480
T v[54:55],v16,22528
M v[240:243],a[68:71],a[172:175],v[240:243]
T v[56:57],v16,24576
T v[58:59],v16,26624
M v[244:247],a[76:79],a[172:175],v[244:247]
C v218,v220,v221
C v219,v222,v223
M v[244:247],a[72:75],a[168:171],v[244:247]
C v224,v224,v225
C v225,v226,v227
M v[248:251],a[80:83],a[168:171],v[248:251]
C v226,v228,v229
C v227,v230,v231
M v[248:251],a[84:87],a[172:175],v[248:251]
C v232,v232,v233
C v233,v234,v235
M v[252:255],a[92:95],a[172:175],v[252:255]
C v234,v236,v237
C v235,v238,v239
M v[252:255],a[88:91],a[168:171],v[252:255]
s_waitcnt lgkmcnt(6)
C v240,v240,v241
C v241,v242,v243
M v[68:71],v[32:35],a[176:179],0
s_mul_i32 s72, s41, 4352
T a[144:145],v17,0
T a[146:147],v17,2048
M v[68:71],v[36:39],a[184:187],v[68:71]
s_mov_b32 s25, 1048704
C v242,v244,v245
C v243,v246,v247
M v[68:71],v[40:43],a[192:195],v[68:71]
s_waitcnt lgkmcnt(2)
T a[148:149],v17,4096
T a[150:151],v17,6144
M v[68:71],v[44:47],a[200:203],v[68:71]
SA m0,s4,98304
T a[152:153],v17,8192
T a[154:155],v17,10240
M v[68:71],v[48:51],a[208:211],v[68:71]
SA s46,s72,104923136
buffer_load_dwordx4 v8, s[52:55], s25 offen lds
M v[68:71],v[52:55],a[216:219],v[68:71]
s_lshl_b32 s45, s42, 7
T a[156:157],v17,12288
T a[158:159],v17,14336
M v[68:71],v[56:59],a[224:227],v[68:71]
s_mov_b32 s25, 1310848
T a[160:161],v17,16384
T a[162:163],v17,18432
M v[76:79],v[56:59],a[228:231],0
SA m0,s4,102400
C v248,v248,v249
C v249,v250,v251
M v[76:79],v[52:55],a[220:223],v[76:79]
SA s45,s45,s46
T a[164:165],v17,20480
T a[166:167],v17,22528
M v[76:79],v[48:51],a[212:215],v[76:79]
s_lshl_b32 s72, s20, 2
T a[168:169],v17,24576
T a[170:171],v17,26624
M v[76:79],v[44:47],a[204:207],v[76:79]
SA s72,s72,s45
buffer_load_dwordx4 v8, s[52:55], s25 offen lds
M v[76:79],v[40:43],a[196:199],v[76:79]
C v250,v252,v253
C v251,v254,v255
M v[76:79],v[36:39],a[188:191],v[76:79]
s_mov_b32 s25, 1572992
v_min_u32 v29, 1, v0
v_lshlrev_b32 v29, 29, v29
M v[76:79],v[32:35],a[180:183],v[76:79]
s_waitcnt lgkmcnt(6)
v_mov_b32 v30, 1
M v[84:87],a[144:147],a[176:179],0
SA m0,s4,106496
T v[32:33],v18,0
T v[34:35],v18,2048
M v[84:87],a[148:151],a[184:187],v[84:87]
buffer_load_dwordx4 v8, s[52:55], s25 offen lds
M v[84:87],a[152:155],a[192:195],v[84:87]
s_waitcnt lgkmcnt(2)
s_nop 0
T v[36:37],v18,4096
T v[38:39],v18,6144
M v[84:87],a[156:159],a[200:203],v[84:87]
s_mov_b32 s25, 1835136
T v[40:41],v18,8192
T v[42:43],v18,10240
M v[84:87],a[160:163],a[208:211],v[84:87]
SA m0,s4,110592
M v[84:87],a[164:167],a[216:219],v[84:87]
s_nop 0
T v[44:45],v18,12288
T v[46:47],v18,14336
M v[84:87],a[168:171],a[224:227],v[84:87]
s_waitcnt vmcnt(3)
T v[48:49],v18,16384
T v[50:51],v18,18432
M v[92:95],a[168:171],a[228:231],0
buffer_load_dwordx4 v8, s[52:55], s25 offen lds
M v[92:95],a[164:167],a[220:223],v[92:95]
s_nop 0
T v[52:53],v18,20480
T v[54:55],v18,22528
M v[92:95],a[160:163],a[212:215],v[92:95]
s_mov_b32 s25, 2097280
T v[56:57],v18,24576
T v[58:59],v18,26624
M v[92:95],a[156:159],a[204:207],v[92:95]
SA m0,s4,114688
buffer_store_dword v30, v29, s[8:11], s72 offen offset:4 sc1
M v[92:95],a[152:155],a[196:199],v[92:95]
SA s3,s93,524288
buffer_load_dwordx4 v8, s[52:55], s25 offen lds
M v[92:95],a[148:151],a[188:191],v[92:95]
v_add_u32 v20, 0x10000, v16
v_add_u32 v21, 0x10000, v17
M v[92:95],a[144:147],a[180:183],v[92:95]
s_waitcnt lgkmcnt(6)
buffer_store_dwordx4 v[64:67], v7, s[8:11], s3 offen offset:0 sc1
M v[100:103],v[32:35],a[176:179],0
s_mov_b32 s25, 2359424
T a[144:145],v19,0
T a[146:147],v19,2048
M v[100:103],v[36:39],a[184:187],v[100:103]
SA m0,s4,118784
L_w_kv08:
s_cbranch_execz L_wd1
buffer_store_dwordx4 v[72:75], v7, s[8:11], s3 offen offset:1024 sc1
M v[100:103],v[40:43],a[192:195],v[100:103]
s_waitcnt lgkmcnt(2)
s_nop 0
T a[148:149],v19,4096
T a[150:151],v19,6144
M v[100:103],v[44:47],a[200:203],v[100:103]
T a[152:153],v19,8192
T a[154:155],v19,10240
M v[100:103],v[48:51],a[208:211],v[100:103]
buffer_load_dwordx4 v8, s[52:55], s25 offen lds
M v[100:103],v[52:55],a[216:219],v[100:103]
s_nop 0
T a[156:157],v19,12288
T a[158:159],v19,14336
M v[100:103],v[56:59],a[224:227],v[100:103]
s_mov_b32 s25, 2621568
T a[160:161],v19,16384
T a[162:163],v19,18432
M v[108:111],v[56:59],a[228:231],0
SA m0,s4,122880
buffer_store_dwordx4 v[80:83], v7, s[8:11], s3 offen offset:2048 sc1
M v[108:111],v[52:55],a[220:223],v[108:111]
s_nop 0
T a[164:165],v19,20480
T a[166:167],v19,22528
M v[108:111],v[48:51],a[212:215],v[108:111]
T a[168:169],v19,24576
T a[170:171],v19,26624
M v[108:111],v[44:47],a[204:207],v[108:111]
buffer_load_dwordx4 v8, s[52:55], s25 offen lds
M v[108:111],v[40:43],a[196:199],v[108:111]
v_add_u32 v22, 0x10000, v18
v_add_u32 v23, 0x10000, v19
M v[108:111],v[36:39],a[188:191],v[108:111]
s_mov_b32 s25, 2883712
buffer_store_dwordx4 v[88:91], v7, s[8:11], s3 offen offset:3072 sc1
M v[108:111],v[32:35],a[180:183],v[108:111]
s_waitcnt lgkmcnt(6)
v_or_b32 v1, s20, v0
v_min_u32 v1, 1, v1
M v[116:119],a[144:147],a[176:179],0
SA m0,s4,126976
T v[32:33],v16,28672
T v[34:35],v16,30720
M v[116:119],a[148:151],a[184:187],v[116:119]
buffer_load_dwordx4 v8, s[52:55], s25 offen lds
M v[116:119],a[152:155],a[192:195],v[116:119]
s_waitcnt lgkmcnt(2)
s_nop 0
T v[36:37],v12,0
T v[38:39],v12,2048
M v[116:119],a[156:159],a[200:203],v[116:119]
s_mov_b32 s25, 3145856
T v[40:41],v12,4096
T v[42:43],v12,6144
M v[116:119],a[160:163],a[208:211],v[116:119]
SA m0,s4,32768
v_lshlrev_b32 v1, 29, v1
M v[116:119],a[164:167],a[216:219],v[116:119]
s_nop 0
T v[44:45],v12,8192
T v[46:47],v12,10240
M v[116:119],a[168:171],a[224:227],v[116:119]
T v[48:49],v12,12288
T v[50:51],v12,14336
M v[124:127],a[168:171],a[228:231],0
buffer_load_dwordx4 v8, s[52:55], s25 offen lds
M v[124:127],a[164:167],a[220:223],v[124:127]
s_nop 0
T v[52:53],v12,16384
T v[54:55],v12,18432
M v[124:127],a[160:163],a[212:215],v[124:127]
s_mov_b32 s25, 3408000
T v[56:57],v12,20480
T v[58:59],v12,22528
M v[124:127],a[156:159],a[204:207],v[124:127]
SA m0,s4,36864
v_min_u32 v9, 15, v0
v_lshlrev_b32 v9, 7, v9
M v[124:127],a[152:155],a[196:199],v[124:127]
s_sub_u32 s66, 15, s42
buffer_load_dwordx4 v8, s[52:55], s25 offen lds
M v[124:127],a[148:151],a[188:191],v[124:127]
s_max_u32 s67, s66, s42
M v[124:127],a[144:147],a[180:183],v[124:127]
s_waitcnt lgkmcnt(6)
M v[68:71],v[32:35],a[232:235],v[68:71]
s_mov_b32 s25, 256
T a[144:145],v17,28672
T a[146:147],v17,30720
M v[68:71],v[36:39],a[96:99],v[68:71]
SA m0,s4,65536
M v[68:71],v[40:43],a[104:107],v[68:71]
s_waitcnt lgkmcnt(2)
s_nop 0
T a[148:149],v13,0
T a[150:151],v13,2048
M v[68:71],v[44:47],a[112:115],v[68:71]
s_min_u32 s66, s66, s42
T a[152:153],v13,4096
T a[154:155],v13,6144
M v[68:71],v[48:51],a[120:123],v[68:71]
s_mul_i32 s21, s41, 1048576
buffer_load_dwordx4 v8, s[52:55], s25 offen lds
M v[68:71],v[52:55],a[128:131],v[68:71]
s_lshl_b32 s64, s67, 16
T a[156:157],v13,8192
T a[158:159],v13,10240
M v[68:71],v[56:59],a[136:139],v[68:71]
s_mov_b32 s25, 262400
T a[160:161],v13,12288
T a[162:163],v13,14336
M v[76:79],v[56:59],a[140:143],v[76:79]
SA m0,s4,69632
M v[76:79],v[52:55],a[132:135],v[76:79]
SA s32,s21,s64
T a[164:165],v13,16384
T a[166:167],v13,18432
M v[76:79],v[48:51],a[124:127],v[76:79]
s_lshl_b32 s64, s20, 14
T a[168:169],v13,20480
T a[170:171],v13,22528
M v[76:79],v[44:47],a[116:119],v[76:79]
SA s32,s32,s64
buffer_load_dwordx4 v8, s[52:55], s25 offen lds
M v[76:79],v[40:43],a[108:111],v[76:79]
SA s32,s32,33554432
M v[76:79],v[36:39],a[100:103],v[76:79]
s_mov_b32 s25, 524544
M v[76:79],v[32:35],a[236:239],v[76:79]
s_waitcnt lgkmcnt(6)
M v[84:87],a[144:147],a[232:235],v[84:87]
SA m0,s4,73728
T v[32:33],v18,28672
T v[34:35],v18,30720
M v[84:87],a[148:151],a[96:99],v[84:87]
s_sub_u32 s64, s42, 10
buffer_load_dwordx4 v8, s[52:55], s25 offen lds
M v[84:87],a[152:155],a[104:107],v[84:87]
s_waitcnt lgkmcnt(2)
s_nop 0
T v[36:37],v14,0
T v[38:39],v14,2048
M v[84:87],a[156:159],a[112:115],v[84:87]
s_mov_b32 s25, 786688
T v[40:41],v14,4096
T v[42:43],v14,6144
M v[84:87],a[160:163],a[120:123],v[84:87]
SA m0,s4,77824
M v[84:87],a[164:167],a[128:131],v[84:87]
s_and_b32 s35, s64, 536870912
T v[44:45],v14,8192
T v[46:47],v14,10240
M v[84:87],a[168:171],a[136:139],v[84:87]
T v[48:49],v14,12288
T v[50:51],v14,14336
M v[92:95],a[168:171],a[140:143],v[92:95]
buffer_load_dwordx4 v8, s[52:55], s25 offen lds
M v[92:95],a[164:167],a[132:135],v[92:95]
s_nop 0
T v[52:53],v14,16384
T v[54:55],v14,18432
M v[92:95],a[160:163],a[124:127],v[92:95]
s_mov_b32 s25, 1048832
T v[56:57],v14,20480
T v[58:59],v14,22528
M v[92:95],a[156:159],a[116:119],v[92:95]
SA m0,s4,81920
v_or_b32 v6, s35, v7
MF v68,s5,v68
M v[92:95],a[152:155],a[108:111],v[92:95]
s_lshl_b32 s28, s20, 13
buffer_load_dwordx4 v8, s[52:55], s25 offen lds
M v[92:95],a[148:151],a[100:103],v[92:95]
v_add_u32 v2, 0x10000, v7
v_add_u32 v3, s28, v7
M v[92:95],a[144:147],a[236:239],v[92:95]
s_waitcnt lgkmcnt(6)
v_add_u32 v4, 0x1000, v3
MF v69,s5,v69
M v[100:103],v[32:35],a[232:235],v[100:103]
s_mov_b32 s25, 1310976
T a[144:145],v19,28672
T a[146:147],v19,30720
M v[100:103],v[36:39],a[96:99],v[100:103]
SA m0,s4,86016
MF v70,s5,v70
MF v71,s5,v71
M v[100:103],v[40:43],a[104:107],v[100:103]
s_waitcnt lgkmcnt(2)
T a[148:149],v15,0
T a[150:151],v15,2048
M v[100:103],v[44:47],a[112:115],v[100:103]
s_lshl_b32 s64, s42, 16
T a[152:153],v15,4096
T a[154:155],v15,6144
M v[100:103],v[48:51],a[120:123],v[100:103]
SA s23,s21,s64
buffer_load_dwordx4 v8, s[52:55], s25 offen lds
M v[100:103],v[52:55],a[128:131],v[100:103]
SA s43,s23,16777216
T a[156:157],v15,8192
T a[158:159],v15,10240
M v[100:103],v[56:59],a[136:139],v[100:103]
s_mov_b32 s25, 1573120
T a[160:161],v15,12288
T a[162:163],v15,14336
M v[108:111],v[56:59],a[140:143],v[108:111]
SA m0,s4,90112
MF v84,s5,v84
MF v85,s5,v85
M v[108:111],v[52:55],a[132:135],v[108:111]
SA s26,s21,16777216
T a[164:165],v15,16384
T a[166:167],v15,18432
M v[108:111],v[48:51],a[124:127],v[108:111]
s_mov_b32 s22, 0x7fff
T a[168:169],v15,20480
T a[170:171],v15,22528
M v[108:111],v[44:47],a[116:119],v[108:111]
s_sub_u32 s27, s42, 1
buffer_load_dwordx4 v8, s[52:55], s25 offen lds
M v[108:111],v[40:43],a[108:111],v[108:111]
s_cmp_eq_u32 s42, 0
MF v86,s5,v86
MF v87,s5,v87
M v[108:111],v[36:39],a[100:103],v[108:111]
s_waitcnt vmcnt(7) lgkmcnt(0)
C v68,v68,v69
C v69,v70,v71
M v[108:111],v[32:35],a[236:239],v[108:111]
s_barrier
M v[116:119],a[144:147],a[232:235],v[116:119]
s_mov_b32 s25, 1835264
T v[32:33],v16,49152
T v[34:35],v16,51200
M v[116:119],a[148:151],a[96:99],v[116:119]
s_cselect_b32 s64, 32768, 0
C v70,v84,v85
C v71,v86,v87
M v[116:119],a[152:155],a[104:107],v[116:119]
SA m0,s4,94208
T v[36:37],v16,53248
T v[38:39],v16,55296
M v[116:119],a[156:159],a[112:115],v[116:119]
SA s26,s26,s64
T v[40:41],v16,57344
T v[42:43],v16,59392
M v[116:119],a[160:163],a[120:123],v[116:119]
s_mov_b32 s31, 0x4b800000
buffer_load_dwordx4 v8, s[52:55], s25 offen lds
M v[116:119],a[164:167],a[128:131],v[116:119]
s_mov_b32 s24, 0x33800000
T v[44:45],v16,61440
T v[46:47],v16,63488
M v[116:119],a[168:171],a[136:139],v[116:119]
s_mov_b32 s25, 2097408
T v[48:49],v20,32768
T v[50:51],v20,34816
M v[124:127],a[168:171],a[140:143],v[124:127]
SA m0,s4,155648
W a0,v68
W a1,v69
M v[124:127],a[164:167],a[132:135],v[124:127]
s_lshl_b32 s47, s66, 7
T v[52:53],v20,36864
T v[54:55],v20,38912
M v[124:127],a[160:163],a[124:127],v[124:127]
SA s47,s47,s46
T v[56:57],v20,40960
T v[58:59],v20,43008
M v[124:127],a[156:159],a[116:119],v[124:127]
s_lshl_b32 s64, s20, 5
buffer_load_dwordx4 v8, s[52:55], s25 offen lds
M v[124:127],a[152:155],a[108:111],v[124:127]
SA s47,s47,s64
W a2,v70
W a3,v71
M v[124:127],a[148:151],a[100:103],v[124:127]
SA s47,s47,2048
MF v76,s5,v76
MF v77,s5,v77
M v[124:127],a[144:147],a[236:239],v[124:127]
s_waitcnt lgkmcnt(6)
MF v78,s5,v78
MF v79,s5,v79
M v[132:135],v[32:35],a[176:179],0
s_lshl_b32 s65, s41, 3
T a[144:145],v17,49152
T a[146:147],v17,51200
M v[132:135],v[36:39],a[184:187],v[132:135]
SA s65,s65,s66
MF v92,s5,v92
MF v93,s5,v93
M v[132:135],v[40:43],a[192:195],v[132:135]
s_waitcnt lgkmcnt(2)
T a[148:149],v17,53248
T a[150:151],v17,55296
M v[132:135],v[44:47],a[200:203],v[132:135]
s_mul_i32 s34, s65, 73728
T a[152:153],v17,57344
T a[154:155],v17,59392
M v[132:135],v[48:51],a[208:211],v[132:135]
SA s34,s34,136314880
MF v94,s5,v94
MF v95,s5,v95
M v[132:135],v[52:55],a[216:219],v[132:135]
s_lshl_b32 s65, s42, 4
T a[156:157],v17,61440
T a[158:159],v17,63488
M v[132:135],v[56:59],a[224:227],v[132:135]
SA s65,s65,s41
T a[160:161],v21,32768
T a[162:163],v21,34816
M v[140:143],v[56:59],a[228:231],0
s_mul_i32 s33, s65, 114688
C v76,v76,v77
C v77,v78,v79
M v[140:143],v[52:55],a[220:223],v[140:143]
s_mul_i32 s65, s20, 28672
T a[164:165],v21,36864
T a[166:167],v21,38912
M v[140:143],v[48:51],a[212:215],v[140:143]
SA s33,s33,s65
T a[168:169],v21,40960
T a[170:171],v21,43008
M v[140:143],v[44:47],a[204:207],v[140:143]
SA s33,s33,67108864
C v78,v92,v93
C v79,v94,v95
M v[140:143],v[40:43],a[196:199],v[140:143]
s_mov_b32 s6, 0
W a32,v76
W a33,v77
M v[140:143],v[36:39],a[188:191],v[140:143]
s_mov_b32 s7, 0
W a34,v78
W a35,v79
M v[140:143],v[32:35],a[180:183],v[140:143]
s_waitcnt lgkmcnt(6)
MF v100,s5,v100
MF v101,s5,v101
M v[148:151],a[144:147],a[176:179],0
s_mov_b32 s40, 1
T v[32:33],v18,49152
T v[34:35],v18,51200
M v[148:151],a[148:151],a[184:187],v[148:151]
s_cmp_eq_u32 s20, 0
MF v102,s5,v102
MF v103,s5,v103
M v[148:151],a[152:155],a[192:195],v[148:151]
s_waitcnt lgkmcnt(2)
T v[36:37],v18,53248
T v[38:39],v18,55296
M v[148:151],a[156:159],a[200:203],v[148:151]
s_cselect_b32 s39, 7, 4
T v[40:41],v18,57344
T v[42:43],v18,59392
M v[148:151],a[160:163],a[208:211],v[148:151]
s_lshl_b32 s64, s41, 1
MF v116,s5,v116
MF v117,s5,v117
M v[148:151],a[164:167],a[216:219],v[148:151]
SA s64,s64,s20
T v[44:45],v18,61440
T v[46:47],v18,63488
M v[148:151],a[168:171],a[224:227],v[148:151]
s_cmp_lt_u32 s64, 30
T v[48:49],v22,32768
T v[50:51],v22,34816
M v[156:159],a[168:171],a[228:231],0
s_cselect_b32 s64, 32798, 0
MF v118,s5,v118
MF v119,s5,v119
M v[156:159],a[164:167],a[220:223],v[156:159]
s_cmp_ge_u32 s20, 2
T v[52:53],v22,36864
T v[54:55],v22,38912
M v[156:159],a[160:163],a[212:215],v[156:159]
s_cselect_b32 s64, s64, 0
T v[56:57],v22,40960
T v[58:59],v22,43008
M v[156:159],a[156:159],a[204:207],v[156:159]
s_cmp_eq_u32 s42, 6
C v100,v100,v101
C v101,v102,v103
M v[156:159],a[152:155],a[196:199],v[156:159]
s_cselect_b32 s64, s64, 0
C v102,v116,v117
C v103,v118,v119
M v[156:159],a[148:151],a[188:191],v[156:159]
s_or_b32 s39, s39, s64
W a4,v100
W a5,v101
M v[156:159],a[144:147],a[180:183],v[156:159]
s_waitcnt lgkmcnt(6)
W a6,v102
W a7,v103
M v[164:167],v[32:35],a[176:179],0
s_mov_b64 s[60:61], s[76:77]
T a[144:145],v19,49152
T a[146:147],v19,51200
M v[164:167],v[36:39],a[184:187],v[164:167]
s_mov_b32 s62, s78
MF v108,s5,v108
MF v109,s5,v109
M v[164:167],v[40:43],a[192:195],v[164:167]
s_waitcnt lgkmcnt(2)
T a[148:149],v19,53248
T a[150:151],v19,55296
M v[164:167],v[44:47],a[200:203],v[164:167]
s_mov_b32 s63, 0x20000
T a[152:153],v19,57344
T a[154:155],v19,59392
M v[164:167],v[48:51],a[208:211],v[164:167]
s_mov_b32 s25, 2359552
v_lshrrev_b32 v24, 4, v0
v_lshlrev_b32 v24, 2, v24
M v[164:167],v[52:55],a[216:219],v[164:167]
SA m0,s4,159744
T a[156:157],v19,61440
T a[158:159],v19,63488
M v[164:167],v[56:59],a[224:227],v[164:167]
SA s3,s93,532480
T a[160:161],v23,32768
T a[162:163],v23,34816
M v[172:175],v[56:59],a[228:231],0
buffer_load_dwordx4 v8, s[52:55], s25 offen lds
M v[172:175],v[52:55],a[220:223],v[172:175]
s_nop 0
T a[164:165],v23,36864
T a[166:167],v23,38912
M v[172:175],v[48:51],a[212:215],v[172:175]
s_mov_b32 s25, 2621696
T a[168:169],v23,40960
T a[170:171],v23,43008
M v[172:175],v[44:47],a[204:207],v[172:175]
SA m0,s4,131072
buffer_store_dwordx4 v[96:99], v7, s[8:11], s3 offen offset:0 sc1
M v[172:175],v[40:43],a[196:199],v[172:175]
v_and_b32 v25, 15, v0
v_sub_u32 v24, v24, v25
M v[172:175],v[36:39],a[188:191],v[172:175]
buffer_load_dwordx4 v8, s[52:55], s25 offen lds
M v[172:175],v[32:35],a[180:183],v[172:175]
s_waitcnt lgkmcnt(6)
v_cmp_lt_i32 s[16:17], 0, v24
v_cmp_lt_i32 s[18:19], -1, v24
M v[180:183],a[144:147],a[176:179],0
s_mov_b32 s25, 2883840
T v[32:33],v20,45056
T v[34:35],v20,47104
M v[180:183],a[148:151],a[184:187],v[180:183]
SA m0,s4,135168
buffer_store_dwordx4 v[104:107], v7, s[8:11], s3 offen offset:1024 sc1
M v[180:183],a[152:155],a[192:195],v[180:183]
s_waitcnt lgkmcnt(2)
s_nop 0
T v[36:37],v20,49152
T v[38:39],v20,51200
M v[180:183],a[156:159],a[200:203],v[180:183]
T v[40:41],v20,53248
T v[42:43],v20,55296
M v[180:183],a[160:163],a[208:211],v[180:183]
buffer_load_dwordx4 v8, s[52:55], s25 offen lds
M v[180:183],a[164:167],a[216:219],v[180:183]
s_nop 0
T v[44:45],v20,57344
T v[46:47],v20,59392
M v[180:183],a[168:171],a[224:227],v[180:183]
s_mov_b32 s25, 3145984
T v[48:49],v20,61440
T v[50:51],v20,63488
M v[188:191],a[168:171],a[228:231],0
SA m0,s4,139264
buffer_store_dwordx4 v[112:115], v7, s[8:11], s3 offen offset:2048 sc1
M v[188:191],a[164:167],a[220:223],v[188:191]
s_nop 0
T v[52:53],v16,32768
T v[54:55],v16,34816
M v[188:191],a[160:163],a[212:215],v[188:191]
T v[56:57],v16,36864
T v[58:59],v16,38912
M v[188:191],a[156:159],a[204:207],v[188:191]
buffer_load_dwordx4 v8, s[52:55], s25 offen lds
M v[188:191],a[152:155],a[196:199],v[188:191]
v_cmp_lt_i32 s[48:49], -2, v24
v_cmp_lt_i32 s[50:51], -3, v24
M v[188:191],a[148:151],a[188:191],v[188:191]
s_mov_b32 s25, 3408128
buffer_store_dwordx4 v[120:123], v7, s[8:11], s3 offen offset:3072 sc1
M v[188:191],a[144:147],a[180:183],v[188:191]
s_waitcnt lgkmcnt(6)
v_lshl_add_u32 v25, v0, 7, s95
v_and_b32 v0, 48, v0
M v[132:135],v[32:35],a[232:235],v[132:135]
SA m0,s4,143360
T a[144:145],v21,45056
T a[146:147],v21,47104
M v[132:135],v[36:39],a[96:99],v[132:135]
buffer_load_dwordx4 v8, s[52:55], s25 offen lds
M v[132:135],v[40:43],a[104:107],v[132:135]
s_waitcnt lgkmcnt(2)
s_nop 0
T a[148:149],v21,49152
T a[150:151],v21,51200
M v[132:135],v[44:47],a[112:115],v[132:135]
s_mov_b32 s25, 384
T a[152:153],v21,53248
T a[154:155],v21,55296
M v[132:135],v[48:51],a[120:123],v[132:135]
SA m0,s4,0
v_lshl_add_u32 v0, v0, 24, v25
v_mov_b32 v24, 0x3f80
M v[132:135],v[52:55],a[128:131],v[132:135]
T a[156:157],v21,57344
T a[158:159],v21,59392
M v[132:135],v[56:59],a[136:139],v[132:135]
T a[160:161],v21,61440
T a[162:163],v21,63488
M v[140:143],v[56:59],a[140:143],v[140:143]
buffer_load_dwordx4 v8, s[52:55], s25 offen lds
M v[140:143],v[52:55],a[132:135],v[140:143]
s_nop 0
T a[164:165],v17,32768
T a[166:167],v17,34816
M v[140:143],v[48:51],a[124:127],v[140:143]
s_mov_b32 s25, 262528
T a[168:169],v17,36864
T a[170:171],v17,38912
M v[140:143],v[44:47],a[116:119],v[140:143]
SA m0,s4,4096
MF v110,s5,v110
MF v111,s5,v111
M v[140:143],v[40:43],a[108:111],v[140:143]
buffer_load_dwordx4 v8, s[52:55], s25 offen lds
M v[140:143],v[36:39],a[100:103],v[140:143]
MF v124,s5,v124
MF v125,s5,v125
M v[140:143],v[32:35],a[236:239],v[140:143]
s_waitcnt lgkmcnt(6)
MF v126,s5,v126
MF v127,s5,v127
M v[148:151],a[144:147],a[232:235],v[148:151]
s_mov_b32 s25, 524672
T v[32:33],v22,45056
T v[34:35],v22,47104
M v[148:151],a[148:151],a[96:99],v[148:151]
SA m0,s4,8192
C v108,v108,v109
C v109,v110,v111
M v[148:151],a[152:155],a[104:107],v[148:151]
s_waitcnt lgkmcnt(2)
T v[36:37],v22,49152
T v[38:39],v22,51200
M v[148:151],a[156:159],a[112:115],v[148:151]
T v[40:41],v22,53248
T v[42:43],v22,55296
M v[148:151],a[160:163],a[120:123],v[148:151]
buffer_load_dwordx4 v8, s[52:55], s25 offen lds
M v[148:151],a[164:167],a[128:131],v[148:151]
s_nop 0
T v[44:45],v22,57344
T v[46:47],v22,59392
M v[148:151],a[168:171],a[136:139],v[148:151]
s_mov_b32 s25, 786816
T v[48:49],v22,61440
T v[50:51],v22,63488
M v[156:159],a[168:171],a[140:143],v[156:159]
SA m0,s4,12288
C v110,v124,v125
C v111,v126,v127
M v[156:159],a[164:167],a[132:135],v[156:159]
T v[52:53],v18,32768
T v[54:55],v18,34816
M v[156:159],a[160:163],a[124:127],v[156:159]
T v[56:57],v18,36864
T v[58:59],v18,38912
M v[156:159],a[156:159],a[116:119],v[156:159]
buffer_load_dwordx4 v8, s[52:55], s25 offen lds
M v[156:159],a[152:155],a[108:111],v[156:159]
W a36,v108
W a37,v109
M v[156:159],a[148:151],a[100:103],v[156:159]
s_mov_b32 s25, 1048960
v_lshrrev_b32 v25, 8, v7
v_bfe_u32 v26, v7, 6, 2
v_and_b32 v27, 16, v7
v_lshlrev_b32 v27, v27, v24
v_cmp_eq_u32 vcc, v25, v26
v_and_b32 v28, 32, v7
W a244,0
v_cndmask_b32 v27, 0, v27, vcc
v_cmp_eq_u32 vcc, 0, v28
W a245,0
W a248,0
v_cndmask_b32 v25, 0, v27, vcc
v_sub_u32 v26, v27, v25
W a249,0
W a246,v25
W a247,v26
M v[156:159],a[144:147],a[236:239],v[156:159]
s_waitcnt lgkmcnt(6)
W a38,v110
W a39,v111
M v[164:167],v[32:35],a[232:235],v[164:167]
SA m0,s4,16384
T a[144:145],v23,45056
T a[146:147],v23,47104
M v[164:167],v[36:39],a[96:99],v[164:167]
buffer_load_dwordx4 v8, s[52:55], s25 offen lds
M v[164:167],v[40:43],a[104:107],v[164:167]
s_waitcnt lgkmcnt(2)
s_nop 0
T a[148:149],v23,49152
T a[150:151],v23,51200
M v[164:167],v[44:47],a[112:115],v[164:167]
s_mov_b32 s25, 1311104
T a[152:153],v23,53248
T a[154:155],v23,55296
M v[164:167],v[48:51],a[120:123],v[164:167]
SA m0,s4,20480
MF v132,s5,v132
MF v133,s5,v133
M v[164:167],v[52:55],a[128:131],v[164:167]
T a[156:157],v23,57344
T a[158:159],v23,59392
M v[164:167],v[56:59],a[136:139],v[164:167]
T a[160:161],v23,61440
T a[162:163],v23,63488
M v[172:175],v[56:59],a[140:143],v[172:175]
buffer_load_dwordx4 v8, s[52:55], s25 offen lds
M v[172:175],v[52:55],a[132:135],v[172:175]
s_nop 0
T a[164:165],v19,32768
T a[166:167],v19,34816
M v[172:175],v[48:51],a[124:127],v[172:175]
s_mov_b32 s25, 1573248
T a[168:169],v19,36864
T a[170:171],v19,38912
M v[172:175],v[44:47],a[116:119],v[172:175]
SA m0,s4,24576
MF v134,s5,v134
MF v135,s5,v135
M v[172:175],v[40:43],a[108:111],v[172:175]
buffer_load_dwordx4 v8, s[52:55], s25 offen lds
M v[172:175],v[36:39],a[100:103],v[172:175]
s_waitcnt vmcnt(7) lgkmcnt(0)
MF v148,s5,v148
MF v149,s5,v149
M v[172:175],v[32:35],a[236:239],v[172:175]
s_barrier
M v[180:183],a[144:147],a[232:235],v[180:183]
s_mov_b32 s25, 1835392
T v[32:33],v20,0
T v[34:35],v20,2048
M v[180:183],a[148:151],a[96:99],v[180:183]
SA m0,s4,28672
MF v150,s5,v150
MF v151,s5,v151
M v[180:183],a[152:155],a[104:107],v[180:183]
T v[36:37],v20,4096
T v[38:39],v20,6144
M v[180:183],a[156:159],a[112:115],v[180:183]
T v[40:41],v20,8192
T v[42:43],v20,10240
M v[180:183],a[160:163],a[120:123],v[180:183]
buffer_load_dwordx4 v8, s[52:55], s25 offen lds
M v[180:183],a[164:167],a[128:131],v[180:183]
s_nop 0
T v[44:45],v20,12288
T v[46:47],v20,14336
M v[180:183],a[168:171],a[136:139],v[180:183]
s_mov_b32 s25, 2097536
T v[48:49],v20,16384
T v[50:51],v20,18432
M v[188:191],a[168:171],a[140:143],v[188:191]
SA m0,s4,40960
C v132,v132,v133
C v133,v134,v135
M v[188:191],a[164:167],a[132:135],v[188:191]
T v[52:53],v20,20480
T v[54:55],v20,22528
M v[188:191],a[160:163],a[124:127],v[188:191]
T v[56:57],v20,24576
T v[58:59],v20,26624
M v[188:191],a[156:159],a[116:119],v[188:191]
buffer_load_dwordx4 v8, s[52:55], s25 offen lds
M v[188:191],a[152:155],a[108:111],v[188:191]
C v134,v148,v149
C v135,v150,v151
M v[188:191],a[148:151],a[100:103],v[188:191]
s_mov_b32 s25, 2359680
W a8,v132
W a9,v133
M v[188:191],a[144:147],a[236:239],v[188:191]
s_waitcnt lgkmcnt(6)
W a10,v134
W a11,v135
M v[68:71],v[32:35],a[176:179],0
SA m0,s4,45056
T a[144:145],v21,0
T a[146:147],v21,2048
M v[68:71],v[36:39],a[184:187],v[68:71]
buffer_load_dwordx4 v8, s[52:55], s25 offen lds
M v[68:71],v[40:43],a[192:195],v[68:71]
s_waitcnt lgkmcnt(2)
s_nop 0
T a[148:149],v21,4096
T a[150:151],v21,6144
M v[68:71],v[44:47],a[200:203],v[68:71]
s_mov_b32 s25, 2621824
T a[152:153],v21,8192
T a[154:155],v21,10240
M v[68:71],v[48:51],a[208:211],v[68:71]
SA m0,s4,49152
v_lshrrev_b32 v31, 6, v7
v_bfe_u32 v28, v7, 4, 2
M v[68:71],v[52:55],a[216:219],v[68:71]
T a[156:157],v21,12288
T a[158:159],v21,14336
M v[68:71],v[56:59],a[224:227],v[68:71]
T a[160:161],v21,16384
T a[162:163],v21,18432
M v[76:79],v[56:59],a[228:231],0
buffer_load_dwordx4 v8, s[52:55], s25 offen lds
M v[76:79],v[52:55],a[220:223],v[76:79]
s_nop 0
T a[164:165],v21,20480
T a[166:167],v21,22528
M v[76:79],v[48:51],a[212:215],v[76:79]
s_mov_b32 s25, 2883968
T a[168:169],v21,24576
T a[170:171],v21,26624
M v[76:79],v[44:47],a[204:207],v[76:79]
SA m0,s4,53248
v_lshlrev_b32 v31, 5, v31
v_add_lshl_u32 v31, v31, v28, 2
M v[76:79],v[40:43],a[196:199],v[76:79]
SA s3,s93,262144
buffer_load_dword v5, v31, s[8:11], s46 offen offset:4 sc1
M v[76:79],v[36:39],a[188:191],v[76:79]
buffer_load_dwordx4 v8, s[52:55], s25 offen lds
M v[76:79],v[32:35],a[180:183],v[76:79]
s_waitcnt lgkmcnt(6)
MF v140,s5,v140
MF v141,s5,v141
M v[84:87],a[144:147],a[176:179],0
s_mov_b32 s25, 3146112
T v[32:33],v22,0
T v[34:35],v22,2048
M v[84:87],a[148:151],a[184:187],v[84:87]
SA m0,s4,57344
buffer_store_dwordx4 v[128:131], v7, s[8:11], s3 offen offset:0 sc1
M v[84:87],a[152:155],a[192:195],v[84:87]
s_waitcnt lgkmcnt(2)
s_nop 0
T v[36:37],v22,4096
T v[38:39],v22,6144
M v[84:87],a[156:159],a[200:203],v[84:87]
T v[40:41],v22,8192
T v[42:43],v22,10240
M v[84:87],a[160:163],a[208:211],v[84:87]
buffer_load_dwordx4 v8, s[52:55], s25 offen lds
M v[84:87],a[164:167],a[216:219],v[84:87]
s_nop 0
T v[44:45],v22,12288
T v[46:47],v22,14336
M v[84:87],a[168:171],a[224:227],v[84:87]
s_mov_b32 s25, 3408256
T v[48:49],v22,16384
T v[50:51],v22,18432
M v[92:95],a[168:171],a[228:231],0
SA m0,s4,61440
buffer_store_dwordx4 v[136:139], v7, s[8:11], s3 offen offset:1024 sc1
M v[92:95],a[164:167],a[220:223],v[92:95]
s_nop 0
T v[52:53],v22,20480
T v[54:55],v22,22528
M v[92:95],a[160:163],a[212:215],v[92:95]
T v[56:57],v22,24576
T v[58:59],v22,26624
M v[92:95],a[156:159],a[204:207],v[92:95]
buffer_load_dwordx4 v8, s[52:55], s25 offen lds
M v[92:95],a[152:155],a[196:199],v[92:95]
MF v142,s5,v142
MF v143,s5,v143
M v[92:95],a[148:151],a[188:191],v[92:95]
buffer_store_dwordx4 v[144:147], v7, s[8:11], s3 offen offset:2048 sc1
M v[92:95],a[144:147],a[180:183],v[92:95]
s_waitcnt lgkmcnt(6)
MF v156,s5,v156
MF v157,s5,v157
M v[100:103],v[32:35],a[176:179],0
T a[144:145],v23,0
T a[146:147],v23,2048
M v[100:103],v[36:39],a[184:187],v[100:103]
buffer_store_dwordx4 v[152:155], v7, s[8:11], s3 offen offset:3072 sc1
M v[100:103],v[40:43],a[192:195],v[100:103]
s_waitcnt lgkmcnt(2)
s_nop 0
T a[148:149],v23,4096
T a[150:151],v23,6144
M v[100:103],v[44:47],a[200:203],v[100:103]
T a[152:153],v23,8192
T a[154:155],v23,10240
M v[100:103],v[48:51],a[208:211],v[100:103]
MF v158,s5,v158
MF v159,s5,v159
M v[100:103],v[52:55],a[216:219],v[100:103]
T a[156:157],v23,12288
T a[158:159],v23,14336
M v[100:103],v[56:59],a[224:227],v[100:103]
T a[160:161],v23,16384
T a[162:163],v23,18432
M v[108:111],v[56:59],a[228:231],0
C v140,v140,v141
C v141,v142,v143
M v[108:111],v[52:55],a[220:223],v[108:111]
T a[164:165],v23,20480
T a[166:167],v23,22528
M v[108:111],v[48:51],a[212:215],v[108:111]
T a[168:169],v23,24576
T a[170:171],v23,26624
M v[108:111],v[44:47],a[204:207],v[108:111]
C v142,v156,v157
C v143,v158,v159
M v[108:111],v[40:43],a[196:199],v[108:111]
W a40,v140
W a41,v141
M v[108:111],v[36:39],a[188:191],v[108:111]
W a42,v142
W a43,v143
M v[108:111],v[32:35],a[180:183],v[108:111]
s_waitcnt lgkmcnt(6)
v_mov_b32 v8, 0xff800000
MF v164,s5,v164
M v[116:119],a[144:147],a[176:179],0
T v[32:33],v20,28672
T v[34:35],v20,30720
M v[116:119],a[148:151],a[184:187],v[116:119]
MF v165,s5,v165
MF v166,s5,v166
M v[116:119],a[152:155],a[192:195],v[116:119]
s_waitcnt lgkmcnt(2)
T v[36:37],v12,24576
T v[38:39],v12,26624
M v[116:119],a[156:159],a[200:203],v[116:119]
T v[40:41],v12,28672
T v[42:43],v12,30720
M v[116:119],a[160:163],a[208:211],v[116:119]
MF v167,s5,v167
MF v180,s5,v180
M v[116:119],a[164:167],a[216:219],v[116:119]
T v[44:45],v12,0
T v[46:47],v12,2048
M v[116:119],a[168:171],a[224:227],v[116:119]
T v[48:49],v12,4096
T v[50:51],v12,6144
M v[124:127],a[168:171],a[228:231],0
MF v181,s5,v181
MF v182,s5,v182
M v[124:127],a[164:167],a[220:223],v[124:127]
T v[52:53],v12,8192
T v[54:55],v12,10240
M v[124:127],a[160:163],a[212:215],v[124:127]
T v[56:57],v12,12288
T v[58:59],v12,14336
M v[124:127],a[156:159],a[204:207],v[124:127]
MF v183,s5,v183
C v164,v164,v165
M v[124:127],a[152:155],a[196:199],v[124:127]
C v165,v166,v167
C v166,v180,v181
M v[124:127],a[148:151],a[188:191],v[124:127]
C v167,v182,v183
W a12,v164
M v[124:127],a[144:147],a[180:183],v[124:127]
s_waitcnt lgkmcnt(6)
W a13,v165
W a14,v166
M v[68:71],v[32:35],a[232:235],v[68:71]
T a[144:145],v21,28672
T a[146:147],v21,30720
M v[68:71],v[36:39],a[96:99],v[68:71]
W a15,v167
MF v172,s5,v172
M v[68:71],v[40:43],a[104:107],v[68:71]
s_waitcnt lgkmcnt(2)
T a[148:149],v13,24576
T a[150:151],v13,26624
M v[68:71],v[44:47],a[112:115],v[68:71]
T a[152:153],v13,28672
T a[154:155],v13,30720
M v[68:71],v[48:51],a[120:123],v[68:71]
MF v173,s5,v173
MF v174,s5,v174
M v[68:71],v[52:55],a[128:131],v[68:71]
T a[156:157],v13,0
T a[158:159],v13,2048
M v[68:71],v[56:59],a[136:139],v[68:71]
T a[160:161],v13,4096
T a[162:163],v13,6144
M v[76:79],v[56:59],a[140:143],v[76:79]
MF v175,s5,v175
MF v188,s5,v188
M v[76:79],v[52:55],a[132:135],v[76:79]
T a[164:165],v13,8192
T a[166:167],v13,10240
M v[76:79],v[48:51],a[124:127],v[76:79]
T a[168:169],v13,12288
T a[170:171],v13,14336
M v[76:79],v[44:47],a[116:119],v[76:79]
MF v189,s5,v189
MF v190,s5,v190
M v[76:79],v[40:43],a[108:111],v[76:79]
MF v191,s5,v191
C v172,v172,v173
M v[76:79],v[36:39],a[100:103],v[76:79]
C v173,v174,v175
C v174,v188,v189
M v[76:79],v[32:35],a[236:239],v[76:79]
s_waitcnt lgkmcnt(6)
C v175,v190,v191
W a44,v172
M v[84:87],a[144:147],a[232:235],v[84:87]
T v[32:33],v22,28672
T v[34:35],v22,30720
M v[84:87],a[148:151],a[96:99],v[84:87]
W a45,v173
W a46,v174
M v[84:87],a[152:155],a[104:107],v[84:87]
s_waitcnt lgkmcnt(2)
T v[36:37],v14,24576
T v[38:39],v14,26624
M v[84:87],a[156:159],a[112:115],v[84:87]
T v[40:41],v14,28672
T v[42:43],v14,30720
M v[84:87],a[160:163],a[120:123],v[84:87]
W a47,v175
s_waitcnt vmcnt(7)
v_cmp_ne_u32 vcc, 1, v5
M v[84:87],a[164:167],a[128:131],v[84:87]
s_nop 0
T v[44:45],v14,0
T v[46:47],v14,2048
M v[84:87],a[168:171],a[136:139],v[84:87]
s_cmp_lg_u32 vcc_lo, 0
T v[48:49],v14,4096
T v[50:51],v14,6144
M v[92:95],a[168:171],a[140:143],v[92:95]
s_cbranch_scc1 L_wsq0
L_wrq0:
M v[92:95],a[164:167],a[132:135],v[92:95]
SA m0,s28,98304
T v[52:53],v14,8192
T v[54:55],v14,10240
M v[92:95],a[160:163],a[124:127],v[92:95]
T v[56:57],v14,12288
T v[58:59],v14,14336
M v[92:95],a[156:159],a[116:119],v[92:95]
buffer_load_dwordx4 v3, s[8:11], s21 offen offset:0 sc1 lds
M v[92:95],a[152:155],a[108:111],v[92:95]
MF v68,s5,v68
MF v69,s5,v69
M v[92:95],a[148:151],a[100:103],v[92:95]
buffer_load_dwordx4 v3, s[8:11], s21 offen offset:1024 sc1 lds
M v[92:95],a[144:147],a[236:239],v[92:95]
s_waitcnt lgkmcnt(6)
MF v70,s5,v70
MF v71,s5,v71
M v[100:103],v[32:35],a[232:235],v[100:103]
T a[144:145],v23,28672
T a[146:147],v23,30720
M v[100:103],v[36:39],a[96:99],v[100:103]
buffer_load_dwordx4 v3, s[8:11], s21 offen offset:2048 sc1 lds
M v[100:103],v[40:43],a[104:107],v[100:103]
s_waitcnt lgkmcnt(2)
s_nop 0
T a[148:149],v15,24576
T a[150:151],v15,26624
M v[100:103],v[44:47],a[112:115],v[100:103]
T a[152:153],v15,28672
T a[154:155],v15,30720
M v[100:103],v[48:51],a[120:123],v[100:103]
buffer_load_dwordx4 v3, s[8:11], s21 offen offset:3072 sc1 lds
M v[100:103],v[52:55],a[128:131],v[100:103]
SA m0,s28,102400
T a[156:157],v15,0
T a[158:159],v15,2048
M v[100:103],v[56:59],a[136:139],v[100:103]
T a[160:161],v15,4096
T a[162:163],v15,6144
M v[108:111],v[56:59],a[140:143],v[108:111]
buffer_load_dwordx4 v4, s[8:11], s21 offen offset:0 sc1 lds
M v[108:111],v[52:55],a[132:135],v[108:111]
s_nop 0
T a[164:165],v15,8192
T a[166:167],v15,10240
M v[108:111],v[48:51],a[124:127],v[108:111]
T a[168:169],v15,12288
T a[170:171],v15,14336
M v[108:111],v[44:47],a[116:119],v[108:111]
buffer_load_dwordx4 v4, s[8:11], s21 offen offset:1024 sc1 lds
M v[108:111],v[40:43],a[108:111],v[108:111]
MF v84,s5,v84
MF v85,s5,v85
M v[108:111],v[36:39],a[100:103],v[108:111]
s_waitcnt vmcnt(8) lgkmcnt(0)
buffer_load_dwordx4 v4, s[8:11], s21 offen offset:2048 sc1 lds
M v[108:111],v[32:35],a[236:239],v[108:111]
s_barrier
M v[116:119],a[144:147],a[232:235],v[116:119]
s_nop 0
T v[32:33],v16,0
T v[34:35],v16,2048
M v[116:119],a[148:151],a[96:99],v[116:119]
buffer_load_dwordx4 v4, s[8:11], s21 offen offset:3072 sc1 lds
M v[116:119],a[152:155],a[104:107],v[116:119]
SA s21,s21,32768
T v[36:37],v16,4096
T v[38:39],v16,6144
M v[116:119],a[156:159],a[112:115],v[116:119]
s_sub_u32 s22, s22, 1
T v[40:41],v16,8192
T v[42:43],v16,10240
M v[116:119],a[160:163],a[120:123],v[116:119]
s_cselect_b32 s21, s23, s21
MF v86,s5,v86
MF v87,s5,v87
M v[116:119],a[164:167],a[128:131],v[116:119]
SA m0,s28,65536
T v[44:45],v16,12288
T v[46:47],v16,14336
M v[116:119],a[168:171],a[136:139],v[116:119]
T v[48:49],v16,16384
T v[50:51],v16,18432
M v[124:127],a[168:171],a[140:143],v[124:127]
buffer_load_dwordx4 v3, s[8:11], s21 offen offset:0 sc1 lds
M v[124:127],a[164:167],a[132:135],v[124:127]
s_nop 0
T v[52:53],v16,20480
T v[54:55],v16,22528
M v[124:127],a[160:163],a[124:127],v[124:127]
T v[56:57],v16,24576
T v[58:59],v16,26624
M v[124:127],a[156:159],a[116:119],v[124:127]
buffer_load_dwordx4 v3, s[8:11], s21 offen offset:1024 sc1 lds
M v[124:127],a[152:155],a[108:111],v[124:127]
buffer_load_dword v5, v31, s[8:11], s46 offen offset:4 sc1
M v[124:127],a[148:151],a[100:103],v[124:127]
buffer_load_dwordx4 v3, s[8:11], s21 offen offset:2048 sc1 lds
M v[124:127],a[144:147],a[236:239],v[124:127]
s_waitcnt lgkmcnt(6)
C v68,v68,v69
C v69,v70,v71
M v[132:135],v[32:35],a[176:179],0
T a[144:145],v17,0
T a[146:147],v17,2048
M v[132:135],v[36:39],a[184:187],v[132:135]
buffer_load_dwordx4 v3, s[8:11], s21 offen offset:3072 sc1 lds
M v[132:135],v[40:43],a[192:195],v[132:135]
s_waitcnt lgkmcnt(2)
s_nop 0
T a[148:149],v17,4096
T a[150:151],v17,6144
M v[132:135],v[44:47],a[200:203],v[132:135]
SA m0,s28,69632
T a[152:153],v17,8192
T a[154:155],v17,10240
M v[132:135],v[48:51],a[208:211],v[132:135]
buffer_load_dwordx4 v4, s[8:11], s21 offen offset:0 sc1 lds
M v[132:135],v[52:55],a[216:219],v[132:135]
s_nop 0
T a[156:157],v17,12288
T a[158:159],v17,14336
M v[132:135],v[56:59],a[224:227],v[132:135]
T a[160:161],v17,16384
T a[162:163],v17,18432
M v[140:143],v[56:59],a[228:231],0
buffer_load_dwordx4 v4, s[8:11], s21 offen offset:1024 sc1 lds
M v[140:143],v[52:55],a[220:223],v[140:143]
s_nop 0
T a[164:165],v17,20480
T a[166:167],v17,22528
M v[140:143],v[48:51],a[212:215],v[140:143]
T a[168:169],v17,24576
T a[170:171],v17,26624
M v[140:143],v[44:47],a[204:207],v[140:143]
SA s3,s93,270336
buffer_load_dwordx4 v4, s[8:11], s21 offen offset:2048 sc1 lds
M v[140:143],v[40:43],a[196:199],v[140:143]
C v70,v84,v85
C v71,v86,v87
M v[140:143],v[36:39],a[188:191],v[140:143]
buffer_load_dwordx4 v4, s[8:11], s21 offen offset:3072 sc1 lds
M v[140:143],v[32:35],a[180:183],v[140:143]
s_waitcnt lgkmcnt(6)
W a16,v68
W a17,v69
M v[148:151],a[144:147],a[176:179],0
SA s21,s21,32768
T v[32:33],v18,0
T v[34:35],v18,2048
M v[148:151],a[148:151],a[184:187],v[148:151]
s_sub_u32 s22, s22, 1
buffer_store_dwordx4 v[160:163], v7, s[8:11], s3 offen offset:0 sc1
M v[148:151],a[152:155],a[192:195],v[148:151]
s_waitcnt lgkmcnt(2)
s_nop 0
T v[36:37],v18,4096
T v[38:39],v18,6144
M v[148:151],a[156:159],a[200:203],v[148:151]
s_cselect_b32 s21, s23, s21
T v[40:41],v18,8192
T v[42:43],v18,10240
M v[148:151],a[160:163],a[208:211],v[148:151]
buffer_store_dwordx4 v[168:171], v7, s[8:11], s3 offen offset:1024 sc1
M v[148:151],a[164:167],a[216:219],v[148:151]
s_nop 0
T v[44:45],v18,12288
T v[46:47],v18,14336
M v[148:151],a[168:171],a[224:227],v[148:151]
T v[48:49],v18,16384
T v[50:51],v18,18432
M v[156:159],a[168:171],a[228:231],0
buffer_store_dwordx4 v[176:179], v7, s[8:11], s3 offen offset:2048 sc1
M v[156:159],a[164:167],a[220:223],v[156:159]
s_nop 0
T v[52:53],v18,20480
T v[54:55],v18,22528
M v[156:159],a[160:163],a[212:215],v[156:159]
T v[56:57],v18,24576
T v[58:59],v18,26624
M v[156:159],a[156:159],a[204:207],v[156:159]
buffer_store_dwordx4 v[184:187], v7, s[8:11], s3 offen offset:3072 sc1
M v[156:159],a[152:155],a[196:199],v[156:159]
W a18,v70
W a19,v71
M v[156:159],a[148:151],a[188:191],v[156:159]
MF v76,s5,v76
MF v77,s5,v77
M v[156:159],a[144:147],a[180:183],v[156:159]
s_waitcnt lgkmcnt(6)
MF v78,s5,v78
MF v79,s5,v79
M v[164:167],v[32:35],a[176:179],0
T a[144:145],v19,0
T a[146:147],v19,2048
M v[164:167],v[36:39],a[184:187],v[164:167]
MF v92,s5,v92
MF v93,s5,v93
M v[164:167],v[40:43],a[192:195],v[164:167]
s_waitcnt lgkmcnt(2)
T a[148:149],v19,4096
T a[150:151],v19,6144
M v[164:167],v[44:47],a[200:203],v[164:167]
T a[152:153],v19,8192
T a[154:155],v19,10240
M v[164:167],v[48:51],a[208:211],v[164:167]
MF v94,s5,v94
MF v95,s5,v95
M v[164:167],v[52:55],a[216:219],v[164:167]
T a[156:157],v19,12288
T a[158:159],v19,14336
M v[164:167],v[56:59],a[224:227],v[164:167]
T a[160:161],v19,16384
T a[162:163],v19,18432
M v[172:175],v[56:59],a[228:231],0
C v76,v76,v77
C v77,v78,v79
M v[172:175],v[52:55],a[220:223],v[172:175]
T a[164:165],v19,20480
T a[166:167],v19,22528
M v[172:175],v[48:51],a[212:215],v[172:175]
T a[168:169],v19,24576
T a[170:171],v19,26624
M v[172:175],v[44:47],a[204:207],v[172:175]
C v78,v92,v93
C v79,v94,v95
M v[172:175],v[40:43],a[196:199],v[172:175]
W a48,v76
W a49,v77
M v[172:175],v[36:39],a[188:191],v[172:175]
W a50,v78
W a51,v79
M v[172:175],v[32:35],a[180:183],v[172:175]
s_waitcnt lgkmcnt(6)
v_mov_b32 v30, 2
MF v100,s5,v100
M v[180:183],a[144:147],a[176:179],0
T v[32:33],v16,28672
T v[34:35],v16,30720
M v[180:183],a[148:151],a[184:187],v[180:183]
buffer_store_dword v30, v1, s[8:11], s45 offen sc1
M v[180:183],a[152:155],a[192:195],v[180:183]
s_waitcnt lgkmcnt(2)
s_nop 0
T v[36:37],v16,40960
T v[38:39],v16,43008
M v[180:183],a[156:159],a[200:203],v[180:183]
T v[40:41],v16,45056
T v[42:43],v16,47104
M v[180:183],a[160:163],a[208:211],v[180:183]
MF v101,s5,v101
MF v102,s5,v102
M v[180:183],a[164:167],a[216:219],v[180:183]
T v[44:45],v16,49152
T v[46:47],v16,51200
M v[180:183],a[168:171],a[224:227],v[180:183]
T v[48:49],v16,53248
T v[50:51],v16,55296
M v[188:191],a[168:171],a[228:231],0
MF v103,s5,v103
MF v116,s5,v116
M v[188:191],a[164:167],a[220:223],v[188:191]
T v[52:53],v16,57344
T v[54:55],v16,59392
M v[188:191],a[160:163],a[212:215],v[188:191]
T v[56:57],v16,61440
T v[58:59],v16,63488
M v[188:191],a[156:159],a[204:207],v[188:191]
MF v117,s5,v117
MF v118,s5,v118
M v[188:191],a[152:155],a[196:199],v[188:191]
MF v119,s5,v119
C v100,v100,v101
M v[188:191],a[148:151],a[188:191],v[188:191]
C v101,v102,v103
C v102,v116,v117
M v[188:191],a[144:147],a[180:183],v[188:191]
s_waitcnt lgkmcnt(6)
C v103,v118,v119
W a20,v100
M v[132:135],v[32:35],a[232:235],v[132:135]
T a[144:145],v17,28672
T a[146:147],v17,30720
M v[132:135],v[36:39],a[96:99],v[132:135]
W a21,v101
W a22,v102
M v[132:135],v[40:43],a[104:107],v[132:135]
s_waitcnt lgkmcnt(2)
T a[148:149],v17,40960
T a[150:151],v17,43008
M v[132:135],v[44:47],a[112:115],v[132:135]
T a[152:153],v17,45056
T a[154:155],v17,47104
M v[132:135],v[48:51],a[120:123],v[132:135]
W a23,v103
MF v108,s5,v108
M v[132:135],v[52:55],a[128:131],v[132:135]
T a[156:157],v17,49152
T a[158:159],v17,51200
M v[132:135],v[56:59],a[136:139],v[132:135]
T a[160:161],v17,53248
T a[162:163],v17,55296
M v[140:143],v[56:59],a[140:143],v[140:143]
MF v109,s5,v109
MF v110,s5,v110
M v[140:143],v[52:55],a[132:135],v[140:143]
T a[164:165],v17,57344
T a[166:167],v17,59392
M v[140:143],v[48:51],a[124:127],v[140:143]
T a[168:169],v17,61440
T a[170:171],v17,63488
M v[140:143],v[44:47],a[116:119],v[140:143]
MF v111,s5,v111
MF v124,s5,v124
M v[140:143],v[40:43],a[108:111],v[140:143]
MF v125,s5,v125
MF v126,s5,v126
M v[140:143],v[36:39],a[100:103],v[140:143]
MF v127,s5,v127
C v108,v108,v109
M v[140:143],v[32:35],a[236:239],v[140:143]
s_waitcnt lgkmcnt(6)
C v109,v110,v111
C v110,v124,v125
M v[148:151],a[144:147],a[232:235],v[148:151]
T v[32:33],v18,28672
T v[34:35],v18,30720
M v[148:151],a[148:151],a[96:99],v[148:151]
C v111,v126,v127
W a52,v108
M v[148:151],a[152:155],a[104:107],v[148:151]
s_waitcnt lgkmcnt(2)
T v[36:37],v18,40960
T v[38:39],v18,43008
M v[148:151],a[156:159],a[112:115],v[148:151]
T v[40:41],v18,45056
T v[42:43],v18,47104
M v[148:151],a[160:163],a[120:123],v[148:151]
W a53,v109
W a54,v110
M v[148:151],a[164:167],a[128:131],v[148:151]
T v[44:45],v18,49152
T v[46:47],v18,51200
M v[148:151],a[168:171],a[136:139],v[148:151]
T v[48:49],v18,53248
T v[50:51],v18,55296
M v[156:159],a[168:171],a[140:143],v[156:159]
W a55,v111
s_waitcnt vmcnt(11)
v_cmp_ne_u32 vcc, 1, v5
M v[156:159],a[164:167],a[132:135],v[156:159]
s_nop 0
T v[52:53],v18,57344
T v[54:55],v18,59392
M v[156:159],a[160:163],a[124:127],v[156:159]
s_cmp_lg_u32 vcc_hi, 0
T v[56:57],v18,61440
T v[58:59],v18,63488
M v[156:159],a[156:159],a[116:119],v[156:159]
s_cbranch_scc1 L_wsr0
L_wrr0:
MF v132,s5,v132
MF v133,s5,v133
M v[156:159],a[152:155],a[108:111],v[156:159]
SA m0,s28,131072
MF v134,s5,v134
MF v135,s5,v135
M v[156:159],a[148:151],a[100:103],v[156:159]
buffer_load_dwordx4 v3, s[8:11], s26 offen offset:0 sc1 lds
M v[156:159],a[144:147],a[236:239],v[156:159]
s_waitcnt lgkmcnt(6)
MF v148,s5,v148
MF v149,s5,v149
M v[164:167],v[32:35],a[232:235],v[164:167]
T a[144:145],v19,28672
T a[146:147],v19,30720
M v[164:167],v[36:39],a[96:99],v[164:167]
buffer_load_dwordx4 v3, s[8:11], s26 offen offset:1024 sc1 lds
M v[164:167],v[40:43],a[104:107],v[164:167]
s_waitcnt lgkmcnt(2)
s_nop 0
T a[148:149],v19,40960
T a[150:151],v19,43008
M v[164:167],v[44:47],a[112:115],v[164:167]
T a[152:153],v19,45056
T a[154:155],v19,47104
M v[164:167],v[48:51],a[120:123],v[164:167]
buffer_load_dwordx4 v3, s[8:11], s26 offen offset:2048 sc1 lds
M v[164:167],v[52:55],a[128:131],v[164:167]
s_nop 0
T a[156:157],v19,49152
T a[158:159],v19,51200
M v[164:167],v[56:59],a[136:139],v[164:167]
T a[160:161],v19,53248
T a[162:163],v19,55296
M v[172:175],v[56:59],a[140:143],v[172:175]
buffer_load_dwordx4 v3, s[8:11], s26 offen offset:3072 sc1 lds
M v[172:175],v[52:55],a[132:135],v[172:175]
SA m0,s28,135168
T a[164:165],v19,57344
T a[166:167],v19,59392
M v[172:175],v[48:51],a[124:127],v[172:175]
T a[168:169],v19,61440
T a[170:171],v19,63488
M v[172:175],v[44:47],a[116:119],v[172:175]
buffer_load_dwordx4 v4, s[8:11], s26 offen offset:0 sc1 lds
M v[172:175],v[40:43],a[108:111],v[172:175]
MF v150,s5,v150
MF v151,s5,v151
M v[172:175],v[36:39],a[100:103],v[172:175]
s_waitcnt lgkmcnt(0)
buffer_load_dwordx4 v4, s[8:11], s26 offen offset:1024 sc1 lds
M v[172:175],v[32:35],a[236:239],v[172:175]
s_barrier
M v[180:183],a[144:147],a[232:235],v[180:183]
R a[64:67],v2,32768
R a[68:71],v2,33792
M v[180:183],a[148:151],a[96:99],v[180:183]
buffer_load_dwordx4 v4, s[8:11], s26 offen offset:2048 sc1 lds
M v[180:183],a[152:155],a[104:107],v[180:183]
C v132,v132,v133
C v133,v134,v135
M v[180:183],a[156:159],a[112:115],v[180:183]
R a[72:75],v2,34816
R a[76:79],v2,35840
M v[180:183],a[160:163],a[120:123],v[180:183]
buffer_load_dwordx4 v4, s[8:11], s26 offen offset:3072 sc1 lds
M v[180:183],a[164:167],a[128:131],v[180:183]
SA s26,s26,32768
C v134,v148,v149
C v135,v150,v151
M v[180:183],a[168:171],a[136:139],v[180:183]
R a[80:83],v2,36864
R a[84:87],v2,37888
M v[188:191],a[168:171],a[140:143],v[188:191]
W a24,v132
W a25,v133
M v[188:191],a[164:167],a[132:135],v[188:191]
W a26,v134
W a27,v135
M v[188:191],a[160:163],a[124:127],v[188:191]
R a[88:91],v2,38912
R a[92:95],v2,39936
M v[188:191],a[156:159],a[116:119],v[188:191]
MF v140,s5,v140
MF v141,s5,v141
M v[188:191],a[152:155],a[108:111],v[188:191]
MF v142,s5,v142
MF v143,s5,v143
M v[188:191],a[148:151],a[100:103],v[188:191]
MF v156,s5,v156
MF v157,s5,v157
M v[188:191],a[144:147],a[236:239],v[188:191]
s_waitcnt lgkmcnt(0)
MF v158,s5,v158
MF v159,s5,v159
C v140,v140,v141
C v141,v142,v143
C v142,v156,v157
C v143,v158,v159
W a56,v140
W a57,v141
W a58,v142
W a59,v143
s_cmp_eq_u32 s42, 0
s_cbranch_scc1 L_j0
M v[64:67],a[64:67],a[0:3],0
R a[96:99],v2,40960
R a[100:103],v2,41984
M v[64:67],a[68:71],a[4:7],v[64:67]
MF v164,s5,v164
MF v165,s5,v165
M v[64:67],a[72:75],a[8:11],v[64:67]
MF v166,s5,v166
MF v167,s5,v167
M v[64:67],a[76:79],a[12:15],v[64:67]
R a[104:107],v2,43008
R a[108:111],v2,44032
M v[64:67],a[80:83],a[16:19],v[64:67]
MF v180,s5,v180
MF v181,s5,v181
MF v182,s5,v182
MF v183,s5,v183
C v164,v164,v165
C v165,v166,v167
C v166,v180,v181
C v167,v182,v183
W a28,v164
W a29,v165
W a30,v166
W a31,v167
M v[64:67],a[84:87],a[20:23],v[64:67]
MF v172,s5,v172
MF v173,s5,v173
M v[64:67],a[88:91],a[24:27],v[64:67]
R a[112:115],v2,45056
R a[116:119],v2,46080
M v[64:67],a[92:95],a[28:31],v[64:67]
MF v174,s5,v174
MF v175,s5,v175
M v[68:71],a[64:67],a[32:35],0
MF v188,s5,v188
MF v189,s5,v189
M v[68:71],a[68:71],a[36:39],v[68:71]
R a[120:123],v2,47104
R a[124:127],v2,48128
M v[68:71],a[72:75],a[40:43],v[68:71]
SA m0,s28,32768
MF v190,s5,v190
MF v191,s5,v191
M v[68:71],a[76:79],a[44:47],v[68:71]
SA s3,s93,786432
buffer_load_dwordx4 v3, s[8:11], s26 offen offset:0 sc1 lds
M v[68:71],a[80:83],a[48:51],v[68:71]
C v172,v172,v173
C v173,v174,v175
C v174,v188,v189
C v175,v190,v191
W a60,v172
W a61,v173
W a62,v174
W a63,v175
M v[68:71],a[84:87],a[52:55],v[68:71]
E v18,v64
M v[68:71],a[88:91],a[56:59],v[68:71]
buffer_store_dwordx4 v[192:195], v7, s[8:11], s3 offen offset:0 sc1
M v[68:71],a[92:95],a[60:63],v[68:71]
s_waitcnt lgkmcnt(0)
E v19,v65
M v[72:75],a[96:99],a[0:3],0
R a[64:67],v2,49152
R a[68:71],v2,50176
M v[72:75],a[100:103],a[4:7],v[72:75]
buffer_load_dwordx4 v3, s[8:11], s26 offen offset:1024 sc1 lds
M v[72:75],a[104:107],a[8:11],v[72:75]
E v20,v66
M v[72:75],a[108:111],a[12:15],v[72:75]
R a[72:75],v2,51200
R a[76:79],v2,52224
M v[72:75],a[112:115],a[16:19],v[72:75]
buffer_load_dwordx4 v3, s[8:11], s26 offen offset:2048 sc1 lds
M v[72:75],a[116:119],a[20:23],v[72:75]
E v21,v67
M v[72:75],a[120:123],a[24:27],v[72:75]
R a[80:83],v2,53248
R a[84:87],v2,54272
M v[72:75],a[124:127],a[28:31],v[72:75]
buffer_load_dwordx4 v3, s[8:11], s26 offen offset:3072 sc1 lds
M v[76:79],a[124:127],a[60:63],0
SA m0,s28,36864
E v22,v68
M v[76:79],a[120:123],a[56:59],v[76:79]
R a[88:91],v2,55296
R a[92:95],v2,56320
M v[76:79],a[116:119],a[52:55],v[76:79]
buffer_load_dwordx4 v4, s[8:11], s26 offen offset:0 sc1 lds
M v[76:79],a[112:115],a[48:51],v[76:79]
E v23,v69
M v[76:79],a[108:111],a[44:47],v[76:79]
AF v26,v18,v19
C v40,v18,v19
M v[76:79],a[104:107],a[40:43],v[76:79]
buffer_load_dwordx4 v4, s[8:11], s26 offen offset:1024 sc1 lds
M v[76:79],a[100:103],a[36:39],v[76:79]
v_add_u32 v16, 0x20000, v7
AF v26,v20,v26
M v[76:79],a[96:99],a[32:35],v[76:79]
s_waitcnt lgkmcnt(0)
E v24,v70
M v[80:83],a[64:67],a[0:3],0
R a[96:99],v2,57344
R a[100:103],v2,58368
M v[80:83],a[68:71],a[4:7],v[80:83]
buffer_load_dwordx4 v4, s[8:11], s26 offen offset:2048 sc1 lds
M v[80:83],a[72:75],a[8:11],v[80:83]
E v25,v71
M v[80:83],a[76:79],a[12:15],v[80:83]
R a[104:107],v2,59392
R a[108:111],v2,60416
M v[80:83],a[80:83],a[16:19],v[80:83]
buffer_store_dwordx4 v[200:203], v7, s[8:11], s3 offen offset:1024 sc1
M v[80:83],a[84:87],a[20:23],v[80:83]
E v18,v72
M v[80:83],a[88:91],a[24:27],v[80:83]
R a[112:115],v2,61440
R a[116:119],v2,62464
M v[80:83],a[92:95],a[28:31],v[80:83]
buffer_load_dwordx4 v4, s[8:11], s26 offen offset:3072 sc1 lds
M v[84:87],a[92:95],a[60:63],0
SA s26,s26,32768
E v19,v73
M v[84:87],a[88:91],a[56:59],v[84:87]
R a[120:123],v2,63488
R a[124:127],v2,64512
M v[84:87],a[84:87],a[52:55],v[84:87]
C v41,v20,v21
AF v26,v21,v26
M v[84:87],a[80:83],a[48:51],v[84:87]
buffer_store_dwordx4 v[208:211], v7, s[8:11], s3 offen offset:2048 sc1
M v[84:87],a[76:79],a[44:47],v[84:87]
E v20,v74
M v[84:87],a[72:75],a[40:43],v[84:87]
AF v27,v22,v23
C v44,v22,v23
M v[84:87],a[68:71],a[36:39],v[84:87]
s_waitcnt vmcnt(24) lgkmcnt(0)
E v21,v75
M v[84:87],a[64:67],a[32:35],v[84:87]
s_barrier
M v[88:91],a[96:99],a[0:3],0
R a[64:67],v2,0
R a[68:71],v2,1024
M v[88:91],a[100:103],a[4:7],v[88:91]
E v22,v76
M v[88:91],a[104:107],a[8:11],v[88:91]
AF v27,v24,v27
C v45,v24,v25
M v[88:91],a[108:111],a[12:15],v[88:91]
R a[72:75],v2,2048
R a[76:79],v2,3072
M v[88:91],a[112:115],a[16:19],v[88:91]
E v23,v77
M v[88:91],a[116:119],a[20:23],v[88:91]
AF v27,v25,v27
AF v26,v18,v26
M v[88:91],a[120:123],a[24:27],v[88:91]
R a[80:83],v2,4096
R a[84:87],v2,5120
M v[88:91],a[124:127],a[28:31],v[88:91]
E v24,v78
M v[92:95],a[124:127],a[60:63],0
C v42,v18,v19
AF v26,v19,v26
M v[92:95],a[120:123],a[56:59],v[92:95]
R a[88:91],v2,6144
R a[92:95],v2,7168
M v[92:95],a[116:119],a[52:55],v[92:95]
E v25,v79
M v[92:95],a[112:115],a[48:51],v[92:95]
AF v26,v20,v26
C v43,v20,v21
M v[92:95],a[108:111],a[44:47],v[92:95]
AF v26,v21,v26
AF v27,v22,v27
M v[92:95],a[104:107],a[40:43],v[92:95]
C v46,v22,v23
AF v27,v23,v27
M v[92:95],a[100:103],a[36:39],v[92:95]
s_waitcnt lgkmcnt(0)
AF v27,v24,v27
C v47,v24,v25
M v[92:95],a[96:99],a[32:35],v[92:95]
AF v27,v25,v27
M v[96:99],a[64:67],a[0:3],0
R a[96:99],v2,8192
R a[100:103],v2,9216
M v[96:99],a[68:71],a[4:7],v[96:99]
SA m0,s28,98304
E v18,v80
M v[96:99],a[72:75],a[8:11],v[96:99]
buffer_load_dwordx4 v3, s[8:11], s21 offen offset:0 sc1 lds
M v[96:99],a[76:79],a[12:15],v[96:99]
R a[104:107],v2,10240
R a[108:111],v2,11264
M v[96:99],a[80:83],a[16:19],v[96:99]
v_mov_b32 v30, 0
M v[96:99],a[84:87],a[20:23],v[96:99]
E v19,v81
M v[96:99],a[88:91],a[24:27],v[96:99]
R a[112:115],v2,12288
R a[116:119],v2,13312
M v[96:99],a[92:95],a[28:31],v[96:99]
buffer_load_dwordx4 v3, s[8:11], s21 offen offset:1024 sc1 lds
M v[100:103],a[92:95],a[60:63],0
v_mov_b32 v31, 0
AF v26,v18,v26
M v[100:103],a[88:91],a[56:59],v[100:103]
R a[120:123],v2,14336
R a[124:127],v2,15360
M v[100:103],a[84:87],a[52:55],v[100:103]
SA s3,s93,786432
E v20,v82
M v[100:103],a[80:83],a[48:51],v[100:103]
buffer_load_dwordx4 v3, s[8:11], s21 offen offset:2048 sc1 lds
M v[100:103],a[76:79],a[44:47],v[100:103]
E v21,v83
M v[100:103],a[72:75],a[40:43],v[100:103]
v_mov_b32 v32, 0
C v56,v18,v19
M v[100:103],a[68:71],a[36:39],v[100:103]
buffer_store_dwordx4 v[216:219], v7, s[8:11], s3 offen offset:3072 sc1
M v[100:103],a[64:67],a[32:35],v[100:103]
s_waitcnt lgkmcnt(0)
E v22,v88
M v[108:111],a[96:99],a[32:35],0
R a[64:67],v2,16384
R a[68:71],v2,17408
M v[108:111],a[100:103],a[36:39],v[108:111]
buffer_load_dwordx4 v3, s[8:11], s21 offen offset:3072 sc1 lds
M v[108:111],a[104:107],a[40:43],v[108:111]
SA m0,s28,102400
v_mov_b32 v33, 0
AF v26,v19,v26
M v[108:111],a[108:111],a[44:47],v[108:111]
R a[72:75],v2,18432
R a[76:79],v2,19456
M v[108:111],a[112:115],a[48:51],v[108:111]
buffer_load_dwordx4 v4, s[8:11], s21 offen offset:0 sc1 lds
M v[108:111],a[116:119],a[52:55],v[108:111]
E v23,v89
M v[108:111],a[120:123],a[56:59],v[108:111]
R a[80:83],v2,20480
R a[84:87],v2,21504
M v[108:111],a[124:127],a[60:63],v[108:111]
buffer_load_dwordx4 v4, s[8:11], s21 offen offset:1024 sc1 lds
M v[104:107],a[124:127],a[28:31],0
v_mov_b32 v34, 0
AF v26,v20,v26
M v[104:107],a[120:123],a[24:27],v[104:107]
SA s3,s93,794624
R a[88:91],v2,22528
R a[92:95],v2,23552
M v[104:107],a[116:119],a[20:23],v[104:107]
buffer_load_dwordx4 v4, s[8:11], s21 offen offset:2048 sc1 lds
M v[104:107],a[112:115],a[16:19],v[104:107]
v_mov_b32 v35, 0
C v57,v20,v21
M v[104:107],a[108:111],a[12:15],v[104:107]
E v24,v90
M v[104:107],a[104:107],a[8:11],v[104:107]
E v25,v91
M v[104:107],a[100:103],a[4:7],v[104:107]
buffer_load_dwordx4 v4, s[8:11], s21 offen offset:3072 sc1 lds
M v[104:107],a[96:99],a[0:3],v[104:107]
s_waitcnt lgkmcnt(0)
v_mov_b32 v36, 0
AF v26,v21,v26
M v[112:115],a[64:67],a[0:3],0
SA s21,s21,32768
R a[96:99],v2,24576
R a[100:103],v2,25600
M v[112:115],a[68:71],a[4:7],v[112:115]
s_sub_u32 s22, s22, 1
buffer_store_dwordx4 v[224:227], v7, s[8:11], s3 offen offset:0 sc1
M v[112:115],a[72:75],a[8:11],v[112:115]
s_cselect_b32 s21, s23, s21
E v18,v84
M v[112:115],a[76:79],a[12:15],v[112:115]
R a[104:107],v2,26624
R a[108:111],v2,27648
M v[112:115],a[80:83],a[16:19],v[112:115]
v_mov_b32 v37, 0
AF v26,v22,v26
M v[112:115],a[84:87],a[20:23],v[112:115]
E v19,v85
M v[112:115],a[88:91],a[24:27],v[112:115]
R a[112:115],v2,28672
R a[116:119],v2,29696
M v[112:115],a[92:95],a[28:31],v[112:115]
E v20,v86
M v[116:119],a[92:95],a[60:63],0
v_mov_b32 v38, 0
C v58,v22,v23
M v[116:119],a[88:91],a[56:59],v[116:119]
R a[120:123],v2,30720
R a[124:127],v2,31744
M v[116:119],a[84:87],a[52:55],v[116:119]
E v21,v87
M v[116:119],a[80:83],a[48:51],v[116:119]
buffer_store_dwordx4 v[232:235], v7, s[8:11], s3 offen offset:1024 sc1
M v[116:119],a[76:79],a[44:47],v[116:119]
AF v26,v23,v26
AF v26,v24,v26
M v[116:119],a[72:75],a[40:43],v[116:119]
v_mov_b32 v39, 0
C v59,v24,v25
M v[116:119],a[68:71],a[36:39],v[116:119]
s_waitcnt vmcnt(22) lgkmcnt(0)
E v22,v92
M v[116:119],a[64:67],a[32:35],v[116:119]
s_barrier
M v[124:127],a[96:99],a[32:35],0
R a[64:67],v16,0
R a[68:71],v16,1024
M v[124:127],a[100:103],a[36:39],v[124:127]
E v23,v93
M v[124:127],a[104:107],a[40:43],v[124:127]
AF v26,v25,v26
AF v27,v18,v27
M v[124:127],a[108:111],a[44:47],v[124:127]
R a[72:75],v16,2048
R a[76:79],v16,3072
M v[124:127],a[112:115],a[48:51],v[124:127]
E v24,v94
M v[124:127],a[116:119],a[52:55],v[124:127]
E v25,v95
M v[124:127],a[120:123],a[56:59],v[124:127]
R a[80:83],v16,4096
R a[84:87],v16,5120
M v[124:127],a[124:127],a[60:63],v[124:127]
C v60,v18,v19
AF v27,v19,v27
M v[120:123],a[124:127],a[28:31],0
AF v27,v20,v27
C v61,v20,v21
M v[120:123],a[120:123],a[24:27],v[120:123]
R a[88:91],v16,6144
R a[92:95],v16,7168
M v[120:123],a[116:119],a[20:23],v[120:123]
AF v27,v21,v27
AF v27,v22,v27
M v[120:123],a[112:115],a[16:19],v[120:123]
C v62,v22,v23
AF v27,v23,v27
M v[120:123],a[108:111],a[12:15],v[120:123]
AF v27,v24,v27
C v63,v24,v25
M v[120:123],a[104:107],a[8:11],v[120:123]
AF v27,v25,v27
M v[120:123],a[100:103],a[4:7],v[120:123]
s_waitcnt lgkmcnt(0)
M v[120:123],a[96:99],a[0:3],v[120:123]
v_max_f32 v10, v26, v27
v_min_f32 v11, v26, v27
v_cmp_lt_f32 vcc, s31, v10
v_cmp_gt_f32 s[64:65], s24, v11
s_nop 0
s_or_b64 vcc, vcc, s[64:65]
s_cbranch_vccnz L_stk1
L_rtk1:
M v[128:131],a[64:67],v[40:43],0
R a[96:99],v16,8192
R a[100:103],v16,9216
M v[128:131],a[68:71],v[56:59],v[128:131]
SA m0,s28,65536
E v18,v96
M v[132:135],a[68:71],v[60:63],0
buffer_load_dwordx4 v3, s[8:11], s21 offen offset:0 sc1 lds
M v[132:135],a[64:67],v[44:47],v[132:135]
R a[104:107],v16,10240
R a[108:111],v16,11264
M v[140:143],a[72:75],v[44:47],0
SA s3,s93,794624
E v19,v97
M v[140:143],a[76:79],v[60:63],v[140:143]
AF v30,v26,v30
AF v31,v27,v31
M v[136:139],a[76:79],v[56:59],0
R a[112:115],v16,12288
R a[116:119],v16,13312
M v[136:139],a[72:75],v[40:43],v[136:139]
buffer_load_dwordx4 v3, s[8:11], s21 offen offset:1024 sc1 lds
M v[144:147],a[80:83],v[40:43],0
E v20,v98
M v[144:147],a[84:87],v[56:59],v[144:147]
R a[120:123],v16,14336
R a[124:127],v16,15360
M v[148:151],a[84:87],v[60:63],0
buffer_store_dwordx4 v[240:243], v7, s[8:11], s3 offen offset:2048 sc1
M v[148:151],a[80:83],v[44:47],v[148:151]
E v21,v99
M v[156:159],a[88:91],v[44:47],0
AF v28,v18,v19
C v48,v18,v19
M v[156:159],a[92:95],v[60:63],v[156:159]
buffer_load_dwordx4 v3, s[8:11], s21 offen offset:2048 sc1 lds
M v[152:155],a[92:95],v[56:59],0
AF v28,v20,v28
C v49,v20,v21
M v[152:155],a[88:91],v[40:43],v[152:155]
s_waitcnt lgkmcnt(0)
E v22,v104
M v[160:163],a[96:99],v[40:43],0
R a[64:67],v16,16384
R a[68:71],v16,17408
M v[160:163],a[100:103],v[56:59],v[160:163]
buffer_load_dwordx4 v3, s[8:11], s21 offen offset:3072 sc1 lds
M v[164:167],a[100:103],v[60:63],0
SA m0,s28,69632
E v23,v105
M v[164:167],a[96:99],v[44:47],v[164:167]
R a[72:75],v16,18432
R a[76:79],v16,19456
M v[172:175],a[104:107],v[44:47],0
buffer_load_dwordx4 v4, s[8:11], s21 offen offset:0 sc1 lds
M v[172:175],a[108:111],v[60:63],v[172:175]
AF v28,v21,v28
AF v28,v22,v28
M v[168:171],a[108:111],v[56:59],0
R a[80:83],v16,20480
R a[84:87],v16,21504
M v[168:171],a[104:107],v[40:43],v[168:171]
buffer_store_dwordx4 v[248:251], v7, s[8:11], s3 offen offset:3072 sc1
M v[176:179],a[112:115],v[40:43],0
E v24,v106
M v[176:179],a[116:119],v[56:59],v[176:179]
R a[88:91],v16,22528
R a[92:95],v16,23552
M v[180:183],a[116:119],v[60:63],0
buffer_load_dwordx4 v4, s[8:11], s21 offen offset:1024 sc1 lds
M v[180:183],a[112:115],v[44:47],v[180:183]
E v25,v107
M v[188:191],a[120:123],v[44:47],0
C v50,v22,v23
AF v28,v23,v28
M v[188:191],a[124:127],v[60:63],v[188:191]
buffer_load_dwordx4 v4, s[8:11], s21 offen offset:2048 sc1 lds
M v[184:187],a[124:127],v[56:59],0
E v18,v100
M v[184:187],a[120:123],v[40:43],v[184:187]
s_waitcnt lgkmcnt(0)
AF v28,v24,v28
C v51,v24,v25
M v[192:195],a[64:67],v[40:43],0
R a[96:99],v16,24576
R a[100:103],v16,25600
M v[192:195],a[68:71],v[56:59],v[192:195]
buffer_load_dwordx4 v4, s[8:11], s21 offen offset:3072 sc1 lds
M v[196:199],a[68:71],v[60:63],0
SA s21,s21,32768
E v19,v101
M v[196:199],a[64:67],v[44:47],v[196:199]
s_sub_u32 s22, s22, 1
R a[104:107],v16,26624
R a[108:111],v16,27648
M v[204:207],a[72:75],v[44:47],0
s_cselect_b32 s21, s23, s21
AF v28,v25,v28
AF v29,v18,v19
M v[204:207],a[76:79],v[60:63],v[204:207]
E v20,v102
M v[200:203],a[76:79],v[56:59],0
R a[112:115],v16,28672
R a[116:119],v16,29696
M v[200:203],a[72:75],v[40:43],v[200:203]
C v52,v18,v19
M v[208:211],a[80:83],v[40:43],0
M v[208:211],a[84:87],v[56:59],v[208:211]
R a[120:123],v16,30720
R a[124:127],v16,31744
M v[212:215],a[84:87],v[60:63],0
E v21,v103
M v[212:215],a[80:83],v[44:47],v[212:215]
AF v29,v20,v29
C v53,v20,v21
M v[220:223],a[88:91],v[44:47],0
AF v29,v21,v29
M v[220:223],a[92:95],v[60:63],v[220:223]
E v22,v108
M v[216:219],a[92:95],v[56:59],0
s_waitcnt vmcnt(12) lgkmcnt(0)
M v[216:219],a[88:91],v[40:43],v[216:219]
s_barrier
M v[224:227],a[96:99],v[40:43],0
R a[64:67],v2,32768
R a[68:71],v2,33792
M v[224:227],a[100:103],v[56:59],v[224:227]
E v23,v109
M v[228:231],a[100:103],v[60:63],0
AF v29,v22,v29
C v54,v22,v23
M v[228:231],a[96:99],v[44:47],v[228:231]
R a[72:75],v2,34816
R a[76:79],v2,35840
M v[236:239],a[104:107],v[44:47],0
E v24,v110
M v[236:239],a[108:111],v[60:63],v[236:239]
AF v29,v23,v29
M v[232:235],a[108:111],v[56:59],0
R a[80:83],v2,36864
R a[84:87],v2,37888
M v[232:235],a[104:107],v[40:43],v[232:235]
M v[240:243],a[112:115],v[40:43],0
E v25,v111
M v[240:243],a[116:119],v[56:59],v[240:243]
R a[88:91],v2,38912
R a[92:95],v2,39936
M v[244:247],a[116:119],v[60:63],0
AF v29,v24,v29
C v55,v24,v25
M v[244:247],a[112:115],v[44:47],v[244:247]
AF v29,v25,v29
M v[252:255],a[120:123],v[44:47],0
M v[252:255],a[124:127],v[60:63],v[252:255]
M v[248:251],a[124:127],v[56:59],0
s_waitcnt lgkmcnt(0)
M v[248:251],a[120:123],v[40:43],v[248:251]
s_cmp_lg_u32 s27, 0
s_cbranch_scc1 L_loop_top
s_branch L_d1s
L_j0:
M v[68:71],a[64:67],a[32:35],0
s_cmp_lt_u32 s20, 0
R a[96:99],v2,40960
R a[100:103],v2,41984
M v[68:71],a[68:71],a[36:39],v[68:71]
s_cselect_b64 s[82:83], -1, 0
v_mov_b32 v30, 0
MF v172,s5,v172
M v[68:71],a[72:75],a[40:43],v[68:71]
s_cmp_eq_u32 s20, 0
MF v173,s5,v173
MF v174,s5,v174
M v[68:71],a[76:79],a[44:47],v[68:71]
s_cselect_b64 s[66:67], s[16:17], s[82:83]
R a[104:107],v2,43008
R a[108:111],v2,44032
M v[68:71],a[80:83],a[48:51],v[68:71]
s_cselect_b64 s[68:69], s[18:19], s[82:83]
MF v175,s5,v175
MF v188,s5,v188
M v[68:71],a[84:87],a[52:55],v[68:71]
s_cselect_b64 s[70:71], s[48:49], s[82:83]
MF v189,s5,v189
MF v190,s5,v190
MF v191,s5,v191
C v172,v172,v173
C v173,v174,v175
C v174,v188,v189
C v175,v190,v191
W a60,v172
W a61,v173
W a62,v174
W a63,v175
M v[68:71],a[88:91],a[56:59],v[68:71]
s_cselect_b64 s[72:73], s[50:51], s[82:83]
R a[112:115],v2,45056
R a[116:119],v2,46080
v_cndmask_b32 v64, 0, v8, s[66:67]
v_cndmask_b32 v65, 0, v8, s[68:69]
v_cndmask_b32 v66, 0, v8, s[70:71]
v_cndmask_b32 v67, 0, v8, s[72:73]
M v[68:71],a[92:95],a[60:63],v[68:71]
s_cmp_lt_u32 s20, 1
MF v164,s5,v164
MF v165,s5,v165
M v[64:67],a[64:67],a[0:3],v[64:67]
s_cselect_b64 s[82:83], -1, 0
MF v166,s5,v166
MF v167,s5,v167
M v[64:67],a[68:71],a[4:7],v[64:67]
s_cmp_eq_u32 s20, 1
R a[120:123],v2,47104
R a[124:127],v2,48128
M v[64:67],a[72:75],a[8:11],v[64:67]
s_cselect_b64 s[74:75], s[16:17], s[82:83]
MF v180,s5,v180
MF v181,s5,v181
M v[64:67],a[76:79],a[12:15],v[64:67]
s_cselect_b64 s[76:77], s[18:19], s[82:83]
MF v182,s5,v182
MF v183,s5,v183
M v[64:67],a[80:83],a[16:19],v[64:67]
s_cselect_b64 s[78:79], s[48:49], s[82:83]
C v164,v164,v165
C v165,v166,v167
C v166,v180,v181
C v167,v182,v183
W a28,v164
W a29,v165
W a30,v166
W a31,v167
M v[64:67],a[84:87],a[20:23],v[64:67]
s_cselect_b64 s[80:81], s[50:51], s[82:83]
v_mov_b32 v31, 0
v_cndmask_b32 v72, 0, v8, s[74:75]
M v[64:67],a[88:91],a[24:27],v[64:67]
s_mov_b32 s26, s43
v_mov_b32 v32, 0
M v[64:67],a[92:95],a[28:31],v[64:67]
s_waitcnt lgkmcnt(0)
v_cndmask_b32 v73, 0, v8, s[76:77]
M v[76:79],a[96:99],a[32:35],0
SA m0,s28,0
R a[64:67],v2,49152
R a[68:71],v2,50176
M v[76:79],a[100:103],a[36:39],v[76:79]
SA s3,s93,786432
buffer_load_dwordx4 v3, s[8:11], s26 offen offset:0 sc1 lds
M v[76:79],a[104:107],a[40:43],v[76:79]
v_cndmask_b32 v74, 0, v8, s[78:79]
v_mov_b32 v33, 0
M v[76:79],a[108:111],a[44:47],v[76:79]
R a[72:75],v2,51200
R a[76:79],v2,52224
M v[76:79],a[112:115],a[48:51],v[76:79]
buffer_store_dwordx4 v[192:195], v7, s[8:11], s3 offen offset:0 sc1
M v[76:79],a[116:119],a[52:55],v[76:79]
v_cndmask_b32 v75, 0, v8, s[80:81]
M v[76:79],a[120:123],a[56:59],v[76:79]
s_cmp_lt_u32 s20, 2
R a[80:83],v2,53248
R a[84:87],v2,54272
M v[76:79],a[124:127],a[60:63],v[76:79]
s_cselect_b64 s[82:83], -1, 0
buffer_load_dwordx4 v3, s[8:11], s26 offen offset:1024 sc1 lds
M v[72:75],a[124:127],a[28:31],v[72:75]
s_cmp_eq_u32 s20, 2
E v18,v68
M v[72:75],a[120:123],a[24:27],v[72:75]
s_cselect_b64 s[66:67], s[16:17], s[82:83]
R a[88:91],v2,55296
R a[92:95],v2,56320
M v[72:75],a[116:119],a[20:23],v[72:75]
s_cselect_b64 s[68:69], s[18:19], s[82:83]
buffer_load_dwordx4 v3, s[8:11], s26 offen offset:2048 sc1 lds
M v[72:75],a[112:115],a[16:19],v[72:75]
s_cselect_b64 s[70:71], s[48:49], s[82:83]
v_mov_b32 v34, 0
M v[72:75],a[108:111],a[12:15],v[72:75]
s_cselect_b64 s[72:73], s[50:51], s[82:83]
v_cndmask_b32 v80, 0, v8, s[66:67]
v_cndmask_b32 v81, 0, v8, s[68:69]
M v[72:75],a[104:107],a[8:11],v[72:75]
buffer_store_dwordx4 v[200:203], v7, s[8:11], s3 offen offset:1024 sc1
M v[72:75],a[100:103],a[4:7],v[72:75]
E v19,v69
M v[72:75],a[96:99],a[0:3],v[72:75]
s_waitcnt lgkmcnt(0)
buffer_load_dwordx4 v3, s[8:11], s26 offen offset:3072 sc1 lds
M v[84:87],a[64:67],a[32:35],0
SA m0,s28,4096
R a[96:99],v2,57344
R a[100:103],v2,58368
M v[84:87],a[68:71],a[36:39],v[84:87]
v_cndmask_b32 v82, 0, v8, s[70:71]
v_mov_b32 v35, 0
M v[84:87],a[72:75],a[40:43],v[84:87]
buffer_load_dwordx4 v4, s[8:11], s26 offen offset:0 sc1 lds
M v[84:87],a[76:79],a[44:47],v[84:87]
R a[104:107],v2,59392
R a[108:111],v2,60416
M v[84:87],a[80:83],a[48:51],v[84:87]
buffer_store_dwordx4 v[208:211], v7, s[8:11], s3 offen offset:2048 sc1
M v[84:87],a[84:87],a[52:55],v[84:87]
v_cndmask_b32 v83, 0, v8, s[72:73]
v_mov_b32 v36, 0
M v[84:87],a[88:91],a[56:59],v[84:87]
s_cmp_lt_u32 s20, 3
R a[112:115],v2,61440
R a[116:119],v2,62464
M v[84:87],a[92:95],a[60:63],v[84:87]
s_cselect_b64 s[82:83], -1, 0
buffer_load_dwordx4 v4, s[8:11], s26 offen offset:1024 sc1 lds
M v[80:83],a[92:95],a[28:31],v[80:83]
s_cmp_eq_u32 s20, 3
E v20,v70
M v[80:83],a[88:91],a[24:27],v[80:83]
s_cselect_b64 s[74:75], s[16:17], s[82:83]
R a[120:123],v2,63488
R a[124:127],v2,64512
M v[80:83],a[84:87],a[20:23],v[80:83]
s_cselect_b64 s[76:77], s[18:19], s[82:83]
buffer_load_dwordx4 v4, s[8:11], s26 offen offset:2048 sc1 lds
M v[80:83],a[80:83],a[16:19],v[80:83]
s_cselect_b64 s[78:79], s[48:49], s[82:83]
E v21,v71
M v[80:83],a[76:79],a[12:15],v[80:83]
s_cselect_b64 s[80:81], s[50:51], s[82:83]
buffer_store_dwordx4 v[216:219], v7, s[8:11], s3 offen offset:3072 sc1
M v[80:83],a[72:75],a[8:11],v[80:83]
SA s3,s93,794624
v_cndmask_b32 v88, 0, v8, s[74:75]
v_cndmask_b32 v89, 0, v8, s[76:77]
M v[80:83],a[68:71],a[4:7],v[80:83]
s_waitcnt vmcnt(24) lgkmcnt(0)
buffer_load_dwordx4 v4, s[8:11], s26 offen offset:3072 sc1 lds
M v[80:83],a[64:67],a[0:3],v[80:83]
s_barrier
M v[92:95],a[96:99],a[32:35],0
R a[64:67],v2,0
R a[68:71],v2,1024
M v[92:95],a[100:103],a[36:39],v[92:95]
buffer_store_dwordx4 v[224:227], v7, s[8:11], s3 offen offset:0 sc1
M v[92:95],a[104:107],a[40:43],v[92:95]
v_min_u32 v17, 896, v9
v_cndmask_b32 v90, 0, v8, s[78:79]
M v[92:95],a[108:111],a[44:47],v[92:95]
R a[72:75],v2,2048
R a[76:79],v2,3072
M v[92:95],a[112:115],a[48:51],v[92:95]
buffer_load_dword v5, v17, s[8:11], s46 offen sc1
M v[92:95],a[116:119],a[52:55],v[92:95]
buffer_store_dwordx4 v[232:235], v7, s[8:11], s3 offen offset:1024 sc1
M v[92:95],a[120:123],a[56:59],v[92:95]
R a[80:83],v2,4096
R a[84:87],v2,5120
v_cndmask_b32 v91, 0, v8, s[80:81]
M v[92:95],a[124:127],a[60:63],v[92:95]
v_mov_b32 v37, 0
v_mov_b32 v38, 0
M v[88:91],a[124:127],a[28:31],v[88:91]
buffer_store_dwordx4 v[240:243], v7, s[8:11], s3 offen offset:2048 sc1
M v[88:91],a[120:123],a[24:27],v[88:91]
R a[88:91],v2,6144
R a[92:95],v2,7168
M v[88:91],a[116:119],a[20:23],v[88:91]
v_mov_b32 v39, 0
AF v27,v18,v19
M v[88:91],a[112:115],a[16:19],v[88:91]
buffer_store_dwordx4 v[248:251], v7, s[8:11], s3 offen offset:3072 sc1
M v[88:91],a[108:111],a[12:15],v[88:91]
E v22,v64
M v[88:91],a[104:107],a[8:11],v[88:91]
E v23,v65
M v[88:91],a[100:103],a[4:7],v[88:91]
s_waitcnt lgkmcnt(0)
E v24,v66
M v[88:91],a[96:99],a[0:3],v[88:91]
E v25,v67
C v44,v18,v19
AF v27,v20,v27
C v45,v20,v21
AF v27,v21,v27
AF v26,v22,v23
C v40,v22,v23
E v18,v76
E v19,v77
AF v26,v24,v26
C v41,v24,v25
AF v26,v25,v26
E v20,v78
E v21,v79
AF v27,v18,v27
C v46,v18,v19
AF v27,v19,v27
E v22,v72
E v23,v73
AF v27,v20,v27
C v47,v20,v21
AF v27,v21,v27
E v24,v74
E v25,v75
AF v26,v22,v26
C v42,v22,v23
AF v26,v23,v26
AF v26,v24,v26
C v43,v24,v25
AF v26,v25,v26
v_mov_b32 v56, 0
v_mov_b32 v57, 0
v_mov_b32 v58, 0
v_mov_b32 v59, 0
s_mul_i32 s21, s41, 1048576
SA s21,s21,589824
s_lshl_b32 s84, s42, 1
s_sub_u32 s22, 11, s84
s_mov_b32 s23, 536870912
s_lshl_b32 s86, s20, 14
SA s86,s86,s34
SA s87,s86,4096
SA s88,s86,8192
SA s89,s86,12288
s_lshl_b32 s90, s20, 10
SA s90,s90,s34
SA s90,s90,65536
s_waitcnt vmcnt(3)
v_cmp_gt_u32 vcc, 2, v5
s_nop 0
s_cbranch_vccnz L_lsj0
L_lrj0:
SA m0,s28,98304
v_mov_b32 v10, v26
buffer_load_dwordx4 v3, s[8:11], s21 offen offset:0 sc1 lds
v_mov_b32 v11, v27
buffer_load_dwordx4 v3, s[8:11], s21 offen offset:1024 sc1 lds
v_mov_b32 v12, v10
v_mov_b32 v13, v11
buffer_load_dwordx4 v3, s[8:11], s21 offen offset:2048 sc1 lds
v_permlane16_swap_b32 v12, v10
v_permlane16_swap_b32 v13, v11
buffer_load_dwordx4 v3, s[8:11], s21 offen offset:3072 sc1 lds
v_max_f32 v10, v12, v10
SA m0,s28,102400
v_max_f32 v11, v13, v11
buffer_load_dwordx4 v4, s[8:11], s21 offen offset:0 sc1 lds
v_mov_b32 v12, v10
v_mov_b32 v13, v11
buffer_load_dwordx4 v4, s[8:11], s21 offen offset:1024 sc1 lds
v_permlane32_swap_b32 v12, v10
v_permlane32_swap_b32 v13, v11
buffer_load_dwordx4 v4, s[8:11], s21 offen offset:2048 sc1 lds
v_max_f32 v10, v12, v10
v_max_f32 v11, v13, v11
buffer_load_dwordx4 v4, s[8:11], s21 offen offset:3072 sc1 lds
SA s21,s21,32768
s_sub_u32 s22, s22, 1
s_cselect_b32 s21, s23, s21
v_min_f32 v10, v10, v11
v_cmp_gt_f32 vcc, s24, v10
s_nop 0
s_cbranch_vccnz L_stj0
L_rtj0:
s_cmp_gt_u32 s20, 3
s_cselect_b64 s[82:83], -1, 0
s_cmp_eq_u32 s20, 3
s_cselect_b64 s[66:67], s[16:17], s[82:83]
v_mfma_f32_32x32x16_bf16 v[128:143], v[56:59], v[56:59], 0
s_cselect_b64 s[68:69], s[18:19], s[82:83]
s_cselect_b64 s[70:71], s[48:49], s[82:83]
s_cselect_b64 s[72:73], s[50:51], s[82:83]
v_cndmask_b32 v100, v36, v8, s[66:67]
v_mfma_f32_32x32x16_bf16 v[144:159], v[56:59], v[56:59], 0
v_cndmask_b32 v101, v36, v8, s[68:69]
v_cndmask_b32 v102, v36, v8, s[70:71]
v_cndmask_b32 v103, v36, v8, s[72:73]
s_cmp_gt_u32 s20, 2
v_mfma_f32_32x32x16_bf16 v[160:175], v[56:59], v[56:59], 0
s_cselect_b64 s[82:83], -1, 0
s_cmp_eq_u32 s20, 2
s_cselect_b64 s[74:75], s[16:17], s[82:83]
s_cselect_b64 s[76:77], s[18:19], s[82:83]
v_mfma_f32_32x32x16_bf16 v[176:191], v[56:59], v[56:59], 0
s_cselect_b64 s[78:79], s[48:49], s[82:83]
s_cselect_b64 s[80:81], s[50:51], s[82:83]
v_cndmask_b32 v108, v36, v8, s[74:75]
v_cndmask_b32 v109, v36, v8, s[76:77]
v_mfma_f32_32x32x16_bf16 v[192:207], v[56:59], v[56:59], 0
v_cndmask_b32 v110, v36, v8, s[78:79]
v_cndmask_b32 v111, v36, v8, s[80:81]
s_cmp_gt_u32 s20, 1
s_cselect_b64 s[82:83], -1, 0
v_mfma_f32_32x32x16_bf16 v[208:223], v[56:59], v[56:59], 0
s_cmp_eq_u32 s20, 1
s_cselect_b64 s[66:67], s[16:17], s[82:83]
s_cselect_b64 s[68:69], s[18:19], s[82:83]
s_cselect_b64 s[70:71], s[48:49], s[82:83]
v_mfma_f32_32x32x16_bf16 v[224:239], v[56:59], v[56:59], 0
s_cselect_b64 s[72:73], s[50:51], s[82:83]
v_cndmask_b32 v116, v36, v8, s[66:67]
v_cndmask_b32 v117, v36, v8, s[68:69]
v_cndmask_b32 v118, v36, v8, s[70:71]
v_mfma_f32_32x32x16_bf16 v[240:255], v[56:59], v[56:59], 0
v_cndmask_b32 v119, v36, v8, s[72:73]
s_cmp_gt_u32 s20, 0
s_cselect_b64 s[82:83], -1, 0
s_cmp_eq_u32 s20, 0
s_cselect_b64 s[74:75], s[16:17], s[82:83]
s_cselect_b64 s[76:77], s[18:19], s[82:83]
s_cselect_b64 s[78:79], s[48:49], s[82:83]
s_cselect_b64 s[80:81], s[50:51], s[82:83]
v_cndmask_b32 v124, v36, v8, s[74:75]
v_cndmask_b32 v125, v36, v8, s[76:77]
v_cndmask_b32 v126, v36, v8, s[78:79]
v_cndmask_b32 v127, v36, v8, s[80:81]
s_branch L_d3h
.p2align 12
L_kv1:
s_and_b32 s31, s42, 7
s_lshl_b32 s30, s41, 3
SA s30,s30,s31
s_lshl_b32 s64, s30, 2
SA s64,s64,s20
s_mul_i32 s72, s64, 3584
v_mov_b32 v32, 536870912
v_cmp_gt_u32 vcc, 56, v0
s_lshl_b32 s67, s64, 2
s_nop 0
v_cndmask_b32 v32, v32, v7, vcc
buffer_load_dwordx4 a[176:179], v32, s[56:59], s72 offen offset:0
buffer_load_dwordx4 a[180:183], v32, s[56:59], s72 offen offset:896
buffer_load_dwordx4 a[184:187], v32, s[56:59], s72 offen offset:1792
buffer_load_dwordx4 a[188:191], v32, s[56:59], s72 offen offset:2688
buffer_load_dwordx4 a[192:195], v32, s[60:63], 0 offen
buffer_load_dwordx4 a[196:199], v32, s[68:71], 0 offen
SA m0,s24,16384
s_nop 0
buffer_load_dwordx4 v12, s[48:51], s22 offen offset:0   lds
buffer_load_dwordx4 v13, s[48:51], s22 offen offset:1024   lds
buffer_load_dwordx4 v14, s[48:51], s22 offen offset:2048   lds
buffer_load_dwordx4 v15, s[48:51], s22 offen offset:3072   lds
s_sub_u32 s22, s22, 1048448
SA m0,s23,32768
s_nop 0
buffer_load_dwordx4 v8, s[16:19], s21 offen offset:0   lds
buffer_load_dwordx4 v9, s[16:19], s21 offen offset:1024   lds
buffer_load_dwordx4 v10, s[16:19], s21 offen offset:2048   lds
buffer_load_dwordx4 v11, s[16:19], s21 offen offset:3072   lds
SA s21,s21,128
s_mov_b64 exec, 0
s_cmp_eq_u32 s20, 0
s_cbranch_scc1 L_w_kv11
s_cmp_eq_u32 s20, 1
s_cbranch_scc1 L_w_kv12
s_cmp_eq_u32 s20, 2
s_cbranch_scc1 L_w_kv13
s_branch L_w_kv14
L_wd2:
s_mov_b64 exec, -1
s_waitcnt vmcnt(14) lgkmcnt(0)
s_barrier
R a[160:163],v5,0
R a[164:167],v6,0
T a[96:97],v1,0
T a[98:99],v1,1024
T a[100:101],v1,8192
T a[102:103],v1,9216
T a[104:105],v2,0
T a[106:107],v2,1024
T a[108:109],v2,8192
T a[110:111],v2,9216
T a[112:113],v3,0
T a[114:115],v3,1024
T a[116:117],v3,8192
T a[118:119],v3,9216
T a[120:121],v4,0
T a[122:123],v4,1024
T a[124:125],v4,8192
T a[126:127],v4,9216
T a[128:129],v1,16384
T a[130:131],v1,17408
T a[132:133],v1,24576
T a[134:135],v1,25600
T a[136:137],v2,16384
T a[138:139],v2,17408
T a[140:141],v2,24576
T a[142:143],v2,25600
T a[144:145],v3,16384
T a[146:147],v3,17408
T a[148:149],v3,24576
T a[150:151],v3,25600
T a[152:153],v4,16384
T a[154:155],v4,17408
T a[156:157],v4,24576
T a[158:159],v4,25600
s_waitcnt lgkmcnt(15)
M a[0:3],a[160:163],a[96:99],0
SA m0,s23,49152
R a[168:171],v5,2048
R a[172:175],v6,2048
M a[0:3],a[164:167],a[100:103],a[0:3]
buffer_load_dwordx4 v8, s[16:19], s21 offen offset:0   lds
M a[4:7],a[164:167],a[108:111],0
M a[4:7],a[160:163],a[104:107],a[4:7]
M a[8:11],a[160:163],a[112:115],0
buffer_load_dwordx4 v9, s[16:19], s21 offen offset:1024   lds
M a[8:11],a[164:167],a[116:119],a[8:11]
s_waitcnt lgkmcnt(14)
M a[12:15],a[164:167],a[124:127],0
M a[12:15],a[160:163],a[120:123],a[12:15]
M a[16:19],a[160:163],a[128:131],0
buffer_load_dwordx4 v10, s[16:19], s21 offen offset:2048   lds
M a[16:19],a[164:167],a[132:135],a[16:19]
s_waitcnt lgkmcnt(6)
M a[20:23],a[164:167],a[140:143],0
M a[20:23],a[160:163],a[136:139],a[20:23]
buffer_load_dwordx4 v11, s[16:19], s21 offen offset:3072   lds
M a[24:27],a[160:163],a[144:147],0
SA s21,s21,524160
M a[24:27],a[164:167],a[148:151],a[24:27]
s_waitcnt lgkmcnt(0)
M a[28:31],a[164:167],a[156:159],0
SA m0,s24,32768
M a[28:31],a[160:163],a[152:155],a[28:31]
buffer_load_dwordx4 v12, s[48:51], s22 offen offset:0   lds
M v[32:35],a[168:171],a[96:99],0
R a[160:163],v5,4096
R a[164:167],v6,4096
M v[32:35],a[172:175],a[100:103],v[32:35]
M v[36:39],a[172:175],a[108:111],0
M v[36:39],a[168:171],a[104:107],v[36:39]
buffer_load_dwordx4 v13, s[48:51], s22 offen offset:1024   lds
M v[40:43],a[168:171],a[112:115],0
M v[40:43],a[172:175],a[116:119],v[40:43]
M v[44:47],a[172:175],a[124:127],0
buffer_load_dwordx4 v14, s[48:51], s22 offen offset:2048   lds
M v[44:47],a[168:171],a[120:123],v[44:47]
M v[48:51],a[168:171],a[128:131],0
M v[48:51],a[172:175],a[132:135],v[48:51]
M v[52:55],a[172:175],a[140:143],0
buffer_load_dwordx4 v15, s[48:51], s22 offen offset:3072   lds
M v[52:55],a[168:171],a[136:139],v[52:55]
SA s22,s22,1048576
M v[56:59],a[168:171],a[144:147],0
M v[56:59],a[172:175],a[148:151],v[56:59]
s_waitcnt lgkmcnt(0)
M v[60:63],a[172:175],a[156:159],0
M v[60:63],a[168:171],a[152:155],v[60:63]
M v[64:67],a[160:163],a[96:99],0
R a[168:171],v5,6144
R a[172:175],v6,6144
M v[64:67],a[164:167],a[100:103],v[64:67]
M v[68:71],a[164:167],a[108:111],0
M v[68:71],a[160:163],a[104:107],v[68:71]
M v[72:75],a[160:163],a[112:115],0
M v[72:75],a[164:167],a[116:119],v[72:75]
M v[76:79],a[164:167],a[124:127],0
M v[76:79],a[160:163],a[120:123],v[76:79]
M v[80:83],a[160:163],a[128:131],0
M v[80:83],a[164:167],a[132:135],v[80:83]
M v[84:87],a[164:167],a[140:143],0
M v[84:87],a[160:163],a[136:139],v[84:87]
M v[88:91],a[160:163],a[144:147],0
M v[88:91],a[164:167],a[148:151],v[88:91]
s_waitcnt lgkmcnt(0)
M v[92:95],a[164:167],a[156:159],0
s_waitcnt vmcnt(12)
M v[92:95],a[160:163],a[152:155],v[92:95]
s_barrier
M v[96:99],a[168:171],a[96:99],0
SA m0,s23,0
R a[160:163],v5,16384
R a[164:167],v6,16384
M v[96:99],a[172:175],a[100:103],v[96:99]
buffer_load_dwordx4 v8, s[16:19], s21 offen offset:0   lds
M v[100:103],a[172:175],a[108:111],0
v_lshlrev_b32 v26, 7, v0
v_and_b32 v27, 48, v0
M v[100:103],a[168:171],a[104:107],v[100:103]
v_lshl_add_u32 v26, v27, 24, v26
M v[104:107],a[168:171],a[112:115],0
buffer_load_dwordx4 v9, s[16:19], s21 offen offset:1024   lds
M v[104:107],a[172:175],a[116:119],v[104:107]
M v[108:111],a[172:175],a[124:127],0
M v[108:111],a[168:171],a[120:123],v[108:111]
buffer_load_dwordx4 v10, s[16:19], s21 offen offset:2048   lds
M v[112:115],a[168:171],a[128:131],0
M v[112:115],a[172:175],a[132:135],v[112:115]
M v[116:119],a[172:175],a[140:143],0
M v[116:119],a[168:171],a[136:139],v[116:119]
buffer_load_dwordx4 v11, s[16:19], s21 offen offset:3072   lds
M v[120:123],a[168:171],a[144:147],0
SA s21,s21,128
M v[120:123],a[172:175],a[148:151],v[120:123]
s_waitcnt lgkmcnt(0)
M v[124:127],a[172:175],a[156:159],0
SA m0,s24,49152
M v[124:127],a[168:171],a[152:155],v[124:127]
buffer_load_dwordx4 v12, s[48:51], s22 offen offset:0   lds
M v[128:131],a[160:163],a[96:99],0
R a[168:171],v5,18432
R a[172:175],v6,18432
M v[128:131],a[164:167],a[100:103],v[128:131]
buffer_load_dwordx4 v13, s[48:51], s22 offen offset:1024   lds
M v[132:135],a[164:167],a[108:111],0
M v[132:135],a[160:163],a[104:107],v[132:135]
M v[136:139],a[160:163],a[112:115],0
M v[136:139],a[164:167],a[116:119],v[136:139]
buffer_load_dwordx4 v14, s[48:51], s22 offen offset:2048   lds
M v[140:143],a[164:167],a[124:127],0
M v[140:143],a[160:163],a[120:123],v[140:143]
M v[144:147],a[160:163],a[128:131],0
buffer_load_dwordx4 v15, s[48:51], s22 offen offset:3072   lds
M v[144:147],a[164:167],a[132:135],v[144:147]
s_sub_u32 s22, s22, 1048448
M v[148:151],a[164:167],a[140:143],0
M v[148:151],a[160:163],a[136:139],v[148:151]
M v[152:155],a[160:163],a[144:147],0
M v[152:155],a[164:167],a[148:151],v[152:155]
s_waitcnt lgkmcnt(0)
M v[156:159],a[164:167],a[156:159],0
s_waitcnt vmcnt(12)
M v[156:159],a[160:163],a[152:155],v[156:159]
s_barrier
M v[160:163],a[168:171],a[96:99],0
SA m0,s23,16384
R a[160:163],v5,20480
R a[164:167],v6,20480
M v[160:163],a[172:175],a[100:103],v[160:163]
T a[32:33],v1,32768
T a[34:35],v1,33792
M v[164:167],a[172:175],a[108:111],0
T a[36:37],v1,40960
T a[38:39],v1,41984
M v[164:167],a[168:171],a[104:107],v[164:167]
T a[40:41],v2,32768
T a[42:43],v2,33792
M v[168:171],a[168:171],a[112:115],0
T a[44:45],v2,40960
T a[46:47],v2,41984
M v[168:171],a[172:175],a[116:119],v[168:171]
buffer_load_dwordx4 v8, s[16:19], s21 offen offset:0   lds
M v[172:175],a[172:175],a[124:127],0
s_nop 0
T a[48:49],v3,32768
T a[50:51],v3,33792
M v[172:175],a[168:171],a[120:123],v[172:175]
buffer_load_dwordx4 v9, s[16:19], s21 offen offset:1024   lds
M v[176:179],a[168:171],a[128:131],0
s_nop 0
T a[52:53],v3,40960
T a[54:55],v3,41984
M v[176:179],a[172:175],a[132:135],v[176:179]
T a[56:57],v4,32768
T a[58:59],v4,33792
M v[180:183],a[172:175],a[140:143],0
buffer_load_dwordx4 v10, s[16:19], s21 offen offset:2048   lds
M v[180:183],a[168:171],a[136:139],v[180:183]
s_nop 0
T a[60:61],v4,40960
T a[62:63],v4,41984
M v[184:187],a[168:171],a[144:147],0
buffer_load_dwordx4 v11, s[16:19], s21 offen offset:3072   lds
M v[184:187],a[172:175],a[148:151],v[184:187]
s_waitcnt lgkmcnt(15)
s_nop 0
T a[64:65],v1,49152
T a[66:67],v1,50176
M v[188:191],a[172:175],a[156:159],0
SA s21,s21,524160
T a[68:69],v1,57344
T a[70:71],v1,58368
M v[188:191],a[168:171],a[152:155],v[188:191]
SA m0,s24,0
M v[192:195],a[160:163],a[96:99],0
R a[168:171],v5,22528
R a[172:175],v6,22528
M v[192:195],a[164:167],a[100:103],v[192:195]
T a[72:73],v2,49152
T a[74:75],v2,50176
M v[196:199],a[164:167],a[108:111],0
T a[76:77],v2,57344
T a[78:79],v2,58368
M v[196:199],a[160:163],a[104:107],v[196:199]
T a[80:81],v3,49152
T a[82:83],v3,50176
M v[200:203],a[160:163],a[112:115],0
buffer_load_dwordx4 v12, s[48:51], s22 offen offset:0   lds
M v[200:203],a[164:167],a[116:119],v[200:203]
s_nop 0
T a[84:85],v3,57344
T a[86:87],v3,58368
M v[204:207],a[164:167],a[124:127],0
T a[88:89],v4,49152
T a[90:91],v4,50176
M v[204:207],a[160:163],a[120:123],v[204:207]
buffer_load_dwordx4 v13, s[48:51], s22 offen offset:1024   lds
M v[208:211],a[160:163],a[128:131],0
s_nop 0
T a[92:93],v4,57344
T a[94:95],v4,58368
M v[208:211],a[164:167],a[132:135],v[208:211]
buffer_load_dwordx4 v14, s[48:51], s22 offen offset:2048   lds
M v[212:215],a[164:167],a[140:143],0
buffer_load_dwordx4 v15, s[48:51], s22 offen offset:3072   lds
M v[212:215],a[160:163],a[136:139],v[212:215]
SA s22,s22,1048576
M v[216:219],a[160:163],a[144:147],0
M v[216:219],a[164:167],a[148:151],v[216:219]
s_waitcnt lgkmcnt(12)
M v[220:223],a[164:167],a[156:159],0
s_waitcnt vmcnt(12) lgkmcnt(0)
M v[220:223],a[160:163],a[152:155],v[220:223]
s_barrier
M v[224:227],a[168:171],a[96:99],0
SA m0,s23,32768
R a[160:163],v5,32768
R a[164:167],v6,32768
M v[224:227],a[172:175],a[100:103],v[224:227]
buffer_load_dwordx4 v8, s[16:19], s21 offen offset:0   lds
M v[228:231],a[172:175],a[108:111],0
M v[228:231],a[168:171],a[104:107],v[228:231]
M v[232:235],a[168:171],a[112:115],0
buffer_load_dwordx4 v9, s[16:19], s21 offen offset:1024   lds
M v[232:235],a[172:175],a[116:119],v[232:235]
M v[236:239],a[172:175],a[124:127],0
M v[236:239],a[168:171],a[120:123],v[236:239]
buffer_load_dwordx4 v10, s[16:19], s21 offen offset:2048   lds
M v[240:243],a[168:171],a[128:131],0
M v[240:243],a[172:175],a[132:135],v[240:243]
M v[244:247],a[172:175],a[140:143],0
buffer_load_dwordx4 v11, s[16:19], s21 offen offset:3072   lds
M v[244:247],a[168:171],a[136:139],v[244:247]
SA s21,s21,128
M v[248:251],a[168:171],a[144:147],0
M v[248:251],a[172:175],a[148:151],v[248:251]
s_waitcnt lgkmcnt(0)
M v[252:255],a[172:175],a[156:159],0
M v[252:255],a[168:171],a[152:155],v[252:255]
M a[0:3],a[160:163],a[32:35],a[0:3]
R a[168:171],v5,34816
R a[172:175],v6,34816
M a[0:3],a[164:167],a[36:39],a[0:3]
T a[96:97],v1,0
T a[98:99],v1,1024
M a[4:7],a[164:167],a[44:47],a[4:7]
SA m0,s24,16384
v_mov_b32 v16, 0
v_mov_b32 v17, 0
M a[4:7],a[160:163],a[40:43],a[4:7]
buffer_load_dwordx4 v12, s[48:51], s22 offen offset:0   lds
M a[8:11],a[160:163],a[48:51],a[8:11]
v_mov_b32 v18, 0
v_mov_b32 v19, 0
M a[8:11],a[164:167],a[52:55],a[8:11]
v_mov_b32 v20, 0
v_mov_b32 v21, 0
M a[12:15],a[164:167],a[60:63],a[12:15]
T a[100:101],v1,8192
T a[102:103],v1,9216
M a[12:15],a[160:163],a[56:59],a[12:15]
v_mov_b32 v22, 0
v_mov_b32 v23, 0
M a[16:19],a[160:163],a[64:67],a[16:19]
buffer_load_dwordx4 v13, s[48:51], s22 offen offset:1024   lds
M a[16:19],a[164:167],a[68:71],a[16:19]
G v28,a192
G v29,a196
M a[20:23],a[164:167],a[76:79],a[20:23]
v_lshlrev_b32 v27, 16, v28
v_lshlrev_b32 v25, 16, v29
M a[20:23],a[160:163],a[72:75],a[20:23]
T a[104:105],v2,0
T a[106:107],v2,1024
M a[24:27],a[160:163],a[80:83],a[24:27]
v_and_b32 v28, 0xffff0000, v28
v_and_b32 v29, 0xffff0000, v29
M a[24:27],a[164:167],a[84:87],a[24:27]
s_waitcnt lgkmcnt(6)
buffer_load_dwordx4 v14, s[48:51], s22 offen offset:2048   lds
M a[28:31],a[164:167],a[92:95],a[28:31]
G v30,a176
v_lshlrev_b32 v31, 16, v30
M a[28:31],a[160:163],a[88:91],a[28:31]
v_and_b32 v30, 0xffff0000, v30
v_fmac_f32 v16, v31, v27
M v[60:63],a[168:171],a[88:91],v[60:63]
R a[160:163],v5,36864
R a[164:167],v6,36864
M v[60:63],a[172:175],a[92:95],v[60:63]
T a[108:109],v2,8192
T a[110:111],v2,9216
M v[56:59],a[172:175],a[84:87],v[56:59]
buffer_load_dwordx4 v15, s[48:51], s22 offen offset:3072   lds
M v[56:59],a[168:171],a[80:83],v[56:59]
s_sub_u32 s22, s22, 1048448
v_fmac_f32 v20, v31, v25
v_fmac_f32 v16, v30, v28
M v[52:55],a[168:171],a[72:75],v[52:55]
v_fmac_f32 v20, v30, v29
G v30,a180
M v[52:55],a[172:175],a[76:79],v[52:55]
T a[112:113],v3,0
T a[114:115],v3,1024
M v[48:51],a[172:175],a[68:71],v[48:51]
SA m0,s23,49152
v_lshlrev_b32 v31, 16, v30
v_and_b32 v30, 0xffff0000, v30
M v[48:51],a[168:171],a[64:67],v[48:51]
buffer_load_dwordx4 v8, s[16:19], s21 offen offset:0   lds
M v[44:47],a[168:171],a[56:59],v[44:47]
v_fmac_f32 v17, v31, v27
v_fmac_f32 v21, v31, v25
M v[44:47],a[172:175],a[60:63],v[44:47]
v_fmac_f32 v17, v30, v28
v_fmac_f32 v21, v30, v29
M v[40:43],a[172:175],a[52:55],v[40:43]
T a[116:117],v3,8192
T a[118:119],v3,9216
M v[40:43],a[168:171],a[48:51],v[40:43]
G v30,a184
v_lshlrev_b32 v31, 16, v30
M v[36:39],a[168:171],a[40:43],v[36:39]
buffer_load_dwordx4 v9, s[16:19], s21 offen offset:1024   lds
M v[36:39],a[172:175],a[44:47],v[36:39]
s_waitcnt lgkmcnt(6)
v_and_b32 v30, 0xffff0000, v30
v_fmac_f32 v18, v31, v27
M v[32:35],a[172:175],a[36:39],v[32:35]
v_fmac_f32 v22, v31, v25
v_fmac_f32 v18, v30, v28
M v[32:35],a[168:171],a[32:35],v[32:35]
T a[120:121],v4,0
T a[122:123],v4,1024
M v[64:67],a[160:163],a[32:35],v[64:67]
R a[168:171],v5,38912
R a[172:175],v6,38912
M v[64:67],a[164:167],a[36:39],v[64:67]
buffer_load_dwordx4 v10, s[16:19], s21 offen offset:2048   lds
M v[68:71],a[164:167],a[44:47],v[68:71]
v_fmac_f32 v22, v30, v29
G v30,a188
M v[68:71],a[160:163],a[40:43],v[68:71]
v_lshlrev_b32 v31, 16, v30
v_and_b32 v30, 0xffff0000, v30
M v[72:75],a[160:163],a[48:51],v[72:75]
T a[124:125],v4,8192
T a[126:127],v4,9216
M v[72:75],a[164:167],a[52:55],v[72:75]
v_fmac_f32 v19, v31, v27
v_fmac_f32 v23, v31, v25
M v[76:79],a[164:167],a[60:63],v[76:79]
buffer_load_dwordx4 v11, s[16:19], s21 offen offset:3072   lds
M v[76:79],a[160:163],a[56:59],v[76:79]
SA s21,s21,524160
v_fmac_f32 v19, v30, v28
v_fmac_f32 v23, v30, v29
M v[80:83],a[160:163],a[64:67],v[80:83]
G v28,a193
G v29,a197
M v[80:83],a[164:167],a[68:71],v[80:83]
v_lshlrev_b32 v27, 16, v28
v_lshlrev_b32 v25, 16, v29
M v[84:87],a[164:167],a[76:79],v[84:87]
v_and_b32 v28, 0xffff0000, v28
v_and_b32 v29, 0xffff0000, v29
M v[84:87],a[160:163],a[72:75],v[84:87]
G v30,a177
v_lshlrev_b32 v31, 16, v30
M v[88:91],a[160:163],a[80:83],v[88:91]
v_and_b32 v30, 0xffff0000, v30
v_fmac_f32 v16, v31, v27
M v[88:91],a[164:167],a[84:87],v[88:91]
s_waitcnt lgkmcnt(2)
v_fmac_f32 v20, v31, v25
v_fmac_f32 v16, v30, v28
M v[92:95],a[164:167],a[92:95],v[92:95]
s_waitcnt vmcnt(16) lgkmcnt(0)
v_fmac_f32 v20, v30, v29
G v30,a181
M v[92:95],a[160:163],a[88:91],v[92:95]
s_barrier
M v[124:127],a[168:171],a[88:91],v[124:127]
R a[160:163],v5,49152
R a[164:167],v6,49152
M v[124:127],a[172:175],a[92:95],v[124:127]
v_lshlrev_b32 v31, 16, v30
v_and_b32 v30, 0xffff0000, v30
M v[120:123],a[172:175],a[84:87],v[120:123]
SA m0,s24,32768
T a[128:129],v1,16384
T a[130:131],v1,17408
M v[120:123],a[168:171],a[80:83],v[120:123]
buffer_load_dwordx4 v12, s[48:51], s22 offen offset:0   lds
M v[116:119],a[168:171],a[72:75],v[116:119]
v_fmac_f32 v17, v31, v27
v_fmac_f32 v21, v31, v25
M v[116:119],a[172:175],a[76:79],v[116:119]
v_fmac_f32 v17, v30, v28
v_fmac_f32 v21, v30, v29
M v[112:115],a[172:175],a[68:71],v[112:115]
G v30,a185
v_lshlrev_b32 v31, 16, v30
M v[112:115],a[168:171],a[64:67],v[112:115]
v_and_b32 v30, 0xffff0000, v30
v_fmac_f32 v18, v31, v27
M v[108:111],a[168:171],a[56:59],v[108:111]
v_fmac_f32 v22, v31, v25
v_fmac_f32 v18, v30, v28
M v[108:111],a[172:175],a[60:63],v[108:111]
T a[132:133],v1,24576
T a[134:135],v1,25600
M v[104:107],a[172:175],a[52:55],v[104:107]
buffer_load_dwordx4 v13, s[48:51], s22 offen offset:1024   lds
M v[104:107],a[168:171],a[48:51],v[104:107]
v_fmac_f32 v22, v30, v29
G v30,a189
M v[100:103],a[168:171],a[40:43],v[100:103]
v_lshlrev_b32 v31, 16, v30
v_and_b32 v30, 0xffff0000, v30
M v[100:103],a[172:175],a[44:47],v[100:103]
s_waitcnt lgkmcnt(4)
v_fmac_f32 v19, v31, v27
v_fmac_f32 v23, v31, v25
M v[96:99],a[172:175],a[36:39],v[96:99]
v_fmac_f32 v19, v30, v28
v_fmac_f32 v23, v30, v29
M v[96:99],a[168:171],a[32:35],v[96:99]
G v28,a194
G v29,a198
M v[128:131],a[160:163],a[32:35],v[128:131]
R a[168:171],v5,51200
R a[172:175],v6,51200
M v[128:131],a[164:167],a[36:39],v[128:131]
T a[136:137],v2,16384
T a[138:139],v2,17408
M v[132:135],a[164:167],a[44:47],v[132:135]
buffer_load_dwordx4 v14, s[48:51], s22 offen offset:2048   lds
M v[132:135],a[160:163],a[40:43],v[132:135]
v_lshlrev_b32 v27, 16, v28
v_lshlrev_b32 v25, 16, v29
M v[136:139],a[160:163],a[48:51],v[136:139]
v_and_b32 v28, 0xffff0000, v28
v_and_b32 v29, 0xffff0000, v29
M v[136:139],a[164:167],a[52:55],v[136:139]
G v30,a178
v_lshlrev_b32 v31, 16, v30
M v[140:143],a[164:167],a[60:63],v[140:143]
v_and_b32 v30, 0xffff0000, v30
v_fmac_f32 v16, v31, v27
M v[140:143],a[160:163],a[56:59],v[140:143]
T a[140:141],v2,24576
T a[142:143],v2,25600
M v[144:147],a[160:163],a[64:67],v[144:147]
buffer_load_dwordx4 v15, s[48:51], s22 offen offset:3072   lds
M v[144:147],a[164:167],a[68:71],v[144:147]
SA s22,s22,1048576
v_fmac_f32 v20, v31, v25
v_fmac_f32 v16, v30, v28
M v[148:151],a[164:167],a[76:79],v[148:151]
v_fmac_f32 v20, v30, v29
G v30,a182
M v[148:151],a[160:163],a[72:75],v[148:151]
v_lshlrev_b32 v31, 16, v30
v_and_b32 v30, 0xffff0000, v30
M v[152:155],a[160:163],a[80:83],v[152:155]
v_fmac_f32 v17, v31, v27
v_fmac_f32 v21, v31, v25
M v[152:155],a[164:167],a[84:87],v[152:155]
s_waitcnt lgkmcnt(4)
v_fmac_f32 v17, v30, v28
v_fmac_f32 v21, v30, v29
M v[156:159],a[164:167],a[92:95],v[156:159]
SA m0,s23,0
T a[144:145],v3,16384
T a[146:147],v3,17408
M v[156:159],a[160:163],a[88:91],v[156:159]
buffer_load_dwordx4 v8, s[16:19], s21 offen offset:0   lds
M v[188:191],a[168:171],a[88:91],v[188:191]
R a[160:163],v5,53248
R a[164:167],v6,53248
M v[188:191],a[172:175],a[92:95],v[188:191]
G v30,a186
v_lshlrev_b32 v31, 16, v30
M v[184:187],a[172:175],a[84:87],v[184:187]
v_and_b32 v30, 0xffff0000, v30
v_fmac_f32 v18, v31, v27
M v[184:187],a[168:171],a[80:83],v[184:187]
v_fmac_f32 v22, v31, v25
v_fmac_f32 v18, v30, v28
M v[180:183],a[168:171],a[72:75],v[180:183]
v_fmac_f32 v22, v30, v29
G v30,a190
M v[180:183],a[172:175],a[76:79],v[180:183]
L_w_kv11:
s_cbranch_execz L_w_kv15
T a[148:149],v3,24576
T a[150:151],v3,25600
M v[176:179],a[172:175],a[68:71],v[176:179]
buffer_load_dwordx4 v9, s[16:19], s21 offen offset:1024   lds
M v[176:179],a[168:171],a[64:67],v[176:179]
v_lshlrev_b32 v31, 16, v30
v_and_b32 v30, 0xffff0000, v30
M v[172:175],a[168:171],a[56:59],v[172:175]
v_fmac_f32 v19, v31, v27
v_fmac_f32 v23, v31, v25
M v[172:175],a[172:175],a[60:63],v[172:175]
v_fmac_f32 v19, v30, v28
v_fmac_f32 v23, v30, v29
M v[168:171],a[172:175],a[52:55],v[168:171]
M v[168:171],a[168:171],a[48:51],v[168:171]
M v[164:167],a[168:171],a[40:43],v[164:167]
s_nop 0
T a[152:153],v4,16384
T a[154:155],v4,17408
M v[164:167],a[172:175],a[44:47],v[164:167]
s_waitcnt lgkmcnt(4)
buffer_load_dwordx4 v10, s[16:19], s21 offen offset:2048   lds
M v[160:163],a[172:175],a[36:39],v[160:163]
M v[160:163],a[168:171],a[32:35],v[160:163]
M v[192:195],a[160:163],a[32:35],v[192:195]
R a[168:171],v5,55296
R a[172:175],v6,55296
M v[192:195],a[164:167],a[36:39],v[192:195]
M v[196:199],a[164:167],a[44:47],v[196:199]
M v[196:199],a[160:163],a[40:43],v[196:199]
s_nop 0
T a[156:157],v4,24576
T a[158:159],v4,25600
M v[200:203],a[160:163],a[48:51],v[200:203]
buffer_load_dwordx4 v11, s[16:19], s21 offen offset:3072   lds
M v[200:203],a[164:167],a[52:55],v[200:203]
SA s21,s21,128
M v[204:207],a[164:167],a[60:63],v[204:207]
M v[204:207],a[160:163],a[56:59],v[204:207]
M v[208:211],a[160:163],a[64:67],v[208:211]
M v[208:211],a[164:167],a[68:71],v[208:211]
M v[212:215],a[164:167],a[76:79],v[212:215]
M v[212:215],a[160:163],a[72:75],v[212:215]
M v[216:219],a[160:163],a[80:83],v[216:219]
M v[216:219],a[164:167],a[84:87],v[216:219]
s_waitcnt lgkmcnt(2)
M v[220:223],a[164:167],a[92:95],v[220:223]
s_waitcnt vmcnt(16) lgkmcnt(0)
M v[220:223],a[160:163],a[88:91],v[220:223]
s_barrier
M v[252:255],a[168:171],a[88:91],v[252:255]
R a[160:163],v5,0
R a[164:167],v6,0
M v[252:255],a[172:175],a[92:95],v[252:255]
M v[248:251],a[172:175],a[84:87],v[248:251]
M v[248:251],a[168:171],a[80:83],v[248:251]
M v[244:247],a[168:171],a[72:75],v[244:247]
M v[244:247],a[172:175],a[76:79],v[244:247]
M v[240:243],a[172:175],a[68:71],v[240:243]
M v[240:243],a[168:171],a[64:67],v[240:243]
M v[236:239],a[168:171],a[56:59],v[236:239]
M v[236:239],a[172:175],a[60:63],v[236:239]
M v[232:235],a[172:175],a[52:55],v[232:235]
M v[232:235],a[168:171],a[48:51],v[232:235]
M v[228:231],a[168:171],a[40:43],v[228:231]
M v[228:231],a[172:175],a[44:47],v[228:231]
s_waitcnt lgkmcnt(0)
M v[224:227],a[172:175],a[36:39],v[224:227]
M v[224:227],a[168:171],a[32:35],v[224:227]
M a[0:3],a[160:163],a[96:99],a[0:3]
R a[168:171],v5,2048
R a[172:175],v6,2048
M a[0:3],a[164:167],a[100:103],a[0:3]
T a[32:33],v1,32768
T a[34:35],v1,33792
M a[4:7],a[164:167],a[108:111],a[4:7]
SA m0,s24,49152
G v28,a195
G v29,a199
M a[4:7],a[160:163],a[104:107],a[4:7]
buffer_load_dwordx4 v12, s[48:51], s22 offen offset:0   lds
M a[8:11],a[160:163],a[112:115],a[8:11]
v_lshlrev_b32 v27, 16, v28
v_lshlrev_b32 v25, 16, v29
M a[8:11],a[164:167],a[116:119],a[8:11]
v_and_b32 v28, 0xffff0000, v28
v_and_b32 v29, 0xffff0000, v29
M a[12:15],a[164:167],a[124:127],a[12:15]
T a[36:37],v1,40960
T a[38:39],v1,41984
M a[12:15],a[160:163],a[120:123],a[12:15]
G v30,a179
v_lshlrev_b32 v31, 16, v30
M a[16:19],a[160:163],a[128:131],a[16:19]
buffer_load_dwordx4 v13, s[48:51], s22 offen offset:1024   lds
M a[16:19],a[164:167],a[132:135],a[16:19]
v_and_b32 v30, 0xffff0000, v30
v_fmac_f32 v16, v31, v27
M a[20:23],a[164:167],a[140:143],a[20:23]
v_fmac_f32 v20, v31, v25
v_fmac_f32 v16, v30, v28
M a[20:23],a[160:163],a[136:139],a[20:23]
T a[40:41],v2,32768
T a[42:43],v2,33792
M a[24:27],a[160:163],a[144:147],a[24:27]
v_fmac_f32 v20, v30, v29
G v30,a183
M a[24:27],a[164:167],a[148:151],a[24:27]
s_waitcnt lgkmcnt(6)
buffer_load_dwordx4 v14, s[48:51], s22 offen offset:2048   lds
M a[28:31],a[164:167],a[156:159],a[28:31]
v_lshlrev_b32 v31, 16, v30
v_and_b32 v30, 0xffff0000, v30
M a[28:31],a[160:163],a[152:155],a[28:31]
v_fmac_f32 v17, v31, v27
v_fmac_f32 v21, v31, v25
M v[60:63],a[168:171],a[152:155],v[60:63]
R a[160:163],v5,4096
R a[164:167],v6,4096
M v[60:63],a[172:175],a[156:159],v[60:63]
T a[44:45],v2,40960
T a[46:47],v2,41984
M v[56:59],a[172:175],a[148:151],v[56:59]
buffer_load_dwordx4 v15, s[48:51], s22 offen offset:3072   lds
M v[56:59],a[168:171],a[144:147],v[56:59]
s_sub_u32 s22, s22, 1048448
v_fmac_f32 v17, v30, v28
v_fmac_f32 v21, v30, v29
M v[52:55],a[168:171],a[136:139],v[52:55]
G v30,a187
v_lshlrev_b32 v31, 16, v30
M v[52:55],a[172:175],a[140:143],v[52:55]
T a[48:49],v3,32768
T a[50:51],v3,33792
M v[48:51],a[172:175],a[132:135],v[48:51]
SA m0,s23,16384
v_and_b32 v30, 0xffff0000, v30
v_fmac_f32 v18, v31, v27
M v[48:51],a[168:171],a[128:131],v[48:51]
buffer_load_dwordx4 v8, s[16:19], s21 offen offset:0   lds
M v[44:47],a[168:171],a[120:123],v[44:47]
v_fmac_f32 v22, v31, v25
v_fmac_f32 v18, v30, v28
M v[44:47],a[172:175],a[124:127],v[44:47]
v_fmac_f32 v22, v30, v29
G v30,a191
M v[40:43],a[172:175],a[116:119],v[40:43]
T a[52:53],v3,40960
T a[54:55],v3,41984
M v[40:43],a[168:171],a[112:115],v[40:43]
v_lshlrev_b32 v31, 16, v30
v_and_b32 v30, 0xffff0000, v30
M v[36:39],a[168:171],a[104:107],v[36:39]
buffer_load_dwordx4 v9, s[16:19], s21 offen offset:1024   lds
M v[36:39],a[172:175],a[108:111],v[36:39]
s_waitcnt lgkmcnt(6)
v_fmac_f32 v19, v31, v27
v_fmac_f32 v23, v31, v25
M v[32:35],a[172:175],a[100:103],v[32:35]
v_fmac_f32 v19, v30, v28
v_fmac_f32 v23, v30, v29
M v[32:35],a[168:171],a[96:99],v[32:35]
T a[56:57],v4,32768
T a[58:59],v4,33792
M v[64:67],a[160:163],a[96:99],v[64:67]
R a[168:171],v5,6144
R a[172:175],v6,6144
M v[64:67],a[164:167],a[100:103],v[64:67]
buffer_load_dwordx4 v10, s[16:19], s21 offen offset:2048   lds
M v[68:71],a[164:167],a[108:111],v[68:71]
v_permlane32_swap_b32 v16, v18
M v[68:71],a[160:163],a[104:107],v[68:71]
v_permlane32_swap_b32 v17, v19
M v[72:75],a[160:163],a[112:115],v[72:75]
s_nop 0
T a[60:61],v4,40960
T a[62:63],v4,41984
M v[72:75],a[164:167],a[116:119],v[72:75]
v_permlane32_swap_b32 v20, v22
M v[76:79],a[164:167],a[124:127],v[76:79]
buffer_load_dwordx4 v11, s[16:19], s21 offen offset:3072   lds
M v[76:79],a[160:163],a[120:123],v[76:79]
SA s21,s21,524160
v_permlane32_swap_b32 v21, v23
M v[80:83],a[160:163],a[128:131],v[80:83]
AF v16,v16,v18
AF v17,v17,v19
M v[80:83],a[164:167],a[132:135],v[80:83]
AF v20,v20,v22
AF v21,v21,v23
M v[84:87],a[164:167],a[140:143],v[84:87]
v_lshrrev_b32 v28, 4, v0
M v[84:87],a[160:163],a[136:139],v[84:87]
v_permlane16_swap_b32 v16, v17
M v[88:91],a[160:163],a[144:147],v[88:91]
v_permlane16_swap_b32 v20, v21
M v[88:91],a[164:167],a[148:151],v[88:91]
s_waitcnt lgkmcnt(2)
AF v16,v16,v17
AF v20,v20,v21
M v[92:95],a[164:167],a[156:159],v[92:95]
s_waitcnt vmcnt(16) lgkmcnt(0)
v_add_u32 v29, s67, v28
v_add_f32 v16, v16, v16 row_ror:8 row_mask:0xf bank_mask:0xf
M v[92:95],a[160:163],a[152:155],v[92:95]
s_barrier
M v[124:127],a[168:171],a[152:155],v[124:127]
R a[160:163],v5,16384
R a[164:167],v6,16384
M v[124:127],a[172:175],a[156:159],v[124:127]
v_add_f32 v20, v20, v20 row_ror:8 row_mask:0xf bank_mask:0xf
v_add_f32 v16, v16, v16 row_ror:4 row_mask:0xf bank_mask:0xf
M v[120:123],a[172:175],a[148:151],v[120:123]
SA m0,s24,0
T a[64:65],v1,49152
T a[66:67],v1,50176
M v[120:123],a[168:171],a[144:147],v[120:123]
buffer_load_dwordx4 v12, s[48:51], s22 offen offset:0   lds
M v[116:119],a[168:171],a[136:139],v[116:119]
v_add_f32 v20, v20, v20 row_ror:4 row_mask:0xf bank_mask:0xf
v_add_f32 v16, v16, v16 row_ror:2 row_mask:0xf bank_mask:0xf
M v[116:119],a[172:175],a[140:143],v[116:119]
v_add_f32 v20, v20, v20 row_ror:2 row_mask:0xf bank_mask:0xf
v_add_f32 v16, v16, v16 row_ror:1 row_mask:0xf bank_mask:0xf
M v[112:115],a[172:175],a[132:135],v[112:115]
v_add_f32 v20, v20, v20 row_ror:1 row_mask:0xf bank_mask:0xf
v_ashrrev_i32 v30, 31, v16
M v[112:115],a[168:171],a[128:131],v[112:115]
v_or_b32 v30, 0x80000000, v30
v_xor_b32 v30, v30, v16
M v[108:111],a[168:171],a[120:123],v[108:111]
v_and_b32 v30, 0xfffff800, v30
v_sub_u32 v29, 2047, v29
M v[108:111],a[172:175],a[124:127],v[108:111]
T a[68:69],v1,57344
T a[70:71],v1,58368
M v[104:107],a[172:175],a[116:119],v[104:107]
buffer_load_dwordx4 v13, s[48:51], s22 offen offset:1024   lds
M v[104:107],a[168:171],a[112:115],v[104:107]
v_or_b32 v30, v30, v29
v_max_u32 v30, 1, v30
M v[100:103],a[168:171],a[104:107],v[100:103]
MF v21,0xbfb8aa3b,v20
M v[100:103],a[172:175],a[108:111],v[100:103]
s_waitcnt lgkmcnt(4)
E v21,v21
M v[96:99],a[172:175],a[100:103],v[96:99]
AF v21,1.0,v21
M v[96:99],a[168:171],a[96:99],v[96:99]
v_rcp_f32 v20, v21
M v[128:131],a[160:163],a[96:99],v[128:131]
s_lshl_b32 s72, s20, 4
R a[168:171],v5,18432
R a[172:175],v6,18432
M v[128:131],a[164:167],a[100:103],v[128:131]
SA s72,s72,163584
T a[72:73],v2,49152
T a[74:75],v2,50176
M v[132:135],a[164:167],a[108:111],v[132:135]
buffer_load_dwordx4 v14, s[48:51], s22 offen offset:2048   lds
M v[132:135],a[160:163],a[104:107],v[132:135]
v_lshl_add_u32 v28, v28, 2, s72
ds_write_b32 v28, v30
M v[136:139],a[160:163],a[112:115],v[136:139]
ds_write_b32 v28, v16 offset:64
ds_write_b32 v28, v20 offset:128
M v[136:139],a[164:167],a[116:119],v[136:139]
M v[140:143],a[164:167],a[124:127],v[140:143]
M v[140:143],a[160:163],a[120:123],v[140:143]
s_nop 0
T a[76:77],v2,57344
T a[78:79],v2,58368
M v[144:147],a[160:163],a[128:131],v[144:147]
buffer_load_dwordx4 v15, s[48:51], s22 offen offset:3072   lds
M v[144:147],a[164:167],a[132:135],v[144:147]
SA s22,s22,1048576
M v[148:151],a[164:167],a[140:143],v[148:151]
M v[148:151],a[160:163],a[136:139],v[148:151]
M v[152:155],a[160:163],a[144:147],v[152:155]
M v[152:155],a[164:167],a[148:151],v[152:155]
s_waitcnt lgkmcnt(7)
M v[156:159],a[164:167],a[156:159],v[156:159]
SA m0,s23,32768
T a[80:81],v3,49152
T a[82:83],v3,50176
M v[156:159],a[160:163],a[152:155],v[156:159]
buffer_load_dwordx4 v8, s[16:19], s21 offen offset:0   lds
M v[188:191],a[168:171],a[152:155],v[188:191]
R a[160:163],v5,20480
R a[164:167],v6,20480
M v[188:191],a[172:175],a[156:159],v[188:191]
M v[184:187],a[172:175],a[148:151],v[184:187]
M v[184:187],a[168:171],a[144:147],v[184:187]
M v[180:183],a[168:171],a[136:139],v[180:183]
M v[180:183],a[172:175],a[140:143],v[180:183]
s_nop 0
T a[84:85],v3,57344
T a[86:87],v3,58368
M v[176:179],a[172:175],a[132:135],v[176:179]
buffer_load_dwordx4 v9, s[16:19], s21 offen offset:1024   lds
M v[176:179],a[168:171],a[128:131],v[176:179]
M v[172:175],a[168:171],a[120:123],v[172:175]
M v[172:175],a[172:175],a[124:127],v[172:175]
M v[168:171],a[172:175],a[116:119],v[168:171]
M v[168:171],a[168:171],a[112:115],v[168:171]
M v[164:167],a[168:171],a[104:107],v[164:167]
s_nop 0
T a[88:89],v4,49152
T a[90:91],v4,50176
M v[164:167],a[172:175],a[108:111],v[164:167]
s_waitcnt lgkmcnt(4)
buffer_load_dwordx4 v10, s[16:19], s21 offen offset:2048   lds
M v[160:163],a[172:175],a[100:103],v[160:163]
M v[160:163],a[168:171],a[96:99],v[160:163]
M v[192:195],a[160:163],a[96:99],v[192:195]
R a[168:171],v5,22528
R a[172:175],v6,22528
M v[192:195],a[164:167],a[100:103],v[192:195]
M v[196:199],a[164:167],a[108:111],v[196:199]
M v[196:199],a[160:163],a[104:107],v[196:199]
s_nop 0
T a[92:93],v4,57344
T a[94:95],v4,58368
M v[200:203],a[160:163],a[112:115],v[200:203]
buffer_load_dwordx4 v11, s[16:19], s21 offen offset:3072   lds
M v[200:203],a[164:167],a[116:119],v[200:203]
SA s21,s21,128
M v[204:207],a[164:167],a[124:127],v[204:207]
M v[204:207],a[160:163],a[120:123],v[204:207]
M v[208:211],a[160:163],a[128:131],v[208:211]
M v[208:211],a[164:167],a[132:135],v[208:211]
M v[212:215],a[164:167],a[140:143],v[212:215]
M v[212:215],a[160:163],a[136:139],v[212:215]
M v[216:219],a[160:163],a[144:147],v[216:219]
M v[216:219],a[164:167],a[148:151],v[216:219]
s_waitcnt lgkmcnt(2)
M v[220:223],a[164:167],a[156:159],v[220:223]
s_waitcnt vmcnt(16) lgkmcnt(0)
M v[220:223],a[160:163],a[152:155],v[220:223]
s_barrier
M v[252:255],a[168:171],a[152:155],v[252:255]
R a[160:163],v5,32768
R a[164:167],v6,32768
M v[252:255],a[172:175],a[156:159],v[252:255]
M v[248:251],a[172:175],a[148:151],v[248:251]
M v[248:251],a[168:171],a[144:147],v[248:251]
M v[244:247],a[168:171],a[136:139],v[244:247]
M v[244:247],a[172:175],a[140:143],v[244:247]
M v[240:243],a[172:175],a[132:135],v[240:243]
M v[240:243],a[168:171],a[128:131],v[240:243]
M v[236:239],a[168:171],a[120:123],v[236:239]
M v[236:239],a[172:175],a[124:127],v[236:239]
M v[232:235],a[172:175],a[116:119],v[232:235]
M v[232:235],a[168:171],a[112:115],v[232:235]
M v[228:231],a[168:171],a[104:107],v[228:231]
M v[228:231],a[172:175],a[108:111],v[228:231]
s_waitcnt lgkmcnt(0)
M v[224:227],a[172:175],a[100:103],v[224:227]
M v[224:227],a[168:171],a[96:99],v[224:227]
M a[0:3],a[160:163],a[32:35],a[0:3]
R a[168:171],v5,34816
R a[172:175],v6,34816
M a[0:3],a[164:167],a[36:39],a[0:3]
T a[96:97],v1,0
T a[98:99],v1,1024
M a[4:7],a[164:167],a[44:47],a[4:7]
SA m0,s24,16384
M a[4:7],a[160:163],a[40:43],a[4:7]
buffer_load_dwordx4 v12, s[48:51], s22 offen offset:0   lds
M a[8:11],a[160:163],a[48:51],a[8:11]
v_and_b32 v20, 31, v0
M a[8:11],a[164:167],a[52:55],a[8:11]
v_lshlrev_b32 v20, 2, v20
M a[12:15],a[164:167],a[60:63],a[12:15]
s_nop 0
T a[100:101],v1,8192
T a[102:103],v1,9216
M a[12:15],a[160:163],a[56:59],a[12:15]
v_add_u32 v21, 163584, v20
M a[16:19],a[160:163],a[64:67],a[16:19]
buffer_load_dwordx4 v13, s[48:51], s22 offen offset:1024   lds
M a[16:19],a[164:167],a[68:71],a[16:19]
ds_read_b32 v19, v21
M a[20:23],a[164:167],a[76:79],a[20:23]
ds_read_b32 v21, v21 offset:64
M a[20:23],a[160:163],a[72:75],a[20:23]
s_min_u32 s64, s20, 1
T a[104:105],v2,0
T a[106:107],v2,1024
M a[24:27],a[160:163],a[80:83],a[24:27]
s_lshl_b32 s64, s64, 29
v_and_b32 v22, 32, v0
M a[24:27],a[164:167],a[84:87],a[24:27]
s_waitcnt lgkmcnt(8)
buffer_load_dwordx4 v14, s[48:51], s22 offen offset:2048   lds
M a[28:31],a[164:167],a[92:95],a[28:31]
v_lshl_or_b32 v20, v22, 24, v20
M a[28:31],a[160:163],a[88:91],a[28:31]
v_or_b32 v20, s64, v20
M v[60:63],a[168:171],a[88:91],v[60:63]
R a[160:163],v5,36864
R a[164:167],v6,36864
M v[60:63],a[172:175],a[92:95],v[60:63]
T a[108:109],v2,8192
T a[110:111],v2,9216
M v[56:59],a[172:175],a[84:87],v[56:59]
buffer_load_dwordx4 v15, s[48:51], s22 offen offset:3072   lds
M v[56:59],a[168:171],a[80:83],v[56:59]
s_sub_u32 s22, s22, 1048448
v_and_b32 v22, 16, v0
M v[52:55],a[168:171],a[72:75],v[52:55]
v_lshl_or_b32 v18, v22, 25, v20
s_and_b32 s27, s42, 7
M v[52:55],a[172:175],a[76:79],v[52:55]
s_lshl_b32 s72, s30, 7
T a[112:113],v3,0
T a[114:115],v3,1024
M v[48:51],a[172:175],a[68:71],v[48:51]
SA m0,s23,49152
SA s72,s72,104857600
s_lshl_b32 s64, s41, 3
M v[48:51],a[168:171],a[64:67],v[48:51]
SA s27,s27,s64
buffer_load_dwordx4 v8, s[16:19], s21 offen offset:0   lds
M v[44:47],a[168:171],a[56:59],v[44:47]
s_lshl_b32 s27, s27, 2
M v[44:47],a[172:175],a[60:63],v[44:47]
SA s27,s27,s20
M v[40:43],a[172:175],a[52:55],v[40:43]
s_mul_i32 s27, s27, 7168
T a[116:117],v3,8192
T a[118:119],v3,9216
M v[40:43],a[168:171],a[48:51],v[40:43]
s_mov_b32 s60, s90
M v[36:39],a[168:171],a[40:43],v[36:39]
s_and_b32 s61, s91, 0xffff
buffer_load_dwordx4 v9, s[16:19], s21 offen offset:1024   lds
M v[36:39],a[172:175],a[44:47],v[36:39]
s_waitcnt lgkmcnt(6)
buffer_store_dword v21, v20, s[8:11], s72 offen sc1
M v[32:35],a[172:175],a[36:39],v[32:35]
s_mov_b32 s62, 3670016
M v[32:35],a[168:171],a[32:35],v[32:35]
s_mov_b32 s63, 0x20000
T a[120:121],v4,0
T a[122:123],v4,1024
M v[64:67],a[160:163],a[32:35],v[64:67]
R a[168:171],v5,38912
R a[172:175],v6,38912
M v[64:67],a[164:167],a[36:39],v[64:67]
buffer_load_dwordx4 v10, s[16:19], s21 offen offset:2048   lds
M v[68:71],a[164:167],a[44:47],v[68:71]
M v[68:71],a[160:163],a[40:43],v[68:71]
M v[72:75],a[160:163],a[48:51],v[72:75]
s_nop 0
T a[124:125],v4,8192
T a[126:127],v4,9216
M v[72:75],a[164:167],a[52:55],v[72:75]
M v[76:79],a[164:167],a[60:63],v[76:79]
buffer_load_dwordx4 v11, s[16:19], s21 offen offset:3072   lds
M v[76:79],a[160:163],a[56:59],v[76:79]
SA s21,s21,524160
M v[80:83],a[160:163],a[64:67],v[80:83]
M v[80:83],a[164:167],a[68:71],v[80:83]
M v[84:87],a[164:167],a[76:79],v[84:87]
M v[84:87],a[160:163],a[72:75],v[84:87]
M v[88:91],a[160:163],a[80:83],v[88:91]
M v[88:91],a[164:167],a[84:87],v[88:91]
s_waitcnt lgkmcnt(2)
M v[92:95],a[164:167],a[92:95],v[92:95]
s_waitcnt vmcnt(17) lgkmcnt(0)
M v[92:95],a[160:163],a[88:91],v[92:95]
s_barrier
M v[124:127],a[168:171],a[88:91],v[124:127]
R a[160:163],v5,49152
R a[164:167],v6,49152
M v[124:127],a[172:175],a[92:95],v[124:127]
M v[120:123],a[172:175],a[84:87],v[120:123]
SA m0,s24,32768
T a[128:129],v1,16384
T a[130:131],v1,17408
M v[120:123],a[168:171],a[80:83],v[120:123]
buffer_load_dwordx4 v12, s[48:51], s22 offen offset:0   lds
M v[116:119],a[168:171],a[72:75],v[116:119]
v_min_u32 v16, 40, v0
v_lshlrev_b32 v16, 2, v16
M v[116:119],a[172:175],a[76:79],v[116:119]
buffer_load_dword v17, v16, s[12:15], 0 offen sc1
M v[112:115],a[172:175],a[68:71],v[112:115]
M v[112:115],a[168:171],a[64:67],v[112:115]
M v[108:111],a[168:171],a[56:59],v[108:111]
M v[108:111],a[172:175],a[60:63],v[108:111]
s_nop 0
T a[132:133],v1,24576
T a[134:135],v1,25600
M v[104:107],a[172:175],a[52:55],v[104:107]
buffer_load_dwordx4 v13, s[48:51], s22 offen offset:1024   lds
M v[104:107],a[168:171],a[48:51],v[104:107]
M v[100:103],a[168:171],a[40:43],v[100:103]
M v[100:103],a[172:175],a[44:47],v[100:103]
s_waitcnt lgkmcnt(4)
M v[96:99],a[172:175],a[36:39],v[96:99]
M v[96:99],a[168:171],a[32:35],v[96:99]
M v[128:131],a[160:163],a[32:35],v[128:131]
R a[168:171],v5,51200
R a[172:175],v6,51200
M v[128:131],a[164:167],a[36:39],v[128:131]
T a[136:137],v2,16384
T a[138:139],v2,17408
M v[132:135],a[164:167],a[44:47],v[132:135]
buffer_load_dwordx4 v14, s[48:51], s22 offen offset:2048   lds
M v[132:135],a[160:163],a[40:43],v[132:135]
M v[136:139],a[160:163],a[48:51],v[136:139]
M v[136:139],a[164:167],a[52:55],v[136:139]
M v[140:143],a[164:167],a[60:63],v[140:143]
M v[140:143],a[160:163],a[56:59],v[140:143]
s_nop 0
T a[140:141],v2,24576
T a[142:143],v2,25600
M v[144:147],a[160:163],a[64:67],v[144:147]
buffer_load_dwordx4 v15, s[48:51], s22 offen offset:3072   lds
M v[144:147],a[164:167],a[68:71],v[144:147]
SA s22,s22,1048576
M v[148:151],a[164:167],a[76:79],v[148:151]
M v[148:151],a[160:163],a[72:75],v[148:151]
M v[152:155],a[160:163],a[80:83],v[152:155]
M v[152:155],a[164:167],a[84:87],v[152:155]
s_waitcnt lgkmcnt(4)
M v[156:159],a[164:167],a[92:95],v[156:159]
SA m0,s23,0
T a[144:145],v3,16384
T a[146:147],v3,17408
M v[156:159],a[160:163],a[88:91],v[156:159]
buffer_load_dwordx4 v8, s[16:19], s21 offen offset:0   lds
M v[188:191],a[168:171],a[88:91],v[188:191]
R a[160:163],v5,53248
R a[164:167],v6,53248
M v[188:191],a[172:175],a[92:95],v[188:191]
buffer_load_dword a240, v26, s[60:63], s27 offen offset:0
M v[184:187],a[172:175],a[84:87],v[184:187]
SA s27,s27,2048
M v[184:187],a[168:171],a[80:83],v[184:187]
M v[180:183],a[168:171],a[72:75],v[180:183]
M v[180:183],a[172:175],a[76:79],v[180:183]
s_nop 0
T a[148:149],v3,24576
T a[150:151],v3,25600
M v[176:179],a[172:175],a[68:71],v[176:179]
buffer_load_dwordx4 v9, s[16:19], s21 offen offset:1024   lds
M v[176:179],a[168:171],a[64:67],v[176:179]
M v[172:175],a[168:171],a[56:59],v[172:175]
M v[172:175],a[172:175],a[60:63],v[172:175]
M v[168:171],a[172:175],a[52:55],v[168:171]
M v[168:171],a[168:171],a[48:51],v[168:171]
M v[164:167],a[168:171],a[40:43],v[164:167]
s_nop 0
T a[152:153],v4,16384
T a[154:155],v4,17408
M v[164:167],a[172:175],a[44:47],v[164:167]
s_waitcnt lgkmcnt(4)
buffer_load_dwordx4 v10, s[16:19], s21 offen offset:2048   lds
M v[160:163],a[172:175],a[36:39],v[160:163]
M v[160:163],a[168:171],a[32:35],v[160:163]
M v[192:195],a[160:163],a[32:35],v[192:195]
L_w_kv12:
s_cbranch_execz L_w_kv16
R a[168:171],v5,55296
R a[172:175],v6,55296
M v[192:195],a[164:167],a[36:39],v[192:195]
M v[196:199],a[164:167],a[44:47],v[196:199]
M v[196:199],a[160:163],a[40:43],v[196:199]
s_nop 0
T a[156:157],v4,24576
T a[158:159],v4,25600
M v[200:203],a[160:163],a[48:51],v[200:203]
buffer_load_dwordx4 v11, s[16:19], s21 offen offset:3072   lds
M v[200:203],a[164:167],a[52:55],v[200:203]
SA s21,s21,128
M v[204:207],a[164:167],a[60:63],v[204:207]
M v[204:207],a[160:163],a[56:59],v[204:207]
M v[208:211],a[160:163],a[64:67],v[208:211]
M v[208:211],a[164:167],a[68:71],v[208:211]
M v[212:215],a[164:167],a[76:79],v[212:215]
M v[212:215],a[160:163],a[72:75],v[212:215]
M v[216:219],a[160:163],a[80:83],v[216:219]
M v[216:219],a[164:167],a[84:87],v[216:219]
s_waitcnt lgkmcnt(2)
M v[220:223],a[164:167],a[92:95],v[220:223]
s_waitcnt vmcnt(19) lgkmcnt(0)
M v[220:223],a[160:163],a[88:91],v[220:223]
s_barrier
M v[252:255],a[168:171],a[88:91],v[252:255]
R a[160:163],v5,0
R a[164:167],v6,0
M v[252:255],a[172:175],a[92:95],v[252:255]
M v[248:251],a[172:175],a[84:87],v[248:251]
M v[248:251],a[168:171],a[80:83],v[248:251]
M v[244:247],a[168:171],a[72:75],v[244:247]
M v[244:247],a[172:175],a[76:79],v[244:247]
M v[240:243],a[172:175],a[68:71],v[240:243]
M v[240:243],a[168:171],a[64:67],v[240:243]
M v[236:239],a[168:171],a[56:59],v[236:239]
M v[236:239],a[172:175],a[60:63],v[236:239]
M v[232:235],a[172:175],a[52:55],v[232:235]
M v[232:235],a[168:171],a[48:51],v[232:235]
M v[228:231],a[168:171],a[40:43],v[228:231]
M v[228:231],a[172:175],a[44:47],v[228:231]
s_waitcnt lgkmcnt(0)
M v[224:227],a[172:175],a[36:39],v[224:227]
M v[224:227],a[168:171],a[32:35],v[224:227]
M a[0:3],a[160:163],a[96:99],a[0:3]
R a[168:171],v5,2048
R a[172:175],v6,2048
M a[0:3],a[164:167],a[100:103],a[0:3]
T a[32:33],v1,32768
T a[34:35],v1,33792
M a[4:7],a[164:167],a[108:111],a[4:7]
SA m0,s24,49152
M a[4:7],a[160:163],a[104:107],a[4:7]
buffer_load_dwordx4 v12, s[48:51], s22 offen offset:0   lds
M a[8:11],a[160:163],a[112:115],a[8:11]
M a[8:11],a[164:167],a[116:119],a[8:11]
M a[12:15],a[164:167],a[124:127],a[12:15]
s_nop 0
T a[36:37],v1,40960
T a[38:39],v1,41984
M a[12:15],a[160:163],a[120:123],a[12:15]
M a[16:19],a[160:163],a[128:131],a[16:19]
buffer_load_dwordx4 v13, s[48:51], s22 offen offset:1024   lds
M a[16:19],a[164:167],a[132:135],a[16:19]
M a[20:23],a[164:167],a[140:143],a[20:23]
M a[20:23],a[160:163],a[136:139],a[20:23]
s_nop 0
T a[40:41],v2,32768
T a[42:43],v2,33792
M a[24:27],a[160:163],a[144:147],a[24:27]
M a[24:27],a[164:167],a[148:151],a[24:27]
s_waitcnt lgkmcnt(6)
buffer_load_dwordx4 v14, s[48:51], s22 offen offset:2048   lds
M a[28:31],a[164:167],a[156:159],a[28:31]
M a[28:31],a[160:163],a[152:155],a[28:31]
M v[60:63],a[168:171],a[152:155],v[60:63]
R a[160:163],v5,4096
R a[164:167],v6,4096
M v[60:63],a[172:175],a[156:159],v[60:63]
T a[44:45],v2,40960
T a[46:47],v2,41984
M v[56:59],a[172:175],a[148:151],v[56:59]
buffer_load_dwordx4 v15, s[48:51], s22 offen offset:3072   lds
M v[56:59],a[168:171],a[144:147],v[56:59]
s_sub_u32 s22, s22, 1048448
M v[52:55],a[168:171],a[136:139],v[52:55]
M v[52:55],a[172:175],a[140:143],v[52:55]
s_nop 0
T a[48:49],v3,32768
T a[50:51],v3,33792
M v[48:51],a[172:175],a[132:135],v[48:51]
SA m0,s23,16384
M v[48:51],a[168:171],a[128:131],v[48:51]
buffer_load_dwordx4 v8, s[16:19], s21 offen offset:0   lds
M v[44:47],a[168:171],a[120:123],v[44:47]
M v[44:47],a[172:175],a[124:127],v[44:47]
M v[40:43],a[172:175],a[116:119],v[40:43]
s_nop 0
T a[52:53],v3,40960
T a[54:55],v3,41984
M v[40:43],a[168:171],a[112:115],v[40:43]
M v[36:39],a[168:171],a[104:107],v[36:39]
buffer_load_dwordx4 v9, s[16:19], s21 offen offset:1024   lds
M v[36:39],a[172:175],a[108:111],v[36:39]
s_waitcnt lgkmcnt(6)
M v[32:35],a[172:175],a[100:103],v[32:35]
M v[32:35],a[168:171],a[96:99],v[32:35]
s_nop 0
T a[56:57],v4,32768
T a[58:59],v4,33792
M v[64:67],a[160:163],a[96:99],v[64:67]
R a[168:171],v5,6144
R a[172:175],v6,6144
M v[64:67],a[164:167],a[100:103],v[64:67]
buffer_load_dwordx4 v10, s[16:19], s21 offen offset:2048   lds
M v[68:71],a[164:167],a[108:111],v[68:71]
M v[68:71],a[160:163],a[104:107],v[68:71]
M v[72:75],a[160:163],a[112:115],v[72:75]
s_nop 0
T a[60:61],v4,40960
T a[62:63],v4,41984
M v[72:75],a[164:167],a[116:119],v[72:75]
M v[76:79],a[164:167],a[124:127],v[76:79]
buffer_load_dwordx4 v11, s[16:19], s21 offen offset:3072   lds
M v[76:79],a[160:163],a[120:123],v[76:79]
SA s21,s21,524160
M v[80:83],a[160:163],a[128:131],v[80:83]
M v[80:83],a[164:167],a[132:135],v[80:83]
M v[84:87],a[164:167],a[140:143],v[84:87]
M v[84:87],a[160:163],a[136:139],v[84:87]
M v[88:91],a[160:163],a[144:147],v[88:91]
M v[88:91],a[164:167],a[148:151],v[88:91]
s_waitcnt lgkmcnt(2)
M v[92:95],a[164:167],a[156:159],v[92:95]
s_waitcnt vmcnt(18) lgkmcnt(0)
M v[92:95],a[160:163],a[152:155],v[92:95]
s_barrier
M v[124:127],a[168:171],a[152:155],v[124:127]
R a[160:163],v5,16384
R a[164:167],v6,16384
M v[124:127],a[172:175],a[156:159],v[124:127]
M v[120:123],a[172:175],a[148:151],v[120:123]
SA m0,s24,0
T a[64:65],v1,49152
T a[66:67],v1,50176
M v[120:123],a[168:171],a[144:147],v[120:123]
buffer_load_dwordx4 v12, s[48:51], s22 offen offset:0   lds
M v[116:119],a[168:171],a[136:139],v[116:119]
M v[116:119],a[172:175],a[140:143],v[116:119]
M v[112:115],a[172:175],a[132:135],v[112:115]
M v[112:115],a[168:171],a[128:131],v[112:115]
M v[108:111],a[168:171],a[120:123],v[108:111]
M v[108:111],a[172:175],a[124:127],v[108:111]
s_nop 0
T a[68:69],v1,57344
T a[70:71],v1,58368
M v[104:107],a[172:175],a[116:119],v[104:107]
buffer_load_dwordx4 v13, s[48:51], s22 offen offset:1024   lds
M v[104:107],a[168:171],a[112:115],v[104:107]
M v[100:103],a[168:171],a[104:107],v[100:103]
M v[100:103],a[172:175],a[108:111],v[100:103]
s_waitcnt lgkmcnt(4)
M v[96:99],a[172:175],a[100:103],v[96:99]
M v[96:99],a[168:171],a[96:99],v[96:99]
M v[128:131],a[160:163],a[96:99],v[128:131]
R a[168:171],v5,18432
R a[172:175],v6,18432
M v[128:131],a[164:167],a[100:103],v[128:131]
T a[72:73],v2,49152
T a[74:75],v2,50176
M v[132:135],a[164:167],a[108:111],v[132:135]
buffer_load_dwordx4 v14, s[48:51], s22 offen offset:2048   lds
M v[132:135],a[160:163],a[104:107],v[132:135]
M v[136:139],a[160:163],a[112:115],v[136:139]
M v[136:139],a[164:167],a[116:119],v[136:139]
M v[140:143],a[164:167],a[124:127],v[140:143]
M v[140:143],a[160:163],a[120:123],v[140:143]
s_nop 0
T a[76:77],v2,57344
T a[78:79],v2,58368
M v[144:147],a[160:163],a[128:131],v[144:147]
buffer_load_dwordx4 v15, s[48:51], s22 offen offset:3072   lds
M v[144:147],a[164:167],a[132:135],v[144:147]
SA s22,s22,1048576
M v[148:151],a[164:167],a[140:143],v[148:151]
M v[148:151],a[160:163],a[136:139],v[148:151]
M v[152:155],a[160:163],a[144:147],v[152:155]
M v[152:155],a[164:167],a[148:151],v[152:155]
s_waitcnt lgkmcnt(4)
M v[156:159],a[164:167],a[156:159],v[156:159]
SA m0,s23,32768
T a[80:81],v3,49152
T a[82:83],v3,50176
M v[156:159],a[160:163],a[152:155],v[156:159]
buffer_load_dwordx4 v8, s[16:19], s21 offen offset:0   lds
M v[188:191],a[168:171],a[152:155],v[188:191]
R a[160:163],v5,20480
R a[164:167],v6,20480
M v[188:191],a[172:175],a[156:159],v[188:191]
buffer_load_dword a240, v26, s[60:63], s27 offen offset:0
M v[184:187],a[172:175],a[148:151],v[184:187]
SA s27,s27,2048
M v[184:187],a[168:171],a[144:147],v[184:187]
M v[180:183],a[168:171],a[136:139],v[180:183]
M v[180:183],a[172:175],a[140:143],v[180:183]
s_nop 0
T a[84:85],v3,57344
T a[86:87],v3,58368
M v[176:179],a[172:175],a[132:135],v[176:179]
buffer_load_dwordx4 v9, s[16:19], s21 offen offset:1024   lds
M v[176:179],a[168:171],a[128:131],v[176:179]
M v[172:175],a[168:171],a[120:123],v[172:175]
M v[172:175],a[172:175],a[124:127],v[172:175]
M v[168:171],a[172:175],a[116:119],v[168:171]
M v[168:171],a[168:171],a[112:115],v[168:171]
M v[164:167],a[168:171],a[104:107],v[164:167]
s_nop 0
T a[88:89],v4,49152
T a[90:91],v4,50176
M v[164:167],a[172:175],a[108:111],v[164:167]
s_waitcnt lgkmcnt(4)
buffer_load_dwordx4 v10, s[16:19], s21 offen offset:2048   lds
M v[160:163],a[172:175],a[100:103],v[160:163]
M v[160:163],a[168:171],a[96:99],v[160:163]
M v[192:195],a[160:163],a[96:99],v[192:195]
R a[168:171],v5,22528
R a[172:175],v6,22528
M v[192:195],a[164:167],a[100:103],v[192:195]
M v[196:199],a[164:167],a[108:111],v[196:199]
M v[196:199],a[160:163],a[104:107],v[196:199]
s_nop 0
T a[92:93],v4,57344
T a[94:95],v4,58368
M v[200:203],a[160:163],a[112:115],v[200:203]
buffer_load_dwordx4 v11, s[16:19], s21 offen offset:3072   lds
M v[200:203],a[164:167],a[116:119],v[200:203]
SA s21,s21,128
M v[204:207],a[164:167],a[124:127],v[204:207]
M v[204:207],a[160:163],a[120:123],v[204:207]
M v[208:211],a[160:163],a[128:131],v[208:211]
M v[208:211],a[164:167],a[132:135],v[208:211]
M v[212:215],a[164:167],a[140:143],v[212:215]
M v[212:215],a[160:163],a[136:139],v[212:215]
M v[216:219],a[160:163],a[144:147],v[216:219]
M v[216:219],a[164:167],a[148:151],v[216:219]
s_waitcnt lgkmcnt(2)
M v[220:223],a[164:167],a[156:159],v[220:223]
s_waitcnt vmcnt(17) lgkmcnt(0)
M v[220:223],a[160:163],a[152:155],v[220:223]
s_barrier
M v[252:255],a[168:171],a[152:155],v[252:255]
R a[160:163],v5,32768
R a[164:167],v6,32768
M v[252:255],a[172:175],a[156:159],v[252:255]
v_cmp_ne_u32 vcc, 1, v17
M v[248:251],a[172:175],a[148:151],v[248:251]
s_nop 0
M v[248:251],a[168:171],a[144:147],v[248:251]
s_cbranch_vccnz L_zs1
L_zr1:
M v[244:247],a[168:171],a[136:139],v[244:247]
M v[244:247],a[172:175],a[140:143],v[244:247]
s_lshl_b32 s72, s30, 6
M v[240:243],a[172:175],a[132:135],v[240:243]
SA s72,s72,104914944
M v[240:243],a[168:171],a[128:131],v[240:243]
buffer_store_dword v19, v18, s[8:11], s72 offen sc1
M v[236:239],a[168:171],a[120:123],v[236:239]
M v[236:239],a[172:175],a[124:127],v[236:239]
M v[232:235],a[172:175],a[116:119],v[232:235]
M v[232:235],a[168:171],a[112:115],v[232:235]
M v[228:231],a[168:171],a[104:107],v[228:231]
M v[228:231],a[172:175],a[108:111],v[228:231]
s_waitcnt lgkmcnt(0)
M v[224:227],a[172:175],a[100:103],v[224:227]
M v[224:227],a[168:171],a[96:99],v[224:227]
M a[0:3],a[160:163],a[32:35],a[0:3]
R a[168:171],v5,34816
R a[172:175],v6,34816
M a[0:3],a[164:167],a[36:39],a[0:3]
T a[96:97],v1,0
T a[98:99],v1,1024
M a[4:7],a[164:167],a[44:47],a[4:7]
SA m0,s24,16384
M a[4:7],a[160:163],a[40:43],a[4:7]
buffer_load_dwordx4 v12, s[48:51], s22 offen offset:0   lds
M a[8:11],a[160:163],a[48:51],a[8:11]
M a[8:11],a[164:167],a[52:55],a[8:11]
s_mul_i32 s64, s41, 229376
M a[12:15],a[164:167],a[60:63],a[12:15]
SA s72,s90,s64
T a[100:101],v1,8192
T a[102:103],v1,9216
M a[12:15],a[160:163],a[56:59],a[12:15]
s_addc_u32 s73, s91, 0
M a[16:19],a[160:163],a[64:67],a[16:19]
s_sub_u32 s75, 3670016, s64
buffer_load_dwordx4 v13, s[48:51], s22 offen offset:1024   lds
M a[16:19],a[164:167],a[68:71],a[16:19]
s_mov_b32 s12, s72
M a[20:23],a[164:167],a[76:79],a[20:23]
s_and_b32 s13, s73, 0xffff
M a[20:23],a[160:163],a[72:75],a[20:23]
s_mov_b32 s14, s75
T a[104:105],v2,0
T a[106:107],v2,1024
M a[24:27],a[160:163],a[80:83],a[24:27]
s_mov_b32 s15, 0x20000
M a[24:27],a[164:167],a[84:87],a[24:27]
s_waitcnt lgkmcnt(6)
buffer_load_dwordx4 v14, s[48:51], s22 offen offset:2048   lds
M a[28:31],a[164:167],a[92:95],a[28:31]
M a[28:31],a[160:163],a[88:91],a[28:31]
M v[60:63],a[168:171],a[88:91],v[60:63]
R a[160:163],v5,36864
R a[164:167],v6,36864
M v[60:63],a[172:175],a[92:95],v[60:63]
T a[108:109],v2,8192
T a[110:111],v2,9216
M v[56:59],a[172:175],a[84:87],v[56:59]
buffer_load_dwordx4 v15, s[48:51], s22 offen offset:3072   lds
M v[56:59],a[168:171],a[80:83],v[56:59]
s_sub_u32 s22, s22, 1048448
M v[52:55],a[168:171],a[72:75],v[52:55]
M v[52:55],a[172:175],a[76:79],v[52:55]
s_nop 0
T a[112:113],v3,0
T a[114:115],v3,1024
M v[48:51],a[172:175],a[68:71],v[48:51]
SA m0,s23,49152
M v[48:51],a[168:171],a[64:67],v[48:51]
buffer_load_dwordx4 v8, s[16:19], s21 offen offset:0   lds
M v[44:47],a[168:171],a[56:59],v[44:47]
M v[44:47],a[172:175],a[60:63],v[44:47]
M v[40:43],a[172:175],a[52:55],v[40:43]
s_nop 0
T a[116:117],v3,8192
T a[118:119],v3,9216
M v[40:43],a[168:171],a[48:51],v[40:43]
M v[36:39],a[168:171],a[40:43],v[36:39]
buffer_load_dwordx4 v9, s[16:19], s21 offen offset:1024   lds
M v[36:39],a[172:175],a[44:47],v[36:39]
s_waitcnt lgkmcnt(6)
M v[32:35],a[172:175],a[36:39],v[32:35]
M v[32:35],a[168:171],a[32:35],v[32:35]
s_nop 0
T a[120:121],v4,0
T a[122:123],v4,1024
M v[64:67],a[160:163],a[32:35],v[64:67]
R a[168:171],v5,38912
R a[172:175],v6,38912
M v[64:67],a[164:167],a[36:39],v[64:67]
buffer_load_dwordx4 v10, s[16:19], s21 offen offset:2048   lds
M v[68:71],a[164:167],a[44:47],v[68:71]
M v[68:71],a[160:163],a[40:43],v[68:71]
M v[72:75],a[160:163],a[48:51],v[72:75]
s_nop 0
T a[124:125],v4,8192
T a[126:127],v4,9216
M v[72:75],a[164:167],a[52:55],v[72:75]
M v[76:79],a[164:167],a[60:63],v[76:79]
buffer_load_dwordx4 v11, s[16:19], s21 offen offset:3072   lds
M v[76:79],a[160:163],a[56:59],v[76:79]
SA s21,s21,524160
M v[80:83],a[160:163],a[64:67],v[80:83]
M v[80:83],a[164:167],a[68:71],v[80:83]
M v[84:87],a[164:167],a[76:79],v[84:87]
M v[84:87],a[160:163],a[72:75],v[84:87]
M v[88:91],a[160:163],a[80:83],v[88:91]
M v[88:91],a[164:167],a[84:87],v[88:91]
s_waitcnt lgkmcnt(2)
M v[92:95],a[164:167],a[92:95],v[92:95]
s_waitcnt vmcnt(18) lgkmcnt(0)
M v[92:95],a[160:163],a[88:91],v[92:95]
s_barrier
M v[124:127],a[168:171],a[88:91],v[124:127]
R a[160:163],v5,49152
R a[164:167],v6,49152
M v[124:127],a[172:175],a[92:95],v[124:127]
M v[120:123],a[172:175],a[84:87],v[120:123]
SA m0,s24,32768
T a[128:129],v1,16384
T a[130:131],v1,17408
M v[120:123],a[168:171],a[80:83],v[120:123]
buffer_load_dwordx4 v12, s[48:51], s22 offen offset:0   lds
M v[116:119],a[168:171],a[72:75],v[116:119]
M v[116:119],a[172:175],a[76:79],v[116:119]
M v[112:115],a[172:175],a[68:71],v[112:115]
M v[112:115],a[168:171],a[64:67],v[112:115]
M v[108:111],a[168:171],a[56:59],v[108:111]
M v[108:111],a[172:175],a[60:63],v[108:111]
s_nop 0
T a[132:133],v1,24576
T a[134:135],v1,25600
M v[104:107],a[172:175],a[52:55],v[104:107]
buffer_load_dwordx4 v13, s[48:51], s22 offen offset:1024   lds
M v[104:107],a[168:171],a[48:51],v[104:107]
M v[100:103],a[168:171],a[40:43],v[100:103]
M v[100:103],a[172:175],a[44:47],v[100:103]
s_waitcnt lgkmcnt(4)
M v[96:99],a[172:175],a[36:39],v[96:99]
M v[96:99],a[168:171],a[32:35],v[96:99]
M v[128:131],a[160:163],a[32:35],v[128:131]
R a[168:171],v5,51200
R a[172:175],v6,51200
M v[128:131],a[164:167],a[36:39],v[128:131]
T a[136:137],v2,16384
T a[138:139],v2,17408
M v[132:135],a[164:167],a[44:47],v[132:135]
buffer_load_dwordx4 v14, s[48:51], s22 offen offset:2048   lds
M v[132:135],a[160:163],a[40:43],v[132:135]
M v[136:139],a[160:163],a[48:51],v[136:139]
M v[136:139],a[164:167],a[52:55],v[136:139]
M v[140:143],a[164:167],a[60:63],v[140:143]
M v[140:143],a[160:163],a[56:59],v[140:143]
s_nop 0
T a[140:141],v2,24576
T a[142:143],v2,25600
M v[144:147],a[160:163],a[64:67],v[144:147]
buffer_load_dwordx4 v15, s[48:51], s22 offen offset:3072   lds
M v[144:147],a[164:167],a[68:71],v[144:147]
SA s22,s22,1048576
M v[148:151],a[164:167],a[76:79],v[148:151]
M v[148:151],a[160:163],a[72:75],v[148:151]
M v[152:155],a[160:163],a[80:83],v[152:155]
M v[152:155],a[164:167],a[84:87],v[152:155]
s_waitcnt lgkmcnt(4)
M v[156:159],a[164:167],a[92:95],v[156:159]
SA m0,s23,0
T a[144:145],v3,16384
T a[146:147],v3,17408
M v[156:159],a[160:163],a[88:91],v[156:159]
buffer_load_dwordx4 v8, s[16:19], s21 offen offset:0   lds
M v[188:191],a[168:171],a[88:91],v[188:191]
R a[160:163],v5,53248
R a[164:167],v6,53248
M v[188:191],a[172:175],a[92:95],v[188:191]
buffer_load_dword a240, v26, s[60:63], s27 offen offset:0
M v[184:187],a[172:175],a[84:87],v[184:187]
SA s27,s27,2048
M v[184:187],a[168:171],a[80:83],v[184:187]
M v[180:183],a[168:171],a[72:75],v[180:183]
M v[180:183],a[172:175],a[76:79],v[180:183]
s_nop 0
T a[148:149],v3,24576
T a[150:151],v3,25600
M v[176:179],a[172:175],a[68:71],v[176:179]
buffer_load_dwordx4 v9, s[16:19], s21 offen offset:1024   lds
M v[176:179],a[168:171],a[64:67],v[176:179]
M v[172:175],a[168:171],a[56:59],v[172:175]
M v[172:175],a[172:175],a[60:63],v[172:175]
M v[168:171],a[172:175],a[52:55],v[168:171]
M v[168:171],a[168:171],a[48:51],v[168:171]
M v[164:167],a[168:171],a[40:43],v[164:167]
s_nop 0
T a[152:153],v4,16384
T a[154:155],v4,17408
M v[164:167],a[172:175],a[44:47],v[164:167]
s_waitcnt lgkmcnt(4)
buffer_load_dwordx4 v10, s[16:19], s21 offen offset:2048   lds
M v[160:163],a[172:175],a[36:39],v[160:163]
M v[160:163],a[168:171],a[32:35],v[160:163]
M v[192:195],a[160:163],a[32:35],v[192:195]
R a[168:171],v5,55296
R a[172:175],v6,55296
M v[192:195],a[164:167],a[36:39],v[192:195]
M v[196:199],a[164:167],a[44:47],v[196:199]
M v[196:199],a[160:163],a[40:43],v[196:199]
s_nop 0
T a[156:157],v4,24576
T a[158:159],v4,25600
M v[200:203],a[160:163],a[48:51],v[200:203]
buffer_load_dwordx4 v11, s[16:19], s21 offen offset:3072   lds
M v[200:203],a[164:167],a[52:55],v[200:203]
SA s21,s21,128
M v[204:207],a[164:167],a[60:63],v[204:207]
M v[204:207],a[160:163],a[56:59],v[204:207]
M v[208:211],a[160:163],a[64:67],v[208:211]
M v[208:211],a[164:167],a[68:71],v[208:211]
M v[212:215],a[164:167],a[76:79],v[212:215]
M v[212:215],a[160:163],a[72:75],v[212:215]
M v[216:219],a[160:163],a[80:83],v[216:219]
M v[216:219],a[164:167],a[84:87],v[216:219]
s_waitcnt lgkmcnt(2)
M v[220:223],a[164:167],a[92:95],v[220:223]
s_waitcnt vmcnt(18) lgkmcnt(0)
M v[220:223],a[160:163],a[88:91],v[220:223]
s_barrier
M v[252:255],a[168:171],a[88:91],v[252:255]
R a[160:163],v5,0
R a[164:167],v6,0
M v[252:255],a[172:175],a[92:95],v[252:255]
M v[248:251],a[172:175],a[84:87],v[248:251]
M v[248:251],a[168:171],a[80:83],v[248:251]
M v[244:247],a[168:171],a[72:75],v[244:247]
M v[244:247],a[172:175],a[76:79],v[244:247]
M v[240:243],a[172:175],a[68:71],v[240:243]
M v[240:243],a[168:171],a[64:67],v[240:243]
M v[236:239],a[168:171],a[56:59],v[236:239]
M v[236:239],a[172:175],a[60:63],v[236:239]
M v[232:235],a[172:175],a[52:55],v[232:235]
M v[232:235],a[168:171],a[48:51],v[232:235]
M v[228:231],a[168:171],a[40:43],v[228:231]
M v[228:231],a[172:175],a[44:47],v[228:231]
s_waitcnt lgkmcnt(0)
M v[224:227],a[172:175],a[36:39],v[224:227]
M v[224:227],a[168:171],a[32:35],v[224:227]
M a[0:3],a[160:163],a[96:99],a[0:3]
R a[168:171],v5,2048
R a[172:175],v6,2048
M a[0:3],a[164:167],a[100:103],a[0:3]
T a[32:33],v1,32768
T a[34:35],v1,33792
M a[4:7],a[164:167],a[108:111],a[4:7]
SA m0,s24,49152
M a[4:7],a[160:163],a[104:107],a[4:7]
buffer_load_dwordx4 v12, s[48:51], s22 offen offset:0   lds
M a[8:11],a[160:163],a[112:115],a[8:11]
M a[8:11],a[164:167],a[116:119],a[8:11]
M a[12:15],a[164:167],a[124:127],a[12:15]
s_nop 0
T a[36:37],v1,40960
T a[38:39],v1,41984
M a[12:15],a[160:163],a[120:123],a[12:15]
M a[16:19],a[160:163],a[128:131],a[16:19]
buffer_load_dwordx4 v13, s[48:51], s22 offen offset:1024   lds
M a[16:19],a[164:167],a[132:135],a[16:19]
M a[20:23],a[164:167],a[140:143],a[20:23]
M a[20:23],a[160:163],a[136:139],a[20:23]
s_nop 0
T a[40:41],v2,32768
T a[42:43],v2,33792
M a[24:27],a[160:163],a[144:147],a[24:27]
M a[24:27],a[164:167],a[148:151],a[24:27]
s_waitcnt lgkmcnt(6)
buffer_load_dwordx4 v14, s[48:51], s22 offen offset:2048   lds
M a[28:31],a[164:167],a[156:159],a[28:31]
M a[28:31],a[160:163],a[152:155],a[28:31]
M v[60:63],a[168:171],a[152:155],v[60:63]
R a[160:163],v5,4096
R a[164:167],v6,4096
M v[60:63],a[172:175],a[156:159],v[60:63]
T a[44:45],v2,40960
T a[46:47],v2,41984
L_w_kv13:
s_cbranch_execz L_w_kv17
M v[56:59],a[172:175],a[148:151],v[56:59]
buffer_load_dwordx4 v15, s[48:51], s22 offen offset:3072   lds
M v[56:59],a[168:171],a[144:147],v[56:59]
s_sub_u32 s22, s22, 1048448
M v[52:55],a[168:171],a[136:139],v[52:55]
M v[52:55],a[172:175],a[140:143],v[52:55]
s_nop 0
T a[48:49],v3,32768
T a[50:51],v3,33792
M v[48:51],a[172:175],a[132:135],v[48:51]
SA m0,s23,16384
M v[48:51],a[168:171],a[128:131],v[48:51]
buffer_load_dwordx4 v8, s[16:19], s21 offen offset:0   lds
M v[44:47],a[168:171],a[120:123],v[44:47]
M v[44:47],a[172:175],a[124:127],v[44:47]
M v[40:43],a[172:175],a[116:119],v[40:43]
s_nop 0
T a[52:53],v3,40960
T a[54:55],v3,41984
M v[40:43],a[168:171],a[112:115],v[40:43]
M v[36:39],a[168:171],a[104:107],v[36:39]
buffer_load_dwordx4 v9, s[16:19], s21 offen offset:1024   lds
M v[36:39],a[172:175],a[108:111],v[36:39]
s_waitcnt lgkmcnt(6)
M v[32:35],a[172:175],a[100:103],v[32:35]
M v[32:35],a[168:171],a[96:99],v[32:35]
s_nop 0
T a[56:57],v4,32768
T a[58:59],v4,33792
M v[64:67],a[160:163],a[96:99],v[64:67]
R a[168:171],v5,6144
R a[172:175],v6,6144
M v[64:67],a[164:167],a[100:103],v[64:67]
buffer_load_dwordx4 v10, s[16:19], s21 offen offset:2048   lds
M v[68:71],a[164:167],a[108:111],v[68:71]
M v[68:71],a[160:163],a[104:107],v[68:71]
M v[72:75],a[160:163],a[112:115],v[72:75]
s_nop 0
T a[60:61],v4,40960
T a[62:63],v4,41984
M v[72:75],a[164:167],a[116:119],v[72:75]
M v[76:79],a[164:167],a[124:127],v[76:79]
buffer_load_dwordx4 v11, s[16:19], s21 offen offset:3072   lds
M v[76:79],a[160:163],a[120:123],v[76:79]
SA s21,s21,524160
M v[80:83],a[160:163],a[128:131],v[80:83]
M v[80:83],a[164:167],a[132:135],v[80:83]
M v[84:87],a[164:167],a[140:143],v[84:87]
M v[84:87],a[160:163],a[136:139],v[84:87]
M v[88:91],a[160:163],a[144:147],v[88:91]
M v[88:91],a[164:167],a[148:151],v[88:91]
s_waitcnt lgkmcnt(2)
M v[92:95],a[164:167],a[156:159],v[92:95]
s_waitcnt vmcnt(17) lgkmcnt(0)
M v[92:95],a[160:163],a[152:155],v[92:95]
s_barrier
M v[124:127],a[168:171],a[152:155],v[124:127]
R a[160:163],v5,16384
R a[164:167],v6,16384
M v[124:127],a[172:175],a[156:159],v[124:127]
M v[120:123],a[172:175],a[148:151],v[120:123]
SA m0,s24,0
T a[64:65],v1,49152
T a[66:67],v1,50176
M v[120:123],a[168:171],a[144:147],v[120:123]
buffer_load_dwordx4 v12, s[48:51], s22 offen offset:0   lds
M v[116:119],a[168:171],a[136:139],v[116:119]
M v[116:119],a[172:175],a[140:143],v[116:119]
M v[112:115],a[172:175],a[132:135],v[112:115]
M v[112:115],a[168:171],a[128:131],v[112:115]
M v[108:111],a[168:171],a[120:123],v[108:111]
M v[108:111],a[172:175],a[124:127],v[108:111]
s_nop 0
T a[68:69],v1,57344
T a[70:71],v1,58368
M v[104:107],a[172:175],a[116:119],v[104:107]
buffer_load_dwordx4 v13, s[48:51], s22 offen offset:1024   lds
M v[104:107],a[168:171],a[112:115],v[104:107]
M v[100:103],a[168:171],a[104:107],v[100:103]
M v[100:103],a[172:175],a[108:111],v[100:103]
s_waitcnt lgkmcnt(4)
M v[96:99],a[172:175],a[100:103],v[96:99]
M v[96:99],a[168:171],a[96:99],v[96:99]
M v[128:131],a[160:163],a[96:99],v[128:131]
R a[168:171],v5,18432
R a[172:175],v6,18432
M v[128:131],a[164:167],a[100:103],v[128:131]
T a[72:73],v2,49152
T a[74:75],v2,50176
M v[132:135],a[164:167],a[108:111],v[132:135]
buffer_load_dwordx4 v14, s[48:51], s22 offen offset:2048   lds
M v[132:135],a[160:163],a[104:107],v[132:135]
M v[136:139],a[160:163],a[112:115],v[136:139]
M v[136:139],a[164:167],a[116:119],v[136:139]
M v[140:143],a[164:167],a[124:127],v[140:143]
M v[140:143],a[160:163],a[120:123],v[140:143]
s_nop 0
T a[76:77],v2,57344
T a[78:79],v2,58368
M v[144:147],a[160:163],a[128:131],v[144:147]
buffer_load_dwordx4 v15, s[48:51], s22 offen offset:3072   lds
M v[144:147],a[164:167],a[132:135],v[144:147]
SA s22,s22,1048576
M v[148:151],a[164:167],a[140:143],v[148:151]
M v[148:151],a[160:163],a[136:139],v[148:151]
M v[152:155],a[160:163],a[144:147],v[152:155]
M v[152:155],a[164:167],a[148:151],v[152:155]
s_waitcnt lgkmcnt(4)
M v[156:159],a[164:167],a[156:159],v[156:159]
SA m0,s23,32768
T a[80:81],v3,49152
T a[82:83],v3,50176
M v[156:159],a[160:163],a[152:155],v[156:159]
buffer_load_dwordx4 v8, s[16:19], s21 offen offset:0   lds
M v[188:191],a[168:171],a[152:155],v[188:191]
R a[160:163],v5,20480
R a[164:167],v6,20480
M v[188:191],a[172:175],a[156:159],v[188:191]
buffer_load_dword a240, v26, s[60:63], s27 offen offset:0
M v[184:187],a[172:175],a[148:151],v[184:187]
SA s27,s27,2048
M v[184:187],a[168:171],a[144:147],v[184:187]
M v[180:183],a[168:171],a[136:139],v[180:183]
M v[180:183],a[172:175],a[140:143],v[180:183]
s_nop 0
T a[84:85],v3,57344
T a[86:87],v3,58368
M v[176:179],a[172:175],a[132:135],v[176:179]
buffer_load_dwordx4 v9, s[16:19], s21 offen offset:1024   lds
M v[176:179],a[168:171],a[128:131],v[176:179]
M v[172:175],a[168:171],a[120:123],v[172:175]
M v[172:175],a[172:175],a[124:127],v[172:175]
M v[168:171],a[172:175],a[116:119],v[168:171]
M v[168:171],a[168:171],a[112:115],v[168:171]
M v[164:167],a[168:171],a[104:107],v[164:167]
s_nop 0
T a[88:89],v4,49152
T a[90:91],v4,50176
M v[164:167],a[172:175],a[108:111],v[164:167]
s_waitcnt lgkmcnt(4)
buffer_load_dwordx4 v10, s[16:19], s21 offen offset:2048   lds
M v[160:163],a[172:175],a[100:103],v[160:163]
M v[160:163],a[168:171],a[96:99],v[160:163]
M v[192:195],a[160:163],a[96:99],v[192:195]
R a[168:171],v5,22528
R a[172:175],v6,22528
M v[192:195],a[164:167],a[100:103],v[192:195]
M v[196:199],a[164:167],a[108:111],v[196:199]
M v[196:199],a[160:163],a[104:107],v[196:199]
s_nop 0
T a[92:93],v4,57344
T a[94:95],v4,58368
M v[200:203],a[160:163],a[112:115],v[200:203]
buffer_load_dwordx4 v11, s[16:19], s21 offen offset:3072   lds
M v[200:203],a[164:167],a[116:119],v[200:203]
SA s21,s21,128
M v[204:207],a[164:167],a[124:127],v[204:207]
M v[204:207],a[160:163],a[120:123],v[204:207]
M v[208:211],a[160:163],a[128:131],v[208:211]
M v[208:211],a[164:167],a[132:135],v[208:211]
M v[212:215],a[164:167],a[140:143],v[212:215]
M v[212:215],a[160:163],a[136:139],v[212:215]
M v[216:219],a[160:163],a[144:147],v[216:219]
M v[216:219],a[164:167],a[148:151],v[216:219]
s_waitcnt lgkmcnt(2)
M v[220:223],a[164:167],a[156:159],v[220:223]
s_waitcnt vmcnt(17) lgkmcnt(0)
M v[220:223],a[160:163],a[152:155],v[220:223]
s_barrier
M v[252:255],a[168:171],a[152:155],v[252:255]
R a[160:163],v5,32768
R a[164:167],v6,32768
M v[252:255],a[172:175],a[156:159],v[252:255]
M v[248:251],a[172:175],a[148:151],v[248:251]
M v[248:251],a[168:171],a[144:147],v[248:251]
M v[244:247],a[168:171],a[136:139],v[244:247]
M v[244:247],a[172:175],a[140:143],v[244:247]
M v[240:243],a[172:175],a[132:135],v[240:243]
M v[240:243],a[168:171],a[128:131],v[240:243]
M v[236:239],a[168:171],a[120:123],v[236:239]
M v[236:239],a[172:175],a[124:127],v[236:239]
M v[232:235],a[172:175],a[116:119],v[232:235]
M v[232:235],a[168:171],a[112:115],v[232:235]
M v[228:231],a[168:171],a[104:107],v[228:231]
M v[228:231],a[172:175],a[108:111],v[228:231]
s_waitcnt lgkmcnt(0)
M v[224:227],a[172:175],a[100:103],v[224:227]
M v[224:227],a[168:171],a[96:99],v[224:227]
M a[0:3],a[160:163],a[32:35],a[0:3]
R a[168:171],v5,34816
R a[172:175],v6,34816
M a[0:3],a[164:167],a[36:39],a[0:3]
T a[96:97],v1,0
T a[98:99],v1,1024
M a[4:7],a[164:167],a[44:47],a[4:7]
SA m0,s24,16384
M a[4:7],a[160:163],a[40:43],a[4:7]
buffer_load_dwordx4 v12, s[48:51], s22 offen offset:0   lds
M a[8:11],a[160:163],a[48:51],a[8:11]
M a[8:11],a[164:167],a[52:55],a[8:11]
M a[12:15],a[164:167],a[60:63],a[12:15]
s_nop 0
T a[100:101],v1,8192
T a[102:103],v1,9216
M a[12:15],a[160:163],a[56:59],a[12:15]
M a[16:19],a[160:163],a[64:67],a[16:19]
buffer_load_dwordx4 v13, s[48:51], s22 offen offset:1024   lds
M a[16:19],a[164:167],a[68:71],a[16:19]
M a[20:23],a[164:167],a[76:79],a[20:23]
M a[20:23],a[160:163],a[72:75],a[20:23]
s_nop 0
T a[104:105],v2,0
T a[106:107],v2,1024
M a[24:27],a[160:163],a[80:83],a[24:27]
M a[24:27],a[164:167],a[84:87],a[24:27]
s_waitcnt lgkmcnt(6)
buffer_load_dwordx4 v14, s[48:51], s22 offen offset:2048   lds
M a[28:31],a[164:167],a[92:95],a[28:31]
M a[28:31],a[160:163],a[88:91],a[28:31]
M v[60:63],a[168:171],a[88:91],v[60:63]
R a[160:163],v5,36864
R a[164:167],v6,36864
M v[60:63],a[172:175],a[92:95],v[60:63]
T a[108:109],v2,8192
T a[110:111],v2,9216
M v[56:59],a[172:175],a[84:87],v[56:59]
buffer_load_dwordx4 v15, s[48:51], s22 offen offset:3072   lds
M v[56:59],a[168:171],a[80:83],v[56:59]
s_sub_u32 s22, s22, 1048448
M v[52:55],a[168:171],a[72:75],v[52:55]
M v[52:55],a[172:175],a[76:79],v[52:55]
s_nop 0
T a[112:113],v3,0
T a[114:115],v3,1024
M v[48:51],a[172:175],a[68:71],v[48:51]
SA m0,s23,49152
M v[48:51],a[168:171],a[64:67],v[48:51]
buffer_load_dwordx4 v8, s[16:19], s21 offen offset:0   lds
M v[44:47],a[168:171],a[56:59],v[44:47]
M v[44:47],a[172:175],a[60:63],v[44:47]
M v[40:43],a[172:175],a[52:55],v[40:43]
s_nop 0
T a[116:117],v3,8192
T a[118:119],v3,9216
M v[40:43],a[168:171],a[48:51],v[40:43]
M v[36:39],a[168:171],a[40:43],v[36:39]
buffer_load_dwordx4 v9, s[16:19], s21 offen offset:1024   lds
M v[36:39],a[172:175],a[44:47],v[36:39]
s_waitcnt lgkmcnt(6)
M v[32:35],a[172:175],a[36:39],v[32:35]
M v[32:35],a[168:171],a[32:35],v[32:35]
s_nop 0
T a[120:121],v4,0
T a[122:123],v4,1024
M v[64:67],a[160:163],a[32:35],v[64:67]
R a[168:171],v5,38912
R a[172:175],v6,38912
M v[64:67],a[164:167],a[36:39],v[64:67]
buffer_load_dwordx4 v10, s[16:19], s21 offen offset:2048   lds
M v[68:71],a[164:167],a[44:47],v[68:71]
M v[68:71],a[160:163],a[40:43],v[68:71]
M v[72:75],a[160:163],a[48:51],v[72:75]
s_nop 0
T a[124:125],v4,8192
T a[126:127],v4,9216
M v[72:75],a[164:167],a[52:55],v[72:75]
M v[76:79],a[164:167],a[60:63],v[76:79]
buffer_load_dwordx4 v11, s[16:19], s21 offen offset:3072   lds
M v[76:79],a[160:163],a[56:59],v[76:79]
SA s21,s21,524160
M v[80:83],a[160:163],a[64:67],v[80:83]
M v[80:83],a[164:167],a[68:71],v[80:83]
M v[84:87],a[164:167],a[76:79],v[84:87]
M v[84:87],a[160:163],a[72:75],v[84:87]
M v[88:91],a[160:163],a[80:83],v[88:91]
M v[88:91],a[164:167],a[84:87],v[88:91]
s_waitcnt lgkmcnt(2)
M v[92:95],a[164:167],a[92:95],v[92:95]
s_waitcnt vmcnt(17) lgkmcnt(0)
M v[92:95],a[160:163],a[88:91],v[92:95]
s_barrier
M v[124:127],a[168:171],a[88:91],v[124:127]
R a[160:163],v5,49152
R a[164:167],v6,49152
M v[124:127],a[172:175],a[92:95],v[124:127]
M v[120:123],a[172:175],a[84:87],v[120:123]
SA m0,s24,32768
T a[128:129],v1,16384
T a[130:131],v1,17408
M v[120:123],a[168:171],a[80:83],v[120:123]
buffer_load_dwordx4 v12, s[48:51], s22 offen offset:0   lds
M v[116:119],a[168:171],a[72:75],v[116:119]
M v[116:119],a[172:175],a[76:79],v[116:119]
M v[112:115],a[172:175],a[68:71],v[112:115]
M v[112:115],a[168:171],a[64:67],v[112:115]
M v[108:111],a[168:171],a[56:59],v[108:111]
M v[108:111],a[172:175],a[60:63],v[108:111]
s_nop 0
T a[132:133],v1,24576
T a[134:135],v1,25600
M v[104:107],a[172:175],a[52:55],v[104:107]
buffer_load_dwordx4 v13, s[48:51], s22 offen offset:1024   lds
M v[104:107],a[168:171],a[48:51],v[104:107]
M v[100:103],a[168:171],a[40:43],v[100:103]
s_and_b32 s64, s42, 7
s_lshl_b32 s64, s64, 2
M v[100:103],a[172:175],a[44:47],v[100:103]
s_waitcnt lgkmcnt(4)
SA s64,s64,s20
M v[96:99],a[172:175],a[36:39],v[96:99]
s_mul_i32 s64, s64, 114688
v_bfe_u32 v28, v0, 2, 2
v_and_b32 v29, 3, v0
M v[96:99],a[168:171],a[32:35],v[96:99]
v_lshlrev_b32 v29, 7, v29
v_lshl_add_u32 v28, v28, 13, v29
M v[128:131],a[160:163],a[32:35],v[128:131]
R a[168:171],v5,51200
R a[172:175],v6,51200
M v[128:131],a[164:167],a[36:39],v[128:131]
T a[136:137],v2,16384
T a[138:139],v2,17408
M v[132:135],a[164:167],a[44:47],v[132:135]
buffer_load_dwordx4 v14, s[48:51], s22 offen offset:2048   lds
M v[132:135],a[160:163],a[40:43],v[132:135]
v_add_u32 v23, s64, v28
v_and_b32 v28, 48, v0
M v[136:139],a[160:163],a[48:51],v[136:139]
v_lshl_add_u32 v23, v28, 24, v23
M v[136:139],a[164:167],a[52:55],v[136:139]
M v[140:143],a[164:167],a[60:63],v[140:143]
M v[140:143],a[160:163],a[56:59],v[140:143]
s_nop 0
T a[140:141],v2,24576
T a[142:143],v2,25600
M v[144:147],a[160:163],a[64:67],v[144:147]
buffer_load_dwordx4 v15, s[48:51], s22 offen offset:3072   lds
M v[144:147],a[164:167],a[68:71],v[144:147]
SA s22,s22,1048576
M v[148:151],a[164:167],a[76:79],v[148:151]
M v[148:151],a[160:163],a[72:75],v[148:151]
M v[152:155],a[160:163],a[80:83],v[152:155]
M v[152:155],a[164:167],a[84:87],v[152:155]
s_waitcnt lgkmcnt(4)
M v[156:159],a[164:167],a[92:95],v[156:159]
SA m0,s23,0
T a[144:145],v3,16384
T a[146:147],v3,17408
M v[156:159],a[160:163],a[88:91],v[156:159]
buffer_load_dwordx4 v8, s[16:19], s21 offen offset:0   lds
M v[188:191],a[168:171],a[88:91],v[188:191]
R a[160:163],v5,53248
R a[164:167],v6,53248
M v[188:191],a[172:175],a[92:95],v[188:191]
M v[184:187],a[172:175],a[84:87],v[184:187]
M v[184:187],a[168:171],a[80:83],v[184:187]
M v[180:183],a[168:171],a[72:75],v[180:183]
M v[180:183],a[172:175],a[76:79],v[180:183]
s_nop 0
T a[148:149],v3,24576
T a[150:151],v3,25600
M v[176:179],a[172:175],a[68:71],v[176:179]
buffer_load_dwordx4 v9, s[16:19], s21 offen offset:1024   lds
M v[176:179],a[168:171],a[64:67],v[176:179]
M v[172:175],a[168:171],a[56:59],v[172:175]
M v[172:175],a[172:175],a[60:63],v[172:175]
M v[168:171],a[172:175],a[52:55],v[168:171]
M v[168:171],a[168:171],a[48:51],v[168:171]
M v[164:167],a[168:171],a[40:43],v[164:167]
s_nop 0
T a[152:153],v4,16384
T a[154:155],v4,17408
M v[164:167],a[172:175],a[44:47],v[164:167]
s_waitcnt lgkmcnt(4)
buffer_load_dwordx4 v10, s[16:19], s21 offen offset:2048   lds
M v[160:163],a[172:175],a[36:39],v[160:163]
M v[160:163],a[168:171],a[32:35],v[160:163]
M v[192:195],a[160:163],a[32:35],v[192:195]
R a[168:171],v5,55296
R a[172:175],v6,55296
M v[192:195],a[164:167],a[36:39],v[192:195]
M v[196:199],a[164:167],a[44:47],v[196:199]
M v[196:199],a[160:163],a[40:43],v[196:199]
s_nop 0
T a[156:157],v4,24576
T a[158:159],v4,25600
M v[200:203],a[160:163],a[48:51],v[200:203]
buffer_load_dwordx4 v11, s[16:19], s21 offen offset:3072   lds
M v[200:203],a[164:167],a[52:55],v[200:203]
SA s21,s21,128
M v[204:207],a[164:167],a[60:63],v[204:207]
M v[204:207],a[160:163],a[56:59],v[204:207]
M v[208:211],a[160:163],a[64:67],v[208:211]
M v[208:211],a[164:167],a[68:71],v[208:211]
M v[212:215],a[164:167],a[76:79],v[212:215]
M v[212:215],a[160:163],a[72:75],v[212:215]
M v[216:219],a[160:163],a[80:83],v[216:219]
M v[216:219],a[164:167],a[84:87],v[216:219]
s_waitcnt lgkmcnt(2)
M v[220:223],a[164:167],a[92:95],v[220:223]
s_waitcnt vmcnt(16) lgkmcnt(0)
M v[220:223],a[160:163],a[88:91],v[220:223]
s_barrier
M v[252:255],a[168:171],a[88:91],v[252:255]
R a[160:163],v5,0
R a[164:167],v6,0
M v[252:255],a[172:175],a[92:95],v[252:255]
buffer_load_dword a240, v23, s[52:55], 0 offen offset:0
M v[248:251],a[172:175],a[84:87],v[248:251]
v_add_u32 v23, 32768, v23
M v[248:251],a[168:171],a[80:83],v[248:251]
M v[244:247],a[168:171],a[72:75],v[244:247]
M v[244:247],a[172:175],a[76:79],v[244:247]
M v[240:243],a[172:175],a[68:71],v[240:243]
M v[240:243],a[168:171],a[64:67],v[240:243]
M v[236:239],a[168:171],a[56:59],v[236:239]
M v[236:239],a[172:175],a[60:63],v[236:239]
M v[232:235],a[172:175],a[52:55],v[232:235]
M v[232:235],a[168:171],a[48:51],v[232:235]
M v[228:231],a[168:171],a[40:43],v[228:231]
M v[228:231],a[172:175],a[44:47],v[228:231]
s_waitcnt lgkmcnt(0)
M v[224:227],a[172:175],a[36:39],v[224:227]
M v[224:227],a[168:171],a[32:35],v[224:227]
M a[0:3],a[160:163],a[96:99],a[0:3]
R a[168:171],v5,2048
R a[172:175],v6,2048
M a[0:3],a[164:167],a[100:103],a[0:3]
T a[32:33],v1,32768
T a[34:35],v1,33792
M a[4:7],a[164:167],a[108:111],a[4:7]
SA m0,s24,49152
M a[4:7],a[160:163],a[104:107],a[4:7]
buffer_load_dwordx4 v12, s[48:51], s22 offen offset:0   lds
M a[8:11],a[160:163],a[112:115],a[8:11]
M a[8:11],a[164:167],a[116:119],a[8:11]
M a[12:15],a[164:167],a[124:127],a[12:15]
s_nop 0
T a[36:37],v1,40960
T a[38:39],v1,41984
M a[12:15],a[160:163],a[120:123],a[12:15]
M a[16:19],a[160:163],a[128:131],a[16:19]
buffer_load_dwordx4 v13, s[48:51], s22 offen offset:1024   lds
M a[16:19],a[164:167],a[132:135],a[16:19]
M a[20:23],a[164:167],a[140:143],a[20:23]
M a[20:23],a[160:163],a[136:139],a[20:23]
s_nop 0
T a[40:41],v2,32768
T a[42:43],v2,33792
M a[24:27],a[160:163],a[144:147],a[24:27]
M a[24:27],a[164:167],a[148:151],a[24:27]
s_waitcnt lgkmcnt(6)
buffer_load_dwordx4 v14, s[48:51], s22 offen offset:2048   lds
M a[28:31],a[164:167],a[156:159],a[28:31]
M a[28:31],a[160:163],a[152:155],a[28:31]
M v[60:63],a[168:171],a[152:155],v[60:63]
R a[160:163],v5,4096
R a[164:167],v6,4096
M v[60:63],a[172:175],a[156:159],v[60:63]
T a[44:45],v2,40960
T a[46:47],v2,41984
M v[56:59],a[172:175],a[148:151],v[56:59]
buffer_load_dwordx4 v15, s[48:51], s22 offen offset:3072   lds
M v[56:59],a[168:171],a[144:147],v[56:59]
s_sub_u32 s22, s22, 1048448
M v[52:55],a[168:171],a[136:139],v[52:55]
M v[52:55],a[172:175],a[140:143],v[52:55]
s_nop 0
T a[48:49],v3,32768
T a[50:51],v3,33792
M v[48:51],a[172:175],a[132:135],v[48:51]
SA m0,s23,16384
M v[48:51],a[168:171],a[128:131],v[48:51]
buffer_load_dwordx4 v8, s[16:19], s21 offen offset:0   lds
M v[44:47],a[168:171],a[120:123],v[44:47]
M v[44:47],a[172:175],a[124:127],v[44:47]
M v[40:43],a[172:175],a[116:119],v[40:43]
s_nop 0
T a[52:53],v3,40960
T a[54:55],v3,41984
M v[40:43],a[168:171],a[112:115],v[40:43]
M v[36:39],a[168:171],a[104:107],v[36:39]
buffer_load_dwordx4 v9, s[16:19], s21 offen offset:1024   lds
M v[36:39],a[172:175],a[108:111],v[36:39]
s_waitcnt lgkmcnt(6)
M v[32:35],a[172:175],a[100:103],v[32:35]
M v[32:35],a[168:171],a[96:99],v[32:35]
s_nop 0
T a[56:57],v4,32768
T a[58:59],v4,33792
M v[64:67],a[160:163],a[96:99],v[64:67]
R a[168:171],v5,6144
R a[172:175],v6,6144
M v[64:67],a[164:167],a[100:103],v[64:67]
buffer_load_dwordx4 v10, s[16:19], s21 offen offset:2048   lds
M v[68:71],a[164:167],a[108:111],v[68:71]
M v[68:71],a[160:163],a[104:107],v[68:71]
M v[72:75],a[160:163],a[112:115],v[72:75]
s_nop 0
T a[60:61],v4,40960
T a[62:63],v4,41984
M v[72:75],a[164:167],a[116:119],v[72:75]
M v[76:79],a[164:167],a[124:127],v[76:79]
buffer_load_dwordx4 v11, s[16:19], s21 offen offset:3072   lds
M v[76:79],a[160:163],a[120:123],v[76:79]
SA s21,s21,524160
M v[80:83],a[160:163],a[128:131],v[80:83]
M v[80:83],a[164:167],a[132:135],v[80:83]
M v[84:87],a[164:167],a[140:143],v[84:87]
M v[84:87],a[160:163],a[136:139],v[84:87]
M v[88:91],a[160:163],a[144:147],v[88:91]
M v[88:91],a[164:167],a[148:151],v[88:91]
s_waitcnt lgkmcnt(2)
M v[92:95],a[164:167],a[156:159],v[92:95]
s_waitcnt vmcnt(17) lgkmcnt(0)
M v[92:95],a[160:163],a[152:155],v[92:95]
s_barrier
M v[124:127],a[168:171],a[152:155],v[124:127]
R a[160:163],v5,16384
R a[164:167],v6,16384
M v[124:127],a[172:175],a[156:159],v[124:127]
M v[120:123],a[172:175],a[148:151],v[120:123]
SA m0,s24,0
T a[64:65],v1,49152
T a[66:67],v1,50176
M v[120:123],a[168:171],a[144:147],v[120:123]
buffer_load_dwordx4 v12, s[48:51], s22 offen offset:0   lds
M v[116:119],a[168:171],a[136:139],v[116:119]
M v[116:119],a[172:175],a[140:143],v[116:119]
M v[112:115],a[172:175],a[132:135],v[112:115]
M v[112:115],a[168:171],a[128:131],v[112:115]
M v[108:111],a[168:171],a[120:123],v[108:111]
M v[108:111],a[172:175],a[124:127],v[108:111]
s_nop 0
T a[68:69],v1,57344
T a[70:71],v1,58368
M v[104:107],a[172:175],a[116:119],v[104:107]
buffer_load_dwordx4 v13, s[48:51], s22 offen offset:1024   lds
M v[104:107],a[168:171],a[112:115],v[104:107]
M v[100:103],a[168:171],a[104:107],v[100:103]
M v[100:103],a[172:175],a[108:111],v[100:103]
s_waitcnt lgkmcnt(4)
M v[96:99],a[172:175],a[100:103],v[96:99]
M v[96:99],a[168:171],a[96:99],v[96:99]
L_w_kv14:
s_cbranch_execz L_w_kv18
M v[128:131],a[160:163],a[96:99],v[128:131]
R a[168:171],v5,18432
R a[172:175],v6,18432
M v[128:131],a[164:167],a[100:103],v[128:131]
T a[72:73],v2,49152
T a[74:75],v2,50176
M v[132:135],a[164:167],a[108:111],v[132:135]
buffer_load_dwordx4 v14, s[48:51], s22 offen offset:2048   lds
M v[132:135],a[160:163],a[104:107],v[132:135]
M v[136:139],a[160:163],a[112:115],v[136:139]
M v[136:139],a[164:167],a[116:119],v[136:139]
M v[140:143],a[164:167],a[124:127],v[140:143]
M v[140:143],a[160:163],a[120:123],v[140:143]
s_nop 0
T a[76:77],v2,57344
T a[78:79],v2,58368
M v[144:147],a[160:163],a[128:131],v[144:147]
buffer_load_dwordx4 v15, s[48:51], s22 offen offset:3072   lds
M v[144:147],a[164:167],a[132:135],v[144:147]
SA s22,s22,1048576
M v[148:151],a[164:167],a[140:143],v[148:151]
M v[148:151],a[160:163],a[136:139],v[148:151]
M v[152:155],a[160:163],a[144:147],v[152:155]
M v[152:155],a[164:167],a[148:151],v[152:155]
s_waitcnt lgkmcnt(4)
M v[156:159],a[164:167],a[156:159],v[156:159]
SA m0,s23,32768
T a[80:81],v3,49152
T a[82:83],v3,50176
M v[156:159],a[160:163],a[152:155],v[156:159]
buffer_load_dwordx4 v8, s[16:19], s21 offen offset:0   lds
M v[188:191],a[168:171],a[152:155],v[188:191]
R a[160:163],v5,20480
R a[164:167],v6,20480
M v[188:191],a[172:175],a[156:159],v[188:191]
M v[184:187],a[172:175],a[148:151],v[184:187]
M v[184:187],a[168:171],a[144:147],v[184:187]
M v[180:183],a[168:171],a[136:139],v[180:183]
M v[180:183],a[172:175],a[140:143],v[180:183]
s_nop 0
T a[84:85],v3,57344
T a[86:87],v3,58368
M v[176:179],a[172:175],a[132:135],v[176:179]
buffer_load_dwordx4 v9, s[16:19], s21 offen offset:1024   lds
M v[176:179],a[168:171],a[128:131],v[176:179]
M v[172:175],a[168:171],a[120:123],v[172:175]
M v[172:175],a[172:175],a[124:127],v[172:175]
M v[168:171],a[172:175],a[116:119],v[168:171]
M v[168:171],a[168:171],a[112:115],v[168:171]
M v[164:167],a[168:171],a[104:107],v[164:167]
s_nop 0
T a[88:89],v4,49152
T a[90:91],v4,50176
M v[164:167],a[172:175],a[108:111],v[164:167]
s_waitcnt lgkmcnt(4)
buffer_load_dwordx4 v10, s[16:19], s21 offen offset:2048   lds
M v[160:163],a[172:175],a[100:103],v[160:163]
M v[160:163],a[168:171],a[96:99],v[160:163]
M v[192:195],a[160:163],a[96:99],v[192:195]
R a[168:171],v5,22528
R a[172:175],v6,22528
M v[192:195],a[164:167],a[100:103],v[192:195]
M v[196:199],a[164:167],a[108:111],v[196:199]
M v[196:199],a[160:163],a[104:107],v[196:199]
s_nop 0
T a[92:93],v4,57344
T a[94:95],v4,58368
M v[200:203],a[160:163],a[112:115],v[200:203]
buffer_load_dwordx4 v11, s[16:19], s21 offen offset:3072   lds
M v[200:203],a[164:167],a[116:119],v[200:203]
SA s21,s21,128
M v[204:207],a[164:167],a[124:127],v[204:207]
M v[204:207],a[160:163],a[120:123],v[204:207]
M v[208:211],a[160:163],a[128:131],v[208:211]
M v[208:211],a[164:167],a[132:135],v[208:211]
M v[212:215],a[164:167],a[140:143],v[212:215]
M v[212:215],a[160:163],a[136:139],v[212:215]
M v[216:219],a[160:163],a[144:147],v[216:219]
M v[216:219],a[164:167],a[148:151],v[216:219]
s_waitcnt lgkmcnt(2)
M v[220:223],a[164:167],a[156:159],v[220:223]
s_waitcnt vmcnt(17) lgkmcnt(0)
M v[220:223],a[160:163],a[152:155],v[220:223]
s_barrier
M v[252:255],a[168:171],a[152:155],v[252:255]
R a[160:163],v5,32768
R a[164:167],v6,32768
M v[252:255],a[172:175],a[156:159],v[252:255]
buffer_load_dword a240, v23, s[52:55], 0 offen offset:0
M v[248:251],a[172:175],a[148:151],v[248:251]
v_add_u32 v23, 32768, v23
M v[248:251],a[168:171],a[144:147],v[248:251]
M v[244:247],a[168:171],a[136:139],v[244:247]
M v[244:247],a[172:175],a[140:143],v[244:247]
M v[240:243],a[172:175],a[132:135],v[240:243]
M v[240:243],a[168:171],a[128:131],v[240:243]
M v[236:239],a[168:171],a[120:123],v[236:239]
M v[236:239],a[172:175],a[124:127],v[236:239]
M v[232:235],a[172:175],a[116:119],v[232:235]
M v[232:235],a[168:171],a[112:115],v[232:235]
M v[228:231],a[168:171],a[104:107],v[228:231]
M v[228:231],a[172:175],a[108:111],v[228:231]
s_waitcnt lgkmcnt(0)
M v[224:227],a[172:175],a[100:103],v[224:227]
M v[224:227],a[168:171],a[96:99],v[224:227]
M a[0:3],a[160:163],a[32:35],a[0:3]
R a[168:171],v5,34816
R a[172:175],v6,34816
M a[0:3],a[164:167],a[36:39],a[0:3]
T a[96:97],v1,0
T a[98:99],v1,1024
M a[4:7],a[164:167],a[44:47],a[4:7]
SA m0,s24,16384
M a[4:7],a[160:163],a[40:43],a[4:7]
buffer_load_dwordx4 v12, s[48:51], s22 offen offset:0   lds
M a[8:11],a[160:163],a[48:51],a[8:11]
M a[8:11],a[164:167],a[52:55],a[8:11]
M a[12:15],a[164:167],a[60:63],a[12:15]
s_nop 0
T a[100:101],v1,8192
T a[102:103],v1,9216
M a[12:15],a[160:163],a[56:59],a[12:15]
M a[16:19],a[160:163],a[64:67],a[16:19]
buffer_load_dwordx4 v13, s[48:51], s22 offen offset:1024   lds
M a[16:19],a[164:167],a[68:71],a[16:19]
M a[20:23],a[164:167],a[76:79],a[20:23]
M a[20:23],a[160:163],a[72:75],a[20:23]
s_nop 0
T a[104:105],v2,0
T a[106:107],v2,1024
M a[24:27],a[160:163],a[80:83],a[24:27]
M a[24:27],a[164:167],a[84:87],a[24:27]
s_waitcnt lgkmcnt(6)
buffer_load_dwordx4 v14, s[48:51], s22 offen offset:2048   lds
M a[28:31],a[164:167],a[92:95],a[28:31]
M a[28:31],a[160:163],a[88:91],a[28:31]
M v[60:63],a[168:171],a[88:91],v[60:63]
R a[160:163],v5,36864
R a[164:167],v6,36864
M v[60:63],a[172:175],a[92:95],v[60:63]
T a[108:109],v2,8192
T a[110:111],v2,9216
M v[56:59],a[172:175],a[84:87],v[56:59]
buffer_load_dwordx4 v15, s[48:51], s22 offen offset:3072   lds
M v[56:59],a[168:171],a[80:83],v[56:59]
s_sub_u32 s22, s22, 1048448
M v[52:55],a[168:171],a[72:75],v[52:55]
M v[52:55],a[172:175],a[76:79],v[52:55]
s_nop 0
T a[112:113],v3,0
T a[114:115],v3,1024
M v[48:51],a[172:175],a[68:71],v[48:51]
SA m0,s23,49152
M v[48:51],a[168:171],a[64:67],v[48:51]
buffer_load_dwordx4 v8, s[16:19], s21 offen offset:0   lds
M v[44:47],a[168:171],a[56:59],v[44:47]
M v[44:47],a[172:175],a[60:63],v[44:47]
M v[40:43],a[172:175],a[52:55],v[40:43]
s_nop 0
T a[116:117],v3,8192
T a[118:119],v3,9216
M v[40:43],a[168:171],a[48:51],v[40:43]
M v[36:39],a[168:171],a[40:43],v[36:39]
buffer_load_dwordx4 v9, s[16:19], s21 offen offset:1024   lds
M v[36:39],a[172:175],a[44:47],v[36:39]
s_waitcnt lgkmcnt(6)
M v[32:35],a[172:175],a[36:39],v[32:35]
M v[32:35],a[168:171],a[32:35],v[32:35]
s_nop 0
T a[120:121],v4,0
T a[122:123],v4,1024
M v[64:67],a[160:163],a[32:35],v[64:67]
R a[168:171],v5,38912
R a[172:175],v6,38912
M v[64:67],a[164:167],a[36:39],v[64:67]
buffer_load_dwordx4 v10, s[16:19], s21 offen offset:2048   lds
M v[68:71],a[164:167],a[44:47],v[68:71]
M v[68:71],a[160:163],a[40:43],v[68:71]
M v[72:75],a[160:163],a[48:51],v[72:75]
s_nop 0
T a[124:125],v4,8192
T a[126:127],v4,9216
M v[72:75],a[164:167],a[52:55],v[72:75]
M v[76:79],a[164:167],a[60:63],v[76:79]
buffer_load_dwordx4 v11, s[16:19], s21 offen offset:3072   lds
M v[76:79],a[160:163],a[56:59],v[76:79]
SA s21,s21,524160
M v[80:83],a[160:163],a[64:67],v[80:83]
M v[80:83],a[164:167],a[68:71],v[80:83]
M v[84:87],a[164:167],a[76:79],v[84:87]
M v[84:87],a[160:163],a[72:75],v[84:87]
M v[88:91],a[160:163],a[80:83],v[88:91]
M v[88:91],a[164:167],a[84:87],v[88:91]
s_waitcnt lgkmcnt(2)
M v[92:95],a[164:167],a[92:95],v[92:95]
s_waitcnt vmcnt(17) lgkmcnt(0)
M v[92:95],a[160:163],a[88:91],v[92:95]
s_barrier
M v[124:127],a[168:171],a[88:91],v[124:127]
R a[160:163],v5,49152
R a[164:167],v6,49152
M v[124:127],a[172:175],a[92:95],v[124:127]
M v[120:123],a[172:175],a[84:87],v[120:123]
SA m0,s24,32768
T a[128:129],v1,16384
T a[130:131],v1,17408
M v[120:123],a[168:171],a[80:83],v[120:123]
buffer_load_dwordx4 v12, s[48:51], s22 offen offset:0   lds
M v[116:119],a[168:171],a[72:75],v[116:119]
M v[116:119],a[172:175],a[76:79],v[116:119]
M v[112:115],a[172:175],a[68:71],v[112:115]
M v[112:115],a[168:171],a[64:67],v[112:115]
M v[108:111],a[168:171],a[56:59],v[108:111]
M v[108:111],a[172:175],a[60:63],v[108:111]
s_nop 0
T a[132:133],v1,24576
T a[134:135],v1,25600
M v[104:107],a[172:175],a[52:55],v[104:107]
buffer_load_dwordx4 v13, s[48:51], s22 offen offset:1024   lds
M v[104:107],a[168:171],a[48:51],v[104:107]
M v[100:103],a[168:171],a[40:43],v[100:103]
M v[100:103],a[172:175],a[44:47],v[100:103]
s_waitcnt lgkmcnt(4)
M v[96:99],a[172:175],a[36:39],v[96:99]
M v[96:99],a[168:171],a[32:35],v[96:99]
M v[128:131],a[160:163],a[32:35],v[128:131]
R a[168:171],v5,51200
R a[172:175],v6,51200
M v[128:131],a[164:167],a[36:39],v[128:131]
T a[136:137],v2,16384
T a[138:139],v2,17408
M v[132:135],a[164:167],a[44:47],v[132:135]
buffer_load_dwordx4 v14, s[48:51], s22 offen offset:2048   lds
M v[132:135],a[160:163],a[40:43],v[132:135]
M v[136:139],a[160:163],a[48:51],v[136:139]
M v[136:139],a[164:167],a[52:55],v[136:139]
M v[140:143],a[164:167],a[60:63],v[140:143]
M v[140:143],a[160:163],a[56:59],v[140:143]
s_nop 0
T a[140:141],v2,24576
T a[142:143],v2,25600
M v[144:147],a[160:163],a[64:67],v[144:147]
buffer_load_dwordx4 v15, s[48:51], s22 offen offset:3072   lds
M v[144:147],a[164:167],a[68:71],v[144:147]
SA s22,s22,1048576
M v[148:151],a[164:167],a[76:79],v[148:151]
M v[148:151],a[160:163],a[72:75],v[148:151]
M v[152:155],a[160:163],a[80:83],v[152:155]
M v[152:155],a[164:167],a[84:87],v[152:155]
s_waitcnt lgkmcnt(4)
M v[156:159],a[164:167],a[92:95],v[156:159]
SA m0,s23,0
T a[144:145],v3,16384
T a[146:147],v3,17408
M v[156:159],a[160:163],a[88:91],v[156:159]
buffer_load_dwordx4 v8, s[16:19], s21 offen offset:0   lds
M v[188:191],a[168:171],a[88:91],v[188:191]
R a[160:163],v5,53248
R a[164:167],v6,53248
M v[188:191],a[172:175],a[92:95],v[188:191]
M v[184:187],a[172:175],a[84:87],v[184:187]
M v[184:187],a[168:171],a[80:83],v[184:187]
M v[180:183],a[168:171],a[72:75],v[180:183]
M v[180:183],a[172:175],a[76:79],v[180:183]
s_nop 0
T a[148:149],v3,24576
T a[150:151],v3,25600
M v[176:179],a[172:175],a[68:71],v[176:179]
buffer_load_dwordx4 v9, s[16:19], s21 offen offset:1024   lds
M v[176:179],a[168:171],a[64:67],v[176:179]
M v[172:175],a[168:171],a[56:59],v[172:175]
M v[172:175],a[172:175],a[60:63],v[172:175]
M v[168:171],a[172:175],a[52:55],v[168:171]
M v[168:171],a[168:171],a[48:51],v[168:171]
M v[164:167],a[168:171],a[40:43],v[164:167]
s_nop 0
T a[152:153],v4,16384
T a[154:155],v4,17408
M v[164:167],a[172:175],a[44:47],v[164:167]
s_waitcnt lgkmcnt(4)
buffer_load_dwordx4 v10, s[16:19], s21 offen offset:2048   lds
M v[160:163],a[172:175],a[36:39],v[160:163]
M v[160:163],a[168:171],a[32:35],v[160:163]
M v[192:195],a[160:163],a[32:35],v[192:195]
R a[168:171],v5,55296
R a[172:175],v6,55296
M v[192:195],a[164:167],a[36:39],v[192:195]
M v[196:199],a[164:167],a[44:47],v[196:199]
M v[196:199],a[160:163],a[40:43],v[196:199]
s_nop 0
T a[156:157],v4,24576
T a[158:159],v4,25600
M v[200:203],a[160:163],a[48:51],v[200:203]
buffer_load_dwordx4 v11, s[16:19], s21 offen offset:3072   lds
M v[200:203],a[164:167],a[52:55],v[200:203]
SA s21,s21,128
M v[204:207],a[164:167],a[60:63],v[204:207]
M v[204:207],a[160:163],a[56:59],v[204:207]
M v[208:211],a[160:163],a[64:67],v[208:211]
M v[208:211],a[164:167],a[68:71],v[208:211]
M v[212:215],a[164:167],a[76:79],v[212:215]
M v[212:215],a[160:163],a[72:75],v[212:215]
M v[216:219],a[160:163],a[80:83],v[216:219]
M v[216:219],a[164:167],a[84:87],v[216:219]
s_waitcnt lgkmcnt(2)
M v[220:223],a[164:167],a[92:95],v[220:223]
s_waitcnt vmcnt(17) lgkmcnt(0)
M v[220:223],a[160:163],a[88:91],v[220:223]
s_barrier
M v[252:255],a[168:171],a[88:91],v[252:255]
R a[160:163],v5,0
R a[164:167],v6,0
M v[252:255],a[172:175],a[92:95],v[252:255]
buffer_load_dword a240, v23, s[52:55], 0 offen offset:0
M v[248:251],a[172:175],a[84:87],v[248:251]
v_add_u32 v23, 16384, v23
M v[248:251],a[168:171],a[80:83],v[248:251]
M v[244:247],a[168:171],a[72:75],v[244:247]
M v[244:247],a[172:175],a[76:79],v[244:247]
M v[240:243],a[172:175],a[68:71],v[240:243]
M v[240:243],a[168:171],a[64:67],v[240:243]
M v[236:239],a[168:171],a[56:59],v[236:239]
M v[236:239],a[172:175],a[60:63],v[236:239]
M v[232:235],a[172:175],a[52:55],v[232:235]
M v[232:235],a[168:171],a[48:51],v[232:235]
M v[228:231],a[168:171],a[40:43],v[228:231]
M v[228:231],a[172:175],a[44:47],v[228:231]
s_waitcnt lgkmcnt(0)
M v[224:227],a[172:175],a[36:39],v[224:227]
M v[224:227],a[168:171],a[32:35],v[224:227]
M a[0:3],a[160:163],a[96:99],a[0:3]
R a[168:171],v5,2048
R a[172:175],v6,2048
M a[0:3],a[164:167],a[100:103],a[0:3]
T a[32:33],v1,32768
T a[34:35],v1,33792
M a[4:7],a[164:167],a[108:111],a[4:7]
SA m0,s24,49152
M a[4:7],a[160:163],a[104:107],a[4:7]
buffer_load_dwordx4 v12, s[48:51], s22 offen offset:0   lds
M a[8:11],a[160:163],a[112:115],a[8:11]
M a[8:11],a[164:167],a[116:119],a[8:11]
M a[12:15],a[164:167],a[124:127],a[12:15]
s_nop 0
T a[36:37],v1,40960
T a[38:39],v1,41984
M a[12:15],a[160:163],a[120:123],a[12:15]
M a[16:19],a[160:163],a[128:131],a[16:19]
buffer_load_dwordx4 v13, s[48:51], s22 offen offset:1024   lds
M a[16:19],a[164:167],a[132:135],a[16:19]
M a[20:23],a[164:167],a[140:143],a[20:23]
M a[20:23],a[160:163],a[136:139],a[20:23]
s_nop 0
T a[40:41],v2,32768
T a[42:43],v2,33792
M a[24:27],a[160:163],a[144:147],a[24:27]
M a[24:27],a[164:167],a[148:151],a[24:27]
s_waitcnt lgkmcnt(6)
buffer_load_dwordx4 v14, s[48:51], s22 offen offset:2048   lds
M a[28:31],a[164:167],a[156:159],a[28:31]
M a[28:31],a[160:163],a[152:155],a[28:31]
M v[60:63],a[168:171],a[152:155],v[60:63]
R a[160:163],v5,4096
R a[164:167],v6,4096
M v[60:63],a[172:175],a[156:159],v[60:63]
T a[44:45],v2,40960
T a[46:47],v2,41984
M v[56:59],a[172:175],a[148:151],v[56:59]
buffer_load_dwordx4 v15, s[48:51], s22 offen offset:3072   lds
M v[56:59],a[168:171],a[144:147],v[56:59]
s_sub_u32 s22, s22, 1048448
M v[52:55],a[168:171],a[136:139],v[52:55]
M v[52:55],a[172:175],a[140:143],v[52:55]
s_nop 0
T a[48:49],v3,32768
T a[50:51],v3,33792
M v[48:51],a[172:175],a[132:135],v[48:51]
SA m0,s23,16384
M v[48:51],a[168:171],a[128:131],v[48:51]
buffer_load_dwordx4 v8, s[16:19], s21 offen offset:0   lds
M v[44:47],a[168:171],a[120:123],v[44:47]
M v[44:47],a[172:175],a[124:127],v[44:47]
M v[40:43],a[172:175],a[116:119],v[40:43]
s_nop 0
T a[52:53],v3,40960
T a[54:55],v3,41984
M v[40:43],a[168:171],a[112:115],v[40:43]
M v[36:39],a[168:171],a[104:107],v[36:39]
buffer_load_dwordx4 v9, s[16:19], s21 offen offset:1024   lds
M v[36:39],a[172:175],a[108:111],v[36:39]
s_waitcnt lgkmcnt(6)
M v[32:35],a[172:175],a[100:103],v[32:35]
M v[32:35],a[168:171],a[96:99],v[32:35]
s_nop 0
T a[56:57],v4,32768
T a[58:59],v4,33792
M v[64:67],a[160:163],a[96:99],v[64:67]
R a[168:171],v5,6144
R a[172:175],v6,6144
M v[64:67],a[164:167],a[100:103],v[64:67]
buffer_load_dwordx4 v10, s[16:19], s21 offen offset:2048   lds
M v[68:71],a[164:167],a[108:111],v[68:71]
M v[68:71],a[160:163],a[104:107],v[68:71]
M v[72:75],a[160:163],a[112:115],v[72:75]
s_nop 0
T a[60:61],v4,40960
T a[62:63],v4,41984
M v[72:75],a[164:167],a[116:119],v[72:75]
M v[76:79],a[164:167],a[124:127],v[76:79]
buffer_load_dwordx4 v11, s[16:19], s21 offen offset:3072   lds
M v[76:79],a[160:163],a[120:123],v[76:79]
SA s21,s21,524160
M v[80:83],a[160:163],a[128:131],v[80:83]
M v[80:83],a[164:167],a[132:135],v[80:83]
M v[84:87],a[164:167],a[140:143],v[84:87]
M v[84:87],a[160:163],a[136:139],v[84:87]
M v[88:91],a[160:163],a[144:147],v[88:91]
M v[88:91],a[164:167],a[148:151],v[88:91]
s_waitcnt lgkmcnt(2)
M v[92:95],a[164:167],a[156:159],v[92:95]
s_waitcnt vmcnt(17) lgkmcnt(0)
M v[92:95],a[160:163],a[152:155],v[92:95]
s_barrier
M v[124:127],a[168:171],a[152:155],v[124:127]
R a[160:163],v5,16384
R a[164:167],v6,16384
M v[124:127],a[172:175],a[156:159],v[124:127]
M v[120:123],a[172:175],a[148:151],v[120:123]
SA m0,s24,0
T a[64:65],v1,49152
T a[66:67],v1,50176
M v[120:123],a[168:171],a[144:147],v[120:123]
buffer_load_dwordx4 v12, s[48:51], s22 offen offset:0   lds
M v[116:119],a[168:171],a[136:139],v[116:119]
M v[116:119],a[172:175],a[140:143],v[116:119]
M v[112:115],a[172:175],a[132:135],v[112:115]
M v[112:115],a[168:171],a[128:131],v[112:115]
M v[108:111],a[168:171],a[120:123],v[108:111]
M v[108:111],a[172:175],a[124:127],v[108:111]
s_nop 0
T a[68:69],v1,57344
T a[70:71],v1,58368
M v[104:107],a[172:175],a[116:119],v[104:107]
buffer_load_dwordx4 v13, s[48:51], s22 offen offset:1024   lds
M v[104:107],a[168:171],a[112:115],v[104:107]
M v[100:103],a[168:171],a[104:107],v[100:103]
M v[100:103],a[172:175],a[108:111],v[100:103]
s_waitcnt lgkmcnt(4)
M v[96:99],a[172:175],a[100:103],v[96:99]
M v[96:99],a[168:171],a[96:99],v[96:99]
M v[128:131],a[160:163],a[96:99],v[128:131]
R a[168:171],v5,18432
R a[172:175],v6,18432
M v[128:131],a[164:167],a[100:103],v[128:131]
T a[72:73],v2,49152
T a[74:75],v2,50176
M v[132:135],a[164:167],a[108:111],v[132:135]
buffer_load_dwordx4 v14, s[48:51], s22 offen offset:2048   lds
M v[132:135],a[160:163],a[104:107],v[132:135]
M v[136:139],a[160:163],a[112:115],v[136:139]
M v[136:139],a[164:167],a[116:119],v[136:139]
M v[140:143],a[164:167],a[124:127],v[140:143]
M v[140:143],a[160:163],a[120:123],v[140:143]
s_nop 0
T a[76:77],v2,57344
T a[78:79],v2,58368
M v[144:147],a[160:163],a[128:131],v[144:147]
buffer_load_dwordx4 v15, s[48:51], s22 offen offset:3072   lds
M v[144:147],a[164:167],a[132:135],v[144:147]
SA s22,s22,1048576
M v[148:151],a[164:167],a[140:143],v[148:151]
M v[148:151],a[160:163],a[136:139],v[148:151]
M v[152:155],a[160:163],a[144:147],v[152:155]
M v[152:155],a[164:167],a[148:151],v[152:155]
s_waitcnt lgkmcnt(4)
M v[156:159],a[164:167],a[156:159],v[156:159]
SA m0,s23,32768
T a[80:81],v3,49152
T a[82:83],v3,50176
M v[156:159],a[160:163],a[152:155],v[156:159]
buffer_load_dwordx4 v8, s[16:19], s21 offen offset:0   lds
M v[188:191],a[168:171],a[152:155],v[188:191]
R a[160:163],v5,20480
R a[164:167],v6,20480
M v[188:191],a[172:175],a[156:159],v[188:191]
M v[184:187],a[172:175],a[148:151],v[184:187]
M v[184:187],a[168:171],a[144:147],v[184:187]
M v[180:183],a[168:171],a[136:139],v[180:183]
M v[180:183],a[172:175],a[140:143],v[180:183]
s_nop 0
T a[84:85],v3,57344
T a[86:87],v3,58368
M v[176:179],a[172:175],a[132:135],v[176:179]
buffer_load_dwordx4 v9, s[16:19], s21 offen offset:1024   lds
M v[176:179],a[168:171],a[128:131],v[176:179]
M v[172:175],a[168:171],a[120:123],v[172:175]
M v[172:175],a[172:175],a[124:127],v[172:175]
M v[168:171],a[172:175],a[116:119],v[168:171]
M v[168:171],a[168:171],a[112:115],v[168:171]
M v[164:167],a[168:171],a[104:107],v[164:167]
s_nop 0
T a[88:89],v4,49152
T a[90:91],v4,50176
M v[164:167],a[172:175],a[108:111],v[164:167]
s_waitcnt lgkmcnt(4)
buffer_load_dwordx4 v10, s[16:19], s21 offen offset:2048   lds
M v[160:163],a[172:175],a[100:103],v[160:163]
M v[160:163],a[168:171],a[96:99],v[160:163]
M v[192:195],a[160:163],a[96:99],v[192:195]
R a[168:171],v5,22528
R a[172:175],v6,22528
M v[192:195],a[164:167],a[100:103],v[192:195]
M v[196:199],a[164:167],a[108:111],v[196:199]
M v[196:199],a[160:163],a[104:107],v[196:199]
s_nop 0
T a[92:93],v4,57344
T a[94:95],v4,58368
M v[200:203],a[160:163],a[112:115],v[200:203]
buffer_load_dwordx4 v11, s[16:19], s21 offen offset:3072   lds
M v[200:203],a[164:167],a[116:119],v[200:203]
SA s21,s21,128
M v[204:207],a[164:167],a[124:127],v[204:207]
M v[204:207],a[160:163],a[120:123],v[204:207]
M v[208:211],a[160:163],a[128:131],v[208:211]
M v[208:211],a[164:167],a[132:135],v[208:211]
M v[212:215],a[164:167],a[140:143],v[212:215]
M v[212:215],a[160:163],a[136:139],v[212:215]
M v[216:219],a[160:163],a[144:147],v[216:219]
M v[216:219],a[164:167],a[148:151],v[216:219]
s_waitcnt lgkmcnt(2)
M v[220:223],a[164:167],a[156:159],v[220:223]
s_waitcnt vmcnt(17) lgkmcnt(0)
M v[220:223],a[160:163],a[152:155],v[220:223]
s_barrier
M v[252:255],a[168:171],a[152:155],v[252:255]
R a[160:163],v5,32768
R a[164:167],v6,32768
M v[252:255],a[172:175],a[156:159],v[252:255]
buffer_load_dword a240, v23, s[52:55], 0 offen offset:0
M v[248:251],a[172:175],a[148:151],v[248:251]
L_w_kv15:
s_cbranch_execz L_wd2
v_add_u32 v23, 16384, v23
M v[248:251],a[168:171],a[144:147],v[248:251]
M v[244:247],a[168:171],a[136:139],v[244:247]
M v[244:247],a[172:175],a[140:143],v[244:247]
M v[240:243],a[172:175],a[132:135],v[240:243]
M v[240:243],a[168:171],a[128:131],v[240:243]
M v[236:239],a[168:171],a[120:123],v[236:239]
M v[236:239],a[172:175],a[124:127],v[236:239]
M v[232:235],a[172:175],a[116:119],v[232:235]
M v[232:235],a[168:171],a[112:115],v[232:235]
M v[228:231],a[168:171],a[104:107],v[228:231]
M v[228:231],a[172:175],a[108:111],v[228:231]
s_waitcnt lgkmcnt(0)
M v[224:227],a[172:175],a[100:103],v[224:227]
M v[224:227],a[168:171],a[96:99],v[224:227]
M a[0:3],a[160:163],a[32:35],a[0:3]
R a[168:171],v5,34816
R a[172:175],v6,34816
M a[0:3],a[164:167],a[36:39],a[0:3]
T a[96:97],v1,0
T a[98:99],v1,1024
M a[4:7],a[164:167],a[44:47],a[4:7]
SA m0,s24,16384
M a[4:7],a[160:163],a[40:43],a[4:7]
buffer_load_dwordx4 v12, s[48:51], s22 offen offset:0   lds
M a[8:11],a[160:163],a[48:51],a[8:11]
M a[8:11],a[164:167],a[52:55],a[8:11]
M a[12:15],a[164:167],a[60:63],a[12:15]
s_nop 0
T a[100:101],v1,8192
T a[102:103],v1,9216
M a[12:15],a[160:163],a[56:59],a[12:15]
M a[16:19],a[160:163],a[64:67],a[16:19]
buffer_load_dwordx4 v13, s[48:51], s22 offen offset:1024   lds
M a[16:19],a[164:167],a[68:71],a[16:19]
M a[20:23],a[164:167],a[76:79],a[20:23]
M a[20:23],a[160:163],a[72:75],a[20:23]
s_nop 0
T a[104:105],v2,0
T a[106:107],v2,1024
M a[24:27],a[160:163],a[80:83],a[24:27]
M a[24:27],a[164:167],a[84:87],a[24:27]
s_waitcnt lgkmcnt(6)
buffer_load_dwordx4 v14, s[48:51], s22 offen offset:2048   lds
M a[28:31],a[164:167],a[92:95],a[28:31]
M a[28:31],a[160:163],a[88:91],a[28:31]
M v[60:63],a[168:171],a[88:91],v[60:63]
R a[160:163],v5,36864
R a[164:167],v6,36864
M v[60:63],a[172:175],a[92:95],v[60:63]
T a[108:109],v2,8192
T a[110:111],v2,9216
M v[56:59],a[172:175],a[84:87],v[56:59]
buffer_load_dwordx4 v15, s[48:51], s22 offen offset:3072   lds
M v[56:59],a[168:171],a[80:83],v[56:59]
s_sub_u32 s22, s22, 1048448
M v[52:55],a[168:171],a[72:75],v[52:55]
M v[52:55],a[172:175],a[76:79],v[52:55]
s_nop 0
T a[112:113],v3,0
T a[114:115],v3,1024
M v[48:51],a[172:175],a[68:71],v[48:51]
SA m0,s23,49152
M v[48:51],a[168:171],a[64:67],v[48:51]
buffer_load_dwordx4 v8, s[16:19], s21 offen offset:0   lds
M v[44:47],a[168:171],a[56:59],v[44:47]
M v[44:47],a[172:175],a[60:63],v[44:47]
M v[40:43],a[172:175],a[52:55],v[40:43]
s_nop 0
T a[116:117],v3,8192
T a[118:119],v3,9216
M v[40:43],a[168:171],a[48:51],v[40:43]
M v[36:39],a[168:171],a[40:43],v[36:39]
buffer_load_dwordx4 v9, s[16:19], s21 offen offset:1024   lds
M v[36:39],a[172:175],a[44:47],v[36:39]
s_waitcnt lgkmcnt(6)
M v[32:35],a[172:175],a[36:39],v[32:35]
M v[32:35],a[168:171],a[32:35],v[32:35]
s_nop 0
T a[120:121],v4,0
T a[122:123],v4,1024
M v[64:67],a[160:163],a[32:35],v[64:67]
R a[168:171],v5,38912
R a[172:175],v6,38912
M v[64:67],a[164:167],a[36:39],v[64:67]
buffer_load_dwordx4 v10, s[16:19], s21 offen offset:2048   lds
M v[68:71],a[164:167],a[44:47],v[68:71]
M v[68:71],a[160:163],a[40:43],v[68:71]
M v[72:75],a[160:163],a[48:51],v[72:75]
s_nop 0
T a[124:125],v4,8192
T a[126:127],v4,9216
M v[72:75],a[164:167],a[52:55],v[72:75]
M v[76:79],a[164:167],a[60:63],v[76:79]
buffer_load_dwordx4 v11, s[16:19], s21 offen offset:3072   lds
M v[76:79],a[160:163],a[56:59],v[76:79]
SA s21,s21,524160
M v[80:83],a[160:163],a[64:67],v[80:83]
M v[80:83],a[164:167],a[68:71],v[80:83]
M v[84:87],a[164:167],a[76:79],v[84:87]
M v[84:87],a[160:163],a[72:75],v[84:87]
M v[88:91],a[160:163],a[80:83],v[88:91]
M v[88:91],a[164:167],a[84:87],v[88:91]
s_waitcnt lgkmcnt(2)
M v[92:95],a[164:167],a[92:95],v[92:95]
s_waitcnt vmcnt(17) lgkmcnt(0)
M v[92:95],a[160:163],a[88:91],v[92:95]
s_barrier
M v[124:127],a[168:171],a[88:91],v[124:127]
R a[160:163],v5,49152
R a[164:167],v6,49152
M v[124:127],a[172:175],a[92:95],v[124:127]
M v[120:123],a[172:175],a[84:87],v[120:123]
SA m0,s24,32768
T a[128:129],v1,16384
T a[130:131],v1,17408
M v[120:123],a[168:171],a[80:83],v[120:123]
buffer_load_dwordx4 v12, s[48:51], s22 offen offset:0   lds
M v[116:119],a[168:171],a[72:75],v[116:119]
M v[116:119],a[172:175],a[76:79],v[116:119]
M v[112:115],a[172:175],a[68:71],v[112:115]
M v[112:115],a[168:171],a[64:67],v[112:115]
M v[108:111],a[168:171],a[56:59],v[108:111]
M v[108:111],a[172:175],a[60:63],v[108:111]
s_nop 0
T a[132:133],v1,24576
T a[134:135],v1,25600
M v[104:107],a[172:175],a[52:55],v[104:107]
buffer_load_dwordx4 v13, s[48:51], s22 offen offset:1024   lds
M v[104:107],a[168:171],a[48:51],v[104:107]
M v[100:103],a[168:171],a[40:43],v[100:103]
M v[100:103],a[172:175],a[44:47],v[100:103]
s_waitcnt lgkmcnt(4)
M v[96:99],a[172:175],a[36:39],v[96:99]
M v[96:99],a[168:171],a[32:35],v[96:99]
M v[128:131],a[160:163],a[32:35],v[128:131]
R a[168:171],v5,51200
R a[172:175],v6,51200
M v[128:131],a[164:167],a[36:39],v[128:131]
T a[136:137],v2,16384
T a[138:139],v2,17408
M v[132:135],a[164:167],a[44:47],v[132:135]
buffer_load_dwordx4 v14, s[48:51], s22 offen offset:2048   lds
M v[132:135],a[160:163],a[40:43],v[132:135]
M v[136:139],a[160:163],a[48:51],v[136:139]
M v[136:139],a[164:167],a[52:55],v[136:139]
M v[140:143],a[164:167],a[60:63],v[140:143]
M v[140:143],a[160:163],a[56:59],v[140:143]
s_nop 0
T a[140:141],v2,24576
T a[142:143],v2,25600
M v[144:147],a[160:163],a[64:67],v[144:147]
buffer_load_dwordx4 v15, s[48:51], s22 offen offset:3072   lds
M v[144:147],a[164:167],a[68:71],v[144:147]
SA s22,s22,1048576
M v[148:151],a[164:167],a[76:79],v[148:151]
M v[148:151],a[160:163],a[72:75],v[148:151]
M v[152:155],a[160:163],a[80:83],v[152:155]
M v[152:155],a[164:167],a[84:87],v[152:155]
s_waitcnt lgkmcnt(4)
M v[156:159],a[164:167],a[92:95],v[156:159]
SA m0,s23,0
T a[144:145],v3,16384
T a[146:147],v3,17408
M v[156:159],a[160:163],a[88:91],v[156:159]
buffer_load_dwordx4 v8, s[16:19], s21 offen offset:0   lds
M v[188:191],a[168:171],a[88:91],v[188:191]
R a[160:163],v5,53248
R a[164:167],v6,53248
M v[188:191],a[172:175],a[92:95],v[188:191]
M v[184:187],a[172:175],a[84:87],v[184:187]
M v[184:187],a[168:171],a[80:83],v[184:187]
M v[180:183],a[168:171],a[72:75],v[180:183]
M v[180:183],a[172:175],a[76:79],v[180:183]
s_nop 0
T a[148:149],v3,24576
T a[150:151],v3,25600
M v[176:179],a[172:175],a[68:71],v[176:179]
buffer_load_dwordx4 v9, s[16:19], s21 offen offset:1024   lds
M v[176:179],a[168:171],a[64:67],v[176:179]
M v[172:175],a[168:171],a[56:59],v[172:175]
M v[172:175],a[172:175],a[60:63],v[172:175]
M v[168:171],a[172:175],a[52:55],v[168:171]
M v[168:171],a[168:171],a[48:51],v[168:171]
M v[164:167],a[168:171],a[40:43],v[164:167]
s_nop 0
T a[152:153],v4,16384
T a[154:155],v4,17408
M v[164:167],a[172:175],a[44:47],v[164:167]
s_waitcnt lgkmcnt(4)
buffer_load_dwordx4 v10, s[16:19], s21 offen offset:2048   lds
M v[160:163],a[172:175],a[36:39],v[160:163]
M v[160:163],a[168:171],a[32:35],v[160:163]
M v[192:195],a[160:163],a[32:35],v[192:195]
R a[168:171],v5,55296
R a[172:175],v6,55296
M v[192:195],a[164:167],a[36:39],v[192:195]
M v[196:199],a[164:167],a[44:47],v[196:199]
M v[196:199],a[160:163],a[40:43],v[196:199]
s_nop 0
T a[156:157],v4,24576
T a[158:159],v4,25600
M v[200:203],a[160:163],a[48:51],v[200:203]
buffer_load_dwordx4 v11, s[16:19], s21 offen offset:3072   lds
M v[200:203],a[164:167],a[52:55],v[200:203]
SA s21,s21,128
M v[204:207],a[164:167],a[60:63],v[204:207]
M v[204:207],a[160:163],a[56:59],v[204:207]
M v[208:211],a[160:163],a[64:67],v[208:211]
M v[208:211],a[164:167],a[68:71],v[208:211]
M v[212:215],a[164:167],a[76:79],v[212:215]
M v[212:215],a[160:163],a[72:75],v[212:215]
M v[216:219],a[160:163],a[80:83],v[216:219]
M v[216:219],a[164:167],a[84:87],v[216:219]
s_waitcnt lgkmcnt(2)
M v[220:223],a[164:167],a[92:95],v[220:223]
s_waitcnt vmcnt(17) lgkmcnt(0)
M v[220:223],a[160:163],a[88:91],v[220:223]
s_barrier
M v[252:255],a[168:171],a[88:91],v[252:255]
R a[160:163],v5,0
R a[164:167],v6,0
M v[252:255],a[172:175],a[92:95],v[252:255]
M v[248:251],a[172:175],a[84:87],v[248:251]
M v[248:251],a[168:171],a[80:83],v[248:251]
M v[244:247],a[168:171],a[72:75],v[244:247]
M v[244:247],a[172:175],a[76:79],v[244:247]
M v[240:243],a[172:175],a[68:71],v[240:243]
M v[240:243],a[168:171],a[64:67],v[240:243]
M v[236:239],a[168:171],a[56:59],v[236:239]
M v[236:239],a[172:175],a[60:63],v[236:239]
M v[232:235],a[172:175],a[52:55],v[232:235]
M v[232:235],a[168:171],a[48:51],v[232:235]
M v[228:231],a[168:171],a[40:43],v[228:231]
M v[228:231],a[172:175],a[44:47],v[228:231]
s_waitcnt lgkmcnt(0)
M v[224:227],a[172:175],a[36:39],v[224:227]
M v[224:227],a[168:171],a[32:35],v[224:227]
M a[0:3],a[160:163],a[96:99],a[0:3]
R a[168:171],v5,2048
R a[172:175],v6,2048
M a[0:3],a[164:167],a[100:103],a[0:3]
T a[32:33],v1,32768
T a[34:35],v1,33792
M a[4:7],a[164:167],a[108:111],a[4:7]
SA m0,s24,49152
v_lshrrev_b32 v28, 4, v0
v_and_b32 v29, 7, v0
M a[4:7],a[160:163],a[104:107],a[4:7]
buffer_load_dwordx4 v12, s[48:51], s22 offen offset:0   lds
M a[8:11],a[160:163],a[112:115],a[8:11]
v_xor_b32 v28, v28, v29
v_lshlrev_b32 v28, 4, v28
M a[8:11],a[164:167],a[116:119],a[8:11]
v_lshrrev_b32 v29, 3, v0
v_mul_u32_u24 v29, 896, v29
M a[12:15],a[164:167],a[124:127],a[12:15]
T a[36:37],v1,40960
T a[38:39],v1,41984
M a[12:15],a[160:163],a[120:123],a[12:15]
v_add_u32 v22, v28, v29
v_xor_b32 v28, 64, v28
M a[16:19],a[160:163],a[128:131],a[16:19]
s_mul_i32 s64, s20, 14336
buffer_load_dwordx4 v13, s[48:51], s22 offen offset:1024   lds
M a[16:19],a[164:167],a[132:135],a[16:19]
s_sub_u32 s65, 98304, s64
M a[20:23],a[164:167],a[140:143],a[20:23]
SA s30,s29,s65
M a[20:23],a[160:163],a[136:139],a[20:23]
SA s29,s29,s64
T a[40:41],v2,32768
T a[42:43],v2,33792
M a[24:27],a[160:163],a[144:147],a[24:27]
v_add_u32 v29, 6144, v29
v_add_u32 v23, v28, v29
M a[24:27],a[164:167],a[148:151],a[24:27]
s_waitcnt lgkmcnt(6)
buffer_load_dwordx4 v14, s[48:51], s22 offen offset:2048   lds
M a[28:31],a[164:167],a[156:159],a[28:31]
s_and_b32 s64, s20, 1
M a[28:31],a[160:163],a[152:155],a[28:31]
s_lshl_b32 s64, s64, 12
M v[60:63],a[168:171],a[152:155],v[60:63]
SA s64,s64,65536
R a[160:163],v5,4096
R a[164:167],v6,4096
M v[60:63],a[172:175],a[156:159],v[60:63]
T a[44:45],v2,40960
T a[46:47],v2,41984
M v[56:59],a[172:175],a[148:151],v[56:59]
buffer_load_dwordx4 v15, s[48:51], s22 offen offset:3072   lds
M v[56:59],a[168:171],a[144:147],v[56:59]
s_sub_u32 s22, s22, 1048448
v_add_u32 v20, s64, v5
v_add_u32 v21, s64, v6
M v[52:55],a[168:171],a[136:139],v[52:55]
M v[52:55],a[172:175],a[140:143],v[52:55]
s_nop 0
T a[48:49],v3,32768
T a[50:51],v3,33792
M v[48:51],a[172:175],a[132:135],v[48:51]
SA m0,s23,16384
M v[48:51],a[168:171],a[128:131],v[48:51]
buffer_load_dwordx4 v8, s[16:19], s21 offen offset:0   lds
M v[44:47],a[168:171],a[120:123],v[44:47]
M v[44:47],a[172:175],a[124:127],v[44:47]
M v[40:43],a[172:175],a[116:119],v[40:43]
s_nop 0
T a[52:53],v3,40960
T a[54:55],v3,41984
M v[40:43],a[168:171],a[112:115],v[40:43]
M v[36:39],a[168:171],a[104:107],v[36:39]
buffer_load_dwordx4 v9, s[16:19], s21 offen offset:1024   lds
M v[36:39],a[172:175],a[108:111],v[36:39]
s_waitcnt lgkmcnt(6)
M v[32:35],a[172:175],a[100:103],v[32:35]
M v[32:35],a[168:171],a[96:99],v[32:35]
s_nop 0
T a[56:57],v4,32768
T a[58:59],v4,33792
M v[64:67],a[160:163],a[96:99],v[64:67]
R a[168:171],v5,6144
R a[172:175],v6,6144
M v[64:67],a[164:167],a[100:103],v[64:67]
buffer_load_dwordx4 v10, s[16:19], s21 offen offset:2048   lds
M v[68:71],a[164:167],a[108:111],v[68:71]
M v[68:71],a[160:163],a[104:107],v[68:71]
M v[72:75],a[160:163],a[112:115],v[72:75]
s_nop 0
T a[60:61],v4,40960
T a[62:63],v4,41984
M v[72:75],a[164:167],a[116:119],v[72:75]
M v[76:79],a[164:167],a[124:127],v[76:79]
buffer_load_dwordx4 v11, s[16:19], s21 offen offset:3072   lds
M v[76:79],a[160:163],a[120:123],v[76:79]
SA s21,s21,524160
M v[80:83],a[160:163],a[128:131],v[80:83]
M v[80:83],a[164:167],a[132:135],v[80:83]
M v[84:87],a[164:167],a[140:143],v[84:87]
M v[84:87],a[160:163],a[136:139],v[84:87]
M v[88:91],a[160:163],a[144:147],v[88:91]
M v[88:91],a[164:167],a[148:151],v[88:91]
s_waitcnt lgkmcnt(2)
M v[92:95],a[164:167],a[156:159],v[92:95]
s_waitcnt vmcnt(16) lgkmcnt(0)
M v[92:95],a[160:163],a[152:155],v[92:95]
s_barrier
M v[124:127],a[168:171],a[152:155],v[124:127]
R a[160:163],v5,16384
R a[164:167],v6,16384
M v[124:127],a[172:175],a[156:159],v[124:127]
SA m0,s23,131072
M v[120:123],a[172:175],a[148:151],v[120:123]
s_nop 0
T a[64:65],v1,49152
T a[66:67],v1,50176
M v[120:123],a[168:171],a[144:147],v[120:123]
buffer_load_dwordx4 v22, s[56:59], s29 offen offset:0 lds
M v[116:119],a[168:171],a[136:139],v[116:119]
M v[116:119],a[172:175],a[140:143],v[116:119]
M v[112:115],a[172:175],a[132:135],v[112:115]
buffer_load_dwordx4 v23, s[56:59], s29 offen offset:1024 lds
M v[112:115],a[168:171],a[128:131],v[112:115]
M v[108:111],a[168:171],a[120:123],v[108:111]
M v[108:111],a[172:175],a[124:127],v[108:111]
s_nop 0
T a[68:69],v1,57344
T a[70:71],v1,58368
M v[104:107],a[172:175],a[116:119],v[104:107]
buffer_load_dwordx4 v22, s[56:59], s30 offen offset:2048 lds
M v[104:107],a[168:171],a[112:115],v[104:107]
M v[100:103],a[168:171],a[104:107],v[100:103]
M v[100:103],a[172:175],a[108:111],v[100:103]
s_waitcnt lgkmcnt(4)
M v[96:99],a[172:175],a[100:103],v[96:99]
M v[96:99],a[168:171],a[96:99],v[96:99]
buffer_load_dwordx4 v23, s[56:59], s30 offen offset:3072 lds
M v[128:131],a[160:163],a[96:99],v[128:131]
R a[168:171],v5,18432
R a[172:175],v6,18432
M v[128:131],a[164:167],a[100:103],v[128:131]
SA s29,s29,128
T a[72:73],v2,49152
T a[74:75],v2,50176
M v[132:135],a[164:167],a[108:111],v[132:135]
SA s30,s30,128
M v[132:135],a[160:163],a[104:107],v[132:135]
SA m0,s24,0
M v[136:139],a[160:163],a[112:115],v[136:139]
buffer_load_dwordx4 v12, s[48:51], s22 offen offset:0   lds
M v[136:139],a[164:167],a[116:119],v[136:139]
M v[140:143],a[164:167],a[124:127],v[140:143]
M v[140:143],a[160:163],a[120:123],v[140:143]
s_nop 0
T a[76:77],v2,57344
T a[78:79],v2,58368
M v[144:147],a[160:163],a[128:131],v[144:147]
buffer_load_dwordx4 v13, s[48:51], s22 offen offset:1024   lds
M v[144:147],a[164:167],a[132:135],v[144:147]
M v[148:151],a[164:167],a[140:143],v[148:151]
M v[148:151],a[160:163],a[136:139],v[148:151]
M v[152:155],a[160:163],a[144:147],v[152:155]
M v[152:155],a[164:167],a[148:151],v[152:155]
s_waitcnt lgkmcnt(4)
buffer_load_dwordx4 v14, s[48:51], s22 offen offset:2048   lds
M v[156:159],a[164:167],a[156:159],v[156:159]
s_nop 0
T a[80:81],v3,49152
T a[82:83],v3,50176
M v[156:159],a[160:163],a[152:155],v[156:159]
M v[188:191],a[168:171],a[152:155],v[188:191]
R a[160:163],v5,20480
R a[164:167],v6,20480
M v[188:191],a[172:175],a[156:159],v[188:191]
M v[184:187],a[172:175],a[148:151],v[184:187]
buffer_load_dwordx4 v15, s[48:51], s22 offen offset:3072   lds
M v[184:187],a[168:171],a[144:147],v[184:187]
M v[180:183],a[168:171],a[136:139],v[180:183]
M v[180:183],a[172:175],a[140:143],v[180:183]
SA s22,s22,1048576
T a[84:85],v3,57344
T a[86:87],v3,58368
M v[176:179],a[172:175],a[132:135],v[176:179]
SA m0,s23,32768
M v[176:179],a[168:171],a[128:131],v[176:179]
buffer_load_dwordx4 v8, s[16:19], s21 offen offset:0   lds
M v[172:175],a[168:171],a[120:123],v[172:175]
M v[172:175],a[172:175],a[124:127],v[172:175]
M v[168:171],a[172:175],a[116:119],v[168:171]
M v[168:171],a[168:171],a[112:115],v[168:171]
buffer_load_dwordx4 v9, s[16:19], s21 offen offset:1024   lds
M v[164:167],a[168:171],a[104:107],v[164:167]
s_nop 0
T a[88:89],v4,49152
T a[90:91],v4,50176
M v[164:167],a[172:175],a[108:111],v[164:167]
s_waitcnt lgkmcnt(4)
M v[160:163],a[172:175],a[100:103],v[160:163]
M v[160:163],a[168:171],a[96:99],v[160:163]
M v[192:195],a[160:163],a[96:99],v[192:195]
R a[168:171],v5,22528
R a[172:175],v6,22528
M v[192:195],a[164:167],a[100:103],v[192:195]
buffer_load_dwordx4 v10, s[16:19], s21 offen offset:2048   lds
M v[196:199],a[164:167],a[108:111],v[196:199]
M v[196:199],a[160:163],a[104:107],v[196:199]
s_nop 0
T a[92:93],v4,57344
T a[94:95],v4,58368
M v[200:203],a[160:163],a[112:115],v[200:203]
M v[200:203],a[164:167],a[116:119],v[200:203]
buffer_load_dwordx4 v11, s[16:19], s21 offen offset:3072   lds
M v[204:207],a[164:167],a[124:127],v[204:207]
M v[204:207],a[160:163],a[120:123],v[204:207]
M v[208:211],a[160:163],a[128:131],v[208:211]
M v[208:211],a[164:167],a[132:135],v[208:211]
M v[212:215],a[164:167],a[140:143],v[212:215]
SA s21,s21,128
M v[212:215],a[160:163],a[136:139],v[212:215]
M v[216:219],a[160:163],a[144:147],v[216:219]
M v[216:219],a[164:167],a[148:151],v[216:219]
s_waitcnt lgkmcnt(2)
M v[220:223],a[164:167],a[156:159],v[220:223]
s_waitcnt vmcnt(20) lgkmcnt(0)
M v[220:223],a[160:163],a[152:155],v[220:223]
s_barrier
M v[252:255],a[168:171],a[152:155],v[252:255]
R a[160:163],v5,32768
R a[164:167],v6,32768
M v[252:255],a[172:175],a[156:159],v[252:255]
M v[248:251],a[172:175],a[148:151],v[248:251]
M v[248:251],a[168:171],a[144:147],v[248:251]
M v[244:247],a[168:171],a[136:139],v[244:247]
M v[244:247],a[172:175],a[140:143],v[244:247]
M v[240:243],a[172:175],a[132:135],v[240:243]
M v[240:243],a[168:171],a[128:131],v[240:243]
M v[236:239],a[168:171],a[120:123],v[236:239]
M v[236:239],a[172:175],a[124:127],v[236:239]
M v[232:235],a[172:175],a[116:119],v[232:235]
M v[232:235],a[168:171],a[112:115],v[232:235]
M v[228:231],a[168:171],a[104:107],v[228:231]
M v[228:231],a[172:175],a[108:111],v[228:231]
s_waitcnt lgkmcnt(0)
M v[224:227],a[172:175],a[100:103],v[224:227]
M v[224:227],a[168:171],a[96:99],v[224:227]
M a[0:3],a[160:163],a[32:35],a[0:3]
R a[168:171],v5,34816
R a[172:175],v6,34816
M a[0:3],a[164:167],a[36:39],a[0:3]
SA m0,s23,147456
T a[96:97],v1,0
T a[98:99],v1,1024
M a[4:7],a[164:167],a[44:47],a[4:7]
buffer_load_dwordx4 v22, s[56:59], s29 offen offset:0 lds
M a[4:7],a[160:163],a[40:43],a[4:7]
M a[8:11],a[160:163],a[48:51],a[8:11]
M a[8:11],a[164:167],a[52:55],a[8:11]
buffer_load_dwordx4 v23, s[56:59], s29 offen offset:1024 lds
M a[12:15],a[164:167],a[60:63],a[12:15]
s_nop 0
T a[100:101],v1,8192
T a[102:103],v1,9216
M a[12:15],a[160:163],a[56:59],a[12:15]
M a[16:19],a[160:163],a[64:67],a[16:19]
buffer_load_dwordx4 v22, s[56:59], s30 offen offset:2048 lds
M a[16:19],a[164:167],a[68:71],a[16:19]
M a[20:23],a[164:167],a[76:79],a[20:23]
M a[20:23],a[160:163],a[72:75],a[20:23]
s_nop 0
T a[104:105],v2,0
T a[106:107],v2,1024
M a[24:27],a[160:163],a[80:83],a[24:27]
buffer_load_dwordx4 v23, s[56:59], s30 offen offset:3072 lds
M a[24:27],a[164:167],a[84:87],a[24:27]
s_waitcnt lgkmcnt(6)
M a[28:31],a[164:167],a[92:95],a[28:31]
SA s29,s29,128
M a[28:31],a[160:163],a[88:91],a[28:31]
SA s30,s30,128
M v[60:63],a[168:171],a[88:91],v[60:63]
SA m0,s24,16384
R a[160:163],v5,36864
R a[164:167],v6,36864
M v[60:63],a[172:175],a[92:95],v[60:63]
T a[108:109],v2,8192
T a[110:111],v2,9216
M v[56:59],a[172:175],a[84:87],v[56:59]
buffer_load_dwordx4 v12, s[48:51], s22 offen offset:0   lds
M v[56:59],a[168:171],a[80:83],v[56:59]
M v[52:55],a[168:171],a[72:75],v[52:55]
M v[52:55],a[172:175],a[76:79],v[52:55]
s_nop 0
T a[112:113],v3,0
T a[114:115],v3,1024
M v[48:51],a[172:175],a[68:71],v[48:51]
buffer_load_dwordx4 v13, s[48:51], s22 offen offset:1024   lds
M v[48:51],a[168:171],a[64:67],v[48:51]
M v[44:47],a[168:171],a[56:59],v[44:47]
M v[44:47],a[172:175],a[60:63],v[44:47]
buffer_load_dwordx4 v14, s[48:51], s22 offen offset:2048   lds
M v[40:43],a[172:175],a[52:55],v[40:43]
s_nop 0
T a[116:117],v3,8192
T a[118:119],v3,9216
L_w_kv16:
s_cbranch_execz L_wd2
M v[40:43],a[168:171],a[48:51],v[40:43]
M v[36:39],a[168:171],a[40:43],v[36:39]
buffer_load_dwordx4 v15, s[48:51], s22 offen offset:3072   lds
M v[36:39],a[172:175],a[44:47],v[36:39]
s_waitcnt lgkmcnt(6)
M v[32:35],a[172:175],a[36:39],v[32:35]
s_sub_u32 s22, s22, 1048448
M v[32:35],a[168:171],a[32:35],v[32:35]
SA m0,s23,49152
T a[120:121],v4,0
T a[122:123],v4,1024
M v[64:67],a[160:163],a[32:35],v[64:67]
R a[168:171],v5,38912
R a[172:175],v6,38912
M v[64:67],a[164:167],a[36:39],v[64:67]
buffer_load_dwordx4 v8, s[16:19], s21 offen offset:0   lds
M v[68:71],a[164:167],a[44:47],v[68:71]
M v[68:71],a[160:163],a[40:43],v[68:71]
M v[72:75],a[160:163],a[48:51],v[72:75]
s_waitcnt vmcnt(17)
s_nop 0
T a[124:125],v4,8192
T a[126:127],v4,9216
M v[72:75],a[164:167],a[52:55],v[72:75]
buffer_load_dwordx4 v9, s[16:19], s21 offen offset:1024   lds
M v[76:79],a[164:167],a[60:63],v[76:79]
R a[176:179],v20,0
R a[180:183],v20,2048
M v[76:79],a[160:163],a[56:59],v[76:79]
R a[184:187],v21,0
R a[188:191],v21,2048
M v[80:83],a[160:163],a[64:67],v[80:83]
buffer_load_dwordx4 v10, s[16:19], s21 offen offset:2048   lds
M v[80:83],a[164:167],a[68:71],v[80:83]
M v[84:87],a[164:167],a[76:79],v[84:87]
M v[84:87],a[160:163],a[72:75],v[84:87]
buffer_load_dwordx4 v11, s[16:19], s21 offen offset:3072   lds
M v[88:91],a[160:163],a[80:83],v[88:91]
SA s21,s21,524160
M v[88:91],a[164:167],a[84:87],v[88:91]
s_waitcnt lgkmcnt(6)
M v[92:95],a[164:167],a[92:95],v[92:95]
s_waitcnt lgkmcnt(0)
M v[92:95],a[160:163],a[88:91],v[92:95]
s_barrier
M v[124:127],a[168:171],a[88:91],v[124:127]
s_lshl_b32 s4, s20, 10
R a[160:163],v5,49152
R a[164:167],v6,49152
M v[124:127],a[172:175],a[92:95],v[124:127]
SA m0,s23,131072
v_bfe_u32 v28, v0, 3, 2
M v[120:123],a[172:175],a[84:87],v[120:123]
s_nop 0
T a[128:129],v1,16384
T a[130:131],v1,17408
M v[120:123],a[168:171],a[80:83],v[120:123]
buffer_load_dwordx4 v22, s[56:59], s29 offen offset:0 lds
M v[116:119],a[168:171],a[72:75],v[116:119]
v_lshrrev_b32 v29, 5, v0
v_lshl_add_u32 v28, v29, 3, v28
M v[116:119],a[172:175],a[76:79],v[116:119]
M v[112:115],a[172:175],a[68:71],v[112:115]
v_lshlrev_b32 v28, 13, v28
M v[112:115],a[168:171],a[64:67],v[112:115]
M v[108:111],a[168:171],a[56:59],v[108:111]
buffer_load_dwordx4 v23, s[56:59], s29 offen offset:1024 lds
M v[108:111],a[172:175],a[60:63],v[108:111]
s_nop 0
T a[132:133],v1,24576
T a[134:135],v1,25600
M v[104:107],a[172:175],a[52:55],v[104:107]
v_lshrrev_b32 v29, 4, v0
v_lshlrev_b32 v29, 1, v29
M v[104:107],a[168:171],a[48:51],v[104:107]
M v[100:103],a[168:171],a[40:43],v[100:103]
v_and_b32 v30, 7, v0
M v[100:103],a[172:175],a[44:47],v[100:103]
s_waitcnt lgkmcnt(4)
M v[96:99],a[172:175],a[36:39],v[96:99]
v_xor_b32 v29, v29, v30
M v[96:99],a[168:171],a[32:35],v[96:99]
buffer_load_dwordx4 v22, s[56:59], s30 offen offset:2048 lds
M v[128:131],a[160:163],a[32:35],v[128:131]
R a[168:171],v5,51200
R a[172:175],v6,51200
M v[128:131],a[164:167],a[36:39],v[128:131]
T a[136:137],v2,16384
T a[138:139],v2,17408
M v[132:135],a[164:167],a[44:47],v[132:135]
v_lshl_add_u32 v28, v29, 4, v28
M v[132:135],a[160:163],a[40:43],v[132:135]
s_and_b32 s64, s20, 1
M v[136:139],a[160:163],a[48:51],v[136:139]
s_lshl_b32 s64, s64, 17
M v[136:139],a[164:167],a[52:55],v[136:139]
s_lshr_b32 s65, s20, 1
M v[140:143],a[164:167],a[60:63],v[140:143]
s_lshl_b32 s65, s65, 15
SA s64,s64,s65
v_add_u32 v8, s64, v28
M v[140:143],a[160:163],a[56:59],v[140:143]
s_nop 0
T a[140:141],v2,24576
T a[142:143],v2,25600
M v[144:147],a[160:163],a[64:67],v[144:147]
buffer_load_dwordx4 v23, s[56:59], s30 offen offset:3072 lds
M v[144:147],a[164:167],a[68:71],v[144:147]
M v[148:151],a[164:167],a[76:79],v[148:151]
SA s29,s29,128
M v[148:151],a[160:163],a[72:75],v[148:151]
SA s30,s30,128
M v[152:155],a[160:163],a[80:83],v[152:155]
SA m0,s24,32768
M v[152:155],a[164:167],a[84:87],v[152:155]
s_waitcnt lgkmcnt(4)
buffer_load_dwordx4 v12, s[48:51], s22 offen offset:0   lds
M v[156:159],a[164:167],a[92:95],v[156:159]
s_nop 0
T a[144:145],v3,16384
T a[146:147],v3,17408
M v[156:159],a[160:163],a[88:91],v[156:159]
M v[188:191],a[168:171],a[88:91],v[188:191]
R a[160:163],v5,53248
R a[164:167],v6,53248
M v[188:191],a[172:175],a[92:95],v[188:191]
M v[184:187],a[172:175],a[84:87],v[184:187]
M v[184:187],a[168:171],a[80:83],v[184:187]
M v[180:183],a[168:171],a[72:75],v[180:183]
buffer_load_dwordx4 v13, s[48:51], s22 offen offset:1024   lds
M v[180:183],a[172:175],a[76:79],v[180:183]
s_nop 0
T a[148:149],v3,24576
T a[150:151],v3,25600
M v[176:179],a[172:175],a[68:71],v[176:179]
M v[176:179],a[168:171],a[64:67],v[176:179]
M v[172:175],a[168:171],a[56:59],v[172:175]
M v[172:175],a[172:175],a[60:63],v[172:175]
M v[168:171],a[172:175],a[52:55],v[168:171]
M v[168:171],a[168:171],a[48:51],v[168:171]
buffer_load_dwordx4 v14, s[48:51], s22 offen offset:2048   lds
M v[164:167],a[168:171],a[40:43],v[164:167]
s_nop 0
T a[152:153],v4,16384
T a[154:155],v4,17408
M v[164:167],a[172:175],a[44:47],v[164:167]
s_waitcnt lgkmcnt(4)
M v[160:163],a[172:175],a[36:39],v[160:163]
M v[160:163],a[168:171],a[32:35],v[160:163]
M v[192:195],a[160:163],a[32:35],v[192:195]
R a[168:171],v5,55296
R a[172:175],v6,55296
M v[192:195],a[164:167],a[36:39],v[192:195]
M v[196:199],a[164:167],a[44:47],v[196:199]
buffer_load_dwordx4 v15, s[48:51], s22 offen offset:3072   lds
M v[196:199],a[160:163],a[40:43],v[196:199]
s_nop 0
T a[156:157],v4,24576
T a[158:159],v4,25600
M v[200:203],a[160:163],a[48:51],v[200:203]
s_waitcnt vmcnt(16)
R a[192:195],v20,16384
R a[196:199],v20,18432
M v[200:203],a[164:167],a[52:55],v[200:203]
R a[200:203],v21,16384
R a[204:207],v21,18432
M v[204:207],a[164:167],a[60:63],v[204:207]
M v[204:207],a[160:163],a[56:59],v[204:207]
M v[208:211],a[160:163],a[64:67],v[208:211]
M v[208:211],a[164:167],a[68:71],v[208:211]
M v[212:215],a[164:167],a[76:79],v[212:215]
SA s22,s22,1048576
M v[212:215],a[160:163],a[72:75],v[212:215]
M v[216:219],a[160:163],a[80:83],v[216:219]
M v[216:219],a[164:167],a[84:87],v[216:219]
s_waitcnt lgkmcnt(6)
M v[220:223],a[164:167],a[92:95],v[220:223]
s_waitcnt lgkmcnt(0)
M v[220:223],a[160:163],a[88:91],v[220:223]
s_barrier
M v[252:255],a[168:171],a[88:91],v[252:255]
R a[160:163],v5,0
R a[164:167],v6,0
M v[252:255],a[172:175],a[92:95],v[252:255]
M v[248:251],a[172:175],a[84:87],v[248:251]
M v[248:251],a[168:171],a[80:83],v[248:251]
M v[244:247],a[168:171],a[72:75],v[244:247]
M v[244:247],a[172:175],a[76:79],v[244:247]
M v[240:243],a[172:175],a[68:71],v[240:243]
M v[240:243],a[168:171],a[64:67],v[240:243]
M v[236:239],a[168:171],a[56:59],v[236:239]
M v[236:239],a[172:175],a[60:63],v[236:239]
M v[232:235],a[172:175],a[52:55],v[232:235]
M v[232:235],a[168:171],a[48:51],v[232:235]
M v[228:231],a[168:171],a[40:43],v[228:231]
M v[228:231],a[172:175],a[44:47],v[228:231]
s_waitcnt lgkmcnt(0)
M v[224:227],a[172:175],a[36:39],v[224:227]
M v[224:227],a[168:171],a[32:35],v[224:227]
M a[0:3],a[160:163],a[96:99],a[0:3]
R a[168:171],v5,2048
R a[172:175],v6,2048
M a[0:3],a[164:167],a[100:103],a[0:3]
SA m0,s23,147456
T a[32:33],v1,32768
T a[34:35],v1,33792
M a[4:7],a[164:167],a[108:111],a[4:7]
buffer_load_dwordx4 v22, s[56:59], s29 offen offset:0 lds
M a[4:7],a[160:163],a[104:107],a[4:7]
M a[8:11],a[160:163],a[112:115],a[8:11]
M a[8:11],a[164:167],a[116:119],a[8:11]
buffer_load_dwordx4 v23, s[56:59], s29 offen offset:1024 lds
M a[12:15],a[164:167],a[124:127],a[12:15]
s_nop 0
T a[36:37],v1,40960
T a[38:39],v1,41984
M a[12:15],a[160:163],a[120:123],a[12:15]
M a[16:19],a[160:163],a[128:131],a[16:19]
buffer_load_dwordx4 v22, s[56:59], s30 offen offset:2048 lds
M a[16:19],a[164:167],a[132:135],a[16:19]
M a[20:23],a[164:167],a[140:143],a[20:23]
M a[20:23],a[160:163],a[136:139],a[20:23]
s_nop 0
T a[40:41],v2,32768
T a[42:43],v2,33792
M a[24:27],a[160:163],a[144:147],a[24:27]
buffer_load_dwordx4 v23, s[56:59], s30 offen offset:3072 lds
M a[24:27],a[164:167],a[148:151],a[24:27]
s_waitcnt lgkmcnt(6)
M a[28:31],a[164:167],a[156:159],a[28:31]
SA s29,s29,128
M a[28:31],a[160:163],a[152:155],a[28:31]
SA s30,s30,128
M v[60:63],a[168:171],a[152:155],v[60:63]
SA m0,s24,49152
R a[160:163],v5,4096
R a[164:167],v6,4096
M v[60:63],a[172:175],a[156:159],v[60:63]
T a[44:45],v2,40960
T a[46:47],v2,41984
M v[56:59],a[172:175],a[148:151],v[56:59]
buffer_load_dwordx4 v12, s[48:51], s22 offen offset:0   lds
M v[56:59],a[168:171],a[144:147],v[56:59]
M v[52:55],a[168:171],a[136:139],v[52:55]
M v[52:55],a[172:175],a[140:143],v[52:55]
s_nop 0
T a[48:49],v3,32768
T a[50:51],v3,33792
M v[48:51],a[172:175],a[132:135],v[48:51]
buffer_load_dwordx4 v13, s[48:51], s22 offen offset:1024   lds
M v[48:51],a[168:171],a[128:131],v[48:51]
M v[44:47],a[168:171],a[120:123],v[44:47]
M v[44:47],a[172:175],a[124:127],v[44:47]
buffer_load_dwordx4 v14, s[48:51], s22 offen offset:2048   lds
M v[40:43],a[172:175],a[116:119],v[40:43]
s_nop 0
T a[52:53],v3,40960
T a[54:55],v3,41984
M v[40:43],a[168:171],a[112:115],v[40:43]
M v[36:39],a[168:171],a[104:107],v[36:39]
buffer_load_dwordx4 v15, s[48:51], s22 offen offset:3072   lds
M v[36:39],a[172:175],a[108:111],v[36:39]
s_waitcnt lgkmcnt(6)
M v[32:35],a[172:175],a[100:103],v[32:35]
s_sub_u32 s22, s22, 1048448
M v[32:35],a[168:171],a[96:99],v[32:35]
s_mov_b32 s25, 0
T a[56:57],v4,32768
T a[58:59],v4,33792
M v[64:67],a[160:163],a[96:99],v[64:67]
SA m0,s4,0
R a[168:171],v5,6144
R a[172:175],v6,6144
M v[64:67],a[164:167],a[100:103],v[64:67]
buffer_load_dwordx4 v8, s[52:55], s25 offen lds
M v[68:71],a[164:167],a[108:111],v[68:71]
s_mov_b32 s25, 262144
M v[68:71],a[160:163],a[104:107],v[68:71]
SA m0,s4,4096
M v[72:75],a[160:163],a[112:115],v[72:75]
s_waitcnt vmcnt(13)
s_nop 0
T a[60:61],v4,40960
T a[62:63],v4,41984
M v[72:75],a[164:167],a[116:119],v[72:75]
buffer_load_dwordx4 v8, s[52:55], s25 offen lds
M v[76:79],a[164:167],a[124:127],v[76:79]
s_mov_b32 s25, 524288
R a[208:211],v20,0
R a[212:215],v20,2048
M v[76:79],a[160:163],a[120:123],v[76:79]
SA m0,s4,8192
R a[216:219],v21,0
R a[220:223],v21,2048
M v[80:83],a[160:163],a[128:131],v[80:83]
buffer_load_dwordx4 v8, s[52:55], s25 offen lds
M v[80:83],a[164:167],a[132:135],v[80:83]
s_mov_b32 s25, 786432
M v[84:87],a[164:167],a[140:143],v[84:87]
SA m0,s4,12288
M v[84:87],a[160:163],a[136:139],v[84:87]
buffer_load_dwordx4 v8, s[52:55], s25 offen lds
M v[88:91],a[160:163],a[144:147],v[88:91]
M v[88:91],a[164:167],a[148:151],v[88:91]
s_waitcnt lgkmcnt(6)
M v[92:95],a[164:167],a[156:159],v[92:95]
s_waitcnt lgkmcnt(0)
M v[92:95],a[160:163],a[152:155],v[92:95]
s_barrier
M v[124:127],a[168:171],a[152:155],v[124:127]
R a[160:163],v5,16384
R a[164:167],v6,16384
M v[124:127],a[172:175],a[156:159],v[124:127]
SA m0,s23,32768
M v[120:123],a[172:175],a[148:151],v[120:123]
s_nop 0
T a[64:65],v1,49152
T a[66:67],v1,50176
M v[120:123],a[168:171],a[144:147],v[120:123]
buffer_load_dwordx4 v22, s[56:59], s29 offen offset:0 lds
M v[116:119],a[168:171],a[136:139],v[116:119]
v_lshrrev_b32 v28, 2, v0
v_lshlrev_b32 v28, 7, v28
M v[116:119],a[172:175],a[140:143],v[116:119]
M v[112:115],a[172:175],a[132:135],v[112:115]
buffer_load_dwordx4 v23, s[56:59], s29 offen offset:1024 lds
M v[112:115],a[168:171],a[128:131],v[112:115]
v_and_b32 v29, 3, v0
M v[108:111],a[168:171],a[120:123],v[108:111]
v_lshl_add_u32 v28, v29, 3, v28
M v[108:111],a[172:175],a[124:127],v[108:111]
s_nop 0
T a[68:69],v1,57344
T a[70:71],v1,58368
M v[104:107],a[172:175],a[116:119],v[104:107]
buffer_load_dwordx4 v22, s[56:59], s30 offen offset:2048 lds
M v[104:107],a[168:171],a[112:115],v[104:107]
v_bfe_u32 v29, v0, 3, 2
M v[100:103],a[168:171],a[104:107],v[100:103]
M v[100:103],a[172:175],a[108:111],v[100:103]
s_waitcnt lgkmcnt(4)
v_lshl_add_u32 v16, v29, 5, v28
M v[96:99],a[172:175],a[100:103],v[96:99]
M v[96:99],a[168:171],a[96:99],v[96:99]
buffer_load_dwordx4 v23, s[56:59], s30 offen offset:3072 lds
M v[128:131],a[160:163],a[96:99],v[128:131]
R a[168:171],v5,18432
R a[172:175],v6,18432
M v[128:131],a[164:167],a[100:103],v[128:131]
SA s29,s29,128
T a[72:73],v2,49152
T a[74:75],v2,50176
M v[132:135],a[164:167],a[108:111],v[132:135]
SA s30,s30,128
v_xor_b32 v17, 32, v16
v_xor_b32 v18, 64, v16
M v[132:135],a[160:163],a[104:107],v[132:135]
SA m0,s23,65536
M v[136:139],a[160:163],a[112:115],v[136:139]
buffer_load_dwordx4 v22, s[56:59], s29 offen offset:0 lds
M v[136:139],a[164:167],a[116:119],v[136:139]
v_xor_b32 v19, 0x60, v16
M v[140:143],a[164:167],a[124:127],v[140:143]
v_add_u32 v12, 0x20000, v16
M v[140:143],a[160:163],a[120:123],v[140:143]
s_nop 0
T a[76:77],v2,57344
T a[78:79],v2,58368
M v[144:147],a[160:163],a[128:131],v[144:147]
buffer_load_dwordx4 v23, s[56:59], s29 offen offset:1024 lds
M v[144:147],a[164:167],a[132:135],v[144:147]
v_add_u32 v13, 0x20000, v17
M v[148:151],a[164:167],a[140:143],v[148:151]
M v[148:151],a[160:163],a[136:139],v[148:151]
v_add_u32 v14, 0x20000, v18
M v[152:155],a[160:163],a[144:147],v[152:155]
M v[152:155],a[164:167],a[148:151],v[152:155]
s_waitcnt lgkmcnt(4)
buffer_load_dwordx4 v22, s[56:59], s30 offen offset:2048 lds
M v[156:159],a[164:167],a[156:159],v[156:159]
s_nop 0
T a[80:81],v3,49152
T a[82:83],v3,50176
M v[156:159],a[160:163],a[152:155],v[156:159]
v_add_u32 v15, 0x20000, v19
M v[188:191],a[168:171],a[152:155],v[188:191]
R a[160:163],v5,20480
R a[164:167],v6,20480
M v[188:191],a[172:175],a[156:159],v[188:191]
M v[184:187],a[172:175],a[148:151],v[184:187]
buffer_load_dwordx4 v23, s[56:59], s30 offen offset:3072 lds
M v[184:187],a[168:171],a[144:147],v[184:187]
SA s29,s29,128
M v[180:183],a[168:171],a[136:139],v[180:183]
SA s30,s30,128
M v[180:183],a[172:175],a[140:143],v[180:183]
s_mov_b32 s25, 1048576
T a[84:85],v3,57344
T a[86:87],v3,58368
M v[176:179],a[172:175],a[132:135],v[176:179]
SA m0,s4,16384
M v[176:179],a[168:171],a[128:131],v[176:179]
buffer_load_dwordx4 v8, s[52:55], s25 offen lds
M v[172:175],a[168:171],a[120:123],v[172:175]
M v[172:175],a[172:175],a[124:127],v[172:175]
s_mov_b32 s25, 1310720
M v[168:171],a[172:175],a[116:119],v[168:171]
SA m0,s4,20480
M v[168:171],a[168:171],a[112:115],v[168:171]
buffer_load_dwordx4 v8, s[52:55], s25 offen lds
M v[164:167],a[168:171],a[104:107],v[164:167]
s_nop 0
T a[88:89],v4,49152
T a[90:91],v4,50176
M v[164:167],a[172:175],a[108:111],v[164:167]
s_waitcnt lgkmcnt(4)
M v[160:163],a[172:175],a[100:103],v[160:163]
s_mov_b32 s25, 1572864
M v[160:163],a[168:171],a[96:99],v[160:163]
SA m0,s4,24576
M v[192:195],a[160:163],a[96:99],v[192:195]
R a[168:171],v5,22528
R a[172:175],v6,22528
M v[192:195],a[164:167],a[100:103],v[192:195]
buffer_load_dwordx4 v8, s[52:55], s25 offen lds
M v[196:199],a[164:167],a[108:111],v[196:199]
M v[196:199],a[160:163],a[104:107],v[196:199]
s_mov_b32 s25, 1835008
T a[92:93],v4,57344
T a[94:95],v4,58368
M v[200:203],a[160:163],a[112:115],v[200:203]
SA m0,s4,28672
M v[200:203],a[164:167],a[116:119],v[200:203]
s_waitcnt vmcnt(19)
buffer_load_dwordx4 v8, s[52:55], s25 offen lds
M v[204:207],a[164:167],a[124:127],v[204:207]
R a[224:227],v20,16384
R a[228:231],v20,18432
M v[204:207],a[160:163],a[120:123],v[204:207]
R a[232:235],v21,16384
R a[236:239],v21,18432
M v[208:211],a[160:163],a[128:131],v[208:211]
v_subrev_u32 v20, 98304, v20
v_subrev_u32 v21, 98304, v21
M v[208:211],a[164:167],a[132:135],v[208:211]
M v[212:215],a[164:167],a[140:143],v[212:215]
M v[212:215],a[160:163],a[136:139],v[212:215]
M v[216:219],a[160:163],a[144:147],v[216:219]
M v[216:219],a[164:167],a[148:151],v[216:219]
s_waitcnt lgkmcnt(6)
M v[220:223],a[164:167],a[156:159],v[220:223]
s_waitcnt lgkmcnt(0)
M v[220:223],a[160:163],a[152:155],v[220:223]
s_barrier
M v[252:255],a[168:171],a[152:155],v[252:255]
R a[160:163],v5,32768
R a[164:167],v6,32768
M v[252:255],a[172:175],a[156:159],v[252:255]
M v[248:251],a[172:175],a[148:151],v[248:251]
M v[248:251],a[168:171],a[144:147],v[248:251]
M v[244:247],a[168:171],a[136:139],v[244:247]
M v[244:247],a[172:175],a[140:143],v[244:247]
M v[240:243],a[172:175],a[132:135],v[240:243]
M v[240:243],a[168:171],a[128:131],v[240:243]
M v[236:239],a[168:171],a[120:123],v[236:239]
M v[236:239],a[172:175],a[124:127],v[236:239]
M v[232:235],a[172:175],a[116:119],v[232:235]
M v[232:235],a[168:171],a[112:115],v[232:235]
M v[228:231],a[168:171],a[104:107],v[228:231]
M v[228:231],a[172:175],a[108:111],v[228:231]
s_waitcnt lgkmcnt(0)
M v[224:227],a[172:175],a[100:103],v[224:227]
M v[224:227],a[168:171],a[96:99],v[224:227]
M a[0:3],a[160:163],a[32:35],a[0:3]
R a[168:171],v5,34816
R a[172:175],v6,34816
M a[0:3],a[164:167],a[36:39],a[0:3]
SA m0,s23,81920
M a[4:7],a[164:167],a[44:47],a[4:7]
buffer_load_dwordx4 v22, s[56:59], s29 offen offset:0 lds
M a[4:7],a[160:163],a[40:43],a[4:7]
M a[8:11],a[160:163],a[48:51],a[8:11]
M a[8:11],a[164:167],a[52:55],a[8:11]
buffer_load_dwordx4 v23, s[56:59], s29 offen offset:1024 lds
M a[12:15],a[164:167],a[60:63],a[12:15]
M a[12:15],a[160:163],a[56:59],a[12:15]
M a[16:19],a[160:163],a[64:67],a[16:19]
M a[16:19],a[164:167],a[68:71],a[16:19]
buffer_load_dwordx4 v22, s[56:59], s30 offen offset:2048 lds
M a[20:23],a[164:167],a[76:79],a[20:23]
M a[20:23],a[160:163],a[72:75],a[20:23]
M a[24:27],a[160:163],a[80:83],a[24:27]
M a[24:27],a[164:167],a[84:87],a[24:27]
s_waitcnt lgkmcnt(0)
buffer_load_dwordx4 v23, s[56:59], s30 offen offset:3072 lds
M a[28:31],a[164:167],a[92:95],a[28:31]
SA s29,s29,128
M a[28:31],a[160:163],a[88:91],a[28:31]
SA s30,s30,128
M v[32:35],a[168:171],a[32:35],v[32:35]
s_mov_b32 s25, 2097152
R a[160:163],v5,36864
R a[164:167],v6,36864
M v[32:35],a[172:175],a[36:39],v[32:35]
SA m0,s4,131072
M v[36:39],a[172:175],a[44:47],v[36:39]
buffer_load_dwordx4 v8, s[52:55], s25 offen lds
M v[36:39],a[168:171],a[40:43],v[36:39]
s_mov_b32 s25, 2359296
M v[40:43],a[168:171],a[48:51],v[40:43]
SA m0,s4,135168
M v[40:43],a[172:175],a[52:55],v[40:43]
buffer_load_dwordx4 v8, s[52:55], s25 offen lds
M v[44:47],a[172:175],a[60:63],v[44:47]
G v24,a0
G v25,a1
M v[44:47],a[168:171],a[56:59],v[44:47]
s_mov_b32 s25, 2621440
G v26,a2
G v27,a3
M v[48:51],a[168:171],a[64:67],v[48:51]
SA m0,s4,139264
C v24,v24,v25
C v25,v26,v27
M v[48:51],a[172:175],a[68:71],v[48:51]
buffer_load_dwordx4 v8, s[52:55], s25 offen lds
M v[52:55],a[172:175],a[76:79],v[52:55]
C v26,v32,v33
C v27,v34,v35
M v[52:55],a[168:171],a[72:75],v[52:55]
SA s3,s93,0
M v[56:59],a[168:171],a[80:83],v[56:59]
s_mov_b32 s25, 2883584
buffer_store_dwordx4 v[24:27], v7, s[8:11], s3 offen offset:0 sc1
M v[56:59],a[172:175],a[84:87],v[56:59]
s_waitcnt lgkmcnt(0)
G v28,a4
G v29,a5
M v[60:63],a[172:175],a[92:95],v[60:63]
SA m0,s4,143360
G v30,a6
G v31,a7
M v[60:63],a[168:171],a[88:91],v[60:63]
s_waitcnt vmcnt(16)
buffer_load_dwordx4 v8, s[52:55], s25 offen lds
M v[64:67],a[160:163],a[32:35],v[64:67]
L_w_kv17:
s_cbranch_execz L_wd2
s_mov_b32 s25, 3145728
R a[168:171],v5,38912
R a[172:175],v6,38912
M v[64:67],a[164:167],a[36:39],v[64:67]
SA m0,s4,147456
C v28,v28,v29
C v29,v30,v31
M v[68:71],a[164:167],a[44:47],v[68:71]
buffer_load_dwordx4 v8, s[52:55], s25 offen lds
M v[68:71],a[160:163],a[40:43],v[68:71]
s_mov_b32 s25, 3407872
C v30,v36,v37
C v31,v38,v39
M v[72:75],a[160:163],a[48:51],v[72:75]
SA m0,s4,151552
buffer_store_dwordx4 v[28:31], v7, s[8:11], s3 offen offset:2048 sc1
M v[72:75],a[164:167],a[52:55],v[72:75]
G v24,a8
G v25,a9
M v[76:79],a[164:167],a[60:63],v[76:79]
G v26,a10
G v27,a11
M v[76:79],a[160:163],a[56:59],v[76:79]
buffer_load_dwordx4 v8, s[52:55], s25 offen lds
M v[80:83],a[160:163],a[64:67],v[80:83]
C v24,v24,v25
C v25,v26,v27
M v[80:83],a[164:167],a[68:71],v[80:83]
C v26,v40,v41
C v27,v42,v43
M v[84:87],a[164:167],a[76:79],v[84:87]
SA s3,s93,4096
buffer_store_dwordx4 v[24:27], v7, s[8:11], s3 offen offset:0 sc1
M v[84:87],a[160:163],a[72:75],v[84:87]
R a[96:99],v20,0
R a[100:103],v20,2048
M v[88:91],a[160:163],a[80:83],v[88:91]
R a[104:107],v21,0
R a[108:111],v21,2048
M v[88:91],a[164:167],a[84:87],v[88:91]
s_waitcnt lgkmcnt(4)
G v28,a12
G v29,a13
M v[92:95],a[164:167],a[92:95],v[92:95]
s_waitcnt lgkmcnt(0)
G v30,a14
G v31,a15
M v[92:95],a[160:163],a[88:91],v[92:95]
s_barrier
M v[96:99],a[168:171],a[32:35],v[96:99]
R a[160:163],v5,49152
R a[164:167],v6,49152
M v[96:99],a[172:175],a[36:39],v[96:99]
s_mov_b32 s25, 128
C v28,v28,v29
C v29,v30,v31
M v[100:103],a[172:175],a[44:47],v[100:103]
SA m0,s4,49152
C v30,v44,v45
C v31,v46,v47
M v[100:103],a[168:171],a[40:43],v[100:103]
s_waitcnt vmcnt(17)
buffer_store_dwordx4 v[28:31], v7, s[8:11], s3 offen offset:2048 sc1
M v[104:107],a[168:171],a[48:51],v[104:107]
G v24,a16
G v25,a17
M v[104:107],a[172:175],a[52:55],v[104:107]
G v26,a18
G v27,a19
M v[108:111],a[172:175],a[60:63],v[108:111]
buffer_load_dwordx4 v8, s[52:55], s25 offen lds
M v[108:111],a[168:171],a[56:59],v[108:111]
C v24,v24,v25
C v25,v26,v27
M v[112:115],a[168:171],a[64:67],v[112:115]
C v26,v48,v49
C v27,v50,v51
M v[112:115],a[172:175],a[68:71],v[112:115]
SA s3,s93,8192
buffer_store_dwordx4 v[24:27], v7, s[8:11], s3 offen offset:0 sc1
M v[116:119],a[172:175],a[76:79],v[116:119]
s_mov_b32 s25, 262272
R a[112:115],v20,32768
R a[116:119],v20,34816
M v[116:119],a[168:171],a[72:75],v[116:119]
SA m0,s4,53248
R a[120:123],v21,32768
R a[124:127],v21,34816
M v[120:123],a[168:171],a[80:83],v[120:123]
C v64,v64,v65
C v65,v66,v67
M v[120:123],a[172:175],a[84:87],v[120:123]
s_waitcnt lgkmcnt(4)
buffer_load_dwordx4 v8, s[52:55], s25 offen lds
M v[124:127],a[172:175],a[92:95],v[124:127]
C v66,v96,v97
C v67,v98,v99
M v[124:127],a[168:171],a[88:91],v[124:127]
G v28,a20
G v29,a21
M v[128:131],a[160:163],a[32:35],v[128:131]
R a[168:171],v5,51200
R a[172:175],v6,51200
M v[128:131],a[164:167],a[36:39],v[128:131]
G v30,a22
G v31,a23
M v[132:135],a[164:167],a[44:47],v[132:135]
C v28,v28,v29
C v29,v30,v31
M v[132:135],a[160:163],a[40:43],v[132:135]
s_mov_b32 s25, 524416
C v30,v52,v53
C v31,v54,v55
M v[136:139],a[160:163],a[48:51],v[136:139]
SA m0,s4,57344
buffer_store_dwordx4 v[28:31], v7, s[8:11], s3 offen offset:2048 sc1
M v[136:139],a[164:167],a[52:55],v[136:139]
C v68,v68,v69
C v69,v70,v71
M v[140:143],a[164:167],a[60:63],v[140:143]
C v70,v100,v101
C v71,v102,v103
M v[140:143],a[160:163],a[56:59],v[140:143]
C v72,v72,v73
C v73,v74,v75
M v[144:147],a[160:163],a[64:67],v[144:147]
buffer_load_dwordx4 v8, s[52:55], s25 offen lds
M v[144:147],a[164:167],a[68:71],v[144:147]
C v74,v104,v105
C v75,v106,v107
M v[148:151],a[164:167],a[76:79],v[148:151]
C v76,v76,v77
C v77,v78,v79
M v[148:151],a[160:163],a[72:75],v[148:151]
C v78,v108,v109
C v79,v110,v111
M v[152:155],a[160:163],a[80:83],v[152:155]
C v80,v80,v81
C v81,v82,v83
M v[152:155],a[164:167],a[84:87],v[152:155]
s_waitcnt lgkmcnt(0)
C v82,v112,v113
C v83,v114,v115
M v[156:159],a[164:167],a[92:95],v[156:159]
s_mov_b32 s25, 786560
C v84,v84,v85
C v85,v86,v87
M v[156:159],a[160:163],a[88:91],v[156:159]
SA m0,s4,61440
C v86,v116,v117
C v87,v118,v119
M v[160:163],a[168:171],a[32:35],v[160:163]
R a[160:163],v5,53248
R a[164:167],v6,53248
M v[160:163],a[172:175],a[36:39],v[160:163]
buffer_load_dwordx4 v8, s[52:55], s25 offen lds
M v[164:167],a[172:175],a[44:47],v[164:167]
G v24,a24
G v25,a25
M v[164:167],a[168:171],a[40:43],v[164:167]
G v26,a26
G v27,a27
M v[168:171],a[168:171],a[48:51],v[168:171]
C v24,v24,v25
C v25,v26,v27
M v[168:171],a[172:175],a[52:55],v[168:171]
C v26,v56,v57
C v27,v58,v59
M v[172:175],a[172:175],a[60:63],v[172:175]
SA s3,s93,12288
buffer_store_dwordx4 v[24:27], v7, s[8:11], s3 offen offset:0 sc1
M v[172:175],a[168:171],a[56:59],v[172:175]
C v88,v88,v89
C v89,v90,v91
M v[176:179],a[168:171],a[64:67],v[176:179]
C v90,v120,v121
C v91,v122,v123
M v[176:179],a[172:175],a[68:71],v[176:179]
C v92,v92,v93
C v93,v94,v95
M v[180:183],a[172:175],a[76:79],v[180:183]
C v94,v124,v125
C v95,v126,v127
M v[180:183],a[168:171],a[72:75],v[180:183]
G v28,a28
G v29,a29
M v[184:187],a[168:171],a[80:83],v[184:187]
G v30,a30
G v31,a31
M v[184:187],a[172:175],a[84:87],v[184:187]
s_waitcnt lgkmcnt(0)
C v28,v28,v29
C v29,v30,v31
M v[188:191],a[172:175],a[92:95],v[188:191]
C v30,v60,v61
C v31,v62,v63
M v[188:191],a[168:171],a[88:91],v[188:191]
buffer_store_dwordx4 v[28:31], v7, s[8:11], s3 offen offset:2048 sc1
M v[192:195],a[160:163],a[32:35],v[192:195]
s_waitcnt vmcnt(18)
R a[168:171],v5,55296
R a[172:175],v6,55296
M v[192:195],a[164:167],a[36:39],v[192:195]
C v128,v128,v129
C v129,v130,v131
M v[196:199],a[164:167],a[44:47],v[196:199]
C v130,v160,v161
C v131,v162,v163
M v[196:199],a[160:163],a[40:43],v[196:199]
C v132,v132,v133
C v133,v134,v135
M v[200:203],a[160:163],a[48:51],v[200:203]
C v134,v164,v165
C v135,v166,v167
M v[200:203],a[164:167],a[52:55],v[200:203]
C v136,v136,v137
C v137,v138,v139
M v[204:207],a[164:167],a[60:63],v[204:207]
C v138,v168,v169
C v139,v170,v171
M v[204:207],a[160:163],a[56:59],v[204:207]
C v140,v140,v141
C v141,v142,v143
M v[208:211],a[160:163],a[64:67],v[208:211]
C v142,v172,v173
C v143,v174,v175
M v[208:211],a[164:167],a[68:71],v[208:211]
C v144,v144,v145
C v145,v146,v147
M v[212:215],a[164:167],a[76:79],v[212:215]
R a[128:131],v20,49152
R a[132:135],v20,51200
R a[136:139],v21,49152
R a[140:143],v21,51200
M v[212:215],a[160:163],a[72:75],v[212:215]
C v146,v176,v177
C v147,v178,v179
M v[216:219],a[160:163],a[80:83],v[216:219]
C v148,v148,v149
C v149,v150,v151
M v[216:219],a[164:167],a[84:87],v[216:219]
s_waitcnt lgkmcnt(4)
C v150,v180,v181
C v151,v182,v183
M v[220:223],a[164:167],a[92:95],v[220:223]
s_waitcnt vmcnt(10) lgkmcnt(0)
C v152,v152,v153
C v153,v154,v155
M v[220:223],a[160:163],a[88:91],v[220:223]
s_barrier
M v[224:227],a[168:171],a[32:35],v[224:227]
s_nop 0
T v[32:33],v16,0
T v[34:35],v16,2048
M v[224:227],a[172:175],a[36:39],v[224:227]
C v154,v184,v185
C v155,v186,v187
M v[228:231],a[172:175],a[44:47],v[228:231]
T v[36:37],v16,4096
T v[38:39],v16,6144
M v[228:231],a[168:171],a[40:43],v[228:231]
T v[40:41],v16,8192
T v[42:43],v16,10240
M v[232:235],a[168:171],a[48:51],v[232:235]
C v156,v156,v157
C v157,v158,v159
M v[232:235],a[172:175],a[52:55],v[232:235]
T v[44:45],v16,12288
T v[46:47],v16,14336
M v[236:239],a[172:175],a[60:63],v[236:239]
T v[48:49],v16,16384
T v[50:51],v16,18432
M v[236:239],a[168:171],a[56:59],v[236:239]
C v158,v188,v189
C v159,v190,v191
M v[240:243],a[168:171],a[64:67],v[240:243]
T v[52:53],v16,20480
T v[54:55],v16,22528
M v[240:243],a[172:175],a[68:71],v[240:243]
T v[56:57],v16,24576
T v[58:59],v16,26624
M v[244:247],a[172:175],a[76:79],v[244:247]
C v192,v192,v193
C v193,v194,v195
M v[244:247],a[168:171],a[72:75],v[244:247]
C v194,v224,v225
C v195,v226,v227
M v[248:251],a[168:171],a[80:83],v[248:251]
C v196,v196,v197
C v197,v198,v199
M v[248:251],a[172:175],a[84:87],v[248:251]
C v198,v228,v229
C v199,v230,v231
M v[252:255],a[172:175],a[92:95],v[252:255]
C v200,v200,v201
C v201,v202,v203
M v[252:255],a[168:171],a[88:91],v[252:255]
s_waitcnt lgkmcnt(6)
C v202,v232,v233
C v203,v234,v235
M v[96:99],v[32:35],a[176:179],0
s_mul_i32 s72, s41, 4352
T a[144:145],v17,0
T a[146:147],v17,2048
M v[96:99],v[36:39],a[184:187],v[96:99]
s_mov_b32 s25, 1048704
C v204,v204,v205
C v205,v206,v207
M v[96:99],v[40:43],a[192:195],v[96:99]
s_waitcnt lgkmcnt(2)
T a[148:149],v17,4096
T a[150:151],v17,6144
M v[96:99],v[44:47],a[200:203],v[96:99]
SA m0,s4,98304
T a[152:153],v17,8192
T a[154:155],v17,10240
M v[96:99],v[48:51],a[208:211],v[96:99]
SA s46,s72,104923136
buffer_load_dwordx4 v8, s[52:55], s25 offen lds
M v[96:99],v[52:55],a[216:219],v[96:99]
s_lshl_b32 s45, s42, 7
T a[156:157],v17,12288
T a[158:159],v17,14336
M v[96:99],v[56:59],a[224:227],v[96:99]
s_mov_b32 s25, 1310848
T a[160:161],v17,16384
T a[162:163],v17,18432
M v[100:103],v[56:59],a[228:231],0
SA m0,s4,102400
C v206,v236,v237
C v207,v238,v239
M v[100:103],v[52:55],a[220:223],v[100:103]
SA s45,s45,s46
T a[164:165],v17,20480
T a[166:167],v17,22528
M v[100:103],v[48:51],a[212:215],v[100:103]
s_lshl_b32 s72, s20, 2
T a[168:169],v17,24576
T a[170:171],v17,26624
M v[100:103],v[44:47],a[204:207],v[100:103]
SA s72,s72,s45
buffer_load_dwordx4 v8, s[52:55], s25 offen lds
M v[100:103],v[40:43],a[196:199],v[100:103]
C v208,v208,v209
C v209,v210,v211
M v[100:103],v[36:39],a[188:191],v[100:103]
s_mov_b32 s25, 1572992
C v210,v240,v241
C v211,v242,v243
M v[100:103],v[32:35],a[180:183],v[100:103]
s_waitcnt lgkmcnt(6)
C v212,v212,v213
C v213,v214,v215
M v[104:107],a[144:147],a[176:179],0
SA m0,s4,106496
T v[32:33],v18,0
T v[34:35],v18,2048
M v[104:107],a[148:151],a[184:187],v[104:107]
buffer_load_dwordx4 v8, s[52:55], s25 offen lds
M v[104:107],a[152:155],a[192:195],v[104:107]
s_waitcnt lgkmcnt(2)
s_nop 0
T v[36:37],v18,4096
T v[38:39],v18,6144
M v[104:107],a[156:159],a[200:203],v[104:107]
s_mov_b32 s25, 1835136
T v[40:41],v18,8192
T v[42:43],v18,10240
M v[104:107],a[160:163],a[208:211],v[104:107]
SA m0,s4,110592
C v214,v244,v245
C v215,v246,v247
M v[104:107],a[164:167],a[216:219],v[104:107]
T v[44:45],v18,12288
T v[46:47],v18,14336
M v[104:107],a[168:171],a[224:227],v[104:107]
T v[48:49],v18,16384
T v[50:51],v18,18432
M v[108:111],a[168:171],a[228:231],0
buffer_load_dwordx4 v8, s[52:55], s25 offen lds
M v[108:111],a[164:167],a[220:223],v[108:111]
s_nop 0
T v[52:53],v18,20480
T v[54:55],v18,22528
M v[108:111],a[160:163],a[212:215],v[108:111]
s_mov_b32 s25, 2097280
T v[56:57],v18,24576
T v[58:59],v18,26624
M v[108:111],a[156:159],a[204:207],v[108:111]
SA m0,s4,114688
C v216,v216,v217
C v217,v218,v219
M v[108:111],a[152:155],a[196:199],v[108:111]
SA s3,s93,524288
buffer_load_dwordx4 v8, s[52:55], s25 offen lds
M v[108:111],a[148:151],a[188:191],v[108:111]
C v218,v248,v249
C v219,v250,v251
M v[108:111],a[144:147],a[180:183],v[108:111]
s_waitcnt lgkmcnt(6)
buffer_store_dwordx4 v[64:67], v7, s[8:11], s3 offen offset:0 sc1
M v[112:115],v[32:35],a[176:179],0
s_mov_b32 s25, 2359424
T a[144:145],v19,0
T a[146:147],v19,2048
M v[112:115],v[36:39],a[184:187],v[112:115]
SA m0,s4,118784
buffer_store_dwordx4 v[68:71], v7, s[8:11], s3 offen offset:2048 sc1
M v[112:115],v[40:43],a[192:195],v[112:115]
s_waitcnt lgkmcnt(2)
s_nop 0
T a[148:149],v19,4096
T a[150:151],v19,6144
M v[112:115],v[44:47],a[200:203],v[112:115]
T a[152:153],v19,8192
T a[154:155],v19,10240
M v[112:115],v[48:51],a[208:211],v[112:115]
buffer_load_dwordx4 v8, s[52:55], s25 offen lds
M v[112:115],v[52:55],a[216:219],v[112:115]
s_nop 0
T a[156:157],v19,12288
T a[158:159],v19,14336
M v[112:115],v[56:59],a[224:227],v[112:115]
s_mov_b32 s25, 2621568
T a[160:161],v19,16384
T a[162:163],v19,18432
M v[116:119],v[56:59],a[228:231],0
SA m0,s4,122880
C v220,v220,v221
C v221,v222,v223
M v[116:119],v[52:55],a[220:223],v[116:119]
T a[164:165],v19,20480
T a[166:167],v19,22528
M v[116:119],v[48:51],a[212:215],v[116:119]
T a[168:169],v19,24576
T a[170:171],v19,26624
M v[116:119],v[44:47],a[204:207],v[116:119]
buffer_load_dwordx4 v8, s[52:55], s25 offen lds
M v[116:119],v[40:43],a[196:199],v[116:119]
C v222,v252,v253
C v223,v254,v255
M v[116:119],v[36:39],a[188:191],v[116:119]
s_mov_b32 s25, 2883712
v_min_u32 v29, 1, v0
v_lshlrev_b32 v29, 29, v29
M v[116:119],v[32:35],a[180:183],v[116:119]
s_waitcnt lgkmcnt(6)
v_mov_b32 v30, 1
v_add_u32 v20, 0x10000, v16
M v[120:123],a[144:147],a[176:179],0
SA m0,s4,126976
T v[32:33],v16,28672
T v[34:35],v16,30720
M v[120:123],a[148:151],a[184:187],v[120:123]
s_waitcnt vmcnt(9)
buffer_load_dwordx4 v8, s[52:55], s25 offen lds
M v[120:123],a[152:155],a[192:195],v[120:123]
s_waitcnt lgkmcnt(2)
s_nop 0
T v[36:37],v12,0
T v[38:39],v12,2048
M v[120:123],a[156:159],a[200:203],v[120:123]
s_mov_b32 s25, 3145856
T v[40:41],v12,4096
T v[42:43],v12,6144
M v[120:123],a[160:163],a[208:211],v[120:123]
SA m0,s4,32768
buffer_store_dword v30, v29, s[8:11], s72 offen offset:4 sc1
M v[120:123],a[164:167],a[216:219],v[120:123]
s_nop 0
T v[44:45],v12,8192
T v[46:47],v12,10240
M v[120:123],a[168:171],a[224:227],v[120:123]
T v[48:49],v12,12288
T v[50:51],v12,14336
M v[124:127],a[168:171],a[228:231],0
buffer_load_dwordx4 v8, s[52:55], s25 offen lds
M v[124:127],a[164:167],a[220:223],v[124:127]
s_nop 0
T v[52:53],v12,16384
T v[54:55],v12,18432
M v[124:127],a[160:163],a[212:215],v[124:127]
s_mov_b32 s25, 3408000
T v[56:57],v12,20480
T v[58:59],v12,22528
M v[124:127],a[156:159],a[204:207],v[124:127]
SA m0,s4,36864
v_add_u32 v21, 0x10000, v17
v_add_u32 v22, 0x10000, v18
M v[124:127],a[152:155],a[196:199],v[124:127]
SA s3,s93,528384
buffer_load_dwordx4 v8, s[52:55], s25 offen lds
M v[124:127],a[148:151],a[188:191],v[124:127]
v_add_u32 v23, 0x10000, v19
v_or_b32 v1, s20, v0
M v[124:127],a[144:147],a[180:183],v[124:127]
s_waitcnt lgkmcnt(6)
buffer_store_dwordx4 v[72:75], v7, s[8:11], s3 offen offset:0 sc1
M v[96:99],v[32:35],a[232:235],v[96:99]
s_mov_b32 s25, 256
T a[144:145],v17,28672
T a[146:147],v17,30720
M v[96:99],v[36:39],a[96:99],v[96:99]
SA m0,s4,65536
v_min_u32 v1, 1, v1
v_lshlrev_b32 v1, 29, v1
M v[96:99],v[40:43],a[104:107],v[96:99]
s_waitcnt lgkmcnt(2)
T a[148:149],v13,0
T a[150:151],v13,2048
M v[96:99],v[44:47],a[112:115],v[96:99]
T a[152:153],v13,4096
T a[154:155],v13,6144
M v[96:99],v[48:51],a[120:123],v[96:99]
buffer_load_dwordx4 v8, s[52:55], s25 offen lds
M v[96:99],v[52:55],a[128:131],v[96:99]
s_nop 0
T a[156:157],v13,8192
T a[158:159],v13,10240
M v[96:99],v[56:59],a[136:139],v[96:99]
s_mov_b32 s25, 262400
T a[160:161],v13,12288
T a[162:163],v13,14336
M v[100:103],v[56:59],a[140:143],v[100:103]
SA m0,s4,69632
v_min_u32 v9, 15, v0
v_lshlrev_b32 v9, 7, v9
M v[100:103],v[52:55],a[132:135],v[100:103]
s_sub_u32 s66, 15, s42
T a[164:165],v13,16384
T a[166:167],v13,18432
M v[100:103],v[48:51],a[124:127],v[100:103]
s_max_u32 s67, s66, s42
T a[168:169],v13,20480
L_w_kv18:
s_cbranch_execz L_wd2
T a[170:171],v13,22528
M v[100:103],v[44:47],a[116:119],v[100:103]
s_min_u32 s66, s66, s42
buffer_load_dwordx4 v8, s[52:55], s25 offen lds
M v[100:103],v[40:43],a[108:111],v[100:103]
s_mul_i32 s21, s41, 1048576
M v[100:103],v[36:39],a[100:103],v[100:103]
s_mov_b32 s25, 524544
M v[100:103],v[32:35],a[236:239],v[100:103]
s_waitcnt lgkmcnt(6)
M v[104:107],a[144:147],a[232:235],v[104:107]
SA m0,s4,73728
T v[32:33],v18,28672
T v[34:35],v18,30720
M v[104:107],a[148:151],a[96:99],v[104:107]
s_lshl_b32 s64, s67, 16
buffer_load_dwordx4 v8, s[52:55], s25 offen lds
M v[104:107],a[152:155],a[104:107],v[104:107]
s_waitcnt lgkmcnt(2)
s_nop 0
T v[36:37],v14,0
T v[38:39],v14,2048
M v[104:107],a[156:159],a[112:115],v[104:107]
s_mov_b32 s25, 786688
T v[40:41],v14,4096
T v[42:43],v14,6144
M v[104:107],a[160:163],a[120:123],v[104:107]
SA m0,s4,77824
M v[104:107],a[164:167],a[128:131],v[104:107]
SA s32,s21,s64
T v[44:45],v14,8192
T v[46:47],v14,10240
M v[104:107],a[168:171],a[136:139],v[104:107]
s_lshl_b32 s64, s20, 14
T v[48:49],v14,12288
T v[50:51],v14,14336
M v[108:111],a[168:171],a[140:143],v[108:111]
SA s32,s32,s64
buffer_load_dwordx4 v8, s[52:55], s25 offen lds
M v[108:111],a[164:167],a[132:135],v[108:111]
SA s32,s32,33554432
T v[52:53],v14,16384
T v[54:55],v14,18432
M v[108:111],a[160:163],a[124:127],v[108:111]
s_mov_b32 s25, 1048832
T v[56:57],v14,20480
T v[58:59],v14,22528
M v[108:111],a[156:159],a[116:119],v[108:111]
s_sub_u32 s64, s42, 10
s_and_b32 s35, s64, 536870912
v_or_b32 v6, s35, v7
M v[108:111],a[152:155],a[108:111],v[108:111]
SA m0,s4,81920
MF v96,s5,v96
MF v97,s5,v97
M v[108:111],a[148:151],a[100:103],v[108:111]
s_lshl_b32 s28, s20, 13
buffer_load_dwordx4 v8, s[52:55], s25 offen lds
M v[108:111],a[144:147],a[236:239],v[108:111]
s_waitcnt lgkmcnt(6)
v_add_u32 v2, 0x10000, v7
v_add_u32 v3, s28, v7
M v[112:115],v[32:35],a[232:235],v[112:115]
s_mov_b32 s25, 1310976
T a[144:145],v19,28672
T a[146:147],v19,30720
M v[112:115],v[36:39],a[96:99],v[112:115]
SA m0,s4,86016
v_add_u32 v4, 0x1000, v3
MF v98,s5,v98
M v[112:115],v[40:43],a[104:107],v[112:115]
s_waitcnt lgkmcnt(2)
T a[148:149],v15,0
T a[150:151],v15,2048
M v[112:115],v[44:47],a[112:115],v[112:115]
s_lshl_b32 s64, s42, 16
T a[152:153],v15,4096
T a[154:155],v15,6144
M v[112:115],v[48:51],a[120:123],v[112:115]
SA s23,s21,s64
buffer_load_dwordx4 v8, s[52:55], s25 offen lds
M v[112:115],v[52:55],a[128:131],v[112:115]
SA s43,s23,16777216
T a[156:157],v15,8192
T a[158:159],v15,10240
M v[112:115],v[56:59],a[136:139],v[112:115]
s_mov_b32 s25, 1573120
T a[160:161],v15,12288
T a[162:163],v15,14336
M v[116:119],v[56:59],a[140:143],v[116:119]
SA m0,s4,90112
MF v99,s5,v99
MF v104,s5,v104
M v[116:119],v[52:55],a[132:135],v[116:119]
SA s26,s21,16777216
T a[164:165],v15,16384
T a[166:167],v15,18432
M v[116:119],v[48:51],a[124:127],v[116:119]
s_min_u32 s27, s42, 9
T a[168:169],v15,20480
T a[170:171],v15,22528
M v[116:119],v[44:47],a[116:119],v[116:119]
s_lshl_b32 s22, s27, 1
buffer_load_dwordx4 v8, s[52:55], s25 offen lds
M v[116:119],v[40:43],a[108:111],v[116:119]
s_sub_u32 s22, s22, 1
MF v105,s5,v105
MF v106,s5,v106
M v[116:119],v[36:39],a[100:103],v[116:119]
s_waitcnt vmcnt(8) lgkmcnt(0)
MF v107,s5,v107
C v96,v96,v97
M v[116:119],v[32:35],a[236:239],v[116:119]
s_barrier
M v[120:123],a[144:147],a[232:235],v[120:123]
s_mov_b32 s25, 1835264
T v[32:33],v16,49152
T v[34:35],v16,51200
M v[120:123],a[148:151],a[96:99],v[120:123]
SA m0,s4,94208
C v97,v98,v99
C v98,v104,v105
M v[120:123],a[152:155],a[104:107],v[120:123]
s_sub_u32 s27, s27, 2
T v[36:37],v16,53248
T v[38:39],v16,55296
M v[120:123],a[156:159],a[112:115],v[120:123]
s_mov_b32 s31, 0x4b800000
T v[40:41],v16,57344
T v[42:43],v16,59392
M v[120:123],a[160:163],a[120:123],v[120:123]
s_mov_b32 s24, 0x33800000
buffer_load_dwordx4 v8, s[52:55], s25 offen lds
M v[120:123],a[164:167],a[128:131],v[120:123]
s_lshl_b32 s47, s66, 7
T v[44:45],v16,61440
T v[46:47],v16,63488
M v[120:123],a[168:171],a[136:139],v[120:123]
s_mov_b32 s25, 2097408
T v[48:49],v20,32768
T v[50:51],v20,34816
M v[124:127],a[168:171],a[140:143],v[124:127]
SA m0,s4,155648
C v99,v106,v107
W a0,v96
M v[124:127],a[164:167],a[132:135],v[124:127]
SA s47,s47,s46
T v[52:53],v20,36864
T v[54:55],v20,38912
M v[124:127],a[160:163],a[124:127],v[124:127]
s_lshl_b32 s64, s20, 5
T v[56:57],v20,40960
T v[58:59],v20,43008
M v[124:127],a[156:159],a[116:119],v[124:127]
SA s47,s47,s64
buffer_load_dwordx4 v8, s[52:55], s25 offen lds
M v[124:127],a[152:155],a[108:111],v[124:127]
SA s47,s47,2048
W a1,v97
W a2,v98
M v[124:127],a[148:151],a[100:103],v[124:127]
s_lshl_b32 s65, s41, 3
W a3,v99
MF v100,s5,v100
M v[124:127],a[144:147],a[236:239],v[124:127]
s_waitcnt lgkmcnt(6)
MF v101,s5,v101
MF v102,s5,v102
M v[160:163],v[32:35],a[176:179],0
SA s65,s65,s66
T a[144:145],v17,49152
T a[146:147],v17,51200
M v[160:163],v[36:39],a[184:187],v[160:163]
s_mul_i32 s34, s65, 73728
MF v103,s5,v103
MF v108,s5,v108
M v[160:163],v[40:43],a[192:195],v[160:163]
s_waitcnt lgkmcnt(2)
T a[148:149],v17,53248
T a[150:151],v17,55296
M v[160:163],v[44:47],a[200:203],v[160:163]
SA s34,s34,136314880
T a[152:153],v17,57344
T a[154:155],v17,59392
M v[160:163],v[48:51],a[208:211],v[160:163]
s_lshl_b32 s65, s42, 4
MF v109,s5,v109
MF v110,s5,v110
M v[160:163],v[52:55],a[216:219],v[160:163]
SA s65,s65,s41
T a[156:157],v17,61440
T a[158:159],v17,63488
M v[160:163],v[56:59],a[224:227],v[160:163]
s_mul_i32 s33, s65, 114688
T a[160:161],v21,32768
T a[162:163],v21,34816
M v[164:167],v[56:59],a[228:231],0
s_mul_i32 s65, s20, 28672
MF v111,s5,v111
C v100,v100,v101
M v[164:167],v[52:55],a[220:223],v[164:167]
SA s33,s33,s65
T a[164:165],v21,36864
T a[166:167],v21,38912
M v[164:167],v[48:51],a[212:215],v[164:167]
SA s33,s33,67108864
T a[168:169],v21,40960
T a[170:171],v21,43008
M v[164:167],v[44:47],a[204:207],v[164:167]
s_mov_b32 s6, 0
C v101,v102,v103
C v102,v108,v109
M v[164:167],v[40:43],a[196:199],v[164:167]
s_mov_b32 s7, 1
C v103,v110,v111
W a32,v100
M v[164:167],v[36:39],a[188:191],v[164:167]
s_mov_b32 s40, 1
W a33,v101
W a34,v102
M v[164:167],v[32:35],a[180:183],v[164:167]
s_waitcnt lgkmcnt(6)
W a35,v103
MF v112,s5,v112
M v[168:171],a[144:147],a[176:179],0
s_cmp_eq_u32 s20, 0
T v[32:33],v18,49152
T v[34:35],v18,51200
M v[168:171],a[148:151],a[184:187],v[168:171]
s_cselect_b32 s39, 6, 4
MF v113,s5,v113
MF v114,s5,v114
M v[168:171],a[152:155],a[192:195],v[168:171]
s_waitcnt lgkmcnt(2)
T v[36:37],v18,53248
T v[38:39],v18,55296
M v[168:171],a[156:159],a[200:203],v[168:171]
s_mov_b64 s[60:61], s[76:77]
T v[40:41],v18,57344
T v[42:43],v18,59392
M v[168:171],a[160:163],a[208:211],v[168:171]
s_mov_b32 s62, s78
MF v115,s5,v115
MF v120,s5,v120
M v[168:171],a[164:167],a[216:219],v[168:171]
s_mov_b32 s63, 0x20000
T v[44:45],v18,61440
T v[46:47],v18,63488
M v[168:171],a[168:171],a[224:227],v[168:171]
SA s30,s32,0
T v[48:49],v22,32768
T v[50:51],v22,34816
M v[172:175],a[168:171],a[228:231],0
s_mov_b32 s25, 2359552
buffer_store_dwordx4 a[0:3], v6, s[8:11], s30 offen offset:0 sc1
M v[172:175],a[164:167],a[220:223],v[172:175]
SA m0,s4,159744
T v[52:53],v22,36864
T v[54:55],v22,38912
M v[172:175],a[160:163],a[212:215],v[172:175]
SA s3,s93,528384
T v[56:57],v22,40960
T v[58:59],v22,43008
M v[172:175],a[156:159],a[204:207],v[172:175]
buffer_load_dwordx4 v8, s[52:55], s25 offen lds
M v[172:175],a[152:155],a[196:199],v[172:175]
v_lshrrev_b32 v24, 4, v0
v_lshlrev_b32 v24, 2, v24
M v[172:175],a[148:151],a[188:191],v[172:175]
s_mov_b32 s25, 2621696
buffer_store_dwordx4 v[76:79], v7, s[8:11], s3 offen offset:2048 sc1
M v[172:175],a[144:147],a[180:183],v[172:175]
s_waitcnt lgkmcnt(6)
v_and_b32 v25, 15, v0
v_sub_u32 v24, v24, v25
M v[176:179],v[32:35],a[176:179],0
SA m0,s4,131072
T a[144:145],v19,49152
T a[146:147],v19,51200
M v[176:179],v[36:39],a[184:187],v[176:179]
buffer_load_dwordx4 v8, s[52:55], s25 offen lds
M v[176:179],v[40:43],a[192:195],v[176:179]
s_waitcnt lgkmcnt(2)
s_nop 0
T a[148:149],v19,53248
T a[150:151],v19,55296
M v[176:179],v[44:47],a[200:203],v[176:179]
s_mov_b32 s25, 2883840
T a[152:153],v19,57344
T a[154:155],v19,59392
M v[176:179],v[48:51],a[208:211],v[176:179]
SA m0,s4,135168
v_cmp_lt_i32 s[16:17], 0, v24
v_cmp_lt_i32 s[18:19], -1, v24
M v[176:179],v[52:55],a[216:219],v[176:179]
T a[156:157],v19,61440
T a[158:159],v19,63488
M v[176:179],v[56:59],a[224:227],v[176:179]
T a[160:161],v23,32768
T a[162:163],v23,34816
M v[180:183],v[56:59],a[228:231],0
buffer_load_dwordx4 v8, s[52:55], s25 offen lds
M v[180:183],v[52:55],a[220:223],v[180:183]
s_nop 0
T a[164:165],v23,36864
T a[166:167],v23,38912
M v[180:183],v[48:51],a[212:215],v[180:183]
s_mov_b32 s25, 3145984
T a[168:169],v23,40960
T a[170:171],v23,43008
M v[180:183],v[44:47],a[204:207],v[180:183]
SA m0,s4,139264
v_cmp_lt_i32 s[48:49], -2, v24
v_cmp_lt_i32 s[50:51], -3, v24
M v[180:183],v[40:43],a[196:199],v[180:183]
buffer_load_dwordx4 v8, s[52:55], s25 offen lds
M v[180:183],v[36:39],a[188:191],v[180:183]
v_lshl_add_u32 v25, v0, 7, s95
v_and_b32 v0, 48, v0
M v[180:183],v[32:35],a[180:183],v[180:183]
s_waitcnt lgkmcnt(6)
MF v121,s5,v121
MF v122,s5,v122
M v[184:187],a[144:147],a[176:179],0
s_mov_b32 s25, 3408128
T v[32:33],v20,45056
T v[34:35],v20,47104
M v[184:187],a[148:151],a[184:187],v[184:187]
SA m0,s4,143360
MF v123,s5,v123
C v112,v112,v113
M v[184:187],a[152:155],a[192:195],v[184:187]
s_waitcnt lgkmcnt(2)
T v[36:37],v20,49152
T v[38:39],v20,51200
M v[184:187],a[156:159],a[200:203],v[184:187]
SA s30,s32,8192
T v[40:41],v20,53248
T v[42:43],v20,55296
M v[184:187],a[160:163],a[208:211],v[184:187]
buffer_store_dwordx4 a[32:35], v6, s[8:11], s30 offen offset:0 sc1
M v[184:187],a[164:167],a[216:219],v[184:187]
s_nop 0
T v[44:45],v20,57344
T v[46:47],v20,59392
M v[184:187],a[168:171],a[224:227],v[184:187]
T v[48:49],v20,61440
T v[50:51],v20,63488
M v[188:191],a[168:171],a[228:231],0
buffer_load_dwordx4 v8, s[52:55], s25 offen lds
M v[188:191],a[164:167],a[220:223],v[188:191]
SA s3,s93,532480
T v[52:53],v16,32768
T v[54:55],v16,34816
M v[188:191],a[160:163],a[212:215],v[188:191]
s_mov_b32 s25, 384
T v[56:57],v16,36864
T v[58:59],v16,38912
M v[188:191],a[156:159],a[204:207],v[188:191]
SA m0,s4,0
buffer_store_dwordx4 v[80:83], v7, s[8:11], s3 offen offset:0 sc1
M v[188:191],a[152:155],a[196:199],v[188:191]
C v113,v114,v115
C v114,v120,v121
M v[188:191],a[148:151],a[188:191],v[188:191]
buffer_load_dwordx4 v8, s[52:55], s25 offen lds
M v[188:191],a[144:147],a[180:183],v[188:191]
s_waitcnt lgkmcnt(6)
C v115,v122,v123
W a4,v112
M v[160:163],v[32:35],a[232:235],v[160:163]
s_mov_b32 s25, 262528
T a[144:145],v21,45056
T a[146:147],v21,47104
M v[160:163],v[36:39],a[96:99],v[160:163]
SA m0,s4,4096
buffer_store_dwordx4 v[84:87], v7, s[8:11], s3 offen offset:2048 sc1
M v[160:163],v[40:43],a[104:107],v[160:163]
s_waitcnt lgkmcnt(2)
s_nop 0
T a[148:149],v21,49152
T a[150:151],v21,51200
M v[160:163],v[44:47],a[112:115],v[160:163]
T a[152:153],v21,53248
T a[154:155],v21,55296
M v[160:163],v[48:51],a[120:123],v[160:163]
buffer_load_dwordx4 v8, s[52:55], s25 offen lds
M v[160:163],v[52:55],a[128:131],v[160:163]
s_nop 0
T a[156:157],v21,57344
T a[158:159],v21,59392
M v[160:163],v[56:59],a[136:139],v[160:163]
s_mov_b32 s25, 524672
T a[160:161],v21,61440
T a[162:163],v21,63488
M v[164:167],v[56:59],a[140:143],v[164:167]
SA m0,s4,8192
W a5,v113
W a6,v114
M v[164:167],v[52:55],a[132:135],v[164:167]
T a[164:165],v17,32768
T a[166:167],v17,34816
M v[164:167],v[48:51],a[124:127],v[164:167]
T a[168:169],v17,36864
T a[170:171],v17,38912
M v[164:167],v[44:47],a[116:119],v[164:167]
buffer_load_dwordx4 v8, s[52:55], s25 offen lds
M v[164:167],v[40:43],a[108:111],v[164:167]
W a7,v115
v_lshl_add_u32 v0, v0, 24, v25
M v[164:167],v[36:39],a[100:103],v[164:167]
s_mov_b32 s25, 786816
v_mov_b32 v24, 0x3f80
MF v116,s5,v116
M v[164:167],v[32:35],a[236:239],v[164:167]
s_waitcnt lgkmcnt(6)
MF v117,s5,v117
MF v118,s5,v118
M v[168:171],a[144:147],a[232:235],v[168:171]
SA s30,s32,0
T v[32:33],v22,45056
T v[34:35],v22,47104
M v[168:171],a[148:151],a[96:99],v[168:171]
SA m0,s4,12288
buffer_store_dwordx4 a[4:7], v6, s[8:11], s30 offen offset:1024 sc1
M v[168:171],a[152:155],a[104:107],v[168:171]
s_waitcnt lgkmcnt(2)
s_nop 0
T v[36:37],v22,49152
T v[38:39],v22,51200
M v[168:171],a[156:159],a[112:115],v[168:171]
T v[40:41],v22,53248
T v[42:43],v22,55296
M v[168:171],a[160:163],a[120:123],v[168:171]
buffer_load_dwordx4 v8, s[52:55], s25 offen lds
M v[168:171],a[164:167],a[128:131],v[168:171]
s_nop 0
T v[44:45],v22,57344
T v[46:47],v22,59392
M v[168:171],a[168:171],a[136:139],v[168:171]
s_mov_b32 s25, 1048960
T v[48:49],v22,61440
T v[50:51],v22,63488
M v[172:175],a[168:171],a[140:143],v[172:175]
SA m0,s4,16384
MF v119,s5,v119
MF v124,s5,v124
M v[172:175],a[164:167],a[132:135],v[172:175]
T v[52:53],v18,32768
T v[54:55],v18,34816
M v[172:175],a[160:163],a[124:127],v[172:175]
T v[56:57],v18,36864
T v[58:59],v18,38912
M v[172:175],a[156:159],a[116:119],v[172:175]
buffer_load_dwordx4 v8, s[52:55], s25 offen lds
M v[172:175],a[152:155],a[108:111],v[172:175]
MF v125,s5,v125
MF v126,s5,v126
M v[172:175],a[148:151],a[100:103],v[172:175]
s_mov_b32 s25, 1311104
v_lshrrev_b32 v25, 8, v7
v_bfe_u32 v26, v7, 6, 2
v_and_b32 v27, 16, v7
v_lshlrev_b32 v27, v27, v24
v_cmp_eq_u32 vcc, v25, v26
v_and_b32 v28, 32, v7
W a244,0
v_cndmask_b32 v27, 0, v27, vcc
v_cmp_eq_u32 vcc, 0, v28
W a245,0
W a248,0
v_cndmask_b32 v25, 0, v27, vcc
v_sub_u32 v26, v27, v25
W a249,0
W a246,v25
W a247,v26
M v[172:175],a[144:147],a[236:239],v[172:175]
s_waitcnt lgkmcnt(6)
MF v127,s5,v127
C v116,v116,v117
M v[176:179],v[32:35],a[232:235],v[176:179]
SA m0,s4,20480
T a[144:145],v23,45056
T a[146:147],v23,47104
M v[176:179],v[36:39],a[96:99],v[176:179]
buffer_load_dwordx4 v8, s[52:55], s25 offen lds
M v[176:179],v[40:43],a[104:107],v[176:179]
s_waitcnt lgkmcnt(2)
s_nop 0
T a[148:149],v23,49152
T a[150:151],v23,51200
M v[176:179],v[44:47],a[112:115],v[176:179]
s_mov_b32 s25, 1573248
T a[152:153],v23,53248
T a[154:155],v23,55296
M v[176:179],v[48:51],a[120:123],v[176:179]
SA m0,s4,24576
C v117,v118,v119
C v118,v124,v125
M v[176:179],v[52:55],a[128:131],v[176:179]
T a[156:157],v23,57344
T a[158:159],v23,59392
M v[176:179],v[56:59],a[136:139],v[176:179]
T a[160:161],v23,61440
T a[162:163],v23,63488
M v[180:183],v[56:59],a[140:143],v[180:183]
buffer_load_dwordx4 v8, s[52:55], s25 offen lds
M v[180:183],v[52:55],a[132:135],v[180:183]
s_nop 0
T a[164:165],v19,32768
T a[166:167],v19,34816
M v[180:183],v[48:51],a[124:127],v[180:183]
s_mov_b32 s25, 1835392
T a[168:169],v19,36864
T a[170:171],v19,38912
M v[180:183],v[44:47],a[116:119],v[180:183]
SA m0,s4,28672
C v119,v126,v127
W a36,v116
M v[180:183],v[40:43],a[108:111],v[180:183]
buffer_load_dwordx4 v8, s[52:55], s25 offen lds
M v[180:183],v[36:39],a[100:103],v[180:183]
s_waitcnt vmcnt(11) lgkmcnt(0)
W a37,v117
W a38,v118
M v[180:183],v[32:35],a[236:239],v[180:183]
s_barrier
M v[184:187],a[144:147],a[232:235],v[184:187]
s_mov_b32 s25, 2097536
T v[32:33],v20,0
T v[34:35],v20,2048
M v[184:187],a[148:151],a[96:99],v[184:187]
SA m0,s4,40960
W a39,v119
MF v160,s5,v160
M v[184:187],a[152:155],a[104:107],v[184:187]
SA s30,s32,8192
T v[36:37],v20,4096
T v[38:39],v20,6144
M v[184:187],a[156:159],a[112:115],v[184:187]
T v[40:41],v20,8192
T v[42:43],v20,10240
M v[184:187],a[160:163],a[120:123],v[184:187]
buffer_store_dwordx4 a[36:39], v6, s[8:11], s30 offen offset:1024 sc1
M v[184:187],a[164:167],a[128:131],v[184:187]
s_nop 0
T v[44:45],v20,12288
T v[46:47],v20,14336
M v[184:187],a[168:171],a[136:139],v[184:187]
T v[48:49],v20,16384
T v[50:51],v20,18432
M v[188:191],a[168:171],a[140:143],v[188:191]
buffer_load_dwordx4 v8, s[52:55], s25 offen lds
M v[188:191],a[164:167],a[132:135],v[188:191]
s_nop 0
T v[52:53],v20,20480
T v[54:55],v20,22528
M v[188:191],a[160:163],a[124:127],v[188:191]
s_mov_b32 s25, 2359680
T v[56:57],v20,24576
T v[58:59],v20,26624
M v[188:191],a[156:159],a[116:119],v[188:191]
SA m0,s4,45056
MF v161,s5,v161
MF v162,s5,v162
M v[188:191],a[152:155],a[108:111],v[188:191]
buffer_load_dwordx4 v8, s[52:55], s25 offen lds
M v[188:191],a[148:151],a[100:103],v[188:191]
MF v163,s5,v163
MF v168,s5,v168
M v[188:191],a[144:147],a[236:239],v[188:191]
s_waitcnt lgkmcnt(6)
MF v169,s5,v169
MF v170,s5,v170
M v[96:99],v[32:35],a[176:179],0
s_mov_b32 s25, 2621824
T a[144:145],v21,0
T a[146:147],v21,2048
M v[96:99],v[36:39],a[184:187],v[96:99]
SA m0,s4,49152
MF v171,s5,v171
C v160,v160,v161
M v[96:99],v[40:43],a[192:195],v[96:99]
s_waitcnt lgkmcnt(2)
T a[148:149],v21,4096
T a[150:151],v21,6144
M v[96:99],v[44:47],a[200:203],v[96:99]
T a[152:153],v21,8192
T a[154:155],v21,10240
M v[96:99],v[48:51],a[208:211],v[96:99]
buffer_load_dwordx4 v8, s[52:55], s25 offen lds
M v[96:99],v[52:55],a[216:219],v[96:99]
s_nop 0
T a[156:157],v21,12288
T a[158:159],v21,14336
M v[96:99],v[56:59],a[224:227],v[96:99]
s_mov_b32 s25, 2883968
T a[160:161],v21,16384
T a[162:163],v21,18432
M v[100:103],v[56:59],a[228:231],0
SA m0,s4,53248
C v161,v162,v163
C v162,v168,v169
M v[100:103],v[52:55],a[220:223],v[100:103]
T a[164:165],v21,20480
T a[166:167],v21,22528
M v[100:103],v[48:51],a[212:215],v[100:103]
T a[168:169],v21,24576
T a[170:171],v21,26624
M v[100:103],v[44:47],a[204:207],v[100:103]
SA s3,s93,536576
buffer_load_dwordx4 v8, s[52:55], s25 offen lds
M v[100:103],v[40:43],a[196:199],v[100:103]
C v163,v170,v171
W a8,v160
M v[100:103],v[36:39],a[188:191],v[100:103]
s_mov_b32 s25, 3146112
W a9,v161
W a10,v162
M v[100:103],v[32:35],a[180:183],v[100:103]
s_waitcnt lgkmcnt(6)
W a11,v163
v_lshrrev_b32 v31, 6, v7
M v[104:107],a[144:147],a[176:179],0
SA s30,s32,0
T v[32:33],v22,0
T v[34:35],v22,2048
M v[104:107],a[148:151],a[184:187],v[104:107]
SA m0,s4,57344
buffer_store_dwordx4 a[8:11], v6, s[8:11], s30 offen offset:2048 sc1
M v[104:107],a[152:155],a[192:195],v[104:107]
s_waitcnt lgkmcnt(2)
s_nop 0
T v[36:37],v22,4096
T v[38:39],v22,6144
M v[104:107],a[156:159],a[200:203],v[104:107]
T v[40:41],v22,8192
T v[42:43],v22,10240
M v[104:107],a[160:163],a[208:211],v[104:107]
buffer_load_dwordx4 v8, s[52:55], s25 offen lds
M v[104:107],a[164:167],a[216:219],v[104:107]
s_nop 0
T v[44:45],v22,12288
T v[46:47],v22,14336
M v[104:107],a[168:171],a[224:227],v[104:107]
s_mov_b32 s25, 3408256
T v[48:49],v22,16384
T v[50:51],v22,18432
M v[108:111],a[168:171],a[228:231],0
SA m0,s4,61440
buffer_store_dwordx4 v[88:91], v7, s[8:11], s3 offen offset:0 sc1
M v[108:111],a[164:167],a[220:223],v[108:111]
s_nop 0
T v[52:53],v22,20480
T v[54:55],v22,22528
M v[108:111],a[160:163],a[212:215],v[108:111]
T v[56:57],v22,24576
T v[58:59],v22,26624
M v[108:111],a[156:159],a[204:207],v[108:111]
buffer_load_dwordx4 v8, s[52:55], s25 offen lds
M v[108:111],a[152:155],a[196:199],v[108:111]
v_bfe_u32 v28, v7, 4, 2
v_lshlrev_b32 v31, 5, v31
M v[108:111],a[148:151],a[188:191],v[108:111]
buffer_store_dwordx4 v[92:95], v7, s[8:11], s3 offen offset:2048 sc1
M v[108:111],a[144:147],a[180:183],v[108:111]
s_waitcnt lgkmcnt(6)
v_add_lshl_u32 v31, v31, v28, 2
MF v164,s5,v164
M v[112:115],v[32:35],a[176:179],0
T a[144:145],v23,0
T a[146:147],v23,2048
M v[112:115],v[36:39],a[184:187],v[112:115]
buffer_load_dword v5, v31, s[8:11], s46 offen offset:4 sc1
M v[112:115],v[40:43],a[192:195],v[112:115]
s_waitcnt lgkmcnt(2)
s_nop 0
T a[148:149],v23,4096
T a[150:151],v23,6144
M v[112:115],v[44:47],a[200:203],v[112:115]
T a[152:153],v23,8192
T a[154:155],v23,10240
M v[112:115],v[48:51],a[208:211],v[112:115]
MF v165,s5,v165
MF v166,s5,v166
M v[112:115],v[52:55],a[216:219],v[112:115]
T a[156:157],v23,12288
T a[158:159],v23,14336
M v[112:115],v[56:59],a[224:227],v[112:115]
T a[160:161],v23,16384
T a[162:163],v23,18432
M v[116:119],v[56:59],a[228:231],0
MF v167,s5,v167
MF v172,s5,v172
M v[116:119],v[52:55],a[220:223],v[116:119]
T a[164:165],v23,20480
T a[166:167],v23,22528
M v[116:119],v[48:51],a[212:215],v[116:119]
T a[168:169],v23,24576
T a[170:171],v23,26624
M v[116:119],v[44:47],a[204:207],v[116:119]
MF v173,s5,v173
MF v174,s5,v174
M v[116:119],v[40:43],a[196:199],v[116:119]
MF v175,s5,v175
C v164,v164,v165
M v[116:119],v[36:39],a[188:191],v[116:119]
C v165,v166,v167
C v166,v172,v173
M v[116:119],v[32:35],a[180:183],v[116:119]
s_waitcnt lgkmcnt(6)
C v167,v174,v175
W a40,v164
M v[120:123],a[144:147],a[176:179],0
T v[32:33],v20,28672
T v[34:35],v20,30720
M v[120:123],a[148:151],a[184:187],v[120:123]
W a41,v165
W a42,v166
M v[120:123],a[152:155],a[192:195],v[120:123]
s_waitcnt lgkmcnt(2)
T v[36:37],v12,24576
T v[38:39],v12,26624
M v[120:123],a[156:159],a[200:203],v[120:123]
T v[40:41],v12,28672
T v[42:43],v12,30720
M v[120:123],a[160:163],a[208:211],v[120:123]
W a43,v167
v_mov_b32 v8, 0xff800000
M v[120:123],a[164:167],a[216:219],v[120:123]
SA s30,s32,8192
T v[44:45],v12,0
T v[46:47],v12,2048
M v[120:123],a[168:171],a[224:227],v[120:123]
T v[48:49],v12,4096
T v[50:51],v12,6144
M v[124:127],a[168:171],a[228:231],0
buffer_store_dwordx4 a[40:43], v6, s[8:11], s30 offen offset:2048 sc1
M v[124:127],a[164:167],a[220:223],v[124:127]
s_nop 0
T v[52:53],v12,8192
T v[54:55],v12,10240
M v[124:127],a[160:163],a[212:215],v[124:127]
T v[56:57],v12,12288
T v[58:59],v12,14336
M v[124:127],a[156:159],a[204:207],v[124:127]
MF v176,s5,v176
MF v177,s5,v177
M v[124:127],a[152:155],a[196:199],v[124:127]
MF v178,s5,v178
MF v179,s5,v179
M v[124:127],a[148:151],a[188:191],v[124:127]
MF v184,s5,v184
MF v185,s5,v185
M v[124:127],a[144:147],a[180:183],v[124:127]
s_waitcnt lgkmcnt(6)
MF v186,s5,v186
MF v187,s5,v187
M v[96:99],v[32:35],a[232:235],v[96:99]
T a[144:145],v21,28672
T a[146:147],v21,30720
M v[96:99],v[36:39],a[96:99],v[96:99]
C v176,v176,v177
C v177,v178,v179
M v[96:99],v[40:43],a[104:107],v[96:99]
s_waitcnt lgkmcnt(2)
T a[148:149],v13,24576
T a[150:151],v13,26624
M v[96:99],v[44:47],a[112:115],v[96:99]
T a[152:153],v13,28672
T a[154:155],v13,30720
M v[96:99],v[48:51],a[120:123],v[96:99]
C v178,v184,v185
C v179,v186,v187
M v[96:99],v[52:55],a[128:131],v[96:99]
T a[156:157],v13,0
T a[158:159],v13,2048
M v[96:99],v[56:59],a[136:139],v[96:99]
T a[160:161],v13,4096
T a[162:163],v13,6144
M v[100:103],v[56:59],a[140:143],v[100:103]
W a12,v176
W a13,v177
M v[100:103],v[52:55],a[132:135],v[100:103]
T a[164:165],v13,8192
T a[166:167],v13,10240
M v[100:103],v[48:51],a[124:127],v[100:103]
T a[168:169],v13,12288
T a[170:171],v13,14336
M v[100:103],v[44:47],a[116:119],v[100:103]
W a14,v178
W a15,v179
M v[100:103],v[40:43],a[108:111],v[100:103]
MF v180,s5,v180
MF v181,s5,v181
M v[100:103],v[36:39],a[100:103],v[100:103]
MF v182,s5,v182
MF v183,s5,v183
M v[100:103],v[32:35],a[236:239],v[100:103]
s_waitcnt lgkmcnt(6)
MF v188,s5,v188
MF v189,s5,v189
M v[104:107],a[144:147],a[232:235],v[104:107]
T v[32:33],v22,28672
T v[34:35],v22,30720
M v[104:107],a[148:151],a[96:99],v[104:107]
MF v190,s5,v190
MF v191,s5,v191
M v[104:107],a[152:155],a[104:107],v[104:107]
s_waitcnt lgkmcnt(2)
T v[36:37],v14,24576
T v[38:39],v14,26624
M v[104:107],a[156:159],a[112:115],v[104:107]
SA s30,s32,0
T v[40:41],v14,28672
T v[42:43],v14,30720
M v[104:107],a[160:163],a[120:123],v[104:107]
buffer_store_dwordx4 a[12:15], v6, s[8:11], s30 offen offset:3072 sc1
M v[104:107],a[164:167],a[128:131],v[104:107]
s_nop 0
T v[44:45],v14,0
T v[46:47],v14,2048
M v[104:107],a[168:171],a[136:139],v[104:107]
T v[48:49],v14,4096
T v[50:51],v14,6144
M v[108:111],a[168:171],a[140:143],v[108:111]
C v180,v180,v181
C v181,v182,v183
M v[108:111],a[164:167],a[132:135],v[108:111]
T v[52:53],v14,8192
T v[54:55],v14,10240
M v[108:111],a[160:163],a[124:127],v[108:111]
T v[56:57],v14,12288
T v[58:59],v14,14336
M v[108:111],a[156:159],a[116:119],v[108:111]
C v182,v188,v189
C v183,v190,v191
M v[108:111],a[152:155],a[108:111],v[108:111]
W a44,v180
W a45,v181
M v[108:111],a[148:151],a[100:103],v[108:111]
W a46,v182
W a47,v183
M v[108:111],a[144:147],a[236:239],v[108:111]
s_waitcnt lgkmcnt(6)
s_waitcnt vmcnt(2)
v_cmp_ne_u32 vcc, 1, v5
MF v96,s5,v96
M v[112:115],v[32:35],a[232:235],v[112:115]
s_nop 0
T a[144:145],v23,28672
T a[146:147],v23,30720
M v[112:115],v[36:39],a[96:99],v[112:115]
s_cmp_lg_u32 vcc_lo, 0
MF v97,s5,v97
MF v98,s5,v98
M v[112:115],v[40:43],a[104:107],v[112:115]
s_waitcnt lgkmcnt(2)
T a[148:149],v15,24576
T a[150:151],v15,26624
M v[112:115],v[44:47],a[112:115],v[112:115]
s_cbranch_scc1 L_wsq1
L_wrq1:
T a[152:153],v15,28672
T a[154:155],v15,30720
M v[112:115],v[48:51],a[120:123],v[112:115]
SA m0,s28,98304
MF v99,s5,v99
MF v104,s5,v104
M v[112:115],v[52:55],a[128:131],v[112:115]
T a[156:157],v15,0
T a[158:159],v15,2048
M v[112:115],v[56:59],a[136:139],v[112:115]
T a[160:161],v15,4096
T a[162:163],v15,6144
M v[116:119],v[56:59],a[140:143],v[116:119]
buffer_load_dwordx4 v3, s[8:11], s21 offen offset:0 sc1 lds
M v[116:119],v[52:55],a[132:135],v[116:119]
s_nop 0
T a[164:165],v15,8192
T a[166:167],v15,10240
M v[116:119],v[48:51],a[124:127],v[116:119]
T a[168:169],v15,12288
T a[170:171],v15,14336
M v[116:119],v[44:47],a[116:119],v[116:119]
buffer_load_dwordx4 v3, s[8:11], s21 offen offset:1024 sc1 lds
M v[116:119],v[40:43],a[108:111],v[116:119]
MF v105,s5,v105
MF v106,s5,v106
M v[116:119],v[36:39],a[100:103],v[116:119]
s_waitcnt lgkmcnt(0)
buffer_load_dwordx4 v3, s[8:11], s21 offen offset:2048 sc1 lds
M v[116:119],v[32:35],a[236:239],v[116:119]
s_barrier
M v[120:123],a[144:147],a[232:235],v[120:123]
SA s30,s32,8192
T v[32:33],v16,0
T v[34:35],v16,2048
M v[120:123],a[148:151],a[96:99],v[120:123]
buffer_store_dwordx4 a[44:47], v6, s[8:11], s30 offen offset:3072 sc1
M v[120:123],a[152:155],a[104:107],v[120:123]
s_nop 0
T v[36:37],v16,4096
T v[38:39],v16,6144
M v[120:123],a[156:159],a[112:115],v[120:123]
T v[40:41],v16,8192
T v[42:43],v16,10240
M v[120:123],a[160:163],a[120:123],v[120:123]
buffer_load_dwordx4 v3, s[8:11], s21 offen offset:3072 sc1 lds
M v[120:123],a[164:167],a[128:131],v[120:123]
SA m0,s28,102400
T v[44:45],v16,12288
T v[46:47],v16,14336
M v[120:123],a[168:171],a[136:139],v[120:123]
T v[48:49],v16,16384
T v[50:51],v16,18432
M v[124:127],a[168:171],a[140:143],v[124:127]
buffer_load_dwordx4 v4, s[8:11], s21 offen offset:0 sc1 lds
M v[124:127],a[164:167],a[132:135],v[124:127]
s_nop 0
T v[52:53],v16,20480
T v[54:55],v16,22528
M v[124:127],a[160:163],a[124:127],v[124:127]
T v[56:57],v16,24576
T v[58:59],v16,26624
M v[124:127],a[156:159],a[116:119],v[124:127]
buffer_load_dwordx4 v4, s[8:11], s21 offen offset:1024 sc1 lds
M v[124:127],a[152:155],a[108:111],v[124:127]
MF v107,s5,v107
C v96,v96,v97
M v[124:127],a[148:151],a[100:103],v[124:127]
buffer_load_dwordx4 v4, s[8:11], s21 offen offset:2048 sc1 lds
M v[124:127],a[144:147],a[236:239],v[124:127]
s_waitcnt lgkmcnt(6)
C v97,v98,v99
C v98,v104,v105
M v[160:163],v[32:35],a[176:179],0
T a[144:145],v17,0
T a[146:147],v17,2048
M v[160:163],v[36:39],a[184:187],v[160:163]
buffer_load_dwordx4 v4, s[8:11], s21 offen offset:3072 sc1 lds
M v[160:163],v[40:43],a[192:195],v[160:163]
s_waitcnt lgkmcnt(2)
s_nop 0
T a[148:149],v17,4096
T a[150:151],v17,6144
M v[160:163],v[44:47],a[200:203],v[160:163]
SA s21,s21,32768
T a[152:153],v17,8192
T a[154:155],v17,10240
M v[160:163],v[48:51],a[208:211],v[160:163]
s_sub_u32 s22, s22, 1
C v99,v106,v107
W a16,v96
M v[160:163],v[52:55],a[216:219],v[160:163]
s_cselect_b32 s21, s23, s21
T a[156:157],v17,12288
T a[158:159],v17,14336
M v[160:163],v[56:59],a[224:227],v[160:163]
SA m0,s28,65536
T a[160:161],v17,16384
T a[162:163],v17,18432
M v[164:167],v[56:59],a[228:231],0
buffer_load_dwordx4 v3, s[8:11], s21 offen offset:0 sc1 lds
M v[164:167],v[52:55],a[220:223],v[164:167]
s_nop 0
T a[164:165],v17,20480
T a[166:167],v17,22528
M v[164:167],v[48:51],a[212:215],v[164:167]
T a[168:169],v17,24576
T a[170:171],v17,26624
M v[164:167],v[44:47],a[204:207],v[164:167]
buffer_load_dwordx4 v3, s[8:11], s21 offen offset:1024 sc1 lds
M v[164:167],v[40:43],a[196:199],v[164:167]
buffer_load_dword v5, v31, s[8:11], s46 offen offset:4 sc1
M v[164:167],v[36:39],a[188:191],v[164:167]
buffer_load_dwordx4 v3, s[8:11], s21 offen offset:2048 sc1 lds
M v[164:167],v[32:35],a[180:183],v[164:167]
s_waitcnt lgkmcnt(6)
W a17,v97
W a18,v98
M v[168:171],a[144:147],a[176:179],0
T v[32:33],v18,0
T v[34:35],v18,2048
M v[168:171],a[148:151],a[184:187],v[168:171]
buffer_load_dwordx4 v3, s[8:11], s21 offen offset:3072 sc1 lds
M v[168:171],a[152:155],a[192:195],v[168:171]
s_waitcnt lgkmcnt(2)
s_nop 0
T v[36:37],v18,4096
T v[38:39],v18,6144
M v[168:171],a[156:159],a[200:203],v[168:171]
SA m0,s28,69632
T v[40:41],v18,8192
T v[42:43],v18,10240
M v[168:171],a[160:163],a[208:211],v[168:171]
buffer_load_dwordx4 v4, s[8:11], s21 offen offset:0 sc1 lds
M v[168:171],a[164:167],a[216:219],v[168:171]
s_nop 0
T v[44:45],v18,12288
T v[46:47],v18,14336
M v[168:171],a[168:171],a[224:227],v[168:171]
T v[48:49],v18,16384
T v[50:51],v18,18432
M v[172:175],a[168:171],a[228:231],0
buffer_load_dwordx4 v4, s[8:11], s21 offen offset:1024 sc1 lds
M v[172:175],a[164:167],a[220:223],v[172:175]
s_nop 0
T v[52:53],v18,20480
T v[54:55],v18,22528
M v[172:175],a[160:163],a[212:215],v[172:175]
T v[56:57],v18,24576
T v[58:59],v18,26624
M v[172:175],a[156:159],a[204:207],v[172:175]
buffer_load_dwordx4 v4, s[8:11], s21 offen offset:2048 sc1 lds
M v[172:175],a[152:155],a[196:199],v[172:175]
W a19,v99
MF v100,s5,v100
M v[172:175],a[148:151],a[188:191],v[172:175]
SA s30,s32,4096
buffer_store_dwordx4 a[16:19], v6, s[8:11], s30 offen offset:0 sc1
M v[172:175],a[144:147],a[180:183],v[172:175]
s_waitcnt lgkmcnt(6)
MF v101,s5,v101
MF v102,s5,v102
M v[176:179],v[32:35],a[176:179],0
T a[144:145],v19,0
T a[146:147],v19,2048
M v[176:179],v[36:39],a[184:187],v[176:179]
buffer_load_dwordx4 v4, s[8:11], s21 offen offset:3072 sc1 lds
M v[176:179],v[40:43],a[192:195],v[176:179]
s_waitcnt lgkmcnt(2)
s_nop 0
T a[148:149],v19,4096
T a[150:151],v19,6144
M v[176:179],v[44:47],a[200:203],v[176:179]
SA s21,s21,32768
T a[152:153],v19,8192
T a[154:155],v19,10240
M v[176:179],v[48:51],a[208:211],v[176:179]
s_sub_u32 s22, s22, 1
MF v103,s5,v103
MF v108,s5,v108
M v[176:179],v[52:55],a[216:219],v[176:179]
s_cselect_b32 s21, s23, s21
T a[156:157],v19,12288
T a[158:159],v19,14336
M v[176:179],v[56:59],a[224:227],v[176:179]
T a[160:161],v19,16384
T a[162:163],v19,18432
M v[180:183],v[56:59],a[228:231],0
MF v109,s5,v109
MF v110,s5,v110
M v[180:183],v[52:55],a[220:223],v[180:183]
T a[164:165],v19,20480
T a[166:167],v19,22528
M v[180:183],v[48:51],a[212:215],v[180:183]
T a[168:169],v19,24576
T a[170:171],v19,26624
M v[180:183],v[44:47],a[204:207],v[180:183]
MF v111,s5,v111
C v100,v100,v101
M v[180:183],v[40:43],a[196:199],v[180:183]
C v101,v102,v103
C v102,v108,v109
M v[180:183],v[36:39],a[188:191],v[180:183]
C v103,v110,v111
W a48,v100
M v[180:183],v[32:35],a[180:183],v[180:183]
s_waitcnt lgkmcnt(6)
W a49,v101
W a50,v102
M v[184:187],a[144:147],a[176:179],0
T v[32:33],v16,28672
T v[34:35],v16,30720
M v[184:187],a[148:151],a[184:187],v[184:187]
W a51,v103
MF v112,s5,v112
M v[184:187],a[152:155],a[192:195],v[184:187]
s_waitcnt lgkmcnt(2)
T v[36:37],v16,40960
T v[38:39],v16,43008
M v[184:187],a[156:159],a[200:203],v[184:187]
T v[40:41],v16,45056
T v[42:43],v16,47104
M v[184:187],a[160:163],a[208:211],v[184:187]
MF v113,s5,v113
MF v114,s5,v114
M v[184:187],a[164:167],a[216:219],v[184:187]
T v[44:45],v16,49152
T v[46:47],v16,51200
M v[184:187],a[168:171],a[224:227],v[184:187]
T v[48:49],v16,53248
T v[50:51],v16,55296
M v[188:191],a[168:171],a[228:231],0
MF v115,s5,v115
MF v120,s5,v120
M v[188:191],a[164:167],a[220:223],v[188:191]
SA s30,s32,12288
T v[52:53],v16,57344
T v[54:55],v16,59392
M v[188:191],a[160:163],a[212:215],v[188:191]
T v[56:57],v16,61440
T v[58:59],v16,63488
M v[188:191],a[156:159],a[204:207],v[188:191]
buffer_store_dwordx4 a[48:51], v6, s[8:11], s30 offen offset:0 sc1
M v[188:191],a[152:155],a[196:199],v[188:191]
MF v121,s5,v121
MF v122,s5,v122
M v[188:191],a[148:151],a[188:191],v[188:191]
MF v123,s5,v123
C v112,v112,v113
M v[188:191],a[144:147],a[180:183],v[188:191]
s_waitcnt lgkmcnt(6)
C v113,v114,v115
C v114,v120,v121
M v[160:163],v[32:35],a[232:235],v[160:163]
T a[144:145],v17,28672
T a[146:147],v17,30720
M v[160:163],v[36:39],a[96:99],v[160:163]
C v115,v122,v123
W a20,v112
M v[160:163],v[40:43],a[104:107],v[160:163]
s_waitcnt lgkmcnt(2)
T a[148:149],v17,40960
T a[150:151],v17,43008
M v[160:163],v[44:47],a[112:115],v[160:163]
T a[152:153],v17,45056
T a[154:155],v17,47104
M v[160:163],v[48:51],a[120:123],v[160:163]
W a21,v113
W a22,v114
M v[160:163],v[52:55],a[128:131],v[160:163]
T a[156:157],v17,49152
T a[158:159],v17,51200
M v[160:163],v[56:59],a[136:139],v[160:163]
T a[160:161],v17,53248
T a[162:163],v17,55296
M v[164:167],v[56:59],a[140:143],v[164:167]
W a23,v115
MF v116,s5,v116
M v[164:167],v[52:55],a[132:135],v[164:167]
T a[164:165],v17,57344
T a[166:167],v17,59392
M v[164:167],v[48:51],a[124:127],v[164:167]
T a[168:169],v17,61440
T a[170:171],v17,63488
M v[164:167],v[44:47],a[116:119],v[164:167]
MF v117,s5,v117
MF v118,s5,v118
M v[164:167],v[40:43],a[108:111],v[164:167]
MF v119,s5,v119
MF v124,s5,v124
M v[164:167],v[36:39],a[100:103],v[164:167]
MF v125,s5,v125
MF v126,s5,v126
M v[164:167],v[32:35],a[236:239],v[164:167]
s_waitcnt lgkmcnt(6)
MF v127,s5,v127
C v116,v116,v117
M v[168:171],a[144:147],a[232:235],v[168:171]
T v[32:33],v18,28672
T v[34:35],v18,30720
M v[168:171],a[148:151],a[96:99],v[168:171]
C v117,v118,v119
C v118,v124,v125
M v[168:171],a[152:155],a[104:107],v[168:171]
s_waitcnt lgkmcnt(2)
T v[36:37],v18,40960
T v[38:39],v18,43008
M v[168:171],a[156:159],a[112:115],v[168:171]
T v[40:41],v18,45056
T v[42:43],v18,47104
M v[168:171],a[160:163],a[120:123],v[168:171]
C v119,v126,v127
W a52,v116
M v[168:171],a[164:167],a[128:131],v[168:171]
T v[44:45],v18,49152
T v[46:47],v18,51200
M v[168:171],a[168:171],a[136:139],v[168:171]
SA s30,s32,4096
T v[48:49],v18,53248
T v[50:51],v18,55296
M v[172:175],a[168:171],a[140:143],v[172:175]
buffer_store_dwordx4 a[20:23], v6, s[8:11], s30 offen offset:1024 sc1
M v[172:175],a[164:167],a[132:135],v[172:175]
s_nop 0
T v[52:53],v18,57344
T v[54:55],v18,59392
M v[172:175],a[160:163],a[124:127],v[172:175]
T v[56:57],v18,61440
T v[58:59],v18,63488
M v[172:175],a[156:159],a[116:119],v[172:175]
W a53,v117
W a54,v118
M v[172:175],a[152:155],a[108:111],v[172:175]
W a55,v119
s_waitcnt vmcnt(9)
v_cmp_ne_u32 vcc, 1, v5
M v[172:175],a[148:151],a[100:103],v[172:175]
s_nop 0
MF v160,s5,v160
MF v161,s5,v161
M v[172:175],a[144:147],a[236:239],v[172:175]
s_waitcnt lgkmcnt(6)
MF v162,s5,v162
MF v163,s5,v163
M v[176:179],v[32:35],a[232:235],v[176:179]
s_cmp_lg_u32 vcc_hi, 0
T a[144:145],v19,28672
T a[146:147],v19,30720
M v[176:179],v[36:39],a[96:99],v[176:179]
s_cbranch_scc1 L_wsr1
L_wrr1:
MF v168,s5,v168
MF v169,s5,v169
M v[176:179],v[40:43],a[104:107],v[176:179]
s_waitcnt lgkmcnt(2)
T a[148:149],v19,40960
T a[150:151],v19,43008
M v[176:179],v[44:47],a[112:115],v[176:179]
SA m0,s28,131072
T a[152:153],v19,45056
T a[154:155],v19,47104
M v[176:179],v[48:51],a[120:123],v[176:179]
buffer_load_dwordx4 v3, s[8:11], s26 offen offset:0 sc1 lds
M v[176:179],v[52:55],a[128:131],v[176:179]
s_nop 0
T a[156:157],v19,49152
T a[158:159],v19,51200
M v[176:179],v[56:59],a[136:139],v[176:179]
T a[160:161],v19,53248
T a[162:163],v19,55296
M v[180:183],v[56:59],a[140:143],v[180:183]
buffer_load_dwordx4 v3, s[8:11], s26 offen offset:1024 sc1 lds
M v[180:183],v[52:55],a[132:135],v[180:183]
s_nop 0
T a[164:165],v19,57344
T a[166:167],v19,59392
M v[180:183],v[48:51],a[124:127],v[180:183]
T a[168:169],v19,61440
T a[170:171],v19,63488
M v[180:183],v[44:47],a[116:119],v[180:183]
buffer_load_dwordx4 v3, s[8:11], s26 offen offset:2048 sc1 lds
M v[180:183],v[40:43],a[108:111],v[180:183]
MF v170,s5,v170
MF v171,s5,v171
M v[180:183],v[36:39],a[100:103],v[180:183]
s_waitcnt lgkmcnt(0)
buffer_load_dwordx4 v3, s[8:11], s26 offen offset:3072 sc1 lds
M v[180:183],v[32:35],a[236:239],v[180:183]
s_barrier
M v[184:187],a[144:147],a[232:235],v[184:187]
SA m0,s28,135168
R a[64:67],v2,32768
R a[68:71],v2,33792
M v[184:187],a[148:151],a[96:99],v[184:187]
buffer_load_dwordx4 v4, s[8:11], s26 offen offset:0 sc1 lds
M v[184:187],a[152:155],a[104:107],v[184:187]
C v160,v160,v161
C v161,v162,v163
M v[184:187],a[156:159],a[112:115],v[184:187]
SA s30,s32,12288
R a[72:75],v2,34816
R a[76:79],v2,35840
M v[184:187],a[160:163],a[120:123],v[184:187]
buffer_store_dwordx4 a[52:55], v6, s[8:11], s30 offen offset:1024 sc1
M v[184:187],a[164:167],a[128:131],v[184:187]
C v162,v168,v169
C v163,v170,v171
M v[184:187],a[168:171],a[136:139],v[184:187]
R a[80:83],v2,36864
R a[84:87],v2,37888
M v[188:191],a[168:171],a[140:143],v[188:191]
buffer_load_dwordx4 v4, s[8:11], s26 offen offset:1024 sc1 lds
M v[188:191],a[164:167],a[132:135],v[188:191]
W a24,v160
W a25,v161
M v[188:191],a[160:163],a[124:127],v[188:191]
R a[88:91],v2,38912
R a[92:95],v2,39936
M v[188:191],a[156:159],a[116:119],v[188:191]
buffer_load_dwordx4 v4, s[8:11], s26 offen offset:2048 sc1 lds
M v[188:191],a[152:155],a[108:111],v[188:191]
W a26,v162
W a27,v163
M v[188:191],a[148:151],a[100:103],v[188:191]
buffer_load_dwordx4 v4, s[8:11], s26 offen offset:3072 sc1 lds
M v[188:191],a[144:147],a[236:239],v[188:191]
s_waitcnt lgkmcnt(0)
SA s30,s32,4096
buffer_store_dwordx4 a[24:27], v6, s[8:11], s30 offen offset:2048 sc1
SA s26,s26,32768
MF v164,s5,v164
MF v165,s5,v165
MF v166,s5,v166
MF v167,s5,v167
MF v172,s5,v172
MF v173,s5,v173
MF v174,s5,v174
MF v175,s5,v175
C v164,v164,v165
C v165,v166,v167
C v166,v172,v173
C v167,v174,v175
W a56,v164
W a57,v165
W a58,v166
W a59,v167
SA s30,s32,12288
buffer_store_dwordx4 a[56:59], v6, s[8:11], s30 offen offset:2048 sc1
v_mov_b32 v30, 2
buffer_store_dword v30, v1, s[8:11], s45 offen sc1
M v[64:67],a[64:67],a[0:3],0
R a[96:99],v2,40960
R a[100:103],v2,41984
M v[64:67],a[68:71],a[4:7],v[64:67]
MF v176,s5,v176
MF v177,s5,v177
M v[64:67],a[72:75],a[8:11],v[64:67]
MF v178,s5,v178
MF v179,s5,v179
M v[64:67],a[76:79],a[12:15],v[64:67]
R a[104:107],v2,43008
R a[108:111],v2,44032
M v[64:67],a[80:83],a[16:19],v[64:67]
MF v184,s5,v184
MF v185,s5,v185
MF v186,s5,v186
MF v187,s5,v187
C v176,v176,v177
C v177,v178,v179
C v178,v184,v185
C v179,v186,v187
W a28,v176
W a29,v177
W a30,v178
W a31,v179
M v[64:67],a[84:87],a[20:23],v[64:67]
MF v180,s5,v180
MF v181,s5,v181
M v[64:67],a[88:91],a[24:27],v[64:67]
R a[112:115],v2,45056
R a[116:119],v2,46080
M v[64:67],a[92:95],a[28:31],v[64:67]
MF v182,s5,v182
MF v183,s5,v183
M v[68:71],a[64:67],a[32:35],0
MF v188,s5,v188
MF v189,s5,v189
M v[68:71],a[68:71],a[36:39],v[68:71]
R a[120:123],v2,47104
R a[124:127],v2,48128
M v[68:71],a[72:75],a[40:43],v[68:71]
SA m0,s28,32768
MF v190,s5,v190
MF v191,s5,v191
M v[68:71],a[76:79],a[44:47],v[68:71]
buffer_load_dwordx4 v3, s[8:11], s26 offen offset:0 sc1 lds
M v[68:71],a[80:83],a[48:51],v[68:71]
C v180,v180,v181
C v181,v182,v183
C v182,v188,v189
C v183,v190,v191
W a60,v180
W a61,v181
W a62,v182
W a63,v183
M v[68:71],a[84:87],a[52:55],v[68:71]
SA s30,s32,4096
buffer_store_dwordx4 a[28:31], v6, s[8:11], s30 offen offset:3072 sc1
M v[68:71],a[88:91],a[56:59],v[68:71]
SA s30,s32,12288
E v18,v64
M v[68:71],a[92:95],a[60:63],v[68:71]
s_waitcnt lgkmcnt(0)
buffer_store_dwordx4 a[60:63], v6, s[8:11], s30 offen offset:3072 sc1
M v[72:75],a[96:99],a[0:3],0
R a[64:67],v2,49152
R a[68:71],v2,50176
M v[72:75],a[100:103],a[4:7],v[72:75]
E v19,v65
M v[72:75],a[104:107],a[8:11],v[72:75]
buffer_load_dwordx4 v3, s[8:11], s26 offen offset:1024 sc1 lds
M v[72:75],a[108:111],a[12:15],v[72:75]
R a[72:75],v2,51200
R a[76:79],v2,52224
M v[72:75],a[112:115],a[16:19],v[72:75]
E v20,v66
M v[72:75],a[116:119],a[20:23],v[72:75]
buffer_load_dwordx4 v3, s[8:11], s26 offen offset:2048 sc1 lds
M v[72:75],a[120:123],a[24:27],v[72:75]
R a[80:83],v2,53248
R a[84:87],v2,54272
M v[72:75],a[124:127],a[28:31],v[72:75]
E v21,v67
M v[76:79],a[124:127],a[60:63],0
buffer_load_dwordx4 v3, s[8:11], s26 offen offset:3072 sc1 lds
M v[76:79],a[120:123],a[56:59],v[76:79]
SA m0,s28,36864
R a[88:91],v2,55296
R a[92:95],v2,56320
M v[76:79],a[116:119],a[52:55],v[76:79]
E v22,v68
M v[76:79],a[112:115],a[48:51],v[76:79]
buffer_load_dwordx4 v4, s[8:11], s26 offen offset:0 sc1 lds
M v[76:79],a[108:111],a[44:47],v[76:79]
E v23,v69
M v[76:79],a[104:107],a[40:43],v[76:79]
AF v26,v18,v19
C v40,v18,v19
M v[76:79],a[100:103],a[36:39],v[76:79]
buffer_load_dwordx4 v4, s[8:11], s26 offen offset:1024 sc1 lds
M v[76:79],a[96:99],a[32:35],v[76:79]
s_waitcnt lgkmcnt(0)
v_add_u32 v16, 0x20000, v7
AF v26,v20,v26
M v[80:83],a[64:67],a[0:3],0
R a[96:99],v2,57344
R a[100:103],v2,58368
M v[80:83],a[68:71],a[4:7],v[80:83]
buffer_load_dwordx4 v4, s[8:11], s26 offen offset:2048 sc1 lds
M v[80:83],a[72:75],a[8:11],v[80:83]
E v24,v70
M v[80:83],a[76:79],a[12:15],v[80:83]
R a[104:107],v2,59392
R a[108:111],v2,60416
M v[80:83],a[80:83],a[16:19],v[80:83]
buffer_load_dwordx4 v4, s[8:11], s26 offen offset:3072 sc1 lds
M v[80:83],a[84:87],a[20:23],v[80:83]
SA s26,s26,32768
E v25,v71
M v[80:83],a[88:91],a[24:27],v[80:83]
R a[112:115],v2,61440
R a[116:119],v2,62464
M v[80:83],a[92:95],a[28:31],v[80:83]
E v18,v72
M v[84:87],a[92:95],a[60:63],0
E v19,v73
M v[84:87],a[88:91],a[56:59],v[84:87]
R a[120:123],v2,63488
R a[124:127],v2,64512
M v[84:87],a[84:87],a[52:55],v[84:87]
C v41,v20,v21
AF v26,v21,v26
M v[84:87],a[80:83],a[48:51],v[84:87]
E v20,v74
M v[84:87],a[76:79],a[44:47],v[84:87]
AF v27,v22,v23
C v44,v22,v23
M v[84:87],a[72:75],a[40:43],v[84:87]
AF v27,v24,v27
C v45,v24,v25
M v[84:87],a[68:71],a[36:39],v[84:87]
s_waitcnt vmcnt(24) lgkmcnt(0)
E v21,v75
M v[84:87],a[64:67],a[32:35],v[84:87]
s_barrier
M v[88:91],a[96:99],a[0:3],0
R a[64:67],v2,0
R a[68:71],v2,1024
M v[88:91],a[100:103],a[4:7],v[88:91]
E v22,v76
M v[88:91],a[104:107],a[8:11],v[88:91]
AF v27,v25,v27
AF v26,v18,v26
M v[88:91],a[108:111],a[12:15],v[88:91]
R a[72:75],v2,2048
R a[76:79],v2,3072
M v[88:91],a[112:115],a[16:19],v[88:91]
E v23,v77
M v[88:91],a[116:119],a[20:23],v[88:91]
C v42,v18,v19
AF v26,v19,v26
M v[88:91],a[120:123],a[24:27],v[88:91]
R a[80:83],v2,4096
R a[84:87],v2,5120
M v[88:91],a[124:127],a[28:31],v[88:91]
E v24,v78
M v[92:95],a[124:127],a[60:63],0
AF v26,v20,v26
C v43,v20,v21
M v[92:95],a[120:123],a[56:59],v[92:95]
R a[88:91],v2,6144
R a[92:95],v2,7168
M v[92:95],a[116:119],a[52:55],v[92:95]
E v25,v79
M v[92:95],a[112:115],a[48:51],v[92:95]
AF v26,v21,v26
AF v27,v22,v27
M v[92:95],a[108:111],a[44:47],v[92:95]
C v46,v22,v23
AF v27,v23,v27
M v[92:95],a[104:107],a[40:43],v[92:95]
AF v27,v24,v27
C v47,v24,v25
M v[92:95],a[100:103],a[36:39],v[92:95]
s_waitcnt lgkmcnt(0)
AF v27,v25,v27
M v[92:95],a[96:99],a[32:35],v[92:95]
M v[96:99],a[64:67],a[0:3],0
R a[96:99],v2,8192
R a[100:103],v2,9216
M v[96:99],a[68:71],a[4:7],v[96:99]
SA m0,s28,98304
W a128,v128
W a129,v129
M v[96:99],a[72:75],a[8:11],v[96:99]
buffer_load_dwordx4 v3, s[8:11], s21 offen offset:0 sc1 lds
M v[96:99],a[76:79],a[12:15],v[96:99]
R a[104:107],v2,10240
R a[108:111],v2,11264
M v[96:99],a[80:83],a[16:19],v[96:99]
W a130,v130
v_mov_b32 v30, 0
M v[96:99],a[84:87],a[20:23],v[96:99]
W a131,v131
M v[96:99],a[88:91],a[24:27],v[96:99]
R a[112:115],v2,12288
R a[116:119],v2,13312
M v[96:99],a[92:95],a[28:31],v[96:99]
buffer_load_dwordx4 v3, s[8:11], s21 offen offset:1024 sc1 lds
M v[100:103],a[92:95],a[60:63],0
W a132,v132
v_mov_b32 v31, 0
M v[100:103],a[88:91],a[56:59],v[100:103]
R a[120:123],v2,14336
R a[124:127],v2,15360
M v[100:103],a[84:87],a[52:55],v[100:103]
W a133,v133
W a134,v134
M v[100:103],a[80:83],a[48:51],v[100:103]
buffer_load_dwordx4 v3, s[8:11], s21 offen offset:2048 sc1 lds
M v[100:103],a[76:79],a[44:47],v[100:103]
W a135,v135
M v[100:103],a[72:75],a[40:43],v[100:103]
v_mov_b32 v32, 0
M v[100:103],a[68:71],a[36:39],v[100:103]
W a136,v136
M v[100:103],a[64:67],a[32:35],v[100:103]
s_waitcnt lgkmcnt(0)
buffer_load_dwordx4 v3, s[8:11], s21 offen offset:3072 sc1 lds
M v[108:111],a[96:99],a[32:35],0
SA m0,s28,102400
R a[64:67],v2,16384
R a[68:71],v2,17408
M v[108:111],a[100:103],a[36:39],v[108:111]
W a137,v137
v_mov_b32 v33, 0
M v[108:111],a[104:107],a[40:43],v[108:111]
W a138,v138
M v[108:111],a[108:111],a[44:47],v[108:111]
R a[72:75],v2,18432
R a[76:79],v2,19456
M v[108:111],a[112:115],a[48:51],v[108:111]
buffer_load_dwordx4 v4, s[8:11], s21 offen offset:0 sc1 lds
M v[108:111],a[116:119],a[52:55],v[108:111]
W a139,v139
W a140,v140
M v[108:111],a[120:123],a[56:59],v[108:111]
R a[80:83],v2,20480
R a[84:87],v2,21504
M v[108:111],a[124:127],a[60:63],v[108:111]
buffer_load_dwordx4 v4, s[8:11], s21 offen offset:1024 sc1 lds
M v[104:107],a[124:127],a[28:31],0
v_mov_b32 v34, 0
W a141,v141
M v[104:107],a[120:123],a[24:27],v[104:107]
R a[88:91],v2,22528
R a[92:95],v2,23552
M v[104:107],a[116:119],a[20:23],v[104:107]
buffer_load_dwordx4 v4, s[8:11], s21 offen offset:2048 sc1 lds
M v[104:107],a[112:115],a[16:19],v[104:107]
W a142,v142
W a143,v143
M v[104:107],a[108:111],a[12:15],v[104:107]
v_mov_b32 v35, 0
W a144,v144
M v[104:107],a[104:107],a[8:11],v[104:107]
W a145,v145
M v[104:107],a[100:103],a[4:7],v[104:107]
buffer_load_dwordx4 v4, s[8:11], s21 offen offset:3072 sc1 lds
M v[104:107],a[96:99],a[0:3],v[104:107]
s_waitcnt lgkmcnt(0)
v_mov_b32 v36, 0
W a146,v146
M v[112:115],a[64:67],a[0:3],0
SA s21,s21,32768
R a[96:99],v2,24576
R a[100:103],v2,25600
M v[112:115],a[68:71],a[4:7],v[112:115]
s_sub_u32 s22, s22, 1
W a147,v147
M v[112:115],a[72:75],a[8:11],v[112:115]
s_cselect_b32 s21, s23, s21
E v18,v80
M v[112:115],a[76:79],a[12:15],v[112:115]
R a[104:107],v2,26624
R a[108:111],v2,27648
M v[112:115],a[80:83],a[16:19],v[112:115]
W a148,v148
v_mov_b32 v37, 0
M v[112:115],a[84:87],a[20:23],v[112:115]
W a149,v149
M v[112:115],a[88:91],a[24:27],v[112:115]
R a[112:115],v2,28672
R a[116:119],v2,29696
M v[112:115],a[92:95],a[28:31],v[112:115]
W a150,v150
M v[116:119],a[92:95],a[60:63],0
v_mov_b32 v38, 0
W a151,v151
M v[116:119],a[88:91],a[56:59],v[116:119]
R a[120:123],v2,30720
R a[124:127],v2,31744
M v[116:119],a[84:87],a[52:55],v[116:119]
W a152,v152
M v[116:119],a[80:83],a[48:51],v[116:119]
W a153,v153
M v[116:119],a[76:79],a[44:47],v[116:119]
E v19,v81
M v[116:119],a[72:75],a[40:43],v[116:119]
v_mov_b32 v39, 0
W a154,v154
M v[116:119],a[68:71],a[36:39],v[116:119]
s_waitcnt vmcnt(21) lgkmcnt(0)
E v20,v82
M v[116:119],a[64:67],a[32:35],v[116:119]
s_barrier
M v[124:127],a[96:99],a[32:35],0
R a[64:67],v16,0
R a[68:71],v16,1024
M v[124:127],a[100:103],a[36:39],v[124:127]
W a155,v155
W a156,v156
M v[124:127],a[104:107],a[40:43],v[124:127]
W a157,v157
AF v26,v18,v26
M v[124:127],a[108:111],a[44:47],v[124:127]
R a[72:75],v16,2048
R a[76:79],v16,3072
M v[124:127],a[112:115],a[48:51],v[124:127]
W a158,v158
C v56,v18,v19
M v[124:127],a[116:119],a[52:55],v[124:127]
E v21,v83
M v[124:127],a[120:123],a[56:59],v[124:127]
R a[80:83],v16,4096
R a[84:87],v16,5120
M v[124:127],a[124:127],a[60:63],v[124:127]
W a159,v159
AF v26,v19,v26
M v[120:123],a[124:127],a[28:31],0
E v22,v88
M v[120:123],a[120:123],a[24:27],v[120:123]
R a[88:91],v16,6144
R a[92:95],v16,7168
M v[120:123],a[116:119],a[20:23],v[120:123]
E v23,v89
M v[120:123],a[112:115],a[16:19],v[120:123]
E v24,v90
M v[120:123],a[108:111],a[12:15],v[120:123]
E v25,v91
M v[120:123],a[104:107],a[8:11],v[120:123]
E v18,v84
M v[120:123],a[100:103],a[4:7],v[120:123]
s_waitcnt lgkmcnt(0)
E v19,v85
M v[120:123],a[96:99],a[0:3],v[120:123]
AF v26,v20,v26
C v57,v20,v21
AF v26,v21,v26
AF v26,v22,v26
C v58,v22,v23
AF v26,v23,v26
AF v26,v24,v26
C v59,v24,v25
AF v26,v25,v26
E v20,v86
E v21,v87
AF v27,v18,v27
C v60,v18,v19
AF v27,v19,v27
E v22,v92
E v23,v93
AF v27,v20,v27
C v61,v20,v21
AF v27,v21,v27
E v24,v94
E v25,v95
AF v27,v22,v27
C v62,v22,v23
AF v27,v23,v27
AF v27,v24,v27
C v63,v24,v25
AF v27,v25,v27
v_max_f32 v10, v26, v27
v_min_f32 v11, v26, v27
v_cmp_lt_f32 vcc, s31, v10
v_cmp_gt_f32 s[64:65], s24, v11
s_nop 0
s_or_b64 vcc, vcc, s[64:65]
s_cbranch_vccnz L_stv1
L_rtv1:
M v[128:131],a[64:67],v[40:43],0
R a[96:99],v16,8192
R a[100:103],v16,9216
M v[128:131],a[68:71],v[56:59],v[128:131]
SA m0,s28,65536
W a160,v192
W a161,v193
M v[132:135],a[68:71],v[60:63],0
buffer_load_dwordx4 v3, s[8:11], s21 offen offset:0 sc1 lds
M v[132:135],a[64:67],v[44:47],v[132:135]
R a[104:107],v16,10240
R a[108:111],v16,11264
M v[140:143],a[72:75],v[44:47],0
W a162,v194
W a163,v195
M v[140:143],a[76:79],v[60:63],v[140:143]
W a164,v196
W a165,v197
M v[136:139],a[76:79],v[56:59],0
R a[112:115],v16,12288
R a[116:119],v16,13312
M v[136:139],a[72:75],v[40:43],v[136:139]
buffer_load_dwordx4 v3, s[8:11], s21 offen offset:1024 sc1 lds
M v[144:147],a[80:83],v[40:43],0
W a166,v198
W a167,v199
M v[144:147],a[84:87],v[56:59],v[144:147]
R a[120:123],v16,14336
R a[124:127],v16,15360
M v[148:151],a[84:87],v[60:63],0
SA s3,s93,262144
W a168,v200
W a169,v201
M v[148:151],a[80:83],v[44:47],v[148:151]
buffer_load_dwordx4 v3, s[8:11], s21 offen offset:2048 sc1 lds
M v[156:159],a[88:91],v[44:47],0
W a170,v202
W a171,v203
M v[156:159],a[92:95],v[60:63],v[156:159]
W a172,v204
W a173,v205
M v[152:155],a[92:95],v[56:59],0
buffer_store_dwordx4 a[128:131], v7, s[8:11], s3 offen offset:0 sc1
M v[152:155],a[88:91],v[40:43],v[152:155]
s_waitcnt lgkmcnt(0)
W a174,v206
W a175,v207
M v[160:163],a[96:99],v[40:43],0
R a[64:67],v16,16384
R a[68:71],v16,17408
M v[160:163],a[100:103],v[56:59],v[160:163]
buffer_load_dwordx4 v3, s[8:11], s21 offen offset:3072 sc1 lds
M v[164:167],a[100:103],v[60:63],0
SA m0,s28,69632
W a176,v208
W a177,v209
M v[164:167],a[96:99],v[44:47],v[164:167]
R a[72:75],v16,18432
R a[76:79],v16,19456
M v[172:175],a[104:107],v[44:47],0
buffer_load_dwordx4 v4, s[8:11], s21 offen offset:0 sc1 lds
M v[172:175],a[108:111],v[60:63],v[172:175]
W a178,v210
W a179,v211
M v[168:171],a[108:111],v[56:59],0
R a[80:83],v16,20480
R a[84:87],v16,21504
M v[168:171],a[104:107],v[40:43],v[168:171]
buffer_load_dwordx4 v4, s[8:11], s21 offen offset:1024 sc1 lds
M v[176:179],a[112:115],v[40:43],0
W a180,v212
W a181,v213
M v[176:179],a[116:119],v[56:59],v[176:179]
R a[88:91],v16,22528
R a[92:95],v16,23552
M v[180:183],a[116:119],v[60:63],0
buffer_load_dwordx4 v4, s[8:11], s21 offen offset:2048 sc1 lds
M v[180:183],a[112:115],v[44:47],v[180:183]
W a182,v214
W a183,v215
M v[188:191],a[120:123],v[44:47],0
W a184,v216
W a185,v217
W a186,v218
W a187,v219
W a188,v220
W a189,v221
W a190,v222
W a191,v223
M v[188:191],a[124:127],v[60:63],v[188:191]
E v18,v96
M v[184:187],a[124:127],v[56:59],0
buffer_load_dwordx4 v4, s[8:11], s21 offen offset:3072 sc1 lds
M v[184:187],a[120:123],v[40:43],v[184:187]
s_waitcnt lgkmcnt(0)
v_min_u32 v17, 1, v7
v_lshlrev_b32 v17, 29, v17
M v[192:195],a[64:67],v[40:43],0
SA s21,s21,32768
R a[96:99],v16,24576
R a[100:103],v16,25600
M v[192:195],a[68:71],v[56:59],v[192:195]
s_sub_u32 s22, s22, 1
buffer_store_dwordx4 a[132:135], v7, s[8:11], s3 offen offset:2048 sc1
M v[196:199],a[68:71],v[60:63],0
s_cselect_b32 s21, s23, s21
v_mov_b32 v15, 1
AF v30,v26,v30
M v[196:199],a[64:67],v[44:47],v[196:199]
SA s84,s47,16
R a[104:107],v16,26624
R a[108:111],v16,27648
M v[204:207],a[72:75],v[44:47],0
E v19,v97
M v[204:207],a[76:79],v[60:63],v[204:207]
E v20,v98
M v[200:203],a[76:79],v[56:59],0
R a[112:115],v16,28672
R a[116:119],v16,29696
M v[200:203],a[72:75],v[40:43],v[200:203]
E v21,v99
M v[208:211],a[80:83],v[40:43],0
E v22,v104
M v[208:211],a[84:87],v[56:59],v[208:211]
R a[120:123],v16,30720
R a[124:127],v16,31744
M v[212:215],a[84:87],v[60:63],0
SA s3,s93,266240
E v23,v105
M v[212:215],a[80:83],v[44:47],v[212:215]
buffer_store_dwordx4 a[136:139], v7, s[8:11], s3 offen offset:0 sc1
M v[220:223],a[88:91],v[44:47],0
AF v31,v27,v31
AF v28,v18,v19
M v[220:223],a[92:95],v[60:63],v[220:223]
E v24,v106
M v[216:219],a[92:95],v[56:59],0
s_waitcnt vmcnt(11) lgkmcnt(0)
E v25,v107
M v[216:219],a[88:91],v[40:43],v[216:219]
s_barrier
M v[224:227],a[96:99],v[40:43],0
R a[64:67],v2,32768
R a[68:71],v2,33792
M v[224:227],a[100:103],v[56:59],v[224:227]
buffer_store_dword v15, v17, s[8:11], s84 offen sc1
M v[228:231],a[100:103],v[60:63],0
C v48,v18,v19
AF v28,v20,v28
M v[228:231],a[96:99],v[44:47],v[228:231]
R a[72:75],v2,34816
R a[76:79],v2,35840
M v[236:239],a[104:107],v[44:47],0
E v18,v100
M v[236:239],a[108:111],v[60:63],v[236:239]
E v19,v101
M v[232:235],a[108:111],v[56:59],0
R a[80:83],v2,36864
R a[84:87],v2,37888
M v[232:235],a[104:107],v[40:43],v[232:235]
C v49,v20,v21
AF v28,v21,v28
M v[240:243],a[112:115],v[40:43],0
E v20,v102
M v[240:243],a[116:119],v[56:59],v[240:243]
R a[88:91],v2,38912
R a[92:95],v2,39936
M v[244:247],a[116:119],v[60:63],0
E v21,v103
M v[244:247],a[112:115],v[44:47],v[244:247]
AF v28,v22,v28
C v50,v22,v23
M v[252:255],a[120:123],v[44:47],0
AF v28,v23,v28
AF v28,v24,v28
M v[252:255],a[124:127],v[60:63],v[252:255]
E v22,v108
M v[248:251],a[124:127],v[56:59],0
s_waitcnt lgkmcnt(0)
E v23,v109
M v[248:251],a[120:123],v[40:43],v[248:251]
C v51,v24,v25
AF v28,v25,v28
AF v29,v18,v19
C v52,v18,v19
AF v29,v20,v29
C v53,v20,v21
AF v29,v21,v29
E v24,v110
E v25,v111
AF v29,v22,v29
C v54,v22,v23
AF v29,v23,v29
AF v29,v24,v29
C v55,v24,v25
AF v29,v25,v29
M v[64:67],a[64:67],a[0:3],v[32:35]
R a[96:99],v2,40960
R a[100:103],v2,41984
M v[64:67],a[68:71],a[4:7],v[64:67]
SA m0,s28,0
E v18,v112
M v[64:67],a[72:75],a[8:11],v[64:67]
buffer_load_dwordx4 v3, s[8:11], s26 offen offset:0 sc1 lds
M v[64:67],a[76:79],a[12:15],v[64:67]
R a[104:107],v2,43008
R a[108:111],v2,44032
M v[64:67],a[80:83],a[16:19],v[64:67]
E v19,v113
M v[64:67],a[84:87],a[20:23],v[64:67]
AF v28,v18,v28
C v56,v18,v19
M v[64:67],a[88:91],a[24:27],v[64:67]
R a[112:115],v2,45056
R a[116:119],v2,46080
M v[64:67],a[92:95],a[28:31],v[64:67]
buffer_load_dwordx4 v3, s[8:11], s26 offen offset:1024 sc1 lds
M v[68:71],a[92:95],a[60:63],v[36:39]
E v20,v114
M v[68:71],a[88:91],a[56:59],v[68:71]
R a[120:123],v2,47104
R a[124:127],v2,48128
M v[68:71],a[84:87],a[52:55],v[68:71]
SA s3,s93,266240
E v21,v115
M v[68:71],a[80:83],a[48:51],v[68:71]
buffer_load_dwordx4 v3, s[8:11], s26 offen offset:2048 sc1 lds
M v[68:71],a[76:79],a[44:47],v[68:71]
AF v28,v19,v28
AF v28,v20,v28
M v[68:71],a[72:75],a[40:43],v[68:71]
C v57,v20,v21
AF v28,v21,v28
M v[68:71],a[68:71],a[36:39],v[68:71]
buffer_store_dwordx4 a[140:143], v7, s[8:11], s3 offen offset:2048 sc1
M v[68:71],a[64:67],a[32:35],v[68:71]
s_waitcnt lgkmcnt(0)
E v22,v120
M v[76:79],a[96:99],a[32:35],v[36:39]
R a[64:67],v2,49152
R a[68:71],v2,50176
M v[76:79],a[100:103],a[36:39],v[76:79]
buffer_load_dwordx4 v3, s[8:11], s26 offen offset:3072 sc1 lds
M v[76:79],a[104:107],a[40:43],v[76:79]
SA m0,s28,4096
E v23,v121
M v[76:79],a[108:111],a[44:47],v[76:79]
R a[72:75],v2,51200
R a[76:79],v2,52224
M v[76:79],a[112:115],a[48:51],v[76:79]
buffer_load_dwordx4 v4, s[8:11], s26 offen offset:0 sc1 lds
M v[76:79],a[116:119],a[52:55],v[76:79]
E v24,v122
M v[76:79],a[120:123],a[56:59],v[76:79]
R a[80:83],v2,53248
R a[84:87],v2,54272
M v[76:79],a[124:127],a[60:63],v[76:79]
buffer_load_dwordx4 v4, s[8:11], s26 offen offset:1024 sc1 lds
M v[72:75],a[124:127],a[28:31],v[32:35]
E v25,v123
M v[72:75],a[120:123],a[24:27],v[72:75]
SA s3,s93,270336
R a[88:91],v2,55296
R a[92:95],v2,56320
M v[72:75],a[116:119],a[20:23],v[72:75]
buffer_load_dwordx4 v4, s[8:11], s26 offen offset:2048 sc1 lds
M v[72:75],a[112:115],a[16:19],v[72:75]
AF v28,v22,v28
C v58,v22,v23
M v[72:75],a[108:111],a[12:15],v[72:75]
E v18,v116
M v[72:75],a[104:107],a[8:11],v[72:75]
AF v28,v23,v28
AF v28,v24,v28
M v[72:75],a[100:103],a[4:7],v[72:75]
buffer_load_dwordx4 v4, s[8:11], s26 offen offset:3072 sc1 lds
M v[72:75],a[96:99],a[0:3],v[72:75]
s_waitcnt lgkmcnt(0)
E v19,v117
M v[80:83],a[64:67],a[0:3],v[32:35]
SA s26,s26,32768
R a[96:99],v2,57344
R a[100:103],v2,58368
M v[80:83],a[68:71],a[4:7],v[80:83]
buffer_store_dwordx4 a[144:147], v7, s[8:11], s3 offen offset:0 sc1
M v[80:83],a[72:75],a[8:11],v[80:83]
C v59,v24,v25
AF v28,v25,v28
M v[80:83],a[76:79],a[12:15],v[80:83]
R a[104:107],v2,59392
R a[108:111],v2,60416
M v[80:83],a[80:83],a[16:19],v[80:83]
E v20,v118
M v[80:83],a[84:87],a[20:23],v[80:83]
AF v29,v18,v29
C v60,v18,v19
M v[80:83],a[88:91],a[24:27],v[80:83]
R a[112:115],v2,61440
R a[116:119],v2,62464
M v[80:83],a[92:95],a[28:31],v[80:83]
E v21,v119
M v[84:87],a[92:95],a[60:63],v[36:39]
AF v29,v19,v29
AF v29,v20,v29
M v[84:87],a[88:91],a[56:59],v[84:87]
R a[120:123],v2,63488
R a[124:127],v2,64512
M v[84:87],a[84:87],a[52:55],v[84:87]
E v22,v124
M v[84:87],a[80:83],a[48:51],v[84:87]
buffer_store_dwordx4 a[148:151], v7, s[8:11], s3 offen offset:2048 sc1
M v[84:87],a[76:79],a[44:47],v[84:87]
C v61,v20,v21
AF v29,v21,v29
M v[84:87],a[72:75],a[40:43],v[84:87]
E v23,v125
M v[84:87],a[68:71],a[36:39],v[84:87]
s_waitcnt lgkmcnt(0)
AF v29,v22,v29
C v62,v22,v23
M v[84:87],a[64:67],a[32:35],v[84:87]
s_barrier
M v[92:95],a[96:99],a[32:35],v[36:39]
R a[64:67],v7,32768
R a[68:71],v7,33792
M v[92:95],a[100:103],a[36:39],v[92:95]
E v24,v126
M v[92:95],a[104:107],a[40:43],v[92:95]
AF v29,v23,v29
M v[92:95],a[108:111],a[44:47],v[92:95]
R a[72:75],v7,34816
R a[76:79],v7,35840
M v[92:95],a[112:115],a[48:51],v[92:95]
E v25,v127
M v[92:95],a[116:119],a[52:55],v[92:95]
AF v29,v24,v29
C v63,v24,v25
M v[92:95],a[120:123],a[56:59],v[92:95]
R a[80:83],v7,36864
R a[84:87],v7,37888
M v[92:95],a[124:127],a[60:63],v[92:95]
AF v29,v25,v29
M v[88:91],a[124:127],a[28:31],v[32:35]
M v[88:91],a[120:123],a[24:27],v[88:91]
R a[88:91],v7,38912
R a[92:95],v7,39936
M v[88:91],a[116:119],a[20:23],v[88:91]
v_max_f32 v10, v28, v29
M v[88:91],a[112:115],a[16:19],v[88:91]
v_cmp_lt_f32 vcc, s31, v10
M v[88:91],a[108:111],a[12:15],v[88:91]
M v[88:91],a[104:107],a[8:11],v[88:91]
M v[88:91],a[100:103],a[4:7],v[88:91]
s_waitcnt lgkmcnt(0)
M v[88:91],a[96:99],a[0:3],v[88:91]
s_cbranch_vccnz L_stv2
L_rtv2:
M v[128:131],a[64:67],v[48:51],v[128:131]
R a[96:99],v7,40960
R a[100:103],v7,41984
M v[128:131],a[68:71],v[56:59],v[128:131]
SA m0,s28,98304
E v18,v64
M v[132:135],a[68:71],v[60:63],v[132:135]
buffer_load_dwordx4 v3, s[8:11], s21 offen offset:0 sc1 lds
M v[132:135],a[64:67],v[52:55],v[132:135]
R a[104:107],v7,43008
R a[108:111],v7,44032
M v[140:143],a[72:75],v[52:55],v[140:143]
E v19,v65
M v[140:143],a[76:79],v[60:63],v[140:143]
AF v30,v28,v30
AF v31,v29,v31
M v[136:139],a[76:79],v[56:59],v[136:139]
R a[112:115],v7,45056
R a[116:119],v7,46080
M v[136:139],a[72:75],v[48:51],v[136:139]
buffer_load_dwordx4 v3, s[8:11], s21 offen offset:1024 sc1 lds
M v[144:147],a[80:83],v[48:51],v[144:147]
E v20,v66
M v[144:147],a[84:87],v[56:59],v[144:147]
R a[120:123],v7,47104
R a[124:127],v7,48128
M v[148:151],a[84:87],v[60:63],v[148:151]
SA s3,s93,274432
AF v26,v18,v19
C v40,v18,v19
M v[148:151],a[80:83],v[52:55],v[148:151]
buffer_load_dwordx4 v3, s[8:11], s21 offen offset:2048 sc1 lds
M v[156:159],a[88:91],v[52:55],v[156:159]
E v21,v67
M v[156:159],a[92:95],v[60:63],v[156:159]
AF v26,v20,v26
C v41,v20,v21
M v[152:155],a[92:95],v[56:59],v[152:155]
buffer_store_dwordx4 a[152:155], v7, s[8:11], s3 offen offset:0 sc1
M v[152:155],a[88:91],v[48:51],v[152:155]
s_waitcnt lgkmcnt(0)
E v22,v72
M v[160:163],a[96:99],v[48:51],v[160:163]
R a[64:67],v7,49152
R a[68:71],v7,50176
M v[160:163],a[100:103],v[56:59],v[160:163]
buffer_load_dwordx4 v3, s[8:11], s21 offen offset:3072 sc1 lds
M v[164:167],a[100:103],v[60:63],v[164:167]
SA m0,s28,102400
E v23,v73
M v[164:167],a[96:99],v[52:55],v[164:167]
R a[72:75],v7,51200
R a[76:79],v7,52224
M v[172:175],a[104:107],v[52:55],v[172:175]
buffer_load_dwordx4 v4, s[8:11], s21 offen offset:0 sc1 lds
M v[172:175],a[108:111],v[60:63],v[172:175]
AF v26,v21,v26
AF v26,v22,v26
M v[168:171],a[108:111],v[56:59],v[168:171]
R a[80:83],v7,53248
R a[84:87],v7,54272
M v[168:171],a[104:107],v[48:51],v[168:171]
buffer_load_dwordx4 v4, s[8:11], s21 offen offset:1024 sc1 lds
M v[176:179],a[112:115],v[48:51],v[176:179]
E v24,v74
M v[176:179],a[116:119],v[56:59],v[176:179]
R a[88:91],v7,55296
R a[92:95],v7,56320
M v[180:183],a[116:119],v[60:63],v[180:183]
buffer_load_dwordx4 v4, s[8:11], s21 offen offset:2048 sc1 lds
M v[180:183],a[112:115],v[52:55],v[180:183]
E v25,v75
M v[188:191],a[120:123],v[52:55],v[188:191]
C v42,v22,v23
AF v26,v23,v26
M v[188:191],a[124:127],v[60:63],v[188:191]
AF v26,v24,v26
C v43,v24,v25
M v[184:187],a[124:127],v[56:59],v[184:187]
buffer_load_dwordx4 v4, s[8:11], s21 offen offset:3072 sc1 lds
M v[184:187],a[120:123],v[48:51],v[184:187]
s_waitcnt lgkmcnt(0)
E v18,v68
M v[192:195],a[64:67],v[48:51],v[192:195]
SA s21,s21,32768
R a[96:99],v7,57344
R a[100:103],v7,58368
M v[192:195],a[68:71],v[56:59],v[192:195]
s_sub_u32 s22, s22, 1
buffer_store_dwordx4 a[156:159], v7, s[8:11], s3 offen offset:2048 sc1
M v[196:199],a[68:71],v[60:63],v[196:199]
s_cselect_b32 s21, s23, s21
E v19,v69
M v[196:199],a[64:67],v[52:55],v[196:199]
R a[104:107],v7,59392
R a[108:111],v7,60416
M v[204:207],a[72:75],v[52:55],v[204:207]
AF v26,v25,v26
AF v27,v18,v19
M v[204:207],a[76:79],v[60:63],v[204:207]
E v20,v70
M v[200:203],a[76:79],v[56:59],v[200:203]
R a[112:115],v7,61440
R a[116:119],v7,62464
M v[200:203],a[72:75],v[48:51],v[200:203]
C v44,v18,v19
M v[208:211],a[80:83],v[48:51],v[208:211]
M v[208:211],a[84:87],v[56:59],v[208:211]
R a[120:123],v7,63488
R a[124:127],v7,64512
M v[212:215],a[84:87],v[60:63],v[212:215]
SA s3,s93,786432
E v21,v71
M v[212:215],a[80:83],v[52:55],v[212:215]
buffer_store_dwordx4 a[160:163], v7, s[8:11], s3 offen offset:0 sc1
M v[220:223],a[88:91],v[52:55],v[220:223]
AF v27,v20,v27
C v45,v20,v21
M v[220:223],a[92:95],v[60:63],v[220:223]
E v22,v76
M v[216:219],a[92:95],v[56:59],v[216:219]
s_waitcnt vmcnt(25) lgkmcnt(0)
AF v27,v21,v27
M v[216:219],a[88:91],v[48:51],v[216:219]
s_barrier
M v[224:227],a[96:99],v[48:51],v[224:227]
R a[64:67],v2,0
R a[68:71],v2,1024
M v[224:227],a[100:103],v[56:59],v[224:227]
E v23,v77
M v[228:231],a[100:103],v[60:63],v[228:231]
AF v27,v22,v27
C v46,v22,v23
M v[228:231],a[96:99],v[52:55],v[228:231]
R a[72:75],v2,2048
R a[76:79],v2,3072
M v[236:239],a[104:107],v[52:55],v[236:239]
E v24,v78
M v[236:239],a[108:111],v[60:63],v[236:239]
AF v27,v23,v27
M v[232:235],a[108:111],v[56:59],v[232:235]
R a[80:83],v2,4096
R a[84:87],v2,5120
M v[232:235],a[104:107],v[48:51],v[232:235]
M v[240:243],a[112:115],v[48:51],v[240:243]
E v25,v79
M v[240:243],a[116:119],v[56:59],v[240:243]
R a[88:91],v2,6144
R a[92:95],v2,7168
M v[244:247],a[116:119],v[60:63],v[244:247]
AF v27,v24,v27
C v47,v24,v25
M v[244:247],a[112:115],v[52:55],v[244:247]
AF v27,v25,v27
M v[252:255],a[120:123],v[52:55],v[252:255]
M v[252:255],a[124:127],v[60:63],v[252:255]
M v[248:251],a[124:127],v[56:59],v[248:251]
s_waitcnt lgkmcnt(0)
M v[248:251],a[120:123],v[48:51],v[248:251]
M v[96:99],a[64:67],a[0:3],v[32:35]
R a[96:99],v2,8192
R a[100:103],v2,9216
M v[96:99],a[68:71],a[4:7],v[96:99]
SA m0,s28,32768
E v18,v80
M v[96:99],a[72:75],a[8:11],v[96:99]
buffer_load_dwordx4 v3, s[8:11], s26 offen offset:0 sc1 lds
M v[96:99],a[76:79],a[12:15],v[96:99]
R a[104:107],v2,10240
R a[108:111],v2,11264
M v[96:99],a[80:83],a[16:19],v[96:99]
E v19,v81
M v[96:99],a[84:87],a[20:23],v[96:99]
AF v26,v18,v26
C v56,v18,v19
M v[96:99],a[88:91],a[24:27],v[96:99]
R a[112:115],v2,12288
R a[116:119],v2,13312
M v[96:99],a[92:95],a[28:31],v[96:99]
buffer_load_dwordx4 v3, s[8:11], s26 offen offset:1024 sc1 lds
M v[100:103],a[92:95],a[60:63],v[36:39]
E v20,v82
M v[100:103],a[88:91],a[56:59],v[100:103]
R a[120:123],v2,14336
R a[124:127],v2,15360
M v[100:103],a[84:87],a[52:55],v[100:103]
SA s3,s93,786432
E v21,v83
M v[100:103],a[80:83],a[48:51],v[100:103]
buffer_load_dwordx4 v3, s[8:11], s26 offen offset:2048 sc1 lds
M v[100:103],a[76:79],a[44:47],v[100:103]
AF v26,v19,v26
AF v26,v20,v26
M v[100:103],a[72:75],a[40:43],v[100:103]
C v57,v20,v21
AF v26,v21,v26
M v[100:103],a[68:71],a[36:39],v[100:103]
buffer_store_dwordx4 a[164:167], v7, s[8:11], s3 offen offset:2048 sc1
M v[100:103],a[64:67],a[32:35],v[100:103]
s_waitcnt lgkmcnt(0)
E v22,v88
M v[108:111],a[96:99],a[32:35],v[36:39]
R a[64:67],v2,16384
R a[68:71],v2,17408
M v[108:111],a[100:103],a[36:39],v[108:111]
buffer_load_dwordx4 v3, s[8:11], s26 offen offset:3072 sc1 lds
M v[108:111],a[104:107],a[40:43],v[108:111]
SA m0,s28,36864
E v23,v89
M v[108:111],a[108:111],a[44:47],v[108:111]
R a[72:75],v2,18432
R a[76:79],v2,19456
M v[108:111],a[112:115],a[48:51],v[108:111]
buffer_load_dwordx4 v4, s[8:11], s26 offen offset:0 sc1 lds
M v[108:111],a[116:119],a[52:55],v[108:111]
SA s3,s93,790528
E v24,v90
M v[108:111],a[120:123],a[56:59],v[108:111]
R a[80:83],v2,20480
R a[84:87],v2,21504
M v[108:111],a[124:127],a[60:63],v[108:111]
buffer_load_dwordx4 v4, s[8:11], s26 offen offset:1024 sc1 lds
M v[104:107],a[124:127],a[28:31],v[32:35]
E v25,v91
M v[104:107],a[120:123],a[24:27],v[104:107]
R a[88:91],v2,22528
R a[92:95],v2,23552
M v[104:107],a[116:119],a[20:23],v[104:107]
buffer_load_dwordx4 v4, s[8:11], s26 offen offset:2048 sc1 lds
M v[104:107],a[112:115],a[16:19],v[104:107]
AF v26,v22,v26
C v58,v22,v23
M v[104:107],a[108:111],a[12:15],v[104:107]
E v18,v84
M v[104:107],a[104:107],a[8:11],v[104:107]
buffer_store_dwordx4 a[168:171], v7, s[8:11], s3 offen offset:0 sc1
M v[104:107],a[100:103],a[4:7],v[104:107]
AF v26,v23,v26
AF v26,v24,v26
M v[104:107],a[96:99],a[0:3],v[104:107]
s_waitcnt lgkmcnt(0)
E v19,v85
M v[112:115],a[64:67],a[0:3],v[32:35]
R a[96:99],v2,24576
R a[100:103],v2,25600
M v[112:115],a[68:71],a[4:7],v[112:115]
buffer_load_dwordx4 v4, s[8:11], s26 offen offset:3072 sc1 lds
M v[112:115],a[72:75],a[8:11],v[112:115]
SA s26,s26,32768
C v59,v24,v25
AF v26,v25,v26
M v[112:115],a[76:79],a[12:15],v[112:115]
R a[104:107],v2,26624
R a[108:111],v2,27648
M v[112:115],a[80:83],a[16:19],v[112:115]
E v20,v86
M v[112:115],a[84:87],a[20:23],v[112:115]
buffer_store_dwordx4 a[172:175], v7, s[8:11], s3 offen offset:2048 sc1
M v[112:115],a[88:91],a[24:27],v[112:115]
R a[112:115],v2,28672
R a[116:119],v2,29696
M v[112:115],a[92:95],a[28:31],v[112:115]
E v21,v87
M v[116:119],a[92:95],a[60:63],v[36:39]
AF v27,v18,v27
C v60,v18,v19
M v[116:119],a[88:91],a[56:59],v[116:119]
R a[120:123],v2,30720
R a[124:127],v2,31744
M v[116:119],a[84:87],a[52:55],v[116:119]
E v22,v92
M v[116:119],a[80:83],a[48:51],v[116:119]
AF v27,v19,v27
AF v27,v20,v27
M v[116:119],a[76:79],a[44:47],v[116:119]
C v61,v20,v21
AF v27,v21,v27
M v[116:119],a[72:75],a[40:43],v[116:119]
E v23,v93
M v[116:119],a[68:71],a[36:39],v[116:119]
s_waitcnt vmcnt(24) lgkmcnt(0)
AF v27,v22,v27
C v62,v22,v23
M v[116:119],a[64:67],a[32:35],v[116:119]
s_barrier
M v[124:127],a[96:99],a[32:35],v[36:39]
SA s3,s93,794624
R a[64:67],v7,0
R a[68:71],v7,1024
M v[124:127],a[100:103],a[36:39],v[124:127]
buffer_store_dwordx4 a[176:179], v7, s[8:11], s3 offen offset:0 sc1
M v[124:127],a[104:107],a[40:43],v[124:127]
E v24,v94
M v[124:127],a[108:111],a[44:47],v[124:127]
R a[72:75],v7,2048
R a[76:79],v7,3072
M v[124:127],a[112:115],a[48:51],v[124:127]
E v25,v95
M v[124:127],a[116:119],a[52:55],v[124:127]
AF v27,v23,v27
AF v27,v24,v27
M v[124:127],a[120:123],a[56:59],v[124:127]
R a[80:83],v7,4096
R a[84:87],v7,5120
M v[124:127],a[124:127],a[60:63],v[124:127]
C v63,v24,v25
AF v27,v25,v27
M v[120:123],a[124:127],a[28:31],v[32:35]
M v[120:123],a[120:123],a[24:27],v[120:123]
R a[88:91],v7,6144
R a[92:95],v7,7168
M v[120:123],a[116:119],a[20:23],v[120:123]
v_max_f32 v10, v26, v27
M v[120:123],a[112:115],a[16:19],v[120:123]
v_cmp_lt_f32 vcc, s31, v10
M v[120:123],a[108:111],a[12:15],v[120:123]
M v[120:123],a[104:107],a[8:11],v[120:123]
M v[120:123],a[100:103],a[4:7],v[120:123]
s_waitcnt lgkmcnt(0)
M v[120:123],a[96:99],a[0:3],v[120:123]
s_cbranch_vccnz L_stv3
L_rtv3:
M v[128:131],a[64:67],v[40:43],v[128:131]
R a[96:99],v7,8192
R a[100:103],v7,9216
M v[128:131],a[68:71],v[56:59],v[128:131]
SA m0,s28,65536
E v18,v96
M v[132:135],a[68:71],v[60:63],v[132:135]
buffer_load_dwordx4 v3, s[8:11], s21 offen offset:0 sc1 lds
M v[132:135],a[64:67],v[44:47],v[132:135]
R a[104:107],v7,10240
R a[108:111],v7,11264
M v[140:143],a[72:75],v[44:47],v[140:143]
E v19,v97
M v[140:143],a[76:79],v[60:63],v[140:143]
AF v30,v26,v30
AF v31,v27,v31
M v[136:139],a[76:79],v[56:59],v[136:139]
R a[112:115],v7,12288
R a[116:119],v7,13312
M v[136:139],a[72:75],v[40:43],v[136:139]
buffer_load_dwordx4 v3, s[8:11], s21 offen offset:1024 sc1 lds
M v[144:147],a[80:83],v[40:43],v[144:147]
E v20,v98
M v[144:147],a[84:87],v[56:59],v[144:147]
R a[120:123],v7,14336
R a[124:127],v7,15360
M v[148:151],a[84:87],v[60:63],v[148:151]
SA s3,s93,794624
AF v28,v18,v19
C v48,v18,v19
M v[148:151],a[80:83],v[44:47],v[148:151]
buffer_load_dwordx4 v3, s[8:11], s21 offen offset:2048 sc1 lds
M v[156:159],a[88:91],v[44:47],v[156:159]
E v21,v99
M v[156:159],a[92:95],v[60:63],v[156:159]
AF v28,v20,v28
C v49,v20,v21
M v[152:155],a[92:95],v[56:59],v[152:155]
buffer_store_dwordx4 a[180:183], v7, s[8:11], s3 offen offset:2048 sc1
M v[152:155],a[88:91],v[40:43],v[152:155]
s_waitcnt lgkmcnt(0)
E v22,v104
M v[160:163],a[96:99],v[40:43],v[160:163]
R a[64:67],v7,16384
R a[68:71],v7,17408
M v[160:163],a[100:103],v[56:59],v[160:163]
buffer_load_dwordx4 v3, s[8:11], s21 offen offset:3072 sc1 lds
M v[164:167],a[100:103],v[60:63],v[164:167]
SA m0,s28,69632
E v23,v105
M v[164:167],a[96:99],v[44:47],v[164:167]
R a[72:75],v7,18432
R a[76:79],v7,19456
M v[172:175],a[104:107],v[44:47],v[172:175]
buffer_load_dwordx4 v4, s[8:11], s21 offen offset:0 sc1 lds
M v[172:175],a[108:111],v[60:63],v[172:175]
AF v28,v21,v28
AF v28,v22,v28
M v[168:171],a[108:111],v[56:59],v[168:171]
R a[80:83],v7,20480
R a[84:87],v7,21504
M v[168:171],a[104:107],v[40:43],v[168:171]
buffer_load_dwordx4 v4, s[8:11], s21 offen offset:1024 sc1 lds
M v[176:179],a[112:115],v[40:43],v[176:179]
E v24,v106
M v[176:179],a[116:119],v[56:59],v[176:179]
SA s3,s93,798720
R a[88:91],v7,22528
R a[92:95],v7,23552
M v[180:183],a[116:119],v[60:63],v[180:183]
buffer_load_dwordx4 v4, s[8:11], s21 offen offset:2048 sc1 lds
M v[180:183],a[112:115],v[44:47],v[180:183]
E v25,v107
M v[188:191],a[120:123],v[44:47],v[188:191]
C v50,v22,v23
AF v28,v23,v28
M v[188:191],a[124:127],v[60:63],v[188:191]
AF v28,v24,v28
C v51,v24,v25
M v[184:187],a[124:127],v[56:59],v[184:187]
buffer_load_dwordx4 v4, s[8:11], s21 offen offset:3072 sc1 lds
M v[184:187],a[120:123],v[40:43],v[184:187]
s_waitcnt lgkmcnt(0)
E v18,v100
M v[192:195],a[64:67],v[40:43],v[192:195]
SA s21,s21,32768
R a[96:99],v7,24576
R a[100:103],v7,25600
M v[192:195],a[68:71],v[56:59],v[192:195]
s_sub_u32 s22, s22, 1
buffer_store_dwordx4 a[184:187], v7, s[8:11], s3 offen offset:0 sc1
M v[196:199],a[68:71],v[60:63],v[196:199]
s_cselect_b32 s21, s23, s21
E v19,v101
M v[196:199],a[64:67],v[44:47],v[196:199]
R a[104:107],v7,26624
R a[108:111],v7,27648
M v[204:207],a[72:75],v[44:47],v[204:207]
AF v28,v25,v28
AF v29,v18,v19
M v[204:207],a[76:79],v[60:63],v[204:207]
E v20,v102
M v[200:203],a[76:79],v[56:59],v[200:203]
R a[112:115],v7,28672
R a[116:119],v7,29696
M v[200:203],a[72:75],v[40:43],v[200:203]
C v52,v18,v19
M v[208:211],a[80:83],v[40:43],v[208:211]
M v[208:211],a[84:87],v[56:59],v[208:211]
R a[120:123],v7,30720
R a[124:127],v7,31744
M v[212:215],a[84:87],v[60:63],v[212:215]
E v21,v103
M v[212:215],a[80:83],v[44:47],v[212:215]
buffer_store_dwordx4 a[188:191], v7, s[8:11], s3 offen offset:2048 sc1
M v[220:223],a[88:91],v[44:47],v[220:223]
AF v29,v20,v29
C v53,v20,v21
M v[220:223],a[92:95],v[60:63],v[220:223]
E v22,v108
M v[216:219],a[92:95],v[56:59],v[216:219]
s_waitcnt vmcnt(25) lgkmcnt(0)
AF v29,v21,v29
M v[216:219],a[88:91],v[40:43],v[216:219]
s_barrier
M v[224:227],a[96:99],v[40:43],v[224:227]
R a[64:67],v2,32768
R a[68:71],v2,33792
M v[224:227],a[100:103],v[56:59],v[224:227]
E v23,v109
M v[228:231],a[100:103],v[60:63],v[228:231]
AF v29,v22,v29
C v54,v22,v23
M v[228:231],a[96:99],v[44:47],v[228:231]
R a[72:75],v2,34816
R a[76:79],v2,35840
M v[236:239],a[104:107],v[44:47],v[236:239]
E v24,v110
M v[236:239],a[108:111],v[60:63],v[236:239]
AF v29,v23,v29
M v[232:235],a[108:111],v[56:59],v[232:235]
R a[80:83],v2,36864
R a[84:87],v2,37888
M v[232:235],a[104:107],v[40:43],v[232:235]
M v[240:243],a[112:115],v[40:43],v[240:243]
E v25,v111
M v[240:243],a[116:119],v[56:59],v[240:243]
R a[88:91],v2,38912
R a[92:95],v2,39936
M v[244:247],a[116:119],v[60:63],v[244:247]
AF v29,v24,v29
C v55,v24,v25
M v[244:247],a[112:115],v[44:47],v[244:247]
AF v29,v25,v29
M v[252:255],a[120:123],v[44:47],v[252:255]
M v[252:255],a[124:127],v[60:63],v[252:255]
M v[248:251],a[124:127],v[56:59],v[248:251]
s_waitcnt lgkmcnt(0)
M v[248:251],a[120:123],v[40:43],v[248:251]
s_branch L_loop_top
L_st0:
s_call_b64 s[36:37], L_slow0
s_branch L_rt0
L_st1:
s_call_b64 s[36:37], L_slow1
s_branch L_rt1
L_stv1:
s_call_b64 s[36:37], L_slowf
s_branch L_rtv1
L_stk1:
s_call_b64 s[36:37], L_slowf
s_branch L_rtk1
L_sth1:
s_call_b64 s[36:37], L_slowf
s_branch L_rth1
L_stj0:
s_call_b64 s[36:37], L_slowj
s_branch L_rtj0
L_stv2:
s_call_b64 s[36:37], L_slow1
s_branch L_rtv2
L_stv3:
s_call_b64 s[36:37], L_slow0
s_branch L_rtv3
L_std1:
s_call_b64 s[36:37], L_slow1
s_branch L_rtd1
L_std3n:
s_call_b64 s[36:37], L_slow0
s_branch L_rtd3n
L_std3h:
s_call_b64 s[36:37], L_slow0
s_branch L_rtd3h
L_std4n:
s_call_b64 s[36:37], L_slowb
s_branch L_rtd4n
L_std4h:
s_call_b64 s[36:37], L_slowb
s_branch L_rtd4h
L_stfh:
s_call_b64 s[36:37], L_slow1n
s_branch L_rtfh
L_stc:
s_call_b64 s[36:37], L_comb
s_branch L_rtc
L_slow0:
s_nop 7
s_nop 3
v_max3_f32 v10, v64, v65, v66
v_max3_f32 v10, v67, v72, v10
v_max3_f32 v10, v73, v74, v10
v_max3_f32 v10, v75, v80, v10
v_max3_f32 v10, v81, v82, v10
v_max3_f32 v10, v83, v88, v10
v_max3_f32 v10, v89, v90, v10
v_max_f32 v10, v91, v10
v_max3_f32 v11, v68, v69, v70
v_max3_f32 v11, v71, v76, v11
v_max3_f32 v11, v77, v78, v11
v_max3_f32 v11, v79, v84, v11
v_max3_f32 v11, v85, v86, v11
v_max3_f32 v11, v87, v92, v11
v_max3_f32 v11, v93, v94, v11
v_max_f32 v11, v95, v11
v_mov_b32 v12, v10
v_mov_b32 v13, v11
s_nop 0
v_permlane16_swap_b32 v12, v10
v_permlane16_swap_b32 v13, v11
v_max_f32 v10, v12, v10
v_max_f32 v11, v13, v11
v_mov_b32 v12, v10
v_mov_b32 v13, v11
s_nop 0
v_permlane32_swap_b32 v12, v10
v_permlane32_swap_b32 v13, v11
v_max_f32 v10, v12, v10
v_max_f32 v11, v13, v11
v_ceil_f32 v10, v10
v_ceil_f32 v11, v11
v_max_f32 v10, 0, v10
v_max_f32 v11, 0, v11
v_sub_f32 v64, v64, v10
v_sub_f32 v65, v65, v10
v_sub_f32 v66, v66, v10
v_sub_f32 v67, v67, v10
v_sub_f32 v68, v68, v11
v_sub_f32 v69, v69, v11
v_sub_f32 v70, v70, v11
v_sub_f32 v71, v71, v11
v_sub_f32 v72, v72, v10
v_sub_f32 v73, v73, v10
v_sub_f32 v74, v74, v10
v_sub_f32 v75, v75, v10
v_sub_f32 v76, v76, v11
v_sub_f32 v77, v77, v11
v_sub_f32 v78, v78, v11
v_sub_f32 v79, v79, v11
v_sub_f32 v80, v80, v10
v_sub_f32 v81, v81, v10
v_sub_f32 v82, v82, v10
v_sub_f32 v83, v83, v10
v_sub_f32 v84, v84, v11
v_sub_f32 v85, v85, v11
v_sub_f32 v86, v86, v11
v_sub_f32 v87, v87, v11
v_sub_f32 v88, v88, v10
v_sub_f32 v89, v89, v10
v_sub_f32 v90, v90, v10
v_sub_f32 v91, v91, v10
v_sub_f32 v92, v92, v11
v_sub_f32 v93, v93, v11
v_sub_f32 v94, v94, v11
v_sub_f32 v95, v95, v11
v_sub_f32 v96, v96, v10
v_sub_f32 v97, v97, v10
v_sub_f32 v98, v98, v10
v_sub_f32 v99, v99, v10
v_sub_f32 v100, v100, v11
v_sub_f32 v101, v101, v11
v_sub_f32 v102, v102, v11
v_sub_f32 v103, v103, v11
v_sub_f32 v104, v104, v10
v_sub_f32 v105, v105, v10
v_sub_f32 v106, v106, v10
v_sub_f32 v107, v107, v10
v_sub_f32 v108, v108, v11
v_sub_f32 v109, v109, v11
v_sub_f32 v110, v110, v11
v_sub_f32 v111, v111, v11
v_sub_f32 v112, v112, v10
v_sub_f32 v113, v113, v10
v_sub_f32 v114, v114, v10
v_sub_f32 v115, v115, v10
v_sub_f32 v116, v116, v11
v_sub_f32 v117, v117, v11
v_sub_f32 v118, v118, v11
v_sub_f32 v119, v119, v11
v_sub_f32 v120, v120, v10
v_sub_f32 v121, v121, v10
v_sub_f32 v122, v122, v10
v_sub_f32 v123, v123, v10
v_sub_f32 v124, v124, v11
v_sub_f32 v125, v125, v11
v_sub_f32 v126, v126, v11
v_sub_f32 v127, v127, v11
v_sub_f32 v32, v32, v10
v_sub_f32 v33, v33, v10
v_sub_f32 v34, v34, v10
v_sub_f32 v35, v35, v10
v_sub_f32 v36, v36, v11
v_sub_f32 v37, v37, v11
v_sub_f32 v38, v38, v11
v_sub_f32 v39, v39, v11
E v12,-v10
E v13,-v11
MF v30,v12,v30
MF v31,v13,v31
MF v128,v12,v128
MF v129,v12,v129
MF v130,v12,v130
MF v131,v12,v131
MF v132,v13,v132
MF v133,v13,v133
MF v134,v13,v134
MF v135,v13,v135
MF v136,v12,v136
MF v137,v12,v137
MF v138,v12,v138
MF v139,v12,v139
MF v140,v13,v140
MF v141,v13,v141
MF v142,v13,v142
MF v143,v13,v143
MF v144,v12,v144
MF v145,v12,v145
MF v146,v12,v146
MF v147,v12,v147
MF v148,v13,v148
MF v149,v13,v149
MF v150,v13,v150
MF v151,v13,v151
MF v152,v12,v152
MF v153,v12,v153
MF v154,v12,v154
MF v155,v12,v155
MF v156,v13,v156
MF v157,v13,v157
MF v158,v13,v158
MF v159,v13,v159
MF v160,v12,v160
MF v161,v12,v161
MF v162,v12,v162
MF v163,v12,v163
MF v164,v13,v164
MF v165,v13,v165
MF v166,v13,v166
MF v167,v13,v167
MF v168,v12,v168
MF v169,v12,v169
MF v170,v12,v170
MF v171,v12,v171
MF v172,v13,v172
MF v173,v13,v173
MF v174,v13,v174
MF v175,v13,v175
MF v176,v12,v176
MF v177,v12,v177
MF v178,v12,v178
MF v179,v12,v179
MF v180,v13,v180
MF v181,v13,v181
MF v182,v13,v182
MF v183,v13,v183
MF v184,v12,v184
MF v185,v12,v185
MF v186,v12,v186
MF v187,v12,v187
MF v188,v13,v188
MF v189,v13,v189
MF v190,v13,v190
MF v191,v13,v191
MF v192,v12,v192
MF v193,v12,v193
MF v194,v12,v194
MF v195,v12,v195
MF v196,v13,v196
MF v197,v13,v197
MF v198,v13,v198
MF v199,v13,v199
MF v200,v12,v200
MF v201,v12,v201
MF v202,v12,v202
MF v203,v12,v203
MF v204,v13,v204
MF v205,v13,v205
MF v206,v13,v206
MF v207,v13,v207
MF v208,v12,v208
MF v209,v12,v209
MF v210,v12,v210
MF v211,v12,v211
MF v212,v13,v212
MF v213,v13,v213
MF v214,v13,v214
MF v215,v13,v215
MF v216,v12,v216
MF v217,v12,v217
MF v218,v12,v218
MF v219,v12,v219
MF v220,v13,v220
MF v221,v13,v221
MF v222,v13,v222
MF v223,v13,v223
MF v224,v12,v224
MF v225,v12,v225
MF v226,v12,v226
MF v227,v12,v227
MF v228,v13,v228
MF v229,v13,v229
MF v230,v13,v230
MF v231,v13,v231
MF v232,v12,v232
MF v233,v12,v233
MF v234,v12,v234
MF v235,v12,v235
MF v236,v13,v236
MF v237,v13,v237
MF v238,v13,v238
MF v239,v13,v239
MF v240,v12,v240
MF v241,v12,v241
MF v242,v12,v242
MF v243,v12,v243
MF v244,v13,v244
MF v245,v13,v245
MF v246,v13,v246
MF v247,v13,v247
MF v248,v12,v248
MF v249,v12,v249
MF v250,v12,v250
MF v251,v12,v251
MF v252,v13,v252
MF v253,v13,v253
MF v254,v13,v254
MF v255,v13,v255
E v18,v64
E v19,v65
E v20,v66
AF v26,v18,v19
C v40,v18,v19
E v21,v67
E v22,v72
AF v26,v20,v26
C v41,v20,v21
E v23,v73
AF v26,v21,v26
E v24,v74
AF v26,v22,v26
C v42,v22,v23
E v25,v75
AF v26,v23,v26
E v18,v68
AF v26,v24,v26
C v43,v24,v25
E v19,v69
AF v26,v25,v26
E v20,v70
AF v27,v18,v19
C v44,v18,v19
E v21,v71
E v22,v76
AF v27,v20,v27
C v45,v20,v21
E v23,v77
AF v27,v21,v27
E v24,v78
AF v27,v22,v27
C v46,v22,v23
E v25,v79
AF v27,v23,v27
AF v27,v24,v27
C v47,v24,v25
AF v27,v25,v27
E v18,v80
E v19,v81
E v20,v82
AF v26,v18,v26
C v56,v18,v19
E v21,v83
AF v26,v19,v26
E v22,v88
AF v26,v20,v26
C v57,v20,v21
E v23,v89
AF v26,v21,v26
E v24,v90
AF v26,v22,v26
C v58,v22,v23
E v25,v91
AF v26,v23,v26
E v18,v84
AF v26,v24,v26
C v59,v24,v25
E v19,v85
AF v26,v25,v26
E v20,v86
AF v27,v18,v27
C v60,v18,v19
E v21,v87
AF v27,v19,v27
E v22,v92
AF v27,v20,v27
C v61,v20,v21
E v23,v93
AF v27,v21,v27
E v24,v94
AF v27,v22,v27
C v62,v22,v23
E v25,v95
AF v27,v23,v27
AF v27,v24,v27
C v63,v24,v25
AF v27,v25,v27
s_nop 3
s_setpc_b64 s[36:37]
L_slow1:
s_nop 7
s_nop 3
v_max3_f32 v10, v96, v97, v98
v_max3_f32 v10, v99, v104, v10
v_max3_f32 v10, v105, v106, v10
v_max3_f32 v10, v107, v112, v10
v_max3_f32 v10, v113, v114, v10
v_max3_f32 v10, v115, v120, v10
v_max3_f32 v10, v121, v122, v10
v_max_f32 v10, v123, v10
v_max3_f32 v11, v100, v101, v102
v_max3_f32 v11, v103, v108, v11
v_max3_f32 v11, v109, v110, v11
v_max3_f32 v11, v111, v116, v11
v_max3_f32 v11, v117, v118, v11
v_max3_f32 v11, v119, v124, v11
v_max3_f32 v11, v125, v126, v11
v_max_f32 v11, v127, v11
v_mov_b32 v12, v10
v_mov_b32 v13, v11
s_nop 0
v_permlane16_swap_b32 v12, v10
v_permlane16_swap_b32 v13, v11
v_max_f32 v10, v12, v10
v_max_f32 v11, v13, v11
v_mov_b32 v12, v10
v_mov_b32 v13, v11
s_nop 0
v_permlane32_swap_b32 v12, v10
v_permlane32_swap_b32 v13, v11
v_max_f32 v10, v12, v10
v_max_f32 v11, v13, v11
v_ceil_f32 v10, v10
v_ceil_f32 v11, v11
v_max_f32 v10, 0, v10
v_max_f32 v11, 0, v11
v_sub_f32 v96, v96, v10
v_sub_f32 v97, v97, v10
v_sub_f32 v98, v98, v10
v_sub_f32 v99, v99, v10
v_sub_f32 v100, v100, v11
v_sub_f32 v101, v101, v11
v_sub_f32 v102, v102, v11
v_sub_f32 v103, v103, v11
v_sub_f32 v104, v104, v10
v_sub_f32 v105, v105, v10
v_sub_f32 v106, v106, v10
v_sub_f32 v107, v107, v10
v_sub_f32 v108, v108, v11
v_sub_f32 v109, v109, v11
v_sub_f32 v110, v110, v11
v_sub_f32 v111, v111, v11
v_sub_f32 v112, v112, v10
v_sub_f32 v113, v113, v10
v_sub_f32 v114, v114, v10
v_sub_f32 v115, v115, v10
v_sub_f32 v116, v116, v11
v_sub_f32 v117, v117, v11
v_sub_f32 v118, v118, v11
v_sub_f32 v119, v119, v11
v_sub_f32 v120, v120, v10
v_sub_f32 v121, v121, v10
v_sub_f32 v122, v122, v10
v_sub_f32 v123, v123, v10
v_sub_f32 v124, v124, v11
v_sub_f32 v125, v125, v11
v_sub_f32 v126, v126, v11
v_sub_f32 v127, v127, v11
v_sub_f32 v64, v64, v10
v_sub_f32 v65, v65, v10
v_sub_f32 v66, v66, v10
v_sub_f32 v67, v67, v10
v_sub_f32 v68, v68, v11
v_sub_f32 v69, v69, v11
v_sub_f32 v70, v70, v11
v_sub_f32 v71, v71, v11
v_sub_f32 v72, v72, v10
v_sub_f32 v73, v73, v10
v_sub_f32 v74, v74, v10
v_sub_f32 v75, v75, v10
v_sub_f32 v76, v76, v11
v_sub_f32 v77, v77, v11
v_sub_f32 v78, v78, v11
v_sub_f32 v79, v79, v11
v_sub_f32 v80, v80, v10
v_sub_f32 v81, v81, v10
v_sub_f32 v82, v82, v10
v_sub_f32 v83, v83, v10
v_sub_f32 v84, v84, v11
v_sub_f32 v85, v85, v11
v_sub_f32 v86, v86, v11
v_sub_f32 v87, v87, v11
v_sub_f32 v88, v88, v10
v_sub_f32 v89, v89, v10
v_sub_f32 v90, v90, v10
v_sub_f32 v91, v91, v10
v_sub_f32 v92, v92, v11
v_sub_f32 v93, v93, v11
v_sub_f32 v94, v94, v11
v_sub_f32 v95, v95, v11
v_sub_f32 v32, v32, v10
v_sub_f32 v33, v33, v10
v_sub_f32 v34, v34, v10
v_sub_f32 v35, v35, v10
v_sub_f32 v36, v36, v11
v_sub_f32 v37, v37, v11
v_sub_f32 v38, v38, v11
v_sub_f32 v39, v39, v11
E v12,-v10
E v13,-v11
MF v30,v12,v30
MF v31,v13,v31
MF v128,v12,v128
MF v129,v12,v129
MF v130,v12,v130
MF v131,v12,v131
MF v132,v13,v132
MF v133,v13,v133
MF v134,v13,v134
MF v135,v13,v135
MF v136,v12,v136
MF v137,v12,v137
MF v138,v12,v138
MF v139,v12,v139
MF v140,v13,v140
MF v141,v13,v141
MF v142,v13,v142
MF v143,v13,v143
MF v144,v12,v144
MF v145,v12,v145
MF v146,v12,v146
MF v147,v12,v147
MF v148,v13,v148
MF v149,v13,v149
MF v150,v13,v150
MF v151,v13,v151
MF v152,v12,v152
MF v153,v12,v153
MF v154,v12,v154
MF v155,v12,v155
MF v156,v13,v156
MF v157,v13,v157
MF v158,v13,v158
MF v159,v13,v159
MF v160,v12,v160
MF v161,v12,v161
MF v162,v12,v162
MF v163,v12,v163
MF v164,v13,v164
MF v165,v13,v165
MF v166,v13,v166
MF v167,v13,v167
MF v168,v12,v168
MF v169,v12,v169
MF v170,v12,v170
MF v171,v12,v171
MF v172,v13,v172
MF v173,v13,v173
MF v174,v13,v174
MF v175,v13,v175
MF v176,v12,v176
MF v177,v12,v177
MF v178,v12,v178
MF v179,v12,v179
MF v180,v13,v180
MF v181,v13,v181
MF v182,v13,v182
MF v183,v13,v183
MF v184,v12,v184
MF v185,v12,v185
MF v186,v12,v186
MF v187,v12,v187
MF v188,v13,v188
MF v189,v13,v189
MF v190,v13,v190
MF v191,v13,v191
MF v192,v12,v192
MF v193,v12,v193
MF v194,v12,v194
MF v195,v12,v195
MF v196,v13,v196
MF v197,v13,v197
MF v198,v13,v198
MF v199,v13,v199
MF v200,v12,v200
MF v201,v12,v201
MF v202,v12,v202
MF v203,v12,v203
MF v204,v13,v204
MF v205,v13,v205
MF v206,v13,v206
MF v207,v13,v207
MF v208,v12,v208
MF v209,v12,v209
MF v210,v12,v210
MF v211,v12,v211
MF v212,v13,v212
MF v213,v13,v213
MF v214,v13,v214
MF v215,v13,v215
MF v216,v12,v216
MF v217,v12,v217
MF v218,v12,v218
MF v219,v12,v219
MF v220,v13,v220
MF v221,v13,v221
MF v222,v13,v222
MF v223,v13,v223
MF v224,v12,v224
MF v225,v12,v225
MF v226,v12,v226
MF v227,v12,v227
MF v228,v13,v228
MF v229,v13,v229
MF v230,v13,v230
MF v231,v13,v231
MF v232,v12,v232
MF v233,v12,v233
MF v234,v12,v234
MF v235,v12,v235
MF v236,v13,v236
MF v237,v13,v237
MF v238,v13,v238
MF v239,v13,v239
MF v240,v12,v240
MF v241,v12,v241
MF v242,v12,v242
MF v243,v12,v243
MF v244,v13,v244
MF v245,v13,v245
MF v246,v13,v246
MF v247,v13,v247
MF v248,v12,v248
MF v249,v12,v249
MF v250,v12,v250
MF v251,v12,v251
MF v252,v13,v252
MF v253,v13,v253
MF v254,v13,v254
MF v255,v13,v255
E v18,v96
E v19,v97
E v20,v98
AF v28,v18,v19
C v48,v18,v19
E v21,v99
E v22,v104
AF v28,v20,v28
C v49,v20,v21
E v23,v105
AF v28,v21,v28
E v24,v106
AF v28,v22,v28
C v50,v22,v23
E v25,v107
AF v28,v23,v28
E v18,v100
AF v28,v24,v28
C v51,v24,v25
E v19,v101
AF v28,v25,v28
E v20,v102
AF v29,v18,v19
C v52,v18,v19
E v21,v103
E v22,v108
AF v29,v20,v29
C v53,v20,v21
E v23,v109
AF v29,v21,v29
E v24,v110
AF v29,v22,v29
C v54,v22,v23
E v25,v111
AF v29,v23,v29
AF v29,v24,v29
C v55,v24,v25
AF v29,v25,v29
E v18,v112
E v19,v113
E v20,v114
AF v28,v18,v28
C v56,v18,v19
E v21,v115
AF v28,v19,v28
E v22,v120
AF v28,v20,v28
C v57,v20,v21
E v23,v121
AF v28,v21,v28
E v24,v122
AF v28,v22,v28
C v58,v22,v23
E v25,v123
AF v28,v23,v28
E v18,v116
AF v28,v24,v28
C v59,v24,v25
E v19,v117
AF v28,v25,v28
E v20,v118
AF v29,v18,v29
C v60,v18,v19
E v21,v119
AF v29,v19,v29
E v22,v124
AF v29,v20,v29
C v61,v20,v21
E v23,v125
AF v29,v21,v29
E v24,v126
AF v29,v22,v29
C v62,v22,v23
E v25,v127
AF v29,v23,v29
AF v29,v24,v29
C v63,v24,v25
AF v29,v25,v29
s_nop 3
s_setpc_b64 s[36:37]
L_slow1n:
s_nop 7
s_nop 3
v_max3_f32 v10, v96, v97, v98
v_max3_f32 v10, v99, v104, v10
v_max3_f32 v10, v105, v106, v10
v_max3_f32 v10, v107, v112, v10
v_max3_f32 v10, v113, v114, v10
v_max3_f32 v10, v115, v120, v10
v_max3_f32 v10, v121, v122, v10
v_max_f32 v10, v123, v10
v_max3_f32 v11, v100, v101, v102
v_max3_f32 v11, v103, v108, v11
v_max3_f32 v11, v109, v110, v11
v_max3_f32 v11, v111, v116, v11
v_max3_f32 v11, v117, v118, v11
v_max3_f32 v11, v119, v124, v11
v_max3_f32 v11, v125, v126, v11
v_max_f32 v11, v127, v11
v_mov_b32 v12, v10
v_mov_b32 v13, v11
s_nop 0
v_permlane16_swap_b32 v12, v10
v_permlane16_swap_b32 v13, v11
v_max_f32 v10, v12, v10
v_max_f32 v11, v13, v11
v_mov_b32 v12, v10
v_mov_b32 v13, v11
s_nop 0
v_permlane32_swap_b32 v12, v10
v_permlane32_swap_b32 v13, v11
v_max_f32 v10, v12, v10
v_max_f32 v11, v13, v11
v_ceil_f32 v10, v10
v_ceil_f32 v11, v11
v_max_f32 v10, 0, v10
v_max_f32 v11, 0, v11
v_sub_f32 v96, v96, v10
v_sub_f32 v97, v97, v10
v_sub_f32 v98, v98, v10
v_sub_f32 v99, v99, v10
v_sub_f32 v100, v100, v11
v_sub_f32 v101, v101, v11
v_sub_f32 v102, v102, v11
v_sub_f32 v103, v103, v11
v_sub_f32 v104, v104, v10
v_sub_f32 v105, v105, v10
v_sub_f32 v106, v106, v10
v_sub_f32 v107, v107, v10
v_sub_f32 v108, v108, v11
v_sub_f32 v109, v109, v11
v_sub_f32 v110, v110, v11
v_sub_f32 v111, v111, v11
v_sub_f32 v112, v112, v10
v_sub_f32 v113, v113, v10
v_sub_f32 v114, v114, v10
v_sub_f32 v115, v115, v10
v_sub_f32 v116, v116, v11
v_sub_f32 v117, v117, v11
v_sub_f32 v118, v118, v11
v_sub_f32 v119, v119, v11
v_sub_f32 v120, v120, v10
v_sub_f32 v121, v121, v10
v_sub_f32 v122, v122, v10
v_sub_f32 v123, v123, v10
v_sub_f32 v124, v124, v11
v_sub_f32 v125, v125, v11
v_sub_f32 v126, v126, v11
v_sub_f32 v127, v127, v11
v_sub_f32 v32, v32, v10
v_sub_f32 v33, v33, v10
v_sub_f32 v34, v34, v10
v_sub_f32 v35, v35, v10
v_sub_f32 v36, v36, v11
v_sub_f32 v37, v37, v11
v_sub_f32 v38, v38, v11
v_sub_f32 v39, v39, v11
E v12,-v10
E v13,-v11
MF v30,v12,v30
MF v31,v13,v31
MF v128,v12,v128
MF v129,v12,v129
MF v130,v12,v130
MF v131,v12,v131
MF v132,v13,v132
MF v133,v13,v133
MF v134,v13,v134
MF v135,v13,v135
MF v136,v12,v136
MF v137,v12,v137
MF v138,v12,v138
MF v139,v12,v139
MF v140,v13,v140
MF v141,v13,v141
MF v142,v13,v142
MF v143,v13,v143
MF v144,v12,v144
MF v145,v12,v145
MF v146,v12,v146
MF v147,v12,v147
MF v148,v13,v148
MF v149,v13,v149
MF v150,v13,v150
MF v151,v13,v151
MF v152,v12,v152
MF v153,v12,v153
MF v154,v12,v154
MF v155,v12,v155
MF v156,v13,v156
MF v157,v13,v157
MF v158,v13,v158
MF v159,v13,v159
MF v160,v12,v160
MF v161,v12,v161
MF v162,v12,v162
MF v163,v12,v163
MF v164,v13,v164
MF v165,v13,v165
MF v166,v13,v166
MF v167,v13,v167
MF v168,v12,v168
MF v169,v12,v169
MF v170,v12,v170
MF v171,v12,v171
MF v172,v13,v172
MF v173,v13,v173
MF v174,v13,v174
MF v175,v13,v175
MF v176,v12,v176
MF v177,v12,v177
MF v178,v12,v178
MF v179,v12,v179
MF v180,v13,v180
MF v181,v13,v181
MF v182,v13,v182
MF v183,v13,v183
MF v184,v12,v184
MF v185,v12,v185
MF v186,v12,v186
MF v187,v12,v187
MF v188,v13,v188
MF v189,v13,v189
MF v190,v13,v190
MF v191,v13,v191
MF v192,v12,v192
MF v193,v12,v193
MF v194,v12,v194
MF v195,v12,v195
MF v196,v13,v196
MF v197,v13,v197
MF v198,v13,v198
MF v199,v13,v199
MF v200,v12,v200
MF v201,v12,v201
MF v202,v12,v202
MF v203,v12,v203
MF v204,v13,v204
MF v205,v13,v205
MF v206,v13,v206
MF v207,v13,v207
MF v208,v12,v208
MF v209,v12,v209
MF v210,v12,v210
MF v211,v12,v211
MF v212,v13,v212
MF v213,v13,v213
MF v214,v13,v214
MF v215,v13,v215
MF v216,v12,v216
MF v217,v12,v217
MF v218,v12,v218
MF v219,v12,v219
MF v220,v13,v220
MF v221,v13,v221
MF v222,v13,v222
MF v223,v13,v223
MF v224,v12,v224
MF v225,v12,v225
MF v226,v12,v226
MF v227,v12,v227
MF v228,v13,v228
MF v229,v13,v229
MF v230,v13,v230
MF v231,v13,v231
MF v232,v12,v232
MF v233,v12,v233
MF v234,v12,v234
MF v235,v12,v235
MF v236,v13,v236
MF v237,v13,v237
MF v238,v13,v238
MF v239,v13,v239
MF v240,v12,v240
MF v241,v12,v241
MF v242,v12,v242
MF v243,v12,v243
MF v244,v13,v244
MF v245,v13,v245
MF v246,v13,v246
MF v247,v13,v247
MF v248,v12,v248
MF v249,v12,v249
MF v250,v12,v250
MF v251,v12,v251
MF v252,v13,v252
MF v253,v13,v253
MF v254,v13,v254
MF v255,v13,v255
E v18,v96
E v19,v97
E v20,v98
AF v28,v18,v19
C v48,v18,v19
E v21,v99
E v22,v104
AF v28,v20,v28
C v49,v20,v21
E v23,v105
AF v28,v21,v28
E v24,v106
AF v28,v22,v28
C v50,v22,v23
E v25,v107
AF v28,v23,v28
E v18,v100
AF v28,v24,v28
C v51,v24,v25
E v19,v101
AF v28,v25,v28
E v20,v102
AF v29,v18,v19
C v52,v18,v19
E v21,v103
E v22,v108
AF v29,v20,v29
C v53,v20,v21
E v23,v109
AF v29,v21,v29
E v24,v110
AF v29,v22,v29
C v54,v22,v23
E v25,v111
AF v29,v23,v29
AF v29,v24,v29
C v55,v24,v25
AF v29,v25,v29
E v18,v112
E v19,v113
E v20,v114
AF v28,v18,v28
C v56,v18,v19
E v21,v115
AF v28,v19,v28
E v22,v120
AF v28,v20,v28
C v57,v20,v21
E v23,v121
AF v28,v21,v28
E v24,v122
AF v28,v22,v28
C v58,v22,v23
E v25,v123
AF v28,v23,v28
E v18,v116
AF v28,v24,v28
C v59,v24,v25
E v19,v117
AF v28,v25,v28
E v20,v118
AF v29,v18,v29
C v60,v18,v19
E v21,v119
AF v29,v19,v29
E v22,v124
AF v29,v20,v29
C v61,v20,v21
E v23,v125
AF v29,v21,v29
E v24,v126
AF v29,v22,v29
C v62,v22,v23
E v25,v127
AF v29,v23,v29
AF v29,v24,v29
C v63,v24,v25
AF v29,v25,v29
s_nop 3
s_setpc_b64 s[36:37]
L_slowf:
s_nop 7
s_nop 3
v_max3_f32 v10, v64, v65, v66
v_max3_f32 v10, v67, v72, v10
v_max3_f32 v10, v73, v74, v10
v_max3_f32 v10, v75, v80, v10
v_max3_f32 v10, v81, v82, v10
v_max3_f32 v10, v83, v88, v10
v_max3_f32 v10, v89, v90, v10
v_max_f32 v10, v91, v10
v_max3_f32 v11, v68, v69, v70
v_max3_f32 v11, v71, v76, v11
v_max3_f32 v11, v77, v78, v11
v_max3_f32 v11, v79, v84, v11
v_max3_f32 v11, v85, v86, v11
v_max3_f32 v11, v87, v92, v11
v_max3_f32 v11, v93, v94, v11
v_max_f32 v11, v95, v11
v_mov_b32 v12, v10
v_mov_b32 v13, v11
s_nop 0
v_permlane16_swap_b32 v12, v10
v_permlane16_swap_b32 v13, v11
v_max_f32 v10, v12, v10
v_max_f32 v11, v13, v11
v_mov_b32 v12, v10
v_mov_b32 v13, v11
s_nop 0
v_permlane32_swap_b32 v12, v10
v_permlane32_swap_b32 v13, v11
v_max_f32 v10, v12, v10
v_max_f32 v11, v13, v11
v_ceil_f32 v10, v10
v_ceil_f32 v11, v11
v_sub_f32 v64, v64, v10
v_sub_f32 v65, v65, v10
v_sub_f32 v66, v66, v10
v_sub_f32 v67, v67, v10
v_sub_f32 v68, v68, v11
v_sub_f32 v69, v69, v11
v_sub_f32 v70, v70, v11
v_sub_f32 v71, v71, v11
v_sub_f32 v72, v72, v10
v_sub_f32 v73, v73, v10
v_sub_f32 v74, v74, v10
v_sub_f32 v75, v75, v10
v_sub_f32 v76, v76, v11
v_sub_f32 v77, v77, v11
v_sub_f32 v78, v78, v11
v_sub_f32 v79, v79, v11
v_sub_f32 v80, v80, v10
v_sub_f32 v81, v81, v10
v_sub_f32 v82, v82, v10
v_sub_f32 v83, v83, v10
v_sub_f32 v84, v84, v11
v_sub_f32 v85, v85, v11
v_sub_f32 v86, v86, v11
v_sub_f32 v87, v87, v11
v_sub_f32 v88, v88, v10
v_sub_f32 v89, v89, v10
v_sub_f32 v90, v90, v10
v_sub_f32 v91, v91, v10
v_sub_f32 v92, v92, v11
v_sub_f32 v93, v93, v11
v_sub_f32 v94, v94, v11
v_sub_f32 v95, v95, v11
v_sub_f32 v96, v96, v10
v_sub_f32 v97, v97, v10
v_sub_f32 v98, v98, v10
v_sub_f32 v99, v99, v10
v_sub_f32 v100, v100, v11
v_sub_f32 v101, v101, v11
v_sub_f32 v102, v102, v11
v_sub_f32 v103, v103, v11
v_sub_f32 v104, v104, v10
v_sub_f32 v105, v105, v10
v_sub_f32 v106, v106, v10
v_sub_f32 v107, v107, v10
v_sub_f32 v108, v108, v11
v_sub_f32 v109, v109, v11
v_sub_f32 v110, v110, v11
v_sub_f32 v111, v111, v11
v_sub_f32 v112, v112, v10
v_sub_f32 v113, v113, v10
v_sub_f32 v114, v114, v10
v_sub_f32 v115, v115, v10
v_sub_f32 v116, v116, v11
v_sub_f32 v117, v117, v11
v_sub_f32 v118, v118, v11
v_sub_f32 v119, v119, v11
v_sub_f32 v120, v120, v10
v_sub_f32 v121, v121, v10
v_sub_f32 v122, v122, v10
v_sub_f32 v123, v123, v10
v_sub_f32 v124, v124, v11
v_sub_f32 v125, v125, v11
v_sub_f32 v126, v126, v11
v_sub_f32 v127, v127, v11
v_sub_f32 v32, v32, v10
v_sub_f32 v33, v33, v10
v_sub_f32 v34, v34, v10
v_sub_f32 v35, v35, v10
v_sub_f32 v36, v36, v11
v_sub_f32 v37, v37, v11
v_sub_f32 v38, v38, v11
v_sub_f32 v39, v39, v11
E v18,v64
E v19,v65
E v20,v66
AF v26,v18,v19
C v40,v18,v19
E v21,v67
E v22,v72
AF v26,v20,v26
C v41,v20,v21
E v23,v73
AF v26,v21,v26
E v24,v74
AF v26,v22,v26
C v42,v22,v23
E v25,v75
AF v26,v23,v26
E v18,v68
AF v26,v24,v26
C v43,v24,v25
E v19,v69
AF v26,v25,v26
E v20,v70
AF v27,v18,v19
C v44,v18,v19
E v21,v71
E v22,v76
AF v27,v20,v27
C v45,v20,v21
E v23,v77
AF v27,v21,v27
E v24,v78
AF v27,v22,v27
C v46,v22,v23
E v25,v79
AF v27,v23,v27
AF v27,v24,v27
C v47,v24,v25
AF v27,v25,v27
E v18,v80
E v19,v81
E v20,v82
AF v26,v18,v26
C v56,v18,v19
E v21,v83
AF v26,v19,v26
E v22,v88
AF v26,v20,v26
C v57,v20,v21
E v23,v89
AF v26,v21,v26
E v24,v90
AF v26,v22,v26
C v58,v22,v23
E v25,v91
AF v26,v23,v26
E v18,v84
AF v26,v24,v26
C v59,v24,v25
E v19,v85
AF v26,v25,v26
E v20,v86
AF v27,v18,v27
C v60,v18,v19
E v21,v87
AF v27,v19,v27
E v22,v92
AF v27,v20,v27
C v61,v20,v21
E v23,v93
AF v27,v21,v27
E v24,v94
AF v27,v22,v27
C v62,v22,v23
E v25,v95
AF v27,v23,v27
AF v27,v24,v27
C v63,v24,v25
AF v27,v25,v27
s_nop 3
s_setpc_b64 s[36:37]
L_slowj:
s_nop 7
s_nop 3
v_max3_f32 v10, v64, v65, v66
v_max3_f32 v10, v67, v72, v10
v_max3_f32 v10, v73, v74, v10
v_max3_f32 v10, v75, v80, v10
v_max3_f32 v10, v81, v82, v10
v_max3_f32 v10, v83, v88, v10
v_max3_f32 v10, v89, v90, v10
v_max_f32 v10, v91, v10
v_max3_f32 v11, v68, v69, v70
v_max3_f32 v11, v71, v76, v11
v_max3_f32 v11, v77, v78, v11
v_max3_f32 v11, v79, v84, v11
v_max3_f32 v11, v85, v86, v11
v_max3_f32 v11, v87, v92, v11
v_max3_f32 v11, v93, v94, v11
v_max_f32 v11, v95, v11
v_mov_b32 v12, v10
v_mov_b32 v13, v11
s_nop 0
v_permlane16_swap_b32 v12, v10
v_permlane16_swap_b32 v13, v11
v_max_f32 v10, v12, v10
v_max_f32 v11, v13, v11
v_mov_b32 v12, v10
v_mov_b32 v13, v11
s_nop 0
v_permlane32_swap_b32 v12, v10
v_permlane32_swap_b32 v13, v11
v_max_f32 v10, v12, v10
v_max_f32 v11, v13, v11
v_ceil_f32 v10, v10
v_ceil_f32 v11, v11
v_sub_f32 v64, v64, v10
v_sub_f32 v65, v65, v10
v_sub_f32 v66, v66, v10
v_sub_f32 v67, v67, v10
v_sub_f32 v68, v68, v11
v_sub_f32 v69, v69, v11
v_sub_f32 v70, v70, v11
v_sub_f32 v71, v71, v11
v_sub_f32 v72, v72, v10
v_sub_f32 v73, v73, v10
v_sub_f32 v74, v74, v10
v_sub_f32 v75, v75, v10
v_sub_f32 v76, v76, v11
v_sub_f32 v77, v77, v11
v_sub_f32 v78, v78, v11
v_sub_f32 v79, v79, v11
v_sub_f32 v80, v80, v10
v_sub_f32 v81, v81, v10
v_sub_f32 v82, v82, v10
v_sub_f32 v83, v83, v10
v_sub_f32 v84, v84, v11
v_sub_f32 v85, v85, v11
v_sub_f32 v86, v86, v11
v_sub_f32 v87, v87, v11
v_sub_f32 v88, v88, v10
v_sub_f32 v89, v89, v10
v_sub_f32 v90, v90, v10
v_sub_f32 v91, v91, v10
v_sub_f32 v92, v92, v11
v_sub_f32 v93, v93, v11
v_sub_f32 v94, v94, v11
v_sub_f32 v95, v95, v11
v_sub_f32 v32, v32, v10
v_sub_f32 v33, v33, v10
v_sub_f32 v34, v34, v10
v_sub_f32 v35, v35, v10
v_sub_f32 v36, v36, v11
v_sub_f32 v37, v37, v11
v_sub_f32 v38, v38, v11
v_sub_f32 v39, v39, v11
E v18,v64
E v19,v65
E v20,v66
AF v26,v18,v19
C v40,v18,v19
E v21,v67
E v22,v72
AF v26,v20,v26
C v41,v20,v21
E v23,v73
AF v26,v21,v26
E v24,v74
AF v26,v22,v26
C v42,v22,v23
E v25,v75
AF v26,v23,v26
E v18,v68
AF v26,v24,v26
C v43,v24,v25
E v19,v69
AF v26,v25,v26
E v20,v70
AF v27,v18,v19
C v44,v18,v19
E v21,v71
E v22,v76
AF v27,v20,v27
C v45,v20,v21
E v23,v77
AF v27,v21,v27
E v24,v78
AF v27,v22,v27
C v46,v22,v23
E v25,v79
AF v27,v23,v27
AF v27,v24,v27
C v47,v24,v25
AF v27,v25,v27
s_nop 3
s_setpc_b64 s[36:37]
L_slowb:
s_nop 7
s_nop 3
v_max3_f32 v11, v100, v101, v102
v_max3_f32 v11, v103, v108, v11
v_max3_f32 v11, v109, v110, v11
v_max3_f32 v11, v111, v116, v11
v_max3_f32 v11, v117, v118, v11
v_max3_f32 v11, v119, v124, v11
v_max3_f32 v11, v125, v126, v11
v_max_f32 v11, v127, v11
v_mov_b32 v13, v11
s_nop 1
v_permlane16_swap_b32 v13, v11
v_max_f32 v11, v13, v11
v_mov_b32 v13, v11
s_nop 1
v_permlane32_swap_b32 v13, v11
v_max_f32 v11, v13, v11
v_ceil_f32 v11, v11
v_max_f32 v11, 0, v11
v_mov_b32 v10, 0
v_sub_f32 v100, v100, v11
v_sub_f32 v101, v101, v11
v_sub_f32 v102, v102, v11
v_sub_f32 v103, v103, v11
v_sub_f32 v108, v108, v11
v_sub_f32 v109, v109, v11
v_sub_f32 v110, v110, v11
v_sub_f32 v111, v111, v11
v_sub_f32 v116, v116, v11
v_sub_f32 v117, v117, v11
v_sub_f32 v118, v118, v11
v_sub_f32 v119, v119, v11
v_sub_f32 v124, v124, v11
v_sub_f32 v125, v125, v11
v_sub_f32 v126, v126, v11
v_sub_f32 v127, v127, v11
v_sub_f32 v32, v32, v10
v_sub_f32 v33, v33, v10
v_sub_f32 v34, v34, v10
v_sub_f32 v35, v35, v10
v_sub_f32 v36, v36, v11
v_sub_f32 v37, v37, v11
v_sub_f32 v38, v38, v11
v_sub_f32 v39, v39, v11
E v12,-v10
E v13,-v11
MF v30,v12,v30
MF v31,v13,v31
MF v128,v12,v128
MF v129,v12,v129
MF v130,v12,v130
MF v131,v12,v131
MF v132,v13,v132
MF v133,v13,v133
MF v134,v13,v134
MF v135,v13,v135
MF v136,v12,v136
MF v137,v12,v137
MF v138,v12,v138
MF v139,v12,v139
MF v140,v13,v140
MF v141,v13,v141
MF v142,v13,v142
MF v143,v13,v143
MF v144,v12,v144
MF v145,v12,v145
MF v146,v12,v146
MF v147,v12,v147
MF v148,v13,v148
MF v149,v13,v149
MF v150,v13,v150
MF v151,v13,v151
MF v152,v12,v152
MF v153,v12,v153
MF v154,v12,v154
MF v155,v12,v155
MF v156,v13,v156
MF v157,v13,v157
MF v158,v13,v158
MF v159,v13,v159
MF v160,v12,v160
MF v161,v12,v161
MF v162,v12,v162
MF v163,v12,v163
MF v164,v13,v164
MF v165,v13,v165
MF v166,v13,v166
MF v167,v13,v167
MF v168,v12,v168
MF v169,v12,v169
MF v170,v12,v170
MF v171,v12,v171
MF v172,v13,v172
MF v173,v13,v173
MF v174,v13,v174
MF v175,v13,v175
MF v176,v12,v176
MF v177,v12,v177
MF v178,v12,v178
MF v179,v12,v179
MF v180,v13,v180
MF v181,v13,v181
MF v182,v13,v182
MF v183,v13,v183
MF v184,v12,v184
MF v185,v12,v185
MF v186,v12,v186
MF v187,v12,v187
MF v188,v13,v188
MF v189,v13,v189
MF v190,v13,v190
MF v191,v13,v191
MF v192,v12,v192
MF v193,v12,v193
MF v194,v12,v194
MF v195,v12,v195
MF v196,v13,v196
MF v197,v13,v197
MF v198,v13,v198
MF v199,v13,v199
MF v200,v12,v200
MF v201,v12,v201
MF v202,v12,v202
MF v203,v12,v203
MF v204,v13,v204
MF v205,v13,v205
MF v206,v13,v206
MF v207,v13,v207
MF v208,v12,v208
MF v209,v12,v209
MF v210,v12,v210
MF v211,v12,v211
MF v212,v13,v212
MF v213,v13,v213
MF v214,v13,v214
MF v215,v13,v215
MF v216,v12,v216
MF v217,v12,v217
MF v218,v12,v218
MF v219,v12,v219
MF v220,v13,v220
MF v221,v13,v221
MF v222,v13,v222
MF v223,v13,v223
MF v224,v12,v224
MF v225,v12,v225
MF v226,v12,v226
MF v227,v12,v227
MF v228,v13,v228
MF v229,v13,v229
MF v230,v13,v230
MF v231,v13,v231
MF v232,v12,v232
MF v233,v12,v233
MF v234,v12,v234
MF v235,v12,v235
MF v236,v13,v236
MF v237,v13,v237
MF v238,v13,v238
MF v239,v13,v239
MF v240,v12,v240
MF v241,v12,v241
MF v242,v12,v242
MF v243,v12,v243
MF v244,v13,v244
MF v245,v13,v245
MF v246,v13,v246
MF v247,v13,v247
MF v248,v12,v248
MF v249,v12,v249
MF v250,v12,v250
MF v251,v12,v251
MF v252,v13,v252
MF v253,v13,v253
MF v254,v13,v254
MF v255,v13,v255
E v18,v100
E v19,v101
E v20,v102
AF v29,v18,v19
C v52,v18,v19
E v21,v103
E v22,v108
AF v29,v20,v29
C v53,v20,v21
E v23,v109
AF v29,v21,v29
E v24,v110
AF v29,v22,v29
C v54,v22,v23
E v25,v111
AF v29,v23,v29
E v18,v116
AF v29,v24,v29
C v55,v24,v25
E v19,v117
AF v29,v25,v29
E v20,v118
AF v29,v18,v29
C v48,v18,v19
E v21,v119
AF v29,v19,v29
E v22,v124
AF v29,v20,v29
C v49,v20,v21
E v23,v125
AF v29,v21,v29
E v24,v126
AF v29,v22,v29
C v50,v22,v23
E v25,v127
AF v29,v23,v29
AF v29,v24,v29
C v51,v24,v25
AF v29,v25,v29
s_nop 3
s_setpc_b64 s[36:37]
L_comb:
s_waitcnt vmcnt(0)
s_nop 7
v_sub_f32 v10, v32, v14
v_sub_f32 v11, v36, v15
v_max_f32 v10, 0, v10
v_max_f32 v11, 0, v11
v_sub_f32 v100, v100, v11
v_sub_f32 v101, v101, v11
v_sub_f32 v102, v102, v11
v_sub_f32 v103, v103, v11
v_sub_f32 v108, v108, v11
v_sub_f32 v109, v109, v11
v_sub_f32 v110, v110, v11
v_sub_f32 v111, v111, v11
v_sub_f32 v116, v116, v11
v_sub_f32 v117, v117, v11
v_sub_f32 v118, v118, v11
v_sub_f32 v119, v119, v11
v_sub_f32 v124, v124, v11
v_sub_f32 v125, v125, v11
v_sub_f32 v126, v126, v11
v_sub_f32 v127, v127, v11
v_sub_f32 v32, v32, v10
v_sub_f32 v33, v33, v10
v_sub_f32 v34, v34, v10
v_sub_f32 v35, v35, v10
v_sub_f32 v36, v36, v11
v_sub_f32 v37, v37, v11
v_sub_f32 v38, v38, v11
v_sub_f32 v39, v39, v11
E v12,-v10
E v13,-v11
MF v30,v12,v30
MF v31,v13,v31
MF v128,v12,v128
MF v129,v12,v129
MF v130,v12,v130
MF v131,v12,v131
MF v132,v13,v132
MF v133,v13,v133
MF v134,v13,v134
MF v135,v13,v135
MF v136,v12,v136
MF v137,v12,v137
MF v138,v12,v138
MF v139,v12,v139
MF v140,v13,v140
MF v141,v13,v141
MF v142,v13,v142
MF v143,v13,v143
MF v144,v12,v144
MF v145,v12,v145
MF v146,v12,v146
MF v147,v12,v147
MF v148,v13,v148
MF v149,v13,v149
MF v150,v13,v150
MF v151,v13,v151
MF v152,v12,v152
MF v153,v12,v153
MF v154,v12,v154
MF v155,v12,v155
MF v156,v13,v156
MF v157,v13,v157
MF v158,v13,v158
MF v159,v13,v159
MF v160,v12,v160
MF v161,v12,v161
MF v162,v12,v162
MF v163,v12,v163
MF v164,v13,v164
MF v165,v13,v165
MF v166,v13,v166
MF v167,v13,v167
MF v168,v12,v168
MF v169,v12,v169
MF v170,v12,v170
MF v171,v12,v171
MF v172,v13,v172
MF v173,v13,v173
MF v174,v13,v174
MF v175,v13,v175
MF v176,v12,v176
MF v177,v12,v177
MF v178,v12,v178
MF v179,v12,v179
MF v180,v13,v180
MF v181,v13,v181
MF v182,v13,v182
MF v183,v13,v183
MF v184,v12,v184
MF v185,v12,v185
MF v186,v12,v186
MF v187,v12,v187
MF v188,v13,v188
MF v189,v13,v189
MF v190,v13,v190
MF v191,v13,v191
MF v192,v12,v192
MF v193,v12,v193
MF v194,v12,v194
MF v195,v12,v195
MF v196,v13,v196
MF v197,v13,v197
MF v198,v13,v198
MF v199,v13,v199
MF v200,v12,v200
MF v201,v12,v201
MF v202,v12,v202
MF v203,v12,v203
MF v204,v13,v204
MF v205,v13,v205
MF v206,v13,v206
MF v207,v13,v207
MF v208,v12,v208
MF v209,v12,v209
MF v210,v12,v210
MF v211,v12,v211
MF v212,v13,v212
MF v213,v13,v213
MF v214,v13,v214
MF v215,v13,v215
MF v216,v12,v216
MF v217,v12,v217
MF v218,v12,v218
MF v219,v12,v219
MF v220,v13,v220
MF v221,v13,v221
MF v222,v13,v222
MF v223,v13,v223
MF v224,v12,v224
MF v225,v12,v225
MF v226,v12,v226
MF v227,v12,v227
MF v228,v13,v228
MF v229,v13,v229
MF v230,v13,v230
MF v231,v13,v231
MF v232,v12,v232
MF v233,v12,v233
MF v234,v12,v234
MF v235,v12,v235
MF v236,v13,v236
MF v237,v13,v237
MF v238,v13,v238
MF v239,v13,v239
MF v240,v12,v240
MF v241,v12,v241
MF v242,v12,v242
MF v243,v12,v243
MF v244,v13,v244
MF v245,v13,v245
MF v246,v13,v246
MF v247,v13,v247
MF v248,v12,v248
MF v249,v12,v249
MF v250,v12,v250
MF v251,v12,v251
MF v252,v13,v252
MF v253,v13,v253
MF v254,v13,v254
MF v255,v13,v255
E v18,v100
E v19,v101
E v20,v102
AF v29,v18,v19
C v52,v18,v19
E v21,v103
E v22,v108
AF v29,v20,v29
C v53,v20,v21
E v23,v109
AF v29,v21,v29
E v24,v110
AF v29,v22,v29
C v54,v22,v23
E v25,v111
AF v29,v23,v29
E v18,v116
AF v29,v24,v29
C v55,v24,v25
E v19,v117
AF v29,v25,v29
E v20,v118
AF v29,v18,v29
C v48,v18,v19
E v21,v119
AF v29,v19,v29
E v22,v124
AF v29,v20,v29
C v49,v20,v21
E v23,v125
AF v29,v21,v29
E v24,v126
AF v29,v22,v29
C v50,v22,v23
E v25,v127
AF v29,v23,v29
AF v29,v24,v29
C v51,v24,v25
AF v29,v25,v29
v_sub_f32 v10, v32, v14
v_sub_f32 v11, v36, v15
E v10,v10
E v11,v11
s_nop 0
MF v16,v10,v16
MF v17,v11,v17
G v64,a128
v_and_b32 v65, 0xffff0000, v64
v_lshlrev_b32 v64, 16, v64
MF v64,v10,v64
MF v65,v10,v65
C v64,v64,v65
W a128,v64
G v66,a129
v_and_b32 v67, 0xffff0000, v66
v_lshlrev_b32 v66, 16, v66
MF v66,v10,v66
MF v67,v10,v67
C v66,v66,v67
W a129,v66
G v68,a130
v_and_b32 v69, 0xffff0000, v68
v_lshlrev_b32 v68, 16, v68
MF v68,v10,v68
MF v69,v10,v69
C v68,v68,v69
W a130,v68
G v70,a131
v_and_b32 v71, 0xffff0000, v70
v_lshlrev_b32 v70, 16, v70
MF v70,v10,v70
MF v71,v10,v71
C v70,v70,v71
W a131,v70
G v72,a132
v_and_b32 v73, 0xffff0000, v72
v_lshlrev_b32 v72, 16, v72
MF v72,v10,v72
MF v73,v10,v73
C v72,v72,v73
W a132,v72
G v74,a133
v_and_b32 v75, 0xffff0000, v74
v_lshlrev_b32 v74, 16, v74
MF v74,v10,v74
MF v75,v10,v75
C v74,v74,v75
W a133,v74
G v76,a134
v_and_b32 v77, 0xffff0000, v76
v_lshlrev_b32 v76, 16, v76
MF v76,v10,v76
MF v77,v10,v77
C v76,v76,v77
W a134,v76
G v78,a135
v_and_b32 v79, 0xffff0000, v78
v_lshlrev_b32 v78, 16, v78
MF v78,v10,v78
MF v79,v10,v79
C v78,v78,v79
W a135,v78
G v64,a136
v_and_b32 v65, 0xffff0000, v64
v_lshlrev_b32 v64, 16, v64
MF v64,v10,v64
MF v65,v10,v65
C v64,v64,v65
W a136,v64
G v66,a137
v_and_b32 v67, 0xffff0000, v66
v_lshlrev_b32 v66, 16, v66
MF v66,v10,v66
MF v67,v10,v67
C v66,v66,v67
W a137,v66
G v68,a138
v_and_b32 v69, 0xffff0000, v68
v_lshlrev_b32 v68, 16, v68
MF v68,v10,v68
MF v69,v10,v69
C v68,v68,v69
W a138,v68
G v70,a139
v_and_b32 v71, 0xffff0000, v70
v_lshlrev_b32 v70, 16, v70
MF v70,v10,v70
MF v71,v10,v71
C v70,v70,v71
W a139,v70
G v72,a140
v_and_b32 v73, 0xffff0000, v72
v_lshlrev_b32 v72, 16, v72
MF v72,v10,v72
MF v73,v10,v73
C v72,v72,v73
W a140,v72
G v74,a141
v_and_b32 v75, 0xffff0000, v74
v_lshlrev_b32 v74, 16, v74
MF v74,v10,v74
MF v75,v10,v75
C v74,v74,v75
W a141,v74
G v76,a142
v_and_b32 v77, 0xffff0000, v76
v_lshlrev_b32 v76, 16, v76
MF v76,v10,v76
MF v77,v10,v77
C v76,v76,v77
W a142,v76
G v78,a143
v_and_b32 v79, 0xffff0000, v78
v_lshlrev_b32 v78, 16, v78
MF v78,v10,v78
MF v79,v10,v79
C v78,v78,v79
W a143,v78
G v64,a144
v_and_b32 v65, 0xffff0000, v64
v_lshlrev_b32 v64, 16, v64
MF v64,v10,v64
MF v65,v10,v65
C v64,v64,v65
W a144,v64
G v66,a145
v_and_b32 v67, 0xffff0000, v66
v_lshlrev_b32 v66, 16, v66
MF v66,v10,v66
MF v67,v10,v67
C v66,v66,v67
W a145,v66
G v68,a146
v_and_b32 v69, 0xffff0000, v68
v_lshlrev_b32 v68, 16, v68
MF v68,v10,v68
MF v69,v10,v69
C v68,v68,v69
W a146,v68
G v70,a147
v_and_b32 v71, 0xffff0000, v70
v_lshlrev_b32 v70, 16, v70
MF v70,v10,v70
MF v71,v10,v71
C v70,v70,v71
W a147,v70
G v72,a148
v_and_b32 v73, 0xffff0000, v72
v_lshlrev_b32 v72, 16, v72
MF v72,v10,v72
MF v73,v10,v73
C v72,v72,v73
W a148,v72
G v74,a149
v_and_b32 v75, 0xffff0000, v74
v_lshlrev_b32 v74, 16, v74
MF v74,v10,v74
MF v75,v10,v75
C v74,v74,v75
W a149,v74
G v76,a150
v_and_b32 v77, 0xffff0000, v76
v_lshlrev_b32 v76, 16, v76
MF v76,v10,v76
MF v77,v10,v77
C v76,v76,v77
W a150,v76
G v78,a151
v_and_b32 v79, 0xffff0000, v78
v_lshlrev_b32 v78, 16, v78
MF v78,v10,v78
MF v79,v10,v79
C v78,v78,v79
W a151,v78
G v64,a152
v_and_b32 v65, 0xffff0000, v64
v_lshlrev_b32 v64, 16, v64
MF v64,v10,v64
MF v65,v10,v65
C v64,v64,v65
W a152,v64
G v66,a153
v_and_b32 v67, 0xffff0000, v66
v_lshlrev_b32 v66, 16, v66
MF v66,v10,v66
MF v67,v10,v67
C v66,v66,v67
W a153,v66
G v68,a154
v_and_b32 v69, 0xffff0000, v68
v_lshlrev_b32 v68, 16, v68
MF v68,v10,v68
MF v69,v10,v69
C v68,v68,v69
W a154,v68
G v70,a155
v_and_b32 v71, 0xffff0000, v70
v_lshlrev_b32 v70, 16, v70
MF v70,v10,v70
MF v71,v10,v71
C v70,v70,v71
W a155,v70
G v72,a156
v_and_b32 v73, 0xffff0000, v72
v_lshlrev_b32 v72, 16, v72
MF v72,v10,v72
MF v73,v10,v73
C v72,v72,v73
W a156,v72
G v74,a157
v_and_b32 v75, 0xffff0000, v74
v_lshlrev_b32 v74, 16, v74
MF v74,v10,v74
MF v75,v10,v75
C v74,v74,v75
W a157,v74
G v76,a158
v_and_b32 v77, 0xffff0000, v76
v_lshlrev_b32 v76, 16, v76
MF v76,v10,v76
MF v77,v10,v77
C v76,v76,v77
W a158,v76
G v78,a159
v_and_b32 v79, 0xffff0000, v78
v_lshlrev_b32 v78, 16, v78
MF v78,v10,v78
MF v79,v10,v79
C v78,v78,v79
W a159,v78
G v64,a160
v_and_b32 v65, 0xffff0000, v64
v_lshlrev_b32 v64, 16, v64
MF v64,v11,v64
MF v65,v11,v65
C v64,v64,v65
W a160,v64
G v66,a161
v_and_b32 v67, 0xffff0000, v66
v_lshlrev_b32 v66, 16, v66
MF v66,v11,v66
MF v67,v11,v67
C v66,v66,v67
W a161,v66
G v68,a162
v_and_b32 v69, 0xffff0000, v68
v_lshlrev_b32 v68, 16, v68
MF v68,v11,v68
MF v69,v11,v69
C v68,v68,v69
W a162,v68
G v70,a163
v_and_b32 v71, 0xffff0000, v70
v_lshlrev_b32 v70, 16, v70
MF v70,v11,v70
MF v71,v11,v71
C v70,v70,v71
W a163,v70
G v72,a164
v_and_b32 v73, 0xffff0000, v72
v_lshlrev_b32 v72, 16, v72
MF v72,v11,v72
MF v73,v11,v73
C v72,v72,v73
W a164,v72
G v74,a165
v_and_b32 v75, 0xffff0000, v74
v_lshlrev_b32 v74, 16, v74
MF v74,v11,v74
MF v75,v11,v75
C v74,v74,v75
W a165,v74
G v76,a166
v_and_b32 v77, 0xffff0000, v76
v_lshlrev_b32 v76, 16, v76
MF v76,v11,v76
MF v77,v11,v77
C v76,v76,v77
W a166,v76
G v78,a167
v_and_b32 v79, 0xffff0000, v78
v_lshlrev_b32 v78, 16, v78
MF v78,v11,v78
MF v79,v11,v79
C v78,v78,v79
W a167,v78
G v64,a168
v_and_b32 v65, 0xffff0000, v64
v_lshlrev_b32 v64, 16, v64
MF v64,v11,v64
MF v65,v11,v65
C v64,v64,v65
W a168,v64
G v66,a169
v_and_b32 v67, 0xffff0000, v66
v_lshlrev_b32 v66, 16, v66
MF v66,v11,v66
MF v67,v11,v67
C v66,v66,v67
W a169,v66
G v68,a170
v_and_b32 v69, 0xffff0000, v68
v_lshlrev_b32 v68, 16, v68
MF v68,v11,v68
MF v69,v11,v69
C v68,v68,v69
W a170,v68
G v70,a171
v_and_b32 v71, 0xffff0000, v70
v_lshlrev_b32 v70, 16, v70
MF v70,v11,v70
MF v71,v11,v71
C v70,v70,v71
W a171,v70
G v72,a172
v_and_b32 v73, 0xffff0000, v72
v_lshlrev_b32 v72, 16, v72
MF v72,v11,v72
MF v73,v11,v73
C v72,v72,v73
W a172,v72
G v74,a173
v_and_b32 v75, 0xffff0000, v74
v_lshlrev_b32 v74, 16, v74
MF v74,v11,v74
MF v75,v11,v75
C v74,v74,v75
W a173,v74
G v76,a174
v_and_b32 v77, 0xffff0000, v76
v_lshlrev_b32 v76, 16, v76
MF v76,v11,v76
MF v77,v11,v77
C v76,v76,v77
W a174,v76
G v78,a175
v_and_b32 v79, 0xffff0000, v78
v_lshlrev_b32 v78, 16, v78
MF v78,v11,v78
MF v79,v11,v79
C v78,v78,v79
W a175,v78
G v64,a176
v_and_b32 v65, 0xffff0000, v64
v_lshlrev_b32 v64, 16, v64
MF v64,v11,v64
MF v65,v11,v65
C v64,v64,v65
W a176,v64
G v66,a177
v_and_b32 v67, 0xffff0000, v66
v_lshlrev_b32 v66, 16, v66
MF v66,v11,v66
MF v67,v11,v67
C v66,v66,v67
W a177,v66
G v68,a178
v_and_b32 v69, 0xffff0000, v68
v_lshlrev_b32 v68, 16, v68
MF v68,v11,v68
MF v69,v11,v69
C v68,v68,v69
W a178,v68
G v70,a179
v_and_b32 v71, 0xffff0000, v70
v_lshlrev_b32 v70, 16, v70
MF v70,v11,v70
MF v71,v11,v71
C v70,v70,v71
W a179,v70
G v72,a180
v_and_b32 v73, 0xffff0000, v72
v_lshlrev_b32 v72, 16, v72
MF v72,v11,v72
MF v73,v11,v73
C v72,v72,v73
W a180,v72
G v74,a181
v_and_b32 v75, 0xffff0000, v74
v_lshlrev_b32 v74, 16, v74
MF v74,v11,v74
MF v75,v11,v75
C v74,v74,v75
W a181,v74
G v76,a182
v_and_b32 v77, 0xffff0000, v76
v_lshlrev_b32 v76, 16, v76
MF v76,v11,v76
MF v77,v11,v77
C v76,v76,v77
W a182,v76
G v78,a183
v_and_b32 v79, 0xffff0000, v78
v_lshlrev_b32 v78, 16, v78
MF v78,v11,v78
MF v79,v11,v79
C v78,v78,v79
W a183,v78
G v64,a184
v_and_b32 v65, 0xffff0000, v64
v_lshlrev_b32 v64, 16, v64
MF v64,v11,v64
MF v65,v11,v65
C v64,v64,v65
W a184,v64
G v66,a185
v_and_b32 v67, 0xffff0000, v66
v_lshlrev_b32 v66, 16, v66
MF v66,v11,v66
MF v67,v11,v67
C v66,v66,v67
W a185,v66
G v68,a186
v_and_b32 v69, 0xffff0000, v68
v_lshlrev_b32 v68, 16, v68
MF v68,v11,v68
MF v69,v11,v69
C v68,v68,v69
W a186,v68
G v70,a187
v_and_b32 v71, 0xffff0000, v70
v_lshlrev_b32 v70, 16, v70
MF v70,v11,v70
MF v71,v11,v71
C v70,v70,v71
W a187,v70
G v72,a188
v_and_b32 v73, 0xffff0000, v72
v_lshlrev_b32 v72, 16, v72
MF v72,v11,v72
MF v73,v11,v73
C v72,v72,v73
W a188,v72
G v74,a189
v_and_b32 v75, 0xffff0000, v74
v_lshlrev_b32 v74, 16, v74
MF v74,v11,v74
MF v75,v11,v75
C v74,v74,v75
W a189,v74
G v76,a190
v_and_b32 v77, 0xffff0000, v76
v_lshlrev_b32 v76, 16, v76
MF v76,v11,v76
MF v77,v11,v77
C v76,v76,v77
W a190,v76
G v78,a191
v_and_b32 v79, 0xffff0000, v78
v_lshlrev_b32 v78, 16, v78
MF v78,v11,v78
MF v79,v11,v79
C v78,v78,v79
W a191,v78
s_nop 3
s_setpc_b64 s[36:37]
L_zs0:
s_mov_b32 s64, 65536
L_zs0_l:
s_sleep 2
buffer_load_dword v17, v16, s[12:15], 0 offen sc1
s_sub_u32 s64, s64, 1
s_cbranch_scc1 L_zs0_x
s_waitcnt vmcnt(0)
v_cmp_ne_u32 vcc, 1, v17
s_nop 0
s_cbranch_vccnz L_zs0_l
L_zs0_x:
s_waitcnt vmcnt(0)
s_branch L_zr0
L_zs1:
s_mov_b32 s64, 65536
L_zs1_l:
s_sleep 2
buffer_load_dword v17, v16, s[12:15], 0 offen sc1
s_sub_u32 s64, s64, 1
s_cbranch_scc1 L_zs1_x
s_waitcnt vmcnt(0)
v_cmp_ne_u32 vcc, 1, v17
s_nop 0
s_cbranch_vccnz L_zs1_l
L_zs1_x:
s_waitcnt vmcnt(0)
s_branch L_zr1
L_hs:
s_mov_b32 s91, 65536
L_hs_l:
buffer_load_dwordx4 v[16:19], v7, s[8:11], s67 offen offset:0 sc1
buffer_load_dwordx4 v[20:23], v7, s[8:11], s67 offen offset:1024 sc1
s_waitcnt vmcnt(0)
s_sub_u32 s91, s91, 1
s_cbranch_scc1 L_hr
v_min3_u32 v28, v16, v17, v18
v_min3_u32 v28, v28, v19, v20
v_min3_u32 v28, v28, v21, v22
v_min_u32 v28, v28, v23
v_cmp_eq_u32 vcc, 0, v28
s_nop 0
s_cbranch_vccnz L_hs_l
s_branch L_hr
L_lsj0:
s_mov_b32 s91, 65536
L_lsj0_l:
s_sleep 2
buffer_load_dword v5, v17, s[8:11], s46 offen sc1
s_sub_u32 s91, s91, 1
s_cbranch_scc1 L_lsj0_x
s_waitcnt vmcnt(0)
v_cmp_gt_u32 vcc, 2, v5
s_nop 0
s_cbranch_vccnz L_lsj0_l
L_lsj0_x:
s_waitcnt vmcnt(0)
s_branch L_lrj0
L_lsh2:
s_mov_b32 s91, 65536
L_lsh2_l:
s_sleep 2
buffer_load_dword v5, v17, s[8:11], s46 offen sc1
s_sub_u32 s91, s91, 1
s_cbranch_scc1 L_lsh2_x
s_waitcnt vmcnt(0)
v_cmp_gt_u32 vcc, 2, v5
s_nop 0
s_cbranch_vccnz L_lsh2_l
L_lsh2_x:
s_waitcnt vmcnt(0)
s_branch L_lrh2
L_lsh4:
s_mov_b32 s91, 65536
L_lsh4_l:
s_sleep 2
buffer_load_dword v5, v9, s[8:11], s46 offen sc1
s_sub_u32 s91, s91, 1
s_cbranch_scc1 L_lsh4_x
s_waitcnt vmcnt(0)
v_cmp_gt_u32 vcc, s84, v5
s_nop 0
s_cbranch_vccnz L_lsh4_l
L_lsh4_x:
s_waitcnt vmcnt(0)
s_branch L_lrh4
L_wsq0:
s_mov_b32 s91, 65536
L_wsq0_l:
s_sleep 2
buffer_load_dword v5, v31, s[8:11], s46 offen offset:4 sc1
s_sub_u32 s91, s91, 1
s_cbranch_scc1 L_wsq0_x
s_waitcnt vmcnt(0)
v_cmp_ne_u32 vcc, 1, v5
s_nop 0
s_mov_b32 vcc_hi, 0
s_cbranch_vccnz L_wsq0_l
L_wsq0_x:
s_waitcnt vmcnt(0)
s_branch L_wrq0
L_wsr0:
s_mov_b32 s91, 65536
L_wsr0_l:
s_sleep 2
buffer_load_dword v5, v31, s[8:11], s46 offen offset:4 sc1
s_sub_u32 s91, s91, 1
s_cbranch_scc1 L_wsr0_x
s_waitcnt vmcnt(0)
v_cmp_ne_u32 vcc, 1, v5
s_nop 0
s_mov_b32 vcc_lo, 0
s_cbranch_vccnz L_wsr0_l
L_wsr0_x:
s_waitcnt vmcnt(0)
s_branch L_wrr0
L_wsq1:
s_mov_b32 s91, 65536
L_wsq1_l:
s_sleep 2
buffer_load_dword v5, v31, s[8:11], s46 offen offset:4 sc1
s_sub_u32 s91, s91, 1
s_cbranch_scc1 L_wsq1_x
s_waitcnt vmcnt(0)
v_cmp_ne_u32 vcc, 1, v5
s_nop 0
s_mov_b32 vcc_hi, 0
s_cbranch_vccnz L_wsq1_l
L_wsq1_x:
s_waitcnt vmcnt(0)
s_branch L_wrq1
L_wsr1:
s_mov_b32 s91, 65536
L_wsr1_l:
s_sleep 2
buffer_load_dword v5, v31, s[8:11], s46 offen offset:4 sc1
s_sub_u32 s91, s91, 1
s_cbranch_scc1 L_wsr1_x
s_waitcnt vmcnt(0)
v_cmp_ne_u32 vcc, 1, v5
s_nop 0
s_mov_b32 vcc_lo, 0
s_cbranch_vccnz L_wsr1_l
L_wsr1_x:
s_waitcnt vmcnt(0)
s_branch L_wrr1
L_fll:
s_sub_u32 s65, s7, s40
s_mov_b32 s64, -1
s_cmp_eq_u32 s65, 1
s_cbranch_scc1 L_fl2
s_cmp_lg_u32 s20, 0
s_cbranch_scc1 L_fl3
s_lshr_b32 s64, s42, 3
s_cmp_eq_u32 s7, s64
s_cbranch_scc0 L_fl1
v_mov_b32 v15, 4
buffer_store_dword v15, v1, s[8:11], s45 offen sc1
L_fl1:
s_cmp_lg_u32 s65, 0
s_cbranch_scc1 L_fllr
s_movk_i32 s64, 0x380
L_fl2:
v_min_u32 v17, s64, v9
s_mov_b32 s6, 4
buffer_load_dword v5, v17, s[8:11], s46 offen sc1
s_bitcmp1_b32 s39, 15
s_cbranch_scc0 L_fllr
L_fl3:
s_cmp_eq_u32 s7, 1
s_cbranch_scc1 L_y2
s_cmp_eq_u32 s7, 2
s_cbranch_scc1 L_y3
s_cmp_eq_u32 s7, 3
s_cbranch_scc1 L_y4
s_branch L_y5
s_waitcnt vmcnt(0)
L_fps:
s_cmp_lg_u32 s35, 0
s_cbranch_scc1 L_fpr
L_fps2:
s_mov_b32 s91, 65536
L_fps2_l:
s_sleep 2
buffer_load_dword v6, off, s[8:11], s47 sc1
s_sub_u32 s91, s91, 1
s_cbranch_scc1 L_fps2_x
s_waitcnt vmcnt(0)
v_cmp_ne_u32 vcc, 1, v6
s_nop 0
s_cbranch_vccnz L_fps2_l
L_fps2_x:
s_waitcnt vmcnt(0)
s_branch L_fpr
L_fqs:
s_mov_b32 s91, 65536
L_fqs_l:
s_sleep 2
buffer_load_dword v6, off, s[8:11], s47 offset:16 sc1
s_sub_u32 s91, s91, 1
s_cbranch_scc1 L_fqs_x
s_waitcnt vmcnt(0)
v_cmp_ne_u32 vcc, 1, v6
s_nop 0
s_cbranch_vccnz L_fqs_l
L_fqs_x:
s_waitcnt vmcnt(0)
s_branch L_fqr
L_fls0:
s_mov_b32 s91, 65536
L_fls0_l:
s_sleep 2
buffer_load_dword v5, v17, s[8:11], s46 offen sc1
s_sub_u32 s91, s91, 1
s_cbranch_scc1 L_fls0_x
s_waitcnt vmcnt(0)
v_cmp_gt_u32 vcc, s6, v5
s_nop 0
s_cbranch_vccnz L_fls0_l
L_fls0_x:
s_waitcnt vmcnt(0)
s_branch L_flr0
L_y2:
v_lshrrev_b32 v11, 7, v7
v_mul_u32_u24 v11, 4352, v11
v_and_b32 v12, 0x70, v7
v_lshl_add_u32 v11, v12, 3, v11
s_mov_b32 s64, 104923136
s_mov_b32 s65, 104957952
buffer_load_dword a128, v11, s[8:11], s64 offen sc1
buffer_load_dword a129, v11, s[8:11], s65 offen sc1
s_branch L_fllr
s_waitcnt vmcnt(0)
L_y3:
s_mov_b32 s91, 65536
L_y3c:
G v12,a128
G v13,a129
v_min_u32 v12, v12, v13
v_cmp_gt_u32 vcc, 2, v12
s_sub_u32 s91, s91, 1
s_cbranch_scc1 L_y3x
s_cbranch_vccz L_y3x
v_lshrrev_b32 v11, 7, v7
v_mul_u32_u24 v11, 4352, v11
v_and_b32 v12, 0x70, v7
v_lshl_add_u32 v11, v12, 3, v11
s_mov_b32 s64, 104923136
s_mov_b32 s65, 104957952
buffer_load_dword a128, v11, s[8:11], s64 offen sc1
buffer_load_dword a129, v11, s[8:11], s65 offen sc1
s_waitcnt vmcnt(0)
s_branch L_y3c
L_y3x:
s_lshl_b32 s66, s41, 1
SA s66,s66,s20
s_sub_u32 s66, s66, 2
s_cmp_lt_u32 s66, 14
s_cselect_b32 s64, 8, 12
SA s64,s64,104890368
buffer_load_dword a130, off, s[8:11], s64 sc1
v_lshrrev_b32 v11, 7, v7
v_mul_u32_u24 v11, 3584, v11
v_and_b32 v12, 0x70, v7
v_add_u32 v11, v12, v11
s_lshl_b32 s65, s66, 7
SA s65,s65,105906176
buffer_load_dwordx4 a[132:135], v11, s[8:11], s65 offen sc1
SA s65,s65,28672
buffer_load_dwordx4 a[136:139], v11, s[8:11], s65 offen sc1
SA s65,s65,28672
buffer_load_dwordx4 a[140:143], v11, s[8:11], s65 offen sc1
SA s65,s65,28672
buffer_load_dwordx4 a[144:147], v11, s[8:11], s65 offen sc1
SA s65,s65,28672
buffer_load_dwordx4 a[148:151], v11, s[8:11], s65 offen sc1
SA s65,s65,28672
buffer_load_dwordx4 a[152:155], v11, s[8:11], s65 offen sc1
SA s65,s65,28672
buffer_load_dwordx4 a[156:159], v11, s[8:11], s65 offen sc1
SA s65,s65,28672
buffer_load_dwordx4 a[160:163], v11, s[8:11], s65 offen sc1
SA s65,s65,28672
buffer_load_dwordx4 a[164:167], v11, s[8:11], s65 offen sc1
SA s65,s65,28672
buffer_load_dwordx4 a[168:171], v11, s[8:11], s65 offen sc1
SA s65,s65,28672
buffer_load_dwordx4 a[172:175], v11, s[8:11], s65 offen sc1
SA s65,s65,28672
buffer_load_dwordx4 a[176:179], v11, s[8:11], s65 offen sc1
SA s65,s65,28672
buffer_load_dwordx4 a[180:183], v11, s[8:11], s65 offen sc1
SA s65,s65,28672
buffer_load_dwordx4 a[184:187], v11, s[8:11], s65 offen sc1
SA s65,s65,28672
s_branch L_fllr
s_waitcnt vmcnt(0)
L_y4:
G v12,a132
G v13,a133
G v14,a134
G v15,a135
G v16,a136
G v17,a137
AF v12,v16,v12
AF v13,v17,v13
G v16,a138
G v17,a139
AF v14,v16,v14
AF v15,v17,v15
G v16,a140
G v17,a141
AF v12,v16,v12
AF v13,v17,v13
G v16,a142
G v17,a143
AF v14,v16,v14
AF v15,v17,v15
G v16,a144
G v17,a145
AF v12,v16,v12
AF v13,v17,v13
G v16,a146
G v17,a147
AF v14,v16,v14
AF v15,v17,v15
G v16,a148
G v17,a149
AF v12,v16,v12
AF v13,v17,v13
G v16,a150
G v17,a151
AF v14,v16,v14
AF v15,v17,v15
G v16,a152
G v17,a153
AF v12,v16,v12
AF v13,v17,v13
G v16,a154
G v17,a155
AF v14,v16,v14
AF v15,v17,v15
G v16,a156
G v17,a157
AF v12,v16,v12
AF v13,v17,v13
G v16,a158
G v17,a159
AF v14,v16,v14
AF v15,v17,v15
G v16,a160
G v17,a161
AF v12,v16,v12
AF v13,v17,v13
G v16,a162
G v17,a163
AF v14,v16,v14
AF v15,v17,v15
G v16,a164
G v17,a165
AF v12,v16,v12
AF v13,v17,v13
G v16,a166
G v17,a167
AF v14,v16,v14
AF v15,v17,v15
G v16,a168
G v17,a169
AF v12,v16,v12
AF v13,v17,v13
G v16,a170
G v17,a171
AF v14,v16,v14
AF v15,v17,v15
G v16,a172
G v17,a173
AF v12,v16,v12
AF v13,v17,v13
G v16,a174
G v17,a175
AF v14,v16,v14
AF v15,v17,v15
G v16,a176
G v17,a177
AF v12,v16,v12
AF v13,v17,v13
G v16,a178
G v17,a179
AF v14,v16,v14
AF v15,v17,v15
G v16,a180
G v17,a181
AF v12,v16,v12
AF v13,v17,v13
G v16,a182
G v17,a183
AF v14,v16,v14
AF v15,v17,v15
G v16,a184
G v17,a185
AF v12,v16,v12
AF v13,v17,v13
G v16,a186
G v17,a187
AF v14,v16,v14
AF v15,v17,v15
v_add_f32 v12, v12, v12 row_ror:8 row_mask:0xf bank_mask:0xf
v_add_f32 v13, v13, v13 row_ror:8 row_mask:0xf bank_mask:0xf
v_add_f32 v14, v14, v14 row_ror:8 row_mask:0xf bank_mask:0xf
v_add_f32 v15, v15, v15 row_ror:8 row_mask:0xf bank_mask:0xf
v_mov_b32 v11, v12
s_nop 1
v_permlane16_swap_b32 v11, v12
AF v12,v11,v12
v_mov_b32 v11, v13
s_nop 1
v_permlane16_swap_b32 v11, v13
AF v13,v11,v13
v_mov_b32 v11, v14
s_nop 1
v_permlane16_swap_b32 v11, v14
AF v14,v11,v14
v_mov_b32 v11, v15
s_nop 1
v_permlane16_swap_b32 v11, v15
AF v15,v11,v15
v_mov_b32 v11, v12
s_nop 1
v_permlane32_swap_b32 v11, v12
AF v12,v11,v12
v_mov_b32 v11, v13
s_nop 1
v_permlane32_swap_b32 v11, v13
AF v13,v11,v13
v_mov_b32 v11, v14
s_nop 1
v_permlane32_swap_b32 v11, v14
AF v14,v11,v14
v_mov_b32 v11, v15
s_nop 1
v_permlane32_swap_b32 v11, v15
AF v15,v11,v15
G v16,a130
C v11,v12,v13
v_lshlrev_b32 v12, 16, v11
v_and_b32 v13, 0xffff0000, v11
C v11,v14,v15
v_lshlrev_b32 v14, 16, v11
v_and_b32 v15, 0xffff0000, v11
MF v12,v16,v12
MF v13,v16,v13
MF v14,v16,v14
MF v15,v16,v15
C v11,v12,v13
v_lshlrev_b32 v12, 16, v11
v_and_b32 v13, 0xffff0000, v11
C v11,v14,v15
v_lshlrev_b32 v14, 16, v11
v_and_b32 v15, 0xffff0000, v11
s_lshl_b32 s66, s41, 1
SA s66,s66,s20
s_sub_u32 s66, s66, 2
s_lshl_b32 s65, s66, 7
SA s65,s65,104898560
s_mov_b64 exec, 0xff
buffer_store_dwordx4 v[12:15], v7, s[8:11], s65 offen sc1
s_mov_b64 exec, -1
s_nop 1
s_branch L_fllr
L_y5:
s_lshl_b32 s66, s41, 1
SA s66,s66,s20
s_sub_u32 s66, s66, 2
s_lshl_b32 s66, s66, 2
SA s66,s66,105062912
v_mov_b32 v11, 1
s_mov_b64 exec, 1
buffer_store_dword v11, off, s[8:11], s66 sc1
s_mov_b64 exec, -1
s_branch L_fllr
.p2align 12
L_loop_top:
M v[64:67],a[64:67],a[0:3],v[32:35]
SA m0,s28,0
R a[96:99],v2,40960
M v[64:67],a[68:71],a[4:7],v[64:67]
buffer_load_dword a240, v0, s[60:63], 0 offen offset:0
M v[64:67],a[72:75],a[8:11],v[64:67]
R a[100:103],v2,41984
M v[64:67],a[76:79],a[12:15],v[64:67]
s_waitcnt lgkmcnt(2)
buffer_load_dwordx4 v3, s[8:11], s26 offen offset:0 sc1 lds
M v[64:67],a[80:83],a[16:19],v[64:67]
R a[104:107],v2,43008
M v[64:67],a[84:87],a[20:23],v[64:67]
E v18,v112
M v[64:67],a[88:91],a[24:27],v[64:67]
R a[108:111],v2,44032
M v[64:67],a[92:95],a[28:31],v[64:67]
buffer_load_dwordx4 v3, s[8:11], s26 offen offset:1024 sc1 lds
M v[68:71],a[92:95],a[60:63],v[36:39]
R a[112:115],v2,45056
M v[68:71],a[88:91],a[56:59],v[68:71]
E v19,v113
M v[68:71],a[84:87],a[52:55],v[68:71]
R a[116:119],v2,46080
AF v28,v18,v28
M v[68:71],a[80:83],a[48:51],v[68:71]
E v20,v114
M v[68:71],a[76:79],a[44:47],v[68:71]
R a[120:123],v2,47104
C v56,v18,v19
M v[68:71],a[72:75],a[40:43],v[68:71]
buffer_load_dwordx4 v3, s[8:11], s26 offen offset:2048 sc1 lds
M v[68:71],a[68:71],a[36:39],v[68:71]
R a[124:127],v2,48128
AF v28,v19,v28
M v[68:71],a[64:67],a[32:35],v[68:71]
s_waitcnt lgkmcnt(4)
E v21,v115
M v[76:79],a[96:99],a[32:35],v[36:39]
R a[64:67],v2,49152
AF v28,v20,v28
M v[76:79],a[100:103],a[36:39],v[76:79]
buffer_load_dwordx4 v3, s[8:11], s26 offen offset:3072 sc1 lds
M v[76:79],a[104:107],a[40:43],v[76:79]
R a[68:71],v2,50176
C v57,v20,v21
M v[76:79],a[108:111],a[44:47],v[76:79]
s_waitcnt lgkmcnt(2)
E v22,v120
M v[76:79],a[112:115],a[48:51],v[76:79]
R a[72:75],v2,51200
AF v28,v21,v28
M v[76:79],a[116:119],a[52:55],v[76:79]
E v23,v121
M v[76:79],a[120:123],a[56:59],v[76:79]
SA m0,s28,4096
R a[76:79],v2,52224
AF v28,v22,v28
M v[76:79],a[124:127],a[60:63],v[76:79]
buffer_load_dwordx4 v4, s[8:11], s26 offen offset:0 sc1 lds
M v[72:75],a[124:127],a[28:31],v[32:35]
R a[80:83],v2,53248
C v58,v22,v23
M v[72:75],a[120:123],a[24:27],v[72:75]
E v24,v122
M v[72:75],a[116:119],a[20:23],v[72:75]
R a[84:87],v2,54272
AF v28,v23,v28
M v[72:75],a[112:115],a[16:19],v[72:75]
E v25,v123
M v[72:75],a[108:111],a[12:15],v[72:75]
R a[88:91],v2,55296
AF v28,v24,v28
M v[72:75],a[104:107],a[8:11],v[72:75]
buffer_load_dwordx4 v4, s[8:11], s26 offen offset:1024 sc1 lds
M v[72:75],a[100:103],a[4:7],v[72:75]
R a[92:95],v2,56320
C v59,v24,v25
M v[72:75],a[96:99],a[0:3],v[72:75]
s_waitcnt lgkmcnt(4)
E v18,v116
M v[80:83],a[64:67],a[0:3],v[32:35]
R a[96:99],v2,57344
AF v28,v25,v28
M v[80:83],a[68:71],a[4:7],v[80:83]
R a[100:103],v2,58368
M v[80:83],a[72:75],a[8:11],v[80:83]
buffer_load_dwordx4 v4, s[8:11], s26 offen offset:2048 sc1 lds
M v[80:83],a[76:79],a[12:15],v[80:83]
s_waitcnt lgkmcnt(2)
R a[104:107],v2,59392
M v[80:83],a[80:83],a[16:19],v[80:83]
R a[108:111],v2,60416
M v[80:83],a[84:87],a[20:23],v[80:83]
E v19,v117
M v[80:83],a[88:91],a[24:27],v[80:83]
R a[112:115],v2,61440
AF v29,v18,v29
M v[80:83],a[92:95],a[28:31],v[80:83]
R a[116:119],v2,62464
C v60,v18,v19
M v[84:87],a[92:95],a[60:63],v[36:39]
buffer_load_dwordx4 v4, s[8:11], s26 offen offset:3072 sc1 lds
M v[84:87],a[88:91],a[56:59],v[84:87]
SA s26,s26,32768
R a[120:123],v2,63488
AF v29,v19,v29
M v[84:87],a[84:87],a[52:55],v[84:87]
R a[124:127],v2,64512
M v[84:87],a[80:83],a[48:51],v[84:87]
E v20,v118
M v[84:87],a[76:79],a[44:47],v[84:87]
E v21,v119
M v[84:87],a[72:75],a[40:43],v[84:87]
E v22,v124
M v[84:87],a[68:71],a[36:39],v[84:87]
s_waitcnt vmcnt(17) lgkmcnt(0)
E v23,v125
M v[84:87],a[64:67],a[32:35],v[84:87]
s_barrier
M v[92:95],a[96:99],a[32:35],v[36:39]
R a[64:67],v7,32768
AF v29,v20,v29
M v[92:95],a[100:103],a[36:39],v[92:95]
E v24,v126
M v[92:95],a[104:107],a[40:43],v[92:95]
R a[68:71],v7,33792
C v61,v20,v21
M v[92:95],a[108:111],a[44:47],v[92:95]
AF v29,v21,v29
AF v29,v22,v29
M v[92:95],a[112:115],a[48:51],v[92:95]
R a[72:75],v7,34816
C v62,v22,v23
M v[92:95],a[116:119],a[52:55],v[92:95]
E v25,v127
M v[92:95],a[120:123],a[56:59],v[92:95]
R a[76:79],v7,35840
AF v29,v23,v29
M v[92:95],a[124:127],a[60:63],v[92:95]
AF v29,v24,v29
C v63,v24,v25
M v[88:91],a[124:127],a[28:31],v[32:35]
R a[80:83],v7,36864
AF v29,v25,v29
M v[88:91],a[120:123],a[24:27],v[88:91]
M v[88:91],a[116:119],a[20:23],v[88:91]
R a[84:87],v7,37888
v_max_f32 v10, v28, v29
M v[88:91],a[112:115],a[16:19],v[88:91]
v_cmp_lt_f32 vcc, s31, v10
M v[88:91],a[108:111],a[12:15],v[88:91]
R a[88:91],v7,38912
M v[88:91],a[104:107],a[8:11],v[88:91]
M v[88:91],a[100:103],a[4:7],v[88:91]
s_waitcnt lgkmcnt(3)
R a[92:95],v7,39936
M v[88:91],a[96:99],a[0:3],v[88:91]
s_cbranch_vccnz L_st1
L_rt1:
M v[128:131],a[64:67],v[48:51],v[128:131]
SA m0,s28,98304
R a[96:99],v7,40960
AF v30,v28,v30
M v[128:131],a[68:71],v[56:59],v[128:131]
buffer_load_dwordx4 v3, s[8:11], s21 offen offset:0 sc1 lds
M v[132:135],a[68:71],v[60:63],v[132:135]
R a[100:103],v7,41984
AF v31,v29,v31
M v[132:135],a[64:67],v[52:55],v[132:135]
s_waitcnt lgkmcnt(2)
E v18,v64
M v[140:143],a[72:75],v[52:55],v[140:143]
R a[104:107],v7,43008
M v[140:143],a[76:79],v[60:63],v[140:143]
buffer_load_dwordx4 v3, s[8:11], s21 offen offset:1024 sc1 lds
M v[136:139],a[76:79],v[56:59],v[136:139]
R a[108:111],v7,44032
M v[136:139],a[72:75],v[48:51],v[136:139]
E v19,v65
M v[144:147],a[80:83],v[48:51],v[144:147]
R a[112:115],v7,45056
AF v26,v18,v19
M v[144:147],a[84:87],v[56:59],v[144:147]
E v20,v66
M v[148:151],a[84:87],v[60:63],v[148:151]
R a[116:119],v7,46080
C v40,v18,v19
M v[148:151],a[80:83],v[52:55],v[148:151]
buffer_load_dwordx4 v3, s[8:11], s21 offen offset:2048 sc1 lds
M v[156:159],a[88:91],v[52:55],v[156:159]
R a[120:123],v7,47104
M v[156:159],a[92:95],v[60:63],v[156:159]
E v21,v67
M v[152:155],a[92:95],v[56:59],v[152:155]
R a[124:127],v7,48128
AF v26,v20,v26
M v[152:155],a[88:91],v[48:51],v[152:155]
s_waitcnt lgkmcnt(4)
buffer_load_dwordx4 v3, s[8:11], s21 offen offset:3072 sc1 lds
M v[160:163],a[96:99],v[48:51],v[160:163]
R a[64:67],v7,49152
C v41,v20,v21
M v[160:163],a[100:103],v[56:59],v[160:163]
E v22,v72
M v[164:167],a[100:103],v[60:63],v[164:167]
SA m0,s28,102400
R a[68:71],v7,50176
AF v26,v21,v26
M v[164:167],a[96:99],v[52:55],v[164:167]
s_waitcnt lgkmcnt(2)
buffer_load_dwordx4 v4, s[8:11], s21 offen offset:0 sc1 lds
M v[172:175],a[104:107],v[52:55],v[172:175]
R a[72:75],v7,51200
M v[172:175],a[108:111],v[60:63],v[172:175]
E v23,v73
M v[168:171],a[108:111],v[56:59],v[168:171]
R a[76:79],v7,52224
AF v26,v22,v26
M v[168:171],a[104:107],v[48:51],v[168:171]
E v24,v74
M v[176:179],a[112:115],v[48:51],v[176:179]
R a[80:83],v7,53248
C v42,v22,v23
M v[176:179],a[116:119],v[56:59],v[176:179]
buffer_load_dwordx4 v4, s[8:11], s21 offen offset:1024 sc1 lds
M v[180:183],a[116:119],v[60:63],v[180:183]
R a[84:87],v7,54272
AF v26,v23,v26
M v[180:183],a[112:115],v[52:55],v[180:183]
E v25,v75
M v[188:191],a[120:123],v[52:55],v[188:191]
R a[88:91],v7,55296
AF v26,v24,v26
M v[188:191],a[124:127],v[60:63],v[188:191]
buffer_load_dwordx4 v4, s[8:11], s21 offen offset:2048 sc1 lds
M v[184:187],a[124:127],v[56:59],v[184:187]
R a[92:95],v7,56320
C v43,v24,v25
M v[184:187],a[120:123],v[48:51],v[184:187]
s_waitcnt lgkmcnt(4)
E v18,v68
M v[192:195],a[64:67],v[48:51],v[192:195]
R a[96:99],v7,57344
AF v26,v25,v26
M v[192:195],a[68:71],v[56:59],v[192:195]
R a[100:103],v7,58368
M v[196:199],a[68:71],v[60:63],v[196:199]
buffer_load_dwordx4 v4, s[8:11], s21 offen offset:3072 sc1 lds
M v[196:199],a[64:67],v[52:55],v[196:199]
s_waitcnt lgkmcnt(2)
R a[104:107],v7,59392
M v[204:207],a[72:75],v[52:55],v[204:207]
SA s21,s21,32768
R a[108:111],v7,60416
M v[204:207],a[76:79],v[60:63],v[204:207]
s_sub_u32 s22, s22, 1
E v19,v69
M v[200:203],a[76:79],v[56:59],v[200:203]
s_cselect_b32 s21, s23, s21
R a[112:115],v7,61440
AF v27,v18,v19
M v[200:203],a[72:75],v[48:51],v[200:203]
R a[116:119],v7,62464
C v44,v18,v19
M v[208:211],a[80:83],v[48:51],v[208:211]
E v20,v70
M v[208:211],a[84:87],v[56:59],v[208:211]
R a[120:123],v7,63488
M v[212:215],a[84:87],v[60:63],v[212:215]
R a[124:127],v7,64512
M v[212:215],a[80:83],v[52:55],v[212:215]
E v21,v71
M v[220:223],a[88:91],v[52:55],v[220:223]
E v22,v76
M v[220:223],a[92:95],v[60:63],v[220:223]
AF v27,v20,v27
C v45,v20,v21
M v[216:219],a[92:95],v[56:59],v[216:219]
s_waitcnt vmcnt(17) lgkmcnt(0)
AF v27,v21,v27
M v[216:219],a[88:91],v[48:51],v[216:219]
s_barrier
M v[224:227],a[96:99],v[48:51],v[224:227]
R a[64:67],v2,0
M v[224:227],a[100:103],v[56:59],v[224:227]
E v23,v77
M v[228:231],a[100:103],v[60:63],v[228:231]
R a[68:71],v2,1024
AF v27,v22,v27
M v[228:231],a[96:99],v[52:55],v[228:231]
E v24,v78
M v[236:239],a[104:107],v[52:55],v[236:239]
R a[72:75],v2,2048
C v46,v22,v23
M v[236:239],a[108:111],v[60:63],v[236:239]
AF v27,v23,v27
M v[232:235],a[108:111],v[56:59],v[232:235]
R a[76:79],v2,3072
M v[232:235],a[104:107],v[48:51],v[232:235]
E v25,v79
M v[240:243],a[112:115],v[48:51],v[240:243]
R a[80:83],v2,4096
AF v27,v24,v27
M v[240:243],a[116:119],v[56:59],v[240:243]
C v47,v24,v25
AF v27,v25,v27
M v[244:247],a[116:119],v[60:63],v[244:247]
R a[84:87],v2,5120
M v[244:247],a[112:115],v[52:55],v[244:247]
M v[252:255],a[120:123],v[52:55],v[252:255]
R a[88:91],v2,6144
M v[252:255],a[124:127],v[60:63],v[252:255]
M v[248:251],a[124:127],v[56:59],v[248:251]
s_waitcnt lgkmcnt(3)
R a[92:95],v2,7168
M v[248:251],a[120:123],v[48:51],v[248:251]
M v[96:99],a[64:67],a[0:3],v[32:35]
s_bitcmp1_b32 s39, s7
R a[96:99],v2,8192
M v[96:99],a[68:71],a[4:7],v[96:99]
s_cbranch_scc1 L_fll
L_fllr:
E v18,v80
M v[96:99],a[72:75],a[8:11],v[96:99]
SA m0,s28,32768
R a[100:103],v2,9216
M v[96:99],a[76:79],a[12:15],v[96:99]
s_waitcnt lgkmcnt(2)
buffer_load_dwordx4 v3, s[8:11], s26 offen offset:0 sc1 lds
M v[96:99],a[80:83],a[16:19],v[96:99]
R a[104:107],v2,10240
M v[96:99],a[84:87],a[20:23],v[96:99]
E v19,v81
M v[96:99],a[88:91],a[24:27],v[96:99]
R a[108:111],v2,11264
AF v26,v18,v26
M v[96:99],a[92:95],a[28:31],v[96:99]
E v20,v82
M v[100:103],a[92:95],a[60:63],v[36:39]
R a[112:115],v2,12288
C v56,v18,v19
M v[100:103],a[88:91],a[56:59],v[100:103]
buffer_load_dwordx4 v3, s[8:11], s26 offen offset:1024 sc1 lds
M v[100:103],a[84:87],a[52:55],v[100:103]
R a[116:119],v2,13312
AF v26,v19,v26
M v[100:103],a[80:83],a[48:51],v[100:103]
E v21,v83
M v[100:103],a[76:79],a[44:47],v[100:103]
R a[120:123],v2,14336
AF v26,v20,v26
M v[100:103],a[72:75],a[40:43],v[100:103]
buffer_load_dwordx4 v3, s[8:11], s26 offen offset:2048 sc1 lds
M v[100:103],a[68:71],a[36:39],v[100:103]
R a[124:127],v2,15360
C v57,v20,v21
M v[100:103],a[64:67],a[32:35],v[100:103]
s_waitcnt lgkmcnt(4)
E v22,v88
M v[108:111],a[96:99],a[32:35],v[36:39]
R a[64:67],v2,16384
AF v26,v21,v26
M v[108:111],a[100:103],a[36:39],v[108:111]
E v23,v89
M v[108:111],a[104:107],a[40:43],v[108:111]
R a[68:71],v2,17408
AF v26,v22,v26
M v[108:111],a[108:111],a[44:47],v[108:111]
s_waitcnt lgkmcnt(2)
buffer_load_dwordx4 v3, s[8:11], s26 offen offset:3072 sc1 lds
M v[108:111],a[112:115],a[48:51],v[108:111]
R a[72:75],v2,18432
C v58,v22,v23
M v[108:111],a[116:119],a[52:55],v[108:111]
E v24,v90
M v[108:111],a[120:123],a[56:59],v[108:111]
R a[76:79],v2,19456
AF v26,v23,v26
M v[108:111],a[124:127],a[60:63],v[108:111]
SA m0,s28,36864
M v[104:107],a[124:127],a[28:31],v[32:35]
R a[80:83],v2,20480
M v[104:107],a[120:123],a[24:27],v[104:107]
buffer_load_dwordx4 v4, s[8:11], s26 offen offset:0 sc1 lds
M v[104:107],a[116:119],a[20:23],v[104:107]
R a[84:87],v2,21504
M v[104:107],a[112:115],a[16:19],v[104:107]
E v25,v91
M v[104:107],a[108:111],a[12:15],v[104:107]
R a[88:91],v2,22528
AF v26,v24,v26
M v[104:107],a[104:107],a[8:11],v[104:107]
buffer_load_dwordx4 v4, s[8:11], s26 offen offset:1024 sc1 lds
M v[104:107],a[100:103],a[4:7],v[104:107]
R a[92:95],v2,23552
C v59,v24,v25
M v[104:107],a[96:99],a[0:3],v[104:107]
s_waitcnt lgkmcnt(4)
E v18,v84
M v[112:115],a[64:67],a[0:3],v[32:35]
R a[96:99],v2,24576
AF v26,v25,v26
M v[112:115],a[68:71],a[4:7],v[112:115]
R a[100:103],v2,25600
M v[112:115],a[72:75],a[8:11],v[112:115]
buffer_load_dwordx4 v4, s[8:11], s26 offen offset:2048 sc1 lds
M v[112:115],a[76:79],a[12:15],v[112:115]
s_waitcnt lgkmcnt(2)
R a[104:107],v2,26624
M v[112:115],a[80:83],a[16:19],v[112:115]
R a[108:111],v2,27648
M v[112:115],a[84:87],a[20:23],v[112:115]
E v19,v85
M v[112:115],a[88:91],a[24:27],v[112:115]
R a[112:115],v2,28672
AF v27,v18,v27
M v[112:115],a[92:95],a[28:31],v[112:115]
R a[116:119],v2,29696
C v60,v18,v19
M v[116:119],a[92:95],a[60:63],v[36:39]
buffer_load_dwordx4 v4, s[8:11], s26 offen offset:3072 sc1 lds
M v[116:119],a[88:91],a[56:59],v[116:119]
SA s26,s26,32768
R a[120:123],v2,30720
AF v27,v19,v27
M v[116:119],a[84:87],a[52:55],v[116:119]
R a[124:127],v2,31744
M v[116:119],a[80:83],a[48:51],v[116:119]
E v20,v86
M v[116:119],a[76:79],a[44:47],v[116:119]
E v21,v87
M v[116:119],a[72:75],a[40:43],v[116:119]
E v22,v92
M v[116:119],a[68:71],a[36:39],v[116:119]
s_waitcnt vmcnt(16) lgkmcnt(0)
E v23,v93
M v[116:119],a[64:67],a[32:35],v[116:119]
s_barrier
M v[124:127],a[96:99],a[32:35],v[36:39]
R a[64:67],v7,0
AF v27,v20,v27
M v[124:127],a[100:103],a[36:39],v[124:127]
E v24,v94
M v[124:127],a[104:107],a[40:43],v[124:127]
R a[68:71],v7,1024
C v61,v20,v21
M v[124:127],a[108:111],a[44:47],v[124:127]
AF v27,v21,v27
AF v27,v22,v27
M v[124:127],a[112:115],a[48:51],v[124:127]
R a[72:75],v7,2048
C v62,v22,v23
M v[124:127],a[116:119],a[52:55],v[124:127]
E v25,v95
M v[124:127],a[120:123],a[56:59],v[124:127]
R a[76:79],v7,3072
AF v27,v23,v27
M v[124:127],a[124:127],a[60:63],v[124:127]
AF v27,v24,v27
C v63,v24,v25
M v[120:123],a[124:127],a[28:31],v[32:35]
R a[80:83],v7,4096
AF v27,v25,v27
M v[120:123],a[120:123],a[24:27],v[120:123]
M v[120:123],a[116:119],a[20:23],v[120:123]
R a[84:87],v7,5120
v_max_f32 v10, v26, v27
M v[120:123],a[112:115],a[16:19],v[120:123]
v_cmp_lt_f32 vcc, s31, v10
M v[120:123],a[108:111],a[12:15],v[120:123]
R a[88:91],v7,6144
M v[120:123],a[104:107],a[8:11],v[120:123]
M v[120:123],a[100:103],a[4:7],v[120:123]
s_waitcnt lgkmcnt(3)
R a[92:95],v7,7168
M v[120:123],a[96:99],a[0:3],v[120:123]
s_cbranch_vccnz L_st0
L_rt0:
M v[128:131],a[64:67],v[40:43],v[128:131]
SA m0,s28,65536
R a[96:99],v7,8192
AF v30,v26,v30
M v[128:131],a[68:71],v[56:59],v[128:131]
buffer_load_dwordx4 v3, s[8:11], s21 offen offset:0 sc1 lds
M v[132:135],a[68:71],v[60:63],v[132:135]
R a[100:103],v7,9216
AF v31,v27,v31
M v[132:135],a[64:67],v[44:47],v[132:135]
s_waitcnt lgkmcnt(2)
E v18,v96
M v[140:143],a[72:75],v[44:47],v[140:143]
R a[104:107],v7,10240
M v[140:143],a[76:79],v[60:63],v[140:143]
buffer_load_dwordx4 v3, s[8:11], s21 offen offset:1024 sc1 lds
M v[136:139],a[76:79],v[56:59],v[136:139]
R a[108:111],v7,11264
M v[136:139],a[72:75],v[40:43],v[136:139]
E v19,v97
M v[144:147],a[80:83],v[40:43],v[144:147]
R a[112:115],v7,12288
AF v28,v18,v19
M v[144:147],a[84:87],v[56:59],v[144:147]
E v20,v98
M v[148:151],a[84:87],v[60:63],v[148:151]
R a[116:119],v7,13312
C v48,v18,v19
M v[148:151],a[80:83],v[44:47],v[148:151]
buffer_load_dwordx4 v3, s[8:11], s21 offen offset:2048 sc1 lds
M v[156:159],a[88:91],v[44:47],v[156:159]
R a[120:123],v7,14336
M v[156:159],a[92:95],v[60:63],v[156:159]
E v21,v99
M v[152:155],a[92:95],v[56:59],v[152:155]
R a[124:127],v7,15360
AF v28,v20,v28
M v[152:155],a[88:91],v[40:43],v[152:155]
s_waitcnt lgkmcnt(4)
buffer_load_dwordx4 v3, s[8:11], s21 offen offset:3072 sc1 lds
M v[160:163],a[96:99],v[40:43],v[160:163]
R a[64:67],v7,16384
C v49,v20,v21
M v[160:163],a[100:103],v[56:59],v[160:163]
E v22,v104
M v[164:167],a[100:103],v[60:63],v[164:167]
SA m0,s28,69632
R a[68:71],v7,17408
AF v28,v21,v28
M v[164:167],a[96:99],v[44:47],v[164:167]
s_waitcnt lgkmcnt(2)
buffer_load_dwordx4 v4, s[8:11], s21 offen offset:0 sc1 lds
M v[172:175],a[104:107],v[44:47],v[172:175]
R a[72:75],v7,18432
M v[172:175],a[108:111],v[60:63],v[172:175]
E v23,v105
M v[168:171],a[108:111],v[56:59],v[168:171]
R a[76:79],v7,19456
AF v28,v22,v28
M v[168:171],a[104:107],v[40:43],v[168:171]
E v24,v106
M v[176:179],a[112:115],v[40:43],v[176:179]
R a[80:83],v7,20480
C v50,v22,v23
M v[176:179],a[116:119],v[56:59],v[176:179]
buffer_load_dwordx4 v4, s[8:11], s21 offen offset:1024 sc1 lds
M v[180:183],a[116:119],v[60:63],v[180:183]
R a[84:87],v7,21504
AF v28,v23,v28
M v[180:183],a[112:115],v[44:47],v[180:183]
E v25,v107
M v[188:191],a[120:123],v[44:47],v[188:191]
R a[88:91],v7,22528
AF v28,v24,v28
M v[188:191],a[124:127],v[60:63],v[188:191]
buffer_load_dwordx4 v4, s[8:11], s21 offen offset:2048 sc1 lds
M v[184:187],a[124:127],v[56:59],v[184:187]
R a[92:95],v7,23552
C v51,v24,v25
M v[184:187],a[120:123],v[40:43],v[184:187]
s_waitcnt lgkmcnt(4)
E v18,v100
M v[192:195],a[64:67],v[40:43],v[192:195]
R a[96:99],v7,24576
AF v28,v25,v28
M v[192:195],a[68:71],v[56:59],v[192:195]
R a[100:103],v7,25600
M v[196:199],a[68:71],v[60:63],v[196:199]
buffer_load_dwordx4 v4, s[8:11], s21 offen offset:3072 sc1 lds
M v[196:199],a[64:67],v[44:47],v[196:199]
s_waitcnt lgkmcnt(2)
R a[104:107],v7,26624
M v[204:207],a[72:75],v[44:47],v[204:207]
SA s21,s21,32768
R a[108:111],v7,27648
M v[204:207],a[76:79],v[60:63],v[204:207]
s_sub_u32 s22, s22, 1
E v19,v101
M v[200:203],a[76:79],v[56:59],v[200:203]
s_cselect_b32 s21, s23, s21
R a[112:115],v7,28672
AF v29,v18,v19
M v[200:203],a[72:75],v[40:43],v[200:203]
R a[116:119],v7,29696
C v52,v18,v19
M v[208:211],a[80:83],v[40:43],v[208:211]
E v20,v102
M v[208:211],a[84:87],v[56:59],v[208:211]
R a[120:123],v7,30720
M v[212:215],a[84:87],v[60:63],v[212:215]
R a[124:127],v7,31744
M v[212:215],a[80:83],v[44:47],v[212:215]
E v21,v103
M v[220:223],a[88:91],v[44:47],v[220:223]
E v22,v108
M v[220:223],a[92:95],v[60:63],v[220:223]
AF v29,v20,v29
C v53,v20,v21
M v[216:219],a[92:95],v[56:59],v[216:219]
s_waitcnt vmcnt(16) lgkmcnt(0)
AF v29,v21,v29
M v[216:219],a[88:91],v[40:43],v[216:219]
s_barrier
M v[224:227],a[96:99],v[40:43],v[224:227]
R a[64:67],v2,32768
M v[224:227],a[100:103],v[56:59],v[224:227]
E v23,v109
M v[228:231],a[100:103],v[60:63],v[228:231]
R a[68:71],v2,33792
v_cmp_gt_u32 vcc, s6, v5
M v[228:231],a[96:99],v[44:47],v[228:231]
E v24,v110
M v[236:239],a[104:107],v[44:47],v[236:239]
R a[72:75],v2,34816
AF v29,v22,v29
M v[236:239],a[108:111],v[60:63],v[236:239]
s_cbranch_vccnz L_fls0
L_flr0:
C v54,v22,v23
AF v29,v23,v29
M v[232:235],a[108:111],v[56:59],v[232:235]
s_mov_b32 s6, 0
R a[76:79],v2,35840
M v[232:235],a[104:107],v[40:43],v[232:235]
SA s7,s7,1
E v25,v111
M v[240:243],a[112:115],v[40:43],v[240:243]
R a[80:83],v2,36864
AF v29,v24,v29
M v[240:243],a[116:119],v[56:59],v[240:243]
C v55,v24,v25
AF v29,v25,v29
M v[244:247],a[116:119],v[60:63],v[244:247]
R a[84:87],v2,37888
M v[244:247],a[112:115],v[44:47],v[244:247]
M v[252:255],a[120:123],v[44:47],v[252:255]
s_sub_u32 s27, s27, 1
R a[88:91],v2,38912
M v[252:255],a[124:127],v[60:63],v[252:255]
s_cmp_lg_u32 s27, 0
M v[248:251],a[124:127],v[56:59],v[248:251]
s_waitcnt lgkmcnt(3)
R a[92:95],v2,39936
M v[248:251],a[120:123],v[40:43],v[248:251]
s_cbranch_scc1 L_loop_top
s_cmp_eq_u32 s40, 0
s_cbranch_scc1 L_final_h
L_d1s:
M v[68:71],a[64:67],a[32:35],v[36:39]
s_cmp_lt_u32 s20, 0
R a[96:99],v2,40960
R a[100:103],v2,41984
M v[68:71],a[68:71],a[36:39],v[68:71]
s_cselect_b64 s[82:83], -1, 0
E v18,v112
M v[68:71],a[72:75],a[40:43],v[68:71]
s_cmp_eq_u32 s20, 0
M v[68:71],a[76:79],a[44:47],v[68:71]
s_cselect_b64 s[66:67], s[16:17], s[82:83]
R a[104:107],v2,43008
R a[108:111],v2,44032
s_waitcnt lgkmcnt(7)
M v[68:71],a[80:83],a[48:51],v[68:71]
s_cselect_b64 s[68:69], s[18:19], s[82:83]
E v19,v113
s_waitcnt lgkmcnt(6)
M v[68:71],a[84:87],a[52:55],v[68:71]
s_cselect_b64 s[70:71], s[48:49], s[82:83]
AF v28,v18,v28
C v56,v18,v19
s_waitcnt lgkmcnt(5)
M v[68:71],a[88:91],a[56:59],v[68:71]
s_cselect_b64 s[72:73], s[50:51], s[82:83]
R a[112:115],v2,45056
R a[116:119],v2,46080
v_cndmask_b32 v64, v32, v8, s[66:67]
v_cndmask_b32 v65, v32, v8, s[68:69]
v_cndmask_b32 v66, v32, v8, s[70:71]
v_cndmask_b32 v67, v32, v8, s[72:73]
s_waitcnt lgkmcnt(6)
M v[68:71],a[92:95],a[60:63],v[68:71]
s_mov_b32 s26, s43
v_min_u32 v17, 896, v9
AF v28,v19,v28
M v[64:67],a[92:95],a[28:31],v[64:67]
s_cmp_lt_u32 s20, 1
buffer_load_dword v5, v17, s[8:11], s46 offen sc1
M v[64:67],a[88:91],a[24:27],v[64:67]
s_cselect_b64 s[82:83], -1, 0
R a[120:123],v2,47104
R a[124:127],v2,48128
M v[64:67],a[84:87],a[20:23],v[64:67]
SA m0,s28,0
E v20,v114
M v[64:67],a[80:83],a[16:19],v[64:67]
s_cmp_eq_u32 s20, 1
buffer_load_dwordx4 v3, s[8:11], s26 offen offset:0 sc1 lds
M v[64:67],a[76:79],a[12:15],v[64:67]
s_cselect_b64 s[74:75], s[16:17], s[82:83]
E v21,v115
M v[64:67],a[72:75],a[8:11],v[64:67]
s_cselect_b64 s[76:77], s[18:19], s[82:83]
AF v28,v20,v28
C v57,v20,v21
M v[64:67],a[68:71],a[4:7],v[64:67]
s_cselect_b64 s[78:79], s[48:49], s[82:83]
E v22,v120
M v[64:67],a[64:67],a[0:3],v[64:67]
s_waitcnt lgkmcnt(0)
buffer_load_dwordx4 v3, s[8:11], s26 offen offset:1024 sc1 lds
M v[76:79],a[96:99],a[32:35],v[36:39]
s_cselect_b64 s[80:81], s[50:51], s[82:83]
R a[64:67],v2,49152
R a[68:71],v2,50176
M v[76:79],a[100:103],a[36:39],v[76:79]
v_cndmask_b32 v72, v32, v8, s[74:75]
v_cndmask_b32 v73, v32, v8, s[76:77]
M v[76:79],a[104:107],a[40:43],v[76:79]
v_cndmask_b32 v74, v32, v8, s[78:79]
AF v28,v21,v28
M v[76:79],a[108:111],a[44:47],v[76:79]
R a[72:75],v2,51200
R a[76:79],v2,52224
M v[76:79],a[112:115],a[48:51],v[76:79]
buffer_load_dwordx4 v3, s[8:11], s26 offen offset:2048 sc1 lds
M v[76:79],a[116:119],a[52:55],v[76:79]
v_cndmask_b32 v75, v32, v8, s[80:81]
M v[76:79],a[120:123],a[56:59],v[76:79]
s_cmp_lt_u32 s20, 2
R a[80:83],v2,53248
R a[84:87],v2,54272
M v[76:79],a[124:127],a[60:63],v[76:79]
s_cselect_b64 s[82:83], -1, 0
E v23,v121
M v[72:75],a[124:127],a[28:31],v[72:75]
s_cmp_eq_u32 s20, 2
buffer_load_dwordx4 v3, s[8:11], s26 offen offset:3072 sc1 lds
M v[72:75],a[120:123],a[24:27],v[72:75]
s_cselect_b64 s[66:67], s[16:17], s[82:83]
R a[88:91],v2,55296
R a[92:95],v2,56320
M v[72:75],a[116:119],a[20:23],v[72:75]
s_cselect_b64 s[68:69], s[18:19], s[82:83]
E v24,v122
M v[72:75],a[112:115],a[16:19],v[72:75]
s_cselect_b64 s[70:71], s[48:49], s[82:83]
E v25,v123
M v[72:75],a[108:111],a[12:15],v[72:75]
s_cselect_b64 s[72:73], s[50:51], s[82:83]
v_cndmask_b32 v80, v32, v8, s[66:67]
v_cndmask_b32 v81, v32, v8, s[68:69]
M v[72:75],a[104:107],a[8:11],v[72:75]
SA m0,s28,4096
E v18,v116
M v[72:75],a[100:103],a[4:7],v[72:75]
s_lshl_b32 s86, s20, 14
buffer_load_dwordx4 v4, s[8:11], s26 offen offset:0 sc1 lds
M v[72:75],a[96:99],a[0:3],v[72:75]
s_waitcnt lgkmcnt(0)
v_cndmask_b32 v82, v32, v8, s[70:71]
AF v28,v22,v28
M v[84:87],a[64:67],a[32:35],v[36:39]
SA s86,s86,s34
R a[96:99],v2,57344
R a[100:103],v2,58368
M v[84:87],a[68:71],a[36:39],v[84:87]
SA s87,s86,4096
buffer_load_dwordx4 v4, s[8:11], s26 offen offset:1024 sc1 lds
M v[84:87],a[72:75],a[40:43],v[84:87]
SA s88,s86,8192
v_cndmask_b32 v83, v32, v8, s[72:73]
C v58,v22,v23
M v[84:87],a[76:79],a[44:47],v[84:87]
s_cmp_lt_u32 s20, 3
R a[104:107],v2,59392
R a[108:111],v2,60416
M v[84:87],a[80:83],a[48:51],v[84:87]
s_cselect_b64 s[82:83], -1, 0
E v19,v117
M v[84:87],a[84:87],a[52:55],v[84:87]
SA s89,s86,12288
buffer_load_dwordx4 v4, s[8:11], s26 offen offset:2048 sc1 lds
M v[84:87],a[88:91],a[56:59],v[84:87]
s_lshl_b32 s90, s20, 10
R a[112:115],v2,61440
R a[116:119],v2,62464
M v[84:87],a[92:95],a[60:63],v[84:87]
SA s90,s90,s34
E v20,v118
M v[80:83],a[92:95],a[28:31],v[80:83]
SA s90,s90,65536
E v21,v119
M v[80:83],a[88:91],a[24:27],v[80:83]
s_cmp_eq_u32 s20, 3
R a[120:123],v2,63488
R a[124:127],v2,64512
M v[80:83],a[84:87],a[20:23],v[80:83]
s_cselect_b64 s[74:75], s[16:17], s[82:83]
buffer_load_dwordx4 v4, s[8:11], s26 offen offset:3072 sc1 lds
M v[80:83],a[80:83],a[16:19],v[80:83]
s_cselect_b64 s[76:77], s[18:19], s[82:83]
AF v28,v23,v28
AF v28,v24,v28
M v[80:83],a[76:79],a[12:15],v[80:83]
s_cselect_b64 s[78:79], s[48:49], s[82:83]
E v22,v124
M v[80:83],a[72:75],a[8:11],v[80:83]
s_cselect_b64 s[80:81], s[50:51], s[82:83]
v_cndmask_b32 v88, v32, v8, s[74:75]
v_cndmask_b32 v89, v32, v8, s[76:77]
M v[80:83],a[68:71],a[4:7],v[80:83]
s_waitcnt vmcnt(17) lgkmcnt(0)
v_cndmask_b32 v90, v32, v8, s[78:79]
v_cndmask_b32 v91, v32, v8, s[80:81]
M v[80:83],a[64:67],a[0:3],v[80:83]
s_barrier
M v[92:95],a[96:99],a[32:35],v[36:39]
SA s26,s26,32768
R a[64:67],v7,32768
R a[68:71],v7,33792
M v[92:95],a[100:103],a[36:39],v[92:95]
SA m0,s28,131072
E v23,v125
M v[92:95],a[104:107],a[40:43],v[92:95]
buffer_load_dwordx4 v3, s[8:11], s26 offen offset:0 sc1 lds
M v[92:95],a[108:111],a[44:47],v[92:95]
R a[72:75],v7,34816
R a[76:79],v7,35840
M v[92:95],a[112:115],a[48:51],v[92:95]
C v59,v24,v25
AF v28,v25,v28
M v[92:95],a[116:119],a[52:55],v[92:95]
buffer_load_dwordx4 v3, s[8:11], s26 offen offset:1024 sc1 lds
M v[92:95],a[120:123],a[56:59],v[92:95]
R a[80:83],v7,36864
R a[84:87],v7,37888
M v[92:95],a[124:127],a[60:63],v[92:95]
E v24,v126
M v[88:91],a[124:127],a[28:31],v[88:91]
buffer_load_dwordx4 v3, s[8:11], s26 offen offset:2048 sc1 lds
M v[88:91],a[120:123],a[24:27],v[88:91]
R a[88:91],v7,38912
R a[92:95],v7,39936
M v[88:91],a[116:119],a[20:23],v[88:91]
E v25,v127
M v[88:91],a[112:115],a[16:19],v[88:91]
buffer_load_dwordx4 v3, s[8:11], s26 offen offset:3072 sc1 lds
M v[88:91],a[108:111],a[12:15],v[88:91]
AF v29,v18,v29
C v60,v18,v19
M v[88:91],a[104:107],a[8:11],v[88:91]
AF v29,v19,v29
AF v29,v20,v29
M v[88:91],a[100:103],a[4:7],v[88:91]
s_waitcnt lgkmcnt(0)
C v61,v20,v21
AF v29,v21,v29
M v[88:91],a[96:99],a[0:3],v[88:91]
AF v29,v22,v29
C v62,v22,v23
AF v29,v23,v29
AF v29,v24,v29
C v63,v24,v25
AF v29,v25,v29
v_max_f32 v10, v28, v29
v_cmp_lt_f32 vcc, s31, v10
s_nop 0
s_cbranch_vccnz L_std1
L_rtd1:
s_cmp_lt_u32 s42, 6
s_cbranch_scc1 L_d2h
M v[128:131],a[64:67],v[48:51],v[128:131]
R a[96:99],v7,40960
R a[100:103],v7,41984
M v[128:131],a[68:71],v[56:59],v[128:131]
SA m0,s28,135168
E v18,v64
M v[132:135],a[68:71],v[60:63],v[132:135]
buffer_load_dwordx4 v4, s[8:11], s26 offen offset:0 sc1 lds
M v[132:135],a[64:67],v[52:55],v[132:135]
R a[104:107],v7,43008
R a[108:111],v7,44032
M v[140:143],a[72:75],v[52:55],v[140:143]
s_cmp_gt_u32 s20, 3
E v19,v65
M v[140:143],a[76:79],v[60:63],v[140:143]
s_cselect_b64 s[82:83], -1, 0
AF v30,v28,v30
AF v31,v29,v31
M v[136:139],a[76:79],v[56:59],v[136:139]
s_cmp_eq_u32 s20, 3
R a[112:115],v7,45056
R a[116:119],v7,46080
M v[136:139],a[72:75],v[48:51],v[136:139]
s_cselect_b64 s[66:67], s[16:17], s[82:83]
buffer_load_dwordx4 v4, s[8:11], s26 offen offset:1024 sc1 lds
M v[144:147],a[80:83],v[48:51],v[144:147]
s_cselect_b64 s[68:69], s[18:19], s[82:83]
E v20,v66
M v[144:147],a[84:87],v[56:59],v[144:147]
s_cselect_b64 s[70:71], s[48:49], s[82:83]
R a[120:123],v7,47104
R a[124:127],v7,48128
M v[148:151],a[84:87],v[60:63],v[148:151]
s_cselect_b64 s[72:73], s[50:51], s[82:83]
v_cndmask_b32 v100, v36, v8, s[66:67]
v_cndmask_b32 v101, v36, v8, s[68:69]
M v[148:151],a[80:83],v[52:55],v[148:151]
buffer_load_dwordx4 v4, s[8:11], s26 offen offset:2048 sc1 lds
M v[156:159],a[88:91],v[52:55],v[156:159]
v_cndmask_b32 v102, v36, v8, s[70:71]
AF v26,v18,v19
M v[156:159],a[92:95],v[60:63],v[156:159]
E v21,v67
M v[152:155],a[92:95],v[56:59],v[152:155]
v_cndmask_b32 v103, v36, v8, s[72:73]
C v40,v18,v19
M v[152:155],a[88:91],v[48:51],v[152:155]
s_waitcnt lgkmcnt(0)
buffer_load_dwordx4 v4, s[8:11], s26 offen offset:3072 sc1 lds
M v[160:163],a[96:99],v[48:51],v[160:163]
s_cmp_gt_u32 s20, 2
R a[64:67],v7,49152
R a[68:71],v7,50176
M v[160:163],a[100:103],v[56:59],v[160:163]
s_cselect_b64 s[82:83], -1, 0
v_lshrrev_b32 v14, 7, v7
AF v26,v20,v26
M v[164:167],a[100:103],v[60:63],v[164:167]
s_cmp_eq_u32 s20, 2
v_mul_u32_u24 v14, 896, v14
C v41,v20,v21
M v[164:167],a[96:99],v[52:55],v[164:167]
s_cselect_b64 s[74:75], s[16:17], s[82:83]
R a[72:75],v7,51200
R a[76:79],v7,52224
M v[172:175],a[104:107],v[52:55],v[172:175]
s_cselect_b64 s[76:77], s[18:19], s[82:83]
v_lshrrev_b32 v15, 8, v7
AF v26,v21,v26
M v[172:175],a[108:111],v[60:63],v[172:175]
s_cselect_b64 s[78:79], s[48:49], s[82:83]
v_lshlrev_b32 v15, 5, v15
M v[168:171],a[108:111],v[56:59],v[168:171]
s_cselect_b64 s[80:81], s[50:51], s[82:83]
R a[80:83],v7,53248
R a[84:87],v7,54272
M v[168:171],a[104:107],v[48:51],v[168:171]
v_cndmask_b32 v108, v36, v8, s[74:75]
v_cndmask_b32 v109, v36, v8, s[76:77]
M v[176:179],a[112:115],v[48:51],v[176:179]
v_xor_b32 v15, v15, v7
M v[176:179],a[116:119],v[56:59],v[176:179]
R a[88:91],v7,55296
R a[92:95],v7,56320
M v[180:183],a[116:119],v[60:63],v[180:183]
v_and_b32 v15, 0x70, v15
v_cndmask_b32 v110, v36, v8, s[78:79]
M v[180:183],a[112:115],v[52:55],v[180:183]
v_add_u32 v0, v14, v15
M v[188:191],a[120:123],v[52:55],v[188:191]
s_mul_i32 s38, s20, 57344
v_cndmask_b32 v111, v36, v8, s[80:81]
M v[188:191],a[124:127],v[60:63],v[188:191]
s_cmp_gt_u32 s20, 1
E v22,v72
M v[184:187],a[124:127],v[56:59],v[184:187]
s_cselect_b64 s[82:83], -1, 0
E v23,v73
M v[184:187],a[120:123],v[48:51],v[184:187]
s_waitcnt lgkmcnt(0)
E v24,v74
M v[192:195],a[64:67],v[48:51],v[192:195]
SA m0,s28,98304
R a[96:99],v7,57344
R a[100:103],v7,58368
M v[192:195],a[68:71],v[56:59],v[192:195]
s_cmp_eq_u32 s20, 1
E v25,v75
M v[196:199],a[68:71],v[60:63],v[196:199]
s_cselect_b64 s[66:67], s[16:17], s[82:83]
E v18,v68
M v[196:199],a[64:67],v[52:55],v[196:199]
s_cselect_b64 s[68:69], s[18:19], s[82:83]
R a[104:107],v7,59392
R a[108:111],v7,60416
M v[204:207],a[72:75],v[52:55],v[204:207]
s_cselect_b64 s[70:71], s[48:49], s[82:83]
E v19,v69
M v[204:207],a[76:79],v[60:63],v[204:207]
s_cselect_b64 s[72:73], s[50:51], s[82:83]
v_cndmask_b32 v116, v36, v8, s[66:67]
v_cndmask_b32 v117, v36, v8, s[68:69]
M v[200:203],a[76:79],v[56:59],v[200:203]
SA s85,s38,0
R a[112:115],v7,61440
R a[116:119],v7,62464
M v[200:203],a[72:75],v[48:51],v[200:203]
buffer_load_dwordx4 v0, s[12:15], s85 offen offset:0 lds
M v[208:211],a[80:83],v[48:51],v[208:211]
SA s85,s38,6144
v_cndmask_b32 v118, v36, v8, s[70:71]
AF v26,v22,v26
M v[208:211],a[84:87],v[56:59],v[208:211]
R a[120:123],v7,63488
R a[124:127],v7,64512
M v[212:215],a[84:87],v[60:63],v[212:215]
buffer_load_dwordx4 v0, s[12:15], s85 offen offset:1024 lds
M v[212:215],a[80:83],v[52:55],v[212:215]
SA s85,s38,12288
v_cndmask_b32 v119, v36, v8, s[72:73]
C v42,v22,v23
M v[220:223],a[88:91],v[52:55],v[220:223]
s_cmp_gt_u32 s20, 0
E v20,v70
M v[220:223],a[92:95],v[60:63],v[220:223]
s_cselect_b64 s[82:83], -1, 0
buffer_load_dwordx4 v0, s[12:15], s85 offen offset:2048 lds
M v[216:219],a[92:95],v[56:59],v[216:219]
s_waitcnt vmcnt(20) lgkmcnt(0)
E v21,v71
M v[216:219],a[88:91],v[48:51],v[216:219]
s_barrier
M v[224:227],a[96:99],v[48:51],v[224:227]
SA s85,s38,18432
R a[64:67],v2,0
R a[68:71],v2,1024
M v[224:227],a[100:103],v[56:59],v[224:227]
s_cmp_eq_u32 s20, 0
buffer_load_dwordx4 v0, s[12:15], s85 offen offset:3072 lds
M v[228:231],a[100:103],v[60:63],v[228:231]
s_cselect_b64 s[74:75], s[16:17], s[82:83]
AF v26,v23,v26
AF v26,v24,v26
M v[228:231],a[96:99],v[52:55],v[228:231]
s_cselect_b64 s[76:77], s[18:19], s[82:83]
R a[72:75],v2,2048
R a[76:79],v2,3072
M v[236:239],a[104:107],v[52:55],v[236:239]
s_cselect_b64 s[78:79], s[48:49], s[82:83]
E v22,v76
M v[236:239],a[108:111],v[60:63],v[236:239]
s_cselect_b64 s[80:81], s[50:51], s[82:83]
v_cndmask_b32 v124, v36, v8, s[74:75]
v_cndmask_b32 v125, v36, v8, s[76:77]
M v[232:235],a[108:111],v[56:59],v[232:235]
SA m0,s28,102400
R a[80:83],v2,4096
R a[84:87],v2,5120
M v[232:235],a[104:107],v[48:51],v[232:235]
SA s85,s38,28672
buffer_load_dwordx4 v0, s[12:15], s85 offen offset:0 lds
M v[240:243],a[112:115],v[48:51],v[240:243]
SA s85,s38,34816
v_cndmask_b32 v126, v36, v8, s[78:79]
v_cndmask_b32 v127, v36, v8, s[80:81]
M v[240:243],a[116:119],v[56:59],v[240:243]
R a[88:91],v2,6144
R a[92:95],v2,7168
M v[244:247],a[116:119],v[60:63],v[244:247]
buffer_load_dwordx4 v0, s[12:15], s85 offen offset:1024 lds
M v[244:247],a[112:115],v[52:55],v[244:247]
SA s85,s38,40960
E v23,v77
M v[252:255],a[120:123],v[52:55],v[252:255]
buffer_load_dwordx4 v0, s[12:15], s85 offen offset:2048 lds
M v[252:255],a[124:127],v[60:63],v[252:255]
SA s85,s38,47104
C v43,v24,v25
AF v26,v25,v26
M v[248:251],a[124:127],v[56:59],v[248:251]
s_waitcnt lgkmcnt(0)
E v24,v78
M v[248:251],a[120:123],v[48:51],v[248:251]
buffer_load_dwordx4 v0, s[12:15], s85 offen offset:3072 lds
SA s38,s38,128
AF v27,v18,v19
C v44,v18,v19
AF v27,v20,v27
C v45,v20,v21
AF v27,v21,v27
E v25,v79
AF v27,v22,v27
C v46,v22,v23
AF v27,v23,v27
AF v27,v24,v27
C v47,v24,v25
AF v27,v25,v27
M v[100:103],a[64:67],a[32:35],v[100:103]
R a[96:99],v2,8192
R a[100:103],v2,9216
M v[100:103],a[68:71],a[36:39],v[100:103]
R a[104:107],v2,10240
R a[108:111],v2,11264
M v[100:103],a[72:75],a[40:43],v[100:103]
R a[112:115],v2,12288
R a[116:119],v2,13312
M v[100:103],a[76:79],a[44:47],v[100:103]
R a[120:123],v2,14336
R a[124:127],v2,15360
M v[100:103],a[80:83],a[48:51],v[100:103]
v_add_u32 v8, 0x20000, v7
M v[100:103],a[84:87],a[52:55],v[100:103]
SA m0,s28,32768
E v18,v80
M v[100:103],a[88:91],a[56:59],v[100:103]
SA s85,s38,0
buffer_load_dwordx4 v0, s[12:15], s85 offen offset:0 lds
M v[100:103],a[92:95],a[60:63],v[100:103]
s_waitcnt lgkmcnt(0)
E v19,v81
M v[108:111],a[96:99],a[32:35],v[108:111]
SA s85,s38,6144
R a[64:67],v2,16384
R a[68:71],v2,17408
M v[108:111],a[100:103],a[36:39],v[108:111]
R a[72:75],v2,18432
R a[76:79],v2,19456
M v[108:111],a[104:107],a[40:43],v[108:111]
R a[80:83],v2,20480
R a[84:87],v2,21504
M v[108:111],a[108:111],a[44:47],v[108:111]
R a[88:91],v2,22528
R a[92:95],v2,23552
M v[108:111],a[112:115],a[48:51],v[108:111]
buffer_load_dwordx4 v0, s[12:15], s85 offen offset:1024 lds
M v[108:111],a[116:119],a[52:55],v[108:111]
SA s85,s38,12288
E v20,v82
M v[108:111],a[120:123],a[56:59],v[108:111]
buffer_load_dwordx4 v0, s[12:15], s85 offen offset:2048 lds
M v[108:111],a[124:127],a[60:63],v[108:111]
s_waitcnt lgkmcnt(0)
E v21,v83
M v[116:119],a[64:67],a[32:35],v[116:119]
SA s85,s38,18432
R a[96:99],v2,24576
R a[100:103],v2,25600
M v[116:119],a[68:71],a[36:39],v[116:119]
R a[104:107],v2,26624
R a[108:111],v2,27648
M v[116:119],a[72:75],a[40:43],v[116:119]
R a[112:115],v2,28672
R a[116:119],v2,29696
M v[116:119],a[76:79],a[44:47],v[116:119]
R a[120:123],v2,30720
R a[124:127],v2,31744
M v[116:119],a[80:83],a[48:51],v[116:119]
buffer_load_dwordx4 v0, s[12:15], s85 offen offset:3072 lds
M v[116:119],a[84:87],a[52:55],v[116:119]
buffer_load_dword v6, off, s[8:11], s47 sc1
M v[116:119],a[88:91],a[56:59],v[116:119]
s_waitcnt vmcnt(21) lgkmcnt(0)
E v22,v88
M v[116:119],a[92:95],a[60:63],v[116:119]
s_barrier
M v[124:127],a[96:99],a[32:35],v[124:127]
R a[64:67],v7,0
R a[68:71],v7,1024
M v[124:127],a[100:103],a[36:39],v[124:127]
R a[72:75],v7,2048
R a[76:79],v7,3072
M v[124:127],a[104:107],a[40:43],v[124:127]
R a[80:83],v7,4096
R a[84:87],v7,5120
M v[124:127],a[108:111],a[44:47],v[124:127]
R a[88:91],v7,6144
R a[92:95],v7,7168
M v[124:127],a[112:115],a[48:51],v[124:127]
E v23,v89
M v[124:127],a[116:119],a[52:55],v[124:127]
E v24,v90
M v[124:127],a[120:123],a[56:59],v[124:127]
s_waitcnt lgkmcnt(0)
E v25,v91
M v[124:127],a[124:127],a[60:63],v[124:127]
AF v26,v18,v26
C v56,v18,v19
AF v26,v19,v26
AF v26,v20,v26
C v57,v20,v21
AF v26,v21,v26
AF v26,v22,v26
C v58,v22,v23
AF v26,v23,v26
E v18,v84
E v19,v85
AF v26,v24,v26
C v59,v24,v25
AF v26,v25,v26
E v20,v86
E v21,v87
AF v27,v18,v27
C v60,v18,v19
AF v27,v19,v27
E v22,v92
E v23,v93
AF v27,v20,v27
C v61,v20,v21
AF v27,v21,v27
E v24,v94
E v25,v95
AF v27,v22,v27
C v62,v22,v23
AF v27,v23,v27
AF v27,v24,v27
C v63,v24,v25
AF v27,v25,v27
v_max_f32 v10, v26, v27
v_cmp_lt_f32 vcc, s31, v10
s_nop 0
s_cbranch_vccnz L_std3n
L_rtd3n:
M v[128:131],a[64:67],v[40:43],v[128:131]
R a[96:99],v7,8192
R a[100:103],v7,9216
M v[128:131],a[68:71],v[56:59],v[128:131]
v_or_b32 v9, s35, v7
s_waitcnt vmcnt(0)
v_cmp_ne_u32 vcc, 1, v6
M v[132:135],a[68:71],v[60:63],v[132:135]
s_cbranch_vccnz L_fps
L_fpr:
E v18,v100
M v[132:135],a[64:67],v[44:47],v[132:135]
R a[104:107],v7,10240
R a[108:111],v7,11264
M v[140:143],a[72:75],v[44:47],v[140:143]
buffer_load_dwordx4 v[14:17], v9, s[8:11], s90 offen sc1
M v[140:143],a[76:79],v[60:63],v[140:143]
E v19,v101
M v[136:139],a[76:79],v[56:59],v[136:139]
R a[112:115],v7,12288
R a[116:119],v7,13312
M v[136:139],a[72:75],v[40:43],v[136:139]
buffer_load_dwordx4 a[160:163], v9, s[8:11], s88 offen offset:0 sc1
M v[144:147],a[80:83],v[40:43],v[144:147]
E v20,v102
M v[144:147],a[84:87],v[56:59],v[144:147]
R a[120:123],v7,14336
R a[124:127],v7,15360
M v[148:151],a[84:87],v[60:63],v[148:151]
buffer_load_dwordx4 a[128:131], v9, s[8:11], s86 offen offset:0 sc1
M v[148:151],a[80:83],v[44:47],v[148:151]
E v21,v103
M v[156:159],a[88:91],v[44:47],v[156:159]
AF v30,v26,v30
AF v31,v27,v31
M v[156:159],a[92:95],v[60:63],v[156:159]
buffer_load_dwordx4 a[164:167], v9, s[8:11], s88 offen offset:1024 sc1
M v[152:155],a[92:95],v[56:59],v[152:155]
AF v29,v18,v19
C v52,v18,v19
M v[152:155],a[88:91],v[40:43],v[152:155]
s_waitcnt lgkmcnt(0)
E v22,v108
M v[160:163],a[96:99],v[40:43],v[160:163]
R a[64:67],v7,16384
R a[68:71],v7,17408
M v[160:163],a[100:103],v[56:59],v[160:163]
buffer_load_dwordx4 a[132:135], v9, s[8:11], s86 offen offset:1024 sc1
M v[164:167],a[100:103],v[60:63],v[164:167]
E v23,v109
M v[164:167],a[96:99],v[44:47],v[164:167]
R a[72:75],v7,18432
R a[76:79],v7,19456
M v[172:175],a[104:107],v[44:47],v[172:175]
buffer_load_dwordx4 a[168:171], v9, s[8:11], s88 offen offset:2048 sc1
M v[172:175],a[108:111],v[60:63],v[172:175]
AF v29,v20,v29
C v53,v20,v21
M v[168:171],a[108:111],v[56:59],v[168:171]
R a[80:83],v7,20480
R a[84:87],v7,21504
M v[168:171],a[104:107],v[40:43],v[168:171]
buffer_load_dwordx4 a[136:139], v9, s[8:11], s86 offen offset:2048 sc1
M v[176:179],a[112:115],v[40:43],v[176:179]
E v24,v110
M v[176:179],a[116:119],v[56:59],v[176:179]
R a[88:91],v7,22528
R a[92:95],v7,23552
M v[180:183],a[116:119],v[60:63],v[180:183]
buffer_load_dwordx4 a[172:175], v9, s[8:11], s88 offen offset:3072 sc1
M v[180:183],a[112:115],v[44:47],v[180:183]
E v25,v111
M v[188:191],a[120:123],v[44:47],v[188:191]
AF v29,v21,v29
AF v29,v22,v29
M v[188:191],a[124:127],v[60:63],v[188:191]
buffer_load_dwordx4 a[140:143], v9, s[8:11], s86 offen offset:3072 sc1
M v[184:187],a[124:127],v[56:59],v[184:187]
E v18,v116
M v[184:187],a[120:123],v[40:43],v[184:187]
s_waitcnt lgkmcnt(0)
C v54,v22,v23
AF v29,v23,v29
M v[192:195],a[64:67],v[40:43],v[192:195]
R a[96:99],v7,24576
R a[100:103],v7,25600
M v[192:195],a[68:71],v[56:59],v[192:195]
buffer_load_dwordx4 a[176:179], v9, s[8:11], s89 offen offset:0 sc1
M v[196:199],a[68:71],v[60:63],v[196:199]
E v19,v117
M v[196:199],a[64:67],v[44:47],v[196:199]
R a[104:107],v7,26624
R a[108:111],v7,27648
M v[204:207],a[72:75],v[44:47],v[204:207]
buffer_load_dwordx4 a[144:147], v9, s[8:11], s87 offen offset:0 sc1
M v[204:207],a[76:79],v[60:63],v[204:207]
E v20,v118
M v[200:203],a[76:79],v[56:59],v[200:203]
R a[112:115],v7,28672
R a[116:119],v7,29696
M v[200:203],a[72:75],v[40:43],v[200:203]
buffer_load_dwordx4 a[180:183], v9, s[8:11], s89 offen offset:1024 sc1
M v[208:211],a[80:83],v[40:43],v[208:211]
AF v29,v24,v29
C v55,v24,v25
M v[208:211],a[84:87],v[56:59],v[208:211]
R a[120:123],v7,30720
R a[124:127],v7,31744
M v[212:215],a[84:87],v[60:63],v[212:215]
buffer_load_dwordx4 a[148:151], v9, s[8:11], s87 offen offset:1024 sc1
M v[212:215],a[80:83],v[44:47],v[212:215]
E v21,v119
M v[220:223],a[88:91],v[44:47],v[220:223]
AF v29,v25,v29
AF v29,v18,v29
M v[220:223],a[92:95],v[60:63],v[220:223]
buffer_load_dwordx4 a[184:187], v9, s[8:11], s89 offen offset:2048 sc1
M v[216:219],a[92:95],v[56:59],v[216:219]
s_waitcnt lgkmcnt(0)
E v22,v124
M v[216:219],a[88:91],v[40:43],v[216:219]
s_barrier
M v[224:227],a[96:99],v[40:43],v[224:227]
R a[64:67],v8,0
R a[68:71],v8,1024
M v[224:227],a[100:103],v[56:59],v[224:227]
buffer_load_dwordx4 a[152:155], v9, s[8:11], s87 offen offset:2048 sc1
M v[228:231],a[100:103],v[60:63],v[228:231]
E v23,v125
M v[228:231],a[96:99],v[44:47],v[228:231]
R a[72:75],v8,2048
R a[76:79],v8,3072
M v[236:239],a[104:107],v[44:47],v[236:239]
buffer_load_dwordx4 a[188:191], v9, s[8:11], s89 offen offset:3072 sc1
M v[236:239],a[108:111],v[60:63],v[236:239]
E v24,v126
M v[232:235],a[108:111],v[56:59],v[232:235]
R a[80:83],v8,4096
R a[84:87],v8,5120
M v[232:235],a[104:107],v[40:43],v[232:235]
buffer_load_dwordx4 a[156:159], v9, s[8:11], s87 offen offset:3072 sc1
M v[240:243],a[112:115],v[40:43],v[240:243]
E v25,v127
M v[240:243],a[116:119],v[56:59],v[240:243]
R a[88:91],v8,6144
R a[92:95],v8,7168
M v[244:247],a[116:119],v[60:63],v[244:247]
C v48,v18,v19
AF v29,v19,v29
M v[244:247],a[112:115],v[44:47],v[244:247]
AF v29,v20,v29
C v49,v20,v21
M v[252:255],a[120:123],v[44:47],v[252:255]
AF v29,v21,v29
AF v29,v22,v29
M v[252:255],a[124:127],v[60:63],v[252:255]
C v50,v22,v23
AF v29,v23,v29
M v[248:251],a[124:127],v[56:59],v[248:251]
s_waitcnt lgkmcnt(0)
AF v29,v24,v29
C v51,v24,v25
M v[248:251],a[120:123],v[40:43],v[248:251]
AF v29,v25,v29
v_cmp_lt_f32 vcc, s31, v29
s_nop 0
s_cbranch_vccnz L_std4n
L_rtd4n:
s_waitcnt vmcnt(16)
v_cmp_neq_f32 vcc, v32, v14
v_cmp_neq_f32 s[64:65], v36, v15
s_cmp_eq_u32 s35, 0
s_cselect_b64 s[66:67], -1, 0
s_or_b64 vcc, vcc, s[64:65]
s_and_b64 vcc, vcc, s[66:67]
s_cbranch_vccnz L_stc
L_rtc:
M v[132:135],a[64:67],v[52:55],v[132:135]
R a[96:99],v8,8192
R a[100:103],v8,9216
M v[132:135],a[68:71],v[48:51],v[132:135]
s_waitcnt vmcnt(12)
AF v30,v16,v30
AF v31,v17,v31
M v[132:135],a[246:249],a[160:163],v[132:135]
SA m0,s28,36864
AF v31,v29,v31
v_mov_b32 v10, v30
M v[128:131],a[246:249],a[128:131],v[128:131]
SA s85,s38,28672
R a[104:107],v8,10240
R a[108:111],v8,11264
M v[140:143],a[72:75],v[52:55],v[140:143]
buffer_load_dwordx4 v0, s[12:15], s85 offen offset:0 lds
M v[140:143],a[76:79],v[48:51],v[140:143]
SA s85,s38,34816
v_mov_b32 v11, v31
M v[140:143],a[244:247],a[160:163],v[140:143]
R a[112:115],v8,12288
R a[116:119],v8,13312
M v[136:139],a[244:247],a[128:131],v[136:139]
v_permlane16_swap_b32 v10, v30
M v[148:151],a[80:83],v[52:55],v[148:151]
v_permlane16_swap_b32 v11, v31
M v[148:151],a[84:87],v[48:51],v[148:151]
R a[120:123],v8,14336
R a[124:127],v8,15360
M v[148:151],a[246:249],a[164:167],v[148:151]
buffer_load_dwordx4 v0, s[12:15], s85 offen offset:1024 lds
M v[144:147],a[246:249],a[132:135],v[144:147]
SA s85,s38,40960
AF v30,v10,v30
AF v31,v11,v31
M v[156:159],a[88:91],v[52:55],v[156:159]
v_mov_b32 v10, v30
v_mov_b32 v11, v31
M v[156:159],a[92:95],v[48:51],v[156:159]
buffer_load_dwordx4 v0, s[12:15], s85 offen offset:2048 lds
M v[156:159],a[244:247],a[164:167],v[156:159]
s_waitcnt vmcnt(11)
v_permlane32_swap_b32 v10, v30
M v[152:155],a[244:247],a[132:135],v[152:155]
s_waitcnt lgkmcnt(0)
v_permlane32_swap_b32 v11, v31
M v[164:167],a[96:99],v[52:55],v[164:167]
SA s85,s38,47104
R a[64:67],v8,16384
R a[68:71],v8,17408
M v[164:167],a[100:103],v[48:51],v[164:167]
buffer_load_dwordx4 v0, s[12:15], s85 offen offset:3072 lds
M v[164:167],a[246:249],a[168:171],v[164:167]
SA s38,s38,128
C v132,v132,v133
C v133,v134,v135
M v[160:163],a[246:249],a[136:139],v[160:163]
SA m0,s28,65536
R a[72:75],v8,18432
R a[76:79],v8,19456
AF v30,v10,v30
AF v31,v11,v31
v_rcp_f32 v5, v30
v_rcp_f32 v6, v31
M v[172:175],a[104:107],v[52:55],v[172:175]
SA s85,s38,0
buffer_load_dwordx4 v0, s[12:15], s85 offen offset:0 lds
M v[172:175],a[108:111],v[48:51],v[172:175]
SA s85,s38,6144
C v134,v140,v141
C v135,v142,v143
M v[172:175],a[244:247],a[168:171],v[172:175]
R a[80:83],v8,20480
R a[84:87],v8,21504
M v[168:171],a[244:247],a[136:139],v[168:171]
buffer_load_dwordx4 v0, s[12:15], s85 offen offset:1024 lds
M v[180:183],a[112:115],v[52:55],v[180:183]
SA s85,s38,12288
C v128,v128,v129
C v129,v130,v131
M v[180:183],a[116:119],v[48:51],v[180:183]
R a[88:91],v8,22528
R a[92:95],v8,23552
M v[180:183],a[246:249],a[172:175],v[180:183]
buffer_load_dwordx4 v0, s[12:15], s85 offen offset:2048 lds
M v[176:179],a[246:249],a[140:143],v[176:179]
SA s85,s38,18432
C v130,v136,v137
C v131,v138,v139
M v[188:191],a[120:123],v[52:55],v[188:191]
C v148,v148,v149
C v149,v150,v151
M v[188:191],a[124:127],v[48:51],v[188:191]
buffer_load_dwordx4 v0, s[12:15], s85 offen offset:3072 lds
M v[188:191],a[244:247],a[172:175],v[188:191]
s_waitcnt vmcnt(12)
C v150,v156,v157
C v151,v158,v159
M v[184:187],a[244:247],a[140:143],v[184:187]
s_waitcnt lgkmcnt(0)
C v144,v144,v145
C v145,v146,v147
M v[196:199],a[64:67],v[52:55],v[196:199]
SA m0,s28,69632
R a[96:99],v8,24576
R a[100:103],v8,25600
M v[196:199],a[68:71],v[48:51],v[196:199]
SA s85,s38,28672
buffer_load_dwordx4 v0, s[12:15], s85 offen offset:0 lds
M v[196:199],a[246:249],a[176:179],v[196:199]
SA s85,s38,34816
C v146,v152,v153
C v147,v154,v155
M v[192:195],a[246:249],a[144:147],v[192:195]
R a[104:107],v8,26624
R a[108:111],v8,27648
M v[204:207],a[72:75],v[52:55],v[204:207]
buffer_load_dwordx4 v0, s[12:15], s85 offen offset:1024 lds
M v[204:207],a[76:79],v[48:51],v[204:207]
SA s85,s38,40960
v_lshrrev_b32 v16, 4, v7
v_lshrrev_b32 v14, 2, v16
M v[204:207],a[244:247],a[176:179],v[204:207]
R a[112:115],v8,28672
R a[116:119],v8,29696
M v[200:203],a[244:247],a[144:147],v[200:203]
buffer_load_dwordx4 v0, s[12:15], s85 offen offset:2048 lds
M v[212:215],a[80:83],v[52:55],v[212:215]
SA s85,s38,47104
v_lshlrev_b32 v14, 7, v14
v_and_b32 v15, 3, v16
M v[212:215],a[84:87],v[48:51],v[212:215]
R a[120:123],v8,30720
R a[124:127],v8,31744
M v[212:215],a[246:249],a[180:183],v[212:215]
buffer_load_dwordx4 v0, s[12:15], s85 offen offset:3072 lds
M v[208:211],a[246:249],a[148:151],v[208:211]
SA s38,s38,128
v_lshl_add_u32 v14, v15, 3, v14
C v164,v164,v165
M v[220:223],a[88:91],v[52:55],v[220:223]
C v165,v166,v167
C v166,v172,v173
M v[220:223],a[92:95],v[48:51],v[220:223]
s_waitcnt vmcnt(12)
C v167,v174,v175
C v160,v160,v161
M v[220:223],a[244:247],a[180:183],v[220:223]
s_waitcnt lgkmcnt(0)
v_bfe_u32 v15, v16, 3, 2
v_lshl_add_u32 v18, v15, 5, v14
v_xor_b32 v19, 32, v18
v_xor_b32 v20, 64, v18
v_xor_b32 v21, 0x60, v18
v_add_u32 v22, 0x10000, v18
v_add_u32 v23, 0x10000, v19
v_add_u32 v24, 0x10000, v20
v_add_u32 v25, 0x10000, v21
M v[216:219],a[244:247],a[148:151],v[216:219]
s_barrier
M v[228:231],a[96:99],v[52:55],v[228:231]
s_nop 0
T a[64:65],v22,32768
T a[66:67],v22,34816
M v[228:231],a[100:103],v[48:51],v[228:231]
T a[68:69],v22,36864
T a[70:71],v22,38912
M v[228:231],a[246:249],a[184:187],v[228:231]
C v161,v162,v163
C v162,v168,v169
M v[224:227],a[246:249],a[152:155],v[224:227]
T a[72:73],v22,40960
T a[74:75],v22,43008
M v[236:239],a[104:107],v[52:55],v[236:239]
T a[76:77],v22,45056
T a[78:79],v22,47104
M v[236:239],a[108:111],v[48:51],v[236:239]
C v163,v170,v171
C v180,v180,v181
M v[236:239],a[244:247],a[184:187],v[236:239]
T a[80:81],v22,49152
T a[82:83],v22,51200
M v[232:235],a[244:247],a[152:155],v[232:235]
T a[84:85],v22,53248
T a[86:87],v22,55296
M v[244:247],a[112:115],v[52:55],v[244:247]
C v181,v182,v183
C v182,v188,v189
M v[244:247],a[116:119],v[48:51],v[244:247]
T a[88:89],v22,57344
T a[90:91],v22,59392
M v[244:247],a[246:249],a[188:191],v[244:247]
T a[92:93],v22,61440
T a[94:95],v22,63488
M v[240:243],a[246:249],a[156:159],v[240:243]
C v183,v190,v191
C v176,v176,v177
M v[252:255],a[120:123],v[52:55],v[252:255]
C v177,v178,v179
C v178,v184,v185
M v[252:255],a[124:127],v[48:51],v[252:255]
C v179,v186,v187
C v196,v196,v197
M v[252:255],a[244:247],a[188:191],v[252:255]
s_waitcnt lgkmcnt(0)
C v197,v198,v199
C v198,v204,v205
M v[248:251],a[244:247],a[156:159],v[248:251]
C v199,v206,v207
C v192,v192,v193
C v193,v194,v195
C v194,v200,v201
C v195,v202,v203
C v212,v212,v213
C v213,v214,v215
C v214,v220,v221
C v215,v222,v223
C v208,v208,v209
C v209,v210,v211
C v210,v216,v217
C v211,v218,v219
C v228,v228,v229
C v229,v230,v231
C v230,v236,v237
C v231,v238,v239
C v224,v224,v225
C v225,v226,v227
C v226,v232,v233
C v227,v234,v235
C v244,v244,v245
C v245,v246,v247
C v246,v252,v253
C v247,v254,v255
C v240,v240,v241
C v241,v242,v243
C v242,v248,v249
C v243,v250,v251
M v[64:67],a[64:67],v[128:131],0
s_sub_u32 s64, 15, s42
T a[96:97],v23,32768
T a[98:99],v23,34816
M v[64:67],a[68:71],v[144:147],v[64:67]
s_min_u32 s64, s64, s42
T a[100:101],v23,36864
T a[102:103],v23,38912
M v[64:67],a[72:75],v[160:163],v[64:67]
s_mul_i32 s45, s64, 8704
M v[64:67],a[76:79],v[176:179],v[64:67]
s_lshl_b32 s64, s41, 2
T a[104:105],v23,40960
T a[106:107],v23,43008
M v[64:67],a[80:83],v[192:195],v[64:67]
SA s45,s45,s64
T a[108:109],v23,45056
T a[110:111],v23,47104
M v[64:67],a[84:87],v[208:211],v[64:67]
s_lshl_b32 s64, s20, 8
M v[64:67],a[88:91],v[224:227],v[64:67]
SA s45,s45,s64
T a[112:113],v23,49152
T a[114:115],v23,51200
M v[64:67],a[92:95],v[240:243],v[64:67]
SA s45,s45,104992768
T a[116:117],v23,53248
T a[118:119],v23,55296
M v[68:71],a[92:95],v[244:247],0
s_mov_b32 s64, 1024
M v[68:71],a[88:91],v[228:231],v[68:71]
s_mov_b32 s66, 4096
T a[120:121],v23,57344
T a[122:123],v23,59392
M v[68:71],a[84:87],v[212:215],v[68:71]
s_cmp_lt_u32 s42, 8
T a[124:125],v23,61440
T a[126:127],v23,63488
M v[68:71],a[80:83],v[196:199],v[68:71]
s_cselect_b32 s64, 4352, s64
M v[68:71],a[76:79],v[180:183],v[68:71]
s_cselect_b32 s65, 0, 64
M v[68:71],a[72:75],v[164:167],v[68:71]
s_cselect_b32 s66, 536870912, s66
M v[68:71],a[68:71],v[148:151],v[68:71]
SA s3,s45,s64
M v[68:71],a[64:67],v[132:135],v[68:71]
s_waitcnt lgkmcnt(0)
M v[72:75],a[96:99],v[128:131],0
SA s45,s45,s65
T a[64:65],v24,32768
T a[66:67],v24,34816
M v[72:75],a[100:103],v[144:147],v[72:75]
SA m0,s28,0
T a[68:69],v24,36864
T a[70:71],v24,38912
M v[72:75],a[104:107],v[160:163],v[72:75]
SA s85,s38,0
buffer_load_dwordx4 v0, s[12:15], s85 offen offset:0 lds
M v[72:75],a[108:111],v[176:179],v[72:75]
SA s85,s38,6144
T a[72:73],v24,40960
T a[74:75],v24,43008
M v[72:75],a[112:115],v[192:195],v[72:75]
SA s29,s33,0
T a[76:77],v24,45056
T a[78:79],v24,47104
M v[72:75],a[116:119],v[208:211],v[72:75]
SA s30,s33,14336
buffer_load_dwordx4 v0, s[12:15], s85 offen offset:1024 lds
M v[72:75],a[120:123],v[224:227],v[72:75]
SA s85,s38,12288
T a[80:81],v24,49152
T a[82:83],v24,51200
M v[72:75],a[124:127],v[240:243],v[72:75]
T a[84:85],v24,53248
T a[86:87],v24,55296
M v[76:79],a[124:127],v[244:247],0
buffer_load_dwordx4 v0, s[12:15], s85 offen offset:2048 lds
M v[76:79],a[120:123],v[228:231],v[76:79]
SA s85,s38,18432
T a[88:89],v24,57344
T a[90:91],v24,59392
M v[76:79],a[116:119],v[212:215],v[76:79]
T a[92:93],v24,61440
T a[94:95],v24,63488
M v[76:79],a[112:115],v[196:199],v[76:79]
buffer_load_dwordx4 v0, s[12:15], s85 offen offset:3072 lds
M v[76:79],a[108:111],v[180:183],v[76:79]
SA m0,s28,4096
v_lshrrev_b32 v17, 5, v7
v_min_u32 v15, 1, v17
M v[76:79],a[104:107],v[164:167],v[76:79]
SA s85,s38,28672
buffer_load_dwordx4 v0, s[12:15], s85 offen offset:0 lds
M v[76:79],a[100:103],v[148:151],v[76:79]
SA s85,s38,34816
v_lshlrev_b32 v14, 3, v7
v_lshl_or_b32 v16, v15, 29, v14
M v[76:79],a[96:99],v[132:135],v[76:79]
s_waitcnt lgkmcnt(0)
buffer_load_dwordx4 v0, s[12:15], s85 offen offset:1024 lds
M v[80:83],a[64:67],v[128:131],0
SA s85,s38,40960
T a[96:97],v25,32768
T a[98:99],v25,34816
M v[80:83],a[68:71],v[144:147],v[80:83]
T a[100:101],v25,36864
T a[102:103],v25,38912
M v[80:83],a[72:75],v[160:163],v[80:83]
buffer_load_dwordx4 v0, s[12:15], s85 offen offset:2048 lds
M v[80:83],a[76:79],v[176:179],v[80:83]
SA s85,s38,47104
T a[104:105],v25,40960
T a[106:107],v25,43008
M v[80:83],a[80:83],v[192:195],v[80:83]
T a[108:109],v25,45056
T a[110:111],v25,47104
M v[80:83],a[84:87],v[208:211],v[80:83]
buffer_load_dwordx4 v0, s[12:15], s85 offen offset:3072 lds
M v[80:83],a[88:91],v[224:227],v[80:83]
SA s38,s38,128
T a[112:113],v25,49152
T a[114:115],v25,51200
M v[80:83],a[92:95],v[240:243],v[80:83]
SA m0,s28,131072
T a[116:117],v25,53248
T a[118:119],v25,55296
M v[84:87],a[92:95],v[244:247],0
SA s85,s38,0
buffer_load_dwordx4 v0, s[12:15], s85 offen offset:0 lds
M v[84:87],a[88:91],v[228:231],v[84:87]
SA s85,s38,6144
T a[120:121],v25,57344
T a[122:123],v25,59392
M v[84:87],a[84:87],v[212:215],v[84:87]
T a[124:125],v25,61440
T a[126:127],v25,63488
M v[84:87],a[80:83],v[196:199],v[84:87]
buffer_load_dwordx4 v0, s[12:15], s85 offen offset:1024 lds
M v[84:87],a[76:79],v[180:183],v[84:87]
SA s85,s38,12288
v_cmp_eq_u32 vcc, 1, v17
v_add_u32 v14, s66, v14
M v[84:87],a[72:75],v[164:167],v[84:87]
buffer_load_dwordx4 v0, s[12:15], s85 offen offset:2048 lds
M v[84:87],a[68:71],v[148:151],v[84:87]
s_waitcnt vmcnt(19) lgkmcnt(0)
v_mov_b32 v15, 1
v_cndmask_b32 v17, v16, v14, vcc
M v[84:87],a[64:67],v[132:135],v[84:87]
s_barrier
M v[88:91],a[96:99],v[128:131],0
SA s85,s38,18432
T a[64:65],v18,32768
T a[66:67],v18,34816
M v[88:91],a[100:103],v[144:147],v[88:91]
T a[68:69],v18,36864
T a[70:71],v18,38912
M v[88:91],a[104:107],v[160:163],v[88:91]
buffer_load_dwordx4 v0, s[12:15], s85 offen offset:3072 lds
M v[88:91],a[108:111],v[176:179],v[88:91]
SA m0,s28,135168
T a[72:73],v18,40960
T a[74:75],v18,43008
M v[88:91],a[112:115],v[192:195],v[88:91]
SA s85,s38,28672
T a[76:77],v18,45056
T a[78:79],v18,47104
M v[88:91],a[116:119],v[208:211],v[88:91]
buffer_load_dwordx4 v0, s[12:15], s85 offen offset:0 lds
M v[88:91],a[120:123],v[224:227],v[88:91]
SA s85,s38,34816
T a[80:81],v18,49152
T a[82:83],v18,51200
M v[88:91],a[124:127],v[240:243],v[88:91]
T a[84:85],v18,53248
T a[86:87],v18,55296
M v[92:95],a[124:127],v[244:247],0
buffer_load_dwordx4 v0, s[12:15], s85 offen offset:1024 lds
M v[92:95],a[120:123],v[228:231],v[92:95]
SA s85,s38,40960
T a[88:89],v18,57344
T a[90:91],v18,59392
M v[92:95],a[116:119],v[212:215],v[92:95]
T a[92:93],v18,61440
T a[94:95],v18,63488
M v[92:95],a[112:115],v[196:199],v[92:95]
buffer_load_dwordx4 v0, s[12:15], s85 offen offset:2048 lds
M v[92:95],a[108:111],v[180:183],v[92:95]
SA s85,s38,47104
v_add_u32 v40, 0x20000, v18
v_add_u32 v41, 0x20000, v19
M v[92:95],a[104:107],v[164:167],v[92:95]
buffer_load_dwordx4 v0, s[12:15], s85 offen offset:3072 lds
M v[92:95],a[100:103],v[148:151],v[92:95]
s_waitcnt lgkmcnt(0)
v_add_u32 v42, 0x20000, v20
v_add_u32 v43, 0x20000, v21
M v[92:95],a[96:99],v[132:135],v[92:95]
SA s38,s38,128
MF v64,v5,v64
MF v65,v5,v65
MF v66,v5,v66
MF v67,v5,v67
MF v72,v5,v72
MF v73,v5,v73
MF v74,v5,v74
MF v75,v5,v75
C v64,v64,v65
C v65,v66,v67
C v66,v72,v73
C v67,v74,v75
buffer_store_dwordx4 v[64:67], v7, s[8:11], s29 offen offset:0 sc1
MF v68,v6,v68
MF v69,v6,v69
MF v70,v6,v70
MF v71,v6,v71
MF v76,v6,v76
MF v77,v6,v77
MF v78,v6,v78
MF v79,v6,v79
C v68,v68,v69
C v69,v70,v71
C v70,v76,v77
C v71,v78,v79
buffer_store_dwordx4 v[68:71], v7, s[8:11], s30 offen offset:0 sc1
M v[96:99],a[64:67],v[128:131],0
s_nop 0
T a[96:97],v19,32768
T a[98:99],v19,34816
M v[96:99],a[68:71],v[144:147],v[96:99]
SA m0,s28,98304
T a[100:101],v19,36864
T a[102:103],v19,38912
M v[96:99],a[72:75],v[160:163],v[96:99]
SA s85,s38,0
buffer_load_dwordx4 v0, s[12:15], s85 offen offset:0 lds
M v[96:99],a[76:79],v[176:179],v[96:99]
s_nop 0
T a[104:105],v19,40960
T a[106:107],v19,43008
M v[96:99],a[80:83],v[192:195],v[96:99]
T a[108:109],v19,45056
T a[110:111],v19,47104
M v[96:99],a[84:87],v[208:211],v[96:99]
SA s85,s38,6144
MF v80,v5,v80
MF v81,v5,v81
M v[96:99],a[88:91],v[224:227],v[96:99]
T a[112:113],v19,49152
T a[114:115],v19,51200
M v[96:99],a[92:95],v[240:243],v[96:99]
T a[116:117],v19,53248
T a[118:119],v19,55296
M v[100:103],a[92:95],v[244:247],0
buffer_load_dwordx4 v0, s[12:15], s85 offen offset:1024 lds
M v[100:103],a[88:91],v[228:231],v[100:103]
s_nop 0
T a[120:121],v19,57344
T a[122:123],v19,59392
M v[100:103],a[84:87],v[212:215],v[100:103]
T a[124:125],v19,61440
T a[126:127],v19,63488
M v[100:103],a[80:83],v[196:199],v[100:103]
SA s85,s38,12288
MF v82,v5,v82
MF v83,v5,v83
M v[100:103],a[76:79],v[180:183],v[100:103]
buffer_load_dwordx4 v0, s[12:15], s85 offen offset:2048 lds
M v[100:103],a[72:75],v[164:167],v[100:103]
MF v88,v5,v88
MF v89,v5,v89
M v[100:103],a[68:71],v[148:151],v[100:103]
MF v90,v5,v90
MF v91,v5,v91
M v[100:103],a[64:67],v[132:135],v[100:103]
s_waitcnt lgkmcnt(0)
C v80,v80,v81
C v81,v82,v83
M v[104:107],a[96:99],v[128:131],0
SA s85,s38,18432
T a[64:65],v20,32768
T a[66:67],v20,34816
M v[104:107],a[100:103],v[144:147],v[104:107]
T a[68:69],v20,36864
T a[70:71],v20,38912
M v[104:107],a[104:107],v[160:163],v[104:107]
buffer_load_dwordx4 v0, s[12:15], s85 offen offset:3072 lds
M v[104:107],a[108:111],v[176:179],v[104:107]
s_nop 0
T a[72:73],v20,40960
T a[74:75],v20,43008
M v[104:107],a[112:115],v[192:195],v[104:107]
T a[76:77],v20,45056
T a[78:79],v20,47104
M v[104:107],a[116:119],v[208:211],v[104:107]
SA m0,s28,102400
C v82,v88,v89
C v83,v90,v91
M v[104:107],a[120:123],v[224:227],v[104:107]
SA s85,s38,28672
T a[80:81],v20,49152
T a[82:83],v20,51200
M v[104:107],a[124:127],v[240:243],v[104:107]
T a[84:85],v20,53248
T a[86:87],v20,55296
M v[108:111],a[124:127],v[244:247],0
buffer_store_dwordx4 v[80:83], v7, s[8:11], s29 offen offset:1024 sc1
M v[108:111],a[120:123],v[228:231],v[108:111]
s_nop 0
T a[88:89],v20,57344
T a[90:91],v20,59392
M v[108:111],a[116:119],v[212:215],v[108:111]
T a[92:93],v20,61440
T a[94:95],v20,63488
M v[108:111],a[112:115],v[196:199],v[108:111]
buffer_load_dwordx4 v0, s[12:15], s85 offen offset:0 lds
M v[108:111],a[108:111],v[180:183],v[108:111]
SA s85,s38,34816
MF v84,v6,v84
MF v85,v6,v85
M v[108:111],a[104:107],v[164:167],v[108:111]
MF v86,v6,v86
MF v87,v6,v87
M v[108:111],a[100:103],v[148:151],v[108:111]
buffer_load_dwordx4 v0, s[12:15], s85 offen offset:1024 lds
M v[108:111],a[96:99],v[132:135],v[108:111]
s_waitcnt lgkmcnt(0)
MF v92,v6,v92
MF v93,v6,v93
M v[112:115],a[64:67],v[128:131],0
T a[96:97],v21,32768
T a[98:99],v21,34816
M v[112:115],a[68:71],v[144:147],v[112:115]
SA s85,s38,40960
T a[100:101],v21,36864
T a[102:103],v21,38912
M v[112:115],a[72:75],v[160:163],v[112:115]
buffer_load_dwordx4 v0, s[12:15], s85 offen offset:2048 lds
M v[112:115],a[76:79],v[176:179],v[112:115]
s_nop 0
T a[104:105],v21,40960
T a[106:107],v21,43008
M v[112:115],a[80:83],v[192:195],v[112:115]
T a[108:109],v21,45056
T a[110:111],v21,47104
M v[112:115],a[84:87],v[208:211],v[112:115]
MF v94,v6,v94
MF v95,v6,v95
M v[112:115],a[88:91],v[224:227],v[112:115]
SA s85,s38,47104
T a[112:113],v21,49152
T a[114:115],v21,51200
M v[112:115],a[92:95],v[240:243],v[112:115]
T a[116:117],v21,53248
T a[118:119],v21,55296
M v[116:119],a[92:95],v[244:247],0
buffer_load_dwordx4 v0, s[12:15], s85 offen offset:3072 lds
M v[116:119],a[88:91],v[228:231],v[116:119]
s_nop 0
T a[120:121],v21,57344
T a[122:123],v21,59392
M v[116:119],a[84:87],v[212:215],v[116:119]
T a[124:125],v21,61440
T a[126:127],v21,63488
M v[116:119],a[80:83],v[196:199],v[116:119]
C v84,v84,v85
C v85,v86,v87
M v[116:119],a[76:79],v[180:183],v[116:119]
C v86,v92,v93
C v87,v94,v95
M v[116:119],a[72:75],v[164:167],v[116:119]
SA s38,s38,128
buffer_store_dwordx4 v[84:87], v7, s[8:11], s30 offen offset:1024 sc1
M v[116:119],a[68:71],v[148:151],v[116:119]
s_waitcnt vmcnt(28) lgkmcnt(0)
M v[116:119],a[64:67],v[132:135],v[116:119]
s_barrier
M v[120:123],a[96:99],v[128:131],0
SA s29,s33,2048
T a[64:65],v22,0
T a[66:67],v22,2048
M v[120:123],a[100:103],v[144:147],v[120:123]
SA s30,s33,16384
T a[68:69],v22,4096
T a[70:71],v22,6144
M v[120:123],a[104:107],v[160:163],v[120:123]
MF v96,v5,v96
MF v97,v5,v97
M v[120:123],a[108:111],v[176:179],v[120:123]
T a[72:73],v22,8192
T a[74:75],v22,10240
M v[120:123],a[112:115],v[192:195],v[120:123]
T a[76:77],v22,12288
T a[78:79],v22,14336
M v[120:123],a[116:119],v[208:211],v[120:123]
MF v98,v5,v98
MF v99,v5,v99
M v[120:123],a[120:123],v[224:227],v[120:123]
T a[80:81],v22,16384
T a[82:83],v22,18432
M v[120:123],a[124:127],v[240:243],v[120:123]
T a[84:85],v22,20480
T a[86:87],v22,22528
M v[124:127],a[124:127],v[244:247],0
MF v104,v5,v104
MF v105,v5,v105
M v[124:127],a[120:123],v[228:231],v[124:127]
T a[88:89],v22,24576
T a[90:91],v22,26624
M v[124:127],a[116:119],v[212:215],v[124:127]
T a[92:93],v22,28672
T a[94:95],v22,30720
M v[124:127],a[112:115],v[196:199],v[124:127]
MF v106,v5,v106
MF v107,v5,v107
M v[124:127],a[108:111],v[180:183],v[124:127]
C v96,v96,v97
C v97,v98,v99
M v[124:127],a[104:107],v[164:167],v[124:127]
C v98,v104,v105
C v99,v106,v107
M v[124:127],a[100:103],v[148:151],v[124:127]
s_waitcnt lgkmcnt(0)
buffer_store_dwordx4 v[96:99], v7, s[8:11], s29 offen offset:0 sc1
M v[124:127],a[96:99],v[132:135],v[124:127]
MF v100,v6,v100
MF v101,v6,v101
MF v102,v6,v102
MF v103,v6,v103
MF v108,v6,v108
MF v109,v6,v109
MF v110,v6,v110
MF v111,v6,v111
C v100,v100,v101
C v101,v102,v103
C v102,v108,v109
C v103,v110,v111
buffer_store_dwordx4 v[100:103], v7, s[8:11], s30 offen offset:0 sc1
M v[64:67],a[64:67],v[128:131],0
s_nop 0
T a[96:97],v23,0
T a[98:99],v23,2048
M v[64:67],a[68:71],v[144:147],v[64:67]
SA m0,s28,32768
T a[100:101],v23,4096
T a[102:103],v23,6144
M v[64:67],a[72:75],v[160:163],v[64:67]
SA s85,s38,0
buffer_load_dwordx4 v0, s[12:15], s85 offen offset:0 lds
M v[64:67],a[76:79],v[176:179],v[64:67]
s_nop 0
T a[104:105],v23,8192
T a[106:107],v23,10240
M v[64:67],a[80:83],v[192:195],v[64:67]
T a[108:109],v23,12288
T a[110:111],v23,14336
M v[64:67],a[84:87],v[208:211],v[64:67]
SA s85,s38,6144
MF v112,v5,v112
MF v113,v5,v113
M v[64:67],a[88:91],v[224:227],v[64:67]
T a[112:113],v23,16384
T a[114:115],v23,18432
M v[64:67],a[92:95],v[240:243],v[64:67]
T a[116:117],v23,20480
T a[118:119],v23,22528
M v[68:71],a[92:95],v[244:247],0
buffer_load_dwordx4 v0, s[12:15], s85 offen offset:1024 lds
M v[68:71],a[88:91],v[228:231],v[68:71]
s_nop 0
T a[120:121],v23,24576
T a[122:123],v23,26624
M v[68:71],a[84:87],v[212:215],v[68:71]
T a[124:125],v23,28672
T a[126:127],v23,30720
M v[68:71],a[80:83],v[196:199],v[68:71]
SA s85,s38,12288
MF v114,v5,v114
MF v115,v5,v115
M v[68:71],a[76:79],v[180:183],v[68:71]
buffer_load_dwordx4 v0, s[12:15], s85 offen offset:2048 lds
M v[68:71],a[72:75],v[164:167],v[68:71]
MF v120,v5,v120
MF v121,v5,v121
M v[68:71],a[68:71],v[148:151],v[68:71]
MF v122,v5,v122
MF v123,v5,v123
M v[68:71],a[64:67],v[132:135],v[68:71]
s_waitcnt lgkmcnt(0)
C v112,v112,v113
C v113,v114,v115
M v[72:75],a[96:99],v[128:131],0
SA s85,s38,18432
T a[64:65],v24,0
T a[66:67],v24,2048
M v[72:75],a[100:103],v[144:147],v[72:75]
T a[68:69],v24,4096
T a[70:71],v24,6144
M v[72:75],a[104:107],v[160:163],v[72:75]
buffer_load_dwordx4 v0, s[12:15], s85 offen offset:3072 lds
M v[72:75],a[108:111],v[176:179],v[72:75]
s_nop 0
T a[72:73],v24,8192
T a[74:75],v24,10240
M v[72:75],a[112:115],v[192:195],v[72:75]
T a[76:77],v24,12288
T a[78:79],v24,14336
M v[72:75],a[116:119],v[208:211],v[72:75]
SA m0,s28,36864
C v114,v120,v121
C v115,v122,v123
M v[72:75],a[120:123],v[224:227],v[72:75]
SA s85,s38,28672
T a[80:81],v24,16384
T a[82:83],v24,18432
M v[72:75],a[124:127],v[240:243],v[72:75]
T a[84:85],v24,20480
T a[86:87],v24,22528
M v[76:79],a[124:127],v[244:247],0
buffer_store_dwordx4 v[112:115], v7, s[8:11], s29 offen offset:1024 sc1
M v[76:79],a[120:123],v[228:231],v[76:79]
s_nop 0
T a[88:89],v24,24576
T a[90:91],v24,26624
M v[76:79],a[116:119],v[212:215],v[76:79]
T a[92:93],v24,28672
T a[94:95],v24,30720
M v[76:79],a[112:115],v[196:199],v[76:79]
buffer_load_dwordx4 v0, s[12:15], s85 offen offset:0 lds
M v[76:79],a[108:111],v[180:183],v[76:79]
SA s85,s38,34816
MF v116,v6,v116
MF v117,v6,v117
M v[76:79],a[104:107],v[164:167],v[76:79]
MF v118,v6,v118
MF v119,v6,v119
M v[76:79],a[100:103],v[148:151],v[76:79]
buffer_load_dwordx4 v0, s[12:15], s85 offen offset:1024 lds
M v[76:79],a[96:99],v[132:135],v[76:79]
s_waitcnt lgkmcnt(0)
MF v124,v6,v124
MF v125,v6,v125
M v[80:83],a[64:67],v[128:131],0
T a[96:97],v25,0
T a[98:99],v25,2048
M v[80:83],a[68:71],v[144:147],v[80:83]
SA s85,s38,40960
T a[100:101],v25,4096
T a[102:103],v25,6144
M v[80:83],a[72:75],v[160:163],v[80:83]
buffer_load_dwordx4 v0, s[12:15], s85 offen offset:2048 lds
M v[80:83],a[76:79],v[176:179],v[80:83]
s_nop 0
T a[104:105],v25,8192
T a[106:107],v25,10240
M v[80:83],a[80:83],v[192:195],v[80:83]
T a[108:109],v25,12288
T a[110:111],v25,14336
M v[80:83],a[84:87],v[208:211],v[80:83]
MF v126,v6,v126
MF v127,v6,v127
M v[80:83],a[88:91],v[224:227],v[80:83]
SA s85,s38,47104
T a[112:113],v25,16384
T a[114:115],v25,18432
M v[80:83],a[92:95],v[240:243],v[80:83]
T a[116:117],v25,20480
T a[118:119],v25,22528
M v[84:87],a[92:95],v[244:247],0
buffer_load_dwordx4 v0, s[12:15], s85 offen offset:3072 lds
M v[84:87],a[88:91],v[228:231],v[84:87]
s_nop 0
T a[120:121],v25,24576
T a[122:123],v25,26624
M v[84:87],a[84:87],v[212:215],v[84:87]
T a[124:125],v25,28672
T a[126:127],v25,30720
M v[84:87],a[80:83],v[196:199],v[84:87]
C v116,v116,v117
C v117,v118,v119
M v[84:87],a[76:79],v[180:183],v[84:87]
C v118,v124,v125
C v119,v126,v127
M v[84:87],a[72:75],v[164:167],v[84:87]
SA s38,s38,128
buffer_store_dwordx4 v[116:119], v7, s[8:11], s30 offen offset:1024 sc1
M v[84:87],a[68:71],v[148:151],v[84:87]
s_waitcnt vmcnt(32) lgkmcnt(0)
M v[84:87],a[64:67],v[132:135],v[84:87]
s_barrier
M v[88:91],a[96:99],v[128:131],0
SA s29,s33,4096
T a[64:65],v18,0
T a[66:67],v18,2048
M v[88:91],a[100:103],v[144:147],v[88:91]
SA s30,s33,18432
T a[68:69],v18,4096
T a[70:71],v18,6144
M v[88:91],a[104:107],v[160:163],v[88:91]
MF v64,v5,v64
MF v65,v5,v65
M v[88:91],a[108:111],v[176:179],v[88:91]
T a[72:73],v18,8192
T a[74:75],v18,10240
M v[88:91],a[112:115],v[192:195],v[88:91]
T a[76:77],v18,12288
T a[78:79],v18,14336
M v[88:91],a[116:119],v[208:211],v[88:91]
MF v66,v5,v66
MF v67,v5,v67
M v[88:91],a[120:123],v[224:227],v[88:91]
T a[80:81],v18,16384
T a[82:83],v18,18432
M v[88:91],a[124:127],v[240:243],v[88:91]
T a[84:85],v18,20480
T a[86:87],v18,22528
M v[92:95],a[124:127],v[244:247],0
MF v72,v5,v72
MF v73,v5,v73
M v[92:95],a[120:123],v[228:231],v[92:95]
T a[88:89],v18,24576
T a[90:91],v18,26624
M v[92:95],a[116:119],v[212:215],v[92:95]
T a[92:93],v18,28672
T a[94:95],v18,30720
M v[92:95],a[112:115],v[196:199],v[92:95]
MF v74,v5,v74
MF v75,v5,v75
M v[92:95],a[108:111],v[180:183],v[92:95]
C v64,v64,v65
C v65,v66,v67
M v[92:95],a[104:107],v[164:167],v[92:95]
C v66,v72,v73
C v67,v74,v75
M v[92:95],a[100:103],v[148:151],v[92:95]
s_waitcnt lgkmcnt(0)
buffer_store_dwordx4 v[64:67], v7, s[8:11], s29 offen offset:0 sc1
M v[92:95],a[96:99],v[132:135],v[92:95]
MF v68,v6,v68
MF v69,v6,v69
MF v70,v6,v70
MF v71,v6,v71
MF v76,v6,v76
MF v77,v6,v77
MF v78,v6,v78
MF v79,v6,v79
C v68,v68,v69
C v69,v70,v71
C v70,v76,v77
C v71,v78,v79
buffer_store_dwordx4 v[68:71], v7, s[8:11], s30 offen offset:0 sc1
M v[96:99],a[64:67],v[128:131],0
s_nop 0
T a[96:97],v19,0
T a[98:99],v19,2048
M v[96:99],a[68:71],v[144:147],v[96:99]
T a[100:101],v19,4096
T a[102:103],v19,6144
M v[96:99],a[72:75],v[160:163],v[96:99]
MF v80,v5,v80
MF v81,v5,v81
M v[96:99],a[76:79],v[176:179],v[96:99]
T a[104:105],v19,8192
T a[106:107],v19,10240
M v[96:99],a[80:83],v[192:195],v[96:99]
T a[108:109],v19,12288
T a[110:111],v19,14336
M v[96:99],a[84:87],v[208:211],v[96:99]
MF v82,v5,v82
MF v83,v5,v83
M v[96:99],a[88:91],v[224:227],v[96:99]
T a[112:113],v19,16384
T a[114:115],v19,18432
M v[96:99],a[92:95],v[240:243],v[96:99]
T a[116:117],v19,20480
T a[118:119],v19,22528
M v[100:103],a[92:95],v[244:247],0
MF v88,v5,v88
MF v89,v5,v89
M v[100:103],a[88:91],v[228:231],v[100:103]
T a[120:121],v19,24576
T a[122:123],v19,26624
M v[100:103],a[84:87],v[212:215],v[100:103]
T a[124:125],v19,28672
T a[126:127],v19,30720
M v[100:103],a[80:83],v[196:199],v[100:103]
MF v90,v5,v90
MF v91,v5,v91
M v[100:103],a[76:79],v[180:183],v[100:103]
C v80,v80,v81
C v81,v82,v83
M v[100:103],a[72:75],v[164:167],v[100:103]
C v82,v88,v89
C v83,v90,v91
M v[100:103],a[68:71],v[148:151],v[100:103]
buffer_store_dwordx4 v[80:83], v7, s[8:11], s29 offen offset:1024 sc1
M v[100:103],a[64:67],v[132:135],v[100:103]
s_waitcnt lgkmcnt(0)
MF v84,v6,v84
MF v85,v6,v85
M v[104:107],a[96:99],v[128:131],0
T a[64:65],v20,0
T a[66:67],v20,2048
M v[104:107],a[100:103],v[144:147],v[104:107]
T a[68:69],v20,4096
T a[70:71],v20,6144
M v[104:107],a[104:107],v[160:163],v[104:107]
MF v86,v6,v86
MF v87,v6,v87
M v[104:107],a[108:111],v[176:179],v[104:107]
T a[72:73],v20,8192
T a[74:75],v20,10240
M v[104:107],a[112:115],v[192:195],v[104:107]
T a[76:77],v20,12288
T a[78:79],v20,14336
M v[104:107],a[116:119],v[208:211],v[104:107]
MF v92,v6,v92
MF v93,v6,v93
M v[104:107],a[120:123],v[224:227],v[104:107]
T a[80:81],v20,16384
T a[82:83],v20,18432
M v[104:107],a[124:127],v[240:243],v[104:107]
T a[84:85],v20,20480
T a[86:87],v20,22528
M v[108:111],a[124:127],v[244:247],0
MF v94,v6,v94
MF v95,v6,v95
M v[108:111],a[120:123],v[228:231],v[108:111]
T a[88:89],v20,24576
T a[90:91],v20,26624
M v[108:111],a[116:119],v[212:215],v[108:111]
T a[92:93],v20,28672
T a[94:95],v20,30720
M v[108:111],a[112:115],v[196:199],v[108:111]
C v84,v84,v85
C v85,v86,v87
M v[108:111],a[108:111],v[180:183],v[108:111]
C v86,v92,v93
C v87,v94,v95
M v[108:111],a[104:107],v[164:167],v[108:111]
buffer_store_dwordx4 v[84:87], v7, s[8:11], s30 offen offset:1024 sc1
M v[108:111],a[100:103],v[148:151],v[108:111]
SA s29,s33,6144
M v[108:111],a[96:99],v[132:135],v[108:111]
s_waitcnt lgkmcnt(0)
M v[112:115],a[64:67],v[128:131],0
SA s30,s33,20480
T a[96:97],v21,0
T a[98:99],v21,2048
M v[112:115],a[68:71],v[144:147],v[112:115]
T a[100:101],v21,4096
T a[102:103],v21,6144
M v[112:115],a[72:75],v[160:163],v[112:115]
MF v96,v5,v96
MF v97,v5,v97
M v[112:115],a[76:79],v[176:179],v[112:115]
T a[104:105],v21,8192
T a[106:107],v21,10240
M v[112:115],a[80:83],v[192:195],v[112:115]
T a[108:109],v21,12288
T a[110:111],v21,14336
M v[112:115],a[84:87],v[208:211],v[112:115]
MF v98,v5,v98
MF v99,v5,v99
M v[112:115],a[88:91],v[224:227],v[112:115]
T a[112:113],v21,16384
T a[114:115],v21,18432
M v[112:115],a[92:95],v[240:243],v[112:115]
T a[116:117],v21,20480
T a[118:119],v21,22528
M v[116:119],a[92:95],v[244:247],0
MF v104,v5,v104
MF v105,v5,v105
M v[116:119],a[88:91],v[228:231],v[116:119]
T a[120:121],v21,24576
T a[122:123],v21,26624
M v[116:119],a[84:87],v[212:215],v[116:119]
T a[124:125],v21,28672
T a[126:127],v21,30720
M v[116:119],a[80:83],v[196:199],v[116:119]
MF v106,v5,v106
MF v107,v5,v107
M v[116:119],a[76:79],v[180:183],v[116:119]
C v96,v96,v97
C v97,v98,v99
M v[116:119],a[72:75],v[164:167],v[116:119]
C v98,v104,v105
C v99,v106,v107
M v[116:119],a[68:71],v[148:151],v[116:119]
s_waitcnt vmcnt(28) lgkmcnt(0)
buffer_store_dwordx4 v[96:99], v7, s[8:11], s29 offen offset:0 sc1
M v[116:119],a[64:67],v[132:135],v[116:119]
s_barrier
M v[120:123],a[96:99],v[128:131],0
s_nop 0
T a[64:65],v40,0
T a[66:67],v40,2048
M v[120:123],a[100:103],v[144:147],v[120:123]
T a[68:69],v40,4096
T a[70:71],v40,6144
M v[120:123],a[104:107],v[160:163],v[120:123]
MF v100,v6,v100
MF v101,v6,v101
M v[120:123],a[108:111],v[176:179],v[120:123]
T a[72:73],v40,8192
T a[74:75],v40,10240
M v[120:123],a[112:115],v[192:195],v[120:123]
T a[76:77],v40,12288
T a[78:79],v40,14336
M v[120:123],a[116:119],v[208:211],v[120:123]
MF v102,v6,v102
MF v103,v6,v103
M v[120:123],a[120:123],v[224:227],v[120:123]
T a[80:81],v40,16384
T a[82:83],v40,18432
M v[120:123],a[124:127],v[240:243],v[120:123]
T a[84:85],v40,20480
T a[86:87],v40,22528
M v[124:127],a[124:127],v[244:247],0
MF v108,v6,v108
MF v109,v6,v109
M v[124:127],a[120:123],v[228:231],v[124:127]
T a[88:89],v40,24576
T a[90:91],v40,26624
M v[124:127],a[116:119],v[212:215],v[124:127]
T a[92:93],v40,28672
T a[94:95],v40,30720
M v[124:127],a[112:115],v[196:199],v[124:127]
MF v110,v6,v110
MF v111,v6,v111
M v[124:127],a[108:111],v[180:183],v[124:127]
C v100,v100,v101
C v101,v102,v103
M v[124:127],a[104:107],v[164:167],v[124:127]
C v102,v108,v109
C v103,v110,v111
M v[124:127],a[100:103],v[148:151],v[124:127]
s_waitcnt lgkmcnt(0)
buffer_store_dwordx4 v[100:103], v7, s[8:11], s30 offen offset:0 sc1
M v[124:127],a[96:99],v[132:135],v[124:127]
M v[64:67],a[64:67],v[128:131],0
s_nop 0
T a[96:97],v41,0
T a[98:99],v41,2048
M v[64:67],a[68:71],v[144:147],v[64:67]
T a[100:101],v41,4096
T a[102:103],v41,6144
M v[64:67],a[72:75],v[160:163],v[64:67]
v_lshrrev_b32 v32, 4, v7
MF v112,v5,v112
M v[64:67],a[76:79],v[176:179],v[64:67]
s_lshr_b32 s74, s41, 3
T a[104:105],v41,8192
T a[106:107],v41,10240
M v[64:67],a[80:83],v[192:195],v[64:67]
s_sub_u32 s64, 15, s42
T a[108:109],v41,12288
T a[110:111],v41,14336
M v[64:67],a[84:87],v[208:211],v[64:67]
s_mul_i32 s46, s64, 8704
MF v113,v5,v113
MF v114,v5,v114
M v[64:67],a[88:91],v[224:227],v[64:67]
s_and_b32 s72, s41, 7
T a[112:113],v41,16384
T a[114:115],v41,18432
M v[64:67],a[92:95],v[240:243],v[64:67]
s_lshl_b32 s65, s72, 7
T a[116:117],v41,20480
T a[118:119],v41,22528
M v[68:71],a[92:95],v[244:247],0
SA s46,s46,s65
MF v115,v5,v115
MF v120,v5,v120
M v[68:71],a[88:91],v[228:231],v[68:71]
SA s46,s46,104993792
T a[120:121],v41,24576
T a[122:123],v41,26624
M v[68:71],a[84:87],v[212:215],v[68:71]
T a[124:125],v41,28672
T a[126:127],v41,30720
M v[68:71],a[80:83],v[196:199],v[68:71]
v_and_b32 v33, 31, v32
MF v121,v5,v121
M v[68:71],a[76:79],v[180:183],v[68:71]
MF v122,v5,v122
MF v123,v5,v123
M v[68:71],a[72:75],v[164:167],v[68:71]
C v112,v112,v113
C v113,v114,v115
M v[68:71],a[68:71],v[148:151],v[68:71]
C v114,v120,v121
C v115,v122,v123
M v[68:71],a[64:67],v[132:135],v[68:71]
s_waitcnt lgkmcnt(0)
buffer_store_dwordx4 v[112:115], v7, s[8:11], s29 offen offset:1024 sc1
M v[72:75],a[96:99],v[128:131],0
s_nop 0
T a[64:65],v42,0
T a[66:67],v42,2048
M v[72:75],a[100:103],v[144:147],v[72:75]
T a[68:69],v42,4096
T a[70:71],v42,6144
M v[72:75],a[104:107],v[160:163],v[72:75]
MF v116,v6,v116
MF v117,v6,v117
M v[72:75],a[108:111],v[176:179],v[72:75]
T a[72:73],v42,8192
T a[74:75],v42,10240
M v[72:75],a[112:115],v[192:195],v[72:75]
T a[76:77],v42,12288
T a[78:79],v42,14336
M v[72:75],a[116:119],v[208:211],v[72:75]
MF v118,v6,v118
MF v119,v6,v119
M v[72:75],a[120:123],v[224:227],v[72:75]
T a[80:81],v42,16384
T a[82:83],v42,18432
M v[72:75],a[124:127],v[240:243],v[72:75]
T a[84:85],v42,20480
T a[86:87],v42,22528
M v[76:79],a[124:127],v[244:247],0
MF v124,v6,v124
MF v125,v6,v125
M v[76:79],a[120:123],v[228:231],v[76:79]
T a[88:89],v42,24576
T a[90:91],v42,26624
M v[76:79],a[116:119],v[212:215],v[76:79]
T a[92:93],v42,28672
T a[94:95],v42,30720
M v[76:79],a[112:115],v[196:199],v[76:79]
MF v126,v6,v126
MF v127,v6,v127
M v[76:79],a[108:111],v[180:183],v[76:79]
C v116,v116,v117
C v117,v118,v119
M v[76:79],a[104:107],v[164:167],v[76:79]
C v118,v124,v125
C v119,v126,v127
M v[76:79],a[100:103],v[148:151],v[76:79]
buffer_store_dwordx4 v[116:119], v7, s[8:11], s30 offen offset:1024 sc1
M v[76:79],a[96:99],v[132:135],v[76:79]
s_waitcnt lgkmcnt(0)
v_lshlrev_b32 v33, 2, v33
M v[80:83],a[64:67],v[128:131],0
SA s29,s33,8192
T a[96:97],v43,0
T a[98:99],v43,2048
M v[80:83],a[68:71],v[144:147],v[80:83]
SA s30,s33,22528
T a[100:101],v43,4096
T a[102:103],v43,6144
M v[80:83],a[72:75],v[160:163],v[80:83]
s_lshl_b32 s65, s41, 7
MF v64,v5,v64
MF v65,v5,v65
M v[80:83],a[76:79],v[176:179],v[80:83]
SA s65,s65,104890368
T a[104:105],v43,8192
T a[106:107],v43,10240
M v[80:83],a[80:83],v[192:195],v[80:83]
T a[108:109],v43,12288
T a[110:111],v43,14336
M v[80:83],a[84:87],v[208:211],v[80:83]
buffer_load_dword v31, v33, s[8:11], s65 offen sc1
M v[80:83],a[88:91],v[224:227],v[80:83]
s_nop 0
T a[112:113],v43,16384
T a[114:115],v43,18432
M v[80:83],a[92:95],v[240:243],v[80:83]
T a[116:117],v43,20480
T a[118:119],v43,22528
M v[84:87],a[92:95],v[244:247],0
s_cmp_ge_u32 s42, 8
v_bfe_u32 v34, v32, 4, 1
v_lshlrev_b32 v34, 1, v34
M v[84:87],a[88:91],v[228:231],v[84:87]
s_cselect_b32 s84, s45, 536870912
T a[120:121],v43,24576
T a[122:123],v43,26624
M v[84:87],a[84:87],v[212:215],v[84:87]
T a[124:125],v43,28672
T a[126:127],v43,30720
M v[84:87],a[80:83],v[196:199],v[84:87]
v_lshrrev_b32 v35, 5, v32
v_add_u32 v34, v34, v35
M v[84:87],a[76:79],v[180:183],v[84:87]
s_mov_b32 s52, s96
MF v66,v5,v66
MF v67,v5,v67
M v[84:87],a[72:75],v[164:167],v[84:87]
s_and_b32 s53, s97, 0xffff
MF v72,v5,v72
MF v73,v5,v73
M v[84:87],a[68:71],v[148:151],v[84:87]
s_waitcnt vmcnt(22) lgkmcnt(0)
MF v74,v5,v74
MF v75,v5,v75
M v[84:87],a[64:67],v[132:135],v[84:87]
s_barrier
M v[88:91],a[96:99],v[128:131],0
s_mov_b32 s54, 1835008
T a[64:65],v22,32768
T a[66:67],v22,34816
M v[88:91],a[100:103],v[144:147],v[88:91]
s_mov_b32 s55, 0x20000
T a[68:69],v22,36864
T a[70:71],v22,38912
M v[88:91],a[104:107],v[160:163],v[88:91]
s_mul_i32 s77, s42, 1835008
C v64,v64,v65
C v65,v66,v67
M v[88:91],a[108:111],v[176:179],v[88:91]
s_mul_i32 s78, s72, 14336
T a[72:73],v22,40960
T a[74:75],v22,43008
M v[88:91],a[112:115],v[192:195],v[88:91]
SA s77,s77,s78
T a[76:77],v22,45056
T a[78:79],v22,47104
M v[88:91],a[116:119],v[208:211],v[88:91]
SA s77,s77,67108864
C v66,v72,v73
C v67,v74,v75
M v[88:91],a[120:123],v[224:227],v[88:91]
s_lshl_b32 s79, s74, 2
T a[80:81],v22,49152
T a[82:83],v22,51200
M v[88:91],a[124:127],v[240:243],v[88:91]
SA s79,s79,s20
T a[84:85],v22,53248
T a[86:87],v22,55296
M v[92:95],a[124:127],v[244:247],0
SA s79,s79,6
buffer_store_dwordx4 v[64:67], v7, s[8:11], s29 offen offset:0 sc1
M v[92:95],a[120:123],v[228:231],v[92:95]
s_sub_u32 s67, 13, s79
T a[88:89],v22,57344
T a[90:91],v22,59392
M v[92:95],a[116:119],v[212:215],v[92:95]
s_and_b32 s67, s67, 536870912
T a[92:93],v22,61440
T a[94:95],v22,63488
M v[92:95],a[112:115],v[196:199],v[92:95]
s_lshl_b32 s78, s79, 10
MF v68,v6,v68
MF v69,v6,v69
M v[92:95],a[108:111],v[180:183],v[92:95]
SA s78,s78,s77
MF v70,v6,v70
MF v71,v6,v71
M v[92:95],a[104:107],v[164:167],v[92:95]
s_lshl_b32 s79, s79, 6
MF v76,v6,v76
MF v77,v6,v77
M v[92:95],a[100:103],v[148:151],v[92:95]
s_waitcnt lgkmcnt(0)
MF v78,v6,v78
MF v79,v6,v79
M v[92:95],a[96:99],v[132:135],v[92:95]
s_or_b32 s79, s79, s67
v_or_b32 v27, s67, v7
s_lshr_b32 s73, s72, 1
s_sub_u32 s65, 7, s73
s_bitcmp1_b32 s72, 0
s_cselect_b32 s73, s65, s73
s_lshl_b32 s73, s73, 4
s_lshl_b32 s65, s42, 7
SA s73,s73,s65
v_and_b32 v29, 15, v32
v_add_u32 v29, s73, v29
s_mov_b32 s64, 104857664
v_mul_u32_u24 v28, 896, v29
v_lshl_add_u32 v28, v34, 4, v28
C v68,v68,v69
C v69,v70,v71
C v70,v76,v77
C v71,v78,v79
buffer_store_dwordx4 v[68:71], v7, s[8:11], s30 offen offset:0 sc1
v_lshrrev_b32 v35, 4, v29
v_lshlrev_b32 v35, 5, v35
v_and_b32 v36, 15, v29
v_add_lshl_u32 v35, v35, v36, 2
buffer_load_dword v26, v35, s[8:11], s64 offen sc1
s_waitcnt vmcnt(8)
buffer_store_dword v15, v17, s[8:11], s84 offen sc1
buffer_load_dwordx4 v[44:47], v28, s[56:59], s79 offen
M v[96:99],a[64:67],v[128:131],0
s_nop 0
T a[96:97],v23,32768
T a[98:99],v23,34816
M v[96:99],a[68:71],v[144:147],v[96:99]
T a[100:101],v23,36864
T a[102:103],v23,38912
M v[96:99],a[72:75],v[160:163],v[96:99]
MF v80,v5,v80
MF v81,v5,v81
M v[96:99],a[76:79],v[176:179],v[96:99]
T a[104:105],v23,40960
T a[106:107],v23,43008
M v[96:99],a[80:83],v[192:195],v[96:99]
T a[108:109],v23,45056
T a[110:111],v23,47104
M v[96:99],a[84:87],v[208:211],v[96:99]
MF v82,v5,v82
MF v83,v5,v83
M v[96:99],a[88:91],v[224:227],v[96:99]
T a[112:113],v23,49152
T a[114:115],v23,51200
M v[96:99],a[92:95],v[240:243],v[96:99]
T a[116:117],v23,53248
T a[118:119],v23,55296
M v[100:103],a[92:95],v[244:247],0
MF v88,v5,v88
MF v89,v5,v89
M v[100:103],a[88:91],v[228:231],v[100:103]
T a[120:121],v23,57344
T a[122:123],v23,59392
M v[100:103],a[84:87],v[212:215],v[100:103]
T a[124:125],v23,61440
T a[126:127],v23,63488
M v[100:103],a[80:83],v[196:199],v[100:103]
MF v90,v5,v90
MF v91,v5,v91
M v[100:103],a[76:79],v[180:183],v[100:103]
C v80,v80,v81
C v81,v82,v83
M v[100:103],a[72:75],v[164:167],v[100:103]
C v82,v88,v89
C v83,v90,v91
M v[100:103],a[68:71],v[148:151],v[100:103]
buffer_store_dwordx4 v[80:83], v7, s[8:11], s29 offen offset:1024 sc1
M v[100:103],a[64:67],v[132:135],v[100:103]
s_waitcnt lgkmcnt(0)
MF v84,v6,v84
MF v85,v6,v85
M v[104:107],a[96:99],v[128:131],0
T a[64:65],v24,32768
T a[66:67],v24,34816
M v[104:107],a[100:103],v[144:147],v[104:107]
T a[68:69],v24,36864
T a[70:71],v24,38912
M v[104:107],a[104:107],v[160:163],v[104:107]
MF v86,v6,v86
MF v87,v6,v87
M v[104:107],a[108:111],v[176:179],v[104:107]
T a[72:73],v24,40960
T a[74:75],v24,43008
M v[104:107],a[112:115],v[192:195],v[104:107]
T a[76:77],v24,45056
T a[78:79],v24,47104
M v[104:107],a[116:119],v[208:211],v[104:107]
MF v92,v6,v92
MF v93,v6,v93
M v[104:107],a[120:123],v[224:227],v[104:107]
T a[80:81],v24,49152
T a[82:83],v24,51200
M v[104:107],a[124:127],v[240:243],v[104:107]
T a[84:85],v24,53248
T a[86:87],v24,55296
M v[108:111],a[124:127],v[244:247],0
MF v94,v6,v94
MF v95,v6,v95
M v[108:111],a[120:123],v[228:231],v[108:111]
T a[88:89],v24,57344
T a[90:91],v24,59392
M v[108:111],a[116:119],v[212:215],v[108:111]
T a[92:93],v24,61440
T a[94:95],v24,63488
M v[108:111],a[112:115],v[196:199],v[108:111]
C v84,v84,v85
C v85,v86,v87
M v[108:111],a[108:111],v[180:183],v[108:111]
C v86,v92,v93
C v87,v94,v95
M v[108:111],a[104:107],v[164:167],v[108:111]
buffer_store_dwordx4 v[84:87], v7, s[8:11], s30 offen offset:1024 sc1
M v[108:111],a[100:103],v[148:151],v[108:111]
SA s29,s33,10240
M v[108:111],a[96:99],v[132:135],v[108:111]
s_waitcnt lgkmcnt(0)
M v[112:115],a[64:67],v[128:131],0
SA s30,s33,24576
T a[96:97],v25,32768
T a[98:99],v25,34816
M v[112:115],a[68:71],v[144:147],v[112:115]
T a[100:101],v25,36864
T a[102:103],v25,38912
M v[112:115],a[72:75],v[160:163],v[112:115]
MF v96,v5,v96
MF v97,v5,v97
M v[112:115],a[76:79],v[176:179],v[112:115]
T a[104:105],v25,40960
T a[106:107],v25,43008
M v[112:115],a[80:83],v[192:195],v[112:115]
T a[108:109],v25,45056
T a[110:111],v25,47104
M v[112:115],a[84:87],v[208:211],v[112:115]
MF v98,v5,v98
MF v99,v5,v99
M v[112:115],a[88:91],v[224:227],v[112:115]
T a[112:113],v25,49152
T a[114:115],v25,51200
M v[112:115],a[92:95],v[240:243],v[112:115]
T a[116:117],v25,53248
T a[118:119],v25,55296
M v[116:119],a[92:95],v[244:247],0
s_cmp_lt_u32 s42, 8
MF v104,v5,v104
MF v105,v5,v105
M v[116:119],a[88:91],v[228:231],v[116:119]
s_cselect_b32 s84, s45, 536870912
T a[120:121],v25,57344
T a[122:123],v25,59392
M v[116:119],a[84:87],v[212:215],v[116:119]
T a[124:125],v25,61440
T a[126:127],v25,63488
M v[116:119],a[80:83],v[196:199],v[116:119]
MF v106,v5,v106
MF v107,v5,v107
M v[116:119],a[76:79],v[180:183],v[116:119]
C v96,v96,v97
C v97,v98,v99
M v[116:119],a[72:75],v[164:167],v[116:119]
C v98,v104,v105
C v99,v106,v107
M v[116:119],a[68:71],v[148:151],v[116:119]
s_waitcnt lgkmcnt(0)
buffer_store_dwordx4 v[96:99], v7, s[8:11], s29 offen offset:0 sc1
M v[116:119],a[64:67],v[132:135],v[116:119]
s_barrier
M v[120:123],a[96:99],v[128:131],0
s_nop 0
T a[64:65],v18,32768
T a[66:67],v18,34816
M v[120:123],a[100:103],v[144:147],v[120:123]
T a[68:69],v18,36864
T a[70:71],v18,38912
M v[120:123],a[104:107],v[160:163],v[120:123]
MF v100,v6,v100
MF v101,v6,v101
M v[120:123],a[108:111],v[176:179],v[120:123]
T a[72:73],v18,40960
T a[74:75],v18,43008
M v[120:123],a[112:115],v[192:195],v[120:123]
s_waitcnt vmcnt(9)
T a[76:77],v18,45056
T a[78:79],v18,47104
M v[120:123],a[116:119],v[208:211],v[120:123]
buffer_store_dword v15, v17, s[8:11], s84 offen sc1
M v[120:123],a[120:123],v[224:227],v[120:123]
s_nop 0
T a[80:81],v18,49152
T a[82:83],v18,51200
M v[120:123],a[124:127],v[240:243],v[120:123]
T a[84:85],v18,53248
T a[86:87],v18,55296
M v[124:127],a[124:127],v[244:247],0
MF v102,v6,v102
MF v103,v6,v103
M v[124:127],a[120:123],v[228:231],v[124:127]
T a[88:89],v18,57344
T a[90:91],v18,59392
M v[124:127],a[116:119],v[212:215],v[124:127]
T a[92:93],v18,61440
T a[94:95],v18,63488
M v[124:127],a[112:115],v[196:199],v[124:127]
MF v108,v6,v108
MF v109,v6,v109
M v[124:127],a[108:111],v[180:183],v[124:127]
MF v110,v6,v110
MF v111,v6,v111
M v[124:127],a[104:107],v[164:167],v[124:127]
C v100,v100,v101
C v101,v102,v103
M v[124:127],a[100:103],v[148:151],v[124:127]
s_waitcnt lgkmcnt(0)
C v102,v108,v109
C v103,v110,v111
M v[124:127],a[96:99],v[132:135],v[124:127]
buffer_store_dwordx4 v[100:103], v7, s[8:11], s30 offen offset:0 sc1
M v[64:67],a[64:67],v[128:131],0
s_nop 0
T a[96:97],v19,32768
T a[98:99],v19,34816
M v[64:67],a[68:71],v[144:147],v[64:67]
T a[100:101],v19,36864
T a[102:103],v19,38912
M v[64:67],a[72:75],v[160:163],v[64:67]
MF v112,v5,v112
MF v113,v5,v113
M v[64:67],a[76:79],v[176:179],v[64:67]
T a[104:105],v19,40960
T a[106:107],v19,43008
M v[64:67],a[80:83],v[192:195],v[64:67]
T a[108:109],v19,45056
T a[110:111],v19,47104
M v[64:67],a[84:87],v[208:211],v[64:67]
MF v114,v5,v114
MF v115,v5,v115
M v[64:67],a[88:91],v[224:227],v[64:67]
T a[112:113],v19,49152
T a[114:115],v19,51200
M v[64:67],a[92:95],v[240:243],v[64:67]
T a[116:117],v19,53248
T a[118:119],v19,55296
M v[68:71],a[92:95],v[244:247],0
MF v120,v5,v120
MF v121,v5,v121
M v[68:71],a[88:91],v[228:231],v[68:71]
T a[120:121],v19,57344
T a[122:123],v19,59392
M v[68:71],a[84:87],v[212:215],v[68:71]
T a[124:125],v19,61440
T a[126:127],v19,63488
M v[68:71],a[80:83],v[196:199],v[68:71]
MF v122,v5,v122
MF v123,v5,v123
M v[68:71],a[76:79],v[180:183],v[68:71]
C v112,v112,v113
C v113,v114,v115
M v[68:71],a[72:75],v[164:167],v[68:71]
C v114,v120,v121
C v115,v122,v123
M v[68:71],a[68:71],v[148:151],v[68:71]
buffer_store_dwordx4 v[112:115], v7, s[8:11], s29 offen offset:1024 sc1
M v[68:71],a[64:67],v[132:135],v[68:71]
s_waitcnt lgkmcnt(0)
MF v116,v6,v116
MF v117,v6,v117
M v[72:75],a[96:99],v[128:131],0
T a[64:65],v20,32768
T a[66:67],v20,34816
M v[72:75],a[100:103],v[144:147],v[72:75]
T a[68:69],v20,36864
T a[70:71],v20,38912
M v[72:75],a[104:107],v[160:163],v[72:75]
MF v118,v6,v118
MF v119,v6,v119
M v[72:75],a[108:111],v[176:179],v[72:75]
T a[72:73],v20,40960
T a[74:75],v20,43008
M v[72:75],a[112:115],v[192:195],v[72:75]
T a[76:77],v20,45056
T a[78:79],v20,47104
M v[72:75],a[116:119],v[208:211],v[72:75]
MF v124,v6,v124
MF v125,v6,v125
M v[72:75],a[120:123],v[224:227],v[72:75]
T a[80:81],v20,49152
T a[82:83],v20,51200
M v[72:75],a[124:127],v[240:243],v[72:75]
T a[84:85],v20,53248
T a[86:87],v20,55296
M v[76:79],a[124:127],v[244:247],0
MF v126,v6,v126
MF v127,v6,v127
M v[76:79],a[120:123],v[228:231],v[76:79]
T a[88:89],v20,57344
T a[90:91],v20,59392
M v[76:79],a[116:119],v[212:215],v[76:79]
T a[92:93],v20,61440
T a[94:95],v20,63488
M v[76:79],a[112:115],v[196:199],v[76:79]
C v116,v116,v117
C v117,v118,v119
M v[76:79],a[108:111],v[180:183],v[76:79]
C v118,v124,v125
C v119,v126,v127
M v[76:79],a[104:107],v[164:167],v[76:79]
buffer_store_dwordx4 v[116:119], v7, s[8:11], s30 offen offset:1024 sc1
M v[76:79],a[100:103],v[148:151],v[76:79]
SA s29,s33,12288
s_waitcnt vmcnt(12)
v_readlane_b32 s92, v31, 0
v_readlane_b32 s94, v31, 1
M v[76:79],a[96:99],v[132:135],v[76:79]
s_waitcnt lgkmcnt(0)
s_waitcnt vmcnt(9)
v_sub_f32 v30, 1.0, v26
s_waitcnt vmcnt(7)
v_lshlrev_b32 v48, 16, v44
M v[80:83],a[64:67],v[128:131],0
SA s30,s33,26624
T a[96:97],v21,32768
T a[98:99],v21,34816
M v[80:83],a[68:71],v[144:147],v[80:83]
T a[100:101],v21,36864
T a[102:103],v21,38912
M v[80:83],a[72:75],v[160:163],v[80:83]
v_and_b32 v49, 0xffff0000, v44
v_lshlrev_b32 v50, 16, v45
M v[80:83],a[76:79],v[176:179],v[80:83]
T a[104:105],v21,40960
T a[106:107],v21,43008
M v[80:83],a[80:83],v[192:195],v[80:83]
T a[108:109],v21,45056
T a[110:111],v21,47104
M v[80:83],a[84:87],v[208:211],v[80:83]
MF v64,v5,v64
MF v65,v5,v65
M v[80:83],a[88:91],v[224:227],v[80:83]
T a[112:113],v21,49152
T a[114:115],v21,51200
M v[80:83],a[92:95],v[240:243],v[80:83]
T a[116:117],v21,53248
T a[118:119],v21,55296
M v[84:87],a[92:95],v[244:247],0
MF v66,v5,v66
MF v67,v5,v67
M v[84:87],a[88:91],v[228:231],v[84:87]
T a[120:121],v21,57344
T a[122:123],v21,59392
M v[84:87],a[84:87],v[212:215],v[84:87]
T a[124:125],v21,61440
T a[126:127],v21,63488
M v[84:87],a[80:83],v[196:199],v[84:87]
MF v72,v5,v72
MF v73,v5,v73
M v[84:87],a[76:79],v[180:183],v[84:87]
MF v74,v5,v74
MF v75,v5,v75
M v[84:87],a[72:75],v[164:167],v[84:87]
C v64,v64,v65
C v65,v66,v67
M v[84:87],a[68:71],v[148:151],v[84:87]
C v66,v72,v73
C v67,v74,v75
M v[84:87],a[64:67],v[132:135],v[84:87]
s_waitcnt lgkmcnt(0)
buffer_store_dwordx4 v[64:67], v7, s[8:11], s29 offen offset:0 sc1
M v[88:91],a[96:99],v[128:131],0
v_and_b32 v51, 0xffff0000, v45
v_lshlrev_b32 v52, 16, v46
M v[88:91],a[100:103],v[144:147],v[88:91]
MF v68,v6,v68
MF v69,v6,v69
M v[88:91],a[104:107],v[160:163],v[88:91]
MF v70,v6,v70
MF v71,v6,v71
M v[88:91],a[108:111],v[176:179],v[88:91]
MF v76,v6,v76
MF v77,v6,v77
M v[88:91],a[112:115],v[192:195],v[88:91]
MF v78,v6,v78
MF v79,v6,v79
M v[88:91],a[116:119],v[208:211],v[88:91]
C v68,v68,v69
C v69,v70,v71
M v[88:91],a[120:123],v[224:227],v[88:91]
C v70,v76,v77
C v71,v78,v79
M v[88:91],a[124:127],v[240:243],v[88:91]
buffer_store_dwordx4 v[68:71], v7, s[8:11], s30 offen offset:0 sc1
M v[92:95],a[124:127],v[244:247],0
v_and_b32 v53, 0xffff0000, v46
v_lshlrev_b32 v54, 16, v47
M v[92:95],a[120:123],v[228:231],v[92:95]
v_and_b32 v55, 0xffff0000, v47
v_cmp_eq_u32 s[80:81], s92, v29
M v[92:95],a[116:119],v[212:215],v[92:95]
v_cmp_eq_u32 s[82:83], s94, v29
M v[92:95],a[112:115],v[196:199],v[92:95]
MF v80,v5,v80
MF v81,v5,v81
M v[92:95],a[108:111],v[180:183],v[92:95]
MF v82,v5,v82
MF v83,v5,v83
M v[92:95],a[104:107],v[164:167],v[92:95]
MF v88,v5,v88
MF v89,v5,v89
M v[92:95],a[100:103],v[148:151],v[92:95]
MF v90,v5,v90
MF v91,v5,v91
M v[92:95],a[96:99],v[132:135],v[92:95]
C v80,v80,v81
C v81,v82,v83
C v82,v88,v89
C v83,v90,v91
buffer_store_dwordx4 v[80:83], v7, s[8:11], s29 offen offset:1024 sc1
MF v84,v6,v84
MF v85,v6,v85
MF v86,v6,v86
MF v87,v6,v87
MF v92,v6,v92
MF v93,v6,v93
MF v94,v6,v94
MF v95,v6,v95
C v84,v84,v85
C v85,v86,v87
C v86,v92,v93
C v87,v94,v95
buffer_store_dwordx4 v[84:87], v7, s[8:11], s30 offen offset:1024 sc1
buffer_load_dword v9, v33, s[8:11], s46 offen sc1
s_waitcnt vmcnt(1)
buffer_store_dword v15, v16, s[8:11], s3 offen sc1
s_cmp_lt_u32 s42, 8
s_cbranch_scc1 L_red
s_waitcnt vmcnt(1)
v_cmp_eq_u32 vcc, 1, v9
s_mov_b32 s91, 65536
s_lshl_b32 s70, 1, s41
s_mov_b32 s69, 0xffff
s_or_b32 s70, s70, vcc_lo
s_mov_b32 s68, s70
s_barrier
s_cmp_lg_u32 s70, 0
s_cbranch_scc1 L_vk0
s_call_b64 s[36:37], L_rpoll
L_vk0:
s_ff1_i32_b32 s71, s70
s_bitset0_b32 s70, s71
s_mul_i32 s71, s71, 114688
SA s16,s71,s78
buffer_load_dwordx4 v[128:131], v27, s[8:11], s16 offen sc1
s_cmp_lg_u32 s70, 0
s_cbranch_scc1 L_vk1
s_call_b64 s[36:37], L_rpoll
L_vk1:
s_ff1_i32_b32 s71, s70
s_bitset0_b32 s70, s71
s_mul_i32 s71, s71, 114688
SA s17,s71,s78
buffer_load_dwordx4 v[132:135], v27, s[8:11], s17 offen sc1
s_cmp_lg_u32 s70, 0
s_cbranch_scc1 L_vk2
s_call_b64 s[36:37], L_rpoll
L_vk2:
s_ff1_i32_b32 s71, s70
s_bitset0_b32 s70, s71
s_mul_i32 s71, s71, 114688
SA s18,s71,s78
buffer_load_dwordx4 v[136:139], v27, s[8:11], s18 offen sc1
s_cmp_lg_u32 s70, 0
s_cbranch_scc1 L_vk3
s_call_b64 s[36:37], L_rpoll
L_vk3:
s_ff1_i32_b32 s71, s70
s_bitset0_b32 s70, s71
s_mul_i32 s71, s71, 114688
SA s19,s71,s78
buffer_load_dwordx4 v[140:143], v27, s[8:11], s19 offen sc1
s_cmp_lg_u32 s70, 0
s_cbranch_scc1 L_vk4
s_call_b64 s[36:37], L_rpoll
L_vk4:
s_ff1_i32_b32 s71, s70
s_bitset0_b32 s70, s71
s_mul_i32 s71, s71, 114688
SA s48,s71,s78
buffer_load_dwordx4 v[144:147], v27, s[8:11], s48 offen sc1
s_cmp_lg_u32 s70, 0
s_cbranch_scc1 L_vk5
s_call_b64 s[36:37], L_rpoll
L_vk5:
s_ff1_i32_b32 s71, s70
s_bitset0_b32 s70, s71
s_mul_i32 s71, s71, 114688
SA s49,s71,s78
buffer_load_dwordx4 v[148:151], v27, s[8:11], s49 offen sc1
s_cmp_lg_u32 s70, 0
s_cbranch_scc1 L_vk6
s_call_b64 s[36:37], L_rpoll
L_vk6:
s_ff1_i32_b32 s71, s70
s_bitset0_b32 s70, s71
s_mul_i32 s71, s71, 114688
SA s50,s71,s78
buffer_load_dwordx4 v[152:155], v27, s[8:11], s50 offen sc1
s_cmp_lg_u32 s70, 0
s_cbranch_scc1 L_vk7
s_call_b64 s[36:37], L_rpoll
L_vk7:
s_ff1_i32_b32 s71, s70
s_bitset0_b32 s70, s71
s_mul_i32 s71, s71, 114688
SA s51,s71,s78
buffer_load_dwordx4 v[156:159], v27, s[8:11], s51 offen sc1
s_or_b64 vcc, s[80:81], s[82:83]
s_cbranch_vccnz L_moe2
L_moe_ret2:
MF v48,v30,v48
MF v49,v30,v49
MF v50,v30,v50
MF v51,v30,v51
MF v52,v30,v52
MF v53,v30,v53
MF v54,v30,v54
MF v55,v30,v55
s_cmp_lg_u32 s70, 0
s_cbranch_scc1 L_vk8
s_call_b64 s[36:37], L_rpoll
L_vk8:
s_ff1_i32_b32 s71, s70
s_bitset0_b32 s70, s71
s_mul_i32 s71, s71, 114688
SA s21,s71,s78
buffer_load_dwordx4 v[160:163], v27, s[8:11], s21 offen sc1
s_waitcnt vmcnt(8)
M v[56:59],a[246:249],v[128:131],0
M v[60:63],a[244:247],v[128:131],0
s_cmp_lg_u32 s70, 0
s_cbranch_scc1 L_vk9
s_call_b64 s[36:37], L_rpoll
L_vk9:
s_ff1_i32_b32 s71, s70
s_bitset0_b32 s70, s71
s_mul_i32 s71, s71, 114688
SA s22,s71,s78
buffer_load_dwordx4 v[164:167], v27, s[8:11], s22 offen sc1
s_waitcnt vmcnt(8)
M v[56:59],a[246:249],v[132:135],v[56:59]
M v[60:63],a[244:247],v[132:135],v[60:63]
s_cmp_lg_u32 s70, 0
s_cbranch_scc1 L_vk10
s_call_b64 s[36:37], L_rpoll
L_vk10:
s_ff1_i32_b32 s71, s70
s_bitset0_b32 s70, s71
s_mul_i32 s71, s71, 114688
SA s23,s71,s78
buffer_load_dwordx4 v[168:171], v27, s[8:11], s23 offen sc1
s_waitcnt vmcnt(8)
M v[56:59],a[246:249],v[136:139],v[56:59]
M v[60:63],a[244:247],v[136:139],v[60:63]
s_cmp_lg_u32 s70, 0
s_cbranch_scc1 L_vk11
s_call_b64 s[36:37], L_rpoll
L_vk11:
s_ff1_i32_b32 s71, s70
s_bitset0_b32 s70, s71
s_mul_i32 s71, s71, 114688
SA s24,s71,s78
buffer_load_dwordx4 v[172:175], v27, s[8:11], s24 offen sc1
s_waitcnt vmcnt(8)
M v[56:59],a[246:249],v[140:143],v[56:59]
M v[60:63],a[244:247],v[140:143],v[60:63]
s_cmp_lg_u32 s70, 0
s_cbranch_scc1 L_vk12
s_call_b64 s[36:37], L_rpoll
L_vk12:
s_ff1_i32_b32 s71, s70
s_bitset0_b32 s70, s71
s_mul_i32 s71, s71, 114688
SA s25,s71,s78
buffer_load_dwordx4 v[176:179], v27, s[8:11], s25 offen sc1
s_waitcnt vmcnt(8)
M v[56:59],a[246:249],v[144:147],v[56:59]
M v[60:63],a[244:247],v[144:147],v[60:63]
s_cmp_lg_u32 s70, 0
s_cbranch_scc1 L_vk13
s_call_b64 s[36:37], L_rpoll
L_vk13:
s_ff1_i32_b32 s71, s70
s_bitset0_b32 s70, s71
s_mul_i32 s71, s71, 114688
SA s26,s71,s78
buffer_load_dwordx4 v[180:183], v27, s[8:11], s26 offen sc1
s_waitcnt vmcnt(8)
M v[56:59],a[246:249],v[148:151],v[56:59]
M v[60:63],a[244:247],v[148:151],v[60:63]
s_cmp_lg_u32 s70, 0
s_cbranch_scc1 L_vk14
s_call_b64 s[36:37], L_rpoll
L_vk14:
s_ff1_i32_b32 s71, s70
s_bitset0_b32 s70, s71
s_mul_i32 s71, s71, 114688
SA s27,s71,s78
buffer_load_dwordx4 v[184:187], v27, s[8:11], s27 offen sc1
s_waitcnt vmcnt(8)
M v[56:59],a[246:249],v[152:155],v[56:59]
M v[60:63],a[244:247],v[152:155],v[60:63]
s_cmp_lg_u32 s70, 0
s_cbranch_scc1 L_vk15
s_call_b64 s[36:37], L_rpoll
L_vk15:
s_ff1_i32_b32 s71, s70
s_bitset0_b32 s70, s71
s_mul_i32 s71, s71, 114688
SA s28,s71,s78
buffer_load_dwordx4 v[188:191], v27, s[8:11], s28 offen sc1
s_waitcnt vmcnt(8)
M v[56:59],a[246:249],v[156:159],v[56:59]
M v[60:63],a[244:247],v[156:159],v[60:63]
s_waitcnt vmcnt(7)
M v[56:59],a[246:249],v[160:163],v[56:59]
M v[60:63],a[244:247],v[160:163],v[60:63]
s_waitcnt vmcnt(6)
M v[56:59],a[246:249],v[164:167],v[56:59]
M v[60:63],a[244:247],v[164:167],v[60:63]
s_waitcnt vmcnt(5)
M v[56:59],a[246:249],v[168:171],v[56:59]
M v[60:63],a[244:247],v[168:171],v[60:63]
s_waitcnt vmcnt(4)
M v[56:59],a[246:249],v[172:175],v[56:59]
M v[60:63],a[244:247],v[172:175],v[60:63]
s_waitcnt vmcnt(3)
M v[56:59],a[246:249],v[176:179],v[56:59]
M v[60:63],a[244:247],v[176:179],v[60:63]
s_waitcnt vmcnt(2)
M v[56:59],a[246:249],v[180:183],v[56:59]
M v[60:63],a[244:247],v[180:183],v[60:63]
s_waitcnt vmcnt(1)
M v[56:59],a[246:249],v[184:187],v[56:59]
M v[60:63],a[244:247],v[184:187],v[60:63]
s_waitcnt vmcnt(0)
M v[56:59],a[246:249],v[188:191],v[56:59]
M v[60:63],a[244:247],v[188:191],v[60:63]
s_nop 7
v_permlane16_swap_b32 v56, v60
v_permlane16_swap_b32 v57, v61
v_permlane16_swap_b32 v58, v62
v_permlane16_swap_b32 v59, v63
v_fmac_f32 v48, v26, v56
v_fmac_f32 v49, v26, v57
v_fmac_f32 v50, v26, v58
v_fmac_f32 v51, v26, v59
v_fmac_f32 v52, v26, v60
v_fmac_f32 v53, v26, v61
v_fmac_f32 v54, v26, v62
v_fmac_f32 v55, v26, v63
C v44,v48,v49
C v45,v50,v51
C v46,v52,v53
C v47,v54,v55
buffer_store_dwordx4 v[44:47], v28, s[52:55], s79 offen sc1
s_endpgm
L_d2h:
M v[128:131],a[64:67],v[48:51],v[128:131]
R a[96:99],v7,40960
R a[100:103],v7,41984
M v[128:131],a[68:71],v[56:59],v[128:131]
SA m0,s28,135168
E v18,v64
M v[132:135],a[68:71],v[60:63],v[132:135]
buffer_load_dwordx4 v4, s[8:11], s26 offen offset:0 sc1 lds
M v[132:135],a[64:67],v[52:55],v[132:135]
R a[104:107],v7,43008
R a[108:111],v7,44032
M v[140:143],a[72:75],v[52:55],v[140:143]
s_cmp_gt_u32 s20, 3
E v19,v65
M v[140:143],a[76:79],v[60:63],v[140:143]
s_cselect_b64 s[82:83], -1, 0
AF v30,v28,v30
AF v31,v29,v31
M v[136:139],a[76:79],v[56:59],v[136:139]
s_cmp_eq_u32 s20, 3
R a[112:115],v7,45056
R a[116:119],v7,46080
M v[136:139],a[72:75],v[48:51],v[136:139]
s_cselect_b64 s[66:67], s[16:17], s[82:83]
buffer_load_dwordx4 v4, s[8:11], s26 offen offset:1024 sc1 lds
M v[144:147],a[80:83],v[48:51],v[144:147]
s_cselect_b64 s[68:69], s[18:19], s[82:83]
E v20,v66
M v[144:147],a[84:87],v[56:59],v[144:147]
s_cselect_b64 s[70:71], s[48:49], s[82:83]
R a[120:123],v7,47104
R a[124:127],v7,48128
M v[148:151],a[84:87],v[60:63],v[148:151]
s_cselect_b64 s[72:73], s[50:51], s[82:83]
v_cndmask_b32 v100, v36, v8, s[66:67]
v_cndmask_b32 v101, v36, v8, s[68:69]
M v[148:151],a[80:83],v[52:55],v[148:151]
buffer_load_dwordx4 v4, s[8:11], s26 offen offset:2048 sc1 lds
M v[156:159],a[88:91],v[52:55],v[156:159]
v_cndmask_b32 v102, v36, v8, s[70:71]
AF v26,v18,v19
M v[156:159],a[92:95],v[60:63],v[156:159]
E v21,v67
M v[152:155],a[92:95],v[56:59],v[152:155]
v_cndmask_b32 v103, v36, v8, s[72:73]
C v40,v18,v19
M v[152:155],a[88:91],v[48:51],v[152:155]
s_waitcnt lgkmcnt(0)
buffer_load_dwordx4 v4, s[8:11], s26 offen offset:3072 sc1 lds
M v[160:163],a[96:99],v[48:51],v[160:163]
s_cmp_gt_u32 s20, 2
R a[64:67],v7,49152
R a[68:71],v7,50176
M v[160:163],a[100:103],v[56:59],v[160:163]
s_cselect_b64 s[82:83], -1, 0
E v22,v72
M v[164:167],a[100:103],v[60:63],v[164:167]
s_cmp_eq_u32 s20, 2
AF v26,v20,v26
C v41,v20,v21
M v[164:167],a[96:99],v[52:55],v[164:167]
s_mul_i32 s21, s41, 1048576
R a[72:75],v7,51200
R a[76:79],v7,52224
M v[172:175],a[104:107],v[52:55],v[172:175]
s_cselect_b64 s[74:75], s[16:17], s[82:83]
E v23,v73
M v[172:175],a[108:111],v[60:63],v[172:175]
s_cselect_b64 s[76:77], s[18:19], s[82:83]
AF v26,v21,v26
AF v26,v22,v26
M v[168:171],a[108:111],v[56:59],v[168:171]
s_cselect_b64 s[78:79], s[48:49], s[82:83]
R a[80:83],v7,53248
R a[84:87],v7,54272
M v[168:171],a[104:107],v[48:51],v[168:171]
s_cselect_b64 s[80:81], s[50:51], s[82:83]
v_cndmask_b32 v108, v36, v8, s[74:75]
v_cndmask_b32 v109, v36, v8, s[76:77]
M v[176:179],a[112:115],v[48:51],v[176:179]
SA s21,s21,589824
E v24,v74
M v[176:179],a[116:119],v[56:59],v[176:179]
s_lshl_b32 s84, s42, 1
R a[88:91],v7,55296
R a[92:95],v7,56320
M v[180:183],a[116:119],v[60:63],v[180:183]
s_sub_u32 s22, 11, s84
v_cndmask_b32 v110, v36, v8, s[78:79]
C v42,v22,v23
M v[180:183],a[112:115],v[52:55],v[180:183]
s_mov_b32 s23, 536870912
s_waitcnt vmcnt(16)
v_cmp_gt_u32 vcc, 2, v5
AF v26,v23,v26
M v[188:191],a[120:123],v[52:55],v[188:191]
s_cbranch_vccnz L_lsh2
L_lrh2:
v_cndmask_b32 v111, v36, v8, s[80:81]
M v[188:191],a[124:127],v[60:63],v[188:191]
SA m0,s28,98304
E v25,v75
M v[184:187],a[124:127],v[56:59],v[184:187]
s_cmp_gt_u32 s20, 1
buffer_load_dwordx4 v3, s[8:11], s21 offen offset:0 sc1 lds
M v[184:187],a[120:123],v[48:51],v[184:187]
s_waitcnt lgkmcnt(0)
E v18,v68
M v[192:195],a[64:67],v[48:51],v[192:195]
s_cselect_b64 s[82:83], -1, 0
R a[96:99],v7,57344
R a[100:103],v7,58368
M v[192:195],a[68:71],v[56:59],v[192:195]
s_cmp_eq_u32 s20, 1
buffer_load_dwordx4 v3, s[8:11], s21 offen offset:1024 sc1 lds
M v[196:199],a[68:71],v[60:63],v[196:199]
s_cselect_b64 s[66:67], s[16:17], s[82:83]
E v19,v69
M v[196:199],a[64:67],v[52:55],v[196:199]
s_cselect_b64 s[68:69], s[18:19], s[82:83]
R a[104:107],v7,59392
R a[108:111],v7,60416
M v[204:207],a[72:75],v[52:55],v[204:207]
s_cselect_b64 s[70:71], s[48:49], s[82:83]
buffer_load_dwordx4 v3, s[8:11], s21 offen offset:2048 sc1 lds
M v[204:207],a[76:79],v[60:63],v[204:207]
s_cselect_b64 s[72:73], s[50:51], s[82:83]
v_cndmask_b32 v116, v36, v8, s[66:67]
v_cndmask_b32 v117, v36, v8, s[68:69]
M v[200:203],a[76:79],v[56:59],v[200:203]
R a[112:115],v7,61440
R a[116:119],v7,62464
M v[200:203],a[72:75],v[48:51],v[200:203]
v_cndmask_b32 v118, v36, v8, s[70:71]
AF v26,v24,v26
M v[208:211],a[80:83],v[48:51],v[208:211]
buffer_load_dwordx4 v3, s[8:11], s21 offen offset:3072 sc1 lds
M v[208:211],a[84:87],v[56:59],v[208:211]
SA m0,s28,102400
R a[120:123],v7,63488
R a[124:127],v7,64512
M v[212:215],a[84:87],v[60:63],v[212:215]
v_cndmask_b32 v119, v36, v8, s[72:73]
C v43,v24,v25
M v[212:215],a[80:83],v[52:55],v[212:215]
s_cmp_gt_u32 s20, 0
E v20,v70
M v[220:223],a[88:91],v[52:55],v[220:223]
s_cselect_b64 s[82:83], -1, 0
buffer_load_dwordx4 v4, s[8:11], s21 offen offset:0 sc1 lds
M v[220:223],a[92:95],v[60:63],v[220:223]
s_cmp_eq_u32 s20, 0
E v21,v71
M v[216:219],a[92:95],v[56:59],v[216:219]
s_waitcnt lgkmcnt(0)
E v22,v76
M v[216:219],a[88:91],v[48:51],v[216:219]
s_barrier
M v[224:227],a[96:99],v[48:51],v[224:227]
s_cselect_b64 s[74:75], s[16:17], s[82:83]
R a[64:67],v2,0
R a[68:71],v2,1024
M v[224:227],a[100:103],v[56:59],v[224:227]
s_cselect_b64 s[76:77], s[18:19], s[82:83]
buffer_load_dwordx4 v4, s[8:11], s21 offen offset:1024 sc1 lds
M v[228:231],a[100:103],v[60:63],v[228:231]
s_cselect_b64 s[78:79], s[48:49], s[82:83]
E v23,v77
M v[228:231],a[96:99],v[52:55],v[228:231]
s_cselect_b64 s[80:81], s[50:51], s[82:83]
R a[72:75],v2,2048
R a[76:79],v2,3072
M v[236:239],a[104:107],v[52:55],v[236:239]
v_cndmask_b32 v124, v36, v8, s[74:75]
v_cndmask_b32 v125, v36, v8, s[76:77]
M v[236:239],a[108:111],v[60:63],v[236:239]
buffer_load_dwordx4 v4, s[8:11], s21 offen offset:2048 sc1 lds
M v[232:235],a[108:111],v[56:59],v[232:235]
R a[80:83],v2,4096
R a[84:87],v2,5120
M v[232:235],a[104:107],v[48:51],v[232:235]
v_cndmask_b32 v126, v36, v8, s[78:79]
AF v26,v25,v26
M v[240:243],a[112:115],v[48:51],v[240:243]
v_cndmask_b32 v127, v36, v8, s[80:81]
AF v27,v18,v19
M v[240:243],a[116:119],v[56:59],v[240:243]
R a[88:91],v2,6144
R a[92:95],v2,7168
M v[244:247],a[116:119],v[60:63],v[244:247]
buffer_load_dwordx4 v4, s[8:11], s21 offen offset:3072 sc1 lds
M v[244:247],a[112:115],v[52:55],v[244:247]
SA s21,s21,32768
E v24,v78
M v[252:255],a[120:123],v[52:55],v[252:255]
s_sub_u32 s22, s22, 1
E v25,v79
M v[252:255],a[124:127],v[60:63],v[252:255]
s_cselect_b32 s21, s23, s21
C v44,v18,v19
AF v27,v20,v27
M v[248:251],a[124:127],v[56:59],v[248:251]
s_waitcnt lgkmcnt(0)
C v45,v20,v21
AF v27,v21,v27
M v[248:251],a[120:123],v[48:51],v[248:251]
AF v27,v22,v27
C v46,v22,v23
AF v27,v23,v27
AF v27,v24,v27
C v47,v24,v25
AF v27,v25,v27
L_d3h:
M v[100:103],a[64:67],a[32:35],v[100:103]
R a[96:99],v2,8192
R a[100:103],v2,9216
M v[100:103],a[68:71],a[36:39],v[100:103]
R a[104:107],v2,10240
R a[108:111],v2,11264
M v[100:103],a[72:75],a[40:43],v[100:103]
R a[112:115],v2,12288
R a[116:119],v2,13312
M v[100:103],a[76:79],a[44:47],v[100:103]
R a[120:123],v2,14336
R a[124:127],v2,15360
M v[100:103],a[80:83],a[48:51],v[100:103]
v_add_u32 v8, 0x20000, v7
M v[100:103],a[84:87],a[52:55],v[100:103]
buffer_load_dword v5, v9, s[8:11], s46 offen sc1
M v[100:103],a[88:91],a[56:59],v[100:103]
buffer_load_dword v6, off, s[8:11], s47 offset:16 sc1
M v[100:103],a[92:95],a[60:63],v[100:103]
s_waitcnt lgkmcnt(0)
E v18,v80
M v[108:111],a[96:99],a[32:35],v[108:111]
R a[64:67],v2,16384
R a[68:71],v2,17408
M v[108:111],a[100:103],a[36:39],v[108:111]
R a[72:75],v2,18432
R a[76:79],v2,19456
M v[108:111],a[104:107],a[40:43],v[108:111]
R a[80:83],v2,20480
R a[84:87],v2,21504
M v[108:111],a[108:111],a[44:47],v[108:111]
R a[88:91],v2,22528
R a[92:95],v2,23552
M v[108:111],a[112:115],a[48:51],v[108:111]
E v19,v81
M v[108:111],a[116:119],a[52:55],v[108:111]
E v20,v82
M v[108:111],a[120:123],a[56:59],v[108:111]
E v21,v83
M v[108:111],a[124:127],a[60:63],v[108:111]
s_waitcnt lgkmcnt(0)
E v22,v88
M v[116:119],a[64:67],a[32:35],v[116:119]
R a[96:99],v2,24576
R a[100:103],v2,25600
M v[116:119],a[68:71],a[36:39],v[116:119]
R a[104:107],v2,26624
R a[108:111],v2,27648
M v[116:119],a[72:75],a[40:43],v[116:119]
R a[112:115],v2,28672
R a[116:119],v2,29696
M v[116:119],a[76:79],a[44:47],v[116:119]
R a[120:123],v2,30720
R a[124:127],v2,31744
M v[116:119],a[80:83],a[48:51],v[116:119]
E v23,v89
M v[116:119],a[84:87],a[52:55],v[116:119]
E v24,v90
M v[116:119],a[88:91],a[56:59],v[116:119]
s_waitcnt vmcnt(18) lgkmcnt(0)
E v25,v91
M v[116:119],a[92:95],a[60:63],v[116:119]
s_barrier
M v[124:127],a[96:99],a[32:35],v[124:127]
R a[64:67],v7,0
R a[68:71],v7,1024
M v[124:127],a[100:103],a[36:39],v[124:127]
R a[72:75],v7,2048
R a[76:79],v7,3072
M v[124:127],a[104:107],a[40:43],v[124:127]
R a[80:83],v7,4096
R a[84:87],v7,5120
M v[124:127],a[108:111],a[44:47],v[124:127]
R a[88:91],v7,6144
R a[92:95],v7,7168
M v[124:127],a[112:115],a[48:51],v[124:127]
AF v26,v18,v26
C v56,v18,v19
M v[124:127],a[116:119],a[52:55],v[124:127]
AF v26,v19,v26
AF v26,v20,v26
M v[124:127],a[120:123],a[56:59],v[124:127]
s_waitcnt lgkmcnt(0)
E v18,v84
M v[124:127],a[124:127],a[60:63],v[124:127]
E v19,v85
C v57,v20,v21
AF v26,v21,v26
AF v26,v22,v26
C v58,v22,v23
AF v26,v23,v26
AF v26,v24,v26
C v59,v24,v25
AF v26,v25,v26
E v20,v86
E v21,v87
AF v27,v18,v27
C v60,v18,v19
AF v27,v19,v27
E v22,v92
E v23,v93
AF v27,v20,v27
C v61,v20,v21
AF v27,v21,v27
E v24,v94
E v25,v95
AF v27,v22,v27
C v62,v22,v23
AF v27,v23,v27
AF v27,v24,v27
C v63,v24,v25
AF v27,v25,v27
v_max_f32 v10, v26, v27
v_cmp_lt_f32 vcc, s31, v10
s_nop 0
s_cbranch_vccnz L_std3h
L_rtd3h:
M v[128:131],a[64:67],v[40:43],v[128:131]
R a[96:99],v7,8192
R a[100:103],v7,9216
M v[128:131],a[68:71],v[56:59],v[128:131]
s_waitcnt vmcnt(0)
v_cmp_ne_u32 vcc, 1, v6
AF v30,v26,v30
M v[132:135],a[68:71],v[60:63],v[132:135]
s_cbranch_vccnz L_fqs
L_fqr:
E v18,v100
M v[132:135],a[64:67],v[44:47],v[132:135]
SA s73,s32,4096
R a[104:107],v7,10240
R a[108:111],v7,11264
M v[140:143],a[72:75],v[44:47],v[140:143]
SA s74,s32,8192
E v19,v101
M v[140:143],a[76:79],v[60:63],v[140:143]
SA s75,s32,12288
buffer_load_dwordx4 a[0:3], v7, s[8:11], s32 offen offset:0 sc1
M v[136:139],a[76:79],v[56:59],v[136:139]
R a[112:115],v7,12288
R a[116:119],v7,13312
M v[136:139],a[72:75],v[40:43],v[136:139]
E v20,v102
M v[144:147],a[80:83],v[40:43],v[144:147]
buffer_load_dwordx4 a[4:7], v7, s[8:11], s32 offen offset:1024 sc1
M v[144:147],a[84:87],v[56:59],v[144:147]
R a[120:123],v7,14336
R a[124:127],v7,15360
M v[148:151],a[84:87],v[60:63],v[148:151]
AF v31,v27,v31
AF v29,v18,v19
M v[148:151],a[80:83],v[44:47],v[148:151]
buffer_load_dwordx4 a[8:11], v7, s[8:11], s32 offen offset:2048 sc1
M v[156:159],a[88:91],v[44:47],v[156:159]
E v21,v103
M v[156:159],a[92:95],v[60:63],v[156:159]
C v52,v18,v19
AF v29,v20,v29
M v[152:155],a[92:95],v[56:59],v[152:155]
buffer_load_dwordx4 a[12:15], v7, s[8:11], s32 offen offset:3072 sc1
M v[152:155],a[88:91],v[40:43],v[152:155]
s_waitcnt lgkmcnt(0)
E v22,v108
M v[160:163],a[96:99],v[40:43],v[160:163]
R a[64:67],v7,16384
R a[68:71],v7,17408
M v[160:163],a[100:103],v[56:59],v[160:163]
buffer_load_dwordx4 a[16:19], v7, s[8:11], s73 offen offset:0 sc1
M v[164:167],a[100:103],v[60:63],v[164:167]
E v23,v109
M v[164:167],a[96:99],v[44:47],v[164:167]
R a[72:75],v7,18432
R a[76:79],v7,19456
M v[172:175],a[104:107],v[44:47],v[172:175]
buffer_load_dwordx4 a[20:23], v7, s[8:11], s73 offen offset:1024 sc1
M v[172:175],a[108:111],v[60:63],v[172:175]
C v53,v20,v21
AF v29,v21,v29
M v[168:171],a[108:111],v[56:59],v[168:171]
R a[80:83],v7,20480
R a[84:87],v7,21504
M v[168:171],a[104:107],v[40:43],v[168:171]
buffer_load_dwordx4 a[24:27], v7, s[8:11], s73 offen offset:2048 sc1
M v[176:179],a[112:115],v[40:43],v[176:179]
E v24,v110
M v[176:179],a[116:119],v[56:59],v[176:179]
R a[88:91],v7,22528
R a[92:95],v7,23552
M v[180:183],a[116:119],v[60:63],v[180:183]
buffer_load_dwordx4 a[28:31], v7, s[8:11], s73 offen offset:3072 sc1
M v[180:183],a[112:115],v[44:47],v[180:183]
E v25,v111
M v[188:191],a[120:123],v[44:47],v[188:191]
AF v29,v22,v29
C v54,v22,v23
M v[188:191],a[124:127],v[60:63],v[188:191]
buffer_load_dwordx4 a[32:35], v7, s[8:11], s74 offen offset:0 sc1
M v[184:187],a[124:127],v[56:59],v[184:187]
E v18,v116
M v[184:187],a[120:123],v[40:43],v[184:187]
s_waitcnt lgkmcnt(0)
AF v29,v23,v29
AF v29,v24,v29
M v[192:195],a[64:67],v[40:43],v[192:195]
R a[96:99],v7,24576
R a[100:103],v7,25600
M v[192:195],a[68:71],v[56:59],v[192:195]
buffer_load_dwordx4 a[36:39], v7, s[8:11], s74 offen offset:1024 sc1
M v[196:199],a[68:71],v[60:63],v[196:199]
E v19,v117
M v[196:199],a[64:67],v[44:47],v[196:199]
R a[104:107],v7,26624
R a[108:111],v7,27648
M v[204:207],a[72:75],v[44:47],v[204:207]
buffer_load_dwordx4 a[40:43], v7, s[8:11], s74 offen offset:2048 sc1
M v[204:207],a[76:79],v[60:63],v[204:207]
E v20,v118
M v[200:203],a[76:79],v[56:59],v[200:203]
R a[112:115],v7,28672
R a[116:119],v7,29696
M v[200:203],a[72:75],v[40:43],v[200:203]
buffer_load_dwordx4 a[44:47], v7, s[8:11], s74 offen offset:3072 sc1
M v[208:211],a[80:83],v[40:43],v[208:211]
C v55,v24,v25
AF v29,v25,v29
M v[208:211],a[84:87],v[56:59],v[208:211]
R a[120:123],v7,30720
R a[124:127],v7,31744
M v[212:215],a[84:87],v[60:63],v[212:215]
buffer_load_dwordx4 a[48:51], v7, s[8:11], s75 offen offset:0 sc1
M v[212:215],a[80:83],v[44:47],v[212:215]
E v21,v119
M v[220:223],a[88:91],v[44:47],v[220:223]
AF v29,v18,v29
C v48,v18,v19
M v[220:223],a[92:95],v[60:63],v[220:223]
buffer_load_dwordx4 a[52:55], v7, s[8:11], s75 offen offset:1024 sc1
M v[216:219],a[92:95],v[56:59],v[216:219]
s_waitcnt lgkmcnt(0)
E v22,v124
M v[216:219],a[88:91],v[40:43],v[216:219]
s_barrier
M v[224:227],a[96:99],v[40:43],v[224:227]
R a[64:67],v8,0
R a[68:71],v8,1024
M v[224:227],a[100:103],v[56:59],v[224:227]
buffer_load_dwordx4 a[56:59], v7, s[8:11], s75 offen offset:2048 sc1
M v[228:231],a[100:103],v[60:63],v[228:231]
v_mov_b32 v15, 4
AF v29,v19,v29
M v[228:231],a[96:99],v[44:47],v[228:231]
R a[72:75],v8,2048
R a[76:79],v8,3072
M v[236:239],a[104:107],v[44:47],v[236:239]
buffer_store_dword v15, v1, s[8:11], s45 offen sc1
M v[236:239],a[108:111],v[60:63],v[236:239]
buffer_load_dwordx4 a[60:63], v7, s[8:11], s75 offen offset:3072 sc1
M v[232:235],a[108:111],v[56:59],v[232:235]
s_cmp_ge_u32 s42, 2
R a[80:83],v8,4096
R a[84:87],v8,5120
M v[232:235],a[104:107],v[40:43],v[232:235]
s_cselect_b32 s84, 4, 2
v_cmp_gt_u32 vcc, s84, v5
AF v29,v20,v29
M v[240:243],a[112:115],v[40:43],v[240:243]
s_cbranch_vccnz L_lsh4
L_lrh4:
E v23,v125
M v[240:243],a[116:119],v[56:59],v[240:243]
R a[88:91],v8,6144
R a[92:95],v8,7168
M v[244:247],a[116:119],v[60:63],v[244:247]
E v24,v126
M v[244:247],a[112:115],v[44:47],v[244:247]
E v25,v127
M v[252:255],a[120:123],v[44:47],v[252:255]
C v49,v20,v21
AF v29,v21,v29
M v[252:255],a[124:127],v[60:63],v[252:255]
AF v29,v22,v29
C v50,v22,v23
M v[248:251],a[124:127],v[56:59],v[248:251]
s_waitcnt lgkmcnt(0)
AF v29,v23,v29
AF v29,v24,v29
M v[248:251],a[120:123],v[40:43],v[248:251]
C v51,v24,v25
AF v29,v25,v29
v_cmp_lt_f32 vcc, s31, v29
s_nop 0
s_cbranch_vccnz L_std4h
L_rtd4h:
M v[132:135],a[64:67],v[52:55],v[132:135]
R a[96:99],v8,8192
R a[100:103],v8,9216
M v[132:135],a[68:71],v[48:51],v[132:135]
R a[104:107],v8,10240
R a[108:111],v8,11264
M v[140:143],a[72:75],v[52:55],v[140:143]
SA m0,s28,65536
R a[112:115],v8,12288
R a[116:119],v8,13312
M v[140:143],a[76:79],v[48:51],v[140:143]
R a[120:123],v8,14336
R a[124:127],v8,15360
M v[148:151],a[80:83],v[52:55],v[148:151]
buffer_load_dwordx4 v3, s[8:11], s21 offen offset:0 sc1 lds
M v[148:151],a[84:87],v[48:51],v[148:151]
AF v31,v29,v31
v_mov_b32 v10, v30
M v[156:159],a[88:91],v[52:55],v[156:159]
v_mov_b32 v11, v31
C v128,v128,v129
M v[156:159],a[92:95],v[48:51],v[156:159]
s_waitcnt lgkmcnt(0)
v_permlane16_swap_b32 v10, v30
M v[164:167],a[96:99],v[52:55],v[164:167]
R a[64:67],v8,16384
R a[68:71],v8,17408
M v[164:167],a[100:103],v[48:51],v[164:167]
R a[72:75],v8,18432
R a[76:79],v8,19456
M v[172:175],a[104:107],v[52:55],v[172:175]
R a[80:83],v8,20480
R a[84:87],v8,21504
M v[172:175],a[108:111],v[48:51],v[172:175]
R a[88:91],v8,22528
R a[92:95],v8,23552
M v[180:183],a[112:115],v[52:55],v[180:183]
buffer_load_dwordx4 v3, s[8:11], s21 offen offset:1024 sc1 lds
M v[180:183],a[116:119],v[48:51],v[180:183]
v_permlane16_swap_b32 v11, v31
M v[188:191],a[120:123],v[52:55],v[188:191]
AF v30,v10,v30
AF v31,v11,v31
M v[188:191],a[124:127],v[48:51],v[188:191]
s_waitcnt lgkmcnt(0)
buffer_load_dwordx4 v3, s[8:11], s21 offen offset:2048 sc1 lds
M v[196:199],a[64:67],v[52:55],v[196:199]
R a[96:99],v8,24576
R a[100:103],v8,25600
M v[196:199],a[68:71],v[48:51],v[196:199]
R a[104:107],v8,26624
R a[108:111],v8,27648
M v[204:207],a[72:75],v[52:55],v[204:207]
R a[112:115],v8,28672
R a[116:119],v8,29696
M v[204:207],a[76:79],v[48:51],v[204:207]
R a[120:123],v8,30720
R a[124:127],v8,31744
M v[212:215],a[80:83],v[52:55],v[212:215]
buffer_load_dwordx4 v3, s[8:11], s21 offen offset:3072 sc1 lds
M v[212:215],a[84:87],v[48:51],v[212:215]
SA m0,s28,69632
v_mov_b32 v10, v30
v_mov_b32 v11, v31
M v[220:223],a[88:91],v[52:55],v[220:223]
s_waitcnt lgkmcnt(0)
v_permlane32_swap_b32 v10, v30
M v[220:223],a[92:95],v[48:51],v[220:223]
s_barrier
M v[228:231],a[96:99],v[52:55],v[228:231]
R a[64:67],v2,32768
R a[68:71],v2,33792
M v[228:231],a[100:103],v[48:51],v[228:231]
R a[72:75],v2,34816
R a[76:79],v2,35840
M v[236:239],a[104:107],v[52:55],v[236:239]
R a[80:83],v2,36864
R a[84:87],v2,37888
M v[236:239],a[108:111],v[48:51],v[236:239]
R a[88:91],v2,38912
R a[92:95],v2,39936
M v[244:247],a[112:115],v[52:55],v[244:247]
v_permlane32_swap_b32 v11, v31
M v[244:247],a[116:119],v[48:51],v[244:247]
s_waitcnt vmcnt(4)
buffer_load_dwordx4 v4, s[8:11], s21 offen offset:0 sc1 lds
M v[252:255],a[120:123],v[52:55],v[252:255]
s_waitcnt lgkmcnt(0)
AF v30,v10,v30
AF v31,v11,v31
M v[252:255],a[124:127],v[48:51],v[252:255]
v_rcp_f32 v5, v30
M v[64:67],a[64:67],a[0:3],0
R a[96:99],v2,40960
R a[100:103],v2,41984
M v[64:67],a[68:71],a[4:7],v[64:67]
v_rcp_f32 v6, v31
M v[64:67],a[72:75],a[8:11],v[64:67]
buffer_load_dwordx4 v4, s[8:11], s21 offen offset:1024 sc1 lds
M v[64:67],a[76:79],a[12:15],v[64:67]
R a[104:107],v2,43008
R a[108:111],v2,44032
M v[64:67],a[80:83],a[16:19],v[64:67]
W a192,v5
W a193,v6
M v[64:67],a[84:87],a[20:23],v[64:67]
buffer_load_dwordx4 v4, s[8:11], s21 offen offset:2048 sc1 lds
M v[64:67],a[88:91],a[24:27],v[64:67]
R a[112:115],v2,45056
R a[116:119],v2,46080
M v[64:67],a[92:95],a[28:31],v[64:67]
v_mov_b32 v30, 0
v_mov_b32 v31, 0
M v[68:71],a[92:95],a[60:63],0
buffer_load_dwordx4 v4, s[8:11], s21 offen offset:3072 sc1 lds
M v[68:71],a[88:91],a[56:59],v[68:71]
SA s21,s21,32768
R a[120:123],v2,47104
R a[124:127],v2,48128
M v[68:71],a[84:87],a[52:55],v[68:71]
s_sub_u32 s22, s22, 1
v_mov_b32 v32, 0
v_mov_b32 v33, 0
M v[68:71],a[80:83],a[48:51],v[68:71]
s_cselect_b32 s21, s23, s21
v_mov_b32 v34, 0
v_mov_b32 v35, 0
M v[68:71],a[76:79],a[44:47],v[68:71]
s_mul_i32 s26, s41, 1048576
v_mov_b32 v36, 0
v_mov_b32 v37, 0
M v[68:71],a[72:75],a[40:43],v[68:71]
SA s26,s26,17367040
v_mov_b32 v38, 0
v_mov_b32 v39, 0
M v[68:71],a[68:71],a[36:39],v[68:71]
SA m0,s28,0
E v18,v64
M v[68:71],a[64:67],a[32:35],v[68:71]
s_waitcnt lgkmcnt(0)
buffer_load_dwordx4 v3, s[8:11], s26 offen offset:0 sc1 lds
M v[72:75],a[96:99],a[0:3],0
R a[64:67],v2,49152
R a[68:71],v2,50176
M v[72:75],a[100:103],a[4:7],v[72:75]
E v19,v65
M v[72:75],a[104:107],a[8:11],v[72:75]
buffer_load_dwordx4 v3, s[8:11], s26 offen offset:1024 sc1 lds
M v[72:75],a[108:111],a[12:15],v[72:75]
R a[72:75],v2,51200
R a[76:79],v2,52224
M v[72:75],a[112:115],a[16:19],v[72:75]
E v20,v66
M v[72:75],a[116:119],a[20:23],v[72:75]
buffer_load_dwordx4 v3, s[8:11], s26 offen offset:2048 sc1 lds
M v[72:75],a[120:123],a[24:27],v[72:75]
R a[80:83],v2,53248
R a[84:87],v2,54272
M v[72:75],a[124:127],a[28:31],v[72:75]
E v21,v67
M v[76:79],a[124:127],a[60:63],0
buffer_load_dwordx4 v3, s[8:11], s26 offen offset:3072 sc1 lds
M v[76:79],a[120:123],a[56:59],v[76:79]
SA m0,s28,4096
R a[88:91],v2,55296
R a[92:95],v2,56320
M v[76:79],a[116:119],a[52:55],v[76:79]
E v22,v68
M v[76:79],a[112:115],a[48:51],v[76:79]
E v23,v69
M v[76:79],a[108:111],a[44:47],v[76:79]
buffer_load_dwordx4 v4, s[8:11], s26 offen offset:0 sc1 lds
M v[76:79],a[104:107],a[40:43],v[76:79]
AF v26,v18,v19
C v40,v18,v19
M v[76:79],a[100:103],a[36:39],v[76:79]
E v24,v70
M v[76:79],a[96:99],a[32:35],v[76:79]
s_waitcnt lgkmcnt(0)
AF v26,v20,v26
C v41,v20,v21
M v[80:83],a[64:67],a[0:3],0
R a[96:99],v2,57344
R a[100:103],v2,58368
M v[80:83],a[68:71],a[4:7],v[80:83]
buffer_load_dwordx4 v4, s[8:11], s26 offen offset:1024 sc1 lds
M v[80:83],a[72:75],a[8:11],v[80:83]
E v25,v71
M v[80:83],a[76:79],a[12:15],v[80:83]
R a[104:107],v2,59392
R a[108:111],v2,60416
M v[80:83],a[80:83],a[16:19],v[80:83]
AF v26,v21,v26
AF v27,v22,v23
M v[80:83],a[84:87],a[20:23],v[80:83]
buffer_load_dwordx4 v4, s[8:11], s26 offen offset:2048 sc1 lds
M v[80:83],a[88:91],a[24:27],v[80:83]
R a[112:115],v2,61440
R a[116:119],v2,62464
M v[80:83],a[92:95],a[28:31],v[80:83]
E v18,v72
M v[84:87],a[92:95],a[60:63],0
E v19,v73
M v[84:87],a[88:91],a[56:59],v[84:87]
R a[120:123],v2,63488
R a[124:127],v2,64512
M v[84:87],a[84:87],a[52:55],v[84:87]
buffer_load_dwordx4 v4, s[8:11], s26 offen offset:3072 sc1 lds
M v[84:87],a[80:83],a[48:51],v[84:87]
SA s26,s26,32768
E v20,v74
M v[84:87],a[76:79],a[44:47],v[84:87]
SA m0,s28,32768
C v44,v22,v23
AF v27,v24,v27
M v[84:87],a[72:75],a[40:43],v[84:87]
C v45,v24,v25
AF v27,v25,v27
M v[84:87],a[68:71],a[36:39],v[84:87]
s_waitcnt vmcnt(8) lgkmcnt(0)
buffer_load_dwordx4 v3, s[8:11], s26 offen offset:0 sc1 lds
M v[84:87],a[64:67],a[32:35],v[84:87]
s_barrier
M v[88:91],a[96:99],a[0:3],0
R a[64:67],v2,0
R a[68:71],v2,1024
M v[88:91],a[100:103],a[4:7],v[88:91]
E v21,v75
M v[88:91],a[104:107],a[8:11],v[88:91]
buffer_load_dwordx4 v3, s[8:11], s26 offen offset:1024 sc1 lds
M v[88:91],a[108:111],a[12:15],v[88:91]
R a[72:75],v2,2048
R a[76:79],v2,3072
M v[88:91],a[112:115],a[16:19],v[88:91]
E v22,v76
M v[88:91],a[116:119],a[20:23],v[88:91]
E v23,v77
M v[88:91],a[120:123],a[24:27],v[88:91]
R a[80:83],v2,4096
R a[84:87],v2,5120
M v[88:91],a[124:127],a[28:31],v[88:91]
buffer_load_dwordx4 v3, s[8:11], s26 offen offset:2048 sc1 lds
M v[92:95],a[124:127],a[60:63],0
E v24,v78
M v[92:95],a[120:123],a[56:59],v[92:95]
R a[88:91],v2,6144
R a[92:95],v2,7168
M v[92:95],a[116:119],a[52:55],v[92:95]
E v25,v79
M v[92:95],a[112:115],a[48:51],v[92:95]
buffer_load_dwordx4 v3, s[8:11], s26 offen offset:3072 sc1 lds
M v[92:95],a[108:111],a[44:47],v[92:95]
AF v26,v18,v26
C v42,v18,v19
M v[92:95],a[104:107],a[40:43],v[92:95]
AF v26,v19,v26
AF v26,v20,v26
M v[92:95],a[100:103],a[36:39],v[92:95]
s_waitcnt lgkmcnt(0)
C v43,v20,v21
AF v26,v21,v26
M v[92:95],a[96:99],a[32:35],v[92:95]
AF v27,v22,v27
C v46,v22,v23
AF v27,v23,v27
AF v27,v24,v27
C v47,v24,v25
AF v27,v25,v27
M v[96:99],a[64:67],a[0:3],0
R a[96:99],v2,8192
R a[100:103],v2,9216
M v[96:99],a[68:71],a[4:7],v[96:99]
SA m0,s28,98304
E v18,v80
M v[96:99],a[72:75],a[8:11],v[96:99]
buffer_load_dwordx4 v3, s[8:11], s21 offen offset:0 sc1 lds
M v[96:99],a[76:79],a[12:15],v[96:99]
R a[104:107],v2,10240
R a[108:111],v2,11264
M v[96:99],a[80:83],a[16:19],v[96:99]
E v19,v81
M v[96:99],a[84:87],a[20:23],v[96:99]
AF v26,v18,v26
C v56,v18,v19
M v[96:99],a[88:91],a[24:27],v[96:99]
R a[112:115],v2,12288
R a[116:119],v2,13312
M v[96:99],a[92:95],a[28:31],v[96:99]
buffer_load_dwordx4 v3, s[8:11], s21 offen offset:1024 sc1 lds
M v[100:103],a[92:95],a[60:63],0
E v20,v82
M v[100:103],a[88:91],a[56:59],v[100:103]
R a[120:123],v2,14336
R a[124:127],v2,15360
M v[100:103],a[84:87],a[52:55],v[100:103]
E v21,v83
M v[100:103],a[80:83],a[48:51],v[100:103]
buffer_load_dwordx4 v3, s[8:11], s21 offen offset:2048 sc1 lds
M v[100:103],a[76:79],a[44:47],v[100:103]
AF v26,v19,v26
AF v26,v20,v26
M v[100:103],a[72:75],a[40:43],v[100:103]
E v22,v88
M v[100:103],a[68:71],a[36:39],v[100:103]
C v57,v20,v21
AF v26,v21,v26
M v[100:103],a[64:67],a[32:35],v[100:103]
s_waitcnt lgkmcnt(0)
buffer_load_dwordx4 v3, s[8:11], s21 offen offset:3072 sc1 lds
M v[108:111],a[96:99],a[32:35],0
R a[64:67],v2,16384
R a[68:71],v2,17408
M v[108:111],a[100:103],a[36:39],v[108:111]
E v23,v89
M v[108:111],a[104:107],a[40:43],v[108:111]
SA m0,s28,102400
AF v26,v22,v26
C v58,v22,v23
M v[108:111],a[108:111],a[44:47],v[108:111]
R a[72:75],v2,18432
R a[76:79],v2,19456
M v[108:111],a[112:115],a[48:51],v[108:111]
buffer_load_dwordx4 v4, s[8:11], s21 offen offset:0 sc1 lds
M v[108:111],a[116:119],a[52:55],v[108:111]
E v24,v90
M v[108:111],a[120:123],a[56:59],v[108:111]
R a[80:83],v2,20480
R a[84:87],v2,21504
M v[108:111],a[124:127],a[60:63],v[108:111]
E v25,v91
M v[104:107],a[124:127],a[28:31],0
buffer_load_dwordx4 v4, s[8:11], s21 offen offset:1024 sc1 lds
M v[104:107],a[120:123],a[24:27],v[104:107]
R a[88:91],v2,22528
R a[92:95],v2,23552
M v[104:107],a[116:119],a[20:23],v[104:107]
AF v26,v23,v26
AF v26,v24,v26
M v[104:107],a[112:115],a[16:19],v[104:107]
E v18,v84
M v[104:107],a[108:111],a[12:15],v[104:107]
buffer_load_dwordx4 v4, s[8:11], s21 offen offset:2048 sc1 lds
M v[104:107],a[104:107],a[8:11],v[104:107]
C v59,v24,v25
AF v26,v25,v26
M v[104:107],a[100:103],a[4:7],v[104:107]
E v19,v85
M v[104:107],a[96:99],a[0:3],v[104:107]
s_waitcnt lgkmcnt(0)
AF v27,v18,v27
C v60,v18,v19
M v[112:115],a[64:67],a[0:3],0
R a[96:99],v2,24576
R a[100:103],v2,25600
M v[112:115],a[68:71],a[4:7],v[112:115]
buffer_load_dwordx4 v4, s[8:11], s21 offen offset:3072 sc1 lds
M v[112:115],a[72:75],a[8:11],v[112:115]
SA s21,s21,32768
E v20,v86
M v[112:115],a[76:79],a[12:15],v[112:115]
s_sub_u32 s22, s22, 1
R a[104:107],v2,26624
R a[108:111],v2,27648
M v[112:115],a[80:83],a[16:19],v[112:115]
s_cselect_b32 s21, s23, s21
AF v27,v19,v27
C v129,v130,v131
M v[112:115],a[84:87],a[20:23],v[112:115]
SA m0,s28,36864
E v21,v87
M v[112:115],a[88:91],a[24:27],v[112:115]
R a[112:115],v2,28672
R a[116:119],v2,29696
M v[112:115],a[92:95],a[28:31],v[112:115]
buffer_load_dwordx4 v4, s[8:11], s26 offen offset:0 sc1 lds
M v[116:119],a[92:95],a[60:63],0
E v22,v92
M v[116:119],a[88:91],a[56:59],v[116:119]
R a[120:123],v2,30720
R a[124:127],v2,31744
M v[116:119],a[84:87],a[52:55],v[116:119]
AF v27,v20,v27
C v61,v20,v21
M v[116:119],a[80:83],a[48:51],v[116:119]
buffer_load_dwordx4 v4, s[8:11], s26 offen offset:1024 sc1 lds
M v[116:119],a[76:79],a[44:47],v[116:119]
E v23,v93
M v[116:119],a[72:75],a[40:43],v[116:119]
AF v27,v21,v27
AF v27,v22,v27
M v[116:119],a[68:71],a[36:39],v[116:119]
s_waitcnt vmcnt(14) lgkmcnt(0)
C v62,v22,v23
AF v27,v23,v27
M v[116:119],a[64:67],a[32:35],v[116:119]
s_barrier
M v[124:127],a[96:99],a[32:35],0
R a[64:67],v7,0
R a[68:71],v7,1024
M v[124:127],a[100:103],a[36:39],v[124:127]
buffer_load_dwordx4 v4, s[8:11], s26 offen offset:2048 sc1 lds
M v[124:127],a[104:107],a[40:43],v[124:127]
E v24,v94
M v[124:127],a[108:111],a[44:47],v[124:127]
R a[72:75],v7,2048
R a[76:79],v7,3072
M v[124:127],a[112:115],a[48:51],v[124:127]
E v25,v95
M v[124:127],a[116:119],a[52:55],v[124:127]
buffer_load_dwordx4 v4, s[8:11], s26 offen offset:3072 sc1 lds
M v[124:127],a[120:123],a[56:59],v[124:127]
R a[80:83],v7,4096
R a[84:87],v7,5120
M v[124:127],a[124:127],a[60:63],v[124:127]
AF v27,v24,v27
C v63,v24,v25
M v[120:123],a[124:127],a[28:31],0
SA s26,s26,32768
AF v27,v25,v27
C v130,v136,v137
M v[120:123],a[120:123],a[24:27],v[120:123]
R a[88:91],v7,6144
R a[92:95],v7,7168
C v131,v138,v139
W a128,v128
W a129,v129
W a130,v130
W a131,v131
C v144,v144,v145
C v145,v146,v147
C v146,v152,v153
C v147,v154,v155
W a132,v144
W a133,v145
W a134,v146
W a135,v147
C v132,v132,v133
C v133,v134,v135
C v134,v140,v141
C v135,v142,v143
W a160,v132
W a161,v133
W a162,v134
W a163,v135
C v160,v160,v161
C v161,v162,v163
C v162,v168,v169
C v163,v170,v171
W a136,v160
W a137,v161
W a138,v162
W a139,v163
C v148,v148,v149
C v149,v150,v151
C v150,v156,v157
C v151,v158,v159
W a164,v148
W a165,v149
W a166,v150
W a167,v151
C v176,v176,v177
C v177,v178,v179
C v178,v184,v185
C v179,v186,v187
W a140,v176
W a141,v177
W a142,v178
W a143,v179
C v164,v164,v165
C v165,v166,v167
C v166,v172,v173
C v167,v174,v175
W a168,v164
W a169,v165
W a170,v166
W a171,v167
C v192,v192,v193
C v193,v194,v195
C v194,v200,v201
C v195,v202,v203
W a144,v192
W a145,v193
W a146,v194
W a147,v195
C v180,v180,v181
C v181,v182,v183
C v182,v188,v189
C v183,v190,v191
W a172,v180
W a173,v181
W a174,v182
W a175,v183
C v208,v208,v209
C v209,v210,v211
C v210,v216,v217
C v211,v218,v219
W a148,v208
W a149,v209
W a150,v210
W a151,v211
C v196,v196,v197
C v197,v198,v199
C v198,v204,v205
C v199,v206,v207
W a176,v196
W a177,v197
W a178,v198
W a179,v199
C v224,v224,v225
C v225,v226,v227
C v226,v232,v233
C v227,v234,v235
W a152,v224
W a153,v225
W a154,v226
W a155,v227
C v212,v212,v213
C v213,v214,v215
C v214,v220,v221
C v215,v222,v223
W a180,v212
W a181,v213
W a182,v214
W a183,v215
C v240,v240,v241
C v241,v242,v243
C v242,v248,v249
C v243,v250,v251
W a156,v240
W a157,v241
W a158,v242
W a159,v243
C v228,v228,v229
C v229,v230,v231
C v230,v236,v237
C v231,v238,v239
W a184,v228
W a185,v229
W a186,v230
W a187,v231
C v244,v244,v245
C v245,v246,v247
C v246,v252,v253
C v247,v254,v255
W a188,v244
W a189,v245
W a190,v246
W a191,v247
M v[120:123],a[116:119],a[20:23],v[120:123]
M v[120:123],a[112:115],a[16:19],v[120:123]
M v[120:123],a[108:111],a[12:15],v[120:123]
M v[120:123],a[104:107],a[8:11],v[120:123]
M v[120:123],a[100:103],a[4:7],v[120:123]
s_waitcnt lgkmcnt(0)
M v[120:123],a[96:99],a[0:3],v[120:123]
v_max_f32 v10, v26, v27
v_min_f32 v11, v26, v27
v_cmp_lt_f32 vcc, s31, v10
v_cmp_gt_f32 s[64:65], s24, v11
s_nop 0
s_or_b64 vcc, vcc, s[64:65]
s_cbranch_vccnz L_sth1
L_rth1:
M v[128:131],a[64:67],v[40:43],0
R a[96:99],v7,8192
R a[100:103],v7,9216
M v[128:131],a[68:71],v[56:59],v[128:131]
SA m0,s28,65536
E v18,v96
M v[132:135],a[68:71],v[60:63],0
buffer_load_dwordx4 v3, s[8:11], s21 offen offset:0 sc1 lds
M v[132:135],a[64:67],v[44:47],v[132:135]
R a[104:107],v7,10240
R a[108:111],v7,11264
M v[140:143],a[72:75],v[44:47],0
E v19,v97
M v[140:143],a[76:79],v[60:63],v[140:143]
AF v30,v26,v30
AF v31,v27,v31
M v[136:139],a[76:79],v[56:59],0
R a[112:115],v7,12288
R a[116:119],v7,13312
M v[136:139],a[72:75],v[40:43],v[136:139]
buffer_load_dwordx4 v3, s[8:11], s21 offen offset:1024 sc1 lds
M v[144:147],a[80:83],v[40:43],0
E v20,v98
M v[144:147],a[84:87],v[56:59],v[144:147]
R a[120:123],v7,14336
R a[124:127],v7,15360
M v[148:151],a[84:87],v[60:63],0
s_mov_b32 s40, 0
AF v28,v18,v19
C v48,v18,v19
M v[148:151],a[80:83],v[44:47],v[148:151]
s_mov_b32 s7, 0
buffer_load_dwordx4 v3, s[8:11], s21 offen offset:2048 sc1 lds
M v[156:159],a[88:91],v[44:47],0
s_and_b32 s39, s39, 1
E v21,v99
M v[156:159],a[92:95],v[60:63],v[156:159]
s_or_b32 s39, s39, 2
AF v28,v20,v28
C v49,v20,v21
M v[152:155],a[92:95],v[56:59],0
s_sub_u32 s27, 5, s42
AF v28,v21,v28
M v[152:155],a[88:91],v[40:43],v[152:155]
s_waitcnt lgkmcnt(0)
buffer_load_dwordx4 v3, s[8:11], s21 offen offset:3072 sc1 lds
M v[160:163],a[96:99],v[40:43],0
SA m0,s28,69632
R a[64:67],v7,16384
R a[68:71],v7,17408
M v[160:163],a[100:103],v[56:59],v[160:163]
E v22,v104
M v[164:167],a[100:103],v[60:63],0
E v23,v105
M v[164:167],a[96:99],v[44:47],v[164:167]
R a[72:75],v7,18432
R a[76:79],v7,19456
M v[172:175],a[104:107],v[44:47],0
buffer_load_dwordx4 v4, s[8:11], s21 offen offset:0 sc1 lds
M v[172:175],a[108:111],v[60:63],v[172:175]
AF v28,v22,v28
C v50,v22,v23
M v[168:171],a[108:111],v[56:59],0
R a[80:83],v7,20480
R a[84:87],v7,21504
M v[168:171],a[104:107],v[40:43],v[168:171]
buffer_load_dwordx4 v4, s[8:11], s21 offen offset:1024 sc1 lds
M v[176:179],a[112:115],v[40:43],0
E v24,v106
M v[176:179],a[116:119],v[56:59],v[176:179]
R a[88:91],v7,22528
R a[92:95],v7,23552
M v[180:183],a[116:119],v[60:63],0
buffer_load_dwordx4 v4, s[8:11], s21 offen offset:2048 sc1 lds
M v[180:183],a[112:115],v[44:47],v[180:183]
E v25,v107
M v[188:191],a[120:123],v[44:47],0
AF v28,v23,v28
AF v28,v24,v28
M v[188:191],a[124:127],v[60:63],v[188:191]
C v51,v24,v25
AF v28,v25,v28
M v[184:187],a[124:127],v[56:59],0
buffer_load_dwordx4 v4, s[8:11], s21 offen offset:3072 sc1 lds
M v[184:187],a[120:123],v[40:43],v[184:187]
s_waitcnt lgkmcnt(0)
E v18,v100
M v[192:195],a[64:67],v[40:43],0
SA s21,s21,32768
R a[96:99],v7,24576
R a[100:103],v7,25600
M v[192:195],a[68:71],v[56:59],v[192:195]
s_sub_u32 s22, s22, 1
E v19,v101
M v[196:199],a[68:71],v[60:63],0
s_cselect_b32 s21, s23, s21
AF v29,v18,v19
C v52,v18,v19
M v[196:199],a[64:67],v[44:47],v[196:199]
R a[104:107],v7,26624
R a[108:111],v7,27648
M v[204:207],a[72:75],v[44:47],0
M v[204:207],a[76:79],v[60:63],v[204:207]
E v20,v102
M v[200:203],a[76:79],v[56:59],0
R a[112:115],v7,28672
R a[116:119],v7,29696
M v[200:203],a[72:75],v[40:43],v[200:203]
M v[208:211],a[80:83],v[40:43],0
M v[208:211],a[84:87],v[56:59],v[208:211]
R a[120:123],v7,30720
R a[124:127],v7,31744
M v[212:215],a[84:87],v[60:63],0
E v21,v103
M v[212:215],a[80:83],v[44:47],v[212:215]
AF v29,v20,v29
C v53,v20,v21
M v[220:223],a[88:91],v[44:47],0
AF v29,v21,v29
M v[220:223],a[92:95],v[60:63],v[220:223]
E v22,v108
M v[216:219],a[92:95],v[56:59],0
s_waitcnt vmcnt(12) lgkmcnt(0)
M v[216:219],a[88:91],v[40:43],v[216:219]
s_barrier
M v[224:227],a[96:99],v[40:43],0
R a[64:67],v2,32768
R a[68:71],v2,33792
M v[224:227],a[100:103],v[56:59],v[224:227]
E v23,v109
M v[228:231],a[100:103],v[60:63],0
AF v29,v22,v29
C v54,v22,v23
M v[228:231],a[96:99],v[44:47],v[228:231]
R a[72:75],v2,34816
R a[76:79],v2,35840
M v[236:239],a[104:107],v[44:47],0
E v24,v110
M v[236:239],a[108:111],v[60:63],v[236:239]
AF v29,v23,v29
M v[232:235],a[108:111],v[56:59],0
R a[80:83],v2,36864
R a[84:87],v2,37888
M v[232:235],a[104:107],v[40:43],v[232:235]
M v[240:243],a[112:115],v[40:43],0
E v25,v111
M v[240:243],a[116:119],v[56:59],v[240:243]
R a[88:91],v2,38912
R a[92:95],v2,39936
M v[244:247],a[116:119],v[60:63],0
AF v29,v24,v29
C v55,v24,v25
M v[244:247],a[112:115],v[44:47],v[244:247]
AF v29,v25,v29
M v[252:255],a[120:123],v[44:47],0
M v[252:255],a[124:127],v[60:63],v[252:255]
M v[248:251],a[124:127],v[56:59],0
s_waitcnt lgkmcnt(0)
M v[248:251],a[120:123],v[40:43],v[248:251]
s_cmp_lg_u32 s27, 0
s_cbranch_scc1 L_loop_top
L_final_h:
s_waitcnt vmcnt(8) lgkmcnt(0)
s_barrier
R a[64:67],v7,32768
R a[68:71],v7,33792
R a[72:75],v7,34816
R a[76:79],v7,35840
R a[80:83],v7,36864
R a[84:87],v7,37888
R a[88:91],v7,38912
R a[92:95],v7,39936
v_lshrrev_b32 v14, 7, v7
v_mul_u32_u24 v14, 896, v14
v_lshrrev_b32 v15, 8, v7
v_lshlrev_b32 v15, 5, v15
v_xor_b32 v15, v15, v7
v_and_b32 v15, 0x70, v15
v_add_u32 v0, v14, v15
s_mul_i32 s38, s20, 57344
SA m0,s28,98304
SA s85,s38,0
E v18,v112
buffer_load_dwordx4 v0, s[12:15], s85 offen offset:0 lds
E v19,v113
E v20,v114
AF v28,v18,v28
SA s85,s38,6144
C v56,v18,v19
buffer_load_dwordx4 v0, s[12:15], s85 offen offset:1024 lds
E v21,v115
AF v28,v19,v28
E v22,v120
AF v28,v20,v28
SA s85,s38,12288
C v57,v20,v21
buffer_load_dwordx4 v0, s[12:15], s85 offen offset:2048 lds
E v23,v121
AF v28,v21,v28
E v24,v122
AF v28,v22,v28
SA s85,s38,18432
C v58,v22,v23
buffer_load_dwordx4 v0, s[12:15], s85 offen offset:3072 lds
E v25,v123
AF v28,v23,v28
E v18,v116
AF v28,v24,v28
SA m0,s28,102400
SA s85,s38,28672
C v59,v24,v25
buffer_load_dwordx4 v0, s[12:15], s85 offen offset:0 lds
E v19,v117
AF v28,v25,v28
E v20,v118
AF v29,v18,v29
SA s85,s38,34816
C v60,v18,v19
buffer_load_dwordx4 v0, s[12:15], s85 offen offset:1024 lds
E v21,v119
AF v29,v19,v29
E v22,v124
AF v29,v20,v29
SA s85,s38,40960
C v61,v20,v21
buffer_load_dwordx4 v0, s[12:15], s85 offen offset:2048 lds
E v23,v125
AF v29,v21,v29
E v24,v126
AF v29,v22,v29
SA s85,s38,47104
C v62,v22,v23
buffer_load_dwordx4 v0, s[12:15], s85 offen offset:3072 lds
SA s38,s38,128
E v25,v127
AF v29,v23,v29
AF v29,v24,v29
C v63,v24,v25
AF v29,v25,v29
v_max_f32 v10, v28, v29
v_cmp_lt_f32 vcc, s31, v10
s_nop 0
s_cbranch_vccnz L_stfh
L_rtfh:
AF v30,v28,v30
AF v31,v29,v31
v_mov_b32 v10, v32
v_mov_b32 v11, v36
v_mov_b32 v12, v30
v_mov_b32 v13, v31
buffer_store_dwordx4 v[10:13], v7, s[8:11], s90 offen sc1
s_waitcnt lgkmcnt(0)
M v[128:131],a[64:67],v[48:51],v[128:131]
SA m0,s28,65536
R a[96:99],v7,40960
R a[100:103],v7,41984
M v[128:131],a[68:71],v[56:59],v[128:131]
SA s85,s38,0
buffer_load_dwordx4 v0, s[12:15], s85 offen offset:0 lds
M v[132:135],a[68:71],v[60:63],v[132:135]
SA s85,s38,6144
v_lshrrev_b32 v16, 4, v7
v_lshrrev_b32 v14, 2, v16
M v[132:135],a[64:67],v[52:55],v[132:135]
R a[104:107],v7,43008
R a[108:111],v7,44032
M v[136:139],a[72:75],v[48:51],v[136:139]
buffer_load_dwordx4 v0, s[12:15], s85 offen offset:1024 lds
M v[136:139],a[76:79],v[56:59],v[136:139]
SA s85,s38,12288
v_lshlrev_b32 v14, 7, v14
v_and_b32 v15, 3, v16
M v[140:143],a[76:79],v[60:63],v[140:143]
R a[112:115],v7,45056
R a[116:119],v7,46080
M v[140:143],a[72:75],v[52:55],v[140:143]
buffer_load_dwordx4 v0, s[12:15], s85 offen offset:2048 lds
M v[144:147],a[80:83],v[48:51],v[144:147]
SA s85,s38,18432
v_lshl_add_u32 v14, v15, 3, v14
v_bfe_u32 v15, v16, 3, 2
M v[144:147],a[84:87],v[56:59],v[144:147]
R a[120:123],v7,47104
R a[124:127],v7,48128
M v[148:151],a[84:87],v[60:63],v[148:151]
buffer_load_dwordx4 v0, s[12:15], s85 offen offset:3072 lds
M v[148:151],a[80:83],v[52:55],v[148:151]
v_lshl_add_u32 v18, v15, 5, v14
v_xor_b32 v19, 32, v18
M v[152:155],a[88:91],v[48:51],v[152:155]
v_xor_b32 v20, 64, v18
v_xor_b32 v21, 0x60, v18
M v[152:155],a[92:95],v[56:59],v[152:155]
v_add_u32 v22, 0x10000, v18
v_add_u32 v23, 0x10000, v19
M v[156:159],a[92:95],v[60:63],v[156:159]
v_add_u32 v24, 0x10000, v20
v_add_u32 v25, 0x10000, v21
M v[156:159],a[88:91],v[52:55],v[156:159]
s_waitcnt lgkmcnt(0)
C v128,v128,v129
C v129,v130,v131
M v[160:163],a[96:99],v[48:51],v[160:163]
R a[64:67],v7,49152
R a[68:71],v7,50176
M v[160:163],a[100:103],v[56:59],v[160:163]
C v130,v136,v137
C v131,v138,v139
M v[164:167],a[100:103],v[60:63],v[164:167]
buffer_store_dwordx4 v[128:131], v7, s[8:11], s86 offen offset:0 sc1
M v[164:167],a[96:99],v[52:55],v[164:167]
R a[72:75],v7,51200
R a[76:79],v7,52224
M v[168:171],a[104:107],v[48:51],v[168:171]
C v132,v132,v133
C v133,v134,v135
M v[168:171],a[108:111],v[56:59],v[168:171]
C v134,v140,v141
C v135,v142,v143
M v[172:175],a[108:111],v[60:63],v[172:175]
R a[80:83],v7,53248
R a[84:87],v7,54272
M v[172:175],a[104:107],v[52:55],v[172:175]
buffer_store_dwordx4 v[132:135], v7, s[8:11], s88 offen offset:0 sc1
M v[176:179],a[112:115],v[48:51],v[176:179]
C v144,v144,v145
C v145,v146,v147
M v[176:179],a[116:119],v[56:59],v[176:179]
R a[88:91],v7,55296
R a[92:95],v7,56320
M v[180:183],a[116:119],v[60:63],v[180:183]
C v146,v152,v153
C v147,v154,v155
M v[180:183],a[112:115],v[52:55],v[180:183]
buffer_store_dwordx4 v[144:147], v7, s[8:11], s86 offen offset:1024 sc1
M v[184:187],a[120:123],v[48:51],v[184:187]
C v148,v148,v149
C v149,v150,v151
M v[184:187],a[124:127],v[56:59],v[184:187]
C v150,v156,v157
C v151,v158,v159
M v[188:191],a[124:127],v[60:63],v[188:191]
buffer_store_dwordx4 v[148:151], v7, s[8:11], s88 offen offset:1024 sc1
M v[188:191],a[120:123],v[52:55],v[188:191]
s_waitcnt lgkmcnt(0)
C v160,v160,v161
C v161,v162,v163
M v[192:195],a[64:67],v[48:51],v[192:195]
R a[96:99],v7,57344
R a[100:103],v7,58368
M v[192:195],a[68:71],v[56:59],v[192:195]
C v162,v168,v169
C v163,v170,v171
M v[196:199],a[68:71],v[60:63],v[196:199]
buffer_store_dwordx4 v[160:163], v7, s[8:11], s86 offen offset:2048 sc1
M v[196:199],a[64:67],v[52:55],v[196:199]
R a[104:107],v7,59392
R a[108:111],v7,60416
M v[200:203],a[72:75],v[48:51],v[200:203]
C v164,v164,v165
C v165,v166,v167
M v[200:203],a[76:79],v[56:59],v[200:203]
C v166,v172,v173
C v167,v174,v175
M v[204:207],a[76:79],v[60:63],v[204:207]
R a[112:115],v7,61440
R a[116:119],v7,62464
M v[204:207],a[72:75],v[52:55],v[204:207]
buffer_store_dwordx4 v[164:167], v7, s[8:11], s88 offen offset:2048 sc1
M v[208:211],a[80:83],v[48:51],v[208:211]
C v176,v176,v177
C v177,v178,v179
M v[208:211],a[84:87],v[56:59],v[208:211]
R a[120:123],v7,63488
R a[124:127],v7,64512
M v[212:215],a[84:87],v[60:63],v[212:215]
C v178,v184,v185
C v179,v186,v187
M v[212:215],a[80:83],v[52:55],v[212:215]
buffer_store_dwordx4 v[176:179], v7, s[8:11], s86 offen offset:3072 sc1
M v[216:219],a[88:91],v[48:51],v[216:219]
C v180,v180,v181
C v181,v182,v183
M v[216:219],a[92:95],v[56:59],v[216:219]
C v182,v188,v189
C v183,v190,v191
M v[220:223],a[92:95],v[60:63],v[220:223]
s_waitcnt vmcnt(12) lgkmcnt(0)
buffer_store_dwordx4 v[180:183], v7, s[8:11], s88 offen offset:3072 sc1
M v[220:223],a[88:91],v[52:55],v[220:223]
s_barrier
M v[224:227],a[96:99],v[48:51],v[224:227]
s_nop 0
T a[64:65],v22,32768
T a[66:67],v22,34816
M v[224:227],a[100:103],v[56:59],v[224:227]
T a[68:69],v22,36864
T a[70:71],v22,38912
M v[228:231],a[100:103],v[60:63],v[228:231]
C v192,v192,v193
C v193,v194,v195
M v[228:231],a[96:99],v[52:55],v[228:231]
T a[72:73],v22,40960
T a[74:75],v22,43008
M v[232:235],a[104:107],v[48:51],v[232:235]
T a[76:77],v22,45056
T a[78:79],v22,47104
M v[232:235],a[108:111],v[56:59],v[232:235]
C v194,v200,v201
C v195,v202,v203
M v[236:239],a[108:111],v[60:63],v[236:239]
T a[80:81],v22,49152
T a[82:83],v22,51200
M v[236:239],a[104:107],v[52:55],v[236:239]
T a[84:85],v22,53248
T a[86:87],v22,55296
M v[240:243],a[112:115],v[48:51],v[240:243]
buffer_store_dwordx4 v[192:195], v7, s[8:11], s87 offen offset:0 sc1
M v[240:243],a[116:119],v[56:59],v[240:243]
s_nop 0
T a[88:89],v22,57344
T a[90:91],v22,59392
M v[244:247],a[116:119],v[60:63],v[244:247]
T a[92:93],v22,61440
T a[94:95],v22,63488
M v[244:247],a[112:115],v[52:55],v[244:247]
C v196,v196,v197
C v197,v198,v199
M v[248:251],a[120:123],v[48:51],v[248:251]
C v198,v204,v205
C v199,v206,v207
M v[248:251],a[124:127],v[56:59],v[248:251]
buffer_store_dwordx4 v[196:199], v7, s[8:11], s89 offen offset:0 sc1
M v[252:255],a[124:127],v[60:63],v[252:255]
s_waitcnt lgkmcnt(0)
C v208,v208,v209
C v209,v210,v211
M v[252:255],a[120:123],v[52:55],v[252:255]
C v210,v216,v217
C v211,v218,v219
buffer_store_dwordx4 v[208:211], v7, s[8:11], s87 offen offset:1024 sc1
C v212,v212,v213
C v213,v214,v215
C v214,v220,v221
C v215,v222,v223
buffer_store_dwordx4 v[212:215], v7, s[8:11], s89 offen offset:1024 sc1
C v224,v224,v225
C v225,v226,v227
C v226,v232,v233
C v227,v234,v235
buffer_store_dwordx4 v[224:227], v7, s[8:11], s87 offen offset:2048 sc1
C v228,v228,v229
C v229,v230,v231
C v230,v236,v237
C v231,v238,v239
buffer_store_dwordx4 v[228:231], v7, s[8:11], s89 offen offset:2048 sc1
C v240,v240,v241
C v241,v242,v243
C v242,v248,v249
C v243,v250,v251
buffer_store_dwordx4 v[240:243], v7, s[8:11], s87 offen offset:3072 sc1
C v244,v244,v245
C v245,v246,v247
C v246,v252,v253
C v247,v254,v255
buffer_store_dwordx4 v[244:247], v7, s[8:11], s89 offen offset:3072 sc1
M v[64:67],a[64:67],a[128:131],0
s_nop 0
T a[96:97],v23,32768
T a[98:99],v23,34816
M v[64:67],a[68:71],a[132:135],v[64:67]
SA m0,s28,69632
T a[100:101],v23,36864
T a[102:103],v23,38912
M v[64:67],a[72:75],a[136:139],v[64:67]
SA s85,s38,28672
buffer_load_dwordx4 v0, s[12:15], s85 offen offset:0 lds
M v[64:67],a[76:79],a[140:143],v[64:67]
SA s85,s38,34816
T a[104:105],v23,40960
T a[106:107],v23,43008
M v[64:67],a[80:83],a[144:147],v[64:67]
SA s29,s33,0
T a[108:109],v23,45056
T a[110:111],v23,47104
M v[64:67],a[84:87],a[148:151],v[64:67]
SA s30,s33,14336
buffer_load_dwordx4 v0, s[12:15], s85 offen offset:1024 lds
M v[64:67],a[88:91],a[152:155],v[64:67]
SA s85,s38,40960
T a[112:113],v23,49152
T a[114:115],v23,51200
M v[64:67],a[92:95],a[156:159],v[64:67]
T a[116:117],v23,53248
T a[118:119],v23,55296
M v[68:71],a[92:95],a[188:191],0
buffer_load_dwordx4 v0, s[12:15], s85 offen offset:2048 lds
M v[68:71],a[88:91],a[184:187],v[68:71]
SA s85,s38,47104
T a[120:121],v23,57344
T a[122:123],v23,59392
M v[68:71],a[84:87],a[180:183],v[68:71]
T a[124:125],v23,61440
T a[126:127],v23,63488
M v[68:71],a[80:83],a[176:179],v[68:71]
buffer_load_dwordx4 v0, s[12:15], s85 offen offset:3072 lds
M v[68:71],a[76:79],a[172:175],v[68:71]
SA s38,s38,128
G v5,a192
G v6,a193
M v[68:71],a[72:75],a[168:171],v[68:71]
s_sub_u32 s64, 15, s42
M v[68:71],a[68:71],a[164:167],v[68:71]
s_min_u32 s64, s64, s42
M v[68:71],a[64:67],a[160:163],v[68:71]
s_waitcnt lgkmcnt(0)
M v[72:75],a[96:99],a[128:131],0
s_mul_i32 s45, s64, 8704
T a[64:65],v24,32768
T a[66:67],v24,34816
M v[72:75],a[100:103],a[132:135],v[72:75]
s_lshl_b32 s64, s41, 2
T a[68:69],v24,36864
T a[70:71],v24,38912
M v[72:75],a[104:107],a[136:139],v[72:75]
SA s45,s45,s64
M v[72:75],a[108:111],a[140:143],v[72:75]
s_lshl_b32 s64, s20, 8
T a[72:73],v24,40960
T a[74:75],v24,43008
M v[72:75],a[112:115],a[144:147],v[72:75]
SA s45,s45,s64
T a[76:77],v24,45056
T a[78:79],v24,47104
M v[72:75],a[116:119],a[148:151],v[72:75]
SA s45,s45,104992768
M v[72:75],a[120:123],a[152:155],v[72:75]
s_mov_b32 s64, 1024
T a[80:81],v24,49152
T a[82:83],v24,51200
M v[72:75],a[124:127],a[156:159],v[72:75]
s_mov_b32 s66, 4096
T a[84:85],v24,53248
T a[86:87],v24,55296
M v[76:79],a[124:127],a[188:191],0
s_cmp_lt_u32 s42, 8
M v[76:79],a[120:123],a[184:187],v[76:79]
s_cselect_b32 s64, 4352, s64
T a[88:89],v24,57344
T a[90:91],v24,59392
M v[76:79],a[116:119],a[180:183],v[76:79]
s_cselect_b32 s65, 0, 64
T a[92:93],v24,61440
T a[94:95],v24,63488
M v[76:79],a[112:115],a[176:179],v[76:79]
s_cselect_b32 s66, 536870912, s66
MF v64,v5,v64
MF v65,v5,v65
M v[76:79],a[108:111],a[172:175],v[76:79]
SA s3,s45,s64
MF v66,v5,v66
MF v67,v5,v67
M v[76:79],a[104:107],a[168:171],v[76:79]
SA s45,s45,s65
v_lshrrev_b32 v17, 5, v7
v_min_u32 v15, 1, v17
M v[76:79],a[100:103],a[164:167],v[76:79]
SA m0,s28,0
v_lshlrev_b32 v14, 3, v7
v_lshl_or_b32 v16, v15, 29, v14
M v[76:79],a[96:99],a[160:163],v[76:79]
s_waitcnt lgkmcnt(0)
v_cmp_eq_u32 vcc, 1, v17
v_add_u32 v14, s66, v14
M v[80:83],a[64:67],a[128:131],0
SA s85,s38,0
T a[96:97],v25,32768
T a[98:99],v25,34816
M v[80:83],a[68:71],a[132:135],v[80:83]
T a[100:101],v25,36864
T a[102:103],v25,38912
M v[80:83],a[72:75],a[136:139],v[80:83]
buffer_load_dwordx4 v0, s[12:15], s85 offen offset:0 lds
M v[80:83],a[76:79],a[140:143],v[80:83]
SA s85,s38,6144
T a[104:105],v25,40960
T a[106:107],v25,43008
M v[80:83],a[80:83],a[144:147],v[80:83]
T a[108:109],v25,45056
T a[110:111],v25,47104
M v[80:83],a[84:87],a[148:151],v[80:83]
buffer_load_dwordx4 v0, s[12:15], s85 offen offset:1024 lds
M v[80:83],a[88:91],a[152:155],v[80:83]
SA s85,s38,12288
T a[112:113],v25,49152
T a[114:115],v25,51200
M v[80:83],a[92:95],a[156:159],v[80:83]
T a[116:117],v25,53248
T a[118:119],v25,55296
M v[84:87],a[92:95],a[188:191],0
buffer_load_dwordx4 v0, s[12:15], s85 offen offset:2048 lds
M v[84:87],a[88:91],a[184:187],v[84:87]
SA s85,s38,18432
T a[120:121],v25,57344
T a[122:123],v25,59392
M v[84:87],a[84:87],a[180:183],v[84:87]
T a[124:125],v25,61440
T a[126:127],v25,63488
M v[84:87],a[80:83],a[176:179],v[84:87]
buffer_load_dwordx4 v0, s[12:15], s85 offen offset:3072 lds
M v[84:87],a[76:79],a[172:175],v[84:87]
SA m0,s28,4096
v_mov_b32 v15, 1
v_cndmask_b32 v17, v16, v14, vcc
M v[84:87],a[72:75],a[168:171],v[84:87]
SA s85,s38,28672
buffer_load_dwordx4 v0, s[12:15], s85 offen offset:0 lds
M v[84:87],a[68:71],a[164:167],v[84:87]
s_waitcnt vmcnt(5) lgkmcnt(0)
v_min_u32 v10, 1, v7
v_lshlrev_b32 v10, 29, v10
M v[84:87],a[64:67],a[160:163],v[84:87]
s_barrier
M v[88:91],a[96:99],a[128:131],0
SA s85,s38,34816
T a[64:65],v22,0
T a[66:67],v22,2048
M v[88:91],a[100:103],a[132:135],v[88:91]
T a[68:69],v22,4096
T a[70:71],v22,6144
M v[88:91],a[104:107],a[136:139],v[88:91]
buffer_load_dwordx4 v0, s[12:15], s85 offen offset:1024 lds
M v[88:91],a[108:111],a[140:143],v[88:91]
SA s85,s38,40960
T a[72:73],v22,8192
T a[74:75],v22,10240
M v[88:91],a[112:115],a[144:147],v[88:91]
T a[76:77],v22,12288
T a[78:79],v22,14336
M v[88:91],a[116:119],a[148:151],v[88:91]
buffer_load_dwordx4 v0, s[12:15], s85 offen offset:2048 lds
M v[88:91],a[120:123],a[152:155],v[88:91]
SA s85,s38,47104
T a[80:81],v22,16384
T a[82:83],v22,18432
M v[88:91],a[124:127],a[156:159],v[88:91]
T a[84:85],v22,20480
T a[86:87],v22,22528
M v[92:95],a[124:127],a[188:191],0
buffer_store_dword v15, v10, s[8:11], s47 offen sc1
M v[92:95],a[120:123],a[184:187],v[92:95]
s_nop 0
T a[88:89],v22,24576
T a[90:91],v22,26624
M v[92:95],a[116:119],a[180:183],v[92:95]
T a[92:93],v22,28672
T a[94:95],v22,30720
M v[92:95],a[112:115],a[176:179],v[92:95]
buffer_load_dwordx4 v0, s[12:15], s85 offen offset:3072 lds
M v[92:95],a[108:111],a[172:175],v[92:95]
SA s38,s38,128
MF v72,v5,v72
MF v73,v5,v73
M v[92:95],a[104:107],a[168:171],v[92:95]
SA m0,s28,131072
MF v74,v5,v74
MF v75,v5,v75
M v[92:95],a[100:103],a[164:167],v[92:95]
s_waitcnt lgkmcnt(0)
C v64,v64,v65
C v65,v66,v67
M v[92:95],a[96:99],a[160:163],v[92:95]
SA s85,s38,0
C v66,v72,v73
C v67,v74,v75
buffer_store_dwordx4 v[64:67], v7, s[8:11], s29 offen offset:0 sc1
buffer_load_dwordx4 v0, s[12:15], s85 offen offset:0 lds
v_add_u32 v40, 0x20000, v18
v_add_u32 v41, 0x20000, v19
v_add_u32 v42, 0x20000, v20
v_add_u32 v43, 0x20000, v21
SA s85,s38,6144
MF v68,v6,v68
MF v69,v6,v69
MF v70,v6,v70
MF v71,v6,v71
MF v76,v6,v76
MF v77,v6,v77
MF v78,v6,v78
MF v79,v6,v79
C v68,v68,v69
C v69,v70,v71
C v70,v76,v77
C v71,v78,v79
buffer_store_dwordx4 v[68:71], v7, s[8:11], s30 offen offset:0 sc1
buffer_load_dwordx4 v0, s[12:15], s85 offen offset:1024 lds
SA s85,s38,12288
buffer_load_dwordx4 v0, s[12:15], s85 offen offset:2048 lds
SA s85,s38,18432
buffer_load_dwordx4 v0, s[12:15], s85 offen offset:3072 lds
M v[96:99],a[64:67],a[128:131],0
s_nop 0
T a[96:97],v23,0
T a[98:99],v23,2048
M v[96:99],a[68:71],a[132:135],v[96:99]
SA m0,s28,135168
T a[100:101],v23,4096
T a[102:103],v23,6144
M v[96:99],a[72:75],a[136:139],v[96:99]
SA s85,s38,28672
buffer_load_dwordx4 v0, s[12:15], s85 offen offset:0 lds
M v[96:99],a[76:79],a[140:143],v[96:99]
SA s85,s38,34816
T a[104:105],v23,8192
T a[106:107],v23,10240
M v[96:99],a[80:83],a[144:147],v[96:99]
T a[108:109],v23,12288
T a[110:111],v23,14336
M v[96:99],a[84:87],a[148:151],v[96:99]
buffer_load_dwordx4 v0, s[12:15], s85 offen offset:1024 lds
M v[96:99],a[88:91],a[152:155],v[96:99]
SA s85,s38,40960
T a[112:113],v23,16384
T a[114:115],v23,18432
M v[96:99],a[92:95],a[156:159],v[96:99]
T a[116:117],v23,20480
T a[118:119],v23,22528
M v[100:103],a[92:95],a[188:191],0
buffer_load_dwordx4 v0, s[12:15], s85 offen offset:2048 lds
M v[100:103],a[88:91],a[184:187],v[100:103]
SA s85,s38,47104
T a[120:121],v23,24576
T a[122:123],v23,26624
M v[100:103],a[84:87],a[180:183],v[100:103]
T a[124:125],v23,28672
T a[126:127],v23,30720
M v[100:103],a[80:83],a[176:179],v[100:103]
buffer_load_dwordx4 v0, s[12:15], s85 offen offset:3072 lds
M v[100:103],a[76:79],a[172:175],v[100:103]
SA s38,s38,128
MF v80,v5,v80
MF v81,v5,v81
M v[100:103],a[72:75],a[168:171],v[100:103]
SA m0,s28,32768
MF v82,v5,v82
MF v83,v5,v83
M v[100:103],a[68:71],a[164:167],v[100:103]
SA s85,s38,0
buffer_load_dwordx4 v0, s[12:15], s85 offen offset:0 lds
M v[100:103],a[64:67],a[160:163],v[100:103]
s_waitcnt lgkmcnt(0)
MF v88,v5,v88
MF v89,v5,v89
M v[104:107],a[96:99],a[128:131],0
SA s85,s38,6144
T a[64:65],v24,0
T a[66:67],v24,2048
M v[104:107],a[100:103],a[132:135],v[104:107]
T a[68:69],v24,4096
T a[70:71],v24,6144
M v[104:107],a[104:107],a[136:139],v[104:107]
buffer_load_dwordx4 v0, s[12:15], s85 offen offset:1024 lds
M v[104:107],a[108:111],a[140:143],v[104:107]
SA s85,s38,12288
T a[72:73],v24,8192
T a[74:75],v24,10240
M v[104:107],a[112:115],a[144:147],v[104:107]
T a[76:77],v24,12288
T a[78:79],v24,14336
M v[104:107],a[116:119],a[148:151],v[104:107]
buffer_load_dwordx4 v0, s[12:15], s85 offen offset:2048 lds
M v[104:107],a[120:123],a[152:155],v[104:107]
SA s85,s38,18432
T a[80:81],v24,16384
T a[82:83],v24,18432
M v[104:107],a[124:127],a[156:159],v[104:107]
T a[84:85],v24,20480
T a[86:87],v24,22528
M v[108:111],a[124:127],a[188:191],0
buffer_load_dwordx4 v0, s[12:15], s85 offen offset:3072 lds
M v[108:111],a[120:123],a[184:187],v[108:111]
SA m0,s28,36864
T a[88:89],v24,24576
T a[90:91],v24,26624
M v[108:111],a[116:119],a[180:183],v[108:111]
SA s85,s38,28672
T a[92:93],v24,28672
T a[94:95],v24,30720
M v[108:111],a[112:115],a[176:179],v[108:111]
buffer_load_dwordx4 v0, s[12:15], s85 offen offset:0 lds
M v[108:111],a[108:111],a[172:175],v[108:111]
SA s85,s38,34816
MF v90,v5,v90
MF v91,v5,v91
M v[108:111],a[104:107],a[168:171],v[108:111]
C v80,v80,v81
C v81,v82,v83
M v[108:111],a[100:103],a[164:167],v[108:111]
buffer_load_dwordx4 v0, s[12:15], s85 offen offset:1024 lds
M v[108:111],a[96:99],a[160:163],v[108:111]
s_waitcnt lgkmcnt(0)
C v82,v88,v89
C v83,v90,v91
M v[112:115],a[64:67],a[128:131],0
SA s85,s38,40960
T a[96:97],v25,0
T a[98:99],v25,2048
M v[112:115],a[68:71],a[132:135],v[112:115]
T a[100:101],v25,4096
T a[102:103],v25,6144
M v[112:115],a[72:75],a[136:139],v[112:115]
buffer_store_dwordx4 v[80:83], v7, s[8:11], s29 offen offset:1024 sc1
M v[112:115],a[76:79],a[140:143],v[112:115]
s_nop 0
T a[104:105],v25,8192
T a[106:107],v25,10240
M v[112:115],a[80:83],a[144:147],v[112:115]
T a[108:109],v25,12288
T a[110:111],v25,14336
M v[112:115],a[84:87],a[148:151],v[112:115]
buffer_load_dwordx4 v0, s[12:15], s85 offen offset:2048 lds
M v[112:115],a[88:91],a[152:155],v[112:115]
SA s85,s38,47104
T a[112:113],v25,16384
T a[114:115],v25,18432
M v[112:115],a[92:95],a[156:159],v[112:115]
T a[116:117],v25,20480
T a[118:119],v25,22528
M v[116:119],a[92:95],a[188:191],0
buffer_load_dwordx4 v0, s[12:15], s85 offen offset:3072 lds
M v[116:119],a[88:91],a[184:187],v[116:119]
SA s38,s38,128
T a[120:121],v25,24576
T a[122:123],v25,26624
M v[116:119],a[84:87],a[180:183],v[116:119]
SA m0,s28,98304
T a[124:125],v25,28672
T a[126:127],v25,30720
M v[116:119],a[80:83],a[176:179],v[116:119]
SA s85,s38,0
buffer_load_dwordx4 v0, s[12:15], s85 offen offset:0 lds
M v[116:119],a[76:79],a[172:175],v[116:119]
SA s85,s38,6144
MF v84,v6,v84
MF v85,v6,v85
M v[116:119],a[72:75],a[168:171],v[116:119]
buffer_load_dwordx4 v0, s[12:15], s85 offen offset:1024 lds
M v[116:119],a[68:71],a[164:167],v[116:119]
s_waitcnt vmcnt(21) lgkmcnt(0)
MF v86,v6,v86
MF v87,v6,v87
M v[116:119],a[64:67],a[160:163],v[116:119]
s_barrier
M v[120:123],a[96:99],a[128:131],0
SA s85,s38,12288
T a[64:65],v18,0
T a[66:67],v18,2048
M v[120:123],a[100:103],a[132:135],v[120:123]
T a[68:69],v18,4096
T a[70:71],v18,6144
M v[120:123],a[104:107],a[136:139],v[120:123]
buffer_load_dwordx4 v0, s[12:15], s85 offen offset:2048 lds
M v[120:123],a[108:111],a[140:143],v[120:123]
SA s85,s38,18432
T a[72:73],v18,8192
T a[74:75],v18,10240
M v[120:123],a[112:115],a[144:147],v[120:123]
T a[76:77],v18,12288
T a[78:79],v18,14336
M v[120:123],a[116:119],a[148:151],v[120:123]
buffer_load_dwordx4 v0, s[12:15], s85 offen offset:3072 lds
M v[120:123],a[120:123],a[152:155],v[120:123]
s_nop 0
T a[80:81],v18,16384
T a[82:83],v18,18432
M v[120:123],a[124:127],a[156:159],v[120:123]
T a[84:85],v18,20480
T a[86:87],v18,22528
M v[124:127],a[124:127],a[188:191],0
MF v92,v6,v92
MF v93,v6,v93
M v[124:127],a[120:123],a[184:187],v[124:127]
T a[88:89],v18,24576
T a[90:91],v18,26624
M v[124:127],a[116:119],a[180:183],v[124:127]
T a[92:93],v18,28672
T a[94:95],v18,30720
M v[124:127],a[112:115],a[176:179],v[124:127]
MF v94,v6,v94
MF v95,v6,v95
M v[124:127],a[108:111],a[172:175],v[124:127]
C v84,v84,v85
C v85,v86,v87
M v[124:127],a[104:107],a[168:171],v[124:127]
C v86,v92,v93
C v87,v94,v95
M v[124:127],a[100:103],a[164:167],v[124:127]
s_waitcnt lgkmcnt(0)
buffer_store_dwordx4 v[84:87], v7, s[8:11], s30 offen offset:1024 sc1
M v[124:127],a[96:99],a[160:163],v[124:127]
SA s29,s33,2048
SA s30,s33,16384
MF v96,v5,v96
MF v97,v5,v97
MF v98,v5,v98
MF v99,v5,v99
MF v104,v5,v104
MF v105,v5,v105
MF v106,v5,v106
MF v107,v5,v107
C v96,v96,v97
C v97,v98,v99
C v98,v104,v105
C v99,v106,v107
buffer_store_dwordx4 v[96:99], v7, s[8:11], s29 offen offset:0 sc1
MF v100,v6,v100
MF v101,v6,v101
MF v102,v6,v102
MF v103,v6,v103
MF v108,v6,v108
MF v109,v6,v109
MF v110,v6,v110
MF v111,v6,v111
C v100,v100,v101
C v101,v102,v103
C v102,v108,v109
C v103,v110,v111
buffer_store_dwordx4 v[100:103], v7, s[8:11], s30 offen offset:0 sc1
M v[64:67],a[64:67],a[128:131],0
s_nop 0
T a[96:97],v19,0
T a[98:99],v19,2048
M v[64:67],a[68:71],a[132:135],v[64:67]
SA m0,s28,102400
T a[100:101],v19,4096
T a[102:103],v19,6144
M v[64:67],a[72:75],a[136:139],v[64:67]
SA s85,s38,28672
buffer_load_dwordx4 v0, s[12:15], s85 offen offset:0 lds
M v[64:67],a[76:79],a[140:143],v[64:67]
SA s85,s38,34816
T a[104:105],v19,8192
T a[106:107],v19,10240
M v[64:67],a[80:83],a[144:147],v[64:67]
T a[108:109],v19,12288
T a[110:111],v19,14336
M v[64:67],a[84:87],a[148:151],v[64:67]
buffer_load_dwordx4 v0, s[12:15], s85 offen offset:1024 lds
M v[64:67],a[88:91],a[152:155],v[64:67]
s_nop 0
T a[112:113],v19,16384
T a[114:115],v19,18432
M v[64:67],a[92:95],a[156:159],v[64:67]
SA s85,s38,40960
T a[116:117],v19,20480
T a[118:119],v19,22528
M v[68:71],a[92:95],a[188:191],0
buffer_load_dwordx4 v0, s[12:15], s85 offen offset:2048 lds
M v[68:71],a[88:91],a[184:187],v[68:71]
s_nop 0
T a[120:121],v19,24576
T a[122:123],v19,26624
M v[68:71],a[84:87],a[180:183],v[68:71]
T a[124:125],v19,28672
T a[126:127],v19,30720
M v[68:71],a[80:83],a[176:179],v[68:71]
SA s85,s38,47104
MF v112,v5,v112
MF v113,v5,v113
M v[68:71],a[76:79],a[172:175],v[68:71]
buffer_load_dwordx4 v0, s[12:15], s85 offen offset:3072 lds
M v[68:71],a[72:75],a[168:171],v[68:71]
SA s38,s38,128
MF v114,v5,v114
MF v115,v5,v115
M v[68:71],a[68:71],a[164:167],v[68:71]
SA m0,s28,65536
MF v120,v5,v120
MF v121,v5,v121
M v[68:71],a[64:67],a[160:163],v[68:71]
s_waitcnt lgkmcnt(0)
MF v122,v5,v122
MF v123,v5,v123
M v[72:75],a[96:99],a[128:131],0
SA s85,s38,0
T a[64:65],v20,0
T a[66:67],v20,2048
M v[72:75],a[100:103],a[132:135],v[72:75]
T a[68:69],v20,4096
T a[70:71],v20,6144
M v[72:75],a[104:107],a[136:139],v[72:75]
buffer_load_dwordx4 v0, s[12:15], s85 offen offset:0 lds
M v[72:75],a[108:111],a[140:143],v[72:75]
SA s85,s38,6144
T a[72:73],v20,8192
T a[74:75],v20,10240
M v[72:75],a[112:115],a[144:147],v[72:75]
T a[76:77],v20,12288
T a[78:79],v20,14336
M v[72:75],a[116:119],a[148:151],v[72:75]
buffer_load_dwordx4 v0, s[12:15], s85 offen offset:1024 lds
M v[72:75],a[120:123],a[152:155],v[72:75]
SA s85,s38,12288
T a[80:81],v20,16384
T a[82:83],v20,18432
M v[72:75],a[124:127],a[156:159],v[72:75]
T a[84:85],v20,20480
T a[86:87],v20,22528
M v[76:79],a[124:127],a[188:191],0
buffer_load_dwordx4 v0, s[12:15], s85 offen offset:2048 lds
M v[76:79],a[120:123],a[184:187],v[76:79]
SA s85,s38,18432
T a[88:89],v20,24576
T a[90:91],v20,26624
M v[76:79],a[116:119],a[180:183],v[76:79]
T a[92:93],v20,28672
T a[94:95],v20,30720
M v[76:79],a[112:115],a[176:179],v[76:79]
buffer_load_dwordx4 v0, s[12:15], s85 offen offset:3072 lds
M v[76:79],a[108:111],a[172:175],v[76:79]
SA m0,s28,69632
C v112,v112,v113
C v113,v114,v115
M v[76:79],a[104:107],a[168:171],v[76:79]
SA s85,s38,28672
C v114,v120,v121
C v115,v122,v123
M v[76:79],a[100:103],a[164:167],v[76:79]
buffer_store_dwordx4 v[112:115], v7, s[8:11], s29 offen offset:1024 sc1
M v[76:79],a[96:99],a[160:163],v[76:79]
s_waitcnt lgkmcnt(0)
MF v116,v6,v116
MF v117,v6,v117
M v[80:83],a[64:67],a[128:131],0
T a[96:97],v21,0
T a[98:99],v21,2048
M v[80:83],a[68:71],a[132:135],v[80:83]
T a[100:101],v21,4096
T a[102:103],v21,6144
M v[80:83],a[72:75],a[136:139],v[80:83]
buffer_load_dwordx4 v0, s[12:15], s85 offen offset:0 lds
M v[80:83],a[76:79],a[140:143],v[80:83]
SA s85,s38,34816
T a[104:105],v21,8192
T a[106:107],v21,10240
M v[80:83],a[80:83],a[144:147],v[80:83]
T a[108:109],v21,12288
T a[110:111],v21,14336
M v[80:83],a[84:87],a[148:151],v[80:83]
buffer_load_dwordx4 v0, s[12:15], s85 offen offset:1024 lds
M v[80:83],a[88:91],a[152:155],v[80:83]
SA s85,s38,40960
T a[112:113],v21,16384
T a[114:115],v21,18432
M v[80:83],a[92:95],a[156:159],v[80:83]
T a[116:117],v21,20480
T a[118:119],v21,22528
M v[84:87],a[92:95],a[188:191],0
buffer_load_dwordx4 v0, s[12:15], s85 offen offset:2048 lds
M v[84:87],a[88:91],a[184:187],v[84:87]
SA s85,s38,47104
T a[120:121],v21,24576
T a[122:123],v21,26624
M v[84:87],a[84:87],a[180:183],v[84:87]
T a[124:125],v21,28672
T a[126:127],v21,30720
M v[84:87],a[80:83],a[176:179],v[84:87]
buffer_load_dwordx4 v0, s[12:15], s85 offen offset:3072 lds
M v[84:87],a[76:79],a[172:175],v[84:87]
MF v118,v6,v118
MF v119,v6,v119
M v[84:87],a[72:75],a[168:171],v[84:87]
SA s38,s38,128
MF v124,v6,v124
MF v125,v6,v125
M v[84:87],a[68:71],a[164:167],v[84:87]
s_waitcnt vmcnt(29) lgkmcnt(0)
MF v126,v6,v126
MF v127,v6,v127
M v[84:87],a[64:67],a[160:163],v[84:87]
s_barrier
M v[88:91],a[96:99],a[128:131],0
s_nop 0
T a[64:65],v40,0
T a[66:67],v40,2048
M v[88:91],a[100:103],a[132:135],v[88:91]
T a[68:69],v40,4096
T a[70:71],v40,6144
M v[88:91],a[104:107],a[136:139],v[88:91]
C v116,v116,v117
C v117,v118,v119
M v[88:91],a[108:111],a[140:143],v[88:91]
T a[72:73],v40,8192
T a[74:75],v40,10240
M v[88:91],a[112:115],a[144:147],v[88:91]
T a[76:77],v40,12288
T a[78:79],v40,14336
M v[88:91],a[116:119],a[148:151],v[88:91]
C v118,v124,v125
C v119,v126,v127
M v[88:91],a[120:123],a[152:155],v[88:91]
T a[80:81],v40,16384
T a[82:83],v40,18432
M v[88:91],a[124:127],a[156:159],v[88:91]
T a[84:85],v40,20480
T a[86:87],v40,22528
M v[92:95],a[124:127],a[188:191],0
buffer_store_dwordx4 v[116:119], v7, s[8:11], s30 offen offset:1024 sc1
M v[92:95],a[120:123],a[184:187],v[92:95]
SA s29,s33,4096
T a[88:89],v40,24576
T a[90:91],v40,26624
M v[92:95],a[116:119],a[180:183],v[92:95]
SA s30,s33,18432
T a[92:93],v40,28672
T a[94:95],v40,30720
M v[92:95],a[112:115],a[176:179],v[92:95]
MF v64,v5,v64
MF v65,v5,v65
M v[92:95],a[108:111],a[172:175],v[92:95]
MF v66,v5,v66
MF v67,v5,v67
M v[92:95],a[104:107],a[168:171],v[92:95]
MF v72,v5,v72
MF v73,v5,v73
M v[92:95],a[100:103],a[164:167],v[92:95]
s_waitcnt lgkmcnt(0)
MF v74,v5,v74
MF v75,v5,v75
M v[92:95],a[96:99],a[160:163],v[92:95]
C v64,v64,v65
C v65,v66,v67
C v66,v72,v73
C v67,v74,v75
buffer_store_dwordx4 v[64:67], v7, s[8:11], s29 offen offset:0 sc1
MF v68,v6,v68
MF v69,v6,v69
MF v70,v6,v70
MF v71,v6,v71
MF v76,v6,v76
MF v77,v6,v77
MF v78,v6,v78
MF v79,v6,v79
C v68,v68,v69
C v69,v70,v71
C v70,v76,v77
C v71,v78,v79
buffer_store_dwordx4 v[68:71], v7, s[8:11], s30 offen offset:0 sc1
M v[96:99],a[64:67],a[128:131],0
s_nop 0
T a[96:97],v41,0
T a[98:99],v41,2048
M v[96:99],a[68:71],a[132:135],v[96:99]
T a[100:101],v41,4096
T a[102:103],v41,6144
M v[96:99],a[72:75],a[136:139],v[96:99]
MF v80,v5,v80
MF v81,v5,v81
M v[96:99],a[76:79],a[140:143],v[96:99]
T a[104:105],v41,8192
T a[106:107],v41,10240
M v[96:99],a[80:83],a[144:147],v[96:99]
T a[108:109],v41,12288
T a[110:111],v41,14336
M v[96:99],a[84:87],a[148:151],v[96:99]
MF v82,v5,v82
MF v83,v5,v83
M v[96:99],a[88:91],a[152:155],v[96:99]
T a[112:113],v41,16384
T a[114:115],v41,18432
M v[96:99],a[92:95],a[156:159],v[96:99]
T a[116:117],v41,20480
T a[118:119],v41,22528
M v[100:103],a[92:95],a[188:191],0
MF v88,v5,v88
MF v89,v5,v89
M v[100:103],a[88:91],a[184:187],v[100:103]
T a[120:121],v41,24576
T a[122:123],v41,26624
M v[100:103],a[84:87],a[180:183],v[100:103]
T a[124:125],v41,28672
T a[126:127],v41,30720
M v[100:103],a[80:83],a[176:179],v[100:103]
MF v90,v5,v90
MF v91,v5,v91
M v[100:103],a[76:79],a[172:175],v[100:103]
C v80,v80,v81
C v81,v82,v83
M v[100:103],a[72:75],a[168:171],v[100:103]
C v82,v88,v89
C v83,v90,v91
M v[100:103],a[68:71],a[164:167],v[100:103]
buffer_store_dwordx4 v[80:83], v7, s[8:11], s29 offen offset:1024 sc1
M v[100:103],a[64:67],a[160:163],v[100:103]
s_waitcnt lgkmcnt(0)
MF v84,v6,v84
MF v85,v6,v85
M v[104:107],a[96:99],a[128:131],0
T a[64:65],v42,0
T a[66:67],v42,2048
M v[104:107],a[100:103],a[132:135],v[104:107]
T a[68:69],v42,4096
T a[70:71],v42,6144
M v[104:107],a[104:107],a[136:139],v[104:107]
MF v86,v6,v86
MF v87,v6,v87
M v[104:107],a[108:111],a[140:143],v[104:107]
T a[72:73],v42,8192
T a[74:75],v42,10240
M v[104:107],a[112:115],a[144:147],v[104:107]
T a[76:77],v42,12288
T a[78:79],v42,14336
M v[104:107],a[116:119],a[148:151],v[104:107]
MF v92,v6,v92
MF v93,v6,v93
M v[104:107],a[120:123],a[152:155],v[104:107]
T a[80:81],v42,16384
T a[82:83],v42,18432
M v[104:107],a[124:127],a[156:159],v[104:107]
T a[84:85],v42,20480
T a[86:87],v42,22528
M v[108:111],a[124:127],a[188:191],0
MF v94,v6,v94
MF v95,v6,v95
M v[108:111],a[120:123],a[184:187],v[108:111]
T a[88:89],v42,24576
T a[90:91],v42,26624
M v[108:111],a[116:119],a[180:183],v[108:111]
T a[92:93],v42,28672
T a[94:95],v42,30720
M v[108:111],a[112:115],a[176:179],v[108:111]
C v84,v84,v85
C v85,v86,v87
M v[108:111],a[108:111],a[172:175],v[108:111]
C v86,v92,v93
C v87,v94,v95
M v[108:111],a[104:107],a[168:171],v[108:111]
buffer_store_dwordx4 v[84:87], v7, s[8:11], s30 offen offset:1024 sc1
M v[108:111],a[100:103],a[164:167],v[108:111]
SA s29,s33,6144
M v[108:111],a[96:99],a[160:163],v[108:111]
s_waitcnt lgkmcnt(0)
M v[112:115],a[64:67],a[128:131],0
SA s30,s33,20480
T a[96:97],v43,0
T a[98:99],v43,2048
M v[112:115],a[68:71],a[132:135],v[112:115]
T a[100:101],v43,4096
T a[102:103],v43,6144
M v[112:115],a[72:75],a[136:139],v[112:115]
MF v96,v5,v96
MF v97,v5,v97
M v[112:115],a[76:79],a[140:143],v[112:115]
T a[104:105],v43,8192
T a[106:107],v43,10240
M v[112:115],a[80:83],a[144:147],v[112:115]
T a[108:109],v43,12288
T a[110:111],v43,14336
M v[112:115],a[84:87],a[148:151],v[112:115]
MF v98,v5,v98
MF v99,v5,v99
M v[112:115],a[88:91],a[152:155],v[112:115]
T a[112:113],v43,16384
T a[114:115],v43,18432
M v[112:115],a[92:95],a[156:159],v[112:115]
T a[116:117],v43,20480
T a[118:119],v43,22528
M v[116:119],a[92:95],a[188:191],0
MF v104,v5,v104
MF v105,v5,v105
M v[116:119],a[88:91],a[184:187],v[116:119]
T a[120:121],v43,24576
T a[122:123],v43,26624
M v[116:119],a[84:87],a[180:183],v[116:119]
T a[124:125],v43,28672
T a[126:127],v43,30720
M v[116:119],a[80:83],a[176:179],v[116:119]
MF v106,v5,v106
MF v107,v5,v107
M v[116:119],a[76:79],a[172:175],v[116:119]
C v96,v96,v97
C v97,v98,v99
M v[116:119],a[72:75],a[168:171],v[116:119]
C v98,v104,v105
C v99,v106,v107
M v[116:119],a[68:71],a[164:167],v[116:119]
s_waitcnt vmcnt(25) lgkmcnt(0)
buffer_store_dwordx4 v[96:99], v7, s[8:11], s29 offen offset:0 sc1
M v[116:119],a[64:67],a[160:163],v[116:119]
s_barrier
M v[120:123],a[96:99],a[128:131],0
s_nop 0
T a[64:65],v18,32768
T a[66:67],v18,34816
M v[120:123],a[100:103],a[132:135],v[120:123]
T a[68:69],v18,36864
T a[70:71],v18,38912
M v[120:123],a[104:107],a[136:139],v[120:123]
MF v100,v6,v100
MF v101,v6,v101
M v[120:123],a[108:111],a[140:143],v[120:123]
T a[72:73],v18,40960
T a[74:75],v18,43008
M v[120:123],a[112:115],a[144:147],v[120:123]
T a[76:77],v18,45056
T a[78:79],v18,47104
M v[120:123],a[116:119],a[148:151],v[120:123]
MF v102,v6,v102
MF v103,v6,v103
M v[120:123],a[120:123],a[152:155],v[120:123]
T a[80:81],v18,49152
T a[82:83],v18,51200
M v[120:123],a[124:127],a[156:159],v[120:123]
T a[84:85],v18,53248
T a[86:87],v18,55296
M v[124:127],a[124:127],a[188:191],0
MF v108,v6,v108
MF v109,v6,v109
M v[124:127],a[120:123],a[184:187],v[124:127]
T a[88:89],v18,57344
T a[90:91],v18,59392
M v[124:127],a[116:119],a[180:183],v[124:127]
T a[92:93],v18,61440
T a[94:95],v18,63488
M v[124:127],a[112:115],a[176:179],v[124:127]
MF v110,v6,v110
MF v111,v6,v111
M v[124:127],a[108:111],a[172:175],v[124:127]
C v100,v100,v101
C v101,v102,v103
M v[124:127],a[104:107],a[168:171],v[124:127]
C v102,v108,v109
C v103,v110,v111
M v[124:127],a[100:103],a[164:167],v[124:127]
s_waitcnt lgkmcnt(0)
buffer_store_dwordx4 v[100:103], v7, s[8:11], s30 offen offset:0 sc1
M v[124:127],a[96:99],a[160:163],v[124:127]
M v[64:67],a[64:67],a[128:131],0
s_nop 0
T a[96:97],v19,32768
T a[98:99],v19,34816
M v[64:67],a[68:71],a[132:135],v[64:67]
T a[100:101],v19,36864
T a[102:103],v19,38912
M v[64:67],a[72:75],a[136:139],v[64:67]
v_lshrrev_b32 v32, 4, v7
MF v112,v5,v112
M v[64:67],a[76:79],a[140:143],v[64:67]
s_lshr_b32 s74, s41, 3
T a[104:105],v19,40960
T a[106:107],v19,43008
M v[64:67],a[80:83],a[144:147],v[64:67]
s_lshl_b32 s64, s42, 1
T a[108:109],v19,45056
T a[110:111],v19,47104
M v[64:67],a[84:87],a[148:151],v[64:67]
SA s46,s64,s74
MF v113,v5,v113
MF v114,v5,v114
M v[64:67],a[88:91],a[152:155],v[64:67]
s_mul_i32 s46, s46, 4352
T a[112:113],v19,49152
T a[114:115],v19,51200
M v[64:67],a[92:95],a[156:159],v[64:67]
s_and_b32 s72, s41, 7
T a[116:117],v19,53248
T a[118:119],v19,55296
M v[68:71],a[92:95],a[188:191],0
s_lshl_b32 s65, s72, 7
MF v115,v5,v115
MF v120,v5,v120
M v[68:71],a[88:91],a[184:187],v[68:71]
SA s46,s46,s65
T a[120:121],v19,57344
T a[122:123],v19,59392
M v[68:71],a[84:87],a[180:183],v[68:71]
SA s46,s46,104992768
T a[124:125],v19,61440
T a[126:127],v19,63488
M v[68:71],a[80:83],a[176:179],v[68:71]
v_and_b32 v33, 31, v32
MF v121,v5,v121
M v[68:71],a[76:79],a[172:175],v[68:71]
MF v122,v5,v122
MF v123,v5,v123
M v[68:71],a[72:75],a[168:171],v[68:71]
C v112,v112,v113
C v113,v114,v115
M v[68:71],a[68:71],a[164:167],v[68:71]
C v114,v120,v121
C v115,v122,v123
M v[68:71],a[64:67],a[160:163],v[68:71]
s_waitcnt lgkmcnt(0)
buffer_store_dwordx4 v[112:115], v7, s[8:11], s29 offen offset:1024 sc1
M v[72:75],a[96:99],a[128:131],0
s_nop 0
T a[64:65],v20,32768
T a[66:67],v20,34816
M v[72:75],a[100:103],a[132:135],v[72:75]
T a[68:69],v20,36864
T a[70:71],v20,38912
M v[72:75],a[104:107],a[136:139],v[72:75]
MF v116,v6,v116
MF v117,v6,v117
M v[72:75],a[108:111],a[140:143],v[72:75]
T a[72:73],v20,40960
T a[74:75],v20,43008
M v[72:75],a[112:115],a[144:147],v[72:75]
T a[76:77],v20,45056
T a[78:79],v20,47104
M v[72:75],a[116:119],a[148:151],v[72:75]
MF v118,v6,v118
MF v119,v6,v119
M v[72:75],a[120:123],a[152:155],v[72:75]
T a[80:81],v20,49152
T a[82:83],v20,51200
M v[72:75],a[124:127],a[156:159],v[72:75]
T a[84:85],v20,53248
T a[86:87],v20,55296
M v[76:79],a[124:127],a[188:191],0
MF v124,v6,v124
MF v125,v6,v125
M v[76:79],a[120:123],a[184:187],v[76:79]
T a[88:89],v20,57344
T a[90:91],v20,59392
M v[76:79],a[116:119],a[180:183],v[76:79]
T a[92:93],v20,61440
T a[94:95],v20,63488
M v[76:79],a[112:115],a[176:179],v[76:79]
MF v126,v6,v126
MF v127,v6,v127
M v[76:79],a[108:111],a[172:175],v[76:79]
C v116,v116,v117
C v117,v118,v119
M v[76:79],a[104:107],a[168:171],v[76:79]
C v118,v124,v125
C v119,v126,v127
M v[76:79],a[100:103],a[164:167],v[76:79]
buffer_store_dwordx4 v[116:119], v7, s[8:11], s30 offen offset:1024 sc1
M v[76:79],a[96:99],a[160:163],v[76:79]
s_waitcnt lgkmcnt(0)
v_lshlrev_b32 v33, 2, v33
M v[80:83],a[64:67],a[128:131],0
SA s29,s33,8192
T a[96:97],v21,32768
T a[98:99],v21,34816
M v[80:83],a[68:71],a[132:135],v[80:83]
SA s30,s33,22528
T a[100:101],v21,36864
T a[102:103],v21,38912
M v[80:83],a[72:75],a[136:139],v[80:83]
s_lshl_b32 s65, s41, 7
MF v64,v5,v64
MF v65,v5,v65
M v[80:83],a[76:79],a[140:143],v[80:83]
SA s65,s65,104890368
T a[104:105],v21,40960
T a[106:107],v21,43008
M v[80:83],a[80:83],a[144:147],v[80:83]
T a[108:109],v21,45056
T a[110:111],v21,47104
M v[80:83],a[84:87],a[148:151],v[80:83]
buffer_load_dword v31, v33, s[8:11], s65 offen sc1
M v[80:83],a[88:91],a[152:155],v[80:83]
s_nop 0
T a[112:113],v21,49152
T a[114:115],v21,51200
M v[80:83],a[92:95],a[156:159],v[80:83]
T a[116:117],v21,53248
T a[118:119],v21,55296
M v[84:87],a[92:95],a[188:191],0
v_bfe_u32 v34, v32, 4, 1
v_lshlrev_b32 v34, 1, v34
M v[84:87],a[88:91],a[184:187],v[84:87]
T a[120:121],v21,57344
T a[122:123],v21,59392
M v[84:87],a[84:87],a[180:183],v[84:87]
T a[124:125],v21,61440
T a[126:127],v21,63488
M v[84:87],a[80:83],a[176:179],v[84:87]
v_lshrrev_b32 v35, 5, v32
v_add_u32 v34, v34, v35
M v[84:87],a[76:79],a[172:175],v[84:87]
s_mov_b32 s52, s96
MF v66,v5,v66
MF v67,v5,v67
M v[84:87],a[72:75],a[168:171],v[84:87]
s_and_b32 s53, s97, 0xffff
MF v72,v5,v72
MF v73,v5,v73
M v[84:87],a[68:71],a[164:167],v[84:87]
s_waitcnt vmcnt(19) lgkmcnt(0)
MF v74,v5,v74
MF v75,v5,v75
M v[84:87],a[64:67],a[160:163],v[84:87]
s_barrier
M v[88:91],a[96:99],a[128:131],0
s_mov_b32 s54, 1835008
T a[64:65],v22,32768
T a[66:67],v22,34816
M v[88:91],a[100:103],a[132:135],v[88:91]
s_mov_b32 s55, 0x20000
T a[68:69],v22,36864
T a[70:71],v22,38912
M v[88:91],a[104:107],a[136:139],v[88:91]
s_mul_i32 s77, s42, 1835008
C v64,v64,v65
C v65,v66,v67
M v[88:91],a[108:111],a[140:143],v[88:91]
s_mul_i32 s78, s72, 14336
T a[72:73],v22,40960
T a[74:75],v22,43008
M v[88:91],a[112:115],a[144:147],v[88:91]
SA s77,s77,s78
T a[76:77],v22,45056
T a[78:79],v22,47104
M v[88:91],a[116:119],a[148:151],v[88:91]
SA s77,s77,67108864
C v66,v72,v73
C v67,v74,v75
M v[88:91],a[120:123],a[152:155],v[88:91]
s_lshl_b32 s79, s74, 1
T a[80:81],v22,49152
T a[82:83],v22,51200
M v[88:91],a[124:127],a[156:159],v[88:91]
SA s79,s79,s20
T a[84:85],v22,53248
T a[86:87],v22,55296
M v[92:95],a[124:127],a[188:191],0
s_lshl_b32 s71, s74, 1
buffer_store_dwordx4 v[64:67], v7, s[8:11], s29 offen offset:0 sc1
M v[92:95],a[120:123],a[184:187],v[92:95]
SA s71,s71,1
T a[88:89],v22,57344
T a[90:91],v22,59392
M v[92:95],a[116:119],a[180:183],v[92:95]
s_sub_u32 s71, s71, s20
T a[92:93],v22,61440
T a[94:95],v22,63488
M v[92:95],a[112:115],a[176:179],v[92:95]
s_and_b32 s71, s71, 536870912
MF v68,v6,v68
MF v69,v6,v69
M v[92:95],a[108:111],a[172:175],v[92:95]
s_sub_u32 s64, 15, s64
MF v70,v6,v70
MF v71,v6,v71
M v[92:95],a[104:107],a[168:171],v[92:95]
s_sub_u32 s78, s64, 1
MF v76,v6,v76
MF v77,v6,v77
M v[92:95],a[100:103],a[164:167],v[92:95]
s_waitcnt lgkmcnt(0)
MF v78,v6,v78
MF v79,v6,v79
M v[92:95],a[96:99],a[160:163],v[92:95]
s_mul_i32 s78, s78, 1835008
SA s78,s78,s77
s_lshl_b32 s65, s79, 10
SA s78,s78,s65
SA s78,s78,s71
s_lshl_b32 s79, s79, 6
s_or_b32 s79, s79, s71
s_mul_i32 s67, s74, -2
s_lshl_b32 s74, s74, 3
SA s74,s74,s20
s_lshl_b32 s75, s74, 6
SA s76,s75,256
SA s67,s67,3
s_sub_u32 s67, s67, s20
s_and_b32 s67, s67, 536870912
s_or_b32 s76, s76, s67
v_or_b32 v27, s67, v7
v_add_u32 v27, 4096, v27
s_lshl_b32 s65, s74, 10
SA s77,s77,s65
s_lshl_b32 s64, s64, 7
s_lshr_b32 s73, s72, 1
s_sub_u32 s65, 7, s73
s_bitcmp1_b32 s72, 0
s_cselect_b32 s73, s65, s73
s_lshl_b32 s73, s73, 4
s_lshl_b32 s65, s42, 7
SA s73,s73,s65
v_and_b32 v37, 15, v32
v_add_u32 v37, s73, v37
v_add_u32 v29, s64, v37
s_mov_b32 s64, 104857664
v_mul_u32_u24 v38, 896, v37
v_lshl_add_u32 v38, v34, 4, v38
v_lshrrev_b32 v35, 4, v37
v_lshlrev_b32 v35, 5, v35
v_and_b32 v36, 15, v37
v_add_lshl_u32 v35, v35, v36, 2
buffer_load_dword v39, v35, s[8:11], s64 offen sc1
C v68,v68,v69
C v69,v70,v71
C v70,v76,v77
C v71,v78,v79
buffer_store_dwordx4 v[68:71], v7, s[8:11], s30 offen offset:0 sc1
buffer_load_dwordx4 v[48:51], v38, s[56:59], s75 offen
buffer_load_dwordx4 v[52:55], v38, s[56:59], s76 offen
v_mul_u32_u24 v28, 896, v29
v_lshl_add_u32 v28, v34, 4, v28
v_lshrrev_b32 v35, 4, v29
v_lshlrev_b32 v35, 5, v35
v_and_b32 v36, 15, v29
v_add_lshl_u32 v35, v35, v36, 2
buffer_load_dword v26, v35, s[8:11], s64 offen sc1
buffer_load_dwordx4 v[44:47], v28, s[56:59], s79 offen
M v[96:99],a[64:67],a[128:131],0
s_nop 0
T a[96:97],v23,32768
T a[98:99],v23,34816
M v[96:99],a[68:71],a[132:135],v[96:99]
T a[100:101],v23,36864
T a[102:103],v23,38912
M v[96:99],a[72:75],a[136:139],v[96:99]
MF v80,v5,v80
MF v81,v5,v81
M v[96:99],a[76:79],a[140:143],v[96:99]
T a[104:105],v23,40960
T a[106:107],v23,43008
M v[96:99],a[80:83],a[144:147],v[96:99]
T a[108:109],v23,45056
T a[110:111],v23,47104
M v[96:99],a[84:87],a[148:151],v[96:99]
MF v82,v5,v82
MF v83,v5,v83
M v[96:99],a[88:91],a[152:155],v[96:99]
T a[112:113],v23,49152
T a[114:115],v23,51200
M v[96:99],a[92:95],a[156:159],v[96:99]
T a[116:117],v23,53248
T a[118:119],v23,55296
M v[100:103],a[92:95],a[188:191],0
MF v88,v5,v88
MF v89,v5,v89
M v[100:103],a[88:91],a[184:187],v[100:103]
T a[120:121],v23,57344
T a[122:123],v23,59392
M v[100:103],a[84:87],a[180:183],v[100:103]
T a[124:125],v23,61440
T a[126:127],v23,63488
M v[100:103],a[80:83],a[176:179],v[100:103]
MF v90,v5,v90
MF v91,v5,v91
M v[100:103],a[76:79],a[172:175],v[100:103]
C v80,v80,v81
C v81,v82,v83
M v[100:103],a[72:75],a[168:171],v[100:103]
C v82,v88,v89
C v83,v90,v91
M v[100:103],a[68:71],a[164:167],v[100:103]
buffer_store_dwordx4 v[80:83], v7, s[8:11], s29 offen offset:1024 sc1
M v[100:103],a[64:67],a[160:163],v[100:103]
s_waitcnt lgkmcnt(0)
MF v84,v6,v84
MF v85,v6,v85
M v[104:107],a[96:99],a[128:131],0
T a[64:65],v24,32768
T a[66:67],v24,34816
M v[104:107],a[100:103],a[132:135],v[104:107]
T a[68:69],v24,36864
T a[70:71],v24,38912
M v[104:107],a[104:107],a[136:139],v[104:107]
MF v86,v6,v86
MF v87,v6,v87
M v[104:107],a[108:111],a[140:143],v[104:107]
T a[72:73],v24,40960
T a[74:75],v24,43008
M v[104:107],a[112:115],a[144:147],v[104:107]
T a[76:77],v24,45056
T a[78:79],v24,47104
M v[104:107],a[116:119],a[148:151],v[104:107]
MF v92,v6,v92
MF v93,v6,v93
M v[104:107],a[120:123],a[152:155],v[104:107]
T a[80:81],v24,49152
T a[82:83],v24,51200
M v[104:107],a[124:127],a[156:159],v[104:107]
T a[84:85],v24,53248
T a[86:87],v24,55296
M v[108:111],a[124:127],a[188:191],0
MF v94,v6,v94
MF v95,v6,v95
M v[108:111],a[120:123],a[184:187],v[108:111]
T a[88:89],v24,57344
T a[90:91],v24,59392
M v[108:111],a[116:119],a[180:183],v[108:111]
T a[92:93],v24,61440
T a[94:95],v24,63488
M v[108:111],a[112:115],a[176:179],v[108:111]
C v84,v84,v85
C v85,v86,v87
M v[108:111],a[108:111],a[172:175],v[108:111]
C v86,v92,v93
C v87,v94,v95
M v[108:111],a[104:107],a[168:171],v[108:111]
buffer_store_dwordx4 v[84:87], v7, s[8:11], s30 offen offset:1024 sc1
M v[108:111],a[100:103],a[164:167],v[108:111]
SA s29,s33,10240
M v[108:111],a[96:99],a[160:163],v[108:111]
s_waitcnt lgkmcnt(0)
M v[112:115],a[64:67],a[128:131],0
SA s30,s33,24576
T a[96:97],v25,32768
T a[98:99],v25,34816
M v[112:115],a[68:71],a[132:135],v[112:115]
T a[100:101],v25,36864
T a[102:103],v25,38912
M v[112:115],a[72:75],a[136:139],v[112:115]
MF v96,v5,v96
MF v97,v5,v97
M v[112:115],a[76:79],a[140:143],v[112:115]
T a[104:105],v25,40960
T a[106:107],v25,43008
M v[112:115],a[80:83],a[144:147],v[112:115]
T a[108:109],v25,45056
T a[110:111],v25,47104
M v[112:115],a[84:87],a[148:151],v[112:115]
MF v98,v5,v98
MF v99,v5,v99
M v[112:115],a[88:91],a[152:155],v[112:115]
T a[112:113],v25,49152
T a[114:115],v25,51200
M v[112:115],a[92:95],a[156:159],v[112:115]
T a[116:117],v25,53248
T a[118:119],v25,55296
M v[116:119],a[92:95],a[188:191],0
s_mov_b32 s84, s45
MF v104,v5,v104
MF v105,v5,v105
M v[116:119],a[88:91],a[184:187],v[116:119]
T a[120:121],v25,57344
T a[122:123],v25,59392
M v[116:119],a[84:87],a[180:183],v[116:119]
T a[124:125],v25,61440
T a[126:127],v25,63488
M v[116:119],a[80:83],a[176:179],v[116:119]
MF v106,v5,v106
MF v107,v5,v107
M v[116:119],a[76:79],a[172:175],v[116:119]
C v96,v96,v97
C v97,v98,v99
M v[116:119],a[72:75],a[168:171],v[116:119]
C v98,v104,v105
C v99,v106,v107
M v[116:119],a[68:71],a[164:167],v[116:119]
s_waitcnt vmcnt(19) lgkmcnt(0)
buffer_store_dwordx4 v[96:99], v7, s[8:11], s29 offen offset:0 sc1
M v[116:119],a[64:67],a[160:163],v[116:119]
s_barrier
M v[120:123],a[96:99],a[128:131],0
s_nop 0
T a[64:65],v22,0
T a[66:67],v22,2048
M v[120:123],a[100:103],a[132:135],v[120:123]
T a[68:69],v22,4096
T a[70:71],v22,6144
M v[120:123],a[104:107],a[136:139],v[120:123]
MF v100,v6,v100
MF v101,v6,v101
M v[120:123],a[108:111],a[140:143],v[120:123]
T a[72:73],v22,8192
T a[74:75],v22,10240
M v[120:123],a[112:115],a[144:147],v[120:123]
s_waitcnt vmcnt(11)
T a[76:77],v22,12288
T a[78:79],v22,14336
M v[120:123],a[116:119],a[148:151],v[120:123]
buffer_store_dword v15, v17, s[8:11], s84 offen sc1
M v[120:123],a[120:123],a[152:155],v[120:123]
s_nop 0
T a[80:81],v22,16384
T a[82:83],v22,18432
M v[120:123],a[124:127],a[156:159],v[120:123]
T a[84:85],v22,20480
T a[86:87],v22,22528
M v[124:127],a[124:127],a[188:191],0
MF v102,v6,v102
MF v103,v6,v103
M v[124:127],a[120:123],a[184:187],v[124:127]
T a[88:89],v22,24576
T a[90:91],v22,26624
M v[124:127],a[116:119],a[180:183],v[124:127]
T a[92:93],v22,28672
T a[94:95],v22,30720
M v[124:127],a[112:115],a[176:179],v[124:127]
MF v108,v6,v108
MF v109,v6,v109
M v[124:127],a[108:111],a[172:175],v[124:127]
MF v110,v6,v110
MF v111,v6,v111
M v[124:127],a[104:107],a[168:171],v[124:127]
C v100,v100,v101
C v101,v102,v103
M v[124:127],a[100:103],a[164:167],v[124:127]
s_waitcnt lgkmcnt(0)
C v102,v108,v109
C v103,v110,v111
M v[124:127],a[96:99],a[160:163],v[124:127]
buffer_store_dwordx4 v[100:103], v7, s[8:11], s30 offen offset:0 sc1
M v[64:67],a[64:67],a[128:131],0
s_nop 0
T a[96:97],v23,0
T a[98:99],v23,2048
M v[64:67],a[68:71],a[132:135],v[64:67]
T a[100:101],v23,4096
T a[102:103],v23,6144
M v[64:67],a[72:75],a[136:139],v[64:67]
MF v112,v5,v112
MF v113,v5,v113
M v[64:67],a[76:79],a[140:143],v[64:67]
T a[104:105],v23,8192
T a[106:107],v23,10240
M v[64:67],a[80:83],a[144:147],v[64:67]
T a[108:109],v23,12288
T a[110:111],v23,14336
M v[64:67],a[84:87],a[148:151],v[64:67]
MF v114,v5,v114
MF v115,v5,v115
M v[64:67],a[88:91],a[152:155],v[64:67]
T a[112:113],v23,16384
T a[114:115],v23,18432
M v[64:67],a[92:95],a[156:159],v[64:67]
T a[116:117],v23,20480
T a[118:119],v23,22528
M v[68:71],a[92:95],a[188:191],0
MF v120,v5,v120
MF v121,v5,v121
M v[68:71],a[88:91],a[184:187],v[68:71]
T a[120:121],v23,24576
T a[122:123],v23,26624
M v[68:71],a[84:87],a[180:183],v[68:71]
T a[124:125],v23,28672
T a[126:127],v23,30720
M v[68:71],a[80:83],a[176:179],v[68:71]
MF v122,v5,v122
MF v123,v5,v123
M v[68:71],a[76:79],a[172:175],v[68:71]
C v112,v112,v113
C v113,v114,v115
M v[68:71],a[72:75],a[168:171],v[68:71]
C v114,v120,v121
C v115,v122,v123
M v[68:71],a[68:71],a[164:167],v[68:71]
buffer_store_dwordx4 v[112:115], v7, s[8:11], s29 offen offset:1024 sc1
M v[68:71],a[64:67],a[160:163],v[68:71]
s_waitcnt lgkmcnt(0)
MF v116,v6,v116
MF v117,v6,v117
M v[72:75],a[96:99],a[128:131],0
T a[64:65],v24,0
T a[66:67],v24,2048
M v[72:75],a[100:103],a[132:135],v[72:75]
T a[68:69],v24,4096
T a[70:71],v24,6144
M v[72:75],a[104:107],a[136:139],v[72:75]
MF v118,v6,v118
MF v119,v6,v119
M v[72:75],a[108:111],a[140:143],v[72:75]
T a[72:73],v24,8192
T a[74:75],v24,10240
M v[72:75],a[112:115],a[144:147],v[72:75]
T a[76:77],v24,12288
T a[78:79],v24,14336
M v[72:75],a[116:119],a[148:151],v[72:75]
MF v124,v6,v124
MF v125,v6,v125
M v[72:75],a[120:123],a[152:155],v[72:75]
T a[80:81],v24,16384
T a[82:83],v24,18432
M v[72:75],a[124:127],a[156:159],v[72:75]
T a[84:85],v24,20480
T a[86:87],v24,22528
M v[76:79],a[124:127],a[188:191],0
MF v126,v6,v126
MF v127,v6,v127
M v[76:79],a[120:123],a[184:187],v[76:79]
T a[88:89],v24,24576
T a[90:91],v24,26624
M v[76:79],a[116:119],a[180:183],v[76:79]
T a[92:93],v24,28672
T a[94:95],v24,30720
M v[76:79],a[112:115],a[176:179],v[76:79]
C v116,v116,v117
C v117,v118,v119
M v[76:79],a[108:111],a[172:175],v[76:79]
C v118,v124,v125
C v119,v126,v127
M v[76:79],a[104:107],a[168:171],v[76:79]
buffer_store_dwordx4 v[116:119], v7, s[8:11], s30 offen offset:1024 sc1
M v[76:79],a[100:103],a[164:167],v[76:79]
SA s29,s33,12288
M v[76:79],a[96:99],a[160:163],v[76:79]
s_waitcnt lgkmcnt(0)
M v[80:83],a[64:67],a[128:131],0
SA s30,s33,26624
T a[96:97],v25,0
T a[98:99],v25,2048
M v[80:83],a[68:71],a[132:135],v[80:83]
T a[100:101],v25,4096
T a[102:103],v25,6144
M v[80:83],a[72:75],a[136:139],v[80:83]
MF v64,v5,v64
MF v65,v5,v65
M v[80:83],a[76:79],a[140:143],v[80:83]
T a[104:105],v25,8192
T a[106:107],v25,10240
M v[80:83],a[80:83],a[144:147],v[80:83]
T a[108:109],v25,12288
T a[110:111],v25,14336
M v[80:83],a[84:87],a[148:151],v[80:83]
MF v66,v5,v66
MF v67,v5,v67
M v[80:83],a[88:91],a[152:155],v[80:83]
T a[112:113],v25,16384
T a[114:115],v25,18432
M v[80:83],a[92:95],a[156:159],v[80:83]
T a[116:117],v25,20480
T a[118:119],v25,22528
M v[84:87],a[92:95],a[188:191],0
MF v72,v5,v72
MF v73,v5,v73
M v[84:87],a[88:91],a[184:187],v[84:87]
T a[120:121],v25,24576
T a[122:123],v25,26624
M v[84:87],a[84:87],a[180:183],v[84:87]
T a[124:125],v25,28672
T a[126:127],v25,30720
M v[84:87],a[80:83],a[176:179],v[84:87]
MF v74,v5,v74
MF v75,v5,v75
M v[84:87],a[76:79],a[172:175],v[84:87]
C v64,v64,v65
C v65,v66,v67
M v[84:87],a[72:75],a[168:171],v[84:87]
C v66,v72,v73
C v67,v74,v75
M v[84:87],a[68:71],a[164:167],v[84:87]
buffer_store_dwordx4 v[64:67], v7, s[8:11], s29 offen offset:0 sc1
M v[84:87],a[64:67],a[160:163],v[84:87]
s_waitcnt lgkmcnt(0)
MF v68,v6,v68
MF v69,v6,v69
M v[88:91],a[96:99],a[128:131],0
MF v70,v6,v70
MF v71,v6,v71
M v[88:91],a[100:103],a[132:135],v[88:91]
MF v76,v6,v76
MF v77,v6,v77
M v[88:91],a[104:107],a[136:139],v[88:91]
MF v78,v6,v78
MF v79,v6,v79
M v[88:91],a[108:111],a[140:143],v[88:91]
C v68,v68,v69
C v69,v70,v71
M v[88:91],a[112:115],a[144:147],v[88:91]
C v70,v76,v77
C v71,v78,v79
M v[88:91],a[116:119],a[148:151],v[88:91]
buffer_store_dwordx4 v[68:71], v7, s[8:11], s30 offen offset:0 sc1
M v[88:91],a[120:123],a[152:155],v[88:91]
M v[88:91],a[124:127],a[156:159],v[88:91]
M v[92:95],a[124:127],a[188:191],0
M v[92:95],a[120:123],a[184:187],v[92:95]
M v[92:95],a[116:119],a[180:183],v[92:95]
M v[92:95],a[112:115],a[176:179],v[92:95]
MF v80,v5,v80
MF v81,v5,v81
M v[92:95],a[108:111],a[172:175],v[92:95]
MF v82,v5,v82
MF v83,v5,v83
M v[92:95],a[104:107],a[168:171],v[92:95]
MF v88,v5,v88
MF v89,v5,v89
M v[92:95],a[100:103],a[164:167],v[92:95]
MF v90,v5,v90
MF v91,v5,v91
M v[92:95],a[96:99],a[160:163],v[92:95]
C v80,v80,v81
C v81,v82,v83
C v82,v88,v89
C v83,v90,v91
buffer_store_dwordx4 v[80:83], v7, s[8:11], s29 offen offset:1024 sc1
MF v84,v6,v84
MF v85,v6,v85
MF v86,v6,v86
MF v87,v6,v87
MF v92,v6,v92
MF v93,v6,v93
MF v94,v6,v94
MF v95,v6,v95
C v84,v84,v85
C v85,v86,v87
C v86,v92,v93
C v87,v94,v95
buffer_store_dwordx4 v[84:87], v7, s[8:11], s30 offen offset:1024 sc1
buffer_load_dword v9, v33, s[8:11], s46 offen sc1
s_waitcnt vmcnt(1)
buffer_store_dword v15, v16, s[8:11], s3 offen sc1
L_red1:
s_waitcnt vmcnt(0)
v_cmp_eq_u32 vcc, 1, v9
s_mov_b32 s91, 65536
s_mov_b32 s69, 0xffff
s_and_b32 s70, vcc_lo, s69
s_mov_b32 s68, s70
s_cmp_lg_u32 s70, 0
s_cbranch_scc1 L_rk0
s_call_b64 s[36:37], L_rpoll
L_rk0:
s_ff1_i32_b32 s71, s70
s_bitset0_b32 s70, s71
s_mul_i32 s71, s71, 114688
SA s72,s71,s77
buffer_load_dwordx4 v[128:131], v7, s[8:11], s72 offen sc1
buffer_load_dwordx4 v[132:135], v27, s[8:11], s72 offen sc1
s_cmp_lg_u32 s70, 0
s_cbranch_scc1 L_rk1
s_call_b64 s[36:37], L_rpoll
L_rk1:
s_ff1_i32_b32 s71, s70
s_bitset0_b32 s70, s71
s_mul_i32 s71, s71, 114688
SA s72,s71,s77
buffer_load_dwordx4 v[136:139], v7, s[8:11], s72 offen sc1
buffer_load_dwordx4 v[140:143], v27, s[8:11], s72 offen sc1
s_cmp_lg_u32 s70, 0
s_cbranch_scc1 L_rk2
s_call_b64 s[36:37], L_rpoll
L_rk2:
s_ff1_i32_b32 s71, s70
s_bitset0_b32 s70, s71
s_mul_i32 s71, s71, 114688
SA s72,s71,s77
buffer_load_dwordx4 v[144:147], v7, s[8:11], s72 offen sc1
buffer_load_dwordx4 v[148:151], v27, s[8:11], s72 offen sc1
v_readlane_b32 s92, v31, 0
v_readlane_b32 s94, v31, 1
v_lshlrev_b32 v64, 16, v48
v_and_b32 v65, 0xffff0000, v48
v_lshlrev_b32 v66, 16, v49
v_and_b32 v67, 0xffff0000, v49
v_lshlrev_b32 v68, 16, v50
v_and_b32 v69, 0xffff0000, v50
v_lshlrev_b32 v70, 16, v51
v_and_b32 v71, 0xffff0000, v51
v_lshlrev_b32 v72, 16, v52
v_and_b32 v73, 0xffff0000, v52
v_lshlrev_b32 v74, 16, v53
v_and_b32 v75, 0xffff0000, v53
v_lshlrev_b32 v76, 16, v54
v_and_b32 v77, 0xffff0000, v54
v_lshlrev_b32 v78, 16, v55
v_and_b32 v79, 0xffff0000, v55
v_sub_f32 v30, 1.0, v39
v_cmp_eq_u32 s[80:81], s92, v37
v_cmp_eq_u32 s[82:83], s94, v37
s_nop 0
s_or_b64 vcc, s[80:81], s[82:83]
s_cbranch_vccnz L_moe0
L_moe_ret0:
MF v64,v30,v64
MF v65,v30,v65
MF v66,v30,v66
MF v67,v30,v67
MF v68,v30,v68
MF v69,v30,v69
MF v70,v30,v70
MF v71,v30,v71
MF v72,v30,v72
MF v73,v30,v73
MF v74,v30,v74
MF v75,v30,v75
MF v76,v30,v76
MF v77,v30,v77
MF v78,v30,v78
MF v79,v30,v79
s_cmp_lg_u32 s70, 0
s_cbranch_scc1 L_rk3
s_call_b64 s[36:37], L_rpoll
L_rk3:
s_ff1_i32_b32 s71, s70
s_bitset0_b32 s70, s71
s_mul_i32 s71, s71, 114688
SA s72,s71,s77
buffer_load_dwordx4 v[152:155], v7, s[8:11], s72 offen sc1
buffer_load_dwordx4 v[156:159], v27, s[8:11], s72 offen sc1
v_lshlrev_b32 v80, 16, v44
v_and_b32 v81, 0xffff0000, v44
v_lshlrev_b32 v82, 16, v45
v_and_b32 v83, 0xffff0000, v45
v_lshlrev_b32 v84, 16, v46
v_and_b32 v85, 0xffff0000, v46
v_lshlrev_b32 v86, 16, v47
v_and_b32 v87, 0xffff0000, v47
v_sub_f32 v30, 1.0, v26
v_cmp_eq_u32 s[80:81], s92, v29
v_cmp_eq_u32 s[82:83], s94, v29
s_nop 0
s_or_b64 vcc, s[80:81], s[82:83]
s_cbranch_vccnz L_moe1
L_moe_ret1:
MF v80,v30,v80
MF v81,v30,v81
MF v82,v30,v82
MF v83,v30,v83
MF v84,v30,v84
MF v85,v30,v85
MF v86,v30,v86
MF v87,v30,v87
s_waitcnt vmcnt(7)
M v[96:99],a[246:249],v[128:131],0
M v[100:103],a[244:247],v[128:131],0
s_waitcnt vmcnt(6)
M v[104:107],a[246:249],v[132:135],0
M v[108:111],a[244:247],v[132:135],0
s_cmp_lg_u32 s70, 0
s_cbranch_scc1 L_rk4
s_call_b64 s[36:37], L_rpoll
L_rk4:
s_ff1_i32_b32 s71, s70
s_bitset0_b32 s70, s71
s_mul_i32 s71, s71, 114688
SA s72,s71,s77
buffer_load_dwordx4 v[160:163], v7, s[8:11], s72 offen sc1
buffer_load_dwordx4 v[164:167], v27, s[8:11], s72 offen sc1
s_waitcnt vmcnt(7)
M v[96:99],a[246:249],v[136:139],v[96:99]
M v[100:103],a[244:247],v[136:139],v[100:103]
s_waitcnt vmcnt(6)
M v[104:107],a[246:249],v[140:143],v[104:107]
M v[108:111],a[244:247],v[140:143],v[108:111]
s_cmp_lg_u32 s70, 0
s_cbranch_scc1 L_rk5
s_call_b64 s[36:37], L_rpoll
L_rk5:
s_ff1_i32_b32 s71, s70
s_bitset0_b32 s70, s71
s_mul_i32 s71, s71, 114688
SA s72,s71,s77
buffer_load_dwordx4 v[168:171], v7, s[8:11], s72 offen sc1
buffer_load_dwordx4 v[172:175], v27, s[8:11], s72 offen sc1
s_waitcnt vmcnt(7)
M v[96:99],a[246:249],v[144:147],v[96:99]
M v[100:103],a[244:247],v[144:147],v[100:103]
s_waitcnt vmcnt(6)
M v[104:107],a[246:249],v[148:151],v[104:107]
M v[108:111],a[244:247],v[148:151],v[108:111]
s_cmp_lg_u32 s70, 0
s_cbranch_scc1 L_rk6
s_call_b64 s[36:37], L_rpoll
L_rk6:
s_ff1_i32_b32 s71, s70
s_bitset0_b32 s70, s71
s_mul_i32 s71, s71, 114688
SA s72,s71,s77
buffer_load_dwordx4 v[176:179], v7, s[8:11], s72 offen sc1
buffer_load_dwordx4 v[180:183], v27, s[8:11], s72 offen sc1
s_waitcnt vmcnt(7)
M v[96:99],a[246:249],v[152:155],v[96:99]
M v[100:103],a[244:247],v[152:155],v[100:103]
s_waitcnt vmcnt(6)
M v[104:107],a[246:249],v[156:159],v[104:107]
M v[108:111],a[244:247],v[156:159],v[108:111]
s_cmp_lg_u32 s70, 0
s_cbranch_scc1 L_rk7
s_call_b64 s[36:37], L_rpoll
L_rk7:
s_ff1_i32_b32 s71, s70
s_bitset0_b32 s70, s71
s_mul_i32 s71, s71, 114688
SA s72,s71,s77
buffer_load_dwordx4 v[184:187], v7, s[8:11], s72 offen sc1
buffer_load_dwordx4 v[188:191], v27, s[8:11], s72 offen sc1
s_waitcnt vmcnt(7)
M v[96:99],a[246:249],v[160:163],v[96:99]
M v[100:103],a[244:247],v[160:163],v[100:103]
s_waitcnt vmcnt(6)
M v[104:107],a[246:249],v[164:167],v[104:107]
M v[108:111],a[244:247],v[164:167],v[108:111]
s_cmp_lg_u32 s70, 0
s_cbranch_scc1 L_rk8
s_call_b64 s[36:37], L_rpoll
L_rk8:
s_ff1_i32_b32 s71, s70
s_bitset0_b32 s70, s71
s_mul_i32 s71, s71, 114688
SA s72,s71,s77
buffer_load_dwordx4 v[128:131], v7, s[8:11], s72 offen sc1
buffer_load_dwordx4 v[132:135], v27, s[8:11], s72 offen sc1
s_waitcnt vmcnt(7)
M v[96:99],a[246:249],v[168:171],v[96:99]
M v[100:103],a[244:247],v[168:171],v[100:103]
s_waitcnt vmcnt(6)
M v[104:107],a[246:249],v[172:175],v[104:107]
M v[108:111],a[244:247],v[172:175],v[108:111]
s_cmp_lg_u32 s70, 0
s_cbranch_scc1 L_rk9
s_call_b64 s[36:37], L_rpoll
L_rk9:
s_ff1_i32_b32 s71, s70
s_bitset0_b32 s70, s71
s_mul_i32 s71, s71, 114688
SA s72,s71,s77
buffer_load_dwordx4 v[136:139], v7, s[8:11], s72 offen sc1
buffer_load_dwordx4 v[140:143], v27, s[8:11], s72 offen sc1
s_waitcnt vmcnt(7)
M v[96:99],a[246:249],v[176:179],v[96:99]
M v[100:103],a[244:247],v[176:179],v[100:103]
s_waitcnt vmcnt(6)
M v[104:107],a[246:249],v[180:183],v[104:107]
M v[108:111],a[244:247],v[180:183],v[108:111]
s_cmp_lg_u32 s70, 0
s_cbranch_scc1 L_rk10
s_call_b64 s[36:37], L_rpoll
L_rk10:
s_ff1_i32_b32 s71, s70
s_bitset0_b32 s70, s71
s_mul_i32 s71, s71, 114688
SA s72,s71,s77
buffer_load_dwordx4 v[144:147], v7, s[8:11], s72 offen sc1
buffer_load_dwordx4 v[148:151], v27, s[8:11], s72 offen sc1
s_waitcnt vmcnt(7)
M v[96:99],a[246:249],v[184:187],v[96:99]
M v[100:103],a[244:247],v[184:187],v[100:103]
s_waitcnt vmcnt(6)
M v[104:107],a[246:249],v[188:191],v[104:107]
M v[108:111],a[244:247],v[188:191],v[108:111]
s_cmp_lg_u32 s70, 0
s_cbranch_scc1 L_rk11
s_call_b64 s[36:37], L_rpoll
L_rk11:
s_ff1_i32_b32 s71, s70
s_bitset0_b32 s70, s71
s_mul_i32 s71, s71, 114688
SA s72,s71,s77
buffer_load_dwordx4 v[152:155], v7, s[8:11], s72 offen sc1
buffer_load_dwordx4 v[156:159], v27, s[8:11], s72 offen sc1
s_waitcnt vmcnt(7)
M v[96:99],a[246:249],v[128:131],v[96:99]
M v[100:103],a[244:247],v[128:131],v[100:103]
s_waitcnt vmcnt(6)
M v[104:107],a[246:249],v[132:135],v[104:107]
M v[108:111],a[244:247],v[132:135],v[108:111]
s_cmp_lg_u32 s70, 0
s_cbranch_scc1 L_rk12
s_call_b64 s[36:37], L_rpoll
L_rk12:
s_ff1_i32_b32 s71, s70
s_bitset0_b32 s70, s71
s_mul_i32 s71, s71, 114688
SA s72,s71,s77
buffer_load_dwordx4 v[160:163], v7, s[8:11], s72 offen sc1
buffer_load_dwordx4 v[164:167], v27, s[8:11], s72 offen sc1
buffer_load_dword v8, v33, s[8:11], s46 offen sc1
s_waitcnt vmcnt(8)
M v[96:99],a[246:249],v[136:139],v[96:99]
M v[100:103],a[244:247],v[136:139],v[100:103]
s_waitcnt vmcnt(7)
M v[104:107],a[246:249],v[140:143],v[104:107]
M v[108:111],a[244:247],v[140:143],v[108:111]
s_cmp_lg_u32 s70, 0
s_cbranch_scc1 L_rk13
s_call_b64 s[36:37], L_rpoll
L_rk13:
s_ff1_i32_b32 s71, s70
s_bitset0_b32 s70, s71
s_mul_i32 s71, s71, 114688
SA s72,s71,s77
buffer_load_dwordx4 v[168:171], v7, s[8:11], s72 offen sc1
buffer_load_dwordx4 v[172:175], v27, s[8:11], s72 offen sc1
s_waitcnt vmcnt(8)
M v[96:99],a[246:249],v[144:147],v[96:99]
M v[100:103],a[244:247],v[144:147],v[100:103]
s_waitcnt vmcnt(7)
M v[104:107],a[246:249],v[148:151],v[104:107]
M v[108:111],a[244:247],v[148:151],v[108:111]
s_cmp_lg_u32 s70, 0
s_cbranch_scc1 L_rk14
s_call_b64 s[36:37], L_rpoll
L_rk14:
s_ff1_i32_b32 s71, s70
s_bitset0_b32 s70, s71
s_mul_i32 s71, s71, 114688
SA s72,s71,s77
buffer_load_dwordx4 v[176:179], v7, s[8:11], s72 offen sc1
buffer_load_dwordx4 v[180:183], v27, s[8:11], s72 offen sc1
s_waitcnt vmcnt(8)
M v[96:99],a[246:249],v[152:155],v[96:99]
M v[100:103],a[244:247],v[152:155],v[100:103]
s_waitcnt vmcnt(7)
M v[104:107],a[246:249],v[156:159],v[104:107]
M v[108:111],a[244:247],v[156:159],v[108:111]
s_cmp_lg_u32 s70, 0
s_cbranch_scc1 L_rk15
s_call_b64 s[36:37], L_rpoll
L_rk15:
s_ff1_i32_b32 s71, s70
s_bitset0_b32 s70, s71
s_mul_i32 s71, s71, 114688
SA s72,s71,s77
buffer_load_dwordx4 v[184:187], v7, s[8:11], s72 offen sc1
buffer_load_dwordx4 v[188:191], v27, s[8:11], s72 offen sc1
s_waitcnt vmcnt(8)
M v[96:99],a[246:249],v[160:163],v[96:99]
M v[100:103],a[244:247],v[160:163],v[100:103]
s_waitcnt vmcnt(7)
M v[104:107],a[246:249],v[164:167],v[104:107]
M v[108:111],a[244:247],v[164:167],v[108:111]
s_waitcnt vmcnt(6)
v_cmp_eq_u32 vcc, 1, v8
s_mov_b32 s69, 0xffff0000
s_and_b32 s70, vcc_lo, s69
s_mov_b32 s68, s70
s_cmp_lg_u32 s70, 0
s_cbranch_scc1 L_rk16
s_call_b64 s[36:37], L_rpoll
L_rk16:
s_ff1_i32_b32 s71, s70
s_bitset0_b32 s70, s71
s_mul_i32 s71, s71, 114688
SA s72,s71,s78
buffer_load_dwordx4 v[192:195], v7, s[8:11], s72 offen sc1
s_waitcnt vmcnt(6)
M v[96:99],a[246:249],v[168:171],v[96:99]
M v[100:103],a[244:247],v[168:171],v[100:103]
s_waitcnt vmcnt(5)
M v[104:107],a[246:249],v[172:175],v[104:107]
M v[108:111],a[244:247],v[172:175],v[108:111]
s_cmp_lg_u32 s70, 0
s_cbranch_scc1 L_rk17
s_call_b64 s[36:37], L_rpoll
L_rk17:
s_ff1_i32_b32 s71, s70
s_bitset0_b32 s70, s71
s_mul_i32 s71, s71, 114688
SA s72,s71,s78
buffer_load_dwordx4 v[196:199], v7, s[8:11], s72 offen sc1
s_waitcnt vmcnt(5)
M v[96:99],a[246:249],v[176:179],v[96:99]
M v[100:103],a[244:247],v[176:179],v[100:103]
s_waitcnt vmcnt(4)
M v[104:107],a[246:249],v[180:183],v[104:107]
M v[108:111],a[244:247],v[180:183],v[108:111]
s_cmp_lg_u32 s70, 0
s_cbranch_scc1 L_rk18
s_call_b64 s[36:37], L_rpoll
L_rk18:
s_ff1_i32_b32 s71, s70
s_bitset0_b32 s70, s71
s_mul_i32 s71, s71, 114688
SA s72,s71,s78
buffer_load_dwordx4 v[200:203], v7, s[8:11], s72 offen sc1
s_waitcnt vmcnt(4)
M v[96:99],a[246:249],v[184:187],v[96:99]
M v[100:103],a[244:247],v[184:187],v[100:103]
s_waitcnt vmcnt(3)
M v[104:107],a[246:249],v[188:191],v[104:107]
M v[108:111],a[244:247],v[188:191],v[108:111]
s_nop 4
v_permlane16_swap_b32 v96, v100
v_permlane16_swap_b32 v97, v101
v_permlane16_swap_b32 v98, v102
v_permlane16_swap_b32 v99, v103
v_permlane16_swap_b32 v104, v108
v_permlane16_swap_b32 v105, v109
v_permlane16_swap_b32 v106, v110
v_permlane16_swap_b32 v107, v111
v_fmac_f32 v64, v39, v96
v_fmac_f32 v65, v39, v97
v_fmac_f32 v66, v39, v98
v_fmac_f32 v67, v39, v99
v_fmac_f32 v68, v39, v100
v_fmac_f32 v69, v39, v101
v_fmac_f32 v70, v39, v102
v_fmac_f32 v71, v39, v103
C v48,v64,v65
C v49,v66,v67
C v50,v68,v69
C v51,v70,v71
buffer_store_dwordx4 v[48:51], v38, s[52:55], s75 offen sc1
v_fmac_f32 v72, v39, v104
v_fmac_f32 v73, v39, v105
v_fmac_f32 v74, v39, v106
v_fmac_f32 v75, v39, v107
v_fmac_f32 v76, v39, v108
v_fmac_f32 v77, v39, v109
v_fmac_f32 v78, v39, v110
v_fmac_f32 v79, v39, v111
C v52,v72,v73
C v53,v74,v75
C v54,v76,v77
C v55,v78,v79
buffer_store_dwordx4 v[52:55], v38, s[52:55], s76 offen sc1
s_cmp_lg_u32 s70, 0
s_cbranch_scc1 L_rk19
s_call_b64 s[36:37], L_rpoll
L_rk19:
s_ff1_i32_b32 s71, s70
s_bitset0_b32 s70, s71
s_mul_i32 s71, s71, 114688
SA s72,s71,s78
buffer_load_dwordx4 v[204:207], v7, s[8:11], s72 offen sc1
s_cmp_lg_u32 s70, 0
s_cbranch_scc1 L_rk20
s_call_b64 s[36:37], L_rpoll
L_rk20:
s_ff1_i32_b32 s71, s70
s_bitset0_b32 s70, s71
s_mul_i32 s71, s71, 114688
SA s72,s71,s78
buffer_load_dwordx4 v[208:211], v7, s[8:11], s72 offen sc1
s_cmp_lg_u32 s70, 0
s_cbranch_scc1 L_rk21
s_call_b64 s[36:37], L_rpoll
L_rk21:
s_ff1_i32_b32 s71, s70
s_bitset0_b32 s70, s71
s_mul_i32 s71, s71, 114688
SA s72,s71,s78
buffer_load_dwordx4 v[212:215], v7, s[8:11], s72 offen sc1
s_cmp_lg_u32 s70, 0
s_cbranch_scc1 L_rk22
s_call_b64 s[36:37], L_rpoll
L_rk22:
s_ff1_i32_b32 s71, s70
s_bitset0_b32 s70, s71
s_mul_i32 s71, s71, 114688
SA s72,s71,s78
buffer_load_dwordx4 v[216:219], v7, s[8:11], s72 offen sc1
s_cmp_lg_u32 s70, 0
s_cbranch_scc1 L_rk23
s_call_b64 s[36:37], L_rpoll
L_rk23:
s_ff1_i32_b32 s71, s70
s_bitset0_b32 s70, s71
s_mul_i32 s71, s71, 114688
SA s72,s71,s78
buffer_load_dwordx4 v[220:223], v7, s[8:11], s72 offen sc1
s_cmp_lg_u32 s70, 0
s_cbranch_scc1 L_rk24
s_call_b64 s[36:37], L_rpoll
L_rk24:
s_ff1_i32_b32 s71, s70
s_bitset0_b32 s70, s71
s_mul_i32 s71, s71, 114688
SA s72,s71,s78
buffer_load_dwordx4 v[224:227], v7, s[8:11], s72 offen sc1
s_cmp_lg_u32 s70, 0
s_cbranch_scc1 L_rk25
s_call_b64 s[36:37], L_rpoll
L_rk25:
s_ff1_i32_b32 s71, s70
s_bitset0_b32 s70, s71
s_mul_i32 s71, s71, 114688
SA s72,s71,s78
buffer_load_dwordx4 v[228:231], v7, s[8:11], s72 offen sc1
s_cmp_lg_u32 s70, 0
s_cbranch_scc1 L_rk26
s_call_b64 s[36:37], L_rpoll
L_rk26:
s_ff1_i32_b32 s71, s70
s_bitset0_b32 s70, s71
s_mul_i32 s71, s71, 114688
SA s72,s71,s78
buffer_load_dwordx4 v[232:235], v7, s[8:11], s72 offen sc1
s_cmp_lg_u32 s70, 0
s_cbranch_scc1 L_rk27
s_call_b64 s[36:37], L_rpoll
L_rk27:
s_ff1_i32_b32 s71, s70
s_bitset0_b32 s70, s71
s_mul_i32 s71, s71, 114688
SA s72,s71,s78
buffer_load_dwordx4 v[236:239], v7, s[8:11], s72 offen sc1
s_waitcnt vmcnt(13)
M v[112:115],a[246:249],v[192:195],0
M v[116:119],a[244:247],v[192:195],0
s_cmp_lg_u32 s70, 0
s_cbranch_scc1 L_rk28
s_call_b64 s[36:37], L_rpoll
L_rk28:
s_ff1_i32_b32 s71, s70
s_bitset0_b32 s70, s71
s_mul_i32 s71, s71, 114688
SA s72,s71,s78
buffer_load_dwordx4 v[240:243], v7, s[8:11], s72 offen sc1
s_waitcnt vmcnt(13)
M v[112:115],a[246:249],v[196:199],v[112:115]
M v[116:119],a[244:247],v[196:199],v[116:119]
s_cmp_lg_u32 s70, 0
s_cbranch_scc1 L_rk29
s_call_b64 s[36:37], L_rpoll
L_rk29:
s_ff1_i32_b32 s71, s70
s_bitset0_b32 s70, s71
s_mul_i32 s71, s71, 114688
SA s72,s71,s78
buffer_load_dwordx4 v[244:247], v7, s[8:11], s72 offen sc1
s_waitcnt vmcnt(13)
M v[112:115],a[246:249],v[200:203],v[112:115]
M v[116:119],a[244:247],v[200:203],v[116:119]
s_cmp_lg_u32 s70, 0
s_cbranch_scc1 L_rk30
s_call_b64 s[36:37], L_rpoll
L_rk30:
s_ff1_i32_b32 s71, s70
s_bitset0_b32 s70, s71
s_mul_i32 s71, s71, 114688
SA s72,s71,s78
buffer_load_dwordx4 v[248:251], v7, s[8:11], s72 offen sc1
s_waitcnt vmcnt(11)
M v[112:115],a[246:249],v[204:207],v[112:115]
M v[116:119],a[244:247],v[204:207],v[116:119]
s_cmp_lg_u32 s70, 0
s_cbranch_scc1 L_rk31
s_call_b64 s[36:37], L_rpoll
L_rk31:
s_ff1_i32_b32 s71, s70
s_bitset0_b32 s70, s71
s_mul_i32 s71, s71, 114688
SA s72,s71,s78
buffer_load_dwordx4 v[252:255], v7, s[8:11], s72 offen sc1
s_waitcnt vmcnt(11)
M v[112:115],a[246:249],v[208:211],v[112:115]
M v[116:119],a[244:247],v[208:211],v[116:119]
s_waitcnt vmcnt(10)
M v[112:115],a[246:249],v[212:215],v[112:115]
M v[116:119],a[244:247],v[212:215],v[116:119]
s_waitcnt vmcnt(9)
M v[112:115],a[246:249],v[216:219],v[112:115]
M v[116:119],a[244:247],v[216:219],v[116:119]
s_waitcnt vmcnt(8)
M v[112:115],a[246:249],v[220:223],v[112:115]
M v[116:119],a[244:247],v[220:223],v[116:119]
s_waitcnt vmcnt(7)
M v[112:115],a[246:249],v[224:227],v[112:115]
M v[116:119],a[244:247],v[224:227],v[116:119]
s_waitcnt vmcnt(6)
M v[112:115],a[246:249],v[228:231],v[112:115]
M v[116:119],a[244:247],v[228:231],v[116:119]
s_waitcnt vmcnt(5)
M v[112:115],a[246:249],v[232:235],v[112:115]
M v[116:119],a[244:247],v[232:235],v[116:119]
s_waitcnt vmcnt(4)
M v[112:115],a[246:249],v[236:239],v[112:115]
M v[116:119],a[244:247],v[236:239],v[116:119]
s_waitcnt vmcnt(3)
M v[112:115],a[246:249],v[240:243],v[112:115]
M v[116:119],a[244:247],v[240:243],v[116:119]
s_waitcnt vmcnt(2)
M v[112:115],a[246:249],v[244:247],v[112:115]
M v[116:119],a[244:247],v[244:247],v[116:119]
s_waitcnt vmcnt(1)
M v[112:115],a[246:249],v[248:251],v[112:115]
M v[116:119],a[244:247],v[248:251],v[116:119]
s_waitcnt vmcnt(0)
M v[112:115],a[246:249],v[252:255],v[112:115]
M v[116:119],a[244:247],v[252:255],v[116:119]
s_nop 7
v_permlane16_swap_b32 v112, v116
v_permlane16_swap_b32 v113, v117
v_permlane16_swap_b32 v114, v118
v_permlane16_swap_b32 v115, v119
v_fmac_f32 v80, v26, v112
v_fmac_f32 v81, v26, v113
v_fmac_f32 v82, v26, v114
v_fmac_f32 v83, v26, v115
v_fmac_f32 v84, v26, v116
v_fmac_f32 v85, v26, v117
v_fmac_f32 v86, v26, v118
v_fmac_f32 v87, v26, v119
C v44,v80,v81
C v45,v82,v83
C v46,v84,v85
C v47,v86,v87
buffer_store_dwordx4 v[44:47], v28, s[52:55], s79 offen sc1
s_endpgm
L_rpoll0:
s_sleep 1
L_rpoll:
buffer_load_dword v9, v33, s[8:11], s46 offen sc1
s_waitcnt vmcnt(0)
v_cmp_eq_u32 vcc, 1, v9
s_sub_u32 s91, s91, 1
s_cselect_b32 s70, -1, 0
s_or_b32 s70, s70, vcc_lo
s_and_b32 s70, s70, s69
s_andn2_b32 s70, s70, s68
s_cbranch_scc0 L_rpoll0
s_or_b32 s68, s68, s70
s_setpc_b64 s[36:37]
L_moe0:
s_lshl_b32 s88, s75, 1
s_call_b64 s[36:37], L_moe
AF v64,v2,v64
AF v65,v3,v65
AF v66,v4,v66
AF v67,v5,v67
AF v68,v10,v68
AF v69,v11,v69
AF v70,v12,v70
AF v71,v13,v71
AF v72,v14,v72
AF v73,v15,v73
AF v74,v16,v74
AF v75,v17,v75
AF v76,v18,v76
AF v77,v19,v77
AF v78,v20,v78
AF v79,v21,v79
s_mov_b64 exec, -1
s_branch L_moe_ret0
L_moe1:
s_lshl_b32 s88, s79, 1
s_call_b64 s[36:37], L_moe
AF v80,v2,v80
AF v81,v3,v81
AF v82,v4,v82
AF v83,v5,v83
AF v84,v10,v84
AF v85,v11,v85
AF v86,v12,v86
AF v87,v13,v87
s_mov_b64 exec, -1
s_branch L_moe_ret1
L_moe2:
s_lshl_b32 s88, s79, 1
s_call_b64 s[36:37], L_moe
AF v48,v2,v48
AF v49,v3,v49
AF v50,v4,v50
AF v51,v5,v51
AF v52,v10,v52
AF v53,v11,v53
AF v54,v12,v54
AF v55,v13,v55
s_mov_b64 exec, -1
s_branch L_moe_ret2
L_moe:
v_min_u32 v0, 27, v32
v_lshlrev_b32 v0, 2, v0
s_mov_b32 s64, 105062912
s_mov_b32 s65, 65536
s_mov_b32 exec_lo, 0xffffffff
s_mov_b32 exec_hi, 0xffffffff
L_pfy:
buffer_load_dword v1, v0, s[8:11], s64 offen sc1
s_sub_u32 s65, s65, 1
s_cbranch_scc1 L_pfy_x
s_waitcnt vmcnt(0)
v_cmp_ne_u32 vcc, 1, v1
s_nop 0
s_cbranch_vccz L_pfy_x
s_sleep 2
s_branch L_pfy
L_pfy_x:
s_waitcnt vmcnt(0)
s_mov_b64 exec, -1
s_or_b64 exec, s[80:81], s[82:83]
v_mov_b32 v0, 1792
v_cndmask_b32 v0, v0, 0, s[80:81]
v_lshl_add_u32 v0, v34, 5, v0
SA s88,s88,104898560
buffer_load_dwordx4 v[2:5], v0, s[8:11], s88 offen sc1
buffer_load_dwordx4 v[10:13], v0, s[8:11], s88 offen offset:16 sc1
buffer_load_dwordx4 v[14:17], v0, s[8:11], s88 offen offset:512 sc1
buffer_load_dwordx4 v[18:21], v0, s[8:11], s88 offen offset:528 sc1
s_waitcnt vmcnt(0)
s_setpc_b64 s[36:37]
L_red:
v_lshrrev_b32 v32, 4, v7
s_lshr_b32 s74, s41, 3
s_lshl_b32 s64, s42, 1
SA s46,s64,s74
s_mul_i32 s46, s46, 4352
s_and_b32 s72, s41, 7
s_lshl_b32 s65, s72, 7
SA s46,s46,s65
SA s46,s46,104992768
v_and_b32 v33, 31, v32
v_lshlrev_b32 v33, 2, v33
s_lshl_b32 s65, s41, 7
SA s65,s65,104890368
buffer_load_dword v31, v33, s[8:11], s65 offen sc1
v_bfe_u32 v34, v32, 4, 1
v_lshlrev_b32 v34, 1, v34
v_lshrrev_b32 v35, 5, v32
v_add_u32 v34, v34, v35
s_mov_b32 s52, s96
s_and_b32 s53, s97, 0xffff
s_mov_b32 s54, 1835008
s_mov_b32 s55, 0x20000
s_mul_i32 s77, s42, 1835008
s_mul_i32 s78, s72, 14336
SA s77,s77,s78
SA s77,s77,67108864
s_lshl_b32 s79, s74, 1
SA s79,s79,s20
s_lshl_b32 s71, s74, 1
SA s71,s71,1
s_sub_u32 s71, s71, s20
s_and_b32 s71, s71, 536870912
s_sub_u32 s64, 15, s64
s_sub_u32 s78, s64, 1
s_mul_i32 s78, s78, 1835008
SA s78,s78,s77
s_lshl_b32 s65, s79, 10
SA s78,s78,s65
SA s78,s78,s71
s_lshl_b32 s79, s79, 6
s_or_b32 s79, s79, s71
s_mul_i32 s67, s74, -2
s_lshl_b32 s74, s74, 3
SA s74,s74,s20
s_lshl_b32 s75, s74, 6
SA s76,s75,256
SA s67,s67,3
s_sub_u32 s67, s67, s20
s_and_b32 s67, s67, 536870912
s_or_b32 s76, s76, s67
v_or_b32 v27, s67, v7
v_add_u32 v27, 4096, v27
s_lshl_b32 s65, s74, 10
SA s77,s77,s65
s_lshl_b32 s64, s64, 7
s_lshr_b32 s73, s72, 1
s_sub_u32 s65, 7, s73
s_bitcmp1_b32 s72, 0
s_cselect_b32 s73, s65, s73
s_lshl_b32 s73, s73, 4
s_lshl_b32 s65, s42, 7
SA s73,s73,s65
v_and_b32 v37, 15, v32
v_add_u32 v37, s73, v37
v_add_u32 v29, s64, v37
s_mov_b32 s64, 104857664
v_mul_u32_u24 v38, 896, v37
v_lshl_add_u32 v38, v34, 4, v38
v_lshrrev_b32 v35, 4, v37
v_lshlrev_b32 v35, 5, v35
v_and_b32 v36, 15, v37
v_add_lshl_u32 v35, v35, v36, 2
buffer_load_dword v39, v35, s[8:11], s64 offen sc1
buffer_load_dwordx4 v[48:51], v38, s[56:59], s75 offen
buffer_load_dwordx4 v[52:55], v38, s[56:59], s76 offen
v_mul_u32_u24 v28, 896, v29
v_lshl_add_u32 v28, v34, 4, v28
v_lshrrev_b32 v35, 4, v29
v_lshlrev_b32 v35, 5, v35
v_and_b32 v36, 15, v29
v_add_lshl_u32 v35, v35, v36, 2
buffer_load_dword v26, v35, s[8:11], s64 offen sc1
buffer_load_dwordx4 v[44:47], v28, s[56:59], s79 offen
s_waitcnt vmcnt(7)
buffer_load_dword v9, v33, s[8:11], s46 offen sc1
s_branch L_red1
L_code_end:
.section .rodata,"a"
.p2align 6
.amdhsa_kernel gated_mix__compressed_kv_cla__moe_arch_mod__prompt_kernel
  .amdhsa_next_free_vgpr 512
  .amdhsa_next_free_sgpr 102
  .amdhsa_accum_offset 256
  .amdhsa_group_segment_fixed_size 0
  .amdhsa_kernarg_size 120
  .amdhsa_user_sgpr_count 2
  .amdhsa_user_sgpr_kernarg_segment_ptr 1
  .amdhsa_system_sgpr_workgroup_id_x 1
  .amdhsa_float_denorm_mode_32 3
.end_amdhsa_kernel
```

```asm
; @launch grid=(256,1,1) block=(256,1,1) lds=163840
.amdgcn_target "amdgcn-amd-amdhsa--gfx950"
.text
.macro M a, b, c, d
v_mfma_f32_16x16x32_bf16 \a, \b, \c, \d
.endm
.macro R a, b, c
ds_read_b128 \a, \b offset:\c
.endm
.macro T a, b, c
ds_read_b64_tr_b16 \a, \b offset:\c
.endm
.macro C a, b, c
v_cvt_pk_bf16_f32 \a, \b, \c
.endm
.macro E a, b
v_exp_f32 \a, \b
.endm
.macro W a, b
v_accvgpr_write_b32 \a, \b
.endm
.macro G a, b
v_accvgpr_read_b32 \a, \b
.endm
.macro AF a, b, c
v_add_f32 \a, \b, \c
.endm
.macro MF a, b, c
v_mul_f32 \a, \b, \c
.endm
.macro SA a, b, c
s_add_u32 \a, \b, \c
.endm
.globl gated_mix__compressed_kv_cla__moe_arch_mod__prompt_kernel
.p2align 8
.type gated_mix__compressed_kv_cla__moe_arch_mod__prompt_kernel,@function
gated_mix__compressed_kv_cla__moe_arch_mod__prompt_kernel:
s_cmp_lt_u32 s2, 256
s_cbranch_scc1 L_go
s_endpgm
L_go:
s_load_dwordx8 s[80:87], s[0:1], 0
s_load_dwordx4 s[88:91], s[0:1], 32
s_getpc_b64 s[76:77]
L_pc0:
s_lshr_b32 s42, s2, 3
s_mov_b32 s79, 0x20000
s_lshl_b32 s67, s42, 13
s_mov_b32 s78, L_code_end-L_pc0
s_and_b32 s77, s77, 0xffff
v_lshl_add_u32 v31, v0, 5, s67
buffer_load_dword a240, v31, s[76:79], 0 offen offset:0
v_lshrrev_b32 v24, 6, v0
v_and_b32 v0, 63, v0
s_and_b32 s41, s2, 7
v_readfirstlane_b32 s20, v24
s_lshr_b32 s64, s2, 4
v_and_b32 v24, 15, v0
v_lshrrev_b32 v25, 4, v0
s_and_b32 s64, s64, 8
s_or_b32 s41, s41, s64
v_lshlrev_b32 v28, 1, v25
v_xor_b32 v28, v28, v24
v_and_b32 v29, 8, v28
v_and_b32 v28, 7, v28
v_lshlrev_b32 v28, 4, v28
v_lshl_add_u32 v28, v29, 5, v28
v_lshl_add_u32 v28, v25, 13, v28
s_lshl_b32 s64, s20, 17
v_add_u32 v8, s64, v28
v_xor_b32 v28, 0x100, v8
v_add_u32 v9, 31744, v8
v_add_u32 v10, 63488, v28
v_add_u32 v11, 95232, v28
s_mov_b32 s21, 0
s_lshl_b32 s23, s20, 12
s_lshl_b32 s74, s41, 9
s_sub_u32 s18, 8388608, s74
s_mov_b32 s19, s79
s_bitcmp0_b32 s2, 6
s_waitcnt lgkmcnt(0)
s_cselect_b64 s[72:73], s[86:87], s[88:89]
SA s16,s72,s74
s_addc_u32 s73, s73, 0
s_and_b32 s17, s73, 0xffff
SA m0,s23,0
s_nop 0
buffer_load_dwordx4 v8, s[16:19], s21 offen offset:0   lds
buffer_load_dwordx4 v9, s[16:19], s21 offen offset:1024   lds
buffer_load_dwordx4 v10, s[16:19], s21 offen offset:2048   lds
buffer_load_dwordx4 v11, s[16:19], s21 offen offset:3072   lds
SA s21,s21,128
s_and_b32 s42, s42, 15
s_lshr_b32 s45, s42, 3
s_and_b32 s65, s20, 1
s_lshr_b32 s66, s20, 1
v_and_b32 v29, 7, v0
v_xor_b32 v28, v25, v29
v_lshlrev_b32 v28, 4, v28
v_lshrrev_b32 v29, 3, v0
v_lshl_add_u32 v30, v29, 11, v28
s_lshl_b32 s64, s66, 19
s_lshl_b32 s67, s65, 21
SA s64,s64,s67
v_add_u32 v12, s64, v30
v_xor_b32 v30, 64, v12
v_add_u32 v14, 30720, v12
v_add_u32 v13, 15360, v30
v_add_u32 v15, 46080, v30
s_mov_b32 s22, 0
SA s24,s23,65536
s_and_b32 s64, s42, 7
s_lshl_b32 s64, s64, 16
s_sub_u32 s50, 4194304, s64
s_mov_b32 s51, s79
SA s48,s82,s64
s_addc_u32 s73, s83, 0
s_and_b32 s49, s73, 0xffff
SA m0,s23,16384
s_nop 0
buffer_load_dwordx4 v8, s[16:19], s21 offen offset:0   lds
buffer_load_dwordx4 v9, s[16:19], s21 offen offset:1024   lds
buffer_load_dwordx4 v10, s[16:19], s21 offen offset:2048   lds
buffer_load_dwordx4 v11, s[16:19], s21 offen offset:3072   lds
SA s21,s21,524160
SA m0,s24,0
s_nop 0
buffer_load_dwordx4 v12, s[48:51], s22 offen offset:0   lds
buffer_load_dwordx4 v13, s[48:51], s22 offen offset:1024   lds
buffer_load_dwordx4 v14, s[48:51], s22 offen offset:2048   lds
buffer_load_dwordx4 v15, s[48:51], s22 offen offset:3072   lds
SA s22,s22,1048576
s_load_dwordx2 s[92:93], s[0:1], 56
s_load_dwordx2 s[94:95], s[0:1], 88
s_load_dwordx4 s[4:7], s[0:1], 104
v_lshlrev_b32 v7, 4, v0
v_lshrrev_b32 v26, 2, v24
v_and_b32 v28, 1, v25
v_lshl_or_b32 v28, v28, 2, v26
v_lshl_add_u32 v29, v25, 3, v26
v_lshlrev_b32 v29, 8, v29
v_and_b32 v30, 3, v0
v_lshl_add_u32 v29, v30, 3, v29
s_lshl_b32 s64, s65, 2
SA s64,s64,0
v_xor_b32 v30, s64, v28
v_lshl_add_u32 v1, v30, 5, v29
s_lshl_b32 s64, s65, 2
SA s64,s64,1
v_xor_b32 v30, s64, v28
v_lshl_add_u32 v2, v30, 5, v29
s_lshl_b32 s64, s65, 2
SA s64,s64,2
v_xor_b32 v30, s64, v28
v_lshl_add_u32 v3, v30, 5, v29
s_lshl_b32 s64, s65, 2
SA s64,s64,3
v_xor_b32 v30, s64, v28
v_lshl_add_u32 v4, v30, 5, v29
v_add_u32 v28, 0, v25
v_lshrrev_b32 v29, 1, v24
v_xor_b32 v28, v28, v29
v_lshlrev_b32 v28, 4, v28
v_lshl_add_u32 v28, v24, 7, v28
s_lshl_b32 s64, s66, 13
SA s64,s64,65536
v_add_u32 v5, s64, v28
v_add_u32 v28, 4, v25
v_lshrrev_b32 v29, 1, v24
v_xor_b32 v28, v28, v29
v_lshlrev_b32 v28, 4, v28
v_lshl_add_u32 v28, v24, 7, v28
s_lshl_b32 s64, s66, 13
SA s64,s64,65536
v_add_u32 v6, s64, v28
s_mov_b32 s56, s80
s_and_b32 s57, s81, 0xffff
s_mov_b32 s58, 1835008
s_mov_b32 s59, 0x20000
s_waitcnt lgkmcnt(0)
s_mov_b32 s60, s92
s_and_b32 s61, s93, 0xffff
s_mov_b32 s62, 896
s_mov_b32 s63, 0x20000
s_mov_b32 s68, s94
s_and_b32 s69, s95, 0xffff
s_mov_b32 s70, 896
s_mov_b32 s71, 0x20000
s_lshl_b32 s95, s20, 11
s_lshr_b32 s64, s2, 3
s_lshl_b32 s64, s64, 13
SA s95,s95,s64
s_mov_b32 s8, s6
s_and_b32 s9, s7, 0xffff
s_mov_b32 s10, 268435456
s_mov_b32 s11, 0x20000
s_mov_b32 s12, s4
s_and_b32 s13, s5, 0xffff
s_mov_b32 s14, 256
s_mov_b32 s15, 0x20000
SA s72,s84,s74
s_addc_u32 s73, s85, 0
s_sub_u32 s75, 3670016, s74
s_mov_b32 s52, s72
s_and_b32 s53, s73, 0xffff
s_mov_b32 s54, s75
s_mov_b32 s55, 0x20000
s_mul_i32 s29, s42, 114688
s_mov_b32 s5, 0x3db8aa3b
s_mul_i32 s72, s45, 16777216
s_mul_i32 s73, s41, 1048576
SA s72,s72,s73
s_bfe_u32 s64, s42, 0x20001
s_lshl_b32 s64, s64, 15
SA s72,s72,s64
s_lshl_b32 s64, s66, 17
SA s72,s72,s64
s_and_b32 s67, s42, 1
s_cmp_eq_u32 s45, 0
s_cselect_b32 s64, 12, 14
s_cselect_b32 s75, 14, 10
s_lshl_b32 s67, s67, s75
SA s72,s72,s67
s_lshl_b32 s64, s65, s64
SA s93,s72,s64
s_load_dwordx4 s[80:83], s[0:1], 64
s_load_dwordx2 s[84:85], s[0:1], 80
s_load_dwordx2 s[96:97], s[0:1], 96
s_cmp_eq_u32 s45, 0
s_cbranch_scc0 L_kv1
s_branch L_kv0
.p2align 12
L_kv0:
s_and_b32 s31, s42, 7
s_lshl_b32 s64, s42, 4
SA s64,s64,s41
s_lshl_b32 s64, s64, 2
SA s64,s64,s20
s_cmp_lt_u32 s64, 41
s_cselect_b32 s39, 0, 536870912
s_min_u32 s64, s64, 41
s_lshl_b32 s38, s64, 2
s_max_u32 s67, s64, 8
s_sub_u32 s67, s67, 8
s_mul_i32 s67, s67, 3328
s_lshl_b32 s64, s64, 10
SA s64,s64,s67
SA s73,s64,104914944
v_or_b32 v64, s39, v7
v_mov_b32 v68, 0
v_mov_b32 v69, 0
v_mov_b32 v70, 0
v_mov_b32 v71, 0
buffer_store_dwordx4 v[68:71], v64, s[8:11], s73 offen offset:0 sc1
buffer_store_dwordx4 v[68:71], v64, s[8:11], s73 offen offset:1024 sc1
buffer_store_dwordx4 v[68:71], v64, s[8:11], s73 offen offset:2048 sc1
SA m0,s24,16384
s_nop 0
buffer_load_dwordx4 v12, s[48:51], s22 offen offset:0   lds
buffer_load_dwordx4 v13, s[48:51], s22 offen offset:1024   lds
buffer_load_dwordx4 v14, s[48:51], s22 offen offset:2048   lds
buffer_load_dwordx4 v15, s[48:51], s22 offen offset:3072   lds
s_sub_u32 s22, s22, 1048448
SA m0,s23,32768
s_nop 0
buffer_load_dwordx4 v8, s[16:19], s21 offen offset:0   lds
buffer_load_dwordx4 v9, s[16:19], s21 offen offset:1024   lds
buffer_load_dwordx4 v10, s[16:19], s21 offen offset:2048   lds
buffer_load_dwordx4 v11, s[16:19], s21 offen offset:3072   lds
SA s21,s21,128
s_mov_b64 exec, 0
s_cmp_eq_u32 s20, 0
s_cbranch_scc1 L_w_kv01
s_cmp_eq_u32 s20, 1
s_cbranch_scc1 L_w_kv02
s_cmp_eq_u32 s20, 2
s_cbranch_scc1 L_w_kv03
s_branch L_w_kv04
L_wd1:
s_mov_b64 exec, -1
s_waitcnt vmcnt(11) lgkmcnt(0)
s_barrier
R a[160:163],v5,0
R a[164:167],v6,0
T a[96:97],v1,0
T a[98:99],v1,1024
T a[100:101],v1,8192
T a[102:103],v1,9216
T a[104:105],v2,0
T a[106:107],v2,1024
T a[108:109],v2,8192
T a[110:111],v2,9216
T a[112:113],v3,0
T a[114:115],v3,1024
T a[116:117],v3,8192
T a[118:119],v3,9216
T a[120:121],v4,0
T a[122:123],v4,1024
T a[124:125],v4,8192
T a[126:127],v4,9216
T a[128:129],v1,16384
T a[130:131],v1,17408
T a[132:133],v1,24576
T a[134:135],v1,25600
T a[136:137],v2,16384
T a[138:139],v2,17408
T a[140:141],v2,24576
T a[142:143],v2,25600
T a[144:145],v3,16384
T a[146:147],v3,17408
T a[148:149],v3,24576
T a[150:151],v3,25600
T a[152:153],v4,16384
T a[154:155],v4,17408
T a[156:157],v4,24576
T a[158:159],v4,25600
s_waitcnt lgkmcnt(15)
M a[0:3],a[96:99],a[160:163],0
SA m0,s23,49152
R a[168:171],v5,2048
R a[172:175],v6,2048
M a[0:3],a[100:103],a[164:167],a[0:3]
buffer_load_dwordx4 v8, s[16:19], s21 offen offset:0   lds
M a[4:7],a[108:111],a[164:167],0
M a[4:7],a[104:107],a[160:163],a[4:7]
M a[8:11],a[112:115],a[160:163],0
buffer_load_dwordx4 v9, s[16:19], s21 offen offset:1024   lds
M a[8:11],a[116:119],a[164:167],a[8:11]
s_waitcnt lgkmcnt(14)
M a[12:15],a[124:127],a[164:167],0
M a[12:15],a[120:123],a[160:163],a[12:15]
M a[16:19],a[128:131],a[160:163],0
buffer_load_dwordx4 v10, s[16:19], s21 offen offset:2048   lds
M a[16:19],a[132:135],a[164:167],a[16:19]
s_waitcnt lgkmcnt(6)
M a[20:23],a[140:143],a[164:167],0
M a[20:23],a[136:139],a[160:163],a[20:23]
buffer_load_dwordx4 v11, s[16:19], s21 offen offset:3072   lds
M a[24:27],a[144:147],a[160:163],0
SA s21,s21,524160
M a[24:27],a[148:151],a[164:167],a[24:27]
s_waitcnt lgkmcnt(0)
M a[28:31],a[156:159],a[164:167],0
SA m0,s24,32768
M a[28:31],a[152:155],a[160:163],a[28:31]
buffer_load_dwordx4 v12, s[48:51], s22 offen offset:0   lds
M v[32:35],a[96:99],a[168:171],0
R a[160:163],v5,4096
R a[164:167],v6,4096
M v[32:35],a[100:103],a[172:175],v[32:35]
M v[36:39],a[108:111],a[172:175],0
M v[36:39],a[104:107],a[168:171],v[36:39]
buffer_load_dwordx4 v13, s[48:51], s22 offen offset:1024   lds
M v[40:43],a[112:115],a[168:171],0
M v[40:43],a[116:119],a[172:175],v[40:43]
M v[44:47],a[124:127],a[172:175],0
buffer_load_dwordx4 v14, s[48:51], s22 offen offset:2048   lds
M v[44:47],a[120:123],a[168:171],v[44:47]
M v[48:51],a[128:131],a[168:171],0
M v[48:51],a[132:135],a[172:175],v[48:51]
M v[52:55],a[140:143],a[172:175],0
buffer_load_dwordx4 v15, s[48:51], s22 offen offset:3072   lds
M v[52:55],a[136:139],a[168:171],v[52:55]
SA s22,s22,1048576
M v[56:59],a[144:147],a[168:171],0
M v[56:59],a[148:151],a[172:175],v[56:59]
s_waitcnt lgkmcnt(0)
M v[60:63],a[156:159],a[172:175],0
M v[60:63],a[152:155],a[168:171],v[60:63]
M v[64:67],a[96:99],a[160:163],0
R a[168:171],v5,6144
R a[172:175],v6,6144
M v[64:67],a[100:103],a[164:167],v[64:67]
M v[68:71],a[108:111],a[164:167],0
M v[68:71],a[104:107],a[160:163],v[68:71]
M v[72:75],a[112:115],a[160:163],0
M v[72:75],a[116:119],a[164:167],v[72:75]
M v[76:79],a[124:127],a[164:167],0
M v[76:79],a[120:123],a[160:163],v[76:79]
M v[80:83],a[128:131],a[160:163],0
M v[80:83],a[132:135],a[164:167],v[80:83]
M v[84:87],a[140:143],a[164:167],0
M v[84:87],a[136:139],a[160:163],v[84:87]
M v[88:91],a[144:147],a[160:163],0
M v[88:91],a[148:151],a[164:167],v[88:91]
s_waitcnt lgkmcnt(0)
M v[92:95],a[156:159],a[164:167],0
s_waitcnt vmcnt(12)
M v[92:95],a[152:155],a[160:163],v[92:95]
s_barrier
M v[96:99],a[96:99],a[168:171],0
SA m0,s23,0
R a[160:163],v5,16384
R a[164:167],v6,16384
M v[96:99],a[100:103],a[172:175],v[96:99]
buffer_load_dwordx4 v8, s[16:19], s21 offen offset:0   lds
M v[100:103],a[108:111],a[172:175],0
v_lshlrev_b32 v26, 7, v0
v_and_b32 v27, 48, v0
M v[100:103],a[104:107],a[168:171],v[100:103]
v_lshl_add_u32 v26, v27, 24, v26
M v[104:107],a[112:115],a[168:171],0
buffer_load_dwordx4 v9, s[16:19], s21 offen offset:1024   lds
M v[104:107],a[116:119],a[172:175],v[104:107]
M v[108:111],a[124:127],a[172:175],0
M v[108:111],a[120:123],a[168:171],v[108:111]
buffer_load_dwordx4 v10, s[16:19], s21 offen offset:2048   lds
M v[112:115],a[128:131],a[168:171],0
M v[112:115],a[132:135],a[172:175],v[112:115]
M v[116:119],a[140:143],a[172:175],0
M v[116:119],a[136:139],a[168:171],v[116:119]
buffer_load_dwordx4 v11, s[16:19], s21 offen offset:3072   lds
M v[120:123],a[144:147],a[168:171],0
SA s21,s21,128
M v[120:123],a[148:151],a[172:175],v[120:123]
s_waitcnt lgkmcnt(0)
M v[124:127],a[156:159],a[172:175],0
SA m0,s24,49152
M v[124:127],a[152:155],a[168:171],v[124:127]
buffer_load_dwordx4 v12, s[48:51], s22 offen offset:0   lds
M v[128:131],a[96:99],a[160:163],0
R a[168:171],v5,18432
R a[172:175],v6,18432
M v[128:131],a[100:103],a[164:167],v[128:131]
buffer_load_dwordx4 v13, s[48:51], s22 offen offset:1024   lds
M v[132:135],a[108:111],a[164:167],0
M v[132:135],a[104:107],a[160:163],v[132:135]
M v[136:139],a[112:115],a[160:163],0
M v[136:139],a[116:119],a[164:167],v[136:139]
buffer_load_dwordx4 v14, s[48:51], s22 offen offset:2048   lds
M v[140:143],a[124:127],a[164:167],0
M v[140:143],a[120:123],a[160:163],v[140:143]
M v[144:147],a[128:131],a[160:163],0
buffer_load_dwordx4 v15, s[48:51], s22 offen offset:3072   lds
M v[144:147],a[132:135],a[164:167],v[144:147]
s_sub_u32 s22, s22, 1048448
M v[148:151],a[140:143],a[164:167],0
M v[148:151],a[136:139],a[160:163],v[148:151]
M v[152:155],a[144:147],a[160:163],0
M v[152:155],a[148:151],a[164:167],v[152:155]
s_waitcnt lgkmcnt(0)
M v[156:159],a[156:159],a[164:167],0
s_waitcnt vmcnt(12)
M v[156:159],a[152:155],a[160:163],v[156:159]
s_barrier
M v[160:163],a[96:99],a[168:171],0
SA m0,s23,16384
R a[160:163],v5,20480
R a[164:167],v6,20480
M v[160:163],a[100:103],a[172:175],v[160:163]
T a[32:33],v1,32768
T a[34:35],v1,33792
M v[164:167],a[108:111],a[172:175],0
T a[36:37],v1,40960
T a[38:39],v1,41984
M v[164:167],a[104:107],a[168:171],v[164:167]
T a[40:41],v2,32768
T a[42:43],v2,33792
M v[168:171],a[112:115],a[168:171],0
T a[44:45],v2,40960
T a[46:47],v2,41984
M v[168:171],a[116:119],a[172:175],v[168:171]
buffer_load_dwordx4 v8, s[16:19], s21 offen offset:0   lds
M v[172:175],a[124:127],a[172:175],0
s_nop 0
T a[48:49],v3,32768
T a[50:51],v3,33792
M v[172:175],a[120:123],a[168:171],v[172:175]
buffer_load_dwordx4 v9, s[16:19], s21 offen offset:1024   lds
M v[176:179],a[128:131],a[168:171],0
s_nop 0
T a[52:53],v3,40960
T a[54:55],v3,41984
M v[176:179],a[132:135],a[172:175],v[176:179]
T a[56:57],v4,32768
T a[58:59],v4,33792
M v[180:183],a[140:143],a[172:175],0
buffer_load_dwordx4 v10, s[16:19], s21 offen offset:2048   lds
M v[180:183],a[136:139],a[168:171],v[180:183]
s_nop 0
T a[60:61],v4,40960
T a[62:63],v4,41984
M v[184:187],a[144:147],a[168:171],0
buffer_load_dwordx4 v11, s[16:19], s21 offen offset:3072   lds
M v[184:187],a[148:151],a[172:175],v[184:187]
s_waitcnt lgkmcnt(15)
s_nop 0
T a[64:65],v1,49152
T a[66:67],v1,50176
M v[188:191],a[156:159],a[172:175],0
SA s21,s21,524160
T a[68:69],v1,57344
T a[70:71],v1,58368
M v[188:191],a[152:155],a[168:171],v[188:191]
SA m0,s24,0
M v[192:195],a[96:99],a[160:163],0
R a[168:171],v5,22528
R a[172:175],v6,22528
M v[192:195],a[100:103],a[164:167],v[192:195]
T a[72:73],v2,49152
T a[74:75],v2,50176
M v[196:199],a[108:111],a[164:167],0
T a[76:77],v2,57344
T a[78:79],v2,58368
M v[196:199],a[104:107],a[160:163],v[196:199]
T a[80:81],v3,49152
T a[82:83],v3,50176
M v[200:203],a[112:115],a[160:163],0
buffer_load_dwordx4 v12, s[48:51], s22 offen offset:0   lds
M v[200:203],a[116:119],a[164:167],v[200:203]
s_nop 0
T a[84:85],v3,57344
T a[86:87],v3,58368
M v[204:207],a[124:127],a[164:167],0
T a[88:89],v4,49152
T a[90:91],v4,50176
M v[204:207],a[120:123],a[160:163],v[204:207]
buffer_load_dwordx4 v13, s[48:51], s22 offen offset:1024   lds
M v[208:211],a[128:131],a[160:163],0
s_nop 0
T a[92:93],v4,57344
T a[94:95],v4,58368
M v[208:211],a[132:135],a[164:167],v[208:211]
buffer_load_dwordx4 v14, s[48:51], s22 offen offset:2048   lds
M v[212:215],a[140:143],a[164:167],0
buffer_load_dwordx4 v15, s[48:51], s22 offen offset:3072   lds
M v[212:215],a[136:139],a[160:163],v[212:215]
SA s22,s22,1048576
M v[216:219],a[144:147],a[160:163],0
M v[216:219],a[148:151],a[164:167],v[216:219]
s_waitcnt lgkmcnt(12)
M v[220:223],a[156:159],a[164:167],0
s_waitcnt vmcnt(12) lgkmcnt(0)
M v[220:223],a[152:155],a[160:163],v[220:223]
s_barrier
M v[224:227],a[96:99],a[168:171],0
SA m0,s23,32768
R a[160:163],v5,32768
R a[164:167],v6,32768
M v[224:227],a[100:103],a[172:175],v[224:227]
buffer_load_dwordx4 v8, s[16:19], s21 offen offset:0   lds
M v[228:231],a[108:111],a[172:175],0
M v[228:231],a[104:107],a[168:171],v[228:231]
M v[232:235],a[112:115],a[168:171],0
buffer_load_dwordx4 v9, s[16:19], s21 offen offset:1024   lds
M v[232:235],a[116:119],a[172:175],v[232:235]
M v[236:239],a[124:127],a[172:175],0
M v[236:239],a[120:123],a[168:171],v[236:239]
buffer_load_dwordx4 v10, s[16:19], s21 offen offset:2048   lds
M v[240:243],a[128:131],a[168:171],0
M v[240:243],a[132:135],a[172:175],v[240:243]
M v[244:247],a[140:143],a[172:175],0
buffer_load_dwordx4 v11, s[16:19], s21 offen offset:3072   lds
M v[244:247],a[136:139],a[168:171],v[244:247]
SA s21,s21,128
M v[248:251],a[144:147],a[168:171],0
M v[248:251],a[148:151],a[172:175],v[248:251]
s_waitcnt lgkmcnt(0)
M v[252:255],a[156:159],a[172:175],0
M v[252:255],a[152:155],a[168:171],v[252:255]
M a[0:3],a[32:35],a[160:163],a[0:3]
R a[168:171],v5,34816
R a[172:175],v6,34816
M a[0:3],a[36:39],a[164:167],a[0:3]
T a[96:97],v1,0
T a[98:99],v1,1024
M a[4:7],a[44:47],a[164:167],a[4:7]
SA m0,s24,16384
M a[4:7],a[40:43],a[160:163],a[4:7]
buffer_load_dwordx4 v12, s[48:51], s22 offen offset:0   lds
M a[8:11],a[48:51],a[160:163],a[8:11]
M a[8:11],a[52:55],a[164:167],a[8:11]
M a[12:15],a[60:63],a[164:167],a[12:15]
s_nop 0
T a[100:101],v1,8192
T a[102:103],v1,9216
M a[12:15],a[56:59],a[160:163],a[12:15]
M a[16:19],a[64:67],a[160:163],a[16:19]
buffer_load_dwordx4 v13, s[48:51], s22 offen offset:1024   lds
M a[16:19],a[68:71],a[164:167],a[16:19]
M a[20:23],a[76:79],a[164:167],a[20:23]
M a[20:23],a[72:75],a[160:163],a[20:23]
s_nop 0
T a[104:105],v2,0
T a[106:107],v2,1024
M a[24:27],a[80:83],a[160:163],a[24:27]
M a[24:27],a[84:87],a[164:167],a[24:27]
s_waitcnt lgkmcnt(6)
buffer_load_dwordx4 v14, s[48:51], s22 offen offset:2048   lds
M a[28:31],a[92:95],a[164:167],a[28:31]
M a[28:31],a[88:91],a[160:163],a[28:31]
M v[60:63],a[88:91],a[168:171],v[60:63]
R a[160:163],v5,36864
R a[164:167],v6,36864
M v[60:63],a[92:95],a[172:175],v[60:63]
T a[108:109],v2,8192
T a[110:111],v2,9216
M v[56:59],a[84:87],a[172:175],v[56:59]
buffer_load_dwordx4 v15, s[48:51], s22 offen offset:3072   lds
M v[56:59],a[80:83],a[168:171],v[56:59]
s_sub_u32 s22, s22, 1048448
M v[52:55],a[72:75],a[168:171],v[52:55]
M v[52:55],a[76:79],a[172:175],v[52:55]
s_nop 0
T a[112:113],v3,0
T a[114:115],v3,1024
M v[48:51],a[68:71],a[172:175],v[48:51]
SA m0,s23,49152
M v[48:51],a[64:67],a[168:171],v[48:51]
buffer_load_dwordx4 v8, s[16:19], s21 offen offset:0   lds
M v[44:47],a[56:59],a[168:171],v[44:47]
M v[44:47],a[60:63],a[172:175],v[44:47]
M v[40:43],a[52:55],a[172:175],v[40:43]
s_nop 0
T a[116:117],v3,8192
T a[118:119],v3,9216
M v[40:43],a[48:51],a[168:171],v[40:43]
M v[36:39],a[40:43],a[168:171],v[36:39]
buffer_load_dwordx4 v9, s[16:19], s21 offen offset:1024   lds
M v[36:39],a[44:47],a[172:175],v[36:39]
s_waitcnt lgkmcnt(6)
M v[32:35],a[36:39],a[172:175],v[32:35]
M v[32:35],a[32:35],a[168:171],v[32:35]
s_nop 0
T a[120:121],v4,0
T a[122:123],v4,1024
M v[64:67],a[32:35],a[160:163],v[64:67]
R a[168:171],v5,38912
R a[172:175],v6,38912
M v[64:67],a[36:39],a[164:167],v[64:67]
buffer_load_dwordx4 v10, s[16:19], s21 offen offset:2048   lds
M v[68:71],a[44:47],a[164:167],v[68:71]
M v[68:71],a[40:43],a[160:163],v[68:71]
M v[72:75],a[48:51],a[160:163],v[72:75]
s_nop 0
T a[124:125],v4,8192
T a[126:127],v4,9216
M v[72:75],a[52:55],a[164:167],v[72:75]
M v[76:79],a[60:63],a[164:167],v[76:79]
buffer_load_dwordx4 v11, s[16:19], s21 offen offset:3072   lds
M v[76:79],a[56:59],a[160:163],v[76:79]
SA s21,s21,524160
M v[80:83],a[64:67],a[160:163],v[80:83]
M v[80:83],a[68:71],a[164:167],v[80:83]
M v[84:87],a[76:79],a[164:167],v[84:87]
M v[84:87],a[72:75],a[160:163],v[84:87]
M v[88:91],a[80:83],a[160:163],v[88:91]
M v[88:91],a[84:87],a[164:167],v[88:91]
s_waitcnt lgkmcnt(2)
M v[92:95],a[92:95],a[164:167],v[92:95]
s_waitcnt vmcnt(16) lgkmcnt(0)
M v[92:95],a[88:91],a[160:163],v[92:95]
s_barrier
M v[124:127],a[88:91],a[168:171],v[124:127]
R a[160:163],v5,49152
R a[164:167],v6,49152
M v[124:127],a[92:95],a[172:175],v[124:127]
M v[120:123],a[84:87],a[172:175],v[120:123]
SA m0,s24,32768
T a[128:129],v1,16384
T a[130:131],v1,17408
M v[120:123],a[80:83],a[168:171],v[120:123]
buffer_load_dwordx4 v12, s[48:51], s22 offen offset:0   lds
M v[116:119],a[72:75],a[168:171],v[116:119]
M v[116:119],a[76:79],a[172:175],v[116:119]
M v[112:115],a[68:71],a[172:175],v[112:115]
M v[112:115],a[64:67],a[168:171],v[112:115]
M v[108:111],a[56:59],a[168:171],v[108:111]
M v[108:111],a[60:63],a[172:175],v[108:111]
s_nop 0
T a[132:133],v1,24576
T a[134:135],v1,25600
M v[104:107],a[52:55],a[172:175],v[104:107]
buffer_load_dwordx4 v13, s[48:51], s22 offen offset:1024   lds
M v[104:107],a[48:51],a[168:171],v[104:107]
M v[100:103],a[40:43],a[168:171],v[100:103]
M v[100:103],a[44:47],a[172:175],v[100:103]
s_waitcnt lgkmcnt(4)
M v[96:99],a[36:39],a[172:175],v[96:99]
M v[96:99],a[32:35],a[168:171],v[96:99]
M v[128:131],a[32:35],a[160:163],v[128:131]
R a[168:171],v5,51200
R a[172:175],v6,51200
M v[128:131],a[36:39],a[164:167],v[128:131]
T a[136:137],v2,16384
T a[138:139],v2,17408
M v[132:135],a[44:47],a[164:167],v[132:135]
buffer_load_dwordx4 v14, s[48:51], s22 offen offset:2048   lds
M v[132:135],a[40:43],a[160:163],v[132:135]
M v[136:139],a[48:51],a[160:163],v[136:139]
M v[136:139],a[52:55],a[164:167],v[136:139]
M v[140:143],a[60:63],a[164:167],v[140:143]
M v[140:143],a[56:59],a[160:163],v[140:143]
s_nop 0
T a[140:141],v2,24576
T a[142:143],v2,25600
M v[144:147],a[64:67],a[160:163],v[144:147]
buffer_load_dwordx4 v15, s[48:51], s22 offen offset:3072   lds
M v[144:147],a[68:71],a[164:167],v[144:147]
SA s22,s22,1048576
M v[148:151],a[76:79],a[164:167],v[148:151]
M v[148:151],a[72:75],a[160:163],v[148:151]
M v[152:155],a[80:83],a[160:163],v[152:155]
M v[152:155],a[84:87],a[164:167],v[152:155]
s_waitcnt lgkmcnt(4)
M v[156:159],a[92:95],a[164:167],v[156:159]
SA m0,s23,0
T a[144:145],v3,16384
T a[146:147],v3,17408
M v[156:159],a[88:91],a[160:163],v[156:159]
buffer_load_dwordx4 v8, s[16:19], s21 offen offset:0   lds
M v[188:191],a[88:91],a[168:171],v[188:191]
R a[160:163],v5,53248
R a[164:167],v6,53248
M v[188:191],a[92:95],a[172:175],v[188:191]
M v[184:187],a[84:87],a[172:175],v[184:187]
M v[184:187],a[80:83],a[168:171],v[184:187]
M v[180:183],a[72:75],a[168:171],v[180:183]
M v[180:183],a[76:79],a[172:175],v[180:183]
s_nop 0
T a[148:149],v3,24576
T a[150:151],v3,25600
M v[176:179],a[68:71],a[172:175],v[176:179]
buffer_load_dwordx4 v9, s[16:19], s21 offen offset:1024   lds
M v[176:179],a[64:67],a[168:171],v[176:179]
M v[172:175],a[56:59],a[168:171],v[172:175]
M v[172:175],a[60:63],a[172:175],v[172:175]
M v[168:171],a[52:55],a[172:175],v[168:171]
M v[168:171],a[48:51],a[168:171],v[168:171]
M v[164:167],a[40:43],a[168:171],v[164:167]
s_nop 0
T a[152:153],v4,16384
T a[154:155],v4,17408
M v[164:167],a[44:47],a[172:175],v[164:167]
s_waitcnt lgkmcnt(4)
buffer_load_dwordx4 v10, s[16:19], s21 offen offset:2048   lds
M v[160:163],a[36:39],a[172:175],v[160:163]
M v[160:163],a[32:35],a[168:171],v[160:163]
M v[192:195],a[32:35],a[160:163],v[192:195]
R a[168:171],v5,55296
R a[172:175],v6,55296
M v[192:195],a[36:39],a[164:167],v[192:195]
M v[196:199],a[44:47],a[164:167],v[196:199]
M v[196:199],a[40:43],a[160:163],v[196:199]
s_nop 0
T a[156:157],v4,24576
T a[158:159],v4,25600
M v[200:203],a[48:51],a[160:163],v[200:203]
buffer_load_dwordx4 v11, s[16:19], s21 offen offset:3072   lds
M v[200:203],a[52:55],a[164:167],v[200:203]
SA s21,s21,128
M v[204:207],a[60:63],a[164:167],v[204:207]
M v[204:207],a[56:59],a[160:163],v[204:207]
M v[208:211],a[64:67],a[160:163],v[208:211]
M v[208:211],a[68:71],a[164:167],v[208:211]
M v[212:215],a[76:79],a[164:167],v[212:215]
M v[212:215],a[72:75],a[160:163],v[212:215]
M v[216:219],a[80:83],a[160:163],v[216:219]
M v[216:219],a[84:87],a[164:167],v[216:219]
s_waitcnt lgkmcnt(2)
M v[220:223],a[92:95],a[164:167],v[220:223]
s_waitcnt vmcnt(16) lgkmcnt(0)
M v[220:223],a[88:91],a[160:163],v[220:223]
s_barrier
M v[252:255],a[88:91],a[168:171],v[252:255]
R a[160:163],v5,0
R a[164:167],v6,0
M v[252:255],a[92:95],a[172:175],v[252:255]
v_min_u32 v16, 1, v0
v_lshlrev_b32 v16, 29, v16
M v[248:251],a[84:87],a[172:175],v[248:251]
v_or_b32 v16, s39, v16
v_mov_b32 v17, 1
M v[248:251],a[80:83],a[168:171],v[248:251]
buffer_store_dword v17, v16, s[12:15], s38 offen sc1
M v[244:247],a[72:75],a[168:171],v[244:247]
M v[244:247],a[76:79],a[172:175],v[244:247]
M v[240:243],a[68:71],a[172:175],v[240:243]
M v[240:243],a[64:67],a[168:171],v[240:243]
M v[236:239],a[56:59],a[168:171],v[236:239]
M v[236:239],a[60:63],a[172:175],v[236:239]
M v[232:235],a[52:55],a[172:175],v[232:235]
M v[232:235],a[48:51],a[168:171],v[232:235]
M v[228:231],a[40:43],a[168:171],v[228:231]
M v[228:231],a[44:47],a[172:175],v[228:231]
s_waitcnt lgkmcnt(0)
M v[224:227],a[36:39],a[172:175],v[224:227]
M v[224:227],a[32:35],a[168:171],v[224:227]
M a[0:3],a[96:99],a[160:163],a[0:3]
L_w_kv01:
s_cbranch_execz L_w_kv05
R a[168:171],v5,2048
R a[172:175],v6,2048
M a[0:3],a[100:103],a[164:167],a[0:3]
T a[32:33],v1,32768
T a[34:35],v1,33792
M a[4:7],a[108:111],a[164:167],a[4:7]
SA m0,s24,49152
M a[4:7],a[104:107],a[160:163],a[4:7]
buffer_load_dwordx4 v12, s[48:51], s22 offen offset:0   lds
M a[8:11],a[112:115],a[160:163],a[8:11]
M a[8:11],a[116:119],a[164:167],a[8:11]
M a[12:15],a[124:127],a[164:167],a[12:15]
s_nop 0
T a[36:37],v1,40960
T a[38:39],v1,41984
M a[12:15],a[120:123],a[160:163],a[12:15]
M a[16:19],a[128:131],a[160:163],a[16:19]
buffer_load_dwordx4 v13, s[48:51], s22 offen offset:1024   lds
M a[16:19],a[132:135],a[164:167],a[16:19]
M a[20:23],a[140:143],a[164:167],a[20:23]
M a[20:23],a[136:139],a[160:163],a[20:23]
s_nop 0
T a[40:41],v2,32768
T a[42:43],v2,33792
M a[24:27],a[144:147],a[160:163],a[24:27]
M a[24:27],a[148:151],a[164:167],a[24:27]
s_waitcnt lgkmcnt(6)
buffer_load_dwordx4 v14, s[48:51], s22 offen offset:2048   lds
M a[28:31],a[156:159],a[164:167],a[28:31]
M a[28:31],a[152:155],a[160:163],a[28:31]
M v[60:63],a[152:155],a[168:171],v[60:63]
R a[160:163],v5,4096
R a[164:167],v6,4096
M v[60:63],a[156:159],a[172:175],v[60:63]
T a[44:45],v2,40960
T a[46:47],v2,41984
M v[56:59],a[148:151],a[172:175],v[56:59]
buffer_load_dwordx4 v15, s[48:51], s22 offen offset:3072   lds
M v[56:59],a[144:147],a[168:171],v[56:59]
s_sub_u32 s22, s22, 1048448
M v[52:55],a[136:139],a[168:171],v[52:55]
M v[52:55],a[140:143],a[172:175],v[52:55]
s_nop 0
T a[48:49],v3,32768
T a[50:51],v3,33792
M v[48:51],a[132:135],a[172:175],v[48:51]
SA m0,s23,16384
M v[48:51],a[128:131],a[168:171],v[48:51]
buffer_load_dwordx4 v8, s[16:19], s21 offen offset:0   lds
M v[44:47],a[120:123],a[168:171],v[44:47]
M v[44:47],a[124:127],a[172:175],v[44:47]
M v[40:43],a[116:119],a[172:175],v[40:43]
s_nop 0
T a[52:53],v3,40960
T a[54:55],v3,41984
M v[40:43],a[112:115],a[168:171],v[40:43]
M v[36:39],a[104:107],a[168:171],v[36:39]
buffer_load_dwordx4 v9, s[16:19], s21 offen offset:1024   lds
M v[36:39],a[108:111],a[172:175],v[36:39]
s_waitcnt lgkmcnt(6)
M v[32:35],a[100:103],a[172:175],v[32:35]
M v[32:35],a[96:99],a[168:171],v[32:35]
s_nop 0
T a[56:57],v4,32768
T a[58:59],v4,33792
M v[64:67],a[96:99],a[160:163],v[64:67]
R a[168:171],v5,6144
R a[172:175],v6,6144
M v[64:67],a[100:103],a[164:167],v[64:67]
buffer_load_dwordx4 v10, s[16:19], s21 offen offset:2048   lds
M v[68:71],a[108:111],a[164:167],v[68:71]
M v[68:71],a[104:107],a[160:163],v[68:71]
M v[72:75],a[112:115],a[160:163],v[72:75]
s_nop 0
T a[60:61],v4,40960
T a[62:63],v4,41984
M v[72:75],a[116:119],a[164:167],v[72:75]
M v[76:79],a[124:127],a[164:167],v[76:79]
buffer_load_dwordx4 v11, s[16:19], s21 offen offset:3072   lds
M v[76:79],a[120:123],a[160:163],v[76:79]
SA s21,s21,524160
M v[80:83],a[128:131],a[160:163],v[80:83]
M v[80:83],a[132:135],a[164:167],v[80:83]
M v[84:87],a[140:143],a[164:167],v[84:87]
M v[84:87],a[136:139],a[160:163],v[84:87]
s_and_b32 s86, s41, 7
M v[88:91],a[144:147],a[160:163],v[88:91]
s_mul_i32 s86, s86, 14
s_lshr_b32 s64, s41, 3
s_mul_i32 s64, s64, 7
M v[88:91],a[148:151],a[164:167],v[88:91]
s_waitcnt lgkmcnt(2)
SA s86,s86,s64
s_min_u32 s64, s31, 6
M v[92:95],a[156:159],a[164:167],v[92:95]
s_waitcnt vmcnt(17) lgkmcnt(0)
SA s86,s86,s64
s_sub_u32 s64, 6, s31
M v[92:95],a[152:155],a[160:163],v[92:95]
s_barrier
M v[124:127],a[152:155],a[168:171],v[124:127]
R a[160:163],v5,16384
R a[164:167],v6,16384
M v[124:127],a[156:159],a[172:175],v[124:127]
s_and_b32 s88, s64, 536870912
s_mul_i32 s87, s20, 7168
M v[120:123],a[148:151],a[172:175],v[120:123]
SA m0,s24,0
T a[64:65],v1,49152
T a[66:67],v1,50176
M v[120:123],a[144:147],a[168:171],v[120:123]
buffer_load_dwordx4 v12, s[48:51], s22 offen offset:0   lds
M v[116:119],a[136:139],a[168:171],v[116:119]
SA s87,s87,131072
M v[116:119],a[140:143],a[172:175],v[116:119]
s_cmp_lt_u32 s20, 2
M v[112:115],a[132:135],a[172:175],v[112:115]
s_cselect_b64 s[72:73], s[80:81], s[82:83]
M v[112:115],a[128:131],a[168:171],v[112:115]
s_mov_b32 s60, s72
M v[108:111],a[120:123],a[168:171],v[108:111]
s_and_b32 s61, s73, 0xffff
M v[108:111],a[124:127],a[172:175],v[108:111]
s_mov_b32 s62, 1605632
T a[68:69],v1,57344
T a[70:71],v1,58368
M v[104:107],a[116:119],a[172:175],v[104:107]
s_mov_b32 s63, 0x20000
buffer_load_dwordx4 v13, s[48:51], s22 offen offset:1024   lds
M v[104:107],a[112:115],a[168:171],v[104:107]
s_mov_b32 s68, s84
M v[100:103],a[104:107],a[168:171],v[100:103]
s_and_b32 s69, s85, 0xffff
s_mov_b32 s70, 1605632
s_mov_b32 s71, 0x20000
M v[100:103],a[108:111],a[172:175],v[100:103]
s_waitcnt lgkmcnt(4)
s_lshl_b32 s89, s86, 5
M v[96:99],a[100:103],a[172:175],v[96:99]
s_and_b32 s64, s20, 1
M v[96:99],a[96:99],a[168:171],v[96:99]
s_mul_i32 s64, s64, 802816
M v[128:131],a[96:99],a[160:163],v[128:131]
SA s89,s89,s64
R a[168:171],v5,18432
R a[172:175],v6,18432
M v[128:131],a[100:103],a[164:167],v[128:131]
T a[72:73],v2,49152
T a[74:75],v2,50176
M v[132:135],a[108:111],a[164:167],v[132:135]
buffer_load_dwordx4 v14, s[48:51], s22 offen offset:2048   lds
M v[132:135],a[104:107],a[160:163],v[132:135]
v_lshrrev_b32 v28, 1, v0
v_mul_u32_u24 v28, 3584, v28
M v[136:139],a[112:115],a[160:163],v[136:139]
v_and_b32 v29, 1, v0
v_lshl_add_u32 v25, v29, 4, v28
M v[136:139],a[116:119],a[164:167],v[136:139]
v_or_b32 v25, s88, v25
M v[140:143],a[124:127],a[164:167],v[140:143]
M v[140:143],a[120:123],a[160:163],v[140:143]
s_nop 0
T a[76:77],v2,57344
T a[78:79],v2,58368
M v[144:147],a[128:131],a[160:163],v[144:147]
buffer_load_dwordx4 v15, s[48:51], s22 offen offset:3072   lds
M v[144:147],a[132:135],a[164:167],v[144:147]
SA s22,s22,1048576
M v[148:151],a[140:143],a[164:167],v[148:151]
M v[148:151],a[136:139],a[160:163],v[148:151]
M v[152:155],a[144:147],a[160:163],v[152:155]
M v[152:155],a[148:151],a[164:167],v[152:155]
s_waitcnt lgkmcnt(4)
M v[156:159],a[156:159],a[164:167],v[156:159]
SA m0,s23,32768
T a[80:81],v3,49152
T a[82:83],v3,50176
M v[156:159],a[152:155],a[160:163],v[156:159]
buffer_load_dwordx4 v8, s[16:19], s21 offen offset:0   lds
M v[188:191],a[152:155],a[168:171],v[188:191]
R a[160:163],v5,20480
R a[164:167],v6,20480
M v[188:191],a[156:159],a[172:175],v[188:191]
M v[184:187],a[148:151],a[172:175],v[184:187]
M v[184:187],a[144:147],a[168:171],v[184:187]
M v[180:183],a[136:139],a[168:171],v[180:183]
M v[180:183],a[140:143],a[172:175],v[180:183]
s_nop 0
T a[84:85],v3,57344
T a[86:87],v3,58368
M v[176:179],a[132:135],a[172:175],v[176:179]
buffer_load_dwordx4 v9, s[16:19], s21 offen offset:1024   lds
M v[176:179],a[128:131],a[168:171],v[176:179]
M v[172:175],a[120:123],a[168:171],v[172:175]
M v[172:175],a[124:127],a[172:175],v[172:175]
M v[168:171],a[116:119],a[172:175],v[168:171]
M v[168:171],a[112:115],a[168:171],v[168:171]
M v[164:167],a[104:107],a[168:171],v[164:167]
s_nop 0
T a[88:89],v4,49152
T a[90:91],v4,50176
M v[164:167],a[108:111],a[172:175],v[164:167]
s_waitcnt lgkmcnt(4)
buffer_load_dwordx4 v10, s[16:19], s21 offen offset:2048   lds
M v[160:163],a[100:103],a[172:175],v[160:163]
M v[160:163],a[96:99],a[168:171],v[160:163]
M v[192:195],a[96:99],a[160:163],v[192:195]
R a[168:171],v5,22528
R a[172:175],v6,22528
M v[192:195],a[100:103],a[164:167],v[192:195]
M v[196:199],a[108:111],a[164:167],v[196:199]
M v[196:199],a[104:107],a[160:163],v[196:199]
s_nop 0
T a[92:93],v4,57344
T a[94:95],v4,58368
M v[200:203],a[112:115],a[160:163],v[200:203]
buffer_load_dwordx4 v11, s[16:19], s21 offen offset:3072   lds
M v[200:203],a[116:119],a[164:167],v[200:203]
SA s21,s21,128
M v[204:207],a[124:127],a[164:167],v[204:207]
M v[204:207],a[120:123],a[160:163],v[204:207]
M v[208:211],a[128:131],a[160:163],v[208:211]
M v[208:211],a[132:135],a[164:167],v[208:211]
M v[212:215],a[140:143],a[164:167],v[212:215]
M v[212:215],a[136:139],a[160:163],v[212:215]
M v[216:219],a[144:147],a[160:163],v[216:219]
M v[216:219],a[148:151],a[164:167],v[216:219]
s_waitcnt lgkmcnt(2)
M v[220:223],a[156:159],a[164:167],v[220:223]
s_waitcnt vmcnt(17) lgkmcnt(0)
M v[220:223],a[152:155],a[160:163],v[220:223]
s_barrier
M v[252:255],a[152:155],a[168:171],v[252:255]
R a[160:163],v5,32768
R a[164:167],v6,32768
M v[252:255],a[156:159],a[172:175],v[252:255]
M v[248:251],a[148:151],a[172:175],v[248:251]
M v[248:251],a[144:147],a[168:171],v[248:251]
M v[244:247],a[136:139],a[168:171],v[244:247]
M v[244:247],a[140:143],a[172:175],v[244:247]
M v[240:243],a[132:135],a[172:175],v[240:243]
M v[240:243],a[128:131],a[168:171],v[240:243]
M v[236:239],a[120:123],a[168:171],v[236:239]
M v[236:239],a[124:127],a[172:175],v[236:239]
M v[232:235],a[116:119],a[172:175],v[232:235]
M v[232:235],a[112:115],a[168:171],v[232:235]
M v[228:231],a[104:107],a[168:171],v[228:231]
M v[228:231],a[108:111],a[172:175],v[228:231]
s_waitcnt lgkmcnt(0)
M v[224:227],a[100:103],a[172:175],v[224:227]
M v[224:227],a[96:99],a[168:171],v[224:227]
M a[0:3],a[32:35],a[160:163],a[0:3]
R a[168:171],v5,34816
R a[172:175],v6,34816
M a[0:3],a[36:39],a[164:167],a[0:3]
T a[96:97],v1,0
T a[98:99],v1,1024
M a[4:7],a[44:47],a[164:167],a[4:7]
SA m0,s24,16384
M a[4:7],a[40:43],a[160:163],a[4:7]
buffer_load_dwordx4 v12, s[48:51], s22 offen offset:0   lds
M a[8:11],a[48:51],a[160:163],a[8:11]
M a[8:11],a[52:55],a[164:167],a[8:11]
M a[12:15],a[60:63],a[164:167],a[12:15]
s_nop 0
T a[100:101],v1,8192
T a[102:103],v1,9216
M a[12:15],a[56:59],a[160:163],a[12:15]
buffer_load_dwordx4 v13, s[48:51], s22 offen offset:1024   lds
M a[16:19],a[64:67],a[160:163],a[16:19]
M a[16:19],a[68:71],a[164:167],a[16:19]
M a[20:23],a[76:79],a[164:167],a[20:23]
M a[20:23],a[72:75],a[160:163],a[20:23]
s_nop 0
T a[104:105],v2,0
T a[106:107],v2,1024
M a[24:27],a[80:83],a[160:163],a[24:27]
buffer_load_dwordx4 v14, s[48:51], s22 offen offset:2048   lds
M a[24:27],a[84:87],a[164:167],a[24:27]
s_waitcnt lgkmcnt(6)
M a[28:31],a[92:95],a[164:167],a[28:31]
M a[28:31],a[88:91],a[160:163],a[28:31]
M v[60:63],a[88:91],a[168:171],v[60:63]
R a[160:163],v5,36864
R a[164:167],v6,36864
M v[60:63],a[92:95],a[172:175],v[60:63]
T a[108:109],v2,8192
T a[110:111],v2,9216
M v[56:59],a[84:87],a[172:175],v[56:59]
buffer_load_dwordx4 v15, s[48:51], s22 offen offset:3072   lds
M v[56:59],a[80:83],a[168:171],v[56:59]
s_sub_u32 s22, s22, 1048448
M v[52:55],a[72:75],a[168:171],v[52:55]
SA m0,s23,49152
M v[52:55],a[76:79],a[172:175],v[52:55]
s_nop 0
T a[112:113],v3,0
T a[114:115],v3,1024
M v[48:51],a[68:71],a[172:175],v[48:51]
buffer_load_dwordx4 v8, s[16:19], s21 offen offset:0   lds
M v[48:51],a[64:67],a[168:171],v[48:51]
M v[44:47],a[56:59],a[168:171],v[44:47]
M v[44:47],a[60:63],a[172:175],v[44:47]
buffer_load_dwordx4 v9, s[16:19], s21 offen offset:1024   lds
M v[40:43],a[52:55],a[172:175],v[40:43]
s_nop 0
T a[116:117],v3,8192
T a[118:119],v3,9216
M v[40:43],a[48:51],a[168:171],v[40:43]
M v[36:39],a[40:43],a[168:171],v[36:39]
M v[36:39],a[44:47],a[172:175],v[36:39]
s_waitcnt lgkmcnt(6)
M v[32:35],a[36:39],a[172:175],v[32:35]
buffer_load_dwordx4 v10, s[16:19], s21 offen offset:2048   lds
M v[32:35],a[32:35],a[168:171],v[32:35]
s_nop 0
T a[120:121],v4,0
T a[122:123],v4,1024
M v[64:67],a[32:35],a[160:163],v[64:67]
R a[168:171],v5,38912
R a[172:175],v6,38912
M v[64:67],a[36:39],a[164:167],v[64:67]
M v[68:71],a[44:47],a[164:167],v[68:71]
buffer_load_dwordx4 v11, s[16:19], s21 offen offset:3072   lds
M v[68:71],a[40:43],a[160:163],v[68:71]
SA s21,s21,524160
M v[72:75],a[48:51],a[160:163],v[72:75]
s_nop 0
T a[124:125],v4,8192
T a[126:127],v4,9216
M v[72:75],a[52:55],a[164:167],v[72:75]
M v[76:79],a[60:63],a[164:167],v[76:79]
SA m0,s87,0
M v[76:79],a[56:59],a[160:163],v[76:79]
buffer_load_dwordx4 v25, s[60:63], s89 offen offset:0  lds
M v[80:83],a[64:67],a[160:163],v[80:83]
SA s89,s89,114688
M v[80:83],a[68:71],a[164:167],v[80:83]
M v[84:87],a[76:79],a[164:167],v[84:87]
M v[84:87],a[72:75],a[160:163],v[84:87]
M v[88:91],a[80:83],a[160:163],v[88:91]
M v[88:91],a[84:87],a[164:167],v[88:91]
s_waitcnt lgkmcnt(2)
M v[92:95],a[92:95],a[164:167],v[92:95]
s_waitcnt vmcnt(17) lgkmcnt(0)
M v[92:95],a[88:91],a[160:163],v[92:95]
s_barrier
M v[124:127],a[88:91],a[168:171],v[124:127]
R a[160:163],v5,49152
R a[164:167],v6,49152
M v[124:127],a[92:95],a[172:175],v[124:127]
M v[120:123],a[84:87],a[172:175],v[120:123]
SA m0,s24,32768
T a[128:129],v1,16384
T a[130:131],v1,17408
M v[120:123],a[80:83],a[168:171],v[120:123]
buffer_load_dwordx4 v12, s[48:51], s22 offen offset:0   lds
M v[116:119],a[72:75],a[168:171],v[116:119]
v_min_u32 v16, 40, v0
v_lshlrev_b32 v16, 2, v16
M v[116:119],a[76:79],a[172:175],v[116:119]
buffer_load_dword v17, v16, s[12:15], 0 offen sc1
M v[112:115],a[68:71],a[172:175],v[112:115]
M v[112:115],a[64:67],a[168:171],v[112:115]
M v[108:111],a[56:59],a[168:171],v[108:111]
M v[108:111],a[60:63],a[172:175],v[108:111]
s_nop 0
T a[132:133],v1,24576
T a[134:135],v1,25600
M v[104:107],a[52:55],a[172:175],v[104:107]
buffer_load_dwordx4 v13, s[48:51], s22 offen offset:1024   lds
M v[104:107],a[48:51],a[168:171],v[104:107]
M v[100:103],a[40:43],a[168:171],v[100:103]
M v[100:103],a[44:47],a[172:175],v[100:103]
s_waitcnt lgkmcnt(4)
M v[96:99],a[36:39],a[172:175],v[96:99]
M v[96:99],a[32:35],a[168:171],v[96:99]
M v[128:131],a[32:35],a[160:163],v[128:131]
R a[168:171],v5,51200
R a[172:175],v6,51200
M v[128:131],a[36:39],a[164:167],v[128:131]
T a[136:137],v2,16384
T a[138:139],v2,17408
M v[132:135],a[44:47],a[164:167],v[132:135]
buffer_load_dwordx4 v14, s[48:51], s22 offen offset:2048   lds
M v[132:135],a[40:43],a[160:163],v[132:135]
M v[136:139],a[48:51],a[160:163],v[136:139]
M v[136:139],a[52:55],a[164:167],v[136:139]
M v[140:143],a[60:63],a[164:167],v[140:143]
M v[140:143],a[56:59],a[160:163],v[140:143]
s_nop 0
T a[140:141],v2,24576
T a[142:143],v2,25600
M v[144:147],a[64:67],a[160:163],v[144:147]
buffer_load_dwordx4 v15, s[48:51], s22 offen offset:3072   lds
M v[144:147],a[68:71],a[164:167],v[144:147]
SA s22,s22,1048576
M v[148:151],a[76:79],a[164:167],v[148:151]
M v[148:151],a[72:75],a[160:163],v[148:151]
M v[152:155],a[80:83],a[160:163],v[152:155]
M v[152:155],a[84:87],a[164:167],v[152:155]
s_waitcnt lgkmcnt(4)
M v[156:159],a[92:95],a[164:167],v[156:159]
SA m0,s23,0
T a[144:145],v3,16384
T a[146:147],v3,17408
M v[156:159],a[88:91],a[160:163],v[156:159]
buffer_load_dwordx4 v8, s[16:19], s21 offen offset:0   lds
M v[188:191],a[88:91],a[168:171],v[188:191]
R a[160:163],v5,53248
R a[164:167],v6,53248
M v[188:191],a[92:95],a[172:175],v[188:191]
M v[184:187],a[84:87],a[172:175],v[184:187]
M v[184:187],a[80:83],a[168:171],v[184:187]
M v[180:183],a[72:75],a[168:171],v[180:183]
M v[180:183],a[76:79],a[172:175],v[180:183]
s_nop 0
T a[148:149],v3,24576
T a[150:151],v3,25600
M v[176:179],a[68:71],a[172:175],v[176:179]
buffer_load_dwordx4 v9, s[16:19], s21 offen offset:1024   lds
M v[176:179],a[64:67],a[168:171],v[176:179]
M v[172:175],a[56:59],a[168:171],v[172:175]
M v[172:175],a[60:63],a[172:175],v[172:175]
M v[168:171],a[52:55],a[172:175],v[168:171]
M v[168:171],a[48:51],a[168:171],v[168:171]
M v[164:167],a[40:43],a[168:171],v[164:167]
s_nop 0
T a[152:153],v4,16384
T a[154:155],v4,17408
M v[164:167],a[44:47],a[172:175],v[164:167]
s_waitcnt lgkmcnt(4)
buffer_load_dwordx4 v10, s[16:19], s21 offen offset:2048   lds
M v[160:163],a[36:39],a[172:175],v[160:163]
M v[160:163],a[32:35],a[168:171],v[160:163]
M v[192:195],a[32:35],a[160:163],v[192:195]
R a[168:171],v5,55296
R a[172:175],v6,55296
M v[192:195],a[36:39],a[164:167],v[192:195]
M v[196:199],a[44:47],a[164:167],v[196:199]
M v[196:199],a[40:43],a[160:163],v[196:199]
s_nop 0
T a[156:157],v4,24576
T a[158:159],v4,25600
M v[200:203],a[48:51],a[160:163],v[200:203]
buffer_load_dwordx4 v11, s[16:19], s21 offen offset:3072   lds
M v[200:203],a[52:55],a[164:167],v[200:203]
SA s21,s21,128
M v[204:207],a[60:63],a[164:167],v[204:207]
M v[204:207],a[56:59],a[160:163],v[204:207]
M v[208:211],a[64:67],a[160:163],v[208:211]
M v[208:211],a[68:71],a[164:167],v[208:211]
M v[212:215],a[76:79],a[164:167],v[212:215]
M v[212:215],a[72:75],a[160:163],v[212:215]
M v[216:219],a[80:83],a[160:163],v[216:219]
M v[216:219],a[84:87],a[164:167],v[216:219]
s_waitcnt lgkmcnt(2)
M v[220:223],a[92:95],a[164:167],v[220:223]
s_waitcnt vmcnt(18) lgkmcnt(0)
M v[220:223],a[88:91],a[160:163],v[220:223]
s_barrier
M v[252:255],a[88:91],a[168:171],v[252:255]
R a[160:163],v5,0
R a[164:167],v6,0
M v[252:255],a[92:95],a[172:175],v[252:255]
M v[248:251],a[84:87],a[172:175],v[248:251]
M v[248:251],a[80:83],a[168:171],v[248:251]
M v[244:247],a[72:75],a[168:171],v[244:247]
M v[244:247],a[76:79],a[172:175],v[244:247]
M v[240:243],a[68:71],a[172:175],v[240:243]
M v[240:243],a[64:67],a[168:171],v[240:243]
M v[236:239],a[56:59],a[168:171],v[236:239]
M v[236:239],a[60:63],a[172:175],v[236:239]
M v[232:235],a[52:55],a[172:175],v[232:235]
M v[232:235],a[48:51],a[168:171],v[232:235]
M v[228:231],a[40:43],a[168:171],v[228:231]
M v[228:231],a[44:47],a[172:175],v[228:231]
s_waitcnt lgkmcnt(0)
M v[224:227],a[36:39],a[172:175],v[224:227]
M v[224:227],a[32:35],a[168:171],v[224:227]
M a[0:3],a[96:99],a[160:163],a[0:3]
R a[168:171],v5,2048
R a[172:175],v6,2048
M a[0:3],a[100:103],a[164:167],a[0:3]
T a[32:33],v1,32768
T a[34:35],v1,33792
M a[4:7],a[108:111],a[164:167],a[4:7]
SA m0,s24,49152
M a[4:7],a[104:107],a[160:163],a[4:7]
buffer_load_dwordx4 v12, s[48:51], s22 offen offset:0   lds
M a[8:11],a[112:115],a[160:163],a[8:11]
M a[8:11],a[116:119],a[164:167],a[8:11]
M a[12:15],a[124:127],a[164:167],a[12:15]
s_nop 0
T a[36:37],v1,40960
T a[38:39],v1,41984
M a[12:15],a[120:123],a[160:163],a[12:15]
buffer_load_dwordx4 v13, s[48:51], s22 offen offset:1024   lds
M a[16:19],a[128:131],a[160:163],a[16:19]
M a[16:19],a[132:135],a[164:167],a[16:19]
M a[20:23],a[140:143],a[164:167],a[20:23]
M a[20:23],a[136:139],a[160:163],a[20:23]
s_nop 0
T a[40:41],v2,32768
T a[42:43],v2,33792
M a[24:27],a[144:147],a[160:163],a[24:27]
buffer_load_dwordx4 v14, s[48:51], s22 offen offset:2048   lds
M a[24:27],a[148:151],a[164:167],a[24:27]
s_waitcnt lgkmcnt(6)
M a[28:31],a[156:159],a[164:167],a[28:31]
M a[28:31],a[152:155],a[160:163],a[28:31]
M v[60:63],a[152:155],a[168:171],v[60:63]
R a[160:163],v5,4096
R a[164:167],v6,4096
M v[60:63],a[156:159],a[172:175],v[60:63]
T a[44:45],v2,40960
T a[46:47],v2,41984
M v[56:59],a[148:151],a[172:175],v[56:59]
buffer_load_dwordx4 v15, s[48:51], s22 offen offset:3072   lds
M v[56:59],a[144:147],a[168:171],v[56:59]
s_sub_u32 s22, s22, 1048448
M v[52:55],a[136:139],a[168:171],v[52:55]
SA m0,s23,16384
M v[52:55],a[140:143],a[172:175],v[52:55]
s_nop 0
T a[48:49],v3,32768
T a[50:51],v3,33792
M v[48:51],a[132:135],a[172:175],v[48:51]
buffer_load_dwordx4 v8, s[16:19], s21 offen offset:0   lds
M v[48:51],a[128:131],a[168:171],v[48:51]
M v[44:47],a[120:123],a[168:171],v[44:47]
M v[44:47],a[124:127],a[172:175],v[44:47]
buffer_load_dwordx4 v9, s[16:19], s21 offen offset:1024   lds
M v[40:43],a[116:119],a[172:175],v[40:43]
s_nop 0
T a[52:53],v3,40960
T a[54:55],v3,41984
M v[40:43],a[112:115],a[168:171],v[40:43]
M v[36:39],a[104:107],a[168:171],v[36:39]
M v[36:39],a[108:111],a[172:175],v[36:39]
s_waitcnt lgkmcnt(6)
M v[32:35],a[100:103],a[172:175],v[32:35]
buffer_load_dwordx4 v10, s[16:19], s21 offen offset:2048   lds
M v[32:35],a[96:99],a[168:171],v[32:35]
s_nop 0
T a[56:57],v4,32768
T a[58:59],v4,33792
M v[64:67],a[96:99],a[160:163],v[64:67]
R a[168:171],v5,6144
L_w_kv02:
s_cbranch_execz L_w_kv06
R a[172:175],v6,6144
M v[64:67],a[100:103],a[164:167],v[64:67]
M v[68:71],a[108:111],a[164:167],v[68:71]
buffer_load_dwordx4 v11, s[16:19], s21 offen offset:3072   lds
M v[68:71],a[104:107],a[160:163],v[68:71]
SA s21,s21,524160
M v[72:75],a[112:115],a[160:163],v[72:75]
s_nop 0
T a[60:61],v4,40960
T a[62:63],v4,41984
M v[72:75],a[116:119],a[164:167],v[72:75]
M v[76:79],a[124:127],a[164:167],v[76:79]
SA m0,s87,1024
M v[76:79],a[120:123],a[160:163],v[76:79]
buffer_load_dwordx4 v25, s[60:63], s89 offen offset:0  lds
M v[80:83],a[128:131],a[160:163],v[80:83]
SA s89,s89,114688
M v[80:83],a[132:135],a[164:167],v[80:83]
M v[84:87],a[140:143],a[164:167],v[84:87]
M v[84:87],a[136:139],a[160:163],v[84:87]
M v[88:91],a[144:147],a[160:163],v[88:91]
M v[88:91],a[148:151],a[164:167],v[88:91]
s_waitcnt lgkmcnt(2)
M v[92:95],a[156:159],a[164:167],v[92:95]
s_waitcnt vmcnt(19) lgkmcnt(0)
M v[92:95],a[152:155],a[160:163],v[92:95]
s_barrier
M v[124:127],a[152:155],a[168:171],v[124:127]
R a[160:163],v5,16384
R a[164:167],v6,16384
M v[124:127],a[156:159],a[172:175],v[124:127]
M v[120:123],a[148:151],a[172:175],v[120:123]
SA m0,s24,0
T a[64:65],v1,49152
T a[66:67],v1,50176
M v[120:123],a[144:147],a[168:171],v[120:123]
buffer_load_dwordx4 v12, s[48:51], s22 offen offset:0   lds
M v[116:119],a[136:139],a[168:171],v[116:119]
M v[116:119],a[140:143],a[172:175],v[116:119]
M v[112:115],a[132:135],a[172:175],v[112:115]
M v[112:115],a[128:131],a[168:171],v[112:115]
M v[108:111],a[120:123],a[168:171],v[108:111]
M v[108:111],a[124:127],a[172:175],v[108:111]
s_nop 0
T a[68:69],v1,57344
T a[70:71],v1,58368
M v[104:107],a[116:119],a[172:175],v[104:107]
buffer_load_dwordx4 v13, s[48:51], s22 offen offset:1024   lds
M v[104:107],a[112:115],a[168:171],v[104:107]
M v[100:103],a[104:107],a[168:171],v[100:103]
M v[100:103],a[108:111],a[172:175],v[100:103]
s_waitcnt lgkmcnt(4)
M v[96:99],a[100:103],a[172:175],v[96:99]
M v[96:99],a[96:99],a[168:171],v[96:99]
M v[128:131],a[96:99],a[160:163],v[128:131]
R a[168:171],v5,18432
R a[172:175],v6,18432
M v[128:131],a[100:103],a[164:167],v[128:131]
T a[72:73],v2,49152
T a[74:75],v2,50176
M v[132:135],a[108:111],a[164:167],v[132:135]
buffer_load_dwordx4 v14, s[48:51], s22 offen offset:2048   lds
M v[132:135],a[104:107],a[160:163],v[132:135]
M v[136:139],a[112:115],a[160:163],v[136:139]
M v[136:139],a[116:119],a[164:167],v[136:139]
M v[140:143],a[124:127],a[164:167],v[140:143]
M v[140:143],a[120:123],a[160:163],v[140:143]
s_nop 0
T a[76:77],v2,57344
T a[78:79],v2,58368
M v[144:147],a[128:131],a[160:163],v[144:147]
buffer_load_dwordx4 v15, s[48:51], s22 offen offset:3072   lds
M v[144:147],a[132:135],a[164:167],v[144:147]
SA s22,s22,1048576
M v[148:151],a[140:143],a[164:167],v[148:151]
M v[148:151],a[136:139],a[160:163],v[148:151]
M v[152:155],a[144:147],a[160:163],v[152:155]
M v[152:155],a[148:151],a[164:167],v[152:155]
s_waitcnt lgkmcnt(4)
M v[156:159],a[156:159],a[164:167],v[156:159]
SA m0,s23,32768
T a[80:81],v3,49152
T a[82:83],v3,50176
M v[156:159],a[152:155],a[160:163],v[156:159]
buffer_load_dwordx4 v8, s[16:19], s21 offen offset:0   lds
M v[188:191],a[152:155],a[168:171],v[188:191]
R a[160:163],v5,20480
R a[164:167],v6,20480
M v[188:191],a[156:159],a[172:175],v[188:191]
M v[184:187],a[148:151],a[172:175],v[184:187]
M v[184:187],a[144:147],a[168:171],v[184:187]
M v[180:183],a[136:139],a[168:171],v[180:183]
M v[180:183],a[140:143],a[172:175],v[180:183]
s_nop 0
T a[84:85],v3,57344
T a[86:87],v3,58368
M v[176:179],a[132:135],a[172:175],v[176:179]
buffer_load_dwordx4 v9, s[16:19], s21 offen offset:1024   lds
M v[176:179],a[128:131],a[168:171],v[176:179]
M v[172:175],a[120:123],a[168:171],v[172:175]
M v[172:175],a[124:127],a[172:175],v[172:175]
M v[168:171],a[116:119],a[172:175],v[168:171]
M v[168:171],a[112:115],a[168:171],v[168:171]
M v[164:167],a[104:107],a[168:171],v[164:167]
s_nop 0
T a[88:89],v4,49152
T a[90:91],v4,50176
M v[164:167],a[108:111],a[172:175],v[164:167]
s_waitcnt lgkmcnt(4)
buffer_load_dwordx4 v10, s[16:19], s21 offen offset:2048   lds
M v[160:163],a[100:103],a[172:175],v[160:163]
M v[160:163],a[96:99],a[168:171],v[160:163]
M v[192:195],a[96:99],a[160:163],v[192:195]
R a[168:171],v5,22528
R a[172:175],v6,22528
M v[192:195],a[100:103],a[164:167],v[192:195]
M v[196:199],a[108:111],a[164:167],v[196:199]
M v[196:199],a[104:107],a[160:163],v[196:199]
s_nop 0
T a[92:93],v4,57344
T a[94:95],v4,58368
M v[200:203],a[112:115],a[160:163],v[200:203]
buffer_load_dwordx4 v11, s[16:19], s21 offen offset:3072   lds
M v[200:203],a[116:119],a[164:167],v[200:203]
SA s21,s21,128
M v[204:207],a[124:127],a[164:167],v[204:207]
M v[204:207],a[120:123],a[160:163],v[204:207]
M v[208:211],a[128:131],a[160:163],v[208:211]
M v[208:211],a[132:135],a[164:167],v[208:211]
M v[212:215],a[140:143],a[164:167],v[212:215]
M v[212:215],a[136:139],a[160:163],v[212:215]
M v[216:219],a[144:147],a[160:163],v[216:219]
M v[216:219],a[148:151],a[164:167],v[216:219]
s_waitcnt lgkmcnt(2)
M v[220:223],a[156:159],a[164:167],v[220:223]
s_waitcnt vmcnt(17) lgkmcnt(0)
M v[220:223],a[152:155],a[160:163],v[220:223]
s_barrier
M v[252:255],a[152:155],a[168:171],v[252:255]
R a[160:163],v5,32768
R a[164:167],v6,32768
M v[252:255],a[156:159],a[172:175],v[252:255]
v_cmp_ne_u32 vcc, 1, v17
M v[248:251],a[148:151],a[172:175],v[248:251]
s_nop 0
M v[248:251],a[144:147],a[168:171],v[248:251]
s_cbranch_vccnz L_zs0
L_zr0:
M v[244:247],a[136:139],a[168:171],v[244:247]
M v[244:247],a[140:143],a[172:175],v[244:247]
M v[240:243],a[132:135],a[172:175],v[240:243]
M v[240:243],a[128:131],a[168:171],v[240:243]
M v[236:239],a[120:123],a[168:171],v[236:239]
M v[236:239],a[124:127],a[172:175],v[236:239]
M v[232:235],a[116:119],a[172:175],v[232:235]
M v[232:235],a[112:115],a[168:171],v[232:235]
M v[228:231],a[104:107],a[168:171],v[228:231]
M v[228:231],a[108:111],a[172:175],v[228:231]
s_waitcnt lgkmcnt(0)
M v[224:227],a[100:103],a[172:175],v[224:227]
M v[224:227],a[96:99],a[168:171],v[224:227]
M a[0:3],a[32:35],a[160:163],a[0:3]
R a[168:171],v5,34816
R a[172:175],v6,34816
M a[0:3],a[36:39],a[164:167],a[0:3]
T a[96:97],v1,0
T a[98:99],v1,1024
M a[4:7],a[44:47],a[164:167],a[4:7]
SA m0,s24,16384
M a[4:7],a[40:43],a[160:163],a[4:7]
buffer_load_dwordx4 v12, s[48:51], s22 offen offset:0   lds
M a[8:11],a[48:51],a[160:163],a[8:11]
M a[8:11],a[52:55],a[164:167],a[8:11]
s_mul_i32 s64, s41, 229376
M a[12:15],a[60:63],a[164:167],a[12:15]
SA s72,s90,s64
T a[100:101],v1,8192
T a[102:103],v1,9216
M a[12:15],a[56:59],a[160:163],a[12:15]
s_addc_u32 s73, s91, 0
buffer_load_dwordx4 v13, s[48:51], s22 offen offset:1024   lds
M a[16:19],a[64:67],a[160:163],a[16:19]
s_sub_u32 s75, 3670016, s64
M a[16:19],a[68:71],a[164:167],a[16:19]
s_mov_b32 s12, s72
M a[20:23],a[76:79],a[164:167],a[20:23]
s_and_b32 s13, s73, 0xffff
M a[20:23],a[72:75],a[160:163],a[20:23]
s_mov_b32 s14, s75
T a[104:105],v2,0
T a[106:107],v2,1024
M a[24:27],a[80:83],a[160:163],a[24:27]
s_mov_b32 s15, 0x20000
buffer_load_dwordx4 v14, s[48:51], s22 offen offset:2048   lds
M a[24:27],a[84:87],a[164:167],a[24:27]
s_waitcnt lgkmcnt(6)
M a[28:31],a[92:95],a[164:167],a[28:31]
M a[28:31],a[88:91],a[160:163],a[28:31]
M v[60:63],a[88:91],a[168:171],v[60:63]
R a[160:163],v5,36864
R a[164:167],v6,36864
M v[60:63],a[92:95],a[172:175],v[60:63]
T a[108:109],v2,8192
T a[110:111],v2,9216
M v[56:59],a[84:87],a[172:175],v[56:59]
buffer_load_dwordx4 v15, s[48:51], s22 offen offset:3072   lds
M v[56:59],a[80:83],a[168:171],v[56:59]
s_sub_u32 s22, s22, 1048448
M v[52:55],a[72:75],a[168:171],v[52:55]
SA m0,s23,49152
M v[52:55],a[76:79],a[172:175],v[52:55]
s_nop 0
T a[112:113],v3,0
T a[114:115],v3,1024
M v[48:51],a[68:71],a[172:175],v[48:51]
buffer_load_dwordx4 v8, s[16:19], s21 offen offset:0   lds
M v[48:51],a[64:67],a[168:171],v[48:51]
M v[44:47],a[56:59],a[168:171],v[44:47]
M v[44:47],a[60:63],a[172:175],v[44:47]
buffer_load_dwordx4 v9, s[16:19], s21 offen offset:1024   lds
M v[40:43],a[52:55],a[172:175],v[40:43]
s_nop 0
T a[116:117],v3,8192
T a[118:119],v3,9216
M v[40:43],a[48:51],a[168:171],v[40:43]
M v[36:39],a[40:43],a[168:171],v[36:39]
M v[36:39],a[44:47],a[172:175],v[36:39]
s_waitcnt lgkmcnt(6)
M v[32:35],a[36:39],a[172:175],v[32:35]
buffer_load_dwordx4 v10, s[16:19], s21 offen offset:2048   lds
M v[32:35],a[32:35],a[168:171],v[32:35]
s_nop 0
T a[120:121],v4,0
T a[122:123],v4,1024
M v[64:67],a[32:35],a[160:163],v[64:67]
R a[168:171],v5,38912
R a[172:175],v6,38912
M v[64:67],a[36:39],a[164:167],v[64:67]
M v[68:71],a[44:47],a[164:167],v[68:71]
buffer_load_dwordx4 v11, s[16:19], s21 offen offset:3072   lds
M v[68:71],a[40:43],a[160:163],v[68:71]
SA s21,s21,524160
M v[72:75],a[48:51],a[160:163],v[72:75]
s_nop 0
T a[124:125],v4,8192
T a[126:127],v4,9216
M v[72:75],a[52:55],a[164:167],v[72:75]
M v[76:79],a[60:63],a[164:167],v[76:79]
SA m0,s87,2048
M v[76:79],a[56:59],a[160:163],v[76:79]
buffer_load_dwordx4 v25, s[60:63], s89 offen offset:0  lds
M v[80:83],a[64:67],a[160:163],v[80:83]
SA s89,s89,114688
M v[80:83],a[68:71],a[164:167],v[80:83]
M v[84:87],a[76:79],a[164:167],v[84:87]
M v[84:87],a[72:75],a[160:163],v[84:87]
M v[88:91],a[80:83],a[160:163],v[88:91]
M v[88:91],a[84:87],a[164:167],v[88:91]
s_waitcnt lgkmcnt(2)
M v[92:95],a[92:95],a[164:167],v[92:95]
s_waitcnt vmcnt(18) lgkmcnt(0)
M v[92:95],a[88:91],a[160:163],v[92:95]
s_barrier
M v[124:127],a[88:91],a[168:171],v[124:127]
R a[160:163],v5,49152
R a[164:167],v6,49152
M v[124:127],a[92:95],a[172:175],v[124:127]
M v[120:123],a[84:87],a[172:175],v[120:123]
SA m0,s24,32768
T a[128:129],v1,16384
T a[130:131],v1,17408
M v[120:123],a[80:83],a[168:171],v[120:123]
buffer_load_dwordx4 v12, s[48:51], s22 offen offset:0   lds
M v[116:119],a[72:75],a[168:171],v[116:119]
M v[116:119],a[76:79],a[172:175],v[116:119]
M v[112:115],a[68:71],a[172:175],v[112:115]
M v[112:115],a[64:67],a[168:171],v[112:115]
M v[108:111],a[56:59],a[168:171],v[108:111]
M v[108:111],a[60:63],a[172:175],v[108:111]
s_nop 0
T a[132:133],v1,24576
T a[134:135],v1,25600
M v[104:107],a[52:55],a[172:175],v[104:107]
buffer_load_dwordx4 v13, s[48:51], s22 offen offset:1024   lds
M v[104:107],a[48:51],a[168:171],v[104:107]
M v[100:103],a[40:43],a[168:171],v[100:103]
M v[100:103],a[44:47],a[172:175],v[100:103]
s_waitcnt lgkmcnt(4)
M v[96:99],a[36:39],a[172:175],v[96:99]
M v[96:99],a[32:35],a[168:171],v[96:99]
M v[128:131],a[32:35],a[160:163],v[128:131]
R a[168:171],v5,51200
R a[172:175],v6,51200
M v[128:131],a[36:39],a[164:167],v[128:131]
T a[136:137],v2,16384
T a[138:139],v2,17408
M v[132:135],a[44:47],a[164:167],v[132:135]
buffer_load_dwordx4 v14, s[48:51], s22 offen offset:2048   lds
M v[132:135],a[40:43],a[160:163],v[132:135]
M v[136:139],a[48:51],a[160:163],v[136:139]
M v[136:139],a[52:55],a[164:167],v[136:139]
M v[140:143],a[60:63],a[164:167],v[140:143]
M v[140:143],a[56:59],a[160:163],v[140:143]
s_nop 0
T a[140:141],v2,24576
T a[142:143],v2,25600
M v[144:147],a[64:67],a[160:163],v[144:147]
buffer_load_dwordx4 v15, s[48:51], s22 offen offset:3072   lds
M v[144:147],a[68:71],a[164:167],v[144:147]
SA s22,s22,1048576
M v[148:151],a[76:79],a[164:167],v[148:151]
M v[148:151],a[72:75],a[160:163],v[148:151]
M v[152:155],a[80:83],a[160:163],v[152:155]
M v[152:155],a[84:87],a[164:167],v[152:155]
s_waitcnt lgkmcnt(4)
M v[156:159],a[92:95],a[164:167],v[156:159]
SA m0,s23,0
T a[144:145],v3,16384
T a[146:147],v3,17408
M v[156:159],a[88:91],a[160:163],v[156:159]
buffer_load_dwordx4 v8, s[16:19], s21 offen offset:0   lds
M v[188:191],a[88:91],a[168:171],v[188:191]
R a[160:163],v5,53248
R a[164:167],v6,53248
M v[188:191],a[92:95],a[172:175],v[188:191]
M v[184:187],a[84:87],a[172:175],v[184:187]
M v[184:187],a[80:83],a[168:171],v[184:187]
M v[180:183],a[72:75],a[168:171],v[180:183]
M v[180:183],a[76:79],a[172:175],v[180:183]
s_nop 0
T a[148:149],v3,24576
T a[150:151],v3,25600
M v[176:179],a[68:71],a[172:175],v[176:179]
buffer_load_dwordx4 v9, s[16:19], s21 offen offset:1024   lds
M v[176:179],a[64:67],a[168:171],v[176:179]
M v[172:175],a[56:59],a[168:171],v[172:175]
M v[172:175],a[60:63],a[172:175],v[172:175]
M v[168:171],a[52:55],a[172:175],v[168:171]
M v[168:171],a[48:51],a[168:171],v[168:171]
M v[164:167],a[40:43],a[168:171],v[164:167]
s_nop 0
T a[152:153],v4,16384
T a[154:155],v4,17408
M v[164:167],a[44:47],a[172:175],v[164:167]
s_waitcnt lgkmcnt(4)
buffer_load_dwordx4 v10, s[16:19], s21 offen offset:2048   lds
M v[160:163],a[36:39],a[172:175],v[160:163]
M v[160:163],a[32:35],a[168:171],v[160:163]
M v[192:195],a[32:35],a[160:163],v[192:195]
R a[168:171],v5,55296
R a[172:175],v6,55296
M v[192:195],a[36:39],a[164:167],v[192:195]
M v[196:199],a[44:47],a[164:167],v[196:199]
M v[196:199],a[40:43],a[160:163],v[196:199]
s_nop 0
T a[156:157],v4,24576
T a[158:159],v4,25600
M v[200:203],a[48:51],a[160:163],v[200:203]
buffer_load_dwordx4 v11, s[16:19], s21 offen offset:3072   lds
M v[200:203],a[52:55],a[164:167],v[200:203]
SA s21,s21,128
M v[204:207],a[60:63],a[164:167],v[204:207]
M v[204:207],a[56:59],a[160:163],v[204:207]
M v[208:211],a[64:67],a[160:163],v[208:211]
M v[208:211],a[68:71],a[164:167],v[208:211]
M v[212:215],a[76:79],a[164:167],v[212:215]
M v[212:215],a[72:75],a[160:163],v[212:215]
M v[216:219],a[80:83],a[160:163],v[216:219]
M v[216:219],a[84:87],a[164:167],v[216:219]
s_waitcnt lgkmcnt(2)
M v[220:223],a[92:95],a[164:167],v[220:223]
s_waitcnt vmcnt(17) lgkmcnt(0)
M v[220:223],a[88:91],a[160:163],v[220:223]
s_barrier
M v[252:255],a[88:91],a[168:171],v[252:255]
R a[160:163],v5,0
R a[164:167],v6,0
M v[252:255],a[92:95],a[172:175],v[252:255]
M v[248:251],a[84:87],a[172:175],v[248:251]
M v[248:251],a[80:83],a[168:171],v[248:251]
M v[244:247],a[72:75],a[168:171],v[244:247]
M v[244:247],a[76:79],a[172:175],v[244:247]
M v[240:243],a[68:71],a[172:175],v[240:243]
M v[240:243],a[64:67],a[168:171],v[240:243]
M v[236:239],a[56:59],a[168:171],v[236:239]
M v[236:239],a[60:63],a[172:175],v[236:239]
M v[232:235],a[52:55],a[172:175],v[232:235]
M v[232:235],a[48:51],a[168:171],v[232:235]
M v[228:231],a[40:43],a[168:171],v[228:231]
M v[228:231],a[44:47],a[172:175],v[228:231]
s_waitcnt lgkmcnt(0)
M v[224:227],a[36:39],a[172:175],v[224:227]
M v[224:227],a[32:35],a[168:171],v[224:227]
M a[0:3],a[96:99],a[160:163],a[0:3]
R a[168:171],v5,2048
R a[172:175],v6,2048
M a[0:3],a[100:103],a[164:167],a[0:3]
T a[32:33],v1,32768
T a[34:35],v1,33792
M a[4:7],a[108:111],a[164:167],a[4:7]
SA m0,s24,49152
M a[4:7],a[104:107],a[160:163],a[4:7]
buffer_load_dwordx4 v12, s[48:51], s22 offen offset:0   lds
M a[8:11],a[112:115],a[160:163],a[8:11]
M a[8:11],a[116:119],a[164:167],a[8:11]
M a[12:15],a[124:127],a[164:167],a[12:15]
s_nop 0
T a[36:37],v1,40960
T a[38:39],v1,41984
M a[12:15],a[120:123],a[160:163],a[12:15]
buffer_load_dwordx4 v13, s[48:51], s22 offen offset:1024   lds
M a[16:19],a[128:131],a[160:163],a[16:19]
M a[16:19],a[132:135],a[164:167],a[16:19]
M a[20:23],a[140:143],a[164:167],a[20:23]
M a[20:23],a[136:139],a[160:163],a[20:23]
s_nop 0
T a[40:41],v2,32768
T a[42:43],v2,33792
M a[24:27],a[144:147],a[160:163],a[24:27]
buffer_load_dwordx4 v14, s[48:51], s22 offen offset:2048   lds
M a[24:27],a[148:151],a[164:167],a[24:27]
s_waitcnt lgkmcnt(6)
M a[28:31],a[156:159],a[164:167],a[28:31]
M a[28:31],a[152:155],a[160:163],a[28:31]
M v[60:63],a[152:155],a[168:171],v[60:63]
R a[160:163],v5,4096
R a[164:167],v6,4096
M v[60:63],a[156:159],a[172:175],v[60:63]
T a[44:45],v2,40960
T a[46:47],v2,41984
M v[56:59],a[148:151],a[172:175],v[56:59]
buffer_load_dwordx4 v15, s[48:51], s22 offen offset:3072   lds
M v[56:59],a[144:147],a[168:171],v[56:59]
s_sub_u32 s22, s22, 1048448
M v[52:55],a[136:139],a[168:171],v[52:55]
SA m0,s23,16384
M v[52:55],a[140:143],a[172:175],v[52:55]
s_nop 0
T a[48:49],v3,32768
T a[50:51],v3,33792
M v[48:51],a[132:135],a[172:175],v[48:51]
buffer_load_dwordx4 v8, s[16:19], s21 offen offset:0   lds
M v[48:51],a[128:131],a[168:171],v[48:51]
M v[44:47],a[120:123],a[168:171],v[44:47]
M v[44:47],a[124:127],a[172:175],v[44:47]
buffer_load_dwordx4 v9, s[16:19], s21 offen offset:1024   lds
M v[40:43],a[116:119],a[172:175],v[40:43]
s_nop 0
T a[52:53],v3,40960
T a[54:55],v3,41984
M v[40:43],a[112:115],a[168:171],v[40:43]
M v[36:39],a[104:107],a[168:171],v[36:39]
M v[36:39],a[108:111],a[172:175],v[36:39]
s_waitcnt lgkmcnt(6)
M v[32:35],a[100:103],a[172:175],v[32:35]
buffer_load_dwordx4 v10, s[16:19], s21 offen offset:2048   lds
M v[32:35],a[96:99],a[168:171],v[32:35]
s_nop 0
T a[56:57],v4,32768
T a[58:59],v4,33792
M v[64:67],a[96:99],a[160:163],v[64:67]
R a[168:171],v5,6144
R a[172:175],v6,6144
M v[64:67],a[100:103],a[164:167],v[64:67]
M v[68:71],a[108:111],a[164:167],v[68:71]
buffer_load_dwordx4 v11, s[16:19], s21 offen offset:3072   lds
M v[68:71],a[104:107],a[160:163],v[68:71]
SA s21,s21,524160
M v[72:75],a[112:115],a[160:163],v[72:75]
s_nop 0
T a[60:61],v4,40960
T a[62:63],v4,41984
M v[72:75],a[116:119],a[164:167],v[72:75]
M v[76:79],a[124:127],a[164:167],v[76:79]
SA m0,s87,3072
M v[76:79],a[120:123],a[160:163],v[76:79]
buffer_load_dwordx4 v25, s[60:63], s89 offen offset:0  lds
M v[80:83],a[128:131],a[160:163],v[80:83]
SA s89,s89,114688
M v[80:83],a[132:135],a[164:167],v[80:83]
M v[84:87],a[140:143],a[164:167],v[84:87]
M v[84:87],a[136:139],a[160:163],v[84:87]
M v[88:91],a[144:147],a[160:163],v[88:91]
M v[88:91],a[148:151],a[164:167],v[88:91]
s_waitcnt lgkmcnt(2)
M v[92:95],a[156:159],a[164:167],v[92:95]
s_waitcnt vmcnt(18) lgkmcnt(0)
M v[92:95],a[152:155],a[160:163],v[92:95]
s_barrier
M v[124:127],a[152:155],a[168:171],v[124:127]
R a[160:163],v5,16384
R a[164:167],v6,16384
M v[124:127],a[156:159],a[172:175],v[124:127]
M v[120:123],a[148:151],a[172:175],v[120:123]
SA m0,s24,0
T a[64:65],v1,49152
T a[66:67],v1,50176
M v[120:123],a[144:147],a[168:171],v[120:123]
buffer_load_dwordx4 v12, s[48:51], s22 offen offset:0   lds
M v[116:119],a[136:139],a[168:171],v[116:119]
M v[116:119],a[140:143],a[172:175],v[116:119]
M v[112:115],a[132:135],a[172:175],v[112:115]
M v[112:115],a[128:131],a[168:171],v[112:115]
M v[108:111],a[120:123],a[168:171],v[108:111]
M v[108:111],a[124:127],a[172:175],v[108:111]
s_nop 0
T a[68:69],v1,57344
T a[70:71],v1,58368
M v[104:107],a[116:119],a[172:175],v[104:107]
buffer_load_dwordx4 v13, s[48:51], s22 offen offset:1024   lds
M v[104:107],a[112:115],a[168:171],v[104:107]
M v[100:103],a[104:107],a[168:171],v[100:103]
M v[100:103],a[108:111],a[172:175],v[100:103]
s_waitcnt lgkmcnt(4)
M v[96:99],a[100:103],a[172:175],v[96:99]
M v[96:99],a[96:99],a[168:171],v[96:99]
M v[128:131],a[96:99],a[160:163],v[128:131]
R a[168:171],v5,18432
R a[172:175],v6,18432
M v[128:131],a[100:103],a[164:167],v[128:131]
s_lshl_b32 s67, s20, 11
T a[72:73],v2,49152
T a[74:75],v2,50176
M v[132:135],a[108:111],a[164:167],v[132:135]
SA s67,s67,104914944
buffer_load_dwordx4 v14, s[48:51], s22 offen offset:2048   lds
M v[132:135],a[104:107],a[160:163],v[132:135]
M v[136:139],a[112:115],a[160:163],v[136:139]
M v[136:139],a[116:119],a[164:167],v[136:139]
buffer_load_dwordx4 v[16:19], v7, s[8:11], s67 offen offset:0 sc1
M v[140:143],a[124:127],a[164:167],v[140:143]
M v[140:143],a[120:123],a[160:163],v[140:143]
s_nop 0
T a[76:77],v2,57344
T a[78:79],v2,58368
M v[144:147],a[128:131],a[160:163],v[144:147]
buffer_load_dwordx4 v15, s[48:51], s22 offen offset:3072   lds
M v[144:147],a[132:135],a[164:167],v[144:147]
SA s22,s22,1048576
M v[148:151],a[140:143],a[164:167],v[148:151]
buffer_load_dwordx4 v[20:23], v7, s[8:11], s67 offen offset:1024 sc1
M v[148:151],a[136:139],a[160:163],v[148:151]
M v[152:155],a[144:147],a[160:163],v[152:155]
L_w_kv03:
s_cbranch_execz L_w_kv07
M v[152:155],a[148:151],a[164:167],v[152:155]
s_waitcnt lgkmcnt(4)
M v[156:159],a[156:159],a[164:167],v[156:159]
SA m0,s23,32768
T a[80:81],v3,49152
T a[82:83],v3,50176
M v[156:159],a[152:155],a[160:163],v[156:159]
buffer_load_dwordx4 v8, s[16:19], s21 offen offset:0   lds
M v[188:191],a[152:155],a[168:171],v[188:191]
R a[160:163],v5,20480
R a[164:167],v6,20480
M v[188:191],a[156:159],a[172:175],v[188:191]
M v[184:187],a[148:151],a[172:175],v[184:187]
M v[184:187],a[144:147],a[168:171],v[184:187]
M v[180:183],a[136:139],a[168:171],v[180:183]
M v[180:183],a[140:143],a[172:175],v[180:183]
s_nop 0
T a[84:85],v3,57344
T a[86:87],v3,58368
M v[176:179],a[132:135],a[172:175],v[176:179]
buffer_load_dwordx4 v9, s[16:19], s21 offen offset:1024   lds
M v[176:179],a[128:131],a[168:171],v[176:179]
M v[172:175],a[120:123],a[168:171],v[172:175]
M v[172:175],a[124:127],a[172:175],v[172:175]
M v[168:171],a[116:119],a[172:175],v[168:171]
M v[168:171],a[112:115],a[168:171],v[168:171]
M v[164:167],a[104:107],a[168:171],v[164:167]
s_nop 0
T a[88:89],v4,49152
T a[90:91],v4,50176
M v[164:167],a[108:111],a[172:175],v[164:167]
s_waitcnt lgkmcnt(4)
buffer_load_dwordx4 v10, s[16:19], s21 offen offset:2048   lds
M v[160:163],a[100:103],a[172:175],v[160:163]
M v[160:163],a[96:99],a[168:171],v[160:163]
M v[192:195],a[96:99],a[160:163],v[192:195]
R a[168:171],v5,22528
R a[172:175],v6,22528
M v[192:195],a[100:103],a[164:167],v[192:195]
M v[196:199],a[108:111],a[164:167],v[196:199]
M v[196:199],a[104:107],a[160:163],v[196:199]
s_nop 0
T a[92:93],v4,57344
T a[94:95],v4,58368
M v[200:203],a[112:115],a[160:163],v[200:203]
buffer_load_dwordx4 v11, s[16:19], s21 offen offset:3072   lds
M v[200:203],a[116:119],a[164:167],v[200:203]
SA s21,s21,128
M v[204:207],a[124:127],a[164:167],v[204:207]
M v[204:207],a[120:123],a[160:163],v[204:207]
M v[208:211],a[128:131],a[160:163],v[208:211]
M v[208:211],a[132:135],a[164:167],v[208:211]
M v[212:215],a[140:143],a[164:167],v[212:215]
M v[212:215],a[136:139],a[160:163],v[212:215]
M v[216:219],a[144:147],a[160:163],v[216:219]
M v[216:219],a[148:151],a[164:167],v[216:219]
s_waitcnt lgkmcnt(2)
M v[220:223],a[156:159],a[164:167],v[220:223]
s_waitcnt vmcnt(19) lgkmcnt(0)
M v[220:223],a[152:155],a[160:163],v[220:223]
s_barrier
M v[252:255],a[152:155],a[168:171],v[252:255]
R a[160:163],v5,32768
R a[164:167],v6,32768
M v[252:255],a[156:159],a[172:175],v[252:255]
M v[248:251],a[148:151],a[172:175],v[248:251]
M v[248:251],a[144:147],a[168:171],v[248:251]
M v[244:247],a[136:139],a[168:171],v[244:247]
M v[244:247],a[140:143],a[172:175],v[244:247]
M v[240:243],a[132:135],a[172:175],v[240:243]
M v[240:243],a[128:131],a[168:171],v[240:243]
M v[236:239],a[120:123],a[168:171],v[236:239]
M v[236:239],a[124:127],a[172:175],v[236:239]
M v[232:235],a[116:119],a[172:175],v[232:235]
M v[232:235],a[112:115],a[168:171],v[232:235]
M v[228:231],a[104:107],a[168:171],v[228:231]
M v[228:231],a[108:111],a[172:175],v[228:231]
s_waitcnt lgkmcnt(0)
M v[224:227],a[100:103],a[172:175],v[224:227]
M v[224:227],a[96:99],a[168:171],v[224:227]
M a[0:3],a[32:35],a[160:163],a[0:3]
R a[168:171],v5,34816
R a[172:175],v6,34816
M a[0:3],a[36:39],a[164:167],a[0:3]
T a[96:97],v1,0
T a[98:99],v1,1024
M a[4:7],a[44:47],a[164:167],a[4:7]
SA m0,s24,16384
M a[4:7],a[40:43],a[160:163],a[4:7]
buffer_load_dwordx4 v12, s[48:51], s22 offen offset:0   lds
M a[8:11],a[48:51],a[160:163],a[8:11]
M a[8:11],a[52:55],a[164:167],a[8:11]
M a[12:15],a[60:63],a[164:167],a[12:15]
s_nop 0
T a[100:101],v1,8192
T a[102:103],v1,9216
M a[12:15],a[56:59],a[160:163],a[12:15]
buffer_load_dwordx4 v13, s[48:51], s22 offen offset:1024   lds
M a[16:19],a[64:67],a[160:163],a[16:19]
M a[16:19],a[68:71],a[164:167],a[16:19]
M a[20:23],a[76:79],a[164:167],a[20:23]
s_waitcnt vmcnt(8)
v_min3_u32 v28, v16, v17, v18
M a[20:23],a[72:75],a[160:163],a[20:23]
s_nop 0
T a[104:105],v2,0
T a[106:107],v2,1024
M a[24:27],a[80:83],a[160:163],a[24:27]
buffer_load_dwordx4 v14, s[48:51], s22 offen offset:2048   lds
M a[24:27],a[84:87],a[164:167],a[24:27]
s_waitcnt lgkmcnt(6)
s_waitcnt vmcnt(7)
v_min3_u32 v28, v28, v19, v20
M a[28:31],a[92:95],a[164:167],a[28:31]
v_min3_u32 v28, v28, v21, v22
M a[28:31],a[88:91],a[160:163],a[28:31]
v_min_u32 v28, v28, v23
M v[60:63],a[88:91],a[168:171],v[60:63]
R a[160:163],v5,36864
R a[164:167],v6,36864
M v[60:63],a[92:95],a[172:175],v[60:63]
T a[108:109],v2,8192
T a[110:111],v2,9216
M v[56:59],a[84:87],a[172:175],v[56:59]
buffer_load_dwordx4 v15, s[48:51], s22 offen offset:3072   lds
M v[56:59],a[80:83],a[168:171],v[56:59]
s_sub_u32 s22, s22, 1048448
v_cmp_eq_u32 vcc, 0, v28
M v[52:55],a[72:75],a[168:171],v[52:55]
SA m0,s23,49152
s_nop 0
M v[52:55],a[76:79],a[172:175],v[52:55]
s_cbranch_vccnz L_hs
L_hr:
T a[112:113],v3,0
T a[114:115],v3,1024
M v[48:51],a[68:71],a[172:175],v[48:51]
buffer_load_dwordx4 v8, s[16:19], s21 offen offset:0   lds
M v[48:51],a[64:67],a[168:171],v[48:51]
v_max_u32 v28, v16, v17
M v[44:47],a[56:59],a[168:171],v[44:47]
v_min_u32 v29, v16, v17
M v[44:47],a[60:63],a[172:175],v[44:47]
buffer_load_dwordx4 v9, s[16:19], s21 offen offset:1024   lds
M v[40:43],a[52:55],a[172:175],v[40:43]
s_nop 0
T a[116:117],v3,8192
T a[118:119],v3,9216
M v[40:43],a[48:51],a[168:171],v[40:43]
v_med3_u32 v29, v28, v29, v18
M v[36:39],a[40:43],a[168:171],v[36:39]
v_max_u32 v28, v28, v18
M v[36:39],a[44:47],a[172:175],v[36:39]
s_waitcnt lgkmcnt(6)
v_med3_u32 v29, v28, v29, v19
M v[32:35],a[36:39],a[172:175],v[32:35]
buffer_load_dwordx4 v10, s[16:19], s21 offen offset:2048   lds
M v[32:35],a[32:35],a[168:171],v[32:35]
s_nop 0
T a[120:121],v4,0
T a[122:123],v4,1024
M v[64:67],a[32:35],a[160:163],v[64:67]
R a[168:171],v5,38912
R a[172:175],v6,38912
M v[64:67],a[36:39],a[164:167],v[64:67]
v_max_u32 v28, v28, v19
M v[68:71],a[44:47],a[164:167],v[68:71]
buffer_load_dwordx4 v11, s[16:19], s21 offen offset:3072   lds
M v[68:71],a[40:43],a[160:163],v[68:71]
SA s21,s21,524160
v_med3_u32 v29, v28, v29, v20
M v[72:75],a[48:51],a[160:163],v[72:75]
s_nop 0
T a[124:125],v4,8192
T a[126:127],v4,9216
M v[72:75],a[52:55],a[164:167],v[72:75]
v_max_u32 v28, v28, v20
M v[76:79],a[60:63],a[164:167],v[76:79]
SA m0,s87,4096
v_med3_u32 v29, v28, v29, v21
M v[76:79],a[56:59],a[160:163],v[76:79]
buffer_load_dwordx4 v25, s[60:63], s89 offen offset:0  lds
M v[80:83],a[64:67],a[160:163],v[80:83]
SA s89,s89,114688
v_max_u32 v28, v28, v21
M v[80:83],a[68:71],a[164:167],v[80:83]
v_med3_u32 v29, v28, v29, v22
M v[84:87],a[76:79],a[164:167],v[84:87]
v_max_u32 v28, v28, v22
M v[84:87],a[72:75],a[160:163],v[84:87]
v_med3_u32 v29, v28, v29, v23
M v[88:91],a[80:83],a[160:163],v[88:91]
v_max_u32 v28, v28, v23
M v[88:91],a[84:87],a[164:167],v[88:91]
s_waitcnt lgkmcnt(2)
v_mov_b32 v30, v28 row_ror:8 row_mask:0xf bank_mask:0xf
M v[92:95],a[92:95],a[164:167],v[92:95]
s_waitcnt lgkmcnt(0)
v_mov_b32 v31, v29 row_ror:8 row_mask:0xf bank_mask:0xf
M v[92:95],a[88:91],a[160:163],v[92:95]
s_barrier
M v[124:127],a[88:91],a[168:171],v[124:127]
R a[160:163],v5,49152
R a[164:167],v6,49152
M v[124:127],a[92:95],a[172:175],v[124:127]
v_min_u32 v16, v28, v30
M v[120:123],a[84:87],a[172:175],v[120:123]
SA m0,s24,32768
T a[128:129],v1,16384
T a[130:131],v1,17408
M v[120:123],a[80:83],a[168:171],v[120:123]
buffer_load_dwordx4 v12, s[48:51], s22 offen offset:0   lds
M v[116:119],a[72:75],a[168:171],v[116:119]
v_max_u32 v28, v28, v30
M v[116:119],a[76:79],a[172:175],v[116:119]
v_max3_u32 v29, v29, v31, v16
M v[112:115],a[68:71],a[172:175],v[112:115]
v_mov_b32 v30, v28 row_ror:4 row_mask:0xf bank_mask:0xf
M v[112:115],a[64:67],a[168:171],v[112:115]
v_mov_b32 v31, v29 row_ror:4 row_mask:0xf bank_mask:0xf
M v[108:111],a[56:59],a[168:171],v[108:111]
v_min_u32 v16, v28, v30
M v[108:111],a[60:63],a[172:175],v[108:111]
s_nop 0
T a[132:133],v1,24576
T a[134:135],v1,25600
M v[104:107],a[52:55],a[172:175],v[104:107]
buffer_load_dwordx4 v13, s[48:51], s22 offen offset:1024   lds
M v[104:107],a[48:51],a[168:171],v[104:107]
v_max_u32 v28, v28, v30
M v[100:103],a[40:43],a[168:171],v[100:103]
v_max3_u32 v29, v29, v31, v16
M v[100:103],a[44:47],a[172:175],v[100:103]
s_waitcnt lgkmcnt(4)
v_mov_b32 v30, v28 row_ror:2 row_mask:0xf bank_mask:0xf
M v[96:99],a[36:39],a[172:175],v[96:99]
v_mov_b32 v31, v29 row_ror:2 row_mask:0xf bank_mask:0xf
M v[96:99],a[32:35],a[168:171],v[96:99]
v_min_u32 v16, v28, v30
M v[128:131],a[32:35],a[160:163],v[128:131]
R a[168:171],v5,51200
R a[172:175],v6,51200
M v[128:131],a[36:39],a[164:167],v[128:131]
T a[136:137],v2,16384
T a[138:139],v2,17408
M v[132:135],a[44:47],a[164:167],v[132:135]
buffer_load_dwordx4 v14, s[48:51], s22 offen offset:2048   lds
M v[132:135],a[40:43],a[160:163],v[132:135]
v_max_u32 v28, v28, v30
M v[136:139],a[48:51],a[160:163],v[136:139]
v_max3_u32 v29, v29, v31, v16
M v[136:139],a[52:55],a[164:167],v[136:139]
v_mov_b32 v30, v28 row_ror:1 row_mask:0xf bank_mask:0xf
M v[140:143],a[60:63],a[164:167],v[140:143]
v_mov_b32 v31, v29 row_ror:1 row_mask:0xf bank_mask:0xf
M v[140:143],a[56:59],a[160:163],v[140:143]
s_nop 0
T a[140:141],v2,24576
T a[142:143],v2,25600
M v[144:147],a[64:67],a[160:163],v[144:147]
buffer_load_dwordx4 v15, s[48:51], s22 offen offset:3072   lds
M v[144:147],a[68:71],a[164:167],v[144:147]
SA s22,s22,1048576
v_min_u32 v16, v28, v30
M v[148:151],a[76:79],a[164:167],v[148:151]
v_max_u32 v28, v28, v30
M v[148:151],a[72:75],a[160:163],v[148:151]
v_max3_u32 v29, v29, v31, v16
M v[152:155],a[80:83],a[160:163],v[152:155]
v_mov_b32 v30, v28
M v[152:155],a[84:87],a[164:167],v[152:155]
s_waitcnt lgkmcnt(4)
v_mov_b32 v31, v29
M v[156:159],a[92:95],a[164:167],v[156:159]
SA m0,s23,0
T a[144:145],v3,16384
T a[146:147],v3,17408
M v[156:159],a[88:91],a[160:163],v[156:159]
buffer_load_dwordx4 v8, s[16:19], s21 offen offset:0   lds
M v[188:191],a[88:91],a[168:171],v[188:191]
R a[160:163],v5,53248
R a[164:167],v6,53248
M v[188:191],a[92:95],a[172:175],v[188:191]
v_permlane16_swap_b32 v30, v28
M v[184:187],a[84:87],a[172:175],v[184:187]
v_permlane16_swap_b32 v31, v29
M v[184:187],a[80:83],a[168:171],v[184:187]
v_min_u32 v16, v28, v30
M v[180:183],a[72:75],a[168:171],v[180:183]
v_max_u32 v28, v28, v30
M v[180:183],a[76:79],a[172:175],v[180:183]
s_nop 0
T a[148:149],v3,24576
T a[150:151],v3,25600
M v[176:179],a[68:71],a[172:175],v[176:179]
buffer_load_dwordx4 v9, s[16:19], s21 offen offset:1024   lds
M v[176:179],a[64:67],a[168:171],v[176:179]
v_max3_u32 v29, v29, v31, v16
M v[172:175],a[56:59],a[168:171],v[172:175]
v_mov_b32 v30, v28
M v[172:175],a[60:63],a[172:175],v[172:175]
v_mov_b32 v31, v29
M v[168:171],a[52:55],a[172:175],v[168:171]
v_permlane32_swap_b32 v30, v28
M v[168:171],a[48:51],a[168:171],v[168:171]
v_permlane32_swap_b32 v31, v29
M v[164:167],a[40:43],a[168:171],v[164:167]
s_nop 0
T a[152:153],v4,16384
T a[154:155],v4,17408
M v[164:167],a[44:47],a[172:175],v[164:167]
s_waitcnt lgkmcnt(4)
buffer_load_dwordx4 v10, s[16:19], s21 offen offset:2048   lds
M v[160:163],a[36:39],a[172:175],v[160:163]
v_min_u32 v16, v28, v30
M v[160:163],a[32:35],a[168:171],v[160:163]
v_max_u32 v28, v28, v30
M v[192:195],a[32:35],a[160:163],v[192:195]
R a[168:171],v5,55296
R a[172:175],v6,55296
M v[192:195],a[36:39],a[164:167],v[192:195]
v_max3_u32 v29, v29, v31, v16
M v[196:199],a[44:47],a[164:167],v[196:199]
s_lshl_b32 s64, s20, 3
M v[196:199],a[40:43],a[160:163],v[196:199]
SA s64,s64,159744
T a[156:157],v4,24576
T a[158:159],v4,25600
M v[200:203],a[48:51],a[160:163],v[200:203]
buffer_load_dwordx4 v11, s[16:19], s21 offen offset:3072   lds
M v[200:203],a[52:55],a[164:167],v[200:203]
SA s21,s21,128
v_mov_b32 v16, s64
M v[204:207],a[60:63],a[164:167],v[204:207]
ds_write_b64 v16, v[28:29]
M v[204:207],a[56:59],a[160:163],v[204:207]
M v[208:211],a[64:67],a[160:163],v[208:211]
M v[208:211],a[68:71],a[164:167],v[208:211]
M v[212:215],a[76:79],a[164:167],v[212:215]
M v[212:215],a[72:75],a[160:163],v[212:215]
M v[216:219],a[80:83],a[160:163],v[216:219]
M v[216:219],a[84:87],a[164:167],v[216:219]
s_waitcnt lgkmcnt(3)
M v[220:223],a[92:95],a[164:167],v[220:223]
s_waitcnt vmcnt(17) lgkmcnt(0)
M v[220:223],a[88:91],a[160:163],v[220:223]
s_barrier
M v[252:255],a[88:91],a[168:171],v[252:255]
R a[160:163],v5,0
R a[164:167],v6,0
M v[252:255],a[92:95],a[172:175],v[252:255]
M v[248:251],a[84:87],a[172:175],v[248:251]
M v[248:251],a[80:83],a[168:171],v[248:251]
M v[244:247],a[72:75],a[168:171],v[244:247]
M v[244:247],a[76:79],a[172:175],v[244:247]
M v[240:243],a[68:71],a[172:175],v[240:243]
M v[240:243],a[64:67],a[168:171],v[240:243]
M v[236:239],a[56:59],a[168:171],v[236:239]
M v[236:239],a[60:63],a[172:175],v[236:239]
M v[232:235],a[52:55],a[172:175],v[232:235]
M v[232:235],a[48:51],a[168:171],v[232:235]
M v[228:231],a[40:43],a[168:171],v[228:231]
M v[228:231],a[44:47],a[172:175],v[228:231]
s_waitcnt lgkmcnt(0)
M v[224:227],a[36:39],a[172:175],v[224:227]
M v[224:227],a[32:35],a[168:171],v[224:227]
M a[0:3],a[96:99],a[160:163],a[0:3]
R a[168:171],v5,2048
R a[172:175],v6,2048
M a[0:3],a[100:103],a[164:167],a[0:3]
T a[32:33],v1,32768
T a[34:35],v1,33792
M a[4:7],a[108:111],a[164:167],a[4:7]
SA m0,s24,49152
M a[4:7],a[104:107],a[160:163],a[4:7]
buffer_load_dwordx4 v12, s[48:51], s22 offen offset:0   lds
M a[8:11],a[112:115],a[160:163],a[8:11]
v_mov_b32 v28, 159744
M a[8:11],a[116:119],a[164:167],a[8:11]
ds_read_b128 v[16:19], v28
M a[12:15],a[124:127],a[164:167],a[12:15]
s_nop 0
T a[36:37],v1,40960
T a[38:39],v1,41984
M a[12:15],a[120:123],a[160:163],a[12:15]
buffer_load_dwordx4 v13, s[48:51], s22 offen offset:1024   lds
M a[16:19],a[128:131],a[160:163],a[16:19]
R v[20:23],v28,16
M a[16:19],a[132:135],a[164:167],a[16:19]
M a[20:23],a[140:143],a[164:167],a[20:23]
M a[20:23],a[136:139],a[160:163],a[20:23]
s_nop 0
T a[40:41],v2,32768
T a[42:43],v2,33792
M a[24:27],a[144:147],a[160:163],a[24:27]
buffer_load_dwordx4 v14, s[48:51], s22 offen offset:2048   lds
M a[24:27],a[148:151],a[164:167],a[24:27]
s_waitcnt lgkmcnt(8)
M a[28:31],a[156:159],a[164:167],a[28:31]
M a[28:31],a[152:155],a[160:163],a[28:31]
M v[60:63],a[152:155],a[168:171],v[60:63]
R a[160:163],v5,4096
R a[164:167],v6,4096
M v[60:63],a[156:159],a[172:175],v[60:63]
T a[44:45],v2,40960
T a[46:47],v2,41984
M v[56:59],a[148:151],a[172:175],v[56:59]
buffer_load_dwordx4 v15, s[48:51], s22 offen offset:3072   lds
M v[56:59],a[144:147],a[168:171],v[56:59]
s_sub_u32 s22, s22, 1048448
s_waitcnt lgkmcnt(9)
v_min_u32 v28, v16, v18
M v[52:55],a[136:139],a[168:171],v[52:55]
SA m0,s23,16384
v_max_u32 v16, v16, v18
M v[52:55],a[140:143],a[172:175],v[52:55]
s_nop 0
T a[48:49],v3,32768
T a[50:51],v3,33792
M v[48:51],a[132:135],a[172:175],v[48:51]
buffer_load_dwordx4 v8, s[16:19], s21 offen offset:0   lds
M v[48:51],a[128:131],a[168:171],v[48:51]
v_max3_u32 v17, v17, v19, v28
M v[44:47],a[120:123],a[168:171],v[44:47]
s_waitcnt lgkmcnt(8)
v_min_u32 v29, v20, v22
M v[44:47],a[124:127],a[172:175],v[44:47]
buffer_load_dwordx4 v9, s[16:19], s21 offen offset:1024   lds
M v[40:43],a[116:119],a[172:175],v[40:43]
s_nop 0
T a[52:53],v3,40960
T a[54:55],v3,41984
M v[40:43],a[112:115],a[168:171],v[40:43]
v_max_u32 v20, v20, v22
M v[36:39],a[104:107],a[168:171],v[36:39]
v_max3_u32 v21, v21, v23, v29
M v[36:39],a[108:111],a[172:175],v[36:39]
s_waitcnt lgkmcnt(6)
v_min_u32 v28, v16, v20
M v[32:35],a[100:103],a[172:175],v[32:35]
buffer_load_dwordx4 v10, s[16:19], s21 offen offset:2048   lds
M v[32:35],a[96:99],a[168:171],v[32:35]
s_nop 0
T a[56:57],v4,32768
T a[58:59],v4,33792
M v[64:67],a[96:99],a[160:163],v[64:67]
R a[168:171],v5,6144
R a[172:175],v6,6144
M v[64:67],a[100:103],a[164:167],v[64:67]
v_max_u32 v16, v16, v20
M v[68:71],a[108:111],a[164:167],v[68:71]
buffer_load_dwordx4 v11, s[16:19], s21 offen offset:3072   lds
M v[68:71],a[104:107],a[160:163],v[68:71]
SA s21,s21,524160
v_max3_u32 v17, v17, v21, v28
M v[72:75],a[112:115],a[160:163],v[72:75]
s_nop 0
T a[60:61],v4,40960
T a[62:63],v4,41984
M v[72:75],a[116:119],a[164:167],v[72:75]
v_and_b32 v28, 1, v0
M v[76:79],a[124:127],a[164:167],v[76:79]
SA m0,s87,5120
v_cmp_eq_u32 vcc, 0, v28
M v[76:79],a[120:123],a[160:163],v[76:79]
s_and_b32 s64, s20, 1
buffer_load_dwordx4 v25, s[60:63], s89 offen offset:0  lds
M v[80:83],a[128:131],a[160:163],v[80:83]
SA s89,s89,114688
s_mul_i32 s64, s64, 448
v_cndmask_b32 v24, v17, v16, vcc
M v[80:83],a[132:135],a[164:167],v[80:83]
v_and_b32 v24, 0x7ff, v24
M v[84:87],a[140:143],a[164:167],v[84:87]
v_sub_u32 v24, 2047, v24
M v[84:87],a[136:139],a[160:163],v[84:87]
v_mul_u32_u24 v28, 896, v24
M v[88:91],a[144:147],a[160:163],v[88:91]
v_lshrrev_b32 v29, 4, v0
M v[88:91],a[148:151],a[164:167],v[88:91]
s_waitcnt lgkmcnt(2)
v_lshl_add_u32 v28, v29, 4, v28
M v[92:95],a[156:159],a[164:167],v[92:95]
s_waitcnt vmcnt(18) lgkmcnt(0)
v_bfe_u32 v30, v0, 1, 3
M v[92:95],a[152:155],a[160:163],v[92:95]
s_barrier
M v[124:127],a[152:155],a[168:171],v[124:127]
R a[160:163],v5,16384
R a[164:167],v6,16384
M v[124:127],a[156:159],a[172:175],v[124:127]
v_lshl_or_b32 v28, v30, 26, v28
M v[120:123],a[148:151],a[172:175],v[120:123]
SA m0,s24,0
T a[64:65],v1,49152
T a[66:67],v1,50176
M v[120:123],a[144:147],a[168:171],v[120:123]
buffer_load_dwordx4 v12, s[48:51], s22 offen offset:0   lds
M v[116:119],a[136:139],a[168:171],v[116:119]
M v[116:119],a[140:143],a[172:175],v[116:119]
M v[112:115],a[132:135],a[172:175],v[112:115]
buffer_load_dwordx4 a[208:211], v28, s[56:59], s64 offen offset:0
M v[112:115],a[128:131],a[168:171],v[112:115]
M v[108:111],a[120:123],a[168:171],v[108:111]
buffer_load_dwordx4 a[212:215], v28, s[56:59], s64 offen offset:64
M v[108:111],a[124:127],a[172:175],v[108:111]
s_nop 0
T a[68:69],v1,57344
T a[70:71],v1,58368
M v[104:107],a[116:119],a[172:175],v[104:107]
buffer_load_dwordx4 v13, s[48:51], s22 offen offset:1024   lds
M v[104:107],a[112:115],a[168:171],v[104:107]
M v[100:103],a[104:107],a[168:171],v[100:103]
buffer_load_dwordx4 a[216:219], v28, s[56:59], s64 offen offset:128
M v[100:103],a[108:111],a[172:175],v[100:103]
s_waitcnt lgkmcnt(4)
M v[96:99],a[100:103],a[172:175],v[96:99]
M v[96:99],a[96:99],a[168:171],v[96:99]
buffer_load_dwordx4 v14, s[48:51], s22 offen offset:2048   lds
M v[128:131],a[96:99],a[160:163],v[128:131]
R a[168:171],v5,18432
R a[172:175],v6,18432
M v[128:131],a[100:103],a[164:167],v[128:131]
T a[72:73],v2,49152
T a[74:75],v2,50176
M v[132:135],a[108:111],a[164:167],v[132:135]
buffer_load_dwordx4 a[220:223], v28, s[56:59], s64 offen offset:192
M v[132:135],a[104:107],a[160:163],v[132:135]
M v[136:139],a[112:115],a[160:163],v[136:139]
buffer_load_dwordx4 a[224:227], v28, s[56:59], s64 offen offset:256
M v[136:139],a[116:119],a[164:167],v[136:139]
M v[140:143],a[124:127],a[164:167],v[140:143]
buffer_load_dwordx4 v15, s[48:51], s22 offen offset:3072   lds
M v[140:143],a[120:123],a[160:163],v[140:143]
SA s22,s22,1048576
T a[76:77],v2,57344
T a[78:79],v2,58368
M v[144:147],a[128:131],a[160:163],v[144:147]
M v[144:147],a[132:135],a[164:167],v[144:147]
buffer_load_dwordx4 a[228:231], v28, s[56:59], s64 offen offset:320
M v[148:151],a[140:143],a[164:167],v[148:151]
M v[148:151],a[136:139],a[160:163],v[148:151]
SA m0,s23,32768
M v[152:155],a[144:147],a[160:163],v[152:155]
buffer_load_dwordx4 v8, s[16:19], s21 offen offset:0   lds
M v[152:155],a[148:151],a[164:167],v[152:155]
s_waitcnt lgkmcnt(4)
M v[156:159],a[156:159],a[164:167],v[156:159]
s_nop 0
T a[80:81],v3,49152
T a[82:83],v3,50176
M v[156:159],a[152:155],a[160:163],v[156:159]
buffer_load_dwordx4 a[232:235], v28, s[56:59], s64 offen offset:384
M v[188:191],a[152:155],a[168:171],v[188:191]
R a[160:163],v5,20480
R a[164:167],v6,20480
M v[188:191],a[156:159],a[172:175],v[188:191]
v_lshrrev_b32 v28, 4, v24
M v[184:187],a[148:151],a[172:175],v[184:187]
buffer_load_dwordx4 v9, s[16:19], s21 offen offset:1024   lds
M v[184:187],a[144:147],a[168:171],v[184:187]
L_w_kv04:
s_cbranch_execz L_w_kv08
v_lshlrev_b32 v28, 5, v28
M v[180:183],a[136:139],a[168:171],v[180:183]
v_and_b32 v30, 15, v24
M v[180:183],a[140:143],a[172:175],v[180:183]
s_nop 0
T a[84:85],v3,57344
T a[86:87],v3,58368
M v[176:179],a[132:135],a[172:175],v[176:179]
v_add_lshl_u32 v28, v28, v30, 2
M v[176:179],a[128:131],a[168:171],v[176:179]
v_lshrrev_b32 v30, 1, v0
M v[172:175],a[120:123],a[168:171],v[172:175]
v_min_u32 v30, 1, v30
M v[172:175],a[124:127],a[172:175],v[172:175]
buffer_load_dwordx4 v10, s[16:19], s21 offen offset:2048   lds
M v[168:171],a[116:119],a[172:175],v[168:171]
v_lshl_or_b32 v28, v30, 29, v28
M v[168:171],a[112:115],a[168:171],v[168:171]
s_or_b32 s64, s31, s20
M v[164:167],a[104:107],a[168:171],v[164:167]
s_min_u32 s64, s64, 1
T a[88:89],v4,49152
T a[90:91],v4,50176
M v[164:167],a[108:111],a[172:175],v[164:167]
s_waitcnt lgkmcnt(4)
s_lshl_b32 s64, s64, 29
M v[160:163],a[100:103],a[172:175],v[160:163]
SA s64,s64,104857600
buffer_load_dword v23, v28, s[8:11], s64 offen sc1
M v[160:163],a[96:99],a[168:171],v[160:163]
buffer_load_dwordx4 v11, s[16:19], s21 offen offset:3072   lds
M v[192:195],a[96:99],a[160:163],v[192:195]
SA s21,s21,128
R a[168:171],v5,22528
R a[172:175],v6,22528
M v[192:195],a[100:103],a[164:167],v[192:195]
v_bfe_u32 v28, v0, 2, 2
M v[196:199],a[108:111],a[164:167],v[196:199]
v_lshl_add_u32 v28, v29, 3, v28
M v[196:199],a[104:107],a[160:163],v[196:199]
s_nop 0
T a[92:93],v4,57344
T a[94:95],v4,58368
M v[200:203],a[112:115],a[160:163],v[200:203]
SA m0,s87,6144
v_lshlrev_b32 v28, 5, v28
M v[200:203],a[116:119],a[164:167],v[200:203]
buffer_load_dwordx4 v25, s[60:63], s89 offen offset:0  lds
M v[204:207],a[124:127],a[164:167],v[204:207]
SA s89,s89,114688
v_and_b32 v30, 3, v0
M v[204:207],a[120:123],a[160:163],v[204:207]
v_lshl_add_u32 v28, v30, 3, v28
M v[208:211],a[128:131],a[160:163],v[208:211]
v_add_u32 v22, s87, v28
M v[208:211],a[132:135],a[164:167],v[208:211]
M v[212:215],a[140:143],a[164:167],v[212:215]
M v[212:215],a[136:139],a[160:163],v[212:215]
M v[216:219],a[144:147],a[160:163],v[216:219]
M v[216:219],a[148:151],a[164:167],v[216:219]
s_waitcnt lgkmcnt(2)
M v[220:223],a[156:159],a[164:167],v[220:223]
s_waitcnt vmcnt(26) lgkmcnt(0)
M v[220:223],a[152:155],a[160:163],v[220:223]
s_barrier
M v[252:255],a[152:155],a[168:171],v[252:255]
R a[160:163],v5,32768
R a[164:167],v6,32768
M v[252:255],a[156:159],a[172:175],v[252:255]
M v[248:251],a[148:151],a[172:175],v[248:251]
M v[248:251],a[144:147],a[168:171],v[248:251]
M v[244:247],a[136:139],a[168:171],v[244:247]
M v[244:247],a[140:143],a[172:175],v[244:247]
M v[240:243],a[132:135],a[172:175],v[240:243]
M v[240:243],a[128:131],a[168:171],v[240:243]
M v[236:239],a[120:123],a[168:171],v[236:239]
M v[236:239],a[124:127],a[172:175],v[236:239]
M v[232:235],a[116:119],a[172:175],v[232:235]
M v[232:235],a[112:115],a[168:171],v[232:235]
M v[228:231],a[104:107],a[168:171],v[228:231]
M v[228:231],a[108:111],a[172:175],v[228:231]
s_waitcnt lgkmcnt(0)
M v[224:227],a[100:103],a[172:175],v[224:227]
M v[224:227],a[96:99],a[168:171],v[224:227]
M a[0:3],a[32:35],a[160:163],a[0:3]
R a[168:171],v5,34816
R a[172:175],v6,34816
M a[0:3],a[36:39],a[164:167],a[0:3]
T a[96:97],v1,0
T a[98:99],v1,1024
M a[4:7],a[44:47],a[164:167],a[4:7]
SA m0,s24,16384
M a[4:7],a[40:43],a[160:163],a[4:7]
buffer_load_dwordx4 v12, s[48:51], s22 offen offset:0   lds
M a[8:11],a[48:51],a[160:163],a[8:11]
M a[8:11],a[52:55],a[164:167],a[8:11]
M a[12:15],a[60:63],a[164:167],a[12:15]
s_nop 0
T a[100:101],v1,8192
T a[102:103],v1,9216
M a[12:15],a[56:59],a[160:163],a[12:15]
M a[16:19],a[64:67],a[160:163],a[16:19]
buffer_load_dwordx4 v13, s[48:51], s22 offen offset:1024   lds
M a[16:19],a[68:71],a[164:167],a[16:19]
M a[20:23],a[76:79],a[164:167],a[20:23]
M a[20:23],a[72:75],a[160:163],a[20:23]
s_nop 0
T a[104:105],v2,0
T a[106:107],v2,1024
M a[24:27],a[80:83],a[160:163],a[24:27]
M a[24:27],a[84:87],a[164:167],a[24:27]
s_waitcnt lgkmcnt(6)
buffer_load_dwordx4 v14, s[48:51], s22 offen offset:2048   lds
M a[28:31],a[92:95],a[164:167],a[28:31]
M a[28:31],a[88:91],a[160:163],a[28:31]
M v[60:63],a[88:91],a[168:171],v[60:63]
R a[160:163],v5,36864
R a[164:167],v6,36864
M v[60:63],a[92:95],a[172:175],v[60:63]
T a[108:109],v2,8192
T a[110:111],v2,9216
M v[56:59],a[84:87],a[172:175],v[56:59]
buffer_load_dwordx4 v15, s[48:51], s22 offen offset:3072   lds
M v[56:59],a[80:83],a[168:171],v[56:59]
s_sub_u32 s22, s22, 1048448
M v[52:55],a[72:75],a[168:171],v[52:55]
M v[52:55],a[76:79],a[172:175],v[52:55]
s_nop 0
T a[112:113],v3,0
T a[114:115],v3,1024
M v[48:51],a[68:71],a[172:175],v[48:51]
SA m0,s23,49152
M v[48:51],a[64:67],a[168:171],v[48:51]
buffer_load_dwordx4 v8, s[16:19], s21 offen offset:0   lds
M v[44:47],a[56:59],a[168:171],v[44:47]
M v[44:47],a[60:63],a[172:175],v[44:47]
M v[40:43],a[52:55],a[172:175],v[40:43]
s_nop 0
T a[116:117],v3,8192
T a[118:119],v3,9216
M v[40:43],a[48:51],a[168:171],v[40:43]
M v[36:39],a[40:43],a[168:171],v[36:39]
buffer_load_dwordx4 v9, s[16:19], s21 offen offset:1024   lds
M v[36:39],a[44:47],a[172:175],v[36:39]
s_waitcnt lgkmcnt(6)
M v[32:35],a[36:39],a[172:175],v[32:35]
M v[32:35],a[32:35],a[168:171],v[32:35]
s_nop 0
T a[120:121],v4,0
T a[122:123],v4,1024
M v[64:67],a[32:35],a[160:163],v[64:67]
R a[168:171],v5,38912
R a[172:175],v6,38912
M v[64:67],a[36:39],a[164:167],v[64:67]
buffer_load_dwordx4 v10, s[16:19], s21 offen offset:2048   lds
M v[68:71],a[44:47],a[164:167],v[68:71]
M v[68:71],a[40:43],a[160:163],v[68:71]
M v[72:75],a[48:51],a[160:163],v[72:75]
s_nop 0
T a[124:125],v4,8192
T a[126:127],v4,9216
M v[72:75],a[52:55],a[164:167],v[72:75]
M v[76:79],a[60:63],a[164:167],v[76:79]
buffer_load_dwordx4 v11, s[16:19], s21 offen offset:3072   lds
M v[76:79],a[56:59],a[160:163],v[76:79]
SA s21,s21,524160
M v[80:83],a[64:67],a[160:163],v[80:83]
M v[80:83],a[68:71],a[164:167],v[80:83]
M v[84:87],a[76:79],a[164:167],v[84:87]
M v[84:87],a[72:75],a[160:163],v[84:87]
M v[88:91],a[80:83],a[160:163],v[88:91]
M v[88:91],a[84:87],a[164:167],v[88:91]
s_waitcnt lgkmcnt(2)
M v[92:95],a[92:95],a[164:167],v[92:95]
s_waitcnt vmcnt(26) lgkmcnt(0)
M v[92:95],a[88:91],a[160:163],v[92:95]
s_barrier
M v[124:127],a[88:91],a[168:171],v[124:127]
R a[160:163],v5,49152
R a[164:167],v6,49152
M v[124:127],a[92:95],a[172:175],v[124:127]
M v[120:123],a[84:87],a[172:175],v[120:123]
SA m0,s24,32768
T a[128:129],v1,16384
T a[130:131],v1,17408
M v[120:123],a[80:83],a[168:171],v[120:123]
s_waitcnt vmcnt(8)
buffer_load_dwordx4 v12, s[48:51], s22 offen offset:0   lds
M v[116:119],a[72:75],a[168:171],v[116:119]
s_nop 0
T a[176:177],v22,0
T a[178:179],v22,128
M v[116:119],a[76:79],a[172:175],v[116:119]
T a[180:181],v22,1024
T a[182:183],v22,1152
M v[112:115],a[68:71],a[172:175],v[112:115]
T a[184:185],v22,2048
T a[186:187],v22,2176
M v[112:115],a[64:67],a[168:171],v[112:115]
T a[188:189],v22,3072
T a[190:191],v22,3200
M v[108:111],a[56:59],a[168:171],v[108:111]
M v[108:111],a[60:63],a[172:175],v[108:111]
s_nop 0
T a[132:133],v1,24576
T a[134:135],v1,25600
M v[104:107],a[52:55],a[172:175],v[104:107]
buffer_load_dwordx4 v13, s[48:51], s22 offen offset:1024   lds
M v[104:107],a[48:51],a[168:171],v[104:107]
M v[100:103],a[40:43],a[168:171],v[100:103]
M v[100:103],a[44:47],a[172:175],v[100:103]
s_waitcnt lgkmcnt(12)
M v[96:99],a[36:39],a[172:175],v[96:99]
M v[96:99],a[32:35],a[168:171],v[96:99]
M v[128:131],a[32:35],a[160:163],v[128:131]
R a[168:171],v5,51200
R a[172:175],v6,51200
M v[128:131],a[36:39],a[164:167],v[128:131]
T a[136:137],v2,16384
T a[138:139],v2,17408
M v[132:135],a[44:47],a[164:167],v[132:135]
buffer_load_dwordx4 v14, s[48:51], s22 offen offset:2048   lds
M v[132:135],a[40:43],a[160:163],v[132:135]
M v[136:139],a[48:51],a[160:163],v[136:139]
M v[136:139],a[52:55],a[164:167],v[136:139]
M v[140:143],a[60:63],a[164:167],v[140:143]
M v[140:143],a[56:59],a[160:163],v[140:143]
s_nop 0
T a[140:141],v2,24576
T a[142:143],v2,25600
M v[144:147],a[64:67],a[160:163],v[144:147]
buffer_load_dwordx4 v15, s[48:51], s22 offen offset:3072   lds
M v[144:147],a[68:71],a[164:167],v[144:147]
SA s22,s22,1048576
M v[148:151],a[76:79],a[164:167],v[148:151]
M v[148:151],a[72:75],a[160:163],v[148:151]
M v[152:155],a[80:83],a[160:163],v[152:155]
M v[152:155],a[84:87],a[164:167],v[152:155]
s_waitcnt lgkmcnt(4)
M v[156:159],a[92:95],a[164:167],v[156:159]
SA m0,s23,0
T a[144:145],v3,16384
T a[146:147],v3,17408
M v[156:159],a[88:91],a[160:163],v[156:159]
buffer_load_dwordx4 v8, s[16:19], s21 offen offset:0   lds
M v[16:19],a[176:179],a[208:211],0
M v[16:19],a[180:183],a[212:215],v[16:19]
M v[16:19],a[184:187],a[216:219],v[16:19]
M v[16:19],a[188:191],a[220:223],v[16:19]
M v[188:191],a[88:91],a[168:171],v[188:191]
R a[160:163],v5,53248
R a[164:167],v6,53248
M v[188:191],a[92:95],a[172:175],v[188:191]
T a[176:177],v22,4096
T a[178:179],v22,4224
M v[184:187],a[84:87],a[172:175],v[184:187]
T a[180:181],v22,5120
T a[182:183],v22,5248
M v[184:187],a[80:83],a[168:171],v[184:187]
T a[184:185],v22,6144
T a[186:187],v22,6272
M v[180:183],a[72:75],a[168:171],v[180:183]
M v[180:183],a[76:79],a[172:175],v[180:183]
s_nop 0
T a[148:149],v3,24576
T a[150:151],v3,25600
M v[176:179],a[68:71],a[172:175],v[176:179]
buffer_load_dwordx4 v9, s[16:19], s21 offen offset:1024   lds
M v[176:179],a[64:67],a[168:171],v[176:179]
M v[172:175],a[56:59],a[168:171],v[172:175]
M v[172:175],a[60:63],a[172:175],v[172:175]
M v[168:171],a[52:55],a[172:175],v[168:171]
M v[168:171],a[48:51],a[168:171],v[168:171]
M v[164:167],a[40:43],a[168:171],v[164:167]
s_nop 0
T a[152:153],v4,16384
T a[154:155],v4,17408
M v[164:167],a[44:47],a[172:175],v[164:167]
s_waitcnt lgkmcnt(10)
buffer_load_dwordx4 v10, s[16:19], s21 offen offset:2048   lds
M v[160:163],a[36:39],a[172:175],v[160:163]
M v[160:163],a[32:35],a[168:171],v[160:163]
M v[192:195],a[32:35],a[160:163],v[192:195]
R a[168:171],v5,55296
R a[172:175],v6,55296
M v[192:195],a[36:39],a[164:167],v[192:195]
M v[196:199],a[44:47],a[164:167],v[196:199]
M v[196:199],a[40:43],a[160:163],v[196:199]
s_nop 0
T a[156:157],v4,24576
T a[158:159],v4,25600
M v[200:203],a[48:51],a[160:163],v[200:203]
buffer_load_dwordx4 v11, s[16:19], s21 offen offset:3072   lds
M v[200:203],a[52:55],a[164:167],v[200:203]
SA s21,s21,128
M v[204:207],a[60:63],a[164:167],v[204:207]
M v[204:207],a[56:59],a[160:163],v[204:207]
M v[208:211],a[64:67],a[160:163],v[208:211]
M v[208:211],a[68:71],a[164:167],v[208:211]
M v[212:215],a[76:79],a[164:167],v[212:215]
M v[212:215],a[72:75],a[160:163],v[212:215]
M v[216:219],a[80:83],a[160:163],v[216:219]
M v[216:219],a[84:87],a[164:167],v[216:219]
s_waitcnt lgkmcnt(2)
M v[220:223],a[92:95],a[164:167],v[220:223]
s_waitcnt lgkmcnt(0)
M v[220:223],a[88:91],a[160:163],v[220:223]
s_barrier
M v[16:19],a[176:179],a[224:227],v[16:19]
M v[16:19],a[180:183],a[228:231],v[16:19]
M v[16:19],a[184:187],a[232:235],v[16:19]
M v[252:255],a[88:91],a[168:171],v[252:255]
R a[160:163],v5,0
R a[164:167],v6,0
M v[252:255],a[92:95],a[172:175],v[252:255]
M v[248:251],a[84:87],a[172:175],v[248:251]
M v[248:251],a[80:83],a[168:171],v[248:251]
M v[244:247],a[72:75],a[168:171],v[244:247]
M v[244:247],a[76:79],a[172:175],v[244:247]
M v[240:243],a[68:71],a[172:175],v[240:243]
M v[240:243],a[64:67],a[168:171],v[240:243]
M v[236:239],a[56:59],a[168:171],v[236:239]
M v[236:239],a[60:63],a[172:175],v[236:239]
M v[232:235],a[52:55],a[172:175],v[232:235]
M v[232:235],a[48:51],a[168:171],v[232:235]
M v[228:231],a[40:43],a[168:171],v[228:231]
M v[228:231],a[44:47],a[172:175],v[228:231]
s_waitcnt lgkmcnt(0)
M v[224:227],a[36:39],a[172:175],v[224:227]
M v[224:227],a[32:35],a[168:171],v[224:227]
M a[0:3],a[96:99],a[160:163],a[0:3]
R a[168:171],v5,2048
R a[172:175],v6,2048
M a[0:3],a[100:103],a[164:167],a[0:3]
T a[32:33],v1,32768
T a[34:35],v1,33792
M a[4:7],a[108:111],a[164:167],a[4:7]
SA m0,s24,49152
M a[4:7],a[104:107],a[160:163],a[4:7]
buffer_load_dwordx4 v12, s[48:51], s22 offen offset:0   lds
M a[8:11],a[112:115],a[160:163],a[8:11]
M a[8:11],a[116:119],a[164:167],a[8:11]
s_lshl_b32 s64, s20, 10
M a[12:15],a[124:127],a[164:167],a[12:15]
SA s64,s64,159744
T a[36:37],v1,40960
T a[38:39],v1,41984
M a[12:15],a[120:123],a[160:163],a[12:15]
v_add_u32 v21, s64, v7
ds_write_b128 v21, v[16:19]
M a[16:19],a[128:131],a[160:163],a[16:19]
s_mul_i32 s67, s86, 14336
buffer_load_dwordx4 v13, s[48:51], s22 offen offset:1024   lds
M a[16:19],a[132:135],a[164:167],a[16:19]
s_mul_i32 s64, s20, 224
M a[20:23],a[140:143],a[164:167],a[20:23]
SA s67,s67,s64
v_lshrrev_b32 v28, 4, v0
v_mul_u32_u24 v28, 896, v28
M a[20:23],a[136:139],a[160:163],a[20:23]
T a[40:41],v2,32768
T a[42:43],v2,33792
M a[24:27],a[144:147],a[160:163],a[24:27]
v_and_b32 v29, 15, v0
v_lshl_add_u32 v28, v29, 4, v28
M a[24:27],a[148:151],a[164:167],a[24:27]
s_waitcnt lgkmcnt(7)
buffer_load_dwordx4 v14, s[48:51], s22 offen offset:2048   lds
M a[28:31],a[156:159],a[164:167],a[28:31]
v_mov_b32 v30, 536870912
v_cmp_gt_u32 vcc, 14, v29
M a[28:31],a[152:155],a[160:163],a[28:31]
s_nop 0
M v[60:63],a[152:155],a[168:171],v[60:63]
s_nop 0
R a[160:163],v5,4096
R a[164:167],v6,4096
M v[60:63],a[156:159],a[172:175],v[60:63]
T a[44:45],v2,40960
T a[46:47],v2,41984
M v[56:59],a[148:151],a[172:175],v[56:59]
buffer_load_dwordx4 v15, s[48:51], s22 offen offset:3072   lds
M v[56:59],a[144:147],a[168:171],v[56:59]
s_sub_u32 s22, s22, 1048448
v_cndmask_b32 v28, v30, v28, vcc
v_add_u32 v29, 2560, v28
M v[52:55],a[136:139],a[168:171],v[52:55]
v_add_u32 v30, 5120, v28
v_add_u32 v31, 7680, v28
M v[52:55],a[140:143],a[172:175],v[52:55]
T a[48:49],v3,32768
T a[50:51],v3,33792
M v[48:51],a[132:135],a[172:175],v[48:51]
SA m0,s23,16384
M v[48:51],a[128:131],a[168:171],v[48:51]
buffer_load_dwordx4 v8, s[16:19], s21 offen offset:0   lds
M v[44:47],a[120:123],a[168:171],v[44:47]
M v[44:47],a[124:127],a[172:175],v[44:47]
M v[40:43],a[116:119],a[172:175],v[40:43]
s_nop 0
T a[52:53],v3,40960
T a[54:55],v3,41984
M v[40:43],a[112:115],a[168:171],v[40:43]
M v[36:39],a[104:107],a[168:171],v[36:39]
buffer_load_dwordx4 v9, s[16:19], s21 offen offset:1024   lds
M v[36:39],a[108:111],a[172:175],v[36:39]
s_waitcnt lgkmcnt(6)
M v[32:35],a[100:103],a[172:175],v[32:35]
M v[32:35],a[96:99],a[168:171],v[32:35]
s_nop 0
T a[56:57],v4,32768
T a[58:59],v4,33792
M v[64:67],a[96:99],a[160:163],v[64:67]
R a[168:171],v5,6144
R a[172:175],v6,6144
M v[64:67],a[100:103],a[164:167],v[64:67]
buffer_load_dwordx4 v10, s[16:19], s21 offen offset:2048   lds
M v[68:71],a[108:111],a[164:167],v[68:71]
M v[68:71],a[104:107],a[160:163],v[68:71]
M v[72:75],a[112:115],a[160:163],v[72:75]
s_nop 0
T a[60:61],v4,40960
T a[62:63],v4,41984
M v[72:75],a[116:119],a[164:167],v[72:75]
M v[76:79],a[124:127],a[164:167],v[76:79]
buffer_load_dwordx4 v11, s[16:19], s21 offen offset:3072   lds
M v[76:79],a[120:123],a[160:163],v[76:79]
SA s21,s21,524160
M v[80:83],a[128:131],a[160:163],v[80:83]
M v[80:83],a[132:135],a[164:167],v[80:83]
M v[84:87],a[140:143],a[164:167],v[84:87]
M v[84:87],a[136:139],a[160:163],v[84:87]
M v[88:91],a[144:147],a[160:163],v[88:91]
M v[88:91],a[148:151],a[164:167],v[88:91]
s_waitcnt lgkmcnt(2)
M v[92:95],a[156:159],a[164:167],v[92:95]
s_waitcnt vmcnt(16) lgkmcnt(0)
M v[92:95],a[152:155],a[160:163],v[92:95]
s_barrier
M v[124:127],a[152:155],a[168:171],v[124:127]
R a[160:163],v5,16384
R a[164:167],v6,16384
M v[124:127],a[156:159],a[172:175],v[124:127]
M v[120:123],a[148:151],a[172:175],v[120:123]
SA m0,s24,0
T a[64:65],v1,49152
T a[66:67],v1,50176
M v[120:123],a[144:147],a[168:171],v[120:123]
buffer_load_dwordx4 v12, s[48:51], s22 offen offset:0   lds
M v[116:119],a[136:139],a[168:171],v[116:119]
M v[116:119],a[140:143],a[172:175],v[116:119]
M v[112:115],a[132:135],a[172:175],v[112:115]
M v[112:115],a[128:131],a[168:171],v[112:115]
buffer_load_dwordx4 v13, s[48:51], s22 offen offset:1024   lds
M v[108:111],a[120:123],a[168:171],v[108:111]
M v[108:111],a[124:127],a[172:175],v[108:111]
s_nop 0
T a[68:69],v1,57344
T a[70:71],v1,58368
M v[104:107],a[116:119],a[172:175],v[104:107]
M v[104:107],a[112:115],a[168:171],v[104:107]
M v[100:103],a[104:107],a[168:171],v[100:103]
buffer_load_dwordx4 v14, s[48:51], s22 offen offset:2048   lds
M v[100:103],a[108:111],a[172:175],v[100:103]
s_waitcnt lgkmcnt(4)
M v[96:99],a[100:103],a[172:175],v[96:99]
M v[96:99],a[96:99],a[168:171],v[96:99]
M v[128:131],a[96:99],a[160:163],v[128:131]
R a[168:171],v5,18432
R a[172:175],v6,18432
M v[128:131],a[100:103],a[164:167],v[128:131]
T a[72:73],v2,49152
T a[74:75],v2,50176
M v[132:135],a[108:111],a[164:167],v[132:135]
buffer_load_dwordx4 v15, s[48:51], s22 offen offset:3072   lds
M v[132:135],a[104:107],a[160:163],v[132:135]
SA s22,s22,1048576
M v[136:139],a[112:115],a[160:163],v[136:139]
M v[136:139],a[116:119],a[164:167],v[136:139]
SA m0,s23,32768
M v[140:143],a[124:127],a[164:167],v[140:143]
buffer_load_dwordx4 v8, s[16:19], s21 offen offset:0   lds
M v[140:143],a[120:123],a[160:163],v[140:143]
s_nop 0
T a[76:77],v2,57344
T a[78:79],v2,58368
M v[144:147],a[128:131],a[160:163],v[144:147]
M v[144:147],a[132:135],a[164:167],v[144:147]
M v[148:151],a[140:143],a[164:167],v[148:151]
buffer_load_dwordx4 v9, s[16:19], s21 offen offset:1024   lds
M v[148:151],a[136:139],a[160:163],v[148:151]
M v[152:155],a[144:147],a[160:163],v[152:155]
M v[152:155],a[148:151],a[164:167],v[152:155]
s_waitcnt lgkmcnt(4)
M v[156:159],a[156:159],a[164:167],v[156:159]
s_nop 0
T a[80:81],v3,49152
T a[82:83],v3,50176
M v[156:159],a[152:155],a[160:163],v[156:159]
buffer_load_dwordx4 v10, s[16:19], s21 offen offset:2048   lds
M v[188:191],a[152:155],a[168:171],v[188:191]
R a[160:163],v5,20480
R a[164:167],v6,20480
M v[188:191],a[156:159],a[172:175],v[188:191]
M v[184:187],a[148:151],a[172:175],v[184:187]
M v[184:187],a[144:147],a[168:171],v[184:187]
M v[180:183],a[136:139],a[168:171],v[180:183]
buffer_load_dwordx4 v11, s[16:19], s21 offen offset:3072   lds
M v[180:183],a[140:143],a[172:175],v[180:183]
SA s21,s21,128
T a[84:85],v3,57344
T a[86:87],v3,58368
M v[176:179],a[132:135],a[172:175],v[176:179]
M v[176:179],a[128:131],a[168:171],v[176:179]
M v[172:175],a[120:123],a[168:171],v[172:175]
SA m0,s87,0
M v[172:175],a[124:127],a[172:175],v[172:175]
buffer_load_dwordx4 v28, s[68:71], s67 offen offset:0 nt lds
M v[168:171],a[116:119],a[172:175],v[168:171]
M v[168:171],a[112:115],a[168:171],v[168:171]
M v[164:167],a[104:107],a[168:171],v[164:167]
s_nop 0
T a[88:89],v4,49152
T a[90:91],v4,50176
M v[164:167],a[108:111],a[172:175],v[164:167]
s_waitcnt lgkmcnt(4)
buffer_load_dwordx4 v29, s[68:71], s67 offen offset:1024 nt lds
M v[160:163],a[100:103],a[172:175],v[160:163]
M v[160:163],a[96:99],a[168:171],v[160:163]
M v[192:195],a[96:99],a[160:163],v[192:195]
R a[168:171],v5,22528
R a[172:175],v6,22528
M v[192:195],a[100:103],a[164:167],v[192:195]
M v[196:199],a[108:111],a[164:167],v[196:199]
buffer_load_dwordx4 v30, s[68:71], s67 offen offset:2048 nt lds
M v[196:199],a[104:107],a[160:163],v[196:199]
s_nop 0
T a[92:93],v4,57344
T a[94:95],v4,58368
M v[200:203],a[112:115],a[160:163],v[200:203]
M v[200:203],a[116:119],a[164:167],v[200:203]
M v[204:207],a[124:127],a[164:167],v[204:207]
M v[204:207],a[120:123],a[160:163],v[204:207]
buffer_load_dwordx4 v31, s[68:71], s67 offen offset:3072 nt lds
M v[208:211],a[128:131],a[160:163],v[208:211]
SA s67,s67,0
M v[208:211],a[132:135],a[164:167],v[208:211]
L_w_kv05:
s_cbranch_execz L_wd1
M v[212:215],a[140:143],a[164:167],v[212:215]
M v[212:215],a[136:139],a[160:163],v[212:215]
M v[216:219],a[144:147],a[160:163],v[216:219]
M v[216:219],a[148:151],a[164:167],v[216:219]
s_waitcnt lgkmcnt(2)
M v[220:223],a[156:159],a[164:167],v[220:223]
s_waitcnt vmcnt(20) lgkmcnt(0)
M v[220:223],a[152:155],a[160:163],v[220:223]
s_barrier
M v[252:255],a[152:155],a[168:171],v[252:255]
R a[160:163],v5,32768
R a[164:167],v6,32768
M v[252:255],a[156:159],a[172:175],v[252:255]
M v[248:251],a[148:151],a[172:175],v[248:251]
M v[248:251],a[144:147],a[168:171],v[248:251]
M v[244:247],a[136:139],a[168:171],v[244:247]
M v[244:247],a[140:143],a[172:175],v[244:247]
M v[240:243],a[132:135],a[172:175],v[240:243]
M v[240:243],a[128:131],a[168:171],v[240:243]
M v[236:239],a[120:123],a[168:171],v[236:239]
M v[236:239],a[124:127],a[172:175],v[236:239]
M v[232:235],a[116:119],a[172:175],v[232:235]
M v[232:235],a[112:115],a[168:171],v[232:235]
M v[228:231],a[104:107],a[168:171],v[228:231]
M v[228:231],a[108:111],a[172:175],v[228:231]
s_waitcnt lgkmcnt(0)
M v[224:227],a[100:103],a[172:175],v[224:227]
M v[224:227],a[96:99],a[168:171],v[224:227]
M a[0:3],a[32:35],a[160:163],a[0:3]
R a[168:171],v5,34816
R a[172:175],v6,34816
M a[0:3],a[36:39],a[164:167],a[0:3]
T a[96:97],v1,0
T a[98:99],v1,1024
M a[4:7],a[44:47],a[164:167],a[4:7]
SA m0,s24,16384
C v23,v23,v23
M a[4:7],a[40:43],a[160:163],a[4:7]
buffer_load_dwordx4 v12, s[48:51], s22 offen offset:0   lds
M a[8:11],a[48:51],a[160:163],a[8:11]
v_and_b32 v23, 0xffff0000, v23
M a[8:11],a[52:55],a[164:167],a[8:11]
MF v22,0xbfb8aa3b,v23
M a[12:15],a[60:63],a[164:167],a[12:15]
s_nop 0
T a[100:101],v1,8192
T a[102:103],v1,9216
M a[12:15],a[56:59],a[160:163],a[12:15]
E v22,v22
M a[16:19],a[64:67],a[160:163],a[16:19]
buffer_load_dwordx4 v13, s[48:51], s22 offen offset:1024   lds
M a[16:19],a[68:71],a[164:167],a[16:19]
AF v22,1.0,v22
M a[20:23],a[76:79],a[164:167],a[20:23]
v_rcp_f32 v23, v22
M a[20:23],a[72:75],a[160:163],a[20:23]
s_or_b32 s64, s31, s20
T a[104:105],v2,0
T a[106:107],v2,1024
M a[24:27],a[80:83],a[160:163],a[24:27]
s_min_u32 s64, s64, 1
s_lshl_b32 s64, s64, 29
v_lshrrev_b32 v22, 1, v0
M a[24:27],a[84:87],a[164:167],a[24:27]
s_waitcnt lgkmcnt(6)
buffer_load_dwordx4 v14, s[48:51], s22 offen offset:2048   lds
M a[28:31],a[92:95],a[164:167],a[28:31]
v_min_u32 v22, 1, v22
M a[28:31],a[88:91],a[160:163],a[28:31]
v_lshlrev_b32 v22, 29, v22
M v[60:63],a[88:91],a[168:171],v[60:63]
R a[160:163],v5,36864
R a[164:167],v6,36864
M v[60:63],a[92:95],a[172:175],v[60:63]
T a[108:109],v2,8192
T a[110:111],v2,9216
M v[56:59],a[84:87],a[172:175],v[56:59]
buffer_load_dwordx4 v15, s[48:51], s22 offen offset:3072   lds
M v[56:59],a[80:83],a[168:171],v[56:59]
s_sub_u32 s22, s22, 1048448
v_lshl_or_b32 v22, v0, 2, v22
M v[52:55],a[72:75],a[168:171],v[52:55]
v_or_b32 v22, s64, v22
M v[52:55],a[76:79],a[172:175],v[52:55]
s_nop 0
T a[112:113],v3,0
T a[114:115],v3,1024
M v[48:51],a[68:71],a[172:175],v[48:51]
SA m0,s23,49152
C v23,v23,v23
M v[48:51],a[64:67],a[168:171],v[48:51]
buffer_load_dwordx4 v8, s[16:19], s21 offen offset:0   lds
M v[44:47],a[56:59],a[168:171],v[44:47]
v_and_b32 v23, 0xffff0000, v23
M v[44:47],a[60:63],a[172:175],v[44:47]
s_lshl_b32 s64, s41, 7
M v[40:43],a[52:55],a[172:175],v[40:43]
SA s64,s64,104890368
T a[116:117],v3,8192
T a[118:119],v3,9216
M v[40:43],a[48:51],a[168:171],v[40:43]
buffer_store_dword v24, v22, s[8:11], s64 offen sc1
M v[36:39],a[40:43],a[168:171],v[36:39]
buffer_load_dwordx4 v9, s[16:19], s21 offen offset:1024   lds
M v[36:39],a[44:47],a[172:175],v[36:39]
s_waitcnt lgkmcnt(6)
buffer_store_dword v23, v22, s[8:11], s64 offen offset:8 sc1
M v[32:35],a[36:39],a[172:175],v[32:35]
v_add_u32 v25, 159744, v7
M v[32:35],a[32:35],a[168:171],v[32:35]
s_nop 0
T a[120:121],v4,0
T a[122:123],v4,1024
M v[64:67],a[32:35],a[160:163],v[64:67]
R a[168:171],v5,38912
R a[172:175],v6,38912
M v[64:67],a[36:39],a[164:167],v[64:67]
buffer_load_dwordx4 v10, s[16:19], s21 offen offset:2048   lds
M v[68:71],a[44:47],a[164:167],v[68:71]
ds_read_b128 v[16:19], v25
M v[68:71],a[40:43],a[160:163],v[68:71]
R v[28:31],v25,1024
M v[72:75],a[48:51],a[160:163],v[72:75]
s_nop 0
T a[124:125],v4,8192
T a[126:127],v4,9216
M v[72:75],a[52:55],a[164:167],v[72:75]
R v[20:23],v25,2048
M v[76:79],a[60:63],a[164:167],v[76:79]
buffer_load_dwordx4 v11, s[16:19], s21 offen offset:3072   lds
M v[76:79],a[56:59],a[160:163],v[76:79]
SA s21,s21,524160
M v[80:83],a[64:67],a[160:163],v[80:83]
M v[80:83],a[68:71],a[164:167],v[80:83]
M v[84:87],a[76:79],a[164:167],v[84:87]
M v[84:87],a[72:75],a[160:163],v[84:87]
M v[88:91],a[80:83],a[160:163],v[88:91]
M v[88:91],a[84:87],a[164:167],v[88:91]
s_waitcnt lgkmcnt(5)
s_waitcnt lgkmcnt(3)
AF v16,v28,v16
M v[92:95],a[92:95],a[164:167],v[92:95]
s_waitcnt vmcnt(22) lgkmcnt(0)
AF v17,v29,v17
M v[92:95],a[88:91],a[160:163],v[92:95]
s_barrier
M v[124:127],a[88:91],a[168:171],v[124:127]
R a[160:163],v5,49152
R a[164:167],v6,49152
M v[124:127],a[92:95],a[172:175],v[124:127]
AF v18,v30,v18
M v[120:123],a[84:87],a[172:175],v[120:123]
SA m0,s24,32768
T a[128:129],v1,16384
T a[130:131],v1,17408
M v[120:123],a[80:83],a[168:171],v[120:123]
buffer_load_dwordx4 v12, s[48:51], s22 offen offset:0   lds
M v[116:119],a[72:75],a[168:171],v[116:119]
AF v19,v31,v19
M v[116:119],a[76:79],a[172:175],v[116:119]
R v[28:31],v25,3072
M v[112:115],a[68:71],a[172:175],v[112:115]
C v25,v16,v17
M v[112:115],a[64:67],a[168:171],v[112:115]
v_lshlrev_b32 v16, 16, v25
M v[108:111],a[56:59],a[168:171],v[108:111]
v_and_b32 v17, 0xffff0000, v25
M v[108:111],a[60:63],a[172:175],v[108:111]
s_nop 0
T a[132:133],v1,24576
T a[134:135],v1,25600
M v[104:107],a[52:55],a[172:175],v[104:107]
buffer_load_dwordx4 v13, s[48:51], s22 offen offset:1024   lds
M v[104:107],a[48:51],a[168:171],v[104:107]
C v25,v18,v19
M v[100:103],a[40:43],a[168:171],v[100:103]
v_lshlrev_b32 v18, 16, v25
M v[100:103],a[44:47],a[172:175],v[100:103]
s_waitcnt lgkmcnt(5)
v_and_b32 v19, 0xffff0000, v25
M v[96:99],a[36:39],a[172:175],v[96:99]
s_waitcnt lgkmcnt(2)
AF v20,v28,v20
M v[96:99],a[32:35],a[168:171],v[96:99]
AF v21,v29,v21
M v[128:131],a[32:35],a[160:163],v[128:131]
R a[168:171],v5,51200
R a[172:175],v6,51200
M v[128:131],a[36:39],a[164:167],v[128:131]
T a[136:137],v2,16384
T a[138:139],v2,17408
M v[132:135],a[44:47],a[164:167],v[132:135]
buffer_load_dwordx4 v14, s[48:51], s22 offen offset:2048   lds
M v[132:135],a[40:43],a[160:163],v[132:135]
AF v22,v30,v22
M v[136:139],a[48:51],a[160:163],v[136:139]
AF v23,v31,v23
M v[136:139],a[52:55],a[164:167],v[136:139]
MF v28,0xbfb8aa3b,v16
M v[140:143],a[60:63],a[164:167],v[140:143]
MF v29,0xbfb8aa3b,v17
M v[140:143],a[56:59],a[160:163],v[140:143]
s_nop 0
T a[140:141],v2,24576
T a[142:143],v2,25600
M v[144:147],a[64:67],a[160:163],v[144:147]
buffer_load_dwordx4 v15, s[48:51], s22 offen offset:3072   lds
M v[144:147],a[68:71],a[164:167],v[144:147]
SA s22,s22,1048576
MF v30,0xbfb8aa3b,v18
M v[148:151],a[76:79],a[164:167],v[148:151]
MF v31,0xbfb8aa3b,v19
M v[148:151],a[72:75],a[160:163],v[148:151]
E v28,v28
M v[152:155],a[80:83],a[160:163],v[152:155]
E v29,v29
M v[152:155],a[84:87],a[164:167],v[152:155]
s_waitcnt lgkmcnt(4)
E v30,v30
M v[156:159],a[92:95],a[164:167],v[156:159]
SA m0,s23,0
T a[144:145],v3,16384
T a[146:147],v3,17408
M v[156:159],a[88:91],a[160:163],v[156:159]
buffer_load_dwordx4 v8, s[16:19], s21 offen offset:0   lds
M v[188:191],a[88:91],a[168:171],v[188:191]
R a[160:163],v5,53248
R a[164:167],v6,53248
M v[188:191],a[92:95],a[172:175],v[188:191]
E v31,v31
M v[184:187],a[84:87],a[172:175],v[184:187]
C v25,v20,v21
M v[184:187],a[80:83],a[168:171],v[184:187]
v_lshlrev_b32 v20, 16, v25
M v[180:183],a[72:75],a[168:171],v[180:183]
v_and_b32 v21, 0xffff0000, v25
M v[180:183],a[76:79],a[172:175],v[180:183]
s_nop 0
T a[148:149],v3,24576
T a[150:151],v3,25600
M v[176:179],a[68:71],a[172:175],v[176:179]
buffer_load_dwordx4 v9, s[16:19], s21 offen offset:1024   lds
M v[176:179],a[64:67],a[168:171],v[176:179]
C v25,v22,v23
M v[172:175],a[56:59],a[168:171],v[172:175]
v_lshlrev_b32 v22, 16, v25
M v[172:175],a[60:63],a[172:175],v[172:175]
v_and_b32 v23, 0xffff0000, v25
M v[168:171],a[52:55],a[172:175],v[168:171]
AF v28,1.0,v28
M v[168:171],a[48:51],a[168:171],v[168:171]
AF v29,1.0,v29
M v[164:167],a[40:43],a[168:171],v[164:167]
s_nop 0
T a[152:153],v4,16384
T a[154:155],v4,17408
M v[164:167],a[44:47],a[172:175],v[164:167]
s_waitcnt lgkmcnt(4)
buffer_load_dwordx4 v10, s[16:19], s21 offen offset:2048   lds
M v[160:163],a[36:39],a[172:175],v[160:163]
AF v30,1.0,v30
M v[160:163],a[32:35],a[168:171],v[160:163]
AF v31,1.0,v31
M v[192:195],a[32:35],a[160:163],v[192:195]
R a[168:171],v5,55296
R a[172:175],v6,55296
M v[192:195],a[36:39],a[164:167],v[192:195]
v_rcp_f32 v28, v28
M v[196:199],a[44:47],a[164:167],v[196:199]
v_rcp_f32 v29, v29
M v[196:199],a[40:43],a[160:163],v[196:199]
T a[156:157],v4,24576
T a[158:159],v4,25600
M v[200:203],a[48:51],a[160:163],v[200:203]
buffer_load_dwordx4 v11, s[16:19], s21 offen offset:3072   lds
M v[200:203],a[52:55],a[164:167],v[200:203]
SA s21,s21,128
v_rcp_f32 v30, v30
M v[204:207],a[60:63],a[164:167],v[204:207]
v_rcp_f32 v31, v31
M v[204:207],a[56:59],a[160:163],v[204:207]
MF v16,v28,v16
M v[208:211],a[64:67],a[160:163],v[208:211]
MF v17,v29,v17
M v[208:211],a[68:71],a[164:167],v[208:211]
MF v18,v30,v18
M v[212:215],a[76:79],a[164:167],v[212:215]
MF v19,v31,v19
M v[212:215],a[72:75],a[160:163],v[212:215]
C v25,v16,v17
M v[216:219],a[80:83],a[160:163],v[216:219]
v_lshlrev_b32 v16, 16, v25
M v[216:219],a[84:87],a[164:167],v[216:219]
s_waitcnt lgkmcnt(2)
v_and_b32 v17, 0xffff0000, v25
M v[220:223],a[92:95],a[164:167],v[220:223]
s_waitcnt vmcnt(22) lgkmcnt(0)
C v25,v18,v19
M v[220:223],a[88:91],a[160:163],v[220:223]
s_barrier
M v[252:255],a[88:91],a[168:171],v[252:255]
R a[160:163],v5,0
R a[164:167],v6,0
M v[252:255],a[92:95],a[172:175],v[252:255]
v_lshlrev_b32 v18, 16, v25
M v[248:251],a[84:87],a[172:175],v[248:251]
v_and_b32 v19, 0xffff0000, v25
M v[248:251],a[80:83],a[168:171],v[248:251]
MF v16,v20,v16
M v[244:247],a[72:75],a[168:171],v[244:247]
MF v17,v21,v17
M v[244:247],a[76:79],a[172:175],v[244:247]
MF v18,v22,v18
M v[240:243],a[68:71],a[172:175],v[240:243]
MF v19,v23,v19
M v[240:243],a[64:67],a[168:171],v[240:243]
C v16,v16,v17
M v[236:239],a[56:59],a[168:171],v[236:239]
C v17,v18,v19
M v[236:239],a[60:63],a[172:175],v[236:239]
M v[232:235],a[52:55],a[172:175],v[232:235]
M v[232:235],a[48:51],a[168:171],v[232:235]
M v[228:231],a[40:43],a[168:171],v[228:231]
M v[228:231],a[44:47],a[172:175],v[228:231]
s_waitcnt lgkmcnt(0)
M v[224:227],a[36:39],a[172:175],v[224:227]
M v[224:227],a[32:35],a[168:171],v[224:227]
M a[0:3],a[96:99],a[160:163],a[0:3]
R a[168:171],v5,2048
R a[172:175],v6,2048
M a[0:3],a[100:103],a[164:167],a[0:3]
T a[32:33],v1,32768
T a[34:35],v1,33792
M a[4:7],a[108:111],a[164:167],a[4:7]
SA m0,s24,49152
v_lshrrev_b32 v28, 4, v0
v_and_b32 v29, 7, v0
M a[4:7],a[104:107],a[160:163],a[4:7]
buffer_load_dwordx4 v12, s[48:51], s22 offen offset:0   lds
M a[8:11],a[112:115],a[160:163],a[8:11]
v_xor_b32 v28, v28, v29
v_lshlrev_b32 v28, 4, v28
M a[8:11],a[116:119],a[164:167],a[8:11]
v_lshrrev_b32 v29, 3, v0
v_mul_u32_u24 v29, 896, v29
M a[12:15],a[124:127],a[164:167],a[12:15]
T a[36:37],v1,40960
T a[38:39],v1,41984
M a[12:15],a[120:123],a[160:163],a[12:15]
v_add_u32 v22, v28, v29
v_xor_b32 v28, 64, v28
M a[16:19],a[128:131],a[160:163],a[16:19]
s_mul_i32 s64, s20, 14336
buffer_load_dwordx4 v13, s[48:51], s22 offen offset:1024   lds
M a[16:19],a[132:135],a[164:167],a[16:19]
s_sub_u32 s65, 98304, s64
M a[20:23],a[140:143],a[164:167],a[20:23]
SA s30,s29,s65
M a[20:23],a[136:139],a[160:163],a[20:23]
SA s29,s29,s64
T a[40:41],v2,32768
T a[42:43],v2,33792
M a[24:27],a[144:147],a[160:163],a[24:27]
v_add_u32 v29, 6144, v29
v_add_u32 v23, v28, v29
M a[24:27],a[148:151],a[164:167],a[24:27]
s_waitcnt lgkmcnt(6)
buffer_load_dwordx4 v14, s[48:51], s22 offen offset:2048   lds
M a[28:31],a[156:159],a[164:167],a[28:31]
s_and_b32 s64, s20, 1
M a[28:31],a[152:155],a[160:163],a[28:31]
s_lshl_b32 s64, s64, 12
M v[60:63],a[152:155],a[168:171],v[60:63]
SA s64,s64,65536
R a[160:163],v5,4096
R a[164:167],v6,4096
M v[60:63],a[156:159],a[172:175],v[60:63]
T a[44:45],v2,40960
T a[46:47],v2,41984
M v[56:59],a[148:151],a[172:175],v[56:59]
buffer_load_dwordx4 v15, s[48:51], s22 offen offset:3072   lds
M v[56:59],a[144:147],a[168:171],v[56:59]
s_sub_u32 s22, s22, 1048448
v_add_u32 v20, s64, v5
v_add_u32 v21, s64, v6
M v[52:55],a[136:139],a[168:171],v[52:55]
v_lshrrev_b32 v28, 2, v0
v_lshlrev_b32 v28, 8, v28
M v[52:55],a[140:143],a[172:175],v[52:55]
T a[48:49],v3,32768
T a[50:51],v3,33792
M v[48:51],a[132:135],a[172:175],v[48:51]
SA m0,s23,16384
v_and_b32 v29, 3, v0
v_lshl_add_u32 v28, v29, 3, v28
M v[48:51],a[128:131],a[168:171],v[48:51]
buffer_load_dwordx4 v8, s[16:19], s21 offen offset:0   lds
M v[44:47],a[120:123],a[168:171],v[44:47]
v_add_u32 v28, s87, v28
M v[44:47],a[124:127],a[172:175],v[44:47]
s_waitcnt vmcnt(23)
s_nop 0
T a[176:177],v28,0
T a[178:179],v28,32
M v[40:43],a[116:119],a[172:175],v[40:43]
T a[52:53],v3,40960
T a[54:55],v3,41984
M v[40:43],a[112:115],a[168:171],v[40:43]
T a[180:181],v28,64
T a[182:183],v28,96
M v[36:39],a[104:107],a[168:171],v[36:39]
buffer_load_dwordx4 v9, s[16:19], s21 offen offset:1024   lds
M v[36:39],a[108:111],a[172:175],v[36:39]
s_waitcnt lgkmcnt(10)
s_nop 0
T a[184:185],v28,128
T a[186:187],v28,160
M v[32:35],a[100:103],a[172:175],v[32:35]
T a[188:189],v28,192
M v[32:35],a[96:99],a[168:171],v[32:35]
s_nop 0
T a[56:57],v4,32768
T a[58:59],v4,33792
M v[64:67],a[96:99],a[160:163],v[64:67]
R a[168:171],v5,6144
R a[172:175],v6,6144
M v[64:67],a[100:103],a[164:167],v[64:67]
buffer_load_dwordx4 v10, s[16:19], s21 offen offset:2048   lds
s_waitcnt lgkmcnt(12)
v_mfma_f32_16x16x16_bf16 a[192:195], a[176:177], v[16:17], 0
M v[68:71],a[108:111],a[164:167],v[68:71]
v_mov_b32 v18, v16 row_shr:2 row_mask:0xf bank_mask:0xf bound_ctrl:0
v_mov_b32 v19, v17 row_shr:2 row_mask:0xf bank_mask:0xf bound_ctrl:0
M v[68:71],a[104:107],a[160:163],v[68:71]
M v[72:75],a[112:115],a[160:163],v[72:75]
s_nop 0
T a[60:61],v4,40960
T a[62:63],v4,41984
M v[72:75],a[116:119],a[164:167],v[72:75]
s_waitcnt lgkmcnt(13)
v_mfma_f32_16x16x16_bf16 a[192:195], a[178:179], v[18:19], a[192:195]
M v[76:79],a[124:127],a[164:167],v[76:79]
buffer_load_dwordx4 v11, s[16:19], s21 offen offset:3072   lds
M v[76:79],a[120:123],a[160:163],v[76:79]
SA s21,s21,524160
v_mov_b32 v16, v18 row_shr:2 row_mask:0xf bank_mask:0xf bound_ctrl:0
v_mov_b32 v17, v19 row_shr:2 row_mask:0xf bank_mask:0xf bound_ctrl:0
M v[80:83],a[128:131],a[160:163],v[80:83]
M v[80:83],a[132:135],a[164:167],v[80:83]
s_waitcnt lgkmcnt(10)
v_mfma_f32_16x16x16_bf16 a[192:195], a[180:181], v[16:17], a[192:195]
M v[84:87],a[140:143],a[164:167],v[84:87]
v_mov_b32 v18, v16 row_shr:2 row_mask:0xf bank_mask:0xf bound_ctrl:0
v_mov_b32 v19, v17 row_shr:2 row_mask:0xf bank_mask:0xf bound_ctrl:0
M v[84:87],a[136:139],a[160:163],v[84:87]
M v[88:91],a[144:147],a[160:163],v[88:91]
M v[88:91],a[148:151],a[164:167],v[88:91]
s_waitcnt lgkmcnt(2)
v_mfma_f32_16x16x16_bf16 a[192:195], a[182:183], v[18:19], a[192:195]
M v[92:95],a[156:159],a[164:167],v[92:95]
s_waitcnt vmcnt(16) lgkmcnt(0)
v_mov_b32 v16, v18 row_shr:2 row_mask:0xf bank_mask:0xf bound_ctrl:0
v_mov_b32 v17, v19 row_shr:2 row_mask:0xf bank_mask:0xf bound_ctrl:0
M v[92:95],a[152:155],a[160:163],v[92:95]
s_barrier
M v[124:127],a[152:155],a[168:171],v[124:127]
R a[160:163],v5,16384
R a[164:167],v6,16384
M v[124:127],a[156:159],a[172:175],v[124:127]
SA m0,s23,131072
v_mfma_f32_16x16x16_bf16 a[192:195], a[184:185], v[16:17], a[192:195]
M v[120:123],a[148:151],a[172:175],v[120:123]
s_nop 0
T a[64:65],v1,49152
T a[66:67],v1,50176
M v[120:123],a[144:147],a[168:171],v[120:123]
v_mov_b32 v18, v16 row_shr:2 row_mask:0xf bank_mask:0xf bound_ctrl:0
v_mov_b32 v19, v17 row_shr:2 row_mask:0xf bank_mask:0xf bound_ctrl:0
M v[116:119],a[136:139],a[168:171],v[116:119]
buffer_load_dwordx4 v22, s[56:59], s29 offen offset:0 lds
M v[116:119],a[140:143],a[172:175],v[116:119]
v_mfma_f32_16x16x16_bf16 a[192:195], a[186:187], v[18:19], a[192:195]
M v[112:115],a[132:135],a[172:175],v[112:115]
v_mov_b32 v16, v18 row_shr:2 row_mask:0xf bank_mask:0xf bound_ctrl:0
v_mov_b32 v17, v19 row_shr:2 row_mask:0xf bank_mask:0xf bound_ctrl:0
M v[112:115],a[128:131],a[168:171],v[112:115]
buffer_load_dwordx4 v23, s[56:59], s29 offen offset:1024 lds
M v[108:111],a[120:123],a[168:171],v[108:111]
M v[108:111],a[124:127],a[172:175],v[108:111]
s_nop 0
T a[68:69],v1,57344
T a[70:71],v1,58368
v_mfma_f32_16x16x16_bf16 a[192:195], a[188:189], v[16:17], a[192:195]
M v[104:107],a[116:119],a[172:175],v[104:107]
buffer_load_dwordx4 v22, s[56:59], s30 offen offset:2048 lds
M v[104:107],a[112:115],a[168:171],v[104:107]
v_and_b32 v29, 1, v0
v_mul_u32_u24 v30, 1792, v29
M v[100:103],a[104:107],a[168:171],v[100:103]
v_lshrrev_b32 v31, 4, v0
v_lshl_add_u32 v30, v31, 4, v30
M v[100:103],a[108:111],a[172:175],v[100:103]
s_waitcnt lgkmcnt(4)
v_bfe_u32 v29, v0, 1, 3
v_lshl_add_u32 v30, v29, 6, v30
M v[96:99],a[100:103],a[172:175],v[96:99]
v_add_u32 v29, 1, v29
v_lshrrev_b32 v29, 3, v29
M v[96:99],a[96:99],a[168:171],v[96:99]
v_lshl_or_b32 v30, v29, 29, v30
v_or_b32 v30, s88, v30
M v[128:131],a[96:99],a[160:163],v[128:131]
s_mul_i32 s89, s86, 3584
R a[168:171],v5,18432
R a[172:175],v6,18432
M v[128:131],a[100:103],a[164:167],v[128:131]
s_mul_i32 s64, s20, 448
T a[72:73],v2,49152
T a[74:75],v2,50176
M v[132:135],a[108:111],a[164:167],v[132:135]
SA s89,s89,s64
M v[132:135],a[104:107],a[160:163],v[132:135]
SA s89,s89,105906176
buffer_store_dwordx4 a[192:195], v30, s[8:11], s89 offen sc1
M v[136:139],a[112:115],a[160:163],v[136:139]
M v[136:139],a[116:119],a[164:167],v[136:139]
M v[140:143],a[124:127],a[164:167],v[140:143]
buffer_load_dwordx4 v23, s[56:59], s30 offen offset:3072 lds
M v[140:143],a[120:123],a[160:163],v[140:143]
SA s29,s29,128
T a[76:77],v2,57344
T a[78:79],v2,58368
M v[144:147],a[128:131],a[160:163],v[144:147]
SA s30,s30,128
M v[144:147],a[132:135],a[164:167],v[144:147]
SA m0,s24,0
M v[148:151],a[140:143],a[164:167],v[148:151]
buffer_load_dwordx4 v12, s[48:51], s22 offen offset:0   lds
M v[148:151],a[136:139],a[160:163],v[148:151]
M v[152:155],a[144:147],a[160:163],v[152:155]
M v[152:155],a[148:151],a[164:167],v[152:155]
s_waitcnt lgkmcnt(4)
buffer_load_dwordx4 v13, s[48:51], s22 offen offset:1024   lds
M v[156:159],a[156:159],a[164:167],v[156:159]
s_nop 0
T a[80:81],v3,49152
T a[82:83],v3,50176
M v[156:159],a[152:155],a[160:163],v[156:159]
M v[188:191],a[152:155],a[168:171],v[188:191]
R a[160:163],v5,20480
R a[164:167],v6,20480
M v[188:191],a[156:159],a[172:175],v[188:191]
buffer_load_dwordx4 v14, s[48:51], s22 offen offset:2048   lds
M v[184:187],a[148:151],a[172:175],v[184:187]
M v[184:187],a[144:147],a[168:171],v[184:187]
M v[180:183],a[136:139],a[168:171],v[180:183]
buffer_load_dwordx4 v15, s[48:51], s22 offen offset:3072   lds
M v[180:183],a[140:143],a[172:175],v[180:183]
SA s22,s22,1048576
T a[84:85],v3,57344
T a[86:87],v3,58368
M v[176:179],a[132:135],a[172:175],v[176:179]
SA m0,s23,32768
M v[176:179],a[128:131],a[168:171],v[176:179]
buffer_load_dwordx4 v8, s[16:19], s21 offen offset:0   lds
M v[172:175],a[120:123],a[168:171],v[172:175]
M v[172:175],a[124:127],a[172:175],v[172:175]
M v[168:171],a[116:119],a[172:175],v[168:171]
M v[168:171],a[112:115],a[168:171],v[168:171]
L_w_kv06:
s_cbranch_execz L_wd1
buffer_load_dwordx4 v9, s[16:19], s21 offen offset:1024   lds
M v[164:167],a[104:107],a[168:171],v[164:167]
s_nop 0
T a[88:89],v4,49152
T a[90:91],v4,50176
M v[164:167],a[108:111],a[172:175],v[164:167]
s_waitcnt lgkmcnt(4)
M v[160:163],a[100:103],a[172:175],v[160:163]
M v[160:163],a[96:99],a[168:171],v[160:163]
M v[192:195],a[96:99],a[160:163],v[192:195]
R a[168:171],v5,22528
R a[172:175],v6,22528
M v[192:195],a[100:103],a[164:167],v[192:195]
buffer_load_dwordx4 v10, s[16:19], s21 offen offset:2048   lds
M v[196:199],a[108:111],a[164:167],v[196:199]
M v[196:199],a[104:107],a[160:163],v[196:199]
s_nop 0
T a[92:93],v4,57344
T a[94:95],v4,58368
M v[200:203],a[112:115],a[160:163],v[200:203]
M v[200:203],a[116:119],a[164:167],v[200:203]
buffer_load_dwordx4 v11, s[16:19], s21 offen offset:3072   lds
M v[204:207],a[124:127],a[164:167],v[204:207]
M v[204:207],a[120:123],a[160:163],v[204:207]
M v[208:211],a[128:131],a[160:163],v[208:211]
M v[208:211],a[132:135],a[164:167],v[208:211]
M v[212:215],a[140:143],a[164:167],v[212:215]
SA s21,s21,128
M v[212:215],a[136:139],a[160:163],v[212:215]
M v[216:219],a[144:147],a[160:163],v[216:219]
M v[216:219],a[148:151],a[164:167],v[216:219]
s_waitcnt lgkmcnt(2)
M v[220:223],a[156:159],a[164:167],v[220:223]
s_waitcnt vmcnt(21) lgkmcnt(0)
M v[220:223],a[152:155],a[160:163],v[220:223]
s_barrier
M v[252:255],a[152:155],a[168:171],v[252:255]
R a[160:163],v5,32768
R a[164:167],v6,32768
M v[252:255],a[156:159],a[172:175],v[252:255]
M v[248:251],a[148:151],a[172:175],v[248:251]
M v[248:251],a[144:147],a[168:171],v[248:251]
M v[244:247],a[136:139],a[168:171],v[244:247]
M v[244:247],a[140:143],a[172:175],v[244:247]
M v[240:243],a[132:135],a[172:175],v[240:243]
M v[240:243],a[128:131],a[168:171],v[240:243]
M v[236:239],a[120:123],a[168:171],v[236:239]
M v[236:239],a[124:127],a[172:175],v[236:239]
M v[232:235],a[116:119],a[172:175],v[232:235]
M v[232:235],a[112:115],a[168:171],v[232:235]
M v[228:231],a[104:107],a[168:171],v[228:231]
M v[228:231],a[108:111],a[172:175],v[228:231]
s_waitcnt lgkmcnt(0)
M v[224:227],a[100:103],a[172:175],v[224:227]
M v[224:227],a[96:99],a[168:171],v[224:227]
M a[0:3],a[32:35],a[160:163],a[0:3]
R a[168:171],v5,34816
R a[172:175],v6,34816
M a[0:3],a[36:39],a[164:167],a[0:3]
SA m0,s23,147456
T a[96:97],v1,0
T a[98:99],v1,1024
M a[4:7],a[44:47],a[164:167],a[4:7]
buffer_load_dwordx4 v22, s[56:59], s29 offen offset:0 lds
M a[4:7],a[40:43],a[160:163],a[4:7]
M a[8:11],a[48:51],a[160:163],a[8:11]
M a[8:11],a[52:55],a[164:167],a[8:11]
buffer_load_dwordx4 v23, s[56:59], s29 offen offset:1024 lds
M a[12:15],a[60:63],a[164:167],a[12:15]
s_nop 0
T a[100:101],v1,8192
T a[102:103],v1,9216
M a[12:15],a[56:59],a[160:163],a[12:15]
M a[16:19],a[64:67],a[160:163],a[16:19]
buffer_load_dwordx4 v22, s[56:59], s30 offen offset:2048 lds
M a[16:19],a[68:71],a[164:167],a[16:19]
M a[20:23],a[76:79],a[164:167],a[20:23]
M a[20:23],a[72:75],a[160:163],a[20:23]
s_nop 0
T a[104:105],v2,0
T a[106:107],v2,1024
M a[24:27],a[80:83],a[160:163],a[24:27]
buffer_load_dwordx4 v23, s[56:59], s30 offen offset:3072 lds
M a[24:27],a[84:87],a[164:167],a[24:27]
s_waitcnt lgkmcnt(6)
M a[28:31],a[92:95],a[164:167],a[28:31]
SA s29,s29,128
M a[28:31],a[88:91],a[160:163],a[28:31]
SA s30,s30,128
M v[60:63],a[88:91],a[168:171],v[60:63]
SA m0,s24,16384
R a[160:163],v5,36864
R a[164:167],v6,36864
M v[60:63],a[92:95],a[172:175],v[60:63]
T a[108:109],v2,8192
T a[110:111],v2,9216
M v[56:59],a[84:87],a[172:175],v[56:59]
buffer_load_dwordx4 v12, s[48:51], s22 offen offset:0   lds
M v[56:59],a[80:83],a[168:171],v[56:59]
M v[52:55],a[72:75],a[168:171],v[52:55]
M v[52:55],a[76:79],a[172:175],v[52:55]
s_nop 0
T a[112:113],v3,0
T a[114:115],v3,1024
M v[48:51],a[68:71],a[172:175],v[48:51]
buffer_load_dwordx4 v13, s[48:51], s22 offen offset:1024   lds
M v[48:51],a[64:67],a[168:171],v[48:51]
M v[44:47],a[56:59],a[168:171],v[44:47]
M v[44:47],a[60:63],a[172:175],v[44:47]
buffer_load_dwordx4 v14, s[48:51], s22 offen offset:2048   lds
M v[40:43],a[52:55],a[172:175],v[40:43]
s_nop 0
T a[116:117],v3,8192
T a[118:119],v3,9216
M v[40:43],a[48:51],a[168:171],v[40:43]
M v[36:39],a[40:43],a[168:171],v[36:39]
buffer_load_dwordx4 v15, s[48:51], s22 offen offset:3072   lds
M v[36:39],a[44:47],a[172:175],v[36:39]
s_waitcnt lgkmcnt(6)
M v[32:35],a[36:39],a[172:175],v[32:35]
s_sub_u32 s22, s22, 1048448
M v[32:35],a[32:35],a[168:171],v[32:35]
SA m0,s23,49152
T a[120:121],v4,0
T a[122:123],v4,1024
M v[64:67],a[32:35],a[160:163],v[64:67]
R a[168:171],v5,38912
R a[172:175],v6,38912
M v[64:67],a[36:39],a[164:167],v[64:67]
buffer_load_dwordx4 v8, s[16:19], s21 offen offset:0   lds
M v[68:71],a[44:47],a[164:167],v[68:71]
M v[68:71],a[40:43],a[160:163],v[68:71]
M v[72:75],a[48:51],a[160:163],v[72:75]
s_waitcnt vmcnt(17)
s_nop 0
T a[124:125],v4,8192
T a[126:127],v4,9216
M v[72:75],a[52:55],a[164:167],v[72:75]
buffer_load_dwordx4 v9, s[16:19], s21 offen offset:1024   lds
M v[76:79],a[60:63],a[164:167],v[76:79]
R a[176:179],v20,0
R a[180:183],v20,2048
M v[76:79],a[56:59],a[160:163],v[76:79]
R a[184:187],v21,0
R a[188:191],v21,2048
M v[80:83],a[64:67],a[160:163],v[80:83]
buffer_load_dwordx4 v10, s[16:19], s21 offen offset:2048   lds
M v[80:83],a[68:71],a[164:167],v[80:83]
M v[84:87],a[76:79],a[164:167],v[84:87]
M v[84:87],a[72:75],a[160:163],v[84:87]
buffer_load_dwordx4 v11, s[16:19], s21 offen offset:3072   lds
M v[88:91],a[80:83],a[160:163],v[88:91]
SA s21,s21,524160
M v[88:91],a[84:87],a[164:167],v[88:91]
s_waitcnt lgkmcnt(6)
M v[92:95],a[92:95],a[164:167],v[92:95]
s_waitcnt lgkmcnt(0)
M v[92:95],a[88:91],a[160:163],v[92:95]
s_barrier
M v[124:127],a[88:91],a[168:171],v[124:127]
s_lshl_b32 s4, s20, 10
R a[160:163],v5,49152
R a[164:167],v6,49152
M v[124:127],a[92:95],a[172:175],v[124:127]
SA m0,s23,131072
v_bfe_u32 v28, v0, 3, 2
M v[120:123],a[84:87],a[172:175],v[120:123]
s_nop 0
T a[128:129],v1,16384
T a[130:131],v1,17408
M v[120:123],a[80:83],a[168:171],v[120:123]
buffer_load_dwordx4 v22, s[56:59], s29 offen offset:0 lds
M v[116:119],a[72:75],a[168:171],v[116:119]
v_lshrrev_b32 v29, 5, v0
v_lshl_add_u32 v28, v29, 3, v28
M v[116:119],a[76:79],a[172:175],v[116:119]
M v[112:115],a[68:71],a[172:175],v[112:115]
v_lshlrev_b32 v28, 13, v28
M v[112:115],a[64:67],a[168:171],v[112:115]
M v[108:111],a[56:59],a[168:171],v[108:111]
buffer_load_dwordx4 v23, s[56:59], s29 offen offset:1024 lds
M v[108:111],a[60:63],a[172:175],v[108:111]
s_nop 0
T a[132:133],v1,24576
T a[134:135],v1,25600
M v[104:107],a[52:55],a[172:175],v[104:107]
v_lshrrev_b32 v29, 4, v0
v_lshlrev_b32 v29, 1, v29
M v[104:107],a[48:51],a[168:171],v[104:107]
M v[100:103],a[40:43],a[168:171],v[100:103]
v_and_b32 v30, 7, v0
M v[100:103],a[44:47],a[172:175],v[100:103]
s_waitcnt lgkmcnt(4)
M v[96:99],a[36:39],a[172:175],v[96:99]
v_xor_b32 v29, v29, v30
M v[96:99],a[32:35],a[168:171],v[96:99]
buffer_load_dwordx4 v22, s[56:59], s30 offen offset:2048 lds
M v[128:131],a[32:35],a[160:163],v[128:131]
R a[168:171],v5,51200
R a[172:175],v6,51200
M v[128:131],a[36:39],a[164:167],v[128:131]
T a[136:137],v2,16384
T a[138:139],v2,17408
M v[132:135],a[44:47],a[164:167],v[132:135]
v_lshl_add_u32 v28, v29, 4, v28
M v[132:135],a[40:43],a[160:163],v[132:135]
s_and_b32 s64, s20, 1
M v[136:139],a[48:51],a[160:163],v[136:139]
s_lshl_b32 s64, s64, 17
M v[136:139],a[52:55],a[164:167],v[136:139]
s_lshr_b32 s65, s20, 1
M v[140:143],a[60:63],a[164:167],v[140:143]
s_lshl_b32 s65, s65, 15
SA s64,s64,s65
v_add_u32 v8, s64, v28
M v[140:143],a[56:59],a[160:163],v[140:143]
s_nop 0
T a[140:141],v2,24576
T a[142:143],v2,25600
M v[144:147],a[64:67],a[160:163],v[144:147]
buffer_load_dwordx4 v23, s[56:59], s30 offen offset:3072 lds
M v[144:147],a[68:71],a[164:167],v[144:147]
M v[148:151],a[76:79],a[164:167],v[148:151]
SA s29,s29,128
M v[148:151],a[72:75],a[160:163],v[148:151]
SA s30,s30,128
M v[152:155],a[80:83],a[160:163],v[152:155]
SA m0,s24,32768
M v[152:155],a[84:87],a[164:167],v[152:155]
s_waitcnt lgkmcnt(4)
buffer_load_dwordx4 v12, s[48:51], s22 offen offset:0   lds
M v[156:159],a[92:95],a[164:167],v[156:159]
s_nop 0
T a[144:145],v3,16384
T a[146:147],v3,17408
M v[156:159],a[88:91],a[160:163],v[156:159]
M v[188:191],a[88:91],a[168:171],v[188:191]
R a[160:163],v5,53248
R a[164:167],v6,53248
M v[188:191],a[92:95],a[172:175],v[188:191]
M v[184:187],a[84:87],a[172:175],v[184:187]
M v[184:187],a[80:83],a[168:171],v[184:187]
M v[180:183],a[72:75],a[168:171],v[180:183]
buffer_load_dwordx4 v13, s[48:51], s22 offen offset:1024   lds
M v[180:183],a[76:79],a[172:175],v[180:183]
s_nop 0
T a[148:149],v3,24576
T a[150:151],v3,25600
M v[176:179],a[68:71],a[172:175],v[176:179]
M v[176:179],a[64:67],a[168:171],v[176:179]
M v[172:175],a[56:59],a[168:171],v[172:175]
M v[172:175],a[60:63],a[172:175],v[172:175]
M v[168:171],a[52:55],a[172:175],v[168:171]
M v[168:171],a[48:51],a[168:171],v[168:171]
buffer_load_dwordx4 v14, s[48:51], s22 offen offset:2048   lds
M v[164:167],a[40:43],a[168:171],v[164:167]
s_nop 0
T a[152:153],v4,16384
T a[154:155],v4,17408
M v[164:167],a[44:47],a[172:175],v[164:167]
s_waitcnt lgkmcnt(4)
M v[160:163],a[36:39],a[172:175],v[160:163]
M v[160:163],a[32:35],a[168:171],v[160:163]
M v[192:195],a[32:35],a[160:163],v[192:195]
R a[168:171],v5,55296
R a[172:175],v6,55296
M v[192:195],a[36:39],a[164:167],v[192:195]
M v[196:199],a[44:47],a[164:167],v[196:199]
buffer_load_dwordx4 v15, s[48:51], s22 offen offset:3072   lds
M v[196:199],a[40:43],a[160:163],v[196:199]
s_nop 0
T a[156:157],v4,24576
T a[158:159],v4,25600
M v[200:203],a[48:51],a[160:163],v[200:203]
s_waitcnt vmcnt(16)
R a[192:195],v20,16384
R a[196:199],v20,18432
M v[200:203],a[52:55],a[164:167],v[200:203]
R a[200:203],v21,16384
R a[204:207],v21,18432
M v[204:207],a[60:63],a[164:167],v[204:207]
M v[204:207],a[56:59],a[160:163],v[204:207]
M v[208:211],a[64:67],a[160:163],v[208:211]
M v[208:211],a[68:71],a[164:167],v[208:211]
M v[212:215],a[76:79],a[164:167],v[212:215]
SA s22,s22,1048576
M v[212:215],a[72:75],a[160:163],v[212:215]
M v[216:219],a[80:83],a[160:163],v[216:219]
M v[216:219],a[84:87],a[164:167],v[216:219]
s_waitcnt lgkmcnt(6)
M v[220:223],a[92:95],a[164:167],v[220:223]
s_waitcnt lgkmcnt(0)
M v[220:223],a[88:91],a[160:163],v[220:223]
s_barrier
M v[252:255],a[88:91],a[168:171],v[252:255]
R a[160:163],v5,0
R a[164:167],v6,0
M v[252:255],a[92:95],a[172:175],v[252:255]
M v[248:251],a[84:87],a[172:175],v[248:251]
M v[248:251],a[80:83],a[168:171],v[248:251]
M v[244:247],a[72:75],a[168:171],v[244:247]
M v[244:247],a[76:79],a[172:175],v[244:247]
M v[240:243],a[68:71],a[172:175],v[240:243]
M v[240:243],a[64:67],a[168:171],v[240:243]
M v[236:239],a[56:59],a[168:171],v[236:239]
M v[236:239],a[60:63],a[172:175],v[236:239]
M v[232:235],a[52:55],a[172:175],v[232:235]
M v[232:235],a[48:51],a[168:171],v[232:235]
M v[228:231],a[40:43],a[168:171],v[228:231]
M v[228:231],a[44:47],a[172:175],v[228:231]
s_waitcnt lgkmcnt(0)
M v[224:227],a[36:39],a[172:175],v[224:227]
M v[224:227],a[32:35],a[168:171],v[224:227]
M a[0:3],a[96:99],a[160:163],a[0:3]
R a[168:171],v5,2048
R a[172:175],v6,2048
M a[0:3],a[100:103],a[164:167],a[0:3]
SA m0,s23,147456
T a[32:33],v1,32768
T a[34:35],v1,33792
M a[4:7],a[108:111],a[164:167],a[4:7]
buffer_load_dwordx4 v22, s[56:59], s29 offen offset:0 lds
M a[4:7],a[104:107],a[160:163],a[4:7]
M a[8:11],a[112:115],a[160:163],a[8:11]
M a[8:11],a[116:119],a[164:167],a[8:11]
buffer_load_dwordx4 v23, s[56:59], s29 offen offset:1024 lds
M a[12:15],a[124:127],a[164:167],a[12:15]
s_nop 0
T a[36:37],v1,40960
T a[38:39],v1,41984
M a[12:15],a[120:123],a[160:163],a[12:15]
M a[16:19],a[128:131],a[160:163],a[16:19]
buffer_load_dwordx4 v22, s[56:59], s30 offen offset:2048 lds
M a[16:19],a[132:135],a[164:167],a[16:19]
M a[20:23],a[140:143],a[164:167],a[20:23]
M a[20:23],a[136:139],a[160:163],a[20:23]
s_nop 0
T a[40:41],v2,32768
T a[42:43],v2,33792
M a[24:27],a[144:147],a[160:163],a[24:27]
buffer_load_dwordx4 v23, s[56:59], s30 offen offset:3072 lds
M a[24:27],a[148:151],a[164:167],a[24:27]
s_waitcnt lgkmcnt(6)
M a[28:31],a[156:159],a[164:167],a[28:31]
SA s29,s29,128
M a[28:31],a[152:155],a[160:163],a[28:31]
SA s30,s30,128
M v[60:63],a[152:155],a[168:171],v[60:63]
SA m0,s24,49152
R a[160:163],v5,4096
R a[164:167],v6,4096
M v[60:63],a[156:159],a[172:175],v[60:63]
T a[44:45],v2,40960
T a[46:47],v2,41984
M v[56:59],a[148:151],a[172:175],v[56:59]
buffer_load_dwordx4 v12, s[48:51], s22 offen offset:0   lds
M v[56:59],a[144:147],a[168:171],v[56:59]
M v[52:55],a[136:139],a[168:171],v[52:55]
M v[52:55],a[140:143],a[172:175],v[52:55]
s_nop 0
T a[48:49],v3,32768
T a[50:51],v3,33792
M v[48:51],a[132:135],a[172:175],v[48:51]
buffer_load_dwordx4 v13, s[48:51], s22 offen offset:1024   lds
M v[48:51],a[128:131],a[168:171],v[48:51]
M v[44:47],a[120:123],a[168:171],v[44:47]
M v[44:47],a[124:127],a[172:175],v[44:47]
buffer_load_dwordx4 v14, s[48:51], s22 offen offset:2048   lds
M v[40:43],a[116:119],a[172:175],v[40:43]
s_nop 0
T a[52:53],v3,40960
T a[54:55],v3,41984
M v[40:43],a[112:115],a[168:171],v[40:43]
M v[36:39],a[104:107],a[168:171],v[36:39]
buffer_load_dwordx4 v15, s[48:51], s22 offen offset:3072   lds
M v[36:39],a[108:111],a[172:175],v[36:39]
s_waitcnt lgkmcnt(6)
M v[32:35],a[100:103],a[172:175],v[32:35]
s_sub_u32 s22, s22, 1048448
M v[32:35],a[96:99],a[168:171],v[32:35]
s_mov_b32 s25, 0
T a[56:57],v4,32768
T a[58:59],v4,33792
M v[64:67],a[96:99],a[160:163],v[64:67]
SA m0,s4,0
R a[168:171],v5,6144
R a[172:175],v6,6144
M v[64:67],a[100:103],a[164:167],v[64:67]
buffer_load_dwordx4 v8, s[52:55], s25 offen lds
M v[68:71],a[108:111],a[164:167],v[68:71]
s_mov_b32 s25, 262144
M v[68:71],a[104:107],a[160:163],v[68:71]
SA m0,s4,4096
M v[72:75],a[112:115],a[160:163],v[72:75]
s_waitcnt vmcnt(13)
s_nop 0
T a[60:61],v4,40960
T a[62:63],v4,41984
M v[72:75],a[116:119],a[164:167],v[72:75]
buffer_load_dwordx4 v8, s[52:55], s25 offen lds
M v[76:79],a[124:127],a[164:167],v[76:79]
s_mov_b32 s25, 524288
R a[208:211],v20,0
R a[212:215],v20,2048
M v[76:79],a[120:123],a[160:163],v[76:79]
SA m0,s4,8192
R a[216:219],v21,0
R a[220:223],v21,2048
M v[80:83],a[128:131],a[160:163],v[80:83]
buffer_load_dwordx4 v8, s[52:55], s25 offen lds
M v[80:83],a[132:135],a[164:167],v[80:83]
s_mov_b32 s25, 786432
M v[84:87],a[140:143],a[164:167],v[84:87]
SA m0,s4,12288
M v[84:87],a[136:139],a[160:163],v[84:87]
buffer_load_dwordx4 v8, s[52:55], s25 offen lds
M v[88:91],a[144:147],a[160:163],v[88:91]
M v[88:91],a[148:151],a[164:167],v[88:91]
s_waitcnt lgkmcnt(6)
M v[92:95],a[156:159],a[164:167],v[92:95]
s_waitcnt lgkmcnt(0)
M v[92:95],a[152:155],a[160:163],v[92:95]
s_barrier
M v[124:127],a[152:155],a[168:171],v[124:127]
R a[160:163],v5,16384
R a[164:167],v6,16384
M v[124:127],a[156:159],a[172:175],v[124:127]
SA m0,s23,32768
M v[120:123],a[148:151],a[172:175],v[120:123]
s_nop 0
T a[64:65],v1,49152
T a[66:67],v1,50176
M v[120:123],a[144:147],a[168:171],v[120:123]
buffer_load_dwordx4 v22, s[56:59], s29 offen offset:0 lds
M v[116:119],a[136:139],a[168:171],v[116:119]
v_lshrrev_b32 v28, 2, v0
v_lshlrev_b32 v28, 7, v28
M v[116:119],a[140:143],a[172:175],v[116:119]
M v[112:115],a[132:135],a[172:175],v[112:115]
buffer_load_dwordx4 v23, s[56:59], s29 offen offset:1024 lds
M v[112:115],a[128:131],a[168:171],v[112:115]
v_and_b32 v29, 3, v0
M v[108:111],a[120:123],a[168:171],v[108:111]
v_lshl_add_u32 v28, v29, 3, v28
M v[108:111],a[124:127],a[172:175],v[108:111]
s_nop 0
T a[68:69],v1,57344
T a[70:71],v1,58368
M v[104:107],a[116:119],a[172:175],v[104:107]
buffer_load_dwordx4 v22, s[56:59], s30 offen offset:2048 lds
M v[104:107],a[112:115],a[168:171],v[104:107]
v_bfe_u32 v29, v0, 3, 2
M v[100:103],a[104:107],a[168:171],v[100:103]
M v[100:103],a[108:111],a[172:175],v[100:103]
s_waitcnt lgkmcnt(4)
v_lshl_add_u32 v16, v29, 5, v28
M v[96:99],a[100:103],a[172:175],v[96:99]
M v[96:99],a[96:99],a[168:171],v[96:99]
buffer_load_dwordx4 v23, s[56:59], s30 offen offset:3072 lds
M v[128:131],a[96:99],a[160:163],v[128:131]
R a[168:171],v5,18432
R a[172:175],v6,18432
M v[128:131],a[100:103],a[164:167],v[128:131]
SA s29,s29,128
T a[72:73],v2,49152
T a[74:75],v2,50176
M v[132:135],a[108:111],a[164:167],v[132:135]
SA s30,s30,128
v_xor_b32 v17, 32, v16
v_xor_b32 v18, 64, v16
M v[132:135],a[104:107],a[160:163],v[132:135]
SA m0,s23,65536
M v[136:139],a[112:115],a[160:163],v[136:139]
buffer_load_dwordx4 v22, s[56:59], s29 offen offset:0 lds
M v[136:139],a[116:119],a[164:167],v[136:139]
v_xor_b32 v19, 0x60, v16
M v[140:143],a[124:127],a[164:167],v[140:143]
v_add_u32 v12, 0x20000, v16
M v[140:143],a[120:123],a[160:163],v[140:143]
s_nop 0
T a[76:77],v2,57344
T a[78:79],v2,58368
M v[144:147],a[128:131],a[160:163],v[144:147]
buffer_load_dwordx4 v23, s[56:59], s29 offen offset:1024 lds
M v[144:147],a[132:135],a[164:167],v[144:147]
v_add_u32 v13, 0x20000, v17
M v[148:151],a[140:143],a[164:167],v[148:151]
M v[148:151],a[136:139],a[160:163],v[148:151]
v_add_u32 v14, 0x20000, v18
M v[152:155],a[144:147],a[160:163],v[152:155]
M v[152:155],a[148:151],a[164:167],v[152:155]
s_waitcnt lgkmcnt(4)
buffer_load_dwordx4 v22, s[56:59], s30 offen offset:2048 lds
M v[156:159],a[156:159],a[164:167],v[156:159]
s_nop 0
T a[80:81],v3,49152
T a[82:83],v3,50176
M v[156:159],a[152:155],a[160:163],v[156:159]
v_add_u32 v15, 0x20000, v19
M v[188:191],a[152:155],a[168:171],v[188:191]
R a[160:163],v5,20480
R a[164:167],v6,20480
M v[188:191],a[156:159],a[172:175],v[188:191]
M v[184:187],a[148:151],a[172:175],v[184:187]
buffer_load_dwordx4 v23, s[56:59], s30 offen offset:3072 lds
M v[184:187],a[144:147],a[168:171],v[184:187]
SA s29,s29,128
M v[180:183],a[136:139],a[168:171],v[180:183]
SA s30,s30,128
M v[180:183],a[140:143],a[172:175],v[180:183]
s_mov_b32 s25, 1048576
T a[84:85],v3,57344
T a[86:87],v3,58368
M v[176:179],a[132:135],a[172:175],v[176:179]
SA m0,s4,16384
M v[176:179],a[128:131],a[168:171],v[176:179]
buffer_load_dwordx4 v8, s[52:55], s25 offen lds
M v[172:175],a[120:123],a[168:171],v[172:175]
M v[172:175],a[124:127],a[172:175],v[172:175]
s_mov_b32 s25, 1310720
M v[168:171],a[116:119],a[172:175],v[168:171]
SA m0,s4,20480
M v[168:171],a[112:115],a[168:171],v[168:171]
buffer_load_dwordx4 v8, s[52:55], s25 offen lds
M v[164:167],a[104:107],a[168:171],v[164:167]
s_nop 0
T a[88:89],v4,49152
T a[90:91],v4,50176
M v[164:167],a[108:111],a[172:175],v[164:167]
s_waitcnt lgkmcnt(4)
M v[160:163],a[100:103],a[172:175],v[160:163]
s_mov_b32 s25, 1572864
M v[160:163],a[96:99],a[168:171],v[160:163]
SA m0,s4,24576
M v[192:195],a[96:99],a[160:163],v[192:195]
R a[168:171],v5,22528
R a[172:175],v6,22528
M v[192:195],a[100:103],a[164:167],v[192:195]
buffer_load_dwordx4 v8, s[52:55], s25 offen lds
M v[196:199],a[108:111],a[164:167],v[196:199]
M v[196:199],a[104:107],a[160:163],v[196:199]
s_mov_b32 s25, 1835008
T a[92:93],v4,57344
T a[94:95],v4,58368
M v[200:203],a[112:115],a[160:163],v[200:203]
SA m0,s4,28672
M v[200:203],a[116:119],a[164:167],v[200:203]
s_waitcnt vmcnt(19)
L_w_kv07:
s_cbranch_execz L_wd1
buffer_load_dwordx4 v8, s[52:55], s25 offen lds
M v[204:207],a[124:127],a[164:167],v[204:207]
R a[224:227],v20,16384
R a[228:231],v20,18432
M v[204:207],a[120:123],a[160:163],v[204:207]
R a[232:235],v21,16384
R a[236:239],v21,18432
M v[208:211],a[128:131],a[160:163],v[208:211]
v_subrev_u32 v20, 98304, v20
v_subrev_u32 v21, 98304, v21
M v[208:211],a[132:135],a[164:167],v[208:211]
M v[212:215],a[140:143],a[164:167],v[212:215]
M v[212:215],a[136:139],a[160:163],v[212:215]
M v[216:219],a[144:147],a[160:163],v[216:219]
M v[216:219],a[148:151],a[164:167],v[216:219]
s_waitcnt lgkmcnt(6)
M v[220:223],a[156:159],a[164:167],v[220:223]
s_waitcnt lgkmcnt(0)
M v[220:223],a[152:155],a[160:163],v[220:223]
s_barrier
M v[252:255],a[152:155],a[168:171],v[252:255]
R a[160:163],v5,32768
R a[164:167],v6,32768
M v[252:255],a[156:159],a[172:175],v[252:255]
M v[248:251],a[148:151],a[172:175],v[248:251]
M v[248:251],a[144:147],a[168:171],v[248:251]
M v[244:247],a[136:139],a[168:171],v[244:247]
M v[244:247],a[140:143],a[172:175],v[244:247]
M v[240:243],a[132:135],a[172:175],v[240:243]
M v[240:243],a[128:131],a[168:171],v[240:243]
M v[236:239],a[120:123],a[168:171],v[236:239]
M v[236:239],a[124:127],a[172:175],v[236:239]
M v[232:235],a[116:119],a[172:175],v[232:235]
M v[232:235],a[112:115],a[168:171],v[232:235]
M v[228:231],a[104:107],a[168:171],v[228:231]
M v[228:231],a[108:111],a[172:175],v[228:231]
s_waitcnt lgkmcnt(0)
M v[224:227],a[100:103],a[172:175],v[224:227]
M v[224:227],a[96:99],a[168:171],v[224:227]
M a[0:3],a[32:35],a[160:163],a[0:3]
R a[168:171],v5,34816
R a[172:175],v6,34816
M a[0:3],a[36:39],a[164:167],a[0:3]
SA m0,s23,81920
M a[4:7],a[44:47],a[164:167],a[4:7]
buffer_load_dwordx4 v22, s[56:59], s29 offen offset:0 lds
M a[4:7],a[40:43],a[160:163],a[4:7]
M a[8:11],a[48:51],a[160:163],a[8:11]
M a[8:11],a[52:55],a[164:167],a[8:11]
buffer_load_dwordx4 v23, s[56:59], s29 offen offset:1024 lds
M a[12:15],a[60:63],a[164:167],a[12:15]
M a[12:15],a[56:59],a[160:163],a[12:15]
G v24,a0
G v25,a1
M a[16:19],a[64:67],a[160:163],a[16:19]
G v26,a2
G v27,a3
M a[16:19],a[68:71],a[164:167],a[16:19]
buffer_load_dwordx4 v22, s[56:59], s30 offen offset:2048 lds
M a[20:23],a[76:79],a[164:167],a[20:23]
G v28,a4
G v29,a5
M a[20:23],a[72:75],a[160:163],a[20:23]
G v30,a6
G v31,a7
M a[24:27],a[80:83],a[160:163],a[24:27]
C v24,v24,v25
C v25,v26,v27
M a[24:27],a[84:87],a[164:167],a[24:27]
s_waitcnt lgkmcnt(0)
buffer_load_dwordx4 v23, s[56:59], s30 offen offset:3072 lds
M a[28:31],a[92:95],a[164:167],a[28:31]
SA s29,s29,128
C v26,v28,v29
C v27,v30,v31
M a[28:31],a[88:91],a[160:163],a[28:31]
SA s3,s93,0
buffer_store_dwordx4 v[24:27], v7, s[8:11], s3 offen offset:0 sc1
M v[32:35],a[32:35],a[168:171],v[32:35]
SA s30,s30,128
R a[160:163],v5,36864
R a[164:167],v6,36864
M v[32:35],a[36:39],a[172:175],v[32:35]
s_mov_b32 s25, 2097152
G v24,a8
G v25,a9
M v[36:39],a[44:47],a[172:175],v[36:39]
SA m0,s4,131072
G v26,a10
G v27,a11
M v[36:39],a[40:43],a[168:171],v[36:39]
buffer_load_dwordx4 v8, s[52:55], s25 offen lds
M v[40:43],a[48:51],a[168:171],v[40:43]
s_mov_b32 s25, 2359296
G v28,a12
G v29,a13
M v[40:43],a[52:55],a[172:175],v[40:43]
SA m0,s4,135168
G v30,a14
G v31,a15
M v[44:47],a[60:63],a[172:175],v[44:47]
buffer_load_dwordx4 v8, s[52:55], s25 offen lds
M v[44:47],a[56:59],a[168:171],v[44:47]
s_mov_b32 s25, 2621440
C v24,v24,v25
C v25,v26,v27
M v[48:51],a[64:67],a[168:171],v[48:51]
SA m0,s4,139264
C v26,v28,v29
C v27,v30,v31
M v[48:51],a[68:71],a[172:175],v[48:51]
buffer_store_dwordx4 v[24:27], v7, s[8:11], s3 offen offset:1024 sc1
M v[52:55],a[76:79],a[172:175],v[52:55]
s_nop 0
G v24,a16
G v25,a17
M v[52:55],a[72:75],a[168:171],v[52:55]
G v26,a18
G v27,a19
M v[56:59],a[80:83],a[168:171],v[56:59]
buffer_load_dwordx4 v8, s[52:55], s25 offen lds
M v[56:59],a[84:87],a[172:175],v[56:59]
s_waitcnt lgkmcnt(0)
G v28,a20
G v29,a21
M v[60:63],a[92:95],a[172:175],v[60:63]
s_mov_b32 s25, 2883584
G v30,a22
G v31,a23
M v[60:63],a[88:91],a[168:171],v[60:63]
SA m0,s4,143360
C v24,v24,v25
C v25,v26,v27
M v[64:67],a[32:35],a[160:163],v[64:67]
s_waitcnt vmcnt(17)
R a[168:171],v5,38912
R a[172:175],v6,38912
M v[64:67],a[36:39],a[164:167],v[64:67]
buffer_load_dwordx4 v8, s[52:55], s25 offen lds
M v[68:71],a[44:47],a[164:167],v[68:71]
s_mov_b32 s25, 3145728
C v26,v28,v29
C v27,v30,v31
M v[68:71],a[40:43],a[160:163],v[68:71]
SA m0,s4,147456
buffer_store_dwordx4 v[24:27], v7, s[8:11], s3 offen offset:2048 sc1
M v[72:75],a[48:51],a[160:163],v[72:75]
R a[96:99],v20,0
R a[100:103],v20,2048
M v[72:75],a[52:55],a[164:167],v[72:75]
R a[104:107],v21,0
R a[108:111],v21,2048
M v[76:79],a[60:63],a[164:167],v[76:79]
buffer_load_dwordx4 v8, s[52:55], s25 offen lds
M v[76:79],a[56:59],a[160:163],v[76:79]
s_mov_b32 s25, 3407872
G v24,a24
G v25,a25
M v[80:83],a[64:67],a[160:163],v[80:83]
SA m0,s4,151552
G v26,a26
G v27,a27
M v[80:83],a[68:71],a[164:167],v[80:83]
buffer_load_dwordx4 v8, s[52:55], s25 offen lds
M v[84:87],a[76:79],a[164:167],v[84:87]
G v28,a28
G v29,a29
M v[84:87],a[72:75],a[160:163],v[84:87]
G v30,a30
G v31,a31
M v[88:91],a[80:83],a[160:163],v[88:91]
C v24,v24,v25
C v25,v26,v27
M v[88:91],a[84:87],a[164:167],v[88:91]
s_waitcnt lgkmcnt(4)
C v26,v28,v29
C v27,v30,v31
M v[92:95],a[92:95],a[164:167],v[92:95]
s_waitcnt lgkmcnt(0)
buffer_store_dwordx4 v[24:27], v7, s[8:11], s3 offen offset:3072 sc1
M v[92:95],a[88:91],a[160:163],v[92:95]
s_barrier
M v[96:99],a[32:35],a[168:171],v[96:99]
R a[160:163],v5,49152
R a[164:167],v6,49152
M v[96:99],a[36:39],a[172:175],v[96:99]
s_mov_b32 s25, 128
C v64,v64,v65
C v65,v66,v67
M v[100:103],a[44:47],a[172:175],v[100:103]
SA m0,s4,49152
C v66,v68,v69
C v67,v70,v71
M v[100:103],a[40:43],a[168:171],v[100:103]
s_waitcnt vmcnt(18)
buffer_load_dwordx4 v8, s[52:55], s25 offen lds
M v[104:107],a[48:51],a[168:171],v[104:107]
C v72,v72,v73
C v73,v74,v75
M v[104:107],a[52:55],a[172:175],v[104:107]
C v74,v76,v77
C v75,v78,v79
M v[108:111],a[60:63],a[172:175],v[108:111]
C v32,v32,v33
C v33,v34,v35
M v[108:111],a[56:59],a[168:171],v[108:111]
C v34,v36,v37
C v35,v38,v39
M v[112:115],a[64:67],a[168:171],v[112:115]
SA s3,s93,8192
buffer_store_dwordx4 v[32:35], v7, s[8:11], s3 offen offset:0 sc1
M v[112:115],a[68:71],a[172:175],v[112:115]
s_mov_b32 s25, 262272
C v80,v80,v81
C v81,v82,v83
M v[116:119],a[76:79],a[172:175],v[116:119]
SA m0,s4,53248
C v82,v84,v85
C v83,v86,v87
M v[116:119],a[72:75],a[168:171],v[116:119]
R a[112:115],v20,32768
R a[116:119],v20,34816
M v[120:123],a[80:83],a[168:171],v[120:123]
buffer_load_dwordx4 v8, s[52:55], s25 offen lds
M v[120:123],a[84:87],a[172:175],v[120:123]
s_waitcnt lgkmcnt(2)
R a[120:123],v21,32768
R a[124:127],v21,34816
M v[124:127],a[92:95],a[172:175],v[124:127]
C v88,v88,v89
C v89,v90,v91
M v[124:127],a[88:91],a[168:171],v[124:127]
C v90,v92,v93
C v91,v94,v95
M v[128:131],a[32:35],a[160:163],v[128:131]
R a[168:171],v5,51200
R a[172:175],v6,51200
M v[128:131],a[36:39],a[164:167],v[128:131]
C v40,v40,v41
C v41,v42,v43
M v[132:135],a[44:47],a[164:167],v[132:135]
C v42,v44,v45
C v43,v46,v47
M v[132:135],a[40:43],a[160:163],v[132:135]
s_mov_b32 s25, 524416
buffer_store_dwordx4 v[40:43], v7, s[8:11], s3 offen offset:1024 sc1
M v[136:139],a[48:51],a[160:163],v[136:139]
SA m0,s4,57344
C v96,v96,v97
C v97,v98,v99
M v[136:139],a[52:55],a[164:167],v[136:139]
C v98,v100,v101
C v99,v102,v103
M v[140:143],a[60:63],a[164:167],v[140:143]
C v104,v104,v105
C v105,v106,v107
M v[140:143],a[56:59],a[160:163],v[140:143]
buffer_load_dwordx4 v8, s[52:55], s25 offen lds
M v[144:147],a[64:67],a[160:163],v[144:147]
C v106,v108,v109
C v107,v110,v111
M v[144:147],a[68:71],a[164:167],v[144:147]
C v112,v112,v113
C v113,v114,v115
M v[148:151],a[76:79],a[164:167],v[148:151]
C v114,v116,v117
C v115,v118,v119
M v[148:151],a[72:75],a[160:163],v[148:151]
C v48,v48,v49
C v49,v50,v51
M v[152:155],a[80:83],a[160:163],v[152:155]
C v50,v52,v53
C v51,v54,v55
M v[152:155],a[84:87],a[164:167],v[152:155]
s_waitcnt lgkmcnt(0)
buffer_store_dwordx4 v[48:51], v7, s[8:11], s3 offen offset:2048 sc1
M v[156:159],a[92:95],a[164:167],v[156:159]
s_mov_b32 s25, 786560
C v120,v120,v121
C v121,v122,v123
M v[156:159],a[88:91],a[160:163],v[156:159]
SA m0,s4,61440
C v122,v124,v125
C v123,v126,v127
M v[160:163],a[32:35],a[168:171],v[160:163]
R a[160:163],v5,53248
R a[164:167],v6,53248
M v[160:163],a[36:39],a[172:175],v[160:163]
buffer_load_dwordx4 v8, s[52:55], s25 offen lds
M v[164:167],a[44:47],a[172:175],v[164:167]
C v128,v128,v129
C v129,v130,v131
M v[164:167],a[40:43],a[168:171],v[164:167]
C v130,v132,v133
C v131,v134,v135
M v[168:171],a[48:51],a[168:171],v[168:171]
C v56,v56,v57
C v57,v58,v59
M v[168:171],a[52:55],a[172:175],v[168:171]
C v58,v60,v61
C v59,v62,v63
M v[172:175],a[60:63],a[172:175],v[172:175]
buffer_store_dwordx4 v[56:59], v7, s[8:11], s3 offen offset:3072 sc1
M v[172:175],a[56:59],a[168:171],v[172:175]
C v136,v136,v137
C v137,v138,v139
M v[176:179],a[64:67],a[168:171],v[176:179]
C v138,v140,v141
C v139,v142,v143
M v[176:179],a[68:71],a[172:175],v[176:179]
C v144,v144,v145
C v145,v146,v147
M v[180:183],a[76:79],a[172:175],v[180:183]
C v146,v148,v149
C v147,v150,v151
M v[180:183],a[72:75],a[168:171],v[180:183]
C v152,v152,v153
C v153,v154,v155
M v[184:187],a[80:83],a[168:171],v[184:187]
C v154,v156,v157
C v155,v158,v159
M v[184:187],a[84:87],a[172:175],v[184:187]
s_waitcnt lgkmcnt(0)
C v160,v160,v161
C v161,v162,v163
M v[188:191],a[92:95],a[172:175],v[188:191]
C v162,v164,v165
C v163,v166,v167
M v[188:191],a[88:91],a[168:171],v[188:191]
C v168,v168,v169
C v169,v170,v171
M v[192:195],a[32:35],a[160:163],v[192:195]
s_waitcnt vmcnt(18)
R a[168:171],v5,55296
R a[172:175],v6,55296
M v[192:195],a[36:39],a[164:167],v[192:195]
C v170,v172,v173
C v171,v174,v175
M v[196:199],a[44:47],a[164:167],v[196:199]
C v176,v176,v177
C v177,v178,v179
M v[196:199],a[40:43],a[160:163],v[196:199]
C v178,v180,v181
C v179,v182,v183
M v[200:203],a[48:51],a[160:163],v[200:203]
R a[128:131],v20,49152
R a[132:135],v20,51200
M v[200:203],a[52:55],a[164:167],v[200:203]
R a[136:139],v21,49152
R a[140:143],v21,51200
M v[204:207],a[60:63],a[164:167],v[204:207]
C v184,v184,v185
C v185,v186,v187
M v[204:207],a[56:59],a[160:163],v[204:207]
C v186,v188,v189
C v187,v190,v191
M v[208:211],a[64:67],a[160:163],v[208:211]
C v192,v192,v193
C v193,v194,v195
M v[208:211],a[68:71],a[164:167],v[208:211]
C v194,v196,v197
C v195,v198,v199
M v[212:215],a[76:79],a[164:167],v[212:215]
M v[212:215],a[72:75],a[160:163],v[212:215]
C v200,v200,v201
C v201,v202,v203
M v[216:219],a[80:83],a[160:163],v[216:219]
C v202,v204,v205
C v203,v206,v207
M v[216:219],a[84:87],a[164:167],v[216:219]
s_waitcnt lgkmcnt(4)
M v[220:223],a[92:95],a[164:167],v[220:223]
s_waitcnt vmcnt(9) lgkmcnt(0)
M v[220:223],a[88:91],a[160:163],v[220:223]
s_barrier
M v[224:227],a[32:35],a[168:171],v[224:227]
s_nop 0
T v[32:33],v16,0
T v[34:35],v16,2048
M v[224:227],a[36:39],a[172:175],v[224:227]
C v208,v208,v209
C v209,v210,v211
M v[228:231],a[44:47],a[172:175],v[228:231]
T v[36:37],v16,4096
T v[38:39],v16,6144
M v[228:231],a[40:43],a[168:171],v[228:231]
T v[40:41],v16,8192
T v[42:43],v16,10240
M v[232:235],a[48:51],a[168:171],v[232:235]
C v210,v212,v213
C v211,v214,v215
M v[232:235],a[52:55],a[172:175],v[232:235]
T v[44:45],v16,12288
T v[46:47],v16,14336
M v[236:239],a[60:63],a[172:175],v[236:239]
T v[48:49],v16,16384
T v[50:51],v16,18432
M v[236:239],a[56:59],a[168:171],v[236:239]
C v216,v216,v217
C v217,v218,v219
M v[240:243],a[64:67],a[168:171],v[240:243]
T v[52:53],v16,20480
T v[54:55],v16,22528
M v[240:243],a[68:71],a[172:175],v[240:243]
T v[56:57],v16,24576
T v[58:59],v16,26624
M v[244:247],a[76:79],a[172:175],v[244:247]
C v218,v220,v221
C v219,v222,v223
M v[244:247],a[72:75],a[168:171],v[244:247]
C v224,v224,v225
C v225,v226,v227
M v[248:251],a[80:83],a[168:171],v[248:251]
C v226,v228,v229
C v227,v230,v231
M v[248:251],a[84:87],a[172:175],v[248:251]
C v232,v232,v233
C v233,v234,v235
M v[252:255],a[92:95],a[172:175],v[252:255]
C v234,v236,v237
C v235,v238,v239
M v[252:255],a[88:91],a[168:171],v[252:255]
s_waitcnt lgkmcnt(6)
C v240,v240,v241
C v241,v242,v243
M v[68:71],v[32:35],a[176:179],0
s_mul_i32 s72, s41, 4352
T a[144:145],v17,0
T a[146:147],v17,2048
M v[68:71],v[36:39],a[184:187],v[68:71]
s_mov_b32 s25, 1048704
C v242,v244,v245
C v243,v246,v247
M v[68:71],v[40:43],a[192:195],v[68:71]
s_waitcnt lgkmcnt(2)
T a[148:149],v17,4096
T a[150:151],v17,6144
M v[68:71],v[44:47],a[200:203],v[68:71]
SA m0,s4,98304
T a[152:153],v17,8192
T a[154:155],v17,10240
M v[68:71],v[48:51],a[208:211],v[68:71]
SA s46,s72,104923136
buffer_load_dwordx4 v8, s[52:55], s25 offen lds
M v[68:71],v[52:55],a[216:219],v[68:71]
s_lshl_b32 s45, s42, 7
T a[156:157],v17,12288
T a[158:159],v17,14336
M v[68:71],v[56:59],a[224:227],v[68:71]
s_mov_b32 s25, 1310848
T a[160:161],v17,16384
T a[162:163],v17,18432
M v[76:79],v[56:59],a[228:231],0
SA m0,s4,102400
C v248,v248,v249
C v249,v250,v251
M v[76:79],v[52:55],a[220:223],v[76:79]
SA s45,s45,s46
T a[164:165],v17,20480
T a[166:167],v17,22528
M v[76:79],v[48:51],a[212:215],v[76:79]
s_lshl_b32 s72, s20, 2
T a[168:169],v17,24576
T a[170:171],v17,26624
M v[76:79],v[44:47],a[204:207],v[76:79]
SA s72,s72,s45
buffer_load_dwordx4 v8, s[52:55], s25 offen lds
M v[76:79],v[40:43],a[196:199],v[76:79]
C v250,v252,v253
C v251,v254,v255
M v[76:79],v[36:39],a[188:191],v[76:79]
s_mov_b32 s25, 1572992
v_min_u32 v29, 1, v0
v_lshlrev_b32 v29, 29, v29
M v[76:79],v[32:35],a[180:183],v[76:79]
s_waitcnt lgkmcnt(6)
v_mov_b32 v30, 1
M v[84:87],a[144:147],a[176:179],0
SA m0,s4,106496
T v[32:33],v18,0
T v[34:35],v18,2048
M v[84:87],a[148:151],a[184:187],v[84:87]
buffer_load_dwordx4 v8, s[52:55], s25 offen lds
M v[84:87],a[152:155],a[192:195],v[84:87]
s_waitcnt lgkmcnt(2)
s_nop 0
T v[36:37],v18,4096
T v[38:39],v18,6144
M v[84:87],a[156:159],a[200:203],v[84:87]
s_mov_b32 s25, 1835136
T v[40:41],v18,8192
T v[42:43],v18,10240
M v[84:87],a[160:163],a[208:211],v[84:87]
SA m0,s4,110592
M v[84:87],a[164:167],a[216:219],v[84:87]
s_nop 0
T v[44:45],v18,12288
T v[46:47],v18,14336
M v[84:87],a[168:171],a[224:227],v[84:87]
s_waitcnt vmcnt(3)
T v[48:49],v18,16384
T v[50:51],v18,18432
M v[92:95],a[168:171],a[228:231],0
buffer_load_dwordx4 v8, s[52:55], s25 offen lds
M v[92:95],a[164:167],a[220:223],v[92:95]
s_nop 0
T v[52:53],v18,20480
T v[54:55],v18,22528
M v[92:95],a[160:163],a[212:215],v[92:95]
s_mov_b32 s25, 2097280
T v[56:57],v18,24576
T v[58:59],v18,26624
M v[92:95],a[156:159],a[204:207],v[92:95]
SA m0,s4,114688
buffer_store_dword v30, v29, s[8:11], s72 offen offset:4 sc1
M v[92:95],a[152:155],a[196:199],v[92:95]
SA s3,s93,524288
buffer_load_dwordx4 v8, s[52:55], s25 offen lds
M v[92:95],a[148:151],a[188:191],v[92:95]
v_add_u32 v20, 0x10000, v16
v_add_u32 v21, 0x10000, v17
M v[92:95],a[144:147],a[180:183],v[92:95]
s_waitcnt lgkmcnt(6)
buffer_store_dwordx4 v[64:67], v7, s[8:11], s3 offen offset:0 sc1
M v[100:103],v[32:35],a[176:179],0
s_mov_b32 s25, 2359424
T a[144:145],v19,0
T a[146:147],v19,2048
M v[100:103],v[36:39],a[184:187],v[100:103]
SA m0,s4,118784
L_w_kv08:
s_cbranch_execz L_wd1
buffer_store_dwordx4 v[72:75], v7, s[8:11], s3 offen offset:1024 sc1
M v[100:103],v[40:43],a[192:195],v[100:103]
s_waitcnt lgkmcnt(2)
s_nop 0
T a[148:149],v19,4096
T a[150:151],v19,6144
M v[100:103],v[44:47],a[200:203],v[100:103]
T a[152:153],v19,8192
T a[154:155],v19,10240
M v[100:103],v[48:51],a[208:211],v[100:103]
buffer_load_dwordx4 v8, s[52:55], s25 offen lds
M v[100:103],v[52:55],a[216:219],v[100:103]
s_nop 0
T a[156:157],v19,12288
T a[158:159],v19,14336
M v[100:103],v[56:59],a[224:227],v[100:103]
s_mov_b32 s25, 2621568
T a[160:161],v19,16384
T a[162:163],v19,18432
M v[108:111],v[56:59],a[228:231],0
SA m0,s4,122880
buffer_store_dwordx4 v[80:83], v7, s[8:11], s3 offen offset:2048 sc1
M v[108:111],v[52:55],a[220:223],v[108:111]
s_nop 0
T a[164:165],v19,20480
T a[166:167],v19,22528
M v[108:111],v[48:51],a[212:215],v[108:111]
T a[168:169],v19,24576
T a[170:171],v19,26624
M v[108:111],v[44:47],a[204:207],v[108:111]
buffer_load_dwordx4 v8, s[52:55], s25 offen lds
M v[108:111],v[40:43],a[196:199],v[108:111]
v_add_u32 v22, 0x10000, v18
v_add_u32 v23, 0x10000, v19
M v[108:111],v[36:39],a[188:191],v[108:111]
s_mov_b32 s25, 2883712
buffer_store_dwordx4 v[88:91], v7, s[8:11], s3 offen offset:3072 sc1
M v[108:111],v[32:35],a[180:183],v[108:111]
s_waitcnt lgkmcnt(6)
v_or_b32 v1, s20, v0
v_min_u32 v1, 1, v1
M v[116:119],a[144:147],a[176:179],0
SA m0,s4,126976
T v[32:33],v16,28672
T v[34:35],v16,30720
M v[116:119],a[148:151],a[184:187],v[116:119]
buffer_load_dwordx4 v8, s[52:55], s25 offen lds
M v[116:119],a[152:155],a[192:195],v[116:119]
s_waitcnt lgkmcnt(2)
s_nop 0
T v[36:37],v12,0
T v[38:39],v12,2048
M v[116:119],a[156:159],a[200:203],v[116:119]
s_mov_b32 s25, 3145856
T v[40:41],v12,4096
T v[42:43],v12,6144
M v[116:119],a[160:163],a[208:211],v[116:119]
SA m0,s4,32768
v_lshlrev_b32 v1, 29, v1
M v[116:119],a[164:167],a[216:219],v[116:119]
s_nop 0
T v[44:45],v12,8192
T v[46:47],v12,10240
M v[116:119],a[168:171],a[224:227],v[116:119]
T v[48:49],v12,12288
T v[50:51],v12,14336
M v[124:127],a[168:171],a[228:231],0
buffer_load_dwordx4 v8, s[52:55], s25 offen lds
M v[124:127],a[164:167],a[220:223],v[124:127]
s_nop 0
T v[52:53],v12,16384
T v[54:55],v12,18432
M v[124:127],a[160:163],a[212:215],v[124:127]
s_mov_b32 s25, 3408000
T v[56:57],v12,20480
T v[58:59],v12,22528
M v[124:127],a[156:159],a[204:207],v[124:127]
SA m0,s4,36864
v_min_u32 v9, 15, v0
v_lshlrev_b32 v9, 7, v9
M v[124:127],a[152:155],a[196:199],v[124:127]
s_sub_u32 s66, 15, s42
buffer_load_dwordx4 v8, s[52:55], s25 offen lds
M v[124:127],a[148:151],a[188:191],v[124:127]
s_max_u32 s67, s66, s42
M v[124:127],a[144:147],a[180:183],v[124:127]
s_waitcnt lgkmcnt(6)
M v[68:71],v[32:35],a[232:235],v[68:71]
s_mov_b32 s25, 256
T a[144:145],v17,28672
T a[146:147],v17,30720
M v[68:71],v[36:39],a[96:99],v[68:71]
SA m0,s4,65536
M v[68:71],v[40:43],a[104:107],v[68:71]
s_waitcnt lgkmcnt(2)
s_nop 0
T a[148:149],v13,0
T a[150:151],v13,2048
M v[68:71],v[44:47],a[112:115],v[68:71]
s_min_u32 s66, s66, s42
T a[152:153],v13,4096
T a[154:155],v13,6144
M v[68:71],v[48:51],a[120:123],v[68:71]
s_mul_i32 s21, s41, 1048576
buffer_load_dwordx4 v8, s[52:55], s25 offen lds
M v[68:71],v[52:55],a[128:131],v[68:71]
s_lshl_b32 s64, s67, 16
T a[156:157],v13,8192
T a[158:159],v13,10240
M v[68:71],v[56:59],a[136:139],v[68:71]
s_mov_b32 s25, 262400
T a[160:161],v13,12288
T a[162:163],v13,14336
M v[76:79],v[56:59],a[140:143],v[76:79]
SA m0,s4,69632
M v[76:79],v[52:55],a[132:135],v[76:79]
SA s32,s21,s64
T a[164:165],v13,16384
T a[166:167],v13,18432
M v[76:79],v[48:51],a[124:127],v[76:79]
s_lshl_b32 s64, s20, 14
T a[168:169],v13,20480
T a[170:171],v13,22528
M v[76:79],v[44:47],a[116:119],v[76:79]
SA s32,s32,s64
buffer_load_dwordx4 v8, s[52:55], s25 offen lds
M v[76:79],v[40:43],a[108:111],v[76:79]
SA s32,s32,33554432
M v[76:79],v[36:39],a[100:103],v[76:79]
s_mov_b32 s25, 524544
M v[76:79],v[32:35],a[236:239],v[76:79]
s_waitcnt lgkmcnt(6)
M v[84:87],a[144:147],a[232:235],v[84:87]
SA m0,s4,73728
T v[32:33],v18,28672
T v[34:35],v18,30720
M v[84:87],a[148:151],a[96:99],v[84:87]
s_sub_u32 s64, s42, 10
buffer_load_dwordx4 v8, s[52:55], s25 offen lds
M v[84:87],a[152:155],a[104:107],v[84:87]
s_waitcnt lgkmcnt(2)
s_nop 0
T v[36:37],v14,0
T v[38:39],v14,2048
M v[84:87],a[156:159],a[112:115],v[84:87]
s_mov_b32 s25, 786688
T v[40:41],v14,4096
T v[42:43],v14,6144
M v[84:87],a[160:163],a[120:123],v[84:87]
SA m0,s4,77824
M v[84:87],a[164:167],a[128:131],v[84:87]
s_and_b32 s35, s64, 536870912
T v[44:45],v14,8192
T v[46:47],v14,10240
M v[84:87],a[168:171],a[136:139],v[84:87]
T v[48:49],v14,12288
T v[50:51],v14,14336
M v[92:95],a[168:171],a[140:143],v[92:95]
buffer_load_dwordx4 v8, s[52:55], s25 offen lds
M v[92:95],a[164:167],a[132:135],v[92:95]
s_nop 0
T v[52:53],v14,16384
T v[54:55],v14,18432
M v[92:95],a[160:163],a[124:127],v[92:95]
s_mov_b32 s25, 1048832
T v[56:57],v14,20480
T v[58:59],v14,22528
M v[92:95],a[156:159],a[116:119],v[92:95]
SA m0,s4,81920
v_or_b32 v6, s35, v7
MF v68,s5,v68
M v[92:95],a[152:155],a[108:111],v[92:95]
s_lshl_b32 s28, s20, 13
buffer_load_dwordx4 v8, s[52:55], s25 offen lds
M v[92:95],a[148:151],a[100:103],v[92:95]
v_add_u32 v2, 0x10000, v7
v_add_u32 v3, s28, v7
M v[92:95],a[144:147],a[236:239],v[92:95]
s_waitcnt lgkmcnt(6)
v_add_u32 v4, 0x1000, v3
MF v69,s5,v69
M v[100:103],v[32:35],a[232:235],v[100:103]
s_mov_b32 s25, 1310976
T a[144:145],v19,28672
T a[146:147],v19,30720
M v[100:103],v[36:39],a[96:99],v[100:103]
SA m0,s4,86016
MF v70,s5,v70
MF v71,s5,v71
M v[100:103],v[40:43],a[104:107],v[100:103]
s_waitcnt lgkmcnt(2)
T a[148:149],v15,0
T a[150:151],v15,2048
M v[100:103],v[44:47],a[112:115],v[100:103]
s_lshl_b32 s64, s42, 16
T a[152:153],v15,4096
T a[154:155],v15,6144
M v[100:103],v[48:51],a[120:123],v[100:103]
SA s23,s21,s64
buffer_load_dwordx4 v8, s[52:55], s25 offen lds
M v[100:103],v[52:55],a[128:131],v[100:103]
SA s43,s23,16777216
T a[156:157],v15,8192
T a[158:159],v15,10240
M v[100:103],v[56:59],a[136:139],v[100:103]
s_mov_b32 s25, 1573120
T a[160:161],v15,12288
T a[162:163],v15,14336
M v[108:111],v[56:59],a[140:143],v[108:111]
SA m0,s4,90112
MF v84,s5,v84
MF v85,s5,v85
M v[108:111],v[52:55],a[132:135],v[108:111]
SA s26,s21,16777216
T a[164:165],v15,16384
T a[166:167],v15,18432
M v[108:111],v[48:51],a[124:127],v[108:111]
s_mov_b32 s22, 0x7fff
T a[168:169],v15,20480
T a[170:171],v15,22528
M v[108:111],v[44:47],a[116:119],v[108:111]
s_sub_u32 s27, s42, 1
buffer_load_dwordx4 v8, s[52:55], s25 offen lds
M v[108:111],v[40:43],a[108:111],v[108:111]
s_cmp_eq_u32 s42, 0
MF v86,s5,v86
MF v87,s5,v87
M v[108:111],v[36:39],a[100:103],v[108:111]
s_waitcnt vmcnt(7) lgkmcnt(0)
C v68,v68,v69
C v69,v70,v71
M v[108:111],v[32:35],a[236:239],v[108:111]
s_barrier
M v[116:119],a[144:147],a[232:235],v[116:119]
s_mov_b32 s25, 1835264
T v[32:33],v16,49152
T v[34:35],v16,51200
M v[116:119],a[148:151],a[96:99],v[116:119]
s_cselect_b32 s64, 32768, 0
C v70,v84,v85
C v71,v86,v87
M v[116:119],a[152:155],a[104:107],v[116:119]
SA m0,s4,94208
T v[36:37],v16,53248
T v[38:39],v16,55296
M v[116:119],a[156:159],a[112:115],v[116:119]
SA s26,s26,s64
T v[40:41],v16,57344
T v[42:43],v16,59392
M v[116:119],a[160:163],a[120:123],v[116:119]
s_mov_b32 s31, 0x4b800000
buffer_load_dwordx4 v8, s[52:55], s25 offen lds
M v[116:119],a[164:167],a[128:131],v[116:119]
s_mov_b32 s24, 0x33800000
T v[44:45],v16,61440
T v[46:47],v16,63488
M v[116:119],a[168:171],a[136:139],v[116:119]
s_mov_b32 s25, 2097408
T v[48:49],v20,32768
T v[50:51],v20,34816
M v[124:127],a[168:171],a[140:143],v[124:127]
SA m0,s4,155648
W a0,v68
W a1,v69
M v[124:127],a[164:167],a[132:135],v[124:127]
s_lshl_b32 s47, s66, 7
T v[52:53],v20,36864
T v[54:55],v20,38912
M v[124:127],a[160:163],a[124:127],v[124:127]
SA s47,s47,s46
T v[56:57],v20,40960
T v[58:59],v20,43008
M v[124:127],a[156:159],a[116:119],v[124:127]
s_lshl_b32 s64, s20, 5
buffer_load_dwordx4 v8, s[52:55], s25 offen lds
M v[124:127],a[152:155],a[108:111],v[124:127]
SA s47,s47,s64
W a2,v70
W a3,v71
M v[124:127],a[148:151],a[100:103],v[124:127]
SA s47,s47,2048
MF v76,s5,v76
MF v77,s5,v77
M v[124:127],a[144:147],a[236:239],v[124:127]
s_waitcnt lgkmcnt(6)
MF v78,s5,v78
MF v79,s5,v79
M v[132:135],v[32:35],a[176:179],0
s_lshl_b32 s65, s41, 3
T a[144:145],v17,49152
T a[146:147],v17,51200
M v[132:135],v[36:39],a[184:187],v[132:135]
SA s65,s65,s66
MF v92,s5,v92
MF v93,s5,v93
M v[132:135],v[40:43],a[192:195],v[132:135]
s_waitcnt lgkmcnt(2)
T a[148:149],v17,53248
T a[150:151],v17,55296
M v[132:135],v[44:47],a[200:203],v[132:135]
s_mul_i32 s34, s65, 73728
T a[152:153],v17,57344
T a[154:155],v17,59392
M v[132:135],v[48:51],a[208:211],v[132:135]
SA s34,s34,136314880
MF v94,s5,v94
MF v95,s5,v95
M v[132:135],v[52:55],a[216:219],v[132:135]
s_lshl_b32 s65, s42, 4
T a[156:157],v17,61440
T a[158:159],v17,63488
M v[132:135],v[56:59],a[224:227],v[132:135]
SA s65,s65,s41
T a[160:161],v21,32768
T a[162:163],v21,34816
M v[140:143],v[56:59],a[228:231],0
s_mul_i32 s33, s65, 114688
C v76,v76,v77
C v77,v78,v79
M v[140:143],v[52:55],a[220:223],v[140:143]
s_mul_i32 s65, s20, 28672
T a[164:165],v21,36864
T a[166:167],v21,38912
M v[140:143],v[48:51],a[212:215],v[140:143]
SA s33,s33,s65
T a[168:169],v21,40960
T a[170:171],v21,43008
M v[140:143],v[44:47],a[204:207],v[140:143]
SA s33,s33,67108864
C v78,v92,v93
C v79,v94,v95
M v[140:143],v[40:43],a[196:199],v[140:143]
s_mov_b32 s6, 0
W a32,v76
W a33,v77
M v[140:143],v[36:39],a[188:191],v[140:143]
s_mov_b32 s7, 0
W a34,v78
W a35,v79
M v[140:143],v[32:35],a[180:183],v[140:143]
s_waitcnt lgkmcnt(6)
MF v100,s5,v100
MF v101,s5,v101
M v[148:151],a[144:147],a[176:179],0
s_mov_b32 s40, 1
T v[32:33],v18,49152
T v[34:35],v18,51200
M v[148:151],a[148:151],a[184:187],v[148:151]
s_cmp_eq_u32 s20, 0
MF v102,s5,v102
MF v103,s5,v103
M v[148:151],a[152:155],a[192:195],v[148:151]
s_waitcnt lgkmcnt(2)
T v[36:37],v18,53248
T v[38:39],v18,55296
M v[148:151],a[156:159],a[200:203],v[148:151]
s_cselect_b32 s39, 7, 4
T v[40:41],v18,57344
T v[42:43],v18,59392
M v[148:151],a[160:163],a[208:211],v[148:151]
s_lshl_b32 s64, s41, 1
MF v116,s5,v116
MF v117,s5,v117
M v[148:151],a[164:167],a[216:219],v[148:151]
SA s64,s64,s20
T v[44:45],v18,61440
T v[46:47],v18,63488
M v[148:151],a[168:171],a[224:227],v[148:151]
s_cmp_lt_u32 s64, 30
T v[48:49],v22,32768
T v[50:51],v22,34816
M v[156:159],a[168:171],a[228:231],0
s_cselect_b32 s64, 32798, 0
MF v118,s5,v118
MF v119,s5,v119
M v[156:159],a[164:167],a[220:223],v[156:159]
s_cmp_ge_u32 s20, 2
T v[52:53],v22,36864
T v[54:55],v22,38912
M v[156:159],a[160:163],a[212:215],v[156:159]
s_cselect_b32 s64, s64, 0
T v[56:57],v22,40960
T v[58:59],v22,43008
M v[156:159],a[156:159],a[204:207],v[156:159]
s_cmp_eq_u32 s42, 6
C v100,v100,v101
C v101,v102,v103
M v[156:159],a[152:155],a[196:199],v[156:159]
s_cselect_b32 s64, s64, 0
C v102,v116,v117
C v103,v118,v119
M v[156:159],a[148:151],a[188:191],v[156:159]
s_or_b32 s39, s39, s64
W a4,v100
W a5,v101
M v[156:159],a[144:147],a[180:183],v[156:159]
s_waitcnt lgkmcnt(6)
W a6,v102
W a7,v103
M v[164:167],v[32:35],a[176:179],0
s_mov_b64 s[60:61], s[76:77]
T a[144:145],v19,49152
T a[146:147],v19,51200
M v[164:167],v[36:39],a[184:187],v[164:167]
s_mov_b32 s62, s78
MF v108,s5,v108
MF v109,s5,v109
M v[164:167],v[40:43],a[192:195],v[164:167]
s_waitcnt lgkmcnt(2)
T a[148:149],v19,53248
T a[150:151],v19,55296
M v[164:167],v[44:47],a[200:203],v[164:167]
s_mov_b32 s63, 0x20000
T a[152:153],v19,57344
T a[154:155],v19,59392
M v[164:167],v[48:51],a[208:211],v[164:167]
s_mov_b32 s25, 2359552
v_lshrrev_b32 v24, 4, v0
v_lshlrev_b32 v24, 2, v24
M v[164:167],v[52:55],a[216:219],v[164:167]
SA m0,s4,159744
T a[156:157],v19,61440
T a[158:159],v19,63488
M v[164:167],v[56:59],a[224:227],v[164:167]
SA s3,s93,532480
T a[160:161],v23,32768
T a[162:163],v23,34816
M v[172:175],v[56:59],a[228:231],0
buffer_load_dwordx4 v8, s[52:55], s25 offen lds
M v[172:175],v[52:55],a[220:223],v[172:175]
s_nop 0
T a[164:165],v23,36864
T a[166:167],v23,38912
M v[172:175],v[48:51],a[212:215],v[172:175]
s_mov_b32 s25, 2621696
T a[168:169],v23,40960
T a[170:171],v23,43008
M v[172:175],v[44:47],a[204:207],v[172:175]
SA m0,s4,131072
buffer_store_dwordx4 v[96:99], v7, s[8:11], s3 offen offset:0 sc1
M v[172:175],v[40:43],a[196:199],v[172:175]
v_and_b32 v25, 15, v0
v_sub_u32 v24, v24, v25
M v[172:175],v[36:39],a[188:191],v[172:175]
buffer_load_dwordx4 v8, s[52:55], s25 offen lds
M v[172:175],v[32:35],a[180:183],v[172:175]
s_waitcnt lgkmcnt(6)
v_cmp_lt_i32 s[16:17], 0, v24
v_cmp_lt_i32 s[18:19], -1, v24
M v[180:183],a[144:147],a[176:179],0
s_mov_b32 s25, 2883840
T v[32:33],v20,45056
T v[34:35],v20,47104
M v[180:183],a[148:151],a[184:187],v[180:183]
SA m0,s4,135168
buffer_store_dwordx4 v[104:107], v7, s[8:11], s3 offen offset:1024 sc1
M v[180:183],a[152:155],a[192:195],v[180:183]
s_waitcnt lgkmcnt(2)
s_nop 0
T v[36:37],v20,49152
T v[38:39],v20,51200
M v[180:183],a[156:159],a[200:203],v[180:183]
T v[40:41],v20,53248
T v[42:43],v20,55296
M v[180:183],a[160:163],a[208:211],v[180:183]
buffer_load_dwordx4 v8, s[52:55], s25 offen lds
M v[180:183],a[164:167],a[216:219],v[180:183]
s_nop 0
T v[44:45],v20,57344
T v[46:47],v20,59392
M v[180:183],a[168:171],a[224:227],v[180:183]
s_mov_b32 s25, 3145984
T v[48:49],v20,61440
T v[50:51],v20,63488
M v[188:191],a[168:171],a[228:231],0
SA m0,s4,139264
buffer_store_dwordx4 v[112:115], v7, s[8:11], s3 offen offset:2048 sc1
M v[188:191],a[164:167],a[220:223],v[188:191]
s_nop 0
T v[52:53],v16,32768
T v[54:55],v16,34816
M v[188:191],a[160:163],a[212:215],v[188:191]
T v[56:57],v16,36864
T v[58:59],v16,38912
M v[188:191],a[156:159],a[204:207],v[188:191]
buffer_load_dwordx4 v8, s[52:55], s25 offen lds
M v[188:191],a[152:155],a[196:199],v[188:191]
v_cmp_lt_i32 s[48:49], -2, v24
v_cmp_lt_i32 s[50:51], -3, v24
M v[188:191],a[148:151],a[188:191],v[188:191]
s_mov_b32 s25, 3408128
buffer_store_dwordx4 v[120:123], v7, s[8:11], s3 offen offset:3072 sc1
M v[188:191],a[144:147],a[180:183],v[188:191]
s_waitcnt lgkmcnt(6)
v_lshl_add_u32 v25, v0, 7, s95
v_and_b32 v0, 48, v0
M v[132:135],v[32:35],a[232:235],v[132:135]
SA m0,s4,143360
T a[144:145],v21,45056
T a[146:147],v21,47104
M v[132:135],v[36:39],a[96:99],v[132:135]
buffer_load_dwordx4 v8, s[52:55], s25 offen lds
M v[132:135],v[40:43],a[104:107],v[132:135]
s_waitcnt lgkmcnt(2)
s_nop 0
T a[148:149],v21,49152
T a[150:151],v21,51200
M v[132:135],v[44:47],a[112:115],v[132:135]
s_mov_b32 s25, 384
T a[152:153],v21,53248
T a[154:155],v21,55296
M v[132:135],v[48:51],a[120:123],v[132:135]
SA m0,s4,0
v_lshl_add_u32 v0, v0, 24, v25
v_mov_b32 v24, 0x3f80
M v[132:135],v[52:55],a[128:131],v[132:135]
T a[156:157],v21,57344
T a[158:159],v21,59392
M v[132:135],v[56:59],a[136:139],v[132:135]
T a[160:161],v21,61440
T a[162:163],v21,63488
M v[140:143],v[56:59],a[140:143],v[140:143]
buffer_load_dwordx4 v8, s[52:55], s25 offen lds
M v[140:143],v[52:55],a[132:135],v[140:143]
s_nop 0
T a[164:165],v17,32768
T a[166:167],v17,34816
M v[140:143],v[48:51],a[124:127],v[140:143]
s_mov_b32 s25, 262528
T a[168:169],v17,36864
T a[170:171],v17,38912
M v[140:143],v[44:47],a[116:119],v[140:143]
SA m0,s4,4096
MF v110,s5,v110
MF v111,s5,v111
M v[140:143],v[40:43],a[108:111],v[140:143]
buffer_load_dwordx4 v8, s[52:55], s25 offen lds
M v[140:143],v[36:39],a[100:103],v[140:143]
MF v124,s5,v124
MF v125,s5,v125
M v[140:143],v[32:35],a[236:239],v[140:143]
s_waitcnt lgkmcnt(6)
MF v126,s5,v126
MF v127,s5,v127
M v[148:151],a[144:147],a[232:235],v[148:151]
s_mov_b32 s25, 524672
T v[32:33],v22,45056
T v[34:35],v22,47104
M v[148:151],a[148:151],a[96:99],v[148:151]
SA m0,s4,8192
C v108,v108,v109
C v109,v110,v111
M v[148:151],a[152:155],a[104:107],v[148:151]
s_waitcnt lgkmcnt(2)
T v[36:37],v22,49152
T v[38:39],v22,51200
M v[148:151],a[156:159],a[112:115],v[148:151]
T v[40:41],v22,53248
T v[42:43],v22,55296
M v[148:151],a[160:163],a[120:123],v[148:151]
buffer_load_dwordx4 v8, s[52:55], s25 offen lds
M v[148:151],a[164:167],a[128:131],v[148:151]
s_nop 0
T v[44:45],v22,57344
T v[46:47],v22,59392
M v[148:151],a[168:171],a[136:139],v[148:151]
s_mov_b32 s25, 786816
T v[48:49],v22,61440
T v[50:51],v22,63488
M v[156:159],a[168:171],a[140:143],v[156:159]
SA m0,s4,12288
C v110,v124,v125
C v111,v126,v127
M v[156:159],a[164:167],a[132:135],v[156:159]
T v[52:53],v18,32768
T v[54:55],v18,34816
M v[156:159],a[160:163],a[124:127],v[156:159]
T v[56:57],v18,36864
T v[58:59],v18,38912
M v[156:159],a[156:159],a[116:119],v[156:159]
buffer_load_dwordx4 v8, s[52:55], s25 offen lds
M v[156:159],a[152:155],a[108:111],v[156:159]
W a36,v108
W a37,v109
M v[156:159],a[148:151],a[100:103],v[156:159]
s_mov_b32 s25, 1048960
v_lshrrev_b32 v25, 8, v7
v_bfe_u32 v26, v7, 6, 2
v_and_b32 v27, 16, v7
v_lshlrev_b32 v27, v27, v24
v_cmp_eq_u32 vcc, v25, v26
v_and_b32 v28, 32, v7
W a244,0
v_cndmask_b32 v27, 0, v27, vcc
v_cmp_eq_u32 vcc, 0, v28
W a245,0
W a248,0
v_cndmask_b32 v25, 0, v27, vcc
v_sub_u32 v26, v27, v25
W a249,0
W a246,v25
W a247,v26
M v[156:159],a[144:147],a[236:239],v[156:159]
s_waitcnt lgkmcnt(6)
W a38,v110
W a39,v111
M v[164:167],v[32:35],a[232:235],v[164:167]
SA m0,s4,16384
T a[144:145],v23,45056
T a[146:147],v23,47104
M v[164:167],v[36:39],a[96:99],v[164:167]
buffer_load_dwordx4 v8, s[52:55], s25 offen lds
M v[164:167],v[40:43],a[104:107],v[164:167]
s_waitcnt lgkmcnt(2)
s_nop 0
T a[148:149],v23,49152
T a[150:151],v23,51200
M v[164:167],v[44:47],a[112:115],v[164:167]
s_mov_b32 s25, 1311104
T a[152:153],v23,53248
T a[154:155],v23,55296
M v[164:167],v[48:51],a[120:123],v[164:167]
SA m0,s4,20480
MF v132,s5,v132
MF v133,s5,v133
M v[164:167],v[52:55],a[128:131],v[164:167]
T a[156:157],v23,57344
T a[158:159],v23,59392
M v[164:167],v[56:59],a[136:139],v[164:167]
T a[160:161],v23,61440
T a[162:163],v23,63488
M v[172:175],v[56:59],a[140:143],v[172:175]
buffer_load_dwordx4 v8, s[52:55], s25 offen lds
M v[172:175],v[52:55],a[132:135],v[172:175]
s_nop 0
T a[164:165],v19,32768
T a[166:167],v19,34816
M v[172:175],v[48:51],a[124:127],v[172:175]
s_mov_b32 s25, 1573248
T a[168:169],v19,36864
T a[170:171],v19,38912
M v[172:175],v[44:47],a[116:119],v[172:175]
SA m0,s4,24576
MF v134,s5,v134
MF v135,s5,v135
M v[172:175],v[40:43],a[108:111],v[172:175]
buffer_load_dwordx4 v8, s[52:55], s25 offen lds
M v[172:175],v[36:39],a[100:103],v[172:175]
s_waitcnt vmcnt(7) lgkmcnt(0)
MF v148,s5,v148
MF v149,s5,v149
M v[172:175],v[32:35],a[236:239],v[172:175]
s_barrier
M v[180:183],a[144:147],a[232:235],v[180:183]
s_mov_b32 s25, 1835392
T v[32:33],v20,0
T v[34:35],v20,2048
M v[180:183],a[148:151],a[96:99],v[180:183]
SA m0,s4,28672
MF v150,s5,v150
MF v151,s5,v151
M v[180:183],a[152:155],a[104:107],v[180:183]
T v[36:37],v20,4096
T v[38:39],v20,6144
M v[180:183],a[156:159],a[112:115],v[180:183]
T v[40:41],v20,8192
T v[42:43],v20,10240
M v[180:183],a[160:163],a[120:123],v[180:183]
buffer_load_dwordx4 v8, s[52:55], s25 offen lds
M v[180:183],a[164:167],a[128:131],v[180:183]
s_nop 0
T v[44:45],v20,12288
T v[46:47],v20,14336
M v[180:183],a[168:171],a[136:139],v[180:183]
s_mov_b32 s25, 2097536
T v[48:49],v20,16384
T v[50:51],v20,18432
M v[188:191],a[168:171],a[140:143],v[188:191]
SA m0,s4,40960
C v132,v132,v133
C v133,v134,v135
M v[188:191],a[164:167],a[132:135],v[188:191]
T v[52:53],v20,20480
T v[54:55],v20,22528
M v[188:191],a[160:163],a[124:127],v[188:191]
T v[56:57],v20,24576
T v[58:59],v20,26624
M v[188:191],a[156:159],a[116:119],v[188:191]
buffer_load_dwordx4 v8, s[52:55], s25 offen lds
M v[188:191],a[152:155],a[108:111],v[188:191]
C v134,v148,v149
C v135,v150,v151
M v[188:191],a[148:151],a[100:103],v[188:191]
s_mov_b32 s25, 2359680
W a8,v132
W a9,v133
M v[188:191],a[144:147],a[236:239],v[188:191]
s_waitcnt lgkmcnt(6)
W a10,v134
W a11,v135
M v[68:71],v[32:35],a[176:179],0
SA m0,s4,45056
T a[144:145],v21,0
T a[146:147],v21,2048
M v[68:71],v[36:39],a[184:187],v[68:71]
buffer_load_dwordx4 v8, s[52:55], s25 offen lds
M v[68:71],v[40:43],a[192:195],v[68:71]
s_waitcnt lgkmcnt(2)
s_nop 0
T a[148:149],v21,4096
T a[150:151],v21,6144
M v[68:71],v[44:47],a[200:203],v[68:71]
s_mov_b32 s25, 2621824
T a[152:153],v21,8192
T a[154:155],v21,10240
M v[68:71],v[48:51],a[208:211],v[68:71]
SA m0,s4,49152
v_lshrrev_b32 v31, 6, v7
v_bfe_u32 v28, v7, 4, 2
M v[68:71],v[52:55],a[216:219],v[68:71]
T a[156:157],v21,12288
T a[158:159],v21,14336
M v[68:71],v[56:59],a[224:227],v[68:71]
T a[160:161],v21,16384
T a[162:163],v21,18432
M v[76:79],v[56:59],a[228:231],0
buffer_load_dwordx4 v8, s[52:55], s25 offen lds
M v[76:79],v[52:55],a[220:223],v[76:79]
s_nop 0
T a[164:165],v21,20480
T a[166:167],v21,22528
M v[76:79],v[48:51],a[212:215],v[76:79]
s_mov_b32 s25, 2883968
T a[168:169],v21,24576
T a[170:171],v21,26624
M v[76:79],v[44:47],a[204:207],v[76:79]
SA m0,s4,53248
v_lshlrev_b32 v31, 5, v31
v_add_lshl_u32 v31, v31, v28, 2
M v[76:79],v[40:43],a[196:199],v[76:79]
SA s3,s93,262144
buffer_load_dword v5, v31, s[8:11], s46 offen offset:4 sc1
M v[76:79],v[36:39],a[188:191],v[76:79]
buffer_load_dwordx4 v8, s[52:55], s25 offen lds
M v[76:79],v[32:35],a[180:183],v[76:79]
s_waitcnt lgkmcnt(6)
MF v140,s5,v140
MF v141,s5,v141
M v[84:87],a[144:147],a[176:179],0
s_mov_b32 s25, 3146112
T v[32:33],v22,0
T v[34:35],v22,2048
M v[84:87],a[148:151],a[184:187],v[84:87]
SA m0,s4,57344
buffer_store_dwordx4 v[128:131], v7, s[8:11], s3 offen offset:0 sc1
M v[84:87],a[152:155],a[192:195],v[84:87]
s_waitcnt lgkmcnt(2)
s_nop 0
T v[36:37],v22,4096
T v[38:39],v22,6144
M v[84:87],a[156:159],a[200:203],v[84:87]
T v[40:41],v22,8192
T v[42:43],v22,10240
M v[84:87],a[160:163],a[208:211],v[84:87]
buffer_load_dwordx4 v8, s[52:55], s25 offen lds
M v[84:87],a[164:167],a[216:219],v[84:87]
s_nop 0
T v[44:45],v22,12288
T v[46:47],v22,14336
M v[84:87],a[168:171],a[224:227],v[84:87]
s_mov_b32 s25, 3408256
T v[48:49],v22,16384
T v[50:51],v22,18432
M v[92:95],a[168:171],a[228:231],0
SA m0,s4,61440
buffer_store_dwordx4 v[136:139], v7, s[8:11], s3 offen offset:1024 sc1
M v[92:95],a[164:167],a[220:223],v[92:95]
s_nop 0
T v[52:53],v22,20480
T v[54:55],v22,22528
M v[92:95],a[160:163],a[212:215],v[92:95]
T v[56:57],v22,24576
T v[58:59],v22,26624
M v[92:95],a[156:159],a[204:207],v[92:95]
buffer_load_dwordx4 v8, s[52:55], s25 offen lds
M v[92:95],a[152:155],a[196:199],v[92:95]
MF v142,s5,v142
MF v143,s5,v143
M v[92:95],a[148:151],a[188:191],v[92:95]
buffer_store_dwordx4 v[144:147], v7, s[8:11], s3 offen offset:2048 sc1
M v[92:95],a[144:147],a[180:183],v[92:95]
s_waitcnt lgkmcnt(6)
MF v156,s5,v156
MF v157,s5,v157
M v[100:103],v[32:35],a[176:179],0
T a[144:145],v23,0
T a[146:147],v23,2048
M v[100:103],v[36:39],a[184:187],v[100:103]
buffer_store_dwordx4 v[152:155], v7, s[8:11], s3 offen offset:3072 sc1
M v[100:103],v[40:43],a[192:195],v[100:103]
s_waitcnt lgkmcnt(2)
s_nop 0
T a[148:149],v23,4096
T a[150:151],v23,6144
M v[100:103],v[44:47],a[200:203],v[100:103]
T a[152:153],v23,8192
T a[154:155],v23,10240
M v[100:103],v[48:51],a[208:211],v[100:103]
MF v158,s5,v158
MF v159,s5,v159
M v[100:103],v[52:55],a[216:219],v[100:103]
T a[156:157],v23,12288
T a[158:159],v23,14336
M v[100:103],v[56:59],a[224:227],v[100:103]
T a[160:161],v23,16384
T a[162:163],v23,18432
M v[108:111],v[56:59],a[228:231],0
C v140,v140,v141
C v141,v142,v143
M v[108:111],v[52:55],a[220:223],v[108:111]
T a[164:165],v23,20480
T a[166:167],v23,22528
M v[108:111],v[48:51],a[212:215],v[108:111]
T a[168:169],v23,24576
T a[170:171],v23,26624
M v[108:111],v[44:47],a[204:207],v[108:111]
C v142,v156,v157
C v143,v158,v159
M v[108:111],v[40:43],a[196:199],v[108:111]
W a40,v140
W a41,v141
M v[108:111],v[36:39],a[188:191],v[108:111]
W a42,v142
W a43,v143
M v[108:111],v[32:35],a[180:183],v[108:111]
s_waitcnt lgkmcnt(6)
v_mov_b32 v8, 0xff800000
MF v164,s5,v164
M v[116:119],a[144:147],a[176:179],0
T v[32:33],v20,28672
T v[34:35],v20,30720
M v[116:119],a[148:151],a[184:187],v[116:119]
MF v165,s5,v165
MF v166,s5,v166
M v[116:119],a[152:155],a[192:195],v[116:119]
s_waitcnt lgkmcnt(2)
T v[36:37],v12,24576
T v[38:39],v12,26624
M v[116:119],a[156:159],a[200:203],v[116:119]
T v[40:41],v12,28672
T v[42:43],v12,30720
M v[116:119],a[160:163],a[208:211],v[116:119]
MF v167,s5,v167
MF v180,s5,v180
M v[116:119],a[164:167],a[216:219],v[116:119]
T v[44:45],v12,0
T v[46:47],v12,2048
M v[116:119],a[168:171],a[224:227],v[116:119]
T v[48:49],v12,4096
T v[50:51],v12,6144
M v[124:127],a[168:171],a[228:231],0
MF v181,s5,v181
MF v182,s5,v182
M v[124:127],a[164:167],a[220:223],v[124:127]
T v[52:53],v12,8192
T v[54:55],v12,10240
M v[124:127],a[160:163],a[212:215],v[124:127]
T v[56:57],v12,12288
T v[58:59],v12,14336
M v[124:127],a[156:159],a[204:207],v[124:127]
MF v183,s5,v183
C v164,v164,v165
M v[124:127],a[152:155],a[196:199],v[124:127]
C v165,v166,v167
C v166,v180,v181
M v[124:127],a[148:151],a[188:191],v[124:127]
C v167,v182,v183
W a12,v164
M v[124:127],a[144:147],a[180:183],v[124:127]
s_waitcnt lgkmcnt(6)
W a13,v165
W a14,v166
M v[68:71],v[32:35],a[232:235],v[68:71]
T a[144:145],v21,28672
T a[146:147],v21,30720
M v[68:71],v[36:39],a[96:99],v[68:71]
W a15,v167
MF v172,s5,v172
M v[68:71],v[40:43],a[104:107],v[68:71]
s_waitcnt lgkmcnt(2)
T a[148:149],v13,24576
T a[150:151],v13,26624
M v[68:71],v[44:47],a[112:115],v[68:71]
T a[152:153],v13,28672
T a[154:155],v13,30720
M v[68:71],v[48:51],a[120:123],v[68:71]
MF v173,s5,v173
MF v174,s5,v174
M v[68:71],v[52:55],a[128:131],v[68:71]
T a[156:157],v13,0
T a[158:159],v13,2048
M v[68:71],v[56:59],a[136:139],v[68:71]
T a[160:161],v13,4096
T a[162:163],v13,6144
M v[76:79],v[56:59],a[140:143],v[76:79]
MF v175,s5,v175
MF v188,s5,v188
M v[76:79],v[52:55],a[132:135],v[76:79]
T a[164:165],v13,8192
T a[166:167],v13,10240
M v[76:79],v[48:51],a[124:127],v[76:79]
T a[168:169],v13,12288
T a[170:171],v13,14336
M v[76:79],v[44:47],a[116:119],v[76:79]
MF v189,s5,v189
MF v190,s5,v190
M v[76:79],v[40:43],a[108:111],v[76:79]
MF v191,s5,v191
C v172,v172,v173
M v[76:79],v[36:39],a[100:103],v[76:79]
C v173,v174,v175
C v174,v188,v189
M v[76:79],v[32:35],a[236:239],v[76:79]
s_waitcnt lgkmcnt(6)
C v175,v190,v191
W a44,v172
M v[84:87],a[144:147],a[232:235],v[84:87]
T v[32:33],v22,28672
T v[34:35],v22,30720
M v[84:87],a[148:151],a[96:99],v[84:87]
W a45,v173
W a46,v174
M v[84:87],a[152:155],a[104:107],v[84:87]
s_waitcnt lgkmcnt(2)
T v[36:37],v14,24576
T v[38:39],v14,26624
M v[84:87],a[156:159],a[112:115],v[84:87]
T v[40:41],v14,28672
T v[42:43],v14,30720
M v[84:87],a[160:163],a[120:123],v[84:87]
W a47,v175
s_waitcnt vmcnt(7)
v_cmp_ne_u32 vcc, 1, v5
M v[84:87],a[164:167],a[128:131],v[84:87]
s_nop 0
T v[44:45],v14,0
T v[46:47],v14,2048
M v[84:87],a[168:171],a[136:139],v[84:87]
s_cmp_lg_u32 vcc_lo, 0
T v[48:49],v14,4096
T v[50:51],v14,6144
M v[92:95],a[168:171],a[140:143],v[92:95]
s_cbranch_scc1 L_wsq0
L_wrq0:
M v[92:95],a[164:167],a[132:135],v[92:95]
SA m0,s28,98304
T v[52:53],v14,8192
T v[54:55],v14,10240
M v[92:95],a[160:163],a[124:127],v[92:95]
T v[56:57],v14,12288
T v[58:59],v14,14336
M v[92:95],a[156:159],a[116:119],v[92:95]
buffer_load_dwordx4 v3, s[8:11], s21 offen offset:0 sc1 lds
M v[92:95],a[152:155],a[108:111],v[92:95]
MF v68,s5,v68
MF v69,s5,v69
M v[92:95],a[148:151],a[100:103],v[92:95]
buffer_load_dwordx4 v3, s[8:11], s21 offen offset:1024 sc1 lds
M v[92:95],a[144:147],a[236:239],v[92:95]
s_waitcnt lgkmcnt(6)
MF v70,s5,v70
MF v71,s5,v71
M v[100:103],v[32:35],a[232:235],v[100:103]
T a[144:145],v23,28672
T a[146:147],v23,30720
M v[100:103],v[36:39],a[96:99],v[100:103]
buffer_load_dwordx4 v3, s[8:11], s21 offen offset:2048 sc1 lds
M v[100:103],v[40:43],a[104:107],v[100:103]
s_waitcnt lgkmcnt(2)
s_nop 0
T a[148:149],v15,24576
T a[150:151],v15,26624
M v[100:103],v[44:47],a[112:115],v[100:103]
T a[152:153],v15,28672
T a[154:155],v15,30720
M v[100:103],v[48:51],a[120:123],v[100:103]
buffer_load_dwordx4 v3, s[8:11], s21 offen offset:3072 sc1 lds
M v[100:103],v[52:55],a[128:131],v[100:103]
SA m0,s28,102400
T a[156:157],v15,0
T a[158:159],v15,2048
M v[100:103],v[56:59],a[136:139],v[100:103]
T a[160:161],v15,4096
T a[162:163],v15,6144
M v[108:111],v[56:59],a[140:143],v[108:111]
buffer_load_dwordx4 v4, s[8:11], s21 offen offset:0 sc1 lds
M v[108:111],v[52:55],a[132:135],v[108:111]
s_nop 0
T a[164:165],v15,8192
T a[166:167],v15,10240
M v[108:111],v[48:51],a[124:127],v[108:111]
T a[168:169],v15,12288
T a[170:171],v15,14336
M v[108:111],v[44:47],a[116:119],v[108:111]
buffer_load_dwordx4 v4, s[8:11], s21 offen offset:1024 sc1 lds
M v[108:111],v[40:43],a[108:111],v[108:111]
MF v84,s5,v84
MF v85,s5,v85
M v[108:111],v[36:39],a[100:103],v[108:111]
s_waitcnt vmcnt(8) lgkmcnt(0)
buffer_load_dwordx4 v4, s[8:11], s21 offen offset:2048 sc1 lds
M v[108:111],v[32:35],a[236:239],v[108:111]
s_barrier
M v[116:119],a[144:147],a[232:235],v[116:119]
s_nop 0
T v[32:33],v16,0
T v[34:35],v16,2048
M v[116:119],a[148:151],a[96:99],v[116:119]
buffer_load_dwordx4 v4, s[8:11], s21 offen offset:3072 sc1 lds
M v[116:119],a[152:155],a[104:107],v[116:119]
SA s21,s21,32768
T v[36:37],v16,4096
T v[38:39],v16,6144
M v[116:119],a[156:159],a[112:115],v[116:119]
s_sub_u32 s22, s22, 1
T v[40:41],v16,8192
T v[42:43],v16,10240
M v[116:119],a[160:163],a[120:123],v[116:119]
s_cselect_b32 s21, s23, s21
MF v86,s5,v86
MF v87,s5,v87
M v[116:119],a[164:167],a[128:131],v[116:119]
SA m0,s28,65536
T v[44:45],v16,12288
T v[46:47],v16,14336
M v[116:119],a[168:171],a[136:139],v[116:119]
T v[48:49],v16,16384
T v[50:51],v16,18432
M v[124:127],a[168:171],a[140:143],v[124:127]
buffer_load_dwordx4 v3, s[8:11], s21 offen offset:0 sc1 lds
M v[124:127],a[164:167],a[132:135],v[124:127]
s_nop 0
T v[52:53],v16,20480
T v[54:55],v16,22528
M v[124:127],a[160:163],a[124:127],v[124:127]
T v[56:57],v16,24576
T v[58:59],v16,26624
M v[124:127],a[156:159],a[116:119],v[124:127]
buffer_load_dwordx4 v3, s[8:11], s21 offen offset:1024 sc1 lds
M v[124:127],a[152:155],a[108:111],v[124:127]
buffer_load_dword v5, v31, s[8:11], s46 offen offset:4 sc1
M v[124:127],a[148:151],a[100:103],v[124:127]
buffer_load_dwordx4 v3, s[8:11], s21 offen offset:2048 sc1 lds
M v[124:127],a[144:147],a[236:239],v[124:127]
s_waitcnt lgkmcnt(6)
C v68,v68,v69
C v69,v70,v71
M v[132:135],v[32:35],a[176:179],0
T a[144:145],v17,0
T a[146:147],v17,2048
M v[132:135],v[36:39],a[184:187],v[132:135]
buffer_load_dwordx4 v3, s[8:11], s21 offen offset:3072 sc1 lds
M v[132:135],v[40:43],a[192:195],v[132:135]
s_waitcnt lgkmcnt(2)
s_nop 0
T a[148:149],v17,4096
T a[150:151],v17,6144
M v[132:135],v[44:47],a[200:203],v[132:135]
SA m0,s28,69632
T a[152:153],v17,8192
T a[154:155],v17,10240
M v[132:135],v[48:51],a[208:211],v[132:135]
buffer_load_dwordx4 v4, s[8:11], s21 offen offset:0 sc1 lds
M v[132:135],v[52:55],a[216:219],v[132:135]
s_nop 0
T a[156:157],v17,12288
T a[158:159],v17,14336
M v[132:135],v[56:59],a[224:227],v[132:135]
T a[160:161],v17,16384
T a[162:163],v17,18432
M v[140:143],v[56:59],a[228:231],0
buffer_load_dwordx4 v4, s[8:11], s21 offen offset:1024 sc1 lds
M v[140:143],v[52:55],a[220:223],v[140:143]
s_nop 0
T a[164:165],v17,20480
T a[166:167],v17,22528
M v[140:143],v[48:51],a[212:215],v[140:143]
T a[168:169],v17,24576
T a[170:171],v17,26624
M v[140:143],v[44:47],a[204:207],v[140:143]
SA s3,s93,270336
buffer_load_dwordx4 v4, s[8:11], s21 offen offset:2048 sc1 lds
M v[140:143],v[40:43],a[196:199],v[140:143]
C v70,v84,v85
C v71,v86,v87
M v[140:143],v[36:39],a[188:191],v[140:143]
buffer_load_dwordx4 v4, s[8:11], s21 offen offset:3072 sc1 lds
M v[140:143],v[32:35],a[180:183],v[140:143]
s_waitcnt lgkmcnt(6)
W a16,v68
W a17,v69
M v[148:151],a[144:147],a[176:179],0
SA s21,s21,32768
T v[32:33],v18,0
T v[34:35],v18,2048
M v[148:151],a[148:151],a[184:187],v[148:151]
s_sub_u32 s22, s22, 1
buffer_store_dwordx4 v[160:163], v7, s[8:11], s3 offen offset:0 sc1
M v[148:151],a[152:155],a[192:195],v[148:151]
s_waitcnt lgkmcnt(2)
s_nop 0
T v[36:37],v18,4096
T v[38:39],v18,6144
M v[148:151],a[156:159],a[200:203],v[148:151]
s_cselect_b32 s21, s23, s21
T v[40:41],v18,8192
T v[42:43],v18,10240
M v[148:151],a[160:163],a[208:211],v[148:151]
buffer_store_dwordx4 v[168:171], v7, s[8:11], s3 offen offset:1024 sc1
M v[148:151],a[164:167],a[216:219],v[148:151]
s_nop 0
T v[44:45],v18,12288
T v[46:47],v18,14336
M v[148:151],a[168:171],a[224:227],v[148:151]
T v[48:49],v18,16384
T v[50:51],v18,18432
M v[156:159],a[168:171],a[228:231],0
buffer_store_dwordx4 v[176:179], v7, s[8:11], s3 offen offset:2048 sc1
M v[156:159],a[164:167],a[220:223],v[156:159]
s_nop 0
T v[52:53],v18,20480
T v[54:55],v18,22528
M v[156:159],a[160:163],a[212:215],v[156:159]
T v[56:57],v18,24576
T v[58:59],v18,26624
M v[156:159],a[156:159],a[204:207],v[156:159]
buffer_store_dwordx4 v[184:187], v7, s[8:11], s3 offen offset:3072 sc1
M v[156:159],a[152:155],a[196:199],v[156:159]
W a18,v70
W a19,v71
M v[156:159],a[148:151],a[188:191],v[156:159]
MF v76,s5,v76
MF v77,s5,v77
M v[156:159],a[144:147],a[180:183],v[156:159]
s_waitcnt lgkmcnt(6)
MF v78,s5,v78
MF v79,s5,v79
M v[164:167],v[32:35],a[176:179],0
T a[144:145],v19,0
T a[146:147],v19,2048
M v[164:167],v[36:39],a[184:187],v[164:167]
MF v92,s5,v92
MF v93,s5,v93
M v[164:167],v[40:43],a[192:195],v[164:167]
s_waitcnt lgkmcnt(2)
T a[148:149],v19,4096
T a[150:151],v19,6144
M v[164:167],v[44:47],a[200:203],v[164:167]
T a[152:153],v19,8192
T a[154:155],v19,10240
M v[164:167],v[48:51],a[208:211],v[164:167]
MF v94,s5,v94
MF v95,s5,v95
M v[164:167],v[52:55],a[216:219],v[164:167]
T a[156:157],v19,12288
T a[158:159],v19,14336
M v[164:167],v[56:59],a[224:227],v[164:167]
T a[160:161],v19,16384
T a[162:163],v19,18432
M v[172:175],v[56:59],a[228:231],0
C v76,v76,v77
C v77,v78,v79
M v[172:175],v[52:55],a[220:223],v[172:175]
T a[164:165],v19,20480
T a[166:167],v19,22528
M v[172:175],v[48:51],a[212:215],v[172:175]
T a[168:169],v19,24576
T a[170:171],v19,26624
M v[172:175],v[44:47],a[204:207],v[172:175]
C v78,v92,v93
C v79,v94,v95
M v[172:175],v[40:43],a[196:199],v[172:175]
W a48,v76
W a49,v77
M v[172:175],v[36:39],a[188:191],v[172:175]
W a50,v78
W a51,v79
M v[172:175],v[32:35],a[180:183],v[172:175]
s_waitcnt lgkmcnt(6)
v_mov_b32 v30, 2
MF v100,s5,v100
M v[180:183],a[144:147],a[176:179],0
T v[32:33],v16,28672
T v[34:35],v16,30720
M v[180:183],a[148:151],a[184:187],v[180:183]
buffer_store_dword v30, v1, s[8:11], s45 offen sc1
M v[180:183],a[152:155],a[192:195],v[180:183]
s_waitcnt lgkmcnt(2)
s_nop 0
T v[36:37],v16,40960
T v[38:39],v16,43008
M v[180:183],a[156:159],a[200:203],v[180:183]
T v[40:41],v16,45056
T v[42:43],v16,47104
M v[180:183],a[160:163],a[208:211],v[180:183]
MF v101,s5,v101
MF v102,s5,v102
M v[180:183],a[164:167],a[216:219],v[180:183]
T v[44:45],v16,49152
T v[46:47],v16,51200
M v[180:183],a[168:171],a[224:227],v[180:183]
T v[48:49],v16,53248
T v[50:51],v16,55296
M v[188:191],a[168:171],a[228:231],0
MF v103,s5,v103
MF v116,s5,v116
M v[188:191],a[164:167],a[220:223],v[188:191]
T v[52:53],v16,57344
T v[54:55],v16,59392
M v[188:191],a[160:163],a[212:215],v[188:191]
T v[56:57],v16,61440
T v[58:59],v16,63488
M v[188:191],a[156:159],a[204:207],v[188:191]
MF v117,s5,v117
MF v118,s5,v118
M v[188:191],a[152:155],a[196:199],v[188:191]
MF v119,s5,v119
C v100,v100,v101
M v[188:191],a[148:151],a[188:191],v[188:191]
C v101,v102,v103
C v102,v116,v117
M v[188:191],a[144:147],a[180:183],v[188:191]
s_waitcnt lgkmcnt(6)
C v103,v118,v119
W a20,v100
M v[132:135],v[32:35],a[232:235],v[132:135]
T a[144:145],v17,28672
T a[146:147],v17,30720
M v[132:135],v[36:39],a[96:99],v[132:135]
W a21,v101
W a22,v102
M v[132:135],v[40:43],a[104:107],v[132:135]
s_waitcnt lgkmcnt(2)
T a[148:149],v17,40960
T a[150:151],v17,43008
M v[132:135],v[44:47],a[112:115],v[132:135]
T a[152:153],v17,45056
T a[154:155],v17,47104
M v[132:135],v[48:51],a[120:123],v[132:135]
W a23,v103
MF v108,s5,v108
M v[132:135],v[52:55],a[128:131],v[132:135]
T a[156:157],v17,49152
T a[158:159],v17,51200
M v[132:135],v[56:59],a[136:139],v[132:135]
T a[160:161],v17,53248
T a[162:163],v17,55296
M v[140:143],v[56:59],a[140:143],v[140:143]
MF v109,s5,v109
MF v110,s5,v110
M v[140:143],v[52:55],a[132:135],v[140:143]
T a[164:165],v17,57344
T a[166:167],v17,59392
M v[140:143],v[48:51],a[124:127],v[140:143]
T a[168:169],v17,61440
T a[170:171],v17,63488
M v[140:143],v[44:47],a[116:119],v[140:143]
MF v111,s5,v111
MF v124,s5,v124
M v[140:143],v[40:43],a[108:111],v[140:143]
MF v125,s5,v125
MF v126,s5,v126
M v[140:143],v[36:39],a[100:103],v[140:143]
MF v127,s5,v127
C v108,v108,v109
M v[140:143],v[32:35],a[236:239],v[140:143]
s_waitcnt lgkmcnt(6)
C v109,v110,v111
C v110,v124,v125
M v[148:151],a[144:147],a[232:235],v[148:151]
T v[32:33],v18,28672
T v[34:35],v18,30720
M v[148:151],a[148:151],a[96:99],v[148:151]
C v111,v126,v127
W a52,v108
M v[148:151],a[152:155],a[104:107],v[148:151]
s_waitcnt lgkmcnt(2)
T v[36:37],v18,40960
T v[38:39],v18,43008
M v[148:151],a[156:159],a[112:115],v[148:151]
T v[40:41],v18,45056
T v[42:43],v18,47104
M v[148:151],a[160:163],a[120:123],v[148:151]
W a53,v109
W a54,v110
M v[148:151],a[164:167],a[128:131],v[148:151]
T v[44:45],v18,49152
T v[46:47],v18,51200
M v[148:151],a[168:171],a[136:139],v[148:151]
T v[48:49],v18,53248
T v[50:51],v18,55296
M v[156:159],a[168:171],a[140:143],v[156:159]
W a55,v111
s_waitcnt vmcnt(11)
v_cmp_ne_u32 vcc, 1, v5
M v[156:159],a[164:167],a[132:135],v[156:159]
s_nop 0
T v[52:53],v18,57344
T v[54:55],v18,59392
M v[156:159],a[160:163],a[124:127],v[156:159]
s_cmp_lg_u32 vcc_hi, 0
T v[56:57],v18,61440
T v[58:59],v18,63488
M v[156:159],a[156:159],a[116:119],v[156:159]
s_cbranch_scc1 L_wsr0
L_wrr0:
MF v132,s5,v132
MF v133,s5,v133
M v[156:159],a[152:155],a[108:111],v[156:159]
SA m0,s28,131072
MF v134,s5,v134
MF v135,s5,v135
M v[156:159],a[148:151],a[100:103],v[156:159]
buffer_load_dwordx4 v3, s[8:11], s26 offen offset:0 sc1 lds
M v[156:159],a[144:147],a[236:239],v[156:159]
s_waitcnt lgkmcnt(6)
MF v148,s5,v148
MF v149,s5,v149
M v[164:167],v[32:35],a[232:235],v[164:167]
T a[144:145],v19,28672
T a[146:147],v19,30720
M v[164:167],v[36:39],a[96:99],v[164:167]
buffer_load_dwordx4 v3, s[8:11], s26 offen offset:1024 sc1 lds
M v[164:167],v[40:43],a[104:107],v[164:167]
s_waitcnt lgkmcnt(2)
s_nop 0
T a[148:149],v19,40960
T a[150:151],v19,43008
M v[164:167],v[44:47],a[112:115],v[164:167]
T a[152:153],v19,45056
T a[154:155],v19,47104
M v[164:167],v[48:51],a[120:123],v[164:167]
buffer_load_dwordx4 v3, s[8:11], s26 offen offset:2048 sc1 lds
M v[164:167],v[52:55],a[128:131],v[164:167]
s_nop 0
T a[156:157],v19,49152
T a[158:159],v19,51200
M v[164:167],v[56:59],a[136:139],v[164:167]
T a[160:161],v19,53248
T a[162:163],v19,55296
M v[172:175],v[56:59],a[140:143],v[172:175]
buffer_load_dwordx4 v3, s[8:11], s26 offen offset:3072 sc1 lds
M v[172:175],v[52:55],a[132:135],v[172:175]
SA m0,s28,135168
T a[164:165],v19,57344
T a[166:167],v19,59392
M v[172:175],v[48:51],a[124:127],v[172:175]
T a[168:169],v19,61440
T a[170:171],v19,63488
M v[172:175],v[44:47],a[116:119],v[172:175]
buffer_load_dwordx4 v4, s[8:11], s26 offen offset:0 sc1 lds
M v[172:175],v[40:43],a[108:111],v[172:175]
MF v150,s5,v150
MF v151,s5,v151
M v[172:175],v[36:39],a[100:103],v[172:175]
s_waitcnt lgkmcnt(0)
buffer_load_dwordx4 v4, s[8:11], s26 offen offset:1024 sc1 lds
M v[172:175],v[32:35],a[236:239],v[172:175]
s_barrier
M v[180:183],a[144:147],a[232:235],v[180:183]
R a[64:67],v2,32768
R a[68:71],v2,33792
M v[180:183],a[148:151],a[96:99],v[180:183]
buffer_load_dwordx4 v4, s[8:11], s26 offen offset:2048 sc1 lds
M v[180:183],a[152:155],a[104:107],v[180:183]
C v132,v132,v133
C v133,v134,v135
M v[180:183],a[156:159],a[112:115],v[180:183]
R a[72:75],v2,34816
R a[76:79],v2,35840
M v[180:183],a[160:163],a[120:123],v[180:183]
buffer_load_dwordx4 v4, s[8:11], s26 offen offset:3072 sc1 lds
M v[180:183],a[164:167],a[128:131],v[180:183]
SA s26,s26,32768
C v134,v148,v149
C v135,v150,v151
M v[180:183],a[168:171],a[136:139],v[180:183]
R a[80:83],v2,36864
R a[84:87],v2,37888
M v[188:191],a[168:171],a[140:143],v[188:191]
W a24,v132
W a25,v133
M v[188:191],a[164:167],a[132:135],v[188:191]
W a26,v134
W a27,v135
M v[188:191],a[160:163],a[124:127],v[188:191]
R a[88:91],v2,38912
R a[92:95],v2,39936
M v[188:191],a[156:159],a[116:119],v[188:191]
MF v140,s5,v140
MF v141,s5,v141
M v[188:191],a[152:155],a[108:111],v[188:191]
MF v142,s5,v142
MF v143,s5,v143
M v[188:191],a[148:151],a[100:103],v[188:191]
MF v156,s5,v156
MF v157,s5,v157
M v[188:191],a[144:147],a[236:239],v[188:191]
s_waitcnt lgkmcnt(0)
MF v158,s5,v158
MF v159,s5,v159
C v140,v140,v141
C v141,v142,v143
C v142,v156,v157
C v143,v158,v159
W a56,v140
W a57,v141
W a58,v142
W a59,v143
s_cmp_eq_u32 s42, 0
s_cbranch_scc1 L_j0
M v[64:67],a[64:67],a[0:3],0
R a[96:99],v2,40960
R a[100:103],v2,41984
M v[64:67],a[68:71],a[4:7],v[64:67]
MF v164,s5,v164
MF v165,s5,v165
M v[64:67],a[72:75],a[8:11],v[64:67]
MF v166,s5,v166
MF v167,s5,v167
M v[64:67],a[76:79],a[12:15],v[64:67]
R a[104:107],v2,43008
R a[108:111],v2,44032
M v[64:67],a[80:83],a[16:19],v[64:67]
MF v180,s5,v180
MF v181,s5,v181
MF v182,s5,v182
MF v183,s5,v183
C v164,v164,v165
C v165,v166,v167
C v166,v180,v181
C v167,v182,v183
W a28,v164
W a29,v165
W a30,v166
W a31,v167
M v[64:67],a[84:87],a[20:23],v[64:67]
MF v172,s5,v172
MF v173,s5,v173
M v[64:67],a[88:91],a[24:27],v[64:67]
R a[112:115],v2,45056
R a[116:119],v2,46080
M v[64:67],a[92:95],a[28:31],v[64:67]
MF v174,s5,v174
MF v175,s5,v175
M v[68:71],a[64:67],a[32:35],0
MF v188,s5,v188
MF v189,s5,v189
M v[68:71],a[68:71],a[36:39],v[68:71]
R a[120:123],v2,47104
R a[124:127],v2,48128
M v[68:71],a[72:75],a[40:43],v[68:71]
SA m0,s28,32768
MF v190,s5,v190
MF v191,s5,v191
M v[68:71],a[76:79],a[44:47],v[68:71]
SA s3,s93,786432
buffer_load_dwordx4 v3, s[8:11], s26 offen offset:0 sc1 lds
M v[68:71],a[80:83],a[48:51],v[68:71]
C v172,v172,v173
C v173,v174,v175
C v174,v188,v189
C v175,v190,v191
W a60,v172
W a61,v173
W a62,v174
W a63,v175
M v[68:71],a[84:87],a[52:55],v[68:71]
E v18,v64
M v[68:71],a[88:91],a[56:59],v[68:71]
buffer_store_dwordx4 v[192:195], v7, s[8:11], s3 offen offset:0 sc1
M v[68:71],a[92:95],a[60:63],v[68:71]
s_waitcnt lgkmcnt(0)
E v19,v65
M v[72:75],a[96:99],a[0:3],0
R a[64:67],v2,49152
R a[68:71],v2,50176
M v[72:75],a[100:103],a[4:7],v[72:75]
buffer_load_dwordx4 v3, s[8:11], s26 offen offset:1024 sc1 lds
M v[72:75],a[104:107],a[8:11],v[72:75]
E v20,v66
M v[72:75],a[108:111],a[12:15],v[72:75]
R a[72:75],v2,51200
R a[76:79],v2,52224
M v[72:75],a[112:115],a[16:19],v[72:75]
buffer_load_dwordx4 v3, s[8:11], s26 offen offset:2048 sc1 lds
M v[72:75],a[116:119],a[20:23],v[72:75]
E v21,v67
M v[72:75],a[120:123],a[24:27],v[72:75]
R a[80:83],v2,53248
R a[84:87],v2,54272
M v[72:75],a[124:127],a[28:31],v[72:75]
buffer_load_dwordx4 v3, s[8:11], s26 offen offset:3072 sc1 lds
M v[76:79],a[124:127],a[60:63],0
SA m0,s28,36864
E v22,v68
M v[76:79],a[120:123],a[56:59],v[76:79]
R a[88:91],v2,55296
R a[92:95],v2,56320
M v[76:79],a[116:119],a[52:55],v[76:79]
buffer_load_dwordx4 v4, s[8:11], s26 offen offset:0 sc1 lds
M v[76:79],a[112:115],a[48:51],v[76:79]
E v23,v69
M v[76:79],a[108:111],a[44:47],v[76:79]
AF v26,v18,v19
C v40,v18,v19
M v[76:79],a[104:107],a[40:43],v[76:79]
buffer_load_dwordx4 v4, s[8:11], s26 offen offset:1024 sc1 lds
M v[76:79],a[100:103],a[36:39],v[76:79]
v_add_u32 v16, 0x20000, v7
AF v26,v20,v26
M v[76:79],a[96:99],a[32:35],v[76:79]
s_waitcnt lgkmcnt(0)
E v24,v70
M v[80:83],a[64:67],a[0:3],0
R a[96:99],v2,57344
R a[100:103],v2,58368
M v[80:83],a[68:71],a[4:7],v[80:83]
buffer_load_dwordx4 v4, s[8:11], s26 offen offset:2048 sc1 lds
M v[80:83],a[72:75],a[8:11],v[80:83]
E v25,v71
M v[80:83],a[76:79],a[12:15],v[80:83]
R a[104:107],v2,59392
R a[108:111],v2,60416
M v[80:83],a[80:83],a[16:19],v[80:83]
buffer_store_dwordx4 v[200:203], v7, s[8:11], s3 offen offset:1024 sc1
M v[80:83],a[84:87],a[20:23],v[80:83]
E v18,v72
M v[80:83],a[88:91],a[24:27],v[80:83]
R a[112:115],v2,61440
R a[116:119],v2,62464
M v[80:83],a[92:95],a[28:31],v[80:83]
buffer_load_dwordx4 v4, s[8:11], s26 offen offset:3072 sc1 lds
M v[84:87],a[92:95],a[60:63],0
SA s26,s26,32768
E v19,v73
M v[84:87],a[88:91],a[56:59],v[84:87]
R a[120:123],v2,63488
R a[124:127],v2,64512
M v[84:87],a[84:87],a[52:55],v[84:87]
C v41,v20,v21
AF v26,v21,v26
M v[84:87],a[80:83],a[48:51],v[84:87]
buffer_store_dwordx4 v[208:211], v7, s[8:11], s3 offen offset:2048 sc1
M v[84:87],a[76:79],a[44:47],v[84:87]
E v20,v74
M v[84:87],a[72:75],a[40:43],v[84:87]
AF v27,v22,v23
C v44,v22,v23
M v[84:87],a[68:71],a[36:39],v[84:87]
s_waitcnt vmcnt(24) lgkmcnt(0)
E v21,v75
M v[84:87],a[64:67],a[32:35],v[84:87]
s_barrier
M v[88:91],a[96:99],a[0:3],0
R a[64:67],v2,0
R a[68:71],v2,1024
M v[88:91],a[100:103],a[4:7],v[88:91]
E v22,v76
M v[88:91],a[104:107],a[8:11],v[88:91]
AF v27,v24,v27
C v45,v24,v25
M v[88:91],a[108:111],a[12:15],v[88:91]
R a[72:75],v2,2048
R a[76:79],v2,3072
M v[88:91],a[112:115],a[16:19],v[88:91]
E v23,v77
M v[88:91],a[116:119],a[20:23],v[88:91]
AF v27,v25,v27
AF v26,v18,v26
M v[88:91],a[120:123],a[24:27],v[88:91]
R a[80:83],v2,4096
R a[84:87],v2,5120
M v[88:91],a[124:127],a[28:31],v[88:91]
E v24,v78
M v[92:95],a[124:127],a[60:63],0
C v42,v18,v19
AF v26,v19,v26
M v[92:95],a[120:123],a[56:59],v[92:95]
R a[88:91],v2,6144
R a[92:95],v2,7168
M v[92:95],a[116:119],a[52:55],v[92:95]
E v25,v79
M v[92:95],a[112:115],a[48:51],v[92:95]
AF v26,v20,v26
C v43,v20,v21
M v[92:95],a[108:111],a[44:47],v[92:95]
AF v26,v21,v26
AF v27,v22,v27
M v[92:95],a[104:107],a[40:43],v[92:95]
C v46,v22,v23
AF v27,v23,v27
M v[92:95],a[100:103],a[36:39],v[92:95]
s_waitcnt lgkmcnt(0)
AF v27,v24,v27
C v47,v24,v25
M v[92:95],a[96:99],a[32:35],v[92:95]
AF v27,v25,v27
M v[96:99],a[64:67],a[0:3],0
R a[96:99],v2,8192
R a[100:103],v2,9216
M v[96:99],a[68:71],a[4:7],v[96:99]
SA m0,s28,98304
E v18,v80
M v[96:99],a[72:75],a[8:11],v[96:99]
buffer_load_dwordx4 v3, s[8:11], s21 offen offset:0 sc1 lds
M v[96:99],a[76:79],a[12:15],v[96:99]
R a[104:107],v2,10240
R a[108:111],v2,11264
M v[96:99],a[80:83],a[16:19],v[96:99]
v_mov_b32 v30, 0
M v[96:99],a[84:87],a[20:23],v[96:99]
E v19,v81
M v[96:99],a[88:91],a[24:27],v[96:99]
R a[112:115],v2,12288
R a[116:119],v2,13312
M v[96:99],a[92:95],a[28:31],v[96:99]
buffer_load_dwordx4 v3, s[8:11], s21 offen offset:1024 sc1 lds
M v[100:103],a[92:95],a[60:63],0
v_mov_b32 v31, 0
AF v26,v18,v26
M v[100:103],a[88:91],a[56:59],v[100:103]
R a[120:123],v2,14336
R a[124:127],v2,15360
M v[100:103],a[84:87],a[52:55],v[100:103]
SA s3,s93,786432
E v20,v82
M v[100:103],a[80:83],a[48:51],v[100:103]
buffer_load_dwordx4 v3, s[8:11], s21 offen offset:2048 sc1 lds
M v[100:103],a[76:79],a[44:47],v[100:103]
E v21,v83
M v[100:103],a[72:75],a[40:43],v[100:103]
v_mov_b32 v32, 0
C v56,v18,v19
M v[100:103],a[68:71],a[36:39],v[100:103]
buffer_store_dwordx4 v[216:219], v7, s[8:11], s3 offen offset:3072 sc1
M v[100:103],a[64:67],a[32:35],v[100:103]
s_waitcnt lgkmcnt(0)
E v22,v88
M v[108:111],a[96:99],a[32:35],0
R a[64:67],v2,16384
R a[68:71],v2,17408
M v[108:111],a[100:103],a[36:39],v[108:111]
buffer_load_dwordx4 v3, s[8:11], s21 offen offset:3072 sc1 lds
M v[108:111],a[104:107],a[40:43],v[108:111]
SA m0,s28,102400
v_mov_b32 v33, 0
AF v26,v19,v26
M v[108:111],a[108:111],a[44:47],v[108:111]
R a[72:75],v2,18432
R a[76:79],v2,19456
M v[108:111],a[112:115],a[48:51],v[108:111]
buffer_load_dwordx4 v4, s[8:11], s21 offen offset:0 sc1 lds
M v[108:111],a[116:119],a[52:55],v[108:111]
E v23,v89
M v[108:111],a[120:123],a[56:59],v[108:111]
R a[80:83],v2,20480
R a[84:87],v2,21504
M v[108:111],a[124:127],a[60:63],v[108:111]
buffer_load_dwordx4 v4, s[8:11], s21 offen offset:1024 sc1 lds
M v[104:107],a[124:127],a[28:31],0
v_mov_b32 v34, 0
AF v26,v20,v26
M v[104:107],a[120:123],a[24:27],v[104:107]
SA s3,s93,794624
R a[88:91],v2,22528
R a[92:95],v2,23552
M v[104:107],a[116:119],a[20:23],v[104:107]
buffer_load_dwordx4 v4, s[8:11], s21 offen offset:2048 sc1 lds
M v[104:107],a[112:115],a[16:19],v[104:107]
v_mov_b32 v35, 0
C v57,v20,v21
M v[104:107],a[108:111],a[12:15],v[104:107]
E v24,v90
M v[104:107],a[104:107],a[8:11],v[104:107]
E v25,v91
M v[104:107],a[100:103],a[4:7],v[104:107]
buffer_load_dwordx4 v4, s[8:11], s21 offen offset:3072 sc1 lds
M v[104:107],a[96:99],a[0:3],v[104:107]
s_waitcnt lgkmcnt(0)
v_mov_b32 v36, 0
AF v26,v21,v26
M v[112:115],a[64:67],a[0:3],0
SA s21,s21,32768
R a[96:99],v2,24576
R a[100:103],v2,25600
M v[112:115],a[68:71],a[4:7],v[112:115]
s_sub_u32 s22, s22, 1
buffer_store_dwordx4 v[224:227], v7, s[8:11], s3 offen offset:0 sc1
M v[112:115],a[72:75],a[8:11],v[112:115]
s_cselect_b32 s21, s23, s21
E v18,v84
M v[112:115],a[76:79],a[12:15],v[112:115]
R a[104:107],v2,26624
R a[108:111],v2,27648
M v[112:115],a[80:83],a[16:19],v[112:115]
v_mov_b32 v37, 0
AF v26,v22,v26
M v[112:115],a[84:87],a[20:23],v[112:115]
E v19,v85
M v[112:115],a[88:91],a[24:27],v[112:115]
R a[112:115],v2,28672
R a[116:119],v2,29696
M v[112:115],a[92:95],a[28:31],v[112:115]
E v20,v86
M v[116:119],a[92:95],a[60:63],0
v_mov_b32 v38, 0
C v58,v22,v23
M v[116:119],a[88:91],a[56:59],v[116:119]
R a[120:123],v2,30720
R a[124:127],v2,31744
M v[116:119],a[84:87],a[52:55],v[116:119]
E v21,v87
M v[116:119],a[80:83],a[48:51],v[116:119]
buffer_store_dwordx4 v[232:235], v7, s[8:11], s3 offen offset:1024 sc1
M v[116:119],a[76:79],a[44:47],v[116:119]
AF v26,v23,v26
AF v26,v24,v26
M v[116:119],a[72:75],a[40:43],v[116:119]
v_mov_b32 v39, 0
C v59,v24,v25
M v[116:119],a[68:71],a[36:39],v[116:119]
s_waitcnt vmcnt(22) lgkmcnt(0)
E v22,v92
M v[116:119],a[64:67],a[32:35],v[116:119]
s_barrier
M v[124:127],a[96:99],a[32:35],0
R a[64:67],v16,0
R a[68:71],v16,1024
M v[124:127],a[100:103],a[36:39],v[124:127]
E v23,v93
M v[124:127],a[104:107],a[40:43],v[124:127]
AF v26,v25,v26
AF v27,v18,v27
M v[124:127],a[108:111],a[44:47],v[124:127]
R a[72:75],v16,2048
R a[76:79],v16,3072
M v[124:127],a[112:115],a[48:51],v[124:127]
E v24,v94
M v[124:127],a[116:119],a[52:55],v[124:127]
E v25,v95
M v[124:127],a[120:123],a[56:59],v[124:127]
R a[80:83],v16,4096
R a[84:87],v16,5120
M v[124:127],a[124:127],a[60:63],v[124:127]
C v60,v18,v19
AF v27,v19,v27
M v[120:123],a[124:127],a[28:31],0
AF v27,v20,v27
C v61,v20,v21
M v[120:123],a[120:123],a[24:27],v[120:123]
R a[88:91],v16,6144
R a[92:95],v16,7168
M v[120:123],a[116:119],a[20:23],v[120:123]
AF v27,v21,v27
AF v27,v22,v27
M v[120:123],a[112:115],a[16:19],v[120:123]
C v62,v22,v23
AF v27,v23,v27
M v[120:123],a[108:111],a[12:15],v[120:123]
AF v27,v24,v27
C v63,v24,v25
M v[120:123],a[104:107],a[8:11],v[120:123]
AF v27,v25,v27
M v[120:123],a[100:103],a[4:7],v[120:123]
s_waitcnt lgkmcnt(0)
M v[120:123],a[96:99],a[0:3],v[120:123]
v_max_f32 v10, v26, v27
v_min_f32 v11, v26, v27
v_cmp_lt_f32 vcc, s31, v10
v_cmp_gt_f32 s[64:65], s24, v11
s_nop 0
s_or_b64 vcc, vcc, s[64:65]
s_cbranch_vccnz L_stk1
L_rtk1:
M v[128:131],a[64:67],v[40:43],0
R a[96:99],v16,8192
R a[100:103],v16,9216
M v[128:131],a[68:71],v[56:59],v[128:131]
SA m0,s28,65536
E v18,v96
M v[132:135],a[68:71],v[60:63],0
buffer_load_dwordx4 v3, s[8:11], s21 offen offset:0 sc1 lds
M v[132:135],a[64:67],v[44:47],v[132:135]
R a[104:107],v16,10240
R a[108:111],v16,11264
M v[140:143],a[72:75],v[44:47],0
SA s3,s93,794624
E v19,v97
M v[140:143],a[76:79],v[60:63],v[140:143]
AF v30,v26,v30
AF v31,v27,v31
M v[136:139],a[76:79],v[56:59],0
R a[112:115],v16,12288
R a[116:119],v16,13312
M v[136:139],a[72:75],v[40:43],v[136:139]
buffer_load_dwordx4 v3, s[8:11], s21 offen offset:1024 sc1 lds
M v[144:147],a[80:83],v[40:43],0
E v20,v98
M v[144:147],a[84:87],v[56:59],v[144:147]
R a[120:123],v16,14336
R a[124:127],v16,15360
M v[148:151],a[84:87],v[60:63],0
buffer_store_dwordx4 v[240:243], v7, s[8:11], s3 offen offset:2048 sc1
M v[148:151],a[80:83],v[44:47],v[148:151]
E v21,v99
M v[156:159],a[88:91],v[44:47],0
AF v28,v18,v19
C v48,v18,v19
M v[156:159],a[92:95],v[60:63],v[156:159]
buffer_load_dwordx4 v3, s[8:11], s21 offen offset:2048 sc1 lds
M v[152:155],a[92:95],v[56:59],0
AF v28,v20,v28
C v49,v20,v21
M v[152:155],a[88:91],v[40:43],v[152:155]
s_waitcnt lgkmcnt(0)
E v22,v104
M v[160:163],a[96:99],v[40:43],0
R a[64:67],v16,16384
R a[68:71],v16,17408
M v[160:163],a[100:103],v[56:59],v[160:163]
buffer_load_dwordx4 v3, s[8:11], s21 offen offset:3072 sc1 lds
M v[164:167],a[100:103],v[60:63],0
SA m0,s28,69632
E v23,v105
M v[164:167],a[96:99],v[44:47],v[164:167]
R a[72:75],v16,18432
R a[76:79],v16,19456
M v[172:175],a[104:107],v[44:47],0
buffer_load_dwordx4 v4, s[8:11], s21 offen offset:0 sc1 lds
M v[172:175],a[108:111],v[60:63],v[172:175]
AF v28,v21,v28
AF v28,v22,v28
M v[168:171],a[108:111],v[56:59],0
R a[80:83],v16,20480
R a[84:87],v16,21504
M v[168:171],a[104:107],v[40:43],v[168:171]
buffer_store_dwordx4 v[248:251], v7, s[8:11], s3 offen offset:3072 sc1
M v[176:179],a[112:115],v[40:43],0
E v24,v106
M v[176:179],a[116:119],v[56:59],v[176:179]
R a[88:91],v16,22528
R a[92:95],v16,23552
M v[180:183],a[116:119],v[60:63],0
buffer_load_dwordx4 v4, s[8:11], s21 offen offset:1024 sc1 lds
M v[180:183],a[112:115],v[44:47],v[180:183]
E v25,v107
M v[188:191],a[120:123],v[44:47],0
C v50,v22,v23
AF v28,v23,v28
M v[188:191],a[124:127],v[60:63],v[188:191]
buffer_load_dwordx4 v4, s[8:11], s21 offen offset:2048 sc1 lds
M v[184:187],a[124:127],v[56:59],0
E v18,v100
M v[184:187],a[120:123],v[40:43],v[184:187]
s_waitcnt lgkmcnt(0)
AF v28,v24,v28
C v51,v24,v25
M v[192:195],a[64:67],v[40:43],0
R a[96:99],v16,24576
R a[100:103],v16,25600
M v[192:195],a[68:71],v[56:59],v[192:195]
buffer_load_dwordx4 v4, s[8:11], s21 offen offset:3072 sc1 lds
M v[196:199],a[68:71],v[60:63],0
SA s21,s21,32768
E v19,v101
M v[196:199],a[64:67],v[44:47],v[196:199]
s_sub_u32 s22, s22, 1
R a[104:107],v16,26624
R a[108:111],v16,27648
M v[204:207],a[72:75],v[44:47],0
s_cselect_b32 s21, s23, s21
AF v28,v25,v28
AF v29,v18,v19
M v[204:207],a[76:79],v[60:63],v[204:207]
E v20,v102
M v[200:203],a[76:79],v[56:59],0
R a[112:115],v16,28672
R a[116:119],v16,29696
M v[200:203],a[72:75],v[40:43],v[200:203]
C v52,v18,v19
M v[208:211],a[80:83],v[40:43],0
M v[208:211],a[84:87],v[56:59],v[208:211]
R a[120:123],v16,30720
R a[124:127],v16,31744
M v[212:215],a[84:87],v[60:63],0
E v21,v103
M v[212:215],a[80:83],v[44:47],v[212:215]
AF v29,v20,v29
C v53,v20,v21
M v[220:223],a[88:91],v[44:47],0
AF v29,v21,v29
M v[220:223],a[92:95],v[60:63],v[220:223]
E v22,v108
M v[216:219],a[92:95],v[56:59],0
s_waitcnt vmcnt(12) lgkmcnt(0)
M v[216:219],a[88:91],v[40:43],v[216:219]
s_barrier
M v[224:227],a[96:99],v[40:43],0
R a[64:67],v2,32768
R a[68:71],v2,33792
M v[224:227],a[100:103],v[56:59],v[224:227]
E v23,v109
M v[228:231],a[100:103],v[60:63],0
AF v29,v22,v29
C v54,v22,v23
M v[228:231],a[96:99],v[44:47],v[228:231]
R a[72:75],v2,34816
R a[76:79],v2,35840
M v[236:239],a[104:107],v[44:47],0
E v24,v110
M v[236:239],a[108:111],v[60:63],v[236:239]
AF v29,v23,v29
M v[232:235],a[108:111],v[56:59],0
R a[80:83],v2,36864
R a[84:87],v2,37888
M v[232:235],a[104:107],v[40:43],v[232:235]
M v[240:243],a[112:115],v[40:43],0
E v25,v111
M v[240:243],a[116:119],v[56:59],v[240:243]
R a[88:91],v2,38912
R a[92:95],v2,39936
M v[244:247],a[116:119],v[60:63],0
AF v29,v24,v29
C v55,v24,v25
M v[244:247],a[112:115],v[44:47],v[244:247]
AF v29,v25,v29
M v[252:255],a[120:123],v[44:47],0
M v[252:255],a[124:127],v[60:63],v[252:255]
M v[248:251],a[124:127],v[56:59],0
s_waitcnt lgkmcnt(0)
M v[248:251],a[120:123],v[40:43],v[248:251]
s_cmp_lg_u32 s27, 0
s_cbranch_scc1 L_loop_top
s_branch L_d1s
L_j0:
M v[68:71],a[64:67],a[32:35],0
s_cmp_lt_u32 s20, 0
R a[96:99],v2,40960
R a[100:103],v2,41984
M v[68:71],a[68:71],a[36:39],v[68:71]
s_cselect_b64 s[82:83], -1, 0
v_mov_b32 v30, 0
MF v172,s5,v172
M v[68:71],a[72:75],a[40:43],v[68:71]
s_cmp_eq_u32 s20, 0
MF v173,s5,v173
MF v174,s5,v174
M v[68:71],a[76:79],a[44:47],v[68:71]
s_cselect_b64 s[66:67], s[16:17], s[82:83]
R a[104:107],v2,43008
R a[108:111],v2,44032
M v[68:71],a[80:83],a[48:51],v[68:71]
s_cselect_b64 s[68:69], s[18:19], s[82:83]
MF v175,s5,v175
MF v188,s5,v188
M v[68:71],a[84:87],a[52:55],v[68:71]
s_cselect_b64 s[70:71], s[48:49], s[82:83]
MF v189,s5,v189
MF v190,s5,v190
MF v191,s5,v191
C v172,v172,v173
C v173,v174,v175
C v174,v188,v189
C v175,v190,v191
W a60,v172
W a61,v173
W a62,v174
W a63,v175
M v[68:71],a[88:91],a[56:59],v[68:71]
s_cselect_b64 s[72:73], s[50:51], s[82:83]
R a[112:115],v2,45056
R a[116:119],v2,46080
v_cndmask_b32 v64, 0, v8, s[66:67]
v_cndmask_b32 v65, 0, v8, s[68:69]
v_cndmask_b32 v66, 0, v8, s[70:71]
v_cndmask_b32 v67, 0, v8, s[72:73]
M v[68:71],a[92:95],a[60:63],v[68:71]
s_cmp_lt_u32 s20, 1
MF v164,s5,v164
MF v165,s5,v165
M v[64:67],a[64:67],a[0:3],v[64:67]
s_cselect_b64 s[82:83], -1, 0
MF v166,s5,v166
MF v167,s5,v167
M v[64:67],a[68:71],a[4:7],v[64:67]
s_cmp_eq_u32 s20, 1
R a[120:123],v2,47104
R a[124:127],v2,48128
M v[64:67],a[72:75],a[8:11],v[64:67]
s_cselect_b64 s[74:75], s[16:17], s[82:83]
MF v180,s5,v180
MF v181,s5,v181
M v[64:67],a[76:79],a[12:15],v[64:67]
s_cselect_b64 s[76:77], s[18:19], s[82:83]
MF v182,s5,v182
MF v183,s5,v183
M v[64:67],a[80:83],a[16:19],v[64:67]
s_cselect_b64 s[78:79], s[48:49], s[82:83]
C v164,v164,v165
C v165,v166,v167
C v166,v180,v181
C v167,v182,v183
W a28,v164
W a29,v165
W a30,v166
W a31,v167
M v[64:67],a[84:87],a[20:23],v[64:67]
s_cselect_b64 s[80:81], s[50:51], s[82:83]
v_mov_b32 v31, 0
v_cndmask_b32 v72, 0, v8, s[74:75]
M v[64:67],a[88:91],a[24:27],v[64:67]
s_mov_b32 s26, s43
v_mov_b32 v32, 0
M v[64:67],a[92:95],a[28:31],v[64:67]
s_waitcnt lgkmcnt(0)
v_cndmask_b32 v73, 0, v8, s[76:77]
M v[76:79],a[96:99],a[32:35],0
SA m0,s28,0
R a[64:67],v2,49152
R a[68:71],v2,50176
M v[76:79],a[100:103],a[36:39],v[76:79]
SA s3,s93,786432
buffer_load_dwordx4 v3, s[8:11], s26 offen offset:0 sc1 lds
M v[76:79],a[104:107],a[40:43],v[76:79]
v_cndmask_b32 v74, 0, v8, s[78:79]
v_mov_b32 v33, 0
M v[76:79],a[108:111],a[44:47],v[76:79]
R a[72:75],v2,51200
R a[76:79],v2,52224
M v[76:79],a[112:115],a[48:51],v[76:79]
buffer_store_dwordx4 v[192:195], v7, s[8:11], s3 offen offset:0 sc1
M v[76:79],a[116:119],a[52:55],v[76:79]
v_cndmask_b32 v75, 0, v8, s[80:81]
M v[76:79],a[120:123],a[56:59],v[76:79]
s_cmp_lt_u32 s20, 2
R a[80:83],v2,53248
R a[84:87],v2,54272
M v[76:79],a[124:127],a[60:63],v[76:79]
s_cselect_b64 s[82:83], -1, 0
buffer_load_dwordx4 v3, s[8:11], s26 offen offset:1024 sc1 lds
M v[72:75],a[124:127],a[28:31],v[72:75]
s_cmp_eq_u32 s20, 2
E v18,v68
M v[72:75],a[120:123],a[24:27],v[72:75]
s_cselect_b64 s[66:67], s[16:17], s[82:83]
R a[88:91],v2,55296
R a[92:95],v2,56320
M v[72:75],a[116:119],a[20:23],v[72:75]
s_cselect_b64 s[68:69], s[18:19], s[82:83]
buffer_load_dwordx4 v3, s[8:11], s26 offen offset:2048 sc1 lds
M v[72:75],a[112:115],a[16:19],v[72:75]
s_cselect_b64 s[70:71], s[48:49], s[82:83]
v_mov_b32 v34, 0
M v[72:75],a[108:111],a[12:15],v[72:75]
s_cselect_b64 s[72:73], s[50:51], s[82:83]
v_cndmask_b32 v80, 0, v8, s[66:67]
v_cndmask_b32 v81, 0, v8, s[68:69]
M v[72:75],a[104:107],a[8:11],v[72:75]
buffer_store_dwordx4 v[200:203], v7, s[8:11], s3 offen offset:1024 sc1
M v[72:75],a[100:103],a[4:7],v[72:75]
E v19,v69
M v[72:75],a[96:99],a[0:3],v[72:75]
s_waitcnt lgkmcnt(0)
buffer_load_dwordx4 v3, s[8:11], s26 offen offset:3072 sc1 lds
M v[84:87],a[64:67],a[32:35],0
SA m0,s28,4096
R a[96:99],v2,57344
R a[100:103],v2,58368
M v[84:87],a[68:71],a[36:39],v[84:87]
v_cndmask_b32 v82, 0, v8, s[70:71]
v_mov_b32 v35, 0
M v[84:87],a[72:75],a[40:43],v[84:87]
buffer_load_dwordx4 v4, s[8:11], s26 offen offset:0 sc1 lds
M v[84:87],a[76:79],a[44:47],v[84:87]
R a[104:107],v2,59392
R a[108:111],v2,60416
M v[84:87],a[80:83],a[48:51],v[84:87]
buffer_store_dwordx4 v[208:211], v7, s[8:11], s3 offen offset:2048 sc1
M v[84:87],a[84:87],a[52:55],v[84:87]
v_cndmask_b32 v83, 0, v8, s[72:73]
v_mov_b32 v36, 0
M v[84:87],a[88:91],a[56:59],v[84:87]
s_cmp_lt_u32 s20, 3
R a[112:115],v2,61440
R a[116:119],v2,62464
M v[84:87],a[92:95],a[60:63],v[84:87]
s_cselect_b64 s[82:83], -1, 0
buffer_load_dwordx4 v4, s[8:11], s26 offen offset:1024 sc1 lds
M v[80:83],a[92:95],a[28:31],v[80:83]
s_cmp_eq_u32 s20, 3
E v20,v70
M v[80:83],a[88:91],a[24:27],v[80:83]
s_cselect_b64 s[74:75], s[16:17], s[82:83]
R a[120:123],v2,63488
R a[124:127],v2,64512
M v[80:83],a[84:87],a[20:23],v[80:83]
s_cselect_b64 s[76:77], s[18:19], s[82:83]
buffer_load_dwordx4 v4, s[8:11], s26 offen offset:2048 sc1 lds
M v[80:83],a[80:83],a[16:19],v[80:83]
s_cselect_b64 s[78:79], s[48:49], s[82:83]
E v21,v71
M v[80:83],a[76:79],a[12:15],v[80:83]
s_cselect_b64 s[80:81], s[50:51], s[82:83]
buffer_store_dwordx4 v[216:219], v7, s[8:11], s3 offen offset:3072 sc1
M v[80:83],a[72:75],a[8:11],v[80:83]
SA s3,s93,794624
v_cndmask_b32 v88, 0, v8, s[74:75]
v_cndmask_b32 v89, 0, v8, s[76:77]
M v[80:83],a[68:71],a[4:7],v[80:83]
s_waitcnt vmcnt(24) lgkmcnt(0)
buffer_load_dwordx4 v4, s[8:11], s26 offen offset:3072 sc1 lds
M v[80:83],a[64:67],a[0:3],v[80:83]
s_barrier
M v[92:95],a[96:99],a[32:35],0
R a[64:67],v2,0
R a[68:71],v2,1024
M v[92:95],a[100:103],a[36:39],v[92:95]
buffer_store_dwordx4 v[224:227], v7, s[8:11], s3 offen offset:0 sc1
M v[92:95],a[104:107],a[40:43],v[92:95]
v_min_u32 v17, 896, v9
v_cndmask_b32 v90, 0, v8, s[78:79]
M v[92:95],a[108:111],a[44:47],v[92:95]
R a[72:75],v2,2048
R a[76:79],v2,3072
M v[92:95],a[112:115],a[48:51],v[92:95]
buffer_load_dword v5, v17, s[8:11], s46 offen sc1
M v[92:95],a[116:119],a[52:55],v[92:95]
buffer_store_dwordx4 v[232:235], v7, s[8:11], s3 offen offset:1024 sc1
M v[92:95],a[120:123],a[56:59],v[92:95]
R a[80:83],v2,4096
R a[84:87],v2,5120
v_cndmask_b32 v91, 0, v8, s[80:81]
M v[92:95],a[124:127],a[60:63],v[92:95]
v_mov_b32 v37, 0
v_mov_b32 v38, 0
M v[88:91],a[124:127],a[28:31],v[88:91]
buffer_store_dwordx4 v[240:243], v7, s[8:11], s3 offen offset:2048 sc1
M v[88:91],a[120:123],a[24:27],v[88:91]
R a[88:91],v2,6144
R a[92:95],v2,7168
M v[88:91],a[116:119],a[20:23],v[88:91]
v_mov_b32 v39, 0
AF v27,v18,v19
M v[88:91],a[112:115],a[16:19],v[88:91]
buffer_store_dwordx4 v[248:251], v7, s[8:11], s3 offen offset:3072 sc1
M v[88:91],a[108:111],a[12:15],v[88:91]
E v22,v64
M v[88:91],a[104:107],a[8:11],v[88:91]
E v23,v65
M v[88:91],a[100:103],a[4:7],v[88:91]
s_waitcnt lgkmcnt(0)
E v24,v66
M v[88:91],a[96:99],a[0:3],v[88:91]
E v25,v67
C v44,v18,v19
AF v27,v20,v27
C v45,v20,v21
AF v27,v21,v27
AF v26,v22,v23
C v40,v22,v23
E v18,v76
E v19,v77
AF v26,v24,v26
C v41,v24,v25
AF v26,v25,v26
E v20,v78
E v21,v79
AF v27,v18,v27
C v46,v18,v19
AF v27,v19,v27
E v22,v72
E v23,v73
AF v27,v20,v27
C v47,v20,v21
AF v27,v21,v27
E v24,v74
E v25,v75
AF v26,v22,v26
C v42,v22,v23
AF v26,v23,v26
AF v26,v24,v26
C v43,v24,v25
AF v26,v25,v26
v_mov_b32 v56, 0
v_mov_b32 v57, 0
v_mov_b32 v58, 0
v_mov_b32 v59, 0
s_mul_i32 s21, s41, 1048576
SA s21,s21,589824
s_lshl_b32 s84, s42, 1
s_sub_u32 s22, 11, s84
s_mov_b32 s23, 536870912
s_lshl_b32 s86, s20, 14
SA s86,s86,s34
SA s87,s86,4096
SA s88,s86,8192
SA s89,s86,12288
s_lshl_b32 s90, s20, 10
SA s90,s90,s34
SA s90,s90,65536
s_waitcnt vmcnt(3)
v_cmp_gt_u32 vcc, 2, v5
s_nop 0
s_cbranch_vccnz L_lsj0
L_lrj0:
SA m0,s28,98304
v_mov_b32 v10, v26
buffer_load_dwordx4 v3, s[8:11], s21 offen offset:0 sc1 lds
v_mov_b32 v11, v27
buffer_load_dwordx4 v3, s[8:11], s21 offen offset:1024 sc1 lds
v_mov_b32 v12, v10
v_mov_b32 v13, v11
buffer_load_dwordx4 v3, s[8:11], s21 offen offset:2048 sc1 lds
v_permlane16_swap_b32 v12, v10
v_permlane16_swap_b32 v13, v11
buffer_load_dwordx4 v3, s[8:11], s21 offen offset:3072 sc1 lds
v_max_f32 v10, v12, v10
SA m0,s28,102400
v_max_f32 v11, v13, v11
buffer_load_dwordx4 v4, s[8:11], s21 offen offset:0 sc1 lds
v_mov_b32 v12, v10
v_mov_b32 v13, v11
buffer_load_dwordx4 v4, s[8:11], s21 offen offset:1024 sc1 lds
v_permlane32_swap_b32 v12, v10
v_permlane32_swap_b32 v13, v11
buffer_load_dwordx4 v4, s[8:11], s21 offen offset:2048 sc1 lds
v_max_f32 v10, v12, v10
v_max_f32 v11, v13, v11
buffer_load_dwordx4 v4, s[8:11], s21 offen offset:3072 sc1 lds
SA s21,s21,32768
s_sub_u32 s22, s22, 1
s_cselect_b32 s21, s23, s21
v_min_f32 v10, v10, v11
v_cmp_gt_f32 vcc, s24, v10
s_nop 0
s_cbranch_vccnz L_stj0
L_rtj0:
s_cmp_gt_u32 s20, 3
s_cselect_b64 s[82:83], -1, 0
s_cmp_eq_u32 s20, 3
s_cselect_b64 s[66:67], s[16:17], s[82:83]
v_mfma_f32_32x32x16_bf16 v[128:143], v[56:59], v[56:59], 0
s_cselect_b64 s[68:69], s[18:19], s[82:83]
s_cselect_b64 s[70:71], s[48:49], s[82:83]
s_cselect_b64 s[72:73], s[50:51], s[82:83]
v_cndmask_b32 v100, v36, v8, s[66:67]
v_mfma_f32_32x32x16_bf16 v[144:159], v[56:59], v[56:59], 0
v_cndmask_b32 v101, v36, v8, s[68:69]
v_cndmask_b32 v102, v36, v8, s[70:71]
v_cndmask_b32 v103, v36, v8, s[72:73]
s_cmp_gt_u32 s20, 2
v_mfma_f32_32x32x16_bf16 v[160:175], v[56:59], v[56:59], 0
s_cselect_b64 s[82:83], -1, 0
s_cmp_eq_u32 s20, 2
s_cselect_b64 s[74:75], s[16:17], s[82:83]
s_cselect_b64 s[76:77], s[18:19], s[82:83]
v_mfma_f32_32x32x16_bf16 v[176:191], v[56:59], v[56:59], 0
s_cselect_b64 s[78:79], s[48:49], s[82:83]
s_cselect_b64 s[80:81], s[50:51], s[82:83]
v_cndmask_b32 v108, v36, v8, s[74:75]
v_cndmask_b32 v109, v36, v8, s[76:77]
v_mfma_f32_32x32x16_bf16 v[192:207], v[56:59], v[56:59], 0
v_cndmask_b32 v110, v36, v8, s[78:79]
v_cndmask_b32 v111, v36, v8, s[80:81]
s_cmp_gt_u32 s20, 1
s_cselect_b64 s[82:83], -1, 0
v_mfma_f32_32x32x16_bf16 v[208:223], v[56:59], v[56:59], 0
s_cmp_eq_u32 s20, 1
s_cselect_b64 s[66:67], s[16:17], s[82:83]
s_cselect_b64 s[68:69], s[18:19], s[82:83]
s_cselect_b64 s[70:71], s[48:49], s[82:83]
v_mfma_f32_32x32x16_bf16 v[224:239], v[56:59], v[56:59], 0
s_cselect_b64 s[72:73], s[50:51], s[82:83]
v_cndmask_b32 v116, v36, v8, s[66:67]
v_cndmask_b32 v117, v36, v8, s[68:69]
v_cndmask_b32 v118, v36, v8, s[70:71]
v_mfma_f32_32x32x16_bf16 v[240:255], v[56:59], v[56:59], 0
v_cndmask_b32 v119, v36, v8, s[72:73]
s_cmp_gt_u32 s20, 0
s_cselect_b64 s[82:83], -1, 0
s_cmp_eq_u32 s20, 0
s_cselect_b64 s[74:75], s[16:17], s[82:83]
s_cselect_b64 s[76:77], s[18:19], s[82:83]
s_cselect_b64 s[78:79], s[48:49], s[82:83]
s_cselect_b64 s[80:81], s[50:51], s[82:83]
v_cndmask_b32 v124, v36, v8, s[74:75]
v_cndmask_b32 v125, v36, v8, s[76:77]
v_cndmask_b32 v126, v36, v8, s[78:79]
v_cndmask_b32 v127, v36, v8, s[80:81]
s_branch L_d3h
.p2align 12
L_kv1:
s_and_b32 s31, s42, 7
s_lshl_b32 s30, s41, 3
SA s30,s30,s31
s_lshl_b32 s64, s30, 2
SA s64,s64,s20
s_mul_i32 s72, s64, 3584
v_mov_b32 v32, 536870912
v_cmp_gt_u32 vcc, 56, v0
s_lshl_b32 s67, s64, 2
s_nop 0
v_cndmask_b32 v32, v32, v7, vcc
buffer_load_dwordx4 a[176:179], v32, s[56:59], s72 offen offset:0
buffer_load_dwordx4 a[180:183], v32, s[56:59], s72 offen offset:896
buffer_load_dwordx4 a[184:187], v32, s[56:59], s72 offen offset:1792
buffer_load_dwordx4 a[188:191], v32, s[56:59], s72 offen offset:2688
buffer_load_dwordx4 a[192:195], v32, s[60:63], 0 offen
buffer_load_dwordx4 a[196:199], v32, s[68:71], 0 offen
SA m0,s24,16384
s_nop 0
buffer_load_dwordx4 v12, s[48:51], s22 offen offset:0   lds
buffer_load_dwordx4 v13, s[48:51], s22 offen offset:1024   lds
buffer_load_dwordx4 v14, s[48:51], s22 offen offset:2048   lds
buffer_load_dwordx4 v15, s[48:51], s22 offen offset:3072   lds
s_sub_u32 s22, s22, 1048448
SA m0,s23,32768
s_nop 0
buffer_load_dwordx4 v8, s[16:19], s21 offen offset:0   lds
buffer_load_dwordx4 v9, s[16:19], s21 offen offset:1024   lds
buffer_load_dwordx4 v10, s[16:19], s21 offen offset:2048   lds
buffer_load_dwordx4 v11, s[16:19], s21 offen offset:3072   lds
SA s21,s21,128
s_mov_b64 exec, 0
s_cmp_eq_u32 s20, 0
s_cbranch_scc1 L_w_kv11
s_cmp_eq_u32 s20, 1
s_cbranch_scc1 L_w_kv12
s_cmp_eq_u32 s20, 2
s_cbranch_scc1 L_w_kv13
s_branch L_w_kv14
L_wd2:
s_mov_b64 exec, -1
s_waitcnt vmcnt(14) lgkmcnt(0)
s_barrier
R a[160:163],v5,0
R a[164:167],v6,0
T a[96:97],v1,0
T a[98:99],v1,1024
T a[100:101],v1,8192
T a[102:103],v1,9216
T a[104:105],v2,0
T a[106:107],v2,1024
T a[108:109],v2,8192
T a[110:111],v2,9216
T a[112:113],v3,0
T a[114:115],v3,1024
T a[116:117],v3,8192
T a[118:119],v3,9216
T a[120:121],v4,0
T a[122:123],v4,1024
T a[124:125],v4,8192
T a[126:127],v4,9216
T a[128:129],v1,16384
T a[130:131],v1,17408
T a[132:133],v1,24576
T a[134:135],v1,25600
T a[136:137],v2,16384
T a[138:139],v2,17408
T a[140:141],v2,24576
T a[142:143],v2,25600
T a[144:145],v3,16384
T a[146:147],v3,17408
T a[148:149],v3,24576
T a[150:151],v3,25600
T a[152:153],v4,16384
T a[154:155],v4,17408
T a[156:157],v4,24576
T a[158:159],v4,25600
s_waitcnt lgkmcnt(15)
M a[0:3],a[160:163],a[96:99],0
SA m0,s23,49152
R a[168:171],v5,2048
R a[172:175],v6,2048
M a[0:3],a[164:167],a[100:103],a[0:3]
buffer_load_dwordx4 v8, s[16:19], s21 offen offset:0   lds
M a[4:7],a[164:167],a[108:111],0
M a[4:7],a[160:163],a[104:107],a[4:7]
M a[8:11],a[160:163],a[112:115],0
buffer_load_dwordx4 v9, s[16:19], s21 offen offset:1024   lds
M a[8:11],a[164:167],a[116:119],a[8:11]
s_waitcnt lgkmcnt(14)
M a[12:15],a[164:167],a[124:127],0
M a[12:15],a[160:163],a[120:123],a[12:15]
M a[16:19],a[160:163],a[128:131],0
buffer_load_dwordx4 v10, s[16:19], s21 offen offset:2048   lds
M a[16:19],a[164:167],a[132:135],a[16:19]
s_waitcnt lgkmcnt(6)
M a[20:23],a[164:167],a[140:143],0
M a[20:23],a[160:163],a[136:139],a[20:23]
buffer_load_dwordx4 v11, s[16:19], s21 offen offset:3072   lds
M a[24:27],a[160:163],a[144:147],0
SA s21,s21,524160
M a[24:27],a[164:167],a[148:151],a[24:27]
s_waitcnt lgkmcnt(0)
M a[28:31],a[164:167],a[156:159],0
SA m0,s24,32768
M a[28:31],a[160:163],a[152:155],a[28:31]
buffer_load_dwordx4 v12, s[48:51], s22 offen offset:0   lds
M v[32:35],a[168:171],a[96:99],0
R a[160:163],v5,4096
R a[164:167],v6,4096
M v[32:35],a[172:175],a[100:103],v[32:35]
M v[36:39],a[172:175],a[108:111],0
M v[36:39],a[168:171],a[104:107],v[36:39]
buffer_load_dwordx4 v13, s[48:51], s22 offen offset:1024   lds
M v[40:43],a[168:171],a[112:115],0
M v[40:43],a[172:175],a[116:119],v[40:43]
M v[44:47],a[172:175],a[124:127],0
buffer_load_dwordx4 v14, s[48:51], s22 offen offset:2048   lds
M v[44:47],a[168:171],a[120:123],v[44:47]
M v[48:51],a[168:171],a[128:131],0
M v[48:51],a[172:175],a[132:135],v[48:51]
M v[52:55],a[172:175],a[140:143],0
buffer_load_dwordx4 v15, s[48:51], s22 offen offset:3072   lds
M v[52:55],a[168:171],a[136:139],v[52:55]
SA s22,s22,1048576
M v[56:59],a[168:171],a[144:147],0
M v[56:59],a[172:175],a[148:151],v[56:59]
s_waitcnt lgkmcnt(0)
M v[60:63],a[172:175],a[156:159],0
M v[60:63],a[168:171],a[152:155],v[60:63]
M v[64:67],a[160:163],a[96:99],0
R a[168:171],v5,6144
R a[172:175],v6,6144
M v[64:67],a[164:167],a[100:103],v[64:67]
M v[68:71],a[164:167],a[108:111],0
M v[68:71],a[160:163],a[104:107],v[68:71]
M v[72:75],a[160:163],a[112:115],0
M v[72:75],a[164:167],a[116:119],v[72:75]
M v[76:79],a[164:167],a[124:127],0
M v[76:79],a[160:163],a[120:123],v[76:79]
M v[80:83],a[160:163],a[128:131],0
M v[80:83],a[164:167],a[132:135],v[80:83]
M v[84:87],a[164:167],a[140:143],0
M v[84:87],a[160:163],a[136:139],v[84:87]
M v[88:91],a[160:163],a[144:147],0
M v[88:91],a[164:167],a[148:151],v[88:91]
s_waitcnt lgkmcnt(0)
M v[92:95],a[164:167],a[156:159],0
s_waitcnt vmcnt(12)
M v[92:95],a[160:163],a[152:155],v[92:95]
s_barrier
M v[96:99],a[168:171],a[96:99],0
SA m0,s23,0
R a[160:163],v5,16384
R a[164:167],v6,16384
M v[96:99],a[172:175],a[100:103],v[96:99]
buffer_load_dwordx4 v8, s[16:19], s21 offen offset:0   lds
M v[100:103],a[172:175],a[108:111],0
v_lshlrev_b32 v26, 7, v0
v_and_b32 v27, 48, v0
M v[100:103],a[168:171],a[104:107],v[100:103]
v_lshl_add_u32 v26, v27, 24, v26
M v[104:107],a[168:171],a[112:115],0
buffer_load_dwordx4 v9, s[16:19], s21 offen offset:1024   lds
M v[104:107],a[172:175],a[116:119],v[104:107]
M v[108:111],a[172:175],a[124:127],0
M v[108:111],a[168:171],a[120:123],v[108:111]
buffer_load_dwordx4 v10, s[16:19], s21 offen offset:2048   lds
M v[112:115],a[168:171],a[128:131],0
M v[112:115],a[172:175],a[132:135],v[112:115]
M v[116:119],a[172:175],a[140:143],0
M v[116:119],a[168:171],a[136:139],v[116:119]
buffer_load_dwordx4 v11, s[16:19], s21 offen offset:3072   lds
M v[120:123],a[168:171],a[144:147],0
SA s21,s21,128
M v[120:123],a[172:175],a[148:151],v[120:123]
s_waitcnt lgkmcnt(0)
M v[124:127],a[172:175],a[156:159],0
SA m0,s24,49152
M v[124:127],a[168:171],a[152:155],v[124:127]
buffer_load_dwordx4 v12, s[48:51], s22 offen offset:0   lds
M v[128:131],a[160:163],a[96:99],0
R a[168:171],v5,18432
R a[172:175],v6,18432
M v[128:131],a[164:167],a[100:103],v[128:131]
buffer_load_dwordx4 v13, s[48:51], s22 offen offset:1024   lds
M v[132:135],a[164:167],a[108:111],0
M v[132:135],a[160:163],a[104:107],v[132:135]
M v[136:139],a[160:163],a[112:115],0
M v[136:139],a[164:167],a[116:119],v[136:139]
buffer_load_dwordx4 v14, s[48:51], s22 offen offset:2048   lds
M v[140:143],a[164:167],a[124:127],0
M v[140:143],a[160:163],a[120:123],v[140:143]
M v[144:147],a[160:163],a[128:131],0
buffer_load_dwordx4 v15, s[48:51], s22 offen offset:3072   lds
M v[144:147],a[164:167],a[132:135],v[144:147]
s_sub_u32 s22, s22, 1048448
M v[148:151],a[164:167],a[140:143],0
M v[148:151],a[160:163],a[136:139],v[148:151]
M v[152:155],a[160:163],a[144:147],0
M v[152:155],a[164:167],a[148:151],v[152:155]
s_waitcnt lgkmcnt(0)
M v[156:159],a[164:167],a[156:159],0
s_waitcnt vmcnt(12)
M v[156:159],a[160:163],a[152:155],v[156:159]
s_barrier
M v[160:163],a[168:171],a[96:99],0
SA m0,s23,16384
R a[160:163],v5,20480
R a[164:167],v6,20480
M v[160:163],a[172:175],a[100:103],v[160:163]
T a[32:33],v1,32768
T a[34:35],v1,33792
M v[164:167],a[172:175],a[108:111],0
T a[36:37],v1,40960
T a[38:39],v1,41984
M v[164:167],a[168:171],a[104:107],v[164:167]
T a[40:41],v2,32768
T a[42:43],v2,33792
M v[168:171],a[168:171],a[112:115],0
T a[44:45],v2,40960
T a[46:47],v2,41984
M v[168:171],a[172:175],a[116:119],v[168:171]
buffer_load_dwordx4 v8, s[16:19], s21 offen offset:0   lds
M v[172:175],a[172:175],a[124:127],0
s_nop 0
T a[48:49],v3,32768
T a[50:51],v3,33792
M v[172:175],a[168:171],a[120:123],v[172:175]
buffer_load_dwordx4 v9, s[16:19], s21 offen offset:1024   lds
M v[176:179],a[168:171],a[128:131],0
s_nop 0
T a[52:53],v3,40960
T a[54:55],v3,41984
M v[176:179],a[172:175],a[132:135],v[176:179]
T a[56:57],v4,32768
T a[58:59],v4,33792
M v[180:183],a[172:175],a[140:143],0
buffer_load_dwordx4 v10, s[16:19], s21 offen offset:2048   lds
M v[180:183],a[168:171],a[136:139],v[180:183]
s_nop 0
T a[60:61],v4,40960
T a[62:63],v4,41984
M v[184:187],a[168:171],a[144:147],0
buffer_load_dwordx4 v11, s[16:19], s21 offen offset:3072   lds
M v[184:187],a[172:175],a[148:151],v[184:187]
s_waitcnt lgkmcnt(15)
s_nop 0
T a[64:65],v1,49152
T a[66:67],v1,50176
M v[188:191],a[172:175],a[156:159],0
SA s21,s21,524160
T a[68:69],v1,57344
T a[70:71],v1,58368
M v[188:191],a[168:171],a[152:155],v[188:191]
SA m0,s24,0
M v[192:195],a[160:163],a[96:99],0
R a[168:171],v5,22528
R a[172:175],v6,22528
M v[192:195],a[164:167],a[100:103],v[192:195]
T a[72:73],v2,49152
T a[74:75],v2,50176
M v[196:199],a[164:167],a[108:111],0
T a[76:77],v2,57344
T a[78:79],v2,58368
M v[196:199],a[160:163],a[104:107],v[196:199]
T a[80:81],v3,49152
T a[82:83],v3,50176
M v[200:203],a[160:163],a[112:115],0
buffer_load_dwordx4 v12, s[48:51], s22 offen offset:0   lds
M v[200:203],a[164:167],a[116:119],v[200:203]
s_nop 0
T a[84:85],v3,57344
T a[86:87],v3,58368
M v[204:207],a[164:167],a[124:127],0
T a[88:89],v4,49152
T a[90:91],v4,50176
M v[204:207],a[160:163],a[120:123],v[204:207]
buffer_load_dwordx4 v13, s[48:51], s22 offen offset:1024   lds
M v[208:211],a[160:163],a[128:131],0
s_nop 0
T a[92:93],v4,57344
T a[94:95],v4,58368
M v[208:211],a[164:167],a[132:135],v[208:211]
buffer_load_dwordx4 v14, s[48:51], s22 offen offset:2048   lds
M v[212:215],a[164:167],a[140:143],0
buffer_load_dwordx4 v15, s[48:51], s22 offen offset:3072   lds
M v[212:215],a[160:163],a[136:139],v[212:215]
SA s22,s22,1048576
M v[216:219],a[160:163],a[144:147],0
M v[216:219],a[164:167],a[148:151],v[216:219]
s_waitcnt lgkmcnt(12)
M v[220:223],a[164:167],a[156:159],0
s_waitcnt vmcnt(12) lgkmcnt(0)
M v[220:223],a[160:163],a[152:155],v[220:223]
s_barrier
M v[224:227],a[168:171],a[96:99],0
SA m0,s23,32768
R a[160:163],v5,32768
R a[164:167],v6,32768
M v[224:227],a[172:175],a[100:103],v[224:227]
buffer_load_dwordx4 v8, s[16:19], s21 offen offset:0   lds
M v[228:231],a[172:175],a[108:111],0
M v[228:231],a[168:171],a[104:107],v[228:231]
M v[232:235],a[168:171],a[112:115],0
buffer_load_dwordx4 v9, s[16:19], s21 offen offset:1024   lds
M v[232:235],a[172:175],a[116:119],v[232:235]
M v[236:239],a[172:175],a[124:127],0
M v[236:239],a[168:171],a[120:123],v[236:239]
buffer_load_dwordx4 v10, s[16:19], s21 offen offset:2048   lds
M v[240:243],a[168:171],a[128:131],0
M v[240:243],a[172:175],a[132:135],v[240:243]
M v[244:247],a[172:175],a[140:143],0
buffer_load_dwordx4 v11, s[16:19], s21 offen offset:3072   lds
M v[244:247],a[168:171],a[136:139],v[244:247]
SA s21,s21,128
M v[248:251],a[168:171],a[144:147],0
M v[248:251],a[172:175],a[148:151],v[248:251]
s_waitcnt lgkmcnt(0)
M v[252:255],a[172:175],a[156:159],0
M v[252:255],a[168:171],a[152:155],v[252:255]
M a[0:3],a[160:163],a[32:35],a[0:3]
R a[168:171],v5,34816
R a[172:175],v6,34816
M a[0:3],a[164:167],a[36:39],a[0:3]
T a[96:97],v1,0
T a[98:99],v1,1024
M a[4:7],a[164:167],a[44:47],a[4:7]
SA m0,s24,16384
v_mov_b32 v16, 0
v_mov_b32 v17, 0
M a[4:7],a[160:163],a[40:43],a[4:7]
buffer_load_dwordx4 v12, s[48:51], s22 offen offset:0   lds
M a[8:11],a[160:163],a[48:51],a[8:11]
v_mov_b32 v18, 0
v_mov_b32 v19, 0
M a[8:11],a[164:167],a[52:55],a[8:11]
v_mov_b32 v20, 0
v_mov_b32 v21, 0
M a[12:15],a[164:167],a[60:63],a[12:15]
T a[100:101],v1,8192
T a[102:103],v1,9216
M a[12:15],a[160:163],a[56:59],a[12:15]
v_mov_b32 v22, 0
v_mov_b32 v23, 0
M a[16:19],a[160:163],a[64:67],a[16:19]
buffer_load_dwordx4 v13, s[48:51], s22 offen offset:1024   lds
M a[16:19],a[164:167],a[68:71],a[16:19]
G v28,a192
G v29,a196
M a[20:23],a[164:167],a[76:79],a[20:23]
v_lshlrev_b32 v27, 16, v28
v_lshlrev_b32 v25, 16, v29
M a[20:23],a[160:163],a[72:75],a[20:23]
T a[104:105],v2,0
T a[106:107],v2,1024
M a[24:27],a[160:163],a[80:83],a[24:27]
v_and_b32 v28, 0xffff0000, v28
v_and_b32 v29, 0xffff0000, v29
M a[24:27],a[164:167],a[84:87],a[24:27]
s_waitcnt lgkmcnt(6)
buffer_load_dwordx4 v14, s[48:51], s22 offen offset:2048   lds
M a[28:31],a[164:167],a[92:95],a[28:31]
G v30,a176
v_lshlrev_b32 v31, 16, v30
M a[28:31],a[160:163],a[88:91],a[28:31]
v_and_b32 v30, 0xffff0000, v30
v_fmac_f32 v16, v31, v27
M v[60:63],a[168:171],a[88:91],v[60:63]
R a[160:163],v5,36864
R a[164:167],v6,36864
M v[60:63],a[172:175],a[92:95],v[60:63]
T a[108:109],v2,8192
T a[110:111],v2,9216
M v[56:59],a[172:175],a[84:87],v[56:59]
buffer_load_dwordx4 v15, s[48:51], s22 offen offset:3072   lds
M v[56:59],a[168:171],a[80:83],v[56:59]
s_sub_u32 s22, s22, 1048448
v_fmac_f32 v20, v31, v25
v_fmac_f32 v16, v30, v28
M v[52:55],a[168:171],a[72:75],v[52:55]
v_fmac_f32 v20, v30, v29
G v30,a180
M v[52:55],a[172:175],a[76:79],v[52:55]
T a[112:113],v3,0
T a[114:115],v3,1024
M v[48:51],a[172:175],a[68:71],v[48:51]
SA m0,s23,49152
v_lshlrev_b32 v31, 16, v30
v_and_b32 v30, 0xffff0000, v30
M v[48:51],a[168:171],a[64:67],v[48:51]
buffer_load_dwordx4 v8, s[16:19], s21 offen offset:0   lds
M v[44:47],a[168:171],a[56:59],v[44:47]
v_fmac_f32 v17, v31, v27
v_fmac_f32 v21, v31, v25
M v[44:47],a[172:175],a[60:63],v[44:47]
v_fmac_f32 v17, v30, v28
v_fmac_f32 v21, v30, v29
M v[40:43],a[172:175],a[52:55],v[40:43]
T a[116:117],v3,8192
T a[118:119],v3,9216
M v[40:43],a[168:171],a[48:51],v[40:43]
G v30,a184
v_lshlrev_b32 v31, 16, v30
M v[36:39],a[168:171],a[40:43],v[36:39]
buffer_load_dwordx4 v9, s[16:19], s21 offen offset:1024   lds
M v[36:39],a[172:175],a[44:47],v[36:39]
s_waitcnt lgkmcnt(6)
v_and_b32 v30, 0xffff0000, v30
v_fmac_f32 v18, v31, v27
M v[32:35],a[172:175],a[36:39],v[32:35]
v_fmac_f32 v22, v31, v25
v_fmac_f32 v18, v30, v28
M v[32:35],a[168:171],a[32:35],v[32:35]
T a[120:121],v4,0
T a[122:123],v4,1024
M v[64:67],a[160:163],a[32:35],v[64:67]
R a[168:171],v5,38912
R a[172:175],v6,38912
M v[64:67],a[164:167],a[36:39],v[64:67]
buffer_load_dwordx4 v10, s[16:19], s21 offen offset:2048   lds
M v[68:71],a[164:167],a[44:47],v[68:71]
v_fmac_f32 v22, v30, v29
G v30,a188
M v[68:71],a[160:163],a[40:43],v[68:71]
v_lshlrev_b32 v31, 16, v30
v_and_b32 v30, 0xffff0000, v30
M v[72:75],a[160:163],a[48:51],v[72:75]
T a[124:125],v4,8192
T a[126:127],v4,9216
M v[72:75],a[164:167],a[52:55],v[72:75]
v_fmac_f32 v19, v31, v27
v_fmac_f32 v23, v31, v25
M v[76:79],a[164:167],a[60:63],v[76:79]
buffer_load_dwordx4 v11, s[16:19], s21 offen offset:3072   lds
M v[76:79],a[160:163],a[56:59],v[76:79]
SA s21,s21,524160
v_fmac_f32 v19, v30, v28
v_fmac_f32 v23, v30, v29
M v[80:83],a[160:163],a[64:67],v[80:83]
G v28,a193
G v29,a197
M v[80:83],a[164:167],a[68:71],v[80:83]
v_lshlrev_b32 v27, 16, v28
v_lshlrev_b32 v25, 16, v29
M v[84:87],a[164:167],a[76:79],v[84:87]
v_and_b32 v28, 0xffff0000, v28
v_and_b32 v29, 0xffff0000, v29
M v[84:87],a[160:163],a[72:75],v[84:87]
G v30,a177
v_lshlrev_b32 v31, 16, v30
M v[88:91],a[160:163],a[80:83],v[88:91]
v_and_b32 v30, 0xffff0000, v30
v_fmac_f32 v16, v31, v27
M v[88:91],a[164:167],a[84:87],v[88:91]
s_waitcnt lgkmcnt(2)
v_fmac_f32 v20, v31, v25
v_fmac_f32 v16, v30, v28
M v[92:95],a[164:167],a[92:95],v[92:95]
s_waitcnt vmcnt(16) lgkmcnt(0)
v_fmac_f32 v20, v30, v29
G v30,a181
M v[92:95],a[160:163],a[88:91],v[92:95]
s_barrier
M v[124:127],a[168:171],a[88:91],v[124:127]
R a[160:163],v5,49152
R a[164:167],v6,49152
M v[124:127],a[172:175],a[92:95],v[124:127]
v_lshlrev_b32 v31, 16, v30
v_and_b32 v30, 0xffff0000, v30
M v[120:123],a[172:175],a[84:87],v[120:123]
SA m0,s24,32768
T a[128:129],v1,16384
T a[130:131],v1,17408
M v[120:123],a[168:171],a[80:83],v[120:123]
buffer_load_dwordx4 v12, s[48:51], s22 offen offset:0   lds
M v[116:119],a[168:171],a[72:75],v[116:119]
v_fmac_f32 v17, v31, v27
v_fmac_f32 v21, v31, v25
M v[116:119],a[172:175],a[76:79],v[116:119]
v_fmac_f32 v17, v30, v28
v_fmac_f32 v21, v30, v29
M v[112:115],a[172:175],a[68:71],v[112:115]
G v30,a185
v_lshlrev_b32 v31, 16, v30
M v[112:115],a[168:171],a[64:67],v[112:115]
v_and_b32 v30, 0xffff0000, v30
v_fmac_f32 v18, v31, v27
M v[108:111],a[168:171],a[56:59],v[108:111]
v_fmac_f32 v22, v31, v25
v_fmac_f32 v18, v30, v28
M v[108:111],a[172:175],a[60:63],v[108:111]
T a[132:133],v1,24576
T a[134:135],v1,25600
M v[104:107],a[172:175],a[52:55],v[104:107]
buffer_load_dwordx4 v13, s[48:51], s22 offen offset:1024   lds
M v[104:107],a[168:171],a[48:51],v[104:107]
v_fmac_f32 v22, v30, v29
G v30,a189
M v[100:103],a[168:171],a[40:43],v[100:103]
v_lshlrev_b32 v31, 16, v30
v_and_b32 v30, 0xffff0000, v30
M v[100:103],a[172:175],a[44:47],v[100:103]
s_waitcnt lgkmcnt(4)
v_fmac_f32 v19, v31, v27
v_fmac_f32 v23, v31, v25
M v[96:99],a[172:175],a[36:39],v[96:99]
v_fmac_f32 v19, v30, v28
v_fmac_f32 v23, v30, v29
M v[96:99],a[168:171],a[32:35],v[96:99]
G v28,a194
G v29,a198
M v[128:131],a[160:163],a[32:35],v[128:131]
R a[168:171],v5,51200
R a[172:175],v6,51200
M v[128:131],a[164:167],a[36:39],v[128:131]
T a[136:137],v2,16384
T a[138:139],v2,17408
M v[132:135],a[164:167],a[44:47],v[132:135]
buffer_load_dwordx4 v14, s[48:51], s22 offen offset:2048   lds
M v[132:135],a[160:163],a[40:43],v[132:135]
v_lshlrev_b32 v27, 16, v28
v_lshlrev_b32 v25, 16, v29
M v[136:139],a[160:163],a[48:51],v[136:139]
v_and_b32 v28, 0xffff0000, v28
v_and_b32 v29, 0xffff0000, v29
M v[136:139],a[164:167],a[52:55],v[136:139]
G v30,a178
v_lshlrev_b32 v31, 16, v30
M v[140:143],a[164:167],a[60:63],v[140:143]
v_and_b32 v30, 0xffff0000, v30
v_fmac_f32 v16, v31, v27
M v[140:143],a[160:163],a[56:59],v[140:143]
T a[140:141],v2,24576
T a[142:143],v2,25600
M v[144:147],a[160:163],a[64:67],v[144:147]
buffer_load_dwordx4 v15, s[48:51], s22 offen offset:3072   lds
M v[144:147],a[164:167],a[68:71],v[144:147]
SA s22,s22,1048576
v_fmac_f32 v20, v31, v25
v_fmac_f32 v16, v30, v28
M v[148:151],a[164:167],a[76:79],v[148:151]
v_fmac_f32 v20, v30, v29
G v30,a182
M v[148:151],a[160:163],a[72:75],v[148:151]
v_lshlrev_b32 v31, 16, v30
v_and_b32 v30, 0xffff0000, v30
M v[152:155],a[160:163],a[80:83],v[152:155]
v_fmac_f32 v17, v31, v27
v_fmac_f32 v21, v31, v25
M v[152:155],a[164:167],a[84:87],v[152:155]
s_waitcnt lgkmcnt(4)
v_fmac_f32 v17, v30, v28
v_fmac_f32 v21, v30, v29
M v[156:159],a[164:167],a[92:95],v[156:159]
SA m0,s23,0
T a[144:145],v3,16384
T a[146:147],v3,17408
M v[156:159],a[160:163],a[88:91],v[156:159]
buffer_load_dwordx4 v8, s[16:19], s21 offen offset:0   lds
M v[188:191],a[168:171],a[88:91],v[188:191]
R a[160:163],v5,53248
R a[164:167],v6,53248
M v[188:191],a[172:175],a[92:95],v[188:191]
G v30,a186
v_lshlrev_b32 v31, 16, v30
M v[184:187],a[172:175],a[84:87],v[184:187]
v_and_b32 v30, 0xffff0000, v30
v_fmac_f32 v18, v31, v27
M v[184:187],a[168:171],a[80:83],v[184:187]
v_fmac_f32 v22, v31, v25
v_fmac_f32 v18, v30, v28
M v[180:183],a[168:171],a[72:75],v[180:183]
v_fmac_f32 v22, v30, v29
G v30,a190
M v[180:183],a[172:175],a[76:79],v[180:183]
L_w_kv11:
s_cbranch_execz L_w_kv15
T a[148:149],v3,24576
T a[150:151],v3,25600
M v[176:179],a[172:175],a[68:71],v[176:179]
buffer_load_dwordx4 v9, s[16:19], s21 offen offset:1024   lds
M v[176:179],a[168:171],a[64:67],v[176:179]
v_lshlrev_b32 v31, 16, v30
v_and_b32 v30, 0xffff0000, v30
M v[172:175],a[168:171],a[56:59],v[172:175]
v_fmac_f32 v19, v31, v27
v_fmac_f32 v23, v31, v25
M v[172:175],a[172:175],a[60:63],v[172:175]
v_fmac_f32 v19, v30, v28
v_fmac_f32 v23, v30, v29
M v[168:171],a[172:175],a[52:55],v[168:171]
M v[168:171],a[168:171],a[48:51],v[168:171]
M v[164:167],a[168:171],a[40:43],v[164:167]
s_nop 0
T a[152:153],v4,16384
T a[154:155],v4,17408
M v[164:167],a[172:175],a[44:47],v[164:167]
s_waitcnt lgkmcnt(4)
buffer_load_dwordx4 v10, s[16:19], s21 offen offset:2048   lds
M v[160:163],a[172:175],a[36:39],v[160:163]
M v[160:163],a[168:171],a[32:35],v[160:163]
M v[192:195],a[160:163],a[32:35],v[192:195]
R a[168:171],v5,55296
R a[172:175],v6,55296
M v[192:195],a[164:167],a[36:39],v[192:195]
M v[196:199],a[164:167],a[44:47],v[196:199]
M v[196:199],a[160:163],a[40:43],v[196:199]
s_nop 0
T a[156:157],v4,24576
T a[158:159],v4,25600
M v[200:203],a[160:163],a[48:51],v[200:203]
buffer_load_dwordx4 v11, s[16:19], s21 offen offset:3072   lds
M v[200:203],a[164:167],a[52:55],v[200:203]
SA s21,s21,128
M v[204:207],a[164:167],a[60:63],v[204:207]
M v[204:207],a[160:163],a[56:59],v[204:207]
M v[208:211],a[160:163],a[64:67],v[208:211]
M v[208:211],a[164:167],a[68:71],v[208:211]
M v[212:215],a[164:167],a[76:79],v[212:215]
M v[212:215],a[160:163],a[72:75],v[212:215]
M v[216:219],a[160:163],a[80:83],v[216:219]
M v[216:219],a[164:167],a[84:87],v[216:219]
s_waitcnt lgkmcnt(2)
M v[220:223],a[164:167],a[92:95],v[220:223]
s_waitcnt vmcnt(16) lgkmcnt(0)
M v[220:223],a[160:163],a[88:91],v[220:223]
s_barrier
M v[252:255],a[168:171],a[88:91],v[252:255]
R a[160:163],v5,0
R a[164:167],v6,0
M v[252:255],a[172:175],a[92:95],v[252:255]
M v[248:251],a[172:175],a[84:87],v[248:251]
M v[248:251],a[168:171],a[80:83],v[248:251]
M v[244:247],a[168:171],a[72:75],v[244:247]
M v[244:247],a[172:175],a[76:79],v[244:247]
M v[240:243],a[172:175],a[68:71],v[240:243]
M v[240:243],a[168:171],a[64:67],v[240:243]
M v[236:239],a[168:171],a[56:59],v[236:239]
M v[236:239],a[172:175],a[60:63],v[236:239]
M v[232:235],a[172:175],a[52:55],v[232:235]
M v[232:235],a[168:171],a[48:51],v[232:235]
M v[228:231],a[168:171],a[40:43],v[228:231]
M v[228:231],a[172:175],a[44:47],v[228:231]
s_waitcnt lgkmcnt(0)
M v[224:227],a[172:175],a[36:39],v[224:227]
M v[224:227],a[168:171],a[32:35],v[224:227]
M a[0:3],a[160:163],a[96:99],a[0:3]
R a[168:171],v5,2048
R a[172:175],v6,2048
M a[0:3],a[164:167],a[100:103],a[0:3]
T a[32:33],v1,32768
T a[34:35],v1,33792
M a[4:7],a[164:167],a[108:111],a[4:7]
SA m0,s24,49152
G v28,a195
G v29,a199
M a[4:7],a[160:163],a[104:107],a[4:7]
buffer_load_dwordx4 v12, s[48:51], s22 offen offset:0   lds
M a[8:11],a[160:163],a[112:115],a[8:11]
v_lshlrev_b32 v27, 16, v28
v_lshlrev_b32 v25, 16, v29
M a[8:11],a[164:167],a[116:119],a[8:11]
v_and_b32 v28, 0xffff0000, v28
v_and_b32 v29, 0xffff0000, v29
M a[12:15],a[164:167],a[124:127],a[12:15]
T a[36:37],v1,40960
T a[38:39],v1,41984
M a[12:15],a[160:163],a[120:123],a[12:15]
G v30,a179
v_lshlrev_b32 v31, 16, v30
M a[16:19],a[160:163],a[128:131],a[16:19]
buffer_load_dwordx4 v13, s[48:51], s22 offen offset:1024   lds
M a[16:19],a[164:167],a[132:135],a[16:19]
v_and_b32 v30, 0xffff0000, v30
v_fmac_f32 v16, v31, v27
M a[20:23],a[164:167],a[140:143],a[20:23]
v_fmac_f32 v20, v31, v25
v_fmac_f32 v16, v30, v28
M a[20:23],a[160:163],a[136:139],a[20:23]
T a[40:41],v2,32768
T a[42:43],v2,33792
M a[24:27],a[160:163],a[144:147],a[24:27]
v_fmac_f32 v20, v30, v29
G v30,a183
M a[24:27],a[164:167],a[148:151],a[24:27]
s_waitcnt lgkmcnt(6)
buffer_load_dwordx4 v14, s[48:51], s22 offen offset:2048   lds
M a[28:31],a[164:167],a[156:159],a[28:31]
v_lshlrev_b32 v31, 16, v30
v_and_b32 v30, 0xffff0000, v30
M a[28:31],a[160:163],a[152:155],a[28:31]
v_fmac_f32 v17, v31, v27
v_fmac_f32 v21, v31, v25
M v[60:63],a[168:171],a[152:155],v[60:63]
R a[160:163],v5,4096
R a[164:167],v6,4096
M v[60:63],a[172:175],a[156:159],v[60:63]
T a[44:45],v2,40960
T a[46:47],v2,41984
M v[56:59],a[172:175],a[148:151],v[56:59]
buffer_load_dwordx4 v15, s[48:51], s22 offen offset:3072   lds
M v[56:59],a[168:171],a[144:147],v[56:59]
s_sub_u32 s22, s22, 1048448
v_fmac_f32 v17, v30, v28
v_fmac_f32 v21, v30, v29
M v[52:55],a[168:171],a[136:139],v[52:55]
G v30,a187
v_lshlrev_b32 v31, 16, v30
M v[52:55],a[172:175],a[140:143],v[52:55]
T a[48:49],v3,32768
T a[50:51],v3,33792
M v[48:51],a[172:175],a[132:135],v[48:51]
SA m0,s23,16384
v_and_b32 v30, 0xffff0000, v30
v_fmac_f32 v18, v31, v27
M v[48:51],a[168:171],a[128:131],v[48:51]
buffer_load_dwordx4 v8, s[16:19], s21 offen offset:0   lds
M v[44:47],a[168:171],a[120:123],v[44:47]
v_fmac_f32 v22, v31, v25
v_fmac_f32 v18, v30, v28
M v[44:47],a[172:175],a[124:127],v[44:47]
v_fmac_f32 v22, v30, v29
G v30,a191
M v[40:43],a[172:175],a[116:119],v[40:43]
T a[52:53],v3,40960
T a[54:55],v3,41984
M v[40:43],a[168:171],a[112:115],v[40:43]
v_lshlrev_b32 v31, 16, v30
v_and_b32 v30, 0xffff0000, v30
M v[36:39],a[168:171],a[104:107],v[36:39]
buffer_load_dwordx4 v9, s[16:19], s21 offen offset:1024   lds
M v[36:39],a[172:175],a[108:111],v[36:39]
s_waitcnt lgkmcnt(6)
v_fmac_f32 v19, v31, v27
v_fmac_f32 v23, v31, v25
M v[32:35],a[172:175],a[100:103],v[32:35]
v_fmac_f32 v19, v30, v28
v_fmac_f32 v23, v30, v29
M v[32:35],a[168:171],a[96:99],v[32:35]
T a[56:57],v4,32768
T a[58:59],v4,33792
M v[64:67],a[160:163],a[96:99],v[64:67]
R a[168:171],v5,6144
R a[172:175],v6,6144
M v[64:67],a[164:167],a[100:103],v[64:67]
buffer_load_dwordx4 v10, s[16:19], s21 offen offset:2048   lds
M v[68:71],a[164:167],a[108:111],v[68:71]
v_permlane32_swap_b32 v16, v18
M v[68:71],a[160:163],a[104:107],v[68:71]
v_permlane32_swap_b32 v17, v19
M v[72:75],a[160:163],a[112:115],v[72:75]
s_nop 0
T a[60:61],v4,40960
T a[62:63],v4,41984
M v[72:75],a[164:167],a[116:119],v[72:75]
v_permlane32_swap_b32 v20, v22
M v[76:79],a[164:167],a[124:127],v[76:79]
buffer_load_dwordx4 v11, s[16:19], s21 offen offset:3072   lds
M v[76:79],a[160:163],a[120:123],v[76:79]
SA s21,s21,524160
v_permlane32_swap_b32 v21, v23
M v[80:83],a[160:163],a[128:131],v[80:83]
AF v16,v16,v18
AF v17,v17,v19
M v[80:83],a[164:167],a[132:135],v[80:83]
AF v20,v20,v22
AF v21,v21,v23
M v[84:87],a[164:167],a[140:143],v[84:87]
v_lshrrev_b32 v28, 4, v0
M v[84:87],a[160:163],a[136:139],v[84:87]
v_permlane16_swap_b32 v16, v17
M v[88:91],a[160:163],a[144:147],v[88:91]
v_permlane16_swap_b32 v20, v21
M v[88:91],a[164:167],a[148:151],v[88:91]
s_waitcnt lgkmcnt(2)
AF v16,v16,v17
AF v20,v20,v21
M v[92:95],a[164:167],a[156:159],v[92:95]
s_waitcnt vmcnt(16) lgkmcnt(0)
v_add_u32 v29, s67, v28
v_add_f32 v16, v16, v16 row_ror:8 row_mask:0xf bank_mask:0xf
M v[92:95],a[160:163],a[152:155],v[92:95]
s_barrier
M v[124:127],a[168:171],a[152:155],v[124:127]
R a[160:163],v5,16384
R a[164:167],v6,16384
M v[124:127],a[172:175],a[156:159],v[124:127]
v_add_f32 v20, v20, v20 row_ror:8 row_mask:0xf bank_mask:0xf
v_add_f32 v16, v16, v16 row_ror:4 row_mask:0xf bank_mask:0xf
M v[120:123],a[172:175],a[148:151],v[120:123]
SA m0,s24,0
T a[64:65],v1,49152
T a[66:67],v1,50176
M v[120:123],a[168:171],a[144:147],v[120:123]
buffer_load_dwordx4 v12, s[48:51], s22 offen offset:0   lds
M v[116:119],a[168:171],a[136:139],v[116:119]
v_add_f32 v20, v20, v20 row_ror:4 row_mask:0xf bank_mask:0xf
v_add_f32 v16, v16, v16 row_ror:2 row_mask:0xf bank_mask:0xf
M v[116:119],a[172:175],a[140:143],v[116:119]
v_add_f32 v20, v20, v20 row_ror:2 row_mask:0xf bank_mask:0xf
v_add_f32 v16, v16, v16 row_ror:1 row_mask:0xf bank_mask:0xf
M v[112:115],a[172:175],a[132:135],v[112:115]
v_add_f32 v20, v20, v20 row_ror:1 row_mask:0xf bank_mask:0xf
v_ashrrev_i32 v30, 31, v16
M v[112:115],a[168:171],a[128:131],v[112:115]
v_or_b32 v30, 0x80000000, v30
v_xor_b32 v30, v30, v16
M v[108:111],a[168:171],a[120:123],v[108:111]
v_and_b32 v30, 0xfffff800, v30
v_sub_u32 v29, 2047, v29
M v[108:111],a[172:175],a[124:127],v[108:111]
T a[68:69],v1,57344
T a[70:71],v1,58368
M v[104:107],a[172:175],a[116:119],v[104:107]
buffer_load_dwordx4 v13, s[48:51], s22 offen offset:1024   lds
M v[104:107],a[168:171],a[112:115],v[104:107]
v_or_b32 v30, v30, v29
v_max_u32 v30, 1, v30
M v[100:103],a[168:171],a[104:107],v[100:103]
MF v21,0xbfb8aa3b,v20
M v[100:103],a[172:175],a[108:111],v[100:103]
s_waitcnt lgkmcnt(4)
E v21,v21
M v[96:99],a[172:175],a[100:103],v[96:99]
AF v21,1.0,v21
M v[96:99],a[168:171],a[96:99],v[96:99]
v_rcp_f32 v20, v21
M v[128:131],a[160:163],a[96:99],v[128:131]
s_lshl_b32 s72, s20, 4
R a[168:171],v5,18432
R a[172:175],v6,18432
M v[128:131],a[164:167],a[100:103],v[128:131]
SA s72,s72,163584
T a[72:73],v2,49152
T a[74:75],v2,50176
M v[132:135],a[164:167],a[108:111],v[132:135]
buffer_load_dwordx4 v14, s[48:51], s22 offen offset:2048   lds
M v[132:135],a[160:163],a[104:107],v[132:135]
v_lshl_add_u32 v28, v28, 2, s72
ds_write_b32 v28, v30
M v[136:139],a[160:163],a[112:115],v[136:139]
ds_write_b32 v28, v16 offset:64
ds_write_b32 v28, v20 offset:128
M v[136:139],a[164:167],a[116:119],v[136:139]
M v[140:143],a[164:167],a[124:127],v[140:143]
M v[140:143],a[160:163],a[120:123],v[140:143]
s_nop 0
T a[76:77],v2,57344
T a[78:79],v2,58368
M v[144:147],a[160:163],a[128:131],v[144:147]
buffer_load_dwordx4 v15, s[48:51], s22 offen offset:3072   lds
M v[144:147],a[164:167],a[132:135],v[144:147]
SA s22,s22,1048576
M v[148:151],a[164:167],a[140:143],v[148:151]
M v[148:151],a[160:163],a[136:139],v[148:151]
M v[152:155],a[160:163],a[144:147],v[152:155]
M v[152:155],a[164:167],a[148:151],v[152:155]
s_waitcnt lgkmcnt(7)
M v[156:159],a[164:167],a[156:159],v[156:159]
SA m0,s23,32768
T a[80:81],v3,49152
T a[82:83],v3,50176
M v[156:159],a[160:163],a[152:155],v[156:159]
buffer_load_dwordx4 v8, s[16:19], s21 offen offset:0   lds
M v[188:191],a[168:171],a[152:155],v[188:191]
R a[160:163],v5,20480
R a[164:167],v6,20480
M v[188:191],a[172:175],a[156:159],v[188:191]
M v[184:187],a[172:175],a[148:151],v[184:187]
M v[184:187],a[168:171],a[144:147],v[184:187]
M v[180:183],a[168:171],a[136:139],v[180:183]
M v[180:183],a[172:175],a[140:143],v[180:183]
s_nop 0
T a[84:85],v3,57344
T a[86:87],v3,58368
M v[176:179],a[172:175],a[132:135],v[176:179]
buffer_load_dwordx4 v9, s[16:19], s21 offen offset:1024   lds
M v[176:179],a[168:171],a[128:131],v[176:179]
M v[172:175],a[168:171],a[120:123],v[172:175]
M v[172:175],a[172:175],a[124:127],v[172:175]
M v[168:171],a[172:175],a[116:119],v[168:171]
M v[168:171],a[168:171],a[112:115],v[168:171]
M v[164:167],a[168:171],a[104:107],v[164:167]
s_nop 0
T a[88:89],v4,49152
T a[90:91],v4,50176
M v[164:167],a[172:175],a[108:111],v[164:167]
s_waitcnt lgkmcnt(4)
buffer_load_dwordx4 v10, s[16:19], s21 offen offset:2048   lds
M v[160:163],a[172:175],a[100:103],v[160:163]
M v[160:163],a[168:171],a[96:99],v[160:163]
M v[192:195],a[160:163],a[96:99],v[192:195]
R a[168:171],v5,22528
R a[172:175],v6,22528
M v[192:195],a[164:167],a[100:103],v[192:195]
M v[196:199],a[164:167],a[108:111],v[196:199]
M v[196:199],a[160:163],a[104:107],v[196:199]
s_nop 0
T a[92:93],v4,57344
T a[94:95],v4,58368
M v[200:203],a[160:163],a[112:115],v[200:203]
buffer_load_dwordx4 v11, s[16:19], s21 offen offset:3072   lds
M v[200:203],a[164:167],a[116:119],v[200:203]
SA s21,s21,128
M v[204:207],a[164:167],a[124:127],v[204:207]
M v[204:207],a[160:163],a[120:123],v[204:207]
M v[208:211],a[160:163],a[128:131],v[208:211]
M v[208:211],a[164:167],a[132:135],v[208:211]
M v[212:215],a[164:167],a[140:143],v[212:215]
M v[212:215],a[160:163],a[136:139],v[212:215]
M v[216:219],a[160:163],a[144:147],v[216:219]
M v[216:219],a[164:167],a[148:151],v[216:219]
s_waitcnt lgkmcnt(2)
M v[220:223],a[164:167],a[156:159],v[220:223]
s_waitcnt vmcnt(16) lgkmcnt(0)
M v[220:223],a[160:163],a[152:155],v[220:223]
s_barrier
M v[252:255],a[168:171],a[152:155],v[252:255]
R a[160:163],v5,32768
R a[164:167],v6,32768
M v[252:255],a[172:175],a[156:159],v[252:255]
M v[248:251],a[172:175],a[148:151],v[248:251]
M v[248:251],a[168:171],a[144:147],v[248:251]
M v[244:247],a[168:171],a[136:139],v[244:247]
M v[244:247],a[172:175],a[140:143],v[244:247]
M v[240:243],a[172:175],a[132:135],v[240:243]
M v[240:243],a[168:171],a[128:131],v[240:243]
M v[236:239],a[168:171],a[120:123],v[236:239]
M v[236:239],a[172:175],a[124:127],v[236:239]
M v[232:235],a[172:175],a[116:119],v[232:235]
M v[232:235],a[168:171],a[112:115],v[232:235]
M v[228:231],a[168:171],a[104:107],v[228:231]
M v[228:231],a[172:175],a[108:111],v[228:231]
s_waitcnt lgkmcnt(0)
M v[224:227],a[172:175],a[100:103],v[224:227]
M v[224:227],a[168:171],a[96:99],v[224:227]
M a[0:3],a[160:163],a[32:35],a[0:3]
R a[168:171],v5,34816
R a[172:175],v6,34816
M a[0:3],a[164:167],a[36:39],a[0:3]
T a[96:97],v1,0
T a[98:99],v1,1024
M a[4:7],a[164:167],a[44:47],a[4:7]
SA m0,s24,16384
M a[4:7],a[160:163],a[40:43],a[4:7]
buffer_load_dwordx4 v12, s[48:51], s22 offen offset:0   lds
M a[8:11],a[160:163],a[48:51],a[8:11]
v_and_b32 v20, 31, v0
M a[8:11],a[164:167],a[52:55],a[8:11]
v_lshlrev_b32 v20, 2, v20
M a[12:15],a[164:167],a[60:63],a[12:15]
s_nop 0
T a[100:101],v1,8192
T a[102:103],v1,9216
M a[12:15],a[160:163],a[56:59],a[12:15]
v_add_u32 v21, 163584, v20
M a[16:19],a[160:163],a[64:67],a[16:19]
buffer_load_dwordx4 v13, s[48:51], s22 offen offset:1024   lds
M a[16:19],a[164:167],a[68:71],a[16:19]
ds_read_b32 v19, v21
M a[20:23],a[164:167],a[76:79],a[20:23]
ds_read_b32 v21, v21 offset:64
M a[20:23],a[160:163],a[72:75],a[20:23]
s_min_u32 s64, s20, 1
T a[104:105],v2,0
T a[106:107],v2,1024
M a[24:27],a[160:163],a[80:83],a[24:27]
s_lshl_b32 s64, s64, 29
v_and_b32 v22, 32, v0
M a[24:27],a[164:167],a[84:87],a[24:27]
s_waitcnt lgkmcnt(8)
buffer_load_dwordx4 v14, s[48:51], s22 offen offset:2048   lds
M a[28:31],a[164:167],a[92:95],a[28:31]
v_lshl_or_b32 v20, v22, 24, v20
M a[28:31],a[160:163],a[88:91],a[28:31]
v_or_b32 v20, s64, v20
M v[60:63],a[168:171],a[88:91],v[60:63]
R a[160:163],v5,36864
R a[164:167],v6,36864
M v[60:63],a[172:175],a[92:95],v[60:63]
T a[108:109],v2,8192
T a[110:111],v2,9216
M v[56:59],a[172:175],a[84:87],v[56:59]
buffer_load_dwordx4 v15, s[48:51], s22 offen offset:3072   lds
M v[56:59],a[168:171],a[80:83],v[56:59]
s_sub_u32 s22, s22, 1048448
v_and_b32 v22, 16, v0
M v[52:55],a[168:171],a[72:75],v[52:55]
v_lshl_or_b32 v18, v22, 25, v20
s_and_b32 s27, s42, 7
M v[52:55],a[172:175],a[76:79],v[52:55]
s_lshl_b32 s72, s30, 7
T a[112:113],v3,0
T a[114:115],v3,1024
M v[48:51],a[172:175],a[68:71],v[48:51]
SA m0,s23,49152
SA s72,s72,104857600
s_lshl_b32 s64, s41, 3
M v[48:51],a[168:171],a[64:67],v[48:51]
SA s27,s27,s64
buffer_load_dwordx4 v8, s[16:19], s21 offen offset:0   lds
M v[44:47],a[168:171],a[56:59],v[44:47]
s_lshl_b32 s27, s27, 2
M v[44:47],a[172:175],a[60:63],v[44:47]
SA s27,s27,s20
M v[40:43],a[172:175],a[52:55],v[40:43]
s_mul_i32 s27, s27, 7168
T a[116:117],v3,8192
T a[118:119],v3,9216
M v[40:43],a[168:171],a[48:51],v[40:43]
s_mov_b32 s60, s90
M v[36:39],a[168:171],a[40:43],v[36:39]
s_and_b32 s61, s91, 0xffff
buffer_load_dwordx4 v9, s[16:19], s21 offen offset:1024   lds
M v[36:39],a[172:175],a[44:47],v[36:39]
s_waitcnt lgkmcnt(6)
buffer_store_dword v21, v20, s[8:11], s72 offen sc1
M v[32:35],a[172:175],a[36:39],v[32:35]
s_mov_b32 s62, 3670016
M v[32:35],a[168:171],a[32:35],v[32:35]
s_mov_b32 s63, 0x20000
T a[120:121],v4,0
T a[122:123],v4,1024
M v[64:67],a[160:163],a[32:35],v[64:67]
R a[168:171],v5,38912
R a[172:175],v6,38912
M v[64:67],a[164:167],a[36:39],v[64:67]
buffer_load_dwordx4 v10, s[16:19], s21 offen offset:2048   lds
M v[68:71],a[164:167],a[44:47],v[68:71]
M v[68:71],a[160:163],a[40:43],v[68:71]
M v[72:75],a[160:163],a[48:51],v[72:75]
s_nop 0
T a[124:125],v4,8192
T a[126:127],v4,9216
M v[72:75],a[164:167],a[52:55],v[72:75]
M v[76:79],a[164:167],a[60:63],v[76:79]
buffer_load_dwordx4 v11, s[16:19], s21 offen offset:3072   lds
M v[76:79],a[160:163],a[56:59],v[76:79]
SA s21,s21,524160
M v[80:83],a[160:163],a[64:67],v[80:83]
M v[80:83],a[164:167],a[68:71],v[80:83]
M v[84:87],a[164:167],a[76:79],v[84:87]
M v[84:87],a[160:163],a[72:75],v[84:87]
M v[88:91],a[160:163],a[80:83],v[88:91]
M v[88:91],a[164:167],a[84:87],v[88:91]
s_waitcnt lgkmcnt(2)
M v[92:95],a[164:167],a[92:95],v[92:95]
s_waitcnt vmcnt(17) lgkmcnt(0)
M v[92:95],a[160:163],a[88:91],v[92:95]
s_barrier
M v[124:127],a[168:171],a[88:91],v[124:127]
R a[160:163],v5,49152
R a[164:167],v6,49152
M v[124:127],a[172:175],a[92:95],v[124:127]
M v[120:123],a[172:175],a[84:87],v[120:123]
SA m0,s24,32768
T a[128:129],v1,16384
T a[130:131],v1,17408
M v[120:123],a[168:171],a[80:83],v[120:123]
buffer_load_dwordx4 v12, s[48:51], s22 offen offset:0   lds
M v[116:119],a[168:171],a[72:75],v[116:119]
v_min_u32 v16, 40, v0
v_lshlrev_b32 v16, 2, v16
M v[116:119],a[172:175],a[76:79],v[116:119]
buffer_load_dword v17, v16, s[12:15], 0 offen sc1
M v[112:115],a[172:175],a[68:71],v[112:115]
M v[112:115],a[168:171],a[64:67],v[112:115]
M v[108:111],a[168:171],a[56:59],v[108:111]
M v[108:111],a[172:175],a[60:63],v[108:111]
s_nop 0
T a[132:133],v1,24576
T a[134:135],v1,25600
M v[104:107],a[172:175],a[52:55],v[104:107]
buffer_load_dwordx4 v13, s[48:51], s22 offen offset:1024   lds
M v[104:107],a[168:171],a[48:51],v[104:107]
M v[100:103],a[168:171],a[40:43],v[100:103]
M v[100:103],a[172:175],a[44:47],v[100:103]
s_waitcnt lgkmcnt(4)
M v[96:99],a[172:175],a[36:39],v[96:99]
M v[96:99],a[168:171],a[32:35],v[96:99]
M v[128:131],a[160:163],a[32:35],v[128:131]
R a[168:171],v5,51200
R a[172:175],v6,51200
M v[128:131],a[164:167],a[36:39],v[128:131]
T a[136:137],v2,16384
T a[138:139],v2,17408
M v[132:135],a[164:167],a[44:47],v[132:135]
buffer_load_dwordx4 v14, s[48:51], s22 offen offset:2048   lds
M v[132:135],a[160:163],a[40:43],v[132:135]
M v[136:139],a[160:163],a[48:51],v[136:139]
M v[136:139],a[164:167],a[52:55],v[136:139]
M v[140:143],a[164:167],a[60:63],v[140:143]
M v[140:143],a[160:163],a[56:59],v[140:143]
s_nop 0
T a[140:141],v2,24576
T a[142:143],v2,25600
M v[144:147],a[160:163],a[64:67],v[144:147]
buffer_load_dwordx4 v15, s[48:51], s22 offen offset:3072   lds
M v[144:147],a[164:167],a[68:71],v[144:147]
SA s22,s22,1048576
M v[148:151],a[164:167],a[76:79],v[148:151]
M v[148:151],a[160:163],a[72:75],v[148:151]
M v[152:155],a[160:163],a[80:83],v[152:155]
M v[152:155],a[164:167],a[84:87],v[152:155]
s_waitcnt lgkmcnt(4)
M v[156:159],a[164:167],a[92:95],v[156:159]
SA m0,s23,0
T a[144:145],v3,16384
T a[146:147],v3,17408
M v[156:159],a[160:163],a[88:91],v[156:159]
buffer_load_dwordx4 v8, s[16:19], s21 offen offset:0   lds
M v[188:191],a[168:171],a[88:91],v[188:191]
R a[160:163],v5,53248
R a[164:167],v6,53248
M v[188:191],a[172:175],a[92:95],v[188:191]
buffer_load_dword a240, v26, s[60:63], s27 offen offset:0
M v[184:187],a[172:175],a[84:87],v[184:187]
SA s27,s27,2048
M v[184:187],a[168:171],a[80:83],v[184:187]
M v[180:183],a[168:171],a[72:75],v[180:183]
M v[180:183],a[172:175],a[76:79],v[180:183]
s_nop 0
T a[148:149],v3,24576
T a[150:151],v3,25600
M v[176:179],a[172:175],a[68:71],v[176:179]
buffer_load_dwordx4 v9, s[16:19], s21 offen offset:1024   lds
M v[176:179],a[168:171],a[64:67],v[176:179]
M v[172:175],a[168:171],a[56:59],v[172:175]
M v[172:175],a[172:175],a[60:63],v[172:175]
M v[168:171],a[172:175],a[52:55],v[168:171]
M v[168:171],a[168:171],a[48:51],v[168:171]
M v[164:167],a[168:171],a[40:43],v[164:167]
s_nop 0
T a[152:153],v4,16384
T a[154:155],v4,17408
M v[164:167],a[172:175],a[44:47],v[164:167]
s_waitcnt lgkmcnt(4)
buffer_load_dwordx4 v10, s[16:19], s21 offen offset:2048   lds
M v[160:163],a[172:175],a[36:39],v[160:163]
M v[160:163],a[168:171],a[32:35],v[160:163]
M v[192:195],a[160:163],a[32:35],v[192:195]
L_w_kv12:
s_cbranch_execz L_w_kv16
R a[168:171],v5,55296
R a[172:175],v6,55296
M v[192:195],a[164:167],a[36:39],v[192:195]
M v[196:199],a[164:167],a[44:47],v[196:199]
M v[196:199],a[160:163],a[40:43],v[196:199]
s_nop 0
T a[156:157],v4,24576
T a[158:159],v4,25600
M v[200:203],a[160:163],a[48:51],v[200:203]
buffer_load_dwordx4 v11, s[16:19], s21 offen offset:3072   lds
M v[200:203],a[164:167],a[52:55],v[200:203]
SA s21,s21,128
M v[204:207],a[164:167],a[60:63],v[204:207]
M v[204:207],a[160:163],a[56:59],v[204:207]
M v[208:211],a[160:163],a[64:67],v[208:211]
M v[208:211],a[164:167],a[68:71],v[208:211]
M v[212:215],a[164:167],a[76:79],v[212:215]
M v[212:215],a[160:163],a[72:75],v[212:215]
M v[216:219],a[160:163],a[80:83],v[216:219]
M v[216:219],a[164:167],a[84:87],v[216:219]
s_waitcnt lgkmcnt(2)
M v[220:223],a[164:167],a[92:95],v[220:223]
s_waitcnt vmcnt(19) lgkmcnt(0)
M v[220:223],a[160:163],a[88:91],v[220:223]
s_barrier
M v[252:255],a[168:171],a[88:91],v[252:255]
R a[160:163],v5,0
R a[164:167],v6,0
M v[252:255],a[172:175],a[92:95],v[252:255]
M v[248:251],a[172:175],a[84:87],v[248:251]
M v[248:251],a[168:171],a[80:83],v[248:251]
M v[244:247],a[168:171],a[72:75],v[244:247]
M v[244:247],a[172:175],a[76:79],v[244:247]
M v[240:243],a[172:175],a[68:71],v[240:243]
M v[240:243],a[168:171],a[64:67],v[240:243]
M v[236:239],a[168:171],a[56:59],v[236:239]
M v[236:239],a[172:175],a[60:63],v[236:239]
M v[232:235],a[172:175],a[52:55],v[232:235]
M v[232:235],a[168:171],a[48:51],v[232:235]
M v[228:231],a[168:171],a[40:43],v[228:231]
M v[228:231],a[172:175],a[44:47],v[228:231]
s_waitcnt lgkmcnt(0)
M v[224:227],a[172:175],a[36:39],v[224:227]
M v[224:227],a[168:171],a[32:35],v[224:227]
M a[0:3],a[160:163],a[96:99],a[0:3]
R a[168:171],v5,2048
R a[172:175],v6,2048
M a[0:3],a[164:167],a[100:103],a[0:3]
T a[32:33],v1,32768
T a[34:35],v1,33792
M a[4:7],a[164:167],a[108:111],a[4:7]
SA m0,s24,49152
M a[4:7],a[160:163],a[104:107],a[4:7]
buffer_load_dwordx4 v12, s[48:51], s22 offen offset:0   lds
M a[8:11],a[160:163],a[112:115],a[8:11]
M a[8:11],a[164:167],a[116:119],a[8:11]
M a[12:15],a[164:167],a[124:127],a[12:15]
s_nop 0
T a[36:37],v1,40960
T a[38:39],v1,41984
M a[12:15],a[160:163],a[120:123],a[12:15]
M a[16:19],a[160:163],a[128:131],a[16:19]
buffer_load_dwordx4 v13, s[48:51], s22 offen offset:1024   lds
M a[16:19],a[164:167],a[132:135],a[16:19]
M a[20:23],a[164:167],a[140:143],a[20:23]
M a[20:23],a[160:163],a[136:139],a[20:23]
s_nop 0
T a[40:41],v2,32768
T a[42:43],v2,33792
M a[24:27],a[160:163],a[144:147],a[24:27]
M a[24:27],a[164:167],a[148:151],a[24:27]
s_waitcnt lgkmcnt(6)
buffer_load_dwordx4 v14, s[48:51], s22 offen offset:2048   lds
M a[28:31],a[164:167],a[156:159],a[28:31]
M a[28:31],a[160:163],a[152:155],a[28:31]
M v[60:63],a[168:171],a[152:155],v[60:63]
R a[160:163],v5,4096
R a[164:167],v6,4096
M v[60:63],a[172:175],a[156:159],v[60:63]
T a[44:45],v2,40960
T a[46:47],v2,41984
M v[56:59],a[172:175],a[148:151],v[56:59]
buffer_load_dwordx4 v15, s[48:51], s22 offen offset:3072   lds
M v[56:59],a[168:171],a[144:147],v[56:59]
s_sub_u32 s22, s22, 1048448
M v[52:55],a[168:171],a[136:139],v[52:55]
M v[52:55],a[172:175],a[140:143],v[52:55]
s_nop 0
T a[48:49],v3,32768
T a[50:51],v3,33792
M v[48:51],a[172:175],a[132:135],v[48:51]
SA m0,s23,16384
M v[48:51],a[168:171],a[128:131],v[48:51]
buffer_load_dwordx4 v8, s[16:19], s21 offen offset:0   lds
M v[44:47],a[168:171],a[120:123],v[44:47]
M v[44:47],a[172:175],a[124:127],v[44:47]
M v[40:43],a[172:175],a[116:119],v[40:43]
s_nop 0
T a[52:53],v3,40960
T a[54:55],v3,41984
M v[40:43],a[168:171],a[112:115],v[40:43]
M v[36:39],a[168:171],a[104:107],v[36:39]
buffer_load_dwordx4 v9, s[16:19], s21 offen offset:1024   lds
M v[36:39],a[172:175],a[108:111],v[36:39]
s_waitcnt lgkmcnt(6)
M v[32:35],a[172:175],a[100:103],v[32:35]
M v[32:35],a[168:171],a[96:99],v[32:35]
s_nop 0
T a[56:57],v4,32768
T a[58:59],v4,33792
M v[64:67],a[160:163],a[96:99],v[64:67]
R a[168:171],v5,6144
R a[172:175],v6,6144
M v[64:67],a[164:167],a[100:103],v[64:67]
buffer_load_dwordx4 v10, s[16:19], s21 offen offset:2048   lds
M v[68:71],a[164:167],a[108:111],v[68:71]
M v[68:71],a[160:163],a[104:107],v[68:71]
M v[72:75],a[160:163],a[112:115],v[72:75]
s_nop 0
T a[60:61],v4,40960
T a[62:63],v4,41984
M v[72:75],a[164:167],a[116:119],v[72:75]
M v[76:79],a[164:167],a[124:127],v[76:79]
buffer_load_dwordx4 v11, s[16:19], s21 offen offset:3072   lds
M v[76:79],a[160:163],a[120:123],v[76:79]
SA s21,s21,524160
M v[80:83],a[160:163],a[128:131],v[80:83]
M v[80:83],a[164:167],a[132:135],v[80:83]
M v[84:87],a[164:167],a[140:143],v[84:87]
M v[84:87],a[160:163],a[136:139],v[84:87]
M v[88:91],a[160:163],a[144:147],v[88:91]
M v[88:91],a[164:167],a[148:151],v[88:91]
s_waitcnt lgkmcnt(2)
M v[92:95],a[164:167],a[156:159],v[92:95]
s_waitcnt vmcnt(18) lgkmcnt(0)
M v[92:95],a[160:163],a[152:155],v[92:95]
s_barrier
M v[124:127],a[168:171],a[152:155],v[124:127]
R a[160:163],v5,16384
R a[164:167],v6,16384
M v[124:127],a[172:175],a[156:159],v[124:127]
M v[120:123],a[172:175],a[148:151],v[120:123]
SA m0,s24,0
T a[64:65],v1,49152
T a[66:67],v1,50176
M v[120:123],a[168:171],a[144:147],v[120:123]
buffer_load_dwordx4 v12, s[48:51], s22 offen offset:0   lds
M v[116:119],a[168:171],a[136:139],v[116:119]
M v[116:119],a[172:175],a[140:143],v[116:119]
M v[112:115],a[172:175],a[132:135],v[112:115]
M v[112:115],a[168:171],a[128:131],v[112:115]
M v[108:111],a[168:171],a[120:123],v[108:111]
M v[108:111],a[172:175],a[124:127],v[108:111]
s_nop 0
T a[68:69],v1,57344
T a[70:71],v1,58368
M v[104:107],a[172:175],a[116:119],v[104:107]
buffer_load_dwordx4 v13, s[48:51], s22 offen offset:1024   lds
M v[104:107],a[168:171],a[112:115],v[104:107]
M v[100:103],a[168:171],a[104:107],v[100:103]
M v[100:103],a[172:175],a[108:111],v[100:103]
s_waitcnt lgkmcnt(4)
M v[96:99],a[172:175],a[100:103],v[96:99]
M v[96:99],a[168:171],a[96:99],v[96:99]
M v[128:131],a[160:163],a[96:99],v[128:131]
R a[168:171],v5,18432
R a[172:175],v6,18432
M v[128:131],a[164:167],a[100:103],v[128:131]
T a[72:73],v2,49152
T a[74:75],v2,50176
M v[132:135],a[164:167],a[108:111],v[132:135]
buffer_load_dwordx4 v14, s[48:51], s22 offen offset:2048   lds
M v[132:135],a[160:163],a[104:107],v[132:135]
M v[136:139],a[160:163],a[112:115],v[136:139]
M v[136:139],a[164:167],a[116:119],v[136:139]
M v[140:143],a[164:167],a[124:127],v[140:143]
M v[140:143],a[160:163],a[120:123],v[140:143]
s_nop 0
T a[76:77],v2,57344
T a[78:79],v2,58368
M v[144:147],a[160:163],a[128:131],v[144:147]
buffer_load_dwordx4 v15, s[48:51], s22 offen offset:3072   lds
M v[144:147],a[164:167],a[132:135],v[144:147]
SA s22,s22,1048576
M v[148:151],a[164:167],a[140:143],v[148:151]
M v[148:151],a[160:163],a[136:139],v[148:151]
M v[152:155],a[160:163],a[144:147],v[152:155]
M v[152:155],a[164:167],a[148:151],v[152:155]
s_waitcnt lgkmcnt(4)
M v[156:159],a[164:167],a[156:159],v[156:159]
SA m0,s23,32768
T a[80:81],v3,49152
T a[82:83],v3,50176
M v[156:159],a[160:163],a[152:155],v[156:159]
buffer_load_dwordx4 v8, s[16:19], s21 offen offset:0   lds
M v[188:191],a[168:171],a[152:155],v[188:191]
R a[160:163],v5,20480
R a[164:167],v6,20480
M v[188:191],a[172:175],a[156:159],v[188:191]
buffer_load_dword a240, v26, s[60:63], s27 offen offset:0
M v[184:187],a[172:175],a[148:151],v[184:187]
SA s27,s27,2048
M v[184:187],a[168:171],a[144:147],v[184:187]
M v[180:183],a[168:171],a[136:139],v[180:183]
M v[180:183],a[172:175],a[140:143],v[180:183]
s_nop 0
T a[84:85],v3,57344
T a[86:87],v3,58368
M v[176:179],a[172:175],a[132:135],v[176:179]
buffer_load_dwordx4 v9, s[16:19], s21 offen offset:1024   lds
M v[176:179],a[168:171],a[128:131],v[176:179]
M v[172:175],a[168:171],a[120:123],v[172:175]
M v[172:175],a[172:175],a[124:127],v[172:175]
M v[168:171],a[172:175],a[116:119],v[168:171]
M v[168:171],a[168:171],a[112:115],v[168:171]
M v[164:167],a[168:171],a[104:107],v[164:167]
s_nop 0
T a[88:89],v4,49152
T a[90:91],v4,50176
M v[164:167],a[172:175],a[108:111],v[164:167]
s_waitcnt lgkmcnt(4)
buffer_load_dwordx4 v10, s[16:19], s21 offen offset:2048   lds
M v[160:163],a[172:175],a[100:103],v[160:163]
M v[160:163],a[168:171],a[96:99],v[160:163]
M v[192:195],a[160:163],a[96:99],v[192:195]
R a[168:171],v5,22528
R a[172:175],v6,22528
M v[192:195],a[164:167],a[100:103],v[192:195]
M v[196:199],a[164:167],a[108:111],v[196:199]
M v[196:199],a[160:163],a[104:107],v[196:199]
s_nop 0
T a[92:93],v4,57344
T a[94:95],v4,58368
M v[200:203],a[160:163],a[112:115],v[200:203]
buffer_load_dwordx4 v11, s[16:19], s21 offen offset:3072   lds
M v[200:203],a[164:167],a[116:119],v[200:203]
SA s21,s21,128
M v[204:207],a[164:167],a[124:127],v[204:207]
M v[204:207],a[160:163],a[120:123],v[204:207]
M v[208:211],a[160:163],a[128:131],v[208:211]
M v[208:211],a[164:167],a[132:135],v[208:211]
M v[212:215],a[164:167],a[140:143],v[212:215]
M v[212:215],a[160:163],a[136:139],v[212:215]
M v[216:219],a[160:163],a[144:147],v[216:219]
M v[216:219],a[164:167],a[148:151],v[216:219]
s_waitcnt lgkmcnt(2)
M v[220:223],a[164:167],a[156:159],v[220:223]
s_waitcnt vmcnt(17) lgkmcnt(0)
M v[220:223],a[160:163],a[152:155],v[220:223]
s_barrier
M v[252:255],a[168:171],a[152:155],v[252:255]
R a[160:163],v5,32768
R a[164:167],v6,32768
M v[252:255],a[172:175],a[156:159],v[252:255]
v_cmp_ne_u32 vcc, 1, v17
M v[248:251],a[172:175],a[148:151],v[248:251]
s_nop 0
M v[248:251],a[168:171],a[144:147],v[248:251]
s_cbranch_vccnz L_zs1
L_zr1:
M v[244:247],a[168:171],a[136:139],v[244:247]
M v[244:247],a[172:175],a[140:143],v[244:247]
s_lshl_b32 s72, s30, 6
M v[240:243],a[172:175],a[132:135],v[240:243]
SA s72,s72,104914944
M v[240:243],a[168:171],a[128:131],v[240:243]
buffer_store_dword v19, v18, s[8:11], s72 offen sc1
M v[236:239],a[168:171],a[120:123],v[236:239]
M v[236:239],a[172:175],a[124:127],v[236:239]
M v[232:235],a[172:175],a[116:119],v[232:235]
M v[232:235],a[168:171],a[112:115],v[232:235]
M v[228:231],a[168:171],a[104:107],v[228:231]
M v[228:231],a[172:175],a[108:111],v[228:231]
s_waitcnt lgkmcnt(0)
M v[224:227],a[172:175],a[100:103],v[224:227]
M v[224:227],a[168:171],a[96:99],v[224:227]
M a[0:3],a[160:163],a[32:35],a[0:3]
R a[168:171],v5,34816
R a[172:175],v6,34816
M a[0:3],a[164:167],a[36:39],a[0:3]
T a[96:97],v1,0
T a[98:99],v1,1024
M a[4:7],a[164:167],a[44:47],a[4:7]
SA m0,s24,16384
M a[4:7],a[160:163],a[40:43],a[4:7]
buffer_load_dwordx4 v12, s[48:51], s22 offen offset:0   lds
M a[8:11],a[160:163],a[48:51],a[8:11]
M a[8:11],a[164:167],a[52:55],a[8:11]
s_mul_i32 s64, s41, 229376
M a[12:15],a[164:167],a[60:63],a[12:15]
SA s72,s90,s64
T a[100:101],v1,8192
T a[102:103],v1,9216
M a[12:15],a[160:163],a[56:59],a[12:15]
s_addc_u32 s73, s91, 0
M a[16:19],a[160:163],a[64:67],a[16:19]
s_sub_u32 s75, 3670016, s64
buffer_load_dwordx4 v13, s[48:51], s22 offen offset:1024   lds
M a[16:19],a[164:167],a[68:71],a[16:19]
s_mov_b32 s12, s72
M a[20:23],a[164:167],a[76:79],a[20:23]
s_and_b32 s13, s73, 0xffff
M a[20:23],a[160:163],a[72:75],a[20:23]
s_mov_b32 s14, s75
T a[104:105],v2,0
T a[106:107],v2,1024
M a[24:27],a[160:163],a[80:83],a[24:27]
s_mov_b32 s15, 0x20000
M a[24:27],a[164:167],a[84:87],a[24:27]
s_waitcnt lgkmcnt(6)
buffer_load_dwordx4 v14, s[48:51], s22 offen offset:2048   lds
M a[28:31],a[164:167],a[92:95],a[28:31]
M a[28:31],a[160:163],a[88:91],a[28:31]
M v[60:63],a[168:171],a[88:91],v[60:63]
R a[160:163],v5,36864
R a[164:167],v6,36864
M v[60:63],a[172:175],a[92:95],v[60:63]
T a[108:109],v2,8192
T a[110:111],v2,9216
M v[56:59],a[172:175],a[84:87],v[56:59]
buffer_load_dwordx4 v15, s[48:51], s22 offen offset:3072   lds
M v[56:59],a[168:171],a[80:83],v[56:59]
s_sub_u32 s22, s22, 1048448
M v[52:55],a[168:171],a[72:75],v[52:55]
M v[52:55],a[172:175],a[76:79],v[52:55]
s_nop 0
T a[112:113],v3,0
T a[114:115],v3,1024
M v[48:51],a[172:175],a[68:71],v[48:51]
SA m0,s23,49152
M v[48:51],a[168:171],a[64:67],v[48:51]
buffer_load_dwordx4 v8, s[16:19], s21 offen offset:0   lds
M v[44:47],a[168:171],a[56:59],v[44:47]
M v[44:47],a[172:175],a[60:63],v[44:47]
M v[40:43],a[172:175],a[52:55],v[40:43]
s_nop 0
T a[116:117],v3,8192
T a[118:119],v3,9216
M v[40:43],a[168:171],a[48:51],v[40:43]
M v[36:39],a[168:171],a[40:43],v[36:39]
buffer_load_dwordx4 v9, s[16:19], s21 offen offset:1024   lds
M v[36:39],a[172:175],a[44:47],v[36:39]
s_waitcnt lgkmcnt(6)
M v[32:35],a[172:175],a[36:39],v[32:35]
M v[32:35],a[168:171],a[32:35],v[32:35]
s_nop 0
T a[120:121],v4,0
T a[122:123],v4,1024
M v[64:67],a[160:163],a[32:35],v[64:67]
R a[168:171],v5,38912
R a[172:175],v6,38912
M v[64:67],a[164:167],a[36:39],v[64:67]
buffer_load_dwordx4 v10, s[16:19], s21 offen offset:2048   lds
M v[68:71],a[164:167],a[44:47],v[68:71]
M v[68:71],a[160:163],a[40:43],v[68:71]
M v[72:75],a[160:163],a[48:51],v[72:75]
s_nop 0
T a[124:125],v4,8192
T a[126:127],v4,9216
M v[72:75],a[164:167],a[52:55],v[72:75]
M v[76:79],a[164:167],a[60:63],v[76:79]
buffer_load_dwordx4 v11, s[16:19], s21 offen offset:3072   lds
M v[76:79],a[160:163],a[56:59],v[76:79]
SA s21,s21,524160
M v[80:83],a[160:163],a[64:67],v[80:83]
M v[80:83],a[164:167],a[68:71],v[80:83]
M v[84:87],a[164:167],a[76:79],v[84:87]
M v[84:87],a[160:163],a[72:75],v[84:87]
M v[88:91],a[160:163],a[80:83],v[88:91]
M v[88:91],a[164:167],a[84:87],v[88:91]
s_waitcnt lgkmcnt(2)
M v[92:95],a[164:167],a[92:95],v[92:95]
s_waitcnt vmcnt(18) lgkmcnt(0)
M v[92:95],a[160:163],a[88:91],v[92:95]
s_barrier
M v[124:127],a[168:171],a[88:91],v[124:127]
R a[160:163],v5,49152
R a[164:167],v6,49152
M v[124:127],a[172:175],a[92:95],v[124:127]
M v[120:123],a[172:175],a[84:87],v[120:123]
SA m0,s24,32768
T a[128:129],v1,16384
T a[130:131],v1,17408
M v[120:123],a[168:171],a[80:83],v[120:123]
buffer_load_dwordx4 v12, s[48:51], s22 offen offset:0   lds
M v[116:119],a[168:171],a[72:75],v[116:119]
M v[116:119],a[172:175],a[76:79],v[116:119]
M v[112:115],a[172:175],a[68:71],v[112:115]
M v[112:115],a[168:171],a[64:67],v[112:115]
M v[108:111],a[168:171],a[56:59],v[108:111]
M v[108:111],a[172:175],a[60:63],v[108:111]
s_nop 0
T a[132:133],v1,24576
T a[134:135],v1,25600
M v[104:107],a[172:175],a[52:55],v[104:107]
buffer_load_dwordx4 v13, s[48:51], s22 offen offset:1024   lds
M v[104:107],a[168:171],a[48:51],v[104:107]
M v[100:103],a[168:171],a[40:43],v[100:103]
M v[100:103],a[172:175],a[44:47],v[100:103]
s_waitcnt lgkmcnt(4)
M v[96:99],a[172:175],a[36:39],v[96:99]
M v[96:99],a[168:171],a[32:35],v[96:99]
M v[128:131],a[160:163],a[32:35],v[128:131]
R a[168:171],v5,51200
R a[172:175],v6,51200
M v[128:131],a[164:167],a[36:39],v[128:131]
T a[136:137],v2,16384
T a[138:139],v2,17408
M v[132:135],a[164:167],a[44:47],v[132:135]
buffer_load_dwordx4 v14, s[48:51], s22 offen offset:2048   lds
M v[132:135],a[160:163],a[40:43],v[132:135]
M v[136:139],a[160:163],a[48:51],v[136:139]
M v[136:139],a[164:167],a[52:55],v[136:139]
M v[140:143],a[164:167],a[60:63],v[140:143]
M v[140:143],a[160:163],a[56:59],v[140:143]
s_nop 0
T a[140:141],v2,24576
T a[142:143],v2,25600
M v[144:147],a[160:163],a[64:67],v[144:147]
buffer_load_dwordx4 v15, s[48:51], s22 offen offset:3072   lds
M v[144:147],a[164:167],a[68:71],v[144:147]
SA s22,s22,1048576
M v[148:151],a[164:167],a[76:79],v[148:151]
M v[148:151],a[160:163],a[72:75],v[148:151]
M v[152:155],a[160:163],a[80:83],v[152:155]
M v[152:155],a[164:167],a[84:87],v[152:155]
s_waitcnt lgkmcnt(4)
M v[156:159],a[164:167],a[92:95],v[156:159]
SA m0,s23,0
T a[144:145],v3,16384
T a[146:147],v3,17408
M v[156:159],a[160:163],a[88:91],v[156:159]
buffer_load_dwordx4 v8, s[16:19], s21 offen offset:0   lds
M v[188:191],a[168:171],a[88:91],v[188:191]
R a[160:163],v5,53248
R a[164:167],v6,53248
M v[188:191],a[172:175],a[92:95],v[188:191]
buffer_load_dword a240, v26, s[60:63], s27 offen offset:0
M v[184:187],a[172:175],a[84:87],v[184:187]
SA s27,s27,2048
M v[184:187],a[168:171],a[80:83],v[184:187]
M v[180:183],a[168:171],a[72:75],v[180:183]
M v[180:183],a[172:175],a[76:79],v[180:183]
s_nop 0
T a[148:149],v3,24576
T a[150:151],v3,25600
M v[176:179],a[172:175],a[68:71],v[176:179]
buffer_load_dwordx4 v9, s[16:19], s21 offen offset:1024   lds
M v[176:179],a[168:171],a[64:67],v[176:179]
M v[172:175],a[168:171],a[56:59],v[172:175]
M v[172:175],a[172:175],a[60:63],v[172:175]
M v[168:171],a[172:175],a[52:55],v[168:171]
M v[168:171],a[168:171],a[48:51],v[168:171]
M v[164:167],a[168:171],a[40:43],v[164:167]
s_nop 0
T a[152:153],v4,16384
T a[154:155],v4,17408
M v[164:167],a[172:175],a[44:47],v[164:167]
s_waitcnt lgkmcnt(4)
buffer_load_dwordx4 v10, s[16:19], s21 offen offset:2048   lds
M v[160:163],a[172:175],a[36:39],v[160:163]
M v[160:163],a[168:171],a[32:35],v[160:163]
M v[192:195],a[160:163],a[32:35],v[192:195]
R a[168:171],v5,55296
R a[172:175],v6,55296
M v[192:195],a[164:167],a[36:39],v[192:195]
M v[196:199],a[164:167],a[44:47],v[196:199]
M v[196:199],a[160:163],a[40:43],v[196:199]
s_nop 0
T a[156:157],v4,24576
T a[158:159],v4,25600
M v[200:203],a[160:163],a[48:51],v[200:203]
buffer_load_dwordx4 v11, s[16:19], s21 offen offset:3072   lds
M v[200:203],a[164:167],a[52:55],v[200:203]
SA s21,s21,128
M v[204:207],a[164:167],a[60:63],v[204:207]
M v[204:207],a[160:163],a[56:59],v[204:207]
M v[208:211],a[160:163],a[64:67],v[208:211]
M v[208:211],a[164:167],a[68:71],v[208:211]
M v[212:215],a[164:167],a[76:79],v[212:215]
M v[212:215],a[160:163],a[72:75],v[212:215]
M v[216:219],a[160:163],a[80:83],v[216:219]
M v[216:219],a[164:167],a[84:87],v[216:219]
s_waitcnt lgkmcnt(2)
M v[220:223],a[164:167],a[92:95],v[220:223]
s_waitcnt vmcnt(18) lgkmcnt(0)
M v[220:223],a[160:163],a[88:91],v[220:223]
s_barrier
M v[252:255],a[168:171],a[88:91],v[252:255]
R a[160:163],v5,0
R a[164:167],v6,0
M v[252:255],a[172:175],a[92:95],v[252:255]
M v[248:251],a[172:175],a[84:87],v[248:251]
M v[248:251],a[168:171],a[80:83],v[248:251]
M v[244:247],a[168:171],a[72:75],v[244:247]
M v[244:247],a[172:175],a[76:79],v[244:247]
M v[240:243],a[172:175],a[68:71],v[240:243]
M v[240:243],a[168:171],a[64:67],v[240:243]
M v[236:239],a[168:171],a[56:59],v[236:239]
M v[236:239],a[172:175],a[60:63],v[236:239]
M v[232:235],a[172:175],a[52:55],v[232:235]
M v[232:235],a[168:171],a[48:51],v[232:235]
M v[228:231],a[168:171],a[40:43],v[228:231]
M v[228:231],a[172:175],a[44:47],v[228:231]
s_waitcnt lgkmcnt(0)
M v[224:227],a[172:175],a[36:39],v[224:227]
M v[224:227],a[168:171],a[32:35],v[224:227]
M a[0:3],a[160:163],a[96:99],a[0:3]
R a[168:171],v5,2048
R a[172:175],v6,2048
M a[0:3],a[164:167],a[100:103],a[0:3]
T a[32:33],v1,32768
T a[34:35],v1,33792
M a[4:7],a[164:167],a[108:111],a[4:7]
SA m0,s24,49152
M a[4:7],a[160:163],a[104:107],a[4:7]
buffer_load_dwordx4 v12, s[48:51], s22 offen offset:0   lds
M a[8:11],a[160:163],a[112:115],a[8:11]
M a[8:11],a[164:167],a[116:119],a[8:11]
M a[12:15],a[164:167],a[124:127],a[12:15]
s_nop 0
T a[36:37],v1,40960
T a[38:39],v1,41984
M a[12:15],a[160:163],a[120:123],a[12:15]
M a[16:19],a[160:163],a[128:131],a[16:19]
buffer_load_dwordx4 v13, s[48:51], s22 offen offset:1024   lds
M a[16:19],a[164:167],a[132:135],a[16:19]
M a[20:23],a[164:167],a[140:143],a[20:23]
M a[20:23],a[160:163],a[136:139],a[20:23]
s_nop 0
T a[40:41],v2,32768
T a[42:43],v2,33792
M a[24:27],a[160:163],a[144:147],a[24:27]
M a[24:27],a[164:167],a[148:151],a[24:27]
s_waitcnt lgkmcnt(6)
buffer_load_dwordx4 v14, s[48:51], s22 offen offset:2048   lds
M a[28:31],a[164:167],a[156:159],a[28:31]
M a[28:31],a[160:163],a[152:155],a[28:31]
M v[60:63],a[168:171],a[152:155],v[60:63]
R a[160:163],v5,4096
R a[164:167],v6,4096
M v[60:63],a[172:175],a[156:159],v[60:63]
T a[44:45],v2,40960
T a[46:47],v2,41984
L_w_kv13:
s_cbranch_execz L_w_kv17
M v[56:59],a[172:175],a[148:151],v[56:59]
buffer_load_dwordx4 v15, s[48:51], s22 offen offset:3072   lds
M v[56:59],a[168:171],a[144:147],v[56:59]
s_sub_u32 s22, s22, 1048448
M v[52:55],a[168:171],a[136:139],v[52:55]
M v[52:55],a[172:175],a[140:143],v[52:55]
s_nop 0
T a[48:49],v3,32768
T a[50:51],v3,33792
M v[48:51],a[172:175],a[132:135],v[48:51]
SA m0,s23,16384
M v[48:51],a[168:171],a[128:131],v[48:51]
buffer_load_dwordx4 v8, s[16:19], s21 offen offset:0   lds
M v[44:47],a[168:171],a[120:123],v[44:47]
M v[44:47],a[172:175],a[124:127],v[44:47]
M v[40:43],a[172:175],a[116:119],v[40:43]
s_nop 0
T a[52:53],v3,40960
T a[54:55],v3,41984
M v[40:43],a[168:171],a[112:115],v[40:43]
M v[36:39],a[168:171],a[104:107],v[36:39]
buffer_load_dwordx4 v9, s[16:19], s21 offen offset:1024   lds
M v[36:39],a[172:175],a[108:111],v[36:39]
s_waitcnt lgkmcnt(6)
M v[32:35],a[172:175],a[100:103],v[32:35]
M v[32:35],a[168:171],a[96:99],v[32:35]
s_nop 0
T a[56:57],v4,32768
T a[58:59],v4,33792
M v[64:67],a[160:163],a[96:99],v[64:67]
R a[168:171],v5,6144
R a[172:175],v6,6144
M v[64:67],a[164:167],a[100:103],v[64:67]
buffer_load_dwordx4 v10, s[16:19], s21 offen offset:2048   lds
M v[68:71],a[164:167],a[108:111],v[68:71]
M v[68:71],a[160:163],a[104:107],v[68:71]
M v[72:75],a[160:163],a[112:115],v[72:75]
s_nop 0
T a[60:61],v4,40960
T a[62:63],v4,41984
M v[72:75],a[164:167],a[116:119],v[72:75]
M v[76:79],a[164:167],a[124:127],v[76:79]
buffer_load_dwordx4 v11, s[16:19], s21 offen offset:3072   lds
M v[76:79],a[160:163],a[120:123],v[76:79]
SA s21,s21,524160
M v[80:83],a[160:163],a[128:131],v[80:83]
M v[80:83],a[164:167],a[132:135],v[80:83]
M v[84:87],a[164:167],a[140:143],v[84:87]
M v[84:87],a[160:163],a[136:139],v[84:87]
M v[88:91],a[160:163],a[144:147],v[88:91]
M v[88:91],a[164:167],a[148:151],v[88:91]
s_waitcnt lgkmcnt(2)
M v[92:95],a[164:167],a[156:159],v[92:95]
s_waitcnt vmcnt(17) lgkmcnt(0)
M v[92:95],a[160:163],a[152:155],v[92:95]
s_barrier
M v[124:127],a[168:171],a[152:155],v[124:127]
R a[160:163],v5,16384
R a[164:167],v6,16384
M v[124:127],a[172:175],a[156:159],v[124:127]
M v[120:123],a[172:175],a[148:151],v[120:123]
SA m0,s24,0
T a[64:65],v1,49152
T a[66:67],v1,50176
M v[120:123],a[168:171],a[144:147],v[120:123]
buffer_load_dwordx4 v12, s[48:51], s22 offen offset:0   lds
M v[116:119],a[168:171],a[136:139],v[116:119]
M v[116:119],a[172:175],a[140:143],v[116:119]
M v[112:115],a[172:175],a[132:135],v[112:115]
M v[112:115],a[168:171],a[128:131],v[112:115]
M v[108:111],a[168:171],a[120:123],v[108:111]
M v[108:111],a[172:175],a[124:127],v[108:111]
s_nop 0
T a[68:69],v1,57344
T a[70:71],v1,58368
M v[104:107],a[172:175],a[116:119],v[104:107]
buffer_load_dwordx4 v13, s[48:51], s22 offen offset:1024   lds
M v[104:107],a[168:171],a[112:115],v[104:107]
M v[100:103],a[168:171],a[104:107],v[100:103]
M v[100:103],a[172:175],a[108:111],v[100:103]
s_waitcnt lgkmcnt(4)
M v[96:99],a[172:175],a[100:103],v[96:99]
M v[96:99],a[168:171],a[96:99],v[96:99]
M v[128:131],a[160:163],a[96:99],v[128:131]
R a[168:171],v5,18432
R a[172:175],v6,18432
M v[128:131],a[164:167],a[100:103],v[128:131]
T a[72:73],v2,49152
T a[74:75],v2,50176
M v[132:135],a[164:167],a[108:111],v[132:135]
buffer_load_dwordx4 v14, s[48:51], s22 offen offset:2048   lds
M v[132:135],a[160:163],a[104:107],v[132:135]
M v[136:139],a[160:163],a[112:115],v[136:139]
M v[136:139],a[164:167],a[116:119],v[136:139]
M v[140:143],a[164:167],a[124:127],v[140:143]
M v[140:143],a[160:163],a[120:123],v[140:143]
s_nop 0
T a[76:77],v2,57344
T a[78:79],v2,58368
M v[144:147],a[160:163],a[128:131],v[144:147]
buffer_load_dwordx4 v15, s[48:51], s22 offen offset:3072   lds
M v[144:147],a[164:167],a[132:135],v[144:147]
SA s22,s22,1048576
M v[148:151],a[164:167],a[140:143],v[148:151]
M v[148:151],a[160:163],a[136:139],v[148:151]
M v[152:155],a[160:163],a[144:147],v[152:155]
M v[152:155],a[164:167],a[148:151],v[152:155]
s_waitcnt lgkmcnt(4)
M v[156:159],a[164:167],a[156:159],v[156:159]
SA m0,s23,32768
T a[80:81],v3,49152
T a[82:83],v3,50176
M v[156:159],a[160:163],a[152:155],v[156:159]
buffer_load_dwordx4 v8, s[16:19], s21 offen offset:0   lds
M v[188:191],a[168:171],a[152:155],v[188:191]
R a[160:163],v5,20480
R a[164:167],v6,20480
M v[188:191],a[172:175],a[156:159],v[188:191]
buffer_load_dword a240, v26, s[60:63], s27 offen offset:0
M v[184:187],a[172:175],a[148:151],v[184:187]
SA s27,s27,2048
M v[184:187],a[168:171],a[144:147],v[184:187]
M v[180:183],a[168:171],a[136:139],v[180:183]
M v[180:183],a[172:175],a[140:143],v[180:183]
s_nop 0
T a[84:85],v3,57344
T a[86:87],v3,58368
M v[176:179],a[172:175],a[132:135],v[176:179]
buffer_load_dwordx4 v9, s[16:19], s21 offen offset:1024   lds
M v[176:179],a[168:171],a[128:131],v[176:179]
M v[172:175],a[168:171],a[120:123],v[172:175]
M v[172:175],a[172:175],a[124:127],v[172:175]
M v[168:171],a[172:175],a[116:119],v[168:171]
M v[168:171],a[168:171],a[112:115],v[168:171]
M v[164:167],a[168:171],a[104:107],v[164:167]
s_nop 0
T a[88:89],v4,49152
T a[90:91],v4,50176
M v[164:167],a[172:175],a[108:111],v[164:167]
s_waitcnt lgkmcnt(4)
buffer_load_dwordx4 v10, s[16:19], s21 offen offset:2048   lds
M v[160:163],a[172:175],a[100:103],v[160:163]
M v[160:163],a[168:171],a[96:99],v[160:163]
M v[192:195],a[160:163],a[96:99],v[192:195]
R a[168:171],v5,22528
R a[172:175],v6,22528
M v[192:195],a[164:167],a[100:103],v[192:195]
M v[196:199],a[164:167],a[108:111],v[196:199]
M v[196:199],a[160:163],a[104:107],v[196:199]
s_nop 0
T a[92:93],v4,57344
T a[94:95],v4,58368
M v[200:203],a[160:163],a[112:115],v[200:203]
buffer_load_dwordx4 v11, s[16:19], s21 offen offset:3072   lds
M v[200:203],a[164:167],a[116:119],v[200:203]
SA s21,s21,128
M v[204:207],a[164:167],a[124:127],v[204:207]
M v[204:207],a[160:163],a[120:123],v[204:207]
M v[208:211],a[160:163],a[128:131],v[208:211]
M v[208:211],a[164:167],a[132:135],v[208:211]
M v[212:215],a[164:167],a[140:143],v[212:215]
M v[212:215],a[160:163],a[136:139],v[212:215]
M v[216:219],a[160:163],a[144:147],v[216:219]
M v[216:219],a[164:167],a[148:151],v[216:219]
s_waitcnt lgkmcnt(2)
M v[220:223],a[164:167],a[156:159],v[220:223]
s_waitcnt vmcnt(17) lgkmcnt(0)
M v[220:223],a[160:163],a[152:155],v[220:223]
s_barrier
M v[252:255],a[168:171],a[152:155],v[252:255]
R a[160:163],v5,32768
R a[164:167],v6,32768
M v[252:255],a[172:175],a[156:159],v[252:255]
M v[248:251],a[172:175],a[148:151],v[248:251]
M v[248:251],a[168:171],a[144:147],v[248:251]
M v[244:247],a[168:171],a[136:139],v[244:247]
M v[244:247],a[172:175],a[140:143],v[244:247]
M v[240:243],a[172:175],a[132:135],v[240:243]
M v[240:243],a[168:171],a[128:131],v[240:243]
M v[236:239],a[168:171],a[120:123],v[236:239]
M v[236:239],a[172:175],a[124:127],v[236:239]
M v[232:235],a[172:175],a[116:119],v[232:235]
M v[232:235],a[168:171],a[112:115],v[232:235]
M v[228:231],a[168:171],a[104:107],v[228:231]
M v[228:231],a[172:175],a[108:111],v[228:231]
s_waitcnt lgkmcnt(0)
M v[224:227],a[172:175],a[100:103],v[224:227]
M v[224:227],a[168:171],a[96:99],v[224:227]
M a[0:3],a[160:163],a[32:35],a[0:3]
R a[168:171],v5,34816
R a[172:175],v6,34816
M a[0:3],a[164:167],a[36:39],a[0:3]
T a[96:97],v1,0
T a[98:99],v1,1024
M a[4:7],a[164:167],a[44:47],a[4:7]
SA m0,s24,16384
M a[4:7],a[160:163],a[40:43],a[4:7]
buffer_load_dwordx4 v12, s[48:51], s22 offen offset:0   lds
M a[8:11],a[160:163],a[48:51],a[8:11]
M a[8:11],a[164:167],a[52:55],a[8:11]
M a[12:15],a[164:167],a[60:63],a[12:15]
s_nop 0
T a[100:101],v1,8192
T a[102:103],v1,9216
M a[12:15],a[160:163],a[56:59],a[12:15]
M a[16:19],a[160:163],a[64:67],a[16:19]
buffer_load_dwordx4 v13, s[48:51], s22 offen offset:1024   lds
M a[16:19],a[164:167],a[68:71],a[16:19]
M a[20:23],a[164:167],a[76:79],a[20:23]
M a[20:23],a[160:163],a[72:75],a[20:23]
s_nop 0
T a[104:105],v2,0
T a[106:107],v2,1024
M a[24:27],a[160:163],a[80:83],a[24:27]
M a[24:27],a[164:167],a[84:87],a[24:27]
s_waitcnt lgkmcnt(6)
buffer_load_dwordx4 v14, s[48:51], s22 offen offset:2048   lds
M a[28:31],a[164:167],a[92:95],a[28:31]
M a[28:31],a[160:163],a[88:91],a[28:31]
M v[60:63],a[168:171],a[88:91],v[60:63]
R a[160:163],v5,36864
R a[164:167],v6,36864
M v[60:63],a[172:175],a[92:95],v[60:63]
T a[108:109],v2,8192
T a[110:111],v2,9216
M v[56:59],a[172:175],a[84:87],v[56:59]
buffer_load_dwordx4 v15, s[48:51], s22 offen offset:3072   lds
M v[56:59],a[168:171],a[80:83],v[56:59]
s_sub_u32 s22, s22, 1048448
M v[52:55],a[168:171],a[72:75],v[52:55]
M v[52:55],a[172:175],a[76:79],v[52:55]
s_nop 0
T a[112:113],v3,0
T a[114:115],v3,1024
M v[48:51],a[172:175],a[68:71],v[48:51]
SA m0,s23,49152
M v[48:51],a[168:171],a[64:67],v[48:51]
buffer_load_dwordx4 v8, s[16:19], s21 offen offset:0   lds
M v[44:47],a[168:171],a[56:59],v[44:47]
M v[44:47],a[172:175],a[60:63],v[44:47]
M v[40:43],a[172:175],a[52:55],v[40:43]
s_nop 0
T a[116:117],v3,8192
T a[118:119],v3,9216
M v[40:43],a[168:171],a[48:51],v[40:43]
M v[36:39],a[168:171],a[40:43],v[36:39]
buffer_load_dwordx4 v9, s[16:19], s21 offen offset:1024   lds
M v[36:39],a[172:175],a[44:47],v[36:39]
s_waitcnt lgkmcnt(6)
M v[32:35],a[172:175],a[36:39],v[32:35]
M v[32:35],a[168:171],a[32:35],v[32:35]
s_nop 0
T a[120:121],v4,0
T a[122:123],v4,1024
M v[64:67],a[160:163],a[32:35],v[64:67]
R a[168:171],v5,38912
R a[172:175],v6,38912
M v[64:67],a[164:167],a[36:39],v[64:67]
buffer_load_dwordx4 v10, s[16:19], s21 offen offset:2048   lds
M v[68:71],a[164:167],a[44:47],v[68:71]
M v[68:71],a[160:163],a[40:43],v[68:71]
M v[72:75],a[160:163],a[48:51],v[72:75]
s_nop 0
T a[124:125],v4,8192
T a[126:127],v4,9216
M v[72:75],a[164:167],a[52:55],v[72:75]
M v[76:79],a[164:167],a[60:63],v[76:79]
buffer_load_dwordx4 v11, s[16:19], s21 offen offset:3072   lds
M v[76:79],a[160:163],a[56:59],v[76:79]
SA s21,s21,524160
M v[80:83],a[160:163],a[64:67],v[80:83]
M v[80:83],a[164:167],a[68:71],v[80:83]
M v[84:87],a[164:167],a[76:79],v[84:87]
M v[84:87],a[160:163],a[72:75],v[84:87]
M v[88:91],a[160:163],a[80:83],v[88:91]
M v[88:91],a[164:167],a[84:87],v[88:91]
s_waitcnt lgkmcnt(2)
M v[92:95],a[164:167],a[92:95],v[92:95]
s_waitcnt vmcnt(17) lgkmcnt(0)
M v[92:95],a[160:163],a[88:91],v[92:95]
s_barrier
M v[124:127],a[168:171],a[88:91],v[124:127]
R a[160:163],v5,49152
R a[164:167],v6,49152
M v[124:127],a[172:175],a[92:95],v[124:127]
M v[120:123],a[172:175],a[84:87],v[120:123]
SA m0,s24,32768
T a[128:129],v1,16384
T a[130:131],v1,17408
M v[120:123],a[168:171],a[80:83],v[120:123]
buffer_load_dwordx4 v12, s[48:51], s22 offen offset:0   lds
M v[116:119],a[168:171],a[72:75],v[116:119]
M v[116:119],a[172:175],a[76:79],v[116:119]
M v[112:115],a[172:175],a[68:71],v[112:115]
M v[112:115],a[168:171],a[64:67],v[112:115]
M v[108:111],a[168:171],a[56:59],v[108:111]
M v[108:111],a[172:175],a[60:63],v[108:111]
s_nop 0
T a[132:133],v1,24576
T a[134:135],v1,25600
M v[104:107],a[172:175],a[52:55],v[104:107]
buffer_load_dwordx4 v13, s[48:51], s22 offen offset:1024   lds
M v[104:107],a[168:171],a[48:51],v[104:107]
M v[100:103],a[168:171],a[40:43],v[100:103]
s_and_b32 s64, s42, 7
s_lshl_b32 s64, s64, 2
M v[100:103],a[172:175],a[44:47],v[100:103]
s_waitcnt lgkmcnt(4)
SA s64,s64,s20
M v[96:99],a[172:175],a[36:39],v[96:99]
s_mul_i32 s64, s64, 114688
v_bfe_u32 v28, v0, 2, 2
v_and_b32 v29, 3, v0
M v[96:99],a[168:171],a[32:35],v[96:99]
v_lshlrev_b32 v29, 7, v29
v_lshl_add_u32 v28, v28, 13, v29
M v[128:131],a[160:163],a[32:35],v[128:131]
R a[168:171],v5,51200
R a[172:175],v6,51200
M v[128:131],a[164:167],a[36:39],v[128:131]
T a[136:137],v2,16384
T a[138:139],v2,17408
M v[132:135],a[164:167],a[44:47],v[132:135]
buffer_load_dwordx4 v14, s[48:51], s22 offen offset:2048   lds
M v[132:135],a[160:163],a[40:43],v[132:135]
v_add_u32 v23, s64, v28
v_and_b32 v28, 48, v0
M v[136:139],a[160:163],a[48:51],v[136:139]
v_lshl_add_u32 v23, v28, 24, v23
M v[136:139],a[164:167],a[52:55],v[136:139]
M v[140:143],a[164:167],a[60:63],v[140:143]
M v[140:143],a[160:163],a[56:59],v[140:143]
s_nop 0
T a[140:141],v2,24576
T a[142:143],v2,25600
M v[144:147],a[160:163],a[64:67],v[144:147]
buffer_load_dwordx4 v15, s[48:51], s22 offen offset:3072   lds
M v[144:147],a[164:167],a[68:71],v[144:147]
SA s22,s22,1048576
M v[148:151],a[164:167],a[76:79],v[148:151]
M v[148:151],a[160:163],a[72:75],v[148:151]
M v[152:155],a[160:163],a[80:83],v[152:155]
M v[152:155],a[164:167],a[84:87],v[152:155]
s_waitcnt lgkmcnt(4)
M v[156:159],a[164:167],a[92:95],v[156:159]
SA m0,s23,0
T a[144:145],v3,16384
T a[146:147],v3,17408
M v[156:159],a[160:163],a[88:91],v[156:159]
buffer_load_dwordx4 v8, s[16:19], s21 offen offset:0   lds
M v[188:191],a[168:171],a[88:91],v[188:191]
R a[160:163],v5,53248
R a[164:167],v6,53248
M v[188:191],a[172:175],a[92:95],v[188:191]
M v[184:187],a[172:175],a[84:87],v[184:187]
M v[184:187],a[168:171],a[80:83],v[184:187]
M v[180:183],a[168:171],a[72:75],v[180:183]
M v[180:183],a[172:175],a[76:79],v[180:183]
s_nop 0
T a[148:149],v3,24576
T a[150:151],v3,25600
M v[176:179],a[172:175],a[68:71],v[176:179]
buffer_load_dwordx4 v9, s[16:19], s21 offen offset:1024   lds
M v[176:179],a[168:171],a[64:67],v[176:179]
M v[172:175],a[168:171],a[56:59],v[172:175]
M v[172:175],a[172:175],a[60:63],v[172:175]
M v[168:171],a[172:175],a[52:55],v[168:171]
M v[168:171],a[168:171],a[48:51],v[168:171]
M v[164:167],a[168:171],a[40:43],v[164:167]
s_nop 0
T a[152:153],v4,16384
T a[154:155],v4,17408
M v[164:167],a[172:175],a[44:47],v[164:167]
s_waitcnt lgkmcnt(4)
buffer_load_dwordx4 v10, s[16:19], s21 offen offset:2048   lds
M v[160:163],a[172:175],a[36:39],v[160:163]
M v[160:163],a[168:171],a[32:35],v[160:163]
M v[192:195],a[160:163],a[32:35],v[192:195]
R a[168:171],v5,55296
R a[172:175],v6,55296
M v[192:195],a[164:167],a[36:39],v[192:195]
M v[196:199],a[164:167],a[44:47],v[196:199]
M v[196:199],a[160:163],a[40:43],v[196:199]
s_nop 0
T a[156:157],v4,24576
T a[158:159],v4,25600
M v[200:203],a[160:163],a[48:51],v[200:203]
buffer_load_dwordx4 v11, s[16:19], s21 offen offset:3072   lds
M v[200:203],a[164:167],a[52:55],v[200:203]
SA s21,s21,128
M v[204:207],a[164:167],a[60:63],v[204:207]
M v[204:207],a[160:163],a[56:59],v[204:207]
M v[208:211],a[160:163],a[64:67],v[208:211]
M v[208:211],a[164:167],a[68:71],v[208:211]
M v[212:215],a[164:167],a[76:79],v[212:215]
M v[212:215],a[160:163],a[72:75],v[212:215]
M v[216:219],a[160:163],a[80:83],v[216:219]
M v[216:219],a[164:167],a[84:87],v[216:219]
s_waitcnt lgkmcnt(2)
M v[220:223],a[164:167],a[92:95],v[220:223]
s_waitcnt vmcnt(16) lgkmcnt(0)
M v[220:223],a[160:163],a[88:91],v[220:223]
s_barrier
M v[252:255],a[168:171],a[88:91],v[252:255]
R a[160:163],v5,0
R a[164:167],v6,0
M v[252:255],a[172:175],a[92:95],v[252:255]
buffer_load_dword a240, v23, s[52:55], 0 offen offset:0
M v[248:251],a[172:175],a[84:87],v[248:251]
v_add_u32 v23, 32768, v23
M v[248:251],a[168:171],a[80:83],v[248:251]
M v[244:247],a[168:171],a[72:75],v[244:247]
M v[244:247],a[172:175],a[76:79],v[244:247]
M v[240:243],a[172:175],a[68:71],v[240:243]
M v[240:243],a[168:171],a[64:67],v[240:243]
M v[236:239],a[168:171],a[56:59],v[236:239]
M v[236:239],a[172:175],a[60:63],v[236:239]
M v[232:235],a[172:175],a[52:55],v[232:235]
M v[232:235],a[168:171],a[48:51],v[232:235]
M v[228:231],a[168:171],a[40:43],v[228:231]
M v[228:231],a[172:175],a[44:47],v[228:231]
s_waitcnt lgkmcnt(0)
M v[224:227],a[172:175],a[36:39],v[224:227]
M v[224:227],a[168:171],a[32:35],v[224:227]
M a[0:3],a[160:163],a[96:99],a[0:3]
R a[168:171],v5,2048
R a[172:175],v6,2048
M a[0:3],a[164:167],a[100:103],a[0:3]
T a[32:33],v1,32768
T a[34:35],v1,33792
M a[4:7],a[164:167],a[108:111],a[4:7]
SA m0,s24,49152
M a[4:7],a[160:163],a[104:107],a[4:7]
buffer_load_dwordx4 v12, s[48:51], s22 offen offset:0   lds
M a[8:11],a[160:163],a[112:115],a[8:11]
M a[8:11],a[164:167],a[116:119],a[8:11]
M a[12:15],a[164:167],a[124:127],a[12:15]
s_nop 0
T a[36:37],v1,40960
T a[38:39],v1,41984
M a[12:15],a[160:163],a[120:123],a[12:15]
M a[16:19],a[160:163],a[128:131],a[16:19]
buffer_load_dwordx4 v13, s[48:51], s22 offen offset:1024   lds
M a[16:19],a[164:167],a[132:135],a[16:19]
M a[20:23],a[164:167],a[140:143],a[20:23]
M a[20:23],a[160:163],a[136:139],a[20:23]
s_nop 0
T a[40:41],v2,32768
T a[42:43],v2,33792
M a[24:27],a[160:163],a[144:147],a[24:27]
M a[24:27],a[164:167],a[148:151],a[24:27]
s_waitcnt lgkmcnt(6)
buffer_load_dwordx4 v14, s[48:51], s22 offen offset:2048   lds
M a[28:31],a[164:167],a[156:159],a[28:31]
M a[28:31],a[160:163],a[152:155],a[28:31]
M v[60:63],a[168:171],a[152:155],v[60:63]
R a[160:163],v5,4096
R a[164:167],v6,4096
M v[60:63],a[172:175],a[156:159],v[60:63]
T a[44:45],v2,40960
T a[46:47],v2,41984
M v[56:59],a[172:175],a[148:151],v[56:59]
buffer_load_dwordx4 v15, s[48:51], s22 offen offset:3072   lds
M v[56:59],a[168:171],a[144:147],v[56:59]
s_sub_u32 s22, s22, 1048448
M v[52:55],a[168:171],a[136:139],v[52:55]
M v[52:55],a[172:175],a[140:143],v[52:55]
s_nop 0
T a[48:49],v3,32768
T a[50:51],v3,33792
M v[48:51],a[172:175],a[132:135],v[48:51]
SA m0,s23,16384
M v[48:51],a[168:171],a[128:131],v[48:51]
buffer_load_dwordx4 v8, s[16:19], s21 offen offset:0   lds
M v[44:47],a[168:171],a[120:123],v[44:47]
M v[44:47],a[172:175],a[124:127],v[44:47]
M v[40:43],a[172:175],a[116:119],v[40:43]
s_nop 0
T a[52:53],v3,40960
T a[54:55],v3,41984
M v[40:43],a[168:171],a[112:115],v[40:43]
M v[36:39],a[168:171],a[104:107],v[36:39]
buffer_load_dwordx4 v9, s[16:19], s21 offen offset:1024   lds
M v[36:39],a[172:175],a[108:111],v[36:39]
s_waitcnt lgkmcnt(6)
M v[32:35],a[172:175],a[100:103],v[32:35]
M v[32:35],a[168:171],a[96:99],v[32:35]
s_nop 0
T a[56:57],v4,32768
T a[58:59],v4,33792
M v[64:67],a[160:163],a[96:99],v[64:67]
R a[168:171],v5,6144
R a[172:175],v6,6144
M v[64:67],a[164:167],a[100:103],v[64:67]
buffer_load_dwordx4 v10, s[16:19], s21 offen offset:2048   lds
M v[68:71],a[164:167],a[108:111],v[68:71]
M v[68:71],a[160:163],a[104:107],v[68:71]
M v[72:75],a[160:163],a[112:115],v[72:75]
s_nop 0
T a[60:61],v4,40960
T a[62:63],v4,41984
M v[72:75],a[164:167],a[116:119],v[72:75]
M v[76:79],a[164:167],a[124:127],v[76:79]
buffer_load_dwordx4 v11, s[16:19], s21 offen offset:3072   lds
M v[76:79],a[160:163],a[120:123],v[76:79]
SA s21,s21,524160
M v[80:83],a[160:163],a[128:131],v[80:83]
M v[80:83],a[164:167],a[132:135],v[80:83]
M v[84:87],a[164:167],a[140:143],v[84:87]
M v[84:87],a[160:163],a[136:139],v[84:87]
M v[88:91],a[160:163],a[144:147],v[88:91]
M v[88:91],a[164:167],a[148:151],v[88:91]
s_waitcnt lgkmcnt(2)
M v[92:95],a[164:167],a[156:159],v[92:95]
s_waitcnt vmcnt(17) lgkmcnt(0)
M v[92:95],a[160:163],a[152:155],v[92:95]
s_barrier
M v[124:127],a[168:171],a[152:155],v[124:127]
R a[160:163],v5,16384
R a[164:167],v6,16384
M v[124:127],a[172:175],a[156:159],v[124:127]
M v[120:123],a[172:175],a[148:151],v[120:123]
SA m0,s24,0
T a[64:65],v1,49152
T a[66:67],v1,50176
M v[120:123],a[168:171],a[144:147],v[120:123]
buffer_load_dwordx4 v12, s[48:51], s22 offen offset:0   lds
M v[116:119],a[168:171],a[136:139],v[116:119]
M v[116:119],a[172:175],a[140:143],v[116:119]
M v[112:115],a[172:175],a[132:135],v[112:115]
M v[112:115],a[168:171],a[128:131],v[112:115]
M v[108:111],a[168:171],a[120:123],v[108:111]
M v[108:111],a[172:175],a[124:127],v[108:111]
s_nop 0
T a[68:69],v1,57344
T a[70:71],v1,58368
M v[104:107],a[172:175],a[116:119],v[104:107]
buffer_load_dwordx4 v13, s[48:51], s22 offen offset:1024   lds
M v[104:107],a[168:171],a[112:115],v[104:107]
M v[100:103],a[168:171],a[104:107],v[100:103]
M v[100:103],a[172:175],a[108:111],v[100:103]
s_waitcnt lgkmcnt(4)
M v[96:99],a[172:175],a[100:103],v[96:99]
M v[96:99],a[168:171],a[96:99],v[96:99]
L_w_kv14:
s_cbranch_execz L_w_kv18
M v[128:131],a[160:163],a[96:99],v[128:131]
R a[168:171],v5,18432
R a[172:175],v6,18432
M v[128:131],a[164:167],a[100:103],v[128:131]
T a[72:73],v2,49152
T a[74:75],v2,50176
M v[132:135],a[164:167],a[108:111],v[132:135]
buffer_load_dwordx4 v14, s[48:51], s22 offen offset:2048   lds
M v[132:135],a[160:163],a[104:107],v[132:135]
M v[136:139],a[160:163],a[112:115],v[136:139]
M v[136:139],a[164:167],a[116:119],v[136:139]
M v[140:143],a[164:167],a[124:127],v[140:143]
M v[140:143],a[160:163],a[120:123],v[140:143]
s_nop 0
T a[76:77],v2,57344
T a[78:79],v2,58368
M v[144:147],a[160:163],a[128:131],v[144:147]
buffer_load_dwordx4 v15, s[48:51], s22 offen offset:3072   lds
M v[144:147],a[164:167],a[132:135],v[144:147]
SA s22,s22,1048576
M v[148:151],a[164:167],a[140:143],v[148:151]
M v[148:151],a[160:163],a[136:139],v[148:151]
M v[152:155],a[160:163],a[144:147],v[152:155]
M v[152:155],a[164:167],a[148:151],v[152:155]
s_waitcnt lgkmcnt(4)
M v[156:159],a[164:167],a[156:159],v[156:159]
SA m0,s23,32768
T a[80:81],v3,49152
T a[82:83],v3,50176
M v[156:159],a[160:163],a[152:155],v[156:159]
buffer_load_dwordx4 v8, s[16:19], s21 offen offset:0   lds
M v[188:191],a[168:171],a[152:155],v[188:191]
R a[160:163],v5,20480
R a[164:167],v6,20480
M v[188:191],a[172:175],a[156:159],v[188:191]
M v[184:187],a[172:175],a[148:151],v[184:187]
M v[184:187],a[168:171],a[144:147],v[184:187]
M v[180:183],a[168:171],a[136:139],v[180:183]
M v[180:183],a[172:175],a[140:143],v[180:183]
s_nop 0
T a[84:85],v3,57344
T a[86:87],v3,58368
M v[176:179],a[172:175],a[132:135],v[176:179]
buffer_load_dwordx4 v9, s[16:19], s21 offen offset:1024   lds
M v[176:179],a[168:171],a[128:131],v[176:179]
M v[172:175],a[168:171],a[120:123],v[172:175]
M v[172:175],a[172:175],a[124:127],v[172:175]
M v[168:171],a[172:175],a[116:119],v[168:171]
M v[168:171],a[168:171],a[112:115],v[168:171]
M v[164:167],a[168:171],a[104:107],v[164:167]
s_nop 0
T a[88:89],v4,49152
T a[90:91],v4,50176
M v[164:167],a[172:175],a[108:111],v[164:167]
s_waitcnt lgkmcnt(4)
buffer_load_dwordx4 v10, s[16:19], s21 offen offset:2048   lds
M v[160:163],a[172:175],a[100:103],v[160:163]
M v[160:163],a[168:171],a[96:99],v[160:163]
M v[192:195],a[160:163],a[96:99],v[192:195]
R a[168:171],v5,22528
R a[172:175],v6,22528
M v[192:195],a[164:167],a[100:103],v[192:195]
M v[196:199],a[164:167],a[108:111],v[196:199]
M v[196:199],a[160:163],a[104:107],v[196:199]
s_nop 0
T a[92:93],v4,57344
T a[94:95],v4,58368
M v[200:203],a[160:163],a[112:115],v[200:203]
buffer_load_dwordx4 v11, s[16:19], s21 offen offset:3072   lds
M v[200:203],a[164:167],a[116:119],v[200:203]
SA s21,s21,128
M v[204:207],a[164:167],a[124:127],v[204:207]
M v[204:207],a[160:163],a[120:123],v[204:207]
M v[208:211],a[160:163],a[128:131],v[208:211]
M v[208:211],a[164:167],a[132:135],v[208:211]
M v[212:215],a[164:167],a[140:143],v[212:215]
M v[212:215],a[160:163],a[136:139],v[212:215]
M v[216:219],a[160:163],a[144:147],v[216:219]
M v[216:219],a[164:167],a[148:151],v[216:219]
s_waitcnt lgkmcnt(2)
M v[220:223],a[164:167],a[156:159],v[220:223]
s_waitcnt vmcnt(17) lgkmcnt(0)
M v[220:223],a[160:163],a[152:155],v[220:223]
s_barrier
M v[252:255],a[168:171],a[152:155],v[252:255]
R a[160:163],v5,32768
R a[164:167],v6,32768
M v[252:255],a[172:175],a[156:159],v[252:255]
buffer_load_dword a240, v23, s[52:55], 0 offen offset:0
M v[248:251],a[172:175],a[148:151],v[248:251]
v_add_u32 v23, 32768, v23
M v[248:251],a[168:171],a[144:147],v[248:251]
M v[244:247],a[168:171],a[136:139],v[244:247]
M v[244:247],a[172:175],a[140:143],v[244:247]
M v[240:243],a[172:175],a[132:135],v[240:243]
M v[240:243],a[168:171],a[128:131],v[240:243]
M v[236:239],a[168:171],a[120:123],v[236:239]
M v[236:239],a[172:175],a[124:127],v[236:239]
M v[232:235],a[172:175],a[116:119],v[232:235]
M v[232:235],a[168:171],a[112:115],v[232:235]
M v[228:231],a[168:171],a[104:107],v[228:231]
M v[228:231],a[172:175],a[108:111],v[228:231]
s_waitcnt lgkmcnt(0)
M v[224:227],a[172:175],a[100:103],v[224:227]
M v[224:227],a[168:171],a[96:99],v[224:227]
M a[0:3],a[160:163],a[32:35],a[0:3]
R a[168:171],v5,34816
R a[172:175],v6,34816
M a[0:3],a[164:167],a[36:39],a[0:3]
T a[96:97],v1,0
T a[98:99],v1,1024
M a[4:7],a[164:167],a[44:47],a[4:7]
SA m0,s24,16384
M a[4:7],a[160:163],a[40:43],a[4:7]
buffer_load_dwordx4 v12, s[48:51], s22 offen offset:0   lds
M a[8:11],a[160:163],a[48:51],a[8:11]
M a[8:11],a[164:167],a[52:55],a[8:11]
M a[12:15],a[164:167],a[60:63],a[12:15]
s_nop 0
T a[100:101],v1,8192
T a[102:103],v1,9216
M a[12:15],a[160:163],a[56:59],a[12:15]
M a[16:19],a[160:163],a[64:67],a[16:19]
buffer_load_dwordx4 v13, s[48:51], s22 offen offset:1024   lds
M a[16:19],a[164:167],a[68:71],a[16:19]
M a[20:23],a[164:167],a[76:79],a[20:23]
M a[20:23],a[160:163],a[72:75],a[20:23]
s_nop 0
T a[104:105],v2,0
T a[106:107],v2,1024
M a[24:27],a[160:163],a[80:83],a[24:27]
M a[24:27],a[164:167],a[84:87],a[24:27]
s_waitcnt lgkmcnt(6)
buffer_load_dwordx4 v14, s[48:51], s22 offen offset:2048   lds
M a[28:31],a[164:167],a[92:95],a[28:31]
M a[28:31],a[160:163],a[88:91],a[28:31]
M v[60:63],a[168:171],a[88:91],v[60:63]
R a[160:163],v5,36864
R a[164:167],v6,36864
M v[60:63],a[172:175],a[92:95],v[60:63]
T a[108:109],v2,8192
T a[110:111],v2,9216
M v[56:59],a[172:175],a[84:87],v[56:59]
buffer_load_dwordx4 v15, s[48:51], s22 offen offset:3072   lds
M v[56:59],a[168:171],a[80:83],v[56:59]
s_sub_u32 s22, s22, 1048448
M v[52:55],a[168:171],a[72:75],v[52:55]
M v[52:55],a[172:175],a[76:79],v[52:55]
s_nop 0
T a[112:113],v3,0
T a[114:115],v3,1024
M v[48:51],a[172:175],a[68:71],v[48:51]
SA m0,s23,49152
M v[48:51],a[168:171],a[64:67],v[48:51]
buffer_load_dwordx4 v8, s[16:19], s21 offen offset:0   lds
M v[44:47],a[168:171],a[56:59],v[44:47]
M v[44:47],a[172:175],a[60:63],v[44:47]
M v[40:43],a[172:175],a[52:55],v[40:43]
s_nop 0
T a[116:117],v3,8192
T a[118:119],v3,9216
M v[40:43],a[168:171],a[48:51],v[40:43]
M v[36:39],a[168:171],a[40:43],v[36:39]
buffer_load_dwordx4 v9, s[16:19], s21 offen offset:1024   lds
M v[36:39],a[172:175],a[44:47],v[36:39]
s_waitcnt lgkmcnt(6)
M v[32:35],a[172:175],a[36:39],v[32:35]
M v[32:35],a[168:171],a[32:35],v[32:35]
s_nop 0
T a[120:121],v4,0
T a[122:123],v4,1024
M v[64:67],a[160:163],a[32:35],v[64:67]
R a[168:171],v5,38912
R a[172:175],v6,38912
M v[64:67],a[164:167],a[36:39],v[64:67]
buffer_load_dwordx4 v10, s[16:19], s21 offen offset:2048   lds
M v[68:71],a[164:167],a[44:47],v[68:71]
M v[68:71],a[160:163],a[40:43],v[68:71]
M v[72:75],a[160:163],a[48:51],v[72:75]
s_nop 0
T a[124:125],v4,8192
T a[126:127],v4,9216
M v[72:75],a[164:167],a[52:55],v[72:75]
M v[76:79],a[164:167],a[60:63],v[76:79]
buffer_load_dwordx4 v11, s[16:19], s21 offen offset:3072   lds
M v[76:79],a[160:163],a[56:59],v[76:79]
SA s21,s21,524160
M v[80:83],a[160:163],a[64:67],v[80:83]
M v[80:83],a[164:167],a[68:71],v[80:83]
M v[84:87],a[164:167],a[76:79],v[84:87]
M v[84:87],a[160:163],a[72:75],v[84:87]
M v[88:91],a[160:163],a[80:83],v[88:91]
M v[88:91],a[164:167],a[84:87],v[88:91]
s_waitcnt lgkmcnt(2)
M v[92:95],a[164:167],a[92:95],v[92:95]
s_waitcnt vmcnt(17) lgkmcnt(0)
M v[92:95],a[160:163],a[88:91],v[92:95]
s_barrier
M v[124:127],a[168:171],a[88:91],v[124:127]
R a[160:163],v5,49152
R a[164:167],v6,49152
M v[124:127],a[172:175],a[92:95],v[124:127]
M v[120:123],a[172:175],a[84:87],v[120:123]
SA m0,s24,32768
T a[128:129],v1,16384
T a[130:131],v1,17408
M v[120:123],a[168:171],a[80:83],v[120:123]
buffer_load_dwordx4 v12, s[48:51], s22 offen offset:0   lds
M v[116:119],a[168:171],a[72:75],v[116:119]
M v[116:119],a[172:175],a[76:79],v[116:119]
M v[112:115],a[172:175],a[68:71],v[112:115]
M v[112:115],a[168:171],a[64:67],v[112:115]
M v[108:111],a[168:171],a[56:59],v[108:111]
M v[108:111],a[172:175],a[60:63],v[108:111]
s_nop 0
T a[132:133],v1,24576
T a[134:135],v1,25600
M v[104:107],a[172:175],a[52:55],v[104:107]
buffer_load_dwordx4 v13, s[48:51], s22 offen offset:1024   lds
M v[104:107],a[168:171],a[48:51],v[104:107]
M v[100:103],a[168:171],a[40:43],v[100:103]
M v[100:103],a[172:175],a[44:47],v[100:103]
s_waitcnt lgkmcnt(4)
M v[96:99],a[172:175],a[36:39],v[96:99]
M v[96:99],a[168:171],a[32:35],v[96:99]
M v[128:131],a[160:163],a[32:35],v[128:131]
R a[168:171],v5,51200
R a[172:175],v6,51200
M v[128:131],a[164:167],a[36:39],v[128:131]
T a[136:137],v2,16384
T a[138:139],v2,17408
M v[132:135],a[164:167],a[44:47],v[132:135]
buffer_load_dwordx4 v14, s[48:51], s22 offen offset:2048   lds
M v[132:135],a[160:163],a[40:43],v[132:135]
M v[136:139],a[160:163],a[48:51],v[136:139]
M v[136:139],a[164:167],a[52:55],v[136:139]
M v[140:143],a[164:167],a[60:63],v[140:143]
M v[140:143],a[160:163],a[56:59],v[140:143]
s_nop 0
T a[140:141],v2,24576
T a[142:143],v2,25600
M v[144:147],a[160:163],a[64:67],v[144:147]
buffer_load_dwordx4 v15, s[48:51], s22 offen offset:3072   lds
M v[144:147],a[164:167],a[68:71],v[144:147]
SA s22,s22,1048576
M v[148:151],a[164:167],a[76:79],v[148:151]
M v[148:151],a[160:163],a[72:75],v[148:151]
M v[152:155],a[160:163],a[80:83],v[152:155]
M v[152:155],a[164:167],a[84:87],v[152:155]
s_waitcnt lgkmcnt(4)
M v[156:159],a[164:167],a[92:95],v[156:159]
SA m0,s23,0
T a[144:145],v3,16384
T a[146:147],v3,17408
M v[156:159],a[160:163],a[88:91],v[156:159]
buffer_load_dwordx4 v8, s[16:19], s21 offen offset:0   lds
M v[188:191],a[168:171],a[88:91],v[188:191]
R a[160:163],v5,53248
R a[164:167],v6,53248
M v[188:191],a[172:175],a[92:95],v[188:191]
M v[184:187],a[172:175],a[84:87],v[184:187]
M v[184:187],a[168:171],a[80:83],v[184:187]
M v[180:183],a[168:171],a[72:75],v[180:183]
M v[180:183],a[172:175],a[76:79],v[180:183]
s_nop 0
T a[148:149],v3,24576
T a[150:151],v3,25600
M v[176:179],a[172:175],a[68:71],v[176:179]
buffer_load_dwordx4 v9, s[16:19], s21 offen offset:1024   lds
M v[176:179],a[168:171],a[64:67],v[176:179]
M v[172:175],a[168:171],a[56:59],v[172:175]
M v[172:175],a[172:175],a[60:63],v[172:175]
M v[168:171],a[172:175],a[52:55],v[168:171]
M v[168:171],a[168:171],a[48:51],v[168:171]
M v[164:167],a[168:171],a[40:43],v[164:167]
s_nop 0
T a[152:153],v4,16384
T a[154:155],v4,17408
M v[164:167],a[172:175],a[44:47],v[164:167]
s_waitcnt lgkmcnt(4)
buffer_load_dwordx4 v10, s[16:19], s21 offen offset:2048   lds
M v[160:163],a[172:175],a[36:39],v[160:163]
M v[160:163],a[168:171],a[32:35],v[160:163]
M v[192:195],a[160:163],a[32:35],v[192:195]
R a[168:171],v5,55296
R a[172:175],v6,55296
M v[192:195],a[164:167],a[36:39],v[192:195]
M v[196:199],a[164:167],a[44:47],v[196:199]
M v[196:199],a[160:163],a[40:43],v[196:199]
s_nop 0
T a[156:157],v4,24576
T a[158:159],v4,25600
M v[200:203],a[160:163],a[48:51],v[200:203]
buffer_load_dwordx4 v11, s[16:19], s21 offen offset:3072   lds
M v[200:203],a[164:167],a[52:55],v[200:203]
SA s21,s21,128
M v[204:207],a[164:167],a[60:63],v[204:207]
M v[204:207],a[160:163],a[56:59],v[204:207]
M v[208:211],a[160:163],a[64:67],v[208:211]
M v[208:211],a[164:167],a[68:71],v[208:211]
M v[212:215],a[164:167],a[76:79],v[212:215]
M v[212:215],a[160:163],a[72:75],v[212:215]
M v[216:219],a[160:163],a[80:83],v[216:219]
M v[216:219],a[164:167],a[84:87],v[216:219]
s_waitcnt lgkmcnt(2)
M v[220:223],a[164:167],a[92:95],v[220:223]
s_waitcnt vmcnt(17) lgkmcnt(0)
M v[220:223],a[160:163],a[88:91],v[220:223]
s_barrier
M v[252:255],a[168:171],a[88:91],v[252:255]
R a[160:163],v5,0
R a[164:167],v6,0
M v[252:255],a[172:175],a[92:95],v[252:255]
buffer_load_dword a240, v23, s[52:55], 0 offen offset:0
M v[248:251],a[172:175],a[84:87],v[248:251]
v_add_u32 v23, 16384, v23
M v[248:251],a[168:171],a[80:83],v[248:251]
M v[244:247],a[168:171],a[72:75],v[244:247]
M v[244:247],a[172:175],a[76:79],v[244:247]
M v[240:243],a[172:175],a[68:71],v[240:243]
M v[240:243],a[168:171],a[64:67],v[240:243]
M v[236:239],a[168:171],a[56:59],v[236:239]
M v[236:239],a[172:175],a[60:63],v[236:239]
M v[232:235],a[172:175],a[52:55],v[232:235]
M v[232:235],a[168:171],a[48:51],v[232:235]
M v[228:231],a[168:171],a[40:43],v[228:231]
M v[228:231],a[172:175],a[44:47],v[228:231]
s_waitcnt lgkmcnt(0)
M v[224:227],a[172:175],a[36:39],v[224:227]
M v[224:227],a[168:171],a[32:35],v[224:227]
M a[0:3],a[160:163],a[96:99],a[0:3]
R a[168:171],v5,2048
R a[172:175],v6,2048
M a[0:3],a[164:167],a[100:103],a[0:3]
T a[32:33],v1,32768
T a[34:35],v1,33792
M a[4:7],a[164:167],a[108:111],a[4:7]
SA m0,s24,49152
M a[4:7],a[160:163],a[104:107],a[4:7]
buffer_load_dwordx4 v12, s[48:51], s22 offen offset:0   lds
M a[8:11],a[160:163],a[112:115],a[8:11]
M a[8:11],a[164:167],a[116:119],a[8:11]
M a[12:15],a[164:167],a[124:127],a[12:15]
s_nop 0
T a[36:37],v1,40960
T a[38:39],v1,41984
M a[12:15],a[160:163],a[120:123],a[12:15]
M a[16:19],a[160:163],a[128:131],a[16:19]
buffer_load_dwordx4 v13, s[48:51], s22 offen offset:1024   lds
M a[16:19],a[164:167],a[132:135],a[16:19]
M a[20:23],a[164:167],a[140:143],a[20:23]
M a[20:23],a[160:163],a[136:139],a[20:23]
s_nop 0
T a[40:41],v2,32768
T a[42:43],v2,33792
M a[24:27],a[160:163],a[144:147],a[24:27]
M a[24:27],a[164:167],a[148:151],a[24:27]
s_waitcnt lgkmcnt(6)
buffer_load_dwordx4 v14, s[48:51], s22 offen offset:2048   lds
M a[28:31],a[164:167],a[156:159],a[28:31]
M a[28:31],a[160:163],a[152:155],a[28:31]
M v[60:63],a[168:171],a[152:155],v[60:63]
R a[160:163],v5,4096
R a[164:167],v6,4096
M v[60:63],a[172:175],a[156:159],v[60:63]
T a[44:45],v2,40960
T a[46:47],v2,41984
M v[56:59],a[172:175],a[148:151],v[56:59]
buffer_load_dwordx4 v15, s[48:51], s22 offen offset:3072   lds
M v[56:59],a[168:171],a[144:147],v[56:59]
s_sub_u32 s22, s22, 1048448
M v[52:55],a[168:171],a[136:139],v[52:55]
M v[52:55],a[172:175],a[140:143],v[52:55]
s_nop 0
T a[48:49],v3,32768
T a[50:51],v3,33792
M v[48:51],a[172:175],a[132:135],v[48:51]
SA m0,s23,16384
M v[48:51],a[168:171],a[128:131],v[48:51]
buffer_load_dwordx4 v8, s[16:19], s21 offen offset:0   lds
M v[44:47],a[168:171],a[120:123],v[44:47]
M v[44:47],a[172:175],a[124:127],v[44:47]
M v[40:43],a[172:175],a[116:119],v[40:43]
s_nop 0
T a[52:53],v3,40960
T a[54:55],v3,41984
M v[40:43],a[168:171],a[112:115],v[40:43]
M v[36:39],a[168:171],a[104:107],v[36:39]
buffer_load_dwordx4 v9, s[16:19], s21 offen offset:1024   lds
M v[36:39],a[172:175],a[108:111],v[36:39]
s_waitcnt lgkmcnt(6)
M v[32:35],a[172:175],a[100:103],v[32:35]
M v[32:35],a[168:171],a[96:99],v[32:35]
s_nop 0
T a[56:57],v4,32768
T a[58:59],v4,33792
M v[64:67],a[160:163],a[96:99],v[64:67]
R a[168:171],v5,6144
R a[172:175],v6,6144
M v[64:67],a[164:167],a[100:103],v[64:67]
buffer_load_dwordx4 v10, s[16:19], s21 offen offset:2048   lds
M v[68:71],a[164:167],a[108:111],v[68:71]
M v[68:71],a[160:163],a[104:107],v[68:71]
M v[72:75],a[160:163],a[112:115],v[72:75]
s_nop 0
T a[60:61],v4,40960
T a[62:63],v4,41984
M v[72:75],a[164:167],a[116:119],v[72:75]
M v[76:79],a[164:167],a[124:127],v[76:79]
buffer_load_dwordx4 v11, s[16:19], s21 offen offset:3072   lds
M v[76:79],a[160:163],a[120:123],v[76:79]
SA s21,s21,524160
M v[80:83],a[160:163],a[128:131],v[80:83]
M v[80:83],a[164:167],a[132:135],v[80:83]
M v[84:87],a[164:167],a[140:143],v[84:87]
M v[84:87],a[160:163],a[136:139],v[84:87]
M v[88:91],a[160:163],a[144:147],v[88:91]
M v[88:91],a[164:167],a[148:151],v[88:91]
s_waitcnt lgkmcnt(2)
M v[92:95],a[164:167],a[156:159],v[92:95]
s_waitcnt vmcnt(17) lgkmcnt(0)
M v[92:95],a[160:163],a[152:155],v[92:95]
s_barrier
M v[124:127],a[168:171],a[152:155],v[124:127]
R a[160:163],v5,16384
R a[164:167],v6,16384
M v[124:127],a[172:175],a[156:159],v[124:127]
M v[120:123],a[172:175],a[148:151],v[120:123]
SA m0,s24,0
T a[64:65],v1,49152
T a[66:67],v1,50176
M v[120:123],a[168:171],a[144:147],v[120:123]
buffer_load_dwordx4 v12, s[48:51], s22 offen offset:0   lds
M v[116:119],a[168:171],a[136:139],v[116:119]
M v[116:119],a[172:175],a[140:143],v[116:119]
M v[112:115],a[172:175],a[132:135],v[112:115]
M v[112:115],a[168:171],a[128:131],v[112:115]
M v[108:111],a[168:171],a[120:123],v[108:111]
M v[108:111],a[172:175],a[124:127],v[108:111]
s_nop 0
T a[68:69],v1,57344
T a[70:71],v1,58368
M v[104:107],a[172:175],a[116:119],v[104:107]
buffer_load_dwordx4 v13, s[48:51], s22 offen offset:1024   lds
M v[104:107],a[168:171],a[112:115],v[104:107]
M v[100:103],a[168:171],a[104:107],v[100:103]
M v[100:103],a[172:175],a[108:111],v[100:103]
s_waitcnt lgkmcnt(4)
M v[96:99],a[172:175],a[100:103],v[96:99]
M v[96:99],a[168:171],a[96:99],v[96:99]
M v[128:131],a[160:163],a[96:99],v[128:131]
R a[168:171],v5,18432
R a[172:175],v6,18432
M v[128:131],a[164:167],a[100:103],v[128:131]
T a[72:73],v2,49152
T a[74:75],v2,50176
M v[132:135],a[164:167],a[108:111],v[132:135]
buffer_load_dwordx4 v14, s[48:51], s22 offen offset:2048   lds
M v[132:135],a[160:163],a[104:107],v[132:135]
M v[136:139],a[160:163],a[112:115],v[136:139]
M v[136:139],a[164:167],a[116:119],v[136:139]
M v[140:143],a[164:167],a[124:127],v[140:143]
M v[140:143],a[160:163],a[120:123],v[140:143]
s_nop 0
T a[76:77],v2,57344
T a[78:79],v2,58368
M v[144:147],a[160:163],a[128:131],v[144:147]
buffer_load_dwordx4 v15, s[48:51], s22 offen offset:3072   lds
M v[144:147],a[164:167],a[132:135],v[144:147]
SA s22,s22,1048576
M v[148:151],a[164:167],a[140:143],v[148:151]
M v[148:151],a[160:163],a[136:139],v[148:151]
M v[152:155],a[160:163],a[144:147],v[152:155]
M v[152:155],a[164:167],a[148:151],v[152:155]
s_waitcnt lgkmcnt(4)
M v[156:159],a[164:167],a[156:159],v[156:159]
SA m0,s23,32768
T a[80:81],v3,49152
T a[82:83],v3,50176
M v[156:159],a[160:163],a[152:155],v[156:159]
buffer_load_dwordx4 v8, s[16:19], s21 offen offset:0   lds
M v[188:191],a[168:171],a[152:155],v[188:191]
R a[160:163],v5,20480
R a[164:167],v6,20480
M v[188:191],a[172:175],a[156:159],v[188:191]
M v[184:187],a[172:175],a[148:151],v[184:187]
M v[184:187],a[168:171],a[144:147],v[184:187]
M v[180:183],a[168:171],a[136:139],v[180:183]
M v[180:183],a[172:175],a[140:143],v[180:183]
s_nop 0
T a[84:85],v3,57344
T a[86:87],v3,58368
M v[176:179],a[172:175],a[132:135],v[176:179]
buffer_load_dwordx4 v9, s[16:19], s21 offen offset:1024   lds
M v[176:179],a[168:171],a[128:131],v[176:179]
M v[172:175],a[168:171],a[120:123],v[172:175]
M v[172:175],a[172:175],a[124:127],v[172:175]
M v[168:171],a[172:175],a[116:119],v[168:171]
M v[168:171],a[168:171],a[112:115],v[168:171]
M v[164:167],a[168:171],a[104:107],v[164:167]
s_nop 0
T a[88:89],v4,49152
T a[90:91],v4,50176
M v[164:167],a[172:175],a[108:111],v[164:167]
s_waitcnt lgkmcnt(4)
buffer_load_dwordx4 v10, s[16:19], s21 offen offset:2048   lds
M v[160:163],a[172:175],a[100:103],v[160:163]
M v[160:163],a[168:171],a[96:99],v[160:163]
M v[192:195],a[160:163],a[96:99],v[192:195]
R a[168:171],v5,22528
R a[172:175],v6,22528
M v[192:195],a[164:167],a[100:103],v[192:195]
M v[196:199],a[164:167],a[108:111],v[196:199]
M v[196:199],a[160:163],a[104:107],v[196:199]
s_nop 0
T a[92:93],v4,57344
T a[94:95],v4,58368
M v[200:203],a[160:163],a[112:115],v[200:203]
buffer_load_dwordx4 v11, s[16:19], s21 offen offset:3072   lds
M v[200:203],a[164:167],a[116:119],v[200:203]
SA s21,s21,128
M v[204:207],a[164:167],a[124:127],v[204:207]
M v[204:207],a[160:163],a[120:123],v[204:207]
M v[208:211],a[160:163],a[128:131],v[208:211]
M v[208:211],a[164:167],a[132:135],v[208:211]
M v[212:215],a[164:167],a[140:143],v[212:215]
M v[212:215],a[160:163],a[136:139],v[212:215]
M v[216:219],a[160:163],a[144:147],v[216:219]
M v[216:219],a[164:167],a[148:151],v[216:219]
s_waitcnt lgkmcnt(2)
M v[220:223],a[164:167],a[156:159],v[220:223]
s_waitcnt vmcnt(17) lgkmcnt(0)
M v[220:223],a[160:163],a[152:155],v[220:223]
s_barrier
M v[252:255],a[168:171],a[152:155],v[252:255]
R a[160:163],v5,32768
R a[164:167],v6,32768
M v[252:255],a[172:175],a[156:159],v[252:255]
buffer_load_dword a240, v23, s[52:55], 0 offen offset:0
M v[248:251],a[172:175],a[148:151],v[248:251]
L_w_kv15:
s_cbranch_execz L_wd2
v_add_u32 v23, 16384, v23
M v[248:251],a[168:171],a[144:147],v[248:251]
M v[244:247],a[168:171],a[136:139],v[244:247]
M v[244:247],a[172:175],a[140:143],v[244:247]
M v[240:243],a[172:175],a[132:135],v[240:243]
M v[240:243],a[168:171],a[128:131],v[240:243]
M v[236:239],a[168:171],a[120:123],v[236:239]
M v[236:239],a[172:175],a[124:127],v[236:239]
M v[232:235],a[172:175],a[116:119],v[232:235]
M v[232:235],a[168:171],a[112:115],v[232:235]
M v[228:231],a[168:171],a[104:107],v[228:231]
M v[228:231],a[172:175],a[108:111],v[228:231]
s_waitcnt lgkmcnt(0)
M v[224:227],a[172:175],a[100:103],v[224:227]
M v[224:227],a[168:171],a[96:99],v[224:227]
M a[0:3],a[160:163],a[32:35],a[0:3]
R a[168:171],v5,34816
R a[172:175],v6,34816
M a[0:3],a[164:167],a[36:39],a[0:3]
T a[96:97],v1,0
T a[98:99],v1,1024
M a[4:7],a[164:167],a[44:47],a[4:7]
SA m0,s24,16384
M a[4:7],a[160:163],a[40:43],a[4:7]
buffer_load_dwordx4 v12, s[48:51], s22 offen offset:0   lds
M a[8:11],a[160:163],a[48:51],a[8:11]
M a[8:11],a[164:167],a[52:55],a[8:11]
M a[12:15],a[164:167],a[60:63],a[12:15]
s_nop 0
T a[100:101],v1,8192
T a[102:103],v1,9216
M a[12:15],a[160:163],a[56:59],a[12:15]
M a[16:19],a[160:163],a[64:67],a[16:19]
buffer_load_dwordx4 v13, s[48:51], s22 offen offset:1024   lds
M a[16:19],a[164:167],a[68:71],a[16:19]
M a[20:23],a[164:167],a[76:79],a[20:23]
M a[20:23],a[160:163],a[72:75],a[20:23]
s_nop 0
T a[104:105],v2,0
T a[106:107],v2,1024
M a[24:27],a[160:163],a[80:83],a[24:27]
M a[24:27],a[164:167],a[84:87],a[24:27]
s_waitcnt lgkmcnt(6)
buffer_load_dwordx4 v14, s[48:51], s22 offen offset:2048   lds
M a[28:31],a[164:167],a[92:95],a[28:31]
M a[28:31],a[160:163],a[88:91],a[28:31]
M v[60:63],a[168:171],a[88:91],v[60:63]
R a[160:163],v5,36864
R a[164:167],v6,36864
M v[60:63],a[172:175],a[92:95],v[60:63]
T a[108:109],v2,8192
T a[110:111],v2,9216
M v[56:59],a[172:175],a[84:87],v[56:59]
buffer_load_dwordx4 v15, s[48:51], s22 offen offset:3072   lds
M v[56:59],a[168:171],a[80:83],v[56:59]
s_sub_u32 s22, s22, 1048448
M v[52:55],a[168:171],a[72:75],v[52:55]
M v[52:55],a[172:175],a[76:79],v[52:55]
s_nop 0
T a[112:113],v3,0
T a[114:115],v3,1024
M v[48:51],a[172:175],a[68:71],v[48:51]
SA m0,s23,49152
M v[48:51],a[168:171],a[64:67],v[48:51]
buffer_load_dwordx4 v8, s[16:19], s21 offen offset:0   lds
M v[44:47],a[168:171],a[56:59],v[44:47]
M v[44:47],a[172:175],a[60:63],v[44:47]
M v[40:43],a[172:175],a[52:55],v[40:43]
s_nop 0
T a[116:117],v3,8192
T a[118:119],v3,9216
M v[40:43],a[168:171],a[48:51],v[40:43]
M v[36:39],a[168:171],a[40:43],v[36:39]
buffer_load_dwordx4 v9, s[16:19], s21 offen offset:1024   lds
M v[36:39],a[172:175],a[44:47],v[36:39]
s_waitcnt lgkmcnt(6)
M v[32:35],a[172:175],a[36:39],v[32:35]
M v[32:35],a[168:171],a[32:35],v[32:35]
s_nop 0
T a[120:121],v4,0
T a[122:123],v4,1024
M v[64:67],a[160:163],a[32:35],v[64:67]
R a[168:171],v5,38912
R a[172:175],v6,38912
M v[64:67],a[164:167],a[36:39],v[64:67]
buffer_load_dwordx4 v10, s[16:19], s21 offen offset:2048   lds
M v[68:71],a[164:167],a[44:47],v[68:71]
M v[68:71],a[160:163],a[40:43],v[68:71]
M v[72:75],a[160:163],a[48:51],v[72:75]
s_nop 0
T a[124:125],v4,8192
T a[126:127],v4,9216
M v[72:75],a[164:167],a[52:55],v[72:75]
M v[76:79],a[164:167],a[60:63],v[76:79]
buffer_load_dwordx4 v11, s[16:19], s21 offen offset:3072   lds
M v[76:79],a[160:163],a[56:59],v[76:79]
SA s21,s21,524160
M v[80:83],a[160:163],a[64:67],v[80:83]
M v[80:83],a[164:167],a[68:71],v[80:83]
M v[84:87],a[164:167],a[76:79],v[84:87]
M v[84:87],a[160:163],a[72:75],v[84:87]
M v[88:91],a[160:163],a[80:83],v[88:91]
M v[88:91],a[164:167],a[84:87],v[88:91]
s_waitcnt lgkmcnt(2)
M v[92:95],a[164:167],a[92:95],v[92:95]
s_waitcnt vmcnt(17) lgkmcnt(0)
M v[92:95],a[160:163],a[88:91],v[92:95]
s_barrier
M v[124:127],a[168:171],a[88:91],v[124:127]
R a[160:163],v5,49152
R a[164:167],v6,49152
M v[124:127],a[172:175],a[92:95],v[124:127]
M v[120:123],a[172:175],a[84:87],v[120:123]
SA m0,s24,32768
T a[128:129],v1,16384
T a[130:131],v1,17408
M v[120:123],a[168:171],a[80:83],v[120:123]
buffer_load_dwordx4 v12, s[48:51], s22 offen offset:0   lds
M v[116:119],a[168:171],a[72:75],v[116:119]
M v[116:119],a[172:175],a[76:79],v[116:119]
M v[112:115],a[172:175],a[68:71],v[112:115]
M v[112:115],a[168:171],a[64:67],v[112:115]
M v[108:111],a[168:171],a[56:59],v[108:111]
M v[108:111],a[172:175],a[60:63],v[108:111]
s_nop 0
T a[132:133],v1,24576
T a[134:135],v1,25600
M v[104:107],a[172:175],a[52:55],v[104:107]
buffer_load_dwordx4 v13, s[48:51], s22 offen offset:1024   lds
M v[104:107],a[168:171],a[48:51],v[104:107]
M v[100:103],a[168:171],a[40:43],v[100:103]
M v[100:103],a[172:175],a[44:47],v[100:103]
s_waitcnt lgkmcnt(4)
M v[96:99],a[172:175],a[36:39],v[96:99]
M v[96:99],a[168:171],a[32:35],v[96:99]
M v[128:131],a[160:163],a[32:35],v[128:131]
R a[168:171],v5,51200
R a[172:175],v6,51200
M v[128:131],a[164:167],a[36:39],v[128:131]
T a[136:137],v2,16384
T a[138:139],v2,17408
M v[132:135],a[164:167],a[44:47],v[132:135]
buffer_load_dwordx4 v14, s[48:51], s22 offen offset:2048   lds
M v[132:135],a[160:163],a[40:43],v[132:135]
M v[136:139],a[160:163],a[48:51],v[136:139]
M v[136:139],a[164:167],a[52:55],v[136:139]
M v[140:143],a[164:167],a[60:63],v[140:143]
M v[140:143],a[160:163],a[56:59],v[140:143]
s_nop 0
T a[140:141],v2,24576
T a[142:143],v2,25600
M v[144:147],a[160:163],a[64:67],v[144:147]
buffer_load_dwordx4 v15, s[48:51], s22 offen offset:3072   lds
M v[144:147],a[164:167],a[68:71],v[144:147]
SA s22,s22,1048576
M v[148:151],a[164:167],a[76:79],v[148:151]
M v[148:151],a[160:163],a[72:75],v[148:151]
M v[152:155],a[160:163],a[80:83],v[152:155]
M v[152:155],a[164:167],a[84:87],v[152:155]
s_waitcnt lgkmcnt(4)
M v[156:159],a[164:167],a[92:95],v[156:159]
SA m0,s23,0
T a[144:145],v3,16384
T a[146:147],v3,17408
M v[156:159],a[160:163],a[88:91],v[156:159]
buffer_load_dwordx4 v8, s[16:19], s21 offen offset:0   lds
M v[188:191],a[168:171],a[88:91],v[188:191]
R a[160:163],v5,53248
R a[164:167],v6,53248
M v[188:191],a[172:175],a[92:95],v[188:191]
M v[184:187],a[172:175],a[84:87],v[184:187]
M v[184:187],a[168:171],a[80:83],v[184:187]
M v[180:183],a[168:171],a[72:75],v[180:183]
M v[180:183],a[172:175],a[76:79],v[180:183]
s_nop 0
T a[148:149],v3,24576
T a[150:151],v3,25600
M v[176:179],a[172:175],a[68:71],v[176:179]
buffer_load_dwordx4 v9, s[16:19], s21 offen offset:1024   lds
M v[176:179],a[168:171],a[64:67],v[176:179]
M v[172:175],a[168:171],a[56:59],v[172:175]
M v[172:175],a[172:175],a[60:63],v[172:175]
M v[168:171],a[172:175],a[52:55],v[168:171]
M v[168:171],a[168:171],a[48:51],v[168:171]
M v[164:167],a[168:171],a[40:43],v[164:167]
s_nop 0
T a[152:153],v4,16384
T a[154:155],v4,17408
M v[164:167],a[172:175],a[44:47],v[164:167]
s_waitcnt lgkmcnt(4)
buffer_load_dwordx4 v10, s[16:19], s21 offen offset:2048   lds
M v[160:163],a[172:175],a[36:39],v[160:163]
M v[160:163],a[168:171],a[32:35],v[160:163]
M v[192:195],a[160:163],a[32:35],v[192:195]
R a[168:171],v5,55296
R a[172:175],v6,55296
M v[192:195],a[164:167],a[36:39],v[192:195]
M v[196:199],a[164:167],a[44:47],v[196:199]
M v[196:199],a[160:163],a[40:43],v[196:199]
s_nop 0
T a[156:157],v4,24576
T a[158:159],v4,25600
M v[200:203],a[160:163],a[48:51],v[200:203]
buffer_load_dwordx4 v11, s[16:19], s21 offen offset:3072   lds
M v[200:203],a[164:167],a[52:55],v[200:203]
SA s21,s21,128
M v[204:207],a[164:167],a[60:63],v[204:207]
M v[204:207],a[160:163],a[56:59],v[204:207]
M v[208:211],a[160:163],a[64:67],v[208:211]
M v[208:211],a[164:167],a[68:71],v[208:211]
M v[212:215],a[164:167],a[76:79],v[212:215]
M v[212:215],a[160:163],a[72:75],v[212:215]
M v[216:219],a[160:163],a[80:83],v[216:219]
M v[216:219],a[164:167],a[84:87],v[216:219]
s_waitcnt lgkmcnt(2)
M v[220:223],a[164:167],a[92:95],v[220:223]
s_waitcnt vmcnt(17) lgkmcnt(0)
M v[220:223],a[160:163],a[88:91],v[220:223]
s_barrier
M v[252:255],a[168:171],a[88:91],v[252:255]
R a[160:163],v5,0
R a[164:167],v6,0
M v[252:255],a[172:175],a[92:95],v[252:255]
M v[248:251],a[172:175],a[84:87],v[248:251]
M v[248:251],a[168:171],a[80:83],v[248:251]
M v[244:247],a[168:171],a[72:75],v[244:247]
M v[244:247],a[172:175],a[76:79],v[244:247]
M v[240:243],a[172:175],a[68:71],v[240:243]
M v[240:243],a[168:171],a[64:67],v[240:243]
M v[236:239],a[168:171],a[56:59],v[236:239]
M v[236:239],a[172:175],a[60:63],v[236:239]
M v[232:235],a[172:175],a[52:55],v[232:235]
M v[232:235],a[168:171],a[48:51],v[232:235]
M v[228:231],a[168:171],a[40:43],v[228:231]
M v[228:231],a[172:175],a[44:47],v[228:231]
s_waitcnt lgkmcnt(0)
M v[224:227],a[172:175],a[36:39],v[224:227]
M v[224:227],a[168:171],a[32:35],v[224:227]
M a[0:3],a[160:163],a[96:99],a[0:3]
R a[168:171],v5,2048
R a[172:175],v6,2048
M a[0:3],a[164:167],a[100:103],a[0:3]
T a[32:33],v1,32768
T a[34:35],v1,33792
M a[4:7],a[164:167],a[108:111],a[4:7]
SA m0,s24,49152
v_lshrrev_b32 v28, 4, v0
v_and_b32 v29, 7, v0
M a[4:7],a[160:163],a[104:107],a[4:7]
buffer_load_dwordx4 v12, s[48:51], s22 offen offset:0   lds
M a[8:11],a[160:163],a[112:115],a[8:11]
v_xor_b32 v28, v28, v29
v_lshlrev_b32 v28, 4, v28
M a[8:11],a[164:167],a[116:119],a[8:11]
v_lshrrev_b32 v29, 3, v0
v_mul_u32_u24 v29, 896, v29
M a[12:15],a[164:167],a[124:127],a[12:15]
T a[36:37],v1,40960
T a[38:39],v1,41984
M a[12:15],a[160:163],a[120:123],a[12:15]
v_add_u32 v22, v28, v29
v_xor_b32 v28, 64, v28
M a[16:19],a[160:163],a[128:131],a[16:19]
s_mul_i32 s64, s20, 14336
buffer_load_dwordx4 v13, s[48:51], s22 offen offset:1024   lds
M a[16:19],a[164:167],a[132:135],a[16:19]
s_sub_u32 s65, 98304, s64
M a[20:23],a[164:167],a[140:143],a[20:23]
SA s30,s29,s65
M a[20:23],a[160:163],a[136:139],a[20:23]
SA s29,s29,s64
T a[40:41],v2,32768
T a[42:43],v2,33792
M a[24:27],a[160:163],a[144:147],a[24:27]
v_add_u32 v29, 6144, v29
v_add_u32 v23, v28, v29
M a[24:27],a[164:167],a[148:151],a[24:27]
s_waitcnt lgkmcnt(6)
buffer_load_dwordx4 v14, s[48:51], s22 offen offset:2048   lds
M a[28:31],a[164:167],a[156:159],a[28:31]
s_and_b32 s64, s20, 1
M a[28:31],a[160:163],a[152:155],a[28:31]
s_lshl_b32 s64, s64, 12
M v[60:63],a[168:171],a[152:155],v[60:63]
SA s64,s64,65536
R a[160:163],v5,4096
R a[164:167],v6,4096
M v[60:63],a[172:175],a[156:159],v[60:63]
T a[44:45],v2,40960
T a[46:47],v2,41984
M v[56:59],a[172:175],a[148:151],v[56:59]
buffer_load_dwordx4 v15, s[48:51], s22 offen offset:3072   lds
M v[56:59],a[168:171],a[144:147],v[56:59]
s_sub_u32 s22, s22, 1048448
v_add_u32 v20, s64, v5
v_add_u32 v21, s64, v6
M v[52:55],a[168:171],a[136:139],v[52:55]
M v[52:55],a[172:175],a[140:143],v[52:55]
s_nop 0
T a[48:49],v3,32768
T a[50:51],v3,33792
M v[48:51],a[172:175],a[132:135],v[48:51]
SA m0,s23,16384
M v[48:51],a[168:171],a[128:131],v[48:51]
buffer_load_dwordx4 v8, s[16:19], s21 offen offset:0   lds
M v[44:47],a[168:171],a[120:123],v[44:47]
M v[44:47],a[172:175],a[124:127],v[44:47]
M v[40:43],a[172:175],a[116:119],v[40:43]
s_nop 0
T a[52:53],v3,40960
T a[54:55],v3,41984
M v[40:43],a[168:171],a[112:115],v[40:43]
M v[36:39],a[168:171],a[104:107],v[36:39]
buffer_load_dwordx4 v9, s[16:19], s21 offen offset:1024   lds
M v[36:39],a[172:175],a[108:111],v[36:39]
s_waitcnt lgkmcnt(6)
M v[32:35],a[172:175],a[100:103],v[32:35]
M v[32:35],a[168:171],a[96:99],v[32:35]
s_nop 0
T a[56:57],v4,32768
T a[58:59],v4,33792
M v[64:67],a[160:163],a[96:99],v[64:67]
R a[168:171],v5,6144
R a[172:175],v6,6144
M v[64:67],a[164:167],a[100:103],v[64:67]
buffer_load_dwordx4 v10, s[16:19], s21 offen offset:2048   lds
M v[68:71],a[164:167],a[108:111],v[68:71]
M v[68:71],a[160:163],a[104:107],v[68:71]
M v[72:75],a[160:163],a[112:115],v[72:75]
s_nop 0
T a[60:61],v4,40960
T a[62:63],v4,41984
M v[72:75],a[164:167],a[116:119],v[72:75]
M v[76:79],a[164:167],a[124:127],v[76:79]
buffer_load_dwordx4 v11, s[16:19], s21 offen offset:3072   lds
M v[76:79],a[160:163],a[120:123],v[76:79]
SA s21,s21,524160
M v[80:83],a[160:163],a[128:131],v[80:83]
M v[80:83],a[164:167],a[132:135],v[80:83]
M v[84:87],a[164:167],a[140:143],v[84:87]
M v[84:87],a[160:163],a[136:139],v[84:87]
M v[88:91],a[160:163],a[144:147],v[88:91]
M v[88:91],a[164:167],a[148:151],v[88:91]
s_waitcnt lgkmcnt(2)
M v[92:95],a[164:167],a[156:159],v[92:95]
s_waitcnt vmcnt(16) lgkmcnt(0)
M v[92:95],a[160:163],a[152:155],v[92:95]
s_barrier
M v[124:127],a[168:171],a[152:155],v[124:127]
R a[160:163],v5,16384
R a[164:167],v6,16384
M v[124:127],a[172:175],a[156:159],v[124:127]
SA m0,s23,131072
M v[120:123],a[172:175],a[148:151],v[120:123]
s_nop 0
T a[64:65],v1,49152
T a[66:67],v1,50176
M v[120:123],a[168:171],a[144:147],v[120:123]
buffer_load_dwordx4 v22, s[56:59], s29 offen offset:0 lds
M v[116:119],a[168:171],a[136:139],v[116:119]
M v[116:119],a[172:175],a[140:143],v[116:119]
M v[112:115],a[172:175],a[132:135],v[112:115]
buffer_load_dwordx4 v23, s[56:59], s29 offen offset:1024 lds
M v[112:115],a[168:171],a[128:131],v[112:115]
M v[108:111],a[168:171],a[120:123],v[108:111]
M v[108:111],a[172:175],a[124:127],v[108:111]
s_nop 0
T a[68:69],v1,57344
T a[70:71],v1,58368
M v[104:107],a[172:175],a[116:119],v[104:107]
buffer_load_dwordx4 v22, s[56:59], s30 offen offset:2048 lds
M v[104:107],a[168:171],a[112:115],v[104:107]
M v[100:103],a[168:171],a[104:107],v[100:103]
M v[100:103],a[172:175],a[108:111],v[100:103]
s_waitcnt lgkmcnt(4)
M v[96:99],a[172:175],a[100:103],v[96:99]
M v[96:99],a[168:171],a[96:99],v[96:99]
buffer_load_dwordx4 v23, s[56:59], s30 offen offset:3072 lds
M v[128:131],a[160:163],a[96:99],v[128:131]
R a[168:171],v5,18432
R a[172:175],v6,18432
M v[128:131],a[164:167],a[100:103],v[128:131]
SA s29,s29,128
T a[72:73],v2,49152
T a[74:75],v2,50176
M v[132:135],a[164:167],a[108:111],v[132:135]
SA s30,s30,128
M v[132:135],a[160:163],a[104:107],v[132:135]
SA m0,s24,0
M v[136:139],a[160:163],a[112:115],v[136:139]
buffer_load_dwordx4 v12, s[48:51], s22 offen offset:0   lds
M v[136:139],a[164:167],a[116:119],v[136:139]
M v[140:143],a[164:167],a[124:127],v[140:143]
M v[140:143],a[160:163],a[120:123],v[140:143]
s_nop 0
T a[76:77],v2,57344
T a[78:79],v2,58368
M v[144:147],a[160:163],a[128:131],v[144:147]
buffer_load_dwordx4 v13, s[48:51], s22 offen offset:1024   lds
M v[144:147],a[164:167],a[132:135],v[144:147]
M v[148:151],a[164:167],a[140:143],v[148:151]
M v[148:151],a[160:163],a[136:139],v[148:151]
M v[152:155],a[160:163],a[144:147],v[152:155]
M v[152:155],a[164:167],a[148:151],v[152:155]
s_waitcnt lgkmcnt(4)
buffer_load_dwordx4 v14, s[48:51], s22 offen offset:2048   lds
M v[156:159],a[164:167],a[156:159],v[156:159]
s_nop 0
T a[80:81],v3,49152
T a[82:83],v3,50176
M v[156:159],a[160:163],a[152:155],v[156:159]
M v[188:191],a[168:171],a[152:155],v[188:191]
R a[160:163],v5,20480
R a[164:167],v6,20480
M v[188:191],a[172:175],a[156:159],v[188:191]
M v[184:187],a[172:175],a[148:151],v[184:187]
buffer_load_dwordx4 v15, s[48:51], s22 offen offset:3072   lds
M v[184:187],a[168:171],a[144:147],v[184:187]
M v[180:183],a[168:171],a[136:139],v[180:183]
M v[180:183],a[172:175],a[140:143],v[180:183]
SA s22,s22,1048576
T a[84:85],v3,57344
T a[86:87],v3,58368
M v[176:179],a[172:175],a[132:135],v[176:179]
SA m0,s23,32768
M v[176:179],a[168:171],a[128:131],v[176:179]
buffer_load_dwordx4 v8, s[16:19], s21 offen offset:0   lds
M v[172:175],a[168:171],a[120:123],v[172:175]
M v[172:175],a[172:175],a[124:127],v[172:175]
M v[168:171],a[172:175],a[116:119],v[168:171]
M v[168:171],a[168:171],a[112:115],v[168:171]
buffer_load_dwordx4 v9, s[16:19], s21 offen offset:1024   lds
M v[164:167],a[168:171],a[104:107],v[164:167]
s_nop 0
T a[88:89],v4,49152
T a[90:91],v4,50176
M v[164:167],a[172:175],a[108:111],v[164:167]
s_waitcnt lgkmcnt(4)
M v[160:163],a[172:175],a[100:103],v[160:163]
M v[160:163],a[168:171],a[96:99],v[160:163]
M v[192:195],a[160:163],a[96:99],v[192:195]
R a[168:171],v5,22528
R a[172:175],v6,22528
M v[192:195],a[164:167],a[100:103],v[192:195]
buffer_load_dwordx4 v10, s[16:19], s21 offen offset:2048   lds
M v[196:199],a[164:167],a[108:111],v[196:199]
M v[196:199],a[160:163],a[104:107],v[196:199]
s_nop 0
T a[92:93],v4,57344
T a[94:95],v4,58368
M v[200:203],a[160:163],a[112:115],v[200:203]
M v[200:203],a[164:167],a[116:119],v[200:203]
buffer_load_dwordx4 v11, s[16:19], s21 offen offset:3072   lds
M v[204:207],a[164:167],a[124:127],v[204:207]
M v[204:207],a[160:163],a[120:123],v[204:207]
M v[208:211],a[160:163],a[128:131],v[208:211]
M v[208:211],a[164:167],a[132:135],v[208:211]
M v[212:215],a[164:167],a[140:143],v[212:215]
SA s21,s21,128
M v[212:215],a[160:163],a[136:139],v[212:215]
M v[216:219],a[160:163],a[144:147],v[216:219]
M v[216:219],a[164:167],a[148:151],v[216:219]
s_waitcnt lgkmcnt(2)
M v[220:223],a[164:167],a[156:159],v[220:223]
s_waitcnt vmcnt(20) lgkmcnt(0)
M v[220:223],a[160:163],a[152:155],v[220:223]
s_barrier
M v[252:255],a[168:171],a[152:155],v[252:255]
R a[160:163],v5,32768
R a[164:167],v6,32768
M v[252:255],a[172:175],a[156:159],v[252:255]
M v[248:251],a[172:175],a[148:151],v[248:251]
M v[248:251],a[168:171],a[144:147],v[248:251]
M v[244:247],a[168:171],a[136:139],v[244:247]
M v[244:247],a[172:175],a[140:143],v[244:247]
M v[240:243],a[172:175],a[132:135],v[240:243]
M v[240:243],a[168:171],a[128:131],v[240:243]
M v[236:239],a[168:171],a[120:123],v[236:239]
M v[236:239],a[172:175],a[124:127],v[236:239]
M v[232:235],a[172:175],a[116:119],v[232:235]
M v[232:235],a[168:171],a[112:115],v[232:235]
M v[228:231],a[168:171],a[104:107],v[228:231]
M v[228:231],a[172:175],a[108:111],v[228:231]
s_waitcnt lgkmcnt(0)
M v[224:227],a[172:175],a[100:103],v[224:227]
M v[224:227],a[168:171],a[96:99],v[224:227]
M a[0:3],a[160:163],a[32:35],a[0:3]
R a[168:171],v5,34816
R a[172:175],v6,34816
M a[0:3],a[164:167],a[36:39],a[0:3]
SA m0,s23,147456
T a[96:97],v1,0
T a[98:99],v1,1024
M a[4:7],a[164:167],a[44:47],a[4:7]
buffer_load_dwordx4 v22, s[56:59], s29 offen offset:0 lds
M a[4:7],a[160:163],a[40:43],a[4:7]
M a[8:11],a[160:163],a[48:51],a[8:11]
M a[8:11],a[164:167],a[52:55],a[8:11]
buffer_load_dwordx4 v23, s[56:59], s29 offen offset:1024 lds
M a[12:15],a[164:167],a[60:63],a[12:15]
s_nop 0
T a[100:101],v1,8192
T a[102:103],v1,9216
M a[12:15],a[160:163],a[56:59],a[12:15]
M a[16:19],a[160:163],a[64:67],a[16:19]
buffer_load_dwordx4 v22, s[56:59], s30 offen offset:2048 lds
M a[16:19],a[164:167],a[68:71],a[16:19]
M a[20:23],a[164:167],a[76:79],a[20:23]
M a[20:23],a[160:163],a[72:75],a[20:23]
s_nop 0
T a[104:105],v2,0
T a[106:107],v2,1024
M a[24:27],a[160:163],a[80:83],a[24:27]
buffer_load_dwordx4 v23, s[56:59], s30 offen offset:3072 lds
M a[24:27],a[164:167],a[84:87],a[24:27]
s_waitcnt lgkmcnt(6)
M a[28:31],a[164:167],a[92:95],a[28:31]
SA s29,s29,128
M a[28:31],a[160:163],a[88:91],a[28:31]
SA s30,s30,128
M v[60:63],a[168:171],a[88:91],v[60:63]
SA m0,s24,16384
R a[160:163],v5,36864
R a[164:167],v6,36864
M v[60:63],a[172:175],a[92:95],v[60:63]
T a[108:109],v2,8192
T a[110:111],v2,9216
M v[56:59],a[172:175],a[84:87],v[56:59]
buffer_load_dwordx4 v12, s[48:51], s22 offen offset:0   lds
M v[56:59],a[168:171],a[80:83],v[56:59]
M v[52:55],a[168:171],a[72:75],v[52:55]
M v[52:55],a[172:175],a[76:79],v[52:55]
s_nop 0
T a[112:113],v3,0
T a[114:115],v3,1024
M v[48:51],a[172:175],a[68:71],v[48:51]
buffer_load_dwordx4 v13, s[48:51], s22 offen offset:1024   lds
M v[48:51],a[168:171],a[64:67],v[48:51]
M v[44:47],a[168:171],a[56:59],v[44:47]
M v[44:47],a[172:175],a[60:63],v[44:47]
buffer_load_dwordx4 v14, s[48:51], s22 offen offset:2048   lds
M v[40:43],a[172:175],a[52:55],v[40:43]
s_nop 0
T a[116:117],v3,8192
T a[118:119],v3,9216
L_w_kv16:
s_cbranch_execz L_wd2
M v[40:43],a[168:171],a[48:51],v[40:43]
M v[36:39],a[168:171],a[40:43],v[36:39]
buffer_load_dwordx4 v15, s[48:51], s22 offen offset:3072   lds
M v[36:39],a[172:175],a[44:47],v[36:39]
s_waitcnt lgkmcnt(6)
M v[32:35],a[172:175],a[36:39],v[32:35]
s_sub_u32 s22, s22, 1048448
M v[32:35],a[168:171],a[32:35],v[32:35]
SA m0,s23,49152
T a[120:121],v4,0
T a[122:123],v4,1024
M v[64:67],a[160:163],a[32:35],v[64:67]
R a[168:171],v5,38912
R a[172:175],v6,38912
M v[64:67],a[164:167],a[36:39],v[64:67]
buffer_load_dwordx4 v8, s[16:19], s21 offen offset:0   lds
M v[68:71],a[164:167],a[44:47],v[68:71]
M v[68:71],a[160:163],a[40:43],v[68:71]
M v[72:75],a[160:163],a[48:51],v[72:75]
s_waitcnt vmcnt(17)
s_nop 0
T a[124:125],v4,8192
T a[126:127],v4,9216
M v[72:75],a[164:167],a[52:55],v[72:75]
buffer_load_dwordx4 v9, s[16:19], s21 offen offset:1024   lds
M v[76:79],a[164:167],a[60:63],v[76:79]
R a[176:179],v20,0
R a[180:183],v20,2048
M v[76:79],a[160:163],a[56:59],v[76:79]
R a[184:187],v21,0
R a[188:191],v21,2048
M v[80:83],a[160:163],a[64:67],v[80:83]
buffer_load_dwordx4 v10, s[16:19], s21 offen offset:2048   lds
M v[80:83],a[164:167],a[68:71],v[80:83]
M v[84:87],a[164:167],a[76:79],v[84:87]
M v[84:87],a[160:163],a[72:75],v[84:87]
buffer_load_dwordx4 v11, s[16:19], s21 offen offset:3072   lds
M v[88:91],a[160:163],a[80:83],v[88:91]
SA s21,s21,524160
M v[88:91],a[164:167],a[84:87],v[88:91]
s_waitcnt lgkmcnt(6)
M v[92:95],a[164:167],a[92:95],v[92:95]
s_waitcnt lgkmcnt(0)
M v[92:95],a[160:163],a[88:91],v[92:95]
s_barrier
M v[124:127],a[168:171],a[88:91],v[124:127]
s_lshl_b32 s4, s20, 10
R a[160:163],v5,49152
R a[164:167],v6,49152
M v[124:127],a[172:175],a[92:95],v[124:127]
SA m0,s23,131072
v_bfe_u32 v28, v0, 3, 2
M v[120:123],a[172:175],a[84:87],v[120:123]
s_nop 0
T a[128:129],v1,16384
T a[130:131],v1,17408
M v[120:123],a[168:171],a[80:83],v[120:123]
buffer_load_dwordx4 v22, s[56:59], s29 offen offset:0 lds
M v[116:119],a[168:171],a[72:75],v[116:119]
v_lshrrev_b32 v29, 5, v0
v_lshl_add_u32 v28, v29, 3, v28
M v[116:119],a[172:175],a[76:79],v[116:119]
M v[112:115],a[172:175],a[68:71],v[112:115]
v_lshlrev_b32 v28, 13, v28
M v[112:115],a[168:171],a[64:67],v[112:115]
M v[108:111],a[168:171],a[56:59],v[108:111]
buffer_load_dwordx4 v23, s[56:59], s29 offen offset:1024 lds
M v[108:111],a[172:175],a[60:63],v[108:111]
s_nop 0
T a[132:133],v1,24576
T a[134:135],v1,25600
M v[104:107],a[172:175],a[52:55],v[104:107]
v_lshrrev_b32 v29, 4, v0
v_lshlrev_b32 v29, 1, v29
M v[104:107],a[168:171],a[48:51],v[104:107]
M v[100:103],a[168:171],a[40:43],v[100:103]
v_and_b32 v30, 7, v0
M v[100:103],a[172:175],a[44:47],v[100:103]
s_waitcnt lgkmcnt(4)
M v[96:99],a[172:175],a[36:39],v[96:99]
v_xor_b32 v29, v29, v30
M v[96:99],a[168:171],a[32:35],v[96:99]
buffer_load_dwordx4 v22, s[56:59], s30 offen offset:2048 lds
M v[128:131],a[160:163],a[32:35],v[128:131]
R a[168:171],v5,51200
R a[172:175],v6,51200
M v[128:131],a[164:167],a[36:39],v[128:131]
T a[136:137],v2,16384
T a[138:139],v2,17408
M v[132:135],a[164:167],a[44:47],v[132:135]
v_lshl_add_u32 v28, v29, 4, v28
M v[132:135],a[160:163],a[40:43],v[132:135]
s_and_b32 s64, s20, 1
M v[136:139],a[160:163],a[48:51],v[136:139]
s_lshl_b32 s64, s64, 17
M v[136:139],a[164:167],a[52:55],v[136:139]
s_lshr_b32 s65, s20, 1
M v[140:143],a[164:167],a[60:63],v[140:143]
s_lshl_b32 s65, s65, 15
SA s64,s64,s65
v_add_u32 v8, s64, v28
M v[140:143],a[160:163],a[56:59],v[140:143]
s_nop 0
T a[140:141],v2,24576
T a[142:143],v2,25600
M v[144:147],a[160:163],a[64:67],v[144:147]
buffer_load_dwordx4 v23, s[56:59], s30 offen offset:3072 lds
M v[144:147],a[164:167],a[68:71],v[144:147]
M v[148:151],a[164:167],a[76:79],v[148:151]
SA s29,s29,128
M v[148:151],a[160:163],a[72:75],v[148:151]
SA s30,s30,128
M v[152:155],a[160:163],a[80:83],v[152:155]
SA m0,s24,32768
M v[152:155],a[164:167],a[84:87],v[152:155]
s_waitcnt lgkmcnt(4)
buffer_load_dwordx4 v12, s[48:51], s22 offen offset:0   lds
M v[156:159],a[164:167],a[92:95],v[156:159]
s_nop 0
T a[144:145],v3,16384
T a[146:147],v3,17408
M v[156:159],a[160:163],a[88:91],v[156:159]
M v[188:191],a[168:171],a[88:91],v[188:191]
R a[160:163],v5,53248
R a[164:167],v6,53248
M v[188:191],a[172:175],a[92:95],v[188:191]
M v[184:187],a[172:175],a[84:87],v[184:187]
M v[184:187],a[168:171],a[80:83],v[184:187]
M v[180:183],a[168:171],a[72:75],v[180:183]
buffer_load_dwordx4 v13, s[48:51], s22 offen offset:1024   lds
M v[180:183],a[172:175],a[76:79],v[180:183]
s_nop 0
T a[148:149],v3,24576
T a[150:151],v3,25600
M v[176:179],a[172:175],a[68:71],v[176:179]
M v[176:179],a[168:171],a[64:67],v[176:179]
M v[172:175],a[168:171],a[56:59],v[172:175]
M v[172:175],a[172:175],a[60:63],v[172:175]
M v[168:171],a[172:175],a[52:55],v[168:171]
M v[168:171],a[168:171],a[48:51],v[168:171]
buffer_load_dwordx4 v14, s[48:51], s22 offen offset:2048   lds
M v[164:167],a[168:171],a[40:43],v[164:167]
s_nop 0
T a[152:153],v4,16384
T a[154:155],v4,17408
M v[164:167],a[172:175],a[44:47],v[164:167]
s_waitcnt lgkmcnt(4)
M v[160:163],a[172:175],a[36:39],v[160:163]
M v[160:163],a[168:171],a[32:35],v[160:163]
M v[192:195],a[160:163],a[32:35],v[192:195]
R a[168:171],v5,55296
R a[172:175],v6,55296
M v[192:195],a[164:167],a[36:39],v[192:195]
M v[196:199],a[164:167],a[44:47],v[196:199]
buffer_load_dwordx4 v15, s[48:51], s22 offen offset:3072   lds
M v[196:199],a[160:163],a[40:43],v[196:199]
s_nop 0
T a[156:157],v4,24576
T a[158:159],v4,25600
M v[200:203],a[160:163],a[48:51],v[200:203]
s_waitcnt vmcnt(16)
R a[192:195],v20,16384
R a[196:199],v20,18432
M v[200:203],a[164:167],a[52:55],v[200:203]
R a[200:203],v21,16384
R a[204:207],v21,18432
M v[204:207],a[164:167],a[60:63],v[204:207]
M v[204:207],a[160:163],a[56:59],v[204:207]
M v[208:211],a[160:163],a[64:67],v[208:211]
M v[208:211],a[164:167],a[68:71],v[208:211]
M v[212:215],a[164:167],a[76:79],v[212:215]
SA s22,s22,1048576
M v[212:215],a[160:163],a[72:75],v[212:215]
M v[216:219],a[160:163],a[80:83],v[216:219]
M v[216:219],a[164:167],a[84:87],v[216:219]
s_waitcnt lgkmcnt(6)
M v[220:223],a[164:167],a[92:95],v[220:223]
s_waitcnt lgkmcnt(0)
M v[220:223],a[160:163],a[88:91],v[220:223]
s_barrier
M v[252:255],a[168:171],a[88:91],v[252:255]
R a[160:163],v5,0
R a[164:167],v6,0
M v[252:255],a[172:175],a[92:95],v[252:255]
M v[248:251],a[172:175],a[84:87],v[248:251]
M v[248:251],a[168:171],a[80:83],v[248:251]
M v[244:247],a[168:171],a[72:75],v[244:247]
M v[244:247],a[172:175],a[76:79],v[244:247]
M v[240:243],a[172:175],a[68:71],v[240:243]
M v[240:243],a[168:171],a[64:67],v[240:243]
M v[236:239],a[168:171],a[56:59],v[236:239]
M v[236:239],a[172:175],a[60:63],v[236:239]
M v[232:235],a[172:175],a[52:55],v[232:235]
M v[232:235],a[168:171],a[48:51],v[232:235]
M v[228:231],a[168:171],a[40:43],v[228:231]
M v[228:231],a[172:175],a[44:47],v[228:231]
s_waitcnt lgkmcnt(0)
M v[224:227],a[172:175],a[36:39],v[224:227]
M v[224:227],a[168:171],a[32:35],v[224:227]
M a[0:3],a[160:163],a[96:99],a[0:3]
R a[168:171],v5,2048
R a[172:175],v6,2048
M a[0:3],a[164:167],a[100:103],a[0:3]
SA m0,s23,147456
T a[32:33],v1,32768
T a[34:35],v1,33792
M a[4:7],a[164:167],a[108:111],a[4:7]
buffer_load_dwordx4 v22, s[56:59], s29 offen offset:0 lds
M a[4:7],a[160:163],a[104:107],a[4:7]
M a[8:11],a[160:163],a[112:115],a[8:11]
M a[8:11],a[164:167],a[116:119],a[8:11]
buffer_load_dwordx4 v23, s[56:59], s29 offen offset:1024 lds
M a[12:15],a[164:167],a[124:127],a[12:15]
s_nop 0
T a[36:37],v1,40960
T a[38:39],v1,41984
M a[12:15],a[160:163],a[120:123],a[12:15]
M a[16:19],a[160:163],a[128:131],a[16:19]
buffer_load_dwordx4 v22, s[56:59], s30 offen offset:2048 lds
M a[16:19],a[164:167],a[132:135],a[16:19]
M a[20:23],a[164:167],a[140:143],a[20:23]
M a[20:23],a[160:163],a[136:139],a[20:23]
s_nop 0
T a[40:41],v2,32768
T a[42:43],v2,33792
M a[24:27],a[160:163],a[144:147],a[24:27]
buffer_load_dwordx4 v23, s[56:59], s30 offen offset:3072 lds
M a[24:27],a[164:167],a[148:151],a[24:27]
s_waitcnt lgkmcnt(6)
M a[28:31],a[164:167],a[156:159],a[28:31]
SA s29,s29,128
M a[28:31],a[160:163],a[152:155],a[28:31]
SA s30,s30,128
M v[60:63],a[168:171],a[152:155],v[60:63]
SA m0,s24,49152
R a[160:163],v5,4096
R a[164:167],v6,4096
M v[60:63],a[172:175],a[156:159],v[60:63]
T a[44:45],v2,40960
T a[46:47],v2,41984
M v[56:59],a[172:175],a[148:151],v[56:59]
buffer_load_dwordx4 v12, s[48:51], s22 offen offset:0   lds
M v[56:59],a[168:171],a[144:147],v[56:59]
M v[52:55],a[168:171],a[136:139],v[52:55]
M v[52:55],a[172:175],a[140:143],v[52:55]
s_nop 0
T a[48:49],v3,32768
T a[50:51],v3,33792
M v[48:51],a[172:175],a[132:135],v[48:51]
buffer_load_dwordx4 v13, s[48:51], s22 offen offset:1024   lds
M v[48:51],a[168:171],a[128:131],v[48:51]
M v[44:47],a[168:171],a[120:123],v[44:47]
M v[44:47],a[172:175],a[124:127],v[44:47]
buffer_load_dwordx4 v14, s[48:51], s22 offen offset:2048   lds
M v[40:43],a[172:175],a[116:119],v[40:43]
s_nop 0
T a[52:53],v3,40960
T a[54:55],v3,41984
M v[40:43],a[168:171],a[112:115],v[40:43]
M v[36:39],a[168:171],a[104:107],v[36:39]
buffer_load_dwordx4 v15, s[48:51], s22 offen offset:3072   lds
M v[36:39],a[172:175],a[108:111],v[36:39]
s_waitcnt lgkmcnt(6)
M v[32:35],a[172:175],a[100:103],v[32:35]
s_sub_u32 s22, s22, 1048448
M v[32:35],a[168:171],a[96:99],v[32:35]
s_mov_b32 s25, 0
T a[56:57],v4,32768
T a[58:59],v4,33792
M v[64:67],a[160:163],a[96:99],v[64:67]
SA m0,s4,0
R a[168:171],v5,6144
R a[172:175],v6,6144
M v[64:67],a[164:167],a[100:103],v[64:67]
buffer_load_dwordx4 v8, s[52:55], s25 offen lds
M v[68:71],a[164:167],a[108:111],v[68:71]
s_mov_b32 s25, 262144
M v[68:71],a[160:163],a[104:107],v[68:71]
SA m0,s4,4096
M v[72:75],a[160:163],a[112:115],v[72:75]
s_waitcnt vmcnt(13)
s_nop 0
T a[60:61],v4,40960
T a[62:63],v4,41984
M v[72:75],a[164:167],a[116:119],v[72:75]
buffer_load_dwordx4 v8, s[52:55], s25 offen lds
M v[76:79],a[164:167],a[124:127],v[76:79]
s_mov_b32 s25, 524288
R a[208:211],v20,0
R a[212:215],v20,2048
M v[76:79],a[160:163],a[120:123],v[76:79]
SA m0,s4,8192
R a[216:219],v21,0
R a[220:223],v21,2048
M v[80:83],a[160:163],a[128:131],v[80:83]
buffer_load_dwordx4 v8, s[52:55], s25 offen lds
M v[80:83],a[164:167],a[132:135],v[80:83]
s_mov_b32 s25, 786432
M v[84:87],a[164:167],a[140:143],v[84:87]
SA m0,s4,12288
M v[84:87],a[160:163],a[136:139],v[84:87]
buffer_load_dwordx4 v8, s[52:55], s25 offen lds
M v[88:91],a[160:163],a[144:147],v[88:91]
M v[88:91],a[164:167],a[148:151],v[88:91]
s_waitcnt lgkmcnt(6)
M v[92:95],a[164:167],a[156:159],v[92:95]
s_waitcnt lgkmcnt(0)
M v[92:95],a[160:163],a[152:155],v[92:95]
s_barrier
M v[124:127],a[168:171],a[152:155],v[124:127]
R a[160:163],v5,16384
R a[164:167],v6,16384
M v[124:127],a[172:175],a[156:159],v[124:127]
SA m0,s23,32768
M v[120:123],a[172:175],a[148:151],v[120:123]
s_nop 0
T a[64:65],v1,49152
T a[66:67],v1,50176
M v[120:123],a[168:171],a[144:147],v[120:123]
buffer_load_dwordx4 v22, s[56:59], s29 offen offset:0 lds
M v[116:119],a[168:171],a[136:139],v[116:119]
v_lshrrev_b32 v28, 2, v0
v_lshlrev_b32 v28, 7, v28
M v[116:119],a[172:175],a[140:143],v[116:119]
M v[112:115],a[172:175],a[132:135],v[112:115]
buffer_load_dwordx4 v23, s[56:59], s29 offen offset:1024 lds
M v[112:115],a[168:171],a[128:131],v[112:115]
v_and_b32 v29, 3, v0
M v[108:111],a[168:171],a[120:123],v[108:111]
v_lshl_add_u32 v28, v29, 3, v28
M v[108:111],a[172:175],a[124:127],v[108:111]
s_nop 0
T a[68:69],v1,57344
T a[70:71],v1,58368
M v[104:107],a[172:175],a[116:119],v[104:107]
buffer_load_dwordx4 v22, s[56:59], s30 offen offset:2048 lds
M v[104:107],a[168:171],a[112:115],v[104:107]
v_bfe_u32 v29, v0, 3, 2
M v[100:103],a[168:171],a[104:107],v[100:103]
M v[100:103],a[172:175],a[108:111],v[100:103]
s_waitcnt lgkmcnt(4)
v_lshl_add_u32 v16, v29, 5, v28
M v[96:99],a[172:175],a[100:103],v[96:99]
M v[96:99],a[168:171],a[96:99],v[96:99]
buffer_load_dwordx4 v23, s[56:59], s30 offen offset:3072 lds
M v[128:131],a[160:163],a[96:99],v[128:131]
R a[168:171],v5,18432
R a[172:175],v6,18432
M v[128:131],a[164:167],a[100:103],v[128:131]
SA s29,s29,128
T a[72:73],v2,49152
T a[74:75],v2,50176
M v[132:135],a[164:167],a[108:111],v[132:135]
SA s30,s30,128
v_xor_b32 v17, 32, v16
v_xor_b32 v18, 64, v16
M v[132:135],a[160:163],a[104:107],v[132:135]
SA m0,s23,65536
M v[136:139],a[160:163],a[112:115],v[136:139]
buffer_load_dwordx4 v22, s[56:59], s29 offen offset:0 lds
M v[136:139],a[164:167],a[116:119],v[136:139]
v_xor_b32 v19, 0x60, v16
M v[140:143],a[164:167],a[124:127],v[140:143]
v_add_u32 v12, 0x20000, v16
M v[140:143],a[160:163],a[120:123],v[140:143]
s_nop 0
T a[76:77],v2,57344
T a[78:79],v2,58368
M v[144:147],a[160:163],a[128:131],v[144:147]
buffer_load_dwordx4 v23, s[56:59], s29 offen offset:1024 lds
M v[144:147],a[164:167],a[132:135],v[144:147]
v_add_u32 v13, 0x20000, v17
M v[148:151],a[164:167],a[140:143],v[148:151]
M v[148:151],a[160:163],a[136:139],v[148:151]
v_add_u32 v14, 0x20000, v18
M v[152:155],a[160:163],a[144:147],v[152:155]
M v[152:155],a[164:167],a[148:151],v[152:155]
s_waitcnt lgkmcnt(4)
buffer_load_dwordx4 v22, s[56:59], s30 offen offset:2048 lds
M v[156:159],a[164:167],a[156:159],v[156:159]
s_nop 0
T a[80:81],v3,49152
T a[82:83],v3,50176
M v[156:159],a[160:163],a[152:155],v[156:159]
v_add_u32 v15, 0x20000, v19
M v[188:191],a[168:171],a[152:155],v[188:191]
R a[160:163],v5,20480
R a[164:167],v6,20480
M v[188:191],a[172:175],a[156:159],v[188:191]
M v[184:187],a[172:175],a[148:151],v[184:187]
buffer_load_dwordx4 v23, s[56:59], s30 offen offset:3072 lds
M v[184:187],a[168:171],a[144:147],v[184:187]
SA s29,s29,128
M v[180:183],a[168:171],a[136:139],v[180:183]
SA s30,s30,128
M v[180:183],a[172:175],a[140:143],v[180:183]
s_mov_b32 s25, 1048576
T a[84:85],v3,57344
T a[86:87],v3,58368
M v[176:179],a[172:175],a[132:135],v[176:179]
SA m0,s4,16384
M v[176:179],a[168:171],a[128:131],v[176:179]
buffer_load_dwordx4 v8, s[52:55], s25 offen lds
M v[172:175],a[168:171],a[120:123],v[172:175]
M v[172:175],a[172:175],a[124:127],v[172:175]
s_mov_b32 s25, 1310720
M v[168:171],a[172:175],a[116:119],v[168:171]
SA m0,s4,20480
M v[168:171],a[168:171],a[112:115],v[168:171]
buffer_load_dwordx4 v8, s[52:55], s25 offen lds
M v[164:167],a[168:171],a[104:107],v[164:167]
s_nop 0
T a[88:89],v4,49152
T a[90:91],v4,50176
M v[164:167],a[172:175],a[108:111],v[164:167]
s_waitcnt lgkmcnt(4)
M v[160:163],a[172:175],a[100:103],v[160:163]
s_mov_b32 s25, 1572864
M v[160:163],a[168:171],a[96:99],v[160:163]
SA m0,s4,24576
M v[192:195],a[160:163],a[96:99],v[192:195]
R a[168:171],v5,22528
R a[172:175],v6,22528
M v[192:195],a[164:167],a[100:103],v[192:195]
buffer_load_dwordx4 v8, s[52:55], s25 offen lds
M v[196:199],a[164:167],a[108:111],v[196:199]
M v[196:199],a[160:163],a[104:107],v[196:199]
s_mov_b32 s25, 1835008
T a[92:93],v4,57344
T a[94:95],v4,58368
M v[200:203],a[160:163],a[112:115],v[200:203]
SA m0,s4,28672
M v[200:203],a[164:167],a[116:119],v[200:203]
s_waitcnt vmcnt(19)
buffer_load_dwordx4 v8, s[52:55], s25 offen lds
M v[204:207],a[164:167],a[124:127],v[204:207]
R a[224:227],v20,16384
R a[228:231],v20,18432
M v[204:207],a[160:163],a[120:123],v[204:207]
R a[232:235],v21,16384
R a[236:239],v21,18432
M v[208:211],a[160:163],a[128:131],v[208:211]
v_subrev_u32 v20, 98304, v20
v_subrev_u32 v21, 98304, v21
M v[208:211],a[164:167],a[132:135],v[208:211]
M v[212:215],a[164:167],a[140:143],v[212:215]
M v[212:215],a[160:163],a[136:139],v[212:215]
M v[216:219],a[160:163],a[144:147],v[216:219]
M v[216:219],a[164:167],a[148:151],v[216:219]
s_waitcnt lgkmcnt(6)
M v[220:223],a[164:167],a[156:159],v[220:223]
s_waitcnt lgkmcnt(0)
M v[220:223],a[160:163],a[152:155],v[220:223]
s_barrier
M v[252:255],a[168:171],a[152:155],v[252:255]
R a[160:163],v5,32768
R a[164:167],v6,32768
M v[252:255],a[172:175],a[156:159],v[252:255]
M v[248:251],a[172:175],a[148:151],v[248:251]
M v[248:251],a[168:171],a[144:147],v[248:251]
M v[244:247],a[168:171],a[136:139],v[244:247]
M v[244:247],a[172:175],a[140:143],v[244:247]
M v[240:243],a[172:175],a[132:135],v[240:243]
M v[240:243],a[168:171],a[128:131],v[240:243]
M v[236:239],a[168:171],a[120:123],v[236:239]
M v[236:239],a[172:175],a[124:127],v[236:239]
M v[232:235],a[172:175],a[116:119],v[232:235]
M v[232:235],a[168:171],a[112:115],v[232:235]
M v[228:231],a[168:171],a[104:107],v[228:231]
M v[228:231],a[172:175],a[108:111],v[228:231]
s_waitcnt lgkmcnt(0)
M v[224:227],a[172:175],a[100:103],v[224:227]
M v[224:227],a[168:171],a[96:99],v[224:227]
M a[0:3],a[160:163],a[32:35],a[0:3]
R a[168:171],v5,34816
R a[172:175],v6,34816
M a[0:3],a[164:167],a[36:39],a[0:3]
SA m0,s23,81920
M a[4:7],a[164:167],a[44:47],a[4:7]
buffer_load_dwordx4 v22, s[56:59], s29 offen offset:0 lds
M a[4:7],a[160:163],a[40:43],a[4:7]
M a[8:11],a[160:163],a[48:51],a[8:11]
M a[8:11],a[164:167],a[52:55],a[8:11]
buffer_load_dwordx4 v23, s[56:59], s29 offen offset:1024 lds
M a[12:15],a[164:167],a[60:63],a[12:15]
M a[12:15],a[160:163],a[56:59],a[12:15]
M a[16:19],a[160:163],a[64:67],a[16:19]
M a[16:19],a[164:167],a[68:71],a[16:19]
buffer_load_dwordx4 v22, s[56:59], s30 offen offset:2048 lds
M a[20:23],a[164:167],a[76:79],a[20:23]
M a[20:23],a[160:163],a[72:75],a[20:23]
M a[24:27],a[160:163],a[80:83],a[24:27]
M a[24:27],a[164:167],a[84:87],a[24:27]
s_waitcnt lgkmcnt(0)
buffer_load_dwordx4 v23, s[56:59], s30 offen offset:3072 lds
M a[28:31],a[164:167],a[92:95],a[28:31]
SA s29,s29,128
M a[28:31],a[160:163],a[88:91],a[28:31]
SA s30,s30,128
M v[32:35],a[168:171],a[32:35],v[32:35]
s_mov_b32 s25, 2097152
R a[160:163],v5,36864
R a[164:167],v6,36864
M v[32:35],a[172:175],a[36:39],v[32:35]
SA m0,s4,131072
M v[36:39],a[172:175],a[44:47],v[36:39]
buffer_load_dwordx4 v8, s[52:55], s25 offen lds
M v[36:39],a[168:171],a[40:43],v[36:39]
s_mov_b32 s25, 2359296
M v[40:43],a[168:171],a[48:51],v[40:43]
SA m0,s4,135168
M v[40:43],a[172:175],a[52:55],v[40:43]
buffer_load_dwordx4 v8, s[52:55], s25 offen lds
M v[44:47],a[172:175],a[60:63],v[44:47]
G v24,a0
G v25,a1
M v[44:47],a[168:171],a[56:59],v[44:47]
s_mov_b32 s25, 2621440
G v26,a2
G v27,a3
M v[48:51],a[168:171],a[64:67],v[48:51]
SA m0,s4,139264
C v24,v24,v25
C v25,v26,v27
M v[48:51],a[172:175],a[68:71],v[48:51]
buffer_load_dwordx4 v8, s[52:55], s25 offen lds
M v[52:55],a[172:175],a[76:79],v[52:55]
C v26,v32,v33
C v27,v34,v35
M v[52:55],a[168:171],a[72:75],v[52:55]
SA s3,s93,0
M v[56:59],a[168:171],a[80:83],v[56:59]
s_mov_b32 s25, 2883584
buffer_store_dwordx4 v[24:27], v7, s[8:11], s3 offen offset:0 sc1
M v[56:59],a[172:175],a[84:87],v[56:59]
s_waitcnt lgkmcnt(0)
G v28,a4
G v29,a5
M v[60:63],a[172:175],a[92:95],v[60:63]
SA m0,s4,143360
G v30,a6
G v31,a7
M v[60:63],a[168:171],a[88:91],v[60:63]
s_waitcnt vmcnt(16)
buffer_load_dwordx4 v8, s[52:55], s25 offen lds
M v[64:67],a[160:163],a[32:35],v[64:67]
L_w_kv17:
s_cbranch_execz L_wd2
s_mov_b32 s25, 3145728
R a[168:171],v5,38912
R a[172:175],v6,38912
M v[64:67],a[164:167],a[36:39],v[64:67]
SA m0,s4,147456
C v28,v28,v29
C v29,v30,v31
M v[68:71],a[164:167],a[44:47],v[68:71]
buffer_load_dwordx4 v8, s[52:55], s25 offen lds
M v[68:71],a[160:163],a[40:43],v[68:71]
s_mov_b32 s25, 3407872
C v30,v36,v37
C v31,v38,v39
M v[72:75],a[160:163],a[48:51],v[72:75]
SA m0,s4,151552
buffer_store_dwordx4 v[28:31], v7, s[8:11], s3 offen offset:2048 sc1
M v[72:75],a[164:167],a[52:55],v[72:75]
G v24,a8
G v25,a9
M v[76:79],a[164:167],a[60:63],v[76:79]
G v26,a10
G v27,a11
M v[76:79],a[160:163],a[56:59],v[76:79]
buffer_load_dwordx4 v8, s[52:55], s25 offen lds
M v[80:83],a[160:163],a[64:67],v[80:83]
C v24,v24,v25
C v25,v26,v27
M v[80:83],a[164:167],a[68:71],v[80:83]
C v26,v40,v41
C v27,v42,v43
M v[84:87],a[164:167],a[76:79],v[84:87]
SA s3,s93,4096
buffer_store_dwordx4 v[24:27], v7, s[8:11], s3 offen offset:0 sc1
M v[84:87],a[160:163],a[72:75],v[84:87]
R a[96:99],v20,0
R a[100:103],v20,2048
M v[88:91],a[160:163],a[80:83],v[88:91]
R a[104:107],v21,0
R a[108:111],v21,2048
M v[88:91],a[164:167],a[84:87],v[88:91]
s_waitcnt lgkmcnt(4)
G v28,a12
G v29,a13
M v[92:95],a[164:167],a[92:95],v[92:95]
s_waitcnt lgkmcnt(0)
G v30,a14
G v31,a15
M v[92:95],a[160:163],a[88:91],v[92:95]
s_barrier
M v[96:99],a[168:171],a[32:35],v[96:99]
R a[160:163],v5,49152
R a[164:167],v6,49152
M v[96:99],a[172:175],a[36:39],v[96:99]
s_mov_b32 s25, 128
C v28,v28,v29
C v29,v30,v31
M v[100:103],a[172:175],a[44:47],v[100:103]
SA m0,s4,49152
C v30,v44,v45
C v31,v46,v47
M v[100:103],a[168:171],a[40:43],v[100:103]
s_waitcnt vmcnt(17)
buffer_store_dwordx4 v[28:31], v7, s[8:11], s3 offen offset:2048 sc1
M v[104:107],a[168:171],a[48:51],v[104:107]
G v24,a16
G v25,a17
M v[104:107],a[172:175],a[52:55],v[104:107]
G v26,a18
G v27,a19
M v[108:111],a[172:175],a[60:63],v[108:111]
buffer_load_dwordx4 v8, s[52:55], s25 offen lds
M v[108:111],a[168:171],a[56:59],v[108:111]
C v24,v24,v25
C v25,v26,v27
M v[112:115],a[168:171],a[64:67],v[112:115]
C v26,v48,v49
C v27,v50,v51
M v[112:115],a[172:175],a[68:71],v[112:115]
SA s3,s93,8192
buffer_store_dwordx4 v[24:27], v7, s[8:11], s3 offen offset:0 sc1
M v[116:119],a[172:175],a[76:79],v[116:119]
s_mov_b32 s25, 262272
R a[112:115],v20,32768
R a[116:119],v20,34816
M v[116:119],a[168:171],a[72:75],v[116:119]
SA m0,s4,53248
R a[120:123],v21,32768
R a[124:127],v21,34816
M v[120:123],a[168:171],a[80:83],v[120:123]
C v64,v64,v65
C v65,v66,v67
M v[120:123],a[172:175],a[84:87],v[120:123]
s_waitcnt lgkmcnt(4)
buffer_load_dwordx4 v8, s[52:55], s25 offen lds
M v[124:127],a[172:175],a[92:95],v[124:127]
C v66,v96,v97
C v67,v98,v99
M v[124:127],a[168:171],a[88:91],v[124:127]
G v28,a20
G v29,a21
M v[128:131],a[160:163],a[32:35],v[128:131]
R a[168:171],v5,51200
R a[172:175],v6,51200
M v[128:131],a[164:167],a[36:39],v[128:131]
G v30,a22
G v31,a23
M v[132:135],a[164:167],a[44:47],v[132:135]
C v28,v28,v29
C v29,v30,v31
M v[132:135],a[160:163],a[40:43],v[132:135]
s_mov_b32 s25, 524416
C v30,v52,v53
C v31,v54,v55
M v[136:139],a[160:163],a[48:51],v[136:139]
SA m0,s4,57344
buffer_store_dwordx4 v[28:31], v7, s[8:11], s3 offen offset:2048 sc1
M v[136:139],a[164:167],a[52:55],v[136:139]
C v68,v68,v69
C v69,v70,v71
M v[140:143],a[164:167],a[60:63],v[140:143]
C v70,v100,v101
C v71,v102,v103
M v[140:143],a[160:163],a[56:59],v[140:143]
C v72,v72,v73
C v73,v74,v75
M v[144:147],a[160:163],a[64:67],v[144:147]
buffer_load_dwordx4 v8, s[52:55], s25 offen lds
M v[144:147],a[164:167],a[68:71],v[144:147]
C v74,v104,v105
C v75,v106,v107
M v[148:151],a[164:167],a[76:79],v[148:151]
C v76,v76,v77
C v77,v78,v79
M v[148:151],a[160:163],a[72:75],v[148:151]
C v78,v108,v109
C v79,v110,v111
M v[152:155],a[160:163],a[80:83],v[152:155]
C v80,v80,v81
C v81,v82,v83
M v[152:155],a[164:167],a[84:87],v[152:155]
s_waitcnt lgkmcnt(0)
C v82,v112,v113
C v83,v114,v115
M v[156:159],a[164:167],a[92:95],v[156:159]
s_mov_b32 s25, 786560
C v84,v84,v85
C v85,v86,v87
M v[156:159],a[160:163],a[88:91],v[156:159]
SA m0,s4,61440
C v86,v116,v117
C v87,v118,v119
M v[160:163],a[168:171],a[32:35],v[160:163]
R a[160:163],v5,53248
R a[164:167],v6,53248
M v[160:163],a[172:175],a[36:39],v[160:163]
buffer_load_dwordx4 v8, s[52:55], s25 offen lds
M v[164:167],a[172:175],a[44:47],v[164:167]
G v24,a24
G v25,a25
M v[164:167],a[168:171],a[40:43],v[164:167]
G v26,a26
G v27,a27
M v[168:171],a[168:171],a[48:51],v[168:171]
C v24,v24,v25
C v25,v26,v27
M v[168:171],a[172:175],a[52:55],v[168:171]
C v26,v56,v57
C v27,v58,v59
M v[172:175],a[172:175],a[60:63],v[172:175]
SA s3,s93,12288
buffer_store_dwordx4 v[24:27], v7, s[8:11], s3 offen offset:0 sc1
M v[172:175],a[168:171],a[56:59],v[172:175]
C v88,v88,v89
C v89,v90,v91
M v[176:179],a[168:171],a[64:67],v[176:179]
C v90,v120,v121
C v91,v122,v123
M v[176:179],a[172:175],a[68:71],v[176:179]
C v92,v92,v93
C v93,v94,v95
M v[180:183],a[172:175],a[76:79],v[180:183]
C v94,v124,v125
C v95,v126,v127
M v[180:183],a[168:171],a[72:75],v[180:183]
G v28,a28
G v29,a29
M v[184:187],a[168:171],a[80:83],v[184:187]
G v30,a30
G v31,a31
M v[184:187],a[172:175],a[84:87],v[184:187]
s_waitcnt lgkmcnt(0)
C v28,v28,v29
C v29,v30,v31
M v[188:191],a[172:175],a[92:95],v[188:191]
C v30,v60,v61
C v31,v62,v63
M v[188:191],a[168:171],a[88:91],v[188:191]
buffer_store_dwordx4 v[28:31], v7, s[8:11], s3 offen offset:2048 sc1
M v[192:195],a[160:163],a[32:35],v[192:195]
s_waitcnt vmcnt(18)
R a[168:171],v5,55296
R a[172:175],v6,55296
M v[192:195],a[164:167],a[36:39],v[192:195]
C v128,v128,v129
C v129,v130,v131
M v[196:199],a[164:167],a[44:47],v[196:199]
C v130,v160,v161
C v131,v162,v163
M v[196:199],a[160:163],a[40:43],v[196:199]
C v132,v132,v133
C v133,v134,v135
M v[200:203],a[160:163],a[48:51],v[200:203]
C v134,v164,v165
C v135,v166,v167
M v[200:203],a[164:167],a[52:55],v[200:203]
C v136,v136,v137
C v137,v138,v139
M v[204:207],a[164:167],a[60:63],v[204:207]
C v138,v168,v169
C v139,v170,v171
M v[204:207],a[160:163],a[56:59],v[204:207]
C v140,v140,v141
C v141,v142,v143
M v[208:211],a[160:163],a[64:67],v[208:211]
C v142,v172,v173
C v143,v174,v175
M v[208:211],a[164:167],a[68:71],v[208:211]
C v144,v144,v145
C v145,v146,v147
M v[212:215],a[164:167],a[76:79],v[212:215]
R a[128:131],v20,49152
R a[132:135],v20,51200
R a[136:139],v21,49152
R a[140:143],v21,51200
M v[212:215],a[160:163],a[72:75],v[212:215]
C v146,v176,v177
C v147,v178,v179
M v[216:219],a[160:163],a[80:83],v[216:219]
C v148,v148,v149
C v149,v150,v151
M v[216:219],a[164:167],a[84:87],v[216:219]
s_waitcnt lgkmcnt(4)
C v150,v180,v181
C v151,v182,v183
M v[220:223],a[164:167],a[92:95],v[220:223]
s_waitcnt vmcnt(10) lgkmcnt(0)
C v152,v152,v153
C v153,v154,v155
M v[220:223],a[160:163],a[88:91],v[220:223]
s_barrier
M v[224:227],a[168:171],a[32:35],v[224:227]
s_nop 0
T v[32:33],v16,0
T v[34:35],v16,2048
M v[224:227],a[172:175],a[36:39],v[224:227]
C v154,v184,v185
C v155,v186,v187
M v[228:231],a[172:175],a[44:47],v[228:231]
T v[36:37],v16,4096
T v[38:39],v16,6144
M v[228:231],a[168:171],a[40:43],v[228:231]
T v[40:41],v16,8192
T v[42:43],v16,10240
M v[232:235],a[168:171],a[48:51],v[232:235]
C v156,v156,v157
C v157,v158,v159
M v[232:235],a[172:175],a[52:55],v[232:235]
T v[44:45],v16,12288
T v[46:47],v16,14336
M v[236:239],a[172:175],a[60:63],v[236:239]
T v[48:49],v16,16384
T v[50:51],v16,18432
M v[236:239],a[168:171],a[56:59],v[236:239]
C v158,v188,v189
C v159,v190,v191
M v[240:243],a[168:171],a[64:67],v[240:243]
T v[52:53],v16,20480
T v[54:55],v16,22528
M v[240:243],a[172:175],a[68:71],v[240:243]
T v[56:57],v16,24576
T v[58:59],v16,26624
M v[244:247],a[172:175],a[76:79],v[244:247]
C v192,v192,v193
C v193,v194,v195
M v[244:247],a[168:171],a[72:75],v[244:247]
C v194,v224,v225
C v195,v226,v227
M v[248:251],a[168:171],a[80:83],v[248:251]
C v196,v196,v197
C v197,v198,v199
M v[248:251],a[172:175],a[84:87],v[248:251]
C v198,v228,v229
C v199,v230,v231
M v[252:255],a[172:175],a[92:95],v[252:255]
C v200,v200,v201
C v201,v202,v203
M v[252:255],a[168:171],a[88:91],v[252:255]
s_waitcnt lgkmcnt(6)
C v202,v232,v233
C v203,v234,v235
M v[96:99],v[32:35],a[176:179],0
s_mul_i32 s72, s41, 4352
T a[144:145],v17,0
T a[146:147],v17,2048
M v[96:99],v[36:39],a[184:187],v[96:99]
s_mov_b32 s25, 1048704
C v204,v204,v205
C v205,v206,v207
M v[96:99],v[40:43],a[192:195],v[96:99]
s_waitcnt lgkmcnt(2)
T a[148:149],v17,4096
T a[150:151],v17,6144
M v[96:99],v[44:47],a[200:203],v[96:99]
SA m0,s4,98304
T a[152:153],v17,8192
T a[154:155],v17,10240
M v[96:99],v[48:51],a[208:211],v[96:99]
SA s46,s72,104923136
buffer_load_dwordx4 v8, s[52:55], s25 offen lds
M v[96:99],v[52:55],a[216:219],v[96:99]
s_lshl_b32 s45, s42, 7
T a[156:157],v17,12288
T a[158:159],v17,14336
M v[96:99],v[56:59],a[224:227],v[96:99]
s_mov_b32 s25, 1310848
T a[160:161],v17,16384
T a[162:163],v17,18432
M v[100:103],v[56:59],a[228:231],0
SA m0,s4,102400
C v206,v236,v237
C v207,v238,v239
M v[100:103],v[52:55],a[220:223],v[100:103]
SA s45,s45,s46
T a[164:165],v17,20480
T a[166:167],v17,22528
M v[100:103],v[48:51],a[212:215],v[100:103]
s_lshl_b32 s72, s20, 2
T a[168:169],v17,24576
T a[170:171],v17,26624
M v[100:103],v[44:47],a[204:207],v[100:103]
SA s72,s72,s45
buffer_load_dwordx4 v8, s[52:55], s25 offen lds
M v[100:103],v[40:43],a[196:199],v[100:103]
C v208,v208,v209
C v209,v210,v211
M v[100:103],v[36:39],a[188:191],v[100:103]
s_mov_b32 s25, 1572992
C v210,v240,v241
C v211,v242,v243
M v[100:103],v[32:35],a[180:183],v[100:103]
s_waitcnt lgkmcnt(6)
C v212,v212,v213
C v213,v214,v215
M v[104:107],a[144:147],a[176:179],0
SA m0,s4,106496
T v[32:33],v18,0
T v[34:35],v18,2048
M v[104:107],a[148:151],a[184:187],v[104:107]
buffer_load_dwordx4 v8, s[52:55], s25 offen lds
M v[104:107],a[152:155],a[192:195],v[104:107]
s_waitcnt lgkmcnt(2)
s_nop 0
T v[36:37],v18,4096
T v[38:39],v18,6144
M v[104:107],a[156:159],a[200:203],v[104:107]
s_mov_b32 s25, 1835136
T v[40:41],v18,8192
T v[42:43],v18,10240
M v[104:107],a[160:163],a[208:211],v[104:107]
SA m0,s4,110592
C v214,v244,v245
C v215,v246,v247
M v[104:107],a[164:167],a[216:219],v[104:107]
T v[44:45],v18,12288
T v[46:47],v18,14336
M v[104:107],a[168:171],a[224:227],v[104:107]
T v[48:49],v18,16384
T v[50:51],v18,18432
M v[108:111],a[168:171],a[228:231],0
buffer_load_dwordx4 v8, s[52:55], s25 offen lds
M v[108:111],a[164:167],a[220:223],v[108:111]
s_nop 0
T v[52:53],v18,20480
T v[54:55],v18,22528
M v[108:111],a[160:163],a[212:215],v[108:111]
s_mov_b32 s25, 2097280
T v[56:57],v18,24576
T v[58:59],v18,26624
M v[108:111],a[156:159],a[204:207],v[108:111]
SA m0,s4,114688
C v216,v216,v217
C v217,v218,v219
M v[108:111],a[152:155],a[196:199],v[108:111]
SA s3,s93,524288
buffer_load_dwordx4 v8, s[52:55], s25 offen lds
M v[108:111],a[148:151],a[188:191],v[108:111]
C v218,v248,v249
C v219,v250,v251
M v[108:111],a[144:147],a[180:183],v[108:111]
s_waitcnt lgkmcnt(6)
buffer_store_dwordx4 v[64:67], v7, s[8:11], s3 offen offset:0 sc1
M v[112:115],v[32:35],a[176:179],0
s_mov_b32 s25, 2359424
T a[144:145],v19,0
T a[146:147],v19,2048
M v[112:115],v[36:39],a[184:187],v[112:115]
SA m0,s4,118784
buffer_store_dwordx4 v[68:71], v7, s[8:11], s3 offen offset:2048 sc1
M v[112:115],v[40:43],a[192:195],v[112:115]
s_waitcnt lgkmcnt(2)
s_nop 0
T a[148:149],v19,4096
T a[150:151],v19,6144
M v[112:115],v[44:47],a[200:203],v[112:115]
T a[152:153],v19,8192
T a[154:155],v19,10240
M v[112:115],v[48:51],a[208:211],v[112:115]
buffer_load_dwordx4 v8, s[52:55], s25 offen lds
M v[112:115],v[52:55],a[216:219],v[112:115]
s_nop 0
T a[156:157],v19,12288
T a[158:159],v19,14336
M v[112:115],v[56:59],a[224:227],v[112:115]
s_mov_b32 s25, 2621568
T a[160:161],v19,16384
T a[162:163],v19,18432
M v[116:119],v[56:59],a[228:231],0
SA m0,s4,122880
C v220,v220,v221
C v221,v222,v223
M v[116:119],v[52:55],a[220:223],v[116:119]
T a[164:165],v19,20480
T a[166:167],v19,22528
M v[116:119],v[48:51],a[212:215],v[116:119]
T a[168:169],v19,24576
T a[170:171],v19,26624
M v[116:119],v[44:47],a[204:207],v[116:119]
buffer_load_dwordx4 v8, s[52:55], s25 offen lds
M v[116:119],v[40:43],a[196:199],v[116:119]
C v222,v252,v253
C v223,v254,v255
M v[116:119],v[36:39],a[188:191],v[116:119]
s_mov_b32 s25, 2883712
v_min_u32 v29, 1, v0
v_lshlrev_b32 v29, 29, v29
M v[116:119],v[32:35],a[180:183],v[116:119]
s_waitcnt lgkmcnt(6)
v_mov_b32 v30, 1
v_add_u32 v20, 0x10000, v16
M v[120:123],a[144:147],a[176:179],0
SA m0,s4,126976
T v[32:33],v16,28672
T v[34:35],v16,30720
M v[120:123],a[148:151],a[184:187],v[120:123]
buffer_load_dwordx4 v8, s[52:55], s25 offen lds
M v[120:123],a[152:155],a[192:195],v[120:123]
s_waitcnt lgkmcnt(2)
s_nop 0
T v[36:37],v12,0
T v[38:39],v12,2048
M v[120:123],a[156:159],a[200:203],v[120:123]
s_mov_b32 s25, 3145856
T v[40:41],v12,4096
T v[42:43],v12,6144
M v[120:123],a[160:163],a[208:211],v[120:123]
SA m0,s4,32768
v_add_u32 v21, 0x10000, v17
v_add_u32 v22, 0x10000, v18
M v[120:123],a[164:167],a[216:219],v[120:123]
T v[44:45],v12,8192
T v[46:47],v12,10240
M v[120:123],a[168:171],a[224:227],v[120:123]
T v[48:49],v12,12288
T v[50:51],v12,14336
M v[124:127],a[168:171],a[228:231],0
buffer_load_dwordx4 v8, s[52:55], s25 offen lds
M v[124:127],a[164:167],a[220:223],v[124:127]
s_nop 0
T v[52:53],v12,16384
T v[54:55],v12,18432
M v[124:127],a[160:163],a[212:215],v[124:127]
s_mov_b32 s25, 3408000
T v[56:57],v12,20480
T v[58:59],v12,22528
M v[124:127],a[156:159],a[204:207],v[124:127]
SA m0,s4,36864
v_add_u32 v23, 0x10000, v19
v_or_b32 v1, s20, v0
M v[124:127],a[152:155],a[196:199],v[124:127]
SA s3,s93,528384
buffer_load_dwordx4 v8, s[52:55], s25 offen lds
M v[124:127],a[148:151],a[188:191],v[124:127]
v_min_u32 v1, 1, v1
v_lshlrev_b32 v1, 29, v1
M v[124:127],a[144:147],a[180:183],v[124:127]
s_waitcnt lgkmcnt(6)
buffer_store_dwordx4 v[72:75], v7, s[8:11], s3 offen offset:0 sc1
M v[96:99],v[32:35],a[232:235],v[96:99]
s_mov_b32 s25, 256
T a[144:145],v17,28672
T a[146:147],v17,30720
M v[96:99],v[36:39],a[96:99],v[96:99]
SA m0,s4,65536
v_min_u32 v9, 15, v0
v_lshlrev_b32 v9, 7, v9
M v[96:99],v[40:43],a[104:107],v[96:99]
s_waitcnt lgkmcnt(2)
T a[148:149],v13,0
T a[150:151],v13,2048
M v[96:99],v[44:47],a[112:115],v[96:99]
s_sub_u32 s66, 15, s42
T a[152:153],v13,4096
T a[154:155],v13,6144
M v[96:99],v[48:51],a[120:123],v[96:99]
s_max_u32 s67, s66, s42
buffer_load_dwordx4 v8, s[52:55], s25 offen lds
M v[96:99],v[52:55],a[128:131],v[96:99]
s_min_u32 s66, s66, s42
T a[156:157],v13,8192
T a[158:159],v13,10240
M v[96:99],v[56:59],a[136:139],v[96:99]
s_mov_b32 s25, 262400
T a[160:161],v13,12288
T a[162:163],v13,14336
M v[100:103],v[56:59],a[140:143],v[100:103]
SA m0,s4,69632
M v[100:103],v[52:55],a[132:135],v[100:103]
s_mul_i32 s21, s41, 1048576
T a[164:165],v13,16384
T a[166:167],v13,18432
M v[100:103],v[48:51],a[124:127],v[100:103]
s_lshl_b32 s64, s67, 16
T a[168:169],v13,20480
T a[170:171],v13,22528
L_w_kv18:
s_cbranch_execz L_wd2
M v[100:103],v[44:47],a[116:119],v[100:103]
SA s32,s21,s64
buffer_load_dwordx4 v8, s[52:55], s25 offen lds
M v[100:103],v[40:43],a[108:111],v[100:103]
s_lshl_b32 s64, s20, 14
M v[100:103],v[36:39],a[100:103],v[100:103]
s_mov_b32 s25, 524544
M v[100:103],v[32:35],a[236:239],v[100:103]
s_waitcnt lgkmcnt(6)
M v[104:107],a[144:147],a[232:235],v[104:107]
SA m0,s4,73728
T v[32:33],v18,28672
T v[34:35],v18,30720
M v[104:107],a[148:151],a[96:99],v[104:107]
SA s32,s32,s64
buffer_load_dwordx4 v8, s[52:55], s25 offen lds
M v[104:107],a[152:155],a[104:107],v[104:107]
s_waitcnt lgkmcnt(2)
s_nop 0
T v[36:37],v14,0
T v[38:39],v14,2048
M v[104:107],a[156:159],a[112:115],v[104:107]
s_mov_b32 s25, 786688
T v[40:41],v14,4096
T v[42:43],v14,6144
M v[104:107],a[160:163],a[120:123],v[104:107]
SA m0,s4,77824
M v[104:107],a[164:167],a[128:131],v[104:107]
SA s32,s32,33554432
T v[44:45],v14,8192
T v[46:47],v14,10240
M v[104:107],a[168:171],a[136:139],v[104:107]
s_sub_u32 s64, s42, 10
T v[48:49],v14,12288
T v[50:51],v14,14336
M v[108:111],a[168:171],a[140:143],v[108:111]
s_and_b32 s35, s64, 536870912
buffer_load_dwordx4 v8, s[52:55], s25 offen lds
M v[108:111],a[164:167],a[132:135],v[108:111]
s_nop 0
T v[52:53],v14,16384
T v[54:55],v14,18432
M v[108:111],a[160:163],a[124:127],v[108:111]
s_mov_b32 s25, 1048832
T v[56:57],v14,20480
T v[58:59],v14,22528
M v[108:111],a[156:159],a[116:119],v[108:111]
SA m0,s4,81920
v_or_b32 v6, s35, v7
MF v96,s5,v96
M v[108:111],a[152:155],a[108:111],v[108:111]
s_lshl_b32 s28, s20, 13
buffer_load_dwordx4 v8, s[52:55], s25 offen lds
M v[108:111],a[148:151],a[100:103],v[108:111]
v_add_u32 v2, 0x10000, v7
v_add_u32 v3, s28, v7
M v[108:111],a[144:147],a[236:239],v[108:111]
s_waitcnt lgkmcnt(6)
v_add_u32 v4, 0x1000, v3
MF v97,s5,v97
M v[112:115],v[32:35],a[232:235],v[112:115]
s_mov_b32 s25, 1310976
T a[144:145],v19,28672
T a[146:147],v19,30720
M v[112:115],v[36:39],a[96:99],v[112:115]
SA m0,s4,86016
MF v98,s5,v98
MF v99,s5,v99
M v[112:115],v[40:43],a[104:107],v[112:115]
s_waitcnt lgkmcnt(2)
T a[148:149],v15,0
T a[150:151],v15,2048
M v[112:115],v[44:47],a[112:115],v[112:115]
s_lshl_b32 s64, s42, 16
T a[152:153],v15,4096
T a[154:155],v15,6144
M v[112:115],v[48:51],a[120:123],v[112:115]
SA s23,s21,s64
buffer_load_dwordx4 v8, s[52:55], s25 offen lds
M v[112:115],v[52:55],a[128:131],v[112:115]
SA s43,s23,16777216
T a[156:157],v15,8192
T a[158:159],v15,10240
M v[112:115],v[56:59],a[136:139],v[112:115]
s_mov_b32 s25, 1573120
T a[160:161],v15,12288
T a[162:163],v15,14336
M v[116:119],v[56:59],a[140:143],v[116:119]
SA m0,s4,90112
MF v104,s5,v104
MF v105,s5,v105
M v[116:119],v[52:55],a[132:135],v[116:119]
SA s26,s21,16777216
T a[164:165],v15,16384
T a[166:167],v15,18432
M v[116:119],v[48:51],a[124:127],v[116:119]
s_min_u32 s27, s42, 9
T a[168:169],v15,20480
T a[170:171],v15,22528
M v[116:119],v[44:47],a[116:119],v[116:119]
s_lshl_b32 s22, s27, 1
buffer_load_dwordx4 v8, s[52:55], s25 offen lds
M v[116:119],v[40:43],a[108:111],v[116:119]
s_sub_u32 s22, s22, 1
MF v106,s5,v106
MF v107,s5,v107
M v[116:119],v[36:39],a[100:103],v[116:119]
s_waitcnt vmcnt(8) lgkmcnt(0)
C v96,v96,v97
C v97,v98,v99
M v[116:119],v[32:35],a[236:239],v[116:119]
s_barrier
M v[120:123],a[144:147],a[232:235],v[120:123]
s_mov_b32 s25, 1835264
T v[32:33],v16,49152
T v[34:35],v16,51200
M v[120:123],a[148:151],a[96:99],v[120:123]
SA m0,s4,94208
C v98,v104,v105
C v99,v106,v107
M v[120:123],a[152:155],a[104:107],v[120:123]
s_sub_u32 s27, s27, 2
T v[36:37],v16,53248
T v[38:39],v16,55296
M v[120:123],a[156:159],a[112:115],v[120:123]
s_mov_b32 s31, 0x4b800000
T v[40:41],v16,57344
T v[42:43],v16,59392
M v[120:123],a[160:163],a[120:123],v[120:123]
s_mov_b32 s24, 0x33800000
buffer_load_dwordx4 v8, s[52:55], s25 offen lds
M v[120:123],a[164:167],a[128:131],v[120:123]
s_lshl_b32 s47, s66, 7
T v[44:45],v16,61440
T v[46:47],v16,63488
M v[120:123],a[168:171],a[136:139],v[120:123]
s_mov_b32 s25, 2097408
T v[48:49],v20,32768
T v[50:51],v20,34816
M v[124:127],a[168:171],a[140:143],v[124:127]
SA m0,s4,155648
W a0,v96
W a1,v97
M v[124:127],a[164:167],a[132:135],v[124:127]
SA s47,s47,s46
T v[52:53],v20,36864
T v[54:55],v20,38912
M v[124:127],a[160:163],a[124:127],v[124:127]
s_lshl_b32 s64, s20, 5
T v[56:57],v20,40960
T v[58:59],v20,43008
M v[124:127],a[156:159],a[116:119],v[124:127]
SA s47,s47,s64
buffer_load_dwordx4 v8, s[52:55], s25 offen lds
M v[124:127],a[152:155],a[108:111],v[124:127]
SA s47,s47,2048
W a2,v98
W a3,v99
M v[124:127],a[148:151],a[100:103],v[124:127]
s_lshl_b32 s65, s41, 3
MF v100,s5,v100
MF v101,s5,v101
M v[124:127],a[144:147],a[236:239],v[124:127]
s_waitcnt lgkmcnt(6)
MF v102,s5,v102
MF v103,s5,v103
M v[160:163],v[32:35],a[176:179],0
SA s65,s65,s66
T a[144:145],v17,49152
T a[146:147],v17,51200
M v[160:163],v[36:39],a[184:187],v[160:163]
s_mul_i32 s34, s65, 73728
MF v108,s5,v108
MF v109,s5,v109
M v[160:163],v[40:43],a[192:195],v[160:163]
s_waitcnt lgkmcnt(2)
T a[148:149],v17,53248
T a[150:151],v17,55296
M v[160:163],v[44:47],a[200:203],v[160:163]
SA s34,s34,136314880
T a[152:153],v17,57344
T a[154:155],v17,59392
M v[160:163],v[48:51],a[208:211],v[160:163]
s_lshl_b32 s65, s42, 4
MF v110,s5,v110
MF v111,s5,v111
M v[160:163],v[52:55],a[216:219],v[160:163]
SA s65,s65,s41
T a[156:157],v17,61440
T a[158:159],v17,63488
M v[160:163],v[56:59],a[224:227],v[160:163]
s_mul_i32 s33, s65, 114688
T a[160:161],v21,32768
T a[162:163],v21,34816
M v[164:167],v[56:59],a[228:231],0
s_mul_i32 s65, s20, 28672
C v100,v100,v101
C v101,v102,v103
M v[164:167],v[52:55],a[220:223],v[164:167]
SA s33,s33,s65
T a[164:165],v21,36864
T a[166:167],v21,38912
M v[164:167],v[48:51],a[212:215],v[164:167]
SA s33,s33,67108864
T a[168:169],v21,40960
T a[170:171],v21,43008
M v[164:167],v[44:47],a[204:207],v[164:167]
s_mov_b32 s6, 0
C v102,v108,v109
C v103,v110,v111
M v[164:167],v[40:43],a[196:199],v[164:167]
s_mov_b32 s7, 1
W a32,v100
W a33,v101
M v[164:167],v[36:39],a[188:191],v[164:167]
s_mov_b32 s40, 1
W a34,v102
W a35,v103
M v[164:167],v[32:35],a[180:183],v[164:167]
s_waitcnt lgkmcnt(6)
MF v112,s5,v112
MF v113,s5,v113
M v[168:171],a[144:147],a[176:179],0
s_cmp_eq_u32 s20, 0
T v[32:33],v18,49152
T v[34:35],v18,51200
M v[168:171],a[148:151],a[184:187],v[168:171]
s_cselect_b32 s39, 6, 4
MF v114,s5,v114
MF v115,s5,v115
M v[168:171],a[152:155],a[192:195],v[168:171]
s_waitcnt lgkmcnt(2)
T v[36:37],v18,53248
T v[38:39],v18,55296
M v[168:171],a[156:159],a[200:203],v[168:171]
s_mov_b64 s[60:61], s[76:77]
T v[40:41],v18,57344
T v[42:43],v18,59392
M v[168:171],a[160:163],a[208:211],v[168:171]
s_mov_b32 s62, s78
MF v120,s5,v120
MF v121,s5,v121
M v[168:171],a[164:167],a[216:219],v[168:171]
s_mov_b32 s63, 0x20000
T v[44:45],v18,61440
T v[46:47],v18,63488
M v[168:171],a[168:171],a[224:227],v[168:171]
SA s30,s32,0
T v[48:49],v22,32768
T v[50:51],v22,34816
M v[172:175],a[168:171],a[228:231],0
s_mov_b32 s25, 2359552
buffer_store_dwordx4 a[0:3], v6, s[8:11], s30 offen offset:0 sc1
M v[172:175],a[164:167],a[220:223],v[172:175]
SA m0,s4,159744
T v[52:53],v22,36864
T v[54:55],v22,38912
M v[172:175],a[160:163],a[212:215],v[172:175]
T v[56:57],v22,40960
T v[58:59],v22,43008
M v[172:175],a[156:159],a[204:207],v[172:175]
SA s3,s93,528384
buffer_load_dwordx4 v8, s[52:55], s25 offen lds
M v[172:175],a[152:155],a[196:199],v[172:175]
buffer_store_dword v30, v29, s[8:11], s72 offen offset:4 sc1
M v[172:175],a[148:151],a[188:191],v[172:175]
s_mov_b32 s25, 2621696
buffer_store_dwordx4 v[76:79], v7, s[8:11], s3 offen offset:2048 sc1
M v[172:175],a[144:147],a[180:183],v[172:175]
s_waitcnt lgkmcnt(6)
v_lshrrev_b32 v24, 4, v0
v_lshlrev_b32 v24, 2, v24
M v[176:179],v[32:35],a[176:179],0
SA m0,s4,131072
T a[144:145],v19,49152
T a[146:147],v19,51200
M v[176:179],v[36:39],a[184:187],v[176:179]
buffer_load_dwordx4 v8, s[52:55], s25 offen lds
M v[176:179],v[40:43],a[192:195],v[176:179]
s_waitcnt lgkmcnt(2)
s_nop 0
T a[148:149],v19,53248
T a[150:151],v19,55296
M v[176:179],v[44:47],a[200:203],v[176:179]
s_mov_b32 s25, 2883840
T a[152:153],v19,57344
T a[154:155],v19,59392
M v[176:179],v[48:51],a[208:211],v[176:179]
SA m0,s4,135168
v_and_b32 v25, 15, v0
v_sub_u32 v24, v24, v25
M v[176:179],v[52:55],a[216:219],v[176:179]
T a[156:157],v19,61440
T a[158:159],v19,63488
M v[176:179],v[56:59],a[224:227],v[176:179]
T a[160:161],v23,32768
T a[162:163],v23,34816
M v[180:183],v[56:59],a[228:231],0
buffer_load_dwordx4 v8, s[52:55], s25 offen lds
M v[180:183],v[52:55],a[220:223],v[180:183]
s_nop 0
T a[164:165],v23,36864
T a[166:167],v23,38912
M v[180:183],v[48:51],a[212:215],v[180:183]
s_mov_b32 s25, 3145984
T a[168:169],v23,40960
T a[170:171],v23,43008
M v[180:183],v[44:47],a[204:207],v[180:183]
SA m0,s4,139264
v_cmp_lt_i32 s[16:17], 0, v24
v_cmp_lt_i32 s[18:19], -1, v24
M v[180:183],v[40:43],a[196:199],v[180:183]
buffer_load_dwordx4 v8, s[52:55], s25 offen lds
M v[180:183],v[36:39],a[188:191],v[180:183]
v_cmp_lt_i32 s[48:49], -2, v24
v_cmp_lt_i32 s[50:51], -3, v24
M v[180:183],v[32:35],a[180:183],v[180:183]
s_waitcnt lgkmcnt(6)
v_lshl_add_u32 v25, v0, 7, s95
v_and_b32 v0, 48, v0
M v[184:187],a[144:147],a[176:179],0
s_mov_b32 s25, 3408128
T v[32:33],v20,45056
T v[34:35],v20,47104
M v[184:187],a[148:151],a[184:187],v[184:187]
SA m0,s4,143360
MF v122,s5,v122
MF v123,s5,v123
M v[184:187],a[152:155],a[192:195],v[184:187]
s_waitcnt lgkmcnt(2)
T v[36:37],v20,49152
T v[38:39],v20,51200
M v[184:187],a[156:159],a[200:203],v[184:187]
SA s30,s32,8192
T v[40:41],v20,53248
T v[42:43],v20,55296
M v[184:187],a[160:163],a[208:211],v[184:187]
buffer_store_dwordx4 a[32:35], v6, s[8:11], s30 offen offset:0 sc1
M v[184:187],a[164:167],a[216:219],v[184:187]
s_nop 0
T v[44:45],v20,57344
T v[46:47],v20,59392
M v[184:187],a[168:171],a[224:227],v[184:187]
T v[48:49],v20,61440
T v[50:51],v20,63488
M v[188:191],a[168:171],a[228:231],0
buffer_load_dwordx4 v8, s[52:55], s25 offen lds
M v[188:191],a[164:167],a[220:223],v[188:191]
SA s3,s93,532480
T v[52:53],v16,32768
T v[54:55],v16,34816
M v[188:191],a[160:163],a[212:215],v[188:191]
s_mov_b32 s25, 384
T v[56:57],v16,36864
T v[58:59],v16,38912
M v[188:191],a[156:159],a[204:207],v[188:191]
SA m0,s4,0
buffer_store_dwordx4 v[80:83], v7, s[8:11], s3 offen offset:0 sc1
M v[188:191],a[152:155],a[196:199],v[188:191]
C v112,v112,v113
C v113,v114,v115
M v[188:191],a[148:151],a[188:191],v[188:191]
buffer_load_dwordx4 v8, s[52:55], s25 offen lds
M v[188:191],a[144:147],a[180:183],v[188:191]
s_waitcnt lgkmcnt(6)
C v114,v120,v121
C v115,v122,v123
M v[160:163],v[32:35],a[232:235],v[160:163]
s_mov_b32 s25, 262528
T a[144:145],v21,45056
T a[146:147],v21,47104
M v[160:163],v[36:39],a[96:99],v[160:163]
SA m0,s4,4096
buffer_store_dwordx4 v[84:87], v7, s[8:11], s3 offen offset:2048 sc1
M v[160:163],v[40:43],a[104:107],v[160:163]
s_waitcnt lgkmcnt(2)
s_nop 0
T a[148:149],v21,49152
T a[150:151],v21,51200
M v[160:163],v[44:47],a[112:115],v[160:163]
T a[152:153],v21,53248
T a[154:155],v21,55296
M v[160:163],v[48:51],a[120:123],v[160:163]
buffer_load_dwordx4 v8, s[52:55], s25 offen lds
M v[160:163],v[52:55],a[128:131],v[160:163]
s_nop 0
T a[156:157],v21,57344
T a[158:159],v21,59392
M v[160:163],v[56:59],a[136:139],v[160:163]
s_mov_b32 s25, 524672
T a[160:161],v21,61440
T a[162:163],v21,63488
M v[164:167],v[56:59],a[140:143],v[164:167]
SA m0,s4,8192
W a4,v112
W a5,v113
M v[164:167],v[52:55],a[132:135],v[164:167]
T a[164:165],v17,32768
T a[166:167],v17,34816
M v[164:167],v[48:51],a[124:127],v[164:167]
T a[168:169],v17,36864
T a[170:171],v17,38912
M v[164:167],v[44:47],a[116:119],v[164:167]
buffer_load_dwordx4 v8, s[52:55], s25 offen lds
M v[164:167],v[40:43],a[108:111],v[164:167]
W a6,v114
W a7,v115
M v[164:167],v[36:39],a[100:103],v[164:167]
s_mov_b32 s25, 786816
v_lshl_add_u32 v0, v0, 24, v25
v_mov_b32 v24, 0x3f80
M v[164:167],v[32:35],a[236:239],v[164:167]
s_waitcnt lgkmcnt(6)
MF v116,s5,v116
MF v117,s5,v117
M v[168:171],a[144:147],a[232:235],v[168:171]
SA s30,s32,0
T v[32:33],v22,45056
T v[34:35],v22,47104
M v[168:171],a[148:151],a[96:99],v[168:171]
SA m0,s4,12288
buffer_store_dwordx4 a[4:7], v6, s[8:11], s30 offen offset:1024 sc1
M v[168:171],a[152:155],a[104:107],v[168:171]
s_waitcnt lgkmcnt(2)
s_nop 0
T v[36:37],v22,49152
T v[38:39],v22,51200
M v[168:171],a[156:159],a[112:115],v[168:171]
T v[40:41],v22,53248
T v[42:43],v22,55296
M v[168:171],a[160:163],a[120:123],v[168:171]
buffer_load_dwordx4 v8, s[52:55], s25 offen lds
M v[168:171],a[164:167],a[128:131],v[168:171]
s_nop 0
T v[44:45],v22,57344
T v[46:47],v22,59392
M v[168:171],a[168:171],a[136:139],v[168:171]
s_mov_b32 s25, 1048960
T v[48:49],v22,61440
T v[50:51],v22,63488
M v[172:175],a[168:171],a[140:143],v[172:175]
SA m0,s4,16384
MF v118,s5,v118
MF v119,s5,v119
M v[172:175],a[164:167],a[132:135],v[172:175]
T v[52:53],v18,32768
T v[54:55],v18,34816
M v[172:175],a[160:163],a[124:127],v[172:175]
T v[56:57],v18,36864
T v[58:59],v18,38912
M v[172:175],a[156:159],a[116:119],v[172:175]
buffer_load_dwordx4 v8, s[52:55], s25 offen lds
M v[172:175],a[152:155],a[108:111],v[172:175]
MF v124,s5,v124
MF v125,s5,v125
M v[172:175],a[148:151],a[100:103],v[172:175]
s_mov_b32 s25, 1311104
v_lshrrev_b32 v25, 8, v7
v_bfe_u32 v26, v7, 6, 2
v_and_b32 v27, 16, v7
v_lshlrev_b32 v27, v27, v24
v_cmp_eq_u32 vcc, v25, v26
v_and_b32 v28, 32, v7
W a244,0
v_cndmask_b32 v27, 0, v27, vcc
v_cmp_eq_u32 vcc, 0, v28
W a245,0
W a248,0
v_cndmask_b32 v25, 0, v27, vcc
v_sub_u32 v26, v27, v25
W a249,0
W a246,v25
W a247,v26
M v[172:175],a[144:147],a[236:239],v[172:175]
s_waitcnt lgkmcnt(6)
MF v126,s5,v126
MF v127,s5,v127
M v[176:179],v[32:35],a[232:235],v[176:179]
SA m0,s4,20480
T a[144:145],v23,45056
T a[146:147],v23,47104
M v[176:179],v[36:39],a[96:99],v[176:179]
buffer_load_dwordx4 v8, s[52:55], s25 offen lds
M v[176:179],v[40:43],a[104:107],v[176:179]
s_waitcnt lgkmcnt(2)
s_nop 0
T a[148:149],v23,49152
T a[150:151],v23,51200
M v[176:179],v[44:47],a[112:115],v[176:179]
s_mov_b32 s25, 1573248
T a[152:153],v23,53248
T a[154:155],v23,55296
M v[176:179],v[48:51],a[120:123],v[176:179]
SA m0,s4,24576
C v116,v116,v117
C v117,v118,v119
M v[176:179],v[52:55],a[128:131],v[176:179]
T a[156:157],v23,57344
T a[158:159],v23,59392
M v[176:179],v[56:59],a[136:139],v[176:179]
T a[160:161],v23,61440
T a[162:163],v23,63488
M v[180:183],v[56:59],a[140:143],v[180:183]
buffer_load_dwordx4 v8, s[52:55], s25 offen lds
M v[180:183],v[52:55],a[132:135],v[180:183]
s_nop 0
T a[164:165],v19,32768
T a[166:167],v19,34816
M v[180:183],v[48:51],a[124:127],v[180:183]
s_mov_b32 s25, 1835392
T a[168:169],v19,36864
T a[170:171],v19,38912
M v[180:183],v[44:47],a[116:119],v[180:183]
SA m0,s4,28672
C v118,v124,v125
C v119,v126,v127
M v[180:183],v[40:43],a[108:111],v[180:183]
buffer_load_dwordx4 v8, s[52:55], s25 offen lds
M v[180:183],v[36:39],a[100:103],v[180:183]
s_waitcnt vmcnt(11) lgkmcnt(0)
W a36,v116
W a37,v117
M v[180:183],v[32:35],a[236:239],v[180:183]
s_barrier
M v[184:187],a[144:147],a[232:235],v[184:187]
s_mov_b32 s25, 2097536
T v[32:33],v20,0
T v[34:35],v20,2048
M v[184:187],a[148:151],a[96:99],v[184:187]
SA m0,s4,40960
W a38,v118
W a39,v119
M v[184:187],a[152:155],a[104:107],v[184:187]
SA s30,s32,8192
T v[36:37],v20,4096
T v[38:39],v20,6144
M v[184:187],a[156:159],a[112:115],v[184:187]
T v[40:41],v20,8192
T v[42:43],v20,10240
M v[184:187],a[160:163],a[120:123],v[184:187]
buffer_store_dwordx4 a[36:39], v6, s[8:11], s30 offen offset:1024 sc1
M v[184:187],a[164:167],a[128:131],v[184:187]
s_nop 0
T v[44:45],v20,12288
T v[46:47],v20,14336
M v[184:187],a[168:171],a[136:139],v[184:187]
T v[48:49],v20,16384
T v[50:51],v20,18432
M v[188:191],a[168:171],a[140:143],v[188:191]
buffer_load_dwordx4 v8, s[52:55], s25 offen lds
M v[188:191],a[164:167],a[132:135],v[188:191]
s_nop 0
T v[52:53],v20,20480
T v[54:55],v20,22528
M v[188:191],a[160:163],a[124:127],v[188:191]
s_mov_b32 s25, 2359680
T v[56:57],v20,24576
T v[58:59],v20,26624
M v[188:191],a[156:159],a[116:119],v[188:191]
SA m0,s4,45056
MF v160,s5,v160
MF v161,s5,v161
M v[188:191],a[152:155],a[108:111],v[188:191]
buffer_load_dwordx4 v8, s[52:55], s25 offen lds
M v[188:191],a[148:151],a[100:103],v[188:191]
MF v162,s5,v162
MF v163,s5,v163
M v[188:191],a[144:147],a[236:239],v[188:191]
s_waitcnt lgkmcnt(6)
MF v168,s5,v168
MF v169,s5,v169
M v[96:99],v[32:35],a[176:179],0
s_mov_b32 s25, 2621824
T a[144:145],v21,0
T a[146:147],v21,2048
M v[96:99],v[36:39],a[184:187],v[96:99]
SA m0,s4,49152
MF v170,s5,v170
MF v171,s5,v171
M v[96:99],v[40:43],a[192:195],v[96:99]
s_waitcnt lgkmcnt(2)
T a[148:149],v21,4096
T a[150:151],v21,6144
M v[96:99],v[44:47],a[200:203],v[96:99]
T a[152:153],v21,8192
T a[154:155],v21,10240
M v[96:99],v[48:51],a[208:211],v[96:99]
buffer_load_dwordx4 v8, s[52:55], s25 offen lds
M v[96:99],v[52:55],a[216:219],v[96:99]
s_nop 0
T a[156:157],v21,12288
T a[158:159],v21,14336
M v[96:99],v[56:59],a[224:227],v[96:99]
s_mov_b32 s25, 2883968
T a[160:161],v21,16384
T a[162:163],v21,18432
M v[100:103],v[56:59],a[228:231],0
SA m0,s4,53248
C v160,v160,v161
C v161,v162,v163
M v[100:103],v[52:55],a[220:223],v[100:103]
T a[164:165],v21,20480
T a[166:167],v21,22528
M v[100:103],v[48:51],a[212:215],v[100:103]
T a[168:169],v21,24576
T a[170:171],v21,26624
M v[100:103],v[44:47],a[204:207],v[100:103]
SA s3,s93,536576
buffer_load_dwordx4 v8, s[52:55], s25 offen lds
M v[100:103],v[40:43],a[196:199],v[100:103]
C v162,v168,v169
C v163,v170,v171
M v[100:103],v[36:39],a[188:191],v[100:103]
s_mov_b32 s25, 3146112
W a8,v160
W a9,v161
M v[100:103],v[32:35],a[180:183],v[100:103]
s_waitcnt lgkmcnt(6)
W a10,v162
W a11,v163
M v[104:107],a[144:147],a[176:179],0
SA s30,s32,0
T v[32:33],v22,0
T v[34:35],v22,2048
M v[104:107],a[148:151],a[184:187],v[104:107]
SA m0,s4,57344
buffer_store_dwordx4 a[8:11], v6, s[8:11], s30 offen offset:2048 sc1
M v[104:107],a[152:155],a[192:195],v[104:107]
s_waitcnt lgkmcnt(2)
s_nop 0
T v[36:37],v22,4096
T v[38:39],v22,6144
M v[104:107],a[156:159],a[200:203],v[104:107]
T v[40:41],v22,8192
T v[42:43],v22,10240
M v[104:107],a[160:163],a[208:211],v[104:107]
buffer_load_dwordx4 v8, s[52:55], s25 offen lds
M v[104:107],a[164:167],a[216:219],v[104:107]
s_nop 0
T v[44:45],v22,12288
T v[46:47],v22,14336
M v[104:107],a[168:171],a[224:227],v[104:107]
s_mov_b32 s25, 3408256
T v[48:49],v22,16384
T v[50:51],v22,18432
M v[108:111],a[168:171],a[228:231],0
SA m0,s4,61440
buffer_store_dwordx4 v[88:91], v7, s[8:11], s3 offen offset:0 sc1
M v[108:111],a[164:167],a[220:223],v[108:111]
s_nop 0
T v[52:53],v22,20480
T v[54:55],v22,22528
M v[108:111],a[160:163],a[212:215],v[108:111]
T v[56:57],v22,24576
T v[58:59],v22,26624
M v[108:111],a[156:159],a[204:207],v[108:111]
buffer_load_dwordx4 v8, s[52:55], s25 offen lds
M v[108:111],a[152:155],a[196:199],v[108:111]
v_lshrrev_b32 v31, 6, v7
v_bfe_u32 v28, v7, 4, 2
M v[108:111],a[148:151],a[188:191],v[108:111]
buffer_store_dwordx4 v[92:95], v7, s[8:11], s3 offen offset:2048 sc1
M v[108:111],a[144:147],a[180:183],v[108:111]
s_waitcnt lgkmcnt(6)
v_lshlrev_b32 v31, 5, v31
v_add_lshl_u32 v31, v31, v28, 2
M v[112:115],v[32:35],a[176:179],0
T a[144:145],v23,0
T a[146:147],v23,2048
M v[112:115],v[36:39],a[184:187],v[112:115]
buffer_load_dword v5, v31, s[8:11], s46 offen offset:4 sc1
M v[112:115],v[40:43],a[192:195],v[112:115]
s_waitcnt lgkmcnt(2)
s_nop 0
T a[148:149],v23,4096
T a[150:151],v23,6144
M v[112:115],v[44:47],a[200:203],v[112:115]
T a[152:153],v23,8192
T a[154:155],v23,10240
M v[112:115],v[48:51],a[208:211],v[112:115]
MF v164,s5,v164
MF v165,s5,v165
M v[112:115],v[52:55],a[216:219],v[112:115]
T a[156:157],v23,12288
T a[158:159],v23,14336
M v[112:115],v[56:59],a[224:227],v[112:115]
T a[160:161],v23,16384
T a[162:163],v23,18432
M v[116:119],v[56:59],a[228:231],0
MF v166,s5,v166
MF v167,s5,v167
M v[116:119],v[52:55],a[220:223],v[116:119]
T a[164:165],v23,20480
T a[166:167],v23,22528
M v[116:119],v[48:51],a[212:215],v[116:119]
T a[168:169],v23,24576
T a[170:171],v23,26624
M v[116:119],v[44:47],a[204:207],v[116:119]
MF v172,s5,v172
MF v173,s5,v173
M v[116:119],v[40:43],a[196:199],v[116:119]
MF v174,s5,v174
MF v175,s5,v175
M v[116:119],v[36:39],a[188:191],v[116:119]
C v164,v164,v165
C v165,v166,v167
M v[116:119],v[32:35],a[180:183],v[116:119]
s_waitcnt lgkmcnt(6)
C v166,v172,v173
C v167,v174,v175
M v[120:123],a[144:147],a[176:179],0
T v[32:33],v20,28672
T v[34:35],v20,30720
M v[120:123],a[148:151],a[184:187],v[120:123]
W a40,v164
W a41,v165
M v[120:123],a[152:155],a[192:195],v[120:123]
s_waitcnt lgkmcnt(2)
T v[36:37],v12,24576
T v[38:39],v12,26624
M v[120:123],a[156:159],a[200:203],v[120:123]
T v[40:41],v12,28672
T v[42:43],v12,30720
M v[120:123],a[160:163],a[208:211],v[120:123]
W a42,v166
W a43,v167
M v[120:123],a[164:167],a[216:219],v[120:123]
SA s30,s32,8192
T v[44:45],v12,0
T v[46:47],v12,2048
M v[120:123],a[168:171],a[224:227],v[120:123]
T v[48:49],v12,4096
T v[50:51],v12,6144
M v[124:127],a[168:171],a[228:231],0
buffer_store_dwordx4 a[40:43], v6, s[8:11], s30 offen offset:2048 sc1
M v[124:127],a[164:167],a[220:223],v[124:127]
s_nop 0
T v[52:53],v12,8192
T v[54:55],v12,10240
M v[124:127],a[160:163],a[212:215],v[124:127]
T v[56:57],v12,12288
T v[58:59],v12,14336
M v[124:127],a[156:159],a[204:207],v[124:127]
v_mov_b32 v8, 0xff800000
MF v176,s5,v176
M v[124:127],a[152:155],a[196:199],v[124:127]
MF v177,s5,v177
MF v178,s5,v178
M v[124:127],a[148:151],a[188:191],v[124:127]
MF v179,s5,v179
MF v184,s5,v184
M v[124:127],a[144:147],a[180:183],v[124:127]
s_waitcnt lgkmcnt(6)
MF v185,s5,v185
MF v186,s5,v186
M v[96:99],v[32:35],a[232:235],v[96:99]
T a[144:145],v21,28672
T a[146:147],v21,30720
M v[96:99],v[36:39],a[96:99],v[96:99]
MF v187,s5,v187
C v176,v176,v177
M v[96:99],v[40:43],a[104:107],v[96:99]
s_waitcnt lgkmcnt(2)
T a[148:149],v13,24576
T a[150:151],v13,26624
M v[96:99],v[44:47],a[112:115],v[96:99]
T a[152:153],v13,28672
T a[154:155],v13,30720
M v[96:99],v[48:51],a[120:123],v[96:99]
C v177,v178,v179
C v178,v184,v185
M v[96:99],v[52:55],a[128:131],v[96:99]
T a[156:157],v13,0
T a[158:159],v13,2048
M v[96:99],v[56:59],a[136:139],v[96:99]
T a[160:161],v13,4096
T a[162:163],v13,6144
M v[100:103],v[56:59],a[140:143],v[100:103]
C v179,v186,v187
W a12,v176
M v[100:103],v[52:55],a[132:135],v[100:103]
T a[164:165],v13,8192
T a[166:167],v13,10240
M v[100:103],v[48:51],a[124:127],v[100:103]
T a[168:169],v13,12288
T a[170:171],v13,14336
M v[100:103],v[44:47],a[116:119],v[100:103]
W a13,v177
W a14,v178
M v[100:103],v[40:43],a[108:111],v[100:103]
W a15,v179
MF v180,s5,v180
M v[100:103],v[36:39],a[100:103],v[100:103]
MF v181,s5,v181
MF v182,s5,v182
M v[100:103],v[32:35],a[236:239],v[100:103]
s_waitcnt lgkmcnt(6)
MF v183,s5,v183
MF v188,s5,v188
M v[104:107],a[144:147],a[232:235],v[104:107]
T v[32:33],v22,28672
T v[34:35],v22,30720
M v[104:107],a[148:151],a[96:99],v[104:107]
MF v189,s5,v189
MF v190,s5,v190
M v[104:107],a[152:155],a[104:107],v[104:107]
s_waitcnt lgkmcnt(2)
T v[36:37],v14,24576
T v[38:39],v14,26624
M v[104:107],a[156:159],a[112:115],v[104:107]
SA s30,s32,0
T v[40:41],v14,28672
T v[42:43],v14,30720
M v[104:107],a[160:163],a[120:123],v[104:107]
buffer_store_dwordx4 a[12:15], v6, s[8:11], s30 offen offset:3072 sc1
M v[104:107],a[164:167],a[128:131],v[104:107]
s_nop 0
T v[44:45],v14,0
T v[46:47],v14,2048
M v[104:107],a[168:171],a[136:139],v[104:107]
T v[48:49],v14,4096
T v[50:51],v14,6144
M v[108:111],a[168:171],a[140:143],v[108:111]
MF v191,s5,v191
C v180,v180,v181
M v[108:111],a[164:167],a[132:135],v[108:111]
T v[52:53],v14,8192
T v[54:55],v14,10240
M v[108:111],a[160:163],a[124:127],v[108:111]
T v[56:57],v14,12288
T v[58:59],v14,14336
M v[108:111],a[156:159],a[116:119],v[108:111]
C v181,v182,v183
C v182,v188,v189
M v[108:111],a[152:155],a[108:111],v[108:111]
C v183,v190,v191
W a44,v180
M v[108:111],a[148:151],a[100:103],v[108:111]
W a45,v181
W a46,v182
M v[108:111],a[144:147],a[236:239],v[108:111]
s_waitcnt lgkmcnt(6)
W a47,v183
s_waitcnt vmcnt(2)
v_cmp_ne_u32 vcc, 1, v5
M v[112:115],v[32:35],a[232:235],v[112:115]
s_nop 0
T a[144:145],v23,28672
T a[146:147],v23,30720
M v[112:115],v[36:39],a[96:99],v[112:115]
s_cmp_lg_u32 vcc_lo, 0
MF v96,s5,v96
MF v97,s5,v97
M v[112:115],v[40:43],a[104:107],v[112:115]
s_waitcnt lgkmcnt(2)
T a[148:149],v15,24576
T a[150:151],v15,26624
M v[112:115],v[44:47],a[112:115],v[112:115]
s_cbranch_scc1 L_wsq1
L_wrq1:
T a[152:153],v15,28672
T a[154:155],v15,30720
M v[112:115],v[48:51],a[120:123],v[112:115]
SA m0,s28,98304
MF v98,s5,v98
MF v99,s5,v99
M v[112:115],v[52:55],a[128:131],v[112:115]
T a[156:157],v15,0
T a[158:159],v15,2048
M v[112:115],v[56:59],a[136:139],v[112:115]
T a[160:161],v15,4096
T a[162:163],v15,6144
M v[116:119],v[56:59],a[140:143],v[116:119]
buffer_load_dwordx4 v3, s[8:11], s21 offen offset:0 sc1 lds
M v[116:119],v[52:55],a[132:135],v[116:119]
s_nop 0
T a[164:165],v15,8192
T a[166:167],v15,10240
M v[116:119],v[48:51],a[124:127],v[116:119]
T a[168:169],v15,12288
T a[170:171],v15,14336
M v[116:119],v[44:47],a[116:119],v[116:119]
buffer_load_dwordx4 v3, s[8:11], s21 offen offset:1024 sc1 lds
M v[116:119],v[40:43],a[108:111],v[116:119]
MF v104,s5,v104
MF v105,s5,v105
M v[116:119],v[36:39],a[100:103],v[116:119]
s_waitcnt lgkmcnt(0)
buffer_load_dwordx4 v3, s[8:11], s21 offen offset:2048 sc1 lds
M v[116:119],v[32:35],a[236:239],v[116:119]
s_barrier
M v[120:123],a[144:147],a[232:235],v[120:123]
SA s30,s32,8192
T v[32:33],v16,0
T v[34:35],v16,2048
M v[120:123],a[148:151],a[96:99],v[120:123]
buffer_store_dwordx4 a[44:47], v6, s[8:11], s30 offen offset:3072 sc1
M v[120:123],a[152:155],a[104:107],v[120:123]
s_nop 0
T v[36:37],v16,4096
T v[38:39],v16,6144
M v[120:123],a[156:159],a[112:115],v[120:123]
T v[40:41],v16,8192
T v[42:43],v16,10240
M v[120:123],a[160:163],a[120:123],v[120:123]
buffer_load_dwordx4 v3, s[8:11], s21 offen offset:3072 sc1 lds
M v[120:123],a[164:167],a[128:131],v[120:123]
SA m0,s28,102400
T v[44:45],v16,12288
T v[46:47],v16,14336
M v[120:123],a[168:171],a[136:139],v[120:123]
T v[48:49],v16,16384
T v[50:51],v16,18432
M v[124:127],a[168:171],a[140:143],v[124:127]
buffer_load_dwordx4 v4, s[8:11], s21 offen offset:0 sc1 lds
M v[124:127],a[164:167],a[132:135],v[124:127]
s_nop 0
T v[52:53],v16,20480
T v[54:55],v16,22528
M v[124:127],a[160:163],a[124:127],v[124:127]
T v[56:57],v16,24576
T v[58:59],v16,26624
M v[124:127],a[156:159],a[116:119],v[124:127]
buffer_load_dwordx4 v4, s[8:11], s21 offen offset:1024 sc1 lds
M v[124:127],a[152:155],a[108:111],v[124:127]
MF v106,s5,v106
MF v107,s5,v107
M v[124:127],a[148:151],a[100:103],v[124:127]
buffer_load_dwordx4 v4, s[8:11], s21 offen offset:2048 sc1 lds
M v[124:127],a[144:147],a[236:239],v[124:127]
s_waitcnt lgkmcnt(6)
C v96,v96,v97
C v97,v98,v99
M v[160:163],v[32:35],a[176:179],0
T a[144:145],v17,0
T a[146:147],v17,2048
M v[160:163],v[36:39],a[184:187],v[160:163]
buffer_load_dwordx4 v4, s[8:11], s21 offen offset:3072 sc1 lds
M v[160:163],v[40:43],a[192:195],v[160:163]
s_waitcnt lgkmcnt(2)
s_nop 0
T a[148:149],v17,4096
T a[150:151],v17,6144
M v[160:163],v[44:47],a[200:203],v[160:163]
SA s21,s21,32768
T a[152:153],v17,8192
T a[154:155],v17,10240
M v[160:163],v[48:51],a[208:211],v[160:163]
s_sub_u32 s22, s22, 1
C v98,v104,v105
C v99,v106,v107
M v[160:163],v[52:55],a[216:219],v[160:163]
s_cselect_b32 s21, s23, s21
T a[156:157],v17,12288
T a[158:159],v17,14336
M v[160:163],v[56:59],a[224:227],v[160:163]
SA m0,s28,65536
T a[160:161],v17,16384
T a[162:163],v17,18432
M v[164:167],v[56:59],a[228:231],0
buffer_load_dwordx4 v3, s[8:11], s21 offen offset:0 sc1 lds
M v[164:167],v[52:55],a[220:223],v[164:167]
s_nop 0
T a[164:165],v17,20480
T a[166:167],v17,22528
M v[164:167],v[48:51],a[212:215],v[164:167]
T a[168:169],v17,24576
T a[170:171],v17,26624
M v[164:167],v[44:47],a[204:207],v[164:167]
buffer_load_dwordx4 v3, s[8:11], s21 offen offset:1024 sc1 lds
M v[164:167],v[40:43],a[196:199],v[164:167]
buffer_load_dword v5, v31, s[8:11], s46 offen offset:4 sc1
M v[164:167],v[36:39],a[188:191],v[164:167]
buffer_load_dwordx4 v3, s[8:11], s21 offen offset:2048 sc1 lds
M v[164:167],v[32:35],a[180:183],v[164:167]
s_waitcnt lgkmcnt(6)
W a16,v96
W a17,v97
M v[168:171],a[144:147],a[176:179],0
T v[32:33],v18,0
T v[34:35],v18,2048
M v[168:171],a[148:151],a[184:187],v[168:171]
buffer_load_dwordx4 v3, s[8:11], s21 offen offset:3072 sc1 lds
M v[168:171],a[152:155],a[192:195],v[168:171]
s_waitcnt lgkmcnt(2)
s_nop 0
T v[36:37],v18,4096
T v[38:39],v18,6144
M v[168:171],a[156:159],a[200:203],v[168:171]
SA m0,s28,69632
T v[40:41],v18,8192
T v[42:43],v18,10240
M v[168:171],a[160:163],a[208:211],v[168:171]
buffer_load_dwordx4 v4, s[8:11], s21 offen offset:0 sc1 lds
M v[168:171],a[164:167],a[216:219],v[168:171]
s_nop 0
T v[44:45],v18,12288
T v[46:47],v18,14336
M v[168:171],a[168:171],a[224:227],v[168:171]
T v[48:49],v18,16384
T v[50:51],v18,18432
M v[172:175],a[168:171],a[228:231],0
buffer_load_dwordx4 v4, s[8:11], s21 offen offset:1024 sc1 lds
M v[172:175],a[164:167],a[220:223],v[172:175]
s_nop 0
T v[52:53],v18,20480
T v[54:55],v18,22528
M v[172:175],a[160:163],a[212:215],v[172:175]
T v[56:57],v18,24576
T v[58:59],v18,26624
M v[172:175],a[156:159],a[204:207],v[172:175]
buffer_load_dwordx4 v4, s[8:11], s21 offen offset:2048 sc1 lds
M v[172:175],a[152:155],a[196:199],v[172:175]
W a18,v98
W a19,v99
M v[172:175],a[148:151],a[188:191],v[172:175]
SA s30,s32,4096
buffer_store_dwordx4 a[16:19], v6, s[8:11], s30 offen offset:0 sc1
M v[172:175],a[144:147],a[180:183],v[172:175]
s_waitcnt lgkmcnt(6)
MF v100,s5,v100
MF v101,s5,v101
M v[176:179],v[32:35],a[176:179],0
T a[144:145],v19,0
T a[146:147],v19,2048
M v[176:179],v[36:39],a[184:187],v[176:179]
buffer_load_dwordx4 v4, s[8:11], s21 offen offset:3072 sc1 lds
M v[176:179],v[40:43],a[192:195],v[176:179]
s_waitcnt lgkmcnt(2)
s_nop 0
T a[148:149],v19,4096
T a[150:151],v19,6144
M v[176:179],v[44:47],a[200:203],v[176:179]
SA s21,s21,32768
T a[152:153],v19,8192
T a[154:155],v19,10240
M v[176:179],v[48:51],a[208:211],v[176:179]
s_sub_u32 s22, s22, 1
MF v102,s5,v102
MF v103,s5,v103
M v[176:179],v[52:55],a[216:219],v[176:179]
s_cselect_b32 s21, s23, s21
T a[156:157],v19,12288
T a[158:159],v19,14336
M v[176:179],v[56:59],a[224:227],v[176:179]
T a[160:161],v19,16384
T a[162:163],v19,18432
M v[180:183],v[56:59],a[228:231],0
MF v108,s5,v108
MF v109,s5,v109
M v[180:183],v[52:55],a[220:223],v[180:183]
T a[164:165],v19,20480
T a[166:167],v19,22528
M v[180:183],v[48:51],a[212:215],v[180:183]
T a[168:169],v19,24576
T a[170:171],v19,26624
M v[180:183],v[44:47],a[204:207],v[180:183]
MF v110,s5,v110
MF v111,s5,v111
M v[180:183],v[40:43],a[196:199],v[180:183]
C v100,v100,v101
C v101,v102,v103
M v[180:183],v[36:39],a[188:191],v[180:183]
C v102,v108,v109
C v103,v110,v111
M v[180:183],v[32:35],a[180:183],v[180:183]
s_waitcnt lgkmcnt(6)
W a48,v100
W a49,v101
M v[184:187],a[144:147],a[176:179],0
T v[32:33],v16,28672
T v[34:35],v16,30720
M v[184:187],a[148:151],a[184:187],v[184:187]
W a50,v102
W a51,v103
M v[184:187],a[152:155],a[192:195],v[184:187]
s_waitcnt lgkmcnt(2)
T v[36:37],v16,40960
T v[38:39],v16,43008
M v[184:187],a[156:159],a[200:203],v[184:187]
T v[40:41],v16,45056
T v[42:43],v16,47104
M v[184:187],a[160:163],a[208:211],v[184:187]
MF v112,s5,v112
MF v113,s5,v113
M v[184:187],a[164:167],a[216:219],v[184:187]
T v[44:45],v16,49152
T v[46:47],v16,51200
M v[184:187],a[168:171],a[224:227],v[184:187]
T v[48:49],v16,53248
T v[50:51],v16,55296
M v[188:191],a[168:171],a[228:231],0
MF v114,s5,v114
MF v115,s5,v115
M v[188:191],a[164:167],a[220:223],v[188:191]
SA s30,s32,12288
T v[52:53],v16,57344
T v[54:55],v16,59392
M v[188:191],a[160:163],a[212:215],v[188:191]
T v[56:57],v16,61440
T v[58:59],v16,63488
M v[188:191],a[156:159],a[204:207],v[188:191]
buffer_store_dwordx4 a[48:51], v6, s[8:11], s30 offen offset:0 sc1
M v[188:191],a[152:155],a[196:199],v[188:191]
MF v120,s5,v120
MF v121,s5,v121
M v[188:191],a[148:151],a[188:191],v[188:191]
MF v122,s5,v122
MF v123,s5,v123
M v[188:191],a[144:147],a[180:183],v[188:191]
s_waitcnt lgkmcnt(6)
C v112,v112,v113
C v113,v114,v115
M v[160:163],v[32:35],a[232:235],v[160:163]
T a[144:145],v17,28672
T a[146:147],v17,30720
M v[160:163],v[36:39],a[96:99],v[160:163]
C v114,v120,v121
C v115,v122,v123
M v[160:163],v[40:43],a[104:107],v[160:163]
s_waitcnt lgkmcnt(2)
T a[148:149],v17,40960
T a[150:151],v17,43008
M v[160:163],v[44:47],a[112:115],v[160:163]
T a[152:153],v17,45056
T a[154:155],v17,47104
M v[160:163],v[48:51],a[120:123],v[160:163]
W a20,v112
W a21,v113
M v[160:163],v[52:55],a[128:131],v[160:163]
T a[156:157],v17,49152
T a[158:159],v17,51200
M v[160:163],v[56:59],a[136:139],v[160:163]
T a[160:161],v17,53248
T a[162:163],v17,55296
M v[164:167],v[56:59],a[140:143],v[164:167]
W a22,v114
W a23,v115
M v[164:167],v[52:55],a[132:135],v[164:167]
T a[164:165],v17,57344
T a[166:167],v17,59392
M v[164:167],v[48:51],a[124:127],v[164:167]
T a[168:169],v17,61440
T a[170:171],v17,63488
M v[164:167],v[44:47],a[116:119],v[164:167]
MF v116,s5,v116
MF v117,s5,v117
M v[164:167],v[40:43],a[108:111],v[164:167]
MF v118,s5,v118
MF v119,s5,v119
M v[164:167],v[36:39],a[100:103],v[164:167]
MF v124,s5,v124
MF v125,s5,v125
M v[164:167],v[32:35],a[236:239],v[164:167]
s_waitcnt lgkmcnt(6)
MF v126,s5,v126
MF v127,s5,v127
M v[168:171],a[144:147],a[232:235],v[168:171]
T v[32:33],v18,28672
T v[34:35],v18,30720
M v[168:171],a[148:151],a[96:99],v[168:171]
C v116,v116,v117
C v117,v118,v119
M v[168:171],a[152:155],a[104:107],v[168:171]
s_waitcnt lgkmcnt(2)
T v[36:37],v18,40960
T v[38:39],v18,43008
M v[168:171],a[156:159],a[112:115],v[168:171]
T v[40:41],v18,45056
T v[42:43],v18,47104
M v[168:171],a[160:163],a[120:123],v[168:171]
C v118,v124,v125
C v119,v126,v127
M v[168:171],a[164:167],a[128:131],v[168:171]
T v[44:45],v18,49152
T v[46:47],v18,51200
M v[168:171],a[168:171],a[136:139],v[168:171]
SA s30,s32,4096
T v[48:49],v18,53248
T v[50:51],v18,55296
M v[172:175],a[168:171],a[140:143],v[172:175]
buffer_store_dwordx4 a[20:23], v6, s[8:11], s30 offen offset:1024 sc1
M v[172:175],a[164:167],a[132:135],v[172:175]
s_nop 0
T v[52:53],v18,57344
T v[54:55],v18,59392
M v[172:175],a[160:163],a[124:127],v[172:175]
T v[56:57],v18,61440
T v[58:59],v18,63488
M v[172:175],a[156:159],a[116:119],v[172:175]
W a52,v116
W a53,v117
M v[172:175],a[152:155],a[108:111],v[172:175]
W a54,v118
W a55,v119
M v[172:175],a[148:151],a[100:103],v[172:175]
s_waitcnt vmcnt(9)
v_cmp_ne_u32 vcc, 1, v5
MF v160,s5,v160
M v[172:175],a[144:147],a[236:239],v[172:175]
s_waitcnt lgkmcnt(6)
MF v161,s5,v161
MF v162,s5,v162
M v[176:179],v[32:35],a[232:235],v[176:179]
s_nop 0
T a[144:145],v19,28672
T a[146:147],v19,30720
M v[176:179],v[36:39],a[96:99],v[176:179]
s_cmp_lg_u32 vcc_hi, 0
MF v163,s5,v163
MF v168,s5,v168
M v[176:179],v[40:43],a[104:107],v[176:179]
s_waitcnt lgkmcnt(2)
T a[148:149],v19,40960
T a[150:151],v19,43008
M v[176:179],v[44:47],a[112:115],v[176:179]
s_cbranch_scc1 L_wsr1
L_wrr1:
T a[152:153],v19,45056
T a[154:155],v19,47104
M v[176:179],v[48:51],a[120:123],v[176:179]
SA m0,s28,131072
MF v169,s5,v169
MF v170,s5,v170
M v[176:179],v[52:55],a[128:131],v[176:179]
T a[156:157],v19,49152
T a[158:159],v19,51200
M v[176:179],v[56:59],a[136:139],v[176:179]
T a[160:161],v19,53248
T a[162:163],v19,55296
M v[180:183],v[56:59],a[140:143],v[180:183]
buffer_load_dwordx4 v3, s[8:11], s26 offen offset:0 sc1 lds
M v[180:183],v[52:55],a[132:135],v[180:183]
s_nop 0
T a[164:165],v19,57344
T a[166:167],v19,59392
M v[180:183],v[48:51],a[124:127],v[180:183]
T a[168:169],v19,61440
T a[170:171],v19,63488
M v[180:183],v[44:47],a[116:119],v[180:183]
buffer_load_dwordx4 v3, s[8:11], s26 offen offset:1024 sc1 lds
M v[180:183],v[40:43],a[108:111],v[180:183]
MF v171,s5,v171
C v160,v160,v161
M v[180:183],v[36:39],a[100:103],v[180:183]
s_waitcnt lgkmcnt(0)
buffer_load_dwordx4 v3, s[8:11], s26 offen offset:2048 sc1 lds
M v[180:183],v[32:35],a[236:239],v[180:183]
s_barrier
M v[184:187],a[144:147],a[232:235],v[184:187]
R a[64:67],v2,32768
R a[68:71],v2,33792
M v[184:187],a[148:151],a[96:99],v[184:187]
buffer_load_dwordx4 v3, s[8:11], s26 offen offset:3072 sc1 lds
M v[184:187],a[152:155],a[104:107],v[184:187]
SA m0,s28,135168
C v161,v162,v163
C v162,v168,v169
M v[184:187],a[156:159],a[112:115],v[184:187]
SA s30,s32,12288
R a[72:75],v2,34816
R a[76:79],v2,35840
M v[184:187],a[160:163],a[120:123],v[184:187]
buffer_store_dwordx4 a[52:55], v6, s[8:11], s30 offen offset:1024 sc1
M v[184:187],a[164:167],a[128:131],v[184:187]
C v163,v170,v171
W a24,v160
M v[184:187],a[168:171],a[136:139],v[184:187]
R a[80:83],v2,36864
R a[84:87],v2,37888
M v[188:191],a[168:171],a[140:143],v[188:191]
buffer_load_dwordx4 v4, s[8:11], s26 offen offset:0 sc1 lds
M v[188:191],a[164:167],a[132:135],v[188:191]
W a25,v161
W a26,v162
M v[188:191],a[160:163],a[124:127],v[188:191]
R a[88:91],v2,38912
R a[92:95],v2,39936
M v[188:191],a[156:159],a[116:119],v[188:191]
buffer_load_dwordx4 v4, s[8:11], s26 offen offset:1024 sc1 lds
M v[188:191],a[152:155],a[108:111],v[188:191]
W a27,v163
MF v164,s5,v164
M v[188:191],a[148:151],a[100:103],v[188:191]
buffer_load_dwordx4 v4, s[8:11], s26 offen offset:2048 sc1 lds
M v[188:191],a[144:147],a[236:239],v[188:191]
s_waitcnt lgkmcnt(0)
SA s30,s32,4096
buffer_store_dwordx4 a[24:27], v6, s[8:11], s30 offen offset:2048 sc1
buffer_load_dwordx4 v4, s[8:11], s26 offen offset:3072 sc1 lds
SA s26,s26,32768
MF v165,s5,v165
MF v166,s5,v166
MF v167,s5,v167
MF v172,s5,v172
MF v173,s5,v173
MF v174,s5,v174
MF v175,s5,v175
C v164,v164,v165
C v165,v166,v167
C v166,v172,v173
C v167,v174,v175
W a56,v164
W a57,v165
W a58,v166
W a59,v167
SA s30,s32,12288
buffer_store_dwordx4 a[56:59], v6, s[8:11], s30 offen offset:2048 sc1
v_mov_b32 v30, 2
buffer_store_dword v30, v1, s[8:11], s45 offen sc1
M v[64:67],a[64:67],a[0:3],0
R a[96:99],v2,40960
R a[100:103],v2,41984
M v[64:67],a[68:71],a[4:7],v[64:67]
MF v176,s5,v176
MF v177,s5,v177
M v[64:67],a[72:75],a[8:11],v[64:67]
MF v178,s5,v178
MF v179,s5,v179
M v[64:67],a[76:79],a[12:15],v[64:67]
R a[104:107],v2,43008
R a[108:111],v2,44032
M v[64:67],a[80:83],a[16:19],v[64:67]
MF v184,s5,v184
MF v185,s5,v185
MF v186,s5,v186
MF v187,s5,v187
C v176,v176,v177
C v177,v178,v179
C v178,v184,v185
C v179,v186,v187
W a28,v176
W a29,v177
W a30,v178
W a31,v179
M v[64:67],a[84:87],a[20:23],v[64:67]
MF v180,s5,v180
MF v181,s5,v181
M v[64:67],a[88:91],a[24:27],v[64:67]
R a[112:115],v2,45056
R a[116:119],v2,46080
M v[64:67],a[92:95],a[28:31],v[64:67]
MF v182,s5,v182
MF v183,s5,v183
M v[68:71],a[64:67],a[32:35],0
MF v188,s5,v188
MF v189,s5,v189
M v[68:71],a[68:71],a[36:39],v[68:71]
R a[120:123],v2,47104
R a[124:127],v2,48128
M v[68:71],a[72:75],a[40:43],v[68:71]
SA m0,s28,32768
MF v190,s5,v190
MF v191,s5,v191
M v[68:71],a[76:79],a[44:47],v[68:71]
buffer_load_dwordx4 v3, s[8:11], s26 offen offset:0 sc1 lds
M v[68:71],a[80:83],a[48:51],v[68:71]
C v180,v180,v181
C v181,v182,v183
C v182,v188,v189
C v183,v190,v191
W a60,v180
W a61,v181
W a62,v182
W a63,v183
M v[68:71],a[84:87],a[52:55],v[68:71]
SA s30,s32,4096
buffer_store_dwordx4 a[28:31], v6, s[8:11], s30 offen offset:3072 sc1
M v[68:71],a[88:91],a[56:59],v[68:71]
SA s30,s32,12288
E v18,v64
M v[68:71],a[92:95],a[60:63],v[68:71]
s_waitcnt lgkmcnt(0)
buffer_store_dwordx4 a[60:63], v6, s[8:11], s30 offen offset:3072 sc1
M v[72:75],a[96:99],a[0:3],0
R a[64:67],v2,49152
R a[68:71],v2,50176
M v[72:75],a[100:103],a[4:7],v[72:75]
E v19,v65
M v[72:75],a[104:107],a[8:11],v[72:75]
buffer_load_dwordx4 v3, s[8:11], s26 offen offset:1024 sc1 lds
M v[72:75],a[108:111],a[12:15],v[72:75]
R a[72:75],v2,51200
R a[76:79],v2,52224
M v[72:75],a[112:115],a[16:19],v[72:75]
E v20,v66
M v[72:75],a[116:119],a[20:23],v[72:75]
buffer_load_dwordx4 v3, s[8:11], s26 offen offset:2048 sc1 lds
M v[72:75],a[120:123],a[24:27],v[72:75]
R a[80:83],v2,53248
R a[84:87],v2,54272
M v[72:75],a[124:127],a[28:31],v[72:75]
E v21,v67
M v[76:79],a[124:127],a[60:63],0
buffer_load_dwordx4 v3, s[8:11], s26 offen offset:3072 sc1 lds
M v[76:79],a[120:123],a[56:59],v[76:79]
SA m0,s28,36864
R a[88:91],v2,55296
R a[92:95],v2,56320
M v[76:79],a[116:119],a[52:55],v[76:79]
E v22,v68
M v[76:79],a[112:115],a[48:51],v[76:79]
buffer_load_dwordx4 v4, s[8:11], s26 offen offset:0 sc1 lds
M v[76:79],a[108:111],a[44:47],v[76:79]
E v23,v69
M v[76:79],a[104:107],a[40:43],v[76:79]
AF v26,v18,v19
C v40,v18,v19
M v[76:79],a[100:103],a[36:39],v[76:79]
buffer_load_dwordx4 v4, s[8:11], s26 offen offset:1024 sc1 lds
M v[76:79],a[96:99],a[32:35],v[76:79]
s_waitcnt lgkmcnt(0)
v_add_u32 v16, 0x20000, v7
AF v26,v20,v26
M v[80:83],a[64:67],a[0:3],0
R a[96:99],v2,57344
R a[100:103],v2,58368
M v[80:83],a[68:71],a[4:7],v[80:83]
buffer_load_dwordx4 v4, s[8:11], s26 offen offset:2048 sc1 lds
M v[80:83],a[72:75],a[8:11],v[80:83]
E v24,v70
M v[80:83],a[76:79],a[12:15],v[80:83]
R a[104:107],v2,59392
R a[108:111],v2,60416
M v[80:83],a[80:83],a[16:19],v[80:83]
buffer_load_dwordx4 v4, s[8:11], s26 offen offset:3072 sc1 lds
M v[80:83],a[84:87],a[20:23],v[80:83]
SA s26,s26,32768
E v25,v71
M v[80:83],a[88:91],a[24:27],v[80:83]
R a[112:115],v2,61440
R a[116:119],v2,62464
M v[80:83],a[92:95],a[28:31],v[80:83]
E v18,v72
M v[84:87],a[92:95],a[60:63],0
E v19,v73
M v[84:87],a[88:91],a[56:59],v[84:87]
R a[120:123],v2,63488
R a[124:127],v2,64512
M v[84:87],a[84:87],a[52:55],v[84:87]
C v41,v20,v21
AF v26,v21,v26
M v[84:87],a[80:83],a[48:51],v[84:87]
E v20,v74
M v[84:87],a[76:79],a[44:47],v[84:87]
AF v27,v22,v23
C v44,v22,v23
M v[84:87],a[72:75],a[40:43],v[84:87]
AF v27,v24,v27
C v45,v24,v25
M v[84:87],a[68:71],a[36:39],v[84:87]
s_waitcnt vmcnt(24) lgkmcnt(0)
E v21,v75
M v[84:87],a[64:67],a[32:35],v[84:87]
s_barrier
M v[88:91],a[96:99],a[0:3],0
R a[64:67],v2,0
R a[68:71],v2,1024
M v[88:91],a[100:103],a[4:7],v[88:91]
E v22,v76
M v[88:91],a[104:107],a[8:11],v[88:91]
AF v27,v25,v27
AF v26,v18,v26
M v[88:91],a[108:111],a[12:15],v[88:91]
R a[72:75],v2,2048
R a[76:79],v2,3072
M v[88:91],a[112:115],a[16:19],v[88:91]
E v23,v77
M v[88:91],a[116:119],a[20:23],v[88:91]
C v42,v18,v19
AF v26,v19,v26
M v[88:91],a[120:123],a[24:27],v[88:91]
R a[80:83],v2,4096
R a[84:87],v2,5120
M v[88:91],a[124:127],a[28:31],v[88:91]
E v24,v78
M v[92:95],a[124:127],a[60:63],0
AF v26,v20,v26
C v43,v20,v21
M v[92:95],a[120:123],a[56:59],v[92:95]
R a[88:91],v2,6144
R a[92:95],v2,7168
M v[92:95],a[116:119],a[52:55],v[92:95]
E v25,v79
M v[92:95],a[112:115],a[48:51],v[92:95]
AF v26,v21,v26
AF v27,v22,v27
M v[92:95],a[108:111],a[44:47],v[92:95]
C v46,v22,v23
AF v27,v23,v27
M v[92:95],a[104:107],a[40:43],v[92:95]
AF v27,v24,v27
C v47,v24,v25
M v[92:95],a[100:103],a[36:39],v[92:95]
s_waitcnt lgkmcnt(0)
AF v27,v25,v27
M v[92:95],a[96:99],a[32:35],v[92:95]
M v[96:99],a[64:67],a[0:3],0
R a[96:99],v2,8192
R a[100:103],v2,9216
M v[96:99],a[68:71],a[4:7],v[96:99]
SA m0,s28,98304
W a128,v128
W a129,v129
M v[96:99],a[72:75],a[8:11],v[96:99]
buffer_load_dwordx4 v3, s[8:11], s21 offen offset:0 sc1 lds
M v[96:99],a[76:79],a[12:15],v[96:99]
R a[104:107],v2,10240
R a[108:111],v2,11264
M v[96:99],a[80:83],a[16:19],v[96:99]
W a130,v130
v_mov_b32 v30, 0
M v[96:99],a[84:87],a[20:23],v[96:99]
W a131,v131
M v[96:99],a[88:91],a[24:27],v[96:99]
R a[112:115],v2,12288
R a[116:119],v2,13312
M v[96:99],a[92:95],a[28:31],v[96:99]
buffer_load_dwordx4 v3, s[8:11], s21 offen offset:1024 sc1 lds
M v[100:103],a[92:95],a[60:63],0
W a132,v132
v_mov_b32 v31, 0
M v[100:103],a[88:91],a[56:59],v[100:103]
R a[120:123],v2,14336
R a[124:127],v2,15360
M v[100:103],a[84:87],a[52:55],v[100:103]
W a133,v133
W a134,v134
M v[100:103],a[80:83],a[48:51],v[100:103]
buffer_load_dwordx4 v3, s[8:11], s21 offen offset:2048 sc1 lds
M v[100:103],a[76:79],a[44:47],v[100:103]
W a135,v135
M v[100:103],a[72:75],a[40:43],v[100:103]
v_mov_b32 v32, 0
M v[100:103],a[68:71],a[36:39],v[100:103]
W a136,v136
M v[100:103],a[64:67],a[32:35],v[100:103]
s_waitcnt lgkmcnt(0)
buffer_load_dwordx4 v3, s[8:11], s21 offen offset:3072 sc1 lds
M v[108:111],a[96:99],a[32:35],0
SA m0,s28,102400
R a[64:67],v2,16384
R a[68:71],v2,17408
M v[108:111],a[100:103],a[36:39],v[108:111]
W a137,v137
v_mov_b32 v33, 0
M v[108:111],a[104:107],a[40:43],v[108:111]
W a138,v138
M v[108:111],a[108:111],a[44:47],v[108:111]
R a[72:75],v2,18432
R a[76:79],v2,19456
M v[108:111],a[112:115],a[48:51],v[108:111]
buffer_load_dwordx4 v4, s[8:11], s21 offen offset:0 sc1 lds
M v[108:111],a[116:119],a[52:55],v[108:111]
W a139,v139
W a140,v140
M v[108:111],a[120:123],a[56:59],v[108:111]
R a[80:83],v2,20480
R a[84:87],v2,21504
M v[108:111],a[124:127],a[60:63],v[108:111]
buffer_load_dwordx4 v4, s[8:11], s21 offen offset:1024 sc1 lds
M v[104:107],a[124:127],a[28:31],0
v_mov_b32 v34, 0
W a141,v141
M v[104:107],a[120:123],a[24:27],v[104:107]
R a[88:91],v2,22528
R a[92:95],v2,23552
M v[104:107],a[116:119],a[20:23],v[104:107]
buffer_load_dwordx4 v4, s[8:11], s21 offen offset:2048 sc1 lds
M v[104:107],a[112:115],a[16:19],v[104:107]
W a142,v142
W a143,v143
M v[104:107],a[108:111],a[12:15],v[104:107]
v_mov_b32 v35, 0
W a144,v144
M v[104:107],a[104:107],a[8:11],v[104:107]
W a145,v145
M v[104:107],a[100:103],a[4:7],v[104:107]
buffer_load_dwordx4 v4, s[8:11], s21 offen offset:3072 sc1 lds
M v[104:107],a[96:99],a[0:3],v[104:107]
s_waitcnt lgkmcnt(0)
v_mov_b32 v36, 0
W a146,v146
M v[112:115],a[64:67],a[0:3],0
SA s21,s21,32768
R a[96:99],v2,24576
R a[100:103],v2,25600
M v[112:115],a[68:71],a[4:7],v[112:115]
s_sub_u32 s22, s22, 1
W a147,v147
M v[112:115],a[72:75],a[8:11],v[112:115]
s_cselect_b32 s21, s23, s21
E v18,v80
M v[112:115],a[76:79],a[12:15],v[112:115]
R a[104:107],v2,26624
R a[108:111],v2,27648
M v[112:115],a[80:83],a[16:19],v[112:115]
W a148,v148
v_mov_b32 v37, 0
M v[112:115],a[84:87],a[20:23],v[112:115]
W a149,v149
M v[112:115],a[88:91],a[24:27],v[112:115]
R a[112:115],v2,28672
R a[116:119],v2,29696
M v[112:115],a[92:95],a[28:31],v[112:115]
W a150,v150
M v[116:119],a[92:95],a[60:63],0
v_mov_b32 v38, 0
W a151,v151
M v[116:119],a[88:91],a[56:59],v[116:119]
R a[120:123],v2,30720
R a[124:127],v2,31744
M v[116:119],a[84:87],a[52:55],v[116:119]
W a152,v152
M v[116:119],a[80:83],a[48:51],v[116:119]
W a153,v153
M v[116:119],a[76:79],a[44:47],v[116:119]
E v19,v81
M v[116:119],a[72:75],a[40:43],v[116:119]
v_mov_b32 v39, 0
W a154,v154
M v[116:119],a[68:71],a[36:39],v[116:119]
s_waitcnt vmcnt(20) lgkmcnt(0)
E v20,v82
M v[116:119],a[64:67],a[32:35],v[116:119]
s_barrier
M v[124:127],a[96:99],a[32:35],0
R a[64:67],v16,0
R a[68:71],v16,1024
M v[124:127],a[100:103],a[36:39],v[124:127]
W a155,v155
W a156,v156
M v[124:127],a[104:107],a[40:43],v[124:127]
W a157,v157
AF v26,v18,v26
M v[124:127],a[108:111],a[44:47],v[124:127]
R a[72:75],v16,2048
R a[76:79],v16,3072
M v[124:127],a[112:115],a[48:51],v[124:127]
W a158,v158
C v56,v18,v19
M v[124:127],a[116:119],a[52:55],v[124:127]
E v21,v83
M v[124:127],a[120:123],a[56:59],v[124:127]
R a[80:83],v16,4096
R a[84:87],v16,5120
M v[124:127],a[124:127],a[60:63],v[124:127]
W a159,v159
AF v26,v19,v26
M v[120:123],a[124:127],a[28:31],0
E v22,v88
M v[120:123],a[120:123],a[24:27],v[120:123]
R a[88:91],v16,6144
R a[92:95],v16,7168
M v[120:123],a[116:119],a[20:23],v[120:123]
E v23,v89
M v[120:123],a[112:115],a[16:19],v[120:123]
E v24,v90
M v[120:123],a[108:111],a[12:15],v[120:123]
E v25,v91
M v[120:123],a[104:107],a[8:11],v[120:123]
E v18,v84
M v[120:123],a[100:103],a[4:7],v[120:123]
s_waitcnt lgkmcnt(0)
E v19,v85
M v[120:123],a[96:99],a[0:3],v[120:123]
AF v26,v20,v26
C v57,v20,v21
AF v26,v21,v26
AF v26,v22,v26
C v58,v22,v23
AF v26,v23,v26
AF v26,v24,v26
C v59,v24,v25
AF v26,v25,v26
E v20,v86
E v21,v87
AF v27,v18,v27
C v60,v18,v19
AF v27,v19,v27
E v22,v92
E v23,v93
AF v27,v20,v27
C v61,v20,v21
AF v27,v21,v27
E v24,v94
E v25,v95
AF v27,v22,v27
C v62,v22,v23
AF v27,v23,v27
AF v27,v24,v27
C v63,v24,v25
AF v27,v25,v27
v_max_f32 v10, v26, v27
v_min_f32 v11, v26, v27
v_cmp_lt_f32 vcc, s31, v10
v_cmp_gt_f32 s[64:65], s24, v11
s_nop 0
s_or_b64 vcc, vcc, s[64:65]
s_cbranch_vccnz L_stv1
L_rtv1:
M v[128:131],a[64:67],v[40:43],0
R a[96:99],v16,8192
R a[100:103],v16,9216
M v[128:131],a[68:71],v[56:59],v[128:131]
SA m0,s28,65536
W a160,v192
W a161,v193
M v[132:135],a[68:71],v[60:63],0
buffer_load_dwordx4 v3, s[8:11], s21 offen offset:0 sc1 lds
M v[132:135],a[64:67],v[44:47],v[132:135]
R a[104:107],v16,10240
R a[108:111],v16,11264
M v[140:143],a[72:75],v[44:47],0
W a162,v194
W a163,v195
M v[140:143],a[76:79],v[60:63],v[140:143]
W a164,v196
W a165,v197
M v[136:139],a[76:79],v[56:59],0
R a[112:115],v16,12288
R a[116:119],v16,13312
M v[136:139],a[72:75],v[40:43],v[136:139]
buffer_load_dwordx4 v3, s[8:11], s21 offen offset:1024 sc1 lds
M v[144:147],a[80:83],v[40:43],0
W a166,v198
W a167,v199
M v[144:147],a[84:87],v[56:59],v[144:147]
R a[120:123],v16,14336
R a[124:127],v16,15360
M v[148:151],a[84:87],v[60:63],0
SA s3,s93,262144
W a168,v200
W a169,v201
M v[148:151],a[80:83],v[44:47],v[148:151]
buffer_load_dwordx4 v3, s[8:11], s21 offen offset:2048 sc1 lds
M v[156:159],a[88:91],v[44:47],0
W a170,v202
W a171,v203
M v[156:159],a[92:95],v[60:63],v[156:159]
W a172,v204
W a173,v205
M v[152:155],a[92:95],v[56:59],0
buffer_store_dwordx4 a[128:131], v7, s[8:11], s3 offen offset:0 sc1
M v[152:155],a[88:91],v[40:43],v[152:155]
s_waitcnt lgkmcnt(0)
W a174,v206
W a175,v207
M v[160:163],a[96:99],v[40:43],0
R a[64:67],v16,16384
R a[68:71],v16,17408
M v[160:163],a[100:103],v[56:59],v[160:163]
buffer_load_dwordx4 v3, s[8:11], s21 offen offset:3072 sc1 lds
M v[164:167],a[100:103],v[60:63],0
SA m0,s28,69632
W a176,v208
W a177,v209
M v[164:167],a[96:99],v[44:47],v[164:167]
R a[72:75],v16,18432
R a[76:79],v16,19456
M v[172:175],a[104:107],v[44:47],0
buffer_load_dwordx4 v4, s[8:11], s21 offen offset:0 sc1 lds
M v[172:175],a[108:111],v[60:63],v[172:175]
W a178,v210
W a179,v211
M v[168:171],a[108:111],v[56:59],0
R a[80:83],v16,20480
R a[84:87],v16,21504
M v[168:171],a[104:107],v[40:43],v[168:171]
buffer_load_dwordx4 v4, s[8:11], s21 offen offset:1024 sc1 lds
M v[176:179],a[112:115],v[40:43],0
W a180,v212
W a181,v213
M v[176:179],a[116:119],v[56:59],v[176:179]
R a[88:91],v16,22528
R a[92:95],v16,23552
M v[180:183],a[116:119],v[60:63],0
buffer_load_dwordx4 v4, s[8:11], s21 offen offset:2048 sc1 lds
M v[180:183],a[112:115],v[44:47],v[180:183]
W a182,v214
W a183,v215
M v[188:191],a[120:123],v[44:47],0
W a184,v216
W a185,v217
W a186,v218
W a187,v219
W a188,v220
W a189,v221
W a190,v222
W a191,v223
M v[188:191],a[124:127],v[60:63],v[188:191]
E v18,v96
M v[184:187],a[124:127],v[56:59],0
buffer_load_dwordx4 v4, s[8:11], s21 offen offset:3072 sc1 lds
M v[184:187],a[120:123],v[40:43],v[184:187]
s_waitcnt lgkmcnt(0)
v_min_u32 v17, 1, v7
v_lshlrev_b32 v17, 29, v17
M v[192:195],a[64:67],v[40:43],0
SA s21,s21,32768
R a[96:99],v16,24576
R a[100:103],v16,25600
M v[192:195],a[68:71],v[56:59],v[192:195]
s_sub_u32 s22, s22, 1
buffer_store_dwordx4 a[132:135], v7, s[8:11], s3 offen offset:2048 sc1
M v[196:199],a[68:71],v[60:63],0
s_cselect_b32 s21, s23, s21
v_mov_b32 v15, 1
AF v30,v26,v30
M v[196:199],a[64:67],v[44:47],v[196:199]
SA s84,s47,16
R a[104:107],v16,26624
R a[108:111],v16,27648
M v[204:207],a[72:75],v[44:47],0
E v19,v97
M v[204:207],a[76:79],v[60:63],v[204:207]
E v20,v98
M v[200:203],a[76:79],v[56:59],0
R a[112:115],v16,28672
R a[116:119],v16,29696
M v[200:203],a[72:75],v[40:43],v[200:203]
E v21,v99
M v[208:211],a[80:83],v[40:43],0
E v22,v104
M v[208:211],a[84:87],v[56:59],v[208:211]
R a[120:123],v16,30720
R a[124:127],v16,31744
M v[212:215],a[84:87],v[60:63],0
SA s3,s93,266240
E v23,v105
M v[212:215],a[80:83],v[44:47],v[212:215]
buffer_store_dwordx4 a[136:139], v7, s[8:11], s3 offen offset:0 sc1
M v[220:223],a[88:91],v[44:47],0
AF v31,v27,v31
AF v28,v18,v19
M v[220:223],a[92:95],v[60:63],v[220:223]
E v24,v106
M v[216:219],a[92:95],v[56:59],0
s_waitcnt vmcnt(11) lgkmcnt(0)
E v25,v107
M v[216:219],a[88:91],v[40:43],v[216:219]
s_barrier
M v[224:227],a[96:99],v[40:43],0
R a[64:67],v2,32768
R a[68:71],v2,33792
M v[224:227],a[100:103],v[56:59],v[224:227]
buffer_store_dword v15, v17, s[8:11], s84 offen sc1
M v[228:231],a[100:103],v[60:63],0
C v48,v18,v19
AF v28,v20,v28
M v[228:231],a[96:99],v[44:47],v[228:231]
R a[72:75],v2,34816
R a[76:79],v2,35840
M v[236:239],a[104:107],v[44:47],0
E v18,v100
M v[236:239],a[108:111],v[60:63],v[236:239]
E v19,v101
M v[232:235],a[108:111],v[56:59],0
R a[80:83],v2,36864
R a[84:87],v2,37888
M v[232:235],a[104:107],v[40:43],v[232:235]
C v49,v20,v21
AF v28,v21,v28
M v[240:243],a[112:115],v[40:43],0
E v20,v102
M v[240:243],a[116:119],v[56:59],v[240:243]
R a[88:91],v2,38912
R a[92:95],v2,39936
M v[244:247],a[116:119],v[60:63],0
E v21,v103
M v[244:247],a[112:115],v[44:47],v[244:247]
AF v28,v22,v28
C v50,v22,v23
M v[252:255],a[120:123],v[44:47],0
AF v28,v23,v28
AF v28,v24,v28
M v[252:255],a[124:127],v[60:63],v[252:255]
E v22,v108
M v[248:251],a[124:127],v[56:59],0
s_waitcnt lgkmcnt(0)
E v23,v109
M v[248:251],a[120:123],v[40:43],v[248:251]
C v51,v24,v25
AF v28,v25,v28
AF v29,v18,v19
C v52,v18,v19
AF v29,v20,v29
C v53,v20,v21
AF v29,v21,v29
E v24,v110
E v25,v111
AF v29,v22,v29
C v54,v22,v23
AF v29,v23,v29
AF v29,v24,v29
C v55,v24,v25
AF v29,v25,v29
M v[64:67],a[64:67],a[0:3],v[32:35]
R a[96:99],v2,40960
R a[100:103],v2,41984
M v[64:67],a[68:71],a[4:7],v[64:67]
SA m0,s28,0
E v18,v112
M v[64:67],a[72:75],a[8:11],v[64:67]
buffer_load_dwordx4 v3, s[8:11], s26 offen offset:0 sc1 lds
M v[64:67],a[76:79],a[12:15],v[64:67]
R a[104:107],v2,43008
R a[108:111],v2,44032
M v[64:67],a[80:83],a[16:19],v[64:67]
E v19,v113
M v[64:67],a[84:87],a[20:23],v[64:67]
AF v28,v18,v28
C v56,v18,v19
M v[64:67],a[88:91],a[24:27],v[64:67]
R a[112:115],v2,45056
R a[116:119],v2,46080
M v[64:67],a[92:95],a[28:31],v[64:67]
buffer_load_dwordx4 v3, s[8:11], s26 offen offset:1024 sc1 lds
M v[68:71],a[92:95],a[60:63],v[36:39]
E v20,v114
M v[68:71],a[88:91],a[56:59],v[68:71]
R a[120:123],v2,47104
R a[124:127],v2,48128
M v[68:71],a[84:87],a[52:55],v[68:71]
SA s3,s93,266240
E v21,v115
M v[68:71],a[80:83],a[48:51],v[68:71]
buffer_load_dwordx4 v3, s[8:11], s26 offen offset:2048 sc1 lds
M v[68:71],a[76:79],a[44:47],v[68:71]
AF v28,v19,v28
AF v28,v20,v28
M v[68:71],a[72:75],a[40:43],v[68:71]
C v57,v20,v21
AF v28,v21,v28
M v[68:71],a[68:71],a[36:39],v[68:71]
buffer_store_dwordx4 a[140:143], v7, s[8:11], s3 offen offset:2048 sc1
M v[68:71],a[64:67],a[32:35],v[68:71]
s_waitcnt lgkmcnt(0)
E v22,v120
M v[76:79],a[96:99],a[32:35],v[36:39]
R a[64:67],v2,49152
R a[68:71],v2,50176
M v[76:79],a[100:103],a[36:39],v[76:79]
buffer_load_dwordx4 v3, s[8:11], s26 offen offset:3072 sc1 lds
M v[76:79],a[104:107],a[40:43],v[76:79]
SA m0,s28,4096
E v23,v121
M v[76:79],a[108:111],a[44:47],v[76:79]
R a[72:75],v2,51200
R a[76:79],v2,52224
M v[76:79],a[112:115],a[48:51],v[76:79]
buffer_load_dwordx4 v4, s[8:11], s26 offen offset:0 sc1 lds
M v[76:79],a[116:119],a[52:55],v[76:79]
E v24,v122
M v[76:79],a[120:123],a[56:59],v[76:79]
R a[80:83],v2,53248
R a[84:87],v2,54272
M v[76:79],a[124:127],a[60:63],v[76:79]
buffer_load_dwordx4 v4, s[8:11], s26 offen offset:1024 sc1 lds
M v[72:75],a[124:127],a[28:31],v[32:35]
E v25,v123
M v[72:75],a[120:123],a[24:27],v[72:75]
SA s3,s93,270336
R a[88:91],v2,55296
R a[92:95],v2,56320
M v[72:75],a[116:119],a[20:23],v[72:75]
buffer_load_dwordx4 v4, s[8:11], s26 offen offset:2048 sc1 lds
M v[72:75],a[112:115],a[16:19],v[72:75]
AF v28,v22,v28
C v58,v22,v23
M v[72:75],a[108:111],a[12:15],v[72:75]
E v18,v116
M v[72:75],a[104:107],a[8:11],v[72:75]
AF v28,v23,v28
AF v28,v24,v28
M v[72:75],a[100:103],a[4:7],v[72:75]
buffer_load_dwordx4 v4, s[8:11], s26 offen offset:3072 sc1 lds
M v[72:75],a[96:99],a[0:3],v[72:75]
s_waitcnt lgkmcnt(0)
E v19,v117
M v[80:83],a[64:67],a[0:3],v[32:35]
SA s26,s26,32768
R a[96:99],v2,57344
R a[100:103],v2,58368
M v[80:83],a[68:71],a[4:7],v[80:83]
buffer_store_dwordx4 a[144:147], v7, s[8:11], s3 offen offset:0 sc1
M v[80:83],a[72:75],a[8:11],v[80:83]
C v59,v24,v25
AF v28,v25,v28
M v[80:83],a[76:79],a[12:15],v[80:83]
R a[104:107],v2,59392
R a[108:111],v2,60416
M v[80:83],a[80:83],a[16:19],v[80:83]
E v20,v118
M v[80:83],a[84:87],a[20:23],v[80:83]
AF v29,v18,v29
C v60,v18,v19
M v[80:83],a[88:91],a[24:27],v[80:83]
R a[112:115],v2,61440
R a[116:119],v2,62464
M v[80:83],a[92:95],a[28:31],v[80:83]
E v21,v119
M v[84:87],a[92:95],a[60:63],v[36:39]
AF v29,v19,v29
AF v29,v20,v29
M v[84:87],a[88:91],a[56:59],v[84:87]
R a[120:123],v2,63488
R a[124:127],v2,64512
M v[84:87],a[84:87],a[52:55],v[84:87]
E v22,v124
M v[84:87],a[80:83],a[48:51],v[84:87]
buffer_store_dwordx4 a[148:151], v7, s[8:11], s3 offen offset:2048 sc1
M v[84:87],a[76:79],a[44:47],v[84:87]
C v61,v20,v21
AF v29,v21,v29
M v[84:87],a[72:75],a[40:43],v[84:87]
E v23,v125
M v[84:87],a[68:71],a[36:39],v[84:87]
s_waitcnt lgkmcnt(0)
AF v29,v22,v29
C v62,v22,v23
M v[84:87],a[64:67],a[32:35],v[84:87]
s_barrier
M v[92:95],a[96:99],a[32:35],v[36:39]
R a[64:67],v7,32768
R a[68:71],v7,33792
M v[92:95],a[100:103],a[36:39],v[92:95]
E v24,v126
M v[92:95],a[104:107],a[40:43],v[92:95]
AF v29,v23,v29
M v[92:95],a[108:111],a[44:47],v[92:95]
R a[72:75],v7,34816
R a[76:79],v7,35840
M v[92:95],a[112:115],a[48:51],v[92:95]
E v25,v127
M v[92:95],a[116:119],a[52:55],v[92:95]
AF v29,v24,v29
C v63,v24,v25
M v[92:95],a[120:123],a[56:59],v[92:95]
R a[80:83],v7,36864
R a[84:87],v7,37888
M v[92:95],a[124:127],a[60:63],v[92:95]
AF v29,v25,v29
M v[88:91],a[124:127],a[28:31],v[32:35]
M v[88:91],a[120:123],a[24:27],v[88:91]
R a[88:91],v7,38912
R a[92:95],v7,39936
M v[88:91],a[116:119],a[20:23],v[88:91]
v_max_f32 v10, v28, v29
M v[88:91],a[112:115],a[16:19],v[88:91]
v_cmp_lt_f32 vcc, s31, v10
M v[88:91],a[108:111],a[12:15],v[88:91]
M v[88:91],a[104:107],a[8:11],v[88:91]
M v[88:91],a[100:103],a[4:7],v[88:91]
s_waitcnt lgkmcnt(0)
M v[88:91],a[96:99],a[0:3],v[88:91]
s_cbranch_vccnz L_stv2
L_rtv2:
M v[128:131],a[64:67],v[48:51],v[128:131]
R a[96:99],v7,40960
R a[100:103],v7,41984
M v[128:131],a[68:71],v[56:59],v[128:131]
SA m0,s28,98304
E v18,v64
M v[132:135],a[68:71],v[60:63],v[132:135]
buffer_load_dwordx4 v3, s[8:11], s21 offen offset:0 sc1 lds
M v[132:135],a[64:67],v[52:55],v[132:135]
R a[104:107],v7,43008
R a[108:111],v7,44032
M v[140:143],a[72:75],v[52:55],v[140:143]
E v19,v65
M v[140:143],a[76:79],v[60:63],v[140:143]
AF v30,v28,v30
AF v31,v29,v31
M v[136:139],a[76:79],v[56:59],v[136:139]
R a[112:115],v7,45056
R a[116:119],v7,46080
M v[136:139],a[72:75],v[48:51],v[136:139]
buffer_load_dwordx4 v3, s[8:11], s21 offen offset:1024 sc1 lds
M v[144:147],a[80:83],v[48:51],v[144:147]
E v20,v66
M v[144:147],a[84:87],v[56:59],v[144:147]
R a[120:123],v7,47104
R a[124:127],v7,48128
M v[148:151],a[84:87],v[60:63],v[148:151]
SA s3,s93,274432
AF v26,v18,v19
C v40,v18,v19
M v[148:151],a[80:83],v[52:55],v[148:151]
buffer_load_dwordx4 v3, s[8:11], s21 offen offset:2048 sc1 lds
M v[156:159],a[88:91],v[52:55],v[156:159]
E v21,v67
M v[156:159],a[92:95],v[60:63],v[156:159]
AF v26,v20,v26
C v41,v20,v21
M v[152:155],a[92:95],v[56:59],v[152:155]
buffer_store_dwordx4 a[152:155], v7, s[8:11], s3 offen offset:0 sc1
M v[152:155],a[88:91],v[48:51],v[152:155]
s_waitcnt lgkmcnt(0)
E v22,v72
M v[160:163],a[96:99],v[48:51],v[160:163]
R a[64:67],v7,49152
R a[68:71],v7,50176
M v[160:163],a[100:103],v[56:59],v[160:163]
buffer_load_dwordx4 v3, s[8:11], s21 offen offset:3072 sc1 lds
M v[164:167],a[100:103],v[60:63],v[164:167]
SA m0,s28,102400
E v23,v73
M v[164:167],a[96:99],v[52:55],v[164:167]
R a[72:75],v7,51200
R a[76:79],v7,52224
M v[172:175],a[104:107],v[52:55],v[172:175]
buffer_load_dwordx4 v4, s[8:11], s21 offen offset:0 sc1 lds
M v[172:175],a[108:111],v[60:63],v[172:175]
AF v26,v21,v26
AF v26,v22,v26
M v[168:171],a[108:111],v[56:59],v[168:171]
R a[80:83],v7,53248
R a[84:87],v7,54272
M v[168:171],a[104:107],v[48:51],v[168:171]
buffer_load_dwordx4 v4, s[8:11], s21 offen offset:1024 sc1 lds
M v[176:179],a[112:115],v[48:51],v[176:179]
E v24,v74
M v[176:179],a[116:119],v[56:59],v[176:179]
R a[88:91],v7,55296
R a[92:95],v7,56320
M v[180:183],a[116:119],v[60:63],v[180:183]
buffer_load_dwordx4 v4, s[8:11], s21 offen offset:2048 sc1 lds
M v[180:183],a[112:115],v[52:55],v[180:183]
E v25,v75
M v[188:191],a[120:123],v[52:55],v[188:191]
C v42,v22,v23
AF v26,v23,v26
M v[188:191],a[124:127],v[60:63],v[188:191]
AF v26,v24,v26
C v43,v24,v25
M v[184:187],a[124:127],v[56:59],v[184:187]
buffer_load_dwordx4 v4, s[8:11], s21 offen offset:3072 sc1 lds
M v[184:187],a[120:123],v[48:51],v[184:187]
s_waitcnt lgkmcnt(0)
E v18,v68
M v[192:195],a[64:67],v[48:51],v[192:195]
SA s21,s21,32768
R a[96:99],v7,57344
R a[100:103],v7,58368
M v[192:195],a[68:71],v[56:59],v[192:195]
s_sub_u32 s22, s22, 1
buffer_store_dwordx4 a[156:159], v7, s[8:11], s3 offen offset:2048 sc1
M v[196:199],a[68:71],v[60:63],v[196:199]
s_cselect_b32 s21, s23, s21
E v19,v69
M v[196:199],a[64:67],v[52:55],v[196:199]
R a[104:107],v7,59392
R a[108:111],v7,60416
M v[204:207],a[72:75],v[52:55],v[204:207]
AF v26,v25,v26
AF v27,v18,v19
M v[204:207],a[76:79],v[60:63],v[204:207]
E v20,v70
M v[200:203],a[76:79],v[56:59],v[200:203]
R a[112:115],v7,61440
R a[116:119],v7,62464
M v[200:203],a[72:75],v[48:51],v[200:203]
C v44,v18,v19
M v[208:211],a[80:83],v[48:51],v[208:211]
M v[208:211],a[84:87],v[56:59],v[208:211]
R a[120:123],v7,63488
R a[124:127],v7,64512
M v[212:215],a[84:87],v[60:63],v[212:215]
SA s3,s93,786432
E v21,v71
M v[212:215],a[80:83],v[52:55],v[212:215]
buffer_store_dwordx4 a[160:163], v7, s[8:11], s3 offen offset:0 sc1
M v[220:223],a[88:91],v[52:55],v[220:223]
AF v27,v20,v27
C v45,v20,v21
M v[220:223],a[92:95],v[60:63],v[220:223]
E v22,v76
M v[216:219],a[92:95],v[56:59],v[216:219]
s_waitcnt vmcnt(25) lgkmcnt(0)
AF v27,v21,v27
M v[216:219],a[88:91],v[48:51],v[216:219]
s_barrier
M v[224:227],a[96:99],v[48:51],v[224:227]
R a[64:67],v2,0
R a[68:71],v2,1024
M v[224:227],a[100:103],v[56:59],v[224:227]
E v23,v77
M v[228:231],a[100:103],v[60:63],v[228:231]
AF v27,v22,v27
C v46,v22,v23
M v[228:231],a[96:99],v[52:55],v[228:231]
R a[72:75],v2,2048
R a[76:79],v2,3072
M v[236:239],a[104:107],v[52:55],v[236:239]
E v24,v78
M v[236:239],a[108:111],v[60:63],v[236:239]
AF v27,v23,v27
M v[232:235],a[108:111],v[56:59],v[232:235]
R a[80:83],v2,4096
R a[84:87],v2,5120
M v[232:235],a[104:107],v[48:51],v[232:235]
M v[240:243],a[112:115],v[48:51],v[240:243]
E v25,v79
M v[240:243],a[116:119],v[56:59],v[240:243]
R a[88:91],v2,6144
R a[92:95],v2,7168
M v[244:247],a[116:119],v[60:63],v[244:247]
AF v27,v24,v27
C v47,v24,v25
M v[244:247],a[112:115],v[52:55],v[244:247]
AF v27,v25,v27
M v[252:255],a[120:123],v[52:55],v[252:255]
M v[252:255],a[124:127],v[60:63],v[252:255]
M v[248:251],a[124:127],v[56:59],v[248:251]
s_waitcnt lgkmcnt(0)
M v[248:251],a[120:123],v[48:51],v[248:251]
M v[96:99],a[64:67],a[0:3],v[32:35]
R a[96:99],v2,8192
R a[100:103],v2,9216
M v[96:99],a[68:71],a[4:7],v[96:99]
SA m0,s28,32768
E v18,v80
M v[96:99],a[72:75],a[8:11],v[96:99]
buffer_load_dwordx4 v3, s[8:11], s26 offen offset:0 sc1 lds
M v[96:99],a[76:79],a[12:15],v[96:99]
R a[104:107],v2,10240
R a[108:111],v2,11264
M v[96:99],a[80:83],a[16:19],v[96:99]
E v19,v81
M v[96:99],a[84:87],a[20:23],v[96:99]
AF v26,v18,v26
C v56,v18,v19
M v[96:99],a[88:91],a[24:27],v[96:99]
R a[112:115],v2,12288
R a[116:119],v2,13312
M v[96:99],a[92:95],a[28:31],v[96:99]
buffer_load_dwordx4 v3, s[8:11], s26 offen offset:1024 sc1 lds
M v[100:103],a[92:95],a[60:63],v[36:39]
E v20,v82
M v[100:103],a[88:91],a[56:59],v[100:103]
R a[120:123],v2,14336
R a[124:127],v2,15360
M v[100:103],a[84:87],a[52:55],v[100:103]
SA s3,s93,786432
E v21,v83
M v[100:103],a[80:83],a[48:51],v[100:103]
buffer_load_dwordx4 v3, s[8:11], s26 offen offset:2048 sc1 lds
M v[100:103],a[76:79],a[44:47],v[100:103]
AF v26,v19,v26
AF v26,v20,v26
M v[100:103],a[72:75],a[40:43],v[100:103]
C v57,v20,v21
AF v26,v21,v26
M v[100:103],a[68:71],a[36:39],v[100:103]
buffer_store_dwordx4 a[164:167], v7, s[8:11], s3 offen offset:2048 sc1
M v[100:103],a[64:67],a[32:35],v[100:103]
s_waitcnt lgkmcnt(0)
E v22,v88
M v[108:111],a[96:99],a[32:35],v[36:39]
R a[64:67],v2,16384
R a[68:71],v2,17408
M v[108:111],a[100:103],a[36:39],v[108:111]
buffer_load_dwordx4 v3, s[8:11], s26 offen offset:3072 sc1 lds
M v[108:111],a[104:107],a[40:43],v[108:111]
SA m0,s28,36864
E v23,v89
M v[108:111],a[108:111],a[44:47],v[108:111]
R a[72:75],v2,18432
R a[76:79],v2,19456
M v[108:111],a[112:115],a[48:51],v[108:111]
buffer_load_dwordx4 v4, s[8:11], s26 offen offset:0 sc1 lds
M v[108:111],a[116:119],a[52:55],v[108:111]
SA s3,s93,790528
E v24,v90
M v[108:111],a[120:123],a[56:59],v[108:111]
R a[80:83],v2,20480
R a[84:87],v2,21504
M v[108:111],a[124:127],a[60:63],v[108:111]
buffer_load_dwordx4 v4, s[8:11], s26 offen offset:1024 sc1 lds
M v[104:107],a[124:127],a[28:31],v[32:35]
E v25,v91
M v[104:107],a[120:123],a[24:27],v[104:107]
R a[88:91],v2,22528
R a[92:95],v2,23552
M v[104:107],a[116:119],a[20:23],v[104:107]
buffer_load_dwordx4 v4, s[8:11], s26 offen offset:2048 sc1 lds
M v[104:107],a[112:115],a[16:19],v[104:107]
AF v26,v22,v26
C v58,v22,v23
M v[104:107],a[108:111],a[12:15],v[104:107]
E v18,v84
M v[104:107],a[104:107],a[8:11],v[104:107]
buffer_store_dwordx4 a[168:171], v7, s[8:11], s3 offen offset:0 sc1
M v[104:107],a[100:103],a[4:7],v[104:107]
AF v26,v23,v26
AF v26,v24,v26
M v[104:107],a[96:99],a[0:3],v[104:107]
s_waitcnt lgkmcnt(0)
E v19,v85
M v[112:115],a[64:67],a[0:3],v[32:35]
R a[96:99],v2,24576
R a[100:103],v2,25600
M v[112:115],a[68:71],a[4:7],v[112:115]
buffer_load_dwordx4 v4, s[8:11], s26 offen offset:3072 sc1 lds
M v[112:115],a[72:75],a[8:11],v[112:115]
SA s26,s26,32768
C v59,v24,v25
AF v26,v25,v26
M v[112:115],a[76:79],a[12:15],v[112:115]
R a[104:107],v2,26624
R a[108:111],v2,27648
M v[112:115],a[80:83],a[16:19],v[112:115]
E v20,v86
M v[112:115],a[84:87],a[20:23],v[112:115]
buffer_store_dwordx4 a[172:175], v7, s[8:11], s3 offen offset:2048 sc1
M v[112:115],a[88:91],a[24:27],v[112:115]
R a[112:115],v2,28672
R a[116:119],v2,29696
M v[112:115],a[92:95],a[28:31],v[112:115]
E v21,v87
M v[116:119],a[92:95],a[60:63],v[36:39]
AF v27,v18,v27
C v60,v18,v19
M v[116:119],a[88:91],a[56:59],v[116:119]
R a[120:123],v2,30720
R a[124:127],v2,31744
M v[116:119],a[84:87],a[52:55],v[116:119]
E v22,v92
M v[116:119],a[80:83],a[48:51],v[116:119]
AF v27,v19,v27
AF v27,v20,v27
M v[116:119],a[76:79],a[44:47],v[116:119]
C v61,v20,v21
AF v27,v21,v27
M v[116:119],a[72:75],a[40:43],v[116:119]
E v23,v93
M v[116:119],a[68:71],a[36:39],v[116:119]
s_waitcnt vmcnt(24) lgkmcnt(0)
AF v27,v22,v27
C v62,v22,v23
M v[116:119],a[64:67],a[32:35],v[116:119]
s_barrier
M v[124:127],a[96:99],a[32:35],v[36:39]
SA s3,s93,794624
R a[64:67],v7,0
R a[68:71],v7,1024
M v[124:127],a[100:103],a[36:39],v[124:127]
buffer_store_dwordx4 a[176:179], v7, s[8:11], s3 offen offset:0 sc1
M v[124:127],a[104:107],a[40:43],v[124:127]
E v24,v94
M v[124:127],a[108:111],a[44:47],v[124:127]
R a[72:75],v7,2048
R a[76:79],v7,3072
M v[124:127],a[112:115],a[48:51],v[124:127]
E v25,v95
M v[124:127],a[116:119],a[52:55],v[124:127]
AF v27,v23,v27
AF v27,v24,v27
M v[124:127],a[120:123],a[56:59],v[124:127]
R a[80:83],v7,4096
R a[84:87],v7,5120
M v[124:127],a[124:127],a[60:63],v[124:127]
C v63,v24,v25
AF v27,v25,v27
M v[120:123],a[124:127],a[28:31],v[32:35]
M v[120:123],a[120:123],a[24:27],v[120:123]
R a[88:91],v7,6144
R a[92:95],v7,7168
M v[120:123],a[116:119],a[20:23],v[120:123]
v_max_f32 v10, v26, v27
M v[120:123],a[112:115],a[16:19],v[120:123]
v_cmp_lt_f32 vcc, s31, v10
M v[120:123],a[108:111],a[12:15],v[120:123]
M v[120:123],a[104:107],a[8:11],v[120:123]
M v[120:123],a[100:103],a[4:7],v[120:123]
s_waitcnt lgkmcnt(0)
M v[120:123],a[96:99],a[0:3],v[120:123]
s_cbranch_vccnz L_stv3
L_rtv3:
M v[128:131],a[64:67],v[40:43],v[128:131]
R a[96:99],v7,8192
R a[100:103],v7,9216
M v[128:131],a[68:71],v[56:59],v[128:131]
SA m0,s28,65536
E v18,v96
M v[132:135],a[68:71],v[60:63],v[132:135]
buffer_load_dwordx4 v3, s[8:11], s21 offen offset:0 sc1 lds
M v[132:135],a[64:67],v[44:47],v[132:135]
R a[104:107],v7,10240
R a[108:111],v7,11264
M v[140:143],a[72:75],v[44:47],v[140:143]
E v19,v97
M v[140:143],a[76:79],v[60:63],v[140:143]
AF v30,v26,v30
AF v31,v27,v31
M v[136:139],a[76:79],v[56:59],v[136:139]
R a[112:115],v7,12288
R a[116:119],v7,13312
M v[136:139],a[72:75],v[40:43],v[136:139]
buffer_load_dwordx4 v3, s[8:11], s21 offen offset:1024 sc1 lds
M v[144:147],a[80:83],v[40:43],v[144:147]
E v20,v98
M v[144:147],a[84:87],v[56:59],v[144:147]
R a[120:123],v7,14336
R a[124:127],v7,15360
M v[148:151],a[84:87],v[60:63],v[148:151]
SA s3,s93,794624
AF v28,v18,v19
C v48,v18,v19
M v[148:151],a[80:83],v[44:47],v[148:151]
buffer_load_dwordx4 v3, s[8:11], s21 offen offset:2048 sc1 lds
M v[156:159],a[88:91],v[44:47],v[156:159]
E v21,v99
M v[156:159],a[92:95],v[60:63],v[156:159]
AF v28,v20,v28
C v49,v20,v21
M v[152:155],a[92:95],v[56:59],v[152:155]
buffer_store_dwordx4 a[180:183], v7, s[8:11], s3 offen offset:2048 sc1
M v[152:155],a[88:91],v[40:43],v[152:155]
s_waitcnt lgkmcnt(0)
E v22,v104
M v[160:163],a[96:99],v[40:43],v[160:163]
R a[64:67],v7,16384
R a[68:71],v7,17408
M v[160:163],a[100:103],v[56:59],v[160:163]
buffer_load_dwordx4 v3, s[8:11], s21 offen offset:3072 sc1 lds
M v[164:167],a[100:103],v[60:63],v[164:167]
SA m0,s28,69632
E v23,v105
M v[164:167],a[96:99],v[44:47],v[164:167]
R a[72:75],v7,18432
R a[76:79],v7,19456
M v[172:175],a[104:107],v[44:47],v[172:175]
buffer_load_dwordx4 v4, s[8:11], s21 offen offset:0 sc1 lds
M v[172:175],a[108:111],v[60:63],v[172:175]
AF v28,v21,v28
AF v28,v22,v28
M v[168:171],a[108:111],v[56:59],v[168:171]
R a[80:83],v7,20480
R a[84:87],v7,21504
M v[168:171],a[104:107],v[40:43],v[168:171]
buffer_load_dwordx4 v4, s[8:11], s21 offen offset:1024 sc1 lds
M v[176:179],a[112:115],v[40:43],v[176:179]
E v24,v106
M v[176:179],a[116:119],v[56:59],v[176:179]
SA s3,s93,798720
R a[88:91],v7,22528
R a[92:95],v7,23552
M v[180:183],a[116:119],v[60:63],v[180:183]
buffer_load_dwordx4 v4, s[8:11], s21 offen offset:2048 sc1 lds
M v[180:183],a[112:115],v[44:47],v[180:183]
E v25,v107
M v[188:191],a[120:123],v[44:47],v[188:191]
C v50,v22,v23
AF v28,v23,v28
M v[188:191],a[124:127],v[60:63],v[188:191]
AF v28,v24,v28
C v51,v24,v25
M v[184:187],a[124:127],v[56:59],v[184:187]
buffer_load_dwordx4 v4, s[8:11], s21 offen offset:3072 sc1 lds
M v[184:187],a[120:123],v[40:43],v[184:187]
s_waitcnt lgkmcnt(0)
E v18,v100
M v[192:195],a[64:67],v[40:43],v[192:195]
SA s21,s21,32768
R a[96:99],v7,24576
R a[100:103],v7,25600
M v[192:195],a[68:71],v[56:59],v[192:195]
s_sub_u32 s22, s22, 1
buffer_store_dwordx4 a[184:187], v7, s[8:11], s3 offen offset:0 sc1
M v[196:199],a[68:71],v[60:63],v[196:199]
s_cselect_b32 s21, s23, s21
E v19,v101
M v[196:199],a[64:67],v[44:47],v[196:199]
R a[104:107],v7,26624
R a[108:111],v7,27648
M v[204:207],a[72:75],v[44:47],v[204:207]
AF v28,v25,v28
AF v29,v18,v19
M v[204:207],a[76:79],v[60:63],v[204:207]
E v20,v102
M v[200:203],a[76:79],v[56:59],v[200:203]
R a[112:115],v7,28672
R a[116:119],v7,29696
M v[200:203],a[72:75],v[40:43],v[200:203]
C v52,v18,v19
M v[208:211],a[80:83],v[40:43],v[208:211]
M v[208:211],a[84:87],v[56:59],v[208:211]
R a[120:123],v7,30720
R a[124:127],v7,31744
M v[212:215],a[84:87],v[60:63],v[212:215]
E v21,v103
M v[212:215],a[80:83],v[44:47],v[212:215]
buffer_store_dwordx4 a[188:191], v7, s[8:11], s3 offen offset:2048 sc1
M v[220:223],a[88:91],v[44:47],v[220:223]
AF v29,v20,v29
C v53,v20,v21
M v[220:223],a[92:95],v[60:63],v[220:223]
E v22,v108
M v[216:219],a[92:95],v[56:59],v[216:219]
s_waitcnt vmcnt(25) lgkmcnt(0)
AF v29,v21,v29
M v[216:219],a[88:91],v[40:43],v[216:219]
s_barrier
M v[224:227],a[96:99],v[40:43],v[224:227]
R a[64:67],v2,32768
R a[68:71],v2,33792
M v[224:227],a[100:103],v[56:59],v[224:227]
E v23,v109
M v[228:231],a[100:103],v[60:63],v[228:231]
AF v29,v22,v29
C v54,v22,v23
M v[228:231],a[96:99],v[44:47],v[228:231]
R a[72:75],v2,34816
R a[76:79],v2,35840
M v[236:239],a[104:107],v[44:47],v[236:239]
E v24,v110
M v[236:239],a[108:111],v[60:63],v[236:239]
AF v29,v23,v29
M v[232:235],a[108:111],v[56:59],v[232:235]
R a[80:83],v2,36864
R a[84:87],v2,37888
M v[232:235],a[104:107],v[40:43],v[232:235]
M v[240:243],a[112:115],v[40:43],v[240:243]
E v25,v111
M v[240:243],a[116:119],v[56:59],v[240:243]
R a[88:91],v2,38912
R a[92:95],v2,39936
M v[244:247],a[116:119],v[60:63],v[244:247]
AF v29,v24,v29
C v55,v24,v25
M v[244:247],a[112:115],v[44:47],v[244:247]
AF v29,v25,v29
M v[252:255],a[120:123],v[44:47],v[252:255]
M v[252:255],a[124:127],v[60:63],v[252:255]
M v[248:251],a[124:127],v[56:59],v[248:251]
s_waitcnt lgkmcnt(0)
M v[248:251],a[120:123],v[40:43],v[248:251]
s_branch L_loop_top
L_st0:
s_call_b64 s[36:37], L_slow0
s_branch L_rt0
L_st1:
s_call_b64 s[36:37], L_slow1
s_branch L_rt1
L_stv1:
s_call_b64 s[36:37], L_slowf
s_branch L_rtv1
L_stk1:
s_call_b64 s[36:37], L_slowf
s_branch L_rtk1
L_sth1:
s_call_b64 s[36:37], L_slowf
s_branch L_rth1
L_stj0:
s_call_b64 s[36:37], L_slowj
s_branch L_rtj0
L_stv2:
s_call_b64 s[36:37], L_slow1
s_branch L_rtv2
L_stv3:
s_call_b64 s[36:37], L_slow0
s_branch L_rtv3
L_std1:
s_call_b64 s[36:37], L_slow1
s_branch L_rtd1
L_std3n:
s_call_b64 s[36:37], L_slow0
s_branch L_rtd3n
L_std3h:
s_call_b64 s[36:37], L_slow0
s_branch L_rtd3h
L_std4n:
s_call_b64 s[36:37], L_slowb
s_branch L_rtd4n
L_std4h:
s_call_b64 s[36:37], L_slowb
s_branch L_rtd4h
L_stfh:
s_call_b64 s[36:37], L_slow1n
s_branch L_rtfh
L_stc:
s_call_b64 s[36:37], L_comb
s_branch L_rtc
L_slow0:
s_nop 7
s_nop 3
v_max3_f32 v10, v64, v65, v66
v_max3_f32 v10, v67, v72, v10
v_max3_f32 v10, v73, v74, v10
v_max3_f32 v10, v75, v80, v10
v_max3_f32 v10, v81, v82, v10
v_max3_f32 v10, v83, v88, v10
v_max3_f32 v10, v89, v90, v10
v_max_f32 v10, v91, v10
v_max3_f32 v11, v68, v69, v70
v_max3_f32 v11, v71, v76, v11
v_max3_f32 v11, v77, v78, v11
v_max3_f32 v11, v79, v84, v11
v_max3_f32 v11, v85, v86, v11
v_max3_f32 v11, v87, v92, v11
v_max3_f32 v11, v93, v94, v11
v_max_f32 v11, v95, v11
v_mov_b32 v12, v10
v_mov_b32 v13, v11
s_nop 0
v_permlane16_swap_b32 v12, v10
v_permlane16_swap_b32 v13, v11
v_max_f32 v10, v12, v10
v_max_f32 v11, v13, v11
v_mov_b32 v12, v10
v_mov_b32 v13, v11
s_nop 0
v_permlane32_swap_b32 v12, v10
v_permlane32_swap_b32 v13, v11
v_max_f32 v10, v12, v10
v_max_f32 v11, v13, v11
v_ceil_f32 v10, v10
v_ceil_f32 v11, v11
v_max_f32 v10, 0, v10
v_max_f32 v11, 0, v11
v_sub_f32 v64, v64, v10
v_sub_f32 v65, v65, v10
v_sub_f32 v66, v66, v10
v_sub_f32 v67, v67, v10
v_sub_f32 v68, v68, v11
v_sub_f32 v69, v69, v11
v_sub_f32 v70, v70, v11
v_sub_f32 v71, v71, v11
v_sub_f32 v72, v72, v10
v_sub_f32 v73, v73, v10
v_sub_f32 v74, v74, v10
v_sub_f32 v75, v75, v10
v_sub_f32 v76, v76, v11
v_sub_f32 v77, v77, v11
v_sub_f32 v78, v78, v11
v_sub_f32 v79, v79, v11
v_sub_f32 v80, v80, v10
v_sub_f32 v81, v81, v10
v_sub_f32 v82, v82, v10
v_sub_f32 v83, v83, v10
v_sub_f32 v84, v84, v11
v_sub_f32 v85, v85, v11
v_sub_f32 v86, v86, v11
v_sub_f32 v87, v87, v11
v_sub_f32 v88, v88, v10
v_sub_f32 v89, v89, v10
v_sub_f32 v90, v90, v10
v_sub_f32 v91, v91, v10
v_sub_f32 v92, v92, v11
v_sub_f32 v93, v93, v11
v_sub_f32 v94, v94, v11
v_sub_f32 v95, v95, v11
v_sub_f32 v96, v96, v10
v_sub_f32 v97, v97, v10
v_sub_f32 v98, v98, v10
v_sub_f32 v99, v99, v10
v_sub_f32 v100, v100, v11
v_sub_f32 v101, v101, v11
v_sub_f32 v102, v102, v11
v_sub_f32 v103, v103, v11
v_sub_f32 v104, v104, v10
v_sub_f32 v105, v105, v10
v_sub_f32 v106, v106, v10
v_sub_f32 v107, v107, v10
v_sub_f32 v108, v108, v11
v_sub_f32 v109, v109, v11
v_sub_f32 v110, v110, v11
v_sub_f32 v111, v111, v11
v_sub_f32 v112, v112, v10
v_sub_f32 v113, v113, v10
v_sub_f32 v114, v114, v10
v_sub_f32 v115, v115, v10
v_sub_f32 v116, v116, v11
v_sub_f32 v117, v117, v11
v_sub_f32 v118, v118, v11
v_sub_f32 v119, v119, v11
v_sub_f32 v120, v120, v10
v_sub_f32 v121, v121, v10
v_sub_f32 v122, v122, v10
v_sub_f32 v123, v123, v10
v_sub_f32 v124, v124, v11
v_sub_f32 v125, v125, v11
v_sub_f32 v126, v126, v11
v_sub_f32 v127, v127, v11
v_sub_f32 v32, v32, v10
v_sub_f32 v33, v33, v10
v_sub_f32 v34, v34, v10
v_sub_f32 v35, v35, v10
v_sub_f32 v36, v36, v11
v_sub_f32 v37, v37, v11
v_sub_f32 v38, v38, v11
v_sub_f32 v39, v39, v11
E v12,-v10
E v13,-v11
MF v30,v12,v30
MF v31,v13,v31
MF v128,v12,v128
MF v129,v12,v129
MF v130,v12,v130
MF v131,v12,v131
MF v132,v13,v132
MF v133,v13,v133
MF v134,v13,v134
MF v135,v13,v135
MF v136,v12,v136
MF v137,v12,v137
MF v138,v12,v138
MF v139,v12,v139
MF v140,v13,v140
MF v141,v13,v141
MF v142,v13,v142
MF v143,v13,v143
MF v144,v12,v144
MF v145,v12,v145
MF v146,v12,v146
MF v147,v12,v147
MF v148,v13,v148
MF v149,v13,v149
MF v150,v13,v150
MF v151,v13,v151
MF v152,v12,v152
MF v153,v12,v153
MF v154,v12,v154
MF v155,v12,v155
MF v156,v13,v156
MF v157,v13,v157
MF v158,v13,v158
MF v159,v13,v159
MF v160,v12,v160
MF v161,v12,v161
MF v162,v12,v162
MF v163,v12,v163
MF v164,v13,v164
MF v165,v13,v165
MF v166,v13,v166
MF v167,v13,v167
MF v168,v12,v168
MF v169,v12,v169
MF v170,v12,v170
MF v171,v12,v171
MF v172,v13,v172
MF v173,v13,v173
MF v174,v13,v174
MF v175,v13,v175
MF v176,v12,v176
MF v177,v12,v177
MF v178,v12,v178
MF v179,v12,v179
MF v180,v13,v180
MF v181,v13,v181
MF v182,v13,v182
MF v183,v13,v183
MF v184,v12,v184
MF v185,v12,v185
MF v186,v12,v186
MF v187,v12,v187
MF v188,v13,v188
MF v189,v13,v189
MF v190,v13,v190
MF v191,v13,v191
MF v192,v12,v192
MF v193,v12,v193
MF v194,v12,v194
MF v195,v12,v195
MF v196,v13,v196
MF v197,v13,v197
MF v198,v13,v198
MF v199,v13,v199
MF v200,v12,v200
MF v201,v12,v201
MF v202,v12,v202
MF v203,v12,v203
MF v204,v13,v204
MF v205,v13,v205
MF v206,v13,v206
MF v207,v13,v207
MF v208,v12,v208
MF v209,v12,v209
MF v210,v12,v210
MF v211,v12,v211
MF v212,v13,v212
MF v213,v13,v213
MF v214,v13,v214
MF v215,v13,v215
MF v216,v12,v216
MF v217,v12,v217
MF v218,v12,v218
MF v219,v12,v219
MF v220,v13,v220
MF v221,v13,v221
MF v222,v13,v222
MF v223,v13,v223
MF v224,v12,v224
MF v225,v12,v225
MF v226,v12,v226
MF v227,v12,v227
MF v228,v13,v228
MF v229,v13,v229
MF v230,v13,v230
MF v231,v13,v231
MF v232,v12,v232
MF v233,v12,v233
MF v234,v12,v234
MF v235,v12,v235
MF v236,v13,v236
MF v237,v13,v237
MF v238,v13,v238
MF v239,v13,v239
MF v240,v12,v240
MF v241,v12,v241
MF v242,v12,v242
MF v243,v12,v243
MF v244,v13,v244
MF v245,v13,v245
MF v246,v13,v246
MF v247,v13,v247
MF v248,v12,v248
MF v249,v12,v249
MF v250,v12,v250
MF v251,v12,v251
MF v252,v13,v252
MF v253,v13,v253
MF v254,v13,v254
MF v255,v13,v255
E v18,v64
E v19,v65
E v20,v66
AF v26,v18,v19
C v40,v18,v19
E v21,v67
E v22,v72
AF v26,v20,v26
C v41,v20,v21
E v23,v73
AF v26,v21,v26
E v24,v74
AF v26,v22,v26
C v42,v22,v23
E v25,v75
AF v26,v23,v26
E v18,v68
AF v26,v24,v26
C v43,v24,v25
E v19,v69
AF v26,v25,v26
E v20,v70
AF v27,v18,v19
C v44,v18,v19
E v21,v71
E v22,v76
AF v27,v20,v27
C v45,v20,v21
E v23,v77
AF v27,v21,v27
E v24,v78
AF v27,v22,v27
C v46,v22,v23
E v25,v79
AF v27,v23,v27
AF v27,v24,v27
C v47,v24,v25
AF v27,v25,v27
E v18,v80
E v19,v81
E v20,v82
AF v26,v18,v26
C v56,v18,v19
E v21,v83
AF v26,v19,v26
E v22,v88
AF v26,v20,v26
C v57,v20,v21
E v23,v89
AF v26,v21,v26
E v24,v90
AF v26,v22,v26
C v58,v22,v23
E v25,v91
AF v26,v23,v26
E v18,v84
AF v26,v24,v26
C v59,v24,v25
E v19,v85
AF v26,v25,v26
E v20,v86
AF v27,v18,v27
C v60,v18,v19
E v21,v87
AF v27,v19,v27
E v22,v92
AF v27,v20,v27
C v61,v20,v21
E v23,v93
AF v27,v21,v27
E v24,v94
AF v27,v22,v27
C v62,v22,v23
E v25,v95
AF v27,v23,v27
AF v27,v24,v27
C v63,v24,v25
AF v27,v25,v27
s_nop 3
s_setpc_b64 s[36:37]
L_slow1:
s_nop 7
s_nop 3
v_max3_f32 v10, v96, v97, v98
v_max3_f32 v10, v99, v104, v10
v_max3_f32 v10, v105, v106, v10
v_max3_f32 v10, v107, v112, v10
v_max3_f32 v10, v113, v114, v10
v_max3_f32 v10, v115, v120, v10
v_max3_f32 v10, v121, v122, v10
v_max_f32 v10, v123, v10
v_max3_f32 v11, v100, v101, v102
v_max3_f32 v11, v103, v108, v11
v_max3_f32 v11, v109, v110, v11
v_max3_f32 v11, v111, v116, v11
v_max3_f32 v11, v117, v118, v11
v_max3_f32 v11, v119, v124, v11
v_max3_f32 v11, v125, v126, v11
v_max_f32 v11, v127, v11
v_mov_b32 v12, v10
v_mov_b32 v13, v11
s_nop 0
v_permlane16_swap_b32 v12, v10
v_permlane16_swap_b32 v13, v11
v_max_f32 v10, v12, v10
v_max_f32 v11, v13, v11
v_mov_b32 v12, v10
v_mov_b32 v13, v11
s_nop 0
v_permlane32_swap_b32 v12, v10
v_permlane32_swap_b32 v13, v11
v_max_f32 v10, v12, v10
v_max_f32 v11, v13, v11
v_ceil_f32 v10, v10
v_ceil_f32 v11, v11
v_max_f32 v10, 0, v10
v_max_f32 v11, 0, v11
v_sub_f32 v96, v96, v10
v_sub_f32 v97, v97, v10
v_sub_f32 v98, v98, v10
v_sub_f32 v99, v99, v10
v_sub_f32 v100, v100, v11
v_sub_f32 v101, v101, v11
v_sub_f32 v102, v102, v11
v_sub_f32 v103, v103, v11
v_sub_f32 v104, v104, v10
v_sub_f32 v105, v105, v10
v_sub_f32 v106, v106, v10
v_sub_f32 v107, v107, v10
v_sub_f32 v108, v108, v11
v_sub_f32 v109, v109, v11
v_sub_f32 v110, v110, v11
v_sub_f32 v111, v111, v11
v_sub_f32 v112, v112, v10
v_sub_f32 v113, v113, v10
v_sub_f32 v114, v114, v10
v_sub_f32 v115, v115, v10
v_sub_f32 v116, v116, v11
v_sub_f32 v117, v117, v11
v_sub_f32 v118, v118, v11
v_sub_f32 v119, v119, v11
v_sub_f32 v120, v120, v10
v_sub_f32 v121, v121, v10
v_sub_f32 v122, v122, v10
v_sub_f32 v123, v123, v10
v_sub_f32 v124, v124, v11
v_sub_f32 v125, v125, v11
v_sub_f32 v126, v126, v11
v_sub_f32 v127, v127, v11
v_sub_f32 v64, v64, v10
v_sub_f32 v65, v65, v10
v_sub_f32 v66, v66, v10
v_sub_f32 v67, v67, v10
v_sub_f32 v68, v68, v11
v_sub_f32 v69, v69, v11
v_sub_f32 v70, v70, v11
v_sub_f32 v71, v71, v11
v_sub_f32 v72, v72, v10
v_sub_f32 v73, v73, v10
v_sub_f32 v74, v74, v10
v_sub_f32 v75, v75, v10
v_sub_f32 v76, v76, v11
v_sub_f32 v77, v77, v11
v_sub_f32 v78, v78, v11
v_sub_f32 v79, v79, v11
v_sub_f32 v80, v80, v10
v_sub_f32 v81, v81, v10
v_sub_f32 v82, v82, v10
v_sub_f32 v83, v83, v10
v_sub_f32 v84, v84, v11
v_sub_f32 v85, v85, v11
v_sub_f32 v86, v86, v11
v_sub_f32 v87, v87, v11
v_sub_f32 v88, v88, v10
v_sub_f32 v89, v89, v10
v_sub_f32 v90, v90, v10
v_sub_f32 v91, v91, v10
v_sub_f32 v92, v92, v11
v_sub_f32 v93, v93, v11
v_sub_f32 v94, v94, v11
v_sub_f32 v95, v95, v11
v_sub_f32 v32, v32, v10
v_sub_f32 v33, v33, v10
v_sub_f32 v34, v34, v10
v_sub_f32 v35, v35, v10
v_sub_f32 v36, v36, v11
v_sub_f32 v37, v37, v11
v_sub_f32 v38, v38, v11
v_sub_f32 v39, v39, v11
E v12,-v10
E v13,-v11
MF v30,v12,v30
MF v31,v13,v31
MF v128,v12,v128
MF v129,v12,v129
MF v130,v12,v130
MF v131,v12,v131
MF v132,v13,v132
MF v133,v13,v133
MF v134,v13,v134
MF v135,v13,v135
MF v136,v12,v136
MF v137,v12,v137
MF v138,v12,v138
MF v139,v12,v139
MF v140,v13,v140
MF v141,v13,v141
MF v142,v13,v142
MF v143,v13,v143
MF v144,v12,v144
MF v145,v12,v145
MF v146,v12,v146
MF v147,v12,v147
MF v148,v13,v148
MF v149,v13,v149
MF v150,v13,v150
MF v151,v13,v151
MF v152,v12,v152
MF v153,v12,v153
MF v154,v12,v154
MF v155,v12,v155
MF v156,v13,v156
MF v157,v13,v157
MF v158,v13,v158
MF v159,v13,v159
MF v160,v12,v160
MF v161,v12,v161
MF v162,v12,v162
MF v163,v12,v163
MF v164,v13,v164
MF v165,v13,v165
MF v166,v13,v166
MF v167,v13,v167
MF v168,v12,v168
MF v169,v12,v169
MF v170,v12,v170
MF v171,v12,v171
MF v172,v13,v172
MF v173,v13,v173
MF v174,v13,v174
MF v175,v13,v175
MF v176,v12,v176
MF v177,v12,v177
MF v178,v12,v178
MF v179,v12,v179
MF v180,v13,v180
MF v181,v13,v181
MF v182,v13,v182
MF v183,v13,v183
MF v184,v12,v184
MF v185,v12,v185
MF v186,v12,v186
MF v187,v12,v187
MF v188,v13,v188
MF v189,v13,v189
MF v190,v13,v190
MF v191,v13,v191
MF v192,v12,v192
MF v193,v12,v193
MF v194,v12,v194
MF v195,v12,v195
MF v196,v13,v196
MF v197,v13,v197
MF v198,v13,v198
MF v199,v13,v199
MF v200,v12,v200
MF v201,v12,v201
MF v202,v12,v202
MF v203,v12,v203
MF v204,v13,v204
MF v205,v13,v205
MF v206,v13,v206
MF v207,v13,v207
MF v208,v12,v208
MF v209,v12,v209
MF v210,v12,v210
MF v211,v12,v211
MF v212,v13,v212
MF v213,v13,v213
MF v214,v13,v214
MF v215,v13,v215
MF v216,v12,v216
MF v217,v12,v217
MF v218,v12,v218
MF v219,v12,v219
MF v220,v13,v220
MF v221,v13,v221
MF v222,v13,v222
MF v223,v13,v223
MF v224,v12,v224
MF v225,v12,v225
MF v226,v12,v226
MF v227,v12,v227
MF v228,v13,v228
MF v229,v13,v229
MF v230,v13,v230
MF v231,v13,v231
MF v232,v12,v232
MF v233,v12,v233
MF v234,v12,v234
MF v235,v12,v235
MF v236,v13,v236
MF v237,v13,v237
MF v238,v13,v238
MF v239,v13,v239
MF v240,v12,v240
MF v241,v12,v241
MF v242,v12,v242
MF v243,v12,v243
MF v244,v13,v244
MF v245,v13,v245
MF v246,v13,v246
MF v247,v13,v247
MF v248,v12,v248
MF v249,v12,v249
MF v250,v12,v250
MF v251,v12,v251
MF v252,v13,v252
MF v253,v13,v253
MF v254,v13,v254
MF v255,v13,v255
E v18,v96
E v19,v97
E v20,v98
AF v28,v18,v19
C v48,v18,v19
E v21,v99
E v22,v104
AF v28,v20,v28
C v49,v20,v21
E v23,v105
AF v28,v21,v28
E v24,v106
AF v28,v22,v28
C v50,v22,v23
E v25,v107
AF v28,v23,v28
E v18,v100
AF v28,v24,v28
C v51,v24,v25
E v19,v101
AF v28,v25,v28
E v20,v102
AF v29,v18,v19
C v52,v18,v19
E v21,v103
E v22,v108
AF v29,v20,v29
C v53,v20,v21
E v23,v109
AF v29,v21,v29
E v24,v110
AF v29,v22,v29
C v54,v22,v23
E v25,v111
AF v29,v23,v29
AF v29,v24,v29
C v55,v24,v25
AF v29,v25,v29
E v18,v112
E v19,v113
E v20,v114
AF v28,v18,v28
C v56,v18,v19
E v21,v115
AF v28,v19,v28
E v22,v120
AF v28,v20,v28
C v57,v20,v21
E v23,v121
AF v28,v21,v28
E v24,v122
AF v28,v22,v28
C v58,v22,v23
E v25,v123
AF v28,v23,v28
E v18,v116
AF v28,v24,v28
C v59,v24,v25
E v19,v117
AF v28,v25,v28
E v20,v118
AF v29,v18,v29
C v60,v18,v19
E v21,v119
AF v29,v19,v29
E v22,v124
AF v29,v20,v29
C v61,v20,v21
E v23,v125
AF v29,v21,v29
E v24,v126
AF v29,v22,v29
C v62,v22,v23
E v25,v127
AF v29,v23,v29
AF v29,v24,v29
C v63,v24,v25
AF v29,v25,v29
s_nop 3
s_setpc_b64 s[36:37]
L_slow1n:
s_nop 7
s_nop 3
v_max3_f32 v10, v96, v97, v98
v_max3_f32 v10, v99, v104, v10
v_max3_f32 v10, v105, v106, v10
v_max3_f32 v10, v107, v112, v10
v_max3_f32 v10, v113, v114, v10
v_max3_f32 v10, v115, v120, v10
v_max3_f32 v10, v121, v122, v10
v_max_f32 v10, v123, v10
v_max3_f32 v11, v100, v101, v102
v_max3_f32 v11, v103, v108, v11
v_max3_f32 v11, v109, v110, v11
v_max3_f32 v11, v111, v116, v11
v_max3_f32 v11, v117, v118, v11
v_max3_f32 v11, v119, v124, v11
v_max3_f32 v11, v125, v126, v11
v_max_f32 v11, v127, v11
v_mov_b32 v12, v10
v_mov_b32 v13, v11
s_nop 0
v_permlane16_swap_b32 v12, v10
v_permlane16_swap_b32 v13, v11
v_max_f32 v10, v12, v10
v_max_f32 v11, v13, v11
v_mov_b32 v12, v10
v_mov_b32 v13, v11
s_nop 0
v_permlane32_swap_b32 v12, v10
v_permlane32_swap_b32 v13, v11
v_max_f32 v10, v12, v10
v_max_f32 v11, v13, v11
v_ceil_f32 v10, v10
v_ceil_f32 v11, v11
v_max_f32 v10, 0, v10
v_max_f32 v11, 0, v11
v_sub_f32 v96, v96, v10
v_sub_f32 v97, v97, v10
v_sub_f32 v98, v98, v10
v_sub_f32 v99, v99, v10
v_sub_f32 v100, v100, v11
v_sub_f32 v101, v101, v11
v_sub_f32 v102, v102, v11
v_sub_f32 v103, v103, v11
v_sub_f32 v104, v104, v10
v_sub_f32 v105, v105, v10
v_sub_f32 v106, v106, v10
v_sub_f32 v107, v107, v10
v_sub_f32 v108, v108, v11
v_sub_f32 v109, v109, v11
v_sub_f32 v110, v110, v11
v_sub_f32 v111, v111, v11
v_sub_f32 v112, v112, v10
v_sub_f32 v113, v113, v10
v_sub_f32 v114, v114, v10
v_sub_f32 v115, v115, v10
v_sub_f32 v116, v116, v11
v_sub_f32 v117, v117, v11
v_sub_f32 v118, v118, v11
v_sub_f32 v119, v119, v11
v_sub_f32 v120, v120, v10
v_sub_f32 v121, v121, v10
v_sub_f32 v122, v122, v10
v_sub_f32 v123, v123, v10
v_sub_f32 v124, v124, v11
v_sub_f32 v125, v125, v11
v_sub_f32 v126, v126, v11
v_sub_f32 v127, v127, v11
v_sub_f32 v32, v32, v10
v_sub_f32 v33, v33, v10
v_sub_f32 v34, v34, v10
v_sub_f32 v35, v35, v10
v_sub_f32 v36, v36, v11
v_sub_f32 v37, v37, v11
v_sub_f32 v38, v38, v11
v_sub_f32 v39, v39, v11
E v12,-v10
E v13,-v11
MF v30,v12,v30
MF v31,v13,v31
MF v128,v12,v128
MF v129,v12,v129
MF v130,v12,v130
MF v131,v12,v131
MF v132,v13,v132
MF v133,v13,v133
MF v134,v13,v134
MF v135,v13,v135
MF v136,v12,v136
MF v137,v12,v137
MF v138,v12,v138
MF v139,v12,v139
MF v140,v13,v140
MF v141,v13,v141
MF v142,v13,v142
MF v143,v13,v143
MF v144,v12,v144
MF v145,v12,v145
MF v146,v12,v146
MF v147,v12,v147
MF v148,v13,v148
MF v149,v13,v149
MF v150,v13,v150
MF v151,v13,v151
MF v152,v12,v152
MF v153,v12,v153
MF v154,v12,v154
MF v155,v12,v155
MF v156,v13,v156
MF v157,v13,v157
MF v158,v13,v158
MF v159,v13,v159
MF v160,v12,v160
MF v161,v12,v161
MF v162,v12,v162
MF v163,v12,v163
MF v164,v13,v164
MF v165,v13,v165
MF v166,v13,v166
MF v167,v13,v167
MF v168,v12,v168
MF v169,v12,v169
MF v170,v12,v170
MF v171,v12,v171
MF v172,v13,v172
MF v173,v13,v173
MF v174,v13,v174
MF v175,v13,v175
MF v176,v12,v176
MF v177,v12,v177
MF v178,v12,v178
MF v179,v12,v179
MF v180,v13,v180
MF v181,v13,v181
MF v182,v13,v182
MF v183,v13,v183
MF v184,v12,v184
MF v185,v12,v185
MF v186,v12,v186
MF v187,v12,v187
MF v188,v13,v188
MF v189,v13,v189
MF v190,v13,v190
MF v191,v13,v191
MF v192,v12,v192
MF v193,v12,v193
MF v194,v12,v194
MF v195,v12,v195
MF v196,v13,v196
MF v197,v13,v197
MF v198,v13,v198
MF v199,v13,v199
MF v200,v12,v200
MF v201,v12,v201
MF v202,v12,v202
MF v203,v12,v203
MF v204,v13,v204
MF v205,v13,v205
MF v206,v13,v206
MF v207,v13,v207
MF v208,v12,v208
MF v209,v12,v209
MF v210,v12,v210
MF v211,v12,v211
MF v212,v13,v212
MF v213,v13,v213
MF v214,v13,v214
MF v215,v13,v215
MF v216,v12,v216
MF v217,v12,v217
MF v218,v12,v218
MF v219,v12,v219
MF v220,v13,v220
MF v221,v13,v221
MF v222,v13,v222
MF v223,v13,v223
MF v224,v12,v224
MF v225,v12,v225
MF v226,v12,v226
MF v227,v12,v227
MF v228,v13,v228
MF v229,v13,v229
MF v230,v13,v230
MF v231,v13,v231
MF v232,v12,v232
MF v233,v12,v233
MF v234,v12,v234
MF v235,v12,v235
MF v236,v13,v236
MF v237,v13,v237
MF v238,v13,v238
MF v239,v13,v239
MF v240,v12,v240
MF v241,v12,v241
MF v242,v12,v242
MF v243,v12,v243
MF v244,v13,v244
MF v245,v13,v245
MF v246,v13,v246
MF v247,v13,v247
MF v248,v12,v248
MF v249,v12,v249
MF v250,v12,v250
MF v251,v12,v251
MF v252,v13,v252
MF v253,v13,v253
MF v254,v13,v254
MF v255,v13,v255
E v18,v96
E v19,v97
E v20,v98
AF v28,v18,v19
C v48,v18,v19
E v21,v99
E v22,v104
AF v28,v20,v28
C v49,v20,v21
E v23,v105
AF v28,v21,v28
E v24,v106
AF v28,v22,v28
C v50,v22,v23
E v25,v107
AF v28,v23,v28
E v18,v100
AF v28,v24,v28
C v51,v24,v25
E v19,v101
AF v28,v25,v28
E v20,v102
AF v29,v18,v19
C v52,v18,v19
E v21,v103
E v22,v108
AF v29,v20,v29
C v53,v20,v21
E v23,v109
AF v29,v21,v29
E v24,v110
AF v29,v22,v29
C v54,v22,v23
E v25,v111
AF v29,v23,v29
AF v29,v24,v29
C v55,v24,v25
AF v29,v25,v29
E v18,v112
E v19,v113
E v20,v114
AF v28,v18,v28
C v56,v18,v19
E v21,v115
AF v28,v19,v28
E v22,v120
AF v28,v20,v28
C v57,v20,v21
E v23,v121
AF v28,v21,v28
E v24,v122
AF v28,v22,v28
C v58,v22,v23
E v25,v123
AF v28,v23,v28
E v18,v116
AF v28,v24,v28
C v59,v24,v25
E v19,v117
AF v28,v25,v28
E v20,v118
AF v29,v18,v29
C v60,v18,v19
E v21,v119
AF v29,v19,v29
E v22,v124
AF v29,v20,v29
C v61,v20,v21
E v23,v125
AF v29,v21,v29
E v24,v126
AF v29,v22,v29
C v62,v22,v23
E v25,v127
AF v29,v23,v29
AF v29,v24,v29
C v63,v24,v25
AF v29,v25,v29
s_nop 3
s_setpc_b64 s[36:37]
L_slowf:
s_nop 7
s_nop 3
v_max3_f32 v10, v64, v65, v66
v_max3_f32 v10, v67, v72, v10
v_max3_f32 v10, v73, v74, v10
v_max3_f32 v10, v75, v80, v10
v_max3_f32 v10, v81, v82, v10
v_max3_f32 v10, v83, v88, v10
v_max3_f32 v10, v89, v90, v10
v_max_f32 v10, v91, v10
v_max3_f32 v11, v68, v69, v70
v_max3_f32 v11, v71, v76, v11
v_max3_f32 v11, v77, v78, v11
v_max3_f32 v11, v79, v84, v11
v_max3_f32 v11, v85, v86, v11
v_max3_f32 v11, v87, v92, v11
v_max3_f32 v11, v93, v94, v11
v_max_f32 v11, v95, v11
v_mov_b32 v12, v10
v_mov_b32 v13, v11
s_nop 0
v_permlane16_swap_b32 v12, v10
v_permlane16_swap_b32 v13, v11
v_max_f32 v10, v12, v10
v_max_f32 v11, v13, v11
v_mov_b32 v12, v10
v_mov_b32 v13, v11
s_nop 0
v_permlane32_swap_b32 v12, v10
v_permlane32_swap_b32 v13, v11
v_max_f32 v10, v12, v10
v_max_f32 v11, v13, v11
v_ceil_f32 v10, v10
v_ceil_f32 v11, v11
v_sub_f32 v64, v64, v10
v_sub_f32 v65, v65, v10
v_sub_f32 v66, v66, v10
v_sub_f32 v67, v67, v10
v_sub_f32 v68, v68, v11
v_sub_f32 v69, v69, v11
v_sub_f32 v70, v70, v11
v_sub_f32 v71, v71, v11
v_sub_f32 v72, v72, v10
v_sub_f32 v73, v73, v10
v_sub_f32 v74, v74, v10
v_sub_f32 v75, v75, v10
v_sub_f32 v76, v76, v11
v_sub_f32 v77, v77, v11
v_sub_f32 v78, v78, v11
v_sub_f32 v79, v79, v11
v_sub_f32 v80, v80, v10
v_sub_f32 v81, v81, v10
v_sub_f32 v82, v82, v10
v_sub_f32 v83, v83, v10
v_sub_f32 v84, v84, v11
v_sub_f32 v85, v85, v11
v_sub_f32 v86, v86, v11
v_sub_f32 v87, v87, v11
v_sub_f32 v88, v88, v10
v_sub_f32 v89, v89, v10
v_sub_f32 v90, v90, v10
v_sub_f32 v91, v91, v10
v_sub_f32 v92, v92, v11
v_sub_f32 v93, v93, v11
v_sub_f32 v94, v94, v11
v_sub_f32 v95, v95, v11
v_sub_f32 v96, v96, v10
v_sub_f32 v97, v97, v10
v_sub_f32 v98, v98, v10
v_sub_f32 v99, v99, v10
v_sub_f32 v100, v100, v11
v_sub_f32 v101, v101, v11
v_sub_f32 v102, v102, v11
v_sub_f32 v103, v103, v11
v_sub_f32 v104, v104, v10
v_sub_f32 v105, v105, v10
v_sub_f32 v106, v106, v10
v_sub_f32 v107, v107, v10
v_sub_f32 v108, v108, v11
v_sub_f32 v109, v109, v11
v_sub_f32 v110, v110, v11
v_sub_f32 v111, v111, v11
v_sub_f32 v112, v112, v10
v_sub_f32 v113, v113, v10
v_sub_f32 v114, v114, v10
v_sub_f32 v115, v115, v10
v_sub_f32 v116, v116, v11
v_sub_f32 v117, v117, v11
v_sub_f32 v118, v118, v11
v_sub_f32 v119, v119, v11
v_sub_f32 v120, v120, v10
v_sub_f32 v121, v121, v10
v_sub_f32 v122, v122, v10
v_sub_f32 v123, v123, v10
v_sub_f32 v124, v124, v11
v_sub_f32 v125, v125, v11
v_sub_f32 v126, v126, v11
v_sub_f32 v127, v127, v11
v_sub_f32 v32, v32, v10
v_sub_f32 v33, v33, v10
v_sub_f32 v34, v34, v10
v_sub_f32 v35, v35, v10
v_sub_f32 v36, v36, v11
v_sub_f32 v37, v37, v11
v_sub_f32 v38, v38, v11
v_sub_f32 v39, v39, v11
E v18,v64
E v19,v65
E v20,v66
AF v26,v18,v19
C v40,v18,v19
E v21,v67
E v22,v72
AF v26,v20,v26
C v41,v20,v21
E v23,v73
AF v26,v21,v26
E v24,v74
AF v26,v22,v26
C v42,v22,v23
E v25,v75
AF v26,v23,v26
E v18,v68
AF v26,v24,v26
C v43,v24,v25
E v19,v69
AF v26,v25,v26
E v20,v70
AF v27,v18,v19
C v44,v18,v19
E v21,v71
E v22,v76
AF v27,v20,v27
C v45,v20,v21
E v23,v77
AF v27,v21,v27
E v24,v78
AF v27,v22,v27
C v46,v22,v23
E v25,v79
AF v27,v23,v27
AF v27,v24,v27
C v47,v24,v25
AF v27,v25,v27
E v18,v80
E v19,v81
E v20,v82
AF v26,v18,v26
C v56,v18,v19
E v21,v83
AF v26,v19,v26
E v22,v88
AF v26,v20,v26
C v57,v20,v21
E v23,v89
AF v26,v21,v26
E v24,v90
AF v26,v22,v26
C v58,v22,v23
E v25,v91
AF v26,v23,v26
E v18,v84
AF v26,v24,v26
C v59,v24,v25
E v19,v85
AF v26,v25,v26
E v20,v86
AF v27,v18,v27
C v60,v18,v19
E v21,v87
AF v27,v19,v27
E v22,v92
AF v27,v20,v27
C v61,v20,v21
E v23,v93
AF v27,v21,v27
E v24,v94
AF v27,v22,v27
C v62,v22,v23
E v25,v95
AF v27,v23,v27
AF v27,v24,v27
C v63,v24,v25
AF v27,v25,v27
s_nop 3
s_setpc_b64 s[36:37]
L_slowj:
s_nop 7
s_nop 3
v_max3_f32 v10, v64, v65, v66
v_max3_f32 v10, v67, v72, v10
v_max3_f32 v10, v73, v74, v10
v_max3_f32 v10, v75, v80, v10
v_max3_f32 v10, v81, v82, v10
v_max3_f32 v10, v83, v88, v10
v_max3_f32 v10, v89, v90, v10
v_max_f32 v10, v91, v10
v_max3_f32 v11, v68, v69, v70
v_max3_f32 v11, v71, v76, v11
v_max3_f32 v11, v77, v78, v11
v_max3_f32 v11, v79, v84, v11
v_max3_f32 v11, v85, v86, v11
v_max3_f32 v11, v87, v92, v11
v_max3_f32 v11, v93, v94, v11
v_max_f32 v11, v95, v11
v_mov_b32 v12, v10
v_mov_b32 v13, v11
s_nop 0
v_permlane16_swap_b32 v12, v10
v_permlane16_swap_b32 v13, v11
v_max_f32 v10, v12, v10
v_max_f32 v11, v13, v11
v_mov_b32 v12, v10
v_mov_b32 v13, v11
s_nop 0
v_permlane32_swap_b32 v12, v10
v_permlane32_swap_b32 v13, v11
v_max_f32 v10, v12, v10
v_max_f32 v11, v13, v11
v_ceil_f32 v10, v10
v_ceil_f32 v11, v11
v_sub_f32 v64, v64, v10
v_sub_f32 v65, v65, v10
v_sub_f32 v66, v66, v10
v_sub_f32 v67, v67, v10
v_sub_f32 v68, v68, v11
v_sub_f32 v69, v69, v11
v_sub_f32 v70, v70, v11
v_sub_f32 v71, v71, v11
v_sub_f32 v72, v72, v10
v_sub_f32 v73, v73, v10
v_sub_f32 v74, v74, v10
v_sub_f32 v75, v75, v10
v_sub_f32 v76, v76, v11
v_sub_f32 v77, v77, v11
v_sub_f32 v78, v78, v11
v_sub_f32 v79, v79, v11
v_sub_f32 v80, v80, v10
v_sub_f32 v81, v81, v10
v_sub_f32 v82, v82, v10
v_sub_f32 v83, v83, v10
v_sub_f32 v84, v84, v11
v_sub_f32 v85, v85, v11
v_sub_f32 v86, v86, v11
v_sub_f32 v87, v87, v11
v_sub_f32 v88, v88, v10
v_sub_f32 v89, v89, v10
v_sub_f32 v90, v90, v10
v_sub_f32 v91, v91, v10
v_sub_f32 v92, v92, v11
v_sub_f32 v93, v93, v11
v_sub_f32 v94, v94, v11
v_sub_f32 v95, v95, v11
v_sub_f32 v32, v32, v10
v_sub_f32 v33, v33, v10
v_sub_f32 v34, v34, v10
v_sub_f32 v35, v35, v10
v_sub_f32 v36, v36, v11
v_sub_f32 v37, v37, v11
v_sub_f32 v38, v38, v11
v_sub_f32 v39, v39, v11
E v18,v64
E v19,v65
E v20,v66
AF v26,v18,v19
C v40,v18,v19
E v21,v67
E v22,v72
AF v26,v20,v26
C v41,v20,v21
E v23,v73
AF v26,v21,v26
E v24,v74
AF v26,v22,v26
C v42,v22,v23
E v25,v75
AF v26,v23,v26
E v18,v68
AF v26,v24,v26
C v43,v24,v25
E v19,v69
AF v26,v25,v26
E v20,v70
AF v27,v18,v19
C v44,v18,v19
E v21,v71
E v22,v76
AF v27,v20,v27
C v45,v20,v21
E v23,v77
AF v27,v21,v27
E v24,v78
AF v27,v22,v27
C v46,v22,v23
E v25,v79
AF v27,v23,v27
AF v27,v24,v27
C v47,v24,v25
AF v27,v25,v27
s_nop 3
s_setpc_b64 s[36:37]
L_slowb:
s_nop 7
s_nop 3
v_max3_f32 v11, v100, v101, v102
v_max3_f32 v11, v103, v108, v11
v_max3_f32 v11, v109, v110, v11
v_max3_f32 v11, v111, v116, v11
v_max3_f32 v11, v117, v118, v11
v_max3_f32 v11, v119, v124, v11
v_max3_f32 v11, v125, v126, v11
v_max_f32 v11, v127, v11
v_mov_b32 v13, v11
s_nop 1
v_permlane16_swap_b32 v13, v11
v_max_f32 v11, v13, v11
v_mov_b32 v13, v11
s_nop 1
v_permlane32_swap_b32 v13, v11
v_max_f32 v11, v13, v11
v_ceil_f32 v11, v11
v_max_f32 v11, 0, v11
v_mov_b32 v10, 0
v_sub_f32 v100, v100, v11
v_sub_f32 v101, v101, v11
v_sub_f32 v102, v102, v11
v_sub_f32 v103, v103, v11
v_sub_f32 v108, v108, v11
v_sub_f32 v109, v109, v11
v_sub_f32 v110, v110, v11
v_sub_f32 v111, v111, v11
v_sub_f32 v116, v116, v11
v_sub_f32 v117, v117, v11
v_sub_f32 v118, v118, v11
v_sub_f32 v119, v119, v11
v_sub_f32 v124, v124, v11
v_sub_f32 v125, v125, v11
v_sub_f32 v126, v126, v11
v_sub_f32 v127, v127, v11
v_sub_f32 v32, v32, v10
v_sub_f32 v33, v33, v10
v_sub_f32 v34, v34, v10
v_sub_f32 v35, v35, v10
v_sub_f32 v36, v36, v11
v_sub_f32 v37, v37, v11
v_sub_f32 v38, v38, v11
v_sub_f32 v39, v39, v11
E v12,-v10
E v13,-v11
MF v30,v12,v30
MF v31,v13,v31
MF v128,v12,v128
MF v129,v12,v129
MF v130,v12,v130
MF v131,v12,v131
MF v132,v13,v132
MF v133,v13,v133
MF v134,v13,v134
MF v135,v13,v135
MF v136,v12,v136
MF v137,v12,v137
MF v138,v12,v138
MF v139,v12,v139
MF v140,v13,v140
MF v141,v13,v141
MF v142,v13,v142
MF v143,v13,v143
MF v144,v12,v144
MF v145,v12,v145
MF v146,v12,v146
MF v147,v12,v147
MF v148,v13,v148
MF v149,v13,v149
MF v150,v13,v150
MF v151,v13,v151
MF v152,v12,v152
MF v153,v12,v153
MF v154,v12,v154
MF v155,v12,v155
MF v156,v13,v156
MF v157,v13,v157
MF v158,v13,v158
MF v159,v13,v159
MF v160,v12,v160
MF v161,v12,v161
MF v162,v12,v162
MF v163,v12,v163
MF v164,v13,v164
MF v165,v13,v165
MF v166,v13,v166
MF v167,v13,v167
MF v168,v12,v168
MF v169,v12,v169
MF v170,v12,v170
MF v171,v12,v171
MF v172,v13,v172
MF v173,v13,v173
MF v174,v13,v174
MF v175,v13,v175
MF v176,v12,v176
MF v177,v12,v177
MF v178,v12,v178
MF v179,v12,v179
MF v180,v13,v180
MF v181,v13,v181
MF v182,v13,v182
MF v183,v13,v183
MF v184,v12,v184
MF v185,v12,v185
MF v186,v12,v186
MF v187,v12,v187
MF v188,v13,v188
MF v189,v13,v189
MF v190,v13,v190
MF v191,v13,v191
MF v192,v12,v192
MF v193,v12,v193
MF v194,v12,v194
MF v195,v12,v195
MF v196,v13,v196
MF v197,v13,v197
MF v198,v13,v198
MF v199,v13,v199
MF v200,v12,v200
MF v201,v12,v201
MF v202,v12,v202
MF v203,v12,v203
MF v204,v13,v204
MF v205,v13,v205
MF v206,v13,v206
MF v207,v13,v207
MF v208,v12,v208
MF v209,v12,v209
MF v210,v12,v210
MF v211,v12,v211
MF v212,v13,v212
MF v213,v13,v213
MF v214,v13,v214
MF v215,v13,v215
MF v216,v12,v216
MF v217,v12,v217
MF v218,v12,v218
MF v219,v12,v219
MF v220,v13,v220
MF v221,v13,v221
MF v222,v13,v222
MF v223,v13,v223
MF v224,v12,v224
MF v225,v12,v225
MF v226,v12,v226
MF v227,v12,v227
MF v228,v13,v228
MF v229,v13,v229
MF v230,v13,v230
MF v231,v13,v231
MF v232,v12,v232
MF v233,v12,v233
MF v234,v12,v234
MF v235,v12,v235
MF v236,v13,v236
MF v237,v13,v237
MF v238,v13,v238
MF v239,v13,v239
MF v240,v12,v240
MF v241,v12,v241
MF v242,v12,v242
MF v243,v12,v243
MF v244,v13,v244
MF v245,v13,v245
MF v246,v13,v246
MF v247,v13,v247
MF v248,v12,v248
MF v249,v12,v249
MF v250,v12,v250
MF v251,v12,v251
MF v252,v13,v252
MF v253,v13,v253
MF v254,v13,v254
MF v255,v13,v255
E v18,v100
E v19,v101
E v20,v102
AF v29,v18,v19
C v52,v18,v19
E v21,v103
E v22,v108
AF v29,v20,v29
C v53,v20,v21
E v23,v109
AF v29,v21,v29
E v24,v110
AF v29,v22,v29
C v54,v22,v23
E v25,v111
AF v29,v23,v29
E v18,v116
AF v29,v24,v29
C v55,v24,v25
E v19,v117
AF v29,v25,v29
E v20,v118
AF v29,v18,v29
C v48,v18,v19
E v21,v119
AF v29,v19,v29
E v22,v124
AF v29,v20,v29
C v49,v20,v21
E v23,v125
AF v29,v21,v29
E v24,v126
AF v29,v22,v29
C v50,v22,v23
E v25,v127
AF v29,v23,v29
AF v29,v24,v29
C v51,v24,v25
AF v29,v25,v29
s_nop 3
s_setpc_b64 s[36:37]
L_comb:
s_waitcnt vmcnt(0)
s_nop 7
v_sub_f32 v10, v32, v14
v_sub_f32 v11, v36, v15
v_max_f32 v10, 0, v10
v_max_f32 v11, 0, v11
v_sub_f32 v100, v100, v11
v_sub_f32 v101, v101, v11
v_sub_f32 v102, v102, v11
v_sub_f32 v103, v103, v11
v_sub_f32 v108, v108, v11
v_sub_f32 v109, v109, v11
v_sub_f32 v110, v110, v11
v_sub_f32 v111, v111, v11
v_sub_f32 v116, v116, v11
v_sub_f32 v117, v117, v11
v_sub_f32 v118, v118, v11
v_sub_f32 v119, v119, v11
v_sub_f32 v124, v124, v11
v_sub_f32 v125, v125, v11
v_sub_f32 v126, v126, v11
v_sub_f32 v127, v127, v11
v_sub_f32 v32, v32, v10
v_sub_f32 v33, v33, v10
v_sub_f32 v34, v34, v10
v_sub_f32 v35, v35, v10
v_sub_f32 v36, v36, v11
v_sub_f32 v37, v37, v11
v_sub_f32 v38, v38, v11
v_sub_f32 v39, v39, v11
E v12,-v10
E v13,-v11
MF v30,v12,v30
MF v31,v13,v31
MF v128,v12,v128
MF v129,v12,v129
MF v130,v12,v130
MF v131,v12,v131
MF v132,v13,v132
MF v133,v13,v133
MF v134,v13,v134
MF v135,v13,v135
MF v136,v12,v136
MF v137,v12,v137
MF v138,v12,v138
MF v139,v12,v139
MF v140,v13,v140
MF v141,v13,v141
MF v142,v13,v142
MF v143,v13,v143
MF v144,v12,v144
MF v145,v12,v145
MF v146,v12,v146
MF v147,v12,v147
MF v148,v13,v148
MF v149,v13,v149
MF v150,v13,v150
MF v151,v13,v151
MF v152,v12,v152
MF v153,v12,v153
MF v154,v12,v154
MF v155,v12,v155
MF v156,v13,v156
MF v157,v13,v157
MF v158,v13,v158
MF v159,v13,v159
MF v160,v12,v160
MF v161,v12,v161
MF v162,v12,v162
MF v163,v12,v163
MF v164,v13,v164
MF v165,v13,v165
MF v166,v13,v166
MF v167,v13,v167
MF v168,v12,v168
MF v169,v12,v169
MF v170,v12,v170
MF v171,v12,v171
MF v172,v13,v172
MF v173,v13,v173
MF v174,v13,v174
MF v175,v13,v175
MF v176,v12,v176
MF v177,v12,v177
MF v178,v12,v178
MF v179,v12,v179
MF v180,v13,v180
MF v181,v13,v181
MF v182,v13,v182
MF v183,v13,v183
MF v184,v12,v184
MF v185,v12,v185
MF v186,v12,v186
MF v187,v12,v187
MF v188,v13,v188
MF v189,v13,v189
MF v190,v13,v190
MF v191,v13,v191
MF v192,v12,v192
MF v193,v12,v193
MF v194,v12,v194
MF v195,v12,v195
MF v196,v13,v196
MF v197,v13,v197
MF v198,v13,v198
MF v199,v13,v199
MF v200,v12,v200
MF v201,v12,v201
MF v202,v12,v202
MF v203,v12,v203
MF v204,v13,v204
MF v205,v13,v205
MF v206,v13,v206
MF v207,v13,v207
MF v208,v12,v208
MF v209,v12,v209
MF v210,v12,v210
MF v211,v12,v211
MF v212,v13,v212
MF v213,v13,v213
MF v214,v13,v214
MF v215,v13,v215
MF v216,v12,v216
MF v217,v12,v217
MF v218,v12,v218
MF v219,v12,v219
MF v220,v13,v220
MF v221,v13,v221
MF v222,v13,v222
MF v223,v13,v223
MF v224,v12,v224
MF v225,v12,v225
MF v226,v12,v226
MF v227,v12,v227
MF v228,v13,v228
MF v229,v13,v229
MF v230,v13,v230
MF v231,v13,v231
MF v232,v12,v232
MF v233,v12,v233
MF v234,v12,v234
MF v235,v12,v235
MF v236,v13,v236
MF v237,v13,v237
MF v238,v13,v238
MF v239,v13,v239
MF v240,v12,v240
MF v241,v12,v241
MF v242,v12,v242
MF v243,v12,v243
MF v244,v13,v244
MF v245,v13,v245
MF v246,v13,v246
MF v247,v13,v247
MF v248,v12,v248
MF v249,v12,v249
MF v250,v12,v250
MF v251,v12,v251
MF v252,v13,v252
MF v253,v13,v253
MF v254,v13,v254
MF v255,v13,v255
E v18,v100
E v19,v101
E v20,v102
AF v29,v18,v19
C v52,v18,v19
E v21,v103
E v22,v108
AF v29,v20,v29
C v53,v20,v21
E v23,v109
AF v29,v21,v29
E v24,v110
AF v29,v22,v29
C v54,v22,v23
E v25,v111
AF v29,v23,v29
E v18,v116
AF v29,v24,v29
C v55,v24,v25
E v19,v117
AF v29,v25,v29
E v20,v118
AF v29,v18,v29
C v48,v18,v19
E v21,v119
AF v29,v19,v29
E v22,v124
AF v29,v20,v29
C v49,v20,v21
E v23,v125
AF v29,v21,v29
E v24,v126
AF v29,v22,v29
C v50,v22,v23
E v25,v127
AF v29,v23,v29
AF v29,v24,v29
C v51,v24,v25
AF v29,v25,v29
v_sub_f32 v10, v32, v14
v_sub_f32 v11, v36, v15
E v10,v10
E v11,v11
s_nop 0
MF v16,v10,v16
MF v17,v11,v17
G v64,a128
v_and_b32 v65, 0xffff0000, v64
v_lshlrev_b32 v64, 16, v64
MF v64,v10,v64
MF v65,v10,v65
C v64,v64,v65
W a128,v64
G v66,a129
v_and_b32 v67, 0xffff0000, v66
v_lshlrev_b32 v66, 16, v66
MF v66,v10,v66
MF v67,v10,v67
C v66,v66,v67
W a129,v66
G v68,a130
v_and_b32 v69, 0xffff0000, v68
v_lshlrev_b32 v68, 16, v68
MF v68,v10,v68
MF v69,v10,v69
C v68,v68,v69
W a130,v68
G v70,a131
v_and_b32 v71, 0xffff0000, v70
v_lshlrev_b32 v70, 16, v70
MF v70,v10,v70
MF v71,v10,v71
C v70,v70,v71
W a131,v70
G v72,a132
v_and_b32 v73, 0xffff0000, v72
v_lshlrev_b32 v72, 16, v72
MF v72,v10,v72
MF v73,v10,v73
C v72,v72,v73
W a132,v72
G v74,a133
v_and_b32 v75, 0xffff0000, v74
v_lshlrev_b32 v74, 16, v74
MF v74,v10,v74
MF v75,v10,v75
C v74,v74,v75
W a133,v74
G v76,a134
v_and_b32 v77, 0xffff0000, v76
v_lshlrev_b32 v76, 16, v76
MF v76,v10,v76
MF v77,v10,v77
C v76,v76,v77
W a134,v76
G v78,a135
v_and_b32 v79, 0xffff0000, v78
v_lshlrev_b32 v78, 16, v78
MF v78,v10,v78
MF v79,v10,v79
C v78,v78,v79
W a135,v78
G v64,a136
v_and_b32 v65, 0xffff0000, v64
v_lshlrev_b32 v64, 16, v64
MF v64,v10,v64
MF v65,v10,v65
C v64,v64,v65
W a136,v64
G v66,a137
v_and_b32 v67, 0xffff0000, v66
v_lshlrev_b32 v66, 16, v66
MF v66,v10,v66
MF v67,v10,v67
C v66,v66,v67
W a137,v66
G v68,a138
v_and_b32 v69, 0xffff0000, v68
v_lshlrev_b32 v68, 16, v68
MF v68,v10,v68
MF v69,v10,v69
C v68,v68,v69
W a138,v68
G v70,a139
v_and_b32 v71, 0xffff0000, v70
v_lshlrev_b32 v70, 16, v70
MF v70,v10,v70
MF v71,v10,v71
C v70,v70,v71
W a139,v70
G v72,a140
v_and_b32 v73, 0xffff0000, v72
v_lshlrev_b32 v72, 16, v72
MF v72,v10,v72
MF v73,v10,v73
C v72,v72,v73
W a140,v72
G v74,a141
v_and_b32 v75, 0xffff0000, v74
v_lshlrev_b32 v74, 16, v74
MF v74,v10,v74
MF v75,v10,v75
C v74,v74,v75
W a141,v74
G v76,a142
v_and_b32 v77, 0xffff0000, v76
v_lshlrev_b32 v76, 16, v76
MF v76,v10,v76
MF v77,v10,v77
C v76,v76,v77
W a142,v76
G v78,a143
v_and_b32 v79, 0xffff0000, v78
v_lshlrev_b32 v78, 16, v78
MF v78,v10,v78
MF v79,v10,v79
C v78,v78,v79
W a143,v78
G v64,a144
v_and_b32 v65, 0xffff0000, v64
v_lshlrev_b32 v64, 16, v64
MF v64,v10,v64
MF v65,v10,v65
C v64,v64,v65
W a144,v64
G v66,a145
v_and_b32 v67, 0xffff0000, v66
v_lshlrev_b32 v66, 16, v66
MF v66,v10,v66
MF v67,v10,v67
C v66,v66,v67
W a145,v66
G v68,a146
v_and_b32 v69, 0xffff0000, v68
v_lshlrev_b32 v68, 16, v68
MF v68,v10,v68
MF v69,v10,v69
C v68,v68,v69
W a146,v68
G v70,a147
v_and_b32 v71, 0xffff0000, v70
v_lshlrev_b32 v70, 16, v70
MF v70,v10,v70
MF v71,v10,v71
C v70,v70,v71
W a147,v70
G v72,a148
v_and_b32 v73, 0xffff0000, v72
v_lshlrev_b32 v72, 16, v72
MF v72,v10,v72
MF v73,v10,v73
C v72,v72,v73
W a148,v72
G v74,a149
v_and_b32 v75, 0xffff0000, v74
v_lshlrev_b32 v74, 16, v74
MF v74,v10,v74
MF v75,v10,v75
C v74,v74,v75
W a149,v74
G v76,a150
v_and_b32 v77, 0xffff0000, v76
v_lshlrev_b32 v76, 16, v76
MF v76,v10,v76
MF v77,v10,v77
C v76,v76,v77
W a150,v76
G v78,a151
v_and_b32 v79, 0xffff0000, v78
v_lshlrev_b32 v78, 16, v78
MF v78,v10,v78
MF v79,v10,v79
C v78,v78,v79
W a151,v78
G v64,a152
v_and_b32 v65, 0xffff0000, v64
v_lshlrev_b32 v64, 16, v64
MF v64,v10,v64
MF v65,v10,v65
C v64,v64,v65
W a152,v64
G v66,a153
v_and_b32 v67, 0xffff0000, v66
v_lshlrev_b32 v66, 16, v66
MF v66,v10,v66
MF v67,v10,v67
C v66,v66,v67
W a153,v66
G v68,a154
v_and_b32 v69, 0xffff0000, v68
v_lshlrev_b32 v68, 16, v68
MF v68,v10,v68
MF v69,v10,v69
C v68,v68,v69
W a154,v68
G v70,a155
v_and_b32 v71, 0xffff0000, v70
v_lshlrev_b32 v70, 16, v70
MF v70,v10,v70
MF v71,v10,v71
C v70,v70,v71
W a155,v70
G v72,a156
v_and_b32 v73, 0xffff0000, v72
v_lshlrev_b32 v72, 16, v72
MF v72,v10,v72
MF v73,v10,v73
C v72,v72,v73
W a156,v72
G v74,a157
v_and_b32 v75, 0xffff0000, v74
v_lshlrev_b32 v74, 16, v74
MF v74,v10,v74
MF v75,v10,v75
C v74,v74,v75
W a157,v74
G v76,a158
v_and_b32 v77, 0xffff0000, v76
v_lshlrev_b32 v76, 16, v76
MF v76,v10,v76
MF v77,v10,v77
C v76,v76,v77
W a158,v76
G v78,a159
v_and_b32 v79, 0xffff0000, v78
v_lshlrev_b32 v78, 16, v78
MF v78,v10,v78
MF v79,v10,v79
C v78,v78,v79
W a159,v78
G v64,a160
v_and_b32 v65, 0xffff0000, v64
v_lshlrev_b32 v64, 16, v64
MF v64,v11,v64
MF v65,v11,v65
C v64,v64,v65
W a160,v64
G v66,a161
v_and_b32 v67, 0xffff0000, v66
v_lshlrev_b32 v66, 16, v66
MF v66,v11,v66
MF v67,v11,v67
C v66,v66,v67
W a161,v66
G v68,a162
v_and_b32 v69, 0xffff0000, v68
v_lshlrev_b32 v68, 16, v68
MF v68,v11,v68
MF v69,v11,v69
C v68,v68,v69
W a162,v68
G v70,a163
v_and_b32 v71, 0xffff0000, v70
v_lshlrev_b32 v70, 16, v70
MF v70,v11,v70
MF v71,v11,v71
C v70,v70,v71
W a163,v70
G v72,a164
v_and_b32 v73, 0xffff0000, v72
v_lshlrev_b32 v72, 16, v72
MF v72,v11,v72
MF v73,v11,v73
C v72,v72,v73
W a164,v72
G v74,a165
v_and_b32 v75, 0xffff0000, v74
v_lshlrev_b32 v74, 16, v74
MF v74,v11,v74
MF v75,v11,v75
C v74,v74,v75
W a165,v74
G v76,a166
v_and_b32 v77, 0xffff0000, v76
v_lshlrev_b32 v76, 16, v76
MF v76,v11,v76
MF v77,v11,v77
C v76,v76,v77
W a166,v76
G v78,a167
v_and_b32 v79, 0xffff0000, v78
v_lshlrev_b32 v78, 16, v78
MF v78,v11,v78
MF v79,v11,v79
C v78,v78,v79
W a167,v78
G v64,a168
v_and_b32 v65, 0xffff0000, v64
v_lshlrev_b32 v64, 16, v64
MF v64,v11,v64
MF v65,v11,v65
C v64,v64,v65
W a168,v64
G v66,a169
v_and_b32 v67, 0xffff0000, v66
v_lshlrev_b32 v66, 16, v66
MF v66,v11,v66
MF v67,v11,v67
C v66,v66,v67
W a169,v66
G v68,a170
v_and_b32 v69, 0xffff0000, v68
v_lshlrev_b32 v68, 16, v68
MF v68,v11,v68
MF v69,v11,v69
C v68,v68,v69
W a170,v68
G v70,a171
v_and_b32 v71, 0xffff0000, v70
v_lshlrev_b32 v70, 16, v70
MF v70,v11,v70
MF v71,v11,v71
C v70,v70,v71
W a171,v70
G v72,a172
v_and_b32 v73, 0xffff0000, v72
v_lshlrev_b32 v72, 16, v72
MF v72,v11,v72
MF v73,v11,v73
C v72,v72,v73
W a172,v72
G v74,a173
v_and_b32 v75, 0xffff0000, v74
v_lshlrev_b32 v74, 16, v74
MF v74,v11,v74
MF v75,v11,v75
C v74,v74,v75
W a173,v74
G v76,a174
v_and_b32 v77, 0xffff0000, v76
v_lshlrev_b32 v76, 16, v76
MF v76,v11,v76
MF v77,v11,v77
C v76,v76,v77
W a174,v76
G v78,a175
v_and_b32 v79, 0xffff0000, v78
v_lshlrev_b32 v78, 16, v78
MF v78,v11,v78
MF v79,v11,v79
C v78,v78,v79
W a175,v78
G v64,a176
v_and_b32 v65, 0xffff0000, v64
v_lshlrev_b32 v64, 16, v64
MF v64,v11,v64
MF v65,v11,v65
C v64,v64,v65
W a176,v64
G v66,a177
v_and_b32 v67, 0xffff0000, v66
v_lshlrev_b32 v66, 16, v66
MF v66,v11,v66
MF v67,v11,v67
C v66,v66,v67
W a177,v66
G v68,a178
v_and_b32 v69, 0xffff0000, v68
v_lshlrev_b32 v68, 16, v68
MF v68,v11,v68
MF v69,v11,v69
C v68,v68,v69
W a178,v68
G v70,a179
v_and_b32 v71, 0xffff0000, v70
v_lshlrev_b32 v70, 16, v70
MF v70,v11,v70
MF v71,v11,v71
C v70,v70,v71
W a179,v70
G v72,a180
v_and_b32 v73, 0xffff0000, v72
v_lshlrev_b32 v72, 16, v72
MF v72,v11,v72
MF v73,v11,v73
C v72,v72,v73
W a180,v72
G v74,a181
v_and_b32 v75, 0xffff0000, v74
v_lshlrev_b32 v74, 16, v74
MF v74,v11,v74
MF v75,v11,v75
C v74,v74,v75
W a181,v74
G v76,a182
v_and_b32 v77, 0xffff0000, v76
v_lshlrev_b32 v76, 16, v76
MF v76,v11,v76
MF v77,v11,v77
C v76,v76,v77
W a182,v76
G v78,a183
v_and_b32 v79, 0xffff0000, v78
v_lshlrev_b32 v78, 16, v78
MF v78,v11,v78
MF v79,v11,v79
C v78,v78,v79
W a183,v78
G v64,a184
v_and_b32 v65, 0xffff0000, v64
v_lshlrev_b32 v64, 16, v64
MF v64,v11,v64
MF v65,v11,v65
C v64,v64,v65
W a184,v64
G v66,a185
v_and_b32 v67, 0xffff0000, v66
v_lshlrev_b32 v66, 16, v66
MF v66,v11,v66
MF v67,v11,v67
C v66,v66,v67
W a185,v66
G v68,a186
v_and_b32 v69, 0xffff0000, v68
v_lshlrev_b32 v68, 16, v68
MF v68,v11,v68
MF v69,v11,v69
C v68,v68,v69
W a186,v68
G v70,a187
v_and_b32 v71, 0xffff0000, v70
v_lshlrev_b32 v70, 16, v70
MF v70,v11,v70
MF v71,v11,v71
C v70,v70,v71
W a187,v70
G v72,a188
v_and_b32 v73, 0xffff0000, v72
v_lshlrev_b32 v72, 16, v72
MF v72,v11,v72
MF v73,v11,v73
C v72,v72,v73
W a188,v72
G v74,a189
v_and_b32 v75, 0xffff0000, v74
v_lshlrev_b32 v74, 16, v74
MF v74,v11,v74
MF v75,v11,v75
C v74,v74,v75
W a189,v74
G v76,a190
v_and_b32 v77, 0xffff0000, v76
v_lshlrev_b32 v76, 16, v76
MF v76,v11,v76
MF v77,v11,v77
C v76,v76,v77
W a190,v76
G v78,a191
v_and_b32 v79, 0xffff0000, v78
v_lshlrev_b32 v78, 16, v78
MF v78,v11,v78
MF v79,v11,v79
C v78,v78,v79
W a191,v78
s_nop 3
s_setpc_b64 s[36:37]
L_zs0:
s_mov_b32 s64, 65536
L_zs0_l:
s_sleep 2
buffer_load_dword v17, v16, s[12:15], 0 offen sc1
s_sub_u32 s64, s64, 1
s_cbranch_scc1 L_zs0_x
s_waitcnt vmcnt(0)
v_cmp_ne_u32 vcc, 1, v17
s_nop 0
s_cbranch_vccnz L_zs0_l
L_zs0_x:
s_waitcnt vmcnt(0)
s_branch L_zr0
L_zs1:
s_mov_b32 s64, 65536
L_zs1_l:
s_sleep 2
buffer_load_dword v17, v16, s[12:15], 0 offen sc1
s_sub_u32 s64, s64, 1
s_cbranch_scc1 L_zs1_x
s_waitcnt vmcnt(0)
v_cmp_ne_u32 vcc, 1, v17
s_nop 0
s_cbranch_vccnz L_zs1_l
L_zs1_x:
s_waitcnt vmcnt(0)
s_branch L_zr1
L_hs:
s_mov_b32 s91, 65536
L_hs_l:
buffer_load_dwordx4 v[16:19], v7, s[8:11], s67 offen offset:0 sc1
buffer_load_dwordx4 v[20:23], v7, s[8:11], s67 offen offset:1024 sc1
s_waitcnt vmcnt(0)
s_sub_u32 s91, s91, 1
s_cbranch_scc1 L_hr
v_min3_u32 v28, v16, v17, v18
v_min3_u32 v28, v28, v19, v20
v_min3_u32 v28, v28, v21, v22
v_min_u32 v28, v28, v23
v_cmp_eq_u32 vcc, 0, v28
s_nop 0
s_cbranch_vccnz L_hs_l
s_branch L_hr
L_lsj0:
s_mov_b32 s91, 65536
L_lsj0_l:
s_sleep 2
buffer_load_dword v5, v17, s[8:11], s46 offen sc1
s_sub_u32 s91, s91, 1
s_cbranch_scc1 L_lsj0_x
s_waitcnt vmcnt(0)
v_cmp_gt_u32 vcc, 2, v5
s_nop 0
s_cbranch_vccnz L_lsj0_l
L_lsj0_x:
s_waitcnt vmcnt(0)
s_branch L_lrj0
L_lsh2:
s_mov_b32 s91, 65536
L_lsh2_l:
s_sleep 2
buffer_load_dword v5, v17, s[8:11], s46 offen sc1
s_sub_u32 s91, s91, 1
s_cbranch_scc1 L_lsh2_x
s_waitcnt vmcnt(0)
v_cmp_gt_u32 vcc, 2, v5
s_nop 0
s_cbranch_vccnz L_lsh2_l
L_lsh2_x:
s_waitcnt vmcnt(0)
s_branch L_lrh2
L_lsh4:
s_mov_b32 s91, 65536
L_lsh4_l:
s_sleep 2
buffer_load_dword v5, v9, s[8:11], s46 offen sc1
s_sub_u32 s91, s91, 1
s_cbranch_scc1 L_lsh4_x
s_waitcnt vmcnt(0)
v_cmp_gt_u32 vcc, s84, v5
s_nop 0
s_cbranch_vccnz L_lsh4_l
L_lsh4_x:
s_waitcnt vmcnt(0)
s_branch L_lrh4
L_wsq0:
s_mov_b32 s91, 65536
L_wsq0_l:
s_sleep 2
buffer_load_dword v5, v31, s[8:11], s46 offen offset:4 sc1
s_sub_u32 s91, s91, 1
s_cbranch_scc1 L_wsq0_x
s_waitcnt vmcnt(0)
v_cmp_ne_u32 vcc, 1, v5
s_nop 0
s_mov_b32 vcc_hi, 0
s_cbranch_vccnz L_wsq0_l
L_wsq0_x:
s_waitcnt vmcnt(0)
s_branch L_wrq0
L_wsr0:
s_mov_b32 s91, 65536
L_wsr0_l:
s_sleep 2
buffer_load_dword v5, v31, s[8:11], s46 offen offset:4 sc1
s_sub_u32 s91, s91, 1
s_cbranch_scc1 L_wsr0_x
s_waitcnt vmcnt(0)
v_cmp_ne_u32 vcc, 1, v5
s_nop 0
s_mov_b32 vcc_lo, 0
s_cbranch_vccnz L_wsr0_l
L_wsr0_x:
s_waitcnt vmcnt(0)
s_branch L_wrr0
L_wsq1:
s_mov_b32 s91, 65536
L_wsq1_l:
s_sleep 2
buffer_load_dword v5, v31, s[8:11], s46 offen offset:4 sc1
s_sub_u32 s91, s91, 1
s_cbranch_scc1 L_wsq1_x
s_waitcnt vmcnt(0)
v_cmp_ne_u32 vcc, 1, v5
s_nop 0
s_mov_b32 vcc_hi, 0
s_cbranch_vccnz L_wsq1_l
L_wsq1_x:
s_waitcnt vmcnt(0)
s_branch L_wrq1
L_wsr1:
s_mov_b32 s91, 65536
L_wsr1_l:
s_sleep 2
buffer_load_dword v5, v31, s[8:11], s46 offen offset:4 sc1
s_sub_u32 s91, s91, 1
s_cbranch_scc1 L_wsr1_x
s_waitcnt vmcnt(0)
v_cmp_ne_u32 vcc, 1, v5
s_nop 0
s_mov_b32 vcc_lo, 0
s_cbranch_vccnz L_wsr1_l
L_wsr1_x:
s_waitcnt vmcnt(0)
s_branch L_wrr1
L_fll:
s_sub_u32 s65, s7, s40
s_mov_b32 s64, -1
s_cmp_eq_u32 s65, 1
s_cbranch_scc1 L_fl2
s_cmp_lg_u32 s20, 0
s_cbranch_scc1 L_fl3
s_lshr_b32 s64, s42, 3
s_cmp_eq_u32 s7, s64
s_cbranch_scc0 L_fl1
v_mov_b32 v15, 4
buffer_store_dword v15, v1, s[8:11], s45 offen sc1
L_fl1:
s_cmp_lg_u32 s65, 0
s_cbranch_scc1 L_fllr
s_movk_i32 s64, 0x380
L_fl2:
v_min_u32 v17, s64, v9
s_mov_b32 s6, 4
buffer_load_dword v5, v17, s[8:11], s46 offen sc1
s_bitcmp1_b32 s39, 15
s_cbranch_scc0 L_fllr
L_fl3:
s_cmp_eq_u32 s7, 1
s_cbranch_scc1 L_y2
s_cmp_eq_u32 s7, 2
s_cbranch_scc1 L_y3
s_cmp_eq_u32 s7, 3
s_cbranch_scc1 L_y4
s_branch L_y5
s_waitcnt vmcnt(0)
L_fps:
s_cmp_lg_u32 s35, 0
s_cbranch_scc1 L_fpr
L_fps2:
s_mov_b32 s91, 65536
L_fps2_l:
s_sleep 2
buffer_load_dword v6, off, s[8:11], s47 sc1
s_sub_u32 s91, s91, 1
s_cbranch_scc1 L_fps2_x
s_waitcnt vmcnt(0)
v_cmp_ne_u32 vcc, 1, v6
s_nop 0
s_cbranch_vccnz L_fps2_l
L_fps2_x:
s_waitcnt vmcnt(0)
s_branch L_fpr
L_fqs:
s_mov_b32 s91, 65536
L_fqs_l:
s_sleep 2
buffer_load_dword v6, off, s[8:11], s47 offset:16 sc1
s_sub_u32 s91, s91, 1
s_cbranch_scc1 L_fqs_x
s_waitcnt vmcnt(0)
v_cmp_ne_u32 vcc, 1, v6
s_nop 0
s_cbranch_vccnz L_fqs_l
L_fqs_x:
s_waitcnt vmcnt(0)
s_branch L_fqr
L_fls0:
s_mov_b32 s91, 65536
L_fls0_l:
s_sleep 2
buffer_load_dword v5, v17, s[8:11], s46 offen sc1
s_sub_u32 s91, s91, 1
s_cbranch_scc1 L_fls0_x
s_waitcnt vmcnt(0)
v_cmp_gt_u32 vcc, s6, v5
s_nop 0
s_cbranch_vccnz L_fls0_l
L_fls0_x:
s_waitcnt vmcnt(0)
s_branch L_flr0
L_y2:
v_lshrrev_b32 v11, 7, v7
v_mul_u32_u24 v11, 4352, v11
v_and_b32 v12, 0x70, v7
v_lshl_add_u32 v11, v12, 3, v11
s_mov_b32 s64, 104923136
s_mov_b32 s65, 104957952
buffer_load_dword a128, v11, s[8:11], s64 offen sc1
buffer_load_dword a129, v11, s[8:11], s65 offen sc1
s_branch L_fllr
s_waitcnt vmcnt(0)
L_y3:
s_mov_b32 s91, 65536
L_y3c:
G v12,a128
G v13,a129
v_min_u32 v12, v12, v13
v_cmp_gt_u32 vcc, 2, v12
s_sub_u32 s91, s91, 1
s_cbranch_scc1 L_y3x
s_cbranch_vccz L_y3x
v_lshrrev_b32 v11, 7, v7
v_mul_u32_u24 v11, 4352, v11
v_and_b32 v12, 0x70, v7
v_lshl_add_u32 v11, v12, 3, v11
s_mov_b32 s64, 104923136
s_mov_b32 s65, 104957952
buffer_load_dword a128, v11, s[8:11], s64 offen sc1
buffer_load_dword a129, v11, s[8:11], s65 offen sc1
s_waitcnt vmcnt(0)
s_branch L_y3c
L_y3x:
s_lshl_b32 s66, s41, 1
SA s66,s66,s20
s_sub_u32 s66, s66, 2
s_cmp_lt_u32 s66, 14
s_cselect_b32 s64, 8, 12
SA s64,s64,104890368
buffer_load_dword a130, off, s[8:11], s64 sc1
v_lshrrev_b32 v11, 7, v7
v_mul_u32_u24 v11, 3584, v11
v_and_b32 v12, 0x70, v7
v_add_u32 v11, v12, v11
s_lshl_b32 s65, s66, 7
SA s65,s65,105906176
buffer_load_dwordx4 a[132:135], v11, s[8:11], s65 offen sc1
SA s65,s65,28672
buffer_load_dwordx4 a[136:139], v11, s[8:11], s65 offen sc1
SA s65,s65,28672
buffer_load_dwordx4 a[140:143], v11, s[8:11], s65 offen sc1
SA s65,s65,28672
buffer_load_dwordx4 a[144:147], v11, s[8:11], s65 offen sc1
SA s65,s65,28672
buffer_load_dwordx4 a[148:151], v11, s[8:11], s65 offen sc1
SA s65,s65,28672
buffer_load_dwordx4 a[152:155], v11, s[8:11], s65 offen sc1
SA s65,s65,28672
buffer_load_dwordx4 a[156:159], v11, s[8:11], s65 offen sc1
SA s65,s65,28672
buffer_load_dwordx4 a[160:163], v11, s[8:11], s65 offen sc1
SA s65,s65,28672
buffer_load_dwordx4 a[164:167], v11, s[8:11], s65 offen sc1
SA s65,s65,28672
buffer_load_dwordx4 a[168:171], v11, s[8:11], s65 offen sc1
SA s65,s65,28672
buffer_load_dwordx4 a[172:175], v11, s[8:11], s65 offen sc1
SA s65,s65,28672
buffer_load_dwordx4 a[176:179], v11, s[8:11], s65 offen sc1
SA s65,s65,28672
buffer_load_dwordx4 a[180:183], v11, s[8:11], s65 offen sc1
SA s65,s65,28672
buffer_load_dwordx4 a[184:187], v11, s[8:11], s65 offen sc1
SA s65,s65,28672
s_branch L_fllr
s_waitcnt vmcnt(0)
L_y4:
G v12,a132
G v13,a133
G v14,a134
G v15,a135
G v16,a136
G v17,a137
AF v12,v16,v12
AF v13,v17,v13
G v16,a138
G v17,a139
AF v14,v16,v14
AF v15,v17,v15
G v16,a140
G v17,a141
AF v12,v16,v12
AF v13,v17,v13
G v16,a142
G v17,a143
AF v14,v16,v14
AF v15,v17,v15
G v16,a144
G v17,a145
AF v12,v16,v12
AF v13,v17,v13
G v16,a146
G v17,a147
AF v14,v16,v14
AF v15,v17,v15
G v16,a148
G v17,a149
AF v12,v16,v12
AF v13,v17,v13
G v16,a150
G v17,a151
AF v14,v16,v14
AF v15,v17,v15
G v16,a152
G v17,a153
AF v12,v16,v12
AF v13,v17,v13
G v16,a154
G v17,a155
AF v14,v16,v14
AF v15,v17,v15
G v16,a156
G v17,a157
AF v12,v16,v12
AF v13,v17,v13
G v16,a158
G v17,a159
AF v14,v16,v14
AF v15,v17,v15
G v16,a160
G v17,a161
AF v12,v16,v12
AF v13,v17,v13
G v16,a162
G v17,a163
AF v14,v16,v14
AF v15,v17,v15
G v16,a164
G v17,a165
AF v12,v16,v12
AF v13,v17,v13
G v16,a166
G v17,a167
AF v14,v16,v14
AF v15,v17,v15
G v16,a168
G v17,a169
AF v12,v16,v12
AF v13,v17,v13
G v16,a170
G v17,a171
AF v14,v16,v14
AF v15,v17,v15
G v16,a172
G v17,a173
AF v12,v16,v12
AF v13,v17,v13
G v16,a174
G v17,a175
AF v14,v16,v14
AF v15,v17,v15
G v16,a176
G v17,a177
AF v12,v16,v12
AF v13,v17,v13
G v16,a178
G v17,a179
AF v14,v16,v14
AF v15,v17,v15
G v16,a180
G v17,a181
AF v12,v16,v12
AF v13,v17,v13
G v16,a182
G v17,a183
AF v14,v16,v14
AF v15,v17,v15
G v16,a184
G v17,a185
AF v12,v16,v12
AF v13,v17,v13
G v16,a186
G v17,a187
AF v14,v16,v14
AF v15,v17,v15
v_add_f32 v12, v12, v12 row_ror:8 row_mask:0xf bank_mask:0xf
v_add_f32 v13, v13, v13 row_ror:8 row_mask:0xf bank_mask:0xf
v_add_f32 v14, v14, v14 row_ror:8 row_mask:0xf bank_mask:0xf
v_add_f32 v15, v15, v15 row_ror:8 row_mask:0xf bank_mask:0xf
v_mov_b32 v11, v12
s_nop 1
v_permlane16_swap_b32 v11, v12
AF v12,v11,v12
v_mov_b32 v11, v13
s_nop 1
v_permlane16_swap_b32 v11, v13
AF v13,v11,v13
v_mov_b32 v11, v14
s_nop 1
v_permlane16_swap_b32 v11, v14
AF v14,v11,v14
v_mov_b32 v11, v15
s_nop 1
v_permlane16_swap_b32 v11, v15
AF v15,v11,v15
v_mov_b32 v11, v12
s_nop 1
v_permlane32_swap_b32 v11, v12
AF v12,v11,v12
v_mov_b32 v11, v13
s_nop 1
v_permlane32_swap_b32 v11, v13
AF v13,v11,v13
v_mov_b32 v11, v14
s_nop 1
v_permlane32_swap_b32 v11, v14
AF v14,v11,v14
v_mov_b32 v11, v15
s_nop 1
v_permlane32_swap_b32 v11, v15
AF v15,v11,v15
G v16,a130
C v11,v12,v13
v_lshlrev_b32 v12, 16, v11
v_and_b32 v13, 0xffff0000, v11
C v11,v14,v15
v_lshlrev_b32 v14, 16, v11
v_and_b32 v15, 0xffff0000, v11
MF v12,v16,v12
MF v13,v16,v13
MF v14,v16,v14
MF v15,v16,v15
C v11,v12,v13
v_lshlrev_b32 v12, 16, v11
v_and_b32 v13, 0xffff0000, v11
C v11,v14,v15
v_lshlrev_b32 v14, 16, v11
v_and_b32 v15, 0xffff0000, v11
s_lshl_b32 s66, s41, 1
SA s66,s66,s20
s_sub_u32 s66, s66, 2
s_lshl_b32 s65, s66, 7
SA s65,s65,104898560
s_mov_b64 exec, 0xff
buffer_store_dwordx4 v[12:15], v7, s[8:11], s65 offen sc1
s_mov_b64 exec, -1
s_nop 1
s_branch L_fllr
L_y5:
s_lshl_b32 s66, s41, 1
SA s66,s66,s20
s_sub_u32 s66, s66, 2
s_lshl_b32 s66, s66, 2
SA s66,s66,105062912
v_mov_b32 v11, 1
s_mov_b64 exec, 1
buffer_store_dword v11, off, s[8:11], s66 sc1
s_mov_b64 exec, -1
s_branch L_fllr
.p2align 12
L_loop_top:
M v[64:67],a[64:67],a[0:3],v[32:35]
SA m0,s28,0
R a[96:99],v2,40960
M v[64:67],a[68:71],a[4:7],v[64:67]
buffer_load_dword a240, v0, s[60:63], 0 offen offset:0
M v[64:67],a[72:75],a[8:11],v[64:67]
R a[100:103],v2,41984
M v[64:67],a[76:79],a[12:15],v[64:67]
s_waitcnt lgkmcnt(2)
buffer_load_dwordx4 v3, s[8:11], s26 offen offset:0 sc1 lds
M v[64:67],a[80:83],a[16:19],v[64:67]
R a[104:107],v2,43008
M v[64:67],a[84:87],a[20:23],v[64:67]
E v18,v112
M v[64:67],a[88:91],a[24:27],v[64:67]
R a[108:111],v2,44032
M v[64:67],a[92:95],a[28:31],v[64:67]
buffer_load_dwordx4 v3, s[8:11], s26 offen offset:1024 sc1 lds
M v[68:71],a[92:95],a[60:63],v[36:39]
R a[112:115],v2,45056
M v[68:71],a[88:91],a[56:59],v[68:71]
E v19,v113
M v[68:71],a[84:87],a[52:55],v[68:71]
R a[116:119],v2,46080
AF v28,v18,v28
M v[68:71],a[80:83],a[48:51],v[68:71]
E v20,v114
M v[68:71],a[76:79],a[44:47],v[68:71]
R a[120:123],v2,47104
C v56,v18,v19
M v[68:71],a[72:75],a[40:43],v[68:71]
buffer_load_dwordx4 v3, s[8:11], s26 offen offset:2048 sc1 lds
M v[68:71],a[68:71],a[36:39],v[68:71]
R a[124:127],v2,48128
AF v28,v19,v28
M v[68:71],a[64:67],a[32:35],v[68:71]
s_waitcnt lgkmcnt(4)
E v21,v115
M v[76:79],a[96:99],a[32:35],v[36:39]
R a[64:67],v2,49152
AF v28,v20,v28
M v[76:79],a[100:103],a[36:39],v[76:79]
buffer_load_dwordx4 v3, s[8:11], s26 offen offset:3072 sc1 lds
M v[76:79],a[104:107],a[40:43],v[76:79]
R a[68:71],v2,50176
C v57,v20,v21
M v[76:79],a[108:111],a[44:47],v[76:79]
s_waitcnt lgkmcnt(2)
E v22,v120
M v[76:79],a[112:115],a[48:51],v[76:79]
R a[72:75],v2,51200
AF v28,v21,v28
M v[76:79],a[116:119],a[52:55],v[76:79]
E v23,v121
M v[76:79],a[120:123],a[56:59],v[76:79]
SA m0,s28,4096
R a[76:79],v2,52224
AF v28,v22,v28
M v[76:79],a[124:127],a[60:63],v[76:79]
buffer_load_dwordx4 v4, s[8:11], s26 offen offset:0 sc1 lds
M v[72:75],a[124:127],a[28:31],v[32:35]
R a[80:83],v2,53248
C v58,v22,v23
M v[72:75],a[120:123],a[24:27],v[72:75]
E v24,v122
M v[72:75],a[116:119],a[20:23],v[72:75]
R a[84:87],v2,54272
AF v28,v23,v28
M v[72:75],a[112:115],a[16:19],v[72:75]
E v25,v123
M v[72:75],a[108:111],a[12:15],v[72:75]
R a[88:91],v2,55296
AF v28,v24,v28
M v[72:75],a[104:107],a[8:11],v[72:75]
buffer_load_dwordx4 v4, s[8:11], s26 offen offset:1024 sc1 lds
M v[72:75],a[100:103],a[4:7],v[72:75]
R a[92:95],v2,56320
C v59,v24,v25
M v[72:75],a[96:99],a[0:3],v[72:75]
s_waitcnt lgkmcnt(4)
E v18,v116
M v[80:83],a[64:67],a[0:3],v[32:35]
R a[96:99],v2,57344
AF v28,v25,v28
M v[80:83],a[68:71],a[4:7],v[80:83]
R a[100:103],v2,58368
M v[80:83],a[72:75],a[8:11],v[80:83]
buffer_load_dwordx4 v4, s[8:11], s26 offen offset:2048 sc1 lds
M v[80:83],a[76:79],a[12:15],v[80:83]
s_waitcnt lgkmcnt(2)
R a[104:107],v2,59392
M v[80:83],a[80:83],a[16:19],v[80:83]
R a[108:111],v2,60416
M v[80:83],a[84:87],a[20:23],v[80:83]
E v19,v117
M v[80:83],a[88:91],a[24:27],v[80:83]
R a[112:115],v2,61440
AF v29,v18,v29
M v[80:83],a[92:95],a[28:31],v[80:83]
R a[116:119],v2,62464
C v60,v18,v19
M v[84:87],a[92:95],a[60:63],v[36:39]
buffer_load_dwordx4 v4, s[8:11], s26 offen offset:3072 sc1 lds
M v[84:87],a[88:91],a[56:59],v[84:87]
SA s26,s26,32768
R a[120:123],v2,63488
AF v29,v19,v29
M v[84:87],a[84:87],a[52:55],v[84:87]
R a[124:127],v2,64512
M v[84:87],a[80:83],a[48:51],v[84:87]
E v20,v118
M v[84:87],a[76:79],a[44:47],v[84:87]
E v21,v119
M v[84:87],a[72:75],a[40:43],v[84:87]
E v22,v124
M v[84:87],a[68:71],a[36:39],v[84:87]
s_waitcnt vmcnt(17) lgkmcnt(0)
E v23,v125
M v[84:87],a[64:67],a[32:35],v[84:87]
s_barrier
M v[92:95],a[96:99],a[32:35],v[36:39]
R a[64:67],v7,32768
AF v29,v20,v29
M v[92:95],a[100:103],a[36:39],v[92:95]
E v24,v126
M v[92:95],a[104:107],a[40:43],v[92:95]
R a[68:71],v7,33792
C v61,v20,v21
M v[92:95],a[108:111],a[44:47],v[92:95]
AF v29,v21,v29
AF v29,v22,v29
M v[92:95],a[112:115],a[48:51],v[92:95]
R a[72:75],v7,34816
C v62,v22,v23
M v[92:95],a[116:119],a[52:55],v[92:95]
E v25,v127
M v[92:95],a[120:123],a[56:59],v[92:95]
R a[76:79],v7,35840
AF v29,v23,v29
M v[92:95],a[124:127],a[60:63],v[92:95]
AF v29,v24,v29
C v63,v24,v25
M v[88:91],a[124:127],a[28:31],v[32:35]
R a[80:83],v7,36864
AF v29,v25,v29
M v[88:91],a[120:123],a[24:27],v[88:91]
M v[88:91],a[116:119],a[20:23],v[88:91]
R a[84:87],v7,37888
v_max_f32 v10, v28, v29
M v[88:91],a[112:115],a[16:19],v[88:91]
v_cmp_lt_f32 vcc, s31, v10
M v[88:91],a[108:111],a[12:15],v[88:91]
R a[88:91],v7,38912
M v[88:91],a[104:107],a[8:11],v[88:91]
M v[88:91],a[100:103],a[4:7],v[88:91]
s_waitcnt lgkmcnt(3)
R a[92:95],v7,39936
M v[88:91],a[96:99],a[0:3],v[88:91]
s_cbranch_vccnz L_st1
L_rt1:
M v[128:131],a[64:67],v[48:51],v[128:131]
SA m0,s28,98304
R a[96:99],v7,40960
AF v30,v28,v30
M v[128:131],a[68:71],v[56:59],v[128:131]
buffer_load_dwordx4 v3, s[8:11], s21 offen offset:0 sc1 lds
M v[132:135],a[68:71],v[60:63],v[132:135]
R a[100:103],v7,41984
AF v31,v29,v31
M v[132:135],a[64:67],v[52:55],v[132:135]
s_waitcnt lgkmcnt(2)
E v18,v64
M v[140:143],a[72:75],v[52:55],v[140:143]
R a[104:107],v7,43008
M v[140:143],a[76:79],v[60:63],v[140:143]
buffer_load_dwordx4 v3, s[8:11], s21 offen offset:1024 sc1 lds
M v[136:139],a[76:79],v[56:59],v[136:139]
R a[108:111],v7,44032
M v[136:139],a[72:75],v[48:51],v[136:139]
E v19,v65
M v[144:147],a[80:83],v[48:51],v[144:147]
R a[112:115],v7,45056
AF v26,v18,v19
M v[144:147],a[84:87],v[56:59],v[144:147]
E v20,v66
M v[148:151],a[84:87],v[60:63],v[148:151]
R a[116:119],v7,46080
C v40,v18,v19
M v[148:151],a[80:83],v[52:55],v[148:151]
buffer_load_dwordx4 v3, s[8:11], s21 offen offset:2048 sc1 lds
M v[156:159],a[88:91],v[52:55],v[156:159]
R a[120:123],v7,47104
M v[156:159],a[92:95],v[60:63],v[156:159]
E v21,v67
M v[152:155],a[92:95],v[56:59],v[152:155]
R a[124:127],v7,48128
AF v26,v20,v26
M v[152:155],a[88:91],v[48:51],v[152:155]
s_waitcnt lgkmcnt(4)
buffer_load_dwordx4 v3, s[8:11], s21 offen offset:3072 sc1 lds
M v[160:163],a[96:99],v[48:51],v[160:163]
R a[64:67],v7,49152
C v41,v20,v21
M v[160:163],a[100:103],v[56:59],v[160:163]
E v22,v72
M v[164:167],a[100:103],v[60:63],v[164:167]
SA m0,s28,102400
R a[68:71],v7,50176
AF v26,v21,v26
M v[164:167],a[96:99],v[52:55],v[164:167]
s_waitcnt lgkmcnt(2)
buffer_load_dwordx4 v4, s[8:11], s21 offen offset:0 sc1 lds
M v[172:175],a[104:107],v[52:55],v[172:175]
R a[72:75],v7,51200
M v[172:175],a[108:111],v[60:63],v[172:175]
E v23,v73
M v[168:171],a[108:111],v[56:59],v[168:171]
R a[76:79],v7,52224
AF v26,v22,v26
M v[168:171],a[104:107],v[48:51],v[168:171]
E v24,v74
M v[176:179],a[112:115],v[48:51],v[176:179]
R a[80:83],v7,53248
C v42,v22,v23
M v[176:179],a[116:119],v[56:59],v[176:179]
buffer_load_dwordx4 v4, s[8:11], s21 offen offset:1024 sc1 lds
M v[180:183],a[116:119],v[60:63],v[180:183]
R a[84:87],v7,54272
AF v26,v23,v26
M v[180:183],a[112:115],v[52:55],v[180:183]
E v25,v75
M v[188:191],a[120:123],v[52:55],v[188:191]
R a[88:91],v7,55296
AF v26,v24,v26
M v[188:191],a[124:127],v[60:63],v[188:191]
buffer_load_dwordx4 v4, s[8:11], s21 offen offset:2048 sc1 lds
M v[184:187],a[124:127],v[56:59],v[184:187]
R a[92:95],v7,56320
C v43,v24,v25
M v[184:187],a[120:123],v[48:51],v[184:187]
s_waitcnt lgkmcnt(4)
E v18,v68
M v[192:195],a[64:67],v[48:51],v[192:195]
R a[96:99],v7,57344
AF v26,v25,v26
M v[192:195],a[68:71],v[56:59],v[192:195]
R a[100:103],v7,58368
M v[196:199],a[68:71],v[60:63],v[196:199]
buffer_load_dwordx4 v4, s[8:11], s21 offen offset:3072 sc1 lds
M v[196:199],a[64:67],v[52:55],v[196:199]
s_waitcnt lgkmcnt(2)
R a[104:107],v7,59392
M v[204:207],a[72:75],v[52:55],v[204:207]
SA s21,s21,32768
R a[108:111],v7,60416
M v[204:207],a[76:79],v[60:63],v[204:207]
s_sub_u32 s22, s22, 1
E v19,v69
M v[200:203],a[76:79],v[56:59],v[200:203]
s_cselect_b32 s21, s23, s21
R a[112:115],v7,61440
AF v27,v18,v19
M v[200:203],a[72:75],v[48:51],v[200:203]
R a[116:119],v7,62464
C v44,v18,v19
M v[208:211],a[80:83],v[48:51],v[208:211]
E v20,v70
M v[208:211],a[84:87],v[56:59],v[208:211]
R a[120:123],v7,63488
M v[212:215],a[84:87],v[60:63],v[212:215]
R a[124:127],v7,64512
M v[212:215],a[80:83],v[52:55],v[212:215]
E v21,v71
M v[220:223],a[88:91],v[52:55],v[220:223]
E v22,v76
M v[220:223],a[92:95],v[60:63],v[220:223]
AF v27,v20,v27
C v45,v20,v21
M v[216:219],a[92:95],v[56:59],v[216:219]
s_waitcnt vmcnt(17) lgkmcnt(0)
AF v27,v21,v27
M v[216:219],a[88:91],v[48:51],v[216:219]
s_barrier
M v[224:227],a[96:99],v[48:51],v[224:227]
R a[64:67],v2,0
M v[224:227],a[100:103],v[56:59],v[224:227]
E v23,v77
M v[228:231],a[100:103],v[60:63],v[228:231]
R a[68:71],v2,1024
AF v27,v22,v27
M v[228:231],a[96:99],v[52:55],v[228:231]
E v24,v78
M v[236:239],a[104:107],v[52:55],v[236:239]
R a[72:75],v2,2048
C v46,v22,v23
M v[236:239],a[108:111],v[60:63],v[236:239]
AF v27,v23,v27
M v[232:235],a[108:111],v[56:59],v[232:235]
R a[76:79],v2,3072
M v[232:235],a[104:107],v[48:51],v[232:235]
E v25,v79
M v[240:243],a[112:115],v[48:51],v[240:243]
R a[80:83],v2,4096
AF v27,v24,v27
M v[240:243],a[116:119],v[56:59],v[240:243]
C v47,v24,v25
AF v27,v25,v27
M v[244:247],a[116:119],v[60:63],v[244:247]
R a[84:87],v2,5120
M v[244:247],a[112:115],v[52:55],v[244:247]
M v[252:255],a[120:123],v[52:55],v[252:255]
R a[88:91],v2,6144
M v[252:255],a[124:127],v[60:63],v[252:255]
M v[248:251],a[124:127],v[56:59],v[248:251]
s_waitcnt lgkmcnt(3)
R a[92:95],v2,7168
M v[248:251],a[120:123],v[48:51],v[248:251]
M v[96:99],a[64:67],a[0:3],v[32:35]
s_bitcmp1_b32 s39, s7
R a[96:99],v2,8192
M v[96:99],a[68:71],a[4:7],v[96:99]
s_cbranch_scc1 L_fll
L_fllr:
E v18,v80
M v[96:99],a[72:75],a[8:11],v[96:99]
SA m0,s28,32768
R a[100:103],v2,9216
M v[96:99],a[76:79],a[12:15],v[96:99]
s_waitcnt lgkmcnt(2)
buffer_load_dwordx4 v3, s[8:11], s26 offen offset:0 sc1 lds
M v[96:99],a[80:83],a[16:19],v[96:99]
R a[104:107],v2,10240
M v[96:99],a[84:87],a[20:23],v[96:99]
E v19,v81
M v[96:99],a[88:91],a[24:27],v[96:99]
R a[108:111],v2,11264
AF v26,v18,v26
M v[96:99],a[92:95],a[28:31],v[96:99]
E v20,v82
M v[100:103],a[92:95],a[60:63],v[36:39]
R a[112:115],v2,12288
C v56,v18,v19
M v[100:103],a[88:91],a[56:59],v[100:103]
buffer_load_dwordx4 v3, s[8:11], s26 offen offset:1024 sc1 lds
M v[100:103],a[84:87],a[52:55],v[100:103]
R a[116:119],v2,13312
AF v26,v19,v26
M v[100:103],a[80:83],a[48:51],v[100:103]
E v21,v83
M v[100:103],a[76:79],a[44:47],v[100:103]
R a[120:123],v2,14336
AF v26,v20,v26
M v[100:103],a[72:75],a[40:43],v[100:103]
buffer_load_dwordx4 v3, s[8:11], s26 offen offset:2048 sc1 lds
M v[100:103],a[68:71],a[36:39],v[100:103]
R a[124:127],v2,15360
C v57,v20,v21
M v[100:103],a[64:67],a[32:35],v[100:103]
s_waitcnt lgkmcnt(4)
E v22,v88
M v[108:111],a[96:99],a[32:35],v[36:39]
R a[64:67],v2,16384
AF v26,v21,v26
M v[108:111],a[100:103],a[36:39],v[108:111]
E v23,v89
M v[108:111],a[104:107],a[40:43],v[108:111]
R a[68:71],v2,17408
AF v26,v22,v26
M v[108:111],a[108:111],a[44:47],v[108:111]
s_waitcnt lgkmcnt(2)
buffer_load_dwordx4 v3, s[8:11], s26 offen offset:3072 sc1 lds
M v[108:111],a[112:115],a[48:51],v[108:111]
R a[72:75],v2,18432
C v58,v22,v23
M v[108:111],a[116:119],a[52:55],v[108:111]
E v24,v90
M v[108:111],a[120:123],a[56:59],v[108:111]
R a[76:79],v2,19456
AF v26,v23,v26
M v[108:111],a[124:127],a[60:63],v[108:111]
SA m0,s28,36864
M v[104:107],a[124:127],a[28:31],v[32:35]
R a[80:83],v2,20480
M v[104:107],a[120:123],a[24:27],v[104:107]
buffer_load_dwordx4 v4, s[8:11], s26 offen offset:0 sc1 lds
M v[104:107],a[116:119],a[20:23],v[104:107]
R a[84:87],v2,21504
M v[104:107],a[112:115],a[16:19],v[104:107]
E v25,v91
M v[104:107],a[108:111],a[12:15],v[104:107]
R a[88:91],v2,22528
AF v26,v24,v26
M v[104:107],a[104:107],a[8:11],v[104:107]
buffer_load_dwordx4 v4, s[8:11], s26 offen offset:1024 sc1 lds
M v[104:107],a[100:103],a[4:7],v[104:107]
R a[92:95],v2,23552
C v59,v24,v25
M v[104:107],a[96:99],a[0:3],v[104:107]
s_waitcnt lgkmcnt(4)
E v18,v84
M v[112:115],a[64:67],a[0:3],v[32:35]
R a[96:99],v2,24576
AF v26,v25,v26
M v[112:115],a[68:71],a[4:7],v[112:115]
R a[100:103],v2,25600
M v[112:115],a[72:75],a[8:11],v[112:115]
buffer_load_dwordx4 v4, s[8:11], s26 offen offset:2048 sc1 lds
M v[112:115],a[76:79],a[12:15],v[112:115]
s_waitcnt lgkmcnt(2)
R a[104:107],v2,26624
M v[112:115],a[80:83],a[16:19],v[112:115]
R a[108:111],v2,27648
M v[112:115],a[84:87],a[20:23],v[112:115]
E v19,v85
M v[112:115],a[88:91],a[24:27],v[112:115]
R a[112:115],v2,28672
AF v27,v18,v27
M v[112:115],a[92:95],a[28:31],v[112:115]
R a[116:119],v2,29696
C v60,v18,v19
M v[116:119],a[92:95],a[60:63],v[36:39]
buffer_load_dwordx4 v4, s[8:11], s26 offen offset:3072 sc1 lds
M v[116:119],a[88:91],a[56:59],v[116:119]
SA s26,s26,32768
R a[120:123],v2,30720
AF v27,v19,v27
M v[116:119],a[84:87],a[52:55],v[116:119]
R a[124:127],v2,31744
M v[116:119],a[80:83],a[48:51],v[116:119]
E v20,v86
M v[116:119],a[76:79],a[44:47],v[116:119]
E v21,v87
M v[116:119],a[72:75],a[40:43],v[116:119]
E v22,v92
M v[116:119],a[68:71],a[36:39],v[116:119]
s_waitcnt vmcnt(16) lgkmcnt(0)
E v23,v93
M v[116:119],a[64:67],a[32:35],v[116:119]
s_barrier
M v[124:127],a[96:99],a[32:35],v[36:39]
R a[64:67],v7,0
AF v27,v20,v27
M v[124:127],a[100:103],a[36:39],v[124:127]
E v24,v94
M v[124:127],a[104:107],a[40:43],v[124:127]
R a[68:71],v7,1024
C v61,v20,v21
M v[124:127],a[108:111],a[44:47],v[124:127]
AF v27,v21,v27
AF v27,v22,v27
M v[124:127],a[112:115],a[48:51],v[124:127]
R a[72:75],v7,2048
C v62,v22,v23
M v[124:127],a[116:119],a[52:55],v[124:127]
E v25,v95
M v[124:127],a[120:123],a[56:59],v[124:127]
R a[76:79],v7,3072
AF v27,v23,v27
M v[124:127],a[124:127],a[60:63],v[124:127]
AF v27,v24,v27
C v63,v24,v25
M v[120:123],a[124:127],a[28:31],v[32:35]
R a[80:83],v7,4096
AF v27,v25,v27
M v[120:123],a[120:123],a[24:27],v[120:123]
M v[120:123],a[116:119],a[20:23],v[120:123]
R a[84:87],v7,5120
v_max_f32 v10, v26, v27
M v[120:123],a[112:115],a[16:19],v[120:123]
v_cmp_lt_f32 vcc, s31, v10
M v[120:123],a[108:111],a[12:15],v[120:123]
R a[88:91],v7,6144
M v[120:123],a[104:107],a[8:11],v[120:123]
M v[120:123],a[100:103],a[4:7],v[120:123]
s_waitcnt lgkmcnt(3)
R a[92:95],v7,7168
M v[120:123],a[96:99],a[0:3],v[120:123]
s_cbranch_vccnz L_st0
L_rt0:
M v[128:131],a[64:67],v[40:43],v[128:131]
SA m0,s28,65536
R a[96:99],v7,8192
AF v30,v26,v30
M v[128:131],a[68:71],v[56:59],v[128:131]
buffer_load_dwordx4 v3, s[8:11], s21 offen offset:0 sc1 lds
M v[132:135],a[68:71],v[60:63],v[132:135]
R a[100:103],v7,9216
AF v31,v27,v31
M v[132:135],a[64:67],v[44:47],v[132:135]
s_waitcnt lgkmcnt(2)
E v18,v96
M v[140:143],a[72:75],v[44:47],v[140:143]
R a[104:107],v7,10240
M v[140:143],a[76:79],v[60:63],v[140:143]
buffer_load_dwordx4 v3, s[8:11], s21 offen offset:1024 sc1 lds
M v[136:139],a[76:79],v[56:59],v[136:139]
R a[108:111],v7,11264
M v[136:139],a[72:75],v[40:43],v[136:139]
E v19,v97
M v[144:147],a[80:83],v[40:43],v[144:147]
R a[112:115],v7,12288
AF v28,v18,v19
M v[144:147],a[84:87],v[56:59],v[144:147]
E v20,v98
M v[148:151],a[84:87],v[60:63],v[148:151]
R a[116:119],v7,13312
C v48,v18,v19
M v[148:151],a[80:83],v[44:47],v[148:151]
buffer_load_dwordx4 v3, s[8:11], s21 offen offset:2048 sc1 lds
M v[156:159],a[88:91],v[44:47],v[156:159]
R a[120:123],v7,14336
M v[156:159],a[92:95],v[60:63],v[156:159]
E v21,v99
M v[152:155],a[92:95],v[56:59],v[152:155]
R a[124:127],v7,15360
AF v28,v20,v28
M v[152:155],a[88:91],v[40:43],v[152:155]
s_waitcnt lgkmcnt(4)
buffer_load_dwordx4 v3, s[8:11], s21 offen offset:3072 sc1 lds
M v[160:163],a[96:99],v[40:43],v[160:163]
R a[64:67],v7,16384
C v49,v20,v21
M v[160:163],a[100:103],v[56:59],v[160:163]
E v22,v104
M v[164:167],a[100:103],v[60:63],v[164:167]
SA m0,s28,69632
R a[68:71],v7,17408
AF v28,v21,v28
M v[164:167],a[96:99],v[44:47],v[164:167]
s_waitcnt lgkmcnt(2)
buffer_load_dwordx4 v4, s[8:11], s21 offen offset:0 sc1 lds
M v[172:175],a[104:107],v[44:47],v[172:175]
R a[72:75],v7,18432
M v[172:175],a[108:111],v[60:63],v[172:175]
E v23,v105
M v[168:171],a[108:111],v[56:59],v[168:171]
R a[76:79],v7,19456
AF v28,v22,v28
M v[168:171],a[104:107],v[40:43],v[168:171]
E v24,v106
M v[176:179],a[112:115],v[40:43],v[176:179]
R a[80:83],v7,20480
C v50,v22,v23
M v[176:179],a[116:119],v[56:59],v[176:179]
buffer_load_dwordx4 v4, s[8:11], s21 offen offset:1024 sc1 lds
M v[180:183],a[116:119],v[60:63],v[180:183]
R a[84:87],v7,21504
AF v28,v23,v28
M v[180:183],a[112:115],v[44:47],v[180:183]
E v25,v107
M v[188:191],a[120:123],v[44:47],v[188:191]
R a[88:91],v7,22528
AF v28,v24,v28
M v[188:191],a[124:127],v[60:63],v[188:191]
buffer_load_dwordx4 v4, s[8:11], s21 offen offset:2048 sc1 lds
M v[184:187],a[124:127],v[56:59],v[184:187]
R a[92:95],v7,23552
C v51,v24,v25
M v[184:187],a[120:123],v[40:43],v[184:187]
s_waitcnt lgkmcnt(4)
E v18,v100
M v[192:195],a[64:67],v[40:43],v[192:195]
R a[96:99],v7,24576
AF v28,v25,v28
M v[192:195],a[68:71],v[56:59],v[192:195]
R a[100:103],v7,25600
M v[196:199],a[68:71],v[60:63],v[196:199]
buffer_load_dwordx4 v4, s[8:11], s21 offen offset:3072 sc1 lds
M v[196:199],a[64:67],v[44:47],v[196:199]
s_waitcnt lgkmcnt(2)
R a[104:107],v7,26624
M v[204:207],a[72:75],v[44:47],v[204:207]
SA s21,s21,32768
R a[108:111],v7,27648
M v[204:207],a[76:79],v[60:63],v[204:207]
s_sub_u32 s22, s22, 1
E v19,v101
M v[200:203],a[76:79],v[56:59],v[200:203]
s_cselect_b32 s21, s23, s21
R a[112:115],v7,28672
AF v29,v18,v19
M v[200:203],a[72:75],v[40:43],v[200:203]
R a[116:119],v7,29696
C v52,v18,v19
M v[208:211],a[80:83],v[40:43],v[208:211]
E v20,v102
M v[208:211],a[84:87],v[56:59],v[208:211]
R a[120:123],v7,30720
M v[212:215],a[84:87],v[60:63],v[212:215]
R a[124:127],v7,31744
M v[212:215],a[80:83],v[44:47],v[212:215]
E v21,v103
M v[220:223],a[88:91],v[44:47],v[220:223]
E v22,v108
M v[220:223],a[92:95],v[60:63],v[220:223]
AF v29,v20,v29
C v53,v20,v21
M v[216:219],a[92:95],v[56:59],v[216:219]
s_waitcnt vmcnt(16) lgkmcnt(0)
AF v29,v21,v29
M v[216:219],a[88:91],v[40:43],v[216:219]
s_barrier
M v[224:227],a[96:99],v[40:43],v[224:227]
R a[64:67],v2,32768
M v[224:227],a[100:103],v[56:59],v[224:227]
E v23,v109
M v[228:231],a[100:103],v[60:63],v[228:231]
R a[68:71],v2,33792
v_cmp_gt_u32 vcc, s6, v5
M v[228:231],a[96:99],v[44:47],v[228:231]
E v24,v110
M v[236:239],a[104:107],v[44:47],v[236:239]
R a[72:75],v2,34816
AF v29,v22,v29
M v[236:239],a[108:111],v[60:63],v[236:239]
s_cbranch_vccnz L_fls0
L_flr0:
C v54,v22,v23
AF v29,v23,v29
M v[232:235],a[108:111],v[56:59],v[232:235]
s_mov_b32 s6, 0
R a[76:79],v2,35840
M v[232:235],a[104:107],v[40:43],v[232:235]
SA s7,s7,1
E v25,v111
M v[240:243],a[112:115],v[40:43],v[240:243]
R a[80:83],v2,36864
AF v29,v24,v29
M v[240:243],a[116:119],v[56:59],v[240:243]
C v55,v24,v25
AF v29,v25,v29
M v[244:247],a[116:119],v[60:63],v[244:247]
R a[84:87],v2,37888
M v[244:247],a[112:115],v[44:47],v[244:247]
M v[252:255],a[120:123],v[44:47],v[252:255]
s_sub_u32 s27, s27, 1
R a[88:91],v2,38912
M v[252:255],a[124:127],v[60:63],v[252:255]
s_cmp_lg_u32 s27, 0
M v[248:251],a[124:127],v[56:59],v[248:251]
s_waitcnt lgkmcnt(3)
R a[92:95],v2,39936
M v[248:251],a[120:123],v[40:43],v[248:251]
s_cbranch_scc1 L_loop_top
s_cmp_eq_u32 s40, 0
s_cbranch_scc1 L_final_h
L_d1s:
M v[68:71],a[64:67],a[32:35],v[36:39]
s_cmp_lt_u32 s20, 0
R a[96:99],v2,40960
R a[100:103],v2,41984
M v[68:71],a[68:71],a[36:39],v[68:71]
s_cselect_b64 s[82:83], -1, 0
E v18,v112
M v[68:71],a[72:75],a[40:43],v[68:71]
s_cmp_eq_u32 s20, 0
M v[68:71],a[76:79],a[44:47],v[68:71]
s_cselect_b64 s[66:67], s[16:17], s[82:83]
R a[104:107],v2,43008
R a[108:111],v2,44032
s_waitcnt lgkmcnt(7)
M v[68:71],a[80:83],a[48:51],v[68:71]
s_cselect_b64 s[68:69], s[18:19], s[82:83]
E v19,v113
s_waitcnt lgkmcnt(6)
M v[68:71],a[84:87],a[52:55],v[68:71]
s_cselect_b64 s[70:71], s[48:49], s[82:83]
AF v28,v18,v28
C v56,v18,v19
s_waitcnt lgkmcnt(5)
M v[68:71],a[88:91],a[56:59],v[68:71]
s_cselect_b64 s[72:73], s[50:51], s[82:83]
R a[112:115],v2,45056
R a[116:119],v2,46080
v_cndmask_b32 v64, v32, v8, s[66:67]
v_cndmask_b32 v65, v32, v8, s[68:69]
v_cndmask_b32 v66, v32, v8, s[70:71]
v_cndmask_b32 v67, v32, v8, s[72:73]
s_waitcnt lgkmcnt(6)
M v[68:71],a[92:95],a[60:63],v[68:71]
s_mov_b32 s26, s43
v_min_u32 v17, 896, v9
AF v28,v19,v28
M v[64:67],a[92:95],a[28:31],v[64:67]
s_cmp_lt_u32 s20, 1
buffer_load_dword v5, v17, s[8:11], s46 offen sc1
M v[64:67],a[88:91],a[24:27],v[64:67]
s_cselect_b64 s[82:83], -1, 0
R a[120:123],v2,47104
R a[124:127],v2,48128
M v[64:67],a[84:87],a[20:23],v[64:67]
SA m0,s28,0
E v20,v114
M v[64:67],a[80:83],a[16:19],v[64:67]
s_cmp_eq_u32 s20, 1
buffer_load_dwordx4 v3, s[8:11], s26 offen offset:0 sc1 lds
M v[64:67],a[76:79],a[12:15],v[64:67]
s_cselect_b64 s[74:75], s[16:17], s[82:83]
E v21,v115
M v[64:67],a[72:75],a[8:11],v[64:67]
s_cselect_b64 s[76:77], s[18:19], s[82:83]
AF v28,v20,v28
C v57,v20,v21
M v[64:67],a[68:71],a[4:7],v[64:67]
s_cselect_b64 s[78:79], s[48:49], s[82:83]
E v22,v120
M v[64:67],a[64:67],a[0:3],v[64:67]
s_waitcnt lgkmcnt(0)
buffer_load_dwordx4 v3, s[8:11], s26 offen offset:1024 sc1 lds
M v[76:79],a[96:99],a[32:35],v[36:39]
s_cselect_b64 s[80:81], s[50:51], s[82:83]
R a[64:67],v2,49152
R a[68:71],v2,50176
M v[76:79],a[100:103],a[36:39],v[76:79]
v_cndmask_b32 v72, v32, v8, s[74:75]
v_cndmask_b32 v73, v32, v8, s[76:77]
M v[76:79],a[104:107],a[40:43],v[76:79]
v_cndmask_b32 v74, v32, v8, s[78:79]
AF v28,v21,v28
M v[76:79],a[108:111],a[44:47],v[76:79]
R a[72:75],v2,51200
R a[76:79],v2,52224
M v[76:79],a[112:115],a[48:51],v[76:79]
buffer_load_dwordx4 v3, s[8:11], s26 offen offset:2048 sc1 lds
M v[76:79],a[116:119],a[52:55],v[76:79]
v_cndmask_b32 v75, v32, v8, s[80:81]
M v[76:79],a[120:123],a[56:59],v[76:79]
s_cmp_lt_u32 s20, 2
R a[80:83],v2,53248
R a[84:87],v2,54272
M v[76:79],a[124:127],a[60:63],v[76:79]
s_cselect_b64 s[82:83], -1, 0
E v23,v121
M v[72:75],a[124:127],a[28:31],v[72:75]
s_cmp_eq_u32 s20, 2
buffer_load_dwordx4 v3, s[8:11], s26 offen offset:3072 sc1 lds
M v[72:75],a[120:123],a[24:27],v[72:75]
s_cselect_b64 s[66:67], s[16:17], s[82:83]
R a[88:91],v2,55296
R a[92:95],v2,56320
M v[72:75],a[116:119],a[20:23],v[72:75]
s_cselect_b64 s[68:69], s[18:19], s[82:83]
E v24,v122
M v[72:75],a[112:115],a[16:19],v[72:75]
s_cselect_b64 s[70:71], s[48:49], s[82:83]
E v25,v123
M v[72:75],a[108:111],a[12:15],v[72:75]
s_cselect_b64 s[72:73], s[50:51], s[82:83]
v_cndmask_b32 v80, v32, v8, s[66:67]
v_cndmask_b32 v81, v32, v8, s[68:69]
M v[72:75],a[104:107],a[8:11],v[72:75]
SA m0,s28,4096
E v18,v116
M v[72:75],a[100:103],a[4:7],v[72:75]
s_lshl_b32 s86, s20, 14
buffer_load_dwordx4 v4, s[8:11], s26 offen offset:0 sc1 lds
M v[72:75],a[96:99],a[0:3],v[72:75]
s_waitcnt lgkmcnt(0)
v_cndmask_b32 v82, v32, v8, s[70:71]
AF v28,v22,v28
M v[84:87],a[64:67],a[32:35],v[36:39]
SA s86,s86,s34
R a[96:99],v2,57344
R a[100:103],v2,58368
M v[84:87],a[68:71],a[36:39],v[84:87]
SA s87,s86,4096
buffer_load_dwordx4 v4, s[8:11], s26 offen offset:1024 sc1 lds
M v[84:87],a[72:75],a[40:43],v[84:87]
SA s88,s86,8192
v_cndmask_b32 v83, v32, v8, s[72:73]
C v58,v22,v23
M v[84:87],a[76:79],a[44:47],v[84:87]
s_cmp_lt_u32 s20, 3
R a[104:107],v2,59392
R a[108:111],v2,60416
M v[84:87],a[80:83],a[48:51],v[84:87]
s_cselect_b64 s[82:83], -1, 0
E v19,v117
M v[84:87],a[84:87],a[52:55],v[84:87]
SA s89,s86,12288
buffer_load_dwordx4 v4, s[8:11], s26 offen offset:2048 sc1 lds
M v[84:87],a[88:91],a[56:59],v[84:87]
s_lshl_b32 s90, s20, 10
R a[112:115],v2,61440
R a[116:119],v2,62464
M v[84:87],a[92:95],a[60:63],v[84:87]
SA s90,s90,s34
E v20,v118
M v[80:83],a[92:95],a[28:31],v[80:83]
SA s90,s90,65536
E v21,v119
M v[80:83],a[88:91],a[24:27],v[80:83]
s_cmp_eq_u32 s20, 3
R a[120:123],v2,63488
R a[124:127],v2,64512
M v[80:83],a[84:87],a[20:23],v[80:83]
s_cselect_b64 s[74:75], s[16:17], s[82:83]
buffer_load_dwordx4 v4, s[8:11], s26 offen offset:3072 sc1 lds
M v[80:83],a[80:83],a[16:19],v[80:83]
s_cselect_b64 s[76:77], s[18:19], s[82:83]
AF v28,v23,v28
AF v28,v24,v28
M v[80:83],a[76:79],a[12:15],v[80:83]
s_cselect_b64 s[78:79], s[48:49], s[82:83]
E v22,v124
M v[80:83],a[72:75],a[8:11],v[80:83]
s_cselect_b64 s[80:81], s[50:51], s[82:83]
v_cndmask_b32 v88, v32, v8, s[74:75]
v_cndmask_b32 v89, v32, v8, s[76:77]
M v[80:83],a[68:71],a[4:7],v[80:83]
s_waitcnt vmcnt(17) lgkmcnt(0)
v_cndmask_b32 v90, v32, v8, s[78:79]
v_cndmask_b32 v91, v32, v8, s[80:81]
M v[80:83],a[64:67],a[0:3],v[80:83]
s_barrier
M v[92:95],a[96:99],a[32:35],v[36:39]
SA s26,s26,32768
R a[64:67],v7,32768
R a[68:71],v7,33792
M v[92:95],a[100:103],a[36:39],v[92:95]
SA m0,s28,131072
E v23,v125
M v[92:95],a[104:107],a[40:43],v[92:95]
buffer_load_dwordx4 v3, s[8:11], s26 offen offset:0 sc1 lds
M v[92:95],a[108:111],a[44:47],v[92:95]
R a[72:75],v7,34816
R a[76:79],v7,35840
M v[92:95],a[112:115],a[48:51],v[92:95]
C v59,v24,v25
AF v28,v25,v28
M v[92:95],a[116:119],a[52:55],v[92:95]
buffer_load_dwordx4 v3, s[8:11], s26 offen offset:1024 sc1 lds
M v[92:95],a[120:123],a[56:59],v[92:95]
R a[80:83],v7,36864
R a[84:87],v7,37888
M v[92:95],a[124:127],a[60:63],v[92:95]
E v24,v126
M v[88:91],a[124:127],a[28:31],v[88:91]
buffer_load_dwordx4 v3, s[8:11], s26 offen offset:2048 sc1 lds
M v[88:91],a[120:123],a[24:27],v[88:91]
R a[88:91],v7,38912
R a[92:95],v7,39936
M v[88:91],a[116:119],a[20:23],v[88:91]
E v25,v127
M v[88:91],a[112:115],a[16:19],v[88:91]
buffer_load_dwordx4 v3, s[8:11], s26 offen offset:3072 sc1 lds
M v[88:91],a[108:111],a[12:15],v[88:91]
AF v29,v18,v29
C v60,v18,v19
M v[88:91],a[104:107],a[8:11],v[88:91]
AF v29,v19,v29
AF v29,v20,v29
M v[88:91],a[100:103],a[4:7],v[88:91]
s_waitcnt lgkmcnt(0)
C v61,v20,v21
AF v29,v21,v29
M v[88:91],a[96:99],a[0:3],v[88:91]
AF v29,v22,v29
C v62,v22,v23
AF v29,v23,v29
AF v29,v24,v29
C v63,v24,v25
AF v29,v25,v29
v_max_f32 v10, v28, v29
v_cmp_lt_f32 vcc, s31, v10
s_nop 0
s_cbranch_vccnz L_std1
L_rtd1:
s_cmp_lt_u32 s42, 6
s_cbranch_scc1 L_d2h
M v[128:131],a[64:67],v[48:51],v[128:131]
R a[96:99],v7,40960
R a[100:103],v7,41984
M v[128:131],a[68:71],v[56:59],v[128:131]
SA m0,s28,135168
E v18,v64
M v[132:135],a[68:71],v[60:63],v[132:135]
buffer_load_dwordx4 v4, s[8:11], s26 offen offset:0 sc1 lds
M v[132:135],a[64:67],v[52:55],v[132:135]
R a[104:107],v7,43008
R a[108:111],v7,44032
M v[140:143],a[72:75],v[52:55],v[140:143]
s_cmp_gt_u32 s20, 3
E v19,v65
M v[140:143],a[76:79],v[60:63],v[140:143]
s_cselect_b64 s[82:83], -1, 0
AF v30,v28,v30
AF v31,v29,v31
M v[136:139],a[76:79],v[56:59],v[136:139]
s_cmp_eq_u32 s20, 3
R a[112:115],v7,45056
R a[116:119],v7,46080
M v[136:139],a[72:75],v[48:51],v[136:139]
s_cselect_b64 s[66:67], s[16:17], s[82:83]
buffer_load_dwordx4 v4, s[8:11], s26 offen offset:1024 sc1 lds
M v[144:147],a[80:83],v[48:51],v[144:147]
s_cselect_b64 s[68:69], s[18:19], s[82:83]
E v20,v66
M v[144:147],a[84:87],v[56:59],v[144:147]
s_cselect_b64 s[70:71], s[48:49], s[82:83]
R a[120:123],v7,47104
R a[124:127],v7,48128
M v[148:151],a[84:87],v[60:63],v[148:151]
s_cselect_b64 s[72:73], s[50:51], s[82:83]
v_cndmask_b32 v100, v36, v8, s[66:67]
v_cndmask_b32 v101, v36, v8, s[68:69]
M v[148:151],a[80:83],v[52:55],v[148:151]
buffer_load_dwordx4 v4, s[8:11], s26 offen offset:2048 sc1 lds
M v[156:159],a[88:91],v[52:55],v[156:159]
v_cndmask_b32 v102, v36, v8, s[70:71]
AF v26,v18,v19
M v[156:159],a[92:95],v[60:63],v[156:159]
E v21,v67
M v[152:155],a[92:95],v[56:59],v[152:155]
v_cndmask_b32 v103, v36, v8, s[72:73]
C v40,v18,v19
M v[152:155],a[88:91],v[48:51],v[152:155]
s_waitcnt lgkmcnt(0)
buffer_load_dwordx4 v4, s[8:11], s26 offen offset:3072 sc1 lds
M v[160:163],a[96:99],v[48:51],v[160:163]
s_cmp_gt_u32 s20, 2
R a[64:67],v7,49152
R a[68:71],v7,50176
M v[160:163],a[100:103],v[56:59],v[160:163]
s_cselect_b64 s[82:83], -1, 0
v_lshrrev_b32 v14, 7, v7
AF v26,v20,v26
M v[164:167],a[100:103],v[60:63],v[164:167]
s_cmp_eq_u32 s20, 2
v_mul_u32_u24 v14, 896, v14
C v41,v20,v21
M v[164:167],a[96:99],v[52:55],v[164:167]
s_cselect_b64 s[74:75], s[16:17], s[82:83]
R a[72:75],v7,51200
R a[76:79],v7,52224
M v[172:175],a[104:107],v[52:55],v[172:175]
s_cselect_b64 s[76:77], s[18:19], s[82:83]
v_lshrrev_b32 v15, 8, v7
AF v26,v21,v26
M v[172:175],a[108:111],v[60:63],v[172:175]
s_cselect_b64 s[78:79], s[48:49], s[82:83]
v_lshlrev_b32 v15, 5, v15
M v[168:171],a[108:111],v[56:59],v[168:171]
s_cselect_b64 s[80:81], s[50:51], s[82:83]
R a[80:83],v7,53248
R a[84:87],v7,54272
M v[168:171],a[104:107],v[48:51],v[168:171]
v_cndmask_b32 v108, v36, v8, s[74:75]
v_cndmask_b32 v109, v36, v8, s[76:77]
M v[176:179],a[112:115],v[48:51],v[176:179]
v_xor_b32 v15, v15, v7
M v[176:179],a[116:119],v[56:59],v[176:179]
R a[88:91],v7,55296
R a[92:95],v7,56320
M v[180:183],a[116:119],v[60:63],v[180:183]
v_and_b32 v15, 0x70, v15
v_cndmask_b32 v110, v36, v8, s[78:79]
M v[180:183],a[112:115],v[52:55],v[180:183]
v_add_u32 v0, v14, v15
M v[188:191],a[120:123],v[52:55],v[188:191]
s_mul_i32 s38, s20, 57344
v_cndmask_b32 v111, v36, v8, s[80:81]
M v[188:191],a[124:127],v[60:63],v[188:191]
s_cmp_gt_u32 s20, 1
E v22,v72
M v[184:187],a[124:127],v[56:59],v[184:187]
s_cselect_b64 s[82:83], -1, 0
E v23,v73
M v[184:187],a[120:123],v[48:51],v[184:187]
s_waitcnt lgkmcnt(0)
E v24,v74
M v[192:195],a[64:67],v[48:51],v[192:195]
SA m0,s28,98304
R a[96:99],v7,57344
R a[100:103],v7,58368
M v[192:195],a[68:71],v[56:59],v[192:195]
s_cmp_eq_u32 s20, 1
E v25,v75
M v[196:199],a[68:71],v[60:63],v[196:199]
s_cselect_b64 s[66:67], s[16:17], s[82:83]
E v18,v68
M v[196:199],a[64:67],v[52:55],v[196:199]
s_cselect_b64 s[68:69], s[18:19], s[82:83]
R a[104:107],v7,59392
R a[108:111],v7,60416
M v[204:207],a[72:75],v[52:55],v[204:207]
s_cselect_b64 s[70:71], s[48:49], s[82:83]
E v19,v69
M v[204:207],a[76:79],v[60:63],v[204:207]
s_cselect_b64 s[72:73], s[50:51], s[82:83]
v_cndmask_b32 v116, v36, v8, s[66:67]
v_cndmask_b32 v117, v36, v8, s[68:69]
M v[200:203],a[76:79],v[56:59],v[200:203]
SA s85,s38,0
R a[112:115],v7,61440
R a[116:119],v7,62464
M v[200:203],a[72:75],v[48:51],v[200:203]
buffer_load_dwordx4 v0, s[12:15], s85 offen offset:0 lds
M v[208:211],a[80:83],v[48:51],v[208:211]
SA s85,s38,6144
v_cndmask_b32 v118, v36, v8, s[70:71]
AF v26,v22,v26
M v[208:211],a[84:87],v[56:59],v[208:211]
R a[120:123],v7,63488
R a[124:127],v7,64512
M v[212:215],a[84:87],v[60:63],v[212:215]
buffer_load_dwordx4 v0, s[12:15], s85 offen offset:1024 lds
M v[212:215],a[80:83],v[52:55],v[212:215]
SA s85,s38,12288
v_cndmask_b32 v119, v36, v8, s[72:73]
C v42,v22,v23
M v[220:223],a[88:91],v[52:55],v[220:223]
s_cmp_gt_u32 s20, 0
E v20,v70
M v[220:223],a[92:95],v[60:63],v[220:223]
s_cselect_b64 s[82:83], -1, 0
buffer_load_dwordx4 v0, s[12:15], s85 offen offset:2048 lds
M v[216:219],a[92:95],v[56:59],v[216:219]
s_waitcnt vmcnt(20) lgkmcnt(0)
E v21,v71
M v[216:219],a[88:91],v[48:51],v[216:219]
s_barrier
M v[224:227],a[96:99],v[48:51],v[224:227]
SA s85,s38,18432
R a[64:67],v2,0
R a[68:71],v2,1024
M v[224:227],a[100:103],v[56:59],v[224:227]
s_cmp_eq_u32 s20, 0
buffer_load_dwordx4 v0, s[12:15], s85 offen offset:3072 lds
M v[228:231],a[100:103],v[60:63],v[228:231]
s_cselect_b64 s[74:75], s[16:17], s[82:83]
AF v26,v23,v26
AF v26,v24,v26
M v[228:231],a[96:99],v[52:55],v[228:231]
s_cselect_b64 s[76:77], s[18:19], s[82:83]
R a[72:75],v2,2048
R a[76:79],v2,3072
M v[236:239],a[104:107],v[52:55],v[236:239]
s_cselect_b64 s[78:79], s[48:49], s[82:83]
E v22,v76
M v[236:239],a[108:111],v[60:63],v[236:239]
s_cselect_b64 s[80:81], s[50:51], s[82:83]
v_cndmask_b32 v124, v36, v8, s[74:75]
v_cndmask_b32 v125, v36, v8, s[76:77]
M v[232:235],a[108:111],v[56:59],v[232:235]
SA m0,s28,102400
R a[80:83],v2,4096
R a[84:87],v2,5120
M v[232:235],a[104:107],v[48:51],v[232:235]
SA s85,s38,28672
buffer_load_dwordx4 v0, s[12:15], s85 offen offset:0 lds
M v[240:243],a[112:115],v[48:51],v[240:243]
SA s85,s38,34816
v_cndmask_b32 v126, v36, v8, s[78:79]
v_cndmask_b32 v127, v36, v8, s[80:81]
M v[240:243],a[116:119],v[56:59],v[240:243]
R a[88:91],v2,6144
R a[92:95],v2,7168
M v[244:247],a[116:119],v[60:63],v[244:247]
buffer_load_dwordx4 v0, s[12:15], s85 offen offset:1024 lds
M v[244:247],a[112:115],v[52:55],v[244:247]
SA s85,s38,40960
E v23,v77
M v[252:255],a[120:123],v[52:55],v[252:255]
buffer_load_dwordx4 v0, s[12:15], s85 offen offset:2048 lds
M v[252:255],a[124:127],v[60:63],v[252:255]
SA s85,s38,47104
C v43,v24,v25
AF v26,v25,v26
M v[248:251],a[124:127],v[56:59],v[248:251]
s_waitcnt lgkmcnt(0)
E v24,v78
M v[248:251],a[120:123],v[48:51],v[248:251]
buffer_load_dwordx4 v0, s[12:15], s85 offen offset:3072 lds
SA s38,s38,128
AF v27,v18,v19
C v44,v18,v19
AF v27,v20,v27
C v45,v20,v21
AF v27,v21,v27
E v25,v79
AF v27,v22,v27
C v46,v22,v23
AF v27,v23,v27
AF v27,v24,v27
C v47,v24,v25
AF v27,v25,v27
M v[100:103],a[64:67],a[32:35],v[100:103]
R a[96:99],v2,8192
R a[100:103],v2,9216
M v[100:103],a[68:71],a[36:39],v[100:103]
R a[104:107],v2,10240
R a[108:111],v2,11264
M v[100:103],a[72:75],a[40:43],v[100:103]
R a[112:115],v2,12288
R a[116:119],v2,13312
M v[100:103],a[76:79],a[44:47],v[100:103]
R a[120:123],v2,14336
R a[124:127],v2,15360
M v[100:103],a[80:83],a[48:51],v[100:103]
v_add_u32 v8, 0x20000, v7
M v[100:103],a[84:87],a[52:55],v[100:103]
SA m0,s28,32768
E v18,v80
M v[100:103],a[88:91],a[56:59],v[100:103]
SA s85,s38,0
buffer_load_dwordx4 v0, s[12:15], s85 offen offset:0 lds
M v[100:103],a[92:95],a[60:63],v[100:103]
s_waitcnt lgkmcnt(0)
E v19,v81
M v[108:111],a[96:99],a[32:35],v[108:111]
SA s85,s38,6144
R a[64:67],v2,16384
R a[68:71],v2,17408
M v[108:111],a[100:103],a[36:39],v[108:111]
R a[72:75],v2,18432
R a[76:79],v2,19456
M v[108:111],a[104:107],a[40:43],v[108:111]
R a[80:83],v2,20480
R a[84:87],v2,21504
M v[108:111],a[108:111],a[44:47],v[108:111]
R a[88:91],v2,22528
R a[92:95],v2,23552
M v[108:111],a[112:115],a[48:51],v[108:111]
buffer_load_dwordx4 v0, s[12:15], s85 offen offset:1024 lds
M v[108:111],a[116:119],a[52:55],v[108:111]
SA s85,s38,12288
E v20,v82
M v[108:111],a[120:123],a[56:59],v[108:111]
buffer_load_dwordx4 v0, s[12:15], s85 offen offset:2048 lds
M v[108:111],a[124:127],a[60:63],v[108:111]
s_waitcnt lgkmcnt(0)
E v21,v83
M v[116:119],a[64:67],a[32:35],v[116:119]
SA s85,s38,18432
R a[96:99],v2,24576
R a[100:103],v2,25600
M v[116:119],a[68:71],a[36:39],v[116:119]
R a[104:107],v2,26624
R a[108:111],v2,27648
M v[116:119],a[72:75],a[40:43],v[116:119]
R a[112:115],v2,28672
R a[116:119],v2,29696
M v[116:119],a[76:79],a[44:47],v[116:119]
R a[120:123],v2,30720
R a[124:127],v2,31744
M v[116:119],a[80:83],a[48:51],v[116:119]
buffer_load_dwordx4 v0, s[12:15], s85 offen offset:3072 lds
M v[116:119],a[84:87],a[52:55],v[116:119]
buffer_load_dword v6, off, s[8:11], s47 sc1
M v[116:119],a[88:91],a[56:59],v[116:119]
s_waitcnt vmcnt(21) lgkmcnt(0)
E v22,v88
M v[116:119],a[92:95],a[60:63],v[116:119]
s_barrier
M v[124:127],a[96:99],a[32:35],v[124:127]
R a[64:67],v7,0
R a[68:71],v7,1024
M v[124:127],a[100:103],a[36:39],v[124:127]
R a[72:75],v7,2048
R a[76:79],v7,3072
M v[124:127],a[104:107],a[40:43],v[124:127]
R a[80:83],v7,4096
R a[84:87],v7,5120
M v[124:127],a[108:111],a[44:47],v[124:127]
R a[88:91],v7,6144
R a[92:95],v7,7168
M v[124:127],a[112:115],a[48:51],v[124:127]
E v23,v89
M v[124:127],a[116:119],a[52:55],v[124:127]
E v24,v90
M v[124:127],a[120:123],a[56:59],v[124:127]
s_waitcnt lgkmcnt(0)
E v25,v91
M v[124:127],a[124:127],a[60:63],v[124:127]
AF v26,v18,v26
C v56,v18,v19
AF v26,v19,v26
AF v26,v20,v26
C v57,v20,v21
AF v26,v21,v26
AF v26,v22,v26
C v58,v22,v23
AF v26,v23,v26
E v18,v84
E v19,v85
AF v26,v24,v26
C v59,v24,v25
AF v26,v25,v26
E v20,v86
E v21,v87
AF v27,v18,v27
C v60,v18,v19
AF v27,v19,v27
E v22,v92
E v23,v93
AF v27,v20,v27
C v61,v20,v21
AF v27,v21,v27
E v24,v94
E v25,v95
AF v27,v22,v27
C v62,v22,v23
AF v27,v23,v27
AF v27,v24,v27
C v63,v24,v25
AF v27,v25,v27
v_max_f32 v10, v26, v27
v_cmp_lt_f32 vcc, s31, v10
s_nop 0
s_cbranch_vccnz L_std3n
L_rtd3n:
M v[128:131],a[64:67],v[40:43],v[128:131]
R a[96:99],v7,8192
R a[100:103],v7,9216
M v[128:131],a[68:71],v[56:59],v[128:131]
v_or_b32 v9, s35, v7
s_waitcnt vmcnt(0)
v_cmp_ne_u32 vcc, 1, v6
M v[132:135],a[68:71],v[60:63],v[132:135]
s_cbranch_vccnz L_fps
L_fpr:
E v18,v100
M v[132:135],a[64:67],v[44:47],v[132:135]
R a[104:107],v7,10240
R a[108:111],v7,11264
M v[140:143],a[72:75],v[44:47],v[140:143]
buffer_load_dwordx4 v[14:17], v9, s[8:11], s90 offen sc1
M v[140:143],a[76:79],v[60:63],v[140:143]
E v19,v101
M v[136:139],a[76:79],v[56:59],v[136:139]
R a[112:115],v7,12288
R a[116:119],v7,13312
M v[136:139],a[72:75],v[40:43],v[136:139]
buffer_load_dwordx4 a[160:163], v9, s[8:11], s88 offen offset:0 sc1
M v[144:147],a[80:83],v[40:43],v[144:147]
E v20,v102
M v[144:147],a[84:87],v[56:59],v[144:147]
R a[120:123],v7,14336
R a[124:127],v7,15360
M v[148:151],a[84:87],v[60:63],v[148:151]
buffer_load_dwordx4 a[128:131], v9, s[8:11], s86 offen offset:0 sc1
M v[148:151],a[80:83],v[44:47],v[148:151]
E v21,v103
M v[156:159],a[88:91],v[44:47],v[156:159]
AF v30,v26,v30
AF v31,v27,v31
M v[156:159],a[92:95],v[60:63],v[156:159]
buffer_load_dwordx4 a[164:167], v9, s[8:11], s88 offen offset:1024 sc1
M v[152:155],a[92:95],v[56:59],v[152:155]
AF v29,v18,v19
C v52,v18,v19
M v[152:155],a[88:91],v[40:43],v[152:155]
s_waitcnt lgkmcnt(0)
E v22,v108
M v[160:163],a[96:99],v[40:43],v[160:163]
R a[64:67],v7,16384
R a[68:71],v7,17408
M v[160:163],a[100:103],v[56:59],v[160:163]
buffer_load_dwordx4 a[132:135], v9, s[8:11], s86 offen offset:1024 sc1
M v[164:167],a[100:103],v[60:63],v[164:167]
E v23,v109
M v[164:167],a[96:99],v[44:47],v[164:167]
R a[72:75],v7,18432
R a[76:79],v7,19456
M v[172:175],a[104:107],v[44:47],v[172:175]
buffer_load_dwordx4 a[168:171], v9, s[8:11], s88 offen offset:2048 sc1
M v[172:175],a[108:111],v[60:63],v[172:175]
AF v29,v20,v29
C v53,v20,v21
M v[168:171],a[108:111],v[56:59],v[168:171]
R a[80:83],v7,20480
R a[84:87],v7,21504
M v[168:171],a[104:107],v[40:43],v[168:171]
buffer_load_dwordx4 a[136:139], v9, s[8:11], s86 offen offset:2048 sc1
M v[176:179],a[112:115],v[40:43],v[176:179]
E v24,v110
M v[176:179],a[116:119],v[56:59],v[176:179]
R a[88:91],v7,22528
R a[92:95],v7,23552
M v[180:183],a[116:119],v[60:63],v[180:183]
buffer_load_dwordx4 a[172:175], v9, s[8:11], s88 offen offset:3072 sc1
M v[180:183],a[112:115],v[44:47],v[180:183]
E v25,v111
M v[188:191],a[120:123],v[44:47],v[188:191]
AF v29,v21,v29
AF v29,v22,v29
M v[188:191],a[124:127],v[60:63],v[188:191]
buffer_load_dwordx4 a[140:143], v9, s[8:11], s86 offen offset:3072 sc1
M v[184:187],a[124:127],v[56:59],v[184:187]
E v18,v116
M v[184:187],a[120:123],v[40:43],v[184:187]
s_waitcnt lgkmcnt(0)
C v54,v22,v23
AF v29,v23,v29
M v[192:195],a[64:67],v[40:43],v[192:195]
R a[96:99],v7,24576
R a[100:103],v7,25600
M v[192:195],a[68:71],v[56:59],v[192:195]
buffer_load_dwordx4 a[176:179], v9, s[8:11], s89 offen offset:0 sc1
M v[196:199],a[68:71],v[60:63],v[196:199]
E v19,v117
M v[196:199],a[64:67],v[44:47],v[196:199]
R a[104:107],v7,26624
R a[108:111],v7,27648
M v[204:207],a[72:75],v[44:47],v[204:207]
buffer_load_dwordx4 a[144:147], v9, s[8:11], s87 offen offset:0 sc1
M v[204:207],a[76:79],v[60:63],v[204:207]
E v20,v118
M v[200:203],a[76:79],v[56:59],v[200:203]
R a[112:115],v7,28672
R a[116:119],v7,29696
M v[200:203],a[72:75],v[40:43],v[200:203]
buffer_load_dwordx4 a[180:183], v9, s[8:11], s89 offen offset:1024 sc1
M v[208:211],a[80:83],v[40:43],v[208:211]
AF v29,v24,v29
C v55,v24,v25
M v[208:211],a[84:87],v[56:59],v[208:211]
R a[120:123],v7,30720
R a[124:127],v7,31744
M v[212:215],a[84:87],v[60:63],v[212:215]
buffer_load_dwordx4 a[148:151], v9, s[8:11], s87 offen offset:1024 sc1
M v[212:215],a[80:83],v[44:47],v[212:215]
E v21,v119
M v[220:223],a[88:91],v[44:47],v[220:223]
AF v29,v25,v29
AF v29,v18,v29
M v[220:223],a[92:95],v[60:63],v[220:223]
buffer_load_dwordx4 a[184:187], v9, s[8:11], s89 offen offset:2048 sc1
M v[216:219],a[92:95],v[56:59],v[216:219]
s_waitcnt lgkmcnt(0)
E v22,v124
M v[216:219],a[88:91],v[40:43],v[216:219]
s_barrier
M v[224:227],a[96:99],v[40:43],v[224:227]
R a[64:67],v8,0
R a[68:71],v8,1024
M v[224:227],a[100:103],v[56:59],v[224:227]
buffer_load_dwordx4 a[152:155], v9, s[8:11], s87 offen offset:2048 sc1
M v[228:231],a[100:103],v[60:63],v[228:231]
E v23,v125
M v[228:231],a[96:99],v[44:47],v[228:231]
R a[72:75],v8,2048
R a[76:79],v8,3072
M v[236:239],a[104:107],v[44:47],v[236:239]
buffer_load_dwordx4 a[188:191], v9, s[8:11], s89 offen offset:3072 sc1
M v[236:239],a[108:111],v[60:63],v[236:239]
E v24,v126
M v[232:235],a[108:111],v[56:59],v[232:235]
R a[80:83],v8,4096
R a[84:87],v8,5120
M v[232:235],a[104:107],v[40:43],v[232:235]
buffer_load_dwordx4 a[156:159], v9, s[8:11], s87 offen offset:3072 sc1
M v[240:243],a[112:115],v[40:43],v[240:243]
E v25,v127
M v[240:243],a[116:119],v[56:59],v[240:243]
R a[88:91],v8,6144
R a[92:95],v8,7168
M v[244:247],a[116:119],v[60:63],v[244:247]
C v48,v18,v19
AF v29,v19,v29
M v[244:247],a[112:115],v[44:47],v[244:247]
AF v29,v20,v29
C v49,v20,v21
M v[252:255],a[120:123],v[44:47],v[252:255]
AF v29,v21,v29
AF v29,v22,v29
M v[252:255],a[124:127],v[60:63],v[252:255]
C v50,v22,v23
AF v29,v23,v29
M v[248:251],a[124:127],v[56:59],v[248:251]
s_waitcnt lgkmcnt(0)
AF v29,v24,v29
C v51,v24,v25
M v[248:251],a[120:123],v[40:43],v[248:251]
AF v29,v25,v29
v_cmp_lt_f32 vcc, s31, v29
s_nop 0
s_cbranch_vccnz L_std4n
L_rtd4n:
s_waitcnt vmcnt(16)
v_cmp_neq_f32 vcc, v32, v14
v_cmp_neq_f32 s[64:65], v36, v15
s_cmp_eq_u32 s35, 0
s_cselect_b64 s[66:67], -1, 0
s_or_b64 vcc, vcc, s[64:65]
s_and_b64 vcc, vcc, s[66:67]
s_cbranch_vccnz L_stc
L_rtc:
M v[132:135],a[64:67],v[52:55],v[132:135]
R a[96:99],v8,8192
R a[100:103],v8,9216
M v[132:135],a[68:71],v[48:51],v[132:135]
s_waitcnt vmcnt(12)
AF v30,v16,v30
AF v31,v17,v31
M v[132:135],a[246:249],a[160:163],v[132:135]
SA m0,s28,36864
AF v31,v29,v31
v_mov_b32 v10, v30
M v[128:131],a[246:249],a[128:131],v[128:131]
SA s85,s38,28672
R a[104:107],v8,10240
R a[108:111],v8,11264
M v[140:143],a[72:75],v[52:55],v[140:143]
buffer_load_dwordx4 v0, s[12:15], s85 offen offset:0 lds
M v[140:143],a[76:79],v[48:51],v[140:143]
SA s85,s38,34816
v_mov_b32 v11, v31
M v[140:143],a[244:247],a[160:163],v[140:143]
R a[112:115],v8,12288
R a[116:119],v8,13312
M v[136:139],a[244:247],a[128:131],v[136:139]
v_permlane16_swap_b32 v10, v30
M v[148:151],a[80:83],v[52:55],v[148:151]
v_permlane16_swap_b32 v11, v31
M v[148:151],a[84:87],v[48:51],v[148:151]
R a[120:123],v8,14336
R a[124:127],v8,15360
M v[148:151],a[246:249],a[164:167],v[148:151]
buffer_load_dwordx4 v0, s[12:15], s85 offen offset:1024 lds
M v[144:147],a[246:249],a[132:135],v[144:147]
SA s85,s38,40960
AF v30,v10,v30
AF v31,v11,v31
M v[156:159],a[88:91],v[52:55],v[156:159]
v_mov_b32 v10, v30
v_mov_b32 v11, v31
M v[156:159],a[92:95],v[48:51],v[156:159]
buffer_load_dwordx4 v0, s[12:15], s85 offen offset:2048 lds
M v[156:159],a[244:247],a[164:167],v[156:159]
s_waitcnt vmcnt(11)
v_permlane32_swap_b32 v10, v30
M v[152:155],a[244:247],a[132:135],v[152:155]
s_waitcnt lgkmcnt(0)
v_permlane32_swap_b32 v11, v31
M v[164:167],a[96:99],v[52:55],v[164:167]
SA s85,s38,47104
R a[64:67],v8,16384
R a[68:71],v8,17408
M v[164:167],a[100:103],v[48:51],v[164:167]
buffer_load_dwordx4 v0, s[12:15], s85 offen offset:3072 lds
M v[164:167],a[246:249],a[168:171],v[164:167]
SA s38,s38,128
C v132,v132,v133
C v133,v134,v135
M v[160:163],a[246:249],a[136:139],v[160:163]
SA m0,s28,65536
R a[72:75],v8,18432
R a[76:79],v8,19456
AF v30,v10,v30
AF v31,v11,v31
v_rcp_f32 v5, v30
v_rcp_f32 v6, v31
M v[172:175],a[104:107],v[52:55],v[172:175]
SA s85,s38,0
buffer_load_dwordx4 v0, s[12:15], s85 offen offset:0 lds
M v[172:175],a[108:111],v[48:51],v[172:175]
SA s85,s38,6144
C v134,v140,v141
C v135,v142,v143
M v[172:175],a[244:247],a[168:171],v[172:175]
R a[80:83],v8,20480
R a[84:87],v8,21504
M v[168:171],a[244:247],a[136:139],v[168:171]
buffer_load_dwordx4 v0, s[12:15], s85 offen offset:1024 lds
M v[180:183],a[112:115],v[52:55],v[180:183]
SA s85,s38,12288
C v128,v128,v129
C v129,v130,v131
M v[180:183],a[116:119],v[48:51],v[180:183]
R a[88:91],v8,22528
R a[92:95],v8,23552
M v[180:183],a[246:249],a[172:175],v[180:183]
buffer_load_dwordx4 v0, s[12:15], s85 offen offset:2048 lds
M v[176:179],a[246:249],a[140:143],v[176:179]
SA s85,s38,18432
C v130,v136,v137
C v131,v138,v139
M v[188:191],a[120:123],v[52:55],v[188:191]
C v148,v148,v149
C v149,v150,v151
M v[188:191],a[124:127],v[48:51],v[188:191]
buffer_load_dwordx4 v0, s[12:15], s85 offen offset:3072 lds
M v[188:191],a[244:247],a[172:175],v[188:191]
s_waitcnt vmcnt(12)
C v150,v156,v157
C v151,v158,v159
M v[184:187],a[244:247],a[140:143],v[184:187]
s_waitcnt lgkmcnt(0)
C v144,v144,v145
C v145,v146,v147
M v[196:199],a[64:67],v[52:55],v[196:199]
SA m0,s28,69632
R a[96:99],v8,24576
R a[100:103],v8,25600
M v[196:199],a[68:71],v[48:51],v[196:199]
SA s85,s38,28672
buffer_load_dwordx4 v0, s[12:15], s85 offen offset:0 lds
M v[196:199],a[246:249],a[176:179],v[196:199]
SA s85,s38,34816
C v146,v152,v153
C v147,v154,v155
M v[192:195],a[246:249],a[144:147],v[192:195]
R a[104:107],v8,26624
R a[108:111],v8,27648
M v[204:207],a[72:75],v[52:55],v[204:207]
buffer_load_dwordx4 v0, s[12:15], s85 offen offset:1024 lds
M v[204:207],a[76:79],v[48:51],v[204:207]
SA s85,s38,40960
v_lshrrev_b32 v16, 4, v7
v_lshrrev_b32 v14, 2, v16
M v[204:207],a[244:247],a[176:179],v[204:207]
R a[112:115],v8,28672
R a[116:119],v8,29696
M v[200:203],a[244:247],a[144:147],v[200:203]
buffer_load_dwordx4 v0, s[12:15], s85 offen offset:2048 lds
M v[212:215],a[80:83],v[52:55],v[212:215]
SA s85,s38,47104
v_lshlrev_b32 v14, 7, v14
v_and_b32 v15, 3, v16
M v[212:215],a[84:87],v[48:51],v[212:215]
R a[120:123],v8,30720
R a[124:127],v8,31744
M v[212:215],a[246:249],a[180:183],v[212:215]
buffer_load_dwordx4 v0, s[12:15], s85 offen offset:3072 lds
M v[208:211],a[246:249],a[148:151],v[208:211]
SA s38,s38,128
v_lshl_add_u32 v14, v15, 3, v14
C v164,v164,v165
M v[220:223],a[88:91],v[52:55],v[220:223]
C v165,v166,v167
C v166,v172,v173
M v[220:223],a[92:95],v[48:51],v[220:223]
s_waitcnt vmcnt(12)
C v167,v174,v175
C v160,v160,v161
M v[220:223],a[244:247],a[180:183],v[220:223]
s_waitcnt lgkmcnt(0)
v_bfe_u32 v15, v16, 3, 2
v_lshl_add_u32 v18, v15, 5, v14
v_xor_b32 v19, 32, v18
v_xor_b32 v20, 64, v18
v_xor_b32 v21, 0x60, v18
v_add_u32 v22, 0x10000, v18
v_add_u32 v23, 0x10000, v19
v_add_u32 v24, 0x10000, v20
v_add_u32 v25, 0x10000, v21
M v[216:219],a[244:247],a[148:151],v[216:219]
s_barrier
M v[228:231],a[96:99],v[52:55],v[228:231]
s_nop 0
T a[64:65],v22,32768
T a[66:67],v22,34816
M v[228:231],a[100:103],v[48:51],v[228:231]
T a[68:69],v22,36864
T a[70:71],v22,38912
M v[228:231],a[246:249],a[184:187],v[228:231]
C v161,v162,v163
C v162,v168,v169
M v[224:227],a[246:249],a[152:155],v[224:227]
T a[72:73],v22,40960
T a[74:75],v22,43008
M v[236:239],a[104:107],v[52:55],v[236:239]
T a[76:77],v22,45056
T a[78:79],v22,47104
M v[236:239],a[108:111],v[48:51],v[236:239]
C v163,v170,v171
C v180,v180,v181
M v[236:239],a[244:247],a[184:187],v[236:239]
T a[80:81],v22,49152
T a[82:83],v22,51200
M v[232:235],a[244:247],a[152:155],v[232:235]
T a[84:85],v22,53248
T a[86:87],v22,55296
M v[244:247],a[112:115],v[52:55],v[244:247]
C v181,v182,v183
C v182,v188,v189
M v[244:247],a[116:119],v[48:51],v[244:247]
T a[88:89],v22,57344
T a[90:91],v22,59392
M v[244:247],a[246:249],a[188:191],v[244:247]
T a[92:93],v22,61440
T a[94:95],v22,63488
M v[240:243],a[246:249],a[156:159],v[240:243]
C v183,v190,v191
C v176,v176,v177
M v[252:255],a[120:123],v[52:55],v[252:255]
C v177,v178,v179
C v178,v184,v185
M v[252:255],a[124:127],v[48:51],v[252:255]
C v179,v186,v187
C v196,v196,v197
M v[252:255],a[244:247],a[188:191],v[252:255]
s_waitcnt lgkmcnt(0)
C v197,v198,v199
C v198,v204,v205
M v[248:251],a[244:247],a[156:159],v[248:251]
C v199,v206,v207
C v192,v192,v193
C v193,v194,v195
C v194,v200,v201
C v195,v202,v203
C v212,v212,v213
C v213,v214,v215
C v214,v220,v221
C v215,v222,v223
C v208,v208,v209
C v209,v210,v211
C v210,v216,v217
C v211,v218,v219
C v228,v228,v229
C v229,v230,v231
C v230,v236,v237
C v231,v238,v239
C v224,v224,v225
C v225,v226,v227
C v226,v232,v233
C v227,v234,v235
C v244,v244,v245
C v245,v246,v247
C v246,v252,v253
C v247,v254,v255
C v240,v240,v241
C v241,v242,v243
C v242,v248,v249
C v243,v250,v251
M v[64:67],a[64:67],v[128:131],0
s_sub_u32 s64, 15, s42
T a[96:97],v23,32768
T a[98:99],v23,34816
M v[64:67],a[68:71],v[144:147],v[64:67]
s_min_u32 s64, s64, s42
T a[100:101],v23,36864
T a[102:103],v23,38912
M v[64:67],a[72:75],v[160:163],v[64:67]
s_mul_i32 s45, s64, 8704
M v[64:67],a[76:79],v[176:179],v[64:67]
s_lshl_b32 s64, s41, 2
T a[104:105],v23,40960
T a[106:107],v23,43008
M v[64:67],a[80:83],v[192:195],v[64:67]
SA s45,s45,s64
T a[108:109],v23,45056
T a[110:111],v23,47104
M v[64:67],a[84:87],v[208:211],v[64:67]
s_lshl_b32 s64, s20, 8
M v[64:67],a[88:91],v[224:227],v[64:67]
SA s45,s45,s64
T a[112:113],v23,49152
T a[114:115],v23,51200
M v[64:67],a[92:95],v[240:243],v[64:67]
SA s45,s45,104992768
T a[116:117],v23,53248
T a[118:119],v23,55296
M v[68:71],a[92:95],v[244:247],0
s_mov_b32 s64, 1024
M v[68:71],a[88:91],v[228:231],v[68:71]
s_mov_b32 s66, 4096
T a[120:121],v23,57344
T a[122:123],v23,59392
M v[68:71],a[84:87],v[212:215],v[68:71]
s_cmp_lt_u32 s42, 8
T a[124:125],v23,61440
T a[126:127],v23,63488
M v[68:71],a[80:83],v[196:199],v[68:71]
s_cselect_b32 s64, 4352, s64
M v[68:71],a[76:79],v[180:183],v[68:71]
s_cselect_b32 s65, 0, 64
M v[68:71],a[72:75],v[164:167],v[68:71]
s_cselect_b32 s66, 536870912, s66
M v[68:71],a[68:71],v[148:151],v[68:71]
SA s3,s45,s64
M v[68:71],a[64:67],v[132:135],v[68:71]
s_waitcnt lgkmcnt(0)
M v[72:75],a[96:99],v[128:131],0
SA s45,s45,s65
T a[64:65],v24,32768
T a[66:67],v24,34816
M v[72:75],a[100:103],v[144:147],v[72:75]
SA m0,s28,0
T a[68:69],v24,36864
T a[70:71],v24,38912
M v[72:75],a[104:107],v[160:163],v[72:75]
SA s85,s38,0
buffer_load_dwordx4 v0, s[12:15], s85 offen offset:0 lds
M v[72:75],a[108:111],v[176:179],v[72:75]
SA s85,s38,6144
T a[72:73],v24,40960
T a[74:75],v24,43008
M v[72:75],a[112:115],v[192:195],v[72:75]
SA s29,s33,0
T a[76:77],v24,45056
T a[78:79],v24,47104
M v[72:75],a[116:119],v[208:211],v[72:75]
SA s30,s33,14336
buffer_load_dwordx4 v0, s[12:15], s85 offen offset:1024 lds
M v[72:75],a[120:123],v[224:227],v[72:75]
SA s85,s38,12288
T a[80:81],v24,49152
T a[82:83],v24,51200
M v[72:75],a[124:127],v[240:243],v[72:75]
T a[84:85],v24,53248
T a[86:87],v24,55296
M v[76:79],a[124:127],v[244:247],0
buffer_load_dwordx4 v0, s[12:15], s85 offen offset:2048 lds
M v[76:79],a[120:123],v[228:231],v[76:79]
SA s85,s38,18432
T a[88:89],v24,57344
T a[90:91],v24,59392
M v[76:79],a[116:119],v[212:215],v[76:79]
T a[92:93],v24,61440
T a[94:95],v24,63488
M v[76:79],a[112:115],v[196:199],v[76:79]
buffer_load_dwordx4 v0, s[12:15], s85 offen offset:3072 lds
M v[76:79],a[108:111],v[180:183],v[76:79]
SA m0,s28,4096
v_lshrrev_b32 v17, 5, v7
v_min_u32 v15, 1, v17
M v[76:79],a[104:107],v[164:167],v[76:79]
SA s85,s38,28672
buffer_load_dwordx4 v0, s[12:15], s85 offen offset:0 lds
M v[76:79],a[100:103],v[148:151],v[76:79]
SA s85,s38,34816
v_lshlrev_b32 v14, 3, v7
v_lshl_or_b32 v16, v15, 29, v14
M v[76:79],a[96:99],v[132:135],v[76:79]
s_waitcnt lgkmcnt(0)
buffer_load_dwordx4 v0, s[12:15], s85 offen offset:1024 lds
M v[80:83],a[64:67],v[128:131],0
SA s85,s38,40960
T a[96:97],v25,32768
T a[98:99],v25,34816
M v[80:83],a[68:71],v[144:147],v[80:83]
T a[100:101],v25,36864
T a[102:103],v25,38912
M v[80:83],a[72:75],v[160:163],v[80:83]
buffer_load_dwordx4 v0, s[12:15], s85 offen offset:2048 lds
M v[80:83],a[76:79],v[176:179],v[80:83]
SA s85,s38,47104
T a[104:105],v25,40960
T a[106:107],v25,43008
M v[80:83],a[80:83],v[192:195],v[80:83]
T a[108:109],v25,45056
T a[110:111],v25,47104
M v[80:83],a[84:87],v[208:211],v[80:83]
buffer_load_dwordx4 v0, s[12:15], s85 offen offset:3072 lds
M v[80:83],a[88:91],v[224:227],v[80:83]
SA s38,s38,128
T a[112:113],v25,49152
T a[114:115],v25,51200
M v[80:83],a[92:95],v[240:243],v[80:83]
SA m0,s28,131072
T a[116:117],v25,53248
T a[118:119],v25,55296
M v[84:87],a[92:95],v[244:247],0
SA s85,s38,0
buffer_load_dwordx4 v0, s[12:15], s85 offen offset:0 lds
M v[84:87],a[88:91],v[228:231],v[84:87]
SA s85,s38,6144
T a[120:121],v25,57344
T a[122:123],v25,59392
M v[84:87],a[84:87],v[212:215],v[84:87]
T a[124:125],v25,61440
T a[126:127],v25,63488
M v[84:87],a[80:83],v[196:199],v[84:87]
buffer_load_dwordx4 v0, s[12:15], s85 offen offset:1024 lds
M v[84:87],a[76:79],v[180:183],v[84:87]
SA s85,s38,12288
v_cmp_eq_u32 vcc, 1, v17
v_add_u32 v14, s66, v14
M v[84:87],a[72:75],v[164:167],v[84:87]
buffer_load_dwordx4 v0, s[12:15], s85 offen offset:2048 lds
M v[84:87],a[68:71],v[148:151],v[84:87]
s_waitcnt vmcnt(19) lgkmcnt(0)
v_mov_b32 v15, 1
v_cndmask_b32 v17, v16, v14, vcc
M v[84:87],a[64:67],v[132:135],v[84:87]
s_barrier
M v[88:91],a[96:99],v[128:131],0
SA s85,s38,18432
T a[64:65],v18,32768
T a[66:67],v18,34816
M v[88:91],a[100:103],v[144:147],v[88:91]
T a[68:69],v18,36864
T a[70:71],v18,38912
M v[88:91],a[104:107],v[160:163],v[88:91]
buffer_load_dwordx4 v0, s[12:15], s85 offen offset:3072 lds
M v[88:91],a[108:111],v[176:179],v[88:91]
SA m0,s28,135168
T a[72:73],v18,40960
T a[74:75],v18,43008
M v[88:91],a[112:115],v[192:195],v[88:91]
SA s85,s38,28672
T a[76:77],v18,45056
T a[78:79],v18,47104
M v[88:91],a[116:119],v[208:211],v[88:91]
buffer_load_dwordx4 v0, s[12:15], s85 offen offset:0 lds
M v[88:91],a[120:123],v[224:227],v[88:91]
SA s85,s38,34816
T a[80:81],v18,49152
T a[82:83],v18,51200
M v[88:91],a[124:127],v[240:243],v[88:91]
T a[84:85],v18,53248
T a[86:87],v18,55296
M v[92:95],a[124:127],v[244:247],0
buffer_load_dwordx4 v0, s[12:15], s85 offen offset:1024 lds
M v[92:95],a[120:123],v[228:231],v[92:95]
SA s85,s38,40960
T a[88:89],v18,57344
T a[90:91],v18,59392
M v[92:95],a[116:119],v[212:215],v[92:95]
T a[92:93],v18,61440
T a[94:95],v18,63488
M v[92:95],a[112:115],v[196:199],v[92:95]
buffer_load_dwordx4 v0, s[12:15], s85 offen offset:2048 lds
M v[92:95],a[108:111],v[180:183],v[92:95]
SA s85,s38,47104
v_add_u32 v40, 0x20000, v18
v_add_u32 v41, 0x20000, v19
M v[92:95],a[104:107],v[164:167],v[92:95]
buffer_load_dwordx4 v0, s[12:15], s85 offen offset:3072 lds
M v[92:95],a[100:103],v[148:151],v[92:95]
s_waitcnt lgkmcnt(0)
v_add_u32 v42, 0x20000, v20
v_add_u32 v43, 0x20000, v21
M v[92:95],a[96:99],v[132:135],v[92:95]
SA s38,s38,128
MF v64,v5,v64
MF v65,v5,v65
MF v66,v5,v66
MF v67,v5,v67
MF v72,v5,v72
MF v73,v5,v73
MF v74,v5,v74
MF v75,v5,v75
C v64,v64,v65
C v65,v66,v67
C v66,v72,v73
C v67,v74,v75
buffer_store_dwordx4 v[64:67], v7, s[8:11], s29 offen offset:0 sc1
MF v68,v6,v68
MF v69,v6,v69
MF v70,v6,v70
MF v71,v6,v71
MF v76,v6,v76
MF v77,v6,v77
MF v78,v6,v78
MF v79,v6,v79
C v68,v68,v69
C v69,v70,v71
C v70,v76,v77
C v71,v78,v79
buffer_store_dwordx4 v[68:71], v7, s[8:11], s30 offen offset:0 sc1
M v[96:99],a[64:67],v[128:131],0
s_nop 0
T a[96:97],v19,32768
T a[98:99],v19,34816
M v[96:99],a[68:71],v[144:147],v[96:99]
SA m0,s28,98304
T a[100:101],v19,36864
T a[102:103],v19,38912
M v[96:99],a[72:75],v[160:163],v[96:99]
SA s85,s38,0
buffer_load_dwordx4 v0, s[12:15], s85 offen offset:0 lds
M v[96:99],a[76:79],v[176:179],v[96:99]
s_nop 0
T a[104:105],v19,40960
T a[106:107],v19,43008
M v[96:99],a[80:83],v[192:195],v[96:99]
T a[108:109],v19,45056
T a[110:111],v19,47104
M v[96:99],a[84:87],v[208:211],v[96:99]
SA s85,s38,6144
MF v80,v5,v80
MF v81,v5,v81
M v[96:99],a[88:91],v[224:227],v[96:99]
T a[112:113],v19,49152
T a[114:115],v19,51200
M v[96:99],a[92:95],v[240:243],v[96:99]
T a[116:117],v19,53248
T a[118:119],v19,55296
M v[100:103],a[92:95],v[244:247],0
buffer_load_dwordx4 v0, s[12:15], s85 offen offset:1024 lds
M v[100:103],a[88:91],v[228:231],v[100:103]
s_nop 0
T a[120:121],v19,57344
T a[122:123],v19,59392
M v[100:103],a[84:87],v[212:215],v[100:103]
T a[124:125],v19,61440
T a[126:127],v19,63488
M v[100:103],a[80:83],v[196:199],v[100:103]
SA s85,s38,12288
MF v82,v5,v82
MF v83,v5,v83
M v[100:103],a[76:79],v[180:183],v[100:103]
buffer_load_dwordx4 v0, s[12:15], s85 offen offset:2048 lds
M v[100:103],a[72:75],v[164:167],v[100:103]
MF v88,v5,v88
MF v89,v5,v89
M v[100:103],a[68:71],v[148:151],v[100:103]
MF v90,v5,v90
MF v91,v5,v91
M v[100:103],a[64:67],v[132:135],v[100:103]
s_waitcnt lgkmcnt(0)
C v80,v80,v81
C v81,v82,v83
M v[104:107],a[96:99],v[128:131],0
SA s85,s38,18432
T a[64:65],v20,32768
T a[66:67],v20,34816
M v[104:107],a[100:103],v[144:147],v[104:107]
T a[68:69],v20,36864
T a[70:71],v20,38912
M v[104:107],a[104:107],v[160:163],v[104:107]
buffer_load_dwordx4 v0, s[12:15], s85 offen offset:3072 lds
M v[104:107],a[108:111],v[176:179],v[104:107]
s_nop 0
T a[72:73],v20,40960
T a[74:75],v20,43008
M v[104:107],a[112:115],v[192:195],v[104:107]
T a[76:77],v20,45056
T a[78:79],v20,47104
M v[104:107],a[116:119],v[208:211],v[104:107]
SA m0,s28,102400
C v82,v88,v89
C v83,v90,v91
M v[104:107],a[120:123],v[224:227],v[104:107]
SA s85,s38,28672
T a[80:81],v20,49152
T a[82:83],v20,51200
M v[104:107],a[124:127],v[240:243],v[104:107]
T a[84:85],v20,53248
T a[86:87],v20,55296
M v[108:111],a[124:127],v[244:247],0
buffer_store_dwordx4 v[80:83], v7, s[8:11], s29 offen offset:1024 sc1
M v[108:111],a[120:123],v[228:231],v[108:111]
s_nop 0
T a[88:89],v20,57344
T a[90:91],v20,59392
M v[108:111],a[116:119],v[212:215],v[108:111]
T a[92:93],v20,61440
T a[94:95],v20,63488
M v[108:111],a[112:115],v[196:199],v[108:111]
buffer_load_dwordx4 v0, s[12:15], s85 offen offset:0 lds
M v[108:111],a[108:111],v[180:183],v[108:111]
SA s85,s38,34816
MF v84,v6,v84
MF v85,v6,v85
M v[108:111],a[104:107],v[164:167],v[108:111]
MF v86,v6,v86
MF v87,v6,v87
M v[108:111],a[100:103],v[148:151],v[108:111]
buffer_load_dwordx4 v0, s[12:15], s85 offen offset:1024 lds
M v[108:111],a[96:99],v[132:135],v[108:111]
s_waitcnt lgkmcnt(0)
MF v92,v6,v92
MF v93,v6,v93
M v[112:115],a[64:67],v[128:131],0
T a[96:97],v21,32768
T a[98:99],v21,34816
M v[112:115],a[68:71],v[144:147],v[112:115]
SA s85,s38,40960
T a[100:101],v21,36864
T a[102:103],v21,38912
M v[112:115],a[72:75],v[160:163],v[112:115]
buffer_load_dwordx4 v0, s[12:15], s85 offen offset:2048 lds
M v[112:115],a[76:79],v[176:179],v[112:115]
s_nop 0
T a[104:105],v21,40960
T a[106:107],v21,43008
M v[112:115],a[80:83],v[192:195],v[112:115]
T a[108:109],v21,45056
T a[110:111],v21,47104
M v[112:115],a[84:87],v[208:211],v[112:115]
MF v94,v6,v94
MF v95,v6,v95
M v[112:115],a[88:91],v[224:227],v[112:115]
SA s85,s38,47104
T a[112:113],v21,49152
T a[114:115],v21,51200
M v[112:115],a[92:95],v[240:243],v[112:115]
T a[116:117],v21,53248
T a[118:119],v21,55296
M v[116:119],a[92:95],v[244:247],0
buffer_load_dwordx4 v0, s[12:15], s85 offen offset:3072 lds
M v[116:119],a[88:91],v[228:231],v[116:119]
s_nop 0
T a[120:121],v21,57344
T a[122:123],v21,59392
M v[116:119],a[84:87],v[212:215],v[116:119]
T a[124:125],v21,61440
T a[126:127],v21,63488
M v[116:119],a[80:83],v[196:199],v[116:119]
C v84,v84,v85
C v85,v86,v87
M v[116:119],a[76:79],v[180:183],v[116:119]
C v86,v92,v93
C v87,v94,v95
M v[116:119],a[72:75],v[164:167],v[116:119]
SA s38,s38,128
buffer_store_dwordx4 v[84:87], v7, s[8:11], s30 offen offset:1024 sc1
M v[116:119],a[68:71],v[148:151],v[116:119]
s_waitcnt vmcnt(28) lgkmcnt(0)
M v[116:119],a[64:67],v[132:135],v[116:119]
s_barrier
M v[120:123],a[96:99],v[128:131],0
SA s29,s33,2048
T a[64:65],v22,0
T a[66:67],v22,2048
M v[120:123],a[100:103],v[144:147],v[120:123]
SA s30,s33,16384
T a[68:69],v22,4096
T a[70:71],v22,6144
M v[120:123],a[104:107],v[160:163],v[120:123]
MF v96,v5,v96
MF v97,v5,v97
M v[120:123],a[108:111],v[176:179],v[120:123]
T a[72:73],v22,8192
T a[74:75],v22,10240
M v[120:123],a[112:115],v[192:195],v[120:123]
T a[76:77],v22,12288
T a[78:79],v22,14336
M v[120:123],a[116:119],v[208:211],v[120:123]
MF v98,v5,v98
MF v99,v5,v99
M v[120:123],a[120:123],v[224:227],v[120:123]
T a[80:81],v22,16384
T a[82:83],v22,18432
M v[120:123],a[124:127],v[240:243],v[120:123]
T a[84:85],v22,20480
T a[86:87],v22,22528
M v[124:127],a[124:127],v[244:247],0
MF v104,v5,v104
MF v105,v5,v105
M v[124:127],a[120:123],v[228:231],v[124:127]
T a[88:89],v22,24576
T a[90:91],v22,26624
M v[124:127],a[116:119],v[212:215],v[124:127]
T a[92:93],v22,28672
T a[94:95],v22,30720
M v[124:127],a[112:115],v[196:199],v[124:127]
MF v106,v5,v106
MF v107,v5,v107
M v[124:127],a[108:111],v[180:183],v[124:127]
C v96,v96,v97
C v97,v98,v99
M v[124:127],a[104:107],v[164:167],v[124:127]
C v98,v104,v105
C v99,v106,v107
M v[124:127],a[100:103],v[148:151],v[124:127]
s_waitcnt lgkmcnt(0)
buffer_store_dwordx4 v[96:99], v7, s[8:11], s29 offen offset:0 sc1
M v[124:127],a[96:99],v[132:135],v[124:127]
MF v100,v6,v100
MF v101,v6,v101
MF v102,v6,v102
MF v103,v6,v103
MF v108,v6,v108
MF v109,v6,v109
MF v110,v6,v110
MF v111,v6,v111
C v100,v100,v101
C v101,v102,v103
C v102,v108,v109
C v103,v110,v111
buffer_store_dwordx4 v[100:103], v7, s[8:11], s30 offen offset:0 sc1
M v[64:67],a[64:67],v[128:131],0
s_nop 0
T a[96:97],v23,0
T a[98:99],v23,2048
M v[64:67],a[68:71],v[144:147],v[64:67]
SA m0,s28,32768
T a[100:101],v23,4096
T a[102:103],v23,6144
M v[64:67],a[72:75],v[160:163],v[64:67]
SA s85,s38,0
buffer_load_dwordx4 v0, s[12:15], s85 offen offset:0 lds
M v[64:67],a[76:79],v[176:179],v[64:67]
s_nop 0
T a[104:105],v23,8192
T a[106:107],v23,10240
M v[64:67],a[80:83],v[192:195],v[64:67]
T a[108:109],v23,12288
T a[110:111],v23,14336
M v[64:67],a[84:87],v[208:211],v[64:67]
SA s85,s38,6144
MF v112,v5,v112
MF v113,v5,v113
M v[64:67],a[88:91],v[224:227],v[64:67]
T a[112:113],v23,16384
T a[114:115],v23,18432
M v[64:67],a[92:95],v[240:243],v[64:67]
T a[116:117],v23,20480
T a[118:119],v23,22528
M v[68:71],a[92:95],v[244:247],0
buffer_load_dwordx4 v0, s[12:15], s85 offen offset:1024 lds
M v[68:71],a[88:91],v[228:231],v[68:71]
s_nop 0
T a[120:121],v23,24576
T a[122:123],v23,26624
M v[68:71],a[84:87],v[212:215],v[68:71]
T a[124:125],v23,28672
T a[126:127],v23,30720
M v[68:71],a[80:83],v[196:199],v[68:71]
SA s85,s38,12288
MF v114,v5,v114
MF v115,v5,v115
M v[68:71],a[76:79],v[180:183],v[68:71]
buffer_load_dwordx4 v0, s[12:15], s85 offen offset:2048 lds
M v[68:71],a[72:75],v[164:167],v[68:71]
MF v120,v5,v120
MF v121,v5,v121
M v[68:71],a[68:71],v[148:151],v[68:71]
MF v122,v5,v122
MF v123,v5,v123
M v[68:71],a[64:67],v[132:135],v[68:71]
s_waitcnt lgkmcnt(0)
C v112,v112,v113
C v113,v114,v115
M v[72:75],a[96:99],v[128:131],0
SA s85,s38,18432
T a[64:65],v24,0
T a[66:67],v24,2048
M v[72:75],a[100:103],v[144:147],v[72:75]
T a[68:69],v24,4096
T a[70:71],v24,6144
M v[72:75],a[104:107],v[160:163],v[72:75]
buffer_load_dwordx4 v0, s[12:15], s85 offen offset:3072 lds
M v[72:75],a[108:111],v[176:179],v[72:75]
s_nop 0
T a[72:73],v24,8192
T a[74:75],v24,10240
M v[72:75],a[112:115],v[192:195],v[72:75]
T a[76:77],v24,12288
T a[78:79],v24,14336
M v[72:75],a[116:119],v[208:211],v[72:75]
SA m0,s28,36864
C v114,v120,v121
C v115,v122,v123
M v[72:75],a[120:123],v[224:227],v[72:75]
SA s85,s38,28672
T a[80:81],v24,16384
T a[82:83],v24,18432
M v[72:75],a[124:127],v[240:243],v[72:75]
T a[84:85],v24,20480
T a[86:87],v24,22528
M v[76:79],a[124:127],v[244:247],0
buffer_store_dwordx4 v[112:115], v7, s[8:11], s29 offen offset:1024 sc1
M v[76:79],a[120:123],v[228:231],v[76:79]
s_nop 0
T a[88:89],v24,24576
T a[90:91],v24,26624
M v[76:79],a[116:119],v[212:215],v[76:79]
T a[92:93],v24,28672
T a[94:95],v24,30720
M v[76:79],a[112:115],v[196:199],v[76:79]
buffer_load_dwordx4 v0, s[12:15], s85 offen offset:0 lds
M v[76:79],a[108:111],v[180:183],v[76:79]
SA s85,s38,34816
MF v116,v6,v116
MF v117,v6,v117
M v[76:79],a[104:107],v[164:167],v[76:79]
MF v118,v6,v118
MF v119,v6,v119
M v[76:79],a[100:103],v[148:151],v[76:79]
buffer_load_dwordx4 v0, s[12:15], s85 offen offset:1024 lds
M v[76:79],a[96:99],v[132:135],v[76:79]
s_waitcnt lgkmcnt(0)
MF v124,v6,v124
MF v125,v6,v125
M v[80:83],a[64:67],v[128:131],0
T a[96:97],v25,0
T a[98:99],v25,2048
M v[80:83],a[68:71],v[144:147],v[80:83]
SA s85,s38,40960
T a[100:101],v25,4096
T a[102:103],v25,6144
M v[80:83],a[72:75],v[160:163],v[80:83]
buffer_load_dwordx4 v0, s[12:15], s85 offen offset:2048 lds
M v[80:83],a[76:79],v[176:179],v[80:83]
s_nop 0
T a[104:105],v25,8192
T a[106:107],v25,10240
M v[80:83],a[80:83],v[192:195],v[80:83]
T a[108:109],v25,12288
T a[110:111],v25,14336
M v[80:83],a[84:87],v[208:211],v[80:83]
MF v126,v6,v126
MF v127,v6,v127
M v[80:83],a[88:91],v[224:227],v[80:83]
SA s85,s38,47104
T a[112:113],v25,16384
T a[114:115],v25,18432
M v[80:83],a[92:95],v[240:243],v[80:83]
T a[116:117],v25,20480
T a[118:119],v25,22528
M v[84:87],a[92:95],v[244:247],0
buffer_load_dwordx4 v0, s[12:15], s85 offen offset:3072 lds
M v[84:87],a[88:91],v[228:231],v[84:87]
s_nop 0
T a[120:121],v25,24576
T a[122:123],v25,26624
M v[84:87],a[84:87],v[212:215],v[84:87]
T a[124:125],v25,28672
T a[126:127],v25,30720
M v[84:87],a[80:83],v[196:199],v[84:87]
C v116,v116,v117
C v117,v118,v119
M v[84:87],a[76:79],v[180:183],v[84:87]
C v118,v124,v125
C v119,v126,v127
M v[84:87],a[72:75],v[164:167],v[84:87]
SA s38,s38,128
buffer_store_dwordx4 v[116:119], v7, s[8:11], s30 offen offset:1024 sc1
M v[84:87],a[68:71],v[148:151],v[84:87]
s_waitcnt vmcnt(32) lgkmcnt(0)
M v[84:87],a[64:67],v[132:135],v[84:87]
s_barrier
M v[88:91],a[96:99],v[128:131],0
SA s29,s33,4096
T a[64:65],v18,0
T a[66:67],v18,2048
M v[88:91],a[100:103],v[144:147],v[88:91]
SA s30,s33,18432
T a[68:69],v18,4096
T a[70:71],v18,6144
M v[88:91],a[104:107],v[160:163],v[88:91]
MF v64,v5,v64
MF v65,v5,v65
M v[88:91],a[108:111],v[176:179],v[88:91]
T a[72:73],v18,8192
T a[74:75],v18,10240
M v[88:91],a[112:115],v[192:195],v[88:91]
T a[76:77],v18,12288
T a[78:79],v18,14336
M v[88:91],a[116:119],v[208:211],v[88:91]
MF v66,v5,v66
MF v67,v5,v67
M v[88:91],a[120:123],v[224:227],v[88:91]
T a[80:81],v18,16384
T a[82:83],v18,18432
M v[88:91],a[124:127],v[240:243],v[88:91]
T a[84:85],v18,20480
T a[86:87],v18,22528
M v[92:95],a[124:127],v[244:247],0
MF v72,v5,v72
MF v73,v5,v73
M v[92:95],a[120:123],v[228:231],v[92:95]
T a[88:89],v18,24576
T a[90:91],v18,26624
M v[92:95],a[116:119],v[212:215],v[92:95]
T a[92:93],v18,28672
T a[94:95],v18,30720
M v[92:95],a[112:115],v[196:199],v[92:95]
MF v74,v5,v74
MF v75,v5,v75
M v[92:95],a[108:111],v[180:183],v[92:95]
C v64,v64,v65
C v65,v66,v67
M v[92:95],a[104:107],v[164:167],v[92:95]
C v66,v72,v73
C v67,v74,v75
M v[92:95],a[100:103],v[148:151],v[92:95]
s_waitcnt lgkmcnt(0)
buffer_store_dwordx4 v[64:67], v7, s[8:11], s29 offen offset:0 sc1
M v[92:95],a[96:99],v[132:135],v[92:95]
MF v68,v6,v68
MF v69,v6,v69
MF v70,v6,v70
MF v71,v6,v71
MF v76,v6,v76
MF v77,v6,v77
MF v78,v6,v78
MF v79,v6,v79
C v68,v68,v69
C v69,v70,v71
C v70,v76,v77
C v71,v78,v79
buffer_store_dwordx4 v[68:71], v7, s[8:11], s30 offen offset:0 sc1
M v[96:99],a[64:67],v[128:131],0
s_nop 0
T a[96:97],v19,0
T a[98:99],v19,2048
M v[96:99],a[68:71],v[144:147],v[96:99]
T a[100:101],v19,4096
T a[102:103],v19,6144
M v[96:99],a[72:75],v[160:163],v[96:99]
MF v80,v5,v80
MF v81,v5,v81
M v[96:99],a[76:79],v[176:179],v[96:99]
T a[104:105],v19,8192
T a[106:107],v19,10240
M v[96:99],a[80:83],v[192:195],v[96:99]
T a[108:109],v19,12288
T a[110:111],v19,14336
M v[96:99],a[84:87],v[208:211],v[96:99]
MF v82,v5,v82
MF v83,v5,v83
M v[96:99],a[88:91],v[224:227],v[96:99]
T a[112:113],v19,16384
T a[114:115],v19,18432
M v[96:99],a[92:95],v[240:243],v[96:99]
T a[116:117],v19,20480
T a[118:119],v19,22528
M v[100:103],a[92:95],v[244:247],0
MF v88,v5,v88
MF v89,v5,v89
M v[100:103],a[88:91],v[228:231],v[100:103]
T a[120:121],v19,24576
T a[122:123],v19,26624
M v[100:103],a[84:87],v[212:215],v[100:103]
T a[124:125],v19,28672
T a[126:127],v19,30720
M v[100:103],a[80:83],v[196:199],v[100:103]
MF v90,v5,v90
MF v91,v5,v91
M v[100:103],a[76:79],v[180:183],v[100:103]
C v80,v80,v81
C v81,v82,v83
M v[100:103],a[72:75],v[164:167],v[100:103]
C v82,v88,v89
C v83,v90,v91
M v[100:103],a[68:71],v[148:151],v[100:103]
buffer_store_dwordx4 v[80:83], v7, s[8:11], s29 offen offset:1024 sc1
M v[100:103],a[64:67],v[132:135],v[100:103]
s_waitcnt lgkmcnt(0)
MF v84,v6,v84
MF v85,v6,v85
M v[104:107],a[96:99],v[128:131],0
T a[64:65],v20,0
T a[66:67],v20,2048
M v[104:107],a[100:103],v[144:147],v[104:107]
T a[68:69],v20,4096
T a[70:71],v20,6144
M v[104:107],a[104:107],v[160:163],v[104:107]
MF v86,v6,v86
MF v87,v6,v87
M v[104:107],a[108:111],v[176:179],v[104:107]
T a[72:73],v20,8192
T a[74:75],v20,10240
M v[104:107],a[112:115],v[192:195],v[104:107]
T a[76:77],v20,12288
T a[78:79],v20,14336
M v[104:107],a[116:119],v[208:211],v[104:107]
MF v92,v6,v92
MF v93,v6,v93
M v[104:107],a[120:123],v[224:227],v[104:107]
T a[80:81],v20,16384
T a[82:83],v20,18432
M v[104:107],a[124:127],v[240:243],v[104:107]
T a[84:85],v20,20480
T a[86:87],v20,22528
M v[108:111],a[124:127],v[244:247],0
MF v94,v6,v94
MF v95,v6,v95
M v[108:111],a[120:123],v[228:231],v[108:111]
T a[88:89],v20,24576
T a[90:91],v20,26624
M v[108:111],a[116:119],v[212:215],v[108:111]
T a[92:93],v20,28672
T a[94:95],v20,30720
M v[108:111],a[112:115],v[196:199],v[108:111]
C v84,v84,v85
C v85,v86,v87
M v[108:111],a[108:111],v[180:183],v[108:111]
C v86,v92,v93
C v87,v94,v95
M v[108:111],a[104:107],v[164:167],v[108:111]
buffer_store_dwordx4 v[84:87], v7, s[8:11], s30 offen offset:1024 sc1
M v[108:111],a[100:103],v[148:151],v[108:111]
SA s29,s33,6144
M v[108:111],a[96:99],v[132:135],v[108:111]
s_waitcnt lgkmcnt(0)
M v[112:115],a[64:67],v[128:131],0
SA s30,s33,20480
T a[96:97],v21,0
T a[98:99],v21,2048
M v[112:115],a[68:71],v[144:147],v[112:115]
T a[100:101],v21,4096
T a[102:103],v21,6144
M v[112:115],a[72:75],v[160:163],v[112:115]
MF v96,v5,v96
MF v97,v5,v97
M v[112:115],a[76:79],v[176:179],v[112:115]
T a[104:105],v21,8192
T a[106:107],v21,10240
M v[112:115],a[80:83],v[192:195],v[112:115]
T a[108:109],v21,12288
T a[110:111],v21,14336
M v[112:115],a[84:87],v[208:211],v[112:115]
MF v98,v5,v98
MF v99,v5,v99
M v[112:115],a[88:91],v[224:227],v[112:115]
T a[112:113],v21,16384
T a[114:115],v21,18432
M v[112:115],a[92:95],v[240:243],v[112:115]
T a[116:117],v21,20480
T a[118:119],v21,22528
M v[116:119],a[92:95],v[244:247],0
MF v104,v5,v104
MF v105,v5,v105
M v[116:119],a[88:91],v[228:231],v[116:119]
T a[120:121],v21,24576
T a[122:123],v21,26624
M v[116:119],a[84:87],v[212:215],v[116:119]
T a[124:125],v21,28672
T a[126:127],v21,30720
M v[116:119],a[80:83],v[196:199],v[116:119]
MF v106,v5,v106
MF v107,v5,v107
M v[116:119],a[76:79],v[180:183],v[116:119]
C v96,v96,v97
C v97,v98,v99
M v[116:119],a[72:75],v[164:167],v[116:119]
C v98,v104,v105
C v99,v106,v107
M v[116:119],a[68:71],v[148:151],v[116:119]
s_waitcnt vmcnt(28) lgkmcnt(0)
buffer_store_dwordx4 v[96:99], v7, s[8:11], s29 offen offset:0 sc1
M v[116:119],a[64:67],v[132:135],v[116:119]
s_barrier
M v[120:123],a[96:99],v[128:131],0
s_nop 0
T a[64:65],v40,0
T a[66:67],v40,2048
M v[120:123],a[100:103],v[144:147],v[120:123]
T a[68:69],v40,4096
T a[70:71],v40,6144
M v[120:123],a[104:107],v[160:163],v[120:123]
MF v100,v6,v100
MF v101,v6,v101
M v[120:123],a[108:111],v[176:179],v[120:123]
T a[72:73],v40,8192
T a[74:75],v40,10240
M v[120:123],a[112:115],v[192:195],v[120:123]
T a[76:77],v40,12288
T a[78:79],v40,14336
M v[120:123],a[116:119],v[208:211],v[120:123]
MF v102,v6,v102
MF v103,v6,v103
M v[120:123],a[120:123],v[224:227],v[120:123]
T a[80:81],v40,16384
T a[82:83],v40,18432
M v[120:123],a[124:127],v[240:243],v[120:123]
T a[84:85],v40,20480
T a[86:87],v40,22528
M v[124:127],a[124:127],v[244:247],0
MF v108,v6,v108
MF v109,v6,v109
M v[124:127],a[120:123],v[228:231],v[124:127]
T a[88:89],v40,24576
T a[90:91],v40,26624
M v[124:127],a[116:119],v[212:215],v[124:127]
T a[92:93],v40,28672
T a[94:95],v40,30720
M v[124:127],a[112:115],v[196:199],v[124:127]
MF v110,v6,v110
MF v111,v6,v111
M v[124:127],a[108:111],v[180:183],v[124:127]
C v100,v100,v101
C v101,v102,v103
M v[124:127],a[104:107],v[164:167],v[124:127]
C v102,v108,v109
C v103,v110,v111
M v[124:127],a[100:103],v[148:151],v[124:127]
s_waitcnt lgkmcnt(0)
buffer_store_dwordx4 v[100:103], v7, s[8:11], s30 offen offset:0 sc1
M v[124:127],a[96:99],v[132:135],v[124:127]
M v[64:67],a[64:67],v[128:131],0
s_nop 0
T a[96:97],v41,0
T a[98:99],v41,2048
M v[64:67],a[68:71],v[144:147],v[64:67]
T a[100:101],v41,4096
T a[102:103],v41,6144
M v[64:67],a[72:75],v[160:163],v[64:67]
v_lshrrev_b32 v32, 4, v7
MF v112,v5,v112
M v[64:67],a[76:79],v[176:179],v[64:67]
s_lshr_b32 s74, s41, 3
T a[104:105],v41,8192
T a[106:107],v41,10240
M v[64:67],a[80:83],v[192:195],v[64:67]
s_sub_u32 s64, 15, s42
T a[108:109],v41,12288
T a[110:111],v41,14336
M v[64:67],a[84:87],v[208:211],v[64:67]
s_mul_i32 s46, s64, 8704
MF v113,v5,v113
MF v114,v5,v114
M v[64:67],a[88:91],v[224:227],v[64:67]
s_and_b32 s72, s41, 7
T a[112:113],v41,16384
T a[114:115],v41,18432
M v[64:67],a[92:95],v[240:243],v[64:67]
s_lshl_b32 s65, s72, 7
T a[116:117],v41,20480
T a[118:119],v41,22528
M v[68:71],a[92:95],v[244:247],0
SA s46,s46,s65
MF v115,v5,v115
MF v120,v5,v120
M v[68:71],a[88:91],v[228:231],v[68:71]
SA s46,s46,104993792
T a[120:121],v41,24576
T a[122:123],v41,26624
M v[68:71],a[84:87],v[212:215],v[68:71]
T a[124:125],v41,28672
T a[126:127],v41,30720
M v[68:71],a[80:83],v[196:199],v[68:71]
v_and_b32 v33, 31, v32
MF v121,v5,v121
M v[68:71],a[76:79],v[180:183],v[68:71]
MF v122,v5,v122
MF v123,v5,v123
M v[68:71],a[72:75],v[164:167],v[68:71]
C v112,v112,v113
C v113,v114,v115
M v[68:71],a[68:71],v[148:151],v[68:71]
C v114,v120,v121
C v115,v122,v123
M v[68:71],a[64:67],v[132:135],v[68:71]
s_waitcnt lgkmcnt(0)
buffer_store_dwordx4 v[112:115], v7, s[8:11], s29 offen offset:1024 sc1
M v[72:75],a[96:99],v[128:131],0
s_nop 0
T a[64:65],v42,0
T a[66:67],v42,2048
M v[72:75],a[100:103],v[144:147],v[72:75]
T a[68:69],v42,4096
T a[70:71],v42,6144
M v[72:75],a[104:107],v[160:163],v[72:75]
MF v116,v6,v116
MF v117,v6,v117
M v[72:75],a[108:111],v[176:179],v[72:75]
T a[72:73],v42,8192
T a[74:75],v42,10240
M v[72:75],a[112:115],v[192:195],v[72:75]
T a[76:77],v42,12288
T a[78:79],v42,14336
M v[72:75],a[116:119],v[208:211],v[72:75]
MF v118,v6,v118
MF v119,v6,v119
M v[72:75],a[120:123],v[224:227],v[72:75]
T a[80:81],v42,16384
T a[82:83],v42,18432
M v[72:75],a[124:127],v[240:243],v[72:75]
T a[84:85],v42,20480
T a[86:87],v42,22528
M v[76:79],a[124:127],v[244:247],0
MF v124,v6,v124
MF v125,v6,v125
M v[76:79],a[120:123],v[228:231],v[76:79]
T a[88:89],v42,24576
T a[90:91],v42,26624
M v[76:79],a[116:119],v[212:215],v[76:79]
T a[92:93],v42,28672
T a[94:95],v42,30720
M v[76:79],a[112:115],v[196:199],v[76:79]
MF v126,v6,v126
MF v127,v6,v127
M v[76:79],a[108:111],v[180:183],v[76:79]
C v116,v116,v117
C v117,v118,v119
M v[76:79],a[104:107],v[164:167],v[76:79]
C v118,v124,v125
C v119,v126,v127
M v[76:79],a[100:103],v[148:151],v[76:79]
buffer_store_dwordx4 v[116:119], v7, s[8:11], s30 offen offset:1024 sc1
M v[76:79],a[96:99],v[132:135],v[76:79]
s_waitcnt lgkmcnt(0)
v_lshlrev_b32 v33, 2, v33
M v[80:83],a[64:67],v[128:131],0
SA s29,s33,8192
T a[96:97],v43,0
T a[98:99],v43,2048
M v[80:83],a[68:71],v[144:147],v[80:83]
SA s30,s33,22528
T a[100:101],v43,4096
T a[102:103],v43,6144
M v[80:83],a[72:75],v[160:163],v[80:83]
s_lshl_b32 s65, s41, 7
MF v64,v5,v64
MF v65,v5,v65
M v[80:83],a[76:79],v[176:179],v[80:83]
SA s65,s65,104890368
T a[104:105],v43,8192
T a[106:107],v43,10240
M v[80:83],a[80:83],v[192:195],v[80:83]
T a[108:109],v43,12288
T a[110:111],v43,14336
M v[80:83],a[84:87],v[208:211],v[80:83]
buffer_load_dword v31, v33, s[8:11], s65 offen sc1
M v[80:83],a[88:91],v[224:227],v[80:83]
s_nop 0
T a[112:113],v43,16384
T a[114:115],v43,18432
M v[80:83],a[92:95],v[240:243],v[80:83]
T a[116:117],v43,20480
T a[118:119],v43,22528
M v[84:87],a[92:95],v[244:247],0
s_cmp_ge_u32 s42, 8
v_bfe_u32 v34, v32, 4, 1
v_lshlrev_b32 v34, 1, v34
M v[84:87],a[88:91],v[228:231],v[84:87]
s_cselect_b32 s84, s45, 536870912
T a[120:121],v43,24576
T a[122:123],v43,26624
M v[84:87],a[84:87],v[212:215],v[84:87]
T a[124:125],v43,28672
T a[126:127],v43,30720
M v[84:87],a[80:83],v[196:199],v[84:87]
v_lshrrev_b32 v35, 5, v32
v_add_u32 v34, v34, v35
M v[84:87],a[76:79],v[180:183],v[84:87]
s_mov_b32 s52, s96
MF v66,v5,v66
MF v67,v5,v67
M v[84:87],a[72:75],v[164:167],v[84:87]
s_and_b32 s53, s97, 0xffff
MF v72,v5,v72
MF v73,v5,v73
M v[84:87],a[68:71],v[148:151],v[84:87]
s_waitcnt vmcnt(22) lgkmcnt(0)
MF v74,v5,v74
MF v75,v5,v75
M v[84:87],a[64:67],v[132:135],v[84:87]
s_barrier
M v[88:91],a[96:99],v[128:131],0
s_mov_b32 s54, 1835008
T a[64:65],v22,32768
T a[66:67],v22,34816
M v[88:91],a[100:103],v[144:147],v[88:91]
s_mov_b32 s55, 0x20000
T a[68:69],v22,36864
T a[70:71],v22,38912
M v[88:91],a[104:107],v[160:163],v[88:91]
s_mul_i32 s77, s42, 1835008
C v64,v64,v65
C v65,v66,v67
M v[88:91],a[108:111],v[176:179],v[88:91]
s_mul_i32 s78, s72, 14336
T a[72:73],v22,40960
T a[74:75],v22,43008
M v[88:91],a[112:115],v[192:195],v[88:91]
SA s77,s77,s78
T a[76:77],v22,45056
T a[78:79],v22,47104
M v[88:91],a[116:119],v[208:211],v[88:91]
SA s77,s77,67108864
C v66,v72,v73
C v67,v74,v75
M v[88:91],a[120:123],v[224:227],v[88:91]
s_lshl_b32 s79, s74, 2
T a[80:81],v22,49152
T a[82:83],v22,51200
M v[88:91],a[124:127],v[240:243],v[88:91]
SA s79,s79,s20
T a[84:85],v22,53248
T a[86:87],v22,55296
M v[92:95],a[124:127],v[244:247],0
SA s79,s79,6
buffer_store_dwordx4 v[64:67], v7, s[8:11], s29 offen offset:0 sc1
M v[92:95],a[120:123],v[228:231],v[92:95]
s_sub_u32 s67, 13, s79
T a[88:89],v22,57344
T a[90:91],v22,59392
M v[92:95],a[116:119],v[212:215],v[92:95]
s_and_b32 s67, s67, 536870912
T a[92:93],v22,61440
T a[94:95],v22,63488
M v[92:95],a[112:115],v[196:199],v[92:95]
s_lshl_b32 s78, s79, 10
MF v68,v6,v68
MF v69,v6,v69
M v[92:95],a[108:111],v[180:183],v[92:95]
SA s78,s78,s77
MF v70,v6,v70
MF v71,v6,v71
M v[92:95],a[104:107],v[164:167],v[92:95]
s_lshl_b32 s79, s79, 6
MF v76,v6,v76
MF v77,v6,v77
M v[92:95],a[100:103],v[148:151],v[92:95]
s_waitcnt lgkmcnt(0)
MF v78,v6,v78
MF v79,v6,v79
M v[92:95],a[96:99],v[132:135],v[92:95]
s_or_b32 s79, s79, s67
v_or_b32 v27, s67, v7
s_lshr_b32 s73, s72, 1
s_sub_u32 s65, 7, s73
s_bitcmp1_b32 s72, 0
s_cselect_b32 s73, s65, s73
s_lshl_b32 s73, s73, 4
s_lshl_b32 s65, s42, 7
SA s73,s73,s65
v_and_b32 v29, 15, v32
v_add_u32 v29, s73, v29
s_mov_b32 s64, 104857664
v_mul_u32_u24 v28, 896, v29
v_lshl_add_u32 v28, v34, 4, v28
C v68,v68,v69
C v69,v70,v71
C v70,v76,v77
C v71,v78,v79
buffer_store_dwordx4 v[68:71], v7, s[8:11], s30 offen offset:0 sc1
v_lshrrev_b32 v35, 4, v29
v_lshlrev_b32 v35, 5, v35
v_and_b32 v36, 15, v29
v_add_lshl_u32 v35, v35, v36, 2
buffer_load_dword v26, v35, s[8:11], s64 offen sc1
s_waitcnt vmcnt(8)
buffer_store_dword v15, v17, s[8:11], s84 offen sc1
buffer_load_dwordx4 v[44:47], v28, s[56:59], s79 offen
M v[96:99],a[64:67],v[128:131],0
s_nop 0
T a[96:97],v23,32768
T a[98:99],v23,34816
M v[96:99],a[68:71],v[144:147],v[96:99]
T a[100:101],v23,36864
T a[102:103],v23,38912
M v[96:99],a[72:75],v[160:163],v[96:99]
MF v80,v5,v80
MF v81,v5,v81
M v[96:99],a[76:79],v[176:179],v[96:99]
T a[104:105],v23,40960
T a[106:107],v23,43008
M v[96:99],a[80:83],v[192:195],v[96:99]
T a[108:109],v23,45056
T a[110:111],v23,47104
M v[96:99],a[84:87],v[208:211],v[96:99]
MF v82,v5,v82
MF v83,v5,v83
M v[96:99],a[88:91],v[224:227],v[96:99]
T a[112:113],v23,49152
T a[114:115],v23,51200
M v[96:99],a[92:95],v[240:243],v[96:99]
T a[116:117],v23,53248
T a[118:119],v23,55296
M v[100:103],a[92:95],v[244:247],0
MF v88,v5,v88
MF v89,v5,v89
M v[100:103],a[88:91],v[228:231],v[100:103]
T a[120:121],v23,57344
T a[122:123],v23,59392
M v[100:103],a[84:87],v[212:215],v[100:103]
T a[124:125],v23,61440
T a[126:127],v23,63488
M v[100:103],a[80:83],v[196:199],v[100:103]
MF v90,v5,v90
MF v91,v5,v91
M v[100:103],a[76:79],v[180:183],v[100:103]
C v80,v80,v81
C v81,v82,v83
M v[100:103],a[72:75],v[164:167],v[100:103]
C v82,v88,v89
C v83,v90,v91
M v[100:103],a[68:71],v[148:151],v[100:103]
buffer_store_dwordx4 v[80:83], v7, s[8:11], s29 offen offset:1024 sc1
M v[100:103],a[64:67],v[132:135],v[100:103]
s_waitcnt lgkmcnt(0)
MF v84,v6,v84
MF v85,v6,v85
M v[104:107],a[96:99],v[128:131],0
T a[64:65],v24,32768
T a[66:67],v24,34816
M v[104:107],a[100:103],v[144:147],v[104:107]
T a[68:69],v24,36864
T a[70:71],v24,38912
M v[104:107],a[104:107],v[160:163],v[104:107]
MF v86,v6,v86
MF v87,v6,v87
M v[104:107],a[108:111],v[176:179],v[104:107]
T a[72:73],v24,40960
T a[74:75],v24,43008
M v[104:107],a[112:115],v[192:195],v[104:107]
T a[76:77],v24,45056
T a[78:79],v24,47104
M v[104:107],a[116:119],v[208:211],v[104:107]
MF v92,v6,v92
MF v93,v6,v93
M v[104:107],a[120:123],v[224:227],v[104:107]
T a[80:81],v24,49152
T a[82:83],v24,51200
M v[104:107],a[124:127],v[240:243],v[104:107]
T a[84:85],v24,53248
T a[86:87],v24,55296
M v[108:111],a[124:127],v[244:247],0
MF v94,v6,v94
MF v95,v6,v95
M v[108:111],a[120:123],v[228:231],v[108:111]
T a[88:89],v24,57344
T a[90:91],v24,59392
M v[108:111],a[116:119],v[212:215],v[108:111]
T a[92:93],v24,61440
T a[94:95],v24,63488
M v[108:111],a[112:115],v[196:199],v[108:111]
C v84,v84,v85
C v85,v86,v87
M v[108:111],a[108:111],v[180:183],v[108:111]
C v86,v92,v93
C v87,v94,v95
M v[108:111],a[104:107],v[164:167],v[108:111]
buffer_store_dwordx4 v[84:87], v7, s[8:11], s30 offen offset:1024 sc1
M v[108:111],a[100:103],v[148:151],v[108:111]
SA s29,s33,10240
M v[108:111],a[96:99],v[132:135],v[108:111]
s_waitcnt lgkmcnt(0)
M v[112:115],a[64:67],v[128:131],0
SA s30,s33,24576
T a[96:97],v25,32768
T a[98:99],v25,34816
M v[112:115],a[68:71],v[144:147],v[112:115]
T a[100:101],v25,36864
T a[102:103],v25,38912
M v[112:115],a[72:75],v[160:163],v[112:115]
MF v96,v5,v96
MF v97,v5,v97
M v[112:115],a[76:79],v[176:179],v[112:115]
T a[104:105],v25,40960
T a[106:107],v25,43008
M v[112:115],a[80:83],v[192:195],v[112:115]
T a[108:109],v25,45056
T a[110:111],v25,47104
M v[112:115],a[84:87],v[208:211],v[112:115]
MF v98,v5,v98
MF v99,v5,v99
M v[112:115],a[88:91],v[224:227],v[112:115]
T a[112:113],v25,49152
T a[114:115],v25,51200
M v[112:115],a[92:95],v[240:243],v[112:115]
T a[116:117],v25,53248
T a[118:119],v25,55296
M v[116:119],a[92:95],v[244:247],0
s_cmp_lt_u32 s42, 8
MF v104,v5,v104
MF v105,v5,v105
M v[116:119],a[88:91],v[228:231],v[116:119]
s_cselect_b32 s84, s45, 536870912
T a[120:121],v25,57344
T a[122:123],v25,59392
M v[116:119],a[84:87],v[212:215],v[116:119]
T a[124:125],v25,61440
T a[126:127],v25,63488
M v[116:119],a[80:83],v[196:199],v[116:119]
MF v106,v5,v106
MF v107,v5,v107
M v[116:119],a[76:79],v[180:183],v[116:119]
C v96,v96,v97
C v97,v98,v99
M v[116:119],a[72:75],v[164:167],v[116:119]
C v98,v104,v105
C v99,v106,v107
M v[116:119],a[68:71],v[148:151],v[116:119]
s_waitcnt lgkmcnt(0)
buffer_store_dwordx4 v[96:99], v7, s[8:11], s29 offen offset:0 sc1
M v[116:119],a[64:67],v[132:135],v[116:119]
s_barrier
M v[120:123],a[96:99],v[128:131],0
s_nop 0
T a[64:65],v18,32768
T a[66:67],v18,34816
M v[120:123],a[100:103],v[144:147],v[120:123]
T a[68:69],v18,36864
T a[70:71],v18,38912
M v[120:123],a[104:107],v[160:163],v[120:123]
MF v100,v6,v100
MF v101,v6,v101
M v[120:123],a[108:111],v[176:179],v[120:123]
T a[72:73],v18,40960
T a[74:75],v18,43008
M v[120:123],a[112:115],v[192:195],v[120:123]
s_waitcnt vmcnt(9)
T a[76:77],v18,45056
T a[78:79],v18,47104
M v[120:123],a[116:119],v[208:211],v[120:123]
buffer_store_dword v15, v17, s[8:11], s84 offen sc1
M v[120:123],a[120:123],v[224:227],v[120:123]
s_nop 0
T a[80:81],v18,49152
T a[82:83],v18,51200
M v[120:123],a[124:127],v[240:243],v[120:123]
T a[84:85],v18,53248
T a[86:87],v18,55296
M v[124:127],a[124:127],v[244:247],0
MF v102,v6,v102
MF v103,v6,v103
M v[124:127],a[120:123],v[228:231],v[124:127]
T a[88:89],v18,57344
T a[90:91],v18,59392
M v[124:127],a[116:119],v[212:215],v[124:127]
T a[92:93],v18,61440
T a[94:95],v18,63488
M v[124:127],a[112:115],v[196:199],v[124:127]
MF v108,v6,v108
MF v109,v6,v109
M v[124:127],a[108:111],v[180:183],v[124:127]
MF v110,v6,v110
MF v111,v6,v111
M v[124:127],a[104:107],v[164:167],v[124:127]
C v100,v100,v101
C v101,v102,v103
M v[124:127],a[100:103],v[148:151],v[124:127]
s_waitcnt lgkmcnt(0)
C v102,v108,v109
C v103,v110,v111
M v[124:127],a[96:99],v[132:135],v[124:127]
buffer_store_dwordx4 v[100:103], v7, s[8:11], s30 offen offset:0 sc1
M v[64:67],a[64:67],v[128:131],0
s_nop 0
T a[96:97],v19,32768
T a[98:99],v19,34816
M v[64:67],a[68:71],v[144:147],v[64:67]
T a[100:101],v19,36864
T a[102:103],v19,38912
M v[64:67],a[72:75],v[160:163],v[64:67]
MF v112,v5,v112
MF v113,v5,v113
M v[64:67],a[76:79],v[176:179],v[64:67]
T a[104:105],v19,40960
T a[106:107],v19,43008
M v[64:67],a[80:83],v[192:195],v[64:67]
T a[108:109],v19,45056
T a[110:111],v19,47104
M v[64:67],a[84:87],v[208:211],v[64:67]
MF v114,v5,v114
MF v115,v5,v115
M v[64:67],a[88:91],v[224:227],v[64:67]
T a[112:113],v19,49152
T a[114:115],v19,51200
M v[64:67],a[92:95],v[240:243],v[64:67]
T a[116:117],v19,53248
T a[118:119],v19,55296
M v[68:71],a[92:95],v[244:247],0
MF v120,v5,v120
MF v121,v5,v121
M v[68:71],a[88:91],v[228:231],v[68:71]
T a[120:121],v19,57344
T a[122:123],v19,59392
M v[68:71],a[84:87],v[212:215],v[68:71]
T a[124:125],v19,61440
T a[126:127],v19,63488
M v[68:71],a[80:83],v[196:199],v[68:71]
MF v122,v5,v122
MF v123,v5,v123
M v[68:71],a[76:79],v[180:183],v[68:71]
C v112,v112,v113
C v113,v114,v115
M v[68:71],a[72:75],v[164:167],v[68:71]
C v114,v120,v121
C v115,v122,v123
M v[68:71],a[68:71],v[148:151],v[68:71]
buffer_store_dwordx4 v[112:115], v7, s[8:11], s29 offen offset:1024 sc1
M v[68:71],a[64:67],v[132:135],v[68:71]
s_waitcnt lgkmcnt(0)
MF v116,v6,v116
MF v117,v6,v117
M v[72:75],a[96:99],v[128:131],0
T a[64:65],v20,32768
T a[66:67],v20,34816
M v[72:75],a[100:103],v[144:147],v[72:75]
T a[68:69],v20,36864
T a[70:71],v20,38912
M v[72:75],a[104:107],v[160:163],v[72:75]
MF v118,v6,v118
MF v119,v6,v119
M v[72:75],a[108:111],v[176:179],v[72:75]
T a[72:73],v20,40960
T a[74:75],v20,43008
M v[72:75],a[112:115],v[192:195],v[72:75]
T a[76:77],v20,45056
T a[78:79],v20,47104
M v[72:75],a[116:119],v[208:211],v[72:75]
MF v124,v6,v124
MF v125,v6,v125
M v[72:75],a[120:123],v[224:227],v[72:75]
T a[80:81],v20,49152
T a[82:83],v20,51200
M v[72:75],a[124:127],v[240:243],v[72:75]
T a[84:85],v20,53248
T a[86:87],v20,55296
M v[76:79],a[124:127],v[244:247],0
MF v126,v6,v126
MF v127,v6,v127
M v[76:79],a[120:123],v[228:231],v[76:79]
T a[88:89],v20,57344
T a[90:91],v20,59392
M v[76:79],a[116:119],v[212:215],v[76:79]
T a[92:93],v20,61440
T a[94:95],v20,63488
M v[76:79],a[112:115],v[196:199],v[76:79]
C v116,v116,v117
C v117,v118,v119
M v[76:79],a[108:111],v[180:183],v[76:79]
C v118,v124,v125
C v119,v126,v127
M v[76:79],a[104:107],v[164:167],v[76:79]
buffer_store_dwordx4 v[116:119], v7, s[8:11], s30 offen offset:1024 sc1
M v[76:79],a[100:103],v[148:151],v[76:79]
SA s29,s33,12288
s_waitcnt vmcnt(12)
v_readlane_b32 s92, v31, 0
v_readlane_b32 s94, v31, 1
M v[76:79],a[96:99],v[132:135],v[76:79]
s_waitcnt lgkmcnt(0)
s_waitcnt vmcnt(9)
v_sub_f32 v30, 1.0, v26
s_waitcnt vmcnt(7)
v_lshlrev_b32 v48, 16, v44
M v[80:83],a[64:67],v[128:131],0
SA s30,s33,26624
T a[96:97],v21,32768
T a[98:99],v21,34816
M v[80:83],a[68:71],v[144:147],v[80:83]
T a[100:101],v21,36864
T a[102:103],v21,38912
M v[80:83],a[72:75],v[160:163],v[80:83]
v_and_b32 v49, 0xffff0000, v44
v_lshlrev_b32 v50, 16, v45
M v[80:83],a[76:79],v[176:179],v[80:83]
T a[104:105],v21,40960
T a[106:107],v21,43008
M v[80:83],a[80:83],v[192:195],v[80:83]
T a[108:109],v21,45056
T a[110:111],v21,47104
M v[80:83],a[84:87],v[208:211],v[80:83]
MF v64,v5,v64
MF v65,v5,v65
M v[80:83],a[88:91],v[224:227],v[80:83]
T a[112:113],v21,49152
T a[114:115],v21,51200
M v[80:83],a[92:95],v[240:243],v[80:83]
T a[116:117],v21,53248
T a[118:119],v21,55296
M v[84:87],a[92:95],v[244:247],0
MF v66,v5,v66
MF v67,v5,v67
M v[84:87],a[88:91],v[228:231],v[84:87]
T a[120:121],v21,57344
T a[122:123],v21,59392
M v[84:87],a[84:87],v[212:215],v[84:87]
T a[124:125],v21,61440
T a[126:127],v21,63488
M v[84:87],a[80:83],v[196:199],v[84:87]
MF v72,v5,v72
MF v73,v5,v73
M v[84:87],a[76:79],v[180:183],v[84:87]
MF v74,v5,v74
MF v75,v5,v75
M v[84:87],a[72:75],v[164:167],v[84:87]
C v64,v64,v65
C v65,v66,v67
M v[84:87],a[68:71],v[148:151],v[84:87]
C v66,v72,v73
C v67,v74,v75
M v[84:87],a[64:67],v[132:135],v[84:87]
s_waitcnt lgkmcnt(0)
buffer_store_dwordx4 v[64:67], v7, s[8:11], s29 offen offset:0 sc1
M v[88:91],a[96:99],v[128:131],0
v_and_b32 v51, 0xffff0000, v45
v_lshlrev_b32 v52, 16, v46
M v[88:91],a[100:103],v[144:147],v[88:91]
MF v68,v6,v68
MF v69,v6,v69
M v[88:91],a[104:107],v[160:163],v[88:91]
MF v70,v6,v70
MF v71,v6,v71
M v[88:91],a[108:111],v[176:179],v[88:91]
MF v76,v6,v76
MF v77,v6,v77
M v[88:91],a[112:115],v[192:195],v[88:91]
MF v78,v6,v78
MF v79,v6,v79
M v[88:91],a[116:119],v[208:211],v[88:91]
C v68,v68,v69
C v69,v70,v71
M v[88:91],a[120:123],v[224:227],v[88:91]
C v70,v76,v77
C v71,v78,v79
M v[88:91],a[124:127],v[240:243],v[88:91]
buffer_store_dwordx4 v[68:71], v7, s[8:11], s30 offen offset:0 sc1
M v[92:95],a[124:127],v[244:247],0
v_and_b32 v53, 0xffff0000, v46
v_lshlrev_b32 v54, 16, v47
M v[92:95],a[120:123],v[228:231],v[92:95]
v_and_b32 v55, 0xffff0000, v47
v_cmp_eq_u32 s[80:81], s92, v29
M v[92:95],a[116:119],v[212:215],v[92:95]
v_cmp_eq_u32 s[82:83], s94, v29
M v[92:95],a[112:115],v[196:199],v[92:95]
MF v80,v5,v80
MF v81,v5,v81
M v[92:95],a[108:111],v[180:183],v[92:95]
MF v82,v5,v82
MF v83,v5,v83
M v[92:95],a[104:107],v[164:167],v[92:95]
MF v88,v5,v88
MF v89,v5,v89
M v[92:95],a[100:103],v[148:151],v[92:95]
MF v90,v5,v90
MF v91,v5,v91
M v[92:95],a[96:99],v[132:135],v[92:95]
C v80,v80,v81
C v81,v82,v83
C v82,v88,v89
C v83,v90,v91
buffer_store_dwordx4 v[80:83], v7, s[8:11], s29 offen offset:1024 sc1
MF v84,v6,v84
MF v85,v6,v85
MF v86,v6,v86
MF v87,v6,v87
MF v92,v6,v92
MF v93,v6,v93
MF v94,v6,v94
MF v95,v6,v95
C v84,v84,v85
C v85,v86,v87
C v86,v92,v93
C v87,v94,v95
buffer_store_dwordx4 v[84:87], v7, s[8:11], s30 offen offset:1024 sc1
buffer_load_dword v9, v33, s[8:11], s46 offen sc1
s_waitcnt vmcnt(1)
buffer_store_dword v15, v16, s[8:11], s3 offen sc1
s_cmp_lt_u32 s42, 8
s_cbranch_scc1 L_red
s_waitcnt vmcnt(1)
v_cmp_eq_u32 vcc, 1, v9
s_mov_b32 s91, 65536
s_lshl_b32 s70, 1, s41
s_mov_b32 s69, 0xffff
s_or_b32 s70, s70, vcc_lo
s_mov_b32 s68, s70
s_barrier
s_cmp_lg_u32 s70, 0
s_cbranch_scc1 L_vk0
s_call_b64 s[36:37], L_rpoll
L_vk0:
s_ff1_i32_b32 s71, s70
s_bitset0_b32 s70, s71
s_mul_i32 s71, s71, 114688
SA s16,s71,s78
buffer_load_dwordx4 v[128:131], v27, s[8:11], s16 offen sc1
s_cmp_lg_u32 s70, 0
s_cbranch_scc1 L_vk1
s_call_b64 s[36:37], L_rpoll
L_vk1:
s_ff1_i32_b32 s71, s70
s_bitset0_b32 s70, s71
s_mul_i32 s71, s71, 114688
SA s17,s71,s78
buffer_load_dwordx4 v[132:135], v27, s[8:11], s17 offen sc1
s_cmp_lg_u32 s70, 0
s_cbranch_scc1 L_vk2
s_call_b64 s[36:37], L_rpoll
L_vk2:
s_ff1_i32_b32 s71, s70
s_bitset0_b32 s70, s71
s_mul_i32 s71, s71, 114688
SA s18,s71,s78
buffer_load_dwordx4 v[136:139], v27, s[8:11], s18 offen sc1
s_cmp_lg_u32 s70, 0
s_cbranch_scc1 L_vk3
s_call_b64 s[36:37], L_rpoll
L_vk3:
s_ff1_i32_b32 s71, s70
s_bitset0_b32 s70, s71
s_mul_i32 s71, s71, 114688
SA s19,s71,s78
buffer_load_dwordx4 v[140:143], v27, s[8:11], s19 offen sc1
s_cmp_lg_u32 s70, 0
s_cbranch_scc1 L_vk4
s_call_b64 s[36:37], L_rpoll
L_vk4:
s_ff1_i32_b32 s71, s70
s_bitset0_b32 s70, s71
s_mul_i32 s71, s71, 114688
SA s48,s71,s78
buffer_load_dwordx4 v[144:147], v27, s[8:11], s48 offen sc1
s_cmp_lg_u32 s70, 0
s_cbranch_scc1 L_vk5
s_call_b64 s[36:37], L_rpoll
L_vk5:
s_ff1_i32_b32 s71, s70
s_bitset0_b32 s70, s71
s_mul_i32 s71, s71, 114688
SA s49,s71,s78
buffer_load_dwordx4 v[148:151], v27, s[8:11], s49 offen sc1
s_cmp_lg_u32 s70, 0
s_cbranch_scc1 L_vk6
s_call_b64 s[36:37], L_rpoll
L_vk6:
s_ff1_i32_b32 s71, s70
s_bitset0_b32 s70, s71
s_mul_i32 s71, s71, 114688
SA s50,s71,s78
buffer_load_dwordx4 v[152:155], v27, s[8:11], s50 offen sc1
s_cmp_lg_u32 s70, 0
s_cbranch_scc1 L_vk7
s_call_b64 s[36:37], L_rpoll
L_vk7:
s_ff1_i32_b32 s71, s70
s_bitset0_b32 s70, s71
s_mul_i32 s71, s71, 114688
SA s51,s71,s78
buffer_load_dwordx4 v[156:159], v27, s[8:11], s51 offen sc1
s_or_b64 vcc, s[80:81], s[82:83]
s_cbranch_vccnz L_moe2
L_moe_ret2:
MF v48,v30,v48
MF v49,v30,v49
MF v50,v30,v50
MF v51,v30,v51
MF v52,v30,v52
MF v53,v30,v53
MF v54,v30,v54
MF v55,v30,v55
s_cmp_lg_u32 s70, 0
s_cbranch_scc1 L_vk8
s_call_b64 s[36:37], L_rpoll
L_vk8:
s_ff1_i32_b32 s71, s70
s_bitset0_b32 s70, s71
s_mul_i32 s71, s71, 114688
SA s21,s71,s78
buffer_load_dwordx4 v[160:163], v27, s[8:11], s21 offen sc1
s_waitcnt vmcnt(8)
M v[56:59],a[246:249],v[128:131],0
M v[60:63],a[244:247],v[128:131],0
s_cmp_lg_u32 s70, 0
s_cbranch_scc1 L_vk9
s_call_b64 s[36:37], L_rpoll
L_vk9:
s_ff1_i32_b32 s71, s70
s_bitset0_b32 s70, s71
s_mul_i32 s71, s71, 114688
SA s22,s71,s78
buffer_load_dwordx4 v[164:167], v27, s[8:11], s22 offen sc1
s_waitcnt vmcnt(8)
M v[56:59],a[246:249],v[132:135],v[56:59]
M v[60:63],a[244:247],v[132:135],v[60:63]
s_cmp_lg_u32 s70, 0
s_cbranch_scc1 L_vk10
s_call_b64 s[36:37], L_rpoll
L_vk10:
s_ff1_i32_b32 s71, s70
s_bitset0_b32 s70, s71
s_mul_i32 s71, s71, 114688
SA s23,s71,s78
buffer_load_dwordx4 v[168:171], v27, s[8:11], s23 offen sc1
s_waitcnt vmcnt(8)
M v[56:59],a[246:249],v[136:139],v[56:59]
M v[60:63],a[244:247],v[136:139],v[60:63]
s_cmp_lg_u32 s70, 0
s_cbranch_scc1 L_vk11
s_call_b64 s[36:37], L_rpoll
L_vk11:
s_ff1_i32_b32 s71, s70
s_bitset0_b32 s70, s71
s_mul_i32 s71, s71, 114688
SA s24,s71,s78
buffer_load_dwordx4 v[172:175], v27, s[8:11], s24 offen sc1
s_waitcnt vmcnt(8)
M v[56:59],a[246:249],v[140:143],v[56:59]
M v[60:63],a[244:247],v[140:143],v[60:63]
s_cmp_lg_u32 s70, 0
s_cbranch_scc1 L_vk12
s_call_b64 s[36:37], L_rpoll
L_vk12:
s_ff1_i32_b32 s71, s70
s_bitset0_b32 s70, s71
s_mul_i32 s71, s71, 114688
SA s25,s71,s78
buffer_load_dwordx4 v[176:179], v27, s[8:11], s25 offen sc1
s_waitcnt vmcnt(8)
M v[56:59],a[246:249],v[144:147],v[56:59]
M v[60:63],a[244:247],v[144:147],v[60:63]
s_cmp_lg_u32 s70, 0
s_cbranch_scc1 L_vk13
s_call_b64 s[36:37], L_rpoll
L_vk13:
s_ff1_i32_b32 s71, s70
s_bitset0_b32 s70, s71
s_mul_i32 s71, s71, 114688
SA s26,s71,s78
buffer_load_dwordx4 v[180:183], v27, s[8:11], s26 offen sc1
s_waitcnt vmcnt(8)
M v[56:59],a[246:249],v[148:151],v[56:59]
M v[60:63],a[244:247],v[148:151],v[60:63]
s_cmp_lg_u32 s70, 0
s_cbranch_scc1 L_vk14
s_call_b64 s[36:37], L_rpoll
L_vk14:
s_ff1_i32_b32 s71, s70
s_bitset0_b32 s70, s71
s_mul_i32 s71, s71, 114688
SA s27,s71,s78
buffer_load_dwordx4 v[184:187], v27, s[8:11], s27 offen sc1
s_waitcnt vmcnt(8)
M v[56:59],a[246:249],v[152:155],v[56:59]
M v[60:63],a[244:247],v[152:155],v[60:63]
s_cmp_lg_u32 s70, 0
s_cbranch_scc1 L_vk15
s_call_b64 s[36:37], L_rpoll
L_vk15:
s_ff1_i32_b32 s71, s70
s_bitset0_b32 s70, s71
s_mul_i32 s71, s71, 114688
SA s28,s71,s78
buffer_load_dwordx4 v[188:191], v27, s[8:11], s28 offen sc1
s_waitcnt vmcnt(8)
M v[56:59],a[246:249],v[156:159],v[56:59]
M v[60:63],a[244:247],v[156:159],v[60:63]
s_waitcnt vmcnt(7)
M v[56:59],a[246:249],v[160:163],v[56:59]
M v[60:63],a[244:247],v[160:163],v[60:63]
s_waitcnt vmcnt(6)
M v[56:59],a[246:249],v[164:167],v[56:59]
M v[60:63],a[244:247],v[164:167],v[60:63]
s_waitcnt vmcnt(5)
M v[56:59],a[246:249],v[168:171],v[56:59]
M v[60:63],a[244:247],v[168:171],v[60:63]
s_waitcnt vmcnt(4)
M v[56:59],a[246:249],v[172:175],v[56:59]
M v[60:63],a[244:247],v[172:175],v[60:63]
s_waitcnt vmcnt(3)
M v[56:59],a[246:249],v[176:179],v[56:59]
M v[60:63],a[244:247],v[176:179],v[60:63]
s_waitcnt vmcnt(2)
M v[56:59],a[246:249],v[180:183],v[56:59]
M v[60:63],a[244:247],v[180:183],v[60:63]
s_waitcnt vmcnt(1)
M v[56:59],a[246:249],v[184:187],v[56:59]
M v[60:63],a[244:247],v[184:187],v[60:63]
s_waitcnt vmcnt(0)
M v[56:59],a[246:249],v[188:191],v[56:59]
M v[60:63],a[244:247],v[188:191],v[60:63]
s_nop 7
v_permlane16_swap_b32 v56, v60
v_permlane16_swap_b32 v57, v61
v_permlane16_swap_b32 v58, v62
v_permlane16_swap_b32 v59, v63
v_fmac_f32 v48, v26, v56
v_fmac_f32 v49, v26, v57
v_fmac_f32 v50, v26, v58
v_fmac_f32 v51, v26, v59
v_fmac_f32 v52, v26, v60
v_fmac_f32 v53, v26, v61
v_fmac_f32 v54, v26, v62
v_fmac_f32 v55, v26, v63
C v44,v48,v49
C v45,v50,v51
C v46,v52,v53
C v47,v54,v55
buffer_store_dwordx4 v[44:47], v28, s[52:55], s79 offen sc1
s_endpgm
L_d2h:
M v[128:131],a[64:67],v[48:51],v[128:131]
R a[96:99],v7,40960
R a[100:103],v7,41984
M v[128:131],a[68:71],v[56:59],v[128:131]
SA m0,s28,135168
E v18,v64
M v[132:135],a[68:71],v[60:63],v[132:135]
buffer_load_dwordx4 v4, s[8:11], s26 offen offset:0 sc1 lds
M v[132:135],a[64:67],v[52:55],v[132:135]
R a[104:107],v7,43008
R a[108:111],v7,44032
M v[140:143],a[72:75],v[52:55],v[140:143]
s_cmp_gt_u32 s20, 3
E v19,v65
M v[140:143],a[76:79],v[60:63],v[140:143]
s_cselect_b64 s[82:83], -1, 0
AF v30,v28,v30
AF v31,v29,v31
M v[136:139],a[76:79],v[56:59],v[136:139]
s_cmp_eq_u32 s20, 3
R a[112:115],v7,45056
R a[116:119],v7,46080
M v[136:139],a[72:75],v[48:51],v[136:139]
s_cselect_b64 s[66:67], s[16:17], s[82:83]
buffer_load_dwordx4 v4, s[8:11], s26 offen offset:1024 sc1 lds
M v[144:147],a[80:83],v[48:51],v[144:147]
s_cselect_b64 s[68:69], s[18:19], s[82:83]
E v20,v66
M v[144:147],a[84:87],v[56:59],v[144:147]
s_cselect_b64 s[70:71], s[48:49], s[82:83]
R a[120:123],v7,47104
R a[124:127],v7,48128
M v[148:151],a[84:87],v[60:63],v[148:151]
s_cselect_b64 s[72:73], s[50:51], s[82:83]
v_cndmask_b32 v100, v36, v8, s[66:67]
v_cndmask_b32 v101, v36, v8, s[68:69]
M v[148:151],a[80:83],v[52:55],v[148:151]
buffer_load_dwordx4 v4, s[8:11], s26 offen offset:2048 sc1 lds
M v[156:159],a[88:91],v[52:55],v[156:159]
v_cndmask_b32 v102, v36, v8, s[70:71]
AF v26,v18,v19
M v[156:159],a[92:95],v[60:63],v[156:159]
E v21,v67
M v[152:155],a[92:95],v[56:59],v[152:155]
v_cndmask_b32 v103, v36, v8, s[72:73]
C v40,v18,v19
M v[152:155],a[88:91],v[48:51],v[152:155]
s_waitcnt lgkmcnt(0)
buffer_load_dwordx4 v4, s[8:11], s26 offen offset:3072 sc1 lds
M v[160:163],a[96:99],v[48:51],v[160:163]
s_cmp_gt_u32 s20, 2
R a[64:67],v7,49152
R a[68:71],v7,50176
M v[160:163],a[100:103],v[56:59],v[160:163]
s_cselect_b64 s[82:83], -1, 0
E v22,v72
M v[164:167],a[100:103],v[60:63],v[164:167]
s_cmp_eq_u32 s20, 2
AF v26,v20,v26
C v41,v20,v21
M v[164:167],a[96:99],v[52:55],v[164:167]
s_mul_i32 s21, s41, 1048576
R a[72:75],v7,51200
R a[76:79],v7,52224
M v[172:175],a[104:107],v[52:55],v[172:175]
s_cselect_b64 s[74:75], s[16:17], s[82:83]
E v23,v73
M v[172:175],a[108:111],v[60:63],v[172:175]
s_cselect_b64 s[76:77], s[18:19], s[82:83]
AF v26,v21,v26
AF v26,v22,v26
M v[168:171],a[108:111],v[56:59],v[168:171]
s_cselect_b64 s[78:79], s[48:49], s[82:83]
R a[80:83],v7,53248
R a[84:87],v7,54272
M v[168:171],a[104:107],v[48:51],v[168:171]
s_cselect_b64 s[80:81], s[50:51], s[82:83]
v_cndmask_b32 v108, v36, v8, s[74:75]
v_cndmask_b32 v109, v36, v8, s[76:77]
M v[176:179],a[112:115],v[48:51],v[176:179]
SA s21,s21,589824
E v24,v74
M v[176:179],a[116:119],v[56:59],v[176:179]
s_lshl_b32 s84, s42, 1
R a[88:91],v7,55296
R a[92:95],v7,56320
M v[180:183],a[116:119],v[60:63],v[180:183]
s_sub_u32 s22, 11, s84
v_cndmask_b32 v110, v36, v8, s[78:79]
C v42,v22,v23
M v[180:183],a[112:115],v[52:55],v[180:183]
s_mov_b32 s23, 536870912
s_waitcnt vmcnt(16)
v_cmp_gt_u32 vcc, 2, v5
AF v26,v23,v26
M v[188:191],a[120:123],v[52:55],v[188:191]
s_cbranch_vccnz L_lsh2
L_lrh2:
v_cndmask_b32 v111, v36, v8, s[80:81]
M v[188:191],a[124:127],v[60:63],v[188:191]
SA m0,s28,98304
E v25,v75
M v[184:187],a[124:127],v[56:59],v[184:187]
s_cmp_gt_u32 s20, 1
buffer_load_dwordx4 v3, s[8:11], s21 offen offset:0 sc1 lds
M v[184:187],a[120:123],v[48:51],v[184:187]
s_waitcnt lgkmcnt(0)
E v18,v68
M v[192:195],a[64:67],v[48:51],v[192:195]
s_cselect_b64 s[82:83], -1, 0
R a[96:99],v7,57344
R a[100:103],v7,58368
M v[192:195],a[68:71],v[56:59],v[192:195]
s_cmp_eq_u32 s20, 1
buffer_load_dwordx4 v3, s[8:11], s21 offen offset:1024 sc1 lds
M v[196:199],a[68:71],v[60:63],v[196:199]
s_cselect_b64 s[66:67], s[16:17], s[82:83]
E v19,v69
M v[196:199],a[64:67],v[52:55],v[196:199]
s_cselect_b64 s[68:69], s[18:19], s[82:83]
R a[104:107],v7,59392
R a[108:111],v7,60416
M v[204:207],a[72:75],v[52:55],v[204:207]
s_cselect_b64 s[70:71], s[48:49], s[82:83]
buffer_load_dwordx4 v3, s[8:11], s21 offen offset:2048 sc1 lds
M v[204:207],a[76:79],v[60:63],v[204:207]
s_cselect_b64 s[72:73], s[50:51], s[82:83]
v_cndmask_b32 v116, v36, v8, s[66:67]
v_cndmask_b32 v117, v36, v8, s[68:69]
M v[200:203],a[76:79],v[56:59],v[200:203]
R a[112:115],v7,61440
R a[116:119],v7,62464
M v[200:203],a[72:75],v[48:51],v[200:203]
v_cndmask_b32 v118, v36, v8, s[70:71]
AF v26,v24,v26
M v[208:211],a[80:83],v[48:51],v[208:211]
buffer_load_dwordx4 v3, s[8:11], s21 offen offset:3072 sc1 lds
M v[208:211],a[84:87],v[56:59],v[208:211]
SA m0,s28,102400
R a[120:123],v7,63488
R a[124:127],v7,64512
M v[212:215],a[84:87],v[60:63],v[212:215]
v_cndmask_b32 v119, v36, v8, s[72:73]
C v43,v24,v25
M v[212:215],a[80:83],v[52:55],v[212:215]
s_cmp_gt_u32 s20, 0
E v20,v70
M v[220:223],a[88:91],v[52:55],v[220:223]
s_cselect_b64 s[82:83], -1, 0
buffer_load_dwordx4 v4, s[8:11], s21 offen offset:0 sc1 lds
M v[220:223],a[92:95],v[60:63],v[220:223]
s_cmp_eq_u32 s20, 0
E v21,v71
M v[216:219],a[92:95],v[56:59],v[216:219]
s_waitcnt lgkmcnt(0)
E v22,v76
M v[216:219],a[88:91],v[48:51],v[216:219]
s_barrier
M v[224:227],a[96:99],v[48:51],v[224:227]
s_cselect_b64 s[74:75], s[16:17], s[82:83]
R a[64:67],v2,0
R a[68:71],v2,1024
M v[224:227],a[100:103],v[56:59],v[224:227]
s_cselect_b64 s[76:77], s[18:19], s[82:83]
buffer_load_dwordx4 v4, s[8:11], s21 offen offset:1024 sc1 lds
M v[228:231],a[100:103],v[60:63],v[228:231]
s_cselect_b64 s[78:79], s[48:49], s[82:83]
E v23,v77
M v[228:231],a[96:99],v[52:55],v[228:231]
s_cselect_b64 s[80:81], s[50:51], s[82:83]
R a[72:75],v2,2048
R a[76:79],v2,3072
M v[236:239],a[104:107],v[52:55],v[236:239]
v_cndmask_b32 v124, v36, v8, s[74:75]
v_cndmask_b32 v125, v36, v8, s[76:77]
M v[236:239],a[108:111],v[60:63],v[236:239]
buffer_load_dwordx4 v4, s[8:11], s21 offen offset:2048 sc1 lds
M v[232:235],a[108:111],v[56:59],v[232:235]
R a[80:83],v2,4096
R a[84:87],v2,5120
M v[232:235],a[104:107],v[48:51],v[232:235]
v_cndmask_b32 v126, v36, v8, s[78:79]
AF v26,v25,v26
M v[240:243],a[112:115],v[48:51],v[240:243]
v_cndmask_b32 v127, v36, v8, s[80:81]
AF v27,v18,v19
M v[240:243],a[116:119],v[56:59],v[240:243]
R a[88:91],v2,6144
R a[92:95],v2,7168
M v[244:247],a[116:119],v[60:63],v[244:247]
buffer_load_dwordx4 v4, s[8:11], s21 offen offset:3072 sc1 lds
M v[244:247],a[112:115],v[52:55],v[244:247]
SA s21,s21,32768
E v24,v78
M v[252:255],a[120:123],v[52:55],v[252:255]
s_sub_u32 s22, s22, 1
E v25,v79
M v[252:255],a[124:127],v[60:63],v[252:255]
s_cselect_b32 s21, s23, s21
C v44,v18,v19
AF v27,v20,v27
M v[248:251],a[124:127],v[56:59],v[248:251]
s_waitcnt lgkmcnt(0)
C v45,v20,v21
AF v27,v21,v27
M v[248:251],a[120:123],v[48:51],v[248:251]
AF v27,v22,v27
C v46,v22,v23
AF v27,v23,v27
AF v27,v24,v27
C v47,v24,v25
AF v27,v25,v27
L_d3h:
M v[100:103],a[64:67],a[32:35],v[100:103]
R a[96:99],v2,8192
R a[100:103],v2,9216
M v[100:103],a[68:71],a[36:39],v[100:103]
R a[104:107],v2,10240
R a[108:111],v2,11264
M v[100:103],a[72:75],a[40:43],v[100:103]
R a[112:115],v2,12288
R a[116:119],v2,13312
M v[100:103],a[76:79],a[44:47],v[100:103]
R a[120:123],v2,14336
R a[124:127],v2,15360
M v[100:103],a[80:83],a[48:51],v[100:103]
v_add_u32 v8, 0x20000, v7
M v[100:103],a[84:87],a[52:55],v[100:103]
buffer_load_dword v5, v9, s[8:11], s46 offen sc1
M v[100:103],a[88:91],a[56:59],v[100:103]
buffer_load_dword v6, off, s[8:11], s47 offset:16 sc1
M v[100:103],a[92:95],a[60:63],v[100:103]
s_waitcnt lgkmcnt(0)
E v18,v80
M v[108:111],a[96:99],a[32:35],v[108:111]
R a[64:67],v2,16384
R a[68:71],v2,17408
M v[108:111],a[100:103],a[36:39],v[108:111]
R a[72:75],v2,18432
R a[76:79],v2,19456
M v[108:111],a[104:107],a[40:43],v[108:111]
R a[80:83],v2,20480
R a[84:87],v2,21504
M v[108:111],a[108:111],a[44:47],v[108:111]
R a[88:91],v2,22528
R a[92:95],v2,23552
M v[108:111],a[112:115],a[48:51],v[108:111]
E v19,v81
M v[108:111],a[116:119],a[52:55],v[108:111]
E v20,v82
M v[108:111],a[120:123],a[56:59],v[108:111]
E v21,v83
M v[108:111],a[124:127],a[60:63],v[108:111]
s_waitcnt lgkmcnt(0)
E v22,v88
M v[116:119],a[64:67],a[32:35],v[116:119]
R a[96:99],v2,24576
R a[100:103],v2,25600
M v[116:119],a[68:71],a[36:39],v[116:119]
R a[104:107],v2,26624
R a[108:111],v2,27648
M v[116:119],a[72:75],a[40:43],v[116:119]
R a[112:115],v2,28672
R a[116:119],v2,29696
M v[116:119],a[76:79],a[44:47],v[116:119]
R a[120:123],v2,30720
R a[124:127],v2,31744
M v[116:119],a[80:83],a[48:51],v[116:119]
E v23,v89
M v[116:119],a[84:87],a[52:55],v[116:119]
E v24,v90
M v[116:119],a[88:91],a[56:59],v[116:119]
s_waitcnt vmcnt(18) lgkmcnt(0)
E v25,v91
M v[116:119],a[92:95],a[60:63],v[116:119]
s_barrier
M v[124:127],a[96:99],a[32:35],v[124:127]
R a[64:67],v7,0
R a[68:71],v7,1024
M v[124:127],a[100:103],a[36:39],v[124:127]
R a[72:75],v7,2048
R a[76:79],v7,3072
M v[124:127],a[104:107],a[40:43],v[124:127]
R a[80:83],v7,4096
R a[84:87],v7,5120
M v[124:127],a[108:111],a[44:47],v[124:127]
R a[88:91],v7,6144
R a[92:95],v7,7168
M v[124:127],a[112:115],a[48:51],v[124:127]
AF v26,v18,v26
C v56,v18,v19
M v[124:127],a[116:119],a[52:55],v[124:127]
AF v26,v19,v26
AF v26,v20,v26
M v[124:127],a[120:123],a[56:59],v[124:127]
s_waitcnt lgkmcnt(0)
E v18,v84
M v[124:127],a[124:127],a[60:63],v[124:127]
E v19,v85
C v57,v20,v21
AF v26,v21,v26
AF v26,v22,v26
C v58,v22,v23
AF v26,v23,v26
AF v26,v24,v26
C v59,v24,v25
AF v26,v25,v26
E v20,v86
E v21,v87
AF v27,v18,v27
C v60,v18,v19
AF v27,v19,v27
E v22,v92
E v23,v93
AF v27,v20,v27
C v61,v20,v21
AF v27,v21,v27
E v24,v94
E v25,v95
AF v27,v22,v27
C v62,v22,v23
AF v27,v23,v27
AF v27,v24,v27
C v63,v24,v25
AF v27,v25,v27
v_max_f32 v10, v26, v27
v_cmp_lt_f32 vcc, s31, v10
s_nop 0
s_cbranch_vccnz L_std3h
L_rtd3h:
M v[128:131],a[64:67],v[40:43],v[128:131]
R a[96:99],v7,8192
R a[100:103],v7,9216
M v[128:131],a[68:71],v[56:59],v[128:131]
s_waitcnt vmcnt(0)
v_cmp_ne_u32 vcc, 1, v6
AF v30,v26,v30
M v[132:135],a[68:71],v[60:63],v[132:135]
s_cbranch_vccnz L_fqs
L_fqr:
E v18,v100
M v[132:135],a[64:67],v[44:47],v[132:135]
SA s73,s32,4096
R a[104:107],v7,10240
R a[108:111],v7,11264
M v[140:143],a[72:75],v[44:47],v[140:143]
SA s74,s32,8192
E v19,v101
M v[140:143],a[76:79],v[60:63],v[140:143]
SA s75,s32,12288
buffer_load_dwordx4 a[0:3], v7, s[8:11], s32 offen offset:0 sc1
M v[136:139],a[76:79],v[56:59],v[136:139]
R a[112:115],v7,12288
R a[116:119],v7,13312
M v[136:139],a[72:75],v[40:43],v[136:139]
E v20,v102
M v[144:147],a[80:83],v[40:43],v[144:147]
buffer_load_dwordx4 a[4:7], v7, s[8:11], s32 offen offset:1024 sc1
M v[144:147],a[84:87],v[56:59],v[144:147]
R a[120:123],v7,14336
R a[124:127],v7,15360
M v[148:151],a[84:87],v[60:63],v[148:151]
AF v31,v27,v31
AF v29,v18,v19
M v[148:151],a[80:83],v[44:47],v[148:151]
buffer_load_dwordx4 a[8:11], v7, s[8:11], s32 offen offset:2048 sc1
M v[156:159],a[88:91],v[44:47],v[156:159]
E v21,v103
M v[156:159],a[92:95],v[60:63],v[156:159]
C v52,v18,v19
AF v29,v20,v29
M v[152:155],a[92:95],v[56:59],v[152:155]
buffer_load_dwordx4 a[12:15], v7, s[8:11], s32 offen offset:3072 sc1
M v[152:155],a[88:91],v[40:43],v[152:155]
s_waitcnt lgkmcnt(0)
E v22,v108
M v[160:163],a[96:99],v[40:43],v[160:163]
R a[64:67],v7,16384
R a[68:71],v7,17408
M v[160:163],a[100:103],v[56:59],v[160:163]
buffer_load_dwordx4 a[16:19], v7, s[8:11], s73 offen offset:0 sc1
M v[164:167],a[100:103],v[60:63],v[164:167]
E v23,v109
M v[164:167],a[96:99],v[44:47],v[164:167]
R a[72:75],v7,18432
R a[76:79],v7,19456
M v[172:175],a[104:107],v[44:47],v[172:175]
buffer_load_dwordx4 a[20:23], v7, s[8:11], s73 offen offset:1024 sc1
M v[172:175],a[108:111],v[60:63],v[172:175]
C v53,v20,v21
AF v29,v21,v29
M v[168:171],a[108:111],v[56:59],v[168:171]
R a[80:83],v7,20480
R a[84:87],v7,21504
M v[168:171],a[104:107],v[40:43],v[168:171]
buffer_load_dwordx4 a[24:27], v7, s[8:11], s73 offen offset:2048 sc1
M v[176:179],a[112:115],v[40:43],v[176:179]
E v24,v110
M v[176:179],a[116:119],v[56:59],v[176:179]
R a[88:91],v7,22528
R a[92:95],v7,23552
M v[180:183],a[116:119],v[60:63],v[180:183]
buffer_load_dwordx4 a[28:31], v7, s[8:11], s73 offen offset:3072 sc1
M v[180:183],a[112:115],v[44:47],v[180:183]
E v25,v111
M v[188:191],a[120:123],v[44:47],v[188:191]
AF v29,v22,v29
C v54,v22,v23
M v[188:191],a[124:127],v[60:63],v[188:191]
buffer_load_dwordx4 a[32:35], v7, s[8:11], s74 offen offset:0 sc1
M v[184:187],a[124:127],v[56:59],v[184:187]
E v18,v116
M v[184:187],a[120:123],v[40:43],v[184:187]
s_waitcnt lgkmcnt(0)
AF v29,v23,v29
AF v29,v24,v29
M v[192:195],a[64:67],v[40:43],v[192:195]
R a[96:99],v7,24576
R a[100:103],v7,25600
M v[192:195],a[68:71],v[56:59],v[192:195]
buffer_load_dwordx4 a[36:39], v7, s[8:11], s74 offen offset:1024 sc1
M v[196:199],a[68:71],v[60:63],v[196:199]
E v19,v117
M v[196:199],a[64:67],v[44:47],v[196:199]
R a[104:107],v7,26624
R a[108:111],v7,27648
M v[204:207],a[72:75],v[44:47],v[204:207]
buffer_load_dwordx4 a[40:43], v7, s[8:11], s74 offen offset:2048 sc1
M v[204:207],a[76:79],v[60:63],v[204:207]
E v20,v118
M v[200:203],a[76:79],v[56:59],v[200:203]
R a[112:115],v7,28672
R a[116:119],v7,29696
M v[200:203],a[72:75],v[40:43],v[200:203]
buffer_load_dwordx4 a[44:47], v7, s[8:11], s74 offen offset:3072 sc1
M v[208:211],a[80:83],v[40:43],v[208:211]
C v55,v24,v25
AF v29,v25,v29
M v[208:211],a[84:87],v[56:59],v[208:211]
R a[120:123],v7,30720
R a[124:127],v7,31744
M v[212:215],a[84:87],v[60:63],v[212:215]
buffer_load_dwordx4 a[48:51], v7, s[8:11], s75 offen offset:0 sc1
M v[212:215],a[80:83],v[44:47],v[212:215]
E v21,v119
M v[220:223],a[88:91],v[44:47],v[220:223]
AF v29,v18,v29
C v48,v18,v19
M v[220:223],a[92:95],v[60:63],v[220:223]
buffer_load_dwordx4 a[52:55], v7, s[8:11], s75 offen offset:1024 sc1
M v[216:219],a[92:95],v[56:59],v[216:219]
s_waitcnt lgkmcnt(0)
E v22,v124
M v[216:219],a[88:91],v[40:43],v[216:219]
s_barrier
M v[224:227],a[96:99],v[40:43],v[224:227]
R a[64:67],v8,0
R a[68:71],v8,1024
M v[224:227],a[100:103],v[56:59],v[224:227]
buffer_load_dwordx4 a[56:59], v7, s[8:11], s75 offen offset:2048 sc1
M v[228:231],a[100:103],v[60:63],v[228:231]
v_mov_b32 v15, 4
AF v29,v19,v29
M v[228:231],a[96:99],v[44:47],v[228:231]
R a[72:75],v8,2048
R a[76:79],v8,3072
M v[236:239],a[104:107],v[44:47],v[236:239]
buffer_store_dword v15, v1, s[8:11], s45 offen sc1
M v[236:239],a[108:111],v[60:63],v[236:239]
buffer_load_dwordx4 a[60:63], v7, s[8:11], s75 offen offset:3072 sc1
M v[232:235],a[108:111],v[56:59],v[232:235]
s_cmp_ge_u32 s42, 2
R a[80:83],v8,4096
R a[84:87],v8,5120
M v[232:235],a[104:107],v[40:43],v[232:235]
s_cselect_b32 s84, 4, 2
v_cmp_gt_u32 vcc, s84, v5
AF v29,v20,v29
M v[240:243],a[112:115],v[40:43],v[240:243]
s_cbranch_vccnz L_lsh4
L_lrh4:
E v23,v125
M v[240:243],a[116:119],v[56:59],v[240:243]
R a[88:91],v8,6144
R a[92:95],v8,7168
M v[244:247],a[116:119],v[60:63],v[244:247]
E v24,v126
M v[244:247],a[112:115],v[44:47],v[244:247]
E v25,v127
M v[252:255],a[120:123],v[44:47],v[252:255]
C v49,v20,v21
AF v29,v21,v29
M v[252:255],a[124:127],v[60:63],v[252:255]
AF v29,v22,v29
C v50,v22,v23
M v[248:251],a[124:127],v[56:59],v[248:251]
s_waitcnt lgkmcnt(0)
AF v29,v23,v29
AF v29,v24,v29
M v[248:251],a[120:123],v[40:43],v[248:251]
C v51,v24,v25
AF v29,v25,v29
v_cmp_lt_f32 vcc, s31, v29
s_nop 0
s_cbranch_vccnz L_std4h
L_rtd4h:
M v[132:135],a[64:67],v[52:55],v[132:135]
R a[96:99],v8,8192
R a[100:103],v8,9216
M v[132:135],a[68:71],v[48:51],v[132:135]
R a[104:107],v8,10240
R a[108:111],v8,11264
M v[140:143],a[72:75],v[52:55],v[140:143]
SA m0,s28,65536
R a[112:115],v8,12288
R a[116:119],v8,13312
M v[140:143],a[76:79],v[48:51],v[140:143]
R a[120:123],v8,14336
R a[124:127],v8,15360
M v[148:151],a[80:83],v[52:55],v[148:151]
buffer_load_dwordx4 v3, s[8:11], s21 offen offset:0 sc1 lds
M v[148:151],a[84:87],v[48:51],v[148:151]
AF v31,v29,v31
v_mov_b32 v10, v30
M v[156:159],a[88:91],v[52:55],v[156:159]
v_mov_b32 v11, v31
C v128,v128,v129
M v[156:159],a[92:95],v[48:51],v[156:159]
s_waitcnt lgkmcnt(0)
v_permlane16_swap_b32 v10, v30
M v[164:167],a[96:99],v[52:55],v[164:167]
R a[64:67],v8,16384
R a[68:71],v8,17408
M v[164:167],a[100:103],v[48:51],v[164:167]
R a[72:75],v8,18432
R a[76:79],v8,19456
M v[172:175],a[104:107],v[52:55],v[172:175]
R a[80:83],v8,20480
R a[84:87],v8,21504
M v[172:175],a[108:111],v[48:51],v[172:175]
R a[88:91],v8,22528
R a[92:95],v8,23552
M v[180:183],a[112:115],v[52:55],v[180:183]
buffer_load_dwordx4 v3, s[8:11], s21 offen offset:1024 sc1 lds
M v[180:183],a[116:119],v[48:51],v[180:183]
v_permlane16_swap_b32 v11, v31
M v[188:191],a[120:123],v[52:55],v[188:191]
AF v30,v10,v30
AF v31,v11,v31
M v[188:191],a[124:127],v[48:51],v[188:191]
s_waitcnt lgkmcnt(0)
buffer_load_dwordx4 v3, s[8:11], s21 offen offset:2048 sc1 lds
M v[196:199],a[64:67],v[52:55],v[196:199]
R a[96:99],v8,24576
R a[100:103],v8,25600
M v[196:199],a[68:71],v[48:51],v[196:199]
R a[104:107],v8,26624
R a[108:111],v8,27648
M v[204:207],a[72:75],v[52:55],v[204:207]
R a[112:115],v8,28672
R a[116:119],v8,29696
M v[204:207],a[76:79],v[48:51],v[204:207]
R a[120:123],v8,30720
R a[124:127],v8,31744
M v[212:215],a[80:83],v[52:55],v[212:215]
buffer_load_dwordx4 v3, s[8:11], s21 offen offset:3072 sc1 lds
M v[212:215],a[84:87],v[48:51],v[212:215]
SA m0,s28,69632
v_mov_b32 v10, v30
v_mov_b32 v11, v31
M v[220:223],a[88:91],v[52:55],v[220:223]
s_waitcnt lgkmcnt(0)
v_permlane32_swap_b32 v10, v30
M v[220:223],a[92:95],v[48:51],v[220:223]
s_barrier
M v[228:231],a[96:99],v[52:55],v[228:231]
R a[64:67],v2,32768
R a[68:71],v2,33792
M v[228:231],a[100:103],v[48:51],v[228:231]
R a[72:75],v2,34816
R a[76:79],v2,35840
M v[236:239],a[104:107],v[52:55],v[236:239]
R a[80:83],v2,36864
R a[84:87],v2,37888
M v[236:239],a[108:111],v[48:51],v[236:239]
R a[88:91],v2,38912
R a[92:95],v2,39936
M v[244:247],a[112:115],v[52:55],v[244:247]
v_permlane32_swap_b32 v11, v31
M v[244:247],a[116:119],v[48:51],v[244:247]
s_waitcnt vmcnt(4)
buffer_load_dwordx4 v4, s[8:11], s21 offen offset:0 sc1 lds
M v[252:255],a[120:123],v[52:55],v[252:255]
s_waitcnt lgkmcnt(0)
AF v30,v10,v30
AF v31,v11,v31
M v[252:255],a[124:127],v[48:51],v[252:255]
v_rcp_f32 v5, v30
M v[64:67],a[64:67],a[0:3],0
R a[96:99],v2,40960
R a[100:103],v2,41984
M v[64:67],a[68:71],a[4:7],v[64:67]
v_rcp_f32 v6, v31
M v[64:67],a[72:75],a[8:11],v[64:67]
buffer_load_dwordx4 v4, s[8:11], s21 offen offset:1024 sc1 lds
M v[64:67],a[76:79],a[12:15],v[64:67]
R a[104:107],v2,43008
R a[108:111],v2,44032
M v[64:67],a[80:83],a[16:19],v[64:67]
W a192,v5
W a193,v6
M v[64:67],a[84:87],a[20:23],v[64:67]
buffer_load_dwordx4 v4, s[8:11], s21 offen offset:2048 sc1 lds
M v[64:67],a[88:91],a[24:27],v[64:67]
R a[112:115],v2,45056
R a[116:119],v2,46080
M v[64:67],a[92:95],a[28:31],v[64:67]
v_mov_b32 v30, 0
v_mov_b32 v31, 0
M v[68:71],a[92:95],a[60:63],0
buffer_load_dwordx4 v4, s[8:11], s21 offen offset:3072 sc1 lds
M v[68:71],a[88:91],a[56:59],v[68:71]
SA s21,s21,32768
R a[120:123],v2,47104
R a[124:127],v2,48128
M v[68:71],a[84:87],a[52:55],v[68:71]
s_sub_u32 s22, s22, 1
v_mov_b32 v32, 0
v_mov_b32 v33, 0
M v[68:71],a[80:83],a[48:51],v[68:71]
s_cselect_b32 s21, s23, s21
v_mov_b32 v34, 0
v_mov_b32 v35, 0
M v[68:71],a[76:79],a[44:47],v[68:71]
s_mul_i32 s26, s41, 1048576
v_mov_b32 v36, 0
v_mov_b32 v37, 0
M v[68:71],a[72:75],a[40:43],v[68:71]
SA s26,s26,17367040
v_mov_b32 v38, 0
v_mov_b32 v39, 0
M v[68:71],a[68:71],a[36:39],v[68:71]
SA m0,s28,0
E v18,v64
M v[68:71],a[64:67],a[32:35],v[68:71]
s_waitcnt lgkmcnt(0)
buffer_load_dwordx4 v3, s[8:11], s26 offen offset:0 sc1 lds
M v[72:75],a[96:99],a[0:3],0
R a[64:67],v2,49152
R a[68:71],v2,50176
M v[72:75],a[100:103],a[4:7],v[72:75]
E v19,v65
M v[72:75],a[104:107],a[8:11],v[72:75]
buffer_load_dwordx4 v3, s[8:11], s26 offen offset:1024 sc1 lds
M v[72:75],a[108:111],a[12:15],v[72:75]
R a[72:75],v2,51200
R a[76:79],v2,52224
M v[72:75],a[112:115],a[16:19],v[72:75]
E v20,v66
M v[72:75],a[116:119],a[20:23],v[72:75]
buffer_load_dwordx4 v3, s[8:11], s26 offen offset:2048 sc1 lds
M v[72:75],a[120:123],a[24:27],v[72:75]
R a[80:83],v2,53248
R a[84:87],v2,54272
M v[72:75],a[124:127],a[28:31],v[72:75]
E v21,v67
M v[76:79],a[124:127],a[60:63],0
buffer_load_dwordx4 v3, s[8:11], s26 offen offset:3072 sc1 lds
M v[76:79],a[120:123],a[56:59],v[76:79]
SA m0,s28,4096
R a[88:91],v2,55296
R a[92:95],v2,56320
M v[76:79],a[116:119],a[52:55],v[76:79]
E v22,v68
M v[76:79],a[112:115],a[48:51],v[76:79]
E v23,v69
M v[76:79],a[108:111],a[44:47],v[76:79]
buffer_load_dwordx4 v4, s[8:11], s26 offen offset:0 sc1 lds
M v[76:79],a[104:107],a[40:43],v[76:79]
AF v26,v18,v19
C v40,v18,v19
M v[76:79],a[100:103],a[36:39],v[76:79]
E v24,v70
M v[76:79],a[96:99],a[32:35],v[76:79]
s_waitcnt lgkmcnt(0)
AF v26,v20,v26
C v41,v20,v21
M v[80:83],a[64:67],a[0:3],0
R a[96:99],v2,57344
R a[100:103],v2,58368
M v[80:83],a[68:71],a[4:7],v[80:83]
buffer_load_dwordx4 v4, s[8:11], s26 offen offset:1024 sc1 lds
M v[80:83],a[72:75],a[8:11],v[80:83]
E v25,v71
M v[80:83],a[76:79],a[12:15],v[80:83]
R a[104:107],v2,59392
R a[108:111],v2,60416
M v[80:83],a[80:83],a[16:19],v[80:83]
AF v26,v21,v26
AF v27,v22,v23
M v[80:83],a[84:87],a[20:23],v[80:83]
buffer_load_dwordx4 v4, s[8:11], s26 offen offset:2048 sc1 lds
M v[80:83],a[88:91],a[24:27],v[80:83]
R a[112:115],v2,61440
R a[116:119],v2,62464
M v[80:83],a[92:95],a[28:31],v[80:83]
E v18,v72
M v[84:87],a[92:95],a[60:63],0
E v19,v73
M v[84:87],a[88:91],a[56:59],v[84:87]
R a[120:123],v2,63488
R a[124:127],v2,64512
M v[84:87],a[84:87],a[52:55],v[84:87]
buffer_load_dwordx4 v4, s[8:11], s26 offen offset:3072 sc1 lds
M v[84:87],a[80:83],a[48:51],v[84:87]
SA s26,s26,32768
E v20,v74
M v[84:87],a[76:79],a[44:47],v[84:87]
SA m0,s28,32768
C v44,v22,v23
AF v27,v24,v27
M v[84:87],a[72:75],a[40:43],v[84:87]
C v45,v24,v25
AF v27,v25,v27
M v[84:87],a[68:71],a[36:39],v[84:87]
s_waitcnt vmcnt(8) lgkmcnt(0)
buffer_load_dwordx4 v3, s[8:11], s26 offen offset:0 sc1 lds
M v[84:87],a[64:67],a[32:35],v[84:87]
s_barrier
M v[88:91],a[96:99],a[0:3],0
R a[64:67],v2,0
R a[68:71],v2,1024
M v[88:91],a[100:103],a[4:7],v[88:91]
E v21,v75
M v[88:91],a[104:107],a[8:11],v[88:91]
buffer_load_dwordx4 v3, s[8:11], s26 offen offset:1024 sc1 lds
M v[88:91],a[108:111],a[12:15],v[88:91]
R a[72:75],v2,2048
R a[76:79],v2,3072
M v[88:91],a[112:115],a[16:19],v[88:91]
E v22,v76
M v[88:91],a[116:119],a[20:23],v[88:91]
E v23,v77
M v[88:91],a[120:123],a[24:27],v[88:91]
R a[80:83],v2,4096
R a[84:87],v2,5120
M v[88:91],a[124:127],a[28:31],v[88:91]
buffer_load_dwordx4 v3, s[8:11], s26 offen offset:2048 sc1 lds
M v[92:95],a[124:127],a[60:63],0
E v24,v78
M v[92:95],a[120:123],a[56:59],v[92:95]
R a[88:91],v2,6144
R a[92:95],v2,7168
M v[92:95],a[116:119],a[52:55],v[92:95]
E v25,v79
M v[92:95],a[112:115],a[48:51],v[92:95]
buffer_load_dwordx4 v3, s[8:11], s26 offen offset:3072 sc1 lds
M v[92:95],a[108:111],a[44:47],v[92:95]
AF v26,v18,v26
C v42,v18,v19
M v[92:95],a[104:107],a[40:43],v[92:95]
AF v26,v19,v26
AF v26,v20,v26
M v[92:95],a[100:103],a[36:39],v[92:95]
s_waitcnt lgkmcnt(0)
C v43,v20,v21
AF v26,v21,v26
M v[92:95],a[96:99],a[32:35],v[92:95]
AF v27,v22,v27
C v46,v22,v23
AF v27,v23,v27
AF v27,v24,v27
C v47,v24,v25
AF v27,v25,v27
M v[96:99],a[64:67],a[0:3],0
R a[96:99],v2,8192
R a[100:103],v2,9216
M v[96:99],a[68:71],a[4:7],v[96:99]
SA m0,s28,98304
E v18,v80
M v[96:99],a[72:75],a[8:11],v[96:99]
buffer_load_dwordx4 v3, s[8:11], s21 offen offset:0 sc1 lds
M v[96:99],a[76:79],a[12:15],v[96:99]
R a[104:107],v2,10240
R a[108:111],v2,11264
M v[96:99],a[80:83],a[16:19],v[96:99]
E v19,v81
M v[96:99],a[84:87],a[20:23],v[96:99]
AF v26,v18,v26
C v56,v18,v19
M v[96:99],a[88:91],a[24:27],v[96:99]
R a[112:115],v2,12288
R a[116:119],v2,13312
M v[96:99],a[92:95],a[28:31],v[96:99]
buffer_load_dwordx4 v3, s[8:11], s21 offen offset:1024 sc1 lds
M v[100:103],a[92:95],a[60:63],0
E v20,v82
M v[100:103],a[88:91],a[56:59],v[100:103]
R a[120:123],v2,14336
R a[124:127],v2,15360
M v[100:103],a[84:87],a[52:55],v[100:103]
E v21,v83
M v[100:103],a[80:83],a[48:51],v[100:103]
buffer_load_dwordx4 v3, s[8:11], s21 offen offset:2048 sc1 lds
M v[100:103],a[76:79],a[44:47],v[100:103]
AF v26,v19,v26
AF v26,v20,v26
M v[100:103],a[72:75],a[40:43],v[100:103]
E v22,v88
M v[100:103],a[68:71],a[36:39],v[100:103]
C v57,v20,v21
AF v26,v21,v26
M v[100:103],a[64:67],a[32:35],v[100:103]
s_waitcnt lgkmcnt(0)
buffer_load_dwordx4 v3, s[8:11], s21 offen offset:3072 sc1 lds
M v[108:111],a[96:99],a[32:35],0
R a[64:67],v2,16384
R a[68:71],v2,17408
M v[108:111],a[100:103],a[36:39],v[108:111]
E v23,v89
M v[108:111],a[104:107],a[40:43],v[108:111]
SA m0,s28,102400
AF v26,v22,v26
C v58,v22,v23
M v[108:111],a[108:111],a[44:47],v[108:111]
R a[72:75],v2,18432
R a[76:79],v2,19456
M v[108:111],a[112:115],a[48:51],v[108:111]
buffer_load_dwordx4 v4, s[8:11], s21 offen offset:0 sc1 lds
M v[108:111],a[116:119],a[52:55],v[108:111]
E v24,v90
M v[108:111],a[120:123],a[56:59],v[108:111]
R a[80:83],v2,20480
R a[84:87],v2,21504
M v[108:111],a[124:127],a[60:63],v[108:111]
E v25,v91
M v[104:107],a[124:127],a[28:31],0
buffer_load_dwordx4 v4, s[8:11], s21 offen offset:1024 sc1 lds
M v[104:107],a[120:123],a[24:27],v[104:107]
R a[88:91],v2,22528
R a[92:95],v2,23552
M v[104:107],a[116:119],a[20:23],v[104:107]
AF v26,v23,v26
AF v26,v24,v26
M v[104:107],a[112:115],a[16:19],v[104:107]
E v18,v84
M v[104:107],a[108:111],a[12:15],v[104:107]
buffer_load_dwordx4 v4, s[8:11], s21 offen offset:2048 sc1 lds
M v[104:107],a[104:107],a[8:11],v[104:107]
C v59,v24,v25
AF v26,v25,v26
M v[104:107],a[100:103],a[4:7],v[104:107]
E v19,v85
M v[104:107],a[96:99],a[0:3],v[104:107]
s_waitcnt lgkmcnt(0)
AF v27,v18,v27
C v60,v18,v19
M v[112:115],a[64:67],a[0:3],0
R a[96:99],v2,24576
R a[100:103],v2,25600
M v[112:115],a[68:71],a[4:7],v[112:115]
buffer_load_dwordx4 v4, s[8:11], s21 offen offset:3072 sc1 lds
M v[112:115],a[72:75],a[8:11],v[112:115]
SA s21,s21,32768
E v20,v86
M v[112:115],a[76:79],a[12:15],v[112:115]
s_sub_u32 s22, s22, 1
R a[104:107],v2,26624
R a[108:111],v2,27648
M v[112:115],a[80:83],a[16:19],v[112:115]
s_cselect_b32 s21, s23, s21
AF v27,v19,v27
C v129,v130,v131
M v[112:115],a[84:87],a[20:23],v[112:115]
SA m0,s28,36864
E v21,v87
M v[112:115],a[88:91],a[24:27],v[112:115]
R a[112:115],v2,28672
R a[116:119],v2,29696
M v[112:115],a[92:95],a[28:31],v[112:115]
buffer_load_dwordx4 v4, s[8:11], s26 offen offset:0 sc1 lds
M v[116:119],a[92:95],a[60:63],0
E v22,v92
M v[116:119],a[88:91],a[56:59],v[116:119]
R a[120:123],v2,30720
R a[124:127],v2,31744
M v[116:119],a[84:87],a[52:55],v[116:119]
AF v27,v20,v27
C v61,v20,v21
M v[116:119],a[80:83],a[48:51],v[116:119]
buffer_load_dwordx4 v4, s[8:11], s26 offen offset:1024 sc1 lds
M v[116:119],a[76:79],a[44:47],v[116:119]
E v23,v93
M v[116:119],a[72:75],a[40:43],v[116:119]
AF v27,v21,v27
AF v27,v22,v27
M v[116:119],a[68:71],a[36:39],v[116:119]
s_waitcnt vmcnt(14) lgkmcnt(0)
C v62,v22,v23
AF v27,v23,v27
M v[116:119],a[64:67],a[32:35],v[116:119]
s_barrier
M v[124:127],a[96:99],a[32:35],0
R a[64:67],v7,0
R a[68:71],v7,1024
M v[124:127],a[100:103],a[36:39],v[124:127]
buffer_load_dwordx4 v4, s[8:11], s26 offen offset:2048 sc1 lds
M v[124:127],a[104:107],a[40:43],v[124:127]
E v24,v94
M v[124:127],a[108:111],a[44:47],v[124:127]
R a[72:75],v7,2048
R a[76:79],v7,3072
M v[124:127],a[112:115],a[48:51],v[124:127]
E v25,v95
M v[124:127],a[116:119],a[52:55],v[124:127]
buffer_load_dwordx4 v4, s[8:11], s26 offen offset:3072 sc1 lds
M v[124:127],a[120:123],a[56:59],v[124:127]
R a[80:83],v7,4096
R a[84:87],v7,5120
M v[124:127],a[124:127],a[60:63],v[124:127]
AF v27,v24,v27
C v63,v24,v25
M v[120:123],a[124:127],a[28:31],0
SA s26,s26,32768
AF v27,v25,v27
C v130,v136,v137
M v[120:123],a[120:123],a[24:27],v[120:123]
R a[88:91],v7,6144
R a[92:95],v7,7168
C v131,v138,v139
W a128,v128
W a129,v129
W a130,v130
W a131,v131
C v144,v144,v145
C v145,v146,v147
C v146,v152,v153
C v147,v154,v155
W a132,v144
W a133,v145
W a134,v146
W a135,v147
C v132,v132,v133
C v133,v134,v135
C v134,v140,v141
C v135,v142,v143
W a160,v132
W a161,v133
W a162,v134
W a163,v135
C v160,v160,v161
C v161,v162,v163
C v162,v168,v169
C v163,v170,v171
W a136,v160
W a137,v161
W a138,v162
W a139,v163
C v148,v148,v149
C v149,v150,v151
C v150,v156,v157
C v151,v158,v159
W a164,v148
W a165,v149
W a166,v150
W a167,v151
C v176,v176,v177
C v177,v178,v179
C v178,v184,v185
C v179,v186,v187
W a140,v176
W a141,v177
W a142,v178
W a143,v179
C v164,v164,v165
C v165,v166,v167
C v166,v172,v173
C v167,v174,v175
W a168,v164
W a169,v165
W a170,v166
W a171,v167
C v192,v192,v193
C v193,v194,v195
C v194,v200,v201
C v195,v202,v203
W a144,v192
W a145,v193
W a146,v194
W a147,v195
C v180,v180,v181
C v181,v182,v183
C v182,v188,v189
C v183,v190,v191
W a172,v180
W a173,v181
W a174,v182
W a175,v183
C v208,v208,v209
C v209,v210,v211
C v210,v216,v217
C v211,v218,v219
W a148,v208
W a149,v209
W a150,v210
W a151,v211
C v196,v196,v197
C v197,v198,v199
C v198,v204,v205
C v199,v206,v207
W a176,v196
W a177,v197
W a178,v198
W a179,v199
C v224,v224,v225
C v225,v226,v227
C v226,v232,v233
C v227,v234,v235
W a152,v224
W a153,v225
W a154,v226
W a155,v227
C v212,v212,v213
C v213,v214,v215
C v214,v220,v221
C v215,v222,v223
W a180,v212
W a181,v213
W a182,v214
W a183,v215
C v240,v240,v241
C v241,v242,v243
C v242,v248,v249
C v243,v250,v251
W a156,v240
W a157,v241
W a158,v242
W a159,v243
C v228,v228,v229
C v229,v230,v231
C v230,v236,v237
C v231,v238,v239
W a184,v228
W a185,v229
W a186,v230
W a187,v231
C v244,v244,v245
C v245,v246,v247
C v246,v252,v253
C v247,v254,v255
W a188,v244
W a189,v245
W a190,v246
W a191,v247
M v[120:123],a[116:119],a[20:23],v[120:123]
M v[120:123],a[112:115],a[16:19],v[120:123]
M v[120:123],a[108:111],a[12:15],v[120:123]
M v[120:123],a[104:107],a[8:11],v[120:123]
M v[120:123],a[100:103],a[4:7],v[120:123]
s_waitcnt lgkmcnt(0)
M v[120:123],a[96:99],a[0:3],v[120:123]
v_max_f32 v10, v26, v27
v_min_f32 v11, v26, v27
v_cmp_lt_f32 vcc, s31, v10
v_cmp_gt_f32 s[64:65], s24, v11
s_nop 0
s_or_b64 vcc, vcc, s[64:65]
s_cbranch_vccnz L_sth1
L_rth1:
M v[128:131],a[64:67],v[40:43],0
R a[96:99],v7,8192
R a[100:103],v7,9216
M v[128:131],a[68:71],v[56:59],v[128:131]
SA m0,s28,65536
E v18,v96
M v[132:135],a[68:71],v[60:63],0
buffer_load_dwordx4 v3, s[8:11], s21 offen offset:0 sc1 lds
M v[132:135],a[64:67],v[44:47],v[132:135]
R a[104:107],v7,10240
R a[108:111],v7,11264
M v[140:143],a[72:75],v[44:47],0
E v19,v97
M v[140:143],a[76:79],v[60:63],v[140:143]
AF v30,v26,v30
AF v31,v27,v31
M v[136:139],a[76:79],v[56:59],0
R a[112:115],v7,12288
R a[116:119],v7,13312
M v[136:139],a[72:75],v[40:43],v[136:139]
buffer_load_dwordx4 v3, s[8:11], s21 offen offset:1024 sc1 lds
M v[144:147],a[80:83],v[40:43],0
E v20,v98
M v[144:147],a[84:87],v[56:59],v[144:147]
R a[120:123],v7,14336
R a[124:127],v7,15360
M v[148:151],a[84:87],v[60:63],0
s_mov_b32 s40, 0
AF v28,v18,v19
C v48,v18,v19
M v[148:151],a[80:83],v[44:47],v[148:151]
s_mov_b32 s7, 0
buffer_load_dwordx4 v3, s[8:11], s21 offen offset:2048 sc1 lds
M v[156:159],a[88:91],v[44:47],0
s_and_b32 s39, s39, 1
E v21,v99
M v[156:159],a[92:95],v[60:63],v[156:159]
s_or_b32 s39, s39, 2
AF v28,v20,v28
C v49,v20,v21
M v[152:155],a[92:95],v[56:59],0
s_sub_u32 s27, 5, s42
AF v28,v21,v28
M v[152:155],a[88:91],v[40:43],v[152:155]
s_waitcnt lgkmcnt(0)
buffer_load_dwordx4 v3, s[8:11], s21 offen offset:3072 sc1 lds
M v[160:163],a[96:99],v[40:43],0
SA m0,s28,69632
R a[64:67],v7,16384
R a[68:71],v7,17408
M v[160:163],a[100:103],v[56:59],v[160:163]
E v22,v104
M v[164:167],a[100:103],v[60:63],0
E v23,v105
M v[164:167],a[96:99],v[44:47],v[164:167]
R a[72:75],v7,18432
R a[76:79],v7,19456
M v[172:175],a[104:107],v[44:47],0
buffer_load_dwordx4 v4, s[8:11], s21 offen offset:0 sc1 lds
M v[172:175],a[108:111],v[60:63],v[172:175]
AF v28,v22,v28
C v50,v22,v23
M v[168:171],a[108:111],v[56:59],0
R a[80:83],v7,20480
R a[84:87],v7,21504
M v[168:171],a[104:107],v[40:43],v[168:171]
buffer_load_dwordx4 v4, s[8:11], s21 offen offset:1024 sc1 lds
M v[176:179],a[112:115],v[40:43],0
E v24,v106
M v[176:179],a[116:119],v[56:59],v[176:179]
R a[88:91],v7,22528
R a[92:95],v7,23552
M v[180:183],a[116:119],v[60:63],0
buffer_load_dwordx4 v4, s[8:11], s21 offen offset:2048 sc1 lds
M v[180:183],a[112:115],v[44:47],v[180:183]
E v25,v107
M v[188:191],a[120:123],v[44:47],0
AF v28,v23,v28
AF v28,v24,v28
M v[188:191],a[124:127],v[60:63],v[188:191]
C v51,v24,v25
AF v28,v25,v28
M v[184:187],a[124:127],v[56:59],0
buffer_load_dwordx4 v4, s[8:11], s21 offen offset:3072 sc1 lds
M v[184:187],a[120:123],v[40:43],v[184:187]
s_waitcnt lgkmcnt(0)
E v18,v100
M v[192:195],a[64:67],v[40:43],0
SA s21,s21,32768
R a[96:99],v7,24576
R a[100:103],v7,25600
M v[192:195],a[68:71],v[56:59],v[192:195]
s_sub_u32 s22, s22, 1
E v19,v101
M v[196:199],a[68:71],v[60:63],0
s_cselect_b32 s21, s23, s21
AF v29,v18,v19
C v52,v18,v19
M v[196:199],a[64:67],v[44:47],v[196:199]
R a[104:107],v7,26624
R a[108:111],v7,27648
M v[204:207],a[72:75],v[44:47],0
M v[204:207],a[76:79],v[60:63],v[204:207]
E v20,v102
M v[200:203],a[76:79],v[56:59],0
R a[112:115],v7,28672
R a[116:119],v7,29696
M v[200:203],a[72:75],v[40:43],v[200:203]
M v[208:211],a[80:83],v[40:43],0
M v[208:211],a[84:87],v[56:59],v[208:211]
R a[120:123],v7,30720
R a[124:127],v7,31744
M v[212:215],a[84:87],v[60:63],0
E v21,v103
M v[212:215],a[80:83],v[44:47],v[212:215]
AF v29,v20,v29
C v53,v20,v21
M v[220:223],a[88:91],v[44:47],0
AF v29,v21,v29
M v[220:223],a[92:95],v[60:63],v[220:223]
E v22,v108
M v[216:219],a[92:95],v[56:59],0
s_waitcnt vmcnt(12) lgkmcnt(0)
M v[216:219],a[88:91],v[40:43],v[216:219]
s_barrier
M v[224:227],a[96:99],v[40:43],0
R a[64:67],v2,32768
R a[68:71],v2,33792
M v[224:227],a[100:103],v[56:59],v[224:227]
E v23,v109
M v[228:231],a[100:103],v[60:63],0
AF v29,v22,v29
C v54,v22,v23
M v[228:231],a[96:99],v[44:47],v[228:231]
R a[72:75],v2,34816
R a[76:79],v2,35840
M v[236:239],a[104:107],v[44:47],0
E v24,v110
M v[236:239],a[108:111],v[60:63],v[236:239]
AF v29,v23,v29
M v[232:235],a[108:111],v[56:59],0
R a[80:83],v2,36864
R a[84:87],v2,37888
M v[232:235],a[104:107],v[40:43],v[232:235]
M v[240:243],a[112:115],v[40:43],0
E v25,v111
M v[240:243],a[116:119],v[56:59],v[240:243]
R a[88:91],v2,38912
R a[92:95],v2,39936
M v[244:247],a[116:119],v[60:63],0
AF v29,v24,v29
C v55,v24,v25
M v[244:247],a[112:115],v[44:47],v[244:247]
AF v29,v25,v29
M v[252:255],a[120:123],v[44:47],0
M v[252:255],a[124:127],v[60:63],v[252:255]
M v[248:251],a[124:127],v[56:59],0
s_waitcnt lgkmcnt(0)
M v[248:251],a[120:123],v[40:43],v[248:251]
s_cmp_lg_u32 s27, 0
s_cbranch_scc1 L_loop_top
L_final_h:
s_waitcnt vmcnt(8) lgkmcnt(0)
s_barrier
R a[64:67],v7,32768
R a[68:71],v7,33792
R a[72:75],v7,34816
R a[76:79],v7,35840
R a[80:83],v7,36864
R a[84:87],v7,37888
R a[88:91],v7,38912
R a[92:95],v7,39936
v_lshrrev_b32 v14, 7, v7
v_mul_u32_u24 v14, 896, v14
v_lshrrev_b32 v15, 8, v7
v_lshlrev_b32 v15, 5, v15
v_xor_b32 v15, v15, v7
v_and_b32 v15, 0x70, v15
v_add_u32 v0, v14, v15
s_mul_i32 s38, s20, 57344
SA m0,s28,98304
SA s85,s38,0
E v18,v112
buffer_load_dwordx4 v0, s[12:15], s85 offen offset:0 lds
E v19,v113
E v20,v114
AF v28,v18,v28
SA s85,s38,6144
C v56,v18,v19
buffer_load_dwordx4 v0, s[12:15], s85 offen offset:1024 lds
E v21,v115
AF v28,v19,v28
E v22,v120
AF v28,v20,v28
SA s85,s38,12288
C v57,v20,v21
buffer_load_dwordx4 v0, s[12:15], s85 offen offset:2048 lds
E v23,v121
AF v28,v21,v28
E v24,v122
AF v28,v22,v28
SA s85,s38,18432
C v58,v22,v23
buffer_load_dwordx4 v0, s[12:15], s85 offen offset:3072 lds
E v25,v123
AF v28,v23,v28
E v18,v116
AF v28,v24,v28
SA m0,s28,102400
SA s85,s38,28672
C v59,v24,v25
buffer_load_dwordx4 v0, s[12:15], s85 offen offset:0 lds
E v19,v117
AF v28,v25,v28
E v20,v118
AF v29,v18,v29
SA s85,s38,34816
C v60,v18,v19
buffer_load_dwordx4 v0, s[12:15], s85 offen offset:1024 lds
E v21,v119
AF v29,v19,v29
E v22,v124
AF v29,v20,v29
SA s85,s38,40960
C v61,v20,v21
buffer_load_dwordx4 v0, s[12:15], s85 offen offset:2048 lds
E v23,v125
AF v29,v21,v29
E v24,v126
AF v29,v22,v29
SA s85,s38,47104
C v62,v22,v23
buffer_load_dwordx4 v0, s[12:15], s85 offen offset:3072 lds
SA s38,s38,128
E v25,v127
AF v29,v23,v29
AF v29,v24,v29
C v63,v24,v25
AF v29,v25,v29
v_max_f32 v10, v28, v29
v_cmp_lt_f32 vcc, s31, v10
s_nop 0
s_cbranch_vccnz L_stfh
L_rtfh:
AF v30,v28,v30
AF v31,v29,v31
v_mov_b32 v10, v32
v_mov_b32 v11, v36
v_mov_b32 v12, v30
v_mov_b32 v13, v31
buffer_store_dwordx4 v[10:13], v7, s[8:11], s90 offen sc1
s_waitcnt lgkmcnt(0)
M v[128:131],a[64:67],v[48:51],v[128:131]
SA m0,s28,65536
R a[96:99],v7,40960
R a[100:103],v7,41984
M v[128:131],a[68:71],v[56:59],v[128:131]
SA s85,s38,0
buffer_load_dwordx4 v0, s[12:15], s85 offen offset:0 lds
M v[132:135],a[68:71],v[60:63],v[132:135]
SA s85,s38,6144
v_lshrrev_b32 v16, 4, v7
v_lshrrev_b32 v14, 2, v16
M v[132:135],a[64:67],v[52:55],v[132:135]
R a[104:107],v7,43008
R a[108:111],v7,44032
M v[136:139],a[72:75],v[48:51],v[136:139]
buffer_load_dwordx4 v0, s[12:15], s85 offen offset:1024 lds
M v[136:139],a[76:79],v[56:59],v[136:139]
SA s85,s38,12288
v_lshlrev_b32 v14, 7, v14
v_and_b32 v15, 3, v16
M v[140:143],a[76:79],v[60:63],v[140:143]
R a[112:115],v7,45056
R a[116:119],v7,46080
M v[140:143],a[72:75],v[52:55],v[140:143]
buffer_load_dwordx4 v0, s[12:15], s85 offen offset:2048 lds
M v[144:147],a[80:83],v[48:51],v[144:147]
SA s85,s38,18432
v_lshl_add_u32 v14, v15, 3, v14
v_bfe_u32 v15, v16, 3, 2
M v[144:147],a[84:87],v[56:59],v[144:147]
R a[120:123],v7,47104
R a[124:127],v7,48128
M v[148:151],a[84:87],v[60:63],v[148:151]
buffer_load_dwordx4 v0, s[12:15], s85 offen offset:3072 lds
M v[148:151],a[80:83],v[52:55],v[148:151]
v_lshl_add_u32 v18, v15, 5, v14
v_xor_b32 v19, 32, v18
M v[152:155],a[88:91],v[48:51],v[152:155]
v_xor_b32 v20, 64, v18
v_xor_b32 v21, 0x60, v18
M v[152:155],a[92:95],v[56:59],v[152:155]
v_add_u32 v22, 0x10000, v18
v_add_u32 v23, 0x10000, v19
M v[156:159],a[92:95],v[60:63],v[156:159]
v_add_u32 v24, 0x10000, v20
v_add_u32 v25, 0x10000, v21
M v[156:159],a[88:91],v[52:55],v[156:159]
s_waitcnt lgkmcnt(0)
C v128,v128,v129
C v129,v130,v131
M v[160:163],a[96:99],v[48:51],v[160:163]
R a[64:67],v7,49152
R a[68:71],v7,50176
M v[160:163],a[100:103],v[56:59],v[160:163]
C v130,v136,v137
C v131,v138,v139
M v[164:167],a[100:103],v[60:63],v[164:167]
buffer_store_dwordx4 v[128:131], v7, s[8:11], s86 offen offset:0 sc1
M v[164:167],a[96:99],v[52:55],v[164:167]
R a[72:75],v7,51200
R a[76:79],v7,52224
M v[168:171],a[104:107],v[48:51],v[168:171]
C v132,v132,v133
C v133,v134,v135
M v[168:171],a[108:111],v[56:59],v[168:171]
C v134,v140,v141
C v135,v142,v143
M v[172:175],a[108:111],v[60:63],v[172:175]
R a[80:83],v7,53248
R a[84:87],v7,54272
M v[172:175],a[104:107],v[52:55],v[172:175]
buffer_store_dwordx4 v[132:135], v7, s[8:11], s88 offen offset:0 sc1
M v[176:179],a[112:115],v[48:51],v[176:179]
C v144,v144,v145
C v145,v146,v147
M v[176:179],a[116:119],v[56:59],v[176:179]
R a[88:91],v7,55296
R a[92:95],v7,56320
M v[180:183],a[116:119],v[60:63],v[180:183]
C v146,v152,v153
C v147,v154,v155
M v[180:183],a[112:115],v[52:55],v[180:183]
buffer_store_dwordx4 v[144:147], v7, s[8:11], s86 offen offset:1024 sc1
M v[184:187],a[120:123],v[48:51],v[184:187]
C v148,v148,v149
C v149,v150,v151
M v[184:187],a[124:127],v[56:59],v[184:187]
C v150,v156,v157
C v151,v158,v159
M v[188:191],a[124:127],v[60:63],v[188:191]
buffer_store_dwordx4 v[148:151], v7, s[8:11], s88 offen offset:1024 sc1
M v[188:191],a[120:123],v[52:55],v[188:191]
s_waitcnt lgkmcnt(0)
C v160,v160,v161
C v161,v162,v163
M v[192:195],a[64:67],v[48:51],v[192:195]
R a[96:99],v7,57344
R a[100:103],v7,58368
M v[192:195],a[68:71],v[56:59],v[192:195]
C v162,v168,v169
C v163,v170,v171
M v[196:199],a[68:71],v[60:63],v[196:199]
buffer_store_dwordx4 v[160:163], v7, s[8:11], s86 offen offset:2048 sc1
M v[196:199],a[64:67],v[52:55],v[196:199]
R a[104:107],v7,59392
R a[108:111],v7,60416
M v[200:203],a[72:75],v[48:51],v[200:203]
C v164,v164,v165
C v165,v166,v167
M v[200:203],a[76:79],v[56:59],v[200:203]
C v166,v172,v173
C v167,v174,v175
M v[204:207],a[76:79],v[60:63],v[204:207]
R a[112:115],v7,61440
R a[116:119],v7,62464
M v[204:207],a[72:75],v[52:55],v[204:207]
buffer_store_dwordx4 v[164:167], v7, s[8:11], s88 offen offset:2048 sc1
M v[208:211],a[80:83],v[48:51],v[208:211]
C v176,v176,v177
C v177,v178,v179
M v[208:211],a[84:87],v[56:59],v[208:211]
R a[120:123],v7,63488
R a[124:127],v7,64512
M v[212:215],a[84:87],v[60:63],v[212:215]
C v178,v184,v185
C v179,v186,v187
M v[212:215],a[80:83],v[52:55],v[212:215]
buffer_store_dwordx4 v[176:179], v7, s[8:11], s86 offen offset:3072 sc1
M v[216:219],a[88:91],v[48:51],v[216:219]
C v180,v180,v181
C v181,v182,v183
M v[216:219],a[92:95],v[56:59],v[216:219]
C v182,v188,v189
C v183,v190,v191
M v[220:223],a[92:95],v[60:63],v[220:223]
s_waitcnt vmcnt(12) lgkmcnt(0)
buffer_store_dwordx4 v[180:183], v7, s[8:11], s88 offen offset:3072 sc1
M v[220:223],a[88:91],v[52:55],v[220:223]
s_barrier
M v[224:227],a[96:99],v[48:51],v[224:227]
s_nop 0
T a[64:65],v22,32768
T a[66:67],v22,34816
M v[224:227],a[100:103],v[56:59],v[224:227]
T a[68:69],v22,36864
T a[70:71],v22,38912
M v[228:231],a[100:103],v[60:63],v[228:231]
C v192,v192,v193
C v193,v194,v195
M v[228:231],a[96:99],v[52:55],v[228:231]
T a[72:73],v22,40960
T a[74:75],v22,43008
M v[232:235],a[104:107],v[48:51],v[232:235]
T a[76:77],v22,45056
T a[78:79],v22,47104
M v[232:235],a[108:111],v[56:59],v[232:235]
C v194,v200,v201
C v195,v202,v203
M v[236:239],a[108:111],v[60:63],v[236:239]
T a[80:81],v22,49152
T a[82:83],v22,51200
M v[236:239],a[104:107],v[52:55],v[236:239]
T a[84:85],v22,53248
T a[86:87],v22,55296
M v[240:243],a[112:115],v[48:51],v[240:243]
buffer_store_dwordx4 v[192:195], v7, s[8:11], s87 offen offset:0 sc1
M v[240:243],a[116:119],v[56:59],v[240:243]
s_nop 0
T a[88:89],v22,57344
T a[90:91],v22,59392
M v[244:247],a[116:119],v[60:63],v[244:247]
T a[92:93],v22,61440
T a[94:95],v22,63488
M v[244:247],a[112:115],v[52:55],v[244:247]
C v196,v196,v197
C v197,v198,v199
M v[248:251],a[120:123],v[48:51],v[248:251]
C v198,v204,v205
C v199,v206,v207
M v[248:251],a[124:127],v[56:59],v[248:251]
buffer_store_dwordx4 v[196:199], v7, s[8:11], s89 offen offset:0 sc1
M v[252:255],a[124:127],v[60:63],v[252:255]
s_waitcnt lgkmcnt(0)
C v208,v208,v209
C v209,v210,v211
M v[252:255],a[120:123],v[52:55],v[252:255]
C v210,v216,v217
C v211,v218,v219
buffer_store_dwordx4 v[208:211], v7, s[8:11], s87 offen offset:1024 sc1
C v212,v212,v213
C v213,v214,v215
C v214,v220,v221
C v215,v222,v223
buffer_store_dwordx4 v[212:215], v7, s[8:11], s89 offen offset:1024 sc1
C v224,v224,v225
C v225,v226,v227
C v226,v232,v233
C v227,v234,v235
buffer_store_dwordx4 v[224:227], v7, s[8:11], s87 offen offset:2048 sc1
C v228,v228,v229
C v229,v230,v231
C v230,v236,v237
C v231,v238,v239
buffer_store_dwordx4 v[228:231], v7, s[8:11], s89 offen offset:2048 sc1
C v240,v240,v241
C v241,v242,v243
C v242,v248,v249
C v243,v250,v251
buffer_store_dwordx4 v[240:243], v7, s[8:11], s87 offen offset:3072 sc1
C v244,v244,v245
C v245,v246,v247
C v246,v252,v253
C v247,v254,v255
buffer_store_dwordx4 v[244:247], v7, s[8:11], s89 offen offset:3072 sc1
M v[64:67],a[64:67],a[128:131],0
s_nop 0
T a[96:97],v23,32768
T a[98:99],v23,34816
M v[64:67],a[68:71],a[132:135],v[64:67]
SA m0,s28,69632
T a[100:101],v23,36864
T a[102:103],v23,38912
M v[64:67],a[72:75],a[136:139],v[64:67]
SA s85,s38,28672
buffer_load_dwordx4 v0, s[12:15], s85 offen offset:0 lds
M v[64:67],a[76:79],a[140:143],v[64:67]
SA s85,s38,34816
T a[104:105],v23,40960
T a[106:107],v23,43008
M v[64:67],a[80:83],a[144:147],v[64:67]
SA s29,s33,0
T a[108:109],v23,45056
T a[110:111],v23,47104
M v[64:67],a[84:87],a[148:151],v[64:67]
SA s30,s33,14336
buffer_load_dwordx4 v0, s[12:15], s85 offen offset:1024 lds
M v[64:67],a[88:91],a[152:155],v[64:67]
SA s85,s38,40960
T a[112:113],v23,49152
T a[114:115],v23,51200
M v[64:67],a[92:95],a[156:159],v[64:67]
T a[116:117],v23,53248
T a[118:119],v23,55296
M v[68:71],a[92:95],a[188:191],0
buffer_load_dwordx4 v0, s[12:15], s85 offen offset:2048 lds
M v[68:71],a[88:91],a[184:187],v[68:71]
SA s85,s38,47104
T a[120:121],v23,57344
T a[122:123],v23,59392
M v[68:71],a[84:87],a[180:183],v[68:71]
T a[124:125],v23,61440
T a[126:127],v23,63488
M v[68:71],a[80:83],a[176:179],v[68:71]
buffer_load_dwordx4 v0, s[12:15], s85 offen offset:3072 lds
M v[68:71],a[76:79],a[172:175],v[68:71]
SA s38,s38,128
G v5,a192
G v6,a193
M v[68:71],a[72:75],a[168:171],v[68:71]
s_sub_u32 s64, 15, s42
M v[68:71],a[68:71],a[164:167],v[68:71]
s_min_u32 s64, s64, s42
M v[68:71],a[64:67],a[160:163],v[68:71]
s_waitcnt lgkmcnt(0)
M v[72:75],a[96:99],a[128:131],0
s_mul_i32 s45, s64, 8704
T a[64:65],v24,32768
T a[66:67],v24,34816
M v[72:75],a[100:103],a[132:135],v[72:75]
s_lshl_b32 s64, s41, 2
T a[68:69],v24,36864
T a[70:71],v24,38912
M v[72:75],a[104:107],a[136:139],v[72:75]
SA s45,s45,s64
M v[72:75],a[108:111],a[140:143],v[72:75]
s_lshl_b32 s64, s20, 8
T a[72:73],v24,40960
T a[74:75],v24,43008
M v[72:75],a[112:115],a[144:147],v[72:75]
SA s45,s45,s64
T a[76:77],v24,45056
T a[78:79],v24,47104
M v[72:75],a[116:119],a[148:151],v[72:75]
SA s45,s45,104992768
M v[72:75],a[120:123],a[152:155],v[72:75]
s_mov_b32 s64, 1024
T a[80:81],v24,49152
T a[82:83],v24,51200
M v[72:75],a[124:127],a[156:159],v[72:75]
s_mov_b32 s66, 4096
T a[84:85],v24,53248
T a[86:87],v24,55296
M v[76:79],a[124:127],a[188:191],0
s_cmp_lt_u32 s42, 8
M v[76:79],a[120:123],a[184:187],v[76:79]
s_cselect_b32 s64, 4352, s64
T a[88:89],v24,57344
T a[90:91],v24,59392
M v[76:79],a[116:119],a[180:183],v[76:79]
s_cselect_b32 s65, 0, 64
T a[92:93],v24,61440
T a[94:95],v24,63488
M v[76:79],a[112:115],a[176:179],v[76:79]
s_cselect_b32 s66, 536870912, s66
MF v64,v5,v64
MF v65,v5,v65
M v[76:79],a[108:111],a[172:175],v[76:79]
SA s3,s45,s64
MF v66,v5,v66
MF v67,v5,v67
M v[76:79],a[104:107],a[168:171],v[76:79]
SA s45,s45,s65
v_lshrrev_b32 v17, 5, v7
v_min_u32 v15, 1, v17
M v[76:79],a[100:103],a[164:167],v[76:79]
SA m0,s28,0
v_lshlrev_b32 v14, 3, v7
v_lshl_or_b32 v16, v15, 29, v14
M v[76:79],a[96:99],a[160:163],v[76:79]
s_waitcnt lgkmcnt(0)
v_cmp_eq_u32 vcc, 1, v17
v_add_u32 v14, s66, v14
M v[80:83],a[64:67],a[128:131],0
SA s85,s38,0
T a[96:97],v25,32768
T a[98:99],v25,34816
M v[80:83],a[68:71],a[132:135],v[80:83]
T a[100:101],v25,36864
T a[102:103],v25,38912
M v[80:83],a[72:75],a[136:139],v[80:83]
buffer_load_dwordx4 v0, s[12:15], s85 offen offset:0 lds
M v[80:83],a[76:79],a[140:143],v[80:83]
SA s85,s38,6144
T a[104:105],v25,40960
T a[106:107],v25,43008
M v[80:83],a[80:83],a[144:147],v[80:83]
T a[108:109],v25,45056
T a[110:111],v25,47104
M v[80:83],a[84:87],a[148:151],v[80:83]
buffer_load_dwordx4 v0, s[12:15], s85 offen offset:1024 lds
M v[80:83],a[88:91],a[152:155],v[80:83]
SA s85,s38,12288
T a[112:113],v25,49152
T a[114:115],v25,51200
M v[80:83],a[92:95],a[156:159],v[80:83]
T a[116:117],v25,53248
T a[118:119],v25,55296
M v[84:87],a[92:95],a[188:191],0
buffer_load_dwordx4 v0, s[12:15], s85 offen offset:2048 lds
M v[84:87],a[88:91],a[184:187],v[84:87]
SA s85,s38,18432
T a[120:121],v25,57344
T a[122:123],v25,59392
M v[84:87],a[84:87],a[180:183],v[84:87]
T a[124:125],v25,61440
T a[126:127],v25,63488
M v[84:87],a[80:83],a[176:179],v[84:87]
buffer_load_dwordx4 v0, s[12:15], s85 offen offset:3072 lds
M v[84:87],a[76:79],a[172:175],v[84:87]
SA m0,s28,4096
v_mov_b32 v15, 1
v_cndmask_b32 v17, v16, v14, vcc
M v[84:87],a[72:75],a[168:171],v[84:87]
SA s85,s38,28672
buffer_load_dwordx4 v0, s[12:15], s85 offen offset:0 lds
M v[84:87],a[68:71],a[164:167],v[84:87]
s_waitcnt vmcnt(5) lgkmcnt(0)
v_min_u32 v10, 1, v7
v_lshlrev_b32 v10, 29, v10
M v[84:87],a[64:67],a[160:163],v[84:87]
s_barrier
M v[88:91],a[96:99],a[128:131],0
SA s85,s38,34816
T a[64:65],v22,0
T a[66:67],v22,2048
M v[88:91],a[100:103],a[132:135],v[88:91]
T a[68:69],v22,4096
T a[70:71],v22,6144
M v[88:91],a[104:107],a[136:139],v[88:91]
buffer_load_dwordx4 v0, s[12:15], s85 offen offset:1024 lds
M v[88:91],a[108:111],a[140:143],v[88:91]
SA s85,s38,40960
T a[72:73],v22,8192
T a[74:75],v22,10240
M v[88:91],a[112:115],a[144:147],v[88:91]
T a[76:77],v22,12288
T a[78:79],v22,14336
M v[88:91],a[116:119],a[148:151],v[88:91]
buffer_load_dwordx4 v0, s[12:15], s85 offen offset:2048 lds
M v[88:91],a[120:123],a[152:155],v[88:91]
SA s85,s38,47104
T a[80:81],v22,16384
T a[82:83],v22,18432
M v[88:91],a[124:127],a[156:159],v[88:91]
T a[84:85],v22,20480
T a[86:87],v22,22528
M v[92:95],a[124:127],a[188:191],0
buffer_store_dword v15, v10, s[8:11], s47 offen sc1
M v[92:95],a[120:123],a[184:187],v[92:95]
s_nop 0
T a[88:89],v22,24576
T a[90:91],v22,26624
M v[92:95],a[116:119],a[180:183],v[92:95]
T a[92:93],v22,28672
T a[94:95],v22,30720
M v[92:95],a[112:115],a[176:179],v[92:95]
buffer_load_dwordx4 v0, s[12:15], s85 offen offset:3072 lds
M v[92:95],a[108:111],a[172:175],v[92:95]
SA s38,s38,128
MF v72,v5,v72
MF v73,v5,v73
M v[92:95],a[104:107],a[168:171],v[92:95]
SA m0,s28,131072
MF v74,v5,v74
MF v75,v5,v75
M v[92:95],a[100:103],a[164:167],v[92:95]
s_waitcnt lgkmcnt(0)
C v64,v64,v65
C v65,v66,v67
M v[92:95],a[96:99],a[160:163],v[92:95]
SA s85,s38,0
C v66,v72,v73
C v67,v74,v75
buffer_store_dwordx4 v[64:67], v7, s[8:11], s29 offen offset:0 sc1
buffer_load_dwordx4 v0, s[12:15], s85 offen offset:0 lds
v_add_u32 v40, 0x20000, v18
v_add_u32 v41, 0x20000, v19
v_add_u32 v42, 0x20000, v20
v_add_u32 v43, 0x20000, v21
SA s85,s38,6144
MF v68,v6,v68
MF v69,v6,v69
MF v70,v6,v70
MF v71,v6,v71
MF v76,v6,v76
MF v77,v6,v77
MF v78,v6,v78
MF v79,v6,v79
C v68,v68,v69
C v69,v70,v71
C v70,v76,v77
C v71,v78,v79
buffer_store_dwordx4 v[68:71], v7, s[8:11], s30 offen offset:0 sc1
buffer_load_dwordx4 v0, s[12:15], s85 offen offset:1024 lds
SA s85,s38,12288
buffer_load_dwordx4 v0, s[12:15], s85 offen offset:2048 lds
SA s85,s38,18432
buffer_load_dwordx4 v0, s[12:15], s85 offen offset:3072 lds
M v[96:99],a[64:67],a[128:131],0
s_nop 0
T a[96:97],v23,0
T a[98:99],v23,2048
M v[96:99],a[68:71],a[132:135],v[96:99]
SA m0,s28,135168
T a[100:101],v23,4096
T a[102:103],v23,6144
M v[96:99],a[72:75],a[136:139],v[96:99]
SA s85,s38,28672
buffer_load_dwordx4 v0, s[12:15], s85 offen offset:0 lds
M v[96:99],a[76:79],a[140:143],v[96:99]
SA s85,s38,34816
T a[104:105],v23,8192
T a[106:107],v23,10240
M v[96:99],a[80:83],a[144:147],v[96:99]
T a[108:109],v23,12288
T a[110:111],v23,14336
M v[96:99],a[84:87],a[148:151],v[96:99]
buffer_load_dwordx4 v0, s[12:15], s85 offen offset:1024 lds
M v[96:99],a[88:91],a[152:155],v[96:99]
SA s85,s38,40960
T a[112:113],v23,16384
T a[114:115],v23,18432
M v[96:99],a[92:95],a[156:159],v[96:99]
T a[116:117],v23,20480
T a[118:119],v23,22528
M v[100:103],a[92:95],a[188:191],0
buffer_load_dwordx4 v0, s[12:15], s85 offen offset:2048 lds
M v[100:103],a[88:91],a[184:187],v[100:103]
SA s85,s38,47104
T a[120:121],v23,24576
T a[122:123],v23,26624
M v[100:103],a[84:87],a[180:183],v[100:103]
T a[124:125],v23,28672
T a[126:127],v23,30720
M v[100:103],a[80:83],a[176:179],v[100:103]
buffer_load_dwordx4 v0, s[12:15], s85 offen offset:3072 lds
M v[100:103],a[76:79],a[172:175],v[100:103]
SA s38,s38,128
MF v80,v5,v80
MF v81,v5,v81
M v[100:103],a[72:75],a[168:171],v[100:103]
SA m0,s28,32768
MF v82,v5,v82
MF v83,v5,v83
M v[100:103],a[68:71],a[164:167],v[100:103]
SA s85,s38,0
buffer_load_dwordx4 v0, s[12:15], s85 offen offset:0 lds
M v[100:103],a[64:67],a[160:163],v[100:103]
s_waitcnt lgkmcnt(0)
MF v88,v5,v88
MF v89,v5,v89
M v[104:107],a[96:99],a[128:131],0
SA s85,s38,6144
T a[64:65],v24,0
T a[66:67],v24,2048
M v[104:107],a[100:103],a[132:135],v[104:107]
T a[68:69],v24,4096
T a[70:71],v24,6144
M v[104:107],a[104:107],a[136:139],v[104:107]
buffer_load_dwordx4 v0, s[12:15], s85 offen offset:1024 lds
M v[104:107],a[108:111],a[140:143],v[104:107]
SA s85,s38,12288
T a[72:73],v24,8192
T a[74:75],v24,10240
M v[104:107],a[112:115],a[144:147],v[104:107]
T a[76:77],v24,12288
T a[78:79],v24,14336
M v[104:107],a[116:119],a[148:151],v[104:107]
buffer_load_dwordx4 v0, s[12:15], s85 offen offset:2048 lds
M v[104:107],a[120:123],a[152:155],v[104:107]
SA s85,s38,18432
T a[80:81],v24,16384
T a[82:83],v24,18432
M v[104:107],a[124:127],a[156:159],v[104:107]
T a[84:85],v24,20480
T a[86:87],v24,22528
M v[108:111],a[124:127],a[188:191],0
buffer_load_dwordx4 v0, s[12:15], s85 offen offset:3072 lds
M v[108:111],a[120:123],a[184:187],v[108:111]
SA m0,s28,36864
T a[88:89],v24,24576
T a[90:91],v24,26624
M v[108:111],a[116:119],a[180:183],v[108:111]
SA s85,s38,28672
T a[92:93],v24,28672
T a[94:95],v24,30720
M v[108:111],a[112:115],a[176:179],v[108:111]
buffer_load_dwordx4 v0, s[12:15], s85 offen offset:0 lds
M v[108:111],a[108:111],a[172:175],v[108:111]
SA s85,s38,34816
MF v90,v5,v90
MF v91,v5,v91
M v[108:111],a[104:107],a[168:171],v[108:111]
C v80,v80,v81
C v81,v82,v83
M v[108:111],a[100:103],a[164:167],v[108:111]
buffer_load_dwordx4 v0, s[12:15], s85 offen offset:1024 lds
M v[108:111],a[96:99],a[160:163],v[108:111]
s_waitcnt lgkmcnt(0)
C v82,v88,v89
C v83,v90,v91
M v[112:115],a[64:67],a[128:131],0
SA s85,s38,40960
T a[96:97],v25,0
T a[98:99],v25,2048
M v[112:115],a[68:71],a[132:135],v[112:115]
T a[100:101],v25,4096
T a[102:103],v25,6144
M v[112:115],a[72:75],a[136:139],v[112:115]
buffer_store_dwordx4 v[80:83], v7, s[8:11], s29 offen offset:1024 sc1
M v[112:115],a[76:79],a[140:143],v[112:115]
s_nop 0
T a[104:105],v25,8192
T a[106:107],v25,10240
M v[112:115],a[80:83],a[144:147],v[112:115]
T a[108:109],v25,12288
T a[110:111],v25,14336
M v[112:115],a[84:87],a[148:151],v[112:115]
buffer_load_dwordx4 v0, s[12:15], s85 offen offset:2048 lds
M v[112:115],a[88:91],a[152:155],v[112:115]
SA s85,s38,47104
T a[112:113],v25,16384
T a[114:115],v25,18432
M v[112:115],a[92:95],a[156:159],v[112:115]
T a[116:117],v25,20480
T a[118:119],v25,22528
M v[116:119],a[92:95],a[188:191],0
buffer_load_dwordx4 v0, s[12:15], s85 offen offset:3072 lds
M v[116:119],a[88:91],a[184:187],v[116:119]
SA s38,s38,128
T a[120:121],v25,24576
T a[122:123],v25,26624
M v[116:119],a[84:87],a[180:183],v[116:119]
SA m0,s28,98304
T a[124:125],v25,28672
T a[126:127],v25,30720
M v[116:119],a[80:83],a[176:179],v[116:119]
SA s85,s38,0
buffer_load_dwordx4 v0, s[12:15], s85 offen offset:0 lds
M v[116:119],a[76:79],a[172:175],v[116:119]
SA s85,s38,6144
MF v84,v6,v84
MF v85,v6,v85
M v[116:119],a[72:75],a[168:171],v[116:119]
buffer_load_dwordx4 v0, s[12:15], s85 offen offset:1024 lds
M v[116:119],a[68:71],a[164:167],v[116:119]
s_waitcnt vmcnt(21) lgkmcnt(0)
MF v86,v6,v86
MF v87,v6,v87
M v[116:119],a[64:67],a[160:163],v[116:119]
s_barrier
M v[120:123],a[96:99],a[128:131],0
SA s85,s38,12288
T a[64:65],v18,0
T a[66:67],v18,2048
M v[120:123],a[100:103],a[132:135],v[120:123]
T a[68:69],v18,4096
T a[70:71],v18,6144
M v[120:123],a[104:107],a[136:139],v[120:123]
buffer_load_dwordx4 v0, s[12:15], s85 offen offset:2048 lds
M v[120:123],a[108:111],a[140:143],v[120:123]
SA s85,s38,18432
T a[72:73],v18,8192
T a[74:75],v18,10240
M v[120:123],a[112:115],a[144:147],v[120:123]
T a[76:77],v18,12288
T a[78:79],v18,14336
M v[120:123],a[116:119],a[148:151],v[120:123]
buffer_load_dwordx4 v0, s[12:15], s85 offen offset:3072 lds
M v[120:123],a[120:123],a[152:155],v[120:123]
s_nop 0
T a[80:81],v18,16384
T a[82:83],v18,18432
M v[120:123],a[124:127],a[156:159],v[120:123]
T a[84:85],v18,20480
T a[86:87],v18,22528
M v[124:127],a[124:127],a[188:191],0
MF v92,v6,v92
MF v93,v6,v93
M v[124:127],a[120:123],a[184:187],v[124:127]
T a[88:89],v18,24576
T a[90:91],v18,26624
M v[124:127],a[116:119],a[180:183],v[124:127]
T a[92:93],v18,28672
T a[94:95],v18,30720
M v[124:127],a[112:115],a[176:179],v[124:127]
MF v94,v6,v94
MF v95,v6,v95
M v[124:127],a[108:111],a[172:175],v[124:127]
C v84,v84,v85
C v85,v86,v87
M v[124:127],a[104:107],a[168:171],v[124:127]
C v86,v92,v93
C v87,v94,v95
M v[124:127],a[100:103],a[164:167],v[124:127]
s_waitcnt lgkmcnt(0)
buffer_store_dwordx4 v[84:87], v7, s[8:11], s30 offen offset:1024 sc1
M v[124:127],a[96:99],a[160:163],v[124:127]
SA s29,s33,2048
SA s30,s33,16384
MF v96,v5,v96
MF v97,v5,v97
MF v98,v5,v98
MF v99,v5,v99
MF v104,v5,v104
MF v105,v5,v105
MF v106,v5,v106
MF v107,v5,v107
C v96,v96,v97
C v97,v98,v99
C v98,v104,v105
C v99,v106,v107
buffer_store_dwordx4 v[96:99], v7, s[8:11], s29 offen offset:0 sc1
MF v100,v6,v100
MF v101,v6,v101
MF v102,v6,v102
MF v103,v6,v103
MF v108,v6,v108
MF v109,v6,v109
MF v110,v6,v110
MF v111,v6,v111
C v100,v100,v101
C v101,v102,v103
C v102,v108,v109
C v103,v110,v111
buffer_store_dwordx4 v[100:103], v7, s[8:11], s30 offen offset:0 sc1
M v[64:67],a[64:67],a[128:131],0
s_nop 0
T a[96:97],v19,0
T a[98:99],v19,2048
M v[64:67],a[68:71],a[132:135],v[64:67]
SA m0,s28,102400
T a[100:101],v19,4096
T a[102:103],v19,6144
M v[64:67],a[72:75],a[136:139],v[64:67]
SA s85,s38,28672
buffer_load_dwordx4 v0, s[12:15], s85 offen offset:0 lds
M v[64:67],a[76:79],a[140:143],v[64:67]
SA s85,s38,34816
T a[104:105],v19,8192
T a[106:107],v19,10240
M v[64:67],a[80:83],a[144:147],v[64:67]
T a[108:109],v19,12288
T a[110:111],v19,14336
M v[64:67],a[84:87],a[148:151],v[64:67]
buffer_load_dwordx4 v0, s[12:15], s85 offen offset:1024 lds
M v[64:67],a[88:91],a[152:155],v[64:67]
s_nop 0
T a[112:113],v19,16384
T a[114:115],v19,18432
M v[64:67],a[92:95],a[156:159],v[64:67]
SA s85,s38,40960
T a[116:117],v19,20480
T a[118:119],v19,22528
M v[68:71],a[92:95],a[188:191],0
buffer_load_dwordx4 v0, s[12:15], s85 offen offset:2048 lds
M v[68:71],a[88:91],a[184:187],v[68:71]
s_nop 0
T a[120:121],v19,24576
T a[122:123],v19,26624
M v[68:71],a[84:87],a[180:183],v[68:71]
T a[124:125],v19,28672
T a[126:127],v19,30720
M v[68:71],a[80:83],a[176:179],v[68:71]
SA s85,s38,47104
MF v112,v5,v112
MF v113,v5,v113
M v[68:71],a[76:79],a[172:175],v[68:71]
buffer_load_dwordx4 v0, s[12:15], s85 offen offset:3072 lds
M v[68:71],a[72:75],a[168:171],v[68:71]
SA s38,s38,128
MF v114,v5,v114
MF v115,v5,v115
M v[68:71],a[68:71],a[164:167],v[68:71]
SA m0,s28,65536
MF v120,v5,v120
MF v121,v5,v121
M v[68:71],a[64:67],a[160:163],v[68:71]
s_waitcnt lgkmcnt(0)
MF v122,v5,v122
MF v123,v5,v123
M v[72:75],a[96:99],a[128:131],0
SA s85,s38,0
T a[64:65],v20,0
T a[66:67],v20,2048
M v[72:75],a[100:103],a[132:135],v[72:75]
T a[68:69],v20,4096
T a[70:71],v20,6144
M v[72:75],a[104:107],a[136:139],v[72:75]
buffer_load_dwordx4 v0, s[12:15], s85 offen offset:0 lds
M v[72:75],a[108:111],a[140:143],v[72:75]
SA s85,s38,6144
T a[72:73],v20,8192
T a[74:75],v20,10240
M v[72:75],a[112:115],a[144:147],v[72:75]
T a[76:77],v20,12288
T a[78:79],v20,14336
M v[72:75],a[116:119],a[148:151],v[72:75]
buffer_load_dwordx4 v0, s[12:15], s85 offen offset:1024 lds
M v[72:75],a[120:123],a[152:155],v[72:75]
SA s85,s38,12288
T a[80:81],v20,16384
T a[82:83],v20,18432
M v[72:75],a[124:127],a[156:159],v[72:75]
T a[84:85],v20,20480
T a[86:87],v20,22528
M v[76:79],a[124:127],a[188:191],0
buffer_load_dwordx4 v0, s[12:15], s85 offen offset:2048 lds
M v[76:79],a[120:123],a[184:187],v[76:79]
SA s85,s38,18432
T a[88:89],v20,24576
T a[90:91],v20,26624
M v[76:79],a[116:119],a[180:183],v[76:79]
T a[92:93],v20,28672
T a[94:95],v20,30720
M v[76:79],a[112:115],a[176:179],v[76:79]
buffer_load_dwordx4 v0, s[12:15], s85 offen offset:3072 lds
M v[76:79],a[108:111],a[172:175],v[76:79]
SA m0,s28,69632
C v112,v112,v113
C v113,v114,v115
M v[76:79],a[104:107],a[168:171],v[76:79]
SA s85,s38,28672
C v114,v120,v121
C v115,v122,v123
M v[76:79],a[100:103],a[164:167],v[76:79]
buffer_store_dwordx4 v[112:115], v7, s[8:11], s29 offen offset:1024 sc1
M v[76:79],a[96:99],a[160:163],v[76:79]
s_waitcnt lgkmcnt(0)
MF v116,v6,v116
MF v117,v6,v117
M v[80:83],a[64:67],a[128:131],0
T a[96:97],v21,0
T a[98:99],v21,2048
M v[80:83],a[68:71],a[132:135],v[80:83]
T a[100:101],v21,4096
T a[102:103],v21,6144
M v[80:83],a[72:75],a[136:139],v[80:83]
buffer_load_dwordx4 v0, s[12:15], s85 offen offset:0 lds
M v[80:83],a[76:79],a[140:143],v[80:83]
SA s85,s38,34816
T a[104:105],v21,8192
T a[106:107],v21,10240
M v[80:83],a[80:83],a[144:147],v[80:83]
T a[108:109],v21,12288
T a[110:111],v21,14336
M v[80:83],a[84:87],a[148:151],v[80:83]
buffer_load_dwordx4 v0, s[12:15], s85 offen offset:1024 lds
M v[80:83],a[88:91],a[152:155],v[80:83]
SA s85,s38,40960
T a[112:113],v21,16384
T a[114:115],v21,18432
M v[80:83],a[92:95],a[156:159],v[80:83]
T a[116:117],v21,20480
T a[118:119],v21,22528
M v[84:87],a[92:95],a[188:191],0
buffer_load_dwordx4 v0, s[12:15], s85 offen offset:2048 lds
M v[84:87],a[88:91],a[184:187],v[84:87]
SA s85,s38,47104
T a[120:121],v21,24576
T a[122:123],v21,26624
M v[84:87],a[84:87],a[180:183],v[84:87]
T a[124:125],v21,28672
T a[126:127],v21,30720
M v[84:87],a[80:83],a[176:179],v[84:87]
buffer_load_dwordx4 v0, s[12:15], s85 offen offset:3072 lds
M v[84:87],a[76:79],a[172:175],v[84:87]
MF v118,v6,v118
MF v119,v6,v119
M v[84:87],a[72:75],a[168:171],v[84:87]
SA s38,s38,128
MF v124,v6,v124
MF v125,v6,v125
M v[84:87],a[68:71],a[164:167],v[84:87]
s_waitcnt vmcnt(29) lgkmcnt(0)
MF v126,v6,v126
MF v127,v6,v127
M v[84:87],a[64:67],a[160:163],v[84:87]
s_barrier
M v[88:91],a[96:99],a[128:131],0
s_nop 0
T a[64:65],v40,0
T a[66:67],v40,2048
M v[88:91],a[100:103],a[132:135],v[88:91]
T a[68:69],v40,4096
T a[70:71],v40,6144
M v[88:91],a[104:107],a[136:139],v[88:91]
C v116,v116,v117
C v117,v118,v119
M v[88:91],a[108:111],a[140:143],v[88:91]
T a[72:73],v40,8192
T a[74:75],v40,10240
M v[88:91],a[112:115],a[144:147],v[88:91]
T a[76:77],v40,12288
T a[78:79],v40,14336
M v[88:91],a[116:119],a[148:151],v[88:91]
C v118,v124,v125
C v119,v126,v127
M v[88:91],a[120:123],a[152:155],v[88:91]
T a[80:81],v40,16384
T a[82:83],v40,18432
M v[88:91],a[124:127],a[156:159],v[88:91]
T a[84:85],v40,20480
T a[86:87],v40,22528
M v[92:95],a[124:127],a[188:191],0
buffer_store_dwordx4 v[116:119], v7, s[8:11], s30 offen offset:1024 sc1
M v[92:95],a[120:123],a[184:187],v[92:95]
SA s29,s33,4096
T a[88:89],v40,24576
T a[90:91],v40,26624
M v[92:95],a[116:119],a[180:183],v[92:95]
SA s30,s33,18432
T a[92:93],v40,28672
T a[94:95],v40,30720
M v[92:95],a[112:115],a[176:179],v[92:95]
MF v64,v5,v64
MF v65,v5,v65
M v[92:95],a[108:111],a[172:175],v[92:95]
MF v66,v5,v66
MF v67,v5,v67
M v[92:95],a[104:107],a[168:171],v[92:95]
MF v72,v5,v72
MF v73,v5,v73
M v[92:95],a[100:103],a[164:167],v[92:95]
s_waitcnt lgkmcnt(0)
MF v74,v5,v74
MF v75,v5,v75
M v[92:95],a[96:99],a[160:163],v[92:95]
C v64,v64,v65
C v65,v66,v67
C v66,v72,v73
C v67,v74,v75
buffer_store_dwordx4 v[64:67], v7, s[8:11], s29 offen offset:0 sc1
MF v68,v6,v68
MF v69,v6,v69
MF v70,v6,v70
MF v71,v6,v71
MF v76,v6,v76
MF v77,v6,v77
MF v78,v6,v78
MF v79,v6,v79
C v68,v68,v69
C v69,v70,v71
C v70,v76,v77
C v71,v78,v79
buffer_store_dwordx4 v[68:71], v7, s[8:11], s30 offen offset:0 sc1
M v[96:99],a[64:67],a[128:131],0
s_nop 0
T a[96:97],v41,0
T a[98:99],v41,2048
M v[96:99],a[68:71],a[132:135],v[96:99]
T a[100:101],v41,4096
T a[102:103],v41,6144
M v[96:99],a[72:75],a[136:139],v[96:99]
MF v80,v5,v80
MF v81,v5,v81
M v[96:99],a[76:79],a[140:143],v[96:99]
T a[104:105],v41,8192
T a[106:107],v41,10240
M v[96:99],a[80:83],a[144:147],v[96:99]
T a[108:109],v41,12288
T a[110:111],v41,14336
M v[96:99],a[84:87],a[148:151],v[96:99]
MF v82,v5,v82
MF v83,v5,v83
M v[96:99],a[88:91],a[152:155],v[96:99]
T a[112:113],v41,16384
T a[114:115],v41,18432
M v[96:99],a[92:95],a[156:159],v[96:99]
T a[116:117],v41,20480
T a[118:119],v41,22528
M v[100:103],a[92:95],a[188:191],0
MF v88,v5,v88
MF v89,v5,v89
M v[100:103],a[88:91],a[184:187],v[100:103]
T a[120:121],v41,24576
T a[122:123],v41,26624
M v[100:103],a[84:87],a[180:183],v[100:103]
T a[124:125],v41,28672
T a[126:127],v41,30720
M v[100:103],a[80:83],a[176:179],v[100:103]
MF v90,v5,v90
MF v91,v5,v91
M v[100:103],a[76:79],a[172:175],v[100:103]
C v80,v80,v81
C v81,v82,v83
M v[100:103],a[72:75],a[168:171],v[100:103]
C v82,v88,v89
C v83,v90,v91
M v[100:103],a[68:71],a[164:167],v[100:103]
buffer_store_dwordx4 v[80:83], v7, s[8:11], s29 offen offset:1024 sc1
M v[100:103],a[64:67],a[160:163],v[100:103]
s_waitcnt lgkmcnt(0)
MF v84,v6,v84
MF v85,v6,v85
M v[104:107],a[96:99],a[128:131],0
T a[64:65],v42,0
T a[66:67],v42,2048
M v[104:107],a[100:103],a[132:135],v[104:107]
T a[68:69],v42,4096
T a[70:71],v42,6144
M v[104:107],a[104:107],a[136:139],v[104:107]
MF v86,v6,v86
MF v87,v6,v87
M v[104:107],a[108:111],a[140:143],v[104:107]
T a[72:73],v42,8192
T a[74:75],v42,10240
M v[104:107],a[112:115],a[144:147],v[104:107]
T a[76:77],v42,12288
T a[78:79],v42,14336
M v[104:107],a[116:119],a[148:151],v[104:107]
MF v92,v6,v92
MF v93,v6,v93
M v[104:107],a[120:123],a[152:155],v[104:107]
T a[80:81],v42,16384
T a[82:83],v42,18432
M v[104:107],a[124:127],a[156:159],v[104:107]
T a[84:85],v42,20480
T a[86:87],v42,22528
M v[108:111],a[124:127],a[188:191],0
MF v94,v6,v94
MF v95,v6,v95
M v[108:111],a[120:123],a[184:187],v[108:111]
T a[88:89],v42,24576
T a[90:91],v42,26624
M v[108:111],a[116:119],a[180:183],v[108:111]
T a[92:93],v42,28672
T a[94:95],v42,30720
M v[108:111],a[112:115],a[176:179],v[108:111]
C v84,v84,v85
C v85,v86,v87
M v[108:111],a[108:111],a[172:175],v[108:111]
C v86,v92,v93
C v87,v94,v95
M v[108:111],a[104:107],a[168:171],v[108:111]
buffer_store_dwordx4 v[84:87], v7, s[8:11], s30 offen offset:1024 sc1
M v[108:111],a[100:103],a[164:167],v[108:111]
SA s29,s33,6144
M v[108:111],a[96:99],a[160:163],v[108:111]
s_waitcnt lgkmcnt(0)
M v[112:115],a[64:67],a[128:131],0
SA s30,s33,20480
T a[96:97],v43,0
T a[98:99],v43,2048
M v[112:115],a[68:71],a[132:135],v[112:115]
T a[100:101],v43,4096
T a[102:103],v43,6144
M v[112:115],a[72:75],a[136:139],v[112:115]
MF v96,v5,v96
MF v97,v5,v97
M v[112:115],a[76:79],a[140:143],v[112:115]
T a[104:105],v43,8192
T a[106:107],v43,10240
M v[112:115],a[80:83],a[144:147],v[112:115]
T a[108:109],v43,12288
T a[110:111],v43,14336
M v[112:115],a[84:87],a[148:151],v[112:115]
MF v98,v5,v98
MF v99,v5,v99
M v[112:115],a[88:91],a[152:155],v[112:115]
T a[112:113],v43,16384
T a[114:115],v43,18432
M v[112:115],a[92:95],a[156:159],v[112:115]
T a[116:117],v43,20480
T a[118:119],v43,22528
M v[116:119],a[92:95],a[188:191],0
MF v104,v5,v104
MF v105,v5,v105
M v[116:119],a[88:91],a[184:187],v[116:119]
T a[120:121],v43,24576
T a[122:123],v43,26624
M v[116:119],a[84:87],a[180:183],v[116:119]
T a[124:125],v43,28672
T a[126:127],v43,30720
M v[116:119],a[80:83],a[176:179],v[116:119]
MF v106,v5,v106
MF v107,v5,v107
M v[116:119],a[76:79],a[172:175],v[116:119]
C v96,v96,v97
C v97,v98,v99
M v[116:119],a[72:75],a[168:171],v[116:119]
C v98,v104,v105
C v99,v106,v107
M v[116:119],a[68:71],a[164:167],v[116:119]
s_waitcnt vmcnt(25) lgkmcnt(0)
buffer_store_dwordx4 v[96:99], v7, s[8:11], s29 offen offset:0 sc1
M v[116:119],a[64:67],a[160:163],v[116:119]
s_barrier
M v[120:123],a[96:99],a[128:131],0
s_nop 0
T a[64:65],v18,32768
T a[66:67],v18,34816
M v[120:123],a[100:103],a[132:135],v[120:123]
T a[68:69],v18,36864
T a[70:71],v18,38912
M v[120:123],a[104:107],a[136:139],v[120:123]
MF v100,v6,v100
MF v101,v6,v101
M v[120:123],a[108:111],a[140:143],v[120:123]
T a[72:73],v18,40960
T a[74:75],v18,43008
M v[120:123],a[112:115],a[144:147],v[120:123]
T a[76:77],v18,45056
T a[78:79],v18,47104
M v[120:123],a[116:119],a[148:151],v[120:123]
MF v102,v6,v102
MF v103,v6,v103
M v[120:123],a[120:123],a[152:155],v[120:123]
T a[80:81],v18,49152
T a[82:83],v18,51200
M v[120:123],a[124:127],a[156:159],v[120:123]
T a[84:85],v18,53248
T a[86:87],v18,55296
M v[124:127],a[124:127],a[188:191],0
MF v108,v6,v108
MF v109,v6,v109
M v[124:127],a[120:123],a[184:187],v[124:127]
T a[88:89],v18,57344
T a[90:91],v18,59392
M v[124:127],a[116:119],a[180:183],v[124:127]
T a[92:93],v18,61440
T a[94:95],v18,63488
M v[124:127],a[112:115],a[176:179],v[124:127]
MF v110,v6,v110
MF v111,v6,v111
M v[124:127],a[108:111],a[172:175],v[124:127]
C v100,v100,v101
C v101,v102,v103
M v[124:127],a[104:107],a[168:171],v[124:127]
C v102,v108,v109
C v103,v110,v111
M v[124:127],a[100:103],a[164:167],v[124:127]
s_waitcnt lgkmcnt(0)
buffer_store_dwordx4 v[100:103], v7, s[8:11], s30 offen offset:0 sc1
M v[124:127],a[96:99],a[160:163],v[124:127]
M v[64:67],a[64:67],a[128:131],0
s_nop 0
T a[96:97],v19,32768
T a[98:99],v19,34816
M v[64:67],a[68:71],a[132:135],v[64:67]
T a[100:101],v19,36864
T a[102:103],v19,38912
M v[64:67],a[72:75],a[136:139],v[64:67]
v_lshrrev_b32 v32, 4, v7
MF v112,v5,v112
M v[64:67],a[76:79],a[140:143],v[64:67]
s_lshr_b32 s74, s41, 3
T a[104:105],v19,40960
T a[106:107],v19,43008
M v[64:67],a[80:83],a[144:147],v[64:67]
s_lshl_b32 s64, s42, 1
T a[108:109],v19,45056
T a[110:111],v19,47104
M v[64:67],a[84:87],a[148:151],v[64:67]
SA s46,s64,s74
MF v113,v5,v113
MF v114,v5,v114
M v[64:67],a[88:91],a[152:155],v[64:67]
s_mul_i32 s46, s46, 4352
T a[112:113],v19,49152
T a[114:115],v19,51200
M v[64:67],a[92:95],a[156:159],v[64:67]
s_and_b32 s72, s41, 7
T a[116:117],v19,53248
T a[118:119],v19,55296
M v[68:71],a[92:95],a[188:191],0
s_lshl_b32 s65, s72, 7
MF v115,v5,v115
MF v120,v5,v120
M v[68:71],a[88:91],a[184:187],v[68:71]
SA s46,s46,s65
T a[120:121],v19,57344
T a[122:123],v19,59392
M v[68:71],a[84:87],a[180:183],v[68:71]
SA s46,s46,104992768
T a[124:125],v19,61440
T a[126:127],v19,63488
M v[68:71],a[80:83],a[176:179],v[68:71]
v_and_b32 v33, 31, v32
MF v121,v5,v121
M v[68:71],a[76:79],a[172:175],v[68:71]
MF v122,v5,v122
MF v123,v5,v123
M v[68:71],a[72:75],a[168:171],v[68:71]
C v112,v112,v113
C v113,v114,v115
M v[68:71],a[68:71],a[164:167],v[68:71]
C v114,v120,v121
C v115,v122,v123
M v[68:71],a[64:67],a[160:163],v[68:71]
s_waitcnt lgkmcnt(0)
buffer_store_dwordx4 v[112:115], v7, s[8:11], s29 offen offset:1024 sc1
M v[72:75],a[96:99],a[128:131],0
s_nop 0
T a[64:65],v20,32768
T a[66:67],v20,34816
M v[72:75],a[100:103],a[132:135],v[72:75]
T a[68:69],v20,36864
T a[70:71],v20,38912
M v[72:75],a[104:107],a[136:139],v[72:75]
MF v116,v6,v116
MF v117,v6,v117
M v[72:75],a[108:111],a[140:143],v[72:75]
T a[72:73],v20,40960
T a[74:75],v20,43008
M v[72:75],a[112:115],a[144:147],v[72:75]
T a[76:77],v20,45056
T a[78:79],v20,47104
M v[72:75],a[116:119],a[148:151],v[72:75]
MF v118,v6,v118
MF v119,v6,v119
M v[72:75],a[120:123],a[152:155],v[72:75]
T a[80:81],v20,49152
T a[82:83],v20,51200
M v[72:75],a[124:127],a[156:159],v[72:75]
T a[84:85],v20,53248
T a[86:87],v20,55296
M v[76:79],a[124:127],a[188:191],0
MF v124,v6,v124
MF v125,v6,v125
M v[76:79],a[120:123],a[184:187],v[76:79]
T a[88:89],v20,57344
T a[90:91],v20,59392
M v[76:79],a[116:119],a[180:183],v[76:79]
T a[92:93],v20,61440
T a[94:95],v20,63488
M v[76:79],a[112:115],a[176:179],v[76:79]
MF v126,v6,v126
MF v127,v6,v127
M v[76:79],a[108:111],a[172:175],v[76:79]
C v116,v116,v117
C v117,v118,v119
M v[76:79],a[104:107],a[168:171],v[76:79]
C v118,v124,v125
C v119,v126,v127
M v[76:79],a[100:103],a[164:167],v[76:79]
buffer_store_dwordx4 v[116:119], v7, s[8:11], s30 offen offset:1024 sc1
M v[76:79],a[96:99],a[160:163],v[76:79]
s_waitcnt lgkmcnt(0)
v_lshlrev_b32 v33, 2, v33
M v[80:83],a[64:67],a[128:131],0
SA s29,s33,8192
T a[96:97],v21,32768
T a[98:99],v21,34816
M v[80:83],a[68:71],a[132:135],v[80:83]
SA s30,s33,22528
T a[100:101],v21,36864
T a[102:103],v21,38912
M v[80:83],a[72:75],a[136:139],v[80:83]
s_lshl_b32 s65, s41, 7
MF v64,v5,v64
MF v65,v5,v65
M v[80:83],a[76:79],a[140:143],v[80:83]
SA s65,s65,104890368
T a[104:105],v21,40960
T a[106:107],v21,43008
M v[80:83],a[80:83],a[144:147],v[80:83]
T a[108:109],v21,45056
T a[110:111],v21,47104
M v[80:83],a[84:87],a[148:151],v[80:83]
buffer_load_dword v31, v33, s[8:11], s65 offen sc1
M v[80:83],a[88:91],a[152:155],v[80:83]
s_nop 0
T a[112:113],v21,49152
T a[114:115],v21,51200
M v[80:83],a[92:95],a[156:159],v[80:83]
T a[116:117],v21,53248
T a[118:119],v21,55296
M v[84:87],a[92:95],a[188:191],0
v_bfe_u32 v34, v32, 4, 1
v_lshlrev_b32 v34, 1, v34
M v[84:87],a[88:91],a[184:187],v[84:87]
T a[120:121],v21,57344
T a[122:123],v21,59392
M v[84:87],a[84:87],a[180:183],v[84:87]
T a[124:125],v21,61440
T a[126:127],v21,63488
M v[84:87],a[80:83],a[176:179],v[84:87]
v_lshrrev_b32 v35, 5, v32
v_add_u32 v34, v34, v35
M v[84:87],a[76:79],a[172:175],v[84:87]
s_mov_b32 s52, s96
MF v66,v5,v66
MF v67,v5,v67
M v[84:87],a[72:75],a[168:171],v[84:87]
s_and_b32 s53, s97, 0xffff
MF v72,v5,v72
MF v73,v5,v73
M v[84:87],a[68:71],a[164:167],v[84:87]
s_waitcnt vmcnt(19) lgkmcnt(0)
MF v74,v5,v74
MF v75,v5,v75
M v[84:87],a[64:67],a[160:163],v[84:87]
s_barrier
M v[88:91],a[96:99],a[128:131],0
s_mov_b32 s54, 1835008
T a[64:65],v22,32768
T a[66:67],v22,34816
M v[88:91],a[100:103],a[132:135],v[88:91]
s_mov_b32 s55, 0x20000
T a[68:69],v22,36864
T a[70:71],v22,38912
M v[88:91],a[104:107],a[136:139],v[88:91]
s_mul_i32 s77, s42, 1835008
C v64,v64,v65
C v65,v66,v67
M v[88:91],a[108:111],a[140:143],v[88:91]
s_mul_i32 s78, s72, 14336
T a[72:73],v22,40960
T a[74:75],v22,43008
M v[88:91],a[112:115],a[144:147],v[88:91]
SA s77,s77,s78
T a[76:77],v22,45056
T a[78:79],v22,47104
M v[88:91],a[116:119],a[148:151],v[88:91]
SA s77,s77,67108864
C v66,v72,v73
C v67,v74,v75
M v[88:91],a[120:123],a[152:155],v[88:91]
s_lshl_b32 s79, s74, 1
T a[80:81],v22,49152
T a[82:83],v22,51200
M v[88:91],a[124:127],a[156:159],v[88:91]
SA s79,s79,s20
T a[84:85],v22,53248
T a[86:87],v22,55296
M v[92:95],a[124:127],a[188:191],0
s_lshl_b32 s71, s74, 1
buffer_store_dwordx4 v[64:67], v7, s[8:11], s29 offen offset:0 sc1
M v[92:95],a[120:123],a[184:187],v[92:95]
SA s71,s71,1
T a[88:89],v22,57344
T a[90:91],v22,59392
M v[92:95],a[116:119],a[180:183],v[92:95]
s_sub_u32 s71, s71, s20
T a[92:93],v22,61440
T a[94:95],v22,63488
M v[92:95],a[112:115],a[176:179],v[92:95]
s_and_b32 s71, s71, 536870912
MF v68,v6,v68
MF v69,v6,v69
M v[92:95],a[108:111],a[172:175],v[92:95]
s_sub_u32 s64, 15, s64
MF v70,v6,v70
MF v71,v6,v71
M v[92:95],a[104:107],a[168:171],v[92:95]
s_sub_u32 s78, s64, 1
MF v76,v6,v76
MF v77,v6,v77
M v[92:95],a[100:103],a[164:167],v[92:95]
s_waitcnt lgkmcnt(0)
MF v78,v6,v78
MF v79,v6,v79
M v[92:95],a[96:99],a[160:163],v[92:95]
s_mul_i32 s78, s78, 1835008
SA s78,s78,s77
s_lshl_b32 s65, s79, 10
SA s78,s78,s65
SA s78,s78,s71
s_lshl_b32 s79, s79, 6
s_or_b32 s79, s79, s71
s_mul_i32 s67, s74, -2
s_lshl_b32 s74, s74, 3
SA s74,s74,s20
s_lshl_b32 s75, s74, 6
SA s76,s75,256
SA s67,s67,3
s_sub_u32 s67, s67, s20
s_and_b32 s67, s67, 536870912
s_or_b32 s76, s76, s67
v_or_b32 v27, s67, v7
v_add_u32 v27, 4096, v27
s_lshl_b32 s65, s74, 10
SA s77,s77,s65
s_lshl_b32 s64, s64, 7
s_lshr_b32 s73, s72, 1
s_sub_u32 s65, 7, s73
s_bitcmp1_b32 s72, 0
s_cselect_b32 s73, s65, s73
s_lshl_b32 s73, s73, 4
s_lshl_b32 s65, s42, 7
SA s73,s73,s65
v_and_b32 v37, 15, v32
v_add_u32 v37, s73, v37
v_add_u32 v29, s64, v37
s_mov_b32 s64, 104857664
v_mul_u32_u24 v38, 896, v37
v_lshl_add_u32 v38, v34, 4, v38
v_lshrrev_b32 v35, 4, v37
v_lshlrev_b32 v35, 5, v35
v_and_b32 v36, 15, v37
v_add_lshl_u32 v35, v35, v36, 2
buffer_load_dword v39, v35, s[8:11], s64 offen sc1
C v68,v68,v69
C v69,v70,v71
C v70,v76,v77
C v71,v78,v79
buffer_store_dwordx4 v[68:71], v7, s[8:11], s30 offen offset:0 sc1
buffer_load_dwordx4 v[48:51], v38, s[56:59], s75 offen
buffer_load_dwordx4 v[52:55], v38, s[56:59], s76 offen
v_mul_u32_u24 v28, 896, v29
v_lshl_add_u32 v28, v34, 4, v28
v_lshrrev_b32 v35, 4, v29
v_lshlrev_b32 v35, 5, v35
v_and_b32 v36, 15, v29
v_add_lshl_u32 v35, v35, v36, 2
buffer_load_dword v26, v35, s[8:11], s64 offen sc1
buffer_load_dwordx4 v[44:47], v28, s[56:59], s79 offen
M v[96:99],a[64:67],a[128:131],0
s_nop 0
T a[96:97],v23,32768
T a[98:99],v23,34816
M v[96:99],a[68:71],a[132:135],v[96:99]
T a[100:101],v23,36864
T a[102:103],v23,38912
M v[96:99],a[72:75],a[136:139],v[96:99]
MF v80,v5,v80
MF v81,v5,v81
M v[96:99],a[76:79],a[140:143],v[96:99]
T a[104:105],v23,40960
T a[106:107],v23,43008
M v[96:99],a[80:83],a[144:147],v[96:99]
T a[108:109],v23,45056
T a[110:111],v23,47104
M v[96:99],a[84:87],a[148:151],v[96:99]
MF v82,v5,v82
MF v83,v5,v83
M v[96:99],a[88:91],a[152:155],v[96:99]
T a[112:113],v23,49152
T a[114:115],v23,51200
M v[96:99],a[92:95],a[156:159],v[96:99]
T a[116:117],v23,53248
T a[118:119],v23,55296
M v[100:103],a[92:95],a[188:191],0
MF v88,v5,v88
MF v89,v5,v89
M v[100:103],a[88:91],a[184:187],v[100:103]
T a[120:121],v23,57344
T a[122:123],v23,59392
M v[100:103],a[84:87],a[180:183],v[100:103]
T a[124:125],v23,61440
T a[126:127],v23,63488
M v[100:103],a[80:83],a[176:179],v[100:103]
MF v90,v5,v90
MF v91,v5,v91
M v[100:103],a[76:79],a[172:175],v[100:103]
C v80,v80,v81
C v81,v82,v83
M v[100:103],a[72:75],a[168:171],v[100:103]
C v82,v88,v89
C v83,v90,v91
M v[100:103],a[68:71],a[164:167],v[100:103]
buffer_store_dwordx4 v[80:83], v7, s[8:11], s29 offen offset:1024 sc1
M v[100:103],a[64:67],a[160:163],v[100:103]
s_waitcnt lgkmcnt(0)
MF v84,v6,v84
MF v85,v6,v85
M v[104:107],a[96:99],a[128:131],0
T a[64:65],v24,32768
T a[66:67],v24,34816
M v[104:107],a[100:103],a[132:135],v[104:107]
T a[68:69],v24,36864
T a[70:71],v24,38912
M v[104:107],a[104:107],a[136:139],v[104:107]
MF v86,v6,v86
MF v87,v6,v87
M v[104:107],a[108:111],a[140:143],v[104:107]
T a[72:73],v24,40960
T a[74:75],v24,43008
M v[104:107],a[112:115],a[144:147],v[104:107]
T a[76:77],v24,45056
T a[78:79],v24,47104
M v[104:107],a[116:119],a[148:151],v[104:107]
MF v92,v6,v92
MF v93,v6,v93
M v[104:107],a[120:123],a[152:155],v[104:107]
T a[80:81],v24,49152
T a[82:83],v24,51200
M v[104:107],a[124:127],a[156:159],v[104:107]
T a[84:85],v24,53248
T a[86:87],v24,55296
M v[108:111],a[124:127],a[188:191],0
MF v94,v6,v94
MF v95,v6,v95
M v[108:111],a[120:123],a[184:187],v[108:111]
T a[88:89],v24,57344
T a[90:91],v24,59392
M v[108:111],a[116:119],a[180:183],v[108:111]
T a[92:93],v24,61440
T a[94:95],v24,63488
M v[108:111],a[112:115],a[176:179],v[108:111]
C v84,v84,v85
C v85,v86,v87
M v[108:111],a[108:111],a[172:175],v[108:111]
C v86,v92,v93
C v87,v94,v95
M v[108:111],a[104:107],a[168:171],v[108:111]
buffer_store_dwordx4 v[84:87], v7, s[8:11], s30 offen offset:1024 sc1
M v[108:111],a[100:103],a[164:167],v[108:111]
SA s29,s33,10240
M v[108:111],a[96:99],a[160:163],v[108:111]
s_waitcnt lgkmcnt(0)
M v[112:115],a[64:67],a[128:131],0
SA s30,s33,24576
T a[96:97],v25,32768
T a[98:99],v25,34816
M v[112:115],a[68:71],a[132:135],v[112:115]
T a[100:101],v25,36864
T a[102:103],v25,38912
M v[112:115],a[72:75],a[136:139],v[112:115]
MF v96,v5,v96
MF v97,v5,v97
M v[112:115],a[76:79],a[140:143],v[112:115]
T a[104:105],v25,40960
T a[106:107],v25,43008
M v[112:115],a[80:83],a[144:147],v[112:115]
T a[108:109],v25,45056
T a[110:111],v25,47104
M v[112:115],a[84:87],a[148:151],v[112:115]
MF v98,v5,v98
MF v99,v5,v99
M v[112:115],a[88:91],a[152:155],v[112:115]
T a[112:113],v25,49152
T a[114:115],v25,51200
M v[112:115],a[92:95],a[156:159],v[112:115]
T a[116:117],v25,53248
T a[118:119],v25,55296
M v[116:119],a[92:95],a[188:191],0
s_mov_b32 s84, s45
MF v104,v5,v104
MF v105,v5,v105
M v[116:119],a[88:91],a[184:187],v[116:119]
T a[120:121],v25,57344
T a[122:123],v25,59392
M v[116:119],a[84:87],a[180:183],v[116:119]
T a[124:125],v25,61440
T a[126:127],v25,63488
M v[116:119],a[80:83],a[176:179],v[116:119]
MF v106,v5,v106
MF v107,v5,v107
M v[116:119],a[76:79],a[172:175],v[116:119]
C v96,v96,v97
C v97,v98,v99
M v[116:119],a[72:75],a[168:171],v[116:119]
C v98,v104,v105
C v99,v106,v107
M v[116:119],a[68:71],a[164:167],v[116:119]
s_waitcnt vmcnt(19) lgkmcnt(0)
buffer_store_dwordx4 v[96:99], v7, s[8:11], s29 offen offset:0 sc1
M v[116:119],a[64:67],a[160:163],v[116:119]
s_barrier
M v[120:123],a[96:99],a[128:131],0
s_nop 0
T a[64:65],v22,0
T a[66:67],v22,2048
M v[120:123],a[100:103],a[132:135],v[120:123]
T a[68:69],v22,4096
T a[70:71],v22,6144
M v[120:123],a[104:107],a[136:139],v[120:123]
MF v100,v6,v100
MF v101,v6,v101
M v[120:123],a[108:111],a[140:143],v[120:123]
T a[72:73],v22,8192
T a[74:75],v22,10240
M v[120:123],a[112:115],a[144:147],v[120:123]
s_waitcnt vmcnt(11)
T a[76:77],v22,12288
T a[78:79],v22,14336
M v[120:123],a[116:119],a[148:151],v[120:123]
buffer_store_dword v15, v17, s[8:11], s84 offen sc1
M v[120:123],a[120:123],a[152:155],v[120:123]
s_nop 0
T a[80:81],v22,16384
T a[82:83],v22,18432
M v[120:123],a[124:127],a[156:159],v[120:123]
T a[84:85],v22,20480
T a[86:87],v22,22528
M v[124:127],a[124:127],a[188:191],0
MF v102,v6,v102
MF v103,v6,v103
M v[124:127],a[120:123],a[184:187],v[124:127]
T a[88:89],v22,24576
T a[90:91],v22,26624
M v[124:127],a[116:119],a[180:183],v[124:127]
T a[92:93],v22,28672
T a[94:95],v22,30720
M v[124:127],a[112:115],a[176:179],v[124:127]
MF v108,v6,v108
MF v109,v6,v109
M v[124:127],a[108:111],a[172:175],v[124:127]
MF v110,v6,v110
MF v111,v6,v111
M v[124:127],a[104:107],a[168:171],v[124:127]
C v100,v100,v101
C v101,v102,v103
M v[124:127],a[100:103],a[164:167],v[124:127]
s_waitcnt lgkmcnt(0)
C v102,v108,v109
C v103,v110,v111
M v[124:127],a[96:99],a[160:163],v[124:127]
buffer_store_dwordx4 v[100:103], v7, s[8:11], s30 offen offset:0 sc1
M v[64:67],a[64:67],a[128:131],0
s_nop 0
T a[96:97],v23,0
T a[98:99],v23,2048
M v[64:67],a[68:71],a[132:135],v[64:67]
T a[100:101],v23,4096
T a[102:103],v23,6144
M v[64:67],a[72:75],a[136:139],v[64:67]
MF v112,v5,v112
MF v113,v5,v113
M v[64:67],a[76:79],a[140:143],v[64:67]
T a[104:105],v23,8192
T a[106:107],v23,10240
M v[64:67],a[80:83],a[144:147],v[64:67]
T a[108:109],v23,12288
T a[110:111],v23,14336
M v[64:67],a[84:87],a[148:151],v[64:67]
MF v114,v5,v114
MF v115,v5,v115
M v[64:67],a[88:91],a[152:155],v[64:67]
T a[112:113],v23,16384
T a[114:115],v23,18432
M v[64:67],a[92:95],a[156:159],v[64:67]
T a[116:117],v23,20480
T a[118:119],v23,22528
M v[68:71],a[92:95],a[188:191],0
MF v120,v5,v120
MF v121,v5,v121
M v[68:71],a[88:91],a[184:187],v[68:71]
T a[120:121],v23,24576
T a[122:123],v23,26624
M v[68:71],a[84:87],a[180:183],v[68:71]
T a[124:125],v23,28672
T a[126:127],v23,30720
M v[68:71],a[80:83],a[176:179],v[68:71]
MF v122,v5,v122
MF v123,v5,v123
M v[68:71],a[76:79],a[172:175],v[68:71]
C v112,v112,v113
C v113,v114,v115
M v[68:71],a[72:75],a[168:171],v[68:71]
C v114,v120,v121
C v115,v122,v123
M v[68:71],a[68:71],a[164:167],v[68:71]
buffer_store_dwordx4 v[112:115], v7, s[8:11], s29 offen offset:1024 sc1
M v[68:71],a[64:67],a[160:163],v[68:71]
s_waitcnt lgkmcnt(0)
MF v116,v6,v116
MF v117,v6,v117
M v[72:75],a[96:99],a[128:131],0
T a[64:65],v24,0
T a[66:67],v24,2048
M v[72:75],a[100:103],a[132:135],v[72:75]
T a[68:69],v24,4096
T a[70:71],v24,6144
M v[72:75],a[104:107],a[136:139],v[72:75]
MF v118,v6,v118
MF v119,v6,v119
M v[72:75],a[108:111],a[140:143],v[72:75]
T a[72:73],v24,8192
T a[74:75],v24,10240
M v[72:75],a[112:115],a[144:147],v[72:75]
T a[76:77],v24,12288
T a[78:79],v24,14336
M v[72:75],a[116:119],a[148:151],v[72:75]
MF v124,v6,v124
MF v125,v6,v125
M v[72:75],a[120:123],a[152:155],v[72:75]
T a[80:81],v24,16384
T a[82:83],v24,18432
M v[72:75],a[124:127],a[156:159],v[72:75]
T a[84:85],v24,20480
T a[86:87],v24,22528
M v[76:79],a[124:127],a[188:191],0
MF v126,v6,v126
MF v127,v6,v127
M v[76:79],a[120:123],a[184:187],v[76:79]
T a[88:89],v24,24576
T a[90:91],v24,26624
M v[76:79],a[116:119],a[180:183],v[76:79]
T a[92:93],v24,28672
T a[94:95],v24,30720
M v[76:79],a[112:115],a[176:179],v[76:79]
C v116,v116,v117
C v117,v118,v119
M v[76:79],a[108:111],a[172:175],v[76:79]
C v118,v124,v125
C v119,v126,v127
M v[76:79],a[104:107],a[168:171],v[76:79]
buffer_store_dwordx4 v[116:119], v7, s[8:11], s30 offen offset:1024 sc1
M v[76:79],a[100:103],a[164:167],v[76:79]
SA s29,s33,12288
M v[76:79],a[96:99],a[160:163],v[76:79]
s_waitcnt lgkmcnt(0)
M v[80:83],a[64:67],a[128:131],0
SA s30,s33,26624
T a[96:97],v25,0
T a[98:99],v25,2048
M v[80:83],a[68:71],a[132:135],v[80:83]
T a[100:101],v25,4096
T a[102:103],v25,6144
M v[80:83],a[72:75],a[136:139],v[80:83]
MF v64,v5,v64
MF v65,v5,v65
M v[80:83],a[76:79],a[140:143],v[80:83]
T a[104:105],v25,8192
T a[106:107],v25,10240
M v[80:83],a[80:83],a[144:147],v[80:83]
T a[108:109],v25,12288
T a[110:111],v25,14336
M v[80:83],a[84:87],a[148:151],v[80:83]
MF v66,v5,v66
MF v67,v5,v67
M v[80:83],a[88:91],a[152:155],v[80:83]
T a[112:113],v25,16384
T a[114:115],v25,18432
M v[80:83],a[92:95],a[156:159],v[80:83]
T a[116:117],v25,20480
T a[118:119],v25,22528
M v[84:87],a[92:95],a[188:191],0
MF v72,v5,v72
MF v73,v5,v73
M v[84:87],a[88:91],a[184:187],v[84:87]
T a[120:121],v25,24576
T a[122:123],v25,26624
M v[84:87],a[84:87],a[180:183],v[84:87]
T a[124:125],v25,28672
T a[126:127],v25,30720
M v[84:87],a[80:83],a[176:179],v[84:87]
MF v74,v5,v74
MF v75,v5,v75
M v[84:87],a[76:79],a[172:175],v[84:87]
C v64,v64,v65
C v65,v66,v67
M v[84:87],a[72:75],a[168:171],v[84:87]
C v66,v72,v73
C v67,v74,v75
M v[84:87],a[68:71],a[164:167],v[84:87]
buffer_store_dwordx4 v[64:67], v7, s[8:11], s29 offen offset:0 sc1
M v[84:87],a[64:67],a[160:163],v[84:87]
s_waitcnt lgkmcnt(0)
MF v68,v6,v68
MF v69,v6,v69
M v[88:91],a[96:99],a[128:131],0
MF v70,v6,v70
MF v71,v6,v71
M v[88:91],a[100:103],a[132:135],v[88:91]
MF v76,v6,v76
MF v77,v6,v77
M v[88:91],a[104:107],a[136:139],v[88:91]
MF v78,v6,v78
MF v79,v6,v79
M v[88:91],a[108:111],a[140:143],v[88:91]
C v68,v68,v69
C v69,v70,v71
M v[88:91],a[112:115],a[144:147],v[88:91]
C v70,v76,v77
C v71,v78,v79
M v[88:91],a[116:119],a[148:151],v[88:91]
buffer_store_dwordx4 v[68:71], v7, s[8:11], s30 offen offset:0 sc1
M v[88:91],a[120:123],a[152:155],v[88:91]
M v[88:91],a[124:127],a[156:159],v[88:91]
M v[92:95],a[124:127],a[188:191],0
M v[92:95],a[120:123],a[184:187],v[92:95]
M v[92:95],a[116:119],a[180:183],v[92:95]
M v[92:95],a[112:115],a[176:179],v[92:95]
MF v80,v5,v80
MF v81,v5,v81
M v[92:95],a[108:111],a[172:175],v[92:95]
MF v82,v5,v82
MF v83,v5,v83
M v[92:95],a[104:107],a[168:171],v[92:95]
MF v88,v5,v88
MF v89,v5,v89
M v[92:95],a[100:103],a[164:167],v[92:95]
MF v90,v5,v90
MF v91,v5,v91
M v[92:95],a[96:99],a[160:163],v[92:95]
C v80,v80,v81
C v81,v82,v83
C v82,v88,v89
C v83,v90,v91
buffer_store_dwordx4 v[80:83], v7, s[8:11], s29 offen offset:1024 sc1
MF v84,v6,v84
MF v85,v6,v85
MF v86,v6,v86
MF v87,v6,v87
MF v92,v6,v92
MF v93,v6,v93
MF v94,v6,v94
MF v95,v6,v95
C v84,v84,v85
C v85,v86,v87
C v86,v92,v93
C v87,v94,v95
buffer_store_dwordx4 v[84:87], v7, s[8:11], s30 offen offset:1024 sc1
buffer_load_dword v9, v33, s[8:11], s46 offen sc1
s_waitcnt vmcnt(1)
buffer_store_dword v15, v16, s[8:11], s3 offen sc1
L_red1:
s_waitcnt vmcnt(0)
v_cmp_eq_u32 vcc, 1, v9
s_mov_b32 s91, 65536
s_mov_b32 s69, 0xffff
s_and_b32 s70, vcc_lo, s69
s_mov_b32 s68, s70
s_cmp_lg_u32 s70, 0
s_cbranch_scc1 L_rk0
s_call_b64 s[36:37], L_rpoll
L_rk0:
s_ff1_i32_b32 s71, s70
s_bitset0_b32 s70, s71
s_mul_i32 s71, s71, 114688
SA s72,s71,s77
buffer_load_dwordx4 v[128:131], v7, s[8:11], s72 offen sc1
buffer_load_dwordx4 v[132:135], v27, s[8:11], s72 offen sc1
s_cmp_lg_u32 s70, 0
s_cbranch_scc1 L_rk1
s_call_b64 s[36:37], L_rpoll
L_rk1:
s_ff1_i32_b32 s71, s70
s_bitset0_b32 s70, s71
s_mul_i32 s71, s71, 114688
SA s72,s71,s77
buffer_load_dwordx4 v[136:139], v7, s[8:11], s72 offen sc1
buffer_load_dwordx4 v[140:143], v27, s[8:11], s72 offen sc1
s_cmp_lg_u32 s70, 0
s_cbranch_scc1 L_rk2
s_call_b64 s[36:37], L_rpoll
L_rk2:
s_ff1_i32_b32 s71, s70
s_bitset0_b32 s70, s71
s_mul_i32 s71, s71, 114688
SA s72,s71,s77
buffer_load_dwordx4 v[144:147], v7, s[8:11], s72 offen sc1
buffer_load_dwordx4 v[148:151], v27, s[8:11], s72 offen sc1
v_readlane_b32 s92, v31, 0
v_readlane_b32 s94, v31, 1
v_lshlrev_b32 v64, 16, v48
v_and_b32 v65, 0xffff0000, v48
v_lshlrev_b32 v66, 16, v49
v_and_b32 v67, 0xffff0000, v49
v_lshlrev_b32 v68, 16, v50
v_and_b32 v69, 0xffff0000, v50
v_lshlrev_b32 v70, 16, v51
v_and_b32 v71, 0xffff0000, v51
v_lshlrev_b32 v72, 16, v52
v_and_b32 v73, 0xffff0000, v52
v_lshlrev_b32 v74, 16, v53
v_and_b32 v75, 0xffff0000, v53
v_lshlrev_b32 v76, 16, v54
v_and_b32 v77, 0xffff0000, v54
v_lshlrev_b32 v78, 16, v55
v_and_b32 v79, 0xffff0000, v55
v_sub_f32 v30, 1.0, v39
v_cmp_eq_u32 s[80:81], s92, v37
v_cmp_eq_u32 s[82:83], s94, v37
s_nop 0
s_or_b64 vcc, s[80:81], s[82:83]
s_cbranch_vccnz L_moe0
L_moe_ret0:
MF v64,v30,v64
MF v65,v30,v65
MF v66,v30,v66
MF v67,v30,v67
MF v68,v30,v68
MF v69,v30,v69
MF v70,v30,v70
MF v71,v30,v71
MF v72,v30,v72
MF v73,v30,v73
MF v74,v30,v74
MF v75,v30,v75
MF v76,v30,v76
MF v77,v30,v77
MF v78,v30,v78
MF v79,v30,v79
s_cmp_lg_u32 s70, 0
s_cbranch_scc1 L_rk3
s_call_b64 s[36:37], L_rpoll
L_rk3:
s_ff1_i32_b32 s71, s70
s_bitset0_b32 s70, s71
s_mul_i32 s71, s71, 114688
SA s72,s71,s77
buffer_load_dwordx4 v[152:155], v7, s[8:11], s72 offen sc1
buffer_load_dwordx4 v[156:159], v27, s[8:11], s72 offen sc1
v_lshlrev_b32 v80, 16, v44
v_and_b32 v81, 0xffff0000, v44
v_lshlrev_b32 v82, 16, v45
v_and_b32 v83, 0xffff0000, v45
v_lshlrev_b32 v84, 16, v46
v_and_b32 v85, 0xffff0000, v46
v_lshlrev_b32 v86, 16, v47
v_and_b32 v87, 0xffff0000, v47
v_sub_f32 v30, 1.0, v26
v_cmp_eq_u32 s[80:81], s92, v29
v_cmp_eq_u32 s[82:83], s94, v29
s_nop 0
s_or_b64 vcc, s[80:81], s[82:83]
s_cbranch_vccnz L_moe1
L_moe_ret1:
MF v80,v30,v80
MF v81,v30,v81
MF v82,v30,v82
MF v83,v30,v83
MF v84,v30,v84
MF v85,v30,v85
MF v86,v30,v86
MF v87,v30,v87
s_waitcnt vmcnt(7)
M v[96:99],a[246:249],v[128:131],0
M v[100:103],a[244:247],v[128:131],0
s_waitcnt vmcnt(6)
M v[104:107],a[246:249],v[132:135],0
M v[108:111],a[244:247],v[132:135],0
s_cmp_lg_u32 s70, 0
s_cbranch_scc1 L_rk4
s_call_b64 s[36:37], L_rpoll
L_rk4:
s_ff1_i32_b32 s71, s70
s_bitset0_b32 s70, s71
s_mul_i32 s71, s71, 114688
SA s72,s71,s77
buffer_load_dwordx4 v[160:163], v7, s[8:11], s72 offen sc1
buffer_load_dwordx4 v[164:167], v27, s[8:11], s72 offen sc1
s_waitcnt vmcnt(7)
M v[96:99],a[246:249],v[136:139],v[96:99]
M v[100:103],a[244:247],v[136:139],v[100:103]
s_waitcnt vmcnt(6)
M v[104:107],a[246:249],v[140:143],v[104:107]
M v[108:111],a[244:247],v[140:143],v[108:111]
s_cmp_lg_u32 s70, 0
s_cbranch_scc1 L_rk5
s_call_b64 s[36:37], L_rpoll
L_rk5:
s_ff1_i32_b32 s71, s70
s_bitset0_b32 s70, s71
s_mul_i32 s71, s71, 114688
SA s72,s71,s77
buffer_load_dwordx4 v[168:171], v7, s[8:11], s72 offen sc1
buffer_load_dwordx4 v[172:175], v27, s[8:11], s72 offen sc1
s_waitcnt vmcnt(7)
M v[96:99],a[246:249],v[144:147],v[96:99]
M v[100:103],a[244:247],v[144:147],v[100:103]
s_waitcnt vmcnt(6)
M v[104:107],a[246:249],v[148:151],v[104:107]
M v[108:111],a[244:247],v[148:151],v[108:111]
s_cmp_lg_u32 s70, 0
s_cbranch_scc1 L_rk6
s_call_b64 s[36:37], L_rpoll
L_rk6:
s_ff1_i32_b32 s71, s70
s_bitset0_b32 s70, s71
s_mul_i32 s71, s71, 114688
SA s72,s71,s77
buffer_load_dwordx4 v[176:179], v7, s[8:11], s72 offen sc1
buffer_load_dwordx4 v[180:183], v27, s[8:11], s72 offen sc1
s_waitcnt vmcnt(7)
M v[96:99],a[246:249],v[152:155],v[96:99]
M v[100:103],a[244:247],v[152:155],v[100:103]
s_waitcnt vmcnt(6)
M v[104:107],a[246:249],v[156:159],v[104:107]
M v[108:111],a[244:247],v[156:159],v[108:111]
s_cmp_lg_u32 s70, 0
s_cbranch_scc1 L_rk7
s_call_b64 s[36:37], L_rpoll
L_rk7:
s_ff1_i32_b32 s71, s70
s_bitset0_b32 s70, s71
s_mul_i32 s71, s71, 114688
SA s72,s71,s77
buffer_load_dwordx4 v[184:187], v7, s[8:11], s72 offen sc1
buffer_load_dwordx4 v[188:191], v27, s[8:11], s72 offen sc1
s_waitcnt vmcnt(7)
M v[96:99],a[246:249],v[160:163],v[96:99]
M v[100:103],a[244:247],v[160:163],v[100:103]
s_waitcnt vmcnt(6)
M v[104:107],a[246:249],v[164:167],v[104:107]
M v[108:111],a[244:247],v[164:167],v[108:111]
s_cmp_lg_u32 s70, 0
s_cbranch_scc1 L_rk8
s_call_b64 s[36:37], L_rpoll
L_rk8:
s_ff1_i32_b32 s71, s70
s_bitset0_b32 s70, s71
s_mul_i32 s71, s71, 114688
SA s72,s71,s77
buffer_load_dwordx4 v[128:131], v7, s[8:11], s72 offen sc1
buffer_load_dwordx4 v[132:135], v27, s[8:11], s72 offen sc1
s_waitcnt vmcnt(7)
M v[96:99],a[246:249],v[168:171],v[96:99]
M v[100:103],a[244:247],v[168:171],v[100:103]
s_waitcnt vmcnt(6)
M v[104:107],a[246:249],v[172:175],v[104:107]
M v[108:111],a[244:247],v[172:175],v[108:111]
s_cmp_lg_u32 s70, 0
s_cbranch_scc1 L_rk9
s_call_b64 s[36:37], L_rpoll
L_rk9:
s_ff1_i32_b32 s71, s70
s_bitset0_b32 s70, s71
s_mul_i32 s71, s71, 114688
SA s72,s71,s77
buffer_load_dwordx4 v[136:139], v7, s[8:11], s72 offen sc1
buffer_load_dwordx4 v[140:143], v27, s[8:11], s72 offen sc1
s_waitcnt vmcnt(7)
M v[96:99],a[246:249],v[176:179],v[96:99]
M v[100:103],a[244:247],v[176:179],v[100:103]
s_waitcnt vmcnt(6)
M v[104:107],a[246:249],v[180:183],v[104:107]
M v[108:111],a[244:247],v[180:183],v[108:111]
s_cmp_lg_u32 s70, 0
s_cbranch_scc1 L_rk10
s_call_b64 s[36:37], L_rpoll
L_rk10:
s_ff1_i32_b32 s71, s70
s_bitset0_b32 s70, s71
s_mul_i32 s71, s71, 114688
SA s72,s71,s77
buffer_load_dwordx4 v[144:147], v7, s[8:11], s72 offen sc1
buffer_load_dwordx4 v[148:151], v27, s[8:11], s72 offen sc1
s_waitcnt vmcnt(7)
M v[96:99],a[246:249],v[184:187],v[96:99]
M v[100:103],a[244:247],v[184:187],v[100:103]
s_waitcnt vmcnt(6)
M v[104:107],a[246:249],v[188:191],v[104:107]
M v[108:111],a[244:247],v[188:191],v[108:111]
s_cmp_lg_u32 s70, 0
s_cbranch_scc1 L_rk11
s_call_b64 s[36:37], L_rpoll
L_rk11:
s_ff1_i32_b32 s71, s70
s_bitset0_b32 s70, s71
s_mul_i32 s71, s71, 114688
SA s72,s71,s77
buffer_load_dwordx4 v[152:155], v7, s[8:11], s72 offen sc1
buffer_load_dwordx4 v[156:159], v27, s[8:11], s72 offen sc1
s_waitcnt vmcnt(7)
M v[96:99],a[246:249],v[128:131],v[96:99]
M v[100:103],a[244:247],v[128:131],v[100:103]
s_waitcnt vmcnt(6)
M v[104:107],a[246:249],v[132:135],v[104:107]
M v[108:111],a[244:247],v[132:135],v[108:111]
s_cmp_lg_u32 s70, 0
s_cbranch_scc1 L_rk12
s_call_b64 s[36:37], L_rpoll
L_rk12:
s_ff1_i32_b32 s71, s70
s_bitset0_b32 s70, s71
s_mul_i32 s71, s71, 114688
SA s72,s71,s77
buffer_load_dwordx4 v[160:163], v7, s[8:11], s72 offen sc1
buffer_load_dwordx4 v[164:167], v27, s[8:11], s72 offen sc1
buffer_load_dword v8, v33, s[8:11], s46 offen sc1
s_waitcnt vmcnt(8)
M v[96:99],a[246:249],v[136:139],v[96:99]
M v[100:103],a[244:247],v[136:139],v[100:103]
s_waitcnt vmcnt(7)
M v[104:107],a[246:249],v[140:143],v[104:107]
M v[108:111],a[244:247],v[140:143],v[108:111]
s_cmp_lg_u32 s70, 0
s_cbranch_scc1 L_rk13
s_call_b64 s[36:37], L_rpoll
L_rk13:
s_ff1_i32_b32 s71, s70
s_bitset0_b32 s70, s71
s_mul_i32 s71, s71, 114688
SA s72,s71,s77
buffer_load_dwordx4 v[168:171], v7, s[8:11], s72 offen sc1
buffer_load_dwordx4 v[172:175], v27, s[8:11], s72 offen sc1
s_waitcnt vmcnt(8)
M v[96:99],a[246:249],v[144:147],v[96:99]
M v[100:103],a[244:247],v[144:147],v[100:103]
s_waitcnt vmcnt(7)
M v[104:107],a[246:249],v[148:151],v[104:107]
M v[108:111],a[244:247],v[148:151],v[108:111]
s_cmp_lg_u32 s70, 0
s_cbranch_scc1 L_rk14
s_call_b64 s[36:37], L_rpoll
L_rk14:
s_ff1_i32_b32 s71, s70
s_bitset0_b32 s70, s71
s_mul_i32 s71, s71, 114688
SA s72,s71,s77
buffer_load_dwordx4 v[176:179], v7, s[8:11], s72 offen sc1
buffer_load_dwordx4 v[180:183], v27, s[8:11], s72 offen sc1
s_waitcnt vmcnt(8)
M v[96:99],a[246:249],v[152:155],v[96:99]
M v[100:103],a[244:247],v[152:155],v[100:103]
s_waitcnt vmcnt(7)
M v[104:107],a[246:249],v[156:159],v[104:107]
M v[108:111],a[244:247],v[156:159],v[108:111]
s_cmp_lg_u32 s70, 0
s_cbranch_scc1 L_rk15
s_call_b64 s[36:37], L_rpoll
L_rk15:
s_ff1_i32_b32 s71, s70
s_bitset0_b32 s70, s71
s_mul_i32 s71, s71, 114688
SA s72,s71,s77
buffer_load_dwordx4 v[184:187], v7, s[8:11], s72 offen sc1
buffer_load_dwordx4 v[188:191], v27, s[8:11], s72 offen sc1
s_waitcnt vmcnt(8)
M v[96:99],a[246:249],v[160:163],v[96:99]
M v[100:103],a[244:247],v[160:163],v[100:103]
s_waitcnt vmcnt(7)
M v[104:107],a[246:249],v[164:167],v[104:107]
M v[108:111],a[244:247],v[164:167],v[108:111]
s_waitcnt vmcnt(6)
v_cmp_eq_u32 vcc, 1, v8
s_mov_b32 s69, 0xffff0000
s_and_b32 s70, vcc_lo, s69
s_mov_b32 s68, s70
s_cmp_lg_u32 s70, 0
s_cbranch_scc1 L_rk16
s_call_b64 s[36:37], L_rpoll
L_rk16:
s_ff1_i32_b32 s71, s70
s_bitset0_b32 s70, s71
s_mul_i32 s71, s71, 114688
SA s72,s71,s78
buffer_load_dwordx4 v[192:195], v7, s[8:11], s72 offen sc1
s_waitcnt vmcnt(6)
M v[96:99],a[246:249],v[168:171],v[96:99]
M v[100:103],a[244:247],v[168:171],v[100:103]
s_waitcnt vmcnt(5)
M v[104:107],a[246:249],v[172:175],v[104:107]
M v[108:111],a[244:247],v[172:175],v[108:111]
s_cmp_lg_u32 s70, 0
s_cbranch_scc1 L_rk17
s_call_b64 s[36:37], L_rpoll
L_rk17:
s_ff1_i32_b32 s71, s70
s_bitset0_b32 s70, s71
s_mul_i32 s71, s71, 114688
SA s72,s71,s78
buffer_load_dwordx4 v[196:199], v7, s[8:11], s72 offen sc1
s_waitcnt vmcnt(5)
M v[96:99],a[246:249],v[176:179],v[96:99]
M v[100:103],a[244:247],v[176:179],v[100:103]
s_waitcnt vmcnt(4)
M v[104:107],a[246:249],v[180:183],v[104:107]
M v[108:111],a[244:247],v[180:183],v[108:111]
s_cmp_lg_u32 s70, 0
s_cbranch_scc1 L_rk18
s_call_b64 s[36:37], L_rpoll
L_rk18:
s_ff1_i32_b32 s71, s70
s_bitset0_b32 s70, s71
s_mul_i32 s71, s71, 114688
SA s72,s71,s78
buffer_load_dwordx4 v[200:203], v7, s[8:11], s72 offen sc1
s_waitcnt vmcnt(4)
M v[96:99],a[246:249],v[184:187],v[96:99]
M v[100:103],a[244:247],v[184:187],v[100:103]
s_waitcnt vmcnt(3)
M v[104:107],a[246:249],v[188:191],v[104:107]
M v[108:111],a[244:247],v[188:191],v[108:111]
s_nop 4
v_permlane16_swap_b32 v96, v100
v_permlane16_swap_b32 v97, v101
v_permlane16_swap_b32 v98, v102
v_permlane16_swap_b32 v99, v103
v_permlane16_swap_b32 v104, v108
v_permlane16_swap_b32 v105, v109
v_permlane16_swap_b32 v106, v110
v_permlane16_swap_b32 v107, v111
v_fmac_f32 v64, v39, v96
v_fmac_f32 v65, v39, v97
v_fmac_f32 v66, v39, v98
v_fmac_f32 v67, v39, v99
v_fmac_f32 v68, v39, v100
v_fmac_f32 v69, v39, v101
v_fmac_f32 v70, v39, v102
v_fmac_f32 v71, v39, v103
C v48,v64,v65
C v49,v66,v67
C v50,v68,v69
C v51,v70,v71
buffer_store_dwordx4 v[48:51], v38, s[52:55], s75 offen sc1
v_fmac_f32 v72, v39, v104
v_fmac_f32 v73, v39, v105
v_fmac_f32 v74, v39, v106
v_fmac_f32 v75, v39, v107
v_fmac_f32 v76, v39, v108
v_fmac_f32 v77, v39, v109
v_fmac_f32 v78, v39, v110
v_fmac_f32 v79, v39, v111
C v52,v72,v73
C v53,v74,v75
C v54,v76,v77
C v55,v78,v79
buffer_store_dwordx4 v[52:55], v38, s[52:55], s76 offen sc1
s_cmp_lg_u32 s70, 0
s_cbranch_scc1 L_rk19
s_call_b64 s[36:37], L_rpoll
L_rk19:
s_ff1_i32_b32 s71, s70
s_bitset0_b32 s70, s71
s_mul_i32 s71, s71, 114688
SA s72,s71,s78
buffer_load_dwordx4 v[204:207], v7, s[8:11], s72 offen sc1
s_cmp_lg_u32 s70, 0
s_cbranch_scc1 L_rk20
s_call_b64 s[36:37], L_rpoll
L_rk20:
s_ff1_i32_b32 s71, s70
s_bitset0_b32 s70, s71
s_mul_i32 s71, s71, 114688
SA s72,s71,s78
buffer_load_dwordx4 v[208:211], v7, s[8:11], s72 offen sc1
s_cmp_lg_u32 s70, 0
s_cbranch_scc1 L_rk21
s_call_b64 s[36:37], L_rpoll
L_rk21:
s_ff1_i32_b32 s71, s70
s_bitset0_b32 s70, s71
s_mul_i32 s71, s71, 114688
SA s72,s71,s78
buffer_load_dwordx4 v[212:215], v7, s[8:11], s72 offen sc1
s_cmp_lg_u32 s70, 0
s_cbranch_scc1 L_rk22
s_call_b64 s[36:37], L_rpoll
L_rk22:
s_ff1_i32_b32 s71, s70
s_bitset0_b32 s70, s71
s_mul_i32 s71, s71, 114688
SA s72,s71,s78
buffer_load_dwordx4 v[216:219], v7, s[8:11], s72 offen sc1
s_cmp_lg_u32 s70, 0
s_cbranch_scc1 L_rk23
s_call_b64 s[36:37], L_rpoll
L_rk23:
s_ff1_i32_b32 s71, s70
s_bitset0_b32 s70, s71
s_mul_i32 s71, s71, 114688
SA s72,s71,s78
buffer_load_dwordx4 v[220:223], v7, s[8:11], s72 offen sc1
s_cmp_lg_u32 s70, 0
s_cbranch_scc1 L_rk24
s_call_b64 s[36:37], L_rpoll
L_rk24:
s_ff1_i32_b32 s71, s70
s_bitset0_b32 s70, s71
s_mul_i32 s71, s71, 114688
SA s72,s71,s78
buffer_load_dwordx4 v[224:227], v7, s[8:11], s72 offen sc1
s_cmp_lg_u32 s70, 0
s_cbranch_scc1 L_rk25
s_call_b64 s[36:37], L_rpoll
L_rk25:
s_ff1_i32_b32 s71, s70
s_bitset0_b32 s70, s71
s_mul_i32 s71, s71, 114688
SA s72,s71,s78
buffer_load_dwordx4 v[228:231], v7, s[8:11], s72 offen sc1
s_cmp_lg_u32 s70, 0
s_cbranch_scc1 L_rk26
s_call_b64 s[36:37], L_rpoll
L_rk26:
s_ff1_i32_b32 s71, s70
s_bitset0_b32 s70, s71
s_mul_i32 s71, s71, 114688
SA s72,s71,s78
buffer_load_dwordx4 v[232:235], v7, s[8:11], s72 offen sc1
s_cmp_lg_u32 s70, 0
s_cbranch_scc1 L_rk27
s_call_b64 s[36:37], L_rpoll
L_rk27:
s_ff1_i32_b32 s71, s70
s_bitset0_b32 s70, s71
s_mul_i32 s71, s71, 114688
SA s72,s71,s78
buffer_load_dwordx4 v[236:239], v7, s[8:11], s72 offen sc1
s_waitcnt vmcnt(13)
M v[112:115],a[246:249],v[192:195],0
M v[116:119],a[244:247],v[192:195],0
s_cmp_lg_u32 s70, 0
s_cbranch_scc1 L_rk28
s_call_b64 s[36:37], L_rpoll
L_rk28:
s_ff1_i32_b32 s71, s70
s_bitset0_b32 s70, s71
s_mul_i32 s71, s71, 114688
SA s72,s71,s78
buffer_load_dwordx4 v[240:243], v7, s[8:11], s72 offen sc1
s_waitcnt vmcnt(13)
M v[112:115],a[246:249],v[196:199],v[112:115]
M v[116:119],a[244:247],v[196:199],v[116:119]
s_cmp_lg_u32 s70, 0
s_cbranch_scc1 L_rk29
s_call_b64 s[36:37], L_rpoll
L_rk29:
s_ff1_i32_b32 s71, s70
s_bitset0_b32 s70, s71
s_mul_i32 s71, s71, 114688
SA s72,s71,s78
buffer_load_dwordx4 v[244:247], v7, s[8:11], s72 offen sc1
s_waitcnt vmcnt(13)
M v[112:115],a[246:249],v[200:203],v[112:115]
M v[116:119],a[244:247],v[200:203],v[116:119]
s_cmp_lg_u32 s70, 0
s_cbranch_scc1 L_rk30
s_call_b64 s[36:37], L_rpoll
L_rk30:
s_ff1_i32_b32 s71, s70
s_bitset0_b32 s70, s71
s_mul_i32 s71, s71, 114688
SA s72,s71,s78
buffer_load_dwordx4 v[248:251], v7, s[8:11], s72 offen sc1
s_waitcnt vmcnt(11)
M v[112:115],a[246:249],v[204:207],v[112:115]
M v[116:119],a[244:247],v[204:207],v[116:119]
s_cmp_lg_u32 s70, 0
s_cbranch_scc1 L_rk31
s_call_b64 s[36:37], L_rpoll
L_rk31:
s_ff1_i32_b32 s71, s70
s_bitset0_b32 s70, s71
s_mul_i32 s71, s71, 114688
SA s72,s71,s78
buffer_load_dwordx4 v[252:255], v7, s[8:11], s72 offen sc1
s_waitcnt vmcnt(11)
M v[112:115],a[246:249],v[208:211],v[112:115]
M v[116:119],a[244:247],v[208:211],v[116:119]
s_waitcnt vmcnt(10)
M v[112:115],a[246:249],v[212:215],v[112:115]
M v[116:119],a[244:247],v[212:215],v[116:119]
s_waitcnt vmcnt(9)
M v[112:115],a[246:249],v[216:219],v[112:115]
M v[116:119],a[244:247],v[216:219],v[116:119]
s_waitcnt vmcnt(8)
M v[112:115],a[246:249],v[220:223],v[112:115]
M v[116:119],a[244:247],v[220:223],v[116:119]
s_waitcnt vmcnt(7)
M v[112:115],a[246:249],v[224:227],v[112:115]
M v[116:119],a[244:247],v[224:227],v[116:119]
s_waitcnt vmcnt(6)
M v[112:115],a[246:249],v[228:231],v[112:115]
M v[116:119],a[244:247],v[228:231],v[116:119]
s_waitcnt vmcnt(5)
M v[112:115],a[246:249],v[232:235],v[112:115]
M v[116:119],a[244:247],v[232:235],v[116:119]
s_waitcnt vmcnt(4)
M v[112:115],a[246:249],v[236:239],v[112:115]
M v[116:119],a[244:247],v[236:239],v[116:119]
s_waitcnt vmcnt(3)
M v[112:115],a[246:249],v[240:243],v[112:115]
M v[116:119],a[244:247],v[240:243],v[116:119]
s_waitcnt vmcnt(2)
M v[112:115],a[246:249],v[244:247],v[112:115]
M v[116:119],a[244:247],v[244:247],v[116:119]
s_waitcnt vmcnt(1)
M v[112:115],a[246:249],v[248:251],v[112:115]
M v[116:119],a[244:247],v[248:251],v[116:119]
s_waitcnt vmcnt(0)
M v[112:115],a[246:249],v[252:255],v[112:115]
M v[116:119],a[244:247],v[252:255],v[116:119]
s_nop 7
v_permlane16_swap_b32 v112, v116
v_permlane16_swap_b32 v113, v117
v_permlane16_swap_b32 v114, v118
v_permlane16_swap_b32 v115, v119
v_fmac_f32 v80, v26, v112
v_fmac_f32 v81, v26, v113
v_fmac_f32 v82, v26, v114
v_fmac_f32 v83, v26, v115
v_fmac_f32 v84, v26, v116
v_fmac_f32 v85, v26, v117
v_fmac_f32 v86, v26, v118
v_fmac_f32 v87, v26, v119
C v44,v80,v81
C v45,v82,v83
C v46,v84,v85
C v47,v86,v87
buffer_store_dwordx4 v[44:47], v28, s[52:55], s79 offen sc1
s_endpgm
L_rpoll0:
s_sleep 1
L_rpoll:
buffer_load_dword v9, v33, s[8:11], s46 offen sc1
s_waitcnt vmcnt(0)
v_cmp_eq_u32 vcc, 1, v9
s_sub_u32 s91, s91, 1
s_cselect_b32 s70, -1, 0
s_or_b32 s70, s70, vcc_lo
s_and_b32 s70, s70, s69
s_andn2_b32 s70, s70, s68
s_cbranch_scc0 L_rpoll0
s_or_b32 s68, s68, s70
s_setpc_b64 s[36:37]
L_moe0:
s_lshl_b32 s88, s75, 1
s_call_b64 s[36:37], L_moe
AF v64,v2,v64
AF v65,v3,v65
AF v66,v4,v66
AF v67,v5,v67
AF v68,v10,v68
AF v69,v11,v69
AF v70,v12,v70
AF v71,v13,v71
AF v72,v14,v72
AF v73,v15,v73
AF v74,v16,v74
AF v75,v17,v75
AF v76,v18,v76
AF v77,v19,v77
AF v78,v20,v78
AF v79,v21,v79
s_mov_b64 exec, -1
s_branch L_moe_ret0
L_moe1:
s_lshl_b32 s88, s79, 1
s_call_b64 s[36:37], L_moe
AF v80,v2,v80
AF v81,v3,v81
AF v82,v4,v82
AF v83,v5,v83
AF v84,v10,v84
AF v85,v11,v85
AF v86,v12,v86
AF v87,v13,v87
s_mov_b64 exec, -1
s_branch L_moe_ret1
L_moe2:
s_lshl_b32 s88, s79, 1
s_call_b64 s[36:37], L_moe
AF v48,v2,v48
AF v49,v3,v49
AF v50,v4,v50
AF v51,v5,v51
AF v52,v10,v52
AF v53,v11,v53
AF v54,v12,v54
AF v55,v13,v55
s_mov_b64 exec, -1
s_branch L_moe_ret2
L_moe:
v_min_u32 v0, 27, v32
v_lshlrev_b32 v0, 2, v0
s_mov_b32 s64, 105062912
s_mov_b32 s65, 65536
s_mov_b32 exec_lo, 0xffffffff
s_mov_b32 exec_hi, 0xffffffff
L_pfy:
buffer_load_dword v1, v0, s[8:11], s64 offen sc1
s_sub_u32 s65, s65, 1
s_cbranch_scc1 L_pfy_x
s_waitcnt vmcnt(0)
v_cmp_ne_u32 vcc, 1, v1
s_nop 0
s_cbranch_vccz L_pfy_x
s_sleep 2
s_branch L_pfy
L_pfy_x:
s_waitcnt vmcnt(0)
s_mov_b64 exec, -1
s_or_b64 exec, s[80:81], s[82:83]
v_mov_b32 v0, 1792
v_cndmask_b32 v0, v0, 0, s[80:81]
v_lshl_add_u32 v0, v34, 5, v0
SA s88,s88,104898560
buffer_load_dwordx4 v[2:5], v0, s[8:11], s88 offen sc1
buffer_load_dwordx4 v[10:13], v0, s[8:11], s88 offen offset:16 sc1
buffer_load_dwordx4 v[14:17], v0, s[8:11], s88 offen offset:512 sc1
buffer_load_dwordx4 v[18:21], v0, s[8:11], s88 offen offset:528 sc1
s_waitcnt vmcnt(0)
s_setpc_b64 s[36:37]
L_red:
v_lshrrev_b32 v32, 4, v7
s_lshr_b32 s74, s41, 3
s_lshl_b32 s64, s42, 1
SA s46,s64,s74
s_mul_i32 s46, s46, 4352
s_and_b32 s72, s41, 7
s_lshl_b32 s65, s72, 7
SA s46,s46,s65
SA s46,s46,104992768
v_and_b32 v33, 31, v32
v_lshlrev_b32 v33, 2, v33
s_lshl_b32 s65, s41, 7
SA s65,s65,104890368
buffer_load_dword v31, v33, s[8:11], s65 offen sc1
v_bfe_u32 v34, v32, 4, 1
v_lshlrev_b32 v34, 1, v34
v_lshrrev_b32 v35, 5, v32
v_add_u32 v34, v34, v35
s_mov_b32 s52, s96
s_and_b32 s53, s97, 0xffff
s_mov_b32 s54, 1835008
s_mov_b32 s55, 0x20000
s_mul_i32 s77, s42, 1835008
s_mul_i32 s78, s72, 14336
SA s77,s77,s78
SA s77,s77,67108864
s_lshl_b32 s79, s74, 1
SA s79,s79,s20
s_lshl_b32 s71, s74, 1
SA s71,s71,1
s_sub_u32 s71, s71, s20
s_and_b32 s71, s71, 536870912
s_sub_u32 s64, 15, s64
s_sub_u32 s78, s64, 1
s_mul_i32 s78, s78, 1835008
SA s78,s78,s77
s_lshl_b32 s65, s79, 10
SA s78,s78,s65
SA s78,s78,s71
s_lshl_b32 s79, s79, 6
s_or_b32 s79, s79, s71
s_mul_i32 s67, s74, -2
s_lshl_b32 s74, s74, 3
SA s74,s74,s20
s_lshl_b32 s75, s74, 6
SA s76,s75,256
SA s67,s67,3
s_sub_u32 s67, s67, s20
s_and_b32 s67, s67, 536870912
s_or_b32 s76, s76, s67
v_or_b32 v27, s67, v7
v_add_u32 v27, 4096, v27
s_lshl_b32 s65, s74, 10
SA s77,s77,s65
s_lshl_b32 s64, s64, 7
s_lshr_b32 s73, s72, 1
s_sub_u32 s65, 7, s73
s_bitcmp1_b32 s72, 0
s_cselect_b32 s73, s65, s73
s_lshl_b32 s73, s73, 4
s_lshl_b32 s65, s42, 7
SA s73,s73,s65
v_and_b32 v37, 15, v32
v_add_u32 v37, s73, v37
v_add_u32 v29, s64, v37
s_mov_b32 s64, 104857664
v_mul_u32_u24 v38, 896, v37
v_lshl_add_u32 v38, v34, 4, v38
v_lshrrev_b32 v35, 4, v37
v_lshlrev_b32 v35, 5, v35
v_and_b32 v36, 15, v37
v_add_lshl_u32 v35, v35, v36, 2
buffer_load_dword v39, v35, s[8:11], s64 offen sc1
buffer_load_dwordx4 v[48:51], v38, s[56:59], s75 offen
buffer_load_dwordx4 v[52:55], v38, s[56:59], s76 offen
v_mul_u32_u24 v28, 896, v29
v_lshl_add_u32 v28, v34, 4, v28
v_lshrrev_b32 v35, 4, v29
v_lshlrev_b32 v35, 5, v35
v_and_b32 v36, 15, v29
v_add_lshl_u32 v35, v35, v36, 2
buffer_load_dword v26, v35, s[8:11], s64 offen sc1
buffer_load_dwordx4 v[44:47], v28, s[56:59], s79 offen
s_waitcnt vmcnt(7)
buffer_load_dword v9, v33, s[8:11], s46 offen sc1
s_branch L_red1
L_code_end:
.section .rodata,"a"
.p2align 6
.amdhsa_kernel gated_mix__compressed_kv_cla__moe_arch_mod__prompt_kernel
  .amdhsa_next_free_vgpr 512
  .amdhsa_next_free_sgpr 102
  .amdhsa_accum_offset 256
  .amdhsa_group_segment_fixed_size 0
  .amdhsa_kernarg_size 120
  .amdhsa_user_sgpr_count 2
  .amdhsa_user_sgpr_kernarg_segment_ptr 1
  .amdhsa_system_sgpr_workgroup_id_x 1
  .amdhsa_float_denorm_mode_32 3
.end_amdhsa_kernel
```

```asm
; @launch grid=(256,1,1) block=(256,1,1) lds=163840
.amdgcn_target "amdgcn-amd-amdhsa--gfx950"
.text
.macro M a, b, c, d
v_mfma_f32_16x16x32_bf16 \a, \b, \c, \d
.endm
.macro R a, b, c
ds_read_b128 \a, \b offset:\c
.endm
.macro T a, b, c
ds_read_b64_tr_b16 \a, \b offset:\c
.endm
.macro C a, b, c
v_cvt_pk_bf16_f32 \a, \b, \c
.endm
.macro E a, b
v_exp_f32 \a, \b
.endm
.macro W a, b
v_accvgpr_write_b32 \a, \b
.endm
.macro G a, b
v_accvgpr_read_b32 \a, \b
.endm
.macro AF a, b, c
v_add_f32 \a, \b, \c
.endm
.macro MF a, b, c
v_mul_f32 \a, \b, \c
.endm
.macro SA a, b, c
s_add_u32 \a, \b, \c
.endm
.globl gated_mix__compressed_kv_cla__moe_arch_mod__prompt_kernel
.p2align 8
.type gated_mix__compressed_kv_cla__moe_arch_mod__prompt_kernel,@function
gated_mix__compressed_kv_cla__moe_arch_mod__prompt_kernel:
s_cmp_lt_u32 s2, 256
s_cbranch_scc1 L_go
s_endpgm
L_go:
s_load_dwordx8 s[80:87], s[0:1], 0
s_load_dwordx4 s[88:91], s[0:1], 32
s_getpc_b64 s[76:77]
L_pc0:
s_lshr_b32 s42, s2, 3
s_mov_b32 s79, 0x20000
s_lshl_b32 s67, s42, 13
s_mov_b32 s78, L_code_end-L_pc0
s_and_b32 s77, s77, 0xffff
v_lshl_add_u32 v31, v0, 5, s67
buffer_load_dword a240, v31, s[76:79], 0 offen offset:0
v_lshrrev_b32 v24, 6, v0
v_and_b32 v0, 63, v0
s_and_b32 s41, s2, 7
v_readfirstlane_b32 s20, v24
s_lshr_b32 s64, s2, 4
v_and_b32 v24, 15, v0
v_lshrrev_b32 v25, 4, v0
s_and_b32 s64, s64, 8
s_or_b32 s41, s41, s64
v_lshlrev_b32 v28, 1, v25
v_xor_b32 v28, v28, v24
v_and_b32 v29, 8, v28
v_and_b32 v28, 7, v28
v_lshlrev_b32 v28, 4, v28
v_lshl_add_u32 v28, v29, 5, v28
v_lshl_add_u32 v28, v25, 13, v28
s_lshl_b32 s64, s20, 17
v_add_u32 v8, s64, v28
v_xor_b32 v28, 0x100, v8
v_add_u32 v9, 31744, v8
v_add_u32 v10, 63488, v28
v_add_u32 v11, 95232, v28
s_mov_b32 s21, 0
s_lshl_b32 s23, s20, 12
s_lshl_b32 s74, s41, 9
s_sub_u32 s18, 8388608, s74
s_mov_b32 s19, s79
s_bitcmp0_b32 s2, 6
s_waitcnt lgkmcnt(0)
s_cselect_b64 s[72:73], s[86:87], s[88:89]
SA s16,s72,s74
s_addc_u32 s73, s73, 0
s_and_b32 s17, s73, 0xffff
SA m0,s23,0
s_nop 0
buffer_load_dwordx4 v8, s[16:19], s21 offen offset:0   lds
buffer_load_dwordx4 v9, s[16:19], s21 offen offset:1024   lds
buffer_load_dwordx4 v10, s[16:19], s21 offen offset:2048   lds
buffer_load_dwordx4 v11, s[16:19], s21 offen offset:3072   lds
SA s21,s21,128
s_and_b32 s42, s42, 15
s_lshr_b32 s45, s42, 3
s_and_b32 s65, s20, 1
s_lshr_b32 s66, s20, 1
v_and_b32 v29, 7, v0
v_xor_b32 v28, v25, v29
v_lshlrev_b32 v28, 4, v28
v_lshrrev_b32 v29, 3, v0
v_lshl_add_u32 v30, v29, 11, v28
s_lshl_b32 s64, s66, 19
s_lshl_b32 s67, s65, 21
SA s64,s64,s67
v_add_u32 v12, s64, v30
v_xor_b32 v30, 64, v12
v_add_u32 v14, 30720, v12
v_add_u32 v13, 15360, v30
v_add_u32 v15, 46080, v30
s_mov_b32 s22, 0
SA s24,s23,65536
s_and_b32 s64, s42, 7
s_lshl_b32 s64, s64, 16
s_sub_u32 s50, 4194304, s64
s_mov_b32 s51, s79
SA s48,s82,s64
s_addc_u32 s73, s83, 0
s_and_b32 s49, s73, 0xffff
SA m0,s23,16384
s_nop 0
buffer_load_dwordx4 v8, s[16:19], s21 offen offset:0   lds
buffer_load_dwordx4 v9, s[16:19], s21 offen offset:1024   lds
buffer_load_dwordx4 v10, s[16:19], s21 offen offset:2048   lds
buffer_load_dwordx4 v11, s[16:19], s21 offen offset:3072   lds
SA s21,s21,524160
SA m0,s24,0
s_nop 0
buffer_load_dwordx4 v12, s[48:51], s22 offen offset:0   lds
buffer_load_dwordx4 v13, s[48:51], s22 offen offset:1024   lds
buffer_load_dwordx4 v14, s[48:51], s22 offen offset:2048   lds
buffer_load_dwordx4 v15, s[48:51], s22 offen offset:3072   lds
SA s22,s22,1048576
s_load_dwordx2 s[92:93], s[0:1], 56
s_load_dwordx2 s[94:95], s[0:1], 88
s_load_dwordx4 s[4:7], s[0:1], 104
v_lshlrev_b32 v7, 4, v0
v_lshrrev_b32 v26, 2, v24
v_and_b32 v28, 1, v25
v_lshl_or_b32 v28, v28, 2, v26
v_lshl_add_u32 v29, v25, 3, v26
v_lshlrev_b32 v29, 8, v29
v_and_b32 v30, 3, v0
v_lshl_add_u32 v29, v30, 3, v29
s_lshl_b32 s64, s65, 2
SA s64,s64,0
v_xor_b32 v30, s64, v28
v_lshl_add_u32 v1, v30, 5, v29
s_lshl_b32 s64, s65, 2
SA s64,s64,1
v_xor_b32 v30, s64, v28
v_lshl_add_u32 v2, v30, 5, v29
s_lshl_b32 s64, s65, 2
SA s64,s64,2
v_xor_b32 v30, s64, v28
v_lshl_add_u32 v3, v30, 5, v29
s_lshl_b32 s64, s65, 2
SA s64,s64,3
v_xor_b32 v30, s64, v28
v_lshl_add_u32 v4, v30, 5, v29
v_add_u32 v28, 0, v25
v_lshrrev_b32 v29, 1, v24
v_xor_b32 v28, v28, v29
v_lshlrev_b32 v28, 4, v28
v_lshl_add_u32 v28, v24, 7, v28
s_lshl_b32 s64, s66, 13
SA s64,s64,65536
v_add_u32 v5, s64, v28
v_add_u32 v28, 4, v25
v_lshrrev_b32 v29, 1, v24
v_xor_b32 v28, v28, v29
v_lshlrev_b32 v28, 4, v28
v_lshl_add_u32 v28, v24, 7, v28
s_lshl_b32 s64, s66, 13
SA s64,s64,65536
v_add_u32 v6, s64, v28
s_mov_b32 s56, s80
s_and_b32 s57, s81, 0xffff
s_mov_b32 s58, 1835008
s_mov_b32 s59, 0x20000
s_waitcnt lgkmcnt(0)
s_mov_b32 s60, s92
s_and_b32 s61, s93, 0xffff
s_mov_b32 s62, 896
s_mov_b32 s63, 0x20000
s_mov_b32 s68, s94
s_and_b32 s69, s95, 0xffff
s_mov_b32 s70, 896
s_mov_b32 s71, 0x20000
s_lshl_b32 s95, s20, 11
s_lshr_b32 s64, s2, 3
s_lshl_b32 s64, s64, 13
SA s95,s95,s64
s_mov_b32 s8, s6
s_and_b32 s9, s7, 0xffff
s_mov_b32 s10, 268435456
s_mov_b32 s11, 0x20000
s_mov_b32 s12, s4
s_and_b32 s13, s5, 0xffff
s_mov_b32 s14, 256
s_mov_b32 s15, 0x20000
SA s72,s84,s74
s_addc_u32 s73, s85, 0
s_sub_u32 s75, 3670016, s74
s_mov_b32 s52, s72
s_and_b32 s53, s73, 0xffff
s_mov_b32 s54, s75
s_mov_b32 s55, 0x20000
s_mul_i32 s29, s42, 114688
s_mov_b32 s5, 0x3db8aa3b
s_mul_i32 s72, s45, 16777216
s_mul_i32 s73, s41, 1048576
SA s72,s72,s73
s_bfe_u32 s64, s42, 0x20001
s_lshl_b32 s64, s64, 15
SA s72,s72,s64
s_lshl_b32 s64, s66, 17
SA s72,s72,s64
s_and_b32 s67, s42, 1
s_cmp_eq_u32 s45, 0
s_cselect_b32 s64, 12, 14
s_cselect_b32 s75, 14, 10
s_lshl_b32 s67, s67, s75
SA s72,s72,s67
s_lshl_b32 s64, s65, s64
SA s93,s72,s64
s_load_dwordx4 s[80:83], s[0:1], 64
s_load_dwordx2 s[84:85], s[0:1], 80
s_load_dwordx2 s[96:97], s[0:1], 96
s_cmp_eq_u32 s45, 0
s_cbranch_scc0 L_kv1
s_branch L_kv0
.p2align 12
L_kv0:
s_and_b32 s31, s42, 7
s_lshl_b32 s64, s42, 4
SA s64,s64,s41
s_lshl_b32 s64, s64, 2
SA s64,s64,s20
s_cmp_lt_u32 s64, 41
s_cselect_b32 s39, 0, 536870912
s_min_u32 s64, s64, 41
s_lshl_b32 s38, s64, 2
s_max_u32 s67, s64, 8
s_sub_u32 s67, s67, 8
s_mul_i32 s67, s67, 3328
s_lshl_b32 s64, s64, 10
SA s64,s64,s67
SA s73,s64,104914944
v_or_b32 v64, s39, v7
v_mov_b32 v68, 0
v_mov_b32 v69, 0
v_mov_b32 v70, 0
v_mov_b32 v71, 0
buffer_store_dwordx4 v[68:71], v64, s[8:11], s73 offen offset:0 sc1
buffer_store_dwordx4 v[68:71], v64, s[8:11], s73 offen offset:1024 sc1
buffer_store_dwordx4 v[68:71], v64, s[8:11], s73 offen offset:2048 sc1
SA m0,s24,16384
s_nop 0
buffer_load_dwordx4 v12, s[48:51], s22 offen offset:0   lds
buffer_load_dwordx4 v13, s[48:51], s22 offen offset:1024   lds
buffer_load_dwordx4 v14, s[48:51], s22 offen offset:2048   lds
buffer_load_dwordx4 v15, s[48:51], s22 offen offset:3072   lds
s_sub_u32 s22, s22, 1048448
SA m0,s23,32768
s_nop 0
buffer_load_dwordx4 v8, s[16:19], s21 offen offset:0   lds
buffer_load_dwordx4 v9, s[16:19], s21 offen offset:1024   lds
buffer_load_dwordx4 v10, s[16:19], s21 offen offset:2048   lds
buffer_load_dwordx4 v11, s[16:19], s21 offen offset:3072   lds
SA s21,s21,128
s_mov_b64 exec, 0
s_cmp_eq_u32 s20, 0
s_cbranch_scc1 L_w_kv01
s_cmp_eq_u32 s20, 1
s_cbranch_scc1 L_w_kv02
s_cmp_eq_u32 s20, 2
s_cbranch_scc1 L_w_kv03
s_branch L_w_kv04
L_wd1:
s_mov_b64 exec, -1
s_waitcnt vmcnt(11) lgkmcnt(0)
s_barrier
R a[160:163],v5,0
R a[164:167],v6,0
T a[96:97],v1,0
T a[98:99],v1,1024
T a[100:101],v1,8192
T a[102:103],v1,9216
T a[104:105],v2,0
T a[106:107],v2,1024
T a[108:109],v2,8192
T a[110:111],v2,9216
T a[112:113],v3,0
T a[114:115],v3,1024
T a[116:117],v3,8192
T a[118:119],v3,9216
T a[120:121],v4,0
T a[122:123],v4,1024
T a[124:125],v4,8192
T a[126:127],v4,9216
T a[128:129],v1,16384
T a[130:131],v1,17408
T a[132:133],v1,24576
T a[134:135],v1,25600
T a[136:137],v2,16384
T a[138:139],v2,17408
T a[140:141],v2,24576
T a[142:143],v2,25600
T a[144:145],v3,16384
T a[146:147],v3,17408
T a[148:149],v3,24576
T a[150:151],v3,25600
T a[152:153],v4,16384
T a[154:155],v4,17408
T a[156:157],v4,24576
T a[158:159],v4,25600
s_waitcnt lgkmcnt(15)
M a[0:3],a[96:99],a[160:163],0
SA m0,s23,49152
R a[168:171],v5,2048
R a[172:175],v6,2048
M a[0:3],a[100:103],a[164:167],a[0:3]
buffer_load_dwordx4 v8, s[16:19], s21 offen offset:0   lds
M a[4:7],a[108:111],a[164:167],0
M a[4:7],a[104:107],a[160:163],a[4:7]
M a[8:11],a[112:115],a[160:163],0
buffer_load_dwordx4 v9, s[16:19], s21 offen offset:1024   lds
M a[8:11],a[116:119],a[164:167],a[8:11]
s_waitcnt lgkmcnt(14)
M a[12:15],a[124:127],a[164:167],0
M a[12:15],a[120:123],a[160:163],a[12:15]
M a[16:19],a[128:131],a[160:163],0
buffer_load_dwordx4 v10, s[16:19], s21 offen offset:2048   lds
M a[16:19],a[132:135],a[164:167],a[16:19]
s_waitcnt lgkmcnt(6)
M a[20:23],a[140:143],a[164:167],0
M a[20:23],a[136:139],a[160:163],a[20:23]
buffer_load_dwordx4 v11, s[16:19], s21 offen offset:3072   lds
M a[24:27],a[144:147],a[160:163],0
SA s21,s21,524160
M a[24:27],a[148:151],a[164:167],a[24:27]
s_waitcnt lgkmcnt(0)
M a[28:31],a[156:159],a[164:167],0
SA m0,s24,32768
M a[28:31],a[152:155],a[160:163],a[28:31]
buffer_load_dwordx4 v12, s[48:51], s22 offen offset:0   lds
M v[32:35],a[96:99],a[168:171],0
R a[160:163],v5,4096
R a[164:167],v6,4096
M v[32:35],a[100:103],a[172:175],v[32:35]
M v[36:39],a[108:111],a[172:175],0
M v[36:39],a[104:107],a[168:171],v[36:39]
buffer_load_dwordx4 v13, s[48:51], s22 offen offset:1024   lds
M v[40:43],a[112:115],a[168:171],0
M v[40:43],a[116:119],a[172:175],v[40:43]
M v[44:47],a[124:127],a[172:175],0
buffer_load_dwordx4 v14, s[48:51], s22 offen offset:2048   lds
M v[44:47],a[120:123],a[168:171],v[44:47]
M v[48:51],a[128:131],a[168:171],0
M v[48:51],a[132:135],a[172:175],v[48:51]
M v[52:55],a[140:143],a[172:175],0
buffer_load_dwordx4 v15, s[48:51], s22 offen offset:3072   lds
M v[52:55],a[136:139],a[168:171],v[52:55]
SA s22,s22,1048576
M v[56:59],a[144:147],a[168:171],0
M v[56:59],a[148:151],a[172:175],v[56:59]
s_waitcnt lgkmcnt(0)
M v[60:63],a[156:159],a[172:175],0
M v[60:63],a[152:155],a[168:171],v[60:63]
M v[64:67],a[96:99],a[160:163],0
R a[168:171],v5,6144
R a[172:175],v6,6144
M v[64:67],a[100:103],a[164:167],v[64:67]
M v[68:71],a[108:111],a[164:167],0
M v[68:71],a[104:107],a[160:163],v[68:71]
M v[72:75],a[112:115],a[160:163],0
M v[72:75],a[116:119],a[164:167],v[72:75]
M v[76:79],a[124:127],a[164:167],0
M v[76:79],a[120:123],a[160:163],v[76:79]
M v[80:83],a[128:131],a[160:163],0
M v[80:83],a[132:135],a[164:167],v[80:83]
M v[84:87],a[140:143],a[164:167],0
M v[84:87],a[136:139],a[160:163],v[84:87]
M v[88:91],a[144:147],a[160:163],0
M v[88:91],a[148:151],a[164:167],v[88:91]
s_waitcnt lgkmcnt(0)
M v[92:95],a[156:159],a[164:167],0
s_waitcnt vmcnt(12)
M v[92:95],a[152:155],a[160:163],v[92:95]
s_barrier
M v[96:99],a[96:99],a[168:171],0
SA m0,s23,0
R a[160:163],v5,16384
R a[164:167],v6,16384
M v[96:99],a[100:103],a[172:175],v[96:99]
buffer_load_dwordx4 v8, s[16:19], s21 offen offset:0   lds
M v[100:103],a[108:111],a[172:175],0
v_lshlrev_b32 v26, 7, v0
v_and_b32 v27, 48, v0
M v[100:103],a[104:107],a[168:171],v[100:103]
v_lshl_add_u32 v26, v27, 24, v26
M v[104:107],a[112:115],a[168:171],0
buffer_load_dwordx4 v9, s[16:19], s21 offen offset:1024   lds
M v[104:107],a[116:119],a[172:175],v[104:107]
M v[108:111],a[124:127],a[172:175],0
M v[108:111],a[120:123],a[168:171],v[108:111]
buffer_load_dwordx4 v10, s[16:19], s21 offen offset:2048   lds
M v[112:115],a[128:131],a[168:171],0
M v[112:115],a[132:135],a[172:175],v[112:115]
M v[116:119],a[140:143],a[172:175],0
M v[116:119],a[136:139],a[168:171],v[116:119]
buffer_load_dwordx4 v11, s[16:19], s21 offen offset:3072   lds
M v[120:123],a[144:147],a[168:171],0
SA s21,s21,128
M v[120:123],a[148:151],a[172:175],v[120:123]
s_waitcnt lgkmcnt(0)
M v[124:127],a[156:159],a[172:175],0
SA m0,s24,49152
M v[124:127],a[152:155],a[168:171],v[124:127]
buffer_load_dwordx4 v12, s[48:51], s22 offen offset:0   lds
M v[128:131],a[96:99],a[160:163],0
R a[168:171],v5,18432
R a[172:175],v6,18432
M v[128:131],a[100:103],a[164:167],v[128:131]
buffer_load_dwordx4 v13, s[48:51], s22 offen offset:1024   lds
M v[132:135],a[108:111],a[164:167],0
M v[132:135],a[104:107],a[160:163],v[132:135]
M v[136:139],a[112:115],a[160:163],0
M v[136:139],a[116:119],a[164:167],v[136:139]
buffer_load_dwordx4 v14, s[48:51], s22 offen offset:2048   lds
M v[140:143],a[124:127],a[164:167],0
M v[140:143],a[120:123],a[160:163],v[140:143]
M v[144:147],a[128:131],a[160:163],0
buffer_load_dwordx4 v15, s[48:51], s22 offen offset:3072   lds
M v[144:147],a[132:135],a[164:167],v[144:147]
s_sub_u32 s22, s22, 1048448
M v[148:151],a[140:143],a[164:167],0
M v[148:151],a[136:139],a[160:163],v[148:151]
M v[152:155],a[144:147],a[160:163],0
M v[152:155],a[148:151],a[164:167],v[152:155]
s_waitcnt lgkmcnt(0)
M v[156:159],a[156:159],a[164:167],0
s_waitcnt vmcnt(12)
M v[156:159],a[152:155],a[160:163],v[156:159]
s_barrier
M v[160:163],a[96:99],a[168:171],0
SA m0,s23,16384
R a[160:163],v5,20480
R a[164:167],v6,20480
M v[160:163],a[100:103],a[172:175],v[160:163]
T a[32:33],v1,32768
T a[34:35],v1,33792
M v[164:167],a[108:111],a[172:175],0
T a[36:37],v1,40960
T a[38:39],v1,41984
M v[164:167],a[104:107],a[168:171],v[164:167]
T a[40:41],v2,32768
T a[42:43],v2,33792
M v[168:171],a[112:115],a[168:171],0
T a[44:45],v2,40960
T a[46:47],v2,41984
M v[168:171],a[116:119],a[172:175],v[168:171]
buffer_load_dwordx4 v8, s[16:19], s21 offen offset:0   lds
M v[172:175],a[124:127],a[172:175],0
s_nop 0
T a[48:49],v3,32768
T a[50:51],v3,33792
M v[172:175],a[120:123],a[168:171],v[172:175]
buffer_load_dwordx4 v9, s[16:19], s21 offen offset:1024   lds
M v[176:179],a[128:131],a[168:171],0
s_nop 0
T a[52:53],v3,40960
T a[54:55],v3,41984
M v[176:179],a[132:135],a[172:175],v[176:179]
T a[56:57],v4,32768
T a[58:59],v4,33792
M v[180:183],a[140:143],a[172:175],0
buffer_load_dwordx4 v10, s[16:19], s21 offen offset:2048   lds
M v[180:183],a[136:139],a[168:171],v[180:183]
s_nop 0
T a[60:61],v4,40960
T a[62:63],v4,41984
M v[184:187],a[144:147],a[168:171],0
buffer_load_dwordx4 v11, s[16:19], s21 offen offset:3072   lds
M v[184:187],a[148:151],a[172:175],v[184:187]
s_waitcnt lgkmcnt(15)
s_nop 0
T a[64:65],v1,49152
T a[66:67],v1,50176
M v[188:191],a[156:159],a[172:175],0
SA s21,s21,524160
T a[68:69],v1,57344
T a[70:71],v1,58368
M v[188:191],a[152:155],a[168:171],v[188:191]
SA m0,s24,0
M v[192:195],a[96:99],a[160:163],0
R a[168:171],v5,22528
R a[172:175],v6,22528
M v[192:195],a[100:103],a[164:167],v[192:195]
T a[72:73],v2,49152
T a[74:75],v2,50176
M v[196:199],a[108:111],a[164:167],0
T a[76:77],v2,57344
T a[78:79],v2,58368
M v[196:199],a[104:107],a[160:163],v[196:199]
T a[80:81],v3,49152
T a[82:83],v3,50176
M v[200:203],a[112:115],a[160:163],0
buffer_load_dwordx4 v12, s[48:51], s22 offen offset:0   lds
M v[200:203],a[116:119],a[164:167],v[200:203]
s_nop 0
T a[84:85],v3,57344
T a[86:87],v3,58368
M v[204:207],a[124:127],a[164:167],0
T a[88:89],v4,49152
T a[90:91],v4,50176
M v[204:207],a[120:123],a[160:163],v[204:207]
buffer_load_dwordx4 v13, s[48:51], s22 offen offset:1024   lds
M v[208:211],a[128:131],a[160:163],0
s_nop 0
T a[92:93],v4,57344
T a[94:95],v4,58368
M v[208:211],a[132:135],a[164:167],v[208:211]
buffer_load_dwordx4 v14, s[48:51], s22 offen offset:2048   lds
M v[212:215],a[140:143],a[164:167],0
buffer_load_dwordx4 v15, s[48:51], s22 offen offset:3072   lds
M v[212:215],a[136:139],a[160:163],v[212:215]
SA s22,s22,1048576
M v[216:219],a[144:147],a[160:163],0
M v[216:219],a[148:151],a[164:167],v[216:219]
s_waitcnt lgkmcnt(12)
M v[220:223],a[156:159],a[164:167],0
s_waitcnt vmcnt(12) lgkmcnt(0)
M v[220:223],a[152:155],a[160:163],v[220:223]
s_barrier
M v[224:227],a[96:99],a[168:171],0
SA m0,s23,32768
R a[160:163],v5,32768
R a[164:167],v6,32768
M v[224:227],a[100:103],a[172:175],v[224:227]
buffer_load_dwordx4 v8, s[16:19], s21 offen offset:0   lds
M v[228:231],a[108:111],a[172:175],0
M v[228:231],a[104:107],a[168:171],v[228:231]
M v[232:235],a[112:115],a[168:171],0
buffer_load_dwordx4 v9, s[16:19], s21 offen offset:1024   lds
M v[232:235],a[116:119],a[172:175],v[232:235]
M v[236:239],a[124:127],a[172:175],0
M v[236:239],a[120:123],a[168:171],v[236:239]
buffer_load_dwordx4 v10, s[16:19], s21 offen offset:2048   lds
M v[240:243],a[128:131],a[168:171],0
M v[240:243],a[132:135],a[172:175],v[240:243]
M v[244:247],a[140:143],a[172:175],0
buffer_load_dwordx4 v11, s[16:19], s21 offen offset:3072   lds
M v[244:247],a[136:139],a[168:171],v[244:247]
SA s21,s21,128
M v[248:251],a[144:147],a[168:171],0
M v[248:251],a[148:151],a[172:175],v[248:251]
s_waitcnt lgkmcnt(0)
M v[252:255],a[156:159],a[172:175],0
M v[252:255],a[152:155],a[168:171],v[252:255]
M a[0:3],a[32:35],a[160:163],a[0:3]
R a[168:171],v5,34816
R a[172:175],v6,34816
M a[0:3],a[36:39],a[164:167],a[0:3]
T a[96:97],v1,0
T a[98:99],v1,1024
M a[4:7],a[44:47],a[164:167],a[4:7]
SA m0,s24,16384
M a[4:7],a[40:43],a[160:163],a[4:7]
buffer_load_dwordx4 v12, s[48:51], s22 offen offset:0   lds
M a[8:11],a[48:51],a[160:163],a[8:11]
M a[8:11],a[52:55],a[164:167],a[8:11]
M a[12:15],a[60:63],a[164:167],a[12:15]
s_nop 0
T a[100:101],v1,8192
T a[102:103],v1,9216
M a[12:15],a[56:59],a[160:163],a[12:15]
M a[16:19],a[64:67],a[160:163],a[16:19]
buffer_load_dwordx4 v13, s[48:51], s22 offen offset:1024   lds
M a[16:19],a[68:71],a[164:167],a[16:19]
M a[20:23],a[76:79],a[164:167],a[20:23]
M a[20:23],a[72:75],a[160:163],a[20:23]
s_nop 0
T a[104:105],v2,0
T a[106:107],v2,1024
M a[24:27],a[80:83],a[160:163],a[24:27]
M a[24:27],a[84:87],a[164:167],a[24:27]
s_waitcnt lgkmcnt(6)
buffer_load_dwordx4 v14, s[48:51], s22 offen offset:2048   lds
M a[28:31],a[92:95],a[164:167],a[28:31]
M a[28:31],a[88:91],a[160:163],a[28:31]
M v[60:63],a[88:91],a[168:171],v[60:63]
R a[160:163],v5,36864
R a[164:167],v6,36864
M v[60:63],a[92:95],a[172:175],v[60:63]
T a[108:109],v2,8192
T a[110:111],v2,9216
M v[56:59],a[84:87],a[172:175],v[56:59]
buffer_load_dwordx4 v15, s[48:51], s22 offen offset:3072   lds
M v[56:59],a[80:83],a[168:171],v[56:59]
s_sub_u32 s22, s22, 1048448
M v[52:55],a[72:75],a[168:171],v[52:55]
M v[52:55],a[76:79],a[172:175],v[52:55]
s_nop 0
T a[112:113],v3,0
T a[114:115],v3,1024
M v[48:51],a[68:71],a[172:175],v[48:51]
SA m0,s23,49152
M v[48:51],a[64:67],a[168:171],v[48:51]
buffer_load_dwordx4 v8, s[16:19], s21 offen offset:0   lds
M v[44:47],a[56:59],a[168:171],v[44:47]
M v[44:47],a[60:63],a[172:175],v[44:47]
M v[40:43],a[52:55],a[172:175],v[40:43]
s_nop 0
T a[116:117],v3,8192
T a[118:119],v3,9216
M v[40:43],a[48:51],a[168:171],v[40:43]
M v[36:39],a[40:43],a[168:171],v[36:39]
buffer_load_dwordx4 v9, s[16:19], s21 offen offset:1024   lds
M v[36:39],a[44:47],a[172:175],v[36:39]
s_waitcnt lgkmcnt(6)
M v[32:35],a[36:39],a[172:175],v[32:35]
M v[32:35],a[32:35],a[168:171],v[32:35]
s_nop 0
T a[120:121],v4,0
T a[122:123],v4,1024
M v[64:67],a[32:35],a[160:163],v[64:67]
R a[168:171],v5,38912
R a[172:175],v6,38912
M v[64:67],a[36:39],a[164:167],v[64:67]
buffer_load_dwordx4 v10, s[16:19], s21 offen offset:2048   lds
M v[68:71],a[44:47],a[164:167],v[68:71]
M v[68:71],a[40:43],a[160:163],v[68:71]
M v[72:75],a[48:51],a[160:163],v[72:75]
s_nop 0
T a[124:125],v4,8192
T a[126:127],v4,9216
M v[72:75],a[52:55],a[164:167],v[72:75]
M v[76:79],a[60:63],a[164:167],v[76:79]
buffer_load_dwordx4 v11, s[16:19], s21 offen offset:3072   lds
M v[76:79],a[56:59],a[160:163],v[76:79]
SA s21,s21,524160
M v[80:83],a[64:67],a[160:163],v[80:83]
M v[80:83],a[68:71],a[164:167],v[80:83]
M v[84:87],a[76:79],a[164:167],v[84:87]
M v[84:87],a[72:75],a[160:163],v[84:87]
M v[88:91],a[80:83],a[160:163],v[88:91]
M v[88:91],a[84:87],a[164:167],v[88:91]
s_waitcnt lgkmcnt(2)
M v[92:95],a[92:95],a[164:167],v[92:95]
s_waitcnt vmcnt(16) lgkmcnt(0)
M v[92:95],a[88:91],a[160:163],v[92:95]
s_barrier
M v[124:127],a[88:91],a[168:171],v[124:127]
R a[160:163],v5,49152
R a[164:167],v6,49152
M v[124:127],a[92:95],a[172:175],v[124:127]
M v[120:123],a[84:87],a[172:175],v[120:123]
SA m0,s24,32768
T a[128:129],v1,16384
T a[130:131],v1,17408
M v[120:123],a[80:83],a[168:171],v[120:123]
buffer_load_dwordx4 v12, s[48:51], s22 offen offset:0   lds
M v[116:119],a[72:75],a[168:171],v[116:119]
M v[116:119],a[76:79],a[172:175],v[116:119]
M v[112:115],a[68:71],a[172:175],v[112:115]
M v[112:115],a[64:67],a[168:171],v[112:115]
M v[108:111],a[56:59],a[168:171],v[108:111]
M v[108:111],a[60:63],a[172:175],v[108:111]
s_nop 0
T a[132:133],v1,24576
T a[134:135],v1,25600
M v[104:107],a[52:55],a[172:175],v[104:107]
buffer_load_dwordx4 v13, s[48:51], s22 offen offset:1024   lds
M v[104:107],a[48:51],a[168:171],v[104:107]
M v[100:103],a[40:43],a[168:171],v[100:103]
M v[100:103],a[44:47],a[172:175],v[100:103]
s_waitcnt lgkmcnt(4)
M v[96:99],a[36:39],a[172:175],v[96:99]
M v[96:99],a[32:35],a[168:171],v[96:99]
M v[128:131],a[32:35],a[160:163],v[128:131]
R a[168:171],v5,51200
R a[172:175],v6,51200
M v[128:131],a[36:39],a[164:167],v[128:131]
T a[136:137],v2,16384
T a[138:139],v2,17408
M v[132:135],a[44:47],a[164:167],v[132:135]
buffer_load_dwordx4 v14, s[48:51], s22 offen offset:2048   lds
M v[132:135],a[40:43],a[160:163],v[132:135]
M v[136:139],a[48:51],a[160:163],v[136:139]
M v[136:139],a[52:55],a[164:167],v[136:139]
M v[140:143],a[60:63],a[164:167],v[140:143]
M v[140:143],a[56:59],a[160:163],v[140:143]
s_nop 0
T a[140:141],v2,24576
T a[142:143],v2,25600
M v[144:147],a[64:67],a[160:163],v[144:147]
buffer_load_dwordx4 v15, s[48:51], s22 offen offset:3072   lds
M v[144:147],a[68:71],a[164:167],v[144:147]
SA s22,s22,1048576
M v[148:151],a[76:79],a[164:167],v[148:151]
M v[148:151],a[72:75],a[160:163],v[148:151]
M v[152:155],a[80:83],a[160:163],v[152:155]
M v[152:155],a[84:87],a[164:167],v[152:155]
s_waitcnt lgkmcnt(4)
M v[156:159],a[92:95],a[164:167],v[156:159]
SA m0,s23,0
T a[144:145],v3,16384
T a[146:147],v3,17408
M v[156:159],a[88:91],a[160:163],v[156:159]
buffer_load_dwordx4 v8, s[16:19], s21 offen offset:0   lds
M v[188:191],a[88:91],a[168:171],v[188:191]
R a[160:163],v5,53248
R a[164:167],v6,53248
M v[188:191],a[92:95],a[172:175],v[188:191]
M v[184:187],a[84:87],a[172:175],v[184:187]
M v[184:187],a[80:83],a[168:171],v[184:187]
M v[180:183],a[72:75],a[168:171],v[180:183]
M v[180:183],a[76:79],a[172:175],v[180:183]
s_nop 0
T a[148:149],v3,24576
T a[150:151],v3,25600
M v[176:179],a[68:71],a[172:175],v[176:179]
buffer_load_dwordx4 v9, s[16:19], s21 offen offset:1024   lds
M v[176:179],a[64:67],a[168:171],v[176:179]
M v[172:175],a[56:59],a[168:171],v[172:175]
M v[172:175],a[60:63],a[172:175],v[172:175]
M v[168:171],a[52:55],a[172:175],v[168:171]
M v[168:171],a[48:51],a[168:171],v[168:171]
M v[164:167],a[40:43],a[168:171],v[164:167]
s_nop 0
T a[152:153],v4,16384
T a[154:155],v4,17408
M v[164:167],a[44:47],a[172:175],v[164:167]
s_waitcnt lgkmcnt(4)
buffer_load_dwordx4 v10, s[16:19], s21 offen offset:2048   lds
M v[160:163],a[36:39],a[172:175],v[160:163]
M v[160:163],a[32:35],a[168:171],v[160:163]
M v[192:195],a[32:35],a[160:163],v[192:195]
R a[168:171],v5,55296
R a[172:175],v6,55296
M v[192:195],a[36:39],a[164:167],v[192:195]
M v[196:199],a[44:47],a[164:167],v[196:199]
M v[196:199],a[40:43],a[160:163],v[196:199]
s_nop 0
T a[156:157],v4,24576
T a[158:159],v4,25600
M v[200:203],a[48:51],a[160:163],v[200:203]
buffer_load_dwordx4 v11, s[16:19], s21 offen offset:3072   lds
M v[200:203],a[52:55],a[164:167],v[200:203]
SA s21,s21,128
M v[204:207],a[60:63],a[164:167],v[204:207]
M v[204:207],a[56:59],a[160:163],v[204:207]
M v[208:211],a[64:67],a[160:163],v[208:211]
M v[208:211],a[68:71],a[164:167],v[208:211]
M v[212:215],a[76:79],a[164:167],v[212:215]
M v[212:215],a[72:75],a[160:163],v[212:215]
M v[216:219],a[80:83],a[160:163],v[216:219]
M v[216:219],a[84:87],a[164:167],v[216:219]
s_waitcnt lgkmcnt(2)
M v[220:223],a[92:95],a[164:167],v[220:223]
s_waitcnt vmcnt(16) lgkmcnt(0)
M v[220:223],a[88:91],a[160:163],v[220:223]
s_barrier
M v[252:255],a[88:91],a[168:171],v[252:255]
R a[160:163],v5,0
R a[164:167],v6,0
M v[252:255],a[92:95],a[172:175],v[252:255]
v_min_u32 v16, 1, v0
v_lshlrev_b32 v16, 29, v16
M v[248:251],a[84:87],a[172:175],v[248:251]
v_or_b32 v16, s39, v16
v_mov_b32 v17, 1
M v[248:251],a[80:83],a[168:171],v[248:251]
buffer_store_dword v17, v16, s[12:15], s38 offen sc1
M v[244:247],a[72:75],a[168:171],v[244:247]
M v[244:247],a[76:79],a[172:175],v[244:247]
M v[240:243],a[68:71],a[172:175],v[240:243]
M v[240:243],a[64:67],a[168:171],v[240:243]
M v[236:239],a[56:59],a[168:171],v[236:239]
M v[236:239],a[60:63],a[172:175],v[236:239]
M v[232:235],a[52:55],a[172:175],v[232:235]
M v[232:235],a[48:51],a[168:171],v[232:235]
M v[228:231],a[40:43],a[168:171],v[228:231]
M v[228:231],a[44:47],a[172:175],v[228:231]
s_waitcnt lgkmcnt(0)
M v[224:227],a[36:39],a[172:175],v[224:227]
M v[224:227],a[32:35],a[168:171],v[224:227]
M a[0:3],a[96:99],a[160:163],a[0:3]
L_w_kv01:
s_cbranch_execz L_w_kv05
R a[168:171],v5,2048
R a[172:175],v6,2048
M a[0:3],a[100:103],a[164:167],a[0:3]
T a[32:33],v1,32768
T a[34:35],v1,33792
M a[4:7],a[108:111],a[164:167],a[4:7]
SA m0,s24,49152
M a[4:7],a[104:107],a[160:163],a[4:7]
buffer_load_dwordx4 v12, s[48:51], s22 offen offset:0   lds
M a[8:11],a[112:115],a[160:163],a[8:11]
M a[8:11],a[116:119],a[164:167],a[8:11]
M a[12:15],a[124:127],a[164:167],a[12:15]
s_nop 0
T a[36:37],v1,40960
T a[38:39],v1,41984
M a[12:15],a[120:123],a[160:163],a[12:15]
M a[16:19],a[128:131],a[160:163],a[16:19]
buffer_load_dwordx4 v13, s[48:51], s22 offen offset:1024   lds
M a[16:19],a[132:135],a[164:167],a[16:19]
M a[20:23],a[140:143],a[164:167],a[20:23]
M a[20:23],a[136:139],a[160:163],a[20:23]
s_nop 0
T a[40:41],v2,32768
T a[42:43],v2,33792
M a[24:27],a[144:147],a[160:163],a[24:27]
M a[24:27],a[148:151],a[164:167],a[24:27]
s_waitcnt lgkmcnt(6)
buffer_load_dwordx4 v14, s[48:51], s22 offen offset:2048   lds
M a[28:31],a[156:159],a[164:167],a[28:31]
M a[28:31],a[152:155],a[160:163],a[28:31]
M v[60:63],a[152:155],a[168:171],v[60:63]
R a[160:163],v5,4096
R a[164:167],v6,4096
M v[60:63],a[156:159],a[172:175],v[60:63]
T a[44:45],v2,40960
T a[46:47],v2,41984
M v[56:59],a[148:151],a[172:175],v[56:59]
buffer_load_dwordx4 v15, s[48:51], s22 offen offset:3072   lds
M v[56:59],a[144:147],a[168:171],v[56:59]
s_sub_u32 s22, s22, 1048448
M v[52:55],a[136:139],a[168:171],v[52:55]
M v[52:55],a[140:143],a[172:175],v[52:55]
s_nop 0
T a[48:49],v3,32768
T a[50:51],v3,33792
M v[48:51],a[132:135],a[172:175],v[48:51]
SA m0,s23,16384
M v[48:51],a[128:131],a[168:171],v[48:51]
buffer_load_dwordx4 v8, s[16:19], s21 offen offset:0   lds
M v[44:47],a[120:123],a[168:171],v[44:47]
M v[44:47],a[124:127],a[172:175],v[44:47]
M v[40:43],a[116:119],a[172:175],v[40:43]
s_nop 0
T a[52:53],v3,40960
T a[54:55],v3,41984
M v[40:43],a[112:115],a[168:171],v[40:43]
M v[36:39],a[104:107],a[168:171],v[36:39]
buffer_load_dwordx4 v9, s[16:19], s21 offen offset:1024   lds
M v[36:39],a[108:111],a[172:175],v[36:39]
s_waitcnt lgkmcnt(6)
M v[32:35],a[100:103],a[172:175],v[32:35]
M v[32:35],a[96:99],a[168:171],v[32:35]
s_nop 0
T a[56:57],v4,32768
T a[58:59],v4,33792
M v[64:67],a[96:99],a[160:163],v[64:67]
R a[168:171],v5,6144
R a[172:175],v6,6144
M v[64:67],a[100:103],a[164:167],v[64:67]
buffer_load_dwordx4 v10, s[16:19], s21 offen offset:2048   lds
M v[68:71],a[108:111],a[164:167],v[68:71]
M v[68:71],a[104:107],a[160:163],v[68:71]
M v[72:75],a[112:115],a[160:163],v[72:75]
s_nop 0
T a[60:61],v4,40960
T a[62:63],v4,41984
M v[72:75],a[116:119],a[164:167],v[72:75]
M v[76:79],a[124:127],a[164:167],v[76:79]
buffer_load_dwordx4 v11, s[16:19], s21 offen offset:3072   lds
M v[76:79],a[120:123],a[160:163],v[76:79]
SA s21,s21,524160
M v[80:83],a[128:131],a[160:163],v[80:83]
M v[80:83],a[132:135],a[164:167],v[80:83]
M v[84:87],a[140:143],a[164:167],v[84:87]
M v[84:87],a[136:139],a[160:163],v[84:87]
s_and_b32 s86, s41, 7
M v[88:91],a[144:147],a[160:163],v[88:91]
s_mul_i32 s86, s86, 14
s_lshr_b32 s64, s41, 3
s_mul_i32 s64, s64, 7
M v[88:91],a[148:151],a[164:167],v[88:91]
s_waitcnt lgkmcnt(2)
SA s86,s86,s64
s_min_u32 s64, s31, 6
M v[92:95],a[156:159],a[164:167],v[92:95]
s_waitcnt vmcnt(17) lgkmcnt(0)
SA s86,s86,s64
s_sub_u32 s64, 6, s31
M v[92:95],a[152:155],a[160:163],v[92:95]
s_barrier
M v[124:127],a[152:155],a[168:171],v[124:127]
R a[160:163],v5,16384
R a[164:167],v6,16384
M v[124:127],a[156:159],a[172:175],v[124:127]
s_and_b32 s88, s64, 536870912
s_mul_i32 s87, s20, 7168
M v[120:123],a[148:151],a[172:175],v[120:123]
SA m0,s24,0
T a[64:65],v1,49152
T a[66:67],v1,50176
M v[120:123],a[144:147],a[168:171],v[120:123]
buffer_load_dwordx4 v12, s[48:51], s22 offen offset:0   lds
M v[116:119],a[136:139],a[168:171],v[116:119]
SA s87,s87,131072
M v[116:119],a[140:143],a[172:175],v[116:119]
s_cmp_lt_u32 s20, 2
M v[112:115],a[132:135],a[172:175],v[112:115]
s_cselect_b64 s[72:73], s[80:81], s[82:83]
M v[112:115],a[128:131],a[168:171],v[112:115]
s_mov_b32 s60, s72
M v[108:111],a[120:123],a[168:171],v[108:111]
s_and_b32 s61, s73, 0xffff
M v[108:111],a[124:127],a[172:175],v[108:111]
s_mov_b32 s62, 1605632
T a[68:69],v1,57344
T a[70:71],v1,58368
M v[104:107],a[116:119],a[172:175],v[104:107]
s_mov_b32 s63, 0x20000
buffer_load_dwordx4 v13, s[48:51], s22 offen offset:1024   lds
M v[104:107],a[112:115],a[168:171],v[104:107]
s_mov_b32 s68, s84
M v[100:103],a[104:107],a[168:171],v[100:103]
s_and_b32 s69, s85, 0xffff
s_mov_b32 s70, 1605632
s_mov_b32 s71, 0x20000
M v[100:103],a[108:111],a[172:175],v[100:103]
s_waitcnt lgkmcnt(4)
s_lshl_b32 s89, s86, 5
M v[96:99],a[100:103],a[172:175],v[96:99]
s_and_b32 s64, s20, 1
M v[96:99],a[96:99],a[168:171],v[96:99]
s_mul_i32 s64, s64, 802816
M v[128:131],a[96:99],a[160:163],v[128:131]
SA s89,s89,s64
R a[168:171],v5,18432
R a[172:175],v6,18432
M v[128:131],a[100:103],a[164:167],v[128:131]
T a[72:73],v2,49152
T a[74:75],v2,50176
M v[132:135],a[108:111],a[164:167],v[132:135]
buffer_load_dwordx4 v14, s[48:51], s22 offen offset:2048   lds
M v[132:135],a[104:107],a[160:163],v[132:135]
v_lshrrev_b32 v28, 1, v0
v_mul_u32_u24 v28, 3584, v28
M v[136:139],a[112:115],a[160:163],v[136:139]
v_and_b32 v29, 1, v0
v_lshl_add_u32 v25, v29, 4, v28
M v[136:139],a[116:119],a[164:167],v[136:139]
v_or_b32 v25, s88, v25
M v[140:143],a[124:127],a[164:167],v[140:143]
M v[140:143],a[120:123],a[160:163],v[140:143]
s_nop 0
T a[76:77],v2,57344
T a[78:79],v2,58368
M v[144:147],a[128:131],a[160:163],v[144:147]
buffer_load_dwordx4 v15, s[48:51], s22 offen offset:3072   lds
M v[144:147],a[132:135],a[164:167],v[144:147]
SA s22,s22,1048576
M v[148:151],a[140:143],a[164:167],v[148:151]
M v[148:151],a[136:139],a[160:163],v[148:151]
M v[152:155],a[144:147],a[160:163],v[152:155]
M v[152:155],a[148:151],a[164:167],v[152:155]
s_waitcnt lgkmcnt(4)
M v[156:159],a[156:159],a[164:167],v[156:159]
SA m0,s23,32768
T a[80:81],v3,49152
T a[82:83],v3,50176
M v[156:159],a[152:155],a[160:163],v[156:159]
buffer_load_dwordx4 v8, s[16:19], s21 offen offset:0   lds
M v[188:191],a[152:155],a[168:171],v[188:191]
R a[160:163],v5,20480
R a[164:167],v6,20480
M v[188:191],a[156:159],a[172:175],v[188:191]
M v[184:187],a[148:151],a[172:175],v[184:187]
M v[184:187],a[144:147],a[168:171],v[184:187]
M v[180:183],a[136:139],a[168:171],v[180:183]
M v[180:183],a[140:143],a[172:175],v[180:183]
s_nop 0
T a[84:85],v3,57344
T a[86:87],v3,58368
M v[176:179],a[132:135],a[172:175],v[176:179]
buffer_load_dwordx4 v9, s[16:19], s21 offen offset:1024   lds
M v[176:179],a[128:131],a[168:171],v[176:179]
M v[172:175],a[120:123],a[168:171],v[172:175]
M v[172:175],a[124:127],a[172:175],v[172:175]
M v[168:171],a[116:119],a[172:175],v[168:171]
M v[168:171],a[112:115],a[168:171],v[168:171]
M v[164:167],a[104:107],a[168:171],v[164:167]
s_nop 0
T a[88:89],v4,49152
T a[90:91],v4,50176
M v[164:167],a[108:111],a[172:175],v[164:167]
s_waitcnt lgkmcnt(4)
buffer_load_dwordx4 v10, s[16:19], s21 offen offset:2048   lds
M v[160:163],a[100:103],a[172:175],v[160:163]
M v[160:163],a[96:99],a[168:171],v[160:163]
M v[192:195],a[96:99],a[160:163],v[192:195]
R a[168:171],v5,22528
R a[172:175],v6,22528
M v[192:195],a[100:103],a[164:167],v[192:195]
M v[196:199],a[108:111],a[164:167],v[196:199]
M v[196:199],a[104:107],a[160:163],v[196:199]
s_nop 0
T a[92:93],v4,57344
T a[94:95],v4,58368
M v[200:203],a[112:115],a[160:163],v[200:203]
buffer_load_dwordx4 v11, s[16:19], s21 offen offset:3072   lds
M v[200:203],a[116:119],a[164:167],v[200:203]
SA s21,s21,128
M v[204:207],a[124:127],a[164:167],v[204:207]
M v[204:207],a[120:123],a[160:163],v[204:207]
M v[208:211],a[128:131],a[160:163],v[208:211]
M v[208:211],a[132:135],a[164:167],v[208:211]
M v[212:215],a[140:143],a[164:167],v[212:215]
M v[212:215],a[136:139],a[160:163],v[212:215]
M v[216:219],a[144:147],a[160:163],v[216:219]
M v[216:219],a[148:151],a[164:167],v[216:219]
s_waitcnt lgkmcnt(2)
M v[220:223],a[156:159],a[164:167],v[220:223]
s_waitcnt vmcnt(17) lgkmcnt(0)
M v[220:223],a[152:155],a[160:163],v[220:223]
s_barrier
M v[252:255],a[152:155],a[168:171],v[252:255]
R a[160:163],v5,32768
R a[164:167],v6,32768
M v[252:255],a[156:159],a[172:175],v[252:255]
M v[248:251],a[148:151],a[172:175],v[248:251]
M v[248:251],a[144:147],a[168:171],v[248:251]
M v[244:247],a[136:139],a[168:171],v[244:247]
M v[244:247],a[140:143],a[172:175],v[244:247]
M v[240:243],a[132:135],a[172:175],v[240:243]
M v[240:243],a[128:131],a[168:171],v[240:243]
M v[236:239],a[120:123],a[168:171],v[236:239]
M v[236:239],a[124:127],a[172:175],v[236:239]
M v[232:235],a[116:119],a[172:175],v[232:235]
M v[232:235],a[112:115],a[168:171],v[232:235]
M v[228:231],a[104:107],a[168:171],v[228:231]
M v[228:231],a[108:111],a[172:175],v[228:231]
s_waitcnt lgkmcnt(0)
M v[224:227],a[100:103],a[172:175],v[224:227]
M v[224:227],a[96:99],a[168:171],v[224:227]
M a[0:3],a[32:35],a[160:163],a[0:3]
R a[168:171],v5,34816
R a[172:175],v6,34816
M a[0:3],a[36:39],a[164:167],a[0:3]
T a[96:97],v1,0
T a[98:99],v1,1024
M a[4:7],a[44:47],a[164:167],a[4:7]
SA m0,s24,16384
M a[4:7],a[40:43],a[160:163],a[4:7]
buffer_load_dwordx4 v12, s[48:51], s22 offen offset:0   lds
M a[8:11],a[48:51],a[160:163],a[8:11]
M a[8:11],a[52:55],a[164:167],a[8:11]
M a[12:15],a[60:63],a[164:167],a[12:15]
s_nop 0
T a[100:101],v1,8192
T a[102:103],v1,9216
M a[12:15],a[56:59],a[160:163],a[12:15]
buffer_load_dwordx4 v13, s[48:51], s22 offen offset:1024   lds
M a[16:19],a[64:67],a[160:163],a[16:19]
M a[16:19],a[68:71],a[164:167],a[16:19]
M a[20:23],a[76:79],a[164:167],a[20:23]
M a[20:23],a[72:75],a[160:163],a[20:23]
s_nop 0
T a[104:105],v2,0
T a[106:107],v2,1024
M a[24:27],a[80:83],a[160:163],a[24:27]
buffer_load_dwordx4 v14, s[48:51], s22 offen offset:2048   lds
M a[24:27],a[84:87],a[164:167],a[24:27]
s_waitcnt lgkmcnt(6)
M a[28:31],a[92:95],a[164:167],a[28:31]
M a[28:31],a[88:91],a[160:163],a[28:31]
M v[60:63],a[88:91],a[168:171],v[60:63]
R a[160:163],v5,36864
R a[164:167],v6,36864
M v[60:63],a[92:95],a[172:175],v[60:63]
T a[108:109],v2,8192
T a[110:111],v2,9216
M v[56:59],a[84:87],a[172:175],v[56:59]
buffer_load_dwordx4 v15, s[48:51], s22 offen offset:3072   lds
M v[56:59],a[80:83],a[168:171],v[56:59]
s_sub_u32 s22, s22, 1048448
M v[52:55],a[72:75],a[168:171],v[52:55]
SA m0,s23,49152
M v[52:55],a[76:79],a[172:175],v[52:55]
s_nop 0
T a[112:113],v3,0
T a[114:115],v3,1024
M v[48:51],a[68:71],a[172:175],v[48:51]
buffer_load_dwordx4 v8, s[16:19], s21 offen offset:0   lds
M v[48:51],a[64:67],a[168:171],v[48:51]
M v[44:47],a[56:59],a[168:171],v[44:47]
M v[44:47],a[60:63],a[172:175],v[44:47]
buffer_load_dwordx4 v9, s[16:19], s21 offen offset:1024   lds
M v[40:43],a[52:55],a[172:175],v[40:43]
s_nop 0
T a[116:117],v3,8192
T a[118:119],v3,9216
M v[40:43],a[48:51],a[168:171],v[40:43]
M v[36:39],a[40:43],a[168:171],v[36:39]
M v[36:39],a[44:47],a[172:175],v[36:39]
s_waitcnt lgkmcnt(6)
M v[32:35],a[36:39],a[172:175],v[32:35]
buffer_load_dwordx4 v10, s[16:19], s21 offen offset:2048   lds
M v[32:35],a[32:35],a[168:171],v[32:35]
s_nop 0
T a[120:121],v4,0
T a[122:123],v4,1024
M v[64:67],a[32:35],a[160:163],v[64:67]
R a[168:171],v5,38912
R a[172:175],v6,38912
M v[64:67],a[36:39],a[164:167],v[64:67]
M v[68:71],a[44:47],a[164:167],v[68:71]
buffer_load_dwordx4 v11, s[16:19], s21 offen offset:3072   lds
M v[68:71],a[40:43],a[160:163],v[68:71]
SA s21,s21,524160
M v[72:75],a[48:51],a[160:163],v[72:75]
s_nop 0
T a[124:125],v4,8192
T a[126:127],v4,9216
M v[72:75],a[52:55],a[164:167],v[72:75]
M v[76:79],a[60:63],a[164:167],v[76:79]
SA m0,s87,0
M v[76:79],a[56:59],a[160:163],v[76:79]
buffer_load_dwordx4 v25, s[60:63], s89 offen offset:0  lds
M v[80:83],a[64:67],a[160:163],v[80:83]
SA s89,s89,114688
M v[80:83],a[68:71],a[164:167],v[80:83]
M v[84:87],a[76:79],a[164:167],v[84:87]
M v[84:87],a[72:75],a[160:163],v[84:87]
M v[88:91],a[80:83],a[160:163],v[88:91]
M v[88:91],a[84:87],a[164:167],v[88:91]
s_waitcnt lgkmcnt(2)
M v[92:95],a[92:95],a[164:167],v[92:95]
s_waitcnt vmcnt(17) lgkmcnt(0)
M v[92:95],a[88:91],a[160:163],v[92:95]
s_barrier
M v[124:127],a[88:91],a[168:171],v[124:127]
R a[160:163],v5,49152
R a[164:167],v6,49152
M v[124:127],a[92:95],a[172:175],v[124:127]
M v[120:123],a[84:87],a[172:175],v[120:123]
SA m0,s24,32768
T a[128:129],v1,16384
T a[130:131],v1,17408
M v[120:123],a[80:83],a[168:171],v[120:123]
buffer_load_dwordx4 v12, s[48:51], s22 offen offset:0   lds
M v[116:119],a[72:75],a[168:171],v[116:119]
v_min_u32 v16, 40, v0
v_lshlrev_b32 v16, 2, v16
M v[116:119],a[76:79],a[172:175],v[116:119]
buffer_load_dword v17, v16, s[12:15], 0 offen sc1
M v[112:115],a[68:71],a[172:175],v[112:115]
M v[112:115],a[64:67],a[168:171],v[112:115]
M v[108:111],a[56:59],a[168:171],v[108:111]
M v[108:111],a[60:63],a[172:175],v[108:111]
s_nop 0
T a[132:133],v1,24576
T a[134:135],v1,25600
M v[104:107],a[52:55],a[172:175],v[104:107]
buffer_load_dwordx4 v13, s[48:51], s22 offen offset:1024   lds
M v[104:107],a[48:51],a[168:171],v[104:107]
M v[100:103],a[40:43],a[168:171],v[100:103]
M v[100:103],a[44:47],a[172:175],v[100:103]
s_waitcnt lgkmcnt(4)
M v[96:99],a[36:39],a[172:175],v[96:99]
M v[96:99],a[32:35],a[168:171],v[96:99]
M v[128:131],a[32:35],a[160:163],v[128:131]
R a[168:171],v5,51200
R a[172:175],v6,51200
M v[128:131],a[36:39],a[164:167],v[128:131]
T a[136:137],v2,16384
T a[138:139],v2,17408
M v[132:135],a[44:47],a[164:167],v[132:135]
buffer_load_dwordx4 v14, s[48:51], s22 offen offset:2048   lds
M v[132:135],a[40:43],a[160:163],v[132:135]
M v[136:139],a[48:51],a[160:163],v[136:139]
M v[136:139],a[52:55],a[164:167],v[136:139]
M v[140:143],a[60:63],a[164:167],v[140:143]
M v[140:143],a[56:59],a[160:163],v[140:143]
s_nop 0
T a[140:141],v2,24576
T a[142:143],v2,25600
M v[144:147],a[64:67],a[160:163],v[144:147]
buffer_load_dwordx4 v15, s[48:51], s22 offen offset:3072   lds
M v[144:147],a[68:71],a[164:167],v[144:147]
SA s22,s22,1048576
M v[148:151],a[76:79],a[164:167],v[148:151]
M v[148:151],a[72:75],a[160:163],v[148:151]
M v[152:155],a[80:83],a[160:163],v[152:155]
M v[152:155],a[84:87],a[164:167],v[152:155]
s_waitcnt lgkmcnt(4)
M v[156:159],a[92:95],a[164:167],v[156:159]
SA m0,s23,0
T a[144:145],v3,16384
T a[146:147],v3,17408
M v[156:159],a[88:91],a[160:163],v[156:159]
buffer_load_dwordx4 v8, s[16:19], s21 offen offset:0   lds
M v[188:191],a[88:91],a[168:171],v[188:191]
R a[160:163],v5,53248
R a[164:167],v6,53248
M v[188:191],a[92:95],a[172:175],v[188:191]
M v[184:187],a[84:87],a[172:175],v[184:187]
M v[184:187],a[80:83],a[168:171],v[184:187]
M v[180:183],a[72:75],a[168:171],v[180:183]
M v[180:183],a[76:79],a[172:175],v[180:183]
s_nop 0
T a[148:149],v3,24576
T a[150:151],v3,25600
M v[176:179],a[68:71],a[172:175],v[176:179]
buffer_load_dwordx4 v9, s[16:19], s21 offen offset:1024   lds
M v[176:179],a[64:67],a[168:171],v[176:179]
M v[172:175],a[56:59],a[168:171],v[172:175]
M v[172:175],a[60:63],a[172:175],v[172:175]
M v[168:171],a[52:55],a[172:175],v[168:171]
M v[168:171],a[48:51],a[168:171],v[168:171]
M v[164:167],a[40:43],a[168:171],v[164:167]
s_nop 0
T a[152:153],v4,16384
T a[154:155],v4,17408
M v[164:167],a[44:47],a[172:175],v[164:167]
s_waitcnt lgkmcnt(4)
buffer_load_dwordx4 v10, s[16:19], s21 offen offset:2048   lds
M v[160:163],a[36:39],a[172:175],v[160:163]
M v[160:163],a[32:35],a[168:171],v[160:163]
M v[192:195],a[32:35],a[160:163],v[192:195]
R a[168:171],v5,55296
R a[172:175],v6,55296
M v[192:195],a[36:39],a[164:167],v[192:195]
M v[196:199],a[44:47],a[164:167],v[196:199]
M v[196:199],a[40:43],a[160:163],v[196:199]
s_nop 0
T a[156:157],v4,24576
T a[158:159],v4,25600
M v[200:203],a[48:51],a[160:163],v[200:203]
buffer_load_dwordx4 v11, s[16:19], s21 offen offset:3072   lds
M v[200:203],a[52:55],a[164:167],v[200:203]
SA s21,s21,128
M v[204:207],a[60:63],a[164:167],v[204:207]
M v[204:207],a[56:59],a[160:163],v[204:207]
M v[208:211],a[64:67],a[160:163],v[208:211]
M v[208:211],a[68:71],a[164:167],v[208:211]
M v[212:215],a[76:79],a[164:167],v[212:215]
M v[212:215],a[72:75],a[160:163],v[212:215]
M v[216:219],a[80:83],a[160:163],v[216:219]
M v[216:219],a[84:87],a[164:167],v[216:219]
s_waitcnt lgkmcnt(2)
M v[220:223],a[92:95],a[164:167],v[220:223]
s_waitcnt vmcnt(18) lgkmcnt(0)
M v[220:223],a[88:91],a[160:163],v[220:223]
s_barrier
M v[252:255],a[88:91],a[168:171],v[252:255]
R a[160:163],v5,0
R a[164:167],v6,0
M v[252:255],a[92:95],a[172:175],v[252:255]
M v[248:251],a[84:87],a[172:175],v[248:251]
M v[248:251],a[80:83],a[168:171],v[248:251]
M v[244:247],a[72:75],a[168:171],v[244:247]
M v[244:247],a[76:79],a[172:175],v[244:247]
M v[240:243],a[68:71],a[172:175],v[240:243]
M v[240:243],a[64:67],a[168:171],v[240:243]
M v[236:239],a[56:59],a[168:171],v[236:239]
M v[236:239],a[60:63],a[172:175],v[236:239]
M v[232:235],a[52:55],a[172:175],v[232:235]
M v[232:235],a[48:51],a[168:171],v[232:235]
M v[228:231],a[40:43],a[168:171],v[228:231]
M v[228:231],a[44:47],a[172:175],v[228:231]
s_waitcnt lgkmcnt(0)
M v[224:227],a[36:39],a[172:175],v[224:227]
M v[224:227],a[32:35],a[168:171],v[224:227]
M a[0:3],a[96:99],a[160:163],a[0:3]
R a[168:171],v5,2048
R a[172:175],v6,2048
M a[0:3],a[100:103],a[164:167],a[0:3]
T a[32:33],v1,32768
T a[34:35],v1,33792
M a[4:7],a[108:111],a[164:167],a[4:7]
SA m0,s24,49152
M a[4:7],a[104:107],a[160:163],a[4:7]
buffer_load_dwordx4 v12, s[48:51], s22 offen offset:0   lds
M a[8:11],a[112:115],a[160:163],a[8:11]
M a[8:11],a[116:119],a[164:167],a[8:11]
M a[12:15],a[124:127],a[164:167],a[12:15]
s_nop 0
T a[36:37],v1,40960
T a[38:39],v1,41984
M a[12:15],a[120:123],a[160:163],a[12:15]
buffer_load_dwordx4 v13, s[48:51], s22 offen offset:1024   lds
M a[16:19],a[128:131],a[160:163],a[16:19]
M a[16:19],a[132:135],a[164:167],a[16:19]
M a[20:23],a[140:143],a[164:167],a[20:23]
M a[20:23],a[136:139],a[160:163],a[20:23]
s_nop 0
T a[40:41],v2,32768
T a[42:43],v2,33792
M a[24:27],a[144:147],a[160:163],a[24:27]
buffer_load_dwordx4 v14, s[48:51], s22 offen offset:2048   lds
M a[24:27],a[148:151],a[164:167],a[24:27]
s_waitcnt lgkmcnt(6)
M a[28:31],a[156:159],a[164:167],a[28:31]
M a[28:31],a[152:155],a[160:163],a[28:31]
M v[60:63],a[152:155],a[168:171],v[60:63]
R a[160:163],v5,4096
R a[164:167],v6,4096
M v[60:63],a[156:159],a[172:175],v[60:63]
T a[44:45],v2,40960
T a[46:47],v2,41984
M v[56:59],a[148:151],a[172:175],v[56:59]
buffer_load_dwordx4 v15, s[48:51], s22 offen offset:3072   lds
M v[56:59],a[144:147],a[168:171],v[56:59]
s_sub_u32 s22, s22, 1048448
M v[52:55],a[136:139],a[168:171],v[52:55]
SA m0,s23,16384
M v[52:55],a[140:143],a[172:175],v[52:55]
s_nop 0
T a[48:49],v3,32768
T a[50:51],v3,33792
M v[48:51],a[132:135],a[172:175],v[48:51]
buffer_load_dwordx4 v8, s[16:19], s21 offen offset:0   lds
M v[48:51],a[128:131],a[168:171],v[48:51]
M v[44:47],a[120:123],a[168:171],v[44:47]
M v[44:47],a[124:127],a[172:175],v[44:47]
buffer_load_dwordx4 v9, s[16:19], s21 offen offset:1024   lds
M v[40:43],a[116:119],a[172:175],v[40:43]
s_nop 0
T a[52:53],v3,40960
T a[54:55],v3,41984
M v[40:43],a[112:115],a[168:171],v[40:43]
M v[36:39],a[104:107],a[168:171],v[36:39]
M v[36:39],a[108:111],a[172:175],v[36:39]
s_waitcnt lgkmcnt(6)
M v[32:35],a[100:103],a[172:175],v[32:35]
buffer_load_dwordx4 v10, s[16:19], s21 offen offset:2048   lds
M v[32:35],a[96:99],a[168:171],v[32:35]
s_nop 0
T a[56:57],v4,32768
T a[58:59],v4,33792
M v[64:67],a[96:99],a[160:163],v[64:67]
R a[168:171],v5,6144
L_w_kv02:
s_cbranch_execz L_w_kv06
R a[172:175],v6,6144
M v[64:67],a[100:103],a[164:167],v[64:67]
M v[68:71],a[108:111],a[164:167],v[68:71]
buffer_load_dwordx4 v11, s[16:19], s21 offen offset:3072   lds
M v[68:71],a[104:107],a[160:163],v[68:71]
SA s21,s21,524160
M v[72:75],a[112:115],a[160:163],v[72:75]
s_nop 0
T a[60:61],v4,40960
T a[62:63],v4,41984
M v[72:75],a[116:119],a[164:167],v[72:75]
M v[76:79],a[124:127],a[164:167],v[76:79]
SA m0,s87,1024
M v[76:79],a[120:123],a[160:163],v[76:79]
buffer_load_dwordx4 v25, s[60:63], s89 offen offset:0  lds
M v[80:83],a[128:131],a[160:163],v[80:83]
SA s89,s89,114688
M v[80:83],a[132:135],a[164:167],v[80:83]
M v[84:87],a[140:143],a[164:167],v[84:87]
M v[84:87],a[136:139],a[160:163],v[84:87]
M v[88:91],a[144:147],a[160:163],v[88:91]
M v[88:91],a[148:151],a[164:167],v[88:91]
s_waitcnt lgkmcnt(2)
M v[92:95],a[156:159],a[164:167],v[92:95]
s_waitcnt vmcnt(19) lgkmcnt(0)
M v[92:95],a[152:155],a[160:163],v[92:95]
s_barrier
M v[124:127],a[152:155],a[168:171],v[124:127]
R a[160:163],v5,16384
R a[164:167],v6,16384
M v[124:127],a[156:159],a[172:175],v[124:127]
M v[120:123],a[148:151],a[172:175],v[120:123]
SA m0,s24,0
T a[64:65],v1,49152
T a[66:67],v1,50176
M v[120:123],a[144:147],a[168:171],v[120:123]
buffer_load_dwordx4 v12, s[48:51], s22 offen offset:0   lds
M v[116:119],a[136:139],a[168:171],v[116:119]
M v[116:119],a[140:143],a[172:175],v[116:119]
M v[112:115],a[132:135],a[172:175],v[112:115]
M v[112:115],a[128:131],a[168:171],v[112:115]
M v[108:111],a[120:123],a[168:171],v[108:111]
M v[108:111],a[124:127],a[172:175],v[108:111]
s_nop 0
T a[68:69],v1,57344
T a[70:71],v1,58368
M v[104:107],a[116:119],a[172:175],v[104:107]
buffer_load_dwordx4 v13, s[48:51], s22 offen offset:1024   lds
M v[104:107],a[112:115],a[168:171],v[104:107]
M v[100:103],a[104:107],a[168:171],v[100:103]
M v[100:103],a[108:111],a[172:175],v[100:103]
s_waitcnt lgkmcnt(4)
M v[96:99],a[100:103],a[172:175],v[96:99]
M v[96:99],a[96:99],a[168:171],v[96:99]
M v[128:131],a[96:99],a[160:163],v[128:131]
R a[168:171],v5,18432
R a[172:175],v6,18432
M v[128:131],a[100:103],a[164:167],v[128:131]
T a[72:73],v2,49152
T a[74:75],v2,50176
M v[132:135],a[108:111],a[164:167],v[132:135]
buffer_load_dwordx4 v14, s[48:51], s22 offen offset:2048   lds
M v[132:135],a[104:107],a[160:163],v[132:135]
M v[136:139],a[112:115],a[160:163],v[136:139]
M v[136:139],a[116:119],a[164:167],v[136:139]
M v[140:143],a[124:127],a[164:167],v[140:143]
M v[140:143],a[120:123],a[160:163],v[140:143]
s_nop 0
T a[76:77],v2,57344
T a[78:79],v2,58368
M v[144:147],a[128:131],a[160:163],v[144:147]
buffer_load_dwordx4 v15, s[48:51], s22 offen offset:3072   lds
M v[144:147],a[132:135],a[164:167],v[144:147]
SA s22,s22,1048576
M v[148:151],a[140:143],a[164:167],v[148:151]
M v[148:151],a[136:139],a[160:163],v[148:151]
M v[152:155],a[144:147],a[160:163],v[152:155]
M v[152:155],a[148:151],a[164:167],v[152:155]
s_waitcnt lgkmcnt(4)
M v[156:159],a[156:159],a[164:167],v[156:159]
SA m0,s23,32768
T a[80:81],v3,49152
T a[82:83],v3,50176
M v[156:159],a[152:155],a[160:163],v[156:159]
buffer_load_dwordx4 v8, s[16:19], s21 offen offset:0   lds
M v[188:191],a[152:155],a[168:171],v[188:191]
R a[160:163],v5,20480
R a[164:167],v6,20480
M v[188:191],a[156:159],a[172:175],v[188:191]
M v[184:187],a[148:151],a[172:175],v[184:187]
M v[184:187],a[144:147],a[168:171],v[184:187]
M v[180:183],a[136:139],a[168:171],v[180:183]
M v[180:183],a[140:143],a[172:175],v[180:183]
s_nop 0
T a[84:85],v3,57344
T a[86:87],v3,58368
M v[176:179],a[132:135],a[172:175],v[176:179]
buffer_load_dwordx4 v9, s[16:19], s21 offen offset:1024   lds
M v[176:179],a[128:131],a[168:171],v[176:179]
M v[172:175],a[120:123],a[168:171],v[172:175]
M v[172:175],a[124:127],a[172:175],v[172:175]
M v[168:171],a[116:119],a[172:175],v[168:171]
M v[168:171],a[112:115],a[168:171],v[168:171]
M v[164:167],a[104:107],a[168:171],v[164:167]
s_nop 0
T a[88:89],v4,49152
T a[90:91],v4,50176
M v[164:167],a[108:111],a[172:175],v[164:167]
s_waitcnt lgkmcnt(4)
buffer_load_dwordx4 v10, s[16:19], s21 offen offset:2048   lds
M v[160:163],a[100:103],a[172:175],v[160:163]
M v[160:163],a[96:99],a[168:171],v[160:163]
M v[192:195],a[96:99],a[160:163],v[192:195]
R a[168:171],v5,22528
R a[172:175],v6,22528
M v[192:195],a[100:103],a[164:167],v[192:195]
M v[196:199],a[108:111],a[164:167],v[196:199]
M v[196:199],a[104:107],a[160:163],v[196:199]
s_nop 0
T a[92:93],v4,57344
T a[94:95],v4,58368
M v[200:203],a[112:115],a[160:163],v[200:203]
buffer_load_dwordx4 v11, s[16:19], s21 offen offset:3072   lds
M v[200:203],a[116:119],a[164:167],v[200:203]
SA s21,s21,128
M v[204:207],a[124:127],a[164:167],v[204:207]
M v[204:207],a[120:123],a[160:163],v[204:207]
M v[208:211],a[128:131],a[160:163],v[208:211]
M v[208:211],a[132:135],a[164:167],v[208:211]
M v[212:215],a[140:143],a[164:167],v[212:215]
M v[212:215],a[136:139],a[160:163],v[212:215]
M v[216:219],a[144:147],a[160:163],v[216:219]
M v[216:219],a[148:151],a[164:167],v[216:219]
s_waitcnt lgkmcnt(2)
M v[220:223],a[156:159],a[164:167],v[220:223]
s_waitcnt vmcnt(17) lgkmcnt(0)
M v[220:223],a[152:155],a[160:163],v[220:223]
s_barrier
M v[252:255],a[152:155],a[168:171],v[252:255]
R a[160:163],v5,32768
R a[164:167],v6,32768
M v[252:255],a[156:159],a[172:175],v[252:255]
v_cmp_ne_u32 vcc, 1, v17
M v[248:251],a[148:151],a[172:175],v[248:251]
s_nop 0
M v[248:251],a[144:147],a[168:171],v[248:251]
s_cbranch_vccnz L_zs0
L_zr0:
M v[244:247],a[136:139],a[168:171],v[244:247]
M v[244:247],a[140:143],a[172:175],v[244:247]
M v[240:243],a[132:135],a[172:175],v[240:243]
M v[240:243],a[128:131],a[168:171],v[240:243]
M v[236:239],a[120:123],a[168:171],v[236:239]
M v[236:239],a[124:127],a[172:175],v[236:239]
M v[232:235],a[116:119],a[172:175],v[232:235]
M v[232:235],a[112:115],a[168:171],v[232:235]
M v[228:231],a[104:107],a[168:171],v[228:231]
M v[228:231],a[108:111],a[172:175],v[228:231]
s_waitcnt lgkmcnt(0)
M v[224:227],a[100:103],a[172:175],v[224:227]
M v[224:227],a[96:99],a[168:171],v[224:227]
M a[0:3],a[32:35],a[160:163],a[0:3]
R a[168:171],v5,34816
R a[172:175],v6,34816
M a[0:3],a[36:39],a[164:167],a[0:3]
T a[96:97],v1,0
T a[98:99],v1,1024
M a[4:7],a[44:47],a[164:167],a[4:7]
SA m0,s24,16384
M a[4:7],a[40:43],a[160:163],a[4:7]
buffer_load_dwordx4 v12, s[48:51], s22 offen offset:0   lds
M a[8:11],a[48:51],a[160:163],a[8:11]
M a[8:11],a[52:55],a[164:167],a[8:11]
s_mul_i32 s64, s41, 229376
M a[12:15],a[60:63],a[164:167],a[12:15]
SA s72,s90,s64
T a[100:101],v1,8192
T a[102:103],v1,9216
M a[12:15],a[56:59],a[160:163],a[12:15]
s_addc_u32 s73, s91, 0
buffer_load_dwordx4 v13, s[48:51], s22 offen offset:1024   lds
M a[16:19],a[64:67],a[160:163],a[16:19]
s_sub_u32 s75, 3670016, s64
M a[16:19],a[68:71],a[164:167],a[16:19]
s_mov_b32 s12, s72
M a[20:23],a[76:79],a[164:167],a[20:23]
s_and_b32 s13, s73, 0xffff
M a[20:23],a[72:75],a[160:163],a[20:23]
s_mov_b32 s14, s75
T a[104:105],v2,0
T a[106:107],v2,1024
M a[24:27],a[80:83],a[160:163],a[24:27]
s_mov_b32 s15, 0x20000
buffer_load_dwordx4 v14, s[48:51], s22 offen offset:2048   lds
M a[24:27],a[84:87],a[164:167],a[24:27]
s_waitcnt lgkmcnt(6)
M a[28:31],a[92:95],a[164:167],a[28:31]
M a[28:31],a[88:91],a[160:163],a[28:31]
M v[60:63],a[88:91],a[168:171],v[60:63]
R a[160:163],v5,36864
R a[164:167],v6,36864
M v[60:63],a[92:95],a[172:175],v[60:63]
T a[108:109],v2,8192
T a[110:111],v2,9216
M v[56:59],a[84:87],a[172:175],v[56:59]
buffer_load_dwordx4 v15, s[48:51], s22 offen offset:3072   lds
M v[56:59],a[80:83],a[168:171],v[56:59]
s_sub_u32 s22, s22, 1048448
M v[52:55],a[72:75],a[168:171],v[52:55]
SA m0,s23,49152
M v[52:55],a[76:79],a[172:175],v[52:55]
s_nop 0
T a[112:113],v3,0
T a[114:115],v3,1024
M v[48:51],a[68:71],a[172:175],v[48:51]
buffer_load_dwordx4 v8, s[16:19], s21 offen offset:0   lds
M v[48:51],a[64:67],a[168:171],v[48:51]
M v[44:47],a[56:59],a[168:171],v[44:47]
M v[44:47],a[60:63],a[172:175],v[44:47]
buffer_load_dwordx4 v9, s[16:19], s21 offen offset:1024   lds
M v[40:43],a[52:55],a[172:175],v[40:43]
s_nop 0
T a[116:117],v3,8192
T a[118:119],v3,9216
M v[40:43],a[48:51],a[168:171],v[40:43]
M v[36:39],a[40:43],a[168:171],v[36:39]
M v[36:39],a[44:47],a[172:175],v[36:39]
s_waitcnt lgkmcnt(6)
M v[32:35],a[36:39],a[172:175],v[32:35]
buffer_load_dwordx4 v10, s[16:19], s21 offen offset:2048   lds
M v[32:35],a[32:35],a[168:171],v[32:35]
s_nop 0
T a[120:121],v4,0
T a[122:123],v4,1024
M v[64:67],a[32:35],a[160:163],v[64:67]
R a[168:171],v5,38912
R a[172:175],v6,38912
M v[64:67],a[36:39],a[164:167],v[64:67]
M v[68:71],a[44:47],a[164:167],v[68:71]
buffer_load_dwordx4 v11, s[16:19], s21 offen offset:3072   lds
M v[68:71],a[40:43],a[160:163],v[68:71]
SA s21,s21,524160
M v[72:75],a[48:51],a[160:163],v[72:75]
s_nop 0
T a[124:125],v4,8192
T a[126:127],v4,9216
M v[72:75],a[52:55],a[164:167],v[72:75]
M v[76:79],a[60:63],a[164:167],v[76:79]
SA m0,s87,2048
M v[76:79],a[56:59],a[160:163],v[76:79]
buffer_load_dwordx4 v25, s[60:63], s89 offen offset:0  lds
M v[80:83],a[64:67],a[160:163],v[80:83]
SA s89,s89,114688
M v[80:83],a[68:71],a[164:167],v[80:83]
M v[84:87],a[76:79],a[164:167],v[84:87]
M v[84:87],a[72:75],a[160:163],v[84:87]
M v[88:91],a[80:83],a[160:163],v[88:91]
M v[88:91],a[84:87],a[164:167],v[88:91]
s_waitcnt lgkmcnt(2)
M v[92:95],a[92:95],a[164:167],v[92:95]
s_waitcnt vmcnt(18) lgkmcnt(0)
M v[92:95],a[88:91],a[160:163],v[92:95]
s_barrier
M v[124:127],a[88:91],a[168:171],v[124:127]
R a[160:163],v5,49152
R a[164:167],v6,49152
M v[124:127],a[92:95],a[172:175],v[124:127]
M v[120:123],a[84:87],a[172:175],v[120:123]
SA m0,s24,32768
T a[128:129],v1,16384
T a[130:131],v1,17408
M v[120:123],a[80:83],a[168:171],v[120:123]
buffer_load_dwordx4 v12, s[48:51], s22 offen offset:0   lds
M v[116:119],a[72:75],a[168:171],v[116:119]
M v[116:119],a[76:79],a[172:175],v[116:119]
M v[112:115],a[68:71],a[172:175],v[112:115]
M v[112:115],a[64:67],a[168:171],v[112:115]
M v[108:111],a[56:59],a[168:171],v[108:111]
M v[108:111],a[60:63],a[172:175],v[108:111]
s_nop 0
T a[132:133],v1,24576
T a[134:135],v1,25600
M v[104:107],a[52:55],a[172:175],v[104:107]
buffer_load_dwordx4 v13, s[48:51], s22 offen offset:1024   lds
M v[104:107],a[48:51],a[168:171],v[104:107]
M v[100:103],a[40:43],a[168:171],v[100:103]
M v[100:103],a[44:47],a[172:175],v[100:103]
s_waitcnt lgkmcnt(4)
M v[96:99],a[36:39],a[172:175],v[96:99]
M v[96:99],a[32:35],a[168:171],v[96:99]
M v[128:131],a[32:35],a[160:163],v[128:131]
R a[168:171],v5,51200
R a[172:175],v6,51200
M v[128:131],a[36:39],a[164:167],v[128:131]
T a[136:137],v2,16384
T a[138:139],v2,17408
M v[132:135],a[44:47],a[164:167],v[132:135]
buffer_load_dwordx4 v14, s[48:51], s22 offen offset:2048   lds
M v[132:135],a[40:43],a[160:163],v[132:135]
M v[136:139],a[48:51],a[160:163],v[136:139]
M v[136:139],a[52:55],a[164:167],v[136:139]
M v[140:143],a[60:63],a[164:167],v[140:143]
M v[140:143],a[56:59],a[160:163],v[140:143]
s_nop 0
T a[140:141],v2,24576
T a[142:143],v2,25600
M v[144:147],a[64:67],a[160:163],v[144:147]
buffer_load_dwordx4 v15, s[48:51], s22 offen offset:3072   lds
M v[144:147],a[68:71],a[164:167],v[144:147]
SA s22,s22,1048576
M v[148:151],a[76:79],a[164:167],v[148:151]
M v[148:151],a[72:75],a[160:163],v[148:151]
M v[152:155],a[80:83],a[160:163],v[152:155]
M v[152:155],a[84:87],a[164:167],v[152:155]
s_waitcnt lgkmcnt(4)
M v[156:159],a[92:95],a[164:167],v[156:159]
SA m0,s23,0
T a[144:145],v3,16384
T a[146:147],v3,17408
M v[156:159],a[88:91],a[160:163],v[156:159]
buffer_load_dwordx4 v8, s[16:19], s21 offen offset:0   lds
M v[188:191],a[88:91],a[168:171],v[188:191]
R a[160:163],v5,53248
R a[164:167],v6,53248
M v[188:191],a[92:95],a[172:175],v[188:191]
M v[184:187],a[84:87],a[172:175],v[184:187]
M v[184:187],a[80:83],a[168:171],v[184:187]
M v[180:183],a[72:75],a[168:171],v[180:183]
M v[180:183],a[76:79],a[172:175],v[180:183]
s_nop 0
T a[148:149],v3,24576
T a[150:151],v3,25600
M v[176:179],a[68:71],a[172:175],v[176:179]
buffer_load_dwordx4 v9, s[16:19], s21 offen offset:1024   lds
M v[176:179],a[64:67],a[168:171],v[176:179]
M v[172:175],a[56:59],a[168:171],v[172:175]
M v[172:175],a[60:63],a[172:175],v[172:175]
M v[168:171],a[52:55],a[172:175],v[168:171]
M v[168:171],a[48:51],a[168:171],v[168:171]
M v[164:167],a[40:43],a[168:171],v[164:167]
s_nop 0
T a[152:153],v4,16384
T a[154:155],v4,17408
M v[164:167],a[44:47],a[172:175],v[164:167]
s_waitcnt lgkmcnt(4)
buffer_load_dwordx4 v10, s[16:19], s21 offen offset:2048   lds
M v[160:163],a[36:39],a[172:175],v[160:163]
M v[160:163],a[32:35],a[168:171],v[160:163]
M v[192:195],a[32:35],a[160:163],v[192:195]
R a[168:171],v5,55296
R a[172:175],v6,55296
M v[192:195],a[36:39],a[164:167],v[192:195]
M v[196:199],a[44:47],a[164:167],v[196:199]
M v[196:199],a[40:43],a[160:163],v[196:199]
s_nop 0
T a[156:157],v4,24576
T a[158:159],v4,25600
M v[200:203],a[48:51],a[160:163],v[200:203]
buffer_load_dwordx4 v11, s[16:19], s21 offen offset:3072   lds
M v[200:203],a[52:55],a[164:167],v[200:203]
SA s21,s21,128
M v[204:207],a[60:63],a[164:167],v[204:207]
M v[204:207],a[56:59],a[160:163],v[204:207]
M v[208:211],a[64:67],a[160:163],v[208:211]
M v[208:211],a[68:71],a[164:167],v[208:211]
M v[212:215],a[76:79],a[164:167],v[212:215]
M v[212:215],a[72:75],a[160:163],v[212:215]
M v[216:219],a[80:83],a[160:163],v[216:219]
M v[216:219],a[84:87],a[164:167],v[216:219]
s_waitcnt lgkmcnt(2)
M v[220:223],a[92:95],a[164:167],v[220:223]
s_waitcnt vmcnt(17) lgkmcnt(0)
M v[220:223],a[88:91],a[160:163],v[220:223]
s_barrier
M v[252:255],a[88:91],a[168:171],v[252:255]
R a[160:163],v5,0
R a[164:167],v6,0
M v[252:255],a[92:95],a[172:175],v[252:255]
M v[248:251],a[84:87],a[172:175],v[248:251]
M v[248:251],a[80:83],a[168:171],v[248:251]
M v[244:247],a[72:75],a[168:171],v[244:247]
M v[244:247],a[76:79],a[172:175],v[244:247]
M v[240:243],a[68:71],a[172:175],v[240:243]
M v[240:243],a[64:67],a[168:171],v[240:243]
M v[236:239],a[56:59],a[168:171],v[236:239]
M v[236:239],a[60:63],a[172:175],v[236:239]
M v[232:235],a[52:55],a[172:175],v[232:235]
M v[232:235],a[48:51],a[168:171],v[232:235]
M v[228:231],a[40:43],a[168:171],v[228:231]
M v[228:231],a[44:47],a[172:175],v[228:231]
s_waitcnt lgkmcnt(0)
M v[224:227],a[36:39],a[172:175],v[224:227]
M v[224:227],a[32:35],a[168:171],v[224:227]
M a[0:3],a[96:99],a[160:163],a[0:3]
R a[168:171],v5,2048
R a[172:175],v6,2048
M a[0:3],a[100:103],a[164:167],a[0:3]
T a[32:33],v1,32768
T a[34:35],v1,33792
M a[4:7],a[108:111],a[164:167],a[4:7]
SA m0,s24,49152
M a[4:7],a[104:107],a[160:163],a[4:7]
buffer_load_dwordx4 v12, s[48:51], s22 offen offset:0   lds
M a[8:11],a[112:115],a[160:163],a[8:11]
M a[8:11],a[116:119],a[164:167],a[8:11]
M a[12:15],a[124:127],a[164:167],a[12:15]
s_nop 0
T a[36:37],v1,40960
T a[38:39],v1,41984
M a[12:15],a[120:123],a[160:163],a[12:15]
buffer_load_dwordx4 v13, s[48:51], s22 offen offset:1024   lds
M a[16:19],a[128:131],a[160:163],a[16:19]
M a[16:19],a[132:135],a[164:167],a[16:19]
M a[20:23],a[140:143],a[164:167],a[20:23]
M a[20:23],a[136:139],a[160:163],a[20:23]
s_nop 0
T a[40:41],v2,32768
T a[42:43],v2,33792
M a[24:27],a[144:147],a[160:163],a[24:27]
buffer_load_dwordx4 v14, s[48:51], s22 offen offset:2048   lds
M a[24:27],a[148:151],a[164:167],a[24:27]
s_waitcnt lgkmcnt(6)
M a[28:31],a[156:159],a[164:167],a[28:31]
M a[28:31],a[152:155],a[160:163],a[28:31]
M v[60:63],a[152:155],a[168:171],v[60:63]
R a[160:163],v5,4096
R a[164:167],v6,4096
M v[60:63],a[156:159],a[172:175],v[60:63]
T a[44:45],v2,40960
T a[46:47],v2,41984
M v[56:59],a[148:151],a[172:175],v[56:59]
buffer_load_dwordx4 v15, s[48:51], s22 offen offset:3072   lds
M v[56:59],a[144:147],a[168:171],v[56:59]
s_sub_u32 s22, s22, 1048448
M v[52:55],a[136:139],a[168:171],v[52:55]
SA m0,s23,16384
M v[52:55],a[140:143],a[172:175],v[52:55]
s_nop 0
T a[48:49],v3,32768
T a[50:51],v3,33792
M v[48:51],a[132:135],a[172:175],v[48:51]
buffer_load_dwordx4 v8, s[16:19], s21 offen offset:0   lds
M v[48:51],a[128:131],a[168:171],v[48:51]
M v[44:47],a[120:123],a[168:171],v[44:47]
M v[44:47],a[124:127],a[172:175],v[44:47]
buffer_load_dwordx4 v9, s[16:19], s21 offen offset:1024   lds
M v[40:43],a[116:119],a[172:175],v[40:43]
s_nop 0
T a[52:53],v3,40960
T a[54:55],v3,41984
M v[40:43],a[112:115],a[168:171],v[40:43]
M v[36:39],a[104:107],a[168:171],v[36:39]
M v[36:39],a[108:111],a[172:175],v[36:39]
s_waitcnt lgkmcnt(6)
M v[32:35],a[100:103],a[172:175],v[32:35]
buffer_load_dwordx4 v10, s[16:19], s21 offen offset:2048   lds
M v[32:35],a[96:99],a[168:171],v[32:35]
s_nop 0
T a[56:57],v4,32768
T a[58:59],v4,33792
M v[64:67],a[96:99],a[160:163],v[64:67]
R a[168:171],v5,6144
R a[172:175],v6,6144
M v[64:67],a[100:103],a[164:167],v[64:67]
M v[68:71],a[108:111],a[164:167],v[68:71]
buffer_load_dwordx4 v11, s[16:19], s21 offen offset:3072   lds
M v[68:71],a[104:107],a[160:163],v[68:71]
SA s21,s21,524160
M v[72:75],a[112:115],a[160:163],v[72:75]
s_nop 0
T a[60:61],v4,40960
T a[62:63],v4,41984
M v[72:75],a[116:119],a[164:167],v[72:75]
M v[76:79],a[124:127],a[164:167],v[76:79]
SA m0,s87,3072
M v[76:79],a[120:123],a[160:163],v[76:79]
buffer_load_dwordx4 v25, s[60:63], s89 offen offset:0  lds
M v[80:83],a[128:131],a[160:163],v[80:83]
SA s89,s89,114688
M v[80:83],a[132:135],a[164:167],v[80:83]
M v[84:87],a[140:143],a[164:167],v[84:87]
M v[84:87],a[136:139],a[160:163],v[84:87]
M v[88:91],a[144:147],a[160:163],v[88:91]
M v[88:91],a[148:151],a[164:167],v[88:91]
s_waitcnt lgkmcnt(2)
M v[92:95],a[156:159],a[164:167],v[92:95]
s_waitcnt vmcnt(18) lgkmcnt(0)
M v[92:95],a[152:155],a[160:163],v[92:95]
s_barrier
M v[124:127],a[152:155],a[168:171],v[124:127]
R a[160:163],v5,16384
R a[164:167],v6,16384
M v[124:127],a[156:159],a[172:175],v[124:127]
M v[120:123],a[148:151],a[172:175],v[120:123]
SA m0,s24,0
T a[64:65],v1,49152
T a[66:67],v1,50176
M v[120:123],a[144:147],a[168:171],v[120:123]
buffer_load_dwordx4 v12, s[48:51], s22 offen offset:0   lds
M v[116:119],a[136:139],a[168:171],v[116:119]
M v[116:119],a[140:143],a[172:175],v[116:119]
M v[112:115],a[132:135],a[172:175],v[112:115]
M v[112:115],a[128:131],a[168:171],v[112:115]
M v[108:111],a[120:123],a[168:171],v[108:111]
M v[108:111],a[124:127],a[172:175],v[108:111]
s_nop 0
T a[68:69],v1,57344
T a[70:71],v1,58368
M v[104:107],a[116:119],a[172:175],v[104:107]
buffer_load_dwordx4 v13, s[48:51], s22 offen offset:1024   lds
M v[104:107],a[112:115],a[168:171],v[104:107]
M v[100:103],a[104:107],a[168:171],v[100:103]
M v[100:103],a[108:111],a[172:175],v[100:103]
s_waitcnt lgkmcnt(4)
M v[96:99],a[100:103],a[172:175],v[96:99]
M v[96:99],a[96:99],a[168:171],v[96:99]
M v[128:131],a[96:99],a[160:163],v[128:131]
R a[168:171],v5,18432
R a[172:175],v6,18432
M v[128:131],a[100:103],a[164:167],v[128:131]
s_lshl_b32 s67, s20, 11
T a[72:73],v2,49152
T a[74:75],v2,50176
M v[132:135],a[108:111],a[164:167],v[132:135]
SA s67,s67,104914944
buffer_load_dwordx4 v14, s[48:51], s22 offen offset:2048   lds
M v[132:135],a[104:107],a[160:163],v[132:135]
M v[136:139],a[112:115],a[160:163],v[136:139]
M v[136:139],a[116:119],a[164:167],v[136:139]
buffer_load_dwordx4 v[16:19], v7, s[8:11], s67 offen offset:0 sc1
M v[140:143],a[124:127],a[164:167],v[140:143]
M v[140:143],a[120:123],a[160:163],v[140:143]
s_nop 0
T a[76:77],v2,57344
T a[78:79],v2,58368
M v[144:147],a[128:131],a[160:163],v[144:147]
buffer_load_dwordx4 v15, s[48:51], s22 offen offset:3072   lds
M v[144:147],a[132:135],a[164:167],v[144:147]
SA s22,s22,1048576
M v[148:151],a[140:143],a[164:167],v[148:151]
buffer_load_dwordx4 v[20:23], v7, s[8:11], s67 offen offset:1024 sc1
M v[148:151],a[136:139],a[160:163],v[148:151]
M v[152:155],a[144:147],a[160:163],v[152:155]
L_w_kv03:
s_cbranch_execz L_w_kv07
M v[152:155],a[148:151],a[164:167],v[152:155]
s_waitcnt lgkmcnt(4)
M v[156:159],a[156:159],a[164:167],v[156:159]
SA m0,s23,32768
T a[80:81],v3,49152
T a[82:83],v3,50176
M v[156:159],a[152:155],a[160:163],v[156:159]
buffer_load_dwordx4 v8, s[16:19], s21 offen offset:0   lds
M v[188:191],a[152:155],a[168:171],v[188:191]
R a[160:163],v5,20480
R a[164:167],v6,20480
M v[188:191],a[156:159],a[172:175],v[188:191]
M v[184:187],a[148:151],a[172:175],v[184:187]
M v[184:187],a[144:147],a[168:171],v[184:187]
M v[180:183],a[136:139],a[168:171],v[180:183]
M v[180:183],a[140:143],a[172:175],v[180:183]
s_nop 0
T a[84:85],v3,57344
T a[86:87],v3,58368
M v[176:179],a[132:135],a[172:175],v[176:179]
buffer_load_dwordx4 v9, s[16:19], s21 offen offset:1024   lds
M v[176:179],a[128:131],a[168:171],v[176:179]
M v[172:175],a[120:123],a[168:171],v[172:175]
M v[172:175],a[124:127],a[172:175],v[172:175]
M v[168:171],a[116:119],a[172:175],v[168:171]
M v[168:171],a[112:115],a[168:171],v[168:171]
M v[164:167],a[104:107],a[168:171],v[164:167]
s_nop 0
T a[88:89],v4,49152
T a[90:91],v4,50176
M v[164:167],a[108:111],a[172:175],v[164:167]
s_waitcnt lgkmcnt(4)
buffer_load_dwordx4 v10, s[16:19], s21 offen offset:2048   lds
M v[160:163],a[100:103],a[172:175],v[160:163]
M v[160:163],a[96:99],a[168:171],v[160:163]
M v[192:195],a[96:99],a[160:163],v[192:195]
R a[168:171],v5,22528
R a[172:175],v6,22528
M v[192:195],a[100:103],a[164:167],v[192:195]
M v[196:199],a[108:111],a[164:167],v[196:199]
M v[196:199],a[104:107],a[160:163],v[196:199]
s_nop 0
T a[92:93],v4,57344
T a[94:95],v4,58368
M v[200:203],a[112:115],a[160:163],v[200:203]
buffer_load_dwordx4 v11, s[16:19], s21 offen offset:3072   lds
M v[200:203],a[116:119],a[164:167],v[200:203]
SA s21,s21,128
M v[204:207],a[124:127],a[164:167],v[204:207]
M v[204:207],a[120:123],a[160:163],v[204:207]
M v[208:211],a[128:131],a[160:163],v[208:211]
M v[208:211],a[132:135],a[164:167],v[208:211]
M v[212:215],a[140:143],a[164:167],v[212:215]
M v[212:215],a[136:139],a[160:163],v[212:215]
M v[216:219],a[144:147],a[160:163],v[216:219]
M v[216:219],a[148:151],a[164:167],v[216:219]
s_waitcnt lgkmcnt(2)
M v[220:223],a[156:159],a[164:167],v[220:223]
s_waitcnt vmcnt(19) lgkmcnt(0)
M v[220:223],a[152:155],a[160:163],v[220:223]
s_barrier
M v[252:255],a[152:155],a[168:171],v[252:255]
R a[160:163],v5,32768
R a[164:167],v6,32768
M v[252:255],a[156:159],a[172:175],v[252:255]
M v[248:251],a[148:151],a[172:175],v[248:251]
M v[248:251],a[144:147],a[168:171],v[248:251]
M v[244:247],a[136:139],a[168:171],v[244:247]
M v[244:247],a[140:143],a[172:175],v[244:247]
M v[240:243],a[132:135],a[172:175],v[240:243]
M v[240:243],a[128:131],a[168:171],v[240:243]
M v[236:239],a[120:123],a[168:171],v[236:239]
M v[236:239],a[124:127],a[172:175],v[236:239]
M v[232:235],a[116:119],a[172:175],v[232:235]
M v[232:235],a[112:115],a[168:171],v[232:235]
M v[228:231],a[104:107],a[168:171],v[228:231]
M v[228:231],a[108:111],a[172:175],v[228:231]
s_waitcnt lgkmcnt(0)
M v[224:227],a[100:103],a[172:175],v[224:227]
M v[224:227],a[96:99],a[168:171],v[224:227]
M a[0:3],a[32:35],a[160:163],a[0:3]
R a[168:171],v5,34816
R a[172:175],v6,34816
M a[0:3],a[36:39],a[164:167],a[0:3]
T a[96:97],v1,0
T a[98:99],v1,1024
M a[4:7],a[44:47],a[164:167],a[4:7]
SA m0,s24,16384
M a[4:7],a[40:43],a[160:163],a[4:7]
buffer_load_dwordx4 v12, s[48:51], s22 offen offset:0   lds
M a[8:11],a[48:51],a[160:163],a[8:11]
M a[8:11],a[52:55],a[164:167],a[8:11]
M a[12:15],a[60:63],a[164:167],a[12:15]
s_nop 0
T a[100:101],v1,8192
T a[102:103],v1,9216
M a[12:15],a[56:59],a[160:163],a[12:15]
buffer_load_dwordx4 v13, s[48:51], s22 offen offset:1024   lds
M a[16:19],a[64:67],a[160:163],a[16:19]
M a[16:19],a[68:71],a[164:167],a[16:19]
M a[20:23],a[76:79],a[164:167],a[20:23]
s_waitcnt vmcnt(8)
v_min3_u32 v28, v16, v17, v18
M a[20:23],a[72:75],a[160:163],a[20:23]
s_nop 0
T a[104:105],v2,0
T a[106:107],v2,1024
M a[24:27],a[80:83],a[160:163],a[24:27]
buffer_load_dwordx4 v14, s[48:51], s22 offen offset:2048   lds
M a[24:27],a[84:87],a[164:167],a[24:27]
s_waitcnt lgkmcnt(6)
s_waitcnt vmcnt(7)
v_min3_u32 v28, v28, v19, v20
M a[28:31],a[92:95],a[164:167],a[28:31]
v_min3_u32 v28, v28, v21, v22
M a[28:31],a[88:91],a[160:163],a[28:31]
v_min_u32 v28, v28, v23
M v[60:63],a[88:91],a[168:171],v[60:63]
R a[160:163],v5,36864
R a[164:167],v6,36864
M v[60:63],a[92:95],a[172:175],v[60:63]
T a[108:109],v2,8192
T a[110:111],v2,9216
M v[56:59],a[84:87],a[172:175],v[56:59]
buffer_load_dwordx4 v15, s[48:51], s22 offen offset:3072   lds
M v[56:59],a[80:83],a[168:171],v[56:59]
s_sub_u32 s22, s22, 1048448
v_cmp_eq_u32 vcc, 0, v28
M v[52:55],a[72:75],a[168:171],v[52:55]
SA m0,s23,49152
s_nop 0
M v[52:55],a[76:79],a[172:175],v[52:55]
s_cbranch_vccnz L_hs
L_hr:
T a[112:113],v3,0
T a[114:115],v3,1024
M v[48:51],a[68:71],a[172:175],v[48:51]
buffer_load_dwordx4 v8, s[16:19], s21 offen offset:0   lds
M v[48:51],a[64:67],a[168:171],v[48:51]
v_max_u32 v28, v16, v17
M v[44:47],a[56:59],a[168:171],v[44:47]
v_min_u32 v29, v16, v17
M v[44:47],a[60:63],a[172:175],v[44:47]
buffer_load_dwordx4 v9, s[16:19], s21 offen offset:1024   lds
M v[40:43],a[52:55],a[172:175],v[40:43]
s_nop 0
T a[116:117],v3,8192
T a[118:119],v3,9216
M v[40:43],a[48:51],a[168:171],v[40:43]
v_med3_u32 v29, v28, v29, v18
M v[36:39],a[40:43],a[168:171],v[36:39]
v_max_u32 v28, v28, v18
M v[36:39],a[44:47],a[172:175],v[36:39]
s_waitcnt lgkmcnt(6)
v_med3_u32 v29, v28, v29, v19
M v[32:35],a[36:39],a[172:175],v[32:35]
buffer_load_dwordx4 v10, s[16:19], s21 offen offset:2048   lds
M v[32:35],a[32:35],a[168:171],v[32:35]
s_nop 0
T a[120:121],v4,0
T a[122:123],v4,1024
M v[64:67],a[32:35],a[160:163],v[64:67]
R a[168:171],v5,38912
R a[172:175],v6,38912
M v[64:67],a[36:39],a[164:167],v[64:67]
v_max_u32 v28, v28, v19
M v[68:71],a[44:47],a[164:167],v[68:71]
buffer_load_dwordx4 v11, s[16:19], s21 offen offset:3072   lds
M v[68:71],a[40:43],a[160:163],v[68:71]
SA s21,s21,524160
v_med3_u32 v29, v28, v29, v20
M v[72:75],a[48:51],a[160:163],v[72:75]
s_nop 0
T a[124:125],v4,8192
T a[126:127],v4,9216
M v[72:75],a[52:55],a[164:167],v[72:75]
v_max_u32 v28, v28, v20
M v[76:79],a[60:63],a[164:167],v[76:79]
SA m0,s87,4096
v_med3_u32 v29, v28, v29, v21
M v[76:79],a[56:59],a[160:163],v[76:79]
buffer_load_dwordx4 v25, s[60:63], s89 offen offset:0  lds
M v[80:83],a[64:67],a[160:163],v[80:83]
SA s89,s89,114688
v_max_u32 v28, v28, v21
M v[80:83],a[68:71],a[164:167],v[80:83]
v_med3_u32 v29, v28, v29, v22
M v[84:87],a[76:79],a[164:167],v[84:87]
v_max_u32 v28, v28, v22
M v[84:87],a[72:75],a[160:163],v[84:87]
v_med3_u32 v29, v28, v29, v23
M v[88:91],a[80:83],a[160:163],v[88:91]
v_max_u32 v28, v28, v23
M v[88:91],a[84:87],a[164:167],v[88:91]
s_waitcnt lgkmcnt(2)
v_mov_b32 v30, v28 row_ror:8 row_mask:0xf bank_mask:0xf
M v[92:95],a[92:95],a[164:167],v[92:95]
s_waitcnt lgkmcnt(0)
v_mov_b32 v31, v29 row_ror:8 row_mask:0xf bank_mask:0xf
M v[92:95],a[88:91],a[160:163],v[92:95]
s_barrier
M v[124:127],a[88:91],a[168:171],v[124:127]
R a[160:163],v5,49152
R a[164:167],v6,49152
M v[124:127],a[92:95],a[172:175],v[124:127]
v_min_u32 v16, v28, v30
M v[120:123],a[84:87],a[172:175],v[120:123]
SA m0,s24,32768
T a[128:129],v1,16384
T a[130:131],v1,17408
M v[120:123],a[80:83],a[168:171],v[120:123]
buffer_load_dwordx4 v12, s[48:51], s22 offen offset:0   lds
M v[116:119],a[72:75],a[168:171],v[116:119]
v_max_u32 v28, v28, v30
M v[116:119],a[76:79],a[172:175],v[116:119]
v_max3_u32 v29, v29, v31, v16
M v[112:115],a[68:71],a[172:175],v[112:115]
v_mov_b32 v30, v28 row_ror:4 row_mask:0xf bank_mask:0xf
M v[112:115],a[64:67],a[168:171],v[112:115]
v_mov_b32 v31, v29 row_ror:4 row_mask:0xf bank_mask:0xf
M v[108:111],a[56:59],a[168:171],v[108:111]
v_min_u32 v16, v28, v30
M v[108:111],a[60:63],a[172:175],v[108:111]
s_nop 0
T a[132:133],v1,24576
T a[134:135],v1,25600
M v[104:107],a[52:55],a[172:175],v[104:107]
buffer_load_dwordx4 v13, s[48:51], s22 offen offset:1024   lds
M v[104:107],a[48:51],a[168:171],v[104:107]
v_max_u32 v28, v28, v30
M v[100:103],a[40:43],a[168:171],v[100:103]
v_max3_u32 v29, v29, v31, v16
M v[100:103],a[44:47],a[172:175],v[100:103]
s_waitcnt lgkmcnt(4)
v_mov_b32 v30, v28 row_ror:2 row_mask:0xf bank_mask:0xf
M v[96:99],a[36:39],a[172:175],v[96:99]
v_mov_b32 v31, v29 row_ror:2 row_mask:0xf bank_mask:0xf
M v[96:99],a[32:35],a[168:171],v[96:99]
v_min_u32 v16, v28, v30
M v[128:131],a[32:35],a[160:163],v[128:131]
R a[168:171],v5,51200
R a[172:175],v6,51200
M v[128:131],a[36:39],a[164:167],v[128:131]
T a[136:137],v2,16384
T a[138:139],v2,17408
M v[132:135],a[44:47],a[164:167],v[132:135]
buffer_load_dwordx4 v14, s[48:51], s22 offen offset:2048   lds
M v[132:135],a[40:43],a[160:163],v[132:135]
v_max_u32 v28, v28, v30
M v[136:139],a[48:51],a[160:163],v[136:139]
v_max3_u32 v29, v29, v31, v16
M v[136:139],a[52:55],a[164:167],v[136:139]
v_mov_b32 v30, v28 row_ror:1 row_mask:0xf bank_mask:0xf
M v[140:143],a[60:63],a[164:167],v[140:143]
v_mov_b32 v31, v29 row_ror:1 row_mask:0xf bank_mask:0xf
M v[140:143],a[56:59],a[160:163],v[140:143]
s_nop 0
T a[140:141],v2,24576
T a[142:143],v2,25600
M v[144:147],a[64:67],a[160:163],v[144:147]
buffer_load_dwordx4 v15, s[48:51], s22 offen offset:3072   lds
M v[144:147],a[68:71],a[164:167],v[144:147]
SA s22,s22,1048576
v_min_u32 v16, v28, v30
M v[148:151],a[76:79],a[164:167],v[148:151]
v_max_u32 v28, v28, v30
M v[148:151],a[72:75],a[160:163],v[148:151]
v_max3_u32 v29, v29, v31, v16
M v[152:155],a[80:83],a[160:163],v[152:155]
v_mov_b32 v30, v28
M v[152:155],a[84:87],a[164:167],v[152:155]
s_waitcnt lgkmcnt(4)
v_mov_b32 v31, v29
M v[156:159],a[92:95],a[164:167],v[156:159]
SA m0,s23,0
T a[144:145],v3,16384
T a[146:147],v3,17408
M v[156:159],a[88:91],a[160:163],v[156:159]
buffer_load_dwordx4 v8, s[16:19], s21 offen offset:0   lds
M v[188:191],a[88:91],a[168:171],v[188:191]
R a[160:163],v5,53248
R a[164:167],v6,53248
M v[188:191],a[92:95],a[172:175],v[188:191]
v_permlane16_swap_b32 v30, v28
M v[184:187],a[84:87],a[172:175],v[184:187]
v_permlane16_swap_b32 v31, v29
M v[184:187],a[80:83],a[168:171],v[184:187]
v_min_u32 v16, v28, v30
M v[180:183],a[72:75],a[168:171],v[180:183]
v_max_u32 v28, v28, v30
M v[180:183],a[76:79],a[172:175],v[180:183]
s_nop 0
T a[148:149],v3,24576
T a[150:151],v3,25600
M v[176:179],a[68:71],a[172:175],v[176:179]
buffer_load_dwordx4 v9, s[16:19], s21 offen offset:1024   lds
M v[176:179],a[64:67],a[168:171],v[176:179]
v_max3_u32 v29, v29, v31, v16
M v[172:175],a[56:59],a[168:171],v[172:175]
v_mov_b32 v30, v28
M v[172:175],a[60:63],a[172:175],v[172:175]
v_mov_b32 v31, v29
M v[168:171],a[52:55],a[172:175],v[168:171]
v_permlane32_swap_b32 v30, v28
M v[168:171],a[48:51],a[168:171],v[168:171]
v_permlane32_swap_b32 v31, v29
M v[164:167],a[40:43],a[168:171],v[164:167]
s_nop 0
T a[152:153],v4,16384
T a[154:155],v4,17408
M v[164:167],a[44:47],a[172:175],v[164:167]
s_waitcnt lgkmcnt(4)
buffer_load_dwordx4 v10, s[16:19], s21 offen offset:2048   lds
M v[160:163],a[36:39],a[172:175],v[160:163]
v_min_u32 v16, v28, v30
M v[160:163],a[32:35],a[168:171],v[160:163]
v_max_u32 v28, v28, v30
M v[192:195],a[32:35],a[160:163],v[192:195]
R a[168:171],v5,55296
R a[172:175],v6,55296
M v[192:195],a[36:39],a[164:167],v[192:195]
v_max3_u32 v29, v29, v31, v16
M v[196:199],a[44:47],a[164:167],v[196:199]
s_lshl_b32 s64, s20, 3
M v[196:199],a[40:43],a[160:163],v[196:199]
SA s64,s64,159744
T a[156:157],v4,24576
T a[158:159],v4,25600
M v[200:203],a[48:51],a[160:163],v[200:203]
buffer_load_dwordx4 v11, s[16:19], s21 offen offset:3072   lds
M v[200:203],a[52:55],a[164:167],v[200:203]
SA s21,s21,128
v_mov_b32 v16, s64
M v[204:207],a[60:63],a[164:167],v[204:207]
ds_write_b64 v16, v[28:29]
M v[204:207],a[56:59],a[160:163],v[204:207]
M v[208:211],a[64:67],a[160:163],v[208:211]
M v[208:211],a[68:71],a[164:167],v[208:211]
M v[212:215],a[76:79],a[164:167],v[212:215]
M v[212:215],a[72:75],a[160:163],v[212:215]
M v[216:219],a[80:83],a[160:163],v[216:219]
M v[216:219],a[84:87],a[164:167],v[216:219]
s_waitcnt lgkmcnt(3)
M v[220:223],a[92:95],a[164:167],v[220:223]
s_waitcnt vmcnt(17) lgkmcnt(0)
M v[220:223],a[88:91],a[160:163],v[220:223]
s_barrier
M v[252:255],a[88:91],a[168:171],v[252:255]
R a[160:163],v5,0
R a[164:167],v6,0
M v[252:255],a[92:95],a[172:175],v[252:255]
M v[248:251],a[84:87],a[172:175],v[248:251]
M v[248:251],a[80:83],a[168:171],v[248:251]
M v[244:247],a[72:75],a[168:171],v[244:247]
M v[244:247],a[76:79],a[172:175],v[244:247]
M v[240:243],a[68:71],a[172:175],v[240:243]
M v[240:243],a[64:67],a[168:171],v[240:243]
M v[236:239],a[56:59],a[168:171],v[236:239]
M v[236:239],a[60:63],a[172:175],v[236:239]
M v[232:235],a[52:55],a[172:175],v[232:235]
M v[232:235],a[48:51],a[168:171],v[232:235]
M v[228:231],a[40:43],a[168:171],v[228:231]
M v[228:231],a[44:47],a[172:175],v[228:231]
s_waitcnt lgkmcnt(0)
M v[224:227],a[36:39],a[172:175],v[224:227]
M v[224:227],a[32:35],a[168:171],v[224:227]
M a[0:3],a[96:99],a[160:163],a[0:3]
R a[168:171],v5,2048
R a[172:175],v6,2048
M a[0:3],a[100:103],a[164:167],a[0:3]
T a[32:33],v1,32768
T a[34:35],v1,33792
M a[4:7],a[108:111],a[164:167],a[4:7]
SA m0,s24,49152
M a[4:7],a[104:107],a[160:163],a[4:7]
buffer_load_dwordx4 v12, s[48:51], s22 offen offset:0   lds
M a[8:11],a[112:115],a[160:163],a[8:11]
v_mov_b32 v28, 159744
M a[8:11],a[116:119],a[164:167],a[8:11]
ds_read_b128 v[16:19], v28
M a[12:15],a[124:127],a[164:167],a[12:15]
s_nop 0
T a[36:37],v1,40960
T a[38:39],v1,41984
M a[12:15],a[120:123],a[160:163],a[12:15]
buffer_load_dwordx4 v13, s[48:51], s22 offen offset:1024   lds
M a[16:19],a[128:131],a[160:163],a[16:19]
R v[20:23],v28,16
M a[16:19],a[132:135],a[164:167],a[16:19]
M a[20:23],a[140:143],a[164:167],a[20:23]
M a[20:23],a[136:139],a[160:163],a[20:23]
s_nop 0
T a[40:41],v2,32768
T a[42:43],v2,33792
M a[24:27],a[144:147],a[160:163],a[24:27]
buffer_load_dwordx4 v14, s[48:51], s22 offen offset:2048   lds
M a[24:27],a[148:151],a[164:167],a[24:27]
s_waitcnt lgkmcnt(8)
M a[28:31],a[156:159],a[164:167],a[28:31]
M a[28:31],a[152:155],a[160:163],a[28:31]
M v[60:63],a[152:155],a[168:171],v[60:63]
R a[160:163],v5,4096
R a[164:167],v6,4096
M v[60:63],a[156:159],a[172:175],v[60:63]
T a[44:45],v2,40960
T a[46:47],v2,41984
M v[56:59],a[148:151],a[172:175],v[56:59]
buffer_load_dwordx4 v15, s[48:51], s22 offen offset:3072   lds
M v[56:59],a[144:147],a[168:171],v[56:59]
s_sub_u32 s22, s22, 1048448
s_waitcnt lgkmcnt(9)
v_min_u32 v28, v16, v18
M v[52:55],a[136:139],a[168:171],v[52:55]
SA m0,s23,16384
v_max_u32 v16, v16, v18
M v[52:55],a[140:143],a[172:175],v[52:55]
s_nop 0
T a[48:49],v3,32768
T a[50:51],v3,33792
M v[48:51],a[132:135],a[172:175],v[48:51]
buffer_load_dwordx4 v8, s[16:19], s21 offen offset:0   lds
M v[48:51],a[128:131],a[168:171],v[48:51]
v_max3_u32 v17, v17, v19, v28
M v[44:47],a[120:123],a[168:171],v[44:47]
s_waitcnt lgkmcnt(8)
v_min_u32 v29, v20, v22
M v[44:47],a[124:127],a[172:175],v[44:47]
buffer_load_dwordx4 v9, s[16:19], s21 offen offset:1024   lds
M v[40:43],a[116:119],a[172:175],v[40:43]
s_nop 0
T a[52:53],v3,40960
T a[54:55],v3,41984
M v[40:43],a[112:115],a[168:171],v[40:43]
v_max_u32 v20, v20, v22
M v[36:39],a[104:107],a[168:171],v[36:39]
v_max3_u32 v21, v21, v23, v29
M v[36:39],a[108:111],a[172:175],v[36:39]
s_waitcnt lgkmcnt(6)
v_min_u32 v28, v16, v20
M v[32:35],a[100:103],a[172:175],v[32:35]
buffer_load_dwordx4 v10, s[16:19], s21 offen offset:2048   lds
M v[32:35],a[96:99],a[168:171],v[32:35]
s_nop 0
T a[56:57],v4,32768
T a[58:59],v4,33792
M v[64:67],a[96:99],a[160:163],v[64:67]
R a[168:171],v5,6144
R a[172:175],v6,6144
M v[64:67],a[100:103],a[164:167],v[64:67]
v_max_u32 v16, v16, v20
M v[68:71],a[108:111],a[164:167],v[68:71]
buffer_load_dwordx4 v11, s[16:19], s21 offen offset:3072   lds
M v[68:71],a[104:107],a[160:163],v[68:71]
SA s21,s21,524160
v_max3_u32 v17, v17, v21, v28
M v[72:75],a[112:115],a[160:163],v[72:75]
s_nop 0
T a[60:61],v4,40960
T a[62:63],v4,41984
M v[72:75],a[116:119],a[164:167],v[72:75]
v_and_b32 v28, 1, v0
M v[76:79],a[124:127],a[164:167],v[76:79]
SA m0,s87,5120
v_cmp_eq_u32 vcc, 0, v28
M v[76:79],a[120:123],a[160:163],v[76:79]
s_and_b32 s64, s20, 1
buffer_load_dwordx4 v25, s[60:63], s89 offen offset:0  lds
M v[80:83],a[128:131],a[160:163],v[80:83]
SA s89,s89,114688
s_mul_i32 s64, s64, 448
v_cndmask_b32 v24, v17, v16, vcc
M v[80:83],a[132:135],a[164:167],v[80:83]
v_and_b32 v24, 0x7ff, v24
M v[84:87],a[140:143],a[164:167],v[84:87]
v_sub_u32 v24, 2047, v24
M v[84:87],a[136:139],a[160:163],v[84:87]
v_mul_u32_u24 v28, 896, v24
M v[88:91],a[144:147],a[160:163],v[88:91]
v_lshrrev_b32 v29, 4, v0
M v[88:91],a[148:151],a[164:167],v[88:91]
s_waitcnt lgkmcnt(2)
v_lshl_add_u32 v28, v29, 4, v28
M v[92:95],a[156:159],a[164:167],v[92:95]
s_waitcnt vmcnt(18) lgkmcnt(0)
v_bfe_u32 v30, v0, 1, 3
M v[92:95],a[152:155],a[160:163],v[92:95]
s_barrier
M v[124:127],a[152:155],a[168:171],v[124:127]
R a[160:163],v5,16384
R a[164:167],v6,16384
M v[124:127],a[156:159],a[172:175],v[124:127]
v_lshl_or_b32 v28, v30, 26, v28
M v[120:123],a[148:151],a[172:175],v[120:123]
SA m0,s24,0
T a[64:65],v1,49152
T a[66:67],v1,50176
M v[120:123],a[144:147],a[168:171],v[120:123]
buffer_load_dwordx4 v12, s[48:51], s22 offen offset:0   lds
M v[116:119],a[136:139],a[168:171],v[116:119]
M v[116:119],a[140:143],a[172:175],v[116:119]
M v[112:115],a[132:135],a[172:175],v[112:115]
buffer_load_dwordx4 a[208:211], v28, s[56:59], s64 offen offset:0
M v[112:115],a[128:131],a[168:171],v[112:115]
M v[108:111],a[120:123],a[168:171],v[108:111]
buffer_load_dwordx4 a[212:215], v28, s[56:59], s64 offen offset:64
M v[108:111],a[124:127],a[172:175],v[108:111]
s_nop 0
T a[68:69],v1,57344
T a[70:71],v1,58368
M v[104:107],a[116:119],a[172:175],v[104:107]
buffer_load_dwordx4 v13, s[48:51], s22 offen offset:1024   lds
M v[104:107],a[112:115],a[168:171],v[104:107]
M v[100:103],a[104:107],a[168:171],v[100:103]
buffer_load_dwordx4 a[216:219], v28, s[56:59], s64 offen offset:128
M v[100:103],a[108:111],a[172:175],v[100:103]
s_waitcnt lgkmcnt(4)
M v[96:99],a[100:103],a[172:175],v[96:99]
M v[96:99],a[96:99],a[168:171],v[96:99]
buffer_load_dwordx4 v14, s[48:51], s22 offen offset:2048   lds
M v[128:131],a[96:99],a[160:163],v[128:131]
R a[168:171],v5,18432
R a[172:175],v6,18432
M v[128:131],a[100:103],a[164:167],v[128:131]
T a[72:73],v2,49152
T a[74:75],v2,50176
M v[132:135],a[108:111],a[164:167],v[132:135]
buffer_load_dwordx4 a[220:223], v28, s[56:59], s64 offen offset:192
M v[132:135],a[104:107],a[160:163],v[132:135]
M v[136:139],a[112:115],a[160:163],v[136:139]
buffer_load_dwordx4 a[224:227], v28, s[56:59], s64 offen offset:256
M v[136:139],a[116:119],a[164:167],v[136:139]
M v[140:143],a[124:127],a[164:167],v[140:143]
buffer_load_dwordx4 v15, s[48:51], s22 offen offset:3072   lds
M v[140:143],a[120:123],a[160:163],v[140:143]
SA s22,s22,1048576
T a[76:77],v2,57344
T a[78:79],v2,58368
M v[144:147],a[128:131],a[160:163],v[144:147]
M v[144:147],a[132:135],a[164:167],v[144:147]
buffer_load_dwordx4 a[228:231], v28, s[56:59], s64 offen offset:320
M v[148:151],a[140:143],a[164:167],v[148:151]
M v[148:151],a[136:139],a[160:163],v[148:151]
SA m0,s23,32768
M v[152:155],a[144:147],a[160:163],v[152:155]
buffer_load_dwordx4 v8, s[16:19], s21 offen offset:0   lds
M v[152:155],a[148:151],a[164:167],v[152:155]
s_waitcnt lgkmcnt(4)
M v[156:159],a[156:159],a[164:167],v[156:159]
s_nop 0
T a[80:81],v3,49152
T a[82:83],v3,50176
M v[156:159],a[152:155],a[160:163],v[156:159]
buffer_load_dwordx4 a[232:235], v28, s[56:59], s64 offen offset:384
M v[188:191],a[152:155],a[168:171],v[188:191]
R a[160:163],v5,20480
R a[164:167],v6,20480
M v[188:191],a[156:159],a[172:175],v[188:191]
v_lshrrev_b32 v28, 4, v24
M v[184:187],a[148:151],a[172:175],v[184:187]
buffer_load_dwordx4 v9, s[16:19], s21 offen offset:1024   lds
M v[184:187],a[144:147],a[168:171],v[184:187]
L_w_kv04:
s_cbranch_execz L_w_kv08
v_lshlrev_b32 v28, 5, v28
M v[180:183],a[136:139],a[168:171],v[180:183]
v_and_b32 v30, 15, v24
M v[180:183],a[140:143],a[172:175],v[180:183]
s_nop 0
T a[84:85],v3,57344
T a[86:87],v3,58368
M v[176:179],a[132:135],a[172:175],v[176:179]
v_add_lshl_u32 v28, v28, v30, 2
M v[176:179],a[128:131],a[168:171],v[176:179]
v_lshrrev_b32 v30, 1, v0
M v[172:175],a[120:123],a[168:171],v[172:175]
v_min_u32 v30, 1, v30
M v[172:175],a[124:127],a[172:175],v[172:175]
buffer_load_dwordx4 v10, s[16:19], s21 offen offset:2048   lds
M v[168:171],a[116:119],a[172:175],v[168:171]
v_lshl_or_b32 v28, v30, 29, v28
M v[168:171],a[112:115],a[168:171],v[168:171]
s_or_b32 s64, s31, s20
M v[164:167],a[104:107],a[168:171],v[164:167]
s_min_u32 s64, s64, 1
T a[88:89],v4,49152
T a[90:91],v4,50176
M v[164:167],a[108:111],a[172:175],v[164:167]
s_waitcnt lgkmcnt(4)
s_lshl_b32 s64, s64, 29
M v[160:163],a[100:103],a[172:175],v[160:163]
SA s64,s64,104857600
buffer_load_dword v23, v28, s[8:11], s64 offen sc1
M v[160:163],a[96:99],a[168:171],v[160:163]
buffer_load_dwordx4 v11, s[16:19], s21 offen offset:3072   lds
M v[192:195],a[96:99],a[160:163],v[192:195]
SA s21,s21,128
R a[168:171],v5,22528
R a[172:175],v6,22528
M v[192:195],a[100:103],a[164:167],v[192:195]
v_bfe_u32 v28, v0, 2, 2
M v[196:199],a[108:111],a[164:167],v[196:199]
v_lshl_add_u32 v28, v29, 3, v28
M v[196:199],a[104:107],a[160:163],v[196:199]
s_nop 0
T a[92:93],v4,57344
T a[94:95],v4,58368
M v[200:203],a[112:115],a[160:163],v[200:203]
SA m0,s87,6144
v_lshlrev_b32 v28, 5, v28
M v[200:203],a[116:119],a[164:167],v[200:203]
buffer_load_dwordx4 v25, s[60:63], s89 offen offset:0  lds
M v[204:207],a[124:127],a[164:167],v[204:207]
SA s89,s89,114688
v_and_b32 v30, 3, v0
M v[204:207],a[120:123],a[160:163],v[204:207]
v_lshl_add_u32 v28, v30, 3, v28
M v[208:211],a[128:131],a[160:163],v[208:211]
v_add_u32 v22, s87, v28
M v[208:211],a[132:135],a[164:167],v[208:211]
M v[212:215],a[140:143],a[164:167],v[212:215]
M v[212:215],a[136:139],a[160:163],v[212:215]
M v[216:219],a[144:147],a[160:163],v[216:219]
M v[216:219],a[148:151],a[164:167],v[216:219]
s_waitcnt lgkmcnt(2)
M v[220:223],a[156:159],a[164:167],v[220:223]
s_waitcnt vmcnt(26) lgkmcnt(0)
M v[220:223],a[152:155],a[160:163],v[220:223]
s_barrier
M v[252:255],a[152:155],a[168:171],v[252:255]
R a[160:163],v5,32768
R a[164:167],v6,32768
M v[252:255],a[156:159],a[172:175],v[252:255]
M v[248:251],a[148:151],a[172:175],v[248:251]
M v[248:251],a[144:147],a[168:171],v[248:251]
M v[244:247],a[136:139],a[168:171],v[244:247]
M v[244:247],a[140:143],a[172:175],v[244:247]
M v[240:243],a[132:135],a[172:175],v[240:243]
M v[240:243],a[128:131],a[168:171],v[240:243]
M v[236:239],a[120:123],a[168:171],v[236:239]
M v[236:239],a[124:127],a[172:175],v[236:239]
M v[232:235],a[116:119],a[172:175],v[232:235]
M v[232:235],a[112:115],a[168:171],v[232:235]
M v[228:231],a[104:107],a[168:171],v[228:231]
M v[228:231],a[108:111],a[172:175],v[228:231]
s_waitcnt lgkmcnt(0)
M v[224:227],a[100:103],a[172:175],v[224:227]
M v[224:227],a[96:99],a[168:171],v[224:227]
M a[0:3],a[32:35],a[160:163],a[0:3]
R a[168:171],v5,34816
R a[172:175],v6,34816
M a[0:3],a[36:39],a[164:167],a[0:3]
T a[96:97],v1,0
T a[98:99],v1,1024
M a[4:7],a[44:47],a[164:167],a[4:7]
SA m0,s24,16384
M a[4:7],a[40:43],a[160:163],a[4:7]
buffer_load_dwordx4 v12, s[48:51], s22 offen offset:0   lds
M a[8:11],a[48:51],a[160:163],a[8:11]
M a[8:11],a[52:55],a[164:167],a[8:11]
M a[12:15],a[60:63],a[164:167],a[12:15]
s_nop 0
T a[100:101],v1,8192
T a[102:103],v1,9216
M a[12:15],a[56:59],a[160:163],a[12:15]
M a[16:19],a[64:67],a[160:163],a[16:19]
buffer_load_dwordx4 v13, s[48:51], s22 offen offset:1024   lds
M a[16:19],a[68:71],a[164:167],a[16:19]
M a[20:23],a[76:79],a[164:167],a[20:23]
M a[20:23],a[72:75],a[160:163],a[20:23]
s_nop 0
T a[104:105],v2,0
T a[106:107],v2,1024
M a[24:27],a[80:83],a[160:163],a[24:27]
M a[24:27],a[84:87],a[164:167],a[24:27]
s_waitcnt lgkmcnt(6)
buffer_load_dwordx4 v14, s[48:51], s22 offen offset:2048   lds
M a[28:31],a[92:95],a[164:167],a[28:31]
M a[28:31],a[88:91],a[160:163],a[28:31]
M v[60:63],a[88:91],a[168:171],v[60:63]
R a[160:163],v5,36864
R a[164:167],v6,36864
M v[60:63],a[92:95],a[172:175],v[60:63]
T a[108:109],v2,8192
T a[110:111],v2,9216
M v[56:59],a[84:87],a[172:175],v[56:59]
buffer_load_dwordx4 v15, s[48:51], s22 offen offset:3072   lds
M v[56:59],a[80:83],a[168:171],v[56:59]
s_sub_u32 s22, s22, 1048448
M v[52:55],a[72:75],a[168:171],v[52:55]
M v[52:55],a[76:79],a[172:175],v[52:55]
s_nop 0
T a[112:113],v3,0
T a[114:115],v3,1024
M v[48:51],a[68:71],a[172:175],v[48:51]
SA m0,s23,49152
M v[48:51],a[64:67],a[168:171],v[48:51]
buffer_load_dwordx4 v8, s[16:19], s21 offen offset:0   lds
M v[44:47],a[56:59],a[168:171],v[44:47]
M v[44:47],a[60:63],a[172:175],v[44:47]
M v[40:43],a[52:55],a[172:175],v[40:43]
s_nop 0
T a[116:117],v3,8192
T a[118:119],v3,9216
M v[40:43],a[48:51],a[168:171],v[40:43]
M v[36:39],a[40:43],a[168:171],v[36:39]
buffer_load_dwordx4 v9, s[16:19], s21 offen offset:1024   lds
M v[36:39],a[44:47],a[172:175],v[36:39]
s_waitcnt lgkmcnt(6)
M v[32:35],a[36:39],a[172:175],v[32:35]
M v[32:35],a[32:35],a[168:171],v[32:35]
s_nop 0
T a[120:121],v4,0
T a[122:123],v4,1024
M v[64:67],a[32:35],a[160:163],v[64:67]
R a[168:171],v5,38912
R a[172:175],v6,38912
M v[64:67],a[36:39],a[164:167],v[64:67]
buffer_load_dwordx4 v10, s[16:19], s21 offen offset:2048   lds
M v[68:71],a[44:47],a[164:167],v[68:71]
M v[68:71],a[40:43],a[160:163],v[68:71]
M v[72:75],a[48:51],a[160:163],v[72:75]
s_nop 0
T a[124:125],v4,8192
T a[126:127],v4,9216
M v[72:75],a[52:55],a[164:167],v[72:75]
M v[76:79],a[60:63],a[164:167],v[76:79]
buffer_load_dwordx4 v11, s[16:19], s21 offen offset:3072   lds
M v[76:79],a[56:59],a[160:163],v[76:79]
SA s21,s21,524160
M v[80:83],a[64:67],a[160:163],v[80:83]
M v[80:83],a[68:71],a[164:167],v[80:83]
M v[84:87],a[76:79],a[164:167],v[84:87]
M v[84:87],a[72:75],a[160:163],v[84:87]
M v[88:91],a[80:83],a[160:163],v[88:91]
M v[88:91],a[84:87],a[164:167],v[88:91]
s_waitcnt lgkmcnt(2)
M v[92:95],a[92:95],a[164:167],v[92:95]
s_waitcnt vmcnt(26) lgkmcnt(0)
M v[92:95],a[88:91],a[160:163],v[92:95]
s_barrier
M v[124:127],a[88:91],a[168:171],v[124:127]
R a[160:163],v5,49152
R a[164:167],v6,49152
M v[124:127],a[92:95],a[172:175],v[124:127]
M v[120:123],a[84:87],a[172:175],v[120:123]
SA m0,s24,32768
T a[128:129],v1,16384
T a[130:131],v1,17408
M v[120:123],a[80:83],a[168:171],v[120:123]
s_waitcnt vmcnt(8)
buffer_load_dwordx4 v12, s[48:51], s22 offen offset:0   lds
M v[116:119],a[72:75],a[168:171],v[116:119]
s_nop 0
T a[176:177],v22,0
T a[178:179],v22,128
M v[116:119],a[76:79],a[172:175],v[116:119]
T a[180:181],v22,1024
T a[182:183],v22,1152
M v[112:115],a[68:71],a[172:175],v[112:115]
T a[184:185],v22,2048
T a[186:187],v22,2176
M v[112:115],a[64:67],a[168:171],v[112:115]
T a[188:189],v22,3072
T a[190:191],v22,3200
M v[108:111],a[56:59],a[168:171],v[108:111]
M v[108:111],a[60:63],a[172:175],v[108:111]
s_nop 0
T a[132:133],v1,24576
T a[134:135],v1,25600
M v[104:107],a[52:55],a[172:175],v[104:107]
buffer_load_dwordx4 v13, s[48:51], s22 offen offset:1024   lds
M v[104:107],a[48:51],a[168:171],v[104:107]
M v[100:103],a[40:43],a[168:171],v[100:103]
M v[100:103],a[44:47],a[172:175],v[100:103]
s_waitcnt lgkmcnt(12)
M v[96:99],a[36:39],a[172:175],v[96:99]
M v[96:99],a[32:35],a[168:171],v[96:99]
M v[128:131],a[32:35],a[160:163],v[128:131]
R a[168:171],v5,51200
R a[172:175],v6,51200
M v[128:131],a[36:39],a[164:167],v[128:131]
T a[136:137],v2,16384
T a[138:139],v2,17408
M v[132:135],a[44:47],a[164:167],v[132:135]
buffer_load_dwordx4 v14, s[48:51], s22 offen offset:2048   lds
M v[132:135],a[40:43],a[160:163],v[132:135]
M v[136:139],a[48:51],a[160:163],v[136:139]
M v[136:139],a[52:55],a[164:167],v[136:139]
M v[140:143],a[60:63],a[164:167],v[140:143]
M v[140:143],a[56:59],a[160:163],v[140:143]
s_nop 0
T a[140:141],v2,24576
T a[142:143],v2,25600
M v[144:147],a[64:67],a[160:163],v[144:147]
buffer_load_dwordx4 v15, s[48:51], s22 offen offset:3072   lds
M v[144:147],a[68:71],a[164:167],v[144:147]
SA s22,s22,1048576
M v[148:151],a[76:79],a[164:167],v[148:151]
M v[148:151],a[72:75],a[160:163],v[148:151]
M v[152:155],a[80:83],a[160:163],v[152:155]
M v[152:155],a[84:87],a[164:167],v[152:155]
s_waitcnt lgkmcnt(4)
M v[156:159],a[92:95],a[164:167],v[156:159]
SA m0,s23,0
T a[144:145],v3,16384
T a[146:147],v3,17408
M v[156:159],a[88:91],a[160:163],v[156:159]
buffer_load_dwordx4 v8, s[16:19], s21 offen offset:0   lds
M v[16:19],a[176:179],a[208:211],0
M v[16:19],a[180:183],a[212:215],v[16:19]
M v[16:19],a[184:187],a[216:219],v[16:19]
M v[16:19],a[188:191],a[220:223],v[16:19]
M v[188:191],a[88:91],a[168:171],v[188:191]
R a[160:163],v5,53248
R a[164:167],v6,53248
M v[188:191],a[92:95],a[172:175],v[188:191]
T a[176:177],v22,4096
T a[178:179],v22,4224
M v[184:187],a[84:87],a[172:175],v[184:187]
T a[180:181],v22,5120
T a[182:183],v22,5248
M v[184:187],a[80:83],a[168:171],v[184:187]
T a[184:185],v22,6144
T a[186:187],v22,6272
M v[180:183],a[72:75],a[168:171],v[180:183]
M v[180:183],a[76:79],a[172:175],v[180:183]
s_nop 0
T a[148:149],v3,24576
T a[150:151],v3,25600
M v[176:179],a[68:71],a[172:175],v[176:179]
buffer_load_dwordx4 v9, s[16:19], s21 offen offset:1024   lds
M v[176:179],a[64:67],a[168:171],v[176:179]
M v[172:175],a[56:59],a[168:171],v[172:175]
M v[172:175],a[60:63],a[172:175],v[172:175]
M v[168:171],a[52:55],a[172:175],v[168:171]
M v[168:171],a[48:51],a[168:171],v[168:171]
M v[164:167],a[40:43],a[168:171],v[164:167]
s_nop 0
T a[152:153],v4,16384
T a[154:155],v4,17408
M v[164:167],a[44:47],a[172:175],v[164:167]
s_waitcnt lgkmcnt(10)
buffer_load_dwordx4 v10, s[16:19], s21 offen offset:2048   lds
M v[160:163],a[36:39],a[172:175],v[160:163]
M v[160:163],a[32:35],a[168:171],v[160:163]
M v[192:195],a[32:35],a[160:163],v[192:195]
R a[168:171],v5,55296
R a[172:175],v6,55296
M v[192:195],a[36:39],a[164:167],v[192:195]
M v[196:199],a[44:47],a[164:167],v[196:199]
M v[196:199],a[40:43],a[160:163],v[196:199]
s_nop 0
T a[156:157],v4,24576
T a[158:159],v4,25600
M v[200:203],a[48:51],a[160:163],v[200:203]
buffer_load_dwordx4 v11, s[16:19], s21 offen offset:3072   lds
M v[200:203],a[52:55],a[164:167],v[200:203]
SA s21,s21,128
M v[204:207],a[60:63],a[164:167],v[204:207]
M v[204:207],a[56:59],a[160:163],v[204:207]
M v[208:211],a[64:67],a[160:163],v[208:211]
M v[208:211],a[68:71],a[164:167],v[208:211]
M v[212:215],a[76:79],a[164:167],v[212:215]
M v[212:215],a[72:75],a[160:163],v[212:215]
M v[216:219],a[80:83],a[160:163],v[216:219]
M v[216:219],a[84:87],a[164:167],v[216:219]
s_waitcnt lgkmcnt(2)
M v[220:223],a[92:95],a[164:167],v[220:223]
s_waitcnt lgkmcnt(0)
M v[220:223],a[88:91],a[160:163],v[220:223]
s_barrier
M v[16:19],a[176:179],a[224:227],v[16:19]
M v[16:19],a[180:183],a[228:231],v[16:19]
M v[16:19],a[184:187],a[232:235],v[16:19]
M v[252:255],a[88:91],a[168:171],v[252:255]
R a[160:163],v5,0
R a[164:167],v6,0
M v[252:255],a[92:95],a[172:175],v[252:255]
M v[248:251],a[84:87],a[172:175],v[248:251]
M v[248:251],a[80:83],a[168:171],v[248:251]
M v[244:247],a[72:75],a[168:171],v[244:247]
M v[244:247],a[76:79],a[172:175],v[244:247]
M v[240:243],a[68:71],a[172:175],v[240:243]
M v[240:243],a[64:67],a[168:171],v[240:243]
M v[236:239],a[56:59],a[168:171],v[236:239]
M v[236:239],a[60:63],a[172:175],v[236:239]
M v[232:235],a[52:55],a[172:175],v[232:235]
M v[232:235],a[48:51],a[168:171],v[232:235]
M v[228:231],a[40:43],a[168:171],v[228:231]
M v[228:231],a[44:47],a[172:175],v[228:231]
s_waitcnt lgkmcnt(0)
M v[224:227],a[36:39],a[172:175],v[224:227]
M v[224:227],a[32:35],a[168:171],v[224:227]
M a[0:3],a[96:99],a[160:163],a[0:3]
R a[168:171],v5,2048
R a[172:175],v6,2048
M a[0:3],a[100:103],a[164:167],a[0:3]
T a[32:33],v1,32768
T a[34:35],v1,33792
M a[4:7],a[108:111],a[164:167],a[4:7]
SA m0,s24,49152
M a[4:7],a[104:107],a[160:163],a[4:7]
buffer_load_dwordx4 v12, s[48:51], s22 offen offset:0   lds
M a[8:11],a[112:115],a[160:163],a[8:11]
M a[8:11],a[116:119],a[164:167],a[8:11]
s_lshl_b32 s64, s20, 10
M a[12:15],a[124:127],a[164:167],a[12:15]
SA s64,s64,159744
T a[36:37],v1,40960
T a[38:39],v1,41984
M a[12:15],a[120:123],a[160:163],a[12:15]
v_add_u32 v21, s64, v7
ds_write_b128 v21, v[16:19]
M a[16:19],a[128:131],a[160:163],a[16:19]
s_mul_i32 s67, s86, 14336
buffer_load_dwordx4 v13, s[48:51], s22 offen offset:1024   lds
M a[16:19],a[132:135],a[164:167],a[16:19]
s_mul_i32 s64, s20, 224
M a[20:23],a[140:143],a[164:167],a[20:23]
SA s67,s67,s64
v_lshrrev_b32 v28, 4, v0
v_mul_u32_u24 v28, 896, v28
M a[20:23],a[136:139],a[160:163],a[20:23]
T a[40:41],v2,32768
T a[42:43],v2,33792
M a[24:27],a[144:147],a[160:163],a[24:27]
v_and_b32 v29, 15, v0
v_lshl_add_u32 v28, v29, 4, v28
M a[24:27],a[148:151],a[164:167],a[24:27]
s_waitcnt lgkmcnt(7)
buffer_load_dwordx4 v14, s[48:51], s22 offen offset:2048   lds
M a[28:31],a[156:159],a[164:167],a[28:31]
v_mov_b32 v30, 536870912
v_cmp_gt_u32 vcc, 14, v29
M a[28:31],a[152:155],a[160:163],a[28:31]
s_nop 0
M v[60:63],a[152:155],a[168:171],v[60:63]
s_nop 0
R a[160:163],v5,4096
R a[164:167],v6,4096
M v[60:63],a[156:159],a[172:175],v[60:63]
T a[44:45],v2,40960
T a[46:47],v2,41984
M v[56:59],a[148:151],a[172:175],v[56:59]
buffer_load_dwordx4 v15, s[48:51], s22 offen offset:3072   lds
M v[56:59],a[144:147],a[168:171],v[56:59]
s_sub_u32 s22, s22, 1048448
v_cndmask_b32 v28, v30, v28, vcc
v_add_u32 v29, 2560, v28
M v[52:55],a[136:139],a[168:171],v[52:55]
v_add_u32 v30, 5120, v28
v_add_u32 v31, 7680, v28
M v[52:55],a[140:143],a[172:175],v[52:55]
T a[48:49],v3,32768
T a[50:51],v3,33792
M v[48:51],a[132:135],a[172:175],v[48:51]
SA m0,s23,16384
M v[48:51],a[128:131],a[168:171],v[48:51]
buffer_load_dwordx4 v8, s[16:19], s21 offen offset:0   lds
M v[44:47],a[120:123],a[168:171],v[44:47]
M v[44:47],a[124:127],a[172:175],v[44:47]
M v[40:43],a[116:119],a[172:175],v[40:43]
s_nop 0
T a[52:53],v3,40960
T a[54:55],v3,41984
M v[40:43],a[112:115],a[168:171],v[40:43]
M v[36:39],a[104:107],a[168:171],v[36:39]
buffer_load_dwordx4 v9, s[16:19], s21 offen offset:1024   lds
M v[36:39],a[108:111],a[172:175],v[36:39]
s_waitcnt lgkmcnt(6)
M v[32:35],a[100:103],a[172:175],v[32:35]
M v[32:35],a[96:99],a[168:171],v[32:35]
s_nop 0
T a[56:57],v4,32768
T a[58:59],v4,33792
M v[64:67],a[96:99],a[160:163],v[64:67]
R a[168:171],v5,6144
R a[172:175],v6,6144
M v[64:67],a[100:103],a[164:167],v[64:67]
buffer_load_dwordx4 v10, s[16:19], s21 offen offset:2048   lds
M v[68:71],a[108:111],a[164:167],v[68:71]
M v[68:71],a[104:107],a[160:163],v[68:71]
M v[72:75],a[112:115],a[160:163],v[72:75]
s_nop 0
T a[60:61],v4,40960
T a[62:63],v4,41984
M v[72:75],a[116:119],a[164:167],v[72:75]
M v[76:79],a[124:127],a[164:167],v[76:79]
buffer_load_dwordx4 v11, s[16:19], s21 offen offset:3072   lds
M v[76:79],a[120:123],a[160:163],v[76:79]
SA s21,s21,524160
M v[80:83],a[128:131],a[160:163],v[80:83]
M v[80:83],a[132:135],a[164:167],v[80:83]
M v[84:87],a[140:143],a[164:167],v[84:87]
M v[84:87],a[136:139],a[160:163],v[84:87]
M v[88:91],a[144:147],a[160:163],v[88:91]
M v[88:91],a[148:151],a[164:167],v[88:91]
s_waitcnt lgkmcnt(2)
M v[92:95],a[156:159],a[164:167],v[92:95]
s_waitcnt vmcnt(16) lgkmcnt(0)
M v[92:95],a[152:155],a[160:163],v[92:95]
s_barrier
M v[124:127],a[152:155],a[168:171],v[124:127]
R a[160:163],v5,16384
R a[164:167],v6,16384
M v[124:127],a[156:159],a[172:175],v[124:127]
M v[120:123],a[148:151],a[172:175],v[120:123]
SA m0,s24,0
T a[64:65],v1,49152
T a[66:67],v1,50176
M v[120:123],a[144:147],a[168:171],v[120:123]
buffer_load_dwordx4 v12, s[48:51], s22 offen offset:0   lds
M v[116:119],a[136:139],a[168:171],v[116:119]
M v[116:119],a[140:143],a[172:175],v[116:119]
M v[112:115],a[132:135],a[172:175],v[112:115]
M v[112:115],a[128:131],a[168:171],v[112:115]
buffer_load_dwordx4 v13, s[48:51], s22 offen offset:1024   lds
M v[108:111],a[120:123],a[168:171],v[108:111]
M v[108:111],a[124:127],a[172:175],v[108:111]
s_nop 0
T a[68:69],v1,57344
T a[70:71],v1,58368
M v[104:107],a[116:119],a[172:175],v[104:107]
M v[104:107],a[112:115],a[168:171],v[104:107]
M v[100:103],a[104:107],a[168:171],v[100:103]
buffer_load_dwordx4 v14, s[48:51], s22 offen offset:2048   lds
M v[100:103],a[108:111],a[172:175],v[100:103]
s_waitcnt lgkmcnt(4)
M v[96:99],a[100:103],a[172:175],v[96:99]
M v[96:99],a[96:99],a[168:171],v[96:99]
M v[128:131],a[96:99],a[160:163],v[128:131]
R a[168:171],v5,18432
R a[172:175],v6,18432
M v[128:131],a[100:103],a[164:167],v[128:131]
T a[72:73],v2,49152
T a[74:75],v2,50176
M v[132:135],a[108:111],a[164:167],v[132:135]
buffer_load_dwordx4 v15, s[48:51], s22 offen offset:3072   lds
M v[132:135],a[104:107],a[160:163],v[132:135]
SA s22,s22,1048576
M v[136:139],a[112:115],a[160:163],v[136:139]
M v[136:139],a[116:119],a[164:167],v[136:139]
SA m0,s23,32768
M v[140:143],a[124:127],a[164:167],v[140:143]
buffer_load_dwordx4 v8, s[16:19], s21 offen offset:0   lds
M v[140:143],a[120:123],a[160:163],v[140:143]
s_nop 0
T a[76:77],v2,57344
T a[78:79],v2,58368
M v[144:147],a[128:131],a[160:163],v[144:147]
M v[144:147],a[132:135],a[164:167],v[144:147]
M v[148:151],a[140:143],a[164:167],v[148:151]
buffer_load_dwordx4 v9, s[16:19], s21 offen offset:1024   lds
M v[148:151],a[136:139],a[160:163],v[148:151]
M v[152:155],a[144:147],a[160:163],v[152:155]
M v[152:155],a[148:151],a[164:167],v[152:155]
s_waitcnt lgkmcnt(4)
M v[156:159],a[156:159],a[164:167],v[156:159]
s_nop 0
T a[80:81],v3,49152
T a[82:83],v3,50176
M v[156:159],a[152:155],a[160:163],v[156:159]
buffer_load_dwordx4 v10, s[16:19], s21 offen offset:2048   lds
M v[188:191],a[152:155],a[168:171],v[188:191]
R a[160:163],v5,20480
R a[164:167],v6,20480
M v[188:191],a[156:159],a[172:175],v[188:191]
M v[184:187],a[148:151],a[172:175],v[184:187]
M v[184:187],a[144:147],a[168:171],v[184:187]
M v[180:183],a[136:139],a[168:171],v[180:183]
buffer_load_dwordx4 v11, s[16:19], s21 offen offset:3072   lds
M v[180:183],a[140:143],a[172:175],v[180:183]
SA s21,s21,128
T a[84:85],v3,57344
T a[86:87],v3,58368
M v[176:179],a[132:135],a[172:175],v[176:179]
M v[176:179],a[128:131],a[168:171],v[176:179]
M v[172:175],a[120:123],a[168:171],v[172:175]
SA m0,s87,0
M v[172:175],a[124:127],a[172:175],v[172:175]
buffer_load_dwordx4 v28, s[68:71], s67 offen offset:0 nt lds
M v[168:171],a[116:119],a[172:175],v[168:171]
M v[168:171],a[112:115],a[168:171],v[168:171]
M v[164:167],a[104:107],a[168:171],v[164:167]
s_nop 0
T a[88:89],v4,49152
T a[90:91],v4,50176
M v[164:167],a[108:111],a[172:175],v[164:167]
s_waitcnt lgkmcnt(4)
buffer_load_dwordx4 v29, s[68:71], s67 offen offset:1024 nt lds
M v[160:163],a[100:103],a[172:175],v[160:163]
M v[160:163],a[96:99],a[168:171],v[160:163]
M v[192:195],a[96:99],a[160:163],v[192:195]
R a[168:171],v5,22528
R a[172:175],v6,22528
M v[192:195],a[100:103],a[164:167],v[192:195]
M v[196:199],a[108:111],a[164:167],v[196:199]
buffer_load_dwordx4 v30, s[68:71], s67 offen offset:2048 nt lds
M v[196:199],a[104:107],a[160:163],v[196:199]
s_nop 0
T a[92:93],v4,57344
T a[94:95],v4,58368
M v[200:203],a[112:115],a[160:163],v[200:203]
M v[200:203],a[116:119],a[164:167],v[200:203]
M v[204:207],a[124:127],a[164:167],v[204:207]
M v[204:207],a[120:123],a[160:163],v[204:207]
buffer_load_dwordx4 v31, s[68:71], s67 offen offset:3072 nt lds
M v[208:211],a[128:131],a[160:163],v[208:211]
SA s67,s67,0
M v[208:211],a[132:135],a[164:167],v[208:211]
L_w_kv05:
s_cbranch_execz L_wd1
M v[212:215],a[140:143],a[164:167],v[212:215]
M v[212:215],a[136:139],a[160:163],v[212:215]
M v[216:219],a[144:147],a[160:163],v[216:219]
M v[216:219],a[148:151],a[164:167],v[216:219]
s_waitcnt lgkmcnt(2)
M v[220:223],a[156:159],a[164:167],v[220:223]
s_waitcnt vmcnt(20) lgkmcnt(0)
M v[220:223],a[152:155],a[160:163],v[220:223]
s_barrier
M v[252:255],a[152:155],a[168:171],v[252:255]
R a[160:163],v5,32768
R a[164:167],v6,32768
M v[252:255],a[156:159],a[172:175],v[252:255]
M v[248:251],a[148:151],a[172:175],v[248:251]
M v[248:251],a[144:147],a[168:171],v[248:251]
M v[244:247],a[136:139],a[168:171],v[244:247]
M v[244:247],a[140:143],a[172:175],v[244:247]
M v[240:243],a[132:135],a[172:175],v[240:243]
M v[240:243],a[128:131],a[168:171],v[240:243]
M v[236:239],a[120:123],a[168:171],v[236:239]
M v[236:239],a[124:127],a[172:175],v[236:239]
M v[232:235],a[116:119],a[172:175],v[232:235]
M v[232:235],a[112:115],a[168:171],v[232:235]
M v[228:231],a[104:107],a[168:171],v[228:231]
M v[228:231],a[108:111],a[172:175],v[228:231]
s_waitcnt lgkmcnt(0)
M v[224:227],a[100:103],a[172:175],v[224:227]
M v[224:227],a[96:99],a[168:171],v[224:227]
M a[0:3],a[32:35],a[160:163],a[0:3]
R a[168:171],v5,34816
R a[172:175],v6,34816
M a[0:3],a[36:39],a[164:167],a[0:3]
T a[96:97],v1,0
T a[98:99],v1,1024
M a[4:7],a[44:47],a[164:167],a[4:7]
SA m0,s24,16384
C v23,v23,v23
M a[4:7],a[40:43],a[160:163],a[4:7]
buffer_load_dwordx4 v12, s[48:51], s22 offen offset:0   lds
M a[8:11],a[48:51],a[160:163],a[8:11]
v_and_b32 v23, 0xffff0000, v23
M a[8:11],a[52:55],a[164:167],a[8:11]
MF v22,0xbfb8aa3b,v23
M a[12:15],a[60:63],a[164:167],a[12:15]
s_nop 0
T a[100:101],v1,8192
T a[102:103],v1,9216
M a[12:15],a[56:59],a[160:163],a[12:15]
E v22,v22
M a[16:19],a[64:67],a[160:163],a[16:19]
buffer_load_dwordx4 v13, s[48:51], s22 offen offset:1024   lds
M a[16:19],a[68:71],a[164:167],a[16:19]
AF v22,1.0,v22
M a[20:23],a[76:79],a[164:167],a[20:23]
v_rcp_f32 v23, v22
M a[20:23],a[72:75],a[160:163],a[20:23]
s_or_b32 s64, s31, s20
T a[104:105],v2,0
T a[106:107],v2,1024
M a[24:27],a[80:83],a[160:163],a[24:27]
s_min_u32 s64, s64, 1
s_lshl_b32 s64, s64, 29
v_lshrrev_b32 v22, 1, v0
M a[24:27],a[84:87],a[164:167],a[24:27]
s_waitcnt lgkmcnt(6)
buffer_load_dwordx4 v14, s[48:51], s22 offen offset:2048   lds
M a[28:31],a[92:95],a[164:167],a[28:31]
v_min_u32 v22, 1, v22
M a[28:31],a[88:91],a[160:163],a[28:31]
v_lshlrev_b32 v22, 29, v22
M v[60:63],a[88:91],a[168:171],v[60:63]
R a[160:163],v5,36864
R a[164:167],v6,36864
M v[60:63],a[92:95],a[172:175],v[60:63]
T a[108:109],v2,8192
T a[110:111],v2,9216
M v[56:59],a[84:87],a[172:175],v[56:59]
buffer_load_dwordx4 v15, s[48:51], s22 offen offset:3072   lds
M v[56:59],a[80:83],a[168:171],v[56:59]
s_sub_u32 s22, s22, 1048448
v_lshl_or_b32 v22, v0, 2, v22
M v[52:55],a[72:75],a[168:171],v[52:55]
v_or_b32 v22, s64, v22
M v[52:55],a[76:79],a[172:175],v[52:55]
s_nop 0
T a[112:113],v3,0
T a[114:115],v3,1024
M v[48:51],a[68:71],a[172:175],v[48:51]
SA m0,s23,49152
C v23,v23,v23
M v[48:51],a[64:67],a[168:171],v[48:51]
buffer_load_dwordx4 v8, s[16:19], s21 offen offset:0   lds
M v[44:47],a[56:59],a[168:171],v[44:47]
v_and_b32 v23, 0xffff0000, v23
M v[44:47],a[60:63],a[172:175],v[44:47]
s_lshl_b32 s64, s41, 7
M v[40:43],a[52:55],a[172:175],v[40:43]
SA s64,s64,104890368
T a[116:117],v3,8192
T a[118:119],v3,9216
M v[40:43],a[48:51],a[168:171],v[40:43]
buffer_store_dword v24, v22, s[8:11], s64 offen sc1
M v[36:39],a[40:43],a[168:171],v[36:39]
buffer_load_dwordx4 v9, s[16:19], s21 offen offset:1024   lds
M v[36:39],a[44:47],a[172:175],v[36:39]
s_waitcnt lgkmcnt(6)
buffer_store_dword v23, v22, s[8:11], s64 offen offset:8 sc1
M v[32:35],a[36:39],a[172:175],v[32:35]
v_add_u32 v25, 159744, v7
M v[32:35],a[32:35],a[168:171],v[32:35]
s_nop 0
T a[120:121],v4,0
T a[122:123],v4,1024
M v[64:67],a[32:35],a[160:163],v[64:67]
R a[168:171],v5,38912
R a[172:175],v6,38912
M v[64:67],a[36:39],a[164:167],v[64:67]
buffer_load_dwordx4 v10, s[16:19], s21 offen offset:2048   lds
M v[68:71],a[44:47],a[164:167],v[68:71]
ds_read_b128 v[16:19], v25
M v[68:71],a[40:43],a[160:163],v[68:71]
R v[28:31],v25,1024
M v[72:75],a[48:51],a[160:163],v[72:75]
s_nop 0
T a[124:125],v4,8192
T a[126:127],v4,9216
M v[72:75],a[52:55],a[164:167],v[72:75]
R v[20:23],v25,2048
M v[76:79],a[60:63],a[164:167],v[76:79]
buffer_load_dwordx4 v11, s[16:19], s21 offen offset:3072   lds
M v[76:79],a[56:59],a[160:163],v[76:79]
SA s21,s21,524160
M v[80:83],a[64:67],a[160:163],v[80:83]
M v[80:83],a[68:71],a[164:167],v[80:83]
M v[84:87],a[76:79],a[164:167],v[84:87]
M v[84:87],a[72:75],a[160:163],v[84:87]
M v[88:91],a[80:83],a[160:163],v[88:91]
M v[88:91],a[84:87],a[164:167],v[88:91]
s_waitcnt lgkmcnt(5)
s_waitcnt lgkmcnt(3)
AF v16,v28,v16
M v[92:95],a[92:95],a[164:167],v[92:95]
s_waitcnt vmcnt(22) lgkmcnt(0)
AF v17,v29,v17
M v[92:95],a[88:91],a[160:163],v[92:95]
s_barrier
M v[124:127],a[88:91],a[168:171],v[124:127]
R a[160:163],v5,49152
R a[164:167],v6,49152
M v[124:127],a[92:95],a[172:175],v[124:127]
AF v18,v30,v18
M v[120:123],a[84:87],a[172:175],v[120:123]
SA m0,s24,32768
T a[128:129],v1,16384
T a[130:131],v1,17408
M v[120:123],a[80:83],a[168:171],v[120:123]
buffer_load_dwordx4 v12, s[48:51], s22 offen offset:0   lds
M v[116:119],a[72:75],a[168:171],v[116:119]
AF v19,v31,v19
M v[116:119],a[76:79],a[172:175],v[116:119]
R v[28:31],v25,3072
M v[112:115],a[68:71],a[172:175],v[112:115]
C v25,v16,v17
M v[112:115],a[64:67],a[168:171],v[112:115]
v_lshlrev_b32 v16, 16, v25
M v[108:111],a[56:59],a[168:171],v[108:111]
v_and_b32 v17, 0xffff0000, v25
M v[108:111],a[60:63],a[172:175],v[108:111]
s_nop 0
T a[132:133],v1,24576
T a[134:135],v1,25600
M v[104:107],a[52:55],a[172:175],v[104:107]
buffer_load_dwordx4 v13, s[48:51], s22 offen offset:1024   lds
M v[104:107],a[48:51],a[168:171],v[104:107]
C v25,v18,v19
M v[100:103],a[40:43],a[168:171],v[100:103]
v_lshlrev_b32 v18, 16, v25
M v[100:103],a[44:47],a[172:175],v[100:103]
s_waitcnt lgkmcnt(5)
v_and_b32 v19, 0xffff0000, v25
M v[96:99],a[36:39],a[172:175],v[96:99]
s_waitcnt lgkmcnt(2)
AF v20,v28,v20
M v[96:99],a[32:35],a[168:171],v[96:99]
AF v21,v29,v21
M v[128:131],a[32:35],a[160:163],v[128:131]
R a[168:171],v5,51200
R a[172:175],v6,51200
M v[128:131],a[36:39],a[164:167],v[128:131]
T a[136:137],v2,16384
T a[138:139],v2,17408
M v[132:135],a[44:47],a[164:167],v[132:135]
buffer_load_dwordx4 v14, s[48:51], s22 offen offset:2048   lds
M v[132:135],a[40:43],a[160:163],v[132:135]
AF v22,v30,v22
M v[136:139],a[48:51],a[160:163],v[136:139]
AF v23,v31,v23
M v[136:139],a[52:55],a[164:167],v[136:139]
MF v28,0xbfb8aa3b,v16
M v[140:143],a[60:63],a[164:167],v[140:143]
MF v29,0xbfb8aa3b,v17
M v[140:143],a[56:59],a[160:163],v[140:143]
s_nop 0
T a[140:141],v2,24576
T a[142:143],v2,25600
M v[144:147],a[64:67],a[160:163],v[144:147]
buffer_load_dwordx4 v15, s[48:51], s22 offen offset:3072   lds
M v[144:147],a[68:71],a[164:167],v[144:147]
SA s22,s22,1048576
MF v30,0xbfb8aa3b,v18
M v[148:151],a[76:79],a[164:167],v[148:151]
MF v31,0xbfb8aa3b,v19
M v[148:151],a[72:75],a[160:163],v[148:151]
E v28,v28
M v[152:155],a[80:83],a[160:163],v[152:155]
E v29,v29
M v[152:155],a[84:87],a[164:167],v[152:155]
s_waitcnt lgkmcnt(4)
E v30,v30
M v[156:159],a[92:95],a[164:167],v[156:159]
SA m0,s23,0
T a[144:145],v3,16384
T a[146:147],v3,17408
M v[156:159],a[88:91],a[160:163],v[156:159]
buffer_load_dwordx4 v8, s[16:19], s21 offen offset:0   lds
M v[188:191],a[88:91],a[168:171],v[188:191]
R a[160:163],v5,53248
R a[164:167],v6,53248
M v[188:191],a[92:95],a[172:175],v[188:191]
E v31,v31
M v[184:187],a[84:87],a[172:175],v[184:187]
C v25,v20,v21
M v[184:187],a[80:83],a[168:171],v[184:187]
v_lshlrev_b32 v20, 16, v25
M v[180:183],a[72:75],a[168:171],v[180:183]
v_and_b32 v21, 0xffff0000, v25
M v[180:183],a[76:79],a[172:175],v[180:183]
s_nop 0
T a[148:149],v3,24576
T a[150:151],v3,25600
M v[176:179],a[68:71],a[172:175],v[176:179]
buffer_load_dwordx4 v9, s[16:19], s21 offen offset:1024   lds
M v[176:179],a[64:67],a[168:171],v[176:179]
C v25,v22,v23
M v[172:175],a[56:59],a[168:171],v[172:175]
v_lshlrev_b32 v22, 16, v25
M v[172:175],a[60:63],a[172:175],v[172:175]
v_and_b32 v23, 0xffff0000, v25
M v[168:171],a[52:55],a[172:175],v[168:171]
AF v28,1.0,v28
M v[168:171],a[48:51],a[168:171],v[168:171]
AF v29,1.0,v29
M v[164:167],a[40:43],a[168:171],v[164:167]
s_nop 0
T a[152:153],v4,16384
T a[154:155],v4,17408
M v[164:167],a[44:47],a[172:175],v[164:167]
s_waitcnt lgkmcnt(4)
buffer_load_dwordx4 v10, s[16:19], s21 offen offset:2048   lds
M v[160:163],a[36:39],a[172:175],v[160:163]
AF v30,1.0,v30
M v[160:163],a[32:35],a[168:171],v[160:163]
AF v31,1.0,v31
M v[192:195],a[32:35],a[160:163],v[192:195]
R a[168:171],v5,55296
R a[172:175],v6,55296
M v[192:195],a[36:39],a[164:167],v[192:195]
v_rcp_f32 v28, v28
M v[196:199],a[44:47],a[164:167],v[196:199]
v_rcp_f32 v29, v29
M v[196:199],a[40:43],a[160:163],v[196:199]
T a[156:157],v4,24576
T a[158:159],v4,25600
M v[200:203],a[48:51],a[160:163],v[200:203]
buffer_load_dwordx4 v11, s[16:19], s21 offen offset:3072   lds
M v[200:203],a[52:55],a[164:167],v[200:203]
SA s21,s21,128
v_rcp_f32 v30, v30
M v[204:207],a[60:63],a[164:167],v[204:207]
v_rcp_f32 v31, v31
M v[204:207],a[56:59],a[160:163],v[204:207]
MF v16,v28,v16
M v[208:211],a[64:67],a[160:163],v[208:211]
MF v17,v29,v17
M v[208:211],a[68:71],a[164:167],v[208:211]
MF v18,v30,v18
M v[212:215],a[76:79],a[164:167],v[212:215]
MF v19,v31,v19
M v[212:215],a[72:75],a[160:163],v[212:215]
C v25,v16,v17
M v[216:219],a[80:83],a[160:163],v[216:219]
v_lshlrev_b32 v16, 16, v25
M v[216:219],a[84:87],a[164:167],v[216:219]
s_waitcnt lgkmcnt(2)
v_and_b32 v17, 0xffff0000, v25
M v[220:223],a[92:95],a[164:167],v[220:223]
s_waitcnt vmcnt(22) lgkmcnt(0)
C v25,v18,v19
M v[220:223],a[88:91],a[160:163],v[220:223]
s_barrier
M v[252:255],a[88:91],a[168:171],v[252:255]
R a[160:163],v5,0
R a[164:167],v6,0
M v[252:255],a[92:95],a[172:175],v[252:255]
v_lshlrev_b32 v18, 16, v25
M v[248:251],a[84:87],a[172:175],v[248:251]
v_and_b32 v19, 0xffff0000, v25
M v[248:251],a[80:83],a[168:171],v[248:251]
MF v16,v20,v16
M v[244:247],a[72:75],a[168:171],v[244:247]
MF v17,v21,v17
M v[244:247],a[76:79],a[172:175],v[244:247]
MF v18,v22,v18
M v[240:243],a[68:71],a[172:175],v[240:243]
MF v19,v23,v19
M v[240:243],a[64:67],a[168:171],v[240:243]
C v16,v16,v17
M v[236:239],a[56:59],a[168:171],v[236:239]
C v17,v18,v19
M v[236:239],a[60:63],a[172:175],v[236:239]
M v[232:235],a[52:55],a[172:175],v[232:235]
M v[232:235],a[48:51],a[168:171],v[232:235]
M v[228:231],a[40:43],a[168:171],v[228:231]
M v[228:231],a[44:47],a[172:175],v[228:231]
s_waitcnt lgkmcnt(0)
M v[224:227],a[36:39],a[172:175],v[224:227]
M v[224:227],a[32:35],a[168:171],v[224:227]
M a[0:3],a[96:99],a[160:163],a[0:3]
R a[168:171],v5,2048
R a[172:175],v6,2048
M a[0:3],a[100:103],a[164:167],a[0:3]
T a[32:33],v1,32768
T a[34:35],v1,33792
M a[4:7],a[108:111],a[164:167],a[4:7]
SA m0,s24,49152
v_lshrrev_b32 v28, 4, v0
v_and_b32 v29, 7, v0
M a[4:7],a[104:107],a[160:163],a[4:7]
buffer_load_dwordx4 v12, s[48:51], s22 offen offset:0   lds
M a[8:11],a[112:115],a[160:163],a[8:11]
v_xor_b32 v28, v28, v29
v_lshlrev_b32 v28, 4, v28
M a[8:11],a[116:119],a[164:167],a[8:11]
v_lshrrev_b32 v29, 3, v0
v_mul_u32_u24 v29, 896, v29
M a[12:15],a[124:127],a[164:167],a[12:15]
T a[36:37],v1,40960
T a[38:39],v1,41984
M a[12:15],a[120:123],a[160:163],a[12:15]
v_add_u32 v22, v28, v29
v_xor_b32 v28, 64, v28
M a[16:19],a[128:131],a[160:163],a[16:19]
s_mul_i32 s64, s20, 14336
buffer_load_dwordx4 v13, s[48:51], s22 offen offset:1024   lds
M a[16:19],a[132:135],a[164:167],a[16:19]
s_sub_u32 s65, 98304, s64
M a[20:23],a[140:143],a[164:167],a[20:23]
SA s30,s29,s65
M a[20:23],a[136:139],a[160:163],a[20:23]
SA s29,s29,s64
T a[40:41],v2,32768
T a[42:43],v2,33792
M a[24:27],a[144:147],a[160:163],a[24:27]
v_add_u32 v29, 6144, v29
v_add_u32 v23, v28, v29
M a[24:27],a[148:151],a[164:167],a[24:27]
s_waitcnt lgkmcnt(6)
buffer_load_dwordx4 v14, s[48:51], s22 offen offset:2048   lds
M a[28:31],a[156:159],a[164:167],a[28:31]
s_and_b32 s64, s20, 1
M a[28:31],a[152:155],a[160:163],a[28:31]
s_lshl_b32 s64, s64, 12
M v[60:63],a[152:155],a[168:171],v[60:63]
SA s64,s64,65536
R a[160:163],v5,4096
R a[164:167],v6,4096
M v[60:63],a[156:159],a[172:175],v[60:63]
T a[44:45],v2,40960
T a[46:47],v2,41984
M v[56:59],a[148:151],a[172:175],v[56:59]
buffer_load_dwordx4 v15, s[48:51], s22 offen offset:3072   lds
M v[56:59],a[144:147],a[168:171],v[56:59]
s_sub_u32 s22, s22, 1048448
v_add_u32 v20, s64, v5
v_add_u32 v21, s64, v6
M v[52:55],a[136:139],a[168:171],v[52:55]
v_lshrrev_b32 v28, 2, v0
v_lshlrev_b32 v28, 8, v28
M v[52:55],a[140:143],a[172:175],v[52:55]
T a[48:49],v3,32768
T a[50:51],v3,33792
M v[48:51],a[132:135],a[172:175],v[48:51]
SA m0,s23,16384
v_and_b32 v29, 3, v0
v_lshl_add_u32 v28, v29, 3, v28
M v[48:51],a[128:131],a[168:171],v[48:51]
buffer_load_dwordx4 v8, s[16:19], s21 offen offset:0   lds
M v[44:47],a[120:123],a[168:171],v[44:47]
v_add_u32 v28, s87, v28
M v[44:47],a[124:127],a[172:175],v[44:47]
s_waitcnt vmcnt(23)
s_nop 0
T a[176:177],v28,0
T a[178:179],v28,32
M v[40:43],a[116:119],a[172:175],v[40:43]
T a[52:53],v3,40960
T a[54:55],v3,41984
M v[40:43],a[112:115],a[168:171],v[40:43]
T a[180:181],v28,64
T a[182:183],v28,96
M v[36:39],a[104:107],a[168:171],v[36:39]
buffer_load_dwordx4 v9, s[16:19], s21 offen offset:1024   lds
M v[36:39],a[108:111],a[172:175],v[36:39]
s_waitcnt lgkmcnt(10)
s_nop 0
T a[184:185],v28,128
T a[186:187],v28,160
M v[32:35],a[100:103],a[172:175],v[32:35]
T a[188:189],v28,192
M v[32:35],a[96:99],a[168:171],v[32:35]
s_nop 0
T a[56:57],v4,32768
T a[58:59],v4,33792
M v[64:67],a[96:99],a[160:163],v[64:67]
R a[168:171],v5,6144
R a[172:175],v6,6144
M v[64:67],a[100:103],a[164:167],v[64:67]
buffer_load_dwordx4 v10, s[16:19], s21 offen offset:2048   lds
s_waitcnt lgkmcnt(12)
v_mfma_f32_16x16x16_bf16 a[192:195], a[176:177], v[16:17], 0
M v[68:71],a[108:111],a[164:167],v[68:71]
v_mov_b32 v18, v16 row_shr:2 row_mask:0xf bank_mask:0xf bound_ctrl:0
v_mov_b32 v19, v17 row_shr:2 row_mask:0xf bank_mask:0xf bound_ctrl:0
M v[68:71],a[104:107],a[160:163],v[68:71]
M v[72:75],a[112:115],a[160:163],v[72:75]
s_nop 0
T a[60:61],v4,40960
T a[62:63],v4,41984
M v[72:75],a[116:119],a[164:167],v[72:75]
s_waitcnt lgkmcnt(13)
v_mfma_f32_16x16x16_bf16 a[192:195], a[178:179], v[18:19], a[192:195]
M v[76:79],a[124:127],a[164:167],v[76:79]
buffer_load_dwordx4 v11, s[16:19], s21 offen offset:3072   lds
M v[76:79],a[120:123],a[160:163],v[76:79]
SA s21,s21,524160
v_mov_b32 v16, v18 row_shr:2 row_mask:0xf bank_mask:0xf bound_ctrl:0
v_mov_b32 v17, v19 row_shr:2 row_mask:0xf bank_mask:0xf bound_ctrl:0
M v[80:83],a[128:131],a[160:163],v[80:83]
M v[80:83],a[132:135],a[164:167],v[80:83]
s_waitcnt lgkmcnt(10)
v_mfma_f32_16x16x16_bf16 a[192:195], a[180:181], v[16:17], a[192:195]
M v[84:87],a[140:143],a[164:167],v[84:87]
v_mov_b32 v18, v16 row_shr:2 row_mask:0xf bank_mask:0xf bound_ctrl:0
v_mov_b32 v19, v17 row_shr:2 row_mask:0xf bank_mask:0xf bound_ctrl:0
M v[84:87],a[136:139],a[160:163],v[84:87]
M v[88:91],a[144:147],a[160:163],v[88:91]
M v[88:91],a[148:151],a[164:167],v[88:91]
s_waitcnt lgkmcnt(2)
v_mfma_f32_16x16x16_bf16 a[192:195], a[182:183], v[18:19], a[192:195]
M v[92:95],a[156:159],a[164:167],v[92:95]
s_waitcnt vmcnt(16) lgkmcnt(0)
v_mov_b32 v16, v18 row_shr:2 row_mask:0xf bank_mask:0xf bound_ctrl:0
v_mov_b32 v17, v19 row_shr:2 row_mask:0xf bank_mask:0xf bound_ctrl:0
M v[92:95],a[152:155],a[160:163],v[92:95]
s_barrier
M v[124:127],a[152:155],a[168:171],v[124:127]
R a[160:163],v5,16384
R a[164:167],v6,16384
M v[124:127],a[156:159],a[172:175],v[124:127]
SA m0,s23,131072
v_mfma_f32_16x16x16_bf16 a[192:195], a[184:185], v[16:17], a[192:195]
M v[120:123],a[148:151],a[172:175],v[120:123]
s_nop 0
T a[64:65],v1,49152
T a[66:67],v1,50176
M v[120:123],a[144:147],a[168:171],v[120:123]
v_mov_b32 v18, v16 row_shr:2 row_mask:0xf bank_mask:0xf bound_ctrl:0
v_mov_b32 v19, v17 row_shr:2 row_mask:0xf bank_mask:0xf bound_ctrl:0
M v[116:119],a[136:139],a[168:171],v[116:119]
buffer_load_dwordx4 v22, s[56:59], s29 offen offset:0 lds
M v[116:119],a[140:143],a[172:175],v[116:119]
v_mfma_f32_16x16x16_bf16 a[192:195], a[186:187], v[18:19], a[192:195]
M v[112:115],a[132:135],a[172:175],v[112:115]
v_mov_b32 v16, v18 row_shr:2 row_mask:0xf bank_mask:0xf bound_ctrl:0
v_mov_b32 v17, v19 row_shr:2 row_mask:0xf bank_mask:0xf bound_ctrl:0
M v[112:115],a[128:131],a[168:171],v[112:115]
buffer_load_dwordx4 v23, s[56:59], s29 offen offset:1024 lds
M v[108:111],a[120:123],a[168:171],v[108:111]
M v[108:111],a[124:127],a[172:175],v[108:111]
s_nop 0
T a[68:69],v1,57344
T a[70:71],v1,58368
v_mfma_f32_16x16x16_bf16 a[192:195], a[188:189], v[16:17], a[192:195]
M v[104:107],a[116:119],a[172:175],v[104:107]
buffer_load_dwordx4 v22, s[56:59], s30 offen offset:2048 lds
M v[104:107],a[112:115],a[168:171],v[104:107]
v_and_b32 v29, 1, v0
v_mul_u32_u24 v30, 1792, v29
M v[100:103],a[104:107],a[168:171],v[100:103]
v_lshrrev_b32 v31, 4, v0
v_lshl_add_u32 v30, v31, 4, v30
M v[100:103],a[108:111],a[172:175],v[100:103]
s_waitcnt lgkmcnt(4)
v_bfe_u32 v29, v0, 1, 3
v_lshl_add_u32 v30, v29, 6, v30
M v[96:99],a[100:103],a[172:175],v[96:99]
v_add_u32 v29, 1, v29
v_lshrrev_b32 v29, 3, v29
M v[96:99],a[96:99],a[168:171],v[96:99]
v_lshl_or_b32 v30, v29, 29, v30
v_or_b32 v30, s88, v30
M v[128:131],a[96:99],a[160:163],v[128:131]
s_mul_i32 s89, s86, 3584
R a[168:171],v5,18432
R a[172:175],v6,18432
M v[128:131],a[100:103],a[164:167],v[128:131]
s_mul_i32 s64, s20, 448
T a[72:73],v2,49152
T a[74:75],v2,50176
M v[132:135],a[108:111],a[164:167],v[132:135]
SA s89,s89,s64
M v[132:135],a[104:107],a[160:163],v[132:135]
SA s89,s89,105906176
buffer_store_dwordx4 a[192:195], v30, s[8:11], s89 offen sc1
M v[136:139],a[112:115],a[160:163],v[136:139]
M v[136:139],a[116:119],a[164:167],v[136:139]
M v[140:143],a[124:127],a[164:167],v[140:143]
buffer_load_dwordx4 v23, s[56:59], s30 offen offset:3072 lds
M v[140:143],a[120:123],a[160:163],v[140:143]
SA s29,s29,128
T a[76:77],v2,57344
T a[78:79],v2,58368
M v[144:147],a[128:131],a[160:163],v[144:147]
SA s30,s30,128
M v[144:147],a[132:135],a[164:167],v[144:147]
SA m0,s24,0
M v[148:151],a[140:143],a[164:167],v[148:151]
buffer_load_dwordx4 v12, s[48:51], s22 offen offset:0   lds
M v[148:151],a[136:139],a[160:163],v[148:151]
M v[152:155],a[144:147],a[160:163],v[152:155]
M v[152:155],a[148:151],a[164:167],v[152:155]
s_waitcnt lgkmcnt(4)
buffer_load_dwordx4 v13, s[48:51], s22 offen offset:1024   lds
M v[156:159],a[156:159],a[164:167],v[156:159]
s_nop 0
T a[80:81],v3,49152
T a[82:83],v3,50176
M v[156:159],a[152:155],a[160:163],v[156:159]
M v[188:191],a[152:155],a[168:171],v[188:191]
R a[160:163],v5,20480
R a[164:167],v6,20480
M v[188:191],a[156:159],a[172:175],v[188:191]
buffer_load_dwordx4 v14, s[48:51], s22 offen offset:2048   lds
M v[184:187],a[148:151],a[172:175],v[184:187]
M v[184:187],a[144:147],a[168:171],v[184:187]
M v[180:183],a[136:139],a[168:171],v[180:183]
buffer_load_dwordx4 v15, s[48:51], s22 offen offset:3072   lds
M v[180:183],a[140:143],a[172:175],v[180:183]
SA s22,s22,1048576
T a[84:85],v3,57344
T a[86:87],v3,58368
M v[176:179],a[132:135],a[172:175],v[176:179]
SA m0,s23,32768
M v[176:179],a[128:131],a[168:171],v[176:179]
buffer_load_dwordx4 v8, s[16:19], s21 offen offset:0   lds
M v[172:175],a[120:123],a[168:171],v[172:175]
M v[172:175],a[124:127],a[172:175],v[172:175]
M v[168:171],a[116:119],a[172:175],v[168:171]
M v[168:171],a[112:115],a[168:171],v[168:171]
L_w_kv06:
s_cbranch_execz L_wd1
buffer_load_dwordx4 v9, s[16:19], s21 offen offset:1024   lds
M v[164:167],a[104:107],a[168:171],v[164:167]
s_nop 0
T a[88:89],v4,49152
T a[90:91],v4,50176
M v[164:167],a[108:111],a[172:175],v[164:167]
s_waitcnt lgkmcnt(4)
M v[160:163],a[100:103],a[172:175],v[160:163]
M v[160:163],a[96:99],a[168:171],v[160:163]
M v[192:195],a[96:99],a[160:163],v[192:195]
R a[168:171],v5,22528
R a[172:175],v6,22528
M v[192:195],a[100:103],a[164:167],v[192:195]
buffer_load_dwordx4 v10, s[16:19], s21 offen offset:2048   lds
M v[196:199],a[108:111],a[164:167],v[196:199]
M v[196:199],a[104:107],a[160:163],v[196:199]
s_nop 0
T a[92:93],v4,57344
T a[94:95],v4,58368
M v[200:203],a[112:115],a[160:163],v[200:203]
M v[200:203],a[116:119],a[164:167],v[200:203]
buffer_load_dwordx4 v11, s[16:19], s21 offen offset:3072   lds
M v[204:207],a[124:127],a[164:167],v[204:207]
M v[204:207],a[120:123],a[160:163],v[204:207]
M v[208:211],a[128:131],a[160:163],v[208:211]
M v[208:211],a[132:135],a[164:167],v[208:211]
M v[212:215],a[140:143],a[164:167],v[212:215]
SA s21,s21,128
M v[212:215],a[136:139],a[160:163],v[212:215]
M v[216:219],a[144:147],a[160:163],v[216:219]
M v[216:219],a[148:151],a[164:167],v[216:219]
s_waitcnt lgkmcnt(2)
M v[220:223],a[156:159],a[164:167],v[220:223]
s_waitcnt vmcnt(21) lgkmcnt(0)
M v[220:223],a[152:155],a[160:163],v[220:223]
s_barrier
M v[252:255],a[152:155],a[168:171],v[252:255]
R a[160:163],v5,32768
R a[164:167],v6,32768
M v[252:255],a[156:159],a[172:175],v[252:255]
M v[248:251],a[148:151],a[172:175],v[248:251]
M v[248:251],a[144:147],a[168:171],v[248:251]
M v[244:247],a[136:139],a[168:171],v[244:247]
M v[244:247],a[140:143],a[172:175],v[244:247]
M v[240:243],a[132:135],a[172:175],v[240:243]
M v[240:243],a[128:131],a[168:171],v[240:243]
M v[236:239],a[120:123],a[168:171],v[236:239]
M v[236:239],a[124:127],a[172:175],v[236:239]
M v[232:235],a[116:119],a[172:175],v[232:235]
M v[232:235],a[112:115],a[168:171],v[232:235]
M v[228:231],a[104:107],a[168:171],v[228:231]
M v[228:231],a[108:111],a[172:175],v[228:231]
s_waitcnt lgkmcnt(0)
M v[224:227],a[100:103],a[172:175],v[224:227]
M v[224:227],a[96:99],a[168:171],v[224:227]
M a[0:3],a[32:35],a[160:163],a[0:3]
R a[168:171],v5,34816
R a[172:175],v6,34816
M a[0:3],a[36:39],a[164:167],a[0:3]
SA m0,s23,147456
T a[96:97],v1,0
T a[98:99],v1,1024
M a[4:7],a[44:47],a[164:167],a[4:7]
buffer_load_dwordx4 v22, s[56:59], s29 offen offset:0 lds
M a[4:7],a[40:43],a[160:163],a[4:7]
M a[8:11],a[48:51],a[160:163],a[8:11]
M a[8:11],a[52:55],a[164:167],a[8:11]
buffer_load_dwordx4 v23, s[56:59], s29 offen offset:1024 lds
M a[12:15],a[60:63],a[164:167],a[12:15]
s_nop 0
T a[100:101],v1,8192
T a[102:103],v1,9216
M a[12:15],a[56:59],a[160:163],a[12:15]
M a[16:19],a[64:67],a[160:163],a[16:19]
buffer_load_dwordx4 v22, s[56:59], s30 offen offset:2048 lds
M a[16:19],a[68:71],a[164:167],a[16:19]
M a[20:23],a[76:79],a[164:167],a[20:23]
M a[20:23],a[72:75],a[160:163],a[20:23]
s_nop 0
T a[104:105],v2,0
T a[106:107],v2,1024
M a[24:27],a[80:83],a[160:163],a[24:27]
buffer_load_dwordx4 v23, s[56:59], s30 offen offset:3072 lds
M a[24:27],a[84:87],a[164:167],a[24:27]
s_waitcnt lgkmcnt(6)
M a[28:31],a[92:95],a[164:167],a[28:31]
SA s29,s29,128
M a[28:31],a[88:91],a[160:163],a[28:31]
SA s30,s30,128
M v[60:63],a[88:91],a[168:171],v[60:63]
SA m0,s24,16384
R a[160:163],v5,36864
R a[164:167],v6,36864
M v[60:63],a[92:95],a[172:175],v[60:63]
T a[108:109],v2,8192
T a[110:111],v2,9216
M v[56:59],a[84:87],a[172:175],v[56:59]
buffer_load_dwordx4 v12, s[48:51], s22 offen offset:0   lds
M v[56:59],a[80:83],a[168:171],v[56:59]
M v[52:55],a[72:75],a[168:171],v[52:55]
M v[52:55],a[76:79],a[172:175],v[52:55]
s_nop 0
T a[112:113],v3,0
T a[114:115],v3,1024
M v[48:51],a[68:71],a[172:175],v[48:51]
buffer_load_dwordx4 v13, s[48:51], s22 offen offset:1024   lds
M v[48:51],a[64:67],a[168:171],v[48:51]
M v[44:47],a[56:59],a[168:171],v[44:47]
M v[44:47],a[60:63],a[172:175],v[44:47]
buffer_load_dwordx4 v14, s[48:51], s22 offen offset:2048   lds
M v[40:43],a[52:55],a[172:175],v[40:43]
s_nop 0
T a[116:117],v3,8192
T a[118:119],v3,9216
M v[40:43],a[48:51],a[168:171],v[40:43]
M v[36:39],a[40:43],a[168:171],v[36:39]
buffer_load_dwordx4 v15, s[48:51], s22 offen offset:3072   lds
M v[36:39],a[44:47],a[172:175],v[36:39]
s_waitcnt lgkmcnt(6)
M v[32:35],a[36:39],a[172:175],v[32:35]
s_sub_u32 s22, s22, 1048448
M v[32:35],a[32:35],a[168:171],v[32:35]
SA m0,s23,49152
T a[120:121],v4,0
T a[122:123],v4,1024
M v[64:67],a[32:35],a[160:163],v[64:67]
R a[168:171],v5,38912
R a[172:175],v6,38912
M v[64:67],a[36:39],a[164:167],v[64:67]
buffer_load_dwordx4 v8, s[16:19], s21 offen offset:0   lds
M v[68:71],a[44:47],a[164:167],v[68:71]
M v[68:71],a[40:43],a[160:163],v[68:71]
M v[72:75],a[48:51],a[160:163],v[72:75]
s_waitcnt vmcnt(17)
s_nop 0
T a[124:125],v4,8192
T a[126:127],v4,9216
M v[72:75],a[52:55],a[164:167],v[72:75]
buffer_load_dwordx4 v9, s[16:19], s21 offen offset:1024   lds
M v[76:79],a[60:63],a[164:167],v[76:79]
R a[176:179],v20,0
R a[180:183],v20,2048
M v[76:79],a[56:59],a[160:163],v[76:79]
R a[184:187],v21,0
R a[188:191],v21,2048
M v[80:83],a[64:67],a[160:163],v[80:83]
buffer_load_dwordx4 v10, s[16:19], s21 offen offset:2048   lds
M v[80:83],a[68:71],a[164:167],v[80:83]
M v[84:87],a[76:79],a[164:167],v[84:87]
M v[84:87],a[72:75],a[160:163],v[84:87]
buffer_load_dwordx4 v11, s[16:19], s21 offen offset:3072   lds
M v[88:91],a[80:83],a[160:163],v[88:91]
SA s21,s21,524160
M v[88:91],a[84:87],a[164:167],v[88:91]
s_waitcnt lgkmcnt(6)
M v[92:95],a[92:95],a[164:167],v[92:95]
s_waitcnt lgkmcnt(0)
M v[92:95],a[88:91],a[160:163],v[92:95]
s_barrier
M v[124:127],a[88:91],a[168:171],v[124:127]
s_lshl_b32 s4, s20, 10
R a[160:163],v5,49152
R a[164:167],v6,49152
M v[124:127],a[92:95],a[172:175],v[124:127]
SA m0,s23,131072
v_bfe_u32 v28, v0, 3, 2
M v[120:123],a[84:87],a[172:175],v[120:123]
s_nop 0
T a[128:129],v1,16384
T a[130:131],v1,17408
M v[120:123],a[80:83],a[168:171],v[120:123]
buffer_load_dwordx4 v22, s[56:59], s29 offen offset:0 lds
M v[116:119],a[72:75],a[168:171],v[116:119]
v_lshrrev_b32 v29, 5, v0
v_lshl_add_u32 v28, v29, 3, v28
M v[116:119],a[76:79],a[172:175],v[116:119]
M v[112:115],a[68:71],a[172:175],v[112:115]
v_lshlrev_b32 v28, 13, v28
M v[112:115],a[64:67],a[168:171],v[112:115]
M v[108:111],a[56:59],a[168:171],v[108:111]
buffer_load_dwordx4 v23, s[56:59], s29 offen offset:1024 lds
M v[108:111],a[60:63],a[172:175],v[108:111]
s_nop 0
T a[132:133],v1,24576
T a[134:135],v1,25600
M v[104:107],a[52:55],a[172:175],v[104:107]
v_lshrrev_b32 v29, 4, v0
v_lshlrev_b32 v29, 1, v29
M v[104:107],a[48:51],a[168:171],v[104:107]
M v[100:103],a[40:43],a[168:171],v[100:103]
v_and_b32 v30, 7, v0
M v[100:103],a[44:47],a[172:175],v[100:103]
s_waitcnt lgkmcnt(4)
M v[96:99],a[36:39],a[172:175],v[96:99]
v_xor_b32 v29, v29, v30
M v[96:99],a[32:35],a[168:171],v[96:99]
buffer_load_dwordx4 v22, s[56:59], s30 offen offset:2048 lds
M v[128:131],a[32:35],a[160:163],v[128:131]
R a[168:171],v5,51200
R a[172:175],v6,51200
M v[128:131],a[36:39],a[164:167],v[128:131]
T a[136:137],v2,16384
T a[138:139],v2,17408
M v[132:135],a[44:47],a[164:167],v[132:135]
v_lshl_add_u32 v28, v29, 4, v28
M v[132:135],a[40:43],a[160:163],v[132:135]
s_and_b32 s64, s20, 1
M v[136:139],a[48:51],a[160:163],v[136:139]
s_lshl_b32 s64, s64, 17
M v[136:139],a[52:55],a[164:167],v[136:139]
s_lshr_b32 s65, s20, 1
M v[140:143],a[60:63],a[164:167],v[140:143]
s_lshl_b32 s65, s65, 15
SA s64,s64,s65
v_add_u32 v8, s64, v28
M v[140:143],a[56:59],a[160:163],v[140:143]
s_nop 0
T a[140:141],v2,24576
T a[142:143],v2,25600
M v[144:147],a[64:67],a[160:163],v[144:147]
buffer_load_dwordx4 v23, s[56:59], s30 offen offset:3072 lds
M v[144:147],a[68:71],a[164:167],v[144:147]
M v[148:151],a[76:79],a[164:167],v[148:151]
SA s29,s29,128
M v[148:151],a[72:75],a[160:163],v[148:151]
SA s30,s30,128
M v[152:155],a[80:83],a[160:163],v[152:155]
SA m0,s24,32768
M v[152:155],a[84:87],a[164:167],v[152:155]
s_waitcnt lgkmcnt(4)
buffer_load_dwordx4 v12, s[48:51], s22 offen offset:0   lds
M v[156:159],a[92:95],a[164:167],v[156:159]
s_nop 0
T a[144:145],v3,16384
T a[146:147],v3,17408
M v[156:159],a[88:91],a[160:163],v[156:159]
M v[188:191],a[88:91],a[168:171],v[188:191]
R a[160:163],v5,53248
R a[164:167],v6,53248
M v[188:191],a[92:95],a[172:175],v[188:191]
M v[184:187],a[84:87],a[172:175],v[184:187]
M v[184:187],a[80:83],a[168:171],v[184:187]
M v[180:183],a[72:75],a[168:171],v[180:183]
buffer_load_dwordx4 v13, s[48:51], s22 offen offset:1024   lds
M v[180:183],a[76:79],a[172:175],v[180:183]
s_nop 0
T a[148:149],v3,24576
T a[150:151],v3,25600
M v[176:179],a[68:71],a[172:175],v[176:179]
M v[176:179],a[64:67],a[168:171],v[176:179]
M v[172:175],a[56:59],a[168:171],v[172:175]
M v[172:175],a[60:63],a[172:175],v[172:175]
M v[168:171],a[52:55],a[172:175],v[168:171]
M v[168:171],a[48:51],a[168:171],v[168:171]
buffer_load_dwordx4 v14, s[48:51], s22 offen offset:2048   lds
M v[164:167],a[40:43],a[168:171],v[164:167]
s_nop 0
T a[152:153],v4,16384
T a[154:155],v4,17408
M v[164:167],a[44:47],a[172:175],v[164:167]
s_waitcnt lgkmcnt(4)
M v[160:163],a[36:39],a[172:175],v[160:163]
M v[160:163],a[32:35],a[168:171],v[160:163]
M v[192:195],a[32:35],a[160:163],v[192:195]
R a[168:171],v5,55296
R a[172:175],v6,55296
M v[192:195],a[36:39],a[164:167],v[192:195]
M v[196:199],a[44:47],a[164:167],v[196:199]
buffer_load_dwordx4 v15, s[48:51], s22 offen offset:3072   lds
M v[196:199],a[40:43],a[160:163],v[196:199]
s_nop 0
T a[156:157],v4,24576
T a[158:159],v4,25600
M v[200:203],a[48:51],a[160:163],v[200:203]
s_waitcnt vmcnt(16)
R a[192:195],v20,16384
R a[196:199],v20,18432
M v[200:203],a[52:55],a[164:167],v[200:203]
R a[200:203],v21,16384
R a[204:207],v21,18432
M v[204:207],a[60:63],a[164:167],v[204:207]
M v[204:207],a[56:59],a[160:163],v[204:207]
M v[208:211],a[64:67],a[160:163],v[208:211]
M v[208:211],a[68:71],a[164:167],v[208:211]
M v[212:215],a[76:79],a[164:167],v[212:215]
SA s22,s22,1048576
M v[212:215],a[72:75],a[160:163],v[212:215]
M v[216:219],a[80:83],a[160:163],v[216:219]
M v[216:219],a[84:87],a[164:167],v[216:219]
s_waitcnt lgkmcnt(6)
M v[220:223],a[92:95],a[164:167],v[220:223]
s_waitcnt lgkmcnt(0)
M v[220:223],a[88:91],a[160:163],v[220:223]
s_barrier
M v[252:255],a[88:91],a[168:171],v[252:255]
R a[160:163],v5,0
R a[164:167],v6,0
M v[252:255],a[92:95],a[172:175],v[252:255]
M v[248:251],a[84:87],a[172:175],v[248:251]
M v[248:251],a[80:83],a[168:171],v[248:251]
M v[244:247],a[72:75],a[168:171],v[244:247]
M v[244:247],a[76:79],a[172:175],v[244:247]
M v[240:243],a[68:71],a[172:175],v[240:243]
M v[240:243],a[64:67],a[168:171],v[240:243]
M v[236:239],a[56:59],a[168:171],v[236:239]
M v[236:239],a[60:63],a[172:175],v[236:239]
M v[232:235],a[52:55],a[172:175],v[232:235]
M v[232:235],a[48:51],a[168:171],v[232:235]
M v[228:231],a[40:43],a[168:171],v[228:231]
M v[228:231],a[44:47],a[172:175],v[228:231]
s_waitcnt lgkmcnt(0)
M v[224:227],a[36:39],a[172:175],v[224:227]
M v[224:227],a[32:35],a[168:171],v[224:227]
M a[0:3],a[96:99],a[160:163],a[0:3]
R a[168:171],v5,2048
R a[172:175],v6,2048
M a[0:3],a[100:103],a[164:167],a[0:3]
SA m0,s23,147456
T a[32:33],v1,32768
T a[34:35],v1,33792
M a[4:7],a[108:111],a[164:167],a[4:7]
buffer_load_dwordx4 v22, s[56:59], s29 offen offset:0 lds
M a[4:7],a[104:107],a[160:163],a[4:7]
M a[8:11],a[112:115],a[160:163],a[8:11]
M a[8:11],a[116:119],a[164:167],a[8:11]
buffer_load_dwordx4 v23, s[56:59], s29 offen offset:1024 lds
M a[12:15],a[124:127],a[164:167],a[12:15]
s_nop 0
T a[36:37],v1,40960
T a[38:39],v1,41984
M a[12:15],a[120:123],a[160:163],a[12:15]
M a[16:19],a[128:131],a[160:163],a[16:19]
buffer_load_dwordx4 v22, s[56:59], s30 offen offset:2048 lds
M a[16:19],a[132:135],a[164:167],a[16:19]
M a[20:23],a[140:143],a[164:167],a[20:23]
M a[20:23],a[136:139],a[160:163],a[20:23]
s_nop 0
T a[40:41],v2,32768
T a[42:43],v2,33792
M a[24:27],a[144:147],a[160:163],a[24:27]
buffer_load_dwordx4 v23, s[56:59], s30 offen offset:3072 lds
M a[24:27],a[148:151],a[164:167],a[24:27]
s_waitcnt lgkmcnt(6)
M a[28:31],a[156:159],a[164:167],a[28:31]
SA s29,s29,128
M a[28:31],a[152:155],a[160:163],a[28:31]
SA s30,s30,128
M v[60:63],a[152:155],a[168:171],v[60:63]
SA m0,s24,49152
R a[160:163],v5,4096
R a[164:167],v6,4096
M v[60:63],a[156:159],a[172:175],v[60:63]
T a[44:45],v2,40960
T a[46:47],v2,41984
M v[56:59],a[148:151],a[172:175],v[56:59]
buffer_load_dwordx4 v12, s[48:51], s22 offen offset:0   lds
M v[56:59],a[144:147],a[168:171],v[56:59]
M v[52:55],a[136:139],a[168:171],v[52:55]
M v[52:55],a[140:143],a[172:175],v[52:55]
s_nop 0
T a[48:49],v3,32768
T a[50:51],v3,33792
M v[48:51],a[132:135],a[172:175],v[48:51]
buffer_load_dwordx4 v13, s[48:51], s22 offen offset:1024   lds
M v[48:51],a[128:131],a[168:171],v[48:51]
M v[44:47],a[120:123],a[168:171],v[44:47]
M v[44:47],a[124:127],a[172:175],v[44:47]
buffer_load_dwordx4 v14, s[48:51], s22 offen offset:2048   lds
M v[40:43],a[116:119],a[172:175],v[40:43]
s_nop 0
T a[52:53],v3,40960
T a[54:55],v3,41984
M v[40:43],a[112:115],a[168:171],v[40:43]
M v[36:39],a[104:107],a[168:171],v[36:39]
buffer_load_dwordx4 v15, s[48:51], s22 offen offset:3072   lds
M v[36:39],a[108:111],a[172:175],v[36:39]
s_waitcnt lgkmcnt(6)
M v[32:35],a[100:103],a[172:175],v[32:35]
s_sub_u32 s22, s22, 1048448
M v[32:35],a[96:99],a[168:171],v[32:35]
s_mov_b32 s25, 0
T a[56:57],v4,32768
T a[58:59],v4,33792
M v[64:67],a[96:99],a[160:163],v[64:67]
SA m0,s4,0
R a[168:171],v5,6144
R a[172:175],v6,6144
M v[64:67],a[100:103],a[164:167],v[64:67]
buffer_load_dwordx4 v8, s[52:55], s25 offen lds
M v[68:71],a[108:111],a[164:167],v[68:71]
s_mov_b32 s25, 262144
M v[68:71],a[104:107],a[160:163],v[68:71]
SA m0,s4,4096
M v[72:75],a[112:115],a[160:163],v[72:75]
s_waitcnt vmcnt(13)
s_nop 0
T a[60:61],v4,40960
T a[62:63],v4,41984
M v[72:75],a[116:119],a[164:167],v[72:75]
buffer_load_dwordx4 v8, s[52:55], s25 offen lds
M v[76:79],a[124:127],a[164:167],v[76:79]
s_mov_b32 s25, 524288
R a[208:211],v20,0
R a[212:215],v20,2048
M v[76:79],a[120:123],a[160:163],v[76:79]
SA m0,s4,8192
R a[216:219],v21,0
R a[220:223],v21,2048
M v[80:83],a[128:131],a[160:163],v[80:83]
buffer_load_dwordx4 v8, s[52:55], s25 offen lds
M v[80:83],a[132:135],a[164:167],v[80:83]
s_mov_b32 s25, 786432
M v[84:87],a[140:143],a[164:167],v[84:87]
SA m0,s4,12288
M v[84:87],a[136:139],a[160:163],v[84:87]
buffer_load_dwordx4 v8, s[52:55], s25 offen lds
M v[88:91],a[144:147],a[160:163],v[88:91]
M v[88:91],a[148:151],a[164:167],v[88:91]
s_waitcnt lgkmcnt(6)
M v[92:95],a[156:159],a[164:167],v[92:95]
s_waitcnt lgkmcnt(0)
M v[92:95],a[152:155],a[160:163],v[92:95]
s_barrier
M v[124:127],a[152:155],a[168:171],v[124:127]
R a[160:163],v5,16384
R a[164:167],v6,16384
M v[124:127],a[156:159],a[172:175],v[124:127]
SA m0,s23,32768
M v[120:123],a[148:151],a[172:175],v[120:123]
s_nop 0
T a[64:65],v1,49152
T a[66:67],v1,50176
M v[120:123],a[144:147],a[168:171],v[120:123]
buffer_load_dwordx4 v22, s[56:59], s29 offen offset:0 lds
M v[116:119],a[136:139],a[168:171],v[116:119]
v_lshrrev_b32 v28, 2, v0
v_lshlrev_b32 v28, 7, v28
M v[116:119],a[140:143],a[172:175],v[116:119]
M v[112:115],a[132:135],a[172:175],v[112:115]
buffer_load_dwordx4 v23, s[56:59], s29 offen offset:1024 lds
M v[112:115],a[128:131],a[168:171],v[112:115]
v_and_b32 v29, 3, v0
M v[108:111],a[120:123],a[168:171],v[108:111]
v_lshl_add_u32 v28, v29, 3, v28
M v[108:111],a[124:127],a[172:175],v[108:111]
s_nop 0
T a[68:69],v1,57344
T a[70:71],v1,58368
M v[104:107],a[116:119],a[172:175],v[104:107]
buffer_load_dwordx4 v22, s[56:59], s30 offen offset:2048 lds
M v[104:107],a[112:115],a[168:171],v[104:107]
v_bfe_u32 v29, v0, 3, 2
M v[100:103],a[104:107],a[168:171],v[100:103]
M v[100:103],a[108:111],a[172:175],v[100:103]
s_waitcnt lgkmcnt(4)
v_lshl_add_u32 v16, v29, 5, v28
M v[96:99],a[100:103],a[172:175],v[96:99]
M v[96:99],a[96:99],a[168:171],v[96:99]
buffer_load_dwordx4 v23, s[56:59], s30 offen offset:3072 lds
M v[128:131],a[96:99],a[160:163],v[128:131]
R a[168:171],v5,18432
R a[172:175],v6,18432
M v[128:131],a[100:103],a[164:167],v[128:131]
SA s29,s29,128
T a[72:73],v2,49152
T a[74:75],v2,50176
M v[132:135],a[108:111],a[164:167],v[132:135]
SA s30,s30,128
v_xor_b32 v17, 32, v16
v_xor_b32 v18, 64, v16
M v[132:135],a[104:107],a[160:163],v[132:135]
SA m0,s23,65536
M v[136:139],a[112:115],a[160:163],v[136:139]
buffer_load_dwordx4 v22, s[56:59], s29 offen offset:0 lds
M v[136:139],a[116:119],a[164:167],v[136:139]
v_xor_b32 v19, 0x60, v16
M v[140:143],a[124:127],a[164:167],v[140:143]
v_add_u32 v12, 0x20000, v16
M v[140:143],a[120:123],a[160:163],v[140:143]
s_nop 0
T a[76:77],v2,57344
T a[78:79],v2,58368
M v[144:147],a[128:131],a[160:163],v[144:147]
buffer_load_dwordx4 v23, s[56:59], s29 offen offset:1024 lds
M v[144:147],a[132:135],a[164:167],v[144:147]
v_add_u32 v13, 0x20000, v17
M v[148:151],a[140:143],a[164:167],v[148:151]
M v[148:151],a[136:139],a[160:163],v[148:151]
v_add_u32 v14, 0x20000, v18
M v[152:155],a[144:147],a[160:163],v[152:155]
M v[152:155],a[148:151],a[164:167],v[152:155]
s_waitcnt lgkmcnt(4)
buffer_load_dwordx4 v22, s[56:59], s30 offen offset:2048 lds
M v[156:159],a[156:159],a[164:167],v[156:159]
s_nop 0
T a[80:81],v3,49152
T a[82:83],v3,50176
M v[156:159],a[152:155],a[160:163],v[156:159]
v_add_u32 v15, 0x20000, v19
M v[188:191],a[152:155],a[168:171],v[188:191]
R a[160:163],v5,20480
R a[164:167],v6,20480
M v[188:191],a[156:159],a[172:175],v[188:191]
M v[184:187],a[148:151],a[172:175],v[184:187]
buffer_load_dwordx4 v23, s[56:59], s30 offen offset:3072 lds
M v[184:187],a[144:147],a[168:171],v[184:187]
SA s29,s29,128
M v[180:183],a[136:139],a[168:171],v[180:183]
SA s30,s30,128
M v[180:183],a[140:143],a[172:175],v[180:183]
s_mov_b32 s25, 1048576
T a[84:85],v3,57344
T a[86:87],v3,58368
M v[176:179],a[132:135],a[172:175],v[176:179]
SA m0,s4,16384
M v[176:179],a[128:131],a[168:171],v[176:179]
buffer_load_dwordx4 v8, s[52:55], s25 offen lds
M v[172:175],a[120:123],a[168:171],v[172:175]
M v[172:175],a[124:127],a[172:175],v[172:175]
s_mov_b32 s25, 1310720
M v[168:171],a[116:119],a[172:175],v[168:171]
SA m0,s4,20480
M v[168:171],a[112:115],a[168:171],v[168:171]
buffer_load_dwordx4 v8, s[52:55], s25 offen lds
M v[164:167],a[104:107],a[168:171],v[164:167]
s_nop 0
T a[88:89],v4,49152
T a[90:91],v4,50176
M v[164:167],a[108:111],a[172:175],v[164:167]
s_waitcnt lgkmcnt(4)
M v[160:163],a[100:103],a[172:175],v[160:163]
s_mov_b32 s25, 1572864
M v[160:163],a[96:99],a[168:171],v[160:163]
SA m0,s4,24576
M v[192:195],a[96:99],a[160:163],v[192:195]
R a[168:171],v5,22528
R a[172:175],v6,22528
M v[192:195],a[100:103],a[164:167],v[192:195]
buffer_load_dwordx4 v8, s[52:55], s25 offen lds
M v[196:199],a[108:111],a[164:167],v[196:199]
M v[196:199],a[104:107],a[160:163],v[196:199]
s_mov_b32 s25, 1835008
T a[92:93],v4,57344
T a[94:95],v4,58368
M v[200:203],a[112:115],a[160:163],v[200:203]
SA m0,s4,28672
M v[200:203],a[116:119],a[164:167],v[200:203]
s_waitcnt vmcnt(19)
L_w_kv07:
s_cbranch_execz L_wd1
buffer_load_dwordx4 v8, s[52:55], s25 offen lds
M v[204:207],a[124:127],a[164:167],v[204:207]
R a[224:227],v20,16384
R a[228:231],v20,18432
M v[204:207],a[120:123],a[160:163],v[204:207]
R a[232:235],v21,16384
R a[236:239],v21,18432
M v[208:211],a[128:131],a[160:163],v[208:211]
v_subrev_u32 v20, 98304, v20
v_subrev_u32 v21, 98304, v21
M v[208:211],a[132:135],a[164:167],v[208:211]
M v[212:215],a[140:143],a[164:167],v[212:215]
M v[212:215],a[136:139],a[160:163],v[212:215]
M v[216:219],a[144:147],a[160:163],v[216:219]
M v[216:219],a[148:151],a[164:167],v[216:219]
s_waitcnt lgkmcnt(6)
M v[220:223],a[156:159],a[164:167],v[220:223]
s_waitcnt lgkmcnt(0)
M v[220:223],a[152:155],a[160:163],v[220:223]
s_barrier
M v[252:255],a[152:155],a[168:171],v[252:255]
R a[160:163],v5,32768
R a[164:167],v6,32768
M v[252:255],a[156:159],a[172:175],v[252:255]
M v[248:251],a[148:151],a[172:175],v[248:251]
M v[248:251],a[144:147],a[168:171],v[248:251]
M v[244:247],a[136:139],a[168:171],v[244:247]
M v[244:247],a[140:143],a[172:175],v[244:247]
M v[240:243],a[132:135],a[172:175],v[240:243]
M v[240:243],a[128:131],a[168:171],v[240:243]
M v[236:239],a[120:123],a[168:171],v[236:239]
M v[236:239],a[124:127],a[172:175],v[236:239]
M v[232:235],a[116:119],a[172:175],v[232:235]
M v[232:235],a[112:115],a[168:171],v[232:235]
M v[228:231],a[104:107],a[168:171],v[228:231]
M v[228:231],a[108:111],a[172:175],v[228:231]
s_waitcnt lgkmcnt(0)
M v[224:227],a[100:103],a[172:175],v[224:227]
M v[224:227],a[96:99],a[168:171],v[224:227]
M a[0:3],a[32:35],a[160:163],a[0:3]
R a[168:171],v5,34816
R a[172:175],v6,34816
M a[0:3],a[36:39],a[164:167],a[0:3]
SA m0,s23,81920
M a[4:7],a[44:47],a[164:167],a[4:7]
buffer_load_dwordx4 v22, s[56:59], s29 offen offset:0 lds
M a[4:7],a[40:43],a[160:163],a[4:7]
M a[8:11],a[48:51],a[160:163],a[8:11]
M a[8:11],a[52:55],a[164:167],a[8:11]
buffer_load_dwordx4 v23, s[56:59], s29 offen offset:1024 lds
M a[12:15],a[60:63],a[164:167],a[12:15]
M a[12:15],a[56:59],a[160:163],a[12:15]
G v24,a0
G v25,a1
M a[16:19],a[64:67],a[160:163],a[16:19]
G v26,a2
G v27,a3
M a[16:19],a[68:71],a[164:167],a[16:19]
buffer_load_dwordx4 v22, s[56:59], s30 offen offset:2048 lds
M a[20:23],a[76:79],a[164:167],a[20:23]
G v28,a4
G v29,a5
M a[20:23],a[72:75],a[160:163],a[20:23]
G v30,a6
G v31,a7
M a[24:27],a[80:83],a[160:163],a[24:27]
C v24,v24,v25
C v25,v26,v27
M a[24:27],a[84:87],a[164:167],a[24:27]
s_waitcnt lgkmcnt(0)
buffer_load_dwordx4 v23, s[56:59], s30 offen offset:3072 lds
M a[28:31],a[92:95],a[164:167],a[28:31]
SA s29,s29,128
C v26,v28,v29
C v27,v30,v31
M a[28:31],a[88:91],a[160:163],a[28:31]
SA s3,s93,0
buffer_store_dwordx4 v[24:27], v7, s[8:11], s3 offen offset:0 sc1
M v[32:35],a[32:35],a[168:171],v[32:35]
SA s30,s30,128
R a[160:163],v5,36864
R a[164:167],v6,36864
M v[32:35],a[36:39],a[172:175],v[32:35]
s_mov_b32 s25, 2097152
G v24,a8
G v25,a9
M v[36:39],a[44:47],a[172:175],v[36:39]
SA m0,s4,131072
G v26,a10
G v27,a11
M v[36:39],a[40:43],a[168:171],v[36:39]
buffer_load_dwordx4 v8, s[52:55], s25 offen lds
M v[40:43],a[48:51],a[168:171],v[40:43]
s_mov_b32 s25, 2359296
G v28,a12
G v29,a13
M v[40:43],a[52:55],a[172:175],v[40:43]
SA m0,s4,135168
G v30,a14
G v31,a15
M v[44:47],a[60:63],a[172:175],v[44:47]
buffer_load_dwordx4 v8, s[52:55], s25 offen lds
M v[44:47],a[56:59],a[168:171],v[44:47]
s_mov_b32 s25, 2621440
C v24,v24,v25
C v25,v26,v27
M v[48:51],a[64:67],a[168:171],v[48:51]
SA m0,s4,139264
C v26,v28,v29
C v27,v30,v31
M v[48:51],a[68:71],a[172:175],v[48:51]
buffer_store_dwordx4 v[24:27], v7, s[8:11], s3 offen offset:1024 sc1
M v[52:55],a[76:79],a[172:175],v[52:55]
s_nop 0
G v24,a16
G v25,a17
M v[52:55],a[72:75],a[168:171],v[52:55]
G v26,a18
G v27,a19
M v[56:59],a[80:83],a[168:171],v[56:59]
buffer_load_dwordx4 v8, s[52:55], s25 offen lds
M v[56:59],a[84:87],a[172:175],v[56:59]
s_waitcnt lgkmcnt(0)
G v28,a20
G v29,a21
M v[60:63],a[92:95],a[172:175],v[60:63]
s_mov_b32 s25, 2883584
G v30,a22
G v31,a23
M v[60:63],a[88:91],a[168:171],v[60:63]
SA m0,s4,143360
C v24,v24,v25
C v25,v26,v27
M v[64:67],a[32:35],a[160:163],v[64:67]
s_waitcnt vmcnt(17)
R a[168:171],v5,38912
R a[172:175],v6,38912
M v[64:67],a[36:39],a[164:167],v[64:67]
buffer_load_dwordx4 v8, s[52:55], s25 offen lds
M v[68:71],a[44:47],a[164:167],v[68:71]
s_mov_b32 s25, 3145728
C v26,v28,v29
C v27,v30,v31
M v[68:71],a[40:43],a[160:163],v[68:71]
SA m0,s4,147456
buffer_store_dwordx4 v[24:27], v7, s[8:11], s3 offen offset:2048 sc1
M v[72:75],a[48:51],a[160:163],v[72:75]
R a[96:99],v20,0
R a[100:103],v20,2048
M v[72:75],a[52:55],a[164:167],v[72:75]
R a[104:107],v21,0
R a[108:111],v21,2048
M v[76:79],a[60:63],a[164:167],v[76:79]
buffer_load_dwordx4 v8, s[52:55], s25 offen lds
M v[76:79],a[56:59],a[160:163],v[76:79]
s_mov_b32 s25, 3407872
G v24,a24
G v25,a25
M v[80:83],a[64:67],a[160:163],v[80:83]
SA m0,s4,151552
G v26,a26
G v27,a27
M v[80:83],a[68:71],a[164:167],v[80:83]
buffer_load_dwordx4 v8, s[52:55], s25 offen lds
M v[84:87],a[76:79],a[164:167],v[84:87]
G v28,a28
G v29,a29
M v[84:87],a[72:75],a[160:163],v[84:87]
G v30,a30
G v31,a31
M v[88:91],a[80:83],a[160:163],v[88:91]
C v24,v24,v25
C v25,v26,v27
M v[88:91],a[84:87],a[164:167],v[88:91]
s_waitcnt lgkmcnt(4)
C v26,v28,v29
C v27,v30,v31
M v[92:95],a[92:95],a[164:167],v[92:95]
s_waitcnt lgkmcnt(0)
buffer_store_dwordx4 v[24:27], v7, s[8:11], s3 offen offset:3072 sc1
M v[92:95],a[88:91],a[160:163],v[92:95]
s_barrier
M v[96:99],a[32:35],a[168:171],v[96:99]
R a[160:163],v5,49152
R a[164:167],v6,49152
M v[96:99],a[36:39],a[172:175],v[96:99]
s_mov_b32 s25, 128
C v64,v64,v65
C v65,v66,v67
M v[100:103],a[44:47],a[172:175],v[100:103]
SA m0,s4,49152
C v66,v68,v69
C v67,v70,v71
M v[100:103],a[40:43],a[168:171],v[100:103]
s_waitcnt vmcnt(18)
buffer_load_dwordx4 v8, s[52:55], s25 offen lds
M v[104:107],a[48:51],a[168:171],v[104:107]
C v72,v72,v73
C v73,v74,v75
M v[104:107],a[52:55],a[172:175],v[104:107]
C v74,v76,v77
C v75,v78,v79
M v[108:111],a[60:63],a[172:175],v[108:111]
C v32,v32,v33
C v33,v34,v35
M v[108:111],a[56:59],a[168:171],v[108:111]
C v34,v36,v37
C v35,v38,v39
M v[112:115],a[64:67],a[168:171],v[112:115]
SA s3,s93,8192
buffer_store_dwordx4 v[32:35], v7, s[8:11], s3 offen offset:0 sc1
M v[112:115],a[68:71],a[172:175],v[112:115]
s_mov_b32 s25, 262272
C v80,v80,v81
C v81,v82,v83
M v[116:119],a[76:79],a[172:175],v[116:119]
SA m0,s4,53248
C v82,v84,v85
C v83,v86,v87
M v[116:119],a[72:75],a[168:171],v[116:119]
R a[112:115],v20,32768
R a[116:119],v20,34816
M v[120:123],a[80:83],a[168:171],v[120:123]
buffer_load_dwordx4 v8, s[52:55], s25 offen lds
M v[120:123],a[84:87],a[172:175],v[120:123]
s_waitcnt lgkmcnt(2)
R a[120:123],v21,32768
R a[124:127],v21,34816
M v[124:127],a[92:95],a[172:175],v[124:127]
C v88,v88,v89
C v89,v90,v91
M v[124:127],a[88:91],a[168:171],v[124:127]
C v90,v92,v93
C v91,v94,v95
M v[128:131],a[32:35],a[160:163],v[128:131]
R a[168:171],v5,51200
R a[172:175],v6,51200
M v[128:131],a[36:39],a[164:167],v[128:131]
C v40,v40,v41
C v41,v42,v43
M v[132:135],a[44:47],a[164:167],v[132:135]
C v42,v44,v45
C v43,v46,v47
M v[132:135],a[40:43],a[160:163],v[132:135]
s_mov_b32 s25, 524416
buffer_store_dwordx4 v[40:43], v7, s[8:11], s3 offen offset:1024 sc1
M v[136:139],a[48:51],a[160:163],v[136:139]
SA m0,s4,57344
C v96,v96,v97
C v97,v98,v99
M v[136:139],a[52:55],a[164:167],v[136:139]
C v98,v100,v101
C v99,v102,v103
M v[140:143],a[60:63],a[164:167],v[140:143]
C v104,v104,v105
C v105,v106,v107
M v[140:143],a[56:59],a[160:163],v[140:143]
buffer_load_dwordx4 v8, s[52:55], s25 offen lds
M v[144:147],a[64:67],a[160:163],v[144:147]
C v106,v108,v109
C v107,v110,v111
M v[144:147],a[68:71],a[164:167],v[144:147]
C v112,v112,v113
C v113,v114,v115
M v[148:151],a[76:79],a[164:167],v[148:151]
C v114,v116,v117
C v115,v118,v119
M v[148:151],a[72:75],a[160:163],v[148:151]
C v48,v48,v49
C v49,v50,v51
M v[152:155],a[80:83],a[160:163],v[152:155]
C v50,v52,v53
C v51,v54,v55
M v[152:155],a[84:87],a[164:167],v[152:155]
s_waitcnt lgkmcnt(0)
buffer_store_dwordx4 v[48:51], v7, s[8:11], s3 offen offset:2048 sc1
M v[156:159],a[92:95],a[164:167],v[156:159]
s_mov_b32 s25, 786560
C v120,v120,v121
C v121,v122,v123
M v[156:159],a[88:91],a[160:163],v[156:159]
SA m0,s4,61440
C v122,v124,v125
C v123,v126,v127
M v[160:163],a[32:35],a[168:171],v[160:163]
R a[160:163],v5,53248
R a[164:167],v6,53248
M v[160:163],a[36:39],a[172:175],v[160:163]
buffer_load_dwordx4 v8, s[52:55], s25 offen lds
M v[164:167],a[44:47],a[172:175],v[164:167]
C v128,v128,v129
C v129,v130,v131
M v[164:167],a[40:43],a[168:171],v[164:167]
C v130,v132,v133
C v131,v134,v135
M v[168:171],a[48:51],a[168:171],v[168:171]
C v56,v56,v57
C v57,v58,v59
M v[168:171],a[52:55],a[172:175],v[168:171]
C v58,v60,v61
C v59,v62,v63
M v[172:175],a[60:63],a[172:175],v[172:175]
buffer_store_dwordx4 v[56:59], v7, s[8:11], s3 offen offset:3072 sc1
M v[172:175],a[56:59],a[168:171],v[172:175]
C v136,v136,v137
C v137,v138,v139
M v[176:179],a[64:67],a[168:171],v[176:179]
C v138,v140,v141
C v139,v142,v143
M v[176:179],a[68:71],a[172:175],v[176:179]
C v144,v144,v145
C v145,v146,v147
M v[180:183],a[76:79],a[172:175],v[180:183]
C v146,v148,v149
C v147,v150,v151
M v[180:183],a[72:75],a[168:171],v[180:183]
C v152,v152,v153
C v153,v154,v155
M v[184:187],a[80:83],a[168:171],v[184:187]
C v154,v156,v157
C v155,v158,v159
M v[184:187],a[84:87],a[172:175],v[184:187]
s_waitcnt lgkmcnt(0)
C v160,v160,v161
C v161,v162,v163
M v[188:191],a[92:95],a[172:175],v[188:191]
C v162,v164,v165
C v163,v166,v167
M v[188:191],a[88:91],a[168:171],v[188:191]
C v168,v168,v169
C v169,v170,v171
M v[192:195],a[32:35],a[160:163],v[192:195]
s_waitcnt vmcnt(18)
R a[168:171],v5,55296
R a[172:175],v6,55296
M v[192:195],a[36:39],a[164:167],v[192:195]
C v170,v172,v173
C v171,v174,v175
M v[196:199],a[44:47],a[164:167],v[196:199]
C v176,v176,v177
C v177,v178,v179
M v[196:199],a[40:43],a[160:163],v[196:199]
C v178,v180,v181
C v179,v182,v183
M v[200:203],a[48:51],a[160:163],v[200:203]
R a[128:131],v20,49152
R a[132:135],v20,51200
M v[200:203],a[52:55],a[164:167],v[200:203]
R a[136:139],v21,49152
R a[140:143],v21,51200
M v[204:207],a[60:63],a[164:167],v[204:207]
C v184,v184,v185
C v185,v186,v187
M v[204:207],a[56:59],a[160:163],v[204:207]
C v186,v188,v189
C v187,v190,v191
M v[208:211],a[64:67],a[160:163],v[208:211]
C v192,v192,v193
C v193,v194,v195
M v[208:211],a[68:71],a[164:167],v[208:211]
C v194,v196,v197
C v195,v198,v199
M v[212:215],a[76:79],a[164:167],v[212:215]
M v[212:215],a[72:75],a[160:163],v[212:215]
C v200,v200,v201
C v201,v202,v203
M v[216:219],a[80:83],a[160:163],v[216:219]
C v202,v204,v205
C v203,v206,v207
M v[216:219],a[84:87],a[164:167],v[216:219]
s_waitcnt lgkmcnt(4)
M v[220:223],a[92:95],a[164:167],v[220:223]
s_waitcnt vmcnt(9) lgkmcnt(0)
M v[220:223],a[88:91],a[160:163],v[220:223]
s_barrier
M v[224:227],a[32:35],a[168:171],v[224:227]
s_nop 0
T v[32:33],v16,0
T v[34:35],v16,2048
M v[224:227],a[36:39],a[172:175],v[224:227]
C v208,v208,v209
C v209,v210,v211
M v[228:231],a[44:47],a[172:175],v[228:231]
T v[36:37],v16,4096
T v[38:39],v16,6144
M v[228:231],a[40:43],a[168:171],v[228:231]
T v[40:41],v16,8192
T v[42:43],v16,10240
M v[232:235],a[48:51],a[168:171],v[232:235]
C v210,v212,v213
C v211,v214,v215
M v[232:235],a[52:55],a[172:175],v[232:235]
T v[44:45],v16,12288
T v[46:47],v16,14336
M v[236:239],a[60:63],a[172:175],v[236:239]
T v[48:49],v16,16384
T v[50:51],v16,18432
M v[236:239],a[56:59],a[168:171],v[236:239]
C v216,v216,v217
C v217,v218,v219
M v[240:243],a[64:67],a[168:171],v[240:243]
T v[52:53],v16,20480
T v[54:55],v16,22528
M v[240:243],a[68:71],a[172:175],v[240:243]
T v[56:57],v16,24576
T v[58:59],v16,26624
M v[244:247],a[76:79],a[172:175],v[244:247]
C v218,v220,v221
C v219,v222,v223
M v[244:247],a[72:75],a[168:171],v[244:247]
C v224,v224,v225
C v225,v226,v227
M v[248:251],a[80:83],a[168:171],v[248:251]
C v226,v228,v229
C v227,v230,v231
M v[248:251],a[84:87],a[172:175],v[248:251]
C v232,v232,v233
C v233,v234,v235
M v[252:255],a[92:95],a[172:175],v[252:255]
C v234,v236,v237
C v235,v238,v239
M v[252:255],a[88:91],a[168:171],v[252:255]
s_waitcnt lgkmcnt(6)
C v240,v240,v241
C v241,v242,v243
M v[68:71],v[32:35],a[176:179],0
s_mul_i32 s72, s41, 4352
T a[144:145],v17,0
T a[146:147],v17,2048
M v[68:71],v[36:39],a[184:187],v[68:71]
s_mov_b32 s25, 1048704
C v242,v244,v245
C v243,v246,v247
M v[68:71],v[40:43],a[192:195],v[68:71]
s_waitcnt lgkmcnt(2)
T a[148:149],v17,4096
T a[150:151],v17,6144
M v[68:71],v[44:47],a[200:203],v[68:71]
SA m0,s4,98304
T a[152:153],v17,8192
T a[154:155],v17,10240
M v[68:71],v[48:51],a[208:211],v[68:71]
SA s46,s72,104923136
buffer_load_dwordx4 v8, s[52:55], s25 offen lds
M v[68:71],v[52:55],a[216:219],v[68:71]
s_lshl_b32 s45, s42, 7
T a[156:157],v17,12288
T a[158:159],v17,14336
M v[68:71],v[56:59],a[224:227],v[68:71]
s_mov_b32 s25, 1310848
T a[160:161],v17,16384
T a[162:163],v17,18432
M v[76:79],v[56:59],a[228:231],0
SA m0,s4,102400
C v248,v248,v249
C v249,v250,v251
M v[76:79],v[52:55],a[220:223],v[76:79]
SA s45,s45,s46
T a[164:165],v17,20480
T a[166:167],v17,22528
M v[76:79],v[48:51],a[212:215],v[76:79]
s_lshl_b32 s72, s20, 2
T a[168:169],v17,24576
T a[170:171],v17,26624
M v[76:79],v[44:47],a[204:207],v[76:79]
SA s72,s72,s45
buffer_load_dwordx4 v8, s[52:55], s25 offen lds
M v[76:79],v[40:43],a[196:199],v[76:79]
C v250,v252,v253
C v251,v254,v255
M v[76:79],v[36:39],a[188:191],v[76:79]
s_mov_b32 s25, 1572992
v_min_u32 v29, 1, v0
v_lshlrev_b32 v29, 29, v29
M v[76:79],v[32:35],a[180:183],v[76:79]
s_waitcnt lgkmcnt(6)
v_mov_b32 v30, 1
M v[84:87],a[144:147],a[176:179],0
SA m0,s4,106496
T v[32:33],v18,0
T v[34:35],v18,2048
M v[84:87],a[148:151],a[184:187],v[84:87]
buffer_load_dwordx4 v8, s[52:55], s25 offen lds
M v[84:87],a[152:155],a[192:195],v[84:87]
s_waitcnt lgkmcnt(2)
s_nop 0
T v[36:37],v18,4096
T v[38:39],v18,6144
M v[84:87],a[156:159],a[200:203],v[84:87]
s_mov_b32 s25, 1835136
T v[40:41],v18,8192
T v[42:43],v18,10240
M v[84:87],a[160:163],a[208:211],v[84:87]
SA m0,s4,110592
M v[84:87],a[164:167],a[216:219],v[84:87]
s_nop 0
T v[44:45],v18,12288
T v[46:47],v18,14336
M v[84:87],a[168:171],a[224:227],v[84:87]
s_waitcnt vmcnt(3)
T v[48:49],v18,16384
T v[50:51],v18,18432
M v[92:95],a[168:171],a[228:231],0
buffer_load_dwordx4 v8, s[52:55], s25 offen lds
M v[92:95],a[164:167],a[220:223],v[92:95]
s_nop 0
T v[52:53],v18,20480
T v[54:55],v18,22528
M v[92:95],a[160:163],a[212:215],v[92:95]
s_mov_b32 s25, 2097280
T v[56:57],v18,24576
T v[58:59],v18,26624
M v[92:95],a[156:159],a[204:207],v[92:95]
SA m0,s4,114688
buffer_store_dword v30, v29, s[8:11], s72 offen offset:4 sc1
M v[92:95],a[152:155],a[196:199],v[92:95]
SA s3,s93,524288
buffer_load_dwordx4 v8, s[52:55], s25 offen lds
M v[92:95],a[148:151],a[188:191],v[92:95]
v_add_u32 v20, 0x10000, v16
v_add_u32 v21, 0x10000, v17
M v[92:95],a[144:147],a[180:183],v[92:95]
s_waitcnt lgkmcnt(6)
buffer_store_dwordx4 v[64:67], v7, s[8:11], s3 offen offset:0 sc1
M v[100:103],v[32:35],a[176:179],0
s_mov_b32 s25, 2359424
T a[144:145],v19,0
T a[146:147],v19,2048
M v[100:103],v[36:39],a[184:187],v[100:103]
SA m0,s4,118784
L_w_kv08:
s_cbranch_execz L_wd1
buffer_store_dwordx4 v[72:75], v7, s[8:11], s3 offen offset:1024 sc1
M v[100:103],v[40:43],a[192:195],v[100:103]
s_waitcnt lgkmcnt(2)
s_nop 0
T a[148:149],v19,4096
T a[150:151],v19,6144
M v[100:103],v[44:47],a[200:203],v[100:103]
T a[152:153],v19,8192
T a[154:155],v19,10240
M v[100:103],v[48:51],a[208:211],v[100:103]
buffer_load_dwordx4 v8, s[52:55], s25 offen lds
M v[100:103],v[52:55],a[216:219],v[100:103]
s_nop 0
T a[156:157],v19,12288
T a[158:159],v19,14336
M v[100:103],v[56:59],a[224:227],v[100:103]
s_mov_b32 s25, 2621568
T a[160:161],v19,16384
T a[162:163],v19,18432
M v[108:111],v[56:59],a[228:231],0
SA m0,s4,122880
buffer_store_dwordx4 v[80:83], v7, s[8:11], s3 offen offset:2048 sc1
M v[108:111],v[52:55],a[220:223],v[108:111]
s_nop 0
T a[164:165],v19,20480
T a[166:167],v19,22528
M v[108:111],v[48:51],a[212:215],v[108:111]
T a[168:169],v19,24576
T a[170:171],v19,26624
M v[108:111],v[44:47],a[204:207],v[108:111]
buffer_load_dwordx4 v8, s[52:55], s25 offen lds
M v[108:111],v[40:43],a[196:199],v[108:111]
v_add_u32 v22, 0x10000, v18
v_add_u32 v23, 0x10000, v19
M v[108:111],v[36:39],a[188:191],v[108:111]
s_mov_b32 s25, 2883712
buffer_store_dwordx4 v[88:91], v7, s[8:11], s3 offen offset:3072 sc1
M v[108:111],v[32:35],a[180:183],v[108:111]
s_waitcnt lgkmcnt(6)
v_or_b32 v1, s20, v0
v_min_u32 v1, 1, v1
M v[116:119],a[144:147],a[176:179],0
SA m0,s4,126976
T v[32:33],v16,28672
T v[34:35],v16,30720
M v[116:119],a[148:151],a[184:187],v[116:119]
buffer_load_dwordx4 v8, s[52:55], s25 offen lds
M v[116:119],a[152:155],a[192:195],v[116:119]
s_waitcnt lgkmcnt(2)
s_nop 0
T v[36:37],v12,0
T v[38:39],v12,2048
M v[116:119],a[156:159],a[200:203],v[116:119]
s_mov_b32 s25, 3145856
T v[40:41],v12,4096
T v[42:43],v12,6144
M v[116:119],a[160:163],a[208:211],v[116:119]
SA m0,s4,32768
v_lshlrev_b32 v1, 29, v1
M v[116:119],a[164:167],a[216:219],v[116:119]
s_nop 0
T v[44:45],v12,8192
T v[46:47],v12,10240
M v[116:119],a[168:171],a[224:227],v[116:119]
T v[48:49],v12,12288
T v[50:51],v12,14336
M v[124:127],a[168:171],a[228:231],0
buffer_load_dwordx4 v8, s[52:55], s25 offen lds
M v[124:127],a[164:167],a[220:223],v[124:127]
s_nop 0
T v[52:53],v12,16384
T v[54:55],v12,18432
M v[124:127],a[160:163],a[212:215],v[124:127]
s_mov_b32 s25, 3408000
T v[56:57],v12,20480
T v[58:59],v12,22528
M v[124:127],a[156:159],a[204:207],v[124:127]
SA m0,s4,36864
v_min_u32 v9, 15, v0
v_lshlrev_b32 v9, 7, v9
M v[124:127],a[152:155],a[196:199],v[124:127]
s_sub_u32 s66, 15, s42
buffer_load_dwordx4 v8, s[52:55], s25 offen lds
M v[124:127],a[148:151],a[188:191],v[124:127]
s_max_u32 s67, s66, s42
M v[124:127],a[144:147],a[180:183],v[124:127]
s_waitcnt lgkmcnt(6)
M v[68:71],v[32:35],a[232:235],v[68:71]
s_mov_b32 s25, 256
T a[144:145],v17,28672
T a[146:147],v17,30720
M v[68:71],v[36:39],a[96:99],v[68:71]
SA m0,s4,65536
M v[68:71],v[40:43],a[104:107],v[68:71]
s_waitcnt lgkmcnt(2)
s_nop 0
T a[148:149],v13,0
T a[150:151],v13,2048
M v[68:71],v[44:47],a[112:115],v[68:71]
s_min_u32 s66, s66, s42
T a[152:153],v13,4096
T a[154:155],v13,6144
M v[68:71],v[48:51],a[120:123],v[68:71]
s_mul_i32 s21, s41, 1048576
buffer_load_dwordx4 v8, s[52:55], s25 offen lds
M v[68:71],v[52:55],a[128:131],v[68:71]
s_lshl_b32 s64, s67, 16
T a[156:157],v13,8192
T a[158:159],v13,10240
M v[68:71],v[56:59],a[136:139],v[68:71]
s_mov_b32 s25, 262400
T a[160:161],v13,12288
T a[162:163],v13,14336
M v[76:79],v[56:59],a[140:143],v[76:79]
SA m0,s4,69632
M v[76:79],v[52:55],a[132:135],v[76:79]
SA s32,s21,s64
T a[164:165],v13,16384
T a[166:167],v13,18432
M v[76:79],v[48:51],a[124:127],v[76:79]
s_lshl_b32 s64, s20, 14
T a[168:169],v13,20480
T a[170:171],v13,22528
M v[76:79],v[44:47],a[116:119],v[76:79]
SA s32,s32,s64
buffer_load_dwordx4 v8, s[52:55], s25 offen lds
M v[76:79],v[40:43],a[108:111],v[76:79]
SA s32,s32,33554432
M v[76:79],v[36:39],a[100:103],v[76:79]
s_mov_b32 s25, 524544
M v[76:79],v[32:35],a[236:239],v[76:79]
s_waitcnt lgkmcnt(6)
M v[84:87],a[144:147],a[232:235],v[84:87]
SA m0,s4,73728
T v[32:33],v18,28672
T v[34:35],v18,30720
M v[84:87],a[148:151],a[96:99],v[84:87]
s_sub_u32 s64, s42, 10
buffer_load_dwordx4 v8, s[52:55], s25 offen lds
M v[84:87],a[152:155],a[104:107],v[84:87]
s_waitcnt lgkmcnt(2)
s_nop 0
T v[36:37],v14,0
T v[38:39],v14,2048
M v[84:87],a[156:159],a[112:115],v[84:87]
s_mov_b32 s25, 786688
T v[40:41],v14,4096
T v[42:43],v14,6144
M v[84:87],a[160:163],a[120:123],v[84:87]
SA m0,s4,77824
M v[84:87],a[164:167],a[128:131],v[84:87]
s_and_b32 s35, s64, 536870912
T v[44:45],v14,8192
T v[46:47],v14,10240
M v[84:87],a[168:171],a[136:139],v[84:87]
T v[48:49],v14,12288
T v[50:51],v14,14336
M v[92:95],a[168:171],a[140:143],v[92:95]
buffer_load_dwordx4 v8, s[52:55], s25 offen lds
M v[92:95],a[164:167],a[132:135],v[92:95]
s_nop 0
T v[52:53],v14,16384
T v[54:55],v14,18432
M v[92:95],a[160:163],a[124:127],v[92:95]
s_mov_b32 s25, 1048832
T v[56:57],v14,20480
T v[58:59],v14,22528
M v[92:95],a[156:159],a[116:119],v[92:95]
SA m0,s4,81920
v_or_b32 v6, s35, v7
MF v68,s5,v68
M v[92:95],a[152:155],a[108:111],v[92:95]
s_lshl_b32 s28, s20, 13
buffer_load_dwordx4 v8, s[52:55], s25 offen lds
M v[92:95],a[148:151],a[100:103],v[92:95]
v_add_u32 v2, 0x10000, v7
v_add_u32 v3, s28, v7
M v[92:95],a[144:147],a[236:239],v[92:95]
s_waitcnt lgkmcnt(6)
v_add_u32 v4, 0x1000, v3
MF v69,s5,v69
M v[100:103],v[32:35],a[232:235],v[100:103]
s_mov_b32 s25, 1310976
T a[144:145],v19,28672
T a[146:147],v19,30720
M v[100:103],v[36:39],a[96:99],v[100:103]
SA m0,s4,86016
MF v70,s5,v70
MF v71,s5,v71
M v[100:103],v[40:43],a[104:107],v[100:103]
s_waitcnt lgkmcnt(2)
T a[148:149],v15,0
T a[150:151],v15,2048
M v[100:103],v[44:47],a[112:115],v[100:103]
s_lshl_b32 s64, s42, 16
T a[152:153],v15,4096
T a[154:155],v15,6144
M v[100:103],v[48:51],a[120:123],v[100:103]
SA s23,s21,s64
buffer_load_dwordx4 v8, s[52:55], s25 offen lds
M v[100:103],v[52:55],a[128:131],v[100:103]
SA s43,s23,16777216
T a[156:157],v15,8192
T a[158:159],v15,10240
M v[100:103],v[56:59],a[136:139],v[100:103]
s_mov_b32 s25, 1573120
T a[160:161],v15,12288
T a[162:163],v15,14336
M v[108:111],v[56:59],a[140:143],v[108:111]
SA m0,s4,90112
MF v84,s5,v84
MF v85,s5,v85
M v[108:111],v[52:55],a[132:135],v[108:111]
SA s26,s21,16777216
T a[164:165],v15,16384
T a[166:167],v15,18432
M v[108:111],v[48:51],a[124:127],v[108:111]
s_mov_b32 s22, 0x7fff
T a[168:169],v15,20480
T a[170:171],v15,22528
M v[108:111],v[44:47],a[116:119],v[108:111]
s_sub_u32 s27, s42, 1
buffer_load_dwordx4 v8, s[52:55], s25 offen lds
M v[108:111],v[40:43],a[108:111],v[108:111]
s_cmp_eq_u32 s42, 0
MF v86,s5,v86
MF v87,s5,v87
M v[108:111],v[36:39],a[100:103],v[108:111]
s_waitcnt vmcnt(7) lgkmcnt(0)
C v68,v68,v69
C v69,v70,v71
M v[108:111],v[32:35],a[236:239],v[108:111]
s_barrier
M v[116:119],a[144:147],a[232:235],v[116:119]
s_mov_b32 s25, 1835264
T v[32:33],v16,49152
T v[34:35],v16,51200
M v[116:119],a[148:151],a[96:99],v[116:119]
s_cselect_b32 s64, 32768, 0
C v70,v84,v85
C v71,v86,v87
M v[116:119],a[152:155],a[104:107],v[116:119]
SA m0,s4,94208
T v[36:37],v16,53248
T v[38:39],v16,55296
M v[116:119],a[156:159],a[112:115],v[116:119]
SA s26,s26,s64
T v[40:41],v16,57344
T v[42:43],v16,59392
M v[116:119],a[160:163],a[120:123],v[116:119]
s_mov_b32 s31, 0x4b800000
buffer_load_dwordx4 v8, s[52:55], s25 offen lds
M v[116:119],a[164:167],a[128:131],v[116:119]
s_mov_b32 s24, 0x33800000
T v[44:45],v16,61440
T v[46:47],v16,63488
M v[116:119],a[168:171],a[136:139],v[116:119]
s_mov_b32 s25, 2097408
T v[48:49],v20,32768
T v[50:51],v20,34816
M v[124:127],a[168:171],a[140:143],v[124:127]
SA m0,s4,155648
W a0,v68
W a1,v69
M v[124:127],a[164:167],a[132:135],v[124:127]
s_lshl_b32 s47, s66, 7
T v[52:53],v20,36864
T v[54:55],v20,38912
M v[124:127],a[160:163],a[124:127],v[124:127]
SA s47,s47,s46
T v[56:57],v20,40960
T v[58:59],v20,43008
M v[124:127],a[156:159],a[116:119],v[124:127]
s_lshl_b32 s64, s20, 5
buffer_load_dwordx4 v8, s[52:55], s25 offen lds
M v[124:127],a[152:155],a[108:111],v[124:127]
SA s47,s47,s64
W a2,v70
W a3,v71
M v[124:127],a[148:151],a[100:103],v[124:127]
SA s47,s47,2048
MF v76,s5,v76
MF v77,s5,v77
M v[124:127],a[144:147],a[236:239],v[124:127]
s_waitcnt lgkmcnt(6)
MF v78,s5,v78
MF v79,s5,v79
M v[132:135],v[32:35],a[176:179],0
s_lshl_b32 s65, s41, 3
T a[144:145],v17,49152
T a[146:147],v17,51200
M v[132:135],v[36:39],a[184:187],v[132:135]
SA s65,s65,s66
MF v92,s5,v92
MF v93,s5,v93
M v[132:135],v[40:43],a[192:195],v[132:135]
s_waitcnt lgkmcnt(2)
T a[148:149],v17,53248
T a[150:151],v17,55296
M v[132:135],v[44:47],a[200:203],v[132:135]
s_mul_i32 s34, s65, 73728
T a[152:153],v17,57344
T a[154:155],v17,59392
M v[132:135],v[48:51],a[208:211],v[132:135]
SA s34,s34,136314880
MF v94,s5,v94
MF v95,s5,v95
M v[132:135],v[52:55],a[216:219],v[132:135]
s_lshl_b32 s65, s42, 4
T a[156:157],v17,61440
T a[158:159],v17,63488
M v[132:135],v[56:59],a[224:227],v[132:135]
SA s65,s65,s41
T a[160:161],v21,32768
T a[162:163],v21,34816
M v[140:143],v[56:59],a[228:231],0
s_mul_i32 s33, s65, 114688
C v76,v76,v77
C v77,v78,v79
M v[140:143],v[52:55],a[220:223],v[140:143]
s_mul_i32 s65, s20, 28672
T a[164:165],v21,36864
T a[166:167],v21,38912
M v[140:143],v[48:51],a[212:215],v[140:143]
SA s33,s33,s65
T a[168:169],v21,40960
T a[170:171],v21,43008
M v[140:143],v[44:47],a[204:207],v[140:143]
SA s33,s33,67108864
C v78,v92,v93
C v79,v94,v95
M v[140:143],v[40:43],a[196:199],v[140:143]
s_mov_b32 s6, 0
W a32,v76
W a33,v77
M v[140:143],v[36:39],a[188:191],v[140:143]
s_mov_b32 s7, 0
W a34,v78
W a35,v79
M v[140:143],v[32:35],a[180:183],v[140:143]
s_waitcnt lgkmcnt(6)
MF v100,s5,v100
MF v101,s5,v101
M v[148:151],a[144:147],a[176:179],0
s_mov_b32 s40, 1
T v[32:33],v18,49152
T v[34:35],v18,51200
M v[148:151],a[148:151],a[184:187],v[148:151]
s_cmp_eq_u32 s20, 0
MF v102,s5,v102
MF v103,s5,v103
M v[148:151],a[152:155],a[192:195],v[148:151]
s_waitcnt lgkmcnt(2)
T v[36:37],v18,53248
T v[38:39],v18,55296
M v[148:151],a[156:159],a[200:203],v[148:151]
s_cselect_b32 s39, 7, 4
T v[40:41],v18,57344
T v[42:43],v18,59392
M v[148:151],a[160:163],a[208:211],v[148:151]
s_lshl_b32 s64, s41, 1
MF v116,s5,v116
MF v117,s5,v117
M v[148:151],a[164:167],a[216:219],v[148:151]
SA s64,s64,s20
T v[44:45],v18,61440
T v[46:47],v18,63488
M v[148:151],a[168:171],a[224:227],v[148:151]
s_cmp_lt_u32 s64, 30
T v[48:49],v22,32768
T v[50:51],v22,34816
M v[156:159],a[168:171],a[228:231],0
s_cselect_b32 s64, 32798, 0
MF v118,s5,v118
MF v119,s5,v119
M v[156:159],a[164:167],a[220:223],v[156:159]
s_cmp_ge_u32 s20, 2
T v[52:53],v22,36864
T v[54:55],v22,38912
M v[156:159],a[160:163],a[212:215],v[156:159]
s_cselect_b32 s64, s64, 0
T v[56:57],v22,40960
T v[58:59],v22,43008
M v[156:159],a[156:159],a[204:207],v[156:159]
s_cmp_eq_u32 s42, 6
C v100,v100,v101
C v101,v102,v103
M v[156:159],a[152:155],a[196:199],v[156:159]
s_cselect_b32 s64, s64, 0
C v102,v116,v117
C v103,v118,v119
M v[156:159],a[148:151],a[188:191],v[156:159]
s_or_b32 s39, s39, s64
W a4,v100
W a5,v101
M v[156:159],a[144:147],a[180:183],v[156:159]
s_waitcnt lgkmcnt(6)
W a6,v102
W a7,v103
M v[164:167],v[32:35],a[176:179],0
s_mov_b64 s[60:61], s[76:77]
T a[144:145],v19,49152
T a[146:147],v19,51200
M v[164:167],v[36:39],a[184:187],v[164:167]
s_mov_b32 s62, s78
MF v108,s5,v108
MF v109,s5,v109
M v[164:167],v[40:43],a[192:195],v[164:167]
s_waitcnt lgkmcnt(2)
T a[148:149],v19,53248
T a[150:151],v19,55296
M v[164:167],v[44:47],a[200:203],v[164:167]
s_mov_b32 s63, 0x20000
T a[152:153],v19,57344
T a[154:155],v19,59392
M v[164:167],v[48:51],a[208:211],v[164:167]
s_mov_b32 s25, 2359552
v_lshrrev_b32 v24, 4, v0
v_lshlrev_b32 v24, 2, v24
M v[164:167],v[52:55],a[216:219],v[164:167]
SA m0,s4,159744
T a[156:157],v19,61440
T a[158:159],v19,63488
M v[164:167],v[56:59],a[224:227],v[164:167]
SA s3,s93,532480
T a[160:161],v23,32768
T a[162:163],v23,34816
M v[172:175],v[56:59],a[228:231],0
buffer_load_dwordx4 v8, s[52:55], s25 offen lds
M v[172:175],v[52:55],a[220:223],v[172:175]
s_nop 0
T a[164:165],v23,36864
T a[166:167],v23,38912
M v[172:175],v[48:51],a[212:215],v[172:175]
s_mov_b32 s25, 2621696
T a[168:169],v23,40960
T a[170:171],v23,43008
M v[172:175],v[44:47],a[204:207],v[172:175]
SA m0,s4,131072
buffer_store_dwordx4 v[96:99], v7, s[8:11], s3 offen offset:0 sc1
M v[172:175],v[40:43],a[196:199],v[172:175]
v_and_b32 v25, 15, v0
v_sub_u32 v24, v24, v25
M v[172:175],v[36:39],a[188:191],v[172:175]
buffer_load_dwordx4 v8, s[52:55], s25 offen lds
M v[172:175],v[32:35],a[180:183],v[172:175]
s_waitcnt lgkmcnt(6)
v_cmp_lt_i32 s[16:17], 0, v24
v_cmp_lt_i32 s[18:19], -1, v24
M v[180:183],a[144:147],a[176:179],0
s_mov_b32 s25, 2883840
T v[32:33],v20,45056
T v[34:35],v20,47104
M v[180:183],a[148:151],a[184:187],v[180:183]
SA m0,s4,135168
buffer_store_dwordx4 v[104:107], v7, s[8:11], s3 offen offset:1024 sc1
M v[180:183],a[152:155],a[192:195],v[180:183]
s_waitcnt lgkmcnt(2)
s_nop 0
T v[36:37],v20,49152
T v[38:39],v20,51200
M v[180:183],a[156:159],a[200:203],v[180:183]
T v[40:41],v20,53248
T v[42:43],v20,55296
M v[180:183],a[160:163],a[208:211],v[180:183]
buffer_load_dwordx4 v8, s[52:55], s25 offen lds
M v[180:183],a[164:167],a[216:219],v[180:183]
s_nop 0
T v[44:45],v20,57344
T v[46:47],v20,59392
M v[180:183],a[168:171],a[224:227],v[180:183]
s_mov_b32 s25, 3145984
T v[48:49],v20,61440
T v[50:51],v20,63488
M v[188:191],a[168:171],a[228:231],0
SA m0,s4,139264
buffer_store_dwordx4 v[112:115], v7, s[8:11], s3 offen offset:2048 sc1
M v[188:191],a[164:167],a[220:223],v[188:191]
s_nop 0
T v[52:53],v16,32768
T v[54:55],v16,34816
M v[188:191],a[160:163],a[212:215],v[188:191]
T v[56:57],v16,36864
T v[58:59],v16,38912
M v[188:191],a[156:159],a[204:207],v[188:191]
buffer_load_dwordx4 v8, s[52:55], s25 offen lds
M v[188:191],a[152:155],a[196:199],v[188:191]
v_cmp_lt_i32 s[48:49], -2, v24
v_cmp_lt_i32 s[50:51], -3, v24
M v[188:191],a[148:151],a[188:191],v[188:191]
s_mov_b32 s25, 3408128
buffer_store_dwordx4 v[120:123], v7, s[8:11], s3 offen offset:3072 sc1
M v[188:191],a[144:147],a[180:183],v[188:191]
s_waitcnt lgkmcnt(6)
v_lshl_add_u32 v25, v0, 7, s95
v_and_b32 v0, 48, v0
M v[132:135],v[32:35],a[232:235],v[132:135]
SA m0,s4,143360
T a[144:145],v21,45056
T a[146:147],v21,47104
M v[132:135],v[36:39],a[96:99],v[132:135]
buffer_load_dwordx4 v8, s[52:55], s25 offen lds
M v[132:135],v[40:43],a[104:107],v[132:135]
s_waitcnt lgkmcnt(2)
s_nop 0
T a[148:149],v21,49152
T a[150:151],v21,51200
M v[132:135],v[44:47],a[112:115],v[132:135]
s_mov_b32 s25, 384
T a[152:153],v21,53248
T a[154:155],v21,55296
M v[132:135],v[48:51],a[120:123],v[132:135]
SA m0,s4,0
v_lshl_add_u32 v0, v0, 24, v25
v_mov_b32 v24, 0x3f80
M v[132:135],v[52:55],a[128:131],v[132:135]
T a[156:157],v21,57344
T a[158:159],v21,59392
M v[132:135],v[56:59],a[136:139],v[132:135]
T a[160:161],v21,61440
T a[162:163],v21,63488
M v[140:143],v[56:59],a[140:143],v[140:143]
buffer_load_dwordx4 v8, s[52:55], s25 offen lds
M v[140:143],v[52:55],a[132:135],v[140:143]
s_nop 0
T a[164:165],v17,32768
T a[166:167],v17,34816
M v[140:143],v[48:51],a[124:127],v[140:143]
s_mov_b32 s25, 262528
T a[168:169],v17,36864
T a[170:171],v17,38912
M v[140:143],v[44:47],a[116:119],v[140:143]
SA m0,s4,4096
MF v110,s5,v110
MF v111,s5,v111
M v[140:143],v[40:43],a[108:111],v[140:143]
buffer_load_dwordx4 v8, s[52:55], s25 offen lds
M v[140:143],v[36:39],a[100:103],v[140:143]
MF v124,s5,v124
MF v125,s5,v125
M v[140:143],v[32:35],a[236:239],v[140:143]
s_waitcnt lgkmcnt(6)
MF v126,s5,v126
MF v127,s5,v127
M v[148:151],a[144:147],a[232:235],v[148:151]
s_mov_b32 s25, 524672
T v[32:33],v22,45056
T v[34:35],v22,47104
M v[148:151],a[148:151],a[96:99],v[148:151]
SA m0,s4,8192
C v108,v108,v109
C v109,v110,v111
M v[148:151],a[152:155],a[104:107],v[148:151]
s_waitcnt lgkmcnt(2)
T v[36:37],v22,49152
T v[38:39],v22,51200
M v[148:151],a[156:159],a[112:115],v[148:151]
T v[40:41],v22,53248
T v[42:43],v22,55296
M v[148:151],a[160:163],a[120:123],v[148:151]
buffer_load_dwordx4 v8, s[52:55], s25 offen lds
M v[148:151],a[164:167],a[128:131],v[148:151]
s_nop 0
T v[44:45],v22,57344
T v[46:47],v22,59392
M v[148:151],a[168:171],a[136:139],v[148:151]
s_mov_b32 s25, 786816
T v[48:49],v22,61440
T v[50:51],v22,63488
M v[156:159],a[168:171],a[140:143],v[156:159]
SA m0,s4,12288
C v110,v124,v125
C v111,v126,v127
M v[156:159],a[164:167],a[132:135],v[156:159]
T v[52:53],v18,32768
T v[54:55],v18,34816
M v[156:159],a[160:163],a[124:127],v[156:159]
T v[56:57],v18,36864
T v[58:59],v18,38912
M v[156:159],a[156:159],a[116:119],v[156:159]
buffer_load_dwordx4 v8, s[52:55], s25 offen lds
M v[156:159],a[152:155],a[108:111],v[156:159]
W a36,v108
W a37,v109
M v[156:159],a[148:151],a[100:103],v[156:159]
s_mov_b32 s25, 1048960
v_lshrrev_b32 v25, 8, v7
v_bfe_u32 v26, v7, 6, 2
v_and_b32 v27, 16, v7
v_lshlrev_b32 v27, v27, v24
v_cmp_eq_u32 vcc, v25, v26
v_and_b32 v28, 32, v7
W a244,0
v_cndmask_b32 v27, 0, v27, vcc
v_cmp_eq_u32 vcc, 0, v28
W a245,0
W a248,0
v_cndmask_b32 v25, 0, v27, vcc
v_sub_u32 v26, v27, v25
W a249,0
W a246,v25
W a247,v26
M v[156:159],a[144:147],a[236:239],v[156:159]
s_waitcnt lgkmcnt(6)
W a38,v110
W a39,v111
M v[164:167],v[32:35],a[232:235],v[164:167]
SA m0,s4,16384
T a[144:145],v23,45056
T a[146:147],v23,47104
M v[164:167],v[36:39],a[96:99],v[164:167]
buffer_load_dwordx4 v8, s[52:55], s25 offen lds
M v[164:167],v[40:43],a[104:107],v[164:167]
s_waitcnt lgkmcnt(2)
s_nop 0
T a[148:149],v23,49152
T a[150:151],v23,51200
M v[164:167],v[44:47],a[112:115],v[164:167]
s_mov_b32 s25, 1311104
T a[152:153],v23,53248
T a[154:155],v23,55296
M v[164:167],v[48:51],a[120:123],v[164:167]
SA m0,s4,20480
MF v132,s5,v132
MF v133,s5,v133
M v[164:167],v[52:55],a[128:131],v[164:167]
T a[156:157],v23,57344
T a[158:159],v23,59392
M v[164:167],v[56:59],a[136:139],v[164:167]
T a[160:161],v23,61440
T a[162:163],v23,63488
M v[172:175],v[56:59],a[140:143],v[172:175]
buffer_load_dwordx4 v8, s[52:55], s25 offen lds
M v[172:175],v[52:55],a[132:135],v[172:175]
s_nop 0
T a[164:165],v19,32768
T a[166:167],v19,34816
M v[172:175],v[48:51],a[124:127],v[172:175]
s_mov_b32 s25, 1573248
T a[168:169],v19,36864
T a[170:171],v19,38912
M v[172:175],v[44:47],a[116:119],v[172:175]
SA m0,s4,24576
MF v134,s5,v134
MF v135,s5,v135
M v[172:175],v[40:43],a[108:111],v[172:175]
buffer_load_dwordx4 v8, s[52:55], s25 offen lds
M v[172:175],v[36:39],a[100:103],v[172:175]
s_waitcnt vmcnt(7) lgkmcnt(0)
MF v148,s5,v148
MF v149,s5,v149
M v[172:175],v[32:35],a[236:239],v[172:175]
s_barrier
M v[180:183],a[144:147],a[232:235],v[180:183]
s_mov_b32 s25, 1835392
T v[32:33],v20,0
T v[34:35],v20,2048
M v[180:183],a[148:151],a[96:99],v[180:183]
SA m0,s4,28672
MF v150,s5,v150
MF v151,s5,v151
M v[180:183],a[152:155],a[104:107],v[180:183]
T v[36:37],v20,4096
T v[38:39],v20,6144
M v[180:183],a[156:159],a[112:115],v[180:183]
T v[40:41],v20,8192
T v[42:43],v20,10240
M v[180:183],a[160:163],a[120:123],v[180:183]
buffer_load_dwordx4 v8, s[52:55], s25 offen lds
M v[180:183],a[164:167],a[128:131],v[180:183]
s_nop 0
T v[44:45],v20,12288
T v[46:47],v20,14336
M v[180:183],a[168:171],a[136:139],v[180:183]
s_mov_b32 s25, 2097536
T v[48:49],v20,16384
T v[50:51],v20,18432
M v[188:191],a[168:171],a[140:143],v[188:191]
SA m0,s4,40960
C v132,v132,v133
C v133,v134,v135
M v[188:191],a[164:167],a[132:135],v[188:191]
T v[52:53],v20,20480
T v[54:55],v20,22528
M v[188:191],a[160:163],a[124:127],v[188:191]
T v[56:57],v20,24576
T v[58:59],v20,26624
M v[188:191],a[156:159],a[116:119],v[188:191]
buffer_load_dwordx4 v8, s[52:55], s25 offen lds
M v[188:191],a[152:155],a[108:111],v[188:191]
C v134,v148,v149
C v135,v150,v151
M v[188:191],a[148:151],a[100:103],v[188:191]
s_mov_b32 s25, 2359680
W a8,v132
W a9,v133
M v[188:191],a[144:147],a[236:239],v[188:191]
s_waitcnt lgkmcnt(6)
W a10,v134
W a11,v135
M v[68:71],v[32:35],a[176:179],0
SA m0,s4,45056
T a[144:145],v21,0
T a[146:147],v21,2048
M v[68:71],v[36:39],a[184:187],v[68:71]
buffer_load_dwordx4 v8, s[52:55], s25 offen lds
M v[68:71],v[40:43],a[192:195],v[68:71]
s_waitcnt lgkmcnt(2)
s_nop 0
T a[148:149],v21,4096
T a[150:151],v21,6144
M v[68:71],v[44:47],a[200:203],v[68:71]
s_mov_b32 s25, 2621824
T a[152:153],v21,8192
T a[154:155],v21,10240
M v[68:71],v[48:51],a[208:211],v[68:71]
SA m0,s4,49152
v_lshrrev_b32 v31, 6, v7
v_bfe_u32 v28, v7, 4, 2
M v[68:71],v[52:55],a[216:219],v[68:71]
T a[156:157],v21,12288
T a[158:159],v21,14336
M v[68:71],v[56:59],a[224:227],v[68:71]
T a[160:161],v21,16384
T a[162:163],v21,18432
M v[76:79],v[56:59],a[228:231],0
buffer_load_dwordx4 v8, s[52:55], s25 offen lds
M v[76:79],v[52:55],a[220:223],v[76:79]
s_nop 0
T a[164:165],v21,20480
T a[166:167],v21,22528
M v[76:79],v[48:51],a[212:215],v[76:79]
s_mov_b32 s25, 2883968
T a[168:169],v21,24576
T a[170:171],v21,26624
M v[76:79],v[44:47],a[204:207],v[76:79]
SA m0,s4,53248
v_lshlrev_b32 v31, 5, v31
v_add_lshl_u32 v31, v31, v28, 2
M v[76:79],v[40:43],a[196:199],v[76:79]
SA s3,s93,262144
buffer_load_dword v5, v31, s[8:11], s46 offen offset:4 sc1
M v[76:79],v[36:39],a[188:191],v[76:79]
buffer_load_dwordx4 v8, s[52:55], s25 offen lds
M v[76:79],v[32:35],a[180:183],v[76:79]
s_waitcnt lgkmcnt(6)
MF v140,s5,v140
MF v141,s5,v141
M v[84:87],a[144:147],a[176:179],0
s_mov_b32 s25, 3146112
T v[32:33],v22,0
T v[34:35],v22,2048
M v[84:87],a[148:151],a[184:187],v[84:87]
SA m0,s4,57344
buffer_store_dwordx4 v[128:131], v7, s[8:11], s3 offen offset:0 sc1
M v[84:87],a[152:155],a[192:195],v[84:87]
s_waitcnt lgkmcnt(2)
s_nop 0
T v[36:37],v22,4096
T v[38:39],v22,6144
M v[84:87],a[156:159],a[200:203],v[84:87]
T v[40:41],v22,8192
T v[42:43],v22,10240
M v[84:87],a[160:163],a[208:211],v[84:87]
buffer_load_dwordx4 v8, s[52:55], s25 offen lds
M v[84:87],a[164:167],a[216:219],v[84:87]
s_nop 0
T v[44:45],v22,12288
T v[46:47],v22,14336
M v[84:87],a[168:171],a[224:227],v[84:87]
s_mov_b32 s25, 3408256
T v[48:49],v22,16384
T v[50:51],v22,18432
M v[92:95],a[168:171],a[228:231],0
SA m0,s4,61440
buffer_store_dwordx4 v[136:139], v7, s[8:11], s3 offen offset:1024 sc1
M v[92:95],a[164:167],a[220:223],v[92:95]
s_nop 0
T v[52:53],v22,20480
T v[54:55],v22,22528
M v[92:95],a[160:163],a[212:215],v[92:95]
T v[56:57],v22,24576
T v[58:59],v22,26624
M v[92:95],a[156:159],a[204:207],v[92:95]
buffer_load_dwordx4 v8, s[52:55], s25 offen lds
M v[92:95],a[152:155],a[196:199],v[92:95]
MF v142,s5,v142
MF v143,s5,v143
M v[92:95],a[148:151],a[188:191],v[92:95]
buffer_store_dwordx4 v[144:147], v7, s[8:11], s3 offen offset:2048 sc1
M v[92:95],a[144:147],a[180:183],v[92:95]
s_waitcnt lgkmcnt(6)
MF v156,s5,v156
MF v157,s5,v157
M v[100:103],v[32:35],a[176:179],0
T a[144:145],v23,0
T a[146:147],v23,2048
M v[100:103],v[36:39],a[184:187],v[100:103]
buffer_store_dwordx4 v[152:155], v7, s[8:11], s3 offen offset:3072 sc1
M v[100:103],v[40:43],a[192:195],v[100:103]
s_waitcnt lgkmcnt(2)
s_nop 0
T a[148:149],v23,4096
T a[150:151],v23,6144
M v[100:103],v[44:47],a[200:203],v[100:103]
T a[152:153],v23,8192
T a[154:155],v23,10240
M v[100:103],v[48:51],a[208:211],v[100:103]
MF v158,s5,v158
MF v159,s5,v159
M v[100:103],v[52:55],a[216:219],v[100:103]
T a[156:157],v23,12288
T a[158:159],v23,14336
M v[100:103],v[56:59],a[224:227],v[100:103]
T a[160:161],v23,16384
T a[162:163],v23,18432
M v[108:111],v[56:59],a[228:231],0
C v140,v140,v141
C v141,v142,v143
M v[108:111],v[52:55],a[220:223],v[108:111]
T a[164:165],v23,20480
T a[166:167],v23,22528
M v[108:111],v[48:51],a[212:215],v[108:111]
T a[168:169],v23,24576
T a[170:171],v23,26624
M v[108:111],v[44:47],a[204:207],v[108:111]
C v142,v156,v157
C v143,v158,v159
M v[108:111],v[40:43],a[196:199],v[108:111]
W a40,v140
W a41,v141
M v[108:111],v[36:39],a[188:191],v[108:111]
W a42,v142
W a43,v143
M v[108:111],v[32:35],a[180:183],v[108:111]
s_waitcnt lgkmcnt(6)
v_mov_b32 v8, 0xff800000
MF v164,s5,v164
M v[116:119],a[144:147],a[176:179],0
T v[32:33],v20,28672
T v[34:35],v20,30720
M v[116:119],a[148:151],a[184:187],v[116:119]
MF v165,s5,v165
MF v166,s5,v166
M v[116:119],a[152:155],a[192:195],v[116:119]
s_waitcnt lgkmcnt(2)
T v[36:37],v12,24576
T v[38:39],v12,26624
M v[116:119],a[156:159],a[200:203],v[116:119]
T v[40:41],v12,28672
T v[42:43],v12,30720
M v[116:119],a[160:163],a[208:211],v[116:119]
MF v167,s5,v167
MF v180,s5,v180
M v[116:119],a[164:167],a[216:219],v[116:119]
T v[44:45],v12,0
T v[46:47],v12,2048
M v[116:119],a[168:171],a[224:227],v[116:119]
T v[48:49],v12,4096
T v[50:51],v12,6144
M v[124:127],a[168:171],a[228:231],0
MF v181,s5,v181
MF v182,s5,v182
M v[124:127],a[164:167],a[220:223],v[124:127]
T v[52:53],v12,8192
T v[54:55],v12,10240
M v[124:127],a[160:163],a[212:215],v[124:127]
T v[56:57],v12,12288
T v[58:59],v12,14336
M v[124:127],a[156:159],a[204:207],v[124:127]
MF v183,s5,v183
C v164,v164,v165
M v[124:127],a[152:155],a[196:199],v[124:127]
C v165,v166,v167
C v166,v180,v181
M v[124:127],a[148:151],a[188:191],v[124:127]
C v167,v182,v183
W a12,v164
M v[124:127],a[144:147],a[180:183],v[124:127]
s_waitcnt lgkmcnt(6)
W a13,v165
W a14,v166
M v[68:71],v[32:35],a[232:235],v[68:71]
T a[144:145],v21,28672
T a[146:147],v21,30720
M v[68:71],v[36:39],a[96:99],v[68:71]
W a15,v167
MF v172,s5,v172
M v[68:71],v[40:43],a[104:107],v[68:71]
s_waitcnt lgkmcnt(2)
T a[148:149],v13,24576
T a[150:151],v13,26624
M v[68:71],v[44:47],a[112:115],v[68:71]
T a[152:153],v13,28672
T a[154:155],v13,30720
M v[68:71],v[48:51],a[120:123],v[68:71]
MF v173,s5,v173
MF v174,s5,v174
M v[68:71],v[52:55],a[128:131],v[68:71]
T a[156:157],v13,0
T a[158:159],v13,2048
M v[68:71],v[56:59],a[136:139],v[68:71]
T a[160:161],v13,4096
T a[162:163],v13,6144
M v[76:79],v[56:59],a[140:143],v[76:79]
MF v175,s5,v175
MF v188,s5,v188
M v[76:79],v[52:55],a[132:135],v[76:79]
T a[164:165],v13,8192
T a[166:167],v13,10240
M v[76:79],v[48:51],a[124:127],v[76:79]
T a[168:169],v13,12288
T a[170:171],v13,14336
M v[76:79],v[44:47],a[116:119],v[76:79]
MF v189,s5,v189
MF v190,s5,v190
M v[76:79],v[40:43],a[108:111],v[76:79]
MF v191,s5,v191
C v172,v172,v173
M v[76:79],v[36:39],a[100:103],v[76:79]
C v173,v174,v175
C v174,v188,v189
M v[76:79],v[32:35],a[236:239],v[76:79]
s_waitcnt lgkmcnt(6)
C v175,v190,v191
W a44,v172
M v[84:87],a[144:147],a[232:235],v[84:87]
T v[32:33],v22,28672
T v[34:35],v22,30720
M v[84:87],a[148:151],a[96:99],v[84:87]
W a45,v173
W a46,v174
M v[84:87],a[152:155],a[104:107],v[84:87]
s_waitcnt lgkmcnt(2)
T v[36:37],v14,24576
T v[38:39],v14,26624
M v[84:87],a[156:159],a[112:115],v[84:87]
T v[40:41],v14,28672
T v[42:43],v14,30720
M v[84:87],a[160:163],a[120:123],v[84:87]
W a47,v175
s_waitcnt vmcnt(7)
v_cmp_ne_u32 vcc, 1, v5
M v[84:87],a[164:167],a[128:131],v[84:87]
s_nop 0
T v[44:45],v14,0
T v[46:47],v14,2048
M v[84:87],a[168:171],a[136:139],v[84:87]
s_cmp_lg_u32 vcc_lo, 0
T v[48:49],v14,4096
T v[50:51],v14,6144
M v[92:95],a[168:171],a[140:143],v[92:95]
s_cbranch_scc1 L_wsq0
L_wrq0:
M v[92:95],a[164:167],a[132:135],v[92:95]
SA m0,s28,98304
T v[52:53],v14,8192
T v[54:55],v14,10240
M v[92:95],a[160:163],a[124:127],v[92:95]
T v[56:57],v14,12288
T v[58:59],v14,14336
M v[92:95],a[156:159],a[116:119],v[92:95]
buffer_load_dwordx4 v3, s[8:11], s21 offen offset:0 sc1 lds
M v[92:95],a[152:155],a[108:111],v[92:95]
MF v68,s5,v68
MF v69,s5,v69
M v[92:95],a[148:151],a[100:103],v[92:95]
buffer_load_dwordx4 v3, s[8:11], s21 offen offset:1024 sc1 lds
M v[92:95],a[144:147],a[236:239],v[92:95]
s_waitcnt lgkmcnt(6)
MF v70,s5,v70
MF v71,s5,v71
M v[100:103],v[32:35],a[232:235],v[100:103]
T a[144:145],v23,28672
T a[146:147],v23,30720
M v[100:103],v[36:39],a[96:99],v[100:103]
buffer_load_dwordx4 v3, s[8:11], s21 offen offset:2048 sc1 lds
M v[100:103],v[40:43],a[104:107],v[100:103]
s_waitcnt lgkmcnt(2)
s_nop 0
T a[148:149],v15,24576
T a[150:151],v15,26624
M v[100:103],v[44:47],a[112:115],v[100:103]
T a[152:153],v15,28672
T a[154:155],v15,30720
M v[100:103],v[48:51],a[120:123],v[100:103]
buffer_load_dwordx4 v3, s[8:11], s21 offen offset:3072 sc1 lds
M v[100:103],v[52:55],a[128:131],v[100:103]
SA m0,s28,102400
T a[156:157],v15,0
T a[158:159],v15,2048
M v[100:103],v[56:59],a[136:139],v[100:103]
T a[160:161],v15,4096
T a[162:163],v15,6144
M v[108:111],v[56:59],a[140:143],v[108:111]
buffer_load_dwordx4 v4, s[8:11], s21 offen offset:0 sc1 lds
M v[108:111],v[52:55],a[132:135],v[108:111]
s_nop 0
T a[164:165],v15,8192
T a[166:167],v15,10240
M v[108:111],v[48:51],a[124:127],v[108:111]
T a[168:169],v15,12288
T a[170:171],v15,14336
M v[108:111],v[44:47],a[116:119],v[108:111]
buffer_load_dwordx4 v4, s[8:11], s21 offen offset:1024 sc1 lds
M v[108:111],v[40:43],a[108:111],v[108:111]
MF v84,s5,v84
MF v85,s5,v85
M v[108:111],v[36:39],a[100:103],v[108:111]
s_waitcnt vmcnt(8) lgkmcnt(0)
buffer_load_dwordx4 v4, s[8:11], s21 offen offset:2048 sc1 lds
M v[108:111],v[32:35],a[236:239],v[108:111]
s_barrier
M v[116:119],a[144:147],a[232:235],v[116:119]
s_nop 0
T v[32:33],v16,0
T v[34:35],v16,2048
M v[116:119],a[148:151],a[96:99],v[116:119]
buffer_load_dwordx4 v4, s[8:11], s21 offen offset:3072 sc1 lds
M v[116:119],a[152:155],a[104:107],v[116:119]
SA s21,s21,32768
T v[36:37],v16,4096
T v[38:39],v16,6144
M v[116:119],a[156:159],a[112:115],v[116:119]
s_sub_u32 s22, s22, 1
T v[40:41],v16,8192
T v[42:43],v16,10240
M v[116:119],a[160:163],a[120:123],v[116:119]
s_cselect_b32 s21, s23, s21
MF v86,s5,v86
MF v87,s5,v87
M v[116:119],a[164:167],a[128:131],v[116:119]
SA m0,s28,65536
T v[44:45],v16,12288
T v[46:47],v16,14336
M v[116:119],a[168:171],a[136:139],v[116:119]
T v[48:49],v16,16384
T v[50:51],v16,18432
M v[124:127],a[168:171],a[140:143],v[124:127]
buffer_load_dwordx4 v3, s[8:11], s21 offen offset:0 sc1 lds
M v[124:127],a[164:167],a[132:135],v[124:127]
s_nop 0
T v[52:53],v16,20480
T v[54:55],v16,22528
M v[124:127],a[160:163],a[124:127],v[124:127]
T v[56:57],v16,24576
T v[58:59],v16,26624
M v[124:127],a[156:159],a[116:119],v[124:127]
buffer_load_dwordx4 v3, s[8:11], s21 offen offset:1024 sc1 lds
M v[124:127],a[152:155],a[108:111],v[124:127]
buffer_load_dword v5, v31, s[8:11], s46 offen offset:4 sc1
M v[124:127],a[148:151],a[100:103],v[124:127]
buffer_load_dwordx4 v3, s[8:11], s21 offen offset:2048 sc1 lds
M v[124:127],a[144:147],a[236:239],v[124:127]
s_waitcnt lgkmcnt(6)
C v68,v68,v69
C v69,v70,v71
M v[132:135],v[32:35],a[176:179],0
T a[144:145],v17,0
T a[146:147],v17,2048
M v[132:135],v[36:39],a[184:187],v[132:135]
buffer_load_dwordx4 v3, s[8:11], s21 offen offset:3072 sc1 lds
M v[132:135],v[40:43],a[192:195],v[132:135]
s_waitcnt lgkmcnt(2)
s_nop 0
T a[148:149],v17,4096
T a[150:151],v17,6144
M v[132:135],v[44:47],a[200:203],v[132:135]
SA m0,s28,69632
T a[152:153],v17,8192
T a[154:155],v17,10240
M v[132:135],v[48:51],a[208:211],v[132:135]
buffer_load_dwordx4 v4, s[8:11], s21 offen offset:0 sc1 lds
M v[132:135],v[52:55],a[216:219],v[132:135]
s_nop 0
T a[156:157],v17,12288
T a[158:159],v17,14336
M v[132:135],v[56:59],a[224:227],v[132:135]
T a[160:161],v17,16384
T a[162:163],v17,18432
M v[140:143],v[56:59],a[228:231],0
buffer_load_dwordx4 v4, s[8:11], s21 offen offset:1024 sc1 lds
M v[140:143],v[52:55],a[220:223],v[140:143]
s_nop 0
T a[164:165],v17,20480
T a[166:167],v17,22528
M v[140:143],v[48:51],a[212:215],v[140:143]
T a[168:169],v17,24576
T a[170:171],v17,26624
M v[140:143],v[44:47],a[204:207],v[140:143]
SA s3,s93,270336
buffer_load_dwordx4 v4, s[8:11], s21 offen offset:2048 sc1 lds
M v[140:143],v[40:43],a[196:199],v[140:143]
C v70,v84,v85
C v71,v86,v87
M v[140:143],v[36:39],a[188:191],v[140:143]
buffer_load_dwordx4 v4, s[8:11], s21 offen offset:3072 sc1 lds
M v[140:143],v[32:35],a[180:183],v[140:143]
s_waitcnt lgkmcnt(6)
W a16,v68
W a17,v69
M v[148:151],a[144:147],a[176:179],0
SA s21,s21,32768
T v[32:33],v18,0
T v[34:35],v18,2048
M v[148:151],a[148:151],a[184:187],v[148:151]
s_sub_u32 s22, s22, 1
buffer_store_dwordx4 v[160:163], v7, s[8:11], s3 offen offset:0 sc1
M v[148:151],a[152:155],a[192:195],v[148:151]
s_waitcnt lgkmcnt(2)
s_nop 0
T v[36:37],v18,4096
T v[38:39],v18,6144
M v[148:151],a[156:159],a[200:203],v[148:151]
s_cselect_b32 s21, s23, s21
T v[40:41],v18,8192
T v[42:43],v18,10240
M v[148:151],a[160:163],a[208:211],v[148:151]
buffer_store_dwordx4 v[168:171], v7, s[8:11], s3 offen offset:1024 sc1
M v[148:151],a[164:167],a[216:219],v[148:151]
s_nop 0
T v[44:45],v18,12288
T v[46:47],v18,14336
M v[148:151],a[168:171],a[224:227],v[148:151]
T v[48:49],v18,16384
T v[50:51],v18,18432
M v[156:159],a[168:171],a[228:231],0
buffer_store_dwordx4 v[176:179], v7, s[8:11], s3 offen offset:2048 sc1
M v[156:159],a[164:167],a[220:223],v[156:159]
s_nop 0
T v[52:53],v18,20480
T v[54:55],v18,22528
M v[156:159],a[160:163],a[212:215],v[156:159]
T v[56:57],v18,24576
T v[58:59],v18,26624
M v[156:159],a[156:159],a[204:207],v[156:159]
buffer_store_dwordx4 v[184:187], v7, s[8:11], s3 offen offset:3072 sc1
M v[156:159],a[152:155],a[196:199],v[156:159]
W a18,v70
W a19,v71
M v[156:159],a[148:151],a[188:191],v[156:159]
MF v76,s5,v76
MF v77,s5,v77
M v[156:159],a[144:147],a[180:183],v[156:159]
s_waitcnt lgkmcnt(6)
MF v78,s5,v78
MF v79,s5,v79
M v[164:167],v[32:35],a[176:179],0
T a[144:145],v19,0
T a[146:147],v19,2048
M v[164:167],v[36:39],a[184:187],v[164:167]
MF v92,s5,v92
MF v93,s5,v93
M v[164:167],v[40:43],a[192:195],v[164:167]
s_waitcnt lgkmcnt(2)
T a[148:149],v19,4096
T a[150:151],v19,6144
M v[164:167],v[44:47],a[200:203],v[164:167]
T a[152:153],v19,8192
T a[154:155],v19,10240
M v[164:167],v[48:51],a[208:211],v[164:167]
MF v94,s5,v94
MF v95,s5,v95
M v[164:167],v[52:55],a[216:219],v[164:167]
T a[156:157],v19,12288
T a[158:159],v19,14336
M v[164:167],v[56:59],a[224:227],v[164:167]
T a[160:161],v19,16384
T a[162:163],v19,18432
M v[172:175],v[56:59],a[228:231],0
C v76,v76,v77
C v77,v78,v79
M v[172:175],v[52:55],a[220:223],v[172:175]
T a[164:165],v19,20480
T a[166:167],v19,22528
M v[172:175],v[48:51],a[212:215],v[172:175]
T a[168:169],v19,24576
T a[170:171],v19,26624
M v[172:175],v[44:47],a[204:207],v[172:175]
C v78,v92,v93
C v79,v94,v95
M v[172:175],v[40:43],a[196:199],v[172:175]
W a48,v76
W a49,v77
M v[172:175],v[36:39],a[188:191],v[172:175]
W a50,v78
W a51,v79
M v[172:175],v[32:35],a[180:183],v[172:175]
s_waitcnt lgkmcnt(6)
v_mov_b32 v30, 2
MF v100,s5,v100
M v[180:183],a[144:147],a[176:179],0
T v[32:33],v16,28672
T v[34:35],v16,30720
M v[180:183],a[148:151],a[184:187],v[180:183]
buffer_store_dword v30, v1, s[8:11], s45 offen sc1
M v[180:183],a[152:155],a[192:195],v[180:183]
s_waitcnt lgkmcnt(2)
s_nop 0
T v[36:37],v16,40960
T v[38:39],v16,43008
M v[180:183],a[156:159],a[200:203],v[180:183]
T v[40:41],v16,45056
T v[42:43],v16,47104
M v[180:183],a[160:163],a[208:211],v[180:183]
MF v101,s5,v101
MF v102,s5,v102
M v[180:183],a[164:167],a[216:219],v[180:183]
T v[44:45],v16,49152
T v[46:47],v16,51200
M v[180:183],a[168:171],a[224:227],v[180:183]
T v[48:49],v16,53248
T v[50:51],v16,55296
M v[188:191],a[168:171],a[228:231],0
MF v103,s5,v103
MF v116,s5,v116
M v[188:191],a[164:167],a[220:223],v[188:191]
T v[52:53],v16,57344
T v[54:55],v16,59392
M v[188:191],a[160:163],a[212:215],v[188:191]
T v[56:57],v16,61440
T v[58:59],v16,63488
M v[188:191],a[156:159],a[204:207],v[188:191]
MF v117,s5,v117
MF v118,s5,v118
M v[188:191],a[152:155],a[196:199],v[188:191]
MF v119,s5,v119
C v100,v100,v101
M v[188:191],a[148:151],a[188:191],v[188:191]
C v101,v102,v103
C v102,v116,v117
M v[188:191],a[144:147],a[180:183],v[188:191]
s_waitcnt lgkmcnt(6)
C v103,v118,v119
W a20,v100
M v[132:135],v[32:35],a[232:235],v[132:135]
T a[144:145],v17,28672
T a[146:147],v17,30720
M v[132:135],v[36:39],a[96:99],v[132:135]
W a21,v101
W a22,v102
M v[132:135],v[40:43],a[104:107],v[132:135]
s_waitcnt lgkmcnt(2)
T a[148:149],v17,40960
T a[150:151],v17,43008
M v[132:135],v[44:47],a[112:115],v[132:135]
T a[152:153],v17,45056
T a[154:155],v17,47104
M v[132:135],v[48:51],a[120:123],v[132:135]
W a23,v103
MF v108,s5,v108
M v[132:135],v[52:55],a[128:131],v[132:135]
T a[156:157],v17,49152
T a[158:159],v17,51200
M v[132:135],v[56:59],a[136:139],v[132:135]
T a[160:161],v17,53248
T a[162:163],v17,55296
M v[140:143],v[56:59],a[140:143],v[140:143]
MF v109,s5,v109
MF v110,s5,v110
M v[140:143],v[52:55],a[132:135],v[140:143]
T a[164:165],v17,57344
T a[166:167],v17,59392
M v[140:143],v[48:51],a[124:127],v[140:143]
T a[168:169],v17,61440
T a[170:171],v17,63488
M v[140:143],v[44:47],a[116:119],v[140:143]
MF v111,s5,v111
MF v124,s5,v124
M v[140:143],v[40:43],a[108:111],v[140:143]
MF v125,s5,v125
MF v126,s5,v126
M v[140:143],v[36:39],a[100:103],v[140:143]
MF v127,s5,v127
C v108,v108,v109
M v[140:143],v[32:35],a[236:239],v[140:143]
s_waitcnt lgkmcnt(6)
C v109,v110,v111
C v110,v124,v125
M v[148:151],a[144:147],a[232:235],v[148:151]
T v[32:33],v18,28672
T v[34:35],v18,30720
M v[148:151],a[148:151],a[96:99],v[148:151]
C v111,v126,v127
W a52,v108
M v[148:151],a[152:155],a[104:107],v[148:151]
s_waitcnt lgkmcnt(2)
T v[36:37],v18,40960
T v[38:39],v18,43008
M v[148:151],a[156:159],a[112:115],v[148:151]
T v[40:41],v18,45056
T v[42:43],v18,47104
M v[148:151],a[160:163],a[120:123],v[148:151]
W a53,v109
W a54,v110
M v[148:151],a[164:167],a[128:131],v[148:151]
T v[44:45],v18,49152
T v[46:47],v18,51200
M v[148:151],a[168:171],a[136:139],v[148:151]
T v[48:49],v18,53248
T v[50:51],v18,55296
M v[156:159],a[168:171],a[140:143],v[156:159]
W a55,v111
s_waitcnt vmcnt(11)
v_cmp_ne_u32 vcc, 1, v5
M v[156:159],a[164:167],a[132:135],v[156:159]
s_nop 0
T v[52:53],v18,57344
T v[54:55],v18,59392
M v[156:159],a[160:163],a[124:127],v[156:159]
s_cmp_lg_u32 vcc_hi, 0
T v[56:57],v18,61440
T v[58:59],v18,63488
M v[156:159],a[156:159],a[116:119],v[156:159]
s_cbranch_scc1 L_wsr0
L_wrr0:
MF v132,s5,v132
MF v133,s5,v133
M v[156:159],a[152:155],a[108:111],v[156:159]
SA m0,s28,131072
MF v134,s5,v134
MF v135,s5,v135
M v[156:159],a[148:151],a[100:103],v[156:159]
buffer_load_dwordx4 v3, s[8:11], s26 offen offset:0 sc1 lds
M v[156:159],a[144:147],a[236:239],v[156:159]
s_waitcnt lgkmcnt(6)
MF v148,s5,v148
MF v149,s5,v149
M v[164:167],v[32:35],a[232:235],v[164:167]
T a[144:145],v19,28672
T a[146:147],v19,30720
M v[164:167],v[36:39],a[96:99],v[164:167]
buffer_load_dwordx4 v3, s[8:11], s26 offen offset:1024 sc1 lds
M v[164:167],v[40:43],a[104:107],v[164:167]
s_waitcnt lgkmcnt(2)
s_nop 0
T a[148:149],v19,40960
T a[150:151],v19,43008
M v[164:167],v[44:47],a[112:115],v[164:167]
T a[152:153],v19,45056
T a[154:155],v19,47104
M v[164:167],v[48:51],a[120:123],v[164:167]
buffer_load_dwordx4 v3, s[8:11], s26 offen offset:2048 sc1 lds
M v[164:167],v[52:55],a[128:131],v[164:167]
s_nop 0
T a[156:157],v19,49152
T a[158:159],v19,51200
M v[164:167],v[56:59],a[136:139],v[164:167]
T a[160:161],v19,53248
T a[162:163],v19,55296
M v[172:175],v[56:59],a[140:143],v[172:175]
buffer_load_dwordx4 v3, s[8:11], s26 offen offset:3072 sc1 lds
M v[172:175],v[52:55],a[132:135],v[172:175]
SA m0,s28,135168
T a[164:165],v19,57344
T a[166:167],v19,59392
M v[172:175],v[48:51],a[124:127],v[172:175]
T a[168:169],v19,61440
T a[170:171],v19,63488
M v[172:175],v[44:47],a[116:119],v[172:175]
buffer_load_dwordx4 v4, s[8:11], s26 offen offset:0 sc1 lds
M v[172:175],v[40:43],a[108:111],v[172:175]
MF v150,s5,v150
MF v151,s5,v151
M v[172:175],v[36:39],a[100:103],v[172:175]
s_waitcnt lgkmcnt(0)
buffer_load_dwordx4 v4, s[8:11], s26 offen offset:1024 sc1 lds
M v[172:175],v[32:35],a[236:239],v[172:175]
s_barrier
M v[180:183],a[144:147],a[232:235],v[180:183]
R a[64:67],v2,32768
R a[68:71],v2,33792
M v[180:183],a[148:151],a[96:99],v[180:183]
buffer_load_dwordx4 v4, s[8:11], s26 offen offset:2048 sc1 lds
M v[180:183],a[152:155],a[104:107],v[180:183]
C v132,v132,v133
C v133,v134,v135
M v[180:183],a[156:159],a[112:115],v[180:183]
R a[72:75],v2,34816
R a[76:79],v2,35840
M v[180:183],a[160:163],a[120:123],v[180:183]
buffer_load_dwordx4 v4, s[8:11], s26 offen offset:3072 sc1 lds
M v[180:183],a[164:167],a[128:131],v[180:183]
SA s26,s26,32768
C v134,v148,v149
C v135,v150,v151
M v[180:183],a[168:171],a[136:139],v[180:183]
R a[80:83],v2,36864
R a[84:87],v2,37888
M v[188:191],a[168:171],a[140:143],v[188:191]
W a24,v132
W a25,v133
M v[188:191],a[164:167],a[132:135],v[188:191]
W a26,v134
W a27,v135
M v[188:191],a[160:163],a[124:127],v[188:191]
R a[88:91],v2,38912
R a[92:95],v2,39936
M v[188:191],a[156:159],a[116:119],v[188:191]
MF v140,s5,v140
MF v141,s5,v141
M v[188:191],a[152:155],a[108:111],v[188:191]
MF v142,s5,v142
MF v143,s5,v143
M v[188:191],a[148:151],a[100:103],v[188:191]
MF v156,s5,v156
MF v157,s5,v157
M v[188:191],a[144:147],a[236:239],v[188:191]
s_waitcnt lgkmcnt(0)
MF v158,s5,v158
MF v159,s5,v159
C v140,v140,v141
C v141,v142,v143
C v142,v156,v157
C v143,v158,v159
W a56,v140
W a57,v141
W a58,v142
W a59,v143
s_cmp_eq_u32 s42, 0
s_cbranch_scc1 L_j0
M v[64:67],a[64:67],a[0:3],0
R a[96:99],v2,40960
R a[100:103],v2,41984
M v[64:67],a[68:71],a[4:7],v[64:67]
MF v164,s5,v164
MF v165,s5,v165
M v[64:67],a[72:75],a[8:11],v[64:67]
MF v166,s5,v166
MF v167,s5,v167
M v[64:67],a[76:79],a[12:15],v[64:67]
R a[104:107],v2,43008
R a[108:111],v2,44032
M v[64:67],a[80:83],a[16:19],v[64:67]
MF v180,s5,v180
MF v181,s5,v181
MF v182,s5,v182
MF v183,s5,v183
C v164,v164,v165
C v165,v166,v167
C v166,v180,v181
C v167,v182,v183
W a28,v164
W a29,v165
W a30,v166
W a31,v167
M v[64:67],a[84:87],a[20:23],v[64:67]
MF v172,s5,v172
MF v173,s5,v173
M v[64:67],a[88:91],a[24:27],v[64:67]
R a[112:115],v2,45056
R a[116:119],v2,46080
M v[64:67],a[92:95],a[28:31],v[64:67]
MF v174,s5,v174
MF v175,s5,v175
M v[68:71],a[64:67],a[32:35],0
MF v188,s5,v188
MF v189,s5,v189
M v[68:71],a[68:71],a[36:39],v[68:71]
R a[120:123],v2,47104
R a[124:127],v2,48128
M v[68:71],a[72:75],a[40:43],v[68:71]
SA m0,s28,32768
MF v190,s5,v190
MF v191,s5,v191
M v[68:71],a[76:79],a[44:47],v[68:71]
SA s3,s93,786432
buffer_load_dwordx4 v3, s[8:11], s26 offen offset:0 sc1 lds
M v[68:71],a[80:83],a[48:51],v[68:71]
C v172,v172,v173
C v173,v174,v175
C v174,v188,v189
C v175,v190,v191
W a60,v172
W a61,v173
W a62,v174
W a63,v175
M v[68:71],a[84:87],a[52:55],v[68:71]
E v18,v64
M v[68:71],a[88:91],a[56:59],v[68:71]
buffer_store_dwordx4 v[192:195], v7, s[8:11], s3 offen offset:0 sc1
M v[68:71],a[92:95],a[60:63],v[68:71]
s_waitcnt lgkmcnt(0)
E v19,v65
M v[72:75],a[96:99],a[0:3],0
R a[64:67],v2,49152
R a[68:71],v2,50176
M v[72:75],a[100:103],a[4:7],v[72:75]
buffer_load_dwordx4 v3, s[8:11], s26 offen offset:1024 sc1 lds
M v[72:75],a[104:107],a[8:11],v[72:75]
E v20,v66
M v[72:75],a[108:111],a[12:15],v[72:75]
R a[72:75],v2,51200
R a[76:79],v2,52224
M v[72:75],a[112:115],a[16:19],v[72:75]
buffer_load_dwordx4 v3, s[8:11], s26 offen offset:2048 sc1 lds
M v[72:75],a[116:119],a[20:23],v[72:75]
E v21,v67
M v[72:75],a[120:123],a[24:27],v[72:75]
R a[80:83],v2,53248
R a[84:87],v2,54272
M v[72:75],a[124:127],a[28:31],v[72:75]
buffer_load_dwordx4 v3, s[8:11], s26 offen offset:3072 sc1 lds
M v[76:79],a[124:127],a[60:63],0
SA m0,s28,36864
E v22,v68
M v[76:79],a[120:123],a[56:59],v[76:79]
R a[88:91],v2,55296
R a[92:95],v2,56320
M v[76:79],a[116:119],a[52:55],v[76:79]
buffer_load_dwordx4 v4, s[8:11], s26 offen offset:0 sc1 lds
M v[76:79],a[112:115],a[48:51],v[76:79]
E v23,v69
M v[76:79],a[108:111],a[44:47],v[76:79]
AF v26,v18,v19
C v40,v18,v19
M v[76:79],a[104:107],a[40:43],v[76:79]
buffer_load_dwordx4 v4, s[8:11], s26 offen offset:1024 sc1 lds
M v[76:79],a[100:103],a[36:39],v[76:79]
v_add_u32 v16, 0x20000, v7
AF v26,v20,v26
M v[76:79],a[96:99],a[32:35],v[76:79]
s_waitcnt lgkmcnt(0)
E v24,v70
M v[80:83],a[64:67],a[0:3],0
R a[96:99],v2,57344
R a[100:103],v2,58368
M v[80:83],a[68:71],a[4:7],v[80:83]
buffer_load_dwordx4 v4, s[8:11], s26 offen offset:2048 sc1 lds
M v[80:83],a[72:75],a[8:11],v[80:83]
E v25,v71
M v[80:83],a[76:79],a[12:15],v[80:83]
R a[104:107],v2,59392
R a[108:111],v2,60416
M v[80:83],a[80:83],a[16:19],v[80:83]
buffer_store_dwordx4 v[200:203], v7, s[8:11], s3 offen offset:1024 sc1
M v[80:83],a[84:87],a[20:23],v[80:83]
E v18,v72
M v[80:83],a[88:91],a[24:27],v[80:83]
R a[112:115],v2,61440
R a[116:119],v2,62464
M v[80:83],a[92:95],a[28:31],v[80:83]
buffer_load_dwordx4 v4, s[8:11], s26 offen offset:3072 sc1 lds
M v[84:87],a[92:95],a[60:63],0
SA s26,s26,32768
E v19,v73
M v[84:87],a[88:91],a[56:59],v[84:87]
R a[120:123],v2,63488
R a[124:127],v2,64512
M v[84:87],a[84:87],a[52:55],v[84:87]
C v41,v20,v21
AF v26,v21,v26
M v[84:87],a[80:83],a[48:51],v[84:87]
buffer_store_dwordx4 v[208:211], v7, s[8:11], s3 offen offset:2048 sc1
M v[84:87],a[76:79],a[44:47],v[84:87]
E v20,v74
M v[84:87],a[72:75],a[40:43],v[84:87]
AF v27,v22,v23
C v44,v22,v23
M v[84:87],a[68:71],a[36:39],v[84:87]
s_waitcnt vmcnt(24) lgkmcnt(0)
E v21,v75
M v[84:87],a[64:67],a[32:35],v[84:87]
s_barrier
M v[88:91],a[96:99],a[0:3],0
R a[64:67],v2,0
R a[68:71],v2,1024
M v[88:91],a[100:103],a[4:7],v[88:91]
E v22,v76
M v[88:91],a[104:107],a[8:11],v[88:91]
AF v27,v24,v27
C v45,v24,v25
M v[88:91],a[108:111],a[12:15],v[88:91]
R a[72:75],v2,2048
R a[76:79],v2,3072
M v[88:91],a[112:115],a[16:19],v[88:91]
E v23,v77
M v[88:91],a[116:119],a[20:23],v[88:91]
AF v27,v25,v27
AF v26,v18,v26
M v[88:91],a[120:123],a[24:27],v[88:91]
R a[80:83],v2,4096
R a[84:87],v2,5120
M v[88:91],a[124:127],a[28:31],v[88:91]
E v24,v78
M v[92:95],a[124:127],a[60:63],0
C v42,v18,v19
AF v26,v19,v26
M v[92:95],a[120:123],a[56:59],v[92:95]
R a[88:91],v2,6144
R a[92:95],v2,7168
M v[92:95],a[116:119],a[52:55],v[92:95]
E v25,v79
M v[92:95],a[112:115],a[48:51],v[92:95]
AF v26,v20,v26
C v43,v20,v21
M v[92:95],a[108:111],a[44:47],v[92:95]
AF v26,v21,v26
AF v27,v22,v27
M v[92:95],a[104:107],a[40:43],v[92:95]
C v46,v22,v23
AF v27,v23,v27
M v[92:95],a[100:103],a[36:39],v[92:95]
s_waitcnt lgkmcnt(0)
AF v27,v24,v27
C v47,v24,v25
M v[92:95],a[96:99],a[32:35],v[92:95]
AF v27,v25,v27
M v[96:99],a[64:67],a[0:3],0
R a[96:99],v2,8192
R a[100:103],v2,9216
M v[96:99],a[68:71],a[4:7],v[96:99]
SA m0,s28,98304
E v18,v80
M v[96:99],a[72:75],a[8:11],v[96:99]
buffer_load_dwordx4 v3, s[8:11], s21 offen offset:0 sc1 lds
M v[96:99],a[76:79],a[12:15],v[96:99]
R a[104:107],v2,10240
R a[108:111],v2,11264
M v[96:99],a[80:83],a[16:19],v[96:99]
v_mov_b32 v30, 0
M v[96:99],a[84:87],a[20:23],v[96:99]
E v19,v81
M v[96:99],a[88:91],a[24:27],v[96:99]
R a[112:115],v2,12288
R a[116:119],v2,13312
M v[96:99],a[92:95],a[28:31],v[96:99]
buffer_load_dwordx4 v3, s[8:11], s21 offen offset:1024 sc1 lds
M v[100:103],a[92:95],a[60:63],0
v_mov_b32 v31, 0
AF v26,v18,v26
M v[100:103],a[88:91],a[56:59],v[100:103]
R a[120:123],v2,14336
R a[124:127],v2,15360
M v[100:103],a[84:87],a[52:55],v[100:103]
SA s3,s93,786432
E v20,v82
M v[100:103],a[80:83],a[48:51],v[100:103]
buffer_load_dwordx4 v3, s[8:11], s21 offen offset:2048 sc1 lds
M v[100:103],a[76:79],a[44:47],v[100:103]
E v21,v83
M v[100:103],a[72:75],a[40:43],v[100:103]
v_mov_b32 v32, 0
C v56,v18,v19
M v[100:103],a[68:71],a[36:39],v[100:103]
buffer_store_dwordx4 v[216:219], v7, s[8:11], s3 offen offset:3072 sc1
M v[100:103],a[64:67],a[32:35],v[100:103]
s_waitcnt lgkmcnt(0)
E v22,v88
M v[108:111],a[96:99],a[32:35],0
R a[64:67],v2,16384
R a[68:71],v2,17408
M v[108:111],a[100:103],a[36:39],v[108:111]
buffer_load_dwordx4 v3, s[8:11], s21 offen offset:3072 sc1 lds
M v[108:111],a[104:107],a[40:43],v[108:111]
SA m0,s28,102400
v_mov_b32 v33, 0
AF v26,v19,v26
M v[108:111],a[108:111],a[44:47],v[108:111]
R a[72:75],v2,18432
R a[76:79],v2,19456
M v[108:111],a[112:115],a[48:51],v[108:111]
buffer_load_dwordx4 v4, s[8:11], s21 offen offset:0 sc1 lds
M v[108:111],a[116:119],a[52:55],v[108:111]
E v23,v89
M v[108:111],a[120:123],a[56:59],v[108:111]
R a[80:83],v2,20480
R a[84:87],v2,21504
M v[108:111],a[124:127],a[60:63],v[108:111]
buffer_load_dwordx4 v4, s[8:11], s21 offen offset:1024 sc1 lds
M v[104:107],a[124:127],a[28:31],0
v_mov_b32 v34, 0
AF v26,v20,v26
M v[104:107],a[120:123],a[24:27],v[104:107]
SA s3,s93,794624
R a[88:91],v2,22528
R a[92:95],v2,23552
M v[104:107],a[116:119],a[20:23],v[104:107]
buffer_load_dwordx4 v4, s[8:11], s21 offen offset:2048 sc1 lds
M v[104:107],a[112:115],a[16:19],v[104:107]
v_mov_b32 v35, 0
C v57,v20,v21
M v[104:107],a[108:111],a[12:15],v[104:107]
E v24,v90
M v[104:107],a[104:107],a[8:11],v[104:107]
E v25,v91
M v[104:107],a[100:103],a[4:7],v[104:107]
buffer_load_dwordx4 v4, s[8:11], s21 offen offset:3072 sc1 lds
M v[104:107],a[96:99],a[0:3],v[104:107]
s_waitcnt lgkmcnt(0)
v_mov_b32 v36, 0
AF v26,v21,v26
M v[112:115],a[64:67],a[0:3],0
SA s21,s21,32768
R a[96:99],v2,24576
R a[100:103],v2,25600
M v[112:115],a[68:71],a[4:7],v[112:115]
s_sub_u32 s22, s22, 1
buffer_store_dwordx4 v[224:227], v7, s[8:11], s3 offen offset:0 sc1
M v[112:115],a[72:75],a[8:11],v[112:115]
s_cselect_b32 s21, s23, s21
E v18,v84
M v[112:115],a[76:79],a[12:15],v[112:115]
R a[104:107],v2,26624
R a[108:111],v2,27648
M v[112:115],a[80:83],a[16:19],v[112:115]
v_mov_b32 v37, 0
AF v26,v22,v26
M v[112:115],a[84:87],a[20:23],v[112:115]
E v19,v85
M v[112:115],a[88:91],a[24:27],v[112:115]
R a[112:115],v2,28672
R a[116:119],v2,29696
M v[112:115],a[92:95],a[28:31],v[112:115]
E v20,v86
M v[116:119],a[92:95],a[60:63],0
v_mov_b32 v38, 0
C v58,v22,v23
M v[116:119],a[88:91],a[56:59],v[116:119]
R a[120:123],v2,30720
R a[124:127],v2,31744
M v[116:119],a[84:87],a[52:55],v[116:119]
E v21,v87
M v[116:119],a[80:83],a[48:51],v[116:119]
buffer_store_dwordx4 v[232:235], v7, s[8:11], s3 offen offset:1024 sc1
M v[116:119],a[76:79],a[44:47],v[116:119]
AF v26,v23,v26
AF v26,v24,v26
M v[116:119],a[72:75],a[40:43],v[116:119]
v_mov_b32 v39, 0
C v59,v24,v25
M v[116:119],a[68:71],a[36:39],v[116:119]
s_waitcnt vmcnt(22) lgkmcnt(0)
E v22,v92
M v[116:119],a[64:67],a[32:35],v[116:119]
s_barrier
M v[124:127],a[96:99],a[32:35],0
R a[64:67],v16,0
R a[68:71],v16,1024
M v[124:127],a[100:103],a[36:39],v[124:127]
E v23,v93
M v[124:127],a[104:107],a[40:43],v[124:127]
AF v26,v25,v26
AF v27,v18,v27
M v[124:127],a[108:111],a[44:47],v[124:127]
R a[72:75],v16,2048
R a[76:79],v16,3072
M v[124:127],a[112:115],a[48:51],v[124:127]
E v24,v94
M v[124:127],a[116:119],a[52:55],v[124:127]
E v25,v95
M v[124:127],a[120:123],a[56:59],v[124:127]
R a[80:83],v16,4096
R a[84:87],v16,5120
M v[124:127],a[124:127],a[60:63],v[124:127]
C v60,v18,v19
AF v27,v19,v27
M v[120:123],a[124:127],a[28:31],0
AF v27,v20,v27
C v61,v20,v21
M v[120:123],a[120:123],a[24:27],v[120:123]
R a[88:91],v16,6144
R a[92:95],v16,7168
M v[120:123],a[116:119],a[20:23],v[120:123]
AF v27,v21,v27
AF v27,v22,v27
M v[120:123],a[112:115],a[16:19],v[120:123]
C v62,v22,v23
AF v27,v23,v27
M v[120:123],a[108:111],a[12:15],v[120:123]
AF v27,v24,v27
C v63,v24,v25
M v[120:123],a[104:107],a[8:11],v[120:123]
AF v27,v25,v27
M v[120:123],a[100:103],a[4:7],v[120:123]
s_waitcnt lgkmcnt(0)
M v[120:123],a[96:99],a[0:3],v[120:123]
v_max_f32 v10, v26, v27
v_min_f32 v11, v26, v27
v_cmp_lt_f32 vcc, s31, v10
v_cmp_gt_f32 s[64:65], s24, v11
s_nop 0
s_or_b64 vcc, vcc, s[64:65]
s_cbranch_vccnz L_stk1
L_rtk1:
M v[128:131],a[64:67],v[40:43],0
R a[96:99],v16,8192
R a[100:103],v16,9216
M v[128:131],a[68:71],v[56:59],v[128:131]
SA m0,s28,65536
E v18,v96
M v[132:135],a[68:71],v[60:63],0
buffer_load_dwordx4 v3, s[8:11], s21 offen offset:0 sc1 lds
M v[132:135],a[64:67],v[44:47],v[132:135]
R a[104:107],v16,10240
R a[108:111],v16,11264
M v[140:143],a[72:75],v[44:47],0
SA s3,s93,794624
E v19,v97
M v[140:143],a[76:79],v[60:63],v[140:143]
AF v30,v26,v30
AF v31,v27,v31
M v[136:139],a[76:79],v[56:59],0
R a[112:115],v16,12288
R a[116:119],v16,13312
M v[136:139],a[72:75],v[40:43],v[136:139]
buffer_load_dwordx4 v3, s[8:11], s21 offen offset:1024 sc1 lds
M v[144:147],a[80:83],v[40:43],0
E v20,v98
M v[144:147],a[84:87],v[56:59],v[144:147]
R a[120:123],v16,14336
R a[124:127],v16,15360
M v[148:151],a[84:87],v[60:63],0
buffer_store_dwordx4 v[240:243], v7, s[8:11], s3 offen offset:2048 sc1
M v[148:151],a[80:83],v[44:47],v[148:151]
E v21,v99
M v[156:159],a[88:91],v[44:47],0
AF v28,v18,v19
C v48,v18,v19
M v[156:159],a[92:95],v[60:63],v[156:159]
buffer_load_dwordx4 v3, s[8:11], s21 offen offset:2048 sc1 lds
M v[152:155],a[92:95],v[56:59],0
AF v28,v20,v28
C v49,v20,v21
M v[152:155],a[88:91],v[40:43],v[152:155]
s_waitcnt lgkmcnt(0)
E v22,v104
M v[160:163],a[96:99],v[40:43],0
R a[64:67],v16,16384
R a[68:71],v16,17408
M v[160:163],a[100:103],v[56:59],v[160:163]
buffer_load_dwordx4 v3, s[8:11], s21 offen offset:3072 sc1 lds
M v[164:167],a[100:103],v[60:63],0
SA m0,s28,69632
E v23,v105
M v[164:167],a[96:99],v[44:47],v[164:167]
R a[72:75],v16,18432
R a[76:79],v16,19456
M v[172:175],a[104:107],v[44:47],0
buffer_load_dwordx4 v4, s[8:11], s21 offen offset:0 sc1 lds
M v[172:175],a[108:111],v[60:63],v[172:175]
AF v28,v21,v28
AF v28,v22,v28
M v[168:171],a[108:111],v[56:59],0
R a[80:83],v16,20480
R a[84:87],v16,21504
M v[168:171],a[104:107],v[40:43],v[168:171]
buffer_store_dwordx4 v[248:251], v7, s[8:11], s3 offen offset:3072 sc1
M v[176:179],a[112:115],v[40:43],0
E v24,v106
M v[176:179],a[116:119],v[56:59],v[176:179]
R a[88:91],v16,22528
R a[92:95],v16,23552
M v[180:183],a[116:119],v[60:63],0
buffer_load_dwordx4 v4, s[8:11], s21 offen offset:1024 sc1 lds
M v[180:183],a[112:115],v[44:47],v[180:183]
E v25,v107
M v[188:191],a[120:123],v[44:47],0
C v50,v22,v23
AF v28,v23,v28
M v[188:191],a[124:127],v[60:63],v[188:191]
buffer_load_dwordx4 v4, s[8:11], s21 offen offset:2048 sc1 lds
M v[184:187],a[124:127],v[56:59],0
E v18,v100
M v[184:187],a[120:123],v[40:43],v[184:187]
s_waitcnt lgkmcnt(0)
AF v28,v24,v28
C v51,v24,v25
M v[192:195],a[64:67],v[40:43],0
R a[96:99],v16,24576
R a[100:103],v16,25600
M v[192:195],a[68:71],v[56:59],v[192:195]
buffer_load_dwordx4 v4, s[8:11], s21 offen offset:3072 sc1 lds
M v[196:199],a[68:71],v[60:63],0
SA s21,s21,32768
E v19,v101
M v[196:199],a[64:67],v[44:47],v[196:199]
s_sub_u32 s22, s22, 1
R a[104:107],v16,26624
R a[108:111],v16,27648
M v[204:207],a[72:75],v[44:47],0
s_cselect_b32 s21, s23, s21
AF v28,v25,v28
AF v29,v18,v19
M v[204:207],a[76:79],v[60:63],v[204:207]
E v20,v102
M v[200:203],a[76:79],v[56:59],0
R a[112:115],v16,28672
R a[116:119],v16,29696
M v[200:203],a[72:75],v[40:43],v[200:203]
C v52,v18,v19
M v[208:211],a[80:83],v[40:43],0
M v[208:211],a[84:87],v[56:59],v[208:211]
R a[120:123],v16,30720
R a[124:127],v16,31744
M v[212:215],a[84:87],v[60:63],0
E v21,v103
M v[212:215],a[80:83],v[44:47],v[212:215]
AF v29,v20,v29
C v53,v20,v21
M v[220:223],a[88:91],v[44:47],0
AF v29,v21,v29
M v[220:223],a[92:95],v[60:63],v[220:223]
E v22,v108
M v[216:219],a[92:95],v[56:59],0
s_waitcnt vmcnt(12) lgkmcnt(0)
M v[216:219],a[88:91],v[40:43],v[216:219]
s_barrier
M v[224:227],a[96:99],v[40:43],0
R a[64:67],v2,32768
R a[68:71],v2,33792
M v[224:227],a[100:103],v[56:59],v[224:227]
E v23,v109
M v[228:231],a[100:103],v[60:63],0
AF v29,v22,v29
C v54,v22,v23
M v[228:231],a[96:99],v[44:47],v[228:231]
R a[72:75],v2,34816
R a[76:79],v2,35840
M v[236:239],a[104:107],v[44:47],0
E v24,v110
M v[236:239],a[108:111],v[60:63],v[236:239]
AF v29,v23,v29
M v[232:235],a[108:111],v[56:59],0
R a[80:83],v2,36864
R a[84:87],v2,37888
M v[232:235],a[104:107],v[40:43],v[232:235]
M v[240:243],a[112:115],v[40:43],0
E v25,v111
M v[240:243],a[116:119],v[56:59],v[240:243]
R a[88:91],v2,38912
R a[92:95],v2,39936
M v[244:247],a[116:119],v[60:63],0
AF v29,v24,v29
C v55,v24,v25
M v[244:247],a[112:115],v[44:47],v[244:247]
AF v29,v25,v29
M v[252:255],a[120:123],v[44:47],0
M v[252:255],a[124:127],v[60:63],v[252:255]
M v[248:251],a[124:127],v[56:59],0
s_waitcnt lgkmcnt(0)
M v[248:251],a[120:123],v[40:43],v[248:251]
s_cmp_lg_u32 s27, 0
s_cbranch_scc1 L_loop_top
s_branch L_d1s
L_j0:
M v[68:71],a[64:67],a[32:35],0
s_cmp_lt_u32 s20, 0
R a[96:99],v2,40960
R a[100:103],v2,41984
M v[68:71],a[68:71],a[36:39],v[68:71]
s_cselect_b64 s[82:83], -1, 0
v_mov_b32 v30, 0
MF v172,s5,v172
M v[68:71],a[72:75],a[40:43],v[68:71]
s_cmp_eq_u32 s20, 0
MF v173,s5,v173
MF v174,s5,v174
M v[68:71],a[76:79],a[44:47],v[68:71]
s_cselect_b64 s[66:67], s[16:17], s[82:83]
R a[104:107],v2,43008
R a[108:111],v2,44032
M v[68:71],a[80:83],a[48:51],v[68:71]
s_cselect_b64 s[68:69], s[18:19], s[82:83]
MF v175,s5,v175
MF v188,s5,v188
M v[68:71],a[84:87],a[52:55],v[68:71]
s_cselect_b64 s[70:71], s[48:49], s[82:83]
MF v189,s5,v189
MF v190,s5,v190
MF v191,s5,v191
C v172,v172,v173
C v173,v174,v175
C v174,v188,v189
C v175,v190,v191
W a60,v172
W a61,v173
W a62,v174
W a63,v175
M v[68:71],a[88:91],a[56:59],v[68:71]
s_cselect_b64 s[72:73], s[50:51], s[82:83]
R a[112:115],v2,45056
R a[116:119],v2,46080
v_cndmask_b32 v64, 0, v8, s[66:67]
v_cndmask_b32 v65, 0, v8, s[68:69]
v_cndmask_b32 v66, 0, v8, s[70:71]
v_cndmask_b32 v67, 0, v8, s[72:73]
M v[68:71],a[92:95],a[60:63],v[68:71]
s_cmp_lt_u32 s20, 1
MF v164,s5,v164
MF v165,s5,v165
M v[64:67],a[64:67],a[0:3],v[64:67]
s_cselect_b64 s[82:83], -1, 0
MF v166,s5,v166
MF v167,s5,v167
M v[64:67],a[68:71],a[4:7],v[64:67]
s_cmp_eq_u32 s20, 1
R a[120:123],v2,47104
R a[124:127],v2,48128
M v[64:67],a[72:75],a[8:11],v[64:67]
s_cselect_b64 s[74:75], s[16:17], s[82:83]
MF v180,s5,v180
MF v181,s5,v181
M v[64:67],a[76:79],a[12:15],v[64:67]
s_cselect_b64 s[76:77], s[18:19], s[82:83]
MF v182,s5,v182
MF v183,s5,v183
M v[64:67],a[80:83],a[16:19],v[64:67]
s_cselect_b64 s[78:79], s[48:49], s[82:83]
C v164,v164,v165
C v165,v166,v167
C v166,v180,v181
C v167,v182,v183
W a28,v164
W a29,v165
W a30,v166
W a31,v167
M v[64:67],a[84:87],a[20:23],v[64:67]
s_cselect_b64 s[80:81], s[50:51], s[82:83]
v_mov_b32 v31, 0
v_cndmask_b32 v72, 0, v8, s[74:75]
M v[64:67],a[88:91],a[24:27],v[64:67]
s_mov_b32 s26, s43
v_mov_b32 v32, 0
M v[64:67],a[92:95],a[28:31],v[64:67]
s_waitcnt lgkmcnt(0)
v_cndmask_b32 v73, 0, v8, s[76:77]
M v[76:79],a[96:99],a[32:35],0
SA m0,s28,0
R a[64:67],v2,49152
R a[68:71],v2,50176
M v[76:79],a[100:103],a[36:39],v[76:79]
SA s3,s93,786432
buffer_load_dwordx4 v3, s[8:11], s26 offen offset:0 sc1 lds
M v[76:79],a[104:107],a[40:43],v[76:79]
v_cndmask_b32 v74, 0, v8, s[78:79]
v_mov_b32 v33, 0
M v[76:79],a[108:111],a[44:47],v[76:79]
R a[72:75],v2,51200
R a[76:79],v2,52224
M v[76:79],a[112:115],a[48:51],v[76:79]
buffer_store_dwordx4 v[192:195], v7, s[8:11], s3 offen offset:0 sc1
M v[76:79],a[116:119],a[52:55],v[76:79]
v_cndmask_b32 v75, 0, v8, s[80:81]
M v[76:79],a[120:123],a[56:59],v[76:79]
s_cmp_lt_u32 s20, 2
R a[80:83],v2,53248
R a[84:87],v2,54272
M v[76:79],a[124:127],a[60:63],v[76:79]
s_cselect_b64 s[82:83], -1, 0
buffer_load_dwordx4 v3, s[8:11], s26 offen offset:1024 sc1 lds
M v[72:75],a[124:127],a[28:31],v[72:75]
s_cmp_eq_u32 s20, 2
E v18,v68
M v[72:75],a[120:123],a[24:27],v[72:75]
s_cselect_b64 s[66:67], s[16:17], s[82:83]
R a[88:91],v2,55296
R a[92:95],v2,56320
M v[72:75],a[116:119],a[20:23],v[72:75]
s_cselect_b64 s[68:69], s[18:19], s[82:83]
buffer_load_dwordx4 v3, s[8:11], s26 offen offset:2048 sc1 lds
M v[72:75],a[112:115],a[16:19],v[72:75]
s_cselect_b64 s[70:71], s[48:49], s[82:83]
v_mov_b32 v34, 0
M v[72:75],a[108:111],a[12:15],v[72:75]
s_cselect_b64 s[72:73], s[50:51], s[82:83]
v_cndmask_b32 v80, 0, v8, s[66:67]
v_cndmask_b32 v81, 0, v8, s[68:69]
M v[72:75],a[104:107],a[8:11],v[72:75]
buffer_store_dwordx4 v[200:203], v7, s[8:11], s3 offen offset:1024 sc1
M v[72:75],a[100:103],a[4:7],v[72:75]
E v19,v69
M v[72:75],a[96:99],a[0:3],v[72:75]
s_waitcnt lgkmcnt(0)
buffer_load_dwordx4 v3, s[8:11], s26 offen offset:3072 sc1 lds
M v[84:87],a[64:67],a[32:35],0
SA m0,s28,4096
R a[96:99],v2,57344
R a[100:103],v2,58368
M v[84:87],a[68:71],a[36:39],v[84:87]
v_cndmask_b32 v82, 0, v8, s[70:71]
v_mov_b32 v35, 0
M v[84:87],a[72:75],a[40:43],v[84:87]
buffer_load_dwordx4 v4, s[8:11], s26 offen offset:0 sc1 lds
M v[84:87],a[76:79],a[44:47],v[84:87]
R a[104:107],v2,59392
R a[108:111],v2,60416
M v[84:87],a[80:83],a[48:51],v[84:87]
buffer_store_dwordx4 v[208:211], v7, s[8:11], s3 offen offset:2048 sc1
M v[84:87],a[84:87],a[52:55],v[84:87]
v_cndmask_b32 v83, 0, v8, s[72:73]
v_mov_b32 v36, 0
M v[84:87],a[88:91],a[56:59],v[84:87]
s_cmp_lt_u32 s20, 3
R a[112:115],v2,61440
R a[116:119],v2,62464
M v[84:87],a[92:95],a[60:63],v[84:87]
s_cselect_b64 s[82:83], -1, 0
buffer_load_dwordx4 v4, s[8:11], s26 offen offset:1024 sc1 lds
M v[80:83],a[92:95],a[28:31],v[80:83]
s_cmp_eq_u32 s20, 3
E v20,v70
M v[80:83],a[88:91],a[24:27],v[80:83]
s_cselect_b64 s[74:75], s[16:17], s[82:83]
R a[120:123],v2,63488
R a[124:127],v2,64512
M v[80:83],a[84:87],a[20:23],v[80:83]
s_cselect_b64 s[76:77], s[18:19], s[82:83]
buffer_load_dwordx4 v4, s[8:11], s26 offen offset:2048 sc1 lds
M v[80:83],a[80:83],a[16:19],v[80:83]
s_cselect_b64 s[78:79], s[48:49], s[82:83]
E v21,v71
M v[80:83],a[76:79],a[12:15],v[80:83]
s_cselect_b64 s[80:81], s[50:51], s[82:83]
buffer_store_dwordx4 v[216:219], v7, s[8:11], s3 offen offset:3072 sc1
M v[80:83],a[72:75],a[8:11],v[80:83]
SA s3,s93,794624
v_cndmask_b32 v88, 0, v8, s[74:75]
v_cndmask_b32 v89, 0, v8, s[76:77]
M v[80:83],a[68:71],a[4:7],v[80:83]
s_waitcnt vmcnt(24) lgkmcnt(0)
buffer_load_dwordx4 v4, s[8:11], s26 offen offset:3072 sc1 lds
M v[80:83],a[64:67],a[0:3],v[80:83]
s_barrier
M v[92:95],a[96:99],a[32:35],0
R a[64:67],v2,0
R a[68:71],v2,1024
M v[92:95],a[100:103],a[36:39],v[92:95]
buffer_store_dwordx4 v[224:227], v7, s[8:11], s3 offen offset:0 sc1
M v[92:95],a[104:107],a[40:43],v[92:95]
v_min_u32 v17, 896, v9
v_cndmask_b32 v90, 0, v8, s[78:79]
M v[92:95],a[108:111],a[44:47],v[92:95]
R a[72:75],v2,2048
R a[76:79],v2,3072
M v[92:95],a[112:115],a[48:51],v[92:95]
buffer_load_dword v5, v17, s[8:11], s46 offen sc1
M v[92:95],a[116:119],a[52:55],v[92:95]
buffer_store_dwordx4 v[232:235], v7, s[8:11], s3 offen offset:1024 sc1
M v[92:95],a[120:123],a[56:59],v[92:95]
R a[80:83],v2,4096
R a[84:87],v2,5120
v_cndmask_b32 v91, 0, v8, s[80:81]
M v[92:95],a[124:127],a[60:63],v[92:95]
v_mov_b32 v37, 0
v_mov_b32 v38, 0
M v[88:91],a[124:127],a[28:31],v[88:91]
buffer_store_dwordx4 v[240:243], v7, s[8:11], s3 offen offset:2048 sc1
M v[88:91],a[120:123],a[24:27],v[88:91]
R a[88:91],v2,6144
R a[92:95],v2,7168
M v[88:91],a[116:119],a[20:23],v[88:91]
v_mov_b32 v39, 0
AF v27,v18,v19
M v[88:91],a[112:115],a[16:19],v[88:91]
buffer_store_dwordx4 v[248:251], v7, s[8:11], s3 offen offset:3072 sc1
M v[88:91],a[108:111],a[12:15],v[88:91]
E v22,v64
M v[88:91],a[104:107],a[8:11],v[88:91]
E v23,v65
M v[88:91],a[100:103],a[4:7],v[88:91]
s_waitcnt lgkmcnt(0)
E v24,v66
M v[88:91],a[96:99],a[0:3],v[88:91]
E v25,v67
C v44,v18,v19
AF v27,v20,v27
C v45,v20,v21
AF v27,v21,v27
AF v26,v22,v23
C v40,v22,v23
E v18,v76
E v19,v77
AF v26,v24,v26
C v41,v24,v25
AF v26,v25,v26
E v20,v78
E v21,v79
AF v27,v18,v27
C v46,v18,v19
AF v27,v19,v27
E v22,v72
E v23,v73
AF v27,v20,v27
C v47,v20,v21
AF v27,v21,v27
E v24,v74
E v25,v75
AF v26,v22,v26
C v42,v22,v23
AF v26,v23,v26
AF v26,v24,v26
C v43,v24,v25
AF v26,v25,v26
v_mov_b32 v56, 0
v_mov_b32 v57, 0
v_mov_b32 v58, 0
v_mov_b32 v59, 0
s_mul_i32 s21, s41, 1048576
SA s21,s21,589824
s_lshl_b32 s84, s42, 1
s_sub_u32 s22, 11, s84
s_mov_b32 s23, 536870912
s_lshl_b32 s86, s20, 14
SA s86,s86,s34
SA s87,s86,4096
SA s88,s86,8192
SA s89,s86,12288
s_lshl_b32 s90, s20, 10
SA s90,s90,s34
SA s90,s90,65536
s_waitcnt vmcnt(3)
v_cmp_gt_u32 vcc, 2, v5
s_nop 0
s_cbranch_vccnz L_lsj0
L_lrj0:
SA m0,s28,98304
v_mov_b32 v10, v26
buffer_load_dwordx4 v3, s[8:11], s21 offen offset:0 sc1 lds
v_mov_b32 v11, v27
buffer_load_dwordx4 v3, s[8:11], s21 offen offset:1024 sc1 lds
v_mov_b32 v12, v10
v_mov_b32 v13, v11
buffer_load_dwordx4 v3, s[8:11], s21 offen offset:2048 sc1 lds
v_permlane16_swap_b32 v12, v10
v_permlane16_swap_b32 v13, v11
buffer_load_dwordx4 v3, s[8:11], s21 offen offset:3072 sc1 lds
v_max_f32 v10, v12, v10
SA m0,s28,102400
v_max_f32 v11, v13, v11
buffer_load_dwordx4 v4, s[8:11], s21 offen offset:0 sc1 lds
v_mov_b32 v12, v10
v_mov_b32 v13, v11
buffer_load_dwordx4 v4, s[8:11], s21 offen offset:1024 sc1 lds
v_permlane32_swap_b32 v12, v10
v_permlane32_swap_b32 v13, v11
buffer_load_dwordx4 v4, s[8:11], s21 offen offset:2048 sc1 lds
v_max_f32 v10, v12, v10
v_max_f32 v11, v13, v11
buffer_load_dwordx4 v4, s[8:11], s21 offen offset:3072 sc1 lds
SA s21,s21,32768
s_sub_u32 s22, s22, 1
s_cselect_b32 s21, s23, s21
v_min_f32 v10, v10, v11
v_cmp_gt_f32 vcc, s24, v10
s_nop 0
s_cbranch_vccnz L_stj0
L_rtj0:
s_cmp_gt_u32 s20, 3
s_cselect_b64 s[82:83], -1, 0
s_cmp_eq_u32 s20, 3
s_cselect_b64 s[66:67], s[16:17], s[82:83]
v_mfma_f32_32x32x16_bf16 v[128:143], v[56:59], v[56:59], 0
s_cselect_b64 s[68:69], s[18:19], s[82:83]
s_cselect_b64 s[70:71], s[48:49], s[82:83]
s_cselect_b64 s[72:73], s[50:51], s[82:83]
v_cndmask_b32 v100, v36, v8, s[66:67]
v_mfma_f32_32x32x16_bf16 v[144:159], v[56:59], v[56:59], 0
v_cndmask_b32 v101, v36, v8, s[68:69]
v_cndmask_b32 v102, v36, v8, s[70:71]
v_cndmask_b32 v103, v36, v8, s[72:73]
s_cmp_gt_u32 s20, 2
v_mfma_f32_32x32x16_bf16 v[160:175], v[56:59], v[56:59], 0
s_cselect_b64 s[82:83], -1, 0
s_cmp_eq_u32 s20, 2
s_cselect_b64 s[74:75], s[16:17], s[82:83]
s_cselect_b64 s[76:77], s[18:19], s[82:83]
v_mfma_f32_32x32x16_bf16 v[176:191], v[56:59], v[56:59], 0
s_cselect_b64 s[78:79], s[48:49], s[82:83]
s_cselect_b64 s[80:81], s[50:51], s[82:83]
v_cndmask_b32 v108, v36, v8, s[74:75]
v_cndmask_b32 v109, v36, v8, s[76:77]
v_mfma_f32_32x32x16_bf16 v[192:207], v[56:59], v[56:59], 0
v_cndmask_b32 v110, v36, v8, s[78:79]
v_cndmask_b32 v111, v36, v8, s[80:81]
s_cmp_gt_u32 s20, 1
s_cselect_b64 s[82:83], -1, 0
v_mfma_f32_32x32x16_bf16 v[208:223], v[56:59], v[56:59], 0
s_cmp_eq_u32 s20, 1
s_cselect_b64 s[66:67], s[16:17], s[82:83]
s_cselect_b64 s[68:69], s[18:19], s[82:83]
s_cselect_b64 s[70:71], s[48:49], s[82:83]
v_mfma_f32_32x32x16_bf16 v[224:239], v[56:59], v[56:59], 0
s_cselect_b64 s[72:73], s[50:51], s[82:83]
v_cndmask_b32 v116, v36, v8, s[66:67]
v_cndmask_b32 v117, v36, v8, s[68:69]
v_cndmask_b32 v118, v36, v8, s[70:71]
v_mfma_f32_32x32x16_bf16 v[240:255], v[56:59], v[56:59], 0
v_cndmask_b32 v119, v36, v8, s[72:73]
s_cmp_gt_u32 s20, 0
s_cselect_b64 s[82:83], -1, 0
s_cmp_eq_u32 s20, 0
s_cselect_b64 s[74:75], s[16:17], s[82:83]
s_cselect_b64 s[76:77], s[18:19], s[82:83]
s_cselect_b64 s[78:79], s[48:49], s[82:83]
s_cselect_b64 s[80:81], s[50:51], s[82:83]
v_cndmask_b32 v124, v36, v8, s[74:75]
v_cndmask_b32 v125, v36, v8, s[76:77]
v_cndmask_b32 v126, v36, v8, s[78:79]
v_cndmask_b32 v127, v36, v8, s[80:81]
s_branch L_d3h
.p2align 12
L_kv1:
s_and_b32 s31, s42, 7
s_lshl_b32 s30, s41, 3
SA s30,s30,s31
s_lshl_b32 s64, s30, 2
SA s64,s64,s20
s_mul_i32 s72, s64, 3584
v_mov_b32 v32, 536870912
v_cmp_gt_u32 vcc, 56, v0
s_lshl_b32 s67, s64, 2
s_nop 0
v_cndmask_b32 v32, v32, v7, vcc
buffer_load_dwordx4 a[176:179], v32, s[56:59], s72 offen offset:0
buffer_load_dwordx4 a[180:183], v32, s[56:59], s72 offen offset:896
buffer_load_dwordx4 a[184:187], v32, s[56:59], s72 offen offset:1792
buffer_load_dwordx4 a[188:191], v32, s[56:59], s72 offen offset:2688
buffer_load_dwordx4 a[192:195], v32, s[60:63], 0 offen
buffer_load_dwordx4 a[196:199], v32, s[68:71], 0 offen
SA m0,s24,16384
s_nop 0
buffer_load_dwordx4 v12, s[48:51], s22 offen offset:0   lds
buffer_load_dwordx4 v13, s[48:51], s22 offen offset:1024   lds
buffer_load_dwordx4 v14, s[48:51], s22 offen offset:2048   lds
buffer_load_dwordx4 v15, s[48:51], s22 offen offset:3072   lds
s_sub_u32 s22, s22, 1048448
SA m0,s23,32768
s_nop 0
buffer_load_dwordx4 v8, s[16:19], s21 offen offset:0   lds
buffer_load_dwordx4 v9, s[16:19], s21 offen offset:1024   lds
buffer_load_dwordx4 v10, s[16:19], s21 offen offset:2048   lds
buffer_load_dwordx4 v11, s[16:19], s21 offen offset:3072   lds
SA s21,s21,128
s_mov_b64 exec, 0
s_cmp_eq_u32 s20, 0
s_cbranch_scc1 L_w_kv11
s_cmp_eq_u32 s20, 1
s_cbranch_scc1 L_w_kv12
s_cmp_eq_u32 s20, 2
s_cbranch_scc1 L_w_kv13
s_branch L_w_kv14
L_wd2:
s_mov_b64 exec, -1
s_waitcnt vmcnt(14) lgkmcnt(0)
s_barrier
R a[160:163],v5,0
R a[164:167],v6,0
T a[96:97],v1,0
T a[98:99],v1,1024
T a[100:101],v1,8192
T a[102:103],v1,9216
T a[104:105],v2,0
T a[106:107],v2,1024
T a[108:109],v2,8192
T a[110:111],v2,9216
T a[112:113],v3,0
T a[114:115],v3,1024
T a[116:117],v3,8192
T a[118:119],v3,9216
T a[120:121],v4,0
T a[122:123],v4,1024
T a[124:125],v4,8192
T a[126:127],v4,9216
T a[128:129],v1,16384
T a[130:131],v1,17408
T a[132:133],v1,24576
T a[134:135],v1,25600
T a[136:137],v2,16384
T a[138:139],v2,17408
T a[140:141],v2,24576
T a[142:143],v2,25600
T a[144:145],v3,16384
T a[146:147],v3,17408
T a[148:149],v3,24576
T a[150:151],v3,25600
T a[152:153],v4,16384
T a[154:155],v4,17408
T a[156:157],v4,24576
T a[158:159],v4,25600
s_waitcnt lgkmcnt(15)
M a[0:3],a[160:163],a[96:99],0
SA m0,s23,49152
R a[168:171],v5,2048
R a[172:175],v6,2048
M a[0:3],a[164:167],a[100:103],a[0:3]
buffer_load_dwordx4 v8, s[16:19], s21 offen offset:0   lds
M a[4:7],a[164:167],a[108:111],0
M a[4:7],a[160:163],a[104:107],a[4:7]
M a[8:11],a[160:163],a[112:115],0
buffer_load_dwordx4 v9, s[16:19], s21 offen offset:1024   lds
M a[8:11],a[164:167],a[116:119],a[8:11]
s_waitcnt lgkmcnt(14)
M a[12:15],a[164:167],a[124:127],0
M a[12:15],a[160:163],a[120:123],a[12:15]
M a[16:19],a[160:163],a[128:131],0
buffer_load_dwordx4 v10, s[16:19], s21 offen offset:2048   lds
M a[16:19],a[164:167],a[132:135],a[16:19]
s_waitcnt lgkmcnt(6)
M a[20:23],a[164:167],a[140:143],0
M a[20:23],a[160:163],a[136:139],a[20:23]
buffer_load_dwordx4 v11, s[16:19], s21 offen offset:3072   lds
M a[24:27],a[160:163],a[144:147],0
SA s21,s21,524160
M a[24:27],a[164:167],a[148:151],a[24:27]
s_waitcnt lgkmcnt(0)
M a[28:31],a[164:167],a[156:159],0
SA m0,s24,32768
M a[28:31],a[160:163],a[152:155],a[28:31]
buffer_load_dwordx4 v12, s[48:51], s22 offen offset:0   lds
M v[32:35],a[168:171],a[96:99],0
R a[160:163],v5,4096
R a[164:167],v6,4096
M v[32:35],a[172:175],a[100:103],v[32:35]
M v[36:39],a[172:175],a[108:111],0
M v[36:39],a[168:171],a[104:107],v[36:39]
buffer_load_dwordx4 v13, s[48:51], s22 offen offset:1024   lds
M v[40:43],a[168:171],a[112:115],0
M v[40:43],a[172:175],a[116:119],v[40:43]
M v[44:47],a[172:175],a[124:127],0
buffer_load_dwordx4 v14, s[48:51], s22 offen offset:2048   lds
M v[44:47],a[168:171],a[120:123],v[44:47]
M v[48:51],a[168:171],a[128:131],0
M v[48:51],a[172:175],a[132:135],v[48:51]
M v[52:55],a[172:175],a[140:143],0
buffer_load_dwordx4 v15, s[48:51], s22 offen offset:3072   lds
M v[52:55],a[168:171],a[136:139],v[52:55]
SA s22,s22,1048576
M v[56:59],a[168:171],a[144:147],0
M v[56:59],a[172:175],a[148:151],v[56:59]
s_waitcnt lgkmcnt(0)
M v[60:63],a[172:175],a[156:159],0
M v[60:63],a[168:171],a[152:155],v[60:63]
M v[64:67],a[160:163],a[96:99],0
R a[168:171],v5,6144
R a[172:175],v6,6144
M v[64:67],a[164:167],a[100:103],v[64:67]
M v[68:71],a[164:167],a[108:111],0
M v[68:71],a[160:163],a[104:107],v[68:71]
M v[72:75],a[160:163],a[112:115],0
M v[72:75],a[164:167],a[116:119],v[72:75]
M v[76:79],a[164:167],a[124:127],0
M v[76:79],a[160:163],a[120:123],v[76:79]
M v[80:83],a[160:163],a[128:131],0
M v[80:83],a[164:167],a[132:135],v[80:83]
M v[84:87],a[164:167],a[140:143],0
M v[84:87],a[160:163],a[136:139],v[84:87]
M v[88:91],a[160:163],a[144:147],0
M v[88:91],a[164:167],a[148:151],v[88:91]
s_waitcnt lgkmcnt(0)
M v[92:95],a[164:167],a[156:159],0
s_waitcnt vmcnt(12)
M v[92:95],a[160:163],a[152:155],v[92:95]
s_barrier
M v[96:99],a[168:171],a[96:99],0
SA m0,s23,0
R a[160:163],v5,16384
R a[164:167],v6,16384
M v[96:99],a[172:175],a[100:103],v[96:99]
buffer_load_dwordx4 v8, s[16:19], s21 offen offset:0   lds
M v[100:103],a[172:175],a[108:111],0
v_lshlrev_b32 v26, 7, v0
v_and_b32 v27, 48, v0
M v[100:103],a[168:171],a[104:107],v[100:103]
v_lshl_add_u32 v26, v27, 24, v26
M v[104:107],a[168:171],a[112:115],0
buffer_load_dwordx4 v9, s[16:19], s21 offen offset:1024   lds
M v[104:107],a[172:175],a[116:119],v[104:107]
M v[108:111],a[172:175],a[124:127],0
M v[108:111],a[168:171],a[120:123],v[108:111]
buffer_load_dwordx4 v10, s[16:19], s21 offen offset:2048   lds
M v[112:115],a[168:171],a[128:131],0
M v[112:115],a[172:175],a[132:135],v[112:115]
M v[116:119],a[172:175],a[140:143],0
M v[116:119],a[168:171],a[136:139],v[116:119]
buffer_load_dwordx4 v11, s[16:19], s21 offen offset:3072   lds
M v[120:123],a[168:171],a[144:147],0
SA s21,s21,128
M v[120:123],a[172:175],a[148:151],v[120:123]
s_waitcnt lgkmcnt(0)
M v[124:127],a[172:175],a[156:159],0
SA m0,s24,49152
M v[124:127],a[168:171],a[152:155],v[124:127]
buffer_load_dwordx4 v12, s[48:51], s22 offen offset:0   lds
M v[128:131],a[160:163],a[96:99],0
R a[168:171],v5,18432
R a[172:175],v6,18432
M v[128:131],a[164:167],a[100:103],v[128:131]
buffer_load_dwordx4 v13, s[48:51], s22 offen offset:1024   lds
M v[132:135],a[164:167],a[108:111],0
M v[132:135],a[160:163],a[104:107],v[132:135]
M v[136:139],a[160:163],a[112:115],0
M v[136:139],a[164:167],a[116:119],v[136:139]
buffer_load_dwordx4 v14, s[48:51], s22 offen offset:2048   lds
M v[140:143],a[164:167],a[124:127],0
M v[140:143],a[160:163],a[120:123],v[140:143]
M v[144:147],a[160:163],a[128:131],0
buffer_load_dwordx4 v15, s[48:51], s22 offen offset:3072   lds
M v[144:147],a[164:167],a[132:135],v[144:147]
s_sub_u32 s22, s22, 1048448
M v[148:151],a[164:167],a[140:143],0
M v[148:151],a[160:163],a[136:139],v[148:151]
M v[152:155],a[160:163],a[144:147],0
M v[152:155],a[164:167],a[148:151],v[152:155]
s_waitcnt lgkmcnt(0)
M v[156:159],a[164:167],a[156:159],0
s_waitcnt vmcnt(12)
M v[156:159],a[160:163],a[152:155],v[156:159]
s_barrier
M v[160:163],a[168:171],a[96:99],0
SA m0,s23,16384
R a[160:163],v5,20480
R a[164:167],v6,20480
M v[160:163],a[172:175],a[100:103],v[160:163]
T a[32:33],v1,32768
T a[34:35],v1,33792
M v[164:167],a[172:175],a[108:111],0
T a[36:37],v1,40960
T a[38:39],v1,41984
M v[164:167],a[168:171],a[104:107],v[164:167]
T a[40:41],v2,32768
T a[42:43],v2,33792
M v[168:171],a[168:171],a[112:115],0
T a[44:45],v2,40960
T a[46:47],v2,41984
M v[168:171],a[172:175],a[116:119],v[168:171]
buffer_load_dwordx4 v8, s[16:19], s21 offen offset:0   lds
M v[172:175],a[172:175],a[124:127],0
s_nop 0
T a[48:49],v3,32768
T a[50:51],v3,33792
M v[172:175],a[168:171],a[120:123],v[172:175]
buffer_load_dwordx4 v9, s[16:19], s21 offen offset:1024   lds
M v[176:179],a[168:171],a[128:131],0
s_nop 0
T a[52:53],v3,40960
T a[54:55],v3,41984
M v[176:179],a[172:175],a[132:135],v[176:179]
T a[56:57],v4,32768
T a[58:59],v4,33792
M v[180:183],a[172:175],a[140:143],0
buffer_load_dwordx4 v10, s[16:19], s21 offen offset:2048   lds
M v[180:183],a[168:171],a[136:139],v[180:183]
s_nop 0
T a[60:61],v4,40960
T a[62:63],v4,41984
M v[184:187],a[168:171],a[144:147],0
buffer_load_dwordx4 v11, s[16:19], s21 offen offset:3072   lds
M v[184:187],a[172:175],a[148:151],v[184:187]
s_waitcnt lgkmcnt(15)
s_nop 0
T a[64:65],v1,49152
T a[66:67],v1,50176
M v[188:191],a[172:175],a[156:159],0
SA s21,s21,524160
T a[68:69],v1,57344
T a[70:71],v1,58368
M v[188:191],a[168:171],a[152:155],v[188:191]
SA m0,s24,0
M v[192:195],a[160:163],a[96:99],0
R a[168:171],v5,22528
R a[172:175],v6,22528
M v[192:195],a[164:167],a[100:103],v[192:195]
T a[72:73],v2,49152
T a[74:75],v2,50176
M v[196:199],a[164:167],a[108:111],0
T a[76:77],v2,57344
T a[78:79],v2,58368
M v[196:199],a[160:163],a[104:107],v[196:199]
T a[80:81],v3,49152
T a[82:83],v3,50176
M v[200:203],a[160:163],a[112:115],0
buffer_load_dwordx4 v12, s[48:51], s22 offen offset:0   lds
M v[200:203],a[164:167],a[116:119],v[200:203]
s_nop 0
T a[84:85],v3,57344
T a[86:87],v3,58368
M v[204:207],a[164:167],a[124:127],0
T a[88:89],v4,49152
T a[90:91],v4,50176
M v[204:207],a[160:163],a[120:123],v[204:207]
buffer_load_dwordx4 v13, s[48:51], s22 offen offset:1024   lds
M v[208:211],a[160:163],a[128:131],0
s_nop 0
T a[92:93],v4,57344
T a[94:95],v4,58368
M v[208:211],a[164:167],a[132:135],v[208:211]
buffer_load_dwordx4 v14, s[48:51], s22 offen offset:2048   lds
M v[212:215],a[164:167],a[140:143],0
buffer_load_dwordx4 v15, s[48:51], s22 offen offset:3072   lds
M v[212:215],a[160:163],a[136:139],v[212:215]
SA s22,s22,1048576
M v[216:219],a[160:163],a[144:147],0
M v[216:219],a[164:167],a[148:151],v[216:219]
s_waitcnt lgkmcnt(12)
M v[220:223],a[164:167],a[156:159],0
s_waitcnt vmcnt(12) lgkmcnt(0)
M v[220:223],a[160:163],a[152:155],v[220:223]
s_barrier
M v[224:227],a[168:171],a[96:99],0
SA m0,s23,32768
R a[160:163],v5,32768
R a[164:167],v6,32768
M v[224:227],a[172:175],a[100:103],v[224:227]
buffer_load_dwordx4 v8, s[16:19], s21 offen offset:0   lds
M v[228:231],a[172:175],a[108:111],0
M v[228:231],a[168:171],a[104:107],v[228:231]
M v[232:235],a[168:171],a[112:115],0
buffer_load_dwordx4 v9, s[16:19], s21 offen offset:1024   lds
M v[232:235],a[172:175],a[116:119],v[232:235]
M v[236:239],a[172:175],a[124:127],0
M v[236:239],a[168:171],a[120:123],v[236:239]
buffer_load_dwordx4 v10, s[16:19], s21 offen offset:2048   lds
M v[240:243],a[168:171],a[128:131],0
M v[240:243],a[172:175],a[132:135],v[240:243]
M v[244:247],a[172:175],a[140:143],0
buffer_load_dwordx4 v11, s[16:19], s21 offen offset:3072   lds
M v[244:247],a[168:171],a[136:139],v[244:247]
SA s21,s21,128
M v[248:251],a[168:171],a[144:147],0
M v[248:251],a[172:175],a[148:151],v[248:251]
s_waitcnt lgkmcnt(0)
M v[252:255],a[172:175],a[156:159],0
M v[252:255],a[168:171],a[152:155],v[252:255]
M a[0:3],a[160:163],a[32:35],a[0:3]
R a[168:171],v5,34816
R a[172:175],v6,34816
M a[0:3],a[164:167],a[36:39],a[0:3]
T a[96:97],v1,0
T a[98:99],v1,1024
M a[4:7],a[164:167],a[44:47],a[4:7]
SA m0,s24,16384
v_mov_b32 v16, 0
v_mov_b32 v17, 0
M a[4:7],a[160:163],a[40:43],a[4:7]
buffer_load_dwordx4 v12, s[48:51], s22 offen offset:0   lds
M a[8:11],a[160:163],a[48:51],a[8:11]
v_mov_b32 v18, 0
v_mov_b32 v19, 0
M a[8:11],a[164:167],a[52:55],a[8:11]
v_mov_b32 v20, 0
v_mov_b32 v21, 0
M a[12:15],a[164:167],a[60:63],a[12:15]
T a[100:101],v1,8192
T a[102:103],v1,9216
M a[12:15],a[160:163],a[56:59],a[12:15]
v_mov_b32 v22, 0
v_mov_b32 v23, 0
M a[16:19],a[160:163],a[64:67],a[16:19]
buffer_load_dwordx4 v13, s[48:51], s22 offen offset:1024   lds
M a[16:19],a[164:167],a[68:71],a[16:19]
G v28,a192
G v29,a196
M a[20:23],a[164:167],a[76:79],a[20:23]
v_lshlrev_b32 v27, 16, v28
v_lshlrev_b32 v25, 16, v29
M a[20:23],a[160:163],a[72:75],a[20:23]
T a[104:105],v2,0
T a[106:107],v2,1024
M a[24:27],a[160:163],a[80:83],a[24:27]
v_and_b32 v28, 0xffff0000, v28
v_and_b32 v29, 0xffff0000, v29
M a[24:27],a[164:167],a[84:87],a[24:27]
s_waitcnt lgkmcnt(6)
buffer_load_dwordx4 v14, s[48:51], s22 offen offset:2048   lds
M a[28:31],a[164:167],a[92:95],a[28:31]
G v30,a176
v_lshlrev_b32 v31, 16, v30
M a[28:31],a[160:163],a[88:91],a[28:31]
v_and_b32 v30, 0xffff0000, v30
v_fmac_f32 v16, v31, v27
M v[60:63],a[168:171],a[88:91],v[60:63]
R a[160:163],v5,36864
R a[164:167],v6,36864
M v[60:63],a[172:175],a[92:95],v[60:63]
T a[108:109],v2,8192
T a[110:111],v2,9216
M v[56:59],a[172:175],a[84:87],v[56:59]
buffer_load_dwordx4 v15, s[48:51], s22 offen offset:3072   lds
M v[56:59],a[168:171],a[80:83],v[56:59]
s_sub_u32 s22, s22, 1048448
v_fmac_f32 v20, v31, v25
v_fmac_f32 v16, v30, v28
M v[52:55],a[168:171],a[72:75],v[52:55]
v_fmac_f32 v20, v30, v29
G v30,a180
M v[52:55],a[172:175],a[76:79],v[52:55]
T a[112:113],v3,0
T a[114:115],v3,1024
M v[48:51],a[172:175],a[68:71],v[48:51]
SA m0,s23,49152
v_lshlrev_b32 v31, 16, v30
v_and_b32 v30, 0xffff0000, v30
M v[48:51],a[168:171],a[64:67],v[48:51]
buffer_load_dwordx4 v8, s[16:19], s21 offen offset:0   lds
M v[44:47],a[168:171],a[56:59],v[44:47]
v_fmac_f32 v17, v31, v27
v_fmac_f32 v21, v31, v25
M v[44:47],a[172:175],a[60:63],v[44:47]
v_fmac_f32 v17, v30, v28
v_fmac_f32 v21, v30, v29
M v[40:43],a[172:175],a[52:55],v[40:43]
T a[116:117],v3,8192
T a[118:119],v3,9216
M v[40:43],a[168:171],a[48:51],v[40:43]
G v30,a184
v_lshlrev_b32 v31, 16, v30
M v[36:39],a[168:171],a[40:43],v[36:39]
buffer_load_dwordx4 v9, s[16:19], s21 offen offset:1024   lds
M v[36:39],a[172:175],a[44:47],v[36:39]
s_waitcnt lgkmcnt(6)
v_and_b32 v30, 0xffff0000, v30
v_fmac_f32 v18, v31, v27
M v[32:35],a[172:175],a[36:39],v[32:35]
v_fmac_f32 v22, v31, v25
v_fmac_f32 v18, v30, v28
M v[32:35],a[168:171],a[32:35],v[32:35]
T a[120:121],v4,0
T a[122:123],v4,1024
M v[64:67],a[160:163],a[32:35],v[64:67]
R a[168:171],v5,38912
R a[172:175],v6,38912
M v[64:67],a[164:167],a[36:39],v[64:67]
buffer_load_dwordx4 v10, s[16:19], s21 offen offset:2048   lds
M v[68:71],a[164:167],a[44:47],v[68:71]
v_fmac_f32 v22, v30, v29
G v30,a188
M v[68:71],a[160:163],a[40:43],v[68:71]
v_lshlrev_b32 v31, 16, v30
v_and_b32 v30, 0xffff0000, v30
M v[72:75],a[160:163],a[48:51],v[72:75]
T a[124:125],v4,8192
T a[126:127],v4,9216
M v[72:75],a[164:167],a[52:55],v[72:75]
v_fmac_f32 v19, v31, v27
v_fmac_f32 v23, v31, v25
M v[76:79],a[164:167],a[60:63],v[76:79]
buffer_load_dwordx4 v11, s[16:19], s21 offen offset:3072   lds
M v[76:79],a[160:163],a[56:59],v[76:79]
SA s21,s21,524160
v_fmac_f32 v19, v30, v28
v_fmac_f32 v23, v30, v29
M v[80:83],a[160:163],a[64:67],v[80:83]
G v28,a193
G v29,a197
M v[80:83],a[164:167],a[68:71],v[80:83]
v_lshlrev_b32 v27, 16, v28
v_lshlrev_b32 v25, 16, v29
M v[84:87],a[164:167],a[76:79],v[84:87]
v_and_b32 v28, 0xffff0000, v28
v_and_b32 v29, 0xffff0000, v29
M v[84:87],a[160:163],a[72:75],v[84:87]
G v30,a177
v_lshlrev_b32 v31, 16, v30
M v[88:91],a[160:163],a[80:83],v[88:91]
v_and_b32 v30, 0xffff0000, v30
v_fmac_f32 v16, v31, v27
M v[88:91],a[164:167],a[84:87],v[88:91]
s_waitcnt lgkmcnt(2)
v_fmac_f32 v20, v31, v25
v_fmac_f32 v16, v30, v28
M v[92:95],a[164:167],a[92:95],v[92:95]
s_waitcnt vmcnt(16) lgkmcnt(0)
v_fmac_f32 v20, v30, v29
G v30,a181
M v[92:95],a[160:163],a[88:91],v[92:95]
s_barrier
M v[124:127],a[168:171],a[88:91],v[124:127]
R a[160:163],v5,49152
R a[164:167],v6,49152
M v[124:127],a[172:175],a[92:95],v[124:127]
v_lshlrev_b32 v31, 16, v30
v_and_b32 v30, 0xffff0000, v30
M v[120:123],a[172:175],a[84:87],v[120:123]
SA m0,s24,32768
T a[128:129],v1,16384
T a[130:131],v1,17408
M v[120:123],a[168:171],a[80:83],v[120:123]
buffer_load_dwordx4 v12, s[48:51], s22 offen offset:0   lds
M v[116:119],a[168:171],a[72:75],v[116:119]
v_fmac_f32 v17, v31, v27
v_fmac_f32 v21, v31, v25
M v[116:119],a[172:175],a[76:79],v[116:119]
v_fmac_f32 v17, v30, v28
v_fmac_f32 v21, v30, v29
M v[112:115],a[172:175],a[68:71],v[112:115]
G v30,a185
v_lshlrev_b32 v31, 16, v30
M v[112:115],a[168:171],a[64:67],v[112:115]
v_and_b32 v30, 0xffff0000, v30
v_fmac_f32 v18, v31, v27
M v[108:111],a[168:171],a[56:59],v[108:111]
v_fmac_f32 v22, v31, v25
v_fmac_f32 v18, v30, v28
M v[108:111],a[172:175],a[60:63],v[108:111]
T a[132:133],v1,24576
T a[134:135],v1,25600
M v[104:107],a[172:175],a[52:55],v[104:107]
buffer_load_dwordx4 v13, s[48:51], s22 offen offset:1024   lds
M v[104:107],a[168:171],a[48:51],v[104:107]
v_fmac_f32 v22, v30, v29
G v30,a189
M v[100:103],a[168:171],a[40:43],v[100:103]
v_lshlrev_b32 v31, 16, v30
v_and_b32 v30, 0xffff0000, v30
M v[100:103],a[172:175],a[44:47],v[100:103]
s_waitcnt lgkmcnt(4)
v_fmac_f32 v19, v31, v27
v_fmac_f32 v23, v31, v25
M v[96:99],a[172:175],a[36:39],v[96:99]
v_fmac_f32 v19, v30, v28
v_fmac_f32 v23, v30, v29
M v[96:99],a[168:171],a[32:35],v[96:99]
G v28,a194
G v29,a198
M v[128:131],a[160:163],a[32:35],v[128:131]
R a[168:171],v5,51200
R a[172:175],v6,51200
M v[128:131],a[164:167],a[36:39],v[128:131]
T a[136:137],v2,16384
T a[138:139],v2,17408
M v[132:135],a[164:167],a[44:47],v[132:135]
buffer_load_dwordx4 v14, s[48:51], s22 offen offset:2048   lds
M v[132:135],a[160:163],a[40:43],v[132:135]
v_lshlrev_b32 v27, 16, v28
v_lshlrev_b32 v25, 16, v29
M v[136:139],a[160:163],a[48:51],v[136:139]
v_and_b32 v28, 0xffff0000, v28
v_and_b32 v29, 0xffff0000, v29
M v[136:139],a[164:167],a[52:55],v[136:139]
G v30,a178
v_lshlrev_b32 v31, 16, v30
M v[140:143],a[164:167],a[60:63],v[140:143]
v_and_b32 v30, 0xffff0000, v30
v_fmac_f32 v16, v31, v27
M v[140:143],a[160:163],a[56:59],v[140:143]
T a[140:141],v2,24576
T a[142:143],v2,25600
M v[144:147],a[160:163],a[64:67],v[144:147]
buffer_load_dwordx4 v15, s[48:51], s22 offen offset:3072   lds
M v[144:147],a[164:167],a[68:71],v[144:147]
SA s22,s22,1048576
v_fmac_f32 v20, v31, v25
v_fmac_f32 v16, v30, v28
M v[148:151],a[164:167],a[76:79],v[148:151]
v_fmac_f32 v20, v30, v29
G v30,a182
M v[148:151],a[160:163],a[72:75],v[148:151]
v_lshlrev_b32 v31, 16, v30
v_and_b32 v30, 0xffff0000, v30
M v[152:155],a[160:163],a[80:83],v[152:155]
v_fmac_f32 v17, v31, v27
v_fmac_f32 v21, v31, v25
M v[152:155],a[164:167],a[84:87],v[152:155]
s_waitcnt lgkmcnt(4)
v_fmac_f32 v17, v30, v28
v_fmac_f32 v21, v30, v29
M v[156:159],a[164:167],a[92:95],v[156:159]
SA m0,s23,0
T a[144:145],v3,16384
T a[146:147],v3,17408
M v[156:159],a[160:163],a[88:91],v[156:159]
buffer_load_dwordx4 v8, s[16:19], s21 offen offset:0   lds
M v[188:191],a[168:171],a[88:91],v[188:191]
R a[160:163],v5,53248
R a[164:167],v6,53248
M v[188:191],a[172:175],a[92:95],v[188:191]
G v30,a186
v_lshlrev_b32 v31, 16, v30
M v[184:187],a[172:175],a[84:87],v[184:187]
v_and_b32 v30, 0xffff0000, v30
v_fmac_f32 v18, v31, v27
M v[184:187],a[168:171],a[80:83],v[184:187]
v_fmac_f32 v22, v31, v25
v_fmac_f32 v18, v30, v28
M v[180:183],a[168:171],a[72:75],v[180:183]
v_fmac_f32 v22, v30, v29
G v30,a190
M v[180:183],a[172:175],a[76:79],v[180:183]
L_w_kv11:
s_cbranch_execz L_w_kv15
T a[148:149],v3,24576
T a[150:151],v3,25600
M v[176:179],a[172:175],a[68:71],v[176:179]
buffer_load_dwordx4 v9, s[16:19], s21 offen offset:1024   lds
M v[176:179],a[168:171],a[64:67],v[176:179]
v_lshlrev_b32 v31, 16, v30
v_and_b32 v30, 0xffff0000, v30
M v[172:175],a[168:171],a[56:59],v[172:175]
v_fmac_f32 v19, v31, v27
v_fmac_f32 v23, v31, v25
M v[172:175],a[172:175],a[60:63],v[172:175]
v_fmac_f32 v19, v30, v28
v_fmac_f32 v23, v30, v29
M v[168:171],a[172:175],a[52:55],v[168:171]
M v[168:171],a[168:171],a[48:51],v[168:171]
M v[164:167],a[168:171],a[40:43],v[164:167]
s_nop 0
T a[152:153],v4,16384
T a[154:155],v4,17408
M v[164:167],a[172:175],a[44:47],v[164:167]
s_waitcnt lgkmcnt(4)
buffer_load_dwordx4 v10, s[16:19], s21 offen offset:2048   lds
M v[160:163],a[172:175],a[36:39],v[160:163]
M v[160:163],a[168:171],a[32:35],v[160:163]
M v[192:195],a[160:163],a[32:35],v[192:195]
R a[168:171],v5,55296
R a[172:175],v6,55296
M v[192:195],a[164:167],a[36:39],v[192:195]
M v[196:199],a[164:167],a[44:47],v[196:199]
M v[196:199],a[160:163],a[40:43],v[196:199]
s_nop 0
T a[156:157],v4,24576
T a[158:159],v4,25600
M v[200:203],a[160:163],a[48:51],v[200:203]
buffer_load_dwordx4 v11, s[16:19], s21 offen offset:3072   lds
M v[200:203],a[164:167],a[52:55],v[200:203]
SA s21,s21,128
M v[204:207],a[164:167],a[60:63],v[204:207]
M v[204:207],a[160:163],a[56:59],v[204:207]
M v[208:211],a[160:163],a[64:67],v[208:211]
M v[208:211],a[164:167],a[68:71],v[208:211]
M v[212:215],a[164:167],a[76:79],v[212:215]
M v[212:215],a[160:163],a[72:75],v[212:215]
M v[216:219],a[160:163],a[80:83],v[216:219]
M v[216:219],a[164:167],a[84:87],v[216:219]
s_waitcnt lgkmcnt(2)
M v[220:223],a[164:167],a[92:95],v[220:223]
s_waitcnt vmcnt(16) lgkmcnt(0)
M v[220:223],a[160:163],a[88:91],v[220:223]
s_barrier
M v[252:255],a[168:171],a[88:91],v[252:255]
R a[160:163],v5,0
R a[164:167],v6,0
M v[252:255],a[172:175],a[92:95],v[252:255]
M v[248:251],a[172:175],a[84:87],v[248:251]
M v[248:251],a[168:171],a[80:83],v[248:251]
M v[244:247],a[168:171],a[72:75],v[244:247]
M v[244:247],a[172:175],a[76:79],v[244:247]
M v[240:243],a[172:175],a[68:71],v[240:243]
M v[240:243],a[168:171],a[64:67],v[240:243]
M v[236:239],a[168:171],a[56:59],v[236:239]
M v[236:239],a[172:175],a[60:63],v[236:239]
M v[232:235],a[172:175],a[52:55],v[232:235]
M v[232:235],a[168:171],a[48:51],v[232:235]
M v[228:231],a[168:171],a[40:43],v[228:231]
M v[228:231],a[172:175],a[44:47],v[228:231]
s_waitcnt lgkmcnt(0)
M v[224:227],a[172:175],a[36:39],v[224:227]
M v[224:227],a[168:171],a[32:35],v[224:227]
M a[0:3],a[160:163],a[96:99],a[0:3]
R a[168:171],v5,2048
R a[172:175],v6,2048
M a[0:3],a[164:167],a[100:103],a[0:3]
T a[32:33],v1,32768
T a[34:35],v1,33792
M a[4:7],a[164:167],a[108:111],a[4:7]
SA m0,s24,49152
G v28,a195
G v29,a199
M a[4:7],a[160:163],a[104:107],a[4:7]
buffer_load_dwordx4 v12, s[48:51], s22 offen offset:0   lds
M a[8:11],a[160:163],a[112:115],a[8:11]
v_lshlrev_b32 v27, 16, v28
v_lshlrev_b32 v25, 16, v29
M a[8:11],a[164:167],a[116:119],a[8:11]
v_and_b32 v28, 0xffff0000, v28
v_and_b32 v29, 0xffff0000, v29
M a[12:15],a[164:167],a[124:127],a[12:15]
T a[36:37],v1,40960
T a[38:39],v1,41984
M a[12:15],a[160:163],a[120:123],a[12:15]
G v30,a179
v_lshlrev_b32 v31, 16, v30
M a[16:19],a[160:163],a[128:131],a[16:19]
buffer_load_dwordx4 v13, s[48:51], s22 offen offset:1024   lds
M a[16:19],a[164:167],a[132:135],a[16:19]
v_and_b32 v30, 0xffff0000, v30
v_fmac_f32 v16, v31, v27
M a[20:23],a[164:167],a[140:143],a[20:23]
v_fmac_f32 v20, v31, v25
v_fmac_f32 v16, v30, v28
M a[20:23],a[160:163],a[136:139],a[20:23]
T a[40:41],v2,32768
T a[42:43],v2,33792
M a[24:27],a[160:163],a[144:147],a[24:27]
v_fmac_f32 v20, v30, v29
G v30,a183
M a[24:27],a[164:167],a[148:151],a[24:27]
s_waitcnt lgkmcnt(6)
buffer_load_dwordx4 v14, s[48:51], s22 offen offset:2048   lds
M a[28:31],a[164:167],a[156:159],a[28:31]
v_lshlrev_b32 v31, 16, v30
v_and_b32 v30, 0xffff0000, v30
M a[28:31],a[160:163],a[152:155],a[28:31]
v_fmac_f32 v17, v31, v27
v_fmac_f32 v21, v31, v25
M v[60:63],a[168:171],a[152:155],v[60:63]
R a[160:163],v5,4096
R a[164:167],v6,4096
M v[60:63],a[172:175],a[156:159],v[60:63]
T a[44:45],v2,40960
T a[46:47],v2,41984
M v[56:59],a[172:175],a[148:151],v[56:59]
buffer_load_dwordx4 v15, s[48:51], s22 offen offset:3072   lds
M v[56:59],a[168:171],a[144:147],v[56:59]
s_sub_u32 s22, s22, 1048448
v_fmac_f32 v17, v30, v28
v_fmac_f32 v21, v30, v29
M v[52:55],a[168:171],a[136:139],v[52:55]
G v30,a187
v_lshlrev_b32 v31, 16, v30
M v[52:55],a[172:175],a[140:143],v[52:55]
T a[48:49],v3,32768
T a[50:51],v3,33792
M v[48:51],a[172:175],a[132:135],v[48:51]
SA m0,s23,16384
v_and_b32 v30, 0xffff0000, v30
v_fmac_f32 v18, v31, v27
M v[48:51],a[168:171],a[128:131],v[48:51]
buffer_load_dwordx4 v8, s[16:19], s21 offen offset:0   lds
M v[44:47],a[168:171],a[120:123],v[44:47]
v_fmac_f32 v22, v31, v25
v_fmac_f32 v18, v30, v28
M v[44:47],a[172:175],a[124:127],v[44:47]
v_fmac_f32 v22, v30, v29
G v30,a191
M v[40:43],a[172:175],a[116:119],v[40:43]
T a[52:53],v3,40960
T a[54:55],v3,41984
M v[40:43],a[168:171],a[112:115],v[40:43]
v_lshlrev_b32 v31, 16, v30
v_and_b32 v30, 0xffff0000, v30
M v[36:39],a[168:171],a[104:107],v[36:39]
buffer_load_dwordx4 v9, s[16:19], s21 offen offset:1024   lds
M v[36:39],a[172:175],a[108:111],v[36:39]
s_waitcnt lgkmcnt(6)
v_fmac_f32 v19, v31, v27
v_fmac_f32 v23, v31, v25
M v[32:35],a[172:175],a[100:103],v[32:35]
v_fmac_f32 v19, v30, v28
v_fmac_f32 v23, v30, v29
M v[32:35],a[168:171],a[96:99],v[32:35]
T a[56:57],v4,32768
T a[58:59],v4,33792
M v[64:67],a[160:163],a[96:99],v[64:67]
R a[168:171],v5,6144
R a[172:175],v6,6144
M v[64:67],a[164:167],a[100:103],v[64:67]
buffer_load_dwordx4 v10, s[16:19], s21 offen offset:2048   lds
M v[68:71],a[164:167],a[108:111],v[68:71]
v_permlane32_swap_b32 v16, v18
M v[68:71],a[160:163],a[104:107],v[68:71]
v_permlane32_swap_b32 v17, v19
M v[72:75],a[160:163],a[112:115],v[72:75]
s_nop 0
T a[60:61],v4,40960
T a[62:63],v4,41984
M v[72:75],a[164:167],a[116:119],v[72:75]
v_permlane32_swap_b32 v20, v22
M v[76:79],a[164:167],a[124:127],v[76:79]
buffer_load_dwordx4 v11, s[16:19], s21 offen offset:3072   lds
M v[76:79],a[160:163],a[120:123],v[76:79]
SA s21,s21,524160
v_permlane32_swap_b32 v21, v23
M v[80:83],a[160:163],a[128:131],v[80:83]
AF v16,v16,v18
AF v17,v17,v19
M v[80:83],a[164:167],a[132:135],v[80:83]
AF v20,v20,v22
AF v21,v21,v23
M v[84:87],a[164:167],a[140:143],v[84:87]
v_lshrrev_b32 v28, 4, v0
M v[84:87],a[160:163],a[136:139],v[84:87]
v_permlane16_swap_b32 v16, v17
M v[88:91],a[160:163],a[144:147],v[88:91]
v_permlane16_swap_b32 v20, v21
M v[88:91],a[164:167],a[148:151],v[88:91]
s_waitcnt lgkmcnt(2)
AF v16,v16,v17
AF v20,v20,v21
M v[92:95],a[164:167],a[156:159],v[92:95]
s_waitcnt vmcnt(16) lgkmcnt(0)
v_add_u32 v29, s67, v28
v_add_f32 v16, v16, v16 row_ror:8 row_mask:0xf bank_mask:0xf
M v[92:95],a[160:163],a[152:155],v[92:95]
s_barrier
M v[124:127],a[168:171],a[152:155],v[124:127]
R a[160:163],v5,16384
R a[164:167],v6,16384
M v[124:127],a[172:175],a[156:159],v[124:127]
v_add_f32 v20, v20, v20 row_ror:8 row_mask:0xf bank_mask:0xf
v_add_f32 v16, v16, v16 row_ror:4 row_mask:0xf bank_mask:0xf
M v[120:123],a[172:175],a[148:151],v[120:123]
SA m0,s24,0
T a[64:65],v1,49152
T a[66:67],v1,50176
M v[120:123],a[168:171],a[144:147],v[120:123]
buffer_load_dwordx4 v12, s[48:51], s22 offen offset:0   lds
M v[116:119],a[168:171],a[136:139],v[116:119]
v_add_f32 v20, v20, v20 row_ror:4 row_mask:0xf bank_mask:0xf
v_add_f32 v16, v16, v16 row_ror:2 row_mask:0xf bank_mask:0xf
M v[116:119],a[172:175],a[140:143],v[116:119]
v_add_f32 v20, v20, v20 row_ror:2 row_mask:0xf bank_mask:0xf
v_add_f32 v16, v16, v16 row_ror:1 row_mask:0xf bank_mask:0xf
M v[112:115],a[172:175],a[132:135],v[112:115]
v_add_f32 v20, v20, v20 row_ror:1 row_mask:0xf bank_mask:0xf
v_ashrrev_i32 v30, 31, v16
M v[112:115],a[168:171],a[128:131],v[112:115]
v_or_b32 v30, 0x80000000, v30
v_xor_b32 v30, v30, v16
M v[108:111],a[168:171],a[120:123],v[108:111]
v_and_b32 v30, 0xfffff800, v30
v_sub_u32 v29, 2047, v29
M v[108:111],a[172:175],a[124:127],v[108:111]
T a[68:69],v1,57344
T a[70:71],v1,58368
M v[104:107],a[172:175],a[116:119],v[104:107]
buffer_load_dwordx4 v13, s[48:51], s22 offen offset:1024   lds
M v[104:107],a[168:171],a[112:115],v[104:107]
v_or_b32 v30, v30, v29
v_max_u32 v30, 1, v30
M v[100:103],a[168:171],a[104:107],v[100:103]
MF v21,0xbfb8aa3b,v20
M v[100:103],a[172:175],a[108:111],v[100:103]
s_waitcnt lgkmcnt(4)
E v21,v21
M v[96:99],a[172:175],a[100:103],v[96:99]
AF v21,1.0,v21
M v[96:99],a[168:171],a[96:99],v[96:99]
v_rcp_f32 v20, v21
M v[128:131],a[160:163],a[96:99],v[128:131]
s_lshl_b32 s72, s20, 4
R a[168:171],v5,18432
R a[172:175],v6,18432
M v[128:131],a[164:167],a[100:103],v[128:131]
SA s72,s72,163584
T a[72:73],v2,49152
T a[74:75],v2,50176
M v[132:135],a[164:167],a[108:111],v[132:135]
buffer_load_dwordx4 v14, s[48:51], s22 offen offset:2048   lds
M v[132:135],a[160:163],a[104:107],v[132:135]
v_lshl_add_u32 v28, v28, 2, s72
ds_write_b32 v28, v30
M v[136:139],a[160:163],a[112:115],v[136:139]
ds_write_b32 v28, v16 offset:64
ds_write_b32 v28, v20 offset:128
M v[136:139],a[164:167],a[116:119],v[136:139]
M v[140:143],a[164:167],a[124:127],v[140:143]
M v[140:143],a[160:163],a[120:123],v[140:143]
s_nop 0
T a[76:77],v2,57344
T a[78:79],v2,58368
M v[144:147],a[160:163],a[128:131],v[144:147]
buffer_load_dwordx4 v15, s[48:51], s22 offen offset:3072   lds
M v[144:147],a[164:167],a[132:135],v[144:147]
SA s22,s22,1048576
M v[148:151],a[164:167],a[140:143],v[148:151]
M v[148:151],a[160:163],a[136:139],v[148:151]
M v[152:155],a[160:163],a[144:147],v[152:155]
M v[152:155],a[164:167],a[148:151],v[152:155]
s_waitcnt lgkmcnt(7)
M v[156:159],a[164:167],a[156:159],v[156:159]
SA m0,s23,32768
T a[80:81],v3,49152
T a[82:83],v3,50176
M v[156:159],a[160:163],a[152:155],v[156:159]
buffer_load_dwordx4 v8, s[16:19], s21 offen offset:0   lds
M v[188:191],a[168:171],a[152:155],v[188:191]
R a[160:163],v5,20480
R a[164:167],v6,20480
M v[188:191],a[172:175],a[156:159],v[188:191]
M v[184:187],a[172:175],a[148:151],v[184:187]
M v[184:187],a[168:171],a[144:147],v[184:187]
M v[180:183],a[168:171],a[136:139],v[180:183]
M v[180:183],a[172:175],a[140:143],v[180:183]
s_nop 0
T a[84:85],v3,57344
T a[86:87],v3,58368
M v[176:179],a[172:175],a[132:135],v[176:179]
buffer_load_dwordx4 v9, s[16:19], s21 offen offset:1024   lds
M v[176:179],a[168:171],a[128:131],v[176:179]
M v[172:175],a[168:171],a[120:123],v[172:175]
M v[172:175],a[172:175],a[124:127],v[172:175]
M v[168:171],a[172:175],a[116:119],v[168:171]
M v[168:171],a[168:171],a[112:115],v[168:171]
M v[164:167],a[168:171],a[104:107],v[164:167]
s_nop 0
T a[88:89],v4,49152
T a[90:91],v4,50176
M v[164:167],a[172:175],a[108:111],v[164:167]
s_waitcnt lgkmcnt(4)
buffer_load_dwordx4 v10, s[16:19], s21 offen offset:2048   lds
M v[160:163],a[172:175],a[100:103],v[160:163]
M v[160:163],a[168:171],a[96:99],v[160:163]
M v[192:195],a[160:163],a[96:99],v[192:195]
R a[168:171],v5,22528
R a[172:175],v6,22528
M v[192:195],a[164:167],a[100:103],v[192:195]
M v[196:199],a[164:167],a[108:111],v[196:199]
M v[196:199],a[160:163],a[104:107],v[196:199]
s_nop 0
T a[92:93],v4,57344
T a[94:95],v4,58368
M v[200:203],a[160:163],a[112:115],v[200:203]
buffer_load_dwordx4 v11, s[16:19], s21 offen offset:3072   lds
M v[200:203],a[164:167],a[116:119],v[200:203]
SA s21,s21,128
M v[204:207],a[164:167],a[124:127],v[204:207]
M v[204:207],a[160:163],a[120:123],v[204:207]
M v[208:211],a[160:163],a[128:131],v[208:211]
M v[208:211],a[164:167],a[132:135],v[208:211]
M v[212:215],a[164:167],a[140:143],v[212:215]
M v[212:215],a[160:163],a[136:139],v[212:215]
M v[216:219],a[160:163],a[144:147],v[216:219]
M v[216:219],a[164:167],a[148:151],v[216:219]
s_waitcnt lgkmcnt(2)
M v[220:223],a[164:167],a[156:159],v[220:223]
s_waitcnt vmcnt(16) lgkmcnt(0)
M v[220:223],a[160:163],a[152:155],v[220:223]
s_barrier
M v[252:255],a[168:171],a[152:155],v[252:255]
R a[160:163],v5,32768
R a[164:167],v6,32768
M v[252:255],a[172:175],a[156:159],v[252:255]
M v[248:251],a[172:175],a[148:151],v[248:251]
M v[248:251],a[168:171],a[144:147],v[248:251]
M v[244:247],a[168:171],a[136:139],v[244:247]
M v[244:247],a[172:175],a[140:143],v[244:247]
M v[240:243],a[172:175],a[132:135],v[240:243]
M v[240:243],a[168:171],a[128:131],v[240:243]
M v[236:239],a[168:171],a[120:123],v[236:239]
M v[236:239],a[172:175],a[124:127],v[236:239]
M v[232:235],a[172:175],a[116:119],v[232:235]
M v[232:235],a[168:171],a[112:115],v[232:235]
M v[228:231],a[168:171],a[104:107],v[228:231]
M v[228:231],a[172:175],a[108:111],v[228:231]
s_waitcnt lgkmcnt(0)
M v[224:227],a[172:175],a[100:103],v[224:227]
M v[224:227],a[168:171],a[96:99],v[224:227]
M a[0:3],a[160:163],a[32:35],a[0:3]
R a[168:171],v5,34816
R a[172:175],v6,34816
M a[0:3],a[164:167],a[36:39],a[0:3]
T a[96:97],v1,0
T a[98:99],v1,1024
M a[4:7],a[164:167],a[44:47],a[4:7]
SA m0,s24,16384
M a[4:7],a[160:163],a[40:43],a[4:7]
buffer_load_dwordx4 v12, s[48:51], s22 offen offset:0   lds
M a[8:11],a[160:163],a[48:51],a[8:11]
v_and_b32 v20, 31, v0
M a[8:11],a[164:167],a[52:55],a[8:11]
v_lshlrev_b32 v20, 2, v20
M a[12:15],a[164:167],a[60:63],a[12:15]
s_nop 0
T a[100:101],v1,8192
T a[102:103],v1,9216
M a[12:15],a[160:163],a[56:59],a[12:15]
v_add_u32 v21, 163584, v20
M a[16:19],a[160:163],a[64:67],a[16:19]
buffer_load_dwordx4 v13, s[48:51], s22 offen offset:1024   lds
M a[16:19],a[164:167],a[68:71],a[16:19]
ds_read_b32 v19, v21
M a[20:23],a[164:167],a[76:79],a[20:23]
ds_read_b32 v21, v21 offset:64
M a[20:23],a[160:163],a[72:75],a[20:23]
s_min_u32 s64, s20, 1
T a[104:105],v2,0
T a[106:107],v2,1024
M a[24:27],a[160:163],a[80:83],a[24:27]
s_lshl_b32 s64, s64, 29
v_and_b32 v22, 32, v0
M a[24:27],a[164:167],a[84:87],a[24:27]
s_waitcnt lgkmcnt(8)
buffer_load_dwordx4 v14, s[48:51], s22 offen offset:2048   lds
M a[28:31],a[164:167],a[92:95],a[28:31]
v_lshl_or_b32 v20, v22, 24, v20
M a[28:31],a[160:163],a[88:91],a[28:31]
v_or_b32 v20, s64, v20
M v[60:63],a[168:171],a[88:91],v[60:63]
R a[160:163],v5,36864
R a[164:167],v6,36864
M v[60:63],a[172:175],a[92:95],v[60:63]
T a[108:109],v2,8192
T a[110:111],v2,9216
M v[56:59],a[172:175],a[84:87],v[56:59]
buffer_load_dwordx4 v15, s[48:51], s22 offen offset:3072   lds
M v[56:59],a[168:171],a[80:83],v[56:59]
s_sub_u32 s22, s22, 1048448
v_and_b32 v22, 16, v0
M v[52:55],a[168:171],a[72:75],v[52:55]
v_lshl_or_b32 v18, v22, 25, v20
s_and_b32 s27, s42, 7
M v[52:55],a[172:175],a[76:79],v[52:55]
s_lshl_b32 s72, s30, 7
T a[112:113],v3,0
T a[114:115],v3,1024
M v[48:51],a[172:175],a[68:71],v[48:51]
SA m0,s23,49152
SA s72,s72,104857600
s_lshl_b32 s64, s41, 3
M v[48:51],a[168:171],a[64:67],v[48:51]
SA s27,s27,s64
buffer_load_dwordx4 v8, s[16:19], s21 offen offset:0   lds
M v[44:47],a[168:171],a[56:59],v[44:47]
s_lshl_b32 s27, s27, 2
M v[44:47],a[172:175],a[60:63],v[44:47]
SA s27,s27,s20
M v[40:43],a[172:175],a[52:55],v[40:43]
s_mul_i32 s27, s27, 7168
T a[116:117],v3,8192
T a[118:119],v3,9216
M v[40:43],a[168:171],a[48:51],v[40:43]
s_mov_b32 s60, s90
M v[36:39],a[168:171],a[40:43],v[36:39]
s_and_b32 s61, s91, 0xffff
buffer_load_dwordx4 v9, s[16:19], s21 offen offset:1024   lds
M v[36:39],a[172:175],a[44:47],v[36:39]
s_waitcnt lgkmcnt(6)
buffer_store_dword v21, v20, s[8:11], s72 offen sc1
M v[32:35],a[172:175],a[36:39],v[32:35]
s_mov_b32 s62, 3670016
M v[32:35],a[168:171],a[32:35],v[32:35]
s_mov_b32 s63, 0x20000
T a[120:121],v4,0
T a[122:123],v4,1024
M v[64:67],a[160:163],a[32:35],v[64:67]
R a[168:171],v5,38912
R a[172:175],v6,38912
M v[64:67],a[164:167],a[36:39],v[64:67]
buffer_load_dwordx4 v10, s[16:19], s21 offen offset:2048   lds
M v[68:71],a[164:167],a[44:47],v[68:71]
M v[68:71],a[160:163],a[40:43],v[68:71]
M v[72:75],a[160:163],a[48:51],v[72:75]
s_nop 0
T a[124:125],v4,8192
T a[126:127],v4,9216
M v[72:75],a[164:167],a[52:55],v[72:75]
M v[76:79],a[164:167],a[60:63],v[76:79]
buffer_load_dwordx4 v11, s[16:19], s21 offen offset:3072   lds
M v[76:79],a[160:163],a[56:59],v[76:79]
SA s21,s21,524160
M v[80:83],a[160:163],a[64:67],v[80:83]
M v[80:83],a[164:167],a[68:71],v[80:83]
M v[84:87],a[164:167],a[76:79],v[84:87]
M v[84:87],a[160:163],a[72:75],v[84:87]
M v[88:91],a[160:163],a[80:83],v[88:91]
M v[88:91],a[164:167],a[84:87],v[88:91]
s_waitcnt lgkmcnt(2)
M v[92:95],a[164:167],a[92:95],v[92:95]
s_waitcnt vmcnt(17) lgkmcnt(0)
M v[92:95],a[160:163],a[88:91],v[92:95]
s_barrier
M v[124:127],a[168:171],a[88:91],v[124:127]
R a[160:163],v5,49152
R a[164:167],v6,49152
M v[124:127],a[172:175],a[92:95],v[124:127]
M v[120:123],a[172:175],a[84:87],v[120:123]
SA m0,s24,32768
T a[128:129],v1,16384
T a[130:131],v1,17408
M v[120:123],a[168:171],a[80:83],v[120:123]
buffer_load_dwordx4 v12, s[48:51], s22 offen offset:0   lds
M v[116:119],a[168:171],a[72:75],v[116:119]
v_min_u32 v16, 40, v0
v_lshlrev_b32 v16, 2, v16
M v[116:119],a[172:175],a[76:79],v[116:119]
buffer_load_dword v17, v16, s[12:15], 0 offen sc1
M v[112:115],a[172:175],a[68:71],v[112:115]
M v[112:115],a[168:171],a[64:67],v[112:115]
M v[108:111],a[168:171],a[56:59],v[108:111]
M v[108:111],a[172:175],a[60:63],v[108:111]
s_nop 0
T a[132:133],v1,24576
T a[134:135],v1,25600
M v[104:107],a[172:175],a[52:55],v[104:107]
buffer_load_dwordx4 v13, s[48:51], s22 offen offset:1024   lds
M v[104:107],a[168:171],a[48:51],v[104:107]
M v[100:103],a[168:171],a[40:43],v[100:103]
M v[100:103],a[172:175],a[44:47],v[100:103]
s_waitcnt lgkmcnt(4)
M v[96:99],a[172:175],a[36:39],v[96:99]
M v[96:99],a[168:171],a[32:35],v[96:99]
M v[128:131],a[160:163],a[32:35],v[128:131]
R a[168:171],v5,51200
R a[172:175],v6,51200
M v[128:131],a[164:167],a[36:39],v[128:131]
T a[136:137],v2,16384
T a[138:139],v2,17408
M v[132:135],a[164:167],a[44:47],v[132:135]
buffer_load_dwordx4 v14, s[48:51], s22 offen offset:2048   lds
M v[132:135],a[160:163],a[40:43],v[132:135]
M v[136:139],a[160:163],a[48:51],v[136:139]
M v[136:139],a[164:167],a[52:55],v[136:139]
M v[140:143],a[164:167],a[60:63],v[140:143]
M v[140:143],a[160:163],a[56:59],v[140:143]
s_nop 0
T a[140:141],v2,24576
T a[142:143],v2,25600
M v[144:147],a[160:163],a[64:67],v[144:147]
buffer_load_dwordx4 v15, s[48:51], s22 offen offset:3072   lds
M v[144:147],a[164:167],a[68:71],v[144:147]
SA s22,s22,1048576
M v[148:151],a[164:167],a[76:79],v[148:151]
M v[148:151],a[160:163],a[72:75],v[148:151]
M v[152:155],a[160:163],a[80:83],v[152:155]
M v[152:155],a[164:167],a[84:87],v[152:155]
s_waitcnt lgkmcnt(4)
M v[156:159],a[164:167],a[92:95],v[156:159]
SA m0,s23,0
T a[144:145],v3,16384
T a[146:147],v3,17408
M v[156:159],a[160:163],a[88:91],v[156:159]
buffer_load_dwordx4 v8, s[16:19], s21 offen offset:0   lds
M v[188:191],a[168:171],a[88:91],v[188:191]
R a[160:163],v5,53248
R a[164:167],v6,53248
M v[188:191],a[172:175],a[92:95],v[188:191]
buffer_load_dword a240, v26, s[60:63], s27 offen offset:0
M v[184:187],a[172:175],a[84:87],v[184:187]
SA s27,s27,2048
M v[184:187],a[168:171],a[80:83],v[184:187]
M v[180:183],a[168:171],a[72:75],v[180:183]
M v[180:183],a[172:175],a[76:79],v[180:183]
s_nop 0
T a[148:149],v3,24576
T a[150:151],v3,25600
M v[176:179],a[172:175],a[68:71],v[176:179]
buffer_load_dwordx4 v9, s[16:19], s21 offen offset:1024   lds
M v[176:179],a[168:171],a[64:67],v[176:179]
M v[172:175],a[168:171],a[56:59],v[172:175]
M v[172:175],a[172:175],a[60:63],v[172:175]
M v[168:171],a[172:175],a[52:55],v[168:171]
M v[168:171],a[168:171],a[48:51],v[168:171]
M v[164:167],a[168:171],a[40:43],v[164:167]
s_nop 0
T a[152:153],v4,16384
T a[154:155],v4,17408
M v[164:167],a[172:175],a[44:47],v[164:167]
s_waitcnt lgkmcnt(4)
buffer_load_dwordx4 v10, s[16:19], s21 offen offset:2048   lds
M v[160:163],a[172:175],a[36:39],v[160:163]
M v[160:163],a[168:171],a[32:35],v[160:163]
M v[192:195],a[160:163],a[32:35],v[192:195]
L_w_kv12:
s_cbranch_execz L_w_kv16
R a[168:171],v5,55296
R a[172:175],v6,55296
M v[192:195],a[164:167],a[36:39],v[192:195]
M v[196:199],a[164:167],a[44:47],v[196:199]
M v[196:199],a[160:163],a[40:43],v[196:199]
s_nop 0
T a[156:157],v4,24576
T a[158:159],v4,25600
M v[200:203],a[160:163],a[48:51],v[200:203]
buffer_load_dwordx4 v11, s[16:19], s21 offen offset:3072   lds
M v[200:203],a[164:167],a[52:55],v[200:203]
SA s21,s21,128
M v[204:207],a[164:167],a[60:63],v[204:207]
M v[204:207],a[160:163],a[56:59],v[204:207]
M v[208:211],a[160:163],a[64:67],v[208:211]
M v[208:211],a[164:167],a[68:71],v[208:211]
M v[212:215],a[164:167],a[76:79],v[212:215]
M v[212:215],a[160:163],a[72:75],v[212:215]
M v[216:219],a[160:163],a[80:83],v[216:219]
M v[216:219],a[164:167],a[84:87],v[216:219]
s_waitcnt lgkmcnt(2)
M v[220:223],a[164:167],a[92:95],v[220:223]
s_waitcnt vmcnt(19) lgkmcnt(0)
M v[220:223],a[160:163],a[88:91],v[220:223]
s_barrier
M v[252:255],a[168:171],a[88:91],v[252:255]
R a[160:163],v5,0
R a[164:167],v6,0
M v[252:255],a[172:175],a[92:95],v[252:255]
M v[248:251],a[172:175],a[84:87],v[248:251]
M v[248:251],a[168:171],a[80:83],v[248:251]
M v[244:247],a[168:171],a[72:75],v[244:247]
M v[244:247],a[172:175],a[76:79],v[244:247]
M v[240:243],a[172:175],a[68:71],v[240:243]
M v[240:243],a[168:171],a[64:67],v[240:243]
M v[236:239],a[168:171],a[56:59],v[236:239]
M v[236:239],a[172:175],a[60:63],v[236:239]
M v[232:235],a[172:175],a[52:55],v[232:235]
M v[232:235],a[168:171],a[48:51],v[232:235]
M v[228:231],a[168:171],a[40:43],v[228:231]
M v[228:231],a[172:175],a[44:47],v[228:231]
s_waitcnt lgkmcnt(0)
M v[224:227],a[172:175],a[36:39],v[224:227]
M v[224:227],a[168:171],a[32:35],v[224:227]
M a[0:3],a[160:163],a[96:99],a[0:3]
R a[168:171],v5,2048
R a[172:175],v6,2048
M a[0:3],a[164:167],a[100:103],a[0:3]
T a[32:33],v1,32768
T a[34:35],v1,33792
M a[4:7],a[164:167],a[108:111],a[4:7]
SA m0,s24,49152
M a[4:7],a[160:163],a[104:107],a[4:7]
buffer_load_dwordx4 v12, s[48:51], s22 offen offset:0   lds
M a[8:11],a[160:163],a[112:115],a[8:11]
M a[8:11],a[164:167],a[116:119],a[8:11]
M a[12:15],a[164:167],a[124:127],a[12:15]
s_nop 0
T a[36:37],v1,40960
T a[38:39],v1,41984
M a[12:15],a[160:163],a[120:123],a[12:15]
M a[16:19],a[160:163],a[128:131],a[16:19]
buffer_load_dwordx4 v13, s[48:51], s22 offen offset:1024   lds
M a[16:19],a[164:167],a[132:135],a[16:19]
M a[20:23],a[164:167],a[140:143],a[20:23]
M a[20:23],a[160:163],a[136:139],a[20:23]
s_nop 0
T a[40:41],v2,32768
T a[42:43],v2,33792
M a[24:27],a[160:163],a[144:147],a[24:27]
M a[24:27],a[164:167],a[148:151],a[24:27]
s_waitcnt lgkmcnt(6)
buffer_load_dwordx4 v14, s[48:51], s22 offen offset:2048   lds
M a[28:31],a[164:167],a[156:159],a[28:31]
M a[28:31],a[160:163],a[152:155],a[28:31]
M v[60:63],a[168:171],a[152:155],v[60:63]
R a[160:163],v5,4096
R a[164:167],v6,4096
M v[60:63],a[172:175],a[156:159],v[60:63]
T a[44:45],v2,40960
T a[46:47],v2,41984
M v[56:59],a[172:175],a[148:151],v[56:59]
buffer_load_dwordx4 v15, s[48:51], s22 offen offset:3072   lds
M v[56:59],a[168:171],a[144:147],v[56:59]
s_sub_u32 s22, s22, 1048448
M v[52:55],a[168:171],a[136:139],v[52:55]
M v[52:55],a[172:175],a[140:143],v[52:55]
s_nop 0
T a[48:49],v3,32768
T a[50:51],v3,33792
M v[48:51],a[172:175],a[132:135],v[48:51]
SA m0,s23,16384
M v[48:51],a[168:171],a[128:131],v[48:51]
buffer_load_dwordx4 v8, s[16:19], s21 offen offset:0   lds
M v[44:47],a[168:171],a[120:123],v[44:47]
M v[44:47],a[172:175],a[124:127],v[44:47]
M v[40:43],a[172:175],a[116:119],v[40:43]
s_nop 0
T a[52:53],v3,40960
T a[54:55],v3,41984
M v[40:43],a[168:171],a[112:115],v[40:43]
M v[36:39],a[168:171],a[104:107],v[36:39]
buffer_load_dwordx4 v9, s[16:19], s21 offen offset:1024   lds
M v[36:39],a[172:175],a[108:111],v[36:39]
s_waitcnt lgkmcnt(6)
M v[32:35],a[172:175],a[100:103],v[32:35]
M v[32:35],a[168:171],a[96:99],v[32:35]
s_nop 0
T a[56:57],v4,32768
T a[58:59],v4,33792
M v[64:67],a[160:163],a[96:99],v[64:67]
R a[168:171],v5,6144
R a[172:175],v6,6144
M v[64:67],a[164:167],a[100:103],v[64:67]
buffer_load_dwordx4 v10, s[16:19], s21 offen offset:2048   lds
M v[68:71],a[164:167],a[108:111],v[68:71]
M v[68:71],a[160:163],a[104:107],v[68:71]
M v[72:75],a[160:163],a[112:115],v[72:75]
s_nop 0
T a[60:61],v4,40960
T a[62:63],v4,41984
M v[72:75],a[164:167],a[116:119],v[72:75]
M v[76:79],a[164:167],a[124:127],v[76:79]
buffer_load_dwordx4 v11, s[16:19], s21 offen offset:3072   lds
M v[76:79],a[160:163],a[120:123],v[76:79]
SA s21,s21,524160
M v[80:83],a[160:163],a[128:131],v[80:83]
M v[80:83],a[164:167],a[132:135],v[80:83]
M v[84:87],a[164:167],a[140:143],v[84:87]
M v[84:87],a[160:163],a[136:139],v[84:87]
M v[88:91],a[160:163],a[144:147],v[88:91]
M v[88:91],a[164:167],a[148:151],v[88:91]
s_waitcnt lgkmcnt(2)
M v[92:95],a[164:167],a[156:159],v[92:95]
s_waitcnt vmcnt(18) lgkmcnt(0)
M v[92:95],a[160:163],a[152:155],v[92:95]
s_barrier
M v[124:127],a[168:171],a[152:155],v[124:127]
R a[160:163],v5,16384
R a[164:167],v6,16384
M v[124:127],a[172:175],a[156:159],v[124:127]
M v[120:123],a[172:175],a[148:151],v[120:123]
SA m0,s24,0
T a[64:65],v1,49152
T a[66:67],v1,50176
M v[120:123],a[168:171],a[144:147],v[120:123]
buffer_load_dwordx4 v12, s[48:51], s22 offen offset:0   lds
M v[116:119],a[168:171],a[136:139],v[116:119]
M v[116:119],a[172:175],a[140:143],v[116:119]
M v[112:115],a[172:175],a[132:135],v[112:115]
M v[112:115],a[168:171],a[128:131],v[112:115]
M v[108:111],a[168:171],a[120:123],v[108:111]
M v[108:111],a[172:175],a[124:127],v[108:111]
s_nop 0
T a[68:69],v1,57344
T a[70:71],v1,58368
M v[104:107],a[172:175],a[116:119],v[104:107]
buffer_load_dwordx4 v13, s[48:51], s22 offen offset:1024   lds
M v[104:107],a[168:171],a[112:115],v[104:107]
M v[100:103],a[168:171],a[104:107],v[100:103]
M v[100:103],a[172:175],a[108:111],v[100:103]
s_waitcnt lgkmcnt(4)
M v[96:99],a[172:175],a[100:103],v[96:99]
M v[96:99],a[168:171],a[96:99],v[96:99]
M v[128:131],a[160:163],a[96:99],v[128:131]
R a[168:171],v5,18432
R a[172:175],v6,18432
M v[128:131],a[164:167],a[100:103],v[128:131]
T a[72:73],v2,49152
T a[74:75],v2,50176
M v[132:135],a[164:167],a[108:111],v[132:135]
buffer_load_dwordx4 v14, s[48:51], s22 offen offset:2048   lds
M v[132:135],a[160:163],a[104:107],v[132:135]
M v[136:139],a[160:163],a[112:115],v[136:139]
M v[136:139],a[164:167],a[116:119],v[136:139]
M v[140:143],a[164:167],a[124:127],v[140:143]
M v[140:143],a[160:163],a[120:123],v[140:143]
s_nop 0
T a[76:77],v2,57344
T a[78:79],v2,58368
M v[144:147],a[160:163],a[128:131],v[144:147]
buffer_load_dwordx4 v15, s[48:51], s22 offen offset:3072   lds
M v[144:147],a[164:167],a[132:135],v[144:147]
SA s22,s22,1048576
M v[148:151],a[164:167],a[140:143],v[148:151]
M v[148:151],a[160:163],a[136:139],v[148:151]
M v[152:155],a[160:163],a[144:147],v[152:155]
M v[152:155],a[164:167],a[148:151],v[152:155]
s_waitcnt lgkmcnt(4)
M v[156:159],a[164:167],a[156:159],v[156:159]
SA m0,s23,32768
T a[80:81],v3,49152
T a[82:83],v3,50176
M v[156:159],a[160:163],a[152:155],v[156:159]
buffer_load_dwordx4 v8, s[16:19], s21 offen offset:0   lds
M v[188:191],a[168:171],a[152:155],v[188:191]
R a[160:163],v5,20480
R a[164:167],v6,20480
M v[188:191],a[172:175],a[156:159],v[188:191]
buffer_load_dword a240, v26, s[60:63], s27 offen offset:0
M v[184:187],a[172:175],a[148:151],v[184:187]
SA s27,s27,2048
M v[184:187],a[168:171],a[144:147],v[184:187]
M v[180:183],a[168:171],a[136:139],v[180:183]
M v[180:183],a[172:175],a[140:143],v[180:183]
s_nop 0
T a[84:85],v3,57344
T a[86:87],v3,58368
M v[176:179],a[172:175],a[132:135],v[176:179]
buffer_load_dwordx4 v9, s[16:19], s21 offen offset:1024   lds
M v[176:179],a[168:171],a[128:131],v[176:179]
M v[172:175],a[168:171],a[120:123],v[172:175]
M v[172:175],a[172:175],a[124:127],v[172:175]
M v[168:171],a[172:175],a[116:119],v[168:171]
M v[168:171],a[168:171],a[112:115],v[168:171]
M v[164:167],a[168:171],a[104:107],v[164:167]
s_nop 0
T a[88:89],v4,49152
T a[90:91],v4,50176
M v[164:167],a[172:175],a[108:111],v[164:167]
s_waitcnt lgkmcnt(4)
buffer_load_dwordx4 v10, s[16:19], s21 offen offset:2048   lds
M v[160:163],a[172:175],a[100:103],v[160:163]
M v[160:163],a[168:171],a[96:99],v[160:163]
M v[192:195],a[160:163],a[96:99],v[192:195]
R a[168:171],v5,22528
R a[172:175],v6,22528
M v[192:195],a[164:167],a[100:103],v[192:195]
M v[196:199],a[164:167],a[108:111],v[196:199]
M v[196:199],a[160:163],a[104:107],v[196:199]
s_nop 0
T a[92:93],v4,57344
T a[94:95],v4,58368
M v[200:203],a[160:163],a[112:115],v[200:203]
buffer_load_dwordx4 v11, s[16:19], s21 offen offset:3072   lds
M v[200:203],a[164:167],a[116:119],v[200:203]
SA s21,s21,128
M v[204:207],a[164:167],a[124:127],v[204:207]
M v[204:207],a[160:163],a[120:123],v[204:207]
M v[208:211],a[160:163],a[128:131],v[208:211]
M v[208:211],a[164:167],a[132:135],v[208:211]
M v[212:215],a[164:167],a[140:143],v[212:215]
M v[212:215],a[160:163],a[136:139],v[212:215]
M v[216:219],a[160:163],a[144:147],v[216:219]
M v[216:219],a[164:167],a[148:151],v[216:219]
s_waitcnt lgkmcnt(2)
M v[220:223],a[164:167],a[156:159],v[220:223]
s_waitcnt vmcnt(17) lgkmcnt(0)
M v[220:223],a[160:163],a[152:155],v[220:223]
s_barrier
M v[252:255],a[168:171],a[152:155],v[252:255]
R a[160:163],v5,32768
R a[164:167],v6,32768
M v[252:255],a[172:175],a[156:159],v[252:255]
v_cmp_ne_u32 vcc, 1, v17
M v[248:251],a[172:175],a[148:151],v[248:251]
s_nop 0
M v[248:251],a[168:171],a[144:147],v[248:251]
s_cbranch_vccnz L_zs1
L_zr1:
M v[244:247],a[168:171],a[136:139],v[244:247]
M v[244:247],a[172:175],a[140:143],v[244:247]
s_lshl_b32 s72, s30, 6
M v[240:243],a[172:175],a[132:135],v[240:243]
SA s72,s72,104914944
M v[240:243],a[168:171],a[128:131],v[240:243]
buffer_store_dword v19, v18, s[8:11], s72 offen sc1
M v[236:239],a[168:171],a[120:123],v[236:239]
M v[236:239],a[172:175],a[124:127],v[236:239]
M v[232:235],a[172:175],a[116:119],v[232:235]
M v[232:235],a[168:171],a[112:115],v[232:235]
M v[228:231],a[168:171],a[104:107],v[228:231]
M v[228:231],a[172:175],a[108:111],v[228:231]
s_waitcnt lgkmcnt(0)
M v[224:227],a[172:175],a[100:103],v[224:227]
M v[224:227],a[168:171],a[96:99],v[224:227]
M a[0:3],a[160:163],a[32:35],a[0:3]
R a[168:171],v5,34816
R a[172:175],v6,34816
M a[0:3],a[164:167],a[36:39],a[0:3]
T a[96:97],v1,0
T a[98:99],v1,1024
M a[4:7],a[164:167],a[44:47],a[4:7]
SA m0,s24,16384
M a[4:7],a[160:163],a[40:43],a[4:7]
buffer_load_dwordx4 v12, s[48:51], s22 offen offset:0   lds
M a[8:11],a[160:163],a[48:51],a[8:11]
M a[8:11],a[164:167],a[52:55],a[8:11]
s_mul_i32 s64, s41, 229376
M a[12:15],a[164:167],a[60:63],a[12:15]
SA s72,s90,s64
T a[100:101],v1,8192
T a[102:103],v1,9216
M a[12:15],a[160:163],a[56:59],a[12:15]
s_addc_u32 s73, s91, 0
M a[16:19],a[160:163],a[64:67],a[16:19]
s_sub_u32 s75, 3670016, s64
buffer_load_dwordx4 v13, s[48:51], s22 offen offset:1024   lds
M a[16:19],a[164:167],a[68:71],a[16:19]
s_mov_b32 s12, s72
M a[20:23],a[164:167],a[76:79],a[20:23]
s_and_b32 s13, s73, 0xffff
M a[20:23],a[160:163],a[72:75],a[20:23]
s_mov_b32 s14, s75
T a[104:105],v2,0
T a[106:107],v2,1024
M a[24:27],a[160:163],a[80:83],a[24:27]
s_mov_b32 s15, 0x20000
M a[24:27],a[164:167],a[84:87],a[24:27]
s_waitcnt lgkmcnt(6)
buffer_load_dwordx4 v14, s[48:51], s22 offen offset:2048   lds
M a[28:31],a[164:167],a[92:95],a[28:31]
M a[28:31],a[160:163],a[88:91],a[28:31]
M v[60:63],a[168:171],a[88:91],v[60:63]
R a[160:163],v5,36864
R a[164:167],v6,36864
M v[60:63],a[172:175],a[92:95],v[60:63]
T a[108:109],v2,8192
T a[110:111],v2,9216
M v[56:59],a[172:175],a[84:87],v[56:59]
buffer_load_dwordx4 v15, s[48:51], s22 offen offset:3072   lds
M v[56:59],a[168:171],a[80:83],v[56:59]
s_sub_u32 s22, s22, 1048448
M v[52:55],a[168:171],a[72:75],v[52:55]
M v[52:55],a[172:175],a[76:79],v[52:55]
s_nop 0
T a[112:113],v3,0
T a[114:115],v3,1024
M v[48:51],a[172:175],a[68:71],v[48:51]
SA m0,s23,49152
M v[48:51],a[168:171],a[64:67],v[48:51]
buffer_load_dwordx4 v8, s[16:19], s21 offen offset:0   lds
M v[44:47],a[168:171],a[56:59],v[44:47]
M v[44:47],a[172:175],a[60:63],v[44:47]
M v[40:43],a[172:175],a[52:55],v[40:43]
s_nop 0
T a[116:117],v3,8192
T a[118:119],v3,9216
M v[40:43],a[168:171],a[48:51],v[40:43]
M v[36:39],a[168:171],a[40:43],v[36:39]
buffer_load_dwordx4 v9, s[16:19], s21 offen offset:1024   lds
M v[36:39],a[172:175],a[44:47],v[36:39]
s_waitcnt lgkmcnt(6)
M v[32:35],a[172:175],a[36:39],v[32:35]
M v[32:35],a[168:171],a[32:35],v[32:35]
s_nop 0
T a[120:121],v4,0
T a[122:123],v4,1024
M v[64:67],a[160:163],a[32:35],v[64:67]
R a[168:171],v5,38912
R a[172:175],v6,38912
M v[64:67],a[164:167],a[36:39],v[64:67]
buffer_load_dwordx4 v10, s[16:19], s21 offen offset:2048   lds
M v[68:71],a[164:167],a[44:47],v[68:71]
M v[68:71],a[160:163],a[40:43],v[68:71]
M v[72:75],a[160:163],a[48:51],v[72:75]
s_nop 0
T a[124:125],v4,8192
T a[126:127],v4,9216
M v[72:75],a[164:167],a[52:55],v[72:75]
M v[76:79],a[164:167],a[60:63],v[76:79]
buffer_load_dwordx4 v11, s[16:19], s21 offen offset:3072   lds
M v[76:79],a[160:163],a[56:59],v[76:79]
SA s21,s21,524160
M v[80:83],a[160:163],a[64:67],v[80:83]
M v[80:83],a[164:167],a[68:71],v[80:83]
M v[84:87],a[164:167],a[76:79],v[84:87]
M v[84:87],a[160:163],a[72:75],v[84:87]
M v[88:91],a[160:163],a[80:83],v[88:91]
M v[88:91],a[164:167],a[84:87],v[88:91]
s_waitcnt lgkmcnt(2)
M v[92:95],a[164:167],a[92:95],v[92:95]
s_waitcnt vmcnt(18) lgkmcnt(0)
M v[92:95],a[160:163],a[88:91],v[92:95]
s_barrier
M v[124:127],a[168:171],a[88:91],v[124:127]
R a[160:163],v5,49152
R a[164:167],v6,49152
M v[124:127],a[172:175],a[92:95],v[124:127]
M v[120:123],a[172:175],a[84:87],v[120:123]
SA m0,s24,32768
T a[128:129],v1,16384
T a[130:131],v1,17408
M v[120:123],a[168:171],a[80:83],v[120:123]
buffer_load_dwordx4 v12, s[48:51], s22 offen offset:0   lds
M v[116:119],a[168:171],a[72:75],v[116:119]
M v[116:119],a[172:175],a[76:79],v[116:119]
M v[112:115],a[172:175],a[68:71],v[112:115]
M v[112:115],a[168:171],a[64:67],v[112:115]
M v[108:111],a[168:171],a[56:59],v[108:111]
M v[108:111],a[172:175],a[60:63],v[108:111]
s_nop 0
T a[132:133],v1,24576
T a[134:135],v1,25600
M v[104:107],a[172:175],a[52:55],v[104:107]
buffer_load_dwordx4 v13, s[48:51], s22 offen offset:1024   lds
M v[104:107],a[168:171],a[48:51],v[104:107]
M v[100:103],a[168:171],a[40:43],v[100:103]
M v[100:103],a[172:175],a[44:47],v[100:103]
s_waitcnt lgkmcnt(4)
M v[96:99],a[172:175],a[36:39],v[96:99]
M v[96:99],a[168:171],a[32:35],v[96:99]
M v[128:131],a[160:163],a[32:35],v[128:131]
R a[168:171],v5,51200
R a[172:175],v6,51200
M v[128:131],a[164:167],a[36:39],v[128:131]
T a[136:137],v2,16384
T a[138:139],v2,17408
M v[132:135],a[164:167],a[44:47],v[132:135]
buffer_load_dwordx4 v14, s[48:51], s22 offen offset:2048   lds
M v[132:135],a[160:163],a[40:43],v[132:135]
M v[136:139],a[160:163],a[48:51],v[136:139]
M v[136:139],a[164:167],a[52:55],v[136:139]
M v[140:143],a[164:167],a[60:63],v[140:143]
M v[140:143],a[160:163],a[56:59],v[140:143]
s_nop 0
T a[140:141],v2,24576
T a[142:143],v2,25600
M v[144:147],a[160:163],a[64:67],v[144:147]
buffer_load_dwordx4 v15, s[48:51], s22 offen offset:3072   lds
M v[144:147],a[164:167],a[68:71],v[144:147]
SA s22,s22,1048576
M v[148:151],a[164:167],a[76:79],v[148:151]
M v[148:151],a[160:163],a[72:75],v[148:151]
M v[152:155],a[160:163],a[80:83],v[152:155]
M v[152:155],a[164:167],a[84:87],v[152:155]
s_waitcnt lgkmcnt(4)
M v[156:159],a[164:167],a[92:95],v[156:159]
SA m0,s23,0
T a[144:145],v3,16384
T a[146:147],v3,17408
M v[156:159],a[160:163],a[88:91],v[156:159]
buffer_load_dwordx4 v8, s[16:19], s21 offen offset:0   lds
M v[188:191],a[168:171],a[88:91],v[188:191]
R a[160:163],v5,53248
R a[164:167],v6,53248
M v[188:191],a[172:175],a[92:95],v[188:191]
buffer_load_dword a240, v26, s[60:63], s27 offen offset:0
M v[184:187],a[172:175],a[84:87],v[184:187]
SA s27,s27,2048
M v[184:187],a[168:171],a[80:83],v[184:187]
M v[180:183],a[168:171],a[72:75],v[180:183]
M v[180:183],a[172:175],a[76:79],v[180:183]
s_nop 0
T a[148:149],v3,24576
T a[150:151],v3,25600
M v[176:179],a[172:175],a[68:71],v[176:179]
buffer_load_dwordx4 v9, s[16:19], s21 offen offset:1024   lds
M v[176:179],a[168:171],a[64:67],v[176:179]
M v[172:175],a[168:171],a[56:59],v[172:175]
M v[172:175],a[172:175],a[60:63],v[172:175]
M v[168:171],a[172:175],a[52:55],v[168:171]
M v[168:171],a[168:171],a[48:51],v[168:171]
M v[164:167],a[168:171],a[40:43],v[164:167]
s_nop 0
T a[152:153],v4,16384
T a[154:155],v4,17408
M v[164:167],a[172:175],a[44:47],v[164:167]
s_waitcnt lgkmcnt(4)
buffer_load_dwordx4 v10, s[16:19], s21 offen offset:2048   lds
M v[160:163],a[172:175],a[36:39],v[160:163]
M v[160:163],a[168:171],a[32:35],v[160:163]
M v[192:195],a[160:163],a[32:35],v[192:195]
R a[168:171],v5,55296
R a[172:175],v6,55296
M v[192:195],a[164:167],a[36:39],v[192:195]
M v[196:199],a[164:167],a[44:47],v[196:199]
M v[196:199],a[160:163],a[40:43],v[196:199]
s_nop 0
T a[156:157],v4,24576
T a[158:159],v4,25600
M v[200:203],a[160:163],a[48:51],v[200:203]
buffer_load_dwordx4 v11, s[16:19], s21 offen offset:3072   lds
M v[200:203],a[164:167],a[52:55],v[200:203]
SA s21,s21,128
M v[204:207],a[164:167],a[60:63],v[204:207]
M v[204:207],a[160:163],a[56:59],v[204:207]
M v[208:211],a[160:163],a[64:67],v[208:211]
M v[208:211],a[164:167],a[68:71],v[208:211]
M v[212:215],a[164:167],a[76:79],v[212:215]
M v[212:215],a[160:163],a[72:75],v[212:215]
M v[216:219],a[160:163],a[80:83],v[216:219]
M v[216:219],a[164:167],a[84:87],v[216:219]
s_waitcnt lgkmcnt(2)
M v[220:223],a[164:167],a[92:95],v[220:223]
s_waitcnt vmcnt(18) lgkmcnt(0)
M v[220:223],a[160:163],a[88:91],v[220:223]
s_barrier
M v[252:255],a[168:171],a[88:91],v[252:255]
R a[160:163],v5,0
R a[164:167],v6,0
M v[252:255],a[172:175],a[92:95],v[252:255]
M v[248:251],a[172:175],a[84:87],v[248:251]
M v[248:251],a[168:171],a[80:83],v[248:251]
M v[244:247],a[168:171],a[72:75],v[244:247]
M v[244:247],a[172:175],a[76:79],v[244:247]
M v[240:243],a[172:175],a[68:71],v[240:243]
M v[240:243],a[168:171],a[64:67],v[240:243]
M v[236:239],a[168:171],a[56:59],v[236:239]
M v[236:239],a[172:175],a[60:63],v[236:239]
M v[232:235],a[172:175],a[52:55],v[232:235]
M v[232:235],a[168:171],a[48:51],v[232:235]
M v[228:231],a[168:171],a[40:43],v[228:231]
M v[228:231],a[172:175],a[44:47],v[228:231]
s_waitcnt lgkmcnt(0)
M v[224:227],a[172:175],a[36:39],v[224:227]
M v[224:227],a[168:171],a[32:35],v[224:227]
M a[0:3],a[160:163],a[96:99],a[0:3]
R a[168:171],v5,2048
R a[172:175],v6,2048
M a[0:3],a[164:167],a[100:103],a[0:3]
T a[32:33],v1,32768
T a[34:35],v1,33792
M a[4:7],a[164:167],a[108:111],a[4:7]
SA m0,s24,49152
M a[4:7],a[160:163],a[104:107],a[4:7]
buffer_load_dwordx4 v12, s[48:51], s22 offen offset:0   lds
M a[8:11],a[160:163],a[112:115],a[8:11]
M a[8:11],a[164:167],a[116:119],a[8:11]
M a[12:15],a[164:167],a[124:127],a[12:15]
s_nop 0
T a[36:37],v1,40960
T a[38:39],v1,41984
M a[12:15],a[160:163],a[120:123],a[12:15]
M a[16:19],a[160:163],a[128:131],a[16:19]
buffer_load_dwordx4 v13, s[48:51], s22 offen offset:1024   lds
M a[16:19],a[164:167],a[132:135],a[16:19]
M a[20:23],a[164:167],a[140:143],a[20:23]
M a[20:23],a[160:163],a[136:139],a[20:23]
s_nop 0
T a[40:41],v2,32768
T a[42:43],v2,33792
M a[24:27],a[160:163],a[144:147],a[24:27]
M a[24:27],a[164:167],a[148:151],a[24:27]
s_waitcnt lgkmcnt(6)
buffer_load_dwordx4 v14, s[48:51], s22 offen offset:2048   lds
M a[28:31],a[164:167],a[156:159],a[28:31]
M a[28:31],a[160:163],a[152:155],a[28:31]
M v[60:63],a[168:171],a[152:155],v[60:63]
R a[160:163],v5,4096
R a[164:167],v6,4096
M v[60:63],a[172:175],a[156:159],v[60:63]
T a[44:45],v2,40960
T a[46:47],v2,41984
L_w_kv13:
s_cbranch_execz L_w_kv17
M v[56:59],a[172:175],a[148:151],v[56:59]
buffer_load_dwordx4 v15, s[48:51], s22 offen offset:3072   lds
M v[56:59],a[168:171],a[144:147],v[56:59]
s_sub_u32 s22, s22, 1048448
M v[52:55],a[168:171],a[136:139],v[52:55]
M v[52:55],a[172:175],a[140:143],v[52:55]
s_nop 0
T a[48:49],v3,32768
T a[50:51],v3,33792
M v[48:51],a[172:175],a[132:135],v[48:51]
SA m0,s23,16384
M v[48:51],a[168:171],a[128:131],v[48:51]
buffer_load_dwordx4 v8, s[16:19], s21 offen offset:0   lds
M v[44:47],a[168:171],a[120:123],v[44:47]
M v[44:47],a[172:175],a[124:127],v[44:47]
M v[40:43],a[172:175],a[116:119],v[40:43]
s_nop 0
T a[52:53],v3,40960
T a[54:55],v3,41984
M v[40:43],a[168:171],a[112:115],v[40:43]
M v[36:39],a[168:171],a[104:107],v[36:39]
buffer_load_dwordx4 v9, s[16:19], s21 offen offset:1024   lds
M v[36:39],a[172:175],a[108:111],v[36:39]
s_waitcnt lgkmcnt(6)
M v[32:35],a[172:175],a[100:103],v[32:35]
M v[32:35],a[168:171],a[96:99],v[32:35]
s_nop 0
T a[56:57],v4,32768
T a[58:59],v4,33792
M v[64:67],a[160:163],a[96:99],v[64:67]
R a[168:171],v5,6144
R a[172:175],v6,6144
M v[64:67],a[164:167],a[100:103],v[64:67]
buffer_load_dwordx4 v10, s[16:19], s21 offen offset:2048   lds
M v[68:71],a[164:167],a[108:111],v[68:71]
M v[68:71],a[160:163],a[104:107],v[68:71]
M v[72:75],a[160:163],a[112:115],v[72:75]
s_nop 0
T a[60:61],v4,40960
T a[62:63],v4,41984
M v[72:75],a[164:167],a[116:119],v[72:75]
M v[76:79],a[164:167],a[124:127],v[76:79]
buffer_load_dwordx4 v11, s[16:19], s21 offen offset:3072   lds
M v[76:79],a[160:163],a[120:123],v[76:79]
SA s21,s21,524160
M v[80:83],a[160:163],a[128:131],v[80:83]
M v[80:83],a[164:167],a[132:135],v[80:83]
M v[84:87],a[164:167],a[140:143],v[84:87]
M v[84:87],a[160:163],a[136:139],v[84:87]
M v[88:91],a[160:163],a[144:147],v[88:91]
M v[88:91],a[164:167],a[148:151],v[88:91]
s_waitcnt lgkmcnt(2)
M v[92:95],a[164:167],a[156:159],v[92:95]
s_waitcnt vmcnt(17) lgkmcnt(0)
M v[92:95],a[160:163],a[152:155],v[92:95]
s_barrier
M v[124:127],a[168:171],a[152:155],v[124:127]
R a[160:163],v5,16384
R a[164:167],v6,16384
M v[124:127],a[172:175],a[156:159],v[124:127]
M v[120:123],a[172:175],a[148:151],v[120:123]
SA m0,s24,0
T a[64:65],v1,49152
T a[66:67],v1,50176
M v[120:123],a[168:171],a[144:147],v[120:123]
buffer_load_dwordx4 v12, s[48:51], s22 offen offset:0   lds
M v[116:119],a[168:171],a[136:139],v[116:119]
M v[116:119],a[172:175],a[140:143],v[116:119]
M v[112:115],a[172:175],a[132:135],v[112:115]
M v[112:115],a[168:171],a[128:131],v[112:115]
M v[108:111],a[168:171],a[120:123],v[108:111]
M v[108:111],a[172:175],a[124:127],v[108:111]
s_nop 0
T a[68:69],v1,57344
T a[70:71],v1,58368
M v[104:107],a[172:175],a[116:119],v[104:107]
buffer_load_dwordx4 v13, s[48:51], s22 offen offset:1024   lds
M v[104:107],a[168:171],a[112:115],v[104:107]
M v[100:103],a[168:171],a[104:107],v[100:103]
M v[100:103],a[172:175],a[108:111],v[100:103]
s_waitcnt lgkmcnt(4)
M v[96:99],a[172:175],a[100:103],v[96:99]
M v[96:99],a[168:171],a[96:99],v[96:99]
M v[128:131],a[160:163],a[96:99],v[128:131]
R a[168:171],v5,18432
R a[172:175],v6,18432
M v[128:131],a[164:167],a[100:103],v[128:131]
T a[72:73],v2,49152
T a[74:75],v2,50176
M v[132:135],a[164:167],a[108:111],v[132:135]
buffer_load_dwordx4 v14, s[48:51], s22 offen offset:2048   lds
M v[132:135],a[160:163],a[104:107],v[132:135]
M v[136:139],a[160:163],a[112:115],v[136:139]
M v[136:139],a[164:167],a[116:119],v[136:139]
M v[140:143],a[164:167],a[124:127],v[140:143]
M v[140:143],a[160:163],a[120:123],v[140:143]
s_nop 0
T a[76:77],v2,57344
T a[78:79],v2,58368
M v[144:147],a[160:163],a[128:131],v[144:147]
buffer_load_dwordx4 v15, s[48:51], s22 offen offset:3072   lds
M v[144:147],a[164:167],a[132:135],v[144:147]
SA s22,s22,1048576
M v[148:151],a[164:167],a[140:143],v[148:151]
M v[148:151],a[160:163],a[136:139],v[148:151]
M v[152:155],a[160:163],a[144:147],v[152:155]
M v[152:155],a[164:167],a[148:151],v[152:155]
s_waitcnt lgkmcnt(4)
M v[156:159],a[164:167],a[156:159],v[156:159]
SA m0,s23,32768
T a[80:81],v3,49152
T a[82:83],v3,50176
M v[156:159],a[160:163],a[152:155],v[156:159]
buffer_load_dwordx4 v8, s[16:19], s21 offen offset:0   lds
M v[188:191],a[168:171],a[152:155],v[188:191]
R a[160:163],v5,20480
R a[164:167],v6,20480
M v[188:191],a[172:175],a[156:159],v[188:191]
buffer_load_dword a240, v26, s[60:63], s27 offen offset:0
M v[184:187],a[172:175],a[148:151],v[184:187]
SA s27,s27,2048
M v[184:187],a[168:171],a[144:147],v[184:187]
M v[180:183],a[168:171],a[136:139],v[180:183]
M v[180:183],a[172:175],a[140:143],v[180:183]
s_nop 0
T a[84:85],v3,57344
T a[86:87],v3,58368
M v[176:179],a[172:175],a[132:135],v[176:179]
buffer_load_dwordx4 v9, s[16:19], s21 offen offset:1024   lds
M v[176:179],a[168:171],a[128:131],v[176:179]
M v[172:175],a[168:171],a[120:123],v[172:175]
M v[172:175],a[172:175],a[124:127],v[172:175]
M v[168:171],a[172:175],a[116:119],v[168:171]
M v[168:171],a[168:171],a[112:115],v[168:171]
M v[164:167],a[168:171],a[104:107],v[164:167]
s_nop 0
T a[88:89],v4,49152
T a[90:91],v4,50176
M v[164:167],a[172:175],a[108:111],v[164:167]
s_waitcnt lgkmcnt(4)
buffer_load_dwordx4 v10, s[16:19], s21 offen offset:2048   lds
M v[160:163],a[172:175],a[100:103],v[160:163]
M v[160:163],a[168:171],a[96:99],v[160:163]
M v[192:195],a[160:163],a[96:99],v[192:195]
R a[168:171],v5,22528
R a[172:175],v6,22528
M v[192:195],a[164:167],a[100:103],v[192:195]
M v[196:199],a[164:167],a[108:111],v[196:199]
M v[196:199],a[160:163],a[104:107],v[196:199]
s_nop 0
T a[92:93],v4,57344
T a[94:95],v4,58368
M v[200:203],a[160:163],a[112:115],v[200:203]
buffer_load_dwordx4 v11, s[16:19], s21 offen offset:3072   lds
M v[200:203],a[164:167],a[116:119],v[200:203]
SA s21,s21,128
M v[204:207],a[164:167],a[124:127],v[204:207]
M v[204:207],a[160:163],a[120:123],v[204:207]
M v[208:211],a[160:163],a[128:131],v[208:211]
M v[208:211],a[164:167],a[132:135],v[208:211]
M v[212:215],a[164:167],a[140:143],v[212:215]
M v[212:215],a[160:163],a[136:139],v[212:215]
M v[216:219],a[160:163],a[144:147],v[216:219]
M v[216:219],a[164:167],a[148:151],v[216:219]
s_waitcnt lgkmcnt(2)
M v[220:223],a[164:167],a[156:159],v[220:223]
s_waitcnt vmcnt(17) lgkmcnt(0)
M v[220:223],a[160:163],a[152:155],v[220:223]
s_barrier
M v[252:255],a[168:171],a[152:155],v[252:255]
R a[160:163],v5,32768
R a[164:167],v6,32768
M v[252:255],a[172:175],a[156:159],v[252:255]
M v[248:251],a[172:175],a[148:151],v[248:251]
M v[248:251],a[168:171],a[144:147],v[248:251]
M v[244:247],a[168:171],a[136:139],v[244:247]
M v[244:247],a[172:175],a[140:143],v[244:247]
M v[240:243],a[172:175],a[132:135],v[240:243]
M v[240:243],a[168:171],a[128:131],v[240:243]
M v[236:239],a[168:171],a[120:123],v[236:239]
M v[236:239],a[172:175],a[124:127],v[236:239]
M v[232:235],a[172:175],a[116:119],v[232:235]
M v[232:235],a[168:171],a[112:115],v[232:235]
M v[228:231],a[168:171],a[104:107],v[228:231]
M v[228:231],a[172:175],a[108:111],v[228:231]
s_waitcnt lgkmcnt(0)
M v[224:227],a[172:175],a[100:103],v[224:227]
M v[224:227],a[168:171],a[96:99],v[224:227]
M a[0:3],a[160:163],a[32:35],a[0:3]
R a[168:171],v5,34816
R a[172:175],v6,34816
M a[0:3],a[164:167],a[36:39],a[0:3]
T a[96:97],v1,0
T a[98:99],v1,1024
M a[4:7],a[164:167],a[44:47],a[4:7]
SA m0,s24,16384
M a[4:7],a[160:163],a[40:43],a[4:7]
buffer_load_dwordx4 v12, s[48:51], s22 offen offset:0   lds
M a[8:11],a[160:163],a[48:51],a[8:11]
M a[8:11],a[164:167],a[52:55],a[8:11]
M a[12:15],a[164:167],a[60:63],a[12:15]
s_nop 0
T a[100:101],v1,8192
T a[102:103],v1,9216
M a[12:15],a[160:163],a[56:59],a[12:15]
M a[16:19],a[160:163],a[64:67],a[16:19]
buffer_load_dwordx4 v13, s[48:51], s22 offen offset:1024   lds
M a[16:19],a[164:167],a[68:71],a[16:19]
M a[20:23],a[164:167],a[76:79],a[20:23]
M a[20:23],a[160:163],a[72:75],a[20:23]
s_nop 0
T a[104:105],v2,0
T a[106:107],v2,1024
M a[24:27],a[160:163],a[80:83],a[24:27]
M a[24:27],a[164:167],a[84:87],a[24:27]
s_waitcnt lgkmcnt(6)
buffer_load_dwordx4 v14, s[48:51], s22 offen offset:2048   lds
M a[28:31],a[164:167],a[92:95],a[28:31]
M a[28:31],a[160:163],a[88:91],a[28:31]
M v[60:63],a[168:171],a[88:91],v[60:63]
R a[160:163],v5,36864
R a[164:167],v6,36864
M v[60:63],a[172:175],a[92:95],v[60:63]
T a[108:109],v2,8192
T a[110:111],v2,9216
M v[56:59],a[172:175],a[84:87],v[56:59]
buffer_load_dwordx4 v15, s[48:51], s22 offen offset:3072   lds
M v[56:59],a[168:171],a[80:83],v[56:59]
s_sub_u32 s22, s22, 1048448
M v[52:55],a[168:171],a[72:75],v[52:55]
M v[52:55],a[172:175],a[76:79],v[52:55]
s_nop 0
T a[112:113],v3,0
T a[114:115],v3,1024
M v[48:51],a[172:175],a[68:71],v[48:51]
SA m0,s23,49152
M v[48:51],a[168:171],a[64:67],v[48:51]
buffer_load_dwordx4 v8, s[16:19], s21 offen offset:0   lds
M v[44:47],a[168:171],a[56:59],v[44:47]
M v[44:47],a[172:175],a[60:63],v[44:47]
M v[40:43],a[172:175],a[52:55],v[40:43]
s_nop 0
T a[116:117],v3,8192
T a[118:119],v3,9216
M v[40:43],a[168:171],a[48:51],v[40:43]
M v[36:39],a[168:171],a[40:43],v[36:39]
buffer_load_dwordx4 v9, s[16:19], s21 offen offset:1024   lds
M v[36:39],a[172:175],a[44:47],v[36:39]
s_waitcnt lgkmcnt(6)
M v[32:35],a[172:175],a[36:39],v[32:35]
M v[32:35],a[168:171],a[32:35],v[32:35]
s_nop 0
T a[120:121],v4,0
T a[122:123],v4,1024
M v[64:67],a[160:163],a[32:35],v[64:67]
R a[168:171],v5,38912
R a[172:175],v6,38912
M v[64:67],a[164:167],a[36:39],v[64:67]
buffer_load_dwordx4 v10, s[16:19], s21 offen offset:2048   lds
M v[68:71],a[164:167],a[44:47],v[68:71]
M v[68:71],a[160:163],a[40:43],v[68:71]
M v[72:75],a[160:163],a[48:51],v[72:75]
s_nop 0
T a[124:125],v4,8192
T a[126:127],v4,9216
M v[72:75],a[164:167],a[52:55],v[72:75]
M v[76:79],a[164:167],a[60:63],v[76:79]
buffer_load_dwordx4 v11, s[16:19], s21 offen offset:3072   lds
M v[76:79],a[160:163],a[56:59],v[76:79]
SA s21,s21,524160
M v[80:83],a[160:163],a[64:67],v[80:83]
M v[80:83],a[164:167],a[68:71],v[80:83]
M v[84:87],a[164:167],a[76:79],v[84:87]
M v[84:87],a[160:163],a[72:75],v[84:87]
M v[88:91],a[160:163],a[80:83],v[88:91]
M v[88:91],a[164:167],a[84:87],v[88:91]
s_waitcnt lgkmcnt(2)
M v[92:95],a[164:167],a[92:95],v[92:95]
s_waitcnt vmcnt(17) lgkmcnt(0)
M v[92:95],a[160:163],a[88:91],v[92:95]
s_barrier
M v[124:127],a[168:171],a[88:91],v[124:127]
R a[160:163],v5,49152
R a[164:167],v6,49152
M v[124:127],a[172:175],a[92:95],v[124:127]
M v[120:123],a[172:175],a[84:87],v[120:123]
SA m0,s24,32768
T a[128:129],v1,16384
T a[130:131],v1,17408
M v[120:123],a[168:171],a[80:83],v[120:123]
buffer_load_dwordx4 v12, s[48:51], s22 offen offset:0   lds
M v[116:119],a[168:171],a[72:75],v[116:119]
M v[116:119],a[172:175],a[76:79],v[116:119]
M v[112:115],a[172:175],a[68:71],v[112:115]
M v[112:115],a[168:171],a[64:67],v[112:115]
M v[108:111],a[168:171],a[56:59],v[108:111]
M v[108:111],a[172:175],a[60:63],v[108:111]
s_nop 0
T a[132:133],v1,24576
T a[134:135],v1,25600
M v[104:107],a[172:175],a[52:55],v[104:107]
buffer_load_dwordx4 v13, s[48:51], s22 offen offset:1024   lds
M v[104:107],a[168:171],a[48:51],v[104:107]
M v[100:103],a[168:171],a[40:43],v[100:103]
s_and_b32 s64, s42, 7
s_lshl_b32 s64, s64, 2
M v[100:103],a[172:175],a[44:47],v[100:103]
s_waitcnt lgkmcnt(4)
SA s64,s64,s20
M v[96:99],a[172:175],a[36:39],v[96:99]
s_mul_i32 s64, s64, 114688
v_bfe_u32 v28, v0, 2, 2
v_and_b32 v29, 3, v0
M v[96:99],a[168:171],a[32:35],v[96:99]
v_lshlrev_b32 v29, 7, v29
v_lshl_add_u32 v28, v28, 13, v29
M v[128:131],a[160:163],a[32:35],v[128:131]
R a[168:171],v5,51200
R a[172:175],v6,51200
M v[128:131],a[164:167],a[36:39],v[128:131]
T a[136:137],v2,16384
T a[138:139],v2,17408
M v[132:135],a[164:167],a[44:47],v[132:135]
buffer_load_dwordx4 v14, s[48:51], s22 offen offset:2048   lds
M v[132:135],a[160:163],a[40:43],v[132:135]
v_add_u32 v23, s64, v28
v_and_b32 v28, 48, v0
M v[136:139],a[160:163],a[48:51],v[136:139]
v_lshl_add_u32 v23, v28, 24, v23
M v[136:139],a[164:167],a[52:55],v[136:139]
M v[140:143],a[164:167],a[60:63],v[140:143]
M v[140:143],a[160:163],a[56:59],v[140:143]
s_nop 0
T a[140:141],v2,24576
T a[142:143],v2,25600
M v[144:147],a[160:163],a[64:67],v[144:147]
buffer_load_dwordx4 v15, s[48:51], s22 offen offset:3072   lds
M v[144:147],a[164:167],a[68:71],v[144:147]
SA s22,s22,1048576
M v[148:151],a[164:167],a[76:79],v[148:151]
M v[148:151],a[160:163],a[72:75],v[148:151]
M v[152:155],a[160:163],a[80:83],v[152:155]
M v[152:155],a[164:167],a[84:87],v[152:155]
s_waitcnt lgkmcnt(4)
M v[156:159],a[164:167],a[92:95],v[156:159]
SA m0,s23,0
T a[144:145],v3,16384
T a[146:147],v3,17408
M v[156:159],a[160:163],a[88:91],v[156:159]
buffer_load_dwordx4 v8, s[16:19], s21 offen offset:0   lds
M v[188:191],a[168:171],a[88:91],v[188:191]
R a[160:163],v5,53248
R a[164:167],v6,53248
M v[188:191],a[172:175],a[92:95],v[188:191]
M v[184:187],a[172:175],a[84:87],v[184:187]
M v[184:187],a[168:171],a[80:83],v[184:187]
M v[180:183],a[168:171],a[72:75],v[180:183]
M v[180:183],a[172:175],a[76:79],v[180:183]
s_nop 0
T a[148:149],v3,24576
T a[150:151],v3,25600
M v[176:179],a[172:175],a[68:71],v[176:179]
buffer_load_dwordx4 v9, s[16:19], s21 offen offset:1024   lds
M v[176:179],a[168:171],a[64:67],v[176:179]
M v[172:175],a[168:171],a[56:59],v[172:175]
M v[172:175],a[172:175],a[60:63],v[172:175]
M v[168:171],a[172:175],a[52:55],v[168:171]
M v[168:171],a[168:171],a[48:51],v[168:171]
M v[164:167],a[168:171],a[40:43],v[164:167]
s_nop 0
T a[152:153],v4,16384
T a[154:155],v4,17408
M v[164:167],a[172:175],a[44:47],v[164:167]
s_waitcnt lgkmcnt(4)
buffer_load_dwordx4 v10, s[16:19], s21 offen offset:2048   lds
M v[160:163],a[172:175],a[36:39],v[160:163]
M v[160:163],a[168:171],a[32:35],v[160:163]
M v[192:195],a[160:163],a[32:35],v[192:195]
R a[168:171],v5,55296
R a[172:175],v6,55296
M v[192:195],a[164:167],a[36:39],v[192:195]
M v[196:199],a[164:167],a[44:47],v[196:199]
M v[196:199],a[160:163],a[40:43],v[196:199]
s_nop 0
T a[156:157],v4,24576
T a[158:159],v4,25600
M v[200:203],a[160:163],a[48:51],v[200:203]
buffer_load_dwordx4 v11, s[16:19], s21 offen offset:3072   lds
M v[200:203],a[164:167],a[52:55],v[200:203]
SA s21,s21,128
M v[204:207],a[164:167],a[60:63],v[204:207]
M v[204:207],a[160:163],a[56:59],v[204:207]
M v[208:211],a[160:163],a[64:67],v[208:211]
M v[208:211],a[164:167],a[68:71],v[208:211]
M v[212:215],a[164:167],a[76:79],v[212:215]
M v[212:215],a[160:163],a[72:75],v[212:215]
M v[216:219],a[160:163],a[80:83],v[216:219]
M v[216:219],a[164:167],a[84:87],v[216:219]
s_waitcnt lgkmcnt(2)
M v[220:223],a[164:167],a[92:95],v[220:223]
s_waitcnt vmcnt(16) lgkmcnt(0)
M v[220:223],a[160:163],a[88:91],v[220:223]
s_barrier
M v[252:255],a[168:171],a[88:91],v[252:255]
R a[160:163],v5,0
R a[164:167],v6,0
M v[252:255],a[172:175],a[92:95],v[252:255]
buffer_load_dword a240, v23, s[52:55], 0 offen offset:0
M v[248:251],a[172:175],a[84:87],v[248:251]
v_add_u32 v23, 32768, v23
M v[248:251],a[168:171],a[80:83],v[248:251]
M v[244:247],a[168:171],a[72:75],v[244:247]
M v[244:247],a[172:175],a[76:79],v[244:247]
M v[240:243],a[172:175],a[68:71],v[240:243]
M v[240:243],a[168:171],a[64:67],v[240:243]
M v[236:239],a[168:171],a[56:59],v[236:239]
M v[236:239],a[172:175],a[60:63],v[236:239]
M v[232:235],a[172:175],a[52:55],v[232:235]
M v[232:235],a[168:171],a[48:51],v[232:235]
M v[228:231],a[168:171],a[40:43],v[228:231]
M v[228:231],a[172:175],a[44:47],v[228:231]
s_waitcnt lgkmcnt(0)
M v[224:227],a[172:175],a[36:39],v[224:227]
M v[224:227],a[168:171],a[32:35],v[224:227]
M a[0:3],a[160:163],a[96:99],a[0:3]
R a[168:171],v5,2048
R a[172:175],v6,2048
M a[0:3],a[164:167],a[100:103],a[0:3]
T a[32:33],v1,32768
T a[34:35],v1,33792
M a[4:7],a[164:167],a[108:111],a[4:7]
SA m0,s24,49152
M a[4:7],a[160:163],a[104:107],a[4:7]
buffer_load_dwordx4 v12, s[48:51], s22 offen offset:0   lds
M a[8:11],a[160:163],a[112:115],a[8:11]
M a[8:11],a[164:167],a[116:119],a[8:11]
M a[12:15],a[164:167],a[124:127],a[12:15]
s_nop 0
T a[36:37],v1,40960
T a[38:39],v1,41984
M a[12:15],a[160:163],a[120:123],a[12:15]
M a[16:19],a[160:163],a[128:131],a[16:19]
buffer_load_dwordx4 v13, s[48:51], s22 offen offset:1024   lds
M a[16:19],a[164:167],a[132:135],a[16:19]
M a[20:23],a[164:167],a[140:143],a[20:23]
M a[20:23],a[160:163],a[136:139],a[20:23]
s_nop 0
T a[40:41],v2,32768
T a[42:43],v2,33792
M a[24:27],a[160:163],a[144:147],a[24:27]
M a[24:27],a[164:167],a[148:151],a[24:27]
s_waitcnt lgkmcnt(6)
buffer_load_dwordx4 v14, s[48:51], s22 offen offset:2048   lds
M a[28:31],a[164:167],a[156:159],a[28:31]
M a[28:31],a[160:163],a[152:155],a[28:31]
M v[60:63],a[168:171],a[152:155],v[60:63]
R a[160:163],v5,4096
R a[164:167],v6,4096
M v[60:63],a[172:175],a[156:159],v[60:63]
T a[44:45],v2,40960
T a[46:47],v2,41984
M v[56:59],a[172:175],a[148:151],v[56:59]
buffer_load_dwordx4 v15, s[48:51], s22 offen offset:3072   lds
M v[56:59],a[168:171],a[144:147],v[56:59]
s_sub_u32 s22, s22, 1048448
M v[52:55],a[168:171],a[136:139],v[52:55]
M v[52:55],a[172:175],a[140:143],v[52:55]
s_nop 0
T a[48:49],v3,32768
T a[50:51],v3,33792
M v[48:51],a[172:175],a[132:135],v[48:51]
SA m0,s23,16384
M v[48:51],a[168:171],a[128:131],v[48:51]
buffer_load_dwordx4 v8, s[16:19], s21 offen offset:0   lds
M v[44:47],a[168:171],a[120:123],v[44:47]
M v[44:47],a[172:175],a[124:127],v[44:47]
M v[40:43],a[172:175],a[116:119],v[40:43]
s_nop 0
T a[52:53],v3,40960
T a[54:55],v3,41984
M v[40:43],a[168:171],a[112:115],v[40:43]
M v[36:39],a[168:171],a[104:107],v[36:39]
buffer_load_dwordx4 v9, s[16:19], s21 offen offset:1024   lds
M v[36:39],a[172:175],a[108:111],v[36:39]
s_waitcnt lgkmcnt(6)
M v[32:35],a[172:175],a[100:103],v[32:35]
M v[32:35],a[168:171],a[96:99],v[32:35]
s_nop 0
T a[56:57],v4,32768
T a[58:59],v4,33792
M v[64:67],a[160:163],a[96:99],v[64:67]
R a[168:171],v5,6144
R a[172:175],v6,6144
M v[64:67],a[164:167],a[100:103],v[64:67]
buffer_load_dwordx4 v10, s[16:19], s21 offen offset:2048   lds
M v[68:71],a[164:167],a[108:111],v[68:71]
M v[68:71],a[160:163],a[104:107],v[68:71]
M v[72:75],a[160:163],a[112:115],v[72:75]
s_nop 0
T a[60:61],v4,40960
T a[62:63],v4,41984
M v[72:75],a[164:167],a[116:119],v[72:75]
M v[76:79],a[164:167],a[124:127],v[76:79]
buffer_load_dwordx4 v11, s[16:19], s21 offen offset:3072   lds
M v[76:79],a[160:163],a[120:123],v[76:79]
SA s21,s21,524160
M v[80:83],a[160:163],a[128:131],v[80:83]
M v[80:83],a[164:167],a[132:135],v[80:83]
M v[84:87],a[164:167],a[140:143],v[84:87]
M v[84:87],a[160:163],a[136:139],v[84:87]
M v[88:91],a[160:163],a[144:147],v[88:91]
M v[88:91],a[164:167],a[148:151],v[88:91]
s_waitcnt lgkmcnt(2)
M v[92:95],a[164:167],a[156:159],v[92:95]
s_waitcnt vmcnt(17) lgkmcnt(0)
M v[92:95],a[160:163],a[152:155],v[92:95]
s_barrier
M v[124:127],a[168:171],a[152:155],v[124:127]
R a[160:163],v5,16384
R a[164:167],v6,16384
M v[124:127],a[172:175],a[156:159],v[124:127]
M v[120:123],a[172:175],a[148:151],v[120:123]
SA m0,s24,0
T a[64:65],v1,49152
T a[66:67],v1,50176
M v[120:123],a[168:171],a[144:147],v[120:123]
buffer_load_dwordx4 v12, s[48:51], s22 offen offset:0   lds
M v[116:119],a[168:171],a[136:139],v[116:119]
M v[116:119],a[172:175],a[140:143],v[116:119]
M v[112:115],a[172:175],a[132:135],v[112:115]
M v[112:115],a[168:171],a[128:131],v[112:115]
M v[108:111],a[168:171],a[120:123],v[108:111]
M v[108:111],a[172:175],a[124:127],v[108:111]
s_nop 0
T a[68:69],v1,57344
T a[70:71],v1,58368
M v[104:107],a[172:175],a[116:119],v[104:107]
buffer_load_dwordx4 v13, s[48:51], s22 offen offset:1024   lds
M v[104:107],a[168:171],a[112:115],v[104:107]
M v[100:103],a[168:171],a[104:107],v[100:103]
M v[100:103],a[172:175],a[108:111],v[100:103]
s_waitcnt lgkmcnt(4)
M v[96:99],a[172:175],a[100:103],v[96:99]
M v[96:99],a[168:171],a[96:99],v[96:99]
L_w_kv14:
s_cbranch_execz L_w_kv18
M v[128:131],a[160:163],a[96:99],v[128:131]
R a[168:171],v5,18432
R a[172:175],v6,18432
M v[128:131],a[164:167],a[100:103],v[128:131]
T a[72:73],v2,49152
T a[74:75],v2,50176
M v[132:135],a[164:167],a[108:111],v[132:135]
buffer_load_dwordx4 v14, s[48:51], s22 offen offset:2048   lds
M v[132:135],a[160:163],a[104:107],v[132:135]
M v[136:139],a[160:163],a[112:115],v[136:139]
M v[136:139],a[164:167],a[116:119],v[136:139]
M v[140:143],a[164:167],a[124:127],v[140:143]
M v[140:143],a[160:163],a[120:123],v[140:143]
s_nop 0
T a[76:77],v2,57344
T a[78:79],v2,58368
M v[144:147],a[160:163],a[128:131],v[144:147]
buffer_load_dwordx4 v15, s[48:51], s22 offen offset:3072   lds
M v[144:147],a[164:167],a[132:135],v[144:147]
SA s22,s22,1048576
M v[148:151],a[164:167],a[140:143],v[148:151]
M v[148:151],a[160:163],a[136:139],v[148:151]
M v[152:155],a[160:163],a[144:147],v[152:155]
M v[152:155],a[164:167],a[148:151],v[152:155]
s_waitcnt lgkmcnt(4)
M v[156:159],a[164:167],a[156:159],v[156:159]
SA m0,s23,32768
T a[80:81],v3,49152
T a[82:83],v3,50176
M v[156:159],a[160:163],a[152:155],v[156:159]
buffer_load_dwordx4 v8, s[16:19], s21 offen offset:0   lds
M v[188:191],a[168:171],a[152:155],v[188:191]
R a[160:163],v5,20480
R a[164:167],v6,20480
M v[188:191],a[172:175],a[156:159],v[188:191]
M v[184:187],a[172:175],a[148:151],v[184:187]
M v[184:187],a[168:171],a[144:147],v[184:187]
M v[180:183],a[168:171],a[136:139],v[180:183]
M v[180:183],a[172:175],a[140:143],v[180:183]
s_nop 0
T a[84:85],v3,57344
T a[86:87],v3,58368
M v[176:179],a[172:175],a[132:135],v[176:179]
buffer_load_dwordx4 v9, s[16:19], s21 offen offset:1024   lds
M v[176:179],a[168:171],a[128:131],v[176:179]
M v[172:175],a[168:171],a[120:123],v[172:175]
M v[172:175],a[172:175],a[124:127],v[172:175]
M v[168:171],a[172:175],a[116:119],v[168:171]
M v[168:171],a[168:171],a[112:115],v[168:171]
M v[164:167],a[168:171],a[104:107],v[164:167]
s_nop 0
T a[88:89],v4,49152
T a[90:91],v4,50176
M v[164:167],a[172:175],a[108:111],v[164:167]
s_waitcnt lgkmcnt(4)
buffer_load_dwordx4 v10, s[16:19], s21 offen offset:2048   lds
M v[160:163],a[172:175],a[100:103],v[160:163]
M v[160:163],a[168:171],a[96:99],v[160:163]
M v[192:195],a[160:163],a[96:99],v[192:195]
R a[168:171],v5,22528
R a[172:175],v6,22528
M v[192:195],a[164:167],a[100:103],v[192:195]
M v[196:199],a[164:167],a[108:111],v[196:199]
M v[196:199],a[160:163],a[104:107],v[196:199]
s_nop 0
T a[92:93],v4,57344
T a[94:95],v4,58368
M v[200:203],a[160:163],a[112:115],v[200:203]
buffer_load_dwordx4 v11, s[16:19], s21 offen offset:3072   lds
M v[200:203],a[164:167],a[116:119],v[200:203]
SA s21,s21,128
M v[204:207],a[164:167],a[124:127],v[204:207]
M v[204:207],a[160:163],a[120:123],v[204:207]
M v[208:211],a[160:163],a[128:131],v[208:211]
M v[208:211],a[164:167],a[132:135],v[208:211]
M v[212:215],a[164:167],a[140:143],v[212:215]
M v[212:215],a[160:163],a[136:139],v[212:215]
M v[216:219],a[160:163],a[144:147],v[216:219]
M v[216:219],a[164:167],a[148:151],v[216:219]
s_waitcnt lgkmcnt(2)
M v[220:223],a[164:167],a[156:159],v[220:223]
s_waitcnt vmcnt(17) lgkmcnt(0)
M v[220:223],a[160:163],a[152:155],v[220:223]
s_barrier
M v[252:255],a[168:171],a[152:155],v[252:255]
R a[160:163],v5,32768
R a[164:167],v6,32768
M v[252:255],a[172:175],a[156:159],v[252:255]
buffer_load_dword a240, v23, s[52:55], 0 offen offset:0
M v[248:251],a[172:175],a[148:151],v[248:251]
v_add_u32 v23, 32768, v23
M v[248:251],a[168:171],a[144:147],v[248:251]
M v[244:247],a[168:171],a[136:139],v[244:247]
M v[244:247],a[172:175],a[140:143],v[244:247]
M v[240:243],a[172:175],a[132:135],v[240:243]
M v[240:243],a[168:171],a[128:131],v[240:243]
M v[236:239],a[168:171],a[120:123],v[236:239]
M v[236:239],a[172:175],a[124:127],v[236:239]
M v[232:235],a[172:175],a[116:119],v[232:235]
M v[232:235],a[168:171],a[112:115],v[232:235]
M v[228:231],a[168:171],a[104:107],v[228:231]
M v[228:231],a[172:175],a[108:111],v[228:231]
s_waitcnt lgkmcnt(0)
M v[224:227],a[172:175],a[100:103],v[224:227]
M v[224:227],a[168:171],a[96:99],v[224:227]
M a[0:3],a[160:163],a[32:35],a[0:3]
R a[168:171],v5,34816
R a[172:175],v6,34816
M a[0:3],a[164:167],a[36:39],a[0:3]
T a[96:97],v1,0
T a[98:99],v1,1024
M a[4:7],a[164:167],a[44:47],a[4:7]
SA m0,s24,16384
M a[4:7],a[160:163],a[40:43],a[4:7]
buffer_load_dwordx4 v12, s[48:51], s22 offen offset:0   lds
M a[8:11],a[160:163],a[48:51],a[8:11]
M a[8:11],a[164:167],a[52:55],a[8:11]
M a[12:15],a[164:167],a[60:63],a[12:15]
s_nop 0
T a[100:101],v1,8192
T a[102:103],v1,9216
M a[12:15],a[160:163],a[56:59],a[12:15]
M a[16:19],a[160:163],a[64:67],a[16:19]
buffer_load_dwordx4 v13, s[48:51], s22 offen offset:1024   lds
M a[16:19],a[164:167],a[68:71],a[16:19]
M a[20:23],a[164:167],a[76:79],a[20:23]
M a[20:23],a[160:163],a[72:75],a[20:23]
s_nop 0
T a[104:105],v2,0
T a[106:107],v2,1024
M a[24:27],a[160:163],a[80:83],a[24:27]
M a[24:27],a[164:167],a[84:87],a[24:27]
s_waitcnt lgkmcnt(6)
buffer_load_dwordx4 v14, s[48:51], s22 offen offset:2048   lds
M a[28:31],a[164:167],a[92:95],a[28:31]
M a[28:31],a[160:163],a[88:91],a[28:31]
M v[60:63],a[168:171],a[88:91],v[60:63]
R a[160:163],v5,36864
R a[164:167],v6,36864
M v[60:63],a[172:175],a[92:95],v[60:63]
T a[108:109],v2,8192
T a[110:111],v2,9216
M v[56:59],a[172:175],a[84:87],v[56:59]
buffer_load_dwordx4 v15, s[48:51], s22 offen offset:3072   lds
M v[56:59],a[168:171],a[80:83],v[56:59]
s_sub_u32 s22, s22, 1048448
M v[52:55],a[168:171],a[72:75],v[52:55]
M v[52:55],a[172:175],a[76:79],v[52:55]
s_nop 0
T a[112:113],v3,0
T a[114:115],v3,1024
M v[48:51],a[172:175],a[68:71],v[48:51]
SA m0,s23,49152
M v[48:51],a[168:171],a[64:67],v[48:51]
buffer_load_dwordx4 v8, s[16:19], s21 offen offset:0   lds
M v[44:47],a[168:171],a[56:59],v[44:47]
M v[44:47],a[172:175],a[60:63],v[44:47]
M v[40:43],a[172:175],a[52:55],v[40:43]
s_nop 0
T a[116:117],v3,8192
T a[118:119],v3,9216
M v[40:43],a[168:171],a[48:51],v[40:43]
M v[36:39],a[168:171],a[40:43],v[36:39]
buffer_load_dwordx4 v9, s[16:19], s21 offen offset:1024   lds
M v[36:39],a[172:175],a[44:47],v[36:39]
s_waitcnt lgkmcnt(6)
M v[32:35],a[172:175],a[36:39],v[32:35]
M v[32:35],a[168:171],a[32:35],v[32:35]
s_nop 0
T a[120:121],v4,0
T a[122:123],v4,1024
M v[64:67],a[160:163],a[32:35],v[64:67]
R a[168:171],v5,38912
R a[172:175],v6,38912
M v[64:67],a[164:167],a[36:39],v[64:67]
buffer_load_dwordx4 v10, s[16:19], s21 offen offset:2048   lds
M v[68:71],a[164:167],a[44:47],v[68:71]
M v[68:71],a[160:163],a[40:43],v[68:71]
M v[72:75],a[160:163],a[48:51],v[72:75]
s_nop 0
T a[124:125],v4,8192
T a[126:127],v4,9216
M v[72:75],a[164:167],a[52:55],v[72:75]
M v[76:79],a[164:167],a[60:63],v[76:79]
buffer_load_dwordx4 v11, s[16:19], s21 offen offset:3072   lds
M v[76:79],a[160:163],a[56:59],v[76:79]
SA s21,s21,524160
M v[80:83],a[160:163],a[64:67],v[80:83]
M v[80:83],a[164:167],a[68:71],v[80:83]
M v[84:87],a[164:167],a[76:79],v[84:87]
M v[84:87],a[160:163],a[72:75],v[84:87]
M v[88:91],a[160:163],a[80:83],v[88:91]
M v[88:91],a[164:167],a[84:87],v[88:91]
s_waitcnt lgkmcnt(2)
M v[92:95],a[164:167],a[92:95],v[92:95]
s_waitcnt vmcnt(17) lgkmcnt(0)
M v[92:95],a[160:163],a[88:91],v[92:95]
s_barrier
M v[124:127],a[168:171],a[88:91],v[124:127]
R a[160:163],v5,49152
R a[164:167],v6,49152
M v[124:127],a[172:175],a[92:95],v[124:127]
M v[120:123],a[172:175],a[84:87],v[120:123]
SA m0,s24,32768
T a[128:129],v1,16384
T a[130:131],v1,17408
M v[120:123],a[168:171],a[80:83],v[120:123]
buffer_load_dwordx4 v12, s[48:51], s22 offen offset:0   lds
M v[116:119],a[168:171],a[72:75],v[116:119]
M v[116:119],a[172:175],a[76:79],v[116:119]
M v[112:115],a[172:175],a[68:71],v[112:115]
M v[112:115],a[168:171],a[64:67],v[112:115]
M v[108:111],a[168:171],a[56:59],v[108:111]
M v[108:111],a[172:175],a[60:63],v[108:111]
s_nop 0
T a[132:133],v1,24576
T a[134:135],v1,25600
M v[104:107],a[172:175],a[52:55],v[104:107]
buffer_load_dwordx4 v13, s[48:51], s22 offen offset:1024   lds
M v[104:107],a[168:171],a[48:51],v[104:107]
M v[100:103],a[168:171],a[40:43],v[100:103]
M v[100:103],a[172:175],a[44:47],v[100:103]
s_waitcnt lgkmcnt(4)
M v[96:99],a[172:175],a[36:39],v[96:99]
M v[96:99],a[168:171],a[32:35],v[96:99]
M v[128:131],a[160:163],a[32:35],v[128:131]
R a[168:171],v5,51200
R a[172:175],v6,51200
M v[128:131],a[164:167],a[36:39],v[128:131]
T a[136:137],v2,16384
T a[138:139],v2,17408
M v[132:135],a[164:167],a[44:47],v[132:135]
buffer_load_dwordx4 v14, s[48:51], s22 offen offset:2048   lds
M v[132:135],a[160:163],a[40:43],v[132:135]
M v[136:139],a[160:163],a[48:51],v[136:139]
M v[136:139],a[164:167],a[52:55],v[136:139]
M v[140:143],a[164:167],a[60:63],v[140:143]
M v[140:143],a[160:163],a[56:59],v[140:143]
s_nop 0
T a[140:141],v2,24576
T a[142:143],v2,25600
M v[144:147],a[160:163],a[64:67],v[144:147]
buffer_load_dwordx4 v15, s[48:51], s22 offen offset:3072   lds
M v[144:147],a[164:167],a[68:71],v[144:147]
SA s22,s22,1048576
M v[148:151],a[164:167],a[76:79],v[148:151]
M v[148:151],a[160:163],a[72:75],v[148:151]
M v[152:155],a[160:163],a[80:83],v[152:155]
M v[152:155],a[164:167],a[84:87],v[152:155]
s_waitcnt lgkmcnt(4)
M v[156:159],a[164:167],a[92:95],v[156:159]
SA m0,s23,0
T a[144:145],v3,16384
T a[146:147],v3,17408
M v[156:159],a[160:163],a[88:91],v[156:159]
buffer_load_dwordx4 v8, s[16:19], s21 offen offset:0   lds
M v[188:191],a[168:171],a[88:91],v[188:191]
R a[160:163],v5,53248
R a[164:167],v6,53248
M v[188:191],a[172:175],a[92:95],v[188:191]
M v[184:187],a[172:175],a[84:87],v[184:187]
M v[184:187],a[168:171],a[80:83],v[184:187]
M v[180:183],a[168:171],a[72:75],v[180:183]
M v[180:183],a[172:175],a[76:79],v[180:183]
s_nop 0
T a[148:149],v3,24576
T a[150:151],v3,25600
M v[176:179],a[172:175],a[68:71],v[176:179]
buffer_load_dwordx4 v9, s[16:19], s21 offen offset:1024   lds
M v[176:179],a[168:171],a[64:67],v[176:179]
M v[172:175],a[168:171],a[56:59],v[172:175]
M v[172:175],a[172:175],a[60:63],v[172:175]
M v[168:171],a[172:175],a[52:55],v[168:171]
M v[168:171],a[168:171],a[48:51],v[168:171]
M v[164:167],a[168:171],a[40:43],v[164:167]
s_nop 0
T a[152:153],v4,16384
T a[154:155],v4,17408
M v[164:167],a[172:175],a[44:47],v[164:167]
s_waitcnt lgkmcnt(4)
buffer_load_dwordx4 v10, s[16:19], s21 offen offset:2048   lds
M v[160:163],a[172:175],a[36:39],v[160:163]
M v[160:163],a[168:171],a[32:35],v[160:163]
M v[192:195],a[160:163],a[32:35],v[192:195]
R a[168:171],v5,55296
R a[172:175],v6,55296
M v[192:195],a[164:167],a[36:39],v[192:195]
M v[196:199],a[164:167],a[44:47],v[196:199]
M v[196:199],a[160:163],a[40:43],v[196:199]
s_nop 0
T a[156:157],v4,24576
T a[158:159],v4,25600
M v[200:203],a[160:163],a[48:51],v[200:203]
buffer_load_dwordx4 v11, s[16:19], s21 offen offset:3072   lds
M v[200:203],a[164:167],a[52:55],v[200:203]
SA s21,s21,128
M v[204:207],a[164:167],a[60:63],v[204:207]
M v[204:207],a[160:163],a[56:59],v[204:207]
M v[208:211],a[160:163],a[64:67],v[208:211]
M v[208:211],a[164:167],a[68:71],v[208:211]
M v[212:215],a[164:167],a[76:79],v[212:215]
M v[212:215],a[160:163],a[72:75],v[212:215]
M v[216:219],a[160:163],a[80:83],v[216:219]
M v[216:219],a[164:167],a[84:87],v[216:219]
s_waitcnt lgkmcnt(2)
M v[220:223],a[164:167],a[92:95],v[220:223]
s_waitcnt vmcnt(17) lgkmcnt(0)
M v[220:223],a[160:163],a[88:91],v[220:223]
s_barrier
M v[252:255],a[168:171],a[88:91],v[252:255]
R a[160:163],v5,0
R a[164:167],v6,0
M v[252:255],a[172:175],a[92:95],v[252:255]
buffer_load_dword a240, v23, s[52:55], 0 offen offset:0
M v[248:251],a[172:175],a[84:87],v[248:251]
v_add_u32 v23, 16384, v23
M v[248:251],a[168:171],a[80:83],v[248:251]
M v[244:247],a[168:171],a[72:75],v[244:247]
M v[244:247],a[172:175],a[76:79],v[244:247]
M v[240:243],a[172:175],a[68:71],v[240:243]
M v[240:243],a[168:171],a[64:67],v[240:243]
M v[236:239],a[168:171],a[56:59],v[236:239]
M v[236:239],a[172:175],a[60:63],v[236:239]
M v[232:235],a[172:175],a[52:55],v[232:235]
M v[232:235],a[168:171],a[48:51],v[232:235]
M v[228:231],a[168:171],a[40:43],v[228:231]
M v[228:231],a[172:175],a[44:47],v[228:231]
s_waitcnt lgkmcnt(0)
M v[224:227],a[172:175],a[36:39],v[224:227]
M v[224:227],a[168:171],a[32:35],v[224:227]
M a[0:3],a[160:163],a[96:99],a[0:3]
R a[168:171],v5,2048
R a[172:175],v6,2048
M a[0:3],a[164:167],a[100:103],a[0:3]
T a[32:33],v1,32768
T a[34:35],v1,33792
M a[4:7],a[164:167],a[108:111],a[4:7]
SA m0,s24,49152
M a[4:7],a[160:163],a[104:107],a[4:7]
buffer_load_dwordx4 v12, s[48:51], s22 offen offset:0   lds
M a[8:11],a[160:163],a[112:115],a[8:11]
M a[8:11],a[164:167],a[116:119],a[8:11]
M a[12:15],a[164:167],a[124:127],a[12:15]
s_nop 0
T a[36:37],v1,40960
T a[38:39],v1,41984
M a[12:15],a[160:163],a[120:123],a[12:15]
M a[16:19],a[160:163],a[128:131],a[16:19]
buffer_load_dwordx4 v13, s[48:51], s22 offen offset:1024   lds
M a[16:19],a[164:167],a[132:135],a[16:19]
M a[20:23],a[164:167],a[140:143],a[20:23]
M a[20:23],a[160:163],a[136:139],a[20:23]
s_nop 0
T a[40:41],v2,32768
T a[42:43],v2,33792
M a[24:27],a[160:163],a[144:147],a[24:27]
M a[24:27],a[164:167],a[148:151],a[24:27]
s_waitcnt lgkmcnt(6)
buffer_load_dwordx4 v14, s[48:51], s22 offen offset:2048   lds
M a[28:31],a[164:167],a[156:159],a[28:31]
M a[28:31],a[160:163],a[152:155],a[28:31]
M v[60:63],a[168:171],a[152:155],v[60:63]
R a[160:163],v5,4096
R a[164:167],v6,4096
M v[60:63],a[172:175],a[156:159],v[60:63]
T a[44:45],v2,40960
T a[46:47],v2,41984
M v[56:59],a[172:175],a[148:151],v[56:59]
buffer_load_dwordx4 v15, s[48:51], s22 offen offset:3072   lds
M v[56:59],a[168:171],a[144:147],v[56:59]
s_sub_u32 s22, s22, 1048448
M v[52:55],a[168:171],a[136:139],v[52:55]
M v[52:55],a[172:175],a[140:143],v[52:55]
s_nop 0
T a[48:49],v3,32768
T a[50:51],v3,33792
M v[48:51],a[172:175],a[132:135],v[48:51]
SA m0,s23,16384
M v[48:51],a[168:171],a[128:131],v[48:51]
buffer_load_dwordx4 v8, s[16:19], s21 offen offset:0   lds
M v[44:47],a[168:171],a[120:123],v[44:47]
M v[44:47],a[172:175],a[124:127],v[44:47]
M v[40:43],a[172:175],a[116:119],v[40:43]
s_nop 0
T a[52:53],v3,40960
T a[54:55],v3,41984
M v[40:43],a[168:171],a[112:115],v[40:43]
M v[36:39],a[168:171],a[104:107],v[36:39]
buffer_load_dwordx4 v9, s[16:19], s21 offen offset:1024   lds
M v[36:39],a[172:175],a[108:111],v[36:39]
s_waitcnt lgkmcnt(6)
M v[32:35],a[172:175],a[100:103],v[32:35]
M v[32:35],a[168:171],a[96:99],v[32:35]
s_nop 0
T a[56:57],v4,32768
T a[58:59],v4,33792
M v[64:67],a[160:163],a[96:99],v[64:67]
R a[168:171],v5,6144
R a[172:175],v6,6144
M v[64:67],a[164:167],a[100:103],v[64:67]
buffer_load_dwordx4 v10, s[16:19], s21 offen offset:2048   lds
M v[68:71],a[164:167],a[108:111],v[68:71]
M v[68:71],a[160:163],a[104:107],v[68:71]
M v[72:75],a[160:163],a[112:115],v[72:75]
s_nop 0
T a[60:61],v4,40960
T a[62:63],v4,41984
M v[72:75],a[164:167],a[116:119],v[72:75]
M v[76:79],a[164:167],a[124:127],v[76:79]
buffer_load_dwordx4 v11, s[16:19], s21 offen offset:3072   lds
M v[76:79],a[160:163],a[120:123],v[76:79]
SA s21,s21,524160
M v[80:83],a[160:163],a[128:131],v[80:83]
M v[80:83],a[164:167],a[132:135],v[80:83]
M v[84:87],a[164:167],a[140:143],v[84:87]
M v[84:87],a[160:163],a[136:139],v[84:87]
M v[88:91],a[160:163],a[144:147],v[88:91]
M v[88:91],a[164:167],a[148:151],v[88:91]
s_waitcnt lgkmcnt(2)
M v[92:95],a[164:167],a[156:159],v[92:95]
s_waitcnt vmcnt(17) lgkmcnt(0)
M v[92:95],a[160:163],a[152:155],v[92:95]
s_barrier
M v[124:127],a[168:171],a[152:155],v[124:127]
R a[160:163],v5,16384
R a[164:167],v6,16384
M v[124:127],a[172:175],a[156:159],v[124:127]
M v[120:123],a[172:175],a[148:151],v[120:123]
SA m0,s24,0
T a[64:65],v1,49152
T a[66:67],v1,50176
M v[120:123],a[168:171],a[144:147],v[120:123]
buffer_load_dwordx4 v12, s[48:51], s22 offen offset:0   lds
M v[116:119],a[168:171],a[136:139],v[116:119]
M v[116:119],a[172:175],a[140:143],v[116:119]
M v[112:115],a[172:175],a[132:135],v[112:115]
M v[112:115],a[168:171],a[128:131],v[112:115]
M v[108:111],a[168:171],a[120:123],v[108:111]
M v[108:111],a[172:175],a[124:127],v[108:111]
s_nop 0
T a[68:69],v1,57344
T a[70:71],v1,58368
M v[104:107],a[172:175],a[116:119],v[104:107]
buffer_load_dwordx4 v13, s[48:51], s22 offen offset:1024   lds
M v[104:107],a[168:171],a[112:115],v[104:107]
M v[100:103],a[168:171],a[104:107],v[100:103]
M v[100:103],a[172:175],a[108:111],v[100:103]
s_waitcnt lgkmcnt(4)
M v[96:99],a[172:175],a[100:103],v[96:99]
M v[96:99],a[168:171],a[96:99],v[96:99]
M v[128:131],a[160:163],a[96:99],v[128:131]
R a[168:171],v5,18432
R a[172:175],v6,18432
M v[128:131],a[164:167],a[100:103],v[128:131]
T a[72:73],v2,49152
T a[74:75],v2,50176
M v[132:135],a[164:167],a[108:111],v[132:135]
buffer_load_dwordx4 v14, s[48:51], s22 offen offset:2048   lds
M v[132:135],a[160:163],a[104:107],v[132:135]
M v[136:139],a[160:163],a[112:115],v[136:139]
M v[136:139],a[164:167],a[116:119],v[136:139]
M v[140:143],a[164:167],a[124:127],v[140:143]
M v[140:143],a[160:163],a[120:123],v[140:143]
s_nop 0
T a[76:77],v2,57344
T a[78:79],v2,58368
M v[144:147],a[160:163],a[128:131],v[144:147]
buffer_load_dwordx4 v15, s[48:51], s22 offen offset:3072   lds
M v[144:147],a[164:167],a[132:135],v[144:147]
SA s22,s22,1048576
M v[148:151],a[164:167],a[140:143],v[148:151]
M v[148:151],a[160:163],a[136:139],v[148:151]
M v[152:155],a[160:163],a[144:147],v[152:155]
M v[152:155],a[164:167],a[148:151],v[152:155]
s_waitcnt lgkmcnt(4)
M v[156:159],a[164:167],a[156:159],v[156:159]
SA m0,s23,32768
T a[80:81],v3,49152
T a[82:83],v3,50176
M v[156:159],a[160:163],a[152:155],v[156:159]
buffer_load_dwordx4 v8, s[16:19], s21 offen offset:0   lds
M v[188:191],a[168:171],a[152:155],v[188:191]
R a[160:163],v5,20480
R a[164:167],v6,20480
M v[188:191],a[172:175],a[156:159],v[188:191]
M v[184:187],a[172:175],a[148:151],v[184:187]
M v[184:187],a[168:171],a[144:147],v[184:187]
M v[180:183],a[168:171],a[136:139],v[180:183]
M v[180:183],a[172:175],a[140:143],v[180:183]
s_nop 0
T a[84:85],v3,57344
T a[86:87],v3,58368
M v[176:179],a[172:175],a[132:135],v[176:179]
buffer_load_dwordx4 v9, s[16:19], s21 offen offset:1024   lds
M v[176:179],a[168:171],a[128:131],v[176:179]
M v[172:175],a[168:171],a[120:123],v[172:175]
M v[172:175],a[172:175],a[124:127],v[172:175]
M v[168:171],a[172:175],a[116:119],v[168:171]
M v[168:171],a[168:171],a[112:115],v[168:171]
M v[164:167],a[168:171],a[104:107],v[164:167]
s_nop 0
T a[88:89],v4,49152
T a[90:91],v4,50176
M v[164:167],a[172:175],a[108:111],v[164:167]
s_waitcnt lgkmcnt(4)
buffer_load_dwordx4 v10, s[16:19], s21 offen offset:2048   lds
M v[160:163],a[172:175],a[100:103],v[160:163]
M v[160:163],a[168:171],a[96:99],v[160:163]
M v[192:195],a[160:163],a[96:99],v[192:195]
R a[168:171],v5,22528
R a[172:175],v6,22528
M v[192:195],a[164:167],a[100:103],v[192:195]
M v[196:199],a[164:167],a[108:111],v[196:199]
M v[196:199],a[160:163],a[104:107],v[196:199]
s_nop 0
T a[92:93],v4,57344
T a[94:95],v4,58368
M v[200:203],a[160:163],a[112:115],v[200:203]
buffer_load_dwordx4 v11, s[16:19], s21 offen offset:3072   lds
M v[200:203],a[164:167],a[116:119],v[200:203]
SA s21,s21,128
M v[204:207],a[164:167],a[124:127],v[204:207]
M v[204:207],a[160:163],a[120:123],v[204:207]
M v[208:211],a[160:163],a[128:131],v[208:211]
M v[208:211],a[164:167],a[132:135],v[208:211]
M v[212:215],a[164:167],a[140:143],v[212:215]
M v[212:215],a[160:163],a[136:139],v[212:215]
M v[216:219],a[160:163],a[144:147],v[216:219]
M v[216:219],a[164:167],a[148:151],v[216:219]
s_waitcnt lgkmcnt(2)
M v[220:223],a[164:167],a[156:159],v[220:223]
s_waitcnt vmcnt(17) lgkmcnt(0)
M v[220:223],a[160:163],a[152:155],v[220:223]
s_barrier
M v[252:255],a[168:171],a[152:155],v[252:255]
R a[160:163],v5,32768
R a[164:167],v6,32768
M v[252:255],a[172:175],a[156:159],v[252:255]
buffer_load_dword a240, v23, s[52:55], 0 offen offset:0
M v[248:251],a[172:175],a[148:151],v[248:251]
L_w_kv15:
s_cbranch_execz L_wd2
v_add_u32 v23, 16384, v23
M v[248:251],a[168:171],a[144:147],v[248:251]
M v[244:247],a[168:171],a[136:139],v[244:247]
M v[244:247],a[172:175],a[140:143],v[244:247]
M v[240:243],a[172:175],a[132:135],v[240:243]
M v[240:243],a[168:171],a[128:131],v[240:243]
M v[236:239],a[168:171],a[120:123],v[236:239]
M v[236:239],a[172:175],a[124:127],v[236:239]
M v[232:235],a[172:175],a[116:119],v[232:235]
M v[232:235],a[168:171],a[112:115],v[232:235]
M v[228:231],a[168:171],a[104:107],v[228:231]
M v[228:231],a[172:175],a[108:111],v[228:231]
s_waitcnt lgkmcnt(0)
M v[224:227],a[172:175],a[100:103],v[224:227]
M v[224:227],a[168:171],a[96:99],v[224:227]
M a[0:3],a[160:163],a[32:35],a[0:3]
R a[168:171],v5,34816
R a[172:175],v6,34816
M a[0:3],a[164:167],a[36:39],a[0:3]
T a[96:97],v1,0
T a[98:99],v1,1024
M a[4:7],a[164:167],a[44:47],a[4:7]
SA m0,s24,16384
M a[4:7],a[160:163],a[40:43],a[4:7]
buffer_load_dwordx4 v12, s[48:51], s22 offen offset:0   lds
M a[8:11],a[160:163],a[48:51],a[8:11]
M a[8:11],a[164:167],a[52:55],a[8:11]
M a[12:15],a[164:167],a[60:63],a[12:15]
s_nop 0
T a[100:101],v1,8192
T a[102:103],v1,9216
M a[12:15],a[160:163],a[56:59],a[12:15]
M a[16:19],a[160:163],a[64:67],a[16:19]
buffer_load_dwordx4 v13, s[48:51], s22 offen offset:1024   lds
M a[16:19],a[164:167],a[68:71],a[16:19]
M a[20:23],a[164:167],a[76:79],a[20:23]
M a[20:23],a[160:163],a[72:75],a[20:23]
s_nop 0
T a[104:105],v2,0
T a[106:107],v2,1024
M a[24:27],a[160:163],a[80:83],a[24:27]
M a[24:27],a[164:167],a[84:87],a[24:27]
s_waitcnt lgkmcnt(6)
buffer_load_dwordx4 v14, s[48:51], s22 offen offset:2048   lds
M a[28:31],a[164:167],a[92:95],a[28:31]
M a[28:31],a[160:163],a[88:91],a[28:31]
M v[60:63],a[168:171],a[88:91],v[60:63]
R a[160:163],v5,36864
R a[164:167],v6,36864
M v[60:63],a[172:175],a[92:95],v[60:63]
T a[108:109],v2,8192
T a[110:111],v2,9216
M v[56:59],a[172:175],a[84:87],v[56:59]
buffer_load_dwordx4 v15, s[48:51], s22 offen offset:3072   lds
M v[56:59],a[168:171],a[80:83],v[56:59]
s_sub_u32 s22, s22, 1048448
M v[52:55],a[168:171],a[72:75],v[52:55]
M v[52:55],a[172:175],a[76:79],v[52:55]
s_nop 0
T a[112:113],v3,0
T a[114:115],v3,1024
M v[48:51],a[172:175],a[68:71],v[48:51]
SA m0,s23,49152
M v[48:51],a[168:171],a[64:67],v[48:51]
buffer_load_dwordx4 v8, s[16:19], s21 offen offset:0   lds
M v[44:47],a[168:171],a[56:59],v[44:47]
M v[44:47],a[172:175],a[60:63],v[44:47]
M v[40:43],a[172:175],a[52:55],v[40:43]
s_nop 0
T a[116:117],v3,8192
T a[118:119],v3,9216
M v[40:43],a[168:171],a[48:51],v[40:43]
M v[36:39],a[168:171],a[40:43],v[36:39]
buffer_load_dwordx4 v9, s[16:19], s21 offen offset:1024   lds
M v[36:39],a[172:175],a[44:47],v[36:39]
s_waitcnt lgkmcnt(6)
M v[32:35],a[172:175],a[36:39],v[32:35]
M v[32:35],a[168:171],a[32:35],v[32:35]
s_nop 0
T a[120:121],v4,0
T a[122:123],v4,1024
M v[64:67],a[160:163],a[32:35],v[64:67]
R a[168:171],v5,38912
R a[172:175],v6,38912
M v[64:67],a[164:167],a[36:39],v[64:67]
buffer_load_dwordx4 v10, s[16:19], s21 offen offset:2048   lds
M v[68:71],a[164:167],a[44:47],v[68:71]
M v[68:71],a[160:163],a[40:43],v[68:71]
M v[72:75],a[160:163],a[48:51],v[72:75]
s_nop 0
T a[124:125],v4,8192
T a[126:127],v4,9216
M v[72:75],a[164:167],a[52:55],v[72:75]
M v[76:79],a[164:167],a[60:63],v[76:79]
buffer_load_dwordx4 v11, s[16:19], s21 offen offset:3072   lds
M v[76:79],a[160:163],a[56:59],v[76:79]
SA s21,s21,524160
M v[80:83],a[160:163],a[64:67],v[80:83]
M v[80:83],a[164:167],a[68:71],v[80:83]
M v[84:87],a[164:167],a[76:79],v[84:87]
M v[84:87],a[160:163],a[72:75],v[84:87]
M v[88:91],a[160:163],a[80:83],v[88:91]
M v[88:91],a[164:167],a[84:87],v[88:91]
s_waitcnt lgkmcnt(2)
M v[92:95],a[164:167],a[92:95],v[92:95]
s_waitcnt vmcnt(17) lgkmcnt(0)
M v[92:95],a[160:163],a[88:91],v[92:95]
s_barrier
M v[124:127],a[168:171],a[88:91],v[124:127]
R a[160:163],v5,49152
R a[164:167],v6,49152
M v[124:127],a[172:175],a[92:95],v[124:127]
M v[120:123],a[172:175],a[84:87],v[120:123]
SA m0,s24,32768
T a[128:129],v1,16384
T a[130:131],v1,17408
M v[120:123],a[168:171],a[80:83],v[120:123]
buffer_load_dwordx4 v12, s[48:51], s22 offen offset:0   lds
M v[116:119],a[168:171],a[72:75],v[116:119]
M v[116:119],a[172:175],a[76:79],v[116:119]
M v[112:115],a[172:175],a[68:71],v[112:115]
M v[112:115],a[168:171],a[64:67],v[112:115]
M v[108:111],a[168:171],a[56:59],v[108:111]
M v[108:111],a[172:175],a[60:63],v[108:111]
s_nop 0
T a[132:133],v1,24576
T a[134:135],v1,25600
M v[104:107],a[172:175],a[52:55],v[104:107]
buffer_load_dwordx4 v13, s[48:51], s22 offen offset:1024   lds
M v[104:107],a[168:171],a[48:51],v[104:107]
M v[100:103],a[168:171],a[40:43],v[100:103]
M v[100:103],a[172:175],a[44:47],v[100:103]
s_waitcnt lgkmcnt(4)
M v[96:99],a[172:175],a[36:39],v[96:99]
M v[96:99],a[168:171],a[32:35],v[96:99]
M v[128:131],a[160:163],a[32:35],v[128:131]
R a[168:171],v5,51200
R a[172:175],v6,51200
M v[128:131],a[164:167],a[36:39],v[128:131]
T a[136:137],v2,16384
T a[138:139],v2,17408
M v[132:135],a[164:167],a[44:47],v[132:135]
buffer_load_dwordx4 v14, s[48:51], s22 offen offset:2048   lds
M v[132:135],a[160:163],a[40:43],v[132:135]
M v[136:139],a[160:163],a[48:51],v[136:139]
M v[136:139],a[164:167],a[52:55],v[136:139]
M v[140:143],a[164:167],a[60:63],v[140:143]
M v[140:143],a[160:163],a[56:59],v[140:143]
s_nop 0
T a[140:141],v2,24576
T a[142:143],v2,25600
M v[144:147],a[160:163],a[64:67],v[144:147]
buffer_load_dwordx4 v15, s[48:51], s22 offen offset:3072   lds
M v[144:147],a[164:167],a[68:71],v[144:147]
SA s22,s22,1048576
M v[148:151],a[164:167],a[76:79],v[148:151]
M v[148:151],a[160:163],a[72:75],v[148:151]
M v[152:155],a[160:163],a[80:83],v[152:155]
M v[152:155],a[164:167],a[84:87],v[152:155]
s_waitcnt lgkmcnt(4)
M v[156:159],a[164:167],a[92:95],v[156:159]
SA m0,s23,0
T a[144:145],v3,16384
T a[146:147],v3,17408
M v[156:159],a[160:163],a[88:91],v[156:159]
buffer_load_dwordx4 v8, s[16:19], s21 offen offset:0   lds
M v[188:191],a[168:171],a[88:91],v[188:191]
R a[160:163],v5,53248
R a[164:167],v6,53248
M v[188:191],a[172:175],a[92:95],v[188:191]
M v[184:187],a[172:175],a[84:87],v[184:187]
M v[184:187],a[168:171],a[80:83],v[184:187]
M v[180:183],a[168:171],a[72:75],v[180:183]
M v[180:183],a[172:175],a[76:79],v[180:183]
s_nop 0
T a[148:149],v3,24576
T a[150:151],v3,25600
M v[176:179],a[172:175],a[68:71],v[176:179]
buffer_load_dwordx4 v9, s[16:19], s21 offen offset:1024   lds
M v[176:179],a[168:171],a[64:67],v[176:179]
M v[172:175],a[168:171],a[56:59],v[172:175]
M v[172:175],a[172:175],a[60:63],v[172:175]
M v[168:171],a[172:175],a[52:55],v[168:171]
M v[168:171],a[168:171],a[48:51],v[168:171]
M v[164:167],a[168:171],a[40:43],v[164:167]
s_nop 0
T a[152:153],v4,16384
T a[154:155],v4,17408
M v[164:167],a[172:175],a[44:47],v[164:167]
s_waitcnt lgkmcnt(4)
buffer_load_dwordx4 v10, s[16:19], s21 offen offset:2048   lds
M v[160:163],a[172:175],a[36:39],v[160:163]
M v[160:163],a[168:171],a[32:35],v[160:163]
M v[192:195],a[160:163],a[32:35],v[192:195]
R a[168:171],v5,55296
R a[172:175],v6,55296
M v[192:195],a[164:167],a[36:39],v[192:195]
M v[196:199],a[164:167],a[44:47],v[196:199]
M v[196:199],a[160:163],a[40:43],v[196:199]
s_nop 0
T a[156:157],v4,24576
T a[158:159],v4,25600
M v[200:203],a[160:163],a[48:51],v[200:203]
buffer_load_dwordx4 v11, s[16:19], s21 offen offset:3072   lds
M v[200:203],a[164:167],a[52:55],v[200:203]
SA s21,s21,128
M v[204:207],a[164:167],a[60:63],v[204:207]
M v[204:207],a[160:163],a[56:59],v[204:207]
M v[208:211],a[160:163],a[64:67],v[208:211]
M v[208:211],a[164:167],a[68:71],v[208:211]
M v[212:215],a[164:167],a[76:79],v[212:215]
M v[212:215],a[160:163],a[72:75],v[212:215]
M v[216:219],a[160:163],a[80:83],v[216:219]
M v[216:219],a[164:167],a[84:87],v[216:219]
s_waitcnt lgkmcnt(2)
M v[220:223],a[164:167],a[92:95],v[220:223]
s_waitcnt vmcnt(17) lgkmcnt(0)
M v[220:223],a[160:163],a[88:91],v[220:223]
s_barrier
M v[252:255],a[168:171],a[88:91],v[252:255]
R a[160:163],v5,0
R a[164:167],v6,0
M v[252:255],a[172:175],a[92:95],v[252:255]
M v[248:251],a[172:175],a[84:87],v[248:251]
M v[248:251],a[168:171],a[80:83],v[248:251]
M v[244:247],a[168:171],a[72:75],v[244:247]
M v[244:247],a[172:175],a[76:79],v[244:247]
M v[240:243],a[172:175],a[68:71],v[240:243]
M v[240:243],a[168:171],a[64:67],v[240:243]
M v[236:239],a[168:171],a[56:59],v[236:239]
M v[236:239],a[172:175],a[60:63],v[236:239]
M v[232:235],a[172:175],a[52:55],v[232:235]
M v[232:235],a[168:171],a[48:51],v[232:235]
M v[228:231],a[168:171],a[40:43],v[228:231]
M v[228:231],a[172:175],a[44:47],v[228:231]
s_waitcnt lgkmcnt(0)
M v[224:227],a[172:175],a[36:39],v[224:227]
M v[224:227],a[168:171],a[32:35],v[224:227]
M a[0:3],a[160:163],a[96:99],a[0:3]
R a[168:171],v5,2048
R a[172:175],v6,2048
M a[0:3],a[164:167],a[100:103],a[0:3]
T a[32:33],v1,32768
T a[34:35],v1,33792
M a[4:7],a[164:167],a[108:111],a[4:7]
SA m0,s24,49152
v_lshrrev_b32 v28, 4, v0
v_and_b32 v29, 7, v0
M a[4:7],a[160:163],a[104:107],a[4:7]
buffer_load_dwordx4 v12, s[48:51], s22 offen offset:0   lds
M a[8:11],a[160:163],a[112:115],a[8:11]
v_xor_b32 v28, v28, v29
v_lshlrev_b32 v28, 4, v28
M a[8:11],a[164:167],a[116:119],a[8:11]
v_lshrrev_b32 v29, 3, v0
v_mul_u32_u24 v29, 896, v29
M a[12:15],a[164:167],a[124:127],a[12:15]
T a[36:37],v1,40960
T a[38:39],v1,41984
M a[12:15],a[160:163],a[120:123],a[12:15]
v_add_u32 v22, v28, v29
v_xor_b32 v28, 64, v28
M a[16:19],a[160:163],a[128:131],a[16:19]
s_mul_i32 s64, s20, 14336
buffer_load_dwordx4 v13, s[48:51], s22 offen offset:1024   lds
M a[16:19],a[164:167],a[132:135],a[16:19]
s_sub_u32 s65, 98304, s64
M a[20:23],a[164:167],a[140:143],a[20:23]
SA s30,s29,s65
M a[20:23],a[160:163],a[136:139],a[20:23]
SA s29,s29,s64
T a[40:41],v2,32768
T a[42:43],v2,33792
M a[24:27],a[160:163],a[144:147],a[24:27]
v_add_u32 v29, 6144, v29
v_add_u32 v23, v28, v29
M a[24:27],a[164:167],a[148:151],a[24:27]
s_waitcnt lgkmcnt(6)
buffer_load_dwordx4 v14, s[48:51], s22 offen offset:2048   lds
M a[28:31],a[164:167],a[156:159],a[28:31]
s_and_b32 s64, s20, 1
M a[28:31],a[160:163],a[152:155],a[28:31]
s_lshl_b32 s64, s64, 12
M v[60:63],a[168:171],a[152:155],v[60:63]
SA s64,s64,65536
R a[160:163],v5,4096
R a[164:167],v6,4096
M v[60:63],a[172:175],a[156:159],v[60:63]
T a[44:45],v2,40960
T a[46:47],v2,41984
M v[56:59],a[172:175],a[148:151],v[56:59]
buffer_load_dwordx4 v15, s[48:51], s22 offen offset:3072   lds
M v[56:59],a[168:171],a[144:147],v[56:59]
s_sub_u32 s22, s22, 1048448
v_add_u32 v20, s64, v5
v_add_u32 v21, s64, v6
M v[52:55],a[168:171],a[136:139],v[52:55]
M v[52:55],a[172:175],a[140:143],v[52:55]
s_nop 0
T a[48:49],v3,32768
T a[50:51],v3,33792
M v[48:51],a[172:175],a[132:135],v[48:51]
SA m0,s23,16384
M v[48:51],a[168:171],a[128:131],v[48:51]
buffer_load_dwordx4 v8, s[16:19], s21 offen offset:0   lds
M v[44:47],a[168:171],a[120:123],v[44:47]
M v[44:47],a[172:175],a[124:127],v[44:47]
M v[40:43],a[172:175],a[116:119],v[40:43]
s_nop 0
T a[52:53],v3,40960
T a[54:55],v3,41984
M v[40:43],a[168:171],a[112:115],v[40:43]
M v[36:39],a[168:171],a[104:107],v[36:39]
buffer_load_dwordx4 v9, s[16:19], s21 offen offset:1024   lds
M v[36:39],a[172:175],a[108:111],v[36:39]
s_waitcnt lgkmcnt(6)
M v[32:35],a[172:175],a[100:103],v[32:35]
M v[32:35],a[168:171],a[96:99],v[32:35]
s_nop 0
T a[56:57],v4,32768
T a[58:59],v4,33792
M v[64:67],a[160:163],a[96:99],v[64:67]
R a[168:171],v5,6144
R a[172:175],v6,6144
M v[64:67],a[164:167],a[100:103],v[64:67]
buffer_load_dwordx4 v10, s[16:19], s21 offen offset:2048   lds
M v[68:71],a[164:167],a[108:111],v[68:71]
M v[68:71],a[160:163],a[104:107],v[68:71]
M v[72:75],a[160:163],a[112:115],v[72:75]
s_nop 0
T a[60:61],v4,40960
T a[62:63],v4,41984
M v[72:75],a[164:167],a[116:119],v[72:75]
M v[76:79],a[164:167],a[124:127],v[76:79]
buffer_load_dwordx4 v11, s[16:19], s21 offen offset:3072   lds
M v[76:79],a[160:163],a[120:123],v[76:79]
SA s21,s21,524160
M v[80:83],a[160:163],a[128:131],v[80:83]
M v[80:83],a[164:167],a[132:135],v[80:83]
M v[84:87],a[164:167],a[140:143],v[84:87]
M v[84:87],a[160:163],a[136:139],v[84:87]
M v[88:91],a[160:163],a[144:147],v[88:91]
M v[88:91],a[164:167],a[148:151],v[88:91]
s_waitcnt lgkmcnt(2)
M v[92:95],a[164:167],a[156:159],v[92:95]
s_waitcnt vmcnt(16) lgkmcnt(0)
M v[92:95],a[160:163],a[152:155],v[92:95]
s_barrier
M v[124:127],a[168:171],a[152:155],v[124:127]
R a[160:163],v5,16384
R a[164:167],v6,16384
M v[124:127],a[172:175],a[156:159],v[124:127]
SA m0,s23,131072
M v[120:123],a[172:175],a[148:151],v[120:123]
s_nop 0
T a[64:65],v1,49152
T a[66:67],v1,50176
M v[120:123],a[168:171],a[144:147],v[120:123]
buffer_load_dwordx4 v22, s[56:59], s29 offen offset:0 lds
M v[116:119],a[168:171],a[136:139],v[116:119]
M v[116:119],a[172:175],a[140:143],v[116:119]
M v[112:115],a[172:175],a[132:135],v[112:115]
buffer_load_dwordx4 v23, s[56:59], s29 offen offset:1024 lds
M v[112:115],a[168:171],a[128:131],v[112:115]
M v[108:111],a[168:171],a[120:123],v[108:111]
M v[108:111],a[172:175],a[124:127],v[108:111]
s_nop 0
T a[68:69],v1,57344
T a[70:71],v1,58368
M v[104:107],a[172:175],a[116:119],v[104:107]
buffer_load_dwordx4 v22, s[56:59], s30 offen offset:2048 lds
M v[104:107],a[168:171],a[112:115],v[104:107]
M v[100:103],a[168:171],a[104:107],v[100:103]
M v[100:103],a[172:175],a[108:111],v[100:103]
s_waitcnt lgkmcnt(4)
M v[96:99],a[172:175],a[100:103],v[96:99]
M v[96:99],a[168:171],a[96:99],v[96:99]
buffer_load_dwordx4 v23, s[56:59], s30 offen offset:3072 lds
M v[128:131],a[160:163],a[96:99],v[128:131]
R a[168:171],v5,18432
R a[172:175],v6,18432
M v[128:131],a[164:167],a[100:103],v[128:131]
SA s29,s29,128
T a[72:73],v2,49152
T a[74:75],v2,50176
M v[132:135],a[164:167],a[108:111],v[132:135]
SA s30,s30,128
M v[132:135],a[160:163],a[104:107],v[132:135]
SA m0,s24,0
M v[136:139],a[160:163],a[112:115],v[136:139]
buffer_load_dwordx4 v12, s[48:51], s22 offen offset:0   lds
M v[136:139],a[164:167],a[116:119],v[136:139]
M v[140:143],a[164:167],a[124:127],v[140:143]
M v[140:143],a[160:163],a[120:123],v[140:143]
s_nop 0
T a[76:77],v2,57344
T a[78:79],v2,58368
M v[144:147],a[160:163],a[128:131],v[144:147]
buffer_load_dwordx4 v13, s[48:51], s22 offen offset:1024   lds
M v[144:147],a[164:167],a[132:135],v[144:147]
M v[148:151],a[164:167],a[140:143],v[148:151]
M v[148:151],a[160:163],a[136:139],v[148:151]
M v[152:155],a[160:163],a[144:147],v[152:155]
M v[152:155],a[164:167],a[148:151],v[152:155]
s_waitcnt lgkmcnt(4)
buffer_load_dwordx4 v14, s[48:51], s22 offen offset:2048   lds
M v[156:159],a[164:167],a[156:159],v[156:159]
s_nop 0
T a[80:81],v3,49152
T a[82:83],v3,50176
M v[156:159],a[160:163],a[152:155],v[156:159]
M v[188:191],a[168:171],a[152:155],v[188:191]
R a[160:163],v5,20480
R a[164:167],v6,20480
M v[188:191],a[172:175],a[156:159],v[188:191]
M v[184:187],a[172:175],a[148:151],v[184:187]
buffer_load_dwordx4 v15, s[48:51], s22 offen offset:3072   lds
M v[184:187],a[168:171],a[144:147],v[184:187]
M v[180:183],a[168:171],a[136:139],v[180:183]
M v[180:183],a[172:175],a[140:143],v[180:183]
SA s22,s22,1048576
T a[84:85],v3,57344
T a[86:87],v3,58368
M v[176:179],a[172:175],a[132:135],v[176:179]
SA m0,s23,32768
M v[176:179],a[168:171],a[128:131],v[176:179]
buffer_load_dwordx4 v8, s[16:19], s21 offen offset:0   lds
M v[172:175],a[168:171],a[120:123],v[172:175]
M v[172:175],a[172:175],a[124:127],v[172:175]
M v[168:171],a[172:175],a[116:119],v[168:171]
M v[168:171],a[168:171],a[112:115],v[168:171]
buffer_load_dwordx4 v9, s[16:19], s21 offen offset:1024   lds
M v[164:167],a[168:171],a[104:107],v[164:167]
s_nop 0
T a[88:89],v4,49152
T a[90:91],v4,50176
M v[164:167],a[172:175],a[108:111],v[164:167]
s_waitcnt lgkmcnt(4)
M v[160:163],a[172:175],a[100:103],v[160:163]
M v[160:163],a[168:171],a[96:99],v[160:163]
M v[192:195],a[160:163],a[96:99],v[192:195]
R a[168:171],v5,22528
R a[172:175],v6,22528
M v[192:195],a[164:167],a[100:103],v[192:195]
buffer_load_dwordx4 v10, s[16:19], s21 offen offset:2048   lds
M v[196:199],a[164:167],a[108:111],v[196:199]
M v[196:199],a[160:163],a[104:107],v[196:199]
s_nop 0
T a[92:93],v4,57344
T a[94:95],v4,58368
M v[200:203],a[160:163],a[112:115],v[200:203]
M v[200:203],a[164:167],a[116:119],v[200:203]
buffer_load_dwordx4 v11, s[16:19], s21 offen offset:3072   lds
M v[204:207],a[164:167],a[124:127],v[204:207]
M v[204:207],a[160:163],a[120:123],v[204:207]
M v[208:211],a[160:163],a[128:131],v[208:211]
M v[208:211],a[164:167],a[132:135],v[208:211]
M v[212:215],a[164:167],a[140:143],v[212:215]
SA s21,s21,128
M v[212:215],a[160:163],a[136:139],v[212:215]
M v[216:219],a[160:163],a[144:147],v[216:219]
M v[216:219],a[164:167],a[148:151],v[216:219]
s_waitcnt lgkmcnt(2)
M v[220:223],a[164:167],a[156:159],v[220:223]
s_waitcnt vmcnt(20) lgkmcnt(0)
M v[220:223],a[160:163],a[152:155],v[220:223]
s_barrier
M v[252:255],a[168:171],a[152:155],v[252:255]
R a[160:163],v5,32768
R a[164:167],v6,32768
M v[252:255],a[172:175],a[156:159],v[252:255]
M v[248:251],a[172:175],a[148:151],v[248:251]
M v[248:251],a[168:171],a[144:147],v[248:251]
M v[244:247],a[168:171],a[136:139],v[244:247]
M v[244:247],a[172:175],a[140:143],v[244:247]
M v[240:243],a[172:175],a[132:135],v[240:243]
M v[240:243],a[168:171],a[128:131],v[240:243]
M v[236:239],a[168:171],a[120:123],v[236:239]
M v[236:239],a[172:175],a[124:127],v[236:239]
M v[232:235],a[172:175],a[116:119],v[232:235]
M v[232:235],a[168:171],a[112:115],v[232:235]
M v[228:231],a[168:171],a[104:107],v[228:231]
M v[228:231],a[172:175],a[108:111],v[228:231]
s_waitcnt lgkmcnt(0)
M v[224:227],a[172:175],a[100:103],v[224:227]
M v[224:227],a[168:171],a[96:99],v[224:227]
M a[0:3],a[160:163],a[32:35],a[0:3]
R a[168:171],v5,34816
R a[172:175],v6,34816
M a[0:3],a[164:167],a[36:39],a[0:3]
SA m0,s23,147456
T a[96:97],v1,0
T a[98:99],v1,1024
M a[4:7],a[164:167],a[44:47],a[4:7]
buffer_load_dwordx4 v22, s[56:59], s29 offen offset:0 lds
M a[4:7],a[160:163],a[40:43],a[4:7]
M a[8:11],a[160:163],a[48:51],a[8:11]
M a[8:11],a[164:167],a[52:55],a[8:11]
buffer_load_dwordx4 v23, s[56:59], s29 offen offset:1024 lds
M a[12:15],a[164:167],a[60:63],a[12:15]
s_nop 0
T a[100:101],v1,8192
T a[102:103],v1,9216
M a[12:15],a[160:163],a[56:59],a[12:15]
M a[16:19],a[160:163],a[64:67],a[16:19]
buffer_load_dwordx4 v22, s[56:59], s30 offen offset:2048 lds
M a[16:19],a[164:167],a[68:71],a[16:19]
M a[20:23],a[164:167],a[76:79],a[20:23]
M a[20:23],a[160:163],a[72:75],a[20:23]
s_nop 0
T a[104:105],v2,0
T a[106:107],v2,1024
M a[24:27],a[160:163],a[80:83],a[24:27]
buffer_load_dwordx4 v23, s[56:59], s30 offen offset:3072 lds
M a[24:27],a[164:167],a[84:87],a[24:27]
s_waitcnt lgkmcnt(6)
M a[28:31],a[164:167],a[92:95],a[28:31]
SA s29,s29,128
M a[28:31],a[160:163],a[88:91],a[28:31]
SA s30,s30,128
M v[60:63],a[168:171],a[88:91],v[60:63]
SA m0,s24,16384
R a[160:163],v5,36864
R a[164:167],v6,36864
M v[60:63],a[172:175],a[92:95],v[60:63]
T a[108:109],v2,8192
T a[110:111],v2,9216
M v[56:59],a[172:175],a[84:87],v[56:59]
buffer_load_dwordx4 v12, s[48:51], s22 offen offset:0   lds
M v[56:59],a[168:171],a[80:83],v[56:59]
M v[52:55],a[168:171],a[72:75],v[52:55]
M v[52:55],a[172:175],a[76:79],v[52:55]
s_nop 0
T a[112:113],v3,0
T a[114:115],v3,1024
M v[48:51],a[172:175],a[68:71],v[48:51]
buffer_load_dwordx4 v13, s[48:51], s22 offen offset:1024   lds
M v[48:51],a[168:171],a[64:67],v[48:51]
M v[44:47],a[168:171],a[56:59],v[44:47]
M v[44:47],a[172:175],a[60:63],v[44:47]
buffer_load_dwordx4 v14, s[48:51], s22 offen offset:2048   lds
M v[40:43],a[172:175],a[52:55],v[40:43]
s_nop 0
T a[116:117],v3,8192
T a[118:119],v3,9216
L_w_kv16:
s_cbranch_execz L_wd2
M v[40:43],a[168:171],a[48:51],v[40:43]
M v[36:39],a[168:171],a[40:43],v[36:39]
buffer_load_dwordx4 v15, s[48:51], s22 offen offset:3072   lds
M v[36:39],a[172:175],a[44:47],v[36:39]
s_waitcnt lgkmcnt(6)
M v[32:35],a[172:175],a[36:39],v[32:35]
s_sub_u32 s22, s22, 1048448
M v[32:35],a[168:171],a[32:35],v[32:35]
SA m0,s23,49152
T a[120:121],v4,0
T a[122:123],v4,1024
M v[64:67],a[160:163],a[32:35],v[64:67]
R a[168:171],v5,38912
R a[172:175],v6,38912
M v[64:67],a[164:167],a[36:39],v[64:67]
buffer_load_dwordx4 v8, s[16:19], s21 offen offset:0   lds
M v[68:71],a[164:167],a[44:47],v[68:71]
M v[68:71],a[160:163],a[40:43],v[68:71]
M v[72:75],a[160:163],a[48:51],v[72:75]
s_waitcnt vmcnt(17)
s_nop 0
T a[124:125],v4,8192
T a[126:127],v4,9216
M v[72:75],a[164:167],a[52:55],v[72:75]
buffer_load_dwordx4 v9, s[16:19], s21 offen offset:1024   lds
M v[76:79],a[164:167],a[60:63],v[76:79]
R a[176:179],v20,0
R a[180:183],v20,2048
M v[76:79],a[160:163],a[56:59],v[76:79]
R a[184:187],v21,0
R a[188:191],v21,2048
M v[80:83],a[160:163],a[64:67],v[80:83]
buffer_load_dwordx4 v10, s[16:19], s21 offen offset:2048   lds
M v[80:83],a[164:167],a[68:71],v[80:83]
M v[84:87],a[164:167],a[76:79],v[84:87]
M v[84:87],a[160:163],a[72:75],v[84:87]
buffer_load_dwordx4 v11, s[16:19], s21 offen offset:3072   lds
M v[88:91],a[160:163],a[80:83],v[88:91]
SA s21,s21,524160
M v[88:91],a[164:167],a[84:87],v[88:91]
s_waitcnt lgkmcnt(6)
M v[92:95],a[164:167],a[92:95],v[92:95]
s_waitcnt lgkmcnt(0)
M v[92:95],a[160:163],a[88:91],v[92:95]
s_barrier
M v[124:127],a[168:171],a[88:91],v[124:127]
s_lshl_b32 s4, s20, 10
R a[160:163],v5,49152
R a[164:167],v6,49152
M v[124:127],a[172:175],a[92:95],v[124:127]
SA m0,s23,131072
v_bfe_u32 v28, v0, 3, 2
M v[120:123],a[172:175],a[84:87],v[120:123]
s_nop 0
T a[128:129],v1,16384
T a[130:131],v1,17408
M v[120:123],a[168:171],a[80:83],v[120:123]
buffer_load_dwordx4 v22, s[56:59], s29 offen offset:0 lds
M v[116:119],a[168:171],a[72:75],v[116:119]
v_lshrrev_b32 v29, 5, v0
v_lshl_add_u32 v28, v29, 3, v28
M v[116:119],a[172:175],a[76:79],v[116:119]
M v[112:115],a[172:175],a[68:71],v[112:115]
v_lshlrev_b32 v28, 13, v28
M v[112:115],a[168:171],a[64:67],v[112:115]
M v[108:111],a[168:171],a[56:59],v[108:111]
buffer_load_dwordx4 v23, s[56:59], s29 offen offset:1024 lds
M v[108:111],a[172:175],a[60:63],v[108:111]
s_nop 0
T a[132:133],v1,24576
T a[134:135],v1,25600
M v[104:107],a[172:175],a[52:55],v[104:107]
v_lshrrev_b32 v29, 4, v0
v_lshlrev_b32 v29, 1, v29
M v[104:107],a[168:171],a[48:51],v[104:107]
M v[100:103],a[168:171],a[40:43],v[100:103]
v_and_b32 v30, 7, v0
M v[100:103],a[172:175],a[44:47],v[100:103]
s_waitcnt lgkmcnt(4)
M v[96:99],a[172:175],a[36:39],v[96:99]
v_xor_b32 v29, v29, v30
M v[96:99],a[168:171],a[32:35],v[96:99]
buffer_load_dwordx4 v22, s[56:59], s30 offen offset:2048 lds
M v[128:131],a[160:163],a[32:35],v[128:131]
R a[168:171],v5,51200
R a[172:175],v6,51200
M v[128:131],a[164:167],a[36:39],v[128:131]
T a[136:137],v2,16384
T a[138:139],v2,17408
M v[132:135],a[164:167],a[44:47],v[132:135]
v_lshl_add_u32 v28, v29, 4, v28
M v[132:135],a[160:163],a[40:43],v[132:135]
s_and_b32 s64, s20, 1
M v[136:139],a[160:163],a[48:51],v[136:139]
s_lshl_b32 s64, s64, 17
M v[136:139],a[164:167],a[52:55],v[136:139]
s_lshr_b32 s65, s20, 1
M v[140:143],a[164:167],a[60:63],v[140:143]
s_lshl_b32 s65, s65, 15
SA s64,s64,s65
v_add_u32 v8, s64, v28
M v[140:143],a[160:163],a[56:59],v[140:143]
s_nop 0
T a[140:141],v2,24576
T a[142:143],v2,25600
M v[144:147],a[160:163],a[64:67],v[144:147]
buffer_load_dwordx4 v23, s[56:59], s30 offen offset:3072 lds
M v[144:147],a[164:167],a[68:71],v[144:147]
M v[148:151],a[164:167],a[76:79],v[148:151]
SA s29,s29,128
M v[148:151],a[160:163],a[72:75],v[148:151]
SA s30,s30,128
M v[152:155],a[160:163],a[80:83],v[152:155]
SA m0,s24,32768
M v[152:155],a[164:167],a[84:87],v[152:155]
s_waitcnt lgkmcnt(4)
buffer_load_dwordx4 v12, s[48:51], s22 offen offset:0   lds
M v[156:159],a[164:167],a[92:95],v[156:159]
s_nop 0
T a[144:145],v3,16384
T a[146:147],v3,17408
M v[156:159],a[160:163],a[88:91],v[156:159]
M v[188:191],a[168:171],a[88:91],v[188:191]
R a[160:163],v5,53248
R a[164:167],v6,53248
M v[188:191],a[172:175],a[92:95],v[188:191]
M v[184:187],a[172:175],a[84:87],v[184:187]
M v[184:187],a[168:171],a[80:83],v[184:187]
M v[180:183],a[168:171],a[72:75],v[180:183]
buffer_load_dwordx4 v13, s[48:51], s22 offen offset:1024   lds
M v[180:183],a[172:175],a[76:79],v[180:183]
s_nop 0
T a[148:149],v3,24576
T a[150:151],v3,25600
M v[176:179],a[172:175],a[68:71],v[176:179]
M v[176:179],a[168:171],a[64:67],v[176:179]
M v[172:175],a[168:171],a[56:59],v[172:175]
M v[172:175],a[172:175],a[60:63],v[172:175]
M v[168:171],a[172:175],a[52:55],v[168:171]
M v[168:171],a[168:171],a[48:51],v[168:171]
buffer_load_dwordx4 v14, s[48:51], s22 offen offset:2048   lds
M v[164:167],a[168:171],a[40:43],v[164:167]
s_nop 0
T a[152:153],v4,16384
T a[154:155],v4,17408
M v[164:167],a[172:175],a[44:47],v[164:167]
s_waitcnt lgkmcnt(4)
M v[160:163],a[172:175],a[36:39],v[160:163]
M v[160:163],a[168:171],a[32:35],v[160:163]
M v[192:195],a[160:163],a[32:35],v[192:195]
R a[168:171],v5,55296
R a[172:175],v6,55296
M v[192:195],a[164:167],a[36:39],v[192:195]
M v[196:199],a[164:167],a[44:47],v[196:199]
buffer_load_dwordx4 v15, s[48:51], s22 offen offset:3072   lds
M v[196:199],a[160:163],a[40:43],v[196:199]
s_nop 0
T a[156:157],v4,24576
T a[158:159],v4,25600
M v[200:203],a[160:163],a[48:51],v[200:203]
s_waitcnt vmcnt(16)
R a[192:195],v20,16384
R a[196:199],v20,18432
M v[200:203],a[164:167],a[52:55],v[200:203]
R a[200:203],v21,16384
R a[204:207],v21,18432
M v[204:207],a[164:167],a[60:63],v[204:207]
M v[204:207],a[160:163],a[56:59],v[204:207]
M v[208:211],a[160:163],a[64:67],v[208:211]
M v[208:211],a[164:167],a[68:71],v[208:211]
M v[212:215],a[164:167],a[76:79],v[212:215]
SA s22,s22,1048576
M v[212:215],a[160:163],a[72:75],v[212:215]
M v[216:219],a[160:163],a[80:83],v[216:219]
M v[216:219],a[164:167],a[84:87],v[216:219]
s_waitcnt lgkmcnt(6)
M v[220:223],a[164:167],a[92:95],v[220:223]
s_waitcnt lgkmcnt(0)
M v[220:223],a[160:163],a[88:91],v[220:223]
s_barrier
M v[252:255],a[168:171],a[88:91],v[252:255]
R a[160:163],v5,0
R a[164:167],v6,0
M v[252:255],a[172:175],a[92:95],v[252:255]
M v[248:251],a[172:175],a[84:87],v[248:251]
M v[248:251],a[168:171],a[80:83],v[248:251]
M v[244:247],a[168:171],a[72:75],v[244:247]
M v[244:247],a[172:175],a[76:79],v[244:247]
M v[240:243],a[172:175],a[68:71],v[240:243]
M v[240:243],a[168:171],a[64:67],v[240:243]
M v[236:239],a[168:171],a[56:59],v[236:239]
M v[236:239],a[172:175],a[60:63],v[236:239]
M v[232:235],a[172:175],a[52:55],v[232:235]
M v[232:235],a[168:171],a[48:51],v[232:235]
M v[228:231],a[168:171],a[40:43],v[228:231]
M v[228:231],a[172:175],a[44:47],v[228:231]
s_waitcnt lgkmcnt(0)
M v[224:227],a[172:175],a[36:39],v[224:227]
M v[224:227],a[168:171],a[32:35],v[224:227]
M a[0:3],a[160:163],a[96:99],a[0:3]
R a[168:171],v5,2048
R a[172:175],v6,2048
M a[0:3],a[164:167],a[100:103],a[0:3]
SA m0,s23,147456
T a[32:33],v1,32768
T a[34:35],v1,33792
M a[4:7],a[164:167],a[108:111],a[4:7]
buffer_load_dwordx4 v22, s[56:59], s29 offen offset:0 lds
M a[4:7],a[160:163],a[104:107],a[4:7]
M a[8:11],a[160:163],a[112:115],a[8:11]
M a[8:11],a[164:167],a[116:119],a[8:11]
buffer_load_dwordx4 v23, s[56:59], s29 offen offset:1024 lds
M a[12:15],a[164:167],a[124:127],a[12:15]
s_nop 0
T a[36:37],v1,40960
T a[38:39],v1,41984
M a[12:15],a[160:163],a[120:123],a[12:15]
M a[16:19],a[160:163],a[128:131],a[16:19]
buffer_load_dwordx4 v22, s[56:59], s30 offen offset:2048 lds
M a[16:19],a[164:167],a[132:135],a[16:19]
M a[20:23],a[164:167],a[140:143],a[20:23]
M a[20:23],a[160:163],a[136:139],a[20:23]
s_nop 0
T a[40:41],v2,32768
T a[42:43],v2,33792
M a[24:27],a[160:163],a[144:147],a[24:27]
buffer_load_dwordx4 v23, s[56:59], s30 offen offset:3072 lds
M a[24:27],a[164:167],a[148:151],a[24:27]
s_waitcnt lgkmcnt(6)
M a[28:31],a[164:167],a[156:159],a[28:31]
SA s29,s29,128
M a[28:31],a[160:163],a[152:155],a[28:31]
SA s30,s30,128
M v[60:63],a[168:171],a[152:155],v[60:63]
SA m0,s24,49152
R a[160:163],v5,4096
R a[164:167],v6,4096
M v[60:63],a[172:175],a[156:159],v[60:63]
T a[44:45],v2,40960
T a[46:47],v2,41984
M v[56:59],a[172:175],a[148:151],v[56:59]
buffer_load_dwordx4 v12, s[48:51], s22 offen offset:0   lds
M v[56:59],a[168:171],a[144:147],v[56:59]
M v[52:55],a[168:171],a[136:139],v[52:55]
M v[52:55],a[172:175],a[140:143],v[52:55]
s_nop 0
T a[48:49],v3,32768
T a[50:51],v3,33792
M v[48:51],a[172:175],a[132:135],v[48:51]
buffer_load_dwordx4 v13, s[48:51], s22 offen offset:1024   lds
M v[48:51],a[168:171],a[128:131],v[48:51]
M v[44:47],a[168:171],a[120:123],v[44:47]
M v[44:47],a[172:175],a[124:127],v[44:47]
buffer_load_dwordx4 v14, s[48:51], s22 offen offset:2048   lds
M v[40:43],a[172:175],a[116:119],v[40:43]
s_nop 0
T a[52:53],v3,40960
T a[54:55],v3,41984
M v[40:43],a[168:171],a[112:115],v[40:43]
M v[36:39],a[168:171],a[104:107],v[36:39]
buffer_load_dwordx4 v15, s[48:51], s22 offen offset:3072   lds
M v[36:39],a[172:175],a[108:111],v[36:39]
s_waitcnt lgkmcnt(6)
M v[32:35],a[172:175],a[100:103],v[32:35]
s_sub_u32 s22, s22, 1048448
M v[32:35],a[168:171],a[96:99],v[32:35]
s_mov_b32 s25, 0
T a[56:57],v4,32768
T a[58:59],v4,33792
M v[64:67],a[160:163],a[96:99],v[64:67]
SA m0,s4,0
R a[168:171],v5,6144
R a[172:175],v6,6144
M v[64:67],a[164:167],a[100:103],v[64:67]
buffer_load_dwordx4 v8, s[52:55], s25 offen lds
M v[68:71],a[164:167],a[108:111],v[68:71]
s_mov_b32 s25, 262144
M v[68:71],a[160:163],a[104:107],v[68:71]
SA m0,s4,4096
M v[72:75],a[160:163],a[112:115],v[72:75]
s_waitcnt vmcnt(13)
s_nop 0
T a[60:61],v4,40960
T a[62:63],v4,41984
M v[72:75],a[164:167],a[116:119],v[72:75]
buffer_load_dwordx4 v8, s[52:55], s25 offen lds
M v[76:79],a[164:167],a[124:127],v[76:79]
s_mov_b32 s25, 524288
R a[208:211],v20,0
R a[212:215],v20,2048
M v[76:79],a[160:163],a[120:123],v[76:79]
SA m0,s4,8192
R a[216:219],v21,0
R a[220:223],v21,2048
M v[80:83],a[160:163],a[128:131],v[80:83]
buffer_load_dwordx4 v8, s[52:55], s25 offen lds
M v[80:83],a[164:167],a[132:135],v[80:83]
s_mov_b32 s25, 786432
M v[84:87],a[164:167],a[140:143],v[84:87]
SA m0,s4,12288
M v[84:87],a[160:163],a[136:139],v[84:87]
buffer_load_dwordx4 v8, s[52:55], s25 offen lds
M v[88:91],a[160:163],a[144:147],v[88:91]
M v[88:91],a[164:167],a[148:151],v[88:91]
s_waitcnt lgkmcnt(6)
M v[92:95],a[164:167],a[156:159],v[92:95]
s_waitcnt lgkmcnt(0)
M v[92:95],a[160:163],a[152:155],v[92:95]
s_barrier
M v[124:127],a[168:171],a[152:155],v[124:127]
R a[160:163],v5,16384
R a[164:167],v6,16384
M v[124:127],a[172:175],a[156:159],v[124:127]
SA m0,s23,32768
M v[120:123],a[172:175],a[148:151],v[120:123]
s_nop 0
T a[64:65],v1,49152
T a[66:67],v1,50176
M v[120:123],a[168:171],a[144:147],v[120:123]
buffer_load_dwordx4 v22, s[56:59], s29 offen offset:0 lds
M v[116:119],a[168:171],a[136:139],v[116:119]
v_lshrrev_b32 v28, 2, v0
v_lshlrev_b32 v28, 7, v28
M v[116:119],a[172:175],a[140:143],v[116:119]
M v[112:115],a[172:175],a[132:135],v[112:115]
buffer_load_dwordx4 v23, s[56:59], s29 offen offset:1024 lds
M v[112:115],a[168:171],a[128:131],v[112:115]
v_and_b32 v29, 3, v0
M v[108:111],a[168:171],a[120:123],v[108:111]
v_lshl_add_u32 v28, v29, 3, v28
M v[108:111],a[172:175],a[124:127],v[108:111]
s_nop 0
T a[68:69],v1,57344
T a[70:71],v1,58368
M v[104:107],a[172:175],a[116:119],v[104:107]
buffer_load_dwordx4 v22, s[56:59], s30 offen offset:2048 lds
M v[104:107],a[168:171],a[112:115],v[104:107]
v_bfe_u32 v29, v0, 3, 2
M v[100:103],a[168:171],a[104:107],v[100:103]
M v[100:103],a[172:175],a[108:111],v[100:103]
s_waitcnt lgkmcnt(4)
v_lshl_add_u32 v16, v29, 5, v28
M v[96:99],a[172:175],a[100:103],v[96:99]
M v[96:99],a[168:171],a[96:99],v[96:99]
buffer_load_dwordx4 v23, s[56:59], s30 offen offset:3072 lds
M v[128:131],a[160:163],a[96:99],v[128:131]
R a[168:171],v5,18432
R a[172:175],v6,18432
M v[128:131],a[164:167],a[100:103],v[128:131]
SA s29,s29,128
T a[72:73],v2,49152
T a[74:75],v2,50176
M v[132:135],a[164:167],a[108:111],v[132:135]
SA s30,s30,128
v_xor_b32 v17, 32, v16
v_xor_b32 v18, 64, v16
M v[132:135],a[160:163],a[104:107],v[132:135]
SA m0,s23,65536
M v[136:139],a[160:163],a[112:115],v[136:139]
buffer_load_dwordx4 v22, s[56:59], s29 offen offset:0 lds
M v[136:139],a[164:167],a[116:119],v[136:139]
v_xor_b32 v19, 0x60, v16
M v[140:143],a[164:167],a[124:127],v[140:143]
v_add_u32 v12, 0x20000, v16
M v[140:143],a[160:163],a[120:123],v[140:143]
s_nop 0
T a[76:77],v2,57344
T a[78:79],v2,58368
M v[144:147],a[160:163],a[128:131],v[144:147]
buffer_load_dwordx4 v23, s[56:59], s29 offen offset:1024 lds
M v[144:147],a[164:167],a[132:135],v[144:147]
v_add_u32 v13, 0x20000, v17
M v[148:151],a[164:167],a[140:143],v[148:151]
M v[148:151],a[160:163],a[136:139],v[148:151]
v_add_u32 v14, 0x20000, v18
M v[152:155],a[160:163],a[144:147],v[152:155]
M v[152:155],a[164:167],a[148:151],v[152:155]
s_waitcnt lgkmcnt(4)
buffer_load_dwordx4 v22, s[56:59], s30 offen offset:2048 lds
M v[156:159],a[164:167],a[156:159],v[156:159]
s_nop 0
T a[80:81],v3,49152
T a[82:83],v3,50176
M v[156:159],a[160:163],a[152:155],v[156:159]
v_add_u32 v15, 0x20000, v19
M v[188:191],a[168:171],a[152:155],v[188:191]
R a[160:163],v5,20480
R a[164:167],v6,20480
M v[188:191],a[172:175],a[156:159],v[188:191]
M v[184:187],a[172:175],a[148:151],v[184:187]
buffer_load_dwordx4 v23, s[56:59], s30 offen offset:3072 lds
M v[184:187],a[168:171],a[144:147],v[184:187]
SA s29,s29,128
M v[180:183],a[168:171],a[136:139],v[180:183]
SA s30,s30,128
M v[180:183],a[172:175],a[140:143],v[180:183]
s_mov_b32 s25, 1048576
T a[84:85],v3,57344
T a[86:87],v3,58368
M v[176:179],a[172:175],a[132:135],v[176:179]
SA m0,s4,16384
M v[176:179],a[168:171],a[128:131],v[176:179]
buffer_load_dwordx4 v8, s[52:55], s25 offen lds
M v[172:175],a[168:171],a[120:123],v[172:175]
M v[172:175],a[172:175],a[124:127],v[172:175]
s_mov_b32 s25, 1310720
M v[168:171],a[172:175],a[116:119],v[168:171]
SA m0,s4,20480
M v[168:171],a[168:171],a[112:115],v[168:171]
buffer_load_dwordx4 v8, s[52:55], s25 offen lds
M v[164:167],a[168:171],a[104:107],v[164:167]
s_nop 0
T a[88:89],v4,49152
T a[90:91],v4,50176
M v[164:167],a[172:175],a[108:111],v[164:167]
s_waitcnt lgkmcnt(4)
M v[160:163],a[172:175],a[100:103],v[160:163]
s_mov_b32 s25, 1572864
M v[160:163],a[168:171],a[96:99],v[160:163]
SA m0,s4,24576
M v[192:195],a[160:163],a[96:99],v[192:195]
R a[168:171],v5,22528
R a[172:175],v6,22528
M v[192:195],a[164:167],a[100:103],v[192:195]
buffer_load_dwordx4 v8, s[52:55], s25 offen lds
M v[196:199],a[164:167],a[108:111],v[196:199]
M v[196:199],a[160:163],a[104:107],v[196:199]
s_mov_b32 s25, 1835008
T a[92:93],v4,57344
T a[94:95],v4,58368
M v[200:203],a[160:163],a[112:115],v[200:203]
SA m0,s4,28672
M v[200:203],a[164:167],a[116:119],v[200:203]
s_waitcnt vmcnt(19)
buffer_load_dwordx4 v8, s[52:55], s25 offen lds
M v[204:207],a[164:167],a[124:127],v[204:207]
R a[224:227],v20,16384
R a[228:231],v20,18432
M v[204:207],a[160:163],a[120:123],v[204:207]
R a[232:235],v21,16384
R a[236:239],v21,18432
M v[208:211],a[160:163],a[128:131],v[208:211]
v_subrev_u32 v20, 98304, v20
v_subrev_u32 v21, 98304, v21
M v[208:211],a[164:167],a[132:135],v[208:211]
M v[212:215],a[164:167],a[140:143],v[212:215]
M v[212:215],a[160:163],a[136:139],v[212:215]
M v[216:219],a[160:163],a[144:147],v[216:219]
M v[216:219],a[164:167],a[148:151],v[216:219]
s_waitcnt lgkmcnt(6)
M v[220:223],a[164:167],a[156:159],v[220:223]
s_waitcnt lgkmcnt(0)
M v[220:223],a[160:163],a[152:155],v[220:223]
s_barrier
M v[252:255],a[168:171],a[152:155],v[252:255]
R a[160:163],v5,32768
R a[164:167],v6,32768
M v[252:255],a[172:175],a[156:159],v[252:255]
M v[248:251],a[172:175],a[148:151],v[248:251]
M v[248:251],a[168:171],a[144:147],v[248:251]
M v[244:247],a[168:171],a[136:139],v[244:247]
M v[244:247],a[172:175],a[140:143],v[244:247]
M v[240:243],a[172:175],a[132:135],v[240:243]
M v[240:243],a[168:171],a[128:131],v[240:243]
M v[236:239],a[168:171],a[120:123],v[236:239]
M v[236:239],a[172:175],a[124:127],v[236:239]
M v[232:235],a[172:175],a[116:119],v[232:235]
M v[232:235],a[168:171],a[112:115],v[232:235]
M v[228:231],a[168:171],a[104:107],v[228:231]
M v[228:231],a[172:175],a[108:111],v[228:231]
s_waitcnt lgkmcnt(0)
M v[224:227],a[172:175],a[100:103],v[224:227]
M v[224:227],a[168:171],a[96:99],v[224:227]
M a[0:3],a[160:163],a[32:35],a[0:3]
R a[168:171],v5,34816
R a[172:175],v6,34816
M a[0:3],a[164:167],a[36:39],a[0:3]
SA m0,s23,81920
M a[4:7],a[164:167],a[44:47],a[4:7]
buffer_load_dwordx4 v22, s[56:59], s29 offen offset:0 lds
M a[4:7],a[160:163],a[40:43],a[4:7]
M a[8:11],a[160:163],a[48:51],a[8:11]
M a[8:11],a[164:167],a[52:55],a[8:11]
buffer_load_dwordx4 v23, s[56:59], s29 offen offset:1024 lds
M a[12:15],a[164:167],a[60:63],a[12:15]
M a[12:15],a[160:163],a[56:59],a[12:15]
M a[16:19],a[160:163],a[64:67],a[16:19]
M a[16:19],a[164:167],a[68:71],a[16:19]
buffer_load_dwordx4 v22, s[56:59], s30 offen offset:2048 lds
M a[20:23],a[164:167],a[76:79],a[20:23]
M a[20:23],a[160:163],a[72:75],a[20:23]
M a[24:27],a[160:163],a[80:83],a[24:27]
M a[24:27],a[164:167],a[84:87],a[24:27]
s_waitcnt lgkmcnt(0)
buffer_load_dwordx4 v23, s[56:59], s30 offen offset:3072 lds
M a[28:31],a[164:167],a[92:95],a[28:31]
SA s29,s29,128
M a[28:31],a[160:163],a[88:91],a[28:31]
SA s30,s30,128
M v[32:35],a[168:171],a[32:35],v[32:35]
s_mov_b32 s25, 2097152
R a[160:163],v5,36864
R a[164:167],v6,36864
M v[32:35],a[172:175],a[36:39],v[32:35]
SA m0,s4,131072
M v[36:39],a[172:175],a[44:47],v[36:39]
buffer_load_dwordx4 v8, s[52:55], s25 offen lds
M v[36:39],a[168:171],a[40:43],v[36:39]
s_mov_b32 s25, 2359296
M v[40:43],a[168:171],a[48:51],v[40:43]
SA m0,s4,135168
M v[40:43],a[172:175],a[52:55],v[40:43]
buffer_load_dwordx4 v8, s[52:55], s25 offen lds
M v[44:47],a[172:175],a[60:63],v[44:47]
G v24,a0
G v25,a1
M v[44:47],a[168:171],a[56:59],v[44:47]
s_mov_b32 s25, 2621440
G v26,a2
G v27,a3
M v[48:51],a[168:171],a[64:67],v[48:51]
SA m0,s4,139264
C v24,v24,v25
C v25,v26,v27
M v[48:51],a[172:175],a[68:71],v[48:51]
buffer_load_dwordx4 v8, s[52:55], s25 offen lds
M v[52:55],a[172:175],a[76:79],v[52:55]
C v26,v32,v33
C v27,v34,v35
M v[52:55],a[168:171],a[72:75],v[52:55]
SA s3,s93,0
M v[56:59],a[168:171],a[80:83],v[56:59]
s_mov_b32 s25, 2883584
buffer_store_dwordx4 v[24:27], v7, s[8:11], s3 offen offset:0 sc1
M v[56:59],a[172:175],a[84:87],v[56:59]
s_waitcnt lgkmcnt(0)
G v28,a4
G v29,a5
M v[60:63],a[172:175],a[92:95],v[60:63]
SA m0,s4,143360
G v30,a6
G v31,a7
M v[60:63],a[168:171],a[88:91],v[60:63]
s_waitcnt vmcnt(16)
buffer_load_dwordx4 v8, s[52:55], s25 offen lds
M v[64:67],a[160:163],a[32:35],v[64:67]
L_w_kv17:
s_cbranch_execz L_wd2
s_mov_b32 s25, 3145728
R a[168:171],v5,38912
R a[172:175],v6,38912
M v[64:67],a[164:167],a[36:39],v[64:67]
SA m0,s4,147456
C v28,v28,v29
C v29,v30,v31
M v[68:71],a[164:167],a[44:47],v[68:71]
buffer_load_dwordx4 v8, s[52:55], s25 offen lds
M v[68:71],a[160:163],a[40:43],v[68:71]
s_mov_b32 s25, 3407872
C v30,v36,v37
C v31,v38,v39
M v[72:75],a[160:163],a[48:51],v[72:75]
SA m0,s4,151552
buffer_store_dwordx4 v[28:31], v7, s[8:11], s3 offen offset:2048 sc1
M v[72:75],a[164:167],a[52:55],v[72:75]
G v24,a8
G v25,a9
M v[76:79],a[164:167],a[60:63],v[76:79]
G v26,a10
G v27,a11
M v[76:79],a[160:163],a[56:59],v[76:79]
buffer_load_dwordx4 v8, s[52:55], s25 offen lds
M v[80:83],a[160:163],a[64:67],v[80:83]
C v24,v24,v25
C v25,v26,v27
M v[80:83],a[164:167],a[68:71],v[80:83]
C v26,v40,v41
C v27,v42,v43
M v[84:87],a[164:167],a[76:79],v[84:87]
SA s3,s93,4096
buffer_store_dwordx4 v[24:27], v7, s[8:11], s3 offen offset:0 sc1
M v[84:87],a[160:163],a[72:75],v[84:87]
R a[96:99],v20,0
R a[100:103],v20,2048
M v[88:91],a[160:163],a[80:83],v[88:91]
R a[104:107],v21,0
R a[108:111],v21,2048
M v[88:91],a[164:167],a[84:87],v[88:91]
s_waitcnt lgkmcnt(4)
G v28,a12
G v29,a13
M v[92:95],a[164:167],a[92:95],v[92:95]
s_waitcnt lgkmcnt(0)
G v30,a14
G v31,a15
M v[92:95],a[160:163],a[88:91],v[92:95]
s_barrier
M v[96:99],a[168:171],a[32:35],v[96:99]
R a[160:163],v5,49152
R a[164:167],v6,49152
M v[96:99],a[172:175],a[36:39],v[96:99]
s_mov_b32 s25, 128
C v28,v28,v29
C v29,v30,v31
M v[100:103],a[172:175],a[44:47],v[100:103]
SA m0,s4,49152
C v30,v44,v45
C v31,v46,v47
M v[100:103],a[168:171],a[40:43],v[100:103]
s_waitcnt vmcnt(17)
buffer_store_dwordx4 v[28:31], v7, s[8:11], s3 offen offset:2048 sc1
M v[104:107],a[168:171],a[48:51],v[104:107]
G v24,a16
G v25,a17
M v[104:107],a[172:175],a[52:55],v[104:107]
G v26,a18
G v27,a19
M v[108:111],a[172:175],a[60:63],v[108:111]
buffer_load_dwordx4 v8, s[52:55], s25 offen lds
M v[108:111],a[168:171],a[56:59],v[108:111]
C v24,v24,v25
C v25,v26,v27
M v[112:115],a[168:171],a[64:67],v[112:115]
C v26,v48,v49
C v27,v50,v51
M v[112:115],a[172:175],a[68:71],v[112:115]
SA s3,s93,8192
buffer_store_dwordx4 v[24:27], v7, s[8:11], s3 offen offset:0 sc1
M v[116:119],a[172:175],a[76:79],v[116:119]
s_mov_b32 s25, 262272
R a[112:115],v20,32768
R a[116:119],v20,34816
M v[116:119],a[168:171],a[72:75],v[116:119]
SA m0,s4,53248
R a[120:123],v21,32768
R a[124:127],v21,34816
M v[120:123],a[168:171],a[80:83],v[120:123]
C v64,v64,v65
C v65,v66,v67
M v[120:123],a[172:175],a[84:87],v[120:123]
s_waitcnt lgkmcnt(4)
buffer_load_dwordx4 v8, s[52:55], s25 offen lds
M v[124:127],a[172:175],a[92:95],v[124:127]
C v66,v96,v97
C v67,v98,v99
M v[124:127],a[168:171],a[88:91],v[124:127]
G v28,a20
G v29,a21
M v[128:131],a[160:163],a[32:35],v[128:131]
R a[168:171],v5,51200
R a[172:175],v6,51200
M v[128:131],a[164:167],a[36:39],v[128:131]
G v30,a22
G v31,a23
M v[132:135],a[164:167],a[44:47],v[132:135]
C v28,v28,v29
C v29,v30,v31
M v[132:135],a[160:163],a[40:43],v[132:135]
s_mov_b32 s25, 524416
C v30,v52,v53
C v31,v54,v55
M v[136:139],a[160:163],a[48:51],v[136:139]
SA m0,s4,57344
buffer_store_dwordx4 v[28:31], v7, s[8:11], s3 offen offset:2048 sc1
M v[136:139],a[164:167],a[52:55],v[136:139]
C v68,v68,v69
C v69,v70,v71
M v[140:143],a[164:167],a[60:63],v[140:143]
C v70,v100,v101
C v71,v102,v103
M v[140:143],a[160:163],a[56:59],v[140:143]
C v72,v72,v73
C v73,v74,v75
M v[144:147],a[160:163],a[64:67],v[144:147]
buffer_load_dwordx4 v8, s[52:55], s25 offen lds
M v[144:147],a[164:167],a[68:71],v[144:147]
C v74,v104,v105
C v75,v106,v107
M v[148:151],a[164:167],a[76:79],v[148:151]
C v76,v76,v77
C v77,v78,v79
M v[148:151],a[160:163],a[72:75],v[148:151]
C v78,v108,v109
C v79,v110,v111
M v[152:155],a[160:163],a[80:83],v[152:155]
C v80,v80,v81
C v81,v82,v83
M v[152:155],a[164:167],a[84:87],v[152:155]
s_waitcnt lgkmcnt(0)
C v82,v112,v113
C v83,v114,v115
M v[156:159],a[164:167],a[92:95],v[156:159]
s_mov_b32 s25, 786560
C v84,v84,v85
C v85,v86,v87
M v[156:159],a[160:163],a[88:91],v[156:159]
SA m0,s4,61440
C v86,v116,v117
C v87,v118,v119
M v[160:163],a[168:171],a[32:35],v[160:163]
R a[160:163],v5,53248
R a[164:167],v6,53248
M v[160:163],a[172:175],a[36:39],v[160:163]
buffer_load_dwordx4 v8, s[52:55], s25 offen lds
M v[164:167],a[172:175],a[44:47],v[164:167]
G v24,a24
G v25,a25
M v[164:167],a[168:171],a[40:43],v[164:167]
G v26,a26
G v27,a27
M v[168:171],a[168:171],a[48:51],v[168:171]
C v24,v24,v25
C v25,v26,v27
M v[168:171],a[172:175],a[52:55],v[168:171]
C v26,v56,v57
C v27,v58,v59
M v[172:175],a[172:175],a[60:63],v[172:175]
SA s3,s93,12288
buffer_store_dwordx4 v[24:27], v7, s[8:11], s3 offen offset:0 sc1
M v[172:175],a[168:171],a[56:59],v[172:175]
C v88,v88,v89
C v89,v90,v91
M v[176:179],a[168:171],a[64:67],v[176:179]
C v90,v120,v121
C v91,v122,v123
M v[176:179],a[172:175],a[68:71],v[176:179]
C v92,v92,v93
C v93,v94,v95
M v[180:183],a[172:175],a[76:79],v[180:183]
C v94,v124,v125
C v95,v126,v127
M v[180:183],a[168:171],a[72:75],v[180:183]
G v28,a28
G v29,a29
M v[184:187],a[168:171],a[80:83],v[184:187]
G v30,a30
G v31,a31
M v[184:187],a[172:175],a[84:87],v[184:187]
s_waitcnt lgkmcnt(0)
C v28,v28,v29
C v29,v30,v31
M v[188:191],a[172:175],a[92:95],v[188:191]
C v30,v60,v61
C v31,v62,v63
M v[188:191],a[168:171],a[88:91],v[188:191]
buffer_store_dwordx4 v[28:31], v7, s[8:11], s3 offen offset:2048 sc1
M v[192:195],a[160:163],a[32:35],v[192:195]
s_waitcnt vmcnt(18)
R a[168:171],v5,55296
R a[172:175],v6,55296
M v[192:195],a[164:167],a[36:39],v[192:195]
C v128,v128,v129
C v129,v130,v131
M v[196:199],a[164:167],a[44:47],v[196:199]
C v130,v160,v161
C v131,v162,v163
M v[196:199],a[160:163],a[40:43],v[196:199]
C v132,v132,v133
C v133,v134,v135
M v[200:203],a[160:163],a[48:51],v[200:203]
C v134,v164,v165
C v135,v166,v167
M v[200:203],a[164:167],a[52:55],v[200:203]
C v136,v136,v137
C v137,v138,v139
M v[204:207],a[164:167],a[60:63],v[204:207]
C v138,v168,v169
C v139,v170,v171
M v[204:207],a[160:163],a[56:59],v[204:207]
C v140,v140,v141
C v141,v142,v143
M v[208:211],a[160:163],a[64:67],v[208:211]
C v142,v172,v173
C v143,v174,v175
M v[208:211],a[164:167],a[68:71],v[208:211]
C v144,v144,v145
C v145,v146,v147
M v[212:215],a[164:167],a[76:79],v[212:215]
R a[128:131],v20,49152
R a[132:135],v20,51200
R a[136:139],v21,49152
R a[140:143],v21,51200
M v[212:215],a[160:163],a[72:75],v[212:215]
C v146,v176,v177
C v147,v178,v179
M v[216:219],a[160:163],a[80:83],v[216:219]
C v148,v148,v149
C v149,v150,v151
M v[216:219],a[164:167],a[84:87],v[216:219]
s_waitcnt lgkmcnt(4)
C v150,v180,v181
C v151,v182,v183
M v[220:223],a[164:167],a[92:95],v[220:223]
s_waitcnt vmcnt(10) lgkmcnt(0)
C v152,v152,v153
C v153,v154,v155
M v[220:223],a[160:163],a[88:91],v[220:223]
s_barrier
M v[224:227],a[168:171],a[32:35],v[224:227]
s_nop 0
T v[32:33],v16,0
T v[34:35],v16,2048
M v[224:227],a[172:175],a[36:39],v[224:227]
C v154,v184,v185
C v155,v186,v187
M v[228:231],a[172:175],a[44:47],v[228:231]
T v[36:37],v16,4096
T v[38:39],v16,6144
M v[228:231],a[168:171],a[40:43],v[228:231]
T v[40:41],v16,8192
T v[42:43],v16,10240
M v[232:235],a[168:171],a[48:51],v[232:235]
C v156,v156,v157
C v157,v158,v159
M v[232:235],a[172:175],a[52:55],v[232:235]
T v[44:45],v16,12288
T v[46:47],v16,14336
M v[236:239],a[172:175],a[60:63],v[236:239]
T v[48:49],v16,16384
T v[50:51],v16,18432
M v[236:239],a[168:171],a[56:59],v[236:239]
C v158,v188,v189
C v159,v190,v191
M v[240:243],a[168:171],a[64:67],v[240:243]
T v[52:53],v16,20480
T v[54:55],v16,22528
M v[240:243],a[172:175],a[68:71],v[240:243]
T v[56:57],v16,24576
T v[58:59],v16,26624
M v[244:247],a[172:175],a[76:79],v[244:247]
C v192,v192,v193
C v193,v194,v195
M v[244:247],a[168:171],a[72:75],v[244:247]
C v194,v224,v225
C v195,v226,v227
M v[248:251],a[168:171],a[80:83],v[248:251]
C v196,v196,v197
C v197,v198,v199
M v[248:251],a[172:175],a[84:87],v[248:251]
C v198,v228,v229
C v199,v230,v231
M v[252:255],a[172:175],a[92:95],v[252:255]
C v200,v200,v201
C v201,v202,v203
M v[252:255],a[168:171],a[88:91],v[252:255]
s_waitcnt lgkmcnt(6)
C v202,v232,v233
C v203,v234,v235
M v[96:99],v[32:35],a[176:179],0
s_mul_i32 s72, s41, 4352
T a[144:145],v17,0
T a[146:147],v17,2048
M v[96:99],v[36:39],a[184:187],v[96:99]
s_mov_b32 s25, 1048704
C v204,v204,v205
C v205,v206,v207
M v[96:99],v[40:43],a[192:195],v[96:99]
s_waitcnt lgkmcnt(2)
T a[148:149],v17,4096
T a[150:151],v17,6144
M v[96:99],v[44:47],a[200:203],v[96:99]
SA m0,s4,98304
T a[152:153],v17,8192
T a[154:155],v17,10240
M v[96:99],v[48:51],a[208:211],v[96:99]
SA s46,s72,104923136
buffer_load_dwordx4 v8, s[52:55], s25 offen lds
M v[96:99],v[52:55],a[216:219],v[96:99]
s_lshl_b32 s45, s42, 7
T a[156:157],v17,12288
T a[158:159],v17,14336
M v[96:99],v[56:59],a[224:227],v[96:99]
s_mov_b32 s25, 1310848
T a[160:161],v17,16384
T a[162:163],v17,18432
M v[100:103],v[56:59],a[228:231],0
SA m0,s4,102400
C v206,v236,v237
C v207,v238,v239
M v[100:103],v[52:55],a[220:223],v[100:103]
SA s45,s45,s46
T a[164:165],v17,20480
T a[166:167],v17,22528
M v[100:103],v[48:51],a[212:215],v[100:103]
s_lshl_b32 s72, s20, 2
T a[168:169],v17,24576
T a[170:171],v17,26624
M v[100:103],v[44:47],a[204:207],v[100:103]
SA s72,s72,s45
buffer_load_dwordx4 v8, s[52:55], s25 offen lds
M v[100:103],v[40:43],a[196:199],v[100:103]
C v208,v208,v209
C v209,v210,v211
M v[100:103],v[36:39],a[188:191],v[100:103]
s_mov_b32 s25, 1572992
C v210,v240,v241
C v211,v242,v243
M v[100:103],v[32:35],a[180:183],v[100:103]
s_waitcnt lgkmcnt(6)
C v212,v212,v213
C v213,v214,v215
M v[104:107],a[144:147],a[176:179],0
SA m0,s4,106496
T v[32:33],v18,0
T v[34:35],v18,2048
M v[104:107],a[148:151],a[184:187],v[104:107]
buffer_load_dwordx4 v8, s[52:55], s25 offen lds
M v[104:107],a[152:155],a[192:195],v[104:107]
s_waitcnt lgkmcnt(2)
s_nop 0
T v[36:37],v18,4096
T v[38:39],v18,6144
M v[104:107],a[156:159],a[200:203],v[104:107]
s_mov_b32 s25, 1835136
T v[40:41],v18,8192
T v[42:43],v18,10240
M v[104:107],a[160:163],a[208:211],v[104:107]
SA m0,s4,110592
C v214,v244,v245
C v215,v246,v247
M v[104:107],a[164:167],a[216:219],v[104:107]
T v[44:45],v18,12288
T v[46:47],v18,14336
M v[104:107],a[168:171],a[224:227],v[104:107]
T v[48:49],v18,16384
T v[50:51],v18,18432
M v[108:111],a[168:171],a[228:231],0
buffer_load_dwordx4 v8, s[52:55], s25 offen lds
M v[108:111],a[164:167],a[220:223],v[108:111]
s_nop 0
T v[52:53],v18,20480
T v[54:55],v18,22528
M v[108:111],a[160:163],a[212:215],v[108:111]
s_mov_b32 s25, 2097280
T v[56:57],v18,24576
T v[58:59],v18,26624
M v[108:111],a[156:159],a[204:207],v[108:111]
SA m0,s4,114688
C v216,v216,v217
C v217,v218,v219
M v[108:111],a[152:155],a[196:199],v[108:111]
SA s3,s93,524288
buffer_load_dwordx4 v8, s[52:55], s25 offen lds
M v[108:111],a[148:151],a[188:191],v[108:111]
C v218,v248,v249
C v219,v250,v251
M v[108:111],a[144:147],a[180:183],v[108:111]
s_waitcnt lgkmcnt(6)
buffer_store_dwordx4 v[64:67], v7, s[8:11], s3 offen offset:0 sc1
M v[112:115],v[32:35],a[176:179],0
s_mov_b32 s25, 2359424
T a[144:145],v19,0
T a[146:147],v19,2048
M v[112:115],v[36:39],a[184:187],v[112:115]
SA m0,s4,118784
buffer_store_dwordx4 v[68:71], v7, s[8:11], s3 offen offset:2048 sc1
M v[112:115],v[40:43],a[192:195],v[112:115]
s_waitcnt lgkmcnt(2)
s_nop 0
T a[148:149],v19,4096
T a[150:151],v19,6144
M v[112:115],v[44:47],a[200:203],v[112:115]
T a[152:153],v19,8192
T a[154:155],v19,10240
M v[112:115],v[48:51],a[208:211],v[112:115]
buffer_load_dwordx4 v8, s[52:55], s25 offen lds
M v[112:115],v[52:55],a[216:219],v[112:115]
s_nop 0
T a[156:157],v19,12288
T a[158:159],v19,14336
M v[112:115],v[56:59],a[224:227],v[112:115]
s_mov_b32 s25, 2621568
T a[160:161],v19,16384
T a[162:163],v19,18432
M v[116:119],v[56:59],a[228:231],0
SA m0,s4,122880
C v220,v220,v221
C v221,v222,v223
M v[116:119],v[52:55],a[220:223],v[116:119]
T a[164:165],v19,20480
T a[166:167],v19,22528
M v[116:119],v[48:51],a[212:215],v[116:119]
T a[168:169],v19,24576
T a[170:171],v19,26624
M v[116:119],v[44:47],a[204:207],v[116:119]
buffer_load_dwordx4 v8, s[52:55], s25 offen lds
M v[116:119],v[40:43],a[196:199],v[116:119]
C v222,v252,v253
C v223,v254,v255
M v[116:119],v[36:39],a[188:191],v[116:119]
s_mov_b32 s25, 2883712
v_min_u32 v29, 1, v0
v_lshlrev_b32 v29, 29, v29
M v[116:119],v[32:35],a[180:183],v[116:119]
s_waitcnt lgkmcnt(6)
v_mov_b32 v30, 1
v_add_u32 v20, 0x10000, v16
M v[120:123],a[144:147],a[176:179],0
SA m0,s4,126976
T v[32:33],v16,28672
T v[34:35],v16,30720
M v[120:123],a[148:151],a[184:187],v[120:123]
buffer_load_dwordx4 v8, s[52:55], s25 offen lds
M v[120:123],a[152:155],a[192:195],v[120:123]
s_waitcnt lgkmcnt(2)
s_nop 0
T v[36:37],v12,0
T v[38:39],v12,2048
M v[120:123],a[156:159],a[200:203],v[120:123]
s_mov_b32 s25, 3145856
T v[40:41],v12,4096
T v[42:43],v12,6144
M v[120:123],a[160:163],a[208:211],v[120:123]
SA m0,s4,32768
v_add_u32 v21, 0x10000, v17
v_add_u32 v22, 0x10000, v18
M v[120:123],a[164:167],a[216:219],v[120:123]
T v[44:45],v12,8192
T v[46:47],v12,10240
M v[120:123],a[168:171],a[224:227],v[120:123]
T v[48:49],v12,12288
T v[50:51],v12,14336
M v[124:127],a[168:171],a[228:231],0
buffer_load_dwordx4 v8, s[52:55], s25 offen lds
M v[124:127],a[164:167],a[220:223],v[124:127]
s_nop 0
T v[52:53],v12,16384
T v[54:55],v12,18432
M v[124:127],a[160:163],a[212:215],v[124:127]
s_mov_b32 s25, 3408000
T v[56:57],v12,20480
T v[58:59],v12,22528
M v[124:127],a[156:159],a[204:207],v[124:127]
SA m0,s4,36864
v_add_u32 v23, 0x10000, v19
v_or_b32 v1, s20, v0
M v[124:127],a[152:155],a[196:199],v[124:127]
SA s3,s93,528384
buffer_load_dwordx4 v8, s[52:55], s25 offen lds
M v[124:127],a[148:151],a[188:191],v[124:127]
v_min_u32 v1, 1, v1
v_lshlrev_b32 v1, 29, v1
M v[124:127],a[144:147],a[180:183],v[124:127]
s_waitcnt lgkmcnt(6)
buffer_store_dwordx4 v[72:75], v7, s[8:11], s3 offen offset:0 sc1
M v[96:99],v[32:35],a[232:235],v[96:99]
s_mov_b32 s25, 256
T a[144:145],v17,28672
T a[146:147],v17,30720
M v[96:99],v[36:39],a[96:99],v[96:99]
SA m0,s4,65536
v_min_u32 v9, 15, v0
v_lshlrev_b32 v9, 7, v9
M v[96:99],v[40:43],a[104:107],v[96:99]
s_waitcnt lgkmcnt(2)
T a[148:149],v13,0
T a[150:151],v13,2048
M v[96:99],v[44:47],a[112:115],v[96:99]
s_sub_u32 s66, 15, s42
T a[152:153],v13,4096
T a[154:155],v13,6144
M v[96:99],v[48:51],a[120:123],v[96:99]
s_max_u32 s67, s66, s42
buffer_load_dwordx4 v8, s[52:55], s25 offen lds
M v[96:99],v[52:55],a[128:131],v[96:99]
s_min_u32 s66, s66, s42
T a[156:157],v13,8192
T a[158:159],v13,10240
M v[96:99],v[56:59],a[136:139],v[96:99]
s_mov_b32 s25, 262400
T a[160:161],v13,12288
T a[162:163],v13,14336
M v[100:103],v[56:59],a[140:143],v[100:103]
SA m0,s4,69632
M v[100:103],v[52:55],a[132:135],v[100:103]
s_mul_i32 s21, s41, 1048576
T a[164:165],v13,16384
T a[166:167],v13,18432
M v[100:103],v[48:51],a[124:127],v[100:103]
s_lshl_b32 s64, s67, 16
T a[168:169],v13,20480
T a[170:171],v13,22528
L_w_kv18:
s_cbranch_execz L_wd2
M v[100:103],v[44:47],a[116:119],v[100:103]
SA s32,s21,s64
buffer_load_dwordx4 v8, s[52:55], s25 offen lds
M v[100:103],v[40:43],a[108:111],v[100:103]
s_lshl_b32 s64, s20, 14
M v[100:103],v[36:39],a[100:103],v[100:103]
s_mov_b32 s25, 524544
M v[100:103],v[32:35],a[236:239],v[100:103]
s_waitcnt lgkmcnt(6)
M v[104:107],a[144:147],a[232:235],v[104:107]
SA m0,s4,73728
T v[32:33],v18,28672
T v[34:35],v18,30720
M v[104:107],a[148:151],a[96:99],v[104:107]
SA s32,s32,s64
buffer_load_dwordx4 v8, s[52:55], s25 offen lds
M v[104:107],a[152:155],a[104:107],v[104:107]
s_waitcnt lgkmcnt(2)
s_nop 0
T v[36:37],v14,0
T v[38:39],v14,2048
M v[104:107],a[156:159],a[112:115],v[104:107]
s_mov_b32 s25, 786688
T v[40:41],v14,4096
T v[42:43],v14,6144
M v[104:107],a[160:163],a[120:123],v[104:107]
SA m0,s4,77824
M v[104:107],a[164:167],a[128:131],v[104:107]
SA s32,s32,33554432
T v[44:45],v14,8192
T v[46:47],v14,10240
M v[104:107],a[168:171],a[136:139],v[104:107]
s_sub_u32 s64, s42, 10
T v[48:49],v14,12288
T v[50:51],v14,14336
M v[108:111],a[168:171],a[140:143],v[108:111]
s_and_b32 s35, s64, 536870912
buffer_load_dwordx4 v8, s[52:55], s25 offen lds
M v[108:111],a[164:167],a[132:135],v[108:111]
s_nop 0
T v[52:53],v14,16384
T v[54:55],v14,18432
M v[108:111],a[160:163],a[124:127],v[108:111]
s_mov_b32 s25, 1048832
T v[56:57],v14,20480
T v[58:59],v14,22528
M v[108:111],a[156:159],a[116:119],v[108:111]
SA m0,s4,81920
v_or_b32 v6, s35, v7
MF v96,s5,v96
M v[108:111],a[152:155],a[108:111],v[108:111]
s_lshl_b32 s28, s20, 13
buffer_load_dwordx4 v8, s[52:55], s25 offen lds
M v[108:111],a[148:151],a[100:103],v[108:111]
v_add_u32 v2, 0x10000, v7
v_add_u32 v3, s28, v7
M v[108:111],a[144:147],a[236:239],v[108:111]
s_waitcnt lgkmcnt(6)
v_add_u32 v4, 0x1000, v3
MF v97,s5,v97
M v[112:115],v[32:35],a[232:235],v[112:115]
s_mov_b32 s25, 1310976
T a[144:145],v19,28672
T a[146:147],v19,30720
M v[112:115],v[36:39],a[96:99],v[112:115]
SA m0,s4,86016
MF v98,s5,v98
MF v99,s5,v99
M v[112:115],v[40:43],a[104:107],v[112:115]
s_waitcnt lgkmcnt(2)
T a[148:149],v15,0
T a[150:151],v15,2048
M v[112:115],v[44:47],a[112:115],v[112:115]
s_lshl_b32 s64, s42, 16
T a[152:153],v15,4096
T a[154:155],v15,6144
M v[112:115],v[48:51],a[120:123],v[112:115]
SA s23,s21,s64
buffer_load_dwordx4 v8, s[52:55], s25 offen lds
M v[112:115],v[52:55],a[128:131],v[112:115]
SA s43,s23,16777216
T a[156:157],v15,8192
T a[158:159],v15,10240
M v[112:115],v[56:59],a[136:139],v[112:115]
s_mov_b32 s25, 1573120
T a[160:161],v15,12288
T a[162:163],v15,14336
M v[116:119],v[56:59],a[140:143],v[116:119]
SA m0,s4,90112
MF v104,s5,v104
MF v105,s5,v105
M v[116:119],v[52:55],a[132:135],v[116:119]
SA s26,s21,16777216
T a[164:165],v15,16384
T a[166:167],v15,18432
M v[116:119],v[48:51],a[124:127],v[116:119]
s_min_u32 s27, s42, 9
T a[168:169],v15,20480
T a[170:171],v15,22528
M v[116:119],v[44:47],a[116:119],v[116:119]
s_lshl_b32 s22, s27, 1
buffer_load_dwordx4 v8, s[52:55], s25 offen lds
M v[116:119],v[40:43],a[108:111],v[116:119]
s_sub_u32 s22, s22, 1
MF v106,s5,v106
MF v107,s5,v107
M v[116:119],v[36:39],a[100:103],v[116:119]
s_waitcnt vmcnt(8) lgkmcnt(0)
C v96,v96,v97
C v97,v98,v99
M v[116:119],v[32:35],a[236:239],v[116:119]
s_barrier
M v[120:123],a[144:147],a[232:235],v[120:123]
s_mov_b32 s25, 1835264
T v[32:33],v16,49152
T v[34:35],v16,51200
M v[120:123],a[148:151],a[96:99],v[120:123]
SA m0,s4,94208
C v98,v104,v105
C v99,v106,v107
M v[120:123],a[152:155],a[104:107],v[120:123]
s_sub_u32 s27, s27, 2
T v[36:37],v16,53248
T v[38:39],v16,55296
M v[120:123],a[156:159],a[112:115],v[120:123]
s_mov_b32 s31, 0x4b800000
T v[40:41],v16,57344
T v[42:43],v16,59392
M v[120:123],a[160:163],a[120:123],v[120:123]
s_mov_b32 s24, 0x33800000
buffer_load_dwordx4 v8, s[52:55], s25 offen lds
M v[120:123],a[164:167],a[128:131],v[120:123]
s_lshl_b32 s47, s66, 7
T v[44:45],v16,61440
T v[46:47],v16,63488
M v[120:123],a[168:171],a[136:139],v[120:123]
s_mov_b32 s25, 2097408
T v[48:49],v20,32768
T v[50:51],v20,34816
M v[124:127],a[168:171],a[140:143],v[124:127]
SA m0,s4,155648
W a0,v96
W a1,v97
M v[124:127],a[164:167],a[132:135],v[124:127]
SA s47,s47,s46
T v[52:53],v20,36864
T v[54:55],v20,38912
M v[124:127],a[160:163],a[124:127],v[124:127]
s_lshl_b32 s64, s20, 5
T v[56:57],v20,40960
T v[58:59],v20,43008
M v[124:127],a[156:159],a[116:119],v[124:127]
SA s47,s47,s64
buffer_load_dwordx4 v8, s[52:55], s25 offen lds
M v[124:127],a[152:155],a[108:111],v[124:127]
SA s47,s47,2048
W a2,v98
W a3,v99
M v[124:127],a[148:151],a[100:103],v[124:127]
s_lshl_b32 s65, s41, 3
MF v100,s5,v100
MF v101,s5,v101
M v[124:127],a[144:147],a[236:239],v[124:127]
s_waitcnt lgkmcnt(6)
MF v102,s5,v102
MF v103,s5,v103
M v[160:163],v[32:35],a[176:179],0
SA s65,s65,s66
T a[144:145],v17,49152
T a[146:147],v17,51200
M v[160:163],v[36:39],a[184:187],v[160:163]
s_mul_i32 s34, s65, 73728
MF v108,s5,v108
MF v109,s5,v109
M v[160:163],v[40:43],a[192:195],v[160:163]
s_waitcnt lgkmcnt(2)
T a[148:149],v17,53248
T a[150:151],v17,55296
M v[160:163],v[44:47],a[200:203],v[160:163]
SA s34,s34,136314880
T a[152:153],v17,57344
T a[154:155],v17,59392
M v[160:163],v[48:51],a[208:211],v[160:163]
s_lshl_b32 s65, s42, 4
MF v110,s5,v110
MF v111,s5,v111
M v[160:163],v[52:55],a[216:219],v[160:163]
SA s65,s65,s41
T a[156:157],v17,61440
T a[158:159],v17,63488
M v[160:163],v[56:59],a[224:227],v[160:163]
s_mul_i32 s33, s65, 114688
T a[160:161],v21,32768
T a[162:163],v21,34816
M v[164:167],v[56:59],a[228:231],0
s_mul_i32 s65, s20, 28672
C v100,v100,v101
C v101,v102,v103
M v[164:167],v[52:55],a[220:223],v[164:167]
SA s33,s33,s65
T a[164:165],v21,36864
T a[166:167],v21,38912
M v[164:167],v[48:51],a[212:215],v[164:167]
SA s33,s33,67108864
T a[168:169],v21,40960
T a[170:171],v21,43008
M v[164:167],v[44:47],a[204:207],v[164:167]
s_mov_b32 s6, 0
C v102,v108,v109
C v103,v110,v111
M v[164:167],v[40:43],a[196:199],v[164:167]
s_mov_b32 s7, 1
W a32,v100
W a33,v101
M v[164:167],v[36:39],a[188:191],v[164:167]
s_mov_b32 s40, 1
W a34,v102
W a35,v103
M v[164:167],v[32:35],a[180:183],v[164:167]
s_waitcnt lgkmcnt(6)
MF v112,s5,v112
MF v113,s5,v113
M v[168:171],a[144:147],a[176:179],0
s_cmp_eq_u32 s20, 0
T v[32:33],v18,49152
T v[34:35],v18,51200
M v[168:171],a[148:151],a[184:187],v[168:171]
s_cselect_b32 s39, 6, 4
MF v114,s5,v114
MF v115,s5,v115
M v[168:171],a[152:155],a[192:195],v[168:171]
s_waitcnt lgkmcnt(2)
T v[36:37],v18,53248
T v[38:39],v18,55296
M v[168:171],a[156:159],a[200:203],v[168:171]
s_mov_b64 s[60:61], s[76:77]
T v[40:41],v18,57344
T v[42:43],v18,59392
M v[168:171],a[160:163],a[208:211],v[168:171]
s_mov_b32 s62, s78
MF v120,s5,v120
MF v121,s5,v121
M v[168:171],a[164:167],a[216:219],v[168:171]
s_mov_b32 s63, 0x20000
T v[44:45],v18,61440
T v[46:47],v18,63488
M v[168:171],a[168:171],a[224:227],v[168:171]
SA s30,s32,0
T v[48:49],v22,32768
T v[50:51],v22,34816
M v[172:175],a[168:171],a[228:231],0
s_mov_b32 s25, 2359552
buffer_store_dwordx4 a[0:3], v6, s[8:11], s30 offen offset:0 sc1
M v[172:175],a[164:167],a[220:223],v[172:175]
SA m0,s4,159744
T v[52:53],v22,36864
T v[54:55],v22,38912
M v[172:175],a[160:163],a[212:215],v[172:175]
T v[56:57],v22,40960
T v[58:59],v22,43008
M v[172:175],a[156:159],a[204:207],v[172:175]
SA s3,s93,528384
buffer_load_dwordx4 v8, s[52:55], s25 offen lds
M v[172:175],a[152:155],a[196:199],v[172:175]
buffer_store_dword v30, v29, s[8:11], s72 offen offset:4 sc1
M v[172:175],a[148:151],a[188:191],v[172:175]
s_mov_b32 s25, 2621696
buffer_store_dwordx4 v[76:79], v7, s[8:11], s3 offen offset:2048 sc1
M v[172:175],a[144:147],a[180:183],v[172:175]
s_waitcnt lgkmcnt(6)
v_lshrrev_b32 v24, 4, v0
v_lshlrev_b32 v24, 2, v24
M v[176:179],v[32:35],a[176:179],0
SA m0,s4,131072
T a[144:145],v19,49152
T a[146:147],v19,51200
M v[176:179],v[36:39],a[184:187],v[176:179]
buffer_load_dwordx4 v8, s[52:55], s25 offen lds
M v[176:179],v[40:43],a[192:195],v[176:179]
s_waitcnt lgkmcnt(2)
s_nop 0
T a[148:149],v19,53248
T a[150:151],v19,55296
M v[176:179],v[44:47],a[200:203],v[176:179]
s_mov_b32 s25, 2883840
T a[152:153],v19,57344
T a[154:155],v19,59392
M v[176:179],v[48:51],a[208:211],v[176:179]
SA m0,s4,135168
v_and_b32 v25, 15, v0
v_sub_u32 v24, v24, v25
M v[176:179],v[52:55],a[216:219],v[176:179]
T a[156:157],v19,61440
T a[158:159],v19,63488
M v[176:179],v[56:59],a[224:227],v[176:179]
T a[160:161],v23,32768
T a[162:163],v23,34816
M v[180:183],v[56:59],a[228:231],0
buffer_load_dwordx4 v8, s[52:55], s25 offen lds
M v[180:183],v[52:55],a[220:223],v[180:183]
s_nop 0
T a[164:165],v23,36864
T a[166:167],v23,38912
M v[180:183],v[48:51],a[212:215],v[180:183]
s_mov_b32 s25, 3145984
T a[168:169],v23,40960
T a[170:171],v23,43008
M v[180:183],v[44:47],a[204:207],v[180:183]
SA m0,s4,139264
v_cmp_lt_i32 s[16:17], 0, v24
v_cmp_lt_i32 s[18:19], -1, v24
M v[180:183],v[40:43],a[196:199],v[180:183]
buffer_load_dwordx4 v8, s[52:55], s25 offen lds
M v[180:183],v[36:39],a[188:191],v[180:183]
v_cmp_lt_i32 s[48:49], -2, v24
v_cmp_lt_i32 s[50:51], -3, v24
M v[180:183],v[32:35],a[180:183],v[180:183]
s_waitcnt lgkmcnt(6)
v_lshl_add_u32 v25, v0, 7, s95
v_and_b32 v0, 48, v0
M v[184:187],a[144:147],a[176:179],0
s_mov_b32 s25, 3408128
T v[32:33],v20,45056
T v[34:35],v20,47104
M v[184:187],a[148:151],a[184:187],v[184:187]
SA m0,s4,143360
MF v122,s5,v122
MF v123,s5,v123
M v[184:187],a[152:155],a[192:195],v[184:187]
s_waitcnt lgkmcnt(2)
T v[36:37],v20,49152
T v[38:39],v20,51200
M v[184:187],a[156:159],a[200:203],v[184:187]
SA s30,s32,8192
T v[40:41],v20,53248
T v[42:43],v20,55296
M v[184:187],a[160:163],a[208:211],v[184:187]
buffer_store_dwordx4 a[32:35], v6, s[8:11], s30 offen offset:0 sc1
M v[184:187],a[164:167],a[216:219],v[184:187]
s_nop 0
T v[44:45],v20,57344
T v[46:47],v20,59392
M v[184:187],a[168:171],a[224:227],v[184:187]
T v[48:49],v20,61440
T v[50:51],v20,63488
M v[188:191],a[168:171],a[228:231],0
buffer_load_dwordx4 v8, s[52:55], s25 offen lds
M v[188:191],a[164:167],a[220:223],v[188:191]
SA s3,s93,532480
T v[52:53],v16,32768
T v[54:55],v16,34816
M v[188:191],a[160:163],a[212:215],v[188:191]
s_mov_b32 s25, 384
T v[56:57],v16,36864
T v[58:59],v16,38912
M v[188:191],a[156:159],a[204:207],v[188:191]
SA m0,s4,0
buffer_store_dwordx4 v[80:83], v7, s[8:11], s3 offen offset:0 sc1
M v[188:191],a[152:155],a[196:199],v[188:191]
C v112,v112,v113
C v113,v114,v115
M v[188:191],a[148:151],a[188:191],v[188:191]
buffer_load_dwordx4 v8, s[52:55], s25 offen lds
M v[188:191],a[144:147],a[180:183],v[188:191]
s_waitcnt lgkmcnt(6)
C v114,v120,v121
C v115,v122,v123
M v[160:163],v[32:35],a[232:235],v[160:163]
s_mov_b32 s25, 262528
T a[144:145],v21,45056
T a[146:147],v21,47104
M v[160:163],v[36:39],a[96:99],v[160:163]
SA m0,s4,4096
buffer_store_dwordx4 v[84:87], v7, s[8:11], s3 offen offset:2048 sc1
M v[160:163],v[40:43],a[104:107],v[160:163]
s_waitcnt lgkmcnt(2)
s_nop 0
T a[148:149],v21,49152
T a[150:151],v21,51200
M v[160:163],v[44:47],a[112:115],v[160:163]
T a[152:153],v21,53248
T a[154:155],v21,55296
M v[160:163],v[48:51],a[120:123],v[160:163]
buffer_load_dwordx4 v8, s[52:55], s25 offen lds
M v[160:163],v[52:55],a[128:131],v[160:163]
s_nop 0
T a[156:157],v21,57344
T a[158:159],v21,59392
M v[160:163],v[56:59],a[136:139],v[160:163]
s_mov_b32 s25, 524672
T a[160:161],v21,61440
T a[162:163],v21,63488
M v[164:167],v[56:59],a[140:143],v[164:167]
SA m0,s4,8192
W a4,v112
W a5,v113
M v[164:167],v[52:55],a[132:135],v[164:167]
T a[164:165],v17,32768
T a[166:167],v17,34816
M v[164:167],v[48:51],a[124:127],v[164:167]
T a[168:169],v17,36864
T a[170:171],v17,38912
M v[164:167],v[44:47],a[116:119],v[164:167]
buffer_load_dwordx4 v8, s[52:55], s25 offen lds
M v[164:167],v[40:43],a[108:111],v[164:167]
W a6,v114
W a7,v115
M v[164:167],v[36:39],a[100:103],v[164:167]
s_mov_b32 s25, 786816
v_lshl_add_u32 v0, v0, 24, v25
v_mov_b32 v24, 0x3f80
M v[164:167],v[32:35],a[236:239],v[164:167]
s_waitcnt lgkmcnt(6)
MF v116,s5,v116
MF v117,s5,v117
M v[168:171],a[144:147],a[232:235],v[168:171]
SA s30,s32,0
T v[32:33],v22,45056
T v[34:35],v22,47104
M v[168:171],a[148:151],a[96:99],v[168:171]
SA m0,s4,12288
buffer_store_dwordx4 a[4:7], v6, s[8:11], s30 offen offset:1024 sc1
M v[168:171],a[152:155],a[104:107],v[168:171]
s_waitcnt lgkmcnt(2)
s_nop 0
T v[36:37],v22,49152
T v[38:39],v22,51200
M v[168:171],a[156:159],a[112:115],v[168:171]
T v[40:41],v22,53248
T v[42:43],v22,55296
M v[168:171],a[160:163],a[120:123],v[168:171]
buffer_load_dwordx4 v8, s[52:55], s25 offen lds
M v[168:171],a[164:167],a[128:131],v[168:171]
s_nop 0
T v[44:45],v22,57344
T v[46:47],v22,59392
M v[168:171],a[168:171],a[136:139],v[168:171]
s_mov_b32 s25, 1048960
T v[48:49],v22,61440
T v[50:51],v22,63488
M v[172:175],a[168:171],a[140:143],v[172:175]
SA m0,s4,16384
MF v118,s5,v118
MF v119,s5,v119
M v[172:175],a[164:167],a[132:135],v[172:175]
T v[52:53],v18,32768
T v[54:55],v18,34816
M v[172:175],a[160:163],a[124:127],v[172:175]
T v[56:57],v18,36864
T v[58:59],v18,38912
M v[172:175],a[156:159],a[116:119],v[172:175]
buffer_load_dwordx4 v8, s[52:55], s25 offen lds
M v[172:175],a[152:155],a[108:111],v[172:175]
MF v124,s5,v124
MF v125,s5,v125
M v[172:175],a[148:151],a[100:103],v[172:175]
s_mov_b32 s25, 1311104
v_lshrrev_b32 v25, 8, v7
v_bfe_u32 v26, v7, 6, 2
v_and_b32 v27, 16, v7
v_lshlrev_b32 v27, v27, v24
v_cmp_eq_u32 vcc, v25, v26
v_and_b32 v28, 32, v7
W a244,0
v_cndmask_b32 v27, 0, v27, vcc
v_cmp_eq_u32 vcc, 0, v28
W a245,0
W a248,0
v_cndmask_b32 v25, 0, v27, vcc
v_sub_u32 v26, v27, v25
W a249,0
W a246,v25
W a247,v26
M v[172:175],a[144:147],a[236:239],v[172:175]
s_waitcnt lgkmcnt(6)
MF v126,s5,v126
MF v127,s5,v127
M v[176:179],v[32:35],a[232:235],v[176:179]
SA m0,s4,20480
T a[144:145],v23,45056
T a[146:147],v23,47104
M v[176:179],v[36:39],a[96:99],v[176:179]
buffer_load_dwordx4 v8, s[52:55], s25 offen lds
M v[176:179],v[40:43],a[104:107],v[176:179]
s_waitcnt lgkmcnt(2)
s_nop 0
T a[148:149],v23,49152
T a[150:151],v23,51200
M v[176:179],v[44:47],a[112:115],v[176:179]
s_mov_b32 s25, 1573248
T a[152:153],v23,53248
T a[154:155],v23,55296
M v[176:179],v[48:51],a[120:123],v[176:179]
SA m0,s4,24576
C v116,v116,v117
C v117,v118,v119
M v[176:179],v[52:55],a[128:131],v[176:179]
T a[156:157],v23,57344
T a[158:159],v23,59392
M v[176:179],v[56:59],a[136:139],v[176:179]
T a[160:161],v23,61440
T a[162:163],v23,63488
M v[180:183],v[56:59],a[140:143],v[180:183]
buffer_load_dwordx4 v8, s[52:55], s25 offen lds
M v[180:183],v[52:55],a[132:135],v[180:183]
s_nop 0
T a[164:165],v19,32768
T a[166:167],v19,34816
M v[180:183],v[48:51],a[124:127],v[180:183]
s_mov_b32 s25, 1835392
T a[168:169],v19,36864
T a[170:171],v19,38912
M v[180:183],v[44:47],a[116:119],v[180:183]
SA m0,s4,28672
C v118,v124,v125
C v119,v126,v127
M v[180:183],v[40:43],a[108:111],v[180:183]
buffer_load_dwordx4 v8, s[52:55], s25 offen lds
M v[180:183],v[36:39],a[100:103],v[180:183]
s_waitcnt vmcnt(11) lgkmcnt(0)
W a36,v116
W a37,v117
M v[180:183],v[32:35],a[236:239],v[180:183]
s_barrier
M v[184:187],a[144:147],a[232:235],v[184:187]
s_mov_b32 s25, 2097536
T v[32:33],v20,0
T v[34:35],v20,2048
M v[184:187],a[148:151],a[96:99],v[184:187]
SA m0,s4,40960
W a38,v118
W a39,v119
M v[184:187],a[152:155],a[104:107],v[184:187]
SA s30,s32,8192
T v[36:37],v20,4096
T v[38:39],v20,6144
M v[184:187],a[156:159],a[112:115],v[184:187]
T v[40:41],v20,8192
T v[42:43],v20,10240
M v[184:187],a[160:163],a[120:123],v[184:187]
buffer_store_dwordx4 a[36:39], v6, s[8:11], s30 offen offset:1024 sc1
M v[184:187],a[164:167],a[128:131],v[184:187]
s_nop 0
T v[44:45],v20,12288
T v[46:47],v20,14336
M v[184:187],a[168:171],a[136:139],v[184:187]
T v[48:49],v20,16384
T v[50:51],v20,18432
M v[188:191],a[168:171],a[140:143],v[188:191]
buffer_load_dwordx4 v8, s[52:55], s25 offen lds
M v[188:191],a[164:167],a[132:135],v[188:191]
s_nop 0
T v[52:53],v20,20480
T v[54:55],v20,22528
M v[188:191],a[160:163],a[124:127],v[188:191]
s_mov_b32 s25, 2359680
T v[56:57],v20,24576
T v[58:59],v20,26624
M v[188:191],a[156:159],a[116:119],v[188:191]
SA m0,s4,45056
MF v160,s5,v160
MF v161,s5,v161
M v[188:191],a[152:155],a[108:111],v[188:191]
buffer_load_dwordx4 v8, s[52:55], s25 offen lds
M v[188:191],a[148:151],a[100:103],v[188:191]
MF v162,s5,v162
MF v163,s5,v163
M v[188:191],a[144:147],a[236:239],v[188:191]
s_waitcnt lgkmcnt(6)
MF v168,s5,v168
MF v169,s5,v169
M v[96:99],v[32:35],a[176:179],0
s_mov_b32 s25, 2621824
T a[144:145],v21,0
T a[146:147],v21,2048
M v[96:99],v[36:39],a[184:187],v[96:99]
SA m0,s4,49152
MF v170,s5,v170
MF v171,s5,v171
M v[96:99],v[40:43],a[192:195],v[96:99]
s_waitcnt lgkmcnt(2)
T a[148:149],v21,4096
T a[150:151],v21,6144
M v[96:99],v[44:47],a[200:203],v[96:99]
T a[152:153],v21,8192
T a[154:155],v21,10240
M v[96:99],v[48:51],a[208:211],v[96:99]
buffer_load_dwordx4 v8, s[52:55], s25 offen lds
M v[96:99],v[52:55],a[216:219],v[96:99]
s_nop 0
T a[156:157],v21,12288
T a[158:159],v21,14336
M v[96:99],v[56:59],a[224:227],v[96:99]
s_mov_b32 s25, 2883968
T a[160:161],v21,16384
T a[162:163],v21,18432
M v[100:103],v[56:59],a[228:231],0
SA m0,s4,53248
C v160,v160,v161
C v161,v162,v163
M v[100:103],v[52:55],a[220:223],v[100:103]
T a[164:165],v21,20480
T a[166:167],v21,22528
M v[100:103],v[48:51],a[212:215],v[100:103]
T a[168:169],v21,24576
T a[170:171],v21,26624
M v[100:103],v[44:47],a[204:207],v[100:103]
SA s3,s93,536576
buffer_load_dwordx4 v8, s[52:55], s25 offen lds
M v[100:103],v[40:43],a[196:199],v[100:103]
C v162,v168,v169
C v163,v170,v171
M v[100:103],v[36:39],a[188:191],v[100:103]
s_mov_b32 s25, 3146112
W a8,v160
W a9,v161
M v[100:103],v[32:35],a[180:183],v[100:103]
s_waitcnt lgkmcnt(6)
W a10,v162
W a11,v163
M v[104:107],a[144:147],a[176:179],0
SA s30,s32,0
T v[32:33],v22,0
T v[34:35],v22,2048
M v[104:107],a[148:151],a[184:187],v[104:107]
SA m0,s4,57344
buffer_store_dwordx4 a[8:11], v6, s[8:11], s30 offen offset:2048 sc1
M v[104:107],a[152:155],a[192:195],v[104:107]
s_waitcnt lgkmcnt(2)
s_nop 0
T v[36:37],v22,4096
T v[38:39],v22,6144
M v[104:107],a[156:159],a[200:203],v[104:107]
T v[40:41],v22,8192
T v[42:43],v22,10240
M v[104:107],a[160:163],a[208:211],v[104:107]
buffer_load_dwordx4 v8, s[52:55], s25 offen lds
M v[104:107],a[164:167],a[216:219],v[104:107]
s_nop 0
T v[44:45],v22,12288
T v[46:47],v22,14336
M v[104:107],a[168:171],a[224:227],v[104:107]
s_mov_b32 s25, 3408256
T v[48:49],v22,16384
T v[50:51],v22,18432
M v[108:111],a[168:171],a[228:231],0
SA m0,s4,61440
buffer_store_dwordx4 v[88:91], v7, s[8:11], s3 offen offset:0 sc1
M v[108:111],a[164:167],a[220:223],v[108:111]
s_nop 0
T v[52:53],v22,20480
T v[54:55],v22,22528
M v[108:111],a[160:163],a[212:215],v[108:111]
T v[56:57],v22,24576
T v[58:59],v22,26624
M v[108:111],a[156:159],a[204:207],v[108:111]
buffer_load_dwordx4 v8, s[52:55], s25 offen lds
M v[108:111],a[152:155],a[196:199],v[108:111]
v_lshrrev_b32 v31, 6, v7
v_bfe_u32 v28, v7, 4, 2
M v[108:111],a[148:151],a[188:191],v[108:111]
buffer_store_dwordx4 v[92:95], v7, s[8:11], s3 offen offset:2048 sc1
M v[108:111],a[144:147],a[180:183],v[108:111]
s_waitcnt lgkmcnt(6)
v_lshlrev_b32 v31, 5, v31
v_add_lshl_u32 v31, v31, v28, 2
M v[112:115],v[32:35],a[176:179],0
T a[144:145],v23,0
T a[146:147],v23,2048
M v[112:115],v[36:39],a[184:187],v[112:115]
buffer_load_dword v5, v31, s[8:11], s46 offen offset:4 sc1
M v[112:115],v[40:43],a[192:195],v[112:115]
s_waitcnt lgkmcnt(2)
s_nop 0
T a[148:149],v23,4096
T a[150:151],v23,6144
M v[112:115],v[44:47],a[200:203],v[112:115]
T a[152:153],v23,8192
T a[154:155],v23,10240
M v[112:115],v[48:51],a[208:211],v[112:115]
MF v164,s5,v164
MF v165,s5,v165
M v[112:115],v[52:55],a[216:219],v[112:115]
T a[156:157],v23,12288
T a[158:159],v23,14336
M v[112:115],v[56:59],a[224:227],v[112:115]
T a[160:161],v23,16384
T a[162:163],v23,18432
M v[116:119],v[56:59],a[228:231],0
MF v166,s5,v166
MF v167,s5,v167
M v[116:119],v[52:55],a[220:223],v[116:119]
T a[164:165],v23,20480
T a[166:167],v23,22528
M v[116:119],v[48:51],a[212:215],v[116:119]
T a[168:169],v23,24576
T a[170:171],v23,26624
M v[116:119],v[44:47],a[204:207],v[116:119]
MF v172,s5,v172
MF v173,s5,v173
M v[116:119],v[40:43],a[196:199],v[116:119]
MF v174,s5,v174
MF v175,s5,v175
M v[116:119],v[36:39],a[188:191],v[116:119]
C v164,v164,v165
C v165,v166,v167
M v[116:119],v[32:35],a[180:183],v[116:119]
s_waitcnt lgkmcnt(6)
C v166,v172,v173
C v167,v174,v175
M v[120:123],a[144:147],a[176:179],0
T v[32:33],v20,28672
T v[34:35],v20,30720
M v[120:123],a[148:151],a[184:187],v[120:123]
W a40,v164
W a41,v165
M v[120:123],a[152:155],a[192:195],v[120:123]
s_waitcnt lgkmcnt(2)
T v[36:37],v12,24576
T v[38:39],v12,26624
M v[120:123],a[156:159],a[200:203],v[120:123]
T v[40:41],v12,28672
T v[42:43],v12,30720
M v[120:123],a[160:163],a[208:211],v[120:123]
W a42,v166
W a43,v167
M v[120:123],a[164:167],a[216:219],v[120:123]
SA s30,s32,8192
T v[44:45],v12,0
T v[46:47],v12,2048
M v[120:123],a[168:171],a[224:227],v[120:123]
T v[48:49],v12,4096
T v[50:51],v12,6144
M v[124:127],a[168:171],a[228:231],0
buffer_store_dwordx4 a[40:43], v6, s[8:11], s30 offen offset:2048 sc1
M v[124:127],a[164:167],a[220:223],v[124:127]
s_nop 0
T v[52:53],v12,8192
T v[54:55],v12,10240
M v[124:127],a[160:163],a[212:215],v[124:127]
T v[56:57],v12,12288
T v[58:59],v12,14336
M v[124:127],a[156:159],a[204:207],v[124:127]
v_mov_b32 v8, 0xff800000
MF v176,s5,v176
M v[124:127],a[152:155],a[196:199],v[124:127]
MF v177,s5,v177
MF v178,s5,v178
M v[124:127],a[148:151],a[188:191],v[124:127]
MF v179,s5,v179
MF v184,s5,v184
M v[124:127],a[144:147],a[180:183],v[124:127]
s_waitcnt lgkmcnt(6)
MF v185,s5,v185
MF v186,s5,v186
M v[96:99],v[32:35],a[232:235],v[96:99]
T a[144:145],v21,28672
T a[146:147],v21,30720
M v[96:99],v[36:39],a[96:99],v[96:99]
MF v187,s5,v187
C v176,v176,v177
M v[96:99],v[40:43],a[104:107],v[96:99]
s_waitcnt lgkmcnt(2)
T a[148:149],v13,24576
T a[150:151],v13,26624
M v[96:99],v[44:47],a[112:115],v[96:99]
T a[152:153],v13,28672
T a[154:155],v13,30720
M v[96:99],v[48:51],a[120:123],v[96:99]
C v177,v178,v179
C v178,v184,v185
M v[96:99],v[52:55],a[128:131],v[96:99]
T a[156:157],v13,0
T a[158:159],v13,2048
M v[96:99],v[56:59],a[136:139],v[96:99]
T a[160:161],v13,4096
T a[162:163],v13,6144
M v[100:103],v[56:59],a[140:143],v[100:103]
C v179,v186,v187
W a12,v176
M v[100:103],v[52:55],a[132:135],v[100:103]
T a[164:165],v13,8192
T a[166:167],v13,10240
M v[100:103],v[48:51],a[124:127],v[100:103]
T a[168:169],v13,12288
T a[170:171],v13,14336
M v[100:103],v[44:47],a[116:119],v[100:103]
W a13,v177
W a14,v178
M v[100:103],v[40:43],a[108:111],v[100:103]
W a15,v179
MF v180,s5,v180
M v[100:103],v[36:39],a[100:103],v[100:103]
MF v181,s5,v181
MF v182,s5,v182
M v[100:103],v[32:35],a[236:239],v[100:103]
s_waitcnt lgkmcnt(6)
MF v183,s5,v183
MF v188,s5,v188
M v[104:107],a[144:147],a[232:235],v[104:107]
T v[32:33],v22,28672
T v[34:35],v22,30720
M v[104:107],a[148:151],a[96:99],v[104:107]
MF v189,s5,v189
MF v190,s5,v190
M v[104:107],a[152:155],a[104:107],v[104:107]
s_waitcnt lgkmcnt(2)
T v[36:37],v14,24576
T v[38:39],v14,26624
M v[104:107],a[156:159],a[112:115],v[104:107]
SA s30,s32,0
T v[40:41],v14,28672
T v[42:43],v14,30720
M v[104:107],a[160:163],a[120:123],v[104:107]
buffer_store_dwordx4 a[12:15], v6, s[8:11], s30 offen offset:3072 sc1
M v[104:107],a[164:167],a[128:131],v[104:107]
s_nop 0
T v[44:45],v14,0
T v[46:47],v14,2048
M v[104:107],a[168:171],a[136:139],v[104:107]
T v[48:49],v14,4096
T v[50:51],v14,6144
M v[108:111],a[168:171],a[140:143],v[108:111]
MF v191,s5,v191
C v180,v180,v181
M v[108:111],a[164:167],a[132:135],v[108:111]
T v[52:53],v14,8192
T v[54:55],v14,10240
M v[108:111],a[160:163],a[124:127],v[108:111]
T v[56:57],v14,12288
T v[58:59],v14,14336
M v[108:111],a[156:159],a[116:119],v[108:111]
C v181,v182,v183
C v182,v188,v189
M v[108:111],a[152:155],a[108:111],v[108:111]
C v183,v190,v191
W a44,v180
M v[108:111],a[148:151],a[100:103],v[108:111]
W a45,v181
W a46,v182
M v[108:111],a[144:147],a[236:239],v[108:111]
s_waitcnt lgkmcnt(6)
W a47,v183
s_waitcnt vmcnt(2)
v_cmp_ne_u32 vcc, 1, v5
M v[112:115],v[32:35],a[232:235],v[112:115]
s_nop 0
T a[144:145],v23,28672
T a[146:147],v23,30720
M v[112:115],v[36:39],a[96:99],v[112:115]
s_cmp_lg_u32 vcc_lo, 0
MF v96,s5,v96
MF v97,s5,v97
M v[112:115],v[40:43],a[104:107],v[112:115]
s_waitcnt lgkmcnt(2)
T a[148:149],v15,24576
T a[150:151],v15,26624
M v[112:115],v[44:47],a[112:115],v[112:115]
s_cbranch_scc1 L_wsq1
L_wrq1:
T a[152:153],v15,28672
T a[154:155],v15,30720
M v[112:115],v[48:51],a[120:123],v[112:115]
SA m0,s28,98304
MF v98,s5,v98
MF v99,s5,v99
M v[112:115],v[52:55],a[128:131],v[112:115]
T a[156:157],v15,0
T a[158:159],v15,2048
M v[112:115],v[56:59],a[136:139],v[112:115]
T a[160:161],v15,4096
T a[162:163],v15,6144
M v[116:119],v[56:59],a[140:143],v[116:119]
buffer_load_dwordx4 v3, s[8:11], s21 offen offset:0 sc1 lds
M v[116:119],v[52:55],a[132:135],v[116:119]
s_nop 0
T a[164:165],v15,8192
T a[166:167],v15,10240
M v[116:119],v[48:51],a[124:127],v[116:119]
T a[168:169],v15,12288
T a[170:171],v15,14336
M v[116:119],v[44:47],a[116:119],v[116:119]
buffer_load_dwordx4 v3, s[8:11], s21 offen offset:1024 sc1 lds
M v[116:119],v[40:43],a[108:111],v[116:119]
MF v104,s5,v104
MF v105,s5,v105
M v[116:119],v[36:39],a[100:103],v[116:119]
s_waitcnt lgkmcnt(0)
buffer_load_dwordx4 v3, s[8:11], s21 offen offset:2048 sc1 lds
M v[116:119],v[32:35],a[236:239],v[116:119]
s_barrier
M v[120:123],a[144:147],a[232:235],v[120:123]
SA s30,s32,8192
T v[32:33],v16,0
T v[34:35],v16,2048
M v[120:123],a[148:151],a[96:99],v[120:123]
buffer_store_dwordx4 a[44:47], v6, s[8:11], s30 offen offset:3072 sc1
M v[120:123],a[152:155],a[104:107],v[120:123]
s_nop 0
T v[36:37],v16,4096
T v[38:39],v16,6144
M v[120:123],a[156:159],a[112:115],v[120:123]
T v[40:41],v16,8192
T v[42:43],v16,10240
M v[120:123],a[160:163],a[120:123],v[120:123]
buffer_load_dwordx4 v3, s[8:11], s21 offen offset:3072 sc1 lds
M v[120:123],a[164:167],a[128:131],v[120:123]
SA m0,s28,102400
T v[44:45],v16,12288
T v[46:47],v16,14336
M v[120:123],a[168:171],a[136:139],v[120:123]
T v[48:49],v16,16384
T v[50:51],v16,18432
M v[124:127],a[168:171],a[140:143],v[124:127]
buffer_load_dwordx4 v4, s[8:11], s21 offen offset:0 sc1 lds
M v[124:127],a[164:167],a[132:135],v[124:127]
s_nop 0
T v[52:53],v16,20480
T v[54:55],v16,22528
M v[124:127],a[160:163],a[124:127],v[124:127]
T v[56:57],v16,24576
T v[58:59],v16,26624
M v[124:127],a[156:159],a[116:119],v[124:127]
buffer_load_dwordx4 v4, s[8:11], s21 offen offset:1024 sc1 lds
M v[124:127],a[152:155],a[108:111],v[124:127]
MF v106,s5,v106
MF v107,s5,v107
M v[124:127],a[148:151],a[100:103],v[124:127]
buffer_load_dwordx4 v4, s[8:11], s21 offen offset:2048 sc1 lds
M v[124:127],a[144:147],a[236:239],v[124:127]
s_waitcnt lgkmcnt(6)
C v96,v96,v97
C v97,v98,v99
M v[160:163],v[32:35],a[176:179],0
T a[144:145],v17,0
T a[146:147],v17,2048
M v[160:163],v[36:39],a[184:187],v[160:163]
buffer_load_dwordx4 v4, s[8:11], s21 offen offset:3072 sc1 lds
M v[160:163],v[40:43],a[192:195],v[160:163]
s_waitcnt lgkmcnt(2)
s_nop 0
T a[148:149],v17,4096
T a[150:151],v17,6144
M v[160:163],v[44:47],a[200:203],v[160:163]
SA s21,s21,32768
T a[152:153],v17,8192
T a[154:155],v17,10240
M v[160:163],v[48:51],a[208:211],v[160:163]
s_sub_u32 s22, s22, 1
C v98,v104,v105
C v99,v106,v107
M v[160:163],v[52:55],a[216:219],v[160:163]
s_cselect_b32 s21, s23, s21
T a[156:157],v17,12288
T a[158:159],v17,14336
M v[160:163],v[56:59],a[224:227],v[160:163]
SA m0,s28,65536
T a[160:161],v17,16384
T a[162:163],v17,18432
M v[164:167],v[56:59],a[228:231],0
buffer_load_dwordx4 v3, s[8:11], s21 offen offset:0 sc1 lds
M v[164:167],v[52:55],a[220:223],v[164:167]
s_nop 0
T a[164:165],v17,20480
T a[166:167],v17,22528
M v[164:167],v[48:51],a[212:215],v[164:167]
T a[168:169],v17,24576
T a[170:171],v17,26624
M v[164:167],v[44:47],a[204:207],v[164:167]
buffer_load_dwordx4 v3, s[8:11], s21 offen offset:1024 sc1 lds
M v[164:167],v[40:43],a[196:199],v[164:167]
buffer_load_dword v5, v31, s[8:11], s46 offen offset:4 sc1
M v[164:167],v[36:39],a[188:191],v[164:167]
buffer_load_dwordx4 v3, s[8:11], s21 offen offset:2048 sc1 lds
M v[164:167],v[32:35],a[180:183],v[164:167]
s_waitcnt lgkmcnt(6)
W a16,v96
W a17,v97
M v[168:171],a[144:147],a[176:179],0
T v[32:33],v18,0
T v[34:35],v18,2048
M v[168:171],a[148:151],a[184:187],v[168:171]
buffer_load_dwordx4 v3, s[8:11], s21 offen offset:3072 sc1 lds
M v[168:171],a[152:155],a[192:195],v[168:171]
s_waitcnt lgkmcnt(2)
s_nop 0
T v[36:37],v18,4096
T v[38:39],v18,6144
M v[168:171],a[156:159],a[200:203],v[168:171]
SA m0,s28,69632
T v[40:41],v18,8192
T v[42:43],v18,10240
M v[168:171],a[160:163],a[208:211],v[168:171]
buffer_load_dwordx4 v4, s[8:11], s21 offen offset:0 sc1 lds
M v[168:171],a[164:167],a[216:219],v[168:171]
s_nop 0
T v[44:45],v18,12288
T v[46:47],v18,14336
M v[168:171],a[168:171],a[224:227],v[168:171]
T v[48:49],v18,16384
T v[50:51],v18,18432
M v[172:175],a[168:171],a[228:231],0
buffer_load_dwordx4 v4, s[8:11], s21 offen offset:1024 sc1 lds
M v[172:175],a[164:167],a[220:223],v[172:175]
s_nop 0
T v[52:53],v18,20480
T v[54:55],v18,22528
M v[172:175],a[160:163],a[212:215],v[172:175]
T v[56:57],v18,24576
T v[58:59],v18,26624
M v[172:175],a[156:159],a[204:207],v[172:175]
buffer_load_dwordx4 v4, s[8:11], s21 offen offset:2048 sc1 lds
M v[172:175],a[152:155],a[196:199],v[172:175]
W a18,v98
W a19,v99
M v[172:175],a[148:151],a[188:191],v[172:175]
SA s30,s32,4096
buffer_store_dwordx4 a[16:19], v6, s[8:11], s30 offen offset:0 sc1
M v[172:175],a[144:147],a[180:183],v[172:175]
s_waitcnt lgkmcnt(6)
MF v100,s5,v100
MF v101,s5,v101
M v[176:179],v[32:35],a[176:179],0
T a[144:145],v19,0
T a[146:147],v19,2048
M v[176:179],v[36:39],a[184:187],v[176:179]
buffer_load_dwordx4 v4, s[8:11], s21 offen offset:3072 sc1 lds
M v[176:179],v[40:43],a[192:195],v[176:179]
s_waitcnt lgkmcnt(2)
s_nop 0
T a[148:149],v19,4096
T a[150:151],v19,6144
M v[176:179],v[44:47],a[200:203],v[176:179]
SA s21,s21,32768
T a[152:153],v19,8192
T a[154:155],v19,10240
M v[176:179],v[48:51],a[208:211],v[176:179]
s_sub_u32 s22, s22, 1
MF v102,s5,v102
MF v103,s5,v103
M v[176:179],v[52:55],a[216:219],v[176:179]
s_cselect_b32 s21, s23, s21
T a[156:157],v19,12288
T a[158:159],v19,14336
M v[176:179],v[56:59],a[224:227],v[176:179]
T a[160:161],v19,16384
T a[162:163],v19,18432
M v[180:183],v[56:59],a[228:231],0
MF v108,s5,v108
MF v109,s5,v109
M v[180:183],v[52:55],a[220:223],v[180:183]
T a[164:165],v19,20480
T a[166:167],v19,22528
M v[180:183],v[48:51],a[212:215],v[180:183]
T a[168:169],v19,24576
T a[170:171],v19,26624
M v[180:183],v[44:47],a[204:207],v[180:183]
MF v110,s5,v110
MF v111,s5,v111
M v[180:183],v[40:43],a[196:199],v[180:183]
C v100,v100,v101
C v101,v102,v103
M v[180:183],v[36:39],a[188:191],v[180:183]
C v102,v108,v109
C v103,v110,v111
M v[180:183],v[32:35],a[180:183],v[180:183]
s_waitcnt lgkmcnt(6)
W a48,v100
W a49,v101
M v[184:187],a[144:147],a[176:179],0
T v[32:33],v16,28672
T v[34:35],v16,30720
M v[184:187],a[148:151],a[184:187],v[184:187]
W a50,v102
W a51,v103
M v[184:187],a[152:155],a[192:195],v[184:187]
s_waitcnt lgkmcnt(2)
T v[36:37],v16,40960
T v[38:39],v16,43008
M v[184:187],a[156:159],a[200:203],v[184:187]
T v[40:41],v16,45056
T v[42:43],v16,47104
M v[184:187],a[160:163],a[208:211],v[184:187]
MF v112,s5,v112
MF v113,s5,v113
M v[184:187],a[164:167],a[216:219],v[184:187]
T v[44:45],v16,49152
T v[46:47],v16,51200
M v[184:187],a[168:171],a[224:227],v[184:187]
T v[48:49],v16,53248
T v[50:51],v16,55296
M v[188:191],a[168:171],a[228:231],0
MF v114,s5,v114
MF v115,s5,v115
M v[188:191],a[164:167],a[220:223],v[188:191]
SA s30,s32,12288
T v[52:53],v16,57344
T v[54:55],v16,59392
M v[188:191],a[160:163],a[212:215],v[188:191]
T v[56:57],v16,61440
T v[58:59],v16,63488
M v[188:191],a[156:159],a[204:207],v[188:191]
buffer_store_dwordx4 a[48:51], v6, s[8:11], s30 offen offset:0 sc1
M v[188:191],a[152:155],a[196:199],v[188:191]
MF v120,s5,v120
MF v121,s5,v121
M v[188:191],a[148:151],a[188:191],v[188:191]
MF v122,s5,v122
MF v123,s5,v123
M v[188:191],a[144:147],a[180:183],v[188:191]
s_waitcnt lgkmcnt(6)
C v112,v112,v113
C v113,v114,v115
M v[160:163],v[32:35],a[232:235],v[160:163]
T a[144:145],v17,28672
T a[146:147],v17,30720
M v[160:163],v[36:39],a[96:99],v[160:163]
C v114,v120,v121
C v115,v122,v123
M v[160:163],v[40:43],a[104:107],v[160:163]
s_waitcnt lgkmcnt(2)
T a[148:149],v17,40960
T a[150:151],v17,43008
M v[160:163],v[44:47],a[112:115],v[160:163]
T a[152:153],v17,45056
T a[154:155],v17,47104
M v[160:163],v[48:51],a[120:123],v[160:163]
W a20,v112
W a21,v113
M v[160:163],v[52:55],a[128:131],v[160:163]
T a[156:157],v17,49152
T a[158:159],v17,51200
M v[160:163],v[56:59],a[136:139],v[160:163]
T a[160:161],v17,53248
T a[162:163],v17,55296
M v[164:167],v[56:59],a[140:143],v[164:167]
W a22,v114
W a23,v115
M v[164:167],v[52:55],a[132:135],v[164:167]
T a[164:165],v17,57344
T a[166:167],v17,59392
M v[164:167],v[48:51],a[124:127],v[164:167]
T a[168:169],v17,61440
T a[170:171],v17,63488
M v[164:167],v[44:47],a[116:119],v[164:167]
MF v116,s5,v116
MF v117,s5,v117
M v[164:167],v[40:43],a[108:111],v[164:167]
MF v118,s5,v118
MF v119,s5,v119
M v[164:167],v[36:39],a[100:103],v[164:167]
MF v124,s5,v124
MF v125,s5,v125
M v[164:167],v[32:35],a[236:239],v[164:167]
s_waitcnt lgkmcnt(6)
MF v126,s5,v126
MF v127,s5,v127
M v[168:171],a[144:147],a[232:235],v[168:171]
T v[32:33],v18,28672
T v[34:35],v18,30720
M v[168:171],a[148:151],a[96:99],v[168:171]
C v116,v116,v117
C v117,v118,v119
M v[168:171],a[152:155],a[104:107],v[168:171]
s_waitcnt lgkmcnt(2)
T v[36:37],v18,40960
T v[38:39],v18,43008
M v[168:171],a[156:159],a[112:115],v[168:171]
T v[40:41],v18,45056
T v[42:43],v18,47104
M v[168:171],a[160:163],a[120:123],v[168:171]
C v118,v124,v125
C v119,v126,v127
M v[168:171],a[164:167],a[128:131],v[168:171]
T v[44:45],v18,49152
T v[46:47],v18,51200
M v[168:171],a[168:171],a[136:139],v[168:171]
SA s30,s32,4096
T v[48:49],v18,53248
T v[50:51],v18,55296
M v[172:175],a[168:171],a[140:143],v[172:175]
buffer_store_dwordx4 a[20:23], v6, s[8:11], s30 offen offset:1024 sc1
M v[172:175],a[164:167],a[132:135],v[172:175]
s_nop 0
T v[52:53],v18,57344
T v[54:55],v18,59392
M v[172:175],a[160:163],a[124:127],v[172:175]
T v[56:57],v18,61440
T v[58:59],v18,63488
M v[172:175],a[156:159],a[116:119],v[172:175]
W a52,v116
W a53,v117
M v[172:175],a[152:155],a[108:111],v[172:175]
W a54,v118
W a55,v119
M v[172:175],a[148:151],a[100:103],v[172:175]
s_waitcnt vmcnt(9)
v_cmp_ne_u32 vcc, 1, v5
MF v160,s5,v160
M v[172:175],a[144:147],a[236:239],v[172:175]
s_waitcnt lgkmcnt(6)
MF v161,s5,v161
MF v162,s5,v162
M v[176:179],v[32:35],a[232:235],v[176:179]
s_nop 0
T a[144:145],v19,28672
T a[146:147],v19,30720
M v[176:179],v[36:39],a[96:99],v[176:179]
s_cmp_lg_u32 vcc_hi, 0
MF v163,s5,v163
MF v168,s5,v168
M v[176:179],v[40:43],a[104:107],v[176:179]
s_waitcnt lgkmcnt(2)
T a[148:149],v19,40960
T a[150:151],v19,43008
M v[176:179],v[44:47],a[112:115],v[176:179]
s_cbranch_scc1 L_wsr1
L_wrr1:
T a[152:153],v19,45056
T a[154:155],v19,47104
M v[176:179],v[48:51],a[120:123],v[176:179]
SA m0,s28,131072
MF v169,s5,v169
MF v170,s5,v170
M v[176:179],v[52:55],a[128:131],v[176:179]
T a[156:157],v19,49152
T a[158:159],v19,51200
M v[176:179],v[56:59],a[136:139],v[176:179]
T a[160:161],v19,53248
T a[162:163],v19,55296
M v[180:183],v[56:59],a[140:143],v[180:183]
buffer_load_dwordx4 v3, s[8:11], s26 offen offset:0 sc1 lds
M v[180:183],v[52:55],a[132:135],v[180:183]
s_nop 0
T a[164:165],v19,57344
T a[166:167],v19,59392
M v[180:183],v[48:51],a[124:127],v[180:183]
T a[168:169],v19,61440
T a[170:171],v19,63488
M v[180:183],v[44:47],a[116:119],v[180:183]
buffer_load_dwordx4 v3, s[8:11], s26 offen offset:1024 sc1 lds
M v[180:183],v[40:43],a[108:111],v[180:183]
MF v171,s5,v171
C v160,v160,v161
M v[180:183],v[36:39],a[100:103],v[180:183]
s_waitcnt lgkmcnt(0)
buffer_load_dwordx4 v3, s[8:11], s26 offen offset:2048 sc1 lds
M v[180:183],v[32:35],a[236:239],v[180:183]
s_barrier
M v[184:187],a[144:147],a[232:235],v[184:187]
R a[64:67],v2,32768
R a[68:71],v2,33792
M v[184:187],a[148:151],a[96:99],v[184:187]
buffer_load_dwordx4 v3, s[8:11], s26 offen offset:3072 sc1 lds
M v[184:187],a[152:155],a[104:107],v[184:187]
SA m0,s28,135168
C v161,v162,v163
C v162,v168,v169
M v[184:187],a[156:159],a[112:115],v[184:187]
SA s30,s32,12288
R a[72:75],v2,34816
R a[76:79],v2,35840
M v[184:187],a[160:163],a[120:123],v[184:187]
buffer_store_dwordx4 a[52:55], v6, s[8:11], s30 offen offset:1024 sc1
M v[184:187],a[164:167],a[128:131],v[184:187]
C v163,v170,v171
W a24,v160
M v[184:187],a[168:171],a[136:139],v[184:187]
R a[80:83],v2,36864
R a[84:87],v2,37888
M v[188:191],a[168:171],a[140:143],v[188:191]
buffer_load_dwordx4 v4, s[8:11], s26 offen offset:0 sc1 lds
M v[188:191],a[164:167],a[132:135],v[188:191]
W a25,v161
W a26,v162
M v[188:191],a[160:163],a[124:127],v[188:191]
R a[88:91],v2,38912
R a[92:95],v2,39936
M v[188:191],a[156:159],a[116:119],v[188:191]
buffer_load_dwordx4 v4, s[8:11], s26 offen offset:1024 sc1 lds
M v[188:191],a[152:155],a[108:111],v[188:191]
W a27,v163
MF v164,s5,v164
M v[188:191],a[148:151],a[100:103],v[188:191]
buffer_load_dwordx4 v4, s[8:11], s26 offen offset:2048 sc1 lds
M v[188:191],a[144:147],a[236:239],v[188:191]
s_waitcnt lgkmcnt(0)
SA s30,s32,4096
buffer_store_dwordx4 a[24:27], v6, s[8:11], s30 offen offset:2048 sc1
buffer_load_dwordx4 v4, s[8:11], s26 offen offset:3072 sc1 lds
SA s26,s26,32768
MF v165,s5,v165
MF v166,s5,v166
MF v167,s5,v167
MF v172,s5,v172
MF v173,s5,v173
MF v174,s5,v174
MF v175,s5,v175
C v164,v164,v165
C v165,v166,v167
C v166,v172,v173
C v167,v174,v175
W a56,v164
W a57,v165
W a58,v166
W a59,v167
SA s30,s32,12288
buffer_store_dwordx4 a[56:59], v6, s[8:11], s30 offen offset:2048 sc1
v_mov_b32 v30, 2
buffer_store_dword v30, v1, s[8:11], s45 offen sc1
M v[64:67],a[64:67],a[0:3],0
R a[96:99],v2,40960
R a[100:103],v2,41984
M v[64:67],a[68:71],a[4:7],v[64:67]
MF v176,s5,v176
MF v177,s5,v177
M v[64:67],a[72:75],a[8:11],v[64:67]
MF v178,s5,v178
MF v179,s5,v179
M v[64:67],a[76:79],a[12:15],v[64:67]
R a[104:107],v2,43008
R a[108:111],v2,44032
M v[64:67],a[80:83],a[16:19],v[64:67]
MF v184,s5,v184
MF v185,s5,v185
MF v186,s5,v186
MF v187,s5,v187
C v176,v176,v177
C v177,v178,v179
C v178,v184,v185
C v179,v186,v187
W a28,v176
W a29,v177
W a30,v178
W a31,v179
M v[64:67],a[84:87],a[20:23],v[64:67]
MF v180,s5,v180
MF v181,s5,v181
M v[64:67],a[88:91],a[24:27],v[64:67]
R a[112:115],v2,45056
R a[116:119],v2,46080
M v[64:67],a[92:95],a[28:31],v[64:67]
MF v182,s5,v182
MF v183,s5,v183
M v[68:71],a[64:67],a[32:35],0
MF v188,s5,v188
MF v189,s5,v189
M v[68:71],a[68:71],a[36:39],v[68:71]
R a[120:123],v2,47104
R a[124:127],v2,48128
M v[68:71],a[72:75],a[40:43],v[68:71]
SA m0,s28,32768
MF v190,s5,v190
MF v191,s5,v191
M v[68:71],a[76:79],a[44:47],v[68:71]
buffer_load_dwordx4 v3, s[8:11], s26 offen offset:0 sc1 lds
M v[68:71],a[80:83],a[48:51],v[68:71]
C v180,v180,v181
C v181,v182,v183
C v182,v188,v189
C v183,v190,v191
W a60,v180
W a61,v181
W a62,v182
W a63,v183
M v[68:71],a[84:87],a[52:55],v[68:71]
SA s30,s32,4096
buffer_store_dwordx4 a[28:31], v6, s[8:11], s30 offen offset:3072 sc1
M v[68:71],a[88:91],a[56:59],v[68:71]
SA s30,s32,12288
E v18,v64
M v[68:71],a[92:95],a[60:63],v[68:71]
s_waitcnt lgkmcnt(0)
buffer_store_dwordx4 a[60:63], v6, s[8:11], s30 offen offset:3072 sc1
M v[72:75],a[96:99],a[0:3],0
R a[64:67],v2,49152
R a[68:71],v2,50176
M v[72:75],a[100:103],a[4:7],v[72:75]
E v19,v65
M v[72:75],a[104:107],a[8:11],v[72:75]
buffer_load_dwordx4 v3, s[8:11], s26 offen offset:1024 sc1 lds
M v[72:75],a[108:111],a[12:15],v[72:75]
R a[72:75],v2,51200
R a[76:79],v2,52224
M v[72:75],a[112:115],a[16:19],v[72:75]
E v20,v66
M v[72:75],a[116:119],a[20:23],v[72:75]
buffer_load_dwordx4 v3, s[8:11], s26 offen offset:2048 sc1 lds
M v[72:75],a[120:123],a[24:27],v[72:75]
R a[80:83],v2,53248
R a[84:87],v2,54272
M v[72:75],a[124:127],a[28:31],v[72:75]
E v21,v67
M v[76:79],a[124:127],a[60:63],0
buffer_load_dwordx4 v3, s[8:11], s26 offen offset:3072 sc1 lds
M v[76:79],a[120:123],a[56:59],v[76:79]
SA m0,s28,36864
R a[88:91],v2,55296
R a[92:95],v2,56320
M v[76:79],a[116:119],a[52:55],v[76:79]
E v22,v68
M v[76:79],a[112:115],a[48:51],v[76:79]
buffer_load_dwordx4 v4, s[8:11], s26 offen offset:0 sc1 lds
M v[76:79],a[108:111],a[44:47],v[76:79]
E v23,v69
M v[76:79],a[104:107],a[40:43],v[76:79]
AF v26,v18,v19
C v40,v18,v19
M v[76:79],a[100:103],a[36:39],v[76:79]
buffer_load_dwordx4 v4, s[8:11], s26 offen offset:1024 sc1 lds
M v[76:79],a[96:99],a[32:35],v[76:79]
s_waitcnt lgkmcnt(0)
v_add_u32 v16, 0x20000, v7
AF v26,v20,v26
M v[80:83],a[64:67],a[0:3],0
R a[96:99],v2,57344
R a[100:103],v2,58368
M v[80:83],a[68:71],a[4:7],v[80:83]
buffer_load_dwordx4 v4, s[8:11], s26 offen offset:2048 sc1 lds
M v[80:83],a[72:75],a[8:11],v[80:83]
E v24,v70
M v[80:83],a[76:79],a[12:15],v[80:83]
R a[104:107],v2,59392
R a[108:111],v2,60416
M v[80:83],a[80:83],a[16:19],v[80:83]
buffer_load_dwordx4 v4, s[8:11], s26 offen offset:3072 sc1 lds
M v[80:83],a[84:87],a[20:23],v[80:83]
SA s26,s26,32768
E v25,v71
M v[80:83],a[88:91],a[24:27],v[80:83]
R a[112:115],v2,61440
R a[116:119],v2,62464
M v[80:83],a[92:95],a[28:31],v[80:83]
E v18,v72
M v[84:87],a[92:95],a[60:63],0
E v19,v73
M v[84:87],a[88:91],a[56:59],v[84:87]
R a[120:123],v2,63488
R a[124:127],v2,64512
M v[84:87],a[84:87],a[52:55],v[84:87]
C v41,v20,v21
AF v26,v21,v26
M v[84:87],a[80:83],a[48:51],v[84:87]
E v20,v74
M v[84:87],a[76:79],a[44:47],v[84:87]
AF v27,v22,v23
C v44,v22,v23
M v[84:87],a[72:75],a[40:43],v[84:87]
AF v27,v24,v27
C v45,v24,v25
M v[84:87],a[68:71],a[36:39],v[84:87]
s_waitcnt vmcnt(24) lgkmcnt(0)
E v21,v75
M v[84:87],a[64:67],a[32:35],v[84:87]
s_barrier
M v[88:91],a[96:99],a[0:3],0
R a[64:67],v2,0
R a[68:71],v2,1024
M v[88:91],a[100:103],a[4:7],v[88:91]
E v22,v76
M v[88:91],a[104:107],a[8:11],v[88:91]
AF v27,v25,v27
AF v26,v18,v26
M v[88:91],a[108:111],a[12:15],v[88:91]
R a[72:75],v2,2048
R a[76:79],v2,3072
M v[88:91],a[112:115],a[16:19],v[88:91]
E v23,v77
M v[88:91],a[116:119],a[20:23],v[88:91]
C v42,v18,v19
AF v26,v19,v26
M v[88:91],a[120:123],a[24:27],v[88:91]
R a[80:83],v2,4096
R a[84:87],v2,5120
M v[88:91],a[124:127],a[28:31],v[88:91]
E v24,v78
M v[92:95],a[124:127],a[60:63],0
AF v26,v20,v26
C v43,v20,v21
M v[92:95],a[120:123],a[56:59],v[92:95]
R a[88:91],v2,6144
R a[92:95],v2,7168
M v[92:95],a[116:119],a[52:55],v[92:95]
E v25,v79
M v[92:95],a[112:115],a[48:51],v[92:95]
AF v26,v21,v26
AF v27,v22,v27
M v[92:95],a[108:111],a[44:47],v[92:95]
C v46,v22,v23
AF v27,v23,v27
M v[92:95],a[104:107],a[40:43],v[92:95]
AF v27,v24,v27
C v47,v24,v25
M v[92:95],a[100:103],a[36:39],v[92:95]
s_waitcnt lgkmcnt(0)
AF v27,v25,v27
M v[92:95],a[96:99],a[32:35],v[92:95]
M v[96:99],a[64:67],a[0:3],0
R a[96:99],v2,8192
R a[100:103],v2,9216
M v[96:99],a[68:71],a[4:7],v[96:99]
SA m0,s28,98304
W a128,v128
W a129,v129
M v[96:99],a[72:75],a[8:11],v[96:99]
buffer_load_dwordx4 v3, s[8:11], s21 offen offset:0 sc1 lds
M v[96:99],a[76:79],a[12:15],v[96:99]
R a[104:107],v2,10240
R a[108:111],v2,11264
M v[96:99],a[80:83],a[16:19],v[96:99]
W a130,v130
v_mov_b32 v30, 0
M v[96:99],a[84:87],a[20:23],v[96:99]
W a131,v131
M v[96:99],a[88:91],a[24:27],v[96:99]
R a[112:115],v2,12288
R a[116:119],v2,13312
M v[96:99],a[92:95],a[28:31],v[96:99]
buffer_load_dwordx4 v3, s[8:11], s21 offen offset:1024 sc1 lds
M v[100:103],a[92:95],a[60:63],0
W a132,v132
v_mov_b32 v31, 0
M v[100:103],a[88:91],a[56:59],v[100:103]
R a[120:123],v2,14336
R a[124:127],v2,15360
M v[100:103],a[84:87],a[52:55],v[100:103]
W a133,v133
W a134,v134
M v[100:103],a[80:83],a[48:51],v[100:103]
buffer_load_dwordx4 v3, s[8:11], s21 offen offset:2048 sc1 lds
M v[100:103],a[76:79],a[44:47],v[100:103]
W a135,v135
M v[100:103],a[72:75],a[40:43],v[100:103]
v_mov_b32 v32, 0
M v[100:103],a[68:71],a[36:39],v[100:103]
W a136,v136
M v[100:103],a[64:67],a[32:35],v[100:103]
s_waitcnt lgkmcnt(0)
buffer_load_dwordx4 v3, s[8:11], s21 offen offset:3072 sc1 lds
M v[108:111],a[96:99],a[32:35],0
SA m0,s28,102400
R a[64:67],v2,16384
R a[68:71],v2,17408
M v[108:111],a[100:103],a[36:39],v[108:111]
W a137,v137
v_mov_b32 v33, 0
M v[108:111],a[104:107],a[40:43],v[108:111]
W a138,v138
M v[108:111],a[108:111],a[44:47],v[108:111]
R a[72:75],v2,18432
R a[76:79],v2,19456
M v[108:111],a[112:115],a[48:51],v[108:111]
buffer_load_dwordx4 v4, s[8:11], s21 offen offset:0 sc1 lds
M v[108:111],a[116:119],a[52:55],v[108:111]
W a139,v139
W a140,v140
M v[108:111],a[120:123],a[56:59],v[108:111]
R a[80:83],v2,20480
R a[84:87],v2,21504
M v[108:111],a[124:127],a[60:63],v[108:111]
buffer_load_dwordx4 v4, s[8:11], s21 offen offset:1024 sc1 lds
M v[104:107],a[124:127],a[28:31],0
v_mov_b32 v34, 0
W a141,v141
M v[104:107],a[120:123],a[24:27],v[104:107]
R a[88:91],v2,22528
R a[92:95],v2,23552
M v[104:107],a[116:119],a[20:23],v[104:107]
buffer_load_dwordx4 v4, s[8:11], s21 offen offset:2048 sc1 lds
M v[104:107],a[112:115],a[16:19],v[104:107]
W a142,v142
W a143,v143
M v[104:107],a[108:111],a[12:15],v[104:107]
v_mov_b32 v35, 0
W a144,v144
M v[104:107],a[104:107],a[8:11],v[104:107]
W a145,v145
M v[104:107],a[100:103],a[4:7],v[104:107]
buffer_load_dwordx4 v4, s[8:11], s21 offen offset:3072 sc1 lds
M v[104:107],a[96:99],a[0:3],v[104:107]
s_waitcnt lgkmcnt(0)
v_mov_b32 v36, 0
W a146,v146
M v[112:115],a[64:67],a[0:3],0
SA s21,s21,32768
R a[96:99],v2,24576
R a[100:103],v2,25600
M v[112:115],a[68:71],a[4:7],v[112:115]
s_sub_u32 s22, s22, 1
W a147,v147
M v[112:115],a[72:75],a[8:11],v[112:115]
s_cselect_b32 s21, s23, s21
E v18,v80
M v[112:115],a[76:79],a[12:15],v[112:115]
R a[104:107],v2,26624
R a[108:111],v2,27648
M v[112:115],a[80:83],a[16:19],v[112:115]
W a148,v148
v_mov_b32 v37, 0
M v[112:115],a[84:87],a[20:23],v[112:115]
W a149,v149
M v[112:115],a[88:91],a[24:27],v[112:115]
R a[112:115],v2,28672
R a[116:119],v2,29696
M v[112:115],a[92:95],a[28:31],v[112:115]
W a150,v150
M v[116:119],a[92:95],a[60:63],0
v_mov_b32 v38, 0
W a151,v151
M v[116:119],a[88:91],a[56:59],v[116:119]
R a[120:123],v2,30720
R a[124:127],v2,31744
M v[116:119],a[84:87],a[52:55],v[116:119]
W a152,v152
M v[116:119],a[80:83],a[48:51],v[116:119]
W a153,v153
M v[116:119],a[76:79],a[44:47],v[116:119]
E v19,v81
M v[116:119],a[72:75],a[40:43],v[116:119]
v_mov_b32 v39, 0
W a154,v154
M v[116:119],a[68:71],a[36:39],v[116:119]
s_waitcnt vmcnt(20) lgkmcnt(0)
E v20,v82
M v[116:119],a[64:67],a[32:35],v[116:119]
s_barrier
M v[124:127],a[96:99],a[32:35],0
R a[64:67],v16,0
R a[68:71],v16,1024
M v[124:127],a[100:103],a[36:39],v[124:127]
W a155,v155
W a156,v156
M v[124:127],a[104:107],a[40:43],v[124:127]
W a157,v157
AF v26,v18,v26
M v[124:127],a[108:111],a[44:47],v[124:127]
R a[72:75],v16,2048
R a[76:79],v16,3072
M v[124:127],a[112:115],a[48:51],v[124:127]
W a158,v158
C v56,v18,v19
M v[124:127],a[116:119],a[52:55],v[124:127]
E v21,v83
M v[124:127],a[120:123],a[56:59],v[124:127]
R a[80:83],v16,4096
R a[84:87],v16,5120
M v[124:127],a[124:127],a[60:63],v[124:127]
W a159,v159
AF v26,v19,v26
M v[120:123],a[124:127],a[28:31],0
E v22,v88
M v[120:123],a[120:123],a[24:27],v[120:123]
R a[88:91],v16,6144
R a[92:95],v16,7168
M v[120:123],a[116:119],a[20:23],v[120:123]
E v23,v89
M v[120:123],a[112:115],a[16:19],v[120:123]
E v24,v90
M v[120:123],a[108:111],a[12:15],v[120:123]
E v25,v91
M v[120:123],a[104:107],a[8:11],v[120:123]
E v18,v84
M v[120:123],a[100:103],a[4:7],v[120:123]
s_waitcnt lgkmcnt(0)
E v19,v85
M v[120:123],a[96:99],a[0:3],v[120:123]
AF v26,v20,v26
C v57,v20,v21
AF v26,v21,v26
AF v26,v22,v26
C v58,v22,v23
AF v26,v23,v26
AF v26,v24,v26
C v59,v24,v25
AF v26,v25,v26
E v20,v86
E v21,v87
AF v27,v18,v27
C v60,v18,v19
AF v27,v19,v27
E v22,v92
E v23,v93
AF v27,v20,v27
C v61,v20,v21
AF v27,v21,v27
E v24,v94
E v25,v95
AF v27,v22,v27
C v62,v22,v23
AF v27,v23,v27
AF v27,v24,v27
C v63,v24,v25
AF v27,v25,v27
v_max_f32 v10, v26, v27
v_min_f32 v11, v26, v27
v_cmp_lt_f32 vcc, s31, v10
v_cmp_gt_f32 s[64:65], s24, v11
s_nop 0
s_or_b64 vcc, vcc, s[64:65]
s_cbranch_vccnz L_stv1
L_rtv1:
M v[128:131],a[64:67],v[40:43],0
R a[96:99],v16,8192
R a[100:103],v16,9216
M v[128:131],a[68:71],v[56:59],v[128:131]
SA m0,s28,65536
W a160,v192
W a161,v193
M v[132:135],a[68:71],v[60:63],0
buffer_load_dwordx4 v3, s[8:11], s21 offen offset:0 sc1 lds
M v[132:135],a[64:67],v[44:47],v[132:135]
R a[104:107],v16,10240
R a[108:111],v16,11264
M v[140:143],a[72:75],v[44:47],0
W a162,v194
W a163,v195
M v[140:143],a[76:79],v[60:63],v[140:143]
W a164,v196
W a165,v197
M v[136:139],a[76:79],v[56:59],0
R a[112:115],v16,12288
R a[116:119],v16,13312
M v[136:139],a[72:75],v[40:43],v[136:139]
buffer_load_dwordx4 v3, s[8:11], s21 offen offset:1024 sc1 lds
M v[144:147],a[80:83],v[40:43],0
W a166,v198
W a167,v199
M v[144:147],a[84:87],v[56:59],v[144:147]
R a[120:123],v16,14336
R a[124:127],v16,15360
M v[148:151],a[84:87],v[60:63],0
SA s3,s93,262144
W a168,v200
W a169,v201
M v[148:151],a[80:83],v[44:47],v[148:151]
buffer_load_dwordx4 v3, s[8:11], s21 offen offset:2048 sc1 lds
M v[156:159],a[88:91],v[44:47],0
W a170,v202
W a171,v203
M v[156:159],a[92:95],v[60:63],v[156:159]
W a172,v204
W a173,v205
M v[152:155],a[92:95],v[56:59],0
buffer_store_dwordx4 a[128:131], v7, s[8:11], s3 offen offset:0 sc1
M v[152:155],a[88:91],v[40:43],v[152:155]
s_waitcnt lgkmcnt(0)
W a174,v206
W a175,v207
M v[160:163],a[96:99],v[40:43],0
R a[64:67],v16,16384
R a[68:71],v16,17408
M v[160:163],a[100:103],v[56:59],v[160:163]
buffer_load_dwordx4 v3, s[8:11], s21 offen offset:3072 sc1 lds
M v[164:167],a[100:103],v[60:63],0
SA m0,s28,69632
W a176,v208
W a177,v209
M v[164:167],a[96:99],v[44:47],v[164:167]
R a[72:75],v16,18432
R a[76:79],v16,19456
M v[172:175],a[104:107],v[44:47],0
buffer_load_dwordx4 v4, s[8:11], s21 offen offset:0 sc1 lds
M v[172:175],a[108:111],v[60:63],v[172:175]
W a178,v210
W a179,v211
M v[168:171],a[108:111],v[56:59],0
R a[80:83],v16,20480
R a[84:87],v16,21504
M v[168:171],a[104:107],v[40:43],v[168:171]
buffer_load_dwordx4 v4, s[8:11], s21 offen offset:1024 sc1 lds
M v[176:179],a[112:115],v[40:43],0
W a180,v212
W a181,v213
M v[176:179],a[116:119],v[56:59],v[176:179]
R a[88:91],v16,22528
R a[92:95],v16,23552
M v[180:183],a[116:119],v[60:63],0
buffer_load_dwordx4 v4, s[8:11], s21 offen offset:2048 sc1 lds
M v[180:183],a[112:115],v[44:47],v[180:183]
W a182,v214
W a183,v215
M v[188:191],a[120:123],v[44:47],0
W a184,v216
W a185,v217
W a186,v218
W a187,v219
W a188,v220
W a189,v221
W a190,v222
W a191,v223
M v[188:191],a[124:127],v[60:63],v[188:191]
E v18,v96
M v[184:187],a[124:127],v[56:59],0
buffer_load_dwordx4 v4, s[8:11], s21 offen offset:3072 sc1 lds
M v[184:187],a[120:123],v[40:43],v[184:187]
s_waitcnt lgkmcnt(0)
v_min_u32 v17, 1, v7
v_lshlrev_b32 v17, 29, v17
M v[192:195],a[64:67],v[40:43],0
SA s21,s21,32768
R a[96:99],v16,24576
R a[100:103],v16,25600
M v[192:195],a[68:71],v[56:59],v[192:195]
s_sub_u32 s22, s22, 1
buffer_store_dwordx4 a[132:135], v7, s[8:11], s3 offen offset:2048 sc1
M v[196:199],a[68:71],v[60:63],0
s_cselect_b32 s21, s23, s21
v_mov_b32 v15, 1
AF v30,v26,v30
M v[196:199],a[64:67],v[44:47],v[196:199]
SA s84,s47,16
R a[104:107],v16,26624
R a[108:111],v16,27648
M v[204:207],a[72:75],v[44:47],0
E v19,v97
M v[204:207],a[76:79],v[60:63],v[204:207]
E v20,v98
M v[200:203],a[76:79],v[56:59],0
R a[112:115],v16,28672
R a[116:119],v16,29696
M v[200:203],a[72:75],v[40:43],v[200:203]
E v21,v99
M v[208:211],a[80:83],v[40:43],0
E v22,v104
M v[208:211],a[84:87],v[56:59],v[208:211]
R a[120:123],v16,30720
R a[124:127],v16,31744
M v[212:215],a[84:87],v[60:63],0
SA s3,s93,266240
E v23,v105
M v[212:215],a[80:83],v[44:47],v[212:215]
buffer_store_dwordx4 a[136:139], v7, s[8:11], s3 offen offset:0 sc1
M v[220:223],a[88:91],v[44:47],0
AF v31,v27,v31
AF v28,v18,v19
M v[220:223],a[92:95],v[60:63],v[220:223]
E v24,v106
M v[216:219],a[92:95],v[56:59],0
s_waitcnt vmcnt(11) lgkmcnt(0)
E v25,v107
M v[216:219],a[88:91],v[40:43],v[216:219]
s_barrier
M v[224:227],a[96:99],v[40:43],0
R a[64:67],v2,32768
R a[68:71],v2,33792
M v[224:227],a[100:103],v[56:59],v[224:227]
buffer_store_dword v15, v17, s[8:11], s84 offen sc1
M v[228:231],a[100:103],v[60:63],0
C v48,v18,v19
AF v28,v20,v28
M v[228:231],a[96:99],v[44:47],v[228:231]
R a[72:75],v2,34816
R a[76:79],v2,35840
M v[236:239],a[104:107],v[44:47],0
E v18,v100
M v[236:239],a[108:111],v[60:63],v[236:239]
E v19,v101
M v[232:235],a[108:111],v[56:59],0
R a[80:83],v2,36864
R a[84:87],v2,37888
M v[232:235],a[104:107],v[40:43],v[232:235]
C v49,v20,v21
AF v28,v21,v28
M v[240:243],a[112:115],v[40:43],0
E v20,v102
M v[240:243],a[116:119],v[56:59],v[240:243]
R a[88:91],v2,38912
R a[92:95],v2,39936
M v[244:247],a[116:119],v[60:63],0
E v21,v103
M v[244:247],a[112:115],v[44:47],v[244:247]
AF v28,v22,v28
C v50,v22,v23
M v[252:255],a[120:123],v[44:47],0
AF v28,v23,v28
AF v28,v24,v28
M v[252:255],a[124:127],v[60:63],v[252:255]
E v22,v108
M v[248:251],a[124:127],v[56:59],0
s_waitcnt lgkmcnt(0)
E v23,v109
M v[248:251],a[120:123],v[40:43],v[248:251]
C v51,v24,v25
AF v28,v25,v28
AF v29,v18,v19
C v52,v18,v19
AF v29,v20,v29
C v53,v20,v21
AF v29,v21,v29
E v24,v110
E v25,v111
AF v29,v22,v29
C v54,v22,v23
AF v29,v23,v29
AF v29,v24,v29
C v55,v24,v25
AF v29,v25,v29
M v[64:67],a[64:67],a[0:3],v[32:35]
R a[96:99],v2,40960
R a[100:103],v2,41984
M v[64:67],a[68:71],a[4:7],v[64:67]
SA m0,s28,0
E v18,v112
M v[64:67],a[72:75],a[8:11],v[64:67]
buffer_load_dwordx4 v3, s[8:11], s26 offen offset:0 sc1 lds
M v[64:67],a[76:79],a[12:15],v[64:67]
R a[104:107],v2,43008
R a[108:111],v2,44032
M v[64:67],a[80:83],a[16:19],v[64:67]
E v19,v113
M v[64:67],a[84:87],a[20:23],v[64:67]
AF v28,v18,v28
C v56,v18,v19
M v[64:67],a[88:91],a[24:27],v[64:67]
R a[112:115],v2,45056
R a[116:119],v2,46080
M v[64:67],a[92:95],a[28:31],v[64:67]
buffer_load_dwordx4 v3, s[8:11], s26 offen offset:1024 sc1 lds
M v[68:71],a[92:95],a[60:63],v[36:39]
E v20,v114
M v[68:71],a[88:91],a[56:59],v[68:71]
R a[120:123],v2,47104
R a[124:127],v2,48128
M v[68:71],a[84:87],a[52:55],v[68:71]
SA s3,s93,266240
E v21,v115
M v[68:71],a[80:83],a[48:51],v[68:71]
buffer_load_dwordx4 v3, s[8:11], s26 offen offset:2048 sc1 lds
M v[68:71],a[76:79],a[44:47],v[68:71]
AF v28,v19,v28
AF v28,v20,v28
M v[68:71],a[72:75],a[40:43],v[68:71]
C v57,v20,v21
AF v28,v21,v28
M v[68:71],a[68:71],a[36:39],v[68:71]
buffer_store_dwordx4 a[140:143], v7, s[8:11], s3 offen offset:2048 sc1
M v[68:71],a[64:67],a[32:35],v[68:71]
s_waitcnt lgkmcnt(0)
E v22,v120
M v[76:79],a[96:99],a[32:35],v[36:39]
R a[64:67],v2,49152
R a[68:71],v2,50176
M v[76:79],a[100:103],a[36:39],v[76:79]
buffer_load_dwordx4 v3, s[8:11], s26 offen offset:3072 sc1 lds
M v[76:79],a[104:107],a[40:43],v[76:79]
SA m0,s28,4096
E v23,v121
M v[76:79],a[108:111],a[44:47],v[76:79]
R a[72:75],v2,51200
R a[76:79],v2,52224
M v[76:79],a[112:115],a[48:51],v[76:79]
buffer_load_dwordx4 v4, s[8:11], s26 offen offset:0 sc1 lds
M v[76:79],a[116:119],a[52:55],v[76:79]
E v24,v122
M v[76:79],a[120:123],a[56:59],v[76:79]
R a[80:83],v2,53248
R a[84:87],v2,54272
M v[76:79],a[124:127],a[60:63],v[76:79]
buffer_load_dwordx4 v4, s[8:11], s26 offen offset:1024 sc1 lds
M v[72:75],a[124:127],a[28:31],v[32:35]
E v25,v123
M v[72:75],a[120:123],a[24:27],v[72:75]
SA s3,s93,270336
R a[88:91],v2,55296
R a[92:95],v2,56320
M v[72:75],a[116:119],a[20:23],v[72:75]
buffer_load_dwordx4 v4, s[8:11], s26 offen offset:2048 sc1 lds
M v[72:75],a[112:115],a[16:19],v[72:75]
AF v28,v22,v28
C v58,v22,v23
M v[72:75],a[108:111],a[12:15],v[72:75]
E v18,v116
M v[72:75],a[104:107],a[8:11],v[72:75]
AF v28,v23,v28
AF v28,v24,v28
M v[72:75],a[100:103],a[4:7],v[72:75]
buffer_load_dwordx4 v4, s[8:11], s26 offen offset:3072 sc1 lds
M v[72:75],a[96:99],a[0:3],v[72:75]
s_waitcnt lgkmcnt(0)
E v19,v117
M v[80:83],a[64:67],a[0:3],v[32:35]
SA s26,s26,32768
R a[96:99],v2,57344
R a[100:103],v2,58368
M v[80:83],a[68:71],a[4:7],v[80:83]
buffer_store_dwordx4 a[144:147], v7, s[8:11], s3 offen offset:0 sc1
M v[80:83],a[72:75],a[8:11],v[80:83]
C v59,v24,v25
AF v28,v25,v28
M v[80:83],a[76:79],a[12:15],v[80:83]
R a[104:107],v2,59392
R a[108:111],v2,60416
M v[80:83],a[80:83],a[16:19],v[80:83]
E v20,v118
M v[80:83],a[84:87],a[20:23],v[80:83]
AF v29,v18,v29
C v60,v18,v19
M v[80:83],a[88:91],a[24:27],v[80:83]
R a[112:115],v2,61440
R a[116:119],v2,62464
M v[80:83],a[92:95],a[28:31],v[80:83]
E v21,v119
M v[84:87],a[92:95],a[60:63],v[36:39]
AF v29,v19,v29
AF v29,v20,v29
M v[84:87],a[88:91],a[56:59],v[84:87]
R a[120:123],v2,63488
R a[124:127],v2,64512
M v[84:87],a[84:87],a[52:55],v[84:87]
E v22,v124
M v[84:87],a[80:83],a[48:51],v[84:87]
buffer_store_dwordx4 a[148:151], v7, s[8:11], s3 offen offset:2048 sc1
M v[84:87],a[76:79],a[44:47],v[84:87]
C v61,v20,v21
AF v29,v21,v29
M v[84:87],a[72:75],a[40:43],v[84:87]
E v23,v125
M v[84:87],a[68:71],a[36:39],v[84:87]
s_waitcnt lgkmcnt(0)
AF v29,v22,v29
C v62,v22,v23
M v[84:87],a[64:67],a[32:35],v[84:87]
s_barrier
M v[92:95],a[96:99],a[32:35],v[36:39]
R a[64:67],v7,32768
R a[68:71],v7,33792
M v[92:95],a[100:103],a[36:39],v[92:95]
E v24,v126
M v[92:95],a[104:107],a[40:43],v[92:95]
AF v29,v23,v29
M v[92:95],a[108:111],a[44:47],v[92:95]
R a[72:75],v7,34816
R a[76:79],v7,35840
M v[92:95],a[112:115],a[48:51],v[92:95]
E v25,v127
M v[92:95],a[116:119],a[52:55],v[92:95]
AF v29,v24,v29
C v63,v24,v25
M v[92:95],a[120:123],a[56:59],v[92:95]
R a[80:83],v7,36864
R a[84:87],v7,37888
M v[92:95],a[124:127],a[60:63],v[92:95]
AF v29,v25,v29
M v[88:91],a[124:127],a[28:31],v[32:35]
M v[88:91],a[120:123],a[24:27],v[88:91]
R a[88:91],v7,38912
R a[92:95],v7,39936
M v[88:91],a[116:119],a[20:23],v[88:91]
v_max_f32 v10, v28, v29
M v[88:91],a[112:115],a[16:19],v[88:91]
v_cmp_lt_f32 vcc, s31, v10
M v[88:91],a[108:111],a[12:15],v[88:91]
M v[88:91],a[104:107],a[8:11],v[88:91]
M v[88:91],a[100:103],a[4:7],v[88:91]
s_waitcnt lgkmcnt(0)
M v[88:91],a[96:99],a[0:3],v[88:91]
s_cbranch_vccnz L_stv2
L_rtv2:
M v[128:131],a[64:67],v[48:51],v[128:131]
R a[96:99],v7,40960
R a[100:103],v7,41984
M v[128:131],a[68:71],v[56:59],v[128:131]
SA m0,s28,98304
E v18,v64
M v[132:135],a[68:71],v[60:63],v[132:135]
buffer_load_dwordx4 v3, s[8:11], s21 offen offset:0 sc1 lds
M v[132:135],a[64:67],v[52:55],v[132:135]
R a[104:107],v7,43008
R a[108:111],v7,44032
M v[140:143],a[72:75],v[52:55],v[140:143]
E v19,v65
M v[140:143],a[76:79],v[60:63],v[140:143]
AF v30,v28,v30
AF v31,v29,v31
M v[136:139],a[76:79],v[56:59],v[136:139]
R a[112:115],v7,45056
R a[116:119],v7,46080
M v[136:139],a[72:75],v[48:51],v[136:139]
buffer_load_dwordx4 v3, s[8:11], s21 offen offset:1024 sc1 lds
M v[144:147],a[80:83],v[48:51],v[144:147]
E v20,v66
M v[144:147],a[84:87],v[56:59],v[144:147]
R a[120:123],v7,47104
R a[124:127],v7,48128
M v[148:151],a[84:87],v[60:63],v[148:151]
SA s3,s93,274432
AF v26,v18,v19
C v40,v18,v19
M v[148:151],a[80:83],v[52:55],v[148:151]
buffer_load_dwordx4 v3, s[8:11], s21 offen offset:2048 sc1 lds
M v[156:159],a[88:91],v[52:55],v[156:159]
E v21,v67
M v[156:159],a[92:95],v[60:63],v[156:159]
AF v26,v20,v26
C v41,v20,v21
M v[152:155],a[92:95],v[56:59],v[152:155]
buffer_store_dwordx4 a[152:155], v7, s[8:11], s3 offen offset:0 sc1
M v[152:155],a[88:91],v[48:51],v[152:155]
s_waitcnt lgkmcnt(0)
E v22,v72
M v[160:163],a[96:99],v[48:51],v[160:163]
R a[64:67],v7,49152
R a[68:71],v7,50176
M v[160:163],a[100:103],v[56:59],v[160:163]
buffer_load_dwordx4 v3, s[8:11], s21 offen offset:3072 sc1 lds
M v[164:167],a[100:103],v[60:63],v[164:167]
SA m0,s28,102400
E v23,v73
M v[164:167],a[96:99],v[52:55],v[164:167]
R a[72:75],v7,51200
R a[76:79],v7,52224
M v[172:175],a[104:107],v[52:55],v[172:175]
buffer_load_dwordx4 v4, s[8:11], s21 offen offset:0 sc1 lds
M v[172:175],a[108:111],v[60:63],v[172:175]
AF v26,v21,v26
AF v26,v22,v26
M v[168:171],a[108:111],v[56:59],v[168:171]
R a[80:83],v7,53248
R a[84:87],v7,54272
M v[168:171],a[104:107],v[48:51],v[168:171]
buffer_load_dwordx4 v4, s[8:11], s21 offen offset:1024 sc1 lds
M v[176:179],a[112:115],v[48:51],v[176:179]
E v24,v74
M v[176:179],a[116:119],v[56:59],v[176:179]
R a[88:91],v7,55296
R a[92:95],v7,56320
M v[180:183],a[116:119],v[60:63],v[180:183]
buffer_load_dwordx4 v4, s[8:11], s21 offen offset:2048 sc1 lds
M v[180:183],a[112:115],v[52:55],v[180:183]
E v25,v75
M v[188:191],a[120:123],v[52:55],v[188:191]
C v42,v22,v23
AF v26,v23,v26
M v[188:191],a[124:127],v[60:63],v[188:191]
AF v26,v24,v26
C v43,v24,v25
M v[184:187],a[124:127],v[56:59],v[184:187]
buffer_load_dwordx4 v4, s[8:11], s21 offen offset:3072 sc1 lds
M v[184:187],a[120:123],v[48:51],v[184:187]
s_waitcnt lgkmcnt(0)
E v18,v68
M v[192:195],a[64:67],v[48:51],v[192:195]
SA s21,s21,32768
R a[96:99],v7,57344
R a[100:103],v7,58368
M v[192:195],a[68:71],v[56:59],v[192:195]
s_sub_u32 s22, s22, 1
buffer_store_dwordx4 a[156:159], v7, s[8:11], s3 offen offset:2048 sc1
M v[196:199],a[68:71],v[60:63],v[196:199]
s_cselect_b32 s21, s23, s21
E v19,v69
M v[196:199],a[64:67],v[52:55],v[196:199]
R a[104:107],v7,59392
R a[108:111],v7,60416
M v[204:207],a[72:75],v[52:55],v[204:207]
AF v26,v25,v26
AF v27,v18,v19
M v[204:207],a[76:79],v[60:63],v[204:207]
E v20,v70
M v[200:203],a[76:79],v[56:59],v[200:203]
R a[112:115],v7,61440
R a[116:119],v7,62464
M v[200:203],a[72:75],v[48:51],v[200:203]
C v44,v18,v19
M v[208:211],a[80:83],v[48:51],v[208:211]
M v[208:211],a[84:87],v[56:59],v[208:211]
R a[120:123],v7,63488
R a[124:127],v7,64512
M v[212:215],a[84:87],v[60:63],v[212:215]
SA s3,s93,786432
E v21,v71
M v[212:215],a[80:83],v[52:55],v[212:215]
buffer_store_dwordx4 a[160:163], v7, s[8:11], s3 offen offset:0 sc1
M v[220:223],a[88:91],v[52:55],v[220:223]
AF v27,v20,v27
C v45,v20,v21
M v[220:223],a[92:95],v[60:63],v[220:223]
E v22,v76
M v[216:219],a[92:95],v[56:59],v[216:219]
s_waitcnt vmcnt(25) lgkmcnt(0)
AF v27,v21,v27
M v[216:219],a[88:91],v[48:51],v[216:219]
s_barrier
M v[224:227],a[96:99],v[48:51],v[224:227]
R a[64:67],v2,0
R a[68:71],v2,1024
M v[224:227],a[100:103],v[56:59],v[224:227]
E v23,v77
M v[228:231],a[100:103],v[60:63],v[228:231]
AF v27,v22,v27
C v46,v22,v23
M v[228:231],a[96:99],v[52:55],v[228:231]
R a[72:75],v2,2048
R a[76:79],v2,3072
M v[236:239],a[104:107],v[52:55],v[236:239]
E v24,v78
M v[236:239],a[108:111],v[60:63],v[236:239]
AF v27,v23,v27
M v[232:235],a[108:111],v[56:59],v[232:235]
R a[80:83],v2,4096
R a[84:87],v2,5120
M v[232:235],a[104:107],v[48:51],v[232:235]
M v[240:243],a[112:115],v[48:51],v[240:243]
E v25,v79
M v[240:243],a[116:119],v[56:59],v[240:243]
R a[88:91],v2,6144
R a[92:95],v2,7168
M v[244:247],a[116:119],v[60:63],v[244:247]
AF v27,v24,v27
C v47,v24,v25
M v[244:247],a[112:115],v[52:55],v[244:247]
AF v27,v25,v27
M v[252:255],a[120:123],v[52:55],v[252:255]
M v[252:255],a[124:127],v[60:63],v[252:255]
M v[248:251],a[124:127],v[56:59],v[248:251]
s_waitcnt lgkmcnt(0)
M v[248:251],a[120:123],v[48:51],v[248:251]
M v[96:99],a[64:67],a[0:3],v[32:35]
R a[96:99],v2,8192
R a[100:103],v2,9216
M v[96:99],a[68:71],a[4:7],v[96:99]
SA m0,s28,32768
E v18,v80
M v[96:99],a[72:75],a[8:11],v[96:99]
buffer_load_dwordx4 v3, s[8:11], s26 offen offset:0 sc1 lds
M v[96:99],a[76:79],a[12:15],v[96:99]
R a[104:107],v2,10240
R a[108:111],v2,11264
M v[96:99],a[80:83],a[16:19],v[96:99]
E v19,v81
M v[96:99],a[84:87],a[20:23],v[96:99]
AF v26,v18,v26
C v56,v18,v19
M v[96:99],a[88:91],a[24:27],v[96:99]
R a[112:115],v2,12288
R a[116:119],v2,13312
M v[96:99],a[92:95],a[28:31],v[96:99]
buffer_load_dwordx4 v3, s[8:11], s26 offen offset:1024 sc1 lds
M v[100:103],a[92:95],a[60:63],v[36:39]
E v20,v82
M v[100:103],a[88:91],a[56:59],v[100:103]
R a[120:123],v2,14336
R a[124:127],v2,15360
M v[100:103],a[84:87],a[52:55],v[100:103]
SA s3,s93,786432
E v21,v83
M v[100:103],a[80:83],a[48:51],v[100:103]
buffer_load_dwordx4 v3, s[8:11], s26 offen offset:2048 sc1 lds
M v[100:103],a[76:79],a[44:47],v[100:103]
AF v26,v19,v26
AF v26,v20,v26
M v[100:103],a[72:75],a[40:43],v[100:103]
C v57,v20,v21
AF v26,v21,v26
M v[100:103],a[68:71],a[36:39],v[100:103]
buffer_store_dwordx4 a[164:167], v7, s[8:11], s3 offen offset:2048 sc1
M v[100:103],a[64:67],a[32:35],v[100:103]
s_waitcnt lgkmcnt(0)
E v22,v88
M v[108:111],a[96:99],a[32:35],v[36:39]
R a[64:67],v2,16384
R a[68:71],v2,17408
M v[108:111],a[100:103],a[36:39],v[108:111]
buffer_load_dwordx4 v3, s[8:11], s26 offen offset:3072 sc1 lds
M v[108:111],a[104:107],a[40:43],v[108:111]
SA m0,s28,36864
E v23,v89
M v[108:111],a[108:111],a[44:47],v[108:111]
R a[72:75],v2,18432
R a[76:79],v2,19456
M v[108:111],a[112:115],a[48:51],v[108:111]
buffer_load_dwordx4 v4, s[8:11], s26 offen offset:0 sc1 lds
M v[108:111],a[116:119],a[52:55],v[108:111]
SA s3,s93,790528
E v24,v90
M v[108:111],a[120:123],a[56:59],v[108:111]
R a[80:83],v2,20480
R a[84:87],v2,21504
M v[108:111],a[124:127],a[60:63],v[108:111]
buffer_load_dwordx4 v4, s[8:11], s26 offen offset:1024 sc1 lds
M v[104:107],a[124:127],a[28:31],v[32:35]
E v25,v91
M v[104:107],a[120:123],a[24:27],v[104:107]
R a[88:91],v2,22528
R a[92:95],v2,23552
M v[104:107],a[116:119],a[20:23],v[104:107]
buffer_load_dwordx4 v4, s[8:11], s26 offen offset:2048 sc1 lds
M v[104:107],a[112:115],a[16:19],v[104:107]
AF v26,v22,v26
C v58,v22,v23
M v[104:107],a[108:111],a[12:15],v[104:107]
E v18,v84
M v[104:107],a[104:107],a[8:11],v[104:107]
buffer_store_dwordx4 a[168:171], v7, s[8:11], s3 offen offset:0 sc1
M v[104:107],a[100:103],a[4:7],v[104:107]
AF v26,v23,v26
AF v26,v24,v26
M v[104:107],a[96:99],a[0:3],v[104:107]
s_waitcnt lgkmcnt(0)
E v19,v85
M v[112:115],a[64:67],a[0:3],v[32:35]
R a[96:99],v2,24576
R a[100:103],v2,25600
M v[112:115],a[68:71],a[4:7],v[112:115]
buffer_load_dwordx4 v4, s[8:11], s26 offen offset:3072 sc1 lds
M v[112:115],a[72:75],a[8:11],v[112:115]
SA s26,s26,32768
C v59,v24,v25
AF v26,v25,v26
M v[112:115],a[76:79],a[12:15],v[112:115]
R a[104:107],v2,26624
R a[108:111],v2,27648
M v[112:115],a[80:83],a[16:19],v[112:115]
E v20,v86
M v[112:115],a[84:87],a[20:23],v[112:115]
buffer_store_dwordx4 a[172:175], v7, s[8:11], s3 offen offset:2048 sc1
M v[112:115],a[88:91],a[24:27],v[112:115]
R a[112:115],v2,28672
R a[116:119],v2,29696
M v[112:115],a[92:95],a[28:31],v[112:115]
E v21,v87
M v[116:119],a[92:95],a[60:63],v[36:39]
AF v27,v18,v27
C v60,v18,v19
M v[116:119],a[88:91],a[56:59],v[116:119]
R a[120:123],v2,30720
R a[124:127],v2,31744
M v[116:119],a[84:87],a[52:55],v[116:119]
E v22,v92
M v[116:119],a[80:83],a[48:51],v[116:119]
AF v27,v19,v27
AF v27,v20,v27
M v[116:119],a[76:79],a[44:47],v[116:119]
C v61,v20,v21
AF v27,v21,v27
M v[116:119],a[72:75],a[40:43],v[116:119]
E v23,v93
M v[116:119],a[68:71],a[36:39],v[116:119]
s_waitcnt vmcnt(24) lgkmcnt(0)
AF v27,v22,v27
C v62,v22,v23
M v[116:119],a[64:67],a[32:35],v[116:119]
s_barrier
M v[124:127],a[96:99],a[32:35],v[36:39]
SA s3,s93,794624
R a[64:67],v7,0
R a[68:71],v7,1024
M v[124:127],a[100:103],a[36:39],v[124:127]
buffer_store_dwordx4 a[176:179], v7, s[8:11], s3 offen offset:0 sc1
M v[124:127],a[104:107],a[40:43],v[124:127]
E v24,v94
M v[124:127],a[108:111],a[44:47],v[124:127]
R a[72:75],v7,2048
R a[76:79],v7,3072
M v[124:127],a[112:115],a[48:51],v[124:127]
E v25,v95
M v[124:127],a[116:119],a[52:55],v[124:127]
AF v27,v23,v27
AF v27,v24,v27
M v[124:127],a[120:123],a[56:59],v[124:127]
R a[80:83],v7,4096
R a[84:87],v7,5120
M v[124:127],a[124:127],a[60:63],v[124:127]
C v63,v24,v25
AF v27,v25,v27
M v[120:123],a[124:127],a[28:31],v[32:35]
M v[120:123],a[120:123],a[24:27],v[120:123]
R a[88:91],v7,6144
R a[92:95],v7,7168
M v[120:123],a[116:119],a[20:23],v[120:123]
v_max_f32 v10, v26, v27
M v[120:123],a[112:115],a[16:19],v[120:123]
v_cmp_lt_f32 vcc, s31, v10
M v[120:123],a[108:111],a[12:15],v[120:123]
M v[120:123],a[104:107],a[8:11],v[120:123]
M v[120:123],a[100:103],a[4:7],v[120:123]
s_waitcnt lgkmcnt(0)
M v[120:123],a[96:99],a[0:3],v[120:123]
s_cbranch_vccnz L_stv3
L_rtv3:
M v[128:131],a[64:67],v[40:43],v[128:131]
R a[96:99],v7,8192
R a[100:103],v7,9216
M v[128:131],a[68:71],v[56:59],v[128:131]
SA m0,s28,65536
E v18,v96
M v[132:135],a[68:71],v[60:63],v[132:135]
buffer_load_dwordx4 v3, s[8:11], s21 offen offset:0 sc1 lds
M v[132:135],a[64:67],v[44:47],v[132:135]
R a[104:107],v7,10240
R a[108:111],v7,11264
M v[140:143],a[72:75],v[44:47],v[140:143]
E v19,v97
M v[140:143],a[76:79],v[60:63],v[140:143]
AF v30,v26,v30
AF v31,v27,v31
M v[136:139],a[76:79],v[56:59],v[136:139]
R a[112:115],v7,12288
R a[116:119],v7,13312
M v[136:139],a[72:75],v[40:43],v[136:139]
buffer_load_dwordx4 v3, s[8:11], s21 offen offset:1024 sc1 lds
M v[144:147],a[80:83],v[40:43],v[144:147]
E v20,v98
M v[144:147],a[84:87],v[56:59],v[144:147]
R a[120:123],v7,14336
R a[124:127],v7,15360
M v[148:151],a[84:87],v[60:63],v[148:151]
SA s3,s93,794624
AF v28,v18,v19
C v48,v18,v19
M v[148:151],a[80:83],v[44:47],v[148:151]
buffer_load_dwordx4 v3, s[8:11], s21 offen offset:2048 sc1 lds
M v[156:159],a[88:91],v[44:47],v[156:159]
E v21,v99
M v[156:159],a[92:95],v[60:63],v[156:159]
AF v28,v20,v28
C v49,v20,v21
M v[152:155],a[92:95],v[56:59],v[152:155]
buffer_store_dwordx4 a[180:183], v7, s[8:11], s3 offen offset:2048 sc1
M v[152:155],a[88:91],v[40:43],v[152:155]
s_waitcnt lgkmcnt(0)
E v22,v104
M v[160:163],a[96:99],v[40:43],v[160:163]
R a[64:67],v7,16384
R a[68:71],v7,17408
M v[160:163],a[100:103],v[56:59],v[160:163]
buffer_load_dwordx4 v3, s[8:11], s21 offen offset:3072 sc1 lds
M v[164:167],a[100:103],v[60:63],v[164:167]
SA m0,s28,69632
E v23,v105
M v[164:167],a[96:99],v[44:47],v[164:167]
R a[72:75],v7,18432
R a[76:79],v7,19456
M v[172:175],a[104:107],v[44:47],v[172:175]
buffer_load_dwordx4 v4, s[8:11], s21 offen offset:0 sc1 lds
M v[172:175],a[108:111],v[60:63],v[172:175]
AF v28,v21,v28
AF v28,v22,v28
M v[168:171],a[108:111],v[56:59],v[168:171]
R a[80:83],v7,20480
R a[84:87],v7,21504
M v[168:171],a[104:107],v[40:43],v[168:171]
buffer_load_dwordx4 v4, s[8:11], s21 offen offset:1024 sc1 lds
M v[176:179],a[112:115],v[40:43],v[176:179]
E v24,v106
M v[176:179],a[116:119],v[56:59],v[176:179]
SA s3,s93,798720
R a[88:91],v7,22528
R a[92:95],v7,23552
M v[180:183],a[116:119],v[60:63],v[180:183]
buffer_load_dwordx4 v4, s[8:11], s21 offen offset:2048 sc1 lds
M v[180:183],a[112:115],v[44:47],v[180:183]
E v25,v107
M v[188:191],a[120:123],v[44:47],v[188:191]
C v50,v22,v23
AF v28,v23,v28
M v[188:191],a[124:127],v[60:63],v[188:191]
AF v28,v24,v28
C v51,v24,v25
M v[184:187],a[124:127],v[56:59],v[184:187]
buffer_load_dwordx4 v4, s[8:11], s21 offen offset:3072 sc1 lds
M v[184:187],a[120:123],v[40:43],v[184:187]
s_waitcnt lgkmcnt(0)
E v18,v100
M v[192:195],a[64:67],v[40:43],v[192:195]
SA s21,s21,32768
R a[96:99],v7,24576
R a[100:103],v7,25600
M v[192:195],a[68:71],v[56:59],v[192:195]
s_sub_u32 s22, s22, 1
buffer_store_dwordx4 a[184:187], v7, s[8:11], s3 offen offset:0 sc1
M v[196:199],a[68:71],v[60:63],v[196:199]
s_cselect_b32 s21, s23, s21
E v19,v101
M v[196:199],a[64:67],v[44:47],v[196:199]
R a[104:107],v7,26624
R a[108:111],v7,27648
M v[204:207],a[72:75],v[44:47],v[204:207]
AF v28,v25,v28
AF v29,v18,v19
M v[204:207],a[76:79],v[60:63],v[204:207]
E v20,v102
M v[200:203],a[76:79],v[56:59],v[200:203]
R a[112:115],v7,28672
R a[116:119],v7,29696
M v[200:203],a[72:75],v[40:43],v[200:203]
C v52,v18,v19
M v[208:211],a[80:83],v[40:43],v[208:211]
M v[208:211],a[84:87],v[56:59],v[208:211]
R a[120:123],v7,30720
R a[124:127],v7,31744
M v[212:215],a[84:87],v[60:63],v[212:215]
E v21,v103
M v[212:215],a[80:83],v[44:47],v[212:215]
buffer_store_dwordx4 a[188:191], v7, s[8:11], s3 offen offset:2048 sc1
M v[220:223],a[88:91],v[44:47],v[220:223]
AF v29,v20,v29
C v53,v20,v21
M v[220:223],a[92:95],v[60:63],v[220:223]
E v22,v108
M v[216:219],a[92:95],v[56:59],v[216:219]
s_waitcnt vmcnt(25) lgkmcnt(0)
AF v29,v21,v29
M v[216:219],a[88:91],v[40:43],v[216:219]
s_barrier
M v[224:227],a[96:99],v[40:43],v[224:227]
R a[64:67],v2,32768
R a[68:71],v2,33792
M v[224:227],a[100:103],v[56:59],v[224:227]
E v23,v109
M v[228:231],a[100:103],v[60:63],v[228:231]
AF v29,v22,v29
C v54,v22,v23
M v[228:231],a[96:99],v[44:47],v[228:231]
R a[72:75],v2,34816
R a[76:79],v2,35840
M v[236:239],a[104:107],v[44:47],v[236:239]
E v24,v110
M v[236:239],a[108:111],v[60:63],v[236:239]
AF v29,v23,v29
M v[232:235],a[108:111],v[56:59],v[232:235]
R a[80:83],v2,36864
R a[84:87],v2,37888
M v[232:235],a[104:107],v[40:43],v[232:235]
M v[240:243],a[112:115],v[40:43],v[240:243]
E v25,v111
M v[240:243],a[116:119],v[56:59],v[240:243]
R a[88:91],v2,38912
R a[92:95],v2,39936
M v[244:247],a[116:119],v[60:63],v[244:247]
AF v29,v24,v29
C v55,v24,v25
M v[244:247],a[112:115],v[44:47],v[244:247]
AF v29,v25,v29
M v[252:255],a[120:123],v[44:47],v[252:255]
M v[252:255],a[124:127],v[60:63],v[252:255]
M v[248:251],a[124:127],v[56:59],v[248:251]
s_waitcnt lgkmcnt(0)
M v[248:251],a[120:123],v[40:43],v[248:251]
s_branch L_loop_top
L_st0:
s_call_b64 s[36:37], L_slow0
s_branch L_rt0
L_st1:
s_call_b64 s[36:37], L_slow1
s_branch L_rt1
L_stv1:
s_call_b64 s[36:37], L_slowf
s_branch L_rtv1
L_stk1:
s_call_b64 s[36:37], L_slowf
s_branch L_rtk1
L_sth1:
s_call_b64 s[36:37], L_slowf
s_branch L_rth1
L_stj0:
s_call_b64 s[36:37], L_slowj
s_branch L_rtj0
L_stv2:
s_call_b64 s[36:37], L_slow1
s_branch L_rtv2
L_stv3:
s_call_b64 s[36:37], L_slow0
s_branch L_rtv3
L_std1:
s_call_b64 s[36:37], L_slow1
s_branch L_rtd1
L_std3n:
s_call_b64 s[36:37], L_slow0
s_branch L_rtd3n
L_std3h:
s_call_b64 s[36:37], L_slow0
s_branch L_rtd3h
L_std4n:
s_call_b64 s[36:37], L_slowb
s_branch L_rtd4n
L_std4h:
s_call_b64 s[36:37], L_slowb
s_branch L_rtd4h
L_stfh:
s_call_b64 s[36:37], L_slow1n
s_branch L_rtfh
L_stc:
s_call_b64 s[36:37], L_comb
s_branch L_rtc
L_slow0:
s_nop 7
s_nop 3
v_max3_f32 v10, v64, v65, v66
v_max3_f32 v10, v67, v72, v10
v_max3_f32 v10, v73, v74, v10
v_max3_f32 v10, v75, v80, v10
v_max3_f32 v10, v81, v82, v10
v_max3_f32 v10, v83, v88, v10
v_max3_f32 v10, v89, v90, v10
v_max_f32 v10, v91, v10
v_max3_f32 v11, v68, v69, v70
v_max3_f32 v11, v71, v76, v11
v_max3_f32 v11, v77, v78, v11
v_max3_f32 v11, v79, v84, v11
v_max3_f32 v11, v85, v86, v11
v_max3_f32 v11, v87, v92, v11
v_max3_f32 v11, v93, v94, v11
v_max_f32 v11, v95, v11
v_mov_b32 v12, v10
v_mov_b32 v13, v11
s_nop 0
v_permlane16_swap_b32 v12, v10
v_permlane16_swap_b32 v13, v11
v_max_f32 v10, v12, v10
v_max_f32 v11, v13, v11
v_mov_b32 v12, v10
v_mov_b32 v13, v11
s_nop 0
v_permlane32_swap_b32 v12, v10
v_permlane32_swap_b32 v13, v11
v_max_f32 v10, v12, v10
v_max_f32 v11, v13, v11
v_ceil_f32 v10, v10
v_ceil_f32 v11, v11
v_max_f32 v10, 0, v10
v_max_f32 v11, 0, v11
v_sub_f32 v64, v64, v10
v_sub_f32 v65, v65, v10
v_sub_f32 v66, v66, v10
v_sub_f32 v67, v67, v10
v_sub_f32 v68, v68, v11
v_sub_f32 v69, v69, v11
v_sub_f32 v70, v70, v11
v_sub_f32 v71, v71, v11
v_sub_f32 v72, v72, v10
v_sub_f32 v73, v73, v10
v_sub_f32 v74, v74, v10
v_sub_f32 v75, v75, v10
v_sub_f32 v76, v76, v11
v_sub_f32 v77, v77, v11
v_sub_f32 v78, v78, v11
v_sub_f32 v79, v79, v11
v_sub_f32 v80, v80, v10
v_sub_f32 v81, v81, v10
v_sub_f32 v82, v82, v10
v_sub_f32 v83, v83, v10
v_sub_f32 v84, v84, v11
v_sub_f32 v85, v85, v11
v_sub_f32 v86, v86, v11
v_sub_f32 v87, v87, v11
v_sub_f32 v88, v88, v10
v_sub_f32 v89, v89, v10
v_sub_f32 v90, v90, v10
v_sub_f32 v91, v91, v10
v_sub_f32 v92, v92, v11
v_sub_f32 v93, v93, v11
v_sub_f32 v94, v94, v11
v_sub_f32 v95, v95, v11
v_sub_f32 v96, v96, v10
v_sub_f32 v97, v97, v10
v_sub_f32 v98, v98, v10
v_sub_f32 v99, v99, v10
v_sub_f32 v100, v100, v11
v_sub_f32 v101, v101, v11
v_sub_f32 v102, v102, v11
v_sub_f32 v103, v103, v11
v_sub_f32 v104, v104, v10
v_sub_f32 v105, v105, v10
v_sub_f32 v106, v106, v10
v_sub_f32 v107, v107, v10
v_sub_f32 v108, v108, v11
v_sub_f32 v109, v109, v11
v_sub_f32 v110, v110, v11
v_sub_f32 v111, v111, v11
v_sub_f32 v112, v112, v10
v_sub_f32 v113, v113, v10
v_sub_f32 v114, v114, v10
v_sub_f32 v115, v115, v10
v_sub_f32 v116, v116, v11
v_sub_f32 v117, v117, v11
v_sub_f32 v118, v118, v11
v_sub_f32 v119, v119, v11
v_sub_f32 v120, v120, v10
v_sub_f32 v121, v121, v10
v_sub_f32 v122, v122, v10
v_sub_f32 v123, v123, v10
v_sub_f32 v124, v124, v11
v_sub_f32 v125, v125, v11
v_sub_f32 v126, v126, v11
v_sub_f32 v127, v127, v11
v_sub_f32 v32, v32, v10
v_sub_f32 v33, v33, v10
v_sub_f32 v34, v34, v10
v_sub_f32 v35, v35, v10
v_sub_f32 v36, v36, v11
v_sub_f32 v37, v37, v11
v_sub_f32 v38, v38, v11
v_sub_f32 v39, v39, v11
E v12,-v10
E v13,-v11
MF v30,v12,v30
MF v31,v13,v31
MF v128,v12,v128
MF v129,v12,v129
MF v130,v12,v130
MF v131,v12,v131
MF v132,v13,v132
MF v133,v13,v133
MF v134,v13,v134
MF v135,v13,v135
MF v136,v12,v136
MF v137,v12,v137
MF v138,v12,v138
MF v139,v12,v139
MF v140,v13,v140
MF v141,v13,v141
MF v142,v13,v142
MF v143,v13,v143
MF v144,v12,v144
MF v145,v12,v145
MF v146,v12,v146
MF v147,v12,v147
MF v148,v13,v148
MF v149,v13,v149
MF v150,v13,v150
MF v151,v13,v151
MF v152,v12,v152
MF v153,v12,v153
MF v154,v12,v154
MF v155,v12,v155
MF v156,v13,v156
MF v157,v13,v157
MF v158,v13,v158
MF v159,v13,v159
MF v160,v12,v160
MF v161,v12,v161
MF v162,v12,v162
MF v163,v12,v163
MF v164,v13,v164
MF v165,v13,v165
MF v166,v13,v166
MF v167,v13,v167
MF v168,v12,v168
MF v169,v12,v169
MF v170,v12,v170
MF v171,v12,v171
MF v172,v13,v172
MF v173,v13,v173
MF v174,v13,v174
MF v175,v13,v175
MF v176,v12,v176
MF v177,v12,v177
MF v178,v12,v178
MF v179,v12,v179
MF v180,v13,v180
MF v181,v13,v181
MF v182,v13,v182
MF v183,v13,v183
MF v184,v12,v184
MF v185,v12,v185
MF v186,v12,v186
MF v187,v12,v187
MF v188,v13,v188
MF v189,v13,v189
MF v190,v13,v190
MF v191,v13,v191
MF v192,v12,v192
MF v193,v12,v193
MF v194,v12,v194
MF v195,v12,v195
MF v196,v13,v196
MF v197,v13,v197
MF v198,v13,v198
MF v199,v13,v199
MF v200,v12,v200
MF v201,v12,v201
MF v202,v12,v202
MF v203,v12,v203
MF v204,v13,v204
MF v205,v13,v205
MF v206,v13,v206
MF v207,v13,v207
MF v208,v12,v208
MF v209,v12,v209
MF v210,v12,v210
MF v211,v12,v211
MF v212,v13,v212
MF v213,v13,v213
MF v214,v13,v214
MF v215,v13,v215
MF v216,v12,v216
MF v217,v12,v217
MF v218,v12,v218
MF v219,v12,v219
MF v220,v13,v220
MF v221,v13,v221
MF v222,v13,v222
MF v223,v13,v223
MF v224,v12,v224
MF v225,v12,v225
MF v226,v12,v226
MF v227,v12,v227
MF v228,v13,v228
MF v229,v13,v229
MF v230,v13,v230
MF v231,v13,v231
MF v232,v12,v232
MF v233,v12,v233
MF v234,v12,v234
MF v235,v12,v235
MF v236,v13,v236
MF v237,v13,v237
MF v238,v13,v238
MF v239,v13,v239
MF v240,v12,v240
MF v241,v12,v241
MF v242,v12,v242
MF v243,v12,v243
MF v244,v13,v244
MF v245,v13,v245
MF v246,v13,v246
MF v247,v13,v247
MF v248,v12,v248
MF v249,v12,v249
MF v250,v12,v250
MF v251,v12,v251
MF v252,v13,v252
MF v253,v13,v253
MF v254,v13,v254
MF v255,v13,v255
E v18,v64
E v19,v65
E v20,v66
AF v26,v18,v19
C v40,v18,v19
E v21,v67
E v22,v72
AF v26,v20,v26
C v41,v20,v21
E v23,v73
AF v26,v21,v26
E v24,v74
AF v26,v22,v26
C v42,v22,v23
E v25,v75
AF v26,v23,v26
E v18,v68
AF v26,v24,v26
C v43,v24,v25
E v19,v69
AF v26,v25,v26
E v20,v70
AF v27,v18,v19
C v44,v18,v19
E v21,v71
E v22,v76
AF v27,v20,v27
C v45,v20,v21
E v23,v77
AF v27,v21,v27
E v24,v78
AF v27,v22,v27
C v46,v22,v23
E v25,v79
AF v27,v23,v27
AF v27,v24,v27
C v47,v24,v25
AF v27,v25,v27
E v18,v80
E v19,v81
E v20,v82
AF v26,v18,v26
C v56,v18,v19
E v21,v83
AF v26,v19,v26
E v22,v88
AF v26,v20,v26
C v57,v20,v21
E v23,v89
AF v26,v21,v26
E v24,v90
AF v26,v22,v26
C v58,v22,v23
E v25,v91
AF v26,v23,v26
E v18,v84
AF v26,v24,v26
C v59,v24,v25
E v19,v85
AF v26,v25,v26
E v20,v86
AF v27,v18,v27
C v60,v18,v19
E v21,v87
AF v27,v19,v27
E v22,v92
AF v27,v20,v27
C v61,v20,v21
E v23,v93
AF v27,v21,v27
E v24,v94
AF v27,v22,v27
C v62,v22,v23
E v25,v95
AF v27,v23,v27
AF v27,v24,v27
C v63,v24,v25
AF v27,v25,v27
s_nop 3
s_setpc_b64 s[36:37]
L_slow1:
s_nop 7
s_nop 3
v_max3_f32 v10, v96, v97, v98
v_max3_f32 v10, v99, v104, v10
v_max3_f32 v10, v105, v106, v10
v_max3_f32 v10, v107, v112, v10
v_max3_f32 v10, v113, v114, v10
v_max3_f32 v10, v115, v120, v10
v_max3_f32 v10, v121, v122, v10
v_max_f32 v10, v123, v10
v_max3_f32 v11, v100, v101, v102
v_max3_f32 v11, v103, v108, v11
v_max3_f32 v11, v109, v110, v11
v_max3_f32 v11, v111, v116, v11
v_max3_f32 v11, v117, v118, v11
v_max3_f32 v11, v119, v124, v11
v_max3_f32 v11, v125, v126, v11
v_max_f32 v11, v127, v11
v_mov_b32 v12, v10
v_mov_b32 v13, v11
s_nop 0
v_permlane16_swap_b32 v12, v10
v_permlane16_swap_b32 v13, v11
v_max_f32 v10, v12, v10
v_max_f32 v11, v13, v11
v_mov_b32 v12, v10
v_mov_b32 v13, v11
s_nop 0
v_permlane32_swap_b32 v12, v10
v_permlane32_swap_b32 v13, v11
v_max_f32 v10, v12, v10
v_max_f32 v11, v13, v11
v_ceil_f32 v10, v10
v_ceil_f32 v11, v11
v_max_f32 v10, 0, v10
v_max_f32 v11, 0, v11
v_sub_f32 v96, v96, v10
v_sub_f32 v97, v97, v10
v_sub_f32 v98, v98, v10
v_sub_f32 v99, v99, v10
v_sub_f32 v100, v100, v11
v_sub_f32 v101, v101, v11
v_sub_f32 v102, v102, v11
v_sub_f32 v103, v103, v11
v_sub_f32 v104, v104, v10
v_sub_f32 v105, v105, v10
v_sub_f32 v106, v106, v10
v_sub_f32 v107, v107, v10
v_sub_f32 v108, v108, v11
v_sub_f32 v109, v109, v11
v_sub_f32 v110, v110, v11
v_sub_f32 v111, v111, v11
v_sub_f32 v112, v112, v10
v_sub_f32 v113, v113, v10
v_sub_f32 v114, v114, v10
v_sub_f32 v115, v115, v10
v_sub_f32 v116, v116, v11
v_sub_f32 v117, v117, v11
v_sub_f32 v118, v118, v11
v_sub_f32 v119, v119, v11
v_sub_f32 v120, v120, v10
v_sub_f32 v121, v121, v10
v_sub_f32 v122, v122, v10
v_sub_f32 v123, v123, v10
v_sub_f32 v124, v124, v11
v_sub_f32 v125, v125, v11
v_sub_f32 v126, v126, v11
v_sub_f32 v127, v127, v11
v_sub_f32 v64, v64, v10
v_sub_f32 v65, v65, v10
v_sub_f32 v66, v66, v10
v_sub_f32 v67, v67, v10
v_sub_f32 v68, v68, v11
v_sub_f32 v69, v69, v11
v_sub_f32 v70, v70, v11
v_sub_f32 v71, v71, v11
v_sub_f32 v72, v72, v10
v_sub_f32 v73, v73, v10
v_sub_f32 v74, v74, v10
v_sub_f32 v75, v75, v10
v_sub_f32 v76, v76, v11
v_sub_f32 v77, v77, v11
v_sub_f32 v78, v78, v11
v_sub_f32 v79, v79, v11
v_sub_f32 v80, v80, v10
v_sub_f32 v81, v81, v10
v_sub_f32 v82, v82, v10
v_sub_f32 v83, v83, v10
v_sub_f32 v84, v84, v11
v_sub_f32 v85, v85, v11
v_sub_f32 v86, v86, v11
v_sub_f32 v87, v87, v11
v_sub_f32 v88, v88, v10
v_sub_f32 v89, v89, v10
v_sub_f32 v90, v90, v10
v_sub_f32 v91, v91, v10
v_sub_f32 v92, v92, v11
v_sub_f32 v93, v93, v11
v_sub_f32 v94, v94, v11
v_sub_f32 v95, v95, v11
v_sub_f32 v32, v32, v10
v_sub_f32 v33, v33, v10
v_sub_f32 v34, v34, v10
v_sub_f32 v35, v35, v10
v_sub_f32 v36, v36, v11
v_sub_f32 v37, v37, v11
v_sub_f32 v38, v38, v11
v_sub_f32 v39, v39, v11
E v12,-v10
E v13,-v11
MF v30,v12,v30
MF v31,v13,v31
MF v128,v12,v128
MF v129,v12,v129
MF v130,v12,v130
MF v131,v12,v131
MF v132,v13,v132
MF v133,v13,v133
MF v134,v13,v134
MF v135,v13,v135
MF v136,v12,v136
MF v137,v12,v137
MF v138,v12,v138
MF v139,v12,v139
MF v140,v13,v140
MF v141,v13,v141
MF v142,v13,v142
MF v143,v13,v143
MF v144,v12,v144
MF v145,v12,v145
MF v146,v12,v146
MF v147,v12,v147
MF v148,v13,v148
MF v149,v13,v149
MF v150,v13,v150
MF v151,v13,v151
MF v152,v12,v152
MF v153,v12,v153
MF v154,v12,v154
MF v155,v12,v155
MF v156,v13,v156
MF v157,v13,v157
MF v158,v13,v158
MF v159,v13,v159
MF v160,v12,v160
MF v161,v12,v161
MF v162,v12,v162
MF v163,v12,v163
MF v164,v13,v164
MF v165,v13,v165
MF v166,v13,v166
MF v167,v13,v167
MF v168,v12,v168
MF v169,v12,v169
MF v170,v12,v170
MF v171,v12,v171
MF v172,v13,v172
MF v173,v13,v173
MF v174,v13,v174
MF v175,v13,v175
MF v176,v12,v176
MF v177,v12,v177
MF v178,v12,v178
MF v179,v12,v179
MF v180,v13,v180
MF v181,v13,v181
MF v182,v13,v182
MF v183,v13,v183
MF v184,v12,v184
MF v185,v12,v185
MF v186,v12,v186
MF v187,v12,v187
MF v188,v13,v188
MF v189,v13,v189
MF v190,v13,v190
MF v191,v13,v191
MF v192,v12,v192
MF v193,v12,v193
MF v194,v12,v194
MF v195,v12,v195
MF v196,v13,v196
MF v197,v13,v197
MF v198,v13,v198
MF v199,v13,v199
MF v200,v12,v200
MF v201,v12,v201
MF v202,v12,v202
MF v203,v12,v203
MF v204,v13,v204
MF v205,v13,v205
MF v206,v13,v206
MF v207,v13,v207
MF v208,v12,v208
MF v209,v12,v209
MF v210,v12,v210
MF v211,v12,v211
MF v212,v13,v212
MF v213,v13,v213
MF v214,v13,v214
MF v215,v13,v215
MF v216,v12,v216
MF v217,v12,v217
MF v218,v12,v218
MF v219,v12,v219
MF v220,v13,v220
MF v221,v13,v221
MF v222,v13,v222
MF v223,v13,v223
MF v224,v12,v224
MF v225,v12,v225
MF v226,v12,v226
MF v227,v12,v227
MF v228,v13,v228
MF v229,v13,v229
MF v230,v13,v230
MF v231,v13,v231
MF v232,v12,v232
MF v233,v12,v233
MF v234,v12,v234
MF v235,v12,v235
MF v236,v13,v236
MF v237,v13,v237
MF v238,v13,v238
MF v239,v13,v239
MF v240,v12,v240
MF v241,v12,v241
MF v242,v12,v242
MF v243,v12,v243
MF v244,v13,v244
MF v245,v13,v245
MF v246,v13,v246
MF v247,v13,v247
MF v248,v12,v248
MF v249,v12,v249
MF v250,v12,v250
MF v251,v12,v251
MF v252,v13,v252
MF v253,v13,v253
MF v254,v13,v254
MF v255,v13,v255
E v18,v96
E v19,v97
E v20,v98
AF v28,v18,v19
C v48,v18,v19
E v21,v99
E v22,v104
AF v28,v20,v28
C v49,v20,v21
E v23,v105
AF v28,v21,v28
E v24,v106
AF v28,v22,v28
C v50,v22,v23
E v25,v107
AF v28,v23,v28
E v18,v100
AF v28,v24,v28
C v51,v24,v25
E v19,v101
AF v28,v25,v28
E v20,v102
AF v29,v18,v19
C v52,v18,v19
E v21,v103
E v22,v108
AF v29,v20,v29
C v53,v20,v21
E v23,v109
AF v29,v21,v29
E v24,v110
AF v29,v22,v29
C v54,v22,v23
E v25,v111
AF v29,v23,v29
AF v29,v24,v29
C v55,v24,v25
AF v29,v25,v29
E v18,v112
E v19,v113
E v20,v114
AF v28,v18,v28
C v56,v18,v19
E v21,v115
AF v28,v19,v28
E v22,v120
AF v28,v20,v28
C v57,v20,v21
E v23,v121
AF v28,v21,v28
E v24,v122
AF v28,v22,v28
C v58,v22,v23
E v25,v123
AF v28,v23,v28
E v18,v116
AF v28,v24,v28
C v59,v24,v25
E v19,v117
AF v28,v25,v28
E v20,v118
AF v29,v18,v29
C v60,v18,v19
E v21,v119
AF v29,v19,v29
E v22,v124
AF v29,v20,v29
C v61,v20,v21
E v23,v125
AF v29,v21,v29
E v24,v126
AF v29,v22,v29
C v62,v22,v23
E v25,v127
AF v29,v23,v29
AF v29,v24,v29
C v63,v24,v25
AF v29,v25,v29
s_nop 3
s_setpc_b64 s[36:37]
L_slow1n:
s_nop 7
s_nop 3
v_max3_f32 v10, v96, v97, v98
v_max3_f32 v10, v99, v104, v10
v_max3_f32 v10, v105, v106, v10
v_max3_f32 v10, v107, v112, v10
v_max3_f32 v10, v113, v114, v10
v_max3_f32 v10, v115, v120, v10
v_max3_f32 v10, v121, v122, v10
v_max_f32 v10, v123, v10
v_max3_f32 v11, v100, v101, v102
v_max3_f32 v11, v103, v108, v11
v_max3_f32 v11, v109, v110, v11
v_max3_f32 v11, v111, v116, v11
v_max3_f32 v11, v117, v118, v11
v_max3_f32 v11, v119, v124, v11
v_max3_f32 v11, v125, v126, v11
v_max_f32 v11, v127, v11
v_mov_b32 v12, v10
v_mov_b32 v13, v11
s_nop 0
v_permlane16_swap_b32 v12, v10
v_permlane16_swap_b32 v13, v11
v_max_f32 v10, v12, v10
v_max_f32 v11, v13, v11
v_mov_b32 v12, v10
v_mov_b32 v13, v11
s_nop 0
v_permlane32_swap_b32 v12, v10
v_permlane32_swap_b32 v13, v11
v_max_f32 v10, v12, v10
v_max_f32 v11, v13, v11
v_ceil_f32 v10, v10
v_ceil_f32 v11, v11
v_max_f32 v10, 0, v10
v_max_f32 v11, 0, v11
v_sub_f32 v96, v96, v10
v_sub_f32 v97, v97, v10
v_sub_f32 v98, v98, v10
v_sub_f32 v99, v99, v10
v_sub_f32 v100, v100, v11
v_sub_f32 v101, v101, v11
v_sub_f32 v102, v102, v11
v_sub_f32 v103, v103, v11
v_sub_f32 v104, v104, v10
v_sub_f32 v105, v105, v10
v_sub_f32 v106, v106, v10
v_sub_f32 v107, v107, v10
v_sub_f32 v108, v108, v11
v_sub_f32 v109, v109, v11
v_sub_f32 v110, v110, v11
v_sub_f32 v111, v111, v11
v_sub_f32 v112, v112, v10
v_sub_f32 v113, v113, v10
v_sub_f32 v114, v114, v10
v_sub_f32 v115, v115, v10
v_sub_f32 v116, v116, v11
v_sub_f32 v117, v117, v11
v_sub_f32 v118, v118, v11
v_sub_f32 v119, v119, v11
v_sub_f32 v120, v120, v10
v_sub_f32 v121, v121, v10
v_sub_f32 v122, v122, v10
v_sub_f32 v123, v123, v10
v_sub_f32 v124, v124, v11
v_sub_f32 v125, v125, v11
v_sub_f32 v126, v126, v11
v_sub_f32 v127, v127, v11
v_sub_f32 v32, v32, v10
v_sub_f32 v33, v33, v10
v_sub_f32 v34, v34, v10
v_sub_f32 v35, v35, v10
v_sub_f32 v36, v36, v11
v_sub_f32 v37, v37, v11
v_sub_f32 v38, v38, v11
v_sub_f32 v39, v39, v11
E v12,-v10
E v13,-v11
MF v30,v12,v30
MF v31,v13,v31
MF v128,v12,v128
MF v129,v12,v129
MF v130,v12,v130
MF v131,v12,v131
MF v132,v13,v132
MF v133,v13,v133
MF v134,v13,v134
MF v135,v13,v135
MF v136,v12,v136
MF v137,v12,v137
MF v138,v12,v138
MF v139,v12,v139
MF v140,v13,v140
MF v141,v13,v141
MF v142,v13,v142
MF v143,v13,v143
MF v144,v12,v144
MF v145,v12,v145
MF v146,v12,v146
MF v147,v12,v147
MF v148,v13,v148
MF v149,v13,v149
MF v150,v13,v150
MF v151,v13,v151
MF v152,v12,v152
MF v153,v12,v153
MF v154,v12,v154
MF v155,v12,v155
MF v156,v13,v156
MF v157,v13,v157
MF v158,v13,v158
MF v159,v13,v159
MF v160,v12,v160
MF v161,v12,v161
MF v162,v12,v162
MF v163,v12,v163
MF v164,v13,v164
MF v165,v13,v165
MF v166,v13,v166
MF v167,v13,v167
MF v168,v12,v168
MF v169,v12,v169
MF v170,v12,v170
MF v171,v12,v171
MF v172,v13,v172
MF v173,v13,v173
MF v174,v13,v174
MF v175,v13,v175
MF v176,v12,v176
MF v177,v12,v177
MF v178,v12,v178
MF v179,v12,v179
MF v180,v13,v180
MF v181,v13,v181
MF v182,v13,v182
MF v183,v13,v183
MF v184,v12,v184
MF v185,v12,v185
MF v186,v12,v186
MF v187,v12,v187
MF v188,v13,v188
MF v189,v13,v189
MF v190,v13,v190
MF v191,v13,v191
MF v192,v12,v192
MF v193,v12,v193
MF v194,v12,v194
MF v195,v12,v195
MF v196,v13,v196
MF v197,v13,v197
MF v198,v13,v198
MF v199,v13,v199
MF v200,v12,v200
MF v201,v12,v201
MF v202,v12,v202
MF v203,v12,v203
MF v204,v13,v204
MF v205,v13,v205
MF v206,v13,v206
MF v207,v13,v207
MF v208,v12,v208
MF v209,v12,v209
MF v210,v12,v210
MF v211,v12,v211
MF v212,v13,v212
MF v213,v13,v213
MF v214,v13,v214
MF v215,v13,v215
MF v216,v12,v216
MF v217,v12,v217
MF v218,v12,v218
MF v219,v12,v219
MF v220,v13,v220
MF v221,v13,v221
MF v222,v13,v222
MF v223,v13,v223
MF v224,v12,v224
MF v225,v12,v225
MF v226,v12,v226
MF v227,v12,v227
MF v228,v13,v228
MF v229,v13,v229
MF v230,v13,v230
MF v231,v13,v231
MF v232,v12,v232
MF v233,v12,v233
MF v234,v12,v234
MF v235,v12,v235
MF v236,v13,v236
MF v237,v13,v237
MF v238,v13,v238
MF v239,v13,v239
MF v240,v12,v240
MF v241,v12,v241
MF v242,v12,v242
MF v243,v12,v243
MF v244,v13,v244
MF v245,v13,v245
MF v246,v13,v246
MF v247,v13,v247
MF v248,v12,v248
MF v249,v12,v249
MF v250,v12,v250
MF v251,v12,v251
MF v252,v13,v252
MF v253,v13,v253
MF v254,v13,v254
MF v255,v13,v255
E v18,v96
E v19,v97
E v20,v98
AF v28,v18,v19
C v48,v18,v19
E v21,v99
E v22,v104
AF v28,v20,v28
C v49,v20,v21
E v23,v105
AF v28,v21,v28
E v24,v106
AF v28,v22,v28
C v50,v22,v23
E v25,v107
AF v28,v23,v28
E v18,v100
AF v28,v24,v28
C v51,v24,v25
E v19,v101
AF v28,v25,v28
E v20,v102
AF v29,v18,v19
C v52,v18,v19
E v21,v103
E v22,v108
AF v29,v20,v29
C v53,v20,v21
E v23,v109
AF v29,v21,v29
E v24,v110
AF v29,v22,v29
C v54,v22,v23
E v25,v111
AF v29,v23,v29
AF v29,v24,v29
C v55,v24,v25
AF v29,v25,v29
E v18,v112
E v19,v113
E v20,v114
AF v28,v18,v28
C v56,v18,v19
E v21,v115
AF v28,v19,v28
E v22,v120
AF v28,v20,v28
C v57,v20,v21
E v23,v121
AF v28,v21,v28
E v24,v122
AF v28,v22,v28
C v58,v22,v23
E v25,v123
AF v28,v23,v28
E v18,v116
AF v28,v24,v28
C v59,v24,v25
E v19,v117
AF v28,v25,v28
E v20,v118
AF v29,v18,v29
C v60,v18,v19
E v21,v119
AF v29,v19,v29
E v22,v124
AF v29,v20,v29
C v61,v20,v21
E v23,v125
AF v29,v21,v29
E v24,v126
AF v29,v22,v29
C v62,v22,v23
E v25,v127
AF v29,v23,v29
AF v29,v24,v29
C v63,v24,v25
AF v29,v25,v29
s_nop 3
s_setpc_b64 s[36:37]
L_slowf:
s_nop 7
s_nop 3
v_max3_f32 v10, v64, v65, v66
v_max3_f32 v10, v67, v72, v10
v_max3_f32 v10, v73, v74, v10
v_max3_f32 v10, v75, v80, v10
v_max3_f32 v10, v81, v82, v10
v_max3_f32 v10, v83, v88, v10
v_max3_f32 v10, v89, v90, v10
v_max_f32 v10, v91, v10
v_max3_f32 v11, v68, v69, v70
v_max3_f32 v11, v71, v76, v11
v_max3_f32 v11, v77, v78, v11
v_max3_f32 v11, v79, v84, v11
v_max3_f32 v11, v85, v86, v11
v_max3_f32 v11, v87, v92, v11
v_max3_f32 v11, v93, v94, v11
v_max_f32 v11, v95, v11
v_mov_b32 v12, v10
v_mov_b32 v13, v11
s_nop 0
v_permlane16_swap_b32 v12, v10
v_permlane16_swap_b32 v13, v11
v_max_f32 v10, v12, v10
v_max_f32 v11, v13, v11
v_mov_b32 v12, v10
v_mov_b32 v13, v11
s_nop 0
v_permlane32_swap_b32 v12, v10
v_permlane32_swap_b32 v13, v11
v_max_f32 v10, v12, v10
v_max_f32 v11, v13, v11
v_ceil_f32 v10, v10
v_ceil_f32 v11, v11
v_sub_f32 v64, v64, v10
v_sub_f32 v65, v65, v10
v_sub_f32 v66, v66, v10
v_sub_f32 v67, v67, v10
v_sub_f32 v68, v68, v11
v_sub_f32 v69, v69, v11
v_sub_f32 v70, v70, v11
v_sub_f32 v71, v71, v11
v_sub_f32 v72, v72, v10
v_sub_f32 v73, v73, v10
v_sub_f32 v74, v74, v10
v_sub_f32 v75, v75, v10
v_sub_f32 v76, v76, v11
v_sub_f32 v77, v77, v11
v_sub_f32 v78, v78, v11
v_sub_f32 v79, v79, v11
v_sub_f32 v80, v80, v10
v_sub_f32 v81, v81, v10
v_sub_f32 v82, v82, v10
v_sub_f32 v83, v83, v10
v_sub_f32 v84, v84, v11
v_sub_f32 v85, v85, v11
v_sub_f32 v86, v86, v11
v_sub_f32 v87, v87, v11
v_sub_f32 v88, v88, v10
v_sub_f32 v89, v89, v10
v_sub_f32 v90, v90, v10
v_sub_f32 v91, v91, v10
v_sub_f32 v92, v92, v11
v_sub_f32 v93, v93, v11
v_sub_f32 v94, v94, v11
v_sub_f32 v95, v95, v11
v_sub_f32 v96, v96, v10
v_sub_f32 v97, v97, v10
v_sub_f32 v98, v98, v10
v_sub_f32 v99, v99, v10
v_sub_f32 v100, v100, v11
v_sub_f32 v101, v101, v11
v_sub_f32 v102, v102, v11
v_sub_f32 v103, v103, v11
v_sub_f32 v104, v104, v10
v_sub_f32 v105, v105, v10
v_sub_f32 v106, v106, v10
v_sub_f32 v107, v107, v10
v_sub_f32 v108, v108, v11
v_sub_f32 v109, v109, v11
v_sub_f32 v110, v110, v11
v_sub_f32 v111, v111, v11
v_sub_f32 v112, v112, v10
v_sub_f32 v113, v113, v10
v_sub_f32 v114, v114, v10
v_sub_f32 v115, v115, v10
v_sub_f32 v116, v116, v11
v_sub_f32 v117, v117, v11
v_sub_f32 v118, v118, v11
v_sub_f32 v119, v119, v11
v_sub_f32 v120, v120, v10
v_sub_f32 v121, v121, v10
v_sub_f32 v122, v122, v10
v_sub_f32 v123, v123, v10
v_sub_f32 v124, v124, v11
v_sub_f32 v125, v125, v11
v_sub_f32 v126, v126, v11
v_sub_f32 v127, v127, v11
v_sub_f32 v32, v32, v10
v_sub_f32 v33, v33, v10
v_sub_f32 v34, v34, v10
v_sub_f32 v35, v35, v10
v_sub_f32 v36, v36, v11
v_sub_f32 v37, v37, v11
v_sub_f32 v38, v38, v11
v_sub_f32 v39, v39, v11
E v18,v64
E v19,v65
E v20,v66
AF v26,v18,v19
C v40,v18,v19
E v21,v67
E v22,v72
AF v26,v20,v26
C v41,v20,v21
E v23,v73
AF v26,v21,v26
E v24,v74
AF v26,v22,v26
C v42,v22,v23
E v25,v75
AF v26,v23,v26
E v18,v68
AF v26,v24,v26
C v43,v24,v25
E v19,v69
AF v26,v25,v26
E v20,v70
AF v27,v18,v19
C v44,v18,v19
E v21,v71
E v22,v76
AF v27,v20,v27
C v45,v20,v21
E v23,v77
AF v27,v21,v27
E v24,v78
AF v27,v22,v27
C v46,v22,v23
E v25,v79
AF v27,v23,v27
AF v27,v24,v27
C v47,v24,v25
AF v27,v25,v27
E v18,v80
E v19,v81
E v20,v82
AF v26,v18,v26
C v56,v18,v19
E v21,v83
AF v26,v19,v26
E v22,v88
AF v26,v20,v26
C v57,v20,v21
E v23,v89
AF v26,v21,v26
E v24,v90
AF v26,v22,v26
C v58,v22,v23
E v25,v91
AF v26,v23,v26
E v18,v84
AF v26,v24,v26
C v59,v24,v25
E v19,v85
AF v26,v25,v26
E v20,v86
AF v27,v18,v27
C v60,v18,v19
E v21,v87
AF v27,v19,v27
E v22,v92
AF v27,v20,v27
C v61,v20,v21
E v23,v93
AF v27,v21,v27
E v24,v94
AF v27,v22,v27
C v62,v22,v23
E v25,v95
AF v27,v23,v27
AF v27,v24,v27
C v63,v24,v25
AF v27,v25,v27
s_nop 3
s_setpc_b64 s[36:37]
L_slowj:
s_nop 7
s_nop 3
v_max3_f32 v10, v64, v65, v66
v_max3_f32 v10, v67, v72, v10
v_max3_f32 v10, v73, v74, v10
v_max3_f32 v10, v75, v80, v10
v_max3_f32 v10, v81, v82, v10
v_max3_f32 v10, v83, v88, v10
v_max3_f32 v10, v89, v90, v10
v_max_f32 v10, v91, v10
v_max3_f32 v11, v68, v69, v70
v_max3_f32 v11, v71, v76, v11
v_max3_f32 v11, v77, v78, v11
v_max3_f32 v11, v79, v84, v11
v_max3_f32 v11, v85, v86, v11
v_max3_f32 v11, v87, v92, v11
v_max3_f32 v11, v93, v94, v11
v_max_f32 v11, v95, v11
v_mov_b32 v12, v10
v_mov_b32 v13, v11
s_nop 0
v_permlane16_swap_b32 v12, v10
v_permlane16_swap_b32 v13, v11
v_max_f32 v10, v12, v10
v_max_f32 v11, v13, v11
v_mov_b32 v12, v10
v_mov_b32 v13, v11
s_nop 0
v_permlane32_swap_b32 v12, v10
v_permlane32_swap_b32 v13, v11
v_max_f32 v10, v12, v10
v_max_f32 v11, v13, v11
v_ceil_f32 v10, v10
v_ceil_f32 v11, v11
v_sub_f32 v64, v64, v10
v_sub_f32 v65, v65, v10
v_sub_f32 v66, v66, v10
v_sub_f32 v67, v67, v10
v_sub_f32 v68, v68, v11
v_sub_f32 v69, v69, v11
v_sub_f32 v70, v70, v11
v_sub_f32 v71, v71, v11
v_sub_f32 v72, v72, v10
v_sub_f32 v73, v73, v10
v_sub_f32 v74, v74, v10
v_sub_f32 v75, v75, v10
v_sub_f32 v76, v76, v11
v_sub_f32 v77, v77, v11
v_sub_f32 v78, v78, v11
v_sub_f32 v79, v79, v11
v_sub_f32 v80, v80, v10
v_sub_f32 v81, v81, v10
v_sub_f32 v82, v82, v10
v_sub_f32 v83, v83, v10
v_sub_f32 v84, v84, v11
v_sub_f32 v85, v85, v11
v_sub_f32 v86, v86, v11
v_sub_f32 v87, v87, v11
v_sub_f32 v88, v88, v10
v_sub_f32 v89, v89, v10
v_sub_f32 v90, v90, v10
v_sub_f32 v91, v91, v10
v_sub_f32 v92, v92, v11
v_sub_f32 v93, v93, v11
v_sub_f32 v94, v94, v11
v_sub_f32 v95, v95, v11
v_sub_f32 v32, v32, v10
v_sub_f32 v33, v33, v10
v_sub_f32 v34, v34, v10
v_sub_f32 v35, v35, v10
v_sub_f32 v36, v36, v11
v_sub_f32 v37, v37, v11
v_sub_f32 v38, v38, v11
v_sub_f32 v39, v39, v11
E v18,v64
E v19,v65
E v20,v66
AF v26,v18,v19
C v40,v18,v19
E v21,v67
E v22,v72
AF v26,v20,v26
C v41,v20,v21
E v23,v73
AF v26,v21,v26
E v24,v74
AF v26,v22,v26
C v42,v22,v23
E v25,v75
AF v26,v23,v26
E v18,v68
AF v26,v24,v26
C v43,v24,v25
E v19,v69
AF v26,v25,v26
E v20,v70
AF v27,v18,v19
C v44,v18,v19
E v21,v71
E v22,v76
AF v27,v20,v27
C v45,v20,v21
E v23,v77
AF v27,v21,v27
E v24,v78
AF v27,v22,v27
C v46,v22,v23
E v25,v79
AF v27,v23,v27
AF v27,v24,v27
C v47,v24,v25
AF v27,v25,v27
s_nop 3
s_setpc_b64 s[36:37]
L_slowb:
s_nop 7
s_nop 3
v_max3_f32 v11, v100, v101, v102
v_max3_f32 v11, v103, v108, v11
v_max3_f32 v11, v109, v110, v11
v_max3_f32 v11, v111, v116, v11
v_max3_f32 v11, v117, v118, v11
v_max3_f32 v11, v119, v124, v11
v_max3_f32 v11, v125, v126, v11
v_max_f32 v11, v127, v11
v_mov_b32 v13, v11
s_nop 1
v_permlane16_swap_b32 v13, v11
v_max_f32 v11, v13, v11
v_mov_b32 v13, v11
s_nop 1
v_permlane32_swap_b32 v13, v11
v_max_f32 v11, v13, v11
v_ceil_f32 v11, v11
v_max_f32 v11, 0, v11
v_mov_b32 v10, 0
v_sub_f32 v100, v100, v11
v_sub_f32 v101, v101, v11
v_sub_f32 v102, v102, v11
v_sub_f32 v103, v103, v11
v_sub_f32 v108, v108, v11
v_sub_f32 v109, v109, v11
v_sub_f32 v110, v110, v11
v_sub_f32 v111, v111, v11
v_sub_f32 v116, v116, v11
v_sub_f32 v117, v117, v11
v_sub_f32 v118, v118, v11
v_sub_f32 v119, v119, v11
v_sub_f32 v124, v124, v11
v_sub_f32 v125, v125, v11
v_sub_f32 v126, v126, v11
v_sub_f32 v127, v127, v11
v_sub_f32 v32, v32, v10
v_sub_f32 v33, v33, v10
v_sub_f32 v34, v34, v10
v_sub_f32 v35, v35, v10
v_sub_f32 v36, v36, v11
v_sub_f32 v37, v37, v11
v_sub_f32 v38, v38, v11
v_sub_f32 v39, v39, v11
E v12,-v10
E v13,-v11
MF v30,v12,v30
MF v31,v13,v31
MF v128,v12,v128
MF v129,v12,v129
MF v130,v12,v130
MF v131,v12,v131
MF v132,v13,v132
MF v133,v13,v133
MF v134,v13,v134
MF v135,v13,v135
MF v136,v12,v136
MF v137,v12,v137
MF v138,v12,v138
MF v139,v12,v139
MF v140,v13,v140
MF v141,v13,v141
MF v142,v13,v142
MF v143,v13,v143
MF v144,v12,v144
MF v145,v12,v145
MF v146,v12,v146
MF v147,v12,v147
MF v148,v13,v148
MF v149,v13,v149
MF v150,v13,v150
MF v151,v13,v151
MF v152,v12,v152
MF v153,v12,v153
MF v154,v12,v154
MF v155,v12,v155
MF v156,v13,v156
MF v157,v13,v157
MF v158,v13,v158
MF v159,v13,v159
MF v160,v12,v160
MF v161,v12,v161
MF v162,v12,v162
MF v163,v12,v163
MF v164,v13,v164
MF v165,v13,v165
MF v166,v13,v166
MF v167,v13,v167
MF v168,v12,v168
MF v169,v12,v169
MF v170,v12,v170
MF v171,v12,v171
MF v172,v13,v172
MF v173,v13,v173
MF v174,v13,v174
MF v175,v13,v175
MF v176,v12,v176
MF v177,v12,v177
MF v178,v12,v178
MF v179,v12,v179
MF v180,v13,v180
MF v181,v13,v181
MF v182,v13,v182
MF v183,v13,v183
MF v184,v12,v184
MF v185,v12,v185
MF v186,v12,v186
MF v187,v12,v187
MF v188,v13,v188
MF v189,v13,v189
MF v190,v13,v190
MF v191,v13,v191
MF v192,v12,v192
MF v193,v12,v193
MF v194,v12,v194
MF v195,v12,v195
MF v196,v13,v196
MF v197,v13,v197
MF v198,v13,v198
MF v199,v13,v199
MF v200,v12,v200
MF v201,v12,v201
MF v202,v12,v202
MF v203,v12,v203
MF v204,v13,v204
MF v205,v13,v205
MF v206,v13,v206
MF v207,v13,v207
MF v208,v12,v208
MF v209,v12,v209
MF v210,v12,v210
MF v211,v12,v211
MF v212,v13,v212
MF v213,v13,v213
MF v214,v13,v214
MF v215,v13,v215
MF v216,v12,v216
MF v217,v12,v217
MF v218,v12,v218
MF v219,v12,v219
MF v220,v13,v220
MF v221,v13,v221
MF v222,v13,v222
MF v223,v13,v223
MF v224,v12,v224
MF v225,v12,v225
MF v226,v12,v226
MF v227,v12,v227
MF v228,v13,v228
MF v229,v13,v229
MF v230,v13,v230
MF v231,v13,v231
MF v232,v12,v232
MF v233,v12,v233
MF v234,v12,v234
MF v235,v12,v235
MF v236,v13,v236
MF v237,v13,v237
MF v238,v13,v238
MF v239,v13,v239
MF v240,v12,v240
MF v241,v12,v241
MF v242,v12,v242
MF v243,v12,v243
MF v244,v13,v244
MF v245,v13,v245
MF v246,v13,v246
MF v247,v13,v247
MF v248,v12,v248
MF v249,v12,v249
MF v250,v12,v250
MF v251,v12,v251
MF v252,v13,v252
MF v253,v13,v253
MF v254,v13,v254
MF v255,v13,v255
E v18,v100
E v19,v101
E v20,v102
AF v29,v18,v19
C v52,v18,v19
E v21,v103
E v22,v108
AF v29,v20,v29
C v53,v20,v21
E v23,v109
AF v29,v21,v29
E v24,v110
AF v29,v22,v29
C v54,v22,v23
E v25,v111
AF v29,v23,v29
E v18,v116
AF v29,v24,v29
C v55,v24,v25
E v19,v117
AF v29,v25,v29
E v20,v118
AF v29,v18,v29
C v48,v18,v19
E v21,v119
AF v29,v19,v29
E v22,v124
AF v29,v20,v29
C v49,v20,v21
E v23,v125
AF v29,v21,v29
E v24,v126
AF v29,v22,v29
C v50,v22,v23
E v25,v127
AF v29,v23,v29
AF v29,v24,v29
C v51,v24,v25
AF v29,v25,v29
s_nop 3
s_setpc_b64 s[36:37]
L_comb:
s_waitcnt vmcnt(0)
s_nop 7
v_sub_f32 v10, v32, v14
v_sub_f32 v11, v36, v15
v_max_f32 v10, 0, v10
v_max_f32 v11, 0, v11
v_sub_f32 v100, v100, v11
v_sub_f32 v101, v101, v11
v_sub_f32 v102, v102, v11
v_sub_f32 v103, v103, v11
v_sub_f32 v108, v108, v11
v_sub_f32 v109, v109, v11
v_sub_f32 v110, v110, v11
v_sub_f32 v111, v111, v11
v_sub_f32 v116, v116, v11
v_sub_f32 v117, v117, v11
v_sub_f32 v118, v118, v11
v_sub_f32 v119, v119, v11
v_sub_f32 v124, v124, v11
v_sub_f32 v125, v125, v11
v_sub_f32 v126, v126, v11
v_sub_f32 v127, v127, v11
v_sub_f32 v32, v32, v10
v_sub_f32 v33, v33, v10
v_sub_f32 v34, v34, v10
v_sub_f32 v35, v35, v10
v_sub_f32 v36, v36, v11
v_sub_f32 v37, v37, v11
v_sub_f32 v38, v38, v11
v_sub_f32 v39, v39, v11
E v12,-v10
E v13,-v11
MF v30,v12,v30
MF v31,v13,v31
MF v128,v12,v128
MF v129,v12,v129
MF v130,v12,v130
MF v131,v12,v131
MF v132,v13,v132
MF v133,v13,v133
MF v134,v13,v134
MF v135,v13,v135
MF v136,v12,v136
MF v137,v12,v137
MF v138,v12,v138
MF v139,v12,v139
MF v140,v13,v140
MF v141,v13,v141
MF v142,v13,v142
MF v143,v13,v143
MF v144,v12,v144
MF v145,v12,v145
MF v146,v12,v146
MF v147,v12,v147
MF v148,v13,v148
MF v149,v13,v149
MF v150,v13,v150
MF v151,v13,v151
MF v152,v12,v152
MF v153,v12,v153
MF v154,v12,v154
MF v155,v12,v155
MF v156,v13,v156
MF v157,v13,v157
MF v158,v13,v158
MF v159,v13,v159
MF v160,v12,v160
MF v161,v12,v161
MF v162,v12,v162
MF v163,v12,v163
MF v164,v13,v164
MF v165,v13,v165
MF v166,v13,v166
MF v167,v13,v167
MF v168,v12,v168
MF v169,v12,v169
MF v170,v12,v170
MF v171,v12,v171
MF v172,v13,v172
MF v173,v13,v173
MF v174,v13,v174
MF v175,v13,v175
MF v176,v12,v176
MF v177,v12,v177
MF v178,v12,v178
MF v179,v12,v179
MF v180,v13,v180
MF v181,v13,v181
MF v182,v13,v182
MF v183,v13,v183
MF v184,v12,v184
MF v185,v12,v185
MF v186,v12,v186
MF v187,v12,v187
MF v188,v13,v188
MF v189,v13,v189
MF v190,v13,v190
MF v191,v13,v191
MF v192,v12,v192
MF v193,v12,v193
MF v194,v12,v194
MF v195,v12,v195
MF v196,v13,v196
MF v197,v13,v197
MF v198,v13,v198
MF v199,v13,v199
MF v200,v12,v200
MF v201,v12,v201
MF v202,v12,v202
MF v203,v12,v203
MF v204,v13,v204
MF v205,v13,v205
MF v206,v13,v206
MF v207,v13,v207
MF v208,v12,v208
MF v209,v12,v209
MF v210,v12,v210
MF v211,v12,v211
MF v212,v13,v212
MF v213,v13,v213
MF v214,v13,v214
MF v215,v13,v215
MF v216,v12,v216
MF v217,v12,v217
MF v218,v12,v218
MF v219,v12,v219
MF v220,v13,v220
MF v221,v13,v221
MF v222,v13,v222
MF v223,v13,v223
MF v224,v12,v224
MF v225,v12,v225
MF v226,v12,v226
MF v227,v12,v227
MF v228,v13,v228
MF v229,v13,v229
MF v230,v13,v230
MF v231,v13,v231
MF v232,v12,v232
MF v233,v12,v233
MF v234,v12,v234
MF v235,v12,v235
MF v236,v13,v236
MF v237,v13,v237
MF v238,v13,v238
MF v239,v13,v239
MF v240,v12,v240
MF v241,v12,v241
MF v242,v12,v242
MF v243,v12,v243
MF v244,v13,v244
MF v245,v13,v245
MF v246,v13,v246
MF v247,v13,v247
MF v248,v12,v248
MF v249,v12,v249
MF v250,v12,v250
MF v251,v12,v251
MF v252,v13,v252
MF v253,v13,v253
MF v254,v13,v254
MF v255,v13,v255
E v18,v100
E v19,v101
E v20,v102
AF v29,v18,v19
C v52,v18,v19
E v21,v103
E v22,v108
AF v29,v20,v29
C v53,v20,v21
E v23,v109
AF v29,v21,v29
E v24,v110
AF v29,v22,v29
C v54,v22,v23
E v25,v111
AF v29,v23,v29
E v18,v116
AF v29,v24,v29
C v55,v24,v25
E v19,v117
AF v29,v25,v29
E v20,v118
AF v29,v18,v29
C v48,v18,v19
E v21,v119
AF v29,v19,v29
E v22,v124
AF v29,v20,v29
C v49,v20,v21
E v23,v125
AF v29,v21,v29
E v24,v126
AF v29,v22,v29
C v50,v22,v23
E v25,v127
AF v29,v23,v29
AF v29,v24,v29
C v51,v24,v25
AF v29,v25,v29
v_sub_f32 v10, v32, v14
v_sub_f32 v11, v36, v15
E v10,v10
E v11,v11
s_nop 0
MF v16,v10,v16
MF v17,v11,v17
G v64,a128
v_and_b32 v65, 0xffff0000, v64
v_lshlrev_b32 v64, 16, v64
MF v64,v10,v64
MF v65,v10,v65
C v64,v64,v65
W a128,v64
G v66,a129
v_and_b32 v67, 0xffff0000, v66
v_lshlrev_b32 v66, 16, v66
MF v66,v10,v66
MF v67,v10,v67
C v66,v66,v67
W a129,v66
G v68,a130
v_and_b32 v69, 0xffff0000, v68
v_lshlrev_b32 v68, 16, v68
MF v68,v10,v68
MF v69,v10,v69
C v68,v68,v69
W a130,v68
G v70,a131
v_and_b32 v71, 0xffff0000, v70
v_lshlrev_b32 v70, 16, v70
MF v70,v10,v70
MF v71,v10,v71
C v70,v70,v71
W a131,v70
G v72,a132
v_and_b32 v73, 0xffff0000, v72
v_lshlrev_b32 v72, 16, v72
MF v72,v10,v72
MF v73,v10,v73
C v72,v72,v73
W a132,v72
G v74,a133
v_and_b32 v75, 0xffff0000, v74
v_lshlrev_b32 v74, 16, v74
MF v74,v10,v74
MF v75,v10,v75
C v74,v74,v75
W a133,v74
G v76,a134
v_and_b32 v77, 0xffff0000, v76
v_lshlrev_b32 v76, 16, v76
MF v76,v10,v76
MF v77,v10,v77
C v76,v76,v77
W a134,v76
G v78,a135
v_and_b32 v79, 0xffff0000, v78
v_lshlrev_b32 v78, 16, v78
MF v78,v10,v78
MF v79,v10,v79
C v78,v78,v79
W a135,v78
G v64,a136
v_and_b32 v65, 0xffff0000, v64
v_lshlrev_b32 v64, 16, v64
MF v64,v10,v64
MF v65,v10,v65
C v64,v64,v65
W a136,v64
G v66,a137
v_and_b32 v67, 0xffff0000, v66
v_lshlrev_b32 v66, 16, v66
MF v66,v10,v66
MF v67,v10,v67
C v66,v66,v67
W a137,v66
G v68,a138
v_and_b32 v69, 0xffff0000, v68
v_lshlrev_b32 v68, 16, v68
MF v68,v10,v68
MF v69,v10,v69
C v68,v68,v69
W a138,v68
G v70,a139
v_and_b32 v71, 0xffff0000, v70
v_lshlrev_b32 v70, 16, v70
MF v70,v10,v70
MF v71,v10,v71
C v70,v70,v71
W a139,v70
G v72,a140
v_and_b32 v73, 0xffff0000, v72
v_lshlrev_b32 v72, 16, v72
MF v72,v10,v72
MF v73,v10,v73
C v72,v72,v73
W a140,v72
G v74,a141
v_and_b32 v75, 0xffff0000, v74
v_lshlrev_b32 v74, 16, v74
MF v74,v10,v74
MF v75,v10,v75
C v74,v74,v75
W a141,v74
G v76,a142
v_and_b32 v77, 0xffff0000, v76
v_lshlrev_b32 v76, 16, v76
MF v76,v10,v76
MF v77,v10,v77
C v76,v76,v77
W a142,v76
G v78,a143
v_and_b32 v79, 0xffff0000, v78
v_lshlrev_b32 v78, 16, v78
MF v78,v10,v78
MF v79,v10,v79
C v78,v78,v79
W a143,v78
G v64,a144
v_and_b32 v65, 0xffff0000, v64
v_lshlrev_b32 v64, 16, v64
MF v64,v10,v64
MF v65,v10,v65
C v64,v64,v65
W a144,v64
G v66,a145
v_and_b32 v67, 0xffff0000, v66
v_lshlrev_b32 v66, 16, v66
MF v66,v10,v66
MF v67,v10,v67
C v66,v66,v67
W a145,v66
G v68,a146
v_and_b32 v69, 0xffff0000, v68
v_lshlrev_b32 v68, 16, v68
MF v68,v10,v68
MF v69,v10,v69
C v68,v68,v69
W a146,v68
G v70,a147
v_and_b32 v71, 0xffff0000, v70
v_lshlrev_b32 v70, 16, v70
MF v70,v10,v70
MF v71,v10,v71
C v70,v70,v71
W a147,v70
G v72,a148
v_and_b32 v73, 0xffff0000, v72
v_lshlrev_b32 v72, 16, v72
MF v72,v10,v72
MF v73,v10,v73
C v72,v72,v73
W a148,v72
G v74,a149
v_and_b32 v75, 0xffff0000, v74
v_lshlrev_b32 v74, 16, v74
MF v74,v10,v74
MF v75,v10,v75
C v74,v74,v75
W a149,v74
G v76,a150
v_and_b32 v77, 0xffff0000, v76
v_lshlrev_b32 v76, 16, v76
MF v76,v10,v76
MF v77,v10,v77
C v76,v76,v77
W a150,v76
G v78,a151
v_and_b32 v79, 0xffff0000, v78
v_lshlrev_b32 v78, 16, v78
MF v78,v10,v78
MF v79,v10,v79
C v78,v78,v79
W a151,v78
G v64,a152
v_and_b32 v65, 0xffff0000, v64
v_lshlrev_b32 v64, 16, v64
MF v64,v10,v64
MF v65,v10,v65
C v64,v64,v65
W a152,v64
G v66,a153
v_and_b32 v67, 0xffff0000, v66
v_lshlrev_b32 v66, 16, v66
MF v66,v10,v66
MF v67,v10,v67
C v66,v66,v67
W a153,v66
G v68,a154
v_and_b32 v69, 0xffff0000, v68
v_lshlrev_b32 v68, 16, v68
MF v68,v10,v68
MF v69,v10,v69
C v68,v68,v69
W a154,v68
G v70,a155
v_and_b32 v71, 0xffff0000, v70
v_lshlrev_b32 v70, 16, v70
MF v70,v10,v70
MF v71,v10,v71
C v70,v70,v71
W a155,v70
G v72,a156
v_and_b32 v73, 0xffff0000, v72
v_lshlrev_b32 v72, 16, v72
MF v72,v10,v72
MF v73,v10,v73
C v72,v72,v73
W a156,v72
G v74,a157
v_and_b32 v75, 0xffff0000, v74
v_lshlrev_b32 v74, 16, v74
MF v74,v10,v74
MF v75,v10,v75
C v74,v74,v75
W a157,v74
G v76,a158
v_and_b32 v77, 0xffff0000, v76
v_lshlrev_b32 v76, 16, v76
MF v76,v10,v76
MF v77,v10,v77
C v76,v76,v77
W a158,v76
G v78,a159
v_and_b32 v79, 0xffff0000, v78
v_lshlrev_b32 v78, 16, v78
MF v78,v10,v78
MF v79,v10,v79
C v78,v78,v79
W a159,v78
G v64,a160
v_and_b32 v65, 0xffff0000, v64
v_lshlrev_b32 v64, 16, v64
MF v64,v11,v64
MF v65,v11,v65
C v64,v64,v65
W a160,v64
G v66,a161
v_and_b32 v67, 0xffff0000, v66
v_lshlrev_b32 v66, 16, v66
MF v66,v11,v66
MF v67,v11,v67
C v66,v66,v67
W a161,v66
G v68,a162
v_and_b32 v69, 0xffff0000, v68
v_lshlrev_b32 v68, 16, v68
MF v68,v11,v68
MF v69,v11,v69
C v68,v68,v69
W a162,v68
G v70,a163
v_and_b32 v71, 0xffff0000, v70
v_lshlrev_b32 v70, 16, v70
MF v70,v11,v70
MF v71,v11,v71
C v70,v70,v71
W a163,v70
G v72,a164
v_and_b32 v73, 0xffff0000, v72
v_lshlrev_b32 v72, 16, v72
MF v72,v11,v72
MF v73,v11,v73
C v72,v72,v73
W a164,v72
G v74,a165
v_and_b32 v75, 0xffff0000, v74
v_lshlrev_b32 v74, 16, v74
MF v74,v11,v74
MF v75,v11,v75
C v74,v74,v75
W a165,v74
G v76,a166
v_and_b32 v77, 0xffff0000, v76
v_lshlrev_b32 v76, 16, v76
MF v76,v11,v76
MF v77,v11,v77
C v76,v76,v77
W a166,v76
G v78,a167
v_and_b32 v79, 0xffff0000, v78
v_lshlrev_b32 v78, 16, v78
MF v78,v11,v78
MF v79,v11,v79
C v78,v78,v79
W a167,v78
G v64,a168
v_and_b32 v65, 0xffff0000, v64
v_lshlrev_b32 v64, 16, v64
MF v64,v11,v64
MF v65,v11,v65
C v64,v64,v65
W a168,v64
G v66,a169
v_and_b32 v67, 0xffff0000, v66
v_lshlrev_b32 v66, 16, v66
MF v66,v11,v66
MF v67,v11,v67
C v66,v66,v67
W a169,v66
G v68,a170
v_and_b32 v69, 0xffff0000, v68
v_lshlrev_b32 v68, 16, v68
MF v68,v11,v68
MF v69,v11,v69
C v68,v68,v69
W a170,v68
G v70,a171
v_and_b32 v71, 0xffff0000, v70
v_lshlrev_b32 v70, 16, v70
MF v70,v11,v70
MF v71,v11,v71
C v70,v70,v71
W a171,v70
G v72,a172
v_and_b32 v73, 0xffff0000, v72
v_lshlrev_b32 v72, 16, v72
MF v72,v11,v72
MF v73,v11,v73
C v72,v72,v73
W a172,v72
G v74,a173
v_and_b32 v75, 0xffff0000, v74
v_lshlrev_b32 v74, 16, v74
MF v74,v11,v74
MF v75,v11,v75
C v74,v74,v75
W a173,v74
G v76,a174
v_and_b32 v77, 0xffff0000, v76
v_lshlrev_b32 v76, 16, v76
MF v76,v11,v76
MF v77,v11,v77
C v76,v76,v77
W a174,v76
G v78,a175
v_and_b32 v79, 0xffff0000, v78
v_lshlrev_b32 v78, 16, v78
MF v78,v11,v78
MF v79,v11,v79
C v78,v78,v79
W a175,v78
G v64,a176
v_and_b32 v65, 0xffff0000, v64
v_lshlrev_b32 v64, 16, v64
MF v64,v11,v64
MF v65,v11,v65
C v64,v64,v65
W a176,v64
G v66,a177
v_and_b32 v67, 0xffff0000, v66
v_lshlrev_b32 v66, 16, v66
MF v66,v11,v66
MF v67,v11,v67
C v66,v66,v67
W a177,v66
G v68,a178
v_and_b32 v69, 0xffff0000, v68
v_lshlrev_b32 v68, 16, v68
MF v68,v11,v68
MF v69,v11,v69
C v68,v68,v69
W a178,v68
G v70,a179
v_and_b32 v71, 0xffff0000, v70
v_lshlrev_b32 v70, 16, v70
MF v70,v11,v70
MF v71,v11,v71
C v70,v70,v71
W a179,v70
G v72,a180
v_and_b32 v73, 0xffff0000, v72
v_lshlrev_b32 v72, 16, v72
MF v72,v11,v72
MF v73,v11,v73
C v72,v72,v73
W a180,v72
G v74,a181
v_and_b32 v75, 0xffff0000, v74
v_lshlrev_b32 v74, 16, v74
MF v74,v11,v74
MF v75,v11,v75
C v74,v74,v75
W a181,v74
G v76,a182
v_and_b32 v77, 0xffff0000, v76
v_lshlrev_b32 v76, 16, v76
MF v76,v11,v76
MF v77,v11,v77
C v76,v76,v77
W a182,v76
G v78,a183
v_and_b32 v79, 0xffff0000, v78
v_lshlrev_b32 v78, 16, v78
MF v78,v11,v78
MF v79,v11,v79
C v78,v78,v79
W a183,v78
G v64,a184
v_and_b32 v65, 0xffff0000, v64
v_lshlrev_b32 v64, 16, v64
MF v64,v11,v64
MF v65,v11,v65
C v64,v64,v65
W a184,v64
G v66,a185
v_and_b32 v67, 0xffff0000, v66
v_lshlrev_b32 v66, 16, v66
MF v66,v11,v66
MF v67,v11,v67
C v66,v66,v67
W a185,v66
G v68,a186
v_and_b32 v69, 0xffff0000, v68
v_lshlrev_b32 v68, 16, v68
MF v68,v11,v68
MF v69,v11,v69
C v68,v68,v69
W a186,v68
G v70,a187
v_and_b32 v71, 0xffff0000, v70
v_lshlrev_b32 v70, 16, v70
MF v70,v11,v70
MF v71,v11,v71
C v70,v70,v71
W a187,v70
G v72,a188
v_and_b32 v73, 0xffff0000, v72
v_lshlrev_b32 v72, 16, v72
MF v72,v11,v72
MF v73,v11,v73
C v72,v72,v73
W a188,v72
G v74,a189
v_and_b32 v75, 0xffff0000, v74
v_lshlrev_b32 v74, 16, v74
MF v74,v11,v74
MF v75,v11,v75
C v74,v74,v75
W a189,v74
G v76,a190
v_and_b32 v77, 0xffff0000, v76
v_lshlrev_b32 v76, 16, v76
MF v76,v11,v76
MF v77,v11,v77
C v76,v76,v77
W a190,v76
G v78,a191
v_and_b32 v79, 0xffff0000, v78
v_lshlrev_b32 v78, 16, v78
MF v78,v11,v78
MF v79,v11,v79
C v78,v78,v79
W a191,v78
s_nop 3
s_setpc_b64 s[36:37]
L_zs0:
s_mov_b32 s64, 65536
L_zs0_l:
s_sleep 2
buffer_load_dword v17, v16, s[12:15], 0 offen sc1
s_sub_u32 s64, s64, 1
s_cbranch_scc1 L_zs0_x
s_waitcnt vmcnt(0)
v_cmp_ne_u32 vcc, 1, v17
s_nop 0
s_cbranch_vccnz L_zs0_l
L_zs0_x:
s_waitcnt vmcnt(0)
s_branch L_zr0
L_zs1:
s_mov_b32 s64, 65536
L_zs1_l:
s_sleep 2
buffer_load_dword v17, v16, s[12:15], 0 offen sc1
s_sub_u32 s64, s64, 1
s_cbranch_scc1 L_zs1_x
s_waitcnt vmcnt(0)
v_cmp_ne_u32 vcc, 1, v17
s_nop 0
s_cbranch_vccnz L_zs1_l
L_zs1_x:
s_waitcnt vmcnt(0)
s_branch L_zr1
L_hs:
s_mov_b32 s91, 65536
L_hs_l:
buffer_load_dwordx4 v[16:19], v7, s[8:11], s67 offen offset:0 sc1
buffer_load_dwordx4 v[20:23], v7, s[8:11], s67 offen offset:1024 sc1
s_waitcnt vmcnt(0)
s_sub_u32 s91, s91, 1
s_cbranch_scc1 L_hr
v_min3_u32 v28, v16, v17, v18
v_min3_u32 v28, v28, v19, v20
v_min3_u32 v28, v28, v21, v22
v_min_u32 v28, v28, v23
v_cmp_eq_u32 vcc, 0, v28
s_nop 0
s_cbranch_vccnz L_hs_l
s_branch L_hr
L_lsj0:
s_mov_b32 s91, 65536
L_lsj0_l:
s_sleep 2
buffer_load_dword v5, v17, s[8:11], s46 offen sc1
s_sub_u32 s91, s91, 1
s_cbranch_scc1 L_lsj0_x
s_waitcnt vmcnt(0)
v_cmp_gt_u32 vcc, 2, v5
s_nop 0
s_cbranch_vccnz L_lsj0_l
L_lsj0_x:
s_waitcnt vmcnt(0)
s_branch L_lrj0
L_lsh2:
s_mov_b32 s91, 65536
L_lsh2_l:
s_sleep 2
buffer_load_dword v5, v17, s[8:11], s46 offen sc1
s_sub_u32 s91, s91, 1
s_cbranch_scc1 L_lsh2_x
s_waitcnt vmcnt(0)
v_cmp_gt_u32 vcc, 2, v5
s_nop 0
s_cbranch_vccnz L_lsh2_l
L_lsh2_x:
s_waitcnt vmcnt(0)
s_branch L_lrh2
L_lsh4:
s_mov_b32 s91, 65536
L_lsh4_l:
s_sleep 2
buffer_load_dword v5, v9, s[8:11], s46 offen sc1
s_sub_u32 s91, s91, 1
s_cbranch_scc1 L_lsh4_x
s_waitcnt vmcnt(0)
v_cmp_gt_u32 vcc, s84, v5
s_nop 0
s_cbranch_vccnz L_lsh4_l
L_lsh4_x:
s_waitcnt vmcnt(0)
s_branch L_lrh4
L_wsq0:
s_mov_b32 s91, 65536
L_wsq0_l:
s_sleep 2
buffer_load_dword v5, v31, s[8:11], s46 offen offset:4 sc1
s_sub_u32 s91, s91, 1
s_cbranch_scc1 L_wsq0_x
s_waitcnt vmcnt(0)
v_cmp_ne_u32 vcc, 1, v5
s_nop 0
s_mov_b32 vcc_hi, 0
s_cbranch_vccnz L_wsq0_l
L_wsq0_x:
s_waitcnt vmcnt(0)
s_branch L_wrq0
L_wsr0:
s_mov_b32 s91, 65536
L_wsr0_l:
s_sleep 2
buffer_load_dword v5, v31, s[8:11], s46 offen offset:4 sc1
s_sub_u32 s91, s91, 1
s_cbranch_scc1 L_wsr0_x
s_waitcnt vmcnt(0)
v_cmp_ne_u32 vcc, 1, v5
s_nop 0
s_mov_b32 vcc_lo, 0
s_cbranch_vccnz L_wsr0_l
L_wsr0_x:
s_waitcnt vmcnt(0)
s_branch L_wrr0
L_wsq1:
s_mov_b32 s91, 65536
L_wsq1_l:
s_sleep 2
buffer_load_dword v5, v31, s[8:11], s46 offen offset:4 sc1
s_sub_u32 s91, s91, 1
s_cbranch_scc1 L_wsq1_x
s_waitcnt vmcnt(0)
v_cmp_ne_u32 vcc, 1, v5
s_nop 0
s_mov_b32 vcc_hi, 0
s_cbranch_vccnz L_wsq1_l
L_wsq1_x:
s_waitcnt vmcnt(0)
s_branch L_wrq1
L_wsr1:
s_mov_b32 s91, 65536
L_wsr1_l:
s_sleep 2
buffer_load_dword v5, v31, s[8:11], s46 offen offset:4 sc1
s_sub_u32 s91, s91, 1
s_cbranch_scc1 L_wsr1_x
s_waitcnt vmcnt(0)
v_cmp_ne_u32 vcc, 1, v5
s_nop 0
s_mov_b32 vcc_lo, 0
s_cbranch_vccnz L_wsr1_l
L_wsr1_x:
s_waitcnt vmcnt(0)
s_branch L_wrr1
L_fll:
s_sub_u32 s65, s7, s40
s_mov_b32 s64, -1
s_cmp_eq_u32 s65, 1
s_cbranch_scc1 L_fl2
s_cmp_lg_u32 s20, 0
s_cbranch_scc1 L_fl3
s_lshr_b32 s64, s42, 3
s_cmp_eq_u32 s7, s64
s_cbranch_scc0 L_fl1
v_mov_b32 v15, 4
buffer_store_dword v15, v1, s[8:11], s45 offen sc1
L_fl1:
s_cmp_lg_u32 s65, 0
s_cbranch_scc1 L_fllr
s_movk_i32 s64, 0x380
L_fl2:
v_min_u32 v17, s64, v9
s_mov_b32 s6, 4
buffer_load_dword v5, v17, s[8:11], s46 offen sc1
s_bitcmp1_b32 s39, 15
s_cbranch_scc0 L_fllr
L_fl3:
s_cmp_eq_u32 s7, 1
s_cbranch_scc1 L_y2
s_cmp_eq_u32 s7, 2
s_cbranch_scc1 L_y3
s_cmp_eq_u32 s7, 3
s_cbranch_scc1 L_y4
s_branch L_y5
s_waitcnt vmcnt(0)
L_fps:
s_cmp_lg_u32 s35, 0
s_cbranch_scc1 L_fpr
L_fps2:
s_mov_b32 s91, 65536
L_fps2_l:
s_sleep 2
buffer_load_dword v6, off, s[8:11], s47 sc1
s_sub_u32 s91, s91, 1
s_cbranch_scc1 L_fps2_x
s_waitcnt vmcnt(0)
v_cmp_ne_u32 vcc, 1, v6
s_nop 0
s_cbranch_vccnz L_fps2_l
L_fps2_x:
s_waitcnt vmcnt(0)
s_branch L_fpr
L_fqs:
s_mov_b32 s91, 65536
L_fqs_l:
s_sleep 2
buffer_load_dword v6, off, s[8:11], s47 offset:16 sc1
s_sub_u32 s91, s91, 1
s_cbranch_scc1 L_fqs_x
s_waitcnt vmcnt(0)
v_cmp_ne_u32 vcc, 1, v6
s_nop 0
s_cbranch_vccnz L_fqs_l
L_fqs_x:
s_waitcnt vmcnt(0)
s_branch L_fqr
L_fls0:
s_mov_b32 s91, 65536
L_fls0_l:
s_sleep 2
buffer_load_dword v5, v17, s[8:11], s46 offen sc1
s_sub_u32 s91, s91, 1
s_cbranch_scc1 L_fls0_x
s_waitcnt vmcnt(0)
v_cmp_gt_u32 vcc, s6, v5
s_nop 0
s_cbranch_vccnz L_fls0_l
L_fls0_x:
s_waitcnt vmcnt(0)
s_branch L_flr0
L_y2:
v_lshrrev_b32 v11, 7, v7
v_mul_u32_u24 v11, 4352, v11
v_and_b32 v12, 0x70, v7
v_lshl_add_u32 v11, v12, 3, v11
s_mov_b32 s64, 104923136
s_mov_b32 s65, 104957952
buffer_load_dword a128, v11, s[8:11], s64 offen sc1
buffer_load_dword a129, v11, s[8:11], s65 offen sc1
s_branch L_fllr
s_waitcnt vmcnt(0)
L_y3:
s_mov_b32 s91, 65536
L_y3c:
G v12,a128
G v13,a129
v_min_u32 v12, v12, v13
v_cmp_gt_u32 vcc, 2, v12
s_sub_u32 s91, s91, 1
s_cbranch_scc1 L_y3x
s_cbranch_vccz L_y3x
v_lshrrev_b32 v11, 7, v7
v_mul_u32_u24 v11, 4352, v11
v_and_b32 v12, 0x70, v7
v_lshl_add_u32 v11, v12, 3, v11
s_mov_b32 s64, 104923136
s_mov_b32 s65, 104957952
buffer_load_dword a128, v11, s[8:11], s64 offen sc1
buffer_load_dword a129, v11, s[8:11], s65 offen sc1
s_waitcnt vmcnt(0)
s_branch L_y3c
L_y3x:
s_lshl_b32 s66, s41, 1
SA s66,s66,s20
s_sub_u32 s66, s66, 2
s_cmp_lt_u32 s66, 14
s_cselect_b32 s64, 8, 12
SA s64,s64,104890368
buffer_load_dword a130, off, s[8:11], s64 sc1
v_lshrrev_b32 v11, 7, v7
v_mul_u32_u24 v11, 3584, v11
v_and_b32 v12, 0x70, v7
v_add_u32 v11, v12, v11
s_lshl_b32 s65, s66, 7
SA s65,s65,105906176
buffer_load_dwordx4 a[132:135], v11, s[8:11], s65 offen sc1
SA s65,s65,28672
buffer_load_dwordx4 a[136:139], v11, s[8:11], s65 offen sc1
SA s65,s65,28672
buffer_load_dwordx4 a[140:143], v11, s[8:11], s65 offen sc1
SA s65,s65,28672
buffer_load_dwordx4 a[144:147], v11, s[8:11], s65 offen sc1
SA s65,s65,28672
buffer_load_dwordx4 a[148:151], v11, s[8:11], s65 offen sc1
SA s65,s65,28672
buffer_load_dwordx4 a[152:155], v11, s[8:11], s65 offen sc1
SA s65,s65,28672
buffer_load_dwordx4 a[156:159], v11, s[8:11], s65 offen sc1
SA s65,s65,28672
buffer_load_dwordx4 a[160:163], v11, s[8:11], s65 offen sc1
SA s65,s65,28672
buffer_load_dwordx4 a[164:167], v11, s[8:11], s65 offen sc1
SA s65,s65,28672
buffer_load_dwordx4 a[168:171], v11, s[8:11], s65 offen sc1
SA s65,s65,28672
buffer_load_dwordx4 a[172:175], v11, s[8:11], s65 offen sc1
SA s65,s65,28672
buffer_load_dwordx4 a[176:179], v11, s[8:11], s65 offen sc1
SA s65,s65,28672
buffer_load_dwordx4 a[180:183], v11, s[8:11], s65 offen sc1
SA s65,s65,28672
buffer_load_dwordx4 a[184:187], v11, s[8:11], s65 offen sc1
SA s65,s65,28672
s_branch L_fllr
s_waitcnt vmcnt(0)
L_y4:
G v12,a132
G v13,a133
G v14,a134
G v15,a135
G v16,a136
G v17,a137
AF v12,v16,v12
AF v13,v17,v13
G v16,a138
G v17,a139
AF v14,v16,v14
AF v15,v17,v15
G v16,a140
G v17,a141
AF v12,v16,v12
AF v13,v17,v13
G v16,a142
G v17,a143
AF v14,v16,v14
AF v15,v17,v15
G v16,a144
G v17,a145
AF v12,v16,v12
AF v13,v17,v13
G v16,a146
G v17,a147
AF v14,v16,v14
AF v15,v17,v15
G v16,a148
G v17,a149
AF v12,v16,v12
AF v13,v17,v13
G v16,a150
G v17,a151
AF v14,v16,v14
AF v15,v17,v15
G v16,a152
G v17,a153
AF v12,v16,v12
AF v13,v17,v13
G v16,a154
G v17,a155
AF v14,v16,v14
AF v15,v17,v15
G v16,a156
G v17,a157
AF v12,v16,v12
AF v13,v17,v13
G v16,a158
G v17,a159
AF v14,v16,v14
AF v15,v17,v15
G v16,a160
G v17,a161
AF v12,v16,v12
AF v13,v17,v13
G v16,a162
G v17,a163
AF v14,v16,v14
AF v15,v17,v15
G v16,a164
G v17,a165
AF v12,v16,v12
AF v13,v17,v13
G v16,a166
G v17,a167
AF v14,v16,v14
AF v15,v17,v15
G v16,a168
G v17,a169
AF v12,v16,v12
AF v13,v17,v13
G v16,a170
G v17,a171
AF v14,v16,v14
AF v15,v17,v15
G v16,a172
G v17,a173
AF v12,v16,v12
AF v13,v17,v13
G v16,a174
G v17,a175
AF v14,v16,v14
AF v15,v17,v15
G v16,a176
G v17,a177
AF v12,v16,v12
AF v13,v17,v13
G v16,a178
G v17,a179
AF v14,v16,v14
AF v15,v17,v15
G v16,a180
G v17,a181
AF v12,v16,v12
AF v13,v17,v13
G v16,a182
G v17,a183
AF v14,v16,v14
AF v15,v17,v15
G v16,a184
G v17,a185
AF v12,v16,v12
AF v13,v17,v13
G v16,a186
G v17,a187
AF v14,v16,v14
AF v15,v17,v15
v_add_f32 v12, v12, v12 row_ror:8 row_mask:0xf bank_mask:0xf
v_add_f32 v13, v13, v13 row_ror:8 row_mask:0xf bank_mask:0xf
v_add_f32 v14, v14, v14 row_ror:8 row_mask:0xf bank_mask:0xf
v_add_f32 v15, v15, v15 row_ror:8 row_mask:0xf bank_mask:0xf
v_mov_b32 v11, v12
s_nop 1
v_permlane16_swap_b32 v11, v12
AF v12,v11,v12
v_mov_b32 v11, v13
s_nop 1
v_permlane16_swap_b32 v11, v13
AF v13,v11,v13
v_mov_b32 v11, v14
s_nop 1
v_permlane16_swap_b32 v11, v14
AF v14,v11,v14
v_mov_b32 v11, v15
s_nop 1
v_permlane16_swap_b32 v11, v15
AF v15,v11,v15
v_mov_b32 v11, v12
s_nop 1
v_permlane32_swap_b32 v11, v12
AF v12,v11,v12
v_mov_b32 v11, v13
s_nop 1
v_permlane32_swap_b32 v11, v13
AF v13,v11,v13
v_mov_b32 v11, v14
s_nop 1
v_permlane32_swap_b32 v11, v14
AF v14,v11,v14
v_mov_b32 v11, v15
s_nop 1
v_permlane32_swap_b32 v11, v15
AF v15,v11,v15
G v16,a130
C v11,v12,v13
v_lshlrev_b32 v12, 16, v11
v_and_b32 v13, 0xffff0000, v11
C v11,v14,v15
v_lshlrev_b32 v14, 16, v11
v_and_b32 v15, 0xffff0000, v11
MF v12,v16,v12
MF v13,v16,v13
MF v14,v16,v14
MF v15,v16,v15
C v11,v12,v13
v_lshlrev_b32 v12, 16, v11
v_and_b32 v13, 0xffff0000, v11
C v11,v14,v15
v_lshlrev_b32 v14, 16, v11
v_and_b32 v15, 0xffff0000, v11
s_lshl_b32 s66, s41, 1
SA s66,s66,s20
s_sub_u32 s66, s66, 2
s_lshl_b32 s65, s66, 7
SA s65,s65,104898560
s_mov_b64 exec, 0xff
buffer_store_dwordx4 v[12:15], v7, s[8:11], s65 offen sc1
s_mov_b64 exec, -1
s_nop 1
s_branch L_fllr
L_y5:
s_lshl_b32 s66, s41, 1
SA s66,s66,s20
s_sub_u32 s66, s66, 2
s_lshl_b32 s66, s66, 2
SA s66,s66,105062912
v_mov_b32 v11, 1
s_mov_b64 exec, 1
buffer_store_dword v11, off, s[8:11], s66 sc1
s_mov_b64 exec, -1
s_branch L_fllr
.p2align 12
L_loop_top:
M v[64:67],a[64:67],a[0:3],v[32:35]
SA m0,s28,0
R a[96:99],v2,40960
M v[64:67],a[68:71],a[4:7],v[64:67]
buffer_load_dword a240, v0, s[60:63], 0 offen offset:0
M v[64:67],a[72:75],a[8:11],v[64:67]
R a[100:103],v2,41984
M v[64:67],a[76:79],a[12:15],v[64:67]
s_waitcnt lgkmcnt(2)
buffer_load_dwordx4 v3, s[8:11], s26 offen offset:0 sc1 lds
M v[64:67],a[80:83],a[16:19],v[64:67]
R a[104:107],v2,43008
M v[64:67],a[84:87],a[20:23],v[64:67]
E v18,v112
M v[64:67],a[88:91],a[24:27],v[64:67]
R a[108:111],v2,44032
M v[64:67],a[92:95],a[28:31],v[64:67]
buffer_load_dwordx4 v3, s[8:11], s26 offen offset:1024 sc1 lds
M v[68:71],a[92:95],a[60:63],v[36:39]
R a[112:115],v2,45056
M v[68:71],a[88:91],a[56:59],v[68:71]
E v19,v113
M v[68:71],a[84:87],a[52:55],v[68:71]
R a[116:119],v2,46080
AF v28,v18,v28
M v[68:71],a[80:83],a[48:51],v[68:71]
E v20,v114
M v[68:71],a[76:79],a[44:47],v[68:71]
R a[120:123],v2,47104
C v56,v18,v19
M v[68:71],a[72:75],a[40:43],v[68:71]
buffer_load_dwordx4 v3, s[8:11], s26 offen offset:2048 sc1 lds
M v[68:71],a[68:71],a[36:39],v[68:71]
R a[124:127],v2,48128
AF v28,v19,v28
M v[68:71],a[64:67],a[32:35],v[68:71]
s_waitcnt lgkmcnt(4)
E v21,v115
M v[76:79],a[96:99],a[32:35],v[36:39]
R a[64:67],v2,49152
AF v28,v20,v28
M v[76:79],a[100:103],a[36:39],v[76:79]
buffer_load_dwordx4 v3, s[8:11], s26 offen offset:3072 sc1 lds
M v[76:79],a[104:107],a[40:43],v[76:79]
R a[68:71],v2,50176
C v57,v20,v21
M v[76:79],a[108:111],a[44:47],v[76:79]
s_waitcnt lgkmcnt(2)
E v22,v120
M v[76:79],a[112:115],a[48:51],v[76:79]
R a[72:75],v2,51200
AF v28,v21,v28
M v[76:79],a[116:119],a[52:55],v[76:79]
E v23,v121
M v[76:79],a[120:123],a[56:59],v[76:79]
SA m0,s28,4096
R a[76:79],v2,52224
AF v28,v22,v28
M v[76:79],a[124:127],a[60:63],v[76:79]
buffer_load_dwordx4 v4, s[8:11], s26 offen offset:0 sc1 lds
M v[72:75],a[124:127],a[28:31],v[32:35]
R a[80:83],v2,53248
C v58,v22,v23
M v[72:75],a[120:123],a[24:27],v[72:75]
E v24,v122
M v[72:75],a[116:119],a[20:23],v[72:75]
R a[84:87],v2,54272
AF v28,v23,v28
M v[72:75],a[112:115],a[16:19],v[72:75]
E v25,v123
M v[72:75],a[108:111],a[12:15],v[72:75]
R a[88:91],v2,55296
AF v28,v24,v28
M v[72:75],a[104:107],a[8:11],v[72:75]
buffer_load_dwordx4 v4, s[8:11], s26 offen offset:1024 sc1 lds
M v[72:75],a[100:103],a[4:7],v[72:75]
R a[92:95],v2,56320
C v59,v24,v25
M v[72:75],a[96:99],a[0:3],v[72:75]
s_waitcnt lgkmcnt(4)
E v18,v116
M v[80:83],a[64:67],a[0:3],v[32:35]
R a[96:99],v2,57344
AF v28,v25,v28
M v[80:83],a[68:71],a[4:7],v[80:83]
R a[100:103],v2,58368
M v[80:83],a[72:75],a[8:11],v[80:83]
buffer_load_dwordx4 v4, s[8:11], s26 offen offset:2048 sc1 lds
M v[80:83],a[76:79],a[12:15],v[80:83]
s_waitcnt lgkmcnt(2)
R a[104:107],v2,59392
M v[80:83],a[80:83],a[16:19],v[80:83]
R a[108:111],v2,60416
M v[80:83],a[84:87],a[20:23],v[80:83]
E v19,v117
M v[80:83],a[88:91],a[24:27],v[80:83]
R a[112:115],v2,61440
AF v29,v18,v29
M v[80:83],a[92:95],a[28:31],v[80:83]
R a[116:119],v2,62464
C v60,v18,v19
M v[84:87],a[92:95],a[60:63],v[36:39]
buffer_load_dwordx4 v4, s[8:11], s26 offen offset:3072 sc1 lds
M v[84:87],a[88:91],a[56:59],v[84:87]
SA s26,s26,32768
R a[120:123],v2,63488
AF v29,v19,v29
M v[84:87],a[84:87],a[52:55],v[84:87]
R a[124:127],v2,64512
M v[84:87],a[80:83],a[48:51],v[84:87]
E v20,v118
M v[84:87],a[76:79],a[44:47],v[84:87]
E v21,v119
M v[84:87],a[72:75],a[40:43],v[84:87]
E v22,v124
M v[84:87],a[68:71],a[36:39],v[84:87]
s_waitcnt vmcnt(17) lgkmcnt(0)
E v23,v125
M v[84:87],a[64:67],a[32:35],v[84:87]
s_barrier
M v[92:95],a[96:99],a[32:35],v[36:39]
R a[64:67],v7,32768
AF v29,v20,v29
M v[92:95],a[100:103],a[36:39],v[92:95]
E v24,v126
M v[92:95],a[104:107],a[40:43],v[92:95]
R a[68:71],v7,33792
C v61,v20,v21
M v[92:95],a[108:111],a[44:47],v[92:95]
AF v29,v21,v29
AF v29,v22,v29
M v[92:95],a[112:115],a[48:51],v[92:95]
R a[72:75],v7,34816
C v62,v22,v23
M v[92:95],a[116:119],a[52:55],v[92:95]
E v25,v127
M v[92:95],a[120:123],a[56:59],v[92:95]
R a[76:79],v7,35840
AF v29,v23,v29
M v[92:95],a[124:127],a[60:63],v[92:95]
AF v29,v24,v29
C v63,v24,v25
M v[88:91],a[124:127],a[28:31],v[32:35]
R a[80:83],v7,36864
AF v29,v25,v29
M v[88:91],a[120:123],a[24:27],v[88:91]
M v[88:91],a[116:119],a[20:23],v[88:91]
R a[84:87],v7,37888
v_max_f32 v10, v28, v29
M v[88:91],a[112:115],a[16:19],v[88:91]
v_cmp_lt_f32 vcc, s31, v10
M v[88:91],a[108:111],a[12:15],v[88:91]
R a[88:91],v7,38912
M v[88:91],a[104:107],a[8:11],v[88:91]
M v[88:91],a[100:103],a[4:7],v[88:91]
s_waitcnt lgkmcnt(3)
R a[92:95],v7,39936
M v[88:91],a[96:99],a[0:3],v[88:91]
s_cbranch_vccnz L_st1
L_rt1:
M v[128:131],a[64:67],v[48:51],v[128:131]
SA m0,s28,98304
R a[96:99],v7,40960
AF v30,v28,v30
M v[128:131],a[68:71],v[56:59],v[128:131]
buffer_load_dwordx4 v3, s[8:11], s21 offen offset:0 sc1 lds
M v[132:135],a[68:71],v[60:63],v[132:135]
R a[100:103],v7,41984
AF v31,v29,v31
M v[132:135],a[64:67],v[52:55],v[132:135]
s_waitcnt lgkmcnt(2)
E v18,v64
M v[140:143],a[72:75],v[52:55],v[140:143]
R a[104:107],v7,43008
M v[140:143],a[76:79],v[60:63],v[140:143]
buffer_load_dwordx4 v3, s[8:11], s21 offen offset:1024 sc1 lds
M v[136:139],a[76:79],v[56:59],v[136:139]
R a[108:111],v7,44032
M v[136:139],a[72:75],v[48:51],v[136:139]
E v19,v65
M v[144:147],a[80:83],v[48:51],v[144:147]
R a[112:115],v7,45056
AF v26,v18,v19
M v[144:147],a[84:87],v[56:59],v[144:147]
E v20,v66
M v[148:151],a[84:87],v[60:63],v[148:151]
R a[116:119],v7,46080
C v40,v18,v19
M v[148:151],a[80:83],v[52:55],v[148:151]
buffer_load_dwordx4 v3, s[8:11], s21 offen offset:2048 sc1 lds
M v[156:159],a[88:91],v[52:55],v[156:159]
R a[120:123],v7,47104
M v[156:159],a[92:95],v[60:63],v[156:159]
E v21,v67
M v[152:155],a[92:95],v[56:59],v[152:155]
R a[124:127],v7,48128
AF v26,v20,v26
M v[152:155],a[88:91],v[48:51],v[152:155]
s_waitcnt lgkmcnt(4)
buffer_load_dwordx4 v3, s[8:11], s21 offen offset:3072 sc1 lds
M v[160:163],a[96:99],v[48:51],v[160:163]
R a[64:67],v7,49152
C v41,v20,v21
M v[160:163],a[100:103],v[56:59],v[160:163]
E v22,v72
M v[164:167],a[100:103],v[60:63],v[164:167]
SA m0,s28,102400
R a[68:71],v7,50176
AF v26,v21,v26
M v[164:167],a[96:99],v[52:55],v[164:167]
s_waitcnt lgkmcnt(2)
buffer_load_dwordx4 v4, s[8:11], s21 offen offset:0 sc1 lds
M v[172:175],a[104:107],v[52:55],v[172:175]
R a[72:75],v7,51200
M v[172:175],a[108:111],v[60:63],v[172:175]
E v23,v73
M v[168:171],a[108:111],v[56:59],v[168:171]
R a[76:79],v7,52224
AF v26,v22,v26
M v[168:171],a[104:107],v[48:51],v[168:171]
E v24,v74
M v[176:179],a[112:115],v[48:51],v[176:179]
R a[80:83],v7,53248
C v42,v22,v23
M v[176:179],a[116:119],v[56:59],v[176:179]
buffer_load_dwordx4 v4, s[8:11], s21 offen offset:1024 sc1 lds
M v[180:183],a[116:119],v[60:63],v[180:183]
R a[84:87],v7,54272
AF v26,v23,v26
M v[180:183],a[112:115],v[52:55],v[180:183]
E v25,v75
M v[188:191],a[120:123],v[52:55],v[188:191]
R a[88:91],v7,55296
AF v26,v24,v26
M v[188:191],a[124:127],v[60:63],v[188:191]
buffer_load_dwordx4 v4, s[8:11], s21 offen offset:2048 sc1 lds
M v[184:187],a[124:127],v[56:59],v[184:187]
R a[92:95],v7,56320
C v43,v24,v25
M v[184:187],a[120:123],v[48:51],v[184:187]
s_waitcnt lgkmcnt(4)
E v18,v68
M v[192:195],a[64:67],v[48:51],v[192:195]
R a[96:99],v7,57344
AF v26,v25,v26
M v[192:195],a[68:71],v[56:59],v[192:195]
R a[100:103],v7,58368
M v[196:199],a[68:71],v[60:63],v[196:199]
buffer_load_dwordx4 v4, s[8:11], s21 offen offset:3072 sc1 lds
M v[196:199],a[64:67],v[52:55],v[196:199]
s_waitcnt lgkmcnt(2)
R a[104:107],v7,59392
M v[204:207],a[72:75],v[52:55],v[204:207]
SA s21,s21,32768
R a[108:111],v7,60416
M v[204:207],a[76:79],v[60:63],v[204:207]
s_sub_u32 s22, s22, 1
E v19,v69
M v[200:203],a[76:79],v[56:59],v[200:203]
s_cselect_b32 s21, s23, s21
R a[112:115],v7,61440
AF v27,v18,v19
M v[200:203],a[72:75],v[48:51],v[200:203]
R a[116:119],v7,62464
C v44,v18,v19
M v[208:211],a[80:83],v[48:51],v[208:211]
E v20,v70
M v[208:211],a[84:87],v[56:59],v[208:211]
R a[120:123],v7,63488
M v[212:215],a[84:87],v[60:63],v[212:215]
R a[124:127],v7,64512
M v[212:215],a[80:83],v[52:55],v[212:215]
E v21,v71
M v[220:223],a[88:91],v[52:55],v[220:223]
E v22,v76
M v[220:223],a[92:95],v[60:63],v[220:223]
AF v27,v20,v27
C v45,v20,v21
M v[216:219],a[92:95],v[56:59],v[216:219]
s_waitcnt vmcnt(17) lgkmcnt(0)
AF v27,v21,v27
M v[216:219],a[88:91],v[48:51],v[216:219]
s_barrier
M v[224:227],a[96:99],v[48:51],v[224:227]
R a[64:67],v2,0
M v[224:227],a[100:103],v[56:59],v[224:227]
E v23,v77
M v[228:231],a[100:103],v[60:63],v[228:231]
R a[68:71],v2,1024
AF v27,v22,v27
M v[228:231],a[96:99],v[52:55],v[228:231]
E v24,v78
M v[236:239],a[104:107],v[52:55],v[236:239]
R a[72:75],v2,2048
C v46,v22,v23
M v[236:239],a[108:111],v[60:63],v[236:239]
AF v27,v23,v27
M v[232:235],a[108:111],v[56:59],v[232:235]
R a[76:79],v2,3072
M v[232:235],a[104:107],v[48:51],v[232:235]
E v25,v79
M v[240:243],a[112:115],v[48:51],v[240:243]
R a[80:83],v2,4096
AF v27,v24,v27
M v[240:243],a[116:119],v[56:59],v[240:243]
C v47,v24,v25
AF v27,v25,v27
M v[244:247],a[116:119],v[60:63],v[244:247]
R a[84:87],v2,5120
M v[244:247],a[112:115],v[52:55],v[244:247]
M v[252:255],a[120:123],v[52:55],v[252:255]
R a[88:91],v2,6144
M v[252:255],a[124:127],v[60:63],v[252:255]
M v[248:251],a[124:127],v[56:59],v[248:251]
s_waitcnt lgkmcnt(3)
R a[92:95],v2,7168
M v[248:251],a[120:123],v[48:51],v[248:251]
M v[96:99],a[64:67],a[0:3],v[32:35]
s_bitcmp1_b32 s39, s7
R a[96:99],v2,8192
M v[96:99],a[68:71],a[4:7],v[96:99]
s_cbranch_scc1 L_fll
L_fllr:
E v18,v80
M v[96:99],a[72:75],a[8:11],v[96:99]
SA m0,s28,32768
R a[100:103],v2,9216
M v[96:99],a[76:79],a[12:15],v[96:99]
s_waitcnt lgkmcnt(2)
buffer_load_dwordx4 v3, s[8:11], s26 offen offset:0 sc1 lds
M v[96:99],a[80:83],a[16:19],v[96:99]
R a[104:107],v2,10240
M v[96:99],a[84:87],a[20:23],v[96:99]
E v19,v81
M v[96:99],a[88:91],a[24:27],v[96:99]
R a[108:111],v2,11264
AF v26,v18,v26
M v[96:99],a[92:95],a[28:31],v[96:99]
E v20,v82
M v[100:103],a[92:95],a[60:63],v[36:39]
R a[112:115],v2,12288
C v56,v18,v19
M v[100:103],a[88:91],a[56:59],v[100:103]
buffer_load_dwordx4 v3, s[8:11], s26 offen offset:1024 sc1 lds
M v[100:103],a[84:87],a[52:55],v[100:103]
R a[116:119],v2,13312
AF v26,v19,v26
M v[100:103],a[80:83],a[48:51],v[100:103]
E v21,v83
M v[100:103],a[76:79],a[44:47],v[100:103]
R a[120:123],v2,14336
AF v26,v20,v26
M v[100:103],a[72:75],a[40:43],v[100:103]
buffer_load_dwordx4 v3, s[8:11], s26 offen offset:2048 sc1 lds
M v[100:103],a[68:71],a[36:39],v[100:103]
R a[124:127],v2,15360
C v57,v20,v21
M v[100:103],a[64:67],a[32:35],v[100:103]
s_waitcnt lgkmcnt(4)
E v22,v88
M v[108:111],a[96:99],a[32:35],v[36:39]
R a[64:67],v2,16384
AF v26,v21,v26
M v[108:111],a[100:103],a[36:39],v[108:111]
E v23,v89
M v[108:111],a[104:107],a[40:43],v[108:111]
R a[68:71],v2,17408
AF v26,v22,v26
M v[108:111],a[108:111],a[44:47],v[108:111]
s_waitcnt lgkmcnt(2)
buffer_load_dwordx4 v3, s[8:11], s26 offen offset:3072 sc1 lds
M v[108:111],a[112:115],a[48:51],v[108:111]
R a[72:75],v2,18432
C v58,v22,v23
M v[108:111],a[116:119],a[52:55],v[108:111]
E v24,v90
M v[108:111],a[120:123],a[56:59],v[108:111]
R a[76:79],v2,19456
AF v26,v23,v26
M v[108:111],a[124:127],a[60:63],v[108:111]
SA m0,s28,36864
M v[104:107],a[124:127],a[28:31],v[32:35]
R a[80:83],v2,20480
M v[104:107],a[120:123],a[24:27],v[104:107]
buffer_load_dwordx4 v4, s[8:11], s26 offen offset:0 sc1 lds
M v[104:107],a[116:119],a[20:23],v[104:107]
R a[84:87],v2,21504
M v[104:107],a[112:115],a[16:19],v[104:107]
E v25,v91
M v[104:107],a[108:111],a[12:15],v[104:107]
R a[88:91],v2,22528
AF v26,v24,v26
M v[104:107],a[104:107],a[8:11],v[104:107]
buffer_load_dwordx4 v4, s[8:11], s26 offen offset:1024 sc1 lds
M v[104:107],a[100:103],a[4:7],v[104:107]
R a[92:95],v2,23552
C v59,v24,v25
M v[104:107],a[96:99],a[0:3],v[104:107]
s_waitcnt lgkmcnt(4)
E v18,v84
M v[112:115],a[64:67],a[0:3],v[32:35]
R a[96:99],v2,24576
AF v26,v25,v26
M v[112:115],a[68:71],a[4:7],v[112:115]
R a[100:103],v2,25600
M v[112:115],a[72:75],a[8:11],v[112:115]
buffer_load_dwordx4 v4, s[8:11], s26 offen offset:2048 sc1 lds
M v[112:115],a[76:79],a[12:15],v[112:115]
s_waitcnt lgkmcnt(2)
R a[104:107],v2,26624
M v[112:115],a[80:83],a[16:19],v[112:115]
R a[108:111],v2,27648
M v[112:115],a[84:87],a[20:23],v[112:115]
E v19,v85
M v[112:115],a[88:91],a[24:27],v[112:115]
R a[112:115],v2,28672
AF v27,v18,v27
M v[112:115],a[92:95],a[28:31],v[112:115]
R a[116:119],v2,29696
C v60,v18,v19
M v[116:119],a[92:95],a[60:63],v[36:39]
buffer_load_dwordx4 v4, s[8:11], s26 offen offset:3072 sc1 lds
M v[116:119],a[88:91],a[56:59],v[116:119]
SA s26,s26,32768
R a[120:123],v2,30720
AF v27,v19,v27
M v[116:119],a[84:87],a[52:55],v[116:119]
R a[124:127],v2,31744
M v[116:119],a[80:83],a[48:51],v[116:119]
E v20,v86
M v[116:119],a[76:79],a[44:47],v[116:119]
E v21,v87
M v[116:119],a[72:75],a[40:43],v[116:119]
E v22,v92
M v[116:119],a[68:71],a[36:39],v[116:119]
s_waitcnt vmcnt(16) lgkmcnt(0)
E v23,v93
M v[116:119],a[64:67],a[32:35],v[116:119]
s_barrier
M v[124:127],a[96:99],a[32:35],v[36:39]
R a[64:67],v7,0
AF v27,v20,v27
M v[124:127],a[100:103],a[36:39],v[124:127]
E v24,v94
M v[124:127],a[104:107],a[40:43],v[124:127]
R a[68:71],v7,1024
C v61,v20,v21
M v[124:127],a[108:111],a[44:47],v[124:127]
AF v27,v21,v27
AF v27,v22,v27
M v[124:127],a[112:115],a[48:51],v[124:127]
R a[72:75],v7,2048
C v62,v22,v23
M v[124:127],a[116:119],a[52:55],v[124:127]
E v25,v95
M v[124:127],a[120:123],a[56:59],v[124:127]
R a[76:79],v7,3072
AF v27,v23,v27
M v[124:127],a[124:127],a[60:63],v[124:127]
AF v27,v24,v27
C v63,v24,v25
M v[120:123],a[124:127],a[28:31],v[32:35]
R a[80:83],v7,4096
AF v27,v25,v27
M v[120:123],a[120:123],a[24:27],v[120:123]
M v[120:123],a[116:119],a[20:23],v[120:123]
R a[84:87],v7,5120
v_max_f32 v10, v26, v27
M v[120:123],a[112:115],a[16:19],v[120:123]
v_cmp_lt_f32 vcc, s31, v10
M v[120:123],a[108:111],a[12:15],v[120:123]
R a[88:91],v7,6144
M v[120:123],a[104:107],a[8:11],v[120:123]
M v[120:123],a[100:103],a[4:7],v[120:123]
s_waitcnt lgkmcnt(3)
R a[92:95],v7,7168
M v[120:123],a[96:99],a[0:3],v[120:123]
s_cbranch_vccnz L_st0
L_rt0:
M v[128:131],a[64:67],v[40:43],v[128:131]
SA m0,s28,65536
R a[96:99],v7,8192
AF v30,v26,v30
M v[128:131],a[68:71],v[56:59],v[128:131]
buffer_load_dwordx4 v3, s[8:11], s21 offen offset:0 sc1 lds
M v[132:135],a[68:71],v[60:63],v[132:135]
R a[100:103],v7,9216
AF v31,v27,v31
M v[132:135],a[64:67],v[44:47],v[132:135]
s_waitcnt lgkmcnt(2)
E v18,v96
M v[140:143],a[72:75],v[44:47],v[140:143]
R a[104:107],v7,10240
M v[140:143],a[76:79],v[60:63],v[140:143]
buffer_load_dwordx4 v3, s[8:11], s21 offen offset:1024 sc1 lds
M v[136:139],a[76:79],v[56:59],v[136:139]
R a[108:111],v7,11264
M v[136:139],a[72:75],v[40:43],v[136:139]
E v19,v97
M v[144:147],a[80:83],v[40:43],v[144:147]
R a[112:115],v7,12288
AF v28,v18,v19
M v[144:147],a[84:87],v[56:59],v[144:147]
E v20,v98
M v[148:151],a[84:87],v[60:63],v[148:151]
R a[116:119],v7,13312
C v48,v18,v19
M v[148:151],a[80:83],v[44:47],v[148:151]
buffer_load_dwordx4 v3, s[8:11], s21 offen offset:2048 sc1 lds
M v[156:159],a[88:91],v[44:47],v[156:159]
R a[120:123],v7,14336
M v[156:159],a[92:95],v[60:63],v[156:159]
E v21,v99
M v[152:155],a[92:95],v[56:59],v[152:155]
R a[124:127],v7,15360
AF v28,v20,v28
M v[152:155],a[88:91],v[40:43],v[152:155]
s_waitcnt lgkmcnt(4)
buffer_load_dwordx4 v3, s[8:11], s21 offen offset:3072 sc1 lds
M v[160:163],a[96:99],v[40:43],v[160:163]
R a[64:67],v7,16384
C v49,v20,v21
M v[160:163],a[100:103],v[56:59],v[160:163]
E v22,v104
M v[164:167],a[100:103],v[60:63],v[164:167]
SA m0,s28,69632
R a[68:71],v7,17408
AF v28,v21,v28
M v[164:167],a[96:99],v[44:47],v[164:167]
s_waitcnt lgkmcnt(2)
buffer_load_dwordx4 v4, s[8:11], s21 offen offset:0 sc1 lds
M v[172:175],a[104:107],v[44:47],v[172:175]
R a[72:75],v7,18432
M v[172:175],a[108:111],v[60:63],v[172:175]
E v23,v105
M v[168:171],a[108:111],v[56:59],v[168:171]
R a[76:79],v7,19456
AF v28,v22,v28
M v[168:171],a[104:107],v[40:43],v[168:171]
E v24,v106
M v[176:179],a[112:115],v[40:43],v[176:179]
R a[80:83],v7,20480
C v50,v22,v23
M v[176:179],a[116:119],v[56:59],v[176:179]
buffer_load_dwordx4 v4, s[8:11], s21 offen offset:1024 sc1 lds
M v[180:183],a[116:119],v[60:63],v[180:183]
R a[84:87],v7,21504
AF v28,v23,v28
M v[180:183],a[112:115],v[44:47],v[180:183]
E v25,v107
M v[188:191],a[120:123],v[44:47],v[188:191]
R a[88:91],v7,22528
AF v28,v24,v28
M v[188:191],a[124:127],v[60:63],v[188:191]
buffer_load_dwordx4 v4, s[8:11], s21 offen offset:2048 sc1 lds
M v[184:187],a[124:127],v[56:59],v[184:187]
R a[92:95],v7,23552
C v51,v24,v25
M v[184:187],a[120:123],v[40:43],v[184:187]
s_waitcnt lgkmcnt(4)
E v18,v100
M v[192:195],a[64:67],v[40:43],v[192:195]
R a[96:99],v7,24576
AF v28,v25,v28
M v[192:195],a[68:71],v[56:59],v[192:195]
R a[100:103],v7,25600
M v[196:199],a[68:71],v[60:63],v[196:199]
buffer_load_dwordx4 v4, s[8:11], s21 offen offset:3072 sc1 lds
M v[196:199],a[64:67],v[44:47],v[196:199]
s_waitcnt lgkmcnt(2)
R a[104:107],v7,26624
M v[204:207],a[72:75],v[44:47],v[204:207]
SA s21,s21,32768
R a[108:111],v7,27648
M v[204:207],a[76:79],v[60:63],v[204:207]
s_sub_u32 s22, s22, 1
E v19,v101
M v[200:203],a[76:79],v[56:59],v[200:203]
s_cselect_b32 s21, s23, s21
R a[112:115],v7,28672
AF v29,v18,v19
M v[200:203],a[72:75],v[40:43],v[200:203]
R a[116:119],v7,29696
C v52,v18,v19
M v[208:211],a[80:83],v[40:43],v[208:211]
E v20,v102
M v[208:211],a[84:87],v[56:59],v[208:211]
R a[120:123],v7,30720
M v[212:215],a[84:87],v[60:63],v[212:215]
R a[124:127],v7,31744
M v[212:215],a[80:83],v[44:47],v[212:215]
E v21,v103
M v[220:223],a[88:91],v[44:47],v[220:223]
E v22,v108
M v[220:223],a[92:95],v[60:63],v[220:223]
AF v29,v20,v29
C v53,v20,v21
M v[216:219],a[92:95],v[56:59],v[216:219]
s_waitcnt vmcnt(16) lgkmcnt(0)
AF v29,v21,v29
M v[216:219],a[88:91],v[40:43],v[216:219]
s_barrier
M v[224:227],a[96:99],v[40:43],v[224:227]
R a[64:67],v2,32768
M v[224:227],a[100:103],v[56:59],v[224:227]
E v23,v109
M v[228:231],a[100:103],v[60:63],v[228:231]
R a[68:71],v2,33792
v_cmp_gt_u32 vcc, s6, v5
M v[228:231],a[96:99],v[44:47],v[228:231]
E v24,v110
M v[236:239],a[104:107],v[44:47],v[236:239]
R a[72:75],v2,34816
AF v29,v22,v29
M v[236:239],a[108:111],v[60:63],v[236:239]
s_cbranch_vccnz L_fls0
L_flr0:
C v54,v22,v23
AF v29,v23,v29
M v[232:235],a[108:111],v[56:59],v[232:235]
s_mov_b32 s6, 0
R a[76:79],v2,35840
M v[232:235],a[104:107],v[40:43],v[232:235]
SA s7,s7,1
E v25,v111
M v[240:243],a[112:115],v[40:43],v[240:243]
R a[80:83],v2,36864
AF v29,v24,v29
M v[240:243],a[116:119],v[56:59],v[240:243]
C v55,v24,v25
AF v29,v25,v29
M v[244:247],a[116:119],v[60:63],v[244:247]
R a[84:87],v2,37888
M v[244:247],a[112:115],v[44:47],v[244:247]
M v[252:255],a[120:123],v[44:47],v[252:255]
s_sub_u32 s27, s27, 1
R a[88:91],v2,38912
M v[252:255],a[124:127],v[60:63],v[252:255]
s_cmp_lg_u32 s27, 0
M v[248:251],a[124:127],v[56:59],v[248:251]
s_waitcnt lgkmcnt(3)
R a[92:95],v2,39936
M v[248:251],a[120:123],v[40:43],v[248:251]
s_cbranch_scc1 L_loop_top
s_cmp_eq_u32 s40, 0
s_cbranch_scc1 L_final_h
L_d1s:
M v[68:71],a[64:67],a[32:35],v[36:39]
s_cmp_lt_u32 s20, 0
R a[96:99],v2,40960
R a[100:103],v2,41984
M v[68:71],a[68:71],a[36:39],v[68:71]
s_cselect_b64 s[82:83], -1, 0
E v18,v112
M v[68:71],a[72:75],a[40:43],v[68:71]
s_cmp_eq_u32 s20, 0
M v[68:71],a[76:79],a[44:47],v[68:71]
s_cselect_b64 s[66:67], s[16:17], s[82:83]
R a[104:107],v2,43008
R a[108:111],v2,44032
s_waitcnt lgkmcnt(7)
M v[68:71],a[80:83],a[48:51],v[68:71]
s_cselect_b64 s[68:69], s[18:19], s[82:83]
E v19,v113
s_waitcnt lgkmcnt(6)
M v[68:71],a[84:87],a[52:55],v[68:71]
s_cselect_b64 s[70:71], s[48:49], s[82:83]
AF v28,v18,v28
C v56,v18,v19
s_waitcnt lgkmcnt(5)
M v[68:71],a[88:91],a[56:59],v[68:71]
s_cselect_b64 s[72:73], s[50:51], s[82:83]
R a[112:115],v2,45056
R a[116:119],v2,46080
v_cndmask_b32 v64, v32, v8, s[66:67]
v_cndmask_b32 v65, v32, v8, s[68:69]
v_cndmask_b32 v66, v32, v8, s[70:71]
v_cndmask_b32 v67, v32, v8, s[72:73]
s_waitcnt lgkmcnt(6)
M v[68:71],a[92:95],a[60:63],v[68:71]
s_mov_b32 s26, s43
v_min_u32 v17, 896, v9
AF v28,v19,v28
M v[64:67],a[92:95],a[28:31],v[64:67]
s_cmp_lt_u32 s20, 1
buffer_load_dword v5, v17, s[8:11], s46 offen sc1
M v[64:67],a[88:91],a[24:27],v[64:67]
s_cselect_b64 s[82:83], -1, 0
R a[120:123],v2,47104
R a[124:127],v2,48128
M v[64:67],a[84:87],a[20:23],v[64:67]
SA m0,s28,0
E v20,v114
M v[64:67],a[80:83],a[16:19],v[64:67]
s_cmp_eq_u32 s20, 1
buffer_load_dwordx4 v3, s[8:11], s26 offen offset:0 sc1 lds
M v[64:67],a[76:79],a[12:15],v[64:67]
s_cselect_b64 s[74:75], s[16:17], s[82:83]
E v21,v115
M v[64:67],a[72:75],a[8:11],v[64:67]
s_cselect_b64 s[76:77], s[18:19], s[82:83]
AF v28,v20,v28
C v57,v20,v21
M v[64:67],a[68:71],a[4:7],v[64:67]
s_cselect_b64 s[78:79], s[48:49], s[82:83]
E v22,v120
M v[64:67],a[64:67],a[0:3],v[64:67]
s_waitcnt lgkmcnt(0)
buffer_load_dwordx4 v3, s[8:11], s26 offen offset:1024 sc1 lds
M v[76:79],a[96:99],a[32:35],v[36:39]
s_cselect_b64 s[80:81], s[50:51], s[82:83]
R a[64:67],v2,49152
R a[68:71],v2,50176
M v[76:79],a[100:103],a[36:39],v[76:79]
v_cndmask_b32 v72, v32, v8, s[74:75]
v_cndmask_b32 v73, v32, v8, s[76:77]
M v[76:79],a[104:107],a[40:43],v[76:79]
v_cndmask_b32 v74, v32, v8, s[78:79]
AF v28,v21,v28
M v[76:79],a[108:111],a[44:47],v[76:79]
R a[72:75],v2,51200
R a[76:79],v2,52224
M v[76:79],a[112:115],a[48:51],v[76:79]
buffer_load_dwordx4 v3, s[8:11], s26 offen offset:2048 sc1 lds
M v[76:79],a[116:119],a[52:55],v[76:79]
v_cndmask_b32 v75, v32, v8, s[80:81]
M v[76:79],a[120:123],a[56:59],v[76:79]
s_cmp_lt_u32 s20, 2
R a[80:83],v2,53248
R a[84:87],v2,54272
M v[76:79],a[124:127],a[60:63],v[76:79]
s_cselect_b64 s[82:83], -1, 0
E v23,v121
M v[72:75],a[124:127],a[28:31],v[72:75]
s_cmp_eq_u32 s20, 2
buffer_load_dwordx4 v3, s[8:11], s26 offen offset:3072 sc1 lds
M v[72:75],a[120:123],a[24:27],v[72:75]
s_cselect_b64 s[66:67], s[16:17], s[82:83]
R a[88:91],v2,55296
R a[92:95],v2,56320
M v[72:75],a[116:119],a[20:23],v[72:75]
s_cselect_b64 s[68:69], s[18:19], s[82:83]
E v24,v122
M v[72:75],a[112:115],a[16:19],v[72:75]
s_cselect_b64 s[70:71], s[48:49], s[82:83]
E v25,v123
M v[72:75],a[108:111],a[12:15],v[72:75]
s_cselect_b64 s[72:73], s[50:51], s[82:83]
v_cndmask_b32 v80, v32, v8, s[66:67]
v_cndmask_b32 v81, v32, v8, s[68:69]
M v[72:75],a[104:107],a[8:11],v[72:75]
SA m0,s28,4096
E v18,v116
M v[72:75],a[100:103],a[4:7],v[72:75]
s_lshl_b32 s86, s20, 14
buffer_load_dwordx4 v4, s[8:11], s26 offen offset:0 sc1 lds
M v[72:75],a[96:99],a[0:3],v[72:75]
s_waitcnt lgkmcnt(0)
v_cndmask_b32 v82, v32, v8, s[70:71]
AF v28,v22,v28
M v[84:87],a[64:67],a[32:35],v[36:39]
SA s86,s86,s34
R a[96:99],v2,57344
R a[100:103],v2,58368
M v[84:87],a[68:71],a[36:39],v[84:87]
SA s87,s86,4096
buffer_load_dwordx4 v4, s[8:11], s26 offen offset:1024 sc1 lds
M v[84:87],a[72:75],a[40:43],v[84:87]
SA s88,s86,8192
v_cndmask_b32 v83, v32, v8, s[72:73]
C v58,v22,v23
M v[84:87],a[76:79],a[44:47],v[84:87]
s_cmp_lt_u32 s20, 3
R a[104:107],v2,59392
R a[108:111],v2,60416
M v[84:87],a[80:83],a[48:51],v[84:87]
s_cselect_b64 s[82:83], -1, 0
E v19,v117
M v[84:87],a[84:87],a[52:55],v[84:87]
SA s89,s86,12288
buffer_load_dwordx4 v4, s[8:11], s26 offen offset:2048 sc1 lds
M v[84:87],a[88:91],a[56:59],v[84:87]
s_lshl_b32 s90, s20, 10
R a[112:115],v2,61440
R a[116:119],v2,62464
M v[84:87],a[92:95],a[60:63],v[84:87]
SA s90,s90,s34
E v20,v118
M v[80:83],a[92:95],a[28:31],v[80:83]
SA s90,s90,65536
E v21,v119
M v[80:83],a[88:91],a[24:27],v[80:83]
s_cmp_eq_u32 s20, 3
R a[120:123],v2,63488
R a[124:127],v2,64512
M v[80:83],a[84:87],a[20:23],v[80:83]
s_cselect_b64 s[74:75], s[16:17], s[82:83]
buffer_load_dwordx4 v4, s[8:11], s26 offen offset:3072 sc1 lds
M v[80:83],a[80:83],a[16:19],v[80:83]
s_cselect_b64 s[76:77], s[18:19], s[82:83]
AF v28,v23,v28
AF v28,v24,v28
M v[80:83],a[76:79],a[12:15],v[80:83]
s_cselect_b64 s[78:79], s[48:49], s[82:83]
E v22,v124
M v[80:83],a[72:75],a[8:11],v[80:83]
s_cselect_b64 s[80:81], s[50:51], s[82:83]
v_cndmask_b32 v88, v32, v8, s[74:75]
v_cndmask_b32 v89, v32, v8, s[76:77]
M v[80:83],a[68:71],a[4:7],v[80:83]
s_waitcnt vmcnt(17) lgkmcnt(0)
v_cndmask_b32 v90, v32, v8, s[78:79]
v_cndmask_b32 v91, v32, v8, s[80:81]
M v[80:83],a[64:67],a[0:3],v[80:83]
s_barrier
M v[92:95],a[96:99],a[32:35],v[36:39]
SA s26,s26,32768
R a[64:67],v7,32768
R a[68:71],v7,33792
M v[92:95],a[100:103],a[36:39],v[92:95]
SA m0,s28,131072
E v23,v125
M v[92:95],a[104:107],a[40:43],v[92:95]
buffer_load_dwordx4 v3, s[8:11], s26 offen offset:0 sc1 lds
M v[92:95],a[108:111],a[44:47],v[92:95]
R a[72:75],v7,34816
R a[76:79],v7,35840
M v[92:95],a[112:115],a[48:51],v[92:95]
C v59,v24,v25
AF v28,v25,v28
M v[92:95],a[116:119],a[52:55],v[92:95]
buffer_load_dwordx4 v3, s[8:11], s26 offen offset:1024 sc1 lds
M v[92:95],a[120:123],a[56:59],v[92:95]
R a[80:83],v7,36864
R a[84:87],v7,37888
M v[92:95],a[124:127],a[60:63],v[92:95]
E v24,v126
M v[88:91],a[124:127],a[28:31],v[88:91]
buffer_load_dwordx4 v3, s[8:11], s26 offen offset:2048 sc1 lds
M v[88:91],a[120:123],a[24:27],v[88:91]
R a[88:91],v7,38912
R a[92:95],v7,39936
M v[88:91],a[116:119],a[20:23],v[88:91]
E v25,v127
M v[88:91],a[112:115],a[16:19],v[88:91]
buffer_load_dwordx4 v3, s[8:11], s26 offen offset:3072 sc1 lds
M v[88:91],a[108:111],a[12:15],v[88:91]
AF v29,v18,v29
C v60,v18,v19
M v[88:91],a[104:107],a[8:11],v[88:91]
AF v29,v19,v29
AF v29,v20,v29
M v[88:91],a[100:103],a[4:7],v[88:91]
s_waitcnt lgkmcnt(0)
C v61,v20,v21
AF v29,v21,v29
M v[88:91],a[96:99],a[0:3],v[88:91]
AF v29,v22,v29
C v62,v22,v23
AF v29,v23,v29
AF v29,v24,v29
C v63,v24,v25
AF v29,v25,v29
v_max_f32 v10, v28, v29
v_cmp_lt_f32 vcc, s31, v10
s_nop 0
s_cbranch_vccnz L_std1
L_rtd1:
s_cmp_lt_u32 s42, 6
s_cbranch_scc1 L_d2h
M v[128:131],a[64:67],v[48:51],v[128:131]
R a[96:99],v7,40960
R a[100:103],v7,41984
M v[128:131],a[68:71],v[56:59],v[128:131]
SA m0,s28,135168
E v18,v64
M v[132:135],a[68:71],v[60:63],v[132:135]
buffer_load_dwordx4 v4, s[8:11], s26 offen offset:0 sc1 lds
M v[132:135],a[64:67],v[52:55],v[132:135]
R a[104:107],v7,43008
R a[108:111],v7,44032
M v[140:143],a[72:75],v[52:55],v[140:143]
s_cmp_gt_u32 s20, 3
E v19,v65
M v[140:143],a[76:79],v[60:63],v[140:143]
s_cselect_b64 s[82:83], -1, 0
AF v30,v28,v30
AF v31,v29,v31
M v[136:139],a[76:79],v[56:59],v[136:139]
s_cmp_eq_u32 s20, 3
R a[112:115],v7,45056
R a[116:119],v7,46080
M v[136:139],a[72:75],v[48:51],v[136:139]
s_cselect_b64 s[66:67], s[16:17], s[82:83]
buffer_load_dwordx4 v4, s[8:11], s26 offen offset:1024 sc1 lds
M v[144:147],a[80:83],v[48:51],v[144:147]
s_cselect_b64 s[68:69], s[18:19], s[82:83]
E v20,v66
M v[144:147],a[84:87],v[56:59],v[144:147]
s_cselect_b64 s[70:71], s[48:49], s[82:83]
R a[120:123],v7,47104
R a[124:127],v7,48128
M v[148:151],a[84:87],v[60:63],v[148:151]
s_cselect_b64 s[72:73], s[50:51], s[82:83]
v_cndmask_b32 v100, v36, v8, s[66:67]
v_cndmask_b32 v101, v36, v8, s[68:69]
M v[148:151],a[80:83],v[52:55],v[148:151]
buffer_load_dwordx4 v4, s[8:11], s26 offen offset:2048 sc1 lds
M v[156:159],a[88:91],v[52:55],v[156:159]
v_cndmask_b32 v102, v36, v8, s[70:71]
AF v26,v18,v19
M v[156:159],a[92:95],v[60:63],v[156:159]
E v21,v67
M v[152:155],a[92:95],v[56:59],v[152:155]
v_cndmask_b32 v103, v36, v8, s[72:73]
C v40,v18,v19
M v[152:155],a[88:91],v[48:51],v[152:155]
s_waitcnt lgkmcnt(0)
buffer_load_dwordx4 v4, s[8:11], s26 offen offset:3072 sc1 lds
M v[160:163],a[96:99],v[48:51],v[160:163]
s_cmp_gt_u32 s20, 2
R a[64:67],v7,49152
R a[68:71],v7,50176
M v[160:163],a[100:103],v[56:59],v[160:163]
s_cselect_b64 s[82:83], -1, 0
v_lshrrev_b32 v14, 7, v7
AF v26,v20,v26
M v[164:167],a[100:103],v[60:63],v[164:167]
s_cmp_eq_u32 s20, 2
v_mul_u32_u24 v14, 896, v14
C v41,v20,v21
M v[164:167],a[96:99],v[52:55],v[164:167]
s_cselect_b64 s[74:75], s[16:17], s[82:83]
R a[72:75],v7,51200
R a[76:79],v7,52224
M v[172:175],a[104:107],v[52:55],v[172:175]
s_cselect_b64 s[76:77], s[18:19], s[82:83]
v_lshrrev_b32 v15, 8, v7
AF v26,v21,v26
M v[172:175],a[108:111],v[60:63],v[172:175]
s_cselect_b64 s[78:79], s[48:49], s[82:83]
v_lshlrev_b32 v15, 5, v15
M v[168:171],a[108:111],v[56:59],v[168:171]
s_cselect_b64 s[80:81], s[50:51], s[82:83]
R a[80:83],v7,53248
R a[84:87],v7,54272
M v[168:171],a[104:107],v[48:51],v[168:171]
v_cndmask_b32 v108, v36, v8, s[74:75]
v_cndmask_b32 v109, v36, v8, s[76:77]
M v[176:179],a[112:115],v[48:51],v[176:179]
v_xor_b32 v15, v15, v7
M v[176:179],a[116:119],v[56:59],v[176:179]
R a[88:91],v7,55296
R a[92:95],v7,56320
M v[180:183],a[116:119],v[60:63],v[180:183]
v_and_b32 v15, 0x70, v15
v_cndmask_b32 v110, v36, v8, s[78:79]
M v[180:183],a[112:115],v[52:55],v[180:183]
v_add_u32 v0, v14, v15
M v[188:191],a[120:123],v[52:55],v[188:191]
s_mul_i32 s38, s20, 57344
v_cndmask_b32 v111, v36, v8, s[80:81]
M v[188:191],a[124:127],v[60:63],v[188:191]
s_cmp_gt_u32 s20, 1
E v22,v72
M v[184:187],a[124:127],v[56:59],v[184:187]
s_cselect_b64 s[82:83], -1, 0
E v23,v73
M v[184:187],a[120:123],v[48:51],v[184:187]
s_waitcnt lgkmcnt(0)
E v24,v74
M v[192:195],a[64:67],v[48:51],v[192:195]
SA m0,s28,98304
R a[96:99],v7,57344
R a[100:103],v7,58368
M v[192:195],a[68:71],v[56:59],v[192:195]
s_cmp_eq_u32 s20, 1
E v25,v75
M v[196:199],a[68:71],v[60:63],v[196:199]
s_cselect_b64 s[66:67], s[16:17], s[82:83]
E v18,v68
M v[196:199],a[64:67],v[52:55],v[196:199]
s_cselect_b64 s[68:69], s[18:19], s[82:83]
R a[104:107],v7,59392
R a[108:111],v7,60416
M v[204:207],a[72:75],v[52:55],v[204:207]
s_cselect_b64 s[70:71], s[48:49], s[82:83]
E v19,v69
M v[204:207],a[76:79],v[60:63],v[204:207]
s_cselect_b64 s[72:73], s[50:51], s[82:83]
v_cndmask_b32 v116, v36, v8, s[66:67]
v_cndmask_b32 v117, v36, v8, s[68:69]
M v[200:203],a[76:79],v[56:59],v[200:203]
SA s85,s38,0
R a[112:115],v7,61440
R a[116:119],v7,62464
M v[200:203],a[72:75],v[48:51],v[200:203]
buffer_load_dwordx4 v0, s[12:15], s85 offen offset:0 lds
M v[208:211],a[80:83],v[48:51],v[208:211]
SA s85,s38,6144
v_cndmask_b32 v118, v36, v8, s[70:71]
AF v26,v22,v26
M v[208:211],a[84:87],v[56:59],v[208:211]
R a[120:123],v7,63488
R a[124:127],v7,64512
M v[212:215],a[84:87],v[60:63],v[212:215]
buffer_load_dwordx4 v0, s[12:15], s85 offen offset:1024 lds
M v[212:215],a[80:83],v[52:55],v[212:215]
SA s85,s38,12288
v_cndmask_b32 v119, v36, v8, s[72:73]
C v42,v22,v23
M v[220:223],a[88:91],v[52:55],v[220:223]
s_cmp_gt_u32 s20, 0
E v20,v70
M v[220:223],a[92:95],v[60:63],v[220:223]
s_cselect_b64 s[82:83], -1, 0
buffer_load_dwordx4 v0, s[12:15], s85 offen offset:2048 lds
M v[216:219],a[92:95],v[56:59],v[216:219]
s_waitcnt vmcnt(20) lgkmcnt(0)
E v21,v71
M v[216:219],a[88:91],v[48:51],v[216:219]
s_barrier
M v[224:227],a[96:99],v[48:51],v[224:227]
SA s85,s38,18432
R a[64:67],v2,0
R a[68:71],v2,1024
M v[224:227],a[100:103],v[56:59],v[224:227]
s_cmp_eq_u32 s20, 0
buffer_load_dwordx4 v0, s[12:15], s85 offen offset:3072 lds
M v[228:231],a[100:103],v[60:63],v[228:231]
s_cselect_b64 s[74:75], s[16:17], s[82:83]
AF v26,v23,v26
AF v26,v24,v26
M v[228:231],a[96:99],v[52:55],v[228:231]
s_cselect_b64 s[76:77], s[18:19], s[82:83]
R a[72:75],v2,2048
R a[76:79],v2,3072
M v[236:239],a[104:107],v[52:55],v[236:239]
s_cselect_b64 s[78:79], s[48:49], s[82:83]
E v22,v76
M v[236:239],a[108:111],v[60:63],v[236:239]
s_cselect_b64 s[80:81], s[50:51], s[82:83]
v_cndmask_b32 v124, v36, v8, s[74:75]
v_cndmask_b32 v125, v36, v8, s[76:77]
M v[232:235],a[108:111],v[56:59],v[232:235]
SA m0,s28,102400
R a[80:83],v2,4096
R a[84:87],v2,5120
M v[232:235],a[104:107],v[48:51],v[232:235]
SA s85,s38,28672
buffer_load_dwordx4 v0, s[12:15], s85 offen offset:0 lds
M v[240:243],a[112:115],v[48:51],v[240:243]
SA s85,s38,34816
v_cndmask_b32 v126, v36, v8, s[78:79]
v_cndmask_b32 v127, v36, v8, s[80:81]
M v[240:243],a[116:119],v[56:59],v[240:243]
R a[88:91],v2,6144
R a[92:95],v2,7168
M v[244:247],a[116:119],v[60:63],v[244:247]
buffer_load_dwordx4 v0, s[12:15], s85 offen offset:1024 lds
M v[244:247],a[112:115],v[52:55],v[244:247]
SA s85,s38,40960
E v23,v77
M v[252:255],a[120:123],v[52:55],v[252:255]
buffer_load_dwordx4 v0, s[12:15], s85 offen offset:2048 lds
M v[252:255],a[124:127],v[60:63],v[252:255]
SA s85,s38,47104
C v43,v24,v25
AF v26,v25,v26
M v[248:251],a[124:127],v[56:59],v[248:251]
s_waitcnt lgkmcnt(0)
E v24,v78
M v[248:251],a[120:123],v[48:51],v[248:251]
buffer_load_dwordx4 v0, s[12:15], s85 offen offset:3072 lds
SA s38,s38,128
AF v27,v18,v19
C v44,v18,v19
AF v27,v20,v27
C v45,v20,v21
AF v27,v21,v27
E v25,v79
AF v27,v22,v27
C v46,v22,v23
AF v27,v23,v27
AF v27,v24,v27
C v47,v24,v25
AF v27,v25,v27
M v[100:103],a[64:67],a[32:35],v[100:103]
R a[96:99],v2,8192
R a[100:103],v2,9216
M v[100:103],a[68:71],a[36:39],v[100:103]
R a[104:107],v2,10240
R a[108:111],v2,11264
M v[100:103],a[72:75],a[40:43],v[100:103]
R a[112:115],v2,12288
R a[116:119],v2,13312
M v[100:103],a[76:79],a[44:47],v[100:103]
R a[120:123],v2,14336
R a[124:127],v2,15360
M v[100:103],a[80:83],a[48:51],v[100:103]
v_add_u32 v8, 0x20000, v7
M v[100:103],a[84:87],a[52:55],v[100:103]
E v18,v80
M v[100:103],a[88:91],a[56:59],v[100:103]
E v19,v81
M v[100:103],a[92:95],a[60:63],v[100:103]
s_waitcnt lgkmcnt(0)
E v20,v82
M v[108:111],a[96:99],a[32:35],v[108:111]
R a[64:67],v2,16384
R a[68:71],v2,17408
M v[108:111],a[100:103],a[36:39],v[108:111]
R a[72:75],v2,18432
R a[76:79],v2,19456
M v[108:111],a[104:107],a[40:43],v[108:111]
R a[80:83],v2,20480
R a[84:87],v2,21504
M v[108:111],a[108:111],a[44:47],v[108:111]
R a[88:91],v2,22528
R a[92:95],v2,23552
M v[108:111],a[112:115],a[48:51],v[108:111]
E v21,v83
M v[108:111],a[116:119],a[52:55],v[108:111]
E v22,v88
M v[108:111],a[120:123],a[56:59],v[108:111]
E v23,v89
M v[108:111],a[124:127],a[60:63],v[108:111]
s_waitcnt lgkmcnt(0)
E v24,v90
M v[116:119],a[64:67],a[32:35],v[116:119]
R a[96:99],v2,24576
R a[100:103],v2,25600
M v[116:119],a[68:71],a[36:39],v[116:119]
R a[104:107],v2,26624
R a[108:111],v2,27648
M v[116:119],a[72:75],a[40:43],v[116:119]
R a[112:115],v2,28672
R a[116:119],v2,29696
M v[116:119],a[76:79],a[44:47],v[116:119]
R a[120:123],v2,30720
R a[124:127],v2,31744
M v[116:119],a[80:83],a[48:51],v[116:119]
buffer_load_dword v6, off, s[8:11], s47 sc1
M v[116:119],a[84:87],a[52:55],v[116:119]
E v25,v91
M v[116:119],a[88:91],a[56:59],v[116:119]
s_waitcnt vmcnt(17) lgkmcnt(0)
AF v26,v18,v26
C v56,v18,v19
M v[116:119],a[92:95],a[60:63],v[116:119]
s_barrier
M v[124:127],a[96:99],a[32:35],v[124:127]
R a[64:67],v7,0
R a[68:71],v7,1024
M v[124:127],a[100:103],a[36:39],v[124:127]
R a[72:75],v7,2048
R a[76:79],v7,3072
M v[124:127],a[104:107],a[40:43],v[124:127]
R a[80:83],v7,4096
R a[84:87],v7,5120
M v[124:127],a[108:111],a[44:47],v[124:127]
R a[88:91],v7,6144
R a[92:95],v7,7168
M v[124:127],a[112:115],a[48:51],v[124:127]
AF v26,v19,v26
AF v26,v20,v26
M v[124:127],a[116:119],a[52:55],v[124:127]
E v18,v84
M v[124:127],a[120:123],a[56:59],v[124:127]
s_waitcnt lgkmcnt(0)
E v19,v85
M v[124:127],a[124:127],a[60:63],v[124:127]
C v57,v20,v21
AF v26,v21,v26
AF v26,v22,v26
C v58,v22,v23
AF v26,v23,v26
AF v26,v24,v26
C v59,v24,v25
AF v26,v25,v26
E v20,v86
E v21,v87
AF v27,v18,v27
C v60,v18,v19
AF v27,v19,v27
E v22,v92
E v23,v93
AF v27,v20,v27
C v61,v20,v21
AF v27,v21,v27
E v24,v94
E v25,v95
AF v27,v22,v27
C v62,v22,v23
AF v27,v23,v27
AF v27,v24,v27
C v63,v24,v25
AF v27,v25,v27
v_max_f32 v10, v26, v27
v_cmp_lt_f32 vcc, s31, v10
s_nop 0
s_cbranch_vccnz L_std3n
L_rtd3n:
M v[128:131],a[64:67],v[40:43],v[128:131]
R a[96:99],v7,8192
R a[100:103],v7,9216
M v[128:131],a[68:71],v[56:59],v[128:131]
v_or_b32 v9, s35, v7
s_waitcnt vmcnt(0)
v_cmp_ne_u32 vcc, 1, v6
M v[132:135],a[68:71],v[60:63],v[132:135]
s_cbranch_vccnz L_fps
L_fpr:
E v18,v100
M v[132:135],a[64:67],v[44:47],v[132:135]
R a[104:107],v7,10240
R a[108:111],v7,11264
M v[140:143],a[72:75],v[44:47],v[140:143]
buffer_load_dwordx4 v[14:17], v9, s[8:11], s90 offen sc1
M v[140:143],a[76:79],v[60:63],v[140:143]
E v19,v101
M v[136:139],a[76:79],v[56:59],v[136:139]
R a[112:115],v7,12288
R a[116:119],v7,13312
M v[136:139],a[72:75],v[40:43],v[136:139]
buffer_load_dwordx4 a[160:163], v9, s[8:11], s88 offen offset:0 sc1
M v[144:147],a[80:83],v[40:43],v[144:147]
E v20,v102
M v[144:147],a[84:87],v[56:59],v[144:147]
R a[120:123],v7,14336
R a[124:127],v7,15360
M v[148:151],a[84:87],v[60:63],v[148:151]
buffer_load_dwordx4 a[128:131], v9, s[8:11], s86 offen offset:0 sc1
M v[148:151],a[80:83],v[44:47],v[148:151]
E v21,v103
M v[156:159],a[88:91],v[44:47],v[156:159]
AF v30,v26,v30
AF v31,v27,v31
M v[156:159],a[92:95],v[60:63],v[156:159]
buffer_load_dwordx4 a[164:167], v9, s[8:11], s88 offen offset:1024 sc1
M v[152:155],a[92:95],v[56:59],v[152:155]
AF v29,v18,v19
C v52,v18,v19
M v[152:155],a[88:91],v[40:43],v[152:155]
s_waitcnt lgkmcnt(0)
E v22,v108
M v[160:163],a[96:99],v[40:43],v[160:163]
R a[64:67],v7,16384
R a[68:71],v7,17408
M v[160:163],a[100:103],v[56:59],v[160:163]
buffer_load_dwordx4 a[132:135], v9, s[8:11], s86 offen offset:1024 sc1
M v[164:167],a[100:103],v[60:63],v[164:167]
E v23,v109
M v[164:167],a[96:99],v[44:47],v[164:167]
R a[72:75],v7,18432
R a[76:79],v7,19456
M v[172:175],a[104:107],v[44:47],v[172:175]
buffer_load_dwordx4 a[168:171], v9, s[8:11], s88 offen offset:2048 sc1
M v[172:175],a[108:111],v[60:63],v[172:175]
AF v29,v20,v29
C v53,v20,v21
M v[168:171],a[108:111],v[56:59],v[168:171]
R a[80:83],v7,20480
R a[84:87],v7,21504
M v[168:171],a[104:107],v[40:43],v[168:171]
buffer_load_dwordx4 a[136:139], v9, s[8:11], s86 offen offset:2048 sc1
M v[176:179],a[112:115],v[40:43],v[176:179]
E v24,v110
M v[176:179],a[116:119],v[56:59],v[176:179]
R a[88:91],v7,22528
R a[92:95],v7,23552
M v[180:183],a[116:119],v[60:63],v[180:183]
buffer_load_dwordx4 a[172:175], v9, s[8:11], s88 offen offset:3072 sc1
M v[180:183],a[112:115],v[44:47],v[180:183]
E v25,v111
M v[188:191],a[120:123],v[44:47],v[188:191]
AF v29,v21,v29
AF v29,v22,v29
M v[188:191],a[124:127],v[60:63],v[188:191]
buffer_load_dwordx4 a[140:143], v9, s[8:11], s86 offen offset:3072 sc1
M v[184:187],a[124:127],v[56:59],v[184:187]
E v18,v116
M v[184:187],a[120:123],v[40:43],v[184:187]
s_waitcnt lgkmcnt(0)
C v54,v22,v23
AF v29,v23,v29
M v[192:195],a[64:67],v[40:43],v[192:195]
R a[96:99],v7,24576
R a[100:103],v7,25600
M v[192:195],a[68:71],v[56:59],v[192:195]
buffer_load_dwordx4 a[176:179], v9, s[8:11], s89 offen offset:0 sc1
M v[196:199],a[68:71],v[60:63],v[196:199]
E v19,v117
M v[196:199],a[64:67],v[44:47],v[196:199]
R a[104:107],v7,26624
R a[108:111],v7,27648
M v[204:207],a[72:75],v[44:47],v[204:207]
buffer_load_dwordx4 a[144:147], v9, s[8:11], s87 offen offset:0 sc1
M v[204:207],a[76:79],v[60:63],v[204:207]
E v20,v118
M v[200:203],a[76:79],v[56:59],v[200:203]
R a[112:115],v7,28672
R a[116:119],v7,29696
M v[200:203],a[72:75],v[40:43],v[200:203]
buffer_load_dwordx4 a[180:183], v9, s[8:11], s89 offen offset:1024 sc1
M v[208:211],a[80:83],v[40:43],v[208:211]
AF v29,v24,v29
C v55,v24,v25
M v[208:211],a[84:87],v[56:59],v[208:211]
R a[120:123],v7,30720
R a[124:127],v7,31744
M v[212:215],a[84:87],v[60:63],v[212:215]
buffer_load_dwordx4 a[148:151], v9, s[8:11], s87 offen offset:1024 sc1
M v[212:215],a[80:83],v[44:47],v[212:215]
E v21,v119
M v[220:223],a[88:91],v[44:47],v[220:223]
AF v29,v25,v29
AF v29,v18,v29
M v[220:223],a[92:95],v[60:63],v[220:223]
buffer_load_dwordx4 a[184:187], v9, s[8:11], s89 offen offset:2048 sc1
M v[216:219],a[92:95],v[56:59],v[216:219]
s_waitcnt lgkmcnt(0)
E v22,v124
M v[216:219],a[88:91],v[40:43],v[216:219]
s_barrier
M v[224:227],a[96:99],v[40:43],v[224:227]
R a[64:67],v8,0
R a[68:71],v8,1024
M v[224:227],a[100:103],v[56:59],v[224:227]
buffer_load_dwordx4 a[152:155], v9, s[8:11], s87 offen offset:2048 sc1
M v[228:231],a[100:103],v[60:63],v[228:231]
E v23,v125
M v[228:231],a[96:99],v[44:47],v[228:231]
R a[72:75],v8,2048
R a[76:79],v8,3072
M v[236:239],a[104:107],v[44:47],v[236:239]
buffer_load_dwordx4 a[188:191], v9, s[8:11], s89 offen offset:3072 sc1
M v[236:239],a[108:111],v[60:63],v[236:239]
E v24,v126
M v[232:235],a[108:111],v[56:59],v[232:235]
R a[80:83],v8,4096
R a[84:87],v8,5120
M v[232:235],a[104:107],v[40:43],v[232:235]
buffer_load_dwordx4 a[156:159], v9, s[8:11], s87 offen offset:3072 sc1
M v[240:243],a[112:115],v[40:43],v[240:243]
E v25,v127
M v[240:243],a[116:119],v[56:59],v[240:243]
R a[88:91],v8,6144
R a[92:95],v8,7168
M v[244:247],a[116:119],v[60:63],v[244:247]
C v48,v18,v19
AF v29,v19,v29
M v[244:247],a[112:115],v[44:47],v[244:247]
AF v29,v20,v29
C v49,v20,v21
M v[252:255],a[120:123],v[44:47],v[252:255]
AF v29,v21,v29
AF v29,v22,v29
M v[252:255],a[124:127],v[60:63],v[252:255]
C v50,v22,v23
AF v29,v23,v29
M v[248:251],a[124:127],v[56:59],v[248:251]
s_waitcnt lgkmcnt(0)
AF v29,v24,v29
C v51,v24,v25
M v[248:251],a[120:123],v[40:43],v[248:251]
AF v29,v25,v29
v_cmp_lt_f32 vcc, s31, v29
s_nop 0
s_cbranch_vccnz L_std4n
L_rtd4n:
s_waitcnt vmcnt(16)
v_cmp_neq_f32 vcc, v32, v14
v_cmp_neq_f32 s[64:65], v36, v15
s_cmp_eq_u32 s35, 0
s_cselect_b64 s[66:67], -1, 0
s_or_b64 vcc, vcc, s[64:65]
s_and_b64 vcc, vcc, s[66:67]
s_cbranch_vccnz L_stc
L_rtc:
M v[132:135],a[64:67],v[52:55],v[132:135]
R a[96:99],v8,8192
R a[100:103],v8,9216
M v[132:135],a[68:71],v[48:51],v[132:135]
s_waitcnt vmcnt(12)
AF v30,v16,v30
AF v31,v17,v31
M v[132:135],a[246:249],a[160:163],v[132:135]
SA m0,s28,32768
AF v31,v29,v31
v_mov_b32 v10, v30
M v[128:131],a[246:249],a[128:131],v[128:131]
SA s85,s38,0
R a[104:107],v8,10240
R a[108:111],v8,11264
M v[140:143],a[72:75],v[52:55],v[140:143]
buffer_load_dwordx4 v0, s[12:15], s85 offen offset:0 lds
M v[140:143],a[76:79],v[48:51],v[140:143]
SA s85,s38,6144
v_mov_b32 v11, v31
M v[140:143],a[244:247],a[160:163],v[140:143]
R a[112:115],v8,12288
R a[116:119],v8,13312
M v[136:139],a[244:247],a[128:131],v[136:139]
v_permlane16_swap_b32 v10, v30
M v[148:151],a[80:83],v[52:55],v[148:151]
v_permlane16_swap_b32 v11, v31
M v[148:151],a[84:87],v[48:51],v[148:151]
R a[120:123],v8,14336
R a[124:127],v8,15360
M v[148:151],a[246:249],a[164:167],v[148:151]
buffer_load_dwordx4 v0, s[12:15], s85 offen offset:1024 lds
M v[144:147],a[246:249],a[132:135],v[144:147]
SA s85,s38,12288
AF v30,v10,v30
AF v31,v11,v31
M v[156:159],a[88:91],v[52:55],v[156:159]
v_mov_b32 v10, v30
v_mov_b32 v11, v31
M v[156:159],a[92:95],v[48:51],v[156:159]
buffer_load_dwordx4 v0, s[12:15], s85 offen offset:2048 lds
M v[156:159],a[244:247],a[164:167],v[156:159]
s_waitcnt vmcnt(11)
v_permlane32_swap_b32 v10, v30
M v[152:155],a[244:247],a[132:135],v[152:155]
s_waitcnt lgkmcnt(0)
v_permlane32_swap_b32 v11, v31
M v[164:167],a[96:99],v[52:55],v[164:167]
SA s85,s38,18432
R a[64:67],v8,16384
R a[68:71],v8,17408
M v[164:167],a[100:103],v[48:51],v[164:167]
buffer_load_dwordx4 v0, s[12:15], s85 offen offset:3072 lds
M v[164:167],a[246:249],a[168:171],v[164:167]
SA m0,s28,36864
C v132,v132,v133
C v133,v134,v135
M v[160:163],a[246:249],a[136:139],v[160:163]
SA s85,s38,28672
R a[72:75],v8,18432
R a[76:79],v8,19456
AF v30,v10,v30
AF v31,v11,v31
v_rcp_f32 v5, v30
v_rcp_f32 v6, v31
M v[172:175],a[104:107],v[52:55],v[172:175]
buffer_load_dwordx4 v0, s[12:15], s85 offen offset:0 lds
M v[172:175],a[108:111],v[48:51],v[172:175]
SA s85,s38,34816
C v134,v140,v141
C v135,v142,v143
M v[172:175],a[244:247],a[168:171],v[172:175]
R a[80:83],v8,20480
R a[84:87],v8,21504
M v[168:171],a[244:247],a[136:139],v[168:171]
buffer_load_dwordx4 v0, s[12:15], s85 offen offset:1024 lds
M v[180:183],a[112:115],v[52:55],v[180:183]
SA s85,s38,40960
C v128,v128,v129
C v129,v130,v131
M v[180:183],a[116:119],v[48:51],v[180:183]
R a[88:91],v8,22528
R a[92:95],v8,23552
M v[180:183],a[246:249],a[172:175],v[180:183]
buffer_load_dwordx4 v0, s[12:15], s85 offen offset:2048 lds
M v[176:179],a[246:249],a[140:143],v[176:179]
SA s85,s38,47104
C v130,v136,v137
C v131,v138,v139
M v[188:191],a[120:123],v[52:55],v[188:191]
C v148,v148,v149
C v149,v150,v151
M v[188:191],a[124:127],v[48:51],v[188:191]
buffer_load_dwordx4 v0, s[12:15], s85 offen offset:3072 lds
M v[188:191],a[244:247],a[172:175],v[188:191]
s_waitcnt vmcnt(12)
C v150,v156,v157
C v151,v158,v159
M v[184:187],a[244:247],a[140:143],v[184:187]
s_waitcnt lgkmcnt(0)
C v144,v144,v145
C v145,v146,v147
M v[196:199],a[64:67],v[52:55],v[196:199]
SA s38,s38,128
R a[96:99],v8,24576
R a[100:103],v8,25600
M v[196:199],a[68:71],v[48:51],v[196:199]
SA m0,s28,65536
C v146,v152,v153
C v147,v154,v155
M v[196:199],a[246:249],a[176:179],v[196:199]
SA s85,s38,0
buffer_load_dwordx4 v0, s[12:15], s85 offen offset:0 lds
M v[192:195],a[246:249],a[144:147],v[192:195]
SA s85,s38,6144
R a[104:107],v8,26624
R a[108:111],v8,27648
M v[204:207],a[72:75],v[52:55],v[204:207]
v_lshrrev_b32 v16, 4, v7
v_lshrrev_b32 v14, 2, v16
M v[204:207],a[76:79],v[48:51],v[204:207]
buffer_load_dwordx4 v0, s[12:15], s85 offen offset:1024 lds
M v[204:207],a[244:247],a[176:179],v[204:207]
SA s85,s38,12288
R a[112:115],v8,28672
R a[116:119],v8,29696
M v[200:203],a[244:247],a[144:147],v[200:203]
v_lshlrev_b32 v14, 7, v14
v_and_b32 v15, 3, v16
M v[212:215],a[80:83],v[52:55],v[212:215]
buffer_load_dwordx4 v0, s[12:15], s85 offen offset:2048 lds
M v[212:215],a[84:87],v[48:51],v[212:215]
SA s85,s38,18432
R a[120:123],v8,30720
R a[124:127],v8,31744
M v[212:215],a[246:249],a[180:183],v[212:215]
v_lshl_add_u32 v14, v15, 3, v14
C v164,v164,v165
M v[208:211],a[246:249],a[148:151],v[208:211]
buffer_load_dwordx4 v0, s[12:15], s85 offen offset:3072 lds
M v[220:223],a[88:91],v[52:55],v[220:223]
C v165,v166,v167
C v166,v172,v173
M v[220:223],a[92:95],v[48:51],v[220:223]
s_waitcnt vmcnt(12)
C v167,v174,v175
C v160,v160,v161
M v[220:223],a[244:247],a[180:183],v[220:223]
s_waitcnt lgkmcnt(0)
v_bfe_u32 v15, v16, 3, 2
v_lshl_add_u32 v18, v15, 5, v14
v_xor_b32 v19, 32, v18
v_xor_b32 v20, 64, v18
v_xor_b32 v21, 0x60, v18
v_add_u32 v22, 0x10000, v18
v_add_u32 v23, 0x10000, v19
v_add_u32 v24, 0x10000, v20
v_add_u32 v25, 0x10000, v21
M v[216:219],a[244:247],a[148:151],v[216:219]
s_barrier
M v[228:231],a[96:99],v[52:55],v[228:231]
s_nop 0
T a[64:65],v22,32768
T a[66:67],v22,34816
M v[228:231],a[100:103],v[48:51],v[228:231]
T a[68:69],v22,36864
T a[70:71],v22,38912
M v[228:231],a[246:249],a[184:187],v[228:231]
C v161,v162,v163
C v162,v168,v169
M v[224:227],a[246:249],a[152:155],v[224:227]
T a[72:73],v22,40960
T a[74:75],v22,43008
M v[236:239],a[104:107],v[52:55],v[236:239]
T a[76:77],v22,45056
T a[78:79],v22,47104
M v[236:239],a[108:111],v[48:51],v[236:239]
C v163,v170,v171
C v180,v180,v181
M v[236:239],a[244:247],a[184:187],v[236:239]
T a[80:81],v22,49152
T a[82:83],v22,51200
M v[232:235],a[244:247],a[152:155],v[232:235]
T a[84:85],v22,53248
T a[86:87],v22,55296
M v[244:247],a[112:115],v[52:55],v[244:247]
C v181,v182,v183
C v182,v188,v189
M v[244:247],a[116:119],v[48:51],v[244:247]
T a[88:89],v22,57344
T a[90:91],v22,59392
M v[244:247],a[246:249],a[188:191],v[244:247]
T a[92:93],v22,61440
T a[94:95],v22,63488
M v[240:243],a[246:249],a[156:159],v[240:243]
C v183,v190,v191
C v176,v176,v177
M v[252:255],a[120:123],v[52:55],v[252:255]
C v177,v178,v179
C v178,v184,v185
M v[252:255],a[124:127],v[48:51],v[252:255]
C v179,v186,v187
C v196,v196,v197
M v[252:255],a[244:247],a[188:191],v[252:255]
s_waitcnt lgkmcnt(0)
C v197,v198,v199
C v198,v204,v205
M v[248:251],a[244:247],a[156:159],v[248:251]
C v199,v206,v207
C v192,v192,v193
C v193,v194,v195
C v194,v200,v201
C v195,v202,v203
C v212,v212,v213
C v213,v214,v215
C v214,v220,v221
C v215,v222,v223
C v208,v208,v209
C v209,v210,v211
C v210,v216,v217
C v211,v218,v219
C v228,v228,v229
C v229,v230,v231
C v230,v236,v237
C v231,v238,v239
C v224,v224,v225
C v225,v226,v227
C v226,v232,v233
C v227,v234,v235
C v244,v244,v245
C v245,v246,v247
C v246,v252,v253
C v247,v254,v255
C v240,v240,v241
C v241,v242,v243
C v242,v248,v249
C v243,v250,v251
M v[64:67],a[64:67],v[128:131],0
s_sub_u32 s64, 15, s42
T a[96:97],v23,32768
T a[98:99],v23,34816
M v[64:67],a[68:71],v[144:147],v[64:67]
s_min_u32 s64, s64, s42
T a[100:101],v23,36864
T a[102:103],v23,38912
M v[64:67],a[72:75],v[160:163],v[64:67]
s_mul_i32 s45, s64, 8704
M v[64:67],a[76:79],v[176:179],v[64:67]
s_lshl_b32 s64, s41, 2
T a[104:105],v23,40960
T a[106:107],v23,43008
M v[64:67],a[80:83],v[192:195],v[64:67]
SA s45,s45,s64
T a[108:109],v23,45056
T a[110:111],v23,47104
M v[64:67],a[84:87],v[208:211],v[64:67]
s_lshl_b32 s64, s20, 8
M v[64:67],a[88:91],v[224:227],v[64:67]
SA s45,s45,s64
T a[112:113],v23,49152
T a[114:115],v23,51200
M v[64:67],a[92:95],v[240:243],v[64:67]
SA s45,s45,104992768
T a[116:117],v23,53248
T a[118:119],v23,55296
M v[68:71],a[92:95],v[244:247],0
s_mov_b32 s64, 1024
M v[68:71],a[88:91],v[228:231],v[68:71]
s_mov_b32 s66, 4096
T a[120:121],v23,57344
T a[122:123],v23,59392
M v[68:71],a[84:87],v[212:215],v[68:71]
s_cmp_lt_u32 s42, 8
T a[124:125],v23,61440
T a[126:127],v23,63488
M v[68:71],a[80:83],v[196:199],v[68:71]
s_cselect_b32 s64, 4352, s64
M v[68:71],a[76:79],v[180:183],v[68:71]
s_cselect_b32 s65, 0, 64
M v[68:71],a[72:75],v[164:167],v[68:71]
s_cselect_b32 s66, 536870912, s66
M v[68:71],a[68:71],v[148:151],v[68:71]
SA s3,s45,s64
M v[68:71],a[64:67],v[132:135],v[68:71]
s_waitcnt lgkmcnt(0)
M v[72:75],a[96:99],v[128:131],0
SA s45,s45,s65
T a[64:65],v24,32768
T a[66:67],v24,34816
M v[72:75],a[100:103],v[144:147],v[72:75]
SA m0,s28,69632
T a[68:69],v24,36864
T a[70:71],v24,38912
M v[72:75],a[104:107],v[160:163],v[72:75]
SA s85,s38,28672
buffer_load_dwordx4 v0, s[12:15], s85 offen offset:0 lds
M v[72:75],a[108:111],v[176:179],v[72:75]
SA s85,s38,34816
T a[72:73],v24,40960
T a[74:75],v24,43008
M v[72:75],a[112:115],v[192:195],v[72:75]
SA s29,s33,0
T a[76:77],v24,45056
T a[78:79],v24,47104
M v[72:75],a[116:119],v[208:211],v[72:75]
SA s30,s33,14336
buffer_load_dwordx4 v0, s[12:15], s85 offen offset:1024 lds
M v[72:75],a[120:123],v[224:227],v[72:75]
SA s85,s38,40960
T a[80:81],v24,49152
T a[82:83],v24,51200
M v[72:75],a[124:127],v[240:243],v[72:75]
T a[84:85],v24,53248
T a[86:87],v24,55296
M v[76:79],a[124:127],v[244:247],0
buffer_load_dwordx4 v0, s[12:15], s85 offen offset:2048 lds
M v[76:79],a[120:123],v[228:231],v[76:79]
SA s85,s38,47104
T a[88:89],v24,57344
T a[90:91],v24,59392
M v[76:79],a[116:119],v[212:215],v[76:79]
T a[92:93],v24,61440
T a[94:95],v24,63488
M v[76:79],a[112:115],v[196:199],v[76:79]
buffer_load_dwordx4 v0, s[12:15], s85 offen offset:3072 lds
M v[76:79],a[108:111],v[180:183],v[76:79]
SA s38,s38,128
v_lshrrev_b32 v17, 5, v7
v_min_u32 v15, 1, v17
M v[76:79],a[104:107],v[164:167],v[76:79]
SA m0,s28,0
v_lshlrev_b32 v14, 3, v7
v_lshl_or_b32 v16, v15, 29, v14
M v[76:79],a[100:103],v[148:151],v[76:79]
SA s85,s38,0
buffer_load_dwordx4 v0, s[12:15], s85 offen offset:0 lds
M v[76:79],a[96:99],v[132:135],v[76:79]
s_waitcnt lgkmcnt(0)
v_cmp_eq_u32 vcc, 1, v17
v_add_u32 v14, s66, v14
M v[80:83],a[64:67],v[128:131],0
SA s85,s38,6144
T a[96:97],v25,32768
T a[98:99],v25,34816
M v[80:83],a[68:71],v[144:147],v[80:83]
T a[100:101],v25,36864
T a[102:103],v25,38912
M v[80:83],a[72:75],v[160:163],v[80:83]
buffer_load_dwordx4 v0, s[12:15], s85 offen offset:1024 lds
M v[80:83],a[76:79],v[176:179],v[80:83]
SA s85,s38,12288
T a[104:105],v25,40960
T a[106:107],v25,43008
M v[80:83],a[80:83],v[192:195],v[80:83]
T a[108:109],v25,45056
T a[110:111],v25,47104
M v[80:83],a[84:87],v[208:211],v[80:83]
buffer_load_dwordx4 v0, s[12:15], s85 offen offset:2048 lds
M v[80:83],a[88:91],v[224:227],v[80:83]
SA s85,s38,18432
T a[112:113],v25,49152
T a[114:115],v25,51200
M v[80:83],a[92:95],v[240:243],v[80:83]
T a[116:117],v25,53248
T a[118:119],v25,55296
M v[84:87],a[92:95],v[244:247],0
buffer_load_dwordx4 v0, s[12:15], s85 offen offset:3072 lds
M v[84:87],a[88:91],v[228:231],v[84:87]
SA m0,s28,4096
T a[120:121],v25,57344
T a[122:123],v25,59392
M v[84:87],a[84:87],v[212:215],v[84:87]
SA s85,s38,28672
T a[124:125],v25,61440
T a[126:127],v25,63488
M v[84:87],a[80:83],v[196:199],v[84:87]
buffer_load_dwordx4 v0, s[12:15], s85 offen offset:0 lds
M v[84:87],a[76:79],v[180:183],v[84:87]
SA s85,s38,34816
v_mov_b32 v15, 1
v_cndmask_b32 v17, v16, v14, vcc
M v[84:87],a[72:75],v[164:167],v[84:87]
buffer_load_dwordx4 v0, s[12:15], s85 offen offset:1024 lds
M v[84:87],a[68:71],v[148:151],v[84:87]
s_waitcnt vmcnt(14) lgkmcnt(0)
v_add_u32 v40, 0x20000, v18
v_add_u32 v41, 0x20000, v19
M v[84:87],a[64:67],v[132:135],v[84:87]
s_barrier
M v[88:91],a[96:99],v[128:131],0
SA s85,s38,40960
T a[64:65],v18,32768
T a[66:67],v18,34816
M v[88:91],a[100:103],v[144:147],v[88:91]
T a[68:69],v18,36864
T a[70:71],v18,38912
M v[88:91],a[104:107],v[160:163],v[88:91]
buffer_load_dwordx4 v0, s[12:15], s85 offen offset:2048 lds
M v[88:91],a[108:111],v[176:179],v[88:91]
SA s85,s38,47104
T a[72:73],v18,40960
T a[74:75],v18,43008
M v[88:91],a[112:115],v[192:195],v[88:91]
T a[76:77],v18,45056
T a[78:79],v18,47104
M v[88:91],a[116:119],v[208:211],v[88:91]
buffer_load_dwordx4 v0, s[12:15], s85 offen offset:3072 lds
M v[88:91],a[120:123],v[224:227],v[88:91]
SA s38,s38,128
T a[80:81],v18,49152
T a[82:83],v18,51200
M v[88:91],a[124:127],v[240:243],v[88:91]
SA m0,s28,131072
T a[84:85],v18,53248
T a[86:87],v18,55296
M v[92:95],a[124:127],v[244:247],0
SA s85,s38,0
buffer_load_dwordx4 v0, s[12:15], s85 offen offset:0 lds
M v[92:95],a[120:123],v[228:231],v[92:95]
SA s85,s38,6144
T a[88:89],v18,57344
T a[90:91],v18,59392
M v[92:95],a[116:119],v[212:215],v[92:95]
T a[92:93],v18,61440
T a[94:95],v18,63488
M v[92:95],a[112:115],v[196:199],v[92:95]
buffer_load_dwordx4 v0, s[12:15], s85 offen offset:1024 lds
M v[92:95],a[108:111],v[180:183],v[92:95]
SA s85,s38,12288
v_add_u32 v42, 0x20000, v20
v_add_u32 v43, 0x20000, v21
M v[92:95],a[104:107],v[164:167],v[92:95]
buffer_load_dwordx4 v0, s[12:15], s85 offen offset:2048 lds
M v[92:95],a[100:103],v[148:151],v[92:95]
s_waitcnt lgkmcnt(0)
MF v64,v5,v64
MF v65,v5,v65
M v[92:95],a[96:99],v[132:135],v[92:95]
SA s85,s38,18432
MF v66,v5,v66
MF v67,v5,v67
MF v72,v5,v72
MF v73,v5,v73
MF v74,v5,v74
MF v75,v5,v75
C v64,v64,v65
C v65,v66,v67
C v66,v72,v73
C v67,v74,v75
buffer_store_dwordx4 v[64:67], v7, s[8:11], s29 offen offset:0 sc1
MF v68,v6,v68
MF v69,v6,v69
MF v70,v6,v70
MF v71,v6,v71
MF v76,v6,v76
MF v77,v6,v77
MF v78,v6,v78
MF v79,v6,v79
C v68,v68,v69
C v69,v70,v71
C v70,v76,v77
C v71,v78,v79
buffer_store_dwordx4 v[68:71], v7, s[8:11], s30 offen offset:0 sc1
buffer_load_dwordx4 v0, s[12:15], s85 offen offset:3072 lds
M v[96:99],a[64:67],v[128:131],0
s_nop 0
T a[96:97],v19,32768
T a[98:99],v19,34816
M v[96:99],a[68:71],v[144:147],v[96:99]
SA m0,s28,135168
T a[100:101],v19,36864
T a[102:103],v19,38912
M v[96:99],a[72:75],v[160:163],v[96:99]
SA s85,s38,28672
buffer_load_dwordx4 v0, s[12:15], s85 offen offset:0 lds
M v[96:99],a[76:79],v[176:179],v[96:99]
SA s85,s38,34816
T a[104:105],v19,40960
T a[106:107],v19,43008
M v[96:99],a[80:83],v[192:195],v[96:99]
T a[108:109],v19,45056
T a[110:111],v19,47104
M v[96:99],a[84:87],v[208:211],v[96:99]
buffer_load_dwordx4 v0, s[12:15], s85 offen offset:1024 lds
M v[96:99],a[88:91],v[224:227],v[96:99]
s_nop 0
T a[112:113],v19,49152
T a[114:115],v19,51200
M v[96:99],a[92:95],v[240:243],v[96:99]
SA s85,s38,40960
T a[116:117],v19,53248
T a[118:119],v19,55296
M v[100:103],a[92:95],v[244:247],0
buffer_load_dwordx4 v0, s[12:15], s85 offen offset:2048 lds
M v[100:103],a[88:91],v[228:231],v[100:103]
s_nop 0
T a[120:121],v19,57344
T a[122:123],v19,59392
M v[100:103],a[84:87],v[212:215],v[100:103]
T a[124:125],v19,61440
T a[126:127],v19,63488
M v[100:103],a[80:83],v[196:199],v[100:103]
SA s85,s38,47104
MF v80,v5,v80
MF v81,v5,v81
M v[100:103],a[76:79],v[180:183],v[100:103]
buffer_load_dwordx4 v0, s[12:15], s85 offen offset:3072 lds
M v[100:103],a[72:75],v[164:167],v[100:103]
SA s38,s38,128
MF v82,v5,v82
MF v83,v5,v83
M v[100:103],a[68:71],v[148:151],v[100:103]
SA m0,s28,98304
MF v88,v5,v88
MF v89,v5,v89
M v[100:103],a[64:67],v[132:135],v[100:103]
s_waitcnt lgkmcnt(0)
MF v90,v5,v90
MF v91,v5,v91
M v[104:107],a[96:99],v[128:131],0
SA s85,s38,0
T a[64:65],v20,32768
T a[66:67],v20,34816
M v[104:107],a[100:103],v[144:147],v[104:107]
T a[68:69],v20,36864
T a[70:71],v20,38912
M v[104:107],a[104:107],v[160:163],v[104:107]
buffer_load_dwordx4 v0, s[12:15], s85 offen offset:0 lds
M v[104:107],a[108:111],v[176:179],v[104:107]
SA s85,s38,6144
T a[72:73],v20,40960
T a[74:75],v20,43008
M v[104:107],a[112:115],v[192:195],v[104:107]
T a[76:77],v20,45056
T a[78:79],v20,47104
M v[104:107],a[116:119],v[208:211],v[104:107]
buffer_load_dwordx4 v0, s[12:15], s85 offen offset:1024 lds
M v[104:107],a[120:123],v[224:227],v[104:107]
SA s85,s38,12288
T a[80:81],v20,49152
T a[82:83],v20,51200
M v[104:107],a[124:127],v[240:243],v[104:107]
T a[84:85],v20,53248
T a[86:87],v20,55296
M v[108:111],a[124:127],v[244:247],0
buffer_load_dwordx4 v0, s[12:15], s85 offen offset:2048 lds
M v[108:111],a[120:123],v[228:231],v[108:111]
SA s85,s38,18432
T a[88:89],v20,57344
T a[90:91],v20,59392
M v[108:111],a[116:119],v[212:215],v[108:111]
T a[92:93],v20,61440
T a[94:95],v20,63488
M v[108:111],a[112:115],v[196:199],v[108:111]
buffer_load_dwordx4 v0, s[12:15], s85 offen offset:3072 lds
M v[108:111],a[108:111],v[180:183],v[108:111]
SA m0,s28,102400
C v80,v80,v81
C v81,v82,v83
M v[108:111],a[104:107],v[164:167],v[108:111]
SA s85,s38,28672
C v82,v88,v89
C v83,v90,v91
M v[108:111],a[100:103],v[148:151],v[108:111]
buffer_store_dwordx4 v[80:83], v7, s[8:11], s29 offen offset:1024 sc1
M v[108:111],a[96:99],v[132:135],v[108:111]
s_waitcnt lgkmcnt(0)
MF v84,v6,v84
MF v85,v6,v85
M v[112:115],a[64:67],v[128:131],0
T a[96:97],v21,32768
T a[98:99],v21,34816
M v[112:115],a[68:71],v[144:147],v[112:115]
T a[100:101],v21,36864
T a[102:103],v21,38912
M v[112:115],a[72:75],v[160:163],v[112:115]
buffer_load_dwordx4 v0, s[12:15], s85 offen offset:0 lds
M v[112:115],a[76:79],v[176:179],v[112:115]
SA s85,s38,34816
T a[104:105],v21,40960
T a[106:107],v21,43008
M v[112:115],a[80:83],v[192:195],v[112:115]
T a[108:109],v21,45056
T a[110:111],v21,47104
M v[112:115],a[84:87],v[208:211],v[112:115]
buffer_load_dwordx4 v0, s[12:15], s85 offen offset:1024 lds
M v[112:115],a[88:91],v[224:227],v[112:115]
SA s85,s38,40960
T a[112:113],v21,49152
T a[114:115],v21,51200
M v[112:115],a[92:95],v[240:243],v[112:115]
T a[116:117],v21,53248
T a[118:119],v21,55296
M v[116:119],a[92:95],v[244:247],0
buffer_load_dwordx4 v0, s[12:15], s85 offen offset:2048 lds
M v[116:119],a[88:91],v[228:231],v[116:119]
SA s85,s38,47104
T a[120:121],v21,57344
T a[122:123],v21,59392
M v[116:119],a[84:87],v[212:215],v[116:119]
T a[124:125],v21,61440
T a[126:127],v21,63488
M v[116:119],a[80:83],v[196:199],v[116:119]
buffer_load_dwordx4 v0, s[12:15], s85 offen offset:3072 lds
M v[116:119],a[76:79],v[180:183],v[116:119]
MF v86,v6,v86
MF v87,v6,v87
M v[116:119],a[72:75],v[164:167],v[116:119]
SA s38,s38,128
MF v92,v6,v92
MF v93,v6,v93
M v[116:119],a[68:71],v[148:151],v[116:119]
s_waitcnt vmcnt(27) lgkmcnt(0)
MF v94,v6,v94
MF v95,v6,v95
M v[116:119],a[64:67],v[132:135],v[116:119]
s_barrier
M v[120:123],a[96:99],v[128:131],0
s_nop 0
T a[64:65],v22,0
T a[66:67],v22,2048
M v[120:123],a[100:103],v[144:147],v[120:123]
T a[68:69],v22,4096
T a[70:71],v22,6144
M v[120:123],a[104:107],v[160:163],v[120:123]
C v84,v84,v85
C v85,v86,v87
M v[120:123],a[108:111],v[176:179],v[120:123]
T a[72:73],v22,8192
T a[74:75],v22,10240
M v[120:123],a[112:115],v[192:195],v[120:123]
T a[76:77],v22,12288
T a[78:79],v22,14336
M v[120:123],a[116:119],v[208:211],v[120:123]
C v86,v92,v93
C v87,v94,v95
M v[120:123],a[120:123],v[224:227],v[120:123]
T a[80:81],v22,16384
T a[82:83],v22,18432
M v[120:123],a[124:127],v[240:243],v[120:123]
T a[84:85],v22,20480
T a[86:87],v22,22528
M v[124:127],a[124:127],v[244:247],0
buffer_store_dwordx4 v[84:87], v7, s[8:11], s30 offen offset:1024 sc1
M v[124:127],a[120:123],v[228:231],v[124:127]
SA s29,s33,2048
T a[88:89],v22,24576
T a[90:91],v22,26624
M v[124:127],a[116:119],v[212:215],v[124:127]
SA s30,s33,16384
T a[92:93],v22,28672
T a[94:95],v22,30720
M v[124:127],a[112:115],v[196:199],v[124:127]
MF v96,v5,v96
MF v97,v5,v97
M v[124:127],a[108:111],v[180:183],v[124:127]
MF v98,v5,v98
MF v99,v5,v99
M v[124:127],a[104:107],v[164:167],v[124:127]
MF v104,v5,v104
MF v105,v5,v105
M v[124:127],a[100:103],v[148:151],v[124:127]
s_waitcnt lgkmcnt(0)
MF v106,v5,v106
MF v107,v5,v107
M v[124:127],a[96:99],v[132:135],v[124:127]
C v96,v96,v97
C v97,v98,v99
C v98,v104,v105
C v99,v106,v107
buffer_store_dwordx4 v[96:99], v7, s[8:11], s29 offen offset:0 sc1
MF v100,v6,v100
MF v101,v6,v101
MF v102,v6,v102
MF v103,v6,v103
MF v108,v6,v108
MF v109,v6,v109
MF v110,v6,v110
MF v111,v6,v111
C v100,v100,v101
C v101,v102,v103
C v102,v108,v109
C v103,v110,v111
buffer_store_dwordx4 v[100:103], v7, s[8:11], s30 offen offset:0 sc1
M v[64:67],a[64:67],v[128:131],0
s_nop 0
T a[96:97],v23,0
T a[98:99],v23,2048
M v[64:67],a[68:71],v[144:147],v[64:67]
SA m0,s28,32768
T a[100:101],v23,4096
T a[102:103],v23,6144
M v[64:67],a[72:75],v[160:163],v[64:67]
SA s85,s38,0
buffer_load_dwordx4 v0, s[12:15], s85 offen offset:0 lds
M v[64:67],a[76:79],v[176:179],v[64:67]
s_nop 0
T a[104:105],v23,8192
T a[106:107],v23,10240
M v[64:67],a[80:83],v[192:195],v[64:67]
T a[108:109],v23,12288
T a[110:111],v23,14336
M v[64:67],a[84:87],v[208:211],v[64:67]
SA s85,s38,6144
MF v112,v5,v112
MF v113,v5,v113
M v[64:67],a[88:91],v[224:227],v[64:67]
T a[112:113],v23,16384
T a[114:115],v23,18432
M v[64:67],a[92:95],v[240:243],v[64:67]
T a[116:117],v23,20480
T a[118:119],v23,22528
M v[68:71],a[92:95],v[244:247],0
buffer_load_dwordx4 v0, s[12:15], s85 offen offset:1024 lds
M v[68:71],a[88:91],v[228:231],v[68:71]
s_nop 0
T a[120:121],v23,24576
T a[122:123],v23,26624
M v[68:71],a[84:87],v[212:215],v[68:71]
T a[124:125],v23,28672
T a[126:127],v23,30720
M v[68:71],a[80:83],v[196:199],v[68:71]
SA s85,s38,12288
MF v114,v5,v114
MF v115,v5,v115
M v[68:71],a[76:79],v[180:183],v[68:71]
buffer_load_dwordx4 v0, s[12:15], s85 offen offset:2048 lds
M v[68:71],a[72:75],v[164:167],v[68:71]
MF v120,v5,v120
MF v121,v5,v121
M v[68:71],a[68:71],v[148:151],v[68:71]
MF v122,v5,v122
MF v123,v5,v123
M v[68:71],a[64:67],v[132:135],v[68:71]
s_waitcnt lgkmcnt(0)
C v112,v112,v113
C v113,v114,v115
M v[72:75],a[96:99],v[128:131],0
SA s85,s38,18432
T a[64:65],v24,0
T a[66:67],v24,2048
M v[72:75],a[100:103],v[144:147],v[72:75]
T a[68:69],v24,4096
T a[70:71],v24,6144
M v[72:75],a[104:107],v[160:163],v[72:75]
buffer_load_dwordx4 v0, s[12:15], s85 offen offset:3072 lds
M v[72:75],a[108:111],v[176:179],v[72:75]
s_nop 0
T a[72:73],v24,8192
T a[74:75],v24,10240
M v[72:75],a[112:115],v[192:195],v[72:75]
T a[76:77],v24,12288
T a[78:79],v24,14336
M v[72:75],a[116:119],v[208:211],v[72:75]
SA m0,s28,36864
C v114,v120,v121
C v115,v122,v123
M v[72:75],a[120:123],v[224:227],v[72:75]
SA s85,s38,28672
T a[80:81],v24,16384
T a[82:83],v24,18432
M v[72:75],a[124:127],v[240:243],v[72:75]
T a[84:85],v24,20480
T a[86:87],v24,22528
M v[76:79],a[124:127],v[244:247],0
buffer_store_dwordx4 v[112:115], v7, s[8:11], s29 offen offset:1024 sc1
M v[76:79],a[120:123],v[228:231],v[76:79]
s_nop 0
T a[88:89],v24,24576
T a[90:91],v24,26624
M v[76:79],a[116:119],v[212:215],v[76:79]
T a[92:93],v24,28672
T a[94:95],v24,30720
M v[76:79],a[112:115],v[196:199],v[76:79]
buffer_load_dwordx4 v0, s[12:15], s85 offen offset:0 lds
M v[76:79],a[108:111],v[180:183],v[76:79]
SA s85,s38,34816
MF v116,v6,v116
MF v117,v6,v117
M v[76:79],a[104:107],v[164:167],v[76:79]
MF v118,v6,v118
MF v119,v6,v119
M v[76:79],a[100:103],v[148:151],v[76:79]
buffer_load_dwordx4 v0, s[12:15], s85 offen offset:1024 lds
M v[76:79],a[96:99],v[132:135],v[76:79]
s_waitcnt lgkmcnt(0)
MF v124,v6,v124
MF v125,v6,v125
M v[80:83],a[64:67],v[128:131],0
T a[96:97],v25,0
T a[98:99],v25,2048
M v[80:83],a[68:71],v[144:147],v[80:83]
SA s85,s38,40960
T a[100:101],v25,4096
T a[102:103],v25,6144
M v[80:83],a[72:75],v[160:163],v[80:83]
buffer_load_dwordx4 v0, s[12:15], s85 offen offset:2048 lds
M v[80:83],a[76:79],v[176:179],v[80:83]
s_nop 0
T a[104:105],v25,8192
T a[106:107],v25,10240
M v[80:83],a[80:83],v[192:195],v[80:83]
T a[108:109],v25,12288
T a[110:111],v25,14336
M v[80:83],a[84:87],v[208:211],v[80:83]
MF v126,v6,v126
MF v127,v6,v127
M v[80:83],a[88:91],v[224:227],v[80:83]
SA s85,s38,47104
T a[112:113],v25,16384
T a[114:115],v25,18432
M v[80:83],a[92:95],v[240:243],v[80:83]
T a[116:117],v25,20480
T a[118:119],v25,22528
M v[84:87],a[92:95],v[244:247],0
buffer_load_dwordx4 v0, s[12:15], s85 offen offset:3072 lds
M v[84:87],a[88:91],v[228:231],v[84:87]
s_nop 0
T a[120:121],v25,24576
T a[122:123],v25,26624
M v[84:87],a[84:87],v[212:215],v[84:87]
T a[124:125],v25,28672
T a[126:127],v25,30720
M v[84:87],a[80:83],v[196:199],v[84:87]
C v116,v116,v117
C v117,v118,v119
M v[84:87],a[76:79],v[180:183],v[84:87]
C v118,v124,v125
C v119,v126,v127
M v[84:87],a[72:75],v[164:167],v[84:87]
SA s38,s38,128
buffer_store_dwordx4 v[116:119], v7, s[8:11], s30 offen offset:1024 sc1
M v[84:87],a[68:71],v[148:151],v[84:87]
s_waitcnt vmcnt(32) lgkmcnt(0)
M v[84:87],a[64:67],v[132:135],v[84:87]
s_barrier
M v[88:91],a[96:99],v[128:131],0
SA s29,s33,4096
T a[64:65],v18,0
T a[66:67],v18,2048
M v[88:91],a[100:103],v[144:147],v[88:91]
SA s30,s33,18432
T a[68:69],v18,4096
T a[70:71],v18,6144
M v[88:91],a[104:107],v[160:163],v[88:91]
MF v64,v5,v64
MF v65,v5,v65
M v[88:91],a[108:111],v[176:179],v[88:91]
T a[72:73],v18,8192
T a[74:75],v18,10240
M v[88:91],a[112:115],v[192:195],v[88:91]
T a[76:77],v18,12288
T a[78:79],v18,14336
M v[88:91],a[116:119],v[208:211],v[88:91]
MF v66,v5,v66
MF v67,v5,v67
M v[88:91],a[120:123],v[224:227],v[88:91]
T a[80:81],v18,16384
T a[82:83],v18,18432
M v[88:91],a[124:127],v[240:243],v[88:91]
T a[84:85],v18,20480
T a[86:87],v18,22528
M v[92:95],a[124:127],v[244:247],0
MF v72,v5,v72
MF v73,v5,v73
M v[92:95],a[120:123],v[228:231],v[92:95]
T a[88:89],v18,24576
T a[90:91],v18,26624
M v[92:95],a[116:119],v[212:215],v[92:95]
T a[92:93],v18,28672
T a[94:95],v18,30720
M v[92:95],a[112:115],v[196:199],v[92:95]
MF v74,v5,v74
MF v75,v5,v75
M v[92:95],a[108:111],v[180:183],v[92:95]
C v64,v64,v65
C v65,v66,v67
M v[92:95],a[104:107],v[164:167],v[92:95]
C v66,v72,v73
C v67,v74,v75
M v[92:95],a[100:103],v[148:151],v[92:95]
s_waitcnt lgkmcnt(0)
buffer_store_dwordx4 v[64:67], v7, s[8:11], s29 offen offset:0 sc1
M v[92:95],a[96:99],v[132:135],v[92:95]
MF v68,v6,v68
MF v69,v6,v69
MF v70,v6,v70
MF v71,v6,v71
MF v76,v6,v76
MF v77,v6,v77
MF v78,v6,v78
MF v79,v6,v79
C v68,v68,v69
C v69,v70,v71
C v70,v76,v77
C v71,v78,v79
buffer_store_dwordx4 v[68:71], v7, s[8:11], s30 offen offset:0 sc1
M v[96:99],a[64:67],v[128:131],0
s_nop 0
T a[96:97],v19,0
T a[98:99],v19,2048
M v[96:99],a[68:71],v[144:147],v[96:99]
T a[100:101],v19,4096
T a[102:103],v19,6144
M v[96:99],a[72:75],v[160:163],v[96:99]
MF v80,v5,v80
MF v81,v5,v81
M v[96:99],a[76:79],v[176:179],v[96:99]
T a[104:105],v19,8192
T a[106:107],v19,10240
M v[96:99],a[80:83],v[192:195],v[96:99]
T a[108:109],v19,12288
T a[110:111],v19,14336
M v[96:99],a[84:87],v[208:211],v[96:99]
MF v82,v5,v82
MF v83,v5,v83
M v[96:99],a[88:91],v[224:227],v[96:99]
T a[112:113],v19,16384
T a[114:115],v19,18432
M v[96:99],a[92:95],v[240:243],v[96:99]
T a[116:117],v19,20480
T a[118:119],v19,22528
M v[100:103],a[92:95],v[244:247],0
MF v88,v5,v88
MF v89,v5,v89
M v[100:103],a[88:91],v[228:231],v[100:103]
T a[120:121],v19,24576
T a[122:123],v19,26624
M v[100:103],a[84:87],v[212:215],v[100:103]
T a[124:125],v19,28672
T a[126:127],v19,30720
M v[100:103],a[80:83],v[196:199],v[100:103]
MF v90,v5,v90
MF v91,v5,v91
M v[100:103],a[76:79],v[180:183],v[100:103]
C v80,v80,v81
C v81,v82,v83
M v[100:103],a[72:75],v[164:167],v[100:103]
C v82,v88,v89
C v83,v90,v91
M v[100:103],a[68:71],v[148:151],v[100:103]
buffer_store_dwordx4 v[80:83], v7, s[8:11], s29 offen offset:1024 sc1
M v[100:103],a[64:67],v[132:135],v[100:103]
s_waitcnt lgkmcnt(0)
MF v84,v6,v84
MF v85,v6,v85
M v[104:107],a[96:99],v[128:131],0
T a[64:65],v20,0
T a[66:67],v20,2048
M v[104:107],a[100:103],v[144:147],v[104:107]
T a[68:69],v20,4096
T a[70:71],v20,6144
M v[104:107],a[104:107],v[160:163],v[104:107]
MF v86,v6,v86
MF v87,v6,v87
M v[104:107],a[108:111],v[176:179],v[104:107]
T a[72:73],v20,8192
T a[74:75],v20,10240
M v[104:107],a[112:115],v[192:195],v[104:107]
T a[76:77],v20,12288
T a[78:79],v20,14336
M v[104:107],a[116:119],v[208:211],v[104:107]
MF v92,v6,v92
MF v93,v6,v93
M v[104:107],a[120:123],v[224:227],v[104:107]
T a[80:81],v20,16384
T a[82:83],v20,18432
M v[104:107],a[124:127],v[240:243],v[104:107]
T a[84:85],v20,20480
T a[86:87],v20,22528
M v[108:111],a[124:127],v[244:247],0
MF v94,v6,v94
MF v95,v6,v95
M v[108:111],a[120:123],v[228:231],v[108:111]
T a[88:89],v20,24576
T a[90:91],v20,26624
M v[108:111],a[116:119],v[212:215],v[108:111]
T a[92:93],v20,28672
T a[94:95],v20,30720
M v[108:111],a[112:115],v[196:199],v[108:111]
C v84,v84,v85
C v85,v86,v87
M v[108:111],a[108:111],v[180:183],v[108:111]
C v86,v92,v93
C v87,v94,v95
M v[108:111],a[104:107],v[164:167],v[108:111]
buffer_store_dwordx4 v[84:87], v7, s[8:11], s30 offen offset:1024 sc1
M v[108:111],a[100:103],v[148:151],v[108:111]
SA s29,s33,6144
M v[108:111],a[96:99],v[132:135],v[108:111]
s_waitcnt lgkmcnt(0)
M v[112:115],a[64:67],v[128:131],0
SA s30,s33,20480
T a[96:97],v21,0
T a[98:99],v21,2048
M v[112:115],a[68:71],v[144:147],v[112:115]
T a[100:101],v21,4096
T a[102:103],v21,6144
M v[112:115],a[72:75],v[160:163],v[112:115]
MF v96,v5,v96
MF v97,v5,v97
M v[112:115],a[76:79],v[176:179],v[112:115]
T a[104:105],v21,8192
T a[106:107],v21,10240
M v[112:115],a[80:83],v[192:195],v[112:115]
T a[108:109],v21,12288
T a[110:111],v21,14336
M v[112:115],a[84:87],v[208:211],v[112:115]
MF v98,v5,v98
MF v99,v5,v99
M v[112:115],a[88:91],v[224:227],v[112:115]
T a[112:113],v21,16384
T a[114:115],v21,18432
M v[112:115],a[92:95],v[240:243],v[112:115]
T a[116:117],v21,20480
T a[118:119],v21,22528
M v[116:119],a[92:95],v[244:247],0
MF v104,v5,v104
MF v105,v5,v105
M v[116:119],a[88:91],v[228:231],v[116:119]
T a[120:121],v21,24576
T a[122:123],v21,26624
M v[116:119],a[84:87],v[212:215],v[116:119]
T a[124:125],v21,28672
T a[126:127],v21,30720
M v[116:119],a[80:83],v[196:199],v[116:119]
MF v106,v5,v106
MF v107,v5,v107
M v[116:119],a[76:79],v[180:183],v[116:119]
C v96,v96,v97
C v97,v98,v99
M v[116:119],a[72:75],v[164:167],v[116:119]
C v98,v104,v105
C v99,v106,v107
M v[116:119],a[68:71],v[148:151],v[116:119]
s_waitcnt vmcnt(26) lgkmcnt(0)
buffer_store_dwordx4 v[96:99], v7, s[8:11], s29 offen offset:0 sc1
M v[116:119],a[64:67],v[132:135],v[116:119]
s_barrier
M v[120:123],a[96:99],v[128:131],0
s_nop 0
T a[64:65],v40,0
T a[66:67],v40,2048
M v[120:123],a[100:103],v[144:147],v[120:123]
T a[68:69],v40,4096
T a[70:71],v40,6144
M v[120:123],a[104:107],v[160:163],v[120:123]
MF v100,v6,v100
MF v101,v6,v101
M v[120:123],a[108:111],v[176:179],v[120:123]
T a[72:73],v40,8192
T a[74:75],v40,10240
M v[120:123],a[112:115],v[192:195],v[120:123]
T a[76:77],v40,12288
T a[78:79],v40,14336
M v[120:123],a[116:119],v[208:211],v[120:123]
MF v102,v6,v102
MF v103,v6,v103
M v[120:123],a[120:123],v[224:227],v[120:123]
T a[80:81],v40,16384
T a[82:83],v40,18432
M v[120:123],a[124:127],v[240:243],v[120:123]
T a[84:85],v40,20480
T a[86:87],v40,22528
M v[124:127],a[124:127],v[244:247],0
MF v108,v6,v108
MF v109,v6,v109
M v[124:127],a[120:123],v[228:231],v[124:127]
T a[88:89],v40,24576
T a[90:91],v40,26624
M v[124:127],a[116:119],v[212:215],v[124:127]
T a[92:93],v40,28672
T a[94:95],v40,30720
M v[124:127],a[112:115],v[196:199],v[124:127]
MF v110,v6,v110
MF v111,v6,v111
M v[124:127],a[108:111],v[180:183],v[124:127]
C v100,v100,v101
C v101,v102,v103
M v[124:127],a[104:107],v[164:167],v[124:127]
C v102,v108,v109
C v103,v110,v111
M v[124:127],a[100:103],v[148:151],v[124:127]
s_waitcnt lgkmcnt(0)
buffer_store_dwordx4 v[100:103], v7, s[8:11], s30 offen offset:0 sc1
M v[124:127],a[96:99],v[132:135],v[124:127]
M v[64:67],a[64:67],v[128:131],0
s_nop 0
T a[96:97],v41,0
T a[98:99],v41,2048
M v[64:67],a[68:71],v[144:147],v[64:67]
T a[100:101],v41,4096
T a[102:103],v41,6144
M v[64:67],a[72:75],v[160:163],v[64:67]
v_lshrrev_b32 v32, 4, v7
MF v112,v5,v112
M v[64:67],a[76:79],v[176:179],v[64:67]
s_lshr_b32 s74, s41, 3
T a[104:105],v41,8192
T a[106:107],v41,10240
M v[64:67],a[80:83],v[192:195],v[64:67]
s_sub_u32 s64, 15, s42
T a[108:109],v41,12288
T a[110:111],v41,14336
M v[64:67],a[84:87],v[208:211],v[64:67]
s_mul_i32 s46, s64, 8704
MF v113,v5,v113
MF v114,v5,v114
M v[64:67],a[88:91],v[224:227],v[64:67]
s_and_b32 s72, s41, 7
T a[112:113],v41,16384
T a[114:115],v41,18432
M v[64:67],a[92:95],v[240:243],v[64:67]
s_lshl_b32 s65, s72, 7
T a[116:117],v41,20480
T a[118:119],v41,22528
M v[68:71],a[92:95],v[244:247],0
SA s46,s46,s65
MF v115,v5,v115
MF v120,v5,v120
M v[68:71],a[88:91],v[228:231],v[68:71]
SA s46,s46,104993792
T a[120:121],v41,24576
T a[122:123],v41,26624
M v[68:71],a[84:87],v[212:215],v[68:71]
T a[124:125],v41,28672
T a[126:127],v41,30720
M v[68:71],a[80:83],v[196:199],v[68:71]
v_and_b32 v33, 31, v32
MF v121,v5,v121
M v[68:71],a[76:79],v[180:183],v[68:71]
MF v122,v5,v122
MF v123,v5,v123
M v[68:71],a[72:75],v[164:167],v[68:71]
C v112,v112,v113
C v113,v114,v115
M v[68:71],a[68:71],v[148:151],v[68:71]
C v114,v120,v121
C v115,v122,v123
M v[68:71],a[64:67],v[132:135],v[68:71]
s_waitcnt lgkmcnt(0)
buffer_store_dwordx4 v[112:115], v7, s[8:11], s29 offen offset:1024 sc1
M v[72:75],a[96:99],v[128:131],0
s_nop 0
T a[64:65],v42,0
T a[66:67],v42,2048
M v[72:75],a[100:103],v[144:147],v[72:75]
T a[68:69],v42,4096
T a[70:71],v42,6144
M v[72:75],a[104:107],v[160:163],v[72:75]
MF v116,v6,v116
MF v117,v6,v117
M v[72:75],a[108:111],v[176:179],v[72:75]
T a[72:73],v42,8192
T a[74:75],v42,10240
M v[72:75],a[112:115],v[192:195],v[72:75]
T a[76:77],v42,12288
T a[78:79],v42,14336
M v[72:75],a[116:119],v[208:211],v[72:75]
MF v118,v6,v118
MF v119,v6,v119
M v[72:75],a[120:123],v[224:227],v[72:75]
T a[80:81],v42,16384
T a[82:83],v42,18432
M v[72:75],a[124:127],v[240:243],v[72:75]
T a[84:85],v42,20480
T a[86:87],v42,22528
M v[76:79],a[124:127],v[244:247],0
MF v124,v6,v124
MF v125,v6,v125
M v[76:79],a[120:123],v[228:231],v[76:79]
T a[88:89],v42,24576
T a[90:91],v42,26624
M v[76:79],a[116:119],v[212:215],v[76:79]
T a[92:93],v42,28672
T a[94:95],v42,30720
M v[76:79],a[112:115],v[196:199],v[76:79]
MF v126,v6,v126
MF v127,v6,v127
M v[76:79],a[108:111],v[180:183],v[76:79]
C v116,v116,v117
C v117,v118,v119
M v[76:79],a[104:107],v[164:167],v[76:79]
C v118,v124,v125
C v119,v126,v127
M v[76:79],a[100:103],v[148:151],v[76:79]
buffer_store_dwordx4 v[116:119], v7, s[8:11], s30 offen offset:1024 sc1
M v[76:79],a[96:99],v[132:135],v[76:79]
s_waitcnt lgkmcnt(0)
v_lshlrev_b32 v33, 2, v33
M v[80:83],a[64:67],v[128:131],0
SA s29,s33,8192
T a[96:97],v43,0
T a[98:99],v43,2048
M v[80:83],a[68:71],v[144:147],v[80:83]
SA s30,s33,22528
T a[100:101],v43,4096
T a[102:103],v43,6144
M v[80:83],a[72:75],v[160:163],v[80:83]
s_lshl_b32 s65, s41, 7
MF v64,v5,v64
MF v65,v5,v65
M v[80:83],a[76:79],v[176:179],v[80:83]
SA s65,s65,104890368
T a[104:105],v43,8192
T a[106:107],v43,10240
M v[80:83],a[80:83],v[192:195],v[80:83]
T a[108:109],v43,12288
T a[110:111],v43,14336
M v[80:83],a[84:87],v[208:211],v[80:83]
buffer_load_dword v31, v33, s[8:11], s65 offen sc1
M v[80:83],a[88:91],v[224:227],v[80:83]
s_nop 0
T a[112:113],v43,16384
T a[114:115],v43,18432
M v[80:83],a[92:95],v[240:243],v[80:83]
T a[116:117],v43,20480
T a[118:119],v43,22528
M v[84:87],a[92:95],v[244:247],0
s_cmp_ge_u32 s42, 8
v_bfe_u32 v34, v32, 4, 1
v_lshlrev_b32 v34, 1, v34
M v[84:87],a[88:91],v[228:231],v[84:87]
s_cselect_b32 s84, s45, 536870912
T a[120:121],v43,24576
T a[122:123],v43,26624
M v[84:87],a[84:87],v[212:215],v[84:87]
T a[124:125],v43,28672
T a[126:127],v43,30720
M v[84:87],a[80:83],v[196:199],v[84:87]
v_lshrrev_b32 v35, 5, v32
v_add_u32 v34, v34, v35
M v[84:87],a[76:79],v[180:183],v[84:87]
s_mov_b32 s52, s96
MF v66,v5,v66
MF v67,v5,v67
M v[84:87],a[72:75],v[164:167],v[84:87]
s_and_b32 s53, s97, 0xffff
MF v72,v5,v72
MF v73,v5,v73
M v[84:87],a[68:71],v[148:151],v[84:87]
s_waitcnt vmcnt(22) lgkmcnt(0)
MF v74,v5,v74
MF v75,v5,v75
M v[84:87],a[64:67],v[132:135],v[84:87]
s_barrier
M v[88:91],a[96:99],v[128:131],0
s_mov_b32 s54, 1835008
T a[64:65],v22,32768
T a[66:67],v22,34816
M v[88:91],a[100:103],v[144:147],v[88:91]
s_mov_b32 s55, 0x20000
T a[68:69],v22,36864
T a[70:71],v22,38912
M v[88:91],a[104:107],v[160:163],v[88:91]
s_mul_i32 s77, s42, 1835008
C v64,v64,v65
C v65,v66,v67
M v[88:91],a[108:111],v[176:179],v[88:91]
s_mul_i32 s78, s72, 14336
T a[72:73],v22,40960
T a[74:75],v22,43008
M v[88:91],a[112:115],v[192:195],v[88:91]
SA s77,s77,s78
T a[76:77],v22,45056
T a[78:79],v22,47104
M v[88:91],a[116:119],v[208:211],v[88:91]
SA s77,s77,67108864
C v66,v72,v73
C v67,v74,v75
M v[88:91],a[120:123],v[224:227],v[88:91]
s_lshl_b32 s79, s74, 2
T a[80:81],v22,49152
T a[82:83],v22,51200
M v[88:91],a[124:127],v[240:243],v[88:91]
SA s79,s79,s20
T a[84:85],v22,53248
T a[86:87],v22,55296
M v[92:95],a[124:127],v[244:247],0
SA s79,s79,6
buffer_store_dwordx4 v[64:67], v7, s[8:11], s29 offen offset:0 sc1
M v[92:95],a[120:123],v[228:231],v[92:95]
s_sub_u32 s67, 13, s79
T a[88:89],v22,57344
T a[90:91],v22,59392
M v[92:95],a[116:119],v[212:215],v[92:95]
s_and_b32 s67, s67, 536870912
T a[92:93],v22,61440
T a[94:95],v22,63488
M v[92:95],a[112:115],v[196:199],v[92:95]
s_lshl_b32 s78, s79, 10
MF v68,v6,v68
MF v69,v6,v69
M v[92:95],a[108:111],v[180:183],v[92:95]
SA s78,s78,s77
MF v70,v6,v70
MF v71,v6,v71
M v[92:95],a[104:107],v[164:167],v[92:95]
s_lshl_b32 s79, s79, 6
MF v76,v6,v76
MF v77,v6,v77
M v[92:95],a[100:103],v[148:151],v[92:95]
s_waitcnt lgkmcnt(0)
MF v78,v6,v78
MF v79,v6,v79
M v[92:95],a[96:99],v[132:135],v[92:95]
s_or_b32 s79, s79, s67
v_or_b32 v27, s67, v7
s_lshr_b32 s73, s72, 1
s_sub_u32 s65, 7, s73
s_bitcmp1_b32 s72, 0
s_cselect_b32 s73, s65, s73
s_lshl_b32 s73, s73, 4
s_lshl_b32 s65, s42, 7
SA s73,s73,s65
v_and_b32 v29, 15, v32
v_add_u32 v29, s73, v29
s_mov_b32 s64, 104857664
v_mul_u32_u24 v28, 896, v29
v_lshl_add_u32 v28, v34, 4, v28
C v68,v68,v69
C v69,v70,v71
C v70,v76,v77
C v71,v78,v79
buffer_store_dwordx4 v[68:71], v7, s[8:11], s30 offen offset:0 sc1
v_lshrrev_b32 v35, 4, v29
v_lshlrev_b32 v35, 5, v35
v_and_b32 v36, 15, v29
v_add_lshl_u32 v35, v35, v36, 2
buffer_load_dword v26, v35, s[8:11], s64 offen sc1
s_waitcnt vmcnt(8)
buffer_store_dword v15, v17, s[8:11], s84 offen sc1
buffer_load_dwordx4 v[44:47], v28, s[56:59], s79 offen
M v[96:99],a[64:67],v[128:131],0
s_nop 0
T a[96:97],v23,32768
T a[98:99],v23,34816
M v[96:99],a[68:71],v[144:147],v[96:99]
T a[100:101],v23,36864
T a[102:103],v23,38912
M v[96:99],a[72:75],v[160:163],v[96:99]
MF v80,v5,v80
MF v81,v5,v81
M v[96:99],a[76:79],v[176:179],v[96:99]
T a[104:105],v23,40960
T a[106:107],v23,43008
M v[96:99],a[80:83],v[192:195],v[96:99]
T a[108:109],v23,45056
T a[110:111],v23,47104
M v[96:99],a[84:87],v[208:211],v[96:99]
MF v82,v5,v82
MF v83,v5,v83
M v[96:99],a[88:91],v[224:227],v[96:99]
T a[112:113],v23,49152
T a[114:115],v23,51200
M v[96:99],a[92:95],v[240:243],v[96:99]
T a[116:117],v23,53248
T a[118:119],v23,55296
M v[100:103],a[92:95],v[244:247],0
MF v88,v5,v88
MF v89,v5,v89
M v[100:103],a[88:91],v[228:231],v[100:103]
T a[120:121],v23,57344
T a[122:123],v23,59392
M v[100:103],a[84:87],v[212:215],v[100:103]
T a[124:125],v23,61440
T a[126:127],v23,63488
M v[100:103],a[80:83],v[196:199],v[100:103]
MF v90,v5,v90
MF v91,v5,v91
M v[100:103],a[76:79],v[180:183],v[100:103]
C v80,v80,v81
C v81,v82,v83
M v[100:103],a[72:75],v[164:167],v[100:103]
C v82,v88,v89
C v83,v90,v91
M v[100:103],a[68:71],v[148:151],v[100:103]
buffer_store_dwordx4 v[80:83], v7, s[8:11], s29 offen offset:1024 sc1
M v[100:103],a[64:67],v[132:135],v[100:103]
s_waitcnt lgkmcnt(0)
MF v84,v6,v84
MF v85,v6,v85
M v[104:107],a[96:99],v[128:131],0
T a[64:65],v24,32768
T a[66:67],v24,34816
M v[104:107],a[100:103],v[144:147],v[104:107]
T a[68:69],v24,36864
T a[70:71],v24,38912
M v[104:107],a[104:107],v[160:163],v[104:107]
MF v86,v6,v86
MF v87,v6,v87
M v[104:107],a[108:111],v[176:179],v[104:107]
T a[72:73],v24,40960
T a[74:75],v24,43008
M v[104:107],a[112:115],v[192:195],v[104:107]
T a[76:77],v24,45056
T a[78:79],v24,47104
M v[104:107],a[116:119],v[208:211],v[104:107]
MF v92,v6,v92
MF v93,v6,v93
M v[104:107],a[120:123],v[224:227],v[104:107]
T a[80:81],v24,49152
T a[82:83],v24,51200
M v[104:107],a[124:127],v[240:243],v[104:107]
T a[84:85],v24,53248
T a[86:87],v24,55296
M v[108:111],a[124:127],v[244:247],0
MF v94,v6,v94
MF v95,v6,v95
M v[108:111],a[120:123],v[228:231],v[108:111]
T a[88:89],v24,57344
T a[90:91],v24,59392
M v[108:111],a[116:119],v[212:215],v[108:111]
T a[92:93],v24,61440
T a[94:95],v24,63488
M v[108:111],a[112:115],v[196:199],v[108:111]
C v84,v84,v85
C v85,v86,v87
M v[108:111],a[108:111],v[180:183],v[108:111]
C v86,v92,v93
C v87,v94,v95
M v[108:111],a[104:107],v[164:167],v[108:111]
buffer_store_dwordx4 v[84:87], v7, s[8:11], s30 offen offset:1024 sc1
M v[108:111],a[100:103],v[148:151],v[108:111]
SA s29,s33,10240
M v[108:111],a[96:99],v[132:135],v[108:111]
s_waitcnt lgkmcnt(0)
M v[112:115],a[64:67],v[128:131],0
SA s30,s33,24576
T a[96:97],v25,32768
T a[98:99],v25,34816
M v[112:115],a[68:71],v[144:147],v[112:115]
T a[100:101],v25,36864
T a[102:103],v25,38912
M v[112:115],a[72:75],v[160:163],v[112:115]
MF v96,v5,v96
MF v97,v5,v97
M v[112:115],a[76:79],v[176:179],v[112:115]
T a[104:105],v25,40960
T a[106:107],v25,43008
M v[112:115],a[80:83],v[192:195],v[112:115]
T a[108:109],v25,45056
T a[110:111],v25,47104
M v[112:115],a[84:87],v[208:211],v[112:115]
MF v98,v5,v98
MF v99,v5,v99
M v[112:115],a[88:91],v[224:227],v[112:115]
T a[112:113],v25,49152
T a[114:115],v25,51200
M v[112:115],a[92:95],v[240:243],v[112:115]
T a[116:117],v25,53248
T a[118:119],v25,55296
M v[116:119],a[92:95],v[244:247],0
s_cmp_lt_u32 s42, 8
MF v104,v5,v104
MF v105,v5,v105
M v[116:119],a[88:91],v[228:231],v[116:119]
s_cselect_b32 s84, s45, 536870912
T a[120:121],v25,57344
T a[122:123],v25,59392
M v[116:119],a[84:87],v[212:215],v[116:119]
T a[124:125],v25,61440
T a[126:127],v25,63488
M v[116:119],a[80:83],v[196:199],v[116:119]
MF v106,v5,v106
MF v107,v5,v107
M v[116:119],a[76:79],v[180:183],v[116:119]
C v96,v96,v97
C v97,v98,v99
M v[116:119],a[72:75],v[164:167],v[116:119]
C v98,v104,v105
C v99,v106,v107
M v[116:119],a[68:71],v[148:151],v[116:119]
s_waitcnt lgkmcnt(0)
buffer_store_dwordx4 v[96:99], v7, s[8:11], s29 offen offset:0 sc1
M v[116:119],a[64:67],v[132:135],v[116:119]
s_barrier
M v[120:123],a[96:99],v[128:131],0
s_nop 0
T a[64:65],v18,32768
T a[66:67],v18,34816
M v[120:123],a[100:103],v[144:147],v[120:123]
T a[68:69],v18,36864
T a[70:71],v18,38912
M v[120:123],a[104:107],v[160:163],v[120:123]
MF v100,v6,v100
MF v101,v6,v101
M v[120:123],a[108:111],v[176:179],v[120:123]
T a[72:73],v18,40960
T a[74:75],v18,43008
M v[120:123],a[112:115],v[192:195],v[120:123]
s_waitcnt vmcnt(9)
T a[76:77],v18,45056
T a[78:79],v18,47104
M v[120:123],a[116:119],v[208:211],v[120:123]
buffer_store_dword v15, v17, s[8:11], s84 offen sc1
M v[120:123],a[120:123],v[224:227],v[120:123]
s_nop 0
T a[80:81],v18,49152
T a[82:83],v18,51200
M v[120:123],a[124:127],v[240:243],v[120:123]
T a[84:85],v18,53248
T a[86:87],v18,55296
M v[124:127],a[124:127],v[244:247],0
MF v102,v6,v102
MF v103,v6,v103
M v[124:127],a[120:123],v[228:231],v[124:127]
T a[88:89],v18,57344
T a[90:91],v18,59392
M v[124:127],a[116:119],v[212:215],v[124:127]
T a[92:93],v18,61440
T a[94:95],v18,63488
M v[124:127],a[112:115],v[196:199],v[124:127]
MF v108,v6,v108
MF v109,v6,v109
M v[124:127],a[108:111],v[180:183],v[124:127]
MF v110,v6,v110
MF v111,v6,v111
M v[124:127],a[104:107],v[164:167],v[124:127]
C v100,v100,v101
C v101,v102,v103
M v[124:127],a[100:103],v[148:151],v[124:127]
s_waitcnt lgkmcnt(0)
C v102,v108,v109
C v103,v110,v111
M v[124:127],a[96:99],v[132:135],v[124:127]
buffer_store_dwordx4 v[100:103], v7, s[8:11], s30 offen offset:0 sc1
M v[64:67],a[64:67],v[128:131],0
s_nop 0
T a[96:97],v19,32768
T a[98:99],v19,34816
M v[64:67],a[68:71],v[144:147],v[64:67]
T a[100:101],v19,36864
T a[102:103],v19,38912
M v[64:67],a[72:75],v[160:163],v[64:67]
MF v112,v5,v112
MF v113,v5,v113
M v[64:67],a[76:79],v[176:179],v[64:67]
T a[104:105],v19,40960
T a[106:107],v19,43008
M v[64:67],a[80:83],v[192:195],v[64:67]
T a[108:109],v19,45056
T a[110:111],v19,47104
M v[64:67],a[84:87],v[208:211],v[64:67]
MF v114,v5,v114
MF v115,v5,v115
M v[64:67],a[88:91],v[224:227],v[64:67]
T a[112:113],v19,49152
T a[114:115],v19,51200
M v[64:67],a[92:95],v[240:243],v[64:67]
T a[116:117],v19,53248
T a[118:119],v19,55296
M v[68:71],a[92:95],v[244:247],0
MF v120,v5,v120
MF v121,v5,v121
M v[68:71],a[88:91],v[228:231],v[68:71]
T a[120:121],v19,57344
T a[122:123],v19,59392
M v[68:71],a[84:87],v[212:215],v[68:71]
T a[124:125],v19,61440
T a[126:127],v19,63488
M v[68:71],a[80:83],v[196:199],v[68:71]
MF v122,v5,v122
MF v123,v5,v123
M v[68:71],a[76:79],v[180:183],v[68:71]
C v112,v112,v113
C v113,v114,v115
M v[68:71],a[72:75],v[164:167],v[68:71]
C v114,v120,v121
C v115,v122,v123
M v[68:71],a[68:71],v[148:151],v[68:71]
buffer_store_dwordx4 v[112:115], v7, s[8:11], s29 offen offset:1024 sc1
M v[68:71],a[64:67],v[132:135],v[68:71]
s_waitcnt lgkmcnt(0)
MF v116,v6,v116
MF v117,v6,v117
M v[72:75],a[96:99],v[128:131],0
T a[64:65],v20,32768
T a[66:67],v20,34816
M v[72:75],a[100:103],v[144:147],v[72:75]
T a[68:69],v20,36864
T a[70:71],v20,38912
M v[72:75],a[104:107],v[160:163],v[72:75]
MF v118,v6,v118
MF v119,v6,v119
M v[72:75],a[108:111],v[176:179],v[72:75]
T a[72:73],v20,40960
T a[74:75],v20,43008
M v[72:75],a[112:115],v[192:195],v[72:75]
T a[76:77],v20,45056
T a[78:79],v20,47104
M v[72:75],a[116:119],v[208:211],v[72:75]
MF v124,v6,v124
MF v125,v6,v125
M v[72:75],a[120:123],v[224:227],v[72:75]
T a[80:81],v20,49152
T a[82:83],v20,51200
M v[72:75],a[124:127],v[240:243],v[72:75]
T a[84:85],v20,53248
T a[86:87],v20,55296
M v[76:79],a[124:127],v[244:247],0
MF v126,v6,v126
MF v127,v6,v127
M v[76:79],a[120:123],v[228:231],v[76:79]
T a[88:89],v20,57344
T a[90:91],v20,59392
M v[76:79],a[116:119],v[212:215],v[76:79]
T a[92:93],v20,61440
T a[94:95],v20,63488
M v[76:79],a[112:115],v[196:199],v[76:79]
C v116,v116,v117
C v117,v118,v119
M v[76:79],a[108:111],v[180:183],v[76:79]
C v118,v124,v125
C v119,v126,v127
M v[76:79],a[104:107],v[164:167],v[76:79]
buffer_store_dwordx4 v[116:119], v7, s[8:11], s30 offen offset:1024 sc1
M v[76:79],a[100:103],v[148:151],v[76:79]
SA s29,s33,12288
s_waitcnt vmcnt(12)
v_readlane_b32 s92, v31, 0
v_readlane_b32 s94, v31, 1
M v[76:79],a[96:99],v[132:135],v[76:79]
s_waitcnt lgkmcnt(0)
s_waitcnt vmcnt(9)
v_sub_f32 v30, 1.0, v26
s_waitcnt vmcnt(7)
v_lshlrev_b32 v48, 16, v44
M v[80:83],a[64:67],v[128:131],0
SA s30,s33,26624
T a[96:97],v21,32768
T a[98:99],v21,34816
M v[80:83],a[68:71],v[144:147],v[80:83]
T a[100:101],v21,36864
T a[102:103],v21,38912
M v[80:83],a[72:75],v[160:163],v[80:83]
v_and_b32 v49, 0xffff0000, v44
v_lshlrev_b32 v50, 16, v45
M v[80:83],a[76:79],v[176:179],v[80:83]
T a[104:105],v21,40960
T a[106:107],v21,43008
M v[80:83],a[80:83],v[192:195],v[80:83]
T a[108:109],v21,45056
T a[110:111],v21,47104
M v[80:83],a[84:87],v[208:211],v[80:83]
MF v64,v5,v64
MF v65,v5,v65
M v[80:83],a[88:91],v[224:227],v[80:83]
T a[112:113],v21,49152
T a[114:115],v21,51200
M v[80:83],a[92:95],v[240:243],v[80:83]
T a[116:117],v21,53248
T a[118:119],v21,55296
M v[84:87],a[92:95],v[244:247],0
MF v66,v5,v66
MF v67,v5,v67
M v[84:87],a[88:91],v[228:231],v[84:87]
T a[120:121],v21,57344
T a[122:123],v21,59392
M v[84:87],a[84:87],v[212:215],v[84:87]
T a[124:125],v21,61440
T a[126:127],v21,63488
M v[84:87],a[80:83],v[196:199],v[84:87]
MF v72,v5,v72
MF v73,v5,v73
M v[84:87],a[76:79],v[180:183],v[84:87]
MF v74,v5,v74
MF v75,v5,v75
M v[84:87],a[72:75],v[164:167],v[84:87]
C v64,v64,v65
C v65,v66,v67
M v[84:87],a[68:71],v[148:151],v[84:87]
C v66,v72,v73
C v67,v74,v75
M v[84:87],a[64:67],v[132:135],v[84:87]
s_waitcnt lgkmcnt(0)
buffer_store_dwordx4 v[64:67], v7, s[8:11], s29 offen offset:0 sc1
M v[88:91],a[96:99],v[128:131],0
v_and_b32 v51, 0xffff0000, v45
v_lshlrev_b32 v52, 16, v46
M v[88:91],a[100:103],v[144:147],v[88:91]
MF v68,v6,v68
MF v69,v6,v69
M v[88:91],a[104:107],v[160:163],v[88:91]
MF v70,v6,v70
MF v71,v6,v71
M v[88:91],a[108:111],v[176:179],v[88:91]
MF v76,v6,v76
MF v77,v6,v77
M v[88:91],a[112:115],v[192:195],v[88:91]
MF v78,v6,v78
MF v79,v6,v79
M v[88:91],a[116:119],v[208:211],v[88:91]
C v68,v68,v69
C v69,v70,v71
M v[88:91],a[120:123],v[224:227],v[88:91]
C v70,v76,v77
C v71,v78,v79
M v[88:91],a[124:127],v[240:243],v[88:91]
buffer_store_dwordx4 v[68:71], v7, s[8:11], s30 offen offset:0 sc1
M v[92:95],a[124:127],v[244:247],0
v_and_b32 v53, 0xffff0000, v46
v_lshlrev_b32 v54, 16, v47
M v[92:95],a[120:123],v[228:231],v[92:95]
v_and_b32 v55, 0xffff0000, v47
v_cmp_eq_u32 s[80:81], s92, v29
M v[92:95],a[116:119],v[212:215],v[92:95]
v_cmp_eq_u32 s[82:83], s94, v29
M v[92:95],a[112:115],v[196:199],v[92:95]
MF v80,v5,v80
MF v81,v5,v81
M v[92:95],a[108:111],v[180:183],v[92:95]
MF v82,v5,v82
MF v83,v5,v83
M v[92:95],a[104:107],v[164:167],v[92:95]
MF v88,v5,v88
MF v89,v5,v89
M v[92:95],a[100:103],v[148:151],v[92:95]
MF v90,v5,v90
MF v91,v5,v91
M v[92:95],a[96:99],v[132:135],v[92:95]
C v80,v80,v81
C v81,v82,v83
C v82,v88,v89
C v83,v90,v91
buffer_store_dwordx4 v[80:83], v7, s[8:11], s29 offen offset:1024 sc1
MF v84,v6,v84
MF v85,v6,v85
MF v86,v6,v86
MF v87,v6,v87
MF v92,v6,v92
MF v93,v6,v93
MF v94,v6,v94
MF v95,v6,v95
C v84,v84,v85
C v85,v86,v87
C v86,v92,v93
C v87,v94,v95
buffer_store_dwordx4 v[84:87], v7, s[8:11], s30 offen offset:1024 sc1
buffer_load_dword v9, v33, s[8:11], s46 offen sc1
s_waitcnt vmcnt(1)
buffer_store_dword v15, v16, s[8:11], s3 offen sc1
s_cmp_lt_u32 s42, 8
s_cbranch_scc1 L_red
s_waitcnt vmcnt(1)
v_cmp_eq_u32 vcc, 1, v9
s_mov_b32 s91, 65536
s_lshl_b32 s70, 1, s41
s_mov_b32 s69, 0xffff
s_or_b32 s70, s70, vcc_lo
s_mov_b32 s68, s70
s_barrier
s_cmp_lg_u32 s70, 0
s_cbranch_scc1 L_vk0
s_call_b64 s[36:37], L_rpoll
L_vk0:
s_ff1_i32_b32 s71, s70
s_bitset0_b32 s70, s71
s_mul_i32 s71, s71, 114688
SA s16,s71,s78
buffer_load_dwordx4 v[128:131], v27, s[8:11], s16 offen sc1
s_cmp_lg_u32 s70, 0
s_cbranch_scc1 L_vk1
s_call_b64 s[36:37], L_rpoll
L_vk1:
s_ff1_i32_b32 s71, s70
s_bitset0_b32 s70, s71
s_mul_i32 s71, s71, 114688
SA s17,s71,s78
buffer_load_dwordx4 v[132:135], v27, s[8:11], s17 offen sc1
s_cmp_lg_u32 s70, 0
s_cbranch_scc1 L_vk2
s_call_b64 s[36:37], L_rpoll
L_vk2:
s_ff1_i32_b32 s71, s70
s_bitset0_b32 s70, s71
s_mul_i32 s71, s71, 114688
SA s18,s71,s78
buffer_load_dwordx4 v[136:139], v27, s[8:11], s18 offen sc1
s_cmp_lg_u32 s70, 0
s_cbranch_scc1 L_vk3
s_call_b64 s[36:37], L_rpoll
L_vk3:
s_ff1_i32_b32 s71, s70
s_bitset0_b32 s70, s71
s_mul_i32 s71, s71, 114688
SA s19,s71,s78
buffer_load_dwordx4 v[140:143], v27, s[8:11], s19 offen sc1
s_cmp_lg_u32 s70, 0
s_cbranch_scc1 L_vk4
s_call_b64 s[36:37], L_rpoll
L_vk4:
s_ff1_i32_b32 s71, s70
s_bitset0_b32 s70, s71
s_mul_i32 s71, s71, 114688
SA s48,s71,s78
buffer_load_dwordx4 v[144:147], v27, s[8:11], s48 offen sc1
s_cmp_lg_u32 s70, 0
s_cbranch_scc1 L_vk5
s_call_b64 s[36:37], L_rpoll
L_vk5:
s_ff1_i32_b32 s71, s70
s_bitset0_b32 s70, s71
s_mul_i32 s71, s71, 114688
SA s49,s71,s78
buffer_load_dwordx4 v[148:151], v27, s[8:11], s49 offen sc1
s_cmp_lg_u32 s70, 0
s_cbranch_scc1 L_vk6
s_call_b64 s[36:37], L_rpoll
L_vk6:
s_ff1_i32_b32 s71, s70
s_bitset0_b32 s70, s71
s_mul_i32 s71, s71, 114688
SA s50,s71,s78
buffer_load_dwordx4 v[152:155], v27, s[8:11], s50 offen sc1
s_cmp_lg_u32 s70, 0
s_cbranch_scc1 L_vk7
s_call_b64 s[36:37], L_rpoll
L_vk7:
s_ff1_i32_b32 s71, s70
s_bitset0_b32 s70, s71
s_mul_i32 s71, s71, 114688
SA s51,s71,s78
buffer_load_dwordx4 v[156:159], v27, s[8:11], s51 offen sc1
s_or_b64 vcc, s[80:81], s[82:83]
s_cbranch_vccnz L_moe2
L_moe_ret2:
MF v48,v30,v48
MF v49,v30,v49
MF v50,v30,v50
MF v51,v30,v51
MF v52,v30,v52
MF v53,v30,v53
MF v54,v30,v54
MF v55,v30,v55
s_cmp_lg_u32 s70, 0
s_cbranch_scc1 L_vk8
s_call_b64 s[36:37], L_rpoll
L_vk8:
s_ff1_i32_b32 s71, s70
s_bitset0_b32 s70, s71
s_mul_i32 s71, s71, 114688
SA s21,s71,s78
buffer_load_dwordx4 v[160:163], v27, s[8:11], s21 offen sc1
s_waitcnt vmcnt(8)
M v[56:59],a[246:249],v[128:131],0
M v[60:63],a[244:247],v[128:131],0
s_cmp_lg_u32 s70, 0
s_cbranch_scc1 L_vk9
s_call_b64 s[36:37], L_rpoll
L_vk9:
s_ff1_i32_b32 s71, s70
s_bitset0_b32 s70, s71
s_mul_i32 s71, s71, 114688
SA s22,s71,s78
buffer_load_dwordx4 v[164:167], v27, s[8:11], s22 offen sc1
s_waitcnt vmcnt(8)
M v[56:59],a[246:249],v[132:135],v[56:59]
M v[60:63],a[244:247],v[132:135],v[60:63]
s_cmp_lg_u32 s70, 0
s_cbranch_scc1 L_vk10
s_call_b64 s[36:37], L_rpoll
L_vk10:
s_ff1_i32_b32 s71, s70
s_bitset0_b32 s70, s71
s_mul_i32 s71, s71, 114688
SA s23,s71,s78
buffer_load_dwordx4 v[168:171], v27, s[8:11], s23 offen sc1
s_waitcnt vmcnt(8)
M v[56:59],a[246:249],v[136:139],v[56:59]
M v[60:63],a[244:247],v[136:139],v[60:63]
s_cmp_lg_u32 s70, 0
s_cbranch_scc1 L_vk11
s_call_b64 s[36:37], L_rpoll
L_vk11:
s_ff1_i32_b32 s71, s70
s_bitset0_b32 s70, s71
s_mul_i32 s71, s71, 114688
SA s24,s71,s78
buffer_load_dwordx4 v[172:175], v27, s[8:11], s24 offen sc1
s_waitcnt vmcnt(8)
M v[56:59],a[246:249],v[140:143],v[56:59]
M v[60:63],a[244:247],v[140:143],v[60:63]
s_cmp_lg_u32 s70, 0
s_cbranch_scc1 L_vk12
s_call_b64 s[36:37], L_rpoll
L_vk12:
s_ff1_i32_b32 s71, s70
s_bitset0_b32 s70, s71
s_mul_i32 s71, s71, 114688
SA s25,s71,s78
buffer_load_dwordx4 v[176:179], v27, s[8:11], s25 offen sc1
s_waitcnt vmcnt(8)
M v[56:59],a[246:249],v[144:147],v[56:59]
M v[60:63],a[244:247],v[144:147],v[60:63]
s_cmp_lg_u32 s70, 0
s_cbranch_scc1 L_vk13
s_call_b64 s[36:37], L_rpoll
L_vk13:
s_ff1_i32_b32 s71, s70
s_bitset0_b32 s70, s71
s_mul_i32 s71, s71, 114688
SA s26,s71,s78
buffer_load_dwordx4 v[180:183], v27, s[8:11], s26 offen sc1
s_waitcnt vmcnt(8)
M v[56:59],a[246:249],v[148:151],v[56:59]
M v[60:63],a[244:247],v[148:151],v[60:63]
s_cmp_lg_u32 s70, 0
s_cbranch_scc1 L_vk14
s_call_b64 s[36:37], L_rpoll
L_vk14:
s_ff1_i32_b32 s71, s70
s_bitset0_b32 s70, s71
s_mul_i32 s71, s71, 114688
SA s27,s71,s78
buffer_load_dwordx4 v[184:187], v27, s[8:11], s27 offen sc1
s_waitcnt vmcnt(8)
M v[56:59],a[246:249],v[152:155],v[56:59]
M v[60:63],a[244:247],v[152:155],v[60:63]
s_cmp_lg_u32 s70, 0
s_cbranch_scc1 L_vk15
s_call_b64 s[36:37], L_rpoll
L_vk15:
s_ff1_i32_b32 s71, s70
s_bitset0_b32 s70, s71
s_mul_i32 s71, s71, 114688
SA s28,s71,s78
buffer_load_dwordx4 v[188:191], v27, s[8:11], s28 offen sc1
s_waitcnt vmcnt(8)
M v[56:59],a[246:249],v[156:159],v[56:59]
M v[60:63],a[244:247],v[156:159],v[60:63]
s_waitcnt vmcnt(7)
M v[56:59],a[246:249],v[160:163],v[56:59]
M v[60:63],a[244:247],v[160:163],v[60:63]
s_waitcnt vmcnt(6)
M v[56:59],a[246:249],v[164:167],v[56:59]
M v[60:63],a[244:247],v[164:167],v[60:63]
s_waitcnt vmcnt(5)
M v[56:59],a[246:249],v[168:171],v[56:59]
M v[60:63],a[244:247],v[168:171],v[60:63]
s_waitcnt vmcnt(4)
M v[56:59],a[246:249],v[172:175],v[56:59]
M v[60:63],a[244:247],v[172:175],v[60:63]
s_waitcnt vmcnt(3)
M v[56:59],a[246:249],v[176:179],v[56:59]
M v[60:63],a[244:247],v[176:179],v[60:63]
s_waitcnt vmcnt(2)
M v[56:59],a[246:249],v[180:183],v[56:59]
M v[60:63],a[244:247],v[180:183],v[60:63]
s_waitcnt vmcnt(1)
M v[56:59],a[246:249],v[184:187],v[56:59]
M v[60:63],a[244:247],v[184:187],v[60:63]
s_waitcnt vmcnt(0)
M v[56:59],a[246:249],v[188:191],v[56:59]
M v[60:63],a[244:247],v[188:191],v[60:63]
s_nop 7
v_permlane16_swap_b32 v56, v60
v_permlane16_swap_b32 v57, v61
v_permlane16_swap_b32 v58, v62
v_permlane16_swap_b32 v59, v63
v_fmac_f32 v48, v26, v56
v_fmac_f32 v49, v26, v57
v_fmac_f32 v50, v26, v58
v_fmac_f32 v51, v26, v59
v_fmac_f32 v52, v26, v60
v_fmac_f32 v53, v26, v61
v_fmac_f32 v54, v26, v62
v_fmac_f32 v55, v26, v63
C v44,v48,v49
C v45,v50,v51
C v46,v52,v53
C v47,v54,v55
buffer_store_dwordx4 v[44:47], v28, s[52:55], s79 offen sc1
s_endpgm
L_d2h:
M v[128:131],a[64:67],v[48:51],v[128:131]
R a[96:99],v7,40960
R a[100:103],v7,41984
M v[128:131],a[68:71],v[56:59],v[128:131]
SA m0,s28,135168
E v18,v64
M v[132:135],a[68:71],v[60:63],v[132:135]
buffer_load_dwordx4 v4, s[8:11], s26 offen offset:0 sc1 lds
M v[132:135],a[64:67],v[52:55],v[132:135]
R a[104:107],v7,43008
R a[108:111],v7,44032
M v[140:143],a[72:75],v[52:55],v[140:143]
s_cmp_gt_u32 s20, 3
E v19,v65
M v[140:143],a[76:79],v[60:63],v[140:143]
s_cselect_b64 s[82:83], -1, 0
AF v30,v28,v30
AF v31,v29,v31
M v[136:139],a[76:79],v[56:59],v[136:139]
s_cmp_eq_u32 s20, 3
R a[112:115],v7,45056
R a[116:119],v7,46080
M v[136:139],a[72:75],v[48:51],v[136:139]
s_cselect_b64 s[66:67], s[16:17], s[82:83]
buffer_load_dwordx4 v4, s[8:11], s26 offen offset:1024 sc1 lds
M v[144:147],a[80:83],v[48:51],v[144:147]
s_cselect_b64 s[68:69], s[18:19], s[82:83]
E v20,v66
M v[144:147],a[84:87],v[56:59],v[144:147]
s_cselect_b64 s[70:71], s[48:49], s[82:83]
R a[120:123],v7,47104
R a[124:127],v7,48128
M v[148:151],a[84:87],v[60:63],v[148:151]
s_cselect_b64 s[72:73], s[50:51], s[82:83]
v_cndmask_b32 v100, v36, v8, s[66:67]
v_cndmask_b32 v101, v36, v8, s[68:69]
M v[148:151],a[80:83],v[52:55],v[148:151]
buffer_load_dwordx4 v4, s[8:11], s26 offen offset:2048 sc1 lds
M v[156:159],a[88:91],v[52:55],v[156:159]
v_cndmask_b32 v102, v36, v8, s[70:71]
AF v26,v18,v19
M v[156:159],a[92:95],v[60:63],v[156:159]
E v21,v67
M v[152:155],a[92:95],v[56:59],v[152:155]
v_cndmask_b32 v103, v36, v8, s[72:73]
C v40,v18,v19
M v[152:155],a[88:91],v[48:51],v[152:155]
s_waitcnt lgkmcnt(0)
buffer_load_dwordx4 v4, s[8:11], s26 offen offset:3072 sc1 lds
M v[160:163],a[96:99],v[48:51],v[160:163]
s_cmp_gt_u32 s20, 2
R a[64:67],v7,49152
R a[68:71],v7,50176
M v[160:163],a[100:103],v[56:59],v[160:163]
s_cselect_b64 s[82:83], -1, 0
E v22,v72
M v[164:167],a[100:103],v[60:63],v[164:167]
s_cmp_eq_u32 s20, 2
AF v26,v20,v26
C v41,v20,v21
M v[164:167],a[96:99],v[52:55],v[164:167]
s_mul_i32 s21, s41, 1048576
R a[72:75],v7,51200
R a[76:79],v7,52224
M v[172:175],a[104:107],v[52:55],v[172:175]
s_cselect_b64 s[74:75], s[16:17], s[82:83]
E v23,v73
M v[172:175],a[108:111],v[60:63],v[172:175]
s_cselect_b64 s[76:77], s[18:19], s[82:83]
AF v26,v21,v26
AF v26,v22,v26
M v[168:171],a[108:111],v[56:59],v[168:171]
s_cselect_b64 s[78:79], s[48:49], s[82:83]
R a[80:83],v7,53248
R a[84:87],v7,54272
M v[168:171],a[104:107],v[48:51],v[168:171]
s_cselect_b64 s[80:81], s[50:51], s[82:83]
v_cndmask_b32 v108, v36, v8, s[74:75]
v_cndmask_b32 v109, v36, v8, s[76:77]
M v[176:179],a[112:115],v[48:51],v[176:179]
SA s21,s21,589824
E v24,v74
M v[176:179],a[116:119],v[56:59],v[176:179]
s_lshl_b32 s84, s42, 1
R a[88:91],v7,55296
R a[92:95],v7,56320
M v[180:183],a[116:119],v[60:63],v[180:183]
s_sub_u32 s22, 11, s84
v_cndmask_b32 v110, v36, v8, s[78:79]
C v42,v22,v23
M v[180:183],a[112:115],v[52:55],v[180:183]
s_mov_b32 s23, 536870912
s_waitcnt vmcnt(16)
v_cmp_gt_u32 vcc, 2, v5
AF v26,v23,v26
M v[188:191],a[120:123],v[52:55],v[188:191]
s_cbranch_vccnz L_lsh2
L_lrh2:
v_cndmask_b32 v111, v36, v8, s[80:81]
M v[188:191],a[124:127],v[60:63],v[188:191]
SA m0,s28,98304
E v25,v75
M v[184:187],a[124:127],v[56:59],v[184:187]
s_cmp_gt_u32 s20, 1
buffer_load_dwordx4 v3, s[8:11], s21 offen offset:0 sc1 lds
M v[184:187],a[120:123],v[48:51],v[184:187]
s_waitcnt lgkmcnt(0)
E v18,v68
M v[192:195],a[64:67],v[48:51],v[192:195]
s_cselect_b64 s[82:83], -1, 0
R a[96:99],v7,57344
R a[100:103],v7,58368
M v[192:195],a[68:71],v[56:59],v[192:195]
s_cmp_eq_u32 s20, 1
buffer_load_dwordx4 v3, s[8:11], s21 offen offset:1024 sc1 lds
M v[196:199],a[68:71],v[60:63],v[196:199]
s_cselect_b64 s[66:67], s[16:17], s[82:83]
E v19,v69
M v[196:199],a[64:67],v[52:55],v[196:199]
s_cselect_b64 s[68:69], s[18:19], s[82:83]
R a[104:107],v7,59392
R a[108:111],v7,60416
M v[204:207],a[72:75],v[52:55],v[204:207]
s_cselect_b64 s[70:71], s[48:49], s[82:83]
buffer_load_dwordx4 v3, s[8:11], s21 offen offset:2048 sc1 lds
M v[204:207],a[76:79],v[60:63],v[204:207]
s_cselect_b64 s[72:73], s[50:51], s[82:83]
v_cndmask_b32 v116, v36, v8, s[66:67]
v_cndmask_b32 v117, v36, v8, s[68:69]
M v[200:203],a[76:79],v[56:59],v[200:203]
R a[112:115],v7,61440
R a[116:119],v7,62464
M v[200:203],a[72:75],v[48:51],v[200:203]
v_cndmask_b32 v118, v36, v8, s[70:71]
AF v26,v24,v26
M v[208:211],a[80:83],v[48:51],v[208:211]
buffer_load_dwordx4 v3, s[8:11], s21 offen offset:3072 sc1 lds
M v[208:211],a[84:87],v[56:59],v[208:211]
SA m0,s28,102400
R a[120:123],v7,63488
R a[124:127],v7,64512
M v[212:215],a[84:87],v[60:63],v[212:215]
v_cndmask_b32 v119, v36, v8, s[72:73]
C v43,v24,v25
M v[212:215],a[80:83],v[52:55],v[212:215]
s_cmp_gt_u32 s20, 0
E v20,v70
M v[220:223],a[88:91],v[52:55],v[220:223]
s_cselect_b64 s[82:83], -1, 0
buffer_load_dwordx4 v4, s[8:11], s21 offen offset:0 sc1 lds
M v[220:223],a[92:95],v[60:63],v[220:223]
s_cmp_eq_u32 s20, 0
E v21,v71
M v[216:219],a[92:95],v[56:59],v[216:219]
s_waitcnt lgkmcnt(0)
E v22,v76
M v[216:219],a[88:91],v[48:51],v[216:219]
s_barrier
M v[224:227],a[96:99],v[48:51],v[224:227]
s_cselect_b64 s[74:75], s[16:17], s[82:83]
R a[64:67],v2,0
R a[68:71],v2,1024
M v[224:227],a[100:103],v[56:59],v[224:227]
s_cselect_b64 s[76:77], s[18:19], s[82:83]
buffer_load_dwordx4 v4, s[8:11], s21 offen offset:1024 sc1 lds
M v[228:231],a[100:103],v[60:63],v[228:231]
s_cselect_b64 s[78:79], s[48:49], s[82:83]
E v23,v77
M v[228:231],a[96:99],v[52:55],v[228:231]
s_cselect_b64 s[80:81], s[50:51], s[82:83]
R a[72:75],v2,2048
R a[76:79],v2,3072
M v[236:239],a[104:107],v[52:55],v[236:239]
v_cndmask_b32 v124, v36, v8, s[74:75]
v_cndmask_b32 v125, v36, v8, s[76:77]
M v[236:239],a[108:111],v[60:63],v[236:239]
buffer_load_dwordx4 v4, s[8:11], s21 offen offset:2048 sc1 lds
M v[232:235],a[108:111],v[56:59],v[232:235]
R a[80:83],v2,4096
R a[84:87],v2,5120
M v[232:235],a[104:107],v[48:51],v[232:235]
v_cndmask_b32 v126, v36, v8, s[78:79]
AF v26,v25,v26
M v[240:243],a[112:115],v[48:51],v[240:243]
v_cndmask_b32 v127, v36, v8, s[80:81]
AF v27,v18,v19
M v[240:243],a[116:119],v[56:59],v[240:243]
R a[88:91],v2,6144
R a[92:95],v2,7168
M v[244:247],a[116:119],v[60:63],v[244:247]
buffer_load_dwordx4 v4, s[8:11], s21 offen offset:3072 sc1 lds
M v[244:247],a[112:115],v[52:55],v[244:247]
SA s21,s21,32768
E v24,v78
M v[252:255],a[120:123],v[52:55],v[252:255]
s_sub_u32 s22, s22, 1
E v25,v79
M v[252:255],a[124:127],v[60:63],v[252:255]
s_cselect_b32 s21, s23, s21
C v44,v18,v19
AF v27,v20,v27
M v[248:251],a[124:127],v[56:59],v[248:251]
s_waitcnt lgkmcnt(0)
C v45,v20,v21
AF v27,v21,v27
M v[248:251],a[120:123],v[48:51],v[248:251]
AF v27,v22,v27
C v46,v22,v23
AF v27,v23,v27
AF v27,v24,v27
C v47,v24,v25
AF v27,v25,v27
L_d3h:
M v[100:103],a[64:67],a[32:35],v[100:103]
R a[96:99],v2,8192
R a[100:103],v2,9216
M v[100:103],a[68:71],a[36:39],v[100:103]
R a[104:107],v2,10240
R a[108:111],v2,11264
M v[100:103],a[72:75],a[40:43],v[100:103]
R a[112:115],v2,12288
R a[116:119],v2,13312
M v[100:103],a[76:79],a[44:47],v[100:103]
R a[120:123],v2,14336
R a[124:127],v2,15360
M v[100:103],a[80:83],a[48:51],v[100:103]
v_add_u32 v8, 0x20000, v7
M v[100:103],a[84:87],a[52:55],v[100:103]
buffer_load_dword v5, v9, s[8:11], s46 offen sc1
M v[100:103],a[88:91],a[56:59],v[100:103]
buffer_load_dword v6, off, s[8:11], s47 offset:16 sc1
M v[100:103],a[92:95],a[60:63],v[100:103]
s_waitcnt lgkmcnt(0)
E v18,v80
M v[108:111],a[96:99],a[32:35],v[108:111]
R a[64:67],v2,16384
R a[68:71],v2,17408
M v[108:111],a[100:103],a[36:39],v[108:111]
R a[72:75],v2,18432
R a[76:79],v2,19456
M v[108:111],a[104:107],a[40:43],v[108:111]
R a[80:83],v2,20480
R a[84:87],v2,21504
M v[108:111],a[108:111],a[44:47],v[108:111]
R a[88:91],v2,22528
R a[92:95],v2,23552
M v[108:111],a[112:115],a[48:51],v[108:111]
E v19,v81
M v[108:111],a[116:119],a[52:55],v[108:111]
E v20,v82
M v[108:111],a[120:123],a[56:59],v[108:111]
E v21,v83
M v[108:111],a[124:127],a[60:63],v[108:111]
s_waitcnt lgkmcnt(0)
E v22,v88
M v[116:119],a[64:67],a[32:35],v[116:119]
R a[96:99],v2,24576
R a[100:103],v2,25600
M v[116:119],a[68:71],a[36:39],v[116:119]
R a[104:107],v2,26624
R a[108:111],v2,27648
M v[116:119],a[72:75],a[40:43],v[116:119]
R a[112:115],v2,28672
R a[116:119],v2,29696
M v[116:119],a[76:79],a[44:47],v[116:119]
R a[120:123],v2,30720
R a[124:127],v2,31744
M v[116:119],a[80:83],a[48:51],v[116:119]
E v23,v89
M v[116:119],a[84:87],a[52:55],v[116:119]
E v24,v90
M v[116:119],a[88:91],a[56:59],v[116:119]
s_waitcnt vmcnt(18) lgkmcnt(0)
E v25,v91
M v[116:119],a[92:95],a[60:63],v[116:119]
s_barrier
M v[124:127],a[96:99],a[32:35],v[124:127]
R a[64:67],v7,0
R a[68:71],v7,1024
M v[124:127],a[100:103],a[36:39],v[124:127]
R a[72:75],v7,2048
R a[76:79],v7,3072
M v[124:127],a[104:107],a[40:43],v[124:127]
R a[80:83],v7,4096
R a[84:87],v7,5120
M v[124:127],a[108:111],a[44:47],v[124:127]
R a[88:91],v7,6144
R a[92:95],v7,7168
M v[124:127],a[112:115],a[48:51],v[124:127]
AF v26,v18,v26
C v56,v18,v19
M v[124:127],a[116:119],a[52:55],v[124:127]
AF v26,v19,v26
AF v26,v20,v26
M v[124:127],a[120:123],a[56:59],v[124:127]
s_waitcnt lgkmcnt(0)
E v18,v84
M v[124:127],a[124:127],a[60:63],v[124:127]
E v19,v85
C v57,v20,v21
AF v26,v21,v26
AF v26,v22,v26
C v58,v22,v23
AF v26,v23,v26
AF v26,v24,v26
C v59,v24,v25
AF v26,v25,v26
E v20,v86
E v21,v87
AF v27,v18,v27
C v60,v18,v19
AF v27,v19,v27
E v22,v92
E v23,v93
AF v27,v20,v27
C v61,v20,v21
AF v27,v21,v27
E v24,v94
E v25,v95
AF v27,v22,v27
C v62,v22,v23
AF v27,v23,v27
AF v27,v24,v27
C v63,v24,v25
AF v27,v25,v27
v_max_f32 v10, v26, v27
v_cmp_lt_f32 vcc, s31, v10
s_nop 0
s_cbranch_vccnz L_std3h
L_rtd3h:
M v[128:131],a[64:67],v[40:43],v[128:131]
R a[96:99],v7,8192
R a[100:103],v7,9216
M v[128:131],a[68:71],v[56:59],v[128:131]
s_waitcnt vmcnt(0)
v_cmp_ne_u32 vcc, 1, v6
AF v30,v26,v30
M v[132:135],a[68:71],v[60:63],v[132:135]
s_cbranch_vccnz L_fqs
L_fqr:
E v18,v100
M v[132:135],a[64:67],v[44:47],v[132:135]
SA s73,s32,4096
R a[104:107],v7,10240
R a[108:111],v7,11264
M v[140:143],a[72:75],v[44:47],v[140:143]
SA s74,s32,8192
E v19,v101
M v[140:143],a[76:79],v[60:63],v[140:143]
SA s75,s32,12288
buffer_load_dwordx4 a[0:3], v7, s[8:11], s32 offen offset:0 sc1
M v[136:139],a[76:79],v[56:59],v[136:139]
R a[112:115],v7,12288
R a[116:119],v7,13312
M v[136:139],a[72:75],v[40:43],v[136:139]
E v20,v102
M v[144:147],a[80:83],v[40:43],v[144:147]
buffer_load_dwordx4 a[4:7], v7, s[8:11], s32 offen offset:1024 sc1
M v[144:147],a[84:87],v[56:59],v[144:147]
R a[120:123],v7,14336
R a[124:127],v7,15360
M v[148:151],a[84:87],v[60:63],v[148:151]
AF v31,v27,v31
AF v29,v18,v19
M v[148:151],a[80:83],v[44:47],v[148:151]
buffer_load_dwordx4 a[8:11], v7, s[8:11], s32 offen offset:2048 sc1
M v[156:159],a[88:91],v[44:47],v[156:159]
E v21,v103
M v[156:159],a[92:95],v[60:63],v[156:159]
C v52,v18,v19
AF v29,v20,v29
M v[152:155],a[92:95],v[56:59],v[152:155]
buffer_load_dwordx4 a[12:15], v7, s[8:11], s32 offen offset:3072 sc1
M v[152:155],a[88:91],v[40:43],v[152:155]
s_waitcnt lgkmcnt(0)
E v22,v108
M v[160:163],a[96:99],v[40:43],v[160:163]
R a[64:67],v7,16384
R a[68:71],v7,17408
M v[160:163],a[100:103],v[56:59],v[160:163]
buffer_load_dwordx4 a[16:19], v7, s[8:11], s73 offen offset:0 sc1
M v[164:167],a[100:103],v[60:63],v[164:167]
E v23,v109
M v[164:167],a[96:99],v[44:47],v[164:167]
R a[72:75],v7,18432
R a[76:79],v7,19456
M v[172:175],a[104:107],v[44:47],v[172:175]
buffer_load_dwordx4 a[20:23], v7, s[8:11], s73 offen offset:1024 sc1
M v[172:175],a[108:111],v[60:63],v[172:175]
C v53,v20,v21
AF v29,v21,v29
M v[168:171],a[108:111],v[56:59],v[168:171]
R a[80:83],v7,20480
R a[84:87],v7,21504
M v[168:171],a[104:107],v[40:43],v[168:171]
buffer_load_dwordx4 a[24:27], v7, s[8:11], s73 offen offset:2048 sc1
M v[176:179],a[112:115],v[40:43],v[176:179]
E v24,v110
M v[176:179],a[116:119],v[56:59],v[176:179]
R a[88:91],v7,22528
R a[92:95],v7,23552
M v[180:183],a[116:119],v[60:63],v[180:183]
buffer_load_dwordx4 a[28:31], v7, s[8:11], s73 offen offset:3072 sc1
M v[180:183],a[112:115],v[44:47],v[180:183]
E v25,v111
M v[188:191],a[120:123],v[44:47],v[188:191]
AF v29,v22,v29
C v54,v22,v23
M v[188:191],a[124:127],v[60:63],v[188:191]
buffer_load_dwordx4 a[32:35], v7, s[8:11], s74 offen offset:0 sc1
M v[184:187],a[124:127],v[56:59],v[184:187]
E v18,v116
M v[184:187],a[120:123],v[40:43],v[184:187]
s_waitcnt lgkmcnt(0)
AF v29,v23,v29
AF v29,v24,v29
M v[192:195],a[64:67],v[40:43],v[192:195]
R a[96:99],v7,24576
R a[100:103],v7,25600
M v[192:195],a[68:71],v[56:59],v[192:195]
buffer_load_dwordx4 a[36:39], v7, s[8:11], s74 offen offset:1024 sc1
M v[196:199],a[68:71],v[60:63],v[196:199]
E v19,v117
M v[196:199],a[64:67],v[44:47],v[196:199]
R a[104:107],v7,26624
R a[108:111],v7,27648
M v[204:207],a[72:75],v[44:47],v[204:207]
buffer_load_dwordx4 a[40:43], v7, s[8:11], s74 offen offset:2048 sc1
M v[204:207],a[76:79],v[60:63],v[204:207]
E v20,v118
M v[200:203],a[76:79],v[56:59],v[200:203]
R a[112:115],v7,28672
R a[116:119],v7,29696
M v[200:203],a[72:75],v[40:43],v[200:203]
buffer_load_dwordx4 a[44:47], v7, s[8:11], s74 offen offset:3072 sc1
M v[208:211],a[80:83],v[40:43],v[208:211]
C v55,v24,v25
AF v29,v25,v29
M v[208:211],a[84:87],v[56:59],v[208:211]
R a[120:123],v7,30720
R a[124:127],v7,31744
M v[212:215],a[84:87],v[60:63],v[212:215]
buffer_load_dwordx4 a[48:51], v7, s[8:11], s75 offen offset:0 sc1
M v[212:215],a[80:83],v[44:47],v[212:215]
E v21,v119
M v[220:223],a[88:91],v[44:47],v[220:223]
AF v29,v18,v29
C v48,v18,v19
M v[220:223],a[92:95],v[60:63],v[220:223]
buffer_load_dwordx4 a[52:55], v7, s[8:11], s75 offen offset:1024 sc1
M v[216:219],a[92:95],v[56:59],v[216:219]
s_waitcnt lgkmcnt(0)
E v22,v124
M v[216:219],a[88:91],v[40:43],v[216:219]
s_barrier
M v[224:227],a[96:99],v[40:43],v[224:227]
R a[64:67],v8,0
R a[68:71],v8,1024
M v[224:227],a[100:103],v[56:59],v[224:227]
buffer_load_dwordx4 a[56:59], v7, s[8:11], s75 offen offset:2048 sc1
M v[228:231],a[100:103],v[60:63],v[228:231]
v_mov_b32 v15, 4
AF v29,v19,v29
M v[228:231],a[96:99],v[44:47],v[228:231]
R a[72:75],v8,2048
R a[76:79],v8,3072
M v[236:239],a[104:107],v[44:47],v[236:239]
buffer_store_dword v15, v1, s[8:11], s45 offen sc1
M v[236:239],a[108:111],v[60:63],v[236:239]
buffer_load_dwordx4 a[60:63], v7, s[8:11], s75 offen offset:3072 sc1
M v[232:235],a[108:111],v[56:59],v[232:235]
s_cmp_ge_u32 s42, 2
R a[80:83],v8,4096
R a[84:87],v8,5120
M v[232:235],a[104:107],v[40:43],v[232:235]
s_cselect_b32 s84, 4, 2
v_cmp_gt_u32 vcc, s84, v5
AF v29,v20,v29
M v[240:243],a[112:115],v[40:43],v[240:243]
s_cbranch_vccnz L_lsh4
L_lrh4:
E v23,v125
M v[240:243],a[116:119],v[56:59],v[240:243]
R a[88:91],v8,6144
R a[92:95],v8,7168
M v[244:247],a[116:119],v[60:63],v[244:247]
E v24,v126
M v[244:247],a[112:115],v[44:47],v[244:247]
E v25,v127
M v[252:255],a[120:123],v[44:47],v[252:255]
C v49,v20,v21
AF v29,v21,v29
M v[252:255],a[124:127],v[60:63],v[252:255]
AF v29,v22,v29
C v50,v22,v23
M v[248:251],a[124:127],v[56:59],v[248:251]
s_waitcnt lgkmcnt(0)
AF v29,v23,v29
AF v29,v24,v29
M v[248:251],a[120:123],v[40:43],v[248:251]
C v51,v24,v25
AF v29,v25,v29
v_cmp_lt_f32 vcc, s31, v29
s_nop 0
s_cbranch_vccnz L_std4h
L_rtd4h:
M v[132:135],a[64:67],v[52:55],v[132:135]
R a[96:99],v8,8192
R a[100:103],v8,9216
M v[132:135],a[68:71],v[48:51],v[132:135]
R a[104:107],v8,10240
R a[108:111],v8,11264
M v[140:143],a[72:75],v[52:55],v[140:143]
SA m0,s28,65536
R a[112:115],v8,12288
R a[116:119],v8,13312
M v[140:143],a[76:79],v[48:51],v[140:143]
R a[120:123],v8,14336
R a[124:127],v8,15360
M v[148:151],a[80:83],v[52:55],v[148:151]
buffer_load_dwordx4 v3, s[8:11], s21 offen offset:0 sc1 lds
M v[148:151],a[84:87],v[48:51],v[148:151]
AF v31,v29,v31
v_mov_b32 v10, v30
M v[156:159],a[88:91],v[52:55],v[156:159]
v_mov_b32 v11, v31
C v128,v128,v129
M v[156:159],a[92:95],v[48:51],v[156:159]
s_waitcnt lgkmcnt(0)
v_permlane16_swap_b32 v10, v30
M v[164:167],a[96:99],v[52:55],v[164:167]
R a[64:67],v8,16384
R a[68:71],v8,17408
M v[164:167],a[100:103],v[48:51],v[164:167]
R a[72:75],v8,18432
R a[76:79],v8,19456
M v[172:175],a[104:107],v[52:55],v[172:175]
R a[80:83],v8,20480
R a[84:87],v8,21504
M v[172:175],a[108:111],v[48:51],v[172:175]
R a[88:91],v8,22528
R a[92:95],v8,23552
M v[180:183],a[112:115],v[52:55],v[180:183]
buffer_load_dwordx4 v3, s[8:11], s21 offen offset:1024 sc1 lds
M v[180:183],a[116:119],v[48:51],v[180:183]
v_permlane16_swap_b32 v11, v31
M v[188:191],a[120:123],v[52:55],v[188:191]
AF v30,v10,v30
AF v31,v11,v31
M v[188:191],a[124:127],v[48:51],v[188:191]
s_waitcnt lgkmcnt(0)
buffer_load_dwordx4 v3, s[8:11], s21 offen offset:2048 sc1 lds
M v[196:199],a[64:67],v[52:55],v[196:199]
R a[96:99],v8,24576
R a[100:103],v8,25600
M v[196:199],a[68:71],v[48:51],v[196:199]
R a[104:107],v8,26624
R a[108:111],v8,27648
M v[204:207],a[72:75],v[52:55],v[204:207]
R a[112:115],v8,28672
R a[116:119],v8,29696
M v[204:207],a[76:79],v[48:51],v[204:207]
R a[120:123],v8,30720
R a[124:127],v8,31744
M v[212:215],a[80:83],v[52:55],v[212:215]
buffer_load_dwordx4 v3, s[8:11], s21 offen offset:3072 sc1 lds
M v[212:215],a[84:87],v[48:51],v[212:215]
SA m0,s28,69632
v_mov_b32 v10, v30
v_mov_b32 v11, v31
M v[220:223],a[88:91],v[52:55],v[220:223]
s_waitcnt lgkmcnt(0)
v_permlane32_swap_b32 v10, v30
M v[220:223],a[92:95],v[48:51],v[220:223]
s_barrier
M v[228:231],a[96:99],v[52:55],v[228:231]
R a[64:67],v2,32768
R a[68:71],v2,33792
M v[228:231],a[100:103],v[48:51],v[228:231]
R a[72:75],v2,34816
R a[76:79],v2,35840
M v[236:239],a[104:107],v[52:55],v[236:239]
R a[80:83],v2,36864
R a[84:87],v2,37888
M v[236:239],a[108:111],v[48:51],v[236:239]
R a[88:91],v2,38912
R a[92:95],v2,39936
M v[244:247],a[112:115],v[52:55],v[244:247]
v_permlane32_swap_b32 v11, v31
M v[244:247],a[116:119],v[48:51],v[244:247]
s_waitcnt vmcnt(4)
buffer_load_dwordx4 v4, s[8:11], s21 offen offset:0 sc1 lds
M v[252:255],a[120:123],v[52:55],v[252:255]
s_waitcnt lgkmcnt(0)
AF v30,v10,v30
AF v31,v11,v31
M v[252:255],a[124:127],v[48:51],v[252:255]
v_rcp_f32 v5, v30
M v[64:67],a[64:67],a[0:3],0
R a[96:99],v2,40960
R a[100:103],v2,41984
M v[64:67],a[68:71],a[4:7],v[64:67]
v_rcp_f32 v6, v31
M v[64:67],a[72:75],a[8:11],v[64:67]
buffer_load_dwordx4 v4, s[8:11], s21 offen offset:1024 sc1 lds
M v[64:67],a[76:79],a[12:15],v[64:67]
R a[104:107],v2,43008
R a[108:111],v2,44032
M v[64:67],a[80:83],a[16:19],v[64:67]
W a192,v5
W a193,v6
M v[64:67],a[84:87],a[20:23],v[64:67]
buffer_load_dwordx4 v4, s[8:11], s21 offen offset:2048 sc1 lds
M v[64:67],a[88:91],a[24:27],v[64:67]
R a[112:115],v2,45056
R a[116:119],v2,46080
M v[64:67],a[92:95],a[28:31],v[64:67]
v_mov_b32 v30, 0
v_mov_b32 v31, 0
M v[68:71],a[92:95],a[60:63],0
buffer_load_dwordx4 v4, s[8:11], s21 offen offset:3072 sc1 lds
M v[68:71],a[88:91],a[56:59],v[68:71]
SA s21,s21,32768
R a[120:123],v2,47104
R a[124:127],v2,48128
M v[68:71],a[84:87],a[52:55],v[68:71]
s_sub_u32 s22, s22, 1
v_mov_b32 v32, 0
v_mov_b32 v33, 0
M v[68:71],a[80:83],a[48:51],v[68:71]
s_cselect_b32 s21, s23, s21
v_mov_b32 v34, 0
v_mov_b32 v35, 0
M v[68:71],a[76:79],a[44:47],v[68:71]
s_mul_i32 s26, s41, 1048576
v_mov_b32 v36, 0
v_mov_b32 v37, 0
M v[68:71],a[72:75],a[40:43],v[68:71]
SA s26,s26,17367040
v_mov_b32 v38, 0
v_mov_b32 v39, 0
M v[68:71],a[68:71],a[36:39],v[68:71]
SA m0,s28,0
E v18,v64
M v[68:71],a[64:67],a[32:35],v[68:71]
s_waitcnt lgkmcnt(0)
buffer_load_dwordx4 v3, s[8:11], s26 offen offset:0 sc1 lds
M v[72:75],a[96:99],a[0:3],0
R a[64:67],v2,49152
R a[68:71],v2,50176
M v[72:75],a[100:103],a[4:7],v[72:75]
E v19,v65
M v[72:75],a[104:107],a[8:11],v[72:75]
buffer_load_dwordx4 v3, s[8:11], s26 offen offset:1024 sc1 lds
M v[72:75],a[108:111],a[12:15],v[72:75]
R a[72:75],v2,51200
R a[76:79],v2,52224
M v[72:75],a[112:115],a[16:19],v[72:75]
E v20,v66
M v[72:75],a[116:119],a[20:23],v[72:75]
buffer_load_dwordx4 v3, s[8:11], s26 offen offset:2048 sc1 lds
M v[72:75],a[120:123],a[24:27],v[72:75]
R a[80:83],v2,53248
R a[84:87],v2,54272
M v[72:75],a[124:127],a[28:31],v[72:75]
E v21,v67
M v[76:79],a[124:127],a[60:63],0
buffer_load_dwordx4 v3, s[8:11], s26 offen offset:3072 sc1 lds
M v[76:79],a[120:123],a[56:59],v[76:79]
SA m0,s28,4096
R a[88:91],v2,55296
R a[92:95],v2,56320
M v[76:79],a[116:119],a[52:55],v[76:79]
E v22,v68
M v[76:79],a[112:115],a[48:51],v[76:79]
E v23,v69
M v[76:79],a[108:111],a[44:47],v[76:79]
buffer_load_dwordx4 v4, s[8:11], s26 offen offset:0 sc1 lds
M v[76:79],a[104:107],a[40:43],v[76:79]
AF v26,v18,v19
C v40,v18,v19
M v[76:79],a[100:103],a[36:39],v[76:79]
E v24,v70
M v[76:79],a[96:99],a[32:35],v[76:79]
s_waitcnt lgkmcnt(0)
AF v26,v20,v26
C v41,v20,v21
M v[80:83],a[64:67],a[0:3],0
R a[96:99],v2,57344
R a[100:103],v2,58368
M v[80:83],a[68:71],a[4:7],v[80:83]
buffer_load_dwordx4 v4, s[8:11], s26 offen offset:1024 sc1 lds
M v[80:83],a[72:75],a[8:11],v[80:83]
E v25,v71
M v[80:83],a[76:79],a[12:15],v[80:83]
R a[104:107],v2,59392
R a[108:111],v2,60416
M v[80:83],a[80:83],a[16:19],v[80:83]
AF v26,v21,v26
AF v27,v22,v23
M v[80:83],a[84:87],a[20:23],v[80:83]
buffer_load_dwordx4 v4, s[8:11], s26 offen offset:2048 sc1 lds
M v[80:83],a[88:91],a[24:27],v[80:83]
R a[112:115],v2,61440
R a[116:119],v2,62464
M v[80:83],a[92:95],a[28:31],v[80:83]
E v18,v72
M v[84:87],a[92:95],a[60:63],0
E v19,v73
M v[84:87],a[88:91],a[56:59],v[84:87]
R a[120:123],v2,63488
R a[124:127],v2,64512
M v[84:87],a[84:87],a[52:55],v[84:87]
buffer_load_dwordx4 v4, s[8:11], s26 offen offset:3072 sc1 lds
M v[84:87],a[80:83],a[48:51],v[84:87]
SA s26,s26,32768
E v20,v74
M v[84:87],a[76:79],a[44:47],v[84:87]
SA m0,s28,32768
C v44,v22,v23
AF v27,v24,v27
M v[84:87],a[72:75],a[40:43],v[84:87]
C v45,v24,v25
AF v27,v25,v27
M v[84:87],a[68:71],a[36:39],v[84:87]
s_waitcnt vmcnt(8) lgkmcnt(0)
buffer_load_dwordx4 v3, s[8:11], s26 offen offset:0 sc1 lds
M v[84:87],a[64:67],a[32:35],v[84:87]
s_barrier
M v[88:91],a[96:99],a[0:3],0
R a[64:67],v2,0
R a[68:71],v2,1024
M v[88:91],a[100:103],a[4:7],v[88:91]
E v21,v75
M v[88:91],a[104:107],a[8:11],v[88:91]
buffer_load_dwordx4 v3, s[8:11], s26 offen offset:1024 sc1 lds
M v[88:91],a[108:111],a[12:15],v[88:91]
R a[72:75],v2,2048
R a[76:79],v2,3072
M v[88:91],a[112:115],a[16:19],v[88:91]
E v22,v76
M v[88:91],a[116:119],a[20:23],v[88:91]
E v23,v77
M v[88:91],a[120:123],a[24:27],v[88:91]
R a[80:83],v2,4096
R a[84:87],v2,5120
M v[88:91],a[124:127],a[28:31],v[88:91]
buffer_load_dwordx4 v3, s[8:11], s26 offen offset:2048 sc1 lds
M v[92:95],a[124:127],a[60:63],0
E v24,v78
M v[92:95],a[120:123],a[56:59],v[92:95]
R a[88:91],v2,6144
R a[92:95],v2,7168
M v[92:95],a[116:119],a[52:55],v[92:95]
E v25,v79
M v[92:95],a[112:115],a[48:51],v[92:95]
buffer_load_dwordx4 v3, s[8:11], s26 offen offset:3072 sc1 lds
M v[92:95],a[108:111],a[44:47],v[92:95]
AF v26,v18,v26
C v42,v18,v19
M v[92:95],a[104:107],a[40:43],v[92:95]
AF v26,v19,v26
AF v26,v20,v26
M v[92:95],a[100:103],a[36:39],v[92:95]
s_waitcnt lgkmcnt(0)
C v43,v20,v21
AF v26,v21,v26
M v[92:95],a[96:99],a[32:35],v[92:95]
AF v27,v22,v27
C v46,v22,v23
AF v27,v23,v27
AF v27,v24,v27
C v47,v24,v25
AF v27,v25,v27
M v[96:99],a[64:67],a[0:3],0
R a[96:99],v2,8192
R a[100:103],v2,9216
M v[96:99],a[68:71],a[4:7],v[96:99]
SA m0,s28,98304
E v18,v80
M v[96:99],a[72:75],a[8:11],v[96:99]
buffer_load_dwordx4 v3, s[8:11], s21 offen offset:0 sc1 lds
M v[96:99],a[76:79],a[12:15],v[96:99]
R a[104:107],v2,10240
R a[108:111],v2,11264
M v[96:99],a[80:83],a[16:19],v[96:99]
E v19,v81
M v[96:99],a[84:87],a[20:23],v[96:99]
AF v26,v18,v26
C v56,v18,v19
M v[96:99],a[88:91],a[24:27],v[96:99]
R a[112:115],v2,12288
R a[116:119],v2,13312
M v[96:99],a[92:95],a[28:31],v[96:99]
buffer_load_dwordx4 v3, s[8:11], s21 offen offset:1024 sc1 lds
M v[100:103],a[92:95],a[60:63],0
E v20,v82
M v[100:103],a[88:91],a[56:59],v[100:103]
R a[120:123],v2,14336
R a[124:127],v2,15360
M v[100:103],a[84:87],a[52:55],v[100:103]
E v21,v83
M v[100:103],a[80:83],a[48:51],v[100:103]
buffer_load_dwordx4 v3, s[8:11], s21 offen offset:2048 sc1 lds
M v[100:103],a[76:79],a[44:47],v[100:103]
AF v26,v19,v26
AF v26,v20,v26
M v[100:103],a[72:75],a[40:43],v[100:103]
E v22,v88
M v[100:103],a[68:71],a[36:39],v[100:103]
C v57,v20,v21
AF v26,v21,v26
M v[100:103],a[64:67],a[32:35],v[100:103]
s_waitcnt lgkmcnt(0)
buffer_load_dwordx4 v3, s[8:11], s21 offen offset:3072 sc1 lds
M v[108:111],a[96:99],a[32:35],0
R a[64:67],v2,16384
R a[68:71],v2,17408
M v[108:111],a[100:103],a[36:39],v[108:111]
E v23,v89
M v[108:111],a[104:107],a[40:43],v[108:111]
SA m0,s28,102400
AF v26,v22,v26
C v58,v22,v23
M v[108:111],a[108:111],a[44:47],v[108:111]
R a[72:75],v2,18432
R a[76:79],v2,19456
M v[108:111],a[112:115],a[48:51],v[108:111]
buffer_load_dwordx4 v4, s[8:11], s21 offen offset:0 sc1 lds
M v[108:111],a[116:119],a[52:55],v[108:111]
E v24,v90
M v[108:111],a[120:123],a[56:59],v[108:111]
R a[80:83],v2,20480
R a[84:87],v2,21504
M v[108:111],a[124:127],a[60:63],v[108:111]
E v25,v91
M v[104:107],a[124:127],a[28:31],0
buffer_load_dwordx4 v4, s[8:11], s21 offen offset:1024 sc1 lds
M v[104:107],a[120:123],a[24:27],v[104:107]
R a[88:91],v2,22528
R a[92:95],v2,23552
M v[104:107],a[116:119],a[20:23],v[104:107]
AF v26,v23,v26
AF v26,v24,v26
M v[104:107],a[112:115],a[16:19],v[104:107]
E v18,v84
M v[104:107],a[108:111],a[12:15],v[104:107]
buffer_load_dwordx4 v4, s[8:11], s21 offen offset:2048 sc1 lds
M v[104:107],a[104:107],a[8:11],v[104:107]
C v59,v24,v25
AF v26,v25,v26
M v[104:107],a[100:103],a[4:7],v[104:107]
E v19,v85
M v[104:107],a[96:99],a[0:3],v[104:107]
s_waitcnt lgkmcnt(0)
AF v27,v18,v27
C v60,v18,v19
M v[112:115],a[64:67],a[0:3],0
R a[96:99],v2,24576
R a[100:103],v2,25600
M v[112:115],a[68:71],a[4:7],v[112:115]
buffer_load_dwordx4 v4, s[8:11], s21 offen offset:3072 sc1 lds
M v[112:115],a[72:75],a[8:11],v[112:115]
SA s21,s21,32768
E v20,v86
M v[112:115],a[76:79],a[12:15],v[112:115]
s_sub_u32 s22, s22, 1
R a[104:107],v2,26624
R a[108:111],v2,27648
M v[112:115],a[80:83],a[16:19],v[112:115]
s_cselect_b32 s21, s23, s21
AF v27,v19,v27
C v129,v130,v131
M v[112:115],a[84:87],a[20:23],v[112:115]
SA m0,s28,36864
E v21,v87
M v[112:115],a[88:91],a[24:27],v[112:115]
R a[112:115],v2,28672
R a[116:119],v2,29696
M v[112:115],a[92:95],a[28:31],v[112:115]
buffer_load_dwordx4 v4, s[8:11], s26 offen offset:0 sc1 lds
M v[116:119],a[92:95],a[60:63],0
E v22,v92
M v[116:119],a[88:91],a[56:59],v[116:119]
R a[120:123],v2,30720
R a[124:127],v2,31744
M v[116:119],a[84:87],a[52:55],v[116:119]
AF v27,v20,v27
C v61,v20,v21
M v[116:119],a[80:83],a[48:51],v[116:119]
buffer_load_dwordx4 v4, s[8:11], s26 offen offset:1024 sc1 lds
M v[116:119],a[76:79],a[44:47],v[116:119]
E v23,v93
M v[116:119],a[72:75],a[40:43],v[116:119]
AF v27,v21,v27
AF v27,v22,v27
M v[116:119],a[68:71],a[36:39],v[116:119]
s_waitcnt vmcnt(14) lgkmcnt(0)
C v62,v22,v23
AF v27,v23,v27
M v[116:119],a[64:67],a[32:35],v[116:119]
s_barrier
M v[124:127],a[96:99],a[32:35],0
R a[64:67],v7,0
R a[68:71],v7,1024
M v[124:127],a[100:103],a[36:39],v[124:127]
buffer_load_dwordx4 v4, s[8:11], s26 offen offset:2048 sc1 lds
M v[124:127],a[104:107],a[40:43],v[124:127]
E v24,v94
M v[124:127],a[108:111],a[44:47],v[124:127]
R a[72:75],v7,2048
R a[76:79],v7,3072
M v[124:127],a[112:115],a[48:51],v[124:127]
E v25,v95
M v[124:127],a[116:119],a[52:55],v[124:127]
buffer_load_dwordx4 v4, s[8:11], s26 offen offset:3072 sc1 lds
M v[124:127],a[120:123],a[56:59],v[124:127]
R a[80:83],v7,4096
R a[84:87],v7,5120
M v[124:127],a[124:127],a[60:63],v[124:127]
AF v27,v24,v27
C v63,v24,v25
M v[120:123],a[124:127],a[28:31],0
SA s26,s26,32768
AF v27,v25,v27
C v130,v136,v137
M v[120:123],a[120:123],a[24:27],v[120:123]
R a[88:91],v7,6144
R a[92:95],v7,7168
C v131,v138,v139
W a128,v128
W a129,v129
W a130,v130
W a131,v131
C v144,v144,v145
C v145,v146,v147
C v146,v152,v153
C v147,v154,v155
W a132,v144
W a133,v145
W a134,v146
W a135,v147
C v132,v132,v133
C v133,v134,v135
C v134,v140,v141
C v135,v142,v143
W a160,v132
W a161,v133
W a162,v134
W a163,v135
C v160,v160,v161
C v161,v162,v163
C v162,v168,v169
C v163,v170,v171
W a136,v160
W a137,v161
W a138,v162
W a139,v163
C v148,v148,v149
C v149,v150,v151
C v150,v156,v157
C v151,v158,v159
W a164,v148
W a165,v149
W a166,v150
W a167,v151
C v176,v176,v177
C v177,v178,v179
C v178,v184,v185
C v179,v186,v187
W a140,v176
W a141,v177
W a142,v178
W a143,v179
C v164,v164,v165
C v165,v166,v167
C v166,v172,v173
C v167,v174,v175
W a168,v164
W a169,v165
W a170,v166
W a171,v167
C v192,v192,v193
C v193,v194,v195
C v194,v200,v201
C v195,v202,v203
W a144,v192
W a145,v193
W a146,v194
W a147,v195
C v180,v180,v181
C v181,v182,v183
C v182,v188,v189
C v183,v190,v191
W a172,v180
W a173,v181
W a174,v182
W a175,v183
C v208,v208,v209
C v209,v210,v211
C v210,v216,v217
C v211,v218,v219
W a148,v208
W a149,v209
W a150,v210
W a151,v211
C v196,v196,v197
C v197,v198,v199
C v198,v204,v205
C v199,v206,v207
W a176,v196
W a177,v197
W a178,v198
W a179,v199
C v224,v224,v225
C v225,v226,v227
C v226,v232,v233
C v227,v234,v235
W a152,v224
W a153,v225
W a154,v226
W a155,v227
C v212,v212,v213
C v213,v214,v215
C v214,v220,v221
C v215,v222,v223
W a180,v212
W a181,v213
W a182,v214
W a183,v215
C v240,v240,v241
C v241,v242,v243
C v242,v248,v249
C v243,v250,v251
W a156,v240
W a157,v241
W a158,v242
W a159,v243
C v228,v228,v229
C v229,v230,v231
C v230,v236,v237
C v231,v238,v239
W a184,v228
W a185,v229
W a186,v230
W a187,v231
C v244,v244,v245
C v245,v246,v247
C v246,v252,v253
C v247,v254,v255
W a188,v244
W a189,v245
W a190,v246
W a191,v247
M v[120:123],a[116:119],a[20:23],v[120:123]
M v[120:123],a[112:115],a[16:19],v[120:123]
M v[120:123],a[108:111],a[12:15],v[120:123]
M v[120:123],a[104:107],a[8:11],v[120:123]
M v[120:123],a[100:103],a[4:7],v[120:123]
s_waitcnt lgkmcnt(0)
M v[120:123],a[96:99],a[0:3],v[120:123]
v_max_f32 v10, v26, v27
v_min_f32 v11, v26, v27
v_cmp_lt_f32 vcc, s31, v10
v_cmp_gt_f32 s[64:65], s24, v11
s_nop 0
s_or_b64 vcc, vcc, s[64:65]
s_cbranch_vccnz L_sth1
L_rth1:
M v[128:131],a[64:67],v[40:43],0
R a[96:99],v7,8192
R a[100:103],v7,9216
M v[128:131],a[68:71],v[56:59],v[128:131]
SA m0,s28,65536
E v18,v96
M v[132:135],a[68:71],v[60:63],0
buffer_load_dwordx4 v3, s[8:11], s21 offen offset:0 sc1 lds
M v[132:135],a[64:67],v[44:47],v[132:135]
R a[104:107],v7,10240
R a[108:111],v7,11264
M v[140:143],a[72:75],v[44:47],0
E v19,v97
M v[140:143],a[76:79],v[60:63],v[140:143]
AF v30,v26,v30
AF v31,v27,v31
M v[136:139],a[76:79],v[56:59],0
R a[112:115],v7,12288
R a[116:119],v7,13312
M v[136:139],a[72:75],v[40:43],v[136:139]
buffer_load_dwordx4 v3, s[8:11], s21 offen offset:1024 sc1 lds
M v[144:147],a[80:83],v[40:43],0
E v20,v98
M v[144:147],a[84:87],v[56:59],v[144:147]
R a[120:123],v7,14336
R a[124:127],v7,15360
M v[148:151],a[84:87],v[60:63],0
s_mov_b32 s40, 0
AF v28,v18,v19
C v48,v18,v19
M v[148:151],a[80:83],v[44:47],v[148:151]
s_mov_b32 s7, 0
buffer_load_dwordx4 v3, s[8:11], s21 offen offset:2048 sc1 lds
M v[156:159],a[88:91],v[44:47],0
s_and_b32 s39, s39, 1
E v21,v99
M v[156:159],a[92:95],v[60:63],v[156:159]
s_or_b32 s39, s39, 2
AF v28,v20,v28
C v49,v20,v21
M v[152:155],a[92:95],v[56:59],0
s_sub_u32 s27, 5, s42
AF v28,v21,v28
M v[152:155],a[88:91],v[40:43],v[152:155]
s_waitcnt lgkmcnt(0)
buffer_load_dwordx4 v3, s[8:11], s21 offen offset:3072 sc1 lds
M v[160:163],a[96:99],v[40:43],0
SA m0,s28,69632
R a[64:67],v7,16384
R a[68:71],v7,17408
M v[160:163],a[100:103],v[56:59],v[160:163]
E v22,v104
M v[164:167],a[100:103],v[60:63],0
E v23,v105
M v[164:167],a[96:99],v[44:47],v[164:167]
R a[72:75],v7,18432
R a[76:79],v7,19456
M v[172:175],a[104:107],v[44:47],0
buffer_load_dwordx4 v4, s[8:11], s21 offen offset:0 sc1 lds
M v[172:175],a[108:111],v[60:63],v[172:175]
AF v28,v22,v28
C v50,v22,v23
M v[168:171],a[108:111],v[56:59],0
R a[80:83],v7,20480
R a[84:87],v7,21504
M v[168:171],a[104:107],v[40:43],v[168:171]
buffer_load_dwordx4 v4, s[8:11], s21 offen offset:1024 sc1 lds
M v[176:179],a[112:115],v[40:43],0
E v24,v106
M v[176:179],a[116:119],v[56:59],v[176:179]
R a[88:91],v7,22528
R a[92:95],v7,23552
M v[180:183],a[116:119],v[60:63],0
buffer_load_dwordx4 v4, s[8:11], s21 offen offset:2048 sc1 lds
M v[180:183],a[112:115],v[44:47],v[180:183]
E v25,v107
M v[188:191],a[120:123],v[44:47],0
AF v28,v23,v28
AF v28,v24,v28
M v[188:191],a[124:127],v[60:63],v[188:191]
C v51,v24,v25
AF v28,v25,v28
M v[184:187],a[124:127],v[56:59],0
buffer_load_dwordx4 v4, s[8:11], s21 offen offset:3072 sc1 lds
M v[184:187],a[120:123],v[40:43],v[184:187]
s_waitcnt lgkmcnt(0)
E v18,v100
M v[192:195],a[64:67],v[40:43],0
SA s21,s21,32768
R a[96:99],v7,24576
R a[100:103],v7,25600
M v[192:195],a[68:71],v[56:59],v[192:195]
s_sub_u32 s22, s22, 1
E v19,v101
M v[196:199],a[68:71],v[60:63],0
s_cselect_b32 s21, s23, s21
AF v29,v18,v19
C v52,v18,v19
M v[196:199],a[64:67],v[44:47],v[196:199]
R a[104:107],v7,26624
R a[108:111],v7,27648
M v[204:207],a[72:75],v[44:47],0
M v[204:207],a[76:79],v[60:63],v[204:207]
E v20,v102
M v[200:203],a[76:79],v[56:59],0
R a[112:115],v7,28672
R a[116:119],v7,29696
M v[200:203],a[72:75],v[40:43],v[200:203]
M v[208:211],a[80:83],v[40:43],0
M v[208:211],a[84:87],v[56:59],v[208:211]
R a[120:123],v7,30720
R a[124:127],v7,31744
M v[212:215],a[84:87],v[60:63],0
E v21,v103
M v[212:215],a[80:83],v[44:47],v[212:215]
AF v29,v20,v29
C v53,v20,v21
M v[220:223],a[88:91],v[44:47],0
AF v29,v21,v29
M v[220:223],a[92:95],v[60:63],v[220:223]
E v22,v108
M v[216:219],a[92:95],v[56:59],0
s_waitcnt vmcnt(12) lgkmcnt(0)
M v[216:219],a[88:91],v[40:43],v[216:219]
s_barrier
M v[224:227],a[96:99],v[40:43],0
R a[64:67],v2,32768
R a[68:71],v2,33792
M v[224:227],a[100:103],v[56:59],v[224:227]
E v23,v109
M v[228:231],a[100:103],v[60:63],0
AF v29,v22,v29
C v54,v22,v23
M v[228:231],a[96:99],v[44:47],v[228:231]
R a[72:75],v2,34816
R a[76:79],v2,35840
M v[236:239],a[104:107],v[44:47],0
E v24,v110
M v[236:239],a[108:111],v[60:63],v[236:239]
AF v29,v23,v29
M v[232:235],a[108:111],v[56:59],0
R a[80:83],v2,36864
R a[84:87],v2,37888
M v[232:235],a[104:107],v[40:43],v[232:235]
M v[240:243],a[112:115],v[40:43],0
E v25,v111
M v[240:243],a[116:119],v[56:59],v[240:243]
R a[88:91],v2,38912
R a[92:95],v2,39936
M v[244:247],a[116:119],v[60:63],0
AF v29,v24,v29
C v55,v24,v25
M v[244:247],a[112:115],v[44:47],v[244:247]
AF v29,v25,v29
M v[252:255],a[120:123],v[44:47],0
M v[252:255],a[124:127],v[60:63],v[252:255]
M v[248:251],a[124:127],v[56:59],0
s_waitcnt lgkmcnt(0)
M v[248:251],a[120:123],v[40:43],v[248:251]
s_cmp_lg_u32 s27, 0
s_cbranch_scc1 L_loop_top
L_final_h:
s_waitcnt vmcnt(8) lgkmcnt(0)
s_barrier
R a[64:67],v7,32768
R a[68:71],v7,33792
R a[72:75],v7,34816
R a[76:79],v7,35840
R a[80:83],v7,36864
R a[84:87],v7,37888
R a[88:91],v7,38912
R a[92:95],v7,39936
v_lshrrev_b32 v14, 7, v7
v_mul_u32_u24 v14, 896, v14
v_lshrrev_b32 v15, 8, v7
v_lshlrev_b32 v15, 5, v15
v_xor_b32 v15, v15, v7
v_and_b32 v15, 0x70, v15
v_add_u32 v0, v14, v15
s_mul_i32 s38, s20, 57344
SA m0,s28,98304
SA s85,s38,0
E v18,v112
buffer_load_dwordx4 v0, s[12:15], s85 offen offset:0 lds
E v19,v113
E v20,v114
AF v28,v18,v28
SA s85,s38,6144
C v56,v18,v19
buffer_load_dwordx4 v0, s[12:15], s85 offen offset:1024 lds
E v21,v115
AF v28,v19,v28
E v22,v120
AF v28,v20,v28
SA s85,s38,12288
C v57,v20,v21
buffer_load_dwordx4 v0, s[12:15], s85 offen offset:2048 lds
E v23,v121
AF v28,v21,v28
E v24,v122
AF v28,v22,v28
SA s85,s38,18432
C v58,v22,v23
buffer_load_dwordx4 v0, s[12:15], s85 offen offset:3072 lds
E v25,v123
AF v28,v23,v28
E v18,v116
AF v28,v24,v28
SA m0,s28,102400
SA s85,s38,28672
C v59,v24,v25
buffer_load_dwordx4 v0, s[12:15], s85 offen offset:0 lds
E v19,v117
AF v28,v25,v28
E v20,v118
AF v29,v18,v29
SA s85,s38,34816
C v60,v18,v19
buffer_load_dwordx4 v0, s[12:15], s85 offen offset:1024 lds
E v21,v119
AF v29,v19,v29
E v22,v124
AF v29,v20,v29
SA s85,s38,40960
C v61,v20,v21
buffer_load_dwordx4 v0, s[12:15], s85 offen offset:2048 lds
E v23,v125
AF v29,v21,v29
E v24,v126
AF v29,v22,v29
SA s85,s38,47104
C v62,v22,v23
buffer_load_dwordx4 v0, s[12:15], s85 offen offset:3072 lds
SA s38,s38,128
E v25,v127
AF v29,v23,v29
AF v29,v24,v29
C v63,v24,v25
AF v29,v25,v29
v_max_f32 v10, v28, v29
v_cmp_lt_f32 vcc, s31, v10
s_nop 0
s_cbranch_vccnz L_stfh
L_rtfh:
AF v30,v28,v30
AF v31,v29,v31
v_mov_b32 v10, v32
v_mov_b32 v11, v36
v_mov_b32 v12, v30
v_mov_b32 v13, v31
buffer_store_dwordx4 v[10:13], v7, s[8:11], s90 offen sc1
s_waitcnt lgkmcnt(0)
M v[128:131],a[64:67],v[48:51],v[128:131]
SA m0,s28,65536
R a[96:99],v7,40960
R a[100:103],v7,41984
M v[128:131],a[68:71],v[56:59],v[128:131]
SA s85,s38,0
buffer_load_dwordx4 v0, s[12:15], s85 offen offset:0 lds
M v[132:135],a[68:71],v[60:63],v[132:135]
SA s85,s38,6144
v_lshrrev_b32 v16, 4, v7
v_lshrrev_b32 v14, 2, v16
M v[132:135],a[64:67],v[52:55],v[132:135]
R a[104:107],v7,43008
R a[108:111],v7,44032
M v[136:139],a[72:75],v[48:51],v[136:139]
buffer_load_dwordx4 v0, s[12:15], s85 offen offset:1024 lds
M v[136:139],a[76:79],v[56:59],v[136:139]
SA s85,s38,12288
v_lshlrev_b32 v14, 7, v14
v_and_b32 v15, 3, v16
M v[140:143],a[76:79],v[60:63],v[140:143]
R a[112:115],v7,45056
R a[116:119],v7,46080
M v[140:143],a[72:75],v[52:55],v[140:143]
buffer_load_dwordx4 v0, s[12:15], s85 offen offset:2048 lds
M v[144:147],a[80:83],v[48:51],v[144:147]
SA s85,s38,18432
v_lshl_add_u32 v14, v15, 3, v14
v_bfe_u32 v15, v16, 3, 2
M v[144:147],a[84:87],v[56:59],v[144:147]
R a[120:123],v7,47104
R a[124:127],v7,48128
M v[148:151],a[84:87],v[60:63],v[148:151]
buffer_load_dwordx4 v0, s[12:15], s85 offen offset:3072 lds
M v[148:151],a[80:83],v[52:55],v[148:151]
v_lshl_add_u32 v18, v15, 5, v14
v_xor_b32 v19, 32, v18
M v[152:155],a[88:91],v[48:51],v[152:155]
v_xor_b32 v20, 64, v18
v_xor_b32 v21, 0x60, v18
M v[152:155],a[92:95],v[56:59],v[152:155]
v_add_u32 v22, 0x10000, v18
v_add_u32 v23, 0x10000, v19
M v[156:159],a[92:95],v[60:63],v[156:159]
v_add_u32 v24, 0x10000, v20
v_add_u32 v25, 0x10000, v21
M v[156:159],a[88:91],v[52:55],v[156:159]
s_waitcnt lgkmcnt(0)
C v128,v128,v129
C v129,v130,v131
M v[160:163],a[96:99],v[48:51],v[160:163]
R a[64:67],v7,49152
R a[68:71],v7,50176
M v[160:163],a[100:103],v[56:59],v[160:163]
C v130,v136,v137
C v131,v138,v139
M v[164:167],a[100:103],v[60:63],v[164:167]
buffer_store_dwordx4 v[128:131], v7, s[8:11], s86 offen offset:0 sc1
M v[164:167],a[96:99],v[52:55],v[164:167]
R a[72:75],v7,51200
R a[76:79],v7,52224
M v[168:171],a[104:107],v[48:51],v[168:171]
C v132,v132,v133
C v133,v134,v135
M v[168:171],a[108:111],v[56:59],v[168:171]
C v134,v140,v141
C v135,v142,v143
M v[172:175],a[108:111],v[60:63],v[172:175]
R a[80:83],v7,53248
R a[84:87],v7,54272
M v[172:175],a[104:107],v[52:55],v[172:175]
buffer_store_dwordx4 v[132:135], v7, s[8:11], s88 offen offset:0 sc1
M v[176:179],a[112:115],v[48:51],v[176:179]
C v144,v144,v145
C v145,v146,v147
M v[176:179],a[116:119],v[56:59],v[176:179]
R a[88:91],v7,55296
R a[92:95],v7,56320
M v[180:183],a[116:119],v[60:63],v[180:183]
C v146,v152,v153
C v147,v154,v155
M v[180:183],a[112:115],v[52:55],v[180:183]
buffer_store_dwordx4 v[144:147], v7, s[8:11], s86 offen offset:1024 sc1
M v[184:187],a[120:123],v[48:51],v[184:187]
C v148,v148,v149
C v149,v150,v151
M v[184:187],a[124:127],v[56:59],v[184:187]
C v150,v156,v157
C v151,v158,v159
M v[188:191],a[124:127],v[60:63],v[188:191]
buffer_store_dwordx4 v[148:151], v7, s[8:11], s88 offen offset:1024 sc1
M v[188:191],a[120:123],v[52:55],v[188:191]
s_waitcnt lgkmcnt(0)
C v160,v160,v161
C v161,v162,v163
M v[192:195],a[64:67],v[48:51],v[192:195]
R a[96:99],v7,57344
R a[100:103],v7,58368
M v[192:195],a[68:71],v[56:59],v[192:195]
C v162,v168,v169
C v163,v170,v171
M v[196:199],a[68:71],v[60:63],v[196:199]
buffer_store_dwordx4 v[160:163], v7, s[8:11], s86 offen offset:2048 sc1
M v[196:199],a[64:67],v[52:55],v[196:199]
R a[104:107],v7,59392
R a[108:111],v7,60416
M v[200:203],a[72:75],v[48:51],v[200:203]
C v164,v164,v165
C v165,v166,v167
M v[200:203],a[76:79],v[56:59],v[200:203]
C v166,v172,v173
C v167,v174,v175
M v[204:207],a[76:79],v[60:63],v[204:207]
R a[112:115],v7,61440
R a[116:119],v7,62464
M v[204:207],a[72:75],v[52:55],v[204:207]
buffer_store_dwordx4 v[164:167], v7, s[8:11], s88 offen offset:2048 sc1
M v[208:211],a[80:83],v[48:51],v[208:211]
C v176,v176,v177
C v177,v178,v179
M v[208:211],a[84:87],v[56:59],v[208:211]
R a[120:123],v7,63488
R a[124:127],v7,64512
M v[212:215],a[84:87],v[60:63],v[212:215]
C v178,v184,v185
C v179,v186,v187
M v[212:215],a[80:83],v[52:55],v[212:215]
buffer_store_dwordx4 v[176:179], v7, s[8:11], s86 offen offset:3072 sc1
M v[216:219],a[88:91],v[48:51],v[216:219]
C v180,v180,v181
C v181,v182,v183
M v[216:219],a[92:95],v[56:59],v[216:219]
C v182,v188,v189
C v183,v190,v191
M v[220:223],a[92:95],v[60:63],v[220:223]
s_waitcnt vmcnt(12) lgkmcnt(0)
buffer_store_dwordx4 v[180:183], v7, s[8:11], s88 offen offset:3072 sc1
M v[220:223],a[88:91],v[52:55],v[220:223]
s_barrier
M v[224:227],a[96:99],v[48:51],v[224:227]
s_nop 0
T a[64:65],v22,32768
T a[66:67],v22,34816
M v[224:227],a[100:103],v[56:59],v[224:227]
T a[68:69],v22,36864
T a[70:71],v22,38912
M v[228:231],a[100:103],v[60:63],v[228:231]
C v192,v192,v193
C v193,v194,v195
M v[228:231],a[96:99],v[52:55],v[228:231]
T a[72:73],v22,40960
T a[74:75],v22,43008
M v[232:235],a[104:107],v[48:51],v[232:235]
T a[76:77],v22,45056
T a[78:79],v22,47104
M v[232:235],a[108:111],v[56:59],v[232:235]
C v194,v200,v201
C v195,v202,v203
M v[236:239],a[108:111],v[60:63],v[236:239]
T a[80:81],v22,49152
T a[82:83],v22,51200
M v[236:239],a[104:107],v[52:55],v[236:239]
T a[84:85],v22,53248
T a[86:87],v22,55296
M v[240:243],a[112:115],v[48:51],v[240:243]
buffer_store_dwordx4 v[192:195], v7, s[8:11], s87 offen offset:0 sc1
M v[240:243],a[116:119],v[56:59],v[240:243]
s_nop 0
T a[88:89],v22,57344
T a[90:91],v22,59392
M v[244:247],a[116:119],v[60:63],v[244:247]
T a[92:93],v22,61440
T a[94:95],v22,63488
M v[244:247],a[112:115],v[52:55],v[244:247]
C v196,v196,v197
C v197,v198,v199
M v[248:251],a[120:123],v[48:51],v[248:251]
C v198,v204,v205
C v199,v206,v207
M v[248:251],a[124:127],v[56:59],v[248:251]
buffer_store_dwordx4 v[196:199], v7, s[8:11], s89 offen offset:0 sc1
M v[252:255],a[124:127],v[60:63],v[252:255]
s_waitcnt lgkmcnt(0)
C v208,v208,v209
C v209,v210,v211
M v[252:255],a[120:123],v[52:55],v[252:255]
C v210,v216,v217
C v211,v218,v219
buffer_store_dwordx4 v[208:211], v7, s[8:11], s87 offen offset:1024 sc1
C v212,v212,v213
C v213,v214,v215
C v214,v220,v221
C v215,v222,v223
buffer_store_dwordx4 v[212:215], v7, s[8:11], s89 offen offset:1024 sc1
C v224,v224,v225
C v225,v226,v227
C v226,v232,v233
C v227,v234,v235
buffer_store_dwordx4 v[224:227], v7, s[8:11], s87 offen offset:2048 sc1
C v228,v228,v229
C v229,v230,v231
C v230,v236,v237
C v231,v238,v239
buffer_store_dwordx4 v[228:231], v7, s[8:11], s89 offen offset:2048 sc1
C v240,v240,v241
C v241,v242,v243
C v242,v248,v249
C v243,v250,v251
buffer_store_dwordx4 v[240:243], v7, s[8:11], s87 offen offset:3072 sc1
C v244,v244,v245
C v245,v246,v247
C v246,v252,v253
C v247,v254,v255
buffer_store_dwordx4 v[244:247], v7, s[8:11], s89 offen offset:3072 sc1
M v[64:67],a[64:67],a[128:131],0
s_nop 0
T a[96:97],v23,32768
T a[98:99],v23,34816
M v[64:67],a[68:71],a[132:135],v[64:67]
SA m0,s28,69632
T a[100:101],v23,36864
T a[102:103],v23,38912
M v[64:67],a[72:75],a[136:139],v[64:67]
SA s85,s38,28672
buffer_load_dwordx4 v0, s[12:15], s85 offen offset:0 lds
M v[64:67],a[76:79],a[140:143],v[64:67]
SA s85,s38,34816
T a[104:105],v23,40960
T a[106:107],v23,43008
M v[64:67],a[80:83],a[144:147],v[64:67]
SA s29,s33,0
T a[108:109],v23,45056
T a[110:111],v23,47104
M v[64:67],a[84:87],a[148:151],v[64:67]
SA s30,s33,14336
buffer_load_dwordx4 v0, s[12:15], s85 offen offset:1024 lds
M v[64:67],a[88:91],a[152:155],v[64:67]
SA s85,s38,40960
T a[112:113],v23,49152
T a[114:115],v23,51200
M v[64:67],a[92:95],a[156:159],v[64:67]
T a[116:117],v23,53248
T a[118:119],v23,55296
M v[68:71],a[92:95],a[188:191],0
buffer_load_dwordx4 v0, s[12:15], s85 offen offset:2048 lds
M v[68:71],a[88:91],a[184:187],v[68:71]
SA s85,s38,47104
T a[120:121],v23,57344
T a[122:123],v23,59392
M v[68:71],a[84:87],a[180:183],v[68:71]
T a[124:125],v23,61440
T a[126:127],v23,63488
M v[68:71],a[80:83],a[176:179],v[68:71]
buffer_load_dwordx4 v0, s[12:15], s85 offen offset:3072 lds
M v[68:71],a[76:79],a[172:175],v[68:71]
SA s38,s38,128
G v5,a192
G v6,a193
M v[68:71],a[72:75],a[168:171],v[68:71]
s_sub_u32 s64, 15, s42
M v[68:71],a[68:71],a[164:167],v[68:71]
s_min_u32 s64, s64, s42
M v[68:71],a[64:67],a[160:163],v[68:71]
s_waitcnt lgkmcnt(0)
M v[72:75],a[96:99],a[128:131],0
s_mul_i32 s45, s64, 8704
T a[64:65],v24,32768
T a[66:67],v24,34816
M v[72:75],a[100:103],a[132:135],v[72:75]
s_lshl_b32 s64, s41, 2
T a[68:69],v24,36864
T a[70:71],v24,38912
M v[72:75],a[104:107],a[136:139],v[72:75]
SA s45,s45,s64
M v[72:75],a[108:111],a[140:143],v[72:75]
s_lshl_b32 s64, s20, 8
T a[72:73],v24,40960
T a[74:75],v24,43008
M v[72:75],a[112:115],a[144:147],v[72:75]
SA s45,s45,s64
T a[76:77],v24,45056
T a[78:79],v24,47104
M v[72:75],a[116:119],a[148:151],v[72:75]
SA s45,s45,104992768
M v[72:75],a[120:123],a[152:155],v[72:75]
s_mov_b32 s64, 1024
T a[80:81],v24,49152
T a[82:83],v24,51200
M v[72:75],a[124:127],a[156:159],v[72:75]
s_mov_b32 s66, 4096
T a[84:85],v24,53248
T a[86:87],v24,55296
M v[76:79],a[124:127],a[188:191],0
s_cmp_lt_u32 s42, 8
M v[76:79],a[120:123],a[184:187],v[76:79]
s_cselect_b32 s64, 4352, s64
T a[88:89],v24,57344
T a[90:91],v24,59392
M v[76:79],a[116:119],a[180:183],v[76:79]
s_cselect_b32 s65, 0, 64
T a[92:93],v24,61440
T a[94:95],v24,63488
M v[76:79],a[112:115],a[176:179],v[76:79]
s_cselect_b32 s66, 536870912, s66
MF v64,v5,v64
MF v65,v5,v65
M v[76:79],a[108:111],a[172:175],v[76:79]
SA s3,s45,s64
MF v66,v5,v66
MF v67,v5,v67
M v[76:79],a[104:107],a[168:171],v[76:79]
SA s45,s45,s65
v_lshrrev_b32 v17, 5, v7
v_min_u32 v15, 1, v17
M v[76:79],a[100:103],a[164:167],v[76:79]
SA m0,s28,0
v_lshlrev_b32 v14, 3, v7
v_lshl_or_b32 v16, v15, 29, v14
M v[76:79],a[96:99],a[160:163],v[76:79]
s_waitcnt lgkmcnt(0)
v_cmp_eq_u32 vcc, 1, v17
v_add_u32 v14, s66, v14
M v[80:83],a[64:67],a[128:131],0
SA s85,s38,0
T a[96:97],v25,32768
T a[98:99],v25,34816
M v[80:83],a[68:71],a[132:135],v[80:83]
T a[100:101],v25,36864
T a[102:103],v25,38912
M v[80:83],a[72:75],a[136:139],v[80:83]
buffer_load_dwordx4 v0, s[12:15], s85 offen offset:0 lds
M v[80:83],a[76:79],a[140:143],v[80:83]
SA s85,s38,6144
T a[104:105],v25,40960
T a[106:107],v25,43008
M v[80:83],a[80:83],a[144:147],v[80:83]
T a[108:109],v25,45056
T a[110:111],v25,47104
M v[80:83],a[84:87],a[148:151],v[80:83]
buffer_load_dwordx4 v0, s[12:15], s85 offen offset:1024 lds
M v[80:83],a[88:91],a[152:155],v[80:83]
SA s85,s38,12288
T a[112:113],v25,49152
T a[114:115],v25,51200
M v[80:83],a[92:95],a[156:159],v[80:83]
T a[116:117],v25,53248
T a[118:119],v25,55296
M v[84:87],a[92:95],a[188:191],0
buffer_load_dwordx4 v0, s[12:15], s85 offen offset:2048 lds
M v[84:87],a[88:91],a[184:187],v[84:87]
SA s85,s38,18432
T a[120:121],v25,57344
T a[122:123],v25,59392
M v[84:87],a[84:87],a[180:183],v[84:87]
T a[124:125],v25,61440
T a[126:127],v25,63488
M v[84:87],a[80:83],a[176:179],v[84:87]
buffer_load_dwordx4 v0, s[12:15], s85 offen offset:3072 lds
M v[84:87],a[76:79],a[172:175],v[84:87]
SA m0,s28,4096
v_mov_b32 v15, 1
v_cndmask_b32 v17, v16, v14, vcc
M v[84:87],a[72:75],a[168:171],v[84:87]
SA s85,s38,28672
buffer_load_dwordx4 v0, s[12:15], s85 offen offset:0 lds
M v[84:87],a[68:71],a[164:167],v[84:87]
s_waitcnt vmcnt(5) lgkmcnt(0)
v_min_u32 v10, 1, v7
v_lshlrev_b32 v10, 29, v10
M v[84:87],a[64:67],a[160:163],v[84:87]
s_barrier
M v[88:91],a[96:99],a[128:131],0
SA s85,s38,34816
T a[64:65],v22,0
T a[66:67],v22,2048
M v[88:91],a[100:103],a[132:135],v[88:91]
T a[68:69],v22,4096
T a[70:71],v22,6144
M v[88:91],a[104:107],a[136:139],v[88:91]
buffer_load_dwordx4 v0, s[12:15], s85 offen offset:1024 lds
M v[88:91],a[108:111],a[140:143],v[88:91]
SA s85,s38,40960
T a[72:73],v22,8192
T a[74:75],v22,10240
M v[88:91],a[112:115],a[144:147],v[88:91]
T a[76:77],v22,12288
T a[78:79],v22,14336
M v[88:91],a[116:119],a[148:151],v[88:91]
buffer_load_dwordx4 v0, s[12:15], s85 offen offset:2048 lds
M v[88:91],a[120:123],a[152:155],v[88:91]
SA s85,s38,47104
T a[80:81],v22,16384
T a[82:83],v22,18432
M v[88:91],a[124:127],a[156:159],v[88:91]
T a[84:85],v22,20480
T a[86:87],v22,22528
M v[92:95],a[124:127],a[188:191],0
buffer_store_dword v15, v10, s[8:11], s47 offen sc1
M v[92:95],a[120:123],a[184:187],v[92:95]
s_nop 0
T a[88:89],v22,24576
T a[90:91],v22,26624
M v[92:95],a[116:119],a[180:183],v[92:95]
T a[92:93],v22,28672
T a[94:95],v22,30720
M v[92:95],a[112:115],a[176:179],v[92:95]
buffer_load_dwordx4 v0, s[12:15], s85 offen offset:3072 lds
M v[92:95],a[108:111],a[172:175],v[92:95]
SA s38,s38,128
MF v72,v5,v72
MF v73,v5,v73
M v[92:95],a[104:107],a[168:171],v[92:95]
SA m0,s28,131072
MF v74,v5,v74
MF v75,v5,v75
M v[92:95],a[100:103],a[164:167],v[92:95]
s_waitcnt lgkmcnt(0)
C v64,v64,v65
C v65,v66,v67
M v[92:95],a[96:99],a[160:163],v[92:95]
SA s85,s38,0
C v66,v72,v73
C v67,v74,v75
buffer_store_dwordx4 v[64:67], v7, s[8:11], s29 offen offset:0 sc1
buffer_load_dwordx4 v0, s[12:15], s85 offen offset:0 lds
v_add_u32 v40, 0x20000, v18
v_add_u32 v41, 0x20000, v19
v_add_u32 v42, 0x20000, v20
v_add_u32 v43, 0x20000, v21
SA s85,s38,6144
MF v68,v6,v68
MF v69,v6,v69
MF v70,v6,v70
MF v71,v6,v71
MF v76,v6,v76
MF v77,v6,v77
MF v78,v6,v78
MF v79,v6,v79
C v68,v68,v69
C v69,v70,v71
C v70,v76,v77
C v71,v78,v79
buffer_store_dwordx4 v[68:71], v7, s[8:11], s30 offen offset:0 sc1
buffer_load_dwordx4 v0, s[12:15], s85 offen offset:1024 lds
SA s85,s38,12288
buffer_load_dwordx4 v0, s[12:15], s85 offen offset:2048 lds
SA s85,s38,18432
buffer_load_dwordx4 v0, s[12:15], s85 offen offset:3072 lds
M v[96:99],a[64:67],a[128:131],0
s_nop 0
T a[96:97],v23,0
T a[98:99],v23,2048
M v[96:99],a[68:71],a[132:135],v[96:99]
SA m0,s28,135168
T a[100:101],v23,4096
T a[102:103],v23,6144
M v[96:99],a[72:75],a[136:139],v[96:99]
SA s85,s38,28672
buffer_load_dwordx4 v0, s[12:15], s85 offen offset:0 lds
M v[96:99],a[76:79],a[140:143],v[96:99]
SA s85,s38,34816
T a[104:105],v23,8192
T a[106:107],v23,10240
M v[96:99],a[80:83],a[144:147],v[96:99]
T a[108:109],v23,12288
T a[110:111],v23,14336
M v[96:99],a[84:87],a[148:151],v[96:99]
buffer_load_dwordx4 v0, s[12:15], s85 offen offset:1024 lds
M v[96:99],a[88:91],a[152:155],v[96:99]
SA s85,s38,40960
T a[112:113],v23,16384
T a[114:115],v23,18432
M v[96:99],a[92:95],a[156:159],v[96:99]
T a[116:117],v23,20480
T a[118:119],v23,22528
M v[100:103],a[92:95],a[188:191],0
buffer_load_dwordx4 v0, s[12:15], s85 offen offset:2048 lds
M v[100:103],a[88:91],a[184:187],v[100:103]
SA s85,s38,47104
T a[120:121],v23,24576
T a[122:123],v23,26624
M v[100:103],a[84:87],a[180:183],v[100:103]
T a[124:125],v23,28672
T a[126:127],v23,30720
M v[100:103],a[80:83],a[176:179],v[100:103]
buffer_load_dwordx4 v0, s[12:15], s85 offen offset:3072 lds
M v[100:103],a[76:79],a[172:175],v[100:103]
SA s38,s38,128
MF v80,v5,v80
MF v81,v5,v81
M v[100:103],a[72:75],a[168:171],v[100:103]
SA m0,s28,32768
MF v82,v5,v82
MF v83,v5,v83
M v[100:103],a[68:71],a[164:167],v[100:103]
SA s85,s38,0
buffer_load_dwordx4 v0, s[12:15], s85 offen offset:0 lds
M v[100:103],a[64:67],a[160:163],v[100:103]
s_waitcnt lgkmcnt(0)
MF v88,v5,v88
MF v89,v5,v89
M v[104:107],a[96:99],a[128:131],0
SA s85,s38,6144
T a[64:65],v24,0
T a[66:67],v24,2048
M v[104:107],a[100:103],a[132:135],v[104:107]
T a[68:69],v24,4096
T a[70:71],v24,6144
M v[104:107],a[104:107],a[136:139],v[104:107]
buffer_load_dwordx4 v0, s[12:15], s85 offen offset:1024 lds
M v[104:107],a[108:111],a[140:143],v[104:107]
SA s85,s38,12288
T a[72:73],v24,8192
T a[74:75],v24,10240
M v[104:107],a[112:115],a[144:147],v[104:107]
T a[76:77],v24,12288
T a[78:79],v24,14336
M v[104:107],a[116:119],a[148:151],v[104:107]
buffer_load_dwordx4 v0, s[12:15], s85 offen offset:2048 lds
M v[104:107],a[120:123],a[152:155],v[104:107]
SA s85,s38,18432
T a[80:81],v24,16384
T a[82:83],v24,18432
M v[104:107],a[124:127],a[156:159],v[104:107]
T a[84:85],v24,20480
T a[86:87],v24,22528
M v[108:111],a[124:127],a[188:191],0
buffer_load_dwordx4 v0, s[12:15], s85 offen offset:3072 lds
M v[108:111],a[120:123],a[184:187],v[108:111]
SA m0,s28,36864
T a[88:89],v24,24576
T a[90:91],v24,26624
M v[108:111],a[116:119],a[180:183],v[108:111]
SA s85,s38,28672
T a[92:93],v24,28672
T a[94:95],v24,30720
M v[108:111],a[112:115],a[176:179],v[108:111]
buffer_load_dwordx4 v0, s[12:15], s85 offen offset:0 lds
M v[108:111],a[108:111],a[172:175],v[108:111]
SA s85,s38,34816
MF v90,v5,v90
MF v91,v5,v91
M v[108:111],a[104:107],a[168:171],v[108:111]
C v80,v80,v81
C v81,v82,v83
M v[108:111],a[100:103],a[164:167],v[108:111]
buffer_load_dwordx4 v0, s[12:15], s85 offen offset:1024 lds
M v[108:111],a[96:99],a[160:163],v[108:111]
s_waitcnt lgkmcnt(0)
C v82,v88,v89
C v83,v90,v91
M v[112:115],a[64:67],a[128:131],0
SA s85,s38,40960
T a[96:97],v25,0
T a[98:99],v25,2048
M v[112:115],a[68:71],a[132:135],v[112:115]
T a[100:101],v25,4096
T a[102:103],v25,6144
M v[112:115],a[72:75],a[136:139],v[112:115]
buffer_store_dwordx4 v[80:83], v7, s[8:11], s29 offen offset:1024 sc1
M v[112:115],a[76:79],a[140:143],v[112:115]
s_nop 0
T a[104:105],v25,8192
T a[106:107],v25,10240
M v[112:115],a[80:83],a[144:147],v[112:115]
T a[108:109],v25,12288
T a[110:111],v25,14336
M v[112:115],a[84:87],a[148:151],v[112:115]
buffer_load_dwordx4 v0, s[12:15], s85 offen offset:2048 lds
M v[112:115],a[88:91],a[152:155],v[112:115]
SA s85,s38,47104
T a[112:113],v25,16384
T a[114:115],v25,18432
M v[112:115],a[92:95],a[156:159],v[112:115]
T a[116:117],v25,20480
T a[118:119],v25,22528
M v[116:119],a[92:95],a[188:191],0
buffer_load_dwordx4 v0, s[12:15], s85 offen offset:3072 lds
M v[116:119],a[88:91],a[184:187],v[116:119]
SA s38,s38,128
T a[120:121],v25,24576
T a[122:123],v25,26624
M v[116:119],a[84:87],a[180:183],v[116:119]
SA m0,s28,98304
T a[124:125],v25,28672
T a[126:127],v25,30720
M v[116:119],a[80:83],a[176:179],v[116:119]
SA s85,s38,0
buffer_load_dwordx4 v0, s[12:15], s85 offen offset:0 lds
M v[116:119],a[76:79],a[172:175],v[116:119]
SA s85,s38,6144
MF v84,v6,v84
MF v85,v6,v85
M v[116:119],a[72:75],a[168:171],v[116:119]
buffer_load_dwordx4 v0, s[12:15], s85 offen offset:1024 lds
M v[116:119],a[68:71],a[164:167],v[116:119]
s_waitcnt vmcnt(21) lgkmcnt(0)
MF v86,v6,v86
MF v87,v6,v87
M v[116:119],a[64:67],a[160:163],v[116:119]
s_barrier
M v[120:123],a[96:99],a[128:131],0
SA s85,s38,12288
T a[64:65],v18,0
T a[66:67],v18,2048
M v[120:123],a[100:103],a[132:135],v[120:123]
T a[68:69],v18,4096
T a[70:71],v18,6144
M v[120:123],a[104:107],a[136:139],v[120:123]
buffer_load_dwordx4 v0, s[12:15], s85 offen offset:2048 lds
M v[120:123],a[108:111],a[140:143],v[120:123]
SA s85,s38,18432
T a[72:73],v18,8192
T a[74:75],v18,10240
M v[120:123],a[112:115],a[144:147],v[120:123]
T a[76:77],v18,12288
T a[78:79],v18,14336
M v[120:123],a[116:119],a[148:151],v[120:123]
buffer_load_dwordx4 v0, s[12:15], s85 offen offset:3072 lds
M v[120:123],a[120:123],a[152:155],v[120:123]
s_nop 0
T a[80:81],v18,16384
T a[82:83],v18,18432
M v[120:123],a[124:127],a[156:159],v[120:123]
T a[84:85],v18,20480
T a[86:87],v18,22528
M v[124:127],a[124:127],a[188:191],0
MF v92,v6,v92
MF v93,v6,v93
M v[124:127],a[120:123],a[184:187],v[124:127]
T a[88:89],v18,24576
T a[90:91],v18,26624
M v[124:127],a[116:119],a[180:183],v[124:127]
T a[92:93],v18,28672
T a[94:95],v18,30720
M v[124:127],a[112:115],a[176:179],v[124:127]
MF v94,v6,v94
MF v95,v6,v95
M v[124:127],a[108:111],a[172:175],v[124:127]
C v84,v84,v85
C v85,v86,v87
M v[124:127],a[104:107],a[168:171],v[124:127]
C v86,v92,v93
C v87,v94,v95
M v[124:127],a[100:103],a[164:167],v[124:127]
s_waitcnt lgkmcnt(0)
buffer_store_dwordx4 v[84:87], v7, s[8:11], s30 offen offset:1024 sc1
M v[124:127],a[96:99],a[160:163],v[124:127]
SA s29,s33,2048
SA s30,s33,16384
MF v96,v5,v96
MF v97,v5,v97
MF v98,v5,v98
MF v99,v5,v99
MF v104,v5,v104
MF v105,v5,v105
MF v106,v5,v106
MF v107,v5,v107
C v96,v96,v97
C v97,v98,v99
C v98,v104,v105
C v99,v106,v107
buffer_store_dwordx4 v[96:99], v7, s[8:11], s29 offen offset:0 sc1
MF v100,v6,v100
MF v101,v6,v101
MF v102,v6,v102
MF v103,v6,v103
MF v108,v6,v108
MF v109,v6,v109
MF v110,v6,v110
MF v111,v6,v111
C v100,v100,v101
C v101,v102,v103
C v102,v108,v109
C v103,v110,v111
buffer_store_dwordx4 v[100:103], v7, s[8:11], s30 offen offset:0 sc1
M v[64:67],a[64:67],a[128:131],0
s_nop 0
T a[96:97],v19,0
T a[98:99],v19,2048
M v[64:67],a[68:71],a[132:135],v[64:67]
SA m0,s28,102400
T a[100:101],v19,4096
T a[102:103],v19,6144
M v[64:67],a[72:75],a[136:139],v[64:67]
SA s85,s38,28672
buffer_load_dwordx4 v0, s[12:15], s85 offen offset:0 lds
M v[64:67],a[76:79],a[140:143],v[64:67]
SA s85,s38,34816
T a[104:105],v19,8192
T a[106:107],v19,10240
M v[64:67],a[80:83],a[144:147],v[64:67]
T a[108:109],v19,12288
T a[110:111],v19,14336
M v[64:67],a[84:87],a[148:151],v[64:67]
buffer_load_dwordx4 v0, s[12:15], s85 offen offset:1024 lds
M v[64:67],a[88:91],a[152:155],v[64:67]
s_nop 0
T a[112:113],v19,16384
T a[114:115],v19,18432
M v[64:67],a[92:95],a[156:159],v[64:67]
SA s85,s38,40960
T a[116:117],v19,20480
T a[118:119],v19,22528
M v[68:71],a[92:95],a[188:191],0
buffer_load_dwordx4 v0, s[12:15], s85 offen offset:2048 lds
M v[68:71],a[88:91],a[184:187],v[68:71]
s_nop 0
T a[120:121],v19,24576
T a[122:123],v19,26624
M v[68:71],a[84:87],a[180:183],v[68:71]
T a[124:125],v19,28672
T a[126:127],v19,30720
M v[68:71],a[80:83],a[176:179],v[68:71]
SA s85,s38,47104
MF v112,v5,v112
MF v113,v5,v113
M v[68:71],a[76:79],a[172:175],v[68:71]
buffer_load_dwordx4 v0, s[12:15], s85 offen offset:3072 lds
M v[68:71],a[72:75],a[168:171],v[68:71]
SA s38,s38,128
MF v114,v5,v114
MF v115,v5,v115
M v[68:71],a[68:71],a[164:167],v[68:71]
SA m0,s28,65536
MF v120,v5,v120
MF v121,v5,v121
M v[68:71],a[64:67],a[160:163],v[68:71]
s_waitcnt lgkmcnt(0)
MF v122,v5,v122
MF v123,v5,v123
M v[72:75],a[96:99],a[128:131],0
SA s85,s38,0
T a[64:65],v20,0
T a[66:67],v20,2048
M v[72:75],a[100:103],a[132:135],v[72:75]
T a[68:69],v20,4096
T a[70:71],v20,6144
M v[72:75],a[104:107],a[136:139],v[72:75]
buffer_load_dwordx4 v0, s[12:15], s85 offen offset:0 lds
M v[72:75],a[108:111],a[140:143],v[72:75]
SA s85,s38,6144
T a[72:73],v20,8192
T a[74:75],v20,10240
M v[72:75],a[112:115],a[144:147],v[72:75]
T a[76:77],v20,12288
T a[78:79],v20,14336
M v[72:75],a[116:119],a[148:151],v[72:75]
buffer_load_dwordx4 v0, s[12:15], s85 offen offset:1024 lds
M v[72:75],a[120:123],a[152:155],v[72:75]
SA s85,s38,12288
T a[80:81],v20,16384
T a[82:83],v20,18432
M v[72:75],a[124:127],a[156:159],v[72:75]
T a[84:85],v20,20480
T a[86:87],v20,22528
M v[76:79],a[124:127],a[188:191],0
buffer_load_dwordx4 v0, s[12:15], s85 offen offset:2048 lds
M v[76:79],a[120:123],a[184:187],v[76:79]
SA s85,s38,18432
T a[88:89],v20,24576
T a[90:91],v20,26624
M v[76:79],a[116:119],a[180:183],v[76:79]
T a[92:93],v20,28672
T a[94:95],v20,30720
M v[76:79],a[112:115],a[176:179],v[76:79]
buffer_load_dwordx4 v0, s[12:15], s85 offen offset:3072 lds
M v[76:79],a[108:111],a[172:175],v[76:79]
SA m0,s28,69632
C v112,v112,v113
C v113,v114,v115
M v[76:79],a[104:107],a[168:171],v[76:79]
SA s85,s38,28672
C v114,v120,v121
C v115,v122,v123
M v[76:79],a[100:103],a[164:167],v[76:79]
buffer_store_dwordx4 v[112:115], v7, s[8:11], s29 offen offset:1024 sc1
M v[76:79],a[96:99],a[160:163],v[76:79]
s_waitcnt lgkmcnt(0)
MF v116,v6,v116
MF v117,v6,v117
M v[80:83],a[64:67],a[128:131],0
T a[96:97],v21,0
T a[98:99],v21,2048
M v[80:83],a[68:71],a[132:135],v[80:83]
T a[100:101],v21,4096
T a[102:103],v21,6144
M v[80:83],a[72:75],a[136:139],v[80:83]
buffer_load_dwordx4 v0, s[12:15], s85 offen offset:0 lds
M v[80:83],a[76:79],a[140:143],v[80:83]
SA s85,s38,34816
T a[104:105],v21,8192
T a[106:107],v21,10240
M v[80:83],a[80:83],a[144:147],v[80:83]
T a[108:109],v21,12288
T a[110:111],v21,14336
M v[80:83],a[84:87],a[148:151],v[80:83]
buffer_load_dwordx4 v0, s[12:15], s85 offen offset:1024 lds
M v[80:83],a[88:91],a[152:155],v[80:83]
SA s85,s38,40960
T a[112:113],v21,16384
T a[114:115],v21,18432
M v[80:83],a[92:95],a[156:159],v[80:83]
T a[116:117],v21,20480
T a[118:119],v21,22528
M v[84:87],a[92:95],a[188:191],0
buffer_load_dwordx4 v0, s[12:15], s85 offen offset:2048 lds
M v[84:87],a[88:91],a[184:187],v[84:87]
SA s85,s38,47104
T a[120:121],v21,24576
T a[122:123],v21,26624
M v[84:87],a[84:87],a[180:183],v[84:87]
T a[124:125],v21,28672
T a[126:127],v21,30720
M v[84:87],a[80:83],a[176:179],v[84:87]
buffer_load_dwordx4 v0, s[12:15], s85 offen offset:3072 lds
M v[84:87],a[76:79],a[172:175],v[84:87]
MF v118,v6,v118
MF v119,v6,v119
M v[84:87],a[72:75],a[168:171],v[84:87]
SA s38,s38,128
MF v124,v6,v124
MF v125,v6,v125
M v[84:87],a[68:71],a[164:167],v[84:87]
s_waitcnt vmcnt(29) lgkmcnt(0)
MF v126,v6,v126
MF v127,v6,v127
M v[84:87],a[64:67],a[160:163],v[84:87]
s_barrier
M v[88:91],a[96:99],a[128:131],0
s_nop 0
T a[64:65],v40,0
T a[66:67],v40,2048
M v[88:91],a[100:103],a[132:135],v[88:91]
T a[68:69],v40,4096
T a[70:71],v40,6144
M v[88:91],a[104:107],a[136:139],v[88:91]
C v116,v116,v117
C v117,v118,v119
M v[88:91],a[108:111],a[140:143],v[88:91]
T a[72:73],v40,8192
T a[74:75],v40,10240
M v[88:91],a[112:115],a[144:147],v[88:91]
T a[76:77],v40,12288
T a[78:79],v40,14336
M v[88:91],a[116:119],a[148:151],v[88:91]
C v118,v124,v125
C v119,v126,v127
M v[88:91],a[120:123],a[152:155],v[88:91]
T a[80:81],v40,16384
T a[82:83],v40,18432
M v[88:91],a[124:127],a[156:159],v[88:91]
T a[84:85],v40,20480
T a[86:87],v40,22528
M v[92:95],a[124:127],a[188:191],0
buffer_store_dwordx4 v[116:119], v7, s[8:11], s30 offen offset:1024 sc1
M v[92:95],a[120:123],a[184:187],v[92:95]
SA s29,s33,4096
T a[88:89],v40,24576
T a[90:91],v40,26624
M v[92:95],a[116:119],a[180:183],v[92:95]
SA s30,s33,18432
T a[92:93],v40,28672
T a[94:95],v40,30720
M v[92:95],a[112:115],a[176:179],v[92:95]
MF v64,v5,v64
MF v65,v5,v65
M v[92:95],a[108:111],a[172:175],v[92:95]
MF v66,v5,v66
MF v67,v5,v67
M v[92:95],a[104:107],a[168:171],v[92:95]
MF v72,v5,v72
MF v73,v5,v73
M v[92:95],a[100:103],a[164:167],v[92:95]
s_waitcnt lgkmcnt(0)
MF v74,v5,v74
MF v75,v5,v75
M v[92:95],a[96:99],a[160:163],v[92:95]
C v64,v64,v65
C v65,v66,v67
C v66,v72,v73
C v67,v74,v75
buffer_store_dwordx4 v[64:67], v7, s[8:11], s29 offen offset:0 sc1
MF v68,v6,v68
MF v69,v6,v69
MF v70,v6,v70
MF v71,v6,v71
MF v76,v6,v76
MF v77,v6,v77
MF v78,v6,v78
MF v79,v6,v79
C v68,v68,v69
C v69,v70,v71
C v70,v76,v77
C v71,v78,v79
buffer_store_dwordx4 v[68:71], v7, s[8:11], s30 offen offset:0 sc1
M v[96:99],a[64:67],a[128:131],0
s_nop 0
T a[96:97],v41,0
T a[98:99],v41,2048
M v[96:99],a[68:71],a[132:135],v[96:99]
T a[100:101],v41,4096
T a[102:103],v41,6144
M v[96:99],a[72:75],a[136:139],v[96:99]
MF v80,v5,v80
MF v81,v5,v81
M v[96:99],a[76:79],a[140:143],v[96:99]
T a[104:105],v41,8192
T a[106:107],v41,10240
M v[96:99],a[80:83],a[144:147],v[96:99]
T a[108:109],v41,12288
T a[110:111],v41,14336
M v[96:99],a[84:87],a[148:151],v[96:99]
MF v82,v5,v82
MF v83,v5,v83
M v[96:99],a[88:91],a[152:155],v[96:99]
T a[112:113],v41,16384
T a[114:115],v41,18432
M v[96:99],a[92:95],a[156:159],v[96:99]
T a[116:117],v41,20480
T a[118:119],v41,22528
M v[100:103],a[92:95],a[188:191],0
MF v88,v5,v88
MF v89,v5,v89
M v[100:103],a[88:91],a[184:187],v[100:103]
T a[120:121],v41,24576
T a[122:123],v41,26624
M v[100:103],a[84:87],a[180:183],v[100:103]
T a[124:125],v41,28672
T a[126:127],v41,30720
M v[100:103],a[80:83],a[176:179],v[100:103]
MF v90,v5,v90
MF v91,v5,v91
M v[100:103],a[76:79],a[172:175],v[100:103]
C v80,v80,v81
C v81,v82,v83
M v[100:103],a[72:75],a[168:171],v[100:103]
C v82,v88,v89
C v83,v90,v91
M v[100:103],a[68:71],a[164:167],v[100:103]
buffer_store_dwordx4 v[80:83], v7, s[8:11], s29 offen offset:1024 sc1
M v[100:103],a[64:67],a[160:163],v[100:103]
s_waitcnt lgkmcnt(0)
MF v84,v6,v84
MF v85,v6,v85
M v[104:107],a[96:99],a[128:131],0
T a[64:65],v42,0
T a[66:67],v42,2048
M v[104:107],a[100:103],a[132:135],v[104:107]
T a[68:69],v42,4096
T a[70:71],v42,6144
M v[104:107],a[104:107],a[136:139],v[104:107]
MF v86,v6,v86
MF v87,v6,v87
M v[104:107],a[108:111],a[140:143],v[104:107]
T a[72:73],v42,8192
T a[74:75],v42,10240
M v[104:107],a[112:115],a[144:147],v[104:107]
T a[76:77],v42,12288
T a[78:79],v42,14336
M v[104:107],a[116:119],a[148:151],v[104:107]
MF v92,v6,v92
MF v93,v6,v93
M v[104:107],a[120:123],a[152:155],v[104:107]
T a[80:81],v42,16384
T a[82:83],v42,18432
M v[104:107],a[124:127],a[156:159],v[104:107]
T a[84:85],v42,20480
T a[86:87],v42,22528
M v[108:111],a[124:127],a[188:191],0
MF v94,v6,v94
MF v95,v6,v95
M v[108:111],a[120:123],a[184:187],v[108:111]
T a[88:89],v42,24576
T a[90:91],v42,26624
M v[108:111],a[116:119],a[180:183],v[108:111]
T a[92:93],v42,28672
T a[94:95],v42,30720
M v[108:111],a[112:115],a[176:179],v[108:111]
C v84,v84,v85
C v85,v86,v87
M v[108:111],a[108:111],a[172:175],v[108:111]
C v86,v92,v93
C v87,v94,v95
M v[108:111],a[104:107],a[168:171],v[108:111]
buffer_store_dwordx4 v[84:87], v7, s[8:11], s30 offen offset:1024 sc1
M v[108:111],a[100:103],a[164:167],v[108:111]
SA s29,s33,6144
M v[108:111],a[96:99],a[160:163],v[108:111]
s_waitcnt lgkmcnt(0)
M v[112:115],a[64:67],a[128:131],0
SA s30,s33,20480
T a[96:97],v43,0
T a[98:99],v43,2048
M v[112:115],a[68:71],a[132:135],v[112:115]
T a[100:101],v43,4096
T a[102:103],v43,6144
M v[112:115],a[72:75],a[136:139],v[112:115]
MF v96,v5,v96
MF v97,v5,v97
M v[112:115],a[76:79],a[140:143],v[112:115]
T a[104:105],v43,8192
T a[106:107],v43,10240
M v[112:115],a[80:83],a[144:147],v[112:115]
T a[108:109],v43,12288
T a[110:111],v43,14336
M v[112:115],a[84:87],a[148:151],v[112:115]
MF v98,v5,v98
MF v99,v5,v99
M v[112:115],a[88:91],a[152:155],v[112:115]
T a[112:113],v43,16384
T a[114:115],v43,18432
M v[112:115],a[92:95],a[156:159],v[112:115]
T a[116:117],v43,20480
T a[118:119],v43,22528
M v[116:119],a[92:95],a[188:191],0
MF v104,v5,v104
MF v105,v5,v105
M v[116:119],a[88:91],a[184:187],v[116:119]
T a[120:121],v43,24576
T a[122:123],v43,26624
M v[116:119],a[84:87],a[180:183],v[116:119]
T a[124:125],v43,28672
T a[126:127],v43,30720
M v[116:119],a[80:83],a[176:179],v[116:119]
MF v106,v5,v106
MF v107,v5,v107
M v[116:119],a[76:79],a[172:175],v[116:119]
C v96,v96,v97
C v97,v98,v99
M v[116:119],a[72:75],a[168:171],v[116:119]
C v98,v104,v105
C v99,v106,v107
M v[116:119],a[68:71],a[164:167],v[116:119]
s_waitcnt vmcnt(25) lgkmcnt(0)
buffer_store_dwordx4 v[96:99], v7, s[8:11], s29 offen offset:0 sc1
M v[116:119],a[64:67],a[160:163],v[116:119]
s_barrier
M v[120:123],a[96:99],a[128:131],0
s_nop 0
T a[64:65],v18,32768
T a[66:67],v18,34816
M v[120:123],a[100:103],a[132:135],v[120:123]
T a[68:69],v18,36864
T a[70:71],v18,38912
M v[120:123],a[104:107],a[136:139],v[120:123]
MF v100,v6,v100
MF v101,v6,v101
M v[120:123],a[108:111],a[140:143],v[120:123]
T a[72:73],v18,40960
T a[74:75],v18,43008
M v[120:123],a[112:115],a[144:147],v[120:123]
T a[76:77],v18,45056
T a[78:79],v18,47104
M v[120:123],a[116:119],a[148:151],v[120:123]
MF v102,v6,v102
MF v103,v6,v103
M v[120:123],a[120:123],a[152:155],v[120:123]
T a[80:81],v18,49152
T a[82:83],v18,51200
M v[120:123],a[124:127],a[156:159],v[120:123]
T a[84:85],v18,53248
T a[86:87],v18,55296
M v[124:127],a[124:127],a[188:191],0
MF v108,v6,v108
MF v109,v6,v109
M v[124:127],a[120:123],a[184:187],v[124:127]
T a[88:89],v18,57344
T a[90:91],v18,59392
M v[124:127],a[116:119],a[180:183],v[124:127]
T a[92:93],v18,61440
T a[94:95],v18,63488
M v[124:127],a[112:115],a[176:179],v[124:127]
MF v110,v6,v110
MF v111,v6,v111
M v[124:127],a[108:111],a[172:175],v[124:127]
C v100,v100,v101
C v101,v102,v103
M v[124:127],a[104:107],a[168:171],v[124:127]
C v102,v108,v109
C v103,v110,v111
M v[124:127],a[100:103],a[164:167],v[124:127]
s_waitcnt lgkmcnt(0)
buffer_store_dwordx4 v[100:103], v7, s[8:11], s30 offen offset:0 sc1
M v[124:127],a[96:99],a[160:163],v[124:127]
M v[64:67],a[64:67],a[128:131],0
s_nop 0
T a[96:97],v19,32768
T a[98:99],v19,34816
M v[64:67],a[68:71],a[132:135],v[64:67]
T a[100:101],v19,36864
T a[102:103],v19,38912
M v[64:67],a[72:75],a[136:139],v[64:67]
v_lshrrev_b32 v32, 4, v7
MF v112,v5,v112
M v[64:67],a[76:79],a[140:143],v[64:67]
s_lshr_b32 s74, s41, 3
T a[104:105],v19,40960
T a[106:107],v19,43008
M v[64:67],a[80:83],a[144:147],v[64:67]
s_lshl_b32 s64, s42, 1
T a[108:109],v19,45056
T a[110:111],v19,47104
M v[64:67],a[84:87],a[148:151],v[64:67]
SA s46,s64,s74
MF v113,v5,v113
MF v114,v5,v114
M v[64:67],a[88:91],a[152:155],v[64:67]
s_mul_i32 s46, s46, 4352
T a[112:113],v19,49152
T a[114:115],v19,51200
M v[64:67],a[92:95],a[156:159],v[64:67]
s_and_b32 s72, s41, 7
T a[116:117],v19,53248
T a[118:119],v19,55296
M v[68:71],a[92:95],a[188:191],0
s_lshl_b32 s65, s72, 7
MF v115,v5,v115
MF v120,v5,v120
M v[68:71],a[88:91],a[184:187],v[68:71]
SA s46,s46,s65
T a[120:121],v19,57344
T a[122:123],v19,59392
M v[68:71],a[84:87],a[180:183],v[68:71]
SA s46,s46,104992768
T a[124:125],v19,61440
T a[126:127],v19,63488
M v[68:71],a[80:83],a[176:179],v[68:71]
v_and_b32 v33, 31, v32
MF v121,v5,v121
M v[68:71],a[76:79],a[172:175],v[68:71]
MF v122,v5,v122
MF v123,v5,v123
M v[68:71],a[72:75],a[168:171],v[68:71]
C v112,v112,v113
C v113,v114,v115
M v[68:71],a[68:71],a[164:167],v[68:71]
C v114,v120,v121
C v115,v122,v123
M v[68:71],a[64:67],a[160:163],v[68:71]
s_waitcnt lgkmcnt(0)
buffer_store_dwordx4 v[112:115], v7, s[8:11], s29 offen offset:1024 sc1
M v[72:75],a[96:99],a[128:131],0
s_nop 0
T a[64:65],v20,32768
T a[66:67],v20,34816
M v[72:75],a[100:103],a[132:135],v[72:75]
T a[68:69],v20,36864
T a[70:71],v20,38912
M v[72:75],a[104:107],a[136:139],v[72:75]
MF v116,v6,v116
MF v117,v6,v117
M v[72:75],a[108:111],a[140:143],v[72:75]
T a[72:73],v20,40960
T a[74:75],v20,43008
M v[72:75],a[112:115],a[144:147],v[72:75]
T a[76:77],v20,45056
T a[78:79],v20,47104
M v[72:75],a[116:119],a[148:151],v[72:75]
MF v118,v6,v118
MF v119,v6,v119
M v[72:75],a[120:123],a[152:155],v[72:75]
T a[80:81],v20,49152
T a[82:83],v20,51200
M v[72:75],a[124:127],a[156:159],v[72:75]
T a[84:85],v20,53248
T a[86:87],v20,55296
M v[76:79],a[124:127],a[188:191],0
MF v124,v6,v124
MF v125,v6,v125
M v[76:79],a[120:123],a[184:187],v[76:79]
T a[88:89],v20,57344
T a[90:91],v20,59392
M v[76:79],a[116:119],a[180:183],v[76:79]
T a[92:93],v20,61440
T a[94:95],v20,63488
M v[76:79],a[112:115],a[176:179],v[76:79]
MF v126,v6,v126
MF v127,v6,v127
M v[76:79],a[108:111],a[172:175],v[76:79]
C v116,v116,v117
C v117,v118,v119
M v[76:79],a[104:107],a[168:171],v[76:79]
C v118,v124,v125
C v119,v126,v127
M v[76:79],a[100:103],a[164:167],v[76:79]
buffer_store_dwordx4 v[116:119], v7, s[8:11], s30 offen offset:1024 sc1
M v[76:79],a[96:99],a[160:163],v[76:79]
s_waitcnt lgkmcnt(0)
v_lshlrev_b32 v33, 2, v33
M v[80:83],a[64:67],a[128:131],0
SA s29,s33,8192
T a[96:97],v21,32768
T a[98:99],v21,34816
M v[80:83],a[68:71],a[132:135],v[80:83]
SA s30,s33,22528
T a[100:101],v21,36864
T a[102:103],v21,38912
M v[80:83],a[72:75],a[136:139],v[80:83]
s_lshl_b32 s65, s41, 7
MF v64,v5,v64
MF v65,v5,v65
M v[80:83],a[76:79],a[140:143],v[80:83]
SA s65,s65,104890368
T a[104:105],v21,40960
T a[106:107],v21,43008
M v[80:83],a[80:83],a[144:147],v[80:83]
T a[108:109],v21,45056
T a[110:111],v21,47104
M v[80:83],a[84:87],a[148:151],v[80:83]
buffer_load_dword v31, v33, s[8:11], s65 offen sc1
M v[80:83],a[88:91],a[152:155],v[80:83]
s_nop 0
T a[112:113],v21,49152
T a[114:115],v21,51200
M v[80:83],a[92:95],a[156:159],v[80:83]
T a[116:117],v21,53248
T a[118:119],v21,55296
M v[84:87],a[92:95],a[188:191],0
v_bfe_u32 v34, v32, 4, 1
v_lshlrev_b32 v34, 1, v34
M v[84:87],a[88:91],a[184:187],v[84:87]
T a[120:121],v21,57344
T a[122:123],v21,59392
M v[84:87],a[84:87],a[180:183],v[84:87]
T a[124:125],v21,61440
T a[126:127],v21,63488
M v[84:87],a[80:83],a[176:179],v[84:87]
v_lshrrev_b32 v35, 5, v32
v_add_u32 v34, v34, v35
M v[84:87],a[76:79],a[172:175],v[84:87]
s_mov_b32 s52, s96
MF v66,v5,v66
MF v67,v5,v67
M v[84:87],a[72:75],a[168:171],v[84:87]
s_and_b32 s53, s97, 0xffff
MF v72,v5,v72
MF v73,v5,v73
M v[84:87],a[68:71],a[164:167],v[84:87]
s_waitcnt vmcnt(19) lgkmcnt(0)
MF v74,v5,v74
MF v75,v5,v75
M v[84:87],a[64:67],a[160:163],v[84:87]
s_barrier
M v[88:91],a[96:99],a[128:131],0
s_mov_b32 s54, 1835008
T a[64:65],v22,32768
T a[66:67],v22,34816
M v[88:91],a[100:103],a[132:135],v[88:91]
s_mov_b32 s55, 0x20000
T a[68:69],v22,36864
T a[70:71],v22,38912
M v[88:91],a[104:107],a[136:139],v[88:91]
s_mul_i32 s77, s42, 1835008
C v64,v64,v65
C v65,v66,v67
M v[88:91],a[108:111],a[140:143],v[88:91]
s_mul_i32 s78, s72, 14336
T a[72:73],v22,40960
T a[74:75],v22,43008
M v[88:91],a[112:115],a[144:147],v[88:91]
SA s77,s77,s78
T a[76:77],v22,45056
T a[78:79],v22,47104
M v[88:91],a[116:119],a[148:151],v[88:91]
SA s77,s77,67108864
C v66,v72,v73
C v67,v74,v75
M v[88:91],a[120:123],a[152:155],v[88:91]
s_lshl_b32 s79, s74, 1
T a[80:81],v22,49152
T a[82:83],v22,51200
M v[88:91],a[124:127],a[156:159],v[88:91]
SA s79,s79,s20
T a[84:85],v22,53248
T a[86:87],v22,55296
M v[92:95],a[124:127],a[188:191],0
s_lshl_b32 s71, s74, 1
buffer_store_dwordx4 v[64:67], v7, s[8:11], s29 offen offset:0 sc1
M v[92:95],a[120:123],a[184:187],v[92:95]
SA s71,s71,1
T a[88:89],v22,57344
T a[90:91],v22,59392
M v[92:95],a[116:119],a[180:183],v[92:95]
s_sub_u32 s71, s71, s20
T a[92:93],v22,61440
T a[94:95],v22,63488
M v[92:95],a[112:115],a[176:179],v[92:95]
s_and_b32 s71, s71, 536870912
MF v68,v6,v68
MF v69,v6,v69
M v[92:95],a[108:111],a[172:175],v[92:95]
s_sub_u32 s64, 15, s64
MF v70,v6,v70
MF v71,v6,v71
M v[92:95],a[104:107],a[168:171],v[92:95]
s_sub_u32 s78, s64, 1
MF v76,v6,v76
MF v77,v6,v77
M v[92:95],a[100:103],a[164:167],v[92:95]
s_waitcnt lgkmcnt(0)
MF v78,v6,v78
MF v79,v6,v79
M v[92:95],a[96:99],a[160:163],v[92:95]
s_mul_i32 s78, s78, 1835008
SA s78,s78,s77
s_lshl_b32 s65, s79, 10
SA s78,s78,s65
SA s78,s78,s71
s_lshl_b32 s79, s79, 6
s_or_b32 s79, s79, s71
s_mul_i32 s67, s74, -2
s_lshl_b32 s74, s74, 3
SA s74,s74,s20
s_lshl_b32 s75, s74, 6
SA s76,s75,256
SA s67,s67,3
s_sub_u32 s67, s67, s20
s_and_b32 s67, s67, 536870912
s_or_b32 s76, s76, s67
v_or_b32 v27, s67, v7
v_add_u32 v27, 4096, v27
s_lshl_b32 s65, s74, 10
SA s77,s77,s65
s_lshl_b32 s64, s64, 7
s_lshr_b32 s73, s72, 1
s_sub_u32 s65, 7, s73
s_bitcmp1_b32 s72, 0
s_cselect_b32 s73, s65, s73
s_lshl_b32 s73, s73, 4
s_lshl_b32 s65, s42, 7
SA s73,s73,s65
v_and_b32 v37, 15, v32
v_add_u32 v37, s73, v37
v_add_u32 v29, s64, v37
s_mov_b32 s64, 104857664
v_mul_u32_u24 v38, 896, v37
v_lshl_add_u32 v38, v34, 4, v38
v_lshrrev_b32 v35, 4, v37
v_lshlrev_b32 v35, 5, v35
v_and_b32 v36, 15, v37
v_add_lshl_u32 v35, v35, v36, 2
buffer_load_dword v39, v35, s[8:11], s64 offen sc1
C v68,v68,v69
C v69,v70,v71
C v70,v76,v77
C v71,v78,v79
buffer_store_dwordx4 v[68:71], v7, s[8:11], s30 offen offset:0 sc1
buffer_load_dwordx4 v[48:51], v38, s[56:59], s75 offen
buffer_load_dwordx4 v[52:55], v38, s[56:59], s76 offen
v_mul_u32_u24 v28, 896, v29
v_lshl_add_u32 v28, v34, 4, v28
v_lshrrev_b32 v35, 4, v29
v_lshlrev_b32 v35, 5, v35
v_and_b32 v36, 15, v29
v_add_lshl_u32 v35, v35, v36, 2
buffer_load_dword v26, v35, s[8:11], s64 offen sc1
buffer_load_dwordx4 v[44:47], v28, s[56:59], s79 offen
M v[96:99],a[64:67],a[128:131],0
s_nop 0
T a[96:97],v23,32768
T a[98:99],v23,34816
M v[96:99],a[68:71],a[132:135],v[96:99]
T a[100:101],v23,36864
T a[102:103],v23,38912
M v[96:99],a[72:75],a[136:139],v[96:99]
MF v80,v5,v80
MF v81,v5,v81
M v[96:99],a[76:79],a[140:143],v[96:99]
T a[104:105],v23,40960
T a[106:107],v23,43008
M v[96:99],a[80:83],a[144:147],v[96:99]
T a[108:109],v23,45056
T a[110:111],v23,47104
M v[96:99],a[84:87],a[148:151],v[96:99]
MF v82,v5,v82
MF v83,v5,v83
M v[96:99],a[88:91],a[152:155],v[96:99]
T a[112:113],v23,49152
T a[114:115],v23,51200
M v[96:99],a[92:95],a[156:159],v[96:99]
T a[116:117],v23,53248
T a[118:119],v23,55296
M v[100:103],a[92:95],a[188:191],0
MF v88,v5,v88
MF v89,v5,v89
M v[100:103],a[88:91],a[184:187],v[100:103]
T a[120:121],v23,57344
T a[122:123],v23,59392
M v[100:103],a[84:87],a[180:183],v[100:103]
T a[124:125],v23,61440
T a[126:127],v23,63488
M v[100:103],a[80:83],a[176:179],v[100:103]
MF v90,v5,v90
MF v91,v5,v91
M v[100:103],a[76:79],a[172:175],v[100:103]
C v80,v80,v81
C v81,v82,v83
M v[100:103],a[72:75],a[168:171],v[100:103]
C v82,v88,v89
C v83,v90,v91
M v[100:103],a[68:71],a[164:167],v[100:103]
buffer_store_dwordx4 v[80:83], v7, s[8:11], s29 offen offset:1024 sc1
M v[100:103],a[64:67],a[160:163],v[100:103]
s_waitcnt lgkmcnt(0)
MF v84,v6,v84
MF v85,v6,v85
M v[104:107],a[96:99],a[128:131],0
T a[64:65],v24,32768
T a[66:67],v24,34816
M v[104:107],a[100:103],a[132:135],v[104:107]
T a[68:69],v24,36864
T a[70:71],v24,38912
M v[104:107],a[104:107],a[136:139],v[104:107]
MF v86,v6,v86
MF v87,v6,v87
M v[104:107],a[108:111],a[140:143],v[104:107]
T a[72:73],v24,40960
T a[74:75],v24,43008
M v[104:107],a[112:115],a[144:147],v[104:107]
T a[76:77],v24,45056
T a[78:79],v24,47104
M v[104:107],a[116:119],a[148:151],v[104:107]
MF v92,v6,v92
MF v93,v6,v93
M v[104:107],a[120:123],a[152:155],v[104:107]
T a[80:81],v24,49152
T a[82:83],v24,51200
M v[104:107],a[124:127],a[156:159],v[104:107]
T a[84:85],v24,53248
T a[86:87],v24,55296
M v[108:111],a[124:127],a[188:191],0
MF v94,v6,v94
MF v95,v6,v95
M v[108:111],a[120:123],a[184:187],v[108:111]
T a[88:89],v24,57344
T a[90:91],v24,59392
M v[108:111],a[116:119],a[180:183],v[108:111]
T a[92:93],v24,61440
T a[94:95],v24,63488
M v[108:111],a[112:115],a[176:179],v[108:111]
C v84,v84,v85
C v85,v86,v87
M v[108:111],a[108:111],a[172:175],v[108:111]
C v86,v92,v93
C v87,v94,v95
M v[108:111],a[104:107],a[168:171],v[108:111]
buffer_store_dwordx4 v[84:87], v7, s[8:11], s30 offen offset:1024 sc1
M v[108:111],a[100:103],a[164:167],v[108:111]
SA s29,s33,10240
M v[108:111],a[96:99],a[160:163],v[108:111]
s_waitcnt lgkmcnt(0)
M v[112:115],a[64:67],a[128:131],0
SA s30,s33,24576
T a[96:97],v25,32768
T a[98:99],v25,34816
M v[112:115],a[68:71],a[132:135],v[112:115]
T a[100:101],v25,36864
T a[102:103],v25,38912
M v[112:115],a[72:75],a[136:139],v[112:115]
MF v96,v5,v96
MF v97,v5,v97
M v[112:115],a[76:79],a[140:143],v[112:115]
T a[104:105],v25,40960
T a[106:107],v25,43008
M v[112:115],a[80:83],a[144:147],v[112:115]
T a[108:109],v25,45056
T a[110:111],v25,47104
M v[112:115],a[84:87],a[148:151],v[112:115]
MF v98,v5,v98
MF v99,v5,v99
M v[112:115],a[88:91],a[152:155],v[112:115]
T a[112:113],v25,49152
T a[114:115],v25,51200
M v[112:115],a[92:95],a[156:159],v[112:115]
T a[116:117],v25,53248
T a[118:119],v25,55296
M v[116:119],a[92:95],a[188:191],0
s_mov_b32 s84, s45
MF v104,v5,v104
MF v105,v5,v105
M v[116:119],a[88:91],a[184:187],v[116:119]
T a[120:121],v25,57344
T a[122:123],v25,59392
M v[116:119],a[84:87],a[180:183],v[116:119]
T a[124:125],v25,61440
T a[126:127],v25,63488
M v[116:119],a[80:83],a[176:179],v[116:119]
MF v106,v5,v106
MF v107,v5,v107
M v[116:119],a[76:79],a[172:175],v[116:119]
C v96,v96,v97
C v97,v98,v99
M v[116:119],a[72:75],a[168:171],v[116:119]
C v98,v104,v105
C v99,v106,v107
M v[116:119],a[68:71],a[164:167],v[116:119]
s_waitcnt vmcnt(19) lgkmcnt(0)
buffer_store_dwordx4 v[96:99], v7, s[8:11], s29 offen offset:0 sc1
M v[116:119],a[64:67],a[160:163],v[116:119]
s_barrier
M v[120:123],a[96:99],a[128:131],0
s_nop 0
T a[64:65],v22,0
T a[66:67],v22,2048
M v[120:123],a[100:103],a[132:135],v[120:123]
T a[68:69],v22,4096
T a[70:71],v22,6144
M v[120:123],a[104:107],a[136:139],v[120:123]
MF v100,v6,v100
MF v101,v6,v101
M v[120:123],a[108:111],a[140:143],v[120:123]
T a[72:73],v22,8192
T a[74:75],v22,10240
M v[120:123],a[112:115],a[144:147],v[120:123]
s_waitcnt vmcnt(11)
T a[76:77],v22,12288
T a[78:79],v22,14336
M v[120:123],a[116:119],a[148:151],v[120:123]
buffer_store_dword v15, v17, s[8:11], s84 offen sc1
M v[120:123],a[120:123],a[152:155],v[120:123]
s_nop 0
T a[80:81],v22,16384
T a[82:83],v22,18432
M v[120:123],a[124:127],a[156:159],v[120:123]
T a[84:85],v22,20480
T a[86:87],v22,22528
M v[124:127],a[124:127],a[188:191],0
MF v102,v6,v102
MF v103,v6,v103
M v[124:127],a[120:123],a[184:187],v[124:127]
T a[88:89],v22,24576
T a[90:91],v22,26624
M v[124:127],a[116:119],a[180:183],v[124:127]
T a[92:93],v22,28672
T a[94:95],v22,30720
M v[124:127],a[112:115],a[176:179],v[124:127]
MF v108,v6,v108
MF v109,v6,v109
M v[124:127],a[108:111],a[172:175],v[124:127]
MF v110,v6,v110
MF v111,v6,v111
M v[124:127],a[104:107],a[168:171],v[124:127]
C v100,v100,v101
C v101,v102,v103
M v[124:127],a[100:103],a[164:167],v[124:127]
s_waitcnt lgkmcnt(0)
C v102,v108,v109
C v103,v110,v111
M v[124:127],a[96:99],a[160:163],v[124:127]
buffer_store_dwordx4 v[100:103], v7, s[8:11], s30 offen offset:0 sc1
M v[64:67],a[64:67],a[128:131],0
s_nop 0
T a[96:97],v23,0
T a[98:99],v23,2048
M v[64:67],a[68:71],a[132:135],v[64:67]
T a[100:101],v23,4096
T a[102:103],v23,6144
M v[64:67],a[72:75],a[136:139],v[64:67]
MF v112,v5,v112
MF v113,v5,v113
M v[64:67],a[76:79],a[140:143],v[64:67]
T a[104:105],v23,8192
T a[106:107],v23,10240
M v[64:67],a[80:83],a[144:147],v[64:67]
T a[108:109],v23,12288
T a[110:111],v23,14336
M v[64:67],a[84:87],a[148:151],v[64:67]
MF v114,v5,v114
MF v115,v5,v115
M v[64:67],a[88:91],a[152:155],v[64:67]
T a[112:113],v23,16384
T a[114:115],v23,18432
M v[64:67],a[92:95],a[156:159],v[64:67]
T a[116:117],v23,20480
T a[118:119],v23,22528
M v[68:71],a[92:95],a[188:191],0
MF v120,v5,v120
MF v121,v5,v121
M v[68:71],a[88:91],a[184:187],v[68:71]
T a[120:121],v23,24576
T a[122:123],v23,26624
M v[68:71],a[84:87],a[180:183],v[68:71]
T a[124:125],v23,28672
T a[126:127],v23,30720
M v[68:71],a[80:83],a[176:179],v[68:71]
MF v122,v5,v122
MF v123,v5,v123
M v[68:71],a[76:79],a[172:175],v[68:71]
C v112,v112,v113
C v113,v114,v115
M v[68:71],a[72:75],a[168:171],v[68:71]
C v114,v120,v121
C v115,v122,v123
M v[68:71],a[68:71],a[164:167],v[68:71]
buffer_store_dwordx4 v[112:115], v7, s[8:11], s29 offen offset:1024 sc1
M v[68:71],a[64:67],a[160:163],v[68:71]
s_waitcnt lgkmcnt(0)
MF v116,v6,v116
MF v117,v6,v117
M v[72:75],a[96:99],a[128:131],0
T a[64:65],v24,0
T a[66:67],v24,2048
M v[72:75],a[100:103],a[132:135],v[72:75]
T a[68:69],v24,4096
T a[70:71],v24,6144
M v[72:75],a[104:107],a[136:139],v[72:75]
MF v118,v6,v118
MF v119,v6,v119
M v[72:75],a[108:111],a[140:143],v[72:75]
T a[72:73],v24,8192
T a[74:75],v24,10240
M v[72:75],a[112:115],a[144:147],v[72:75]
T a[76:77],v24,12288
T a[78:79],v24,14336
M v[72:75],a[116:119],a[148:151],v[72:75]
MF v124,v6,v124
MF v125,v6,v125
M v[72:75],a[120:123],a[152:155],v[72:75]
T a[80:81],v24,16384
T a[82:83],v24,18432
M v[72:75],a[124:127],a[156:159],v[72:75]
T a[84:85],v24,20480
T a[86:87],v24,22528
M v[76:79],a[124:127],a[188:191],0
MF v126,v6,v126
MF v127,v6,v127
M v[76:79],a[120:123],a[184:187],v[76:79]
T a[88:89],v24,24576
T a[90:91],v24,26624
M v[76:79],a[116:119],a[180:183],v[76:79]
T a[92:93],v24,28672
T a[94:95],v24,30720
M v[76:79],a[112:115],a[176:179],v[76:79]
C v116,v116,v117
C v117,v118,v119
M v[76:79],a[108:111],a[172:175],v[76:79]
C v118,v124,v125
C v119,v126,v127
M v[76:79],a[104:107],a[168:171],v[76:79]
buffer_store_dwordx4 v[116:119], v7, s[8:11], s30 offen offset:1024 sc1
M v[76:79],a[100:103],a[164:167],v[76:79]
SA s29,s33,12288
M v[76:79],a[96:99],a[160:163],v[76:79]
s_waitcnt lgkmcnt(0)
M v[80:83],a[64:67],a[128:131],0
SA s30,s33,26624
T a[96:97],v25,0
T a[98:99],v25,2048
M v[80:83],a[68:71],a[132:135],v[80:83]
T a[100:101],v25,4096
T a[102:103],v25,6144
M v[80:83],a[72:75],a[136:139],v[80:83]
MF v64,v5,v64
MF v65,v5,v65
M v[80:83],a[76:79],a[140:143],v[80:83]
T a[104:105],v25,8192
T a[106:107],v25,10240
M v[80:83],a[80:83],a[144:147],v[80:83]
T a[108:109],v25,12288
T a[110:111],v25,14336
M v[80:83],a[84:87],a[148:151],v[80:83]
MF v66,v5,v66
MF v67,v5,v67
M v[80:83],a[88:91],a[152:155],v[80:83]
T a[112:113],v25,16384
T a[114:115],v25,18432
M v[80:83],a[92:95],a[156:159],v[80:83]
T a[116:117],v25,20480
T a[118:119],v25,22528
M v[84:87],a[92:95],a[188:191],0
MF v72,v5,v72
MF v73,v5,v73
M v[84:87],a[88:91],a[184:187],v[84:87]
T a[120:121],v25,24576
T a[122:123],v25,26624
M v[84:87],a[84:87],a[180:183],v[84:87]
T a[124:125],v25,28672
T a[126:127],v25,30720
M v[84:87],a[80:83],a[176:179],v[84:87]
MF v74,v5,v74
MF v75,v5,v75
M v[84:87],a[76:79],a[172:175],v[84:87]
C v64,v64,v65
C v65,v66,v67
M v[84:87],a[72:75],a[168:171],v[84:87]
C v66,v72,v73
C v67,v74,v75
M v[84:87],a[68:71],a[164:167],v[84:87]
buffer_store_dwordx4 v[64:67], v7, s[8:11], s29 offen offset:0 sc1
M v[84:87],a[64:67],a[160:163],v[84:87]
s_waitcnt lgkmcnt(0)
MF v68,v6,v68
MF v69,v6,v69
M v[88:91],a[96:99],a[128:131],0
MF v70,v6,v70
MF v71,v6,v71
M v[88:91],a[100:103],a[132:135],v[88:91]
MF v76,v6,v76
MF v77,v6,v77
M v[88:91],a[104:107],a[136:139],v[88:91]
MF v78,v6,v78
MF v79,v6,v79
M v[88:91],a[108:111],a[140:143],v[88:91]
C v68,v68,v69
C v69,v70,v71
M v[88:91],a[112:115],a[144:147],v[88:91]
C v70,v76,v77
C v71,v78,v79
M v[88:91],a[116:119],a[148:151],v[88:91]
buffer_store_dwordx4 v[68:71], v7, s[8:11], s30 offen offset:0 sc1
M v[88:91],a[120:123],a[152:155],v[88:91]
M v[88:91],a[124:127],a[156:159],v[88:91]
M v[92:95],a[124:127],a[188:191],0
M v[92:95],a[120:123],a[184:187],v[92:95]
M v[92:95],a[116:119],a[180:183],v[92:95]
M v[92:95],a[112:115],a[176:179],v[92:95]
MF v80,v5,v80
MF v81,v5,v81
M v[92:95],a[108:111],a[172:175],v[92:95]
MF v82,v5,v82
MF v83,v5,v83
M v[92:95],a[104:107],a[168:171],v[92:95]
MF v88,v5,v88
MF v89,v5,v89
M v[92:95],a[100:103],a[164:167],v[92:95]
MF v90,v5,v90
MF v91,v5,v91
M v[92:95],a[96:99],a[160:163],v[92:95]
C v80,v80,v81
C v81,v82,v83
C v82,v88,v89
C v83,v90,v91
buffer_store_dwordx4 v[80:83], v7, s[8:11], s29 offen offset:1024 sc1
MF v84,v6,v84
MF v85,v6,v85
MF v86,v6,v86
MF v87,v6,v87
MF v92,v6,v92
MF v93,v6,v93
MF v94,v6,v94
MF v95,v6,v95
C v84,v84,v85
C v85,v86,v87
C v86,v92,v93
C v87,v94,v95
buffer_store_dwordx4 v[84:87], v7, s[8:11], s30 offen offset:1024 sc1
buffer_load_dword v9, v33, s[8:11], s46 offen sc1
s_waitcnt vmcnt(1)
buffer_store_dword v15, v16, s[8:11], s3 offen sc1
L_red1:
s_waitcnt vmcnt(0)
v_cmp_eq_u32 vcc, 1, v9
s_mov_b32 s91, 65536
s_mov_b32 s69, 0xffff
s_and_b32 s70, vcc_lo, s69
s_mov_b32 s68, s70
s_cmp_lg_u32 s70, 0
s_cbranch_scc1 L_rk0
s_call_b64 s[36:37], L_rpoll
L_rk0:
s_ff1_i32_b32 s71, s70
s_bitset0_b32 s70, s71
s_mul_i32 s71, s71, 114688
SA s72,s71,s77
buffer_load_dwordx4 v[128:131], v7, s[8:11], s72 offen sc1
buffer_load_dwordx4 v[132:135], v27, s[8:11], s72 offen sc1
s_cmp_lg_u32 s70, 0
s_cbranch_scc1 L_rk1
s_call_b64 s[36:37], L_rpoll
L_rk1:
s_ff1_i32_b32 s71, s70
s_bitset0_b32 s70, s71
s_mul_i32 s71, s71, 114688
SA s72,s71,s77
buffer_load_dwordx4 v[136:139], v7, s[8:11], s72 offen sc1
buffer_load_dwordx4 v[140:143], v27, s[8:11], s72 offen sc1
s_cmp_lg_u32 s70, 0
s_cbranch_scc1 L_rk2
s_call_b64 s[36:37], L_rpoll
L_rk2:
s_ff1_i32_b32 s71, s70
s_bitset0_b32 s70, s71
s_mul_i32 s71, s71, 114688
SA s72,s71,s77
buffer_load_dwordx4 v[144:147], v7, s[8:11], s72 offen sc1
buffer_load_dwordx4 v[148:151], v27, s[8:11], s72 offen sc1
v_readlane_b32 s92, v31, 0
v_readlane_b32 s94, v31, 1
v_lshlrev_b32 v64, 16, v48
v_and_b32 v65, 0xffff0000, v48
v_lshlrev_b32 v66, 16, v49
v_and_b32 v67, 0xffff0000, v49
v_lshlrev_b32 v68, 16, v50
v_and_b32 v69, 0xffff0000, v50
v_lshlrev_b32 v70, 16, v51
v_and_b32 v71, 0xffff0000, v51
v_lshlrev_b32 v72, 16, v52
v_and_b32 v73, 0xffff0000, v52
v_lshlrev_b32 v74, 16, v53
v_and_b32 v75, 0xffff0000, v53
v_lshlrev_b32 v76, 16, v54
v_and_b32 v77, 0xffff0000, v54
v_lshlrev_b32 v78, 16, v55
v_and_b32 v79, 0xffff0000, v55
v_sub_f32 v30, 1.0, v39
v_cmp_eq_u32 s[80:81], s92, v37
v_cmp_eq_u32 s[82:83], s94, v37
s_nop 0
s_or_b64 vcc, s[80:81], s[82:83]
s_cbranch_vccnz L_moe0
L_moe_ret0:
MF v64,v30,v64
MF v65,v30,v65
MF v66,v30,v66
MF v67,v30,v67
MF v68,v30,v68
MF v69,v30,v69
MF v70,v30,v70
MF v71,v30,v71
MF v72,v30,v72
MF v73,v30,v73
MF v74,v30,v74
MF v75,v30,v75
MF v76,v30,v76
MF v77,v30,v77
MF v78,v30,v78
MF v79,v30,v79
s_cmp_lg_u32 s70, 0
s_cbranch_scc1 L_rk3
s_call_b64 s[36:37], L_rpoll
L_rk3:
s_ff1_i32_b32 s71, s70
s_bitset0_b32 s70, s71
s_mul_i32 s71, s71, 114688
SA s72,s71,s77
buffer_load_dwordx4 v[152:155], v7, s[8:11], s72 offen sc1
buffer_load_dwordx4 v[156:159], v27, s[8:11], s72 offen sc1
v_lshlrev_b32 v80, 16, v44
v_and_b32 v81, 0xffff0000, v44
v_lshlrev_b32 v82, 16, v45
v_and_b32 v83, 0xffff0000, v45
v_lshlrev_b32 v84, 16, v46
v_and_b32 v85, 0xffff0000, v46
v_lshlrev_b32 v86, 16, v47
v_and_b32 v87, 0xffff0000, v47
v_sub_f32 v30, 1.0, v26
v_cmp_eq_u32 s[80:81], s92, v29
v_cmp_eq_u32 s[82:83], s94, v29
s_nop 0
s_or_b64 vcc, s[80:81], s[82:83]
s_cbranch_vccnz L_moe1
L_moe_ret1:
MF v80,v30,v80
MF v81,v30,v81
MF v82,v30,v82
MF v83,v30,v83
MF v84,v30,v84
MF v85,v30,v85
MF v86,v30,v86
MF v87,v30,v87
s_waitcnt vmcnt(7)
M v[96:99],a[246:249],v[128:131],0
M v[100:103],a[244:247],v[128:131],0
s_waitcnt vmcnt(6)
M v[104:107],a[246:249],v[132:135],0
M v[108:111],a[244:247],v[132:135],0
s_cmp_lg_u32 s70, 0
s_cbranch_scc1 L_rk4
s_call_b64 s[36:37], L_rpoll
L_rk4:
s_ff1_i32_b32 s71, s70
s_bitset0_b32 s70, s71
s_mul_i32 s71, s71, 114688
SA s72,s71,s77
buffer_load_dwordx4 v[160:163], v7, s[8:11], s72 offen sc1
buffer_load_dwordx4 v[164:167], v27, s[8:11], s72 offen sc1
s_waitcnt vmcnt(7)
M v[96:99],a[246:249],v[136:139],v[96:99]
M v[100:103],a[244:247],v[136:139],v[100:103]
s_waitcnt vmcnt(6)
M v[104:107],a[246:249],v[140:143],v[104:107]
M v[108:111],a[244:247],v[140:143],v[108:111]
s_cmp_lg_u32 s70, 0
s_cbranch_scc1 L_rk5
s_call_b64 s[36:37], L_rpoll
L_rk5:
s_ff1_i32_b32 s71, s70
s_bitset0_b32 s70, s71
s_mul_i32 s71, s71, 114688
SA s72,s71,s77
buffer_load_dwordx4 v[168:171], v7, s[8:11], s72 offen sc1
buffer_load_dwordx4 v[172:175], v27, s[8:11], s72 offen sc1
s_waitcnt vmcnt(7)
M v[96:99],a[246:249],v[144:147],v[96:99]
M v[100:103],a[244:247],v[144:147],v[100:103]
s_waitcnt vmcnt(6)
M v[104:107],a[246:249],v[148:151],v[104:107]
M v[108:111],a[244:247],v[148:151],v[108:111]
s_cmp_lg_u32 s70, 0
s_cbranch_scc1 L_rk6
s_call_b64 s[36:37], L_rpoll
L_rk6:
s_ff1_i32_b32 s71, s70
s_bitset0_b32 s70, s71
s_mul_i32 s71, s71, 114688
SA s72,s71,s77
buffer_load_dwordx4 v[176:179], v7, s[8:11], s72 offen sc1
buffer_load_dwordx4 v[180:183], v27, s[8:11], s72 offen sc1
s_waitcnt vmcnt(7)
M v[96:99],a[246:249],v[152:155],v[96:99]
M v[100:103],a[244:247],v[152:155],v[100:103]
s_waitcnt vmcnt(6)
M v[104:107],a[246:249],v[156:159],v[104:107]
M v[108:111],a[244:247],v[156:159],v[108:111]
s_cmp_lg_u32 s70, 0
s_cbranch_scc1 L_rk7
s_call_b64 s[36:37], L_rpoll
L_rk7:
s_ff1_i32_b32 s71, s70
s_bitset0_b32 s70, s71
s_mul_i32 s71, s71, 114688
SA s72,s71,s77
buffer_load_dwordx4 v[184:187], v7, s[8:11], s72 offen sc1
buffer_load_dwordx4 v[188:191], v27, s[8:11], s72 offen sc1
s_waitcnt vmcnt(7)
M v[96:99],a[246:249],v[160:163],v[96:99]
M v[100:103],a[244:247],v[160:163],v[100:103]
s_waitcnt vmcnt(6)
M v[104:107],a[246:249],v[164:167],v[104:107]
M v[108:111],a[244:247],v[164:167],v[108:111]
s_cmp_lg_u32 s70, 0
s_cbranch_scc1 L_rk8
s_call_b64 s[36:37], L_rpoll
L_rk8:
s_ff1_i32_b32 s71, s70
s_bitset0_b32 s70, s71
s_mul_i32 s71, s71, 114688
SA s72,s71,s77
buffer_load_dwordx4 v[128:131], v7, s[8:11], s72 offen sc1
buffer_load_dwordx4 v[132:135], v27, s[8:11], s72 offen sc1
s_waitcnt vmcnt(7)
M v[96:99],a[246:249],v[168:171],v[96:99]
M v[100:103],a[244:247],v[168:171],v[100:103]
s_waitcnt vmcnt(6)
M v[104:107],a[246:249],v[172:175],v[104:107]
M v[108:111],a[244:247],v[172:175],v[108:111]
s_cmp_lg_u32 s70, 0
s_cbranch_scc1 L_rk9
s_call_b64 s[36:37], L_rpoll
L_rk9:
s_ff1_i32_b32 s71, s70
s_bitset0_b32 s70, s71
s_mul_i32 s71, s71, 114688
SA s72,s71,s77
buffer_load_dwordx4 v[136:139], v7, s[8:11], s72 offen sc1
buffer_load_dwordx4 v[140:143], v27, s[8:11], s72 offen sc1
s_waitcnt vmcnt(7)
M v[96:99],a[246:249],v[176:179],v[96:99]
M v[100:103],a[244:247],v[176:179],v[100:103]
s_waitcnt vmcnt(6)
M v[104:107],a[246:249],v[180:183],v[104:107]
M v[108:111],a[244:247],v[180:183],v[108:111]
s_cmp_lg_u32 s70, 0
s_cbranch_scc1 L_rk10
s_call_b64 s[36:37], L_rpoll
L_rk10:
s_ff1_i32_b32 s71, s70
s_bitset0_b32 s70, s71
s_mul_i32 s71, s71, 114688
SA s72,s71,s77
buffer_load_dwordx4 v[144:147], v7, s[8:11], s72 offen sc1
buffer_load_dwordx4 v[148:151], v27, s[8:11], s72 offen sc1
s_waitcnt vmcnt(7)
M v[96:99],a[246:249],v[184:187],v[96:99]
M v[100:103],a[244:247],v[184:187],v[100:103]
s_waitcnt vmcnt(6)
M v[104:107],a[246:249],v[188:191],v[104:107]
M v[108:111],a[244:247],v[188:191],v[108:111]
s_cmp_lg_u32 s70, 0
s_cbranch_scc1 L_rk11
s_call_b64 s[36:37], L_rpoll
L_rk11:
s_ff1_i32_b32 s71, s70
s_bitset0_b32 s70, s71
s_mul_i32 s71, s71, 114688
SA s72,s71,s77
buffer_load_dwordx4 v[152:155], v7, s[8:11], s72 offen sc1
buffer_load_dwordx4 v[156:159], v27, s[8:11], s72 offen sc1
s_waitcnt vmcnt(7)
M v[96:99],a[246:249],v[128:131],v[96:99]
M v[100:103],a[244:247],v[128:131],v[100:103]
s_waitcnt vmcnt(6)
M v[104:107],a[246:249],v[132:135],v[104:107]
M v[108:111],a[244:247],v[132:135],v[108:111]
s_cmp_lg_u32 s70, 0
s_cbranch_scc1 L_rk12
s_call_b64 s[36:37], L_rpoll
L_rk12:
s_ff1_i32_b32 s71, s70
s_bitset0_b32 s70, s71
s_mul_i32 s71, s71, 114688
SA s72,s71,s77
buffer_load_dwordx4 v[160:163], v7, s[8:11], s72 offen sc1
buffer_load_dwordx4 v[164:167], v27, s[8:11], s72 offen sc1
buffer_load_dword v8, v33, s[8:11], s46 offen sc1
s_waitcnt vmcnt(8)
M v[96:99],a[246:249],v[136:139],v[96:99]
M v[100:103],a[244:247],v[136:139],v[100:103]
s_waitcnt vmcnt(7)
M v[104:107],a[246:249],v[140:143],v[104:107]
M v[108:111],a[244:247],v[140:143],v[108:111]
s_cmp_lg_u32 s70, 0
s_cbranch_scc1 L_rk13
s_call_b64 s[36:37], L_rpoll
L_rk13:
s_ff1_i32_b32 s71, s70
s_bitset0_b32 s70, s71
s_mul_i32 s71, s71, 114688
SA s72,s71,s77
buffer_load_dwordx4 v[168:171], v7, s[8:11], s72 offen sc1
buffer_load_dwordx4 v[172:175], v27, s[8:11], s72 offen sc1
s_waitcnt vmcnt(8)
M v[96:99],a[246:249],v[144:147],v[96:99]
M v[100:103],a[244:247],v[144:147],v[100:103]
s_waitcnt vmcnt(7)
M v[104:107],a[246:249],v[148:151],v[104:107]
M v[108:111],a[244:247],v[148:151],v[108:111]
s_cmp_lg_u32 s70, 0
s_cbranch_scc1 L_rk14
s_call_b64 s[36:37], L_rpoll
L_rk14:
s_ff1_i32_b32 s71, s70
s_bitset0_b32 s70, s71
s_mul_i32 s71, s71, 114688
SA s72,s71,s77
buffer_load_dwordx4 v[176:179], v7, s[8:11], s72 offen sc1
buffer_load_dwordx4 v[180:183], v27, s[8:11], s72 offen sc1
s_waitcnt vmcnt(8)
M v[96:99],a[246:249],v[152:155],v[96:99]
M v[100:103],a[244:247],v[152:155],v[100:103]
s_waitcnt vmcnt(7)
M v[104:107],a[246:249],v[156:159],v[104:107]
M v[108:111],a[244:247],v[156:159],v[108:111]
s_cmp_lg_u32 s70, 0
s_cbranch_scc1 L_rk15
s_call_b64 s[36:37], L_rpoll
L_rk15:
s_ff1_i32_b32 s71, s70
s_bitset0_b32 s70, s71
s_mul_i32 s71, s71, 114688
SA s72,s71,s77
buffer_load_dwordx4 v[184:187], v7, s[8:11], s72 offen sc1
buffer_load_dwordx4 v[188:191], v27, s[8:11], s72 offen sc1
s_waitcnt vmcnt(8)
M v[96:99],a[246:249],v[160:163],v[96:99]
M v[100:103],a[244:247],v[160:163],v[100:103]
s_waitcnt vmcnt(7)
M v[104:107],a[246:249],v[164:167],v[104:107]
M v[108:111],a[244:247],v[164:167],v[108:111]
s_waitcnt vmcnt(6)
v_cmp_eq_u32 vcc, 1, v8
s_mov_b32 s69, 0xffff0000
s_and_b32 s70, vcc_lo, s69
s_mov_b32 s68, s70
s_cmp_lg_u32 s70, 0
s_cbranch_scc1 L_rk16
s_call_b64 s[36:37], L_rpoll
L_rk16:
s_ff1_i32_b32 s71, s70
s_bitset0_b32 s70, s71
s_mul_i32 s71, s71, 114688
SA s72,s71,s78
buffer_load_dwordx4 v[192:195], v7, s[8:11], s72 offen sc1
s_waitcnt vmcnt(6)
M v[96:99],a[246:249],v[168:171],v[96:99]
M v[100:103],a[244:247],v[168:171],v[100:103]
s_waitcnt vmcnt(5)
M v[104:107],a[246:249],v[172:175],v[104:107]
M v[108:111],a[244:247],v[172:175],v[108:111]
s_cmp_lg_u32 s70, 0
s_cbranch_scc1 L_rk17
s_call_b64 s[36:37], L_rpoll
L_rk17:
s_ff1_i32_b32 s71, s70
s_bitset0_b32 s70, s71
s_mul_i32 s71, s71, 114688
SA s72,s71,s78
buffer_load_dwordx4 v[196:199], v7, s[8:11], s72 offen sc1
s_waitcnt vmcnt(5)
M v[96:99],a[246:249],v[176:179],v[96:99]
M v[100:103],a[244:247],v[176:179],v[100:103]
s_waitcnt vmcnt(4)
M v[104:107],a[246:249],v[180:183],v[104:107]
M v[108:111],a[244:247],v[180:183],v[108:111]
s_cmp_lg_u32 s70, 0
s_cbranch_scc1 L_rk18
s_call_b64 s[36:37], L_rpoll
L_rk18:
s_ff1_i32_b32 s71, s70
s_bitset0_b32 s70, s71
s_mul_i32 s71, s71, 114688
SA s72,s71,s78
buffer_load_dwordx4 v[200:203], v7, s[8:11], s72 offen sc1
s_waitcnt vmcnt(4)
M v[96:99],a[246:249],v[184:187],v[96:99]
M v[100:103],a[244:247],v[184:187],v[100:103]
s_waitcnt vmcnt(3)
M v[104:107],a[246:249],v[188:191],v[104:107]
M v[108:111],a[244:247],v[188:191],v[108:111]
s_nop 4
v_permlane16_swap_b32 v96, v100
v_permlane16_swap_b32 v97, v101
v_permlane16_swap_b32 v98, v102
v_permlane16_swap_b32 v99, v103
v_permlane16_swap_b32 v104, v108
v_permlane16_swap_b32 v105, v109
v_permlane16_swap_b32 v106, v110
v_permlane16_swap_b32 v107, v111
v_fmac_f32 v64, v39, v96
v_fmac_f32 v65, v39, v97
v_fmac_f32 v66, v39, v98
v_fmac_f32 v67, v39, v99
v_fmac_f32 v68, v39, v100
v_fmac_f32 v69, v39, v101
v_fmac_f32 v70, v39, v102
v_fmac_f32 v71, v39, v103
C v48,v64,v65
C v49,v66,v67
C v50,v68,v69
C v51,v70,v71
buffer_store_dwordx4 v[48:51], v38, s[52:55], s75 offen sc1
v_fmac_f32 v72, v39, v104
v_fmac_f32 v73, v39, v105
v_fmac_f32 v74, v39, v106
v_fmac_f32 v75, v39, v107
v_fmac_f32 v76, v39, v108
v_fmac_f32 v77, v39, v109
v_fmac_f32 v78, v39, v110
v_fmac_f32 v79, v39, v111
C v52,v72,v73
C v53,v74,v75
C v54,v76,v77
C v55,v78,v79
buffer_store_dwordx4 v[52:55], v38, s[52:55], s76 offen sc1
s_cmp_lg_u32 s70, 0
s_cbranch_scc1 L_rk19
s_call_b64 s[36:37], L_rpoll
L_rk19:
s_ff1_i32_b32 s71, s70
s_bitset0_b32 s70, s71
s_mul_i32 s71, s71, 114688
SA s72,s71,s78
buffer_load_dwordx4 v[204:207], v7, s[8:11], s72 offen sc1
s_cmp_lg_u32 s70, 0
s_cbranch_scc1 L_rk20
s_call_b64 s[36:37], L_rpoll
L_rk20:
s_ff1_i32_b32 s71, s70
s_bitset0_b32 s70, s71
s_mul_i32 s71, s71, 114688
SA s72,s71,s78
buffer_load_dwordx4 v[208:211], v7, s[8:11], s72 offen sc1
s_cmp_lg_u32 s70, 0
s_cbranch_scc1 L_rk21
s_call_b64 s[36:37], L_rpoll
L_rk21:
s_ff1_i32_b32 s71, s70
s_bitset0_b32 s70, s71
s_mul_i32 s71, s71, 114688
SA s72,s71,s78
buffer_load_dwordx4 v[212:215], v7, s[8:11], s72 offen sc1
s_cmp_lg_u32 s70, 0
s_cbranch_scc1 L_rk22
s_call_b64 s[36:37], L_rpoll
L_rk22:
s_ff1_i32_b32 s71, s70
s_bitset0_b32 s70, s71
s_mul_i32 s71, s71, 114688
SA s72,s71,s78
buffer_load_dwordx4 v[216:219], v7, s[8:11], s72 offen sc1
s_cmp_lg_u32 s70, 0
s_cbranch_scc1 L_rk23
s_call_b64 s[36:37], L_rpoll
L_rk23:
s_ff1_i32_b32 s71, s70
s_bitset0_b32 s70, s71
s_mul_i32 s71, s71, 114688
SA s72,s71,s78
buffer_load_dwordx4 v[220:223], v7, s[8:11], s72 offen sc1
s_cmp_lg_u32 s70, 0
s_cbranch_scc1 L_rk24
s_call_b64 s[36:37], L_rpoll
L_rk24:
s_ff1_i32_b32 s71, s70
s_bitset0_b32 s70, s71
s_mul_i32 s71, s71, 114688
SA s72,s71,s78
buffer_load_dwordx4 v[224:227], v7, s[8:11], s72 offen sc1
s_cmp_lg_u32 s70, 0
s_cbranch_scc1 L_rk25
s_call_b64 s[36:37], L_rpoll
L_rk25:
s_ff1_i32_b32 s71, s70
s_bitset0_b32 s70, s71
s_mul_i32 s71, s71, 114688
SA s72,s71,s78
buffer_load_dwordx4 v[228:231], v7, s[8:11], s72 offen sc1
s_cmp_lg_u32 s70, 0
s_cbranch_scc1 L_rk26
s_call_b64 s[36:37], L_rpoll
L_rk26:
s_ff1_i32_b32 s71, s70
s_bitset0_b32 s70, s71
s_mul_i32 s71, s71, 114688
SA s72,s71,s78
buffer_load_dwordx4 v[232:235], v7, s[8:11], s72 offen sc1
s_cmp_lg_u32 s70, 0
s_cbranch_scc1 L_rk27
s_call_b64 s[36:37], L_rpoll
L_rk27:
s_ff1_i32_b32 s71, s70
s_bitset0_b32 s70, s71
s_mul_i32 s71, s71, 114688
SA s72,s71,s78
buffer_load_dwordx4 v[236:239], v7, s[8:11], s72 offen sc1
s_waitcnt vmcnt(13)
M v[112:115],a[246:249],v[192:195],0
M v[116:119],a[244:247],v[192:195],0
s_cmp_lg_u32 s70, 0
s_cbranch_scc1 L_rk28
s_call_b64 s[36:37], L_rpoll
L_rk28:
s_ff1_i32_b32 s71, s70
s_bitset0_b32 s70, s71
s_mul_i32 s71, s71, 114688
SA s72,s71,s78
buffer_load_dwordx4 v[240:243], v7, s[8:11], s72 offen sc1
s_waitcnt vmcnt(13)
M v[112:115],a[246:249],v[196:199],v[112:115]
M v[116:119],a[244:247],v[196:199],v[116:119]
s_cmp_lg_u32 s70, 0
s_cbranch_scc1 L_rk29
s_call_b64 s[36:37], L_rpoll
L_rk29:
s_ff1_i32_b32 s71, s70
s_bitset0_b32 s70, s71
s_mul_i32 s71, s71, 114688
SA s72,s71,s78
buffer_load_dwordx4 v[244:247], v7, s[8:11], s72 offen sc1
s_waitcnt vmcnt(13)
M v[112:115],a[246:249],v[200:203],v[112:115]
M v[116:119],a[244:247],v[200:203],v[116:119]
s_cmp_lg_u32 s70, 0
s_cbranch_scc1 L_rk30
s_call_b64 s[36:37], L_rpoll
L_rk30:
s_ff1_i32_b32 s71, s70
s_bitset0_b32 s70, s71
s_mul_i32 s71, s71, 114688
SA s72,s71,s78
buffer_load_dwordx4 v[248:251], v7, s[8:11], s72 offen sc1
s_waitcnt vmcnt(11)
M v[112:115],a[246:249],v[204:207],v[112:115]
M v[116:119],a[244:247],v[204:207],v[116:119]
s_cmp_lg_u32 s70, 0
s_cbranch_scc1 L_rk31
s_call_b64 s[36:37], L_rpoll
L_rk31:
s_ff1_i32_b32 s71, s70
s_bitset0_b32 s70, s71
s_mul_i32 s71, s71, 114688
SA s72,s71,s78
buffer_load_dwordx4 v[252:255], v7, s[8:11], s72 offen sc1
s_waitcnt vmcnt(11)
M v[112:115],a[246:249],v[208:211],v[112:115]
M v[116:119],a[244:247],v[208:211],v[116:119]
s_waitcnt vmcnt(10)
M v[112:115],a[246:249],v[212:215],v[112:115]
M v[116:119],a[244:247],v[212:215],v[116:119]
s_waitcnt vmcnt(9)
M v[112:115],a[246:249],v[216:219],v[112:115]
M v[116:119],a[244:247],v[216:219],v[116:119]
s_waitcnt vmcnt(8)
M v[112:115],a[246:249],v[220:223],v[112:115]
M v[116:119],a[244:247],v[220:223],v[116:119]
s_waitcnt vmcnt(7)
M v[112:115],a[246:249],v[224:227],v[112:115]
M v[116:119],a[244:247],v[224:227],v[116:119]
s_waitcnt vmcnt(6)
M v[112:115],a[246:249],v[228:231],v[112:115]
M v[116:119],a[244:247],v[228:231],v[116:119]
s_waitcnt vmcnt(5)
M v[112:115],a[246:249],v[232:235],v[112:115]
M v[116:119],a[244:247],v[232:235],v[116:119]
s_waitcnt vmcnt(4)
M v[112:115],a[246:249],v[236:239],v[112:115]
M v[116:119],a[244:247],v[236:239],v[116:119]
s_waitcnt vmcnt(3)
M v[112:115],a[246:249],v[240:243],v[112:115]
M v[116:119],a[244:247],v[240:243],v[116:119]
s_waitcnt vmcnt(2)
M v[112:115],a[246:249],v[244:247],v[112:115]
M v[116:119],a[244:247],v[244:247],v[116:119]
s_waitcnt vmcnt(1)
M v[112:115],a[246:249],v[248:251],v[112:115]
M v[116:119],a[244:247],v[248:251],v[116:119]
s_waitcnt vmcnt(0)
M v[112:115],a[246:249],v[252:255],v[112:115]
M v[116:119],a[244:247],v[252:255],v[116:119]
s_nop 7
v_permlane16_swap_b32 v112, v116
v_permlane16_swap_b32 v113, v117
v_permlane16_swap_b32 v114, v118
v_permlane16_swap_b32 v115, v119
v_fmac_f32 v80, v26, v112
v_fmac_f32 v81, v26, v113
v_fmac_f32 v82, v26, v114
v_fmac_f32 v83, v26, v115
v_fmac_f32 v84, v26, v116
v_fmac_f32 v85, v26, v117
v_fmac_f32 v86, v26, v118
v_fmac_f32 v87, v26, v119
C v44,v80,v81
C v45,v82,v83
C v46,v84,v85
C v47,v86,v87
buffer_store_dwordx4 v[44:47], v28, s[52:55], s79 offen sc1
s_endpgm
L_rpoll0:
s_sleep 1
L_rpoll:
buffer_load_dword v9, v33, s[8:11], s46 offen sc1
s_waitcnt vmcnt(0)
v_cmp_eq_u32 vcc, 1, v9
s_sub_u32 s91, s91, 1
s_cselect_b32 s70, -1, 0
s_or_b32 s70, s70, vcc_lo
s_and_b32 s70, s70, s69
s_andn2_b32 s70, s70, s68
s_cbranch_scc0 L_rpoll0
s_or_b32 s68, s68, s70
s_setpc_b64 s[36:37]
L_moe0:
s_lshl_b32 s88, s75, 1
s_call_b64 s[36:37], L_moe
AF v64,v2,v64
AF v65,v3,v65
AF v66,v4,v66
AF v67,v5,v67
AF v68,v10,v68
AF v69,v11,v69
AF v70,v12,v70
AF v71,v13,v71
AF v72,v14,v72
AF v73,v15,v73
AF v74,v16,v74
AF v75,v17,v75
AF v76,v18,v76
AF v77,v19,v77
AF v78,v20,v78
AF v79,v21,v79
s_mov_b64 exec, -1
s_branch L_moe_ret0
L_moe1:
s_lshl_b32 s88, s79, 1
s_call_b64 s[36:37], L_moe
AF v80,v2,v80
AF v81,v3,v81
AF v82,v4,v82
AF v83,v5,v83
AF v84,v10,v84
AF v85,v11,v85
AF v86,v12,v86
AF v87,v13,v87
s_mov_b64 exec, -1
s_branch L_moe_ret1
L_moe2:
s_lshl_b32 s88, s79, 1
s_call_b64 s[36:37], L_moe
AF v48,v2,v48
AF v49,v3,v49
AF v50,v4,v50
AF v51,v5,v51
AF v52,v10,v52
AF v53,v11,v53
AF v54,v12,v54
AF v55,v13,v55
s_mov_b64 exec, -1
s_branch L_moe_ret2
L_moe:
v_min_u32 v0, 27, v32
v_lshlrev_b32 v0, 2, v0
s_mov_b32 s64, 105062912
s_mov_b32 s65, 65536
s_mov_b32 exec_lo, 0xffffffff
s_mov_b32 exec_hi, 0xffffffff
L_pfy:
buffer_load_dword v1, v0, s[8:11], s64 offen sc1
s_sub_u32 s65, s65, 1
s_cbranch_scc1 L_pfy_x
s_waitcnt vmcnt(0)
v_cmp_ne_u32 vcc, 1, v1
s_nop 0
s_cbranch_vccz L_pfy_x
s_sleep 2
s_branch L_pfy
L_pfy_x:
s_waitcnt vmcnt(0)
s_mov_b64 exec, -1
s_or_b64 exec, s[80:81], s[82:83]
v_mov_b32 v0, 1792
v_cndmask_b32 v0, v0, 0, s[80:81]
v_lshl_add_u32 v0, v34, 5, v0
SA s88,s88,104898560
buffer_load_dwordx4 v[2:5], v0, s[8:11], s88 offen sc1
buffer_load_dwordx4 v[10:13], v0, s[8:11], s88 offen offset:16 sc1
buffer_load_dwordx4 v[14:17], v0, s[8:11], s88 offen offset:512 sc1
buffer_load_dwordx4 v[18:21], v0, s[8:11], s88 offen offset:528 sc1
s_waitcnt vmcnt(0)
s_setpc_b64 s[36:37]
L_red:
v_lshrrev_b32 v32, 4, v7
s_lshr_b32 s74, s41, 3
s_lshl_b32 s64, s42, 1
SA s46,s64,s74
s_mul_i32 s46, s46, 4352
s_and_b32 s72, s41, 7
s_lshl_b32 s65, s72, 7
SA s46,s46,s65
SA s46,s46,104992768
v_and_b32 v33, 31, v32
v_lshlrev_b32 v33, 2, v33
s_lshl_b32 s65, s41, 7
SA s65,s65,104890368
buffer_load_dword v31, v33, s[8:11], s65 offen sc1
v_bfe_u32 v34, v32, 4, 1
v_lshlrev_b32 v34, 1, v34
v_lshrrev_b32 v35, 5, v32
v_add_u32 v34, v34, v35
s_mov_b32 s52, s96
s_and_b32 s53, s97, 0xffff
s_mov_b32 s54, 1835008
s_mov_b32 s55, 0x20000
s_mul_i32 s77, s42, 1835008
s_mul_i32 s78, s72, 14336
SA s77,s77,s78
SA s77,s77,67108864
s_lshl_b32 s79, s74, 1
SA s79,s79,s20
s_lshl_b32 s71, s74, 1
SA s71,s71,1
s_sub_u32 s71, s71, s20
s_and_b32 s71, s71, 536870912
s_sub_u32 s64, 15, s64
s_sub_u32 s78, s64, 1
s_mul_i32 s78, s78, 1835008
SA s78,s78,s77
s_lshl_b32 s65, s79, 10
SA s78,s78,s65
SA s78,s78,s71
s_lshl_b32 s79, s79, 6
s_or_b32 s79, s79, s71
s_mul_i32 s67, s74, -2
s_lshl_b32 s74, s74, 3
SA s74,s74,s20
s_lshl_b32 s75, s74, 6
SA s76,s75,256
SA s67,s67,3
s_sub_u32 s67, s67, s20
s_and_b32 s67, s67, 536870912
s_or_b32 s76, s76, s67
v_or_b32 v27, s67, v7
v_add_u32 v27, 4096, v27
s_lshl_b32 s65, s74, 10
SA s77,s77,s65
s_lshl_b32 s64, s64, 7
s_lshr_b32 s73, s72, 1
s_sub_u32 s65, 7, s73
s_bitcmp1_b32 s72, 0
s_cselect_b32 s73, s65, s73
s_lshl_b32 s73, s73, 4
s_lshl_b32 s65, s42, 7
SA s73,s73,s65
v_and_b32 v37, 15, v32
v_add_u32 v37, s73, v37
v_add_u32 v29, s64, v37
s_mov_b32 s64, 104857664
v_mul_u32_u24 v38, 896, v37
v_lshl_add_u32 v38, v34, 4, v38
v_lshrrev_b32 v35, 4, v37
v_lshlrev_b32 v35, 5, v35
v_and_b32 v36, 15, v37
v_add_lshl_u32 v35, v35, v36, 2
buffer_load_dword v39, v35, s[8:11], s64 offen sc1
buffer_load_dwordx4 v[48:51], v38, s[56:59], s75 offen
buffer_load_dwordx4 v[52:55], v38, s[56:59], s76 offen
v_mul_u32_u24 v28, 896, v29
v_lshl_add_u32 v28, v34, 4, v28
v_lshrrev_b32 v35, 4, v29
v_lshlrev_b32 v35, 5, v35
v_and_b32 v36, 15, v29
v_add_lshl_u32 v35, v35, v36, 2
buffer_load_dword v26, v35, s[8:11], s64 offen sc1
buffer_load_dwordx4 v[44:47], v28, s[56:59], s79 offen
s_waitcnt vmcnt(7)
buffer_load_dword v9, v33, s[8:11], s46 offen sc1
s_branch L_red1
L_code_end:
.section .rodata,"a"
.p2align 6
.amdhsa_kernel gated_mix__compressed_kv_cla__moe_arch_mod__prompt_kernel
  .amdhsa_next_free_vgpr 512
  .amdhsa_next_free_sgpr 102
  .amdhsa_accum_offset 256
  .amdhsa_group_segment_fixed_size 0
  .amdhsa_kernarg_size 120
  .amdhsa_user_sgpr_count 2
  .amdhsa_user_sgpr_kernarg_segment_ptr 1
  .amdhsa_system_sgpr_workgroup_id_x 1
  .amdhsa_float_denorm_mode_32 3
.end_amdhsa_kernel
```

```asm
; @launch grid=(256,1,1) block=(256,1,1) lds=163840
.amdgcn_target "amdgcn-amd-amdhsa--gfx950"
.text
.macro M a, b, c, d
v_mfma_f32_16x16x32_bf16 \a, \b, \c, \d
.endm
.macro R a, b, c
ds_read_b128 \a, \b offset:\c
.endm
.macro T a, b, c
ds_read_b64_tr_b16 \a, \b offset:\c
.endm
.macro C a, b, c
v_cvt_pk_bf16_f32 \a, \b, \c
.endm
.macro E a, b
v_exp_f32 \a, \b
.endm
.macro W a, b
v_accvgpr_write_b32 \a, \b
.endm
.macro G a, b
v_accvgpr_read_b32 \a, \b
.endm
.macro AF a, b, c
v_add_f32 \a, \b, \c
.endm
.macro MF a, b, c
v_mul_f32 \a, \b, \c
.endm
.macro SA a, b, c
s_add_u32 \a, \b, \c
.endm
.globl gated_mix__compressed_kv_cla__moe_arch_mod__prompt_kernel
.p2align 8
.type gated_mix__compressed_kv_cla__moe_arch_mod__prompt_kernel,@function
gated_mix__compressed_kv_cla__moe_arch_mod__prompt_kernel:
s_cmp_lt_u32 s2, 256
s_cbranch_scc1 L_go
s_endpgm
L_go:
s_load_dwordx8 s[80:87], s[0:1], 0
s_load_dwordx4 s[88:91], s[0:1], 32
s_getpc_b64 s[76:77]
L_pc0:
s_lshr_b32 s42, s2, 3
s_mov_b32 s79, 0x20000
s_lshl_b32 s67, s42, 13
s_mov_b32 s78, L_code_end-L_pc0
s_and_b32 s77, s77, 0xffff
v_lshl_add_u32 v31, v0, 5, s67
buffer_load_dword a240, v31, s[76:79], 0 offen offset:0
v_lshrrev_b32 v24, 6, v0
v_and_b32 v0, 63, v0
s_and_b32 s41, s2, 7
v_readfirstlane_b32 s20, v24
s_lshr_b32 s64, s2, 4
v_and_b32 v24, 15, v0
v_lshrrev_b32 v25, 4, v0
s_and_b32 s64, s64, 8
s_or_b32 s41, s41, s64
v_lshlrev_b32 v28, 1, v25
v_xor_b32 v28, v28, v24
v_and_b32 v29, 8, v28
v_and_b32 v28, 7, v28
v_lshlrev_b32 v28, 4, v28
v_lshl_add_u32 v28, v29, 5, v28
v_lshl_add_u32 v28, v25, 13, v28
s_lshl_b32 s64, s20, 17
v_add_u32 v8, s64, v28
v_xor_b32 v28, 0x100, v8
v_add_u32 v9, 31744, v8
v_add_u32 v10, 63488, v28
v_add_u32 v11, 95232, v28
s_mov_b32 s21, 0
s_lshl_b32 s23, s20, 12
s_lshl_b32 s74, s41, 9
s_sub_u32 s18, 8388608, s74
s_mov_b32 s19, s79
s_bitcmp0_b32 s2, 3
s_waitcnt lgkmcnt(0)
s_cselect_b64 s[72:73], s[86:87], s[88:89]
SA s16,s72,s74
s_addc_u32 s73, s73, 0
s_and_b32 s17, s73, 0xffff
SA m0,s23,0
s_nop 0
buffer_load_dwordx4 v8, s[16:19], s21 offen offset:0   lds
buffer_load_dwordx4 v9, s[16:19], s21 offen offset:1024   lds
buffer_load_dwordx4 v10, s[16:19], s21 offen offset:2048   lds
buffer_load_dwordx4 v11, s[16:19], s21 offen offset:3072   lds
SA s21,s21,128
s_and_b32 s45, s42, 1
s_bfe_u32 s42, s2, 0x30004
s_lshl_b32 s64, s45, 3
s_or_b32 s42, s42, s64
s_and_b32 s65, s20, 1
s_lshr_b32 s66, s20, 1
v_and_b32 v29, 7, v0
v_xor_b32 v28, v25, v29
v_lshlrev_b32 v28, 4, v28
v_lshrrev_b32 v29, 3, v0
v_lshl_add_u32 v30, v29, 11, v28
s_lshl_b32 s64, s66, 19
s_lshl_b32 s67, s65, 21
SA s64,s64,s67
v_add_u32 v12, s64, v30
v_xor_b32 v30, 64, v12
v_add_u32 v14, 30720, v12
v_add_u32 v13, 15360, v30
v_add_u32 v15, 46080, v30
s_mov_b32 s22, 0
SA s24,s23,65536
s_and_b32 s64, s42, 7
s_lshl_b32 s64, s64, 16
s_sub_u32 s50, 4194304, s64
s_mov_b32 s51, s79
SA s48,s82,s64
s_addc_u32 s73, s83, 0
s_and_b32 s49, s73, 0xffff
SA m0,s23,16384
s_nop 0
buffer_load_dwordx4 v8, s[16:19], s21 offen offset:0   lds
buffer_load_dwordx4 v9, s[16:19], s21 offen offset:1024   lds
buffer_load_dwordx4 v10, s[16:19], s21 offen offset:2048   lds
buffer_load_dwordx4 v11, s[16:19], s21 offen offset:3072   lds
SA s21,s21,524160
SA m0,s24,0
s_nop 0
buffer_load_dwordx4 v12, s[48:51], s22 offen offset:0   lds
buffer_load_dwordx4 v13, s[48:51], s22 offen offset:1024   lds
buffer_load_dwordx4 v14, s[48:51], s22 offen offset:2048   lds
buffer_load_dwordx4 v15, s[48:51], s22 offen offset:3072   lds
SA s22,s22,1048576
s_load_dwordx2 s[92:93], s[0:1], 56
s_load_dwordx2 s[94:95], s[0:1], 88
s_load_dwordx4 s[4:7], s[0:1], 104
v_lshlrev_b32 v7, 4, v0
v_lshrrev_b32 v26, 2, v24
v_and_b32 v28, 1, v25
v_lshl_or_b32 v28, v28, 2, v26
v_lshl_add_u32 v29, v25, 3, v26
v_lshlrev_b32 v29, 8, v29
v_and_b32 v30, 3, v0
v_lshl_add_u32 v29, v30, 3, v29
s_lshl_b32 s64, s65, 2
SA s64,s64,0
v_xor_b32 v30, s64, v28
v_lshl_add_u32 v1, v30, 5, v29
s_lshl_b32 s64, s65, 2
SA s64,s64,1
v_xor_b32 v30, s64, v28
v_lshl_add_u32 v2, v30, 5, v29
s_lshl_b32 s64, s65, 2
SA s64,s64,2
v_xor_b32 v30, s64, v28
v_lshl_add_u32 v3, v30, 5, v29
s_lshl_b32 s64, s65, 2
SA s64,s64,3
v_xor_b32 v30, s64, v28
v_lshl_add_u32 v4, v30, 5, v29
v_add_u32 v28, 0, v25
v_lshrrev_b32 v29, 1, v24
v_xor_b32 v28, v28, v29
v_lshlrev_b32 v28, 4, v28
v_lshl_add_u32 v28, v24, 7, v28
s_lshl_b32 s64, s66, 13
SA s64,s64,65536
v_add_u32 v5, s64, v28
v_add_u32 v28, 4, v25
v_lshrrev_b32 v29, 1, v24
v_xor_b32 v28, v28, v29
v_lshlrev_b32 v28, 4, v28
v_lshl_add_u32 v28, v24, 7, v28
s_lshl_b32 s64, s66, 13
SA s64,s64,65536
v_add_u32 v6, s64, v28
s_mov_b32 s56, s80
s_and_b32 s57, s81, 0xffff
s_mov_b32 s58, 1835008
s_mov_b32 s59, 0x20000
s_waitcnt lgkmcnt(0)
s_mov_b32 s60, s92
s_and_b32 s61, s93, 0xffff
s_mov_b32 s62, 896
s_mov_b32 s63, 0x20000
s_mov_b32 s68, s94
s_and_b32 s69, s95, 0xffff
s_mov_b32 s70, 896
s_mov_b32 s71, 0x20000
s_lshl_b32 s95, s20, 11
s_lshr_b32 s64, s2, 3
s_lshl_b32 s64, s64, 13
SA s95,s95,s64
s_mov_b32 s8, s6
s_and_b32 s9, s7, 0xffff
s_mov_b32 s10, 268435456
s_mov_b32 s11, 0x20000
s_mov_b32 s12, s4
s_and_b32 s13, s5, 0xffff
s_mov_b32 s14, 256
s_mov_b32 s15, 0x20000
SA s72,s84,s74
s_addc_u32 s73, s85, 0
s_sub_u32 s75, 3670016, s74
s_mov_b32 s52, s72
s_and_b32 s53, s73, 0xffff
s_mov_b32 s54, s75
s_mov_b32 s55, 0x20000
s_mul_i32 s29, s42, 114688
s_mov_b32 s5, 0x3db8aa3b
s_mul_i32 s72, s45, 16777216
s_mul_i32 s73, s41, 1048576
SA s72,s72,s73
s_bfe_u32 s64, s42, 0x20001
s_lshl_b32 s64, s64, 15
SA s72,s72,s64
s_lshl_b32 s64, s66, 17
SA s72,s72,s64
s_and_b32 s67, s42, 1
s_cmp_eq_u32 s45, 0
s_cselect_b32 s64, 12, 14
s_cselect_b32 s75, 14, 10
s_lshl_b32 s67, s67, s75
SA s72,s72,s67
s_lshl_b32 s64, s65, s64
SA s93,s72,s64
s_load_dwordx4 s[80:83], s[0:1], 64
s_load_dwordx2 s[84:85], s[0:1], 80
s_load_dwordx2 s[96:97], s[0:1], 96
s_cmp_eq_u32 s45, 0
s_cbranch_scc0 L_kv1
s_branch L_kv0
.p2align 12
L_kv0:
s_and_b32 s31, s42, 7
s_lshl_b32 s64, s42, 4
SA s64,s64,s41
s_lshl_b32 s64, s64, 2
SA s64,s64,s20
s_cmp_lt_u32 s64, 41
s_cselect_b32 s39, 0, 536870912
s_min_u32 s64, s64, 41
s_lshl_b32 s38, s64, 2
s_max_u32 s67, s64, 8
s_sub_u32 s67, s67, 8
s_mul_i32 s67, s67, 3328
s_lshl_b32 s64, s64, 10
SA s64,s64,s67
SA s73,s64,104914944
v_or_b32 v64, s39, v7
v_mov_b32 v68, 0
v_mov_b32 v69, 0
v_mov_b32 v70, 0
v_mov_b32 v71, 0
buffer_store_dwordx4 v[68:71], v64, s[8:11], s73 offen offset:0 sc1
buffer_store_dwordx4 v[68:71], v64, s[8:11], s73 offen offset:1024 sc1
buffer_store_dwordx4 v[68:71], v64, s[8:11], s73 offen offset:2048 sc1
SA m0,s24,16384
s_nop 0
buffer_load_dwordx4 v12, s[48:51], s22 offen offset:0   lds
buffer_load_dwordx4 v13, s[48:51], s22 offen offset:1024   lds
buffer_load_dwordx4 v14, s[48:51], s22 offen offset:2048   lds
buffer_load_dwordx4 v15, s[48:51], s22 offen offset:3072   lds
s_sub_u32 s22, s22, 1048448
SA m0,s23,32768
s_nop 0
buffer_load_dwordx4 v8, s[16:19], s21 offen offset:0   lds
buffer_load_dwordx4 v9, s[16:19], s21 offen offset:1024   lds
buffer_load_dwordx4 v10, s[16:19], s21 offen offset:2048   lds
buffer_load_dwordx4 v11, s[16:19], s21 offen offset:3072   lds
SA s21,s21,128
s_mov_b64 exec, 0
s_cmp_eq_u32 s20, 0
s_cbranch_scc1 L_w_kv01
s_cmp_eq_u32 s20, 1
s_cbranch_scc1 L_w_kv02
s_cmp_eq_u32 s20, 2
s_cbranch_scc1 L_w_kv03
s_branch L_w_kv04
L_wd1:
s_mov_b64 exec, -1
s_waitcnt vmcnt(11) lgkmcnt(0)
s_barrier
R a[160:163],v5,0
R a[164:167],v6,0
T a[96:97],v1,0
T a[98:99],v1,1024
T a[100:101],v1,8192
T a[102:103],v1,9216
T a[104:105],v2,0
T a[106:107],v2,1024
T a[108:109],v2,8192
T a[110:111],v2,9216
T a[112:113],v3,0
T a[114:115],v3,1024
T a[116:117],v3,8192
T a[118:119],v3,9216
T a[120:121],v4,0
T a[122:123],v4,1024
T a[124:125],v4,8192
T a[126:127],v4,9216
T a[128:129],v1,16384
T a[130:131],v1,17408
T a[132:133],v1,24576
T a[134:135],v1,25600
T a[136:137],v2,16384
T a[138:139],v2,17408
T a[140:141],v2,24576
T a[142:143],v2,25600
T a[144:145],v3,16384
T a[146:147],v3,17408
T a[148:149],v3,24576
T a[150:151],v3,25600
T a[152:153],v4,16384
T a[154:155],v4,17408
T a[156:157],v4,24576
T a[158:159],v4,25600
s_waitcnt lgkmcnt(15)
M a[0:3],a[96:99],a[160:163],0
SA m0,s23,49152
R a[168:171],v5,2048
R a[172:175],v6,2048
M a[0:3],a[100:103],a[164:167],a[0:3]
buffer_load_dwordx4 v8, s[16:19], s21 offen offset:0   lds
M a[4:7],a[108:111],a[164:167],0
M a[4:7],a[104:107],a[160:163],a[4:7]
M a[8:11],a[112:115],a[160:163],0
buffer_load_dwordx4 v9, s[16:19], s21 offen offset:1024   lds
M a[8:11],a[116:119],a[164:167],a[8:11]
s_waitcnt lgkmcnt(14)
M a[12:15],a[124:127],a[164:167],0
M a[12:15],a[120:123],a[160:163],a[12:15]
M a[16:19],a[128:131],a[160:163],0
buffer_load_dwordx4 v10, s[16:19], s21 offen offset:2048   lds
M a[16:19],a[132:135],a[164:167],a[16:19]
s_waitcnt lgkmcnt(6)
M a[20:23],a[140:143],a[164:167],0
M a[20:23],a[136:139],a[160:163],a[20:23]
buffer_load_dwordx4 v11, s[16:19], s21 offen offset:3072   lds
M a[24:27],a[144:147],a[160:163],0
SA s21,s21,524160
M a[24:27],a[148:151],a[164:167],a[24:27]
s_waitcnt lgkmcnt(0)
M a[28:31],a[156:159],a[164:167],0
SA m0,s24,32768
M a[28:31],a[152:155],a[160:163],a[28:31]
buffer_load_dwordx4 v12, s[48:51], s22 offen offset:0   lds
M v[32:35],a[96:99],a[168:171],0
R a[160:163],v5,4096
R a[164:167],v6,4096
M v[32:35],a[100:103],a[172:175],v[32:35]
M v[36:39],a[108:111],a[172:175],0
M v[36:39],a[104:107],a[168:171],v[36:39]
buffer_load_dwordx4 v13, s[48:51], s22 offen offset:1024   lds
M v[40:43],a[112:115],a[168:171],0
M v[40:43],a[116:119],a[172:175],v[40:43]
M v[44:47],a[124:127],a[172:175],0
buffer_load_dwordx4 v14, s[48:51], s22 offen offset:2048   lds
M v[44:47],a[120:123],a[168:171],v[44:47]
M v[48:51],a[128:131],a[168:171],0
M v[48:51],a[132:135],a[172:175],v[48:51]
M v[52:55],a[140:143],a[172:175],0
buffer_load_dwordx4 v15, s[48:51], s22 offen offset:3072   lds
M v[52:55],a[136:139],a[168:171],v[52:55]
SA s22,s22,1048576
M v[56:59],a[144:147],a[168:171],0
M v[56:59],a[148:151],a[172:175],v[56:59]
s_waitcnt lgkmcnt(0)
M v[60:63],a[156:159],a[172:175],0
M v[60:63],a[152:155],a[168:171],v[60:63]
M v[64:67],a[96:99],a[160:163],0
R a[168:171],v5,6144
R a[172:175],v6,6144
M v[64:67],a[100:103],a[164:167],v[64:67]
M v[68:71],a[108:111],a[164:167],0
M v[68:71],a[104:107],a[160:163],v[68:71]
M v[72:75],a[112:115],a[160:163],0
M v[72:75],a[116:119],a[164:167],v[72:75]
M v[76:79],a[124:127],a[164:167],0
M v[76:79],a[120:123],a[160:163],v[76:79]
M v[80:83],a[128:131],a[160:163],0
M v[80:83],a[132:135],a[164:167],v[80:83]
M v[84:87],a[140:143],a[164:167],0
M v[84:87],a[136:139],a[160:163],v[84:87]
M v[88:91],a[144:147],a[160:163],0
M v[88:91],a[148:151],a[164:167],v[88:91]
s_waitcnt lgkmcnt(0)
M v[92:95],a[156:159],a[164:167],0
s_waitcnt vmcnt(12)
M v[92:95],a[152:155],a[160:163],v[92:95]
s_barrier
M v[96:99],a[96:99],a[168:171],0
SA m0,s23,0
R a[160:163],v5,16384
R a[164:167],v6,16384
M v[96:99],a[100:103],a[172:175],v[96:99]
buffer_load_dwordx4 v8, s[16:19], s21 offen offset:0   lds
M v[100:103],a[108:111],a[172:175],0
v_lshlrev_b32 v26, 7, v0
v_and_b32 v27, 48, v0
M v[100:103],a[104:107],a[168:171],v[100:103]
v_lshl_add_u32 v26, v27, 24, v26
M v[104:107],a[112:115],a[168:171],0
buffer_load_dwordx4 v9, s[16:19], s21 offen offset:1024   lds
M v[104:107],a[116:119],a[172:175],v[104:107]
M v[108:111],a[124:127],a[172:175],0
M v[108:111],a[120:123],a[168:171],v[108:111]
buffer_load_dwordx4 v10, s[16:19], s21 offen offset:2048   lds
M v[112:115],a[128:131],a[168:171],0
M v[112:115],a[132:135],a[172:175],v[112:115]
M v[116:119],a[140:143],a[172:175],0
M v[116:119],a[136:139],a[168:171],v[116:119]
buffer_load_dwordx4 v11, s[16:19], s21 offen offset:3072   lds
M v[120:123],a[144:147],a[168:171],0
SA s21,s21,128
M v[120:123],a[148:151],a[172:175],v[120:123]
s_waitcnt lgkmcnt(0)
M v[124:127],a[156:159],a[172:175],0
SA m0,s24,49152
M v[124:127],a[152:155],a[168:171],v[124:127]
buffer_load_dwordx4 v12, s[48:51], s22 offen offset:0   lds
M v[128:131],a[96:99],a[160:163],0
R a[168:171],v5,18432
R a[172:175],v6,18432
M v[128:131],a[100:103],a[164:167],v[128:131]
buffer_load_dwordx4 v13, s[48:51], s22 offen offset:1024   lds
M v[132:135],a[108:111],a[164:167],0
M v[132:135],a[104:107],a[160:163],v[132:135]
M v[136:139],a[112:115],a[160:163],0
M v[136:139],a[116:119],a[164:167],v[136:139]
buffer_load_dwordx4 v14, s[48:51], s22 offen offset:2048   lds
M v[140:143],a[124:127],a[164:167],0
M v[140:143],a[120:123],a[160:163],v[140:143]
M v[144:147],a[128:131],a[160:163],0
buffer_load_dwordx4 v15, s[48:51], s22 offen offset:3072   lds
M v[144:147],a[132:135],a[164:167],v[144:147]
s_sub_u32 s22, s22, 1048448
M v[148:151],a[140:143],a[164:167],0
M v[148:151],a[136:139],a[160:163],v[148:151]
M v[152:155],a[144:147],a[160:163],0
M v[152:155],a[148:151],a[164:167],v[152:155]
s_waitcnt lgkmcnt(0)
M v[156:159],a[156:159],a[164:167],0
s_waitcnt vmcnt(12)
M v[156:159],a[152:155],a[160:163],v[156:159]
s_barrier
M v[160:163],a[96:99],a[168:171],0
SA m0,s23,16384
R a[160:163],v5,20480
R a[164:167],v6,20480
M v[160:163],a[100:103],a[172:175],v[160:163]
T a[32:33],v1,32768
T a[34:35],v1,33792
M v[164:167],a[108:111],a[172:175],0
T a[36:37],v1,40960
T a[38:39],v1,41984
M v[164:167],a[104:107],a[168:171],v[164:167]
T a[40:41],v2,32768
T a[42:43],v2,33792
M v[168:171],a[112:115],a[168:171],0
T a[44:45],v2,40960
T a[46:47],v2,41984
M v[168:171],a[116:119],a[172:175],v[168:171]
buffer_load_dwordx4 v8, s[16:19], s21 offen offset:0   lds
M v[172:175],a[124:127],a[172:175],0
s_nop 0
T a[48:49],v3,32768
T a[50:51],v3,33792
M v[172:175],a[120:123],a[168:171],v[172:175]
buffer_load_dwordx4 v9, s[16:19], s21 offen offset:1024   lds
M v[176:179],a[128:131],a[168:171],0
s_nop 0
T a[52:53],v3,40960
T a[54:55],v3,41984
M v[176:179],a[132:135],a[172:175],v[176:179]
T a[56:57],v4,32768
T a[58:59],v4,33792
M v[180:183],a[140:143],a[172:175],0
buffer_load_dwordx4 v10, s[16:19], s21 offen offset:2048   lds
M v[180:183],a[136:139],a[168:171],v[180:183]
s_nop 0
T a[60:61],v4,40960
T a[62:63],v4,41984
M v[184:187],a[144:147],a[168:171],0
buffer_load_dwordx4 v11, s[16:19], s21 offen offset:3072   lds
M v[184:187],a[148:151],a[172:175],v[184:187]
s_waitcnt lgkmcnt(15)
s_nop 0
T a[64:65],v1,49152
T a[66:67],v1,50176
M v[188:191],a[156:159],a[172:175],0
SA s21,s21,524160
T a[68:69],v1,57344
T a[70:71],v1,58368
M v[188:191],a[152:155],a[168:171],v[188:191]
SA m0,s24,0
M v[192:195],a[96:99],a[160:163],0
R a[168:171],v5,22528
R a[172:175],v6,22528
M v[192:195],a[100:103],a[164:167],v[192:195]
T a[72:73],v2,49152
T a[74:75],v2,50176
M v[196:199],a[108:111],a[164:167],0
T a[76:77],v2,57344
T a[78:79],v2,58368
M v[196:199],a[104:107],a[160:163],v[196:199]
T a[80:81],v3,49152
T a[82:83],v3,50176
M v[200:203],a[112:115],a[160:163],0
buffer_load_dwordx4 v12, s[48:51], s22 offen offset:0   lds
M v[200:203],a[116:119],a[164:167],v[200:203]
s_nop 0
T a[84:85],v3,57344
T a[86:87],v3,58368
M v[204:207],a[124:127],a[164:167],0
T a[88:89],v4,49152
T a[90:91],v4,50176
M v[204:207],a[120:123],a[160:163],v[204:207]
buffer_load_dwordx4 v13, s[48:51], s22 offen offset:1024   lds
M v[208:211],a[128:131],a[160:163],0
s_nop 0
T a[92:93],v4,57344
T a[94:95],v4,58368
M v[208:211],a[132:135],a[164:167],v[208:211]
buffer_load_dwordx4 v14, s[48:51], s22 offen offset:2048   lds
M v[212:215],a[140:143],a[164:167],0
buffer_load_dwordx4 v15, s[48:51], s22 offen offset:3072   lds
M v[212:215],a[136:139],a[160:163],v[212:215]
SA s22,s22,1048576
M v[216:219],a[144:147],a[160:163],0
M v[216:219],a[148:151],a[164:167],v[216:219]
s_waitcnt lgkmcnt(12)
M v[220:223],a[156:159],a[164:167],0
s_waitcnt vmcnt(12) lgkmcnt(0)
M v[220:223],a[152:155],a[160:163],v[220:223]
s_barrier
M v[224:227],a[96:99],a[168:171],0
SA m0,s23,32768
R a[160:163],v5,32768
R a[164:167],v6,32768
M v[224:227],a[100:103],a[172:175],v[224:227]
buffer_load_dwordx4 v8, s[16:19], s21 offen offset:0   lds
M v[228:231],a[108:111],a[172:175],0
M v[228:231],a[104:107],a[168:171],v[228:231]
M v[232:235],a[112:115],a[168:171],0
buffer_load_dwordx4 v9, s[16:19], s21 offen offset:1024   lds
M v[232:235],a[116:119],a[172:175],v[232:235]
M v[236:239],a[124:127],a[172:175],0
M v[236:239],a[120:123],a[168:171],v[236:239]
buffer_load_dwordx4 v10, s[16:19], s21 offen offset:2048   lds
M v[240:243],a[128:131],a[168:171],0
M v[240:243],a[132:135],a[172:175],v[240:243]
M v[244:247],a[140:143],a[172:175],0
buffer_load_dwordx4 v11, s[16:19], s21 offen offset:3072   lds
M v[244:247],a[136:139],a[168:171],v[244:247]
SA s21,s21,128
M v[248:251],a[144:147],a[168:171],0
M v[248:251],a[148:151],a[172:175],v[248:251]
s_waitcnt lgkmcnt(0)
M v[252:255],a[156:159],a[172:175],0
M v[252:255],a[152:155],a[168:171],v[252:255]
M a[0:3],a[32:35],a[160:163],a[0:3]
R a[168:171],v5,34816
R a[172:175],v6,34816
M a[0:3],a[36:39],a[164:167],a[0:3]
T a[96:97],v1,0
T a[98:99],v1,1024
M a[4:7],a[44:47],a[164:167],a[4:7]
SA m0,s24,16384
M a[4:7],a[40:43],a[160:163],a[4:7]
buffer_load_dwordx4 v12, s[48:51], s22 offen offset:0   lds
M a[8:11],a[48:51],a[160:163],a[8:11]
M a[8:11],a[52:55],a[164:167],a[8:11]
M a[12:15],a[60:63],a[164:167],a[12:15]
s_nop 0
T a[100:101],v1,8192
T a[102:103],v1,9216
M a[12:15],a[56:59],a[160:163],a[12:15]
M a[16:19],a[64:67],a[160:163],a[16:19]
buffer_load_dwordx4 v13, s[48:51], s22 offen offset:1024   lds
M a[16:19],a[68:71],a[164:167],a[16:19]
M a[20:23],a[76:79],a[164:167],a[20:23]
M a[20:23],a[72:75],a[160:163],a[20:23]
s_nop 0
T a[104:105],v2,0
T a[106:107],v2,1024
M a[24:27],a[80:83],a[160:163],a[24:27]
M a[24:27],a[84:87],a[164:167],a[24:27]
s_waitcnt lgkmcnt(6)
buffer_load_dwordx4 v14, s[48:51], s22 offen offset:2048   lds
M a[28:31],a[92:95],a[164:167],a[28:31]
M a[28:31],a[88:91],a[160:163],a[28:31]
M v[60:63],a[88:91],a[168:171],v[60:63]
R a[160:163],v5,36864
R a[164:167],v6,36864
M v[60:63],a[92:95],a[172:175],v[60:63]
T a[108:109],v2,8192
T a[110:111],v2,9216
M v[56:59],a[84:87],a[172:175],v[56:59]
buffer_load_dwordx4 v15, s[48:51], s22 offen offset:3072   lds
M v[56:59],a[80:83],a[168:171],v[56:59]
s_sub_u32 s22, s22, 1048448
M v[52:55],a[72:75],a[168:171],v[52:55]
M v[52:55],a[76:79],a[172:175],v[52:55]
s_nop 0
T a[112:113],v3,0
T a[114:115],v3,1024
M v[48:51],a[68:71],a[172:175],v[48:51]
SA m0,s23,49152
M v[48:51],a[64:67],a[168:171],v[48:51]
buffer_load_dwordx4 v8, s[16:19], s21 offen offset:0   lds
M v[44:47],a[56:59],a[168:171],v[44:47]
M v[44:47],a[60:63],a[172:175],v[44:47]
M v[40:43],a[52:55],a[172:175],v[40:43]
s_nop 0
T a[116:117],v3,8192
T a[118:119],v3,9216
M v[40:43],a[48:51],a[168:171],v[40:43]
M v[36:39],a[40:43],a[168:171],v[36:39]
buffer_load_dwordx4 v9, s[16:19], s21 offen offset:1024   lds
M v[36:39],a[44:47],a[172:175],v[36:39]
s_waitcnt lgkmcnt(6)
M v[32:35],a[36:39],a[172:175],v[32:35]
M v[32:35],a[32:35],a[168:171],v[32:35]
s_nop 0
T a[120:121],v4,0
T a[122:123],v4,1024
M v[64:67],a[32:35],a[160:163],v[64:67]
R a[168:171],v5,38912
R a[172:175],v6,38912
M v[64:67],a[36:39],a[164:167],v[64:67]
buffer_load_dwordx4 v10, s[16:19], s21 offen offset:2048   lds
M v[68:71],a[44:47],a[164:167],v[68:71]
M v[68:71],a[40:43],a[160:163],v[68:71]
M v[72:75],a[48:51],a[160:163],v[72:75]
s_nop 0
T a[124:125],v4,8192
T a[126:127],v4,9216
M v[72:75],a[52:55],a[164:167],v[72:75]
M v[76:79],a[60:63],a[164:167],v[76:79]
buffer_load_dwordx4 v11, s[16:19], s21 offen offset:3072   lds
M v[76:79],a[56:59],a[160:163],v[76:79]
SA s21,s21,524160
M v[80:83],a[64:67],a[160:163],v[80:83]
M v[80:83],a[68:71],a[164:167],v[80:83]
M v[84:87],a[76:79],a[164:167],v[84:87]
M v[84:87],a[72:75],a[160:163],v[84:87]
M v[88:91],a[80:83],a[160:163],v[88:91]
M v[88:91],a[84:87],a[164:167],v[88:91]
s_waitcnt lgkmcnt(2)
M v[92:95],a[92:95],a[164:167],v[92:95]
s_waitcnt vmcnt(16) lgkmcnt(0)
M v[92:95],a[88:91],a[160:163],v[92:95]
s_barrier
M v[124:127],a[88:91],a[168:171],v[124:127]
R a[160:163],v5,49152
R a[164:167],v6,49152
M v[124:127],a[92:95],a[172:175],v[124:127]
M v[120:123],a[84:87],a[172:175],v[120:123]
SA m0,s24,32768
T a[128:129],v1,16384
T a[130:131],v1,17408
M v[120:123],a[80:83],a[168:171],v[120:123]
buffer_load_dwordx4 v12, s[48:51], s22 offen offset:0   lds
M v[116:119],a[72:75],a[168:171],v[116:119]
M v[116:119],a[76:79],a[172:175],v[116:119]
M v[112:115],a[68:71],a[172:175],v[112:115]
M v[112:115],a[64:67],a[168:171],v[112:115]
M v[108:111],a[56:59],a[168:171],v[108:111]
M v[108:111],a[60:63],a[172:175],v[108:111]
s_nop 0
T a[132:133],v1,24576
T a[134:135],v1,25600
M v[104:107],a[52:55],a[172:175],v[104:107]
buffer_load_dwordx4 v13, s[48:51], s22 offen offset:1024   lds
M v[104:107],a[48:51],a[168:171],v[104:107]
M v[100:103],a[40:43],a[168:171],v[100:103]
M v[100:103],a[44:47],a[172:175],v[100:103]
s_waitcnt lgkmcnt(4)
M v[96:99],a[36:39],a[172:175],v[96:99]
M v[96:99],a[32:35],a[168:171],v[96:99]
M v[128:131],a[32:35],a[160:163],v[128:131]
R a[168:171],v5,51200
R a[172:175],v6,51200
M v[128:131],a[36:39],a[164:167],v[128:131]
T a[136:137],v2,16384
T a[138:139],v2,17408
M v[132:135],a[44:47],a[164:167],v[132:135]
buffer_load_dwordx4 v14, s[48:51], s22 offen offset:2048   lds
M v[132:135],a[40:43],a[160:163],v[132:135]
M v[136:139],a[48:51],a[160:163],v[136:139]
M v[136:139],a[52:55],a[164:167],v[136:139]
M v[140:143],a[60:63],a[164:167],v[140:143]
M v[140:143],a[56:59],a[160:163],v[140:143]
s_nop 0
T a[140:141],v2,24576
T a[142:143],v2,25600
M v[144:147],a[64:67],a[160:163],v[144:147]
buffer_load_dwordx4 v15, s[48:51], s22 offen offset:3072   lds
M v[144:147],a[68:71],a[164:167],v[144:147]
SA s22,s22,1048576
M v[148:151],a[76:79],a[164:167],v[148:151]
M v[148:151],a[72:75],a[160:163],v[148:151]
M v[152:155],a[80:83],a[160:163],v[152:155]
M v[152:155],a[84:87],a[164:167],v[152:155]
s_waitcnt lgkmcnt(4)
M v[156:159],a[92:95],a[164:167],v[156:159]
SA m0,s23,0
T a[144:145],v3,16384
T a[146:147],v3,17408
M v[156:159],a[88:91],a[160:163],v[156:159]
buffer_load_dwordx4 v8, s[16:19], s21 offen offset:0   lds
M v[188:191],a[88:91],a[168:171],v[188:191]
R a[160:163],v5,53248
R a[164:167],v6,53248
M v[188:191],a[92:95],a[172:175],v[188:191]
M v[184:187],a[84:87],a[172:175],v[184:187]
M v[184:187],a[80:83],a[168:171],v[184:187]
M v[180:183],a[72:75],a[168:171],v[180:183]
M v[180:183],a[76:79],a[172:175],v[180:183]
s_nop 0
T a[148:149],v3,24576
T a[150:151],v3,25600
M v[176:179],a[68:71],a[172:175],v[176:179]
buffer_load_dwordx4 v9, s[16:19], s21 offen offset:1024   lds
M v[176:179],a[64:67],a[168:171],v[176:179]
M v[172:175],a[56:59],a[168:171],v[172:175]
M v[172:175],a[60:63],a[172:175],v[172:175]
M v[168:171],a[52:55],a[172:175],v[168:171]
M v[168:171],a[48:51],a[168:171],v[168:171]
M v[164:167],a[40:43],a[168:171],v[164:167]
s_nop 0
T a[152:153],v4,16384
T a[154:155],v4,17408
M v[164:167],a[44:47],a[172:175],v[164:167]
s_waitcnt lgkmcnt(4)
buffer_load_dwordx4 v10, s[16:19], s21 offen offset:2048   lds
M v[160:163],a[36:39],a[172:175],v[160:163]
M v[160:163],a[32:35],a[168:171],v[160:163]
M v[192:195],a[32:35],a[160:163],v[192:195]
R a[168:171],v5,55296
R a[172:175],v6,55296
M v[192:195],a[36:39],a[164:167],v[192:195]
M v[196:199],a[44:47],a[164:167],v[196:199]
M v[196:199],a[40:43],a[160:163],v[196:199]
s_nop 0
T a[156:157],v4,24576
T a[158:159],v4,25600
M v[200:203],a[48:51],a[160:163],v[200:203]
buffer_load_dwordx4 v11, s[16:19], s21 offen offset:3072   lds
M v[200:203],a[52:55],a[164:167],v[200:203]
SA s21,s21,128
M v[204:207],a[60:63],a[164:167],v[204:207]
M v[204:207],a[56:59],a[160:163],v[204:207]
M v[208:211],a[64:67],a[160:163],v[208:211]
M v[208:211],a[68:71],a[164:167],v[208:211]
M v[212:215],a[76:79],a[164:167],v[212:215]
M v[212:215],a[72:75],a[160:163],v[212:215]
M v[216:219],a[80:83],a[160:163],v[216:219]
M v[216:219],a[84:87],a[164:167],v[216:219]
s_waitcnt lgkmcnt(2)
M v[220:223],a[92:95],a[164:167],v[220:223]
s_waitcnt vmcnt(16) lgkmcnt(0)
M v[220:223],a[88:91],a[160:163],v[220:223]
s_barrier
M v[252:255],a[88:91],a[168:171],v[252:255]
R a[160:163],v5,0
R a[164:167],v6,0
M v[252:255],a[92:95],a[172:175],v[252:255]
v_min_u32 v16, 1, v0
v_lshlrev_b32 v16, 29, v16
M v[248:251],a[84:87],a[172:175],v[248:251]
v_or_b32 v16, s39, v16
v_mov_b32 v17, 1
M v[248:251],a[80:83],a[168:171],v[248:251]
buffer_store_dword v17, v16, s[12:15], s38 offen sc1
M v[244:247],a[72:75],a[168:171],v[244:247]
M v[244:247],a[76:79],a[172:175],v[244:247]
M v[240:243],a[68:71],a[172:175],v[240:243]
M v[240:243],a[64:67],a[168:171],v[240:243]
M v[236:239],a[56:59],a[168:171],v[236:239]
M v[236:239],a[60:63],a[172:175],v[236:239]
M v[232:235],a[52:55],a[172:175],v[232:235]
M v[232:235],a[48:51],a[168:171],v[232:235]
M v[228:231],a[40:43],a[168:171],v[228:231]
M v[228:231],a[44:47],a[172:175],v[228:231]
s_waitcnt lgkmcnt(0)
M v[224:227],a[36:39],a[172:175],v[224:227]
M v[224:227],a[32:35],a[168:171],v[224:227]
M a[0:3],a[96:99],a[160:163],a[0:3]
L_w_kv01:
s_cbranch_execz L_w_kv05
R a[168:171],v5,2048
R a[172:175],v6,2048
M a[0:3],a[100:103],a[164:167],a[0:3]
T a[32:33],v1,32768
T a[34:35],v1,33792
M a[4:7],a[108:111],a[164:167],a[4:7]
SA m0,s24,49152
M a[4:7],a[104:107],a[160:163],a[4:7]
buffer_load_dwordx4 v12, s[48:51], s22 offen offset:0   lds
M a[8:11],a[112:115],a[160:163],a[8:11]
M a[8:11],a[116:119],a[164:167],a[8:11]
M a[12:15],a[124:127],a[164:167],a[12:15]
s_nop 0
T a[36:37],v1,40960
T a[38:39],v1,41984
M a[12:15],a[120:123],a[160:163],a[12:15]
M a[16:19],a[128:131],a[160:163],a[16:19]
buffer_load_dwordx4 v13, s[48:51], s22 offen offset:1024   lds
M a[16:19],a[132:135],a[164:167],a[16:19]
M a[20:23],a[140:143],a[164:167],a[20:23]
M a[20:23],a[136:139],a[160:163],a[20:23]
s_nop 0
T a[40:41],v2,32768
T a[42:43],v2,33792
M a[24:27],a[144:147],a[160:163],a[24:27]
M a[24:27],a[148:151],a[164:167],a[24:27]
s_waitcnt lgkmcnt(6)
buffer_load_dwordx4 v14, s[48:51], s22 offen offset:2048   lds
M a[28:31],a[156:159],a[164:167],a[28:31]
M a[28:31],a[152:155],a[160:163],a[28:31]
M v[60:63],a[152:155],a[168:171],v[60:63]
R a[160:163],v5,4096
R a[164:167],v6,4096
M v[60:63],a[156:159],a[172:175],v[60:63]
T a[44:45],v2,40960
T a[46:47],v2,41984
M v[56:59],a[148:151],a[172:175],v[56:59]
buffer_load_dwordx4 v15, s[48:51], s22 offen offset:3072   lds
M v[56:59],a[144:147],a[168:171],v[56:59]
s_sub_u32 s22, s22, 1048448
M v[52:55],a[136:139],a[168:171],v[52:55]
M v[52:55],a[140:143],a[172:175],v[52:55]
s_nop 0
T a[48:49],v3,32768
T a[50:51],v3,33792
M v[48:51],a[132:135],a[172:175],v[48:51]
SA m0,s23,16384
M v[48:51],a[128:131],a[168:171],v[48:51]
buffer_load_dwordx4 v8, s[16:19], s21 offen offset:0   lds
M v[44:47],a[120:123],a[168:171],v[44:47]
M v[44:47],a[124:127],a[172:175],v[44:47]
M v[40:43],a[116:119],a[172:175],v[40:43]
s_nop 0
T a[52:53],v3,40960
T a[54:55],v3,41984
M v[40:43],a[112:115],a[168:171],v[40:43]
M v[36:39],a[104:107],a[168:171],v[36:39]
buffer_load_dwordx4 v9, s[16:19], s21 offen offset:1024   lds
M v[36:39],a[108:111],a[172:175],v[36:39]
s_waitcnt lgkmcnt(6)
M v[32:35],a[100:103],a[172:175],v[32:35]
M v[32:35],a[96:99],a[168:171],v[32:35]
s_nop 0
T a[56:57],v4,32768
T a[58:59],v4,33792
M v[64:67],a[96:99],a[160:163],v[64:67]
R a[168:171],v5,6144
R a[172:175],v6,6144
M v[64:67],a[100:103],a[164:167],v[64:67]
buffer_load_dwordx4 v10, s[16:19], s21 offen offset:2048   lds
M v[68:71],a[108:111],a[164:167],v[68:71]
M v[68:71],a[104:107],a[160:163],v[68:71]
M v[72:75],a[112:115],a[160:163],v[72:75]
s_nop 0
T a[60:61],v4,40960
T a[62:63],v4,41984
M v[72:75],a[116:119],a[164:167],v[72:75]
M v[76:79],a[124:127],a[164:167],v[76:79]
buffer_load_dwordx4 v11, s[16:19], s21 offen offset:3072   lds
M v[76:79],a[120:123],a[160:163],v[76:79]
SA s21,s21,524160
M v[80:83],a[128:131],a[160:163],v[80:83]
M v[80:83],a[132:135],a[164:167],v[80:83]
M v[84:87],a[140:143],a[164:167],v[84:87]
M v[84:87],a[136:139],a[160:163],v[84:87]
s_and_b32 s64, s41, 7
M v[88:91],a[144:147],a[160:163],v[88:91]
s_min_u32 s65, s64, 4
s_mul_i32 s86, s64, 12
s_lshl_b32 s65, s65, 2
M v[88:91],a[148:151],a[164:167],v[88:91]
s_waitcnt lgkmcnt(2)
SA s86,s86,s65
s_and_b32 s65, s41, 8
M v[92:95],a[156:159],a[164:167],v[92:95]
s_waitcnt vmcnt(17) lgkmcnt(0)
SA s65,s65,s31
SA s86,s86,s65
M v[92:95],a[152:155],a[160:163],v[92:95]
s_barrier
M v[124:127],a[152:155],a[168:171],v[124:127]
R a[160:163],v5,16384
R a[164:167],v6,16384
M v[124:127],a[156:159],a[172:175],v[124:127]
s_and_b32 s64, s64, 4
s_sub_u32 s64, 15, s64
M v[120:123],a[148:151],a[172:175],v[120:123]
SA m0,s24,0
T a[64:65],v1,49152
T a[66:67],v1,50176
M v[120:123],a[144:147],a[168:171],v[120:123]
buffer_load_dwordx4 v12, s[48:51], s22 offen offset:0   lds
M v[116:119],a[136:139],a[168:171],v[116:119]
s_sub_u32 s64, s64, s65
M v[116:119],a[140:143],a[172:175],v[116:119]
s_and_b32 s88, s64, 536870912
M v[112:115],a[132:135],a[172:175],v[112:115]
s_min_u32 s86, s86, 111
M v[112:115],a[128:131],a[168:171],v[112:115]
s_mul_i32 s87, s20, 7168
M v[108:111],a[120:123],a[168:171],v[108:111]
SA s87,s87,131072
M v[108:111],a[124:127],a[172:175],v[108:111]
s_cmp_lt_u32 s20, 2
T a[68:69],v1,57344
T a[70:71],v1,58368
M v[104:107],a[116:119],a[172:175],v[104:107]
s_cselect_b64 s[72:73], s[80:81], s[82:83]
buffer_load_dwordx4 v13, s[48:51], s22 offen offset:1024   lds
M v[104:107],a[112:115],a[168:171],v[104:107]
s_mov_b32 s60, s72
M v[100:103],a[104:107],a[168:171],v[100:103]
s_and_b32 s61, s73, 0xffff
s_mov_b32 s62, 1605632
s_mov_b32 s63, 0x20000
M v[100:103],a[108:111],a[172:175],v[100:103]
s_waitcnt lgkmcnt(4)
s_mov_b32 s68, s84
M v[96:99],a[100:103],a[172:175],v[96:99]
s_and_b32 s69, s85, 0xffff
M v[96:99],a[96:99],a[168:171],v[96:99]
s_mov_b32 s70, 1605632
M v[128:131],a[96:99],a[160:163],v[128:131]
s_mov_b32 s71, 0x20000
R a[168:171],v5,18432
R a[172:175],v6,18432
M v[128:131],a[100:103],a[164:167],v[128:131]
s_lshl_b32 s89, s86, 5
T a[72:73],v2,49152
T a[74:75],v2,50176
M v[132:135],a[108:111],a[164:167],v[132:135]
s_and_b32 s64, s20, 1
buffer_load_dwordx4 v14, s[48:51], s22 offen offset:2048   lds
M v[132:135],a[104:107],a[160:163],v[132:135]
s_mul_i32 s64, s64, 802816
M v[136:139],a[112:115],a[160:163],v[136:139]
SA s89,s89,s64
v_lshrrev_b32 v28, 1, v0
v_mul_u32_u24 v28, 3584, v28
M v[136:139],a[116:119],a[164:167],v[136:139]
v_and_b32 v29, 1, v0
v_lshl_add_u32 v25, v29, 4, v28
M v[140:143],a[124:127],a[164:167],v[140:143]
v_or_b32 v25, s88, v25
M v[140:143],a[120:123],a[160:163],v[140:143]
s_nop 0
T a[76:77],v2,57344
T a[78:79],v2,58368
M v[144:147],a[128:131],a[160:163],v[144:147]
buffer_load_dwordx4 v15, s[48:51], s22 offen offset:3072   lds
M v[144:147],a[132:135],a[164:167],v[144:147]
SA s22,s22,1048576
M v[148:151],a[140:143],a[164:167],v[148:151]
M v[148:151],a[136:139],a[160:163],v[148:151]
M v[152:155],a[144:147],a[160:163],v[152:155]
M v[152:155],a[148:151],a[164:167],v[152:155]
s_waitcnt lgkmcnt(4)
M v[156:159],a[156:159],a[164:167],v[156:159]
SA m0,s23,32768
T a[80:81],v3,49152
T a[82:83],v3,50176
M v[156:159],a[152:155],a[160:163],v[156:159]
buffer_load_dwordx4 v8, s[16:19], s21 offen offset:0   lds
M v[188:191],a[152:155],a[168:171],v[188:191]
R a[160:163],v5,20480
R a[164:167],v6,20480
M v[188:191],a[156:159],a[172:175],v[188:191]
M v[184:187],a[148:151],a[172:175],v[184:187]
M v[184:187],a[144:147],a[168:171],v[184:187]
M v[180:183],a[136:139],a[168:171],v[180:183]
M v[180:183],a[140:143],a[172:175],v[180:183]
s_nop 0
T a[84:85],v3,57344
T a[86:87],v3,58368
M v[176:179],a[132:135],a[172:175],v[176:179]
buffer_load_dwordx4 v9, s[16:19], s21 offen offset:1024   lds
M v[176:179],a[128:131],a[168:171],v[176:179]
M v[172:175],a[120:123],a[168:171],v[172:175]
M v[172:175],a[124:127],a[172:175],v[172:175]
M v[168:171],a[116:119],a[172:175],v[168:171]
M v[168:171],a[112:115],a[168:171],v[168:171]
M v[164:167],a[104:107],a[168:171],v[164:167]
s_nop 0
T a[88:89],v4,49152
T a[90:91],v4,50176
M v[164:167],a[108:111],a[172:175],v[164:167]
s_waitcnt lgkmcnt(4)
buffer_load_dwordx4 v10, s[16:19], s21 offen offset:2048   lds
M v[160:163],a[100:103],a[172:175],v[160:163]
M v[160:163],a[96:99],a[168:171],v[160:163]
M v[192:195],a[96:99],a[160:163],v[192:195]
R a[168:171],v5,22528
R a[172:175],v6,22528
M v[192:195],a[100:103],a[164:167],v[192:195]
M v[196:199],a[108:111],a[164:167],v[196:199]
M v[196:199],a[104:107],a[160:163],v[196:199]
s_nop 0
T a[92:93],v4,57344
T a[94:95],v4,58368
M v[200:203],a[112:115],a[160:163],v[200:203]
buffer_load_dwordx4 v11, s[16:19], s21 offen offset:3072   lds
M v[200:203],a[116:119],a[164:167],v[200:203]
SA s21,s21,128
M v[204:207],a[124:127],a[164:167],v[204:207]
M v[204:207],a[120:123],a[160:163],v[204:207]
M v[208:211],a[128:131],a[160:163],v[208:211]
M v[208:211],a[132:135],a[164:167],v[208:211]
M v[212:215],a[140:143],a[164:167],v[212:215]
M v[212:215],a[136:139],a[160:163],v[212:215]
M v[216:219],a[144:147],a[160:163],v[216:219]
M v[216:219],a[148:151],a[164:167],v[216:219]
s_waitcnt lgkmcnt(2)
M v[220:223],a[156:159],a[164:167],v[220:223]
s_waitcnt vmcnt(17) lgkmcnt(0)
M v[220:223],a[152:155],a[160:163],v[220:223]
s_barrier
M v[252:255],a[152:155],a[168:171],v[252:255]
R a[160:163],v5,32768
R a[164:167],v6,32768
M v[252:255],a[156:159],a[172:175],v[252:255]
M v[248:251],a[148:151],a[172:175],v[248:251]
M v[248:251],a[144:147],a[168:171],v[248:251]
M v[244:247],a[136:139],a[168:171],v[244:247]
M v[244:247],a[140:143],a[172:175],v[244:247]
M v[240:243],a[132:135],a[172:175],v[240:243]
M v[240:243],a[128:131],a[168:171],v[240:243]
M v[236:239],a[120:123],a[168:171],v[236:239]
M v[236:239],a[124:127],a[172:175],v[236:239]
M v[232:235],a[116:119],a[172:175],v[232:235]
M v[232:235],a[112:115],a[168:171],v[232:235]
M v[228:231],a[104:107],a[168:171],v[228:231]
M v[228:231],a[108:111],a[172:175],v[228:231]
s_waitcnt lgkmcnt(0)
M v[224:227],a[100:103],a[172:175],v[224:227]
M v[224:227],a[96:99],a[168:171],v[224:227]
M a[0:3],a[32:35],a[160:163],a[0:3]
R a[168:171],v5,34816
R a[172:175],v6,34816
M a[0:3],a[36:39],a[164:167],a[0:3]
T a[96:97],v1,0
T a[98:99],v1,1024
M a[4:7],a[44:47],a[164:167],a[4:7]
SA m0,s24,16384
M a[4:7],a[40:43],a[160:163],a[4:7]
buffer_load_dwordx4 v12, s[48:51], s22 offen offset:0   lds
M a[8:11],a[48:51],a[160:163],a[8:11]
M a[8:11],a[52:55],a[164:167],a[8:11]
M a[12:15],a[60:63],a[164:167],a[12:15]
s_nop 0
T a[100:101],v1,8192
T a[102:103],v1,9216
M a[12:15],a[56:59],a[160:163],a[12:15]
buffer_load_dwordx4 v13, s[48:51], s22 offen offset:1024   lds
M a[16:19],a[64:67],a[160:163],a[16:19]
M a[16:19],a[68:71],a[164:167],a[16:19]
M a[20:23],a[76:79],a[164:167],a[20:23]
M a[20:23],a[72:75],a[160:163],a[20:23]
s_nop 0
T a[104:105],v2,0
T a[106:107],v2,1024
M a[24:27],a[80:83],a[160:163],a[24:27]
buffer_load_dwordx4 v14, s[48:51], s22 offen offset:2048   lds
M a[24:27],a[84:87],a[164:167],a[24:27]
s_waitcnt lgkmcnt(6)
M a[28:31],a[92:95],a[164:167],a[28:31]
M a[28:31],a[88:91],a[160:163],a[28:31]
M v[60:63],a[88:91],a[168:171],v[60:63]
R a[160:163],v5,36864
R a[164:167],v6,36864
M v[60:63],a[92:95],a[172:175],v[60:63]
T a[108:109],v2,8192
T a[110:111],v2,9216
M v[56:59],a[84:87],a[172:175],v[56:59]
buffer_load_dwordx4 v15, s[48:51], s22 offen offset:3072   lds
M v[56:59],a[80:83],a[168:171],v[56:59]
s_sub_u32 s22, s22, 1048448
M v[52:55],a[72:75],a[168:171],v[52:55]
SA m0,s23,49152
M v[52:55],a[76:79],a[172:175],v[52:55]
s_nop 0
T a[112:113],v3,0
T a[114:115],v3,1024
M v[48:51],a[68:71],a[172:175],v[48:51]
buffer_load_dwordx4 v8, s[16:19], s21 offen offset:0   lds
M v[48:51],a[64:67],a[168:171],v[48:51]
M v[44:47],a[56:59],a[168:171],v[44:47]
M v[44:47],a[60:63],a[172:175],v[44:47]
buffer_load_dwordx4 v9, s[16:19], s21 offen offset:1024   lds
M v[40:43],a[52:55],a[172:175],v[40:43]
s_nop 0
T a[116:117],v3,8192
T a[118:119],v3,9216
M v[40:43],a[48:51],a[168:171],v[40:43]
M v[36:39],a[40:43],a[168:171],v[36:39]
M v[36:39],a[44:47],a[172:175],v[36:39]
s_waitcnt lgkmcnt(6)
M v[32:35],a[36:39],a[172:175],v[32:35]
buffer_load_dwordx4 v10, s[16:19], s21 offen offset:2048   lds
M v[32:35],a[32:35],a[168:171],v[32:35]
s_nop 0
T a[120:121],v4,0
T a[122:123],v4,1024
M v[64:67],a[32:35],a[160:163],v[64:67]
R a[168:171],v5,38912
R a[172:175],v6,38912
M v[64:67],a[36:39],a[164:167],v[64:67]
M v[68:71],a[44:47],a[164:167],v[68:71]
buffer_load_dwordx4 v11, s[16:19], s21 offen offset:3072   lds
M v[68:71],a[40:43],a[160:163],v[68:71]
SA s21,s21,524160
M v[72:75],a[48:51],a[160:163],v[72:75]
s_nop 0
T a[124:125],v4,8192
T a[126:127],v4,9216
M v[72:75],a[52:55],a[164:167],v[72:75]
M v[76:79],a[60:63],a[164:167],v[76:79]
SA m0,s87,0
M v[76:79],a[56:59],a[160:163],v[76:79]
buffer_load_dwordx4 v25, s[60:63], s89 offen offset:0  lds
M v[80:83],a[64:67],a[160:163],v[80:83]
SA s89,s89,114688
M v[80:83],a[68:71],a[164:167],v[80:83]
M v[84:87],a[76:79],a[164:167],v[84:87]
M v[84:87],a[72:75],a[160:163],v[84:87]
M v[88:91],a[80:83],a[160:163],v[88:91]
M v[88:91],a[84:87],a[164:167],v[88:91]
s_waitcnt lgkmcnt(2)
M v[92:95],a[92:95],a[164:167],v[92:95]
s_waitcnt vmcnt(17) lgkmcnt(0)
M v[92:95],a[88:91],a[160:163],v[92:95]
s_barrier
M v[124:127],a[88:91],a[168:171],v[124:127]
R a[160:163],v5,49152
R a[164:167],v6,49152
M v[124:127],a[92:95],a[172:175],v[124:127]
M v[120:123],a[84:87],a[172:175],v[120:123]
SA m0,s24,32768
T a[128:129],v1,16384
T a[130:131],v1,17408
M v[120:123],a[80:83],a[168:171],v[120:123]
buffer_load_dwordx4 v12, s[48:51], s22 offen offset:0   lds
M v[116:119],a[72:75],a[168:171],v[116:119]
v_min_u32 v16, 40, v0
v_lshlrev_b32 v16, 2, v16
M v[116:119],a[76:79],a[172:175],v[116:119]
buffer_load_dword v17, v16, s[12:15], 0 offen sc1
M v[112:115],a[68:71],a[172:175],v[112:115]
M v[112:115],a[64:67],a[168:171],v[112:115]
M v[108:111],a[56:59],a[168:171],v[108:111]
M v[108:111],a[60:63],a[172:175],v[108:111]
s_nop 0
T a[132:133],v1,24576
T a[134:135],v1,25600
M v[104:107],a[52:55],a[172:175],v[104:107]
buffer_load_dwordx4 v13, s[48:51], s22 offen offset:1024   lds
M v[104:107],a[48:51],a[168:171],v[104:107]
M v[100:103],a[40:43],a[168:171],v[100:103]
M v[100:103],a[44:47],a[172:175],v[100:103]
s_waitcnt lgkmcnt(4)
M v[96:99],a[36:39],a[172:175],v[96:99]
M v[96:99],a[32:35],a[168:171],v[96:99]
M v[128:131],a[32:35],a[160:163],v[128:131]
R a[168:171],v5,51200
R a[172:175],v6,51200
M v[128:131],a[36:39],a[164:167],v[128:131]
T a[136:137],v2,16384
T a[138:139],v2,17408
M v[132:135],a[44:47],a[164:167],v[132:135]
buffer_load_dwordx4 v14, s[48:51], s22 offen offset:2048   lds
M v[132:135],a[40:43],a[160:163],v[132:135]
M v[136:139],a[48:51],a[160:163],v[136:139]
M v[136:139],a[52:55],a[164:167],v[136:139]
M v[140:143],a[60:63],a[164:167],v[140:143]
M v[140:143],a[56:59],a[160:163],v[140:143]
s_nop 0
T a[140:141],v2,24576
T a[142:143],v2,25600
M v[144:147],a[64:67],a[160:163],v[144:147]
buffer_load_dwordx4 v15, s[48:51], s22 offen offset:3072   lds
M v[144:147],a[68:71],a[164:167],v[144:147]
SA s22,s22,1048576
M v[148:151],a[76:79],a[164:167],v[148:151]
M v[148:151],a[72:75],a[160:163],v[148:151]
M v[152:155],a[80:83],a[160:163],v[152:155]
M v[152:155],a[84:87],a[164:167],v[152:155]
s_waitcnt lgkmcnt(4)
M v[156:159],a[92:95],a[164:167],v[156:159]
SA m0,s23,0
T a[144:145],v3,16384
T a[146:147],v3,17408
M v[156:159],a[88:91],a[160:163],v[156:159]
buffer_load_dwordx4 v8, s[16:19], s21 offen offset:0   lds
M v[188:191],a[88:91],a[168:171],v[188:191]
R a[160:163],v5,53248
R a[164:167],v6,53248
M v[188:191],a[92:95],a[172:175],v[188:191]
M v[184:187],a[84:87],a[172:175],v[184:187]
M v[184:187],a[80:83],a[168:171],v[184:187]
M v[180:183],a[72:75],a[168:171],v[180:183]
M v[180:183],a[76:79],a[172:175],v[180:183]
s_nop 0
T a[148:149],v3,24576
T a[150:151],v3,25600
M v[176:179],a[68:71],a[172:175],v[176:179]
buffer_load_dwordx4 v9, s[16:19], s21 offen offset:1024   lds
M v[176:179],a[64:67],a[168:171],v[176:179]
M v[172:175],a[56:59],a[168:171],v[172:175]
M v[172:175],a[60:63],a[172:175],v[172:175]
M v[168:171],a[52:55],a[172:175],v[168:171]
M v[168:171],a[48:51],a[168:171],v[168:171]
M v[164:167],a[40:43],a[168:171],v[164:167]
s_nop 0
T a[152:153],v4,16384
T a[154:155],v4,17408
M v[164:167],a[44:47],a[172:175],v[164:167]
s_waitcnt lgkmcnt(4)
buffer_load_dwordx4 v10, s[16:19], s21 offen offset:2048   lds
M v[160:163],a[36:39],a[172:175],v[160:163]
M v[160:163],a[32:35],a[168:171],v[160:163]
M v[192:195],a[32:35],a[160:163],v[192:195]
R a[168:171],v5,55296
R a[172:175],v6,55296
M v[192:195],a[36:39],a[164:167],v[192:195]
M v[196:199],a[44:47],a[164:167],v[196:199]
M v[196:199],a[40:43],a[160:163],v[196:199]
s_nop 0
T a[156:157],v4,24576
T a[158:159],v4,25600
M v[200:203],a[48:51],a[160:163],v[200:203]
buffer_load_dwordx4 v11, s[16:19], s21 offen offset:3072   lds
M v[200:203],a[52:55],a[164:167],v[200:203]
SA s21,s21,128
M v[204:207],a[60:63],a[164:167],v[204:207]
M v[204:207],a[56:59],a[160:163],v[204:207]
M v[208:211],a[64:67],a[160:163],v[208:211]
M v[208:211],a[68:71],a[164:167],v[208:211]
M v[212:215],a[76:79],a[164:167],v[212:215]
M v[212:215],a[72:75],a[160:163],v[212:215]
M v[216:219],a[80:83],a[160:163],v[216:219]
M v[216:219],a[84:87],a[164:167],v[216:219]
s_waitcnt lgkmcnt(2)
M v[220:223],a[92:95],a[164:167],v[220:223]
s_waitcnt vmcnt(18) lgkmcnt(0)
M v[220:223],a[88:91],a[160:163],v[220:223]
s_barrier
M v[252:255],a[88:91],a[168:171],v[252:255]
R a[160:163],v5,0
R a[164:167],v6,0
M v[252:255],a[92:95],a[172:175],v[252:255]
M v[248:251],a[84:87],a[172:175],v[248:251]
M v[248:251],a[80:83],a[168:171],v[248:251]
M v[244:247],a[72:75],a[168:171],v[244:247]
M v[244:247],a[76:79],a[172:175],v[244:247]
M v[240:243],a[68:71],a[172:175],v[240:243]
M v[240:243],a[64:67],a[168:171],v[240:243]
M v[236:239],a[56:59],a[168:171],v[236:239]
M v[236:239],a[60:63],a[172:175],v[236:239]
M v[232:235],a[52:55],a[172:175],v[232:235]
M v[232:235],a[48:51],a[168:171],v[232:235]
M v[228:231],a[40:43],a[168:171],v[228:231]
M v[228:231],a[44:47],a[172:175],v[228:231]
s_waitcnt lgkmcnt(0)
M v[224:227],a[36:39],a[172:175],v[224:227]
M v[224:227],a[32:35],a[168:171],v[224:227]
M a[0:3],a[96:99],a[160:163],a[0:3]
R a[168:171],v5,2048
R a[172:175],v6,2048
M a[0:3],a[100:103],a[164:167],a[0:3]
T a[32:33],v1,32768
T a[34:35],v1,33792
M a[4:7],a[108:111],a[164:167],a[4:7]
SA m0,s24,49152
M a[4:7],a[104:107],a[160:163],a[4:7]
buffer_load_dwordx4 v12, s[48:51], s22 offen offset:0   lds
M a[8:11],a[112:115],a[160:163],a[8:11]
M a[8:11],a[116:119],a[164:167],a[8:11]
M a[12:15],a[124:127],a[164:167],a[12:15]
s_nop 0
T a[36:37],v1,40960
T a[38:39],v1,41984
M a[12:15],a[120:123],a[160:163],a[12:15]
buffer_load_dwordx4 v13, s[48:51], s22 offen offset:1024   lds
M a[16:19],a[128:131],a[160:163],a[16:19]
M a[16:19],a[132:135],a[164:167],a[16:19]
M a[20:23],a[140:143],a[164:167],a[20:23]
M a[20:23],a[136:139],a[160:163],a[20:23]
s_nop 0
T a[40:41],v2,32768
T a[42:43],v2,33792
M a[24:27],a[144:147],a[160:163],a[24:27]
buffer_load_dwordx4 v14, s[48:51], s22 offen offset:2048   lds
M a[24:27],a[148:151],a[164:167],a[24:27]
s_waitcnt lgkmcnt(6)
M a[28:31],a[156:159],a[164:167],a[28:31]
M a[28:31],a[152:155],a[160:163],a[28:31]
M v[60:63],a[152:155],a[168:171],v[60:63]
R a[160:163],v5,4096
R a[164:167],v6,4096
M v[60:63],a[156:159],a[172:175],v[60:63]
T a[44:45],v2,40960
T a[46:47],v2,41984
M v[56:59],a[148:151],a[172:175],v[56:59]
buffer_load_dwordx4 v15, s[48:51], s22 offen offset:3072   lds
M v[56:59],a[144:147],a[168:171],v[56:59]
s_sub_u32 s22, s22, 1048448
M v[52:55],a[136:139],a[168:171],v[52:55]
SA m0,s23,16384
M v[52:55],a[140:143],a[172:175],v[52:55]
s_nop 0
T a[48:49],v3,32768
T a[50:51],v3,33792
M v[48:51],a[132:135],a[172:175],v[48:51]
buffer_load_dwordx4 v8, s[16:19], s21 offen offset:0   lds
M v[48:51],a[128:131],a[168:171],v[48:51]
M v[44:47],a[120:123],a[168:171],v[44:47]
M v[44:47],a[124:127],a[172:175],v[44:47]
buffer_load_dwordx4 v9, s[16:19], s21 offen offset:1024   lds
M v[40:43],a[116:119],a[172:175],v[40:43]
s_nop 0
T a[52:53],v3,40960
T a[54:55],v3,41984
M v[40:43],a[112:115],a[168:171],v[40:43]
M v[36:39],a[104:107],a[168:171],v[36:39]
M v[36:39],a[108:111],a[172:175],v[36:39]
s_waitcnt lgkmcnt(6)
M v[32:35],a[100:103],a[172:175],v[32:35]
buffer_load_dwordx4 v10, s[16:19], s21 offen offset:2048   lds
M v[32:35],a[96:99],a[168:171],v[32:35]
s_nop 0
T a[56:57],v4,32768
L_w_kv02:
s_cbranch_execz L_w_kv06
T a[58:59],v4,33792
M v[64:67],a[96:99],a[160:163],v[64:67]
R a[168:171],v5,6144
R a[172:175],v6,6144
M v[64:67],a[100:103],a[164:167],v[64:67]
M v[68:71],a[108:111],a[164:167],v[68:71]
buffer_load_dwordx4 v11, s[16:19], s21 offen offset:3072   lds
M v[68:71],a[104:107],a[160:163],v[68:71]
SA s21,s21,524160
M v[72:75],a[112:115],a[160:163],v[72:75]
s_nop 0
T a[60:61],v4,40960
T a[62:63],v4,41984
M v[72:75],a[116:119],a[164:167],v[72:75]
M v[76:79],a[124:127],a[164:167],v[76:79]
SA m0,s87,1024
M v[76:79],a[120:123],a[160:163],v[76:79]
buffer_load_dwordx4 v25, s[60:63], s89 offen offset:0  lds
M v[80:83],a[128:131],a[160:163],v[80:83]
SA s89,s89,114688
M v[80:83],a[132:135],a[164:167],v[80:83]
M v[84:87],a[140:143],a[164:167],v[84:87]
M v[84:87],a[136:139],a[160:163],v[84:87]
M v[88:91],a[144:147],a[160:163],v[88:91]
M v[88:91],a[148:151],a[164:167],v[88:91]
s_waitcnt lgkmcnt(2)
M v[92:95],a[156:159],a[164:167],v[92:95]
s_waitcnt vmcnt(19) lgkmcnt(0)
M v[92:95],a[152:155],a[160:163],v[92:95]
s_barrier
M v[124:127],a[152:155],a[168:171],v[124:127]
R a[160:163],v5,16384
R a[164:167],v6,16384
M v[124:127],a[156:159],a[172:175],v[124:127]
M v[120:123],a[148:151],a[172:175],v[120:123]
SA m0,s24,0
T a[64:65],v1,49152
T a[66:67],v1,50176
M v[120:123],a[144:147],a[168:171],v[120:123]
buffer_load_dwordx4 v12, s[48:51], s22 offen offset:0   lds
M v[116:119],a[136:139],a[168:171],v[116:119]
M v[116:119],a[140:143],a[172:175],v[116:119]
M v[112:115],a[132:135],a[172:175],v[112:115]
M v[112:115],a[128:131],a[168:171],v[112:115]
M v[108:111],a[120:123],a[168:171],v[108:111]
M v[108:111],a[124:127],a[172:175],v[108:111]
s_nop 0
T a[68:69],v1,57344
T a[70:71],v1,58368
M v[104:107],a[116:119],a[172:175],v[104:107]
buffer_load_dwordx4 v13, s[48:51], s22 offen offset:1024   lds
M v[104:107],a[112:115],a[168:171],v[104:107]
M v[100:103],a[104:107],a[168:171],v[100:103]
M v[100:103],a[108:111],a[172:175],v[100:103]
s_waitcnt lgkmcnt(4)
M v[96:99],a[100:103],a[172:175],v[96:99]
M v[96:99],a[96:99],a[168:171],v[96:99]
M v[128:131],a[96:99],a[160:163],v[128:131]
R a[168:171],v5,18432
R a[172:175],v6,18432
M v[128:131],a[100:103],a[164:167],v[128:131]
T a[72:73],v2,49152
T a[74:75],v2,50176
M v[132:135],a[108:111],a[164:167],v[132:135]
buffer_load_dwordx4 v14, s[48:51], s22 offen offset:2048   lds
M v[132:135],a[104:107],a[160:163],v[132:135]
M v[136:139],a[112:115],a[160:163],v[136:139]
M v[136:139],a[116:119],a[164:167],v[136:139]
M v[140:143],a[124:127],a[164:167],v[140:143]
M v[140:143],a[120:123],a[160:163],v[140:143]
s_nop 0
T a[76:77],v2,57344
T a[78:79],v2,58368
M v[144:147],a[128:131],a[160:163],v[144:147]
buffer_load_dwordx4 v15, s[48:51], s22 offen offset:3072   lds
M v[144:147],a[132:135],a[164:167],v[144:147]
SA s22,s22,1048576
M v[148:151],a[140:143],a[164:167],v[148:151]
M v[148:151],a[136:139],a[160:163],v[148:151]
M v[152:155],a[144:147],a[160:163],v[152:155]
M v[152:155],a[148:151],a[164:167],v[152:155]
s_waitcnt lgkmcnt(4)
M v[156:159],a[156:159],a[164:167],v[156:159]
SA m0,s23,32768
T a[80:81],v3,49152
T a[82:83],v3,50176
M v[156:159],a[152:155],a[160:163],v[156:159]
buffer_load_dwordx4 v8, s[16:19], s21 offen offset:0   lds
M v[188:191],a[152:155],a[168:171],v[188:191]
R a[160:163],v5,20480
R a[164:167],v6,20480
M v[188:191],a[156:159],a[172:175],v[188:191]
M v[184:187],a[148:151],a[172:175],v[184:187]
M v[184:187],a[144:147],a[168:171],v[184:187]
M v[180:183],a[136:139],a[168:171],v[180:183]
M v[180:183],a[140:143],a[172:175],v[180:183]
s_nop 0
T a[84:85],v3,57344
T a[86:87],v3,58368
M v[176:179],a[132:135],a[172:175],v[176:179]
buffer_load_dwordx4 v9, s[16:19], s21 offen offset:1024   lds
M v[176:179],a[128:131],a[168:171],v[176:179]
M v[172:175],a[120:123],a[168:171],v[172:175]
M v[172:175],a[124:127],a[172:175],v[172:175]
M v[168:171],a[116:119],a[172:175],v[168:171]
M v[168:171],a[112:115],a[168:171],v[168:171]
M v[164:167],a[104:107],a[168:171],v[164:167]
s_nop 0
T a[88:89],v4,49152
T a[90:91],v4,50176
M v[164:167],a[108:111],a[172:175],v[164:167]
s_waitcnt lgkmcnt(4)
buffer_load_dwordx4 v10, s[16:19], s21 offen offset:2048   lds
M v[160:163],a[100:103],a[172:175],v[160:163]
M v[160:163],a[96:99],a[168:171],v[160:163]
M v[192:195],a[96:99],a[160:163],v[192:195]
R a[168:171],v5,22528
R a[172:175],v6,22528
M v[192:195],a[100:103],a[164:167],v[192:195]
M v[196:199],a[108:111],a[164:167],v[196:199]
M v[196:199],a[104:107],a[160:163],v[196:199]
s_nop 0
T a[92:93],v4,57344
T a[94:95],v4,58368
M v[200:203],a[112:115],a[160:163],v[200:203]
buffer_load_dwordx4 v11, s[16:19], s21 offen offset:3072   lds
M v[200:203],a[116:119],a[164:167],v[200:203]
SA s21,s21,128
M v[204:207],a[124:127],a[164:167],v[204:207]
M v[204:207],a[120:123],a[160:163],v[204:207]
M v[208:211],a[128:131],a[160:163],v[208:211]
M v[208:211],a[132:135],a[164:167],v[208:211]
M v[212:215],a[140:143],a[164:167],v[212:215]
M v[212:215],a[136:139],a[160:163],v[212:215]
M v[216:219],a[144:147],a[160:163],v[216:219]
M v[216:219],a[148:151],a[164:167],v[216:219]
s_waitcnt lgkmcnt(2)
M v[220:223],a[156:159],a[164:167],v[220:223]
s_waitcnt vmcnt(17) lgkmcnt(0)
M v[220:223],a[152:155],a[160:163],v[220:223]
s_barrier
M v[252:255],a[152:155],a[168:171],v[252:255]
R a[160:163],v5,32768
R a[164:167],v6,32768
M v[252:255],a[156:159],a[172:175],v[252:255]
v_cmp_ne_u32 vcc, 1, v17
M v[248:251],a[148:151],a[172:175],v[248:251]
s_nop 0
M v[248:251],a[144:147],a[168:171],v[248:251]
s_cbranch_vccnz L_zs0
L_zr0:
M v[244:247],a[136:139],a[168:171],v[244:247]
M v[244:247],a[140:143],a[172:175],v[244:247]
M v[240:243],a[132:135],a[172:175],v[240:243]
M v[240:243],a[128:131],a[168:171],v[240:243]
M v[236:239],a[120:123],a[168:171],v[236:239]
M v[236:239],a[124:127],a[172:175],v[236:239]
M v[232:235],a[116:119],a[172:175],v[232:235]
M v[232:235],a[112:115],a[168:171],v[232:235]
M v[228:231],a[104:107],a[168:171],v[228:231]
M v[228:231],a[108:111],a[172:175],v[228:231]
s_waitcnt lgkmcnt(0)
M v[224:227],a[100:103],a[172:175],v[224:227]
M v[224:227],a[96:99],a[168:171],v[224:227]
M a[0:3],a[32:35],a[160:163],a[0:3]
R a[168:171],v5,34816
R a[172:175],v6,34816
M a[0:3],a[36:39],a[164:167],a[0:3]
T a[96:97],v1,0
T a[98:99],v1,1024
M a[4:7],a[44:47],a[164:167],a[4:7]
SA m0,s24,16384
M a[4:7],a[40:43],a[160:163],a[4:7]
buffer_load_dwordx4 v12, s[48:51], s22 offen offset:0   lds
M a[8:11],a[48:51],a[160:163],a[8:11]
M a[8:11],a[52:55],a[164:167],a[8:11]
s_mul_i32 s64, s41, 229376
M a[12:15],a[60:63],a[164:167],a[12:15]
SA s72,s90,s64
T a[100:101],v1,8192
T a[102:103],v1,9216
M a[12:15],a[56:59],a[160:163],a[12:15]
s_addc_u32 s73, s91, 0
buffer_load_dwordx4 v13, s[48:51], s22 offen offset:1024   lds
M a[16:19],a[64:67],a[160:163],a[16:19]
s_sub_u32 s75, 3670016, s64
M a[16:19],a[68:71],a[164:167],a[16:19]
s_mov_b32 s12, s72
M a[20:23],a[76:79],a[164:167],a[20:23]
s_and_b32 s13, s73, 0xffff
M a[20:23],a[72:75],a[160:163],a[20:23]
s_mov_b32 s14, s75
T a[104:105],v2,0
T a[106:107],v2,1024
M a[24:27],a[80:83],a[160:163],a[24:27]
s_mov_b32 s15, 0x20000
buffer_load_dwordx4 v14, s[48:51], s22 offen offset:2048   lds
M a[24:27],a[84:87],a[164:167],a[24:27]
s_waitcnt lgkmcnt(6)
M a[28:31],a[92:95],a[164:167],a[28:31]
M a[28:31],a[88:91],a[160:163],a[28:31]
M v[60:63],a[88:91],a[168:171],v[60:63]
R a[160:163],v5,36864
R a[164:167],v6,36864
M v[60:63],a[92:95],a[172:175],v[60:63]
T a[108:109],v2,8192
T a[110:111],v2,9216
M v[56:59],a[84:87],a[172:175],v[56:59]
buffer_load_dwordx4 v15, s[48:51], s22 offen offset:3072   lds
M v[56:59],a[80:83],a[168:171],v[56:59]
s_sub_u32 s22, s22, 1048448
M v[52:55],a[72:75],a[168:171],v[52:55]
SA m0,s23,49152
M v[52:55],a[76:79],a[172:175],v[52:55]
s_nop 0
T a[112:113],v3,0
T a[114:115],v3,1024
M v[48:51],a[68:71],a[172:175],v[48:51]
buffer_load_dwordx4 v8, s[16:19], s21 offen offset:0   lds
M v[48:51],a[64:67],a[168:171],v[48:51]
M v[44:47],a[56:59],a[168:171],v[44:47]
M v[44:47],a[60:63],a[172:175],v[44:47]
buffer_load_dwordx4 v9, s[16:19], s21 offen offset:1024   lds
M v[40:43],a[52:55],a[172:175],v[40:43]
s_nop 0
T a[116:117],v3,8192
T a[118:119],v3,9216
M v[40:43],a[48:51],a[168:171],v[40:43]
M v[36:39],a[40:43],a[168:171],v[36:39]
M v[36:39],a[44:47],a[172:175],v[36:39]
s_waitcnt lgkmcnt(6)
M v[32:35],a[36:39],a[172:175],v[32:35]
buffer_load_dwordx4 v10, s[16:19], s21 offen offset:2048   lds
M v[32:35],a[32:35],a[168:171],v[32:35]
s_nop 0
T a[120:121],v4,0
T a[122:123],v4,1024
M v[64:67],a[32:35],a[160:163],v[64:67]
R a[168:171],v5,38912
R a[172:175],v6,38912
M v[64:67],a[36:39],a[164:167],v[64:67]
M v[68:71],a[44:47],a[164:167],v[68:71]
buffer_load_dwordx4 v11, s[16:19], s21 offen offset:3072   lds
M v[68:71],a[40:43],a[160:163],v[68:71]
SA s21,s21,524160
M v[72:75],a[48:51],a[160:163],v[72:75]
s_nop 0
T a[124:125],v4,8192
T a[126:127],v4,9216
M v[72:75],a[52:55],a[164:167],v[72:75]
M v[76:79],a[60:63],a[164:167],v[76:79]
SA m0,s87,2048
M v[76:79],a[56:59],a[160:163],v[76:79]
buffer_load_dwordx4 v25, s[60:63], s89 offen offset:0  lds
M v[80:83],a[64:67],a[160:163],v[80:83]
SA s89,s89,114688
M v[80:83],a[68:71],a[164:167],v[80:83]
M v[84:87],a[76:79],a[164:167],v[84:87]
M v[84:87],a[72:75],a[160:163],v[84:87]
M v[88:91],a[80:83],a[160:163],v[88:91]
M v[88:91],a[84:87],a[164:167],v[88:91]
s_waitcnt lgkmcnt(2)
M v[92:95],a[92:95],a[164:167],v[92:95]
s_waitcnt vmcnt(18) lgkmcnt(0)
M v[92:95],a[88:91],a[160:163],v[92:95]
s_barrier
M v[124:127],a[88:91],a[168:171],v[124:127]
R a[160:163],v5,49152
R a[164:167],v6,49152
M v[124:127],a[92:95],a[172:175],v[124:127]
M v[120:123],a[84:87],a[172:175],v[120:123]
SA m0,s24,32768
T a[128:129],v1,16384
T a[130:131],v1,17408
M v[120:123],a[80:83],a[168:171],v[120:123]
buffer_load_dwordx4 v12, s[48:51], s22 offen offset:0   lds
M v[116:119],a[72:75],a[168:171],v[116:119]
M v[116:119],a[76:79],a[172:175],v[116:119]
M v[112:115],a[68:71],a[172:175],v[112:115]
M v[112:115],a[64:67],a[168:171],v[112:115]
M v[108:111],a[56:59],a[168:171],v[108:111]
M v[108:111],a[60:63],a[172:175],v[108:111]
s_nop 0
T a[132:133],v1,24576
T a[134:135],v1,25600
M v[104:107],a[52:55],a[172:175],v[104:107]
buffer_load_dwordx4 v13, s[48:51], s22 offen offset:1024   lds
M v[104:107],a[48:51],a[168:171],v[104:107]
M v[100:103],a[40:43],a[168:171],v[100:103]
M v[100:103],a[44:47],a[172:175],v[100:103]
s_waitcnt lgkmcnt(4)
M v[96:99],a[36:39],a[172:175],v[96:99]
M v[96:99],a[32:35],a[168:171],v[96:99]
M v[128:131],a[32:35],a[160:163],v[128:131]
R a[168:171],v5,51200
R a[172:175],v6,51200
M v[128:131],a[36:39],a[164:167],v[128:131]
T a[136:137],v2,16384
T a[138:139],v2,17408
M v[132:135],a[44:47],a[164:167],v[132:135]
buffer_load_dwordx4 v14, s[48:51], s22 offen offset:2048   lds
M v[132:135],a[40:43],a[160:163],v[132:135]
M v[136:139],a[48:51],a[160:163],v[136:139]
M v[136:139],a[52:55],a[164:167],v[136:139]
M v[140:143],a[60:63],a[164:167],v[140:143]
M v[140:143],a[56:59],a[160:163],v[140:143]
s_nop 0
T a[140:141],v2,24576
T a[142:143],v2,25600
M v[144:147],a[64:67],a[160:163],v[144:147]
buffer_load_dwordx4 v15, s[48:51], s22 offen offset:3072   lds
M v[144:147],a[68:71],a[164:167],v[144:147]
SA s22,s22,1048576
M v[148:151],a[76:79],a[164:167],v[148:151]
M v[148:151],a[72:75],a[160:163],v[148:151]
M v[152:155],a[80:83],a[160:163],v[152:155]
M v[152:155],a[84:87],a[164:167],v[152:155]
s_waitcnt lgkmcnt(4)
M v[156:159],a[92:95],a[164:167],v[156:159]
SA m0,s23,0
T a[144:145],v3,16384
T a[146:147],v3,17408
M v[156:159],a[88:91],a[160:163],v[156:159]
buffer_load_dwordx4 v8, s[16:19], s21 offen offset:0   lds
M v[188:191],a[88:91],a[168:171],v[188:191]
R a[160:163],v5,53248
R a[164:167],v6,53248
M v[188:191],a[92:95],a[172:175],v[188:191]
M v[184:187],a[84:87],a[172:175],v[184:187]
M v[184:187],a[80:83],a[168:171],v[184:187]
M v[180:183],a[72:75],a[168:171],v[180:183]
M v[180:183],a[76:79],a[172:175],v[180:183]
s_nop 0
T a[148:149],v3,24576
T a[150:151],v3,25600
M v[176:179],a[68:71],a[172:175],v[176:179]
buffer_load_dwordx4 v9, s[16:19], s21 offen offset:1024   lds
M v[176:179],a[64:67],a[168:171],v[176:179]
M v[172:175],a[56:59],a[168:171],v[172:175]
M v[172:175],a[60:63],a[172:175],v[172:175]
M v[168:171],a[52:55],a[172:175],v[168:171]
M v[168:171],a[48:51],a[168:171],v[168:171]
M v[164:167],a[40:43],a[168:171],v[164:167]
s_nop 0
T a[152:153],v4,16384
T a[154:155],v4,17408
M v[164:167],a[44:47],a[172:175],v[164:167]
s_waitcnt lgkmcnt(4)
buffer_load_dwordx4 v10, s[16:19], s21 offen offset:2048   lds
M v[160:163],a[36:39],a[172:175],v[160:163]
M v[160:163],a[32:35],a[168:171],v[160:163]
M v[192:195],a[32:35],a[160:163],v[192:195]
R a[168:171],v5,55296
R a[172:175],v6,55296
M v[192:195],a[36:39],a[164:167],v[192:195]
M v[196:199],a[44:47],a[164:167],v[196:199]
M v[196:199],a[40:43],a[160:163],v[196:199]
s_nop 0
T a[156:157],v4,24576
T a[158:159],v4,25600
M v[200:203],a[48:51],a[160:163],v[200:203]
buffer_load_dwordx4 v11, s[16:19], s21 offen offset:3072   lds
M v[200:203],a[52:55],a[164:167],v[200:203]
SA s21,s21,128
M v[204:207],a[60:63],a[164:167],v[204:207]
M v[204:207],a[56:59],a[160:163],v[204:207]
M v[208:211],a[64:67],a[160:163],v[208:211]
M v[208:211],a[68:71],a[164:167],v[208:211]
M v[212:215],a[76:79],a[164:167],v[212:215]
M v[212:215],a[72:75],a[160:163],v[212:215]
M v[216:219],a[80:83],a[160:163],v[216:219]
M v[216:219],a[84:87],a[164:167],v[216:219]
s_waitcnt lgkmcnt(2)
M v[220:223],a[92:95],a[164:167],v[220:223]
s_waitcnt vmcnt(17) lgkmcnt(0)
M v[220:223],a[88:91],a[160:163],v[220:223]
s_barrier
M v[252:255],a[88:91],a[168:171],v[252:255]
R a[160:163],v5,0
R a[164:167],v6,0
M v[252:255],a[92:95],a[172:175],v[252:255]
M v[248:251],a[84:87],a[172:175],v[248:251]
M v[248:251],a[80:83],a[168:171],v[248:251]
M v[244:247],a[72:75],a[168:171],v[244:247]
M v[244:247],a[76:79],a[172:175],v[244:247]
M v[240:243],a[68:71],a[172:175],v[240:243]
M v[240:243],a[64:67],a[168:171],v[240:243]
M v[236:239],a[56:59],a[168:171],v[236:239]
M v[236:239],a[60:63],a[172:175],v[236:239]
M v[232:235],a[52:55],a[172:175],v[232:235]
M v[232:235],a[48:51],a[168:171],v[232:235]
M v[228:231],a[40:43],a[168:171],v[228:231]
M v[228:231],a[44:47],a[172:175],v[228:231]
s_waitcnt lgkmcnt(0)
M v[224:227],a[36:39],a[172:175],v[224:227]
M v[224:227],a[32:35],a[168:171],v[224:227]
M a[0:3],a[96:99],a[160:163],a[0:3]
R a[168:171],v5,2048
R a[172:175],v6,2048
M a[0:3],a[100:103],a[164:167],a[0:3]
T a[32:33],v1,32768
T a[34:35],v1,33792
M a[4:7],a[108:111],a[164:167],a[4:7]
SA m0,s24,49152
M a[4:7],a[104:107],a[160:163],a[4:7]
buffer_load_dwordx4 v12, s[48:51], s22 offen offset:0   lds
M a[8:11],a[112:115],a[160:163],a[8:11]
M a[8:11],a[116:119],a[164:167],a[8:11]
M a[12:15],a[124:127],a[164:167],a[12:15]
s_nop 0
T a[36:37],v1,40960
T a[38:39],v1,41984
M a[12:15],a[120:123],a[160:163],a[12:15]
buffer_load_dwordx4 v13, s[48:51], s22 offen offset:1024   lds
M a[16:19],a[128:131],a[160:163],a[16:19]
M a[16:19],a[132:135],a[164:167],a[16:19]
M a[20:23],a[140:143],a[164:167],a[20:23]
M a[20:23],a[136:139],a[160:163],a[20:23]
s_nop 0
T a[40:41],v2,32768
T a[42:43],v2,33792
M a[24:27],a[144:147],a[160:163],a[24:27]
buffer_load_dwordx4 v14, s[48:51], s22 offen offset:2048   lds
M a[24:27],a[148:151],a[164:167],a[24:27]
s_waitcnt lgkmcnt(6)
M a[28:31],a[156:159],a[164:167],a[28:31]
M a[28:31],a[152:155],a[160:163],a[28:31]
M v[60:63],a[152:155],a[168:171],v[60:63]
R a[160:163],v5,4096
R a[164:167],v6,4096
M v[60:63],a[156:159],a[172:175],v[60:63]
T a[44:45],v2,40960
T a[46:47],v2,41984
M v[56:59],a[148:151],a[172:175],v[56:59]
buffer_load_dwordx4 v15, s[48:51], s22 offen offset:3072   lds
M v[56:59],a[144:147],a[168:171],v[56:59]
s_sub_u32 s22, s22, 1048448
M v[52:55],a[136:139],a[168:171],v[52:55]
SA m0,s23,16384
M v[52:55],a[140:143],a[172:175],v[52:55]
s_nop 0
T a[48:49],v3,32768
T a[50:51],v3,33792
M v[48:51],a[132:135],a[172:175],v[48:51]
buffer_load_dwordx4 v8, s[16:19], s21 offen offset:0   lds
M v[48:51],a[128:131],a[168:171],v[48:51]
M v[44:47],a[120:123],a[168:171],v[44:47]
M v[44:47],a[124:127],a[172:175],v[44:47]
buffer_load_dwordx4 v9, s[16:19], s21 offen offset:1024   lds
M v[40:43],a[116:119],a[172:175],v[40:43]
s_nop 0
T a[52:53],v3,40960
T a[54:55],v3,41984
M v[40:43],a[112:115],a[168:171],v[40:43]
M v[36:39],a[104:107],a[168:171],v[36:39]
M v[36:39],a[108:111],a[172:175],v[36:39]
s_waitcnt lgkmcnt(6)
M v[32:35],a[100:103],a[172:175],v[32:35]
buffer_load_dwordx4 v10, s[16:19], s21 offen offset:2048   lds
M v[32:35],a[96:99],a[168:171],v[32:35]
s_nop 0
T a[56:57],v4,32768
T a[58:59],v4,33792
M v[64:67],a[96:99],a[160:163],v[64:67]
R a[168:171],v5,6144
R a[172:175],v6,6144
M v[64:67],a[100:103],a[164:167],v[64:67]
M v[68:71],a[108:111],a[164:167],v[68:71]
buffer_load_dwordx4 v11, s[16:19], s21 offen offset:3072   lds
M v[68:71],a[104:107],a[160:163],v[68:71]
SA s21,s21,524160
M v[72:75],a[112:115],a[160:163],v[72:75]
s_nop 0
T a[60:61],v4,40960
T a[62:63],v4,41984
M v[72:75],a[116:119],a[164:167],v[72:75]
M v[76:79],a[124:127],a[164:167],v[76:79]
SA m0,s87,3072
M v[76:79],a[120:123],a[160:163],v[76:79]
buffer_load_dwordx4 v25, s[60:63], s89 offen offset:0  lds
M v[80:83],a[128:131],a[160:163],v[80:83]
SA s89,s89,114688
M v[80:83],a[132:135],a[164:167],v[80:83]
M v[84:87],a[140:143],a[164:167],v[84:87]
M v[84:87],a[136:139],a[160:163],v[84:87]
M v[88:91],a[144:147],a[160:163],v[88:91]
M v[88:91],a[148:151],a[164:167],v[88:91]
s_waitcnt lgkmcnt(2)
M v[92:95],a[156:159],a[164:167],v[92:95]
s_waitcnt vmcnt(18) lgkmcnt(0)
M v[92:95],a[152:155],a[160:163],v[92:95]
s_barrier
M v[124:127],a[152:155],a[168:171],v[124:127]
R a[160:163],v5,16384
R a[164:167],v6,16384
M v[124:127],a[156:159],a[172:175],v[124:127]
M v[120:123],a[148:151],a[172:175],v[120:123]
SA m0,s24,0
T a[64:65],v1,49152
T a[66:67],v1,50176
M v[120:123],a[144:147],a[168:171],v[120:123]
buffer_load_dwordx4 v12, s[48:51], s22 offen offset:0   lds
M v[116:119],a[136:139],a[168:171],v[116:119]
M v[116:119],a[140:143],a[172:175],v[116:119]
M v[112:115],a[132:135],a[172:175],v[112:115]
M v[112:115],a[128:131],a[168:171],v[112:115]
M v[108:111],a[120:123],a[168:171],v[108:111]
M v[108:111],a[124:127],a[172:175],v[108:111]
s_nop 0
T a[68:69],v1,57344
T a[70:71],v1,58368
M v[104:107],a[116:119],a[172:175],v[104:107]
buffer_load_dwordx4 v13, s[48:51], s22 offen offset:1024   lds
M v[104:107],a[112:115],a[168:171],v[104:107]
M v[100:103],a[104:107],a[168:171],v[100:103]
M v[100:103],a[108:111],a[172:175],v[100:103]
s_waitcnt lgkmcnt(4)
M v[96:99],a[100:103],a[172:175],v[96:99]
M v[96:99],a[96:99],a[168:171],v[96:99]
M v[128:131],a[96:99],a[160:163],v[128:131]
R a[168:171],v5,18432
R a[172:175],v6,18432
M v[128:131],a[100:103],a[164:167],v[128:131]
s_lshl_b32 s67, s20, 11
T a[72:73],v2,49152
T a[74:75],v2,50176
M v[132:135],a[108:111],a[164:167],v[132:135]
SA s67,s67,104914944
buffer_load_dwordx4 v14, s[48:51], s22 offen offset:2048   lds
M v[132:135],a[104:107],a[160:163],v[132:135]
M v[136:139],a[112:115],a[160:163],v[136:139]
M v[136:139],a[116:119],a[164:167],v[136:139]
buffer_load_dwordx4 v[16:19], v7, s[8:11], s67 offen offset:0 sc1
M v[140:143],a[124:127],a[164:167],v[140:143]
M v[140:143],a[120:123],a[160:163],v[140:143]
s_nop 0
T a[76:77],v2,57344
T a[78:79],v2,58368
M v[144:147],a[128:131],a[160:163],v[144:147]
buffer_load_dwordx4 v15, s[48:51], s22 offen offset:3072   lds
M v[144:147],a[132:135],a[164:167],v[144:147]
SA s22,s22,1048576
M v[148:151],a[140:143],a[164:167],v[148:151]
buffer_load_dwordx4 v[20:23], v7, s[8:11], s67 offen offset:1024 sc1
L_w_kv03:
s_cbranch_execz L_w_kv07
M v[148:151],a[136:139],a[160:163],v[148:151]
M v[152:155],a[144:147],a[160:163],v[152:155]
M v[152:155],a[148:151],a[164:167],v[152:155]
s_waitcnt lgkmcnt(4)
M v[156:159],a[156:159],a[164:167],v[156:159]
SA m0,s23,32768
T a[80:81],v3,49152
T a[82:83],v3,50176
M v[156:159],a[152:155],a[160:163],v[156:159]
buffer_load_dwordx4 v8, s[16:19], s21 offen offset:0   lds
M v[188:191],a[152:155],a[168:171],v[188:191]
R a[160:163],v5,20480
R a[164:167],v6,20480
M v[188:191],a[156:159],a[172:175],v[188:191]
M v[184:187],a[148:151],a[172:175],v[184:187]
M v[184:187],a[144:147],a[168:171],v[184:187]
M v[180:183],a[136:139],a[168:171],v[180:183]
M v[180:183],a[140:143],a[172:175],v[180:183]
s_nop 0
T a[84:85],v3,57344
T a[86:87],v3,58368
M v[176:179],a[132:135],a[172:175],v[176:179]
buffer_load_dwordx4 v9, s[16:19], s21 offen offset:1024   lds
M v[176:179],a[128:131],a[168:171],v[176:179]
M v[172:175],a[120:123],a[168:171],v[172:175]
M v[172:175],a[124:127],a[172:175],v[172:175]
M v[168:171],a[116:119],a[172:175],v[168:171]
M v[168:171],a[112:115],a[168:171],v[168:171]
M v[164:167],a[104:107],a[168:171],v[164:167]
s_nop 0
T a[88:89],v4,49152
T a[90:91],v4,50176
M v[164:167],a[108:111],a[172:175],v[164:167]
s_waitcnt lgkmcnt(4)
buffer_load_dwordx4 v10, s[16:19], s21 offen offset:2048   lds
M v[160:163],a[100:103],a[172:175],v[160:163]
M v[160:163],a[96:99],a[168:171],v[160:163]
M v[192:195],a[96:99],a[160:163],v[192:195]
R a[168:171],v5,22528
R a[172:175],v6,22528
M v[192:195],a[100:103],a[164:167],v[192:195]
M v[196:199],a[108:111],a[164:167],v[196:199]
M v[196:199],a[104:107],a[160:163],v[196:199]
s_nop 0
T a[92:93],v4,57344
T a[94:95],v4,58368
M v[200:203],a[112:115],a[160:163],v[200:203]
buffer_load_dwordx4 v11, s[16:19], s21 offen offset:3072   lds
M v[200:203],a[116:119],a[164:167],v[200:203]
SA s21,s21,128
M v[204:207],a[124:127],a[164:167],v[204:207]
M v[204:207],a[120:123],a[160:163],v[204:207]
M v[208:211],a[128:131],a[160:163],v[208:211]
M v[208:211],a[132:135],a[164:167],v[208:211]
M v[212:215],a[140:143],a[164:167],v[212:215]
M v[212:215],a[136:139],a[160:163],v[212:215]
M v[216:219],a[144:147],a[160:163],v[216:219]
M v[216:219],a[148:151],a[164:167],v[216:219]
s_waitcnt lgkmcnt(2)
M v[220:223],a[156:159],a[164:167],v[220:223]
s_waitcnt vmcnt(19) lgkmcnt(0)
M v[220:223],a[152:155],a[160:163],v[220:223]
s_barrier
M v[252:255],a[152:155],a[168:171],v[252:255]
R a[160:163],v5,32768
R a[164:167],v6,32768
M v[252:255],a[156:159],a[172:175],v[252:255]
M v[248:251],a[148:151],a[172:175],v[248:251]
M v[248:251],a[144:147],a[168:171],v[248:251]
M v[244:247],a[136:139],a[168:171],v[244:247]
M v[244:247],a[140:143],a[172:175],v[244:247]
M v[240:243],a[132:135],a[172:175],v[240:243]
M v[240:243],a[128:131],a[168:171],v[240:243]
M v[236:239],a[120:123],a[168:171],v[236:239]
M v[236:239],a[124:127],a[172:175],v[236:239]
M v[232:235],a[116:119],a[172:175],v[232:235]
M v[232:235],a[112:115],a[168:171],v[232:235]
M v[228:231],a[104:107],a[168:171],v[228:231]
M v[228:231],a[108:111],a[172:175],v[228:231]
s_waitcnt lgkmcnt(0)
M v[224:227],a[100:103],a[172:175],v[224:227]
M v[224:227],a[96:99],a[168:171],v[224:227]
M a[0:3],a[32:35],a[160:163],a[0:3]
R a[168:171],v5,34816
R a[172:175],v6,34816
M a[0:3],a[36:39],a[164:167],a[0:3]
T a[96:97],v1,0
T a[98:99],v1,1024
M a[4:7],a[44:47],a[164:167],a[4:7]
SA m0,s24,16384
M a[4:7],a[40:43],a[160:163],a[4:7]
buffer_load_dwordx4 v12, s[48:51], s22 offen offset:0   lds
M a[8:11],a[48:51],a[160:163],a[8:11]
M a[8:11],a[52:55],a[164:167],a[8:11]
M a[12:15],a[60:63],a[164:167],a[12:15]
s_nop 0
T a[100:101],v1,8192
T a[102:103],v1,9216
M a[12:15],a[56:59],a[160:163],a[12:15]
buffer_load_dwordx4 v13, s[48:51], s22 offen offset:1024   lds
M a[16:19],a[64:67],a[160:163],a[16:19]
M a[16:19],a[68:71],a[164:167],a[16:19]
M a[20:23],a[76:79],a[164:167],a[20:23]
s_waitcnt vmcnt(8)
v_min3_u32 v28, v16, v17, v18
M a[20:23],a[72:75],a[160:163],a[20:23]
s_nop 0
T a[104:105],v2,0
T a[106:107],v2,1024
M a[24:27],a[80:83],a[160:163],a[24:27]
buffer_load_dwordx4 v14, s[48:51], s22 offen offset:2048   lds
M a[24:27],a[84:87],a[164:167],a[24:27]
s_waitcnt lgkmcnt(6)
s_waitcnt vmcnt(7)
v_min3_u32 v28, v28, v19, v20
M a[28:31],a[92:95],a[164:167],a[28:31]
v_min3_u32 v28, v28, v21, v22
M a[28:31],a[88:91],a[160:163],a[28:31]
v_min_u32 v28, v28, v23
M v[60:63],a[88:91],a[168:171],v[60:63]
R a[160:163],v5,36864
R a[164:167],v6,36864
M v[60:63],a[92:95],a[172:175],v[60:63]
T a[108:109],v2,8192
T a[110:111],v2,9216
M v[56:59],a[84:87],a[172:175],v[56:59]
buffer_load_dwordx4 v15, s[48:51], s22 offen offset:3072   lds
M v[56:59],a[80:83],a[168:171],v[56:59]
s_sub_u32 s22, s22, 1048448
v_cmp_eq_u32 vcc, 0, v28
M v[52:55],a[72:75],a[168:171],v[52:55]
SA m0,s23,49152
s_nop 0
M v[52:55],a[76:79],a[172:175],v[52:55]
s_cbranch_vccnz L_hs
L_hr:
T a[112:113],v3,0
T a[114:115],v3,1024
M v[48:51],a[68:71],a[172:175],v[48:51]
buffer_load_dwordx4 v8, s[16:19], s21 offen offset:0   lds
M v[48:51],a[64:67],a[168:171],v[48:51]
v_max_u32 v28, v16, v17
M v[44:47],a[56:59],a[168:171],v[44:47]
v_min_u32 v29, v16, v17
M v[44:47],a[60:63],a[172:175],v[44:47]
buffer_load_dwordx4 v9, s[16:19], s21 offen offset:1024   lds
M v[40:43],a[52:55],a[172:175],v[40:43]
s_nop 0
T a[116:117],v3,8192
T a[118:119],v3,9216
M v[40:43],a[48:51],a[168:171],v[40:43]
v_med3_u32 v29, v28, v29, v18
M v[36:39],a[40:43],a[168:171],v[36:39]
v_max_u32 v28, v28, v18
M v[36:39],a[44:47],a[172:175],v[36:39]
s_waitcnt lgkmcnt(6)
v_med3_u32 v29, v28, v29, v19
M v[32:35],a[36:39],a[172:175],v[32:35]
buffer_load_dwordx4 v10, s[16:19], s21 offen offset:2048   lds
M v[32:35],a[32:35],a[168:171],v[32:35]
s_nop 0
T a[120:121],v4,0
T a[122:123],v4,1024
M v[64:67],a[32:35],a[160:163],v[64:67]
R a[168:171],v5,38912
R a[172:175],v6,38912
M v[64:67],a[36:39],a[164:167],v[64:67]
v_max_u32 v28, v28, v19
M v[68:71],a[44:47],a[164:167],v[68:71]
buffer_load_dwordx4 v11, s[16:19], s21 offen offset:3072   lds
M v[68:71],a[40:43],a[160:163],v[68:71]
SA s21,s21,524160
v_med3_u32 v29, v28, v29, v20
M v[72:75],a[48:51],a[160:163],v[72:75]
s_nop 0
T a[124:125],v4,8192
T a[126:127],v4,9216
M v[72:75],a[52:55],a[164:167],v[72:75]
v_max_u32 v28, v28, v20
M v[76:79],a[60:63],a[164:167],v[76:79]
SA m0,s87,4096
v_med3_u32 v29, v28, v29, v21
M v[76:79],a[56:59],a[160:163],v[76:79]
buffer_load_dwordx4 v25, s[60:63], s89 offen offset:0  lds
M v[80:83],a[64:67],a[160:163],v[80:83]
SA s89,s89,114688
v_max_u32 v28, v28, v21
M v[80:83],a[68:71],a[164:167],v[80:83]
v_med3_u32 v29, v28, v29, v22
M v[84:87],a[76:79],a[164:167],v[84:87]
v_max_u32 v28, v28, v22
M v[84:87],a[72:75],a[160:163],v[84:87]
v_med3_u32 v29, v28, v29, v23
M v[88:91],a[80:83],a[160:163],v[88:91]
v_max_u32 v28, v28, v23
M v[88:91],a[84:87],a[164:167],v[88:91]
s_waitcnt lgkmcnt(2)
v_mov_b32 v30, v28 row_ror:8 row_mask:0xf bank_mask:0xf
M v[92:95],a[92:95],a[164:167],v[92:95]
s_waitcnt lgkmcnt(0)
v_mov_b32 v31, v29 row_ror:8 row_mask:0xf bank_mask:0xf
M v[92:95],a[88:91],a[160:163],v[92:95]
s_barrier
M v[124:127],a[88:91],a[168:171],v[124:127]
R a[160:163],v5,49152
R a[164:167],v6,49152
M v[124:127],a[92:95],a[172:175],v[124:127]
v_min_u32 v16, v28, v30
M v[120:123],a[84:87],a[172:175],v[120:123]
SA m0,s24,32768
T a[128:129],v1,16384
T a[130:131],v1,17408
M v[120:123],a[80:83],a[168:171],v[120:123]
buffer_load_dwordx4 v12, s[48:51], s22 offen offset:0   lds
M v[116:119],a[72:75],a[168:171],v[116:119]
v_max_u32 v28, v28, v30
M v[116:119],a[76:79],a[172:175],v[116:119]
v_max3_u32 v29, v29, v31, v16
M v[112:115],a[68:71],a[172:175],v[112:115]
v_mov_b32 v30, v28 row_ror:4 row_mask:0xf bank_mask:0xf
M v[112:115],a[64:67],a[168:171],v[112:115]
v_mov_b32 v31, v29 row_ror:4 row_mask:0xf bank_mask:0xf
M v[108:111],a[56:59],a[168:171],v[108:111]
v_min_u32 v16, v28, v30
M v[108:111],a[60:63],a[172:175],v[108:111]
s_nop 0
T a[132:133],v1,24576
T a[134:135],v1,25600
M v[104:107],a[52:55],a[172:175],v[104:107]
buffer_load_dwordx4 v13, s[48:51], s22 offen offset:1024   lds
M v[104:107],a[48:51],a[168:171],v[104:107]
v_max_u32 v28, v28, v30
M v[100:103],a[40:43],a[168:171],v[100:103]
v_max3_u32 v29, v29, v31, v16
M v[100:103],a[44:47],a[172:175],v[100:103]
s_waitcnt lgkmcnt(4)
v_mov_b32 v30, v28 row_ror:2 row_mask:0xf bank_mask:0xf
M v[96:99],a[36:39],a[172:175],v[96:99]
v_mov_b32 v31, v29 row_ror:2 row_mask:0xf bank_mask:0xf
M v[96:99],a[32:35],a[168:171],v[96:99]
v_min_u32 v16, v28, v30
M v[128:131],a[32:35],a[160:163],v[128:131]
R a[168:171],v5,51200
R a[172:175],v6,51200
M v[128:131],a[36:39],a[164:167],v[128:131]
T a[136:137],v2,16384
T a[138:139],v2,17408
M v[132:135],a[44:47],a[164:167],v[132:135]
buffer_load_dwordx4 v14, s[48:51], s22 offen offset:2048   lds
M v[132:135],a[40:43],a[160:163],v[132:135]
v_max_u32 v28, v28, v30
M v[136:139],a[48:51],a[160:163],v[136:139]
v_max3_u32 v29, v29, v31, v16
M v[136:139],a[52:55],a[164:167],v[136:139]
v_mov_b32 v30, v28 row_ror:1 row_mask:0xf bank_mask:0xf
M v[140:143],a[60:63],a[164:167],v[140:143]
v_mov_b32 v31, v29 row_ror:1 row_mask:0xf bank_mask:0xf
M v[140:143],a[56:59],a[160:163],v[140:143]
s_nop 0
T a[140:141],v2,24576
T a[142:143],v2,25600
M v[144:147],a[64:67],a[160:163],v[144:147]
buffer_load_dwordx4 v15, s[48:51], s22 offen offset:3072   lds
M v[144:147],a[68:71],a[164:167],v[144:147]
SA s22,s22,1048576
v_min_u32 v16, v28, v30
M v[148:151],a[76:79],a[164:167],v[148:151]
v_max_u32 v28, v28, v30
M v[148:151],a[72:75],a[160:163],v[148:151]
v_max3_u32 v29, v29, v31, v16
M v[152:155],a[80:83],a[160:163],v[152:155]
v_mov_b32 v30, v28
M v[152:155],a[84:87],a[164:167],v[152:155]
s_waitcnt lgkmcnt(4)
v_mov_b32 v31, v29
M v[156:159],a[92:95],a[164:167],v[156:159]
SA m0,s23,0
T a[144:145],v3,16384
T a[146:147],v3,17408
M v[156:159],a[88:91],a[160:163],v[156:159]
buffer_load_dwordx4 v8, s[16:19], s21 offen offset:0   lds
M v[188:191],a[88:91],a[168:171],v[188:191]
R a[160:163],v5,53248
R a[164:167],v6,53248
M v[188:191],a[92:95],a[172:175],v[188:191]
v_permlane16_swap_b32 v30, v28
M v[184:187],a[84:87],a[172:175],v[184:187]
v_permlane16_swap_b32 v31, v29
M v[184:187],a[80:83],a[168:171],v[184:187]
v_min_u32 v16, v28, v30
M v[180:183],a[72:75],a[168:171],v[180:183]
v_max_u32 v28, v28, v30
M v[180:183],a[76:79],a[172:175],v[180:183]
s_nop 0
T a[148:149],v3,24576
T a[150:151],v3,25600
M v[176:179],a[68:71],a[172:175],v[176:179]
buffer_load_dwordx4 v9, s[16:19], s21 offen offset:1024   lds
M v[176:179],a[64:67],a[168:171],v[176:179]
v_max3_u32 v29, v29, v31, v16
M v[172:175],a[56:59],a[168:171],v[172:175]
v_mov_b32 v30, v28
M v[172:175],a[60:63],a[172:175],v[172:175]
v_mov_b32 v31, v29
M v[168:171],a[52:55],a[172:175],v[168:171]
v_permlane32_swap_b32 v30, v28
M v[168:171],a[48:51],a[168:171],v[168:171]
v_permlane32_swap_b32 v31, v29
M v[164:167],a[40:43],a[168:171],v[164:167]
s_nop 0
T a[152:153],v4,16384
T a[154:155],v4,17408
M v[164:167],a[44:47],a[172:175],v[164:167]
s_waitcnt lgkmcnt(4)
buffer_load_dwordx4 v10, s[16:19], s21 offen offset:2048   lds
M v[160:163],a[36:39],a[172:175],v[160:163]
v_min_u32 v16, v28, v30
M v[160:163],a[32:35],a[168:171],v[160:163]
v_max_u32 v28, v28, v30
M v[192:195],a[32:35],a[160:163],v[192:195]
R a[168:171],v5,55296
R a[172:175],v6,55296
M v[192:195],a[36:39],a[164:167],v[192:195]
v_max3_u32 v29, v29, v31, v16
M v[196:199],a[44:47],a[164:167],v[196:199]
s_lshl_b32 s64, s20, 3
M v[196:199],a[40:43],a[160:163],v[196:199]
SA s64,s64,159744
T a[156:157],v4,24576
T a[158:159],v4,25600
M v[200:203],a[48:51],a[160:163],v[200:203]
buffer_load_dwordx4 v11, s[16:19], s21 offen offset:3072   lds
M v[200:203],a[52:55],a[164:167],v[200:203]
SA s21,s21,128
v_mov_b32 v16, s64
M v[204:207],a[60:63],a[164:167],v[204:207]
ds_write_b64 v16, v[28:29]
M v[204:207],a[56:59],a[160:163],v[204:207]
M v[208:211],a[64:67],a[160:163],v[208:211]
M v[208:211],a[68:71],a[164:167],v[208:211]
M v[212:215],a[76:79],a[164:167],v[212:215]
M v[212:215],a[72:75],a[160:163],v[212:215]
M v[216:219],a[80:83],a[160:163],v[216:219]
M v[216:219],a[84:87],a[164:167],v[216:219]
s_waitcnt lgkmcnt(3)
M v[220:223],a[92:95],a[164:167],v[220:223]
s_waitcnt vmcnt(17) lgkmcnt(0)
M v[220:223],a[88:91],a[160:163],v[220:223]
s_barrier
M v[252:255],a[88:91],a[168:171],v[252:255]
R a[160:163],v5,0
R a[164:167],v6,0
M v[252:255],a[92:95],a[172:175],v[252:255]
M v[248:251],a[84:87],a[172:175],v[248:251]
M v[248:251],a[80:83],a[168:171],v[248:251]
M v[244:247],a[72:75],a[168:171],v[244:247]
M v[244:247],a[76:79],a[172:175],v[244:247]
M v[240:243],a[68:71],a[172:175],v[240:243]
M v[240:243],a[64:67],a[168:171],v[240:243]
M v[236:239],a[56:59],a[168:171],v[236:239]
M v[236:239],a[60:63],a[172:175],v[236:239]
M v[232:235],a[52:55],a[172:175],v[232:235]
M v[232:235],a[48:51],a[168:171],v[232:235]
M v[228:231],a[40:43],a[168:171],v[228:231]
M v[228:231],a[44:47],a[172:175],v[228:231]
s_waitcnt lgkmcnt(0)
M v[224:227],a[36:39],a[172:175],v[224:227]
M v[224:227],a[32:35],a[168:171],v[224:227]
M a[0:3],a[96:99],a[160:163],a[0:3]
R a[168:171],v5,2048
R a[172:175],v6,2048
M a[0:3],a[100:103],a[164:167],a[0:3]
T a[32:33],v1,32768
T a[34:35],v1,33792
M a[4:7],a[108:111],a[164:167],a[4:7]
SA m0,s24,49152
M a[4:7],a[104:107],a[160:163],a[4:7]
buffer_load_dwordx4 v12, s[48:51], s22 offen offset:0   lds
M a[8:11],a[112:115],a[160:163],a[8:11]
v_mov_b32 v28, 159744
M a[8:11],a[116:119],a[164:167],a[8:11]
ds_read_b128 v[16:19], v28
M a[12:15],a[124:127],a[164:167],a[12:15]
s_nop 0
T a[36:37],v1,40960
T a[38:39],v1,41984
M a[12:15],a[120:123],a[160:163],a[12:15]
buffer_load_dwordx4 v13, s[48:51], s22 offen offset:1024   lds
M a[16:19],a[128:131],a[160:163],a[16:19]
R v[20:23],v28,16
M a[16:19],a[132:135],a[164:167],a[16:19]
M a[20:23],a[140:143],a[164:167],a[20:23]
M a[20:23],a[136:139],a[160:163],a[20:23]
s_nop 0
T a[40:41],v2,32768
T a[42:43],v2,33792
M a[24:27],a[144:147],a[160:163],a[24:27]
buffer_load_dwordx4 v14, s[48:51], s22 offen offset:2048   lds
M a[24:27],a[148:151],a[164:167],a[24:27]
s_waitcnt lgkmcnt(8)
M a[28:31],a[156:159],a[164:167],a[28:31]
M a[28:31],a[152:155],a[160:163],a[28:31]
M v[60:63],a[152:155],a[168:171],v[60:63]
R a[160:163],v5,4096
R a[164:167],v6,4096
M v[60:63],a[156:159],a[172:175],v[60:63]
T a[44:45],v2,40960
T a[46:47],v2,41984
M v[56:59],a[148:151],a[172:175],v[56:59]
buffer_load_dwordx4 v15, s[48:51], s22 offen offset:3072   lds
M v[56:59],a[144:147],a[168:171],v[56:59]
s_sub_u32 s22, s22, 1048448
s_waitcnt lgkmcnt(9)
v_min_u32 v28, v16, v18
M v[52:55],a[136:139],a[168:171],v[52:55]
SA m0,s23,16384
v_max_u32 v16, v16, v18
M v[52:55],a[140:143],a[172:175],v[52:55]
s_nop 0
T a[48:49],v3,32768
T a[50:51],v3,33792
M v[48:51],a[132:135],a[172:175],v[48:51]
buffer_load_dwordx4 v8, s[16:19], s21 offen offset:0   lds
M v[48:51],a[128:131],a[168:171],v[48:51]
v_max3_u32 v17, v17, v19, v28
M v[44:47],a[120:123],a[168:171],v[44:47]
s_waitcnt lgkmcnt(8)
v_min_u32 v29, v20, v22
M v[44:47],a[124:127],a[172:175],v[44:47]
buffer_load_dwordx4 v9, s[16:19], s21 offen offset:1024   lds
M v[40:43],a[116:119],a[172:175],v[40:43]
s_nop 0
T a[52:53],v3,40960
T a[54:55],v3,41984
M v[40:43],a[112:115],a[168:171],v[40:43]
v_max_u32 v20, v20, v22
M v[36:39],a[104:107],a[168:171],v[36:39]
v_max3_u32 v21, v21, v23, v29
M v[36:39],a[108:111],a[172:175],v[36:39]
s_waitcnt lgkmcnt(6)
v_min_u32 v28, v16, v20
M v[32:35],a[100:103],a[172:175],v[32:35]
buffer_load_dwordx4 v10, s[16:19], s21 offen offset:2048   lds
M v[32:35],a[96:99],a[168:171],v[32:35]
s_nop 0
T a[56:57],v4,32768
T a[58:59],v4,33792
M v[64:67],a[96:99],a[160:163],v[64:67]
R a[168:171],v5,6144
R a[172:175],v6,6144
M v[64:67],a[100:103],a[164:167],v[64:67]
v_max_u32 v16, v16, v20
M v[68:71],a[108:111],a[164:167],v[68:71]
buffer_load_dwordx4 v11, s[16:19], s21 offen offset:3072   lds
M v[68:71],a[104:107],a[160:163],v[68:71]
SA s21,s21,524160
v_max3_u32 v17, v17, v21, v28
M v[72:75],a[112:115],a[160:163],v[72:75]
s_nop 0
T a[60:61],v4,40960
T a[62:63],v4,41984
M v[72:75],a[116:119],a[164:167],v[72:75]
v_and_b32 v28, 1, v0
M v[76:79],a[124:127],a[164:167],v[76:79]
SA m0,s87,5120
v_cmp_eq_u32 vcc, 0, v28
M v[76:79],a[120:123],a[160:163],v[76:79]
s_and_b32 s64, s20, 1
buffer_load_dwordx4 v25, s[60:63], s89 offen offset:0  lds
M v[80:83],a[128:131],a[160:163],v[80:83]
SA s89,s89,114688
s_mul_i32 s64, s64, 448
v_cndmask_b32 v24, v17, v16, vcc
M v[80:83],a[132:135],a[164:167],v[80:83]
v_and_b32 v24, 0x7ff, v24
M v[84:87],a[140:143],a[164:167],v[84:87]
v_sub_u32 v24, 2047, v24
M v[84:87],a[136:139],a[160:163],v[84:87]
v_mul_u32_u24 v28, 896, v24
M v[88:91],a[144:147],a[160:163],v[88:91]
v_lshrrev_b32 v29, 4, v0
M v[88:91],a[148:151],a[164:167],v[88:91]
s_waitcnt lgkmcnt(2)
v_lshl_add_u32 v28, v29, 4, v28
M v[92:95],a[156:159],a[164:167],v[92:95]
s_waitcnt vmcnt(18) lgkmcnt(0)
v_bfe_u32 v30, v0, 1, 3
M v[92:95],a[152:155],a[160:163],v[92:95]
s_barrier
M v[124:127],a[152:155],a[168:171],v[124:127]
R a[160:163],v5,16384
R a[164:167],v6,16384
M v[124:127],a[156:159],a[172:175],v[124:127]
v_lshl_or_b32 v28, v30, 26, v28
M v[120:123],a[148:151],a[172:175],v[120:123]
SA m0,s24,0
T a[64:65],v1,49152
T a[66:67],v1,50176
M v[120:123],a[144:147],a[168:171],v[120:123]
buffer_load_dwordx4 v12, s[48:51], s22 offen offset:0   lds
M v[116:119],a[136:139],a[168:171],v[116:119]
M v[116:119],a[140:143],a[172:175],v[116:119]
M v[112:115],a[132:135],a[172:175],v[112:115]
buffer_load_dwordx4 a[208:211], v28, s[56:59], s64 offen offset:0
M v[112:115],a[128:131],a[168:171],v[112:115]
M v[108:111],a[120:123],a[168:171],v[108:111]
buffer_load_dwordx4 a[212:215], v28, s[56:59], s64 offen offset:64
M v[108:111],a[124:127],a[172:175],v[108:111]
s_nop 0
T a[68:69],v1,57344
T a[70:71],v1,58368
M v[104:107],a[116:119],a[172:175],v[104:107]
buffer_load_dwordx4 v13, s[48:51], s22 offen offset:1024   lds
M v[104:107],a[112:115],a[168:171],v[104:107]
M v[100:103],a[104:107],a[168:171],v[100:103]
buffer_load_dwordx4 a[216:219], v28, s[56:59], s64 offen offset:128
M v[100:103],a[108:111],a[172:175],v[100:103]
s_waitcnt lgkmcnt(4)
M v[96:99],a[100:103],a[172:175],v[96:99]
M v[96:99],a[96:99],a[168:171],v[96:99]
buffer_load_dwordx4 v14, s[48:51], s22 offen offset:2048   lds
M v[128:131],a[96:99],a[160:163],v[128:131]
R a[168:171],v5,18432
R a[172:175],v6,18432
M v[128:131],a[100:103],a[164:167],v[128:131]
T a[72:73],v2,49152
T a[74:75],v2,50176
M v[132:135],a[108:111],a[164:167],v[132:135]
buffer_load_dwordx4 a[220:223], v28, s[56:59], s64 offen offset:192
M v[132:135],a[104:107],a[160:163],v[132:135]
M v[136:139],a[112:115],a[160:163],v[136:139]
buffer_load_dwordx4 a[224:227], v28, s[56:59], s64 offen offset:256
M v[136:139],a[116:119],a[164:167],v[136:139]
M v[140:143],a[124:127],a[164:167],v[140:143]
buffer_load_dwordx4 v15, s[48:51], s22 offen offset:3072   lds
M v[140:143],a[120:123],a[160:163],v[140:143]
SA s22,s22,1048576
T a[76:77],v2,57344
T a[78:79],v2,58368
M v[144:147],a[128:131],a[160:163],v[144:147]
M v[144:147],a[132:135],a[164:167],v[144:147]
buffer_load_dwordx4 a[228:231], v28, s[56:59], s64 offen offset:320
M v[148:151],a[140:143],a[164:167],v[148:151]
M v[148:151],a[136:139],a[160:163],v[148:151]
SA m0,s23,32768
M v[152:155],a[144:147],a[160:163],v[152:155]
buffer_load_dwordx4 v8, s[16:19], s21 offen offset:0   lds
M v[152:155],a[148:151],a[164:167],v[152:155]
s_waitcnt lgkmcnt(4)
M v[156:159],a[156:159],a[164:167],v[156:159]
s_nop 0
T a[80:81],v3,49152
T a[82:83],v3,50176
M v[156:159],a[152:155],a[160:163],v[156:159]
buffer_load_dwordx4 a[232:235], v28, s[56:59], s64 offen offset:384
M v[188:191],a[152:155],a[168:171],v[188:191]
R a[160:163],v5,20480
R a[164:167],v6,20480
M v[188:191],a[156:159],a[172:175],v[188:191]
v_lshrrev_b32 v28, 4, v24
M v[184:187],a[148:151],a[172:175],v[184:187]
L_w_kv04:
s_cbranch_execz L_w_kv08
buffer_load_dwordx4 v9, s[16:19], s21 offen offset:1024   lds
M v[184:187],a[144:147],a[168:171],v[184:187]
v_lshlrev_b32 v28, 5, v28
M v[180:183],a[136:139],a[168:171],v[180:183]
v_and_b32 v30, 15, v24
M v[180:183],a[140:143],a[172:175],v[180:183]
s_nop 0
T a[84:85],v3,57344
T a[86:87],v3,58368
M v[176:179],a[132:135],a[172:175],v[176:179]
v_add_lshl_u32 v28, v28, v30, 2
M v[176:179],a[128:131],a[168:171],v[176:179]
v_lshrrev_b32 v30, 1, v0
M v[172:175],a[120:123],a[168:171],v[172:175]
v_min_u32 v30, 1, v30
M v[172:175],a[124:127],a[172:175],v[172:175]
buffer_load_dwordx4 v10, s[16:19], s21 offen offset:2048   lds
M v[168:171],a[116:119],a[172:175],v[168:171]
v_lshl_or_b32 v28, v30, 29, v28
M v[168:171],a[112:115],a[168:171],v[168:171]
s_or_b32 s64, s31, s20
M v[164:167],a[104:107],a[168:171],v[164:167]
s_min_u32 s64, s64, 1
T a[88:89],v4,49152
T a[90:91],v4,50176
M v[164:167],a[108:111],a[172:175],v[164:167]
s_waitcnt lgkmcnt(4)
s_lshl_b32 s64, s64, 29
M v[160:163],a[100:103],a[172:175],v[160:163]
SA s64,s64,104857600
buffer_load_dword v23, v28, s[8:11], s64 offen sc1
M v[160:163],a[96:99],a[168:171],v[160:163]
buffer_load_dwordx4 v11, s[16:19], s21 offen offset:3072   lds
M v[192:195],a[96:99],a[160:163],v[192:195]
SA s21,s21,128
R a[168:171],v5,22528
R a[172:175],v6,22528
M v[192:195],a[100:103],a[164:167],v[192:195]
v_bfe_u32 v28, v0, 2, 2
M v[196:199],a[108:111],a[164:167],v[196:199]
v_lshl_add_u32 v28, v29, 3, v28
M v[196:199],a[104:107],a[160:163],v[196:199]
s_nop 0
T a[92:93],v4,57344
T a[94:95],v4,58368
M v[200:203],a[112:115],a[160:163],v[200:203]
SA m0,s87,6144
v_lshlrev_b32 v28, 5, v28
M v[200:203],a[116:119],a[164:167],v[200:203]
buffer_load_dwordx4 v25, s[60:63], s89 offen offset:0  lds
M v[204:207],a[124:127],a[164:167],v[204:207]
SA s89,s89,114688
v_and_b32 v30, 3, v0
M v[204:207],a[120:123],a[160:163],v[204:207]
v_lshl_add_u32 v28, v30, 3, v28
M v[208:211],a[128:131],a[160:163],v[208:211]
v_add_u32 v22, s87, v28
M v[208:211],a[132:135],a[164:167],v[208:211]
M v[212:215],a[140:143],a[164:167],v[212:215]
M v[212:215],a[136:139],a[160:163],v[212:215]
M v[216:219],a[144:147],a[160:163],v[216:219]
M v[216:219],a[148:151],a[164:167],v[216:219]
s_waitcnt lgkmcnt(2)
M v[220:223],a[156:159],a[164:167],v[220:223]
s_waitcnt vmcnt(26) lgkmcnt(0)
M v[220:223],a[152:155],a[160:163],v[220:223]
s_barrier
M v[252:255],a[152:155],a[168:171],v[252:255]
R a[160:163],v5,32768
R a[164:167],v6,32768
M v[252:255],a[156:159],a[172:175],v[252:255]
M v[248:251],a[148:151],a[172:175],v[248:251]
M v[248:251],a[144:147],a[168:171],v[248:251]
M v[244:247],a[136:139],a[168:171],v[244:247]
M v[244:247],a[140:143],a[172:175],v[244:247]
M v[240:243],a[132:135],a[172:175],v[240:243]
M v[240:243],a[128:131],a[168:171],v[240:243]
M v[236:239],a[120:123],a[168:171],v[236:239]
M v[236:239],a[124:127],a[172:175],v[236:239]
M v[232:235],a[116:119],a[172:175],v[232:235]
M v[232:235],a[112:115],a[168:171],v[232:235]
M v[228:231],a[104:107],a[168:171],v[228:231]
M v[228:231],a[108:111],a[172:175],v[228:231]
s_waitcnt lgkmcnt(0)
M v[224:227],a[100:103],a[172:175],v[224:227]
M v[224:227],a[96:99],a[168:171],v[224:227]
M a[0:3],a[32:35],a[160:163],a[0:3]
R a[168:171],v5,34816
R a[172:175],v6,34816
M a[0:3],a[36:39],a[164:167],a[0:3]
T a[96:97],v1,0
T a[98:99],v1,1024
M a[4:7],a[44:47],a[164:167],a[4:7]
SA m0,s24,16384
M a[4:7],a[40:43],a[160:163],a[4:7]
buffer_load_dwordx4 v12, s[48:51], s22 offen offset:0   lds
M a[8:11],a[48:51],a[160:163],a[8:11]
M a[8:11],a[52:55],a[164:167],a[8:11]
M a[12:15],a[60:63],a[164:167],a[12:15]
s_nop 0
T a[100:101],v1,8192
T a[102:103],v1,9216
M a[12:15],a[56:59],a[160:163],a[12:15]
M a[16:19],a[64:67],a[160:163],a[16:19]
buffer_load_dwordx4 v13, s[48:51], s22 offen offset:1024   lds
M a[16:19],a[68:71],a[164:167],a[16:19]
M a[20:23],a[76:79],a[164:167],a[20:23]
M a[20:23],a[72:75],a[160:163],a[20:23]
s_nop 0
T a[104:105],v2,0
T a[106:107],v2,1024
M a[24:27],a[80:83],a[160:163],a[24:27]
M a[24:27],a[84:87],a[164:167],a[24:27]
s_waitcnt lgkmcnt(6)
buffer_load_dwordx4 v14, s[48:51], s22 offen offset:2048   lds
M a[28:31],a[92:95],a[164:167],a[28:31]
M a[28:31],a[88:91],a[160:163],a[28:31]
M v[60:63],a[88:91],a[168:171],v[60:63]
R a[160:163],v5,36864
R a[164:167],v6,36864
M v[60:63],a[92:95],a[172:175],v[60:63]
T a[108:109],v2,8192
T a[110:111],v2,9216
M v[56:59],a[84:87],a[172:175],v[56:59]
buffer_load_dwordx4 v15, s[48:51], s22 offen offset:3072   lds
M v[56:59],a[80:83],a[168:171],v[56:59]
s_sub_u32 s22, s22, 1048448
M v[52:55],a[72:75],a[168:171],v[52:55]
M v[52:55],a[76:79],a[172:175],v[52:55]
s_nop 0
T a[112:113],v3,0
T a[114:115],v3,1024
M v[48:51],a[68:71],a[172:175],v[48:51]
SA m0,s23,49152
M v[48:51],a[64:67],a[168:171],v[48:51]
buffer_load_dwordx4 v8, s[16:19], s21 offen offset:0   lds
M v[44:47],a[56:59],a[168:171],v[44:47]
M v[44:47],a[60:63],a[172:175],v[44:47]
M v[40:43],a[52:55],a[172:175],v[40:43]
s_nop 0
T a[116:117],v3,8192
T a[118:119],v3,9216
M v[40:43],a[48:51],a[168:171],v[40:43]
M v[36:39],a[40:43],a[168:171],v[36:39]
buffer_load_dwordx4 v9, s[16:19], s21 offen offset:1024   lds
M v[36:39],a[44:47],a[172:175],v[36:39]
s_waitcnt lgkmcnt(6)
M v[32:35],a[36:39],a[172:175],v[32:35]
M v[32:35],a[32:35],a[168:171],v[32:35]
s_nop 0
T a[120:121],v4,0
T a[122:123],v4,1024
M v[64:67],a[32:35],a[160:163],v[64:67]
R a[168:171],v5,38912
R a[172:175],v6,38912
M v[64:67],a[36:39],a[164:167],v[64:67]
buffer_load_dwordx4 v10, s[16:19], s21 offen offset:2048   lds
M v[68:71],a[44:47],a[164:167],v[68:71]
M v[68:71],a[40:43],a[160:163],v[68:71]
M v[72:75],a[48:51],a[160:163],v[72:75]
s_nop 0
T a[124:125],v4,8192
T a[126:127],v4,9216
M v[72:75],a[52:55],a[164:167],v[72:75]
M v[76:79],a[60:63],a[164:167],v[76:79]
buffer_load_dwordx4 v11, s[16:19], s21 offen offset:3072   lds
M v[76:79],a[56:59],a[160:163],v[76:79]
SA s21,s21,524160
M v[80:83],a[64:67],a[160:163],v[80:83]
M v[80:83],a[68:71],a[164:167],v[80:83]
M v[84:87],a[76:79],a[164:167],v[84:87]
M v[84:87],a[72:75],a[160:163],v[84:87]
M v[88:91],a[80:83],a[160:163],v[88:91]
M v[88:91],a[84:87],a[164:167],v[88:91]
s_waitcnt lgkmcnt(2)
M v[92:95],a[92:95],a[164:167],v[92:95]
s_waitcnt vmcnt(26) lgkmcnt(0)
M v[92:95],a[88:91],a[160:163],v[92:95]
s_barrier
M v[124:127],a[88:91],a[168:171],v[124:127]
R a[160:163],v5,49152
R a[164:167],v6,49152
M v[124:127],a[92:95],a[172:175],v[124:127]
M v[120:123],a[84:87],a[172:175],v[120:123]
SA m0,s24,32768
T a[128:129],v1,16384
T a[130:131],v1,17408
M v[120:123],a[80:83],a[168:171],v[120:123]
s_waitcnt vmcnt(8)
buffer_load_dwordx4 v12, s[48:51], s22 offen offset:0   lds
M v[116:119],a[72:75],a[168:171],v[116:119]
s_nop 0
T a[176:177],v22,0
T a[178:179],v22,128
M v[116:119],a[76:79],a[172:175],v[116:119]
T a[180:181],v22,1024
T a[182:183],v22,1152
M v[112:115],a[68:71],a[172:175],v[112:115]
T a[184:185],v22,2048
T a[186:187],v22,2176
M v[112:115],a[64:67],a[168:171],v[112:115]
T a[188:189],v22,3072
T a[190:191],v22,3200
M v[108:111],a[56:59],a[168:171],v[108:111]
M v[108:111],a[60:63],a[172:175],v[108:111]
s_nop 0
T a[132:133],v1,24576
T a[134:135],v1,25600
M v[104:107],a[52:55],a[172:175],v[104:107]
buffer_load_dwordx4 v13, s[48:51], s22 offen offset:1024   lds
M v[104:107],a[48:51],a[168:171],v[104:107]
M v[100:103],a[40:43],a[168:171],v[100:103]
M v[100:103],a[44:47],a[172:175],v[100:103]
s_waitcnt lgkmcnt(12)
M v[96:99],a[36:39],a[172:175],v[96:99]
M v[96:99],a[32:35],a[168:171],v[96:99]
M v[128:131],a[32:35],a[160:163],v[128:131]
R a[168:171],v5,51200
R a[172:175],v6,51200
M v[128:131],a[36:39],a[164:167],v[128:131]
T a[136:137],v2,16384
T a[138:139],v2,17408
M v[132:135],a[44:47],a[164:167],v[132:135]
buffer_load_dwordx4 v14, s[48:51], s22 offen offset:2048   lds
M v[132:135],a[40:43],a[160:163],v[132:135]
M v[136:139],a[48:51],a[160:163],v[136:139]
M v[136:139],a[52:55],a[164:167],v[136:139]
M v[140:143],a[60:63],a[164:167],v[140:143]
M v[140:143],a[56:59],a[160:163],v[140:143]
s_nop 0
T a[140:141],v2,24576
T a[142:143],v2,25600
M v[144:147],a[64:67],a[160:163],v[144:147]
buffer_load_dwordx4 v15, s[48:51], s22 offen offset:3072   lds
M v[144:147],a[68:71],a[164:167],v[144:147]
SA s22,s22,1048576
M v[148:151],a[76:79],a[164:167],v[148:151]
M v[148:151],a[72:75],a[160:163],v[148:151]
M v[152:155],a[80:83],a[160:163],v[152:155]
M v[152:155],a[84:87],a[164:167],v[152:155]
s_waitcnt lgkmcnt(4)
M v[156:159],a[92:95],a[164:167],v[156:159]
SA m0,s23,0
T a[144:145],v3,16384
T a[146:147],v3,17408
M v[156:159],a[88:91],a[160:163],v[156:159]
buffer_load_dwordx4 v8, s[16:19], s21 offen offset:0   lds
M v[16:19],a[176:179],a[208:211],0
M v[16:19],a[180:183],a[212:215],v[16:19]
M v[16:19],a[184:187],a[216:219],v[16:19]
M v[16:19],a[188:191],a[220:223],v[16:19]
M v[188:191],a[88:91],a[168:171],v[188:191]
R a[160:163],v5,53248
R a[164:167],v6,53248
M v[188:191],a[92:95],a[172:175],v[188:191]
T a[176:177],v22,4096
T a[178:179],v22,4224
M v[184:187],a[84:87],a[172:175],v[184:187]
T a[180:181],v22,5120
T a[182:183],v22,5248
M v[184:187],a[80:83],a[168:171],v[184:187]
T a[184:185],v22,6144
T a[186:187],v22,6272
M v[180:183],a[72:75],a[168:171],v[180:183]
M v[180:183],a[76:79],a[172:175],v[180:183]
s_nop 0
T a[148:149],v3,24576
T a[150:151],v3,25600
M v[176:179],a[68:71],a[172:175],v[176:179]
buffer_load_dwordx4 v9, s[16:19], s21 offen offset:1024   lds
M v[176:179],a[64:67],a[168:171],v[176:179]
M v[172:175],a[56:59],a[168:171],v[172:175]
M v[172:175],a[60:63],a[172:175],v[172:175]
M v[168:171],a[52:55],a[172:175],v[168:171]
M v[168:171],a[48:51],a[168:171],v[168:171]
M v[164:167],a[40:43],a[168:171],v[164:167]
s_nop 0
T a[152:153],v4,16384
T a[154:155],v4,17408
M v[164:167],a[44:47],a[172:175],v[164:167]
s_waitcnt lgkmcnt(10)
buffer_load_dwordx4 v10, s[16:19], s21 offen offset:2048   lds
M v[160:163],a[36:39],a[172:175],v[160:163]
M v[160:163],a[32:35],a[168:171],v[160:163]
M v[192:195],a[32:35],a[160:163],v[192:195]
R a[168:171],v5,55296
R a[172:175],v6,55296
M v[192:195],a[36:39],a[164:167],v[192:195]
M v[196:199],a[44:47],a[164:167],v[196:199]
M v[196:199],a[40:43],a[160:163],v[196:199]
s_nop 0
T a[156:157],v4,24576
T a[158:159],v4,25600
M v[200:203],a[48:51],a[160:163],v[200:203]
buffer_load_dwordx4 v11, s[16:19], s21 offen offset:3072   lds
M v[200:203],a[52:55],a[164:167],v[200:203]
SA s21,s21,128
M v[204:207],a[60:63],a[164:167],v[204:207]
M v[204:207],a[56:59],a[160:163],v[204:207]
M v[208:211],a[64:67],a[160:163],v[208:211]
M v[208:211],a[68:71],a[164:167],v[208:211]
M v[212:215],a[76:79],a[164:167],v[212:215]
M v[212:215],a[72:75],a[160:163],v[212:215]
M v[216:219],a[80:83],a[160:163],v[216:219]
M v[216:219],a[84:87],a[164:167],v[216:219]
s_waitcnt lgkmcnt(2)
M v[220:223],a[92:95],a[164:167],v[220:223]
s_waitcnt lgkmcnt(0)
M v[220:223],a[88:91],a[160:163],v[220:223]
s_barrier
M v[16:19],a[176:179],a[224:227],v[16:19]
M v[16:19],a[180:183],a[228:231],v[16:19]
M v[16:19],a[184:187],a[232:235],v[16:19]
M v[252:255],a[88:91],a[168:171],v[252:255]
R a[160:163],v5,0
R a[164:167],v6,0
M v[252:255],a[92:95],a[172:175],v[252:255]
M v[248:251],a[84:87],a[172:175],v[248:251]
M v[248:251],a[80:83],a[168:171],v[248:251]
M v[244:247],a[72:75],a[168:171],v[244:247]
M v[244:247],a[76:79],a[172:175],v[244:247]
M v[240:243],a[68:71],a[172:175],v[240:243]
M v[240:243],a[64:67],a[168:171],v[240:243]
M v[236:239],a[56:59],a[168:171],v[236:239]
M v[236:239],a[60:63],a[172:175],v[236:239]
M v[232:235],a[52:55],a[172:175],v[232:235]
M v[232:235],a[48:51],a[168:171],v[232:235]
M v[228:231],a[40:43],a[168:171],v[228:231]
M v[228:231],a[44:47],a[172:175],v[228:231]
s_waitcnt lgkmcnt(0)
M v[224:227],a[36:39],a[172:175],v[224:227]
M v[224:227],a[32:35],a[168:171],v[224:227]
M a[0:3],a[96:99],a[160:163],a[0:3]
R a[168:171],v5,2048
R a[172:175],v6,2048
M a[0:3],a[100:103],a[164:167],a[0:3]
T a[32:33],v1,32768
T a[34:35],v1,33792
M a[4:7],a[108:111],a[164:167],a[4:7]
SA m0,s24,49152
M a[4:7],a[104:107],a[160:163],a[4:7]
buffer_load_dwordx4 v12, s[48:51], s22 offen offset:0   lds
M a[8:11],a[112:115],a[160:163],a[8:11]
M a[8:11],a[116:119],a[164:167],a[8:11]
s_lshl_b32 s64, s20, 10
M a[12:15],a[124:127],a[164:167],a[12:15]
SA s64,s64,159744
T a[36:37],v1,40960
T a[38:39],v1,41984
M a[12:15],a[120:123],a[160:163],a[12:15]
v_add_u32 v21, s64, v7
ds_write_b128 v21, v[16:19]
M a[16:19],a[128:131],a[160:163],a[16:19]
s_mul_i32 s67, s86, 14336
buffer_load_dwordx4 v13, s[48:51], s22 offen offset:1024   lds
M a[16:19],a[132:135],a[164:167],a[16:19]
s_mul_i32 s64, s20, 224
M a[20:23],a[140:143],a[164:167],a[20:23]
SA s67,s67,s64
v_lshrrev_b32 v28, 4, v0
v_mul_u32_u24 v28, 896, v28
M a[20:23],a[136:139],a[160:163],a[20:23]
T a[40:41],v2,32768
T a[42:43],v2,33792
M a[24:27],a[144:147],a[160:163],a[24:27]
v_and_b32 v29, 15, v0
v_lshl_add_u32 v28, v29, 4, v28
M a[24:27],a[148:151],a[164:167],a[24:27]
s_waitcnt lgkmcnt(7)
buffer_load_dwordx4 v14, s[48:51], s22 offen offset:2048   lds
M a[28:31],a[156:159],a[164:167],a[28:31]
v_mov_b32 v30, 536870912
v_cmp_gt_u32 vcc, 14, v29
M a[28:31],a[152:155],a[160:163],a[28:31]
s_nop 0
M v[60:63],a[152:155],a[168:171],v[60:63]
s_nop 0
R a[160:163],v5,4096
R a[164:167],v6,4096
M v[60:63],a[156:159],a[172:175],v[60:63]
T a[44:45],v2,40960
T a[46:47],v2,41984
M v[56:59],a[148:151],a[172:175],v[56:59]
buffer_load_dwordx4 v15, s[48:51], s22 offen offset:3072   lds
M v[56:59],a[144:147],a[168:171],v[56:59]
s_sub_u32 s22, s22, 1048448
v_cndmask_b32 v28, v30, v28, vcc
v_add_u32 v29, 2560, v28
M v[52:55],a[136:139],a[168:171],v[52:55]
v_add_u32 v30, 5120, v28
v_add_u32 v31, 7680, v28
M v[52:55],a[140:143],a[172:175],v[52:55]
T a[48:49],v3,32768
T a[50:51],v3,33792
M v[48:51],a[132:135],a[172:175],v[48:51]
SA m0,s23,16384
M v[48:51],a[128:131],a[168:171],v[48:51]
buffer_load_dwordx4 v8, s[16:19], s21 offen offset:0   lds
M v[44:47],a[120:123],a[168:171],v[44:47]
M v[44:47],a[124:127],a[172:175],v[44:47]
M v[40:43],a[116:119],a[172:175],v[40:43]
s_nop 0
T a[52:53],v3,40960
T a[54:55],v3,41984
M v[40:43],a[112:115],a[168:171],v[40:43]
M v[36:39],a[104:107],a[168:171],v[36:39]
buffer_load_dwordx4 v9, s[16:19], s21 offen offset:1024   lds
M v[36:39],a[108:111],a[172:175],v[36:39]
s_waitcnt lgkmcnt(6)
M v[32:35],a[100:103],a[172:175],v[32:35]
M v[32:35],a[96:99],a[168:171],v[32:35]
s_nop 0
T a[56:57],v4,32768
T a[58:59],v4,33792
M v[64:67],a[96:99],a[160:163],v[64:67]
R a[168:171],v5,6144
R a[172:175],v6,6144
M v[64:67],a[100:103],a[164:167],v[64:67]
buffer_load_dwordx4 v10, s[16:19], s21 offen offset:2048   lds
M v[68:71],a[108:111],a[164:167],v[68:71]
M v[68:71],a[104:107],a[160:163],v[68:71]
M v[72:75],a[112:115],a[160:163],v[72:75]
s_nop 0
T a[60:61],v4,40960
T a[62:63],v4,41984
M v[72:75],a[116:119],a[164:167],v[72:75]
M v[76:79],a[124:127],a[164:167],v[76:79]
buffer_load_dwordx4 v11, s[16:19], s21 offen offset:3072   lds
M v[76:79],a[120:123],a[160:163],v[76:79]
SA s21,s21,524160
M v[80:83],a[128:131],a[160:163],v[80:83]
M v[80:83],a[132:135],a[164:167],v[80:83]
M v[84:87],a[140:143],a[164:167],v[84:87]
M v[84:87],a[136:139],a[160:163],v[84:87]
M v[88:91],a[144:147],a[160:163],v[88:91]
M v[88:91],a[148:151],a[164:167],v[88:91]
s_waitcnt lgkmcnt(2)
M v[92:95],a[156:159],a[164:167],v[92:95]
s_waitcnt vmcnt(16) lgkmcnt(0)
M v[92:95],a[152:155],a[160:163],v[92:95]
s_barrier
M v[124:127],a[152:155],a[168:171],v[124:127]
R a[160:163],v5,16384
R a[164:167],v6,16384
M v[124:127],a[156:159],a[172:175],v[124:127]
M v[120:123],a[148:151],a[172:175],v[120:123]
SA m0,s24,0
T a[64:65],v1,49152
T a[66:67],v1,50176
M v[120:123],a[144:147],a[168:171],v[120:123]
buffer_load_dwordx4 v12, s[48:51], s22 offen offset:0   lds
M v[116:119],a[136:139],a[168:171],v[116:119]
M v[116:119],a[140:143],a[172:175],v[116:119]
M v[112:115],a[132:135],a[172:175],v[112:115]
M v[112:115],a[128:131],a[168:171],v[112:115]
buffer_load_dwordx4 v13, s[48:51], s22 offen offset:1024   lds
M v[108:111],a[120:123],a[168:171],v[108:111]
M v[108:111],a[124:127],a[172:175],v[108:111]
s_nop 0
T a[68:69],v1,57344
T a[70:71],v1,58368
M v[104:107],a[116:119],a[172:175],v[104:107]
M v[104:107],a[112:115],a[168:171],v[104:107]
M v[100:103],a[104:107],a[168:171],v[100:103]
buffer_load_dwordx4 v14, s[48:51], s22 offen offset:2048   lds
M v[100:103],a[108:111],a[172:175],v[100:103]
s_waitcnt lgkmcnt(4)
M v[96:99],a[100:103],a[172:175],v[96:99]
M v[96:99],a[96:99],a[168:171],v[96:99]
M v[128:131],a[96:99],a[160:163],v[128:131]
R a[168:171],v5,18432
R a[172:175],v6,18432
M v[128:131],a[100:103],a[164:167],v[128:131]
T a[72:73],v2,49152
T a[74:75],v2,50176
M v[132:135],a[108:111],a[164:167],v[132:135]
buffer_load_dwordx4 v15, s[48:51], s22 offen offset:3072   lds
M v[132:135],a[104:107],a[160:163],v[132:135]
SA s22,s22,1048576
M v[136:139],a[112:115],a[160:163],v[136:139]
M v[136:139],a[116:119],a[164:167],v[136:139]
SA m0,s23,32768
M v[140:143],a[124:127],a[164:167],v[140:143]
buffer_load_dwordx4 v8, s[16:19], s21 offen offset:0   lds
M v[140:143],a[120:123],a[160:163],v[140:143]
s_nop 0
T a[76:77],v2,57344
T a[78:79],v2,58368
M v[144:147],a[128:131],a[160:163],v[144:147]
M v[144:147],a[132:135],a[164:167],v[144:147]
M v[148:151],a[140:143],a[164:167],v[148:151]
buffer_load_dwordx4 v9, s[16:19], s21 offen offset:1024   lds
M v[148:151],a[136:139],a[160:163],v[148:151]
M v[152:155],a[144:147],a[160:163],v[152:155]
M v[152:155],a[148:151],a[164:167],v[152:155]
s_waitcnt lgkmcnt(4)
M v[156:159],a[156:159],a[164:167],v[156:159]
s_nop 0
T a[80:81],v3,49152
T a[82:83],v3,50176
M v[156:159],a[152:155],a[160:163],v[156:159]
buffer_load_dwordx4 v10, s[16:19], s21 offen offset:2048   lds
M v[188:191],a[152:155],a[168:171],v[188:191]
R a[160:163],v5,20480
R a[164:167],v6,20480
M v[188:191],a[156:159],a[172:175],v[188:191]
M v[184:187],a[148:151],a[172:175],v[184:187]
M v[184:187],a[144:147],a[168:171],v[184:187]
M v[180:183],a[136:139],a[168:171],v[180:183]
buffer_load_dwordx4 v11, s[16:19], s21 offen offset:3072   lds
M v[180:183],a[140:143],a[172:175],v[180:183]
SA s21,s21,128
T a[84:85],v3,57344
T a[86:87],v3,58368
M v[176:179],a[132:135],a[172:175],v[176:179]
M v[176:179],a[128:131],a[168:171],v[176:179]
M v[172:175],a[120:123],a[168:171],v[172:175]
SA m0,s87,0
M v[172:175],a[124:127],a[172:175],v[172:175]
buffer_load_dwordx4 v28, s[68:71], s67 offen offset:0 nt lds
M v[168:171],a[116:119],a[172:175],v[168:171]
M v[168:171],a[112:115],a[168:171],v[168:171]
M v[164:167],a[104:107],a[168:171],v[164:167]
s_nop 0
T a[88:89],v4,49152
T a[90:91],v4,50176
M v[164:167],a[108:111],a[172:175],v[164:167]
s_waitcnt lgkmcnt(4)
buffer_load_dwordx4 v29, s[68:71], s67 offen offset:1024 nt lds
M v[160:163],a[100:103],a[172:175],v[160:163]
M v[160:163],a[96:99],a[168:171],v[160:163]
M v[192:195],a[96:99],a[160:163],v[192:195]
R a[168:171],v5,22528
R a[172:175],v6,22528
M v[192:195],a[100:103],a[164:167],v[192:195]
M v[196:199],a[108:111],a[164:167],v[196:199]
buffer_load_dwordx4 v30, s[68:71], s67 offen offset:2048 nt lds
M v[196:199],a[104:107],a[160:163],v[196:199]
s_nop 0
T a[92:93],v4,57344
T a[94:95],v4,58368
M v[200:203],a[112:115],a[160:163],v[200:203]
M v[200:203],a[116:119],a[164:167],v[200:203]
M v[204:207],a[124:127],a[164:167],v[204:207]
M v[204:207],a[120:123],a[160:163],v[204:207]
buffer_load_dwordx4 v31, s[68:71], s67 offen offset:3072 nt lds
L_w_kv05:
s_cbranch_execz L_w_kv09
M v[208:211],a[128:131],a[160:163],v[208:211]
SA s67,s67,0
M v[208:211],a[132:135],a[164:167],v[208:211]
M v[212:215],a[140:143],a[164:167],v[212:215]
M v[212:215],a[136:139],a[160:163],v[212:215]
M v[216:219],a[144:147],a[160:163],v[216:219]
M v[216:219],a[148:151],a[164:167],v[216:219]
s_waitcnt lgkmcnt(2)
M v[220:223],a[156:159],a[164:167],v[220:223]
s_waitcnt vmcnt(20) lgkmcnt(0)
M v[220:223],a[152:155],a[160:163],v[220:223]
s_barrier
M v[252:255],a[152:155],a[168:171],v[252:255]
R a[160:163],v5,32768
R a[164:167],v6,32768
M v[252:255],a[156:159],a[172:175],v[252:255]
M v[248:251],a[148:151],a[172:175],v[248:251]
M v[248:251],a[144:147],a[168:171],v[248:251]
M v[244:247],a[136:139],a[168:171],v[244:247]
M v[244:247],a[140:143],a[172:175],v[244:247]
M v[240:243],a[132:135],a[172:175],v[240:243]
M v[240:243],a[128:131],a[168:171],v[240:243]
M v[236:239],a[120:123],a[168:171],v[236:239]
M v[236:239],a[124:127],a[172:175],v[236:239]
M v[232:235],a[116:119],a[172:175],v[232:235]
M v[232:235],a[112:115],a[168:171],v[232:235]
M v[228:231],a[104:107],a[168:171],v[228:231]
M v[228:231],a[108:111],a[172:175],v[228:231]
s_waitcnt lgkmcnt(0)
M v[224:227],a[100:103],a[172:175],v[224:227]
M v[224:227],a[96:99],a[168:171],v[224:227]
M a[0:3],a[32:35],a[160:163],a[0:3]
R a[168:171],v5,34816
R a[172:175],v6,34816
M a[0:3],a[36:39],a[164:167],a[0:3]
T a[96:97],v1,0
T a[98:99],v1,1024
M a[4:7],a[44:47],a[164:167],a[4:7]
SA m0,s24,16384
C v23,v23,v23
M a[4:7],a[40:43],a[160:163],a[4:7]
buffer_load_dwordx4 v12, s[48:51], s22 offen offset:0   lds
M a[8:11],a[48:51],a[160:163],a[8:11]
v_and_b32 v23, 0xffff0000, v23
M a[8:11],a[52:55],a[164:167],a[8:11]
MF v22,0xbfb8aa3b,v23
M a[12:15],a[60:63],a[164:167],a[12:15]
s_nop 0
T a[100:101],v1,8192
T a[102:103],v1,9216
M a[12:15],a[56:59],a[160:163],a[12:15]
E v22,v22
M a[16:19],a[64:67],a[160:163],a[16:19]
buffer_load_dwordx4 v13, s[48:51], s22 offen offset:1024   lds
M a[16:19],a[68:71],a[164:167],a[16:19]
AF v22,1.0,v22
M a[20:23],a[76:79],a[164:167],a[20:23]
v_rcp_f32 v23, v22
M a[20:23],a[72:75],a[160:163],a[20:23]
s_or_b32 s64, s31, s20
T a[104:105],v2,0
T a[106:107],v2,1024
M a[24:27],a[80:83],a[160:163],a[24:27]
s_min_u32 s64, s64, 1
s_lshl_b32 s64, s64, 29
v_lshrrev_b32 v22, 1, v0
M a[24:27],a[84:87],a[164:167],a[24:27]
s_waitcnt lgkmcnt(6)
buffer_load_dwordx4 v14, s[48:51], s22 offen offset:2048   lds
M a[28:31],a[92:95],a[164:167],a[28:31]
v_min_u32 v22, 1, v22
M a[28:31],a[88:91],a[160:163],a[28:31]
v_lshlrev_b32 v22, 29, v22
M v[60:63],a[88:91],a[168:171],v[60:63]
R a[160:163],v5,36864
R a[164:167],v6,36864
M v[60:63],a[92:95],a[172:175],v[60:63]
T a[108:109],v2,8192
T a[110:111],v2,9216
M v[56:59],a[84:87],a[172:175],v[56:59]
buffer_load_dwordx4 v15, s[48:51], s22 offen offset:3072   lds
M v[56:59],a[80:83],a[168:171],v[56:59]
s_sub_u32 s22, s22, 1048448
v_lshl_or_b32 v22, v0, 2, v22
M v[52:55],a[72:75],a[168:171],v[52:55]
v_or_b32 v22, s64, v22
M v[52:55],a[76:79],a[172:175],v[52:55]
s_nop 0
T a[112:113],v3,0
T a[114:115],v3,1024
M v[48:51],a[68:71],a[172:175],v[48:51]
SA m0,s23,49152
C v23,v23,v23
M v[48:51],a[64:67],a[168:171],v[48:51]
buffer_load_dwordx4 v8, s[16:19], s21 offen offset:0   lds
M v[44:47],a[56:59],a[168:171],v[44:47]
v_and_b32 v23, 0xffff0000, v23
M v[44:47],a[60:63],a[172:175],v[44:47]
s_lshl_b32 s64, s41, 7
M v[40:43],a[52:55],a[172:175],v[40:43]
SA s64,s64,104890368
T a[116:117],v3,8192
T a[118:119],v3,9216
M v[40:43],a[48:51],a[168:171],v[40:43]
buffer_store_dword v24, v22, s[8:11], s64 offen sc1
M v[36:39],a[40:43],a[168:171],v[36:39]
buffer_load_dwordx4 v9, s[16:19], s21 offen offset:1024   lds
M v[36:39],a[44:47],a[172:175],v[36:39]
s_waitcnt lgkmcnt(6)
buffer_store_dword v23, v22, s[8:11], s64 offen offset:8 sc1
M v[32:35],a[36:39],a[172:175],v[32:35]
v_add_u32 v25, 159744, v7
M v[32:35],a[32:35],a[168:171],v[32:35]
s_nop 0
T a[120:121],v4,0
T a[122:123],v4,1024
M v[64:67],a[32:35],a[160:163],v[64:67]
R a[168:171],v5,38912
R a[172:175],v6,38912
M v[64:67],a[36:39],a[164:167],v[64:67]
buffer_load_dwordx4 v10, s[16:19], s21 offen offset:2048   lds
M v[68:71],a[44:47],a[164:167],v[68:71]
ds_read_b128 v[16:19], v25
M v[68:71],a[40:43],a[160:163],v[68:71]
R v[28:31],v25,1024
M v[72:75],a[48:51],a[160:163],v[72:75]
s_nop 0
T a[124:125],v4,8192
T a[126:127],v4,9216
M v[72:75],a[52:55],a[164:167],v[72:75]
R v[20:23],v25,2048
M v[76:79],a[60:63],a[164:167],v[76:79]
buffer_load_dwordx4 v11, s[16:19], s21 offen offset:3072   lds
M v[76:79],a[56:59],a[160:163],v[76:79]
SA s21,s21,524160
M v[80:83],a[64:67],a[160:163],v[80:83]
M v[80:83],a[68:71],a[164:167],v[80:83]
M v[84:87],a[76:79],a[164:167],v[84:87]
M v[84:87],a[72:75],a[160:163],v[84:87]
M v[88:91],a[80:83],a[160:163],v[88:91]
M v[88:91],a[84:87],a[164:167],v[88:91]
s_waitcnt lgkmcnt(5)
s_waitcnt lgkmcnt(3)
AF v16,v28,v16
M v[92:95],a[92:95],a[164:167],v[92:95]
s_waitcnt vmcnt(22) lgkmcnt(0)
AF v17,v29,v17
M v[92:95],a[88:91],a[160:163],v[92:95]
s_barrier
M v[124:127],a[88:91],a[168:171],v[124:127]
R a[160:163],v5,49152
R a[164:167],v6,49152
M v[124:127],a[92:95],a[172:175],v[124:127]
AF v18,v30,v18
M v[120:123],a[84:87],a[172:175],v[120:123]
SA m0,s24,32768
T a[128:129],v1,16384
T a[130:131],v1,17408
M v[120:123],a[80:83],a[168:171],v[120:123]
buffer_load_dwordx4 v12, s[48:51], s22 offen offset:0   lds
M v[116:119],a[72:75],a[168:171],v[116:119]
AF v19,v31,v19
M v[116:119],a[76:79],a[172:175],v[116:119]
R v[28:31],v25,3072
M v[112:115],a[68:71],a[172:175],v[112:115]
C v25,v16,v17
M v[112:115],a[64:67],a[168:171],v[112:115]
v_lshlrev_b32 v16, 16, v25
M v[108:111],a[56:59],a[168:171],v[108:111]
v_and_b32 v17, 0xffff0000, v25
M v[108:111],a[60:63],a[172:175],v[108:111]
s_nop 0
T a[132:133],v1,24576
T a[134:135],v1,25600
M v[104:107],a[52:55],a[172:175],v[104:107]
buffer_load_dwordx4 v13, s[48:51], s22 offen offset:1024   lds
M v[104:107],a[48:51],a[168:171],v[104:107]
C v25,v18,v19
M v[100:103],a[40:43],a[168:171],v[100:103]
v_lshlrev_b32 v18, 16, v25
M v[100:103],a[44:47],a[172:175],v[100:103]
s_waitcnt lgkmcnt(5)
v_and_b32 v19, 0xffff0000, v25
M v[96:99],a[36:39],a[172:175],v[96:99]
s_waitcnt lgkmcnt(2)
AF v20,v28,v20
M v[96:99],a[32:35],a[168:171],v[96:99]
AF v21,v29,v21
M v[128:131],a[32:35],a[160:163],v[128:131]
R a[168:171],v5,51200
R a[172:175],v6,51200
M v[128:131],a[36:39],a[164:167],v[128:131]
T a[136:137],v2,16384
T a[138:139],v2,17408
M v[132:135],a[44:47],a[164:167],v[132:135]
buffer_load_dwordx4 v14, s[48:51], s22 offen offset:2048   lds
M v[132:135],a[40:43],a[160:163],v[132:135]
AF v22,v30,v22
M v[136:139],a[48:51],a[160:163],v[136:139]
AF v23,v31,v23
M v[136:139],a[52:55],a[164:167],v[136:139]
MF v28,0xbfb8aa3b,v16
M v[140:143],a[60:63],a[164:167],v[140:143]
MF v29,0xbfb8aa3b,v17
M v[140:143],a[56:59],a[160:163],v[140:143]
s_nop 0
T a[140:141],v2,24576
T a[142:143],v2,25600
M v[144:147],a[64:67],a[160:163],v[144:147]
buffer_load_dwordx4 v15, s[48:51], s22 offen offset:3072   lds
M v[144:147],a[68:71],a[164:167],v[144:147]
SA s22,s22,1048576
MF v30,0xbfb8aa3b,v18
M v[148:151],a[76:79],a[164:167],v[148:151]
MF v31,0xbfb8aa3b,v19
M v[148:151],a[72:75],a[160:163],v[148:151]
E v28,v28
M v[152:155],a[80:83],a[160:163],v[152:155]
E v29,v29
M v[152:155],a[84:87],a[164:167],v[152:155]
s_waitcnt lgkmcnt(4)
E v30,v30
M v[156:159],a[92:95],a[164:167],v[156:159]
SA m0,s23,0
T a[144:145],v3,16384
T a[146:147],v3,17408
M v[156:159],a[88:91],a[160:163],v[156:159]
buffer_load_dwordx4 v8, s[16:19], s21 offen offset:0   lds
M v[188:191],a[88:91],a[168:171],v[188:191]
R a[160:163],v5,53248
R a[164:167],v6,53248
M v[188:191],a[92:95],a[172:175],v[188:191]
E v31,v31
M v[184:187],a[84:87],a[172:175],v[184:187]
C v25,v20,v21
M v[184:187],a[80:83],a[168:171],v[184:187]
v_lshlrev_b32 v20, 16, v25
M v[180:183],a[72:75],a[168:171],v[180:183]
v_and_b32 v21, 0xffff0000, v25
M v[180:183],a[76:79],a[172:175],v[180:183]
s_nop 0
T a[148:149],v3,24576
T a[150:151],v3,25600
M v[176:179],a[68:71],a[172:175],v[176:179]
buffer_load_dwordx4 v9, s[16:19], s21 offen offset:1024   lds
M v[176:179],a[64:67],a[168:171],v[176:179]
C v25,v22,v23
M v[172:175],a[56:59],a[168:171],v[172:175]
v_lshlrev_b32 v22, 16, v25
M v[172:175],a[60:63],a[172:175],v[172:175]
v_and_b32 v23, 0xffff0000, v25
M v[168:171],a[52:55],a[172:175],v[168:171]
AF v28,1.0,v28
M v[168:171],a[48:51],a[168:171],v[168:171]
AF v29,1.0,v29
M v[164:167],a[40:43],a[168:171],v[164:167]
s_nop 0
T a[152:153],v4,16384
T a[154:155],v4,17408
M v[164:167],a[44:47],a[172:175],v[164:167]
s_waitcnt lgkmcnt(4)
buffer_load_dwordx4 v10, s[16:19], s21 offen offset:2048   lds
M v[160:163],a[36:39],a[172:175],v[160:163]
AF v30,1.0,v30
M v[160:163],a[32:35],a[168:171],v[160:163]
AF v31,1.0,v31
M v[192:195],a[32:35],a[160:163],v[192:195]
R a[168:171],v5,55296
R a[172:175],v6,55296
M v[192:195],a[36:39],a[164:167],v[192:195]
v_rcp_f32 v28, v28
M v[196:199],a[44:47],a[164:167],v[196:199]
v_rcp_f32 v29, v29
M v[196:199],a[40:43],a[160:163],v[196:199]
T a[156:157],v4,24576
T a[158:159],v4,25600
M v[200:203],a[48:51],a[160:163],v[200:203]
buffer_load_dwordx4 v11, s[16:19], s21 offen offset:3072   lds
M v[200:203],a[52:55],a[164:167],v[200:203]
SA s21,s21,128
v_rcp_f32 v30, v30
M v[204:207],a[60:63],a[164:167],v[204:207]
v_rcp_f32 v31, v31
M v[204:207],a[56:59],a[160:163],v[204:207]
MF v16,v28,v16
M v[208:211],a[64:67],a[160:163],v[208:211]
MF v17,v29,v17
M v[208:211],a[68:71],a[164:167],v[208:211]
MF v18,v30,v18
M v[212:215],a[76:79],a[164:167],v[212:215]
MF v19,v31,v19
M v[212:215],a[72:75],a[160:163],v[212:215]
C v25,v16,v17
M v[216:219],a[80:83],a[160:163],v[216:219]
v_lshlrev_b32 v16, 16, v25
M v[216:219],a[84:87],a[164:167],v[216:219]
s_waitcnt lgkmcnt(2)
v_and_b32 v17, 0xffff0000, v25
M v[220:223],a[92:95],a[164:167],v[220:223]
s_waitcnt vmcnt(22) lgkmcnt(0)
C v25,v18,v19
M v[220:223],a[88:91],a[160:163],v[220:223]
s_barrier
M v[252:255],a[88:91],a[168:171],v[252:255]
R a[160:163],v5,0
R a[164:167],v6,0
M v[252:255],a[92:95],a[172:175],v[252:255]
v_lshlrev_b32 v18, 16, v25
M v[248:251],a[84:87],a[172:175],v[248:251]
v_and_b32 v19, 0xffff0000, v25
M v[248:251],a[80:83],a[168:171],v[248:251]
MF v16,v20,v16
M v[244:247],a[72:75],a[168:171],v[244:247]
MF v17,v21,v17
M v[244:247],a[76:79],a[172:175],v[244:247]
MF v18,v22,v18
M v[240:243],a[68:71],a[172:175],v[240:243]
MF v19,v23,v19
M v[240:243],a[64:67],a[168:171],v[240:243]
C v16,v16,v17
M v[236:239],a[56:59],a[168:171],v[236:239]
C v17,v18,v19
M v[236:239],a[60:63],a[172:175],v[236:239]
M v[232:235],a[52:55],a[172:175],v[232:235]
M v[232:235],a[48:51],a[168:171],v[232:235]
M v[228:231],a[40:43],a[168:171],v[228:231]
M v[228:231],a[44:47],a[172:175],v[228:231]
s_waitcnt lgkmcnt(0)
M v[224:227],a[36:39],a[172:175],v[224:227]
M v[224:227],a[32:35],a[168:171],v[224:227]
M a[0:3],a[96:99],a[160:163],a[0:3]
R a[168:171],v5,2048
R a[172:175],v6,2048
M a[0:3],a[100:103],a[164:167],a[0:3]
T a[32:33],v1,32768
T a[34:35],v1,33792
M a[4:7],a[108:111],a[164:167],a[4:7]
SA m0,s24,49152
v_lshrrev_b32 v28, 4, v0
v_and_b32 v29, 7, v0
M a[4:7],a[104:107],a[160:163],a[4:7]
buffer_load_dwordx4 v12, s[48:51], s22 offen offset:0   lds
M a[8:11],a[112:115],a[160:163],a[8:11]
v_xor_b32 v28, v28, v29
v_lshlrev_b32 v28, 4, v28
M a[8:11],a[116:119],a[164:167],a[8:11]
v_lshrrev_b32 v29, 3, v0
v_mul_u32_u24 v29, 896, v29
M a[12:15],a[124:127],a[164:167],a[12:15]
T a[36:37],v1,40960
T a[38:39],v1,41984
M a[12:15],a[120:123],a[160:163],a[12:15]
v_add_u32 v22, v28, v29
v_xor_b32 v28, 64, v28
M a[16:19],a[128:131],a[160:163],a[16:19]
s_mul_i32 s64, s20, 14336
buffer_load_dwordx4 v13, s[48:51], s22 offen offset:1024   lds
M a[16:19],a[132:135],a[164:167],a[16:19]
s_sub_u32 s65, 98304, s64
M a[20:23],a[140:143],a[164:167],a[20:23]
SA s30,s29,s65
M a[20:23],a[136:139],a[160:163],a[20:23]
SA s29,s29,s64
T a[40:41],v2,32768
T a[42:43],v2,33792
M a[24:27],a[144:147],a[160:163],a[24:27]
v_add_u32 v29, 6144, v29
v_add_u32 v23, v28, v29
M a[24:27],a[148:151],a[164:167],a[24:27]
s_waitcnt lgkmcnt(6)
buffer_load_dwordx4 v14, s[48:51], s22 offen offset:2048   lds
M a[28:31],a[156:159],a[164:167],a[28:31]
s_and_b32 s64, s20, 1
M a[28:31],a[152:155],a[160:163],a[28:31]
s_lshl_b32 s64, s64, 12
M v[60:63],a[152:155],a[168:171],v[60:63]
SA s64,s64,65536
R a[160:163],v5,4096
R a[164:167],v6,4096
M v[60:63],a[156:159],a[172:175],v[60:63]
T a[44:45],v2,40960
T a[46:47],v2,41984
M v[56:59],a[148:151],a[172:175],v[56:59]
buffer_load_dwordx4 v15, s[48:51], s22 offen offset:3072   lds
M v[56:59],a[144:147],a[168:171],v[56:59]
s_sub_u32 s22, s22, 1048448
v_add_u32 v20, s64, v5
v_add_u32 v21, s64, v6
M v[52:55],a[136:139],a[168:171],v[52:55]
v_lshrrev_b32 v28, 2, v0
v_lshlrev_b32 v28, 8, v28
M v[52:55],a[140:143],a[172:175],v[52:55]
T a[48:49],v3,32768
T a[50:51],v3,33792
M v[48:51],a[132:135],a[172:175],v[48:51]
SA m0,s23,16384
v_and_b32 v29, 3, v0
v_lshl_add_u32 v28, v29, 3, v28
M v[48:51],a[128:131],a[168:171],v[48:51]
buffer_load_dwordx4 v8, s[16:19], s21 offen offset:0   lds
M v[44:47],a[120:123],a[168:171],v[44:47]
v_add_u32 v28, s87, v28
M v[44:47],a[124:127],a[172:175],v[44:47]
s_waitcnt vmcnt(23)
s_nop 0
T a[176:177],v28,0
T a[178:179],v28,32
M v[40:43],a[116:119],a[172:175],v[40:43]
T a[52:53],v3,40960
T a[54:55],v3,41984
M v[40:43],a[112:115],a[168:171],v[40:43]
T a[180:181],v28,64
T a[182:183],v28,96
M v[36:39],a[104:107],a[168:171],v[36:39]
buffer_load_dwordx4 v9, s[16:19], s21 offen offset:1024   lds
M v[36:39],a[108:111],a[172:175],v[36:39]
s_waitcnt lgkmcnt(10)
s_nop 0
T a[184:185],v28,128
T a[186:187],v28,160
M v[32:35],a[100:103],a[172:175],v[32:35]
T a[188:189],v28,192
M v[32:35],a[96:99],a[168:171],v[32:35]
s_nop 0
T a[56:57],v4,32768
T a[58:59],v4,33792
M v[64:67],a[96:99],a[160:163],v[64:67]
R a[168:171],v5,6144
R a[172:175],v6,6144
M v[64:67],a[100:103],a[164:167],v[64:67]
buffer_load_dwordx4 v10, s[16:19], s21 offen offset:2048   lds
s_waitcnt lgkmcnt(12)
v_mfma_f32_16x16x16_bf16 a[192:195], a[176:177], v[16:17], 0
M v[68:71],a[108:111],a[164:167],v[68:71]
v_mov_b32 v18, v16 row_shr:2 row_mask:0xf bank_mask:0xf bound_ctrl:0
v_mov_b32 v19, v17 row_shr:2 row_mask:0xf bank_mask:0xf bound_ctrl:0
M v[68:71],a[104:107],a[160:163],v[68:71]
M v[72:75],a[112:115],a[160:163],v[72:75]
s_nop 0
T a[60:61],v4,40960
T a[62:63],v4,41984
M v[72:75],a[116:119],a[164:167],v[72:75]
s_waitcnt lgkmcnt(13)
v_mfma_f32_16x16x16_bf16 a[192:195], a[178:179], v[18:19], a[192:195]
M v[76:79],a[124:127],a[164:167],v[76:79]
buffer_load_dwordx4 v11, s[16:19], s21 offen offset:3072   lds
M v[76:79],a[120:123],a[160:163],v[76:79]
SA s21,s21,524160
v_mov_b32 v16, v18 row_shr:2 row_mask:0xf bank_mask:0xf bound_ctrl:0
v_mov_b32 v17, v19 row_shr:2 row_mask:0xf bank_mask:0xf bound_ctrl:0
M v[80:83],a[128:131],a[160:163],v[80:83]
M v[80:83],a[132:135],a[164:167],v[80:83]
s_waitcnt lgkmcnt(10)
v_mfma_f32_16x16x16_bf16 a[192:195], a[180:181], v[16:17], a[192:195]
M v[84:87],a[140:143],a[164:167],v[84:87]
v_mov_b32 v18, v16 row_shr:2 row_mask:0xf bank_mask:0xf bound_ctrl:0
v_mov_b32 v19, v17 row_shr:2 row_mask:0xf bank_mask:0xf bound_ctrl:0
M v[84:87],a[136:139],a[160:163],v[84:87]
M v[88:91],a[144:147],a[160:163],v[88:91]
M v[88:91],a[148:151],a[164:167],v[88:91]
s_waitcnt lgkmcnt(2)
v_mfma_f32_16x16x16_bf16 a[192:195], a[182:183], v[18:19], a[192:195]
M v[92:95],a[156:159],a[164:167],v[92:95]
s_waitcnt vmcnt(16) lgkmcnt(0)
v_mov_b32 v16, v18 row_shr:2 row_mask:0xf bank_mask:0xf bound_ctrl:0
v_mov_b32 v17, v19 row_shr:2 row_mask:0xf bank_mask:0xf bound_ctrl:0
M v[92:95],a[152:155],a[160:163],v[92:95]
s_barrier
M v[124:127],a[152:155],a[168:171],v[124:127]
R a[160:163],v5,16384
R a[164:167],v6,16384
M v[124:127],a[156:159],a[172:175],v[124:127]
SA m0,s23,131072
v_mfma_f32_16x16x16_bf16 a[192:195], a[184:185], v[16:17], a[192:195]
M v[120:123],a[148:151],a[172:175],v[120:123]
s_nop 0
T a[64:65],v1,49152
T a[66:67],v1,50176
M v[120:123],a[144:147],a[168:171],v[120:123]
v_mov_b32 v18, v16 row_shr:2 row_mask:0xf bank_mask:0xf bound_ctrl:0
v_mov_b32 v19, v17 row_shr:2 row_mask:0xf bank_mask:0xf bound_ctrl:0
M v[116:119],a[136:139],a[168:171],v[116:119]
buffer_load_dwordx4 v22, s[56:59], s29 offen offset:0 lds
M v[116:119],a[140:143],a[172:175],v[116:119]
v_mfma_f32_16x16x16_bf16 a[192:195], a[186:187], v[18:19], a[192:195]
M v[112:115],a[132:135],a[172:175],v[112:115]
v_mov_b32 v16, v18 row_shr:2 row_mask:0xf bank_mask:0xf bound_ctrl:0
v_mov_b32 v17, v19 row_shr:2 row_mask:0xf bank_mask:0xf bound_ctrl:0
M v[112:115],a[128:131],a[168:171],v[112:115]
buffer_load_dwordx4 v23, s[56:59], s29 offen offset:1024 lds
M v[108:111],a[120:123],a[168:171],v[108:111]
M v[108:111],a[124:127],a[172:175],v[108:111]
s_nop 0
T a[68:69],v1,57344
T a[70:71],v1,58368
v_mfma_f32_16x16x16_bf16 a[192:195], a[188:189], v[16:17], a[192:195]
M v[104:107],a[116:119],a[172:175],v[104:107]
buffer_load_dwordx4 v22, s[56:59], s30 offen offset:2048 lds
M v[104:107],a[112:115],a[168:171],v[104:107]
v_and_b32 v29, 1, v0
v_mul_u32_u24 v30, 1792, v29
M v[100:103],a[104:107],a[168:171],v[100:103]
v_lshrrev_b32 v31, 4, v0
v_lshl_add_u32 v30, v31, 4, v30
M v[100:103],a[108:111],a[172:175],v[100:103]
s_waitcnt lgkmcnt(4)
v_bfe_u32 v29, v0, 1, 3
v_lshl_add_u32 v30, v29, 6, v30
M v[96:99],a[100:103],a[172:175],v[96:99]
v_add_u32 v29, 1, v29
v_lshrrev_b32 v29, 3, v29
M v[96:99],a[96:99],a[168:171],v[96:99]
v_lshl_or_b32 v30, v29, 29, v30
v_or_b32 v30, s88, v30
M v[128:131],a[96:99],a[160:163],v[128:131]
s_mul_i32 s89, s86, 3584
R a[168:171],v5,18432
R a[172:175],v6,18432
M v[128:131],a[100:103],a[164:167],v[128:131]
s_mul_i32 s64, s20, 448
T a[72:73],v2,49152
T a[74:75],v2,50176
M v[132:135],a[108:111],a[164:167],v[132:135]
SA s89,s89,s64
M v[132:135],a[104:107],a[160:163],v[132:135]
SA s89,s89,105906176
buffer_store_dwordx4 a[192:195], v30, s[8:11], s89 offen sc1
M v[136:139],a[112:115],a[160:163],v[136:139]
M v[136:139],a[116:119],a[164:167],v[136:139]
M v[140:143],a[124:127],a[164:167],v[140:143]
buffer_load_dwordx4 v23, s[56:59], s30 offen offset:3072 lds
M v[140:143],a[120:123],a[160:163],v[140:143]
SA s29,s29,128
T a[76:77],v2,57344
T a[78:79],v2,58368
M v[144:147],a[128:131],a[160:163],v[144:147]
SA s30,s30,128
M v[144:147],a[132:135],a[164:167],v[144:147]
SA m0,s24,0
M v[148:151],a[140:143],a[164:167],v[148:151]
buffer_load_dwordx4 v12, s[48:51], s22 offen offset:0   lds
M v[148:151],a[136:139],a[160:163],v[148:151]
M v[152:155],a[144:147],a[160:163],v[152:155]
M v[152:155],a[148:151],a[164:167],v[152:155]
s_waitcnt lgkmcnt(4)
buffer_load_dwordx4 v13, s[48:51], s22 offen offset:1024   lds
M v[156:159],a[156:159],a[164:167],v[156:159]
s_nop 0
T a[80:81],v3,49152
T a[82:83],v3,50176
M v[156:159],a[152:155],a[160:163],v[156:159]
M v[188:191],a[152:155],a[168:171],v[188:191]
R a[160:163],v5,20480
R a[164:167],v6,20480
M v[188:191],a[156:159],a[172:175],v[188:191]
buffer_load_dwordx4 v14, s[48:51], s22 offen offset:2048   lds
M v[184:187],a[148:151],a[172:175],v[184:187]
M v[184:187],a[144:147],a[168:171],v[184:187]
M v[180:183],a[136:139],a[168:171],v[180:183]
buffer_load_dwordx4 v15, s[48:51], s22 offen offset:3072   lds
M v[180:183],a[140:143],a[172:175],v[180:183]
SA s22,s22,1048576
T a[84:85],v3,57344
T a[86:87],v3,58368
M v[176:179],a[132:135],a[172:175],v[176:179]
SA m0,s23,32768
M v[176:179],a[128:131],a[168:171],v[176:179]
buffer_load_dwordx4 v8, s[16:19], s21 offen offset:0   lds
M v[172:175],a[120:123],a[168:171],v[172:175]
M v[172:175],a[124:127],a[172:175],v[172:175]
L_w_kv06:
s_cbranch_execz L_w_kv010
M v[168:171],a[116:119],a[172:175],v[168:171]
M v[168:171],a[112:115],a[168:171],v[168:171]
buffer_load_dwordx4 v9, s[16:19], s21 offen offset:1024   lds
M v[164:167],a[104:107],a[168:171],v[164:167]
s_nop 0
T a[88:89],v4,49152
T a[90:91],v4,50176
M v[164:167],a[108:111],a[172:175],v[164:167]
s_waitcnt lgkmcnt(4)
M v[160:163],a[100:103],a[172:175],v[160:163]
M v[160:163],a[96:99],a[168:171],v[160:163]
M v[192:195],a[96:99],a[160:163],v[192:195]
R a[168:171],v5,22528
R a[172:175],v6,22528
M v[192:195],a[100:103],a[164:167],v[192:195]
buffer_load_dwordx4 v10, s[16:19], s21 offen offset:2048   lds
M v[196:199],a[108:111],a[164:167],v[196:199]
M v[196:199],a[104:107],a[160:163],v[196:199]
s_nop 0
T a[92:93],v4,57344
T a[94:95],v4,58368
M v[200:203],a[112:115],a[160:163],v[200:203]
M v[200:203],a[116:119],a[164:167],v[200:203]
buffer_load_dwordx4 v11, s[16:19], s21 offen offset:3072   lds
M v[204:207],a[124:127],a[164:167],v[204:207]
M v[204:207],a[120:123],a[160:163],v[204:207]
M v[208:211],a[128:131],a[160:163],v[208:211]
M v[208:211],a[132:135],a[164:167],v[208:211]
M v[212:215],a[140:143],a[164:167],v[212:215]
SA s21,s21,128
M v[212:215],a[136:139],a[160:163],v[212:215]
M v[216:219],a[144:147],a[160:163],v[216:219]
M v[216:219],a[148:151],a[164:167],v[216:219]
s_waitcnt lgkmcnt(2)
M v[220:223],a[156:159],a[164:167],v[220:223]
s_waitcnt vmcnt(21) lgkmcnt(0)
M v[220:223],a[152:155],a[160:163],v[220:223]
s_barrier
M v[252:255],a[152:155],a[168:171],v[252:255]
R a[160:163],v5,32768
R a[164:167],v6,32768
M v[252:255],a[156:159],a[172:175],v[252:255]
M v[248:251],a[148:151],a[172:175],v[248:251]
M v[248:251],a[144:147],a[168:171],v[248:251]
M v[244:247],a[136:139],a[168:171],v[244:247]
M v[244:247],a[140:143],a[172:175],v[244:247]
M v[240:243],a[132:135],a[172:175],v[240:243]
M v[240:243],a[128:131],a[168:171],v[240:243]
M v[236:239],a[120:123],a[168:171],v[236:239]
M v[236:239],a[124:127],a[172:175],v[236:239]
M v[232:235],a[116:119],a[172:175],v[232:235]
M v[232:235],a[112:115],a[168:171],v[232:235]
M v[228:231],a[104:107],a[168:171],v[228:231]
M v[228:231],a[108:111],a[172:175],v[228:231]
s_waitcnt lgkmcnt(0)
M v[224:227],a[100:103],a[172:175],v[224:227]
M v[224:227],a[96:99],a[168:171],v[224:227]
M a[0:3],a[32:35],a[160:163],a[0:3]
R a[168:171],v5,34816
R a[172:175],v6,34816
M a[0:3],a[36:39],a[164:167],a[0:3]
SA m0,s23,147456
T a[96:97],v1,0
T a[98:99],v1,1024
M a[4:7],a[44:47],a[164:167],a[4:7]
buffer_load_dwordx4 v22, s[56:59], s29 offen offset:0 lds
M a[4:7],a[40:43],a[160:163],a[4:7]
M a[8:11],a[48:51],a[160:163],a[8:11]
M a[8:11],a[52:55],a[164:167],a[8:11]
buffer_load_dwordx4 v23, s[56:59], s29 offen offset:1024 lds
M a[12:15],a[60:63],a[164:167],a[12:15]
s_nop 0
T a[100:101],v1,8192
T a[102:103],v1,9216
M a[12:15],a[56:59],a[160:163],a[12:15]
M a[16:19],a[64:67],a[160:163],a[16:19]
buffer_load_dwordx4 v22, s[56:59], s30 offen offset:2048 lds
M a[16:19],a[68:71],a[164:167],a[16:19]
M a[20:23],a[76:79],a[164:167],a[20:23]
M a[20:23],a[72:75],a[160:163],a[20:23]
s_nop 0
T a[104:105],v2,0
T a[106:107],v2,1024
M a[24:27],a[80:83],a[160:163],a[24:27]
buffer_load_dwordx4 v23, s[56:59], s30 offen offset:3072 lds
M a[24:27],a[84:87],a[164:167],a[24:27]
s_waitcnt lgkmcnt(6)
M a[28:31],a[92:95],a[164:167],a[28:31]
SA s29,s29,128
M a[28:31],a[88:91],a[160:163],a[28:31]
SA s30,s30,128
M v[60:63],a[88:91],a[168:171],v[60:63]
SA m0,s24,16384
R a[160:163],v5,36864
R a[164:167],v6,36864
M v[60:63],a[92:95],a[172:175],v[60:63]
T a[108:109],v2,8192
T a[110:111],v2,9216
M v[56:59],a[84:87],a[172:175],v[56:59]
buffer_load_dwordx4 v12, s[48:51], s22 offen offset:0   lds
M v[56:59],a[80:83],a[168:171],v[56:59]
M v[52:55],a[72:75],a[168:171],v[52:55]
M v[52:55],a[76:79],a[172:175],v[52:55]
s_nop 0
T a[112:113],v3,0
T a[114:115],v3,1024
M v[48:51],a[68:71],a[172:175],v[48:51]
buffer_load_dwordx4 v13, s[48:51], s22 offen offset:1024   lds
M v[48:51],a[64:67],a[168:171],v[48:51]
M v[44:47],a[56:59],a[168:171],v[44:47]
M v[44:47],a[60:63],a[172:175],v[44:47]
buffer_load_dwordx4 v14, s[48:51], s22 offen offset:2048   lds
M v[40:43],a[52:55],a[172:175],v[40:43]
s_nop 0
T a[116:117],v3,8192
T a[118:119],v3,9216
M v[40:43],a[48:51],a[168:171],v[40:43]
M v[36:39],a[40:43],a[168:171],v[36:39]
buffer_load_dwordx4 v15, s[48:51], s22 offen offset:3072   lds
M v[36:39],a[44:47],a[172:175],v[36:39]
s_waitcnt lgkmcnt(6)
M v[32:35],a[36:39],a[172:175],v[32:35]
s_sub_u32 s22, s22, 1048448
M v[32:35],a[32:35],a[168:171],v[32:35]
SA m0,s23,49152
T a[120:121],v4,0
T a[122:123],v4,1024
M v[64:67],a[32:35],a[160:163],v[64:67]
R a[168:171],v5,38912
R a[172:175],v6,38912
M v[64:67],a[36:39],a[164:167],v[64:67]
buffer_load_dwordx4 v8, s[16:19], s21 offen offset:0   lds
M v[68:71],a[44:47],a[164:167],v[68:71]
M v[68:71],a[40:43],a[160:163],v[68:71]
M v[72:75],a[48:51],a[160:163],v[72:75]
s_waitcnt vmcnt(17)
s_nop 0
T a[124:125],v4,8192
T a[126:127],v4,9216
M v[72:75],a[52:55],a[164:167],v[72:75]
buffer_load_dwordx4 v9, s[16:19], s21 offen offset:1024   lds
M v[76:79],a[60:63],a[164:167],v[76:79]
R a[176:179],v20,0
R a[180:183],v20,2048
M v[76:79],a[56:59],a[160:163],v[76:79]
R a[184:187],v21,0
R a[188:191],v21,2048
M v[80:83],a[64:67],a[160:163],v[80:83]
buffer_load_dwordx4 v10, s[16:19], s21 offen offset:2048   lds
M v[80:83],a[68:71],a[164:167],v[80:83]
M v[84:87],a[76:79],a[164:167],v[84:87]
M v[84:87],a[72:75],a[160:163],v[84:87]
buffer_load_dwordx4 v11, s[16:19], s21 offen offset:3072   lds
M v[88:91],a[80:83],a[160:163],v[88:91]
SA s21,s21,524160
M v[88:91],a[84:87],a[164:167],v[88:91]
s_waitcnt lgkmcnt(6)
M v[92:95],a[92:95],a[164:167],v[92:95]
s_waitcnt lgkmcnt(0)
M v[92:95],a[88:91],a[160:163],v[92:95]
s_barrier
M v[124:127],a[88:91],a[168:171],v[124:127]
s_lshl_b32 s4, s20, 10
R a[160:163],v5,49152
R a[164:167],v6,49152
M v[124:127],a[92:95],a[172:175],v[124:127]
SA m0,s23,131072
v_bfe_u32 v28, v0, 3, 2
M v[120:123],a[84:87],a[172:175],v[120:123]
s_nop 0
T a[128:129],v1,16384
T a[130:131],v1,17408
M v[120:123],a[80:83],a[168:171],v[120:123]
buffer_load_dwordx4 v22, s[56:59], s29 offen offset:0 lds
M v[116:119],a[72:75],a[168:171],v[116:119]
v_lshrrev_b32 v29, 5, v0
v_lshl_add_u32 v28, v29, 3, v28
M v[116:119],a[76:79],a[172:175],v[116:119]
M v[112:115],a[68:71],a[172:175],v[112:115]
v_lshlrev_b32 v28, 13, v28
M v[112:115],a[64:67],a[168:171],v[112:115]
M v[108:111],a[56:59],a[168:171],v[108:111]
buffer_load_dwordx4 v23, s[56:59], s29 offen offset:1024 lds
M v[108:111],a[60:63],a[172:175],v[108:111]
s_nop 0
T a[132:133],v1,24576
T a[134:135],v1,25600
M v[104:107],a[52:55],a[172:175],v[104:107]
v_lshrrev_b32 v29, 4, v0
v_lshlrev_b32 v29, 1, v29
M v[104:107],a[48:51],a[168:171],v[104:107]
M v[100:103],a[40:43],a[168:171],v[100:103]
v_and_b32 v30, 7, v0
M v[100:103],a[44:47],a[172:175],v[100:103]
s_waitcnt lgkmcnt(4)
M v[96:99],a[36:39],a[172:175],v[96:99]
v_xor_b32 v29, v29, v30
M v[96:99],a[32:35],a[168:171],v[96:99]
buffer_load_dwordx4 v22, s[56:59], s30 offen offset:2048 lds
M v[128:131],a[32:35],a[160:163],v[128:131]
R a[168:171],v5,51200
R a[172:175],v6,51200
M v[128:131],a[36:39],a[164:167],v[128:131]
T a[136:137],v2,16384
T a[138:139],v2,17408
M v[132:135],a[44:47],a[164:167],v[132:135]
v_lshl_add_u32 v28, v29, 4, v28
M v[132:135],a[40:43],a[160:163],v[132:135]
s_and_b32 s64, s20, 1
M v[136:139],a[48:51],a[160:163],v[136:139]
s_lshl_b32 s64, s64, 17
M v[136:139],a[52:55],a[164:167],v[136:139]
s_lshr_b32 s65, s20, 1
M v[140:143],a[60:63],a[164:167],v[140:143]
s_lshl_b32 s65, s65, 15
SA s64,s64,s65
v_add_u32 v8, s64, v28
M v[140:143],a[56:59],a[160:163],v[140:143]
s_nop 0
T a[140:141],v2,24576
T a[142:143],v2,25600
M v[144:147],a[64:67],a[160:163],v[144:147]
buffer_load_dwordx4 v23, s[56:59], s30 offen offset:3072 lds
M v[144:147],a[68:71],a[164:167],v[144:147]
M v[148:151],a[76:79],a[164:167],v[148:151]
SA s29,s29,128
M v[148:151],a[72:75],a[160:163],v[148:151]
SA s30,s30,128
M v[152:155],a[80:83],a[160:163],v[152:155]
SA m0,s24,32768
M v[152:155],a[84:87],a[164:167],v[152:155]
s_waitcnt lgkmcnt(4)
buffer_load_dwordx4 v12, s[48:51], s22 offen offset:0   lds
M v[156:159],a[92:95],a[164:167],v[156:159]
s_nop 0
T a[144:145],v3,16384
T a[146:147],v3,17408
M v[156:159],a[88:91],a[160:163],v[156:159]
M v[188:191],a[88:91],a[168:171],v[188:191]
R a[160:163],v5,53248
R a[164:167],v6,53248
M v[188:191],a[92:95],a[172:175],v[188:191]
M v[184:187],a[84:87],a[172:175],v[184:187]
M v[184:187],a[80:83],a[168:171],v[184:187]
M v[180:183],a[72:75],a[168:171],v[180:183]
buffer_load_dwordx4 v13, s[48:51], s22 offen offset:1024   lds
M v[180:183],a[76:79],a[172:175],v[180:183]
s_nop 0
T a[148:149],v3,24576
T a[150:151],v3,25600
M v[176:179],a[68:71],a[172:175],v[176:179]
M v[176:179],a[64:67],a[168:171],v[176:179]
M v[172:175],a[56:59],a[168:171],v[172:175]
M v[172:175],a[60:63],a[172:175],v[172:175]
M v[168:171],a[52:55],a[172:175],v[168:171]
M v[168:171],a[48:51],a[168:171],v[168:171]
buffer_load_dwordx4 v14, s[48:51], s22 offen offset:2048   lds
M v[164:167],a[40:43],a[168:171],v[164:167]
s_nop 0
T a[152:153],v4,16384
T a[154:155],v4,17408
M v[164:167],a[44:47],a[172:175],v[164:167]
s_waitcnt lgkmcnt(4)
M v[160:163],a[36:39],a[172:175],v[160:163]
M v[160:163],a[32:35],a[168:171],v[160:163]
M v[192:195],a[32:35],a[160:163],v[192:195]
R a[168:171],v5,55296
R a[172:175],v6,55296
M v[192:195],a[36:39],a[164:167],v[192:195]
M v[196:199],a[44:47],a[164:167],v[196:199]
buffer_load_dwordx4 v15, s[48:51], s22 offen offset:3072   lds
M v[196:199],a[40:43],a[160:163],v[196:199]
s_nop 0
T a[156:157],v4,24576
T a[158:159],v4,25600
M v[200:203],a[48:51],a[160:163],v[200:203]
s_waitcnt vmcnt(16)
R a[192:195],v20,16384
R a[196:199],v20,18432
M v[200:203],a[52:55],a[164:167],v[200:203]
R a[200:203],v21,16384
R a[204:207],v21,18432
M v[204:207],a[60:63],a[164:167],v[204:207]
M v[204:207],a[56:59],a[160:163],v[204:207]
M v[208:211],a[64:67],a[160:163],v[208:211]
M v[208:211],a[68:71],a[164:167],v[208:211]
M v[212:215],a[76:79],a[164:167],v[212:215]
SA s22,s22,1048576
M v[212:215],a[72:75],a[160:163],v[212:215]
M v[216:219],a[80:83],a[160:163],v[216:219]
M v[216:219],a[84:87],a[164:167],v[216:219]
s_waitcnt lgkmcnt(6)
M v[220:223],a[92:95],a[164:167],v[220:223]
s_waitcnt lgkmcnt(0)
M v[220:223],a[88:91],a[160:163],v[220:223]
s_barrier
M v[252:255],a[88:91],a[168:171],v[252:255]
R a[160:163],v5,0
R a[164:167],v6,0
M v[252:255],a[92:95],a[172:175],v[252:255]
M v[248:251],a[84:87],a[172:175],v[248:251]
M v[248:251],a[80:83],a[168:171],v[248:251]
M v[244:247],a[72:75],a[168:171],v[244:247]
M v[244:247],a[76:79],a[172:175],v[244:247]
M v[240:243],a[68:71],a[172:175],v[240:243]
M v[240:243],a[64:67],a[168:171],v[240:243]
M v[236:239],a[56:59],a[168:171],v[236:239]
M v[236:239],a[60:63],a[172:175],v[236:239]
M v[232:235],a[52:55],a[172:175],v[232:235]
M v[232:235],a[48:51],a[168:171],v[232:235]
M v[228:231],a[40:43],a[168:171],v[228:231]
M v[228:231],a[44:47],a[172:175],v[228:231]
s_waitcnt lgkmcnt(0)
M v[224:227],a[36:39],a[172:175],v[224:227]
M v[224:227],a[32:35],a[168:171],v[224:227]
M a[0:3],a[96:99],a[160:163],a[0:3]
R a[168:171],v5,2048
R a[172:175],v6,2048
M a[0:3],a[100:103],a[164:167],a[0:3]
SA m0,s23,147456
T a[32:33],v1,32768
T a[34:35],v1,33792
M a[4:7],a[108:111],a[164:167],a[4:7]
buffer_load_dwordx4 v22, s[56:59], s29 offen offset:0 lds
M a[4:7],a[104:107],a[160:163],a[4:7]
M a[8:11],a[112:115],a[160:163],a[8:11]
M a[8:11],a[116:119],a[164:167],a[8:11]
buffer_load_dwordx4 v23, s[56:59], s29 offen offset:1024 lds
M a[12:15],a[124:127],a[164:167],a[12:15]
s_nop 0
T a[36:37],v1,40960
T a[38:39],v1,41984
M a[12:15],a[120:123],a[160:163],a[12:15]
M a[16:19],a[128:131],a[160:163],a[16:19]
buffer_load_dwordx4 v22, s[56:59], s30 offen offset:2048 lds
M a[16:19],a[132:135],a[164:167],a[16:19]
M a[20:23],a[140:143],a[164:167],a[20:23]
M a[20:23],a[136:139],a[160:163],a[20:23]
s_nop 0
T a[40:41],v2,32768
T a[42:43],v2,33792
M a[24:27],a[144:147],a[160:163],a[24:27]
buffer_load_dwordx4 v23, s[56:59], s30 offen offset:3072 lds
M a[24:27],a[148:151],a[164:167],a[24:27]
s_waitcnt lgkmcnt(6)
M a[28:31],a[156:159],a[164:167],a[28:31]
SA s29,s29,128
M a[28:31],a[152:155],a[160:163],a[28:31]
SA s30,s30,128
M v[60:63],a[152:155],a[168:171],v[60:63]
SA m0,s24,49152
R a[160:163],v5,4096
R a[164:167],v6,4096
M v[60:63],a[156:159],a[172:175],v[60:63]
T a[44:45],v2,40960
T a[46:47],v2,41984
M v[56:59],a[148:151],a[172:175],v[56:59]
buffer_load_dwordx4 v12, s[48:51], s22 offen offset:0   lds
M v[56:59],a[144:147],a[168:171],v[56:59]
M v[52:55],a[136:139],a[168:171],v[52:55]
M v[52:55],a[140:143],a[172:175],v[52:55]
s_nop 0
T a[48:49],v3,32768
T a[50:51],v3,33792
M v[48:51],a[132:135],a[172:175],v[48:51]
buffer_load_dwordx4 v13, s[48:51], s22 offen offset:1024   lds
M v[48:51],a[128:131],a[168:171],v[48:51]
M v[44:47],a[120:123],a[168:171],v[44:47]
M v[44:47],a[124:127],a[172:175],v[44:47]
buffer_load_dwordx4 v14, s[48:51], s22 offen offset:2048   lds
M v[40:43],a[116:119],a[172:175],v[40:43]
s_nop 0
T a[52:53],v3,40960
T a[54:55],v3,41984
M v[40:43],a[112:115],a[168:171],v[40:43]
M v[36:39],a[104:107],a[168:171],v[36:39]
buffer_load_dwordx4 v15, s[48:51], s22 offen offset:3072   lds
M v[36:39],a[108:111],a[172:175],v[36:39]
s_waitcnt lgkmcnt(6)
M v[32:35],a[100:103],a[172:175],v[32:35]
s_sub_u32 s22, s22, 1048448
M v[32:35],a[96:99],a[168:171],v[32:35]
s_mov_b32 s25, 0
T a[56:57],v4,32768
T a[58:59],v4,33792
M v[64:67],a[96:99],a[160:163],v[64:67]
SA m0,s4,0
R a[168:171],v5,6144
R a[172:175],v6,6144
M v[64:67],a[100:103],a[164:167],v[64:67]
buffer_load_dwordx4 v8, s[52:55], s25 offen lds
M v[68:71],a[108:111],a[164:167],v[68:71]
s_mov_b32 s25, 262144
M v[68:71],a[104:107],a[160:163],v[68:71]
SA m0,s4,4096
M v[72:75],a[112:115],a[160:163],v[72:75]
s_waitcnt vmcnt(13)
s_nop 0
T a[60:61],v4,40960
T a[62:63],v4,41984
M v[72:75],a[116:119],a[164:167],v[72:75]
buffer_load_dwordx4 v8, s[52:55], s25 offen lds
M v[76:79],a[124:127],a[164:167],v[76:79]
s_mov_b32 s25, 524288
R a[208:211],v20,0
R a[212:215],v20,2048
M v[76:79],a[120:123],a[160:163],v[76:79]
SA m0,s4,8192
R a[216:219],v21,0
R a[220:223],v21,2048
M v[80:83],a[128:131],a[160:163],v[80:83]
buffer_load_dwordx4 v8, s[52:55], s25 offen lds
M v[80:83],a[132:135],a[164:167],v[80:83]
s_mov_b32 s25, 786432
M v[84:87],a[140:143],a[164:167],v[84:87]
SA m0,s4,12288
M v[84:87],a[136:139],a[160:163],v[84:87]
buffer_load_dwordx4 v8, s[52:55], s25 offen lds
M v[88:91],a[144:147],a[160:163],v[88:91]
M v[88:91],a[148:151],a[164:167],v[88:91]
s_waitcnt lgkmcnt(6)
M v[92:95],a[156:159],a[164:167],v[92:95]
s_waitcnt lgkmcnt(0)
M v[92:95],a[152:155],a[160:163],v[92:95]
s_barrier
M v[124:127],a[152:155],a[168:171],v[124:127]
R a[160:163],v5,16384
R a[164:167],v6,16384
M v[124:127],a[156:159],a[172:175],v[124:127]
SA m0,s23,32768
M v[120:123],a[148:151],a[172:175],v[120:123]
s_nop 0
T a[64:65],v1,49152
T a[66:67],v1,50176
M v[120:123],a[144:147],a[168:171],v[120:123]
buffer_load_dwordx4 v22, s[56:59], s29 offen offset:0 lds
M v[116:119],a[136:139],a[168:171],v[116:119]
v_lshrrev_b32 v28, 2, v0
v_lshlrev_b32 v28, 7, v28
M v[116:119],a[140:143],a[172:175],v[116:119]
M v[112:115],a[132:135],a[172:175],v[112:115]
buffer_load_dwordx4 v23, s[56:59], s29 offen offset:1024 lds
M v[112:115],a[128:131],a[168:171],v[112:115]
v_and_b32 v29, 3, v0
M v[108:111],a[120:123],a[168:171],v[108:111]
v_lshl_add_u32 v28, v29, 3, v28
M v[108:111],a[124:127],a[172:175],v[108:111]
s_nop 0
T a[68:69],v1,57344
T a[70:71],v1,58368
M v[104:107],a[116:119],a[172:175],v[104:107]
buffer_load_dwordx4 v22, s[56:59], s30 offen offset:2048 lds
M v[104:107],a[112:115],a[168:171],v[104:107]
v_bfe_u32 v29, v0, 3, 2
M v[100:103],a[104:107],a[168:171],v[100:103]
M v[100:103],a[108:111],a[172:175],v[100:103]
s_waitcnt lgkmcnt(4)
v_lshl_add_u32 v16, v29, 5, v28
M v[96:99],a[100:103],a[172:175],v[96:99]
M v[96:99],a[96:99],a[168:171],v[96:99]
buffer_load_dwordx4 v23, s[56:59], s30 offen offset:3072 lds
M v[128:131],a[96:99],a[160:163],v[128:131]
R a[168:171],v5,18432
R a[172:175],v6,18432
M v[128:131],a[100:103],a[164:167],v[128:131]
SA s29,s29,128
T a[72:73],v2,49152
T a[74:75],v2,50176
M v[132:135],a[108:111],a[164:167],v[132:135]
SA s30,s30,128
v_xor_b32 v17, 32, v16
v_xor_b32 v18, 64, v16
M v[132:135],a[104:107],a[160:163],v[132:135]
SA m0,s23,65536
M v[136:139],a[112:115],a[160:163],v[136:139]
buffer_load_dwordx4 v22, s[56:59], s29 offen offset:0 lds
M v[136:139],a[116:119],a[164:167],v[136:139]
v_xor_b32 v19, 0x60, v16
M v[140:143],a[124:127],a[164:167],v[140:143]
v_add_u32 v12, 0x20000, v16
M v[140:143],a[120:123],a[160:163],v[140:143]
s_nop 0
T a[76:77],v2,57344
T a[78:79],v2,58368
M v[144:147],a[128:131],a[160:163],v[144:147]
buffer_load_dwordx4 v23, s[56:59], s29 offen offset:1024 lds
M v[144:147],a[132:135],a[164:167],v[144:147]
v_add_u32 v13, 0x20000, v17
M v[148:151],a[140:143],a[164:167],v[148:151]
M v[148:151],a[136:139],a[160:163],v[148:151]
v_add_u32 v14, 0x20000, v18
M v[152:155],a[144:147],a[160:163],v[152:155]
M v[152:155],a[148:151],a[164:167],v[152:155]
s_waitcnt lgkmcnt(4)
buffer_load_dwordx4 v22, s[56:59], s30 offen offset:2048 lds
M v[156:159],a[156:159],a[164:167],v[156:159]
s_nop 0
T a[80:81],v3,49152
T a[82:83],v3,50176
M v[156:159],a[152:155],a[160:163],v[156:159]
v_add_u32 v15, 0x20000, v19
M v[188:191],a[152:155],a[168:171],v[188:191]
R a[160:163],v5,20480
R a[164:167],v6,20480
M v[188:191],a[156:159],a[172:175],v[188:191]
M v[184:187],a[148:151],a[172:175],v[184:187]
buffer_load_dwordx4 v23, s[56:59], s30 offen offset:3072 lds
M v[184:187],a[144:147],a[168:171],v[184:187]
SA s29,s29,128
M v[180:183],a[136:139],a[168:171],v[180:183]
SA s30,s30,128
M v[180:183],a[140:143],a[172:175],v[180:183]
s_mov_b32 s25, 1048576
T a[84:85],v3,57344
T a[86:87],v3,58368
M v[176:179],a[132:135],a[172:175],v[176:179]
SA m0,s4,16384
M v[176:179],a[128:131],a[168:171],v[176:179]
buffer_load_dwordx4 v8, s[52:55], s25 offen lds
M v[172:175],a[120:123],a[168:171],v[172:175]
M v[172:175],a[124:127],a[172:175],v[172:175]
s_mov_b32 s25, 1310720
M v[168:171],a[116:119],a[172:175],v[168:171]
SA m0,s4,20480
M v[168:171],a[112:115],a[168:171],v[168:171]
buffer_load_dwordx4 v8, s[52:55], s25 offen lds
M v[164:167],a[104:107],a[168:171],v[164:167]
s_nop 0
T a[88:89],v4,49152
T a[90:91],v4,50176
M v[164:167],a[108:111],a[172:175],v[164:167]
s_waitcnt lgkmcnt(4)
M v[160:163],a[100:103],a[172:175],v[160:163]
s_mov_b32 s25, 1572864
M v[160:163],a[96:99],a[168:171],v[160:163]
SA m0,s4,24576
M v[192:195],a[96:99],a[160:163],v[192:195]
R a[168:171],v5,22528
R a[172:175],v6,22528
M v[192:195],a[100:103],a[164:167],v[192:195]
buffer_load_dwordx4 v8, s[52:55], s25 offen lds
M v[196:199],a[108:111],a[164:167],v[196:199]
M v[196:199],a[104:107],a[160:163],v[196:199]
s_mov_b32 s25, 1835008
T a[92:93],v4,57344
T a[94:95],v4,58368
M v[200:203],a[112:115],a[160:163],v[200:203]
L_w_kv07:
s_cbranch_execz L_w_kv011
SA m0,s4,28672
M v[200:203],a[116:119],a[164:167],v[200:203]
s_waitcnt vmcnt(19)
buffer_load_dwordx4 v8, s[52:55], s25 offen lds
M v[204:207],a[124:127],a[164:167],v[204:207]
R a[224:227],v20,16384
R a[228:231],v20,18432
M v[204:207],a[120:123],a[160:163],v[204:207]
R a[232:235],v21,16384
R a[236:239],v21,18432
M v[208:211],a[128:131],a[160:163],v[208:211]
v_subrev_u32 v20, 98304, v20
v_subrev_u32 v21, 98304, v21
M v[208:211],a[132:135],a[164:167],v[208:211]
M v[212:215],a[140:143],a[164:167],v[212:215]
M v[212:215],a[136:139],a[160:163],v[212:215]
M v[216:219],a[144:147],a[160:163],v[216:219]
M v[216:219],a[148:151],a[164:167],v[216:219]
s_waitcnt lgkmcnt(6)
M v[220:223],a[156:159],a[164:167],v[220:223]
s_waitcnt lgkmcnt(0)
M v[220:223],a[152:155],a[160:163],v[220:223]
s_barrier
M v[252:255],a[152:155],a[168:171],v[252:255]
R a[160:163],v5,32768
R a[164:167],v6,32768
M v[252:255],a[156:159],a[172:175],v[252:255]
M v[248:251],a[148:151],a[172:175],v[248:251]
M v[248:251],a[144:147],a[168:171],v[248:251]
M v[244:247],a[136:139],a[168:171],v[244:247]
M v[244:247],a[140:143],a[172:175],v[244:247]
M v[240:243],a[132:135],a[172:175],v[240:243]
M v[240:243],a[128:131],a[168:171],v[240:243]
M v[236:239],a[120:123],a[168:171],v[236:239]
M v[236:239],a[124:127],a[172:175],v[236:239]
M v[232:235],a[116:119],a[172:175],v[232:235]
M v[232:235],a[112:115],a[168:171],v[232:235]
M v[228:231],a[104:107],a[168:171],v[228:231]
M v[228:231],a[108:111],a[172:175],v[228:231]
s_waitcnt lgkmcnt(0)
M v[224:227],a[100:103],a[172:175],v[224:227]
M v[224:227],a[96:99],a[168:171],v[224:227]
M a[0:3],a[32:35],a[160:163],a[0:3]
R a[168:171],v5,34816
R a[172:175],v6,34816
M a[0:3],a[36:39],a[164:167],a[0:3]
SA m0,s23,81920
M a[4:7],a[44:47],a[164:167],a[4:7]
buffer_load_dwordx4 v22, s[56:59], s29 offen offset:0 lds
M a[4:7],a[40:43],a[160:163],a[4:7]
M a[8:11],a[48:51],a[160:163],a[8:11]
M a[8:11],a[52:55],a[164:167],a[8:11]
buffer_load_dwordx4 v23, s[56:59], s29 offen offset:1024 lds
M a[12:15],a[60:63],a[164:167],a[12:15]
M a[12:15],a[56:59],a[160:163],a[12:15]
G v24,a0
G v25,a1
M a[16:19],a[64:67],a[160:163],a[16:19]
G v26,a2
G v27,a3
M a[16:19],a[68:71],a[164:167],a[16:19]
buffer_load_dwordx4 v22, s[56:59], s30 offen offset:2048 lds
M a[20:23],a[76:79],a[164:167],a[20:23]
G v28,a4
G v29,a5
M a[20:23],a[72:75],a[160:163],a[20:23]
G v30,a6
G v31,a7
M a[24:27],a[80:83],a[160:163],a[24:27]
C v24,v24,v25
C v25,v26,v27
M a[24:27],a[84:87],a[164:167],a[24:27]
s_waitcnt lgkmcnt(0)
buffer_load_dwordx4 v23, s[56:59], s30 offen offset:3072 lds
M a[28:31],a[92:95],a[164:167],a[28:31]
SA s29,s29,128
C v26,v28,v29
C v27,v30,v31
M a[28:31],a[88:91],a[160:163],a[28:31]
SA s3,s93,0
buffer_store_dwordx4 v[24:27], v7, s[8:11], s3 offen offset:0 sc1
M v[32:35],a[32:35],a[168:171],v[32:35]
SA s30,s30,128
R a[160:163],v5,36864
R a[164:167],v6,36864
M v[32:35],a[36:39],a[172:175],v[32:35]
s_mov_b32 s25, 2097152
G v24,a8
G v25,a9
M v[36:39],a[44:47],a[172:175],v[36:39]
SA m0,s4,131072
G v26,a10
G v27,a11
M v[36:39],a[40:43],a[168:171],v[36:39]
buffer_load_dwordx4 v8, s[52:55], s25 offen lds
M v[40:43],a[48:51],a[168:171],v[40:43]
s_mov_b32 s25, 2359296
G v28,a12
G v29,a13
M v[40:43],a[52:55],a[172:175],v[40:43]
SA m0,s4,135168
G v30,a14
G v31,a15
M v[44:47],a[60:63],a[172:175],v[44:47]
buffer_load_dwordx4 v8, s[52:55], s25 offen lds
M v[44:47],a[56:59],a[168:171],v[44:47]
s_mov_b32 s25, 2621440
C v24,v24,v25
C v25,v26,v27
M v[48:51],a[64:67],a[168:171],v[48:51]
SA m0,s4,139264
C v26,v28,v29
C v27,v30,v31
M v[48:51],a[68:71],a[172:175],v[48:51]
buffer_store_dwordx4 v[24:27], v7, s[8:11], s3 offen offset:1024 sc1
M v[52:55],a[76:79],a[172:175],v[52:55]
s_nop 0
G v24,a16
G v25,a17
M v[52:55],a[72:75],a[168:171],v[52:55]
G v26,a18
G v27,a19
M v[56:59],a[80:83],a[168:171],v[56:59]
buffer_load_dwordx4 v8, s[52:55], s25 offen lds
M v[56:59],a[84:87],a[172:175],v[56:59]
s_waitcnt lgkmcnt(0)
G v28,a20
G v29,a21
M v[60:63],a[92:95],a[172:175],v[60:63]
s_mov_b32 s25, 2883584
G v30,a22
G v31,a23
M v[60:63],a[88:91],a[168:171],v[60:63]
SA m0,s4,143360
C v24,v24,v25
C v25,v26,v27
M v[64:67],a[32:35],a[160:163],v[64:67]
s_waitcnt vmcnt(17)
R a[168:171],v5,38912
R a[172:175],v6,38912
M v[64:67],a[36:39],a[164:167],v[64:67]
buffer_load_dwordx4 v8, s[52:55], s25 offen lds
M v[68:71],a[44:47],a[164:167],v[68:71]
s_mov_b32 s25, 3145728
C v26,v28,v29
C v27,v30,v31
M v[68:71],a[40:43],a[160:163],v[68:71]
SA m0,s4,147456
buffer_store_dwordx4 v[24:27], v7, s[8:11], s3 offen offset:2048 sc1
M v[72:75],a[48:51],a[160:163],v[72:75]
R a[96:99],v20,0
R a[100:103],v20,2048
M v[72:75],a[52:55],a[164:167],v[72:75]
R a[104:107],v21,0
R a[108:111],v21,2048
M v[76:79],a[60:63],a[164:167],v[76:79]
buffer_load_dwordx4 v8, s[52:55], s25 offen lds
M v[76:79],a[56:59],a[160:163],v[76:79]
s_mov_b32 s25, 3407872
G v24,a24
G v25,a25
M v[80:83],a[64:67],a[160:163],v[80:83]
SA m0,s4,151552
G v26,a26
G v27,a27
M v[80:83],a[68:71],a[164:167],v[80:83]
buffer_load_dwordx4 v8, s[52:55], s25 offen lds
M v[84:87],a[76:79],a[164:167],v[84:87]
G v28,a28
G v29,a29
M v[84:87],a[72:75],a[160:163],v[84:87]
G v30,a30
G v31,a31
M v[88:91],a[80:83],a[160:163],v[88:91]
C v24,v24,v25
C v25,v26,v27
M v[88:91],a[84:87],a[164:167],v[88:91]
s_waitcnt lgkmcnt(4)
C v26,v28,v29
C v27,v30,v31
M v[92:95],a[92:95],a[164:167],v[92:95]
s_waitcnt lgkmcnt(0)
buffer_store_dwordx4 v[24:27], v7, s[8:11], s3 offen offset:3072 sc1
M v[92:95],a[88:91],a[160:163],v[92:95]
s_barrier
M v[96:99],a[32:35],a[168:171],v[96:99]
R a[160:163],v5,49152
R a[164:167],v6,49152
M v[96:99],a[36:39],a[172:175],v[96:99]
s_mov_b32 s25, 128
C v64,v64,v65
C v65,v66,v67
M v[100:103],a[44:47],a[172:175],v[100:103]
SA m0,s4,49152
C v66,v68,v69
C v67,v70,v71
M v[100:103],a[40:43],a[168:171],v[100:103]
s_waitcnt vmcnt(18)
buffer_load_dwordx4 v8, s[52:55], s25 offen lds
M v[104:107],a[48:51],a[168:171],v[104:107]
C v72,v72,v73
C v73,v74,v75
M v[104:107],a[52:55],a[172:175],v[104:107]
C v74,v76,v77
C v75,v78,v79
M v[108:111],a[60:63],a[172:175],v[108:111]
C v32,v32,v33
C v33,v34,v35
M v[108:111],a[56:59],a[168:171],v[108:111]
C v34,v36,v37
C v35,v38,v39
M v[112:115],a[64:67],a[168:171],v[112:115]
SA s3,s93,8192
buffer_store_dwordx4 v[32:35], v7, s[8:11], s3 offen offset:0 sc1
M v[112:115],a[68:71],a[172:175],v[112:115]
s_mov_b32 s25, 262272
C v80,v80,v81
C v81,v82,v83
M v[116:119],a[76:79],a[172:175],v[116:119]
SA m0,s4,53248
C v82,v84,v85
C v83,v86,v87
M v[116:119],a[72:75],a[168:171],v[116:119]
R a[112:115],v20,32768
R a[116:119],v20,34816
M v[120:123],a[80:83],a[168:171],v[120:123]
buffer_load_dwordx4 v8, s[52:55], s25 offen lds
M v[120:123],a[84:87],a[172:175],v[120:123]
s_waitcnt lgkmcnt(2)
R a[120:123],v21,32768
R a[124:127],v21,34816
M v[124:127],a[92:95],a[172:175],v[124:127]
C v88,v88,v89
C v89,v90,v91
M v[124:127],a[88:91],a[168:171],v[124:127]
C v90,v92,v93
C v91,v94,v95
M v[128:131],a[32:35],a[160:163],v[128:131]
R a[168:171],v5,51200
R a[172:175],v6,51200
M v[128:131],a[36:39],a[164:167],v[128:131]
C v40,v40,v41
C v41,v42,v43
M v[132:135],a[44:47],a[164:167],v[132:135]
C v42,v44,v45
C v43,v46,v47
M v[132:135],a[40:43],a[160:163],v[132:135]
s_mov_b32 s25, 524416
buffer_store_dwordx4 v[40:43], v7, s[8:11], s3 offen offset:1024 sc1
M v[136:139],a[48:51],a[160:163],v[136:139]
SA m0,s4,57344
C v96,v96,v97
C v97,v98,v99
M v[136:139],a[52:55],a[164:167],v[136:139]
C v98,v100,v101
C v99,v102,v103
M v[140:143],a[60:63],a[164:167],v[140:143]
C v104,v104,v105
C v105,v106,v107
M v[140:143],a[56:59],a[160:163],v[140:143]
buffer_load_dwordx4 v8, s[52:55], s25 offen lds
M v[144:147],a[64:67],a[160:163],v[144:147]
C v106,v108,v109
C v107,v110,v111
M v[144:147],a[68:71],a[164:167],v[144:147]
C v112,v112,v113
C v113,v114,v115
M v[148:151],a[76:79],a[164:167],v[148:151]
C v114,v116,v117
C v115,v118,v119
M v[148:151],a[72:75],a[160:163],v[148:151]
C v48,v48,v49
C v49,v50,v51
M v[152:155],a[80:83],a[160:163],v[152:155]
C v50,v52,v53
C v51,v54,v55
M v[152:155],a[84:87],a[164:167],v[152:155]
s_waitcnt lgkmcnt(0)
buffer_store_dwordx4 v[48:51], v7, s[8:11], s3 offen offset:2048 sc1
M v[156:159],a[92:95],a[164:167],v[156:159]
s_mov_b32 s25, 786560
C v120,v120,v121
C v121,v122,v123
M v[156:159],a[88:91],a[160:163],v[156:159]
SA m0,s4,61440
C v122,v124,v125
C v123,v126,v127
M v[160:163],a[32:35],a[168:171],v[160:163]
R a[160:163],v5,53248
R a[164:167],v6,53248
M v[160:163],a[36:39],a[172:175],v[160:163]
buffer_load_dwordx4 v8, s[52:55], s25 offen lds
M v[164:167],a[44:47],a[172:175],v[164:167]
C v128,v128,v129
C v129,v130,v131
M v[164:167],a[40:43],a[168:171],v[164:167]
C v130,v132,v133
C v131,v134,v135
M v[168:171],a[48:51],a[168:171],v[168:171]
C v56,v56,v57
C v57,v58,v59
M v[168:171],a[52:55],a[172:175],v[168:171]
C v58,v60,v61
C v59,v62,v63
M v[172:175],a[60:63],a[172:175],v[172:175]
buffer_store_dwordx4 v[56:59], v7, s[8:11], s3 offen offset:3072 sc1
M v[172:175],a[56:59],a[168:171],v[172:175]
C v136,v136,v137
C v137,v138,v139
M v[176:179],a[64:67],a[168:171],v[176:179]
C v138,v140,v141
C v139,v142,v143
M v[176:179],a[68:71],a[172:175],v[176:179]
C v144,v144,v145
C v145,v146,v147
M v[180:183],a[76:79],a[172:175],v[180:183]
C v146,v148,v149
C v147,v150,v151
M v[180:183],a[72:75],a[168:171],v[180:183]
C v152,v152,v153
C v153,v154,v155
M v[184:187],a[80:83],a[168:171],v[184:187]
C v154,v156,v157
C v155,v158,v159
M v[184:187],a[84:87],a[172:175],v[184:187]
s_waitcnt lgkmcnt(0)
C v160,v160,v161
C v161,v162,v163
M v[188:191],a[92:95],a[172:175],v[188:191]
C v162,v164,v165
C v163,v166,v167
M v[188:191],a[88:91],a[168:171],v[188:191]
C v168,v168,v169
C v169,v170,v171
M v[192:195],a[32:35],a[160:163],v[192:195]
s_waitcnt vmcnt(18)
R a[168:171],v5,55296
R a[172:175],v6,55296
M v[192:195],a[36:39],a[164:167],v[192:195]
C v170,v172,v173
C v171,v174,v175
M v[196:199],a[44:47],a[164:167],v[196:199]
C v176,v176,v177
C v177,v178,v179
M v[196:199],a[40:43],a[160:163],v[196:199]
C v178,v180,v181
C v179,v182,v183
M v[200:203],a[48:51],a[160:163],v[200:203]
R a[128:131],v20,49152
R a[132:135],v20,51200
M v[200:203],a[52:55],a[164:167],v[200:203]
R a[136:139],v21,49152
R a[140:143],v21,51200
M v[204:207],a[60:63],a[164:167],v[204:207]
C v184,v184,v185
C v185,v186,v187
M v[204:207],a[56:59],a[160:163],v[204:207]
C v186,v188,v189
C v187,v190,v191
M v[208:211],a[64:67],a[160:163],v[208:211]
C v192,v192,v193
C v193,v194,v195
M v[208:211],a[68:71],a[164:167],v[208:211]
C v194,v196,v197
C v195,v198,v199
M v[212:215],a[76:79],a[164:167],v[212:215]
M v[212:215],a[72:75],a[160:163],v[212:215]
C v200,v200,v201
C v201,v202,v203
M v[216:219],a[80:83],a[160:163],v[216:219]
C v202,v204,v205
C v203,v206,v207
M v[216:219],a[84:87],a[164:167],v[216:219]
s_waitcnt lgkmcnt(4)
M v[220:223],a[92:95],a[164:167],v[220:223]
s_waitcnt vmcnt(9) lgkmcnt(0)
M v[220:223],a[88:91],a[160:163],v[220:223]
s_barrier
M v[224:227],a[32:35],a[168:171],v[224:227]
s_nop 0
T v[32:33],v16,0
T v[34:35],v16,2048
M v[224:227],a[36:39],a[172:175],v[224:227]
C v208,v208,v209
C v209,v210,v211
M v[228:231],a[44:47],a[172:175],v[228:231]
T v[36:37],v16,4096
T v[38:39],v16,6144
M v[228:231],a[40:43],a[168:171],v[228:231]
T v[40:41],v16,8192
T v[42:43],v16,10240
M v[232:235],a[48:51],a[168:171],v[232:235]
C v210,v212,v213
C v211,v214,v215
M v[232:235],a[52:55],a[172:175],v[232:235]
T v[44:45],v16,12288
T v[46:47],v16,14336
M v[236:239],a[60:63],a[172:175],v[236:239]
T v[48:49],v16,16384
T v[50:51],v16,18432
M v[236:239],a[56:59],a[168:171],v[236:239]
C v216,v216,v217
C v217,v218,v219
M v[240:243],a[64:67],a[168:171],v[240:243]
T v[52:53],v16,20480
T v[54:55],v16,22528
M v[240:243],a[68:71],a[172:175],v[240:243]
T v[56:57],v16,24576
T v[58:59],v16,26624
M v[244:247],a[76:79],a[172:175],v[244:247]
C v218,v220,v221
C v219,v222,v223
M v[244:247],a[72:75],a[168:171],v[244:247]
C v224,v224,v225
C v225,v226,v227
M v[248:251],a[80:83],a[168:171],v[248:251]
C v226,v228,v229
C v227,v230,v231
M v[248:251],a[84:87],a[172:175],v[248:251]
C v232,v232,v233
C v233,v234,v235
M v[252:255],a[92:95],a[172:175],v[252:255]
C v234,v236,v237
C v235,v238,v239
M v[252:255],a[88:91],a[168:171],v[252:255]
s_waitcnt lgkmcnt(6)
C v240,v240,v241
C v241,v242,v243
M v[68:71],v[32:35],a[176:179],0
s_mul_i32 s72, s41, 4352
T a[144:145],v17,0
T a[146:147],v17,2048
M v[68:71],v[36:39],a[184:187],v[68:71]
s_mov_b32 s25, 1048704
C v242,v244,v245
C v243,v246,v247
M v[68:71],v[40:43],a[192:195],v[68:71]
s_waitcnt lgkmcnt(2)
T a[148:149],v17,4096
T a[150:151],v17,6144
M v[68:71],v[44:47],a[200:203],v[68:71]
SA m0,s4,98304
T a[152:153],v17,8192
T a[154:155],v17,10240
M v[68:71],v[48:51],a[208:211],v[68:71]
SA s46,s72,104923136
buffer_load_dwordx4 v8, s[52:55], s25 offen lds
M v[68:71],v[52:55],a[216:219],v[68:71]
s_lshl_b32 s45, s42, 7
T a[156:157],v17,12288
T a[158:159],v17,14336
M v[68:71],v[56:59],a[224:227],v[68:71]
s_mov_b32 s25, 1310848
T a[160:161],v17,16384
T a[162:163],v17,18432
M v[76:79],v[56:59],a[228:231],0
SA m0,s4,102400
C v248,v248,v249
C v249,v250,v251
M v[76:79],v[52:55],a[220:223],v[76:79]
SA s45,s45,s46
T a[164:165],v17,20480
T a[166:167],v17,22528
M v[76:79],v[48:51],a[212:215],v[76:79]
s_lshl_b32 s72, s20, 2
T a[168:169],v17,24576
T a[170:171],v17,26624
M v[76:79],v[44:47],a[204:207],v[76:79]
SA s72,s72,s45
buffer_load_dwordx4 v8, s[52:55], s25 offen lds
M v[76:79],v[40:43],a[196:199],v[76:79]
C v250,v252,v253
C v251,v254,v255
M v[76:79],v[36:39],a[188:191],v[76:79]
s_mov_b32 s25, 1572992
v_min_u32 v29, 1, v0
v_lshlrev_b32 v29, 29, v29
M v[76:79],v[32:35],a[180:183],v[76:79]
s_waitcnt lgkmcnt(6)
v_mov_b32 v30, 1
M v[84:87],a[144:147],a[176:179],0
SA m0,s4,106496
T v[32:33],v18,0
T v[34:35],v18,2048
M v[84:87],a[148:151],a[184:187],v[84:87]
buffer_load_dwordx4 v8, s[52:55], s25 offen lds
M v[84:87],a[152:155],a[192:195],v[84:87]
s_waitcnt lgkmcnt(2)
s_nop 0
T v[36:37],v18,4096
T v[38:39],v18,6144
M v[84:87],a[156:159],a[200:203],v[84:87]
s_mov_b32 s25, 1835136
T v[40:41],v18,8192
T v[42:43],v18,10240
M v[84:87],a[160:163],a[208:211],v[84:87]
SA m0,s4,110592
M v[84:87],a[164:167],a[216:219],v[84:87]
s_nop 0
T v[44:45],v18,12288
T v[46:47],v18,14336
M v[84:87],a[168:171],a[224:227],v[84:87]
s_waitcnt vmcnt(3)
T v[48:49],v18,16384
T v[50:51],v18,18432
M v[92:95],a[168:171],a[228:231],0
buffer_load_dwordx4 v8, s[52:55], s25 offen lds
M v[92:95],a[164:167],a[220:223],v[92:95]
s_nop 0
T v[52:53],v18,20480
T v[54:55],v18,22528
M v[92:95],a[160:163],a[212:215],v[92:95]
s_mov_b32 s25, 2097280
T v[56:57],v18,24576
T v[58:59],v18,26624
M v[92:95],a[156:159],a[204:207],v[92:95]
SA m0,s4,114688
buffer_store_dword v30, v29, s[8:11], s72 offen offset:4 sc1
M v[92:95],a[152:155],a[196:199],v[92:95]
SA s3,s93,524288
buffer_load_dwordx4 v8, s[52:55], s25 offen lds
M v[92:95],a[148:151],a[188:191],v[92:95]
v_add_u32 v20, 0x10000, v16
v_add_u32 v21, 0x10000, v17
M v[92:95],a[144:147],a[180:183],v[92:95]
s_waitcnt lgkmcnt(6)
buffer_store_dwordx4 v[64:67], v7, s[8:11], s3 offen offset:0 sc1
M v[100:103],v[32:35],a[176:179],0
s_mov_b32 s25, 2359424
T a[144:145],v19,0
T a[146:147],v19,2048
L_w_kv08:
s_cbranch_execz L_wd1
M v[100:103],v[36:39],a[184:187],v[100:103]
SA m0,s4,118784
buffer_store_dwordx4 v[72:75], v7, s[8:11], s3 offen offset:1024 sc1
M v[100:103],v[40:43],a[192:195],v[100:103]
s_waitcnt lgkmcnt(2)
s_nop 0
T a[148:149],v19,4096
T a[150:151],v19,6144
M v[100:103],v[44:47],a[200:203],v[100:103]
T a[152:153],v19,8192
T a[154:155],v19,10240
M v[100:103],v[48:51],a[208:211],v[100:103]
buffer_load_dwordx4 v8, s[52:55], s25 offen lds
M v[100:103],v[52:55],a[216:219],v[100:103]
s_nop 0
T a[156:157],v19,12288
T a[158:159],v19,14336
M v[100:103],v[56:59],a[224:227],v[100:103]
s_mov_b32 s25, 2621568
T a[160:161],v19,16384
T a[162:163],v19,18432
M v[108:111],v[56:59],a[228:231],0
SA m0,s4,122880
buffer_store_dwordx4 v[80:83], v7, s[8:11], s3 offen offset:2048 sc1
M v[108:111],v[52:55],a[220:223],v[108:111]
s_nop 0
T a[164:165],v19,20480
T a[166:167],v19,22528
M v[108:111],v[48:51],a[212:215],v[108:111]
T a[168:169],v19,24576
T a[170:171],v19,26624
M v[108:111],v[44:47],a[204:207],v[108:111]
buffer_load_dwordx4 v8, s[52:55], s25 offen lds
M v[108:111],v[40:43],a[196:199],v[108:111]
v_add_u32 v22, 0x10000, v18
v_add_u32 v23, 0x10000, v19
M v[108:111],v[36:39],a[188:191],v[108:111]
s_mov_b32 s25, 2883712
buffer_store_dwordx4 v[88:91], v7, s[8:11], s3 offen offset:3072 sc1
M v[108:111],v[32:35],a[180:183],v[108:111]
s_waitcnt lgkmcnt(6)
v_or_b32 v1, s20, v0
v_min_u32 v1, 1, v1
M v[116:119],a[144:147],a[176:179],0
SA m0,s4,126976
T v[32:33],v16,28672
T v[34:35],v16,30720
M v[116:119],a[148:151],a[184:187],v[116:119]
buffer_load_dwordx4 v8, s[52:55], s25 offen lds
M v[116:119],a[152:155],a[192:195],v[116:119]
s_waitcnt lgkmcnt(2)
s_nop 0
T v[36:37],v12,0
T v[38:39],v12,2048
M v[116:119],a[156:159],a[200:203],v[116:119]
s_mov_b32 s25, 3145856
T v[40:41],v12,4096
T v[42:43],v12,6144
M v[116:119],a[160:163],a[208:211],v[116:119]
SA m0,s4,32768
v_lshlrev_b32 v1, 29, v1
M v[116:119],a[164:167],a[216:219],v[116:119]
s_nop 0
T v[44:45],v12,8192
T v[46:47],v12,10240
M v[116:119],a[168:171],a[224:227],v[116:119]
T v[48:49],v12,12288
T v[50:51],v12,14336
M v[124:127],a[168:171],a[228:231],0
buffer_load_dwordx4 v8, s[52:55], s25 offen lds
M v[124:127],a[164:167],a[220:223],v[124:127]
s_nop 0
T v[52:53],v12,16384
T v[54:55],v12,18432
M v[124:127],a[160:163],a[212:215],v[124:127]
s_mov_b32 s25, 3408000
T v[56:57],v12,20480
T v[58:59],v12,22528
M v[124:127],a[156:159],a[204:207],v[124:127]
SA m0,s4,36864
v_min_u32 v9, 15, v0
v_lshlrev_b32 v9, 7, v9
M v[124:127],a[152:155],a[196:199],v[124:127]
s_sub_u32 s66, 15, s42
buffer_load_dwordx4 v8, s[52:55], s25 offen lds
M v[124:127],a[148:151],a[188:191],v[124:127]
s_max_u32 s67, s66, s42
M v[124:127],a[144:147],a[180:183],v[124:127]
s_waitcnt lgkmcnt(6)
M v[68:71],v[32:35],a[232:235],v[68:71]
s_mov_b32 s25, 256
T a[144:145],v17,28672
T a[146:147],v17,30720
M v[68:71],v[36:39],a[96:99],v[68:71]
SA m0,s4,65536
M v[68:71],v[40:43],a[104:107],v[68:71]
s_waitcnt lgkmcnt(2)
s_nop 0
T a[148:149],v13,0
T a[150:151],v13,2048
M v[68:71],v[44:47],a[112:115],v[68:71]
s_min_u32 s66, s66, s42
T a[152:153],v13,4096
T a[154:155],v13,6144
M v[68:71],v[48:51],a[120:123],v[68:71]
s_mul_i32 s21, s41, 1048576
buffer_load_dwordx4 v8, s[52:55], s25 offen lds
M v[68:71],v[52:55],a[128:131],v[68:71]
s_lshl_b32 s64, s67, 16
T a[156:157],v13,8192
T a[158:159],v13,10240
M v[68:71],v[56:59],a[136:139],v[68:71]
s_mov_b32 s25, 262400
T a[160:161],v13,12288
T a[162:163],v13,14336
M v[76:79],v[56:59],a[140:143],v[76:79]
SA m0,s4,69632
M v[76:79],v[52:55],a[132:135],v[76:79]
SA s32,s21,s64
T a[164:165],v13,16384
T a[166:167],v13,18432
M v[76:79],v[48:51],a[124:127],v[76:79]
s_lshl_b32 s64, s20, 14
T a[168:169],v13,20480
T a[170:171],v13,22528
M v[76:79],v[44:47],a[116:119],v[76:79]
SA s32,s32,s64
buffer_load_dwordx4 v8, s[52:55], s25 offen lds
M v[76:79],v[40:43],a[108:111],v[76:79]
SA s32,s32,33554432
M v[76:79],v[36:39],a[100:103],v[76:79]
s_mov_b32 s25, 524544
M v[76:79],v[32:35],a[236:239],v[76:79]
s_waitcnt lgkmcnt(6)
M v[84:87],a[144:147],a[232:235],v[84:87]
SA m0,s4,73728
T v[32:33],v18,28672
T v[34:35],v18,30720
M v[84:87],a[148:151],a[96:99],v[84:87]
s_sub_u32 s64, s42, 10
buffer_load_dwordx4 v8, s[52:55], s25 offen lds
M v[84:87],a[152:155],a[104:107],v[84:87]
s_waitcnt lgkmcnt(2)
s_nop 0
T v[36:37],v14,0
T v[38:39],v14,2048
M v[84:87],a[156:159],a[112:115],v[84:87]
s_mov_b32 s25, 786688
T v[40:41],v14,4096
T v[42:43],v14,6144
M v[84:87],a[160:163],a[120:123],v[84:87]
SA m0,s4,77824
M v[84:87],a[164:167],a[128:131],v[84:87]
s_and_b32 s35, s64, 536870912
T v[44:45],v14,8192
T v[46:47],v14,10240
M v[84:87],a[168:171],a[136:139],v[84:87]
T v[48:49],v14,12288
T v[50:51],v14,14336
M v[92:95],a[168:171],a[140:143],v[92:95]
buffer_load_dwordx4 v8, s[52:55], s25 offen lds
M v[92:95],a[164:167],a[132:135],v[92:95]
s_nop 0
T v[52:53],v14,16384
T v[54:55],v14,18432
M v[92:95],a[160:163],a[124:127],v[92:95]
s_mov_b32 s25, 1048832
T v[56:57],v14,20480
T v[58:59],v14,22528
M v[92:95],a[156:159],a[116:119],v[92:95]
SA m0,s4,81920
v_or_b32 v6, s35, v7
MF v68,s5,v68
M v[92:95],a[152:155],a[108:111],v[92:95]
s_lshl_b32 s28, s20, 13
buffer_load_dwordx4 v8, s[52:55], s25 offen lds
M v[92:95],a[148:151],a[100:103],v[92:95]
v_add_u32 v2, 0x10000, v7
v_add_u32 v3, s28, v7
M v[92:95],a[144:147],a[236:239],v[92:95]
s_waitcnt lgkmcnt(6)
v_add_u32 v4, 0x1000, v3
MF v69,s5,v69
M v[100:103],v[32:35],a[232:235],v[100:103]
s_mov_b32 s25, 1310976
T a[144:145],v19,28672
T a[146:147],v19,30720
M v[100:103],v[36:39],a[96:99],v[100:103]
SA m0,s4,86016
MF v70,s5,v70
MF v71,s5,v71
M v[100:103],v[40:43],a[104:107],v[100:103]
s_waitcnt lgkmcnt(2)
T a[148:149],v15,0
T a[150:151],v15,2048
M v[100:103],v[44:47],a[112:115],v[100:103]
s_lshl_b32 s64, s42, 16
T a[152:153],v15,4096
T a[154:155],v15,6144
M v[100:103],v[48:51],a[120:123],v[100:103]
SA s23,s21,s64
buffer_load_dwordx4 v8, s[52:55], s25 offen lds
M v[100:103],v[52:55],a[128:131],v[100:103]
SA s43,s23,16777216
T a[156:157],v15,8192
T a[158:159],v15,10240
M v[100:103],v[56:59],a[136:139],v[100:103]
s_mov_b32 s25, 1573120
T a[160:161],v15,12288
T a[162:163],v15,14336
M v[108:111],v[56:59],a[140:143],v[108:111]
SA m0,s4,90112
MF v84,s5,v84
MF v85,s5,v85
M v[108:111],v[52:55],a[132:135],v[108:111]
SA s26,s21,16777216
T a[164:165],v15,16384
T a[166:167],v15,18432
M v[108:111],v[48:51],a[124:127],v[108:111]
s_mov_b32 s22, 0x7fff
T a[168:169],v15,20480
T a[170:171],v15,22528
M v[108:111],v[44:47],a[116:119],v[108:111]
s_sub_u32 s27, s42, 1
buffer_load_dwordx4 v8, s[52:55], s25 offen lds
M v[108:111],v[40:43],a[108:111],v[108:111]
s_cmp_eq_u32 s42, 0
MF v86,s5,v86
MF v87,s5,v87
M v[108:111],v[36:39],a[100:103],v[108:111]
s_waitcnt vmcnt(7) lgkmcnt(0)
C v68,v68,v69
C v69,v70,v71
M v[108:111],v[32:35],a[236:239],v[108:111]
s_barrier
M v[116:119],a[144:147],a[232:235],v[116:119]
s_mov_b32 s25, 1835264
T v[32:33],v16,49152
T v[34:35],v16,51200
M v[116:119],a[148:151],a[96:99],v[116:119]
s_cselect_b32 s64, 32768, 0
C v70,v84,v85
C v71,v86,v87
M v[116:119],a[152:155],a[104:107],v[116:119]
SA m0,s4,94208
T v[36:37],v16,53248
T v[38:39],v16,55296
M v[116:119],a[156:159],a[112:115],v[116:119]
SA s26,s26,s64
T v[40:41],v16,57344
T v[42:43],v16,59392
M v[116:119],a[160:163],a[120:123],v[116:119]
s_mov_b32 s31, 0x4b800000
buffer_load_dwordx4 v8, s[52:55], s25 offen lds
M v[116:119],a[164:167],a[128:131],v[116:119]
s_mov_b32 s24, 0x33800000
T v[44:45],v16,61440
T v[46:47],v16,63488
M v[116:119],a[168:171],a[136:139],v[116:119]
s_mov_b32 s25, 2097408
T v[48:49],v20,32768
T v[50:51],v20,34816
M v[124:127],a[168:171],a[140:143],v[124:127]
SA m0,s4,155648
W a0,v68
W a1,v69
M v[124:127],a[164:167],a[132:135],v[124:127]
s_lshl_b32 s47, s66, 7
T v[52:53],v20,36864
T v[54:55],v20,38912
M v[124:127],a[160:163],a[124:127],v[124:127]
SA s47,s47,s46
T v[56:57],v20,40960
T v[58:59],v20,43008
M v[124:127],a[156:159],a[116:119],v[124:127]
s_lshl_b32 s64, s20, 5
buffer_load_dwordx4 v8, s[52:55], s25 offen lds
M v[124:127],a[152:155],a[108:111],v[124:127]
SA s47,s47,s64
W a2,v70
W a3,v71
M v[124:127],a[148:151],a[100:103],v[124:127]
SA s47,s47,2048
MF v76,s5,v76
MF v77,s5,v77
M v[124:127],a[144:147],a[236:239],v[124:127]
s_waitcnt lgkmcnt(6)
MF v78,s5,v78
MF v79,s5,v79
M v[132:135],v[32:35],a[176:179],0
s_lshl_b32 s65, s41, 3
T a[144:145],v17,49152
T a[146:147],v17,51200
M v[132:135],v[36:39],a[184:187],v[132:135]
SA s65,s65,s66
MF v92,s5,v92
MF v93,s5,v93
M v[132:135],v[40:43],a[192:195],v[132:135]
s_waitcnt lgkmcnt(2)
T a[148:149],v17,53248
T a[150:151],v17,55296
M v[132:135],v[44:47],a[200:203],v[132:135]
s_mul_i32 s34, s65, 73728
T a[152:153],v17,57344
T a[154:155],v17,59392
M v[132:135],v[48:51],a[208:211],v[132:135]
SA s34,s34,136314880
MF v94,s5,v94
MF v95,s5,v95
M v[132:135],v[52:55],a[216:219],v[132:135]
s_lshl_b32 s65, s42, 4
T a[156:157],v17,61440
T a[158:159],v17,63488
M v[132:135],v[56:59],a[224:227],v[132:135]
SA s65,s65,s41
T a[160:161],v21,32768
T a[162:163],v21,34816
M v[140:143],v[56:59],a[228:231],0
s_mul_i32 s33, s65, 114688
C v76,v76,v77
C v77,v78,v79
M v[140:143],v[52:55],a[220:223],v[140:143]
s_mul_i32 s65, s20, 28672
T a[164:165],v21,36864
T a[166:167],v21,38912
M v[140:143],v[48:51],a[212:215],v[140:143]
SA s33,s33,s65
T a[168:169],v21,40960
T a[170:171],v21,43008
M v[140:143],v[44:47],a[204:207],v[140:143]
SA s33,s33,67108864
C v78,v92,v93
C v79,v94,v95
M v[140:143],v[40:43],a[196:199],v[140:143]
s_mov_b32 s6, 0
W a32,v76
W a33,v77
M v[140:143],v[36:39],a[188:191],v[140:143]
s_mov_b32 s7, 0
W a34,v78
W a35,v79
M v[140:143],v[32:35],a[180:183],v[140:143]
s_waitcnt lgkmcnt(6)
MF v100,s5,v100
MF v101,s5,v101
M v[148:151],a[144:147],a[176:179],0
s_mov_b32 s40, 1
T v[32:33],v18,49152
T v[34:35],v18,51200
M v[148:151],a[148:151],a[184:187],v[148:151]
s_cmp_eq_u32 s20, 0
MF v102,s5,v102
MF v103,s5,v103
M v[148:151],a[152:155],a[192:195],v[148:151]
s_waitcnt lgkmcnt(2)
T v[36:37],v18,53248
T v[38:39],v18,55296
M v[148:151],a[156:159],a[200:203],v[148:151]
s_cselect_b32 s39, 7, 4
T v[40:41],v18,57344
T v[42:43],v18,59392
M v[148:151],a[160:163],a[208:211],v[148:151]
s_lshl_b32 s64, s41, 1
MF v116,s5,v116
MF v117,s5,v117
M v[148:151],a[164:167],a[216:219],v[148:151]
SA s64,s64,s20
T v[44:45],v18,61440
T v[46:47],v18,63488
M v[148:151],a[168:171],a[224:227],v[148:151]
s_cmp_lt_u32 s64, 30
T v[48:49],v22,32768
T v[50:51],v22,34816
M v[156:159],a[168:171],a[228:231],0
s_cselect_b32 s64, 32798, 0
MF v118,s5,v118
MF v119,s5,v119
M v[156:159],a[164:167],a[220:223],v[156:159]
s_cmp_ge_u32 s20, 2
T v[52:53],v22,36864
T v[54:55],v22,38912
M v[156:159],a[160:163],a[212:215],v[156:159]
s_cselect_b32 s64, s64, 0
T v[56:57],v22,40960
T v[58:59],v22,43008
M v[156:159],a[156:159],a[204:207],v[156:159]
s_cmp_eq_u32 s42, 6
C v100,v100,v101
C v101,v102,v103
M v[156:159],a[152:155],a[196:199],v[156:159]
s_cselect_b32 s64, s64, 0
C v102,v116,v117
C v103,v118,v119
M v[156:159],a[148:151],a[188:191],v[156:159]
s_or_b32 s39, s39, s64
W a4,v100
W a5,v101
M v[156:159],a[144:147],a[180:183],v[156:159]
s_waitcnt lgkmcnt(6)
W a6,v102
W a7,v103
M v[164:167],v[32:35],a[176:179],0
s_mov_b64 s[60:61], s[76:77]
T a[144:145],v19,49152
T a[146:147],v19,51200
M v[164:167],v[36:39],a[184:187],v[164:167]
s_mov_b32 s62, s78
MF v108,s5,v108
MF v109,s5,v109
M v[164:167],v[40:43],a[192:195],v[164:167]
s_waitcnt lgkmcnt(2)
T a[148:149],v19,53248
T a[150:151],v19,55296
M v[164:167],v[44:47],a[200:203],v[164:167]
s_mov_b32 s63, 0x20000
T a[152:153],v19,57344
T a[154:155],v19,59392
M v[164:167],v[48:51],a[208:211],v[164:167]
s_mov_b32 s25, 2359552
v_lshrrev_b32 v24, 4, v0
v_lshlrev_b32 v24, 2, v24
M v[164:167],v[52:55],a[216:219],v[164:167]
SA m0,s4,159744
T a[156:157],v19,61440
T a[158:159],v19,63488
M v[164:167],v[56:59],a[224:227],v[164:167]
SA s3,s93,532480
T a[160:161],v23,32768
T a[162:163],v23,34816
M v[172:175],v[56:59],a[228:231],0
buffer_load_dwordx4 v8, s[52:55], s25 offen lds
M v[172:175],v[52:55],a[220:223],v[172:175]
s_nop 0
T a[164:165],v23,36864
T a[166:167],v23,38912
M v[172:175],v[48:51],a[212:215],v[172:175]
s_mov_b32 s25, 2621696
T a[168:169],v23,40960
T a[170:171],v23,43008
M v[172:175],v[44:47],a[204:207],v[172:175]
SA m0,s4,131072
buffer_store_dwordx4 v[96:99], v7, s[8:11], s3 offen offset:0 sc1
M v[172:175],v[40:43],a[196:199],v[172:175]
v_and_b32 v25, 15, v0
v_sub_u32 v24, v24, v25
M v[172:175],v[36:39],a[188:191],v[172:175]
buffer_load_dwordx4 v8, s[52:55], s25 offen lds
M v[172:175],v[32:35],a[180:183],v[172:175]
s_waitcnt lgkmcnt(6)
v_cmp_lt_i32 s[16:17], 0, v24
v_cmp_lt_i32 s[18:19], -1, v24
M v[180:183],a[144:147],a[176:179],0
s_mov_b32 s25, 2883840
T v[32:33],v20,45056
T v[34:35],v20,47104
M v[180:183],a[148:151],a[184:187],v[180:183]
SA m0,s4,135168
buffer_store_dwordx4 v[104:107], v7, s[8:11], s3 offen offset:1024 sc1
M v[180:183],a[152:155],a[192:195],v[180:183]
s_waitcnt lgkmcnt(2)
s_nop 0
T v[36:37],v20,49152
T v[38:39],v20,51200
M v[180:183],a[156:159],a[200:203],v[180:183]
T v[40:41],v20,53248
T v[42:43],v20,55296
M v[180:183],a[160:163],a[208:211],v[180:183]
buffer_load_dwordx4 v8, s[52:55], s25 offen lds
M v[180:183],a[164:167],a[216:219],v[180:183]
s_nop 0
T v[44:45],v20,57344
T v[46:47],v20,59392
M v[180:183],a[168:171],a[224:227],v[180:183]
s_mov_b32 s25, 3145984
T v[48:49],v20,61440
T v[50:51],v20,63488
M v[188:191],a[168:171],a[228:231],0
SA m0,s4,139264
buffer_store_dwordx4 v[112:115], v7, s[8:11], s3 offen offset:2048 sc1
M v[188:191],a[164:167],a[220:223],v[188:191]
s_nop 0
T v[52:53],v16,32768
T v[54:55],v16,34816
M v[188:191],a[160:163],a[212:215],v[188:191]
T v[56:57],v16,36864
T v[58:59],v16,38912
M v[188:191],a[156:159],a[204:207],v[188:191]
buffer_load_dwordx4 v8, s[52:55], s25 offen lds
M v[188:191],a[152:155],a[196:199],v[188:191]
v_cmp_lt_i32 s[48:49], -2, v24
v_cmp_lt_i32 s[50:51], -3, v24
M v[188:191],a[148:151],a[188:191],v[188:191]
s_mov_b32 s25, 3408128
buffer_store_dwordx4 v[120:123], v7, s[8:11], s3 offen offset:3072 sc1
M v[188:191],a[144:147],a[180:183],v[188:191]
s_waitcnt lgkmcnt(6)
v_lshl_add_u32 v25, v0, 7, s95
v_and_b32 v0, 48, v0
M v[132:135],v[32:35],a[232:235],v[132:135]
SA m0,s4,143360
T a[144:145],v21,45056
T a[146:147],v21,47104
M v[132:135],v[36:39],a[96:99],v[132:135]
buffer_load_dwordx4 v8, s[52:55], s25 offen lds
M v[132:135],v[40:43],a[104:107],v[132:135]
s_waitcnt lgkmcnt(2)
s_nop 0
T a[148:149],v21,49152
T a[150:151],v21,51200
M v[132:135],v[44:47],a[112:115],v[132:135]
s_mov_b32 s25, 384
T a[152:153],v21,53248
T a[154:155],v21,55296
M v[132:135],v[48:51],a[120:123],v[132:135]
SA m0,s4,0
v_lshl_add_u32 v0, v0, 24, v25
v_mov_b32 v24, 0x3f80
M v[132:135],v[52:55],a[128:131],v[132:135]
T a[156:157],v21,57344
T a[158:159],v21,59392
M v[132:135],v[56:59],a[136:139],v[132:135]
T a[160:161],v21,61440
T a[162:163],v21,63488
M v[140:143],v[56:59],a[140:143],v[140:143]
buffer_load_dwordx4 v8, s[52:55], s25 offen lds
M v[140:143],v[52:55],a[132:135],v[140:143]
s_nop 0
T a[164:165],v17,32768
T a[166:167],v17,34816
M v[140:143],v[48:51],a[124:127],v[140:143]
s_mov_b32 s25, 262528
T a[168:169],v17,36864
T a[170:171],v17,38912
M v[140:143],v[44:47],a[116:119],v[140:143]
SA m0,s4,4096
MF v110,s5,v110
MF v111,s5,v111
M v[140:143],v[40:43],a[108:111],v[140:143]
buffer_load_dwordx4 v8, s[52:55], s25 offen lds
M v[140:143],v[36:39],a[100:103],v[140:143]
MF v124,s5,v124
MF v125,s5,v125
M v[140:143],v[32:35],a[236:239],v[140:143]
s_waitcnt lgkmcnt(6)
MF v126,s5,v126
MF v127,s5,v127
M v[148:151],a[144:147],a[232:235],v[148:151]
s_mov_b32 s25, 524672
T v[32:33],v22,45056
T v[34:35],v22,47104
M v[148:151],a[148:151],a[96:99],v[148:151]
SA m0,s4,8192
C v108,v108,v109
C v109,v110,v111
M v[148:151],a[152:155],a[104:107],v[148:151]
s_waitcnt lgkmcnt(2)
T v[36:37],v22,49152
T v[38:39],v22,51200
M v[148:151],a[156:159],a[112:115],v[148:151]
T v[40:41],v22,53248
T v[42:43],v22,55296
M v[148:151],a[160:163],a[120:123],v[148:151]
buffer_load_dwordx4 v8, s[52:55], s25 offen lds
M v[148:151],a[164:167],a[128:131],v[148:151]
s_nop 0
T v[44:45],v22,57344
T v[46:47],v22,59392
M v[148:151],a[168:171],a[136:139],v[148:151]
s_mov_b32 s25, 786816
T v[48:49],v22,61440
T v[50:51],v22,63488
M v[156:159],a[168:171],a[140:143],v[156:159]
L_w_kv09:
s_cbranch_execz L_wd1
SA m0,s4,12288
C v110,v124,v125
C v111,v126,v127
M v[156:159],a[164:167],a[132:135],v[156:159]
T v[52:53],v18,32768
T v[54:55],v18,34816
M v[156:159],a[160:163],a[124:127],v[156:159]
T v[56:57],v18,36864
T v[58:59],v18,38912
M v[156:159],a[156:159],a[116:119],v[156:159]
buffer_load_dwordx4 v8, s[52:55], s25 offen lds
M v[156:159],a[152:155],a[108:111],v[156:159]
W a36,v108
W a37,v109
M v[156:159],a[148:151],a[100:103],v[156:159]
s_mov_b32 s25, 1048960
v_lshrrev_b32 v25, 8, v7
v_bfe_u32 v26, v7, 6, 2
v_and_b32 v27, 16, v7
v_lshlrev_b32 v27, v27, v24
v_cmp_eq_u32 vcc, v25, v26
v_and_b32 v28, 32, v7
W a244,0
v_cndmask_b32 v27, 0, v27, vcc
v_cmp_eq_u32 vcc, 0, v28
W a245,0
W a248,0
v_cndmask_b32 v25, 0, v27, vcc
v_sub_u32 v26, v27, v25
W a249,0
W a246,v25
W a247,v26
M v[156:159],a[144:147],a[236:239],v[156:159]
s_waitcnt lgkmcnt(6)
W a38,v110
W a39,v111
M v[164:167],v[32:35],a[232:235],v[164:167]
SA m0,s4,16384
T a[144:145],v23,45056
T a[146:147],v23,47104
M v[164:167],v[36:39],a[96:99],v[164:167]
buffer_load_dwordx4 v8, s[52:55], s25 offen lds
M v[164:167],v[40:43],a[104:107],v[164:167]
s_waitcnt lgkmcnt(2)
s_nop 0
T a[148:149],v23,49152
T a[150:151],v23,51200
M v[164:167],v[44:47],a[112:115],v[164:167]
s_mov_b32 s25, 1311104
T a[152:153],v23,53248
T a[154:155],v23,55296
M v[164:167],v[48:51],a[120:123],v[164:167]
SA m0,s4,20480
MF v132,s5,v132
MF v133,s5,v133
M v[164:167],v[52:55],a[128:131],v[164:167]
T a[156:157],v23,57344
T a[158:159],v23,59392
M v[164:167],v[56:59],a[136:139],v[164:167]
T a[160:161],v23,61440
T a[162:163],v23,63488
M v[172:175],v[56:59],a[140:143],v[172:175]
buffer_load_dwordx4 v8, s[52:55], s25 offen lds
M v[172:175],v[52:55],a[132:135],v[172:175]
s_nop 0
T a[164:165],v19,32768
T a[166:167],v19,34816
M v[172:175],v[48:51],a[124:127],v[172:175]
s_mov_b32 s25, 1573248
T a[168:169],v19,36864
T a[170:171],v19,38912
M v[172:175],v[44:47],a[116:119],v[172:175]
SA m0,s4,24576
MF v134,s5,v134
MF v135,s5,v135
M v[172:175],v[40:43],a[108:111],v[172:175]
buffer_load_dwordx4 v8, s[52:55], s25 offen lds
M v[172:175],v[36:39],a[100:103],v[172:175]
s_waitcnt vmcnt(7) lgkmcnt(0)
MF v148,s5,v148
MF v149,s5,v149
M v[172:175],v[32:35],a[236:239],v[172:175]
s_barrier
M v[180:183],a[144:147],a[232:235],v[180:183]
s_mov_b32 s25, 1835392
T v[32:33],v20,0
T v[34:35],v20,2048
M v[180:183],a[148:151],a[96:99],v[180:183]
SA m0,s4,28672
MF v150,s5,v150
MF v151,s5,v151
M v[180:183],a[152:155],a[104:107],v[180:183]
T v[36:37],v20,4096
T v[38:39],v20,6144
M v[180:183],a[156:159],a[112:115],v[180:183]
T v[40:41],v20,8192
T v[42:43],v20,10240
M v[180:183],a[160:163],a[120:123],v[180:183]
buffer_load_dwordx4 v8, s[52:55], s25 offen lds
M v[180:183],a[164:167],a[128:131],v[180:183]
s_nop 0
T v[44:45],v20,12288
T v[46:47],v20,14336
M v[180:183],a[168:171],a[136:139],v[180:183]
s_mov_b32 s25, 2097536
T v[48:49],v20,16384
T v[50:51],v20,18432
M v[188:191],a[168:171],a[140:143],v[188:191]
SA m0,s4,40960
C v132,v132,v133
C v133,v134,v135
M v[188:191],a[164:167],a[132:135],v[188:191]
T v[52:53],v20,20480
T v[54:55],v20,22528
M v[188:191],a[160:163],a[124:127],v[188:191]
T v[56:57],v20,24576
T v[58:59],v20,26624
M v[188:191],a[156:159],a[116:119],v[188:191]
buffer_load_dwordx4 v8, s[52:55], s25 offen lds
M v[188:191],a[152:155],a[108:111],v[188:191]
C v134,v148,v149
C v135,v150,v151
M v[188:191],a[148:151],a[100:103],v[188:191]
s_mov_b32 s25, 2359680
W a8,v132
W a9,v133
M v[188:191],a[144:147],a[236:239],v[188:191]
s_waitcnt lgkmcnt(6)
W a10,v134
W a11,v135
M v[68:71],v[32:35],a[176:179],0
SA m0,s4,45056
T a[144:145],v21,0
T a[146:147],v21,2048
M v[68:71],v[36:39],a[184:187],v[68:71]
buffer_load_dwordx4 v8, s[52:55], s25 offen lds
M v[68:71],v[40:43],a[192:195],v[68:71]
s_waitcnt lgkmcnt(2)
s_nop 0
T a[148:149],v21,4096
T a[150:151],v21,6144
M v[68:71],v[44:47],a[200:203],v[68:71]
s_mov_b32 s25, 2621824
T a[152:153],v21,8192
T a[154:155],v21,10240
M v[68:71],v[48:51],a[208:211],v[68:71]
SA m0,s4,49152
v_lshrrev_b32 v31, 6, v7
v_bfe_u32 v28, v7, 4, 2
M v[68:71],v[52:55],a[216:219],v[68:71]
T a[156:157],v21,12288
T a[158:159],v21,14336
M v[68:71],v[56:59],a[224:227],v[68:71]
T a[160:161],v21,16384
T a[162:163],v21,18432
M v[76:79],v[56:59],a[228:231],0
buffer_load_dwordx4 v8, s[52:55], s25 offen lds
M v[76:79],v[52:55],a[220:223],v[76:79]
s_nop 0
T a[164:165],v21,20480
T a[166:167],v21,22528
M v[76:79],v[48:51],a[212:215],v[76:79]
s_mov_b32 s25, 2883968
T a[168:169],v21,24576
T a[170:171],v21,26624
M v[76:79],v[44:47],a[204:207],v[76:79]
SA m0,s4,53248
v_lshlrev_b32 v31, 5, v31
v_add_lshl_u32 v31, v31, v28, 2
M v[76:79],v[40:43],a[196:199],v[76:79]
SA s3,s93,262144
buffer_load_dword v5, v31, s[8:11], s46 offen offset:4 sc1
M v[76:79],v[36:39],a[188:191],v[76:79]
buffer_load_dwordx4 v8, s[52:55], s25 offen lds
M v[76:79],v[32:35],a[180:183],v[76:79]
s_waitcnt lgkmcnt(6)
MF v140,s5,v140
MF v141,s5,v141
M v[84:87],a[144:147],a[176:179],0
s_mov_b32 s25, 3146112
T v[32:33],v22,0
T v[34:35],v22,2048
M v[84:87],a[148:151],a[184:187],v[84:87]
SA m0,s4,57344
buffer_store_dwordx4 v[128:131], v7, s[8:11], s3 offen offset:0 sc1
M v[84:87],a[152:155],a[192:195],v[84:87]
s_waitcnt lgkmcnt(2)
s_nop 0
T v[36:37],v22,4096
T v[38:39],v22,6144
M v[84:87],a[156:159],a[200:203],v[84:87]
T v[40:41],v22,8192
T v[42:43],v22,10240
M v[84:87],a[160:163],a[208:211],v[84:87]
buffer_load_dwordx4 v8, s[52:55], s25 offen lds
M v[84:87],a[164:167],a[216:219],v[84:87]
s_nop 0
T v[44:45],v22,12288
T v[46:47],v22,14336
M v[84:87],a[168:171],a[224:227],v[84:87]
s_mov_b32 s25, 3408256
T v[48:49],v22,16384
T v[50:51],v22,18432
M v[92:95],a[168:171],a[228:231],0
SA m0,s4,61440
buffer_store_dwordx4 v[136:139], v7, s[8:11], s3 offen offset:1024 sc1
M v[92:95],a[164:167],a[220:223],v[92:95]
s_nop 0
T v[52:53],v22,20480
T v[54:55],v22,22528
M v[92:95],a[160:163],a[212:215],v[92:95]
T v[56:57],v22,24576
T v[58:59],v22,26624
M v[92:95],a[156:159],a[204:207],v[92:95]
buffer_load_dwordx4 v8, s[52:55], s25 offen lds
M v[92:95],a[152:155],a[196:199],v[92:95]
MF v142,s5,v142
MF v143,s5,v143
M v[92:95],a[148:151],a[188:191],v[92:95]
buffer_store_dwordx4 v[144:147], v7, s[8:11], s3 offen offset:2048 sc1
M v[92:95],a[144:147],a[180:183],v[92:95]
s_waitcnt lgkmcnt(6)
MF v156,s5,v156
MF v157,s5,v157
M v[100:103],v[32:35],a[176:179],0
T a[144:145],v23,0
T a[146:147],v23,2048
M v[100:103],v[36:39],a[184:187],v[100:103]
buffer_store_dwordx4 v[152:155], v7, s[8:11], s3 offen offset:3072 sc1
M v[100:103],v[40:43],a[192:195],v[100:103]
s_waitcnt lgkmcnt(2)
s_nop 0
T a[148:149],v23,4096
T a[150:151],v23,6144
M v[100:103],v[44:47],a[200:203],v[100:103]
T a[152:153],v23,8192
T a[154:155],v23,10240
M v[100:103],v[48:51],a[208:211],v[100:103]
MF v158,s5,v158
MF v159,s5,v159
M v[100:103],v[52:55],a[216:219],v[100:103]
T a[156:157],v23,12288
T a[158:159],v23,14336
M v[100:103],v[56:59],a[224:227],v[100:103]
T a[160:161],v23,16384
T a[162:163],v23,18432
M v[108:111],v[56:59],a[228:231],0
C v140,v140,v141
C v141,v142,v143
M v[108:111],v[52:55],a[220:223],v[108:111]
T a[164:165],v23,20480
T a[166:167],v23,22528
M v[108:111],v[48:51],a[212:215],v[108:111]
T a[168:169],v23,24576
T a[170:171],v23,26624
M v[108:111],v[44:47],a[204:207],v[108:111]
C v142,v156,v157
C v143,v158,v159
M v[108:111],v[40:43],a[196:199],v[108:111]
W a40,v140
W a41,v141
M v[108:111],v[36:39],a[188:191],v[108:111]
W a42,v142
W a43,v143
M v[108:111],v[32:35],a[180:183],v[108:111]
s_waitcnt lgkmcnt(6)
v_mov_b32 v8, 0xff800000
MF v164,s5,v164
M v[116:119],a[144:147],a[176:179],0
T v[32:33],v20,28672
T v[34:35],v20,30720
M v[116:119],a[148:151],a[184:187],v[116:119]
MF v165,s5,v165
MF v166,s5,v166
M v[116:119],a[152:155],a[192:195],v[116:119]
s_waitcnt lgkmcnt(2)
T v[36:37],v12,24576
T v[38:39],v12,26624
M v[116:119],a[156:159],a[200:203],v[116:119]
T v[40:41],v12,28672
T v[42:43],v12,30720
M v[116:119],a[160:163],a[208:211],v[116:119]
MF v167,s5,v167
MF v180,s5,v180
M v[116:119],a[164:167],a[216:219],v[116:119]
T v[44:45],v12,0
T v[46:47],v12,2048
M v[116:119],a[168:171],a[224:227],v[116:119]
T v[48:49],v12,4096
T v[50:51],v12,6144
M v[124:127],a[168:171],a[228:231],0
MF v181,s5,v181
MF v182,s5,v182
M v[124:127],a[164:167],a[220:223],v[124:127]
T v[52:53],v12,8192
T v[54:55],v12,10240
M v[124:127],a[160:163],a[212:215],v[124:127]
T v[56:57],v12,12288
T v[58:59],v12,14336
M v[124:127],a[156:159],a[204:207],v[124:127]
MF v183,s5,v183
C v164,v164,v165
M v[124:127],a[152:155],a[196:199],v[124:127]
C v165,v166,v167
C v166,v180,v181
M v[124:127],a[148:151],a[188:191],v[124:127]
C v167,v182,v183
W a12,v164
M v[124:127],a[144:147],a[180:183],v[124:127]
s_waitcnt lgkmcnt(6)
W a13,v165
W a14,v166
M v[68:71],v[32:35],a[232:235],v[68:71]
T a[144:145],v21,28672
T a[146:147],v21,30720
M v[68:71],v[36:39],a[96:99],v[68:71]
W a15,v167
MF v172,s5,v172
M v[68:71],v[40:43],a[104:107],v[68:71]
s_waitcnt lgkmcnt(2)
T a[148:149],v13,24576
T a[150:151],v13,26624
M v[68:71],v[44:47],a[112:115],v[68:71]
T a[152:153],v13,28672
T a[154:155],v13,30720
M v[68:71],v[48:51],a[120:123],v[68:71]
MF v173,s5,v173
MF v174,s5,v174
M v[68:71],v[52:55],a[128:131],v[68:71]
T a[156:157],v13,0
T a[158:159],v13,2048
M v[68:71],v[56:59],a[136:139],v[68:71]
T a[160:161],v13,4096
T a[162:163],v13,6144
M v[76:79],v[56:59],a[140:143],v[76:79]
MF v175,s5,v175
MF v188,s5,v188
M v[76:79],v[52:55],a[132:135],v[76:79]
T a[164:165],v13,8192
T a[166:167],v13,10240
M v[76:79],v[48:51],a[124:127],v[76:79]
T a[168:169],v13,12288
T a[170:171],v13,14336
M v[76:79],v[44:47],a[116:119],v[76:79]
MF v189,s5,v189
MF v190,s5,v190
M v[76:79],v[40:43],a[108:111],v[76:79]
MF v191,s5,v191
C v172,v172,v173
M v[76:79],v[36:39],a[100:103],v[76:79]
C v173,v174,v175
C v174,v188,v189
M v[76:79],v[32:35],a[236:239],v[76:79]
s_waitcnt lgkmcnt(6)
C v175,v190,v191
W a44,v172
M v[84:87],a[144:147],a[232:235],v[84:87]
T v[32:33],v22,28672
T v[34:35],v22,30720
M v[84:87],a[148:151],a[96:99],v[84:87]
W a45,v173
W a46,v174
M v[84:87],a[152:155],a[104:107],v[84:87]
s_waitcnt lgkmcnt(2)
T v[36:37],v14,24576
T v[38:39],v14,26624
M v[84:87],a[156:159],a[112:115],v[84:87]
T v[40:41],v14,28672
T v[42:43],v14,30720
M v[84:87],a[160:163],a[120:123],v[84:87]
W a47,v175
s_waitcnt vmcnt(7)
v_cmp_ne_u32 vcc, 1, v5
M v[84:87],a[164:167],a[128:131],v[84:87]
s_nop 0
T v[44:45],v14,0
T v[46:47],v14,2048
M v[84:87],a[168:171],a[136:139],v[84:87]
s_cmp_lg_u32 vcc_lo, 0
T v[48:49],v14,4096
T v[50:51],v14,6144
M v[92:95],a[168:171],a[140:143],v[92:95]
s_cbranch_scc1 L_wsq0
L_wrq0:
M v[92:95],a[164:167],a[132:135],v[92:95]
SA m0,s28,98304
T v[52:53],v14,8192
T v[54:55],v14,10240
M v[92:95],a[160:163],a[124:127],v[92:95]
T v[56:57],v14,12288
T v[58:59],v14,14336
M v[92:95],a[156:159],a[116:119],v[92:95]
buffer_load_dwordx4 v3, s[8:11], s21 offen offset:0 sc1 lds
M v[92:95],a[152:155],a[108:111],v[92:95]
MF v68,s5,v68
MF v69,s5,v69
M v[92:95],a[148:151],a[100:103],v[92:95]
buffer_load_dwordx4 v3, s[8:11], s21 offen offset:1024 sc1 lds
M v[92:95],a[144:147],a[236:239],v[92:95]
s_waitcnt lgkmcnt(6)
MF v70,s5,v70
MF v71,s5,v71
M v[100:103],v[32:35],a[232:235],v[100:103]
T a[144:145],v23,28672
T a[146:147],v23,30720
M v[100:103],v[36:39],a[96:99],v[100:103]
buffer_load_dwordx4 v3, s[8:11], s21 offen offset:2048 sc1 lds
M v[100:103],v[40:43],a[104:107],v[100:103]
s_waitcnt lgkmcnt(2)
s_nop 0
T a[148:149],v15,24576
T a[150:151],v15,26624
M v[100:103],v[44:47],a[112:115],v[100:103]
T a[152:153],v15,28672
T a[154:155],v15,30720
M v[100:103],v[48:51],a[120:123],v[100:103]
buffer_load_dwordx4 v3, s[8:11], s21 offen offset:3072 sc1 lds
M v[100:103],v[52:55],a[128:131],v[100:103]
SA m0,s28,102400
T a[156:157],v15,0
T a[158:159],v15,2048
M v[100:103],v[56:59],a[136:139],v[100:103]
T a[160:161],v15,4096
T a[162:163],v15,6144
M v[108:111],v[56:59],a[140:143],v[108:111]
buffer_load_dwordx4 v4, s[8:11], s21 offen offset:0 sc1 lds
M v[108:111],v[52:55],a[132:135],v[108:111]
s_nop 0
T a[164:165],v15,8192
T a[166:167],v15,10240
M v[108:111],v[48:51],a[124:127],v[108:111]
T a[168:169],v15,12288
T a[170:171],v15,14336
M v[108:111],v[44:47],a[116:119],v[108:111]
buffer_load_dwordx4 v4, s[8:11], s21 offen offset:1024 sc1 lds
M v[108:111],v[40:43],a[108:111],v[108:111]
MF v84,s5,v84
MF v85,s5,v85
M v[108:111],v[36:39],a[100:103],v[108:111]
s_waitcnt vmcnt(8) lgkmcnt(0)
buffer_load_dwordx4 v4, s[8:11], s21 offen offset:2048 sc1 lds
M v[108:111],v[32:35],a[236:239],v[108:111]
s_barrier
M v[116:119],a[144:147],a[232:235],v[116:119]
s_nop 0
T v[32:33],v16,0
T v[34:35],v16,2048
M v[116:119],a[148:151],a[96:99],v[116:119]
buffer_load_dwordx4 v4, s[8:11], s21 offen offset:3072 sc1 lds
M v[116:119],a[152:155],a[104:107],v[116:119]
SA s21,s21,32768
T v[36:37],v16,4096
T v[38:39],v16,6144
M v[116:119],a[156:159],a[112:115],v[116:119]
s_sub_u32 s22, s22, 1
T v[40:41],v16,8192
T v[42:43],v16,10240
M v[116:119],a[160:163],a[120:123],v[116:119]
s_cselect_b32 s21, s23, s21
MF v86,s5,v86
MF v87,s5,v87
M v[116:119],a[164:167],a[128:131],v[116:119]
SA m0,s28,65536
T v[44:45],v16,12288
T v[46:47],v16,14336
M v[116:119],a[168:171],a[136:139],v[116:119]
T v[48:49],v16,16384
T v[50:51],v16,18432
M v[124:127],a[168:171],a[140:143],v[124:127]
buffer_load_dwordx4 v3, s[8:11], s21 offen offset:0 sc1 lds
M v[124:127],a[164:167],a[132:135],v[124:127]
s_nop 0
T v[52:53],v16,20480
T v[54:55],v16,22528
M v[124:127],a[160:163],a[124:127],v[124:127]
T v[56:57],v16,24576
T v[58:59],v16,26624
M v[124:127],a[156:159],a[116:119],v[124:127]
buffer_load_dwordx4 v3, s[8:11], s21 offen offset:1024 sc1 lds
M v[124:127],a[152:155],a[108:111],v[124:127]
buffer_load_dword v5, v31, s[8:11], s46 offen offset:4 sc1
M v[124:127],a[148:151],a[100:103],v[124:127]
buffer_load_dwordx4 v3, s[8:11], s21 offen offset:2048 sc1 lds
M v[124:127],a[144:147],a[236:239],v[124:127]
s_waitcnt lgkmcnt(6)
C v68,v68,v69
C v69,v70,v71
M v[132:135],v[32:35],a[176:179],0
T a[144:145],v17,0
T a[146:147],v17,2048
M v[132:135],v[36:39],a[184:187],v[132:135]
buffer_load_dwordx4 v3, s[8:11], s21 offen offset:3072 sc1 lds
M v[132:135],v[40:43],a[192:195],v[132:135]
s_waitcnt lgkmcnt(2)
s_nop 0
T a[148:149],v17,4096
T a[150:151],v17,6144
M v[132:135],v[44:47],a[200:203],v[132:135]
SA m0,s28,69632
T a[152:153],v17,8192
T a[154:155],v17,10240
M v[132:135],v[48:51],a[208:211],v[132:135]
buffer_load_dwordx4 v4, s[8:11], s21 offen offset:0 sc1 lds
M v[132:135],v[52:55],a[216:219],v[132:135]
s_nop 0
T a[156:157],v17,12288
T a[158:159],v17,14336
M v[132:135],v[56:59],a[224:227],v[132:135]
T a[160:161],v17,16384
T a[162:163],v17,18432
M v[140:143],v[56:59],a[228:231],0
buffer_load_dwordx4 v4, s[8:11], s21 offen offset:1024 sc1 lds
M v[140:143],v[52:55],a[220:223],v[140:143]
s_nop 0
T a[164:165],v17,20480
T a[166:167],v17,22528
M v[140:143],v[48:51],a[212:215],v[140:143]
T a[168:169],v17,24576
T a[170:171],v17,26624
M v[140:143],v[44:47],a[204:207],v[140:143]
SA s3,s93,270336
buffer_load_dwordx4 v4, s[8:11], s21 offen offset:2048 sc1 lds
M v[140:143],v[40:43],a[196:199],v[140:143]
C v70,v84,v85
C v71,v86,v87
M v[140:143],v[36:39],a[188:191],v[140:143]
buffer_load_dwordx4 v4, s[8:11], s21 offen offset:3072 sc1 lds
M v[140:143],v[32:35],a[180:183],v[140:143]
s_waitcnt lgkmcnt(6)
W a16,v68
W a17,v69
M v[148:151],a[144:147],a[176:179],0
SA s21,s21,32768
T v[32:33],v18,0
T v[34:35],v18,2048
M v[148:151],a[148:151],a[184:187],v[148:151]
s_sub_u32 s22, s22, 1
buffer_store_dwordx4 v[160:163], v7, s[8:11], s3 offen offset:0 sc1
M v[148:151],a[152:155],a[192:195],v[148:151]
s_waitcnt lgkmcnt(2)
s_nop 0
T v[36:37],v18,4096
T v[38:39],v18,6144
M v[148:151],a[156:159],a[200:203],v[148:151]
s_cselect_b32 s21, s23, s21
T v[40:41],v18,8192
T v[42:43],v18,10240
M v[148:151],a[160:163],a[208:211],v[148:151]
buffer_store_dwordx4 v[168:171], v7, s[8:11], s3 offen offset:1024 sc1
M v[148:151],a[164:167],a[216:219],v[148:151]
s_nop 0
T v[44:45],v18,12288
T v[46:47],v18,14336
M v[148:151],a[168:171],a[224:227],v[148:151]
T v[48:49],v18,16384
T v[50:51],v18,18432
M v[156:159],a[168:171],a[228:231],0
buffer_store_dwordx4 v[176:179], v7, s[8:11], s3 offen offset:2048 sc1
M v[156:159],a[164:167],a[220:223],v[156:159]
s_nop 0
T v[52:53],v18,20480
T v[54:55],v18,22528
M v[156:159],a[160:163],a[212:215],v[156:159]
T v[56:57],v18,24576
L_w_kv010:
s_cbranch_execz L_wd1
T v[58:59],v18,26624
M v[156:159],a[156:159],a[204:207],v[156:159]
buffer_store_dwordx4 v[184:187], v7, s[8:11], s3 offen offset:3072 sc1
M v[156:159],a[152:155],a[196:199],v[156:159]
W a18,v70
W a19,v71
M v[156:159],a[148:151],a[188:191],v[156:159]
MF v76,s5,v76
MF v77,s5,v77
M v[156:159],a[144:147],a[180:183],v[156:159]
s_waitcnt lgkmcnt(6)
MF v78,s5,v78
MF v79,s5,v79
M v[164:167],v[32:35],a[176:179],0
T a[144:145],v19,0
T a[146:147],v19,2048
M v[164:167],v[36:39],a[184:187],v[164:167]
MF v92,s5,v92
MF v93,s5,v93
M v[164:167],v[40:43],a[192:195],v[164:167]
s_waitcnt lgkmcnt(2)
T a[148:149],v19,4096
T a[150:151],v19,6144
M v[164:167],v[44:47],a[200:203],v[164:167]
T a[152:153],v19,8192
T a[154:155],v19,10240
M v[164:167],v[48:51],a[208:211],v[164:167]
MF v94,s5,v94
MF v95,s5,v95
M v[164:167],v[52:55],a[216:219],v[164:167]
T a[156:157],v19,12288
T a[158:159],v19,14336
M v[164:167],v[56:59],a[224:227],v[164:167]
T a[160:161],v19,16384
T a[162:163],v19,18432
M v[172:175],v[56:59],a[228:231],0
C v76,v76,v77
C v77,v78,v79
M v[172:175],v[52:55],a[220:223],v[172:175]
T a[164:165],v19,20480
T a[166:167],v19,22528
M v[172:175],v[48:51],a[212:215],v[172:175]
T a[168:169],v19,24576
T a[170:171],v19,26624
M v[172:175],v[44:47],a[204:207],v[172:175]
C v78,v92,v93
C v79,v94,v95
M v[172:175],v[40:43],a[196:199],v[172:175]
W a48,v76
W a49,v77
M v[172:175],v[36:39],a[188:191],v[172:175]
W a50,v78
W a51,v79
M v[172:175],v[32:35],a[180:183],v[172:175]
s_waitcnt lgkmcnt(6)
v_mov_b32 v30, 2
MF v100,s5,v100
M v[180:183],a[144:147],a[176:179],0
T v[32:33],v16,28672
T v[34:35],v16,30720
M v[180:183],a[148:151],a[184:187],v[180:183]
buffer_store_dword v30, v1, s[8:11], s45 offen sc1
M v[180:183],a[152:155],a[192:195],v[180:183]
s_waitcnt lgkmcnt(2)
s_nop 0
T v[36:37],v16,40960
T v[38:39],v16,43008
M v[180:183],a[156:159],a[200:203],v[180:183]
T v[40:41],v16,45056
T v[42:43],v16,47104
M v[180:183],a[160:163],a[208:211],v[180:183]
MF v101,s5,v101
MF v102,s5,v102
M v[180:183],a[164:167],a[216:219],v[180:183]
T v[44:45],v16,49152
T v[46:47],v16,51200
M v[180:183],a[168:171],a[224:227],v[180:183]
T v[48:49],v16,53248
T v[50:51],v16,55296
M v[188:191],a[168:171],a[228:231],0
MF v103,s5,v103
MF v116,s5,v116
M v[188:191],a[164:167],a[220:223],v[188:191]
T v[52:53],v16,57344
T v[54:55],v16,59392
M v[188:191],a[160:163],a[212:215],v[188:191]
T v[56:57],v16,61440
T v[58:59],v16,63488
M v[188:191],a[156:159],a[204:207],v[188:191]
MF v117,s5,v117
MF v118,s5,v118
M v[188:191],a[152:155],a[196:199],v[188:191]
MF v119,s5,v119
C v100,v100,v101
M v[188:191],a[148:151],a[188:191],v[188:191]
C v101,v102,v103
C v102,v116,v117
M v[188:191],a[144:147],a[180:183],v[188:191]
s_waitcnt lgkmcnt(6)
C v103,v118,v119
W a20,v100
M v[132:135],v[32:35],a[232:235],v[132:135]
T a[144:145],v17,28672
T a[146:147],v17,30720
M v[132:135],v[36:39],a[96:99],v[132:135]
W a21,v101
W a22,v102
M v[132:135],v[40:43],a[104:107],v[132:135]
s_waitcnt lgkmcnt(2)
T a[148:149],v17,40960
T a[150:151],v17,43008
M v[132:135],v[44:47],a[112:115],v[132:135]
T a[152:153],v17,45056
T a[154:155],v17,47104
M v[132:135],v[48:51],a[120:123],v[132:135]
W a23,v103
MF v108,s5,v108
M v[132:135],v[52:55],a[128:131],v[132:135]
T a[156:157],v17,49152
T a[158:159],v17,51200
M v[132:135],v[56:59],a[136:139],v[132:135]
T a[160:161],v17,53248
T a[162:163],v17,55296
M v[140:143],v[56:59],a[140:143],v[140:143]
MF v109,s5,v109
MF v110,s5,v110
M v[140:143],v[52:55],a[132:135],v[140:143]
T a[164:165],v17,57344
T a[166:167],v17,59392
M v[140:143],v[48:51],a[124:127],v[140:143]
T a[168:169],v17,61440
T a[170:171],v17,63488
M v[140:143],v[44:47],a[116:119],v[140:143]
MF v111,s5,v111
MF v124,s5,v124
M v[140:143],v[40:43],a[108:111],v[140:143]
MF v125,s5,v125
MF v126,s5,v126
M v[140:143],v[36:39],a[100:103],v[140:143]
MF v127,s5,v127
C v108,v108,v109
M v[140:143],v[32:35],a[236:239],v[140:143]
s_waitcnt lgkmcnt(6)
C v109,v110,v111
C v110,v124,v125
M v[148:151],a[144:147],a[232:235],v[148:151]
T v[32:33],v18,28672
T v[34:35],v18,30720
M v[148:151],a[148:151],a[96:99],v[148:151]
C v111,v126,v127
W a52,v108
M v[148:151],a[152:155],a[104:107],v[148:151]
s_waitcnt lgkmcnt(2)
T v[36:37],v18,40960
T v[38:39],v18,43008
M v[148:151],a[156:159],a[112:115],v[148:151]
T v[40:41],v18,45056
T v[42:43],v18,47104
M v[148:151],a[160:163],a[120:123],v[148:151]
W a53,v109
W a54,v110
M v[148:151],a[164:167],a[128:131],v[148:151]
T v[44:45],v18,49152
T v[46:47],v18,51200
M v[148:151],a[168:171],a[136:139],v[148:151]
T v[48:49],v18,53248
T v[50:51],v18,55296
M v[156:159],a[168:171],a[140:143],v[156:159]
W a55,v111
s_waitcnt vmcnt(11)
v_cmp_ne_u32 vcc, 1, v5
M v[156:159],a[164:167],a[132:135],v[156:159]
s_nop 0
T v[52:53],v18,57344
T v[54:55],v18,59392
M v[156:159],a[160:163],a[124:127],v[156:159]
s_cmp_lg_u32 vcc_hi, 0
T v[56:57],v18,61440
T v[58:59],v18,63488
M v[156:159],a[156:159],a[116:119],v[156:159]
s_cbranch_scc1 L_wsr0
L_wrr0:
MF v132,s5,v132
MF v133,s5,v133
M v[156:159],a[152:155],a[108:111],v[156:159]
SA m0,s28,131072
MF v134,s5,v134
MF v135,s5,v135
M v[156:159],a[148:151],a[100:103],v[156:159]
buffer_load_dwordx4 v3, s[8:11], s26 offen offset:0 sc1 lds
M v[156:159],a[144:147],a[236:239],v[156:159]
s_waitcnt lgkmcnt(6)
MF v148,s5,v148
MF v149,s5,v149
M v[164:167],v[32:35],a[232:235],v[164:167]
T a[144:145],v19,28672
T a[146:147],v19,30720
M v[164:167],v[36:39],a[96:99],v[164:167]
buffer_load_dwordx4 v3, s[8:11], s26 offen offset:1024 sc1 lds
M v[164:167],v[40:43],a[104:107],v[164:167]
s_waitcnt lgkmcnt(2)
s_nop 0
T a[148:149],v19,40960
T a[150:151],v19,43008
M v[164:167],v[44:47],a[112:115],v[164:167]
T a[152:153],v19,45056
T a[154:155],v19,47104
M v[164:167],v[48:51],a[120:123],v[164:167]
buffer_load_dwordx4 v3, s[8:11], s26 offen offset:2048 sc1 lds
M v[164:167],v[52:55],a[128:131],v[164:167]
s_nop 0
T a[156:157],v19,49152
T a[158:159],v19,51200
M v[164:167],v[56:59],a[136:139],v[164:167]
T a[160:161],v19,53248
T a[162:163],v19,55296
M v[172:175],v[56:59],a[140:143],v[172:175]
buffer_load_dwordx4 v3, s[8:11], s26 offen offset:3072 sc1 lds
M v[172:175],v[52:55],a[132:135],v[172:175]
SA m0,s28,135168
T a[164:165],v19,57344
T a[166:167],v19,59392
M v[172:175],v[48:51],a[124:127],v[172:175]
T a[168:169],v19,61440
T a[170:171],v19,63488
M v[172:175],v[44:47],a[116:119],v[172:175]
buffer_load_dwordx4 v4, s[8:11], s26 offen offset:0 sc1 lds
M v[172:175],v[40:43],a[108:111],v[172:175]
MF v150,s5,v150
MF v151,s5,v151
M v[172:175],v[36:39],a[100:103],v[172:175]
s_waitcnt lgkmcnt(0)
buffer_load_dwordx4 v4, s[8:11], s26 offen offset:1024 sc1 lds
M v[172:175],v[32:35],a[236:239],v[172:175]
s_barrier
M v[180:183],a[144:147],a[232:235],v[180:183]
R a[64:67],v2,32768
R a[68:71],v2,33792
M v[180:183],a[148:151],a[96:99],v[180:183]
buffer_load_dwordx4 v4, s[8:11], s26 offen offset:2048 sc1 lds
M v[180:183],a[152:155],a[104:107],v[180:183]
C v132,v132,v133
C v133,v134,v135
M v[180:183],a[156:159],a[112:115],v[180:183]
R a[72:75],v2,34816
R a[76:79],v2,35840
M v[180:183],a[160:163],a[120:123],v[180:183]
buffer_load_dwordx4 v4, s[8:11], s26 offen offset:3072 sc1 lds
M v[180:183],a[164:167],a[128:131],v[180:183]
SA s26,s26,32768
C v134,v148,v149
C v135,v150,v151
M v[180:183],a[168:171],a[136:139],v[180:183]
R a[80:83],v2,36864
R a[84:87],v2,37888
M v[188:191],a[168:171],a[140:143],v[188:191]
W a24,v132
W a25,v133
M v[188:191],a[164:167],a[132:135],v[188:191]
W a26,v134
W a27,v135
M v[188:191],a[160:163],a[124:127],v[188:191]
R a[88:91],v2,38912
R a[92:95],v2,39936
M v[188:191],a[156:159],a[116:119],v[188:191]
MF v140,s5,v140
MF v141,s5,v141
M v[188:191],a[152:155],a[108:111],v[188:191]
MF v142,s5,v142
MF v143,s5,v143
M v[188:191],a[148:151],a[100:103],v[188:191]
MF v156,s5,v156
MF v157,s5,v157
M v[188:191],a[144:147],a[236:239],v[188:191]
s_waitcnt lgkmcnt(0)
MF v158,s5,v158
MF v159,s5,v159
C v140,v140,v141
C v141,v142,v143
C v142,v156,v157
C v143,v158,v159
W a56,v140
W a57,v141
W a58,v142
W a59,v143
s_cmp_eq_u32 s42, 0
s_cbranch_scc1 L_j0
M v[64:67],a[64:67],a[0:3],0
R a[96:99],v2,40960
R a[100:103],v2,41984
M v[64:67],a[68:71],a[4:7],v[64:67]
MF v164,s5,v164
MF v165,s5,v165
M v[64:67],a[72:75],a[8:11],v[64:67]
MF v166,s5,v166
MF v167,s5,v167
M v[64:67],a[76:79],a[12:15],v[64:67]
R a[104:107],v2,43008
R a[108:111],v2,44032
M v[64:67],a[80:83],a[16:19],v[64:67]
MF v180,s5,v180
MF v181,s5,v181
MF v182,s5,v182
MF v183,s5,v183
C v164,v164,v165
C v165,v166,v167
C v166,v180,v181
C v167,v182,v183
W a28,v164
W a29,v165
W a30,v166
W a31,v167
M v[64:67],a[84:87],a[20:23],v[64:67]
MF v172,s5,v172
MF v173,s5,v173
M v[64:67],a[88:91],a[24:27],v[64:67]
R a[112:115],v2,45056
R a[116:119],v2,46080
M v[64:67],a[92:95],a[28:31],v[64:67]
MF v174,s5,v174
MF v175,s5,v175
M v[68:71],a[64:67],a[32:35],0
MF v188,s5,v188
MF v189,s5,v189
M v[68:71],a[68:71],a[36:39],v[68:71]
R a[120:123],v2,47104
R a[124:127],v2,48128
M v[68:71],a[72:75],a[40:43],v[68:71]
SA m0,s28,32768
MF v190,s5,v190
MF v191,s5,v191
M v[68:71],a[76:79],a[44:47],v[68:71]
SA s3,s93,786432
buffer_load_dwordx4 v3, s[8:11], s26 offen offset:0 sc1 lds
M v[68:71],a[80:83],a[48:51],v[68:71]
C v172,v172,v173
C v173,v174,v175
C v174,v188,v189
C v175,v190,v191
W a60,v172
W a61,v173
W a62,v174
W a63,v175
M v[68:71],a[84:87],a[52:55],v[68:71]
E v18,v64
M v[68:71],a[88:91],a[56:59],v[68:71]
buffer_store_dwordx4 v[192:195], v7, s[8:11], s3 offen offset:0 sc1
M v[68:71],a[92:95],a[60:63],v[68:71]
s_waitcnt lgkmcnt(0)
E v19,v65
M v[72:75],a[96:99],a[0:3],0
R a[64:67],v2,49152
R a[68:71],v2,50176
M v[72:75],a[100:103],a[4:7],v[72:75]
buffer_load_dwordx4 v3, s[8:11], s26 offen offset:1024 sc1 lds
M v[72:75],a[104:107],a[8:11],v[72:75]
E v20,v66
M v[72:75],a[108:111],a[12:15],v[72:75]
R a[72:75],v2,51200
R a[76:79],v2,52224
M v[72:75],a[112:115],a[16:19],v[72:75]
buffer_load_dwordx4 v3, s[8:11], s26 offen offset:2048 sc1 lds
M v[72:75],a[116:119],a[20:23],v[72:75]
E v21,v67
M v[72:75],a[120:123],a[24:27],v[72:75]
R a[80:83],v2,53248
R a[84:87],v2,54272
M v[72:75],a[124:127],a[28:31],v[72:75]
buffer_load_dwordx4 v3, s[8:11], s26 offen offset:3072 sc1 lds
M v[76:79],a[124:127],a[60:63],0
SA m0,s28,36864
E v22,v68
M v[76:79],a[120:123],a[56:59],v[76:79]
R a[88:91],v2,55296
R a[92:95],v2,56320
M v[76:79],a[116:119],a[52:55],v[76:79]
buffer_load_dwordx4 v4, s[8:11], s26 offen offset:0 sc1 lds
M v[76:79],a[112:115],a[48:51],v[76:79]
E v23,v69
M v[76:79],a[108:111],a[44:47],v[76:79]
AF v26,v18,v19
C v40,v18,v19
M v[76:79],a[104:107],a[40:43],v[76:79]
buffer_load_dwordx4 v4, s[8:11], s26 offen offset:1024 sc1 lds
M v[76:79],a[100:103],a[36:39],v[76:79]
v_add_u32 v16, 0x20000, v7
AF v26,v20,v26
M v[76:79],a[96:99],a[32:35],v[76:79]
s_waitcnt lgkmcnt(0)
E v24,v70
M v[80:83],a[64:67],a[0:3],0
R a[96:99],v2,57344
R a[100:103],v2,58368
M v[80:83],a[68:71],a[4:7],v[80:83]
buffer_load_dwordx4 v4, s[8:11], s26 offen offset:2048 sc1 lds
M v[80:83],a[72:75],a[8:11],v[80:83]
E v25,v71
M v[80:83],a[76:79],a[12:15],v[80:83]
R a[104:107],v2,59392
R a[108:111],v2,60416
M v[80:83],a[80:83],a[16:19],v[80:83]
buffer_store_dwordx4 v[200:203], v7, s[8:11], s3 offen offset:1024 sc1
M v[80:83],a[84:87],a[20:23],v[80:83]
E v18,v72
M v[80:83],a[88:91],a[24:27],v[80:83]
R a[112:115],v2,61440
R a[116:119],v2,62464
M v[80:83],a[92:95],a[28:31],v[80:83]
buffer_load_dwordx4 v4, s[8:11], s26 offen offset:3072 sc1 lds
M v[84:87],a[92:95],a[60:63],0
SA s26,s26,32768
E v19,v73
M v[84:87],a[88:91],a[56:59],v[84:87]
R a[120:123],v2,63488
R a[124:127],v2,64512
M v[84:87],a[84:87],a[52:55],v[84:87]
C v41,v20,v21
AF v26,v21,v26
M v[84:87],a[80:83],a[48:51],v[84:87]
buffer_store_dwordx4 v[208:211], v7, s[8:11], s3 offen offset:2048 sc1
M v[84:87],a[76:79],a[44:47],v[84:87]
E v20,v74
M v[84:87],a[72:75],a[40:43],v[84:87]
AF v27,v22,v23
C v44,v22,v23
M v[84:87],a[68:71],a[36:39],v[84:87]
s_waitcnt vmcnt(24) lgkmcnt(0)
E v21,v75
M v[84:87],a[64:67],a[32:35],v[84:87]
s_barrier
M v[88:91],a[96:99],a[0:3],0
R a[64:67],v2,0
R a[68:71],v2,1024
M v[88:91],a[100:103],a[4:7],v[88:91]
E v22,v76
M v[88:91],a[104:107],a[8:11],v[88:91]
AF v27,v24,v27
C v45,v24,v25
M v[88:91],a[108:111],a[12:15],v[88:91]
R a[72:75],v2,2048
R a[76:79],v2,3072
M v[88:91],a[112:115],a[16:19],v[88:91]
E v23,v77
M v[88:91],a[116:119],a[20:23],v[88:91]
AF v27,v25,v27
AF v26,v18,v26
M v[88:91],a[120:123],a[24:27],v[88:91]
R a[80:83],v2,4096
R a[84:87],v2,5120
M v[88:91],a[124:127],a[28:31],v[88:91]
E v24,v78
M v[92:95],a[124:127],a[60:63],0
C v42,v18,v19
AF v26,v19,v26
M v[92:95],a[120:123],a[56:59],v[92:95]
R a[88:91],v2,6144
R a[92:95],v2,7168
M v[92:95],a[116:119],a[52:55],v[92:95]
E v25,v79
M v[92:95],a[112:115],a[48:51],v[92:95]
AF v26,v20,v26
C v43,v20,v21
M v[92:95],a[108:111],a[44:47],v[92:95]
AF v26,v21,v26
AF v27,v22,v27
M v[92:95],a[104:107],a[40:43],v[92:95]
C v46,v22,v23
AF v27,v23,v27
M v[92:95],a[100:103],a[36:39],v[92:95]
s_waitcnt lgkmcnt(0)
AF v27,v24,v27
C v47,v24,v25
M v[92:95],a[96:99],a[32:35],v[92:95]
AF v27,v25,v27
M v[96:99],a[64:67],a[0:3],0
R a[96:99],v2,8192
R a[100:103],v2,9216
M v[96:99],a[68:71],a[4:7],v[96:99]
SA m0,s28,98304
E v18,v80
M v[96:99],a[72:75],a[8:11],v[96:99]
buffer_load_dwordx4 v3, s[8:11], s21 offen offset:0 sc1 lds
M v[96:99],a[76:79],a[12:15],v[96:99]
R a[104:107],v2,10240
R a[108:111],v2,11264
M v[96:99],a[80:83],a[16:19],v[96:99]
v_mov_b32 v30, 0
M v[96:99],a[84:87],a[20:23],v[96:99]
E v19,v81
M v[96:99],a[88:91],a[24:27],v[96:99]
R a[112:115],v2,12288
R a[116:119],v2,13312
M v[96:99],a[92:95],a[28:31],v[96:99]
buffer_load_dwordx4 v3, s[8:11], s21 offen offset:1024 sc1 lds
M v[100:103],a[92:95],a[60:63],0
v_mov_b32 v31, 0
AF v26,v18,v26
M v[100:103],a[88:91],a[56:59],v[100:103]
R a[120:123],v2,14336
R a[124:127],v2,15360
M v[100:103],a[84:87],a[52:55],v[100:103]
SA s3,s93,786432
E v20,v82
M v[100:103],a[80:83],a[48:51],v[100:103]
buffer_load_dwordx4 v3, s[8:11], s21 offen offset:2048 sc1 lds
M v[100:103],a[76:79],a[44:47],v[100:103]
E v21,v83
M v[100:103],a[72:75],a[40:43],v[100:103]
v_mov_b32 v32, 0
C v56,v18,v19
M v[100:103],a[68:71],a[36:39],v[100:103]
buffer_store_dwordx4 v[216:219], v7, s[8:11], s3 offen offset:3072 sc1
M v[100:103],a[64:67],a[32:35],v[100:103]
s_waitcnt lgkmcnt(0)
E v22,v88
M v[108:111],a[96:99],a[32:35],0
R a[64:67],v2,16384
R a[68:71],v2,17408
M v[108:111],a[100:103],a[36:39],v[108:111]
buffer_load_dwordx4 v3, s[8:11], s21 offen offset:3072 sc1 lds
M v[108:111],a[104:107],a[40:43],v[108:111]
SA m0,s28,102400
v_mov_b32 v33, 0
AF v26,v19,v26
M v[108:111],a[108:111],a[44:47],v[108:111]
R a[72:75],v2,18432
R a[76:79],v2,19456
M v[108:111],a[112:115],a[48:51],v[108:111]
buffer_load_dwordx4 v4, s[8:11], s21 offen offset:0 sc1 lds
M v[108:111],a[116:119],a[52:55],v[108:111]
E v23,v89
M v[108:111],a[120:123],a[56:59],v[108:111]
R a[80:83],v2,20480
R a[84:87],v2,21504
M v[108:111],a[124:127],a[60:63],v[108:111]
buffer_load_dwordx4 v4, s[8:11], s21 offen offset:1024 sc1 lds
M v[104:107],a[124:127],a[28:31],0
v_mov_b32 v34, 0
AF v26,v20,v26
M v[104:107],a[120:123],a[24:27],v[104:107]
SA s3,s93,794624
R a[88:91],v2,22528
R a[92:95],v2,23552
M v[104:107],a[116:119],a[20:23],v[104:107]
buffer_load_dwordx4 v4, s[8:11], s21 offen offset:2048 sc1 lds
M v[104:107],a[112:115],a[16:19],v[104:107]
v_mov_b32 v35, 0
C v57,v20,v21
M v[104:107],a[108:111],a[12:15],v[104:107]
E v24,v90
M v[104:107],a[104:107],a[8:11],v[104:107]
E v25,v91
M v[104:107],a[100:103],a[4:7],v[104:107]
buffer_load_dwordx4 v4, s[8:11], s21 offen offset:3072 sc1 lds
M v[104:107],a[96:99],a[0:3],v[104:107]
s_waitcnt lgkmcnt(0)
v_mov_b32 v36, 0
AF v26,v21,v26
M v[112:115],a[64:67],a[0:3],0
SA s21,s21,32768
R a[96:99],v2,24576
R a[100:103],v2,25600
M v[112:115],a[68:71],a[4:7],v[112:115]
s_sub_u32 s22, s22, 1
buffer_store_dwordx4 v[224:227], v7, s[8:11], s3 offen offset:0 sc1
M v[112:115],a[72:75],a[8:11],v[112:115]
s_cselect_b32 s21, s23, s21
E v18,v84
M v[112:115],a[76:79],a[12:15],v[112:115]
R a[104:107],v2,26624
R a[108:111],v2,27648
M v[112:115],a[80:83],a[16:19],v[112:115]
v_mov_b32 v37, 0
AF v26,v22,v26
M v[112:115],a[84:87],a[20:23],v[112:115]
E v19,v85
M v[112:115],a[88:91],a[24:27],v[112:115]
R a[112:115],v2,28672
R a[116:119],v2,29696
M v[112:115],a[92:95],a[28:31],v[112:115]
E v20,v86
M v[116:119],a[92:95],a[60:63],0
v_mov_b32 v38, 0
C v58,v22,v23
M v[116:119],a[88:91],a[56:59],v[116:119]
L_w_kv011:
s_cbranch_execz L_wd1
R a[120:123],v2,30720
R a[124:127],v2,31744
M v[116:119],a[84:87],a[52:55],v[116:119]
E v21,v87
M v[116:119],a[80:83],a[48:51],v[116:119]
buffer_store_dwordx4 v[232:235], v7, s[8:11], s3 offen offset:1024 sc1
M v[116:119],a[76:79],a[44:47],v[116:119]
AF v26,v23,v26
AF v26,v24,v26
M v[116:119],a[72:75],a[40:43],v[116:119]
v_mov_b32 v39, 0
C v59,v24,v25
M v[116:119],a[68:71],a[36:39],v[116:119]
s_waitcnt vmcnt(22) lgkmcnt(0)
E v22,v92
M v[116:119],a[64:67],a[32:35],v[116:119]
s_barrier
M v[124:127],a[96:99],a[32:35],0
R a[64:67],v16,0
R a[68:71],v16,1024
M v[124:127],a[100:103],a[36:39],v[124:127]
E v23,v93
M v[124:127],a[104:107],a[40:43],v[124:127]
AF v26,v25,v26
AF v27,v18,v27
M v[124:127],a[108:111],a[44:47],v[124:127]
R a[72:75],v16,2048
R a[76:79],v16,3072
M v[124:127],a[112:115],a[48:51],v[124:127]
E v24,v94
M v[124:127],a[116:119],a[52:55],v[124:127]
E v25,v95
M v[124:127],a[120:123],a[56:59],v[124:127]
R a[80:83],v16,4096
R a[84:87],v16,5120
M v[124:127],a[124:127],a[60:63],v[124:127]
C v60,v18,v19
AF v27,v19,v27
M v[120:123],a[124:127],a[28:31],0
AF v27,v20,v27
C v61,v20,v21
M v[120:123],a[120:123],a[24:27],v[120:123]
R a[88:91],v16,6144
R a[92:95],v16,7168
M v[120:123],a[116:119],a[20:23],v[120:123]
AF v27,v21,v27
AF v27,v22,v27
M v[120:123],a[112:115],a[16:19],v[120:123]
C v62,v22,v23
AF v27,v23,v27
M v[120:123],a[108:111],a[12:15],v[120:123]
AF v27,v24,v27
C v63,v24,v25
M v[120:123],a[104:107],a[8:11],v[120:123]
AF v27,v25,v27
M v[120:123],a[100:103],a[4:7],v[120:123]
s_waitcnt lgkmcnt(0)
M v[120:123],a[96:99],a[0:3],v[120:123]
v_max_f32 v10, v26, v27
v_min_f32 v11, v26, v27
v_cmp_lt_f32 vcc, s31, v10
v_cmp_gt_f32 s[64:65], s24, v11
s_nop 0
s_or_b64 vcc, vcc, s[64:65]
s_cbranch_vccnz L_stk1
L_rtk1:
M v[128:131],a[64:67],v[40:43],0
R a[96:99],v16,8192
R a[100:103],v16,9216
M v[128:131],a[68:71],v[56:59],v[128:131]
SA m0,s28,65536
E v18,v96
M v[132:135],a[68:71],v[60:63],0
buffer_load_dwordx4 v3, s[8:11], s21 offen offset:0 sc1 lds
M v[132:135],a[64:67],v[44:47],v[132:135]
R a[104:107],v16,10240
R a[108:111],v16,11264
M v[140:143],a[72:75],v[44:47],0
SA s3,s93,794624
E v19,v97
M v[140:143],a[76:79],v[60:63],v[140:143]
AF v30,v26,v30
AF v31,v27,v31
M v[136:139],a[76:79],v[56:59],0
R a[112:115],v16,12288
R a[116:119],v16,13312
M v[136:139],a[72:75],v[40:43],v[136:139]
buffer_load_dwordx4 v3, s[8:11], s21 offen offset:1024 sc1 lds
M v[144:147],a[80:83],v[40:43],0
E v20,v98
M v[144:147],a[84:87],v[56:59],v[144:147]
R a[120:123],v16,14336
R a[124:127],v16,15360
M v[148:151],a[84:87],v[60:63],0
buffer_store_dwordx4 v[240:243], v7, s[8:11], s3 offen offset:2048 sc1
M v[148:151],a[80:83],v[44:47],v[148:151]
E v21,v99
M v[156:159],a[88:91],v[44:47],0
AF v28,v18,v19
C v48,v18,v19
M v[156:159],a[92:95],v[60:63],v[156:159]
buffer_load_dwordx4 v3, s[8:11], s21 offen offset:2048 sc1 lds
M v[152:155],a[92:95],v[56:59],0
AF v28,v20,v28
C v49,v20,v21
M v[152:155],a[88:91],v[40:43],v[152:155]
s_waitcnt lgkmcnt(0)
E v22,v104
M v[160:163],a[96:99],v[40:43],0
R a[64:67],v16,16384
R a[68:71],v16,17408
M v[160:163],a[100:103],v[56:59],v[160:163]
buffer_load_dwordx4 v3, s[8:11], s21 offen offset:3072 sc1 lds
M v[164:167],a[100:103],v[60:63],0
SA m0,s28,69632
E v23,v105
M v[164:167],a[96:99],v[44:47],v[164:167]
R a[72:75],v16,18432
R a[76:79],v16,19456
M v[172:175],a[104:107],v[44:47],0
buffer_load_dwordx4 v4, s[8:11], s21 offen offset:0 sc1 lds
M v[172:175],a[108:111],v[60:63],v[172:175]
AF v28,v21,v28
AF v28,v22,v28
M v[168:171],a[108:111],v[56:59],0
R a[80:83],v16,20480
R a[84:87],v16,21504
M v[168:171],a[104:107],v[40:43],v[168:171]
buffer_store_dwordx4 v[248:251], v7, s[8:11], s3 offen offset:3072 sc1
M v[176:179],a[112:115],v[40:43],0
E v24,v106
M v[176:179],a[116:119],v[56:59],v[176:179]
R a[88:91],v16,22528
R a[92:95],v16,23552
M v[180:183],a[116:119],v[60:63],0
buffer_load_dwordx4 v4, s[8:11], s21 offen offset:1024 sc1 lds
M v[180:183],a[112:115],v[44:47],v[180:183]
E v25,v107
M v[188:191],a[120:123],v[44:47],0
C v50,v22,v23
AF v28,v23,v28
M v[188:191],a[124:127],v[60:63],v[188:191]
buffer_load_dwordx4 v4, s[8:11], s21 offen offset:2048 sc1 lds
M v[184:187],a[124:127],v[56:59],0
E v18,v100
M v[184:187],a[120:123],v[40:43],v[184:187]
s_waitcnt lgkmcnt(0)
AF v28,v24,v28
C v51,v24,v25
M v[192:195],a[64:67],v[40:43],0
R a[96:99],v16,24576
R a[100:103],v16,25600
M v[192:195],a[68:71],v[56:59],v[192:195]
buffer_load_dwordx4 v4, s[8:11], s21 offen offset:3072 sc1 lds
M v[196:199],a[68:71],v[60:63],0
SA s21,s21,32768
E v19,v101
M v[196:199],a[64:67],v[44:47],v[196:199]
s_sub_u32 s22, s22, 1
R a[104:107],v16,26624
R a[108:111],v16,27648
M v[204:207],a[72:75],v[44:47],0
s_cselect_b32 s21, s23, s21
AF v28,v25,v28
AF v29,v18,v19
M v[204:207],a[76:79],v[60:63],v[204:207]
E v20,v102
M v[200:203],a[76:79],v[56:59],0
R a[112:115],v16,28672
R a[116:119],v16,29696
M v[200:203],a[72:75],v[40:43],v[200:203]
C v52,v18,v19
M v[208:211],a[80:83],v[40:43],0
M v[208:211],a[84:87],v[56:59],v[208:211]
R a[120:123],v16,30720
R a[124:127],v16,31744
M v[212:215],a[84:87],v[60:63],0
E v21,v103
M v[212:215],a[80:83],v[44:47],v[212:215]
AF v29,v20,v29
C v53,v20,v21
M v[220:223],a[88:91],v[44:47],0
AF v29,v21,v29
M v[220:223],a[92:95],v[60:63],v[220:223]
E v22,v108
M v[216:219],a[92:95],v[56:59],0
s_waitcnt vmcnt(12) lgkmcnt(0)
M v[216:219],a[88:91],v[40:43],v[216:219]
s_barrier
M v[224:227],a[96:99],v[40:43],0
R a[64:67],v2,32768
R a[68:71],v2,33792
M v[224:227],a[100:103],v[56:59],v[224:227]
E v23,v109
M v[228:231],a[100:103],v[60:63],0
AF v29,v22,v29
C v54,v22,v23
M v[228:231],a[96:99],v[44:47],v[228:231]
R a[72:75],v2,34816
R a[76:79],v2,35840
M v[236:239],a[104:107],v[44:47],0
E v24,v110
M v[236:239],a[108:111],v[60:63],v[236:239]
AF v29,v23,v29
M v[232:235],a[108:111],v[56:59],0
R a[80:83],v2,36864
R a[84:87],v2,37888
M v[232:235],a[104:107],v[40:43],v[232:235]
M v[240:243],a[112:115],v[40:43],0
E v25,v111
M v[240:243],a[116:119],v[56:59],v[240:243]
R a[88:91],v2,38912
R a[92:95],v2,39936
M v[244:247],a[116:119],v[60:63],0
AF v29,v24,v29
C v55,v24,v25
M v[244:247],a[112:115],v[44:47],v[244:247]
AF v29,v25,v29
M v[252:255],a[120:123],v[44:47],0
M v[252:255],a[124:127],v[60:63],v[252:255]
M v[248:251],a[124:127],v[56:59],0
s_waitcnt lgkmcnt(0)
M v[248:251],a[120:123],v[40:43],v[248:251]
s_cmp_lg_u32 s27, 0
s_cbranch_scc1 L_loop_top
s_branch L_d1s
L_j0:
M v[68:71],a[64:67],a[32:35],0
s_cmp_lt_u32 s20, 0
R a[96:99],v2,40960
R a[100:103],v2,41984
M v[68:71],a[68:71],a[36:39],v[68:71]
s_cselect_b64 s[82:83], -1, 0
v_mov_b32 v30, 0
MF v172,s5,v172
M v[68:71],a[72:75],a[40:43],v[68:71]
s_cmp_eq_u32 s20, 0
MF v173,s5,v173
MF v174,s5,v174
M v[68:71],a[76:79],a[44:47],v[68:71]
s_cselect_b64 s[66:67], s[16:17], s[82:83]
R a[104:107],v2,43008
R a[108:111],v2,44032
M v[68:71],a[80:83],a[48:51],v[68:71]
s_cselect_b64 s[68:69], s[18:19], s[82:83]
MF v175,s5,v175
MF v188,s5,v188
M v[68:71],a[84:87],a[52:55],v[68:71]
s_cselect_b64 s[70:71], s[48:49], s[82:83]
MF v189,s5,v189
MF v190,s5,v190
MF v191,s5,v191
C v172,v172,v173
C v173,v174,v175
C v174,v188,v189
C v175,v190,v191
W a60,v172
W a61,v173
W a62,v174
W a63,v175
M v[68:71],a[88:91],a[56:59],v[68:71]
s_cselect_b64 s[72:73], s[50:51], s[82:83]
R a[112:115],v2,45056
R a[116:119],v2,46080
v_cndmask_b32 v64, 0, v8, s[66:67]
v_cndmask_b32 v65, 0, v8, s[68:69]
v_cndmask_b32 v66, 0, v8, s[70:71]
v_cndmask_b32 v67, 0, v8, s[72:73]
M v[68:71],a[92:95],a[60:63],v[68:71]
s_cmp_lt_u32 s20, 1
MF v164,s5,v164
MF v165,s5,v165
M v[64:67],a[64:67],a[0:3],v[64:67]
s_cselect_b64 s[82:83], -1, 0
MF v166,s5,v166
MF v167,s5,v167
M v[64:67],a[68:71],a[4:7],v[64:67]
s_cmp_eq_u32 s20, 1
R a[120:123],v2,47104
R a[124:127],v2,48128
M v[64:67],a[72:75],a[8:11],v[64:67]
s_cselect_b64 s[74:75], s[16:17], s[82:83]
MF v180,s5,v180
MF v181,s5,v181
M v[64:67],a[76:79],a[12:15],v[64:67]
s_cselect_b64 s[76:77], s[18:19], s[82:83]
MF v182,s5,v182
MF v183,s5,v183
M v[64:67],a[80:83],a[16:19],v[64:67]
s_cselect_b64 s[78:79], s[48:49], s[82:83]
C v164,v164,v165
C v165,v166,v167
C v166,v180,v181
C v167,v182,v183
W a28,v164
W a29,v165
W a30,v166
W a31,v167
M v[64:67],a[84:87],a[20:23],v[64:67]
s_cselect_b64 s[80:81], s[50:51], s[82:83]
v_mov_b32 v31, 0
v_cndmask_b32 v72, 0, v8, s[74:75]
M v[64:67],a[88:91],a[24:27],v[64:67]
s_mov_b32 s26, s43
v_mov_b32 v32, 0
M v[64:67],a[92:95],a[28:31],v[64:67]
s_waitcnt lgkmcnt(0)
v_cndmask_b32 v73, 0, v8, s[76:77]
M v[76:79],a[96:99],a[32:35],0
SA m0,s28,0
R a[64:67],v2,49152
R a[68:71],v2,50176
M v[76:79],a[100:103],a[36:39],v[76:79]
SA s3,s93,786432
buffer_load_dwordx4 v3, s[8:11], s26 offen offset:0 sc1 lds
M v[76:79],a[104:107],a[40:43],v[76:79]
v_cndmask_b32 v74, 0, v8, s[78:79]
v_mov_b32 v33, 0
M v[76:79],a[108:111],a[44:47],v[76:79]
R a[72:75],v2,51200
R a[76:79],v2,52224
M v[76:79],a[112:115],a[48:51],v[76:79]
buffer_store_dwordx4 v[192:195], v7, s[8:11], s3 offen offset:0 sc1
M v[76:79],a[116:119],a[52:55],v[76:79]
v_cndmask_b32 v75, 0, v8, s[80:81]
M v[76:79],a[120:123],a[56:59],v[76:79]
s_cmp_lt_u32 s20, 2
R a[80:83],v2,53248
R a[84:87],v2,54272
M v[76:79],a[124:127],a[60:63],v[76:79]
s_cselect_b64 s[82:83], -1, 0
buffer_load_dwordx4 v3, s[8:11], s26 offen offset:1024 sc1 lds
M v[72:75],a[124:127],a[28:31],v[72:75]
s_cmp_eq_u32 s20, 2
E v18,v68
M v[72:75],a[120:123],a[24:27],v[72:75]
s_cselect_b64 s[66:67], s[16:17], s[82:83]
R a[88:91],v2,55296
R a[92:95],v2,56320
M v[72:75],a[116:119],a[20:23],v[72:75]
s_cselect_b64 s[68:69], s[18:19], s[82:83]
buffer_load_dwordx4 v3, s[8:11], s26 offen offset:2048 sc1 lds
M v[72:75],a[112:115],a[16:19],v[72:75]
s_cselect_b64 s[70:71], s[48:49], s[82:83]
v_mov_b32 v34, 0
M v[72:75],a[108:111],a[12:15],v[72:75]
s_cselect_b64 s[72:73], s[50:51], s[82:83]
v_cndmask_b32 v80, 0, v8, s[66:67]
v_cndmask_b32 v81, 0, v8, s[68:69]
M v[72:75],a[104:107],a[8:11],v[72:75]
buffer_store_dwordx4 v[200:203], v7, s[8:11], s3 offen offset:1024 sc1
M v[72:75],a[100:103],a[4:7],v[72:75]
E v19,v69
M v[72:75],a[96:99],a[0:3],v[72:75]
s_waitcnt lgkmcnt(0)
buffer_load_dwordx4 v3, s[8:11], s26 offen offset:3072 sc1 lds
M v[84:87],a[64:67],a[32:35],0
SA m0,s28,4096
R a[96:99],v2,57344
R a[100:103],v2,58368
M v[84:87],a[68:71],a[36:39],v[84:87]
v_cndmask_b32 v82, 0, v8, s[70:71]
v_mov_b32 v35, 0
M v[84:87],a[72:75],a[40:43],v[84:87]
buffer_load_dwordx4 v4, s[8:11], s26 offen offset:0 sc1 lds
M v[84:87],a[76:79],a[44:47],v[84:87]
R a[104:107],v2,59392
R a[108:111],v2,60416
M v[84:87],a[80:83],a[48:51],v[84:87]
buffer_store_dwordx4 v[208:211], v7, s[8:11], s3 offen offset:2048 sc1
M v[84:87],a[84:87],a[52:55],v[84:87]
v_cndmask_b32 v83, 0, v8, s[72:73]
v_mov_b32 v36, 0
M v[84:87],a[88:91],a[56:59],v[84:87]
s_cmp_lt_u32 s20, 3
R a[112:115],v2,61440
R a[116:119],v2,62464
M v[84:87],a[92:95],a[60:63],v[84:87]
s_cselect_b64 s[82:83], -1, 0
buffer_load_dwordx4 v4, s[8:11], s26 offen offset:1024 sc1 lds
M v[80:83],a[92:95],a[28:31],v[80:83]
s_cmp_eq_u32 s20, 3
E v20,v70
M v[80:83],a[88:91],a[24:27],v[80:83]
s_cselect_b64 s[74:75], s[16:17], s[82:83]
R a[120:123],v2,63488
R a[124:127],v2,64512
M v[80:83],a[84:87],a[20:23],v[80:83]
s_cselect_b64 s[76:77], s[18:19], s[82:83]
buffer_load_dwordx4 v4, s[8:11], s26 offen offset:2048 sc1 lds
M v[80:83],a[80:83],a[16:19],v[80:83]
s_cselect_b64 s[78:79], s[48:49], s[82:83]
E v21,v71
M v[80:83],a[76:79],a[12:15],v[80:83]
s_cselect_b64 s[80:81], s[50:51], s[82:83]
buffer_store_dwordx4 v[216:219], v7, s[8:11], s3 offen offset:3072 sc1
M v[80:83],a[72:75],a[8:11],v[80:83]
SA s3,s93,794624
v_cndmask_b32 v88, 0, v8, s[74:75]
v_cndmask_b32 v89, 0, v8, s[76:77]
M v[80:83],a[68:71],a[4:7],v[80:83]
s_waitcnt vmcnt(24) lgkmcnt(0)
buffer_load_dwordx4 v4, s[8:11], s26 offen offset:3072 sc1 lds
M v[80:83],a[64:67],a[0:3],v[80:83]
s_barrier
M v[92:95],a[96:99],a[32:35],0
R a[64:67],v2,0
R a[68:71],v2,1024
M v[92:95],a[100:103],a[36:39],v[92:95]
buffer_store_dwordx4 v[224:227], v7, s[8:11], s3 offen offset:0 sc1
M v[92:95],a[104:107],a[40:43],v[92:95]
v_min_u32 v17, 896, v9
v_cndmask_b32 v90, 0, v8, s[78:79]
M v[92:95],a[108:111],a[44:47],v[92:95]
R a[72:75],v2,2048
R a[76:79],v2,3072
M v[92:95],a[112:115],a[48:51],v[92:95]
buffer_load_dword v5, v17, s[8:11], s46 offen sc1
M v[92:95],a[116:119],a[52:55],v[92:95]
buffer_store_dwordx4 v[232:235], v7, s[8:11], s3 offen offset:1024 sc1
M v[92:95],a[120:123],a[56:59],v[92:95]
R a[80:83],v2,4096
R a[84:87],v2,5120
v_cndmask_b32 v91, 0, v8, s[80:81]
M v[92:95],a[124:127],a[60:63],v[92:95]
v_mov_b32 v37, 0
v_mov_b32 v38, 0
M v[88:91],a[124:127],a[28:31],v[88:91]
buffer_store_dwordx4 v[240:243], v7, s[8:11], s3 offen offset:2048 sc1
M v[88:91],a[120:123],a[24:27],v[88:91]
R a[88:91],v2,6144
R a[92:95],v2,7168
M v[88:91],a[116:119],a[20:23],v[88:91]
v_mov_b32 v39, 0
AF v27,v18,v19
M v[88:91],a[112:115],a[16:19],v[88:91]
buffer_store_dwordx4 v[248:251], v7, s[8:11], s3 offen offset:3072 sc1
M v[88:91],a[108:111],a[12:15],v[88:91]
E v22,v64
M v[88:91],a[104:107],a[8:11],v[88:91]
E v23,v65
M v[88:91],a[100:103],a[4:7],v[88:91]
s_waitcnt lgkmcnt(0)
E v24,v66
M v[88:91],a[96:99],a[0:3],v[88:91]
E v25,v67
C v44,v18,v19
AF v27,v20,v27
C v45,v20,v21
AF v27,v21,v27
AF v26,v22,v23
C v40,v22,v23
E v18,v76
E v19,v77
AF v26,v24,v26
C v41,v24,v25
AF v26,v25,v26
E v20,v78
E v21,v79
AF v27,v18,v27
C v46,v18,v19
AF v27,v19,v27
E v22,v72
E v23,v73
AF v27,v20,v27
C v47,v20,v21
AF v27,v21,v27
E v24,v74
E v25,v75
AF v26,v22,v26
C v42,v22,v23
AF v26,v23,v26
AF v26,v24,v26
C v43,v24,v25
AF v26,v25,v26
v_mov_b32 v56, 0
v_mov_b32 v57, 0
v_mov_b32 v58, 0
v_mov_b32 v59, 0
s_mul_i32 s21, s41, 1048576
SA s21,s21,589824
s_lshl_b32 s84, s42, 1
s_sub_u32 s22, 11, s84
s_mov_b32 s23, 536870912
s_lshl_b32 s86, s20, 14
SA s86,s86,s34
SA s87,s86,4096
SA s88,s86,8192
SA s89,s86,12288
s_lshl_b32 s90, s20, 10
SA s90,s90,s34
SA s90,s90,65536
s_waitcnt vmcnt(3)
v_cmp_gt_u32 vcc, 2, v5
s_nop 0
s_cbranch_vccnz L_lsj0
L_lrj0:
SA m0,s28,98304
v_mov_b32 v10, v26
buffer_load_dwordx4 v3, s[8:11], s21 offen offset:0 sc1 lds
v_mov_b32 v11, v27
buffer_load_dwordx4 v3, s[8:11], s21 offen offset:1024 sc1 lds
v_mov_b32 v12, v10
v_mov_b32 v13, v11
buffer_load_dwordx4 v3, s[8:11], s21 offen offset:2048 sc1 lds
v_permlane16_swap_b32 v12, v10
v_permlane16_swap_b32 v13, v11
buffer_load_dwordx4 v3, s[8:11], s21 offen offset:3072 sc1 lds
v_max_f32 v10, v12, v10
SA m0,s28,102400
v_max_f32 v11, v13, v11
buffer_load_dwordx4 v4, s[8:11], s21 offen offset:0 sc1 lds
v_mov_b32 v12, v10
v_mov_b32 v13, v11
buffer_load_dwordx4 v4, s[8:11], s21 offen offset:1024 sc1 lds
v_permlane32_swap_b32 v12, v10
v_permlane32_swap_b32 v13, v11
buffer_load_dwordx4 v4, s[8:11], s21 offen offset:2048 sc1 lds
v_max_f32 v10, v12, v10
v_max_f32 v11, v13, v11
buffer_load_dwordx4 v4, s[8:11], s21 offen offset:3072 sc1 lds
SA s21,s21,32768
s_sub_u32 s22, s22, 1
s_cselect_b32 s21, s23, s21
v_min_f32 v10, v10, v11
v_cmp_gt_f32 vcc, s24, v10
s_nop 0
s_cbranch_vccnz L_stj0
L_rtj0:
s_cmp_gt_u32 s20, 3
s_cselect_b64 s[82:83], -1, 0
s_cmp_eq_u32 s20, 3
s_cselect_b64 s[66:67], s[16:17], s[82:83]
v_mfma_f32_32x32x16_bf16 v[128:143], v[56:59], v[56:59], 0
s_cselect_b64 s[68:69], s[18:19], s[82:83]
s_cselect_b64 s[70:71], s[48:49], s[82:83]
s_cselect_b64 s[72:73], s[50:51], s[82:83]
v_cndmask_b32 v100, v36, v8, s[66:67]
v_mfma_f32_32x32x16_bf16 v[144:159], v[56:59], v[56:59], 0
v_cndmask_b32 v101, v36, v8, s[68:69]
v_cndmask_b32 v102, v36, v8, s[70:71]
v_cndmask_b32 v103, v36, v8, s[72:73]
s_cmp_gt_u32 s20, 2
v_mfma_f32_32x32x16_bf16 v[160:175], v[56:59], v[56:59], 0
s_cselect_b64 s[82:83], -1, 0
s_cmp_eq_u32 s20, 2
s_cselect_b64 s[74:75], s[16:17], s[82:83]
s_cselect_b64 s[76:77], s[18:19], s[82:83]
v_mfma_f32_32x32x16_bf16 v[176:191], v[56:59], v[56:59], 0
s_cselect_b64 s[78:79], s[48:49], s[82:83]
s_cselect_b64 s[80:81], s[50:51], s[82:83]
v_cndmask_b32 v108, v36, v8, s[74:75]
v_cndmask_b32 v109, v36, v8, s[76:77]
v_mfma_f32_32x32x16_bf16 v[192:207], v[56:59], v[56:59], 0
v_cndmask_b32 v110, v36, v8, s[78:79]
v_cndmask_b32 v111, v36, v8, s[80:81]
s_cmp_gt_u32 s20, 1
s_cselect_b64 s[82:83], -1, 0
v_mfma_f32_32x32x16_bf16 v[208:223], v[56:59], v[56:59], 0
s_cmp_eq_u32 s20, 1
s_cselect_b64 s[66:67], s[16:17], s[82:83]
s_cselect_b64 s[68:69], s[18:19], s[82:83]
s_cselect_b64 s[70:71], s[48:49], s[82:83]
v_mfma_f32_32x32x16_bf16 v[224:239], v[56:59], v[56:59], 0
s_cselect_b64 s[72:73], s[50:51], s[82:83]
v_cndmask_b32 v116, v36, v8, s[66:67]
v_cndmask_b32 v117, v36, v8, s[68:69]
v_cndmask_b32 v118, v36, v8, s[70:71]
v_mfma_f32_32x32x16_bf16 v[240:255], v[56:59], v[56:59], 0
v_cndmask_b32 v119, v36, v8, s[72:73]
s_cmp_gt_u32 s20, 0
s_cselect_b64 s[82:83], -1, 0
s_cmp_eq_u32 s20, 0
s_cselect_b64 s[74:75], s[16:17], s[82:83]
s_cselect_b64 s[76:77], s[18:19], s[82:83]
s_cselect_b64 s[78:79], s[48:49], s[82:83]
s_cselect_b64 s[80:81], s[50:51], s[82:83]
v_cndmask_b32 v124, v36, v8, s[74:75]
v_cndmask_b32 v125, v36, v8, s[76:77]
v_cndmask_b32 v126, v36, v8, s[78:79]
v_cndmask_b32 v127, v36, v8, s[80:81]
s_branch L_d3h
.p2align 12
L_kv1:
s_and_b32 s31, s42, 7
s_lshl_b32 s30, s41, 3
SA s30,s30,s31
s_lshl_b32 s64, s30, 2
SA s64,s64,s20
s_mul_i32 s72, s64, 3584
v_mov_b32 v32, 536870912
v_cmp_gt_u32 vcc, 56, v0
s_lshl_b32 s67, s64, 2
s_nop 0
v_cndmask_b32 v32, v32, v7, vcc
buffer_load_dwordx4 a[176:179], v32, s[56:59], s72 offen offset:0
buffer_load_dwordx4 a[180:183], v32, s[56:59], s72 offen offset:896
buffer_load_dwordx4 a[184:187], v32, s[56:59], s72 offen offset:1792
buffer_load_dwordx4 a[188:191], v32, s[56:59], s72 offen offset:2688
buffer_load_dwordx4 a[192:195], v32, s[60:63], 0 offen
buffer_load_dwordx4 a[196:199], v32, s[68:71], 0 offen
SA m0,s24,16384
s_nop 0
buffer_load_dwordx4 v12, s[48:51], s22 offen offset:0   lds
buffer_load_dwordx4 v13, s[48:51], s22 offen offset:1024   lds
buffer_load_dwordx4 v14, s[48:51], s22 offen offset:2048   lds
buffer_load_dwordx4 v15, s[48:51], s22 offen offset:3072   lds
s_sub_u32 s22, s22, 1048448
SA m0,s23,32768
s_nop 0
buffer_load_dwordx4 v8, s[16:19], s21 offen offset:0   lds
buffer_load_dwordx4 v9, s[16:19], s21 offen offset:1024   lds
buffer_load_dwordx4 v10, s[16:19], s21 offen offset:2048   lds
buffer_load_dwordx4 v11, s[16:19], s21 offen offset:3072   lds
SA s21,s21,128
s_mov_b64 exec, 0
s_cmp_eq_u32 s20, 0
s_cbranch_scc1 L_w_kv11
s_cmp_eq_u32 s20, 1
s_cbranch_scc1 L_w_kv12
s_cmp_eq_u32 s20, 2
s_cbranch_scc1 L_w_kv13
s_branch L_w_kv14
L_wd2:
s_mov_b64 exec, -1
s_waitcnt vmcnt(14) lgkmcnt(0)
s_barrier
R a[160:163],v5,0
R a[164:167],v6,0
T a[96:97],v1,0
T a[98:99],v1,1024
T a[100:101],v1,8192
T a[102:103],v1,9216
T a[104:105],v2,0
T a[106:107],v2,1024
T a[108:109],v2,8192
T a[110:111],v2,9216
T a[112:113],v3,0
T a[114:115],v3,1024
T a[116:117],v3,8192
T a[118:119],v3,9216
T a[120:121],v4,0
T a[122:123],v4,1024
T a[124:125],v4,8192
T a[126:127],v4,9216
T a[128:129],v1,16384
T a[130:131],v1,17408
T a[132:133],v1,24576
T a[134:135],v1,25600
T a[136:137],v2,16384
T a[138:139],v2,17408
T a[140:141],v2,24576
T a[142:143],v2,25600
T a[144:145],v3,16384
T a[146:147],v3,17408
T a[148:149],v3,24576
T a[150:151],v3,25600
T a[152:153],v4,16384
T a[154:155],v4,17408
T a[156:157],v4,24576
T a[158:159],v4,25600
s_waitcnt lgkmcnt(15)
M a[0:3],a[160:163],a[96:99],0
SA m0,s23,49152
R a[168:171],v5,2048
R a[172:175],v6,2048
M a[0:3],a[164:167],a[100:103],a[0:3]
buffer_load_dwordx4 v8, s[16:19], s21 offen offset:0   lds
M a[4:7],a[164:167],a[108:111],0
M a[4:7],a[160:163],a[104:107],a[4:7]
M a[8:11],a[160:163],a[112:115],0
buffer_load_dwordx4 v9, s[16:19], s21 offen offset:1024   lds
M a[8:11],a[164:167],a[116:119],a[8:11]
s_waitcnt lgkmcnt(14)
M a[12:15],a[164:167],a[124:127],0
M a[12:15],a[160:163],a[120:123],a[12:15]
M a[16:19],a[160:163],a[128:131],0
buffer_load_dwordx4 v10, s[16:19], s21 offen offset:2048   lds
M a[16:19],a[164:167],a[132:135],a[16:19]
s_waitcnt lgkmcnt(6)
M a[20:23],a[164:167],a[140:143],0
M a[20:23],a[160:163],a[136:139],a[20:23]
buffer_load_dwordx4 v11, s[16:19], s21 offen offset:3072   lds
M a[24:27],a[160:163],a[144:147],0
SA s21,s21,524160
M a[24:27],a[164:167],a[148:151],a[24:27]
s_waitcnt lgkmcnt(0)
M a[28:31],a[164:167],a[156:159],0
SA m0,s24,32768
M a[28:31],a[160:163],a[152:155],a[28:31]
buffer_load_dwordx4 v12, s[48:51], s22 offen offset:0   lds
M v[32:35],a[168:171],a[96:99],0
R a[160:163],v5,4096
R a[164:167],v6,4096
M v[32:35],a[172:175],a[100:103],v[32:35]
M v[36:39],a[172:175],a[108:111],0
M v[36:39],a[168:171],a[104:107],v[36:39]
buffer_load_dwordx4 v13, s[48:51], s22 offen offset:1024   lds
M v[40:43],a[168:171],a[112:115],0
M v[40:43],a[172:175],a[116:119],v[40:43]
M v[44:47],a[172:175],a[124:127],0
buffer_load_dwordx4 v14, s[48:51], s22 offen offset:2048   lds
M v[44:47],a[168:171],a[120:123],v[44:47]
M v[48:51],a[168:171],a[128:131],0
M v[48:51],a[172:175],a[132:135],v[48:51]
M v[52:55],a[172:175],a[140:143],0
buffer_load_dwordx4 v15, s[48:51], s22 offen offset:3072   lds
M v[52:55],a[168:171],a[136:139],v[52:55]
SA s22,s22,1048576
M v[56:59],a[168:171],a[144:147],0
M v[56:59],a[172:175],a[148:151],v[56:59]
s_waitcnt lgkmcnt(0)
M v[60:63],a[172:175],a[156:159],0
M v[60:63],a[168:171],a[152:155],v[60:63]
M v[64:67],a[160:163],a[96:99],0
R a[168:171],v5,6144
R a[172:175],v6,6144
M v[64:67],a[164:167],a[100:103],v[64:67]
M v[68:71],a[164:167],a[108:111],0
M v[68:71],a[160:163],a[104:107],v[68:71]
M v[72:75],a[160:163],a[112:115],0
M v[72:75],a[164:167],a[116:119],v[72:75]
M v[76:79],a[164:167],a[124:127],0
M v[76:79],a[160:163],a[120:123],v[76:79]
M v[80:83],a[160:163],a[128:131],0
M v[80:83],a[164:167],a[132:135],v[80:83]
M v[84:87],a[164:167],a[140:143],0
M v[84:87],a[160:163],a[136:139],v[84:87]
M v[88:91],a[160:163],a[144:147],0
M v[88:91],a[164:167],a[148:151],v[88:91]
s_waitcnt lgkmcnt(0)
M v[92:95],a[164:167],a[156:159],0
s_waitcnt vmcnt(12)
M v[92:95],a[160:163],a[152:155],v[92:95]
s_barrier
M v[96:99],a[168:171],a[96:99],0
SA m0,s23,0
R a[160:163],v5,16384
R a[164:167],v6,16384
M v[96:99],a[172:175],a[100:103],v[96:99]
buffer_load_dwordx4 v8, s[16:19], s21 offen offset:0   lds
M v[100:103],a[172:175],a[108:111],0
v_lshlrev_b32 v26, 7, v0
v_and_b32 v27, 48, v0
M v[100:103],a[168:171],a[104:107],v[100:103]
v_lshl_add_u32 v26, v27, 24, v26
M v[104:107],a[168:171],a[112:115],0
buffer_load_dwordx4 v9, s[16:19], s21 offen offset:1024   lds
M v[104:107],a[172:175],a[116:119],v[104:107]
M v[108:111],a[172:175],a[124:127],0
M v[108:111],a[168:171],a[120:123],v[108:111]
buffer_load_dwordx4 v10, s[16:19], s21 offen offset:2048   lds
M v[112:115],a[168:171],a[128:131],0
M v[112:115],a[172:175],a[132:135],v[112:115]
M v[116:119],a[172:175],a[140:143],0
M v[116:119],a[168:171],a[136:139],v[116:119]
buffer_load_dwordx4 v11, s[16:19], s21 offen offset:3072   lds
M v[120:123],a[168:171],a[144:147],0
SA s21,s21,128
M v[120:123],a[172:175],a[148:151],v[120:123]
s_waitcnt lgkmcnt(0)
M v[124:127],a[172:175],a[156:159],0
SA m0,s24,49152
M v[124:127],a[168:171],a[152:155],v[124:127]
buffer_load_dwordx4 v12, s[48:51], s22 offen offset:0   lds
M v[128:131],a[160:163],a[96:99],0
R a[168:171],v5,18432
R a[172:175],v6,18432
M v[128:131],a[164:167],a[100:103],v[128:131]
buffer_load_dwordx4 v13, s[48:51], s22 offen offset:1024   lds
M v[132:135],a[164:167],a[108:111],0
M v[132:135],a[160:163],a[104:107],v[132:135]
M v[136:139],a[160:163],a[112:115],0
M v[136:139],a[164:167],a[116:119],v[136:139]
buffer_load_dwordx4 v14, s[48:51], s22 offen offset:2048   lds
M v[140:143],a[164:167],a[124:127],0
M v[140:143],a[160:163],a[120:123],v[140:143]
M v[144:147],a[160:163],a[128:131],0
buffer_load_dwordx4 v15, s[48:51], s22 offen offset:3072   lds
M v[144:147],a[164:167],a[132:135],v[144:147]
s_sub_u32 s22, s22, 1048448
M v[148:151],a[164:167],a[140:143],0
M v[148:151],a[160:163],a[136:139],v[148:151]
M v[152:155],a[160:163],a[144:147],0
M v[152:155],a[164:167],a[148:151],v[152:155]
s_waitcnt lgkmcnt(0)
M v[156:159],a[164:167],a[156:159],0
s_waitcnt vmcnt(12)
M v[156:159],a[160:163],a[152:155],v[156:159]
s_barrier
M v[160:163],a[168:171],a[96:99],0
SA m0,s23,16384
R a[160:163],v5,20480
R a[164:167],v6,20480
M v[160:163],a[172:175],a[100:103],v[160:163]
T a[32:33],v1,32768
T a[34:35],v1,33792
M v[164:167],a[172:175],a[108:111],0
T a[36:37],v1,40960
T a[38:39],v1,41984
M v[164:167],a[168:171],a[104:107],v[164:167]
T a[40:41],v2,32768
T a[42:43],v2,33792
M v[168:171],a[168:171],a[112:115],0
T a[44:45],v2,40960
T a[46:47],v2,41984
M v[168:171],a[172:175],a[116:119],v[168:171]
buffer_load_dwordx4 v8, s[16:19], s21 offen offset:0   lds
M v[172:175],a[172:175],a[124:127],0
s_nop 0
T a[48:49],v3,32768
T a[50:51],v3,33792
M v[172:175],a[168:171],a[120:123],v[172:175]
buffer_load_dwordx4 v9, s[16:19], s21 offen offset:1024   lds
M v[176:179],a[168:171],a[128:131],0
s_nop 0
T a[52:53],v3,40960
T a[54:55],v3,41984
M v[176:179],a[172:175],a[132:135],v[176:179]
T a[56:57],v4,32768
T a[58:59],v4,33792
M v[180:183],a[172:175],a[140:143],0
buffer_load_dwordx4 v10, s[16:19], s21 offen offset:2048   lds
M v[180:183],a[168:171],a[136:139],v[180:183]
s_nop 0
T a[60:61],v4,40960
T a[62:63],v4,41984
M v[184:187],a[168:171],a[144:147],0
buffer_load_dwordx4 v11, s[16:19], s21 offen offset:3072   lds
M v[184:187],a[172:175],a[148:151],v[184:187]
s_waitcnt lgkmcnt(15)
s_nop 0
T a[64:65],v1,49152
T a[66:67],v1,50176
M v[188:191],a[172:175],a[156:159],0
SA s21,s21,524160
T a[68:69],v1,57344
T a[70:71],v1,58368
M v[188:191],a[168:171],a[152:155],v[188:191]
SA m0,s24,0
M v[192:195],a[160:163],a[96:99],0
R a[168:171],v5,22528
R a[172:175],v6,22528
M v[192:195],a[164:167],a[100:103],v[192:195]
T a[72:73],v2,49152
T a[74:75],v2,50176
M v[196:199],a[164:167],a[108:111],0
T a[76:77],v2,57344
T a[78:79],v2,58368
M v[196:199],a[160:163],a[104:107],v[196:199]
T a[80:81],v3,49152
T a[82:83],v3,50176
M v[200:203],a[160:163],a[112:115],0
buffer_load_dwordx4 v12, s[48:51], s22 offen offset:0   lds
M v[200:203],a[164:167],a[116:119],v[200:203]
s_nop 0
T a[84:85],v3,57344
T a[86:87],v3,58368
M v[204:207],a[164:167],a[124:127],0
T a[88:89],v4,49152
T a[90:91],v4,50176
M v[204:207],a[160:163],a[120:123],v[204:207]
buffer_load_dwordx4 v13, s[48:51], s22 offen offset:1024   lds
M v[208:211],a[160:163],a[128:131],0
s_nop 0
T a[92:93],v4,57344
T a[94:95],v4,58368
M v[208:211],a[164:167],a[132:135],v[208:211]
buffer_load_dwordx4 v14, s[48:51], s22 offen offset:2048   lds
M v[212:215],a[164:167],a[140:143],0
buffer_load_dwordx4 v15, s[48:51], s22 offen offset:3072   lds
M v[212:215],a[160:163],a[136:139],v[212:215]
SA s22,s22,1048576
M v[216:219],a[160:163],a[144:147],0
M v[216:219],a[164:167],a[148:151],v[216:219]
s_waitcnt lgkmcnt(12)
M v[220:223],a[164:167],a[156:159],0
s_waitcnt vmcnt(12) lgkmcnt(0)
M v[220:223],a[160:163],a[152:155],v[220:223]
s_barrier
M v[224:227],a[168:171],a[96:99],0
SA m0,s23,32768
R a[160:163],v5,32768
R a[164:167],v6,32768
M v[224:227],a[172:175],a[100:103],v[224:227]
buffer_load_dwordx4 v8, s[16:19], s21 offen offset:0   lds
M v[228:231],a[172:175],a[108:111],0
M v[228:231],a[168:171],a[104:107],v[228:231]
M v[232:235],a[168:171],a[112:115],0
buffer_load_dwordx4 v9, s[16:19], s21 offen offset:1024   lds
M v[232:235],a[172:175],a[116:119],v[232:235]
M v[236:239],a[172:175],a[124:127],0
M v[236:239],a[168:171],a[120:123],v[236:239]
buffer_load_dwordx4 v10, s[16:19], s21 offen offset:2048   lds
M v[240:243],a[168:171],a[128:131],0
M v[240:243],a[172:175],a[132:135],v[240:243]
M v[244:247],a[172:175],a[140:143],0
buffer_load_dwordx4 v11, s[16:19], s21 offen offset:3072   lds
M v[244:247],a[168:171],a[136:139],v[244:247]
SA s21,s21,128
M v[248:251],a[168:171],a[144:147],0
M v[248:251],a[172:175],a[148:151],v[248:251]
s_waitcnt lgkmcnt(0)
M v[252:255],a[172:175],a[156:159],0
M v[252:255],a[168:171],a[152:155],v[252:255]
M a[0:3],a[160:163],a[32:35],a[0:3]
R a[168:171],v5,34816
R a[172:175],v6,34816
M a[0:3],a[164:167],a[36:39],a[0:3]
T a[96:97],v1,0
T a[98:99],v1,1024
M a[4:7],a[164:167],a[44:47],a[4:7]
SA m0,s24,16384
v_mov_b32 v16, 0
v_mov_b32 v17, 0
M a[4:7],a[160:163],a[40:43],a[4:7]
buffer_load_dwordx4 v12, s[48:51], s22 offen offset:0   lds
M a[8:11],a[160:163],a[48:51],a[8:11]
v_mov_b32 v18, 0
v_mov_b32 v19, 0
M a[8:11],a[164:167],a[52:55],a[8:11]
v_mov_b32 v20, 0
v_mov_b32 v21, 0
M a[12:15],a[164:167],a[60:63],a[12:15]
T a[100:101],v1,8192
T a[102:103],v1,9216
M a[12:15],a[160:163],a[56:59],a[12:15]
v_mov_b32 v22, 0
v_mov_b32 v23, 0
M a[16:19],a[160:163],a[64:67],a[16:19]
buffer_load_dwordx4 v13, s[48:51], s22 offen offset:1024   lds
M a[16:19],a[164:167],a[68:71],a[16:19]
G v28,a192
G v29,a196
M a[20:23],a[164:167],a[76:79],a[20:23]
v_lshlrev_b32 v27, 16, v28
v_lshlrev_b32 v25, 16, v29
M a[20:23],a[160:163],a[72:75],a[20:23]
T a[104:105],v2,0
T a[106:107],v2,1024
M a[24:27],a[160:163],a[80:83],a[24:27]
v_and_b32 v28, 0xffff0000, v28
v_and_b32 v29, 0xffff0000, v29
M a[24:27],a[164:167],a[84:87],a[24:27]
s_waitcnt lgkmcnt(6)
buffer_load_dwordx4 v14, s[48:51], s22 offen offset:2048   lds
M a[28:31],a[164:167],a[92:95],a[28:31]
G v30,a176
v_lshlrev_b32 v31, 16, v30
M a[28:31],a[160:163],a[88:91],a[28:31]
v_and_b32 v30, 0xffff0000, v30
v_fmac_f32 v16, v31, v27
M v[60:63],a[168:171],a[88:91],v[60:63]
R a[160:163],v5,36864
R a[164:167],v6,36864
M v[60:63],a[172:175],a[92:95],v[60:63]
T a[108:109],v2,8192
T a[110:111],v2,9216
M v[56:59],a[172:175],a[84:87],v[56:59]
buffer_load_dwordx4 v15, s[48:51], s22 offen offset:3072   lds
M v[56:59],a[168:171],a[80:83],v[56:59]
s_sub_u32 s22, s22, 1048448
v_fmac_f32 v20, v31, v25
v_fmac_f32 v16, v30, v28
M v[52:55],a[168:171],a[72:75],v[52:55]
v_fmac_f32 v20, v30, v29
G v30,a180
M v[52:55],a[172:175],a[76:79],v[52:55]
T a[112:113],v3,0
T a[114:115],v3,1024
M v[48:51],a[172:175],a[68:71],v[48:51]
SA m0,s23,49152
v_lshlrev_b32 v31, 16, v30
v_and_b32 v30, 0xffff0000, v30
M v[48:51],a[168:171],a[64:67],v[48:51]
buffer_load_dwordx4 v8, s[16:19], s21 offen offset:0   lds
M v[44:47],a[168:171],a[56:59],v[44:47]
v_fmac_f32 v17, v31, v27
v_fmac_f32 v21, v31, v25
M v[44:47],a[172:175],a[60:63],v[44:47]
v_fmac_f32 v17, v30, v28
v_fmac_f32 v21, v30, v29
M v[40:43],a[172:175],a[52:55],v[40:43]
T a[116:117],v3,8192
T a[118:119],v3,9216
M v[40:43],a[168:171],a[48:51],v[40:43]
G v30,a184
v_lshlrev_b32 v31, 16, v30
M v[36:39],a[168:171],a[40:43],v[36:39]
buffer_load_dwordx4 v9, s[16:19], s21 offen offset:1024   lds
M v[36:39],a[172:175],a[44:47],v[36:39]
s_waitcnt lgkmcnt(6)
v_and_b32 v30, 0xffff0000, v30
v_fmac_f32 v18, v31, v27
M v[32:35],a[172:175],a[36:39],v[32:35]
v_fmac_f32 v22, v31, v25
v_fmac_f32 v18, v30, v28
M v[32:35],a[168:171],a[32:35],v[32:35]
T a[120:121],v4,0
T a[122:123],v4,1024
M v[64:67],a[160:163],a[32:35],v[64:67]
R a[168:171],v5,38912
R a[172:175],v6,38912
M v[64:67],a[164:167],a[36:39],v[64:67]
buffer_load_dwordx4 v10, s[16:19], s21 offen offset:2048   lds
M v[68:71],a[164:167],a[44:47],v[68:71]
v_fmac_f32 v22, v30, v29
G v30,a188
M v[68:71],a[160:163],a[40:43],v[68:71]
v_lshlrev_b32 v31, 16, v30
v_and_b32 v30, 0xffff0000, v30
M v[72:75],a[160:163],a[48:51],v[72:75]
T a[124:125],v4,8192
T a[126:127],v4,9216
M v[72:75],a[164:167],a[52:55],v[72:75]
v_fmac_f32 v19, v31, v27
v_fmac_f32 v23, v31, v25
M v[76:79],a[164:167],a[60:63],v[76:79]
buffer_load_dwordx4 v11, s[16:19], s21 offen offset:3072   lds
M v[76:79],a[160:163],a[56:59],v[76:79]
SA s21,s21,524160
v_fmac_f32 v19, v30, v28
v_fmac_f32 v23, v30, v29
M v[80:83],a[160:163],a[64:67],v[80:83]
G v28,a193
G v29,a197
M v[80:83],a[164:167],a[68:71],v[80:83]
v_lshlrev_b32 v27, 16, v28
v_lshlrev_b32 v25, 16, v29
M v[84:87],a[164:167],a[76:79],v[84:87]
v_and_b32 v28, 0xffff0000, v28
v_and_b32 v29, 0xffff0000, v29
M v[84:87],a[160:163],a[72:75],v[84:87]
G v30,a177
v_lshlrev_b32 v31, 16, v30
M v[88:91],a[160:163],a[80:83],v[88:91]
v_and_b32 v30, 0xffff0000, v30
v_fmac_f32 v16, v31, v27
M v[88:91],a[164:167],a[84:87],v[88:91]
s_waitcnt lgkmcnt(2)
v_fmac_f32 v20, v31, v25
v_fmac_f32 v16, v30, v28
M v[92:95],a[164:167],a[92:95],v[92:95]
s_waitcnt vmcnt(16) lgkmcnt(0)
v_fmac_f32 v20, v30, v29
G v30,a181
M v[92:95],a[160:163],a[88:91],v[92:95]
s_barrier
M v[124:127],a[168:171],a[88:91],v[124:127]
R a[160:163],v5,49152
R a[164:167],v6,49152
M v[124:127],a[172:175],a[92:95],v[124:127]
v_lshlrev_b32 v31, 16, v30
v_and_b32 v30, 0xffff0000, v30
M v[120:123],a[172:175],a[84:87],v[120:123]
SA m0,s24,32768
T a[128:129],v1,16384
T a[130:131],v1,17408
M v[120:123],a[168:171],a[80:83],v[120:123]
buffer_load_dwordx4 v12, s[48:51], s22 offen offset:0   lds
M v[116:119],a[168:171],a[72:75],v[116:119]
v_fmac_f32 v17, v31, v27
v_fmac_f32 v21, v31, v25
M v[116:119],a[172:175],a[76:79],v[116:119]
v_fmac_f32 v17, v30, v28
v_fmac_f32 v21, v30, v29
M v[112:115],a[172:175],a[68:71],v[112:115]
G v30,a185
v_lshlrev_b32 v31, 16, v30
M v[112:115],a[168:171],a[64:67],v[112:115]
v_and_b32 v30, 0xffff0000, v30
v_fmac_f32 v18, v31, v27
M v[108:111],a[168:171],a[56:59],v[108:111]
v_fmac_f32 v22, v31, v25
v_fmac_f32 v18, v30, v28
M v[108:111],a[172:175],a[60:63],v[108:111]
T a[132:133],v1,24576
T a[134:135],v1,25600
M v[104:107],a[172:175],a[52:55],v[104:107]
buffer_load_dwordx4 v13, s[48:51], s22 offen offset:1024   lds
M v[104:107],a[168:171],a[48:51],v[104:107]
v_fmac_f32 v22, v30, v29
G v30,a189
M v[100:103],a[168:171],a[40:43],v[100:103]
v_lshlrev_b32 v31, 16, v30
v_and_b32 v30, 0xffff0000, v30
M v[100:103],a[172:175],a[44:47],v[100:103]
s_waitcnt lgkmcnt(4)
v_fmac_f32 v19, v31, v27
v_fmac_f32 v23, v31, v25
M v[96:99],a[172:175],a[36:39],v[96:99]
v_fmac_f32 v19, v30, v28
v_fmac_f32 v23, v30, v29
M v[96:99],a[168:171],a[32:35],v[96:99]
G v28,a194
G v29,a198
M v[128:131],a[160:163],a[32:35],v[128:131]
R a[168:171],v5,51200
R a[172:175],v6,51200
M v[128:131],a[164:167],a[36:39],v[128:131]
T a[136:137],v2,16384
T a[138:139],v2,17408
M v[132:135],a[164:167],a[44:47],v[132:135]
buffer_load_dwordx4 v14, s[48:51], s22 offen offset:2048   lds
M v[132:135],a[160:163],a[40:43],v[132:135]
v_lshlrev_b32 v27, 16, v28
v_lshlrev_b32 v25, 16, v29
M v[136:139],a[160:163],a[48:51],v[136:139]
v_and_b32 v28, 0xffff0000, v28
v_and_b32 v29, 0xffff0000, v29
M v[136:139],a[164:167],a[52:55],v[136:139]
G v30,a178
v_lshlrev_b32 v31, 16, v30
M v[140:143],a[164:167],a[60:63],v[140:143]
v_and_b32 v30, 0xffff0000, v30
v_fmac_f32 v16, v31, v27
M v[140:143],a[160:163],a[56:59],v[140:143]
T a[140:141],v2,24576
T a[142:143],v2,25600
M v[144:147],a[160:163],a[64:67],v[144:147]
buffer_load_dwordx4 v15, s[48:51], s22 offen offset:3072   lds
M v[144:147],a[164:167],a[68:71],v[144:147]
SA s22,s22,1048576
v_fmac_f32 v20, v31, v25
v_fmac_f32 v16, v30, v28
M v[148:151],a[164:167],a[76:79],v[148:151]
v_fmac_f32 v20, v30, v29
G v30,a182
M v[148:151],a[160:163],a[72:75],v[148:151]
v_lshlrev_b32 v31, 16, v30
v_and_b32 v30, 0xffff0000, v30
M v[152:155],a[160:163],a[80:83],v[152:155]
v_fmac_f32 v17, v31, v27
v_fmac_f32 v21, v31, v25
M v[152:155],a[164:167],a[84:87],v[152:155]
s_waitcnt lgkmcnt(4)
v_fmac_f32 v17, v30, v28
v_fmac_f32 v21, v30, v29
M v[156:159],a[164:167],a[92:95],v[156:159]
SA m0,s23,0
T a[144:145],v3,16384
T a[146:147],v3,17408
M v[156:159],a[160:163],a[88:91],v[156:159]
buffer_load_dwordx4 v8, s[16:19], s21 offen offset:0   lds
M v[188:191],a[168:171],a[88:91],v[188:191]
R a[160:163],v5,53248
R a[164:167],v6,53248
M v[188:191],a[172:175],a[92:95],v[188:191]
G v30,a186
v_lshlrev_b32 v31, 16, v30
M v[184:187],a[172:175],a[84:87],v[184:187]
v_and_b32 v30, 0xffff0000, v30
v_fmac_f32 v18, v31, v27
M v[184:187],a[168:171],a[80:83],v[184:187]
v_fmac_f32 v22, v31, v25
v_fmac_f32 v18, v30, v28
M v[180:183],a[168:171],a[72:75],v[180:183]
v_fmac_f32 v22, v30, v29
G v30,a190
M v[180:183],a[172:175],a[76:79],v[180:183]
L_w_kv11:
s_cbranch_execz L_w_kv15
T a[148:149],v3,24576
T a[150:151],v3,25600
M v[176:179],a[172:175],a[68:71],v[176:179]
buffer_load_dwordx4 v9, s[16:19], s21 offen offset:1024   lds
M v[176:179],a[168:171],a[64:67],v[176:179]
v_lshlrev_b32 v31, 16, v30
v_and_b32 v30, 0xffff0000, v30
M v[172:175],a[168:171],a[56:59],v[172:175]
v_fmac_f32 v19, v31, v27
v_fmac_f32 v23, v31, v25
M v[172:175],a[172:175],a[60:63],v[172:175]
v_fmac_f32 v19, v30, v28
v_fmac_f32 v23, v30, v29
M v[168:171],a[172:175],a[52:55],v[168:171]
M v[168:171],a[168:171],a[48:51],v[168:171]
M v[164:167],a[168:171],a[40:43],v[164:167]
s_nop 0
T a[152:153],v4,16384
T a[154:155],v4,17408
M v[164:167],a[172:175],a[44:47],v[164:167]
s_waitcnt lgkmcnt(4)
buffer_load_dwordx4 v10, s[16:19], s21 offen offset:2048   lds
M v[160:163],a[172:175],a[36:39],v[160:163]
M v[160:163],a[168:171],a[32:35],v[160:163]
M v[192:195],a[160:163],a[32:35],v[192:195]
R a[168:171],v5,55296
R a[172:175],v6,55296
M v[192:195],a[164:167],a[36:39],v[192:195]
M v[196:199],a[164:167],a[44:47],v[196:199]
M v[196:199],a[160:163],a[40:43],v[196:199]
s_nop 0
T a[156:157],v4,24576
T a[158:159],v4,25600
M v[200:203],a[160:163],a[48:51],v[200:203]
buffer_load_dwordx4 v11, s[16:19], s21 offen offset:3072   lds
M v[200:203],a[164:167],a[52:55],v[200:203]
SA s21,s21,128
M v[204:207],a[164:167],a[60:63],v[204:207]
M v[204:207],a[160:163],a[56:59],v[204:207]
M v[208:211],a[160:163],a[64:67],v[208:211]
M v[208:211],a[164:167],a[68:71],v[208:211]
M v[212:215],a[164:167],a[76:79],v[212:215]
M v[212:215],a[160:163],a[72:75],v[212:215]
M v[216:219],a[160:163],a[80:83],v[216:219]
M v[216:219],a[164:167],a[84:87],v[216:219]
s_waitcnt lgkmcnt(2)
M v[220:223],a[164:167],a[92:95],v[220:223]
s_waitcnt vmcnt(16) lgkmcnt(0)
M v[220:223],a[160:163],a[88:91],v[220:223]
s_barrier
M v[252:255],a[168:171],a[88:91],v[252:255]
R a[160:163],v5,0
R a[164:167],v6,0
M v[252:255],a[172:175],a[92:95],v[252:255]
M v[248:251],a[172:175],a[84:87],v[248:251]
M v[248:251],a[168:171],a[80:83],v[248:251]
M v[244:247],a[168:171],a[72:75],v[244:247]
M v[244:247],a[172:175],a[76:79],v[244:247]
M v[240:243],a[172:175],a[68:71],v[240:243]
M v[240:243],a[168:171],a[64:67],v[240:243]
M v[236:239],a[168:171],a[56:59],v[236:239]
M v[236:239],a[172:175],a[60:63],v[236:239]
M v[232:235],a[172:175],a[52:55],v[232:235]
M v[232:235],a[168:171],a[48:51],v[232:235]
M v[228:231],a[168:171],a[40:43],v[228:231]
M v[228:231],a[172:175],a[44:47],v[228:231]
s_waitcnt lgkmcnt(0)
M v[224:227],a[172:175],a[36:39],v[224:227]
M v[224:227],a[168:171],a[32:35],v[224:227]
M a[0:3],a[160:163],a[96:99],a[0:3]
R a[168:171],v5,2048
R a[172:175],v6,2048
M a[0:3],a[164:167],a[100:103],a[0:3]
T a[32:33],v1,32768
T a[34:35],v1,33792
M a[4:7],a[164:167],a[108:111],a[4:7]
SA m0,s24,49152
G v28,a195
G v29,a199
M a[4:7],a[160:163],a[104:107],a[4:7]
buffer_load_dwordx4 v12, s[48:51], s22 offen offset:0   lds
M a[8:11],a[160:163],a[112:115],a[8:11]
v_lshlrev_b32 v27, 16, v28
v_lshlrev_b32 v25, 16, v29
M a[8:11],a[164:167],a[116:119],a[8:11]
v_and_b32 v28, 0xffff0000, v28
v_and_b32 v29, 0xffff0000, v29
M a[12:15],a[164:167],a[124:127],a[12:15]
T a[36:37],v1,40960
T a[38:39],v1,41984
M a[12:15],a[160:163],a[120:123],a[12:15]
G v30,a179
v_lshlrev_b32 v31, 16, v30
M a[16:19],a[160:163],a[128:131],a[16:19]
buffer_load_dwordx4 v13, s[48:51], s22 offen offset:1024   lds
M a[16:19],a[164:167],a[132:135],a[16:19]
v_and_b32 v30, 0xffff0000, v30
v_fmac_f32 v16, v31, v27
M a[20:23],a[164:167],a[140:143],a[20:23]
v_fmac_f32 v20, v31, v25
v_fmac_f32 v16, v30, v28
M a[20:23],a[160:163],a[136:139],a[20:23]
T a[40:41],v2,32768
T a[42:43],v2,33792
M a[24:27],a[160:163],a[144:147],a[24:27]
v_fmac_f32 v20, v30, v29
G v30,a183
M a[24:27],a[164:167],a[148:151],a[24:27]
s_waitcnt lgkmcnt(6)
buffer_load_dwordx4 v14, s[48:51], s22 offen offset:2048   lds
M a[28:31],a[164:167],a[156:159],a[28:31]
v_lshlrev_b32 v31, 16, v30
v_and_b32 v30, 0xffff0000, v30
M a[28:31],a[160:163],a[152:155],a[28:31]
v_fmac_f32 v17, v31, v27
v_fmac_f32 v21, v31, v25
M v[60:63],a[168:171],a[152:155],v[60:63]
R a[160:163],v5,4096
R a[164:167],v6,4096
M v[60:63],a[172:175],a[156:159],v[60:63]
T a[44:45],v2,40960
T a[46:47],v2,41984
M v[56:59],a[172:175],a[148:151],v[56:59]
buffer_load_dwordx4 v15, s[48:51], s22 offen offset:3072   lds
M v[56:59],a[168:171],a[144:147],v[56:59]
s_sub_u32 s22, s22, 1048448
v_fmac_f32 v17, v30, v28
v_fmac_f32 v21, v30, v29
M v[52:55],a[168:171],a[136:139],v[52:55]
G v30,a187
v_lshlrev_b32 v31, 16, v30
M v[52:55],a[172:175],a[140:143],v[52:55]
T a[48:49],v3,32768
T a[50:51],v3,33792
M v[48:51],a[172:175],a[132:135],v[48:51]
SA m0,s23,16384
v_and_b32 v30, 0xffff0000, v30
v_fmac_f32 v18, v31, v27
M v[48:51],a[168:171],a[128:131],v[48:51]
buffer_load_dwordx4 v8, s[16:19], s21 offen offset:0   lds
M v[44:47],a[168:171],a[120:123],v[44:47]
v_fmac_f32 v22, v31, v25
v_fmac_f32 v18, v30, v28
M v[44:47],a[172:175],a[124:127],v[44:47]
v_fmac_f32 v22, v30, v29
G v30,a191
M v[40:43],a[172:175],a[116:119],v[40:43]
T a[52:53],v3,40960
T a[54:55],v3,41984
M v[40:43],a[168:171],a[112:115],v[40:43]
v_lshlrev_b32 v31, 16, v30
v_and_b32 v30, 0xffff0000, v30
M v[36:39],a[168:171],a[104:107],v[36:39]
buffer_load_dwordx4 v9, s[16:19], s21 offen offset:1024   lds
M v[36:39],a[172:175],a[108:111],v[36:39]
s_waitcnt lgkmcnt(6)
v_fmac_f32 v19, v31, v27
v_fmac_f32 v23, v31, v25
M v[32:35],a[172:175],a[100:103],v[32:35]
v_fmac_f32 v19, v30, v28
v_fmac_f32 v23, v30, v29
M v[32:35],a[168:171],a[96:99],v[32:35]
T a[56:57],v4,32768
T a[58:59],v4,33792
M v[64:67],a[160:163],a[96:99],v[64:67]
R a[168:171],v5,6144
R a[172:175],v6,6144
M v[64:67],a[164:167],a[100:103],v[64:67]
buffer_load_dwordx4 v10, s[16:19], s21 offen offset:2048   lds
M v[68:71],a[164:167],a[108:111],v[68:71]
v_permlane32_swap_b32 v16, v18
M v[68:71],a[160:163],a[104:107],v[68:71]
v_permlane32_swap_b32 v17, v19
M v[72:75],a[160:163],a[112:115],v[72:75]
s_nop 0
T a[60:61],v4,40960
T a[62:63],v4,41984
M v[72:75],a[164:167],a[116:119],v[72:75]
v_permlane32_swap_b32 v20, v22
M v[76:79],a[164:167],a[124:127],v[76:79]
buffer_load_dwordx4 v11, s[16:19], s21 offen offset:3072   lds
M v[76:79],a[160:163],a[120:123],v[76:79]
SA s21,s21,524160
v_permlane32_swap_b32 v21, v23
M v[80:83],a[160:163],a[128:131],v[80:83]
AF v16,v16,v18
AF v17,v17,v19
M v[80:83],a[164:167],a[132:135],v[80:83]
AF v20,v20,v22
AF v21,v21,v23
M v[84:87],a[164:167],a[140:143],v[84:87]
v_lshrrev_b32 v28, 4, v0
M v[84:87],a[160:163],a[136:139],v[84:87]
v_permlane16_swap_b32 v16, v17
M v[88:91],a[160:163],a[144:147],v[88:91]
v_permlane16_swap_b32 v20, v21
M v[88:91],a[164:167],a[148:151],v[88:91]
s_waitcnt lgkmcnt(2)
AF v16,v16,v17
AF v20,v20,v21
M v[92:95],a[164:167],a[156:159],v[92:95]
s_waitcnt vmcnt(16) lgkmcnt(0)
v_add_u32 v29, s67, v28
v_add_f32 v16, v16, v16 row_ror:8 row_mask:0xf bank_mask:0xf
M v[92:95],a[160:163],a[152:155],v[92:95]
s_barrier
M v[124:127],a[168:171],a[152:155],v[124:127]
R a[160:163],v5,16384
R a[164:167],v6,16384
M v[124:127],a[172:175],a[156:159],v[124:127]
v_add_f32 v20, v20, v20 row_ror:8 row_mask:0xf bank_mask:0xf
v_add_f32 v16, v16, v16 row_ror:4 row_mask:0xf bank_mask:0xf
M v[120:123],a[172:175],a[148:151],v[120:123]
SA m0,s24,0
T a[64:65],v1,49152
T a[66:67],v1,50176
M v[120:123],a[168:171],a[144:147],v[120:123]
buffer_load_dwordx4 v12, s[48:51], s22 offen offset:0   lds
M v[116:119],a[168:171],a[136:139],v[116:119]
v_add_f32 v20, v20, v20 row_ror:4 row_mask:0xf bank_mask:0xf
v_add_f32 v16, v16, v16 row_ror:2 row_mask:0xf bank_mask:0xf
M v[116:119],a[172:175],a[140:143],v[116:119]
v_add_f32 v20, v20, v20 row_ror:2 row_mask:0xf bank_mask:0xf
v_add_f32 v16, v16, v16 row_ror:1 row_mask:0xf bank_mask:0xf
M v[112:115],a[172:175],a[132:135],v[112:115]
v_add_f32 v20, v20, v20 row_ror:1 row_mask:0xf bank_mask:0xf
v_ashrrev_i32 v30, 31, v16
M v[112:115],a[168:171],a[128:131],v[112:115]
v_or_b32 v30, 0x80000000, v30
v_xor_b32 v30, v30, v16
M v[108:111],a[168:171],a[120:123],v[108:111]
v_and_b32 v30, 0xfffff800, v30
v_sub_u32 v29, 2047, v29
M v[108:111],a[172:175],a[124:127],v[108:111]
T a[68:69],v1,57344
T a[70:71],v1,58368
M v[104:107],a[172:175],a[116:119],v[104:107]
buffer_load_dwordx4 v13, s[48:51], s22 offen offset:1024   lds
M v[104:107],a[168:171],a[112:115],v[104:107]
v_or_b32 v30, v30, v29
v_max_u32 v30, 1, v30
M v[100:103],a[168:171],a[104:107],v[100:103]
MF v21,0xbfb8aa3b,v20
M v[100:103],a[172:175],a[108:111],v[100:103]
s_waitcnt lgkmcnt(4)
E v21,v21
M v[96:99],a[172:175],a[100:103],v[96:99]
AF v21,1.0,v21
M v[96:99],a[168:171],a[96:99],v[96:99]
v_rcp_f32 v20, v21
M v[128:131],a[160:163],a[96:99],v[128:131]
s_lshl_b32 s72, s20, 4
R a[168:171],v5,18432
R a[172:175],v6,18432
M v[128:131],a[164:167],a[100:103],v[128:131]
SA s72,s72,163584
T a[72:73],v2,49152
T a[74:75],v2,50176
M v[132:135],a[164:167],a[108:111],v[132:135]
buffer_load_dwordx4 v14, s[48:51], s22 offen offset:2048   lds
M v[132:135],a[160:163],a[104:107],v[132:135]
v_lshl_add_u32 v28, v28, 2, s72
ds_write_b32 v28, v30
M v[136:139],a[160:163],a[112:115],v[136:139]
ds_write_b32 v28, v16 offset:64
ds_write_b32 v28, v20 offset:128
M v[136:139],a[164:167],a[116:119],v[136:139]
M v[140:143],a[164:167],a[124:127],v[140:143]
M v[140:143],a[160:163],a[120:123],v[140:143]
s_nop 0
T a[76:77],v2,57344
T a[78:79],v2,58368
M v[144:147],a[160:163],a[128:131],v[144:147]
buffer_load_dwordx4 v15, s[48:51], s22 offen offset:3072   lds
M v[144:147],a[164:167],a[132:135],v[144:147]
SA s22,s22,1048576
M v[148:151],a[164:167],a[140:143],v[148:151]
M v[148:151],a[160:163],a[136:139],v[148:151]
M v[152:155],a[160:163],a[144:147],v[152:155]
M v[152:155],a[164:167],a[148:151],v[152:155]
s_waitcnt lgkmcnt(7)
M v[156:159],a[164:167],a[156:159],v[156:159]
SA m0,s23,32768
T a[80:81],v3,49152
T a[82:83],v3,50176
M v[156:159],a[160:163],a[152:155],v[156:159]
buffer_load_dwordx4 v8, s[16:19], s21 offen offset:0   lds
M v[188:191],a[168:171],a[152:155],v[188:191]
R a[160:163],v5,20480
R a[164:167],v6,20480
M v[188:191],a[172:175],a[156:159],v[188:191]
M v[184:187],a[172:175],a[148:151],v[184:187]
M v[184:187],a[168:171],a[144:147],v[184:187]
M v[180:183],a[168:171],a[136:139],v[180:183]
M v[180:183],a[172:175],a[140:143],v[180:183]
s_nop 0
T a[84:85],v3,57344
T a[86:87],v3,58368
M v[176:179],a[172:175],a[132:135],v[176:179]
buffer_load_dwordx4 v9, s[16:19], s21 offen offset:1024   lds
M v[176:179],a[168:171],a[128:131],v[176:179]
M v[172:175],a[168:171],a[120:123],v[172:175]
M v[172:175],a[172:175],a[124:127],v[172:175]
M v[168:171],a[172:175],a[116:119],v[168:171]
M v[168:171],a[168:171],a[112:115],v[168:171]
M v[164:167],a[168:171],a[104:107],v[164:167]
s_nop 0
T a[88:89],v4,49152
T a[90:91],v4,50176
M v[164:167],a[172:175],a[108:111],v[164:167]
s_waitcnt lgkmcnt(4)
buffer_load_dwordx4 v10, s[16:19], s21 offen offset:2048   lds
M v[160:163],a[172:175],a[100:103],v[160:163]
M v[160:163],a[168:171],a[96:99],v[160:163]
M v[192:195],a[160:163],a[96:99],v[192:195]
R a[168:171],v5,22528
R a[172:175],v6,22528
M v[192:195],a[164:167],a[100:103],v[192:195]
M v[196:199],a[164:167],a[108:111],v[196:199]
M v[196:199],a[160:163],a[104:107],v[196:199]
s_nop 0
T a[92:93],v4,57344
T a[94:95],v4,58368
M v[200:203],a[160:163],a[112:115],v[200:203]
buffer_load_dwordx4 v11, s[16:19], s21 offen offset:3072   lds
M v[200:203],a[164:167],a[116:119],v[200:203]
SA s21,s21,128
M v[204:207],a[164:167],a[124:127],v[204:207]
M v[204:207],a[160:163],a[120:123],v[204:207]
M v[208:211],a[160:163],a[128:131],v[208:211]
M v[208:211],a[164:167],a[132:135],v[208:211]
M v[212:215],a[164:167],a[140:143],v[212:215]
M v[212:215],a[160:163],a[136:139],v[212:215]
M v[216:219],a[160:163],a[144:147],v[216:219]
M v[216:219],a[164:167],a[148:151],v[216:219]
s_waitcnt lgkmcnt(2)
M v[220:223],a[164:167],a[156:159],v[220:223]
s_waitcnt vmcnt(16) lgkmcnt(0)
M v[220:223],a[160:163],a[152:155],v[220:223]
s_barrier
M v[252:255],a[168:171],a[152:155],v[252:255]
R a[160:163],v5,32768
R a[164:167],v6,32768
M v[252:255],a[172:175],a[156:159],v[252:255]
M v[248:251],a[172:175],a[148:151],v[248:251]
M v[248:251],a[168:171],a[144:147],v[248:251]
M v[244:247],a[168:171],a[136:139],v[244:247]
M v[244:247],a[172:175],a[140:143],v[244:247]
M v[240:243],a[172:175],a[132:135],v[240:243]
M v[240:243],a[168:171],a[128:131],v[240:243]
M v[236:239],a[168:171],a[120:123],v[236:239]
M v[236:239],a[172:175],a[124:127],v[236:239]
M v[232:235],a[172:175],a[116:119],v[232:235]
M v[232:235],a[168:171],a[112:115],v[232:235]
M v[228:231],a[168:171],a[104:107],v[228:231]
M v[228:231],a[172:175],a[108:111],v[228:231]
s_waitcnt lgkmcnt(0)
M v[224:227],a[172:175],a[100:103],v[224:227]
M v[224:227],a[168:171],a[96:99],v[224:227]
M a[0:3],a[160:163],a[32:35],a[0:3]
R a[168:171],v5,34816
R a[172:175],v6,34816
M a[0:3],a[164:167],a[36:39],a[0:3]
T a[96:97],v1,0
T a[98:99],v1,1024
M a[4:7],a[164:167],a[44:47],a[4:7]
SA m0,s24,16384
M a[4:7],a[160:163],a[40:43],a[4:7]
buffer_load_dwordx4 v12, s[48:51], s22 offen offset:0   lds
M a[8:11],a[160:163],a[48:51],a[8:11]
v_and_b32 v20, 31, v0
M a[8:11],a[164:167],a[52:55],a[8:11]
v_lshlrev_b32 v20, 2, v20
M a[12:15],a[164:167],a[60:63],a[12:15]
s_nop 0
T a[100:101],v1,8192
T a[102:103],v1,9216
M a[12:15],a[160:163],a[56:59],a[12:15]
v_add_u32 v21, 163584, v20
M a[16:19],a[160:163],a[64:67],a[16:19]
buffer_load_dwordx4 v13, s[48:51], s22 offen offset:1024   lds
M a[16:19],a[164:167],a[68:71],a[16:19]
ds_read_b32 v19, v21
M a[20:23],a[164:167],a[76:79],a[20:23]
ds_read_b32 v21, v21 offset:64
M a[20:23],a[160:163],a[72:75],a[20:23]
s_min_u32 s64, s20, 1
T a[104:105],v2,0
T a[106:107],v2,1024
M a[24:27],a[160:163],a[80:83],a[24:27]
s_lshl_b32 s64, s64, 29
v_and_b32 v22, 32, v0
M a[24:27],a[164:167],a[84:87],a[24:27]
s_waitcnt lgkmcnt(8)
buffer_load_dwordx4 v14, s[48:51], s22 offen offset:2048   lds
M a[28:31],a[164:167],a[92:95],a[28:31]
v_lshl_or_b32 v20, v22, 24, v20
M a[28:31],a[160:163],a[88:91],a[28:31]
v_or_b32 v20, s64, v20
M v[60:63],a[168:171],a[88:91],v[60:63]
R a[160:163],v5,36864
R a[164:167],v6,36864
M v[60:63],a[172:175],a[92:95],v[60:63]
T a[108:109],v2,8192
T a[110:111],v2,9216
M v[56:59],a[172:175],a[84:87],v[56:59]
buffer_load_dwordx4 v15, s[48:51], s22 offen offset:3072   lds
M v[56:59],a[168:171],a[80:83],v[56:59]
s_sub_u32 s22, s22, 1048448
v_and_b32 v22, 16, v0
M v[52:55],a[168:171],a[72:75],v[52:55]
v_lshl_or_b32 v18, v22, 25, v20
s_and_b32 s27, s42, 7
M v[52:55],a[172:175],a[76:79],v[52:55]
s_lshl_b32 s72, s30, 7
T a[112:113],v3,0
T a[114:115],v3,1024
M v[48:51],a[172:175],a[68:71],v[48:51]
SA m0,s23,49152
SA s72,s72,104857600
s_lshl_b32 s64, s41, 3
M v[48:51],a[168:171],a[64:67],v[48:51]
SA s27,s27,s64
buffer_load_dwordx4 v8, s[16:19], s21 offen offset:0   lds
M v[44:47],a[168:171],a[56:59],v[44:47]
s_lshl_b32 s27, s27, 2
M v[44:47],a[172:175],a[60:63],v[44:47]
SA s27,s27,s20
M v[40:43],a[172:175],a[52:55],v[40:43]
s_mul_i32 s27, s27, 7168
T a[116:117],v3,8192
T a[118:119],v3,9216
M v[40:43],a[168:171],a[48:51],v[40:43]
s_mov_b32 s60, s90
M v[36:39],a[168:171],a[40:43],v[36:39]
s_and_b32 s61, s91, 0xffff
buffer_load_dwordx4 v9, s[16:19], s21 offen offset:1024   lds
M v[36:39],a[172:175],a[44:47],v[36:39]
s_waitcnt lgkmcnt(6)
buffer_store_dword v21, v20, s[8:11], s72 offen sc1
M v[32:35],a[172:175],a[36:39],v[32:35]
s_mov_b32 s62, 3670016
M v[32:35],a[168:171],a[32:35],v[32:35]
s_mov_b32 s63, 0x20000
T a[120:121],v4,0
T a[122:123],v4,1024
M v[64:67],a[160:163],a[32:35],v[64:67]
R a[168:171],v5,38912
R a[172:175],v6,38912
M v[64:67],a[164:167],a[36:39],v[64:67]
buffer_load_dwordx4 v10, s[16:19], s21 offen offset:2048   lds
M v[68:71],a[164:167],a[44:47],v[68:71]
M v[68:71],a[160:163],a[40:43],v[68:71]
M v[72:75],a[160:163],a[48:51],v[72:75]
s_nop 0
T a[124:125],v4,8192
T a[126:127],v4,9216
M v[72:75],a[164:167],a[52:55],v[72:75]
M v[76:79],a[164:167],a[60:63],v[76:79]
buffer_load_dwordx4 v11, s[16:19], s21 offen offset:3072   lds
M v[76:79],a[160:163],a[56:59],v[76:79]
SA s21,s21,524160
M v[80:83],a[160:163],a[64:67],v[80:83]
M v[80:83],a[164:167],a[68:71],v[80:83]
M v[84:87],a[164:167],a[76:79],v[84:87]
M v[84:87],a[160:163],a[72:75],v[84:87]
M v[88:91],a[160:163],a[80:83],v[88:91]
M v[88:91],a[164:167],a[84:87],v[88:91]
s_waitcnt lgkmcnt(2)
M v[92:95],a[164:167],a[92:95],v[92:95]
s_waitcnt vmcnt(17) lgkmcnt(0)
M v[92:95],a[160:163],a[88:91],v[92:95]
s_barrier
M v[124:127],a[168:171],a[88:91],v[124:127]
R a[160:163],v5,49152
R a[164:167],v6,49152
M v[124:127],a[172:175],a[92:95],v[124:127]
M v[120:123],a[172:175],a[84:87],v[120:123]
SA m0,s24,32768
T a[128:129],v1,16384
T a[130:131],v1,17408
M v[120:123],a[168:171],a[80:83],v[120:123]
buffer_load_dwordx4 v12, s[48:51], s22 offen offset:0   lds
M v[116:119],a[168:171],a[72:75],v[116:119]
v_min_u32 v16, 40, v0
v_lshlrev_b32 v16, 2, v16
M v[116:119],a[172:175],a[76:79],v[116:119]
buffer_load_dword v17, v16, s[12:15], 0 offen sc1
M v[112:115],a[172:175],a[68:71],v[112:115]
M v[112:115],a[168:171],a[64:67],v[112:115]
M v[108:111],a[168:171],a[56:59],v[108:111]
M v[108:111],a[172:175],a[60:63],v[108:111]
s_nop 0
T a[132:133],v1,24576
T a[134:135],v1,25600
M v[104:107],a[172:175],a[52:55],v[104:107]
buffer_load_dwordx4 v13, s[48:51], s22 offen offset:1024   lds
M v[104:107],a[168:171],a[48:51],v[104:107]
M v[100:103],a[168:171],a[40:43],v[100:103]
M v[100:103],a[172:175],a[44:47],v[100:103]
s_waitcnt lgkmcnt(4)
M v[96:99],a[172:175],a[36:39],v[96:99]
M v[96:99],a[168:171],a[32:35],v[96:99]
M v[128:131],a[160:163],a[32:35],v[128:131]
R a[168:171],v5,51200
R a[172:175],v6,51200
M v[128:131],a[164:167],a[36:39],v[128:131]
T a[136:137],v2,16384
T a[138:139],v2,17408
M v[132:135],a[164:167],a[44:47],v[132:135]
buffer_load_dwordx4 v14, s[48:51], s22 offen offset:2048   lds
M v[132:135],a[160:163],a[40:43],v[132:135]
M v[136:139],a[160:163],a[48:51],v[136:139]
M v[136:139],a[164:167],a[52:55],v[136:139]
M v[140:143],a[164:167],a[60:63],v[140:143]
M v[140:143],a[160:163],a[56:59],v[140:143]
s_nop 0
T a[140:141],v2,24576
T a[142:143],v2,25600
M v[144:147],a[160:163],a[64:67],v[144:147]
buffer_load_dwordx4 v15, s[48:51], s22 offen offset:3072   lds
M v[144:147],a[164:167],a[68:71],v[144:147]
SA s22,s22,1048576
M v[148:151],a[164:167],a[76:79],v[148:151]
M v[148:151],a[160:163],a[72:75],v[148:151]
M v[152:155],a[160:163],a[80:83],v[152:155]
M v[152:155],a[164:167],a[84:87],v[152:155]
s_waitcnt lgkmcnt(4)
M v[156:159],a[164:167],a[92:95],v[156:159]
SA m0,s23,0
T a[144:145],v3,16384
T a[146:147],v3,17408
M v[156:159],a[160:163],a[88:91],v[156:159]
buffer_load_dwordx4 v8, s[16:19], s21 offen offset:0   lds
M v[188:191],a[168:171],a[88:91],v[188:191]
R a[160:163],v5,53248
R a[164:167],v6,53248
M v[188:191],a[172:175],a[92:95],v[188:191]
buffer_load_dword a240, v26, s[60:63], s27 offen offset:0
M v[184:187],a[172:175],a[84:87],v[184:187]
SA s27,s27,2048
M v[184:187],a[168:171],a[80:83],v[184:187]
M v[180:183],a[168:171],a[72:75],v[180:183]
M v[180:183],a[172:175],a[76:79],v[180:183]
s_nop 0
T a[148:149],v3,24576
T a[150:151],v3,25600
M v[176:179],a[172:175],a[68:71],v[176:179]
buffer_load_dwordx4 v9, s[16:19], s21 offen offset:1024   lds
M v[176:179],a[168:171],a[64:67],v[176:179]
M v[172:175],a[168:171],a[56:59],v[172:175]
M v[172:175],a[172:175],a[60:63],v[172:175]
M v[168:171],a[172:175],a[52:55],v[168:171]
M v[168:171],a[168:171],a[48:51],v[168:171]
M v[164:167],a[168:171],a[40:43],v[164:167]
s_nop 0
T a[152:153],v4,16384
T a[154:155],v4,17408
M v[164:167],a[172:175],a[44:47],v[164:167]
s_waitcnt lgkmcnt(4)
buffer_load_dwordx4 v10, s[16:19], s21 offen offset:2048   lds
M v[160:163],a[172:175],a[36:39],v[160:163]
M v[160:163],a[168:171],a[32:35],v[160:163]
M v[192:195],a[160:163],a[32:35],v[192:195]
L_w_kv12:
s_cbranch_execz L_w_kv16
R a[168:171],v5,55296
R a[172:175],v6,55296
M v[192:195],a[164:167],a[36:39],v[192:195]
M v[196:199],a[164:167],a[44:47],v[196:199]
M v[196:199],a[160:163],a[40:43],v[196:199]
s_nop 0
T a[156:157],v4,24576
T a[158:159],v4,25600
M v[200:203],a[160:163],a[48:51],v[200:203]
buffer_load_dwordx4 v11, s[16:19], s21 offen offset:3072   lds
M v[200:203],a[164:167],a[52:55],v[200:203]
SA s21,s21,128
M v[204:207],a[164:167],a[60:63],v[204:207]
M v[204:207],a[160:163],a[56:59],v[204:207]
M v[208:211],a[160:163],a[64:67],v[208:211]
M v[208:211],a[164:167],a[68:71],v[208:211]
M v[212:215],a[164:167],a[76:79],v[212:215]
M v[212:215],a[160:163],a[72:75],v[212:215]
M v[216:219],a[160:163],a[80:83],v[216:219]
M v[216:219],a[164:167],a[84:87],v[216:219]
s_waitcnt lgkmcnt(2)
M v[220:223],a[164:167],a[92:95],v[220:223]
s_waitcnt vmcnt(19) lgkmcnt(0)
M v[220:223],a[160:163],a[88:91],v[220:223]
s_barrier
M v[252:255],a[168:171],a[88:91],v[252:255]
R a[160:163],v5,0
R a[164:167],v6,0
M v[252:255],a[172:175],a[92:95],v[252:255]
M v[248:251],a[172:175],a[84:87],v[248:251]
M v[248:251],a[168:171],a[80:83],v[248:251]
M v[244:247],a[168:171],a[72:75],v[244:247]
M v[244:247],a[172:175],a[76:79],v[244:247]
M v[240:243],a[172:175],a[68:71],v[240:243]
M v[240:243],a[168:171],a[64:67],v[240:243]
M v[236:239],a[168:171],a[56:59],v[236:239]
M v[236:239],a[172:175],a[60:63],v[236:239]
M v[232:235],a[172:175],a[52:55],v[232:235]
M v[232:235],a[168:171],a[48:51],v[232:235]
M v[228:231],a[168:171],a[40:43],v[228:231]
M v[228:231],a[172:175],a[44:47],v[228:231]
s_waitcnt lgkmcnt(0)
M v[224:227],a[172:175],a[36:39],v[224:227]
M v[224:227],a[168:171],a[32:35],v[224:227]
M a[0:3],a[160:163],a[96:99],a[0:3]
R a[168:171],v5,2048
R a[172:175],v6,2048
M a[0:3],a[164:167],a[100:103],a[0:3]
T a[32:33],v1,32768
T a[34:35],v1,33792
M a[4:7],a[164:167],a[108:111],a[4:7]
SA m0,s24,49152
M a[4:7],a[160:163],a[104:107],a[4:7]
buffer_load_dwordx4 v12, s[48:51], s22 offen offset:0   lds
M a[8:11],a[160:163],a[112:115],a[8:11]
M a[8:11],a[164:167],a[116:119],a[8:11]
M a[12:15],a[164:167],a[124:127],a[12:15]
s_nop 0
T a[36:37],v1,40960
T a[38:39],v1,41984
M a[12:15],a[160:163],a[120:123],a[12:15]
M a[16:19],a[160:163],a[128:131],a[16:19]
buffer_load_dwordx4 v13, s[48:51], s22 offen offset:1024   lds
M a[16:19],a[164:167],a[132:135],a[16:19]
M a[20:23],a[164:167],a[140:143],a[20:23]
M a[20:23],a[160:163],a[136:139],a[20:23]
s_nop 0
T a[40:41],v2,32768
T a[42:43],v2,33792
M a[24:27],a[160:163],a[144:147],a[24:27]
M a[24:27],a[164:167],a[148:151],a[24:27]
s_waitcnt lgkmcnt(6)
buffer_load_dwordx4 v14, s[48:51], s22 offen offset:2048   lds
M a[28:31],a[164:167],a[156:159],a[28:31]
M a[28:31],a[160:163],a[152:155],a[28:31]
M v[60:63],a[168:171],a[152:155],v[60:63]
R a[160:163],v5,4096
R a[164:167],v6,4096
M v[60:63],a[172:175],a[156:159],v[60:63]
T a[44:45],v2,40960
T a[46:47],v2,41984
M v[56:59],a[172:175],a[148:151],v[56:59]
buffer_load_dwordx4 v15, s[48:51], s22 offen offset:3072   lds
M v[56:59],a[168:171],a[144:147],v[56:59]
s_sub_u32 s22, s22, 1048448
M v[52:55],a[168:171],a[136:139],v[52:55]
M v[52:55],a[172:175],a[140:143],v[52:55]
s_nop 0
T a[48:49],v3,32768
T a[50:51],v3,33792
M v[48:51],a[172:175],a[132:135],v[48:51]
SA m0,s23,16384
M v[48:51],a[168:171],a[128:131],v[48:51]
buffer_load_dwordx4 v8, s[16:19], s21 offen offset:0   lds
M v[44:47],a[168:171],a[120:123],v[44:47]
M v[44:47],a[172:175],a[124:127],v[44:47]
M v[40:43],a[172:175],a[116:119],v[40:43]
s_nop 0
T a[52:53],v3,40960
T a[54:55],v3,41984
M v[40:43],a[168:171],a[112:115],v[40:43]
M v[36:39],a[168:171],a[104:107],v[36:39]
buffer_load_dwordx4 v9, s[16:19], s21 offen offset:1024   lds
M v[36:39],a[172:175],a[108:111],v[36:39]
s_waitcnt lgkmcnt(6)
M v[32:35],a[172:175],a[100:103],v[32:35]
M v[32:35],a[168:171],a[96:99],v[32:35]
s_nop 0
T a[56:57],v4,32768
T a[58:59],v4,33792
M v[64:67],a[160:163],a[96:99],v[64:67]
R a[168:171],v5,6144
R a[172:175],v6,6144
M v[64:67],a[164:167],a[100:103],v[64:67]
buffer_load_dwordx4 v10, s[16:19], s21 offen offset:2048   lds
M v[68:71],a[164:167],a[108:111],v[68:71]
M v[68:71],a[160:163],a[104:107],v[68:71]
M v[72:75],a[160:163],a[112:115],v[72:75]
s_nop 0
T a[60:61],v4,40960
T a[62:63],v4,41984
M v[72:75],a[164:167],a[116:119],v[72:75]
M v[76:79],a[164:167],a[124:127],v[76:79]
buffer_load_dwordx4 v11, s[16:19], s21 offen offset:3072   lds
M v[76:79],a[160:163],a[120:123],v[76:79]
SA s21,s21,524160
M v[80:83],a[160:163],a[128:131],v[80:83]
M v[80:83],a[164:167],a[132:135],v[80:83]
M v[84:87],a[164:167],a[140:143],v[84:87]
M v[84:87],a[160:163],a[136:139],v[84:87]
M v[88:91],a[160:163],a[144:147],v[88:91]
M v[88:91],a[164:167],a[148:151],v[88:91]
s_waitcnt lgkmcnt(2)
M v[92:95],a[164:167],a[156:159],v[92:95]
s_waitcnt vmcnt(18) lgkmcnt(0)
M v[92:95],a[160:163],a[152:155],v[92:95]
s_barrier
M v[124:127],a[168:171],a[152:155],v[124:127]
R a[160:163],v5,16384
R a[164:167],v6,16384
M v[124:127],a[172:175],a[156:159],v[124:127]
M v[120:123],a[172:175],a[148:151],v[120:123]
SA m0,s24,0
T a[64:65],v1,49152
T a[66:67],v1,50176
M v[120:123],a[168:171],a[144:147],v[120:123]
buffer_load_dwordx4 v12, s[48:51], s22 offen offset:0   lds
M v[116:119],a[168:171],a[136:139],v[116:119]
M v[116:119],a[172:175],a[140:143],v[116:119]
M v[112:115],a[172:175],a[132:135],v[112:115]
M v[112:115],a[168:171],a[128:131],v[112:115]
M v[108:111],a[168:171],a[120:123],v[108:111]
M v[108:111],a[172:175],a[124:127],v[108:111]
s_nop 0
T a[68:69],v1,57344
T a[70:71],v1,58368
M v[104:107],a[172:175],a[116:119],v[104:107]
buffer_load_dwordx4 v13, s[48:51], s22 offen offset:1024   lds
M v[104:107],a[168:171],a[112:115],v[104:107]
M v[100:103],a[168:171],a[104:107],v[100:103]
M v[100:103],a[172:175],a[108:111],v[100:103]
s_waitcnt lgkmcnt(4)
M v[96:99],a[172:175],a[100:103],v[96:99]
M v[96:99],a[168:171],a[96:99],v[96:99]
M v[128:131],a[160:163],a[96:99],v[128:131]
R a[168:171],v5,18432
R a[172:175],v6,18432
M v[128:131],a[164:167],a[100:103],v[128:131]
T a[72:73],v2,49152
T a[74:75],v2,50176
M v[132:135],a[164:167],a[108:111],v[132:135]
buffer_load_dwordx4 v14, s[48:51], s22 offen offset:2048   lds
M v[132:135],a[160:163],a[104:107],v[132:135]
M v[136:139],a[160:163],a[112:115],v[136:139]
M v[136:139],a[164:167],a[116:119],v[136:139]
M v[140:143],a[164:167],a[124:127],v[140:143]
M v[140:143],a[160:163],a[120:123],v[140:143]
s_nop 0
T a[76:77],v2,57344
T a[78:79],v2,58368
M v[144:147],a[160:163],a[128:131],v[144:147]
buffer_load_dwordx4 v15, s[48:51], s22 offen offset:3072   lds
M v[144:147],a[164:167],a[132:135],v[144:147]
SA s22,s22,1048576
M v[148:151],a[164:167],a[140:143],v[148:151]
M v[148:151],a[160:163],a[136:139],v[148:151]
M v[152:155],a[160:163],a[144:147],v[152:155]
M v[152:155],a[164:167],a[148:151],v[152:155]
s_waitcnt lgkmcnt(4)
M v[156:159],a[164:167],a[156:159],v[156:159]
SA m0,s23,32768
T a[80:81],v3,49152
T a[82:83],v3,50176
M v[156:159],a[160:163],a[152:155],v[156:159]
buffer_load_dwordx4 v8, s[16:19], s21 offen offset:0   lds
M v[188:191],a[168:171],a[152:155],v[188:191]
R a[160:163],v5,20480
R a[164:167],v6,20480
M v[188:191],a[172:175],a[156:159],v[188:191]
buffer_load_dword a240, v26, s[60:63], s27 offen offset:0
M v[184:187],a[172:175],a[148:151],v[184:187]
SA s27,s27,2048
M v[184:187],a[168:171],a[144:147],v[184:187]
M v[180:183],a[168:171],a[136:139],v[180:183]
M v[180:183],a[172:175],a[140:143],v[180:183]
s_nop 0
T a[84:85],v3,57344
T a[86:87],v3,58368
M v[176:179],a[172:175],a[132:135],v[176:179]
buffer_load_dwordx4 v9, s[16:19], s21 offen offset:1024   lds
M v[176:179],a[168:171],a[128:131],v[176:179]
M v[172:175],a[168:171],a[120:123],v[172:175]
M v[172:175],a[172:175],a[124:127],v[172:175]
M v[168:171],a[172:175],a[116:119],v[168:171]
M v[168:171],a[168:171],a[112:115],v[168:171]
M v[164:167],a[168:171],a[104:107],v[164:167]
s_nop 0
T a[88:89],v4,49152
T a[90:91],v4,50176
M v[164:167],a[172:175],a[108:111],v[164:167]
s_waitcnt lgkmcnt(4)
buffer_load_dwordx4 v10, s[16:19], s21 offen offset:2048   lds
M v[160:163],a[172:175],a[100:103],v[160:163]
M v[160:163],a[168:171],a[96:99],v[160:163]
M v[192:195],a[160:163],a[96:99],v[192:195]
R a[168:171],v5,22528
R a[172:175],v6,22528
M v[192:195],a[164:167],a[100:103],v[192:195]
M v[196:199],a[164:167],a[108:111],v[196:199]
M v[196:199],a[160:163],a[104:107],v[196:199]
s_nop 0
T a[92:93],v4,57344
T a[94:95],v4,58368
M v[200:203],a[160:163],a[112:115],v[200:203]
buffer_load_dwordx4 v11, s[16:19], s21 offen offset:3072   lds
M v[200:203],a[164:167],a[116:119],v[200:203]
SA s21,s21,128
M v[204:207],a[164:167],a[124:127],v[204:207]
M v[204:207],a[160:163],a[120:123],v[204:207]
M v[208:211],a[160:163],a[128:131],v[208:211]
M v[208:211],a[164:167],a[132:135],v[208:211]
M v[212:215],a[164:167],a[140:143],v[212:215]
M v[212:215],a[160:163],a[136:139],v[212:215]
M v[216:219],a[160:163],a[144:147],v[216:219]
M v[216:219],a[164:167],a[148:151],v[216:219]
s_waitcnt lgkmcnt(2)
M v[220:223],a[164:167],a[156:159],v[220:223]
s_waitcnt vmcnt(17) lgkmcnt(0)
M v[220:223],a[160:163],a[152:155],v[220:223]
s_barrier
M v[252:255],a[168:171],a[152:155],v[252:255]
R a[160:163],v5,32768
R a[164:167],v6,32768
M v[252:255],a[172:175],a[156:159],v[252:255]
v_cmp_ne_u32 vcc, 1, v17
M v[248:251],a[172:175],a[148:151],v[248:251]
s_nop 0
M v[248:251],a[168:171],a[144:147],v[248:251]
s_cbranch_vccnz L_zs1
L_zr1:
M v[244:247],a[168:171],a[136:139],v[244:247]
M v[244:247],a[172:175],a[140:143],v[244:247]
s_lshl_b32 s72, s30, 6
M v[240:243],a[172:175],a[132:135],v[240:243]
SA s72,s72,104914944
M v[240:243],a[168:171],a[128:131],v[240:243]
buffer_store_dword v19, v18, s[8:11], s72 offen sc1
M v[236:239],a[168:171],a[120:123],v[236:239]
M v[236:239],a[172:175],a[124:127],v[236:239]
M v[232:235],a[172:175],a[116:119],v[232:235]
M v[232:235],a[168:171],a[112:115],v[232:235]
M v[228:231],a[168:171],a[104:107],v[228:231]
M v[228:231],a[172:175],a[108:111],v[228:231]
s_waitcnt lgkmcnt(0)
M v[224:227],a[172:175],a[100:103],v[224:227]
M v[224:227],a[168:171],a[96:99],v[224:227]
M a[0:3],a[160:163],a[32:35],a[0:3]
R a[168:171],v5,34816
R a[172:175],v6,34816
M a[0:3],a[164:167],a[36:39],a[0:3]
T a[96:97],v1,0
T a[98:99],v1,1024
M a[4:7],a[164:167],a[44:47],a[4:7]
SA m0,s24,16384
M a[4:7],a[160:163],a[40:43],a[4:7]
buffer_load_dwordx4 v12, s[48:51], s22 offen offset:0   lds
M a[8:11],a[160:163],a[48:51],a[8:11]
M a[8:11],a[164:167],a[52:55],a[8:11]
s_mul_i32 s64, s41, 229376
M a[12:15],a[164:167],a[60:63],a[12:15]
SA s72,s90,s64
T a[100:101],v1,8192
T a[102:103],v1,9216
M a[12:15],a[160:163],a[56:59],a[12:15]
s_addc_u32 s73, s91, 0
M a[16:19],a[160:163],a[64:67],a[16:19]
s_sub_u32 s75, 3670016, s64
buffer_load_dwordx4 v13, s[48:51], s22 offen offset:1024   lds
M a[16:19],a[164:167],a[68:71],a[16:19]
s_mov_b32 s12, s72
M a[20:23],a[164:167],a[76:79],a[20:23]
s_and_b32 s13, s73, 0xffff
M a[20:23],a[160:163],a[72:75],a[20:23]
s_mov_b32 s14, s75
T a[104:105],v2,0
T a[106:107],v2,1024
M a[24:27],a[160:163],a[80:83],a[24:27]
s_mov_b32 s15, 0x20000
M a[24:27],a[164:167],a[84:87],a[24:27]
s_waitcnt lgkmcnt(6)
buffer_load_dwordx4 v14, s[48:51], s22 offen offset:2048   lds
M a[28:31],a[164:167],a[92:95],a[28:31]
M a[28:31],a[160:163],a[88:91],a[28:31]
M v[60:63],a[168:171],a[88:91],v[60:63]
R a[160:163],v5,36864
R a[164:167],v6,36864
M v[60:63],a[172:175],a[92:95],v[60:63]
T a[108:109],v2,8192
T a[110:111],v2,9216
M v[56:59],a[172:175],a[84:87],v[56:59]
buffer_load_dwordx4 v15, s[48:51], s22 offen offset:3072   lds
M v[56:59],a[168:171],a[80:83],v[56:59]
s_sub_u32 s22, s22, 1048448
M v[52:55],a[168:171],a[72:75],v[52:55]
M v[52:55],a[172:175],a[76:79],v[52:55]
s_nop 0
T a[112:113],v3,0
T a[114:115],v3,1024
M v[48:51],a[172:175],a[68:71],v[48:51]
SA m0,s23,49152
M v[48:51],a[168:171],a[64:67],v[48:51]
buffer_load_dwordx4 v8, s[16:19], s21 offen offset:0   lds
M v[44:47],a[168:171],a[56:59],v[44:47]
M v[44:47],a[172:175],a[60:63],v[44:47]
M v[40:43],a[172:175],a[52:55],v[40:43]
s_nop 0
T a[116:117],v3,8192
T a[118:119],v3,9216
M v[40:43],a[168:171],a[48:51],v[40:43]
M v[36:39],a[168:171],a[40:43],v[36:39]
buffer_load_dwordx4 v9, s[16:19], s21 offen offset:1024   lds
M v[36:39],a[172:175],a[44:47],v[36:39]
s_waitcnt lgkmcnt(6)
M v[32:35],a[172:175],a[36:39],v[32:35]
M v[32:35],a[168:171],a[32:35],v[32:35]
s_nop 0
T a[120:121],v4,0
T a[122:123],v4,1024
M v[64:67],a[160:163],a[32:35],v[64:67]
R a[168:171],v5,38912
R a[172:175],v6,38912
M v[64:67],a[164:167],a[36:39],v[64:67]
buffer_load_dwordx4 v10, s[16:19], s21 offen offset:2048   lds
M v[68:71],a[164:167],a[44:47],v[68:71]
M v[68:71],a[160:163],a[40:43],v[68:71]
M v[72:75],a[160:163],a[48:51],v[72:75]
s_nop 0
T a[124:125],v4,8192
T a[126:127],v4,9216
M v[72:75],a[164:167],a[52:55],v[72:75]
M v[76:79],a[164:167],a[60:63],v[76:79]
buffer_load_dwordx4 v11, s[16:19], s21 offen offset:3072   lds
M v[76:79],a[160:163],a[56:59],v[76:79]
SA s21,s21,524160
M v[80:83],a[160:163],a[64:67],v[80:83]
M v[80:83],a[164:167],a[68:71],v[80:83]
M v[84:87],a[164:167],a[76:79],v[84:87]
M v[84:87],a[160:163],a[72:75],v[84:87]
M v[88:91],a[160:163],a[80:83],v[88:91]
M v[88:91],a[164:167],a[84:87],v[88:91]
s_waitcnt lgkmcnt(2)
M v[92:95],a[164:167],a[92:95],v[92:95]
s_waitcnt vmcnt(18) lgkmcnt(0)
M v[92:95],a[160:163],a[88:91],v[92:95]
s_barrier
M v[124:127],a[168:171],a[88:91],v[124:127]
R a[160:163],v5,49152
R a[164:167],v6,49152
M v[124:127],a[172:175],a[92:95],v[124:127]
M v[120:123],a[172:175],a[84:87],v[120:123]
SA m0,s24,32768
T a[128:129],v1,16384
T a[130:131],v1,17408
M v[120:123],a[168:171],a[80:83],v[120:123]
buffer_load_dwordx4 v12, s[48:51], s22 offen offset:0   lds
M v[116:119],a[168:171],a[72:75],v[116:119]
M v[116:119],a[172:175],a[76:79],v[116:119]
M v[112:115],a[172:175],a[68:71],v[112:115]
M v[112:115],a[168:171],a[64:67],v[112:115]
M v[108:111],a[168:171],a[56:59],v[108:111]
M v[108:111],a[172:175],a[60:63],v[108:111]
s_nop 0
T a[132:133],v1,24576
T a[134:135],v1,25600
M v[104:107],a[172:175],a[52:55],v[104:107]
buffer_load_dwordx4 v13, s[48:51], s22 offen offset:1024   lds
M v[104:107],a[168:171],a[48:51],v[104:107]
M v[100:103],a[168:171],a[40:43],v[100:103]
M v[100:103],a[172:175],a[44:47],v[100:103]
s_waitcnt lgkmcnt(4)
M v[96:99],a[172:175],a[36:39],v[96:99]
M v[96:99],a[168:171],a[32:35],v[96:99]
M v[128:131],a[160:163],a[32:35],v[128:131]
R a[168:171],v5,51200
R a[172:175],v6,51200
M v[128:131],a[164:167],a[36:39],v[128:131]
T a[136:137],v2,16384
T a[138:139],v2,17408
M v[132:135],a[164:167],a[44:47],v[132:135]
buffer_load_dwordx4 v14, s[48:51], s22 offen offset:2048   lds
M v[132:135],a[160:163],a[40:43],v[132:135]
M v[136:139],a[160:163],a[48:51],v[136:139]
M v[136:139],a[164:167],a[52:55],v[136:139]
M v[140:143],a[164:167],a[60:63],v[140:143]
M v[140:143],a[160:163],a[56:59],v[140:143]
s_nop 0
T a[140:141],v2,24576
T a[142:143],v2,25600
M v[144:147],a[160:163],a[64:67],v[144:147]
buffer_load_dwordx4 v15, s[48:51], s22 offen offset:3072   lds
M v[144:147],a[164:167],a[68:71],v[144:147]
SA s22,s22,1048576
M v[148:151],a[164:167],a[76:79],v[148:151]
M v[148:151],a[160:163],a[72:75],v[148:151]
M v[152:155],a[160:163],a[80:83],v[152:155]
M v[152:155],a[164:167],a[84:87],v[152:155]
s_waitcnt lgkmcnt(4)
M v[156:159],a[164:167],a[92:95],v[156:159]
SA m0,s23,0
T a[144:145],v3,16384
T a[146:147],v3,17408
M v[156:159],a[160:163],a[88:91],v[156:159]
buffer_load_dwordx4 v8, s[16:19], s21 offen offset:0   lds
M v[188:191],a[168:171],a[88:91],v[188:191]
R a[160:163],v5,53248
R a[164:167],v6,53248
M v[188:191],a[172:175],a[92:95],v[188:191]
buffer_load_dword a240, v26, s[60:63], s27 offen offset:0
M v[184:187],a[172:175],a[84:87],v[184:187]
SA s27,s27,2048
M v[184:187],a[168:171],a[80:83],v[184:187]
M v[180:183],a[168:171],a[72:75],v[180:183]
M v[180:183],a[172:175],a[76:79],v[180:183]
s_nop 0
T a[148:149],v3,24576
T a[150:151],v3,25600
M v[176:179],a[172:175],a[68:71],v[176:179]
buffer_load_dwordx4 v9, s[16:19], s21 offen offset:1024   lds
M v[176:179],a[168:171],a[64:67],v[176:179]
M v[172:175],a[168:171],a[56:59],v[172:175]
M v[172:175],a[172:175],a[60:63],v[172:175]
M v[168:171],a[172:175],a[52:55],v[168:171]
M v[168:171],a[168:171],a[48:51],v[168:171]
M v[164:167],a[168:171],a[40:43],v[164:167]
s_nop 0
T a[152:153],v4,16384
T a[154:155],v4,17408
M v[164:167],a[172:175],a[44:47],v[164:167]
s_waitcnt lgkmcnt(4)
buffer_load_dwordx4 v10, s[16:19], s21 offen offset:2048   lds
M v[160:163],a[172:175],a[36:39],v[160:163]
M v[160:163],a[168:171],a[32:35],v[160:163]
M v[192:195],a[160:163],a[32:35],v[192:195]
R a[168:171],v5,55296
R a[172:175],v6,55296
M v[192:195],a[164:167],a[36:39],v[192:195]
M v[196:199],a[164:167],a[44:47],v[196:199]
M v[196:199],a[160:163],a[40:43],v[196:199]
s_nop 0
T a[156:157],v4,24576
T a[158:159],v4,25600
M v[200:203],a[160:163],a[48:51],v[200:203]
buffer_load_dwordx4 v11, s[16:19], s21 offen offset:3072   lds
M v[200:203],a[164:167],a[52:55],v[200:203]
SA s21,s21,128
M v[204:207],a[164:167],a[60:63],v[204:207]
M v[204:207],a[160:163],a[56:59],v[204:207]
M v[208:211],a[160:163],a[64:67],v[208:211]
M v[208:211],a[164:167],a[68:71],v[208:211]
M v[212:215],a[164:167],a[76:79],v[212:215]
M v[212:215],a[160:163],a[72:75],v[212:215]
M v[216:219],a[160:163],a[80:83],v[216:219]
M v[216:219],a[164:167],a[84:87],v[216:219]
s_waitcnt lgkmcnt(2)
M v[220:223],a[164:167],a[92:95],v[220:223]
s_waitcnt vmcnt(18) lgkmcnt(0)
M v[220:223],a[160:163],a[88:91],v[220:223]
s_barrier
M v[252:255],a[168:171],a[88:91],v[252:255]
R a[160:163],v5,0
R a[164:167],v6,0
M v[252:255],a[172:175],a[92:95],v[252:255]
M v[248:251],a[172:175],a[84:87],v[248:251]
M v[248:251],a[168:171],a[80:83],v[248:251]
M v[244:247],a[168:171],a[72:75],v[244:247]
M v[244:247],a[172:175],a[76:79],v[244:247]
M v[240:243],a[172:175],a[68:71],v[240:243]
M v[240:243],a[168:171],a[64:67],v[240:243]
M v[236:239],a[168:171],a[56:59],v[236:239]
M v[236:239],a[172:175],a[60:63],v[236:239]
M v[232:235],a[172:175],a[52:55],v[232:235]
M v[232:235],a[168:171],a[48:51],v[232:235]
M v[228:231],a[168:171],a[40:43],v[228:231]
M v[228:231],a[172:175],a[44:47],v[228:231]
s_waitcnt lgkmcnt(0)
M v[224:227],a[172:175],a[36:39],v[224:227]
M v[224:227],a[168:171],a[32:35],v[224:227]
M a[0:3],a[160:163],a[96:99],a[0:3]
R a[168:171],v5,2048
R a[172:175],v6,2048
M a[0:3],a[164:167],a[100:103],a[0:3]
T a[32:33],v1,32768
T a[34:35],v1,33792
M a[4:7],a[164:167],a[108:111],a[4:7]
SA m0,s24,49152
M a[4:7],a[160:163],a[104:107],a[4:7]
buffer_load_dwordx4 v12, s[48:51], s22 offen offset:0   lds
M a[8:11],a[160:163],a[112:115],a[8:11]
M a[8:11],a[164:167],a[116:119],a[8:11]
M a[12:15],a[164:167],a[124:127],a[12:15]
s_nop 0
T a[36:37],v1,40960
T a[38:39],v1,41984
M a[12:15],a[160:163],a[120:123],a[12:15]
M a[16:19],a[160:163],a[128:131],a[16:19]
buffer_load_dwordx4 v13, s[48:51], s22 offen offset:1024   lds
M a[16:19],a[164:167],a[132:135],a[16:19]
M a[20:23],a[164:167],a[140:143],a[20:23]
M a[20:23],a[160:163],a[136:139],a[20:23]
s_nop 0
T a[40:41],v2,32768
T a[42:43],v2,33792
M a[24:27],a[160:163],a[144:147],a[24:27]
M a[24:27],a[164:167],a[148:151],a[24:27]
s_waitcnt lgkmcnt(6)
buffer_load_dwordx4 v14, s[48:51], s22 offen offset:2048   lds
M a[28:31],a[164:167],a[156:159],a[28:31]
M a[28:31],a[160:163],a[152:155],a[28:31]
M v[60:63],a[168:171],a[152:155],v[60:63]
R a[160:163],v5,4096
R a[164:167],v6,4096
M v[60:63],a[172:175],a[156:159],v[60:63]
T a[44:45],v2,40960
T a[46:47],v2,41984
L_w_kv13:
s_cbranch_execz L_w_kv17
M v[56:59],a[172:175],a[148:151],v[56:59]
buffer_load_dwordx4 v15, s[48:51], s22 offen offset:3072   lds
M v[56:59],a[168:171],a[144:147],v[56:59]
s_sub_u32 s22, s22, 1048448
M v[52:55],a[168:171],a[136:139],v[52:55]
M v[52:55],a[172:175],a[140:143],v[52:55]
s_nop 0
T a[48:49],v3,32768
T a[50:51],v3,33792
M v[48:51],a[172:175],a[132:135],v[48:51]
SA m0,s23,16384
M v[48:51],a[168:171],a[128:131],v[48:51]
buffer_load_dwordx4 v8, s[16:19], s21 offen offset:0   lds
M v[44:47],a[168:171],a[120:123],v[44:47]
M v[44:47],a[172:175],a[124:127],v[44:47]
M v[40:43],a[172:175],a[116:119],v[40:43]
s_nop 0
T a[52:53],v3,40960
T a[54:55],v3,41984
M v[40:43],a[168:171],a[112:115],v[40:43]
M v[36:39],a[168:171],a[104:107],v[36:39]
buffer_load_dwordx4 v9, s[16:19], s21 offen offset:1024   lds
M v[36:39],a[172:175],a[108:111],v[36:39]
s_waitcnt lgkmcnt(6)
M v[32:35],a[172:175],a[100:103],v[32:35]
M v[32:35],a[168:171],a[96:99],v[32:35]
s_nop 0
T a[56:57],v4,32768
T a[58:59],v4,33792
M v[64:67],a[160:163],a[96:99],v[64:67]
R a[168:171],v5,6144
R a[172:175],v6,6144
M v[64:67],a[164:167],a[100:103],v[64:67]
buffer_load_dwordx4 v10, s[16:19], s21 offen offset:2048   lds
M v[68:71],a[164:167],a[108:111],v[68:71]
M v[68:71],a[160:163],a[104:107],v[68:71]
M v[72:75],a[160:163],a[112:115],v[72:75]
s_nop 0
T a[60:61],v4,40960
T a[62:63],v4,41984
M v[72:75],a[164:167],a[116:119],v[72:75]
M v[76:79],a[164:167],a[124:127],v[76:79]
buffer_load_dwordx4 v11, s[16:19], s21 offen offset:3072   lds
M v[76:79],a[160:163],a[120:123],v[76:79]
SA s21,s21,524160
M v[80:83],a[160:163],a[128:131],v[80:83]
M v[80:83],a[164:167],a[132:135],v[80:83]
M v[84:87],a[164:167],a[140:143],v[84:87]
M v[84:87],a[160:163],a[136:139],v[84:87]
M v[88:91],a[160:163],a[144:147],v[88:91]
M v[88:91],a[164:167],a[148:151],v[88:91]
s_waitcnt lgkmcnt(2)
M v[92:95],a[164:167],a[156:159],v[92:95]
s_waitcnt vmcnt(17) lgkmcnt(0)
M v[92:95],a[160:163],a[152:155],v[92:95]
s_barrier
M v[124:127],a[168:171],a[152:155],v[124:127]
R a[160:163],v5,16384
R a[164:167],v6,16384
M v[124:127],a[172:175],a[156:159],v[124:127]
M v[120:123],a[172:175],a[148:151],v[120:123]
SA m0,s24,0
T a[64:65],v1,49152
T a[66:67],v1,50176
M v[120:123],a[168:171],a[144:147],v[120:123]
buffer_load_dwordx4 v12, s[48:51], s22 offen offset:0   lds
M v[116:119],a[168:171],a[136:139],v[116:119]
M v[116:119],a[172:175],a[140:143],v[116:119]
M v[112:115],a[172:175],a[132:135],v[112:115]
M v[112:115],a[168:171],a[128:131],v[112:115]
M v[108:111],a[168:171],a[120:123],v[108:111]
M v[108:111],a[172:175],a[124:127],v[108:111]
s_nop 0
T a[68:69],v1,57344
T a[70:71],v1,58368
M v[104:107],a[172:175],a[116:119],v[104:107]
buffer_load_dwordx4 v13, s[48:51], s22 offen offset:1024   lds
M v[104:107],a[168:171],a[112:115],v[104:107]
M v[100:103],a[168:171],a[104:107],v[100:103]
M v[100:103],a[172:175],a[108:111],v[100:103]
s_waitcnt lgkmcnt(4)
M v[96:99],a[172:175],a[100:103],v[96:99]
M v[96:99],a[168:171],a[96:99],v[96:99]
M v[128:131],a[160:163],a[96:99],v[128:131]
R a[168:171],v5,18432
R a[172:175],v6,18432
M v[128:131],a[164:167],a[100:103],v[128:131]
T a[72:73],v2,49152
T a[74:75],v2,50176
M v[132:135],a[164:167],a[108:111],v[132:135]
buffer_load_dwordx4 v14, s[48:51], s22 offen offset:2048   lds
M v[132:135],a[160:163],a[104:107],v[132:135]
M v[136:139],a[160:163],a[112:115],v[136:139]
M v[136:139],a[164:167],a[116:119],v[136:139]
M v[140:143],a[164:167],a[124:127],v[140:143]
M v[140:143],a[160:163],a[120:123],v[140:143]
s_nop 0
T a[76:77],v2,57344
T a[78:79],v2,58368
M v[144:147],a[160:163],a[128:131],v[144:147]
buffer_load_dwordx4 v15, s[48:51], s22 offen offset:3072   lds
M v[144:147],a[164:167],a[132:135],v[144:147]
SA s22,s22,1048576
M v[148:151],a[164:167],a[140:143],v[148:151]
M v[148:151],a[160:163],a[136:139],v[148:151]
M v[152:155],a[160:163],a[144:147],v[152:155]
M v[152:155],a[164:167],a[148:151],v[152:155]
s_waitcnt lgkmcnt(4)
M v[156:159],a[164:167],a[156:159],v[156:159]
SA m0,s23,32768
T a[80:81],v3,49152
T a[82:83],v3,50176
M v[156:159],a[160:163],a[152:155],v[156:159]
buffer_load_dwordx4 v8, s[16:19], s21 offen offset:0   lds
M v[188:191],a[168:171],a[152:155],v[188:191]
R a[160:163],v5,20480
R a[164:167],v6,20480
M v[188:191],a[172:175],a[156:159],v[188:191]
buffer_load_dword a240, v26, s[60:63], s27 offen offset:0
M v[184:187],a[172:175],a[148:151],v[184:187]
SA s27,s27,2048
M v[184:187],a[168:171],a[144:147],v[184:187]
M v[180:183],a[168:171],a[136:139],v[180:183]
M v[180:183],a[172:175],a[140:143],v[180:183]
s_nop 0
T a[84:85],v3,57344
T a[86:87],v3,58368
M v[176:179],a[172:175],a[132:135],v[176:179]
buffer_load_dwordx4 v9, s[16:19], s21 offen offset:1024   lds
M v[176:179],a[168:171],a[128:131],v[176:179]
M v[172:175],a[168:171],a[120:123],v[172:175]
M v[172:175],a[172:175],a[124:127],v[172:175]
M v[168:171],a[172:175],a[116:119],v[168:171]
M v[168:171],a[168:171],a[112:115],v[168:171]
M v[164:167],a[168:171],a[104:107],v[164:167]
s_nop 0
T a[88:89],v4,49152
T a[90:91],v4,50176
M v[164:167],a[172:175],a[108:111],v[164:167]
s_waitcnt lgkmcnt(4)
buffer_load_dwordx4 v10, s[16:19], s21 offen offset:2048   lds
M v[160:163],a[172:175],a[100:103],v[160:163]
M v[160:163],a[168:171],a[96:99],v[160:163]
M v[192:195],a[160:163],a[96:99],v[192:195]
R a[168:171],v5,22528
R a[172:175],v6,22528
M v[192:195],a[164:167],a[100:103],v[192:195]
M v[196:199],a[164:167],a[108:111],v[196:199]
M v[196:199],a[160:163],a[104:107],v[196:199]
s_nop 0
T a[92:93],v4,57344
T a[94:95],v4,58368
M v[200:203],a[160:163],a[112:115],v[200:203]
buffer_load_dwordx4 v11, s[16:19], s21 offen offset:3072   lds
M v[200:203],a[164:167],a[116:119],v[200:203]
SA s21,s21,128
M v[204:207],a[164:167],a[124:127],v[204:207]
M v[204:207],a[160:163],a[120:123],v[204:207]
M v[208:211],a[160:163],a[128:131],v[208:211]
M v[208:211],a[164:167],a[132:135],v[208:211]
M v[212:215],a[164:167],a[140:143],v[212:215]
M v[212:215],a[160:163],a[136:139],v[212:215]
M v[216:219],a[160:163],a[144:147],v[216:219]
M v[216:219],a[164:167],a[148:151],v[216:219]
s_waitcnt lgkmcnt(2)
M v[220:223],a[164:167],a[156:159],v[220:223]
s_waitcnt vmcnt(17) lgkmcnt(0)
M v[220:223],a[160:163],a[152:155],v[220:223]
s_barrier
M v[252:255],a[168:171],a[152:155],v[252:255]
R a[160:163],v5,32768
R a[164:167],v6,32768
M v[252:255],a[172:175],a[156:159],v[252:255]
M v[248:251],a[172:175],a[148:151],v[248:251]
M v[248:251],a[168:171],a[144:147],v[248:251]
M v[244:247],a[168:171],a[136:139],v[244:247]
M v[244:247],a[172:175],a[140:143],v[244:247]
M v[240:243],a[172:175],a[132:135],v[240:243]
M v[240:243],a[168:171],a[128:131],v[240:243]
M v[236:239],a[168:171],a[120:123],v[236:239]
M v[236:239],a[172:175],a[124:127],v[236:239]
M v[232:235],a[172:175],a[116:119],v[232:235]
M v[232:235],a[168:171],a[112:115],v[232:235]
M v[228:231],a[168:171],a[104:107],v[228:231]
M v[228:231],a[172:175],a[108:111],v[228:231]
s_waitcnt lgkmcnt(0)
M v[224:227],a[172:175],a[100:103],v[224:227]
M v[224:227],a[168:171],a[96:99],v[224:227]
M a[0:3],a[160:163],a[32:35],a[0:3]
R a[168:171],v5,34816
R a[172:175],v6,34816
M a[0:3],a[164:167],a[36:39],a[0:3]
T a[96:97],v1,0
T a[98:99],v1,1024
M a[4:7],a[164:167],a[44:47],a[4:7]
SA m0,s24,16384
M a[4:7],a[160:163],a[40:43],a[4:7]
buffer_load_dwordx4 v12, s[48:51], s22 offen offset:0   lds
M a[8:11],a[160:163],a[48:51],a[8:11]
M a[8:11],a[164:167],a[52:55],a[8:11]
M a[12:15],a[164:167],a[60:63],a[12:15]
s_nop 0
T a[100:101],v1,8192
T a[102:103],v1,9216
M a[12:15],a[160:163],a[56:59],a[12:15]
M a[16:19],a[160:163],a[64:67],a[16:19]
buffer_load_dwordx4 v13, s[48:51], s22 offen offset:1024   lds
M a[16:19],a[164:167],a[68:71],a[16:19]
M a[20:23],a[164:167],a[76:79],a[20:23]
M a[20:23],a[160:163],a[72:75],a[20:23]
s_nop 0
T a[104:105],v2,0
T a[106:107],v2,1024
M a[24:27],a[160:163],a[80:83],a[24:27]
M a[24:27],a[164:167],a[84:87],a[24:27]
s_waitcnt lgkmcnt(6)
buffer_load_dwordx4 v14, s[48:51], s22 offen offset:2048   lds
M a[28:31],a[164:167],a[92:95],a[28:31]
M a[28:31],a[160:163],a[88:91],a[28:31]
M v[60:63],a[168:171],a[88:91],v[60:63]
R a[160:163],v5,36864
R a[164:167],v6,36864
M v[60:63],a[172:175],a[92:95],v[60:63]
T a[108:109],v2,8192
T a[110:111],v2,9216
M v[56:59],a[172:175],a[84:87],v[56:59]
buffer_load_dwordx4 v15, s[48:51], s22 offen offset:3072   lds
M v[56:59],a[168:171],a[80:83],v[56:59]
s_sub_u32 s22, s22, 1048448
M v[52:55],a[168:171],a[72:75],v[52:55]
M v[52:55],a[172:175],a[76:79],v[52:55]
s_nop 0
T a[112:113],v3,0
T a[114:115],v3,1024
M v[48:51],a[172:175],a[68:71],v[48:51]
SA m0,s23,49152
M v[48:51],a[168:171],a[64:67],v[48:51]
buffer_load_dwordx4 v8, s[16:19], s21 offen offset:0   lds
M v[44:47],a[168:171],a[56:59],v[44:47]
M v[44:47],a[172:175],a[60:63],v[44:47]
M v[40:43],a[172:175],a[52:55],v[40:43]
s_nop 0
T a[116:117],v3,8192
T a[118:119],v3,9216
M v[40:43],a[168:171],a[48:51],v[40:43]
M v[36:39],a[168:171],a[40:43],v[36:39]
buffer_load_dwordx4 v9, s[16:19], s21 offen offset:1024   lds
M v[36:39],a[172:175],a[44:47],v[36:39]
s_waitcnt lgkmcnt(6)
M v[32:35],a[172:175],a[36:39],v[32:35]
M v[32:35],a[168:171],a[32:35],v[32:35]
s_nop 0
T a[120:121],v4,0
T a[122:123],v4,1024
M v[64:67],a[160:163],a[32:35],v[64:67]
R a[168:171],v5,38912
R a[172:175],v6,38912
M v[64:67],a[164:167],a[36:39],v[64:67]
buffer_load_dwordx4 v10, s[16:19], s21 offen offset:2048   lds
M v[68:71],a[164:167],a[44:47],v[68:71]
M v[68:71],a[160:163],a[40:43],v[68:71]
M v[72:75],a[160:163],a[48:51],v[72:75]
s_nop 0
T a[124:125],v4,8192
T a[126:127],v4,9216
M v[72:75],a[164:167],a[52:55],v[72:75]
M v[76:79],a[164:167],a[60:63],v[76:79]
buffer_load_dwordx4 v11, s[16:19], s21 offen offset:3072   lds
M v[76:79],a[160:163],a[56:59],v[76:79]
SA s21,s21,524160
M v[80:83],a[160:163],a[64:67],v[80:83]
M v[80:83],a[164:167],a[68:71],v[80:83]
M v[84:87],a[164:167],a[76:79],v[84:87]
M v[84:87],a[160:163],a[72:75],v[84:87]
M v[88:91],a[160:163],a[80:83],v[88:91]
M v[88:91],a[164:167],a[84:87],v[88:91]
s_waitcnt lgkmcnt(2)
M v[92:95],a[164:167],a[92:95],v[92:95]
s_waitcnt vmcnt(17) lgkmcnt(0)
M v[92:95],a[160:163],a[88:91],v[92:95]
s_barrier
M v[124:127],a[168:171],a[88:91],v[124:127]
R a[160:163],v5,49152
R a[164:167],v6,49152
M v[124:127],a[172:175],a[92:95],v[124:127]
M v[120:123],a[172:175],a[84:87],v[120:123]
SA m0,s24,32768
T a[128:129],v1,16384
T a[130:131],v1,17408
M v[120:123],a[168:171],a[80:83],v[120:123]
buffer_load_dwordx4 v12, s[48:51], s22 offen offset:0   lds
M v[116:119],a[168:171],a[72:75],v[116:119]
M v[116:119],a[172:175],a[76:79],v[116:119]
M v[112:115],a[172:175],a[68:71],v[112:115]
M v[112:115],a[168:171],a[64:67],v[112:115]
M v[108:111],a[168:171],a[56:59],v[108:111]
M v[108:111],a[172:175],a[60:63],v[108:111]
s_nop 0
T a[132:133],v1,24576
T a[134:135],v1,25600
M v[104:107],a[172:175],a[52:55],v[104:107]
buffer_load_dwordx4 v13, s[48:51], s22 offen offset:1024   lds
M v[104:107],a[168:171],a[48:51],v[104:107]
M v[100:103],a[168:171],a[40:43],v[100:103]
s_and_b32 s64, s42, 7
s_lshl_b32 s64, s64, 2
M v[100:103],a[172:175],a[44:47],v[100:103]
s_waitcnt lgkmcnt(4)
SA s64,s64,s20
M v[96:99],a[172:175],a[36:39],v[96:99]
s_mul_i32 s64, s64, 114688
v_bfe_u32 v28, v0, 2, 2
v_and_b32 v29, 3, v0
M v[96:99],a[168:171],a[32:35],v[96:99]
v_lshlrev_b32 v29, 7, v29
v_lshl_add_u32 v28, v28, 13, v29
M v[128:131],a[160:163],a[32:35],v[128:131]
R a[168:171],v5,51200
R a[172:175],v6,51200
M v[128:131],a[164:167],a[36:39],v[128:131]
T a[136:137],v2,16384
T a[138:139],v2,17408
M v[132:135],a[164:167],a[44:47],v[132:135]
buffer_load_dwordx4 v14, s[48:51], s22 offen offset:2048   lds
M v[132:135],a[160:163],a[40:43],v[132:135]
v_add_u32 v23, s64, v28
v_and_b32 v28, 48, v0
M v[136:139],a[160:163],a[48:51],v[136:139]
v_lshl_add_u32 v23, v28, 24, v23
M v[136:139],a[164:167],a[52:55],v[136:139]
M v[140:143],a[164:167],a[60:63],v[140:143]
M v[140:143],a[160:163],a[56:59],v[140:143]
s_nop 0
T a[140:141],v2,24576
T a[142:143],v2,25600
M v[144:147],a[160:163],a[64:67],v[144:147]
buffer_load_dwordx4 v15, s[48:51], s22 offen offset:3072   lds
M v[144:147],a[164:167],a[68:71],v[144:147]
SA s22,s22,1048576
M v[148:151],a[164:167],a[76:79],v[148:151]
M v[148:151],a[160:163],a[72:75],v[148:151]
M v[152:155],a[160:163],a[80:83],v[152:155]
M v[152:155],a[164:167],a[84:87],v[152:155]
s_waitcnt lgkmcnt(4)
M v[156:159],a[164:167],a[92:95],v[156:159]
SA m0,s23,0
T a[144:145],v3,16384
T a[146:147],v3,17408
M v[156:159],a[160:163],a[88:91],v[156:159]
buffer_load_dwordx4 v8, s[16:19], s21 offen offset:0   lds
M v[188:191],a[168:171],a[88:91],v[188:191]
R a[160:163],v5,53248
R a[164:167],v6,53248
M v[188:191],a[172:175],a[92:95],v[188:191]
M v[184:187],a[172:175],a[84:87],v[184:187]
M v[184:187],a[168:171],a[80:83],v[184:187]
M v[180:183],a[168:171],a[72:75],v[180:183]
M v[180:183],a[172:175],a[76:79],v[180:183]
s_nop 0
T a[148:149],v3,24576
T a[150:151],v3,25600
M v[176:179],a[172:175],a[68:71],v[176:179]
buffer_load_dwordx4 v9, s[16:19], s21 offen offset:1024   lds
M v[176:179],a[168:171],a[64:67],v[176:179]
M v[172:175],a[168:171],a[56:59],v[172:175]
M v[172:175],a[172:175],a[60:63],v[172:175]
M v[168:171],a[172:175],a[52:55],v[168:171]
M v[168:171],a[168:171],a[48:51],v[168:171]
M v[164:167],a[168:171],a[40:43],v[164:167]
s_nop 0
T a[152:153],v4,16384
T a[154:155],v4,17408
M v[164:167],a[172:175],a[44:47],v[164:167]
s_waitcnt lgkmcnt(4)
buffer_load_dwordx4 v10, s[16:19], s21 offen offset:2048   lds
M v[160:163],a[172:175],a[36:39],v[160:163]
M v[160:163],a[168:171],a[32:35],v[160:163]
M v[192:195],a[160:163],a[32:35],v[192:195]
R a[168:171],v5,55296
R a[172:175],v6,55296
M v[192:195],a[164:167],a[36:39],v[192:195]
M v[196:199],a[164:167],a[44:47],v[196:199]
M v[196:199],a[160:163],a[40:43],v[196:199]
s_nop 0
T a[156:157],v4,24576
T a[158:159],v4,25600
M v[200:203],a[160:163],a[48:51],v[200:203]
buffer_load_dwordx4 v11, s[16:19], s21 offen offset:3072   lds
M v[200:203],a[164:167],a[52:55],v[200:203]
SA s21,s21,128
M v[204:207],a[164:167],a[60:63],v[204:207]
M v[204:207],a[160:163],a[56:59],v[204:207]
M v[208:211],a[160:163],a[64:67],v[208:211]
M v[208:211],a[164:167],a[68:71],v[208:211]
M v[212:215],a[164:167],a[76:79],v[212:215]
M v[212:215],a[160:163],a[72:75],v[212:215]
M v[216:219],a[160:163],a[80:83],v[216:219]
M v[216:219],a[164:167],a[84:87],v[216:219]
s_waitcnt lgkmcnt(2)
M v[220:223],a[164:167],a[92:95],v[220:223]
s_waitcnt vmcnt(16) lgkmcnt(0)
M v[220:223],a[160:163],a[88:91],v[220:223]
s_barrier
M v[252:255],a[168:171],a[88:91],v[252:255]
R a[160:163],v5,0
R a[164:167],v6,0
M v[252:255],a[172:175],a[92:95],v[252:255]
buffer_load_dword a240, v23, s[52:55], 0 offen offset:0
M v[248:251],a[172:175],a[84:87],v[248:251]
v_add_u32 v23, 32768, v23
M v[248:251],a[168:171],a[80:83],v[248:251]
M v[244:247],a[168:171],a[72:75],v[244:247]
M v[244:247],a[172:175],a[76:79],v[244:247]
M v[240:243],a[172:175],a[68:71],v[240:243]
M v[240:243],a[168:171],a[64:67],v[240:243]
M v[236:239],a[168:171],a[56:59],v[236:239]
M v[236:239],a[172:175],a[60:63],v[236:239]
M v[232:235],a[172:175],a[52:55],v[232:235]
M v[232:235],a[168:171],a[48:51],v[232:235]
M v[228:231],a[168:171],a[40:43],v[228:231]
M v[228:231],a[172:175],a[44:47],v[228:231]
s_waitcnt lgkmcnt(0)
M v[224:227],a[172:175],a[36:39],v[224:227]
M v[224:227],a[168:171],a[32:35],v[224:227]
M a[0:3],a[160:163],a[96:99],a[0:3]
R a[168:171],v5,2048
R a[172:175],v6,2048
M a[0:3],a[164:167],a[100:103],a[0:3]
T a[32:33],v1,32768
T a[34:35],v1,33792
M a[4:7],a[164:167],a[108:111],a[4:7]
SA m0,s24,49152
M a[4:7],a[160:163],a[104:107],a[4:7]
buffer_load_dwordx4 v12, s[48:51], s22 offen offset:0   lds
M a[8:11],a[160:163],a[112:115],a[8:11]
M a[8:11],a[164:167],a[116:119],a[8:11]
M a[12:15],a[164:167],a[124:127],a[12:15]
s_nop 0
T a[36:37],v1,40960
T a[38:39],v1,41984
M a[12:15],a[160:163],a[120:123],a[12:15]
M a[16:19],a[160:163],a[128:131],a[16:19]
buffer_load_dwordx4 v13, s[48:51], s22 offen offset:1024   lds
M a[16:19],a[164:167],a[132:135],a[16:19]
M a[20:23],a[164:167],a[140:143],a[20:23]
M a[20:23],a[160:163],a[136:139],a[20:23]
s_nop 0
T a[40:41],v2,32768
T a[42:43],v2,33792
M a[24:27],a[160:163],a[144:147],a[24:27]
M a[24:27],a[164:167],a[148:151],a[24:27]
s_waitcnt lgkmcnt(6)
buffer_load_dwordx4 v14, s[48:51], s22 offen offset:2048   lds
M a[28:31],a[164:167],a[156:159],a[28:31]
M a[28:31],a[160:163],a[152:155],a[28:31]
M v[60:63],a[168:171],a[152:155],v[60:63]
R a[160:163],v5,4096
R a[164:167],v6,4096
M v[60:63],a[172:175],a[156:159],v[60:63]
T a[44:45],v2,40960
T a[46:47],v2,41984
M v[56:59],a[172:175],a[148:151],v[56:59]
buffer_load_dwordx4 v15, s[48:51], s22 offen offset:3072   lds
M v[56:59],a[168:171],a[144:147],v[56:59]
s_sub_u32 s22, s22, 1048448
M v[52:55],a[168:171],a[136:139],v[52:55]
M v[52:55],a[172:175],a[140:143],v[52:55]
s_nop 0
T a[48:49],v3,32768
T a[50:51],v3,33792
M v[48:51],a[172:175],a[132:135],v[48:51]
SA m0,s23,16384
M v[48:51],a[168:171],a[128:131],v[48:51]
buffer_load_dwordx4 v8, s[16:19], s21 offen offset:0   lds
M v[44:47],a[168:171],a[120:123],v[44:47]
M v[44:47],a[172:175],a[124:127],v[44:47]
M v[40:43],a[172:175],a[116:119],v[40:43]
s_nop 0
T a[52:53],v3,40960
T a[54:55],v3,41984
M v[40:43],a[168:171],a[112:115],v[40:43]
M v[36:39],a[168:171],a[104:107],v[36:39]
buffer_load_dwordx4 v9, s[16:19], s21 offen offset:1024   lds
M v[36:39],a[172:175],a[108:111],v[36:39]
s_waitcnt lgkmcnt(6)
M v[32:35],a[172:175],a[100:103],v[32:35]
M v[32:35],a[168:171],a[96:99],v[32:35]
s_nop 0
T a[56:57],v4,32768
T a[58:59],v4,33792
M v[64:67],a[160:163],a[96:99],v[64:67]
R a[168:171],v5,6144
R a[172:175],v6,6144
M v[64:67],a[164:167],a[100:103],v[64:67]
buffer_load_dwordx4 v10, s[16:19], s21 offen offset:2048   lds
M v[68:71],a[164:167],a[108:111],v[68:71]
M v[68:71],a[160:163],a[104:107],v[68:71]
M v[72:75],a[160:163],a[112:115],v[72:75]
s_nop 0
T a[60:61],v4,40960
T a[62:63],v4,41984
M v[72:75],a[164:167],a[116:119],v[72:75]
M v[76:79],a[164:167],a[124:127],v[76:79]
buffer_load_dwordx4 v11, s[16:19], s21 offen offset:3072   lds
M v[76:79],a[160:163],a[120:123],v[76:79]
SA s21,s21,524160
M v[80:83],a[160:163],a[128:131],v[80:83]
M v[80:83],a[164:167],a[132:135],v[80:83]
M v[84:87],a[164:167],a[140:143],v[84:87]
M v[84:87],a[160:163],a[136:139],v[84:87]
M v[88:91],a[160:163],a[144:147],v[88:91]
M v[88:91],a[164:167],a[148:151],v[88:91]
s_waitcnt lgkmcnt(2)
M v[92:95],a[164:167],a[156:159],v[92:95]
s_waitcnt vmcnt(17) lgkmcnt(0)
M v[92:95],a[160:163],a[152:155],v[92:95]
s_barrier
M v[124:127],a[168:171],a[152:155],v[124:127]
R a[160:163],v5,16384
R a[164:167],v6,16384
M v[124:127],a[172:175],a[156:159],v[124:127]
M v[120:123],a[172:175],a[148:151],v[120:123]
SA m0,s24,0
T a[64:65],v1,49152
T a[66:67],v1,50176
M v[120:123],a[168:171],a[144:147],v[120:123]
buffer_load_dwordx4 v12, s[48:51], s22 offen offset:0   lds
M v[116:119],a[168:171],a[136:139],v[116:119]
M v[116:119],a[172:175],a[140:143],v[116:119]
M v[112:115],a[172:175],a[132:135],v[112:115]
M v[112:115],a[168:171],a[128:131],v[112:115]
M v[108:111],a[168:171],a[120:123],v[108:111]
M v[108:111],a[172:175],a[124:127],v[108:111]
s_nop 0
T a[68:69],v1,57344
T a[70:71],v1,58368
M v[104:107],a[172:175],a[116:119],v[104:107]
buffer_load_dwordx4 v13, s[48:51], s22 offen offset:1024   lds
M v[104:107],a[168:171],a[112:115],v[104:107]
M v[100:103],a[168:171],a[104:107],v[100:103]
M v[100:103],a[172:175],a[108:111],v[100:103]
s_waitcnt lgkmcnt(4)
M v[96:99],a[172:175],a[100:103],v[96:99]
M v[96:99],a[168:171],a[96:99],v[96:99]
L_w_kv14:
s_cbranch_execz L_w_kv18
M v[128:131],a[160:163],a[96:99],v[128:131]
R a[168:171],v5,18432
R a[172:175],v6,18432
M v[128:131],a[164:167],a[100:103],v[128:131]
T a[72:73],v2,49152
T a[74:75],v2,50176
M v[132:135],a[164:167],a[108:111],v[132:135]
buffer_load_dwordx4 v14, s[48:51], s22 offen offset:2048   lds
M v[132:135],a[160:163],a[104:107],v[132:135]
M v[136:139],a[160:163],a[112:115],v[136:139]
M v[136:139],a[164:167],a[116:119],v[136:139]
M v[140:143],a[164:167],a[124:127],v[140:143]
M v[140:143],a[160:163],a[120:123],v[140:143]
s_nop 0
T a[76:77],v2,57344
T a[78:79],v2,58368
M v[144:147],a[160:163],a[128:131],v[144:147]
buffer_load_dwordx4 v15, s[48:51], s22 offen offset:3072   lds
M v[144:147],a[164:167],a[132:135],v[144:147]
SA s22,s22,1048576
M v[148:151],a[164:167],a[140:143],v[148:151]
M v[148:151],a[160:163],a[136:139],v[148:151]
M v[152:155],a[160:163],a[144:147],v[152:155]
M v[152:155],a[164:167],a[148:151],v[152:155]
s_waitcnt lgkmcnt(4)
M v[156:159],a[164:167],a[156:159],v[156:159]
SA m0,s23,32768
T a[80:81],v3,49152
T a[82:83],v3,50176
M v[156:159],a[160:163],a[152:155],v[156:159]
buffer_load_dwordx4 v8, s[16:19], s21 offen offset:0   lds
M v[188:191],a[168:171],a[152:155],v[188:191]
R a[160:163],v5,20480
R a[164:167],v6,20480
M v[188:191],a[172:175],a[156:159],v[188:191]
M v[184:187],a[172:175],a[148:151],v[184:187]
M v[184:187],a[168:171],a[144:147],v[184:187]
M v[180:183],a[168:171],a[136:139],v[180:183]
M v[180:183],a[172:175],a[140:143],v[180:183]
s_nop 0
T a[84:85],v3,57344
T a[86:87],v3,58368
M v[176:179],a[172:175],a[132:135],v[176:179]
buffer_load_dwordx4 v9, s[16:19], s21 offen offset:1024   lds
M v[176:179],a[168:171],a[128:131],v[176:179]
M v[172:175],a[168:171],a[120:123],v[172:175]
M v[172:175],a[172:175],a[124:127],v[172:175]
M v[168:171],a[172:175],a[116:119],v[168:171]
M v[168:171],a[168:171],a[112:115],v[168:171]
M v[164:167],a[168:171],a[104:107],v[164:167]
s_nop 0
T a[88:89],v4,49152
T a[90:91],v4,50176
M v[164:167],a[172:175],a[108:111],v[164:167]
s_waitcnt lgkmcnt(4)
buffer_load_dwordx4 v10, s[16:19], s21 offen offset:2048   lds
M v[160:163],a[172:175],a[100:103],v[160:163]
M v[160:163],a[168:171],a[96:99],v[160:163]
M v[192:195],a[160:163],a[96:99],v[192:195]
R a[168:171],v5,22528
R a[172:175],v6,22528
M v[192:195],a[164:167],a[100:103],v[192:195]
M v[196:199],a[164:167],a[108:111],v[196:199]
M v[196:199],a[160:163],a[104:107],v[196:199]
s_nop 0
T a[92:93],v4,57344
T a[94:95],v4,58368
M v[200:203],a[160:163],a[112:115],v[200:203]
buffer_load_dwordx4 v11, s[16:19], s21 offen offset:3072   lds
M v[200:203],a[164:167],a[116:119],v[200:203]
SA s21,s21,128
M v[204:207],a[164:167],a[124:127],v[204:207]
M v[204:207],a[160:163],a[120:123],v[204:207]
M v[208:211],a[160:163],a[128:131],v[208:211]
M v[208:211],a[164:167],a[132:135],v[208:211]
M v[212:215],a[164:167],a[140:143],v[212:215]
M v[212:215],a[160:163],a[136:139],v[212:215]
M v[216:219],a[160:163],a[144:147],v[216:219]
M v[216:219],a[164:167],a[148:151],v[216:219]
s_waitcnt lgkmcnt(2)
M v[220:223],a[164:167],a[156:159],v[220:223]
s_waitcnt vmcnt(17) lgkmcnt(0)
M v[220:223],a[160:163],a[152:155],v[220:223]
s_barrier
M v[252:255],a[168:171],a[152:155],v[252:255]
R a[160:163],v5,32768
R a[164:167],v6,32768
M v[252:255],a[172:175],a[156:159],v[252:255]
buffer_load_dword a240, v23, s[52:55], 0 offen offset:0
M v[248:251],a[172:175],a[148:151],v[248:251]
v_add_u32 v23, 32768, v23
M v[248:251],a[168:171],a[144:147],v[248:251]
M v[244:247],a[168:171],a[136:139],v[244:247]
M v[244:247],a[172:175],a[140:143],v[244:247]
M v[240:243],a[172:175],a[132:135],v[240:243]
M v[240:243],a[168:171],a[128:131],v[240:243]
M v[236:239],a[168:171],a[120:123],v[236:239]
M v[236:239],a[172:175],a[124:127],v[236:239]
M v[232:235],a[172:175],a[116:119],v[232:235]
M v[232:235],a[168:171],a[112:115],v[232:235]
M v[228:231],a[168:171],a[104:107],v[228:231]
M v[228:231],a[172:175],a[108:111],v[228:231]
s_waitcnt lgkmcnt(0)
M v[224:227],a[172:175],a[100:103],v[224:227]
M v[224:227],a[168:171],a[96:99],v[224:227]
M a[0:3],a[160:163],a[32:35],a[0:3]
R a[168:171],v5,34816
R a[172:175],v6,34816
M a[0:3],a[164:167],a[36:39],a[0:3]
T a[96:97],v1,0
T a[98:99],v1,1024
M a[4:7],a[164:167],a[44:47],a[4:7]
SA m0,s24,16384
M a[4:7],a[160:163],a[40:43],a[4:7]
buffer_load_dwordx4 v12, s[48:51], s22 offen offset:0   lds
M a[8:11],a[160:163],a[48:51],a[8:11]
M a[8:11],a[164:167],a[52:55],a[8:11]
M a[12:15],a[164:167],a[60:63],a[12:15]
s_nop 0
T a[100:101],v1,8192
T a[102:103],v1,9216
M a[12:15],a[160:163],a[56:59],a[12:15]
M a[16:19],a[160:163],a[64:67],a[16:19]
buffer_load_dwordx4 v13, s[48:51], s22 offen offset:1024   lds
M a[16:19],a[164:167],a[68:71],a[16:19]
M a[20:23],a[164:167],a[76:79],a[20:23]
M a[20:23],a[160:163],a[72:75],a[20:23]
s_nop 0
T a[104:105],v2,0
T a[106:107],v2,1024
M a[24:27],a[160:163],a[80:83],a[24:27]
M a[24:27],a[164:167],a[84:87],a[24:27]
s_waitcnt lgkmcnt(6)
buffer_load_dwordx4 v14, s[48:51], s22 offen offset:2048   lds
M a[28:31],a[164:167],a[92:95],a[28:31]
M a[28:31],a[160:163],a[88:91],a[28:31]
M v[60:63],a[168:171],a[88:91],v[60:63]
R a[160:163],v5,36864
R a[164:167],v6,36864
M v[60:63],a[172:175],a[92:95],v[60:63]
T a[108:109],v2,8192
T a[110:111],v2,9216
M v[56:59],a[172:175],a[84:87],v[56:59]
buffer_load_dwordx4 v15, s[48:51], s22 offen offset:3072   lds
M v[56:59],a[168:171],a[80:83],v[56:59]
s_sub_u32 s22, s22, 1048448
M v[52:55],a[168:171],a[72:75],v[52:55]
M v[52:55],a[172:175],a[76:79],v[52:55]
s_nop 0
T a[112:113],v3,0
T a[114:115],v3,1024
M v[48:51],a[172:175],a[68:71],v[48:51]
SA m0,s23,49152
M v[48:51],a[168:171],a[64:67],v[48:51]
buffer_load_dwordx4 v8, s[16:19], s21 offen offset:0   lds
M v[44:47],a[168:171],a[56:59],v[44:47]
M v[44:47],a[172:175],a[60:63],v[44:47]
M v[40:43],a[172:175],a[52:55],v[40:43]
s_nop 0
T a[116:117],v3,8192
T a[118:119],v3,9216
M v[40:43],a[168:171],a[48:51],v[40:43]
M v[36:39],a[168:171],a[40:43],v[36:39]
buffer_load_dwordx4 v9, s[16:19], s21 offen offset:1024   lds
M v[36:39],a[172:175],a[44:47],v[36:39]
s_waitcnt lgkmcnt(6)
M v[32:35],a[172:175],a[36:39],v[32:35]
M v[32:35],a[168:171],a[32:35],v[32:35]
s_nop 0
T a[120:121],v4,0
T a[122:123],v4,1024
M v[64:67],a[160:163],a[32:35],v[64:67]
R a[168:171],v5,38912
R a[172:175],v6,38912
M v[64:67],a[164:167],a[36:39],v[64:67]
buffer_load_dwordx4 v10, s[16:19], s21 offen offset:2048   lds
M v[68:71],a[164:167],a[44:47],v[68:71]
M v[68:71],a[160:163],a[40:43],v[68:71]
M v[72:75],a[160:163],a[48:51],v[72:75]
s_nop 0
T a[124:125],v4,8192
T a[126:127],v4,9216
M v[72:75],a[164:167],a[52:55],v[72:75]
M v[76:79],a[164:167],a[60:63],v[76:79]
buffer_load_dwordx4 v11, s[16:19], s21 offen offset:3072   lds
M v[76:79],a[160:163],a[56:59],v[76:79]
SA s21,s21,524160
M v[80:83],a[160:163],a[64:67],v[80:83]
M v[80:83],a[164:167],a[68:71],v[80:83]
M v[84:87],a[164:167],a[76:79],v[84:87]
M v[84:87],a[160:163],a[72:75],v[84:87]
M v[88:91],a[160:163],a[80:83],v[88:91]
M v[88:91],a[164:167],a[84:87],v[88:91]
s_waitcnt lgkmcnt(2)
M v[92:95],a[164:167],a[92:95],v[92:95]
s_waitcnt vmcnt(17) lgkmcnt(0)
M v[92:95],a[160:163],a[88:91],v[92:95]
s_barrier
M v[124:127],a[168:171],a[88:91],v[124:127]
R a[160:163],v5,49152
R a[164:167],v6,49152
M v[124:127],a[172:175],a[92:95],v[124:127]
M v[120:123],a[172:175],a[84:87],v[120:123]
SA m0,s24,32768
T a[128:129],v1,16384
T a[130:131],v1,17408
M v[120:123],a[168:171],a[80:83],v[120:123]
buffer_load_dwordx4 v12, s[48:51], s22 offen offset:0   lds
M v[116:119],a[168:171],a[72:75],v[116:119]
M v[116:119],a[172:175],a[76:79],v[116:119]
M v[112:115],a[172:175],a[68:71],v[112:115]
M v[112:115],a[168:171],a[64:67],v[112:115]
M v[108:111],a[168:171],a[56:59],v[108:111]
M v[108:111],a[172:175],a[60:63],v[108:111]
s_nop 0
T a[132:133],v1,24576
T a[134:135],v1,25600
M v[104:107],a[172:175],a[52:55],v[104:107]
buffer_load_dwordx4 v13, s[48:51], s22 offen offset:1024   lds
M v[104:107],a[168:171],a[48:51],v[104:107]
M v[100:103],a[168:171],a[40:43],v[100:103]
M v[100:103],a[172:175],a[44:47],v[100:103]
s_waitcnt lgkmcnt(4)
M v[96:99],a[172:175],a[36:39],v[96:99]
M v[96:99],a[168:171],a[32:35],v[96:99]
M v[128:131],a[160:163],a[32:35],v[128:131]
R a[168:171],v5,51200
R a[172:175],v6,51200
M v[128:131],a[164:167],a[36:39],v[128:131]
T a[136:137],v2,16384
T a[138:139],v2,17408
M v[132:135],a[164:167],a[44:47],v[132:135]
buffer_load_dwordx4 v14, s[48:51], s22 offen offset:2048   lds
M v[132:135],a[160:163],a[40:43],v[132:135]
M v[136:139],a[160:163],a[48:51],v[136:139]
M v[136:139],a[164:167],a[52:55],v[136:139]
M v[140:143],a[164:167],a[60:63],v[140:143]
M v[140:143],a[160:163],a[56:59],v[140:143]
s_nop 0
T a[140:141],v2,24576
T a[142:143],v2,25600
M v[144:147],a[160:163],a[64:67],v[144:147]
buffer_load_dwordx4 v15, s[48:51], s22 offen offset:3072   lds
M v[144:147],a[164:167],a[68:71],v[144:147]
SA s22,s22,1048576
M v[148:151],a[164:167],a[76:79],v[148:151]
M v[148:151],a[160:163],a[72:75],v[148:151]
M v[152:155],a[160:163],a[80:83],v[152:155]
M v[152:155],a[164:167],a[84:87],v[152:155]
s_waitcnt lgkmcnt(4)
M v[156:159],a[164:167],a[92:95],v[156:159]
SA m0,s23,0
T a[144:145],v3,16384
T a[146:147],v3,17408
M v[156:159],a[160:163],a[88:91],v[156:159]
buffer_load_dwordx4 v8, s[16:19], s21 offen offset:0   lds
M v[188:191],a[168:171],a[88:91],v[188:191]
R a[160:163],v5,53248
R a[164:167],v6,53248
M v[188:191],a[172:175],a[92:95],v[188:191]
M v[184:187],a[172:175],a[84:87],v[184:187]
M v[184:187],a[168:171],a[80:83],v[184:187]
M v[180:183],a[168:171],a[72:75],v[180:183]
M v[180:183],a[172:175],a[76:79],v[180:183]
s_nop 0
T a[148:149],v3,24576
T a[150:151],v3,25600
M v[176:179],a[172:175],a[68:71],v[176:179]
buffer_load_dwordx4 v9, s[16:19], s21 offen offset:1024   lds
M v[176:179],a[168:171],a[64:67],v[176:179]
M v[172:175],a[168:171],a[56:59],v[172:175]
M v[172:175],a[172:175],a[60:63],v[172:175]
M v[168:171],a[172:175],a[52:55],v[168:171]
M v[168:171],a[168:171],a[48:51],v[168:171]
M v[164:167],a[168:171],a[40:43],v[164:167]
s_nop 0
T a[152:153],v4,16384
T a[154:155],v4,17408
M v[164:167],a[172:175],a[44:47],v[164:167]
s_waitcnt lgkmcnt(4)
buffer_load_dwordx4 v10, s[16:19], s21 offen offset:2048   lds
M v[160:163],a[172:175],a[36:39],v[160:163]
M v[160:163],a[168:171],a[32:35],v[160:163]
M v[192:195],a[160:163],a[32:35],v[192:195]
R a[168:171],v5,55296
R a[172:175],v6,55296
M v[192:195],a[164:167],a[36:39],v[192:195]
M v[196:199],a[164:167],a[44:47],v[196:199]
M v[196:199],a[160:163],a[40:43],v[196:199]
s_nop 0
T a[156:157],v4,24576
T a[158:159],v4,25600
M v[200:203],a[160:163],a[48:51],v[200:203]
buffer_load_dwordx4 v11, s[16:19], s21 offen offset:3072   lds
M v[200:203],a[164:167],a[52:55],v[200:203]
SA s21,s21,128
M v[204:207],a[164:167],a[60:63],v[204:207]
M v[204:207],a[160:163],a[56:59],v[204:207]
M v[208:211],a[160:163],a[64:67],v[208:211]
M v[208:211],a[164:167],a[68:71],v[208:211]
M v[212:215],a[164:167],a[76:79],v[212:215]
M v[212:215],a[160:163],a[72:75],v[212:215]
M v[216:219],a[160:163],a[80:83],v[216:219]
M v[216:219],a[164:167],a[84:87],v[216:219]
s_waitcnt lgkmcnt(2)
M v[220:223],a[164:167],a[92:95],v[220:223]
s_waitcnt vmcnt(17) lgkmcnt(0)
M v[220:223],a[160:163],a[88:91],v[220:223]
s_barrier
M v[252:255],a[168:171],a[88:91],v[252:255]
R a[160:163],v5,0
R a[164:167],v6,0
M v[252:255],a[172:175],a[92:95],v[252:255]
buffer_load_dword a240, v23, s[52:55], 0 offen offset:0
M v[248:251],a[172:175],a[84:87],v[248:251]
v_add_u32 v23, 16384, v23
M v[248:251],a[168:171],a[80:83],v[248:251]
M v[244:247],a[168:171],a[72:75],v[244:247]
M v[244:247],a[172:175],a[76:79],v[244:247]
M v[240:243],a[172:175],a[68:71],v[240:243]
M v[240:243],a[168:171],a[64:67],v[240:243]
M v[236:239],a[168:171],a[56:59],v[236:239]
M v[236:239],a[172:175],a[60:63],v[236:239]
M v[232:235],a[172:175],a[52:55],v[232:235]
M v[232:235],a[168:171],a[48:51],v[232:235]
M v[228:231],a[168:171],a[40:43],v[228:231]
M v[228:231],a[172:175],a[44:47],v[228:231]
s_waitcnt lgkmcnt(0)
M v[224:227],a[172:175],a[36:39],v[224:227]
M v[224:227],a[168:171],a[32:35],v[224:227]
M a[0:3],a[160:163],a[96:99],a[0:3]
R a[168:171],v5,2048
R a[172:175],v6,2048
M a[0:3],a[164:167],a[100:103],a[0:3]
T a[32:33],v1,32768
T a[34:35],v1,33792
M a[4:7],a[164:167],a[108:111],a[4:7]
SA m0,s24,49152
M a[4:7],a[160:163],a[104:107],a[4:7]
buffer_load_dwordx4 v12, s[48:51], s22 offen offset:0   lds
M a[8:11],a[160:163],a[112:115],a[8:11]
M a[8:11],a[164:167],a[116:119],a[8:11]
M a[12:15],a[164:167],a[124:127],a[12:15]
s_nop 0
T a[36:37],v1,40960
T a[38:39],v1,41984
M a[12:15],a[160:163],a[120:123],a[12:15]
M a[16:19],a[160:163],a[128:131],a[16:19]
buffer_load_dwordx4 v13, s[48:51], s22 offen offset:1024   lds
M a[16:19],a[164:167],a[132:135],a[16:19]
M a[20:23],a[164:167],a[140:143],a[20:23]
M a[20:23],a[160:163],a[136:139],a[20:23]
s_nop 0
T a[40:41],v2,32768
T a[42:43],v2,33792
M a[24:27],a[160:163],a[144:147],a[24:27]
M a[24:27],a[164:167],a[148:151],a[24:27]
s_waitcnt lgkmcnt(6)
buffer_load_dwordx4 v14, s[48:51], s22 offen offset:2048   lds
M a[28:31],a[164:167],a[156:159],a[28:31]
M a[28:31],a[160:163],a[152:155],a[28:31]
M v[60:63],a[168:171],a[152:155],v[60:63]
R a[160:163],v5,4096
R a[164:167],v6,4096
M v[60:63],a[172:175],a[156:159],v[60:63]
T a[44:45],v2,40960
T a[46:47],v2,41984
M v[56:59],a[172:175],a[148:151],v[56:59]
buffer_load_dwordx4 v15, s[48:51], s22 offen offset:3072   lds
M v[56:59],a[168:171],a[144:147],v[56:59]
s_sub_u32 s22, s22, 1048448
M v[52:55],a[168:171],a[136:139],v[52:55]
M v[52:55],a[172:175],a[140:143],v[52:55]
s_nop 0
T a[48:49],v3,32768
T a[50:51],v3,33792
M v[48:51],a[172:175],a[132:135],v[48:51]
SA m0,s23,16384
M v[48:51],a[168:171],a[128:131],v[48:51]
buffer_load_dwordx4 v8, s[16:19], s21 offen offset:0   lds
M v[44:47],a[168:171],a[120:123],v[44:47]
M v[44:47],a[172:175],a[124:127],v[44:47]
M v[40:43],a[172:175],a[116:119],v[40:43]
s_nop 0
T a[52:53],v3,40960
T a[54:55],v3,41984
M v[40:43],a[168:171],a[112:115],v[40:43]
M v[36:39],a[168:171],a[104:107],v[36:39]
buffer_load_dwordx4 v9, s[16:19], s21 offen offset:1024   lds
M v[36:39],a[172:175],a[108:111],v[36:39]
s_waitcnt lgkmcnt(6)
M v[32:35],a[172:175],a[100:103],v[32:35]
M v[32:35],a[168:171],a[96:99],v[32:35]
s_nop 0
T a[56:57],v4,32768
T a[58:59],v4,33792
M v[64:67],a[160:163],a[96:99],v[64:67]
R a[168:171],v5,6144
R a[172:175],v6,6144
M v[64:67],a[164:167],a[100:103],v[64:67]
buffer_load_dwordx4 v10, s[16:19], s21 offen offset:2048   lds
M v[68:71],a[164:167],a[108:111],v[68:71]
M v[68:71],a[160:163],a[104:107],v[68:71]
M v[72:75],a[160:163],a[112:115],v[72:75]
s_nop 0
T a[60:61],v4,40960
T a[62:63],v4,41984
M v[72:75],a[164:167],a[116:119],v[72:75]
M v[76:79],a[164:167],a[124:127],v[76:79]
buffer_load_dwordx4 v11, s[16:19], s21 offen offset:3072   lds
M v[76:79],a[160:163],a[120:123],v[76:79]
SA s21,s21,524160
M v[80:83],a[160:163],a[128:131],v[80:83]
M v[80:83],a[164:167],a[132:135],v[80:83]
M v[84:87],a[164:167],a[140:143],v[84:87]
M v[84:87],a[160:163],a[136:139],v[84:87]
M v[88:91],a[160:163],a[144:147],v[88:91]
M v[88:91],a[164:167],a[148:151],v[88:91]
s_waitcnt lgkmcnt(2)
M v[92:95],a[164:167],a[156:159],v[92:95]
s_waitcnt vmcnt(17) lgkmcnt(0)
M v[92:95],a[160:163],a[152:155],v[92:95]
s_barrier
M v[124:127],a[168:171],a[152:155],v[124:127]
R a[160:163],v5,16384
R a[164:167],v6,16384
M v[124:127],a[172:175],a[156:159],v[124:127]
M v[120:123],a[172:175],a[148:151],v[120:123]
SA m0,s24,0
T a[64:65],v1,49152
T a[66:67],v1,50176
M v[120:123],a[168:171],a[144:147],v[120:123]
buffer_load_dwordx4 v12, s[48:51], s22 offen offset:0   lds
M v[116:119],a[168:171],a[136:139],v[116:119]
M v[116:119],a[172:175],a[140:143],v[116:119]
M v[112:115],a[172:175],a[132:135],v[112:115]
M v[112:115],a[168:171],a[128:131],v[112:115]
M v[108:111],a[168:171],a[120:123],v[108:111]
M v[108:111],a[172:175],a[124:127],v[108:111]
s_nop 0
T a[68:69],v1,57344
T a[70:71],v1,58368
M v[104:107],a[172:175],a[116:119],v[104:107]
buffer_load_dwordx4 v13, s[48:51], s22 offen offset:1024   lds
M v[104:107],a[168:171],a[112:115],v[104:107]
M v[100:103],a[168:171],a[104:107],v[100:103]
M v[100:103],a[172:175],a[108:111],v[100:103]
s_waitcnt lgkmcnt(4)
M v[96:99],a[172:175],a[100:103],v[96:99]
M v[96:99],a[168:171],a[96:99],v[96:99]
M v[128:131],a[160:163],a[96:99],v[128:131]
R a[168:171],v5,18432
R a[172:175],v6,18432
M v[128:131],a[164:167],a[100:103],v[128:131]
T a[72:73],v2,49152
T a[74:75],v2,50176
M v[132:135],a[164:167],a[108:111],v[132:135]
buffer_load_dwordx4 v14, s[48:51], s22 offen offset:2048   lds
M v[132:135],a[160:163],a[104:107],v[132:135]
M v[136:139],a[160:163],a[112:115],v[136:139]
M v[136:139],a[164:167],a[116:119],v[136:139]
M v[140:143],a[164:167],a[124:127],v[140:143]
M v[140:143],a[160:163],a[120:123],v[140:143]
s_nop 0
T a[76:77],v2,57344
T a[78:79],v2,58368
M v[144:147],a[160:163],a[128:131],v[144:147]
buffer_load_dwordx4 v15, s[48:51], s22 offen offset:3072   lds
M v[144:147],a[164:167],a[132:135],v[144:147]
SA s22,s22,1048576
M v[148:151],a[164:167],a[140:143],v[148:151]
M v[148:151],a[160:163],a[136:139],v[148:151]
M v[152:155],a[160:163],a[144:147],v[152:155]
M v[152:155],a[164:167],a[148:151],v[152:155]
s_waitcnt lgkmcnt(4)
M v[156:159],a[164:167],a[156:159],v[156:159]
SA m0,s23,32768
T a[80:81],v3,49152
T a[82:83],v3,50176
M v[156:159],a[160:163],a[152:155],v[156:159]
buffer_load_dwordx4 v8, s[16:19], s21 offen offset:0   lds
M v[188:191],a[168:171],a[152:155],v[188:191]
R a[160:163],v5,20480
R a[164:167],v6,20480
M v[188:191],a[172:175],a[156:159],v[188:191]
M v[184:187],a[172:175],a[148:151],v[184:187]
M v[184:187],a[168:171],a[144:147],v[184:187]
M v[180:183],a[168:171],a[136:139],v[180:183]
M v[180:183],a[172:175],a[140:143],v[180:183]
s_nop 0
T a[84:85],v3,57344
T a[86:87],v3,58368
M v[176:179],a[172:175],a[132:135],v[176:179]
buffer_load_dwordx4 v9, s[16:19], s21 offen offset:1024   lds
M v[176:179],a[168:171],a[128:131],v[176:179]
M v[172:175],a[168:171],a[120:123],v[172:175]
M v[172:175],a[172:175],a[124:127],v[172:175]
M v[168:171],a[172:175],a[116:119],v[168:171]
M v[168:171],a[168:171],a[112:115],v[168:171]
M v[164:167],a[168:171],a[104:107],v[164:167]
s_nop 0
T a[88:89],v4,49152
T a[90:91],v4,50176
M v[164:167],a[172:175],a[108:111],v[164:167]
s_waitcnt lgkmcnt(4)
buffer_load_dwordx4 v10, s[16:19], s21 offen offset:2048   lds
M v[160:163],a[172:175],a[100:103],v[160:163]
M v[160:163],a[168:171],a[96:99],v[160:163]
M v[192:195],a[160:163],a[96:99],v[192:195]
R a[168:171],v5,22528
R a[172:175],v6,22528
M v[192:195],a[164:167],a[100:103],v[192:195]
M v[196:199],a[164:167],a[108:111],v[196:199]
M v[196:199],a[160:163],a[104:107],v[196:199]
s_nop 0
T a[92:93],v4,57344
T a[94:95],v4,58368
M v[200:203],a[160:163],a[112:115],v[200:203]
buffer_load_dwordx4 v11, s[16:19], s21 offen offset:3072   lds
M v[200:203],a[164:167],a[116:119],v[200:203]
SA s21,s21,128
M v[204:207],a[164:167],a[124:127],v[204:207]
M v[204:207],a[160:163],a[120:123],v[204:207]
M v[208:211],a[160:163],a[128:131],v[208:211]
M v[208:211],a[164:167],a[132:135],v[208:211]
M v[212:215],a[164:167],a[140:143],v[212:215]
M v[212:215],a[160:163],a[136:139],v[212:215]
M v[216:219],a[160:163],a[144:147],v[216:219]
M v[216:219],a[164:167],a[148:151],v[216:219]
s_waitcnt lgkmcnt(2)
M v[220:223],a[164:167],a[156:159],v[220:223]
s_waitcnt vmcnt(17) lgkmcnt(0)
M v[220:223],a[160:163],a[152:155],v[220:223]
s_barrier
M v[252:255],a[168:171],a[152:155],v[252:255]
R a[160:163],v5,32768
R a[164:167],v6,32768
M v[252:255],a[172:175],a[156:159],v[252:255]
buffer_load_dword a240, v23, s[52:55], 0 offen offset:0
M v[248:251],a[172:175],a[148:151],v[248:251]
L_w_kv15:
s_cbranch_execz L_w_kv19
v_add_u32 v23, 16384, v23
M v[248:251],a[168:171],a[144:147],v[248:251]
M v[244:247],a[168:171],a[136:139],v[244:247]
M v[244:247],a[172:175],a[140:143],v[244:247]
M v[240:243],a[172:175],a[132:135],v[240:243]
M v[240:243],a[168:171],a[128:131],v[240:243]
M v[236:239],a[168:171],a[120:123],v[236:239]
M v[236:239],a[172:175],a[124:127],v[236:239]
M v[232:235],a[172:175],a[116:119],v[232:235]
M v[232:235],a[168:171],a[112:115],v[232:235]
M v[228:231],a[168:171],a[104:107],v[228:231]
M v[228:231],a[172:175],a[108:111],v[228:231]
s_waitcnt lgkmcnt(0)
M v[224:227],a[172:175],a[100:103],v[224:227]
M v[224:227],a[168:171],a[96:99],v[224:227]
M a[0:3],a[160:163],a[32:35],a[0:3]
R a[168:171],v5,34816
R a[172:175],v6,34816
M a[0:3],a[164:167],a[36:39],a[0:3]
T a[96:97],v1,0
T a[98:99],v1,1024
M a[4:7],a[164:167],a[44:47],a[4:7]
SA m0,s24,16384
M a[4:7],a[160:163],a[40:43],a[4:7]
buffer_load_dwordx4 v12, s[48:51], s22 offen offset:0   lds
M a[8:11],a[160:163],a[48:51],a[8:11]
M a[8:11],a[164:167],a[52:55],a[8:11]
M a[12:15],a[164:167],a[60:63],a[12:15]
s_nop 0
T a[100:101],v1,8192
T a[102:103],v1,9216
M a[12:15],a[160:163],a[56:59],a[12:15]
M a[16:19],a[160:163],a[64:67],a[16:19]
buffer_load_dwordx4 v13, s[48:51], s22 offen offset:1024   lds
M a[16:19],a[164:167],a[68:71],a[16:19]
M a[20:23],a[164:167],a[76:79],a[20:23]
M a[20:23],a[160:163],a[72:75],a[20:23]
s_nop 0
T a[104:105],v2,0
T a[106:107],v2,1024
M a[24:27],a[160:163],a[80:83],a[24:27]
M a[24:27],a[164:167],a[84:87],a[24:27]
s_waitcnt lgkmcnt(6)
buffer_load_dwordx4 v14, s[48:51], s22 offen offset:2048   lds
M a[28:31],a[164:167],a[92:95],a[28:31]
M a[28:31],a[160:163],a[88:91],a[28:31]
M v[60:63],a[168:171],a[88:91],v[60:63]
R a[160:163],v5,36864
R a[164:167],v6,36864
M v[60:63],a[172:175],a[92:95],v[60:63]
T a[108:109],v2,8192
T a[110:111],v2,9216
M v[56:59],a[172:175],a[84:87],v[56:59]
buffer_load_dwordx4 v15, s[48:51], s22 offen offset:3072   lds
M v[56:59],a[168:171],a[80:83],v[56:59]
s_sub_u32 s22, s22, 1048448
M v[52:55],a[168:171],a[72:75],v[52:55]
M v[52:55],a[172:175],a[76:79],v[52:55]
s_nop 0
T a[112:113],v3,0
T a[114:115],v3,1024
M v[48:51],a[172:175],a[68:71],v[48:51]
SA m0,s23,49152
M v[48:51],a[168:171],a[64:67],v[48:51]
buffer_load_dwordx4 v8, s[16:19], s21 offen offset:0   lds
M v[44:47],a[168:171],a[56:59],v[44:47]
M v[44:47],a[172:175],a[60:63],v[44:47]
M v[40:43],a[172:175],a[52:55],v[40:43]
s_nop 0
T a[116:117],v3,8192
T a[118:119],v3,9216
M v[40:43],a[168:171],a[48:51],v[40:43]
M v[36:39],a[168:171],a[40:43],v[36:39]
buffer_load_dwordx4 v9, s[16:19], s21 offen offset:1024   lds
M v[36:39],a[172:175],a[44:47],v[36:39]
s_waitcnt lgkmcnt(6)
M v[32:35],a[172:175],a[36:39],v[32:35]
M v[32:35],a[168:171],a[32:35],v[32:35]
s_nop 0
T a[120:121],v4,0
T a[122:123],v4,1024
M v[64:67],a[160:163],a[32:35],v[64:67]
R a[168:171],v5,38912
R a[172:175],v6,38912
M v[64:67],a[164:167],a[36:39],v[64:67]
buffer_load_dwordx4 v10, s[16:19], s21 offen offset:2048   lds
M v[68:71],a[164:167],a[44:47],v[68:71]
M v[68:71],a[160:163],a[40:43],v[68:71]
M v[72:75],a[160:163],a[48:51],v[72:75]
s_nop 0
T a[124:125],v4,8192
T a[126:127],v4,9216
M v[72:75],a[164:167],a[52:55],v[72:75]
M v[76:79],a[164:167],a[60:63],v[76:79]
buffer_load_dwordx4 v11, s[16:19], s21 offen offset:3072   lds
M v[76:79],a[160:163],a[56:59],v[76:79]
SA s21,s21,524160
M v[80:83],a[160:163],a[64:67],v[80:83]
M v[80:83],a[164:167],a[68:71],v[80:83]
M v[84:87],a[164:167],a[76:79],v[84:87]
M v[84:87],a[160:163],a[72:75],v[84:87]
M v[88:91],a[160:163],a[80:83],v[88:91]
M v[88:91],a[164:167],a[84:87],v[88:91]
s_waitcnt lgkmcnt(2)
M v[92:95],a[164:167],a[92:95],v[92:95]
s_waitcnt vmcnt(17) lgkmcnt(0)
M v[92:95],a[160:163],a[88:91],v[92:95]
s_barrier
M v[124:127],a[168:171],a[88:91],v[124:127]
R a[160:163],v5,49152
R a[164:167],v6,49152
M v[124:127],a[172:175],a[92:95],v[124:127]
M v[120:123],a[172:175],a[84:87],v[120:123]
SA m0,s24,32768
T a[128:129],v1,16384
T a[130:131],v1,17408
M v[120:123],a[168:171],a[80:83],v[120:123]
buffer_load_dwordx4 v12, s[48:51], s22 offen offset:0   lds
M v[116:119],a[168:171],a[72:75],v[116:119]
M v[116:119],a[172:175],a[76:79],v[116:119]
M v[112:115],a[172:175],a[68:71],v[112:115]
M v[112:115],a[168:171],a[64:67],v[112:115]
M v[108:111],a[168:171],a[56:59],v[108:111]
M v[108:111],a[172:175],a[60:63],v[108:111]
s_nop 0
T a[132:133],v1,24576
T a[134:135],v1,25600
M v[104:107],a[172:175],a[52:55],v[104:107]
buffer_load_dwordx4 v13, s[48:51], s22 offen offset:1024   lds
M v[104:107],a[168:171],a[48:51],v[104:107]
M v[100:103],a[168:171],a[40:43],v[100:103]
M v[100:103],a[172:175],a[44:47],v[100:103]
s_waitcnt lgkmcnt(4)
M v[96:99],a[172:175],a[36:39],v[96:99]
M v[96:99],a[168:171],a[32:35],v[96:99]
M v[128:131],a[160:163],a[32:35],v[128:131]
R a[168:171],v5,51200
R a[172:175],v6,51200
M v[128:131],a[164:167],a[36:39],v[128:131]
T a[136:137],v2,16384
T a[138:139],v2,17408
M v[132:135],a[164:167],a[44:47],v[132:135]
buffer_load_dwordx4 v14, s[48:51], s22 offen offset:2048   lds
M v[132:135],a[160:163],a[40:43],v[132:135]
M v[136:139],a[160:163],a[48:51],v[136:139]
M v[136:139],a[164:167],a[52:55],v[136:139]
M v[140:143],a[164:167],a[60:63],v[140:143]
M v[140:143],a[160:163],a[56:59],v[140:143]
s_nop 0
T a[140:141],v2,24576
T a[142:143],v2,25600
M v[144:147],a[160:163],a[64:67],v[144:147]
buffer_load_dwordx4 v15, s[48:51], s22 offen offset:3072   lds
M v[144:147],a[164:167],a[68:71],v[144:147]
SA s22,s22,1048576
M v[148:151],a[164:167],a[76:79],v[148:151]
M v[148:151],a[160:163],a[72:75],v[148:151]
M v[152:155],a[160:163],a[80:83],v[152:155]
M v[152:155],a[164:167],a[84:87],v[152:155]
s_waitcnt lgkmcnt(4)
M v[156:159],a[164:167],a[92:95],v[156:159]
SA m0,s23,0
T a[144:145],v3,16384
T a[146:147],v3,17408
M v[156:159],a[160:163],a[88:91],v[156:159]
buffer_load_dwordx4 v8, s[16:19], s21 offen offset:0   lds
M v[188:191],a[168:171],a[88:91],v[188:191]
R a[160:163],v5,53248
R a[164:167],v6,53248
M v[188:191],a[172:175],a[92:95],v[188:191]
M v[184:187],a[172:175],a[84:87],v[184:187]
M v[184:187],a[168:171],a[80:83],v[184:187]
M v[180:183],a[168:171],a[72:75],v[180:183]
M v[180:183],a[172:175],a[76:79],v[180:183]
s_nop 0
T a[148:149],v3,24576
T a[150:151],v3,25600
M v[176:179],a[172:175],a[68:71],v[176:179]
buffer_load_dwordx4 v9, s[16:19], s21 offen offset:1024   lds
M v[176:179],a[168:171],a[64:67],v[176:179]
M v[172:175],a[168:171],a[56:59],v[172:175]
M v[172:175],a[172:175],a[60:63],v[172:175]
M v[168:171],a[172:175],a[52:55],v[168:171]
M v[168:171],a[168:171],a[48:51],v[168:171]
M v[164:167],a[168:171],a[40:43],v[164:167]
s_nop 0
T a[152:153],v4,16384
T a[154:155],v4,17408
M v[164:167],a[172:175],a[44:47],v[164:167]
s_waitcnt lgkmcnt(4)
buffer_load_dwordx4 v10, s[16:19], s21 offen offset:2048   lds
M v[160:163],a[172:175],a[36:39],v[160:163]
M v[160:163],a[168:171],a[32:35],v[160:163]
M v[192:195],a[160:163],a[32:35],v[192:195]
R a[168:171],v5,55296
R a[172:175],v6,55296
M v[192:195],a[164:167],a[36:39],v[192:195]
M v[196:199],a[164:167],a[44:47],v[196:199]
M v[196:199],a[160:163],a[40:43],v[196:199]
s_nop 0
T a[156:157],v4,24576
T a[158:159],v4,25600
M v[200:203],a[160:163],a[48:51],v[200:203]
buffer_load_dwordx4 v11, s[16:19], s21 offen offset:3072   lds
M v[200:203],a[164:167],a[52:55],v[200:203]
SA s21,s21,128
M v[204:207],a[164:167],a[60:63],v[204:207]
M v[204:207],a[160:163],a[56:59],v[204:207]
M v[208:211],a[160:163],a[64:67],v[208:211]
M v[208:211],a[164:167],a[68:71],v[208:211]
M v[212:215],a[164:167],a[76:79],v[212:215]
M v[212:215],a[160:163],a[72:75],v[212:215]
M v[216:219],a[160:163],a[80:83],v[216:219]
M v[216:219],a[164:167],a[84:87],v[216:219]
s_waitcnt lgkmcnt(2)
M v[220:223],a[164:167],a[92:95],v[220:223]
s_waitcnt vmcnt(17) lgkmcnt(0)
M v[220:223],a[160:163],a[88:91],v[220:223]
s_barrier
M v[252:255],a[168:171],a[88:91],v[252:255]
R a[160:163],v5,0
R a[164:167],v6,0
M v[252:255],a[172:175],a[92:95],v[252:255]
M v[248:251],a[172:175],a[84:87],v[248:251]
M v[248:251],a[168:171],a[80:83],v[248:251]
M v[244:247],a[168:171],a[72:75],v[244:247]
M v[244:247],a[172:175],a[76:79],v[244:247]
M v[240:243],a[172:175],a[68:71],v[240:243]
M v[240:243],a[168:171],a[64:67],v[240:243]
M v[236:239],a[168:171],a[56:59],v[236:239]
M v[236:239],a[172:175],a[60:63],v[236:239]
M v[232:235],a[172:175],a[52:55],v[232:235]
M v[232:235],a[168:171],a[48:51],v[232:235]
M v[228:231],a[168:171],a[40:43],v[228:231]
M v[228:231],a[172:175],a[44:47],v[228:231]
s_waitcnt lgkmcnt(0)
M v[224:227],a[172:175],a[36:39],v[224:227]
M v[224:227],a[168:171],a[32:35],v[224:227]
M a[0:3],a[160:163],a[96:99],a[0:3]
R a[168:171],v5,2048
R a[172:175],v6,2048
M a[0:3],a[164:167],a[100:103],a[0:3]
T a[32:33],v1,32768
T a[34:35],v1,33792
M a[4:7],a[164:167],a[108:111],a[4:7]
SA m0,s24,49152
v_lshrrev_b32 v28, 4, v0
v_and_b32 v29, 7, v0
M a[4:7],a[160:163],a[104:107],a[4:7]
buffer_load_dwordx4 v12, s[48:51], s22 offen offset:0   lds
M a[8:11],a[160:163],a[112:115],a[8:11]
v_xor_b32 v28, v28, v29
v_lshlrev_b32 v28, 4, v28
M a[8:11],a[164:167],a[116:119],a[8:11]
v_lshrrev_b32 v29, 3, v0
v_mul_u32_u24 v29, 896, v29
M a[12:15],a[164:167],a[124:127],a[12:15]
T a[36:37],v1,40960
T a[38:39],v1,41984
M a[12:15],a[160:163],a[120:123],a[12:15]
v_add_u32 v22, v28, v29
v_xor_b32 v28, 64, v28
M a[16:19],a[160:163],a[128:131],a[16:19]
s_mul_i32 s64, s20, 14336
buffer_load_dwordx4 v13, s[48:51], s22 offen offset:1024   lds
M a[16:19],a[164:167],a[132:135],a[16:19]
s_sub_u32 s65, 98304, s64
M a[20:23],a[164:167],a[140:143],a[20:23]
SA s30,s29,s65
M a[20:23],a[160:163],a[136:139],a[20:23]
SA s29,s29,s64
T a[40:41],v2,32768
T a[42:43],v2,33792
M a[24:27],a[160:163],a[144:147],a[24:27]
v_add_u32 v29, 6144, v29
v_add_u32 v23, v28, v29
M a[24:27],a[164:167],a[148:151],a[24:27]
s_waitcnt lgkmcnt(6)
buffer_load_dwordx4 v14, s[48:51], s22 offen offset:2048   lds
M a[28:31],a[164:167],a[156:159],a[28:31]
s_and_b32 s64, s20, 1
M a[28:31],a[160:163],a[152:155],a[28:31]
s_lshl_b32 s64, s64, 12
M v[60:63],a[168:171],a[152:155],v[60:63]
SA s64,s64,65536
R a[160:163],v5,4096
R a[164:167],v6,4096
M v[60:63],a[172:175],a[156:159],v[60:63]
T a[44:45],v2,40960
T a[46:47],v2,41984
M v[56:59],a[172:175],a[148:151],v[56:59]
buffer_load_dwordx4 v15, s[48:51], s22 offen offset:3072   lds
M v[56:59],a[168:171],a[144:147],v[56:59]
s_sub_u32 s22, s22, 1048448
v_add_u32 v20, s64, v5
v_add_u32 v21, s64, v6
M v[52:55],a[168:171],a[136:139],v[52:55]
M v[52:55],a[172:175],a[140:143],v[52:55]
s_nop 0
T a[48:49],v3,32768
T a[50:51],v3,33792
M v[48:51],a[172:175],a[132:135],v[48:51]
SA m0,s23,16384
M v[48:51],a[168:171],a[128:131],v[48:51]
buffer_load_dwordx4 v8, s[16:19], s21 offen offset:0   lds
M v[44:47],a[168:171],a[120:123],v[44:47]
M v[44:47],a[172:175],a[124:127],v[44:47]
M v[40:43],a[172:175],a[116:119],v[40:43]
s_nop 0
T a[52:53],v3,40960
T a[54:55],v3,41984
M v[40:43],a[168:171],a[112:115],v[40:43]
M v[36:39],a[168:171],a[104:107],v[36:39]
buffer_load_dwordx4 v9, s[16:19], s21 offen offset:1024   lds
M v[36:39],a[172:175],a[108:111],v[36:39]
s_waitcnt lgkmcnt(6)
M v[32:35],a[172:175],a[100:103],v[32:35]
M v[32:35],a[168:171],a[96:99],v[32:35]
s_nop 0
T a[56:57],v4,32768
T a[58:59],v4,33792
M v[64:67],a[160:163],a[96:99],v[64:67]
R a[168:171],v5,6144
R a[172:175],v6,6144
M v[64:67],a[164:167],a[100:103],v[64:67]
buffer_load_dwordx4 v10, s[16:19], s21 offen offset:2048   lds
M v[68:71],a[164:167],a[108:111],v[68:71]
M v[68:71],a[160:163],a[104:107],v[68:71]
M v[72:75],a[160:163],a[112:115],v[72:75]
s_nop 0
T a[60:61],v4,40960
T a[62:63],v4,41984
M v[72:75],a[164:167],a[116:119],v[72:75]
M v[76:79],a[164:167],a[124:127],v[76:79]
buffer_load_dwordx4 v11, s[16:19], s21 offen offset:3072   lds
M v[76:79],a[160:163],a[120:123],v[76:79]
SA s21,s21,524160
M v[80:83],a[160:163],a[128:131],v[80:83]
M v[80:83],a[164:167],a[132:135],v[80:83]
M v[84:87],a[164:167],a[140:143],v[84:87]
M v[84:87],a[160:163],a[136:139],v[84:87]
M v[88:91],a[160:163],a[144:147],v[88:91]
M v[88:91],a[164:167],a[148:151],v[88:91]
s_waitcnt lgkmcnt(2)
M v[92:95],a[164:167],a[156:159],v[92:95]
s_waitcnt vmcnt(16) lgkmcnt(0)
M v[92:95],a[160:163],a[152:155],v[92:95]
s_barrier
M v[124:127],a[168:171],a[152:155],v[124:127]
R a[160:163],v5,16384
R a[164:167],v6,16384
M v[124:127],a[172:175],a[156:159],v[124:127]
SA m0,s23,131072
M v[120:123],a[172:175],a[148:151],v[120:123]
s_nop 0
T a[64:65],v1,49152
T a[66:67],v1,50176
M v[120:123],a[168:171],a[144:147],v[120:123]
buffer_load_dwordx4 v22, s[56:59], s29 offen offset:0 lds
M v[116:119],a[168:171],a[136:139],v[116:119]
M v[116:119],a[172:175],a[140:143],v[116:119]
M v[112:115],a[172:175],a[132:135],v[112:115]
buffer_load_dwordx4 v23, s[56:59], s29 offen offset:1024 lds
M v[112:115],a[168:171],a[128:131],v[112:115]
M v[108:111],a[168:171],a[120:123],v[108:111]
M v[108:111],a[172:175],a[124:127],v[108:111]
s_nop 0
T a[68:69],v1,57344
T a[70:71],v1,58368
M v[104:107],a[172:175],a[116:119],v[104:107]
buffer_load_dwordx4 v22, s[56:59], s30 offen offset:2048 lds
M v[104:107],a[168:171],a[112:115],v[104:107]
M v[100:103],a[168:171],a[104:107],v[100:103]
M v[100:103],a[172:175],a[108:111],v[100:103]
s_waitcnt lgkmcnt(4)
M v[96:99],a[172:175],a[100:103],v[96:99]
M v[96:99],a[168:171],a[96:99],v[96:99]
buffer_load_dwordx4 v23, s[56:59], s30 offen offset:3072 lds
M v[128:131],a[160:163],a[96:99],v[128:131]
R a[168:171],v5,18432
R a[172:175],v6,18432
M v[128:131],a[164:167],a[100:103],v[128:131]
SA s29,s29,128
T a[72:73],v2,49152
T a[74:75],v2,50176
M v[132:135],a[164:167],a[108:111],v[132:135]
SA s30,s30,128
M v[132:135],a[160:163],a[104:107],v[132:135]
SA m0,s24,0
M v[136:139],a[160:163],a[112:115],v[136:139]
buffer_load_dwordx4 v12, s[48:51], s22 offen offset:0   lds
M v[136:139],a[164:167],a[116:119],v[136:139]
M v[140:143],a[164:167],a[124:127],v[140:143]
M v[140:143],a[160:163],a[120:123],v[140:143]
s_nop 0
T a[76:77],v2,57344
T a[78:79],v2,58368
M v[144:147],a[160:163],a[128:131],v[144:147]
buffer_load_dwordx4 v13, s[48:51], s22 offen offset:1024   lds
M v[144:147],a[164:167],a[132:135],v[144:147]
M v[148:151],a[164:167],a[140:143],v[148:151]
M v[148:151],a[160:163],a[136:139],v[148:151]
M v[152:155],a[160:163],a[144:147],v[152:155]
M v[152:155],a[164:167],a[148:151],v[152:155]
s_waitcnt lgkmcnt(4)
buffer_load_dwordx4 v14, s[48:51], s22 offen offset:2048   lds
M v[156:159],a[164:167],a[156:159],v[156:159]
s_nop 0
T a[80:81],v3,49152
T a[82:83],v3,50176
M v[156:159],a[160:163],a[152:155],v[156:159]
M v[188:191],a[168:171],a[152:155],v[188:191]
R a[160:163],v5,20480
R a[164:167],v6,20480
M v[188:191],a[172:175],a[156:159],v[188:191]
M v[184:187],a[172:175],a[148:151],v[184:187]
buffer_load_dwordx4 v15, s[48:51], s22 offen offset:3072   lds
M v[184:187],a[168:171],a[144:147],v[184:187]
M v[180:183],a[168:171],a[136:139],v[180:183]
M v[180:183],a[172:175],a[140:143],v[180:183]
SA s22,s22,1048576
T a[84:85],v3,57344
T a[86:87],v3,58368
M v[176:179],a[172:175],a[132:135],v[176:179]
SA m0,s23,32768
M v[176:179],a[168:171],a[128:131],v[176:179]
buffer_load_dwordx4 v8, s[16:19], s21 offen offset:0   lds
M v[172:175],a[168:171],a[120:123],v[172:175]
M v[172:175],a[172:175],a[124:127],v[172:175]
M v[168:171],a[172:175],a[116:119],v[168:171]
M v[168:171],a[168:171],a[112:115],v[168:171]
buffer_load_dwordx4 v9, s[16:19], s21 offen offset:1024   lds
M v[164:167],a[168:171],a[104:107],v[164:167]
s_nop 0
T a[88:89],v4,49152
T a[90:91],v4,50176
M v[164:167],a[172:175],a[108:111],v[164:167]
s_waitcnt lgkmcnt(4)
M v[160:163],a[172:175],a[100:103],v[160:163]
M v[160:163],a[168:171],a[96:99],v[160:163]
M v[192:195],a[160:163],a[96:99],v[192:195]
R a[168:171],v5,22528
R a[172:175],v6,22528
M v[192:195],a[164:167],a[100:103],v[192:195]
buffer_load_dwordx4 v10, s[16:19], s21 offen offset:2048   lds
M v[196:199],a[164:167],a[108:111],v[196:199]
M v[196:199],a[160:163],a[104:107],v[196:199]
s_nop 0
T a[92:93],v4,57344
T a[94:95],v4,58368
M v[200:203],a[160:163],a[112:115],v[200:203]
M v[200:203],a[164:167],a[116:119],v[200:203]
buffer_load_dwordx4 v11, s[16:19], s21 offen offset:3072   lds
M v[204:207],a[164:167],a[124:127],v[204:207]
M v[204:207],a[160:163],a[120:123],v[204:207]
M v[208:211],a[160:163],a[128:131],v[208:211]
M v[208:211],a[164:167],a[132:135],v[208:211]
M v[212:215],a[164:167],a[140:143],v[212:215]
SA s21,s21,128
M v[212:215],a[160:163],a[136:139],v[212:215]
M v[216:219],a[160:163],a[144:147],v[216:219]
M v[216:219],a[164:167],a[148:151],v[216:219]
s_waitcnt lgkmcnt(2)
M v[220:223],a[164:167],a[156:159],v[220:223]
s_waitcnt vmcnt(20) lgkmcnt(0)
M v[220:223],a[160:163],a[152:155],v[220:223]
s_barrier
M v[252:255],a[168:171],a[152:155],v[252:255]
R a[160:163],v5,32768
R a[164:167],v6,32768
M v[252:255],a[172:175],a[156:159],v[252:255]
M v[248:251],a[172:175],a[148:151],v[248:251]
M v[248:251],a[168:171],a[144:147],v[248:251]
M v[244:247],a[168:171],a[136:139],v[244:247]
M v[244:247],a[172:175],a[140:143],v[244:247]
M v[240:243],a[172:175],a[132:135],v[240:243]
M v[240:243],a[168:171],a[128:131],v[240:243]
M v[236:239],a[168:171],a[120:123],v[236:239]
M v[236:239],a[172:175],a[124:127],v[236:239]
M v[232:235],a[172:175],a[116:119],v[232:235]
M v[232:235],a[168:171],a[112:115],v[232:235]
M v[228:231],a[168:171],a[104:107],v[228:231]
M v[228:231],a[172:175],a[108:111],v[228:231]
s_waitcnt lgkmcnt(0)
M v[224:227],a[172:175],a[100:103],v[224:227]
M v[224:227],a[168:171],a[96:99],v[224:227]
M a[0:3],a[160:163],a[32:35],a[0:3]
R a[168:171],v5,34816
R a[172:175],v6,34816
M a[0:3],a[164:167],a[36:39],a[0:3]
SA m0,s23,147456
T a[96:97],v1,0
T a[98:99],v1,1024
M a[4:7],a[164:167],a[44:47],a[4:7]
buffer_load_dwordx4 v22, s[56:59], s29 offen offset:0 lds
M a[4:7],a[160:163],a[40:43],a[4:7]
M a[8:11],a[160:163],a[48:51],a[8:11]
M a[8:11],a[164:167],a[52:55],a[8:11]
buffer_load_dwordx4 v23, s[56:59], s29 offen offset:1024 lds
M a[12:15],a[164:167],a[60:63],a[12:15]
s_nop 0
T a[100:101],v1,8192
T a[102:103],v1,9216
M a[12:15],a[160:163],a[56:59],a[12:15]
M a[16:19],a[160:163],a[64:67],a[16:19]
buffer_load_dwordx4 v22, s[56:59], s30 offen offset:2048 lds
M a[16:19],a[164:167],a[68:71],a[16:19]
M a[20:23],a[164:167],a[76:79],a[20:23]
M a[20:23],a[160:163],a[72:75],a[20:23]
s_nop 0
T a[104:105],v2,0
T a[106:107],v2,1024
M a[24:27],a[160:163],a[80:83],a[24:27]
buffer_load_dwordx4 v23, s[56:59], s30 offen offset:3072 lds
M a[24:27],a[164:167],a[84:87],a[24:27]
s_waitcnt lgkmcnt(6)
M a[28:31],a[164:167],a[92:95],a[28:31]
SA s29,s29,128
M a[28:31],a[160:163],a[88:91],a[28:31]
SA s30,s30,128
M v[60:63],a[168:171],a[88:91],v[60:63]
SA m0,s24,16384
R a[160:163],v5,36864
R a[164:167],v6,36864
M v[60:63],a[172:175],a[92:95],v[60:63]
T a[108:109],v2,8192
T a[110:111],v2,9216
M v[56:59],a[172:175],a[84:87],v[56:59]
buffer_load_dwordx4 v12, s[48:51], s22 offen offset:0   lds
M v[56:59],a[168:171],a[80:83],v[56:59]
M v[52:55],a[168:171],a[72:75],v[52:55]
M v[52:55],a[172:175],a[76:79],v[52:55]
s_nop 0
T a[112:113],v3,0
T a[114:115],v3,1024
M v[48:51],a[172:175],a[68:71],v[48:51]
buffer_load_dwordx4 v13, s[48:51], s22 offen offset:1024   lds
M v[48:51],a[168:171],a[64:67],v[48:51]
M v[44:47],a[168:171],a[56:59],v[44:47]
M v[44:47],a[172:175],a[60:63],v[44:47]
buffer_load_dwordx4 v14, s[48:51], s22 offen offset:2048   lds
M v[40:43],a[172:175],a[52:55],v[40:43]
s_nop 0
T a[116:117],v3,8192
T a[118:119],v3,9216
L_w_kv16:
s_cbranch_execz L_w_kv110
M v[40:43],a[168:171],a[48:51],v[40:43]
M v[36:39],a[168:171],a[40:43],v[36:39]
buffer_load_dwordx4 v15, s[48:51], s22 offen offset:3072   lds
M v[36:39],a[172:175],a[44:47],v[36:39]
s_waitcnt lgkmcnt(6)
M v[32:35],a[172:175],a[36:39],v[32:35]
s_sub_u32 s22, s22, 1048448
M v[32:35],a[168:171],a[32:35],v[32:35]
SA m0,s23,49152
T a[120:121],v4,0
T a[122:123],v4,1024
M v[64:67],a[160:163],a[32:35],v[64:67]
R a[168:171],v5,38912
R a[172:175],v6,38912
M v[64:67],a[164:167],a[36:39],v[64:67]
buffer_load_dwordx4 v8, s[16:19], s21 offen offset:0   lds
M v[68:71],a[164:167],a[44:47],v[68:71]
M v[68:71],a[160:163],a[40:43],v[68:71]
M v[72:75],a[160:163],a[48:51],v[72:75]
s_waitcnt vmcnt(17)
s_nop 0
T a[124:125],v4,8192
T a[126:127],v4,9216
M v[72:75],a[164:167],a[52:55],v[72:75]
buffer_load_dwordx4 v9, s[16:19], s21 offen offset:1024   lds
M v[76:79],a[164:167],a[60:63],v[76:79]
R a[176:179],v20,0
R a[180:183],v20,2048
M v[76:79],a[160:163],a[56:59],v[76:79]
R a[184:187],v21,0
R a[188:191],v21,2048
M v[80:83],a[160:163],a[64:67],v[80:83]
buffer_load_dwordx4 v10, s[16:19], s21 offen offset:2048   lds
M v[80:83],a[164:167],a[68:71],v[80:83]
M v[84:87],a[164:167],a[76:79],v[84:87]
M v[84:87],a[160:163],a[72:75],v[84:87]
buffer_load_dwordx4 v11, s[16:19], s21 offen offset:3072   lds
M v[88:91],a[160:163],a[80:83],v[88:91]
SA s21,s21,524160
M v[88:91],a[164:167],a[84:87],v[88:91]
s_waitcnt lgkmcnt(6)
M v[92:95],a[164:167],a[92:95],v[92:95]
s_waitcnt lgkmcnt(0)
M v[92:95],a[160:163],a[88:91],v[92:95]
s_barrier
M v[124:127],a[168:171],a[88:91],v[124:127]
s_lshl_b32 s4, s20, 10
R a[160:163],v5,49152
R a[164:167],v6,49152
M v[124:127],a[172:175],a[92:95],v[124:127]
SA m0,s23,131072
v_bfe_u32 v28, v0, 3, 2
M v[120:123],a[172:175],a[84:87],v[120:123]
s_nop 0
T a[128:129],v1,16384
T a[130:131],v1,17408
M v[120:123],a[168:171],a[80:83],v[120:123]
buffer_load_dwordx4 v22, s[56:59], s29 offen offset:0 lds
M v[116:119],a[168:171],a[72:75],v[116:119]
v_lshrrev_b32 v29, 5, v0
v_lshl_add_u32 v28, v29, 3, v28
M v[116:119],a[172:175],a[76:79],v[116:119]
M v[112:115],a[172:175],a[68:71],v[112:115]
v_lshlrev_b32 v28, 13, v28
M v[112:115],a[168:171],a[64:67],v[112:115]
M v[108:111],a[168:171],a[56:59],v[108:111]
buffer_load_dwordx4 v23, s[56:59], s29 offen offset:1024 lds
M v[108:111],a[172:175],a[60:63],v[108:111]
s_nop 0
T a[132:133],v1,24576
T a[134:135],v1,25600
M v[104:107],a[172:175],a[52:55],v[104:107]
v_lshrrev_b32 v29, 4, v0
v_lshlrev_b32 v29, 1, v29
M v[104:107],a[168:171],a[48:51],v[104:107]
M v[100:103],a[168:171],a[40:43],v[100:103]
v_and_b32 v30, 7, v0
M v[100:103],a[172:175],a[44:47],v[100:103]
s_waitcnt lgkmcnt(4)
M v[96:99],a[172:175],a[36:39],v[96:99]
v_xor_b32 v29, v29, v30
M v[96:99],a[168:171],a[32:35],v[96:99]
buffer_load_dwordx4 v22, s[56:59], s30 offen offset:2048 lds
M v[128:131],a[160:163],a[32:35],v[128:131]
R a[168:171],v5,51200
R a[172:175],v6,51200
M v[128:131],a[164:167],a[36:39],v[128:131]
T a[136:137],v2,16384
T a[138:139],v2,17408
M v[132:135],a[164:167],a[44:47],v[132:135]
v_lshl_add_u32 v28, v29, 4, v28
M v[132:135],a[160:163],a[40:43],v[132:135]
s_and_b32 s64, s20, 1
M v[136:139],a[160:163],a[48:51],v[136:139]
s_lshl_b32 s64, s64, 17
M v[136:139],a[164:167],a[52:55],v[136:139]
s_lshr_b32 s65, s20, 1
M v[140:143],a[164:167],a[60:63],v[140:143]
s_lshl_b32 s65, s65, 15
SA s64,s64,s65
v_add_u32 v8, s64, v28
M v[140:143],a[160:163],a[56:59],v[140:143]
s_nop 0
T a[140:141],v2,24576
T a[142:143],v2,25600
M v[144:147],a[160:163],a[64:67],v[144:147]
buffer_load_dwordx4 v23, s[56:59], s30 offen offset:3072 lds
M v[144:147],a[164:167],a[68:71],v[144:147]
M v[148:151],a[164:167],a[76:79],v[148:151]
SA s29,s29,128
M v[148:151],a[160:163],a[72:75],v[148:151]
SA s30,s30,128
M v[152:155],a[160:163],a[80:83],v[152:155]
SA m0,s24,32768
M v[152:155],a[164:167],a[84:87],v[152:155]
s_waitcnt lgkmcnt(4)
buffer_load_dwordx4 v12, s[48:51], s22 offen offset:0   lds
M v[156:159],a[164:167],a[92:95],v[156:159]
s_nop 0
T a[144:145],v3,16384
T a[146:147],v3,17408
M v[156:159],a[160:163],a[88:91],v[156:159]
M v[188:191],a[168:171],a[88:91],v[188:191]
R a[160:163],v5,53248
R a[164:167],v6,53248
M v[188:191],a[172:175],a[92:95],v[188:191]
M v[184:187],a[172:175],a[84:87],v[184:187]
M v[184:187],a[168:171],a[80:83],v[184:187]
M v[180:183],a[168:171],a[72:75],v[180:183]
buffer_load_dwordx4 v13, s[48:51], s22 offen offset:1024   lds
M v[180:183],a[172:175],a[76:79],v[180:183]
s_nop 0
T a[148:149],v3,24576
T a[150:151],v3,25600
M v[176:179],a[172:175],a[68:71],v[176:179]
M v[176:179],a[168:171],a[64:67],v[176:179]
M v[172:175],a[168:171],a[56:59],v[172:175]
M v[172:175],a[172:175],a[60:63],v[172:175]
M v[168:171],a[172:175],a[52:55],v[168:171]
M v[168:171],a[168:171],a[48:51],v[168:171]
buffer_load_dwordx4 v14, s[48:51], s22 offen offset:2048   lds
M v[164:167],a[168:171],a[40:43],v[164:167]
s_nop 0
T a[152:153],v4,16384
T a[154:155],v4,17408
M v[164:167],a[172:175],a[44:47],v[164:167]
s_waitcnt lgkmcnt(4)
M v[160:163],a[172:175],a[36:39],v[160:163]
M v[160:163],a[168:171],a[32:35],v[160:163]
M v[192:195],a[160:163],a[32:35],v[192:195]
R a[168:171],v5,55296
R a[172:175],v6,55296
M v[192:195],a[164:167],a[36:39],v[192:195]
M v[196:199],a[164:167],a[44:47],v[196:199]
buffer_load_dwordx4 v15, s[48:51], s22 offen offset:3072   lds
M v[196:199],a[160:163],a[40:43],v[196:199]
s_nop 0
T a[156:157],v4,24576
T a[158:159],v4,25600
M v[200:203],a[160:163],a[48:51],v[200:203]
s_waitcnt vmcnt(16)
R a[192:195],v20,16384
R a[196:199],v20,18432
M v[200:203],a[164:167],a[52:55],v[200:203]
R a[200:203],v21,16384
R a[204:207],v21,18432
M v[204:207],a[164:167],a[60:63],v[204:207]
M v[204:207],a[160:163],a[56:59],v[204:207]
M v[208:211],a[160:163],a[64:67],v[208:211]
M v[208:211],a[164:167],a[68:71],v[208:211]
M v[212:215],a[164:167],a[76:79],v[212:215]
SA s22,s22,1048576
M v[212:215],a[160:163],a[72:75],v[212:215]
M v[216:219],a[160:163],a[80:83],v[216:219]
M v[216:219],a[164:167],a[84:87],v[216:219]
s_waitcnt lgkmcnt(6)
M v[220:223],a[164:167],a[92:95],v[220:223]
s_waitcnt lgkmcnt(0)
M v[220:223],a[160:163],a[88:91],v[220:223]
s_barrier
M v[252:255],a[168:171],a[88:91],v[252:255]
R a[160:163],v5,0
R a[164:167],v6,0
M v[252:255],a[172:175],a[92:95],v[252:255]
M v[248:251],a[172:175],a[84:87],v[248:251]
M v[248:251],a[168:171],a[80:83],v[248:251]
M v[244:247],a[168:171],a[72:75],v[244:247]
M v[244:247],a[172:175],a[76:79],v[244:247]
M v[240:243],a[172:175],a[68:71],v[240:243]
M v[240:243],a[168:171],a[64:67],v[240:243]
M v[236:239],a[168:171],a[56:59],v[236:239]
M v[236:239],a[172:175],a[60:63],v[236:239]
M v[232:235],a[172:175],a[52:55],v[232:235]
M v[232:235],a[168:171],a[48:51],v[232:235]
M v[228:231],a[168:171],a[40:43],v[228:231]
M v[228:231],a[172:175],a[44:47],v[228:231]
s_waitcnt lgkmcnt(0)
M v[224:227],a[172:175],a[36:39],v[224:227]
M v[224:227],a[168:171],a[32:35],v[224:227]
M a[0:3],a[160:163],a[96:99],a[0:3]
R a[168:171],v5,2048
R a[172:175],v6,2048
M a[0:3],a[164:167],a[100:103],a[0:3]
SA m0,s23,147456
T a[32:33],v1,32768
T a[34:35],v1,33792
M a[4:7],a[164:167],a[108:111],a[4:7]
buffer_load_dwordx4 v22, s[56:59], s29 offen offset:0 lds
M a[4:7],a[160:163],a[104:107],a[4:7]
M a[8:11],a[160:163],a[112:115],a[8:11]
M a[8:11],a[164:167],a[116:119],a[8:11]
buffer_load_dwordx4 v23, s[56:59], s29 offen offset:1024 lds
M a[12:15],a[164:167],a[124:127],a[12:15]
s_nop 0
T a[36:37],v1,40960
T a[38:39],v1,41984
M a[12:15],a[160:163],a[120:123],a[12:15]
M a[16:19],a[160:163],a[128:131],a[16:19]
buffer_load_dwordx4 v22, s[56:59], s30 offen offset:2048 lds
M a[16:19],a[164:167],a[132:135],a[16:19]
M a[20:23],a[164:167],a[140:143],a[20:23]
M a[20:23],a[160:163],a[136:139],a[20:23]
s_nop 0
T a[40:41],v2,32768
T a[42:43],v2,33792
M a[24:27],a[160:163],a[144:147],a[24:27]
buffer_load_dwordx4 v23, s[56:59], s30 offen offset:3072 lds
M a[24:27],a[164:167],a[148:151],a[24:27]
s_waitcnt lgkmcnt(6)
M a[28:31],a[164:167],a[156:159],a[28:31]
SA s29,s29,128
M a[28:31],a[160:163],a[152:155],a[28:31]
SA s30,s30,128
M v[60:63],a[168:171],a[152:155],v[60:63]
SA m0,s24,49152
R a[160:163],v5,4096
R a[164:167],v6,4096
M v[60:63],a[172:175],a[156:159],v[60:63]
T a[44:45],v2,40960
T a[46:47],v2,41984
M v[56:59],a[172:175],a[148:151],v[56:59]
buffer_load_dwordx4 v12, s[48:51], s22 offen offset:0   lds
M v[56:59],a[168:171],a[144:147],v[56:59]
M v[52:55],a[168:171],a[136:139],v[52:55]
M v[52:55],a[172:175],a[140:143],v[52:55]
s_nop 0
T a[48:49],v3,32768
T a[50:51],v3,33792
M v[48:51],a[172:175],a[132:135],v[48:51]
buffer_load_dwordx4 v13, s[48:51], s22 offen offset:1024   lds
M v[48:51],a[168:171],a[128:131],v[48:51]
M v[44:47],a[168:171],a[120:123],v[44:47]
M v[44:47],a[172:175],a[124:127],v[44:47]
buffer_load_dwordx4 v14, s[48:51], s22 offen offset:2048   lds
M v[40:43],a[172:175],a[116:119],v[40:43]
s_nop 0
T a[52:53],v3,40960
T a[54:55],v3,41984
M v[40:43],a[168:171],a[112:115],v[40:43]
M v[36:39],a[168:171],a[104:107],v[36:39]
buffer_load_dwordx4 v15, s[48:51], s22 offen offset:3072   lds
M v[36:39],a[172:175],a[108:111],v[36:39]
s_waitcnt lgkmcnt(6)
M v[32:35],a[172:175],a[100:103],v[32:35]
s_sub_u32 s22, s22, 1048448
M v[32:35],a[168:171],a[96:99],v[32:35]
s_mov_b32 s25, 0
T a[56:57],v4,32768
T a[58:59],v4,33792
M v[64:67],a[160:163],a[96:99],v[64:67]
SA m0,s4,0
R a[168:171],v5,6144
R a[172:175],v6,6144
M v[64:67],a[164:167],a[100:103],v[64:67]
buffer_load_dwordx4 v8, s[52:55], s25 offen lds
M v[68:71],a[164:167],a[108:111],v[68:71]
s_mov_b32 s25, 262144
M v[68:71],a[160:163],a[104:107],v[68:71]
SA m0,s4,4096
M v[72:75],a[160:163],a[112:115],v[72:75]
s_waitcnt vmcnt(13)
s_nop 0
T a[60:61],v4,40960
T a[62:63],v4,41984
M v[72:75],a[164:167],a[116:119],v[72:75]
buffer_load_dwordx4 v8, s[52:55], s25 offen lds
M v[76:79],a[164:167],a[124:127],v[76:79]
s_mov_b32 s25, 524288
R a[208:211],v20,0
R a[212:215],v20,2048
M v[76:79],a[160:163],a[120:123],v[76:79]
SA m0,s4,8192
R a[216:219],v21,0
R a[220:223],v21,2048
M v[80:83],a[160:163],a[128:131],v[80:83]
buffer_load_dwordx4 v8, s[52:55], s25 offen lds
M v[80:83],a[164:167],a[132:135],v[80:83]
s_mov_b32 s25, 786432
M v[84:87],a[164:167],a[140:143],v[84:87]
SA m0,s4,12288
M v[84:87],a[160:163],a[136:139],v[84:87]
buffer_load_dwordx4 v8, s[52:55], s25 offen lds
M v[88:91],a[160:163],a[144:147],v[88:91]
M v[88:91],a[164:167],a[148:151],v[88:91]
s_waitcnt lgkmcnt(6)
M v[92:95],a[164:167],a[156:159],v[92:95]
s_waitcnt lgkmcnt(0)
M v[92:95],a[160:163],a[152:155],v[92:95]
s_barrier
M v[124:127],a[168:171],a[152:155],v[124:127]
R a[160:163],v5,16384
R a[164:167],v6,16384
M v[124:127],a[172:175],a[156:159],v[124:127]
SA m0,s23,32768
M v[120:123],a[172:175],a[148:151],v[120:123]
s_nop 0
T a[64:65],v1,49152
T a[66:67],v1,50176
M v[120:123],a[168:171],a[144:147],v[120:123]
buffer_load_dwordx4 v22, s[56:59], s29 offen offset:0 lds
M v[116:119],a[168:171],a[136:139],v[116:119]
v_lshrrev_b32 v28, 2, v0
v_lshlrev_b32 v28, 7, v28
M v[116:119],a[172:175],a[140:143],v[116:119]
M v[112:115],a[172:175],a[132:135],v[112:115]
buffer_load_dwordx4 v23, s[56:59], s29 offen offset:1024 lds
M v[112:115],a[168:171],a[128:131],v[112:115]
v_and_b32 v29, 3, v0
M v[108:111],a[168:171],a[120:123],v[108:111]
v_lshl_add_u32 v28, v29, 3, v28
M v[108:111],a[172:175],a[124:127],v[108:111]
s_nop 0
T a[68:69],v1,57344
T a[70:71],v1,58368
M v[104:107],a[172:175],a[116:119],v[104:107]
buffer_load_dwordx4 v22, s[56:59], s30 offen offset:2048 lds
M v[104:107],a[168:171],a[112:115],v[104:107]
v_bfe_u32 v29, v0, 3, 2
M v[100:103],a[168:171],a[104:107],v[100:103]
M v[100:103],a[172:175],a[108:111],v[100:103]
s_waitcnt lgkmcnt(4)
v_lshl_add_u32 v16, v29, 5, v28
M v[96:99],a[172:175],a[100:103],v[96:99]
M v[96:99],a[168:171],a[96:99],v[96:99]
buffer_load_dwordx4 v23, s[56:59], s30 offen offset:3072 lds
M v[128:131],a[160:163],a[96:99],v[128:131]
R a[168:171],v5,18432
R a[172:175],v6,18432
M v[128:131],a[164:167],a[100:103],v[128:131]
SA s29,s29,128
T a[72:73],v2,49152
T a[74:75],v2,50176
M v[132:135],a[164:167],a[108:111],v[132:135]
SA s30,s30,128
v_xor_b32 v17, 32, v16
v_xor_b32 v18, 64, v16
M v[132:135],a[160:163],a[104:107],v[132:135]
SA m0,s23,65536
M v[136:139],a[160:163],a[112:115],v[136:139]
buffer_load_dwordx4 v22, s[56:59], s29 offen offset:0 lds
M v[136:139],a[164:167],a[116:119],v[136:139]
v_xor_b32 v19, 0x60, v16
M v[140:143],a[164:167],a[124:127],v[140:143]
v_add_u32 v12, 0x20000, v16
M v[140:143],a[160:163],a[120:123],v[140:143]
s_nop 0
T a[76:77],v2,57344
T a[78:79],v2,58368
M v[144:147],a[160:163],a[128:131],v[144:147]
buffer_load_dwordx4 v23, s[56:59], s29 offen offset:1024 lds
M v[144:147],a[164:167],a[132:135],v[144:147]
v_add_u32 v13, 0x20000, v17
M v[148:151],a[164:167],a[140:143],v[148:151]
M v[148:151],a[160:163],a[136:139],v[148:151]
v_add_u32 v14, 0x20000, v18
M v[152:155],a[160:163],a[144:147],v[152:155]
M v[152:155],a[164:167],a[148:151],v[152:155]
s_waitcnt lgkmcnt(4)
buffer_load_dwordx4 v22, s[56:59], s30 offen offset:2048 lds
M v[156:159],a[164:167],a[156:159],v[156:159]
s_nop 0
T a[80:81],v3,49152
T a[82:83],v3,50176
M v[156:159],a[160:163],a[152:155],v[156:159]
v_add_u32 v15, 0x20000, v19
M v[188:191],a[168:171],a[152:155],v[188:191]
R a[160:163],v5,20480
R a[164:167],v6,20480
M v[188:191],a[172:175],a[156:159],v[188:191]
M v[184:187],a[172:175],a[148:151],v[184:187]
buffer_load_dwordx4 v23, s[56:59], s30 offen offset:3072 lds
M v[184:187],a[168:171],a[144:147],v[184:187]
SA s29,s29,128
M v[180:183],a[168:171],a[136:139],v[180:183]
SA s30,s30,128
M v[180:183],a[172:175],a[140:143],v[180:183]
s_mov_b32 s25, 1048576
T a[84:85],v3,57344
T a[86:87],v3,58368
M v[176:179],a[172:175],a[132:135],v[176:179]
SA m0,s4,16384
M v[176:179],a[168:171],a[128:131],v[176:179]
buffer_load_dwordx4 v8, s[52:55], s25 offen lds
M v[172:175],a[168:171],a[120:123],v[172:175]
M v[172:175],a[172:175],a[124:127],v[172:175]
s_mov_b32 s25, 1310720
M v[168:171],a[172:175],a[116:119],v[168:171]
SA m0,s4,20480
M v[168:171],a[168:171],a[112:115],v[168:171]
buffer_load_dwordx4 v8, s[52:55], s25 offen lds
M v[164:167],a[168:171],a[104:107],v[164:167]
s_nop 0
T a[88:89],v4,49152
T a[90:91],v4,50176
M v[164:167],a[172:175],a[108:111],v[164:167]
s_waitcnt lgkmcnt(4)
M v[160:163],a[172:175],a[100:103],v[160:163]
s_mov_b32 s25, 1572864
M v[160:163],a[168:171],a[96:99],v[160:163]
SA m0,s4,24576
M v[192:195],a[160:163],a[96:99],v[192:195]
R a[168:171],v5,22528
R a[172:175],v6,22528
M v[192:195],a[164:167],a[100:103],v[192:195]
buffer_load_dwordx4 v8, s[52:55], s25 offen lds
M v[196:199],a[164:167],a[108:111],v[196:199]
M v[196:199],a[160:163],a[104:107],v[196:199]
s_mov_b32 s25, 1835008
T a[92:93],v4,57344
T a[94:95],v4,58368
M v[200:203],a[160:163],a[112:115],v[200:203]
SA m0,s4,28672
M v[200:203],a[164:167],a[116:119],v[200:203]
s_waitcnt vmcnt(19)
buffer_load_dwordx4 v8, s[52:55], s25 offen lds
M v[204:207],a[164:167],a[124:127],v[204:207]
R a[224:227],v20,16384
R a[228:231],v20,18432
M v[204:207],a[160:163],a[120:123],v[204:207]
R a[232:235],v21,16384
R a[236:239],v21,18432
M v[208:211],a[160:163],a[128:131],v[208:211]
v_subrev_u32 v20, 98304, v20
v_subrev_u32 v21, 98304, v21
M v[208:211],a[164:167],a[132:135],v[208:211]
M v[212:215],a[164:167],a[140:143],v[212:215]
M v[212:215],a[160:163],a[136:139],v[212:215]
M v[216:219],a[160:163],a[144:147],v[216:219]
M v[216:219],a[164:167],a[148:151],v[216:219]
s_waitcnt lgkmcnt(6)
M v[220:223],a[164:167],a[156:159],v[220:223]
s_waitcnt lgkmcnt(0)
M v[220:223],a[160:163],a[152:155],v[220:223]
s_barrier
M v[252:255],a[168:171],a[152:155],v[252:255]
R a[160:163],v5,32768
R a[164:167],v6,32768
M v[252:255],a[172:175],a[156:159],v[252:255]
M v[248:251],a[172:175],a[148:151],v[248:251]
M v[248:251],a[168:171],a[144:147],v[248:251]
M v[244:247],a[168:171],a[136:139],v[244:247]
M v[244:247],a[172:175],a[140:143],v[244:247]
M v[240:243],a[172:175],a[132:135],v[240:243]
M v[240:243],a[168:171],a[128:131],v[240:243]
M v[236:239],a[168:171],a[120:123],v[236:239]
M v[236:239],a[172:175],a[124:127],v[236:239]
M v[232:235],a[172:175],a[116:119],v[232:235]
M v[232:235],a[168:171],a[112:115],v[232:235]
M v[228:231],a[168:171],a[104:107],v[228:231]
M v[228:231],a[172:175],a[108:111],v[228:231]
s_waitcnt lgkmcnt(0)
M v[224:227],a[172:175],a[100:103],v[224:227]
M v[224:227],a[168:171],a[96:99],v[224:227]
M a[0:3],a[160:163],a[32:35],a[0:3]
R a[168:171],v5,34816
R a[172:175],v6,34816
M a[0:3],a[164:167],a[36:39],a[0:3]
SA m0,s23,81920
M a[4:7],a[164:167],a[44:47],a[4:7]
buffer_load_dwordx4 v22, s[56:59], s29 offen offset:0 lds
M a[4:7],a[160:163],a[40:43],a[4:7]
M a[8:11],a[160:163],a[48:51],a[8:11]
M a[8:11],a[164:167],a[52:55],a[8:11]
buffer_load_dwordx4 v23, s[56:59], s29 offen offset:1024 lds
M a[12:15],a[164:167],a[60:63],a[12:15]
M a[12:15],a[160:163],a[56:59],a[12:15]
M a[16:19],a[160:163],a[64:67],a[16:19]
M a[16:19],a[164:167],a[68:71],a[16:19]
buffer_load_dwordx4 v22, s[56:59], s30 offen offset:2048 lds
M a[20:23],a[164:167],a[76:79],a[20:23]
M a[20:23],a[160:163],a[72:75],a[20:23]
M a[24:27],a[160:163],a[80:83],a[24:27]
M a[24:27],a[164:167],a[84:87],a[24:27]
s_waitcnt lgkmcnt(0)
buffer_load_dwordx4 v23, s[56:59], s30 offen offset:3072 lds
M a[28:31],a[164:167],a[92:95],a[28:31]
SA s29,s29,128
M a[28:31],a[160:163],a[88:91],a[28:31]
SA s30,s30,128
M v[32:35],a[168:171],a[32:35],v[32:35]
s_mov_b32 s25, 2097152
R a[160:163],v5,36864
R a[164:167],v6,36864
M v[32:35],a[172:175],a[36:39],v[32:35]
SA m0,s4,131072
M v[36:39],a[172:175],a[44:47],v[36:39]
buffer_load_dwordx4 v8, s[52:55], s25 offen lds
M v[36:39],a[168:171],a[40:43],v[36:39]
s_mov_b32 s25, 2359296
M v[40:43],a[168:171],a[48:51],v[40:43]
SA m0,s4,135168
M v[40:43],a[172:175],a[52:55],v[40:43]
buffer_load_dwordx4 v8, s[52:55], s25 offen lds
M v[44:47],a[172:175],a[60:63],v[44:47]
G v24,a0
G v25,a1
M v[44:47],a[168:171],a[56:59],v[44:47]
s_mov_b32 s25, 2621440
G v26,a2
G v27,a3
M v[48:51],a[168:171],a[64:67],v[48:51]
SA m0,s4,139264
C v24,v24,v25
C v25,v26,v27
M v[48:51],a[172:175],a[68:71],v[48:51]
buffer_load_dwordx4 v8, s[52:55], s25 offen lds
M v[52:55],a[172:175],a[76:79],v[52:55]
C v26,v32,v33
C v27,v34,v35
M v[52:55],a[168:171],a[72:75],v[52:55]
SA s3,s93,0
M v[56:59],a[168:171],a[80:83],v[56:59]
s_mov_b32 s25, 2883584
buffer_store_dwordx4 v[24:27], v7, s[8:11], s3 offen offset:0 sc1
M v[56:59],a[172:175],a[84:87],v[56:59]
s_waitcnt lgkmcnt(0)
G v28,a4
G v29,a5
M v[60:63],a[172:175],a[92:95],v[60:63]
SA m0,s4,143360
G v30,a6
G v31,a7
M v[60:63],a[168:171],a[88:91],v[60:63]
s_waitcnt vmcnt(16)
buffer_load_dwordx4 v8, s[52:55], s25 offen lds
M v[64:67],a[160:163],a[32:35],v[64:67]
L_w_kv17:
s_cbranch_execz L_w_kv111
s_mov_b32 s25, 3145728
R a[168:171],v5,38912
R a[172:175],v6,38912
M v[64:67],a[164:167],a[36:39],v[64:67]
SA m0,s4,147456
C v28,v28,v29
C v29,v30,v31
M v[68:71],a[164:167],a[44:47],v[68:71]
buffer_load_dwordx4 v8, s[52:55], s25 offen lds
M v[68:71],a[160:163],a[40:43],v[68:71]
s_mov_b32 s25, 3407872
C v30,v36,v37
C v31,v38,v39
M v[72:75],a[160:163],a[48:51],v[72:75]
SA m0,s4,151552
buffer_store_dwordx4 v[28:31], v7, s[8:11], s3 offen offset:2048 sc1
M v[72:75],a[164:167],a[52:55],v[72:75]
G v24,a8
G v25,a9
M v[76:79],a[164:167],a[60:63],v[76:79]
G v26,a10
G v27,a11
M v[76:79],a[160:163],a[56:59],v[76:79]
buffer_load_dwordx4 v8, s[52:55], s25 offen lds
M v[80:83],a[160:163],a[64:67],v[80:83]
C v24,v24,v25
C v25,v26,v27
M v[80:83],a[164:167],a[68:71],v[80:83]
C v26,v40,v41
C v27,v42,v43
M v[84:87],a[164:167],a[76:79],v[84:87]
SA s3,s93,4096
buffer_store_dwordx4 v[24:27], v7, s[8:11], s3 offen offset:0 sc1
M v[84:87],a[160:163],a[72:75],v[84:87]
R a[96:99],v20,0
R a[100:103],v20,2048
M v[88:91],a[160:163],a[80:83],v[88:91]
R a[104:107],v21,0
R a[108:111],v21,2048
M v[88:91],a[164:167],a[84:87],v[88:91]
s_waitcnt lgkmcnt(4)
G v28,a12
G v29,a13
M v[92:95],a[164:167],a[92:95],v[92:95]
s_waitcnt lgkmcnt(0)
G v30,a14
G v31,a15
M v[92:95],a[160:163],a[88:91],v[92:95]
s_barrier
M v[96:99],a[168:171],a[32:35],v[96:99]
R a[160:163],v5,49152
R a[164:167],v6,49152
M v[96:99],a[172:175],a[36:39],v[96:99]
s_mov_b32 s25, 128
C v28,v28,v29
C v29,v30,v31
M v[100:103],a[172:175],a[44:47],v[100:103]
SA m0,s4,49152
C v30,v44,v45
C v31,v46,v47
M v[100:103],a[168:171],a[40:43],v[100:103]
s_waitcnt vmcnt(17)
buffer_store_dwordx4 v[28:31], v7, s[8:11], s3 offen offset:2048 sc1
M v[104:107],a[168:171],a[48:51],v[104:107]
G v24,a16
G v25,a17
M v[104:107],a[172:175],a[52:55],v[104:107]
G v26,a18
G v27,a19
M v[108:111],a[172:175],a[60:63],v[108:111]
buffer_load_dwordx4 v8, s[52:55], s25 offen lds
M v[108:111],a[168:171],a[56:59],v[108:111]
C v24,v24,v25
C v25,v26,v27
M v[112:115],a[168:171],a[64:67],v[112:115]
C v26,v48,v49
C v27,v50,v51
M v[112:115],a[172:175],a[68:71],v[112:115]
SA s3,s93,8192
buffer_store_dwordx4 v[24:27], v7, s[8:11], s3 offen offset:0 sc1
M v[116:119],a[172:175],a[76:79],v[116:119]
s_mov_b32 s25, 262272
R a[112:115],v20,32768
R a[116:119],v20,34816
M v[116:119],a[168:171],a[72:75],v[116:119]
SA m0,s4,53248
R a[120:123],v21,32768
R a[124:127],v21,34816
M v[120:123],a[168:171],a[80:83],v[120:123]
C v64,v64,v65
C v65,v66,v67
M v[120:123],a[172:175],a[84:87],v[120:123]
s_waitcnt lgkmcnt(4)
buffer_load_dwordx4 v8, s[52:55], s25 offen lds
M v[124:127],a[172:175],a[92:95],v[124:127]
C v66,v96,v97
C v67,v98,v99
M v[124:127],a[168:171],a[88:91],v[124:127]
G v28,a20
G v29,a21
M v[128:131],a[160:163],a[32:35],v[128:131]
R a[168:171],v5,51200
R a[172:175],v6,51200
M v[128:131],a[164:167],a[36:39],v[128:131]
G v30,a22
G v31,a23
M v[132:135],a[164:167],a[44:47],v[132:135]
C v28,v28,v29
C v29,v30,v31
M v[132:135],a[160:163],a[40:43],v[132:135]
s_mov_b32 s25, 524416
C v30,v52,v53
C v31,v54,v55
M v[136:139],a[160:163],a[48:51],v[136:139]
SA m0,s4,57344
buffer_store_dwordx4 v[28:31], v7, s[8:11], s3 offen offset:2048 sc1
M v[136:139],a[164:167],a[52:55],v[136:139]
C v68,v68,v69
C v69,v70,v71
M v[140:143],a[164:167],a[60:63],v[140:143]
C v70,v100,v101
C v71,v102,v103
M v[140:143],a[160:163],a[56:59],v[140:143]
C v72,v72,v73
C v73,v74,v75
M v[144:147],a[160:163],a[64:67],v[144:147]
buffer_load_dwordx4 v8, s[52:55], s25 offen lds
M v[144:147],a[164:167],a[68:71],v[144:147]
C v74,v104,v105
C v75,v106,v107
M v[148:151],a[164:167],a[76:79],v[148:151]
C v76,v76,v77
C v77,v78,v79
M v[148:151],a[160:163],a[72:75],v[148:151]
C v78,v108,v109
C v79,v110,v111
M v[152:155],a[160:163],a[80:83],v[152:155]
C v80,v80,v81
C v81,v82,v83
M v[152:155],a[164:167],a[84:87],v[152:155]
s_waitcnt lgkmcnt(0)
C v82,v112,v113
C v83,v114,v115
M v[156:159],a[164:167],a[92:95],v[156:159]
s_mov_b32 s25, 786560
C v84,v84,v85
C v85,v86,v87
M v[156:159],a[160:163],a[88:91],v[156:159]
SA m0,s4,61440
C v86,v116,v117
C v87,v118,v119
M v[160:163],a[168:171],a[32:35],v[160:163]
R a[160:163],v5,53248
R a[164:167],v6,53248
M v[160:163],a[172:175],a[36:39],v[160:163]
buffer_load_dwordx4 v8, s[52:55], s25 offen lds
M v[164:167],a[172:175],a[44:47],v[164:167]
G v24,a24
G v25,a25
M v[164:167],a[168:171],a[40:43],v[164:167]
G v26,a26
G v27,a27
M v[168:171],a[168:171],a[48:51],v[168:171]
C v24,v24,v25
C v25,v26,v27
M v[168:171],a[172:175],a[52:55],v[168:171]
C v26,v56,v57
C v27,v58,v59
M v[172:175],a[172:175],a[60:63],v[172:175]
SA s3,s93,12288
buffer_store_dwordx4 v[24:27], v7, s[8:11], s3 offen offset:0 sc1
M v[172:175],a[168:171],a[56:59],v[172:175]
C v88,v88,v89
C v89,v90,v91
M v[176:179],a[168:171],a[64:67],v[176:179]
C v90,v120,v121
C v91,v122,v123
M v[176:179],a[172:175],a[68:71],v[176:179]
C v92,v92,v93
C v93,v94,v95
M v[180:183],a[172:175],a[76:79],v[180:183]
C v94,v124,v125
C v95,v126,v127
M v[180:183],a[168:171],a[72:75],v[180:183]
G v28,a28
G v29,a29
M v[184:187],a[168:171],a[80:83],v[184:187]
G v30,a30
G v31,a31
M v[184:187],a[172:175],a[84:87],v[184:187]
s_waitcnt lgkmcnt(0)
C v28,v28,v29
C v29,v30,v31
M v[188:191],a[172:175],a[92:95],v[188:191]
C v30,v60,v61
C v31,v62,v63
M v[188:191],a[168:171],a[88:91],v[188:191]
buffer_store_dwordx4 v[28:31], v7, s[8:11], s3 offen offset:2048 sc1
M v[192:195],a[160:163],a[32:35],v[192:195]
s_waitcnt vmcnt(18)
R a[168:171],v5,55296
R a[172:175],v6,55296
M v[192:195],a[164:167],a[36:39],v[192:195]
C v128,v128,v129
C v129,v130,v131
M v[196:199],a[164:167],a[44:47],v[196:199]
C v130,v160,v161
C v131,v162,v163
M v[196:199],a[160:163],a[40:43],v[196:199]
C v132,v132,v133
C v133,v134,v135
M v[200:203],a[160:163],a[48:51],v[200:203]
C v134,v164,v165
C v135,v166,v167
M v[200:203],a[164:167],a[52:55],v[200:203]
C v136,v136,v137
C v137,v138,v139
M v[204:207],a[164:167],a[60:63],v[204:207]
C v138,v168,v169
C v139,v170,v171
M v[204:207],a[160:163],a[56:59],v[204:207]
C v140,v140,v141
C v141,v142,v143
M v[208:211],a[160:163],a[64:67],v[208:211]
C v142,v172,v173
C v143,v174,v175
M v[208:211],a[164:167],a[68:71],v[208:211]
C v144,v144,v145
C v145,v146,v147
M v[212:215],a[164:167],a[76:79],v[212:215]
R a[128:131],v20,49152
R a[132:135],v20,51200
R a[136:139],v21,49152
R a[140:143],v21,51200
M v[212:215],a[160:163],a[72:75],v[212:215]
C v146,v176,v177
C v147,v178,v179
M v[216:219],a[160:163],a[80:83],v[216:219]
C v148,v148,v149
C v149,v150,v151
M v[216:219],a[164:167],a[84:87],v[216:219]
s_waitcnt lgkmcnt(4)
C v150,v180,v181
C v151,v182,v183
M v[220:223],a[164:167],a[92:95],v[220:223]
s_waitcnt vmcnt(10) lgkmcnt(0)
C v152,v152,v153
C v153,v154,v155
M v[220:223],a[160:163],a[88:91],v[220:223]
s_barrier
M v[224:227],a[168:171],a[32:35],v[224:227]
s_nop 0
T v[32:33],v16,0
T v[34:35],v16,2048
M v[224:227],a[172:175],a[36:39],v[224:227]
C v154,v184,v185
C v155,v186,v187
M v[228:231],a[172:175],a[44:47],v[228:231]
T v[36:37],v16,4096
T v[38:39],v16,6144
M v[228:231],a[168:171],a[40:43],v[228:231]
T v[40:41],v16,8192
T v[42:43],v16,10240
M v[232:235],a[168:171],a[48:51],v[232:235]
C v156,v156,v157
C v157,v158,v159
M v[232:235],a[172:175],a[52:55],v[232:235]
T v[44:45],v16,12288
T v[46:47],v16,14336
M v[236:239],a[172:175],a[60:63],v[236:239]
T v[48:49],v16,16384
T v[50:51],v16,18432
M v[236:239],a[168:171],a[56:59],v[236:239]
C v158,v188,v189
C v159,v190,v191
M v[240:243],a[168:171],a[64:67],v[240:243]
T v[52:53],v16,20480
T v[54:55],v16,22528
M v[240:243],a[172:175],a[68:71],v[240:243]
T v[56:57],v16,24576
T v[58:59],v16,26624
M v[244:247],a[172:175],a[76:79],v[244:247]
C v192,v192,v193
C v193,v194,v195
M v[244:247],a[168:171],a[72:75],v[244:247]
C v194,v224,v225
C v195,v226,v227
M v[248:251],a[168:171],a[80:83],v[248:251]
C v196,v196,v197
C v197,v198,v199
M v[248:251],a[172:175],a[84:87],v[248:251]
C v198,v228,v229
C v199,v230,v231
M v[252:255],a[172:175],a[92:95],v[252:255]
C v200,v200,v201
C v201,v202,v203
M v[252:255],a[168:171],a[88:91],v[252:255]
s_waitcnt lgkmcnt(6)
C v202,v232,v233
C v203,v234,v235
M v[96:99],v[32:35],a[176:179],0
s_mul_i32 s72, s41, 4352
T a[144:145],v17,0
T a[146:147],v17,2048
M v[96:99],v[36:39],a[184:187],v[96:99]
s_mov_b32 s25, 1048704
C v204,v204,v205
C v205,v206,v207
M v[96:99],v[40:43],a[192:195],v[96:99]
s_waitcnt lgkmcnt(2)
T a[148:149],v17,4096
T a[150:151],v17,6144
M v[96:99],v[44:47],a[200:203],v[96:99]
SA m0,s4,98304
T a[152:153],v17,8192
T a[154:155],v17,10240
M v[96:99],v[48:51],a[208:211],v[96:99]
SA s46,s72,104923136
buffer_load_dwordx4 v8, s[52:55], s25 offen lds
M v[96:99],v[52:55],a[216:219],v[96:99]
s_lshl_b32 s45, s42, 7
T a[156:157],v17,12288
T a[158:159],v17,14336
M v[96:99],v[56:59],a[224:227],v[96:99]
s_mov_b32 s25, 1310848
T a[160:161],v17,16384
T a[162:163],v17,18432
M v[100:103],v[56:59],a[228:231],0
SA m0,s4,102400
C v206,v236,v237
C v207,v238,v239
M v[100:103],v[52:55],a[220:223],v[100:103]
SA s45,s45,s46
T a[164:165],v17,20480
T a[166:167],v17,22528
M v[100:103],v[48:51],a[212:215],v[100:103]
s_lshl_b32 s72, s20, 2
T a[168:169],v17,24576
T a[170:171],v17,26624
M v[100:103],v[44:47],a[204:207],v[100:103]
SA s72,s72,s45
buffer_load_dwordx4 v8, s[52:55], s25 offen lds
M v[100:103],v[40:43],a[196:199],v[100:103]
C v208,v208,v209
C v209,v210,v211
M v[100:103],v[36:39],a[188:191],v[100:103]
s_mov_b32 s25, 1572992
C v210,v240,v241
C v211,v242,v243
M v[100:103],v[32:35],a[180:183],v[100:103]
s_waitcnt lgkmcnt(6)
C v212,v212,v213
C v213,v214,v215
M v[104:107],a[144:147],a[176:179],0
SA m0,s4,106496
T v[32:33],v18,0
T v[34:35],v18,2048
M v[104:107],a[148:151],a[184:187],v[104:107]
buffer_load_dwordx4 v8, s[52:55], s25 offen lds
M v[104:107],a[152:155],a[192:195],v[104:107]
s_waitcnt lgkmcnt(2)
s_nop 0
T v[36:37],v18,4096
T v[38:39],v18,6144
M v[104:107],a[156:159],a[200:203],v[104:107]
s_mov_b32 s25, 1835136
T v[40:41],v18,8192
T v[42:43],v18,10240
M v[104:107],a[160:163],a[208:211],v[104:107]
SA m0,s4,110592
C v214,v244,v245
C v215,v246,v247
M v[104:107],a[164:167],a[216:219],v[104:107]
T v[44:45],v18,12288
T v[46:47],v18,14336
M v[104:107],a[168:171],a[224:227],v[104:107]
T v[48:49],v18,16384
T v[50:51],v18,18432
M v[108:111],a[168:171],a[228:231],0
buffer_load_dwordx4 v8, s[52:55], s25 offen lds
M v[108:111],a[164:167],a[220:223],v[108:111]
s_nop 0
T v[52:53],v18,20480
T v[54:55],v18,22528
M v[108:111],a[160:163],a[212:215],v[108:111]
s_mov_b32 s25, 2097280
T v[56:57],v18,24576
T v[58:59],v18,26624
M v[108:111],a[156:159],a[204:207],v[108:111]
SA m0,s4,114688
C v216,v216,v217
C v217,v218,v219
M v[108:111],a[152:155],a[196:199],v[108:111]
SA s3,s93,524288
buffer_load_dwordx4 v8, s[52:55], s25 offen lds
M v[108:111],a[148:151],a[188:191],v[108:111]
C v218,v248,v249
C v219,v250,v251
M v[108:111],a[144:147],a[180:183],v[108:111]
s_waitcnt lgkmcnt(6)
buffer_store_dwordx4 v[64:67], v7, s[8:11], s3 offen offset:0 sc1
M v[112:115],v[32:35],a[176:179],0
s_mov_b32 s25, 2359424
T a[144:145],v19,0
T a[146:147],v19,2048
M v[112:115],v[36:39],a[184:187],v[112:115]
SA m0,s4,118784
buffer_store_dwordx4 v[68:71], v7, s[8:11], s3 offen offset:2048 sc1
M v[112:115],v[40:43],a[192:195],v[112:115]
s_waitcnt lgkmcnt(2)
s_nop 0
T a[148:149],v19,4096
T a[150:151],v19,6144
M v[112:115],v[44:47],a[200:203],v[112:115]
T a[152:153],v19,8192
T a[154:155],v19,10240
M v[112:115],v[48:51],a[208:211],v[112:115]
buffer_load_dwordx4 v8, s[52:55], s25 offen lds
M v[112:115],v[52:55],a[216:219],v[112:115]
s_nop 0
T a[156:157],v19,12288
T a[158:159],v19,14336
M v[112:115],v[56:59],a[224:227],v[112:115]
s_mov_b32 s25, 2621568
T a[160:161],v19,16384
T a[162:163],v19,18432
M v[116:119],v[56:59],a[228:231],0
SA m0,s4,122880
C v220,v220,v221
C v221,v222,v223
M v[116:119],v[52:55],a[220:223],v[116:119]
T a[164:165],v19,20480
T a[166:167],v19,22528
M v[116:119],v[48:51],a[212:215],v[116:119]
T a[168:169],v19,24576
T a[170:171],v19,26624
M v[116:119],v[44:47],a[204:207],v[116:119]
buffer_load_dwordx4 v8, s[52:55], s25 offen lds
M v[116:119],v[40:43],a[196:199],v[116:119]
C v222,v252,v253
C v223,v254,v255
M v[116:119],v[36:39],a[188:191],v[116:119]
s_mov_b32 s25, 2883712
v_min_u32 v29, 1, v0
v_lshlrev_b32 v29, 29, v29
M v[116:119],v[32:35],a[180:183],v[116:119]
s_waitcnt lgkmcnt(6)
v_mov_b32 v30, 1
v_add_u32 v20, 0x10000, v16
M v[120:123],a[144:147],a[176:179],0
SA m0,s4,126976
T v[32:33],v16,28672
T v[34:35],v16,30720
M v[120:123],a[148:151],a[184:187],v[120:123]
buffer_load_dwordx4 v8, s[52:55], s25 offen lds
M v[120:123],a[152:155],a[192:195],v[120:123]
s_waitcnt lgkmcnt(2)
s_nop 0
T v[36:37],v12,0
T v[38:39],v12,2048
M v[120:123],a[156:159],a[200:203],v[120:123]
s_mov_b32 s25, 3145856
T v[40:41],v12,4096
T v[42:43],v12,6144
M v[120:123],a[160:163],a[208:211],v[120:123]
SA m0,s4,32768
v_add_u32 v21, 0x10000, v17
v_add_u32 v22, 0x10000, v18
M v[120:123],a[164:167],a[216:219],v[120:123]
T v[44:45],v12,8192
T v[46:47],v12,10240
M v[120:123],a[168:171],a[224:227],v[120:123]
T v[48:49],v12,12288
T v[50:51],v12,14336
M v[124:127],a[168:171],a[228:231],0
buffer_load_dwordx4 v8, s[52:55], s25 offen lds
M v[124:127],a[164:167],a[220:223],v[124:127]
s_nop 0
T v[52:53],v12,16384
T v[54:55],v12,18432
M v[124:127],a[160:163],a[212:215],v[124:127]
s_mov_b32 s25, 3408000
T v[56:57],v12,20480
T v[58:59],v12,22528
M v[124:127],a[156:159],a[204:207],v[124:127]
SA m0,s4,36864
v_add_u32 v23, 0x10000, v19
v_or_b32 v1, s20, v0
M v[124:127],a[152:155],a[196:199],v[124:127]
SA s3,s93,528384
buffer_load_dwordx4 v8, s[52:55], s25 offen lds
M v[124:127],a[148:151],a[188:191],v[124:127]
v_min_u32 v1, 1, v1
v_lshlrev_b32 v1, 29, v1
M v[124:127],a[144:147],a[180:183],v[124:127]
s_waitcnt lgkmcnt(6)
buffer_store_dwordx4 v[72:75], v7, s[8:11], s3 offen offset:0 sc1
M v[96:99],v[32:35],a[232:235],v[96:99]
s_mov_b32 s25, 256
T a[144:145],v17,28672
T a[146:147],v17,30720
M v[96:99],v[36:39],a[96:99],v[96:99]
SA m0,s4,65536
v_min_u32 v9, 15, v0
v_lshlrev_b32 v9, 7, v9
M v[96:99],v[40:43],a[104:107],v[96:99]
s_waitcnt lgkmcnt(2)
T a[148:149],v13,0
T a[150:151],v13,2048
M v[96:99],v[44:47],a[112:115],v[96:99]
s_sub_u32 s66, 15, s42
T a[152:153],v13,4096
T a[154:155],v13,6144
M v[96:99],v[48:51],a[120:123],v[96:99]
s_max_u32 s67, s66, s42
buffer_load_dwordx4 v8, s[52:55], s25 offen lds
M v[96:99],v[52:55],a[128:131],v[96:99]
s_min_u32 s66, s66, s42
T a[156:157],v13,8192
T a[158:159],v13,10240
M v[96:99],v[56:59],a[136:139],v[96:99]
s_mov_b32 s25, 262400
T a[160:161],v13,12288
T a[162:163],v13,14336
M v[100:103],v[56:59],a[140:143],v[100:103]
SA m0,s4,69632
M v[100:103],v[52:55],a[132:135],v[100:103]
s_mul_i32 s21, s41, 1048576
T a[164:165],v13,16384
T a[166:167],v13,18432
M v[100:103],v[48:51],a[124:127],v[100:103]
s_lshl_b32 s64, s67, 16
T a[168:169],v13,20480
T a[170:171],v13,22528
L_w_kv18:
s_cbranch_execz L_w_kv112
M v[100:103],v[44:47],a[116:119],v[100:103]
SA s32,s21,s64
buffer_load_dwordx4 v8, s[52:55], s25 offen lds
M v[100:103],v[40:43],a[108:111],v[100:103]
s_lshl_b32 s64, s20, 14
M v[100:103],v[36:39],a[100:103],v[100:103]
s_mov_b32 s25, 524544
M v[100:103],v[32:35],a[236:239],v[100:103]
s_waitcnt lgkmcnt(6)
M v[104:107],a[144:147],a[232:235],v[104:107]
SA m0,s4,73728
T v[32:33],v18,28672
T v[34:35],v18,30720
M v[104:107],a[148:151],a[96:99],v[104:107]
SA s32,s32,s64
buffer_load_dwordx4 v8, s[52:55], s25 offen lds
M v[104:107],a[152:155],a[104:107],v[104:107]
s_waitcnt lgkmcnt(2)
s_nop 0
T v[36:37],v14,0
T v[38:39],v14,2048
M v[104:107],a[156:159],a[112:115],v[104:107]
s_mov_b32 s25, 786688
T v[40:41],v14,4096
T v[42:43],v14,6144
M v[104:107],a[160:163],a[120:123],v[104:107]
SA m0,s4,77824
M v[104:107],a[164:167],a[128:131],v[104:107]
SA s32,s32,33554432
T v[44:45],v14,8192
T v[46:47],v14,10240
M v[104:107],a[168:171],a[136:139],v[104:107]
s_sub_u32 s64, s42, 10
T v[48:49],v14,12288
T v[50:51],v14,14336
M v[108:111],a[168:171],a[140:143],v[108:111]
s_and_b32 s35, s64, 536870912
buffer_load_dwordx4 v8, s[52:55], s25 offen lds
M v[108:111],a[164:167],a[132:135],v[108:111]
s_nop 0
T v[52:53],v14,16384
T v[54:55],v14,18432
M v[108:111],a[160:163],a[124:127],v[108:111]
s_mov_b32 s25, 1048832
T v[56:57],v14,20480
T v[58:59],v14,22528
M v[108:111],a[156:159],a[116:119],v[108:111]
SA m0,s4,81920
v_or_b32 v6, s35, v7
MF v96,s5,v96
M v[108:111],a[152:155],a[108:111],v[108:111]
s_lshl_b32 s28, s20, 13
buffer_load_dwordx4 v8, s[52:55], s25 offen lds
M v[108:111],a[148:151],a[100:103],v[108:111]
v_add_u32 v2, 0x10000, v7
v_add_u32 v3, s28, v7
M v[108:111],a[144:147],a[236:239],v[108:111]
s_waitcnt lgkmcnt(6)
v_add_u32 v4, 0x1000, v3
MF v97,s5,v97
M v[112:115],v[32:35],a[232:235],v[112:115]
s_mov_b32 s25, 1310976
T a[144:145],v19,28672
T a[146:147],v19,30720
M v[112:115],v[36:39],a[96:99],v[112:115]
SA m0,s4,86016
MF v98,s5,v98
MF v99,s5,v99
M v[112:115],v[40:43],a[104:107],v[112:115]
s_waitcnt lgkmcnt(2)
T a[148:149],v15,0
T a[150:151],v15,2048
M v[112:115],v[44:47],a[112:115],v[112:115]
s_lshl_b32 s64, s42, 16
T a[152:153],v15,4096
T a[154:155],v15,6144
M v[112:115],v[48:51],a[120:123],v[112:115]
SA s23,s21,s64
buffer_load_dwordx4 v8, s[52:55], s25 offen lds
M v[112:115],v[52:55],a[128:131],v[112:115]
SA s43,s23,16777216
T a[156:157],v15,8192
T a[158:159],v15,10240
M v[112:115],v[56:59],a[136:139],v[112:115]
s_mov_b32 s25, 1573120
T a[160:161],v15,12288
T a[162:163],v15,14336
M v[116:119],v[56:59],a[140:143],v[116:119]
SA m0,s4,90112
MF v104,s5,v104
MF v105,s5,v105
M v[116:119],v[52:55],a[132:135],v[116:119]
SA s26,s21,16777216
T a[164:165],v15,16384
T a[166:167],v15,18432
M v[116:119],v[48:51],a[124:127],v[116:119]
s_min_u32 s27, s42, 9
T a[168:169],v15,20480
T a[170:171],v15,22528
M v[116:119],v[44:47],a[116:119],v[116:119]
s_lshl_b32 s22, s27, 1
buffer_load_dwordx4 v8, s[52:55], s25 offen lds
M v[116:119],v[40:43],a[108:111],v[116:119]
s_sub_u32 s22, s22, 1
MF v106,s5,v106
MF v107,s5,v107
M v[116:119],v[36:39],a[100:103],v[116:119]
s_waitcnt vmcnt(8) lgkmcnt(0)
C v96,v96,v97
C v97,v98,v99
M v[116:119],v[32:35],a[236:239],v[116:119]
s_barrier
M v[120:123],a[144:147],a[232:235],v[120:123]
s_mov_b32 s25, 1835264
T v[32:33],v16,49152
T v[34:35],v16,51200
M v[120:123],a[148:151],a[96:99],v[120:123]
SA m0,s4,94208
C v98,v104,v105
C v99,v106,v107
M v[120:123],a[152:155],a[104:107],v[120:123]
s_sub_u32 s27, s27, 2
T v[36:37],v16,53248
T v[38:39],v16,55296
M v[120:123],a[156:159],a[112:115],v[120:123]
s_mov_b32 s31, 0x4b800000
T v[40:41],v16,57344
T v[42:43],v16,59392
M v[120:123],a[160:163],a[120:123],v[120:123]
s_mov_b32 s24, 0x33800000
buffer_load_dwordx4 v8, s[52:55], s25 offen lds
M v[120:123],a[164:167],a[128:131],v[120:123]
s_lshl_b32 s47, s66, 7
T v[44:45],v16,61440
T v[46:47],v16,63488
M v[120:123],a[168:171],a[136:139],v[120:123]
s_mov_b32 s25, 2097408
T v[48:49],v20,32768
T v[50:51],v20,34816
M v[124:127],a[168:171],a[140:143],v[124:127]
SA m0,s4,155648
W a0,v96
W a1,v97
M v[124:127],a[164:167],a[132:135],v[124:127]
SA s47,s47,s46
T v[52:53],v20,36864
T v[54:55],v20,38912
M v[124:127],a[160:163],a[124:127],v[124:127]
s_lshl_b32 s64, s20, 5
T v[56:57],v20,40960
T v[58:59],v20,43008
M v[124:127],a[156:159],a[116:119],v[124:127]
SA s47,s47,s64
buffer_load_dwordx4 v8, s[52:55], s25 offen lds
M v[124:127],a[152:155],a[108:111],v[124:127]
SA s47,s47,2048
W a2,v98
W a3,v99
M v[124:127],a[148:151],a[100:103],v[124:127]
s_lshl_b32 s65, s41, 3
MF v100,s5,v100
MF v101,s5,v101
M v[124:127],a[144:147],a[236:239],v[124:127]
s_waitcnt lgkmcnt(6)
MF v102,s5,v102
MF v103,s5,v103
M v[160:163],v[32:35],a[176:179],0
SA s65,s65,s66
T a[144:145],v17,49152
T a[146:147],v17,51200
M v[160:163],v[36:39],a[184:187],v[160:163]
s_mul_i32 s34, s65, 73728
MF v108,s5,v108
MF v109,s5,v109
M v[160:163],v[40:43],a[192:195],v[160:163]
s_waitcnt lgkmcnt(2)
T a[148:149],v17,53248
T a[150:151],v17,55296
M v[160:163],v[44:47],a[200:203],v[160:163]
SA s34,s34,136314880
T a[152:153],v17,57344
T a[154:155],v17,59392
M v[160:163],v[48:51],a[208:211],v[160:163]
s_lshl_b32 s65, s42, 4
MF v110,s5,v110
MF v111,s5,v111
M v[160:163],v[52:55],a[216:219],v[160:163]
SA s65,s65,s41
T a[156:157],v17,61440
T a[158:159],v17,63488
M v[160:163],v[56:59],a[224:227],v[160:163]
s_mul_i32 s33, s65, 114688
T a[160:161],v21,32768
T a[162:163],v21,34816
M v[164:167],v[56:59],a[228:231],0
s_mul_i32 s65, s20, 28672
C v100,v100,v101
C v101,v102,v103
M v[164:167],v[52:55],a[220:223],v[164:167]
SA s33,s33,s65
T a[164:165],v21,36864
T a[166:167],v21,38912
M v[164:167],v[48:51],a[212:215],v[164:167]
SA s33,s33,67108864
T a[168:169],v21,40960
T a[170:171],v21,43008
M v[164:167],v[44:47],a[204:207],v[164:167]
s_mov_b32 s6, 0
C v102,v108,v109
C v103,v110,v111
M v[164:167],v[40:43],a[196:199],v[164:167]
s_mov_b32 s7, 1
W a32,v100
W a33,v101
M v[164:167],v[36:39],a[188:191],v[164:167]
s_mov_b32 s40, 1
W a34,v102
W a35,v103
M v[164:167],v[32:35],a[180:183],v[164:167]
s_waitcnt lgkmcnt(6)
MF v112,s5,v112
MF v113,s5,v113
M v[168:171],a[144:147],a[176:179],0
s_cmp_eq_u32 s20, 0
T v[32:33],v18,49152
T v[34:35],v18,51200
M v[168:171],a[148:151],a[184:187],v[168:171]
s_cselect_b32 s39, 6, 4
MF v114,s5,v114
MF v115,s5,v115
M v[168:171],a[152:155],a[192:195],v[168:171]
s_waitcnt lgkmcnt(2)
T v[36:37],v18,53248
T v[38:39],v18,55296
M v[168:171],a[156:159],a[200:203],v[168:171]
s_mov_b64 s[60:61], s[76:77]
T v[40:41],v18,57344
T v[42:43],v18,59392
M v[168:171],a[160:163],a[208:211],v[168:171]
s_mov_b32 s62, s78
MF v120,s5,v120
MF v121,s5,v121
M v[168:171],a[164:167],a[216:219],v[168:171]
s_mov_b32 s63, 0x20000
T v[44:45],v18,61440
T v[46:47],v18,63488
M v[168:171],a[168:171],a[224:227],v[168:171]
SA s30,s32,0
T v[48:49],v22,32768
T v[50:51],v22,34816
M v[172:175],a[168:171],a[228:231],0
s_mov_b32 s25, 2359552
buffer_store_dwordx4 a[0:3], v6, s[8:11], s30 offen offset:0 sc1
M v[172:175],a[164:167],a[220:223],v[172:175]
SA m0,s4,159744
T v[52:53],v22,36864
T v[54:55],v22,38912
M v[172:175],a[160:163],a[212:215],v[172:175]
T v[56:57],v22,40960
T v[58:59],v22,43008
M v[172:175],a[156:159],a[204:207],v[172:175]
SA s3,s93,528384
buffer_load_dwordx4 v8, s[52:55], s25 offen lds
M v[172:175],a[152:155],a[196:199],v[172:175]
buffer_store_dword v30, v29, s[8:11], s72 offen offset:4 sc1
M v[172:175],a[148:151],a[188:191],v[172:175]
s_mov_b32 s25, 2621696
buffer_store_dwordx4 v[76:79], v7, s[8:11], s3 offen offset:2048 sc1
M v[172:175],a[144:147],a[180:183],v[172:175]
s_waitcnt lgkmcnt(6)
v_lshrrev_b32 v24, 4, v0
v_lshlrev_b32 v24, 2, v24
M v[176:179],v[32:35],a[176:179],0
SA m0,s4,131072
T a[144:145],v19,49152
T a[146:147],v19,51200
M v[176:179],v[36:39],a[184:187],v[176:179]
buffer_load_dwordx4 v8, s[52:55], s25 offen lds
M v[176:179],v[40:43],a[192:195],v[176:179]
s_waitcnt lgkmcnt(2)
s_nop 0
T a[148:149],v19,53248
T a[150:151],v19,55296
M v[176:179],v[44:47],a[200:203],v[176:179]
s_mov_b32 s25, 2883840
T a[152:153],v19,57344
T a[154:155],v19,59392
M v[176:179],v[48:51],a[208:211],v[176:179]
SA m0,s4,135168
v_and_b32 v25, 15, v0
v_sub_u32 v24, v24, v25
M v[176:179],v[52:55],a[216:219],v[176:179]
T a[156:157],v19,61440
T a[158:159],v19,63488
M v[176:179],v[56:59],a[224:227],v[176:179]
T a[160:161],v23,32768
T a[162:163],v23,34816
M v[180:183],v[56:59],a[228:231],0
buffer_load_dwordx4 v8, s[52:55], s25 offen lds
M v[180:183],v[52:55],a[220:223],v[180:183]
s_nop 0
T a[164:165],v23,36864
T a[166:167],v23,38912
M v[180:183],v[48:51],a[212:215],v[180:183]
s_mov_b32 s25, 3145984
T a[168:169],v23,40960
T a[170:171],v23,43008
M v[180:183],v[44:47],a[204:207],v[180:183]
SA m0,s4,139264
v_cmp_lt_i32 s[16:17], 0, v24
v_cmp_lt_i32 s[18:19], -1, v24
M v[180:183],v[40:43],a[196:199],v[180:183]
buffer_load_dwordx4 v8, s[52:55], s25 offen lds
M v[180:183],v[36:39],a[188:191],v[180:183]
v_cmp_lt_i32 s[48:49], -2, v24
v_cmp_lt_i32 s[50:51], -3, v24
M v[180:183],v[32:35],a[180:183],v[180:183]
s_waitcnt lgkmcnt(6)
v_lshl_add_u32 v25, v0, 7, s95
v_and_b32 v0, 48, v0
M v[184:187],a[144:147],a[176:179],0
s_mov_b32 s25, 3408128
T v[32:33],v20,45056
T v[34:35],v20,47104
M v[184:187],a[148:151],a[184:187],v[184:187]
SA m0,s4,143360
MF v122,s5,v122
MF v123,s5,v123
M v[184:187],a[152:155],a[192:195],v[184:187]
s_waitcnt lgkmcnt(2)
T v[36:37],v20,49152
T v[38:39],v20,51200
M v[184:187],a[156:159],a[200:203],v[184:187]
SA s30,s32,8192
T v[40:41],v20,53248
T v[42:43],v20,55296
M v[184:187],a[160:163],a[208:211],v[184:187]
buffer_store_dwordx4 a[32:35], v6, s[8:11], s30 offen offset:0 sc1
M v[184:187],a[164:167],a[216:219],v[184:187]
s_nop 0
T v[44:45],v20,57344
T v[46:47],v20,59392
M v[184:187],a[168:171],a[224:227],v[184:187]
T v[48:49],v20,61440
T v[50:51],v20,63488
M v[188:191],a[168:171],a[228:231],0
buffer_load_dwordx4 v8, s[52:55], s25 offen lds
M v[188:191],a[164:167],a[220:223],v[188:191]
SA s3,s93,532480
T v[52:53],v16,32768
T v[54:55],v16,34816
M v[188:191],a[160:163],a[212:215],v[188:191]
s_mov_b32 s25, 384
T v[56:57],v16,36864
T v[58:59],v16,38912
M v[188:191],a[156:159],a[204:207],v[188:191]
SA m0,s4,0
buffer_store_dwordx4 v[80:83], v7, s[8:11], s3 offen offset:0 sc1
M v[188:191],a[152:155],a[196:199],v[188:191]
C v112,v112,v113
C v113,v114,v115
M v[188:191],a[148:151],a[188:191],v[188:191]
buffer_load_dwordx4 v8, s[52:55], s25 offen lds
M v[188:191],a[144:147],a[180:183],v[188:191]
s_waitcnt lgkmcnt(6)
C v114,v120,v121
C v115,v122,v123
M v[160:163],v[32:35],a[232:235],v[160:163]
s_mov_b32 s25, 262528
T a[144:145],v21,45056
T a[146:147],v21,47104
M v[160:163],v[36:39],a[96:99],v[160:163]
SA m0,s4,4096
buffer_store_dwordx4 v[84:87], v7, s[8:11], s3 offen offset:2048 sc1
M v[160:163],v[40:43],a[104:107],v[160:163]
s_waitcnt lgkmcnt(2)
s_nop 0
T a[148:149],v21,49152
T a[150:151],v21,51200
M v[160:163],v[44:47],a[112:115],v[160:163]
T a[152:153],v21,53248
T a[154:155],v21,55296
M v[160:163],v[48:51],a[120:123],v[160:163]
buffer_load_dwordx4 v8, s[52:55], s25 offen lds
M v[160:163],v[52:55],a[128:131],v[160:163]
s_nop 0
T a[156:157],v21,57344
T a[158:159],v21,59392
M v[160:163],v[56:59],a[136:139],v[160:163]
s_mov_b32 s25, 524672
T a[160:161],v21,61440
T a[162:163],v21,63488
M v[164:167],v[56:59],a[140:143],v[164:167]
SA m0,s4,8192
W a4,v112
W a5,v113
M v[164:167],v[52:55],a[132:135],v[164:167]
T a[164:165],v17,32768
T a[166:167],v17,34816
M v[164:167],v[48:51],a[124:127],v[164:167]
T a[168:169],v17,36864
T a[170:171],v17,38912
M v[164:167],v[44:47],a[116:119],v[164:167]
buffer_load_dwordx4 v8, s[52:55], s25 offen lds
M v[164:167],v[40:43],a[108:111],v[164:167]
W a6,v114
W a7,v115
M v[164:167],v[36:39],a[100:103],v[164:167]
s_mov_b32 s25, 786816
v_lshl_add_u32 v0, v0, 24, v25
v_mov_b32 v24, 0x3f80
M v[164:167],v[32:35],a[236:239],v[164:167]
s_waitcnt lgkmcnt(6)
MF v116,s5,v116
MF v117,s5,v117
M v[168:171],a[144:147],a[232:235],v[168:171]
SA s30,s32,0
T v[32:33],v22,45056
T v[34:35],v22,47104
M v[168:171],a[148:151],a[96:99],v[168:171]
SA m0,s4,12288
buffer_store_dwordx4 a[4:7], v6, s[8:11], s30 offen offset:1024 sc1
M v[168:171],a[152:155],a[104:107],v[168:171]
s_waitcnt lgkmcnt(2)
s_nop 0
T v[36:37],v22,49152
T v[38:39],v22,51200
M v[168:171],a[156:159],a[112:115],v[168:171]
T v[40:41],v22,53248
T v[42:43],v22,55296
M v[168:171],a[160:163],a[120:123],v[168:171]
buffer_load_dwordx4 v8, s[52:55], s25 offen lds
M v[168:171],a[164:167],a[128:131],v[168:171]
s_nop 0
T v[44:45],v22,57344
T v[46:47],v22,59392
M v[168:171],a[168:171],a[136:139],v[168:171]
s_mov_b32 s25, 1048960
T v[48:49],v22,61440
T v[50:51],v22,63488
M v[172:175],a[168:171],a[140:143],v[172:175]
SA m0,s4,16384
MF v118,s5,v118
MF v119,s5,v119
M v[172:175],a[164:167],a[132:135],v[172:175]
T v[52:53],v18,32768
T v[54:55],v18,34816
M v[172:175],a[160:163],a[124:127],v[172:175]
T v[56:57],v18,36864
T v[58:59],v18,38912
M v[172:175],a[156:159],a[116:119],v[172:175]
buffer_load_dwordx4 v8, s[52:55], s25 offen lds
M v[172:175],a[152:155],a[108:111],v[172:175]
MF v124,s5,v124
MF v125,s5,v125
M v[172:175],a[148:151],a[100:103],v[172:175]
s_mov_b32 s25, 1311104
v_lshrrev_b32 v25, 8, v7
v_bfe_u32 v26, v7, 6, 2
v_and_b32 v27, 16, v7
v_lshlrev_b32 v27, v27, v24
v_cmp_eq_u32 vcc, v25, v26
v_and_b32 v28, 32, v7
W a244,0
v_cndmask_b32 v27, 0, v27, vcc
v_cmp_eq_u32 vcc, 0, v28
W a245,0
W a248,0
v_cndmask_b32 v25, 0, v27, vcc
v_sub_u32 v26, v27, v25
W a249,0
W a246,v25
W a247,v26
M v[172:175],a[144:147],a[236:239],v[172:175]
s_waitcnt lgkmcnt(6)
MF v126,s5,v126
MF v127,s5,v127
M v[176:179],v[32:35],a[232:235],v[176:179]
SA m0,s4,20480
T a[144:145],v23,45056
T a[146:147],v23,47104
M v[176:179],v[36:39],a[96:99],v[176:179]
buffer_load_dwordx4 v8, s[52:55], s25 offen lds
M v[176:179],v[40:43],a[104:107],v[176:179]
s_waitcnt lgkmcnt(2)
s_nop 0
T a[148:149],v23,49152
T a[150:151],v23,51200
M v[176:179],v[44:47],a[112:115],v[176:179]
s_mov_b32 s25, 1573248
T a[152:153],v23,53248
T a[154:155],v23,55296
M v[176:179],v[48:51],a[120:123],v[176:179]
SA m0,s4,24576
C v116,v116,v117
C v117,v118,v119
M v[176:179],v[52:55],a[128:131],v[176:179]
T a[156:157],v23,57344
T a[158:159],v23,59392
M v[176:179],v[56:59],a[136:139],v[176:179]
T a[160:161],v23,61440
T a[162:163],v23,63488
M v[180:183],v[56:59],a[140:143],v[180:183]
buffer_load_dwordx4 v8, s[52:55], s25 offen lds
M v[180:183],v[52:55],a[132:135],v[180:183]
s_nop 0
T a[164:165],v19,32768
T a[166:167],v19,34816
M v[180:183],v[48:51],a[124:127],v[180:183]
s_mov_b32 s25, 1835392
T a[168:169],v19,36864
T a[170:171],v19,38912
M v[180:183],v[44:47],a[116:119],v[180:183]
SA m0,s4,28672
C v118,v124,v125
C v119,v126,v127
M v[180:183],v[40:43],a[108:111],v[180:183]
buffer_load_dwordx4 v8, s[52:55], s25 offen lds
M v[180:183],v[36:39],a[100:103],v[180:183]
s_waitcnt vmcnt(11) lgkmcnt(0)
W a36,v116
W a37,v117
M v[180:183],v[32:35],a[236:239],v[180:183]
s_barrier
M v[184:187],a[144:147],a[232:235],v[184:187]
s_mov_b32 s25, 2097536
T v[32:33],v20,0
T v[34:35],v20,2048
M v[184:187],a[148:151],a[96:99],v[184:187]
SA m0,s4,40960
W a38,v118
W a39,v119
M v[184:187],a[152:155],a[104:107],v[184:187]
SA s30,s32,8192
T v[36:37],v20,4096
T v[38:39],v20,6144
M v[184:187],a[156:159],a[112:115],v[184:187]
T v[40:41],v20,8192
T v[42:43],v20,10240
M v[184:187],a[160:163],a[120:123],v[184:187]
buffer_store_dwordx4 a[36:39], v6, s[8:11], s30 offen offset:1024 sc1
M v[184:187],a[164:167],a[128:131],v[184:187]
s_nop 0
T v[44:45],v20,12288
T v[46:47],v20,14336
M v[184:187],a[168:171],a[136:139],v[184:187]
T v[48:49],v20,16384
T v[50:51],v20,18432
M v[188:191],a[168:171],a[140:143],v[188:191]
buffer_load_dwordx4 v8, s[52:55], s25 offen lds
M v[188:191],a[164:167],a[132:135],v[188:191]
s_nop 0
T v[52:53],v20,20480
T v[54:55],v20,22528
M v[188:191],a[160:163],a[124:127],v[188:191]
s_mov_b32 s25, 2359680
T v[56:57],v20,24576
T v[58:59],v20,26624
M v[188:191],a[156:159],a[116:119],v[188:191]
SA m0,s4,45056
MF v160,s5,v160
MF v161,s5,v161
M v[188:191],a[152:155],a[108:111],v[188:191]
buffer_load_dwordx4 v8, s[52:55], s25 offen lds
M v[188:191],a[148:151],a[100:103],v[188:191]
MF v162,s5,v162
MF v163,s5,v163
M v[188:191],a[144:147],a[236:239],v[188:191]
s_waitcnt lgkmcnt(6)
MF v168,s5,v168
MF v169,s5,v169
L_w_kv19:
s_cbranch_execz L_wd2
M v[96:99],v[32:35],a[176:179],0
s_mov_b32 s25, 2621824
T a[144:145],v21,0
T a[146:147],v21,2048
M v[96:99],v[36:39],a[184:187],v[96:99]
SA m0,s4,49152
MF v170,s5,v170
MF v171,s5,v171
M v[96:99],v[40:43],a[192:195],v[96:99]
s_waitcnt lgkmcnt(2)
T a[148:149],v21,4096
T a[150:151],v21,6144
M v[96:99],v[44:47],a[200:203],v[96:99]
T a[152:153],v21,8192
T a[154:155],v21,10240
M v[96:99],v[48:51],a[208:211],v[96:99]
buffer_load_dwordx4 v8, s[52:55], s25 offen lds
M v[96:99],v[52:55],a[216:219],v[96:99]
s_nop 0
T a[156:157],v21,12288
T a[158:159],v21,14336
M v[96:99],v[56:59],a[224:227],v[96:99]
s_mov_b32 s25, 2883968
T a[160:161],v21,16384
T a[162:163],v21,18432
M v[100:103],v[56:59],a[228:231],0
SA m0,s4,53248
C v160,v160,v161
C v161,v162,v163
M v[100:103],v[52:55],a[220:223],v[100:103]
T a[164:165],v21,20480
T a[166:167],v21,22528
M v[100:103],v[48:51],a[212:215],v[100:103]
T a[168:169],v21,24576
T a[170:171],v21,26624
M v[100:103],v[44:47],a[204:207],v[100:103]
SA s3,s93,536576
buffer_load_dwordx4 v8, s[52:55], s25 offen lds
M v[100:103],v[40:43],a[196:199],v[100:103]
C v162,v168,v169
C v163,v170,v171
M v[100:103],v[36:39],a[188:191],v[100:103]
s_mov_b32 s25, 3146112
W a8,v160
W a9,v161
M v[100:103],v[32:35],a[180:183],v[100:103]
s_waitcnt lgkmcnt(6)
W a10,v162
W a11,v163
M v[104:107],a[144:147],a[176:179],0
SA s30,s32,0
T v[32:33],v22,0
T v[34:35],v22,2048
M v[104:107],a[148:151],a[184:187],v[104:107]
SA m0,s4,57344
buffer_store_dwordx4 a[8:11], v6, s[8:11], s30 offen offset:2048 sc1
M v[104:107],a[152:155],a[192:195],v[104:107]
s_waitcnt lgkmcnt(2)
s_nop 0
T v[36:37],v22,4096
T v[38:39],v22,6144
M v[104:107],a[156:159],a[200:203],v[104:107]
T v[40:41],v22,8192
T v[42:43],v22,10240
M v[104:107],a[160:163],a[208:211],v[104:107]
buffer_load_dwordx4 v8, s[52:55], s25 offen lds
M v[104:107],a[164:167],a[216:219],v[104:107]
s_nop 0
T v[44:45],v22,12288
T v[46:47],v22,14336
M v[104:107],a[168:171],a[224:227],v[104:107]
s_mov_b32 s25, 3408256
T v[48:49],v22,16384
T v[50:51],v22,18432
M v[108:111],a[168:171],a[228:231],0
SA m0,s4,61440
buffer_store_dwordx4 v[88:91], v7, s[8:11], s3 offen offset:0 sc1
M v[108:111],a[164:167],a[220:223],v[108:111]
s_nop 0
T v[52:53],v22,20480
T v[54:55],v22,22528
M v[108:111],a[160:163],a[212:215],v[108:111]
T v[56:57],v22,24576
T v[58:59],v22,26624
M v[108:111],a[156:159],a[204:207],v[108:111]
buffer_load_dwordx4 v8, s[52:55], s25 offen lds
M v[108:111],a[152:155],a[196:199],v[108:111]
v_lshrrev_b32 v31, 6, v7
v_bfe_u32 v28, v7, 4, 2
M v[108:111],a[148:151],a[188:191],v[108:111]
buffer_store_dwordx4 v[92:95], v7, s[8:11], s3 offen offset:2048 sc1
M v[108:111],a[144:147],a[180:183],v[108:111]
s_waitcnt lgkmcnt(6)
v_lshlrev_b32 v31, 5, v31
v_add_lshl_u32 v31, v31, v28, 2
M v[112:115],v[32:35],a[176:179],0
T a[144:145],v23,0
T a[146:147],v23,2048
M v[112:115],v[36:39],a[184:187],v[112:115]
buffer_load_dword v5, v31, s[8:11], s46 offen offset:4 sc1
M v[112:115],v[40:43],a[192:195],v[112:115]
s_waitcnt lgkmcnt(2)
s_nop 0
T a[148:149],v23,4096
T a[150:151],v23,6144
M v[112:115],v[44:47],a[200:203],v[112:115]
T a[152:153],v23,8192
T a[154:155],v23,10240
M v[112:115],v[48:51],a[208:211],v[112:115]
MF v164,s5,v164
MF v165,s5,v165
M v[112:115],v[52:55],a[216:219],v[112:115]
T a[156:157],v23,12288
T a[158:159],v23,14336
M v[112:115],v[56:59],a[224:227],v[112:115]
T a[160:161],v23,16384
T a[162:163],v23,18432
M v[116:119],v[56:59],a[228:231],0
MF v166,s5,v166
MF v167,s5,v167
M v[116:119],v[52:55],a[220:223],v[116:119]
T a[164:165],v23,20480
T a[166:167],v23,22528
M v[116:119],v[48:51],a[212:215],v[116:119]
T a[168:169],v23,24576
T a[170:171],v23,26624
M v[116:119],v[44:47],a[204:207],v[116:119]
MF v172,s5,v172
MF v173,s5,v173
M v[116:119],v[40:43],a[196:199],v[116:119]
MF v174,s5,v174
MF v175,s5,v175
M v[116:119],v[36:39],a[188:191],v[116:119]
C v164,v164,v165
C v165,v166,v167
M v[116:119],v[32:35],a[180:183],v[116:119]
s_waitcnt lgkmcnt(6)
C v166,v172,v173
C v167,v174,v175
M v[120:123],a[144:147],a[176:179],0
T v[32:33],v20,28672
T v[34:35],v20,30720
M v[120:123],a[148:151],a[184:187],v[120:123]
W a40,v164
W a41,v165
M v[120:123],a[152:155],a[192:195],v[120:123]
s_waitcnt lgkmcnt(2)
T v[36:37],v12,24576
T v[38:39],v12,26624
M v[120:123],a[156:159],a[200:203],v[120:123]
T v[40:41],v12,28672
T v[42:43],v12,30720
M v[120:123],a[160:163],a[208:211],v[120:123]
W a42,v166
W a43,v167
M v[120:123],a[164:167],a[216:219],v[120:123]
SA s30,s32,8192
T v[44:45],v12,0
T v[46:47],v12,2048
M v[120:123],a[168:171],a[224:227],v[120:123]
T v[48:49],v12,4096
T v[50:51],v12,6144
M v[124:127],a[168:171],a[228:231],0
buffer_store_dwordx4 a[40:43], v6, s[8:11], s30 offen offset:2048 sc1
M v[124:127],a[164:167],a[220:223],v[124:127]
s_nop 0
T v[52:53],v12,8192
T v[54:55],v12,10240
M v[124:127],a[160:163],a[212:215],v[124:127]
T v[56:57],v12,12288
T v[58:59],v12,14336
M v[124:127],a[156:159],a[204:207],v[124:127]
v_mov_b32 v8, 0xff800000
MF v176,s5,v176
M v[124:127],a[152:155],a[196:199],v[124:127]
MF v177,s5,v177
MF v178,s5,v178
M v[124:127],a[148:151],a[188:191],v[124:127]
MF v179,s5,v179
MF v184,s5,v184
M v[124:127],a[144:147],a[180:183],v[124:127]
s_waitcnt lgkmcnt(6)
MF v185,s5,v185
MF v186,s5,v186
M v[96:99],v[32:35],a[232:235],v[96:99]
T a[144:145],v21,28672
T a[146:147],v21,30720
M v[96:99],v[36:39],a[96:99],v[96:99]
MF v187,s5,v187
C v176,v176,v177
M v[96:99],v[40:43],a[104:107],v[96:99]
s_waitcnt lgkmcnt(2)
T a[148:149],v13,24576
T a[150:151],v13,26624
M v[96:99],v[44:47],a[112:115],v[96:99]
T a[152:153],v13,28672
T a[154:155],v13,30720
M v[96:99],v[48:51],a[120:123],v[96:99]
C v177,v178,v179
C v178,v184,v185
M v[96:99],v[52:55],a[128:131],v[96:99]
T a[156:157],v13,0
T a[158:159],v13,2048
M v[96:99],v[56:59],a[136:139],v[96:99]
T a[160:161],v13,4096
T a[162:163],v13,6144
M v[100:103],v[56:59],a[140:143],v[100:103]
C v179,v186,v187
W a12,v176
M v[100:103],v[52:55],a[132:135],v[100:103]
T a[164:165],v13,8192
T a[166:167],v13,10240
M v[100:103],v[48:51],a[124:127],v[100:103]
T a[168:169],v13,12288
T a[170:171],v13,14336
M v[100:103],v[44:47],a[116:119],v[100:103]
W a13,v177
W a14,v178
M v[100:103],v[40:43],a[108:111],v[100:103]
W a15,v179
MF v180,s5,v180
M v[100:103],v[36:39],a[100:103],v[100:103]
MF v181,s5,v181
MF v182,s5,v182
M v[100:103],v[32:35],a[236:239],v[100:103]
s_waitcnt lgkmcnt(6)
MF v183,s5,v183
MF v188,s5,v188
M v[104:107],a[144:147],a[232:235],v[104:107]
T v[32:33],v22,28672
T v[34:35],v22,30720
M v[104:107],a[148:151],a[96:99],v[104:107]
MF v189,s5,v189
MF v190,s5,v190
M v[104:107],a[152:155],a[104:107],v[104:107]
s_waitcnt lgkmcnt(2)
T v[36:37],v14,24576
T v[38:39],v14,26624
M v[104:107],a[156:159],a[112:115],v[104:107]
SA s30,s32,0
T v[40:41],v14,28672
T v[42:43],v14,30720
M v[104:107],a[160:163],a[120:123],v[104:107]
buffer_store_dwordx4 a[12:15], v6, s[8:11], s30 offen offset:3072 sc1
M v[104:107],a[164:167],a[128:131],v[104:107]
s_nop 0
T v[44:45],v14,0
T v[46:47],v14,2048
M v[104:107],a[168:171],a[136:139],v[104:107]
T v[48:49],v14,4096
T v[50:51],v14,6144
M v[108:111],a[168:171],a[140:143],v[108:111]
MF v191,s5,v191
C v180,v180,v181
M v[108:111],a[164:167],a[132:135],v[108:111]
T v[52:53],v14,8192
T v[54:55],v14,10240
M v[108:111],a[160:163],a[124:127],v[108:111]
T v[56:57],v14,12288
T v[58:59],v14,14336
M v[108:111],a[156:159],a[116:119],v[108:111]
C v181,v182,v183
C v182,v188,v189
M v[108:111],a[152:155],a[108:111],v[108:111]
C v183,v190,v191
W a44,v180
M v[108:111],a[148:151],a[100:103],v[108:111]
W a45,v181
W a46,v182
M v[108:111],a[144:147],a[236:239],v[108:111]
s_waitcnt lgkmcnt(6)
W a47,v183
s_waitcnt vmcnt(2)
v_cmp_ne_u32 vcc, 1, v5
M v[112:115],v[32:35],a[232:235],v[112:115]
s_nop 0
T a[144:145],v23,28672
T a[146:147],v23,30720
M v[112:115],v[36:39],a[96:99],v[112:115]
s_cmp_lg_u32 vcc_lo, 0
MF v96,s5,v96
MF v97,s5,v97
M v[112:115],v[40:43],a[104:107],v[112:115]
s_waitcnt lgkmcnt(2)
T a[148:149],v15,24576
T a[150:151],v15,26624
M v[112:115],v[44:47],a[112:115],v[112:115]
s_cbranch_scc1 L_wsq1
L_wrq1:
T a[152:153],v15,28672
T a[154:155],v15,30720
M v[112:115],v[48:51],a[120:123],v[112:115]
SA m0,s28,98304
MF v98,s5,v98
MF v99,s5,v99
M v[112:115],v[52:55],a[128:131],v[112:115]
T a[156:157],v15,0
T a[158:159],v15,2048
M v[112:115],v[56:59],a[136:139],v[112:115]
T a[160:161],v15,4096
T a[162:163],v15,6144
M v[116:119],v[56:59],a[140:143],v[116:119]
buffer_load_dwordx4 v3, s[8:11], s21 offen offset:0 sc1 lds
M v[116:119],v[52:55],a[132:135],v[116:119]
s_nop 0
T a[164:165],v15,8192
T a[166:167],v15,10240
M v[116:119],v[48:51],a[124:127],v[116:119]
T a[168:169],v15,12288
T a[170:171],v15,14336
M v[116:119],v[44:47],a[116:119],v[116:119]
buffer_load_dwordx4 v3, s[8:11], s21 offen offset:1024 sc1 lds
M v[116:119],v[40:43],a[108:111],v[116:119]
MF v104,s5,v104
MF v105,s5,v105
M v[116:119],v[36:39],a[100:103],v[116:119]
s_waitcnt lgkmcnt(0)
buffer_load_dwordx4 v3, s[8:11], s21 offen offset:2048 sc1 lds
M v[116:119],v[32:35],a[236:239],v[116:119]
s_barrier
M v[120:123],a[144:147],a[232:235],v[120:123]
SA s30,s32,8192
T v[32:33],v16,0
T v[34:35],v16,2048
M v[120:123],a[148:151],a[96:99],v[120:123]
buffer_store_dwordx4 a[44:47], v6, s[8:11], s30 offen offset:3072 sc1
M v[120:123],a[152:155],a[104:107],v[120:123]
s_nop 0
T v[36:37],v16,4096
T v[38:39],v16,6144
M v[120:123],a[156:159],a[112:115],v[120:123]
T v[40:41],v16,8192
T v[42:43],v16,10240
M v[120:123],a[160:163],a[120:123],v[120:123]
buffer_load_dwordx4 v3, s[8:11], s21 offen offset:3072 sc1 lds
M v[120:123],a[164:167],a[128:131],v[120:123]
SA m0,s28,102400
T v[44:45],v16,12288
T v[46:47],v16,14336
M v[120:123],a[168:171],a[136:139],v[120:123]
T v[48:49],v16,16384
T v[50:51],v16,18432
M v[124:127],a[168:171],a[140:143],v[124:127]
buffer_load_dwordx4 v4, s[8:11], s21 offen offset:0 sc1 lds
M v[124:127],a[164:167],a[132:135],v[124:127]
s_nop 0
T v[52:53],v16,20480
T v[54:55],v16,22528
M v[124:127],a[160:163],a[124:127],v[124:127]
T v[56:57],v16,24576
T v[58:59],v16,26624
M v[124:127],a[156:159],a[116:119],v[124:127]
buffer_load_dwordx4 v4, s[8:11], s21 offen offset:1024 sc1 lds
M v[124:127],a[152:155],a[108:111],v[124:127]
MF v106,s5,v106
MF v107,s5,v107
M v[124:127],a[148:151],a[100:103],v[124:127]
buffer_load_dwordx4 v4, s[8:11], s21 offen offset:2048 sc1 lds
M v[124:127],a[144:147],a[236:239],v[124:127]
s_waitcnt lgkmcnt(6)
C v96,v96,v97
C v97,v98,v99
M v[160:163],v[32:35],a[176:179],0
T a[144:145],v17,0
T a[146:147],v17,2048
M v[160:163],v[36:39],a[184:187],v[160:163]
buffer_load_dwordx4 v4, s[8:11], s21 offen offset:3072 sc1 lds
M v[160:163],v[40:43],a[192:195],v[160:163]
s_waitcnt lgkmcnt(2)
s_nop 0
T a[148:149],v17,4096
T a[150:151],v17,6144
M v[160:163],v[44:47],a[200:203],v[160:163]
SA s21,s21,32768
T a[152:153],v17,8192
T a[154:155],v17,10240
M v[160:163],v[48:51],a[208:211],v[160:163]
s_sub_u32 s22, s22, 1
C v98,v104,v105
C v99,v106,v107
M v[160:163],v[52:55],a[216:219],v[160:163]
s_cselect_b32 s21, s23, s21
T a[156:157],v17,12288
T a[158:159],v17,14336
M v[160:163],v[56:59],a[224:227],v[160:163]
SA m0,s28,65536
T a[160:161],v17,16384
T a[162:163],v17,18432
M v[164:167],v[56:59],a[228:231],0
buffer_load_dwordx4 v3, s[8:11], s21 offen offset:0 sc1 lds
M v[164:167],v[52:55],a[220:223],v[164:167]
s_nop 0
T a[164:165],v17,20480
T a[166:167],v17,22528
M v[164:167],v[48:51],a[212:215],v[164:167]
T a[168:169],v17,24576
T a[170:171],v17,26624
M v[164:167],v[44:47],a[204:207],v[164:167]
buffer_load_dwordx4 v3, s[8:11], s21 offen offset:1024 sc1 lds
M v[164:167],v[40:43],a[196:199],v[164:167]
buffer_load_dword v5, v31, s[8:11], s46 offen offset:4 sc1
M v[164:167],v[36:39],a[188:191],v[164:167]
buffer_load_dwordx4 v3, s[8:11], s21 offen offset:2048 sc1 lds
M v[164:167],v[32:35],a[180:183],v[164:167]
s_waitcnt lgkmcnt(6)
W a16,v96
W a17,v97
M v[168:171],a[144:147],a[176:179],0
T v[32:33],v18,0
T v[34:35],v18,2048
M v[168:171],a[148:151],a[184:187],v[168:171]
buffer_load_dwordx4 v3, s[8:11], s21 offen offset:3072 sc1 lds
M v[168:171],a[152:155],a[192:195],v[168:171]
s_waitcnt lgkmcnt(2)
s_nop 0
T v[36:37],v18,4096
T v[38:39],v18,6144
M v[168:171],a[156:159],a[200:203],v[168:171]
SA m0,s28,69632
T v[40:41],v18,8192
T v[42:43],v18,10240
M v[168:171],a[160:163],a[208:211],v[168:171]
buffer_load_dwordx4 v4, s[8:11], s21 offen offset:0 sc1 lds
M v[168:171],a[164:167],a[216:219],v[168:171]
s_nop 0
T v[44:45],v18,12288
T v[46:47],v18,14336
M v[168:171],a[168:171],a[224:227],v[168:171]
T v[48:49],v18,16384
T v[50:51],v18,18432
M v[172:175],a[168:171],a[228:231],0
buffer_load_dwordx4 v4, s[8:11], s21 offen offset:1024 sc1 lds
M v[172:175],a[164:167],a[220:223],v[172:175]
s_nop 0
T v[52:53],v18,20480
T v[54:55],v18,22528
M v[172:175],a[160:163],a[212:215],v[172:175]
T v[56:57],v18,24576
T v[58:59],v18,26624
M v[172:175],a[156:159],a[204:207],v[172:175]
buffer_load_dwordx4 v4, s[8:11], s21 offen offset:2048 sc1 lds
M v[172:175],a[152:155],a[196:199],v[172:175]
W a18,v98
W a19,v99
M v[172:175],a[148:151],a[188:191],v[172:175]
SA s30,s32,4096
buffer_store_dwordx4 a[16:19], v6, s[8:11], s30 offen offset:0 sc1
M v[172:175],a[144:147],a[180:183],v[172:175]
s_waitcnt lgkmcnt(6)
MF v100,s5,v100
MF v101,s5,v101
M v[176:179],v[32:35],a[176:179],0
T a[144:145],v19,0
T a[146:147],v19,2048
M v[176:179],v[36:39],a[184:187],v[176:179]
buffer_load_dwordx4 v4, s[8:11], s21 offen offset:3072 sc1 lds
M v[176:179],v[40:43],a[192:195],v[176:179]
s_waitcnt lgkmcnt(2)
s_nop 0
T a[148:149],v19,4096
T a[150:151],v19,6144
M v[176:179],v[44:47],a[200:203],v[176:179]
SA s21,s21,32768
T a[152:153],v19,8192
T a[154:155],v19,10240
M v[176:179],v[48:51],a[208:211],v[176:179]
s_sub_u32 s22, s22, 1
MF v102,s5,v102
MF v103,s5,v103
M v[176:179],v[52:55],a[216:219],v[176:179]
s_cselect_b32 s21, s23, s21
T a[156:157],v19,12288
T a[158:159],v19,14336
M v[176:179],v[56:59],a[224:227],v[176:179]
T a[160:161],v19,16384
T a[162:163],v19,18432
M v[180:183],v[56:59],a[228:231],0
MF v108,s5,v108
MF v109,s5,v109
M v[180:183],v[52:55],a[220:223],v[180:183]
T a[164:165],v19,20480
T a[166:167],v19,22528
M v[180:183],v[48:51],a[212:215],v[180:183]
T a[168:169],v19,24576
T a[170:171],v19,26624
M v[180:183],v[44:47],a[204:207],v[180:183]
MF v110,s5,v110
MF v111,s5,v111
M v[180:183],v[40:43],a[196:199],v[180:183]
C v100,v100,v101
C v101,v102,v103
M v[180:183],v[36:39],a[188:191],v[180:183]
C v102,v108,v109
C v103,v110,v111
M v[180:183],v[32:35],a[180:183],v[180:183]
s_waitcnt lgkmcnt(6)
W a48,v100
W a49,v101
M v[184:187],a[144:147],a[176:179],0
T v[32:33],v16,28672
T v[34:35],v16,30720
M v[184:187],a[148:151],a[184:187],v[184:187]
W a50,v102
W a51,v103
M v[184:187],a[152:155],a[192:195],v[184:187]
s_waitcnt lgkmcnt(2)
T v[36:37],v16,40960
T v[38:39],v16,43008
M v[184:187],a[156:159],a[200:203],v[184:187]
T v[40:41],v16,45056
T v[42:43],v16,47104
M v[184:187],a[160:163],a[208:211],v[184:187]
MF v112,s5,v112
MF v113,s5,v113
M v[184:187],a[164:167],a[216:219],v[184:187]
T v[44:45],v16,49152
T v[46:47],v16,51200
M v[184:187],a[168:171],a[224:227],v[184:187]
T v[48:49],v16,53248
T v[50:51],v16,55296
M v[188:191],a[168:171],a[228:231],0
MF v114,s5,v114
MF v115,s5,v115
M v[188:191],a[164:167],a[220:223],v[188:191]
SA s30,s32,12288
T v[52:53],v16,57344
T v[54:55],v16,59392
M v[188:191],a[160:163],a[212:215],v[188:191]
T v[56:57],v16,61440
T v[58:59],v16,63488
M v[188:191],a[156:159],a[204:207],v[188:191]
buffer_store_dwordx4 a[48:51], v6, s[8:11], s30 offen offset:0 sc1
M v[188:191],a[152:155],a[196:199],v[188:191]
MF v120,s5,v120
MF v121,s5,v121
M v[188:191],a[148:151],a[188:191],v[188:191]
MF v122,s5,v122
MF v123,s5,v123
M v[188:191],a[144:147],a[180:183],v[188:191]
s_waitcnt lgkmcnt(6)
C v112,v112,v113
C v113,v114,v115
M v[160:163],v[32:35],a[232:235],v[160:163]
T a[144:145],v17,28672
T a[146:147],v17,30720
M v[160:163],v[36:39],a[96:99],v[160:163]
C v114,v120,v121
C v115,v122,v123
M v[160:163],v[40:43],a[104:107],v[160:163]
s_waitcnt lgkmcnt(2)
T a[148:149],v17,40960
T a[150:151],v17,43008
M v[160:163],v[44:47],a[112:115],v[160:163]
T a[152:153],v17,45056
T a[154:155],v17,47104
M v[160:163],v[48:51],a[120:123],v[160:163]
W a20,v112
W a21,v113
M v[160:163],v[52:55],a[128:131],v[160:163]
T a[156:157],v17,49152
T a[158:159],v17,51200
M v[160:163],v[56:59],a[136:139],v[160:163]
T a[160:161],v17,53248
T a[162:163],v17,55296
M v[164:167],v[56:59],a[140:143],v[164:167]
L_w_kv110:
s_cbranch_execz L_wd2
W a22,v114
W a23,v115
M v[164:167],v[52:55],a[132:135],v[164:167]
T a[164:165],v17,57344
T a[166:167],v17,59392
M v[164:167],v[48:51],a[124:127],v[164:167]
T a[168:169],v17,61440
T a[170:171],v17,63488
M v[164:167],v[44:47],a[116:119],v[164:167]
MF v116,s5,v116
MF v117,s5,v117
M v[164:167],v[40:43],a[108:111],v[164:167]
MF v118,s5,v118
MF v119,s5,v119
M v[164:167],v[36:39],a[100:103],v[164:167]
MF v124,s5,v124
MF v125,s5,v125
M v[164:167],v[32:35],a[236:239],v[164:167]
s_waitcnt lgkmcnt(6)
MF v126,s5,v126
MF v127,s5,v127
M v[168:171],a[144:147],a[232:235],v[168:171]
T v[32:33],v18,28672
T v[34:35],v18,30720
M v[168:171],a[148:151],a[96:99],v[168:171]
C v116,v116,v117
C v117,v118,v119
M v[168:171],a[152:155],a[104:107],v[168:171]
s_waitcnt lgkmcnt(2)
T v[36:37],v18,40960
T v[38:39],v18,43008
M v[168:171],a[156:159],a[112:115],v[168:171]
T v[40:41],v18,45056
T v[42:43],v18,47104
M v[168:171],a[160:163],a[120:123],v[168:171]
C v118,v124,v125
C v119,v126,v127
M v[168:171],a[164:167],a[128:131],v[168:171]
T v[44:45],v18,49152
T v[46:47],v18,51200
M v[168:171],a[168:171],a[136:139],v[168:171]
SA s30,s32,4096
T v[48:49],v18,53248
T v[50:51],v18,55296
M v[172:175],a[168:171],a[140:143],v[172:175]
buffer_store_dwordx4 a[20:23], v6, s[8:11], s30 offen offset:1024 sc1
M v[172:175],a[164:167],a[132:135],v[172:175]
s_nop 0
T v[52:53],v18,57344
T v[54:55],v18,59392
M v[172:175],a[160:163],a[124:127],v[172:175]
T v[56:57],v18,61440
T v[58:59],v18,63488
M v[172:175],a[156:159],a[116:119],v[172:175]
W a52,v116
W a53,v117
M v[172:175],a[152:155],a[108:111],v[172:175]
W a54,v118
W a55,v119
M v[172:175],a[148:151],a[100:103],v[172:175]
s_waitcnt vmcnt(9)
v_cmp_ne_u32 vcc, 1, v5
MF v160,s5,v160
M v[172:175],a[144:147],a[236:239],v[172:175]
s_waitcnt lgkmcnt(6)
MF v161,s5,v161
MF v162,s5,v162
M v[176:179],v[32:35],a[232:235],v[176:179]
s_nop 0
T a[144:145],v19,28672
T a[146:147],v19,30720
M v[176:179],v[36:39],a[96:99],v[176:179]
s_cmp_lg_u32 vcc_hi, 0
MF v163,s5,v163
MF v168,s5,v168
M v[176:179],v[40:43],a[104:107],v[176:179]
s_waitcnt lgkmcnt(2)
T a[148:149],v19,40960
T a[150:151],v19,43008
M v[176:179],v[44:47],a[112:115],v[176:179]
s_cbranch_scc1 L_wsr1
L_wrr1:
T a[152:153],v19,45056
T a[154:155],v19,47104
M v[176:179],v[48:51],a[120:123],v[176:179]
SA m0,s28,131072
MF v169,s5,v169
MF v170,s5,v170
M v[176:179],v[52:55],a[128:131],v[176:179]
T a[156:157],v19,49152
T a[158:159],v19,51200
M v[176:179],v[56:59],a[136:139],v[176:179]
T a[160:161],v19,53248
T a[162:163],v19,55296
M v[180:183],v[56:59],a[140:143],v[180:183]
buffer_load_dwordx4 v3, s[8:11], s26 offen offset:0 sc1 lds
M v[180:183],v[52:55],a[132:135],v[180:183]
s_nop 0
T a[164:165],v19,57344
T a[166:167],v19,59392
M v[180:183],v[48:51],a[124:127],v[180:183]
T a[168:169],v19,61440
T a[170:171],v19,63488
M v[180:183],v[44:47],a[116:119],v[180:183]
buffer_load_dwordx4 v3, s[8:11], s26 offen offset:1024 sc1 lds
M v[180:183],v[40:43],a[108:111],v[180:183]
MF v171,s5,v171
C v160,v160,v161
M v[180:183],v[36:39],a[100:103],v[180:183]
s_waitcnt lgkmcnt(0)
buffer_load_dwordx4 v3, s[8:11], s26 offen offset:2048 sc1 lds
M v[180:183],v[32:35],a[236:239],v[180:183]
s_barrier
M v[184:187],a[144:147],a[232:235],v[184:187]
R a[64:67],v2,32768
R a[68:71],v2,33792
M v[184:187],a[148:151],a[96:99],v[184:187]
buffer_load_dwordx4 v3, s[8:11], s26 offen offset:3072 sc1 lds
M v[184:187],a[152:155],a[104:107],v[184:187]
SA m0,s28,135168
C v161,v162,v163
C v162,v168,v169
M v[184:187],a[156:159],a[112:115],v[184:187]
SA s30,s32,12288
R a[72:75],v2,34816
R a[76:79],v2,35840
M v[184:187],a[160:163],a[120:123],v[184:187]
buffer_store_dwordx4 a[52:55], v6, s[8:11], s30 offen offset:1024 sc1
M v[184:187],a[164:167],a[128:131],v[184:187]
C v163,v170,v171
W a24,v160
M v[184:187],a[168:171],a[136:139],v[184:187]
R a[80:83],v2,36864
R a[84:87],v2,37888
M v[188:191],a[168:171],a[140:143],v[188:191]
buffer_load_dwordx4 v4, s[8:11], s26 offen offset:0 sc1 lds
M v[188:191],a[164:167],a[132:135],v[188:191]
W a25,v161
W a26,v162
M v[188:191],a[160:163],a[124:127],v[188:191]
R a[88:91],v2,38912
R a[92:95],v2,39936
M v[188:191],a[156:159],a[116:119],v[188:191]
buffer_load_dwordx4 v4, s[8:11], s26 offen offset:1024 sc1 lds
M v[188:191],a[152:155],a[108:111],v[188:191]
W a27,v163
MF v164,s5,v164
M v[188:191],a[148:151],a[100:103],v[188:191]
buffer_load_dwordx4 v4, s[8:11], s26 offen offset:2048 sc1 lds
M v[188:191],a[144:147],a[236:239],v[188:191]
s_waitcnt lgkmcnt(0)
SA s30,s32,4096
buffer_store_dwordx4 a[24:27], v6, s[8:11], s30 offen offset:2048 sc1
buffer_load_dwordx4 v4, s[8:11], s26 offen offset:3072 sc1 lds
SA s26,s26,32768
MF v165,s5,v165
MF v166,s5,v166
MF v167,s5,v167
MF v172,s5,v172
MF v173,s5,v173
MF v174,s5,v174
MF v175,s5,v175
C v164,v164,v165
C v165,v166,v167
C v166,v172,v173
C v167,v174,v175
W a56,v164
W a57,v165
W a58,v166
W a59,v167
SA s30,s32,12288
buffer_store_dwordx4 a[56:59], v6, s[8:11], s30 offen offset:2048 sc1
v_mov_b32 v30, 2
buffer_store_dword v30, v1, s[8:11], s45 offen sc1
M v[64:67],a[64:67],a[0:3],0
R a[96:99],v2,40960
R a[100:103],v2,41984
M v[64:67],a[68:71],a[4:7],v[64:67]
MF v176,s5,v176
MF v177,s5,v177
M v[64:67],a[72:75],a[8:11],v[64:67]
MF v178,s5,v178
MF v179,s5,v179
M v[64:67],a[76:79],a[12:15],v[64:67]
R a[104:107],v2,43008
R a[108:111],v2,44032
M v[64:67],a[80:83],a[16:19],v[64:67]
MF v184,s5,v184
MF v185,s5,v185
MF v186,s5,v186
MF v187,s5,v187
C v176,v176,v177
C v177,v178,v179
C v178,v184,v185
C v179,v186,v187
W a28,v176
W a29,v177
W a30,v178
W a31,v179
M v[64:67],a[84:87],a[20:23],v[64:67]
MF v180,s5,v180
MF v181,s5,v181
M v[64:67],a[88:91],a[24:27],v[64:67]
R a[112:115],v2,45056
R a[116:119],v2,46080
M v[64:67],a[92:95],a[28:31],v[64:67]
MF v182,s5,v182
MF v183,s5,v183
M v[68:71],a[64:67],a[32:35],0
MF v188,s5,v188
MF v189,s5,v189
M v[68:71],a[68:71],a[36:39],v[68:71]
R a[120:123],v2,47104
R a[124:127],v2,48128
M v[68:71],a[72:75],a[40:43],v[68:71]
SA m0,s28,32768
MF v190,s5,v190
MF v191,s5,v191
M v[68:71],a[76:79],a[44:47],v[68:71]
buffer_load_dwordx4 v3, s[8:11], s26 offen offset:0 sc1 lds
M v[68:71],a[80:83],a[48:51],v[68:71]
C v180,v180,v181
C v181,v182,v183
C v182,v188,v189
C v183,v190,v191
W a60,v180
W a61,v181
W a62,v182
W a63,v183
M v[68:71],a[84:87],a[52:55],v[68:71]
SA s30,s32,4096
buffer_store_dwordx4 a[28:31], v6, s[8:11], s30 offen offset:3072 sc1
M v[68:71],a[88:91],a[56:59],v[68:71]
SA s30,s32,12288
E v18,v64
M v[68:71],a[92:95],a[60:63],v[68:71]
s_waitcnt lgkmcnt(0)
buffer_store_dwordx4 a[60:63], v6, s[8:11], s30 offen offset:3072 sc1
M v[72:75],a[96:99],a[0:3],0
R a[64:67],v2,49152
R a[68:71],v2,50176
M v[72:75],a[100:103],a[4:7],v[72:75]
E v19,v65
M v[72:75],a[104:107],a[8:11],v[72:75]
buffer_load_dwordx4 v3, s[8:11], s26 offen offset:1024 sc1 lds
M v[72:75],a[108:111],a[12:15],v[72:75]
R a[72:75],v2,51200
R a[76:79],v2,52224
M v[72:75],a[112:115],a[16:19],v[72:75]
E v20,v66
M v[72:75],a[116:119],a[20:23],v[72:75]
buffer_load_dwordx4 v3, s[8:11], s26 offen offset:2048 sc1 lds
M v[72:75],a[120:123],a[24:27],v[72:75]
R a[80:83],v2,53248
R a[84:87],v2,54272
M v[72:75],a[124:127],a[28:31],v[72:75]
E v21,v67
M v[76:79],a[124:127],a[60:63],0
buffer_load_dwordx4 v3, s[8:11], s26 offen offset:3072 sc1 lds
M v[76:79],a[120:123],a[56:59],v[76:79]
SA m0,s28,36864
R a[88:91],v2,55296
R a[92:95],v2,56320
M v[76:79],a[116:119],a[52:55],v[76:79]
E v22,v68
M v[76:79],a[112:115],a[48:51],v[76:79]
buffer_load_dwordx4 v4, s[8:11], s26 offen offset:0 sc1 lds
M v[76:79],a[108:111],a[44:47],v[76:79]
E v23,v69
M v[76:79],a[104:107],a[40:43],v[76:79]
AF v26,v18,v19
C v40,v18,v19
M v[76:79],a[100:103],a[36:39],v[76:79]
buffer_load_dwordx4 v4, s[8:11], s26 offen offset:1024 sc1 lds
M v[76:79],a[96:99],a[32:35],v[76:79]
s_waitcnt lgkmcnt(0)
v_add_u32 v16, 0x20000, v7
AF v26,v20,v26
M v[80:83],a[64:67],a[0:3],0
R a[96:99],v2,57344
R a[100:103],v2,58368
M v[80:83],a[68:71],a[4:7],v[80:83]
buffer_load_dwordx4 v4, s[8:11], s26 offen offset:2048 sc1 lds
M v[80:83],a[72:75],a[8:11],v[80:83]
E v24,v70
M v[80:83],a[76:79],a[12:15],v[80:83]
R a[104:107],v2,59392
R a[108:111],v2,60416
M v[80:83],a[80:83],a[16:19],v[80:83]
buffer_load_dwordx4 v4, s[8:11], s26 offen offset:3072 sc1 lds
M v[80:83],a[84:87],a[20:23],v[80:83]
SA s26,s26,32768
E v25,v71
M v[80:83],a[88:91],a[24:27],v[80:83]
R a[112:115],v2,61440
R a[116:119],v2,62464
M v[80:83],a[92:95],a[28:31],v[80:83]
E v18,v72
M v[84:87],a[92:95],a[60:63],0
E v19,v73
M v[84:87],a[88:91],a[56:59],v[84:87]
R a[120:123],v2,63488
R a[124:127],v2,64512
M v[84:87],a[84:87],a[52:55],v[84:87]
C v41,v20,v21
AF v26,v21,v26
M v[84:87],a[80:83],a[48:51],v[84:87]
E v20,v74
M v[84:87],a[76:79],a[44:47],v[84:87]
AF v27,v22,v23
C v44,v22,v23
M v[84:87],a[72:75],a[40:43],v[84:87]
AF v27,v24,v27
C v45,v24,v25
M v[84:87],a[68:71],a[36:39],v[84:87]
s_waitcnt vmcnt(24) lgkmcnt(0)
E v21,v75
M v[84:87],a[64:67],a[32:35],v[84:87]
s_barrier
M v[88:91],a[96:99],a[0:3],0
R a[64:67],v2,0
R a[68:71],v2,1024
M v[88:91],a[100:103],a[4:7],v[88:91]
E v22,v76
M v[88:91],a[104:107],a[8:11],v[88:91]
AF v27,v25,v27
AF v26,v18,v26
M v[88:91],a[108:111],a[12:15],v[88:91]
R a[72:75],v2,2048
R a[76:79],v2,3072
M v[88:91],a[112:115],a[16:19],v[88:91]
E v23,v77
M v[88:91],a[116:119],a[20:23],v[88:91]
C v42,v18,v19
AF v26,v19,v26
M v[88:91],a[120:123],a[24:27],v[88:91]
R a[80:83],v2,4096
R a[84:87],v2,5120
M v[88:91],a[124:127],a[28:31],v[88:91]
E v24,v78
M v[92:95],a[124:127],a[60:63],0
AF v26,v20,v26
C v43,v20,v21
M v[92:95],a[120:123],a[56:59],v[92:95]
R a[88:91],v2,6144
R a[92:95],v2,7168
M v[92:95],a[116:119],a[52:55],v[92:95]
E v25,v79
M v[92:95],a[112:115],a[48:51],v[92:95]
AF v26,v21,v26
AF v27,v22,v27
M v[92:95],a[108:111],a[44:47],v[92:95]
C v46,v22,v23
AF v27,v23,v27
M v[92:95],a[104:107],a[40:43],v[92:95]
AF v27,v24,v27
C v47,v24,v25
M v[92:95],a[100:103],a[36:39],v[92:95]
s_waitcnt lgkmcnt(0)
AF v27,v25,v27
M v[92:95],a[96:99],a[32:35],v[92:95]
M v[96:99],a[64:67],a[0:3],0
R a[96:99],v2,8192
R a[100:103],v2,9216
M v[96:99],a[68:71],a[4:7],v[96:99]
SA m0,s28,98304
W a128,v128
W a129,v129
M v[96:99],a[72:75],a[8:11],v[96:99]
buffer_load_dwordx4 v3, s[8:11], s21 offen offset:0 sc1 lds
M v[96:99],a[76:79],a[12:15],v[96:99]
R a[104:107],v2,10240
R a[108:111],v2,11264
M v[96:99],a[80:83],a[16:19],v[96:99]
W a130,v130
v_mov_b32 v30, 0
M v[96:99],a[84:87],a[20:23],v[96:99]
W a131,v131
M v[96:99],a[88:91],a[24:27],v[96:99]
R a[112:115],v2,12288
R a[116:119],v2,13312
M v[96:99],a[92:95],a[28:31],v[96:99]
buffer_load_dwordx4 v3, s[8:11], s21 offen offset:1024 sc1 lds
M v[100:103],a[92:95],a[60:63],0
W a132,v132
v_mov_b32 v31, 0
M v[100:103],a[88:91],a[56:59],v[100:103]
R a[120:123],v2,14336
R a[124:127],v2,15360
M v[100:103],a[84:87],a[52:55],v[100:103]
W a133,v133
W a134,v134
M v[100:103],a[80:83],a[48:51],v[100:103]
buffer_load_dwordx4 v3, s[8:11], s21 offen offset:2048 sc1 lds
M v[100:103],a[76:79],a[44:47],v[100:103]
W a135,v135
M v[100:103],a[72:75],a[40:43],v[100:103]
v_mov_b32 v32, 0
M v[100:103],a[68:71],a[36:39],v[100:103]
W a136,v136
M v[100:103],a[64:67],a[32:35],v[100:103]
s_waitcnt lgkmcnt(0)
buffer_load_dwordx4 v3, s[8:11], s21 offen offset:3072 sc1 lds
M v[108:111],a[96:99],a[32:35],0
SA m0,s28,102400
R a[64:67],v2,16384
R a[68:71],v2,17408
M v[108:111],a[100:103],a[36:39],v[108:111]
W a137,v137
v_mov_b32 v33, 0
M v[108:111],a[104:107],a[40:43],v[108:111]
W a138,v138
M v[108:111],a[108:111],a[44:47],v[108:111]
R a[72:75],v2,18432
R a[76:79],v2,19456
M v[108:111],a[112:115],a[48:51],v[108:111]
buffer_load_dwordx4 v4, s[8:11], s21 offen offset:0 sc1 lds
M v[108:111],a[116:119],a[52:55],v[108:111]
W a139,v139
W a140,v140
M v[108:111],a[120:123],a[56:59],v[108:111]
R a[80:83],v2,20480
R a[84:87],v2,21504
M v[108:111],a[124:127],a[60:63],v[108:111]
buffer_load_dwordx4 v4, s[8:11], s21 offen offset:1024 sc1 lds
M v[104:107],a[124:127],a[28:31],0
v_mov_b32 v34, 0
W a141,v141
M v[104:107],a[120:123],a[24:27],v[104:107]
R a[88:91],v2,22528
R a[92:95],v2,23552
M v[104:107],a[116:119],a[20:23],v[104:107]
buffer_load_dwordx4 v4, s[8:11], s21 offen offset:2048 sc1 lds
M v[104:107],a[112:115],a[16:19],v[104:107]
W a142,v142
W a143,v143
M v[104:107],a[108:111],a[12:15],v[104:107]
v_mov_b32 v35, 0
W a144,v144
M v[104:107],a[104:107],a[8:11],v[104:107]
W a145,v145
M v[104:107],a[100:103],a[4:7],v[104:107]
buffer_load_dwordx4 v4, s[8:11], s21 offen offset:3072 sc1 lds
M v[104:107],a[96:99],a[0:3],v[104:107]
s_waitcnt lgkmcnt(0)
v_mov_b32 v36, 0
W a146,v146
M v[112:115],a[64:67],a[0:3],0
SA s21,s21,32768
R a[96:99],v2,24576
R a[100:103],v2,25600
M v[112:115],a[68:71],a[4:7],v[112:115]
s_sub_u32 s22, s22, 1
W a147,v147
M v[112:115],a[72:75],a[8:11],v[112:115]
s_cselect_b32 s21, s23, s21
E v18,v80
M v[112:115],a[76:79],a[12:15],v[112:115]
R a[104:107],v2,26624
R a[108:111],v2,27648
M v[112:115],a[80:83],a[16:19],v[112:115]
W a148,v148
v_mov_b32 v37, 0
M v[112:115],a[84:87],a[20:23],v[112:115]
W a149,v149
M v[112:115],a[88:91],a[24:27],v[112:115]
R a[112:115],v2,28672
R a[116:119],v2,29696
M v[112:115],a[92:95],a[28:31],v[112:115]
W a150,v150
M v[116:119],a[92:95],a[60:63],0
v_mov_b32 v38, 0
W a151,v151
M v[116:119],a[88:91],a[56:59],v[116:119]
R a[120:123],v2,30720
R a[124:127],v2,31744
M v[116:119],a[84:87],a[52:55],v[116:119]
W a152,v152
M v[116:119],a[80:83],a[48:51],v[116:119]
W a153,v153
M v[116:119],a[76:79],a[44:47],v[116:119]
E v19,v81
M v[116:119],a[72:75],a[40:43],v[116:119]
v_mov_b32 v39, 0
W a154,v154
M v[116:119],a[68:71],a[36:39],v[116:119]
s_waitcnt vmcnt(20) lgkmcnt(0)
E v20,v82
M v[116:119],a[64:67],a[32:35],v[116:119]
s_barrier
M v[124:127],a[96:99],a[32:35],0
R a[64:67],v16,0
R a[68:71],v16,1024
M v[124:127],a[100:103],a[36:39],v[124:127]
W a155,v155
W a156,v156
M v[124:127],a[104:107],a[40:43],v[124:127]
W a157,v157
AF v26,v18,v26
M v[124:127],a[108:111],a[44:47],v[124:127]
R a[72:75],v16,2048
R a[76:79],v16,3072
M v[124:127],a[112:115],a[48:51],v[124:127]
W a158,v158
C v56,v18,v19
M v[124:127],a[116:119],a[52:55],v[124:127]
E v21,v83
M v[124:127],a[120:123],a[56:59],v[124:127]
R a[80:83],v16,4096
R a[84:87],v16,5120
M v[124:127],a[124:127],a[60:63],v[124:127]
W a159,v159
AF v26,v19,v26
M v[120:123],a[124:127],a[28:31],0
E v22,v88
M v[120:123],a[120:123],a[24:27],v[120:123]
R a[88:91],v16,6144
R a[92:95],v16,7168
M v[120:123],a[116:119],a[20:23],v[120:123]
E v23,v89
M v[120:123],a[112:115],a[16:19],v[120:123]
E v24,v90
M v[120:123],a[108:111],a[12:15],v[120:123]
E v25,v91
M v[120:123],a[104:107],a[8:11],v[120:123]
E v18,v84
M v[120:123],a[100:103],a[4:7],v[120:123]
s_waitcnt lgkmcnt(0)
E v19,v85
M v[120:123],a[96:99],a[0:3],v[120:123]
AF v26,v20,v26
C v57,v20,v21
AF v26,v21,v26
AF v26,v22,v26
C v58,v22,v23
AF v26,v23,v26
AF v26,v24,v26
C v59,v24,v25
AF v26,v25,v26
E v20,v86
E v21,v87
AF v27,v18,v27
C v60,v18,v19
AF v27,v19,v27
E v22,v92
E v23,v93
AF v27,v20,v27
C v61,v20,v21
AF v27,v21,v27
E v24,v94
E v25,v95
AF v27,v22,v27
C v62,v22,v23
AF v27,v23,v27
AF v27,v24,v27
C v63,v24,v25
AF v27,v25,v27
v_max_f32 v10, v26, v27
v_min_f32 v11, v26, v27
v_cmp_lt_f32 vcc, s31, v10
v_cmp_gt_f32 s[64:65], s24, v11
s_nop 0
s_or_b64 vcc, vcc, s[64:65]
s_cbranch_vccnz L_stv1
L_rtv1:
M v[128:131],a[64:67],v[40:43],0
R a[96:99],v16,8192
R a[100:103],v16,9216
M v[128:131],a[68:71],v[56:59],v[128:131]
SA m0,s28,65536
W a160,v192
W a161,v193
M v[132:135],a[68:71],v[60:63],0
buffer_load_dwordx4 v3, s[8:11], s21 offen offset:0 sc1 lds
M v[132:135],a[64:67],v[44:47],v[132:135]
R a[104:107],v16,10240
R a[108:111],v16,11264
M v[140:143],a[72:75],v[44:47],0
W a162,v194
W a163,v195
M v[140:143],a[76:79],v[60:63],v[140:143]
W a164,v196
W a165,v197
M v[136:139],a[76:79],v[56:59],0
R a[112:115],v16,12288
R a[116:119],v16,13312
L_w_kv111:
s_cbranch_execz L_wd2
M v[136:139],a[72:75],v[40:43],v[136:139]
buffer_load_dwordx4 v3, s[8:11], s21 offen offset:1024 sc1 lds
M v[144:147],a[80:83],v[40:43],0
W a166,v198
W a167,v199
M v[144:147],a[84:87],v[56:59],v[144:147]
R a[120:123],v16,14336
R a[124:127],v16,15360
M v[148:151],a[84:87],v[60:63],0
SA s3,s93,262144
W a168,v200
W a169,v201
M v[148:151],a[80:83],v[44:47],v[148:151]
buffer_load_dwordx4 v3, s[8:11], s21 offen offset:2048 sc1 lds
M v[156:159],a[88:91],v[44:47],0
W a170,v202
W a171,v203
M v[156:159],a[92:95],v[60:63],v[156:159]
W a172,v204
W a173,v205
M v[152:155],a[92:95],v[56:59],0
buffer_store_dwordx4 a[128:131], v7, s[8:11], s3 offen offset:0 sc1
M v[152:155],a[88:91],v[40:43],v[152:155]
s_waitcnt lgkmcnt(0)
W a174,v206
W a175,v207
M v[160:163],a[96:99],v[40:43],0
R a[64:67],v16,16384
R a[68:71],v16,17408
M v[160:163],a[100:103],v[56:59],v[160:163]
buffer_load_dwordx4 v3, s[8:11], s21 offen offset:3072 sc1 lds
M v[164:167],a[100:103],v[60:63],0
SA m0,s28,69632
W a176,v208
W a177,v209
M v[164:167],a[96:99],v[44:47],v[164:167]
R a[72:75],v16,18432
R a[76:79],v16,19456
M v[172:175],a[104:107],v[44:47],0
buffer_load_dwordx4 v4, s[8:11], s21 offen offset:0 sc1 lds
M v[172:175],a[108:111],v[60:63],v[172:175]
W a178,v210
W a179,v211
M v[168:171],a[108:111],v[56:59],0
R a[80:83],v16,20480
R a[84:87],v16,21504
M v[168:171],a[104:107],v[40:43],v[168:171]
buffer_load_dwordx4 v4, s[8:11], s21 offen offset:1024 sc1 lds
M v[176:179],a[112:115],v[40:43],0
W a180,v212
W a181,v213
M v[176:179],a[116:119],v[56:59],v[176:179]
R a[88:91],v16,22528
R a[92:95],v16,23552
M v[180:183],a[116:119],v[60:63],0
buffer_load_dwordx4 v4, s[8:11], s21 offen offset:2048 sc1 lds
M v[180:183],a[112:115],v[44:47],v[180:183]
W a182,v214
W a183,v215
M v[188:191],a[120:123],v[44:47],0
W a184,v216
W a185,v217
W a186,v218
W a187,v219
W a188,v220
W a189,v221
W a190,v222
W a191,v223
M v[188:191],a[124:127],v[60:63],v[188:191]
E v18,v96
M v[184:187],a[124:127],v[56:59],0
buffer_load_dwordx4 v4, s[8:11], s21 offen offset:3072 sc1 lds
M v[184:187],a[120:123],v[40:43],v[184:187]
s_waitcnt lgkmcnt(0)
v_min_u32 v17, 1, v7
v_lshlrev_b32 v17, 29, v17
M v[192:195],a[64:67],v[40:43],0
SA s21,s21,32768
R a[96:99],v16,24576
R a[100:103],v16,25600
M v[192:195],a[68:71],v[56:59],v[192:195]
s_sub_u32 s22, s22, 1
buffer_store_dwordx4 a[132:135], v7, s[8:11], s3 offen offset:2048 sc1
M v[196:199],a[68:71],v[60:63],0
s_cselect_b32 s21, s23, s21
v_mov_b32 v15, 1
AF v30,v26,v30
M v[196:199],a[64:67],v[44:47],v[196:199]
SA s84,s47,16
R a[104:107],v16,26624
R a[108:111],v16,27648
M v[204:207],a[72:75],v[44:47],0
E v19,v97
M v[204:207],a[76:79],v[60:63],v[204:207]
E v20,v98
M v[200:203],a[76:79],v[56:59],0
R a[112:115],v16,28672
R a[116:119],v16,29696
M v[200:203],a[72:75],v[40:43],v[200:203]
E v21,v99
M v[208:211],a[80:83],v[40:43],0
E v22,v104
M v[208:211],a[84:87],v[56:59],v[208:211]
R a[120:123],v16,30720
R a[124:127],v16,31744
M v[212:215],a[84:87],v[60:63],0
SA s3,s93,266240
E v23,v105
M v[212:215],a[80:83],v[44:47],v[212:215]
buffer_store_dwordx4 a[136:139], v7, s[8:11], s3 offen offset:0 sc1
M v[220:223],a[88:91],v[44:47],0
AF v31,v27,v31
AF v28,v18,v19
M v[220:223],a[92:95],v[60:63],v[220:223]
E v24,v106
M v[216:219],a[92:95],v[56:59],0
s_waitcnt vmcnt(11) lgkmcnt(0)
E v25,v107
M v[216:219],a[88:91],v[40:43],v[216:219]
s_barrier
M v[224:227],a[96:99],v[40:43],0
R a[64:67],v2,32768
R a[68:71],v2,33792
M v[224:227],a[100:103],v[56:59],v[224:227]
buffer_store_dword v15, v17, s[8:11], s84 offen sc1
M v[228:231],a[100:103],v[60:63],0
C v48,v18,v19
AF v28,v20,v28
M v[228:231],a[96:99],v[44:47],v[228:231]
R a[72:75],v2,34816
R a[76:79],v2,35840
M v[236:239],a[104:107],v[44:47],0
E v18,v100
M v[236:239],a[108:111],v[60:63],v[236:239]
E v19,v101
M v[232:235],a[108:111],v[56:59],0
R a[80:83],v2,36864
R a[84:87],v2,37888
M v[232:235],a[104:107],v[40:43],v[232:235]
C v49,v20,v21
AF v28,v21,v28
M v[240:243],a[112:115],v[40:43],0
E v20,v102
M v[240:243],a[116:119],v[56:59],v[240:243]
R a[88:91],v2,38912
R a[92:95],v2,39936
M v[244:247],a[116:119],v[60:63],0
E v21,v103
M v[244:247],a[112:115],v[44:47],v[244:247]
AF v28,v22,v28
C v50,v22,v23
M v[252:255],a[120:123],v[44:47],0
AF v28,v23,v28
AF v28,v24,v28
M v[252:255],a[124:127],v[60:63],v[252:255]
E v22,v108
M v[248:251],a[124:127],v[56:59],0
s_waitcnt lgkmcnt(0)
E v23,v109
M v[248:251],a[120:123],v[40:43],v[248:251]
C v51,v24,v25
AF v28,v25,v28
AF v29,v18,v19
C v52,v18,v19
AF v29,v20,v29
C v53,v20,v21
AF v29,v21,v29
E v24,v110
E v25,v111
AF v29,v22,v29
C v54,v22,v23
AF v29,v23,v29
AF v29,v24,v29
C v55,v24,v25
AF v29,v25,v29
M v[64:67],a[64:67],a[0:3],v[32:35]
R a[96:99],v2,40960
R a[100:103],v2,41984
M v[64:67],a[68:71],a[4:7],v[64:67]
SA m0,s28,0
E v18,v112
M v[64:67],a[72:75],a[8:11],v[64:67]
buffer_load_dwordx4 v3, s[8:11], s26 offen offset:0 sc1 lds
M v[64:67],a[76:79],a[12:15],v[64:67]
R a[104:107],v2,43008
R a[108:111],v2,44032
M v[64:67],a[80:83],a[16:19],v[64:67]
E v19,v113
M v[64:67],a[84:87],a[20:23],v[64:67]
AF v28,v18,v28
C v56,v18,v19
M v[64:67],a[88:91],a[24:27],v[64:67]
R a[112:115],v2,45056
R a[116:119],v2,46080
M v[64:67],a[92:95],a[28:31],v[64:67]
buffer_load_dwordx4 v3, s[8:11], s26 offen offset:1024 sc1 lds
M v[68:71],a[92:95],a[60:63],v[36:39]
E v20,v114
M v[68:71],a[88:91],a[56:59],v[68:71]
R a[120:123],v2,47104
R a[124:127],v2,48128
M v[68:71],a[84:87],a[52:55],v[68:71]
SA s3,s93,266240
E v21,v115
M v[68:71],a[80:83],a[48:51],v[68:71]
buffer_load_dwordx4 v3, s[8:11], s26 offen offset:2048 sc1 lds
M v[68:71],a[76:79],a[44:47],v[68:71]
AF v28,v19,v28
AF v28,v20,v28
M v[68:71],a[72:75],a[40:43],v[68:71]
C v57,v20,v21
AF v28,v21,v28
M v[68:71],a[68:71],a[36:39],v[68:71]
buffer_store_dwordx4 a[140:143], v7, s[8:11], s3 offen offset:2048 sc1
M v[68:71],a[64:67],a[32:35],v[68:71]
s_waitcnt lgkmcnt(0)
E v22,v120
M v[76:79],a[96:99],a[32:35],v[36:39]
R a[64:67],v2,49152
R a[68:71],v2,50176
M v[76:79],a[100:103],a[36:39],v[76:79]
buffer_load_dwordx4 v3, s[8:11], s26 offen offset:3072 sc1 lds
M v[76:79],a[104:107],a[40:43],v[76:79]
SA m0,s28,4096
E v23,v121
M v[76:79],a[108:111],a[44:47],v[76:79]
R a[72:75],v2,51200
R a[76:79],v2,52224
M v[76:79],a[112:115],a[48:51],v[76:79]
buffer_load_dwordx4 v4, s[8:11], s26 offen offset:0 sc1 lds
M v[76:79],a[116:119],a[52:55],v[76:79]
E v24,v122
M v[76:79],a[120:123],a[56:59],v[76:79]
R a[80:83],v2,53248
R a[84:87],v2,54272
M v[76:79],a[124:127],a[60:63],v[76:79]
buffer_load_dwordx4 v4, s[8:11], s26 offen offset:1024 sc1 lds
M v[72:75],a[124:127],a[28:31],v[32:35]
E v25,v123
M v[72:75],a[120:123],a[24:27],v[72:75]
SA s3,s93,270336
R a[88:91],v2,55296
R a[92:95],v2,56320
M v[72:75],a[116:119],a[20:23],v[72:75]
buffer_load_dwordx4 v4, s[8:11], s26 offen offset:2048 sc1 lds
M v[72:75],a[112:115],a[16:19],v[72:75]
AF v28,v22,v28
C v58,v22,v23
M v[72:75],a[108:111],a[12:15],v[72:75]
E v18,v116
M v[72:75],a[104:107],a[8:11],v[72:75]
AF v28,v23,v28
AF v28,v24,v28
M v[72:75],a[100:103],a[4:7],v[72:75]
buffer_load_dwordx4 v4, s[8:11], s26 offen offset:3072 sc1 lds
M v[72:75],a[96:99],a[0:3],v[72:75]
s_waitcnt lgkmcnt(0)
E v19,v117
M v[80:83],a[64:67],a[0:3],v[32:35]
SA s26,s26,32768
R a[96:99],v2,57344
R a[100:103],v2,58368
M v[80:83],a[68:71],a[4:7],v[80:83]
buffer_store_dwordx4 a[144:147], v7, s[8:11], s3 offen offset:0 sc1
M v[80:83],a[72:75],a[8:11],v[80:83]
C v59,v24,v25
AF v28,v25,v28
M v[80:83],a[76:79],a[12:15],v[80:83]
R a[104:107],v2,59392
R a[108:111],v2,60416
M v[80:83],a[80:83],a[16:19],v[80:83]
E v20,v118
M v[80:83],a[84:87],a[20:23],v[80:83]
AF v29,v18,v29
C v60,v18,v19
M v[80:83],a[88:91],a[24:27],v[80:83]
R a[112:115],v2,61440
R a[116:119],v2,62464
M v[80:83],a[92:95],a[28:31],v[80:83]
E v21,v119
M v[84:87],a[92:95],a[60:63],v[36:39]
AF v29,v19,v29
AF v29,v20,v29
M v[84:87],a[88:91],a[56:59],v[84:87]
R a[120:123],v2,63488
R a[124:127],v2,64512
M v[84:87],a[84:87],a[52:55],v[84:87]
E v22,v124
M v[84:87],a[80:83],a[48:51],v[84:87]
buffer_store_dwordx4 a[148:151], v7, s[8:11], s3 offen offset:2048 sc1
M v[84:87],a[76:79],a[44:47],v[84:87]
C v61,v20,v21
AF v29,v21,v29
M v[84:87],a[72:75],a[40:43],v[84:87]
E v23,v125
M v[84:87],a[68:71],a[36:39],v[84:87]
s_waitcnt lgkmcnt(0)
AF v29,v22,v29
C v62,v22,v23
M v[84:87],a[64:67],a[32:35],v[84:87]
s_barrier
M v[92:95],a[96:99],a[32:35],v[36:39]
R a[64:67],v7,32768
R a[68:71],v7,33792
M v[92:95],a[100:103],a[36:39],v[92:95]
E v24,v126
M v[92:95],a[104:107],a[40:43],v[92:95]
AF v29,v23,v29
M v[92:95],a[108:111],a[44:47],v[92:95]
R a[72:75],v7,34816
R a[76:79],v7,35840
M v[92:95],a[112:115],a[48:51],v[92:95]
E v25,v127
M v[92:95],a[116:119],a[52:55],v[92:95]
AF v29,v24,v29
C v63,v24,v25
M v[92:95],a[120:123],a[56:59],v[92:95]
R a[80:83],v7,36864
R a[84:87],v7,37888
M v[92:95],a[124:127],a[60:63],v[92:95]
AF v29,v25,v29
M v[88:91],a[124:127],a[28:31],v[32:35]
M v[88:91],a[120:123],a[24:27],v[88:91]
R a[88:91],v7,38912
R a[92:95],v7,39936
M v[88:91],a[116:119],a[20:23],v[88:91]
v_max_f32 v10, v28, v29
M v[88:91],a[112:115],a[16:19],v[88:91]
v_cmp_lt_f32 vcc, s31, v10
M v[88:91],a[108:111],a[12:15],v[88:91]
M v[88:91],a[104:107],a[8:11],v[88:91]
M v[88:91],a[100:103],a[4:7],v[88:91]
s_waitcnt lgkmcnt(0)
M v[88:91],a[96:99],a[0:3],v[88:91]
s_cbranch_vccnz L_stv2
L_rtv2:
M v[128:131],a[64:67],v[48:51],v[128:131]
R a[96:99],v7,40960
R a[100:103],v7,41984
M v[128:131],a[68:71],v[56:59],v[128:131]
SA m0,s28,98304
E v18,v64
M v[132:135],a[68:71],v[60:63],v[132:135]
buffer_load_dwordx4 v3, s[8:11], s21 offen offset:0 sc1 lds
M v[132:135],a[64:67],v[52:55],v[132:135]
R a[104:107],v7,43008
R a[108:111],v7,44032
M v[140:143],a[72:75],v[52:55],v[140:143]
E v19,v65
M v[140:143],a[76:79],v[60:63],v[140:143]
AF v30,v28,v30
AF v31,v29,v31
M v[136:139],a[76:79],v[56:59],v[136:139]
R a[112:115],v7,45056
R a[116:119],v7,46080
M v[136:139],a[72:75],v[48:51],v[136:139]
buffer_load_dwordx4 v3, s[8:11], s21 offen offset:1024 sc1 lds
M v[144:147],a[80:83],v[48:51],v[144:147]
E v20,v66
M v[144:147],a[84:87],v[56:59],v[144:147]
R a[120:123],v7,47104
R a[124:127],v7,48128
M v[148:151],a[84:87],v[60:63],v[148:151]
SA s3,s93,274432
AF v26,v18,v19
C v40,v18,v19
M v[148:151],a[80:83],v[52:55],v[148:151]
buffer_load_dwordx4 v3, s[8:11], s21 offen offset:2048 sc1 lds
M v[156:159],a[88:91],v[52:55],v[156:159]
E v21,v67
M v[156:159],a[92:95],v[60:63],v[156:159]
AF v26,v20,v26
C v41,v20,v21
M v[152:155],a[92:95],v[56:59],v[152:155]
buffer_store_dwordx4 a[152:155], v7, s[8:11], s3 offen offset:0 sc1
M v[152:155],a[88:91],v[48:51],v[152:155]
s_waitcnt lgkmcnt(0)
E v22,v72
M v[160:163],a[96:99],v[48:51],v[160:163]
R a[64:67],v7,49152
R a[68:71],v7,50176
M v[160:163],a[100:103],v[56:59],v[160:163]
buffer_load_dwordx4 v3, s[8:11], s21 offen offset:3072 sc1 lds
M v[164:167],a[100:103],v[60:63],v[164:167]
SA m0,s28,102400
E v23,v73
M v[164:167],a[96:99],v[52:55],v[164:167]
R a[72:75],v7,51200
R a[76:79],v7,52224
M v[172:175],a[104:107],v[52:55],v[172:175]
buffer_load_dwordx4 v4, s[8:11], s21 offen offset:0 sc1 lds
M v[172:175],a[108:111],v[60:63],v[172:175]
AF v26,v21,v26
AF v26,v22,v26
M v[168:171],a[108:111],v[56:59],v[168:171]
R a[80:83],v7,53248
R a[84:87],v7,54272
M v[168:171],a[104:107],v[48:51],v[168:171]
buffer_load_dwordx4 v4, s[8:11], s21 offen offset:1024 sc1 lds
M v[176:179],a[112:115],v[48:51],v[176:179]
E v24,v74
M v[176:179],a[116:119],v[56:59],v[176:179]
R a[88:91],v7,55296
R a[92:95],v7,56320
M v[180:183],a[116:119],v[60:63],v[180:183]
buffer_load_dwordx4 v4, s[8:11], s21 offen offset:2048 sc1 lds
M v[180:183],a[112:115],v[52:55],v[180:183]
E v25,v75
M v[188:191],a[120:123],v[52:55],v[188:191]
C v42,v22,v23
AF v26,v23,v26
M v[188:191],a[124:127],v[60:63],v[188:191]
AF v26,v24,v26
C v43,v24,v25
M v[184:187],a[124:127],v[56:59],v[184:187]
buffer_load_dwordx4 v4, s[8:11], s21 offen offset:3072 sc1 lds
M v[184:187],a[120:123],v[48:51],v[184:187]
s_waitcnt lgkmcnt(0)
E v18,v68
M v[192:195],a[64:67],v[48:51],v[192:195]
SA s21,s21,32768
R a[96:99],v7,57344
R a[100:103],v7,58368
M v[192:195],a[68:71],v[56:59],v[192:195]
s_sub_u32 s22, s22, 1
buffer_store_dwordx4 a[156:159], v7, s[8:11], s3 offen offset:2048 sc1
M v[196:199],a[68:71],v[60:63],v[196:199]
s_cselect_b32 s21, s23, s21
E v19,v69
M v[196:199],a[64:67],v[52:55],v[196:199]
R a[104:107],v7,59392
R a[108:111],v7,60416
M v[204:207],a[72:75],v[52:55],v[204:207]
AF v26,v25,v26
AF v27,v18,v19
M v[204:207],a[76:79],v[60:63],v[204:207]
E v20,v70
M v[200:203],a[76:79],v[56:59],v[200:203]
R a[112:115],v7,61440
R a[116:119],v7,62464
M v[200:203],a[72:75],v[48:51],v[200:203]
C v44,v18,v19
M v[208:211],a[80:83],v[48:51],v[208:211]
M v[208:211],a[84:87],v[56:59],v[208:211]
R a[120:123],v7,63488
R a[124:127],v7,64512
M v[212:215],a[84:87],v[60:63],v[212:215]
SA s3,s93,786432
E v21,v71
M v[212:215],a[80:83],v[52:55],v[212:215]
buffer_store_dwordx4 a[160:163], v7, s[8:11], s3 offen offset:0 sc1
M v[220:223],a[88:91],v[52:55],v[220:223]
AF v27,v20,v27
C v45,v20,v21
M v[220:223],a[92:95],v[60:63],v[220:223]
E v22,v76
M v[216:219],a[92:95],v[56:59],v[216:219]
s_waitcnt vmcnt(25) lgkmcnt(0)
AF v27,v21,v27
M v[216:219],a[88:91],v[48:51],v[216:219]
s_barrier
M v[224:227],a[96:99],v[48:51],v[224:227]
R a[64:67],v2,0
R a[68:71],v2,1024
M v[224:227],a[100:103],v[56:59],v[224:227]
E v23,v77
M v[228:231],a[100:103],v[60:63],v[228:231]
AF v27,v22,v27
C v46,v22,v23
M v[228:231],a[96:99],v[52:55],v[228:231]
R a[72:75],v2,2048
R a[76:79],v2,3072
M v[236:239],a[104:107],v[52:55],v[236:239]
E v24,v78
M v[236:239],a[108:111],v[60:63],v[236:239]
AF v27,v23,v27
M v[232:235],a[108:111],v[56:59],v[232:235]
R a[80:83],v2,4096
R a[84:87],v2,5120
M v[232:235],a[104:107],v[48:51],v[232:235]
M v[240:243],a[112:115],v[48:51],v[240:243]
E v25,v79
M v[240:243],a[116:119],v[56:59],v[240:243]
R a[88:91],v2,6144
R a[92:95],v2,7168
M v[244:247],a[116:119],v[60:63],v[244:247]
AF v27,v24,v27
C v47,v24,v25
M v[244:247],a[112:115],v[52:55],v[244:247]
AF v27,v25,v27
M v[252:255],a[120:123],v[52:55],v[252:255]
M v[252:255],a[124:127],v[60:63],v[252:255]
M v[248:251],a[124:127],v[56:59],v[248:251]
s_waitcnt lgkmcnt(0)
M v[248:251],a[120:123],v[48:51],v[248:251]
M v[96:99],a[64:67],a[0:3],v[32:35]
R a[96:99],v2,8192
R a[100:103],v2,9216
M v[96:99],a[68:71],a[4:7],v[96:99]
SA m0,s28,32768
E v18,v80
M v[96:99],a[72:75],a[8:11],v[96:99]
buffer_load_dwordx4 v3, s[8:11], s26 offen offset:0 sc1 lds
M v[96:99],a[76:79],a[12:15],v[96:99]
R a[104:107],v2,10240
R a[108:111],v2,11264
M v[96:99],a[80:83],a[16:19],v[96:99]
E v19,v81
M v[96:99],a[84:87],a[20:23],v[96:99]
AF v26,v18,v26
C v56,v18,v19
M v[96:99],a[88:91],a[24:27],v[96:99]
R a[112:115],v2,12288
R a[116:119],v2,13312
M v[96:99],a[92:95],a[28:31],v[96:99]
buffer_load_dwordx4 v3, s[8:11], s26 offen offset:1024 sc1 lds
M v[100:103],a[92:95],a[60:63],v[36:39]
E v20,v82
M v[100:103],a[88:91],a[56:59],v[100:103]
R a[120:123],v2,14336
R a[124:127],v2,15360
M v[100:103],a[84:87],a[52:55],v[100:103]
SA s3,s93,786432
E v21,v83
M v[100:103],a[80:83],a[48:51],v[100:103]
buffer_load_dwordx4 v3, s[8:11], s26 offen offset:2048 sc1 lds
M v[100:103],a[76:79],a[44:47],v[100:103]
AF v26,v19,v26
AF v26,v20,v26
M v[100:103],a[72:75],a[40:43],v[100:103]
C v57,v20,v21
AF v26,v21,v26
M v[100:103],a[68:71],a[36:39],v[100:103]
buffer_store_dwordx4 a[164:167], v7, s[8:11], s3 offen offset:2048 sc1
M v[100:103],a[64:67],a[32:35],v[100:103]
s_waitcnt lgkmcnt(0)
E v22,v88
M v[108:111],a[96:99],a[32:35],v[36:39]
R a[64:67],v2,16384
R a[68:71],v2,17408
M v[108:111],a[100:103],a[36:39],v[108:111]
buffer_load_dwordx4 v3, s[8:11], s26 offen offset:3072 sc1 lds
M v[108:111],a[104:107],a[40:43],v[108:111]
SA m0,s28,36864
E v23,v89
M v[108:111],a[108:111],a[44:47],v[108:111]
R a[72:75],v2,18432
R a[76:79],v2,19456
M v[108:111],a[112:115],a[48:51],v[108:111]
buffer_load_dwordx4 v4, s[8:11], s26 offen offset:0 sc1 lds
M v[108:111],a[116:119],a[52:55],v[108:111]
SA s3,s93,790528
E v24,v90
M v[108:111],a[120:123],a[56:59],v[108:111]
R a[80:83],v2,20480
R a[84:87],v2,21504
M v[108:111],a[124:127],a[60:63],v[108:111]
buffer_load_dwordx4 v4, s[8:11], s26 offen offset:1024 sc1 lds
M v[104:107],a[124:127],a[28:31],v[32:35]
E v25,v91
M v[104:107],a[120:123],a[24:27],v[104:107]
R a[88:91],v2,22528
R a[92:95],v2,23552
M v[104:107],a[116:119],a[20:23],v[104:107]
buffer_load_dwordx4 v4, s[8:11], s26 offen offset:2048 sc1 lds
M v[104:107],a[112:115],a[16:19],v[104:107]
AF v26,v22,v26
C v58,v22,v23
M v[104:107],a[108:111],a[12:15],v[104:107]
E v18,v84
M v[104:107],a[104:107],a[8:11],v[104:107]
buffer_store_dwordx4 a[168:171], v7, s[8:11], s3 offen offset:0 sc1
M v[104:107],a[100:103],a[4:7],v[104:107]
AF v26,v23,v26
AF v26,v24,v26
M v[104:107],a[96:99],a[0:3],v[104:107]
s_waitcnt lgkmcnt(0)
E v19,v85
M v[112:115],a[64:67],a[0:3],v[32:35]
R a[96:99],v2,24576
R a[100:103],v2,25600
M v[112:115],a[68:71],a[4:7],v[112:115]
buffer_load_dwordx4 v4, s[8:11], s26 offen offset:3072 sc1 lds
L_w_kv112:
s_cbranch_execz L_wd2
M v[112:115],a[72:75],a[8:11],v[112:115]
SA s26,s26,32768
C v59,v24,v25
AF v26,v25,v26
M v[112:115],a[76:79],a[12:15],v[112:115]
R a[104:107],v2,26624
R a[108:111],v2,27648
M v[112:115],a[80:83],a[16:19],v[112:115]
E v20,v86
M v[112:115],a[84:87],a[20:23],v[112:115]
buffer_store_dwordx4 a[172:175], v7, s[8:11], s3 offen offset:2048 sc1
M v[112:115],a[88:91],a[24:27],v[112:115]
R a[112:115],v2,28672
R a[116:119],v2,29696
M v[112:115],a[92:95],a[28:31],v[112:115]
E v21,v87
M v[116:119],a[92:95],a[60:63],v[36:39]
AF v27,v18,v27
C v60,v18,v19
M v[116:119],a[88:91],a[56:59],v[116:119]
R a[120:123],v2,30720
R a[124:127],v2,31744
M v[116:119],a[84:87],a[52:55],v[116:119]
E v22,v92
M v[116:119],a[80:83],a[48:51],v[116:119]
AF v27,v19,v27
AF v27,v20,v27
M v[116:119],a[76:79],a[44:47],v[116:119]
C v61,v20,v21
AF v27,v21,v27
M v[116:119],a[72:75],a[40:43],v[116:119]
E v23,v93
M v[116:119],a[68:71],a[36:39],v[116:119]
s_waitcnt vmcnt(24) lgkmcnt(0)
AF v27,v22,v27
C v62,v22,v23
M v[116:119],a[64:67],a[32:35],v[116:119]
s_barrier
M v[124:127],a[96:99],a[32:35],v[36:39]
SA s3,s93,794624
R a[64:67],v7,0
R a[68:71],v7,1024
M v[124:127],a[100:103],a[36:39],v[124:127]
buffer_store_dwordx4 a[176:179], v7, s[8:11], s3 offen offset:0 sc1
M v[124:127],a[104:107],a[40:43],v[124:127]
E v24,v94
M v[124:127],a[108:111],a[44:47],v[124:127]
R a[72:75],v7,2048
R a[76:79],v7,3072
M v[124:127],a[112:115],a[48:51],v[124:127]
E v25,v95
M v[124:127],a[116:119],a[52:55],v[124:127]
AF v27,v23,v27
AF v27,v24,v27
M v[124:127],a[120:123],a[56:59],v[124:127]
R a[80:83],v7,4096
R a[84:87],v7,5120
M v[124:127],a[124:127],a[60:63],v[124:127]
C v63,v24,v25
AF v27,v25,v27
M v[120:123],a[124:127],a[28:31],v[32:35]
M v[120:123],a[120:123],a[24:27],v[120:123]
R a[88:91],v7,6144
R a[92:95],v7,7168
M v[120:123],a[116:119],a[20:23],v[120:123]
v_max_f32 v10, v26, v27
M v[120:123],a[112:115],a[16:19],v[120:123]
v_cmp_lt_f32 vcc, s31, v10
M v[120:123],a[108:111],a[12:15],v[120:123]
M v[120:123],a[104:107],a[8:11],v[120:123]
M v[120:123],a[100:103],a[4:7],v[120:123]
s_waitcnt lgkmcnt(0)
M v[120:123],a[96:99],a[0:3],v[120:123]
s_cbranch_vccnz L_stv3
L_rtv3:
M v[128:131],a[64:67],v[40:43],v[128:131]
R a[96:99],v7,8192
R a[100:103],v7,9216
M v[128:131],a[68:71],v[56:59],v[128:131]
SA m0,s28,65536
E v18,v96
M v[132:135],a[68:71],v[60:63],v[132:135]
buffer_load_dwordx4 v3, s[8:11], s21 offen offset:0 sc1 lds
M v[132:135],a[64:67],v[44:47],v[132:135]
R a[104:107],v7,10240
R a[108:111],v7,11264
M v[140:143],a[72:75],v[44:47],v[140:143]
E v19,v97
M v[140:143],a[76:79],v[60:63],v[140:143]
AF v30,v26,v30
AF v31,v27,v31
M v[136:139],a[76:79],v[56:59],v[136:139]
R a[112:115],v7,12288
R a[116:119],v7,13312
M v[136:139],a[72:75],v[40:43],v[136:139]
buffer_load_dwordx4 v3, s[8:11], s21 offen offset:1024 sc1 lds
M v[144:147],a[80:83],v[40:43],v[144:147]
E v20,v98
M v[144:147],a[84:87],v[56:59],v[144:147]
R a[120:123],v7,14336
R a[124:127],v7,15360
M v[148:151],a[84:87],v[60:63],v[148:151]
SA s3,s93,794624
AF v28,v18,v19
C v48,v18,v19
M v[148:151],a[80:83],v[44:47],v[148:151]
buffer_load_dwordx4 v3, s[8:11], s21 offen offset:2048 sc1 lds
M v[156:159],a[88:91],v[44:47],v[156:159]
E v21,v99
M v[156:159],a[92:95],v[60:63],v[156:159]
AF v28,v20,v28
C v49,v20,v21
M v[152:155],a[92:95],v[56:59],v[152:155]
buffer_store_dwordx4 a[180:183], v7, s[8:11], s3 offen offset:2048 sc1
M v[152:155],a[88:91],v[40:43],v[152:155]
s_waitcnt lgkmcnt(0)
E v22,v104
M v[160:163],a[96:99],v[40:43],v[160:163]
R a[64:67],v7,16384
R a[68:71],v7,17408
M v[160:163],a[100:103],v[56:59],v[160:163]
buffer_load_dwordx4 v3, s[8:11], s21 offen offset:3072 sc1 lds
M v[164:167],a[100:103],v[60:63],v[164:167]
SA m0,s28,69632
E v23,v105
M v[164:167],a[96:99],v[44:47],v[164:167]
R a[72:75],v7,18432
R a[76:79],v7,19456
M v[172:175],a[104:107],v[44:47],v[172:175]
buffer_load_dwordx4 v4, s[8:11], s21 offen offset:0 sc1 lds
M v[172:175],a[108:111],v[60:63],v[172:175]
AF v28,v21,v28
AF v28,v22,v28
M v[168:171],a[108:111],v[56:59],v[168:171]
R a[80:83],v7,20480
R a[84:87],v7,21504
M v[168:171],a[104:107],v[40:43],v[168:171]
buffer_load_dwordx4 v4, s[8:11], s21 offen offset:1024 sc1 lds
M v[176:179],a[112:115],v[40:43],v[176:179]
E v24,v106
M v[176:179],a[116:119],v[56:59],v[176:179]
SA s3,s93,798720
R a[88:91],v7,22528
R a[92:95],v7,23552
M v[180:183],a[116:119],v[60:63],v[180:183]
buffer_load_dwordx4 v4, s[8:11], s21 offen offset:2048 sc1 lds
M v[180:183],a[112:115],v[44:47],v[180:183]
E v25,v107
M v[188:191],a[120:123],v[44:47],v[188:191]
C v50,v22,v23
AF v28,v23,v28
M v[188:191],a[124:127],v[60:63],v[188:191]
AF v28,v24,v28
C v51,v24,v25
M v[184:187],a[124:127],v[56:59],v[184:187]
buffer_load_dwordx4 v4, s[8:11], s21 offen offset:3072 sc1 lds
M v[184:187],a[120:123],v[40:43],v[184:187]
s_waitcnt lgkmcnt(0)
E v18,v100
M v[192:195],a[64:67],v[40:43],v[192:195]
SA s21,s21,32768
R a[96:99],v7,24576
R a[100:103],v7,25600
M v[192:195],a[68:71],v[56:59],v[192:195]
s_sub_u32 s22, s22, 1
buffer_store_dwordx4 a[184:187], v7, s[8:11], s3 offen offset:0 sc1
M v[196:199],a[68:71],v[60:63],v[196:199]
s_cselect_b32 s21, s23, s21
E v19,v101
M v[196:199],a[64:67],v[44:47],v[196:199]
R a[104:107],v7,26624
R a[108:111],v7,27648
M v[204:207],a[72:75],v[44:47],v[204:207]
AF v28,v25,v28
AF v29,v18,v19
M v[204:207],a[76:79],v[60:63],v[204:207]
E v20,v102
M v[200:203],a[76:79],v[56:59],v[200:203]
R a[112:115],v7,28672
R a[116:119],v7,29696
M v[200:203],a[72:75],v[40:43],v[200:203]
C v52,v18,v19
M v[208:211],a[80:83],v[40:43],v[208:211]
M v[208:211],a[84:87],v[56:59],v[208:211]
R a[120:123],v7,30720
R a[124:127],v7,31744
M v[212:215],a[84:87],v[60:63],v[212:215]
E v21,v103
M v[212:215],a[80:83],v[44:47],v[212:215]
buffer_store_dwordx4 a[188:191], v7, s[8:11], s3 offen offset:2048 sc1
M v[220:223],a[88:91],v[44:47],v[220:223]
AF v29,v20,v29
C v53,v20,v21
M v[220:223],a[92:95],v[60:63],v[220:223]
E v22,v108
M v[216:219],a[92:95],v[56:59],v[216:219]
s_waitcnt vmcnt(25) lgkmcnt(0)
AF v29,v21,v29
M v[216:219],a[88:91],v[40:43],v[216:219]
s_barrier
M v[224:227],a[96:99],v[40:43],v[224:227]
R a[64:67],v2,32768
R a[68:71],v2,33792
M v[224:227],a[100:103],v[56:59],v[224:227]
E v23,v109
M v[228:231],a[100:103],v[60:63],v[228:231]
AF v29,v22,v29
C v54,v22,v23
M v[228:231],a[96:99],v[44:47],v[228:231]
R a[72:75],v2,34816
R a[76:79],v2,35840
M v[236:239],a[104:107],v[44:47],v[236:239]
E v24,v110
M v[236:239],a[108:111],v[60:63],v[236:239]
AF v29,v23,v29
M v[232:235],a[108:111],v[56:59],v[232:235]
R a[80:83],v2,36864
R a[84:87],v2,37888
M v[232:235],a[104:107],v[40:43],v[232:235]
M v[240:243],a[112:115],v[40:43],v[240:243]
E v25,v111
M v[240:243],a[116:119],v[56:59],v[240:243]
R a[88:91],v2,38912
R a[92:95],v2,39936
M v[244:247],a[116:119],v[60:63],v[244:247]
AF v29,v24,v29
C v55,v24,v25
M v[244:247],a[112:115],v[44:47],v[244:247]
AF v29,v25,v29
M v[252:255],a[120:123],v[44:47],v[252:255]
M v[252:255],a[124:127],v[60:63],v[252:255]
M v[248:251],a[124:127],v[56:59],v[248:251]
s_waitcnt lgkmcnt(0)
M v[248:251],a[120:123],v[40:43],v[248:251]
s_branch L_loop_top
L_st0:
s_call_b64 s[36:37], L_slow0
s_branch L_rt0
L_st1:
s_call_b64 s[36:37], L_slow1
s_branch L_rt1
L_stv1:
s_call_b64 s[36:37], L_slowf
s_branch L_rtv1
L_stk1:
s_call_b64 s[36:37], L_slowf
s_branch L_rtk1
L_sth1:
s_call_b64 s[36:37], L_slowf
s_branch L_rth1
L_stj0:
s_call_b64 s[36:37], L_slowj
s_branch L_rtj0
L_stv2:
s_call_b64 s[36:37], L_slow1
s_branch L_rtv2
L_stv3:
s_call_b64 s[36:37], L_slow0
s_branch L_rtv3
L_std1:
s_call_b64 s[36:37], L_slow1
s_branch L_rtd1
L_std3n:
s_call_b64 s[36:37], L_slow0
s_branch L_rtd3n
L_std3h:
s_call_b64 s[36:37], L_slow0
s_branch L_rtd3h
L_std4n:
s_call_b64 s[36:37], L_slowb
s_branch L_rtd4n
L_std4h:
s_call_b64 s[36:37], L_slowb
s_branch L_rtd4h
L_stfh:
s_call_b64 s[36:37], L_slow1n
s_branch L_rtfh
L_stc:
s_call_b64 s[36:37], L_comb
s_branch L_rtc
L_slow0:
s_nop 7
s_nop 3
v_max3_f32 v10, v64, v65, v66
v_max3_f32 v10, v67, v72, v10
v_max3_f32 v10, v73, v74, v10
v_max3_f32 v10, v75, v80, v10
v_max3_f32 v10, v81, v82, v10
v_max3_f32 v10, v83, v88, v10
v_max3_f32 v10, v89, v90, v10
v_max_f32 v10, v91, v10
v_max3_f32 v11, v68, v69, v70
v_max3_f32 v11, v71, v76, v11
v_max3_f32 v11, v77, v78, v11
v_max3_f32 v11, v79, v84, v11
v_max3_f32 v11, v85, v86, v11
v_max3_f32 v11, v87, v92, v11
v_max3_f32 v11, v93, v94, v11
v_max_f32 v11, v95, v11
v_mov_b32 v12, v10
v_mov_b32 v13, v11
s_nop 0
v_permlane16_swap_b32 v12, v10
v_permlane16_swap_b32 v13, v11
v_max_f32 v10, v12, v10
v_max_f32 v11, v13, v11
v_mov_b32 v12, v10
v_mov_b32 v13, v11
s_nop 0
v_permlane32_swap_b32 v12, v10
v_permlane32_swap_b32 v13, v11
v_max_f32 v10, v12, v10
v_max_f32 v11, v13, v11
v_ceil_f32 v10, v10
v_ceil_f32 v11, v11
v_max_f32 v10, 0, v10
v_max_f32 v11, 0, v11
v_sub_f32 v64, v64, v10
v_sub_f32 v65, v65, v10
v_sub_f32 v66, v66, v10
v_sub_f32 v67, v67, v10
v_sub_f32 v68, v68, v11
v_sub_f32 v69, v69, v11
v_sub_f32 v70, v70, v11
v_sub_f32 v71, v71, v11
v_sub_f32 v72, v72, v10
v_sub_f32 v73, v73, v10
v_sub_f32 v74, v74, v10
v_sub_f32 v75, v75, v10
v_sub_f32 v76, v76, v11
v_sub_f32 v77, v77, v11
v_sub_f32 v78, v78, v11
v_sub_f32 v79, v79, v11
v_sub_f32 v80, v80, v10
v_sub_f32 v81, v81, v10
v_sub_f32 v82, v82, v10
v_sub_f32 v83, v83, v10
v_sub_f32 v84, v84, v11
v_sub_f32 v85, v85, v11
v_sub_f32 v86, v86, v11
v_sub_f32 v87, v87, v11
v_sub_f32 v88, v88, v10
v_sub_f32 v89, v89, v10
v_sub_f32 v90, v90, v10
v_sub_f32 v91, v91, v10
v_sub_f32 v92, v92, v11
v_sub_f32 v93, v93, v11
v_sub_f32 v94, v94, v11
v_sub_f32 v95, v95, v11
v_sub_f32 v96, v96, v10
v_sub_f32 v97, v97, v10
v_sub_f32 v98, v98, v10
v_sub_f32 v99, v99, v10
v_sub_f32 v100, v100, v11
v_sub_f32 v101, v101, v11
v_sub_f32 v102, v102, v11
v_sub_f32 v103, v103, v11
v_sub_f32 v104, v104, v10
v_sub_f32 v105, v105, v10
v_sub_f32 v106, v106, v10
v_sub_f32 v107, v107, v10
v_sub_f32 v108, v108, v11
v_sub_f32 v109, v109, v11
v_sub_f32 v110, v110, v11
v_sub_f32 v111, v111, v11
v_sub_f32 v112, v112, v10
v_sub_f32 v113, v113, v10
v_sub_f32 v114, v114, v10
v_sub_f32 v115, v115, v10
v_sub_f32 v116, v116, v11
v_sub_f32 v117, v117, v11
v_sub_f32 v118, v118, v11
v_sub_f32 v119, v119, v11
v_sub_f32 v120, v120, v10
v_sub_f32 v121, v121, v10
v_sub_f32 v122, v122, v10
v_sub_f32 v123, v123, v10
v_sub_f32 v124, v124, v11
v_sub_f32 v125, v125, v11
v_sub_f32 v126, v126, v11
v_sub_f32 v127, v127, v11
v_sub_f32 v32, v32, v10
v_sub_f32 v33, v33, v10
v_sub_f32 v34, v34, v10
v_sub_f32 v35, v35, v10
v_sub_f32 v36, v36, v11
v_sub_f32 v37, v37, v11
v_sub_f32 v38, v38, v11
v_sub_f32 v39, v39, v11
E v12,-v10
E v13,-v11
MF v30,v12,v30
MF v31,v13,v31
MF v128,v12,v128
MF v129,v12,v129
MF v130,v12,v130
MF v131,v12,v131
MF v132,v13,v132
MF v133,v13,v133
MF v134,v13,v134
MF v135,v13,v135
MF v136,v12,v136
MF v137,v12,v137
MF v138,v12,v138
MF v139,v12,v139
MF v140,v13,v140
MF v141,v13,v141
MF v142,v13,v142
MF v143,v13,v143
MF v144,v12,v144
MF v145,v12,v145
MF v146,v12,v146
MF v147,v12,v147
MF v148,v13,v148
MF v149,v13,v149
MF v150,v13,v150
MF v151,v13,v151
MF v152,v12,v152
MF v153,v12,v153
MF v154,v12,v154
MF v155,v12,v155
MF v156,v13,v156
MF v157,v13,v157
MF v158,v13,v158
MF v159,v13,v159
MF v160,v12,v160
MF v161,v12,v161
MF v162,v12,v162
MF v163,v12,v163
MF v164,v13,v164
MF v165,v13,v165
MF v166,v13,v166
MF v167,v13,v167
MF v168,v12,v168
MF v169,v12,v169
MF v170,v12,v170
MF v171,v12,v171
MF v172,v13,v172
MF v173,v13,v173
MF v174,v13,v174
MF v175,v13,v175
MF v176,v12,v176
MF v177,v12,v177
MF v178,v12,v178
MF v179,v12,v179
MF v180,v13,v180
MF v181,v13,v181
MF v182,v13,v182
MF v183,v13,v183
MF v184,v12,v184
MF v185,v12,v185
MF v186,v12,v186
MF v187,v12,v187
MF v188,v13,v188
MF v189,v13,v189
MF v190,v13,v190
MF v191,v13,v191
MF v192,v12,v192
MF v193,v12,v193
MF v194,v12,v194
MF v195,v12,v195
MF v196,v13,v196
MF v197,v13,v197
MF v198,v13,v198
MF v199,v13,v199
MF v200,v12,v200
MF v201,v12,v201
MF v202,v12,v202
MF v203,v12,v203
MF v204,v13,v204
MF v205,v13,v205
MF v206,v13,v206
MF v207,v13,v207
MF v208,v12,v208
MF v209,v12,v209
MF v210,v12,v210
MF v211,v12,v211
MF v212,v13,v212
MF v213,v13,v213
MF v214,v13,v214
MF v215,v13,v215
MF v216,v12,v216
MF v217,v12,v217
MF v218,v12,v218
MF v219,v12,v219
MF v220,v13,v220
MF v221,v13,v221
MF v222,v13,v222
MF v223,v13,v223
MF v224,v12,v224
MF v225,v12,v225
MF v226,v12,v226
MF v227,v12,v227
MF v228,v13,v228
MF v229,v13,v229
MF v230,v13,v230
MF v231,v13,v231
MF v232,v12,v232
MF v233,v12,v233
MF v234,v12,v234
MF v235,v12,v235
MF v236,v13,v236
MF v237,v13,v237
MF v238,v13,v238
MF v239,v13,v239
MF v240,v12,v240
MF v241,v12,v241
MF v242,v12,v242
MF v243,v12,v243
MF v244,v13,v244
MF v245,v13,v245
MF v246,v13,v246
MF v247,v13,v247
MF v248,v12,v248
MF v249,v12,v249
MF v250,v12,v250
MF v251,v12,v251
MF v252,v13,v252
MF v253,v13,v253
MF v254,v13,v254
MF v255,v13,v255
E v18,v64
E v19,v65
E v20,v66
AF v26,v18,v19
C v40,v18,v19
E v21,v67
E v22,v72
AF v26,v20,v26
C v41,v20,v21
E v23,v73
AF v26,v21,v26
E v24,v74
AF v26,v22,v26
C v42,v22,v23
E v25,v75
AF v26,v23,v26
E v18,v68
AF v26,v24,v26
C v43,v24,v25
E v19,v69
AF v26,v25,v26
E v20,v70
AF v27,v18,v19
C v44,v18,v19
E v21,v71
E v22,v76
AF v27,v20,v27
C v45,v20,v21
E v23,v77
AF v27,v21,v27
E v24,v78
AF v27,v22,v27
C v46,v22,v23
E v25,v79
AF v27,v23,v27
AF v27,v24,v27
C v47,v24,v25
AF v27,v25,v27
E v18,v80
E v19,v81
E v20,v82
AF v26,v18,v26
C v56,v18,v19
E v21,v83
AF v26,v19,v26
E v22,v88
AF v26,v20,v26
C v57,v20,v21
E v23,v89
AF v26,v21,v26
E v24,v90
AF v26,v22,v26
C v58,v22,v23
E v25,v91
AF v26,v23,v26
E v18,v84
AF v26,v24,v26
C v59,v24,v25
E v19,v85
AF v26,v25,v26
E v20,v86
AF v27,v18,v27
C v60,v18,v19
E v21,v87
AF v27,v19,v27
E v22,v92
AF v27,v20,v27
C v61,v20,v21
E v23,v93
AF v27,v21,v27
E v24,v94
AF v27,v22,v27
C v62,v22,v23
E v25,v95
AF v27,v23,v27
AF v27,v24,v27
C v63,v24,v25
AF v27,v25,v27
s_nop 3
s_setpc_b64 s[36:37]
L_slow1:
s_nop 7
s_nop 3
v_max3_f32 v10, v96, v97, v98
v_max3_f32 v10, v99, v104, v10
v_max3_f32 v10, v105, v106, v10
v_max3_f32 v10, v107, v112, v10
v_max3_f32 v10, v113, v114, v10
v_max3_f32 v10, v115, v120, v10
v_max3_f32 v10, v121, v122, v10
v_max_f32 v10, v123, v10
v_max3_f32 v11, v100, v101, v102
v_max3_f32 v11, v103, v108, v11
v_max3_f32 v11, v109, v110, v11
v_max3_f32 v11, v111, v116, v11
v_max3_f32 v11, v117, v118, v11
v_max3_f32 v11, v119, v124, v11
v_max3_f32 v11, v125, v126, v11
v_max_f32 v11, v127, v11
v_mov_b32 v12, v10
v_mov_b32 v13, v11
s_nop 0
v_permlane16_swap_b32 v12, v10
v_permlane16_swap_b32 v13, v11
v_max_f32 v10, v12, v10
v_max_f32 v11, v13, v11
v_mov_b32 v12, v10
v_mov_b32 v13, v11
s_nop 0
v_permlane32_swap_b32 v12, v10
v_permlane32_swap_b32 v13, v11
v_max_f32 v10, v12, v10
v_max_f32 v11, v13, v11
v_ceil_f32 v10, v10
v_ceil_f32 v11, v11
v_max_f32 v10, 0, v10
v_max_f32 v11, 0, v11
v_sub_f32 v96, v96, v10
v_sub_f32 v97, v97, v10
v_sub_f32 v98, v98, v10
v_sub_f32 v99, v99, v10
v_sub_f32 v100, v100, v11
v_sub_f32 v101, v101, v11
v_sub_f32 v102, v102, v11
v_sub_f32 v103, v103, v11
v_sub_f32 v104, v104, v10
v_sub_f32 v105, v105, v10
v_sub_f32 v106, v106, v10
v_sub_f32 v107, v107, v10
v_sub_f32 v108, v108, v11
v_sub_f32 v109, v109, v11
v_sub_f32 v110, v110, v11
v_sub_f32 v111, v111, v11
v_sub_f32 v112, v112, v10
v_sub_f32 v113, v113, v10
v_sub_f32 v114, v114, v10
v_sub_f32 v115, v115, v10
v_sub_f32 v116, v116, v11
v_sub_f32 v117, v117, v11
v_sub_f32 v118, v118, v11
v_sub_f32 v119, v119, v11
v_sub_f32 v120, v120, v10
v_sub_f32 v121, v121, v10
v_sub_f32 v122, v122, v10
v_sub_f32 v123, v123, v10
v_sub_f32 v124, v124, v11
v_sub_f32 v125, v125, v11
v_sub_f32 v126, v126, v11
v_sub_f32 v127, v127, v11
v_sub_f32 v64, v64, v10
v_sub_f32 v65, v65, v10
v_sub_f32 v66, v66, v10
v_sub_f32 v67, v67, v10
v_sub_f32 v68, v68, v11
v_sub_f32 v69, v69, v11
v_sub_f32 v70, v70, v11
v_sub_f32 v71, v71, v11
v_sub_f32 v72, v72, v10
v_sub_f32 v73, v73, v10
v_sub_f32 v74, v74, v10
v_sub_f32 v75, v75, v10
v_sub_f32 v76, v76, v11
v_sub_f32 v77, v77, v11
v_sub_f32 v78, v78, v11
v_sub_f32 v79, v79, v11
v_sub_f32 v80, v80, v10
v_sub_f32 v81, v81, v10
v_sub_f32 v82, v82, v10
v_sub_f32 v83, v83, v10
v_sub_f32 v84, v84, v11
v_sub_f32 v85, v85, v11
v_sub_f32 v86, v86, v11
v_sub_f32 v87, v87, v11
v_sub_f32 v88, v88, v10
v_sub_f32 v89, v89, v10
v_sub_f32 v90, v90, v10
v_sub_f32 v91, v91, v10
v_sub_f32 v92, v92, v11
v_sub_f32 v93, v93, v11
v_sub_f32 v94, v94, v11
v_sub_f32 v95, v95, v11
v_sub_f32 v32, v32, v10
v_sub_f32 v33, v33, v10
v_sub_f32 v34, v34, v10
v_sub_f32 v35, v35, v10
v_sub_f32 v36, v36, v11
v_sub_f32 v37, v37, v11
v_sub_f32 v38, v38, v11
v_sub_f32 v39, v39, v11
E v12,-v10
E v13,-v11
MF v30,v12,v30
MF v31,v13,v31
MF v128,v12,v128
MF v129,v12,v129
MF v130,v12,v130
MF v131,v12,v131
MF v132,v13,v132
MF v133,v13,v133
MF v134,v13,v134
MF v135,v13,v135
MF v136,v12,v136
MF v137,v12,v137
MF v138,v12,v138
MF v139,v12,v139
MF v140,v13,v140
MF v141,v13,v141
MF v142,v13,v142
MF v143,v13,v143
MF v144,v12,v144
MF v145,v12,v145
MF v146,v12,v146
MF v147,v12,v147
MF v148,v13,v148
MF v149,v13,v149
MF v150,v13,v150
MF v151,v13,v151
MF v152,v12,v152
MF v153,v12,v153
MF v154,v12,v154
MF v155,v12,v155
MF v156,v13,v156
MF v157,v13,v157
MF v158,v13,v158
MF v159,v13,v159
MF v160,v12,v160
MF v161,v12,v161
MF v162,v12,v162
MF v163,v12,v163
MF v164,v13,v164
MF v165,v13,v165
MF v166,v13,v166
MF v167,v13,v167
MF v168,v12,v168
MF v169,v12,v169
MF v170,v12,v170
MF v171,v12,v171
MF v172,v13,v172
MF v173,v13,v173
MF v174,v13,v174
MF v175,v13,v175
MF v176,v12,v176
MF v177,v12,v177
MF v178,v12,v178
MF v179,v12,v179
MF v180,v13,v180
MF v181,v13,v181
MF v182,v13,v182
MF v183,v13,v183
MF v184,v12,v184
MF v185,v12,v185
MF v186,v12,v186
MF v187,v12,v187
MF v188,v13,v188
MF v189,v13,v189
MF v190,v13,v190
MF v191,v13,v191
MF v192,v12,v192
MF v193,v12,v193
MF v194,v12,v194
MF v195,v12,v195
MF v196,v13,v196
MF v197,v13,v197
MF v198,v13,v198
MF v199,v13,v199
MF v200,v12,v200
MF v201,v12,v201
MF v202,v12,v202
MF v203,v12,v203
MF v204,v13,v204
MF v205,v13,v205
MF v206,v13,v206
MF v207,v13,v207
MF v208,v12,v208
MF v209,v12,v209
MF v210,v12,v210
MF v211,v12,v211
MF v212,v13,v212
MF v213,v13,v213
MF v214,v13,v214
MF v215,v13,v215
MF v216,v12,v216
MF v217,v12,v217
MF v218,v12,v218
MF v219,v12,v219
MF v220,v13,v220
MF v221,v13,v221
MF v222,v13,v222
MF v223,v13,v223
MF v224,v12,v224
MF v225,v12,v225
MF v226,v12,v226
MF v227,v12,v227
MF v228,v13,v228
MF v229,v13,v229
MF v230,v13,v230
MF v231,v13,v231
MF v232,v12,v232
MF v233,v12,v233
MF v234,v12,v234
MF v235,v12,v235
MF v236,v13,v236
MF v237,v13,v237
MF v238,v13,v238
MF v239,v13,v239
MF v240,v12,v240
MF v241,v12,v241
MF v242,v12,v242
MF v243,v12,v243
MF v244,v13,v244
MF v245,v13,v245
MF v246,v13,v246
MF v247,v13,v247
MF v248,v12,v248
MF v249,v12,v249
MF v250,v12,v250
MF v251,v12,v251
MF v252,v13,v252
MF v253,v13,v253
MF v254,v13,v254
MF v255,v13,v255
E v18,v96
E v19,v97
E v20,v98
AF v28,v18,v19
C v48,v18,v19
E v21,v99
E v22,v104
AF v28,v20,v28
C v49,v20,v21
E v23,v105
AF v28,v21,v28
E v24,v106
AF v28,v22,v28
C v50,v22,v23
E v25,v107
AF v28,v23,v28
E v18,v100
AF v28,v24,v28
C v51,v24,v25
E v19,v101
AF v28,v25,v28
E v20,v102
AF v29,v18,v19
C v52,v18,v19
E v21,v103
E v22,v108
AF v29,v20,v29
C v53,v20,v21
E v23,v109
AF v29,v21,v29
E v24,v110
AF v29,v22,v29
C v54,v22,v23
E v25,v111
AF v29,v23,v29
AF v29,v24,v29
C v55,v24,v25
AF v29,v25,v29
E v18,v112
E v19,v113
E v20,v114
AF v28,v18,v28
C v56,v18,v19
E v21,v115
AF v28,v19,v28
E v22,v120
AF v28,v20,v28
C v57,v20,v21
E v23,v121
AF v28,v21,v28
E v24,v122
AF v28,v22,v28
C v58,v22,v23
E v25,v123
AF v28,v23,v28
E v18,v116
AF v28,v24,v28
C v59,v24,v25
E v19,v117
AF v28,v25,v28
E v20,v118
AF v29,v18,v29
C v60,v18,v19
E v21,v119
AF v29,v19,v29
E v22,v124
AF v29,v20,v29
C v61,v20,v21
E v23,v125
AF v29,v21,v29
E v24,v126
AF v29,v22,v29
C v62,v22,v23
E v25,v127
AF v29,v23,v29
AF v29,v24,v29
C v63,v24,v25
AF v29,v25,v29
s_nop 3
s_setpc_b64 s[36:37]
L_slow1n:
s_nop 7
s_nop 3
v_max3_f32 v10, v96, v97, v98
v_max3_f32 v10, v99, v104, v10
v_max3_f32 v10, v105, v106, v10
v_max3_f32 v10, v107, v112, v10
v_max3_f32 v10, v113, v114, v10
v_max3_f32 v10, v115, v120, v10
v_max3_f32 v10, v121, v122, v10
v_max_f32 v10, v123, v10
v_max3_f32 v11, v100, v101, v102
v_max3_f32 v11, v103, v108, v11
v_max3_f32 v11, v109, v110, v11
v_max3_f32 v11, v111, v116, v11
v_max3_f32 v11, v117, v118, v11
v_max3_f32 v11, v119, v124, v11
v_max3_f32 v11, v125, v126, v11
v_max_f32 v11, v127, v11
v_mov_b32 v12, v10
v_mov_b32 v13, v11
s_nop 0
v_permlane16_swap_b32 v12, v10
v_permlane16_swap_b32 v13, v11
v_max_f32 v10, v12, v10
v_max_f32 v11, v13, v11
v_mov_b32 v12, v10
v_mov_b32 v13, v11
s_nop 0
v_permlane32_swap_b32 v12, v10
v_permlane32_swap_b32 v13, v11
v_max_f32 v10, v12, v10
v_max_f32 v11, v13, v11
v_ceil_f32 v10, v10
v_ceil_f32 v11, v11
v_max_f32 v10, 0, v10
v_max_f32 v11, 0, v11
v_sub_f32 v96, v96, v10
v_sub_f32 v97, v97, v10
v_sub_f32 v98, v98, v10
v_sub_f32 v99, v99, v10
v_sub_f32 v100, v100, v11
v_sub_f32 v101, v101, v11
v_sub_f32 v102, v102, v11
v_sub_f32 v103, v103, v11
v_sub_f32 v104, v104, v10
v_sub_f32 v105, v105, v10
v_sub_f32 v106, v106, v10
v_sub_f32 v107, v107, v10
v_sub_f32 v108, v108, v11
v_sub_f32 v109, v109, v11
v_sub_f32 v110, v110, v11
v_sub_f32 v111, v111, v11
v_sub_f32 v112, v112, v10
v_sub_f32 v113, v113, v10
v_sub_f32 v114, v114, v10
v_sub_f32 v115, v115, v10
v_sub_f32 v116, v116, v11
v_sub_f32 v117, v117, v11
v_sub_f32 v118, v118, v11
v_sub_f32 v119, v119, v11
v_sub_f32 v120, v120, v10
v_sub_f32 v121, v121, v10
v_sub_f32 v122, v122, v10
v_sub_f32 v123, v123, v10
v_sub_f32 v124, v124, v11
v_sub_f32 v125, v125, v11
v_sub_f32 v126, v126, v11
v_sub_f32 v127, v127, v11
v_sub_f32 v32, v32, v10
v_sub_f32 v33, v33, v10
v_sub_f32 v34, v34, v10
v_sub_f32 v35, v35, v10
v_sub_f32 v36, v36, v11
v_sub_f32 v37, v37, v11
v_sub_f32 v38, v38, v11
v_sub_f32 v39, v39, v11
E v12,-v10
E v13,-v11
MF v30,v12,v30
MF v31,v13,v31
MF v128,v12,v128
MF v129,v12,v129
MF v130,v12,v130
MF v131,v12,v131
MF v132,v13,v132
MF v133,v13,v133
MF v134,v13,v134
MF v135,v13,v135
MF v136,v12,v136
MF v137,v12,v137
MF v138,v12,v138
MF v139,v12,v139
MF v140,v13,v140
MF v141,v13,v141
MF v142,v13,v142
MF v143,v13,v143
MF v144,v12,v144
MF v145,v12,v145
MF v146,v12,v146
MF v147,v12,v147
MF v148,v13,v148
MF v149,v13,v149
MF v150,v13,v150
MF v151,v13,v151
MF v152,v12,v152
MF v153,v12,v153
MF v154,v12,v154
MF v155,v12,v155
MF v156,v13,v156
MF v157,v13,v157
MF v158,v13,v158
MF v159,v13,v159
MF v160,v12,v160
MF v161,v12,v161
MF v162,v12,v162
MF v163,v12,v163
MF v164,v13,v164
MF v165,v13,v165
MF v166,v13,v166
MF v167,v13,v167
MF v168,v12,v168
MF v169,v12,v169
MF v170,v12,v170
MF v171,v12,v171
MF v172,v13,v172
MF v173,v13,v173
MF v174,v13,v174
MF v175,v13,v175
MF v176,v12,v176
MF v177,v12,v177
MF v178,v12,v178
MF v179,v12,v179
MF v180,v13,v180
MF v181,v13,v181
MF v182,v13,v182
MF v183,v13,v183
MF v184,v12,v184
MF v185,v12,v185
MF v186,v12,v186
MF v187,v12,v187
MF v188,v13,v188
MF v189,v13,v189
MF v190,v13,v190
MF v191,v13,v191
MF v192,v12,v192
MF v193,v12,v193
MF v194,v12,v194
MF v195,v12,v195
MF v196,v13,v196
MF v197,v13,v197
MF v198,v13,v198
MF v199,v13,v199
MF v200,v12,v200
MF v201,v12,v201
MF v202,v12,v202
MF v203,v12,v203
MF v204,v13,v204
MF v205,v13,v205
MF v206,v13,v206
MF v207,v13,v207
MF v208,v12,v208
MF v209,v12,v209
MF v210,v12,v210
MF v211,v12,v211
MF v212,v13,v212
MF v213,v13,v213
MF v214,v13,v214
MF v215,v13,v215
MF v216,v12,v216
MF v217,v12,v217
MF v218,v12,v218
MF v219,v12,v219
MF v220,v13,v220
MF v221,v13,v221
MF v222,v13,v222
MF v223,v13,v223
MF v224,v12,v224
MF v225,v12,v225
MF v226,v12,v226
MF v227,v12,v227
MF v228,v13,v228
MF v229,v13,v229
MF v230,v13,v230
MF v231,v13,v231
MF v232,v12,v232
MF v233,v12,v233
MF v234,v12,v234
MF v235,v12,v235
MF v236,v13,v236
MF v237,v13,v237
MF v238,v13,v238
MF v239,v13,v239
MF v240,v12,v240
MF v241,v12,v241
MF v242,v12,v242
MF v243,v12,v243
MF v244,v13,v244
MF v245,v13,v245
MF v246,v13,v246
MF v247,v13,v247
MF v248,v12,v248
MF v249,v12,v249
MF v250,v12,v250
MF v251,v12,v251
MF v252,v13,v252
MF v253,v13,v253
MF v254,v13,v254
MF v255,v13,v255
E v18,v96
E v19,v97
E v20,v98
AF v28,v18,v19
C v48,v18,v19
E v21,v99
E v22,v104
AF v28,v20,v28
C v49,v20,v21
E v23,v105
AF v28,v21,v28
E v24,v106
AF v28,v22,v28
C v50,v22,v23
E v25,v107
AF v28,v23,v28
E v18,v100
AF v28,v24,v28
C v51,v24,v25
E v19,v101
AF v28,v25,v28
E v20,v102
AF v29,v18,v19
C v52,v18,v19
E v21,v103
E v22,v108
AF v29,v20,v29
C v53,v20,v21
E v23,v109
AF v29,v21,v29
E v24,v110
AF v29,v22,v29
C v54,v22,v23
E v25,v111
AF v29,v23,v29
AF v29,v24,v29
C v55,v24,v25
AF v29,v25,v29
E v18,v112
E v19,v113
E v20,v114
AF v28,v18,v28
C v56,v18,v19
E v21,v115
AF v28,v19,v28
E v22,v120
AF v28,v20,v28
C v57,v20,v21
E v23,v121
AF v28,v21,v28
E v24,v122
AF v28,v22,v28
C v58,v22,v23
E v25,v123
AF v28,v23,v28
E v18,v116
AF v28,v24,v28
C v59,v24,v25
E v19,v117
AF v28,v25,v28
E v20,v118
AF v29,v18,v29
C v60,v18,v19
E v21,v119
AF v29,v19,v29
E v22,v124
AF v29,v20,v29
C v61,v20,v21
E v23,v125
AF v29,v21,v29
E v24,v126
AF v29,v22,v29
C v62,v22,v23
E v25,v127
AF v29,v23,v29
AF v29,v24,v29
C v63,v24,v25
AF v29,v25,v29
s_nop 3
s_setpc_b64 s[36:37]
L_slowf:
s_nop 7
s_nop 3
v_max3_f32 v10, v64, v65, v66
v_max3_f32 v10, v67, v72, v10
v_max3_f32 v10, v73, v74, v10
v_max3_f32 v10, v75, v80, v10
v_max3_f32 v10, v81, v82, v10
v_max3_f32 v10, v83, v88, v10
v_max3_f32 v10, v89, v90, v10
v_max_f32 v10, v91, v10
v_max3_f32 v11, v68, v69, v70
v_max3_f32 v11, v71, v76, v11
v_max3_f32 v11, v77, v78, v11
v_max3_f32 v11, v79, v84, v11
v_max3_f32 v11, v85, v86, v11
v_max3_f32 v11, v87, v92, v11
v_max3_f32 v11, v93, v94, v11
v_max_f32 v11, v95, v11
v_mov_b32 v12, v10
v_mov_b32 v13, v11
s_nop 0
v_permlane16_swap_b32 v12, v10
v_permlane16_swap_b32 v13, v11
v_max_f32 v10, v12, v10
v_max_f32 v11, v13, v11
v_mov_b32 v12, v10
v_mov_b32 v13, v11
s_nop 0
v_permlane32_swap_b32 v12, v10
v_permlane32_swap_b32 v13, v11
v_max_f32 v10, v12, v10
v_max_f32 v11, v13, v11
v_ceil_f32 v10, v10
v_ceil_f32 v11, v11
v_sub_f32 v64, v64, v10
v_sub_f32 v65, v65, v10
v_sub_f32 v66, v66, v10
v_sub_f32 v67, v67, v10
v_sub_f32 v68, v68, v11
v_sub_f32 v69, v69, v11
v_sub_f32 v70, v70, v11
v_sub_f32 v71, v71, v11
v_sub_f32 v72, v72, v10
v_sub_f32 v73, v73, v10
v_sub_f32 v74, v74, v10
v_sub_f32 v75, v75, v10
v_sub_f32 v76, v76, v11
v_sub_f32 v77, v77, v11
v_sub_f32 v78, v78, v11
v_sub_f32 v79, v79, v11
v_sub_f32 v80, v80, v10
v_sub_f32 v81, v81, v10
v_sub_f32 v82, v82, v10
v_sub_f32 v83, v83, v10
v_sub_f32 v84, v84, v11
v_sub_f32 v85, v85, v11
v_sub_f32 v86, v86, v11
v_sub_f32 v87, v87, v11
v_sub_f32 v88, v88, v10
v_sub_f32 v89, v89, v10
v_sub_f32 v90, v90, v10
v_sub_f32 v91, v91, v10
v_sub_f32 v92, v92, v11
v_sub_f32 v93, v93, v11
v_sub_f32 v94, v94, v11
v_sub_f32 v95, v95, v11
v_sub_f32 v96, v96, v10
v_sub_f32 v97, v97, v10
v_sub_f32 v98, v98, v10
v_sub_f32 v99, v99, v10
v_sub_f32 v100, v100, v11
v_sub_f32 v101, v101, v11
v_sub_f32 v102, v102, v11
v_sub_f32 v103, v103, v11
v_sub_f32 v104, v104, v10
v_sub_f32 v105, v105, v10
v_sub_f32 v106, v106, v10
v_sub_f32 v107, v107, v10
v_sub_f32 v108, v108, v11
v_sub_f32 v109, v109, v11
v_sub_f32 v110, v110, v11
v_sub_f32 v111, v111, v11
v_sub_f32 v112, v112, v10
v_sub_f32 v113, v113, v10
v_sub_f32 v114, v114, v10
v_sub_f32 v115, v115, v10
v_sub_f32 v116, v116, v11
v_sub_f32 v117, v117, v11
v_sub_f32 v118, v118, v11
v_sub_f32 v119, v119, v11
v_sub_f32 v120, v120, v10
v_sub_f32 v121, v121, v10
v_sub_f32 v122, v122, v10
v_sub_f32 v123, v123, v10
v_sub_f32 v124, v124, v11
v_sub_f32 v125, v125, v11
v_sub_f32 v126, v126, v11
v_sub_f32 v127, v127, v11
v_sub_f32 v32, v32, v10
v_sub_f32 v33, v33, v10
v_sub_f32 v34, v34, v10
v_sub_f32 v35, v35, v10
v_sub_f32 v36, v36, v11
v_sub_f32 v37, v37, v11
v_sub_f32 v38, v38, v11
v_sub_f32 v39, v39, v11
E v18,v64
E v19,v65
E v20,v66
AF v26,v18,v19
C v40,v18,v19
E v21,v67
E v22,v72
AF v26,v20,v26
C v41,v20,v21
E v23,v73
AF v26,v21,v26
E v24,v74
AF v26,v22,v26
C v42,v22,v23
E v25,v75
AF v26,v23,v26
E v18,v68
AF v26,v24,v26
C v43,v24,v25
E v19,v69
AF v26,v25,v26
E v20,v70
AF v27,v18,v19
C v44,v18,v19
E v21,v71
E v22,v76
AF v27,v20,v27
C v45,v20,v21
E v23,v77
AF v27,v21,v27
E v24,v78
AF v27,v22,v27
C v46,v22,v23
E v25,v79
AF v27,v23,v27
AF v27,v24,v27
C v47,v24,v25
AF v27,v25,v27
E v18,v80
E v19,v81
E v20,v82
AF v26,v18,v26
C v56,v18,v19
E v21,v83
AF v26,v19,v26
E v22,v88
AF v26,v20,v26
C v57,v20,v21
E v23,v89
AF v26,v21,v26
E v24,v90
AF v26,v22,v26
C v58,v22,v23
E v25,v91
AF v26,v23,v26
E v18,v84
AF v26,v24,v26
C v59,v24,v25
E v19,v85
AF v26,v25,v26
E v20,v86
AF v27,v18,v27
C v60,v18,v19
E v21,v87
AF v27,v19,v27
E v22,v92
AF v27,v20,v27
C v61,v20,v21
E v23,v93
AF v27,v21,v27
E v24,v94
AF v27,v22,v27
C v62,v22,v23
E v25,v95
AF v27,v23,v27
AF v27,v24,v27
C v63,v24,v25
AF v27,v25,v27
s_nop 3
s_setpc_b64 s[36:37]
L_slowj:
s_nop 7
s_nop 3
v_max3_f32 v10, v64, v65, v66
v_max3_f32 v10, v67, v72, v10
v_max3_f32 v10, v73, v74, v10
v_max3_f32 v10, v75, v80, v10
v_max3_f32 v10, v81, v82, v10
v_max3_f32 v10, v83, v88, v10
v_max3_f32 v10, v89, v90, v10
v_max_f32 v10, v91, v10
v_max3_f32 v11, v68, v69, v70
v_max3_f32 v11, v71, v76, v11
v_max3_f32 v11, v77, v78, v11
v_max3_f32 v11, v79, v84, v11
v_max3_f32 v11, v85, v86, v11
v_max3_f32 v11, v87, v92, v11
v_max3_f32 v11, v93, v94, v11
v_max_f32 v11, v95, v11
v_mov_b32 v12, v10
v_mov_b32 v13, v11
s_nop 0
v_permlane16_swap_b32 v12, v10
v_permlane16_swap_b32 v13, v11
v_max_f32 v10, v12, v10
v_max_f32 v11, v13, v11
v_mov_b32 v12, v10
v_mov_b32 v13, v11
s_nop 0
v_permlane32_swap_b32 v12, v10
v_permlane32_swap_b32 v13, v11
v_max_f32 v10, v12, v10
v_max_f32 v11, v13, v11
v_ceil_f32 v10, v10
v_ceil_f32 v11, v11
v_sub_f32 v64, v64, v10
v_sub_f32 v65, v65, v10
v_sub_f32 v66, v66, v10
v_sub_f32 v67, v67, v10
v_sub_f32 v68, v68, v11
v_sub_f32 v69, v69, v11
v_sub_f32 v70, v70, v11
v_sub_f32 v71, v71, v11
v_sub_f32 v72, v72, v10
v_sub_f32 v73, v73, v10
v_sub_f32 v74, v74, v10
v_sub_f32 v75, v75, v10
v_sub_f32 v76, v76, v11
v_sub_f32 v77, v77, v11
v_sub_f32 v78, v78, v11
v_sub_f32 v79, v79, v11
v_sub_f32 v80, v80, v10
v_sub_f32 v81, v81, v10
v_sub_f32 v82, v82, v10
v_sub_f32 v83, v83, v10
v_sub_f32 v84, v84, v11
v_sub_f32 v85, v85, v11
v_sub_f32 v86, v86, v11
v_sub_f32 v87, v87, v11
v_sub_f32 v88, v88, v10
v_sub_f32 v89, v89, v10
v_sub_f32 v90, v90, v10
v_sub_f32 v91, v91, v10
v_sub_f32 v92, v92, v11
v_sub_f32 v93, v93, v11
v_sub_f32 v94, v94, v11
v_sub_f32 v95, v95, v11
v_sub_f32 v32, v32, v10
v_sub_f32 v33, v33, v10
v_sub_f32 v34, v34, v10
v_sub_f32 v35, v35, v10
v_sub_f32 v36, v36, v11
v_sub_f32 v37, v37, v11
v_sub_f32 v38, v38, v11
v_sub_f32 v39, v39, v11
E v18,v64
E v19,v65
E v20,v66
AF v26,v18,v19
C v40,v18,v19
E v21,v67
E v22,v72
AF v26,v20,v26
C v41,v20,v21
E v23,v73
AF v26,v21,v26
E v24,v74
AF v26,v22,v26
C v42,v22,v23
E v25,v75
AF v26,v23,v26
E v18,v68
AF v26,v24,v26
C v43,v24,v25
E v19,v69
AF v26,v25,v26
E v20,v70
AF v27,v18,v19
C v44,v18,v19
E v21,v71
E v22,v76
AF v27,v20,v27
C v45,v20,v21
E v23,v77
AF v27,v21,v27
E v24,v78
AF v27,v22,v27
C v46,v22,v23
E v25,v79
AF v27,v23,v27
AF v27,v24,v27
C v47,v24,v25
AF v27,v25,v27
s_nop 3
s_setpc_b64 s[36:37]
L_slowb:
s_nop 7
s_nop 3
v_max3_f32 v11, v100, v101, v102
v_max3_f32 v11, v103, v108, v11
v_max3_f32 v11, v109, v110, v11
v_max3_f32 v11, v111, v116, v11
v_max3_f32 v11, v117, v118, v11
v_max3_f32 v11, v119, v124, v11
v_max3_f32 v11, v125, v126, v11
v_max_f32 v11, v127, v11
v_mov_b32 v13, v11
s_nop 1
v_permlane16_swap_b32 v13, v11
v_max_f32 v11, v13, v11
v_mov_b32 v13, v11
s_nop 1
v_permlane32_swap_b32 v13, v11
v_max_f32 v11, v13, v11
v_ceil_f32 v11, v11
v_max_f32 v11, 0, v11
v_mov_b32 v10, 0
v_sub_f32 v100, v100, v11
v_sub_f32 v101, v101, v11
v_sub_f32 v102, v102, v11
v_sub_f32 v103, v103, v11
v_sub_f32 v108, v108, v11
v_sub_f32 v109, v109, v11
v_sub_f32 v110, v110, v11
v_sub_f32 v111, v111, v11
v_sub_f32 v116, v116, v11
v_sub_f32 v117, v117, v11
v_sub_f32 v118, v118, v11
v_sub_f32 v119, v119, v11
v_sub_f32 v124, v124, v11
v_sub_f32 v125, v125, v11
v_sub_f32 v126, v126, v11
v_sub_f32 v127, v127, v11
v_sub_f32 v32, v32, v10
v_sub_f32 v33, v33, v10
v_sub_f32 v34, v34, v10
v_sub_f32 v35, v35, v10
v_sub_f32 v36, v36, v11
v_sub_f32 v37, v37, v11
v_sub_f32 v38, v38, v11
v_sub_f32 v39, v39, v11
E v12,-v10
E v13,-v11
MF v30,v12,v30
MF v31,v13,v31
MF v128,v12,v128
MF v129,v12,v129
MF v130,v12,v130
MF v131,v12,v131
MF v132,v13,v132
MF v133,v13,v133
MF v134,v13,v134
MF v135,v13,v135
MF v136,v12,v136
MF v137,v12,v137
MF v138,v12,v138
MF v139,v12,v139
MF v140,v13,v140
MF v141,v13,v141
MF v142,v13,v142
MF v143,v13,v143
MF v144,v12,v144
MF v145,v12,v145
MF v146,v12,v146
MF v147,v12,v147
MF v148,v13,v148
MF v149,v13,v149
MF v150,v13,v150
MF v151,v13,v151
MF v152,v12,v152
MF v153,v12,v153
MF v154,v12,v154
MF v155,v12,v155
MF v156,v13,v156
MF v157,v13,v157
MF v158,v13,v158
MF v159,v13,v159
MF v160,v12,v160
MF v161,v12,v161
MF v162,v12,v162
MF v163,v12,v163
MF v164,v13,v164
MF v165,v13,v165
MF v166,v13,v166
MF v167,v13,v167
MF v168,v12,v168
MF v169,v12,v169
MF v170,v12,v170
MF v171,v12,v171
MF v172,v13,v172
MF v173,v13,v173
MF v174,v13,v174
MF v175,v13,v175
MF v176,v12,v176
MF v177,v12,v177
MF v178,v12,v178
MF v179,v12,v179
MF v180,v13,v180
MF v181,v13,v181
MF v182,v13,v182
MF v183,v13,v183
MF v184,v12,v184
MF v185,v12,v185
MF v186,v12,v186
MF v187,v12,v187
MF v188,v13,v188
MF v189,v13,v189
MF v190,v13,v190
MF v191,v13,v191
MF v192,v12,v192
MF v193,v12,v193
MF v194,v12,v194
MF v195,v12,v195
MF v196,v13,v196
MF v197,v13,v197
MF v198,v13,v198
MF v199,v13,v199
MF v200,v12,v200
MF v201,v12,v201
MF v202,v12,v202
MF v203,v12,v203
MF v204,v13,v204
MF v205,v13,v205
MF v206,v13,v206
MF v207,v13,v207
MF v208,v12,v208
MF v209,v12,v209
MF v210,v12,v210
MF v211,v12,v211
MF v212,v13,v212
MF v213,v13,v213
MF v214,v13,v214
MF v215,v13,v215
MF v216,v12,v216
MF v217,v12,v217
MF v218,v12,v218
MF v219,v12,v219
MF v220,v13,v220
MF v221,v13,v221
MF v222,v13,v222
MF v223,v13,v223
MF v224,v12,v224
MF v225,v12,v225
MF v226,v12,v226
MF v227,v12,v227
MF v228,v13,v228
MF v229,v13,v229
MF v230,v13,v230
MF v231,v13,v231
MF v232,v12,v232
MF v233,v12,v233
MF v234,v12,v234
MF v235,v12,v235
MF v236,v13,v236
MF v237,v13,v237
MF v238,v13,v238
MF v239,v13,v239
MF v240,v12,v240
MF v241,v12,v241
MF v242,v12,v242
MF v243,v12,v243
MF v244,v13,v244
MF v245,v13,v245
MF v246,v13,v246
MF v247,v13,v247
MF v248,v12,v248
MF v249,v12,v249
MF v250,v12,v250
MF v251,v12,v251
MF v252,v13,v252
MF v253,v13,v253
MF v254,v13,v254
MF v255,v13,v255
E v18,v100
E v19,v101
E v20,v102
AF v29,v18,v19
C v52,v18,v19
E v21,v103
E v22,v108
AF v29,v20,v29
C v53,v20,v21
E v23,v109
AF v29,v21,v29
E v24,v110
AF v29,v22,v29
C v54,v22,v23
E v25,v111
AF v29,v23,v29
E v18,v116
AF v29,v24,v29
C v55,v24,v25
E v19,v117
AF v29,v25,v29
E v20,v118
AF v29,v18,v29
C v48,v18,v19
E v21,v119
AF v29,v19,v29
E v22,v124
AF v29,v20,v29
C v49,v20,v21
E v23,v125
AF v29,v21,v29
E v24,v126
AF v29,v22,v29
C v50,v22,v23
E v25,v127
AF v29,v23,v29
AF v29,v24,v29
C v51,v24,v25
AF v29,v25,v29
s_nop 3
s_setpc_b64 s[36:37]
L_comb:
s_waitcnt vmcnt(0)
s_nop 7
v_sub_f32 v10, v32, v14
v_sub_f32 v11, v36, v15
v_max_f32 v10, 0, v10
v_max_f32 v11, 0, v11
v_sub_f32 v100, v100, v11
v_sub_f32 v101, v101, v11
v_sub_f32 v102, v102, v11
v_sub_f32 v103, v103, v11
v_sub_f32 v108, v108, v11
v_sub_f32 v109, v109, v11
v_sub_f32 v110, v110, v11
v_sub_f32 v111, v111, v11
v_sub_f32 v116, v116, v11
v_sub_f32 v117, v117, v11
v_sub_f32 v118, v118, v11
v_sub_f32 v119, v119, v11
v_sub_f32 v124, v124, v11
v_sub_f32 v125, v125, v11
v_sub_f32 v126, v126, v11
v_sub_f32 v127, v127, v11
v_sub_f32 v32, v32, v10
v_sub_f32 v33, v33, v10
v_sub_f32 v34, v34, v10
v_sub_f32 v35, v35, v10
v_sub_f32 v36, v36, v11
v_sub_f32 v37, v37, v11
v_sub_f32 v38, v38, v11
v_sub_f32 v39, v39, v11
E v12,-v10
E v13,-v11
MF v30,v12,v30
MF v31,v13,v31
MF v128,v12,v128
MF v129,v12,v129
MF v130,v12,v130
MF v131,v12,v131
MF v132,v13,v132
MF v133,v13,v133
MF v134,v13,v134
MF v135,v13,v135
MF v136,v12,v136
MF v137,v12,v137
MF v138,v12,v138
MF v139,v12,v139
MF v140,v13,v140
MF v141,v13,v141
MF v142,v13,v142
MF v143,v13,v143
MF v144,v12,v144
MF v145,v12,v145
MF v146,v12,v146
MF v147,v12,v147
MF v148,v13,v148
MF v149,v13,v149
MF v150,v13,v150
MF v151,v13,v151
MF v152,v12,v152
MF v153,v12,v153
MF v154,v12,v154
MF v155,v12,v155
MF v156,v13,v156
MF v157,v13,v157
MF v158,v13,v158
MF v159,v13,v159
MF v160,v12,v160
MF v161,v12,v161
MF v162,v12,v162
MF v163,v12,v163
MF v164,v13,v164
MF v165,v13,v165
MF v166,v13,v166
MF v167,v13,v167
MF v168,v12,v168
MF v169,v12,v169
MF v170,v12,v170
MF v171,v12,v171
MF v172,v13,v172
MF v173,v13,v173
MF v174,v13,v174
MF v175,v13,v175
MF v176,v12,v176
MF v177,v12,v177
MF v178,v12,v178
MF v179,v12,v179
MF v180,v13,v180
MF v181,v13,v181
MF v182,v13,v182
MF v183,v13,v183
MF v184,v12,v184
MF v185,v12,v185
MF v186,v12,v186
MF v187,v12,v187
MF v188,v13,v188
MF v189,v13,v189
MF v190,v13,v190
MF v191,v13,v191
MF v192,v12,v192
MF v193,v12,v193
MF v194,v12,v194
MF v195,v12,v195
MF v196,v13,v196
MF v197,v13,v197
MF v198,v13,v198
MF v199,v13,v199
MF v200,v12,v200
MF v201,v12,v201
MF v202,v12,v202
MF v203,v12,v203
MF v204,v13,v204
MF v205,v13,v205
MF v206,v13,v206
MF v207,v13,v207
MF v208,v12,v208
MF v209,v12,v209
MF v210,v12,v210
MF v211,v12,v211
MF v212,v13,v212
MF v213,v13,v213
MF v214,v13,v214
MF v215,v13,v215
MF v216,v12,v216
MF v217,v12,v217
MF v218,v12,v218
MF v219,v12,v219
MF v220,v13,v220
MF v221,v13,v221
MF v222,v13,v222
MF v223,v13,v223
MF v224,v12,v224
MF v225,v12,v225
MF v226,v12,v226
MF v227,v12,v227
MF v228,v13,v228
MF v229,v13,v229
MF v230,v13,v230
MF v231,v13,v231
MF v232,v12,v232
MF v233,v12,v233
MF v234,v12,v234
MF v235,v12,v235
MF v236,v13,v236
MF v237,v13,v237
MF v238,v13,v238
MF v239,v13,v239
MF v240,v12,v240
MF v241,v12,v241
MF v242,v12,v242
MF v243,v12,v243
MF v244,v13,v244
MF v245,v13,v245
MF v246,v13,v246
MF v247,v13,v247
MF v248,v12,v248
MF v249,v12,v249
MF v250,v12,v250
MF v251,v12,v251
MF v252,v13,v252
MF v253,v13,v253
MF v254,v13,v254
MF v255,v13,v255
E v18,v100
E v19,v101
E v20,v102
AF v29,v18,v19
C v52,v18,v19
E v21,v103
E v22,v108
AF v29,v20,v29
C v53,v20,v21
E v23,v109
AF v29,v21,v29
E v24,v110
AF v29,v22,v29
C v54,v22,v23
E v25,v111
AF v29,v23,v29
E v18,v116
AF v29,v24,v29
C v55,v24,v25
E v19,v117
AF v29,v25,v29
E v20,v118
AF v29,v18,v29
C v48,v18,v19
E v21,v119
AF v29,v19,v29
E v22,v124
AF v29,v20,v29
C v49,v20,v21
E v23,v125
AF v29,v21,v29
E v24,v126
AF v29,v22,v29
C v50,v22,v23
E v25,v127
AF v29,v23,v29
AF v29,v24,v29
C v51,v24,v25
AF v29,v25,v29
v_sub_f32 v10, v32, v14
v_sub_f32 v11, v36, v15
E v10,v10
E v11,v11
s_nop 0
MF v16,v10,v16
MF v17,v11,v17
G v64,a128
v_and_b32 v65, 0xffff0000, v64
v_lshlrev_b32 v64, 16, v64
MF v64,v10,v64
MF v65,v10,v65
C v64,v64,v65
W a128,v64
G v66,a129
v_and_b32 v67, 0xffff0000, v66
v_lshlrev_b32 v66, 16, v66
MF v66,v10,v66
MF v67,v10,v67
C v66,v66,v67
W a129,v66
G v68,a130
v_and_b32 v69, 0xffff0000, v68
v_lshlrev_b32 v68, 16, v68
MF v68,v10,v68
MF v69,v10,v69
C v68,v68,v69
W a130,v68
G v70,a131
v_and_b32 v71, 0xffff0000, v70
v_lshlrev_b32 v70, 16, v70
MF v70,v10,v70
MF v71,v10,v71
C v70,v70,v71
W a131,v70
G v72,a132
v_and_b32 v73, 0xffff0000, v72
v_lshlrev_b32 v72, 16, v72
MF v72,v10,v72
MF v73,v10,v73
C v72,v72,v73
W a132,v72
G v74,a133
v_and_b32 v75, 0xffff0000, v74
v_lshlrev_b32 v74, 16, v74
MF v74,v10,v74
MF v75,v10,v75
C v74,v74,v75
W a133,v74
G v76,a134
v_and_b32 v77, 0xffff0000, v76
v_lshlrev_b32 v76, 16, v76
MF v76,v10,v76
MF v77,v10,v77
C v76,v76,v77
W a134,v76
G v78,a135
v_and_b32 v79, 0xffff0000, v78
v_lshlrev_b32 v78, 16, v78
MF v78,v10,v78
MF v79,v10,v79
C v78,v78,v79
W a135,v78
G v64,a136
v_and_b32 v65, 0xffff0000, v64
v_lshlrev_b32 v64, 16, v64
MF v64,v10,v64
MF v65,v10,v65
C v64,v64,v65
W a136,v64
G v66,a137
v_and_b32 v67, 0xffff0000, v66
v_lshlrev_b32 v66, 16, v66
MF v66,v10,v66
MF v67,v10,v67
C v66,v66,v67
W a137,v66
G v68,a138
v_and_b32 v69, 0xffff0000, v68
v_lshlrev_b32 v68, 16, v68
MF v68,v10,v68
MF v69,v10,v69
C v68,v68,v69
W a138,v68
G v70,a139
v_and_b32 v71, 0xffff0000, v70
v_lshlrev_b32 v70, 16, v70
MF v70,v10,v70
MF v71,v10,v71
C v70,v70,v71
W a139,v70
G v72,a140
v_and_b32 v73, 0xffff0000, v72
v_lshlrev_b32 v72, 16, v72
MF v72,v10,v72
MF v73,v10,v73
C v72,v72,v73
W a140,v72
G v74,a141
v_and_b32 v75, 0xffff0000, v74
v_lshlrev_b32 v74, 16, v74
MF v74,v10,v74
MF v75,v10,v75
C v74,v74,v75
W a141,v74
G v76,a142
v_and_b32 v77, 0xffff0000, v76
v_lshlrev_b32 v76, 16, v76
MF v76,v10,v76
MF v77,v10,v77
C v76,v76,v77
W a142,v76
G v78,a143
v_and_b32 v79, 0xffff0000, v78
v_lshlrev_b32 v78, 16, v78
MF v78,v10,v78
MF v79,v10,v79
C v78,v78,v79
W a143,v78
G v64,a144
v_and_b32 v65, 0xffff0000, v64
v_lshlrev_b32 v64, 16, v64
MF v64,v10,v64
MF v65,v10,v65
C v64,v64,v65
W a144,v64
G v66,a145
v_and_b32 v67, 0xffff0000, v66
v_lshlrev_b32 v66, 16, v66
MF v66,v10,v66
MF v67,v10,v67
C v66,v66,v67
W a145,v66
G v68,a146
v_and_b32 v69, 0xffff0000, v68
v_lshlrev_b32 v68, 16, v68
MF v68,v10,v68
MF v69,v10,v69
C v68,v68,v69
W a146,v68
G v70,a147
v_and_b32 v71, 0xffff0000, v70
v_lshlrev_b32 v70, 16, v70
MF v70,v10,v70
MF v71,v10,v71
C v70,v70,v71
W a147,v70
G v72,a148
v_and_b32 v73, 0xffff0000, v72
v_lshlrev_b32 v72, 16, v72
MF v72,v10,v72
MF v73,v10,v73
C v72,v72,v73
W a148,v72
G v74,a149
v_and_b32 v75, 0xffff0000, v74
v_lshlrev_b32 v74, 16, v74
MF v74,v10,v74
MF v75,v10,v75
C v74,v74,v75
W a149,v74
G v76,a150
v_and_b32 v77, 0xffff0000, v76
v_lshlrev_b32 v76, 16, v76
MF v76,v10,v76
MF v77,v10,v77
C v76,v76,v77
W a150,v76
G v78,a151
v_and_b32 v79, 0xffff0000, v78
v_lshlrev_b32 v78, 16, v78
MF v78,v10,v78
MF v79,v10,v79
C v78,v78,v79
W a151,v78
G v64,a152
v_and_b32 v65, 0xffff0000, v64
v_lshlrev_b32 v64, 16, v64
MF v64,v10,v64
MF v65,v10,v65
C v64,v64,v65
W a152,v64
G v66,a153
v_and_b32 v67, 0xffff0000, v66
v_lshlrev_b32 v66, 16, v66
MF v66,v10,v66
MF v67,v10,v67
C v66,v66,v67
W a153,v66
G v68,a154
v_and_b32 v69, 0xffff0000, v68
v_lshlrev_b32 v68, 16, v68
MF v68,v10,v68
MF v69,v10,v69
C v68,v68,v69
W a154,v68
G v70,a155
v_and_b32 v71, 0xffff0000, v70
v_lshlrev_b32 v70, 16, v70
MF v70,v10,v70
MF v71,v10,v71
C v70,v70,v71
W a155,v70
G v72,a156
v_and_b32 v73, 0xffff0000, v72
v_lshlrev_b32 v72, 16, v72
MF v72,v10,v72
MF v73,v10,v73
C v72,v72,v73
W a156,v72
G v74,a157
v_and_b32 v75, 0xffff0000, v74
v_lshlrev_b32 v74, 16, v74
MF v74,v10,v74
MF v75,v10,v75
C v74,v74,v75
W a157,v74
G v76,a158
v_and_b32 v77, 0xffff0000, v76
v_lshlrev_b32 v76, 16, v76
MF v76,v10,v76
MF v77,v10,v77
C v76,v76,v77
W a158,v76
G v78,a159
v_and_b32 v79, 0xffff0000, v78
v_lshlrev_b32 v78, 16, v78
MF v78,v10,v78
MF v79,v10,v79
C v78,v78,v79
W a159,v78
G v64,a160
v_and_b32 v65, 0xffff0000, v64
v_lshlrev_b32 v64, 16, v64
MF v64,v11,v64
MF v65,v11,v65
C v64,v64,v65
W a160,v64
G v66,a161
v_and_b32 v67, 0xffff0000, v66
v_lshlrev_b32 v66, 16, v66
MF v66,v11,v66
MF v67,v11,v67
C v66,v66,v67
W a161,v66
G v68,a162
v_and_b32 v69, 0xffff0000, v68
v_lshlrev_b32 v68, 16, v68
MF v68,v11,v68
MF v69,v11,v69
C v68,v68,v69
W a162,v68
G v70,a163
v_and_b32 v71, 0xffff0000, v70
v_lshlrev_b32 v70, 16, v70
MF v70,v11,v70
MF v71,v11,v71
C v70,v70,v71
W a163,v70
G v72,a164
v_and_b32 v73, 0xffff0000, v72
v_lshlrev_b32 v72, 16, v72
MF v72,v11,v72
MF v73,v11,v73
C v72,v72,v73
W a164,v72
G v74,a165
v_and_b32 v75, 0xffff0000, v74
v_lshlrev_b32 v74, 16, v74
MF v74,v11,v74
MF v75,v11,v75
C v74,v74,v75
W a165,v74
G v76,a166
v_and_b32 v77, 0xffff0000, v76
v_lshlrev_b32 v76, 16, v76
MF v76,v11,v76
MF v77,v11,v77
C v76,v76,v77
W a166,v76
G v78,a167
v_and_b32 v79, 0xffff0000, v78
v_lshlrev_b32 v78, 16, v78
MF v78,v11,v78
MF v79,v11,v79
C v78,v78,v79
W a167,v78
G v64,a168
v_and_b32 v65, 0xffff0000, v64
v_lshlrev_b32 v64, 16, v64
MF v64,v11,v64
MF v65,v11,v65
C v64,v64,v65
W a168,v64
G v66,a169
v_and_b32 v67, 0xffff0000, v66
v_lshlrev_b32 v66, 16, v66
MF v66,v11,v66
MF v67,v11,v67
C v66,v66,v67
W a169,v66
G v68,a170
v_and_b32 v69, 0xffff0000, v68
v_lshlrev_b32 v68, 16, v68
MF v68,v11,v68
MF v69,v11,v69
C v68,v68,v69
W a170,v68
G v70,a171
v_and_b32 v71, 0xffff0000, v70
v_lshlrev_b32 v70, 16, v70
MF v70,v11,v70
MF v71,v11,v71
C v70,v70,v71
W a171,v70
G v72,a172
v_and_b32 v73, 0xffff0000, v72
v_lshlrev_b32 v72, 16, v72
MF v72,v11,v72
MF v73,v11,v73
C v72,v72,v73
W a172,v72
G v74,a173
v_and_b32 v75, 0xffff0000, v74
v_lshlrev_b32 v74, 16, v74
MF v74,v11,v74
MF v75,v11,v75
C v74,v74,v75
W a173,v74
G v76,a174
v_and_b32 v77, 0xffff0000, v76
v_lshlrev_b32 v76, 16, v76
MF v76,v11,v76
MF v77,v11,v77
C v76,v76,v77
W a174,v76
G v78,a175
v_and_b32 v79, 0xffff0000, v78
v_lshlrev_b32 v78, 16, v78
MF v78,v11,v78
MF v79,v11,v79
C v78,v78,v79
W a175,v78
G v64,a176
v_and_b32 v65, 0xffff0000, v64
v_lshlrev_b32 v64, 16, v64
MF v64,v11,v64
MF v65,v11,v65
C v64,v64,v65
W a176,v64
G v66,a177
v_and_b32 v67, 0xffff0000, v66
v_lshlrev_b32 v66, 16, v66
MF v66,v11,v66
MF v67,v11,v67
C v66,v66,v67
W a177,v66
G v68,a178
v_and_b32 v69, 0xffff0000, v68
v_lshlrev_b32 v68, 16, v68
MF v68,v11,v68
MF v69,v11,v69
C v68,v68,v69
W a178,v68
G v70,a179
v_and_b32 v71, 0xffff0000, v70
v_lshlrev_b32 v70, 16, v70
MF v70,v11,v70
MF v71,v11,v71
C v70,v70,v71
W a179,v70
G v72,a180
v_and_b32 v73, 0xffff0000, v72
v_lshlrev_b32 v72, 16, v72
MF v72,v11,v72
MF v73,v11,v73
C v72,v72,v73
W a180,v72
G v74,a181
v_and_b32 v75, 0xffff0000, v74
v_lshlrev_b32 v74, 16, v74
MF v74,v11,v74
MF v75,v11,v75
C v74,v74,v75
W a181,v74
G v76,a182
v_and_b32 v77, 0xffff0000, v76
v_lshlrev_b32 v76, 16, v76
MF v76,v11,v76
MF v77,v11,v77
C v76,v76,v77
W a182,v76
G v78,a183
v_and_b32 v79, 0xffff0000, v78
v_lshlrev_b32 v78, 16, v78
MF v78,v11,v78
MF v79,v11,v79
C v78,v78,v79
W a183,v78
G v64,a184
v_and_b32 v65, 0xffff0000, v64
v_lshlrev_b32 v64, 16, v64
MF v64,v11,v64
MF v65,v11,v65
C v64,v64,v65
W a184,v64
G v66,a185
v_and_b32 v67, 0xffff0000, v66
v_lshlrev_b32 v66, 16, v66
MF v66,v11,v66
MF v67,v11,v67
C v66,v66,v67
W a185,v66
G v68,a186
v_and_b32 v69, 0xffff0000, v68
v_lshlrev_b32 v68, 16, v68
MF v68,v11,v68
MF v69,v11,v69
C v68,v68,v69
W a186,v68
G v70,a187
v_and_b32 v71, 0xffff0000, v70
v_lshlrev_b32 v70, 16, v70
MF v70,v11,v70
MF v71,v11,v71
C v70,v70,v71
W a187,v70
G v72,a188
v_and_b32 v73, 0xffff0000, v72
v_lshlrev_b32 v72, 16, v72
MF v72,v11,v72
MF v73,v11,v73
C v72,v72,v73
W a188,v72
G v74,a189
v_and_b32 v75, 0xffff0000, v74
v_lshlrev_b32 v74, 16, v74
MF v74,v11,v74
MF v75,v11,v75
C v74,v74,v75
W a189,v74
G v76,a190
v_and_b32 v77, 0xffff0000, v76
v_lshlrev_b32 v76, 16, v76
MF v76,v11,v76
MF v77,v11,v77
C v76,v76,v77
W a190,v76
G v78,a191
v_and_b32 v79, 0xffff0000, v78
v_lshlrev_b32 v78, 16, v78
MF v78,v11,v78
MF v79,v11,v79
C v78,v78,v79
W a191,v78
s_nop 3
s_setpc_b64 s[36:37]
L_zs0:
s_mov_b32 s64, 65536
L_zs0_l:
s_sleep 2
buffer_load_dword v17, v16, s[12:15], 0 offen sc1
s_sub_u32 s64, s64, 1
s_cbranch_scc1 L_zs0_x
s_waitcnt vmcnt(0)
v_cmp_ne_u32 vcc, 1, v17
s_nop 0
s_cbranch_vccnz L_zs0_l
L_zs0_x:
s_waitcnt vmcnt(0)
s_branch L_zr0
L_zs1:
s_mov_b32 s64, 65536
L_zs1_l:
s_sleep 2
buffer_load_dword v17, v16, s[12:15], 0 offen sc1
s_sub_u32 s64, s64, 1
s_cbranch_scc1 L_zs1_x
s_waitcnt vmcnt(0)
v_cmp_ne_u32 vcc, 1, v17
s_nop 0
s_cbranch_vccnz L_zs1_l
L_zs1_x:
s_waitcnt vmcnt(0)
s_branch L_zr1
L_hs:
s_mov_b32 s91, 65536
L_hs_l:
buffer_load_dwordx4 v[16:19], v7, s[8:11], s67 offen offset:0 sc1
buffer_load_dwordx4 v[20:23], v7, s[8:11], s67 offen offset:1024 sc1
s_waitcnt vmcnt(0)
s_sub_u32 s91, s91, 1
s_cbranch_scc1 L_hr
v_min3_u32 v28, v16, v17, v18
v_min3_u32 v28, v28, v19, v20
v_min3_u32 v28, v28, v21, v22
v_min_u32 v28, v28, v23
v_cmp_eq_u32 vcc, 0, v28
s_nop 0
s_cbranch_vccnz L_hs_l
s_branch L_hr
L_lsj0:
s_mov_b32 s91, 65536
L_lsj0_l:
s_sleep 2
buffer_load_dword v5, v17, s[8:11], s46 offen sc1
s_sub_u32 s91, s91, 1
s_cbranch_scc1 L_lsj0_x
s_waitcnt vmcnt(0)
v_cmp_gt_u32 vcc, 2, v5
s_nop 0
s_cbranch_vccnz L_lsj0_l
L_lsj0_x:
s_waitcnt vmcnt(0)
s_branch L_lrj0
L_lsh2:
s_mov_b32 s91, 65536
L_lsh2_l:
s_sleep 2
buffer_load_dword v5, v17, s[8:11], s46 offen sc1
s_sub_u32 s91, s91, 1
s_cbranch_scc1 L_lsh2_x
s_waitcnt vmcnt(0)
v_cmp_gt_u32 vcc, 2, v5
s_nop 0
s_cbranch_vccnz L_lsh2_l
L_lsh2_x:
s_waitcnt vmcnt(0)
s_branch L_lrh2
L_lsh4:
s_mov_b32 s91, 65536
L_lsh4_l:
s_sleep 2
buffer_load_dword v5, v9, s[8:11], s46 offen sc1
s_sub_u32 s91, s91, 1
s_cbranch_scc1 L_lsh4_x
s_waitcnt vmcnt(0)
v_cmp_gt_u32 vcc, s84, v5
s_nop 0
s_cbranch_vccnz L_lsh4_l
L_lsh4_x:
s_waitcnt vmcnt(0)
s_branch L_lrh4
L_wsq0:
s_mov_b32 s91, 65536
L_wsq0_l:
s_sleep 2
buffer_load_dword v5, v31, s[8:11], s46 offen offset:4 sc1
s_sub_u32 s91, s91, 1
s_cbranch_scc1 L_wsq0_x
s_waitcnt vmcnt(0)
v_cmp_ne_u32 vcc, 1, v5
s_nop 0
s_mov_b32 vcc_hi, 0
s_cbranch_vccnz L_wsq0_l
L_wsq0_x:
s_waitcnt vmcnt(0)
s_branch L_wrq0
L_wsr0:
s_mov_b32 s91, 65536
L_wsr0_l:
s_sleep 2
buffer_load_dword v5, v31, s[8:11], s46 offen offset:4 sc1
s_sub_u32 s91, s91, 1
s_cbranch_scc1 L_wsr0_x
s_waitcnt vmcnt(0)
v_cmp_ne_u32 vcc, 1, v5
s_nop 0
s_mov_b32 vcc_lo, 0
s_cbranch_vccnz L_wsr0_l
L_wsr0_x:
s_waitcnt vmcnt(0)
s_branch L_wrr0
L_wsq1:
s_mov_b32 s91, 65536
L_wsq1_l:
s_sleep 2
buffer_load_dword v5, v31, s[8:11], s46 offen offset:4 sc1
s_sub_u32 s91, s91, 1
s_cbranch_scc1 L_wsq1_x
s_waitcnt vmcnt(0)
v_cmp_ne_u32 vcc, 1, v5
s_nop 0
s_mov_b32 vcc_hi, 0
s_cbranch_vccnz L_wsq1_l
L_wsq1_x:
s_waitcnt vmcnt(0)
s_branch L_wrq1
L_wsr1:
s_mov_b32 s91, 65536
L_wsr1_l:
s_sleep 2
buffer_load_dword v5, v31, s[8:11], s46 offen offset:4 sc1
s_sub_u32 s91, s91, 1
s_cbranch_scc1 L_wsr1_x
s_waitcnt vmcnt(0)
v_cmp_ne_u32 vcc, 1, v5
s_nop 0
s_mov_b32 vcc_lo, 0
s_cbranch_vccnz L_wsr1_l
L_wsr1_x:
s_waitcnt vmcnt(0)
s_branch L_wrr1
L_fll:
s_sub_u32 s65, s7, s40
s_mov_b32 s64, -1
s_cmp_eq_u32 s65, 1
s_cbranch_scc1 L_fl2
s_cmp_lg_u32 s20, 0
s_cbranch_scc1 L_fl3
s_lshr_b32 s64, s42, 3
s_cmp_eq_u32 s7, s64
s_cbranch_scc0 L_fl1
v_mov_b32 v15, 4
buffer_store_dword v15, v1, s[8:11], s45 offen sc1
L_fl1:
s_cmp_lg_u32 s65, 0
s_cbranch_scc1 L_fllr
s_movk_i32 s64, 0x380
L_fl2:
v_min_u32 v17, s64, v9
s_mov_b32 s6, 4
buffer_load_dword v5, v17, s[8:11], s46 offen sc1
s_bitcmp1_b32 s39, 15
s_cbranch_scc0 L_fllr
L_fl3:
s_cmp_eq_u32 s7, 1
s_cbranch_scc1 L_y2
s_cmp_eq_u32 s7, 2
s_cbranch_scc1 L_y3
s_cmp_eq_u32 s7, 3
s_cbranch_scc1 L_y4
s_branch L_y5
s_waitcnt vmcnt(0)
L_fps:
s_cmp_lg_u32 s35, 0
s_cbranch_scc1 L_fpr
L_fps2:
s_mov_b32 s91, 65536
L_fps2_l:
s_sleep 2
buffer_load_dword v6, off, s[8:11], s47 sc1
s_sub_u32 s91, s91, 1
s_cbranch_scc1 L_fps2_x
s_waitcnt vmcnt(0)
v_cmp_ne_u32 vcc, 1, v6
s_nop 0
s_cbranch_vccnz L_fps2_l
L_fps2_x:
s_waitcnt vmcnt(0)
s_branch L_fpr
L_fqs:
s_mov_b32 s91, 65536
L_fqs_l:
s_sleep 2
buffer_load_dword v6, off, s[8:11], s47 offset:16 sc1
s_sub_u32 s91, s91, 1
s_cbranch_scc1 L_fqs_x
s_waitcnt vmcnt(0)
v_cmp_ne_u32 vcc, 1, v6
s_nop 0
s_cbranch_vccnz L_fqs_l
L_fqs_x:
s_waitcnt vmcnt(0)
s_branch L_fqr
L_fls0:
s_mov_b32 s91, 65536
L_fls0_l:
s_sleep 2
buffer_load_dword v5, v17, s[8:11], s46 offen sc1
s_sub_u32 s91, s91, 1
s_cbranch_scc1 L_fls0_x
s_waitcnt vmcnt(0)
v_cmp_gt_u32 vcc, s6, v5
s_nop 0
s_cbranch_vccnz L_fls0_l
L_fls0_x:
s_waitcnt vmcnt(0)
s_branch L_flr0
L_y2:
v_lshrrev_b32 v11, 7, v7
v_mul_u32_u24 v11, 4352, v11
v_and_b32 v12, 0x70, v7
v_lshl_add_u32 v11, v12, 3, v11
s_mov_b32 s64, 104923136
s_mov_b32 s65, 104957952
buffer_load_dword a128, v11, s[8:11], s64 offen sc1
buffer_load_dword a129, v11, s[8:11], s65 offen sc1
s_branch L_fllr
s_waitcnt vmcnt(0)
L_y3:
s_mov_b32 s91, 65536
L_y3c:
G v12,a128
G v13,a129
v_min_u32 v12, v12, v13
v_cmp_gt_u32 vcc, 2, v12
s_sub_u32 s91, s91, 1
s_cbranch_scc1 L_y3x
s_cbranch_vccz L_y3x
v_lshrrev_b32 v11, 7, v7
v_mul_u32_u24 v11, 4352, v11
v_and_b32 v12, 0x70, v7
v_lshl_add_u32 v11, v12, 3, v11
s_mov_b32 s64, 104923136
s_mov_b32 s65, 104957952
buffer_load_dword a128, v11, s[8:11], s64 offen sc1
buffer_load_dword a129, v11, s[8:11], s65 offen sc1
s_waitcnt vmcnt(0)
s_branch L_y3c
L_y3x:
s_lshl_b32 s66, s41, 1
SA s66,s66,s20
s_sub_u32 s66, s66, 2
s_cmp_lt_u32 s66, 14
s_cselect_b32 s64, 8, 12
SA s64,s64,104890368
buffer_load_dword a130, off, s[8:11], s64 sc1
v_lshrrev_b32 v11, 7, v7
v_mul_u32_u24 v11, 3584, v11
v_and_b32 v12, 0x70, v7
v_add_u32 v11, v12, v11
s_lshl_b32 s65, s66, 7
SA s65,s65,105906176
buffer_load_dwordx4 a[132:135], v11, s[8:11], s65 offen sc1
SA s65,s65,28672
buffer_load_dwordx4 a[136:139], v11, s[8:11], s65 offen sc1
SA s65,s65,28672
buffer_load_dwordx4 a[140:143], v11, s[8:11], s65 offen sc1
SA s65,s65,28672
buffer_load_dwordx4 a[144:147], v11, s[8:11], s65 offen sc1
SA s65,s65,28672
buffer_load_dwordx4 a[148:151], v11, s[8:11], s65 offen sc1
SA s65,s65,28672
buffer_load_dwordx4 a[152:155], v11, s[8:11], s65 offen sc1
SA s65,s65,28672
buffer_load_dwordx4 a[156:159], v11, s[8:11], s65 offen sc1
SA s65,s65,28672
buffer_load_dwordx4 a[160:163], v11, s[8:11], s65 offen sc1
SA s65,s65,28672
buffer_load_dwordx4 a[164:167], v11, s[8:11], s65 offen sc1
SA s65,s65,28672
buffer_load_dwordx4 a[168:171], v11, s[8:11], s65 offen sc1
SA s65,s65,28672
buffer_load_dwordx4 a[172:175], v11, s[8:11], s65 offen sc1
SA s65,s65,28672
buffer_load_dwordx4 a[176:179], v11, s[8:11], s65 offen sc1
SA s65,s65,28672
buffer_load_dwordx4 a[180:183], v11, s[8:11], s65 offen sc1
SA s65,s65,28672
buffer_load_dwordx4 a[184:187], v11, s[8:11], s65 offen sc1
SA s65,s65,28672
s_branch L_fllr
s_waitcnt vmcnt(0)
L_y4:
G v12,a132
G v13,a133
G v14,a134
G v15,a135
G v16,a136
G v17,a137
AF v12,v16,v12
AF v13,v17,v13
G v16,a138
G v17,a139
AF v14,v16,v14
AF v15,v17,v15
G v16,a140
G v17,a141
AF v12,v16,v12
AF v13,v17,v13
G v16,a142
G v17,a143
AF v14,v16,v14
AF v15,v17,v15
G v16,a144
G v17,a145
AF v12,v16,v12
AF v13,v17,v13
G v16,a146
G v17,a147
AF v14,v16,v14
AF v15,v17,v15
G v16,a148
G v17,a149
AF v12,v16,v12
AF v13,v17,v13
G v16,a150
G v17,a151
AF v14,v16,v14
AF v15,v17,v15
G v16,a152
G v17,a153
AF v12,v16,v12
AF v13,v17,v13
G v16,a154
G v17,a155
AF v14,v16,v14
AF v15,v17,v15
G v16,a156
G v17,a157
AF v12,v16,v12
AF v13,v17,v13
G v16,a158
G v17,a159
AF v14,v16,v14
AF v15,v17,v15
G v16,a160
G v17,a161
AF v12,v16,v12
AF v13,v17,v13
G v16,a162
G v17,a163
AF v14,v16,v14
AF v15,v17,v15
G v16,a164
G v17,a165
AF v12,v16,v12
AF v13,v17,v13
G v16,a166
G v17,a167
AF v14,v16,v14
AF v15,v17,v15
G v16,a168
G v17,a169
AF v12,v16,v12
AF v13,v17,v13
G v16,a170
G v17,a171
AF v14,v16,v14
AF v15,v17,v15
G v16,a172
G v17,a173
AF v12,v16,v12
AF v13,v17,v13
G v16,a174
G v17,a175
AF v14,v16,v14
AF v15,v17,v15
G v16,a176
G v17,a177
AF v12,v16,v12
AF v13,v17,v13
G v16,a178
G v17,a179
AF v14,v16,v14
AF v15,v17,v15
G v16,a180
G v17,a181
AF v12,v16,v12
AF v13,v17,v13
G v16,a182
G v17,a183
AF v14,v16,v14
AF v15,v17,v15
G v16,a184
G v17,a185
AF v12,v16,v12
AF v13,v17,v13
G v16,a186
G v17,a187
AF v14,v16,v14
AF v15,v17,v15
v_add_f32 v12, v12, v12 row_ror:8 row_mask:0xf bank_mask:0xf
v_add_f32 v13, v13, v13 row_ror:8 row_mask:0xf bank_mask:0xf
v_add_f32 v14, v14, v14 row_ror:8 row_mask:0xf bank_mask:0xf
v_add_f32 v15, v15, v15 row_ror:8 row_mask:0xf bank_mask:0xf
v_mov_b32 v11, v12
s_nop 1
v_permlane16_swap_b32 v11, v12
AF v12,v11,v12
v_mov_b32 v11, v13
s_nop 1
v_permlane16_swap_b32 v11, v13
AF v13,v11,v13
v_mov_b32 v11, v14
s_nop 1
v_permlane16_swap_b32 v11, v14
AF v14,v11,v14
v_mov_b32 v11, v15
s_nop 1
v_permlane16_swap_b32 v11, v15
AF v15,v11,v15
v_mov_b32 v11, v12
s_nop 1
v_permlane32_swap_b32 v11, v12
AF v12,v11,v12
v_mov_b32 v11, v13
s_nop 1
v_permlane32_swap_b32 v11, v13
AF v13,v11,v13
v_mov_b32 v11, v14
s_nop 1
v_permlane32_swap_b32 v11, v14
AF v14,v11,v14
v_mov_b32 v11, v15
s_nop 1
v_permlane32_swap_b32 v11, v15
AF v15,v11,v15
G v16,a130
C v11,v12,v13
v_lshlrev_b32 v12, 16, v11
v_and_b32 v13, 0xffff0000, v11
C v11,v14,v15
v_lshlrev_b32 v14, 16, v11
v_and_b32 v15, 0xffff0000, v11
MF v12,v16,v12
MF v13,v16,v13
MF v14,v16,v14
MF v15,v16,v15
C v11,v12,v13
v_lshlrev_b32 v12, 16, v11
v_and_b32 v13, 0xffff0000, v11
C v11,v14,v15
v_lshlrev_b32 v14, 16, v11
v_and_b32 v15, 0xffff0000, v11
s_lshl_b32 s66, s41, 1
SA s66,s66,s20
s_sub_u32 s66, s66, 2
s_lshl_b32 s65, s66, 7
SA s65,s65,104898560
s_mov_b64 exec, 0xff
buffer_store_dwordx4 v[12:15], v7, s[8:11], s65 offen sc1
s_mov_b64 exec, -1
s_nop 1
s_branch L_fllr
L_y5:
s_lshl_b32 s66, s41, 1
SA s66,s66,s20
s_sub_u32 s66, s66, 2
s_lshl_b32 s66, s66, 2
SA s66,s66,105062912
v_mov_b32 v11, 1
s_mov_b64 exec, 1
buffer_store_dword v11, off, s[8:11], s66 sc1
s_mov_b64 exec, -1
s_branch L_fllr
.p2align 12
L_loop_top:
M v[64:67],a[64:67],a[0:3],v[32:35]
SA m0,s28,0
R a[96:99],v2,40960
M v[64:67],a[68:71],a[4:7],v[64:67]
buffer_load_dword a240, v0, s[60:63], 0 offen offset:0
M v[64:67],a[72:75],a[8:11],v[64:67]
R a[100:103],v2,41984
M v[64:67],a[76:79],a[12:15],v[64:67]
s_waitcnt lgkmcnt(2)
buffer_load_dwordx4 v3, s[8:11], s26 offen offset:0 sc1 lds
M v[64:67],a[80:83],a[16:19],v[64:67]
R a[104:107],v2,43008
M v[64:67],a[84:87],a[20:23],v[64:67]
E v18,v112
M v[64:67],a[88:91],a[24:27],v[64:67]
R a[108:111],v2,44032
M v[64:67],a[92:95],a[28:31],v[64:67]
buffer_load_dwordx4 v3, s[8:11], s26 offen offset:1024 sc1 lds
M v[68:71],a[92:95],a[60:63],v[36:39]
R a[112:115],v2,45056
M v[68:71],a[88:91],a[56:59],v[68:71]
E v19,v113
M v[68:71],a[84:87],a[52:55],v[68:71]
R a[116:119],v2,46080
AF v28,v18,v28
M v[68:71],a[80:83],a[48:51],v[68:71]
E v20,v114
M v[68:71],a[76:79],a[44:47],v[68:71]
R a[120:123],v2,47104
C v56,v18,v19
M v[68:71],a[72:75],a[40:43],v[68:71]
buffer_load_dwordx4 v3, s[8:11], s26 offen offset:2048 sc1 lds
M v[68:71],a[68:71],a[36:39],v[68:71]
R a[124:127],v2,48128
AF v28,v19,v28
M v[68:71],a[64:67],a[32:35],v[68:71]
s_waitcnt lgkmcnt(4)
E v21,v115
M v[76:79],a[96:99],a[32:35],v[36:39]
R a[64:67],v2,49152
AF v28,v20,v28
M v[76:79],a[100:103],a[36:39],v[76:79]
buffer_load_dwordx4 v3, s[8:11], s26 offen offset:3072 sc1 lds
M v[76:79],a[104:107],a[40:43],v[76:79]
R a[68:71],v2,50176
C v57,v20,v21
M v[76:79],a[108:111],a[44:47],v[76:79]
s_waitcnt lgkmcnt(2)
E v22,v120
M v[76:79],a[112:115],a[48:51],v[76:79]
R a[72:75],v2,51200
AF v28,v21,v28
M v[76:79],a[116:119],a[52:55],v[76:79]
E v23,v121
M v[76:79],a[120:123],a[56:59],v[76:79]
SA m0,s28,4096
R a[76:79],v2,52224
AF v28,v22,v28
M v[76:79],a[124:127],a[60:63],v[76:79]
buffer_load_dwordx4 v4, s[8:11], s26 offen offset:0 sc1 lds
M v[72:75],a[124:127],a[28:31],v[32:35]
R a[80:83],v2,53248
C v58,v22,v23
M v[72:75],a[120:123],a[24:27],v[72:75]
E v24,v122
M v[72:75],a[116:119],a[20:23],v[72:75]
R a[84:87],v2,54272
AF v28,v23,v28
M v[72:75],a[112:115],a[16:19],v[72:75]
E v25,v123
M v[72:75],a[108:111],a[12:15],v[72:75]
R a[88:91],v2,55296
AF v28,v24,v28
M v[72:75],a[104:107],a[8:11],v[72:75]
buffer_load_dwordx4 v4, s[8:11], s26 offen offset:1024 sc1 lds
M v[72:75],a[100:103],a[4:7],v[72:75]
R a[92:95],v2,56320
C v59,v24,v25
M v[72:75],a[96:99],a[0:3],v[72:75]
s_waitcnt lgkmcnt(4)
E v18,v116
M v[80:83],a[64:67],a[0:3],v[32:35]
R a[96:99],v2,57344
AF v28,v25,v28
M v[80:83],a[68:71],a[4:7],v[80:83]
R a[100:103],v2,58368
M v[80:83],a[72:75],a[8:11],v[80:83]
buffer_load_dwordx4 v4, s[8:11], s26 offen offset:2048 sc1 lds
M v[80:83],a[76:79],a[12:15],v[80:83]
s_waitcnt lgkmcnt(2)
R a[104:107],v2,59392
M v[80:83],a[80:83],a[16:19],v[80:83]
R a[108:111],v2,60416
M v[80:83],a[84:87],a[20:23],v[80:83]
E v19,v117
M v[80:83],a[88:91],a[24:27],v[80:83]
R a[112:115],v2,61440
AF v29,v18,v29
M v[80:83],a[92:95],a[28:31],v[80:83]
R a[116:119],v2,62464
C v60,v18,v19
M v[84:87],a[92:95],a[60:63],v[36:39]
buffer_load_dwordx4 v4, s[8:11], s26 offen offset:3072 sc1 lds
M v[84:87],a[88:91],a[56:59],v[84:87]
SA s26,s26,32768
R a[120:123],v2,63488
AF v29,v19,v29
M v[84:87],a[84:87],a[52:55],v[84:87]
R a[124:127],v2,64512
M v[84:87],a[80:83],a[48:51],v[84:87]
E v20,v118
M v[84:87],a[76:79],a[44:47],v[84:87]
E v21,v119
M v[84:87],a[72:75],a[40:43],v[84:87]
E v22,v124
M v[84:87],a[68:71],a[36:39],v[84:87]
s_waitcnt vmcnt(17) lgkmcnt(0)
E v23,v125
M v[84:87],a[64:67],a[32:35],v[84:87]
s_barrier
M v[92:95],a[96:99],a[32:35],v[36:39]
R a[64:67],v7,32768
AF v29,v20,v29
M v[92:95],a[100:103],a[36:39],v[92:95]
E v24,v126
M v[92:95],a[104:107],a[40:43],v[92:95]
R a[68:71],v7,33792
C v61,v20,v21
M v[92:95],a[108:111],a[44:47],v[92:95]
AF v29,v21,v29
AF v29,v22,v29
M v[92:95],a[112:115],a[48:51],v[92:95]
R a[72:75],v7,34816
C v62,v22,v23
M v[92:95],a[116:119],a[52:55],v[92:95]
E v25,v127
M v[92:95],a[120:123],a[56:59],v[92:95]
R a[76:79],v7,35840
AF v29,v23,v29
M v[92:95],a[124:127],a[60:63],v[92:95]
AF v29,v24,v29
C v63,v24,v25
M v[88:91],a[124:127],a[28:31],v[32:35]
R a[80:83],v7,36864
AF v29,v25,v29
M v[88:91],a[120:123],a[24:27],v[88:91]
M v[88:91],a[116:119],a[20:23],v[88:91]
R a[84:87],v7,37888
v_max_f32 v10, v28, v29
M v[88:91],a[112:115],a[16:19],v[88:91]
v_cmp_lt_f32 vcc, s31, v10
M v[88:91],a[108:111],a[12:15],v[88:91]
R a[88:91],v7,38912
M v[88:91],a[104:107],a[8:11],v[88:91]
M v[88:91],a[100:103],a[4:7],v[88:91]
s_waitcnt lgkmcnt(3)
R a[92:95],v7,39936
M v[88:91],a[96:99],a[0:3],v[88:91]
s_cbranch_vccnz L_st1
L_rt1:
M v[128:131],a[64:67],v[48:51],v[128:131]
SA m0,s28,98304
R a[96:99],v7,40960
AF v30,v28,v30
M v[128:131],a[68:71],v[56:59],v[128:131]
buffer_load_dwordx4 v3, s[8:11], s21 offen offset:0 sc1 lds
M v[132:135],a[68:71],v[60:63],v[132:135]
R a[100:103],v7,41984
AF v31,v29,v31
M v[132:135],a[64:67],v[52:55],v[132:135]
s_waitcnt lgkmcnt(2)
E v18,v64
M v[140:143],a[72:75],v[52:55],v[140:143]
R a[104:107],v7,43008
M v[140:143],a[76:79],v[60:63],v[140:143]
buffer_load_dwordx4 v3, s[8:11], s21 offen offset:1024 sc1 lds
M v[136:139],a[76:79],v[56:59],v[136:139]
R a[108:111],v7,44032
M v[136:139],a[72:75],v[48:51],v[136:139]
E v19,v65
M v[144:147],a[80:83],v[48:51],v[144:147]
R a[112:115],v7,45056
AF v26,v18,v19
M v[144:147],a[84:87],v[56:59],v[144:147]
E v20,v66
M v[148:151],a[84:87],v[60:63],v[148:151]
R a[116:119],v7,46080
C v40,v18,v19
M v[148:151],a[80:83],v[52:55],v[148:151]
buffer_load_dwordx4 v3, s[8:11], s21 offen offset:2048 sc1 lds
M v[156:159],a[88:91],v[52:55],v[156:159]
R a[120:123],v7,47104
M v[156:159],a[92:95],v[60:63],v[156:159]
E v21,v67
M v[152:155],a[92:95],v[56:59],v[152:155]
R a[124:127],v7,48128
AF v26,v20,v26
M v[152:155],a[88:91],v[48:51],v[152:155]
s_waitcnt lgkmcnt(4)
buffer_load_dwordx4 v3, s[8:11], s21 offen offset:3072 sc1 lds
M v[160:163],a[96:99],v[48:51],v[160:163]
R a[64:67],v7,49152
C v41,v20,v21
M v[160:163],a[100:103],v[56:59],v[160:163]
E v22,v72
M v[164:167],a[100:103],v[60:63],v[164:167]
SA m0,s28,102400
R a[68:71],v7,50176
AF v26,v21,v26
M v[164:167],a[96:99],v[52:55],v[164:167]
s_waitcnt lgkmcnt(2)
buffer_load_dwordx4 v4, s[8:11], s21 offen offset:0 sc1 lds
M v[172:175],a[104:107],v[52:55],v[172:175]
R a[72:75],v7,51200
M v[172:175],a[108:111],v[60:63],v[172:175]
E v23,v73
M v[168:171],a[108:111],v[56:59],v[168:171]
R a[76:79],v7,52224
AF v26,v22,v26
M v[168:171],a[104:107],v[48:51],v[168:171]
E v24,v74
M v[176:179],a[112:115],v[48:51],v[176:179]
R a[80:83],v7,53248
C v42,v22,v23
M v[176:179],a[116:119],v[56:59],v[176:179]
buffer_load_dwordx4 v4, s[8:11], s21 offen offset:1024 sc1 lds
M v[180:183],a[116:119],v[60:63],v[180:183]
R a[84:87],v7,54272
AF v26,v23,v26
M v[180:183],a[112:115],v[52:55],v[180:183]
E v25,v75
M v[188:191],a[120:123],v[52:55],v[188:191]
R a[88:91],v7,55296
AF v26,v24,v26
M v[188:191],a[124:127],v[60:63],v[188:191]
buffer_load_dwordx4 v4, s[8:11], s21 offen offset:2048 sc1 lds
M v[184:187],a[124:127],v[56:59],v[184:187]
R a[92:95],v7,56320
C v43,v24,v25
M v[184:187],a[120:123],v[48:51],v[184:187]
s_waitcnt lgkmcnt(4)
E v18,v68
M v[192:195],a[64:67],v[48:51],v[192:195]
R a[96:99],v7,57344
AF v26,v25,v26
M v[192:195],a[68:71],v[56:59],v[192:195]
R a[100:103],v7,58368
M v[196:199],a[68:71],v[60:63],v[196:199]
buffer_load_dwordx4 v4, s[8:11], s21 offen offset:3072 sc1 lds
M v[196:199],a[64:67],v[52:55],v[196:199]
s_waitcnt lgkmcnt(2)
R a[104:107],v7,59392
M v[204:207],a[72:75],v[52:55],v[204:207]
SA s21,s21,32768
R a[108:111],v7,60416
M v[204:207],a[76:79],v[60:63],v[204:207]
s_sub_u32 s22, s22, 1
E v19,v69
M v[200:203],a[76:79],v[56:59],v[200:203]
s_cselect_b32 s21, s23, s21
R a[112:115],v7,61440
AF v27,v18,v19
M v[200:203],a[72:75],v[48:51],v[200:203]
R a[116:119],v7,62464
C v44,v18,v19
M v[208:211],a[80:83],v[48:51],v[208:211]
E v20,v70
M v[208:211],a[84:87],v[56:59],v[208:211]
R a[120:123],v7,63488
M v[212:215],a[84:87],v[60:63],v[212:215]
R a[124:127],v7,64512
M v[212:215],a[80:83],v[52:55],v[212:215]
E v21,v71
M v[220:223],a[88:91],v[52:55],v[220:223]
E v22,v76
M v[220:223],a[92:95],v[60:63],v[220:223]
AF v27,v20,v27
C v45,v20,v21
M v[216:219],a[92:95],v[56:59],v[216:219]
s_waitcnt vmcnt(17) lgkmcnt(0)
AF v27,v21,v27
M v[216:219],a[88:91],v[48:51],v[216:219]
s_barrier
M v[224:227],a[96:99],v[48:51],v[224:227]
R a[64:67],v2,0
M v[224:227],a[100:103],v[56:59],v[224:227]
E v23,v77
M v[228:231],a[100:103],v[60:63],v[228:231]
R a[68:71],v2,1024
AF v27,v22,v27
M v[228:231],a[96:99],v[52:55],v[228:231]
E v24,v78
M v[236:239],a[104:107],v[52:55],v[236:239]
R a[72:75],v2,2048
C v46,v22,v23
M v[236:239],a[108:111],v[60:63],v[236:239]
AF v27,v23,v27
M v[232:235],a[108:111],v[56:59],v[232:235]
R a[76:79],v2,3072
M v[232:235],a[104:107],v[48:51],v[232:235]
E v25,v79
M v[240:243],a[112:115],v[48:51],v[240:243]
R a[80:83],v2,4096
AF v27,v24,v27
M v[240:243],a[116:119],v[56:59],v[240:243]
C v47,v24,v25
AF v27,v25,v27
M v[244:247],a[116:119],v[60:63],v[244:247]
R a[84:87],v2,5120
M v[244:247],a[112:115],v[52:55],v[244:247]
M v[252:255],a[120:123],v[52:55],v[252:255]
R a[88:91],v2,6144
M v[252:255],a[124:127],v[60:63],v[252:255]
M v[248:251],a[124:127],v[56:59],v[248:251]
s_waitcnt lgkmcnt(3)
R a[92:95],v2,7168
M v[248:251],a[120:123],v[48:51],v[248:251]
M v[96:99],a[64:67],a[0:3],v[32:35]
s_bitcmp1_b32 s39, s7
R a[96:99],v2,8192
M v[96:99],a[68:71],a[4:7],v[96:99]
s_cbranch_scc1 L_fll
L_fllr:
E v18,v80
M v[96:99],a[72:75],a[8:11],v[96:99]
SA m0,s28,32768
R a[100:103],v2,9216
M v[96:99],a[76:79],a[12:15],v[96:99]
s_waitcnt lgkmcnt(2)
buffer_load_dwordx4 v3, s[8:11], s26 offen offset:0 sc1 lds
M v[96:99],a[80:83],a[16:19],v[96:99]
R a[104:107],v2,10240
M v[96:99],a[84:87],a[20:23],v[96:99]
E v19,v81
M v[96:99],a[88:91],a[24:27],v[96:99]
R a[108:111],v2,11264
AF v26,v18,v26
M v[96:99],a[92:95],a[28:31],v[96:99]
E v20,v82
M v[100:103],a[92:95],a[60:63],v[36:39]
R a[112:115],v2,12288
C v56,v18,v19
M v[100:103],a[88:91],a[56:59],v[100:103]
buffer_load_dwordx4 v3, s[8:11], s26 offen offset:1024 sc1 lds
M v[100:103],a[84:87],a[52:55],v[100:103]
R a[116:119],v2,13312
AF v26,v19,v26
M v[100:103],a[80:83],a[48:51],v[100:103]
E v21,v83
M v[100:103],a[76:79],a[44:47],v[100:103]
R a[120:123],v2,14336
AF v26,v20,v26
M v[100:103],a[72:75],a[40:43],v[100:103]
buffer_load_dwordx4 v3, s[8:11], s26 offen offset:2048 sc1 lds
M v[100:103],a[68:71],a[36:39],v[100:103]
R a[124:127],v2,15360
C v57,v20,v21
M v[100:103],a[64:67],a[32:35],v[100:103]
s_waitcnt lgkmcnt(4)
E v22,v88
M v[108:111],a[96:99],a[32:35],v[36:39]
R a[64:67],v2,16384
AF v26,v21,v26
M v[108:111],a[100:103],a[36:39],v[108:111]
E v23,v89
M v[108:111],a[104:107],a[40:43],v[108:111]
R a[68:71],v2,17408
AF v26,v22,v26
M v[108:111],a[108:111],a[44:47],v[108:111]
s_waitcnt lgkmcnt(2)
buffer_load_dwordx4 v3, s[8:11], s26 offen offset:3072 sc1 lds
M v[108:111],a[112:115],a[48:51],v[108:111]
R a[72:75],v2,18432
C v58,v22,v23
M v[108:111],a[116:119],a[52:55],v[108:111]
E v24,v90
M v[108:111],a[120:123],a[56:59],v[108:111]
R a[76:79],v2,19456
AF v26,v23,v26
M v[108:111],a[124:127],a[60:63],v[108:111]
SA m0,s28,36864
M v[104:107],a[124:127],a[28:31],v[32:35]
R a[80:83],v2,20480
M v[104:107],a[120:123],a[24:27],v[104:107]
buffer_load_dwordx4 v4, s[8:11], s26 offen offset:0 sc1 lds
M v[104:107],a[116:119],a[20:23],v[104:107]
R a[84:87],v2,21504
M v[104:107],a[112:115],a[16:19],v[104:107]
E v25,v91
M v[104:107],a[108:111],a[12:15],v[104:107]
R a[88:91],v2,22528
AF v26,v24,v26
M v[104:107],a[104:107],a[8:11],v[104:107]
buffer_load_dwordx4 v4, s[8:11], s26 offen offset:1024 sc1 lds
M v[104:107],a[100:103],a[4:7],v[104:107]
R a[92:95],v2,23552
C v59,v24,v25
M v[104:107],a[96:99],a[0:3],v[104:107]
s_waitcnt lgkmcnt(4)
E v18,v84
M v[112:115],a[64:67],a[0:3],v[32:35]
R a[96:99],v2,24576
AF v26,v25,v26
M v[112:115],a[68:71],a[4:7],v[112:115]
R a[100:103],v2,25600
M v[112:115],a[72:75],a[8:11],v[112:115]
buffer_load_dwordx4 v4, s[8:11], s26 offen offset:2048 sc1 lds
M v[112:115],a[76:79],a[12:15],v[112:115]
s_waitcnt lgkmcnt(2)
R a[104:107],v2,26624
M v[112:115],a[80:83],a[16:19],v[112:115]
R a[108:111],v2,27648
M v[112:115],a[84:87],a[20:23],v[112:115]
E v19,v85
M v[112:115],a[88:91],a[24:27],v[112:115]
R a[112:115],v2,28672
AF v27,v18,v27
M v[112:115],a[92:95],a[28:31],v[112:115]
R a[116:119],v2,29696
C v60,v18,v19
M v[116:119],a[92:95],a[60:63],v[36:39]
buffer_load_dwordx4 v4, s[8:11], s26 offen offset:3072 sc1 lds
M v[116:119],a[88:91],a[56:59],v[116:119]
SA s26,s26,32768
R a[120:123],v2,30720
AF v27,v19,v27
M v[116:119],a[84:87],a[52:55],v[116:119]
R a[124:127],v2,31744
M v[116:119],a[80:83],a[48:51],v[116:119]
E v20,v86
M v[116:119],a[76:79],a[44:47],v[116:119]
E v21,v87
M v[116:119],a[72:75],a[40:43],v[116:119]
E v22,v92
M v[116:119],a[68:71],a[36:39],v[116:119]
s_waitcnt vmcnt(16) lgkmcnt(0)
E v23,v93
M v[116:119],a[64:67],a[32:35],v[116:119]
s_barrier
M v[124:127],a[96:99],a[32:35],v[36:39]
R a[64:67],v7,0
AF v27,v20,v27
M v[124:127],a[100:103],a[36:39],v[124:127]
E v24,v94
M v[124:127],a[104:107],a[40:43],v[124:127]
R a[68:71],v7,1024
C v61,v20,v21
M v[124:127],a[108:111],a[44:47],v[124:127]
AF v27,v21,v27
AF v27,v22,v27
M v[124:127],a[112:115],a[48:51],v[124:127]
R a[72:75],v7,2048
C v62,v22,v23
M v[124:127],a[116:119],a[52:55],v[124:127]
E v25,v95
M v[124:127],a[120:123],a[56:59],v[124:127]
R a[76:79],v7,3072
AF v27,v23,v27
M v[124:127],a[124:127],a[60:63],v[124:127]
AF v27,v24,v27
C v63,v24,v25
M v[120:123],a[124:127],a[28:31],v[32:35]
R a[80:83],v7,4096
AF v27,v25,v27
M v[120:123],a[120:123],a[24:27],v[120:123]
M v[120:123],a[116:119],a[20:23],v[120:123]
R a[84:87],v7,5120
v_max_f32 v10, v26, v27
M v[120:123],a[112:115],a[16:19],v[120:123]
v_cmp_lt_f32 vcc, s31, v10
M v[120:123],a[108:111],a[12:15],v[120:123]
R a[88:91],v7,6144
M v[120:123],a[104:107],a[8:11],v[120:123]
M v[120:123],a[100:103],a[4:7],v[120:123]
s_waitcnt lgkmcnt(3)
R a[92:95],v7,7168
M v[120:123],a[96:99],a[0:3],v[120:123]
s_cbranch_vccnz L_st0
L_rt0:
M v[128:131],a[64:67],v[40:43],v[128:131]
SA m0,s28,65536
R a[96:99],v7,8192
AF v30,v26,v30
M v[128:131],a[68:71],v[56:59],v[128:131]
buffer_load_dwordx4 v3, s[8:11], s21 offen offset:0 sc1 lds
M v[132:135],a[68:71],v[60:63],v[132:135]
R a[100:103],v7,9216
AF v31,v27,v31
M v[132:135],a[64:67],v[44:47],v[132:135]
s_waitcnt lgkmcnt(2)
E v18,v96
M v[140:143],a[72:75],v[44:47],v[140:143]
R a[104:107],v7,10240
M v[140:143],a[76:79],v[60:63],v[140:143]
buffer_load_dwordx4 v3, s[8:11], s21 offen offset:1024 sc1 lds
M v[136:139],a[76:79],v[56:59],v[136:139]
R a[108:111],v7,11264
M v[136:139],a[72:75],v[40:43],v[136:139]
E v19,v97
M v[144:147],a[80:83],v[40:43],v[144:147]
R a[112:115],v7,12288
AF v28,v18,v19
M v[144:147],a[84:87],v[56:59],v[144:147]
E v20,v98
M v[148:151],a[84:87],v[60:63],v[148:151]
R a[116:119],v7,13312
C v48,v18,v19
M v[148:151],a[80:83],v[44:47],v[148:151]
buffer_load_dwordx4 v3, s[8:11], s21 offen offset:2048 sc1 lds
M v[156:159],a[88:91],v[44:47],v[156:159]
R a[120:123],v7,14336
M v[156:159],a[92:95],v[60:63],v[156:159]
E v21,v99
M v[152:155],a[92:95],v[56:59],v[152:155]
R a[124:127],v7,15360
AF v28,v20,v28
M v[152:155],a[88:91],v[40:43],v[152:155]
s_waitcnt lgkmcnt(4)
buffer_load_dwordx4 v3, s[8:11], s21 offen offset:3072 sc1 lds
M v[160:163],a[96:99],v[40:43],v[160:163]
R a[64:67],v7,16384
C v49,v20,v21
M v[160:163],a[100:103],v[56:59],v[160:163]
E v22,v104
M v[164:167],a[100:103],v[60:63],v[164:167]
SA m0,s28,69632
R a[68:71],v7,17408
AF v28,v21,v28
M v[164:167],a[96:99],v[44:47],v[164:167]
s_waitcnt lgkmcnt(2)
buffer_load_dwordx4 v4, s[8:11], s21 offen offset:0 sc1 lds
M v[172:175],a[104:107],v[44:47],v[172:175]
R a[72:75],v7,18432
M v[172:175],a[108:111],v[60:63],v[172:175]
E v23,v105
M v[168:171],a[108:111],v[56:59],v[168:171]
R a[76:79],v7,19456
AF v28,v22,v28
M v[168:171],a[104:107],v[40:43],v[168:171]
E v24,v106
M v[176:179],a[112:115],v[40:43],v[176:179]
R a[80:83],v7,20480
C v50,v22,v23
M v[176:179],a[116:119],v[56:59],v[176:179]
buffer_load_dwordx4 v4, s[8:11], s21 offen offset:1024 sc1 lds
M v[180:183],a[116:119],v[60:63],v[180:183]
R a[84:87],v7,21504
AF v28,v23,v28
M v[180:183],a[112:115],v[44:47],v[180:183]
E v25,v107
M v[188:191],a[120:123],v[44:47],v[188:191]
R a[88:91],v7,22528
AF v28,v24,v28
M v[188:191],a[124:127],v[60:63],v[188:191]
buffer_load_dwordx4 v4, s[8:11], s21 offen offset:2048 sc1 lds
M v[184:187],a[124:127],v[56:59],v[184:187]
R a[92:95],v7,23552
C v51,v24,v25
M v[184:187],a[120:123],v[40:43],v[184:187]
s_waitcnt lgkmcnt(4)
E v18,v100
M v[192:195],a[64:67],v[40:43],v[192:195]
R a[96:99],v7,24576
AF v28,v25,v28
M v[192:195],a[68:71],v[56:59],v[192:195]
R a[100:103],v7,25600
M v[196:199],a[68:71],v[60:63],v[196:199]
buffer_load_dwordx4 v4, s[8:11], s21 offen offset:3072 sc1 lds
M v[196:199],a[64:67],v[44:47],v[196:199]
s_waitcnt lgkmcnt(2)
R a[104:107],v7,26624
M v[204:207],a[72:75],v[44:47],v[204:207]
SA s21,s21,32768
R a[108:111],v7,27648
M v[204:207],a[76:79],v[60:63],v[204:207]
s_sub_u32 s22, s22, 1
E v19,v101
M v[200:203],a[76:79],v[56:59],v[200:203]
s_cselect_b32 s21, s23, s21
R a[112:115],v7,28672
AF v29,v18,v19
M v[200:203],a[72:75],v[40:43],v[200:203]
R a[116:119],v7,29696
C v52,v18,v19
M v[208:211],a[80:83],v[40:43],v[208:211]
E v20,v102
M v[208:211],a[84:87],v[56:59],v[208:211]
R a[120:123],v7,30720
M v[212:215],a[84:87],v[60:63],v[212:215]
R a[124:127],v7,31744
M v[212:215],a[80:83],v[44:47],v[212:215]
E v21,v103
M v[220:223],a[88:91],v[44:47],v[220:223]
E v22,v108
M v[220:223],a[92:95],v[60:63],v[220:223]
AF v29,v20,v29
C v53,v20,v21
M v[216:219],a[92:95],v[56:59],v[216:219]
s_waitcnt vmcnt(16) lgkmcnt(0)
AF v29,v21,v29
M v[216:219],a[88:91],v[40:43],v[216:219]
s_barrier
M v[224:227],a[96:99],v[40:43],v[224:227]
R a[64:67],v2,32768
M v[224:227],a[100:103],v[56:59],v[224:227]
E v23,v109
M v[228:231],a[100:103],v[60:63],v[228:231]
R a[68:71],v2,33792
v_cmp_gt_u32 vcc, s6, v5
M v[228:231],a[96:99],v[44:47],v[228:231]
E v24,v110
M v[236:239],a[104:107],v[44:47],v[236:239]
R a[72:75],v2,34816
AF v29,v22,v29
M v[236:239],a[108:111],v[60:63],v[236:239]
s_cbranch_vccnz L_fls0
L_flr0:
C v54,v22,v23
AF v29,v23,v29
M v[232:235],a[108:111],v[56:59],v[232:235]
s_mov_b32 s6, 0
R a[76:79],v2,35840
M v[232:235],a[104:107],v[40:43],v[232:235]
SA s7,s7,1
E v25,v111
M v[240:243],a[112:115],v[40:43],v[240:243]
R a[80:83],v2,36864
AF v29,v24,v29
M v[240:243],a[116:119],v[56:59],v[240:243]
C v55,v24,v25
AF v29,v25,v29
M v[244:247],a[116:119],v[60:63],v[244:247]
R a[84:87],v2,37888
M v[244:247],a[112:115],v[44:47],v[244:247]
M v[252:255],a[120:123],v[44:47],v[252:255]
s_sub_u32 s27, s27, 1
R a[88:91],v2,38912
M v[252:255],a[124:127],v[60:63],v[252:255]
s_cmp_lg_u32 s27, 0
M v[248:251],a[124:127],v[56:59],v[248:251]
s_waitcnt lgkmcnt(3)
R a[92:95],v2,39936
M v[248:251],a[120:123],v[40:43],v[248:251]
s_cbranch_scc1 L_loop_top
s_cmp_eq_u32 s40, 0
s_cbranch_scc1 L_final_h
L_d1s:
M v[68:71],a[64:67],a[32:35],v[36:39]
s_cmp_lt_u32 s20, 0
R a[96:99],v2,40960
R a[100:103],v2,41984
M v[68:71],a[68:71],a[36:39],v[68:71]
s_cselect_b64 s[82:83], -1, 0
E v18,v112
M v[68:71],a[72:75],a[40:43],v[68:71]
s_cmp_eq_u32 s20, 0
M v[68:71],a[76:79],a[44:47],v[68:71]
s_cselect_b64 s[66:67], s[16:17], s[82:83]
R a[104:107],v2,43008
R a[108:111],v2,44032
s_waitcnt lgkmcnt(7)
M v[68:71],a[80:83],a[48:51],v[68:71]
s_cselect_b64 s[68:69], s[18:19], s[82:83]
E v19,v113
s_waitcnt lgkmcnt(6)
M v[68:71],a[84:87],a[52:55],v[68:71]
s_cselect_b64 s[70:71], s[48:49], s[82:83]
AF v28,v18,v28
C v56,v18,v19
s_waitcnt lgkmcnt(5)
M v[68:71],a[88:91],a[56:59],v[68:71]
s_cselect_b64 s[72:73], s[50:51], s[82:83]
R a[112:115],v2,45056
R a[116:119],v2,46080
v_cndmask_b32 v64, v32, v8, s[66:67]
v_cndmask_b32 v65, v32, v8, s[68:69]
v_cndmask_b32 v66, v32, v8, s[70:71]
v_cndmask_b32 v67, v32, v8, s[72:73]
s_waitcnt lgkmcnt(6)
M v[68:71],a[92:95],a[60:63],v[68:71]
s_mov_b32 s26, s43
v_min_u32 v17, 896, v9
AF v28,v19,v28
M v[64:67],a[92:95],a[28:31],v[64:67]
s_cmp_lt_u32 s20, 1
buffer_load_dword v5, v17, s[8:11], s46 offen sc1
M v[64:67],a[88:91],a[24:27],v[64:67]
s_cselect_b64 s[82:83], -1, 0
R a[120:123],v2,47104
R a[124:127],v2,48128
M v[64:67],a[84:87],a[20:23],v[64:67]
SA m0,s28,0
E v20,v114
M v[64:67],a[80:83],a[16:19],v[64:67]
s_cmp_eq_u32 s20, 1
buffer_load_dwordx4 v3, s[8:11], s26 offen offset:0 sc1 lds
M v[64:67],a[76:79],a[12:15],v[64:67]
s_cselect_b64 s[74:75], s[16:17], s[82:83]
E v21,v115
M v[64:67],a[72:75],a[8:11],v[64:67]
s_cselect_b64 s[76:77], s[18:19], s[82:83]
AF v28,v20,v28
C v57,v20,v21
M v[64:67],a[68:71],a[4:7],v[64:67]
s_cselect_b64 s[78:79], s[48:49], s[82:83]
E v22,v120
M v[64:67],a[64:67],a[0:3],v[64:67]
s_waitcnt lgkmcnt(0)
buffer_load_dwordx4 v3, s[8:11], s26 offen offset:1024 sc1 lds
M v[76:79],a[96:99],a[32:35],v[36:39]
s_cselect_b64 s[80:81], s[50:51], s[82:83]
R a[64:67],v2,49152
R a[68:71],v2,50176
M v[76:79],a[100:103],a[36:39],v[76:79]
v_cndmask_b32 v72, v32, v8, s[74:75]
v_cndmask_b32 v73, v32, v8, s[76:77]
M v[76:79],a[104:107],a[40:43],v[76:79]
v_cndmask_b32 v74, v32, v8, s[78:79]
AF v28,v21,v28
M v[76:79],a[108:111],a[44:47],v[76:79]
R a[72:75],v2,51200
R a[76:79],v2,52224
M v[76:79],a[112:115],a[48:51],v[76:79]
buffer_load_dwordx4 v3, s[8:11], s26 offen offset:2048 sc1 lds
M v[76:79],a[116:119],a[52:55],v[76:79]
v_cndmask_b32 v75, v32, v8, s[80:81]
M v[76:79],a[120:123],a[56:59],v[76:79]
s_cmp_lt_u32 s20, 2
R a[80:83],v2,53248
R a[84:87],v2,54272
M v[76:79],a[124:127],a[60:63],v[76:79]
s_cselect_b64 s[82:83], -1, 0
E v23,v121
M v[72:75],a[124:127],a[28:31],v[72:75]
s_cmp_eq_u32 s20, 2
buffer_load_dwordx4 v3, s[8:11], s26 offen offset:3072 sc1 lds
M v[72:75],a[120:123],a[24:27],v[72:75]
s_cselect_b64 s[66:67], s[16:17], s[82:83]
R a[88:91],v2,55296
R a[92:95],v2,56320
M v[72:75],a[116:119],a[20:23],v[72:75]
s_cselect_b64 s[68:69], s[18:19], s[82:83]
E v24,v122
M v[72:75],a[112:115],a[16:19],v[72:75]
s_cselect_b64 s[70:71], s[48:49], s[82:83]
E v25,v123
M v[72:75],a[108:111],a[12:15],v[72:75]
s_cselect_b64 s[72:73], s[50:51], s[82:83]
v_cndmask_b32 v80, v32, v8, s[66:67]
v_cndmask_b32 v81, v32, v8, s[68:69]
M v[72:75],a[104:107],a[8:11],v[72:75]
SA m0,s28,4096
E v18,v116
M v[72:75],a[100:103],a[4:7],v[72:75]
s_lshl_b32 s86, s20, 14
buffer_load_dwordx4 v4, s[8:11], s26 offen offset:0 sc1 lds
M v[72:75],a[96:99],a[0:3],v[72:75]
s_waitcnt lgkmcnt(0)
v_cndmask_b32 v82, v32, v8, s[70:71]
AF v28,v22,v28
M v[84:87],a[64:67],a[32:35],v[36:39]
SA s86,s86,s34
R a[96:99],v2,57344
R a[100:103],v2,58368
M v[84:87],a[68:71],a[36:39],v[84:87]
SA s87,s86,4096
buffer_load_dwordx4 v4, s[8:11], s26 offen offset:1024 sc1 lds
M v[84:87],a[72:75],a[40:43],v[84:87]
SA s88,s86,8192
v_cndmask_b32 v83, v32, v8, s[72:73]
C v58,v22,v23
M v[84:87],a[76:79],a[44:47],v[84:87]
s_cmp_lt_u32 s20, 3
R a[104:107],v2,59392
R a[108:111],v2,60416
M v[84:87],a[80:83],a[48:51],v[84:87]
s_cselect_b64 s[82:83], -1, 0
E v19,v117
M v[84:87],a[84:87],a[52:55],v[84:87]
SA s89,s86,12288
buffer_load_dwordx4 v4, s[8:11], s26 offen offset:2048 sc1 lds
M v[84:87],a[88:91],a[56:59],v[84:87]
s_lshl_b32 s90, s20, 10
R a[112:115],v2,61440
R a[116:119],v2,62464
M v[84:87],a[92:95],a[60:63],v[84:87]
SA s90,s90,s34
E v20,v118
M v[80:83],a[92:95],a[28:31],v[80:83]
SA s90,s90,65536
E v21,v119
M v[80:83],a[88:91],a[24:27],v[80:83]
s_cmp_eq_u32 s20, 3
R a[120:123],v2,63488
R a[124:127],v2,64512
M v[80:83],a[84:87],a[20:23],v[80:83]
s_cselect_b64 s[74:75], s[16:17], s[82:83]
buffer_load_dwordx4 v4, s[8:11], s26 offen offset:3072 sc1 lds
M v[80:83],a[80:83],a[16:19],v[80:83]
s_cselect_b64 s[76:77], s[18:19], s[82:83]
AF v28,v23,v28
AF v28,v24,v28
M v[80:83],a[76:79],a[12:15],v[80:83]
s_cselect_b64 s[78:79], s[48:49], s[82:83]
E v22,v124
M v[80:83],a[72:75],a[8:11],v[80:83]
s_cselect_b64 s[80:81], s[50:51], s[82:83]
v_cndmask_b32 v88, v32, v8, s[74:75]
v_cndmask_b32 v89, v32, v8, s[76:77]
M v[80:83],a[68:71],a[4:7],v[80:83]
s_waitcnt vmcnt(17) lgkmcnt(0)
v_cndmask_b32 v90, v32, v8, s[78:79]
v_cndmask_b32 v91, v32, v8, s[80:81]
M v[80:83],a[64:67],a[0:3],v[80:83]
s_barrier
M v[92:95],a[96:99],a[32:35],v[36:39]
SA s26,s26,32768
R a[64:67],v7,32768
R a[68:71],v7,33792
M v[92:95],a[100:103],a[36:39],v[92:95]
SA m0,s28,131072
E v23,v125
M v[92:95],a[104:107],a[40:43],v[92:95]
buffer_load_dwordx4 v3, s[8:11], s26 offen offset:0 sc1 lds
M v[92:95],a[108:111],a[44:47],v[92:95]
R a[72:75],v7,34816
R a[76:79],v7,35840
M v[92:95],a[112:115],a[48:51],v[92:95]
C v59,v24,v25
AF v28,v25,v28
M v[92:95],a[116:119],a[52:55],v[92:95]
buffer_load_dwordx4 v3, s[8:11], s26 offen offset:1024 sc1 lds
M v[92:95],a[120:123],a[56:59],v[92:95]
R a[80:83],v7,36864
R a[84:87],v7,37888
M v[92:95],a[124:127],a[60:63],v[92:95]
E v24,v126
M v[88:91],a[124:127],a[28:31],v[88:91]
buffer_load_dwordx4 v3, s[8:11], s26 offen offset:2048 sc1 lds
M v[88:91],a[120:123],a[24:27],v[88:91]
R a[88:91],v7,38912
R a[92:95],v7,39936
M v[88:91],a[116:119],a[20:23],v[88:91]
E v25,v127
M v[88:91],a[112:115],a[16:19],v[88:91]
buffer_load_dwordx4 v3, s[8:11], s26 offen offset:3072 sc1 lds
M v[88:91],a[108:111],a[12:15],v[88:91]
AF v29,v18,v29
C v60,v18,v19
M v[88:91],a[104:107],a[8:11],v[88:91]
AF v29,v19,v29
AF v29,v20,v29
M v[88:91],a[100:103],a[4:7],v[88:91]
s_waitcnt lgkmcnt(0)
C v61,v20,v21
AF v29,v21,v29
M v[88:91],a[96:99],a[0:3],v[88:91]
AF v29,v22,v29
C v62,v22,v23
AF v29,v23,v29
AF v29,v24,v29
C v63,v24,v25
AF v29,v25,v29
v_max_f32 v10, v28, v29
v_cmp_lt_f32 vcc, s31, v10
s_nop 0
s_cbranch_vccnz L_std1
L_rtd1:
s_cmp_lt_u32 s42, 6
s_cbranch_scc1 L_d2h
M v[128:131],a[64:67],v[48:51],v[128:131]
R a[96:99],v7,40960
R a[100:103],v7,41984
M v[128:131],a[68:71],v[56:59],v[128:131]
SA m0,s28,135168
E v18,v64
M v[132:135],a[68:71],v[60:63],v[132:135]
buffer_load_dwordx4 v4, s[8:11], s26 offen offset:0 sc1 lds
M v[132:135],a[64:67],v[52:55],v[132:135]
R a[104:107],v7,43008
R a[108:111],v7,44032
M v[140:143],a[72:75],v[52:55],v[140:143]
s_cmp_gt_u32 s20, 3
E v19,v65
M v[140:143],a[76:79],v[60:63],v[140:143]
s_cselect_b64 s[82:83], -1, 0
AF v30,v28,v30
AF v31,v29,v31
M v[136:139],a[76:79],v[56:59],v[136:139]
s_cmp_eq_u32 s20, 3
R a[112:115],v7,45056
R a[116:119],v7,46080
M v[136:139],a[72:75],v[48:51],v[136:139]
s_cselect_b64 s[66:67], s[16:17], s[82:83]
buffer_load_dwordx4 v4, s[8:11], s26 offen offset:1024 sc1 lds
M v[144:147],a[80:83],v[48:51],v[144:147]
s_cselect_b64 s[68:69], s[18:19], s[82:83]
E v20,v66
M v[144:147],a[84:87],v[56:59],v[144:147]
s_cselect_b64 s[70:71], s[48:49], s[82:83]
R a[120:123],v7,47104
R a[124:127],v7,48128
M v[148:151],a[84:87],v[60:63],v[148:151]
s_cselect_b64 s[72:73], s[50:51], s[82:83]
v_cndmask_b32 v100, v36, v8, s[66:67]
v_cndmask_b32 v101, v36, v8, s[68:69]
M v[148:151],a[80:83],v[52:55],v[148:151]
buffer_load_dwordx4 v4, s[8:11], s26 offen offset:2048 sc1 lds
M v[156:159],a[88:91],v[52:55],v[156:159]
v_cndmask_b32 v102, v36, v8, s[70:71]
AF v26,v18,v19
M v[156:159],a[92:95],v[60:63],v[156:159]
E v21,v67
M v[152:155],a[92:95],v[56:59],v[152:155]
v_cndmask_b32 v103, v36, v8, s[72:73]
C v40,v18,v19
M v[152:155],a[88:91],v[48:51],v[152:155]
s_waitcnt lgkmcnt(0)
buffer_load_dwordx4 v4, s[8:11], s26 offen offset:3072 sc1 lds
M v[160:163],a[96:99],v[48:51],v[160:163]
s_cmp_gt_u32 s20, 2
R a[64:67],v7,49152
R a[68:71],v7,50176
M v[160:163],a[100:103],v[56:59],v[160:163]
s_cselect_b64 s[82:83], -1, 0
v_lshrrev_b32 v14, 7, v7
AF v26,v20,v26
M v[164:167],a[100:103],v[60:63],v[164:167]
s_cmp_eq_u32 s20, 2
v_mul_u32_u24 v14, 896, v14
C v41,v20,v21
M v[164:167],a[96:99],v[52:55],v[164:167]
s_cselect_b64 s[74:75], s[16:17], s[82:83]
R a[72:75],v7,51200
R a[76:79],v7,52224
M v[172:175],a[104:107],v[52:55],v[172:175]
s_cselect_b64 s[76:77], s[18:19], s[82:83]
v_lshrrev_b32 v15, 8, v7
AF v26,v21,v26
M v[172:175],a[108:111],v[60:63],v[172:175]
s_cselect_b64 s[78:79], s[48:49], s[82:83]
v_lshlrev_b32 v15, 5, v15
M v[168:171],a[108:111],v[56:59],v[168:171]
s_cselect_b64 s[80:81], s[50:51], s[82:83]
R a[80:83],v7,53248
R a[84:87],v7,54272
M v[168:171],a[104:107],v[48:51],v[168:171]
v_cndmask_b32 v108, v36, v8, s[74:75]
v_cndmask_b32 v109, v36, v8, s[76:77]
M v[176:179],a[112:115],v[48:51],v[176:179]
v_xor_b32 v15, v15, v7
M v[176:179],a[116:119],v[56:59],v[176:179]
R a[88:91],v7,55296
R a[92:95],v7,56320
M v[180:183],a[116:119],v[60:63],v[180:183]
v_and_b32 v15, 0x70, v15
v_cndmask_b32 v110, v36, v8, s[78:79]
M v[180:183],a[112:115],v[52:55],v[180:183]
v_add_u32 v0, v14, v15
M v[188:191],a[120:123],v[52:55],v[188:191]
s_mul_i32 s38, s20, 57344
v_cndmask_b32 v111, v36, v8, s[80:81]
M v[188:191],a[124:127],v[60:63],v[188:191]
s_cmp_gt_u32 s20, 1
E v22,v72
M v[184:187],a[124:127],v[56:59],v[184:187]
s_cselect_b64 s[82:83], -1, 0
E v23,v73
M v[184:187],a[120:123],v[48:51],v[184:187]
s_waitcnt lgkmcnt(0)
E v24,v74
M v[192:195],a[64:67],v[48:51],v[192:195]
SA m0,s28,98304
R a[96:99],v7,57344
R a[100:103],v7,58368
M v[192:195],a[68:71],v[56:59],v[192:195]
s_cmp_eq_u32 s20, 1
E v25,v75
M v[196:199],a[68:71],v[60:63],v[196:199]
s_cselect_b64 s[66:67], s[16:17], s[82:83]
E v18,v68
M v[196:199],a[64:67],v[52:55],v[196:199]
s_cselect_b64 s[68:69], s[18:19], s[82:83]
R a[104:107],v7,59392
R a[108:111],v7,60416
M v[204:207],a[72:75],v[52:55],v[204:207]
s_cselect_b64 s[70:71], s[48:49], s[82:83]
E v19,v69
M v[204:207],a[76:79],v[60:63],v[204:207]
s_cselect_b64 s[72:73], s[50:51], s[82:83]
v_cndmask_b32 v116, v36, v8, s[66:67]
v_cndmask_b32 v117, v36, v8, s[68:69]
M v[200:203],a[76:79],v[56:59],v[200:203]
SA s85,s38,0
R a[112:115],v7,61440
R a[116:119],v7,62464
M v[200:203],a[72:75],v[48:51],v[200:203]
buffer_load_dwordx4 v0, s[12:15], s85 offen offset:0 lds
M v[208:211],a[80:83],v[48:51],v[208:211]
SA s85,s38,6144
v_cndmask_b32 v118, v36, v8, s[70:71]
AF v26,v22,v26
M v[208:211],a[84:87],v[56:59],v[208:211]
R a[120:123],v7,63488
R a[124:127],v7,64512
M v[212:215],a[84:87],v[60:63],v[212:215]
buffer_load_dwordx4 v0, s[12:15], s85 offen offset:1024 lds
M v[212:215],a[80:83],v[52:55],v[212:215]
SA s85,s38,12288
v_cndmask_b32 v119, v36, v8, s[72:73]
C v42,v22,v23
M v[220:223],a[88:91],v[52:55],v[220:223]
s_cmp_gt_u32 s20, 0
E v20,v70
M v[220:223],a[92:95],v[60:63],v[220:223]
s_cselect_b64 s[82:83], -1, 0
buffer_load_dwordx4 v0, s[12:15], s85 offen offset:2048 lds
M v[216:219],a[92:95],v[56:59],v[216:219]
s_waitcnt vmcnt(20) lgkmcnt(0)
E v21,v71
M v[216:219],a[88:91],v[48:51],v[216:219]
s_barrier
M v[224:227],a[96:99],v[48:51],v[224:227]
SA s85,s38,18432
R a[64:67],v2,0
R a[68:71],v2,1024
M v[224:227],a[100:103],v[56:59],v[224:227]
s_cmp_eq_u32 s20, 0
buffer_load_dwordx4 v0, s[12:15], s85 offen offset:3072 lds
M v[228:231],a[100:103],v[60:63],v[228:231]
s_cselect_b64 s[74:75], s[16:17], s[82:83]
AF v26,v23,v26
AF v26,v24,v26
M v[228:231],a[96:99],v[52:55],v[228:231]
s_cselect_b64 s[76:77], s[18:19], s[82:83]
R a[72:75],v2,2048
R a[76:79],v2,3072
M v[236:239],a[104:107],v[52:55],v[236:239]
s_cselect_b64 s[78:79], s[48:49], s[82:83]
E v22,v76
M v[236:239],a[108:111],v[60:63],v[236:239]
s_cselect_b64 s[80:81], s[50:51], s[82:83]
v_cndmask_b32 v124, v36, v8, s[74:75]
v_cndmask_b32 v125, v36, v8, s[76:77]
M v[232:235],a[108:111],v[56:59],v[232:235]
SA m0,s28,102400
R a[80:83],v2,4096
R a[84:87],v2,5120
M v[232:235],a[104:107],v[48:51],v[232:235]
SA s85,s38,28672
buffer_load_dwordx4 v0, s[12:15], s85 offen offset:0 lds
M v[240:243],a[112:115],v[48:51],v[240:243]
SA s85,s38,34816
v_cndmask_b32 v126, v36, v8, s[78:79]
v_cndmask_b32 v127, v36, v8, s[80:81]
M v[240:243],a[116:119],v[56:59],v[240:243]
R a[88:91],v2,6144
R a[92:95],v2,7168
M v[244:247],a[116:119],v[60:63],v[244:247]
buffer_load_dwordx4 v0, s[12:15], s85 offen offset:1024 lds
M v[244:247],a[112:115],v[52:55],v[244:247]
SA s85,s38,40960
E v23,v77
M v[252:255],a[120:123],v[52:55],v[252:255]
buffer_load_dwordx4 v0, s[12:15], s85 offen offset:2048 lds
M v[252:255],a[124:127],v[60:63],v[252:255]
SA s85,s38,47104
C v43,v24,v25
AF v26,v25,v26
M v[248:251],a[124:127],v[56:59],v[248:251]
s_waitcnt lgkmcnt(0)
E v24,v78
M v[248:251],a[120:123],v[48:51],v[248:251]
buffer_load_dwordx4 v0, s[12:15], s85 offen offset:3072 lds
SA s38,s38,128
AF v27,v18,v19
C v44,v18,v19
AF v27,v20,v27
C v45,v20,v21
AF v27,v21,v27
E v25,v79
AF v27,v22,v27
C v46,v22,v23
AF v27,v23,v27
AF v27,v24,v27
C v47,v24,v25
AF v27,v25,v27
M v[100:103],a[64:67],a[32:35],v[100:103]
R a[96:99],v2,8192
R a[100:103],v2,9216
M v[100:103],a[68:71],a[36:39],v[100:103]
R a[104:107],v2,10240
R a[108:111],v2,11264
M v[100:103],a[72:75],a[40:43],v[100:103]
R a[112:115],v2,12288
R a[116:119],v2,13312
M v[100:103],a[76:79],a[44:47],v[100:103]
R a[120:123],v2,14336
R a[124:127],v2,15360
M v[100:103],a[80:83],a[48:51],v[100:103]
v_add_u32 v8, 0x20000, v7
M v[100:103],a[84:87],a[52:55],v[100:103]
E v18,v80
M v[100:103],a[88:91],a[56:59],v[100:103]
E v19,v81
M v[100:103],a[92:95],a[60:63],v[100:103]
s_waitcnt lgkmcnt(0)
E v20,v82
M v[108:111],a[96:99],a[32:35],v[108:111]
R a[64:67],v2,16384
R a[68:71],v2,17408
M v[108:111],a[100:103],a[36:39],v[108:111]
R a[72:75],v2,18432
R a[76:79],v2,19456
M v[108:111],a[104:107],a[40:43],v[108:111]
R a[80:83],v2,20480
R a[84:87],v2,21504
M v[108:111],a[108:111],a[44:47],v[108:111]
R a[88:91],v2,22528
R a[92:95],v2,23552
M v[108:111],a[112:115],a[48:51],v[108:111]
E v21,v83
M v[108:111],a[116:119],a[52:55],v[108:111]
E v22,v88
M v[108:111],a[120:123],a[56:59],v[108:111]
E v23,v89
M v[108:111],a[124:127],a[60:63],v[108:111]
s_waitcnt lgkmcnt(0)
E v24,v90
M v[116:119],a[64:67],a[32:35],v[116:119]
R a[96:99],v2,24576
R a[100:103],v2,25600
M v[116:119],a[68:71],a[36:39],v[116:119]
R a[104:107],v2,26624
R a[108:111],v2,27648
M v[116:119],a[72:75],a[40:43],v[116:119]
R a[112:115],v2,28672
R a[116:119],v2,29696
M v[116:119],a[76:79],a[44:47],v[116:119]
R a[120:123],v2,30720
R a[124:127],v2,31744
M v[116:119],a[80:83],a[48:51],v[116:119]
buffer_load_dword v6, off, s[8:11], s47 sc1
M v[116:119],a[84:87],a[52:55],v[116:119]
E v25,v91
M v[116:119],a[88:91],a[56:59],v[116:119]
s_waitcnt vmcnt(17) lgkmcnt(0)
AF v26,v18,v26
C v56,v18,v19
M v[116:119],a[92:95],a[60:63],v[116:119]
s_barrier
M v[124:127],a[96:99],a[32:35],v[124:127]
R a[64:67],v7,0
R a[68:71],v7,1024
M v[124:127],a[100:103],a[36:39],v[124:127]
R a[72:75],v7,2048
R a[76:79],v7,3072
M v[124:127],a[104:107],a[40:43],v[124:127]
R a[80:83],v7,4096
R a[84:87],v7,5120
M v[124:127],a[108:111],a[44:47],v[124:127]
R a[88:91],v7,6144
R a[92:95],v7,7168
M v[124:127],a[112:115],a[48:51],v[124:127]
AF v26,v19,v26
AF v26,v20,v26
M v[124:127],a[116:119],a[52:55],v[124:127]
E v18,v84
M v[124:127],a[120:123],a[56:59],v[124:127]
s_waitcnt lgkmcnt(0)
E v19,v85
M v[124:127],a[124:127],a[60:63],v[124:127]
C v57,v20,v21
AF v26,v21,v26
AF v26,v22,v26
C v58,v22,v23
AF v26,v23,v26
AF v26,v24,v26
C v59,v24,v25
AF v26,v25,v26
E v20,v86
E v21,v87
AF v27,v18,v27
C v60,v18,v19
AF v27,v19,v27
E v22,v92
E v23,v93
AF v27,v20,v27
C v61,v20,v21
AF v27,v21,v27
E v24,v94
E v25,v95
AF v27,v22,v27
C v62,v22,v23
AF v27,v23,v27
AF v27,v24,v27
C v63,v24,v25
AF v27,v25,v27
v_max_f32 v10, v26, v27
v_cmp_lt_f32 vcc, s31, v10
s_nop 0
s_cbranch_vccnz L_std3n
L_rtd3n:
M v[128:131],a[64:67],v[40:43],v[128:131]
R a[96:99],v7,8192
R a[100:103],v7,9216
M v[128:131],a[68:71],v[56:59],v[128:131]
v_or_b32 v9, s35, v7
s_waitcnt vmcnt(0)
v_cmp_ne_u32 vcc, 1, v6
M v[132:135],a[68:71],v[60:63],v[132:135]
s_cbranch_vccnz L_fps
L_fpr:
E v18,v100
M v[132:135],a[64:67],v[44:47],v[132:135]
R a[104:107],v7,10240
R a[108:111],v7,11264
M v[140:143],a[72:75],v[44:47],v[140:143]
buffer_load_dwordx4 v[14:17], v9, s[8:11], s90 offen sc1
M v[140:143],a[76:79],v[60:63],v[140:143]
E v19,v101
M v[136:139],a[76:79],v[56:59],v[136:139]
R a[112:115],v7,12288
R a[116:119],v7,13312
M v[136:139],a[72:75],v[40:43],v[136:139]
buffer_load_dwordx4 a[160:163], v9, s[8:11], s88 offen offset:0 sc1
M v[144:147],a[80:83],v[40:43],v[144:147]
E v20,v102
M v[144:147],a[84:87],v[56:59],v[144:147]
R a[120:123],v7,14336
R a[124:127],v7,15360
M v[148:151],a[84:87],v[60:63],v[148:151]
buffer_load_dwordx4 a[128:131], v9, s[8:11], s86 offen offset:0 sc1
M v[148:151],a[80:83],v[44:47],v[148:151]
E v21,v103
M v[156:159],a[88:91],v[44:47],v[156:159]
AF v30,v26,v30
AF v31,v27,v31
M v[156:159],a[92:95],v[60:63],v[156:159]
buffer_load_dwordx4 a[164:167], v9, s[8:11], s88 offen offset:1024 sc1
M v[152:155],a[92:95],v[56:59],v[152:155]
AF v29,v18,v19
C v52,v18,v19
M v[152:155],a[88:91],v[40:43],v[152:155]
s_waitcnt lgkmcnt(0)
E v22,v108
M v[160:163],a[96:99],v[40:43],v[160:163]
R a[64:67],v7,16384
R a[68:71],v7,17408
M v[160:163],a[100:103],v[56:59],v[160:163]
buffer_load_dwordx4 a[132:135], v9, s[8:11], s86 offen offset:1024 sc1
M v[164:167],a[100:103],v[60:63],v[164:167]
E v23,v109
M v[164:167],a[96:99],v[44:47],v[164:167]
R a[72:75],v7,18432
R a[76:79],v7,19456
M v[172:175],a[104:107],v[44:47],v[172:175]
buffer_load_dwordx4 a[168:171], v9, s[8:11], s88 offen offset:2048 sc1
M v[172:175],a[108:111],v[60:63],v[172:175]
AF v29,v20,v29
C v53,v20,v21
M v[168:171],a[108:111],v[56:59],v[168:171]
R a[80:83],v7,20480
R a[84:87],v7,21504
M v[168:171],a[104:107],v[40:43],v[168:171]
buffer_load_dwordx4 a[136:139], v9, s[8:11], s86 offen offset:2048 sc1
M v[176:179],a[112:115],v[40:43],v[176:179]
E v24,v110
M v[176:179],a[116:119],v[56:59],v[176:179]
R a[88:91],v7,22528
R a[92:95],v7,23552
M v[180:183],a[116:119],v[60:63],v[180:183]
buffer_load_dwordx4 a[172:175], v9, s[8:11], s88 offen offset:3072 sc1
M v[180:183],a[112:115],v[44:47],v[180:183]
E v25,v111
M v[188:191],a[120:123],v[44:47],v[188:191]
AF v29,v21,v29
AF v29,v22,v29
M v[188:191],a[124:127],v[60:63],v[188:191]
buffer_load_dwordx4 a[140:143], v9, s[8:11], s86 offen offset:3072 sc1
M v[184:187],a[124:127],v[56:59],v[184:187]
E v18,v116
M v[184:187],a[120:123],v[40:43],v[184:187]
s_waitcnt lgkmcnt(0)
C v54,v22,v23
AF v29,v23,v29
M v[192:195],a[64:67],v[40:43],v[192:195]
R a[96:99],v7,24576
R a[100:103],v7,25600
M v[192:195],a[68:71],v[56:59],v[192:195]
buffer_load_dwordx4 a[176:179], v9, s[8:11], s89 offen offset:0 sc1
M v[196:199],a[68:71],v[60:63],v[196:199]
E v19,v117
M v[196:199],a[64:67],v[44:47],v[196:199]
R a[104:107],v7,26624
R a[108:111],v7,27648
M v[204:207],a[72:75],v[44:47],v[204:207]
buffer_load_dwordx4 a[144:147], v9, s[8:11], s87 offen offset:0 sc1
M v[204:207],a[76:79],v[60:63],v[204:207]
E v20,v118
M v[200:203],a[76:79],v[56:59],v[200:203]
R a[112:115],v7,28672
R a[116:119],v7,29696
M v[200:203],a[72:75],v[40:43],v[200:203]
buffer_load_dwordx4 a[180:183], v9, s[8:11], s89 offen offset:1024 sc1
M v[208:211],a[80:83],v[40:43],v[208:211]
AF v29,v24,v29
C v55,v24,v25
M v[208:211],a[84:87],v[56:59],v[208:211]
R a[120:123],v7,30720
R a[124:127],v7,31744
M v[212:215],a[84:87],v[60:63],v[212:215]
buffer_load_dwordx4 a[148:151], v9, s[8:11], s87 offen offset:1024 sc1
M v[212:215],a[80:83],v[44:47],v[212:215]
E v21,v119
M v[220:223],a[88:91],v[44:47],v[220:223]
AF v29,v25,v29
AF v29,v18,v29
M v[220:223],a[92:95],v[60:63],v[220:223]
buffer_load_dwordx4 a[184:187], v9, s[8:11], s89 offen offset:2048 sc1
M v[216:219],a[92:95],v[56:59],v[216:219]
s_waitcnt lgkmcnt(0)
E v22,v124
M v[216:219],a[88:91],v[40:43],v[216:219]
s_barrier
M v[224:227],a[96:99],v[40:43],v[224:227]
R a[64:67],v8,0
R a[68:71],v8,1024
M v[224:227],a[100:103],v[56:59],v[224:227]
buffer_load_dwordx4 a[152:155], v9, s[8:11], s87 offen offset:2048 sc1
M v[228:231],a[100:103],v[60:63],v[228:231]
E v23,v125
M v[228:231],a[96:99],v[44:47],v[228:231]
R a[72:75],v8,2048
R a[76:79],v8,3072
M v[236:239],a[104:107],v[44:47],v[236:239]
buffer_load_dwordx4 a[188:191], v9, s[8:11], s89 offen offset:3072 sc1
M v[236:239],a[108:111],v[60:63],v[236:239]
E v24,v126
M v[232:235],a[108:111],v[56:59],v[232:235]
R a[80:83],v8,4096
R a[84:87],v8,5120
M v[232:235],a[104:107],v[40:43],v[232:235]
buffer_load_dwordx4 a[156:159], v9, s[8:11], s87 offen offset:3072 sc1
M v[240:243],a[112:115],v[40:43],v[240:243]
E v25,v127
M v[240:243],a[116:119],v[56:59],v[240:243]
R a[88:91],v8,6144
R a[92:95],v8,7168
M v[244:247],a[116:119],v[60:63],v[244:247]
C v48,v18,v19
AF v29,v19,v29
M v[244:247],a[112:115],v[44:47],v[244:247]
AF v29,v20,v29
C v49,v20,v21
M v[252:255],a[120:123],v[44:47],v[252:255]
AF v29,v21,v29
AF v29,v22,v29
M v[252:255],a[124:127],v[60:63],v[252:255]
C v50,v22,v23
AF v29,v23,v29
M v[248:251],a[124:127],v[56:59],v[248:251]
s_waitcnt lgkmcnt(0)
AF v29,v24,v29
C v51,v24,v25
M v[248:251],a[120:123],v[40:43],v[248:251]
AF v29,v25,v29
v_cmp_lt_f32 vcc, s31, v29
s_nop 0
s_cbranch_vccnz L_std4n
L_rtd4n:
s_waitcnt vmcnt(16)
v_cmp_neq_f32 vcc, v32, v14
v_cmp_neq_f32 s[64:65], v36, v15
s_cmp_eq_u32 s35, 0
s_cselect_b64 s[66:67], -1, 0
s_or_b64 vcc, vcc, s[64:65]
s_and_b64 vcc, vcc, s[66:67]
s_cbranch_vccnz L_stc
L_rtc:
M v[132:135],a[64:67],v[52:55],v[132:135]
R a[96:99],v8,8192
R a[100:103],v8,9216
M v[132:135],a[68:71],v[48:51],v[132:135]
s_waitcnt vmcnt(12)
AF v30,v16,v30
AF v31,v17,v31
M v[132:135],a[246:249],a[160:163],v[132:135]
SA m0,s28,32768
AF v31,v29,v31
v_mov_b32 v10, v30
M v[128:131],a[246:249],a[128:131],v[128:131]
SA s85,s38,0
R a[104:107],v8,10240
R a[108:111],v8,11264
M v[140:143],a[72:75],v[52:55],v[140:143]
buffer_load_dwordx4 v0, s[12:15], s85 offen offset:0 lds
M v[140:143],a[76:79],v[48:51],v[140:143]
SA s85,s38,6144
v_mov_b32 v11, v31
M v[140:143],a[244:247],a[160:163],v[140:143]
R a[112:115],v8,12288
R a[116:119],v8,13312
M v[136:139],a[244:247],a[128:131],v[136:139]
v_permlane16_swap_b32 v10, v30
M v[148:151],a[80:83],v[52:55],v[148:151]
v_permlane16_swap_b32 v11, v31
M v[148:151],a[84:87],v[48:51],v[148:151]
R a[120:123],v8,14336
R a[124:127],v8,15360
M v[148:151],a[246:249],a[164:167],v[148:151]
buffer_load_dwordx4 v0, s[12:15], s85 offen offset:1024 lds
M v[144:147],a[246:249],a[132:135],v[144:147]
SA s85,s38,12288
AF v30,v10,v30
AF v31,v11,v31
M v[156:159],a[88:91],v[52:55],v[156:159]
v_mov_b32 v10, v30
v_mov_b32 v11, v31
M v[156:159],a[92:95],v[48:51],v[156:159]
buffer_load_dwordx4 v0, s[12:15], s85 offen offset:2048 lds
M v[156:159],a[244:247],a[164:167],v[156:159]
s_waitcnt vmcnt(11)
v_permlane32_swap_b32 v10, v30
M v[152:155],a[244:247],a[132:135],v[152:155]
s_waitcnt lgkmcnt(0)
v_permlane32_swap_b32 v11, v31
M v[164:167],a[96:99],v[52:55],v[164:167]
SA s85,s38,18432
R a[64:67],v8,16384
R a[68:71],v8,17408
M v[164:167],a[100:103],v[48:51],v[164:167]
buffer_load_dwordx4 v0, s[12:15], s85 offen offset:3072 lds
M v[164:167],a[246:249],a[168:171],v[164:167]
SA m0,s28,36864
C v132,v132,v133
C v133,v134,v135
M v[160:163],a[246:249],a[136:139],v[160:163]
SA s85,s38,28672
R a[72:75],v8,18432
R a[76:79],v8,19456
AF v30,v10,v30
AF v31,v11,v31
v_rcp_f32 v5, v30
v_rcp_f32 v6, v31
M v[172:175],a[104:107],v[52:55],v[172:175]
buffer_load_dwordx4 v0, s[12:15], s85 offen offset:0 lds
M v[172:175],a[108:111],v[48:51],v[172:175]
SA s85,s38,34816
C v134,v140,v141
C v135,v142,v143
M v[172:175],a[244:247],a[168:171],v[172:175]
R a[80:83],v8,20480
R a[84:87],v8,21504
M v[168:171],a[244:247],a[136:139],v[168:171]
buffer_load_dwordx4 v0, s[12:15], s85 offen offset:1024 lds
M v[180:183],a[112:115],v[52:55],v[180:183]
SA s85,s38,40960
C v128,v128,v129
C v129,v130,v131
M v[180:183],a[116:119],v[48:51],v[180:183]
R a[88:91],v8,22528
R a[92:95],v8,23552
M v[180:183],a[246:249],a[172:175],v[180:183]
buffer_load_dwordx4 v0, s[12:15], s85 offen offset:2048 lds
M v[176:179],a[246:249],a[140:143],v[176:179]
SA s85,s38,47104
C v130,v136,v137
C v131,v138,v139
M v[188:191],a[120:123],v[52:55],v[188:191]
C v148,v148,v149
C v149,v150,v151
M v[188:191],a[124:127],v[48:51],v[188:191]
buffer_load_dwordx4 v0, s[12:15], s85 offen offset:3072 lds
M v[188:191],a[244:247],a[172:175],v[188:191]
s_waitcnt vmcnt(12)
C v150,v156,v157
C v151,v158,v159
M v[184:187],a[244:247],a[140:143],v[184:187]
s_waitcnt lgkmcnt(0)
C v144,v144,v145
C v145,v146,v147
M v[196:199],a[64:67],v[52:55],v[196:199]
SA s38,s38,128
R a[96:99],v8,24576
R a[100:103],v8,25600
M v[196:199],a[68:71],v[48:51],v[196:199]
SA m0,s28,65536
C v146,v152,v153
C v147,v154,v155
M v[196:199],a[246:249],a[176:179],v[196:199]
SA s85,s38,0
buffer_load_dwordx4 v0, s[12:15], s85 offen offset:0 lds
M v[192:195],a[246:249],a[144:147],v[192:195]
SA s85,s38,6144
R a[104:107],v8,26624
R a[108:111],v8,27648
M v[204:207],a[72:75],v[52:55],v[204:207]
v_lshrrev_b32 v16, 4, v7
v_lshrrev_b32 v14, 2, v16
M v[204:207],a[76:79],v[48:51],v[204:207]
buffer_load_dwordx4 v0, s[12:15], s85 offen offset:1024 lds
M v[204:207],a[244:247],a[176:179],v[204:207]
SA s85,s38,12288
R a[112:115],v8,28672
R a[116:119],v8,29696
M v[200:203],a[244:247],a[144:147],v[200:203]
v_lshlrev_b32 v14, 7, v14
v_and_b32 v15, 3, v16
M v[212:215],a[80:83],v[52:55],v[212:215]
buffer_load_dwordx4 v0, s[12:15], s85 offen offset:2048 lds
M v[212:215],a[84:87],v[48:51],v[212:215]
SA s85,s38,18432
R a[120:123],v8,30720
R a[124:127],v8,31744
M v[212:215],a[246:249],a[180:183],v[212:215]
v_lshl_add_u32 v14, v15, 3, v14
C v164,v164,v165
M v[208:211],a[246:249],a[148:151],v[208:211]
buffer_load_dwordx4 v0, s[12:15], s85 offen offset:3072 lds
M v[220:223],a[88:91],v[52:55],v[220:223]
C v165,v166,v167
C v166,v172,v173
M v[220:223],a[92:95],v[48:51],v[220:223]
s_waitcnt vmcnt(12)
C v167,v174,v175
C v160,v160,v161
M v[220:223],a[244:247],a[180:183],v[220:223]
s_waitcnt lgkmcnt(0)
v_bfe_u32 v15, v16, 3, 2
v_lshl_add_u32 v18, v15, 5, v14
v_xor_b32 v19, 32, v18
v_xor_b32 v20, 64, v18
v_xor_b32 v21, 0x60, v18
v_add_u32 v22, 0x10000, v18
v_add_u32 v23, 0x10000, v19
v_add_u32 v24, 0x10000, v20
v_add_u32 v25, 0x10000, v21
M v[216:219],a[244:247],a[148:151],v[216:219]
s_barrier
M v[228:231],a[96:99],v[52:55],v[228:231]
s_nop 0
T a[64:65],v22,32768
T a[66:67],v22,34816
M v[228:231],a[100:103],v[48:51],v[228:231]
T a[68:69],v22,36864
T a[70:71],v22,38912
M v[228:231],a[246:249],a[184:187],v[228:231]
C v161,v162,v163
C v162,v168,v169
M v[224:227],a[246:249],a[152:155],v[224:227]
T a[72:73],v22,40960
T a[74:75],v22,43008
M v[236:239],a[104:107],v[52:55],v[236:239]
T a[76:77],v22,45056
T a[78:79],v22,47104
M v[236:239],a[108:111],v[48:51],v[236:239]
C v163,v170,v171
C v180,v180,v181
M v[236:239],a[244:247],a[184:187],v[236:239]
T a[80:81],v22,49152
T a[82:83],v22,51200
M v[232:235],a[244:247],a[152:155],v[232:235]
T a[84:85],v22,53248
T a[86:87],v22,55296
M v[244:247],a[112:115],v[52:55],v[244:247]
C v181,v182,v183
C v182,v188,v189
M v[244:247],a[116:119],v[48:51],v[244:247]
T a[88:89],v22,57344
T a[90:91],v22,59392
M v[244:247],a[246:249],a[188:191],v[244:247]
T a[92:93],v22,61440
T a[94:95],v22,63488
M v[240:243],a[246:249],a[156:159],v[240:243]
C v183,v190,v191
C v176,v176,v177
M v[252:255],a[120:123],v[52:55],v[252:255]
C v177,v178,v179
C v178,v184,v185
M v[252:255],a[124:127],v[48:51],v[252:255]
C v179,v186,v187
C v196,v196,v197
M v[252:255],a[244:247],a[188:191],v[252:255]
s_waitcnt lgkmcnt(0)
C v197,v198,v199
C v198,v204,v205
M v[248:251],a[244:247],a[156:159],v[248:251]
C v199,v206,v207
C v192,v192,v193
C v193,v194,v195
C v194,v200,v201
C v195,v202,v203
C v212,v212,v213
C v213,v214,v215
C v214,v220,v221
C v215,v222,v223
C v208,v208,v209
C v209,v210,v211
C v210,v216,v217
C v211,v218,v219
C v228,v228,v229
C v229,v230,v231
C v230,v236,v237
C v231,v238,v239
C v224,v224,v225
C v225,v226,v227
C v226,v232,v233
C v227,v234,v235
C v244,v244,v245
C v245,v246,v247
C v246,v252,v253
C v247,v254,v255
C v240,v240,v241
C v241,v242,v243
C v242,v248,v249
C v243,v250,v251
M v[64:67],a[64:67],v[128:131],0
s_sub_u32 s64, 15, s42
T a[96:97],v23,32768
T a[98:99],v23,34816
M v[64:67],a[68:71],v[144:147],v[64:67]
s_min_u32 s64, s64, s42
T a[100:101],v23,36864
T a[102:103],v23,38912
M v[64:67],a[72:75],v[160:163],v[64:67]
s_mul_i32 s45, s64, 8704
M v[64:67],a[76:79],v[176:179],v[64:67]
s_lshl_b32 s64, s41, 2
T a[104:105],v23,40960
T a[106:107],v23,43008
M v[64:67],a[80:83],v[192:195],v[64:67]
SA s45,s45,s64
T a[108:109],v23,45056
T a[110:111],v23,47104
M v[64:67],a[84:87],v[208:211],v[64:67]
s_lshl_b32 s64, s20, 8
M v[64:67],a[88:91],v[224:227],v[64:67]
SA s45,s45,s64
T a[112:113],v23,49152
T a[114:115],v23,51200
M v[64:67],a[92:95],v[240:243],v[64:67]
SA s45,s45,104992768
T a[116:117],v23,53248
T a[118:119],v23,55296
M v[68:71],a[92:95],v[244:247],0
s_mov_b32 s64, 1024
M v[68:71],a[88:91],v[228:231],v[68:71]
s_mov_b32 s66, 4096
T a[120:121],v23,57344
T a[122:123],v23,59392
M v[68:71],a[84:87],v[212:215],v[68:71]
s_cmp_lt_u32 s42, 8
T a[124:125],v23,61440
T a[126:127],v23,63488
M v[68:71],a[80:83],v[196:199],v[68:71]
s_cselect_b32 s64, 4352, s64
M v[68:71],a[76:79],v[180:183],v[68:71]
s_cselect_b32 s65, 0, 64
M v[68:71],a[72:75],v[164:167],v[68:71]
s_cselect_b32 s66, 536870912, s66
M v[68:71],a[68:71],v[148:151],v[68:71]
SA s3,s45,s64
M v[68:71],a[64:67],v[132:135],v[68:71]
s_waitcnt lgkmcnt(0)
M v[72:75],a[96:99],v[128:131],0
SA s45,s45,s65
T a[64:65],v24,32768
T a[66:67],v24,34816
M v[72:75],a[100:103],v[144:147],v[72:75]
SA m0,s28,69632
T a[68:69],v24,36864
T a[70:71],v24,38912
M v[72:75],a[104:107],v[160:163],v[72:75]
SA s85,s38,28672
buffer_load_dwordx4 v0, s[12:15], s85 offen offset:0 lds
M v[72:75],a[108:111],v[176:179],v[72:75]
SA s85,s38,34816
T a[72:73],v24,40960
T a[74:75],v24,43008
M v[72:75],a[112:115],v[192:195],v[72:75]
SA s29,s33,0
T a[76:77],v24,45056
T a[78:79],v24,47104
M v[72:75],a[116:119],v[208:211],v[72:75]
SA s30,s33,14336
buffer_load_dwordx4 v0, s[12:15], s85 offen offset:1024 lds
M v[72:75],a[120:123],v[224:227],v[72:75]
SA s85,s38,40960
T a[80:81],v24,49152
T a[82:83],v24,51200
M v[72:75],a[124:127],v[240:243],v[72:75]
T a[84:85],v24,53248
T a[86:87],v24,55296
M v[76:79],a[124:127],v[244:247],0
buffer_load_dwordx4 v0, s[12:15], s85 offen offset:2048 lds
M v[76:79],a[120:123],v[228:231],v[76:79]
SA s85,s38,47104
T a[88:89],v24,57344
T a[90:91],v24,59392
M v[76:79],a[116:119],v[212:215],v[76:79]
T a[92:93],v24,61440
T a[94:95],v24,63488
M v[76:79],a[112:115],v[196:199],v[76:79]
buffer_load_dwordx4 v0, s[12:15], s85 offen offset:3072 lds
M v[76:79],a[108:111],v[180:183],v[76:79]
SA s38,s38,128
v_lshrrev_b32 v17, 5, v7
v_min_u32 v15, 1, v17
M v[76:79],a[104:107],v[164:167],v[76:79]
SA m0,s28,0
v_lshlrev_b32 v14, 3, v7
v_lshl_or_b32 v16, v15, 29, v14
M v[76:79],a[100:103],v[148:151],v[76:79]
SA s85,s38,0
buffer_load_dwordx4 v0, s[12:15], s85 offen offset:0 lds
M v[76:79],a[96:99],v[132:135],v[76:79]
s_waitcnt lgkmcnt(0)
v_cmp_eq_u32 vcc, 1, v17
v_add_u32 v14, s66, v14
M v[80:83],a[64:67],v[128:131],0
SA s85,s38,6144
T a[96:97],v25,32768
T a[98:99],v25,34816
M v[80:83],a[68:71],v[144:147],v[80:83]
T a[100:101],v25,36864
T a[102:103],v25,38912
M v[80:83],a[72:75],v[160:163],v[80:83]
buffer_load_dwordx4 v0, s[12:15], s85 offen offset:1024 lds
M v[80:83],a[76:79],v[176:179],v[80:83]
SA s85,s38,12288
T a[104:105],v25,40960
T a[106:107],v25,43008
M v[80:83],a[80:83],v[192:195],v[80:83]
T a[108:109],v25,45056
T a[110:111],v25,47104
M v[80:83],a[84:87],v[208:211],v[80:83]
buffer_load_dwordx4 v0, s[12:15], s85 offen offset:2048 lds
M v[80:83],a[88:91],v[224:227],v[80:83]
SA s85,s38,18432
T a[112:113],v25,49152
T a[114:115],v25,51200
M v[80:83],a[92:95],v[240:243],v[80:83]
T a[116:117],v25,53248
T a[118:119],v25,55296
M v[84:87],a[92:95],v[244:247],0
buffer_load_dwordx4 v0, s[12:15], s85 offen offset:3072 lds
M v[84:87],a[88:91],v[228:231],v[84:87]
SA m0,s28,4096
T a[120:121],v25,57344
T a[122:123],v25,59392
M v[84:87],a[84:87],v[212:215],v[84:87]
SA s85,s38,28672
T a[124:125],v25,61440
T a[126:127],v25,63488
M v[84:87],a[80:83],v[196:199],v[84:87]
buffer_load_dwordx4 v0, s[12:15], s85 offen offset:0 lds
M v[84:87],a[76:79],v[180:183],v[84:87]
SA s85,s38,34816
v_mov_b32 v15, 1
v_cndmask_b32 v17, v16, v14, vcc
M v[84:87],a[72:75],v[164:167],v[84:87]
buffer_load_dwordx4 v0, s[12:15], s85 offen offset:1024 lds
M v[84:87],a[68:71],v[148:151],v[84:87]
s_waitcnt vmcnt(14) lgkmcnt(0)
v_add_u32 v40, 0x20000, v18
v_add_u32 v41, 0x20000, v19
M v[84:87],a[64:67],v[132:135],v[84:87]
s_barrier
M v[88:91],a[96:99],v[128:131],0
SA s85,s38,40960
T a[64:65],v18,32768
T a[66:67],v18,34816
M v[88:91],a[100:103],v[144:147],v[88:91]
T a[68:69],v18,36864
T a[70:71],v18,38912
M v[88:91],a[104:107],v[160:163],v[88:91]
buffer_load_dwordx4 v0, s[12:15], s85 offen offset:2048 lds
M v[88:91],a[108:111],v[176:179],v[88:91]
SA s85,s38,47104
T a[72:73],v18,40960
T a[74:75],v18,43008
M v[88:91],a[112:115],v[192:195],v[88:91]
T a[76:77],v18,45056
T a[78:79],v18,47104
M v[88:91],a[116:119],v[208:211],v[88:91]
buffer_load_dwordx4 v0, s[12:15], s85 offen offset:3072 lds
M v[88:91],a[120:123],v[224:227],v[88:91]
SA s38,s38,128
T a[80:81],v18,49152
T a[82:83],v18,51200
M v[88:91],a[124:127],v[240:243],v[88:91]
SA m0,s28,131072
T a[84:85],v18,53248
T a[86:87],v18,55296
M v[92:95],a[124:127],v[244:247],0
SA s85,s38,0
buffer_load_dwordx4 v0, s[12:15], s85 offen offset:0 lds
M v[92:95],a[120:123],v[228:231],v[92:95]
SA s85,s38,6144
T a[88:89],v18,57344
T a[90:91],v18,59392
M v[92:95],a[116:119],v[212:215],v[92:95]
T a[92:93],v18,61440
T a[94:95],v18,63488
M v[92:95],a[112:115],v[196:199],v[92:95]
buffer_load_dwordx4 v0, s[12:15], s85 offen offset:1024 lds
M v[92:95],a[108:111],v[180:183],v[92:95]
SA s85,s38,12288
v_add_u32 v42, 0x20000, v20
v_add_u32 v43, 0x20000, v21
M v[92:95],a[104:107],v[164:167],v[92:95]
buffer_load_dwordx4 v0, s[12:15], s85 offen offset:2048 lds
M v[92:95],a[100:103],v[148:151],v[92:95]
s_waitcnt lgkmcnt(0)
MF v64,v5,v64
MF v65,v5,v65
M v[92:95],a[96:99],v[132:135],v[92:95]
SA s85,s38,18432
MF v66,v5,v66
MF v67,v5,v67
MF v72,v5,v72
MF v73,v5,v73
MF v74,v5,v74
MF v75,v5,v75
C v64,v64,v65
C v65,v66,v67
C v66,v72,v73
C v67,v74,v75
buffer_store_dwordx4 v[64:67], v7, s[8:11], s29 offen offset:0 sc1
MF v68,v6,v68
MF v69,v6,v69
MF v70,v6,v70
MF v71,v6,v71
MF v76,v6,v76
MF v77,v6,v77
MF v78,v6,v78
MF v79,v6,v79
C v68,v68,v69
C v69,v70,v71
C v70,v76,v77
C v71,v78,v79
buffer_store_dwordx4 v[68:71], v7, s[8:11], s30 offen offset:0 sc1
buffer_load_dwordx4 v0, s[12:15], s85 offen offset:3072 lds
M v[96:99],a[64:67],v[128:131],0
s_nop 0
T a[96:97],v19,32768
T a[98:99],v19,34816
M v[96:99],a[68:71],v[144:147],v[96:99]
SA m0,s28,135168
T a[100:101],v19,36864
T a[102:103],v19,38912
M v[96:99],a[72:75],v[160:163],v[96:99]
SA s85,s38,28672
buffer_load_dwordx4 v0, s[12:15], s85 offen offset:0 lds
M v[96:99],a[76:79],v[176:179],v[96:99]
SA s85,s38,34816
T a[104:105],v19,40960
T a[106:107],v19,43008
M v[96:99],a[80:83],v[192:195],v[96:99]
T a[108:109],v19,45056
T a[110:111],v19,47104
M v[96:99],a[84:87],v[208:211],v[96:99]
buffer_load_dwordx4 v0, s[12:15], s85 offen offset:1024 lds
M v[96:99],a[88:91],v[224:227],v[96:99]
s_nop 0
T a[112:113],v19,49152
T a[114:115],v19,51200
M v[96:99],a[92:95],v[240:243],v[96:99]
SA s85,s38,40960
T a[116:117],v19,53248
T a[118:119],v19,55296
M v[100:103],a[92:95],v[244:247],0
buffer_load_dwordx4 v0, s[12:15], s85 offen offset:2048 lds
M v[100:103],a[88:91],v[228:231],v[100:103]
s_nop 0
T a[120:121],v19,57344
T a[122:123],v19,59392
M v[100:103],a[84:87],v[212:215],v[100:103]
T a[124:125],v19,61440
T a[126:127],v19,63488
M v[100:103],a[80:83],v[196:199],v[100:103]
SA s85,s38,47104
MF v80,v5,v80
MF v81,v5,v81
M v[100:103],a[76:79],v[180:183],v[100:103]
buffer_load_dwordx4 v0, s[12:15], s85 offen offset:3072 lds
M v[100:103],a[72:75],v[164:167],v[100:103]
SA s38,s38,128
MF v82,v5,v82
MF v83,v5,v83
M v[100:103],a[68:71],v[148:151],v[100:103]
SA m0,s28,98304
MF v88,v5,v88
MF v89,v5,v89
M v[100:103],a[64:67],v[132:135],v[100:103]
s_waitcnt lgkmcnt(0)
MF v90,v5,v90
MF v91,v5,v91
M v[104:107],a[96:99],v[128:131],0
SA s85,s38,0
T a[64:65],v20,32768
T a[66:67],v20,34816
M v[104:107],a[100:103],v[144:147],v[104:107]
T a[68:69],v20,36864
T a[70:71],v20,38912
M v[104:107],a[104:107],v[160:163],v[104:107]
buffer_load_dwordx4 v0, s[12:15], s85 offen offset:0 lds
M v[104:107],a[108:111],v[176:179],v[104:107]
SA s85,s38,6144
T a[72:73],v20,40960
T a[74:75],v20,43008
M v[104:107],a[112:115],v[192:195],v[104:107]
T a[76:77],v20,45056
T a[78:79],v20,47104
M v[104:107],a[116:119],v[208:211],v[104:107]
buffer_load_dwordx4 v0, s[12:15], s85 offen offset:1024 lds
M v[104:107],a[120:123],v[224:227],v[104:107]
SA s85,s38,12288
T a[80:81],v20,49152
T a[82:83],v20,51200
M v[104:107],a[124:127],v[240:243],v[104:107]
T a[84:85],v20,53248
T a[86:87],v20,55296
M v[108:111],a[124:127],v[244:247],0
buffer_load_dwordx4 v0, s[12:15], s85 offen offset:2048 lds
M v[108:111],a[120:123],v[228:231],v[108:111]
SA s85,s38,18432
T a[88:89],v20,57344
T a[90:91],v20,59392
M v[108:111],a[116:119],v[212:215],v[108:111]
T a[92:93],v20,61440
T a[94:95],v20,63488
M v[108:111],a[112:115],v[196:199],v[108:111]
buffer_load_dwordx4 v0, s[12:15], s85 offen offset:3072 lds
M v[108:111],a[108:111],v[180:183],v[108:111]
SA m0,s28,102400
C v80,v80,v81
C v81,v82,v83
M v[108:111],a[104:107],v[164:167],v[108:111]
SA s85,s38,28672
C v82,v88,v89
C v83,v90,v91
M v[108:111],a[100:103],v[148:151],v[108:111]
buffer_store_dwordx4 v[80:83], v7, s[8:11], s29 offen offset:1024 sc1
M v[108:111],a[96:99],v[132:135],v[108:111]
s_waitcnt lgkmcnt(0)
MF v84,v6,v84
MF v85,v6,v85
M v[112:115],a[64:67],v[128:131],0
T a[96:97],v21,32768
T a[98:99],v21,34816
M v[112:115],a[68:71],v[144:147],v[112:115]
T a[100:101],v21,36864
T a[102:103],v21,38912
M v[112:115],a[72:75],v[160:163],v[112:115]
buffer_load_dwordx4 v0, s[12:15], s85 offen offset:0 lds
M v[112:115],a[76:79],v[176:179],v[112:115]
SA s85,s38,34816
T a[104:105],v21,40960
T a[106:107],v21,43008
M v[112:115],a[80:83],v[192:195],v[112:115]
T a[108:109],v21,45056
T a[110:111],v21,47104
M v[112:115],a[84:87],v[208:211],v[112:115]
buffer_load_dwordx4 v0, s[12:15], s85 offen offset:1024 lds
M v[112:115],a[88:91],v[224:227],v[112:115]
SA s85,s38,40960
T a[112:113],v21,49152
T a[114:115],v21,51200
M v[112:115],a[92:95],v[240:243],v[112:115]
T a[116:117],v21,53248
T a[118:119],v21,55296
M v[116:119],a[92:95],v[244:247],0
buffer_load_dwordx4 v0, s[12:15], s85 offen offset:2048 lds
M v[116:119],a[88:91],v[228:231],v[116:119]
SA s85,s38,47104
T a[120:121],v21,57344
T a[122:123],v21,59392
M v[116:119],a[84:87],v[212:215],v[116:119]
T a[124:125],v21,61440
T a[126:127],v21,63488
M v[116:119],a[80:83],v[196:199],v[116:119]
buffer_load_dwordx4 v0, s[12:15], s85 offen offset:3072 lds
M v[116:119],a[76:79],v[180:183],v[116:119]
MF v86,v6,v86
MF v87,v6,v87
M v[116:119],a[72:75],v[164:167],v[116:119]
SA s38,s38,128
MF v92,v6,v92
MF v93,v6,v93
M v[116:119],a[68:71],v[148:151],v[116:119]
s_waitcnt vmcnt(27) lgkmcnt(0)
MF v94,v6,v94
MF v95,v6,v95
M v[116:119],a[64:67],v[132:135],v[116:119]
s_barrier
M v[120:123],a[96:99],v[128:131],0
s_nop 0
T a[64:65],v22,0
T a[66:67],v22,2048
M v[120:123],a[100:103],v[144:147],v[120:123]
T a[68:69],v22,4096
T a[70:71],v22,6144
M v[120:123],a[104:107],v[160:163],v[120:123]
C v84,v84,v85
C v85,v86,v87
M v[120:123],a[108:111],v[176:179],v[120:123]
T a[72:73],v22,8192
T a[74:75],v22,10240
M v[120:123],a[112:115],v[192:195],v[120:123]
T a[76:77],v22,12288
T a[78:79],v22,14336
M v[120:123],a[116:119],v[208:211],v[120:123]
C v86,v92,v93
C v87,v94,v95
M v[120:123],a[120:123],v[224:227],v[120:123]
T a[80:81],v22,16384
T a[82:83],v22,18432
M v[120:123],a[124:127],v[240:243],v[120:123]
T a[84:85],v22,20480
T a[86:87],v22,22528
M v[124:127],a[124:127],v[244:247],0
buffer_store_dwordx4 v[84:87], v7, s[8:11], s30 offen offset:1024 sc1
M v[124:127],a[120:123],v[228:231],v[124:127]
SA s29,s33,2048
T a[88:89],v22,24576
T a[90:91],v22,26624
M v[124:127],a[116:119],v[212:215],v[124:127]
SA s30,s33,16384
T a[92:93],v22,28672
T a[94:95],v22,30720
M v[124:127],a[112:115],v[196:199],v[124:127]
MF v96,v5,v96
MF v97,v5,v97
M v[124:127],a[108:111],v[180:183],v[124:127]
MF v98,v5,v98
MF v99,v5,v99
M v[124:127],a[104:107],v[164:167],v[124:127]
MF v104,v5,v104
MF v105,v5,v105
M v[124:127],a[100:103],v[148:151],v[124:127]
s_waitcnt lgkmcnt(0)
MF v106,v5,v106
MF v107,v5,v107
M v[124:127],a[96:99],v[132:135],v[124:127]
C v96,v96,v97
C v97,v98,v99
C v98,v104,v105
C v99,v106,v107
buffer_store_dwordx4 v[96:99], v7, s[8:11], s29 offen offset:0 sc1
MF v100,v6,v100
MF v101,v6,v101
MF v102,v6,v102
MF v103,v6,v103
MF v108,v6,v108
MF v109,v6,v109
MF v110,v6,v110
MF v111,v6,v111
C v100,v100,v101
C v101,v102,v103
C v102,v108,v109
C v103,v110,v111
buffer_store_dwordx4 v[100:103], v7, s[8:11], s30 offen offset:0 sc1
M v[64:67],a[64:67],v[128:131],0
s_nop 0
T a[96:97],v23,0
T a[98:99],v23,2048
M v[64:67],a[68:71],v[144:147],v[64:67]
SA m0,s28,32768
T a[100:101],v23,4096
T a[102:103],v23,6144
M v[64:67],a[72:75],v[160:163],v[64:67]
SA s85,s38,0
buffer_load_dwordx4 v0, s[12:15], s85 offen offset:0 lds
M v[64:67],a[76:79],v[176:179],v[64:67]
s_nop 0
T a[104:105],v23,8192
T a[106:107],v23,10240
M v[64:67],a[80:83],v[192:195],v[64:67]
T a[108:109],v23,12288
T a[110:111],v23,14336
M v[64:67],a[84:87],v[208:211],v[64:67]
SA s85,s38,6144
MF v112,v5,v112
MF v113,v5,v113
M v[64:67],a[88:91],v[224:227],v[64:67]
T a[112:113],v23,16384
T a[114:115],v23,18432
M v[64:67],a[92:95],v[240:243],v[64:67]
T a[116:117],v23,20480
T a[118:119],v23,22528
M v[68:71],a[92:95],v[244:247],0
buffer_load_dwordx4 v0, s[12:15], s85 offen offset:1024 lds
M v[68:71],a[88:91],v[228:231],v[68:71]
s_nop 0
T a[120:121],v23,24576
T a[122:123],v23,26624
M v[68:71],a[84:87],v[212:215],v[68:71]
T a[124:125],v23,28672
T a[126:127],v23,30720
M v[68:71],a[80:83],v[196:199],v[68:71]
SA s85,s38,12288
MF v114,v5,v114
MF v115,v5,v115
M v[68:71],a[76:79],v[180:183],v[68:71]
buffer_load_dwordx4 v0, s[12:15], s85 offen offset:2048 lds
M v[68:71],a[72:75],v[164:167],v[68:71]
MF v120,v5,v120
MF v121,v5,v121
M v[68:71],a[68:71],v[148:151],v[68:71]
MF v122,v5,v122
MF v123,v5,v123
M v[68:71],a[64:67],v[132:135],v[68:71]
s_waitcnt lgkmcnt(0)
C v112,v112,v113
C v113,v114,v115
M v[72:75],a[96:99],v[128:131],0
SA s85,s38,18432
T a[64:65],v24,0
T a[66:67],v24,2048
M v[72:75],a[100:103],v[144:147],v[72:75]
T a[68:69],v24,4096
T a[70:71],v24,6144
M v[72:75],a[104:107],v[160:163],v[72:75]
buffer_load_dwordx4 v0, s[12:15], s85 offen offset:3072 lds
M v[72:75],a[108:111],v[176:179],v[72:75]
s_nop 0
T a[72:73],v24,8192
T a[74:75],v24,10240
M v[72:75],a[112:115],v[192:195],v[72:75]
T a[76:77],v24,12288
T a[78:79],v24,14336
M v[72:75],a[116:119],v[208:211],v[72:75]
SA m0,s28,36864
C v114,v120,v121
C v115,v122,v123
M v[72:75],a[120:123],v[224:227],v[72:75]
SA s85,s38,28672
T a[80:81],v24,16384
T a[82:83],v24,18432
M v[72:75],a[124:127],v[240:243],v[72:75]
T a[84:85],v24,20480
T a[86:87],v24,22528
M v[76:79],a[124:127],v[244:247],0
buffer_store_dwordx4 v[112:115], v7, s[8:11], s29 offen offset:1024 sc1
M v[76:79],a[120:123],v[228:231],v[76:79]
s_nop 0
T a[88:89],v24,24576
T a[90:91],v24,26624
M v[76:79],a[116:119],v[212:215],v[76:79]
T a[92:93],v24,28672
T a[94:95],v24,30720
M v[76:79],a[112:115],v[196:199],v[76:79]
buffer_load_dwordx4 v0, s[12:15], s85 offen offset:0 lds
M v[76:79],a[108:111],v[180:183],v[76:79]
SA s85,s38,34816
MF v116,v6,v116
MF v117,v6,v117
M v[76:79],a[104:107],v[164:167],v[76:79]
MF v118,v6,v118
MF v119,v6,v119
M v[76:79],a[100:103],v[148:151],v[76:79]
buffer_load_dwordx4 v0, s[12:15], s85 offen offset:1024 lds
M v[76:79],a[96:99],v[132:135],v[76:79]
s_waitcnt lgkmcnt(0)
MF v124,v6,v124
MF v125,v6,v125
M v[80:83],a[64:67],v[128:131],0
T a[96:97],v25,0
T a[98:99],v25,2048
M v[80:83],a[68:71],v[144:147],v[80:83]
SA s85,s38,40960
T a[100:101],v25,4096
T a[102:103],v25,6144
M v[80:83],a[72:75],v[160:163],v[80:83]
buffer_load_dwordx4 v0, s[12:15], s85 offen offset:2048 lds
M v[80:83],a[76:79],v[176:179],v[80:83]
s_nop 0
T a[104:105],v25,8192
T a[106:107],v25,10240
M v[80:83],a[80:83],v[192:195],v[80:83]
T a[108:109],v25,12288
T a[110:111],v25,14336
M v[80:83],a[84:87],v[208:211],v[80:83]
MF v126,v6,v126
MF v127,v6,v127
M v[80:83],a[88:91],v[224:227],v[80:83]
SA s85,s38,47104
T a[112:113],v25,16384
T a[114:115],v25,18432
M v[80:83],a[92:95],v[240:243],v[80:83]
T a[116:117],v25,20480
T a[118:119],v25,22528
M v[84:87],a[92:95],v[244:247],0
buffer_load_dwordx4 v0, s[12:15], s85 offen offset:3072 lds
M v[84:87],a[88:91],v[228:231],v[84:87]
s_nop 0
T a[120:121],v25,24576
T a[122:123],v25,26624
M v[84:87],a[84:87],v[212:215],v[84:87]
T a[124:125],v25,28672
T a[126:127],v25,30720
M v[84:87],a[80:83],v[196:199],v[84:87]
C v116,v116,v117
C v117,v118,v119
M v[84:87],a[76:79],v[180:183],v[84:87]
C v118,v124,v125
C v119,v126,v127
M v[84:87],a[72:75],v[164:167],v[84:87]
SA s38,s38,128
buffer_store_dwordx4 v[116:119], v7, s[8:11], s30 offen offset:1024 sc1
M v[84:87],a[68:71],v[148:151],v[84:87]
s_waitcnt vmcnt(32) lgkmcnt(0)
M v[84:87],a[64:67],v[132:135],v[84:87]
s_barrier
M v[88:91],a[96:99],v[128:131],0
SA s29,s33,4096
T a[64:65],v18,0
T a[66:67],v18,2048
M v[88:91],a[100:103],v[144:147],v[88:91]
SA s30,s33,18432
T a[68:69],v18,4096
T a[70:71],v18,6144
M v[88:91],a[104:107],v[160:163],v[88:91]
MF v64,v5,v64
MF v65,v5,v65
M v[88:91],a[108:111],v[176:179],v[88:91]
T a[72:73],v18,8192
T a[74:75],v18,10240
M v[88:91],a[112:115],v[192:195],v[88:91]
T a[76:77],v18,12288
T a[78:79],v18,14336
M v[88:91],a[116:119],v[208:211],v[88:91]
MF v66,v5,v66
MF v67,v5,v67
M v[88:91],a[120:123],v[224:227],v[88:91]
T a[80:81],v18,16384
T a[82:83],v18,18432
M v[88:91],a[124:127],v[240:243],v[88:91]
T a[84:85],v18,20480
T a[86:87],v18,22528
M v[92:95],a[124:127],v[244:247],0
MF v72,v5,v72
MF v73,v5,v73
M v[92:95],a[120:123],v[228:231],v[92:95]
T a[88:89],v18,24576
T a[90:91],v18,26624
M v[92:95],a[116:119],v[212:215],v[92:95]
T a[92:93],v18,28672
T a[94:95],v18,30720
M v[92:95],a[112:115],v[196:199],v[92:95]
MF v74,v5,v74
MF v75,v5,v75
M v[92:95],a[108:111],v[180:183],v[92:95]
C v64,v64,v65
C v65,v66,v67
M v[92:95],a[104:107],v[164:167],v[92:95]
C v66,v72,v73
C v67,v74,v75
M v[92:95],a[100:103],v[148:151],v[92:95]
s_waitcnt lgkmcnt(0)
buffer_store_dwordx4 v[64:67], v7, s[8:11], s29 offen offset:0 sc1
M v[92:95],a[96:99],v[132:135],v[92:95]
MF v68,v6,v68
MF v69,v6,v69
MF v70,v6,v70
MF v71,v6,v71
MF v76,v6,v76
MF v77,v6,v77
MF v78,v6,v78
MF v79,v6,v79
C v68,v68,v69
C v69,v70,v71
C v70,v76,v77
C v71,v78,v79
buffer_store_dwordx4 v[68:71], v7, s[8:11], s30 offen offset:0 sc1
M v[96:99],a[64:67],v[128:131],0
s_nop 0
T a[96:97],v19,0
T a[98:99],v19,2048
M v[96:99],a[68:71],v[144:147],v[96:99]
T a[100:101],v19,4096
T a[102:103],v19,6144
M v[96:99],a[72:75],v[160:163],v[96:99]
MF v80,v5,v80
MF v81,v5,v81
M v[96:99],a[76:79],v[176:179],v[96:99]
T a[104:105],v19,8192
T a[106:107],v19,10240
M v[96:99],a[80:83],v[192:195],v[96:99]
T a[108:109],v19,12288
T a[110:111],v19,14336
M v[96:99],a[84:87],v[208:211],v[96:99]
MF v82,v5,v82
MF v83,v5,v83
M v[96:99],a[88:91],v[224:227],v[96:99]
T a[112:113],v19,16384
T a[114:115],v19,18432
M v[96:99],a[92:95],v[240:243],v[96:99]
T a[116:117],v19,20480
T a[118:119],v19,22528
M v[100:103],a[92:95],v[244:247],0
MF v88,v5,v88
MF v89,v5,v89
M v[100:103],a[88:91],v[228:231],v[100:103]
T a[120:121],v19,24576
T a[122:123],v19,26624
M v[100:103],a[84:87],v[212:215],v[100:103]
T a[124:125],v19,28672
T a[126:127],v19,30720
M v[100:103],a[80:83],v[196:199],v[100:103]
MF v90,v5,v90
MF v91,v5,v91
M v[100:103],a[76:79],v[180:183],v[100:103]
C v80,v80,v81
C v81,v82,v83
M v[100:103],a[72:75],v[164:167],v[100:103]
C v82,v88,v89
C v83,v90,v91
M v[100:103],a[68:71],v[148:151],v[100:103]
buffer_store_dwordx4 v[80:83], v7, s[8:11], s29 offen offset:1024 sc1
M v[100:103],a[64:67],v[132:135],v[100:103]
s_waitcnt lgkmcnt(0)
MF v84,v6,v84
MF v85,v6,v85
M v[104:107],a[96:99],v[128:131],0
T a[64:65],v20,0
T a[66:67],v20,2048
M v[104:107],a[100:103],v[144:147],v[104:107]
T a[68:69],v20,4096
T a[70:71],v20,6144
M v[104:107],a[104:107],v[160:163],v[104:107]
MF v86,v6,v86
MF v87,v6,v87
M v[104:107],a[108:111],v[176:179],v[104:107]
T a[72:73],v20,8192
T a[74:75],v20,10240
M v[104:107],a[112:115],v[192:195],v[104:107]
T a[76:77],v20,12288
T a[78:79],v20,14336
M v[104:107],a[116:119],v[208:211],v[104:107]
MF v92,v6,v92
MF v93,v6,v93
M v[104:107],a[120:123],v[224:227],v[104:107]
T a[80:81],v20,16384
T a[82:83],v20,18432
M v[104:107],a[124:127],v[240:243],v[104:107]
T a[84:85],v20,20480
T a[86:87],v20,22528
M v[108:111],a[124:127],v[244:247],0
MF v94,v6,v94
MF v95,v6,v95
M v[108:111],a[120:123],v[228:231],v[108:111]
T a[88:89],v20,24576
T a[90:91],v20,26624
M v[108:111],a[116:119],v[212:215],v[108:111]
T a[92:93],v20,28672
T a[94:95],v20,30720
M v[108:111],a[112:115],v[196:199],v[108:111]
C v84,v84,v85
C v85,v86,v87
M v[108:111],a[108:111],v[180:183],v[108:111]
C v86,v92,v93
C v87,v94,v95
M v[108:111],a[104:107],v[164:167],v[108:111]
buffer_store_dwordx4 v[84:87], v7, s[8:11], s30 offen offset:1024 sc1
M v[108:111],a[100:103],v[148:151],v[108:111]
SA s29,s33,6144
M v[108:111],a[96:99],v[132:135],v[108:111]
s_waitcnt lgkmcnt(0)
M v[112:115],a[64:67],v[128:131],0
SA s30,s33,20480
T a[96:97],v21,0
T a[98:99],v21,2048
M v[112:115],a[68:71],v[144:147],v[112:115]
T a[100:101],v21,4096
T a[102:103],v21,6144
M v[112:115],a[72:75],v[160:163],v[112:115]
MF v96,v5,v96
MF v97,v5,v97
M v[112:115],a[76:79],v[176:179],v[112:115]
T a[104:105],v21,8192
T a[106:107],v21,10240
M v[112:115],a[80:83],v[192:195],v[112:115]
T a[108:109],v21,12288
T a[110:111],v21,14336
M v[112:115],a[84:87],v[208:211],v[112:115]
MF v98,v5,v98
MF v99,v5,v99
M v[112:115],a[88:91],v[224:227],v[112:115]
T a[112:113],v21,16384
T a[114:115],v21,18432
M v[112:115],a[92:95],v[240:243],v[112:115]
T a[116:117],v21,20480
T a[118:119],v21,22528
M v[116:119],a[92:95],v[244:247],0
MF v104,v5,v104
MF v105,v5,v105
M v[116:119],a[88:91],v[228:231],v[116:119]
T a[120:121],v21,24576
T a[122:123],v21,26624
M v[116:119],a[84:87],v[212:215],v[116:119]
T a[124:125],v21,28672
T a[126:127],v21,30720
M v[116:119],a[80:83],v[196:199],v[116:119]
MF v106,v5,v106
MF v107,v5,v107
M v[116:119],a[76:79],v[180:183],v[116:119]
C v96,v96,v97
C v97,v98,v99
M v[116:119],a[72:75],v[164:167],v[116:119]
C v98,v104,v105
C v99,v106,v107
M v[116:119],a[68:71],v[148:151],v[116:119]
s_waitcnt vmcnt(26) lgkmcnt(0)
buffer_store_dwordx4 v[96:99], v7, s[8:11], s29 offen offset:0 sc1
M v[116:119],a[64:67],v[132:135],v[116:119]
s_barrier
M v[120:123],a[96:99],v[128:131],0
s_nop 0
T a[64:65],v40,0
T a[66:67],v40,2048
M v[120:123],a[100:103],v[144:147],v[120:123]
T a[68:69],v40,4096
T a[70:71],v40,6144
M v[120:123],a[104:107],v[160:163],v[120:123]
MF v100,v6,v100
MF v101,v6,v101
M v[120:123],a[108:111],v[176:179],v[120:123]
T a[72:73],v40,8192
T a[74:75],v40,10240
M v[120:123],a[112:115],v[192:195],v[120:123]
T a[76:77],v40,12288
T a[78:79],v40,14336
M v[120:123],a[116:119],v[208:211],v[120:123]
MF v102,v6,v102
MF v103,v6,v103
M v[120:123],a[120:123],v[224:227],v[120:123]
T a[80:81],v40,16384
T a[82:83],v40,18432
M v[120:123],a[124:127],v[240:243],v[120:123]
T a[84:85],v40,20480
T a[86:87],v40,22528
M v[124:127],a[124:127],v[244:247],0
MF v108,v6,v108
MF v109,v6,v109
M v[124:127],a[120:123],v[228:231],v[124:127]
T a[88:89],v40,24576
T a[90:91],v40,26624
M v[124:127],a[116:119],v[212:215],v[124:127]
T a[92:93],v40,28672
T a[94:95],v40,30720
M v[124:127],a[112:115],v[196:199],v[124:127]
MF v110,v6,v110
MF v111,v6,v111
M v[124:127],a[108:111],v[180:183],v[124:127]
C v100,v100,v101
C v101,v102,v103
M v[124:127],a[104:107],v[164:167],v[124:127]
C v102,v108,v109
C v103,v110,v111
M v[124:127],a[100:103],v[148:151],v[124:127]
s_waitcnt lgkmcnt(0)
buffer_store_dwordx4 v[100:103], v7, s[8:11], s30 offen offset:0 sc1
M v[124:127],a[96:99],v[132:135],v[124:127]
M v[64:67],a[64:67],v[128:131],0
s_nop 0
T a[96:97],v41,0
T a[98:99],v41,2048
M v[64:67],a[68:71],v[144:147],v[64:67]
T a[100:101],v41,4096
T a[102:103],v41,6144
M v[64:67],a[72:75],v[160:163],v[64:67]
v_lshrrev_b32 v32, 4, v7
MF v112,v5,v112
M v[64:67],a[76:79],v[176:179],v[64:67]
s_lshr_b32 s74, s41, 3
T a[104:105],v41,8192
T a[106:107],v41,10240
M v[64:67],a[80:83],v[192:195],v[64:67]
s_sub_u32 s64, 15, s42
T a[108:109],v41,12288
T a[110:111],v41,14336
M v[64:67],a[84:87],v[208:211],v[64:67]
s_mul_i32 s46, s64, 8704
MF v113,v5,v113
MF v114,v5,v114
M v[64:67],a[88:91],v[224:227],v[64:67]
s_and_b32 s72, s41, 7
T a[112:113],v41,16384
T a[114:115],v41,18432
M v[64:67],a[92:95],v[240:243],v[64:67]
s_lshl_b32 s65, s72, 7
T a[116:117],v41,20480
T a[118:119],v41,22528
M v[68:71],a[92:95],v[244:247],0
SA s46,s46,s65
MF v115,v5,v115
MF v120,v5,v120
M v[68:71],a[88:91],v[228:231],v[68:71]
SA s46,s46,104993792
T a[120:121],v41,24576
T a[122:123],v41,26624
M v[68:71],a[84:87],v[212:215],v[68:71]
T a[124:125],v41,28672
T a[126:127],v41,30720
M v[68:71],a[80:83],v[196:199],v[68:71]
v_and_b32 v33, 31, v32
MF v121,v5,v121
M v[68:71],a[76:79],v[180:183],v[68:71]
MF v122,v5,v122
MF v123,v5,v123
M v[68:71],a[72:75],v[164:167],v[68:71]
C v112,v112,v113
C v113,v114,v115
M v[68:71],a[68:71],v[148:151],v[68:71]
C v114,v120,v121
C v115,v122,v123
M v[68:71],a[64:67],v[132:135],v[68:71]
s_waitcnt lgkmcnt(0)
buffer_store_dwordx4 v[112:115], v7, s[8:11], s29 offen offset:1024 sc1
M v[72:75],a[96:99],v[128:131],0
s_nop 0
T a[64:65],v42,0
T a[66:67],v42,2048
M v[72:75],a[100:103],v[144:147],v[72:75]
T a[68:69],v42,4096
T a[70:71],v42,6144
M v[72:75],a[104:107],v[160:163],v[72:75]
MF v116,v6,v116
MF v117,v6,v117
M v[72:75],a[108:111],v[176:179],v[72:75]
T a[72:73],v42,8192
T a[74:75],v42,10240
M v[72:75],a[112:115],v[192:195],v[72:75]
T a[76:77],v42,12288
T a[78:79],v42,14336
M v[72:75],a[116:119],v[208:211],v[72:75]
MF v118,v6,v118
MF v119,v6,v119
M v[72:75],a[120:123],v[224:227],v[72:75]
T a[80:81],v42,16384
T a[82:83],v42,18432
M v[72:75],a[124:127],v[240:243],v[72:75]
T a[84:85],v42,20480
T a[86:87],v42,22528
M v[76:79],a[124:127],v[244:247],0
MF v124,v6,v124
MF v125,v6,v125
M v[76:79],a[120:123],v[228:231],v[76:79]
T a[88:89],v42,24576
T a[90:91],v42,26624
M v[76:79],a[116:119],v[212:215],v[76:79]
T a[92:93],v42,28672
T a[94:95],v42,30720
M v[76:79],a[112:115],v[196:199],v[76:79]
MF v126,v6,v126
MF v127,v6,v127
M v[76:79],a[108:111],v[180:183],v[76:79]
C v116,v116,v117
C v117,v118,v119
M v[76:79],a[104:107],v[164:167],v[76:79]
C v118,v124,v125
C v119,v126,v127
M v[76:79],a[100:103],v[148:151],v[76:79]
buffer_store_dwordx4 v[116:119], v7, s[8:11], s30 offen offset:1024 sc1
M v[76:79],a[96:99],v[132:135],v[76:79]
s_waitcnt lgkmcnt(0)
v_lshlrev_b32 v33, 2, v33
M v[80:83],a[64:67],v[128:131],0
SA s29,s33,8192
T a[96:97],v43,0
T a[98:99],v43,2048
M v[80:83],a[68:71],v[144:147],v[80:83]
SA s30,s33,22528
T a[100:101],v43,4096
T a[102:103],v43,6144
M v[80:83],a[72:75],v[160:163],v[80:83]
s_lshl_b32 s65, s41, 7
MF v64,v5,v64
MF v65,v5,v65
M v[80:83],a[76:79],v[176:179],v[80:83]
SA s65,s65,104890368
T a[104:105],v43,8192
T a[106:107],v43,10240
M v[80:83],a[80:83],v[192:195],v[80:83]
T a[108:109],v43,12288
T a[110:111],v43,14336
M v[80:83],a[84:87],v[208:211],v[80:83]
buffer_load_dword v31, v33, s[8:11], s65 offen sc1
M v[80:83],a[88:91],v[224:227],v[80:83]
s_nop 0
T a[112:113],v43,16384
T a[114:115],v43,18432
M v[80:83],a[92:95],v[240:243],v[80:83]
T a[116:117],v43,20480
T a[118:119],v43,22528
M v[84:87],a[92:95],v[244:247],0
s_cmp_ge_u32 s42, 8
v_bfe_u32 v34, v32, 4, 1
v_lshlrev_b32 v34, 1, v34
M v[84:87],a[88:91],v[228:231],v[84:87]
s_cselect_b32 s84, s45, 536870912
T a[120:121],v43,24576
T a[122:123],v43,26624
M v[84:87],a[84:87],v[212:215],v[84:87]
T a[124:125],v43,28672
T a[126:127],v43,30720
M v[84:87],a[80:83],v[196:199],v[84:87]
v_lshrrev_b32 v35, 5, v32
v_add_u32 v34, v34, v35
M v[84:87],a[76:79],v[180:183],v[84:87]
s_mov_b32 s52, s96
MF v66,v5,v66
MF v67,v5,v67
M v[84:87],a[72:75],v[164:167],v[84:87]
s_and_b32 s53, s97, 0xffff
MF v72,v5,v72
MF v73,v5,v73
M v[84:87],a[68:71],v[148:151],v[84:87]
s_waitcnt vmcnt(22) lgkmcnt(0)
MF v74,v5,v74
MF v75,v5,v75
M v[84:87],a[64:67],v[132:135],v[84:87]
s_barrier
M v[88:91],a[96:99],v[128:131],0
s_mov_b32 s54, 1835008
T a[64:65],v22,32768
T a[66:67],v22,34816
M v[88:91],a[100:103],v[144:147],v[88:91]
s_mov_b32 s55, 0x20000
T a[68:69],v22,36864
T a[70:71],v22,38912
M v[88:91],a[104:107],v[160:163],v[88:91]
s_mul_i32 s77, s42, 1835008
C v64,v64,v65
C v65,v66,v67
M v[88:91],a[108:111],v[176:179],v[88:91]
s_mul_i32 s78, s72, 14336
T a[72:73],v22,40960
T a[74:75],v22,43008
M v[88:91],a[112:115],v[192:195],v[88:91]
SA s77,s77,s78
T a[76:77],v22,45056
T a[78:79],v22,47104
M v[88:91],a[116:119],v[208:211],v[88:91]
SA s77,s77,67108864
C v66,v72,v73
C v67,v74,v75
M v[88:91],a[120:123],v[224:227],v[88:91]
s_lshl_b32 s79, s74, 2
T a[80:81],v22,49152
T a[82:83],v22,51200
M v[88:91],a[124:127],v[240:243],v[88:91]
SA s79,s79,s20
T a[84:85],v22,53248
T a[86:87],v22,55296
M v[92:95],a[124:127],v[244:247],0
SA s79,s79,6
buffer_store_dwordx4 v[64:67], v7, s[8:11], s29 offen offset:0 sc1
M v[92:95],a[120:123],v[228:231],v[92:95]
s_sub_u32 s67, 13, s79
T a[88:89],v22,57344
T a[90:91],v22,59392
M v[92:95],a[116:119],v[212:215],v[92:95]
s_and_b32 s67, s67, 536870912
T a[92:93],v22,61440
T a[94:95],v22,63488
M v[92:95],a[112:115],v[196:199],v[92:95]
s_lshl_b32 s78, s79, 10
MF v68,v6,v68
MF v69,v6,v69
M v[92:95],a[108:111],v[180:183],v[92:95]
SA s78,s78,s77
MF v70,v6,v70
MF v71,v6,v71
M v[92:95],a[104:107],v[164:167],v[92:95]
s_lshl_b32 s79, s79, 6
MF v76,v6,v76
MF v77,v6,v77
M v[92:95],a[100:103],v[148:151],v[92:95]
s_waitcnt lgkmcnt(0)
MF v78,v6,v78
MF v79,v6,v79
M v[92:95],a[96:99],v[132:135],v[92:95]
s_or_b32 s79, s79, s67
v_or_b32 v27, s67, v7
s_lshr_b32 s73, s72, 1
s_sub_u32 s65, 7, s73
s_bitcmp1_b32 s72, 0
s_cselect_b32 s73, s65, s73
s_lshl_b32 s73, s73, 4
s_lshl_b32 s65, s42, 7
SA s73,s73,s65
v_and_b32 v29, 15, v32
v_add_u32 v29, s73, v29
s_mov_b32 s64, 104857664
v_mul_u32_u24 v28, 896, v29
v_lshl_add_u32 v28, v34, 4, v28
C v68,v68,v69
C v69,v70,v71
C v70,v76,v77
C v71,v78,v79
buffer_store_dwordx4 v[68:71], v7, s[8:11], s30 offen offset:0 sc1
v_lshrrev_b32 v35, 4, v29
v_lshlrev_b32 v35, 5, v35
v_and_b32 v36, 15, v29
v_add_lshl_u32 v35, v35, v36, 2
buffer_load_dword v26, v35, s[8:11], s64 offen sc1
s_waitcnt vmcnt(8)
buffer_store_dword v15, v17, s[8:11], s84 offen sc1
buffer_load_dwordx4 v[44:47], v28, s[56:59], s79 offen
M v[96:99],a[64:67],v[128:131],0
s_nop 0
T a[96:97],v23,32768
T a[98:99],v23,34816
M v[96:99],a[68:71],v[144:147],v[96:99]
T a[100:101],v23,36864
T a[102:103],v23,38912
M v[96:99],a[72:75],v[160:163],v[96:99]
MF v80,v5,v80
MF v81,v5,v81
M v[96:99],a[76:79],v[176:179],v[96:99]
T a[104:105],v23,40960
T a[106:107],v23,43008
M v[96:99],a[80:83],v[192:195],v[96:99]
T a[108:109],v23,45056
T a[110:111],v23,47104
M v[96:99],a[84:87],v[208:211],v[96:99]
MF v82,v5,v82
MF v83,v5,v83
M v[96:99],a[88:91],v[224:227],v[96:99]
T a[112:113],v23,49152
T a[114:115],v23,51200
M v[96:99],a[92:95],v[240:243],v[96:99]
T a[116:117],v23,53248
T a[118:119],v23,55296
M v[100:103],a[92:95],v[244:247],0
MF v88,v5,v88
MF v89,v5,v89
M v[100:103],a[88:91],v[228:231],v[100:103]
T a[120:121],v23,57344
T a[122:123],v23,59392
M v[100:103],a[84:87],v[212:215],v[100:103]
T a[124:125],v23,61440
T a[126:127],v23,63488
M v[100:103],a[80:83],v[196:199],v[100:103]
MF v90,v5,v90
MF v91,v5,v91
M v[100:103],a[76:79],v[180:183],v[100:103]
C v80,v80,v81
C v81,v82,v83
M v[100:103],a[72:75],v[164:167],v[100:103]
C v82,v88,v89
C v83,v90,v91
M v[100:103],a[68:71],v[148:151],v[100:103]
buffer_store_dwordx4 v[80:83], v7, s[8:11], s29 offen offset:1024 sc1
M v[100:103],a[64:67],v[132:135],v[100:103]
s_waitcnt lgkmcnt(0)
MF v84,v6,v84
MF v85,v6,v85
M v[104:107],a[96:99],v[128:131],0
T a[64:65],v24,32768
T a[66:67],v24,34816
M v[104:107],a[100:103],v[144:147],v[104:107]
T a[68:69],v24,36864
T a[70:71],v24,38912
M v[104:107],a[104:107],v[160:163],v[104:107]
MF v86,v6,v86
MF v87,v6,v87
M v[104:107],a[108:111],v[176:179],v[104:107]
T a[72:73],v24,40960
T a[74:75],v24,43008
M v[104:107],a[112:115],v[192:195],v[104:107]
T a[76:77],v24,45056
T a[78:79],v24,47104
M v[104:107],a[116:119],v[208:211],v[104:107]
MF v92,v6,v92
MF v93,v6,v93
M v[104:107],a[120:123],v[224:227],v[104:107]
T a[80:81],v24,49152
T a[82:83],v24,51200
M v[104:107],a[124:127],v[240:243],v[104:107]
T a[84:85],v24,53248
T a[86:87],v24,55296
M v[108:111],a[124:127],v[244:247],0
MF v94,v6,v94
MF v95,v6,v95
M v[108:111],a[120:123],v[228:231],v[108:111]
T a[88:89],v24,57344
T a[90:91],v24,59392
M v[108:111],a[116:119],v[212:215],v[108:111]
T a[92:93],v24,61440
T a[94:95],v24,63488
M v[108:111],a[112:115],v[196:199],v[108:111]
C v84,v84,v85
C v85,v86,v87
M v[108:111],a[108:111],v[180:183],v[108:111]
C v86,v92,v93
C v87,v94,v95
M v[108:111],a[104:107],v[164:167],v[108:111]
buffer_store_dwordx4 v[84:87], v7, s[8:11], s30 offen offset:1024 sc1
M v[108:111],a[100:103],v[148:151],v[108:111]
SA s29,s33,10240
M v[108:111],a[96:99],v[132:135],v[108:111]
s_waitcnt lgkmcnt(0)
M v[112:115],a[64:67],v[128:131],0
SA s30,s33,24576
T a[96:97],v25,32768
T a[98:99],v25,34816
M v[112:115],a[68:71],v[144:147],v[112:115]
T a[100:101],v25,36864
T a[102:103],v25,38912
M v[112:115],a[72:75],v[160:163],v[112:115]
MF v96,v5,v96
MF v97,v5,v97
M v[112:115],a[76:79],v[176:179],v[112:115]
T a[104:105],v25,40960
T a[106:107],v25,43008
M v[112:115],a[80:83],v[192:195],v[112:115]
T a[108:109],v25,45056
T a[110:111],v25,47104
M v[112:115],a[84:87],v[208:211],v[112:115]
MF v98,v5,v98
MF v99,v5,v99
M v[112:115],a[88:91],v[224:227],v[112:115]
T a[112:113],v25,49152
T a[114:115],v25,51200
M v[112:115],a[92:95],v[240:243],v[112:115]
T a[116:117],v25,53248
T a[118:119],v25,55296
M v[116:119],a[92:95],v[244:247],0
s_cmp_lt_u32 s42, 8
MF v104,v5,v104
MF v105,v5,v105
M v[116:119],a[88:91],v[228:231],v[116:119]
s_cselect_b32 s84, s45, 536870912
T a[120:121],v25,57344
T a[122:123],v25,59392
M v[116:119],a[84:87],v[212:215],v[116:119]
T a[124:125],v25,61440
T a[126:127],v25,63488
M v[116:119],a[80:83],v[196:199],v[116:119]
MF v106,v5,v106
MF v107,v5,v107
M v[116:119],a[76:79],v[180:183],v[116:119]
C v96,v96,v97
C v97,v98,v99
M v[116:119],a[72:75],v[164:167],v[116:119]
C v98,v104,v105
C v99,v106,v107
M v[116:119],a[68:71],v[148:151],v[116:119]
s_waitcnt lgkmcnt(0)
buffer_store_dwordx4 v[96:99], v7, s[8:11], s29 offen offset:0 sc1
M v[116:119],a[64:67],v[132:135],v[116:119]
s_barrier
M v[120:123],a[96:99],v[128:131],0
s_nop 0
T a[64:65],v18,32768
T a[66:67],v18,34816
M v[120:123],a[100:103],v[144:147],v[120:123]
T a[68:69],v18,36864
T a[70:71],v18,38912
M v[120:123],a[104:107],v[160:163],v[120:123]
MF v100,v6,v100
MF v101,v6,v101
M v[120:123],a[108:111],v[176:179],v[120:123]
T a[72:73],v18,40960
T a[74:75],v18,43008
M v[120:123],a[112:115],v[192:195],v[120:123]
s_waitcnt vmcnt(9)
T a[76:77],v18,45056
T a[78:79],v18,47104
M v[120:123],a[116:119],v[208:211],v[120:123]
buffer_store_dword v15, v17, s[8:11], s84 offen sc1
M v[120:123],a[120:123],v[224:227],v[120:123]
s_nop 0
T a[80:81],v18,49152
T a[82:83],v18,51200
M v[120:123],a[124:127],v[240:243],v[120:123]
T a[84:85],v18,53248
T a[86:87],v18,55296
M v[124:127],a[124:127],v[244:247],0
MF v102,v6,v102
MF v103,v6,v103
M v[124:127],a[120:123],v[228:231],v[124:127]
T a[88:89],v18,57344
T a[90:91],v18,59392
M v[124:127],a[116:119],v[212:215],v[124:127]
T a[92:93],v18,61440
T a[94:95],v18,63488
M v[124:127],a[112:115],v[196:199],v[124:127]
MF v108,v6,v108
MF v109,v6,v109
M v[124:127],a[108:111],v[180:183],v[124:127]
MF v110,v6,v110
MF v111,v6,v111
M v[124:127],a[104:107],v[164:167],v[124:127]
C v100,v100,v101
C v101,v102,v103
M v[124:127],a[100:103],v[148:151],v[124:127]
s_waitcnt lgkmcnt(0)
C v102,v108,v109
C v103,v110,v111
M v[124:127],a[96:99],v[132:135],v[124:127]
buffer_store_dwordx4 v[100:103], v7, s[8:11], s30 offen offset:0 sc1
M v[64:67],a[64:67],v[128:131],0
s_nop 0
T a[96:97],v19,32768
T a[98:99],v19,34816
M v[64:67],a[68:71],v[144:147],v[64:67]
T a[100:101],v19,36864
T a[102:103],v19,38912
M v[64:67],a[72:75],v[160:163],v[64:67]
MF v112,v5,v112
MF v113,v5,v113
M v[64:67],a[76:79],v[176:179],v[64:67]
T a[104:105],v19,40960
T a[106:107],v19,43008
M v[64:67],a[80:83],v[192:195],v[64:67]
T a[108:109],v19,45056
T a[110:111],v19,47104
M v[64:67],a[84:87],v[208:211],v[64:67]
MF v114,v5,v114
MF v115,v5,v115
M v[64:67],a[88:91],v[224:227],v[64:67]
T a[112:113],v19,49152
T a[114:115],v19,51200
M v[64:67],a[92:95],v[240:243],v[64:67]
T a[116:117],v19,53248
T a[118:119],v19,55296
M v[68:71],a[92:95],v[244:247],0
MF v120,v5,v120
MF v121,v5,v121
M v[68:71],a[88:91],v[228:231],v[68:71]
T a[120:121],v19,57344
T a[122:123],v19,59392
M v[68:71],a[84:87],v[212:215],v[68:71]
T a[124:125],v19,61440
T a[126:127],v19,63488
M v[68:71],a[80:83],v[196:199],v[68:71]
MF v122,v5,v122
MF v123,v5,v123
M v[68:71],a[76:79],v[180:183],v[68:71]
C v112,v112,v113
C v113,v114,v115
M v[68:71],a[72:75],v[164:167],v[68:71]
C v114,v120,v121
C v115,v122,v123
M v[68:71],a[68:71],v[148:151],v[68:71]
buffer_store_dwordx4 v[112:115], v7, s[8:11], s29 offen offset:1024 sc1
M v[68:71],a[64:67],v[132:135],v[68:71]
s_waitcnt lgkmcnt(0)
MF v116,v6,v116
MF v117,v6,v117
M v[72:75],a[96:99],v[128:131],0
T a[64:65],v20,32768
T a[66:67],v20,34816
M v[72:75],a[100:103],v[144:147],v[72:75]
T a[68:69],v20,36864
T a[70:71],v20,38912
M v[72:75],a[104:107],v[160:163],v[72:75]
MF v118,v6,v118
MF v119,v6,v119
M v[72:75],a[108:111],v[176:179],v[72:75]
T a[72:73],v20,40960
T a[74:75],v20,43008
M v[72:75],a[112:115],v[192:195],v[72:75]
T a[76:77],v20,45056
T a[78:79],v20,47104
M v[72:75],a[116:119],v[208:211],v[72:75]
MF v124,v6,v124
MF v125,v6,v125
M v[72:75],a[120:123],v[224:227],v[72:75]
T a[80:81],v20,49152
T a[82:83],v20,51200
M v[72:75],a[124:127],v[240:243],v[72:75]
T a[84:85],v20,53248
T a[86:87],v20,55296
M v[76:79],a[124:127],v[244:247],0
MF v126,v6,v126
MF v127,v6,v127
M v[76:79],a[120:123],v[228:231],v[76:79]
T a[88:89],v20,57344
T a[90:91],v20,59392
M v[76:79],a[116:119],v[212:215],v[76:79]
T a[92:93],v20,61440
T a[94:95],v20,63488
M v[76:79],a[112:115],v[196:199],v[76:79]
C v116,v116,v117
C v117,v118,v119
M v[76:79],a[108:111],v[180:183],v[76:79]
C v118,v124,v125
C v119,v126,v127
M v[76:79],a[104:107],v[164:167],v[76:79]
buffer_store_dwordx4 v[116:119], v7, s[8:11], s30 offen offset:1024 sc1
M v[76:79],a[100:103],v[148:151],v[76:79]
SA s29,s33,12288
s_waitcnt vmcnt(12)
v_readlane_b32 s92, v31, 0
v_readlane_b32 s94, v31, 1
M v[76:79],a[96:99],v[132:135],v[76:79]
s_waitcnt lgkmcnt(0)
s_waitcnt vmcnt(9)
v_sub_f32 v30, 1.0, v26
s_waitcnt vmcnt(7)
v_lshlrev_b32 v48, 16, v44
M v[80:83],a[64:67],v[128:131],0
SA s30,s33,26624
T a[96:97],v21,32768
T a[98:99],v21,34816
M v[80:83],a[68:71],v[144:147],v[80:83]
T a[100:101],v21,36864
T a[102:103],v21,38912
M v[80:83],a[72:75],v[160:163],v[80:83]
v_and_b32 v49, 0xffff0000, v44
v_lshlrev_b32 v50, 16, v45
M v[80:83],a[76:79],v[176:179],v[80:83]
T a[104:105],v21,40960
T a[106:107],v21,43008
M v[80:83],a[80:83],v[192:195],v[80:83]
T a[108:109],v21,45056
T a[110:111],v21,47104
M v[80:83],a[84:87],v[208:211],v[80:83]
MF v64,v5,v64
MF v65,v5,v65
M v[80:83],a[88:91],v[224:227],v[80:83]
T a[112:113],v21,49152
T a[114:115],v21,51200
M v[80:83],a[92:95],v[240:243],v[80:83]
T a[116:117],v21,53248
T a[118:119],v21,55296
M v[84:87],a[92:95],v[244:247],0
MF v66,v5,v66
MF v67,v5,v67
M v[84:87],a[88:91],v[228:231],v[84:87]
T a[120:121],v21,57344
T a[122:123],v21,59392
M v[84:87],a[84:87],v[212:215],v[84:87]
T a[124:125],v21,61440
T a[126:127],v21,63488
M v[84:87],a[80:83],v[196:199],v[84:87]
MF v72,v5,v72
MF v73,v5,v73
M v[84:87],a[76:79],v[180:183],v[84:87]
MF v74,v5,v74
MF v75,v5,v75
M v[84:87],a[72:75],v[164:167],v[84:87]
C v64,v64,v65
C v65,v66,v67
M v[84:87],a[68:71],v[148:151],v[84:87]
C v66,v72,v73
C v67,v74,v75
M v[84:87],a[64:67],v[132:135],v[84:87]
s_waitcnt lgkmcnt(0)
buffer_store_dwordx4 v[64:67], v7, s[8:11], s29 offen offset:0 sc1
M v[88:91],a[96:99],v[128:131],0
v_and_b32 v51, 0xffff0000, v45
v_lshlrev_b32 v52, 16, v46
M v[88:91],a[100:103],v[144:147],v[88:91]
MF v68,v6,v68
MF v69,v6,v69
M v[88:91],a[104:107],v[160:163],v[88:91]
MF v70,v6,v70
MF v71,v6,v71
M v[88:91],a[108:111],v[176:179],v[88:91]
MF v76,v6,v76
MF v77,v6,v77
M v[88:91],a[112:115],v[192:195],v[88:91]
MF v78,v6,v78
MF v79,v6,v79
M v[88:91],a[116:119],v[208:211],v[88:91]
C v68,v68,v69
C v69,v70,v71
M v[88:91],a[120:123],v[224:227],v[88:91]
C v70,v76,v77
C v71,v78,v79
M v[88:91],a[124:127],v[240:243],v[88:91]
buffer_store_dwordx4 v[68:71], v7, s[8:11], s30 offen offset:0 sc1
M v[92:95],a[124:127],v[244:247],0
v_and_b32 v53, 0xffff0000, v46
v_lshlrev_b32 v54, 16, v47
M v[92:95],a[120:123],v[228:231],v[92:95]
v_and_b32 v55, 0xffff0000, v47
v_cmp_eq_u32 s[80:81], s92, v29
M v[92:95],a[116:119],v[212:215],v[92:95]
v_cmp_eq_u32 s[82:83], s94, v29
M v[92:95],a[112:115],v[196:199],v[92:95]
MF v80,v5,v80
MF v81,v5,v81
M v[92:95],a[108:111],v[180:183],v[92:95]
MF v82,v5,v82
MF v83,v5,v83
M v[92:95],a[104:107],v[164:167],v[92:95]
MF v88,v5,v88
MF v89,v5,v89
M v[92:95],a[100:103],v[148:151],v[92:95]
MF v90,v5,v90
MF v91,v5,v91
M v[92:95],a[96:99],v[132:135],v[92:95]
C v80,v80,v81
C v81,v82,v83
C v82,v88,v89
C v83,v90,v91
buffer_store_dwordx4 v[80:83], v7, s[8:11], s29 offen offset:1024 sc1
MF v84,v6,v84
MF v85,v6,v85
MF v86,v6,v86
MF v87,v6,v87
MF v92,v6,v92
MF v93,v6,v93
MF v94,v6,v94
MF v95,v6,v95
C v84,v84,v85
C v85,v86,v87
C v86,v92,v93
C v87,v94,v95
buffer_store_dwordx4 v[84:87], v7, s[8:11], s30 offen offset:1024 sc1
buffer_load_dword v9, v33, s[8:11], s46 offen sc1
s_waitcnt vmcnt(1)
buffer_store_dword v15, v16, s[8:11], s3 offen sc1
s_cmp_lt_u32 s42, 8
s_cbranch_scc1 L_red
s_waitcnt vmcnt(1)
v_cmp_eq_u32 vcc, 1, v9
s_mov_b32 s91, 65536
s_lshl_b32 s70, 1, s41
s_mov_b32 s69, 0xffff
s_or_b32 s70, s70, vcc_lo
s_mov_b32 s68, s70
s_barrier
s_cmp_lg_u32 s70, 0
s_cbranch_scc1 L_vk0
s_call_b64 s[36:37], L_rpoll
L_vk0:
s_ff1_i32_b32 s71, s70
s_bitset0_b32 s70, s71
s_mul_i32 s71, s71, 114688
SA s16,s71,s78
buffer_load_dwordx4 v[128:131], v27, s[8:11], s16 offen sc1
s_cmp_lg_u32 s70, 0
s_cbranch_scc1 L_vk1
s_call_b64 s[36:37], L_rpoll
L_vk1:
s_ff1_i32_b32 s71, s70
s_bitset0_b32 s70, s71
s_mul_i32 s71, s71, 114688
SA s17,s71,s78
buffer_load_dwordx4 v[132:135], v27, s[8:11], s17 offen sc1
s_cmp_lg_u32 s70, 0
s_cbranch_scc1 L_vk2
s_call_b64 s[36:37], L_rpoll
L_vk2:
s_ff1_i32_b32 s71, s70
s_bitset0_b32 s70, s71
s_mul_i32 s71, s71, 114688
SA s18,s71,s78
buffer_load_dwordx4 v[136:139], v27, s[8:11], s18 offen sc1
s_cmp_lg_u32 s70, 0
s_cbranch_scc1 L_vk3
s_call_b64 s[36:37], L_rpoll
L_vk3:
s_ff1_i32_b32 s71, s70
s_bitset0_b32 s70, s71
s_mul_i32 s71, s71, 114688
SA s19,s71,s78
buffer_load_dwordx4 v[140:143], v27, s[8:11], s19 offen sc1
s_cmp_lg_u32 s70, 0
s_cbranch_scc1 L_vk4
s_call_b64 s[36:37], L_rpoll
L_vk4:
s_ff1_i32_b32 s71, s70
s_bitset0_b32 s70, s71
s_mul_i32 s71, s71, 114688
SA s48,s71,s78
buffer_load_dwordx4 v[144:147], v27, s[8:11], s48 offen sc1
s_cmp_lg_u32 s70, 0
s_cbranch_scc1 L_vk5
s_call_b64 s[36:37], L_rpoll
L_vk5:
s_ff1_i32_b32 s71, s70
s_bitset0_b32 s70, s71
s_mul_i32 s71, s71, 114688
SA s49,s71,s78
buffer_load_dwordx4 v[148:151], v27, s[8:11], s49 offen sc1
s_cmp_lg_u32 s70, 0
s_cbranch_scc1 L_vk6
s_call_b64 s[36:37], L_rpoll
L_vk6:
s_ff1_i32_b32 s71, s70
s_bitset0_b32 s70, s71
s_mul_i32 s71, s71, 114688
SA s50,s71,s78
buffer_load_dwordx4 v[152:155], v27, s[8:11], s50 offen sc1
s_cmp_lg_u32 s70, 0
s_cbranch_scc1 L_vk7
s_call_b64 s[36:37], L_rpoll
L_vk7:
s_ff1_i32_b32 s71, s70
s_bitset0_b32 s70, s71
s_mul_i32 s71, s71, 114688
SA s51,s71,s78
buffer_load_dwordx4 v[156:159], v27, s[8:11], s51 offen sc1
s_or_b64 vcc, s[80:81], s[82:83]
s_cbranch_vccnz L_moe2
L_moe_ret2:
MF v48,v30,v48
MF v49,v30,v49
MF v50,v30,v50
MF v51,v30,v51
MF v52,v30,v52
MF v53,v30,v53
MF v54,v30,v54
MF v55,v30,v55
s_cmp_lg_u32 s70, 0
s_cbranch_scc1 L_vk8
s_call_b64 s[36:37], L_rpoll
L_vk8:
s_ff1_i32_b32 s71, s70
s_bitset0_b32 s70, s71
s_mul_i32 s71, s71, 114688
SA s21,s71,s78
buffer_load_dwordx4 v[160:163], v27, s[8:11], s21 offen sc1
s_waitcnt vmcnt(8)
M v[56:59],a[246:249],v[128:131],0
M v[60:63],a[244:247],v[128:131],0
s_cmp_lg_u32 s70, 0
s_cbranch_scc1 L_vk9
s_call_b64 s[36:37], L_rpoll
L_vk9:
s_ff1_i32_b32 s71, s70
s_bitset0_b32 s70, s71
s_mul_i32 s71, s71, 114688
SA s22,s71,s78
buffer_load_dwordx4 v[164:167], v27, s[8:11], s22 offen sc1
s_waitcnt vmcnt(8)
M v[56:59],a[246:249],v[132:135],v[56:59]
M v[60:63],a[244:247],v[132:135],v[60:63]
s_cmp_lg_u32 s70, 0
s_cbranch_scc1 L_vk10
s_call_b64 s[36:37], L_rpoll
L_vk10:
s_ff1_i32_b32 s71, s70
s_bitset0_b32 s70, s71
s_mul_i32 s71, s71, 114688
SA s23,s71,s78
buffer_load_dwordx4 v[168:171], v27, s[8:11], s23 offen sc1
s_waitcnt vmcnt(8)
M v[56:59],a[246:249],v[136:139],v[56:59]
M v[60:63],a[244:247],v[136:139],v[60:63]
s_cmp_lg_u32 s70, 0
s_cbranch_scc1 L_vk11
s_call_b64 s[36:37], L_rpoll
L_vk11:
s_ff1_i32_b32 s71, s70
s_bitset0_b32 s70, s71
s_mul_i32 s71, s71, 114688
SA s24,s71,s78
buffer_load_dwordx4 v[172:175], v27, s[8:11], s24 offen sc1
s_waitcnt vmcnt(8)
M v[56:59],a[246:249],v[140:143],v[56:59]
M v[60:63],a[244:247],v[140:143],v[60:63]
s_cmp_lg_u32 s70, 0
s_cbranch_scc1 L_vk12
s_call_b64 s[36:37], L_rpoll
L_vk12:
s_ff1_i32_b32 s71, s70
s_bitset0_b32 s70, s71
s_mul_i32 s71, s71, 114688
SA s25,s71,s78
buffer_load_dwordx4 v[176:179], v27, s[8:11], s25 offen sc1
s_waitcnt vmcnt(8)
M v[56:59],a[246:249],v[144:147],v[56:59]
M v[60:63],a[244:247],v[144:147],v[60:63]
s_cmp_lg_u32 s70, 0
s_cbranch_scc1 L_vk13
s_call_b64 s[36:37], L_rpoll
L_vk13:
s_ff1_i32_b32 s71, s70
s_bitset0_b32 s70, s71
s_mul_i32 s71, s71, 114688
SA s26,s71,s78
buffer_load_dwordx4 v[180:183], v27, s[8:11], s26 offen sc1
s_waitcnt vmcnt(8)
M v[56:59],a[246:249],v[148:151],v[56:59]
M v[60:63],a[244:247],v[148:151],v[60:63]
s_cmp_lg_u32 s70, 0
s_cbranch_scc1 L_vk14
s_call_b64 s[36:37], L_rpoll
L_vk14:
s_ff1_i32_b32 s71, s70
s_bitset0_b32 s70, s71
s_mul_i32 s71, s71, 114688
SA s27,s71,s78
buffer_load_dwordx4 v[184:187], v27, s[8:11], s27 offen sc1
s_waitcnt vmcnt(8)
M v[56:59],a[246:249],v[152:155],v[56:59]
M v[60:63],a[244:247],v[152:155],v[60:63]
s_cmp_lg_u32 s70, 0
s_cbranch_scc1 L_vk15
s_call_b64 s[36:37], L_rpoll
L_vk15:
s_ff1_i32_b32 s71, s70
s_bitset0_b32 s70, s71
s_mul_i32 s71, s71, 114688
SA s28,s71,s78
buffer_load_dwordx4 v[188:191], v27, s[8:11], s28 offen sc1
s_waitcnt vmcnt(8)
M v[56:59],a[246:249],v[156:159],v[56:59]
M v[60:63],a[244:247],v[156:159],v[60:63]
s_waitcnt vmcnt(7)
M v[56:59],a[246:249],v[160:163],v[56:59]
M v[60:63],a[244:247],v[160:163],v[60:63]
s_waitcnt vmcnt(6)
M v[56:59],a[246:249],v[164:167],v[56:59]
M v[60:63],a[244:247],v[164:167],v[60:63]
s_waitcnt vmcnt(5)
M v[56:59],a[246:249],v[168:171],v[56:59]
M v[60:63],a[244:247],v[168:171],v[60:63]
s_waitcnt vmcnt(4)
M v[56:59],a[246:249],v[172:175],v[56:59]
M v[60:63],a[244:247],v[172:175],v[60:63]
s_waitcnt vmcnt(3)
M v[56:59],a[246:249],v[176:179],v[56:59]
M v[60:63],a[244:247],v[176:179],v[60:63]
s_waitcnt vmcnt(2)
M v[56:59],a[246:249],v[180:183],v[56:59]
M v[60:63],a[244:247],v[180:183],v[60:63]
s_waitcnt vmcnt(1)
M v[56:59],a[246:249],v[184:187],v[56:59]
M v[60:63],a[244:247],v[184:187],v[60:63]
s_waitcnt vmcnt(0)
M v[56:59],a[246:249],v[188:191],v[56:59]
M v[60:63],a[244:247],v[188:191],v[60:63]
s_nop 7
v_permlane16_swap_b32 v56, v60
v_permlane16_swap_b32 v57, v61
v_permlane16_swap_b32 v58, v62
v_permlane16_swap_b32 v59, v63
v_fmac_f32 v48, v26, v56
v_fmac_f32 v49, v26, v57
v_fmac_f32 v50, v26, v58
v_fmac_f32 v51, v26, v59
v_fmac_f32 v52, v26, v60
v_fmac_f32 v53, v26, v61
v_fmac_f32 v54, v26, v62
v_fmac_f32 v55, v26, v63
C v44,v48,v49
C v45,v50,v51
C v46,v52,v53
C v47,v54,v55
buffer_store_dwordx4 v[44:47], v28, s[52:55], s79 offen sc1
s_endpgm
L_d2h:
M v[128:131],a[64:67],v[48:51],v[128:131]
R a[96:99],v7,40960
R a[100:103],v7,41984
M v[128:131],a[68:71],v[56:59],v[128:131]
SA m0,s28,135168
E v18,v64
M v[132:135],a[68:71],v[60:63],v[132:135]
buffer_load_dwordx4 v4, s[8:11], s26 offen offset:0 sc1 lds
M v[132:135],a[64:67],v[52:55],v[132:135]
R a[104:107],v7,43008
R a[108:111],v7,44032
M v[140:143],a[72:75],v[52:55],v[140:143]
s_cmp_gt_u32 s20, 3
E v19,v65
M v[140:143],a[76:79],v[60:63],v[140:143]
s_cselect_b64 s[82:83], -1, 0
AF v30,v28,v30
AF v31,v29,v31
M v[136:139],a[76:79],v[56:59],v[136:139]
s_cmp_eq_u32 s20, 3
R a[112:115],v7,45056
R a[116:119],v7,46080
M v[136:139],a[72:75],v[48:51],v[136:139]
s_cselect_b64 s[66:67], s[16:17], s[82:83]
buffer_load_dwordx4 v4, s[8:11], s26 offen offset:1024 sc1 lds
M v[144:147],a[80:83],v[48:51],v[144:147]
s_cselect_b64 s[68:69], s[18:19], s[82:83]
E v20,v66
M v[144:147],a[84:87],v[56:59],v[144:147]
s_cselect_b64 s[70:71], s[48:49], s[82:83]
R a[120:123],v7,47104
R a[124:127],v7,48128
M v[148:151],a[84:87],v[60:63],v[148:151]
s_cselect_b64 s[72:73], s[50:51], s[82:83]
v_cndmask_b32 v100, v36, v8, s[66:67]
v_cndmask_b32 v101, v36, v8, s[68:69]
M v[148:151],a[80:83],v[52:55],v[148:151]
buffer_load_dwordx4 v4, s[8:11], s26 offen offset:2048 sc1 lds
M v[156:159],a[88:91],v[52:55],v[156:159]
v_cndmask_b32 v102, v36, v8, s[70:71]
AF v26,v18,v19
M v[156:159],a[92:95],v[60:63],v[156:159]
E v21,v67
M v[152:155],a[92:95],v[56:59],v[152:155]
v_cndmask_b32 v103, v36, v8, s[72:73]
C v40,v18,v19
M v[152:155],a[88:91],v[48:51],v[152:155]
s_waitcnt lgkmcnt(0)
buffer_load_dwordx4 v4, s[8:11], s26 offen offset:3072 sc1 lds
M v[160:163],a[96:99],v[48:51],v[160:163]
s_cmp_gt_u32 s20, 2
R a[64:67],v7,49152
R a[68:71],v7,50176
M v[160:163],a[100:103],v[56:59],v[160:163]
s_cselect_b64 s[82:83], -1, 0
E v22,v72
M v[164:167],a[100:103],v[60:63],v[164:167]
s_cmp_eq_u32 s20, 2
AF v26,v20,v26
C v41,v20,v21
M v[164:167],a[96:99],v[52:55],v[164:167]
s_mul_i32 s21, s41, 1048576
R a[72:75],v7,51200
R a[76:79],v7,52224
M v[172:175],a[104:107],v[52:55],v[172:175]
s_cselect_b64 s[74:75], s[16:17], s[82:83]
E v23,v73
M v[172:175],a[108:111],v[60:63],v[172:175]
s_cselect_b64 s[76:77], s[18:19], s[82:83]
AF v26,v21,v26
AF v26,v22,v26
M v[168:171],a[108:111],v[56:59],v[168:171]
s_cselect_b64 s[78:79], s[48:49], s[82:83]
R a[80:83],v7,53248
R a[84:87],v7,54272
M v[168:171],a[104:107],v[48:51],v[168:171]
s_cselect_b64 s[80:81], s[50:51], s[82:83]
v_cndmask_b32 v108, v36, v8, s[74:75]
v_cndmask_b32 v109, v36, v8, s[76:77]
M v[176:179],a[112:115],v[48:51],v[176:179]
SA s21,s21,589824
E v24,v74
M v[176:179],a[116:119],v[56:59],v[176:179]
s_lshl_b32 s84, s42, 1
R a[88:91],v7,55296
R a[92:95],v7,56320
M v[180:183],a[116:119],v[60:63],v[180:183]
s_sub_u32 s22, 11, s84
v_cndmask_b32 v110, v36, v8, s[78:79]
C v42,v22,v23
M v[180:183],a[112:115],v[52:55],v[180:183]
s_mov_b32 s23, 536870912
s_waitcnt vmcnt(16)
v_cmp_gt_u32 vcc, 2, v5
AF v26,v23,v26
M v[188:191],a[120:123],v[52:55],v[188:191]
s_cbranch_vccnz L_lsh2
L_lrh2:
v_cndmask_b32 v111, v36, v8, s[80:81]
M v[188:191],a[124:127],v[60:63],v[188:191]
SA m0,s28,98304
E v25,v75
M v[184:187],a[124:127],v[56:59],v[184:187]
s_cmp_gt_u32 s20, 1
buffer_load_dwordx4 v3, s[8:11], s21 offen offset:0 sc1 lds
M v[184:187],a[120:123],v[48:51],v[184:187]
s_waitcnt lgkmcnt(0)
E v18,v68
M v[192:195],a[64:67],v[48:51],v[192:195]
s_cselect_b64 s[82:83], -1, 0
R a[96:99],v7,57344
R a[100:103],v7,58368
M v[192:195],a[68:71],v[56:59],v[192:195]
s_cmp_eq_u32 s20, 1
buffer_load_dwordx4 v3, s[8:11], s21 offen offset:1024 sc1 lds
M v[196:199],a[68:71],v[60:63],v[196:199]
s_cselect_b64 s[66:67], s[16:17], s[82:83]
E v19,v69
M v[196:199],a[64:67],v[52:55],v[196:199]
s_cselect_b64 s[68:69], s[18:19], s[82:83]
R a[104:107],v7,59392
R a[108:111],v7,60416
M v[204:207],a[72:75],v[52:55],v[204:207]
s_cselect_b64 s[70:71], s[48:49], s[82:83]
buffer_load_dwordx4 v3, s[8:11], s21 offen offset:2048 sc1 lds
M v[204:207],a[76:79],v[60:63],v[204:207]
s_cselect_b64 s[72:73], s[50:51], s[82:83]
v_cndmask_b32 v116, v36, v8, s[66:67]
v_cndmask_b32 v117, v36, v8, s[68:69]
M v[200:203],a[76:79],v[56:59],v[200:203]
R a[112:115],v7,61440
R a[116:119],v7,62464
M v[200:203],a[72:75],v[48:51],v[200:203]
v_cndmask_b32 v118, v36, v8, s[70:71]
AF v26,v24,v26
M v[208:211],a[80:83],v[48:51],v[208:211]
buffer_load_dwordx4 v3, s[8:11], s21 offen offset:3072 sc1 lds
M v[208:211],a[84:87],v[56:59],v[208:211]
SA m0,s28,102400
R a[120:123],v7,63488
R a[124:127],v7,64512
M v[212:215],a[84:87],v[60:63],v[212:215]
v_cndmask_b32 v119, v36, v8, s[72:73]
C v43,v24,v25
M v[212:215],a[80:83],v[52:55],v[212:215]
s_cmp_gt_u32 s20, 0
E v20,v70
M v[220:223],a[88:91],v[52:55],v[220:223]
s_cselect_b64 s[82:83], -1, 0
buffer_load_dwordx4 v4, s[8:11], s21 offen offset:0 sc1 lds
M v[220:223],a[92:95],v[60:63],v[220:223]
s_cmp_eq_u32 s20, 0
E v21,v71
M v[216:219],a[92:95],v[56:59],v[216:219]
s_waitcnt lgkmcnt(0)
E v22,v76
M v[216:219],a[88:91],v[48:51],v[216:219]
s_barrier
M v[224:227],a[96:99],v[48:51],v[224:227]
s_cselect_b64 s[74:75], s[16:17], s[82:83]
R a[64:67],v2,0
R a[68:71],v2,1024
M v[224:227],a[100:103],v[56:59],v[224:227]
s_cselect_b64 s[76:77], s[18:19], s[82:83]
buffer_load_dwordx4 v4, s[8:11], s21 offen offset:1024 sc1 lds
M v[228:231],a[100:103],v[60:63],v[228:231]
s_cselect_b64 s[78:79], s[48:49], s[82:83]
E v23,v77
M v[228:231],a[96:99],v[52:55],v[228:231]
s_cselect_b64 s[80:81], s[50:51], s[82:83]
R a[72:75],v2,2048
R a[76:79],v2,3072
M v[236:239],a[104:107],v[52:55],v[236:239]
v_cndmask_b32 v124, v36, v8, s[74:75]
v_cndmask_b32 v125, v36, v8, s[76:77]
M v[236:239],a[108:111],v[60:63],v[236:239]
buffer_load_dwordx4 v4, s[8:11], s21 offen offset:2048 sc1 lds
M v[232:235],a[108:111],v[56:59],v[232:235]
R a[80:83],v2,4096
R a[84:87],v2,5120
M v[232:235],a[104:107],v[48:51],v[232:235]
v_cndmask_b32 v126, v36, v8, s[78:79]
AF v26,v25,v26
M v[240:243],a[112:115],v[48:51],v[240:243]
v_cndmask_b32 v127, v36, v8, s[80:81]
AF v27,v18,v19
M v[240:243],a[116:119],v[56:59],v[240:243]
R a[88:91],v2,6144
R a[92:95],v2,7168
M v[244:247],a[116:119],v[60:63],v[244:247]
buffer_load_dwordx4 v4, s[8:11], s21 offen offset:3072 sc1 lds
M v[244:247],a[112:115],v[52:55],v[244:247]
SA s21,s21,32768
E v24,v78
M v[252:255],a[120:123],v[52:55],v[252:255]
s_sub_u32 s22, s22, 1
E v25,v79
M v[252:255],a[124:127],v[60:63],v[252:255]
s_cselect_b32 s21, s23, s21
C v44,v18,v19
AF v27,v20,v27
M v[248:251],a[124:127],v[56:59],v[248:251]
s_waitcnt lgkmcnt(0)
C v45,v20,v21
AF v27,v21,v27
M v[248:251],a[120:123],v[48:51],v[248:251]
AF v27,v22,v27
C v46,v22,v23
AF v27,v23,v27
AF v27,v24,v27
C v47,v24,v25
AF v27,v25,v27
L_d3h:
M v[100:103],a[64:67],a[32:35],v[100:103]
R a[96:99],v2,8192
R a[100:103],v2,9216
M v[100:103],a[68:71],a[36:39],v[100:103]
R a[104:107],v2,10240
R a[108:111],v2,11264
M v[100:103],a[72:75],a[40:43],v[100:103]
R a[112:115],v2,12288
R a[116:119],v2,13312
M v[100:103],a[76:79],a[44:47],v[100:103]
R a[120:123],v2,14336
R a[124:127],v2,15360
M v[100:103],a[80:83],a[48:51],v[100:103]
v_add_u32 v8, 0x20000, v7
M v[100:103],a[84:87],a[52:55],v[100:103]
buffer_load_dword v5, v9, s[8:11], s46 offen sc1
M v[100:103],a[88:91],a[56:59],v[100:103]
buffer_load_dword v6, off, s[8:11], s47 offset:16 sc1
M v[100:103],a[92:95],a[60:63],v[100:103]
s_waitcnt lgkmcnt(0)
E v18,v80
M v[108:111],a[96:99],a[32:35],v[108:111]
R a[64:67],v2,16384
R a[68:71],v2,17408
M v[108:111],a[100:103],a[36:39],v[108:111]
R a[72:75],v2,18432
R a[76:79],v2,19456
M v[108:111],a[104:107],a[40:43],v[108:111]
R a[80:83],v2,20480
R a[84:87],v2,21504
M v[108:111],a[108:111],a[44:47],v[108:111]
R a[88:91],v2,22528
R a[92:95],v2,23552
M v[108:111],a[112:115],a[48:51],v[108:111]
E v19,v81
M v[108:111],a[116:119],a[52:55],v[108:111]
E v20,v82
M v[108:111],a[120:123],a[56:59],v[108:111]
E v21,v83
M v[108:111],a[124:127],a[60:63],v[108:111]
s_waitcnt lgkmcnt(0)
E v22,v88
M v[116:119],a[64:67],a[32:35],v[116:119]
R a[96:99],v2,24576
R a[100:103],v2,25600
M v[116:119],a[68:71],a[36:39],v[116:119]
R a[104:107],v2,26624
R a[108:111],v2,27648
M v[116:119],a[72:75],a[40:43],v[116:119]
R a[112:115],v2,28672
R a[116:119],v2,29696
M v[116:119],a[76:79],a[44:47],v[116:119]
R a[120:123],v2,30720
R a[124:127],v2,31744
M v[116:119],a[80:83],a[48:51],v[116:119]
E v23,v89
M v[116:119],a[84:87],a[52:55],v[116:119]
E v24,v90
M v[116:119],a[88:91],a[56:59],v[116:119]
s_waitcnt vmcnt(18) lgkmcnt(0)
E v25,v91
M v[116:119],a[92:95],a[60:63],v[116:119]
s_barrier
M v[124:127],a[96:99],a[32:35],v[124:127]
R a[64:67],v7,0
R a[68:71],v7,1024
M v[124:127],a[100:103],a[36:39],v[124:127]
R a[72:75],v7,2048
R a[76:79],v7,3072
M v[124:127],a[104:107],a[40:43],v[124:127]
R a[80:83],v7,4096
R a[84:87],v7,5120
M v[124:127],a[108:111],a[44:47],v[124:127]
R a[88:91],v7,6144
R a[92:95],v7,7168
M v[124:127],a[112:115],a[48:51],v[124:127]
AF v26,v18,v26
C v56,v18,v19
M v[124:127],a[116:119],a[52:55],v[124:127]
AF v26,v19,v26
AF v26,v20,v26
M v[124:127],a[120:123],a[56:59],v[124:127]
s_waitcnt lgkmcnt(0)
E v18,v84
M v[124:127],a[124:127],a[60:63],v[124:127]
E v19,v85
C v57,v20,v21
AF v26,v21,v26
AF v26,v22,v26
C v58,v22,v23
AF v26,v23,v26
AF v26,v24,v26
C v59,v24,v25
AF v26,v25,v26
E v20,v86
E v21,v87
AF v27,v18,v27
C v60,v18,v19
AF v27,v19,v27
E v22,v92
E v23,v93
AF v27,v20,v27
C v61,v20,v21
AF v27,v21,v27
E v24,v94
E v25,v95
AF v27,v22,v27
C v62,v22,v23
AF v27,v23,v27
AF v27,v24,v27
C v63,v24,v25
AF v27,v25,v27
v_max_f32 v10, v26, v27
v_cmp_lt_f32 vcc, s31, v10
s_nop 0
s_cbranch_vccnz L_std3h
L_rtd3h:
M v[128:131],a[64:67],v[40:43],v[128:131]
R a[96:99],v7,8192
R a[100:103],v7,9216
M v[128:131],a[68:71],v[56:59],v[128:131]
s_waitcnt vmcnt(0)
v_cmp_ne_u32 vcc, 1, v6
AF v30,v26,v30
M v[132:135],a[68:71],v[60:63],v[132:135]
s_cbranch_vccnz L_fqs
L_fqr:
E v18,v100
M v[132:135],a[64:67],v[44:47],v[132:135]
SA s73,s32,4096
R a[104:107],v7,10240
R a[108:111],v7,11264
M v[140:143],a[72:75],v[44:47],v[140:143]
SA s74,s32,8192
E v19,v101
M v[140:143],a[76:79],v[60:63],v[140:143]
SA s75,s32,12288
buffer_load_dwordx4 a[0:3], v7, s[8:11], s32 offen offset:0 sc1
M v[136:139],a[76:79],v[56:59],v[136:139]
R a[112:115],v7,12288
R a[116:119],v7,13312
M v[136:139],a[72:75],v[40:43],v[136:139]
E v20,v102
M v[144:147],a[80:83],v[40:43],v[144:147]
buffer_load_dwordx4 a[4:7], v7, s[8:11], s32 offen offset:1024 sc1
M v[144:147],a[84:87],v[56:59],v[144:147]
R a[120:123],v7,14336
R a[124:127],v7,15360
M v[148:151],a[84:87],v[60:63],v[148:151]
AF v31,v27,v31
AF v29,v18,v19
M v[148:151],a[80:83],v[44:47],v[148:151]
buffer_load_dwordx4 a[8:11], v7, s[8:11], s32 offen offset:2048 sc1
M v[156:159],a[88:91],v[44:47],v[156:159]
E v21,v103
M v[156:159],a[92:95],v[60:63],v[156:159]
C v52,v18,v19
AF v29,v20,v29
M v[152:155],a[92:95],v[56:59],v[152:155]
buffer_load_dwordx4 a[12:15], v7, s[8:11], s32 offen offset:3072 sc1
M v[152:155],a[88:91],v[40:43],v[152:155]
s_waitcnt lgkmcnt(0)
E v22,v108
M v[160:163],a[96:99],v[40:43],v[160:163]
R a[64:67],v7,16384
R a[68:71],v7,17408
M v[160:163],a[100:103],v[56:59],v[160:163]
buffer_load_dwordx4 a[16:19], v7, s[8:11], s73 offen offset:0 sc1
M v[164:167],a[100:103],v[60:63],v[164:167]
E v23,v109
M v[164:167],a[96:99],v[44:47],v[164:167]
R a[72:75],v7,18432
R a[76:79],v7,19456
M v[172:175],a[104:107],v[44:47],v[172:175]
buffer_load_dwordx4 a[20:23], v7, s[8:11], s73 offen offset:1024 sc1
M v[172:175],a[108:111],v[60:63],v[172:175]
C v53,v20,v21
AF v29,v21,v29
M v[168:171],a[108:111],v[56:59],v[168:171]
R a[80:83],v7,20480
R a[84:87],v7,21504
M v[168:171],a[104:107],v[40:43],v[168:171]
buffer_load_dwordx4 a[24:27], v7, s[8:11], s73 offen offset:2048 sc1
M v[176:179],a[112:115],v[40:43],v[176:179]
E v24,v110
M v[176:179],a[116:119],v[56:59],v[176:179]
R a[88:91],v7,22528
R a[92:95],v7,23552
M v[180:183],a[116:119],v[60:63],v[180:183]
buffer_load_dwordx4 a[28:31], v7, s[8:11], s73 offen offset:3072 sc1
M v[180:183],a[112:115],v[44:47],v[180:183]
E v25,v111
M v[188:191],a[120:123],v[44:47],v[188:191]
AF v29,v22,v29
C v54,v22,v23
M v[188:191],a[124:127],v[60:63],v[188:191]
buffer_load_dwordx4 a[32:35], v7, s[8:11], s74 offen offset:0 sc1
M v[184:187],a[124:127],v[56:59],v[184:187]
E v18,v116
M v[184:187],a[120:123],v[40:43],v[184:187]
s_waitcnt lgkmcnt(0)
AF v29,v23,v29
AF v29,v24,v29
M v[192:195],a[64:67],v[40:43],v[192:195]
R a[96:99],v7,24576
R a[100:103],v7,25600
M v[192:195],a[68:71],v[56:59],v[192:195]
buffer_load_dwordx4 a[36:39], v7, s[8:11], s74 offen offset:1024 sc1
M v[196:199],a[68:71],v[60:63],v[196:199]
E v19,v117
M v[196:199],a[64:67],v[44:47],v[196:199]
R a[104:107],v7,26624
R a[108:111],v7,27648
M v[204:207],a[72:75],v[44:47],v[204:207]
buffer_load_dwordx4 a[40:43], v7, s[8:11], s74 offen offset:2048 sc1
M v[204:207],a[76:79],v[60:63],v[204:207]
E v20,v118
M v[200:203],a[76:79],v[56:59],v[200:203]
R a[112:115],v7,28672
R a[116:119],v7,29696
M v[200:203],a[72:75],v[40:43],v[200:203]
buffer_load_dwordx4 a[44:47], v7, s[8:11], s74 offen offset:3072 sc1
M v[208:211],a[80:83],v[40:43],v[208:211]
C v55,v24,v25
AF v29,v25,v29
M v[208:211],a[84:87],v[56:59],v[208:211]
R a[120:123],v7,30720
R a[124:127],v7,31744
M v[212:215],a[84:87],v[60:63],v[212:215]
buffer_load_dwordx4 a[48:51], v7, s[8:11], s75 offen offset:0 sc1
M v[212:215],a[80:83],v[44:47],v[212:215]
E v21,v119
M v[220:223],a[88:91],v[44:47],v[220:223]
AF v29,v18,v29
C v48,v18,v19
M v[220:223],a[92:95],v[60:63],v[220:223]
buffer_load_dwordx4 a[52:55], v7, s[8:11], s75 offen offset:1024 sc1
M v[216:219],a[92:95],v[56:59],v[216:219]
s_waitcnt lgkmcnt(0)
E v22,v124
M v[216:219],a[88:91],v[40:43],v[216:219]
s_barrier
M v[224:227],a[96:99],v[40:43],v[224:227]
R a[64:67],v8,0
R a[68:71],v8,1024
M v[224:227],a[100:103],v[56:59],v[224:227]
buffer_load_dwordx4 a[56:59], v7, s[8:11], s75 offen offset:2048 sc1
M v[228:231],a[100:103],v[60:63],v[228:231]
v_mov_b32 v15, 4
AF v29,v19,v29
M v[228:231],a[96:99],v[44:47],v[228:231]
R a[72:75],v8,2048
R a[76:79],v8,3072
M v[236:239],a[104:107],v[44:47],v[236:239]
buffer_store_dword v15, v1, s[8:11], s45 offen sc1
M v[236:239],a[108:111],v[60:63],v[236:239]
buffer_load_dwordx4 a[60:63], v7, s[8:11], s75 offen offset:3072 sc1
M v[232:235],a[108:111],v[56:59],v[232:235]
s_cmp_ge_u32 s42, 2
R a[80:83],v8,4096
R a[84:87],v8,5120
M v[232:235],a[104:107],v[40:43],v[232:235]
s_cselect_b32 s84, 4, 2
v_cmp_gt_u32 vcc, s84, v5
AF v29,v20,v29
M v[240:243],a[112:115],v[40:43],v[240:243]
s_cbranch_vccnz L_lsh4
L_lrh4:
E v23,v125
M v[240:243],a[116:119],v[56:59],v[240:243]
R a[88:91],v8,6144
R a[92:95],v8,7168
M v[244:247],a[116:119],v[60:63],v[244:247]
E v24,v126
M v[244:247],a[112:115],v[44:47],v[244:247]
E v25,v127
M v[252:255],a[120:123],v[44:47],v[252:255]
C v49,v20,v21
AF v29,v21,v29
M v[252:255],a[124:127],v[60:63],v[252:255]
AF v29,v22,v29
C v50,v22,v23
M v[248:251],a[124:127],v[56:59],v[248:251]
s_waitcnt lgkmcnt(0)
AF v29,v23,v29
AF v29,v24,v29
M v[248:251],a[120:123],v[40:43],v[248:251]
C v51,v24,v25
AF v29,v25,v29
v_cmp_lt_f32 vcc, s31, v29
s_nop 0
s_cbranch_vccnz L_std4h
L_rtd4h:
M v[132:135],a[64:67],v[52:55],v[132:135]
R a[96:99],v8,8192
R a[100:103],v8,9216
M v[132:135],a[68:71],v[48:51],v[132:135]
R a[104:107],v8,10240
R a[108:111],v8,11264
M v[140:143],a[72:75],v[52:55],v[140:143]
SA m0,s28,65536
R a[112:115],v8,12288
R a[116:119],v8,13312
M v[140:143],a[76:79],v[48:51],v[140:143]
R a[120:123],v8,14336
R a[124:127],v8,15360
M v[148:151],a[80:83],v[52:55],v[148:151]
buffer_load_dwordx4 v3, s[8:11], s21 offen offset:0 sc1 lds
M v[148:151],a[84:87],v[48:51],v[148:151]
AF v31,v29,v31
v_mov_b32 v10, v30
M v[156:159],a[88:91],v[52:55],v[156:159]
v_mov_b32 v11, v31
C v128,v128,v129
M v[156:159],a[92:95],v[48:51],v[156:159]
s_waitcnt lgkmcnt(0)
v_permlane16_swap_b32 v10, v30
M v[164:167],a[96:99],v[52:55],v[164:167]
R a[64:67],v8,16384
R a[68:71],v8,17408
M v[164:167],a[100:103],v[48:51],v[164:167]
R a[72:75],v8,18432
R a[76:79],v8,19456
M v[172:175],a[104:107],v[52:55],v[172:175]
R a[80:83],v8,20480
R a[84:87],v8,21504
M v[172:175],a[108:111],v[48:51],v[172:175]
R a[88:91],v8,22528
R a[92:95],v8,23552
M v[180:183],a[112:115],v[52:55],v[180:183]
buffer_load_dwordx4 v3, s[8:11], s21 offen offset:1024 sc1 lds
M v[180:183],a[116:119],v[48:51],v[180:183]
v_permlane16_swap_b32 v11, v31
M v[188:191],a[120:123],v[52:55],v[188:191]
AF v30,v10,v30
AF v31,v11,v31
M v[188:191],a[124:127],v[48:51],v[188:191]
s_waitcnt lgkmcnt(0)
buffer_load_dwordx4 v3, s[8:11], s21 offen offset:2048 sc1 lds
M v[196:199],a[64:67],v[52:55],v[196:199]
R a[96:99],v8,24576
R a[100:103],v8,25600
M v[196:199],a[68:71],v[48:51],v[196:199]
R a[104:107],v8,26624
R a[108:111],v8,27648
M v[204:207],a[72:75],v[52:55],v[204:207]
R a[112:115],v8,28672
R a[116:119],v8,29696
M v[204:207],a[76:79],v[48:51],v[204:207]
R a[120:123],v8,30720
R a[124:127],v8,31744
M v[212:215],a[80:83],v[52:55],v[212:215]
buffer_load_dwordx4 v3, s[8:11], s21 offen offset:3072 sc1 lds
M v[212:215],a[84:87],v[48:51],v[212:215]
SA m0,s28,69632
v_mov_b32 v10, v30
v_mov_b32 v11, v31
M v[220:223],a[88:91],v[52:55],v[220:223]
s_waitcnt lgkmcnt(0)
v_permlane32_swap_b32 v10, v30
M v[220:223],a[92:95],v[48:51],v[220:223]
s_barrier
M v[228:231],a[96:99],v[52:55],v[228:231]
R a[64:67],v2,32768
R a[68:71],v2,33792
M v[228:231],a[100:103],v[48:51],v[228:231]
R a[72:75],v2,34816
R a[76:79],v2,35840
M v[236:239],a[104:107],v[52:55],v[236:239]
R a[80:83],v2,36864
R a[84:87],v2,37888
M v[236:239],a[108:111],v[48:51],v[236:239]
R a[88:91],v2,38912
R a[92:95],v2,39936
M v[244:247],a[112:115],v[52:55],v[244:247]
v_permlane32_swap_b32 v11, v31
M v[244:247],a[116:119],v[48:51],v[244:247]
s_waitcnt vmcnt(4)
buffer_load_dwordx4 v4, s[8:11], s21 offen offset:0 sc1 lds
M v[252:255],a[120:123],v[52:55],v[252:255]
s_waitcnt lgkmcnt(0)
AF v30,v10,v30
AF v31,v11,v31
M v[252:255],a[124:127],v[48:51],v[252:255]
v_rcp_f32 v5, v30
M v[64:67],a[64:67],a[0:3],0
R a[96:99],v2,40960
R a[100:103],v2,41984
M v[64:67],a[68:71],a[4:7],v[64:67]
v_rcp_f32 v6, v31
M v[64:67],a[72:75],a[8:11],v[64:67]
buffer_load_dwordx4 v4, s[8:11], s21 offen offset:1024 sc1 lds
M v[64:67],a[76:79],a[12:15],v[64:67]
R a[104:107],v2,43008
R a[108:111],v2,44032
M v[64:67],a[80:83],a[16:19],v[64:67]
W a192,v5
W a193,v6
M v[64:67],a[84:87],a[20:23],v[64:67]
buffer_load_dwordx4 v4, s[8:11], s21 offen offset:2048 sc1 lds
M v[64:67],a[88:91],a[24:27],v[64:67]
R a[112:115],v2,45056
R a[116:119],v2,46080
M v[64:67],a[92:95],a[28:31],v[64:67]
v_mov_b32 v30, 0
v_mov_b32 v31, 0
M v[68:71],a[92:95],a[60:63],0
buffer_load_dwordx4 v4, s[8:11], s21 offen offset:3072 sc1 lds
M v[68:71],a[88:91],a[56:59],v[68:71]
SA s21,s21,32768
R a[120:123],v2,47104
R a[124:127],v2,48128
M v[68:71],a[84:87],a[52:55],v[68:71]
s_sub_u32 s22, s22, 1
v_mov_b32 v32, 0
v_mov_b32 v33, 0
M v[68:71],a[80:83],a[48:51],v[68:71]
s_cselect_b32 s21, s23, s21
v_mov_b32 v34, 0
v_mov_b32 v35, 0
M v[68:71],a[76:79],a[44:47],v[68:71]
s_mul_i32 s26, s41, 1048576
v_mov_b32 v36, 0
v_mov_b32 v37, 0
M v[68:71],a[72:75],a[40:43],v[68:71]
SA s26,s26,17367040
v_mov_b32 v38, 0
v_mov_b32 v39, 0
M v[68:71],a[68:71],a[36:39],v[68:71]
SA m0,s28,0
E v18,v64
M v[68:71],a[64:67],a[32:35],v[68:71]
s_waitcnt lgkmcnt(0)
buffer_load_dwordx4 v3, s[8:11], s26 offen offset:0 sc1 lds
M v[72:75],a[96:99],a[0:3],0
R a[64:67],v2,49152
R a[68:71],v2,50176
M v[72:75],a[100:103],a[4:7],v[72:75]
E v19,v65
M v[72:75],a[104:107],a[8:11],v[72:75]
buffer_load_dwordx4 v3, s[8:11], s26 offen offset:1024 sc1 lds
M v[72:75],a[108:111],a[12:15],v[72:75]
R a[72:75],v2,51200
R a[76:79],v2,52224
M v[72:75],a[112:115],a[16:19],v[72:75]
E v20,v66
M v[72:75],a[116:119],a[20:23],v[72:75]
buffer_load_dwordx4 v3, s[8:11], s26 offen offset:2048 sc1 lds
M v[72:75],a[120:123],a[24:27],v[72:75]
R a[80:83],v2,53248
R a[84:87],v2,54272
M v[72:75],a[124:127],a[28:31],v[72:75]
E v21,v67
M v[76:79],a[124:127],a[60:63],0
buffer_load_dwordx4 v3, s[8:11], s26 offen offset:3072 sc1 lds
M v[76:79],a[120:123],a[56:59],v[76:79]
SA m0,s28,4096
R a[88:91],v2,55296
R a[92:95],v2,56320
M v[76:79],a[116:119],a[52:55],v[76:79]
E v22,v68
M v[76:79],a[112:115],a[48:51],v[76:79]
E v23,v69
M v[76:79],a[108:111],a[44:47],v[76:79]
buffer_load_dwordx4 v4, s[8:11], s26 offen offset:0 sc1 lds
M v[76:79],a[104:107],a[40:43],v[76:79]
AF v26,v18,v19
C v40,v18,v19
M v[76:79],a[100:103],a[36:39],v[76:79]
E v24,v70
M v[76:79],a[96:99],a[32:35],v[76:79]
s_waitcnt lgkmcnt(0)
AF v26,v20,v26
C v41,v20,v21
M v[80:83],a[64:67],a[0:3],0
R a[96:99],v2,57344
R a[100:103],v2,58368
M v[80:83],a[68:71],a[4:7],v[80:83]
buffer_load_dwordx4 v4, s[8:11], s26 offen offset:1024 sc1 lds
M v[80:83],a[72:75],a[8:11],v[80:83]
E v25,v71
M v[80:83],a[76:79],a[12:15],v[80:83]
R a[104:107],v2,59392
R a[108:111],v2,60416
M v[80:83],a[80:83],a[16:19],v[80:83]
AF v26,v21,v26
AF v27,v22,v23
M v[80:83],a[84:87],a[20:23],v[80:83]
buffer_load_dwordx4 v4, s[8:11], s26 offen offset:2048 sc1 lds
M v[80:83],a[88:91],a[24:27],v[80:83]
R a[112:115],v2,61440
R a[116:119],v2,62464
M v[80:83],a[92:95],a[28:31],v[80:83]
E v18,v72
M v[84:87],a[92:95],a[60:63],0
E v19,v73
M v[84:87],a[88:91],a[56:59],v[84:87]
R a[120:123],v2,63488
R a[124:127],v2,64512
M v[84:87],a[84:87],a[52:55],v[84:87]
buffer_load_dwordx4 v4, s[8:11], s26 offen offset:3072 sc1 lds
M v[84:87],a[80:83],a[48:51],v[84:87]
SA s26,s26,32768
E v20,v74
M v[84:87],a[76:79],a[44:47],v[84:87]
SA m0,s28,32768
C v44,v22,v23
AF v27,v24,v27
M v[84:87],a[72:75],a[40:43],v[84:87]
C v45,v24,v25
AF v27,v25,v27
M v[84:87],a[68:71],a[36:39],v[84:87]
s_waitcnt vmcnt(8) lgkmcnt(0)
buffer_load_dwordx4 v3, s[8:11], s26 offen offset:0 sc1 lds
M v[84:87],a[64:67],a[32:35],v[84:87]
s_barrier
M v[88:91],a[96:99],a[0:3],0
R a[64:67],v2,0
R a[68:71],v2,1024
M v[88:91],a[100:103],a[4:7],v[88:91]
E v21,v75
M v[88:91],a[104:107],a[8:11],v[88:91]
buffer_load_dwordx4 v3, s[8:11], s26 offen offset:1024 sc1 lds
M v[88:91],a[108:111],a[12:15],v[88:91]
R a[72:75],v2,2048
R a[76:79],v2,3072
M v[88:91],a[112:115],a[16:19],v[88:91]
E v22,v76
M v[88:91],a[116:119],a[20:23],v[88:91]
E v23,v77
M v[88:91],a[120:123],a[24:27],v[88:91]
R a[80:83],v2,4096
R a[84:87],v2,5120
M v[88:91],a[124:127],a[28:31],v[88:91]
buffer_load_dwordx4 v3, s[8:11], s26 offen offset:2048 sc1 lds
M v[92:95],a[124:127],a[60:63],0
E v24,v78
M v[92:95],a[120:123],a[56:59],v[92:95]
R a[88:91],v2,6144
R a[92:95],v2,7168
M v[92:95],a[116:119],a[52:55],v[92:95]
E v25,v79
M v[92:95],a[112:115],a[48:51],v[92:95]
buffer_load_dwordx4 v3, s[8:11], s26 offen offset:3072 sc1 lds
M v[92:95],a[108:111],a[44:47],v[92:95]
AF v26,v18,v26
C v42,v18,v19
M v[92:95],a[104:107],a[40:43],v[92:95]
AF v26,v19,v26
AF v26,v20,v26
M v[92:95],a[100:103],a[36:39],v[92:95]
s_waitcnt lgkmcnt(0)
C v43,v20,v21
AF v26,v21,v26
M v[92:95],a[96:99],a[32:35],v[92:95]
AF v27,v22,v27
C v46,v22,v23
AF v27,v23,v27
AF v27,v24,v27
C v47,v24,v25
AF v27,v25,v27
M v[96:99],a[64:67],a[0:3],0
R a[96:99],v2,8192
R a[100:103],v2,9216
M v[96:99],a[68:71],a[4:7],v[96:99]
SA m0,s28,98304
E v18,v80
M v[96:99],a[72:75],a[8:11],v[96:99]
buffer_load_dwordx4 v3, s[8:11], s21 offen offset:0 sc1 lds
M v[96:99],a[76:79],a[12:15],v[96:99]
R a[104:107],v2,10240
R a[108:111],v2,11264
M v[96:99],a[80:83],a[16:19],v[96:99]
E v19,v81
M v[96:99],a[84:87],a[20:23],v[96:99]
AF v26,v18,v26
C v56,v18,v19
M v[96:99],a[88:91],a[24:27],v[96:99]
R a[112:115],v2,12288
R a[116:119],v2,13312
M v[96:99],a[92:95],a[28:31],v[96:99]
buffer_load_dwordx4 v3, s[8:11], s21 offen offset:1024 sc1 lds
M v[100:103],a[92:95],a[60:63],0
E v20,v82
M v[100:103],a[88:91],a[56:59],v[100:103]
R a[120:123],v2,14336
R a[124:127],v2,15360
M v[100:103],a[84:87],a[52:55],v[100:103]
E v21,v83
M v[100:103],a[80:83],a[48:51],v[100:103]
buffer_load_dwordx4 v3, s[8:11], s21 offen offset:2048 sc1 lds
M v[100:103],a[76:79],a[44:47],v[100:103]
AF v26,v19,v26
AF v26,v20,v26
M v[100:103],a[72:75],a[40:43],v[100:103]
E v22,v88
M v[100:103],a[68:71],a[36:39],v[100:103]
C v57,v20,v21
AF v26,v21,v26
M v[100:103],a[64:67],a[32:35],v[100:103]
s_waitcnt lgkmcnt(0)
buffer_load_dwordx4 v3, s[8:11], s21 offen offset:3072 sc1 lds
M v[108:111],a[96:99],a[32:35],0
R a[64:67],v2,16384
R a[68:71],v2,17408
M v[108:111],a[100:103],a[36:39],v[108:111]
E v23,v89
M v[108:111],a[104:107],a[40:43],v[108:111]
SA m0,s28,102400
AF v26,v22,v26
C v58,v22,v23
M v[108:111],a[108:111],a[44:47],v[108:111]
R a[72:75],v2,18432
R a[76:79],v2,19456
M v[108:111],a[112:115],a[48:51],v[108:111]
buffer_load_dwordx4 v4, s[8:11], s21 offen offset:0 sc1 lds
M v[108:111],a[116:119],a[52:55],v[108:111]
E v24,v90
M v[108:111],a[120:123],a[56:59],v[108:111]
R a[80:83],v2,20480
R a[84:87],v2,21504
M v[108:111],a[124:127],a[60:63],v[108:111]
E v25,v91
M v[104:107],a[124:127],a[28:31],0
buffer_load_dwordx4 v4, s[8:11], s21 offen offset:1024 sc1 lds
M v[104:107],a[120:123],a[24:27],v[104:107]
R a[88:91],v2,22528
R a[92:95],v2,23552
M v[104:107],a[116:119],a[20:23],v[104:107]
AF v26,v23,v26
AF v26,v24,v26
M v[104:107],a[112:115],a[16:19],v[104:107]
E v18,v84
M v[104:107],a[108:111],a[12:15],v[104:107]
buffer_load_dwordx4 v4, s[8:11], s21 offen offset:2048 sc1 lds
M v[104:107],a[104:107],a[8:11],v[104:107]
C v59,v24,v25
AF v26,v25,v26
M v[104:107],a[100:103],a[4:7],v[104:107]
E v19,v85
M v[104:107],a[96:99],a[0:3],v[104:107]
s_waitcnt lgkmcnt(0)
AF v27,v18,v27
C v60,v18,v19
M v[112:115],a[64:67],a[0:3],0
R a[96:99],v2,24576
R a[100:103],v2,25600
M v[112:115],a[68:71],a[4:7],v[112:115]
buffer_load_dwordx4 v4, s[8:11], s21 offen offset:3072 sc1 lds
M v[112:115],a[72:75],a[8:11],v[112:115]
SA s21,s21,32768
E v20,v86
M v[112:115],a[76:79],a[12:15],v[112:115]
s_sub_u32 s22, s22, 1
R a[104:107],v2,26624
R a[108:111],v2,27648
M v[112:115],a[80:83],a[16:19],v[112:115]
s_cselect_b32 s21, s23, s21
AF v27,v19,v27
C v129,v130,v131
M v[112:115],a[84:87],a[20:23],v[112:115]
SA m0,s28,36864
E v21,v87
M v[112:115],a[88:91],a[24:27],v[112:115]
R a[112:115],v2,28672
R a[116:119],v2,29696
M v[112:115],a[92:95],a[28:31],v[112:115]
buffer_load_dwordx4 v4, s[8:11], s26 offen offset:0 sc1 lds
M v[116:119],a[92:95],a[60:63],0
E v22,v92
M v[116:119],a[88:91],a[56:59],v[116:119]
R a[120:123],v2,30720
R a[124:127],v2,31744
M v[116:119],a[84:87],a[52:55],v[116:119]
AF v27,v20,v27
C v61,v20,v21
M v[116:119],a[80:83],a[48:51],v[116:119]
buffer_load_dwordx4 v4, s[8:11], s26 offen offset:1024 sc1 lds
M v[116:119],a[76:79],a[44:47],v[116:119]
E v23,v93
M v[116:119],a[72:75],a[40:43],v[116:119]
AF v27,v21,v27
AF v27,v22,v27
M v[116:119],a[68:71],a[36:39],v[116:119]
s_waitcnt vmcnt(14) lgkmcnt(0)
C v62,v22,v23
AF v27,v23,v27
M v[116:119],a[64:67],a[32:35],v[116:119]
s_barrier
M v[124:127],a[96:99],a[32:35],0
R a[64:67],v7,0
R a[68:71],v7,1024
M v[124:127],a[100:103],a[36:39],v[124:127]
buffer_load_dwordx4 v4, s[8:11], s26 offen offset:2048 sc1 lds
M v[124:127],a[104:107],a[40:43],v[124:127]
E v24,v94
M v[124:127],a[108:111],a[44:47],v[124:127]
R a[72:75],v7,2048
R a[76:79],v7,3072
M v[124:127],a[112:115],a[48:51],v[124:127]
E v25,v95
M v[124:127],a[116:119],a[52:55],v[124:127]
buffer_load_dwordx4 v4, s[8:11], s26 offen offset:3072 sc1 lds
M v[124:127],a[120:123],a[56:59],v[124:127]
R a[80:83],v7,4096
R a[84:87],v7,5120
M v[124:127],a[124:127],a[60:63],v[124:127]
AF v27,v24,v27
C v63,v24,v25
M v[120:123],a[124:127],a[28:31],0
SA s26,s26,32768
AF v27,v25,v27
C v130,v136,v137
M v[120:123],a[120:123],a[24:27],v[120:123]
R a[88:91],v7,6144
R a[92:95],v7,7168
C v131,v138,v139
W a128,v128
W a129,v129
W a130,v130
W a131,v131
C v144,v144,v145
C v145,v146,v147
C v146,v152,v153
C v147,v154,v155
W a132,v144
W a133,v145
W a134,v146
W a135,v147
C v132,v132,v133
C v133,v134,v135
C v134,v140,v141
C v135,v142,v143
W a160,v132
W a161,v133
W a162,v134
W a163,v135
C v160,v160,v161
C v161,v162,v163
C v162,v168,v169
C v163,v170,v171
W a136,v160
W a137,v161
W a138,v162
W a139,v163
C v148,v148,v149
C v149,v150,v151
C v150,v156,v157
C v151,v158,v159
W a164,v148
W a165,v149
W a166,v150
W a167,v151
C v176,v176,v177
C v177,v178,v179
C v178,v184,v185
C v179,v186,v187
W a140,v176
W a141,v177
W a142,v178
W a143,v179
C v164,v164,v165
C v165,v166,v167
C v166,v172,v173
C v167,v174,v175
W a168,v164
W a169,v165
W a170,v166
W a171,v167
C v192,v192,v193
C v193,v194,v195
C v194,v200,v201
C v195,v202,v203
W a144,v192
W a145,v193
W a146,v194
W a147,v195
C v180,v180,v181
C v181,v182,v183
C v182,v188,v189
C v183,v190,v191
W a172,v180
W a173,v181
W a174,v182
W a175,v183
C v208,v208,v209
C v209,v210,v211
C v210,v216,v217
C v211,v218,v219
W a148,v208
W a149,v209
W a150,v210
W a151,v211
C v196,v196,v197
C v197,v198,v199
C v198,v204,v205
C v199,v206,v207
W a176,v196
W a177,v197
W a178,v198
W a179,v199
C v224,v224,v225
C v225,v226,v227
C v226,v232,v233
C v227,v234,v235
W a152,v224
W a153,v225
W a154,v226
W a155,v227
C v212,v212,v213
C v213,v214,v215
C v214,v220,v221
C v215,v222,v223
W a180,v212
W a181,v213
W a182,v214
W a183,v215
C v240,v240,v241
C v241,v242,v243
C v242,v248,v249
C v243,v250,v251
W a156,v240
W a157,v241
W a158,v242
W a159,v243
C v228,v228,v229
C v229,v230,v231
C v230,v236,v237
C v231,v238,v239
W a184,v228
W a185,v229
W a186,v230
W a187,v231
C v244,v244,v245
C v245,v246,v247
C v246,v252,v253
C v247,v254,v255
W a188,v244
W a189,v245
W a190,v246
W a191,v247
M v[120:123],a[116:119],a[20:23],v[120:123]
M v[120:123],a[112:115],a[16:19],v[120:123]
M v[120:123],a[108:111],a[12:15],v[120:123]
M v[120:123],a[104:107],a[8:11],v[120:123]
M v[120:123],a[100:103],a[4:7],v[120:123]
s_waitcnt lgkmcnt(0)
M v[120:123],a[96:99],a[0:3],v[120:123]
v_max_f32 v10, v26, v27
v_min_f32 v11, v26, v27
v_cmp_lt_f32 vcc, s31, v10
v_cmp_gt_f32 s[64:65], s24, v11
s_nop 0
s_or_b64 vcc, vcc, s[64:65]
s_cbranch_vccnz L_sth1
L_rth1:
M v[128:131],a[64:67],v[40:43],0
R a[96:99],v7,8192
R a[100:103],v7,9216
M v[128:131],a[68:71],v[56:59],v[128:131]
SA m0,s28,65536
E v18,v96
M v[132:135],a[68:71],v[60:63],0
buffer_load_dwordx4 v3, s[8:11], s21 offen offset:0 sc1 lds
M v[132:135],a[64:67],v[44:47],v[132:135]
R a[104:107],v7,10240
R a[108:111],v7,11264
M v[140:143],a[72:75],v[44:47],0
E v19,v97
M v[140:143],a[76:79],v[60:63],v[140:143]
AF v30,v26,v30
AF v31,v27,v31
M v[136:139],a[76:79],v[56:59],0
R a[112:115],v7,12288
R a[116:119],v7,13312
M v[136:139],a[72:75],v[40:43],v[136:139]
buffer_load_dwordx4 v3, s[8:11], s21 offen offset:1024 sc1 lds
M v[144:147],a[80:83],v[40:43],0
E v20,v98
M v[144:147],a[84:87],v[56:59],v[144:147]
R a[120:123],v7,14336
R a[124:127],v7,15360
M v[148:151],a[84:87],v[60:63],0
s_mov_b32 s40, 0
AF v28,v18,v19
C v48,v18,v19
M v[148:151],a[80:83],v[44:47],v[148:151]
s_mov_b32 s7, 0
buffer_load_dwordx4 v3, s[8:11], s21 offen offset:2048 sc1 lds
M v[156:159],a[88:91],v[44:47],0
s_and_b32 s39, s39, 1
E v21,v99
M v[156:159],a[92:95],v[60:63],v[156:159]
s_or_b32 s39, s39, 2
AF v28,v20,v28
C v49,v20,v21
M v[152:155],a[92:95],v[56:59],0
s_sub_u32 s27, 5, s42
AF v28,v21,v28
M v[152:155],a[88:91],v[40:43],v[152:155]
s_waitcnt lgkmcnt(0)
buffer_load_dwordx4 v3, s[8:11], s21 offen offset:3072 sc1 lds
M v[160:163],a[96:99],v[40:43],0
SA m0,s28,69632
R a[64:67],v7,16384
R a[68:71],v7,17408
M v[160:163],a[100:103],v[56:59],v[160:163]
E v22,v104
M v[164:167],a[100:103],v[60:63],0
E v23,v105
M v[164:167],a[96:99],v[44:47],v[164:167]
R a[72:75],v7,18432
R a[76:79],v7,19456
M v[172:175],a[104:107],v[44:47],0
buffer_load_dwordx4 v4, s[8:11], s21 offen offset:0 sc1 lds
M v[172:175],a[108:111],v[60:63],v[172:175]
AF v28,v22,v28
C v50,v22,v23
M v[168:171],a[108:111],v[56:59],0
R a[80:83],v7,20480
R a[84:87],v7,21504
M v[168:171],a[104:107],v[40:43],v[168:171]
buffer_load_dwordx4 v4, s[8:11], s21 offen offset:1024 sc1 lds
M v[176:179],a[112:115],v[40:43],0
E v24,v106
M v[176:179],a[116:119],v[56:59],v[176:179]
R a[88:91],v7,22528
R a[92:95],v7,23552
M v[180:183],a[116:119],v[60:63],0
buffer_load_dwordx4 v4, s[8:11], s21 offen offset:2048 sc1 lds
M v[180:183],a[112:115],v[44:47],v[180:183]
E v25,v107
M v[188:191],a[120:123],v[44:47],0
AF v28,v23,v28
AF v28,v24,v28
M v[188:191],a[124:127],v[60:63],v[188:191]
C v51,v24,v25
AF v28,v25,v28
M v[184:187],a[124:127],v[56:59],0
buffer_load_dwordx4 v4, s[8:11], s21 offen offset:3072 sc1 lds
M v[184:187],a[120:123],v[40:43],v[184:187]
s_waitcnt lgkmcnt(0)
E v18,v100
M v[192:195],a[64:67],v[40:43],0
SA s21,s21,32768
R a[96:99],v7,24576
R a[100:103],v7,25600
M v[192:195],a[68:71],v[56:59],v[192:195]
s_sub_u32 s22, s22, 1
E v19,v101
M v[196:199],a[68:71],v[60:63],0
s_cselect_b32 s21, s23, s21
AF v29,v18,v19
C v52,v18,v19
M v[196:199],a[64:67],v[44:47],v[196:199]
R a[104:107],v7,26624
R a[108:111],v7,27648
M v[204:207],a[72:75],v[44:47],0
M v[204:207],a[76:79],v[60:63],v[204:207]
E v20,v102
M v[200:203],a[76:79],v[56:59],0
R a[112:115],v7,28672
R a[116:119],v7,29696
M v[200:203],a[72:75],v[40:43],v[200:203]
M v[208:211],a[80:83],v[40:43],0
M v[208:211],a[84:87],v[56:59],v[208:211]
R a[120:123],v7,30720
R a[124:127],v7,31744
M v[212:215],a[84:87],v[60:63],0
E v21,v103
M v[212:215],a[80:83],v[44:47],v[212:215]
AF v29,v20,v29
C v53,v20,v21
M v[220:223],a[88:91],v[44:47],0
AF v29,v21,v29
M v[220:223],a[92:95],v[60:63],v[220:223]
E v22,v108
M v[216:219],a[92:95],v[56:59],0
s_waitcnt vmcnt(12) lgkmcnt(0)
M v[216:219],a[88:91],v[40:43],v[216:219]
s_barrier
M v[224:227],a[96:99],v[40:43],0
R a[64:67],v2,32768
R a[68:71],v2,33792
M v[224:227],a[100:103],v[56:59],v[224:227]
E v23,v109
M v[228:231],a[100:103],v[60:63],0
AF v29,v22,v29
C v54,v22,v23
M v[228:231],a[96:99],v[44:47],v[228:231]
R a[72:75],v2,34816
R a[76:79],v2,35840
M v[236:239],a[104:107],v[44:47],0
E v24,v110
M v[236:239],a[108:111],v[60:63],v[236:239]
AF v29,v23,v29
M v[232:235],a[108:111],v[56:59],0
R a[80:83],v2,36864
R a[84:87],v2,37888
M v[232:235],a[104:107],v[40:43],v[232:235]
M v[240:243],a[112:115],v[40:43],0
E v25,v111
M v[240:243],a[116:119],v[56:59],v[240:243]
R a[88:91],v2,38912
R a[92:95],v2,39936
M v[244:247],a[116:119],v[60:63],0
AF v29,v24,v29
C v55,v24,v25
M v[244:247],a[112:115],v[44:47],v[244:247]
AF v29,v25,v29
M v[252:255],a[120:123],v[44:47],0
M v[252:255],a[124:127],v[60:63],v[252:255]
M v[248:251],a[124:127],v[56:59],0
s_waitcnt lgkmcnt(0)
M v[248:251],a[120:123],v[40:43],v[248:251]
s_cmp_lg_u32 s27, 0
s_cbranch_scc1 L_loop_top
L_final_h:
s_waitcnt vmcnt(8) lgkmcnt(0)
s_barrier
R a[64:67],v7,32768
R a[68:71],v7,33792
R a[72:75],v7,34816
R a[76:79],v7,35840
R a[80:83],v7,36864
R a[84:87],v7,37888
R a[88:91],v7,38912
R a[92:95],v7,39936
v_lshrrev_b32 v14, 7, v7
v_mul_u32_u24 v14, 896, v14
v_lshrrev_b32 v15, 8, v7
v_lshlrev_b32 v15, 5, v15
v_xor_b32 v15, v15, v7
v_and_b32 v15, 0x70, v15
v_add_u32 v0, v14, v15
s_mul_i32 s38, s20, 57344
SA m0,s28,98304
SA s85,s38,0
E v18,v112
buffer_load_dwordx4 v0, s[12:15], s85 offen offset:0 lds
E v19,v113
E v20,v114
AF v28,v18,v28
SA s85,s38,6144
C v56,v18,v19
buffer_load_dwordx4 v0, s[12:15], s85 offen offset:1024 lds
E v21,v115
AF v28,v19,v28
E v22,v120
AF v28,v20,v28
SA s85,s38,12288
C v57,v20,v21
buffer_load_dwordx4 v0, s[12:15], s85 offen offset:2048 lds
E v23,v121
AF v28,v21,v28
E v24,v122
AF v28,v22,v28
SA s85,s38,18432
C v58,v22,v23
buffer_load_dwordx4 v0, s[12:15], s85 offen offset:3072 lds
E v25,v123
AF v28,v23,v28
E v18,v116
AF v28,v24,v28
SA m0,s28,102400
SA s85,s38,28672
C v59,v24,v25
buffer_load_dwordx4 v0, s[12:15], s85 offen offset:0 lds
E v19,v117
AF v28,v25,v28
E v20,v118
AF v29,v18,v29
SA s85,s38,34816
C v60,v18,v19
buffer_load_dwordx4 v0, s[12:15], s85 offen offset:1024 lds
E v21,v119
AF v29,v19,v29
E v22,v124
AF v29,v20,v29
SA s85,s38,40960
C v61,v20,v21
buffer_load_dwordx4 v0, s[12:15], s85 offen offset:2048 lds
E v23,v125
AF v29,v21,v29
E v24,v126
AF v29,v22,v29
SA s85,s38,47104
C v62,v22,v23
buffer_load_dwordx4 v0, s[12:15], s85 offen offset:3072 lds
SA s38,s38,128
E v25,v127
AF v29,v23,v29
AF v29,v24,v29
C v63,v24,v25
AF v29,v25,v29
v_max_f32 v10, v28, v29
v_cmp_lt_f32 vcc, s31, v10
s_nop 0
s_cbranch_vccnz L_stfh
L_rtfh:
AF v30,v28,v30
AF v31,v29,v31
v_mov_b32 v10, v32
v_mov_b32 v11, v36
v_mov_b32 v12, v30
v_mov_b32 v13, v31
buffer_store_dwordx4 v[10:13], v7, s[8:11], s90 offen sc1
s_waitcnt lgkmcnt(0)
M v[128:131],a[64:67],v[48:51],v[128:131]
SA m0,s28,65536
R a[96:99],v7,40960
R a[100:103],v7,41984
M v[128:131],a[68:71],v[56:59],v[128:131]
SA s85,s38,0
buffer_load_dwordx4 v0, s[12:15], s85 offen offset:0 lds
M v[132:135],a[68:71],v[60:63],v[132:135]
SA s85,s38,6144
v_lshrrev_b32 v16, 4, v7
v_lshrrev_b32 v14, 2, v16
M v[132:135],a[64:67],v[52:55],v[132:135]
R a[104:107],v7,43008
R a[108:111],v7,44032
M v[136:139],a[72:75],v[48:51],v[136:139]
buffer_load_dwordx4 v0, s[12:15], s85 offen offset:1024 lds
M v[136:139],a[76:79],v[56:59],v[136:139]
SA s85,s38,12288
v_lshlrev_b32 v14, 7, v14
v_and_b32 v15, 3, v16
M v[140:143],a[76:79],v[60:63],v[140:143]
R a[112:115],v7,45056
R a[116:119],v7,46080
M v[140:143],a[72:75],v[52:55],v[140:143]
buffer_load_dwordx4 v0, s[12:15], s85 offen offset:2048 lds
M v[144:147],a[80:83],v[48:51],v[144:147]
SA s85,s38,18432
v_lshl_add_u32 v14, v15, 3, v14
v_bfe_u32 v15, v16, 3, 2
M v[144:147],a[84:87],v[56:59],v[144:147]
R a[120:123],v7,47104
R a[124:127],v7,48128
M v[148:151],a[84:87],v[60:63],v[148:151]
buffer_load_dwordx4 v0, s[12:15], s85 offen offset:3072 lds
M v[148:151],a[80:83],v[52:55],v[148:151]
v_lshl_add_u32 v18, v15, 5, v14
v_xor_b32 v19, 32, v18
M v[152:155],a[88:91],v[48:51],v[152:155]
v_xor_b32 v20, 64, v18
v_xor_b32 v21, 0x60, v18
M v[152:155],a[92:95],v[56:59],v[152:155]
v_add_u32 v22, 0x10000, v18
v_add_u32 v23, 0x10000, v19
M v[156:159],a[92:95],v[60:63],v[156:159]
v_add_u32 v24, 0x10000, v20
v_add_u32 v25, 0x10000, v21
M v[156:159],a[88:91],v[52:55],v[156:159]
s_waitcnt lgkmcnt(0)
C v128,v128,v129
C v129,v130,v131
M v[160:163],a[96:99],v[48:51],v[160:163]
R a[64:67],v7,49152
R a[68:71],v7,50176
M v[160:163],a[100:103],v[56:59],v[160:163]
C v130,v136,v137
C v131,v138,v139
M v[164:167],a[100:103],v[60:63],v[164:167]
buffer_store_dwordx4 v[128:131], v7, s[8:11], s86 offen offset:0 sc1
M v[164:167],a[96:99],v[52:55],v[164:167]
R a[72:75],v7,51200
R a[76:79],v7,52224
M v[168:171],a[104:107],v[48:51],v[168:171]
C v132,v132,v133
C v133,v134,v135
M v[168:171],a[108:111],v[56:59],v[168:171]
C v134,v140,v141
C v135,v142,v143
M v[172:175],a[108:111],v[60:63],v[172:175]
R a[80:83],v7,53248
R a[84:87],v7,54272
M v[172:175],a[104:107],v[52:55],v[172:175]
buffer_store_dwordx4 v[132:135], v7, s[8:11], s88 offen offset:0 sc1
M v[176:179],a[112:115],v[48:51],v[176:179]
C v144,v144,v145
C v145,v146,v147
M v[176:179],a[116:119],v[56:59],v[176:179]
R a[88:91],v7,55296
R a[92:95],v7,56320
M v[180:183],a[116:119],v[60:63],v[180:183]
C v146,v152,v153
C v147,v154,v155
M v[180:183],a[112:115],v[52:55],v[180:183]
buffer_store_dwordx4 v[144:147], v7, s[8:11], s86 offen offset:1024 sc1
M v[184:187],a[120:123],v[48:51],v[184:187]
C v148,v148,v149
C v149,v150,v151
M v[184:187],a[124:127],v[56:59],v[184:187]
C v150,v156,v157
C v151,v158,v159
M v[188:191],a[124:127],v[60:63],v[188:191]
buffer_store_dwordx4 v[148:151], v7, s[8:11], s88 offen offset:1024 sc1
M v[188:191],a[120:123],v[52:55],v[188:191]
s_waitcnt lgkmcnt(0)
C v160,v160,v161
C v161,v162,v163
M v[192:195],a[64:67],v[48:51],v[192:195]
R a[96:99],v7,57344
R a[100:103],v7,58368
M v[192:195],a[68:71],v[56:59],v[192:195]
C v162,v168,v169
C v163,v170,v171
M v[196:199],a[68:71],v[60:63],v[196:199]
buffer_store_dwordx4 v[160:163], v7, s[8:11], s86 offen offset:2048 sc1
M v[196:199],a[64:67],v[52:55],v[196:199]
R a[104:107],v7,59392
R a[108:111],v7,60416
M v[200:203],a[72:75],v[48:51],v[200:203]
C v164,v164,v165
C v165,v166,v167
M v[200:203],a[76:79],v[56:59],v[200:203]
C v166,v172,v173
C v167,v174,v175
M v[204:207],a[76:79],v[60:63],v[204:207]
R a[112:115],v7,61440
R a[116:119],v7,62464
M v[204:207],a[72:75],v[52:55],v[204:207]
buffer_store_dwordx4 v[164:167], v7, s[8:11], s88 offen offset:2048 sc1
M v[208:211],a[80:83],v[48:51],v[208:211]
C v176,v176,v177
C v177,v178,v179
M v[208:211],a[84:87],v[56:59],v[208:211]
R a[120:123],v7,63488
R a[124:127],v7,64512
M v[212:215],a[84:87],v[60:63],v[212:215]
C v178,v184,v185
C v179,v186,v187
M v[212:215],a[80:83],v[52:55],v[212:215]
buffer_store_dwordx4 v[176:179], v7, s[8:11], s86 offen offset:3072 sc1
M v[216:219],a[88:91],v[48:51],v[216:219]
C v180,v180,v181
C v181,v182,v183
M v[216:219],a[92:95],v[56:59],v[216:219]
C v182,v188,v189
C v183,v190,v191
M v[220:223],a[92:95],v[60:63],v[220:223]
s_waitcnt vmcnt(12) lgkmcnt(0)
buffer_store_dwordx4 v[180:183], v7, s[8:11], s88 offen offset:3072 sc1
M v[220:223],a[88:91],v[52:55],v[220:223]
s_barrier
M v[224:227],a[96:99],v[48:51],v[224:227]
s_nop 0
T a[64:65],v22,32768
T a[66:67],v22,34816
M v[224:227],a[100:103],v[56:59],v[224:227]
T a[68:69],v22,36864
T a[70:71],v22,38912
M v[228:231],a[100:103],v[60:63],v[228:231]
C v192,v192,v193
C v193,v194,v195
M v[228:231],a[96:99],v[52:55],v[228:231]
T a[72:73],v22,40960
T a[74:75],v22,43008
M v[232:235],a[104:107],v[48:51],v[232:235]
T a[76:77],v22,45056
T a[78:79],v22,47104
M v[232:235],a[108:111],v[56:59],v[232:235]
C v194,v200,v201
C v195,v202,v203
M v[236:239],a[108:111],v[60:63],v[236:239]
T a[80:81],v22,49152
T a[82:83],v22,51200
M v[236:239],a[104:107],v[52:55],v[236:239]
T a[84:85],v22,53248
T a[86:87],v22,55296
M v[240:243],a[112:115],v[48:51],v[240:243]
buffer_store_dwordx4 v[192:195], v7, s[8:11], s87 offen offset:0 sc1
M v[240:243],a[116:119],v[56:59],v[240:243]
s_nop 0
T a[88:89],v22,57344
T a[90:91],v22,59392
M v[244:247],a[116:119],v[60:63],v[244:247]
T a[92:93],v22,61440
T a[94:95],v22,63488
M v[244:247],a[112:115],v[52:55],v[244:247]
C v196,v196,v197
C v197,v198,v199
M v[248:251],a[120:123],v[48:51],v[248:251]
C v198,v204,v205
C v199,v206,v207
M v[248:251],a[124:127],v[56:59],v[248:251]
buffer_store_dwordx4 v[196:199], v7, s[8:11], s89 offen offset:0 sc1
M v[252:255],a[124:127],v[60:63],v[252:255]
s_waitcnt lgkmcnt(0)
C v208,v208,v209
C v209,v210,v211
M v[252:255],a[120:123],v[52:55],v[252:255]
C v210,v216,v217
C v211,v218,v219
buffer_store_dwordx4 v[208:211], v7, s[8:11], s87 offen offset:1024 sc1
C v212,v212,v213
C v213,v214,v215
C v214,v220,v221
C v215,v222,v223
buffer_store_dwordx4 v[212:215], v7, s[8:11], s89 offen offset:1024 sc1
C v224,v224,v225
C v225,v226,v227
C v226,v232,v233
C v227,v234,v235
buffer_store_dwordx4 v[224:227], v7, s[8:11], s87 offen offset:2048 sc1
C v228,v228,v229
C v229,v230,v231
C v230,v236,v237
C v231,v238,v239
buffer_store_dwordx4 v[228:231], v7, s[8:11], s89 offen offset:2048 sc1
C v240,v240,v241
C v241,v242,v243
C v242,v248,v249
C v243,v250,v251
buffer_store_dwordx4 v[240:243], v7, s[8:11], s87 offen offset:3072 sc1
C v244,v244,v245
C v245,v246,v247
C v246,v252,v253
C v247,v254,v255
buffer_store_dwordx4 v[244:247], v7, s[8:11], s89 offen offset:3072 sc1
M v[64:67],a[64:67],a[128:131],0
s_nop 0
T a[96:97],v23,32768
T a[98:99],v23,34816
M v[64:67],a[68:71],a[132:135],v[64:67]
SA m0,s28,69632
T a[100:101],v23,36864
T a[102:103],v23,38912
M v[64:67],a[72:75],a[136:139],v[64:67]
SA s85,s38,28672
buffer_load_dwordx4 v0, s[12:15], s85 offen offset:0 lds
M v[64:67],a[76:79],a[140:143],v[64:67]
SA s85,s38,34816
T a[104:105],v23,40960
T a[106:107],v23,43008
M v[64:67],a[80:83],a[144:147],v[64:67]
SA s29,s33,0
T a[108:109],v23,45056
T a[110:111],v23,47104
M v[64:67],a[84:87],a[148:151],v[64:67]
SA s30,s33,14336
buffer_load_dwordx4 v0, s[12:15], s85 offen offset:1024 lds
M v[64:67],a[88:91],a[152:155],v[64:67]
SA s85,s38,40960
T a[112:113],v23,49152
T a[114:115],v23,51200
M v[64:67],a[92:95],a[156:159],v[64:67]
T a[116:117],v23,53248
T a[118:119],v23,55296
M v[68:71],a[92:95],a[188:191],0
buffer_load_dwordx4 v0, s[12:15], s85 offen offset:2048 lds
M v[68:71],a[88:91],a[184:187],v[68:71]
SA s85,s38,47104
T a[120:121],v23,57344
T a[122:123],v23,59392
M v[68:71],a[84:87],a[180:183],v[68:71]
T a[124:125],v23,61440
T a[126:127],v23,63488
M v[68:71],a[80:83],a[176:179],v[68:71]
buffer_load_dwordx4 v0, s[12:15], s85 offen offset:3072 lds
M v[68:71],a[76:79],a[172:175],v[68:71]
SA s38,s38,128
G v5,a192
G v6,a193
M v[68:71],a[72:75],a[168:171],v[68:71]
s_sub_u32 s64, 15, s42
M v[68:71],a[68:71],a[164:167],v[68:71]
s_min_u32 s64, s64, s42
M v[68:71],a[64:67],a[160:163],v[68:71]
s_waitcnt lgkmcnt(0)
M v[72:75],a[96:99],a[128:131],0
s_mul_i32 s45, s64, 8704
T a[64:65],v24,32768
T a[66:67],v24,34816
M v[72:75],a[100:103],a[132:135],v[72:75]
s_lshl_b32 s64, s41, 2
T a[68:69],v24,36864
T a[70:71],v24,38912
M v[72:75],a[104:107],a[136:139],v[72:75]
SA s45,s45,s64
M v[72:75],a[108:111],a[140:143],v[72:75]
s_lshl_b32 s64, s20, 8
T a[72:73],v24,40960
T a[74:75],v24,43008
M v[72:75],a[112:115],a[144:147],v[72:75]
SA s45,s45,s64
T a[76:77],v24,45056
T a[78:79],v24,47104
M v[72:75],a[116:119],a[148:151],v[72:75]
SA s45,s45,104992768
M v[72:75],a[120:123],a[152:155],v[72:75]
s_mov_b32 s64, 1024
T a[80:81],v24,49152
T a[82:83],v24,51200
M v[72:75],a[124:127],a[156:159],v[72:75]
s_mov_b32 s66, 4096
T a[84:85],v24,53248
T a[86:87],v24,55296
M v[76:79],a[124:127],a[188:191],0
s_cmp_lt_u32 s42, 8
M v[76:79],a[120:123],a[184:187],v[76:79]
s_cselect_b32 s64, 4352, s64
T a[88:89],v24,57344
T a[90:91],v24,59392
M v[76:79],a[116:119],a[180:183],v[76:79]
s_cselect_b32 s65, 0, 64
T a[92:93],v24,61440
T a[94:95],v24,63488
M v[76:79],a[112:115],a[176:179],v[76:79]
s_cselect_b32 s66, 536870912, s66
MF v64,v5,v64
MF v65,v5,v65
M v[76:79],a[108:111],a[172:175],v[76:79]
SA s3,s45,s64
MF v66,v5,v66
MF v67,v5,v67
M v[76:79],a[104:107],a[168:171],v[76:79]
SA s45,s45,s65
v_lshrrev_b32 v17, 5, v7
v_min_u32 v15, 1, v17
M v[76:79],a[100:103],a[164:167],v[76:79]
SA m0,s28,0
v_lshlrev_b32 v14, 3, v7
v_lshl_or_b32 v16, v15, 29, v14
M v[76:79],a[96:99],a[160:163],v[76:79]
s_waitcnt lgkmcnt(0)
v_cmp_eq_u32 vcc, 1, v17
v_add_u32 v14, s66, v14
M v[80:83],a[64:67],a[128:131],0
SA s85,s38,0
T a[96:97],v25,32768
T a[98:99],v25,34816
M v[80:83],a[68:71],a[132:135],v[80:83]
T a[100:101],v25,36864
T a[102:103],v25,38912
M v[80:83],a[72:75],a[136:139],v[80:83]
buffer_load_dwordx4 v0, s[12:15], s85 offen offset:0 lds
M v[80:83],a[76:79],a[140:143],v[80:83]
SA s85,s38,6144
T a[104:105],v25,40960
T a[106:107],v25,43008
M v[80:83],a[80:83],a[144:147],v[80:83]
T a[108:109],v25,45056
T a[110:111],v25,47104
M v[80:83],a[84:87],a[148:151],v[80:83]
buffer_load_dwordx4 v0, s[12:15], s85 offen offset:1024 lds
M v[80:83],a[88:91],a[152:155],v[80:83]
SA s85,s38,12288
T a[112:113],v25,49152
T a[114:115],v25,51200
M v[80:83],a[92:95],a[156:159],v[80:83]
T a[116:117],v25,53248
T a[118:119],v25,55296
M v[84:87],a[92:95],a[188:191],0
buffer_load_dwordx4 v0, s[12:15], s85 offen offset:2048 lds
M v[84:87],a[88:91],a[184:187],v[84:87]
SA s85,s38,18432
T a[120:121],v25,57344
T a[122:123],v25,59392
M v[84:87],a[84:87],a[180:183],v[84:87]
T a[124:125],v25,61440
T a[126:127],v25,63488
M v[84:87],a[80:83],a[176:179],v[84:87]
buffer_load_dwordx4 v0, s[12:15], s85 offen offset:3072 lds
M v[84:87],a[76:79],a[172:175],v[84:87]
SA m0,s28,4096
v_mov_b32 v15, 1
v_cndmask_b32 v17, v16, v14, vcc
M v[84:87],a[72:75],a[168:171],v[84:87]
SA s85,s38,28672
buffer_load_dwordx4 v0, s[12:15], s85 offen offset:0 lds
M v[84:87],a[68:71],a[164:167],v[84:87]
s_waitcnt vmcnt(5) lgkmcnt(0)
v_min_u32 v10, 1, v7
v_lshlrev_b32 v10, 29, v10
M v[84:87],a[64:67],a[160:163],v[84:87]
s_barrier
M v[88:91],a[96:99],a[128:131],0
SA s85,s38,34816
T a[64:65],v22,0
T a[66:67],v22,2048
M v[88:91],a[100:103],a[132:135],v[88:91]
T a[68:69],v22,4096
T a[70:71],v22,6144
M v[88:91],a[104:107],a[136:139],v[88:91]
buffer_load_dwordx4 v0, s[12:15], s85 offen offset:1024 lds
M v[88:91],a[108:111],a[140:143],v[88:91]
SA s85,s38,40960
T a[72:73],v22,8192
T a[74:75],v22,10240
M v[88:91],a[112:115],a[144:147],v[88:91]
T a[76:77],v22,12288
T a[78:79],v22,14336
M v[88:91],a[116:119],a[148:151],v[88:91]
buffer_load_dwordx4 v0, s[12:15], s85 offen offset:2048 lds
M v[88:91],a[120:123],a[152:155],v[88:91]
SA s85,s38,47104
T a[80:81],v22,16384
T a[82:83],v22,18432
M v[88:91],a[124:127],a[156:159],v[88:91]
T a[84:85],v22,20480
T a[86:87],v22,22528
M v[92:95],a[124:127],a[188:191],0
buffer_store_dword v15, v10, s[8:11], s47 offen sc1
M v[92:95],a[120:123],a[184:187],v[92:95]
s_nop 0
T a[88:89],v22,24576
T a[90:91],v22,26624
M v[92:95],a[116:119],a[180:183],v[92:95]
T a[92:93],v22,28672
T a[94:95],v22,30720
M v[92:95],a[112:115],a[176:179],v[92:95]
buffer_load_dwordx4 v0, s[12:15], s85 offen offset:3072 lds
M v[92:95],a[108:111],a[172:175],v[92:95]
SA s38,s38,128
MF v72,v5,v72
MF v73,v5,v73
M v[92:95],a[104:107],a[168:171],v[92:95]
SA m0,s28,131072
MF v74,v5,v74
MF v75,v5,v75
M v[92:95],a[100:103],a[164:167],v[92:95]
s_waitcnt lgkmcnt(0)
C v64,v64,v65
C v65,v66,v67
M v[92:95],a[96:99],a[160:163],v[92:95]
SA s85,s38,0
C v66,v72,v73
C v67,v74,v75
buffer_store_dwordx4 v[64:67], v7, s[8:11], s29 offen offset:0 sc1
buffer_load_dwordx4 v0, s[12:15], s85 offen offset:0 lds
v_add_u32 v40, 0x20000, v18
v_add_u32 v41, 0x20000, v19
v_add_u32 v42, 0x20000, v20
v_add_u32 v43, 0x20000, v21
SA s85,s38,6144
MF v68,v6,v68
MF v69,v6,v69
MF v70,v6,v70
MF v71,v6,v71
MF v76,v6,v76
MF v77,v6,v77
MF v78,v6,v78
MF v79,v6,v79
C v68,v68,v69
C v69,v70,v71
C v70,v76,v77
C v71,v78,v79
buffer_store_dwordx4 v[68:71], v7, s[8:11], s30 offen offset:0 sc1
buffer_load_dwordx4 v0, s[12:15], s85 offen offset:1024 lds
SA s85,s38,12288
buffer_load_dwordx4 v0, s[12:15], s85 offen offset:2048 lds
SA s85,s38,18432
buffer_load_dwordx4 v0, s[12:15], s85 offen offset:3072 lds
M v[96:99],a[64:67],a[128:131],0
s_nop 0
T a[96:97],v23,0
T a[98:99],v23,2048
M v[96:99],a[68:71],a[132:135],v[96:99]
SA m0,s28,135168
T a[100:101],v23,4096
T a[102:103],v23,6144
M v[96:99],a[72:75],a[136:139],v[96:99]
SA s85,s38,28672
buffer_load_dwordx4 v0, s[12:15], s85 offen offset:0 lds
M v[96:99],a[76:79],a[140:143],v[96:99]
SA s85,s38,34816
T a[104:105],v23,8192
T a[106:107],v23,10240
M v[96:99],a[80:83],a[144:147],v[96:99]
T a[108:109],v23,12288
T a[110:111],v23,14336
M v[96:99],a[84:87],a[148:151],v[96:99]
buffer_load_dwordx4 v0, s[12:15], s85 offen offset:1024 lds
M v[96:99],a[88:91],a[152:155],v[96:99]
SA s85,s38,40960
T a[112:113],v23,16384
T a[114:115],v23,18432
M v[96:99],a[92:95],a[156:159],v[96:99]
T a[116:117],v23,20480
T a[118:119],v23,22528
M v[100:103],a[92:95],a[188:191],0
buffer_load_dwordx4 v0, s[12:15], s85 offen offset:2048 lds
M v[100:103],a[88:91],a[184:187],v[100:103]
SA s85,s38,47104
T a[120:121],v23,24576
T a[122:123],v23,26624
M v[100:103],a[84:87],a[180:183],v[100:103]
T a[124:125],v23,28672
T a[126:127],v23,30720
M v[100:103],a[80:83],a[176:179],v[100:103]
buffer_load_dwordx4 v0, s[12:15], s85 offen offset:3072 lds
M v[100:103],a[76:79],a[172:175],v[100:103]
SA s38,s38,128
MF v80,v5,v80
MF v81,v5,v81
M v[100:103],a[72:75],a[168:171],v[100:103]
SA m0,s28,32768
MF v82,v5,v82
MF v83,v5,v83
M v[100:103],a[68:71],a[164:167],v[100:103]
SA s85,s38,0
buffer_load_dwordx4 v0, s[12:15], s85 offen offset:0 lds
M v[100:103],a[64:67],a[160:163],v[100:103]
s_waitcnt lgkmcnt(0)
MF v88,v5,v88
MF v89,v5,v89
M v[104:107],a[96:99],a[128:131],0
SA s85,s38,6144
T a[64:65],v24,0
T a[66:67],v24,2048
M v[104:107],a[100:103],a[132:135],v[104:107]
T a[68:69],v24,4096
T a[70:71],v24,6144
M v[104:107],a[104:107],a[136:139],v[104:107]
buffer_load_dwordx4 v0, s[12:15], s85 offen offset:1024 lds
M v[104:107],a[108:111],a[140:143],v[104:107]
SA s85,s38,12288
T a[72:73],v24,8192
T a[74:75],v24,10240
M v[104:107],a[112:115],a[144:147],v[104:107]
T a[76:77],v24,12288
T a[78:79],v24,14336
M v[104:107],a[116:119],a[148:151],v[104:107]
buffer_load_dwordx4 v0, s[12:15], s85 offen offset:2048 lds
M v[104:107],a[120:123],a[152:155],v[104:107]
SA s85,s38,18432
T a[80:81],v24,16384
T a[82:83],v24,18432
M v[104:107],a[124:127],a[156:159],v[104:107]
T a[84:85],v24,20480
T a[86:87],v24,22528
M v[108:111],a[124:127],a[188:191],0
buffer_load_dwordx4 v0, s[12:15], s85 offen offset:3072 lds
M v[108:111],a[120:123],a[184:187],v[108:111]
SA m0,s28,36864
T a[88:89],v24,24576
T a[90:91],v24,26624
M v[108:111],a[116:119],a[180:183],v[108:111]
SA s85,s38,28672
T a[92:93],v24,28672
T a[94:95],v24,30720
M v[108:111],a[112:115],a[176:179],v[108:111]
buffer_load_dwordx4 v0, s[12:15], s85 offen offset:0 lds
M v[108:111],a[108:111],a[172:175],v[108:111]
SA s85,s38,34816
MF v90,v5,v90
MF v91,v5,v91
M v[108:111],a[104:107],a[168:171],v[108:111]
C v80,v80,v81
C v81,v82,v83
M v[108:111],a[100:103],a[164:167],v[108:111]
buffer_load_dwordx4 v0, s[12:15], s85 offen offset:1024 lds
M v[108:111],a[96:99],a[160:163],v[108:111]
s_waitcnt lgkmcnt(0)
C v82,v88,v89
C v83,v90,v91
M v[112:115],a[64:67],a[128:131],0
SA s85,s38,40960
T a[96:97],v25,0
T a[98:99],v25,2048
M v[112:115],a[68:71],a[132:135],v[112:115]
T a[100:101],v25,4096
T a[102:103],v25,6144
M v[112:115],a[72:75],a[136:139],v[112:115]
buffer_store_dwordx4 v[80:83], v7, s[8:11], s29 offen offset:1024 sc1
M v[112:115],a[76:79],a[140:143],v[112:115]
s_nop 0
T a[104:105],v25,8192
T a[106:107],v25,10240
M v[112:115],a[80:83],a[144:147],v[112:115]
T a[108:109],v25,12288
T a[110:111],v25,14336
M v[112:115],a[84:87],a[148:151],v[112:115]
buffer_load_dwordx4 v0, s[12:15], s85 offen offset:2048 lds
M v[112:115],a[88:91],a[152:155],v[112:115]
SA s85,s38,47104
T a[112:113],v25,16384
T a[114:115],v25,18432
M v[112:115],a[92:95],a[156:159],v[112:115]
T a[116:117],v25,20480
T a[118:119],v25,22528
M v[116:119],a[92:95],a[188:191],0
buffer_load_dwordx4 v0, s[12:15], s85 offen offset:3072 lds
M v[116:119],a[88:91],a[184:187],v[116:119]
SA s38,s38,128
T a[120:121],v25,24576
T a[122:123],v25,26624
M v[116:119],a[84:87],a[180:183],v[116:119]
SA m0,s28,98304
T a[124:125],v25,28672
T a[126:127],v25,30720
M v[116:119],a[80:83],a[176:179],v[116:119]
SA s85,s38,0
buffer_load_dwordx4 v0, s[12:15], s85 offen offset:0 lds
M v[116:119],a[76:79],a[172:175],v[116:119]
SA s85,s38,6144
MF v84,v6,v84
MF v85,v6,v85
M v[116:119],a[72:75],a[168:171],v[116:119]
buffer_load_dwordx4 v0, s[12:15], s85 offen offset:1024 lds
M v[116:119],a[68:71],a[164:167],v[116:119]
s_waitcnt vmcnt(21) lgkmcnt(0)
MF v86,v6,v86
MF v87,v6,v87
M v[116:119],a[64:67],a[160:163],v[116:119]
s_barrier
M v[120:123],a[96:99],a[128:131],0
SA s85,s38,12288
T a[64:65],v18,0
T a[66:67],v18,2048
M v[120:123],a[100:103],a[132:135],v[120:123]
T a[68:69],v18,4096
T a[70:71],v18,6144
M v[120:123],a[104:107],a[136:139],v[120:123]
buffer_load_dwordx4 v0, s[12:15], s85 offen offset:2048 lds
M v[120:123],a[108:111],a[140:143],v[120:123]
SA s85,s38,18432
T a[72:73],v18,8192
T a[74:75],v18,10240
M v[120:123],a[112:115],a[144:147],v[120:123]
T a[76:77],v18,12288
T a[78:79],v18,14336
M v[120:123],a[116:119],a[148:151],v[120:123]
buffer_load_dwordx4 v0, s[12:15], s85 offen offset:3072 lds
M v[120:123],a[120:123],a[152:155],v[120:123]
s_nop 0
T a[80:81],v18,16384
T a[82:83],v18,18432
M v[120:123],a[124:127],a[156:159],v[120:123]
T a[84:85],v18,20480
T a[86:87],v18,22528
M v[124:127],a[124:127],a[188:191],0
MF v92,v6,v92
MF v93,v6,v93
M v[124:127],a[120:123],a[184:187],v[124:127]
T a[88:89],v18,24576
T a[90:91],v18,26624
M v[124:127],a[116:119],a[180:183],v[124:127]
T a[92:93],v18,28672
T a[94:95],v18,30720
M v[124:127],a[112:115],a[176:179],v[124:127]
MF v94,v6,v94
MF v95,v6,v95
M v[124:127],a[108:111],a[172:175],v[124:127]
C v84,v84,v85
C v85,v86,v87
M v[124:127],a[104:107],a[168:171],v[124:127]
C v86,v92,v93
C v87,v94,v95
M v[124:127],a[100:103],a[164:167],v[124:127]
s_waitcnt lgkmcnt(0)
buffer_store_dwordx4 v[84:87], v7, s[8:11], s30 offen offset:1024 sc1
M v[124:127],a[96:99],a[160:163],v[124:127]
SA s29,s33,2048
SA s30,s33,16384
MF v96,v5,v96
MF v97,v5,v97
MF v98,v5,v98
MF v99,v5,v99
MF v104,v5,v104
MF v105,v5,v105
MF v106,v5,v106
MF v107,v5,v107
C v96,v96,v97
C v97,v98,v99
C v98,v104,v105
C v99,v106,v107
buffer_store_dwordx4 v[96:99], v7, s[8:11], s29 offen offset:0 sc1
MF v100,v6,v100
MF v101,v6,v101
MF v102,v6,v102
MF v103,v6,v103
MF v108,v6,v108
MF v109,v6,v109
MF v110,v6,v110
MF v111,v6,v111
C v100,v100,v101
C v101,v102,v103
C v102,v108,v109
C v103,v110,v111
buffer_store_dwordx4 v[100:103], v7, s[8:11], s30 offen offset:0 sc1
M v[64:67],a[64:67],a[128:131],0
s_nop 0
T a[96:97],v19,0
T a[98:99],v19,2048
M v[64:67],a[68:71],a[132:135],v[64:67]
SA m0,s28,102400
T a[100:101],v19,4096
T a[102:103],v19,6144
M v[64:67],a[72:75],a[136:139],v[64:67]
SA s85,s38,28672
buffer_load_dwordx4 v0, s[12:15], s85 offen offset:0 lds
M v[64:67],a[76:79],a[140:143],v[64:67]
SA s85,s38,34816
T a[104:105],v19,8192
T a[106:107],v19,10240
M v[64:67],a[80:83],a[144:147],v[64:67]
T a[108:109],v19,12288
T a[110:111],v19,14336
M v[64:67],a[84:87],a[148:151],v[64:67]
buffer_load_dwordx4 v0, s[12:15], s85 offen offset:1024 lds
M v[64:67],a[88:91],a[152:155],v[64:67]
s_nop 0
T a[112:113],v19,16384
T a[114:115],v19,18432
M v[64:67],a[92:95],a[156:159],v[64:67]
SA s85,s38,40960
T a[116:117],v19,20480
T a[118:119],v19,22528
M v[68:71],a[92:95],a[188:191],0
buffer_load_dwordx4 v0, s[12:15], s85 offen offset:2048 lds
M v[68:71],a[88:91],a[184:187],v[68:71]
s_nop 0
T a[120:121],v19,24576
T a[122:123],v19,26624
M v[68:71],a[84:87],a[180:183],v[68:71]
T a[124:125],v19,28672
T a[126:127],v19,30720
M v[68:71],a[80:83],a[176:179],v[68:71]
SA s85,s38,47104
MF v112,v5,v112
MF v113,v5,v113
M v[68:71],a[76:79],a[172:175],v[68:71]
buffer_load_dwordx4 v0, s[12:15], s85 offen offset:3072 lds
M v[68:71],a[72:75],a[168:171],v[68:71]
SA s38,s38,128
MF v114,v5,v114
MF v115,v5,v115
M v[68:71],a[68:71],a[164:167],v[68:71]
SA m0,s28,65536
MF v120,v5,v120
MF v121,v5,v121
M v[68:71],a[64:67],a[160:163],v[68:71]
s_waitcnt lgkmcnt(0)
MF v122,v5,v122
MF v123,v5,v123
M v[72:75],a[96:99],a[128:131],0
SA s85,s38,0
T a[64:65],v20,0
T a[66:67],v20,2048
M v[72:75],a[100:103],a[132:135],v[72:75]
T a[68:69],v20,4096
T a[70:71],v20,6144
M v[72:75],a[104:107],a[136:139],v[72:75]
buffer_load_dwordx4 v0, s[12:15], s85 offen offset:0 lds
M v[72:75],a[108:111],a[140:143],v[72:75]
SA s85,s38,6144
T a[72:73],v20,8192
T a[74:75],v20,10240
M v[72:75],a[112:115],a[144:147],v[72:75]
T a[76:77],v20,12288
T a[78:79],v20,14336
M v[72:75],a[116:119],a[148:151],v[72:75]
buffer_load_dwordx4 v0, s[12:15], s85 offen offset:1024 lds
M v[72:75],a[120:123],a[152:155],v[72:75]
SA s85,s38,12288
T a[80:81],v20,16384
T a[82:83],v20,18432
M v[72:75],a[124:127],a[156:159],v[72:75]
T a[84:85],v20,20480
T a[86:87],v20,22528
M v[76:79],a[124:127],a[188:191],0
buffer_load_dwordx4 v0, s[12:15], s85 offen offset:2048 lds
M v[76:79],a[120:123],a[184:187],v[76:79]
SA s85,s38,18432
T a[88:89],v20,24576
T a[90:91],v20,26624
M v[76:79],a[116:119],a[180:183],v[76:79]
T a[92:93],v20,28672
T a[94:95],v20,30720
M v[76:79],a[112:115],a[176:179],v[76:79]
buffer_load_dwordx4 v0, s[12:15], s85 offen offset:3072 lds
M v[76:79],a[108:111],a[172:175],v[76:79]
SA m0,s28,69632
C v112,v112,v113
C v113,v114,v115
M v[76:79],a[104:107],a[168:171],v[76:79]
SA s85,s38,28672
C v114,v120,v121
C v115,v122,v123
M v[76:79],a[100:103],a[164:167],v[76:79]
buffer_store_dwordx4 v[112:115], v7, s[8:11], s29 offen offset:1024 sc1
M v[76:79],a[96:99],a[160:163],v[76:79]
s_waitcnt lgkmcnt(0)
MF v116,v6,v116
MF v117,v6,v117
M v[80:83],a[64:67],a[128:131],0
T a[96:97],v21,0
T a[98:99],v21,2048
M v[80:83],a[68:71],a[132:135],v[80:83]
T a[100:101],v21,4096
T a[102:103],v21,6144
M v[80:83],a[72:75],a[136:139],v[80:83]
buffer_load_dwordx4 v0, s[12:15], s85 offen offset:0 lds
M v[80:83],a[76:79],a[140:143],v[80:83]
SA s85,s38,34816
T a[104:105],v21,8192
T a[106:107],v21,10240
M v[80:83],a[80:83],a[144:147],v[80:83]
T a[108:109],v21,12288
T a[110:111],v21,14336
M v[80:83],a[84:87],a[148:151],v[80:83]
buffer_load_dwordx4 v0, s[12:15], s85 offen offset:1024 lds
M v[80:83],a[88:91],a[152:155],v[80:83]
SA s85,s38,40960
T a[112:113],v21,16384
T a[114:115],v21,18432
M v[80:83],a[92:95],a[156:159],v[80:83]
T a[116:117],v21,20480
T a[118:119],v21,22528
M v[84:87],a[92:95],a[188:191],0
buffer_load_dwordx4 v0, s[12:15], s85 offen offset:2048 lds
M v[84:87],a[88:91],a[184:187],v[84:87]
SA s85,s38,47104
T a[120:121],v21,24576
T a[122:123],v21,26624
M v[84:87],a[84:87],a[180:183],v[84:87]
T a[124:125],v21,28672
T a[126:127],v21,30720
M v[84:87],a[80:83],a[176:179],v[84:87]
buffer_load_dwordx4 v0, s[12:15], s85 offen offset:3072 lds
M v[84:87],a[76:79],a[172:175],v[84:87]
MF v118,v6,v118
MF v119,v6,v119
M v[84:87],a[72:75],a[168:171],v[84:87]
SA s38,s38,128
MF v124,v6,v124
MF v125,v6,v125
M v[84:87],a[68:71],a[164:167],v[84:87]
s_waitcnt vmcnt(29) lgkmcnt(0)
MF v126,v6,v126
MF v127,v6,v127
M v[84:87],a[64:67],a[160:163],v[84:87]
s_barrier
M v[88:91],a[96:99],a[128:131],0
s_nop 0
T a[64:65],v40,0
T a[66:67],v40,2048
M v[88:91],a[100:103],a[132:135],v[88:91]
T a[68:69],v40,4096
T a[70:71],v40,6144
M v[88:91],a[104:107],a[136:139],v[88:91]
C v116,v116,v117
C v117,v118,v119
M v[88:91],a[108:111],a[140:143],v[88:91]
T a[72:73],v40,8192
T a[74:75],v40,10240
M v[88:91],a[112:115],a[144:147],v[88:91]
T a[76:77],v40,12288
T a[78:79],v40,14336
M v[88:91],a[116:119],a[148:151],v[88:91]
C v118,v124,v125
C v119,v126,v127
M v[88:91],a[120:123],a[152:155],v[88:91]
T a[80:81],v40,16384
T a[82:83],v40,18432
M v[88:91],a[124:127],a[156:159],v[88:91]
T a[84:85],v40,20480
T a[86:87],v40,22528
M v[92:95],a[124:127],a[188:191],0
buffer_store_dwordx4 v[116:119], v7, s[8:11], s30 offen offset:1024 sc1
M v[92:95],a[120:123],a[184:187],v[92:95]
SA s29,s33,4096
T a[88:89],v40,24576
T a[90:91],v40,26624
M v[92:95],a[116:119],a[180:183],v[92:95]
SA s30,s33,18432
T a[92:93],v40,28672
T a[94:95],v40,30720
M v[92:95],a[112:115],a[176:179],v[92:95]
MF v64,v5,v64
MF v65,v5,v65
M v[92:95],a[108:111],a[172:175],v[92:95]
MF v66,v5,v66
MF v67,v5,v67
M v[92:95],a[104:107],a[168:171],v[92:95]
MF v72,v5,v72
MF v73,v5,v73
M v[92:95],a[100:103],a[164:167],v[92:95]
s_waitcnt lgkmcnt(0)
MF v74,v5,v74
MF v75,v5,v75
M v[92:95],a[96:99],a[160:163],v[92:95]
C v64,v64,v65
C v65,v66,v67
C v66,v72,v73
C v67,v74,v75
buffer_store_dwordx4 v[64:67], v7, s[8:11], s29 offen offset:0 sc1
MF v68,v6,v68
MF v69,v6,v69
MF v70,v6,v70
MF v71,v6,v71
MF v76,v6,v76
MF v77,v6,v77
MF v78,v6,v78
MF v79,v6,v79
C v68,v68,v69
C v69,v70,v71
C v70,v76,v77
C v71,v78,v79
buffer_store_dwordx4 v[68:71], v7, s[8:11], s30 offen offset:0 sc1
M v[96:99],a[64:67],a[128:131],0
s_nop 0
T a[96:97],v41,0
T a[98:99],v41,2048
M v[96:99],a[68:71],a[132:135],v[96:99]
T a[100:101],v41,4096
T a[102:103],v41,6144
M v[96:99],a[72:75],a[136:139],v[96:99]
MF v80,v5,v80
MF v81,v5,v81
M v[96:99],a[76:79],a[140:143],v[96:99]
T a[104:105],v41,8192
T a[106:107],v41,10240
M v[96:99],a[80:83],a[144:147],v[96:99]
T a[108:109],v41,12288
T a[110:111],v41,14336
M v[96:99],a[84:87],a[148:151],v[96:99]
MF v82,v5,v82
MF v83,v5,v83
M v[96:99],a[88:91],a[152:155],v[96:99]
T a[112:113],v41,16384
T a[114:115],v41,18432
M v[96:99],a[92:95],a[156:159],v[96:99]
T a[116:117],v41,20480
T a[118:119],v41,22528
M v[100:103],a[92:95],a[188:191],0
MF v88,v5,v88
MF v89,v5,v89
M v[100:103],a[88:91],a[184:187],v[100:103]
T a[120:121],v41,24576
T a[122:123],v41,26624
M v[100:103],a[84:87],a[180:183],v[100:103]
T a[124:125],v41,28672
T a[126:127],v41,30720
M v[100:103],a[80:83],a[176:179],v[100:103]
MF v90,v5,v90
MF v91,v5,v91
M v[100:103],a[76:79],a[172:175],v[100:103]
C v80,v80,v81
C v81,v82,v83
M v[100:103],a[72:75],a[168:171],v[100:103]
C v82,v88,v89
C v83,v90,v91
M v[100:103],a[68:71],a[164:167],v[100:103]
buffer_store_dwordx4 v[80:83], v7, s[8:11], s29 offen offset:1024 sc1
M v[100:103],a[64:67],a[160:163],v[100:103]
s_waitcnt lgkmcnt(0)
MF v84,v6,v84
MF v85,v6,v85
M v[104:107],a[96:99],a[128:131],0
T a[64:65],v42,0
T a[66:67],v42,2048
M v[104:107],a[100:103],a[132:135],v[104:107]
T a[68:69],v42,4096
T a[70:71],v42,6144
M v[104:107],a[104:107],a[136:139],v[104:107]
MF v86,v6,v86
MF v87,v6,v87
M v[104:107],a[108:111],a[140:143],v[104:107]
T a[72:73],v42,8192
T a[74:75],v42,10240
M v[104:107],a[112:115],a[144:147],v[104:107]
T a[76:77],v42,12288
T a[78:79],v42,14336
M v[104:107],a[116:119],a[148:151],v[104:107]
MF v92,v6,v92
MF v93,v6,v93
M v[104:107],a[120:123],a[152:155],v[104:107]
T a[80:81],v42,16384
T a[82:83],v42,18432
M v[104:107],a[124:127],a[156:159],v[104:107]
T a[84:85],v42,20480
T a[86:87],v42,22528
M v[108:111],a[124:127],a[188:191],0
MF v94,v6,v94
MF v95,v6,v95
M v[108:111],a[120:123],a[184:187],v[108:111]
T a[88:89],v42,24576
T a[90:91],v42,26624
M v[108:111],a[116:119],a[180:183],v[108:111]
T a[92:93],v42,28672
T a[94:95],v42,30720
M v[108:111],a[112:115],a[176:179],v[108:111]
C v84,v84,v85
C v85,v86,v87
M v[108:111],a[108:111],a[172:175],v[108:111]
C v86,v92,v93
C v87,v94,v95
M v[108:111],a[104:107],a[168:171],v[108:111]
buffer_store_dwordx4 v[84:87], v7, s[8:11], s30 offen offset:1024 sc1
M v[108:111],a[100:103],a[164:167],v[108:111]
SA s29,s33,6144
M v[108:111],a[96:99],a[160:163],v[108:111]
s_waitcnt lgkmcnt(0)
M v[112:115],a[64:67],a[128:131],0
SA s30,s33,20480
T a[96:97],v43,0
T a[98:99],v43,2048
M v[112:115],a[68:71],a[132:135],v[112:115]
T a[100:101],v43,4096
T a[102:103],v43,6144
M v[112:115],a[72:75],a[136:139],v[112:115]
MF v96,v5,v96
MF v97,v5,v97
M v[112:115],a[76:79],a[140:143],v[112:115]
T a[104:105],v43,8192
T a[106:107],v43,10240
M v[112:115],a[80:83],a[144:147],v[112:115]
T a[108:109],v43,12288
T a[110:111],v43,14336
M v[112:115],a[84:87],a[148:151],v[112:115]
MF v98,v5,v98
MF v99,v5,v99
M v[112:115],a[88:91],a[152:155],v[112:115]
T a[112:113],v43,16384
T a[114:115],v43,18432
M v[112:115],a[92:95],a[156:159],v[112:115]
T a[116:117],v43,20480
T a[118:119],v43,22528
M v[116:119],a[92:95],a[188:191],0
MF v104,v5,v104
MF v105,v5,v105
M v[116:119],a[88:91],a[184:187],v[116:119]
T a[120:121],v43,24576
T a[122:123],v43,26624
M v[116:119],a[84:87],a[180:183],v[116:119]
T a[124:125],v43,28672
T a[126:127],v43,30720
M v[116:119],a[80:83],a[176:179],v[116:119]
MF v106,v5,v106
MF v107,v5,v107
M v[116:119],a[76:79],a[172:175],v[116:119]
C v96,v96,v97
C v97,v98,v99
M v[116:119],a[72:75],a[168:171],v[116:119]
C v98,v104,v105
C v99,v106,v107
M v[116:119],a[68:71],a[164:167],v[116:119]
s_waitcnt vmcnt(25) lgkmcnt(0)
buffer_store_dwordx4 v[96:99], v7, s[8:11], s29 offen offset:0 sc1
M v[116:119],a[64:67],a[160:163],v[116:119]
s_barrier
M v[120:123],a[96:99],a[128:131],0
s_nop 0
T a[64:65],v18,32768
T a[66:67],v18,34816
M v[120:123],a[100:103],a[132:135],v[120:123]
T a[68:69],v18,36864
T a[70:71],v18,38912
M v[120:123],a[104:107],a[136:139],v[120:123]
MF v100,v6,v100
MF v101,v6,v101
M v[120:123],a[108:111],a[140:143],v[120:123]
T a[72:73],v18,40960
T a[74:75],v18,43008
M v[120:123],a[112:115],a[144:147],v[120:123]
T a[76:77],v18,45056
T a[78:79],v18,47104
M v[120:123],a[116:119],a[148:151],v[120:123]
MF v102,v6,v102
MF v103,v6,v103
M v[120:123],a[120:123],a[152:155],v[120:123]
T a[80:81],v18,49152
T a[82:83],v18,51200
M v[120:123],a[124:127],a[156:159],v[120:123]
T a[84:85],v18,53248
T a[86:87],v18,55296
M v[124:127],a[124:127],a[188:191],0
MF v108,v6,v108
MF v109,v6,v109
M v[124:127],a[120:123],a[184:187],v[124:127]
T a[88:89],v18,57344
T a[90:91],v18,59392
M v[124:127],a[116:119],a[180:183],v[124:127]
T a[92:93],v18,61440
T a[94:95],v18,63488
M v[124:127],a[112:115],a[176:179],v[124:127]
MF v110,v6,v110
MF v111,v6,v111
M v[124:127],a[108:111],a[172:175],v[124:127]
C v100,v100,v101
C v101,v102,v103
M v[124:127],a[104:107],a[168:171],v[124:127]
C v102,v108,v109
C v103,v110,v111
M v[124:127],a[100:103],a[164:167],v[124:127]
s_waitcnt lgkmcnt(0)
buffer_store_dwordx4 v[100:103], v7, s[8:11], s30 offen offset:0 sc1
M v[124:127],a[96:99],a[160:163],v[124:127]
M v[64:67],a[64:67],a[128:131],0
s_nop 0
T a[96:97],v19,32768
T a[98:99],v19,34816
M v[64:67],a[68:71],a[132:135],v[64:67]
T a[100:101],v19,36864
T a[102:103],v19,38912
M v[64:67],a[72:75],a[136:139],v[64:67]
v_lshrrev_b32 v32, 4, v7
MF v112,v5,v112
M v[64:67],a[76:79],a[140:143],v[64:67]
s_lshr_b32 s74, s41, 3
T a[104:105],v19,40960
T a[106:107],v19,43008
M v[64:67],a[80:83],a[144:147],v[64:67]
s_lshl_b32 s64, s42, 1
T a[108:109],v19,45056
T a[110:111],v19,47104
M v[64:67],a[84:87],a[148:151],v[64:67]
SA s46,s64,s74
MF v113,v5,v113
MF v114,v5,v114
M v[64:67],a[88:91],a[152:155],v[64:67]
s_mul_i32 s46, s46, 4352
T a[112:113],v19,49152
T a[114:115],v19,51200
M v[64:67],a[92:95],a[156:159],v[64:67]
s_and_b32 s72, s41, 7
T a[116:117],v19,53248
T a[118:119],v19,55296
M v[68:71],a[92:95],a[188:191],0
s_lshl_b32 s65, s72, 7
MF v115,v5,v115
MF v120,v5,v120
M v[68:71],a[88:91],a[184:187],v[68:71]
SA s46,s46,s65
T a[120:121],v19,57344
T a[122:123],v19,59392
M v[68:71],a[84:87],a[180:183],v[68:71]
SA s46,s46,104992768
T a[124:125],v19,61440
T a[126:127],v19,63488
M v[68:71],a[80:83],a[176:179],v[68:71]
v_and_b32 v33, 31, v32
MF v121,v5,v121
M v[68:71],a[76:79],a[172:175],v[68:71]
MF v122,v5,v122
MF v123,v5,v123
M v[68:71],a[72:75],a[168:171],v[68:71]
C v112,v112,v113
C v113,v114,v115
M v[68:71],a[68:71],a[164:167],v[68:71]
C v114,v120,v121
C v115,v122,v123
M v[68:71],a[64:67],a[160:163],v[68:71]
s_waitcnt lgkmcnt(0)
buffer_store_dwordx4 v[112:115], v7, s[8:11], s29 offen offset:1024 sc1
M v[72:75],a[96:99],a[128:131],0
s_nop 0
T a[64:65],v20,32768
T a[66:67],v20,34816
M v[72:75],a[100:103],a[132:135],v[72:75]
T a[68:69],v20,36864
T a[70:71],v20,38912
M v[72:75],a[104:107],a[136:139],v[72:75]
MF v116,v6,v116
MF v117,v6,v117
M v[72:75],a[108:111],a[140:143],v[72:75]
T a[72:73],v20,40960
T a[74:75],v20,43008
M v[72:75],a[112:115],a[144:147],v[72:75]
T a[76:77],v20,45056
T a[78:79],v20,47104
M v[72:75],a[116:119],a[148:151],v[72:75]
MF v118,v6,v118
MF v119,v6,v119
M v[72:75],a[120:123],a[152:155],v[72:75]
T a[80:81],v20,49152
T a[82:83],v20,51200
M v[72:75],a[124:127],a[156:159],v[72:75]
T a[84:85],v20,53248
T a[86:87],v20,55296
M v[76:79],a[124:127],a[188:191],0
MF v124,v6,v124
MF v125,v6,v125
M v[76:79],a[120:123],a[184:187],v[76:79]
T a[88:89],v20,57344
T a[90:91],v20,59392
M v[76:79],a[116:119],a[180:183],v[76:79]
T a[92:93],v20,61440
T a[94:95],v20,63488
M v[76:79],a[112:115],a[176:179],v[76:79]
MF v126,v6,v126
MF v127,v6,v127
M v[76:79],a[108:111],a[172:175],v[76:79]
C v116,v116,v117
C v117,v118,v119
M v[76:79],a[104:107],a[168:171],v[76:79]
C v118,v124,v125
C v119,v126,v127
M v[76:79],a[100:103],a[164:167],v[76:79]
buffer_store_dwordx4 v[116:119], v7, s[8:11], s30 offen offset:1024 sc1
M v[76:79],a[96:99],a[160:163],v[76:79]
s_waitcnt lgkmcnt(0)
v_lshlrev_b32 v33, 2, v33
M v[80:83],a[64:67],a[128:131],0
SA s29,s33,8192
T a[96:97],v21,32768
T a[98:99],v21,34816
M v[80:83],a[68:71],a[132:135],v[80:83]
SA s30,s33,22528
T a[100:101],v21,36864
T a[102:103],v21,38912
M v[80:83],a[72:75],a[136:139],v[80:83]
s_lshl_b32 s65, s41, 7
MF v64,v5,v64
MF v65,v5,v65
M v[80:83],a[76:79],a[140:143],v[80:83]
SA s65,s65,104890368
T a[104:105],v21,40960
T a[106:107],v21,43008
M v[80:83],a[80:83],a[144:147],v[80:83]
T a[108:109],v21,45056
T a[110:111],v21,47104
M v[80:83],a[84:87],a[148:151],v[80:83]
buffer_load_dword v31, v33, s[8:11], s65 offen sc1
M v[80:83],a[88:91],a[152:155],v[80:83]
s_nop 0
T a[112:113],v21,49152
T a[114:115],v21,51200
M v[80:83],a[92:95],a[156:159],v[80:83]
T a[116:117],v21,53248
T a[118:119],v21,55296
M v[84:87],a[92:95],a[188:191],0
v_bfe_u32 v34, v32, 4, 1
v_lshlrev_b32 v34, 1, v34
M v[84:87],a[88:91],a[184:187],v[84:87]
T a[120:121],v21,57344
T a[122:123],v21,59392
M v[84:87],a[84:87],a[180:183],v[84:87]
T a[124:125],v21,61440
T a[126:127],v21,63488
M v[84:87],a[80:83],a[176:179],v[84:87]
v_lshrrev_b32 v35, 5, v32
v_add_u32 v34, v34, v35
M v[84:87],a[76:79],a[172:175],v[84:87]
s_mov_b32 s52, s96
MF v66,v5,v66
MF v67,v5,v67
M v[84:87],a[72:75],a[168:171],v[84:87]
s_and_b32 s53, s97, 0xffff
MF v72,v5,v72
MF v73,v5,v73
M v[84:87],a[68:71],a[164:167],v[84:87]
s_waitcnt vmcnt(19) lgkmcnt(0)
MF v74,v5,v74
MF v75,v5,v75
M v[84:87],a[64:67],a[160:163],v[84:87]
s_barrier
M v[88:91],a[96:99],a[128:131],0
s_mov_b32 s54, 1835008
T a[64:65],v22,32768
T a[66:67],v22,34816
M v[88:91],a[100:103],a[132:135],v[88:91]
s_mov_b32 s55, 0x20000
T a[68:69],v22,36864
T a[70:71],v22,38912
M v[88:91],a[104:107],a[136:139],v[88:91]
s_mul_i32 s77, s42, 1835008
C v64,v64,v65
C v65,v66,v67
M v[88:91],a[108:111],a[140:143],v[88:91]
s_mul_i32 s78, s72, 14336
T a[72:73],v22,40960
T a[74:75],v22,43008
M v[88:91],a[112:115],a[144:147],v[88:91]
SA s77,s77,s78
T a[76:77],v22,45056
T a[78:79],v22,47104
M v[88:91],a[116:119],a[148:151],v[88:91]
SA s77,s77,67108864
C v66,v72,v73
C v67,v74,v75
M v[88:91],a[120:123],a[152:155],v[88:91]
s_lshl_b32 s79, s74, 1
T a[80:81],v22,49152
T a[82:83],v22,51200
M v[88:91],a[124:127],a[156:159],v[88:91]
SA s79,s79,s20
T a[84:85],v22,53248
T a[86:87],v22,55296
M v[92:95],a[124:127],a[188:191],0
s_lshl_b32 s71, s74, 1
buffer_store_dwordx4 v[64:67], v7, s[8:11], s29 offen offset:0 sc1
M v[92:95],a[120:123],a[184:187],v[92:95]
SA s71,s71,1
T a[88:89],v22,57344
T a[90:91],v22,59392
M v[92:95],a[116:119],a[180:183],v[92:95]
s_sub_u32 s71, s71, s20
T a[92:93],v22,61440
T a[94:95],v22,63488
M v[92:95],a[112:115],a[176:179],v[92:95]
s_and_b32 s71, s71, 536870912
MF v68,v6,v68
MF v69,v6,v69
M v[92:95],a[108:111],a[172:175],v[92:95]
s_sub_u32 s64, 15, s64
MF v70,v6,v70
MF v71,v6,v71
M v[92:95],a[104:107],a[168:171],v[92:95]
s_sub_u32 s78, s64, 1
MF v76,v6,v76
MF v77,v6,v77
M v[92:95],a[100:103],a[164:167],v[92:95]
s_waitcnt lgkmcnt(0)
MF v78,v6,v78
MF v79,v6,v79
M v[92:95],a[96:99],a[160:163],v[92:95]
s_mul_i32 s78, s78, 1835008
SA s78,s78,s77
s_lshl_b32 s65, s79, 10
SA s78,s78,s65
SA s78,s78,s71
s_lshl_b32 s79, s79, 6
s_or_b32 s79, s79, s71
s_mul_i32 s67, s74, -2
s_lshl_b32 s74, s74, 3
SA s74,s74,s20
s_lshl_b32 s75, s74, 6
SA s76,s75,256
SA s67,s67,3
s_sub_u32 s67, s67, s20
s_and_b32 s67, s67, 536870912
s_or_b32 s76, s76, s67
v_or_b32 v27, s67, v7
v_add_u32 v27, 4096, v27
s_lshl_b32 s65, s74, 10
SA s77,s77,s65
s_lshl_b32 s64, s64, 7
s_lshr_b32 s73, s72, 1
s_sub_u32 s65, 7, s73
s_bitcmp1_b32 s72, 0
s_cselect_b32 s73, s65, s73
s_lshl_b32 s73, s73, 4
s_lshl_b32 s65, s42, 7
SA s73,s73,s65
v_and_b32 v37, 15, v32
v_add_u32 v37, s73, v37
v_add_u32 v29, s64, v37
s_mov_b32 s64, 104857664
v_mul_u32_u24 v38, 896, v37
v_lshl_add_u32 v38, v34, 4, v38
v_lshrrev_b32 v35, 4, v37
v_lshlrev_b32 v35, 5, v35
v_and_b32 v36, 15, v37
v_add_lshl_u32 v35, v35, v36, 2
buffer_load_dword v39, v35, s[8:11], s64 offen sc1
C v68,v68,v69
C v69,v70,v71
C v70,v76,v77
C v71,v78,v79
buffer_store_dwordx4 v[68:71], v7, s[8:11], s30 offen offset:0 sc1
buffer_load_dwordx4 v[48:51], v38, s[56:59], s75 offen
buffer_load_dwordx4 v[52:55], v38, s[56:59], s76 offen
v_mul_u32_u24 v28, 896, v29
v_lshl_add_u32 v28, v34, 4, v28
v_lshrrev_b32 v35, 4, v29
v_lshlrev_b32 v35, 5, v35
v_and_b32 v36, 15, v29
v_add_lshl_u32 v35, v35, v36, 2
buffer_load_dword v26, v35, s[8:11], s64 offen sc1
buffer_load_dwordx4 v[44:47], v28, s[56:59], s79 offen
M v[96:99],a[64:67],a[128:131],0
s_nop 0
T a[96:97],v23,32768
T a[98:99],v23,34816
M v[96:99],a[68:71],a[132:135],v[96:99]
T a[100:101],v23,36864
T a[102:103],v23,38912
M v[96:99],a[72:75],a[136:139],v[96:99]
MF v80,v5,v80
MF v81,v5,v81
M v[96:99],a[76:79],a[140:143],v[96:99]
T a[104:105],v23,40960
T a[106:107],v23,43008
M v[96:99],a[80:83],a[144:147],v[96:99]
T a[108:109],v23,45056
T a[110:111],v23,47104
M v[96:99],a[84:87],a[148:151],v[96:99]
MF v82,v5,v82
MF v83,v5,v83
M v[96:99],a[88:91],a[152:155],v[96:99]
T a[112:113],v23,49152
T a[114:115],v23,51200
M v[96:99],a[92:95],a[156:159],v[96:99]
T a[116:117],v23,53248
T a[118:119],v23,55296
M v[100:103],a[92:95],a[188:191],0
MF v88,v5,v88
MF v89,v5,v89
M v[100:103],a[88:91],a[184:187],v[100:103]
T a[120:121],v23,57344
T a[122:123],v23,59392
M v[100:103],a[84:87],a[180:183],v[100:103]
T a[124:125],v23,61440
T a[126:127],v23,63488
M v[100:103],a[80:83],a[176:179],v[100:103]
MF v90,v5,v90
MF v91,v5,v91
M v[100:103],a[76:79],a[172:175],v[100:103]
C v80,v80,v81
C v81,v82,v83
M v[100:103],a[72:75],a[168:171],v[100:103]
C v82,v88,v89
C v83,v90,v91
M v[100:103],a[68:71],a[164:167],v[100:103]
buffer_store_dwordx4 v[80:83], v7, s[8:11], s29 offen offset:1024 sc1
M v[100:103],a[64:67],a[160:163],v[100:103]
s_waitcnt lgkmcnt(0)
MF v84,v6,v84
MF v85,v6,v85
M v[104:107],a[96:99],a[128:131],0
T a[64:65],v24,32768
T a[66:67],v24,34816
M v[104:107],a[100:103],a[132:135],v[104:107]
T a[68:69],v24,36864
T a[70:71],v24,38912
M v[104:107],a[104:107],a[136:139],v[104:107]
MF v86,v6,v86
MF v87,v6,v87
M v[104:107],a[108:111],a[140:143],v[104:107]
T a[72:73],v24,40960
T a[74:75],v24,43008
M v[104:107],a[112:115],a[144:147],v[104:107]
T a[76:77],v24,45056
T a[78:79],v24,47104
M v[104:107],a[116:119],a[148:151],v[104:107]
MF v92,v6,v92
MF v93,v6,v93
M v[104:107],a[120:123],a[152:155],v[104:107]
T a[80:81],v24,49152
T a[82:83],v24,51200
M v[104:107],a[124:127],a[156:159],v[104:107]
T a[84:85],v24,53248
T a[86:87],v24,55296
M v[108:111],a[124:127],a[188:191],0
MF v94,v6,v94
MF v95,v6,v95
M v[108:111],a[120:123],a[184:187],v[108:111]
T a[88:89],v24,57344
T a[90:91],v24,59392
M v[108:111],a[116:119],a[180:183],v[108:111]
T a[92:93],v24,61440
T a[94:95],v24,63488
M v[108:111],a[112:115],a[176:179],v[108:111]
C v84,v84,v85
C v85,v86,v87
M v[108:111],a[108:111],a[172:175],v[108:111]
C v86,v92,v93
C v87,v94,v95
M v[108:111],a[104:107],a[168:171],v[108:111]
buffer_store_dwordx4 v[84:87], v7, s[8:11], s30 offen offset:1024 sc1
M v[108:111],a[100:103],a[164:167],v[108:111]
SA s29,s33,10240
M v[108:111],a[96:99],a[160:163],v[108:111]
s_waitcnt lgkmcnt(0)
M v[112:115],a[64:67],a[128:131],0
SA s30,s33,24576
T a[96:97],v25,32768
T a[98:99],v25,34816
M v[112:115],a[68:71],a[132:135],v[112:115]
T a[100:101],v25,36864
T a[102:103],v25,38912
M v[112:115],a[72:75],a[136:139],v[112:115]
MF v96,v5,v96
MF v97,v5,v97
M v[112:115],a[76:79],a[140:143],v[112:115]
T a[104:105],v25,40960
T a[106:107],v25,43008
M v[112:115],a[80:83],a[144:147],v[112:115]
T a[108:109],v25,45056
T a[110:111],v25,47104
M v[112:115],a[84:87],a[148:151],v[112:115]
MF v98,v5,v98
MF v99,v5,v99
M v[112:115],a[88:91],a[152:155],v[112:115]
T a[112:113],v25,49152
T a[114:115],v25,51200
M v[112:115],a[92:95],a[156:159],v[112:115]
T a[116:117],v25,53248
T a[118:119],v25,55296
M v[116:119],a[92:95],a[188:191],0
s_mov_b32 s84, s45
MF v104,v5,v104
MF v105,v5,v105
M v[116:119],a[88:91],a[184:187],v[116:119]
T a[120:121],v25,57344
T a[122:123],v25,59392
M v[116:119],a[84:87],a[180:183],v[116:119]
T a[124:125],v25,61440
T a[126:127],v25,63488
M v[116:119],a[80:83],a[176:179],v[116:119]
MF v106,v5,v106
MF v107,v5,v107
M v[116:119],a[76:79],a[172:175],v[116:119]
C v96,v96,v97
C v97,v98,v99
M v[116:119],a[72:75],a[168:171],v[116:119]
C v98,v104,v105
C v99,v106,v107
M v[116:119],a[68:71],a[164:167],v[116:119]
s_waitcnt vmcnt(19) lgkmcnt(0)
buffer_store_dwordx4 v[96:99], v7, s[8:11], s29 offen offset:0 sc1
M v[116:119],a[64:67],a[160:163],v[116:119]
s_barrier
M v[120:123],a[96:99],a[128:131],0
s_nop 0
T a[64:65],v22,0
T a[66:67],v22,2048
M v[120:123],a[100:103],a[132:135],v[120:123]
T a[68:69],v22,4096
T a[70:71],v22,6144
M v[120:123],a[104:107],a[136:139],v[120:123]
MF v100,v6,v100
MF v101,v6,v101
M v[120:123],a[108:111],a[140:143],v[120:123]
T a[72:73],v22,8192
T a[74:75],v22,10240
M v[120:123],a[112:115],a[144:147],v[120:123]
s_waitcnt vmcnt(11)
T a[76:77],v22,12288
T a[78:79],v22,14336
M v[120:123],a[116:119],a[148:151],v[120:123]
buffer_store_dword v15, v17, s[8:11], s84 offen sc1
M v[120:123],a[120:123],a[152:155],v[120:123]
s_nop 0
T a[80:81],v22,16384
T a[82:83],v22,18432
M v[120:123],a[124:127],a[156:159],v[120:123]
T a[84:85],v22,20480
T a[86:87],v22,22528
M v[124:127],a[124:127],a[188:191],0
MF v102,v6,v102
MF v103,v6,v103
M v[124:127],a[120:123],a[184:187],v[124:127]
T a[88:89],v22,24576
T a[90:91],v22,26624
M v[124:127],a[116:119],a[180:183],v[124:127]
T a[92:93],v22,28672
T a[94:95],v22,30720
M v[124:127],a[112:115],a[176:179],v[124:127]
MF v108,v6,v108
MF v109,v6,v109
M v[124:127],a[108:111],a[172:175],v[124:127]
MF v110,v6,v110
MF v111,v6,v111
M v[124:127],a[104:107],a[168:171],v[124:127]
C v100,v100,v101
C v101,v102,v103
M v[124:127],a[100:103],a[164:167],v[124:127]
s_waitcnt lgkmcnt(0)
C v102,v108,v109
C v103,v110,v111
M v[124:127],a[96:99],a[160:163],v[124:127]
buffer_store_dwordx4 v[100:103], v7, s[8:11], s30 offen offset:0 sc1
M v[64:67],a[64:67],a[128:131],0
s_nop 0
T a[96:97],v23,0
T a[98:99],v23,2048
M v[64:67],a[68:71],a[132:135],v[64:67]
T a[100:101],v23,4096
T a[102:103],v23,6144
M v[64:67],a[72:75],a[136:139],v[64:67]
MF v112,v5,v112
MF v113,v5,v113
M v[64:67],a[76:79],a[140:143],v[64:67]
T a[104:105],v23,8192
T a[106:107],v23,10240
M v[64:67],a[80:83],a[144:147],v[64:67]
T a[108:109],v23,12288
T a[110:111],v23,14336
M v[64:67],a[84:87],a[148:151],v[64:67]
MF v114,v5,v114
MF v115,v5,v115
M v[64:67],a[88:91],a[152:155],v[64:67]
T a[112:113],v23,16384
T a[114:115],v23,18432
M v[64:67],a[92:95],a[156:159],v[64:67]
T a[116:117],v23,20480
T a[118:119],v23,22528
M v[68:71],a[92:95],a[188:191],0
MF v120,v5,v120
MF v121,v5,v121
M v[68:71],a[88:91],a[184:187],v[68:71]
T a[120:121],v23,24576
T a[122:123],v23,26624
M v[68:71],a[84:87],a[180:183],v[68:71]
T a[124:125],v23,28672
T a[126:127],v23,30720
M v[68:71],a[80:83],a[176:179],v[68:71]
MF v122,v5,v122
MF v123,v5,v123
M v[68:71],a[76:79],a[172:175],v[68:71]
C v112,v112,v113
C v113,v114,v115
M v[68:71],a[72:75],a[168:171],v[68:71]
C v114,v120,v121
C v115,v122,v123
M v[68:71],a[68:71],a[164:167],v[68:71]
buffer_store_dwordx4 v[112:115], v7, s[8:11], s29 offen offset:1024 sc1
M v[68:71],a[64:67],a[160:163],v[68:71]
s_waitcnt lgkmcnt(0)
MF v116,v6,v116
MF v117,v6,v117
M v[72:75],a[96:99],a[128:131],0
T a[64:65],v24,0
T a[66:67],v24,2048
M v[72:75],a[100:103],a[132:135],v[72:75]
T a[68:69],v24,4096
T a[70:71],v24,6144
M v[72:75],a[104:107],a[136:139],v[72:75]
MF v118,v6,v118
MF v119,v6,v119
M v[72:75],a[108:111],a[140:143],v[72:75]
T a[72:73],v24,8192
T a[74:75],v24,10240
M v[72:75],a[112:115],a[144:147],v[72:75]
T a[76:77],v24,12288
T a[78:79],v24,14336
M v[72:75],a[116:119],a[148:151],v[72:75]
MF v124,v6,v124
MF v125,v6,v125
M v[72:75],a[120:123],a[152:155],v[72:75]
T a[80:81],v24,16384
T a[82:83],v24,18432
M v[72:75],a[124:127],a[156:159],v[72:75]
T a[84:85],v24,20480
T a[86:87],v24,22528
M v[76:79],a[124:127],a[188:191],0
MF v126,v6,v126
MF v127,v6,v127
M v[76:79],a[120:123],a[184:187],v[76:79]
T a[88:89],v24,24576
T a[90:91],v24,26624
M v[76:79],a[116:119],a[180:183],v[76:79]
T a[92:93],v24,28672
T a[94:95],v24,30720
M v[76:79],a[112:115],a[176:179],v[76:79]
C v116,v116,v117
C v117,v118,v119
M v[76:79],a[108:111],a[172:175],v[76:79]
C v118,v124,v125
C v119,v126,v127
M v[76:79],a[104:107],a[168:171],v[76:79]
buffer_store_dwordx4 v[116:119], v7, s[8:11], s30 offen offset:1024 sc1
M v[76:79],a[100:103],a[164:167],v[76:79]
SA s29,s33,12288
M v[76:79],a[96:99],a[160:163],v[76:79]
s_waitcnt lgkmcnt(0)
M v[80:83],a[64:67],a[128:131],0
SA s30,s33,26624
T a[96:97],v25,0
T a[98:99],v25,2048
M v[80:83],a[68:71],a[132:135],v[80:83]
T a[100:101],v25,4096
T a[102:103],v25,6144
M v[80:83],a[72:75],a[136:139],v[80:83]
MF v64,v5,v64
MF v65,v5,v65
M v[80:83],a[76:79],a[140:143],v[80:83]
T a[104:105],v25,8192
T a[106:107],v25,10240
M v[80:83],a[80:83],a[144:147],v[80:83]
T a[108:109],v25,12288
T a[110:111],v25,14336
M v[80:83],a[84:87],a[148:151],v[80:83]
MF v66,v5,v66
MF v67,v5,v67
M v[80:83],a[88:91],a[152:155],v[80:83]
T a[112:113],v25,16384
T a[114:115],v25,18432
M v[80:83],a[92:95],a[156:159],v[80:83]
T a[116:117],v25,20480
T a[118:119],v25,22528
M v[84:87],a[92:95],a[188:191],0
MF v72,v5,v72
MF v73,v5,v73
M v[84:87],a[88:91],a[184:187],v[84:87]
T a[120:121],v25,24576
T a[122:123],v25,26624
M v[84:87],a[84:87],a[180:183],v[84:87]
T a[124:125],v25,28672
T a[126:127],v25,30720
M v[84:87],a[80:83],a[176:179],v[84:87]
MF v74,v5,v74
MF v75,v5,v75
M v[84:87],a[76:79],a[172:175],v[84:87]
C v64,v64,v65
C v65,v66,v67
M v[84:87],a[72:75],a[168:171],v[84:87]
C v66,v72,v73
C v67,v74,v75
M v[84:87],a[68:71],a[164:167],v[84:87]
buffer_store_dwordx4 v[64:67], v7, s[8:11], s29 offen offset:0 sc1
M v[84:87],a[64:67],a[160:163],v[84:87]
s_waitcnt lgkmcnt(0)
MF v68,v6,v68
MF v69,v6,v69
M v[88:91],a[96:99],a[128:131],0
MF v70,v6,v70
MF v71,v6,v71
M v[88:91],a[100:103],a[132:135],v[88:91]
MF v76,v6,v76
MF v77,v6,v77
M v[88:91],a[104:107],a[136:139],v[88:91]
MF v78,v6,v78
MF v79,v6,v79
M v[88:91],a[108:111],a[140:143],v[88:91]
C v68,v68,v69
C v69,v70,v71
M v[88:91],a[112:115],a[144:147],v[88:91]
C v70,v76,v77
C v71,v78,v79
M v[88:91],a[116:119],a[148:151],v[88:91]
buffer_store_dwordx4 v[68:71], v7, s[8:11], s30 offen offset:0 sc1
M v[88:91],a[120:123],a[152:155],v[88:91]
M v[88:91],a[124:127],a[156:159],v[88:91]
M v[92:95],a[124:127],a[188:191],0
M v[92:95],a[120:123],a[184:187],v[92:95]
M v[92:95],a[116:119],a[180:183],v[92:95]
M v[92:95],a[112:115],a[176:179],v[92:95]
MF v80,v5,v80
MF v81,v5,v81
M v[92:95],a[108:111],a[172:175],v[92:95]
MF v82,v5,v82
MF v83,v5,v83
M v[92:95],a[104:107],a[168:171],v[92:95]
MF v88,v5,v88
MF v89,v5,v89
M v[92:95],a[100:103],a[164:167],v[92:95]
MF v90,v5,v90
MF v91,v5,v91
M v[92:95],a[96:99],a[160:163],v[92:95]
C v80,v80,v81
C v81,v82,v83
C v82,v88,v89
C v83,v90,v91
buffer_store_dwordx4 v[80:83], v7, s[8:11], s29 offen offset:1024 sc1
MF v84,v6,v84
MF v85,v6,v85
MF v86,v6,v86
MF v87,v6,v87
MF v92,v6,v92
MF v93,v6,v93
MF v94,v6,v94
MF v95,v6,v95
C v84,v84,v85
C v85,v86,v87
C v86,v92,v93
C v87,v94,v95
buffer_store_dwordx4 v[84:87], v7, s[8:11], s30 offen offset:1024 sc1
buffer_load_dword v9, v33, s[8:11], s46 offen sc1
s_waitcnt vmcnt(1)
buffer_store_dword v15, v16, s[8:11], s3 offen sc1
L_red1:
s_waitcnt vmcnt(0)
v_cmp_eq_u32 vcc, 1, v9
s_mov_b32 s91, 65536
s_mov_b32 s69, 0xffff
s_and_b32 s70, vcc_lo, s69
s_mov_b32 s68, s70
s_cmp_lg_u32 s70, 0
s_cbranch_scc1 L_rk0
s_call_b64 s[36:37], L_rpoll
L_rk0:
s_ff1_i32_b32 s71, s70
s_bitset0_b32 s70, s71
s_mul_i32 s71, s71, 114688
SA s72,s71,s77
buffer_load_dwordx4 v[128:131], v7, s[8:11], s72 offen sc1
buffer_load_dwordx4 v[132:135], v27, s[8:11], s72 offen sc1
s_cmp_lg_u32 s70, 0
s_cbranch_scc1 L_rk1
s_call_b64 s[36:37], L_rpoll
L_rk1:
s_ff1_i32_b32 s71, s70
s_bitset0_b32 s70, s71
s_mul_i32 s71, s71, 114688
SA s72,s71,s77
buffer_load_dwordx4 v[136:139], v7, s[8:11], s72 offen sc1
buffer_load_dwordx4 v[140:143], v27, s[8:11], s72 offen sc1
s_cmp_lg_u32 s70, 0
s_cbranch_scc1 L_rk2
s_call_b64 s[36:37], L_rpoll
L_rk2:
s_ff1_i32_b32 s71, s70
s_bitset0_b32 s70, s71
s_mul_i32 s71, s71, 114688
SA s72,s71,s77
buffer_load_dwordx4 v[144:147], v7, s[8:11], s72 offen sc1
buffer_load_dwordx4 v[148:151], v27, s[8:11], s72 offen sc1
v_readlane_b32 s92, v31, 0
v_readlane_b32 s94, v31, 1
v_lshlrev_b32 v64, 16, v48
v_and_b32 v65, 0xffff0000, v48
v_lshlrev_b32 v66, 16, v49
v_and_b32 v67, 0xffff0000, v49
v_lshlrev_b32 v68, 16, v50
v_and_b32 v69, 0xffff0000, v50
v_lshlrev_b32 v70, 16, v51
v_and_b32 v71, 0xffff0000, v51
v_lshlrev_b32 v72, 16, v52
v_and_b32 v73, 0xffff0000, v52
v_lshlrev_b32 v74, 16, v53
v_and_b32 v75, 0xffff0000, v53
v_lshlrev_b32 v76, 16, v54
v_and_b32 v77, 0xffff0000, v54
v_lshlrev_b32 v78, 16, v55
v_and_b32 v79, 0xffff0000, v55
v_sub_f32 v30, 1.0, v39
v_cmp_eq_u32 s[80:81], s92, v37
v_cmp_eq_u32 s[82:83], s94, v37
s_nop 0
s_or_b64 vcc, s[80:81], s[82:83]
s_cbranch_vccnz L_moe0
L_moe_ret0:
MF v64,v30,v64
MF v65,v30,v65
MF v66,v30,v66
MF v67,v30,v67
MF v68,v30,v68
MF v69,v30,v69
MF v70,v30,v70
MF v71,v30,v71
MF v72,v30,v72
MF v73,v30,v73
MF v74,v30,v74
MF v75,v30,v75
MF v76,v30,v76
MF v77,v30,v77
MF v78,v30,v78
MF v79,v30,v79
s_cmp_lg_u32 s70, 0
s_cbranch_scc1 L_rk3
s_call_b64 s[36:37], L_rpoll
L_rk3:
s_ff1_i32_b32 s71, s70
s_bitset0_b32 s70, s71
s_mul_i32 s71, s71, 114688
SA s72,s71,s77
buffer_load_dwordx4 v[152:155], v7, s[8:11], s72 offen sc1
buffer_load_dwordx4 v[156:159], v27, s[8:11], s72 offen sc1
v_lshlrev_b32 v80, 16, v44
v_and_b32 v81, 0xffff0000, v44
v_lshlrev_b32 v82, 16, v45
v_and_b32 v83, 0xffff0000, v45
v_lshlrev_b32 v84, 16, v46
v_and_b32 v85, 0xffff0000, v46
v_lshlrev_b32 v86, 16, v47
v_and_b32 v87, 0xffff0000, v47
v_sub_f32 v30, 1.0, v26
v_cmp_eq_u32 s[80:81], s92, v29
v_cmp_eq_u32 s[82:83], s94, v29
s_nop 0
s_or_b64 vcc, s[80:81], s[82:83]
s_cbranch_vccnz L_moe1
L_moe_ret1:
MF v80,v30,v80
MF v81,v30,v81
MF v82,v30,v82
MF v83,v30,v83
MF v84,v30,v84
MF v85,v30,v85
MF v86,v30,v86
MF v87,v30,v87
s_waitcnt vmcnt(7)
M v[96:99],a[246:249],v[128:131],0
M v[100:103],a[244:247],v[128:131],0
s_waitcnt vmcnt(6)
M v[104:107],a[246:249],v[132:135],0
M v[108:111],a[244:247],v[132:135],0
s_cmp_lg_u32 s70, 0
s_cbranch_scc1 L_rk4
s_call_b64 s[36:37], L_rpoll
L_rk4:
s_ff1_i32_b32 s71, s70
s_bitset0_b32 s70, s71
s_mul_i32 s71, s71, 114688
SA s72,s71,s77
buffer_load_dwordx4 v[160:163], v7, s[8:11], s72 offen sc1
buffer_load_dwordx4 v[164:167], v27, s[8:11], s72 offen sc1
s_waitcnt vmcnt(7)
M v[96:99],a[246:249],v[136:139],v[96:99]
M v[100:103],a[244:247],v[136:139],v[100:103]
s_waitcnt vmcnt(6)
M v[104:107],a[246:249],v[140:143],v[104:107]
M v[108:111],a[244:247],v[140:143],v[108:111]
s_cmp_lg_u32 s70, 0
s_cbranch_scc1 L_rk5
s_call_b64 s[36:37], L_rpoll
L_rk5:
s_ff1_i32_b32 s71, s70
s_bitset0_b32 s70, s71
s_mul_i32 s71, s71, 114688
SA s72,s71,s77
buffer_load_dwordx4 v[168:171], v7, s[8:11], s72 offen sc1
buffer_load_dwordx4 v[172:175], v27, s[8:11], s72 offen sc1
s_waitcnt vmcnt(7)
M v[96:99],a[246:249],v[144:147],v[96:99]
M v[100:103],a[244:247],v[144:147],v[100:103]
s_waitcnt vmcnt(6)
M v[104:107],a[246:249],v[148:151],v[104:107]
M v[108:111],a[244:247],v[148:151],v[108:111]
s_cmp_lg_u32 s70, 0
s_cbranch_scc1 L_rk6
s_call_b64 s[36:37], L_rpoll
L_rk6:
s_ff1_i32_b32 s71, s70
s_bitset0_b32 s70, s71
s_mul_i32 s71, s71, 114688
SA s72,s71,s77
buffer_load_dwordx4 v[176:179], v7, s[8:11], s72 offen sc1
buffer_load_dwordx4 v[180:183], v27, s[8:11], s72 offen sc1
s_waitcnt vmcnt(7)
M v[96:99],a[246:249],v[152:155],v[96:99]
M v[100:103],a[244:247],v[152:155],v[100:103]
s_waitcnt vmcnt(6)
M v[104:107],a[246:249],v[156:159],v[104:107]
M v[108:111],a[244:247],v[156:159],v[108:111]
s_cmp_lg_u32 s70, 0
s_cbranch_scc1 L_rk7
s_call_b64 s[36:37], L_rpoll
L_rk7:
s_ff1_i32_b32 s71, s70
s_bitset0_b32 s70, s71
s_mul_i32 s71, s71, 114688
SA s72,s71,s77
buffer_load_dwordx4 v[184:187], v7, s[8:11], s72 offen sc1
buffer_load_dwordx4 v[188:191], v27, s[8:11], s72 offen sc1
s_waitcnt vmcnt(7)
M v[96:99],a[246:249],v[160:163],v[96:99]
M v[100:103],a[244:247],v[160:163],v[100:103]
s_waitcnt vmcnt(6)
M v[104:107],a[246:249],v[164:167],v[104:107]
M v[108:111],a[244:247],v[164:167],v[108:111]
s_cmp_lg_u32 s70, 0
s_cbranch_scc1 L_rk8
s_call_b64 s[36:37], L_rpoll
L_rk8:
s_ff1_i32_b32 s71, s70
s_bitset0_b32 s70, s71
s_mul_i32 s71, s71, 114688
SA s72,s71,s77
buffer_load_dwordx4 v[128:131], v7, s[8:11], s72 offen sc1
buffer_load_dwordx4 v[132:135], v27, s[8:11], s72 offen sc1
s_waitcnt vmcnt(7)
M v[96:99],a[246:249],v[168:171],v[96:99]
M v[100:103],a[244:247],v[168:171],v[100:103]
s_waitcnt vmcnt(6)
M v[104:107],a[246:249],v[172:175],v[104:107]
M v[108:111],a[244:247],v[172:175],v[108:111]
s_cmp_lg_u32 s70, 0
s_cbranch_scc1 L_rk9
s_call_b64 s[36:37], L_rpoll
L_rk9:
s_ff1_i32_b32 s71, s70
s_bitset0_b32 s70, s71
s_mul_i32 s71, s71, 114688
SA s72,s71,s77
buffer_load_dwordx4 v[136:139], v7, s[8:11], s72 offen sc1
buffer_load_dwordx4 v[140:143], v27, s[8:11], s72 offen sc1
s_waitcnt vmcnt(7)
M v[96:99],a[246:249],v[176:179],v[96:99]
M v[100:103],a[244:247],v[176:179],v[100:103]
s_waitcnt vmcnt(6)
M v[104:107],a[246:249],v[180:183],v[104:107]
M v[108:111],a[244:247],v[180:183],v[108:111]
s_cmp_lg_u32 s70, 0
s_cbranch_scc1 L_rk10
s_call_b64 s[36:37], L_rpoll
L_rk10:
s_ff1_i32_b32 s71, s70
s_bitset0_b32 s70, s71
s_mul_i32 s71, s71, 114688
SA s72,s71,s77
buffer_load_dwordx4 v[144:147], v7, s[8:11], s72 offen sc1
buffer_load_dwordx4 v[148:151], v27, s[8:11], s72 offen sc1
s_waitcnt vmcnt(7)
M v[96:99],a[246:249],v[184:187],v[96:99]
M v[100:103],a[244:247],v[184:187],v[100:103]
s_waitcnt vmcnt(6)
M v[104:107],a[246:249],v[188:191],v[104:107]
M v[108:111],a[244:247],v[188:191],v[108:111]
s_cmp_lg_u32 s70, 0
s_cbranch_scc1 L_rk11
s_call_b64 s[36:37], L_rpoll
L_rk11:
s_ff1_i32_b32 s71, s70
s_bitset0_b32 s70, s71
s_mul_i32 s71, s71, 114688
SA s72,s71,s77
buffer_load_dwordx4 v[152:155], v7, s[8:11], s72 offen sc1
buffer_load_dwordx4 v[156:159], v27, s[8:11], s72 offen sc1
s_waitcnt vmcnt(7)
M v[96:99],a[246:249],v[128:131],v[96:99]
M v[100:103],a[244:247],v[128:131],v[100:103]
s_waitcnt vmcnt(6)
M v[104:107],a[246:249],v[132:135],v[104:107]
M v[108:111],a[244:247],v[132:135],v[108:111]
s_cmp_lg_u32 s70, 0
s_cbranch_scc1 L_rk12
s_call_b64 s[36:37], L_rpoll
L_rk12:
s_ff1_i32_b32 s71, s70
s_bitset0_b32 s70, s71
s_mul_i32 s71, s71, 114688
SA s72,s71,s77
buffer_load_dwordx4 v[160:163], v7, s[8:11], s72 offen sc1
buffer_load_dwordx4 v[164:167], v27, s[8:11], s72 offen sc1
buffer_load_dword v8, v33, s[8:11], s46 offen sc1
s_waitcnt vmcnt(8)
M v[96:99],a[246:249],v[136:139],v[96:99]
M v[100:103],a[244:247],v[136:139],v[100:103]
s_waitcnt vmcnt(7)
M v[104:107],a[246:249],v[140:143],v[104:107]
M v[108:111],a[244:247],v[140:143],v[108:111]
s_cmp_lg_u32 s70, 0
s_cbranch_scc1 L_rk13
s_call_b64 s[36:37], L_rpoll
L_rk13:
s_ff1_i32_b32 s71, s70
s_bitset0_b32 s70, s71
s_mul_i32 s71, s71, 114688
SA s72,s71,s77
buffer_load_dwordx4 v[168:171], v7, s[8:11], s72 offen sc1
buffer_load_dwordx4 v[172:175], v27, s[8:11], s72 offen sc1
s_waitcnt vmcnt(8)
M v[96:99],a[246:249],v[144:147],v[96:99]
M v[100:103],a[244:247],v[144:147],v[100:103]
s_waitcnt vmcnt(7)
M v[104:107],a[246:249],v[148:151],v[104:107]
M v[108:111],a[244:247],v[148:151],v[108:111]
s_cmp_lg_u32 s70, 0
s_cbranch_scc1 L_rk14
s_call_b64 s[36:37], L_rpoll
L_rk14:
s_ff1_i32_b32 s71, s70
s_bitset0_b32 s70, s71
s_mul_i32 s71, s71, 114688
SA s72,s71,s77
buffer_load_dwordx4 v[176:179], v7, s[8:11], s72 offen sc1
buffer_load_dwordx4 v[180:183], v27, s[8:11], s72 offen sc1
s_waitcnt vmcnt(8)
M v[96:99],a[246:249],v[152:155],v[96:99]
M v[100:103],a[244:247],v[152:155],v[100:103]
s_waitcnt vmcnt(7)
M v[104:107],a[246:249],v[156:159],v[104:107]
M v[108:111],a[244:247],v[156:159],v[108:111]
s_cmp_lg_u32 s70, 0
s_cbranch_scc1 L_rk15
s_call_b64 s[36:37], L_rpoll
L_rk15:
s_ff1_i32_b32 s71, s70
s_bitset0_b32 s70, s71
s_mul_i32 s71, s71, 114688
SA s72,s71,s77
buffer_load_dwordx4 v[184:187], v7, s[8:11], s72 offen sc1
buffer_load_dwordx4 v[188:191], v27, s[8:11], s72 offen sc1
s_waitcnt vmcnt(8)
M v[96:99],a[246:249],v[160:163],v[96:99]
M v[100:103],a[244:247],v[160:163],v[100:103]
s_waitcnt vmcnt(7)
M v[104:107],a[246:249],v[164:167],v[104:107]
M v[108:111],a[244:247],v[164:167],v[108:111]
s_waitcnt vmcnt(6)
v_cmp_eq_u32 vcc, 1, v8
s_mov_b32 s69, 0xffff0000
s_and_b32 s70, vcc_lo, s69
s_mov_b32 s68, s70
s_cmp_lg_u32 s70, 0
s_cbranch_scc1 L_rk16
s_call_b64 s[36:37], L_rpoll
L_rk16:
s_ff1_i32_b32 s71, s70
s_bitset0_b32 s70, s71
s_mul_i32 s71, s71, 114688
SA s72,s71,s78
buffer_load_dwordx4 v[192:195], v7, s[8:11], s72 offen sc1
s_waitcnt vmcnt(6)
M v[96:99],a[246:249],v[168:171],v[96:99]
M v[100:103],a[244:247],v[168:171],v[100:103]
s_waitcnt vmcnt(5)
M v[104:107],a[246:249],v[172:175],v[104:107]
M v[108:111],a[244:247],v[172:175],v[108:111]
s_cmp_lg_u32 s70, 0
s_cbranch_scc1 L_rk17
s_call_b64 s[36:37], L_rpoll
L_rk17:
s_ff1_i32_b32 s71, s70
s_bitset0_b32 s70, s71
s_mul_i32 s71, s71, 114688
SA s72,s71,s78
buffer_load_dwordx4 v[196:199], v7, s[8:11], s72 offen sc1
s_waitcnt vmcnt(5)
M v[96:99],a[246:249],v[176:179],v[96:99]
M v[100:103],a[244:247],v[176:179],v[100:103]
s_waitcnt vmcnt(4)
M v[104:107],a[246:249],v[180:183],v[104:107]
M v[108:111],a[244:247],v[180:183],v[108:111]
s_cmp_lg_u32 s70, 0
s_cbranch_scc1 L_rk18
s_call_b64 s[36:37], L_rpoll
L_rk18:
s_ff1_i32_b32 s71, s70
s_bitset0_b32 s70, s71
s_mul_i32 s71, s71, 114688
SA s72,s71,s78
buffer_load_dwordx4 v[200:203], v7, s[8:11], s72 offen sc1
s_waitcnt vmcnt(4)
M v[96:99],a[246:249],v[184:187],v[96:99]
M v[100:103],a[244:247],v[184:187],v[100:103]
s_waitcnt vmcnt(3)
M v[104:107],a[246:249],v[188:191],v[104:107]
M v[108:111],a[244:247],v[188:191],v[108:111]
s_nop 4
v_permlane16_swap_b32 v96, v100
v_permlane16_swap_b32 v97, v101
v_permlane16_swap_b32 v98, v102
v_permlane16_swap_b32 v99, v103
v_permlane16_swap_b32 v104, v108
v_permlane16_swap_b32 v105, v109
v_permlane16_swap_b32 v106, v110
v_permlane16_swap_b32 v107, v111
v_fmac_f32 v64, v39, v96
v_fmac_f32 v65, v39, v97
v_fmac_f32 v66, v39, v98
v_fmac_f32 v67, v39, v99
v_fmac_f32 v68, v39, v100
v_fmac_f32 v69, v39, v101
v_fmac_f32 v70, v39, v102
v_fmac_f32 v71, v39, v103
C v48,v64,v65
C v49,v66,v67
C v50,v68,v69
C v51,v70,v71
buffer_store_dwordx4 v[48:51], v38, s[52:55], s75 offen sc1
v_fmac_f32 v72, v39, v104
v_fmac_f32 v73, v39, v105
v_fmac_f32 v74, v39, v106
v_fmac_f32 v75, v39, v107
v_fmac_f32 v76, v39, v108
v_fmac_f32 v77, v39, v109
v_fmac_f32 v78, v39, v110
v_fmac_f32 v79, v39, v111
C v52,v72,v73
C v53,v74,v75
C v54,v76,v77
C v55,v78,v79
buffer_store_dwordx4 v[52:55], v38, s[52:55], s76 offen sc1
s_cmp_lg_u32 s70, 0
s_cbranch_scc1 L_rk19
s_call_b64 s[36:37], L_rpoll
L_rk19:
s_ff1_i32_b32 s71, s70
s_bitset0_b32 s70, s71
s_mul_i32 s71, s71, 114688
SA s72,s71,s78
buffer_load_dwordx4 v[204:207], v7, s[8:11], s72 offen sc1
s_cmp_lg_u32 s70, 0
s_cbranch_scc1 L_rk20
s_call_b64 s[36:37], L_rpoll
L_rk20:
s_ff1_i32_b32 s71, s70
s_bitset0_b32 s70, s71
s_mul_i32 s71, s71, 114688
SA s72,s71,s78
buffer_load_dwordx4 v[208:211], v7, s[8:11], s72 offen sc1
s_cmp_lg_u32 s70, 0
s_cbranch_scc1 L_rk21
s_call_b64 s[36:37], L_rpoll
L_rk21:
s_ff1_i32_b32 s71, s70
s_bitset0_b32 s70, s71
s_mul_i32 s71, s71, 114688
SA s72,s71,s78
buffer_load_dwordx4 v[212:215], v7, s[8:11], s72 offen sc1
s_cmp_lg_u32 s70, 0
s_cbranch_scc1 L_rk22
s_call_b64 s[36:37], L_rpoll
L_rk22:
s_ff1_i32_b32 s71, s70
s_bitset0_b32 s70, s71
s_mul_i32 s71, s71, 114688
SA s72,s71,s78
buffer_load_dwordx4 v[216:219], v7, s[8:11], s72 offen sc1
s_cmp_lg_u32 s70, 0
s_cbranch_scc1 L_rk23
s_call_b64 s[36:37], L_rpoll
L_rk23:
s_ff1_i32_b32 s71, s70
s_bitset0_b32 s70, s71
s_mul_i32 s71, s71, 114688
SA s72,s71,s78
buffer_load_dwordx4 v[220:223], v7, s[8:11], s72 offen sc1
s_cmp_lg_u32 s70, 0
s_cbranch_scc1 L_rk24
s_call_b64 s[36:37], L_rpoll
L_rk24:
s_ff1_i32_b32 s71, s70
s_bitset0_b32 s70, s71
s_mul_i32 s71, s71, 114688
SA s72,s71,s78
buffer_load_dwordx4 v[224:227], v7, s[8:11], s72 offen sc1
s_cmp_lg_u32 s70, 0
s_cbranch_scc1 L_rk25
s_call_b64 s[36:37], L_rpoll
L_rk25:
s_ff1_i32_b32 s71, s70
s_bitset0_b32 s70, s71
s_mul_i32 s71, s71, 114688
SA s72,s71,s78
buffer_load_dwordx4 v[228:231], v7, s[8:11], s72 offen sc1
s_cmp_lg_u32 s70, 0
s_cbranch_scc1 L_rk26
s_call_b64 s[36:37], L_rpoll
L_rk26:
s_ff1_i32_b32 s71, s70
s_bitset0_b32 s70, s71
s_mul_i32 s71, s71, 114688
SA s72,s71,s78
buffer_load_dwordx4 v[232:235], v7, s[8:11], s72 offen sc1
s_cmp_lg_u32 s70, 0
s_cbranch_scc1 L_rk27
s_call_b64 s[36:37], L_rpoll
L_rk27:
s_ff1_i32_b32 s71, s70
s_bitset0_b32 s70, s71
s_mul_i32 s71, s71, 114688
SA s72,s71,s78
buffer_load_dwordx4 v[236:239], v7, s[8:11], s72 offen sc1
s_waitcnt vmcnt(13)
M v[112:115],a[246:249],v[192:195],0
M v[116:119],a[244:247],v[192:195],0
s_cmp_lg_u32 s70, 0
s_cbranch_scc1 L_rk28
s_call_b64 s[36:37], L_rpoll
L_rk28:
s_ff1_i32_b32 s71, s70
s_bitset0_b32 s70, s71
s_mul_i32 s71, s71, 114688
SA s72,s71,s78
buffer_load_dwordx4 v[240:243], v7, s[8:11], s72 offen sc1
s_waitcnt vmcnt(13)
M v[112:115],a[246:249],v[196:199],v[112:115]
M v[116:119],a[244:247],v[196:199],v[116:119]
s_cmp_lg_u32 s70, 0
s_cbranch_scc1 L_rk29
s_call_b64 s[36:37], L_rpoll
L_rk29:
s_ff1_i32_b32 s71, s70
s_bitset0_b32 s70, s71
s_mul_i32 s71, s71, 114688
SA s72,s71,s78
buffer_load_dwordx4 v[244:247], v7, s[8:11], s72 offen sc1
s_waitcnt vmcnt(13)
M v[112:115],a[246:249],v[200:203],v[112:115]
M v[116:119],a[244:247],v[200:203],v[116:119]
s_cmp_lg_u32 s70, 0
s_cbranch_scc1 L_rk30
s_call_b64 s[36:37], L_rpoll
L_rk30:
s_ff1_i32_b32 s71, s70
s_bitset0_b32 s70, s71
s_mul_i32 s71, s71, 114688
SA s72,s71,s78
buffer_load_dwordx4 v[248:251], v7, s[8:11], s72 offen sc1
s_waitcnt vmcnt(11)
M v[112:115],a[246:249],v[204:207],v[112:115]
M v[116:119],a[244:247],v[204:207],v[116:119]
s_cmp_lg_u32 s70, 0
s_cbranch_scc1 L_rk31
s_call_b64 s[36:37], L_rpoll
L_rk31:
s_ff1_i32_b32 s71, s70
s_bitset0_b32 s70, s71
s_mul_i32 s71, s71, 114688
SA s72,s71,s78
buffer_load_dwordx4 v[252:255], v7, s[8:11], s72 offen sc1
s_waitcnt vmcnt(11)
M v[112:115],a[246:249],v[208:211],v[112:115]
M v[116:119],a[244:247],v[208:211],v[116:119]
s_waitcnt vmcnt(10)
M v[112:115],a[246:249],v[212:215],v[112:115]
M v[116:119],a[244:247],v[212:215],v[116:119]
s_waitcnt vmcnt(9)
M v[112:115],a[246:249],v[216:219],v[112:115]
M v[116:119],a[244:247],v[216:219],v[116:119]
s_waitcnt vmcnt(8)
M v[112:115],a[246:249],v[220:223],v[112:115]
M v[116:119],a[244:247],v[220:223],v[116:119]
s_waitcnt vmcnt(7)
M v[112:115],a[246:249],v[224:227],v[112:115]
M v[116:119],a[244:247],v[224:227],v[116:119]
s_waitcnt vmcnt(6)
M v[112:115],a[246:249],v[228:231],v[112:115]
M v[116:119],a[244:247],v[228:231],v[116:119]
s_waitcnt vmcnt(5)
M v[112:115],a[246:249],v[232:235],v[112:115]
M v[116:119],a[244:247],v[232:235],v[116:119]
s_waitcnt vmcnt(4)
M v[112:115],a[246:249],v[236:239],v[112:115]
M v[116:119],a[244:247],v[236:239],v[116:119]
s_waitcnt vmcnt(3)
M v[112:115],a[246:249],v[240:243],v[112:115]
M v[116:119],a[244:247],v[240:243],v[116:119]
s_waitcnt vmcnt(2)
M v[112:115],a[246:249],v[244:247],v[112:115]
M v[116:119],a[244:247],v[244:247],v[116:119]
s_waitcnt vmcnt(1)
M v[112:115],a[246:249],v[248:251],v[112:115]
M v[116:119],a[244:247],v[248:251],v[116:119]
s_waitcnt vmcnt(0)
M v[112:115],a[246:249],v[252:255],v[112:115]
M v[116:119],a[244:247],v[252:255],v[116:119]
s_nop 7
v_permlane16_swap_b32 v112, v116
v_permlane16_swap_b32 v113, v117
v_permlane16_swap_b32 v114, v118
v_permlane16_swap_b32 v115, v119
v_fmac_f32 v80, v26, v112
v_fmac_f32 v81, v26, v113
v_fmac_f32 v82, v26, v114
v_fmac_f32 v83, v26, v115
v_fmac_f32 v84, v26, v116
v_fmac_f32 v85, v26, v117
v_fmac_f32 v86, v26, v118
v_fmac_f32 v87, v26, v119
C v44,v80,v81
C v45,v82,v83
C v46,v84,v85
C v47,v86,v87
buffer_store_dwordx4 v[44:47], v28, s[52:55], s79 offen sc1
s_endpgm
L_rpoll0:
s_sleep 1
L_rpoll:
buffer_load_dword v9, v33, s[8:11], s46 offen sc1
s_waitcnt vmcnt(0)
v_cmp_eq_u32 vcc, 1, v9
s_sub_u32 s91, s91, 1
s_cselect_b32 s70, -1, 0
s_or_b32 s70, s70, vcc_lo
s_and_b32 s70, s70, s69
s_andn2_b32 s70, s70, s68
s_cbranch_scc0 L_rpoll0
s_or_b32 s68, s68, s70
s_setpc_b64 s[36:37]
L_moe0:
s_lshl_b32 s88, s75, 1
s_call_b64 s[36:37], L_moe
AF v64,v2,v64
AF v65,v3,v65
AF v66,v4,v66
AF v67,v5,v67
AF v68,v10,v68
AF v69,v11,v69
AF v70,v12,v70
AF v71,v13,v71
AF v72,v14,v72
AF v73,v15,v73
AF v74,v16,v74
AF v75,v17,v75
AF v76,v18,v76
AF v77,v19,v77
AF v78,v20,v78
AF v79,v21,v79
s_mov_b64 exec, -1
s_branch L_moe_ret0
L_moe1:
s_lshl_b32 s88, s79, 1
s_call_b64 s[36:37], L_moe
AF v80,v2,v80
AF v81,v3,v81
AF v82,v4,v82
AF v83,v5,v83
AF v84,v10,v84
AF v85,v11,v85
AF v86,v12,v86
AF v87,v13,v87
s_mov_b64 exec, -1
s_branch L_moe_ret1
L_moe2:
s_lshl_b32 s88, s79, 1
s_call_b64 s[36:37], L_moe
AF v48,v2,v48
AF v49,v3,v49
AF v50,v4,v50
AF v51,v5,v51
AF v52,v10,v52
AF v53,v11,v53
AF v54,v12,v54
AF v55,v13,v55
s_mov_b64 exec, -1
s_branch L_moe_ret2
L_moe:
v_min_u32 v0, 27, v32
v_lshlrev_b32 v0, 2, v0
s_mov_b32 s64, 105062912
s_mov_b32 s65, 65536
s_mov_b32 exec_lo, 0xffffffff
s_mov_b32 exec_hi, 0xffffffff
L_pfy:
buffer_load_dword v1, v0, s[8:11], s64 offen sc1
s_sub_u32 s65, s65, 1
s_cbranch_scc1 L_pfy_x
s_waitcnt vmcnt(0)
v_cmp_ne_u32 vcc, 1, v1
s_nop 0
s_cbranch_vccz L_pfy_x
s_sleep 2
s_branch L_pfy
L_pfy_x:
s_waitcnt vmcnt(0)
s_mov_b64 exec, -1
s_or_b64 exec, s[80:81], s[82:83]
v_mov_b32 v0, 1792
v_cndmask_b32 v0, v0, 0, s[80:81]
v_lshl_add_u32 v0, v34, 5, v0
SA s88,s88,104898560
buffer_load_dwordx4 v[2:5], v0, s[8:11], s88 offen sc1
buffer_load_dwordx4 v[10:13], v0, s[8:11], s88 offen offset:16 sc1
buffer_load_dwordx4 v[14:17], v0, s[8:11], s88 offen offset:512 sc1
buffer_load_dwordx4 v[18:21], v0, s[8:11], s88 offen offset:528 sc1
s_waitcnt vmcnt(0)
s_setpc_b64 s[36:37]
L_red:
v_lshrrev_b32 v32, 4, v7
s_lshr_b32 s74, s41, 3
s_lshl_b32 s64, s42, 1
SA s46,s64,s74
s_mul_i32 s46, s46, 4352
s_and_b32 s72, s41, 7
s_lshl_b32 s65, s72, 7
SA s46,s46,s65
SA s46,s46,104992768
v_and_b32 v33, 31, v32
v_lshlrev_b32 v33, 2, v33
s_lshl_b32 s65, s41, 7
SA s65,s65,104890368
buffer_load_dword v31, v33, s[8:11], s65 offen sc1
v_bfe_u32 v34, v32, 4, 1
v_lshlrev_b32 v34, 1, v34
v_lshrrev_b32 v35, 5, v32
v_add_u32 v34, v34, v35
s_mov_b32 s52, s96
s_and_b32 s53, s97, 0xffff
s_mov_b32 s54, 1835008
s_mov_b32 s55, 0x20000
s_mul_i32 s77, s42, 1835008
s_mul_i32 s78, s72, 14336
SA s77,s77,s78
SA s77,s77,67108864
s_lshl_b32 s79, s74, 1
SA s79,s79,s20
s_lshl_b32 s71, s74, 1
SA s71,s71,1
s_sub_u32 s71, s71, s20
s_and_b32 s71, s71, 536870912
s_sub_u32 s64, 15, s64
s_sub_u32 s78, s64, 1
s_mul_i32 s78, s78, 1835008
SA s78,s78,s77
s_lshl_b32 s65, s79, 10
SA s78,s78,s65
SA s78,s78,s71
s_lshl_b32 s79, s79, 6
s_or_b32 s79, s79, s71
s_mul_i32 s67, s74, -2
s_lshl_b32 s74, s74, 3
SA s74,s74,s20
s_lshl_b32 s75, s74, 6
SA s76,s75,256
SA s67,s67,3
s_sub_u32 s67, s67, s20
s_and_b32 s67, s67, 536870912
s_or_b32 s76, s76, s67
v_or_b32 v27, s67, v7
v_add_u32 v27, 4096, v27
s_lshl_b32 s65, s74, 10
SA s77,s77,s65
s_lshl_b32 s64, s64, 7
s_lshr_b32 s73, s72, 1
s_sub_u32 s65, 7, s73
s_bitcmp1_b32 s72, 0
s_cselect_b32 s73, s65, s73
s_lshl_b32 s73, s73, 4
s_lshl_b32 s65, s42, 7
SA s73,s73,s65
v_and_b32 v37, 15, v32
v_add_u32 v37, s73, v37
v_add_u32 v29, s64, v37
s_mov_b32 s64, 104857664
v_mul_u32_u24 v38, 896, v37
v_lshl_add_u32 v38, v34, 4, v38
v_lshrrev_b32 v35, 4, v37
v_lshlrev_b32 v35, 5, v35
v_and_b32 v36, 15, v37
v_add_lshl_u32 v35, v35, v36, 2
buffer_load_dword v39, v35, s[8:11], s64 offen sc1
buffer_load_dwordx4 v[48:51], v38, s[56:59], s75 offen
buffer_load_dwordx4 v[52:55], v38, s[56:59], s76 offen
v_mul_u32_u24 v28, 896, v29
v_lshl_add_u32 v28, v34, 4, v28
v_lshrrev_b32 v35, 4, v29
v_lshlrev_b32 v35, 5, v35
v_and_b32 v36, 15, v29
v_add_lshl_u32 v35, v35, v36, 2
buffer_load_dword v26, v35, s[8:11], s64 offen sc1
buffer_load_dwordx4 v[44:47], v28, s[56:59], s79 offen
s_waitcnt vmcnt(7)
buffer_load_dword v9, v33, s[8:11], s46 offen sc1
s_branch L_red1
L_code_end:
.section .rodata,"a"
.p2align 6
.amdhsa_kernel gated_mix__compressed_kv_cla__moe_arch_mod__prompt_kernel
  .amdhsa_next_free_vgpr 512
  .amdhsa_next_free_sgpr 102
  .amdhsa_accum_offset 256
  .amdhsa_group_segment_fixed_size 0
  .amdhsa_kernarg_size 120
  .amdhsa_user_sgpr_count 2
  .amdhsa_user_sgpr_kernarg_segment_ptr 1
  .amdhsa_system_sgpr_workgroup_id_x 1
  .amdhsa_float_denorm_mode_32 3
.end_amdhsa_kernel
```
